```python
import torch

def _softmax(x, axis=-1):
    return torch.softmax(x, dim=axis)

def _gelu(x):
    return torch.nn.functional.gelu(x, approximate='tanh')

def _silu(x):
    return torch.nn.functional.silu(x)

def _sigmoid(x):
    return torch.sigmoid(x)

def _layernorm(x, axis=-1, eps=1e-05):
    m = x.mean(dim=axis, keepdim=True)
    v = x.var(dim=axis, keepdim=True, unbiased=False)
    return (x - m) / torch.sqrt(v + eps)

def _scatter_add(tgt, idx, src, axis=0):
    return tgt.clone().index_add_(axis, idx, src)

def _segment_sum(src, seg, n):
    out = torch.zeros((n,) + src.shape[1:], dtype=src.dtype)
    return out.index_add_(0, seg, src)

def _pad(x, pw):
    flat = tuple((v for pair in reversed(pw) for v in pair))
    return torch.nn.functional.pad(x, flat)
kernel_name = 'adaLN_cond__gqa_block_cached__moe_arch_mod__prompt'

def setup_inputs():

    _w = lambda a: (lambda t: t.to(torch.bfloat16) if t.is_floating_point() else t)(torch.as_tensor(a))

    def _A_setup():
        B, Sq, D = (1, 2048, 576)
        Hq, Hkv, Sk, Dh = (32, 16, 2048, 128)
        assert Hq % Hkv == 0, (Hq, Hkv)
        return {'x': _w((lambda *s: torch.randn(*s, dtype=torch.bfloat16) * 0.1)(B, Sq, D)), 'k_cache': _w((lambda *s: torch.randn(*s, dtype=torch.bfloat16) * 0.8)(B, Hkv, Sk, Dh)), 'v_cache': _w((lambda *s: torch.randn(*s, dtype=torch.bfloat16) * 0.8)(B, Hkv, Sk, Dh)), 'wq': _w((lambda *s: torch.randn(*s, dtype=torch.bfloat16) * 0.8)(D, Hq * Dh) * D ** (-0.5)), 'wo': _w((lambda *s: torch.randn(*s, dtype=torch.bfloat16) * 0.8)(Hq * Dh, D) * (Hq * Dh) ** (-0.5))}
    _A_in = _A_setup()

    def _B_setup():
        B, S, D, F, C = (1, 2048, 576, 4608, 2)
        return {'x': _w((lambda *s: torch.randn(*s, dtype=torch.bfloat16) * 0.1)(B, S, D)), 'w_r': _w((lambda *s: torch.randn(*s, dtype=torch.bfloat16) * 3.2)(D)), 'w_gate': _w((lambda *s: torch.randn(*s, dtype=torch.bfloat16) * 0.2)(D, F)), 'w_up': _w((lambda *s: torch.randn(*s, dtype=torch.bfloat16) * 0.2)(D, F)), 'w_down': _w((lambda *s: torch.randn(*s, dtype=torch.bfloat16) * 0.2)(F, D))}
    _B_in = _B_setup()
    return {'A_x': _A_in['x'], 'A_k_cache': _A_in['k_cache'], 'A_v_cache': _A_in['v_cache'], 'A_wq': _A_in['wq'], 'A_wo': _A_in['wo'], 'B_x': _B_in['x'], 'B_w_r': _B_in['w_r'], 'B_w_gate': _B_in['w_gate'], 'B_w_up': _B_in['w_up'], 'B_w_down': _B_in['w_down'], 'c': _w((lambda *s: torch.randn(*s, dtype=torch.bfloat16) * 0.4)(1, 576) * 8.0), 'w_mod': _w((lambda *s: torch.randn(*s, dtype=torch.bfloat16) * 0.4)(576, 6 * 576) * 576 ** (-0.5) * 8.0)}

def reference(A_x, A_k_cache, A_v_cache, A_wq, A_wo, B_x, B_w_r, B_w_gate, B_w_up, B_w_down, c, w_mod):

    def _A_ref(x, k_cache, v_cache, wq, wo):
        B, Sq, D = x.shape
        Hq, Dh = (32, 128)
        Hkv = k_cache.shape[1]
        rep = Hq // Hkv
        q = (lambda x, *d: x.permute(*d))((x @ wq).reshape(B, Sq, Hq, Dh), 0, 2, 1, 3)
        k = (lambda x, n, axis: torch.repeat_interleave(x, n, dim=axis))(k_cache, rep, axis=1)
        v = (lambda x, n, axis: torch.repeat_interleave(x, n, dim=axis))(v_cache, rep, axis=1)
        scores = torch.einsum('bhqd,bhkd->bhqk', q, k) * Dh ** (-0.5)
        p = _softmax(scores, axis=-1)
        o = torch.einsum('bhqk,bhkd->bhqd', p, v)
        return (lambda x, *d: x.permute(*d))(o, 0, 2, 1, 3).reshape(B, Sq, Hq * Dh) @ wo

    def _B_ref(x, w_r, w_gate, w_up, w_down):
        B, S, D = x.shape
        C = 2
        r = x @ w_r
        idx = torch.argsort(-r, axis=-1)[:, :C]
        idx_e = (lambda x, n, axis: torch.repeat_interleave(x, n, dim=axis))(idx.reshape(B, C, 1), D, axis=2)
        x_sel = (lambda x, i, axis: torch.take_along_dim(x, i, dim=axis))(x, idx_e, axis=1)
        g = _silu(x_sel @ w_gate)
        u = x_sel @ w_up
        y = g * u @ w_down
        r_sel = _sigmoid((lambda x, i, axis: torch.take_along_dim(x, i, dim=axis))(r, idx, axis=1))
        y = y * r_sel.reshape(B, C, 1)
        b_off = (torch.arange(B) * S).reshape(B, 1)
        flat_idx = (idx + b_off).reshape(B * C)
        zero = (x * 0.0).reshape(B * S, D)
        upd = _scatter_add(zero, flat_idx, y.reshape(B * C, D), axis=0)
        return x + upd.reshape(B, S, D)
    x = A_x
    mod = (_silu(c) @ w_mod).reshape(c.shape[0], 6, 1, -1)
    sa, ca, ga, sb, cb, gb = (mod[:, 0].clone(), mod[:, 1].clone(), mod[:, 2].clone(), mod[:, 3].clone(), mod[:, 4].clone(), mod[:, 5].clone())
    h = _layernorm(x, axis=-1) * (1 + ca) + sa
    x = x + ga * _A_ref(h, A_k_cache, A_v_cache, A_wq, A_wo)
    h = _layernorm(x, axis=-1) * (1 + cb) + sb
    x = x + gb * _B_ref(h, B_w_r, B_w_gate, B_w_up, B_w_down)
    return x
```

```asm
; @launch kernel=mod_kernel grid=(108,1,1) block=(256,1,1) lds=512
; @launch kernel=ln1_kernel grid=(256,1,1) block=(576,1,1) lds=1024
; @launch kernel=attn_kernel grid=(256,1,1) block=(256,1,1) lds=163840
; @launch kernel=post_kernel grid=(256,1,1) block=(576,1,1) lds=2048
; @launch kernel=ffn_kernel grid=(144,1,1) block=(576,1,1) lds=45056
; @launch kernel=fin_kernel grid=(36,1,1) block=(192,1,1) lds=512
.amdgcn_target "amdgcn-amd-amdhsa--gfx950"
.text
.globl mod_kernel
.p2align 8
.type mod_kernel,@function
mod_kernel:
    s_cmp_ge_u32 s2, 108
    s_cbranch_scc1 Lmod_end
    s_load_dwordx4 s[4:7], s[0:1], 80
    s_load_dwordx2 s[16:17], s[0:1], 112
    v_and_b32 v1, 3, v0
    v_lshrrev_b32 v2, 2, v0
    v_mul_u32_u24 v3, 6912, v2
    s_lshl_b32 s3, s2, 6
    v_lshl_add_u32 v3, v1, 4, v3
    v_add_u32 v3, s3, v3
    v_lshlrev_b32 v4, 1, v2
    s_waitcnt lgkmcnt(0)
    s_mov_b32 s8, s4
    s_mov_b32 s9, s5
    s_mov_b32 s10, 1152
    s_mov_b32 s11, 0x20000
    s_mov_b32 s12, s6
    s_mov_b32 s13, s7
    s_mov_b32 s14, 3981312
    s_mov_b32 s15, 0x20000
    s_mov_b32 s18, 13824
    s_mov_b32 s19, 0x20000
    buffer_load_ushort v8, v4, s[8:11], 0 offen offset:0
    buffer_load_ushort v9, v4, s[8:11], 0 offen offset:128
    buffer_load_ushort v10, v4, s[8:11], 0 offen offset:256
    buffer_load_ushort v11, v4, s[8:11], 0 offen offset:384
    buffer_load_ushort v12, v4, s[8:11], 0 offen offset:512
    buffer_load_ushort v13, v4, s[8:11], 0 offen offset:640
    buffer_load_ushort v14, v4, s[8:11], 0 offen offset:768
    buffer_load_ushort v15, v4, s[8:11], 0 offen offset:896
    buffer_load_ushort v16, v4, s[8:11], 0 offen offset:1024
    s_mov_b32 s20, 0
    buffer_load_dwordx4 v[20:23], v3, s[12:15], s20 offen
    s_mov_b32 s20, 442368
    buffer_load_dwordx4 v[24:27], v3, s[12:15], s20 offen
    s_mov_b32 s20, 884736
    buffer_load_dwordx4 v[28:31], v3, s[12:15], s20 offen
    s_mov_b32 s20, 1327104
    buffer_load_dwordx4 v[32:35], v3, s[12:15], s20 offen
    s_mov_b32 s20, 1769472
    buffer_load_dwordx4 v[36:39], v3, s[12:15], s20 offen
    s_mov_b32 s20, 2211840
    buffer_load_dwordx4 v[40:43], v3, s[12:15], s20 offen
    s_mov_b32 s20, 2654208
    buffer_load_dwordx4 v[44:47], v3, s[12:15], s20 offen
    s_mov_b32 s20, 3096576
    buffer_load_dwordx4 v[48:51], v3, s[12:15], s20 offen
    s_mov_b32 s20, 3538944
    buffer_load_dwordx4 v[52:55], v3, s[12:15], s20 offen
    s_waitcnt vmcnt(9)
    v_lshlrev_b32 v8, 16, v8
    v_mul_f32 v5, 0xbfb8aa3b, v8
    v_min_f32 v5, 0x42fc0000, v5
    v_exp_f32 v5, v5
    s_nop 0
    v_add_f32 v5, 1.0, v5
    v_rcp_f32 v6, v5
    s_nop 0
    v_mul_f32 v7, v8, v6
    v_fma_f32 v5, -v7, v5, v8
    v_fma_f32 v8, v5, v6, v7
    v_cvt_pk_bf16_f32 v8, v8, v8
    v_and_b32 v8, 0xffff0000, v8
    v_lshlrev_b32 v9, 16, v9
    v_mul_f32 v5, 0xbfb8aa3b, v9
    v_min_f32 v5, 0x42fc0000, v5
    v_exp_f32 v5, v5
    s_nop 0
    v_add_f32 v5, 1.0, v5
    v_rcp_f32 v6, v5
    s_nop 0
    v_mul_f32 v7, v9, v6
    v_fma_f32 v5, -v7, v5, v9
    v_fma_f32 v9, v5, v6, v7
    v_cvt_pk_bf16_f32 v9, v9, v9
    v_and_b32 v9, 0xffff0000, v9
    v_lshlrev_b32 v10, 16, v10
    v_mul_f32 v5, 0xbfb8aa3b, v10
    v_min_f32 v5, 0x42fc0000, v5
    v_exp_f32 v5, v5
    s_nop 0
    v_add_f32 v5, 1.0, v5
    v_rcp_f32 v6, v5
    s_nop 0
    v_mul_f32 v7, v10, v6
    v_fma_f32 v5, -v7, v5, v10
    v_fma_f32 v10, v5, v6, v7
    v_cvt_pk_bf16_f32 v10, v10, v10
    v_and_b32 v10, 0xffff0000, v10
    v_lshlrev_b32 v11, 16, v11
    v_mul_f32 v5, 0xbfb8aa3b, v11
    v_min_f32 v5, 0x42fc0000, v5
    v_exp_f32 v5, v5
    s_nop 0
    v_add_f32 v5, 1.0, v5
    v_rcp_f32 v6, v5
    s_nop 0
    v_mul_f32 v7, v11, v6
    v_fma_f32 v5, -v7, v5, v11
    v_fma_f32 v11, v5, v6, v7
    v_cvt_pk_bf16_f32 v11, v11, v11
    v_and_b32 v11, 0xffff0000, v11
    v_lshlrev_b32 v12, 16, v12
    v_mul_f32 v5, 0xbfb8aa3b, v12
    v_min_f32 v5, 0x42fc0000, v5
    v_exp_f32 v5, v5
    s_nop 0
    v_add_f32 v5, 1.0, v5
    v_rcp_f32 v6, v5
    s_nop 0
    v_mul_f32 v7, v12, v6
    v_fma_f32 v5, -v7, v5, v12
    v_fma_f32 v12, v5, v6, v7
    v_cvt_pk_bf16_f32 v12, v12, v12
    v_and_b32 v12, 0xffff0000, v12
    v_lshlrev_b32 v13, 16, v13
    v_mul_f32 v5, 0xbfb8aa3b, v13
    v_min_f32 v5, 0x42fc0000, v5
    v_exp_f32 v5, v5
    s_nop 0
    v_add_f32 v5, 1.0, v5
    v_rcp_f32 v6, v5
    s_nop 0
    v_mul_f32 v7, v13, v6
    v_fma_f32 v5, -v7, v5, v13
    v_fma_f32 v13, v5, v6, v7
    v_cvt_pk_bf16_f32 v13, v13, v13
    v_and_b32 v13, 0xffff0000, v13
    v_lshlrev_b32 v14, 16, v14
    v_mul_f32 v5, 0xbfb8aa3b, v14
    v_min_f32 v5, 0x42fc0000, v5
    v_exp_f32 v5, v5
    s_nop 0
    v_add_f32 v5, 1.0, v5
    v_rcp_f32 v6, v5
    s_nop 0
    v_mul_f32 v7, v14, v6
    v_fma_f32 v5, -v7, v5, v14
    v_fma_f32 v14, v5, v6, v7
    v_cvt_pk_bf16_f32 v14, v14, v14
    v_and_b32 v14, 0xffff0000, v14
    v_lshlrev_b32 v15, 16, v15
    v_mul_f32 v5, 0xbfb8aa3b, v15
    v_min_f32 v5, 0x42fc0000, v5
    v_exp_f32 v5, v5
    s_nop 0
    v_add_f32 v5, 1.0, v5
    v_rcp_f32 v6, v5
    s_nop 0
    v_mul_f32 v7, v15, v6
    v_fma_f32 v5, -v7, v5, v15
    v_fma_f32 v15, v5, v6, v7
    v_cvt_pk_bf16_f32 v15, v15, v15
    v_and_b32 v15, 0xffff0000, v15
    v_lshlrev_b32 v16, 16, v16
    v_mul_f32 v5, 0xbfb8aa3b, v16
    v_min_f32 v5, 0x42fc0000, v5
    v_exp_f32 v5, v5
    s_nop 0
    v_add_f32 v5, 1.0, v5
    v_rcp_f32 v6, v5
    s_nop 0
    v_mul_f32 v7, v16, v6
    v_fma_f32 v5, -v7, v5, v16
    v_fma_f32 v16, v5, v6, v7
    v_cvt_pk_bf16_f32 v16, v16, v16
    v_and_b32 v16, 0xffff0000, v16
    s_waitcnt vmcnt(8)
    v_lshlrev_b32 v64, 16, v20
    v_and_b32 v65, 0xffff0000, v20
    v_lshlrev_b32 v66, 16, v21
    v_and_b32 v67, 0xffff0000, v21
    v_lshlrev_b32 v68, 16, v22
    v_and_b32 v69, 0xffff0000, v22
    v_lshlrev_b32 v70, 16, v23
    v_and_b32 v71, 0xffff0000, v23
    v_mul_f32 v56, v8, v64
    v_mul_f32 v57, v8, v65
    v_mul_f32 v58, v8, v66
    v_mul_f32 v59, v8, v67
    v_mul_f32 v60, v8, v68
    v_mul_f32 v61, v8, v69
    v_mul_f32 v62, v8, v70
    v_mul_f32 v63, v8, v71
    s_waitcnt vmcnt(7)
    v_lshlrev_b32 v64, 16, v24
    v_and_b32 v65, 0xffff0000, v24
    v_lshlrev_b32 v66, 16, v25
    v_and_b32 v67, 0xffff0000, v25
    v_lshlrev_b32 v68, 16, v26
    v_and_b32 v69, 0xffff0000, v26
    v_lshlrev_b32 v70, 16, v27
    v_and_b32 v71, 0xffff0000, v27
    v_fmac_f32 v56, v9, v64
    v_fmac_f32 v57, v9, v65
    v_fmac_f32 v58, v9, v66
    v_fmac_f32 v59, v9, v67
    v_fmac_f32 v60, v9, v68
    v_fmac_f32 v61, v9, v69
    v_fmac_f32 v62, v9, v70
    v_fmac_f32 v63, v9, v71
    s_waitcnt vmcnt(6)
    v_lshlrev_b32 v64, 16, v28
    v_and_b32 v65, 0xffff0000, v28
    v_lshlrev_b32 v66, 16, v29
    v_and_b32 v67, 0xffff0000, v29
    v_lshlrev_b32 v68, 16, v30
    v_and_b32 v69, 0xffff0000, v30
    v_lshlrev_b32 v70, 16, v31
    v_and_b32 v71, 0xffff0000, v31
    v_fmac_f32 v56, v10, v64
    v_fmac_f32 v57, v10, v65
    v_fmac_f32 v58, v10, v66
    v_fmac_f32 v59, v10, v67
    v_fmac_f32 v60, v10, v68
    v_fmac_f32 v61, v10, v69
    v_fmac_f32 v62, v10, v70
    v_fmac_f32 v63, v10, v71
    s_waitcnt vmcnt(5)
    v_lshlrev_b32 v64, 16, v32
    v_and_b32 v65, 0xffff0000, v32
    v_lshlrev_b32 v66, 16, v33
    v_and_b32 v67, 0xffff0000, v33
    v_lshlrev_b32 v68, 16, v34
    v_and_b32 v69, 0xffff0000, v34
    v_lshlrev_b32 v70, 16, v35
    v_and_b32 v71, 0xffff0000, v35
    v_fmac_f32 v56, v11, v64
    v_fmac_f32 v57, v11, v65
    v_fmac_f32 v58, v11, v66
    v_fmac_f32 v59, v11, v67
    v_fmac_f32 v60, v11, v68
    v_fmac_f32 v61, v11, v69
    v_fmac_f32 v62, v11, v70
    v_fmac_f32 v63, v11, v71
    s_waitcnt vmcnt(4)
    v_lshlrev_b32 v64, 16, v36
    v_and_b32 v65, 0xffff0000, v36
    v_lshlrev_b32 v66, 16, v37
    v_and_b32 v67, 0xffff0000, v37
    v_lshlrev_b32 v68, 16, v38
    v_and_b32 v69, 0xffff0000, v38
    v_lshlrev_b32 v70, 16, v39
    v_and_b32 v71, 0xffff0000, v39
    v_fmac_f32 v56, v12, v64
    v_fmac_f32 v57, v12, v65
    v_fmac_f32 v58, v12, v66
    v_fmac_f32 v59, v12, v67
    v_fmac_f32 v60, v12, v68
    v_fmac_f32 v61, v12, v69
    v_fmac_f32 v62, v12, v70
    v_fmac_f32 v63, v12, v71
    s_waitcnt vmcnt(3)
    v_lshlrev_b32 v64, 16, v40
    v_and_b32 v65, 0xffff0000, v40
    v_lshlrev_b32 v66, 16, v41
    v_and_b32 v67, 0xffff0000, v41
    v_lshlrev_b32 v68, 16, v42
    v_and_b32 v69, 0xffff0000, v42
    v_lshlrev_b32 v70, 16, v43
    v_and_b32 v71, 0xffff0000, v43
    v_fmac_f32 v56, v13, v64
    v_fmac_f32 v57, v13, v65
    v_fmac_f32 v58, v13, v66
    v_fmac_f32 v59, v13, v67
    v_fmac_f32 v60, v13, v68
    v_fmac_f32 v61, v13, v69
    v_fmac_f32 v62, v13, v70
    v_fmac_f32 v63, v13, v71
    s_waitcnt vmcnt(2)
    v_lshlrev_b32 v64, 16, v44
    v_and_b32 v65, 0xffff0000, v44
    v_lshlrev_b32 v66, 16, v45
    v_and_b32 v67, 0xffff0000, v45
    v_lshlrev_b32 v68, 16, v46
    v_and_b32 v69, 0xffff0000, v46
    v_lshlrev_b32 v70, 16, v47
    v_and_b32 v71, 0xffff0000, v47
    v_fmac_f32 v56, v14, v64
    v_fmac_f32 v57, v14, v65
    v_fmac_f32 v58, v14, v66
    v_fmac_f32 v59, v14, v67
    v_fmac_f32 v60, v14, v68
    v_fmac_f32 v61, v14, v69
    v_fmac_f32 v62, v14, v70
    v_fmac_f32 v63, v14, v71
    s_waitcnt vmcnt(1)
    v_lshlrev_b32 v64, 16, v48
    v_and_b32 v65, 0xffff0000, v48
    v_lshlrev_b32 v66, 16, v49
    v_and_b32 v67, 0xffff0000, v49
    v_lshlrev_b32 v68, 16, v50
    v_and_b32 v69, 0xffff0000, v50
    v_lshlrev_b32 v70, 16, v51
    v_and_b32 v71, 0xffff0000, v51
    v_fmac_f32 v56, v15, v64
    v_fmac_f32 v57, v15, v65
    v_fmac_f32 v58, v15, v66
    v_fmac_f32 v59, v15, v67
    v_fmac_f32 v60, v15, v68
    v_fmac_f32 v61, v15, v69
    v_fmac_f32 v62, v15, v70
    v_fmac_f32 v63, v15, v71
    s_waitcnt vmcnt(0)
    v_lshlrev_b32 v64, 16, v52
    v_and_b32 v65, 0xffff0000, v52
    v_lshlrev_b32 v66, 16, v53
    v_and_b32 v67, 0xffff0000, v53
    v_lshlrev_b32 v68, 16, v54
    v_and_b32 v69, 0xffff0000, v54
    v_lshlrev_b32 v70, 16, v55
    v_and_b32 v71, 0xffff0000, v55
    v_fmac_f32 v56, v16, v64
    v_fmac_f32 v57, v16, v65
    v_fmac_f32 v58, v16, v66
    v_fmac_f32 v59, v16, v67
    v_fmac_f32 v60, v16, v68
    v_fmac_f32 v61, v16, v69
    v_fmac_f32 v62, v16, v70
    v_fmac_f32 v63, v16, v71
    s_nop 1
    v_add_f32_dpp v56, v56, v56 row_ror:4 row_mask:0xf bank_mask:0xf
    v_add_f32_dpp v57, v57, v57 row_ror:4 row_mask:0xf bank_mask:0xf
    v_add_f32_dpp v58, v58, v58 row_ror:4 row_mask:0xf bank_mask:0xf
    v_add_f32_dpp v59, v59, v59 row_ror:4 row_mask:0xf bank_mask:0xf
    v_add_f32_dpp v60, v60, v60 row_ror:4 row_mask:0xf bank_mask:0xf
    v_add_f32_dpp v61, v61, v61 row_ror:4 row_mask:0xf bank_mask:0xf
    v_add_f32_dpp v62, v62, v62 row_ror:4 row_mask:0xf bank_mask:0xf
    v_add_f32_dpp v63, v63, v63 row_ror:4 row_mask:0xf bank_mask:0xf
    s_nop 1
    v_add_f32_dpp v56, v56, v56 row_ror:8 row_mask:0xf bank_mask:0xf
    v_add_f32_dpp v57, v57, v57 row_ror:8 row_mask:0xf bank_mask:0xf
    v_add_f32_dpp v58, v58, v58 row_ror:8 row_mask:0xf bank_mask:0xf
    v_add_f32_dpp v59, v59, v59 row_ror:8 row_mask:0xf bank_mask:0xf
    v_add_f32_dpp v60, v60, v60 row_ror:8 row_mask:0xf bank_mask:0xf
    v_add_f32_dpp v61, v61, v61 row_ror:8 row_mask:0xf bank_mask:0xf
    v_add_f32_dpp v62, v62, v62 row_ror:8 row_mask:0xf bank_mask:0xf
    v_add_f32_dpp v63, v63, v63 row_ror:8 row_mask:0xf bank_mask:0xf
    v_mov_b32 v64, v56
    v_mov_b32 v65, v57
    v_mov_b32 v66, v58
    v_mov_b32 v67, v59
    v_mov_b32 v68, v60
    v_mov_b32 v69, v61
    v_mov_b32 v70, v62
    v_mov_b32 v71, v63
    s_nop 1
    v_permlane16_swap_b32 v56, v64
    v_permlane16_swap_b32 v57, v65
    v_permlane16_swap_b32 v58, v66
    v_permlane16_swap_b32 v59, v67
    v_permlane16_swap_b32 v60, v68
    v_permlane16_swap_b32 v61, v69
    v_permlane16_swap_b32 v62, v70
    v_permlane16_swap_b32 v63, v71
    s_nop 1
    v_add_f32 v56, v56, v64
    v_add_f32 v57, v57, v65
    v_add_f32 v58, v58, v66
    v_add_f32 v59, v59, v67
    v_add_f32 v60, v60, v68
    v_add_f32 v61, v61, v69
    v_add_f32 v62, v62, v70
    v_add_f32 v63, v63, v71
    v_mov_b32 v64, v56
    v_mov_b32 v65, v57
    v_mov_b32 v66, v58
    v_mov_b32 v67, v59
    v_mov_b32 v68, v60
    v_mov_b32 v69, v61
    v_mov_b32 v70, v62
    v_mov_b32 v71, v63
    s_nop 1
    v_permlane32_swap_b32 v56, v64
    v_permlane32_swap_b32 v57, v65
    v_permlane32_swap_b32 v58, v66
    v_permlane32_swap_b32 v59, v67
    v_permlane32_swap_b32 v60, v68
    v_permlane32_swap_b32 v61, v69
    v_permlane32_swap_b32 v62, v70
    v_permlane32_swap_b32 v63, v71
    s_nop 1
    v_add_f32 v56, v56, v64
    v_add_f32 v57, v57, v65
    v_add_f32 v58, v58, v66
    v_add_f32 v59, v59, v67
    v_add_f32 v60, v60, v68
    v_add_f32 v61, v61, v69
    v_add_f32 v62, v62, v70
    v_add_f32 v63, v63, v71
    v_lshrrev_b32 v5, 6, v0
    v_lshlrev_b32 v5, 7, v5
    v_lshl_add_u32 v5, v1, 5, v5
    ds_write_b128 v5, v[56:59]
    ds_write_b128 v5, v[60:63] offset:16
    s_waitcnt lgkmcnt(0)
    s_barrier
    v_cmp_gt_u32 vcc, 32, v0
    s_and_saveexec_b64 s[22:23], vcc
    s_cbranch_execz Lmod_end
    v_lshlrev_b32 v5, 2, v0
    ds_read2_b32 v[6:7], v5 offset0:0 offset1:32
    ds_read2_b32 v[8:9], v5 offset0:64 offset1:96
    s_lshl_b32 s3, s2, 7
    s_waitcnt lgkmcnt(0)
    v_add_f32 v6, v6, v7
    v_add_f32 v8, v8, v9
    v_add_f32 v6, v6, v8
    v_cvt_pk_bf16_f32 v6, v6, v6
    v_and_b32 v6, 0xffff0000, v6
    buffer_store_dword v6, v5, s[16:19], s3 offen
Lmod_end:
    s_endpgm
.globl ln1_kernel
.p2align 8
.type ln1_kernel,@function
ln1_kernel:
    s_cmp_ge_u32 s2, 256
    s_cbranch_scc1 Lln1_end
    s_load_dwordx2 s[4:5], s[0:1], 0
    s_load_dwordx2 s[6:7], s[0:1], 112
    v_and_b32 v1, 7, v0
    v_lshrrev_b32 v2, 5, v0
    v_lshlrev_b32 v2, 6, v2
    v_and_b32 v3, 24, v0
    v_add_u32 v2, v2, v3
    s_lshl_b32 s3, s2, 3
    v_add_u32 v3, s3, v1
    v_mul_u32_u24 v3, 1152, v3
    v_add_u32 v3, v3, v2
    v_lshlrev_b32 v5, 7, v1
    v_lshrrev_b32 v4, 6, v0
    v_lshl_add_u32 v4, v4, 2, v5
    v_lshlrev_b32 v6, 1, v2
    s_waitcnt lgkmcnt(0)
    s_mov_b32 s8, s4
    s_mov_b32 s9, s5
    s_mov_b32 s10, 2359296
    s_mov_b32 s11, 0x20000
    s_mov_b32 s12, s6
    s_mov_b32 s13, s7
    s_mov_b32 s14, 13824
    s_mov_b32 s15, 0x20000
    s_add_u32 s16, s6, 65536
    s_addc_u32 s17, s7, 0
    s_mov_b32 s18, 2359296
    s_mov_b32 s19, 0x20000
    buffer_load_dwordx2 v[8:9], v3, s[8:11], 0 offen
    buffer_load_dwordx2 v[10:11], v3, s[8:11], 0 offen offset:32
    s_mov_b32 s30, 0
    buffer_load_dwordx4 v[24:27], v6, s[12:15], s30 offen
    buffer_load_dwordx4 v[28:31], v6, s[12:15], s30 offen offset:64
    s_mov_b32 s30, 2304
    buffer_load_dwordx4 v[32:35], v6, s[12:15], s30 offen
    buffer_load_dwordx4 v[36:39], v6, s[12:15], s30 offen offset:64
    s_lshr_b32 s20, s2, 1
    s_mul_i32 s20, s20, 18432
    s_and_b32 s21, s2, 1
    s_lshl_b32 s21, s21, 7
    s_add_u32 s20, s20, s21
    v_lshrrev_b32 v7, 3, v0
    v_lshlrev_b32 v7, 8, v7
    v_lshl_add_u32 v7, v1, 4, v7
    s_waitcnt vmcnt(4)
    v_lshlrev_b32 v16, 16, v8
    v_and_b32 v17, 0xffff0000, v8
    v_lshlrev_b32 v18, 16, v9
    v_and_b32 v19, 0xffff0000, v9
    v_lshlrev_b32 v20, 16, v10
    v_and_b32 v21, 0xffff0000, v10
    v_lshlrev_b32 v22, 16, v11
    v_and_b32 v23, 0xffff0000, v11
    v_add_f32 v40, v16, v17
    v_add_f32 v40, v40, v18
    v_add_f32 v40, v40, v19
    v_add_f32 v40, v40, v20
    v_add_f32 v40, v40, v21
    v_add_f32 v40, v40, v22
    v_add_f32 v40, v40, v23
    s_nop 1
    v_add_f32_dpp v40, v40, v40 row_ror:8 row_mask:0xf bank_mask:0xf
    v_mov_b32 v42, v40
    s_nop 1
    v_permlane16_swap_b32 v40, v42
    s_nop 1
    v_add_f32 v40, v40, v42
    v_mov_b32 v42, v40
    s_nop 1
    v_permlane32_swap_b32 v40, v42
    s_nop 1
    v_add_f32 v40, v40, v42
    v_mul_f32 v40, 0x3c800000, v40
    v_sub_f32 v64, v16, v40
    v_sub_f32 v65, v17, v40
    v_sub_f32 v66, v18, v40
    v_sub_f32 v67, v19, v40
    v_sub_f32 v68, v20, v40
    v_sub_f32 v69, v21, v40
    v_sub_f32 v70, v22, v40
    v_sub_f32 v71, v23, v40
    v_mul_f32 v41, v64, v64
    v_fmac_f32 v41, v65, v65
    v_fmac_f32 v41, v66, v66
    v_fmac_f32 v41, v67, v67
    v_fmac_f32 v41, v68, v68
    v_fmac_f32 v41, v69, v69
    v_fmac_f32 v41, v70, v70
    v_fmac_f32 v41, v71, v71
    s_nop 1
    v_add_f32_dpp v41, v41, v41 row_ror:8 row_mask:0xf bank_mask:0xf
    v_mov_b32 v42, v41
    s_nop 1
    v_permlane16_swap_b32 v41, v42
    s_nop 1
    v_add_f32 v41, v41, v42
    v_mov_b32 v42, v41
    s_nop 1
    v_permlane32_swap_b32 v41, v42
    s_nop 1
    v_add_f32 v41, v41, v42
    ds_write2_b32 v4, v40, v41 offset0:0 offset1:16
    s_waitcnt lgkmcnt(0)
    s_barrier
    ds_read_b128 v[44:47], v5
    ds_read_b128 v[48:51], v5 offset:16
    ds_read_b32 v52, v5 offset:32
    ds_read_b128 v[56:59], v5 offset:64
    ds_read_b128 v[60:63], v5 offset:80
    ds_read_b32 v64, v5 offset:96
    s_waitcnt lgkmcnt(3)
    v_add_f32 v40, v44, v45
    v_add_f32 v40, v40, v46
    v_add_f32 v40, v40, v47
    v_add_f32 v40, v40, v48
    v_add_f32 v40, v40, v49
    v_add_f32 v40, v40, v50
    v_add_f32 v40, v40, v51
    v_add_f32 v40, v40, v52
    v_mul_f32 v40, 0x3de38e39, v40
    v_sub_f32 v44, v44, v40
    v_sub_f32 v45, v45, v40
    v_sub_f32 v46, v46, v40
    v_sub_f32 v47, v47, v40
    v_sub_f32 v48, v48, v40
    v_sub_f32 v49, v49, v40
    v_sub_f32 v50, v50, v40
    v_sub_f32 v51, v51, v40
    v_sub_f32 v52, v52, v40
    v_mul_f32 v42, v44, v44
    v_fmac_f32 v42, v45, v45
    v_fmac_f32 v42, v46, v46
    v_fmac_f32 v42, v47, v47
    v_fmac_f32 v42, v48, v48
    v_fmac_f32 v42, v49, v49
    v_fmac_f32 v42, v50, v50
    v_fmac_f32 v42, v51, v51
    v_fmac_f32 v42, v52, v52
    s_waitcnt lgkmcnt(0)
    v_add_f32 v41, v56, v57
    v_add_f32 v41, v41, v58
    v_add_f32 v41, v41, v59
    v_add_f32 v41, v41, v60
    v_add_f32 v41, v41, v61
    v_add_f32 v41, v41, v62
    v_add_f32 v41, v41, v63
    v_add_f32 v41, v41, v64
    v_fmac_f32 v41, 0x42800000, v42
    v_mul_f32 v41, 0x3ae38e39, v41
    v_cvt_pk_bf16_f32 v42, v40, v41
    v_lshlrev_b32 v40, 16, v42
    v_and_b32 v41, 0xffff0000, v42
    v_add_f32 v41, 0x3727c5ac, v41
    v_cvt_pk_bf16_f32 v41, v41, v41
    v_and_b32 v41, 0xffff0000, v41
    v_sqrt_f32 v41, v41
    s_nop 0
    v_cvt_pk_bf16_f32 v41, v41, v41
    v_and_b32 v41, 0xffff0000, v41
    v_rcp_f32 v41, v41
    s_waitcnt vmcnt(0)
    v_sub_f32 v64, v16, v40
    v_sub_f32 v65, v17, v40
    v_sub_f32 v66, v18, v40
    v_sub_f32 v67, v19, v40
    v_sub_f32 v68, v20, v40
    v_sub_f32 v69, v21, v40
    v_sub_f32 v70, v22, v40
    v_sub_f32 v71, v23, v40
    v_cvt_pk_bf16_f32 v42, v64, v65
    v_lshlrev_b32 v64, 16, v42
    v_and_b32 v65, 0xffff0000, v42
    v_cvt_pk_bf16_f32 v42, v66, v67
    v_lshlrev_b32 v66, 16, v42
    v_and_b32 v67, 0xffff0000, v42
    v_cvt_pk_bf16_f32 v42, v68, v69
    v_lshlrev_b32 v68, 16, v42
    v_and_b32 v69, 0xffff0000, v42
    v_cvt_pk_bf16_f32 v42, v70, v71
    v_lshlrev_b32 v70, 16, v42
    v_and_b32 v71, 0xffff0000, v42
    v_mul_f32 v64, v64, v41
    v_mul_f32 v65, v65, v41
    v_mul_f32 v66, v66, v41
    v_mul_f32 v67, v67, v41
    v_mul_f32 v68, v68, v41
    v_mul_f32 v69, v69, v41
    v_mul_f32 v70, v70, v41
    v_mul_f32 v71, v71, v41
    v_cvt_pk_bf16_f32 v42, v64, v65
    v_lshlrev_b32 v64, 16, v42
    v_and_b32 v65, 0xffff0000, v42
    v_cvt_pk_bf16_f32 v42, v66, v67
    v_lshlrev_b32 v66, 16, v42
    v_and_b32 v67, 0xffff0000, v42
    v_cvt_pk_bf16_f32 v42, v68, v69
    v_lshlrev_b32 v68, 16, v42
    v_and_b32 v69, 0xffff0000, v42
    v_cvt_pk_bf16_f32 v42, v70, v71
    v_lshlrev_b32 v70, 16, v42
    v_and_b32 v71, 0xffff0000, v42
    v_add_f32 v32, 1.0, v32
    v_add_f32 v33, 1.0, v33
    v_add_f32 v34, 1.0, v34
    v_add_f32 v35, 1.0, v35
    v_add_f32 v36, 1.0, v36
    v_add_f32 v37, 1.0, v37
    v_add_f32 v38, 1.0, v38
    v_add_f32 v39, 1.0, v39
    v_cvt_pk_bf16_f32 v42, v32, v33
    v_lshlrev_b32 v32, 16, v42
    v_and_b32 v33, 0xffff0000, v42
    v_cvt_pk_bf16_f32 v42, v34, v35
    v_lshlrev_b32 v34, 16, v42
    v_and_b32 v35, 0xffff0000, v42
    v_cvt_pk_bf16_f32 v42, v36, v37
    v_lshlrev_b32 v36, 16, v42
    v_and_b32 v37, 0xffff0000, v42
    v_cvt_pk_bf16_f32 v42, v38, v39
    v_lshlrev_b32 v38, 16, v42
    v_and_b32 v39, 0xffff0000, v42
    v_mul_f32 v64, v64, v32
    v_mul_f32 v65, v65, v33
    v_mul_f32 v66, v66, v34
    v_mul_f32 v67, v67, v35
    v_mul_f32 v68, v68, v36
    v_mul_f32 v69, v69, v37
    v_mul_f32 v70, v70, v38
    v_mul_f32 v71, v71, v39
    v_cvt_pk_bf16_f32 v42, v64, v65
    v_lshlrev_b32 v64, 16, v42
    v_and_b32 v65, 0xffff0000, v42
    v_cvt_pk_bf16_f32 v42, v66, v67
    v_lshlrev_b32 v66, 16, v42
    v_and_b32 v67, 0xffff0000, v42
    v_cvt_pk_bf16_f32 v42, v68, v69
    v_lshlrev_b32 v68, 16, v42
    v_and_b32 v69, 0xffff0000, v42
    v_cvt_pk_bf16_f32 v42, v70, v71
    v_lshlrev_b32 v70, 16, v42
    v_and_b32 v71, 0xffff0000, v42
    v_add_f32 v64, v64, v24
    v_add_f32 v65, v65, v25
    v_add_f32 v66, v66, v26
    v_add_f32 v67, v67, v27
    v_add_f32 v68, v68, v28
    v_add_f32 v69, v69, v29
    v_add_f32 v70, v70, v30
    v_add_f32 v71, v71, v31
    v_cvt_pk_bf16_f32 v8, v64, v65
    v_cvt_pk_bf16_f32 v9, v66, v67
    v_cvt_pk_bf16_f32 v10, v68, v69
    v_cvt_pk_bf16_f32 v11, v70, v71
    buffer_store_dwordx4 v[8:11], v7, s[16:19], s20 offen
Lln1_end:
    s_endpgm
.globl attn_kernel
.p2align 8
.type attn_kernel,@function
attn_kernel:
    s_cmp_ge_u32 s2, 256
    s_cbranch_scc1 Lattn_end
    s_load_dwordx8 s[52:59], s[0:1], 8
    s_load_dwordx2 s[50:51], s[0:1], 112
    s_getpc_b64 s[32:33]
Lattn_pc:
    s_mov_b32 s34, Lattn_end-Lattn_pc
    s_mov_b32 s35, 0x20000
    v_lshlrev_b32 v2, 6, v0
    v_lshrrev_b32 v3, 6, v0
    v_and_b32 v1, 63, v0
    v_readfirstlane_b32 s3, v3
    s_mov_b32 s49, 0
    buffer_load_dword v216, v2, s[32:35], s49 offen
    s_mov_b32 s49, 16384
    buffer_load_dword v217, v2, s[32:35], s49 offen
    s_mov_b32 s49, 32768
    buffer_load_dword v218, v2, s[32:35], s49 offen
    s_mov_b32 s49, 49152
    buffer_load_dword v219, v2, s[32:35], s49 offen
    s_and_b32 s4, s2, 7
    s_lshl_b32 s4, s4, 1
    s_bfe_u32 s5, s2, 0x10003
    s_add_u32 s4, s4, s5
    s_lshr_b32 s5, s2, 4
    s_lshl_b32 s42, s3, 12
    v_lshrrev_b32 v2, 4, v1
    v_and_b32 v3, 15, v1
    v_lshlrev_b32 v51, 4, v1
    s_lshl_b32 s6, s5, 2
    s_add_u32 s6, s6, s3
    s_mul_i32 s46, s6, 36864
    s_lshl_b32 s44, s4, 9
    s_mul_i32 s45, s4, 294912
    s_lshl_b32 s7, s3, 4
    v_add_u32 v4, s7, v2
    v_lshlrev_b32 v5, 1, v2
    v_xor_b32 v5, v5, v3
    v_xor_b32 v6, 8, v5
    v_lshlrev_b32 v7, 13, v4
    v_lshl_add_u32 v42, v5, 4, v7
    v_lshl_add_u32 v43, v6, 4, v7
    v_add_u32 v44, 63488, v42
    v_add_u32 v45, 95232, v43
    v_add_u32 v43, 31744, v43
    s_waitcnt lgkmcnt(0)
    s_mov_b32 s16, s56
    s_mov_b32 s17, s57
    s_mov_b32 s18, 4718592
    s_mov_b32 s19, 0x20000
    s_add_u32 s24, s50, 65536
    s_addc_u32 s25, s51, 0
    s_mov_b32 s26, 2359296
    s_mov_b32 s27, 0x20000
    s_add_u32 s49, s46, 0
    buffer_load_dwordx4 a[0:3], v51, s[24:27], s49 offen
    buffer_load_dwordx4 a[8:11], v51, s[24:27], s49 offen offset:1024
    s_add_u32 s49, s46, 18432
    buffer_load_dwordx4 a[4:7], v51, s[24:27], s49 offen
    buffer_load_dwordx4 a[12:15], v51, s[24:27], s49 offen offset:1024
    s_add_u32 s49, s44, 0
    s_add_u32 m0, s42, 32768
    s_nop 0
    buffer_load_dwordx4 v42, s[16:19], s49 offen lds
    buffer_load_dwordx4 v43, s[16:19], s49 offen offset:1024 lds
    buffer_load_dwordx4 v44, s[16:19], s49 offen offset:2048 lds
    buffer_load_dwordx4 v45, s[16:19], s49 offen offset:3072 lds
    s_add_u32 s49, s44, 256
    s_add_u32 m0, s42, 49152
    s_nop 0
    buffer_load_dwordx4 v42, s[16:19], s49 offen lds
    buffer_load_dwordx4 v43, s[16:19], s49 offen offset:1024 lds
    buffer_load_dwordx4 v44, s[16:19], s49 offen offset:2048 lds
    buffer_load_dwordx4 v45, s[16:19], s49 offen offset:3072 lds
    s_add_u32 s49, s46, 2048
    buffer_load_dwordx4 a[16:19], v51, s[24:27], s49 offen
    buffer_load_dwordx4 a[24:27], v51, s[24:27], s49 offen offset:1024
    s_add_u32 s49, s46, 20480
    buffer_load_dwordx4 a[20:23], v51, s[24:27], s49 offen
    buffer_load_dwordx4 a[28:31], v51, s[24:27], s49 offen offset:1024
    s_add_u32 s49, s44, 524288
    s_add_u32 m0, s42, 65536
    s_nop 0
    buffer_load_dwordx4 v42, s[16:19], s49 offen lds
    buffer_load_dwordx4 v43, s[16:19], s49 offen offset:1024 lds
    buffer_load_dwordx4 v44, s[16:19], s49 offen offset:2048 lds
    buffer_load_dwordx4 v45, s[16:19], s49 offen offset:3072 lds
    s_add_u32 s49, s44, 524544
    s_add_u32 m0, s42, 81920
    s_nop 0
    buffer_load_dwordx4 v42, s[16:19], s49 offen lds
    buffer_load_dwordx4 v43, s[16:19], s49 offen offset:1024 lds
    buffer_load_dwordx4 v44, s[16:19], s49 offen offset:2048 lds
    buffer_load_dwordx4 v45, s[16:19], s49 offen offset:3072 lds
    s_add_u32 s49, s46, 4096
    buffer_load_dwordx4 a[32:35], v51, s[24:27], s49 offen
    buffer_load_dwordx4 a[40:43], v51, s[24:27], s49 offen offset:1024
    s_add_u32 s49, s46, 22528
    buffer_load_dwordx4 a[36:39], v51, s[24:27], s49 offen
    buffer_load_dwordx4 a[44:47], v51, s[24:27], s49 offen offset:1024
    s_add_u32 s49, s44, 1048576
    s_add_u32 m0, s42, 98304
    s_nop 0
    buffer_load_dwordx4 v42, s[16:19], s49 offen lds
    buffer_load_dwordx4 v43, s[16:19], s49 offen offset:1024 lds
    buffer_load_dwordx4 v44, s[16:19], s49 offen offset:2048 lds
    buffer_load_dwordx4 v45, s[16:19], s49 offen offset:3072 lds
    s_add_u32 s49, s44, 1048832
    s_add_u32 m0, s42, 114688
    s_nop 0
    buffer_load_dwordx4 v42, s[16:19], s49 offen lds
    buffer_load_dwordx4 v43, s[16:19], s49 offen offset:1024 lds
    buffer_load_dwordx4 v44, s[16:19], s49 offen offset:2048 lds
    buffer_load_dwordx4 v45, s[16:19], s49 offen offset:3072 lds
    s_add_u32 s49, s46, 6144
    buffer_load_dwordx4 a[48:51], v51, s[24:27], s49 offen
    buffer_load_dwordx4 a[56:59], v51, s[24:27], s49 offen offset:1024
    s_add_u32 s49, s46, 24576
    buffer_load_dwordx4 a[52:55], v51, s[24:27], s49 offen
    buffer_load_dwordx4 a[60:63], v51, s[24:27], s49 offen offset:1024
    s_add_u32 s49, s44, 1572864
    s_add_u32 m0, s42, 131072
    s_nop 0
    buffer_load_dwordx4 v42, s[16:19], s49 offen lds
    buffer_load_dwordx4 v43, s[16:19], s49 offen offset:1024 lds
    buffer_load_dwordx4 v44, s[16:19], s49 offen offset:2048 lds
    buffer_load_dwordx4 v45, s[16:19], s49 offen offset:3072 lds
    s_add_u32 s49, s44, 1573120
    s_add_u32 m0, s42, 147456
    s_nop 0
    buffer_load_dwordx4 v42, s[16:19], s49 offen lds
    buffer_load_dwordx4 v43, s[16:19], s49 offen offset:1024 lds
    buffer_load_dwordx4 v44, s[16:19], s49 offen offset:2048 lds
    buffer_load_dwordx4 v45, s[16:19], s49 offen offset:3072 lds
    s_lshl_b32 s7, s4, 19
    s_add_u32 s8, s52, s7
    s_addc_u32 s9, s53, 0
    s_mov_b32 s10, 524288
    s_mov_b32 s11, 0x20000
    s_add_u32 s12, s54, s7
    s_addc_u32 s13, s55, 0
    s_mov_b32 s14, 524288
    s_mov_b32 s15, 0x20000
    s_mov_b32 s20, s58
    s_mov_b32 s21, s59
    s_mov_b32 s22, 4718592
    s_mov_b32 s23, 0x20000
    s_add_u32 s28, s50, 10485760
    s_addc_u32 s29, s51, 0
    s_mov_b32 s30, 37748736
    s_mov_b32 s31, 0x20000
    v_lshlrev_b32 v7, 8, v4
    v_lshl_add_u32 v40, v5, 4, v7
    v_lshl_add_u32 v41, v6, 4, v7
    v_xor_b32 v224, v3, v2
    v_lshl_add_u32 v36, v224, 4, v7
    v_xor_b32 v37, 64, v36
    v_xor_b32 v38, 128, v36
    v_xor_b32 v39, 192, v36
    v_lshrrev_b32 v7, 3, v5
    v_lshl_add_u32 v7, v7, 7, v4
    v_mul_u32_u24 v7, 1152, v7
    v_and_b32 v225, 7, v5
    v_lshl_add_u32 v46, v225, 4, v7
    v_lshrrev_b32 v7, 3, v6
    v_lshl_add_u32 v7, v7, 7, v4
    v_mul_u32_u24 v7, 1152, v7
    v_and_b32 v225, 7, v6
    v_lshl_add_u32 v47, v225, 4, v7
    v_add_u32 v48, 7168, v46
    v_add_u32 v49, 10752, v47
    v_add_u32 v47, 3584, v47
    v_lshlrev_b32 v7, 8, v3
    v_lshl_add_u32 v8, v224, 4, v7
    v_xor_b32 v9, 64, v8
    v_xor_b32 v10, 128, v8
    v_xor_b32 v11, 192, v8
    v_lshrrev_b32 v5, 2, v1
    v_and_b32 v6, 7, v5
    v_lshlrev_b32 v6, 5, v6
    v_lshl_add_u32 v6, v5, 8, v6
    v_and_b32 v7, 3, v1
    v_lshl_add_u32 v12, v7, 3, v6
    v_xor_b32 v13, 32, v12
    v_xor_b32 v14, 64, v12
    v_xor_b32 v15, 96, v12
    v_xor_b32 v16, 128, v12
    v_xor_b32 v17, 160, v12
    v_xor_b32 v18, 192, v12
    v_xor_b32 v19, 224, v12
    v_add_u32 v20, 65536, v12
    v_add_u32 v21, 65536, v13
    v_add_u32 v22, 65536, v14
    v_add_u32 v23, 65536, v15
    v_add_u32 v24, 65536, v16
    v_add_u32 v25, 65536, v17
    v_add_u32 v26, 65536, v18
    v_add_u32 v27, 65536, v19
    v_add_u32 v28, 131072, v12
    v_add_u32 v29, 131072, v13
    v_add_u32 v30, 131072, v14
    v_add_u32 v31, 131072, v15
    v_add_u32 v32, 131072, v16
    v_add_u32 v33, 131072, v17
    v_add_u32 v34, 131072, v18
    v_add_u32 v35, 131072, v19
    v_mov_b32 v52, 0x3f803f80
    v_mov_b32 v53, 0x3f803f80
    v_mov_b32 v54, 0x3f803f80
    v_mov_b32 v55, 0x3f803f80
    v_and_b32 v5, 1, v1
    v_mul_u32_u24 v5, 0xaaaa, v5
    v_add_u32 v5, 0x4444, v5
    v_lshl_add_u32 v50, v5, 16, v5
    v_lshrrev_b32 v5, 3, v3
    v_mul_u32_u24 v5, 147456, v5
    v_lshl_add_u32 v5, v2, 7, v5
    v_and_b32 v6, 7, v3
    v_lshl_add_u32 v56, v6, 4, v5
    s_mul_i32 s47, s6, 589824
    s_mul_i32 s7, s4, 9216
    s_add_u32 s47, s47, s7
    s_mov_b32 s40, 0
    s_mov_b32 s41, 0
    s_mov_b32 s48, 0
    s_waitcnt vmcnt(36)
    s_barrier
    ds_read_b64_tr_b16 a[160:161], v12 offset:32768
    ds_read_b64_tr_b16 a[162:163], v12 offset:36864
    ds_read_b64_tr_b16 a[164:165], v12 offset:40960
    ds_read_b64_tr_b16 a[166:167], v12 offset:45056
    ds_read_b64_tr_b16 a[168:169], v13 offset:32768
    ds_read_b64_tr_b16 a[170:171], v13 offset:36864
    ds_read_b64_tr_b16 a[172:173], v13 offset:40960
    ds_read_b64_tr_b16 a[174:175], v13 offset:45056
    ds_read_b64_tr_b16 a[176:177], v14 offset:32768
    ds_read_b64_tr_b16 a[178:179], v14 offset:36864
    ds_read_b64_tr_b16 a[180:181], v14 offset:40960
    ds_read_b64_tr_b16 a[182:183], v14 offset:45056
    s_waitcnt lgkmcnt(10)
    v_mfma_f32_16x16x32_bf16 v[128:131], a[160:163], a[0:3], 0
    s_waitcnt lgkmcnt(8)
    ds_read_b64_tr_b16 a[184:185], v15 offset:32768
    v_mfma_f32_16x16x32_bf16 v[128:131], a[164:167], a[8:11], v[128:131]
    ds_read_b64_tr_b16 a[186:187], v15 offset:36864
    v_mfma_f32_16x16x32_bf16 v[132:135], a[160:163], a[4:7], 0
    s_add_u32 s49, s46, 8192
    ds_read_b64_tr_b16 a[188:189], v15 offset:40960
    v_mfma_f32_16x16x32_bf16 v[132:135], a[164:167], a[12:15], v[132:135]
    s_waitcnt lgkmcnt(9)
    ds_read_b64_tr_b16 a[190:191], v15 offset:45056
    buffer_load_dwordx4 a[64:67], v51, s[24:27], s49 offen
    v_mfma_f32_16x16x32_bf16 v[136:139], a[168:171], a[0:3], 0
    s_waitcnt lgkmcnt(8)
    ds_read_b64_tr_b16 a[160:161], v16 offset:32768
    v_mfma_f32_16x16x32_bf16 v[136:139], a[172:175], a[8:11], v[136:139]
    ds_read_b64_tr_b16 a[162:163], v16 offset:36864
    v_mfma_f32_16x16x32_bf16 v[140:143], a[168:171], a[4:7], 0
    ds_read_b64_tr_b16 a[164:165], v16 offset:40960
    v_mfma_f32_16x16x32_bf16 v[140:143], a[172:175], a[12:15], v[140:143]
    s_waitcnt lgkmcnt(9)
    ds_read_b64_tr_b16 a[166:167], v16 offset:45056
    buffer_load_dwordx4 a[72:75], v51, s[24:27], s49 offen offset:1024
    v_mfma_f32_16x16x32_bf16 v[144:147], a[176:179], a[0:3], 0
    s_waitcnt lgkmcnt(8)
    ds_read_b64_tr_b16 a[168:169], v17 offset:32768
    v_mfma_f32_16x16x32_bf16 v[144:147], a[180:183], a[8:11], v[144:147]
    ds_read_b64_tr_b16 a[170:171], v17 offset:36864
    v_mfma_f32_16x16x32_bf16 v[148:151], a[176:179], a[4:7], 0
    s_add_u32 s49, s46, 26624
    ds_read_b64_tr_b16 a[172:173], v17 offset:40960
    v_mfma_f32_16x16x32_bf16 v[148:151], a[180:183], a[12:15], v[148:151]
    s_waitcnt lgkmcnt(9)
    ds_read_b64_tr_b16 a[174:175], v17 offset:45056
    buffer_load_dwordx4 a[68:71], v51, s[24:27], s49 offen
    v_mfma_f32_16x16x32_bf16 v[152:155], a[184:187], a[0:3], 0
    s_waitcnt lgkmcnt(8)
    ds_read_b64_tr_b16 a[176:177], v18 offset:32768
    v_mfma_f32_16x16x32_bf16 v[152:155], a[188:191], a[8:11], v[152:155]
    ds_read_b64_tr_b16 a[178:179], v18 offset:36864
    v_mfma_f32_16x16x32_bf16 v[156:159], a[184:187], a[4:7], 0
    ds_read_b64_tr_b16 a[180:181], v18 offset:40960
    v_mfma_f32_16x16x32_bf16 v[156:159], a[188:191], a[12:15], v[156:159]
    s_waitcnt lgkmcnt(9)
    ds_read_b64_tr_b16 a[182:183], v18 offset:45056
    buffer_load_dwordx4 a[76:79], v51, s[24:27], s49 offen offset:1024
    v_mfma_f32_16x16x32_bf16 v[160:163], a[160:163], a[0:3], 0
    s_waitcnt lgkmcnt(8)
    ds_read_b64_tr_b16 a[184:185], v19 offset:32768
    v_mfma_f32_16x16x32_bf16 v[160:163], a[164:167], a[8:11], v[160:163]
    s_add_u32 s49, s44, 2097152
    ds_read_b64_tr_b16 a[186:187], v19 offset:36864
    v_mfma_f32_16x16x32_bf16 v[164:167], a[160:163], a[4:7], 0
    s_add_u32 m0, s42, 0
    ds_read_b64_tr_b16 a[188:189], v19 offset:40960
    v_mfma_f32_16x16x32_bf16 v[164:167], a[164:167], a[12:15], v[164:167]
    s_waitcnt lgkmcnt(9)
    ds_read_b64_tr_b16 a[190:191], v19 offset:45056
    buffer_load_dwordx4 v42, s[16:19], s49 offen lds
    v_mfma_f32_16x16x32_bf16 v[168:171], a[168:171], a[0:3], 0
    s_waitcnt lgkmcnt(8)
    ds_read_b64_tr_b16 a[160:161], v12 offset:49152
    v_mfma_f32_16x16x32_bf16 v[168:171], a[172:175], a[8:11], v[168:171]
    ds_read_b64_tr_b16 a[162:163], v12 offset:53248
    v_mfma_f32_16x16x32_bf16 v[172:175], a[168:171], a[4:7], 0
    ds_read_b64_tr_b16 a[164:165], v12 offset:57344
    v_mfma_f32_16x16x32_bf16 v[172:175], a[172:175], a[12:15], v[172:175]
    s_waitcnt lgkmcnt(9)
    ds_read_b64_tr_b16 a[166:167], v12 offset:61440
    buffer_load_dwordx4 v43, s[16:19], s49 offen offset:1024 lds
    v_mfma_f32_16x16x32_bf16 v[176:179], a[176:179], a[0:3], 0
    s_waitcnt lgkmcnt(8)
    ds_read_b64_tr_b16 a[168:169], v13 offset:49152
    v_mfma_f32_16x16x32_bf16 v[176:179], a[180:183], a[8:11], v[176:179]
    ds_read_b64_tr_b16 a[170:171], v13 offset:53248
    v_mfma_f32_16x16x32_bf16 v[180:183], a[176:179], a[4:7], 0
    ds_read_b64_tr_b16 a[172:173], v13 offset:57344
    v_mfma_f32_16x16x32_bf16 v[180:183], a[180:183], a[12:15], v[180:183]
    s_waitcnt lgkmcnt(9)
    ds_read_b64_tr_b16 a[174:175], v13 offset:61440
    buffer_load_dwordx4 v44, s[16:19], s49 offen offset:2048 lds
    v_mfma_f32_16x16x32_bf16 v[184:187], a[184:187], a[0:3], 0
    s_waitcnt lgkmcnt(8)
    ds_read_b64_tr_b16 a[176:177], v14 offset:49152
    v_mfma_f32_16x16x32_bf16 v[184:187], a[188:191], a[8:11], v[184:187]
    ds_read_b64_tr_b16 a[178:179], v14 offset:53248
    v_mfma_f32_16x16x32_bf16 v[188:191], a[184:187], a[4:7], 0
    ds_read_b64_tr_b16 a[180:181], v14 offset:57344
    v_mfma_f32_16x16x32_bf16 v[188:191], a[188:191], a[12:15], v[188:191]
    s_waitcnt lgkmcnt(9)
    ds_read_b64_tr_b16 a[182:183], v14 offset:61440
    buffer_load_dwordx4 v45, s[16:19], s49 offen offset:3072 lds
    v_mfma_f32_16x16x32_bf16 v[192:195], a[160:163], a[0:3], 0
    s_waitcnt lgkmcnt(8)
    ds_read_b64_tr_b16 a[184:185], v15 offset:49152
    v_mfma_f32_16x16x32_bf16 v[192:195], a[164:167], a[8:11], v[192:195]
    s_add_u32 s49, s44, 2097408
    ds_read_b64_tr_b16 a[186:187], v15 offset:53248
    v_mfma_f32_16x16x32_bf16 v[196:199], a[160:163], a[4:7], 0
    s_add_u32 m0, s42, 16384
    ds_read_b64_tr_b16 a[188:189], v15 offset:57344
    v_mfma_f32_16x16x32_bf16 v[196:199], a[164:167], a[12:15], v[196:199]
    s_waitcnt lgkmcnt(9)
    ds_read_b64_tr_b16 a[190:191], v15 offset:61440
    buffer_load_dwordx4 v42, s[16:19], s49 offen lds
    v_mfma_f32_16x16x32_bf16 v[200:203], a[168:171], a[0:3], 0
    s_waitcnt lgkmcnt(8)
    ds_read_b64_tr_b16 a[160:161], v16 offset:49152
    v_mfma_f32_16x16x32_bf16 v[200:203], a[172:175], a[8:11], v[200:203]
    ds_read_b64_tr_b16 a[162:163], v16 offset:53248
    v_mfma_f32_16x16x32_bf16 v[204:207], a[168:171], a[4:7], 0
    ds_read_b64_tr_b16 a[164:165], v16 offset:57344
    v_mfma_f32_16x16x32_bf16 v[204:207], a[172:175], a[12:15], v[204:207]
    s_waitcnt lgkmcnt(9)
    ds_read_b64_tr_b16 a[166:167], v16 offset:61440
    buffer_load_dwordx4 v43, s[16:19], s49 offen offset:1024 lds
    v_mfma_f32_16x16x32_bf16 v[208:211], a[176:179], a[0:3], 0
    s_waitcnt lgkmcnt(8)
    ds_read_b64_tr_b16 a[168:169], v17 offset:49152
    v_mfma_f32_16x16x32_bf16 v[208:211], a[180:183], a[8:11], v[208:211]
    ds_read_b64_tr_b16 a[170:171], v17 offset:53248
    v_mfma_f32_16x16x32_bf16 v[212:215], a[176:179], a[4:7], 0
    ds_read_b64_tr_b16 a[172:173], v17 offset:57344
    v_mfma_f32_16x16x32_bf16 v[212:215], a[180:183], a[12:15], v[212:215]
    s_waitcnt lgkmcnt(9)
    ds_read_b64_tr_b16 a[174:175], v17 offset:61440
    buffer_load_dwordx4 v44, s[16:19], s49 offen offset:2048 lds
    v_mfma_f32_16x16x32_bf16 v[216:219], a[184:187], a[0:3], 0
    s_waitcnt lgkmcnt(8)
    ds_read_b64_tr_b16 a[176:177], v18 offset:49152
    v_mfma_f32_16x16x32_bf16 v[216:219], a[188:191], a[8:11], v[216:219]
    ds_read_b64_tr_b16 a[178:179], v18 offset:53248
    v_mfma_f32_16x16x32_bf16 v[220:223], a[184:187], a[4:7], 0
    ds_read_b64_tr_b16 a[180:181], v18 offset:57344
    v_mfma_f32_16x16x32_bf16 v[220:223], a[188:191], a[12:15], v[220:223]
    s_waitcnt lgkmcnt(9)
    ds_read_b64_tr_b16 a[182:183], v18 offset:61440
    buffer_load_dwordx4 v45, s[16:19], s49 offen offset:3072 lds
    v_mfma_f32_16x16x32_bf16 v[224:227], a[160:163], a[0:3], 0
    s_waitcnt lgkmcnt(8)
    ds_read_b64_tr_b16 a[184:185], v19 offset:49152
    v_mfma_f32_16x16x32_bf16 v[224:227], a[164:167], a[8:11], v[224:227]
    ds_read_b64_tr_b16 a[186:187], v19 offset:53248
    v_mfma_f32_16x16x32_bf16 v[228:231], a[160:163], a[4:7], 0
    ds_read_b64_tr_b16 a[188:189], v19 offset:57344
    v_mfma_f32_16x16x32_bf16 v[228:231], a[164:167], a[12:15], v[228:231]
    s_waitcnt lgkmcnt(9)
    ds_read_b64_tr_b16 a[190:191], v19 offset:61440
    s_waitcnt vmcnt(36)
    s_barrier
    v_mfma_f32_16x16x32_bf16 v[232:235], a[168:171], a[0:3], 0
    s_waitcnt lgkmcnt(8)
    ds_read_b64_tr_b16 a[160:161], v20 offset:0
    v_mfma_f32_16x16x32_bf16 v[232:235], a[172:175], a[8:11], v[232:235]
    ds_read_b64_tr_b16 a[162:163], v20 offset:4096
    v_mfma_f32_16x16x32_bf16 v[236:239], a[168:171], a[4:7], 0
    ds_read_b64_tr_b16 a[164:165], v20 offset:8192
    v_mfma_f32_16x16x32_bf16 v[236:239], a[172:175], a[12:15], v[236:239]
    s_waitcnt lgkmcnt(9)
    ds_read_b64_tr_b16 a[166:167], v20 offset:12288
    v_mfma_f32_16x16x32_bf16 v[240:243], a[176:179], a[0:3], 0
    s_waitcnt lgkmcnt(8)
    ds_read_b64_tr_b16 a[168:169], v21 offset:0
    v_mfma_f32_16x16x32_bf16 v[240:243], a[180:183], a[8:11], v[240:243]
    ds_read_b64_tr_b16 a[170:171], v21 offset:4096
    v_mfma_f32_16x16x32_bf16 v[244:247], a[176:179], a[4:7], 0
    ds_read_b64_tr_b16 a[172:173], v21 offset:8192
    v_mfma_f32_16x16x32_bf16 v[244:247], a[180:183], a[12:15], v[244:247]
    s_waitcnt lgkmcnt(9)
    ds_read_b64_tr_b16 a[174:175], v21 offset:12288
    v_mfma_f32_16x16x32_bf16 v[248:251], a[184:187], a[0:3], 0
    s_waitcnt lgkmcnt(8)
    ds_read_b64_tr_b16 a[176:177], v22 offset:0
    v_mfma_f32_16x16x32_bf16 v[248:251], a[188:191], a[8:11], v[248:251]
    ds_read_b64_tr_b16 a[178:179], v22 offset:4096
    v_mfma_f32_16x16x32_bf16 v[252:255], a[184:187], a[4:7], 0
    ds_read_b64_tr_b16 a[180:181], v22 offset:8192
    v_mfma_f32_16x16x32_bf16 v[252:255], a[188:191], a[12:15], v[252:255]
    s_waitcnt lgkmcnt(9)
    ds_read_b64_tr_b16 a[182:183], v22 offset:12288
    v_mfma_f32_16x16x32_bf16 v[128:131], a[160:163], a[16:19], v[128:131]
    s_waitcnt lgkmcnt(8)
    ds_read_b64_tr_b16 a[184:185], v23 offset:0
    v_mfma_f32_16x16x32_bf16 v[128:131], a[164:167], a[24:27], v[128:131]
    ds_read_b64_tr_b16 a[186:187], v23 offset:4096
    v_mfma_f32_16x16x32_bf16 v[132:135], a[160:163], a[20:23], v[132:135]
    ds_read_b64_tr_b16 a[188:189], v23 offset:8192
    v_mfma_f32_16x16x32_bf16 v[132:135], a[164:167], a[28:31], v[132:135]
    s_waitcnt lgkmcnt(9)
    ds_read_b64_tr_b16 a[190:191], v23 offset:12288
    v_mfma_f32_16x16x32_bf16 v[136:139], a[168:171], a[16:19], v[136:139]
    s_waitcnt lgkmcnt(8)
    ds_read_b64_tr_b16 a[160:161], v24 offset:0
    v_mfma_f32_16x16x32_bf16 v[136:139], a[172:175], a[24:27], v[136:139]
    ds_read_b64_tr_b16 a[162:163], v24 offset:4096
    v_mfma_f32_16x16x32_bf16 v[140:143], a[168:171], a[20:23], v[140:143]
    ds_read_b64_tr_b16 a[164:165], v24 offset:8192
    v_mfma_f32_16x16x32_bf16 v[140:143], a[172:175], a[28:31], v[140:143]
    s_waitcnt lgkmcnt(9)
    ds_read_b64_tr_b16 a[166:167], v24 offset:12288
    v_mfma_f32_16x16x32_bf16 v[144:147], a[176:179], a[16:19], v[144:147]
    s_waitcnt lgkmcnt(8)
    ds_read_b64_tr_b16 a[168:169], v25 offset:0
    v_mfma_f32_16x16x32_bf16 v[144:147], a[180:183], a[24:27], v[144:147]
    ds_read_b64_tr_b16 a[170:171], v25 offset:4096
    v_mfma_f32_16x16x32_bf16 v[148:151], a[176:179], a[20:23], v[148:151]
    ds_read_b64_tr_b16 a[172:173], v25 offset:8192
    v_mfma_f32_16x16x32_bf16 v[148:151], a[180:183], a[28:31], v[148:151]
    s_waitcnt lgkmcnt(9)
    ds_read_b64_tr_b16 a[174:175], v25 offset:12288
    v_mfma_f32_16x16x32_bf16 v[152:155], a[184:187], a[16:19], v[152:155]
    s_waitcnt lgkmcnt(8)
    ds_read_b64_tr_b16 a[176:177], v26 offset:0
    v_mfma_f32_16x16x32_bf16 v[152:155], a[188:191], a[24:27], v[152:155]
    ds_read_b64_tr_b16 a[178:179], v26 offset:4096
    v_mfma_f32_16x16x32_bf16 v[156:159], a[184:187], a[20:23], v[156:159]
    ds_read_b64_tr_b16 a[180:181], v26 offset:8192
    v_mfma_f32_16x16x32_bf16 v[156:159], a[188:191], a[28:31], v[156:159]
    s_waitcnt lgkmcnt(9)
    ds_read_b64_tr_b16 a[182:183], v26 offset:12288
    v_mfma_f32_16x16x32_bf16 v[160:163], a[160:163], a[16:19], v[160:163]
    s_waitcnt lgkmcnt(8)
    ds_read_b64_tr_b16 a[184:185], v27 offset:0
    v_mfma_f32_16x16x32_bf16 v[160:163], a[164:167], a[24:27], v[160:163]
    ds_read_b64_tr_b16 a[186:187], v27 offset:4096
    v_mfma_f32_16x16x32_bf16 v[164:167], a[160:163], a[20:23], v[164:167]
    ds_read_b64_tr_b16 a[188:189], v27 offset:8192
    v_mfma_f32_16x16x32_bf16 v[164:167], a[164:167], a[28:31], v[164:167]
    s_waitcnt lgkmcnt(9)
    ds_read_b64_tr_b16 a[190:191], v27 offset:12288
    v_mfma_f32_16x16x32_bf16 v[168:171], a[168:171], a[16:19], v[168:171]
    s_waitcnt lgkmcnt(8)
    ds_read_b64_tr_b16 a[160:161], v20 offset:16384
    v_mfma_f32_16x16x32_bf16 v[168:171], a[172:175], a[24:27], v[168:171]
    ds_read_b64_tr_b16 a[162:163], v20 offset:20480
    v_mfma_f32_16x16x32_bf16 v[172:175], a[168:171], a[20:23], v[172:175]
    ds_read_b64_tr_b16 a[164:165], v20 offset:24576
    v_mfma_f32_16x16x32_bf16 v[172:175], a[172:175], a[28:31], v[172:175]
    s_waitcnt lgkmcnt(9)
    ds_read_b64_tr_b16 a[166:167], v20 offset:28672
    v_mfma_f32_16x16x32_bf16 v[176:179], a[176:179], a[16:19], v[176:179]
    s_waitcnt lgkmcnt(8)
    ds_read_b64_tr_b16 a[168:169], v21 offset:16384
    v_mfma_f32_16x16x32_bf16 v[176:179], a[180:183], a[24:27], v[176:179]
    ds_read_b64_tr_b16 a[170:171], v21 offset:20480
    v_mfma_f32_16x16x32_bf16 v[180:183], a[176:179], a[20:23], v[180:183]
    ds_read_b64_tr_b16 a[172:173], v21 offset:24576
    v_mfma_f32_16x16x32_bf16 v[180:183], a[180:183], a[28:31], v[180:183]
    s_waitcnt lgkmcnt(9)
    ds_read_b64_tr_b16 a[174:175], v21 offset:28672
    v_mfma_f32_16x16x32_bf16 v[184:187], a[184:187], a[16:19], v[184:187]
    s_waitcnt lgkmcnt(8)
    ds_read_b64_tr_b16 a[176:177], v22 offset:16384
    v_mfma_f32_16x16x32_bf16 v[184:187], a[188:191], a[24:27], v[184:187]
    ds_read_b64_tr_b16 a[178:179], v22 offset:20480
    v_mfma_f32_16x16x32_bf16 v[188:191], a[184:187], a[20:23], v[188:191]
    ds_read_b64_tr_b16 a[180:181], v22 offset:24576
    v_mfma_f32_16x16x32_bf16 v[188:191], a[188:191], a[28:31], v[188:191]
    s_waitcnt lgkmcnt(9)
    ds_read_b64_tr_b16 a[182:183], v22 offset:28672
    v_mfma_f32_16x16x32_bf16 v[192:195], a[160:163], a[16:19], v[192:195]
    s_waitcnt lgkmcnt(8)
    ds_read_b64_tr_b16 a[184:185], v23 offset:16384
    v_mfma_f32_16x16x32_bf16 v[192:195], a[164:167], a[24:27], v[192:195]
    ds_read_b64_tr_b16 a[186:187], v23 offset:20480
    v_mfma_f32_16x16x32_bf16 v[196:199], a[160:163], a[20:23], v[196:199]
    ds_read_b64_tr_b16 a[188:189], v23 offset:24576
    v_mfma_f32_16x16x32_bf16 v[196:199], a[164:167], a[28:31], v[196:199]
    s_waitcnt lgkmcnt(9)
    ds_read_b64_tr_b16 a[190:191], v23 offset:28672
    v_mfma_f32_16x16x32_bf16 v[200:203], a[168:171], a[16:19], v[200:203]
    s_waitcnt lgkmcnt(8)
    ds_read_b64_tr_b16 a[160:161], v24 offset:16384
    v_mfma_f32_16x16x32_bf16 v[200:203], a[172:175], a[24:27], v[200:203]
    ds_read_b64_tr_b16 a[162:163], v24 offset:20480
    v_mfma_f32_16x16x32_bf16 v[204:207], a[168:171], a[20:23], v[204:207]
    ds_read_b64_tr_b16 a[164:165], v24 offset:24576
    v_mfma_f32_16x16x32_bf16 v[204:207], a[172:175], a[28:31], v[204:207]
    s_waitcnt lgkmcnt(9)
    ds_read_b64_tr_b16 a[166:167], v24 offset:28672
    v_mfma_f32_16x16x32_bf16 v[208:211], a[176:179], a[16:19], v[208:211]
    s_waitcnt lgkmcnt(8)
    ds_read_b64_tr_b16 a[168:169], v25 offset:16384
    v_mfma_f32_16x16x32_bf16 v[208:211], a[180:183], a[24:27], v[208:211]
    ds_read_b64_tr_b16 a[170:171], v25 offset:20480
    v_mfma_f32_16x16x32_bf16 v[212:215], a[176:179], a[20:23], v[212:215]
    ds_read_b64_tr_b16 a[172:173], v25 offset:24576
    v_mfma_f32_16x16x32_bf16 v[212:215], a[180:183], a[28:31], v[212:215]
    s_waitcnt lgkmcnt(9)
    ds_read_b64_tr_b16 a[174:175], v25 offset:28672
    v_mfma_f32_16x16x32_bf16 v[216:219], a[184:187], a[16:19], v[216:219]
    s_waitcnt lgkmcnt(8)
    ds_read_b64_tr_b16 a[176:177], v26 offset:16384
    v_mfma_f32_16x16x32_bf16 v[216:219], a[188:191], a[24:27], v[216:219]
    ds_read_b64_tr_b16 a[178:179], v26 offset:20480
    v_mfma_f32_16x16x32_bf16 v[220:223], a[184:187], a[20:23], v[220:223]
    ds_read_b64_tr_b16 a[180:181], v26 offset:24576
    v_mfma_f32_16x16x32_bf16 v[220:223], a[188:191], a[28:31], v[220:223]
    s_waitcnt lgkmcnt(9)
    ds_read_b64_tr_b16 a[182:183], v26 offset:28672
    v_mfma_f32_16x16x32_bf16 v[224:227], a[160:163], a[16:19], v[224:227]
    s_waitcnt lgkmcnt(8)
    ds_read_b64_tr_b16 a[184:185], v27 offset:16384
    v_mfma_f32_16x16x32_bf16 v[224:227], a[164:167], a[24:27], v[224:227]
    ds_read_b64_tr_b16 a[186:187], v27 offset:20480
    v_mfma_f32_16x16x32_bf16 v[228:231], a[160:163], a[20:23], v[228:231]
    ds_read_b64_tr_b16 a[188:189], v27 offset:24576
    v_mfma_f32_16x16x32_bf16 v[228:231], a[164:167], a[28:31], v[228:231]
    s_waitcnt lgkmcnt(9)
    ds_read_b64_tr_b16 a[190:191], v27 offset:28672
    s_waitcnt vmcnt(24)
    s_barrier
    v_mfma_f32_16x16x32_bf16 v[232:235], a[168:171], a[16:19], v[232:235]
    s_waitcnt lgkmcnt(8)
    ds_read_b64_tr_b16 a[160:161], v20 offset:32768
    v_mfma_f32_16x16x32_bf16 v[232:235], a[172:175], a[24:27], v[232:235]
    ds_read_b64_tr_b16 a[162:163], v20 offset:36864
    v_mfma_f32_16x16x32_bf16 v[236:239], a[168:171], a[20:23], v[236:239]
    s_add_u32 s49, s46, 10240
    ds_read_b64_tr_b16 a[164:165], v20 offset:40960
    v_mfma_f32_16x16x32_bf16 v[236:239], a[172:175], a[28:31], v[236:239]
    s_waitcnt lgkmcnt(9)
    ds_read_b64_tr_b16 a[166:167], v20 offset:45056
    buffer_load_dwordx4 a[80:83], v51, s[24:27], s49 offen
    v_mfma_f32_16x16x32_bf16 v[240:243], a[176:179], a[16:19], v[240:243]
    s_waitcnt lgkmcnt(8)
    ds_read_b64_tr_b16 a[168:169], v21 offset:32768
    v_mfma_f32_16x16x32_bf16 v[240:243], a[180:183], a[24:27], v[240:243]
    ds_read_b64_tr_b16 a[170:171], v21 offset:36864
    v_mfma_f32_16x16x32_bf16 v[244:247], a[176:179], a[20:23], v[244:247]
    ds_read_b64_tr_b16 a[172:173], v21 offset:40960
    v_mfma_f32_16x16x32_bf16 v[244:247], a[180:183], a[28:31], v[244:247]
    s_waitcnt lgkmcnt(9)
    ds_read_b64_tr_b16 a[174:175], v21 offset:45056
    buffer_load_dwordx4 a[88:91], v51, s[24:27], s49 offen offset:1024
    v_mfma_f32_16x16x32_bf16 v[248:251], a[184:187], a[16:19], v[248:251]
    s_waitcnt lgkmcnt(8)
    ds_read_b64_tr_b16 a[176:177], v22 offset:32768
    v_mfma_f32_16x16x32_bf16 v[248:251], a[188:191], a[24:27], v[248:251]
    ds_read_b64_tr_b16 a[178:179], v22 offset:36864
    v_mfma_f32_16x16x32_bf16 v[252:255], a[184:187], a[20:23], v[252:255]
    s_add_u32 s49, s46, 28672
    ds_read_b64_tr_b16 a[180:181], v22 offset:40960
    v_mfma_f32_16x16x32_bf16 v[252:255], a[188:191], a[28:31], v[252:255]
    s_waitcnt lgkmcnt(9)
    ds_read_b64_tr_b16 a[182:183], v22 offset:45056
    buffer_load_dwordx4 a[84:87], v51, s[24:27], s49 offen
    v_mfma_f32_16x16x32_bf16 v[128:131], a[160:163], a[32:35], v[128:131]
    s_waitcnt lgkmcnt(8)
    ds_read_b64_tr_b16 a[184:185], v23 offset:32768
    v_mfma_f32_16x16x32_bf16 v[128:131], a[164:167], a[40:43], v[128:131]
    ds_read_b64_tr_b16 a[186:187], v23 offset:36864
    v_mfma_f32_16x16x32_bf16 v[132:135], a[160:163], a[36:39], v[132:135]
    ds_read_b64_tr_b16 a[188:189], v23 offset:40960
    v_mfma_f32_16x16x32_bf16 v[132:135], a[164:167], a[44:47], v[132:135]
    s_waitcnt lgkmcnt(9)
    ds_read_b64_tr_b16 a[190:191], v23 offset:45056
    buffer_load_dwordx4 a[92:95], v51, s[24:27], s49 offen offset:1024
    v_mfma_f32_16x16x32_bf16 v[136:139], a[168:171], a[32:35], v[136:139]
    s_waitcnt lgkmcnt(8)
    ds_read_b64_tr_b16 a[160:161], v24 offset:32768
    v_mfma_f32_16x16x32_bf16 v[136:139], a[172:175], a[40:43], v[136:139]
    s_add_u32 s49, s44, 2621440
    ds_read_b64_tr_b16 a[162:163], v24 offset:36864
    v_mfma_f32_16x16x32_bf16 v[140:143], a[168:171], a[36:39], v[140:143]
    s_add_u32 m0, s42, 32768
    ds_read_b64_tr_b16 a[164:165], v24 offset:40960
    v_mfma_f32_16x16x32_bf16 v[140:143], a[172:175], a[44:47], v[140:143]
    s_waitcnt lgkmcnt(9)
    ds_read_b64_tr_b16 a[166:167], v24 offset:45056
    buffer_load_dwordx4 v42, s[16:19], s49 offen lds
    v_mfma_f32_16x16x32_bf16 v[144:147], a[176:179], a[32:35], v[144:147]
    s_waitcnt lgkmcnt(8)
    ds_read_b64_tr_b16 a[168:169], v25 offset:32768
    v_mfma_f32_16x16x32_bf16 v[144:147], a[180:183], a[40:43], v[144:147]
    ds_read_b64_tr_b16 a[170:171], v25 offset:36864
    v_mfma_f32_16x16x32_bf16 v[148:151], a[176:179], a[36:39], v[148:151]
    ds_read_b64_tr_b16 a[172:173], v25 offset:40960
    v_mfma_f32_16x16x32_bf16 v[148:151], a[180:183], a[44:47], v[148:151]
    s_waitcnt lgkmcnt(9)
    ds_read_b64_tr_b16 a[174:175], v25 offset:45056
    buffer_load_dwordx4 v43, s[16:19], s49 offen offset:1024 lds
    v_mfma_f32_16x16x32_bf16 v[152:155], a[184:187], a[32:35], v[152:155]
    s_waitcnt lgkmcnt(8)
    ds_read_b64_tr_b16 a[176:177], v26 offset:32768
    v_mfma_f32_16x16x32_bf16 v[152:155], a[188:191], a[40:43], v[152:155]
    ds_read_b64_tr_b16 a[178:179], v26 offset:36864
    v_mfma_f32_16x16x32_bf16 v[156:159], a[184:187], a[36:39], v[156:159]
    ds_read_b64_tr_b16 a[180:181], v26 offset:40960
    v_mfma_f32_16x16x32_bf16 v[156:159], a[188:191], a[44:47], v[156:159]
    s_waitcnt lgkmcnt(9)
    ds_read_b64_tr_b16 a[182:183], v26 offset:45056
    buffer_load_dwordx4 v44, s[16:19], s49 offen offset:2048 lds
    v_mfma_f32_16x16x32_bf16 v[160:163], a[160:163], a[32:35], v[160:163]
    s_waitcnt lgkmcnt(8)
    ds_read_b64_tr_b16 a[184:185], v27 offset:32768
    v_mfma_f32_16x16x32_bf16 v[160:163], a[164:167], a[40:43], v[160:163]
    ds_read_b64_tr_b16 a[186:187], v27 offset:36864
    v_mfma_f32_16x16x32_bf16 v[164:167], a[160:163], a[36:39], v[164:167]
    ds_read_b64_tr_b16 a[188:189], v27 offset:40960
    v_mfma_f32_16x16x32_bf16 v[164:167], a[164:167], a[44:47], v[164:167]
    s_waitcnt lgkmcnt(9)
    ds_read_b64_tr_b16 a[190:191], v27 offset:45056
    buffer_load_dwordx4 v45, s[16:19], s49 offen offset:3072 lds
    v_mfma_f32_16x16x32_bf16 v[168:171], a[168:171], a[32:35], v[168:171]
    s_waitcnt lgkmcnt(8)
    ds_read_b64_tr_b16 a[160:161], v20 offset:49152
    v_mfma_f32_16x16x32_bf16 v[168:171], a[172:175], a[40:43], v[168:171]
    s_add_u32 s49, s44, 2621696
    ds_read_b64_tr_b16 a[162:163], v20 offset:53248
    v_mfma_f32_16x16x32_bf16 v[172:175], a[168:171], a[36:39], v[172:175]
    s_add_u32 m0, s42, 49152
    ds_read_b64_tr_b16 a[164:165], v20 offset:57344
    v_mfma_f32_16x16x32_bf16 v[172:175], a[172:175], a[44:47], v[172:175]
    s_waitcnt lgkmcnt(9)
    ds_read_b64_tr_b16 a[166:167], v20 offset:61440
    buffer_load_dwordx4 v42, s[16:19], s49 offen lds
    v_mfma_f32_16x16x32_bf16 v[176:179], a[176:179], a[32:35], v[176:179]
    s_waitcnt lgkmcnt(8)
    ds_read_b64_tr_b16 a[168:169], v21 offset:49152
    v_mfma_f32_16x16x32_bf16 v[176:179], a[180:183], a[40:43], v[176:179]
    ds_read_b64_tr_b16 a[170:171], v21 offset:53248
    v_mfma_f32_16x16x32_bf16 v[180:183], a[176:179], a[36:39], v[180:183]
    ds_read_b64_tr_b16 a[172:173], v21 offset:57344
    v_mfma_f32_16x16x32_bf16 v[180:183], a[180:183], a[44:47], v[180:183]
    s_waitcnt lgkmcnt(9)
    ds_read_b64_tr_b16 a[174:175], v21 offset:61440
    buffer_load_dwordx4 v43, s[16:19], s49 offen offset:1024 lds
    v_mfma_f32_16x16x32_bf16 v[184:187], a[184:187], a[32:35], v[184:187]
    s_waitcnt lgkmcnt(8)
    ds_read_b64_tr_b16 a[176:177], v22 offset:49152
    v_mfma_f32_16x16x32_bf16 v[184:187], a[188:191], a[40:43], v[184:187]
    ds_read_b64_tr_b16 a[178:179], v22 offset:53248
    v_mfma_f32_16x16x32_bf16 v[188:191], a[184:187], a[36:39], v[188:191]
    ds_read_b64_tr_b16 a[180:181], v22 offset:57344
    v_mfma_f32_16x16x32_bf16 v[188:191], a[188:191], a[44:47], v[188:191]
    s_waitcnt lgkmcnt(9)
    ds_read_b64_tr_b16 a[182:183], v22 offset:61440
    buffer_load_dwordx4 v44, s[16:19], s49 offen offset:2048 lds
    v_mfma_f32_16x16x32_bf16 v[192:195], a[160:163], a[32:35], v[192:195]
    s_waitcnt lgkmcnt(8)
    ds_read_b64_tr_b16 a[184:185], v23 offset:49152
    v_mfma_f32_16x16x32_bf16 v[192:195], a[164:167], a[40:43], v[192:195]
    ds_read_b64_tr_b16 a[186:187], v23 offset:53248
    v_mfma_f32_16x16x32_bf16 v[196:199], a[160:163], a[36:39], v[196:199]
    ds_read_b64_tr_b16 a[188:189], v23 offset:57344
    v_mfma_f32_16x16x32_bf16 v[196:199], a[164:167], a[44:47], v[196:199]
    s_waitcnt lgkmcnt(9)
    ds_read_b64_tr_b16 a[190:191], v23 offset:61440
    buffer_load_dwordx4 v45, s[16:19], s49 offen offset:3072 lds
    v_mfma_f32_16x16x32_bf16 v[200:203], a[168:171], a[32:35], v[200:203]
    s_waitcnt lgkmcnt(8)
    ds_read_b64_tr_b16 a[160:161], v24 offset:49152
    v_mfma_f32_16x16x32_bf16 v[200:203], a[172:175], a[40:43], v[200:203]
    ds_read_b64_tr_b16 a[162:163], v24 offset:53248
    v_mfma_f32_16x16x32_bf16 v[204:207], a[168:171], a[36:39], v[204:207]
    ds_read_b64_tr_b16 a[164:165], v24 offset:57344
    v_mfma_f32_16x16x32_bf16 v[204:207], a[172:175], a[44:47], v[204:207]
    s_waitcnt lgkmcnt(9)
    ds_read_b64_tr_b16 a[166:167], v24 offset:61440
    v_mfma_f32_16x16x32_bf16 v[208:211], a[176:179], a[32:35], v[208:211]
    s_waitcnt lgkmcnt(8)
    ds_read_b64_tr_b16 a[168:169], v25 offset:49152
    v_mfma_f32_16x16x32_bf16 v[208:211], a[180:183], a[40:43], v[208:211]
    ds_read_b64_tr_b16 a[170:171], v25 offset:53248
    v_mfma_f32_16x16x32_bf16 v[212:215], a[176:179], a[36:39], v[212:215]
    ds_read_b64_tr_b16 a[172:173], v25 offset:57344
    v_mfma_f32_16x16x32_bf16 v[212:215], a[180:183], a[44:47], v[212:215]
    s_waitcnt lgkmcnt(9)
    ds_read_b64_tr_b16 a[174:175], v25 offset:61440
    v_mfma_f32_16x16x32_bf16 v[216:219], a[184:187], a[32:35], v[216:219]
    s_waitcnt lgkmcnt(8)
    ds_read_b64_tr_b16 a[176:177], v26 offset:49152
    v_mfma_f32_16x16x32_bf16 v[216:219], a[188:191], a[40:43], v[216:219]
    ds_read_b64_tr_b16 a[178:179], v26 offset:53248
    v_mfma_f32_16x16x32_bf16 v[220:223], a[184:187], a[36:39], v[220:223]
    ds_read_b64_tr_b16 a[180:181], v26 offset:57344
    v_mfma_f32_16x16x32_bf16 v[220:223], a[188:191], a[44:47], v[220:223]
    s_waitcnt lgkmcnt(9)
    ds_read_b64_tr_b16 a[182:183], v26 offset:61440
    v_mfma_f32_16x16x32_bf16 v[224:227], a[160:163], a[32:35], v[224:227]
    s_waitcnt lgkmcnt(8)
    ds_read_b64_tr_b16 a[184:185], v27 offset:49152
    v_mfma_f32_16x16x32_bf16 v[224:227], a[164:167], a[40:43], v[224:227]
    ds_read_b64_tr_b16 a[186:187], v27 offset:53248
    v_mfma_f32_16x16x32_bf16 v[228:231], a[160:163], a[36:39], v[228:231]
    ds_read_b64_tr_b16 a[188:189], v27 offset:57344
    v_mfma_f32_16x16x32_bf16 v[228:231], a[164:167], a[44:47], v[228:231]
    s_waitcnt lgkmcnt(9)
    ds_read_b64_tr_b16 a[190:191], v27 offset:61440
    s_waitcnt vmcnt(24)
    s_barrier
    v_mfma_f32_16x16x32_bf16 v[232:235], a[168:171], a[32:35], v[232:235]
    s_waitcnt lgkmcnt(8)
    ds_read_b64_tr_b16 a[160:161], v28 offset:0
    v_mfma_f32_16x16x32_bf16 v[232:235], a[172:175], a[40:43], v[232:235]
    ds_read_b64_tr_b16 a[162:163], v28 offset:4096
    v_mfma_f32_16x16x32_bf16 v[236:239], a[168:171], a[36:39], v[236:239]
    s_add_u32 s49, s46, 12288
    ds_read_b64_tr_b16 a[164:165], v28 offset:8192
    v_mfma_f32_16x16x32_bf16 v[236:239], a[172:175], a[44:47], v[236:239]
    s_waitcnt lgkmcnt(9)
    ds_read_b64_tr_b16 a[166:167], v28 offset:12288
    buffer_load_dwordx4 a[96:99], v51, s[24:27], s49 offen
    v_mfma_f32_16x16x32_bf16 v[240:243], a[176:179], a[32:35], v[240:243]
    s_waitcnt lgkmcnt(8)
    ds_read_b64_tr_b16 a[168:169], v29 offset:0
    v_mfma_f32_16x16x32_bf16 v[240:243], a[180:183], a[40:43], v[240:243]
    ds_read_b64_tr_b16 a[170:171], v29 offset:4096
    v_mfma_f32_16x16x32_bf16 v[244:247], a[176:179], a[36:39], v[244:247]
    ds_read_b64_tr_b16 a[172:173], v29 offset:8192
    v_mfma_f32_16x16x32_bf16 v[244:247], a[180:183], a[44:47], v[244:247]
    s_waitcnt lgkmcnt(9)
    ds_read_b64_tr_b16 a[174:175], v29 offset:12288
    buffer_load_dwordx4 a[104:107], v51, s[24:27], s49 offen offset:1024
    v_mfma_f32_16x16x32_bf16 v[248:251], a[184:187], a[32:35], v[248:251]
    s_waitcnt lgkmcnt(8)
    ds_read_b64_tr_b16 a[176:177], v30 offset:0
    v_mfma_f32_16x16x32_bf16 v[248:251], a[188:191], a[40:43], v[248:251]
    ds_read_b64_tr_b16 a[178:179], v30 offset:4096
    v_mfma_f32_16x16x32_bf16 v[252:255], a[184:187], a[36:39], v[252:255]
    s_add_u32 s49, s46, 30720
    ds_read_b64_tr_b16 a[180:181], v30 offset:8192
    v_mfma_f32_16x16x32_bf16 v[252:255], a[188:191], a[44:47], v[252:255]
    s_waitcnt lgkmcnt(9)
    ds_read_b64_tr_b16 a[182:183], v30 offset:12288
    buffer_load_dwordx4 a[100:103], v51, s[24:27], s49 offen
    v_mfma_f32_16x16x32_bf16 v[128:131], a[160:163], a[48:51], v[128:131]
    s_waitcnt lgkmcnt(8)
    ds_read_b64_tr_b16 a[184:185], v31 offset:0
    v_mfma_f32_16x16x32_bf16 v[128:131], a[164:167], a[56:59], v[128:131]
    ds_read_b64_tr_b16 a[186:187], v31 offset:4096
    v_mfma_f32_16x16x32_bf16 v[132:135], a[160:163], a[52:55], v[132:135]
    ds_read_b64_tr_b16 a[188:189], v31 offset:8192
    v_mfma_f32_16x16x32_bf16 v[132:135], a[164:167], a[60:63], v[132:135]
    s_waitcnt lgkmcnt(9)
    ds_read_b64_tr_b16 a[190:191], v31 offset:12288
    buffer_load_dwordx4 a[108:111], v51, s[24:27], s49 offen offset:1024
    v_mfma_f32_16x16x32_bf16 v[136:139], a[168:171], a[48:51], v[136:139]
    s_waitcnt lgkmcnt(8)
    ds_read_b64_tr_b16 a[160:161], v32 offset:0
    v_mfma_f32_16x16x32_bf16 v[136:139], a[172:175], a[56:59], v[136:139]
    s_add_u32 s49, s44, 3145728
    ds_read_b64_tr_b16 a[162:163], v32 offset:4096
    v_mfma_f32_16x16x32_bf16 v[140:143], a[168:171], a[52:55], v[140:143]
    s_add_u32 m0, s42, 65536
    ds_read_b64_tr_b16 a[164:165], v32 offset:8192
    v_mfma_f32_16x16x32_bf16 v[140:143], a[172:175], a[60:63], v[140:143]
    s_waitcnt lgkmcnt(9)
    ds_read_b64_tr_b16 a[166:167], v32 offset:12288
    buffer_load_dwordx4 v42, s[16:19], s49 offen lds
    v_mfma_f32_16x16x32_bf16 v[144:147], a[176:179], a[48:51], v[144:147]
    s_waitcnt lgkmcnt(8)
    ds_read_b64_tr_b16 a[168:169], v33 offset:0
    v_mfma_f32_16x16x32_bf16 v[144:147], a[180:183], a[56:59], v[144:147]
    ds_read_b64_tr_b16 a[170:171], v33 offset:4096
    v_mfma_f32_16x16x32_bf16 v[148:151], a[176:179], a[52:55], v[148:151]
    ds_read_b64_tr_b16 a[172:173], v33 offset:8192
    v_mfma_f32_16x16x32_bf16 v[148:151], a[180:183], a[60:63], v[148:151]
    s_waitcnt lgkmcnt(9)
    ds_read_b64_tr_b16 a[174:175], v33 offset:12288
    buffer_load_dwordx4 v43, s[16:19], s49 offen offset:1024 lds
    v_mfma_f32_16x16x32_bf16 v[152:155], a[184:187], a[48:51], v[152:155]
    s_waitcnt lgkmcnt(8)
    ds_read_b64_tr_b16 a[176:177], v34 offset:0
    v_mfma_f32_16x16x32_bf16 v[152:155], a[188:191], a[56:59], v[152:155]
    ds_read_b64_tr_b16 a[178:179], v34 offset:4096
    v_mfma_f32_16x16x32_bf16 v[156:159], a[184:187], a[52:55], v[156:159]
    ds_read_b64_tr_b16 a[180:181], v34 offset:8192
    v_mfma_f32_16x16x32_bf16 v[156:159], a[188:191], a[60:63], v[156:159]
    s_waitcnt lgkmcnt(9)
    ds_read_b64_tr_b16 a[182:183], v34 offset:12288
    buffer_load_dwordx4 v44, s[16:19], s49 offen offset:2048 lds
    v_mfma_f32_16x16x32_bf16 v[160:163], a[160:163], a[48:51], v[160:163]
    s_waitcnt lgkmcnt(8)
    ds_read_b64_tr_b16 a[184:185], v35 offset:0
    v_mfma_f32_16x16x32_bf16 v[160:163], a[164:167], a[56:59], v[160:163]
    ds_read_b64_tr_b16 a[186:187], v35 offset:4096
    v_mfma_f32_16x16x32_bf16 v[164:167], a[160:163], a[52:55], v[164:167]
    ds_read_b64_tr_b16 a[188:189], v35 offset:8192
    v_mfma_f32_16x16x32_bf16 v[164:167], a[164:167], a[60:63], v[164:167]
    s_waitcnt lgkmcnt(9)
    ds_read_b64_tr_b16 a[190:191], v35 offset:12288
    buffer_load_dwordx4 v45, s[16:19], s49 offen offset:3072 lds
    v_mfma_f32_16x16x32_bf16 v[168:171], a[168:171], a[48:51], v[168:171]
    s_waitcnt lgkmcnt(8)
    ds_read_b64_tr_b16 a[160:161], v28 offset:16384
    v_mfma_f32_16x16x32_bf16 v[168:171], a[172:175], a[56:59], v[168:171]
    s_add_u32 s49, s44, 3145984
    ds_read_b64_tr_b16 a[162:163], v28 offset:20480
    v_mfma_f32_16x16x32_bf16 v[172:175], a[168:171], a[52:55], v[172:175]
    s_add_u32 m0, s42, 81920
    ds_read_b64_tr_b16 a[164:165], v28 offset:24576
    v_mfma_f32_16x16x32_bf16 v[172:175], a[172:175], a[60:63], v[172:175]
    s_waitcnt lgkmcnt(9)
    ds_read_b64_tr_b16 a[166:167], v28 offset:28672
    buffer_load_dwordx4 v42, s[16:19], s49 offen lds
    v_mfma_f32_16x16x32_bf16 v[176:179], a[176:179], a[48:51], v[176:179]
    s_waitcnt lgkmcnt(8)
    ds_read_b64_tr_b16 a[168:169], v29 offset:16384
    v_mfma_f32_16x16x32_bf16 v[176:179], a[180:183], a[56:59], v[176:179]
    ds_read_b64_tr_b16 a[170:171], v29 offset:20480
    v_mfma_f32_16x16x32_bf16 v[180:183], a[176:179], a[52:55], v[180:183]
    ds_read_b64_tr_b16 a[172:173], v29 offset:24576
    v_mfma_f32_16x16x32_bf16 v[180:183], a[180:183], a[60:63], v[180:183]
    s_waitcnt lgkmcnt(9)
    ds_read_b64_tr_b16 a[174:175], v29 offset:28672
    buffer_load_dwordx4 v43, s[16:19], s49 offen offset:1024 lds
    v_mfma_f32_16x16x32_bf16 v[184:187], a[184:187], a[48:51], v[184:187]
    s_waitcnt lgkmcnt(8)
    ds_read_b64_tr_b16 a[176:177], v30 offset:16384
    v_mfma_f32_16x16x32_bf16 v[184:187], a[188:191], a[56:59], v[184:187]
    ds_read_b64_tr_b16 a[178:179], v30 offset:20480
    v_mfma_f32_16x16x32_bf16 v[188:191], a[184:187], a[52:55], v[188:191]
    ds_read_b64_tr_b16 a[180:181], v30 offset:24576
    v_mfma_f32_16x16x32_bf16 v[188:191], a[188:191], a[60:63], v[188:191]
    s_waitcnt lgkmcnt(9)
    ds_read_b64_tr_b16 a[182:183], v30 offset:28672
    buffer_load_dwordx4 v44, s[16:19], s49 offen offset:2048 lds
    v_mfma_f32_16x16x32_bf16 v[192:195], a[160:163], a[48:51], v[192:195]
    s_waitcnt lgkmcnt(8)
    ds_read_b64_tr_b16 a[184:185], v31 offset:16384
    v_mfma_f32_16x16x32_bf16 v[192:195], a[164:167], a[56:59], v[192:195]
    ds_read_b64_tr_b16 a[186:187], v31 offset:20480
    v_mfma_f32_16x16x32_bf16 v[196:199], a[160:163], a[52:55], v[196:199]
    ds_read_b64_tr_b16 a[188:189], v31 offset:24576
    v_mfma_f32_16x16x32_bf16 v[196:199], a[164:167], a[60:63], v[196:199]
    s_waitcnt lgkmcnt(9)
    ds_read_b64_tr_b16 a[190:191], v31 offset:28672
    buffer_load_dwordx4 v45, s[16:19], s49 offen offset:3072 lds
    v_mfma_f32_16x16x32_bf16 v[200:203], a[168:171], a[48:51], v[200:203]
    s_waitcnt lgkmcnt(8)
    ds_read_b64_tr_b16 a[160:161], v32 offset:16384
    v_mfma_f32_16x16x32_bf16 v[200:203], a[172:175], a[56:59], v[200:203]
    ds_read_b64_tr_b16 a[162:163], v32 offset:20480
    v_mfma_f32_16x16x32_bf16 v[204:207], a[168:171], a[52:55], v[204:207]
    ds_read_b64_tr_b16 a[164:165], v32 offset:24576
    v_mfma_f32_16x16x32_bf16 v[204:207], a[172:175], a[60:63], v[204:207]
    s_waitcnt lgkmcnt(9)
    ds_read_b64_tr_b16 a[166:167], v32 offset:28672
    v_mfma_f32_16x16x32_bf16 v[208:211], a[176:179], a[48:51], v[208:211]
    s_waitcnt lgkmcnt(8)
    ds_read_b64_tr_b16 a[168:169], v33 offset:16384
    v_mfma_f32_16x16x32_bf16 v[208:211], a[180:183], a[56:59], v[208:211]
    ds_read_b64_tr_b16 a[170:171], v33 offset:20480
    v_mfma_f32_16x16x32_bf16 v[212:215], a[176:179], a[52:55], v[212:215]
    ds_read_b64_tr_b16 a[172:173], v33 offset:24576
    v_mfma_f32_16x16x32_bf16 v[212:215], a[180:183], a[60:63], v[212:215]
    s_waitcnt lgkmcnt(9)
    ds_read_b64_tr_b16 a[174:175], v33 offset:28672
    v_mfma_f32_16x16x32_bf16 v[216:219], a[184:187], a[48:51], v[216:219]
    s_waitcnt lgkmcnt(8)
    ds_read_b64_tr_b16 a[176:177], v34 offset:16384
    v_mfma_f32_16x16x32_bf16 v[216:219], a[188:191], a[56:59], v[216:219]
    ds_read_b64_tr_b16 a[178:179], v34 offset:20480
    v_mfma_f32_16x16x32_bf16 v[220:223], a[184:187], a[52:55], v[220:223]
    ds_read_b64_tr_b16 a[180:181], v34 offset:24576
    v_mfma_f32_16x16x32_bf16 v[220:223], a[188:191], a[60:63], v[220:223]
    s_waitcnt lgkmcnt(9)
    ds_read_b64_tr_b16 a[182:183], v34 offset:28672
    v_mfma_f32_16x16x32_bf16 v[224:227], a[160:163], a[48:51], v[224:227]
    s_waitcnt lgkmcnt(8)
    ds_read_b64_tr_b16 a[184:185], v35 offset:16384
    v_mfma_f32_16x16x32_bf16 v[224:227], a[164:167], a[56:59], v[224:227]
    ds_read_b64_tr_b16 a[186:187], v35 offset:20480
    v_mfma_f32_16x16x32_bf16 v[228:231], a[160:163], a[52:55], v[228:231]
    ds_read_b64_tr_b16 a[188:189], v35 offset:24576
    v_mfma_f32_16x16x32_bf16 v[228:231], a[164:167], a[60:63], v[228:231]
    s_waitcnt lgkmcnt(9)
    ds_read_b64_tr_b16 a[190:191], v35 offset:28672
    s_waitcnt vmcnt(24)
    s_barrier
    v_mfma_f32_16x16x32_bf16 v[232:235], a[168:171], a[48:51], v[232:235]
    s_waitcnt lgkmcnt(8)
    ds_read_b64_tr_b16 a[160:161], v12 offset:0
    v_mfma_f32_16x16x32_bf16 v[232:235], a[172:175], a[56:59], v[232:235]
    ds_read_b64_tr_b16 a[162:163], v12 offset:4096
    v_mfma_f32_16x16x32_bf16 v[236:239], a[168:171], a[52:55], v[236:239]
    s_add_u32 s49, s46, 14336
    ds_read_b64_tr_b16 a[164:165], v12 offset:8192
    v_mfma_f32_16x16x32_bf16 v[236:239], a[172:175], a[60:63], v[236:239]
    s_waitcnt lgkmcnt(9)
    ds_read_b64_tr_b16 a[166:167], v12 offset:12288
    buffer_load_dwordx4 a[112:115], v51, s[24:27], s49 offen
    v_mfma_f32_16x16x32_bf16 v[240:243], a[176:179], a[48:51], v[240:243]
    s_waitcnt lgkmcnt(8)
    ds_read_b64_tr_b16 a[168:169], v13 offset:0
    v_mfma_f32_16x16x32_bf16 v[240:243], a[180:183], a[56:59], v[240:243]
    ds_read_b64_tr_b16 a[170:171], v13 offset:4096
    v_mfma_f32_16x16x32_bf16 v[244:247], a[176:179], a[52:55], v[244:247]
    ds_read_b64_tr_b16 a[172:173], v13 offset:8192
    v_mfma_f32_16x16x32_bf16 v[244:247], a[180:183], a[60:63], v[244:247]
    s_waitcnt lgkmcnt(9)
    ds_read_b64_tr_b16 a[174:175], v13 offset:12288
    buffer_load_dwordx4 a[120:123], v51, s[24:27], s49 offen offset:1024
    v_mfma_f32_16x16x32_bf16 v[248:251], a[184:187], a[48:51], v[248:251]
    s_waitcnt lgkmcnt(8)
    ds_read_b64_tr_b16 a[176:177], v14 offset:0
    v_mfma_f32_16x16x32_bf16 v[248:251], a[188:191], a[56:59], v[248:251]
    ds_read_b64_tr_b16 a[178:179], v14 offset:4096
    v_mfma_f32_16x16x32_bf16 v[252:255], a[184:187], a[52:55], v[252:255]
    s_add_u32 s49, s46, 32768
    ds_read_b64_tr_b16 a[180:181], v14 offset:8192
    v_mfma_f32_16x16x32_bf16 v[252:255], a[188:191], a[60:63], v[252:255]
    s_waitcnt lgkmcnt(9)
    ds_read_b64_tr_b16 a[182:183], v14 offset:12288
    buffer_load_dwordx4 a[116:119], v51, s[24:27], s49 offen
    v_mfma_f32_16x16x32_bf16 v[128:131], a[160:163], a[64:67], v[128:131]
    s_waitcnt lgkmcnt(8)
    ds_read_b64_tr_b16 a[184:185], v15 offset:0
    v_mfma_f32_16x16x32_bf16 v[128:131], a[164:167], a[72:75], v[128:131]
    ds_read_b64_tr_b16 a[186:187], v15 offset:4096
    v_mfma_f32_16x16x32_bf16 v[132:135], a[160:163], a[68:71], v[132:135]
    ds_read_b64_tr_b16 a[188:189], v15 offset:8192
    v_mfma_f32_16x16x32_bf16 v[132:135], a[164:167], a[76:79], v[132:135]
    s_waitcnt lgkmcnt(9)
    ds_read_b64_tr_b16 a[190:191], v15 offset:12288
    buffer_load_dwordx4 a[124:127], v51, s[24:27], s49 offen offset:1024
    v_mfma_f32_16x16x32_bf16 v[136:139], a[168:171], a[64:67], v[136:139]
    s_waitcnt lgkmcnt(8)
    ds_read_b64_tr_b16 a[160:161], v16 offset:0
    v_mfma_f32_16x16x32_bf16 v[136:139], a[172:175], a[72:75], v[136:139]
    s_add_u32 s49, s44, 3670016
    ds_read_b64_tr_b16 a[162:163], v16 offset:4096
    v_mfma_f32_16x16x32_bf16 v[140:143], a[168:171], a[68:71], v[140:143]
    s_add_u32 m0, s42, 98304
    ds_read_b64_tr_b16 a[164:165], v16 offset:8192
    v_mfma_f32_16x16x32_bf16 v[140:143], a[172:175], a[76:79], v[140:143]
    s_waitcnt lgkmcnt(9)
    ds_read_b64_tr_b16 a[166:167], v16 offset:12288
    buffer_load_dwordx4 v42, s[16:19], s49 offen lds
    v_mfma_f32_16x16x32_bf16 v[144:147], a[176:179], a[64:67], v[144:147]
    s_waitcnt lgkmcnt(8)
    ds_read_b64_tr_b16 a[168:169], v17 offset:0
    v_mfma_f32_16x16x32_bf16 v[144:147], a[180:183], a[72:75], v[144:147]
    ds_read_b64_tr_b16 a[170:171], v17 offset:4096
    v_mfma_f32_16x16x32_bf16 v[148:151], a[176:179], a[68:71], v[148:151]
    ds_read_b64_tr_b16 a[172:173], v17 offset:8192
    v_mfma_f32_16x16x32_bf16 v[148:151], a[180:183], a[76:79], v[148:151]
    s_waitcnt lgkmcnt(9)
    ds_read_b64_tr_b16 a[174:175], v17 offset:12288
    buffer_load_dwordx4 v43, s[16:19], s49 offen offset:1024 lds
    v_mfma_f32_16x16x32_bf16 v[152:155], a[184:187], a[64:67], v[152:155]
    s_waitcnt lgkmcnt(8)
    ds_read_b64_tr_b16 a[176:177], v18 offset:0
    v_mfma_f32_16x16x32_bf16 v[152:155], a[188:191], a[72:75], v[152:155]
    ds_read_b64_tr_b16 a[178:179], v18 offset:4096
    v_mfma_f32_16x16x32_bf16 v[156:159], a[184:187], a[68:71], v[156:159]
    ds_read_b64_tr_b16 a[180:181], v18 offset:8192
    v_mfma_f32_16x16x32_bf16 v[156:159], a[188:191], a[76:79], v[156:159]
    s_waitcnt lgkmcnt(9)
    ds_read_b64_tr_b16 a[182:183], v18 offset:12288
    buffer_load_dwordx4 v44, s[16:19], s49 offen offset:2048 lds
    v_mfma_f32_16x16x32_bf16 v[160:163], a[160:163], a[64:67], v[160:163]
    s_waitcnt lgkmcnt(8)
    ds_read_b64_tr_b16 a[184:185], v19 offset:0
    v_mfma_f32_16x16x32_bf16 v[160:163], a[164:167], a[72:75], v[160:163]
    ds_read_b64_tr_b16 a[186:187], v19 offset:4096
    v_mfma_f32_16x16x32_bf16 v[164:167], a[160:163], a[68:71], v[164:167]
    ds_read_b64_tr_b16 a[188:189], v19 offset:8192
    v_mfma_f32_16x16x32_bf16 v[164:167], a[164:167], a[76:79], v[164:167]
    s_waitcnt lgkmcnt(9)
    ds_read_b64_tr_b16 a[190:191], v19 offset:12288
    buffer_load_dwordx4 v45, s[16:19], s49 offen offset:3072 lds
    v_mfma_f32_16x16x32_bf16 v[168:171], a[168:171], a[64:67], v[168:171]
    s_waitcnt lgkmcnt(8)
    ds_read_b64_tr_b16 a[160:161], v12 offset:16384
    v_mfma_f32_16x16x32_bf16 v[168:171], a[172:175], a[72:75], v[168:171]
    s_add_u32 s49, s44, 3670272
    ds_read_b64_tr_b16 a[162:163], v12 offset:20480
    v_mfma_f32_16x16x32_bf16 v[172:175], a[168:171], a[68:71], v[172:175]
    s_add_u32 m0, s42, 114688
    ds_read_b64_tr_b16 a[164:165], v12 offset:24576
    v_mfma_f32_16x16x32_bf16 v[172:175], a[172:175], a[76:79], v[172:175]
    s_waitcnt lgkmcnt(9)
    ds_read_b64_tr_b16 a[166:167], v12 offset:28672
    buffer_load_dwordx4 v42, s[16:19], s49 offen lds
    v_mfma_f32_16x16x32_bf16 v[176:179], a[176:179], a[64:67], v[176:179]
    s_waitcnt lgkmcnt(8)
    ds_read_b64_tr_b16 a[168:169], v13 offset:16384
    v_mfma_f32_16x16x32_bf16 v[176:179], a[180:183], a[72:75], v[176:179]
    ds_read_b64_tr_b16 a[170:171], v13 offset:20480
    v_mfma_f32_16x16x32_bf16 v[180:183], a[176:179], a[68:71], v[180:183]
    ds_read_b64_tr_b16 a[172:173], v13 offset:24576
    v_mfma_f32_16x16x32_bf16 v[180:183], a[180:183], a[76:79], v[180:183]
    s_waitcnt lgkmcnt(9)
    ds_read_b64_tr_b16 a[174:175], v13 offset:28672
    buffer_load_dwordx4 v43, s[16:19], s49 offen offset:1024 lds
    v_mfma_f32_16x16x32_bf16 v[184:187], a[184:187], a[64:67], v[184:187]
    s_waitcnt lgkmcnt(8)
    ds_read_b64_tr_b16 a[176:177], v14 offset:16384
    v_mfma_f32_16x16x32_bf16 v[184:187], a[188:191], a[72:75], v[184:187]
    ds_read_b64_tr_b16 a[178:179], v14 offset:20480
    v_mfma_f32_16x16x32_bf16 v[188:191], a[184:187], a[68:71], v[188:191]
    ds_read_b64_tr_b16 a[180:181], v14 offset:24576
    v_mfma_f32_16x16x32_bf16 v[188:191], a[188:191], a[76:79], v[188:191]
    s_waitcnt lgkmcnt(9)
    ds_read_b64_tr_b16 a[182:183], v14 offset:28672
    buffer_load_dwordx4 v44, s[16:19], s49 offen offset:2048 lds
    v_mfma_f32_16x16x32_bf16 v[192:195], a[160:163], a[64:67], v[192:195]
    s_waitcnt lgkmcnt(8)
    ds_read_b64_tr_b16 a[184:185], v15 offset:16384
    v_mfma_f32_16x16x32_bf16 v[192:195], a[164:167], a[72:75], v[192:195]
    ds_read_b64_tr_b16 a[186:187], v15 offset:20480
    v_mfma_f32_16x16x32_bf16 v[196:199], a[160:163], a[68:71], v[196:199]
    ds_read_b64_tr_b16 a[188:189], v15 offset:24576
    v_mfma_f32_16x16x32_bf16 v[196:199], a[164:167], a[76:79], v[196:199]
    s_waitcnt lgkmcnt(9)
    ds_read_b64_tr_b16 a[190:191], v15 offset:28672
    buffer_load_dwordx4 v45, s[16:19], s49 offen offset:3072 lds
    v_mfma_f32_16x16x32_bf16 v[200:203], a[168:171], a[64:67], v[200:203]
    s_waitcnt lgkmcnt(8)
    ds_read_b64_tr_b16 a[160:161], v16 offset:16384
    v_mfma_f32_16x16x32_bf16 v[200:203], a[172:175], a[72:75], v[200:203]
    ds_read_b64_tr_b16 a[162:163], v16 offset:20480
    v_mfma_f32_16x16x32_bf16 v[204:207], a[168:171], a[68:71], v[204:207]
    ds_read_b64_tr_b16 a[164:165], v16 offset:24576
    v_mfma_f32_16x16x32_bf16 v[204:207], a[172:175], a[76:79], v[204:207]
    s_waitcnt lgkmcnt(9)
    ds_read_b64_tr_b16 a[166:167], v16 offset:28672
    v_mfma_f32_16x16x32_bf16 v[208:211], a[176:179], a[64:67], v[208:211]
    s_waitcnt lgkmcnt(8)
    ds_read_b64_tr_b16 a[168:169], v17 offset:16384
    v_mfma_f32_16x16x32_bf16 v[208:211], a[180:183], a[72:75], v[208:211]
    ds_read_b64_tr_b16 a[170:171], v17 offset:20480
    v_mfma_f32_16x16x32_bf16 v[212:215], a[176:179], a[68:71], v[212:215]
    ds_read_b64_tr_b16 a[172:173], v17 offset:24576
    v_mfma_f32_16x16x32_bf16 v[212:215], a[180:183], a[76:79], v[212:215]
    s_waitcnt lgkmcnt(9)
    ds_read_b64_tr_b16 a[174:175], v17 offset:28672
    v_mfma_f32_16x16x32_bf16 v[216:219], a[184:187], a[64:67], v[216:219]
    s_waitcnt lgkmcnt(8)
    ds_read_b64_tr_b16 a[176:177], v18 offset:16384
    v_mfma_f32_16x16x32_bf16 v[216:219], a[188:191], a[72:75], v[216:219]
    ds_read_b64_tr_b16 a[178:179], v18 offset:20480
    v_mfma_f32_16x16x32_bf16 v[220:223], a[184:187], a[68:71], v[220:223]
    ds_read_b64_tr_b16 a[180:181], v18 offset:24576
    v_mfma_f32_16x16x32_bf16 v[220:223], a[188:191], a[76:79], v[220:223]
    s_waitcnt lgkmcnt(9)
    ds_read_b64_tr_b16 a[182:183], v18 offset:28672
    v_mfma_f32_16x16x32_bf16 v[224:227], a[160:163], a[64:67], v[224:227]
    s_waitcnt lgkmcnt(8)
    ds_read_b64_tr_b16 a[184:185], v19 offset:16384
    v_mfma_f32_16x16x32_bf16 v[224:227], a[164:167], a[72:75], v[224:227]
    ds_read_b64_tr_b16 a[186:187], v19 offset:20480
    v_mfma_f32_16x16x32_bf16 v[228:231], a[160:163], a[68:71], v[228:231]
    ds_read_b64_tr_b16 a[188:189], v19 offset:24576
    v_mfma_f32_16x16x32_bf16 v[228:231], a[164:167], a[76:79], v[228:231]
    s_waitcnt lgkmcnt(9)
    ds_read_b64_tr_b16 a[190:191], v19 offset:28672
    s_waitcnt vmcnt(24)
    s_barrier
    v_mfma_f32_16x16x32_bf16 v[232:235], a[168:171], a[64:67], v[232:235]
    s_waitcnt lgkmcnt(8)
    ds_read_b64_tr_b16 a[160:161], v12 offset:32768
    v_mfma_f32_16x16x32_bf16 v[232:235], a[172:175], a[72:75], v[232:235]
    ds_read_b64_tr_b16 a[162:163], v12 offset:36864
    v_mfma_f32_16x16x32_bf16 v[236:239], a[168:171], a[68:71], v[236:239]
    s_add_u32 s49, s46, 16384
    ds_read_b64_tr_b16 a[164:165], v12 offset:40960
    v_mfma_f32_16x16x32_bf16 v[236:239], a[172:175], a[76:79], v[236:239]
    s_waitcnt lgkmcnt(9)
    ds_read_b64_tr_b16 a[166:167], v12 offset:45056
    buffer_load_dwordx4 a[128:131], v51, s[24:27], s49 offen
    v_mfma_f32_16x16x32_bf16 v[240:243], a[176:179], a[64:67], v[240:243]
    s_waitcnt lgkmcnt(8)
    ds_read_b64_tr_b16 a[168:169], v13 offset:32768
    v_mfma_f32_16x16x32_bf16 v[240:243], a[180:183], a[72:75], v[240:243]
    ds_read_b64_tr_b16 a[170:171], v13 offset:36864
    v_mfma_f32_16x16x32_bf16 v[244:247], a[176:179], a[68:71], v[244:247]
    ds_read_b64_tr_b16 a[172:173], v13 offset:40960
    v_mfma_f32_16x16x32_bf16 v[244:247], a[180:183], a[76:79], v[244:247]
    s_waitcnt lgkmcnt(9)
    ds_read_b64_tr_b16 a[174:175], v13 offset:45056
    buffer_load_dwordx4 a[136:139], v51, s[24:27], s49 offen offset:1024
    v_mfma_f32_16x16x32_bf16 v[248:251], a[184:187], a[64:67], v[248:251]
    s_waitcnt lgkmcnt(8)
    ds_read_b64_tr_b16 a[176:177], v14 offset:32768
    v_mfma_f32_16x16x32_bf16 v[248:251], a[188:191], a[72:75], v[248:251]
    ds_read_b64_tr_b16 a[178:179], v14 offset:36864
    v_mfma_f32_16x16x32_bf16 v[252:255], a[184:187], a[68:71], v[252:255]
    s_add_u32 s49, s46, 34816
    ds_read_b64_tr_b16 a[180:181], v14 offset:40960
    v_mfma_f32_16x16x32_bf16 v[252:255], a[188:191], a[76:79], v[252:255]
    s_waitcnt lgkmcnt(9)
    ds_read_b64_tr_b16 a[182:183], v14 offset:45056
    buffer_load_dwordx4 a[132:135], v51, s[24:27], s49 offen
    v_mfma_f32_16x16x32_bf16 v[128:131], a[160:163], a[80:83], v[128:131]
    s_waitcnt lgkmcnt(8)
    ds_read_b64_tr_b16 a[184:185], v15 offset:32768
    v_mfma_f32_16x16x32_bf16 v[128:131], a[164:167], a[88:91], v[128:131]
    ds_read_b64_tr_b16 a[186:187], v15 offset:36864
    v_mfma_f32_16x16x32_bf16 v[132:135], a[160:163], a[84:87], v[132:135]
    ds_read_b64_tr_b16 a[188:189], v15 offset:40960
    v_mfma_f32_16x16x32_bf16 v[132:135], a[164:167], a[92:95], v[132:135]
    s_waitcnt lgkmcnt(9)
    ds_read_b64_tr_b16 a[190:191], v15 offset:45056
    buffer_load_dwordx4 a[140:143], v51, s[24:27], s49 offen offset:1024
    v_mfma_f32_16x16x32_bf16 v[136:139], a[168:171], a[80:83], v[136:139]
    s_waitcnt lgkmcnt(8)
    ds_read_b64_tr_b16 a[160:161], v16 offset:32768
    v_mfma_f32_16x16x32_bf16 v[136:139], a[172:175], a[88:91], v[136:139]
    s_add_u32 s49, s44, 4194304
    ds_read_b64_tr_b16 a[162:163], v16 offset:36864
    v_mfma_f32_16x16x32_bf16 v[140:143], a[168:171], a[84:87], v[140:143]
    s_add_u32 m0, s42, 131072
    ds_read_b64_tr_b16 a[164:165], v16 offset:40960
    v_mfma_f32_16x16x32_bf16 v[140:143], a[172:175], a[92:95], v[140:143]
    s_waitcnt lgkmcnt(9)
    ds_read_b64_tr_b16 a[166:167], v16 offset:45056
    buffer_load_dwordx4 v42, s[16:19], s49 offen lds
    v_mfma_f32_16x16x32_bf16 v[144:147], a[176:179], a[80:83], v[144:147]
    s_waitcnt lgkmcnt(8)
    ds_read_b64_tr_b16 a[168:169], v17 offset:32768
    v_mfma_f32_16x16x32_bf16 v[144:147], a[180:183], a[88:91], v[144:147]
    ds_read_b64_tr_b16 a[170:171], v17 offset:36864
    v_mfma_f32_16x16x32_bf16 v[148:151], a[176:179], a[84:87], v[148:151]
    ds_read_b64_tr_b16 a[172:173], v17 offset:40960
    v_mfma_f32_16x16x32_bf16 v[148:151], a[180:183], a[92:95], v[148:151]
    s_waitcnt lgkmcnt(9)
    ds_read_b64_tr_b16 a[174:175], v17 offset:45056
    buffer_load_dwordx4 v43, s[16:19], s49 offen offset:1024 lds
    v_mfma_f32_16x16x32_bf16 v[152:155], a[184:187], a[80:83], v[152:155]
    s_waitcnt lgkmcnt(8)
    ds_read_b64_tr_b16 a[176:177], v18 offset:32768
    v_mfma_f32_16x16x32_bf16 v[152:155], a[188:191], a[88:91], v[152:155]
    ds_read_b64_tr_b16 a[178:179], v18 offset:36864
    v_mfma_f32_16x16x32_bf16 v[156:159], a[184:187], a[84:87], v[156:159]
    ds_read_b64_tr_b16 a[180:181], v18 offset:40960
    v_mfma_f32_16x16x32_bf16 v[156:159], a[188:191], a[92:95], v[156:159]
    s_waitcnt lgkmcnt(9)
    ds_read_b64_tr_b16 a[182:183], v18 offset:45056
    buffer_load_dwordx4 v44, s[16:19], s49 offen offset:2048 lds
    v_mfma_f32_16x16x32_bf16 v[160:163], a[160:163], a[80:83], v[160:163]
    s_waitcnt lgkmcnt(8)
    ds_read_b64_tr_b16 a[184:185], v19 offset:32768
    v_mfma_f32_16x16x32_bf16 v[160:163], a[164:167], a[88:91], v[160:163]
    ds_read_b64_tr_b16 a[186:187], v19 offset:36864
    v_mfma_f32_16x16x32_bf16 v[164:167], a[160:163], a[84:87], v[164:167]
    ds_read_b64_tr_b16 a[188:189], v19 offset:40960
    v_mfma_f32_16x16x32_bf16 v[164:167], a[164:167], a[92:95], v[164:167]
    s_waitcnt lgkmcnt(9)
    ds_read_b64_tr_b16 a[190:191], v19 offset:45056
    buffer_load_dwordx4 v45, s[16:19], s49 offen offset:3072 lds
    v_mfma_f32_16x16x32_bf16 v[168:171], a[168:171], a[80:83], v[168:171]
    s_waitcnt lgkmcnt(8)
    ds_read_b64_tr_b16 a[160:161], v12 offset:49152
    v_mfma_f32_16x16x32_bf16 v[168:171], a[172:175], a[88:91], v[168:171]
    s_add_u32 s49, s44, 4194560
    ds_read_b64_tr_b16 a[162:163], v12 offset:53248
    v_mfma_f32_16x16x32_bf16 v[172:175], a[168:171], a[84:87], v[172:175]
    s_add_u32 m0, s42, 147456
    ds_read_b64_tr_b16 a[164:165], v12 offset:57344
    v_mfma_f32_16x16x32_bf16 v[172:175], a[172:175], a[92:95], v[172:175]
    s_waitcnt lgkmcnt(9)
    ds_read_b64_tr_b16 a[166:167], v12 offset:61440
    buffer_load_dwordx4 v42, s[16:19], s49 offen lds
    v_mfma_f32_16x16x32_bf16 v[176:179], a[176:179], a[80:83], v[176:179]
    s_waitcnt lgkmcnt(8)
    ds_read_b64_tr_b16 a[168:169], v13 offset:49152
    v_mfma_f32_16x16x32_bf16 v[176:179], a[180:183], a[88:91], v[176:179]
    ds_read_b64_tr_b16 a[170:171], v13 offset:53248
    v_mfma_f32_16x16x32_bf16 v[180:183], a[176:179], a[84:87], v[180:183]
    ds_read_b64_tr_b16 a[172:173], v13 offset:57344
    v_mfma_f32_16x16x32_bf16 v[180:183], a[180:183], a[92:95], v[180:183]
    s_waitcnt lgkmcnt(9)
    ds_read_b64_tr_b16 a[174:175], v13 offset:61440
    buffer_load_dwordx4 v43, s[16:19], s49 offen offset:1024 lds
    v_mfma_f32_16x16x32_bf16 v[184:187], a[184:187], a[80:83], v[184:187]
    s_waitcnt lgkmcnt(8)
    ds_read_b64_tr_b16 a[176:177], v14 offset:49152
    v_mfma_f32_16x16x32_bf16 v[184:187], a[188:191], a[88:91], v[184:187]
    ds_read_b64_tr_b16 a[178:179], v14 offset:53248
    v_mfma_f32_16x16x32_bf16 v[188:191], a[184:187], a[84:87], v[188:191]
    ds_read_b64_tr_b16 a[180:181], v14 offset:57344
    v_mfma_f32_16x16x32_bf16 v[188:191], a[188:191], a[92:95], v[188:191]
    s_waitcnt lgkmcnt(9)
    ds_read_b64_tr_b16 a[182:183], v14 offset:61440
    buffer_load_dwordx4 v44, s[16:19], s49 offen offset:2048 lds
    v_mfma_f32_16x16x32_bf16 v[192:195], a[160:163], a[80:83], v[192:195]
    s_waitcnt lgkmcnt(8)
    ds_read_b64_tr_b16 a[184:185], v15 offset:49152
    v_mfma_f32_16x16x32_bf16 v[192:195], a[164:167], a[88:91], v[192:195]
    ds_read_b64_tr_b16 a[186:187], v15 offset:53248
    v_mfma_f32_16x16x32_bf16 v[196:199], a[160:163], a[84:87], v[196:199]
    ds_read_b64_tr_b16 a[188:189], v15 offset:57344
    v_mfma_f32_16x16x32_bf16 v[196:199], a[164:167], a[92:95], v[196:199]
    s_waitcnt lgkmcnt(9)
    ds_read_b64_tr_b16 a[190:191], v15 offset:61440
    buffer_load_dwordx4 v45, s[16:19], s49 offen offset:3072 lds
    v_mfma_f32_16x16x32_bf16 v[200:203], a[168:171], a[80:83], v[200:203]
    s_waitcnt lgkmcnt(8)
    ds_read_b64_tr_b16 a[160:161], v16 offset:49152
    v_mfma_f32_16x16x32_bf16 v[200:203], a[172:175], a[88:91], v[200:203]
    ds_read_b64_tr_b16 a[162:163], v16 offset:53248
    v_mfma_f32_16x16x32_bf16 v[204:207], a[168:171], a[84:87], v[204:207]
    ds_read_b64_tr_b16 a[164:165], v16 offset:57344
    v_mfma_f32_16x16x32_bf16 v[204:207], a[172:175], a[92:95], v[204:207]
    s_waitcnt lgkmcnt(9)
    ds_read_b64_tr_b16 a[166:167], v16 offset:61440
    v_mfma_f32_16x16x32_bf16 v[208:211], a[176:179], a[80:83], v[208:211]
    s_waitcnt lgkmcnt(8)
    ds_read_b64_tr_b16 a[168:169], v17 offset:49152
    v_mfma_f32_16x16x32_bf16 v[208:211], a[180:183], a[88:91], v[208:211]
    ds_read_b64_tr_b16 a[170:171], v17 offset:53248
    v_mfma_f32_16x16x32_bf16 v[212:215], a[176:179], a[84:87], v[212:215]
    ds_read_b64_tr_b16 a[172:173], v17 offset:57344
    v_mfma_f32_16x16x32_bf16 v[212:215], a[180:183], a[92:95], v[212:215]
    s_waitcnt lgkmcnt(9)
    ds_read_b64_tr_b16 a[174:175], v17 offset:61440
    v_mfma_f32_16x16x32_bf16 v[216:219], a[184:187], a[80:83], v[216:219]
    s_waitcnt lgkmcnt(8)
    ds_read_b64_tr_b16 a[176:177], v18 offset:49152
    v_mfma_f32_16x16x32_bf16 v[216:219], a[188:191], a[88:91], v[216:219]
    ds_read_b64_tr_b16 a[178:179], v18 offset:53248
    v_mfma_f32_16x16x32_bf16 v[220:223], a[184:187], a[84:87], v[220:223]
    ds_read_b64_tr_b16 a[180:181], v18 offset:57344
    v_mfma_f32_16x16x32_bf16 v[220:223], a[188:191], a[92:95], v[220:223]
    s_waitcnt lgkmcnt(9)
    ds_read_b64_tr_b16 a[182:183], v18 offset:61440
    v_mfma_f32_16x16x32_bf16 v[224:227], a[160:163], a[80:83], v[224:227]
    s_waitcnt lgkmcnt(8)
    ds_read_b64_tr_b16 a[184:185], v19 offset:49152
    v_mfma_f32_16x16x32_bf16 v[224:227], a[164:167], a[88:91], v[224:227]
    ds_read_b64_tr_b16 a[186:187], v19 offset:53248
    v_mfma_f32_16x16x32_bf16 v[228:231], a[160:163], a[84:87], v[228:231]
    ds_read_b64_tr_b16 a[188:189], v19 offset:57344
    v_mfma_f32_16x16x32_bf16 v[228:231], a[164:167], a[92:95], v[228:231]
    s_waitcnt lgkmcnt(9)
    ds_read_b64_tr_b16 a[190:191], v19 offset:61440
    s_waitcnt vmcnt(24)
    s_barrier
    v_mfma_f32_16x16x32_bf16 v[232:235], a[168:171], a[80:83], v[232:235]
    s_waitcnt lgkmcnt(8)
    ds_read_b64_tr_b16 a[160:161], v20 offset:0
    v_mfma_f32_16x16x32_bf16 v[232:235], a[172:175], a[88:91], v[232:235]
    ds_read_b64_tr_b16 a[162:163], v20 offset:4096
    v_mfma_f32_16x16x32_bf16 v[236:239], a[168:171], a[84:87], v[236:239]
    s_add_u32 m0, s42, 0
    ds_read_b64_tr_b16 a[164:165], v20 offset:8192
    v_mfma_f32_16x16x32_bf16 v[236:239], a[172:175], a[92:95], v[236:239]
    s_waitcnt lgkmcnt(9)
    ds_read_b64_tr_b16 a[166:167], v20 offset:12288
    buffer_load_dwordx4 v36, s[8:11], s40 offen lds
    v_mfma_f32_16x16x32_bf16 v[240:243], a[176:179], a[80:83], v[240:243]
    s_waitcnt lgkmcnt(8)
    ds_read_b64_tr_b16 a[168:169], v21 offset:0
    v_mfma_f32_16x16x32_bf16 v[240:243], a[180:183], a[88:91], v[240:243]
    ds_read_b64_tr_b16 a[170:171], v21 offset:4096
    v_mfma_f32_16x16x32_bf16 v[244:247], a[176:179], a[84:87], v[244:247]
    ds_read_b64_tr_b16 a[172:173], v21 offset:8192
    v_mfma_f32_16x16x32_bf16 v[244:247], a[180:183], a[92:95], v[244:247]
    s_waitcnt lgkmcnt(9)
    ds_read_b64_tr_b16 a[174:175], v21 offset:12288
    buffer_load_dwordx4 v37, s[8:11], s40 offen offset:1024 lds
    v_mfma_f32_16x16x32_bf16 v[248:251], a[184:187], a[80:83], v[248:251]
    s_waitcnt lgkmcnt(8)
    ds_read_b64_tr_b16 a[176:177], v22 offset:0
    v_mfma_f32_16x16x32_bf16 v[248:251], a[188:191], a[88:91], v[248:251]
    ds_read_b64_tr_b16 a[178:179], v22 offset:4096
    v_mfma_f32_16x16x32_bf16 v[252:255], a[184:187], a[84:87], v[252:255]
    ds_read_b64_tr_b16 a[180:181], v22 offset:8192
    v_mfma_f32_16x16x32_bf16 v[252:255], a[188:191], a[92:95], v[252:255]
    s_waitcnt lgkmcnt(9)
    ds_read_b64_tr_b16 a[182:183], v22 offset:12288
    buffer_load_dwordx4 v38, s[8:11], s40 offen offset:2048 lds
    v_mfma_f32_16x16x32_bf16 v[128:131], a[160:163], a[96:99], v[128:131]
    s_waitcnt lgkmcnt(8)
    ds_read_b64_tr_b16 a[184:185], v23 offset:0
    v_mfma_f32_16x16x32_bf16 v[128:131], a[164:167], a[104:107], v[128:131]
    ds_read_b64_tr_b16 a[186:187], v23 offset:4096
    v_mfma_f32_16x16x32_bf16 v[132:135], a[160:163], a[100:103], v[132:135]
    ds_read_b64_tr_b16 a[188:189], v23 offset:8192
    v_mfma_f32_16x16x32_bf16 v[132:135], a[164:167], a[108:111], v[132:135]
    s_waitcnt lgkmcnt(9)
    ds_read_b64_tr_b16 a[190:191], v23 offset:12288
    buffer_load_dwordx4 v39, s[8:11], s40 offen offset:3072 lds
    v_mfma_f32_16x16x32_bf16 v[136:139], a[168:171], a[96:99], v[136:139]
    s_waitcnt lgkmcnt(8)
    s_add_u32 s40, s40, 16384
    ds_read_b64_tr_b16 a[160:161], v24 offset:0
    v_mfma_f32_16x16x32_bf16 v[136:139], a[172:175], a[104:107], v[136:139]
    ds_read_b64_tr_b16 a[162:163], v24 offset:4096
    v_mfma_f32_16x16x32_bf16 v[140:143], a[168:171], a[100:103], v[140:143]
    s_add_u32 m0, s42, 16384
    ds_read_b64_tr_b16 a[164:165], v24 offset:8192
    v_mfma_f32_16x16x32_bf16 v[140:143], a[172:175], a[108:111], v[140:143]
    s_waitcnt lgkmcnt(9)
    ds_read_b64_tr_b16 a[166:167], v24 offset:12288
    buffer_load_dwordx4 v36, s[8:11], s40 offen lds
    v_mfma_f32_16x16x32_bf16 v[144:147], a[176:179], a[96:99], v[144:147]
    s_waitcnt lgkmcnt(8)
    ds_read_b64_tr_b16 a[168:169], v25 offset:0
    v_mfma_f32_16x16x32_bf16 v[144:147], a[180:183], a[104:107], v[144:147]
    ds_read_b64_tr_b16 a[170:171], v25 offset:4096
    v_mfma_f32_16x16x32_bf16 v[148:151], a[176:179], a[100:103], v[148:151]
    ds_read_b64_tr_b16 a[172:173], v25 offset:8192
    v_mfma_f32_16x16x32_bf16 v[148:151], a[180:183], a[108:111], v[148:151]
    s_waitcnt lgkmcnt(9)
    ds_read_b64_tr_b16 a[174:175], v25 offset:12288
    buffer_load_dwordx4 v37, s[8:11], s40 offen offset:1024 lds
    v_mfma_f32_16x16x32_bf16 v[152:155], a[184:187], a[96:99], v[152:155]
    s_waitcnt lgkmcnt(8)
    ds_read_b64_tr_b16 a[176:177], v26 offset:0
    v_mfma_f32_16x16x32_bf16 v[152:155], a[188:191], a[104:107], v[152:155]
    ds_read_b64_tr_b16 a[178:179], v26 offset:4096
    v_mfma_f32_16x16x32_bf16 v[156:159], a[184:187], a[100:103], v[156:159]
    ds_read_b64_tr_b16 a[180:181], v26 offset:8192
    v_mfma_f32_16x16x32_bf16 v[156:159], a[188:191], a[108:111], v[156:159]
    s_waitcnt lgkmcnt(9)
    ds_read_b64_tr_b16 a[182:183], v26 offset:12288
    buffer_load_dwordx4 v38, s[8:11], s40 offen offset:2048 lds
    v_mfma_f32_16x16x32_bf16 v[160:163], a[160:163], a[96:99], v[160:163]
    s_waitcnt lgkmcnt(8)
    ds_read_b64_tr_b16 a[184:185], v27 offset:0
    v_mfma_f32_16x16x32_bf16 v[160:163], a[164:167], a[104:107], v[160:163]
    ds_read_b64_tr_b16 a[186:187], v27 offset:4096
    v_mfma_f32_16x16x32_bf16 v[164:167], a[160:163], a[100:103], v[164:167]
    ds_read_b64_tr_b16 a[188:189], v27 offset:8192
    v_mfma_f32_16x16x32_bf16 v[164:167], a[164:167], a[108:111], v[164:167]
    s_waitcnt lgkmcnt(9)
    ds_read_b64_tr_b16 a[190:191], v27 offset:12288
    buffer_load_dwordx4 v39, s[8:11], s40 offen offset:3072 lds
    v_mfma_f32_16x16x32_bf16 v[168:171], a[168:171], a[96:99], v[168:171]
    s_waitcnt lgkmcnt(8)
    s_add_u32 s40, s40, 16384
    ds_read_b64_tr_b16 a[160:161], v20 offset:16384
    v_mfma_f32_16x16x32_bf16 v[168:171], a[172:175], a[104:107], v[168:171]
    ds_read_b64_tr_b16 a[162:163], v20 offset:20480
    v_mfma_f32_16x16x32_bf16 v[172:175], a[168:171], a[100:103], v[172:175]
    ds_read_b64_tr_b16 a[164:165], v20 offset:24576
    v_mfma_f32_16x16x32_bf16 v[172:175], a[172:175], a[108:111], v[172:175]
    s_waitcnt lgkmcnt(9)
    ds_read_b64_tr_b16 a[166:167], v20 offset:28672
    v_mfma_f32_16x16x32_bf16 v[176:179], a[176:179], a[96:99], v[176:179]
    s_waitcnt lgkmcnt(8)
    ds_read_b64_tr_b16 a[168:169], v21 offset:16384
    v_mfma_f32_16x16x32_bf16 v[176:179], a[180:183], a[104:107], v[176:179]
    ds_read_b64_tr_b16 a[170:171], v21 offset:20480
    v_mfma_f32_16x16x32_bf16 v[180:183], a[176:179], a[100:103], v[180:183]
    ds_read_b64_tr_b16 a[172:173], v21 offset:24576
    v_mfma_f32_16x16x32_bf16 v[180:183], a[180:183], a[108:111], v[180:183]
    s_waitcnt lgkmcnt(9)
    ds_read_b64_tr_b16 a[174:175], v21 offset:28672
    v_mfma_f32_16x16x32_bf16 v[184:187], a[184:187], a[96:99], v[184:187]
    s_waitcnt lgkmcnt(8)
    ds_read_b64_tr_b16 a[176:177], v22 offset:16384
    v_mfma_f32_16x16x32_bf16 v[184:187], a[188:191], a[104:107], v[184:187]
    ds_read_b64_tr_b16 a[178:179], v22 offset:20480
    v_mfma_f32_16x16x32_bf16 v[188:191], a[184:187], a[100:103], v[188:191]
    ds_read_b64_tr_b16 a[180:181], v22 offset:24576
    v_mfma_f32_16x16x32_bf16 v[188:191], a[188:191], a[108:111], v[188:191]
    s_waitcnt lgkmcnt(9)
    ds_read_b64_tr_b16 a[182:183], v22 offset:28672
    v_mfma_f32_16x16x32_bf16 v[192:195], a[160:163], a[96:99], v[192:195]
    s_waitcnt lgkmcnt(8)
    ds_read_b64_tr_b16 a[184:185], v23 offset:16384
    v_accvgpr_write_b32 a0, 0
    v_mfma_f32_16x16x32_bf16 v[192:195], a[164:167], a[104:107], v[192:195]
    ds_read_b64_tr_b16 a[186:187], v23 offset:20480
    v_accvgpr_write_b32 a1, 0
    v_mfma_f32_16x16x32_bf16 v[196:199], a[160:163], a[100:103], v[196:199]
    ds_read_b64_tr_b16 a[188:189], v23 offset:24576
    v_accvgpr_write_b32 a2, 0
    v_mfma_f32_16x16x32_bf16 v[196:199], a[164:167], a[108:111], v[196:199]
    s_waitcnt lgkmcnt(9)
    ds_read_b64_tr_b16 a[190:191], v23 offset:28672
    v_accvgpr_write_b32 a3, 0
    v_mfma_f32_16x16x32_bf16 v[200:203], a[168:171], a[96:99], v[200:203]
    s_waitcnt lgkmcnt(8)
    ds_read_b64_tr_b16 a[160:161], v24 offset:16384
    v_accvgpr_write_b32 a4, 0
    v_mfma_f32_16x16x32_bf16 v[200:203], a[172:175], a[104:107], v[200:203]
    ds_read_b64_tr_b16 a[162:163], v24 offset:20480
    v_accvgpr_write_b32 a5, 0
    v_mfma_f32_16x16x32_bf16 v[204:207], a[168:171], a[100:103], v[204:207]
    ds_read_b64_tr_b16 a[164:165], v24 offset:24576
    v_accvgpr_write_b32 a6, 0
    v_mfma_f32_16x16x32_bf16 v[204:207], a[172:175], a[108:111], v[204:207]
    s_waitcnt lgkmcnt(9)
    ds_read_b64_tr_b16 a[166:167], v24 offset:28672
    v_accvgpr_write_b32 a7, 0
    v_mfma_f32_16x16x32_bf16 v[208:211], a[176:179], a[96:99], v[208:211]
    s_waitcnt lgkmcnt(8)
    ds_read_b64_tr_b16 a[168:169], v25 offset:16384
    v_accvgpr_write_b32 a8, 0
    v_mfma_f32_16x16x32_bf16 v[208:211], a[180:183], a[104:107], v[208:211]
    ds_read_b64_tr_b16 a[170:171], v25 offset:20480
    v_accvgpr_write_b32 a9, 0
    v_mfma_f32_16x16x32_bf16 v[212:215], a[176:179], a[100:103], v[212:215]
    ds_read_b64_tr_b16 a[172:173], v25 offset:24576
    v_accvgpr_write_b32 a10, 0
    v_mfma_f32_16x16x32_bf16 v[212:215], a[180:183], a[108:111], v[212:215]
    s_waitcnt lgkmcnt(9)
    ds_read_b64_tr_b16 a[174:175], v25 offset:28672
    v_accvgpr_write_b32 a11, 0
    v_mfma_f32_16x16x32_bf16 v[216:219], a[184:187], a[96:99], v[216:219]
    s_waitcnt lgkmcnt(8)
    ds_read_b64_tr_b16 a[176:177], v26 offset:16384
    v_accvgpr_write_b32 a12, 0
    v_mfma_f32_16x16x32_bf16 v[216:219], a[188:191], a[104:107], v[216:219]
    ds_read_b64_tr_b16 a[178:179], v26 offset:20480
    v_accvgpr_write_b32 a13, 0
    v_mfma_f32_16x16x32_bf16 v[220:223], a[184:187], a[100:103], v[220:223]
    ds_read_b64_tr_b16 a[180:181], v26 offset:24576
    v_accvgpr_write_b32 a14, 0
    v_mfma_f32_16x16x32_bf16 v[220:223], a[188:191], a[108:111], v[220:223]
    s_waitcnt lgkmcnt(9)
    ds_read_b64_tr_b16 a[182:183], v26 offset:28672
    v_accvgpr_write_b32 a15, 0
    v_mfma_f32_16x16x32_bf16 v[224:227], a[160:163], a[96:99], v[224:227]
    s_waitcnt lgkmcnt(8)
    ds_read_b64_tr_b16 a[184:185], v27 offset:16384
    v_accvgpr_write_b32 a16, 0
    v_mfma_f32_16x16x32_bf16 v[224:227], a[164:167], a[104:107], v[224:227]
    ds_read_b64_tr_b16 a[186:187], v27 offset:20480
    v_accvgpr_write_b32 a17, 0
    v_mfma_f32_16x16x32_bf16 v[228:231], a[160:163], a[100:103], v[228:231]
    ds_read_b64_tr_b16 a[188:189], v27 offset:24576
    v_accvgpr_write_b32 a18, 0
    v_mfma_f32_16x16x32_bf16 v[228:231], a[164:167], a[108:111], v[228:231]
    s_waitcnt lgkmcnt(9)
    ds_read_b64_tr_b16 a[190:191], v27 offset:28672
    v_accvgpr_write_b32 a19, 0
    s_waitcnt vmcnt(20)
    s_barrier
    v_mfma_f32_16x16x32_bf16 v[232:235], a[168:171], a[96:99], v[232:235]
    s_waitcnt lgkmcnt(8)
    ds_read_b64_tr_b16 a[160:161], v20 offset:32768
    v_accvgpr_write_b32 a20, 0
    v_mfma_f32_16x16x32_bf16 v[232:235], a[172:175], a[104:107], v[232:235]
    ds_read_b64_tr_b16 a[162:163], v20 offset:36864
    v_accvgpr_write_b32 a21, 0
    v_mfma_f32_16x16x32_bf16 v[236:239], a[168:171], a[100:103], v[236:239]
    s_add_u32 m0, s42, 32768
    ds_read_b64_tr_b16 a[164:165], v20 offset:40960
    v_accvgpr_write_b32 a22, 0
    v_mfma_f32_16x16x32_bf16 v[236:239], a[172:175], a[108:111], v[236:239]
    s_waitcnt lgkmcnt(9)
    ds_read_b64_tr_b16 a[166:167], v20 offset:45056
    buffer_load_dwordx4 v36, s[8:11], s40 offen lds
    v_mfma_f32_16x16x32_bf16 v[240:243], a[176:179], a[96:99], v[240:243]
    s_waitcnt lgkmcnt(8)
    ds_read_b64_tr_b16 a[168:169], v21 offset:32768
    v_accvgpr_write_b32 a23, 0
    v_mfma_f32_16x16x32_bf16 v[240:243], a[180:183], a[104:107], v[240:243]
    ds_read_b64_tr_b16 a[170:171], v21 offset:36864
    v_accvgpr_write_b32 a24, 0
    v_mfma_f32_16x16x32_bf16 v[244:247], a[176:179], a[100:103], v[244:247]
    ds_read_b64_tr_b16 a[172:173], v21 offset:40960
    v_accvgpr_write_b32 a25, 0
    v_mfma_f32_16x16x32_bf16 v[244:247], a[180:183], a[108:111], v[244:247]
    s_waitcnt lgkmcnt(9)
    ds_read_b64_tr_b16 a[174:175], v21 offset:45056
    buffer_load_dwordx4 v37, s[8:11], s40 offen offset:1024 lds
    v_mfma_f32_16x16x32_bf16 v[248:251], a[184:187], a[96:99], v[248:251]
    s_waitcnt lgkmcnt(8)
    ds_read_b64_tr_b16 a[176:177], v22 offset:32768
    v_accvgpr_write_b32 a26, 0
    v_mfma_f32_16x16x32_bf16 v[248:251], a[188:191], a[104:107], v[248:251]
    ds_read_b64_tr_b16 a[178:179], v22 offset:36864
    v_accvgpr_write_b32 a27, 0
    v_mfma_f32_16x16x32_bf16 v[252:255], a[184:187], a[100:103], v[252:255]
    ds_read_b64_tr_b16 a[180:181], v22 offset:40960
    v_accvgpr_write_b32 a28, 0
    v_mfma_f32_16x16x32_bf16 v[252:255], a[188:191], a[108:111], v[252:255]
    s_waitcnt lgkmcnt(9)
    ds_read_b64_tr_b16 a[182:183], v22 offset:45056
    buffer_load_dwordx4 v38, s[8:11], s40 offen offset:2048 lds
    v_mfma_f32_16x16x32_bf16 v[128:131], a[160:163], a[112:115], v[128:131]
    s_waitcnt lgkmcnt(8)
    ds_read_b64_tr_b16 a[184:185], v23 offset:32768
    v_accvgpr_write_b32 a29, 0
    v_mfma_f32_16x16x32_bf16 v[128:131], a[164:167], a[120:123], v[128:131]
    ds_read_b64_tr_b16 a[186:187], v23 offset:36864
    v_accvgpr_write_b32 a30, 0
    v_mfma_f32_16x16x32_bf16 v[132:135], a[160:163], a[116:119], v[132:135]
    ds_read_b64_tr_b16 a[188:189], v23 offset:40960
    v_accvgpr_write_b32 a31, 0
    v_mfma_f32_16x16x32_bf16 v[132:135], a[164:167], a[124:127], v[132:135]
    s_waitcnt lgkmcnt(9)
    ds_read_b64_tr_b16 a[190:191], v23 offset:45056
    buffer_load_dwordx4 v39, s[8:11], s40 offen offset:3072 lds
    v_mfma_f32_16x16x32_bf16 v[136:139], a[168:171], a[112:115], v[136:139]
    s_waitcnt lgkmcnt(8)
    s_add_u32 s40, s40, 16384
    ds_read_b64_tr_b16 a[160:161], v24 offset:32768
    v_accvgpr_write_b32 a32, 0
    v_mfma_f32_16x16x32_bf16 v[136:139], a[172:175], a[120:123], v[136:139]
    ds_read_b64_tr_b16 a[162:163], v24 offset:36864
    v_accvgpr_write_b32 a33, 0
    v_mfma_f32_16x16x32_bf16 v[140:143], a[168:171], a[116:119], v[140:143]
    ds_read_b64_tr_b16 a[164:165], v24 offset:40960
    v_accvgpr_write_b32 a34, 0
    v_mfma_f32_16x16x32_bf16 v[140:143], a[172:175], a[124:127], v[140:143]
    s_waitcnt lgkmcnt(9)
    ds_read_b64_tr_b16 a[166:167], v24 offset:45056
    v_accvgpr_write_b32 a35, 0
    v_mfma_f32_16x16x32_bf16 v[144:147], a[176:179], a[112:115], v[144:147]
    s_waitcnt lgkmcnt(8)
    ds_read_b64_tr_b16 a[168:169], v25 offset:32768
    v_accvgpr_write_b32 a36, 0
    v_mfma_f32_16x16x32_bf16 v[144:147], a[180:183], a[120:123], v[144:147]
    ds_read_b64_tr_b16 a[170:171], v25 offset:36864
    v_accvgpr_write_b32 a37, 0
    v_mfma_f32_16x16x32_bf16 v[148:151], a[176:179], a[116:119], v[148:151]
    ds_read_b64_tr_b16 a[172:173], v25 offset:40960
    v_accvgpr_write_b32 a38, 0
    v_mfma_f32_16x16x32_bf16 v[148:151], a[180:183], a[124:127], v[148:151]
    s_waitcnt lgkmcnt(9)
    ds_read_b64_tr_b16 a[174:175], v25 offset:45056
    v_accvgpr_write_b32 a39, 0
    v_mfma_f32_16x16x32_bf16 v[152:155], a[184:187], a[112:115], v[152:155]
    s_waitcnt lgkmcnt(8)
    ds_read_b64_tr_b16 a[176:177], v26 offset:32768
    v_accvgpr_write_b32 a40, 0
    v_mfma_f32_16x16x32_bf16 v[152:155], a[188:191], a[120:123], v[152:155]
    ds_read_b64_tr_b16 a[178:179], v26 offset:36864
    v_accvgpr_write_b32 a41, 0
    v_mfma_f32_16x16x32_bf16 v[156:159], a[184:187], a[116:119], v[156:159]
    ds_read_b64_tr_b16 a[180:181], v26 offset:40960
    v_accvgpr_write_b32 a42, 0
    v_mfma_f32_16x16x32_bf16 v[156:159], a[188:191], a[124:127], v[156:159]
    s_waitcnt lgkmcnt(9)
    ds_read_b64_tr_b16 a[182:183], v26 offset:45056
    v_accvgpr_write_b32 a43, 0
    v_mfma_f32_16x16x32_bf16 v[160:163], a[160:163], a[112:115], v[160:163]
    s_waitcnt lgkmcnt(8)
    ds_read_b64_tr_b16 a[184:185], v27 offset:32768
    v_accvgpr_write_b32 a44, 0
    v_mfma_f32_16x16x32_bf16 v[160:163], a[164:167], a[120:123], v[160:163]
    ds_read_b64_tr_b16 a[186:187], v27 offset:36864
    v_accvgpr_write_b32 a45, 0
    v_mfma_f32_16x16x32_bf16 v[164:167], a[160:163], a[116:119], v[164:167]
    ds_read_b64_tr_b16 a[188:189], v27 offset:40960
    v_accvgpr_write_b32 a46, 0
    v_mfma_f32_16x16x32_bf16 v[164:167], a[164:167], a[124:127], v[164:167]
    s_waitcnt lgkmcnt(9)
    ds_read_b64_tr_b16 a[190:191], v27 offset:45056
    v_accvgpr_write_b32 a47, 0
    v_mfma_f32_16x16x32_bf16 v[168:171], a[168:171], a[112:115], v[168:171]
    s_waitcnt lgkmcnt(8)
    ds_read_b64_tr_b16 a[160:161], v20 offset:49152
    v_accvgpr_write_b32 a48, 0
    v_mfma_f32_16x16x32_bf16 v[168:171], a[172:175], a[120:123], v[168:171]
    ds_read_b64_tr_b16 a[162:163], v20 offset:53248
    v_accvgpr_write_b32 a49, 0
    v_mfma_f32_16x16x32_bf16 v[172:175], a[168:171], a[116:119], v[172:175]
    ds_read_b64_tr_b16 a[164:165], v20 offset:57344
    v_accvgpr_write_b32 a50, 0
    v_mfma_f32_16x16x32_bf16 v[172:175], a[172:175], a[124:127], v[172:175]
    s_waitcnt lgkmcnt(9)
    ds_read_b64_tr_b16 a[166:167], v20 offset:61440
    v_accvgpr_write_b32 a51, 0
    v_mfma_f32_16x16x32_bf16 v[176:179], a[176:179], a[112:115], v[176:179]
    s_waitcnt lgkmcnt(8)
    ds_read_b64_tr_b16 a[168:169], v21 offset:49152
    v_accvgpr_write_b32 a52, 0
    v_mfma_f32_16x16x32_bf16 v[176:179], a[180:183], a[120:123], v[176:179]
    ds_read_b64_tr_b16 a[170:171], v21 offset:53248
    v_accvgpr_write_b32 a53, 0
    v_mfma_f32_16x16x32_bf16 v[180:183], a[176:179], a[116:119], v[180:183]
    ds_read_b64_tr_b16 a[172:173], v21 offset:57344
    v_accvgpr_write_b32 a54, 0
    v_mfma_f32_16x16x32_bf16 v[180:183], a[180:183], a[124:127], v[180:183]
    s_waitcnt lgkmcnt(9)
    ds_read_b64_tr_b16 a[174:175], v21 offset:61440
    v_accvgpr_write_b32 a55, 0
    v_mfma_f32_16x16x32_bf16 v[184:187], a[184:187], a[112:115], v[184:187]
    s_waitcnt lgkmcnt(8)
    ds_read_b64_tr_b16 a[176:177], v22 offset:49152
    v_accvgpr_write_b32 a56, 0
    v_mfma_f32_16x16x32_bf16 v[184:187], a[188:191], a[120:123], v[184:187]
    ds_read_b64_tr_b16 a[178:179], v22 offset:53248
    v_accvgpr_write_b32 a57, 0
    v_mfma_f32_16x16x32_bf16 v[188:191], a[184:187], a[116:119], v[188:191]
    ds_read_b64_tr_b16 a[180:181], v22 offset:57344
    v_accvgpr_write_b32 a58, 0
    v_mfma_f32_16x16x32_bf16 v[188:191], a[188:191], a[124:127], v[188:191]
    s_waitcnt lgkmcnt(9)
    ds_read_b64_tr_b16 a[182:183], v22 offset:61440
    v_accvgpr_write_b32 a59, 0
    v_mfma_f32_16x16x32_bf16 v[192:195], a[160:163], a[112:115], v[192:195]
    s_waitcnt lgkmcnt(8)
    ds_read_b64_tr_b16 a[184:185], v23 offset:49152
    v_accvgpr_write_b32 a60, 0
    v_mfma_f32_16x16x32_bf16 v[192:195], a[164:167], a[120:123], v[192:195]
    ds_read_b64_tr_b16 a[186:187], v23 offset:53248
    v_accvgpr_write_b32 a61, 0
    v_mfma_f32_16x16x32_bf16 v[196:199], a[160:163], a[116:119], v[196:199]
    ds_read_b64_tr_b16 a[188:189], v23 offset:57344
    v_accvgpr_write_b32 a62, 0
    v_mfma_f32_16x16x32_bf16 v[196:199], a[164:167], a[124:127], v[196:199]
    s_waitcnt lgkmcnt(9)
    ds_read_b64_tr_b16 a[190:191], v23 offset:61440
    v_accvgpr_write_b32 a63, 0
    v_mfma_f32_16x16x32_bf16 v[200:203], a[168:171], a[112:115], v[200:203]
    s_waitcnt lgkmcnt(8)
    ds_read_b64_tr_b16 a[160:161], v24 offset:49152
    v_accvgpr_write_b32 a64, 0
    v_mfma_f32_16x16x32_bf16 v[200:203], a[172:175], a[120:123], v[200:203]
    ds_read_b64_tr_b16 a[162:163], v24 offset:53248
    v_accvgpr_write_b32 a65, 0
    v_mfma_f32_16x16x32_bf16 v[204:207], a[168:171], a[116:119], v[204:207]
    ds_read_b64_tr_b16 a[164:165], v24 offset:57344
    v_accvgpr_write_b32 a66, 0
    v_mfma_f32_16x16x32_bf16 v[204:207], a[172:175], a[124:127], v[204:207]
    s_waitcnt lgkmcnt(9)
    ds_read_b64_tr_b16 a[166:167], v24 offset:61440
    v_accvgpr_write_b32 a67, 0
    v_mfma_f32_16x16x32_bf16 v[208:211], a[176:179], a[112:115], v[208:211]
    s_waitcnt lgkmcnt(8)
    ds_read_b64_tr_b16 a[168:169], v25 offset:49152
    v_accvgpr_write_b32 a68, 0
    v_mfma_f32_16x16x32_bf16 v[208:211], a[180:183], a[120:123], v[208:211]
    ds_read_b64_tr_b16 a[170:171], v25 offset:53248
    v_accvgpr_write_b32 a69, 0
    v_mfma_f32_16x16x32_bf16 v[212:215], a[176:179], a[116:119], v[212:215]
    ds_read_b64_tr_b16 a[172:173], v25 offset:57344
    v_accvgpr_write_b32 a70, 0
    v_mfma_f32_16x16x32_bf16 v[212:215], a[180:183], a[124:127], v[212:215]
    s_waitcnt lgkmcnt(9)
    ds_read_b64_tr_b16 a[174:175], v25 offset:61440
    v_accvgpr_write_b32 a71, 0
    v_mfma_f32_16x16x32_bf16 v[216:219], a[184:187], a[112:115], v[216:219]
    s_waitcnt lgkmcnt(8)
    ds_read_b64_tr_b16 a[176:177], v26 offset:49152
    v_accvgpr_write_b32 a72, 0
    v_mfma_f32_16x16x32_bf16 v[216:219], a[188:191], a[120:123], v[216:219]
    ds_read_b64_tr_b16 a[178:179], v26 offset:53248
    v_accvgpr_write_b32 a73, 0
    v_mfma_f32_16x16x32_bf16 v[220:223], a[184:187], a[116:119], v[220:223]
    ds_read_b64_tr_b16 a[180:181], v26 offset:57344
    v_accvgpr_write_b32 a74, 0
    v_mfma_f32_16x16x32_bf16 v[220:223], a[188:191], a[124:127], v[220:223]
    s_waitcnt lgkmcnt(9)
    ds_read_b64_tr_b16 a[182:183], v26 offset:61440
    v_accvgpr_write_b32 a75, 0
    v_mfma_f32_16x16x32_bf16 v[224:227], a[160:163], a[112:115], v[224:227]
    s_waitcnt lgkmcnt(8)
    ds_read_b64_tr_b16 a[184:185], v27 offset:49152
    v_accvgpr_write_b32 a76, 0
    v_mfma_f32_16x16x32_bf16 v[224:227], a[164:167], a[120:123], v[224:227]
    ds_read_b64_tr_b16 a[186:187], v27 offset:53248
    v_accvgpr_write_b32 a77, 0
    v_mfma_f32_16x16x32_bf16 v[228:231], a[160:163], a[116:119], v[228:231]
    ds_read_b64_tr_b16 a[188:189], v27 offset:57344
    v_accvgpr_write_b32 a78, 0
    v_mfma_f32_16x16x32_bf16 v[228:231], a[164:167], a[124:127], v[228:231]
    s_waitcnt lgkmcnt(9)
    ds_read_b64_tr_b16 a[190:191], v27 offset:61440
    v_accvgpr_write_b32 a79, 0
    s_waitcnt vmcnt(12)
    s_barrier
    v_mfma_f32_16x16x32_bf16 v[232:235], a[168:171], a[112:115], v[232:235]
    s_waitcnt lgkmcnt(8)
    ds_read_b64_tr_b16 a[160:161], v28 offset:0
    v_accvgpr_write_b32 a80, 0
    v_mfma_f32_16x16x32_bf16 v[232:235], a[172:175], a[120:123], v[232:235]
    ds_read_b64_tr_b16 a[162:163], v28 offset:4096
    v_accvgpr_write_b32 a81, 0
    v_mfma_f32_16x16x32_bf16 v[236:239], a[168:171], a[116:119], v[236:239]
    s_add_u32 m0, s42, 65536
    ds_read_b64_tr_b16 a[164:165], v28 offset:8192
    v_accvgpr_write_b32 a82, 0
    v_mfma_f32_16x16x32_bf16 v[236:239], a[172:175], a[124:127], v[236:239]
    s_waitcnt lgkmcnt(9)
    ds_read_b64_tr_b16 a[166:167], v28 offset:12288
    buffer_load_dwordx4 v40, s[12:15], s41 offen lds
    v_mfma_f32_16x16x32_bf16 v[240:243], a[176:179], a[112:115], v[240:243]
    s_waitcnt lgkmcnt(8)
    ds_read_b64_tr_b16 a[168:169], v29 offset:0
    v_accvgpr_write_b32 a83, 0
    v_mfma_f32_16x16x32_bf16 v[240:243], a[180:183], a[120:123], v[240:243]
    ds_read_b64_tr_b16 a[170:171], v29 offset:4096
    v_accvgpr_write_b32 a84, 0
    v_mfma_f32_16x16x32_bf16 v[244:247], a[176:179], a[116:119], v[244:247]
    ds_read_b64_tr_b16 a[172:173], v29 offset:8192
    v_accvgpr_write_b32 a85, 0
    v_mfma_f32_16x16x32_bf16 v[244:247], a[180:183], a[124:127], v[244:247]
    s_waitcnt lgkmcnt(9)
    ds_read_b64_tr_b16 a[174:175], v29 offset:12288
    buffer_load_dwordx4 v41, s[12:15], s41 offen offset:1024 lds
    v_mfma_f32_16x16x32_bf16 v[248:251], a[184:187], a[112:115], v[248:251]
    s_waitcnt lgkmcnt(8)
    ds_read_b64_tr_b16 a[176:177], v30 offset:0
    v_accvgpr_write_b32 a86, 0
    v_mfma_f32_16x16x32_bf16 v[248:251], a[188:191], a[120:123], v[248:251]
    ds_read_b64_tr_b16 a[178:179], v30 offset:4096
    v_accvgpr_write_b32 a87, 0
    v_mfma_f32_16x16x32_bf16 v[252:255], a[184:187], a[116:119], v[252:255]
    ds_read_b64_tr_b16 a[180:181], v30 offset:8192
    v_accvgpr_write_b32 a88, 0
    v_mfma_f32_16x16x32_bf16 v[252:255], a[188:191], a[124:127], v[252:255]
    s_waitcnt lgkmcnt(9)
    ds_read_b64_tr_b16 a[182:183], v30 offset:12288
    buffer_load_dwordx4 v40, s[12:15], s41 offen offset:2048 lds
    v_mfma_f32_16x16x32_bf16 v[128:131], a[160:163], a[128:131], v[128:131]
    s_waitcnt lgkmcnt(8)
    ds_read_b64_tr_b16 a[184:185], v31 offset:0
    v_accvgpr_write_b32 a89, 0
    v_mfma_f32_16x16x32_bf16 v[128:131], a[164:167], a[136:139], v[128:131]
    ds_read_b64_tr_b16 a[186:187], v31 offset:4096
    v_accvgpr_write_b32 a90, 0
    v_mfma_f32_16x16x32_bf16 v[132:135], a[160:163], a[132:135], v[132:135]
    ds_read_b64_tr_b16 a[188:189], v31 offset:8192
    v_accvgpr_write_b32 a91, 0
    v_mfma_f32_16x16x32_bf16 v[132:135], a[164:167], a[140:143], v[132:135]
    s_waitcnt lgkmcnt(9)
    ds_read_b64_tr_b16 a[190:191], v31 offset:12288
    buffer_load_dwordx4 v41, s[12:15], s41 offen offset:3072 lds
    v_mfma_f32_16x16x32_bf16 v[136:139], a[168:171], a[128:131], v[136:139]
    s_waitcnt lgkmcnt(8)
    s_add_u32 s41, s41, 16384
    ds_read_b64_tr_b16 a[160:161], v32 offset:0
    v_accvgpr_write_b32 a92, 0
    v_mfma_f32_16x16x32_bf16 v[136:139], a[172:175], a[136:139], v[136:139]
    ds_read_b64_tr_b16 a[162:163], v32 offset:4096
    v_accvgpr_write_b32 a93, 0
    v_mfma_f32_16x16x32_bf16 v[140:143], a[168:171], a[132:135], v[140:143]
    s_add_u32 m0, s42, 81920
    ds_read_b64_tr_b16 a[164:165], v32 offset:8192
    v_accvgpr_write_b32 a94, 0
    v_mfma_f32_16x16x32_bf16 v[140:143], a[172:175], a[140:143], v[140:143]
    s_waitcnt lgkmcnt(9)
    ds_read_b64_tr_b16 a[166:167], v32 offset:12288
    buffer_load_dwordx4 v40, s[12:15], s41 offen lds
    v_mfma_f32_16x16x32_bf16 v[144:147], a[176:179], a[128:131], v[144:147]
    s_waitcnt lgkmcnt(8)
    ds_read_b64_tr_b16 a[168:169], v33 offset:0
    v_accvgpr_write_b32 a95, 0
    v_mfma_f32_16x16x32_bf16 v[144:147], a[180:183], a[136:139], v[144:147]
    ds_read_b64_tr_b16 a[170:171], v33 offset:4096
    v_accvgpr_write_b32 a96, 0
    v_mfma_f32_16x16x32_bf16 v[148:151], a[176:179], a[132:135], v[148:151]
    ds_read_b64_tr_b16 a[172:173], v33 offset:8192
    v_accvgpr_write_b32 a97, 0
    v_mfma_f32_16x16x32_bf16 v[148:151], a[180:183], a[140:143], v[148:151]
    s_waitcnt lgkmcnt(9)
    ds_read_b64_tr_b16 a[174:175], v33 offset:12288
    buffer_load_dwordx4 v41, s[12:15], s41 offen offset:1024 lds
    v_mfma_f32_16x16x32_bf16 v[152:155], a[184:187], a[128:131], v[152:155]
    s_waitcnt lgkmcnt(8)
    ds_read_b64_tr_b16 a[176:177], v34 offset:0
    v_accvgpr_write_b32 a98, 0
    v_mfma_f32_16x16x32_bf16 v[152:155], a[188:191], a[136:139], v[152:155]
    ds_read_b64_tr_b16 a[178:179], v34 offset:4096
    v_accvgpr_write_b32 a99, 0
    v_mfma_f32_16x16x32_bf16 v[156:159], a[184:187], a[132:135], v[156:159]
    ds_read_b64_tr_b16 a[180:181], v34 offset:8192
    v_accvgpr_write_b32 a100, 0
    v_mfma_f32_16x16x32_bf16 v[156:159], a[188:191], a[140:143], v[156:159]
    s_waitcnt lgkmcnt(9)
    ds_read_b64_tr_b16 a[182:183], v34 offset:12288
    buffer_load_dwordx4 v40, s[12:15], s41 offen offset:2048 lds
    v_mfma_f32_16x16x32_bf16 v[160:163], a[160:163], a[128:131], v[160:163]
    s_waitcnt lgkmcnt(8)
    ds_read_b64_tr_b16 a[184:185], v35 offset:0
    v_accvgpr_write_b32 a101, 0
    v_mfma_f32_16x16x32_bf16 v[160:163], a[164:167], a[136:139], v[160:163]
    ds_read_b64_tr_b16 a[186:187], v35 offset:4096
    v_accvgpr_write_b32 a102, 0
    v_mfma_f32_16x16x32_bf16 v[164:167], a[160:163], a[132:135], v[164:167]
    ds_read_b64_tr_b16 a[188:189], v35 offset:8192
    v_accvgpr_write_b32 a103, 0
    v_mfma_f32_16x16x32_bf16 v[164:167], a[164:167], a[140:143], v[164:167]
    s_waitcnt lgkmcnt(9)
    ds_read_b64_tr_b16 a[190:191], v35 offset:12288
    buffer_load_dwordx4 v41, s[12:15], s41 offen offset:3072 lds
    v_mfma_f32_16x16x32_bf16 v[168:171], a[168:171], a[128:131], v[168:171]
    s_waitcnt lgkmcnt(8)
    s_add_u32 s41, s41, 16384
    ds_read_b64_tr_b16 a[160:161], v28 offset:16384
    v_accvgpr_write_b32 a104, 0
    v_mfma_f32_16x16x32_bf16 v[168:171], a[172:175], a[136:139], v[168:171]
    ds_read_b64_tr_b16 a[162:163], v28 offset:20480
    v_accvgpr_write_b32 a105, 0
    v_mfma_f32_16x16x32_bf16 v[172:175], a[168:171], a[132:135], v[172:175]
    ds_read_b64_tr_b16 a[164:165], v28 offset:24576
    v_accvgpr_write_b32 a106, 0
    v_mfma_f32_16x16x32_bf16 v[172:175], a[172:175], a[140:143], v[172:175]
    s_waitcnt lgkmcnt(9)
    ds_read_b64_tr_b16 a[166:167], v28 offset:28672
    v_accvgpr_write_b32 a107, 0
    v_mfma_f32_16x16x32_bf16 v[176:179], a[176:179], a[128:131], v[176:179]
    s_waitcnt lgkmcnt(8)
    ds_read_b64_tr_b16 a[168:169], v29 offset:16384
    v_accvgpr_write_b32 a108, 0
    v_mfma_f32_16x16x32_bf16 v[176:179], a[180:183], a[136:139], v[176:179]
    ds_read_b64_tr_b16 a[170:171], v29 offset:20480
    v_accvgpr_write_b32 a109, 0
    v_mfma_f32_16x16x32_bf16 v[180:183], a[176:179], a[132:135], v[180:183]
    ds_read_b64_tr_b16 a[172:173], v29 offset:24576
    v_accvgpr_write_b32 a110, 0
    v_mfma_f32_16x16x32_bf16 v[180:183], a[180:183], a[140:143], v[180:183]
    s_waitcnt lgkmcnt(9)
    ds_read_b64_tr_b16 a[174:175], v29 offset:28672
    v_accvgpr_write_b32 a111, 0
    v_mfma_f32_16x16x32_bf16 v[184:187], a[184:187], a[128:131], v[184:187]
    s_waitcnt lgkmcnt(8)
    ds_read_b64_tr_b16 a[176:177], v30 offset:16384
    v_accvgpr_write_b32 a192, 0
    v_mfma_f32_16x16x32_bf16 v[184:187], a[188:191], a[136:139], v[184:187]
    ds_read_b64_tr_b16 a[178:179], v30 offset:20480
    v_accvgpr_write_b32 a193, 0
    v_mfma_f32_16x16x32_bf16 v[188:191], a[184:187], a[132:135], v[188:191]
    ds_read_b64_tr_b16 a[180:181], v30 offset:24576
    v_accvgpr_write_b32 a194, 0
    v_mfma_f32_16x16x32_bf16 v[188:191], a[188:191], a[140:143], v[188:191]
    s_waitcnt lgkmcnt(9)
    ds_read_b64_tr_b16 a[182:183], v30 offset:28672
    v_accvgpr_write_b32 a195, 0
    v_mfma_f32_16x16x32_bf16 v[192:195], a[160:163], a[128:131], v[192:195]
    s_waitcnt lgkmcnt(8)
    ds_read_b64_tr_b16 a[184:185], v31 offset:16384
    v_accvgpr_write_b32 a196, 0
    v_mfma_f32_16x16x32_bf16 v[192:195], a[164:167], a[136:139], v[192:195]
    ds_read_b64_tr_b16 a[186:187], v31 offset:20480
    v_accvgpr_write_b32 a197, 0
    v_mfma_f32_16x16x32_bf16 v[196:199], a[160:163], a[132:135], v[196:199]
    ds_read_b64_tr_b16 a[188:189], v31 offset:24576
    v_accvgpr_write_b32 a198, 0
    v_mfma_f32_16x16x32_bf16 v[196:199], a[164:167], a[140:143], v[196:199]
    s_waitcnt lgkmcnt(9)
    ds_read_b64_tr_b16 a[190:191], v31 offset:28672
    v_accvgpr_write_b32 a199, 0
    v_mfma_f32_16x16x32_bf16 v[200:203], a[168:171], a[128:131], v[200:203]
    s_waitcnt lgkmcnt(8)
    ds_read_b64_tr_b16 a[160:161], v32 offset:16384
    v_accvgpr_write_b32 a200, 0
    v_mfma_f32_16x16x32_bf16 v[200:203], a[172:175], a[136:139], v[200:203]
    ds_read_b64_tr_b16 a[162:163], v32 offset:20480
    v_accvgpr_write_b32 a201, 0
    v_mfma_f32_16x16x32_bf16 v[204:207], a[168:171], a[132:135], v[204:207]
    ds_read_b64_tr_b16 a[164:165], v32 offset:24576
    v_accvgpr_write_b32 a202, 0
    v_mfma_f32_16x16x32_bf16 v[204:207], a[172:175], a[140:143], v[204:207]
    s_waitcnt lgkmcnt(9)
    ds_read_b64_tr_b16 a[166:167], v32 offset:28672
    v_accvgpr_write_b32 a203, 0
    v_mfma_f32_16x16x32_bf16 v[208:211], a[176:179], a[128:131], v[208:211]
    s_waitcnt lgkmcnt(8)
    ds_read_b64_tr_b16 a[168:169], v33 offset:16384
    v_accvgpr_write_b32 a204, 0
    v_mfma_f32_16x16x32_bf16 v[208:211], a[180:183], a[136:139], v[208:211]
    ds_read_b64_tr_b16 a[170:171], v33 offset:20480
    v_accvgpr_write_b32 a205, 0
    v_mfma_f32_16x16x32_bf16 v[212:215], a[176:179], a[132:135], v[212:215]
    ds_read_b64_tr_b16 a[172:173], v33 offset:24576
    v_accvgpr_write_b32 a206, 0
    v_mfma_f32_16x16x32_bf16 v[212:215], a[180:183], a[140:143], v[212:215]
    s_waitcnt lgkmcnt(9)
    ds_read_b64_tr_b16 a[174:175], v33 offset:28672
    v_accvgpr_write_b32 a207, 0
    v_mfma_f32_16x16x32_bf16 v[216:219], a[184:187], a[128:131], v[216:219]
    s_waitcnt lgkmcnt(8)
    ds_read_b64_tr_b16 a[176:177], v34 offset:16384
    v_accvgpr_write_b32 a112, 0
    v_mfma_f32_16x16x32_bf16 v[216:219], a[188:191], a[136:139], v[216:219]
    ds_read_b64_tr_b16 a[178:179], v34 offset:20480
    v_accvgpr_write_b32 a113, 0
    v_mfma_f32_16x16x32_bf16 v[220:223], a[184:187], a[132:135], v[220:223]
    ds_read_b64_tr_b16 a[180:181], v34 offset:24576
    v_accvgpr_write_b32 a114, 0
    v_mfma_f32_16x16x32_bf16 v[220:223], a[188:191], a[140:143], v[220:223]
    s_waitcnt lgkmcnt(9)
    ds_read_b64_tr_b16 a[182:183], v34 offset:28672
    v_accvgpr_write_b32 a115, 0
    v_mfma_f32_16x16x32_bf16 v[224:227], a[160:163], a[128:131], v[224:227]
    s_waitcnt lgkmcnt(8)
    ds_read_b64_tr_b16 a[184:185], v35 offset:16384
    v_accvgpr_write_b32 a116, 0
    v_mfma_f32_16x16x32_bf16 v[224:227], a[164:167], a[136:139], v[224:227]
    ds_read_b64_tr_b16 a[186:187], v35 offset:20480
    v_accvgpr_write_b32 a117, 0
    v_mfma_f32_16x16x32_bf16 v[228:231], a[160:163], a[132:135], v[228:231]
    ds_read_b64_tr_b16 a[188:189], v35 offset:24576
    v_accvgpr_write_b32 a118, 0
    v_mfma_f32_16x16x32_bf16 v[228:231], a[164:167], a[140:143], v[228:231]
    s_waitcnt lgkmcnt(9)
    ds_read_b64_tr_b16 a[190:191], v35 offset:28672
    v_accvgpr_write_b32 a119, 0
    v_mfma_f32_16x16x32_bf16 v[232:235], a[168:171], a[128:131], v[232:235]
    s_waitcnt lgkmcnt(8)
    v_accvgpr_write_b32 a120, 0
    v_mfma_f32_16x16x32_bf16 v[232:235], a[172:175], a[136:139], v[232:235]
    v_accvgpr_write_b32 a121, 0
    v_mfma_f32_16x16x32_bf16 v[236:239], a[168:171], a[132:135], v[236:239]
    v_accvgpr_write_b32 a122, 0
    v_mfma_f32_16x16x32_bf16 v[236:239], a[172:175], a[140:143], v[236:239]
    s_waitcnt lgkmcnt(6)
    v_accvgpr_write_b32 a123, 0
    s_waitcnt vmcnt(16)
    s_barrier
    v_mfma_f32_16x16x32_bf16 v[240:243], a[176:179], a[128:131], v[240:243]
    s_waitcnt lgkmcnt(4)
    ds_read_b128 a[208:211], v8 offset:0
    v_accvgpr_write_b32 a124, 0
    v_mfma_f32_16x16x32_bf16 v[240:243], a[180:183], a[136:139], v[240:243]
    ds_read_b128 a[212:215], v9 offset:0
    v_accvgpr_write_b32 a125, 0
    v_mfma_f32_16x16x32_bf16 v[244:247], a[176:179], a[132:135], v[244:247]
    ds_read_b128 a[216:219], v10 offset:0
    v_accvgpr_write_b32 a126, 0
    v_mfma_f32_16x16x32_bf16 v[244:247], a[180:183], a[140:143], v[244:247]
    s_waitcnt lgkmcnt(5)
    ds_read_b128 a[220:223], v11 offset:0
    v_accvgpr_write_b32 a127, 0
    v_mfma_f32_16x16x32_bf16 v[248:251], a[184:187], a[128:131], v[248:251]
    s_waitcnt lgkmcnt(4)
    ds_read_b128 a[224:227], v8 offset:4096
    v_mfma_f32_16x16x32_bf16 v[248:251], a[188:191], a[136:139], v[248:251]
    v_mfma_f32_16x16x32_bf16 v[252:255], a[184:187], a[132:135], v[252:255]
    v_mfma_f32_16x16x32_bf16 v[252:255], a[188:191], a[140:143], v[252:255]
    s_waitcnt lgkmcnt(4)
    s_mov_b32 s36, 1040356334
    s_mov_b32 s37, 1040356334
    v_pk_mul_f32 v[128:129], v[128:129], s[36:37]
    v_pk_mul_f32 v[130:131], v[130:131], s[36:37]
    v_pk_mul_f32 v[136:137], v[136:137], s[36:37]
    v_pk_mul_f32 v[138:139], v[138:139], s[36:37]
    v_cvt_pk_bf16_f32 v64, v128, v129
    v_cvt_pk_bf16_f32 v65, v130, v131
    v_cvt_pk_bf16_f32 v66, v136, v137
    v_cvt_pk_bf16_f32 v67, v138, v139
    v_pk_mul_f32 v[132:133], v[132:133], s[36:37]
    v_pk_mul_f32 v[134:135], v[134:135], s[36:37]
    v_pk_mul_f32 v[140:141], v[140:141], s[36:37]
    v_pk_mul_f32 v[142:143], v[142:143], s[36:37]
    v_cvt_pk_bf16_f32 v80, v132, v133
    v_cvt_pk_bf16_f32 v81, v134, v135
    v_cvt_pk_bf16_f32 v82, v140, v141
    v_cvt_pk_bf16_f32 v83, v142, v143
    v_permlane32_swap_b32 v64, v66
    v_permlane32_swap_b32 v65, v67
    v_permlane32_swap_b32 v80, v82
    v_permlane32_swap_b32 v81, v83
    v_permlane16_swap_b32 v64, v66
    v_permlane16_swap_b32 v65, v67
    v_permlane16_swap_b32 v80, v82
    v_permlane16_swap_b32 v81, v83
    v_pk_mul_f32 v[144:145], v[144:145], s[36:37]
    v_pk_mul_f32 v[146:147], v[146:147], s[36:37]
    v_pk_mul_f32 v[152:153], v[152:153], s[36:37]
    v_pk_mul_f32 v[154:155], v[154:155], s[36:37]
    v_cvt_pk_bf16_f32 v68, v144, v145
    v_cvt_pk_bf16_f32 v69, v146, v147
    v_cvt_pk_bf16_f32 v70, v152, v153
    v_cvt_pk_bf16_f32 v71, v154, v155
    v_pk_mul_f32 v[148:149], v[148:149], s[36:37]
    v_pk_mul_f32 v[150:151], v[150:151], s[36:37]
    v_pk_mul_f32 v[156:157], v[156:157], s[36:37]
    v_pk_mul_f32 v[158:159], v[158:159], s[36:37]
    v_cvt_pk_bf16_f32 v84, v148, v149
    v_cvt_pk_bf16_f32 v85, v150, v151
    v_cvt_pk_bf16_f32 v86, v156, v157
    v_cvt_pk_bf16_f32 v87, v158, v159
    v_permlane32_swap_b32 v68, v70
    v_permlane32_swap_b32 v69, v71
    v_permlane32_swap_b32 v84, v86
    v_permlane32_swap_b32 v85, v87
    v_permlane16_swap_b32 v68, v70
    v_permlane16_swap_b32 v69, v71
    v_permlane16_swap_b32 v84, v86
    v_permlane16_swap_b32 v85, v87
    v_pk_mul_f32 v[160:161], v[160:161], s[36:37]
    v_pk_mul_f32 v[162:163], v[162:163], s[36:37]
    v_pk_mul_f32 v[168:169], v[168:169], s[36:37]
    v_pk_mul_f32 v[170:171], v[170:171], s[36:37]
    v_cvt_pk_bf16_f32 v72, v160, v161
    v_cvt_pk_bf16_f32 v73, v162, v163
    v_cvt_pk_bf16_f32 v74, v168, v169
    v_cvt_pk_bf16_f32 v75, v170, v171
    v_pk_mul_f32 v[164:165], v[164:165], s[36:37]
    v_pk_mul_f32 v[166:167], v[166:167], s[36:37]
    v_pk_mul_f32 v[172:173], v[172:173], s[36:37]
    v_pk_mul_f32 v[174:175], v[174:175], s[36:37]
    v_cvt_pk_bf16_f32 v88, v164, v165
    v_cvt_pk_bf16_f32 v89, v166, v167
    v_cvt_pk_bf16_f32 v90, v172, v173
    v_cvt_pk_bf16_f32 v91, v174, v175
    v_permlane32_swap_b32 v72, v74
    v_permlane32_swap_b32 v73, v75
    v_permlane32_swap_b32 v88, v90
    v_permlane32_swap_b32 v89, v91
    v_permlane16_swap_b32 v72, v74
    v_permlane16_swap_b32 v73, v75
    v_permlane16_swap_b32 v88, v90
    v_permlane16_swap_b32 v89, v91
    v_pk_mul_f32 v[176:177], v[176:177], s[36:37]
    v_pk_mul_f32 v[178:179], v[178:179], s[36:37]
    v_pk_mul_f32 v[184:185], v[184:185], s[36:37]
    v_pk_mul_f32 v[186:187], v[186:187], s[36:37]
    v_cvt_pk_bf16_f32 v76, v176, v177
    v_cvt_pk_bf16_f32 v77, v178, v179
    v_cvt_pk_bf16_f32 v78, v184, v185
    v_cvt_pk_bf16_f32 v79, v186, v187
    v_pk_mul_f32 v[180:181], v[180:181], s[36:37]
    v_pk_mul_f32 v[182:183], v[182:183], s[36:37]
    v_pk_mul_f32 v[188:189], v[188:189], s[36:37]
    v_pk_mul_f32 v[190:191], v[190:191], s[36:37]
    v_cvt_pk_bf16_f32 v92, v180, v181
    v_cvt_pk_bf16_f32 v93, v182, v183
    v_cvt_pk_bf16_f32 v94, v188, v189
    v_cvt_pk_bf16_f32 v95, v190, v191
    v_permlane32_swap_b32 v76, v78
    v_permlane32_swap_b32 v77, v79
    v_permlane32_swap_b32 v92, v94
    v_permlane32_swap_b32 v93, v95
    v_permlane16_swap_b32 v76, v78
    v_permlane16_swap_b32 v77, v79
    v_permlane16_swap_b32 v92, v94
    v_permlane16_swap_b32 v93, v95
    v_pk_mul_f32 v[192:193], v[192:193], s[36:37]
    v_pk_mul_f32 v[194:195], v[194:195], s[36:37]
    v_pk_mul_f32 v[200:201], v[200:201], s[36:37]
    v_pk_mul_f32 v[202:203], v[202:203], s[36:37]
    v_cvt_pk_bf16_f32 v96, v192, v193
    v_cvt_pk_bf16_f32 v97, v194, v195
    v_cvt_pk_bf16_f32 v98, v200, v201
    v_cvt_pk_bf16_f32 v99, v202, v203
    v_pk_mul_f32 v[196:197], v[196:197], s[36:37]
    v_pk_mul_f32 v[198:199], v[198:199], s[36:37]
    v_pk_mul_f32 v[204:205], v[204:205], s[36:37]
    v_pk_mul_f32 v[206:207], v[206:207], s[36:37]
    v_cvt_pk_bf16_f32 v112, v196, v197
    v_cvt_pk_bf16_f32 v113, v198, v199
    v_cvt_pk_bf16_f32 v114, v204, v205
    v_cvt_pk_bf16_f32 v115, v206, v207
    v_permlane32_swap_b32 v96, v98
    v_permlane32_swap_b32 v97, v99
    v_permlane32_swap_b32 v112, v114
    v_permlane32_swap_b32 v113, v115
    v_permlane16_swap_b32 v96, v98
    v_permlane16_swap_b32 v97, v99
    v_permlane16_swap_b32 v112, v114
    v_permlane16_swap_b32 v113, v115
    v_pk_mul_f32 v[208:209], v[208:209], s[36:37]
    v_pk_mul_f32 v[210:211], v[210:211], s[36:37]
    v_pk_mul_f32 v[216:217], v[216:217], s[36:37]
    v_pk_mul_f32 v[218:219], v[218:219], s[36:37]
    v_cvt_pk_bf16_f32 v100, v208, v209
    v_cvt_pk_bf16_f32 v101, v210, v211
    v_cvt_pk_bf16_f32 v102, v216, v217
    v_cvt_pk_bf16_f32 v103, v218, v219
    v_pk_mul_f32 v[212:213], v[212:213], s[36:37]
    v_pk_mul_f32 v[214:215], v[214:215], s[36:37]
    v_pk_mul_f32 v[220:221], v[220:221], s[36:37]
    v_pk_mul_f32 v[222:223], v[222:223], s[36:37]
    v_cvt_pk_bf16_f32 v116, v212, v213
    v_cvt_pk_bf16_f32 v117, v214, v215
    v_cvt_pk_bf16_f32 v118, v220, v221
    v_cvt_pk_bf16_f32 v119, v222, v223
    v_permlane32_swap_b32 v100, v102
    v_permlane32_swap_b32 v101, v103
    v_permlane32_swap_b32 v116, v118
    v_permlane32_swap_b32 v117, v119
    v_permlane16_swap_b32 v100, v102
    v_permlane16_swap_b32 v101, v103
    v_permlane16_swap_b32 v116, v118
    v_permlane16_swap_b32 v117, v119
    v_pk_mul_f32 v[224:225], v[224:225], s[36:37]
    v_pk_mul_f32 v[226:227], v[226:227], s[36:37]
    v_pk_mul_f32 v[232:233], v[232:233], s[36:37]
    v_pk_mul_f32 v[234:235], v[234:235], s[36:37]
    v_cvt_pk_bf16_f32 v104, v224, v225
    v_cvt_pk_bf16_f32 v105, v226, v227
    v_cvt_pk_bf16_f32 v106, v232, v233
    v_cvt_pk_bf16_f32 v107, v234, v235
    v_pk_mul_f32 v[228:229], v[228:229], s[36:37]
    v_pk_mul_f32 v[230:231], v[230:231], s[36:37]
    v_pk_mul_f32 v[236:237], v[236:237], s[36:37]
    v_pk_mul_f32 v[238:239], v[238:239], s[36:37]
    v_cvt_pk_bf16_f32 v120, v228, v229
    v_cvt_pk_bf16_f32 v121, v230, v231
    v_cvt_pk_bf16_f32 v122, v236, v237
    v_cvt_pk_bf16_f32 v123, v238, v239
    v_permlane32_swap_b32 v104, v106
    v_permlane32_swap_b32 v105, v107
    v_permlane32_swap_b32 v120, v122
    v_permlane32_swap_b32 v121, v123
    v_permlane16_swap_b32 v104, v106
    v_permlane16_swap_b32 v105, v107
    v_permlane16_swap_b32 v120, v122
    v_permlane16_swap_b32 v121, v123
    v_pk_mul_f32 v[240:241], v[240:241], s[36:37]
    v_pk_mul_f32 v[242:243], v[242:243], s[36:37]
    v_pk_mul_f32 v[248:249], v[248:249], s[36:37]
    v_pk_mul_f32 v[250:251], v[250:251], s[36:37]
    v_cvt_pk_bf16_f32 v108, v240, v241
    v_cvt_pk_bf16_f32 v109, v242, v243
    v_cvt_pk_bf16_f32 v110, v248, v249
    v_cvt_pk_bf16_f32 v111, v250, v251
    v_pk_mul_f32 v[244:245], v[244:245], s[36:37]
    v_pk_mul_f32 v[246:247], v[246:247], s[36:37]
    v_pk_mul_f32 v[252:253], v[252:253], s[36:37]
    v_pk_mul_f32 v[254:255], v[254:255], s[36:37]
    v_cvt_pk_bf16_f32 v124, v244, v245
    v_cvt_pk_bf16_f32 v125, v246, v247
    v_cvt_pk_bf16_f32 v126, v252, v253
    v_cvt_pk_bf16_f32 v127, v254, v255
    v_permlane32_swap_b32 v108, v110
    v_permlane32_swap_b32 v109, v111
    v_permlane32_swap_b32 v124, v126
    v_permlane32_swap_b32 v125, v127
    v_permlane16_swap_b32 v108, v110
    v_permlane16_swap_b32 v109, v111
    v_permlane16_swap_b32 v124, v126
    v_permlane16_swap_b32 v125, v127
    v_mfma_f32_16x16x32_bf16 v[216:219], a[208:211], v[64:67], 0
    s_waitcnt lgkmcnt(3)
    v_mfma_f32_16x16x32_bf16 v[216:219], a[212:215], v[68:71], v[216:219]
    s_waitcnt lgkmcnt(2)
    v_mfma_f32_16x16x32_bf16 v[216:219], a[216:219], v[72:75], v[216:219]
    s_waitcnt lgkmcnt(1)
    v_mfma_f32_16x16x32_bf16 v[216:219], a[220:223], v[76:79], v[216:219]
    v_mfma_f32_16x16x32_bf16 v[220:223], a[208:211], v[80:83], 0
    v_mfma_f32_16x16x32_bf16 v[220:223], a[212:215], v[84:87], v[220:223]
    v_mfma_f32_16x16x32_bf16 v[220:223], a[216:219], v[88:91], v[220:223]
    v_mfma_f32_16x16x32_bf16 v[220:223], a[220:223], v[92:95], v[220:223]
    v_mfma_f32_16x16x32_bf16 v[224:227], a[208:211], v[96:99], 0
    v_mfma_f32_16x16x32_bf16 v[224:227], a[212:215], v[100:103], v[224:227]
    v_mfma_f32_16x16x32_bf16 v[224:227], a[216:219], v[104:107], v[224:227]
    v_mfma_f32_16x16x32_bf16 v[224:227], a[220:223], v[108:111], v[224:227]
    v_mfma_f32_16x16x32_bf16 v[228:231], a[208:211], v[112:115], 0
    v_mfma_f32_16x16x32_bf16 v[228:231], a[212:215], v[116:119], v[228:231]
    v_mfma_f32_16x16x32_bf16 v[228:231], a[216:219], v[120:123], v[228:231]
    v_mfma_f32_16x16x32_bf16 v[228:231], a[220:223], v[124:127], v[228:231]
    v_max3_f32 v232, v216, v217, v218
    v_max_f32 v232, v232, v219
    v_max3_f32 v233, v220, v221, v222
    v_max_f32 v233, v233, v223
    v_max3_f32 v234, v224, v225, v226
    v_max_f32 v234, v234, v227
    s_nop 1
    v_max3_f32 v235, v228, v229, v230
    v_max_f32 v235, v235, v231
    v_mov_b32 v236, v232
    v_mov_b32 v237, v233
    v_mov_b32 v238, v234
    v_mov_b32 v239, v235
    v_permlane16_swap_b32 v232, v236
    v_permlane16_swap_b32 v233, v237
    v_permlane16_swap_b32 v234, v238
    v_permlane16_swap_b32 v235, v239
    v_max_f32 v232, v232, v236
    v_max_f32 v233, v233, v237
    v_max_f32 v234, v234, v238
    v_max_f32 v235, v235, v239
    v_mov_b32 v236, v232
    v_mov_b32 v237, v233
    v_mov_b32 v238, v234
    v_mov_b32 v239, v235
    v_permlane32_swap_b32 v232, v236
    v_permlane32_swap_b32 v233, v237
    v_permlane32_swap_b32 v234, v238
    v_permlane32_swap_b32 v235, v239
    v_max_f32 v232, v232, v236
    v_max_f32 v233, v233, v237
    v_max_f32 v234, v234, v238
    v_max_f32 v235, v235, v239
    v_sub_f32 v192, 0, v232
    v_sub_f32 v193, 0, v232
    v_sub_f32 v194, 0, v232
    v_sub_f32 v195, 0, v232
    v_sub_f32 v196, 0, v233
    v_sub_f32 v197, 0, v233
    v_sub_f32 v198, 0, v233
    v_sub_f32 v199, 0, v233
    v_sub_f32 v200, 0, v234
    v_sub_f32 v201, 0, v234
    v_sub_f32 v202, 0, v234
    v_sub_f32 v203, 0, v234
    v_sub_f32 v204, 0, v235
    v_sub_f32 v205, 0, v235
    v_sub_f32 v206, 0, v235
    v_sub_f32 v207, 0, v235
Lattn_stage0:
    s_mov_b32 s43, 7
    v_mfma_f32_16x16x32_bf16 v[208:211], a[208:211], v[64:67], v[192:195]
    v_mfma_f32_16x16x32_bf16 v[208:211], a[212:215], v[68:71], v[208:211]
    v_mfma_f32_16x16x32_bf16 v[208:211], a[216:219], v[72:75], v[208:211]
    v_mfma_f32_16x16x32_bf16 v[208:211], a[220:223], v[76:79], v[208:211]
    ds_read_b128 a[228:231], v9 offset:4096
    v_mfma_f32_16x16x32_bf16 v[212:215], a[208:211], v[80:83], v[196:199]
    s_nop 5
    v_exp_f32 v208, v208
    v_mfma_f32_16x16x32_bf16 v[212:215], a[212:215], v[84:87], v[212:215]
    v_exp_f32 v209, v209
    v_mfma_f32_16x16x32_bf16 v[212:215], a[216:219], v[88:91], v[212:215]
    v_exp_f32 v210, v210
    v_mfma_f32_16x16x32_bf16 v[212:215], a[220:223], v[92:95], v[212:215]
    v_exp_f32 v211, v211
    v_cvt_pk_bf16_f32 v128, v208, v209
    ds_read_b128 a[232:235], v10 offset:4096
    v_cvt_pk_bf16_f32 v129, v210, v211
    v_mfma_f32_16x16x32_bf16 v[208:211], a[208:211], v[96:99], v[200:203]
    s_nop 2
    v_exp_f32 v212, v212
    v_mfma_f32_16x16x32_bf16 v[208:211], a[212:215], v[100:103], v[208:211]
    v_exp_f32 v213, v213
    v_mfma_f32_16x16x32_bf16 v[208:211], a[216:219], v[104:107], v[208:211]
    v_exp_f32 v214, v214
    v_mfma_f32_16x16x32_bf16 v[208:211], a[220:223], v[108:111], v[208:211]
    v_exp_f32 v215, v215
    v_cvt_pk_bf16_f32 v136, v212, v213
    ds_read_b128 a[236:239], v11 offset:4096
    v_cvt_pk_bf16_f32 v137, v214, v215
    v_mfma_f32_16x16x32_bf16 v[212:215], a[208:211], v[112:115], v[204:207]
    s_nop 2
    v_exp_f32 v208, v208
    v_mfma_f32_16x16x32_bf16 v[212:215], a[212:215], v[116:119], v[212:215]
    v_exp_f32 v209, v209
    v_mfma_f32_16x16x32_bf16 v[212:215], a[216:219], v[120:123], v[212:215]
    v_exp_f32 v210, v210
    v_mfma_f32_16x16x32_bf16 v[212:215], a[220:223], v[124:127], v[212:215]
    s_waitcnt lgkmcnt(3)
    v_exp_f32 v211, v211
    v_cvt_pk_bf16_f32 v144, v208, v209
    ds_read_b128 a[208:211], v8 offset:8192
    v_cvt_pk_bf16_f32 v145, v210, v211
    v_mfma_f32_16x16x32_bf16 v[208:211], a[224:227], v[64:67], v[192:195]
    s_waitcnt lgkmcnt(3)
    s_nop 0
    v_exp_f32 v212, v212
    v_mfma_f32_16x16x32_bf16 v[208:211], a[228:231], v[68:71], v[208:211]
    s_waitcnt lgkmcnt(2)
    v_exp_f32 v213, v213
    v_mfma_f32_16x16x32_bf16 v[208:211], a[232:235], v[72:75], v[208:211]
    s_waitcnt lgkmcnt(1)
    v_exp_f32 v214, v214
    v_mfma_f32_16x16x32_bf16 v[208:211], a[236:239], v[76:79], v[208:211]
    v_exp_f32 v215, v215
    v_cvt_pk_bf16_f32 v152, v212, v213
    ds_read_b128 a[212:215], v9 offset:8192
    v_cvt_pk_bf16_f32 v153, v214, v215
    v_mfma_f32_16x16x32_bf16 v[212:215], a[224:227], v[80:83], v[196:199]
    s_nop 2
    v_exp_f32 v208, v208
    v_mfma_f32_16x16x32_bf16 v[212:215], a[228:231], v[84:87], v[212:215]
    v_exp_f32 v209, v209
    v_mfma_f32_16x16x32_bf16 v[212:215], a[232:235], v[88:91], v[212:215]
    v_exp_f32 v210, v210
    v_mfma_f32_16x16x32_bf16 v[212:215], a[236:239], v[92:95], v[212:215]
    v_exp_f32 v211, v211
    v_cvt_pk_bf16_f32 v130, v208, v209
    ds_read_b128 a[216:219], v10 offset:8192
    v_cvt_pk_bf16_f32 v131, v210, v211
    v_mfma_f32_16x16x32_bf16 v[208:211], a[224:227], v[96:99], v[200:203]
    s_nop 2
    v_exp_f32 v212, v212
    v_mfma_f32_16x16x32_bf16 v[208:211], a[228:231], v[100:103], v[208:211]
    v_exp_f32 v213, v213
    v_mfma_f32_16x16x32_bf16 v[208:211], a[232:235], v[104:107], v[208:211]
    v_exp_f32 v214, v214
    v_mfma_f32_16x16x32_bf16 v[208:211], a[236:239], v[108:111], v[208:211]
    v_exp_f32 v215, v215
    v_cvt_pk_bf16_f32 v138, v212, v213
    ds_read_b128 a[220:223], v11 offset:8192
    v_cvt_pk_bf16_f32 v139, v214, v215
    v_mfma_f32_16x16x32_bf16 v[212:215], a[224:227], v[112:115], v[204:207]
    s_nop 2
    v_exp_f32 v208, v208
    v_mfma_f32_16x16x32_bf16 v[212:215], a[228:231], v[116:119], v[212:215]
    v_exp_f32 v209, v209
    v_mfma_f32_16x16x32_bf16 v[212:215], a[232:235], v[120:123], v[212:215]
    v_exp_f32 v210, v210
    v_mfma_f32_16x16x32_bf16 v[212:215], a[236:239], v[124:127], v[212:215]
    s_waitcnt lgkmcnt(3)
    v_exp_f32 v211, v211
    v_cvt_pk_bf16_f32 v146, v208, v209
    ds_read_b128 a[224:227], v8 offset:12288
    v_cvt_pk_bf16_f32 v147, v210, v211
    v_mfma_f32_16x16x32_bf16 v[208:211], a[208:211], v[64:67], v[192:195]
    s_waitcnt lgkmcnt(3)
    s_nop 0
    v_exp_f32 v212, v212
    v_mfma_f32_16x16x32_bf16 v[208:211], a[212:215], v[68:71], v[208:211]
    s_waitcnt lgkmcnt(2)
    v_exp_f32 v213, v213
    v_mfma_f32_16x16x32_bf16 v[208:211], a[216:219], v[72:75], v[208:211]
    s_waitcnt lgkmcnt(1)
    v_exp_f32 v214, v214
    v_mfma_f32_16x16x32_bf16 v[208:211], a[220:223], v[76:79], v[208:211]
    v_exp_f32 v215, v215
    v_cvt_pk_bf16_f32 v154, v212, v213
    ds_read_b128 a[228:231], v9 offset:12288
    v_cvt_pk_bf16_f32 v155, v214, v215
    v_mfma_f32_16x16x32_bf16 v[212:215], a[208:211], v[80:83], v[196:199]
    s_nop 2
    v_exp_f32 v208, v208
    v_mfma_f32_16x16x32_bf16 v[212:215], a[212:215], v[84:87], v[212:215]
    v_exp_f32 v209, v209
    v_mfma_f32_16x16x32_bf16 v[212:215], a[216:219], v[88:91], v[212:215]
    v_exp_f32 v210, v210
    v_mfma_f32_16x16x32_bf16 v[212:215], a[220:223], v[92:95], v[212:215]
    v_exp_f32 v211, v211
    v_cvt_pk_bf16_f32 v132, v208, v209
    ds_read_b128 a[232:235], v10 offset:12288
    v_cvt_pk_bf16_f32 v133, v210, v211
    v_mfma_f32_16x16x32_bf16 v[208:211], a[208:211], v[96:99], v[200:203]
    s_nop 2
    v_exp_f32 v212, v212
    v_mfma_f32_16x16x32_bf16 v[208:211], a[212:215], v[100:103], v[208:211]
    v_exp_f32 v213, v213
    v_mfma_f32_16x16x32_bf16 v[208:211], a[216:219], v[104:107], v[208:211]
    v_exp_f32 v214, v214
    v_mfma_f32_16x16x32_bf16 v[208:211], a[220:223], v[108:111], v[208:211]
    v_exp_f32 v215, v215
    v_cvt_pk_bf16_f32 v140, v212, v213
    ds_read_b128 a[236:239], v11 offset:12288
    v_cvt_pk_bf16_f32 v141, v214, v215
    s_waitcnt vmcnt(4)
    s_barrier
    v_mfma_f32_16x16x32_bf16 v[212:215], a[208:211], v[112:115], v[204:207]
    s_nop 0
    v_exp_f32 v208, v208
    v_mfma_f32_16x16x32_bf16 v[212:215], a[212:215], v[116:119], v[212:215]
    s_add_u32 m0, s42, 49152
    v_exp_f32 v209, v209
    v_mfma_f32_16x16x32_bf16 v[212:215], a[216:219], v[120:123], v[212:215]
    v_exp_f32 v210, v210
    v_mfma_f32_16x16x32_bf16 v[212:215], a[220:223], v[124:127], v[212:215]
    s_waitcnt lgkmcnt(3)
    v_exp_f32 v211, v211
    v_cvt_pk_bf16_f32 v148, v208, v209
    ds_read_b128 a[208:211], v8 offset:16384
    v_cvt_pk_bf16_f32 v149, v210, v211
    buffer_load_dwordx4 v36, s[8:11], s40 offen lds
    v_mfma_f32_16x16x32_bf16 v[208:211], a[224:227], v[64:67], v[192:195]
    s_waitcnt lgkmcnt(3)
    v_exp_f32 v212, v212
    v_mfma_f32_16x16x32_bf16 v[208:211], a[228:231], v[68:71], v[208:211]
    s_waitcnt lgkmcnt(2)
    v_exp_f32 v213, v213
    v_mfma_f32_16x16x32_bf16 v[208:211], a[232:235], v[72:75], v[208:211]
    s_waitcnt lgkmcnt(1)
    v_exp_f32 v214, v214
    v_mfma_f32_16x16x32_bf16 v[208:211], a[236:239], v[76:79], v[208:211]
    v_exp_f32 v215, v215
    v_cvt_pk_bf16_f32 v156, v212, v213
    ds_read_b128 a[212:215], v9 offset:16384
    v_cvt_pk_bf16_f32 v157, v214, v215
    v_mfma_f32_16x16x32_bf16 v[212:215], a[224:227], v[80:83], v[196:199]
    s_nop 2
    v_exp_f32 v208, v208
    v_mfma_f32_16x16x32_bf16 v[212:215], a[228:231], v[84:87], v[212:215]
    v_exp_f32 v209, v209
    v_mfma_f32_16x16x32_bf16 v[212:215], a[232:235], v[88:91], v[212:215]
    v_exp_f32 v210, v210
    v_mfma_f32_16x16x32_bf16 v[212:215], a[236:239], v[92:95], v[212:215]
    v_exp_f32 v211, v211
    ds_read_b64_tr_b16 a[160:161], v20 offset:0
    v_cvt_pk_bf16_f32 v134, v208, v209
    ds_read_b64_tr_b16 a[162:163], v20 offset:4096
    ds_read_b128 a[216:219], v10 offset:16384
    v_cvt_pk_bf16_f32 v135, v210, v211
    buffer_load_dwordx4 v37, s[8:11], s40 offen offset:1024 lds
    v_mfma_f32_16x16x32_bf16 v[208:211], a[224:227], v[96:99], v[200:203]
    v_exp_f32 v212, v212
    v_mfma_f32_16x16x32_bf16 v[208:211], a[228:231], v[100:103], v[208:211]
    v_exp_f32 v213, v213
    v_mfma_f32_16x16x32_bf16 v[208:211], a[232:235], v[104:107], v[208:211]
    v_exp_f32 v214, v214
    v_mfma_f32_16x16x32_bf16 v[208:211], a[236:239], v[108:111], v[208:211]
    v_exp_f32 v215, v215
    ds_read_b64_tr_b16 a[164:165], v20 offset:8192
    v_cvt_pk_bf16_f32 v142, v212, v213
    ds_read_b64_tr_b16 a[166:167], v20 offset:12288
    ds_read_b128 a[220:223], v11 offset:16384
    v_cvt_pk_bf16_f32 v143, v214, v215
    v_mfma_f32_16x16x32_bf16 v[212:215], a[224:227], v[112:115], v[204:207]
    s_nop 0
    v_exp_f32 v208, v208
    v_mfma_f32_16x16x32_bf16 v[212:215], a[228:231], v[116:119], v[212:215]
    v_exp_f32 v209, v209
    v_mfma_f32_16x16x32_bf16 v[212:215], a[232:235], v[120:123], v[212:215]
    v_exp_f32 v210, v210
    v_mfma_f32_16x16x32_bf16 v[212:215], a[236:239], v[124:127], v[212:215]
    v_exp_f32 v211, v211
    ds_read_b64_tr_b16 a[168:169], v21 offset:0
    v_cvt_pk_bf16_f32 v150, v208, v209
    ds_read_b64_tr_b16 a[170:171], v21 offset:4096
    ds_read_b128 a[224:227], v8 offset:20480
    v_cvt_pk_bf16_f32 v151, v210, v211
    s_waitcnt lgkmcnt(3)
    buffer_load_dwordx4 v38, s[8:11], s40 offen offset:2048 lds
Lattn_loop:
    v_mfma_f32_16x16x32_bf16 v[208:211], a[208:211], v[64:67], v[192:195]
    v_exp_f32 v212, v212
    v_mfma_f32_16x16x32_bf16 v[208:211], a[212:215], v[68:71], v[208:211]
    v_exp_f32 v213, v213
    v_mfma_f32_16x16x32_bf16 v[208:211], a[216:219], v[72:75], v[208:211]
    v_exp_f32 v214, v214
    v_mfma_f32_16x16x32_bf16 v[208:211], a[220:223], v[76:79], v[208:211]
    v_exp_f32 v215, v215
    v_mfma_f32_16x16x32_bf16 a[0:3], a[160:163], v[128:131], a[0:3]
    ds_read_b64_tr_b16 a[172:173], v21 offset:8192
    v_cvt_pk_bf16_f32 v158, v212, v213
    v_mfma_f32_16x16x32_bf16 a[0:3], a[164:167], v[132:135], a[0:3]
    ds_read_b64_tr_b16 a[174:175], v21 offset:12288
    v_mfma_f32_16x16x32_bf16 a[4:7], a[160:163], v[136:139], a[4:7]
    ds_read_b128 a[228:231], v9 offset:20480
    v_cvt_pk_bf16_f32 v159, v214, v215
    v_mfma_f32_16x16x32_bf16 a[4:7], a[164:167], v[140:143], a[4:7]
    v_mfma_f32_16x16x32_bf16 v[212:215], a[208:211], v[80:83], v[196:199]
    v_exp_f32 v208, v208
    v_mfma_f32_16x16x32_bf16 v[212:215], a[212:215], v[84:87], v[212:215]
    v_exp_f32 v209, v209
    v_mfma_f32_16x16x32_bf16 v[212:215], a[216:219], v[88:91], v[212:215]
    v_exp_f32 v210, v210
    v_mfma_f32_16x16x32_bf16 v[212:215], a[220:223], v[92:95], v[212:215]
    v_exp_f32 v211, v211
    v_mfma_f32_16x16x32_bf16 a[8:11], a[160:163], v[144:147], a[8:11]
    ds_read_b64_tr_b16 a[176:177], v22 offset:0
    v_cvt_pk_bf16_f32 v160, v208, v209
    v_mfma_f32_16x16x32_bf16 a[8:11], a[164:167], v[148:151], a[8:11]
    ds_read_b64_tr_b16 a[178:179], v22 offset:4096
    v_mfma_f32_16x16x32_bf16 a[12:15], a[160:163], v[152:155], a[12:15]
    ds_read_b128 a[232:235], v10 offset:20480
    v_cvt_pk_bf16_f32 v161, v210, v211
    v_mfma_f32_16x16x32_bf16 a[12:15], a[164:167], v[156:159], a[12:15]
    s_waitcnt lgkmcnt(3)
    buffer_load_dwordx4 v39, s[8:11], s40 offen offset:3072 lds
    v_mfma_f32_16x16x32_bf16 v[208:211], a[208:211], v[96:99], v[200:203]
    v_exp_f32 v212, v212
    v_mfma_f32_16x16x32_bf16 v[208:211], a[212:215], v[100:103], v[208:211]
    s_add_u32 s40, s40, 16384
    v_exp_f32 v213, v213
    v_mfma_f32_16x16x32_bf16 v[208:211], a[216:219], v[104:107], v[208:211]
    v_exp_f32 v214, v214
    v_mfma_f32_16x16x32_bf16 v[208:211], a[220:223], v[108:111], v[208:211]
    v_exp_f32 v215, v215
    v_mfma_f32_16x16x32_bf16 a[16:19], a[168:171], v[128:131], a[16:19]
    ds_read_b64_tr_b16 a[180:181], v22 offset:8192
    v_cvt_pk_bf16_f32 v168, v212, v213
    v_mfma_f32_16x16x32_bf16 a[16:19], a[172:175], v[132:135], a[16:19]
    ds_read_b64_tr_b16 a[182:183], v22 offset:12288
    v_mfma_f32_16x16x32_bf16 a[20:23], a[168:171], v[136:139], a[20:23]
    ds_read_b128 a[236:239], v11 offset:20480
    v_cvt_pk_bf16_f32 v169, v214, v215
    v_mfma_f32_16x16x32_bf16 a[20:23], a[172:175], v[140:143], a[20:23]
    v_smfmac_f32_16x16x64_bf16 a[192:195], v[52:55], v[128:135], v50
    v_mfma_f32_16x16x32_bf16 v[212:215], a[208:211], v[112:115], v[204:207]
    v_exp_f32 v208, v208
    v_mfma_f32_16x16x32_bf16 v[212:215], a[212:215], v[116:119], v[212:215]
    s_add_u32 m0, s42, 98304
    v_exp_f32 v209, v209
    v_mfma_f32_16x16x32_bf16 v[212:215], a[216:219], v[120:123], v[212:215]
    v_exp_f32 v210, v210
    v_mfma_f32_16x16x32_bf16 v[212:215], a[220:223], v[124:127], v[212:215]
    v_exp_f32 v211, v211
    v_mfma_f32_16x16x32_bf16 a[24:27], a[168:171], v[144:147], a[24:27]
    ds_read_b64_tr_b16 a[184:185], v23 offset:0
    v_cvt_pk_bf16_f32 v176, v208, v209
    v_mfma_f32_16x16x32_bf16 a[24:27], a[172:175], v[148:151], a[24:27]
    ds_read_b64_tr_b16 a[186:187], v23 offset:4096
    v_mfma_f32_16x16x32_bf16 a[28:31], a[168:171], v[152:155], a[28:31]
    ds_read_b128 a[208:211], v8 offset:24576
    v_cvt_pk_bf16_f32 v177, v210, v211
    v_mfma_f32_16x16x32_bf16 a[28:31], a[172:175], v[156:159], a[28:31]
    s_waitcnt lgkmcnt(3)
    buffer_load_dwordx4 v40, s[12:15], s41 offen lds
    v_mfma_f32_16x16x32_bf16 v[208:211], a[224:227], v[64:67], v[192:195]
    v_exp_f32 v212, v212
    v_mfma_f32_16x16x32_bf16 v[208:211], a[228:231], v[68:71], v[208:211]
    v_exp_f32 v213, v213
    v_mfma_f32_16x16x32_bf16 v[208:211], a[232:235], v[72:75], v[208:211]
    v_exp_f32 v214, v214
    v_mfma_f32_16x16x32_bf16 v[208:211], a[236:239], v[76:79], v[208:211]
    v_exp_f32 v215, v215
    v_mfma_f32_16x16x32_bf16 a[32:35], a[176:179], v[128:131], a[32:35]
    ds_read_b64_tr_b16 a[188:189], v23 offset:8192
    v_cvt_pk_bf16_f32 v184, v212, v213
    v_mfma_f32_16x16x32_bf16 a[32:35], a[180:183], v[132:135], a[32:35]
    ds_read_b64_tr_b16 a[190:191], v23 offset:12288
    v_mfma_f32_16x16x32_bf16 a[36:39], a[176:179], v[136:139], a[36:39]
    ds_read_b128 a[212:215], v9 offset:24576
    v_cvt_pk_bf16_f32 v185, v214, v215
    v_mfma_f32_16x16x32_bf16 a[36:39], a[180:183], v[140:143], a[36:39]
    v_smfmac_f32_16x16x64_bf16 a[196:199], v[52:55], v[136:143], v50
    v_mfma_f32_16x16x32_bf16 v[212:215], a[224:227], v[80:83], v[196:199]
    v_exp_f32 v208, v208
    v_mfma_f32_16x16x32_bf16 v[212:215], a[228:231], v[84:87], v[212:215]
    v_exp_f32 v209, v209
    v_mfma_f32_16x16x32_bf16 v[212:215], a[232:235], v[88:91], v[212:215]
    v_exp_f32 v210, v210
    v_mfma_f32_16x16x32_bf16 v[212:215], a[236:239], v[92:95], v[212:215]
    v_exp_f32 v211, v211
    v_mfma_f32_16x16x32_bf16 a[40:43], a[176:179], v[144:147], a[40:43]
    ds_read_b64_tr_b16 a[160:161], v24 offset:0
    v_cvt_pk_bf16_f32 v162, v208, v209
    v_mfma_f32_16x16x32_bf16 a[40:43], a[180:183], v[148:151], a[40:43]
    ds_read_b64_tr_b16 a[162:163], v24 offset:4096
    v_mfma_f32_16x16x32_bf16 a[44:47], a[176:179], v[152:155], a[44:47]
    ds_read_b128 a[216:219], v10 offset:24576
    v_cvt_pk_bf16_f32 v163, v210, v211
    v_mfma_f32_16x16x32_bf16 a[44:47], a[180:183], v[156:159], a[44:47]
    s_waitcnt lgkmcnt(3)
    buffer_load_dwordx4 v41, s[12:15], s41 offen offset:1024 lds
    v_mfma_f32_16x16x32_bf16 v[208:211], a[224:227], v[96:99], v[200:203]
    v_exp_f32 v212, v212
    v_mfma_f32_16x16x32_bf16 v[208:211], a[228:231], v[100:103], v[208:211]
    v_exp_f32 v213, v213
    v_mfma_f32_16x16x32_bf16 v[208:211], a[232:235], v[104:107], v[208:211]
    v_exp_f32 v214, v214
    v_mfma_f32_16x16x32_bf16 v[208:211], a[236:239], v[108:111], v[208:211]
    v_exp_f32 v215, v215
    v_mfma_f32_16x16x32_bf16 a[48:51], a[184:187], v[128:131], a[48:51]
    ds_read_b64_tr_b16 a[164:165], v24 offset:8192
    v_cvt_pk_bf16_f32 v170, v212, v213
    v_mfma_f32_16x16x32_bf16 a[48:51], a[188:191], v[132:135], a[48:51]
    ds_read_b64_tr_b16 a[166:167], v24 offset:12288
    v_mfma_f32_16x16x32_bf16 a[52:55], a[184:187], v[136:139], a[52:55]
    ds_read_b128 a[220:223], v11 offset:24576
    v_cvt_pk_bf16_f32 v171, v214, v215
    v_mfma_f32_16x16x32_bf16 a[52:55], a[188:191], v[140:143], a[52:55]
    v_smfmac_f32_16x16x64_bf16 a[200:203], v[52:55], v[144:151], v50
    v_mfma_f32_16x16x32_bf16 v[212:215], a[224:227], v[112:115], v[204:207]
    v_exp_f32 v208, v208
    v_mfma_f32_16x16x32_bf16 v[212:215], a[228:231], v[116:119], v[212:215]
    v_exp_f32 v209, v209
    v_mfma_f32_16x16x32_bf16 v[212:215], a[232:235], v[120:123], v[212:215]
    v_exp_f32 v210, v210
    v_mfma_f32_16x16x32_bf16 v[212:215], a[236:239], v[124:127], v[212:215]
    v_exp_f32 v211, v211
    v_mfma_f32_16x16x32_bf16 a[56:59], a[184:187], v[144:147], a[56:59]
    ds_read_b64_tr_b16 a[168:169], v25 offset:0
    v_cvt_pk_bf16_f32 v178, v208, v209
    v_mfma_f32_16x16x32_bf16 a[56:59], a[188:191], v[148:151], a[56:59]
    ds_read_b64_tr_b16 a[170:171], v25 offset:4096
    v_mfma_f32_16x16x32_bf16 a[60:63], a[184:187], v[152:155], a[60:63]
    ds_read_b128 a[224:227], v8 offset:28672
    v_cvt_pk_bf16_f32 v179, v210, v211
    v_mfma_f32_16x16x32_bf16 a[60:63], a[188:191], v[156:159], a[60:63]
    s_waitcnt lgkmcnt(3)
    buffer_load_dwordx4 v40, s[12:15], s41 offen offset:2048 lds
    v_mfma_f32_16x16x32_bf16 v[208:211], a[208:211], v[64:67], v[192:195]
    v_exp_f32 v212, v212
    v_mfma_f32_16x16x32_bf16 v[208:211], a[212:215], v[68:71], v[208:211]
    v_exp_f32 v213, v213
    v_mfma_f32_16x16x32_bf16 v[208:211], a[216:219], v[72:75], v[208:211]
    v_exp_f32 v214, v214
    v_mfma_f32_16x16x32_bf16 v[208:211], a[220:223], v[76:79], v[208:211]
    v_exp_f32 v215, v215
    v_mfma_f32_16x16x32_bf16 a[64:67], a[160:163], v[128:131], a[64:67]
    ds_read_b64_tr_b16 a[172:173], v25 offset:8192
    v_cvt_pk_bf16_f32 v186, v212, v213
    v_mfma_f32_16x16x32_bf16 a[64:67], a[164:167], v[132:135], a[64:67]
    ds_read_b64_tr_b16 a[174:175], v25 offset:12288
    v_mfma_f32_16x16x32_bf16 a[68:71], a[160:163], v[136:139], a[68:71]
    ds_read_b128 a[228:231], v9 offset:28672
    v_cvt_pk_bf16_f32 v187, v214, v215
    v_mfma_f32_16x16x32_bf16 a[68:71], a[164:167], v[140:143], a[68:71]
    v_smfmac_f32_16x16x64_bf16 a[204:207], v[52:55], v[152:159], v50
    v_mfma_f32_16x16x32_bf16 v[212:215], a[208:211], v[80:83], v[196:199]
    v_exp_f32 v208, v208
    v_mfma_f32_16x16x32_bf16 v[212:215], a[212:215], v[84:87], v[212:215]
    v_exp_f32 v209, v209
    v_mfma_f32_16x16x32_bf16 v[212:215], a[216:219], v[88:91], v[212:215]
    v_exp_f32 v210, v210
    v_mfma_f32_16x16x32_bf16 v[212:215], a[220:223], v[92:95], v[212:215]
    v_exp_f32 v211, v211
    v_mfma_f32_16x16x32_bf16 a[72:75], a[160:163], v[144:147], a[72:75]
    ds_read_b64_tr_b16 a[176:177], v26 offset:0
    v_cvt_pk_bf16_f32 v164, v208, v209
    v_mfma_f32_16x16x32_bf16 a[72:75], a[164:167], v[148:151], a[72:75]
    ds_read_b64_tr_b16 a[178:179], v26 offset:4096
    v_mfma_f32_16x16x32_bf16 a[76:79], a[160:163], v[152:155], a[76:79]
    ds_read_b128 a[232:235], v10 offset:28672
    v_cvt_pk_bf16_f32 v165, v210, v211
    v_mfma_f32_16x16x32_bf16 a[76:79], a[164:167], v[156:159], a[76:79]
    s_waitcnt lgkmcnt(3)
    buffer_load_dwordx4 v41, s[12:15], s41 offen offset:3072 lds
    v_mfma_f32_16x16x32_bf16 v[208:211], a[208:211], v[96:99], v[200:203]
    v_exp_f32 v212, v212
    v_mfma_f32_16x16x32_bf16 v[208:211], a[212:215], v[100:103], v[208:211]
    s_add_u32 s41, s41, 16384
    v_exp_f32 v213, v213
    v_mfma_f32_16x16x32_bf16 v[208:211], a[216:219], v[104:107], v[208:211]
    v_exp_f32 v214, v214
    v_mfma_f32_16x16x32_bf16 v[208:211], a[220:223], v[108:111], v[208:211]
    v_exp_f32 v215, v215
    v_mfma_f32_16x16x32_bf16 a[80:83], a[168:171], v[128:131], a[80:83]
    ds_read_b64_tr_b16 a[180:181], v26 offset:8192
    v_cvt_pk_bf16_f32 v172, v212, v213
    v_mfma_f32_16x16x32_bf16 a[80:83], a[172:175], v[132:135], a[80:83]
    ds_read_b64_tr_b16 a[182:183], v26 offset:12288
    v_mfma_f32_16x16x32_bf16 a[84:87], a[168:171], v[136:139], a[84:87]
    ds_read_b128 a[236:239], v11 offset:28672
    v_cvt_pk_bf16_f32 v173, v214, v215
    v_mfma_f32_16x16x32_bf16 a[84:87], a[172:175], v[140:143], a[84:87]
    s_waitcnt vmcnt(8)
    s_barrier
    v_mfma_f32_16x16x32_bf16 v[212:215], a[208:211], v[112:115], v[204:207]
    v_exp_f32 v208, v208
    v_mfma_f32_16x16x32_bf16 v[212:215], a[212:215], v[116:119], v[212:215]
    s_add_u32 m0, s42, 0
    v_exp_f32 v209, v209
    v_mfma_f32_16x16x32_bf16 v[212:215], a[216:219], v[120:123], v[212:215]
    v_exp_f32 v210, v210
    v_mfma_f32_16x16x32_bf16 v[212:215], a[220:223], v[124:127], v[212:215]
    v_exp_f32 v211, v211
    v_mfma_f32_16x16x32_bf16 a[88:91], a[168:171], v[144:147], a[88:91]
    ds_read_b64_tr_b16 a[184:185], v27 offset:0
    v_cvt_pk_bf16_f32 v180, v208, v209
    v_mfma_f32_16x16x32_bf16 a[88:91], a[172:175], v[148:151], a[88:91]
    ds_read_b64_tr_b16 a[186:187], v27 offset:4096
    v_mfma_f32_16x16x32_bf16 a[92:95], a[168:171], v[152:155], a[92:95]
    ds_read_b128 a[208:211], v8 offset:32768
    v_cvt_pk_bf16_f32 v181, v210, v211
    v_mfma_f32_16x16x32_bf16 a[92:95], a[172:175], v[156:159], a[92:95]
    s_waitcnt lgkmcnt(3)
    buffer_load_dwordx4 v36, s[8:11], s40 offen lds
    v_mfma_f32_16x16x32_bf16 v[208:211], a[224:227], v[64:67], v[192:195]
    v_exp_f32 v212, v212
    v_mfma_f32_16x16x32_bf16 v[208:211], a[228:231], v[68:71], v[208:211]
    v_exp_f32 v213, v213
    v_mfma_f32_16x16x32_bf16 v[208:211], a[232:235], v[72:75], v[208:211]
    v_exp_f32 v214, v214
    v_mfma_f32_16x16x32_bf16 v[208:211], a[236:239], v[76:79], v[208:211]
    v_exp_f32 v215, v215
    v_mfma_f32_16x16x32_bf16 a[96:99], a[176:179], v[128:131], a[96:99]
    ds_read_b64_tr_b16 a[188:189], v27 offset:8192
    v_cvt_pk_bf16_f32 v188, v212, v213
    v_mfma_f32_16x16x32_bf16 a[96:99], a[180:183], v[132:135], a[96:99]
    ds_read_b64_tr_b16 a[190:191], v27 offset:12288
    v_mfma_f32_16x16x32_bf16 a[100:103], a[176:179], v[136:139], a[100:103]
    ds_read_b128 a[212:215], v9 offset:32768
    v_cvt_pk_bf16_f32 v189, v214, v215
    v_mfma_f32_16x16x32_bf16 a[100:103], a[180:183], v[140:143], a[100:103]
    v_mfma_f32_16x16x32_bf16 v[212:215], a[224:227], v[80:83], v[196:199]
    v_exp_f32 v208, v208
    v_mfma_f32_16x16x32_bf16 v[212:215], a[228:231], v[84:87], v[212:215]
    v_exp_f32 v209, v209
    v_mfma_f32_16x16x32_bf16 v[212:215], a[232:235], v[88:91], v[212:215]
    v_exp_f32 v210, v210
    v_mfma_f32_16x16x32_bf16 v[212:215], a[236:239], v[92:95], v[212:215]
    v_exp_f32 v211, v211
    v_mfma_f32_16x16x32_bf16 a[104:107], a[176:179], v[144:147], a[104:107]
    ds_read_b64_tr_b16 a[160:161], v20 offset:16384
    v_cvt_pk_bf16_f32 v166, v208, v209
    v_mfma_f32_16x16x32_bf16 a[104:107], a[180:183], v[148:151], a[104:107]
    ds_read_b64_tr_b16 a[162:163], v20 offset:20480
    v_mfma_f32_16x16x32_bf16 a[108:111], a[176:179], v[152:155], a[108:111]
    ds_read_b128 a[216:219], v10 offset:32768
    v_cvt_pk_bf16_f32 v167, v210, v211
    v_mfma_f32_16x16x32_bf16 a[108:111], a[180:183], v[156:159], a[108:111]
    s_waitcnt lgkmcnt(3)
    buffer_load_dwordx4 v37, s[8:11], s40 offen offset:1024 lds
    v_mfma_f32_16x16x32_bf16 v[208:211], a[224:227], v[96:99], v[200:203]
    v_exp_f32 v212, v212
    v_mfma_f32_16x16x32_bf16 v[208:211], a[228:231], v[100:103], v[208:211]
    v_exp_f32 v213, v213
    v_mfma_f32_16x16x32_bf16 v[208:211], a[232:235], v[104:107], v[208:211]
    v_exp_f32 v214, v214
    v_mfma_f32_16x16x32_bf16 v[208:211], a[236:239], v[108:111], v[208:211]
    v_exp_f32 v215, v215
    v_mfma_f32_16x16x32_bf16 a[112:115], a[184:187], v[128:131], a[112:115]
    ds_read_b64_tr_b16 a[164:165], v20 offset:24576
    v_cvt_pk_bf16_f32 v174, v212, v213
    v_mfma_f32_16x16x32_bf16 a[112:115], a[188:191], v[132:135], a[112:115]
    ds_read_b64_tr_b16 a[166:167], v20 offset:28672
    v_mfma_f32_16x16x32_bf16 a[116:119], a[184:187], v[136:139], a[116:119]
    ds_read_b128 a[220:223], v11 offset:32768
    v_cvt_pk_bf16_f32 v175, v214, v215
    v_mfma_f32_16x16x32_bf16 a[116:119], a[188:191], v[140:143], a[116:119]
    v_mfma_f32_16x16x32_bf16 v[212:215], a[224:227], v[112:115], v[204:207]
    v_exp_f32 v208, v208
    v_mfma_f32_16x16x32_bf16 v[212:215], a[228:231], v[116:119], v[212:215]
    v_exp_f32 v209, v209
    v_mfma_f32_16x16x32_bf16 v[212:215], a[232:235], v[120:123], v[212:215]
    v_exp_f32 v210, v210
    v_mfma_f32_16x16x32_bf16 v[212:215], a[236:239], v[124:127], v[212:215]
    v_exp_f32 v211, v211
    v_mfma_f32_16x16x32_bf16 a[120:123], a[184:187], v[144:147], a[120:123]
    ds_read_b64_tr_b16 a[168:169], v21 offset:16384
    v_cvt_pk_bf16_f32 v182, v208, v209
    v_mfma_f32_16x16x32_bf16 a[120:123], a[188:191], v[148:151], a[120:123]
    ds_read_b64_tr_b16 a[170:171], v21 offset:20480
    v_mfma_f32_16x16x32_bf16 a[124:127], a[184:187], v[152:155], a[124:127]
    ds_read_b128 a[224:227], v8 offset:36864
    v_cvt_pk_bf16_f32 v183, v210, v211
    v_mfma_f32_16x16x32_bf16 a[124:127], a[188:191], v[156:159], a[124:127]
    s_waitcnt lgkmcnt(3)
    buffer_load_dwordx4 v38, s[8:11], s40 offen offset:2048 lds
    v_mfma_f32_16x16x32_bf16 v[208:211], a[208:211], v[64:67], v[192:195]
    v_exp_f32 v212, v212
    v_mfma_f32_16x16x32_bf16 v[208:211], a[212:215], v[68:71], v[208:211]
    v_exp_f32 v213, v213
    v_mfma_f32_16x16x32_bf16 v[208:211], a[216:219], v[72:75], v[208:211]
    v_exp_f32 v214, v214
    v_mfma_f32_16x16x32_bf16 v[208:211], a[220:223], v[76:79], v[208:211]
    v_exp_f32 v215, v215
    v_mfma_f32_16x16x32_bf16 a[0:3], a[160:163], v[160:163], a[0:3]
    ds_read_b64_tr_b16 a[172:173], v21 offset:24576
    v_cvt_pk_bf16_f32 v190, v212, v213
    v_mfma_f32_16x16x32_bf16 a[0:3], a[164:167], v[164:167], a[0:3]
    ds_read_b64_tr_b16 a[174:175], v21 offset:28672
    v_mfma_f32_16x16x32_bf16 a[4:7], a[160:163], v[168:171], a[4:7]
    ds_read_b128 a[228:231], v9 offset:36864
    v_cvt_pk_bf16_f32 v191, v214, v215
    v_mfma_f32_16x16x32_bf16 a[4:7], a[164:167], v[172:175], a[4:7]
    v_mfma_f32_16x16x32_bf16 v[212:215], a[208:211], v[80:83], v[196:199]
    v_exp_f32 v208, v208
    v_mfma_f32_16x16x32_bf16 v[212:215], a[212:215], v[84:87], v[212:215]
    v_exp_f32 v209, v209
    v_mfma_f32_16x16x32_bf16 v[212:215], a[216:219], v[88:91], v[212:215]
    v_exp_f32 v210, v210
    v_mfma_f32_16x16x32_bf16 v[212:215], a[220:223], v[92:95], v[212:215]
    v_exp_f32 v211, v211
    v_mfma_f32_16x16x32_bf16 a[8:11], a[160:163], v[176:179], a[8:11]
    ds_read_b64_tr_b16 a[176:177], v22 offset:16384
    v_cvt_pk_bf16_f32 v128, v208, v209
    v_mfma_f32_16x16x32_bf16 a[8:11], a[164:167], v[180:183], a[8:11]
    ds_read_b64_tr_b16 a[178:179], v22 offset:20480
    v_mfma_f32_16x16x32_bf16 a[12:15], a[160:163], v[184:187], a[12:15]
    ds_read_b128 a[232:235], v10 offset:36864
    v_cvt_pk_bf16_f32 v129, v210, v211
    v_mfma_f32_16x16x32_bf16 a[12:15], a[164:167], v[188:191], a[12:15]
    s_waitcnt lgkmcnt(3)
    buffer_load_dwordx4 v39, s[8:11], s40 offen offset:3072 lds
    v_mfma_f32_16x16x32_bf16 v[208:211], a[208:211], v[96:99], v[200:203]
    v_exp_f32 v212, v212
    v_mfma_f32_16x16x32_bf16 v[208:211], a[212:215], v[100:103], v[208:211]
    s_add_u32 s40, s40, 16384
    v_exp_f32 v213, v213
    v_mfma_f32_16x16x32_bf16 v[208:211], a[216:219], v[104:107], v[208:211]
    v_exp_f32 v214, v214
    v_mfma_f32_16x16x32_bf16 v[208:211], a[220:223], v[108:111], v[208:211]
    v_exp_f32 v215, v215
    v_mfma_f32_16x16x32_bf16 a[16:19], a[168:171], v[160:163], a[16:19]
    ds_read_b64_tr_b16 a[180:181], v22 offset:24576
    v_cvt_pk_bf16_f32 v136, v212, v213
    v_mfma_f32_16x16x32_bf16 a[16:19], a[172:175], v[164:167], a[16:19]
    ds_read_b64_tr_b16 a[182:183], v22 offset:28672
    v_mfma_f32_16x16x32_bf16 a[20:23], a[168:171], v[168:171], a[20:23]
    ds_read_b128 a[236:239], v11 offset:36864
    v_cvt_pk_bf16_f32 v137, v214, v215
    v_mfma_f32_16x16x32_bf16 a[20:23], a[172:175], v[172:175], a[20:23]
    v_smfmac_f32_16x16x64_bf16 a[192:195], v[52:55], v[160:167], v50
    v_mfma_f32_16x16x32_bf16 v[212:215], a[208:211], v[112:115], v[204:207]
    v_exp_f32 v208, v208
    v_mfma_f32_16x16x32_bf16 v[212:215], a[212:215], v[116:119], v[212:215]
    s_add_u32 m0, s42, 114688
    v_exp_f32 v209, v209
    v_mfma_f32_16x16x32_bf16 v[212:215], a[216:219], v[120:123], v[212:215]
    v_exp_f32 v210, v210
    v_mfma_f32_16x16x32_bf16 v[212:215], a[220:223], v[124:127], v[212:215]
    v_exp_f32 v211, v211
    v_mfma_f32_16x16x32_bf16 a[24:27], a[168:171], v[176:179], a[24:27]
    ds_read_b64_tr_b16 a[184:185], v23 offset:16384
    v_cvt_pk_bf16_f32 v144, v208, v209
    v_mfma_f32_16x16x32_bf16 a[24:27], a[172:175], v[180:183], a[24:27]
    ds_read_b64_tr_b16 a[186:187], v23 offset:20480
    v_mfma_f32_16x16x32_bf16 a[28:31], a[168:171], v[184:187], a[28:31]
    ds_read_b128 a[208:211], v8 offset:40960
    v_cvt_pk_bf16_f32 v145, v210, v211
    v_mfma_f32_16x16x32_bf16 a[28:31], a[172:175], v[188:191], a[28:31]
    s_waitcnt lgkmcnt(3)
    buffer_load_dwordx4 v40, s[12:15], s41 offen lds
    v_mfma_f32_16x16x32_bf16 v[208:211], a[224:227], v[64:67], v[192:195]
    v_exp_f32 v212, v212
    v_mfma_f32_16x16x32_bf16 v[208:211], a[228:231], v[68:71], v[208:211]
    v_exp_f32 v213, v213
    v_mfma_f32_16x16x32_bf16 v[208:211], a[232:235], v[72:75], v[208:211]
    v_exp_f32 v214, v214
    v_mfma_f32_16x16x32_bf16 v[208:211], a[236:239], v[76:79], v[208:211]
    v_exp_f32 v215, v215
    v_mfma_f32_16x16x32_bf16 a[32:35], a[176:179], v[160:163], a[32:35]
    ds_read_b64_tr_b16 a[188:189], v23 offset:24576
    v_cvt_pk_bf16_f32 v152, v212, v213
    v_mfma_f32_16x16x32_bf16 a[32:35], a[180:183], v[164:167], a[32:35]
    ds_read_b64_tr_b16 a[190:191], v23 offset:28672
    v_mfma_f32_16x16x32_bf16 a[36:39], a[176:179], v[168:171], a[36:39]
    ds_read_b128 a[212:215], v9 offset:40960
    v_cvt_pk_bf16_f32 v153, v214, v215
    v_mfma_f32_16x16x32_bf16 a[36:39], a[180:183], v[172:175], a[36:39]
    v_smfmac_f32_16x16x64_bf16 a[196:199], v[52:55], v[168:175], v50
    v_mfma_f32_16x16x32_bf16 v[212:215], a[224:227], v[80:83], v[196:199]
    v_exp_f32 v208, v208
    v_mfma_f32_16x16x32_bf16 v[212:215], a[228:231], v[84:87], v[212:215]
    v_exp_f32 v209, v209
    v_mfma_f32_16x16x32_bf16 v[212:215], a[232:235], v[88:91], v[212:215]
    v_exp_f32 v210, v210
    v_mfma_f32_16x16x32_bf16 v[212:215], a[236:239], v[92:95], v[212:215]
    v_exp_f32 v211, v211
    v_mfma_f32_16x16x32_bf16 a[40:43], a[176:179], v[176:179], a[40:43]
    ds_read_b64_tr_b16 a[160:161], v24 offset:16384
    v_cvt_pk_bf16_f32 v130, v208, v209
    v_mfma_f32_16x16x32_bf16 a[40:43], a[180:183], v[180:183], a[40:43]
    ds_read_b64_tr_b16 a[162:163], v24 offset:20480
    v_mfma_f32_16x16x32_bf16 a[44:47], a[176:179], v[184:187], a[44:47]
    ds_read_b128 a[216:219], v10 offset:40960
    v_cvt_pk_bf16_f32 v131, v210, v211
    v_mfma_f32_16x16x32_bf16 a[44:47], a[180:183], v[188:191], a[44:47]
    s_waitcnt lgkmcnt(3)
    buffer_load_dwordx4 v41, s[12:15], s41 offen offset:1024 lds
    v_mfma_f32_16x16x32_bf16 v[208:211], a[224:227], v[96:99], v[200:203]
    v_exp_f32 v212, v212
    v_mfma_f32_16x16x32_bf16 v[208:211], a[228:231], v[100:103], v[208:211]
    v_exp_f32 v213, v213
    v_mfma_f32_16x16x32_bf16 v[208:211], a[232:235], v[104:107], v[208:211]
    v_exp_f32 v214, v214
    v_mfma_f32_16x16x32_bf16 v[208:211], a[236:239], v[108:111], v[208:211]
    v_exp_f32 v215, v215
    v_mfma_f32_16x16x32_bf16 a[48:51], a[184:187], v[160:163], a[48:51]
    ds_read_b64_tr_b16 a[164:165], v24 offset:24576
    v_cvt_pk_bf16_f32 v138, v212, v213
    v_mfma_f32_16x16x32_bf16 a[48:51], a[188:191], v[164:167], a[48:51]
    ds_read_b64_tr_b16 a[166:167], v24 offset:28672
    v_mfma_f32_16x16x32_bf16 a[52:55], a[184:187], v[168:171], a[52:55]
    ds_read_b128 a[220:223], v11 offset:40960
    v_cvt_pk_bf16_f32 v139, v214, v215
    v_mfma_f32_16x16x32_bf16 a[52:55], a[188:191], v[172:175], a[52:55]
    v_smfmac_f32_16x16x64_bf16 a[200:203], v[52:55], v[176:183], v50
    v_mfma_f32_16x16x32_bf16 v[212:215], a[224:227], v[112:115], v[204:207]
    v_exp_f32 v208, v208
    v_mfma_f32_16x16x32_bf16 v[212:215], a[228:231], v[116:119], v[212:215]
    v_exp_f32 v209, v209
    v_mfma_f32_16x16x32_bf16 v[212:215], a[232:235], v[120:123], v[212:215]
    v_exp_f32 v210, v210
    v_mfma_f32_16x16x32_bf16 v[212:215], a[236:239], v[124:127], v[212:215]
    v_exp_f32 v211, v211
    v_mfma_f32_16x16x32_bf16 a[56:59], a[184:187], v[176:179], a[56:59]
    ds_read_b64_tr_b16 a[168:169], v25 offset:16384
    v_cvt_pk_bf16_f32 v146, v208, v209
    v_mfma_f32_16x16x32_bf16 a[56:59], a[188:191], v[180:183], a[56:59]
    ds_read_b64_tr_b16 a[170:171], v25 offset:20480
    v_mfma_f32_16x16x32_bf16 a[60:63], a[184:187], v[184:187], a[60:63]
    ds_read_b128 a[224:227], v8 offset:45056
    v_cvt_pk_bf16_f32 v147, v210, v211
    v_mfma_f32_16x16x32_bf16 a[60:63], a[188:191], v[188:191], a[60:63]
    s_waitcnt lgkmcnt(3)
    buffer_load_dwordx4 v40, s[12:15], s41 offen offset:2048 lds
    v_mfma_f32_16x16x32_bf16 v[208:211], a[208:211], v[64:67], v[192:195]
    v_exp_f32 v212, v212
    v_mfma_f32_16x16x32_bf16 v[208:211], a[212:215], v[68:71], v[208:211]
    v_exp_f32 v213, v213
    v_mfma_f32_16x16x32_bf16 v[208:211], a[216:219], v[72:75], v[208:211]
    v_exp_f32 v214, v214
    v_mfma_f32_16x16x32_bf16 v[208:211], a[220:223], v[76:79], v[208:211]
    v_exp_f32 v215, v215
    v_mfma_f32_16x16x32_bf16 a[64:67], a[160:163], v[160:163], a[64:67]
    ds_read_b64_tr_b16 a[172:173], v25 offset:24576
    v_cvt_pk_bf16_f32 v154, v212, v213
    v_mfma_f32_16x16x32_bf16 a[64:67], a[164:167], v[164:167], a[64:67]
    ds_read_b64_tr_b16 a[174:175], v25 offset:28672
    v_mfma_f32_16x16x32_bf16 a[68:71], a[160:163], v[168:171], a[68:71]
    ds_read_b128 a[228:231], v9 offset:45056
    v_cvt_pk_bf16_f32 v155, v214, v215
    v_mfma_f32_16x16x32_bf16 a[68:71], a[164:167], v[172:175], a[68:71]
    v_smfmac_f32_16x16x64_bf16 a[204:207], v[52:55], v[184:191], v50
    v_mfma_f32_16x16x32_bf16 v[212:215], a[208:211], v[80:83], v[196:199]
    v_exp_f32 v208, v208
    v_mfma_f32_16x16x32_bf16 v[212:215], a[212:215], v[84:87], v[212:215]
    v_exp_f32 v209, v209
    v_mfma_f32_16x16x32_bf16 v[212:215], a[216:219], v[88:91], v[212:215]
    v_exp_f32 v210, v210
    v_mfma_f32_16x16x32_bf16 v[212:215], a[220:223], v[92:95], v[212:215]
    v_exp_f32 v211, v211
    v_mfma_f32_16x16x32_bf16 a[72:75], a[160:163], v[176:179], a[72:75]
    ds_read_b64_tr_b16 a[176:177], v26 offset:16384
    v_cvt_pk_bf16_f32 v132, v208, v209
    v_mfma_f32_16x16x32_bf16 a[72:75], a[164:167], v[180:183], a[72:75]
    ds_read_b64_tr_b16 a[178:179], v26 offset:20480
    v_mfma_f32_16x16x32_bf16 a[76:79], a[160:163], v[184:187], a[76:79]
    ds_read_b128 a[232:235], v10 offset:45056
    v_cvt_pk_bf16_f32 v133, v210, v211
    v_mfma_f32_16x16x32_bf16 a[76:79], a[164:167], v[188:191], a[76:79]
    s_waitcnt lgkmcnt(3)
    buffer_load_dwordx4 v41, s[12:15], s41 offen offset:3072 lds
    v_mfma_f32_16x16x32_bf16 v[208:211], a[208:211], v[96:99], v[200:203]
    v_exp_f32 v212, v212
    v_mfma_f32_16x16x32_bf16 v[208:211], a[212:215], v[100:103], v[208:211]
    s_add_u32 s41, s41, 16384
    v_exp_f32 v213, v213
    v_mfma_f32_16x16x32_bf16 v[208:211], a[216:219], v[104:107], v[208:211]
    v_exp_f32 v214, v214
    v_mfma_f32_16x16x32_bf16 v[208:211], a[220:223], v[108:111], v[208:211]
    v_exp_f32 v215, v215
    v_mfma_f32_16x16x32_bf16 a[80:83], a[168:171], v[160:163], a[80:83]
    ds_read_b64_tr_b16 a[180:181], v26 offset:24576
    v_cvt_pk_bf16_f32 v140, v212, v213
    v_mfma_f32_16x16x32_bf16 a[80:83], a[172:175], v[164:167], a[80:83]
    ds_read_b64_tr_b16 a[182:183], v26 offset:28672
    v_mfma_f32_16x16x32_bf16 a[84:87], a[168:171], v[168:171], a[84:87]
    ds_read_b128 a[236:239], v11 offset:45056
    v_cvt_pk_bf16_f32 v141, v214, v215
    v_mfma_f32_16x16x32_bf16 a[84:87], a[172:175], v[172:175], a[84:87]
    s_waitcnt vmcnt(8)
    s_barrier
    v_mfma_f32_16x16x32_bf16 v[212:215], a[208:211], v[112:115], v[204:207]
    v_exp_f32 v208, v208
    v_mfma_f32_16x16x32_bf16 v[212:215], a[212:215], v[116:119], v[212:215]
    s_add_u32 m0, s42, 16384
    v_exp_f32 v209, v209
    v_mfma_f32_16x16x32_bf16 v[212:215], a[216:219], v[120:123], v[212:215]
    v_exp_f32 v210, v210
    v_mfma_f32_16x16x32_bf16 v[212:215], a[220:223], v[124:127], v[212:215]
    v_exp_f32 v211, v211
    v_mfma_f32_16x16x32_bf16 a[88:91], a[168:171], v[176:179], a[88:91]
    ds_read_b64_tr_b16 a[184:185], v27 offset:16384
    v_cvt_pk_bf16_f32 v148, v208, v209
    v_mfma_f32_16x16x32_bf16 a[88:91], a[172:175], v[180:183], a[88:91]
    ds_read_b64_tr_b16 a[186:187], v27 offset:20480
    v_mfma_f32_16x16x32_bf16 a[92:95], a[168:171], v[184:187], a[92:95]
    ds_read_b128 a[208:211], v8 offset:49152
    v_cvt_pk_bf16_f32 v149, v210, v211
    v_mfma_f32_16x16x32_bf16 a[92:95], a[172:175], v[188:191], a[92:95]
    s_waitcnt lgkmcnt(3)
    buffer_load_dwordx4 v36, s[8:11], s40 offen lds
    v_mfma_f32_16x16x32_bf16 v[208:211], a[224:227], v[64:67], v[192:195]
    v_exp_f32 v212, v212
    v_mfma_f32_16x16x32_bf16 v[208:211], a[228:231], v[68:71], v[208:211]
    v_exp_f32 v213, v213
    v_mfma_f32_16x16x32_bf16 v[208:211], a[232:235], v[72:75], v[208:211]
    v_exp_f32 v214, v214
    v_mfma_f32_16x16x32_bf16 v[208:211], a[236:239], v[76:79], v[208:211]
    v_exp_f32 v215, v215
    v_mfma_f32_16x16x32_bf16 a[96:99], a[176:179], v[160:163], a[96:99]
    ds_read_b64_tr_b16 a[188:189], v27 offset:24576
    v_cvt_pk_bf16_f32 v156, v212, v213
    v_mfma_f32_16x16x32_bf16 a[96:99], a[180:183], v[164:167], a[96:99]
    ds_read_b64_tr_b16 a[190:191], v27 offset:28672
    v_mfma_f32_16x16x32_bf16 a[100:103], a[176:179], v[168:171], a[100:103]
    ds_read_b128 a[212:215], v9 offset:49152
    v_cvt_pk_bf16_f32 v157, v214, v215
    v_mfma_f32_16x16x32_bf16 a[100:103], a[180:183], v[172:175], a[100:103]
    v_mfma_f32_16x16x32_bf16 v[212:215], a[224:227], v[80:83], v[196:199]
    v_exp_f32 v208, v208
    v_mfma_f32_16x16x32_bf16 v[212:215], a[228:231], v[84:87], v[212:215]
    v_exp_f32 v209, v209
    v_mfma_f32_16x16x32_bf16 v[212:215], a[232:235], v[88:91], v[212:215]
    v_exp_f32 v210, v210
    v_mfma_f32_16x16x32_bf16 v[212:215], a[236:239], v[92:95], v[212:215]
    v_exp_f32 v211, v211
    v_mfma_f32_16x16x32_bf16 a[104:107], a[176:179], v[176:179], a[104:107]
    ds_read_b64_tr_b16 a[160:161], v20 offset:32768
    v_cvt_pk_bf16_f32 v134, v208, v209
    v_mfma_f32_16x16x32_bf16 a[104:107], a[180:183], v[180:183], a[104:107]
    ds_read_b64_tr_b16 a[162:163], v20 offset:36864
    v_mfma_f32_16x16x32_bf16 a[108:111], a[176:179], v[184:187], a[108:111]
    ds_read_b128 a[216:219], v10 offset:49152
    v_cvt_pk_bf16_f32 v135, v210, v211
    v_mfma_f32_16x16x32_bf16 a[108:111], a[180:183], v[188:191], a[108:111]
    s_waitcnt lgkmcnt(3)
    buffer_load_dwordx4 v37, s[8:11], s40 offen offset:1024 lds
    v_mfma_f32_16x16x32_bf16 v[208:211], a[224:227], v[96:99], v[200:203]
    v_exp_f32 v212, v212
    v_mfma_f32_16x16x32_bf16 v[208:211], a[228:231], v[100:103], v[208:211]
    v_exp_f32 v213, v213
    v_mfma_f32_16x16x32_bf16 v[208:211], a[232:235], v[104:107], v[208:211]
    v_exp_f32 v214, v214
    v_mfma_f32_16x16x32_bf16 v[208:211], a[236:239], v[108:111], v[208:211]
    v_exp_f32 v215, v215
    v_mfma_f32_16x16x32_bf16 a[112:115], a[184:187], v[160:163], a[112:115]
    ds_read_b64_tr_b16 a[164:165], v20 offset:40960
    v_cvt_pk_bf16_f32 v142, v212, v213
    v_mfma_f32_16x16x32_bf16 a[112:115], a[188:191], v[164:167], a[112:115]
    ds_read_b64_tr_b16 a[166:167], v20 offset:45056
    v_mfma_f32_16x16x32_bf16 a[116:119], a[184:187], v[168:171], a[116:119]
    ds_read_b128 a[220:223], v11 offset:49152
    v_cvt_pk_bf16_f32 v143, v214, v215
    v_mfma_f32_16x16x32_bf16 a[116:119], a[188:191], v[172:175], a[116:119]
    v_mfma_f32_16x16x32_bf16 v[212:215], a[224:227], v[112:115], v[204:207]
    v_exp_f32 v208, v208
    v_mfma_f32_16x16x32_bf16 v[212:215], a[228:231], v[116:119], v[212:215]
    v_exp_f32 v209, v209
    v_mfma_f32_16x16x32_bf16 v[212:215], a[232:235], v[120:123], v[212:215]
    v_exp_f32 v210, v210
    v_mfma_f32_16x16x32_bf16 v[212:215], a[236:239], v[124:127], v[212:215]
    v_exp_f32 v211, v211
    v_mfma_f32_16x16x32_bf16 a[120:123], a[184:187], v[176:179], a[120:123]
    ds_read_b64_tr_b16 a[168:169], v21 offset:32768
    v_cvt_pk_bf16_f32 v150, v208, v209
    v_mfma_f32_16x16x32_bf16 a[120:123], a[188:191], v[180:183], a[120:123]
    ds_read_b64_tr_b16 a[170:171], v21 offset:36864
    v_mfma_f32_16x16x32_bf16 a[124:127], a[184:187], v[184:187], a[124:127]
    ds_read_b128 a[224:227], v8 offset:53248
    v_cvt_pk_bf16_f32 v151, v210, v211
    v_mfma_f32_16x16x32_bf16 a[124:127], a[188:191], v[188:191], a[124:127]
    s_waitcnt lgkmcnt(3)
    buffer_load_dwordx4 v38, s[8:11], s40 offen offset:2048 lds
    v_mfma_f32_16x16x32_bf16 v[208:211], a[208:211], v[64:67], v[192:195]
    v_exp_f32 v212, v212
    v_mfma_f32_16x16x32_bf16 v[208:211], a[212:215], v[68:71], v[208:211]
    v_exp_f32 v213, v213
    v_mfma_f32_16x16x32_bf16 v[208:211], a[216:219], v[72:75], v[208:211]
    v_exp_f32 v214, v214
    v_mfma_f32_16x16x32_bf16 v[208:211], a[220:223], v[76:79], v[208:211]
    v_exp_f32 v215, v215
    v_mfma_f32_16x16x32_bf16 a[0:3], a[160:163], v[128:131], a[0:3]
    ds_read_b64_tr_b16 a[172:173], v21 offset:40960
    v_cvt_pk_bf16_f32 v158, v212, v213
    v_mfma_f32_16x16x32_bf16 a[0:3], a[164:167], v[132:135], a[0:3]
    ds_read_b64_tr_b16 a[174:175], v21 offset:45056
    v_mfma_f32_16x16x32_bf16 a[4:7], a[160:163], v[136:139], a[4:7]
    ds_read_b128 a[228:231], v9 offset:53248
    v_cvt_pk_bf16_f32 v159, v214, v215
    v_mfma_f32_16x16x32_bf16 a[4:7], a[164:167], v[140:143], a[4:7]
    v_mfma_f32_16x16x32_bf16 v[212:215], a[208:211], v[80:83], v[196:199]
    v_exp_f32 v208, v208
    v_mfma_f32_16x16x32_bf16 v[212:215], a[212:215], v[84:87], v[212:215]
    v_exp_f32 v209, v209
    v_mfma_f32_16x16x32_bf16 v[212:215], a[216:219], v[88:91], v[212:215]
    v_exp_f32 v210, v210
    v_mfma_f32_16x16x32_bf16 v[212:215], a[220:223], v[92:95], v[212:215]
    v_exp_f32 v211, v211
    v_mfma_f32_16x16x32_bf16 a[8:11], a[160:163], v[144:147], a[8:11]
    ds_read_b64_tr_b16 a[176:177], v22 offset:32768
    v_cvt_pk_bf16_f32 v160, v208, v209
    v_mfma_f32_16x16x32_bf16 a[8:11], a[164:167], v[148:151], a[8:11]
    ds_read_b64_tr_b16 a[178:179], v22 offset:36864
    v_mfma_f32_16x16x32_bf16 a[12:15], a[160:163], v[152:155], a[12:15]
    ds_read_b128 a[232:235], v10 offset:53248
    v_cvt_pk_bf16_f32 v161, v210, v211
    v_mfma_f32_16x16x32_bf16 a[12:15], a[164:167], v[156:159], a[12:15]
    s_waitcnt lgkmcnt(3)
    buffer_load_dwordx4 v39, s[8:11], s40 offen offset:3072 lds
    v_mfma_f32_16x16x32_bf16 v[208:211], a[208:211], v[96:99], v[200:203]
    v_exp_f32 v212, v212
    v_mfma_f32_16x16x32_bf16 v[208:211], a[212:215], v[100:103], v[208:211]
    s_add_u32 s40, s40, 16384
    v_exp_f32 v213, v213
    v_mfma_f32_16x16x32_bf16 v[208:211], a[216:219], v[104:107], v[208:211]
    v_exp_f32 v214, v214
    v_mfma_f32_16x16x32_bf16 v[208:211], a[220:223], v[108:111], v[208:211]
    v_exp_f32 v215, v215
    v_mfma_f32_16x16x32_bf16 a[16:19], a[168:171], v[128:131], a[16:19]
    ds_read_b64_tr_b16 a[180:181], v22 offset:40960
    v_cvt_pk_bf16_f32 v168, v212, v213
    v_mfma_f32_16x16x32_bf16 a[16:19], a[172:175], v[132:135], a[16:19]
    ds_read_b64_tr_b16 a[182:183], v22 offset:45056
    v_mfma_f32_16x16x32_bf16 a[20:23], a[168:171], v[136:139], a[20:23]
    ds_read_b128 a[236:239], v11 offset:53248
    v_cvt_pk_bf16_f32 v169, v214, v215
    v_mfma_f32_16x16x32_bf16 a[20:23], a[172:175], v[140:143], a[20:23]
    v_smfmac_f32_16x16x64_bf16 a[192:195], v[52:55], v[128:135], v50
    v_mfma_f32_16x16x32_bf16 v[212:215], a[208:211], v[112:115], v[204:207]
    v_exp_f32 v208, v208
    v_mfma_f32_16x16x32_bf16 v[212:215], a[212:215], v[116:119], v[212:215]
    s_add_u32 m0, s42, 65536
    v_exp_f32 v209, v209
    v_mfma_f32_16x16x32_bf16 v[212:215], a[216:219], v[120:123], v[212:215]
    v_exp_f32 v210, v210
    v_mfma_f32_16x16x32_bf16 v[212:215], a[220:223], v[124:127], v[212:215]
    v_exp_f32 v211, v211
    v_mfma_f32_16x16x32_bf16 a[24:27], a[168:171], v[144:147], a[24:27]
    ds_read_b64_tr_b16 a[184:185], v23 offset:32768
    v_cvt_pk_bf16_f32 v176, v208, v209
    v_mfma_f32_16x16x32_bf16 a[24:27], a[172:175], v[148:151], a[24:27]
    ds_read_b64_tr_b16 a[186:187], v23 offset:36864
    v_mfma_f32_16x16x32_bf16 a[28:31], a[168:171], v[152:155], a[28:31]
    ds_read_b128 a[208:211], v8 offset:57344
    v_cvt_pk_bf16_f32 v177, v210, v211
    v_mfma_f32_16x16x32_bf16 a[28:31], a[172:175], v[156:159], a[28:31]
    s_waitcnt lgkmcnt(3)
    buffer_load_dwordx4 v40, s[12:15], s41 offen lds
    v_mfma_f32_16x16x32_bf16 v[208:211], a[224:227], v[64:67], v[192:195]
    v_exp_f32 v212, v212
    v_mfma_f32_16x16x32_bf16 v[208:211], a[228:231], v[68:71], v[208:211]
    v_exp_f32 v213, v213
    v_mfma_f32_16x16x32_bf16 v[208:211], a[232:235], v[72:75], v[208:211]
    v_exp_f32 v214, v214
    v_mfma_f32_16x16x32_bf16 v[208:211], a[236:239], v[76:79], v[208:211]
    v_exp_f32 v215, v215
    v_mfma_f32_16x16x32_bf16 a[32:35], a[176:179], v[128:131], a[32:35]
    ds_read_b64_tr_b16 a[188:189], v23 offset:40960
    v_cvt_pk_bf16_f32 v184, v212, v213
    v_mfma_f32_16x16x32_bf16 a[32:35], a[180:183], v[132:135], a[32:35]
    ds_read_b64_tr_b16 a[190:191], v23 offset:45056
    v_mfma_f32_16x16x32_bf16 a[36:39], a[176:179], v[136:139], a[36:39]
    ds_read_b128 a[212:215], v9 offset:57344
    v_cvt_pk_bf16_f32 v185, v214, v215
    v_mfma_f32_16x16x32_bf16 a[36:39], a[180:183], v[140:143], a[36:39]
    v_smfmac_f32_16x16x64_bf16 a[196:199], v[52:55], v[136:143], v50
    v_mfma_f32_16x16x32_bf16 v[212:215], a[224:227], v[80:83], v[196:199]
    v_exp_f32 v208, v208
    v_mfma_f32_16x16x32_bf16 v[212:215], a[228:231], v[84:87], v[212:215]
    v_exp_f32 v209, v209
    v_mfma_f32_16x16x32_bf16 v[212:215], a[232:235], v[88:91], v[212:215]
    v_exp_f32 v210, v210
    v_mfma_f32_16x16x32_bf16 v[212:215], a[236:239], v[92:95], v[212:215]
    v_exp_f32 v211, v211
    v_mfma_f32_16x16x32_bf16 a[40:43], a[176:179], v[144:147], a[40:43]
    ds_read_b64_tr_b16 a[160:161], v24 offset:32768
    v_cvt_pk_bf16_f32 v162, v208, v209
    v_mfma_f32_16x16x32_bf16 a[40:43], a[180:183], v[148:151], a[40:43]
    ds_read_b64_tr_b16 a[162:163], v24 offset:36864
    v_mfma_f32_16x16x32_bf16 a[44:47], a[176:179], v[152:155], a[44:47]
    ds_read_b128 a[216:219], v10 offset:57344
    v_cvt_pk_bf16_f32 v163, v210, v211
    v_mfma_f32_16x16x32_bf16 a[44:47], a[180:183], v[156:159], a[44:47]
    s_waitcnt lgkmcnt(3)
    buffer_load_dwordx4 v41, s[12:15], s41 offen offset:1024 lds
    v_mfma_f32_16x16x32_bf16 v[208:211], a[224:227], v[96:99], v[200:203]
    v_exp_f32 v212, v212
    v_mfma_f32_16x16x32_bf16 v[208:211], a[228:231], v[100:103], v[208:211]
    v_exp_f32 v213, v213
    v_mfma_f32_16x16x32_bf16 v[208:211], a[232:235], v[104:107], v[208:211]
    v_exp_f32 v214, v214
    v_mfma_f32_16x16x32_bf16 v[208:211], a[236:239], v[108:111], v[208:211]
    v_exp_f32 v215, v215
    v_mfma_f32_16x16x32_bf16 a[48:51], a[184:187], v[128:131], a[48:51]
    ds_read_b64_tr_b16 a[164:165], v24 offset:40960
    v_cvt_pk_bf16_f32 v170, v212, v213
    v_mfma_f32_16x16x32_bf16 a[48:51], a[188:191], v[132:135], a[48:51]
    ds_read_b64_tr_b16 a[166:167], v24 offset:45056
    v_mfma_f32_16x16x32_bf16 a[52:55], a[184:187], v[136:139], a[52:55]
    ds_read_b128 a[220:223], v11 offset:57344
    v_cvt_pk_bf16_f32 v171, v214, v215
    v_mfma_f32_16x16x32_bf16 a[52:55], a[188:191], v[140:143], a[52:55]
    v_smfmac_f32_16x16x64_bf16 a[200:203], v[52:55], v[144:151], v50
    v_mfma_f32_16x16x32_bf16 v[212:215], a[224:227], v[112:115], v[204:207]
    v_exp_f32 v208, v208
    v_mfma_f32_16x16x32_bf16 v[212:215], a[228:231], v[116:119], v[212:215]
    v_exp_f32 v209, v209
    v_mfma_f32_16x16x32_bf16 v[212:215], a[232:235], v[120:123], v[212:215]
    v_exp_f32 v210, v210
    v_mfma_f32_16x16x32_bf16 v[212:215], a[236:239], v[124:127], v[212:215]
    v_exp_f32 v211, v211
    v_mfma_f32_16x16x32_bf16 a[56:59], a[184:187], v[144:147], a[56:59]
    ds_read_b64_tr_b16 a[168:169], v25 offset:32768
    v_cvt_pk_bf16_f32 v178, v208, v209
    v_mfma_f32_16x16x32_bf16 a[56:59], a[188:191], v[148:151], a[56:59]
    ds_read_b64_tr_b16 a[170:171], v25 offset:36864
    v_mfma_f32_16x16x32_bf16 a[60:63], a[184:187], v[152:155], a[60:63]
    ds_read_b128 a[224:227], v8 offset:61440
    v_cvt_pk_bf16_f32 v179, v210, v211
    v_mfma_f32_16x16x32_bf16 a[60:63], a[188:191], v[156:159], a[60:63]
    s_waitcnt lgkmcnt(3)
    buffer_load_dwordx4 v40, s[12:15], s41 offen offset:2048 lds
    v_mfma_f32_16x16x32_bf16 v[208:211], a[208:211], v[64:67], v[192:195]
    v_exp_f32 v212, v212
    v_mfma_f32_16x16x32_bf16 v[208:211], a[212:215], v[68:71], v[208:211]
    v_exp_f32 v213, v213
    v_mfma_f32_16x16x32_bf16 v[208:211], a[216:219], v[72:75], v[208:211]
    v_exp_f32 v214, v214
    v_mfma_f32_16x16x32_bf16 v[208:211], a[220:223], v[76:79], v[208:211]
    v_exp_f32 v215, v215
    v_mfma_f32_16x16x32_bf16 a[64:67], a[160:163], v[128:131], a[64:67]
    ds_read_b64_tr_b16 a[172:173], v25 offset:40960
    v_cvt_pk_bf16_f32 v186, v212, v213
    v_mfma_f32_16x16x32_bf16 a[64:67], a[164:167], v[132:135], a[64:67]
    ds_read_b64_tr_b16 a[174:175], v25 offset:45056
    v_mfma_f32_16x16x32_bf16 a[68:71], a[160:163], v[136:139], a[68:71]
    ds_read_b128 a[228:231], v9 offset:61440
    v_cvt_pk_bf16_f32 v187, v214, v215
    v_mfma_f32_16x16x32_bf16 a[68:71], a[164:167], v[140:143], a[68:71]
    v_smfmac_f32_16x16x64_bf16 a[204:207], v[52:55], v[152:159], v50
    v_mfma_f32_16x16x32_bf16 v[212:215], a[208:211], v[80:83], v[196:199]
    v_exp_f32 v208, v208
    v_mfma_f32_16x16x32_bf16 v[212:215], a[212:215], v[84:87], v[212:215]
    v_exp_f32 v209, v209
    v_mfma_f32_16x16x32_bf16 v[212:215], a[216:219], v[88:91], v[212:215]
    v_exp_f32 v210, v210
    v_mfma_f32_16x16x32_bf16 v[212:215], a[220:223], v[92:95], v[212:215]
    v_exp_f32 v211, v211
    v_mfma_f32_16x16x32_bf16 a[72:75], a[160:163], v[144:147], a[72:75]
    ds_read_b64_tr_b16 a[176:177], v26 offset:32768
    v_cvt_pk_bf16_f32 v164, v208, v209
    v_mfma_f32_16x16x32_bf16 a[72:75], a[164:167], v[148:151], a[72:75]
    ds_read_b64_tr_b16 a[178:179], v26 offset:36864
    v_mfma_f32_16x16x32_bf16 a[76:79], a[160:163], v[152:155], a[76:79]
    ds_read_b128 a[232:235], v10 offset:61440
    v_cvt_pk_bf16_f32 v165, v210, v211
    v_mfma_f32_16x16x32_bf16 a[76:79], a[164:167], v[156:159], a[76:79]
    s_waitcnt lgkmcnt(3)
    buffer_load_dwordx4 v41, s[12:15], s41 offen offset:3072 lds
    v_mfma_f32_16x16x32_bf16 v[208:211], a[208:211], v[96:99], v[200:203]
    v_exp_f32 v212, v212
    v_mfma_f32_16x16x32_bf16 v[208:211], a[212:215], v[100:103], v[208:211]
    s_add_u32 s41, s41, 16384
    v_exp_f32 v213, v213
    v_mfma_f32_16x16x32_bf16 v[208:211], a[216:219], v[104:107], v[208:211]
    v_exp_f32 v214, v214
    v_mfma_f32_16x16x32_bf16 v[208:211], a[220:223], v[108:111], v[208:211]
    v_exp_f32 v215, v215
    v_mfma_f32_16x16x32_bf16 a[80:83], a[168:171], v[128:131], a[80:83]
    ds_read_b64_tr_b16 a[180:181], v26 offset:40960
    v_cvt_pk_bf16_f32 v172, v212, v213
    v_mfma_f32_16x16x32_bf16 a[80:83], a[172:175], v[132:135], a[80:83]
    ds_read_b64_tr_b16 a[182:183], v26 offset:45056
    v_mfma_f32_16x16x32_bf16 a[84:87], a[168:171], v[136:139], a[84:87]
    ds_read_b128 a[236:239], v11 offset:61440
    v_cvt_pk_bf16_f32 v173, v214, v215
    v_mfma_f32_16x16x32_bf16 a[84:87], a[172:175], v[140:143], a[84:87]
    s_waitcnt vmcnt(8)
    s_barrier
    v_mfma_f32_16x16x32_bf16 v[212:215], a[208:211], v[112:115], v[204:207]
    v_exp_f32 v208, v208
    v_mfma_f32_16x16x32_bf16 v[212:215], a[212:215], v[116:119], v[212:215]
    s_add_u32 m0, s42, 32768
    v_exp_f32 v209, v209
    v_mfma_f32_16x16x32_bf16 v[212:215], a[216:219], v[120:123], v[212:215]
    v_exp_f32 v210, v210
    v_mfma_f32_16x16x32_bf16 v[212:215], a[220:223], v[124:127], v[212:215]
    v_exp_f32 v211, v211
    v_mfma_f32_16x16x32_bf16 a[88:91], a[168:171], v[144:147], a[88:91]
    ds_read_b64_tr_b16 a[184:185], v27 offset:32768
    v_cvt_pk_bf16_f32 v180, v208, v209
    v_mfma_f32_16x16x32_bf16 a[88:91], a[172:175], v[148:151], a[88:91]
    ds_read_b64_tr_b16 a[186:187], v27 offset:36864
    v_mfma_f32_16x16x32_bf16 a[92:95], a[168:171], v[152:155], a[92:95]
    ds_read_b128 a[208:211], v8 offset:0
    v_cvt_pk_bf16_f32 v181, v210, v211
    v_mfma_f32_16x16x32_bf16 a[92:95], a[172:175], v[156:159], a[92:95]
    s_waitcnt lgkmcnt(3)
    buffer_load_dwordx4 v36, s[8:11], s40 offen lds
    v_mfma_f32_16x16x32_bf16 v[208:211], a[224:227], v[64:67], v[192:195]
    v_exp_f32 v212, v212
    v_mfma_f32_16x16x32_bf16 v[208:211], a[228:231], v[68:71], v[208:211]
    v_exp_f32 v213, v213
    v_mfma_f32_16x16x32_bf16 v[208:211], a[232:235], v[72:75], v[208:211]
    v_exp_f32 v214, v214
    v_mfma_f32_16x16x32_bf16 v[208:211], a[236:239], v[76:79], v[208:211]
    v_exp_f32 v215, v215
    v_mfma_f32_16x16x32_bf16 a[96:99], a[176:179], v[128:131], a[96:99]
    ds_read_b64_tr_b16 a[188:189], v27 offset:40960
    v_cvt_pk_bf16_f32 v188, v212, v213
    v_mfma_f32_16x16x32_bf16 a[96:99], a[180:183], v[132:135], a[96:99]
    ds_read_b64_tr_b16 a[190:191], v27 offset:45056
    v_mfma_f32_16x16x32_bf16 a[100:103], a[176:179], v[136:139], a[100:103]
    ds_read_b128 a[212:215], v9 offset:0
    v_cvt_pk_bf16_f32 v189, v214, v215
    v_mfma_f32_16x16x32_bf16 a[100:103], a[180:183], v[140:143], a[100:103]
    v_mfma_f32_16x16x32_bf16 v[212:215], a[224:227], v[80:83], v[196:199]
    v_exp_f32 v208, v208
    v_mfma_f32_16x16x32_bf16 v[212:215], a[228:231], v[84:87], v[212:215]
    v_exp_f32 v209, v209
    v_mfma_f32_16x16x32_bf16 v[212:215], a[232:235], v[88:91], v[212:215]
    v_exp_f32 v210, v210
    v_mfma_f32_16x16x32_bf16 v[212:215], a[236:239], v[92:95], v[212:215]
    v_exp_f32 v211, v211
    v_mfma_f32_16x16x32_bf16 a[104:107], a[176:179], v[144:147], a[104:107]
    ds_read_b64_tr_b16 a[160:161], v20 offset:49152
    v_cvt_pk_bf16_f32 v166, v208, v209
    v_mfma_f32_16x16x32_bf16 a[104:107], a[180:183], v[148:151], a[104:107]
    ds_read_b64_tr_b16 a[162:163], v20 offset:53248
    v_mfma_f32_16x16x32_bf16 a[108:111], a[176:179], v[152:155], a[108:111]
    ds_read_b128 a[216:219], v10 offset:0
    v_cvt_pk_bf16_f32 v167, v210, v211
    v_mfma_f32_16x16x32_bf16 a[108:111], a[180:183], v[156:159], a[108:111]
    s_waitcnt lgkmcnt(3)
    buffer_load_dwordx4 v37, s[8:11], s40 offen offset:1024 lds
    v_mfma_f32_16x16x32_bf16 v[208:211], a[224:227], v[96:99], v[200:203]
    v_exp_f32 v212, v212
    v_mfma_f32_16x16x32_bf16 v[208:211], a[228:231], v[100:103], v[208:211]
    v_exp_f32 v213, v213
    v_mfma_f32_16x16x32_bf16 v[208:211], a[232:235], v[104:107], v[208:211]
    v_exp_f32 v214, v214
    v_mfma_f32_16x16x32_bf16 v[208:211], a[236:239], v[108:111], v[208:211]
    v_exp_f32 v215, v215
    v_mfma_f32_16x16x32_bf16 a[112:115], a[184:187], v[128:131], a[112:115]
    ds_read_b64_tr_b16 a[164:165], v20 offset:57344
    v_cvt_pk_bf16_f32 v174, v212, v213
    v_mfma_f32_16x16x32_bf16 a[112:115], a[188:191], v[132:135], a[112:115]
    ds_read_b64_tr_b16 a[166:167], v20 offset:61440
    v_mfma_f32_16x16x32_bf16 a[116:119], a[184:187], v[136:139], a[116:119]
    ds_read_b128 a[220:223], v11 offset:0
    v_cvt_pk_bf16_f32 v175, v214, v215
    v_mfma_f32_16x16x32_bf16 a[116:119], a[188:191], v[140:143], a[116:119]
    v_mfma_f32_16x16x32_bf16 v[212:215], a[224:227], v[112:115], v[204:207]
    v_exp_f32 v208, v208
    v_mfma_f32_16x16x32_bf16 v[212:215], a[228:231], v[116:119], v[212:215]
    v_exp_f32 v209, v209
    v_mfma_f32_16x16x32_bf16 v[212:215], a[232:235], v[120:123], v[212:215]
    v_exp_f32 v210, v210
    v_mfma_f32_16x16x32_bf16 v[212:215], a[236:239], v[124:127], v[212:215]
    v_exp_f32 v211, v211
    v_mfma_f32_16x16x32_bf16 a[120:123], a[184:187], v[144:147], a[120:123]
    ds_read_b64_tr_b16 a[168:169], v21 offset:49152
    v_cvt_pk_bf16_f32 v182, v208, v209
    v_mfma_f32_16x16x32_bf16 a[120:123], a[188:191], v[148:151], a[120:123]
    ds_read_b64_tr_b16 a[170:171], v21 offset:53248
    v_mfma_f32_16x16x32_bf16 a[124:127], a[184:187], v[152:155], a[124:127]
    ds_read_b128 a[224:227], v8 offset:4096
    v_cvt_pk_bf16_f32 v183, v210, v211
    v_mfma_f32_16x16x32_bf16 a[124:127], a[188:191], v[156:159], a[124:127]
    s_waitcnt lgkmcnt(3)
    buffer_load_dwordx4 v38, s[8:11], s40 offen offset:2048 lds
    v_mfma_f32_16x16x32_bf16 v[208:211], a[208:211], v[64:67], v[192:195]
    v_exp_f32 v212, v212
    v_mfma_f32_16x16x32_bf16 v[208:211], a[212:215], v[68:71], v[208:211]
    v_exp_f32 v213, v213
    v_mfma_f32_16x16x32_bf16 v[208:211], a[216:219], v[72:75], v[208:211]
    v_exp_f32 v214, v214
    v_mfma_f32_16x16x32_bf16 v[208:211], a[220:223], v[76:79], v[208:211]
    v_exp_f32 v215, v215
    v_mfma_f32_16x16x32_bf16 a[0:3], a[160:163], v[160:163], a[0:3]
    ds_read_b64_tr_b16 a[172:173], v21 offset:57344
    v_cvt_pk_bf16_f32 v190, v212, v213
    v_mfma_f32_16x16x32_bf16 a[0:3], a[164:167], v[164:167], a[0:3]
    ds_read_b64_tr_b16 a[174:175], v21 offset:61440
    v_mfma_f32_16x16x32_bf16 a[4:7], a[160:163], v[168:171], a[4:7]
    ds_read_b128 a[228:231], v9 offset:4096
    v_cvt_pk_bf16_f32 v191, v214, v215
    v_mfma_f32_16x16x32_bf16 a[4:7], a[164:167], v[172:175], a[4:7]
    v_mfma_f32_16x16x32_bf16 v[212:215], a[208:211], v[80:83], v[196:199]
    v_exp_f32 v208, v208
    v_mfma_f32_16x16x32_bf16 v[212:215], a[212:215], v[84:87], v[212:215]
    v_exp_f32 v209, v209
    v_mfma_f32_16x16x32_bf16 v[212:215], a[216:219], v[88:91], v[212:215]
    v_exp_f32 v210, v210
    v_mfma_f32_16x16x32_bf16 v[212:215], a[220:223], v[92:95], v[212:215]
    v_exp_f32 v211, v211
    v_mfma_f32_16x16x32_bf16 a[8:11], a[160:163], v[176:179], a[8:11]
    ds_read_b64_tr_b16 a[176:177], v22 offset:49152
    v_cvt_pk_bf16_f32 v128, v208, v209
    v_mfma_f32_16x16x32_bf16 a[8:11], a[164:167], v[180:183], a[8:11]
    ds_read_b64_tr_b16 a[178:179], v22 offset:53248
    v_mfma_f32_16x16x32_bf16 a[12:15], a[160:163], v[184:187], a[12:15]
    ds_read_b128 a[232:235], v10 offset:4096
    v_cvt_pk_bf16_f32 v129, v210, v211
    v_mfma_f32_16x16x32_bf16 a[12:15], a[164:167], v[188:191], a[12:15]
    s_waitcnt lgkmcnt(3)
    buffer_load_dwordx4 v39, s[8:11], s40 offen offset:3072 lds
    v_mfma_f32_16x16x32_bf16 v[208:211], a[208:211], v[96:99], v[200:203]
    v_exp_f32 v212, v212
    v_mfma_f32_16x16x32_bf16 v[208:211], a[212:215], v[100:103], v[208:211]
    s_add_u32 s40, s40, 16384
    v_exp_f32 v213, v213
    v_mfma_f32_16x16x32_bf16 v[208:211], a[216:219], v[104:107], v[208:211]
    v_exp_f32 v214, v214
    v_mfma_f32_16x16x32_bf16 v[208:211], a[220:223], v[108:111], v[208:211]
    v_exp_f32 v215, v215
    v_mfma_f32_16x16x32_bf16 a[16:19], a[168:171], v[160:163], a[16:19]
    ds_read_b64_tr_b16 a[180:181], v22 offset:57344
    v_cvt_pk_bf16_f32 v136, v212, v213
    v_mfma_f32_16x16x32_bf16 a[16:19], a[172:175], v[164:167], a[16:19]
    ds_read_b64_tr_b16 a[182:183], v22 offset:61440
    v_mfma_f32_16x16x32_bf16 a[20:23], a[168:171], v[168:171], a[20:23]
    ds_read_b128 a[236:239], v11 offset:4096
    v_cvt_pk_bf16_f32 v137, v214, v215
    v_mfma_f32_16x16x32_bf16 a[20:23], a[172:175], v[172:175], a[20:23]
    v_smfmac_f32_16x16x64_bf16 a[192:195], v[52:55], v[160:167], v50
    v_mfma_f32_16x16x32_bf16 v[212:215], a[208:211], v[112:115], v[204:207]
    v_exp_f32 v208, v208
    v_mfma_f32_16x16x32_bf16 v[212:215], a[212:215], v[116:119], v[212:215]
    s_add_u32 m0, s42, 81920
    v_exp_f32 v209, v209
    v_mfma_f32_16x16x32_bf16 v[212:215], a[216:219], v[120:123], v[212:215]
    v_exp_f32 v210, v210
    v_mfma_f32_16x16x32_bf16 v[212:215], a[220:223], v[124:127], v[212:215]
    v_exp_f32 v211, v211
    v_mfma_f32_16x16x32_bf16 a[24:27], a[168:171], v[176:179], a[24:27]
    ds_read_b64_tr_b16 a[184:185], v23 offset:49152
    v_cvt_pk_bf16_f32 v144, v208, v209
    v_mfma_f32_16x16x32_bf16 a[24:27], a[172:175], v[180:183], a[24:27]
    ds_read_b64_tr_b16 a[186:187], v23 offset:53248
    v_mfma_f32_16x16x32_bf16 a[28:31], a[168:171], v[184:187], a[28:31]
    ds_read_b128 a[208:211], v8 offset:8192
    v_cvt_pk_bf16_f32 v145, v210, v211
    v_mfma_f32_16x16x32_bf16 a[28:31], a[172:175], v[188:191], a[28:31]
    s_waitcnt lgkmcnt(3)
    buffer_load_dwordx4 v40, s[12:15], s41 offen lds
    v_mfma_f32_16x16x32_bf16 v[208:211], a[224:227], v[64:67], v[192:195]
    v_exp_f32 v212, v212
    v_mfma_f32_16x16x32_bf16 v[208:211], a[228:231], v[68:71], v[208:211]
    v_exp_f32 v213, v213
    v_mfma_f32_16x16x32_bf16 v[208:211], a[232:235], v[72:75], v[208:211]
    v_exp_f32 v214, v214
    v_mfma_f32_16x16x32_bf16 v[208:211], a[236:239], v[76:79], v[208:211]
    v_exp_f32 v215, v215
    v_mfma_f32_16x16x32_bf16 a[32:35], a[176:179], v[160:163], a[32:35]
    ds_read_b64_tr_b16 a[188:189], v23 offset:57344
    v_cvt_pk_bf16_f32 v152, v212, v213
    v_mfma_f32_16x16x32_bf16 a[32:35], a[180:183], v[164:167], a[32:35]
    ds_read_b64_tr_b16 a[190:191], v23 offset:61440
    v_mfma_f32_16x16x32_bf16 a[36:39], a[176:179], v[168:171], a[36:39]
    ds_read_b128 a[212:215], v9 offset:8192
    v_cvt_pk_bf16_f32 v153, v214, v215
    v_mfma_f32_16x16x32_bf16 a[36:39], a[180:183], v[172:175], a[36:39]
    v_smfmac_f32_16x16x64_bf16 a[196:199], v[52:55], v[168:175], v50
    v_mfma_f32_16x16x32_bf16 v[212:215], a[224:227], v[80:83], v[196:199]
    v_exp_f32 v208, v208
    v_mfma_f32_16x16x32_bf16 v[212:215], a[228:231], v[84:87], v[212:215]
    v_exp_f32 v209, v209
    v_mfma_f32_16x16x32_bf16 v[212:215], a[232:235], v[88:91], v[212:215]
    v_exp_f32 v210, v210
    v_mfma_f32_16x16x32_bf16 v[212:215], a[236:239], v[92:95], v[212:215]
    v_exp_f32 v211, v211
    v_mfma_f32_16x16x32_bf16 a[40:43], a[176:179], v[176:179], a[40:43]
    ds_read_b64_tr_b16 a[160:161], v24 offset:49152
    v_cvt_pk_bf16_f32 v130, v208, v209
    v_mfma_f32_16x16x32_bf16 a[40:43], a[180:183], v[180:183], a[40:43]
    ds_read_b64_tr_b16 a[162:163], v24 offset:53248
    v_mfma_f32_16x16x32_bf16 a[44:47], a[176:179], v[184:187], a[44:47]
    ds_read_b128 a[216:219], v10 offset:8192
    v_cvt_pk_bf16_f32 v131, v210, v211
    v_mfma_f32_16x16x32_bf16 a[44:47], a[180:183], v[188:191], a[44:47]
    s_waitcnt lgkmcnt(3)
    buffer_load_dwordx4 v41, s[12:15], s41 offen offset:1024 lds
    v_mfma_f32_16x16x32_bf16 v[208:211], a[224:227], v[96:99], v[200:203]
    v_exp_f32 v212, v212
    v_mfma_f32_16x16x32_bf16 v[208:211], a[228:231], v[100:103], v[208:211]
    v_exp_f32 v213, v213
    v_mfma_f32_16x16x32_bf16 v[208:211], a[232:235], v[104:107], v[208:211]
    v_exp_f32 v214, v214
    v_mfma_f32_16x16x32_bf16 v[208:211], a[236:239], v[108:111], v[208:211]
    v_exp_f32 v215, v215
    v_mfma_f32_16x16x32_bf16 a[48:51], a[184:187], v[160:163], a[48:51]
    ds_read_b64_tr_b16 a[164:165], v24 offset:57344
    v_cvt_pk_bf16_f32 v138, v212, v213
    v_mfma_f32_16x16x32_bf16 a[48:51], a[188:191], v[164:167], a[48:51]
    ds_read_b64_tr_b16 a[166:167], v24 offset:61440
    v_mfma_f32_16x16x32_bf16 a[52:55], a[184:187], v[168:171], a[52:55]
    ds_read_b128 a[220:223], v11 offset:8192
    v_cvt_pk_bf16_f32 v139, v214, v215
    v_mfma_f32_16x16x32_bf16 a[52:55], a[188:191], v[172:175], a[52:55]
    v_smfmac_f32_16x16x64_bf16 a[200:203], v[52:55], v[176:183], v50
    v_mfma_f32_16x16x32_bf16 v[212:215], a[224:227], v[112:115], v[204:207]
    v_exp_f32 v208, v208
    v_mfma_f32_16x16x32_bf16 v[212:215], a[228:231], v[116:119], v[212:215]
    v_exp_f32 v209, v209
    v_mfma_f32_16x16x32_bf16 v[212:215], a[232:235], v[120:123], v[212:215]
    v_exp_f32 v210, v210
    v_mfma_f32_16x16x32_bf16 v[212:215], a[236:239], v[124:127], v[212:215]
    v_exp_f32 v211, v211
    v_mfma_f32_16x16x32_bf16 a[56:59], a[184:187], v[176:179], a[56:59]
    ds_read_b64_tr_b16 a[168:169], v25 offset:49152
    v_cvt_pk_bf16_f32 v146, v208, v209
    v_mfma_f32_16x16x32_bf16 a[56:59], a[188:191], v[180:183], a[56:59]
    ds_read_b64_tr_b16 a[170:171], v25 offset:53248
    v_mfma_f32_16x16x32_bf16 a[60:63], a[184:187], v[184:187], a[60:63]
    ds_read_b128 a[224:227], v8 offset:12288
    v_cvt_pk_bf16_f32 v147, v210, v211
    v_mfma_f32_16x16x32_bf16 a[60:63], a[188:191], v[188:191], a[60:63]
    s_waitcnt lgkmcnt(3)
    buffer_load_dwordx4 v40, s[12:15], s41 offen offset:2048 lds
    v_mfma_f32_16x16x32_bf16 v[208:211], a[208:211], v[64:67], v[192:195]
    v_exp_f32 v212, v212
    v_mfma_f32_16x16x32_bf16 v[208:211], a[212:215], v[68:71], v[208:211]
    v_exp_f32 v213, v213
    v_mfma_f32_16x16x32_bf16 v[208:211], a[216:219], v[72:75], v[208:211]
    v_exp_f32 v214, v214
    v_mfma_f32_16x16x32_bf16 v[208:211], a[220:223], v[76:79], v[208:211]
    v_exp_f32 v215, v215
    v_mfma_f32_16x16x32_bf16 a[64:67], a[160:163], v[160:163], a[64:67]
    ds_read_b64_tr_b16 a[172:173], v25 offset:57344
    v_cvt_pk_bf16_f32 v154, v212, v213
    v_mfma_f32_16x16x32_bf16 a[64:67], a[164:167], v[164:167], a[64:67]
    ds_read_b64_tr_b16 a[174:175], v25 offset:61440
    v_mfma_f32_16x16x32_bf16 a[68:71], a[160:163], v[168:171], a[68:71]
    ds_read_b128 a[228:231], v9 offset:12288
    v_cvt_pk_bf16_f32 v155, v214, v215
    v_mfma_f32_16x16x32_bf16 a[68:71], a[164:167], v[172:175], a[68:71]
    v_smfmac_f32_16x16x64_bf16 a[204:207], v[52:55], v[184:191], v50
    v_mfma_f32_16x16x32_bf16 v[212:215], a[208:211], v[80:83], v[196:199]
    v_exp_f32 v208, v208
    v_mfma_f32_16x16x32_bf16 v[212:215], a[212:215], v[84:87], v[212:215]
    v_exp_f32 v209, v209
    v_mfma_f32_16x16x32_bf16 v[212:215], a[216:219], v[88:91], v[212:215]
    v_exp_f32 v210, v210
    v_mfma_f32_16x16x32_bf16 v[212:215], a[220:223], v[92:95], v[212:215]
    v_exp_f32 v211, v211
    v_mfma_f32_16x16x32_bf16 a[72:75], a[160:163], v[176:179], a[72:75]
    ds_read_b64_tr_b16 a[176:177], v26 offset:49152
    v_cvt_pk_bf16_f32 v132, v208, v209
    v_mfma_f32_16x16x32_bf16 a[72:75], a[164:167], v[180:183], a[72:75]
    ds_read_b64_tr_b16 a[178:179], v26 offset:53248
    v_mfma_f32_16x16x32_bf16 a[76:79], a[160:163], v[184:187], a[76:79]
    ds_read_b128 a[232:235], v10 offset:12288
    v_cvt_pk_bf16_f32 v133, v210, v211
    v_mfma_f32_16x16x32_bf16 a[76:79], a[164:167], v[188:191], a[76:79]
    s_waitcnt lgkmcnt(3)
    buffer_load_dwordx4 v41, s[12:15], s41 offen offset:3072 lds
    v_mfma_f32_16x16x32_bf16 v[208:211], a[208:211], v[96:99], v[200:203]
    v_exp_f32 v212, v212
    v_mfma_f32_16x16x32_bf16 v[208:211], a[212:215], v[100:103], v[208:211]
    s_add_u32 s41, s41, 16384
    v_exp_f32 v213, v213
    v_mfma_f32_16x16x32_bf16 v[208:211], a[216:219], v[104:107], v[208:211]
    v_exp_f32 v214, v214
    v_mfma_f32_16x16x32_bf16 v[208:211], a[220:223], v[108:111], v[208:211]
    v_exp_f32 v215, v215
    v_mfma_f32_16x16x32_bf16 a[80:83], a[168:171], v[160:163], a[80:83]
    ds_read_b64_tr_b16 a[180:181], v26 offset:57344
    v_cvt_pk_bf16_f32 v140, v212, v213
    v_mfma_f32_16x16x32_bf16 a[80:83], a[172:175], v[164:167], a[80:83]
    ds_read_b64_tr_b16 a[182:183], v26 offset:61440
    v_mfma_f32_16x16x32_bf16 a[84:87], a[168:171], v[168:171], a[84:87]
    ds_read_b128 a[236:239], v11 offset:12288
    v_cvt_pk_bf16_f32 v141, v214, v215
    v_mfma_f32_16x16x32_bf16 a[84:87], a[172:175], v[172:175], a[84:87]
    s_waitcnt vmcnt(8)
    s_barrier
    v_mfma_f32_16x16x32_bf16 v[212:215], a[208:211], v[112:115], v[204:207]
    v_exp_f32 v208, v208
    v_mfma_f32_16x16x32_bf16 v[212:215], a[212:215], v[116:119], v[212:215]
    s_add_u32 m0, s42, 49152
    v_exp_f32 v209, v209
    v_mfma_f32_16x16x32_bf16 v[212:215], a[216:219], v[120:123], v[212:215]
    v_exp_f32 v210, v210
    v_mfma_f32_16x16x32_bf16 v[212:215], a[220:223], v[124:127], v[212:215]
    v_exp_f32 v211, v211
    v_mfma_f32_16x16x32_bf16 a[88:91], a[168:171], v[176:179], a[88:91]
    ds_read_b64_tr_b16 a[184:185], v27 offset:49152
    v_cvt_pk_bf16_f32 v148, v208, v209
    v_mfma_f32_16x16x32_bf16 a[88:91], a[172:175], v[180:183], a[88:91]
    ds_read_b64_tr_b16 a[186:187], v27 offset:53248
    v_mfma_f32_16x16x32_bf16 a[92:95], a[168:171], v[184:187], a[92:95]
    ds_read_b128 a[208:211], v8 offset:16384
    v_cvt_pk_bf16_f32 v149, v210, v211
    v_mfma_f32_16x16x32_bf16 a[92:95], a[172:175], v[188:191], a[92:95]
    s_waitcnt lgkmcnt(3)
    buffer_load_dwordx4 v36, s[8:11], s40 offen lds
    v_mfma_f32_16x16x32_bf16 v[208:211], a[224:227], v[64:67], v[192:195]
    v_exp_f32 v212, v212
    v_mfma_f32_16x16x32_bf16 v[208:211], a[228:231], v[68:71], v[208:211]
    v_exp_f32 v213, v213
    v_mfma_f32_16x16x32_bf16 v[208:211], a[232:235], v[72:75], v[208:211]
    v_exp_f32 v214, v214
    v_mfma_f32_16x16x32_bf16 v[208:211], a[236:239], v[76:79], v[208:211]
    v_exp_f32 v215, v215
    v_mfma_f32_16x16x32_bf16 a[96:99], a[176:179], v[160:163], a[96:99]
    ds_read_b64_tr_b16 a[188:189], v27 offset:57344
    v_cvt_pk_bf16_f32 v156, v212, v213
    v_mfma_f32_16x16x32_bf16 a[96:99], a[180:183], v[164:167], a[96:99]
    ds_read_b64_tr_b16 a[190:191], v27 offset:61440
    v_mfma_f32_16x16x32_bf16 a[100:103], a[176:179], v[168:171], a[100:103]
    ds_read_b128 a[212:215], v9 offset:16384
    v_cvt_pk_bf16_f32 v157, v214, v215
    v_mfma_f32_16x16x32_bf16 a[100:103], a[180:183], v[172:175], a[100:103]
    v_mfma_f32_16x16x32_bf16 v[212:215], a[224:227], v[80:83], v[196:199]
    v_exp_f32 v208, v208
    v_mfma_f32_16x16x32_bf16 v[212:215], a[228:231], v[84:87], v[212:215]
    v_exp_f32 v209, v209
    v_mfma_f32_16x16x32_bf16 v[212:215], a[232:235], v[88:91], v[212:215]
    v_exp_f32 v210, v210
    v_mfma_f32_16x16x32_bf16 v[212:215], a[236:239], v[92:95], v[212:215]
    v_exp_f32 v211, v211
    v_mfma_f32_16x16x32_bf16 a[104:107], a[176:179], v[176:179], a[104:107]
    ds_read_b64_tr_b16 a[160:161], v20 offset:0
    v_cvt_pk_bf16_f32 v134, v208, v209
    v_mfma_f32_16x16x32_bf16 a[104:107], a[180:183], v[180:183], a[104:107]
    ds_read_b64_tr_b16 a[162:163], v20 offset:4096
    v_mfma_f32_16x16x32_bf16 a[108:111], a[176:179], v[184:187], a[108:111]
    ds_read_b128 a[216:219], v10 offset:16384
    v_cvt_pk_bf16_f32 v135, v210, v211
    v_mfma_f32_16x16x32_bf16 a[108:111], a[180:183], v[188:191], a[108:111]
    s_waitcnt lgkmcnt(3)
    buffer_load_dwordx4 v37, s[8:11], s40 offen offset:1024 lds
    v_mfma_f32_16x16x32_bf16 v[208:211], a[224:227], v[96:99], v[200:203]
    v_exp_f32 v212, v212
    v_mfma_f32_16x16x32_bf16 v[208:211], a[228:231], v[100:103], v[208:211]
    v_exp_f32 v213, v213
    v_mfma_f32_16x16x32_bf16 v[208:211], a[232:235], v[104:107], v[208:211]
    v_exp_f32 v214, v214
    v_mfma_f32_16x16x32_bf16 v[208:211], a[236:239], v[108:111], v[208:211]
    v_exp_f32 v215, v215
    v_mfma_f32_16x16x32_bf16 a[112:115], a[184:187], v[160:163], a[112:115]
    ds_read_b64_tr_b16 a[164:165], v20 offset:8192
    v_cvt_pk_bf16_f32 v142, v212, v213
    v_mfma_f32_16x16x32_bf16 a[112:115], a[188:191], v[164:167], a[112:115]
    ds_read_b64_tr_b16 a[166:167], v20 offset:12288
    v_mfma_f32_16x16x32_bf16 a[116:119], a[184:187], v[168:171], a[116:119]
    ds_read_b128 a[220:223], v11 offset:16384
    v_cvt_pk_bf16_f32 v143, v214, v215
    v_mfma_f32_16x16x32_bf16 a[116:119], a[188:191], v[172:175], a[116:119]
    v_mfma_f32_16x16x32_bf16 v[212:215], a[224:227], v[112:115], v[204:207]
    v_exp_f32 v208, v208
    v_mfma_f32_16x16x32_bf16 v[212:215], a[228:231], v[116:119], v[212:215]
    v_exp_f32 v209, v209
    v_mfma_f32_16x16x32_bf16 v[212:215], a[232:235], v[120:123], v[212:215]
    v_exp_f32 v210, v210
    v_mfma_f32_16x16x32_bf16 v[212:215], a[236:239], v[124:127], v[212:215]
    v_exp_f32 v211, v211
    v_mfma_f32_16x16x32_bf16 a[120:123], a[184:187], v[176:179], a[120:123]
    ds_read_b64_tr_b16 a[168:169], v21 offset:0
    v_cvt_pk_bf16_f32 v150, v208, v209
    v_mfma_f32_16x16x32_bf16 a[120:123], a[188:191], v[180:183], a[120:123]
    ds_read_b64_tr_b16 a[170:171], v21 offset:4096
    v_mfma_f32_16x16x32_bf16 a[124:127], a[184:187], v[184:187], a[124:127]
    ds_read_b128 a[224:227], v8 offset:20480
    v_cvt_pk_bf16_f32 v151, v210, v211
    v_mfma_f32_16x16x32_bf16 a[124:127], a[188:191], v[188:191], a[124:127]
    s_waitcnt lgkmcnt(3)
    buffer_load_dwordx4 v38, s[8:11], s40 offen offset:2048 lds
    s_sub_u32 s43, s43, 1
    s_cmp_lg_u32 s43, 0
    s_cbranch_scc1 Lattn_loop
    v_mfma_f32_16x16x32_bf16 v[208:211], a[208:211], v[64:67], v[192:195]
    v_exp_f32 v212, v212
    v_mfma_f32_16x16x32_bf16 v[208:211], a[212:215], v[68:71], v[208:211]
    v_exp_f32 v213, v213
    v_mfma_f32_16x16x32_bf16 v[208:211], a[216:219], v[72:75], v[208:211]
    v_exp_f32 v214, v214
    v_mfma_f32_16x16x32_bf16 v[208:211], a[220:223], v[76:79], v[208:211]
    v_exp_f32 v215, v215
    v_mfma_f32_16x16x32_bf16 a[0:3], a[160:163], v[128:131], a[0:3]
    ds_read_b64_tr_b16 a[172:173], v21 offset:8192
    v_cvt_pk_bf16_f32 v158, v212, v213
    v_mfma_f32_16x16x32_bf16 a[0:3], a[164:167], v[132:135], a[0:3]
    ds_read_b64_tr_b16 a[174:175], v21 offset:12288
    v_mfma_f32_16x16x32_bf16 a[4:7], a[160:163], v[136:139], a[4:7]
    ds_read_b128 a[228:231], v9 offset:20480
    v_cvt_pk_bf16_f32 v159, v214, v215
    v_mfma_f32_16x16x32_bf16 a[4:7], a[164:167], v[140:143], a[4:7]
    v_mfma_f32_16x16x32_bf16 v[212:215], a[208:211], v[80:83], v[196:199]
    v_exp_f32 v208, v208
    v_mfma_f32_16x16x32_bf16 v[212:215], a[212:215], v[84:87], v[212:215]
    v_exp_f32 v209, v209
    v_mfma_f32_16x16x32_bf16 v[212:215], a[216:219], v[88:91], v[212:215]
    v_exp_f32 v210, v210
    v_mfma_f32_16x16x32_bf16 v[212:215], a[220:223], v[92:95], v[212:215]
    v_exp_f32 v211, v211
    v_mfma_f32_16x16x32_bf16 a[8:11], a[160:163], v[144:147], a[8:11]
    ds_read_b64_tr_b16 a[176:177], v22 offset:0
    v_cvt_pk_bf16_f32 v160, v208, v209
    v_mfma_f32_16x16x32_bf16 a[8:11], a[164:167], v[148:151], a[8:11]
    ds_read_b64_tr_b16 a[178:179], v22 offset:4096
    v_mfma_f32_16x16x32_bf16 a[12:15], a[160:163], v[152:155], a[12:15]
    ds_read_b128 a[232:235], v10 offset:20480
    v_cvt_pk_bf16_f32 v161, v210, v211
    v_mfma_f32_16x16x32_bf16 a[12:15], a[164:167], v[156:159], a[12:15]
    s_waitcnt lgkmcnt(3)
    buffer_load_dwordx4 v39, s[8:11], s40 offen offset:3072 lds
    v_mfma_f32_16x16x32_bf16 v[208:211], a[208:211], v[96:99], v[200:203]
    v_exp_f32 v212, v212
    v_mfma_f32_16x16x32_bf16 v[208:211], a[212:215], v[100:103], v[208:211]
    s_add_u32 s40, s40, 16384
    v_exp_f32 v213, v213
    v_mfma_f32_16x16x32_bf16 v[208:211], a[216:219], v[104:107], v[208:211]
    v_exp_f32 v214, v214
    v_mfma_f32_16x16x32_bf16 v[208:211], a[220:223], v[108:111], v[208:211]
    v_exp_f32 v215, v215
    v_mfma_f32_16x16x32_bf16 a[16:19], a[168:171], v[128:131], a[16:19]
    ds_read_b64_tr_b16 a[180:181], v22 offset:8192
    v_cvt_pk_bf16_f32 v168, v212, v213
    v_mfma_f32_16x16x32_bf16 a[16:19], a[172:175], v[132:135], a[16:19]
    ds_read_b64_tr_b16 a[182:183], v22 offset:12288
    v_mfma_f32_16x16x32_bf16 a[20:23], a[168:171], v[136:139], a[20:23]
    ds_read_b128 a[236:239], v11 offset:20480
    v_cvt_pk_bf16_f32 v169, v214, v215
    v_mfma_f32_16x16x32_bf16 a[20:23], a[172:175], v[140:143], a[20:23]
    v_smfmac_f32_16x16x64_bf16 a[192:195], v[52:55], v[128:135], v50
    v_mfma_f32_16x16x32_bf16 v[212:215], a[208:211], v[112:115], v[204:207]
    v_exp_f32 v208, v208
    v_mfma_f32_16x16x32_bf16 v[212:215], a[212:215], v[116:119], v[212:215]
    s_add_u32 m0, s42, 98304
    v_exp_f32 v209, v209
    v_mfma_f32_16x16x32_bf16 v[212:215], a[216:219], v[120:123], v[212:215]
    v_exp_f32 v210, v210
    v_mfma_f32_16x16x32_bf16 v[212:215], a[220:223], v[124:127], v[212:215]
    v_exp_f32 v211, v211
    v_mfma_f32_16x16x32_bf16 a[24:27], a[168:171], v[144:147], a[24:27]
    ds_read_b64_tr_b16 a[184:185], v23 offset:0
    v_cvt_pk_bf16_f32 v176, v208, v209
    v_mfma_f32_16x16x32_bf16 a[24:27], a[172:175], v[148:151], a[24:27]
    ds_read_b64_tr_b16 a[186:187], v23 offset:4096
    v_mfma_f32_16x16x32_bf16 a[28:31], a[168:171], v[152:155], a[28:31]
    ds_read_b128 a[208:211], v8 offset:24576
    v_cvt_pk_bf16_f32 v177, v210, v211
    v_mfma_f32_16x16x32_bf16 a[28:31], a[172:175], v[156:159], a[28:31]
    s_waitcnt lgkmcnt(3)
    buffer_load_dwordx4 v40, s[12:15], s41 offen lds
    v_mfma_f32_16x16x32_bf16 v[208:211], a[224:227], v[64:67], v[192:195]
    v_exp_f32 v212, v212
    v_mfma_f32_16x16x32_bf16 v[208:211], a[228:231], v[68:71], v[208:211]
    v_exp_f32 v213, v213
    v_mfma_f32_16x16x32_bf16 v[208:211], a[232:235], v[72:75], v[208:211]
    v_exp_f32 v214, v214
    v_mfma_f32_16x16x32_bf16 v[208:211], a[236:239], v[76:79], v[208:211]
    v_exp_f32 v215, v215
    v_mfma_f32_16x16x32_bf16 a[32:35], a[176:179], v[128:131], a[32:35]
    ds_read_b64_tr_b16 a[188:189], v23 offset:8192
    v_cvt_pk_bf16_f32 v184, v212, v213
    v_mfma_f32_16x16x32_bf16 a[32:35], a[180:183], v[132:135], a[32:35]
    ds_read_b64_tr_b16 a[190:191], v23 offset:12288
    v_mfma_f32_16x16x32_bf16 a[36:39], a[176:179], v[136:139], a[36:39]
    ds_read_b128 a[212:215], v9 offset:24576
    v_cvt_pk_bf16_f32 v185, v214, v215
    v_mfma_f32_16x16x32_bf16 a[36:39], a[180:183], v[140:143], a[36:39]
    v_smfmac_f32_16x16x64_bf16 a[196:199], v[52:55], v[136:143], v50
    v_mfma_f32_16x16x32_bf16 v[212:215], a[224:227], v[80:83], v[196:199]
    v_exp_f32 v208, v208
    v_mfma_f32_16x16x32_bf16 v[212:215], a[228:231], v[84:87], v[212:215]
    v_exp_f32 v209, v209
    v_mfma_f32_16x16x32_bf16 v[212:215], a[232:235], v[88:91], v[212:215]
    v_exp_f32 v210, v210
    v_mfma_f32_16x16x32_bf16 v[212:215], a[236:239], v[92:95], v[212:215]
    v_exp_f32 v211, v211
    v_mfma_f32_16x16x32_bf16 a[40:43], a[176:179], v[144:147], a[40:43]
    ds_read_b64_tr_b16 a[160:161], v24 offset:0
    v_cvt_pk_bf16_f32 v162, v208, v209
    v_mfma_f32_16x16x32_bf16 a[40:43], a[180:183], v[148:151], a[40:43]
    ds_read_b64_tr_b16 a[162:163], v24 offset:4096
    v_mfma_f32_16x16x32_bf16 a[44:47], a[176:179], v[152:155], a[44:47]
    ds_read_b128 a[216:219], v10 offset:24576
    v_cvt_pk_bf16_f32 v163, v210, v211
    v_mfma_f32_16x16x32_bf16 a[44:47], a[180:183], v[156:159], a[44:47]
    s_waitcnt lgkmcnt(3)
    buffer_load_dwordx4 v41, s[12:15], s41 offen offset:1024 lds
    v_mfma_f32_16x16x32_bf16 v[208:211], a[224:227], v[96:99], v[200:203]
    v_exp_f32 v212, v212
    v_mfma_f32_16x16x32_bf16 v[208:211], a[228:231], v[100:103], v[208:211]
    v_exp_f32 v213, v213
    v_mfma_f32_16x16x32_bf16 v[208:211], a[232:235], v[104:107], v[208:211]
    v_exp_f32 v214, v214
    v_mfma_f32_16x16x32_bf16 v[208:211], a[236:239], v[108:111], v[208:211]
    v_exp_f32 v215, v215
    v_mfma_f32_16x16x32_bf16 a[48:51], a[184:187], v[128:131], a[48:51]
    ds_read_b64_tr_b16 a[164:165], v24 offset:8192
    v_cvt_pk_bf16_f32 v170, v212, v213
    v_mfma_f32_16x16x32_bf16 a[48:51], a[188:191], v[132:135], a[48:51]
    ds_read_b64_tr_b16 a[166:167], v24 offset:12288
    v_mfma_f32_16x16x32_bf16 a[52:55], a[184:187], v[136:139], a[52:55]
    ds_read_b128 a[220:223], v11 offset:24576
    v_cvt_pk_bf16_f32 v171, v214, v215
    v_mfma_f32_16x16x32_bf16 a[52:55], a[188:191], v[140:143], a[52:55]
    v_smfmac_f32_16x16x64_bf16 a[200:203], v[52:55], v[144:151], v50
    v_mfma_f32_16x16x32_bf16 v[212:215], a[224:227], v[112:115], v[204:207]
    v_exp_f32 v208, v208
    v_mfma_f32_16x16x32_bf16 v[212:215], a[228:231], v[116:119], v[212:215]
    v_exp_f32 v209, v209
    v_mfma_f32_16x16x32_bf16 v[212:215], a[232:235], v[120:123], v[212:215]
    v_exp_f32 v210, v210
    v_mfma_f32_16x16x32_bf16 v[212:215], a[236:239], v[124:127], v[212:215]
    v_exp_f32 v211, v211
    v_mfma_f32_16x16x32_bf16 a[56:59], a[184:187], v[144:147], a[56:59]
    ds_read_b64_tr_b16 a[168:169], v25 offset:0
    v_cvt_pk_bf16_f32 v178, v208, v209
    v_mfma_f32_16x16x32_bf16 a[56:59], a[188:191], v[148:151], a[56:59]
    ds_read_b64_tr_b16 a[170:171], v25 offset:4096
    v_mfma_f32_16x16x32_bf16 a[60:63], a[184:187], v[152:155], a[60:63]
    ds_read_b128 a[224:227], v8 offset:28672
    v_cvt_pk_bf16_f32 v179, v210, v211
    v_mfma_f32_16x16x32_bf16 a[60:63], a[188:191], v[156:159], a[60:63]
    s_waitcnt lgkmcnt(3)
    buffer_load_dwordx4 v40, s[12:15], s41 offen offset:2048 lds
    v_mfma_f32_16x16x32_bf16 v[208:211], a[208:211], v[64:67], v[192:195]
    v_exp_f32 v212, v212
    v_mfma_f32_16x16x32_bf16 v[208:211], a[212:215], v[68:71], v[208:211]
    v_exp_f32 v213, v213
    v_mfma_f32_16x16x32_bf16 v[208:211], a[216:219], v[72:75], v[208:211]
    v_exp_f32 v214, v214
    v_mfma_f32_16x16x32_bf16 v[208:211], a[220:223], v[76:79], v[208:211]
    v_exp_f32 v215, v215
    v_mfma_f32_16x16x32_bf16 a[64:67], a[160:163], v[128:131], a[64:67]
    ds_read_b64_tr_b16 a[172:173], v25 offset:8192
    v_cvt_pk_bf16_f32 v186, v212, v213
    v_mfma_f32_16x16x32_bf16 a[64:67], a[164:167], v[132:135], a[64:67]
    ds_read_b64_tr_b16 a[174:175], v25 offset:12288
    v_mfma_f32_16x16x32_bf16 a[68:71], a[160:163], v[136:139], a[68:71]
    ds_read_b128 a[228:231], v9 offset:28672
    v_cvt_pk_bf16_f32 v187, v214, v215
    v_mfma_f32_16x16x32_bf16 a[68:71], a[164:167], v[140:143], a[68:71]
    v_smfmac_f32_16x16x64_bf16 a[204:207], v[52:55], v[152:159], v50
    v_mfma_f32_16x16x32_bf16 v[212:215], a[208:211], v[80:83], v[196:199]
    v_exp_f32 v208, v208
    v_mfma_f32_16x16x32_bf16 v[212:215], a[212:215], v[84:87], v[212:215]
    v_exp_f32 v209, v209
    v_mfma_f32_16x16x32_bf16 v[212:215], a[216:219], v[88:91], v[212:215]
    v_exp_f32 v210, v210
    v_mfma_f32_16x16x32_bf16 v[212:215], a[220:223], v[92:95], v[212:215]
    v_exp_f32 v211, v211
    v_mfma_f32_16x16x32_bf16 a[72:75], a[160:163], v[144:147], a[72:75]
    ds_read_b64_tr_b16 a[176:177], v26 offset:0
    v_cvt_pk_bf16_f32 v164, v208, v209
    v_mfma_f32_16x16x32_bf16 a[72:75], a[164:167], v[148:151], a[72:75]
    ds_read_b64_tr_b16 a[178:179], v26 offset:4096
    v_mfma_f32_16x16x32_bf16 a[76:79], a[160:163], v[152:155], a[76:79]
    ds_read_b128 a[232:235], v10 offset:28672
    v_cvt_pk_bf16_f32 v165, v210, v211
    v_mfma_f32_16x16x32_bf16 a[76:79], a[164:167], v[156:159], a[76:79]
    s_waitcnt lgkmcnt(3)
    buffer_load_dwordx4 v41, s[12:15], s41 offen offset:3072 lds
    v_mfma_f32_16x16x32_bf16 v[208:211], a[208:211], v[96:99], v[200:203]
    v_exp_f32 v212, v212
    v_mfma_f32_16x16x32_bf16 v[208:211], a[212:215], v[100:103], v[208:211]
    s_add_u32 s41, s41, 16384
    v_exp_f32 v213, v213
    v_mfma_f32_16x16x32_bf16 v[208:211], a[216:219], v[104:107], v[208:211]
    v_exp_f32 v214, v214
    v_mfma_f32_16x16x32_bf16 v[208:211], a[220:223], v[108:111], v[208:211]
    v_exp_f32 v215, v215
    v_mfma_f32_16x16x32_bf16 a[80:83], a[168:171], v[128:131], a[80:83]
    ds_read_b64_tr_b16 a[180:181], v26 offset:8192
    v_cvt_pk_bf16_f32 v172, v212, v213
    v_mfma_f32_16x16x32_bf16 a[80:83], a[172:175], v[132:135], a[80:83]
    ds_read_b64_tr_b16 a[182:183], v26 offset:12288
    v_mfma_f32_16x16x32_bf16 a[84:87], a[168:171], v[136:139], a[84:87]
    ds_read_b128 a[236:239], v11 offset:28672
    v_cvt_pk_bf16_f32 v173, v214, v215
    v_mfma_f32_16x16x32_bf16 a[84:87], a[172:175], v[140:143], a[84:87]
    s_waitcnt vmcnt(8)
    s_barrier
    v_mfma_f32_16x16x32_bf16 v[212:215], a[208:211], v[112:115], v[204:207]
    v_exp_f32 v208, v208
    v_mfma_f32_16x16x32_bf16 v[212:215], a[212:215], v[116:119], v[212:215]
    s_add_u32 s49, s45, 0
    v_exp_f32 v209, v209
    v_mfma_f32_16x16x32_bf16 v[212:215], a[216:219], v[120:123], v[212:215]
    s_add_u32 m0, s42, 131072
    v_exp_f32 v210, v210
    v_mfma_f32_16x16x32_bf16 v[212:215], a[220:223], v[124:127], v[212:215]
    v_exp_f32 v211, v211
    v_mfma_f32_16x16x32_bf16 a[88:91], a[168:171], v[144:147], a[88:91]
    ds_read_b64_tr_b16 a[184:185], v27 offset:0
    v_cvt_pk_bf16_f32 v180, v208, v209
    v_mfma_f32_16x16x32_bf16 a[88:91], a[172:175], v[148:151], a[88:91]
    ds_read_b64_tr_b16 a[186:187], v27 offset:4096
    v_mfma_f32_16x16x32_bf16 a[92:95], a[168:171], v[152:155], a[92:95]
    ds_read_b128 a[208:211], v8 offset:32768
    v_cvt_pk_bf16_f32 v181, v210, v211
    v_mfma_f32_16x16x32_bf16 a[92:95], a[172:175], v[156:159], a[92:95]
    s_waitcnt lgkmcnt(3)
    buffer_load_dwordx4 v46, s[20:23], s49 offen lds
    v_mfma_f32_16x16x32_bf16 v[208:211], a[224:227], v[64:67], v[192:195]
    v_exp_f32 v212, v212
    v_mfma_f32_16x16x32_bf16 v[208:211], a[228:231], v[68:71], v[208:211]
    v_exp_f32 v213, v213
    v_mfma_f32_16x16x32_bf16 v[208:211], a[232:235], v[72:75], v[208:211]
    v_exp_f32 v214, v214
    v_mfma_f32_16x16x32_bf16 v[208:211], a[236:239], v[76:79], v[208:211]
    v_exp_f32 v215, v215
    v_mfma_f32_16x16x32_bf16 a[96:99], a[176:179], v[128:131], a[96:99]
    ds_read_b64_tr_b16 a[188:189], v27 offset:8192
    v_cvt_pk_bf16_f32 v188, v212, v213
    v_mfma_f32_16x16x32_bf16 a[96:99], a[180:183], v[132:135], a[96:99]
    ds_read_b64_tr_b16 a[190:191], v27 offset:12288
    v_mfma_f32_16x16x32_bf16 a[100:103], a[176:179], v[136:139], a[100:103]
    ds_read_b128 a[212:215], v9 offset:32768
    v_cvt_pk_bf16_f32 v189, v214, v215
    v_mfma_f32_16x16x32_bf16 a[100:103], a[180:183], v[140:143], a[100:103]
    v_mfma_f32_16x16x32_bf16 v[212:215], a[224:227], v[80:83], v[196:199]
    v_exp_f32 v208, v208
    v_mfma_f32_16x16x32_bf16 v[212:215], a[228:231], v[84:87], v[212:215]
    v_exp_f32 v209, v209
    v_mfma_f32_16x16x32_bf16 v[212:215], a[232:235], v[88:91], v[212:215]
    v_exp_f32 v210, v210
    v_mfma_f32_16x16x32_bf16 v[212:215], a[236:239], v[92:95], v[212:215]
    v_exp_f32 v211, v211
    v_mfma_f32_16x16x32_bf16 a[104:107], a[176:179], v[144:147], a[104:107]
    ds_read_b64_tr_b16 a[160:161], v20 offset:16384
    v_cvt_pk_bf16_f32 v166, v208, v209
    v_mfma_f32_16x16x32_bf16 a[104:107], a[180:183], v[148:151], a[104:107]
    ds_read_b64_tr_b16 a[162:163], v20 offset:20480
    v_mfma_f32_16x16x32_bf16 a[108:111], a[176:179], v[152:155], a[108:111]
    ds_read_b128 a[216:219], v10 offset:32768
    v_cvt_pk_bf16_f32 v167, v210, v211
    v_mfma_f32_16x16x32_bf16 a[108:111], a[180:183], v[156:159], a[108:111]
    s_waitcnt lgkmcnt(3)
    buffer_load_dwordx4 v47, s[20:23], s49 offen offset:1024 lds
    v_mfma_f32_16x16x32_bf16 v[208:211], a[224:227], v[96:99], v[200:203]
    v_exp_f32 v212, v212
    v_mfma_f32_16x16x32_bf16 v[208:211], a[228:231], v[100:103], v[208:211]
    v_exp_f32 v213, v213
    v_mfma_f32_16x16x32_bf16 v[208:211], a[232:235], v[104:107], v[208:211]
    v_exp_f32 v214, v214
    v_mfma_f32_16x16x32_bf16 v[208:211], a[236:239], v[108:111], v[208:211]
    v_exp_f32 v215, v215
    v_mfma_f32_16x16x32_bf16 a[112:115], a[184:187], v[128:131], a[112:115]
    ds_read_b64_tr_b16 a[164:165], v20 offset:24576
    v_cvt_pk_bf16_f32 v174, v212, v213
    v_mfma_f32_16x16x32_bf16 a[112:115], a[188:191], v[132:135], a[112:115]
    ds_read_b64_tr_b16 a[166:167], v20 offset:28672
    v_mfma_f32_16x16x32_bf16 a[116:119], a[184:187], v[136:139], a[116:119]
    ds_read_b128 a[220:223], v11 offset:32768
    v_cvt_pk_bf16_f32 v175, v214, v215
    v_mfma_f32_16x16x32_bf16 a[116:119], a[188:191], v[140:143], a[116:119]
    v_mfma_f32_16x16x32_bf16 v[212:215], a[224:227], v[112:115], v[204:207]
    v_exp_f32 v208, v208
    v_mfma_f32_16x16x32_bf16 v[212:215], a[228:231], v[116:119], v[212:215]
    v_exp_f32 v209, v209
    v_mfma_f32_16x16x32_bf16 v[212:215], a[232:235], v[120:123], v[212:215]
    v_exp_f32 v210, v210
    v_mfma_f32_16x16x32_bf16 v[212:215], a[236:239], v[124:127], v[212:215]
    v_exp_f32 v211, v211
    v_mfma_f32_16x16x32_bf16 a[120:123], a[184:187], v[144:147], a[120:123]
    ds_read_b64_tr_b16 a[168:169], v21 offset:16384
    v_cvt_pk_bf16_f32 v182, v208, v209
    v_mfma_f32_16x16x32_bf16 a[120:123], a[188:191], v[148:151], a[120:123]
    ds_read_b64_tr_b16 a[170:171], v21 offset:20480
    v_mfma_f32_16x16x32_bf16 a[124:127], a[184:187], v[152:155], a[124:127]
    ds_read_b128 a[224:227], v8 offset:36864
    v_cvt_pk_bf16_f32 v183, v210, v211
    v_mfma_f32_16x16x32_bf16 a[124:127], a[188:191], v[156:159], a[124:127]
    s_waitcnt lgkmcnt(3)
    buffer_load_dwordx4 v48, s[20:23], s49 offen offset:2048 lds
    v_mfma_f32_16x16x32_bf16 v[208:211], a[208:211], v[64:67], v[192:195]
    v_exp_f32 v212, v212
    v_mfma_f32_16x16x32_bf16 v[208:211], a[212:215], v[68:71], v[208:211]
    v_exp_f32 v213, v213
    v_mfma_f32_16x16x32_bf16 v[208:211], a[216:219], v[72:75], v[208:211]
    v_exp_f32 v214, v214
    v_mfma_f32_16x16x32_bf16 v[208:211], a[220:223], v[76:79], v[208:211]
    v_exp_f32 v215, v215
    v_mfma_f32_16x16x32_bf16 a[0:3], a[160:163], v[160:163], a[0:3]
    ds_read_b64_tr_b16 a[172:173], v21 offset:24576
    v_cvt_pk_bf16_f32 v190, v212, v213
    v_mfma_f32_16x16x32_bf16 a[0:3], a[164:167], v[164:167], a[0:3]
    ds_read_b64_tr_b16 a[174:175], v21 offset:28672
    v_mfma_f32_16x16x32_bf16 a[4:7], a[160:163], v[168:171], a[4:7]
    ds_read_b128 a[228:231], v9 offset:36864
    v_cvt_pk_bf16_f32 v191, v214, v215
    v_mfma_f32_16x16x32_bf16 a[4:7], a[164:167], v[172:175], a[4:7]
    v_mfma_f32_16x16x32_bf16 v[212:215], a[208:211], v[80:83], v[196:199]
    v_exp_f32 v208, v208
    v_mfma_f32_16x16x32_bf16 v[212:215], a[212:215], v[84:87], v[212:215]
    v_exp_f32 v209, v209
    v_mfma_f32_16x16x32_bf16 v[212:215], a[216:219], v[88:91], v[212:215]
    v_exp_f32 v210, v210
    v_mfma_f32_16x16x32_bf16 v[212:215], a[220:223], v[92:95], v[212:215]
    v_exp_f32 v211, v211
    v_mfma_f32_16x16x32_bf16 a[8:11], a[160:163], v[176:179], a[8:11]
    ds_read_b64_tr_b16 a[176:177], v22 offset:16384
    v_cvt_pk_bf16_f32 v128, v208, v209
    v_mfma_f32_16x16x32_bf16 a[8:11], a[164:167], v[180:183], a[8:11]
    ds_read_b64_tr_b16 a[178:179], v22 offset:20480
    v_mfma_f32_16x16x32_bf16 a[12:15], a[160:163], v[184:187], a[12:15]
    ds_read_b128 a[232:235], v10 offset:36864
    v_cvt_pk_bf16_f32 v129, v210, v211
    v_mfma_f32_16x16x32_bf16 a[12:15], a[164:167], v[188:191], a[12:15]
    s_waitcnt lgkmcnt(3)
    buffer_load_dwordx4 v49, s[20:23], s49 offen offset:3072 lds
    v_mfma_f32_16x16x32_bf16 v[208:211], a[208:211], v[96:99], v[200:203]
    v_exp_f32 v212, v212
    v_mfma_f32_16x16x32_bf16 v[208:211], a[212:215], v[100:103], v[208:211]
    v_exp_f32 v213, v213
    v_mfma_f32_16x16x32_bf16 v[208:211], a[216:219], v[104:107], v[208:211]
    v_exp_f32 v214, v214
    v_mfma_f32_16x16x32_bf16 v[208:211], a[220:223], v[108:111], v[208:211]
    v_exp_f32 v215, v215
    v_mfma_f32_16x16x32_bf16 a[16:19], a[168:171], v[160:163], a[16:19]
    ds_read_b64_tr_b16 a[180:181], v22 offset:24576
    v_cvt_pk_bf16_f32 v136, v212, v213
    v_mfma_f32_16x16x32_bf16 a[16:19], a[172:175], v[164:167], a[16:19]
    ds_read_b64_tr_b16 a[182:183], v22 offset:28672
    v_mfma_f32_16x16x32_bf16 a[20:23], a[168:171], v[168:171], a[20:23]
    ds_read_b128 a[236:239], v11 offset:36864
    v_cvt_pk_bf16_f32 v137, v214, v215
    v_mfma_f32_16x16x32_bf16 a[20:23], a[172:175], v[172:175], a[20:23]
    v_smfmac_f32_16x16x64_bf16 a[192:195], v[52:55], v[160:167], v50
    v_mfma_f32_16x16x32_bf16 v[212:215], a[208:211], v[112:115], v[204:207]
    v_exp_f32 v208, v208
    v_mfma_f32_16x16x32_bf16 v[212:215], a[212:215], v[116:119], v[212:215]
    s_add_u32 m0, s42, 114688
    v_exp_f32 v209, v209
    v_mfma_f32_16x16x32_bf16 v[212:215], a[216:219], v[120:123], v[212:215]
    v_exp_f32 v210, v210
    v_mfma_f32_16x16x32_bf16 v[212:215], a[220:223], v[124:127], v[212:215]
    v_exp_f32 v211, v211
    v_mfma_f32_16x16x32_bf16 a[24:27], a[168:171], v[176:179], a[24:27]
    ds_read_b64_tr_b16 a[184:185], v23 offset:16384
    v_cvt_pk_bf16_f32 v144, v208, v209
    v_mfma_f32_16x16x32_bf16 a[24:27], a[172:175], v[180:183], a[24:27]
    ds_read_b64_tr_b16 a[186:187], v23 offset:20480
    v_mfma_f32_16x16x32_bf16 a[28:31], a[168:171], v[184:187], a[28:31]
    ds_read_b128 a[208:211], v8 offset:40960
    v_cvt_pk_bf16_f32 v145, v210, v211
    v_mfma_f32_16x16x32_bf16 a[28:31], a[172:175], v[188:191], a[28:31]
    s_waitcnt lgkmcnt(3)
    buffer_load_dwordx4 v40, s[12:15], s41 offen lds
    v_mfma_f32_16x16x32_bf16 v[208:211], a[224:227], v[64:67], v[192:195]
    v_exp_f32 v212, v212
    v_mfma_f32_16x16x32_bf16 v[208:211], a[228:231], v[68:71], v[208:211]
    v_exp_f32 v213, v213
    v_mfma_f32_16x16x32_bf16 v[208:211], a[232:235], v[72:75], v[208:211]
    v_exp_f32 v214, v214
    v_mfma_f32_16x16x32_bf16 v[208:211], a[236:239], v[76:79], v[208:211]
    v_exp_f32 v215, v215
    v_mfma_f32_16x16x32_bf16 a[32:35], a[176:179], v[160:163], a[32:35]
    ds_read_b64_tr_b16 a[188:189], v23 offset:24576
    v_cvt_pk_bf16_f32 v152, v212, v213
    v_mfma_f32_16x16x32_bf16 a[32:35], a[180:183], v[164:167], a[32:35]
    ds_read_b64_tr_b16 a[190:191], v23 offset:28672
    v_mfma_f32_16x16x32_bf16 a[36:39], a[176:179], v[168:171], a[36:39]
    ds_read_b128 a[212:215], v9 offset:40960
    v_cvt_pk_bf16_f32 v153, v214, v215
    v_mfma_f32_16x16x32_bf16 a[36:39], a[180:183], v[172:175], a[36:39]
    v_smfmac_f32_16x16x64_bf16 a[196:199], v[52:55], v[168:175], v50
    v_mfma_f32_16x16x32_bf16 v[212:215], a[224:227], v[80:83], v[196:199]
    v_exp_f32 v208, v208
    v_mfma_f32_16x16x32_bf16 v[212:215], a[228:231], v[84:87], v[212:215]
    v_exp_f32 v209, v209
    v_mfma_f32_16x16x32_bf16 v[212:215], a[232:235], v[88:91], v[212:215]
    v_exp_f32 v210, v210
    v_mfma_f32_16x16x32_bf16 v[212:215], a[236:239], v[92:95], v[212:215]
    v_exp_f32 v211, v211
    v_mfma_f32_16x16x32_bf16 a[40:43], a[176:179], v[176:179], a[40:43]
    ds_read_b64_tr_b16 a[160:161], v24 offset:16384
    v_cvt_pk_bf16_f32 v130, v208, v209
    v_mfma_f32_16x16x32_bf16 a[40:43], a[180:183], v[180:183], a[40:43]
    ds_read_b64_tr_b16 a[162:163], v24 offset:20480
    v_mfma_f32_16x16x32_bf16 a[44:47], a[176:179], v[184:187], a[44:47]
    ds_read_b128 a[216:219], v10 offset:40960
    v_cvt_pk_bf16_f32 v131, v210, v211
    v_mfma_f32_16x16x32_bf16 a[44:47], a[180:183], v[188:191], a[44:47]
    s_waitcnt lgkmcnt(3)
    buffer_load_dwordx4 v41, s[12:15], s41 offen offset:1024 lds
    v_mfma_f32_16x16x32_bf16 v[208:211], a[224:227], v[96:99], v[200:203]
    v_exp_f32 v212, v212
    v_mfma_f32_16x16x32_bf16 v[208:211], a[228:231], v[100:103], v[208:211]
    v_exp_f32 v213, v213
    v_mfma_f32_16x16x32_bf16 v[208:211], a[232:235], v[104:107], v[208:211]
    v_exp_f32 v214, v214
    v_mfma_f32_16x16x32_bf16 v[208:211], a[236:239], v[108:111], v[208:211]
    v_exp_f32 v215, v215
    v_mfma_f32_16x16x32_bf16 a[48:51], a[184:187], v[160:163], a[48:51]
    ds_read_b64_tr_b16 a[164:165], v24 offset:24576
    v_cvt_pk_bf16_f32 v138, v212, v213
    v_mfma_f32_16x16x32_bf16 a[48:51], a[188:191], v[164:167], a[48:51]
    ds_read_b64_tr_b16 a[166:167], v24 offset:28672
    v_mfma_f32_16x16x32_bf16 a[52:55], a[184:187], v[168:171], a[52:55]
    ds_read_b128 a[220:223], v11 offset:40960
    v_cvt_pk_bf16_f32 v139, v214, v215
    v_mfma_f32_16x16x32_bf16 a[52:55], a[188:191], v[172:175], a[52:55]
    v_smfmac_f32_16x16x64_bf16 a[200:203], v[52:55], v[176:183], v50
    v_mfma_f32_16x16x32_bf16 v[212:215], a[224:227], v[112:115], v[204:207]
    v_exp_f32 v208, v208
    v_mfma_f32_16x16x32_bf16 v[212:215], a[228:231], v[116:119], v[212:215]
    v_exp_f32 v209, v209
    v_mfma_f32_16x16x32_bf16 v[212:215], a[232:235], v[120:123], v[212:215]
    v_exp_f32 v210, v210
    v_mfma_f32_16x16x32_bf16 v[212:215], a[236:239], v[124:127], v[212:215]
    v_exp_f32 v211, v211
    v_mfma_f32_16x16x32_bf16 a[56:59], a[184:187], v[176:179], a[56:59]
    ds_read_b64_tr_b16 a[168:169], v25 offset:16384
    v_cvt_pk_bf16_f32 v146, v208, v209
    v_mfma_f32_16x16x32_bf16 a[56:59], a[188:191], v[180:183], a[56:59]
    ds_read_b64_tr_b16 a[170:171], v25 offset:20480
    v_mfma_f32_16x16x32_bf16 a[60:63], a[184:187], v[184:187], a[60:63]
    ds_read_b128 a[224:227], v8 offset:45056
    v_cvt_pk_bf16_f32 v147, v210, v211
    v_mfma_f32_16x16x32_bf16 a[60:63], a[188:191], v[188:191], a[60:63]
    s_waitcnt lgkmcnt(3)
    buffer_load_dwordx4 v40, s[12:15], s41 offen offset:2048 lds
    v_mfma_f32_16x16x32_bf16 v[208:211], a[208:211], v[64:67], v[192:195]
    v_exp_f32 v212, v212
    v_mfma_f32_16x16x32_bf16 v[208:211], a[212:215], v[68:71], v[208:211]
    v_exp_f32 v213, v213
    v_mfma_f32_16x16x32_bf16 v[208:211], a[216:219], v[72:75], v[208:211]
    v_exp_f32 v214, v214
    v_mfma_f32_16x16x32_bf16 v[208:211], a[220:223], v[76:79], v[208:211]
    v_exp_f32 v215, v215
    v_mfma_f32_16x16x32_bf16 a[64:67], a[160:163], v[160:163], a[64:67]
    ds_read_b64_tr_b16 a[172:173], v25 offset:24576
    v_cvt_pk_bf16_f32 v154, v212, v213
    v_mfma_f32_16x16x32_bf16 a[64:67], a[164:167], v[164:167], a[64:67]
    ds_read_b64_tr_b16 a[174:175], v25 offset:28672
    v_mfma_f32_16x16x32_bf16 a[68:71], a[160:163], v[168:171], a[68:71]
    ds_read_b128 a[228:231], v9 offset:45056
    v_cvt_pk_bf16_f32 v155, v214, v215
    v_mfma_f32_16x16x32_bf16 a[68:71], a[164:167], v[172:175], a[68:71]
    v_smfmac_f32_16x16x64_bf16 a[204:207], v[52:55], v[184:191], v50
    v_mfma_f32_16x16x32_bf16 v[212:215], a[208:211], v[80:83], v[196:199]
    v_exp_f32 v208, v208
    v_mfma_f32_16x16x32_bf16 v[212:215], a[212:215], v[84:87], v[212:215]
    v_exp_f32 v209, v209
    v_mfma_f32_16x16x32_bf16 v[212:215], a[216:219], v[88:91], v[212:215]
    v_exp_f32 v210, v210
    v_mfma_f32_16x16x32_bf16 v[212:215], a[220:223], v[92:95], v[212:215]
    v_exp_f32 v211, v211
    v_mfma_f32_16x16x32_bf16 a[72:75], a[160:163], v[176:179], a[72:75]
    ds_read_b64_tr_b16 a[176:177], v26 offset:16384
    v_cvt_pk_bf16_f32 v132, v208, v209
    v_mfma_f32_16x16x32_bf16 a[72:75], a[164:167], v[180:183], a[72:75]
    ds_read_b64_tr_b16 a[178:179], v26 offset:20480
    v_mfma_f32_16x16x32_bf16 a[76:79], a[160:163], v[184:187], a[76:79]
    ds_read_b128 a[232:235], v10 offset:45056
    v_cvt_pk_bf16_f32 v133, v210, v211
    v_mfma_f32_16x16x32_bf16 a[76:79], a[164:167], v[188:191], a[76:79]
    s_waitcnt lgkmcnt(3)
    buffer_load_dwordx4 v41, s[12:15], s41 offen offset:3072 lds
    v_mfma_f32_16x16x32_bf16 v[208:211], a[208:211], v[96:99], v[200:203]
    v_exp_f32 v212, v212
    v_mfma_f32_16x16x32_bf16 v[208:211], a[212:215], v[100:103], v[208:211]
    s_add_u32 s41, s41, 16384
    v_exp_f32 v213, v213
    v_mfma_f32_16x16x32_bf16 v[208:211], a[216:219], v[104:107], v[208:211]
    v_exp_f32 v214, v214
    v_mfma_f32_16x16x32_bf16 v[208:211], a[220:223], v[108:111], v[208:211]
    v_exp_f32 v215, v215
    v_mfma_f32_16x16x32_bf16 a[80:83], a[168:171], v[160:163], a[80:83]
    ds_read_b64_tr_b16 a[180:181], v26 offset:24576
    v_cvt_pk_bf16_f32 v140, v212, v213
    v_mfma_f32_16x16x32_bf16 a[80:83], a[172:175], v[164:167], a[80:83]
    ds_read_b64_tr_b16 a[182:183], v26 offset:28672
    v_mfma_f32_16x16x32_bf16 a[84:87], a[168:171], v[168:171], a[84:87]
    ds_read_b128 a[236:239], v11 offset:45056
    v_cvt_pk_bf16_f32 v141, v214, v215
    v_mfma_f32_16x16x32_bf16 a[84:87], a[172:175], v[172:175], a[84:87]
    s_waitcnt vmcnt(8)
    s_barrier
    v_mfma_f32_16x16x32_bf16 v[212:215], a[208:211], v[112:115], v[204:207]
    v_exp_f32 v208, v208
    v_mfma_f32_16x16x32_bf16 v[212:215], a[212:215], v[116:119], v[212:215]
    s_add_u32 s49, s45, 73728
    v_exp_f32 v209, v209
    v_mfma_f32_16x16x32_bf16 v[212:215], a[216:219], v[120:123], v[212:215]
    s_add_u32 m0, s42, 147456
    v_exp_f32 v210, v210
    v_mfma_f32_16x16x32_bf16 v[212:215], a[220:223], v[124:127], v[212:215]
    v_exp_f32 v211, v211
    v_mfma_f32_16x16x32_bf16 a[88:91], a[168:171], v[176:179], a[88:91]
    ds_read_b64_tr_b16 a[184:185], v27 offset:16384
    v_cvt_pk_bf16_f32 v148, v208, v209
    v_mfma_f32_16x16x32_bf16 a[88:91], a[172:175], v[180:183], a[88:91]
    ds_read_b64_tr_b16 a[186:187], v27 offset:20480
    v_mfma_f32_16x16x32_bf16 a[92:95], a[168:171], v[184:187], a[92:95]
    ds_read_b128 a[208:211], v8 offset:49152
    v_cvt_pk_bf16_f32 v149, v210, v211
    v_mfma_f32_16x16x32_bf16 a[92:95], a[172:175], v[188:191], a[92:95]
    s_waitcnt lgkmcnt(3)
    buffer_load_dwordx4 v46, s[20:23], s49 offen lds
    v_mfma_f32_16x16x32_bf16 v[208:211], a[224:227], v[64:67], v[192:195]
    v_exp_f32 v212, v212
    v_mfma_f32_16x16x32_bf16 v[208:211], a[228:231], v[68:71], v[208:211]
    v_exp_f32 v213, v213
    v_mfma_f32_16x16x32_bf16 v[208:211], a[232:235], v[72:75], v[208:211]
    v_exp_f32 v214, v214
    v_mfma_f32_16x16x32_bf16 v[208:211], a[236:239], v[76:79], v[208:211]
    v_exp_f32 v215, v215
    v_mfma_f32_16x16x32_bf16 a[96:99], a[176:179], v[160:163], a[96:99]
    ds_read_b64_tr_b16 a[188:189], v27 offset:24576
    v_cvt_pk_bf16_f32 v156, v212, v213
    v_mfma_f32_16x16x32_bf16 a[96:99], a[180:183], v[164:167], a[96:99]
    ds_read_b64_tr_b16 a[190:191], v27 offset:28672
    v_mfma_f32_16x16x32_bf16 a[100:103], a[176:179], v[168:171], a[100:103]
    ds_read_b128 a[212:215], v9 offset:49152
    v_cvt_pk_bf16_f32 v157, v214, v215
    v_mfma_f32_16x16x32_bf16 a[100:103], a[180:183], v[172:175], a[100:103]
    v_mfma_f32_16x16x32_bf16 v[212:215], a[224:227], v[80:83], v[196:199]
    v_exp_f32 v208, v208
    v_mfma_f32_16x16x32_bf16 v[212:215], a[228:231], v[84:87], v[212:215]
    v_exp_f32 v209, v209
    v_mfma_f32_16x16x32_bf16 v[212:215], a[232:235], v[88:91], v[212:215]
    v_exp_f32 v210, v210
    v_mfma_f32_16x16x32_bf16 v[212:215], a[236:239], v[92:95], v[212:215]
    v_exp_f32 v211, v211
    v_mfma_f32_16x16x32_bf16 a[104:107], a[176:179], v[176:179], a[104:107]
    ds_read_b64_tr_b16 a[160:161], v20 offset:32768
    v_cvt_pk_bf16_f32 v134, v208, v209
    v_mfma_f32_16x16x32_bf16 a[104:107], a[180:183], v[180:183], a[104:107]
    ds_read_b64_tr_b16 a[162:163], v20 offset:36864
    v_mfma_f32_16x16x32_bf16 a[108:111], a[176:179], v[184:187], a[108:111]
    ds_read_b128 a[216:219], v10 offset:49152
    v_cvt_pk_bf16_f32 v135, v210, v211
    v_mfma_f32_16x16x32_bf16 a[108:111], a[180:183], v[188:191], a[108:111]
    s_waitcnt lgkmcnt(3)
    buffer_load_dwordx4 v47, s[20:23], s49 offen offset:1024 lds
    v_mfma_f32_16x16x32_bf16 v[208:211], a[224:227], v[96:99], v[200:203]
    v_exp_f32 v212, v212
    v_mfma_f32_16x16x32_bf16 v[208:211], a[228:231], v[100:103], v[208:211]
    v_exp_f32 v213, v213
    v_mfma_f32_16x16x32_bf16 v[208:211], a[232:235], v[104:107], v[208:211]
    v_exp_f32 v214, v214
    v_mfma_f32_16x16x32_bf16 v[208:211], a[236:239], v[108:111], v[208:211]
    v_exp_f32 v215, v215
    v_mfma_f32_16x16x32_bf16 a[112:115], a[184:187], v[160:163], a[112:115]
    ds_read_b64_tr_b16 a[164:165], v20 offset:40960
    v_cvt_pk_bf16_f32 v142, v212, v213
    v_mfma_f32_16x16x32_bf16 a[112:115], a[188:191], v[164:167], a[112:115]
    ds_read_b64_tr_b16 a[166:167], v20 offset:45056
    v_mfma_f32_16x16x32_bf16 a[116:119], a[184:187], v[168:171], a[116:119]
    ds_read_b128 a[220:223], v11 offset:49152
    v_cvt_pk_bf16_f32 v143, v214, v215
    v_mfma_f32_16x16x32_bf16 a[116:119], a[188:191], v[172:175], a[116:119]
    v_mfma_f32_16x16x32_bf16 v[212:215], a[224:227], v[112:115], v[204:207]
    v_exp_f32 v208, v208
    v_mfma_f32_16x16x32_bf16 v[212:215], a[228:231], v[116:119], v[212:215]
    v_exp_f32 v209, v209
    v_mfma_f32_16x16x32_bf16 v[212:215], a[232:235], v[120:123], v[212:215]
    v_exp_f32 v210, v210
    v_mfma_f32_16x16x32_bf16 v[212:215], a[236:239], v[124:127], v[212:215]
    v_exp_f32 v211, v211
    v_mfma_f32_16x16x32_bf16 a[120:123], a[184:187], v[176:179], a[120:123]
    ds_read_b64_tr_b16 a[168:169], v21 offset:32768
    v_cvt_pk_bf16_f32 v150, v208, v209
    v_mfma_f32_16x16x32_bf16 a[120:123], a[188:191], v[180:183], a[120:123]
    ds_read_b64_tr_b16 a[170:171], v21 offset:36864
    v_mfma_f32_16x16x32_bf16 a[124:127], a[184:187], v[184:187], a[124:127]
    ds_read_b128 a[224:227], v8 offset:53248
    v_cvt_pk_bf16_f32 v151, v210, v211
    v_mfma_f32_16x16x32_bf16 a[124:127], a[188:191], v[188:191], a[124:127]
    s_waitcnt lgkmcnt(3)
    buffer_load_dwordx4 v48, s[20:23], s49 offen offset:2048 lds
    v_mfma_f32_16x16x32_bf16 v[208:211], a[208:211], v[64:67], v[192:195]
    v_exp_f32 v212, v212
    v_mfma_f32_16x16x32_bf16 v[208:211], a[212:215], v[68:71], v[208:211]
    v_exp_f32 v213, v213
    v_mfma_f32_16x16x32_bf16 v[208:211], a[216:219], v[72:75], v[208:211]
    v_exp_f32 v214, v214
    v_mfma_f32_16x16x32_bf16 v[208:211], a[220:223], v[76:79], v[208:211]
    v_exp_f32 v215, v215
    v_mfma_f32_16x16x32_bf16 a[0:3], a[160:163], v[128:131], a[0:3]
    ds_read_b64_tr_b16 a[172:173], v21 offset:40960
    v_cvt_pk_bf16_f32 v158, v212, v213
    v_mfma_f32_16x16x32_bf16 a[0:3], a[164:167], v[132:135], a[0:3]
    ds_read_b64_tr_b16 a[174:175], v21 offset:45056
    v_mfma_f32_16x16x32_bf16 a[4:7], a[160:163], v[136:139], a[4:7]
    ds_read_b128 a[228:231], v9 offset:53248
    v_cvt_pk_bf16_f32 v159, v214, v215
    v_mfma_f32_16x16x32_bf16 a[4:7], a[164:167], v[140:143], a[4:7]
    v_mfma_f32_16x16x32_bf16 v[212:215], a[208:211], v[80:83], v[196:199]
    v_exp_f32 v208, v208
    v_mfma_f32_16x16x32_bf16 v[212:215], a[212:215], v[84:87], v[212:215]
    v_exp_f32 v209, v209
    v_mfma_f32_16x16x32_bf16 v[212:215], a[216:219], v[88:91], v[212:215]
    v_exp_f32 v210, v210
    v_mfma_f32_16x16x32_bf16 v[212:215], a[220:223], v[92:95], v[212:215]
    v_exp_f32 v211, v211
    v_mfma_f32_16x16x32_bf16 a[8:11], a[160:163], v[144:147], a[8:11]
    ds_read_b64_tr_b16 a[176:177], v22 offset:32768
    v_cvt_pk_bf16_f32 v160, v208, v209
    v_mfma_f32_16x16x32_bf16 a[8:11], a[164:167], v[148:151], a[8:11]
    ds_read_b64_tr_b16 a[178:179], v22 offset:36864
    v_mfma_f32_16x16x32_bf16 a[12:15], a[160:163], v[152:155], a[12:15]
    ds_read_b128 a[232:235], v10 offset:53248
    v_cvt_pk_bf16_f32 v161, v210, v211
    v_mfma_f32_16x16x32_bf16 a[12:15], a[164:167], v[156:159], a[12:15]
    s_waitcnt lgkmcnt(3)
    buffer_load_dwordx4 v49, s[20:23], s49 offen offset:3072 lds
    v_mfma_f32_16x16x32_bf16 v[208:211], a[208:211], v[96:99], v[200:203]
    v_exp_f32 v212, v212
    v_mfma_f32_16x16x32_bf16 v[208:211], a[212:215], v[100:103], v[208:211]
    v_exp_f32 v213, v213
    v_mfma_f32_16x16x32_bf16 v[208:211], a[216:219], v[104:107], v[208:211]
    v_exp_f32 v214, v214
    v_mfma_f32_16x16x32_bf16 v[208:211], a[220:223], v[108:111], v[208:211]
    v_exp_f32 v215, v215
    v_mfma_f32_16x16x32_bf16 a[16:19], a[168:171], v[128:131], a[16:19]
    ds_read_b64_tr_b16 a[180:181], v22 offset:40960
    v_cvt_pk_bf16_f32 v168, v212, v213
    v_mfma_f32_16x16x32_bf16 a[16:19], a[172:175], v[132:135], a[16:19]
    ds_read_b64_tr_b16 a[182:183], v22 offset:45056
    v_mfma_f32_16x16x32_bf16 a[20:23], a[168:171], v[136:139], a[20:23]
    ds_read_b128 a[236:239], v11 offset:53248
    v_cvt_pk_bf16_f32 v169, v214, v215
    v_mfma_f32_16x16x32_bf16 a[20:23], a[172:175], v[140:143], a[20:23]
    v_smfmac_f32_16x16x64_bf16 a[192:195], v[52:55], v[128:135], v50
    v_mfma_f32_16x16x32_bf16 v[212:215], a[208:211], v[112:115], v[204:207]
    v_exp_f32 v208, v208
    v_mfma_f32_16x16x32_bf16 v[212:215], a[212:215], v[116:119], v[212:215]
    s_add_u32 s49, s45, 128
    v_exp_f32 v209, v209
    v_mfma_f32_16x16x32_bf16 v[212:215], a[216:219], v[120:123], v[212:215]
    s_add_u32 m0, s42, 0
    v_exp_f32 v210, v210
    v_mfma_f32_16x16x32_bf16 v[212:215], a[220:223], v[124:127], v[212:215]
    v_exp_f32 v211, v211
    v_mfma_f32_16x16x32_bf16 a[24:27], a[168:171], v[144:147], a[24:27]
    ds_read_b64_tr_b16 a[184:185], v23 offset:32768
    v_cvt_pk_bf16_f32 v176, v208, v209
    v_mfma_f32_16x16x32_bf16 a[24:27], a[172:175], v[148:151], a[24:27]
    ds_read_b64_tr_b16 a[186:187], v23 offset:36864
    v_mfma_f32_16x16x32_bf16 a[28:31], a[168:171], v[152:155], a[28:31]
    ds_read_b128 a[208:211], v8 offset:57344
    v_cvt_pk_bf16_f32 v177, v210, v211
    v_mfma_f32_16x16x32_bf16 a[28:31], a[172:175], v[156:159], a[28:31]
    s_waitcnt lgkmcnt(3)
    buffer_load_dwordx4 v46, s[20:23], s49 offen lds
    v_mfma_f32_16x16x32_bf16 v[208:211], a[224:227], v[64:67], v[192:195]
    v_exp_f32 v212, v212
    v_mfma_f32_16x16x32_bf16 v[208:211], a[228:231], v[68:71], v[208:211]
    v_exp_f32 v213, v213
    v_mfma_f32_16x16x32_bf16 v[208:211], a[232:235], v[72:75], v[208:211]
    v_exp_f32 v214, v214
    v_mfma_f32_16x16x32_bf16 v[208:211], a[236:239], v[76:79], v[208:211]
    v_exp_f32 v215, v215
    v_mfma_f32_16x16x32_bf16 a[32:35], a[176:179], v[128:131], a[32:35]
    ds_read_b64_tr_b16 a[188:189], v23 offset:40960
    v_cvt_pk_bf16_f32 v184, v212, v213
    v_mfma_f32_16x16x32_bf16 a[32:35], a[180:183], v[132:135], a[32:35]
    ds_read_b64_tr_b16 a[190:191], v23 offset:45056
    v_mfma_f32_16x16x32_bf16 a[36:39], a[176:179], v[136:139], a[36:39]
    ds_read_b128 a[212:215], v9 offset:57344
    v_cvt_pk_bf16_f32 v185, v214, v215
    v_mfma_f32_16x16x32_bf16 a[36:39], a[180:183], v[140:143], a[36:39]
    v_smfmac_f32_16x16x64_bf16 a[196:199], v[52:55], v[136:143], v50
    v_mfma_f32_16x16x32_bf16 v[212:215], a[224:227], v[80:83], v[196:199]
    v_exp_f32 v208, v208
    v_mfma_f32_16x16x32_bf16 v[212:215], a[228:231], v[84:87], v[212:215]
    v_exp_f32 v209, v209
    v_mfma_f32_16x16x32_bf16 v[212:215], a[232:235], v[88:91], v[212:215]
    v_exp_f32 v210, v210
    v_mfma_f32_16x16x32_bf16 v[212:215], a[236:239], v[92:95], v[212:215]
    v_exp_f32 v211, v211
    v_mfma_f32_16x16x32_bf16 a[40:43], a[176:179], v[144:147], a[40:43]
    ds_read_b64_tr_b16 a[160:161], v24 offset:32768
    v_cvt_pk_bf16_f32 v162, v208, v209
    v_mfma_f32_16x16x32_bf16 a[40:43], a[180:183], v[148:151], a[40:43]
    ds_read_b64_tr_b16 a[162:163], v24 offset:36864
    v_mfma_f32_16x16x32_bf16 a[44:47], a[176:179], v[152:155], a[44:47]
    ds_read_b128 a[216:219], v10 offset:57344
    v_cvt_pk_bf16_f32 v163, v210, v211
    v_mfma_f32_16x16x32_bf16 a[44:47], a[180:183], v[156:159], a[44:47]
    s_waitcnt lgkmcnt(3)
    buffer_load_dwordx4 v47, s[20:23], s49 offen offset:1024 lds
    v_mfma_f32_16x16x32_bf16 v[208:211], a[224:227], v[96:99], v[200:203]
    v_exp_f32 v212, v212
    v_mfma_f32_16x16x32_bf16 v[208:211], a[228:231], v[100:103], v[208:211]
    v_exp_f32 v213, v213
    v_mfma_f32_16x16x32_bf16 v[208:211], a[232:235], v[104:107], v[208:211]
    v_exp_f32 v214, v214
    v_mfma_f32_16x16x32_bf16 v[208:211], a[236:239], v[108:111], v[208:211]
    v_exp_f32 v215, v215
    v_mfma_f32_16x16x32_bf16 a[48:51], a[184:187], v[128:131], a[48:51]
    ds_read_b64_tr_b16 a[164:165], v24 offset:40960
    v_cvt_pk_bf16_f32 v170, v212, v213
    v_mfma_f32_16x16x32_bf16 a[48:51], a[188:191], v[132:135], a[48:51]
    ds_read_b64_tr_b16 a[166:167], v24 offset:45056
    v_mfma_f32_16x16x32_bf16 a[52:55], a[184:187], v[136:139], a[52:55]
    ds_read_b128 a[220:223], v11 offset:57344
    v_cvt_pk_bf16_f32 v171, v214, v215
    v_mfma_f32_16x16x32_bf16 a[52:55], a[188:191], v[140:143], a[52:55]
    v_smfmac_f32_16x16x64_bf16 a[200:203], v[52:55], v[144:151], v50
    v_mfma_f32_16x16x32_bf16 v[212:215], a[224:227], v[112:115], v[204:207]
    v_exp_f32 v208, v208
    v_mfma_f32_16x16x32_bf16 v[212:215], a[228:231], v[116:119], v[212:215]
    v_exp_f32 v209, v209
    v_mfma_f32_16x16x32_bf16 v[212:215], a[232:235], v[120:123], v[212:215]
    v_exp_f32 v210, v210
    v_mfma_f32_16x16x32_bf16 v[212:215], a[236:239], v[124:127], v[212:215]
    v_exp_f32 v211, v211
    v_mfma_f32_16x16x32_bf16 a[56:59], a[184:187], v[144:147], a[56:59]
    ds_read_b64_tr_b16 a[168:169], v25 offset:32768
    v_cvt_pk_bf16_f32 v178, v208, v209
    v_mfma_f32_16x16x32_bf16 a[56:59], a[188:191], v[148:151], a[56:59]
    ds_read_b64_tr_b16 a[170:171], v25 offset:36864
    v_mfma_f32_16x16x32_bf16 a[60:63], a[184:187], v[152:155], a[60:63]
    ds_read_b128 a[224:227], v8 offset:61440
    v_cvt_pk_bf16_f32 v179, v210, v211
    v_mfma_f32_16x16x32_bf16 a[60:63], a[188:191], v[156:159], a[60:63]
    s_waitcnt lgkmcnt(3)
    buffer_load_dwordx4 v48, s[20:23], s49 offen offset:2048 lds
    v_mfma_f32_16x16x32_bf16 v[208:211], a[208:211], v[64:67], v[192:195]
    v_exp_f32 v212, v212
    v_mfma_f32_16x16x32_bf16 v[208:211], a[212:215], v[68:71], v[208:211]
    v_exp_f32 v213, v213
    v_mfma_f32_16x16x32_bf16 v[208:211], a[216:219], v[72:75], v[208:211]
    v_exp_f32 v214, v214
    v_mfma_f32_16x16x32_bf16 v[208:211], a[220:223], v[76:79], v[208:211]
    v_exp_f32 v215, v215
    v_mfma_f32_16x16x32_bf16 a[64:67], a[160:163], v[128:131], a[64:67]
    ds_read_b64_tr_b16 a[172:173], v25 offset:40960
    v_cvt_pk_bf16_f32 v186, v212, v213
    v_mfma_f32_16x16x32_bf16 a[64:67], a[164:167], v[132:135], a[64:67]
    ds_read_b64_tr_b16 a[174:175], v25 offset:45056
    v_mfma_f32_16x16x32_bf16 a[68:71], a[160:163], v[136:139], a[68:71]
    ds_read_b128 a[228:231], v9 offset:61440
    v_cvt_pk_bf16_f32 v187, v214, v215
    v_mfma_f32_16x16x32_bf16 a[68:71], a[164:167], v[140:143], a[68:71]
    v_smfmac_f32_16x16x64_bf16 a[204:207], v[52:55], v[152:159], v50
    v_mfma_f32_16x16x32_bf16 v[212:215], a[208:211], v[80:83], v[196:199]
    v_exp_f32 v208, v208
    v_mfma_f32_16x16x32_bf16 v[212:215], a[212:215], v[84:87], v[212:215]
    v_exp_f32 v209, v209
    v_mfma_f32_16x16x32_bf16 v[212:215], a[216:219], v[88:91], v[212:215]
    v_exp_f32 v210, v210
    v_mfma_f32_16x16x32_bf16 v[212:215], a[220:223], v[92:95], v[212:215]
    v_exp_f32 v211, v211
    v_mfma_f32_16x16x32_bf16 a[72:75], a[160:163], v[144:147], a[72:75]
    ds_read_b64_tr_b16 a[176:177], v26 offset:32768
    v_cvt_pk_bf16_f32 v164, v208, v209
    v_mfma_f32_16x16x32_bf16 a[72:75], a[164:167], v[148:151], a[72:75]
    ds_read_b64_tr_b16 a[178:179], v26 offset:36864
    v_mfma_f32_16x16x32_bf16 a[76:79], a[160:163], v[152:155], a[76:79]
    ds_read_b128 a[232:235], v10 offset:61440
    v_cvt_pk_bf16_f32 v165, v210, v211
    v_mfma_f32_16x16x32_bf16 a[76:79], a[164:167], v[156:159], a[76:79]
    s_waitcnt lgkmcnt(3)
    buffer_load_dwordx4 v49, s[20:23], s49 offen offset:3072 lds
    v_mfma_f32_16x16x32_bf16 v[208:211], a[208:211], v[96:99], v[200:203]
    v_exp_f32 v212, v212
    v_mfma_f32_16x16x32_bf16 v[208:211], a[212:215], v[100:103], v[208:211]
    v_exp_f32 v213, v213
    v_mfma_f32_16x16x32_bf16 v[208:211], a[216:219], v[104:107], v[208:211]
    v_exp_f32 v214, v214
    v_mfma_f32_16x16x32_bf16 v[208:211], a[220:223], v[108:111], v[208:211]
    v_exp_f32 v215, v215
    v_mfma_f32_16x16x32_bf16 a[80:83], a[168:171], v[128:131], a[80:83]
    ds_read_b64_tr_b16 a[180:181], v26 offset:40960
    v_cvt_pk_bf16_f32 v172, v212, v213
    v_mfma_f32_16x16x32_bf16 a[80:83], a[172:175], v[132:135], a[80:83]
    ds_read_b64_tr_b16 a[182:183], v26 offset:45056
    v_mfma_f32_16x16x32_bf16 a[84:87], a[168:171], v[136:139], a[84:87]
    ds_read_b128 a[236:239], v11 offset:61440
    v_cvt_pk_bf16_f32 v173, v214, v215
    v_mfma_f32_16x16x32_bf16 a[84:87], a[172:175], v[140:143], a[84:87]
    s_waitcnt vmcnt(8)
    s_barrier
    v_mfma_f32_16x16x32_bf16 v[212:215], a[208:211], v[112:115], v[204:207]
    v_exp_f32 v208, v208
    v_mfma_f32_16x16x32_bf16 v[212:215], a[212:215], v[116:119], v[212:215]
    s_add_u32 s49, s45, 73856
    v_exp_f32 v209, v209
    v_mfma_f32_16x16x32_bf16 v[212:215], a[216:219], v[120:123], v[212:215]
    s_add_u32 m0, s42, 16384
    v_exp_f32 v210, v210
    v_mfma_f32_16x16x32_bf16 v[212:215], a[220:223], v[124:127], v[212:215]
    v_exp_f32 v211, v211
    v_mfma_f32_16x16x32_bf16 a[88:91], a[168:171], v[144:147], a[88:91]
    ds_read_b64_tr_b16 a[184:185], v27 offset:32768
    v_cvt_pk_bf16_f32 v180, v208, v209
    v_mfma_f32_16x16x32_bf16 a[88:91], a[172:175], v[148:151], a[88:91]
    ds_read_b64_tr_b16 a[186:187], v27 offset:36864
    v_mfma_f32_16x16x32_bf16 a[92:95], a[168:171], v[152:155], a[92:95]
    v_cvt_pk_bf16_f32 v181, v210, v211
    v_mfma_f32_16x16x32_bf16 a[92:95], a[172:175], v[156:159], a[92:95]
    s_waitcnt lgkmcnt(3)
    buffer_load_dwordx4 v46, s[20:23], s49 offen lds
    v_mfma_f32_16x16x32_bf16 v[208:211], a[224:227], v[64:67], v[192:195]
    v_exp_f32 v212, v212
    v_mfma_f32_16x16x32_bf16 v[208:211], a[228:231], v[68:71], v[208:211]
    v_exp_f32 v213, v213
    v_mfma_f32_16x16x32_bf16 v[208:211], a[232:235], v[72:75], v[208:211]
    s_waitcnt lgkmcnt(2)
    v_exp_f32 v214, v214
    v_mfma_f32_16x16x32_bf16 v[208:211], a[236:239], v[76:79], v[208:211]
    v_exp_f32 v215, v215
    v_mfma_f32_16x16x32_bf16 a[96:99], a[176:179], v[128:131], a[96:99]
    ds_read_b64_tr_b16 a[188:189], v27 offset:40960
    v_cvt_pk_bf16_f32 v188, v212, v213
    v_mfma_f32_16x16x32_bf16 a[96:99], a[180:183], v[132:135], a[96:99]
    ds_read_b64_tr_b16 a[190:191], v27 offset:45056
    v_mfma_f32_16x16x32_bf16 a[100:103], a[176:179], v[136:139], a[100:103]
    v_cvt_pk_bf16_f32 v189, v214, v215
    v_mfma_f32_16x16x32_bf16 a[100:103], a[180:183], v[140:143], a[100:103]
    v_mfma_f32_16x16x32_bf16 v[212:215], a[224:227], v[80:83], v[196:199]
    v_exp_f32 v208, v208
    v_mfma_f32_16x16x32_bf16 v[212:215], a[228:231], v[84:87], v[212:215]
    v_exp_f32 v209, v209
    v_mfma_f32_16x16x32_bf16 v[212:215], a[232:235], v[88:91], v[212:215]
    v_exp_f32 v210, v210
    v_mfma_f32_16x16x32_bf16 v[212:215], a[236:239], v[92:95], v[212:215]
    v_exp_f32 v211, v211
    v_mfma_f32_16x16x32_bf16 a[104:107], a[176:179], v[144:147], a[104:107]
    ds_read_b64_tr_b16 a[160:161], v20 offset:49152
    v_cvt_pk_bf16_f32 v166, v208, v209
    v_mfma_f32_16x16x32_bf16 a[104:107], a[180:183], v[148:151], a[104:107]
    ds_read_b64_tr_b16 a[162:163], v20 offset:53248
    v_mfma_f32_16x16x32_bf16 a[108:111], a[176:179], v[152:155], a[108:111]
    v_cvt_pk_bf16_f32 v167, v210, v211
    v_mfma_f32_16x16x32_bf16 a[108:111], a[180:183], v[156:159], a[108:111]
    s_waitcnt lgkmcnt(3)
    buffer_load_dwordx4 v47, s[20:23], s49 offen offset:1024 lds
    v_mfma_f32_16x16x32_bf16 v[208:211], a[224:227], v[96:99], v[200:203]
    v_exp_f32 v212, v212
    v_mfma_f32_16x16x32_bf16 v[208:211], a[228:231], v[100:103], v[208:211]
    v_exp_f32 v213, v213
    v_mfma_f32_16x16x32_bf16 v[208:211], a[232:235], v[104:107], v[208:211]
    v_exp_f32 v214, v214
    v_mfma_f32_16x16x32_bf16 v[208:211], a[236:239], v[108:111], v[208:211]
    v_exp_f32 v215, v215
    v_mfma_f32_16x16x32_bf16 a[112:115], a[184:187], v[128:131], a[112:115]
    s_waitcnt lgkmcnt(2)
    ds_read_b64_tr_b16 a[164:165], v20 offset:57344
    v_cvt_pk_bf16_f32 v174, v212, v213
    v_mfma_f32_16x16x32_bf16 a[112:115], a[188:191], v[132:135], a[112:115]
    ds_read_b64_tr_b16 a[166:167], v20 offset:61440
    v_mfma_f32_16x16x32_bf16 a[116:119], a[184:187], v[136:139], a[116:119]
    v_cvt_pk_bf16_f32 v175, v214, v215
    v_mfma_f32_16x16x32_bf16 a[116:119], a[188:191], v[140:143], a[116:119]
    v_mfma_f32_16x16x32_bf16 v[212:215], a[224:227], v[112:115], v[204:207]
    v_exp_f32 v208, v208
    v_mfma_f32_16x16x32_bf16 v[212:215], a[228:231], v[116:119], v[212:215]
    v_exp_f32 v209, v209
    v_mfma_f32_16x16x32_bf16 v[212:215], a[232:235], v[120:123], v[212:215]
    v_exp_f32 v210, v210
    v_mfma_f32_16x16x32_bf16 v[212:215], a[236:239], v[124:127], v[212:215]
    v_exp_f32 v211, v211
    v_mfma_f32_16x16x32_bf16 a[120:123], a[184:187], v[144:147], a[120:123]
    ds_read_b64_tr_b16 a[168:169], v21 offset:49152
    v_cvt_pk_bf16_f32 v182, v208, v209
    v_mfma_f32_16x16x32_bf16 a[120:123], a[188:191], v[148:151], a[120:123]
    ds_read_b64_tr_b16 a[170:171], v21 offset:53248
    v_mfma_f32_16x16x32_bf16 a[124:127], a[184:187], v[152:155], a[124:127]
    v_cvt_pk_bf16_f32 v183, v210, v211
    v_mfma_f32_16x16x32_bf16 a[124:127], a[188:191], v[156:159], a[124:127]
    s_waitcnt lgkmcnt(3)
    buffer_load_dwordx4 v48, s[20:23], s49 offen offset:2048 lds
    v_exp_f32 v212, v212
    v_exp_f32 v213, v213
    v_exp_f32 v214, v214
    v_exp_f32 v215, v215
    v_mfma_f32_16x16x32_bf16 a[0:3], a[160:163], v[160:163], a[0:3]
    s_waitcnt lgkmcnt(2)
    ds_read_b64_tr_b16 a[172:173], v21 offset:57344
    v_cvt_pk_bf16_f32 v190, v212, v213
    v_mfma_f32_16x16x32_bf16 a[0:3], a[164:167], v[164:167], a[0:3]
    ds_read_b64_tr_b16 a[174:175], v21 offset:61440
    v_mfma_f32_16x16x32_bf16 a[4:7], a[160:163], v[168:171], a[4:7]
    v_cvt_pk_bf16_f32 v191, v214, v215
    v_mfma_f32_16x16x32_bf16 a[4:7], a[164:167], v[172:175], a[4:7]
    v_mfma_f32_16x16x32_bf16 a[8:11], a[160:163], v[176:179], a[8:11]
    ds_read_b64_tr_b16 a[176:177], v22 offset:49152
    v_mfma_f32_16x16x32_bf16 a[8:11], a[164:167], v[180:183], a[8:11]
    ds_read_b64_tr_b16 a[178:179], v22 offset:53248
    v_mfma_f32_16x16x32_bf16 a[12:15], a[160:163], v[184:187], a[12:15]
    v_mfma_f32_16x16x32_bf16 a[12:15], a[164:167], v[188:191], a[12:15]
    buffer_load_dwordx4 v49, s[20:23], s49 offen offset:3072 lds
    v_smfmac_f32_16x16x64_bf16 a[192:195], v[52:55], v[160:167], v50
    s_waitcnt lgkmcnt(4)
    v_mfma_f32_16x16x32_bf16 a[16:19], a[168:171], v[160:163], a[16:19]
    s_waitcnt lgkmcnt(2)
    ds_read_b64_tr_b16 a[180:181], v22 offset:57344
    v_mfma_f32_16x16x32_bf16 a[16:19], a[172:175], v[164:167], a[16:19]
    ds_read_b64_tr_b16 a[182:183], v22 offset:61440
    v_mfma_f32_16x16x32_bf16 a[20:23], a[168:171], v[168:171], a[20:23]
    v_mfma_f32_16x16x32_bf16 a[20:23], a[172:175], v[172:175], a[20:23]
    v_smfmac_f32_16x16x64_bf16 a[196:199], v[52:55], v[168:175], v50
    s_add_u32 s49, s45, 256
    s_add_u32 m0, s42, 32768
    v_mfma_f32_16x16x32_bf16 a[24:27], a[168:171], v[176:179], a[24:27]
    ds_read_b64_tr_b16 a[184:185], v23 offset:49152
    v_mfma_f32_16x16x32_bf16 a[24:27], a[172:175], v[180:183], a[24:27]
    ds_read_b64_tr_b16 a[186:187], v23 offset:53248
    v_mfma_f32_16x16x32_bf16 a[28:31], a[168:171], v[184:187], a[28:31]
    v_mfma_f32_16x16x32_bf16 a[28:31], a[172:175], v[188:191], a[28:31]
    buffer_load_dwordx4 v46, s[20:23], s49 offen lds
    v_smfmac_f32_16x16x64_bf16 a[200:203], v[52:55], v[176:183], v50
    s_waitcnt lgkmcnt(4)
    v_mfma_f32_16x16x32_bf16 a[32:35], a[176:179], v[160:163], a[32:35]
    s_waitcnt lgkmcnt(2)
    ds_read_b64_tr_b16 a[188:189], v23 offset:57344
    v_mfma_f32_16x16x32_bf16 a[32:35], a[180:183], v[164:167], a[32:35]
    ds_read_b64_tr_b16 a[190:191], v23 offset:61440
    v_mfma_f32_16x16x32_bf16 a[36:39], a[176:179], v[168:171], a[36:39]
    v_mfma_f32_16x16x32_bf16 a[36:39], a[180:183], v[172:175], a[36:39]
    v_smfmac_f32_16x16x64_bf16 a[204:207], v[52:55], v[184:191], v50
    v_mfma_f32_16x16x32_bf16 a[40:43], a[176:179], v[176:179], a[40:43]
    ds_read_b64_tr_b16 a[160:161], v24 offset:49152
    v_mfma_f32_16x16x32_bf16 a[40:43], a[180:183], v[180:183], a[40:43]
    ds_read_b64_tr_b16 a[162:163], v24 offset:53248
    v_mfma_f32_16x16x32_bf16 a[44:47], a[176:179], v[184:187], a[44:47]
    v_mfma_f32_16x16x32_bf16 a[44:47], a[180:183], v[188:191], a[44:47]
    s_waitcnt lgkmcnt(4)
    buffer_load_dwordx4 v47, s[20:23], s49 offen offset:1024 lds
    v_mfma_f32_16x16x32_bf16 a[48:51], a[184:187], v[160:163], a[48:51]
    s_waitcnt lgkmcnt(2)
    ds_read_b64_tr_b16 a[164:165], v24 offset:57344
    v_accvgpr_read_b32 v216, a192
    v_mfma_f32_16x16x32_bf16 a[48:51], a[188:191], v[164:167], a[48:51]
    ds_read_b64_tr_b16 a[166:167], v24 offset:61440
    v_accvgpr_read_b32 v217, a193
    v_mfma_f32_16x16x32_bf16 a[52:55], a[184:187], v[168:171], a[52:55]
    v_accvgpr_read_b32 v218, a196
    v_accvgpr_read_b32 v219, a197
    v_mfma_f32_16x16x32_bf16 a[52:55], a[188:191], v[172:175], a[52:55]
    v_accvgpr_read_b32 v220, a200
    v_accvgpr_read_b32 v221, a201
    v_mfma_f32_16x16x32_bf16 a[56:59], a[184:187], v[176:179], a[56:59]
    ds_read_b64_tr_b16 a[168:169], v25 offset:49152
    v_accvgpr_read_b32 v222, a204
    v_mfma_f32_16x16x32_bf16 a[56:59], a[188:191], v[180:183], a[56:59]
    ds_read_b64_tr_b16 a[170:171], v25 offset:53248
    v_accvgpr_read_b32 v223, a205
    v_mfma_f32_16x16x32_bf16 a[60:63], a[184:187], v[184:187], a[60:63]
    v_add_f32 v58, v216, v217
    v_add_f32 v59, v218, v219
    v_mfma_f32_16x16x32_bf16 a[60:63], a[188:191], v[188:191], a[60:63]
    s_waitcnt lgkmcnt(4)
    buffer_load_dwordx4 v48, s[20:23], s49 offen offset:2048 lds
    v_add_f32 v60, v220, v221
    v_add_f32 v61, v222, v223
    v_mfma_f32_16x16x32_bf16 a[64:67], a[160:163], v[160:163], a[64:67]
    s_waitcnt lgkmcnt(2)
    ds_read_b64_tr_b16 a[172:173], v25 offset:57344
    v_add_f32 v216, v58, v59
    v_mfma_f32_16x16x32_bf16 a[64:67], a[164:167], v[164:167], a[64:67]
    ds_read_b64_tr_b16 a[174:175], v25 offset:61440
    v_add_f32 v217, v60, v61
    v_mfma_f32_16x16x32_bf16 a[68:71], a[160:163], v[168:171], a[68:71]
    v_add_f32 v216, v216, v217
    v_cmp_ngt_f32 vcc, 1602224128, v216
    v_mfma_f32_16x16x32_bf16 a[68:71], a[164:167], v[172:175], a[68:71]
    v_rcp_f32 v58, v58
    v_rcp_f32 v59, v59
    v_mfma_f32_16x16x32_bf16 a[72:75], a[160:163], v[176:179], a[72:75]
    ds_read_b64_tr_b16 a[176:177], v26 offset:49152
    v_rcp_f32 v60, v60
    v_mfma_f32_16x16x32_bf16 a[72:75], a[164:167], v[180:183], a[72:75]
    ds_read_b64_tr_b16 a[178:179], v26 offset:53248
    v_rcp_f32 v61, v61
    v_mfma_f32_16x16x32_bf16 a[76:79], a[160:163], v[184:187], a[76:79]
    v_mov_b32 v228, 81920
    s_or_b32 s36, vcc_lo, vcc_hi
    v_mfma_f32_16x16x32_bf16 a[76:79], a[164:167], v[188:191], a[76:79]
    s_waitcnt lgkmcnt(4)
    buffer_load_dwordx4 v49, s[20:23], s49 offen offset:3072 lds
    v_mov_b32 v218, s36
    s_lshl_b32 s37, s3, 2
    v_mfma_f32_16x16x32_bf16 a[80:83], a[168:171], v[160:163], a[80:83]
    s_waitcnt lgkmcnt(2)
    ds_read_b64_tr_b16 a[180:181], v26 offset:57344
    v_add_u32 v219, s37, v228
    ds_write_b32 v219, v218
    v_mfma_f32_16x16x32_bf16 a[80:83], a[172:175], v[164:167], a[80:83]
    ds_read_b64_tr_b16 a[182:183], v26 offset:61440
    v_mfma_f32_16x16x32_bf16 a[84:87], a[168:171], v[168:171], a[84:87]
    v_mfma_f32_16x16x32_bf16 a[84:87], a[172:175], v[172:175], a[84:87]
    s_waitcnt lgkmcnt(1)
    s_waitcnt vmcnt(12)
    s_barrier
    v_mfma_f32_16x16x32_bf16 a[88:91], a[168:171], v[176:179], a[88:91]
    ds_read_b64_tr_b16 a[184:185], v27 offset:49152
    v_mfma_f32_16x16x32_bf16 a[88:91], a[172:175], v[180:183], a[88:91]
    ds_read_b64_tr_b16 a[186:187], v27 offset:53248
    v_mfma_f32_16x16x32_bf16 a[92:95], a[168:171], v[184:187], a[92:95]
    ds_read_b128 v[224:227], v228
    v_mfma_f32_16x16x32_bf16 a[92:95], a[172:175], v[188:191], a[92:95]
    s_add_u32 s49, s45, 73984
    v_mfma_f32_16x16x32_bf16 a[96:99], a[176:179], v[160:163], a[96:99]
    s_waitcnt lgkmcnt(3)
    s_add_u32 m0, s42, 49152
    ds_read_b64_tr_b16 a[188:189], v27 offset:57344
    v_mfma_f32_16x16x32_bf16 a[96:99], a[180:183], v[164:167], a[96:99]
    ds_read_b64_tr_b16 a[190:191], v27 offset:61440
    buffer_load_dwordx4 v46, s[20:23], s49 offen lds
    v_mfma_f32_16x16x32_bf16 a[100:103], a[176:179], v[168:171], a[100:103]
    v_mfma_f32_16x16x32_bf16 a[100:103], a[180:183], v[172:175], a[100:103]
    buffer_load_dwordx4 v47, s[20:23], s49 offen offset:1024 lds
    v_mfma_f32_16x16x32_bf16 a[104:107], a[176:179], v[176:179], a[104:107]
    v_mfma_f32_16x16x32_bf16 a[104:107], a[180:183], v[180:183], a[104:107]
    buffer_load_dwordx4 v48, s[20:23], s49 offen offset:2048 lds
    v_mfma_f32_16x16x32_bf16 a[108:111], a[176:179], v[184:187], a[108:111]
    v_mfma_f32_16x16x32_bf16 a[108:111], a[180:183], v[188:191], a[108:111]
    s_waitcnt lgkmcnt(3)
    buffer_load_dwordx4 v49, s[20:23], s49 offen offset:3072 lds
    s_add_u32 s49, s45, 384
    v_mfma_f32_16x16x32_bf16 a[112:115], a[184:187], v[160:163], a[112:115]
    s_waitcnt lgkmcnt(0)
    s_add_u32 m0, s42, 65536
    v_mfma_f32_16x16x32_bf16 a[112:115], a[188:191], v[164:167], a[112:115]
    buffer_load_dwordx4 v46, s[20:23], s49 offen lds
    v_mfma_f32_16x16x32_bf16 a[116:119], a[184:187], v[168:171], a[116:119]
    v_mfma_f32_16x16x32_bf16 a[116:119], a[188:191], v[172:175], a[116:119]
    buffer_load_dwordx4 v47, s[20:23], s49 offen offset:1024 lds
    v_mfma_f32_16x16x32_bf16 a[120:123], a[184:187], v[176:179], a[120:123]
    v_mfma_f32_16x16x32_bf16 a[120:123], a[188:191], v[180:183], a[120:123]
    buffer_load_dwordx4 v48, s[20:23], s49 offen offset:2048 lds
    v_mfma_f32_16x16x32_bf16 a[124:127], a[184:187], v[184:187], a[124:127]
    v_mfma_f32_16x16x32_bf16 a[124:127], a[188:191], v[188:191], a[124:127]
    buffer_load_dwordx4 v49, s[20:23], s49 offen offset:3072 lds
    v_or3_b32 v224, v224, v225, v226
    v_or_b32 v224, v224, v227
    s_nop 0
    v_readfirstlane_b32 s36, v224
    ds_read_b64_tr_b16 a[128:129], v28 offset:0
    ds_read_b64_tr_b16 a[130:131], v28 offset:4096
    ds_read_b64_tr_b16 a[132:133], v28 offset:8192
    ds_read_b64_tr_b16 a[134:135], v28 offset:12288
    ds_read_b64_tr_b16 a[136:137], v28 offset:16384
    ds_read_b64_tr_b16 a[138:139], v28 offset:20480
    ds_read_b64_tr_b16 a[140:141], v28 offset:24576
    ds_read_b64_tr_b16 a[142:143], v28 offset:28672
    ds_read_b64_tr_b16 a[144:145], v32 offset:0
    ds_read_b64_tr_b16 a[146:147], v32 offset:4096
    ds_read_b64_tr_b16 a[148:149], v32 offset:8192
    ds_read_b64_tr_b16 a[150:151], v32 offset:12288
    ds_read_b64_tr_b16 a[152:153], v32 offset:16384
    ds_read_b64_tr_b16 a[154:155], v32 offset:20480
    ds_read_b64_tr_b16 a[156:157], v32 offset:24576
    ds_read_b64_tr_b16 a[158:159], v32 offset:28672
    s_andn2_b32 s36, s36, s48
    s_cbranch_scc1 Lattn_redo
    v_accvgpr_read_b32 v216, a0
    v_accvgpr_read_b32 v217, a1
    v_accvgpr_read_b32 v218, a2
    v_accvgpr_read_b32 v219, a3
    v_pk_mul_f32 v[216:217], v[216:217], v[58:59] op_sel:[0,0] op_sel_hi:[1,0]
    v_pk_mul_f32 v[218:219], v[218:219], v[58:59] op_sel:[0,0] op_sel_hi:[1,0]
    v_cvt_pk_bf16_f32 v128, v216, v217
    v_cvt_pk_bf16_f32 v129, v218, v219
    v_accvgpr_read_b32 v220, a4
    v_accvgpr_read_b32 v221, a5
    v_accvgpr_read_b32 v222, a6
    v_accvgpr_read_b32 v223, a7
    v_pk_mul_f32 v[220:221], v[220:221], v[58:59] op_sel:[0,1] op_sel_hi:[1,1]
    v_pk_mul_f32 v[222:223], v[222:223], v[58:59] op_sel:[0,1] op_sel_hi:[1,1]
    v_cvt_pk_bf16_f32 v160, v220, v221
    v_cvt_pk_bf16_f32 v161, v222, v223
    v_accvgpr_read_b32 v224, a8
    v_accvgpr_read_b32 v225, a9
    v_accvgpr_read_b32 v226, a10
    v_accvgpr_read_b32 v227, a11
    v_pk_mul_f32 v[224:225], v[224:225], v[60:61] op_sel:[0,0] op_sel_hi:[1,0]
    v_pk_mul_f32 v[226:227], v[226:227], v[60:61] op_sel:[0,0] op_sel_hi:[1,0]
    v_cvt_pk_bf16_f32 v144, v224, v225
    v_cvt_pk_bf16_f32 v145, v226, v227
    v_accvgpr_read_b32 v228, a12
    v_accvgpr_read_b32 v229, a13
    v_accvgpr_read_b32 v230, a14
    v_accvgpr_read_b32 v231, a15
    v_pk_mul_f32 v[228:229], v[228:229], v[60:61] op_sel:[0,1] op_sel_hi:[1,1]
    v_pk_mul_f32 v[230:231], v[230:231], v[60:61] op_sel:[0,1] op_sel_hi:[1,1]
    v_cvt_pk_bf16_f32 v176, v228, v229
    v_cvt_pk_bf16_f32 v177, v230, v231
    v_accvgpr_read_b32 v216, a16
    v_accvgpr_read_b32 v217, a17
    v_accvgpr_read_b32 v218, a18
    v_accvgpr_read_b32 v219, a19
    v_pk_mul_f32 v[216:217], v[216:217], v[58:59] op_sel:[0,0] op_sel_hi:[1,0]
    v_pk_mul_f32 v[218:219], v[218:219], v[58:59] op_sel:[0,0] op_sel_hi:[1,0]
    v_cvt_pk_bf16_f32 v130, v216, v217
    v_cvt_pk_bf16_f32 v131, v218, v219
    v_accvgpr_read_b32 v220, a20
    v_accvgpr_read_b32 v221, a21
    v_accvgpr_read_b32 v222, a22
    v_accvgpr_read_b32 v223, a23
    v_pk_mul_f32 v[220:221], v[220:221], v[58:59] op_sel:[0,1] op_sel_hi:[1,1]
    v_pk_mul_f32 v[222:223], v[222:223], v[58:59] op_sel:[0,1] op_sel_hi:[1,1]
    v_cvt_pk_bf16_f32 v162, v220, v221
    v_cvt_pk_bf16_f32 v163, v222, v223
    v_accvgpr_read_b32 v224, a24
    v_accvgpr_read_b32 v225, a25
    v_accvgpr_read_b32 v226, a26
    v_accvgpr_read_b32 v227, a27
    v_pk_mul_f32 v[224:225], v[224:225], v[60:61] op_sel:[0,0] op_sel_hi:[1,0]
    v_pk_mul_f32 v[226:227], v[226:227], v[60:61] op_sel:[0,0] op_sel_hi:[1,0]
    v_cvt_pk_bf16_f32 v146, v224, v225
    v_cvt_pk_bf16_f32 v147, v226, v227
    v_accvgpr_read_b32 v228, a28
    v_accvgpr_read_b32 v229, a29
    v_accvgpr_read_b32 v230, a30
    v_accvgpr_read_b32 v231, a31
    v_pk_mul_f32 v[228:229], v[228:229], v[60:61] op_sel:[0,1] op_sel_hi:[1,1]
    v_pk_mul_f32 v[230:231], v[230:231], v[60:61] op_sel:[0,1] op_sel_hi:[1,1]
    v_cvt_pk_bf16_f32 v178, v228, v229
    v_cvt_pk_bf16_f32 v179, v230, v231
    v_accvgpr_read_b32 v216, a32
    v_accvgpr_read_b32 v217, a33
    v_accvgpr_read_b32 v218, a34
    v_accvgpr_read_b32 v219, a35
    v_pk_mul_f32 v[216:217], v[216:217], v[58:59] op_sel:[0,0] op_sel_hi:[1,0]
    v_pk_mul_f32 v[218:219], v[218:219], v[58:59] op_sel:[0,0] op_sel_hi:[1,0]
    v_cvt_pk_bf16_f32 v132, v216, v217
    v_cvt_pk_bf16_f32 v133, v218, v219
    v_accvgpr_read_b32 v220, a36
    v_accvgpr_read_b32 v221, a37
    v_accvgpr_read_b32 v222, a38
    v_accvgpr_read_b32 v223, a39
    v_pk_mul_f32 v[220:221], v[220:221], v[58:59] op_sel:[0,1] op_sel_hi:[1,1]
    v_pk_mul_f32 v[222:223], v[222:223], v[58:59] op_sel:[0,1] op_sel_hi:[1,1]
    v_cvt_pk_bf16_f32 v164, v220, v221
    v_cvt_pk_bf16_f32 v165, v222, v223
    v_accvgpr_read_b32 v224, a40
    v_accvgpr_read_b32 v225, a41
    v_accvgpr_read_b32 v226, a42
    v_accvgpr_read_b32 v227, a43
    v_pk_mul_f32 v[224:225], v[224:225], v[60:61] op_sel:[0,0] op_sel_hi:[1,0]
    v_pk_mul_f32 v[226:227], v[226:227], v[60:61] op_sel:[0,0] op_sel_hi:[1,0]
    v_cvt_pk_bf16_f32 v148, v224, v225
    v_cvt_pk_bf16_f32 v149, v226, v227
    v_accvgpr_read_b32 v228, a44
    v_accvgpr_read_b32 v229, a45
    v_accvgpr_read_b32 v230, a46
    v_accvgpr_read_b32 v231, a47
    v_pk_mul_f32 v[228:229], v[228:229], v[60:61] op_sel:[0,1] op_sel_hi:[1,1]
    v_pk_mul_f32 v[230:231], v[230:231], v[60:61] op_sel:[0,1] op_sel_hi:[1,1]
    v_cvt_pk_bf16_f32 v180, v228, v229
    v_cvt_pk_bf16_f32 v181, v230, v231
    v_accvgpr_read_b32 v216, a48
    v_accvgpr_read_b32 v217, a49
    v_accvgpr_read_b32 v218, a50
    v_accvgpr_read_b32 v219, a51
    v_pk_mul_f32 v[216:217], v[216:217], v[58:59] op_sel:[0,0] op_sel_hi:[1,0]
    v_pk_mul_f32 v[218:219], v[218:219], v[58:59] op_sel:[0,0] op_sel_hi:[1,0]
    v_cvt_pk_bf16_f32 v134, v216, v217
    v_cvt_pk_bf16_f32 v135, v218, v219
    v_accvgpr_read_b32 v220, a52
    v_accvgpr_read_b32 v221, a53
    v_accvgpr_read_b32 v222, a54
    v_accvgpr_read_b32 v223, a55
    v_pk_mul_f32 v[220:221], v[220:221], v[58:59] op_sel:[0,1] op_sel_hi:[1,1]
    v_pk_mul_f32 v[222:223], v[222:223], v[58:59] op_sel:[0,1] op_sel_hi:[1,1]
    v_cvt_pk_bf16_f32 v166, v220, v221
    v_cvt_pk_bf16_f32 v167, v222, v223
    v_accvgpr_read_b32 v224, a56
    v_accvgpr_read_b32 v225, a57
    v_accvgpr_read_b32 v226, a58
    v_accvgpr_read_b32 v227, a59
    v_pk_mul_f32 v[224:225], v[224:225], v[60:61] op_sel:[0,0] op_sel_hi:[1,0]
    v_pk_mul_f32 v[226:227], v[226:227], v[60:61] op_sel:[0,0] op_sel_hi:[1,0]
    v_cvt_pk_bf16_f32 v150, v224, v225
    v_cvt_pk_bf16_f32 v151, v226, v227
    v_accvgpr_read_b32 v228, a60
    v_accvgpr_read_b32 v229, a61
    v_accvgpr_read_b32 v230, a62
    v_accvgpr_read_b32 v231, a63
    v_pk_mul_f32 v[228:229], v[228:229], v[60:61] op_sel:[0,1] op_sel_hi:[1,1]
    v_pk_mul_f32 v[230:231], v[230:231], v[60:61] op_sel:[0,1] op_sel_hi:[1,1]
    v_cvt_pk_bf16_f32 v182, v228, v229
    v_cvt_pk_bf16_f32 v183, v230, v231
    v_accvgpr_read_b32 v216, a64
    v_accvgpr_read_b32 v217, a65
    v_accvgpr_read_b32 v218, a66
    v_accvgpr_read_b32 v219, a67
    v_pk_mul_f32 v[216:217], v[216:217], v[58:59] op_sel:[0,0] op_sel_hi:[1,0]
    v_pk_mul_f32 v[218:219], v[218:219], v[58:59] op_sel:[0,0] op_sel_hi:[1,0]
    v_cvt_pk_bf16_f32 v136, v216, v217
    v_cvt_pk_bf16_f32 v137, v218, v219
    v_accvgpr_read_b32 v220, a68
    v_accvgpr_read_b32 v221, a69
    v_accvgpr_read_b32 v222, a70
    v_accvgpr_read_b32 v223, a71
    v_pk_mul_f32 v[220:221], v[220:221], v[58:59] op_sel:[0,1] op_sel_hi:[1,1]
    v_pk_mul_f32 v[222:223], v[222:223], v[58:59] op_sel:[0,1] op_sel_hi:[1,1]
    v_cvt_pk_bf16_f32 v168, v220, v221
    v_cvt_pk_bf16_f32 v169, v222, v223
    v_accvgpr_read_b32 v224, a72
    v_accvgpr_read_b32 v225, a73
    v_accvgpr_read_b32 v226, a74
    v_accvgpr_read_b32 v227, a75
    v_pk_mul_f32 v[224:225], v[224:225], v[60:61] op_sel:[0,0] op_sel_hi:[1,0]
    v_pk_mul_f32 v[226:227], v[226:227], v[60:61] op_sel:[0,0] op_sel_hi:[1,0]
    v_cvt_pk_bf16_f32 v152, v224, v225
    v_cvt_pk_bf16_f32 v153, v226, v227
    v_accvgpr_read_b32 v228, a76
    v_accvgpr_read_b32 v229, a77
    v_accvgpr_read_b32 v230, a78
    v_accvgpr_read_b32 v231, a79
    v_pk_mul_f32 v[228:229], v[228:229], v[60:61] op_sel:[0,1] op_sel_hi:[1,1]
    v_pk_mul_f32 v[230:231], v[230:231], v[60:61] op_sel:[0,1] op_sel_hi:[1,1]
    v_cvt_pk_bf16_f32 v184, v228, v229
    v_cvt_pk_bf16_f32 v185, v230, v231
    v_accvgpr_read_b32 v216, a80
    v_accvgpr_read_b32 v217, a81
    v_accvgpr_read_b32 v218, a82
    v_accvgpr_read_b32 v219, a83
    v_pk_mul_f32 v[216:217], v[216:217], v[58:59] op_sel:[0,0] op_sel_hi:[1,0]
    v_pk_mul_f32 v[218:219], v[218:219], v[58:59] op_sel:[0,0] op_sel_hi:[1,0]
    v_cvt_pk_bf16_f32 v138, v216, v217
    v_cvt_pk_bf16_f32 v139, v218, v219
    v_accvgpr_read_b32 v220, a84
    v_accvgpr_read_b32 v221, a85
    v_accvgpr_read_b32 v222, a86
    v_accvgpr_read_b32 v223, a87
    v_pk_mul_f32 v[220:221], v[220:221], v[58:59] op_sel:[0,1] op_sel_hi:[1,1]
    v_pk_mul_f32 v[222:223], v[222:223], v[58:59] op_sel:[0,1] op_sel_hi:[1,1]
    v_cvt_pk_bf16_f32 v170, v220, v221
    v_cvt_pk_bf16_f32 v171, v222, v223
    v_accvgpr_read_b32 v224, a88
    v_accvgpr_read_b32 v225, a89
    v_accvgpr_read_b32 v226, a90
    v_accvgpr_read_b32 v227, a91
    v_pk_mul_f32 v[224:225], v[224:225], v[60:61] op_sel:[0,0] op_sel_hi:[1,0]
    v_pk_mul_f32 v[226:227], v[226:227], v[60:61] op_sel:[0,0] op_sel_hi:[1,0]
    v_cvt_pk_bf16_f32 v154, v224, v225
    v_cvt_pk_bf16_f32 v155, v226, v227
    v_accvgpr_read_b32 v228, a92
    v_accvgpr_read_b32 v229, a93
    v_accvgpr_read_b32 v230, a94
    v_accvgpr_read_b32 v231, a95
    v_pk_mul_f32 v[228:229], v[228:229], v[60:61] op_sel:[0,1] op_sel_hi:[1,1]
    v_pk_mul_f32 v[230:231], v[230:231], v[60:61] op_sel:[0,1] op_sel_hi:[1,1]
    v_cvt_pk_bf16_f32 v186, v228, v229
    v_cvt_pk_bf16_f32 v187, v230, v231
    v_accvgpr_read_b32 v216, a96
    v_accvgpr_read_b32 v217, a97
    v_accvgpr_read_b32 v218, a98
    v_accvgpr_read_b32 v219, a99
    v_pk_mul_f32 v[216:217], v[216:217], v[58:59] op_sel:[0,0] op_sel_hi:[1,0]
    v_pk_mul_f32 v[218:219], v[218:219], v[58:59] op_sel:[0,0] op_sel_hi:[1,0]
    v_cvt_pk_bf16_f32 v140, v216, v217
    v_cvt_pk_bf16_f32 v141, v218, v219
    v_accvgpr_read_b32 v220, a100
    v_accvgpr_read_b32 v221, a101
    v_accvgpr_read_b32 v222, a102
    v_accvgpr_read_b32 v223, a103
    v_pk_mul_f32 v[220:221], v[220:221], v[58:59] op_sel:[0,1] op_sel_hi:[1,1]
    v_pk_mul_f32 v[222:223], v[222:223], v[58:59] op_sel:[0,1] op_sel_hi:[1,1]
    v_cvt_pk_bf16_f32 v172, v220, v221
    v_cvt_pk_bf16_f32 v173, v222, v223
    v_accvgpr_read_b32 v224, a104
    v_accvgpr_read_b32 v225, a105
    v_accvgpr_read_b32 v226, a106
    v_accvgpr_read_b32 v227, a107
    v_pk_mul_f32 v[224:225], v[224:225], v[60:61] op_sel:[0,0] op_sel_hi:[1,0]
    v_pk_mul_f32 v[226:227], v[226:227], v[60:61] op_sel:[0,0] op_sel_hi:[1,0]
    v_cvt_pk_bf16_f32 v156, v224, v225
    v_cvt_pk_bf16_f32 v157, v226, v227
    v_accvgpr_read_b32 v228, a108
    v_accvgpr_read_b32 v229, a109
    v_accvgpr_read_b32 v230, a110
    v_accvgpr_read_b32 v231, a111
    v_pk_mul_f32 v[228:229], v[228:229], v[60:61] op_sel:[0,1] op_sel_hi:[1,1]
    v_pk_mul_f32 v[230:231], v[230:231], v[60:61] op_sel:[0,1] op_sel_hi:[1,1]
    v_cvt_pk_bf16_f32 v188, v228, v229
    v_cvt_pk_bf16_f32 v189, v230, v231
    v_accvgpr_read_b32 v216, a112
    v_accvgpr_read_b32 v217, a113
    v_accvgpr_read_b32 v218, a114
    v_accvgpr_read_b32 v219, a115
    v_pk_mul_f32 v[216:217], v[216:217], v[58:59] op_sel:[0,0] op_sel_hi:[1,0]
    v_pk_mul_f32 v[218:219], v[218:219], v[58:59] op_sel:[0,0] op_sel_hi:[1,0]
    v_cvt_pk_bf16_f32 v142, v216, v217
    v_cvt_pk_bf16_f32 v143, v218, v219
    v_accvgpr_read_b32 v220, a116
    v_accvgpr_read_b32 v221, a117
    v_accvgpr_read_b32 v222, a118
    v_accvgpr_read_b32 v223, a119
    v_pk_mul_f32 v[220:221], v[220:221], v[58:59] op_sel:[0,1] op_sel_hi:[1,1]
    v_pk_mul_f32 v[222:223], v[222:223], v[58:59] op_sel:[0,1] op_sel_hi:[1,1]
    v_cvt_pk_bf16_f32 v174, v220, v221
    v_cvt_pk_bf16_f32 v175, v222, v223
    v_accvgpr_read_b32 v224, a120
    v_accvgpr_read_b32 v225, a121
    v_accvgpr_read_b32 v226, a122
    v_accvgpr_read_b32 v227, a123
    v_pk_mul_f32 v[224:225], v[224:225], v[60:61] op_sel:[0,0] op_sel_hi:[1,0]
    v_pk_mul_f32 v[226:227], v[226:227], v[60:61] op_sel:[0,0] op_sel_hi:[1,0]
    v_cvt_pk_bf16_f32 v158, v224, v225
    v_cvt_pk_bf16_f32 v159, v226, v227
    v_accvgpr_read_b32 v228, a124
    v_accvgpr_read_b32 v229, a125
    v_accvgpr_read_b32 v230, a126
    v_accvgpr_read_b32 v231, a127
    v_pk_mul_f32 v[228:229], v[228:229], v[60:61] op_sel:[0,1] op_sel_hi:[1,1]
    v_pk_mul_f32 v[230:231], v[230:231], v[60:61] op_sel:[0,1] op_sel_hi:[1,1]
    v_cvt_pk_bf16_f32 v190, v228, v229
    v_cvt_pk_bf16_f32 v191, v230, v231
    s_waitcnt lgkmcnt(14)
    v_mfma_f32_16x16x32_bf16 v[192:195], a[128:131], v[128:131], 0
    s_waitcnt lgkmcnt(12)
    ds_read_b64_tr_b16 a[160:161], v29 offset:0
    v_mfma_f32_16x16x32_bf16 v[192:195], a[132:135], v[132:135], v[192:195]
    s_waitcnt lgkmcnt(11)
    ds_read_b64_tr_b16 a[162:163], v29 offset:4096
    v_mfma_f32_16x16x32_bf16 v[192:195], a[136:139], v[136:139], v[192:195]
    s_waitcnt lgkmcnt(10)
    ds_read_b64_tr_b16 a[164:165], v29 offset:8192
    v_mfma_f32_16x16x32_bf16 v[192:195], a[140:143], v[140:143], v[192:195]
    s_waitcnt lgkmcnt(9)
    ds_read_b64_tr_b16 a[166:167], v29 offset:12288
    v_mfma_f32_16x16x32_bf16 v[192:195], a[144:147], v[144:147], v[192:195]
    s_waitcnt lgkmcnt(8)
    ds_read_b64_tr_b16 a[168:169], v29 offset:16384
    v_mfma_f32_16x16x32_bf16 v[192:195], a[148:151], v[148:151], v[192:195]
    s_waitcnt lgkmcnt(7)
    ds_read_b64_tr_b16 a[170:171], v29 offset:20480
    v_mfma_f32_16x16x32_bf16 v[192:195], a[152:155], v[152:155], v[192:195]
    s_waitcnt lgkmcnt(6)
    ds_read_b64_tr_b16 a[172:173], v29 offset:24576
    v_mfma_f32_16x16x32_bf16 v[192:195], a[156:159], v[156:159], v[192:195]
    ds_read_b64_tr_b16 a[174:175], v29 offset:28672
    v_mfma_f32_16x16x32_bf16 v[196:199], a[128:131], v[160:163], 0
    ds_read_b64_tr_b16 a[176:177], v33 offset:0
    v_mfma_f32_16x16x32_bf16 v[196:199], a[132:135], v[164:167], v[196:199]
    ds_read_b64_tr_b16 a[178:179], v33 offset:4096
    v_mfma_f32_16x16x32_bf16 v[196:199], a[136:139], v[168:171], v[196:199]
    ds_read_b64_tr_b16 a[180:181], v33 offset:8192
    v_mfma_f32_16x16x32_bf16 v[196:199], a[140:143], v[172:175], v[196:199]
    ds_read_b64_tr_b16 a[182:183], v33 offset:12288
    v_mfma_f32_16x16x32_bf16 v[196:199], a[144:147], v[176:179], v[196:199]
    ds_read_b64_tr_b16 a[184:185], v33 offset:16384
    v_cvt_pk_bf16_f32 v224, v192, v193
    v_mfma_f32_16x16x32_bf16 v[196:199], a[148:151], v[180:183], v[196:199]
    ds_read_b64_tr_b16 a[186:187], v33 offset:20480
    v_cvt_pk_bf16_f32 v225, v194, v195
    v_mfma_f32_16x16x32_bf16 v[196:199], a[152:155], v[184:187], v[196:199]
    ds_read_b64_tr_b16 a[188:189], v33 offset:24576
    v_mfma_f32_16x16x32_bf16 v[196:199], a[156:159], v[188:191], v[196:199]
    s_waitcnt lgkmcnt(13)
    ds_read_b64_tr_b16 a[190:191], v33 offset:28672
    v_mfma_f32_16x16x32_bf16 v[200:203], a[160:163], v[128:131], 0
    s_waitcnt lgkmcnt(12)
    ds_read_b64_tr_b16 a[128:129], v30 offset:0
    v_mfma_f32_16x16x32_bf16 v[200:203], a[164:167], v[132:135], v[200:203]
    s_waitcnt lgkmcnt(11)
    ds_read_b64_tr_b16 a[130:131], v30 offset:4096
    v_mfma_f32_16x16x32_bf16 v[200:203], a[168:171], v[136:139], v[200:203]
    s_waitcnt lgkmcnt(10)
    ds_read_b64_tr_b16 a[132:133], v30 offset:8192
    v_mfma_f32_16x16x32_bf16 v[200:203], a[172:175], v[140:143], v[200:203]
    s_waitcnt lgkmcnt(9)
    ds_read_b64_tr_b16 a[134:135], v30 offset:12288
    v_mfma_f32_16x16x32_bf16 v[200:203], a[176:179], v[144:147], v[200:203]
    s_waitcnt lgkmcnt(8)
    ds_read_b64_tr_b16 a[136:137], v30 offset:16384
    v_cvt_pk_bf16_f32 v228, v196, v197
    v_mfma_f32_16x16x32_bf16 v[200:203], a[180:183], v[148:151], v[200:203]
    s_waitcnt lgkmcnt(7)
    ds_read_b64_tr_b16 a[138:139], v30 offset:20480
    v_cvt_pk_bf16_f32 v229, v198, v199
    v_mfma_f32_16x16x32_bf16 v[200:203], a[184:187], v[152:155], v[200:203]
    s_waitcnt lgkmcnt(6)
    ds_read_b64_tr_b16 a[140:141], v30 offset:24576
    v_mfma_f32_16x16x32_bf16 v[200:203], a[188:191], v[156:159], v[200:203]
    ds_read_b64_tr_b16 a[142:143], v30 offset:28672
    v_mfma_f32_16x16x32_bf16 v[204:207], a[160:163], v[160:163], 0
    ds_read_b64_tr_b16 a[144:145], v34 offset:0
    v_mfma_f32_16x16x32_bf16 v[204:207], a[164:167], v[164:167], v[204:207]
    ds_read_b64_tr_b16 a[146:147], v34 offset:4096
    v_mfma_f32_16x16x32_bf16 v[204:207], a[168:171], v[168:171], v[204:207]
    ds_read_b64_tr_b16 a[148:149], v34 offset:8192
    v_mfma_f32_16x16x32_bf16 v[204:207], a[172:175], v[172:175], v[204:207]
    ds_read_b64_tr_b16 a[150:151], v34 offset:12288
    v_mfma_f32_16x16x32_bf16 v[204:207], a[176:179], v[176:179], v[204:207]
    ds_read_b64_tr_b16 a[152:153], v34 offset:16384
    v_cvt_pk_bf16_f32 v226, v200, v201
    v_mfma_f32_16x16x32_bf16 v[204:207], a[180:183], v[180:183], v[204:207]
    s_add_u32 s38, s47, 0
    ds_read_b64_tr_b16 a[154:155], v34 offset:20480
    v_cvt_pk_bf16_f32 v227, v202, v203
    v_mfma_f32_16x16x32_bf16 v[204:207], a[184:187], v[184:187], v[204:207]
    ds_read_b64_tr_b16 a[156:157], v34 offset:24576
    buffer_store_dwordx4 v[224:227], v56, s[28:31], s38 offen
    v_mfma_f32_16x16x32_bf16 v[204:207], a[188:191], v[188:191], v[204:207]
    s_waitcnt lgkmcnt(13)
    ds_read_b64_tr_b16 a[158:159], v34 offset:28672
    v_mfma_f32_16x16x32_bf16 v[192:195], a[128:131], v[128:131], 0
    s_waitcnt lgkmcnt(12)
    ds_read_b64_tr_b16 a[160:161], v31 offset:0
    v_mfma_f32_16x16x32_bf16 v[192:195], a[132:135], v[132:135], v[192:195]
    s_waitcnt lgkmcnt(11)
    ds_read_b64_tr_b16 a[162:163], v31 offset:4096
    v_mfma_f32_16x16x32_bf16 v[192:195], a[136:139], v[136:139], v[192:195]
    s_waitcnt lgkmcnt(10)
    ds_read_b64_tr_b16 a[164:165], v31 offset:8192
    v_mfma_f32_16x16x32_bf16 v[192:195], a[140:143], v[140:143], v[192:195]
    s_waitcnt lgkmcnt(9)
    ds_read_b64_tr_b16 a[166:167], v31 offset:12288
    v_mfma_f32_16x16x32_bf16 v[192:195], a[144:147], v[144:147], v[192:195]
    s_waitcnt lgkmcnt(8)
    ds_read_b64_tr_b16 a[168:169], v31 offset:16384
    v_cvt_pk_bf16_f32 v230, v204, v205
    v_mfma_f32_16x16x32_bf16 v[192:195], a[148:151], v[148:151], v[192:195]
    s_waitcnt lgkmcnt(7)
    s_add_u32 s38, s47, 294912
    ds_read_b64_tr_b16 a[170:171], v31 offset:20480
    v_cvt_pk_bf16_f32 v231, v206, v207
    v_mfma_f32_16x16x32_bf16 v[192:195], a[152:155], v[152:155], v[192:195]
    s_waitcnt lgkmcnt(6)
    ds_read_b64_tr_b16 a[172:173], v31 offset:24576
    buffer_store_dwordx4 v[228:231], v56, s[28:31], s38 offen
    v_mfma_f32_16x16x32_bf16 v[192:195], a[156:159], v[156:159], v[192:195]
    ds_read_b64_tr_b16 a[174:175], v31 offset:28672
    v_mfma_f32_16x16x32_bf16 v[196:199], a[128:131], v[160:163], 0
    ds_read_b64_tr_b16 a[176:177], v35 offset:0
    v_mfma_f32_16x16x32_bf16 v[196:199], a[132:135], v[164:167], v[196:199]
    ds_read_b64_tr_b16 a[178:179], v35 offset:4096
    v_mfma_f32_16x16x32_bf16 v[196:199], a[136:139], v[168:171], v[196:199]
    ds_read_b64_tr_b16 a[180:181], v35 offset:8192
    v_mfma_f32_16x16x32_bf16 v[196:199], a[140:143], v[172:175], v[196:199]
    ds_read_b64_tr_b16 a[182:183], v35 offset:12288
    v_mfma_f32_16x16x32_bf16 v[196:199], a[144:147], v[176:179], v[196:199]
    ds_read_b64_tr_b16 a[184:185], v35 offset:16384
    v_cvt_pk_bf16_f32 v232, v192, v193
    v_mfma_f32_16x16x32_bf16 v[196:199], a[148:151], v[180:183], v[196:199]
    ds_read_b64_tr_b16 a[186:187], v35 offset:20480
    v_cvt_pk_bf16_f32 v233, v194, v195
    v_mfma_f32_16x16x32_bf16 v[196:199], a[152:155], v[184:187], v[196:199]
    ds_read_b64_tr_b16 a[188:189], v35 offset:24576
    v_mfma_f32_16x16x32_bf16 v[196:199], a[156:159], v[188:191], v[196:199]
    s_waitcnt lgkmcnt(13)
    ds_read_b64_tr_b16 a[190:191], v35 offset:28672
    s_waitcnt vmcnt(14)
    s_barrier
    v_mfma_f32_16x16x32_bf16 v[200:203], a[160:163], v[128:131], 0
    s_waitcnt lgkmcnt(12)
    ds_read_b64_tr_b16 a[128:129], v12 offset:0
    v_mfma_f32_16x16x32_bf16 v[200:203], a[164:167], v[132:135], v[200:203]
    s_waitcnt lgkmcnt(11)
    s_add_u32 s49, s45, 74112
    ds_read_b64_tr_b16 a[130:131], v12 offset:4096
    v_mfma_f32_16x16x32_bf16 v[200:203], a[168:171], v[136:139], v[200:203]
    s_waitcnt lgkmcnt(10)
    s_add_u32 m0, s42, 81920
    ds_read_b64_tr_b16 a[132:133], v12 offset:8192
    v_mfma_f32_16x16x32_bf16 v[200:203], a[172:175], v[140:143], v[200:203]
    s_waitcnt lgkmcnt(9)
    ds_read_b64_tr_b16 a[134:135], v12 offset:12288
    buffer_load_dwordx4 v46, s[20:23], s49 offen lds
    v_mfma_f32_16x16x32_bf16 v[200:203], a[176:179], v[144:147], v[200:203]
    s_waitcnt lgkmcnt(8)
    ds_read_b64_tr_b16 a[136:137], v12 offset:16384
    v_cvt_pk_bf16_f32 v236, v196, v197
    v_mfma_f32_16x16x32_bf16 v[200:203], a[180:183], v[148:151], v[200:203]
    s_waitcnt lgkmcnt(7)
    ds_read_b64_tr_b16 a[138:139], v12 offset:20480
    v_cvt_pk_bf16_f32 v237, v198, v199
    v_mfma_f32_16x16x32_bf16 v[200:203], a[184:187], v[152:155], v[200:203]
    s_waitcnt lgkmcnt(6)
    ds_read_b64_tr_b16 a[140:141], v12 offset:24576
    v_mfma_f32_16x16x32_bf16 v[200:203], a[188:191], v[156:159], v[200:203]
    ds_read_b64_tr_b16 a[142:143], v12 offset:28672
    buffer_load_dwordx4 v47, s[20:23], s49 offen offset:1024 lds
    v_mfma_f32_16x16x32_bf16 v[204:207], a[160:163], v[160:163], 0
    ds_read_b64_tr_b16 a[144:145], v16 offset:0
    v_mfma_f32_16x16x32_bf16 v[204:207], a[164:167], v[164:167], v[204:207]
    ds_read_b64_tr_b16 a[146:147], v16 offset:4096
    v_mfma_f32_16x16x32_bf16 v[204:207], a[168:171], v[168:171], v[204:207]
    ds_read_b64_tr_b16 a[148:149], v16 offset:8192
    v_mfma_f32_16x16x32_bf16 v[204:207], a[172:175], v[172:175], v[204:207]
    ds_read_b64_tr_b16 a[150:151], v16 offset:12288
    buffer_load_dwordx4 v48, s[20:23], s49 offen offset:2048 lds
    v_mfma_f32_16x16x32_bf16 v[204:207], a[176:179], v[176:179], v[204:207]
    ds_read_b64_tr_b16 a[152:153], v16 offset:16384
    v_cvt_pk_bf16_f32 v234, v200, v201
    v_mfma_f32_16x16x32_bf16 v[204:207], a[180:183], v[180:183], v[204:207]
    s_add_u32 s38, s47, 512
    ds_read_b64_tr_b16 a[154:155], v16 offset:20480
    v_cvt_pk_bf16_f32 v235, v202, v203
    v_mfma_f32_16x16x32_bf16 v[204:207], a[184:187], v[184:187], v[204:207]
    ds_read_b64_tr_b16 a[156:157], v16 offset:24576
    buffer_store_dwordx4 v[232:235], v56, s[28:31], s38 offen
    v_mfma_f32_16x16x32_bf16 v[204:207], a[188:191], v[188:191], v[204:207]
    s_waitcnt lgkmcnt(13)
    ds_read_b64_tr_b16 a[158:159], v16 offset:28672
    buffer_load_dwordx4 v49, s[20:23], s49 offen offset:3072 lds
    v_mfma_f32_16x16x32_bf16 v[192:195], a[128:131], v[128:131], 0
    s_waitcnt lgkmcnt(12)
    ds_read_b64_tr_b16 a[160:161], v13 offset:0
    v_mfma_f32_16x16x32_bf16 v[192:195], a[132:135], v[132:135], v[192:195]
    s_waitcnt lgkmcnt(11)
    s_add_u32 s49, s45, 512
    ds_read_b64_tr_b16 a[162:163], v13 offset:4096
    v_mfma_f32_16x16x32_bf16 v[192:195], a[136:139], v[136:139], v[192:195]
    s_waitcnt lgkmcnt(10)
    s_add_u32 m0, s42, 98304
    ds_read_b64_tr_b16 a[164:165], v13 offset:8192
    v_mfma_f32_16x16x32_bf16 v[192:195], a[140:143], v[140:143], v[192:195]
    s_waitcnt lgkmcnt(9)
    ds_read_b64_tr_b16 a[166:167], v13 offset:12288
    buffer_load_dwordx4 v46, s[20:23], s49 offen lds
    v_mfma_f32_16x16x32_bf16 v[192:195], a[144:147], v[144:147], v[192:195]
    s_waitcnt lgkmcnt(8)
    ds_read_b64_tr_b16 a[168:169], v13 offset:16384
    v_cvt_pk_bf16_f32 v238, v204, v205
    v_mfma_f32_16x16x32_bf16 v[192:195], a[148:151], v[148:151], v[192:195]
    s_waitcnt lgkmcnt(7)
    s_add_u32 s38, s47, 295424
    ds_read_b64_tr_b16 a[170:171], v13 offset:20480
    v_cvt_pk_bf16_f32 v239, v206, v207
    v_mfma_f32_16x16x32_bf16 v[192:195], a[152:155], v[152:155], v[192:195]
    s_waitcnt lgkmcnt(6)
    ds_read_b64_tr_b16 a[172:173], v13 offset:24576
    buffer_store_dwordx4 v[236:239], v56, s[28:31], s38 offen
    v_mfma_f32_16x16x32_bf16 v[192:195], a[156:159], v[156:159], v[192:195]
    ds_read_b64_tr_b16 a[174:175], v13 offset:28672
    buffer_load_dwordx4 v47, s[20:23], s49 offen offset:1024 lds
    v_mfma_f32_16x16x32_bf16 v[196:199], a[128:131], v[160:163], 0
    ds_read_b64_tr_b16 a[176:177], v17 offset:0
    v_mfma_f32_16x16x32_bf16 v[196:199], a[132:135], v[164:167], v[196:199]
    ds_read_b64_tr_b16 a[178:179], v17 offset:4096
    v_mfma_f32_16x16x32_bf16 v[196:199], a[136:139], v[168:171], v[196:199]
    ds_read_b64_tr_b16 a[180:181], v17 offset:8192
    v_mfma_f32_16x16x32_bf16 v[196:199], a[140:143], v[172:175], v[196:199]
    ds_read_b64_tr_b16 a[182:183], v17 offset:12288
    buffer_load_dwordx4 v48, s[20:23], s49 offen offset:2048 lds
    v_mfma_f32_16x16x32_bf16 v[196:199], a[144:147], v[176:179], v[196:199]
    ds_read_b64_tr_b16 a[184:185], v17 offset:16384
    v_cvt_pk_bf16_f32 v224, v192, v193
    v_mfma_f32_16x16x32_bf16 v[196:199], a[148:151], v[180:183], v[196:199]
    ds_read_b64_tr_b16 a[186:187], v17 offset:20480
    v_cvt_pk_bf16_f32 v225, v194, v195
    v_mfma_f32_16x16x32_bf16 v[196:199], a[152:155], v[184:187], v[196:199]
    ds_read_b64_tr_b16 a[188:189], v17 offset:24576
    v_mfma_f32_16x16x32_bf16 v[196:199], a[156:159], v[188:191], v[196:199]
    s_waitcnt lgkmcnt(13)
    ds_read_b64_tr_b16 a[190:191], v17 offset:28672
    buffer_load_dwordx4 v49, s[20:23], s49 offen offset:3072 lds
    v_mfma_f32_16x16x32_bf16 v[200:203], a[160:163], v[128:131], 0
    s_waitcnt lgkmcnt(12)
    ds_read_b64_tr_b16 a[128:129], v14 offset:0
    v_mfma_f32_16x16x32_bf16 v[200:203], a[164:167], v[132:135], v[200:203]
    s_waitcnt lgkmcnt(11)
    s_add_u32 s49, s45, 74240
    ds_read_b64_tr_b16 a[130:131], v14 offset:4096
    v_mfma_f32_16x16x32_bf16 v[200:203], a[168:171], v[136:139], v[200:203]
    s_waitcnt lgkmcnt(10)
    s_add_u32 m0, s42, 114688
    ds_read_b64_tr_b16 a[132:133], v14 offset:8192
    v_mfma_f32_16x16x32_bf16 v[200:203], a[172:175], v[140:143], v[200:203]
    s_waitcnt lgkmcnt(9)
    ds_read_b64_tr_b16 a[134:135], v14 offset:12288
    buffer_load_dwordx4 v46, s[20:23], s49 offen lds
    v_mfma_f32_16x16x32_bf16 v[200:203], a[176:179], v[144:147], v[200:203]
    s_waitcnt lgkmcnt(8)
    ds_read_b64_tr_b16 a[136:137], v14 offset:16384
    v_cvt_pk_bf16_f32 v228, v196, v197
    v_mfma_f32_16x16x32_bf16 v[200:203], a[180:183], v[148:151], v[200:203]
    s_waitcnt lgkmcnt(7)
    ds_read_b64_tr_b16 a[138:139], v14 offset:20480
    v_cvt_pk_bf16_f32 v229, v198, v199
    v_mfma_f32_16x16x32_bf16 v[200:203], a[184:187], v[152:155], v[200:203]
    s_waitcnt lgkmcnt(6)
    ds_read_b64_tr_b16 a[140:141], v14 offset:24576
    v_mfma_f32_16x16x32_bf16 v[200:203], a[188:191], v[156:159], v[200:203]
    ds_read_b64_tr_b16 a[142:143], v14 offset:28672
    buffer_load_dwordx4 v47, s[20:23], s49 offen offset:1024 lds
    v_mfma_f32_16x16x32_bf16 v[204:207], a[160:163], v[160:163], 0
    ds_read_b64_tr_b16 a[144:145], v18 offset:0
    v_mfma_f32_16x16x32_bf16 v[204:207], a[164:167], v[164:167], v[204:207]
    ds_read_b64_tr_b16 a[146:147], v18 offset:4096
    v_mfma_f32_16x16x32_bf16 v[204:207], a[168:171], v[168:171], v[204:207]
    ds_read_b64_tr_b16 a[148:149], v18 offset:8192
    v_mfma_f32_16x16x32_bf16 v[204:207], a[172:175], v[172:175], v[204:207]
    ds_read_b64_tr_b16 a[150:151], v18 offset:12288
    buffer_load_dwordx4 v48, s[20:23], s49 offen offset:2048 lds
    v_mfma_f32_16x16x32_bf16 v[204:207], a[176:179], v[176:179], v[204:207]
    ds_read_b64_tr_b16 a[152:153], v18 offset:16384
    v_cvt_pk_bf16_f32 v226, v200, v201
    v_mfma_f32_16x16x32_bf16 v[204:207], a[180:183], v[180:183], v[204:207]
    s_add_u32 s38, s47, 1024
    ds_read_b64_tr_b16 a[154:155], v18 offset:20480
    v_cvt_pk_bf16_f32 v227, v202, v203
    v_mfma_f32_16x16x32_bf16 v[204:207], a[184:187], v[184:187], v[204:207]
    ds_read_b64_tr_b16 a[156:157], v18 offset:24576
    buffer_store_dwordx4 v[224:227], v56, s[28:31], s38 offen
    v_mfma_f32_16x16x32_bf16 v[204:207], a[188:191], v[188:191], v[204:207]
    s_waitcnt lgkmcnt(13)
    ds_read_b64_tr_b16 a[158:159], v18 offset:28672
    buffer_load_dwordx4 v49, s[20:23], s49 offen offset:3072 lds
    v_mfma_f32_16x16x32_bf16 v[192:195], a[128:131], v[128:131], 0
    s_waitcnt lgkmcnt(12)
    ds_read_b64_tr_b16 a[160:161], v15 offset:0
    v_mfma_f32_16x16x32_bf16 v[192:195], a[132:135], v[132:135], v[192:195]
    s_waitcnt lgkmcnt(11)
    ds_read_b64_tr_b16 a[162:163], v15 offset:4096
    v_mfma_f32_16x16x32_bf16 v[192:195], a[136:139], v[136:139], v[192:195]
    s_waitcnt lgkmcnt(10)
    ds_read_b64_tr_b16 a[164:165], v15 offset:8192
    v_mfma_f32_16x16x32_bf16 v[192:195], a[140:143], v[140:143], v[192:195]
    s_waitcnt lgkmcnt(9)
    ds_read_b64_tr_b16 a[166:167], v15 offset:12288
    v_mfma_f32_16x16x32_bf16 v[192:195], a[144:147], v[144:147], v[192:195]
    s_waitcnt lgkmcnt(8)
    ds_read_b64_tr_b16 a[168:169], v15 offset:16384
    v_cvt_pk_bf16_f32 v230, v204, v205
    v_mfma_f32_16x16x32_bf16 v[192:195], a[148:151], v[148:151], v[192:195]
    s_waitcnt lgkmcnt(7)
    s_add_u32 s38, s47, 295936
    ds_read_b64_tr_b16 a[170:171], v15 offset:20480
    v_cvt_pk_bf16_f32 v231, v206, v207
    v_mfma_f32_16x16x32_bf16 v[192:195], a[152:155], v[152:155], v[192:195]
    s_waitcnt lgkmcnt(6)
    ds_read_b64_tr_b16 a[172:173], v15 offset:24576
    buffer_store_dwordx4 v[228:231], v56, s[28:31], s38 offen
    v_mfma_f32_16x16x32_bf16 v[192:195], a[156:159], v[156:159], v[192:195]
    ds_read_b64_tr_b16 a[174:175], v15 offset:28672
    v_mfma_f32_16x16x32_bf16 v[196:199], a[128:131], v[160:163], 0
    ds_read_b64_tr_b16 a[176:177], v19 offset:0
    v_mfma_f32_16x16x32_bf16 v[196:199], a[132:135], v[164:167], v[196:199]
    ds_read_b64_tr_b16 a[178:179], v19 offset:4096
    v_mfma_f32_16x16x32_bf16 v[196:199], a[136:139], v[168:171], v[196:199]
    ds_read_b64_tr_b16 a[180:181], v19 offset:8192
    v_mfma_f32_16x16x32_bf16 v[196:199], a[140:143], v[172:175], v[196:199]
    ds_read_b64_tr_b16 a[182:183], v19 offset:12288
    v_mfma_f32_16x16x32_bf16 v[196:199], a[144:147], v[176:179], v[196:199]
    ds_read_b64_tr_b16 a[184:185], v19 offset:16384
    v_cvt_pk_bf16_f32 v232, v192, v193
    v_mfma_f32_16x16x32_bf16 v[196:199], a[148:151], v[180:183], v[196:199]
    ds_read_b64_tr_b16 a[186:187], v19 offset:20480
    v_cvt_pk_bf16_f32 v233, v194, v195
    v_mfma_f32_16x16x32_bf16 v[196:199], a[152:155], v[184:187], v[196:199]
    ds_read_b64_tr_b16 a[188:189], v19 offset:24576
    v_mfma_f32_16x16x32_bf16 v[196:199], a[156:159], v[188:191], v[196:199]
    s_waitcnt lgkmcnt(13)
    ds_read_b64_tr_b16 a[190:191], v19 offset:28672
    s_waitcnt vmcnt(22)
    s_barrier
    v_mfma_f32_16x16x32_bf16 v[200:203], a[160:163], v[128:131], 0
    s_waitcnt lgkmcnt(12)
    ds_read_b64_tr_b16 a[128:129], v12 offset:32768
    v_mfma_f32_16x16x32_bf16 v[200:203], a[164:167], v[132:135], v[200:203]
    s_waitcnt lgkmcnt(11)
    s_add_u32 s49, s45, 640
    ds_read_b64_tr_b16 a[130:131], v12 offset:36864
    v_mfma_f32_16x16x32_bf16 v[200:203], a[168:171], v[136:139], v[200:203]
    s_waitcnt lgkmcnt(10)
    s_add_u32 m0, s42, 131072
    ds_read_b64_tr_b16 a[132:133], v12 offset:40960
    v_mfma_f32_16x16x32_bf16 v[200:203], a[172:175], v[140:143], v[200:203]
    s_waitcnt lgkmcnt(9)
    ds_read_b64_tr_b16 a[134:135], v12 offset:45056
    buffer_load_dwordx4 v46, s[20:23], s49 offen lds
    v_mfma_f32_16x16x32_bf16 v[200:203], a[176:179], v[144:147], v[200:203]
    s_waitcnt lgkmcnt(8)
    ds_read_b64_tr_b16 a[136:137], v12 offset:49152
    v_cvt_pk_bf16_f32 v236, v196, v197
    v_mfma_f32_16x16x32_bf16 v[200:203], a[180:183], v[148:151], v[200:203]
    s_waitcnt lgkmcnt(7)
    ds_read_b64_tr_b16 a[138:139], v12 offset:53248
    v_cvt_pk_bf16_f32 v237, v198, v199
    v_mfma_f32_16x16x32_bf16 v[200:203], a[184:187], v[152:155], v[200:203]
    s_waitcnt lgkmcnt(6)
    ds_read_b64_tr_b16 a[140:141], v12 offset:57344
    v_mfma_f32_16x16x32_bf16 v[200:203], a[188:191], v[156:159], v[200:203]
    ds_read_b64_tr_b16 a[142:143], v12 offset:61440
    buffer_load_dwordx4 v47, s[20:23], s49 offen offset:1024 lds
    v_mfma_f32_16x16x32_bf16 v[204:207], a[160:163], v[160:163], 0
    ds_read_b64_tr_b16 a[144:145], v16 offset:32768
    v_mfma_f32_16x16x32_bf16 v[204:207], a[164:167], v[164:167], v[204:207]
    ds_read_b64_tr_b16 a[146:147], v16 offset:36864
    v_mfma_f32_16x16x32_bf16 v[204:207], a[168:171], v[168:171], v[204:207]
    ds_read_b64_tr_b16 a[148:149], v16 offset:40960
    v_mfma_f32_16x16x32_bf16 v[204:207], a[172:175], v[172:175], v[204:207]
    ds_read_b64_tr_b16 a[150:151], v16 offset:45056
    buffer_load_dwordx4 v48, s[20:23], s49 offen offset:2048 lds
    v_mfma_f32_16x16x32_bf16 v[204:207], a[176:179], v[176:179], v[204:207]
    ds_read_b64_tr_b16 a[152:153], v16 offset:49152
    v_cvt_pk_bf16_f32 v234, v200, v201
    v_mfma_f32_16x16x32_bf16 v[204:207], a[180:183], v[180:183], v[204:207]
    s_add_u32 s38, s47, 1536
    ds_read_b64_tr_b16 a[154:155], v16 offset:53248
    v_cvt_pk_bf16_f32 v235, v202, v203
    v_mfma_f32_16x16x32_bf16 v[204:207], a[184:187], v[184:187], v[204:207]
    ds_read_b64_tr_b16 a[156:157], v16 offset:57344
    buffer_store_dwordx4 v[232:235], v56, s[28:31], s38 offen
    v_mfma_f32_16x16x32_bf16 v[204:207], a[188:191], v[188:191], v[204:207]
    s_waitcnt lgkmcnt(13)
    ds_read_b64_tr_b16 a[158:159], v16 offset:61440
    buffer_load_dwordx4 v49, s[20:23], s49 offen offset:3072 lds
    v_mfma_f32_16x16x32_bf16 v[192:195], a[128:131], v[128:131], 0
    s_waitcnt lgkmcnt(12)
    ds_read_b64_tr_b16 a[160:161], v13 offset:32768
    v_mfma_f32_16x16x32_bf16 v[192:195], a[132:135], v[132:135], v[192:195]
    s_waitcnt lgkmcnt(11)
    s_add_u32 s49, s45, 74368
    ds_read_b64_tr_b16 a[162:163], v13 offset:36864
    v_mfma_f32_16x16x32_bf16 v[192:195], a[136:139], v[136:139], v[192:195]
    s_waitcnt lgkmcnt(10)
    s_add_u32 m0, s42, 147456
    ds_read_b64_tr_b16 a[164:165], v13 offset:40960
    v_mfma_f32_16x16x32_bf16 v[192:195], a[140:143], v[140:143], v[192:195]
    s_waitcnt lgkmcnt(9)
    ds_read_b64_tr_b16 a[166:167], v13 offset:45056
    buffer_load_dwordx4 v46, s[20:23], s49 offen lds
    v_mfma_f32_16x16x32_bf16 v[192:195], a[144:147], v[144:147], v[192:195]
    s_waitcnt lgkmcnt(8)
    ds_read_b64_tr_b16 a[168:169], v13 offset:49152
    v_cvt_pk_bf16_f32 v238, v204, v205
    v_mfma_f32_16x16x32_bf16 v[192:195], a[148:151], v[148:151], v[192:195]
    s_waitcnt lgkmcnt(7)
    s_add_u32 s38, s47, 296448
    ds_read_b64_tr_b16 a[170:171], v13 offset:53248
    v_cvt_pk_bf16_f32 v239, v206, v207
    v_mfma_f32_16x16x32_bf16 v[192:195], a[152:155], v[152:155], v[192:195]
    s_waitcnt lgkmcnt(6)
    ds_read_b64_tr_b16 a[172:173], v13 offset:57344
    buffer_store_dwordx4 v[236:239], v56, s[28:31], s38 offen
    v_mfma_f32_16x16x32_bf16 v[192:195], a[156:159], v[156:159], v[192:195]
    ds_read_b64_tr_b16 a[174:175], v13 offset:61440
    buffer_load_dwordx4 v47, s[20:23], s49 offen offset:1024 lds
    v_mfma_f32_16x16x32_bf16 v[196:199], a[128:131], v[160:163], 0
    ds_read_b64_tr_b16 a[176:177], v17 offset:32768
    v_mfma_f32_16x16x32_bf16 v[196:199], a[132:135], v[164:167], v[196:199]
    ds_read_b64_tr_b16 a[178:179], v17 offset:36864
    v_mfma_f32_16x16x32_bf16 v[196:199], a[136:139], v[168:171], v[196:199]
    ds_read_b64_tr_b16 a[180:181], v17 offset:40960
    v_mfma_f32_16x16x32_bf16 v[196:199], a[140:143], v[172:175], v[196:199]
    ds_read_b64_tr_b16 a[182:183], v17 offset:45056
    buffer_load_dwordx4 v48, s[20:23], s49 offen offset:2048 lds
    v_mfma_f32_16x16x32_bf16 v[196:199], a[144:147], v[176:179], v[196:199]
    ds_read_b64_tr_b16 a[184:185], v17 offset:49152
    v_cvt_pk_bf16_f32 v224, v192, v193
    v_mfma_f32_16x16x32_bf16 v[196:199], a[148:151], v[180:183], v[196:199]
    ds_read_b64_tr_b16 a[186:187], v17 offset:53248
    v_cvt_pk_bf16_f32 v225, v194, v195
    v_mfma_f32_16x16x32_bf16 v[196:199], a[152:155], v[184:187], v[196:199]
    ds_read_b64_tr_b16 a[188:189], v17 offset:57344
    v_mfma_f32_16x16x32_bf16 v[196:199], a[156:159], v[188:191], v[196:199]
    s_waitcnt lgkmcnt(13)
    ds_read_b64_tr_b16 a[190:191], v17 offset:61440
    buffer_load_dwordx4 v49, s[20:23], s49 offen offset:3072 lds
    v_mfma_f32_16x16x32_bf16 v[200:203], a[160:163], v[128:131], 0
    s_waitcnt lgkmcnt(12)
    ds_read_b64_tr_b16 a[128:129], v14 offset:32768
    v_mfma_f32_16x16x32_bf16 v[200:203], a[164:167], v[132:135], v[200:203]
    s_waitcnt lgkmcnt(11)
    ds_read_b64_tr_b16 a[130:131], v14 offset:36864
    v_mfma_f32_16x16x32_bf16 v[200:203], a[168:171], v[136:139], v[200:203]
    s_waitcnt lgkmcnt(10)
    ds_read_b64_tr_b16 a[132:133], v14 offset:40960
    v_mfma_f32_16x16x32_bf16 v[200:203], a[172:175], v[140:143], v[200:203]
    s_waitcnt lgkmcnt(9)
    ds_read_b64_tr_b16 a[134:135], v14 offset:45056
    v_mfma_f32_16x16x32_bf16 v[200:203], a[176:179], v[144:147], v[200:203]
    s_waitcnt lgkmcnt(8)
    ds_read_b64_tr_b16 a[136:137], v14 offset:49152
    v_cvt_pk_bf16_f32 v228, v196, v197
    v_mfma_f32_16x16x32_bf16 v[200:203], a[180:183], v[148:151], v[200:203]
    s_waitcnt lgkmcnt(7)
    ds_read_b64_tr_b16 a[138:139], v14 offset:53248
    v_cvt_pk_bf16_f32 v229, v198, v199
    v_mfma_f32_16x16x32_bf16 v[200:203], a[184:187], v[152:155], v[200:203]
    s_waitcnt lgkmcnt(6)
    ds_read_b64_tr_b16 a[140:141], v14 offset:57344
    v_mfma_f32_16x16x32_bf16 v[200:203], a[188:191], v[156:159], v[200:203]
    ds_read_b64_tr_b16 a[142:143], v14 offset:61440
    v_mfma_f32_16x16x32_bf16 v[204:207], a[160:163], v[160:163], 0
    ds_read_b64_tr_b16 a[144:145], v18 offset:32768
    v_mfma_f32_16x16x32_bf16 v[204:207], a[164:167], v[164:167], v[204:207]
    ds_read_b64_tr_b16 a[146:147], v18 offset:36864
    v_mfma_f32_16x16x32_bf16 v[204:207], a[168:171], v[168:171], v[204:207]
    ds_read_b64_tr_b16 a[148:149], v18 offset:40960
    v_mfma_f32_16x16x32_bf16 v[204:207], a[172:175], v[172:175], v[204:207]
    ds_read_b64_tr_b16 a[150:151], v18 offset:45056
    v_mfma_f32_16x16x32_bf16 v[204:207], a[176:179], v[176:179], v[204:207]
    ds_read_b64_tr_b16 a[152:153], v18 offset:49152
    v_cvt_pk_bf16_f32 v226, v200, v201
    v_mfma_f32_16x16x32_bf16 v[204:207], a[180:183], v[180:183], v[204:207]
    s_add_u32 s38, s47, 2048
    ds_read_b64_tr_b16 a[154:155], v18 offset:53248
    v_cvt_pk_bf16_f32 v227, v202, v203
    v_mfma_f32_16x16x32_bf16 v[204:207], a[184:187], v[184:187], v[204:207]
    ds_read_b64_tr_b16 a[156:157], v18 offset:57344
    buffer_store_dwordx4 v[224:227], v56, s[28:31], s38 offen
    v_mfma_f32_16x16x32_bf16 v[204:207], a[188:191], v[188:191], v[204:207]
    s_waitcnt lgkmcnt(13)
    ds_read_b64_tr_b16 a[158:159], v18 offset:61440
    v_mfma_f32_16x16x32_bf16 v[192:195], a[128:131], v[128:131], 0
    s_waitcnt lgkmcnt(12)
    ds_read_b64_tr_b16 a[160:161], v15 offset:32768
    v_mfma_f32_16x16x32_bf16 v[192:195], a[132:135], v[132:135], v[192:195]
    s_waitcnt lgkmcnt(11)
    ds_read_b64_tr_b16 a[162:163], v15 offset:36864
    v_mfma_f32_16x16x32_bf16 v[192:195], a[136:139], v[136:139], v[192:195]
    s_waitcnt lgkmcnt(10)
    ds_read_b64_tr_b16 a[164:165], v15 offset:40960
    v_mfma_f32_16x16x32_bf16 v[192:195], a[140:143], v[140:143], v[192:195]
    s_waitcnt lgkmcnt(9)
    ds_read_b64_tr_b16 a[166:167], v15 offset:45056
    v_mfma_f32_16x16x32_bf16 v[192:195], a[144:147], v[144:147], v[192:195]
    s_waitcnt lgkmcnt(8)
    ds_read_b64_tr_b16 a[168:169], v15 offset:49152
    v_cvt_pk_bf16_f32 v230, v204, v205
    v_mfma_f32_16x16x32_bf16 v[192:195], a[148:151], v[148:151], v[192:195]
    s_waitcnt lgkmcnt(7)
    s_add_u32 s38, s47, 296960
    ds_read_b64_tr_b16 a[170:171], v15 offset:53248
    v_cvt_pk_bf16_f32 v231, v206, v207
    v_mfma_f32_16x16x32_bf16 v[192:195], a[152:155], v[152:155], v[192:195]
    s_waitcnt lgkmcnt(6)
    ds_read_b64_tr_b16 a[172:173], v15 offset:57344
    buffer_store_dwordx4 v[228:231], v56, s[28:31], s38 offen
    v_mfma_f32_16x16x32_bf16 v[192:195], a[156:159], v[156:159], v[192:195]
    ds_read_b64_tr_b16 a[174:175], v15 offset:61440
    v_mfma_f32_16x16x32_bf16 v[196:199], a[128:131], v[160:163], 0
    ds_read_b64_tr_b16 a[176:177], v19 offset:32768
    v_mfma_f32_16x16x32_bf16 v[196:199], a[132:135], v[164:167], v[196:199]
    ds_read_b64_tr_b16 a[178:179], v19 offset:36864
    v_mfma_f32_16x16x32_bf16 v[196:199], a[136:139], v[168:171], v[196:199]
    ds_read_b64_tr_b16 a[180:181], v19 offset:40960
    v_mfma_f32_16x16x32_bf16 v[196:199], a[140:143], v[172:175], v[196:199]
    ds_read_b64_tr_b16 a[182:183], v19 offset:45056
    v_mfma_f32_16x16x32_bf16 v[196:199], a[144:147], v[176:179], v[196:199]
    ds_read_b64_tr_b16 a[184:185], v19 offset:49152
    v_cvt_pk_bf16_f32 v232, v192, v193
    v_mfma_f32_16x16x32_bf16 v[196:199], a[148:151], v[180:183], v[196:199]
    ds_read_b64_tr_b16 a[186:187], v19 offset:53248
    v_cvt_pk_bf16_f32 v233, v194, v195
    v_mfma_f32_16x16x32_bf16 v[196:199], a[152:155], v[184:187], v[196:199]
    ds_read_b64_tr_b16 a[188:189], v19 offset:57344
    v_mfma_f32_16x16x32_bf16 v[196:199], a[156:159], v[188:191], v[196:199]
    s_waitcnt lgkmcnt(13)
    ds_read_b64_tr_b16 a[190:191], v19 offset:61440
    s_waitcnt vmcnt(23)
    s_barrier
    v_mfma_f32_16x16x32_bf16 v[200:203], a[160:163], v[128:131], 0
    s_waitcnt lgkmcnt(12)
    ds_read_b64_tr_b16 a[128:129], v20 offset:0
    v_mfma_f32_16x16x32_bf16 v[200:203], a[164:167], v[132:135], v[200:203]
    s_waitcnt lgkmcnt(11)
    s_add_u32 s49, s45, 768
    ds_read_b64_tr_b16 a[130:131], v20 offset:4096
    v_mfma_f32_16x16x32_bf16 v[200:203], a[168:171], v[136:139], v[200:203]
    s_waitcnt lgkmcnt(10)
    s_add_u32 m0, s42, 0
    ds_read_b64_tr_b16 a[132:133], v20 offset:8192
    v_mfma_f32_16x16x32_bf16 v[200:203], a[172:175], v[140:143], v[200:203]
    s_waitcnt lgkmcnt(9)
    ds_read_b64_tr_b16 a[134:135], v20 offset:12288
    buffer_load_dwordx4 v46, s[20:23], s49 offen lds
    v_mfma_f32_16x16x32_bf16 v[200:203], a[176:179], v[144:147], v[200:203]
    s_waitcnt lgkmcnt(8)
    ds_read_b64_tr_b16 a[136:137], v20 offset:16384
    v_cvt_pk_bf16_f32 v236, v196, v197
    v_mfma_f32_16x16x32_bf16 v[200:203], a[180:183], v[148:151], v[200:203]
    s_waitcnt lgkmcnt(7)
    ds_read_b64_tr_b16 a[138:139], v20 offset:20480
    v_cvt_pk_bf16_f32 v237, v198, v199
    v_mfma_f32_16x16x32_bf16 v[200:203], a[184:187], v[152:155], v[200:203]
    s_waitcnt lgkmcnt(6)
    ds_read_b64_tr_b16 a[140:141], v20 offset:24576
    v_mfma_f32_16x16x32_bf16 v[200:203], a[188:191], v[156:159], v[200:203]
    ds_read_b64_tr_b16 a[142:143], v20 offset:28672
    buffer_load_dwordx4 v47, s[20:23], s49 offen offset:1024 lds
    v_mfma_f32_16x16x32_bf16 v[204:207], a[160:163], v[160:163], 0
    ds_read_b64_tr_b16 a[144:145], v24 offset:0
    v_mfma_f32_16x16x32_bf16 v[204:207], a[164:167], v[164:167], v[204:207]
    ds_read_b64_tr_b16 a[146:147], v24 offset:4096
    v_mfma_f32_16x16x32_bf16 v[204:207], a[168:171], v[168:171], v[204:207]
    ds_read_b64_tr_b16 a[148:149], v24 offset:8192
    v_mfma_f32_16x16x32_bf16 v[204:207], a[172:175], v[172:175], v[204:207]
    ds_read_b64_tr_b16 a[150:151], v24 offset:12288
    buffer_load_dwordx4 v48, s[20:23], s49 offen offset:2048 lds
    v_mfma_f32_16x16x32_bf16 v[204:207], a[176:179], v[176:179], v[204:207]
    ds_read_b64_tr_b16 a[152:153], v24 offset:16384
    v_cvt_pk_bf16_f32 v234, v200, v201
    v_mfma_f32_16x16x32_bf16 v[204:207], a[180:183], v[180:183], v[204:207]
    s_add_u32 s38, s47, 2560
    ds_read_b64_tr_b16 a[154:155], v24 offset:20480
    v_cvt_pk_bf16_f32 v235, v202, v203
    v_mfma_f32_16x16x32_bf16 v[204:207], a[184:187], v[184:187], v[204:207]
    ds_read_b64_tr_b16 a[156:157], v24 offset:24576
    buffer_store_dwordx4 v[232:235], v56, s[28:31], s38 offen
    v_mfma_f32_16x16x32_bf16 v[204:207], a[188:191], v[188:191], v[204:207]
    s_waitcnt lgkmcnt(13)
    ds_read_b64_tr_b16 a[158:159], v24 offset:28672
    buffer_load_dwordx4 v49, s[20:23], s49 offen offset:3072 lds
    v_mfma_f32_16x16x32_bf16 v[192:195], a[128:131], v[128:131], 0
    s_waitcnt lgkmcnt(12)
    ds_read_b64_tr_b16 a[160:161], v21 offset:0
    v_mfma_f32_16x16x32_bf16 v[192:195], a[132:135], v[132:135], v[192:195]
    s_waitcnt lgkmcnt(11)
    s_add_u32 s49, s45, 74496
    ds_read_b64_tr_b16 a[162:163], v21 offset:4096
    v_mfma_f32_16x16x32_bf16 v[192:195], a[136:139], v[136:139], v[192:195]
    s_waitcnt lgkmcnt(10)
    s_add_u32 m0, s42, 16384
    ds_read_b64_tr_b16 a[164:165], v21 offset:8192
    v_mfma_f32_16x16x32_bf16 v[192:195], a[140:143], v[140:143], v[192:195]
    s_waitcnt lgkmcnt(9)
    ds_read_b64_tr_b16 a[166:167], v21 offset:12288
    buffer_load_dwordx4 v46, s[20:23], s49 offen lds
    v_mfma_f32_16x16x32_bf16 v[192:195], a[144:147], v[144:147], v[192:195]
    s_waitcnt lgkmcnt(8)
    ds_read_b64_tr_b16 a[168:169], v21 offset:16384
    v_cvt_pk_bf16_f32 v238, v204, v205
    v_mfma_f32_16x16x32_bf16 v[192:195], a[148:151], v[148:151], v[192:195]
    s_waitcnt lgkmcnt(7)
    s_add_u32 s38, s47, 297472
    ds_read_b64_tr_b16 a[170:171], v21 offset:20480
    v_cvt_pk_bf16_f32 v239, v206, v207
    v_mfma_f32_16x16x32_bf16 v[192:195], a[152:155], v[152:155], v[192:195]
    s_waitcnt lgkmcnt(6)
    ds_read_b64_tr_b16 a[172:173], v21 offset:24576
    buffer_store_dwordx4 v[236:239], v56, s[28:31], s38 offen
    v_mfma_f32_16x16x32_bf16 v[192:195], a[156:159], v[156:159], v[192:195]
    ds_read_b64_tr_b16 a[174:175], v21 offset:28672
    buffer_load_dwordx4 v47, s[20:23], s49 offen offset:1024 lds
    v_mfma_f32_16x16x32_bf16 v[196:199], a[128:131], v[160:163], 0
    ds_read_b64_tr_b16 a[176:177], v25 offset:0
    v_mfma_f32_16x16x32_bf16 v[196:199], a[132:135], v[164:167], v[196:199]
    ds_read_b64_tr_b16 a[178:179], v25 offset:4096
    v_mfma_f32_16x16x32_bf16 v[196:199], a[136:139], v[168:171], v[196:199]
    ds_read_b64_tr_b16 a[180:181], v25 offset:8192
    v_mfma_f32_16x16x32_bf16 v[196:199], a[140:143], v[172:175], v[196:199]
    ds_read_b64_tr_b16 a[182:183], v25 offset:12288
    buffer_load_dwordx4 v48, s[20:23], s49 offen offset:2048 lds
    v_mfma_f32_16x16x32_bf16 v[196:199], a[144:147], v[176:179], v[196:199]
    ds_read_b64_tr_b16 a[184:185], v25 offset:16384
    v_cvt_pk_bf16_f32 v224, v192, v193
    v_mfma_f32_16x16x32_bf16 v[196:199], a[148:151], v[180:183], v[196:199]
    ds_read_b64_tr_b16 a[186:187], v25 offset:20480
    v_cvt_pk_bf16_f32 v225, v194, v195
    v_mfma_f32_16x16x32_bf16 v[196:199], a[152:155], v[184:187], v[196:199]
    ds_read_b64_tr_b16 a[188:189], v25 offset:24576
    v_mfma_f32_16x16x32_bf16 v[196:199], a[156:159], v[188:191], v[196:199]
    s_waitcnt lgkmcnt(13)
    ds_read_b64_tr_b16 a[190:191], v25 offset:28672
    buffer_load_dwordx4 v49, s[20:23], s49 offen offset:3072 lds
    v_mfma_f32_16x16x32_bf16 v[200:203], a[160:163], v[128:131], 0
    s_waitcnt lgkmcnt(12)
    ds_read_b64_tr_b16 a[128:129], v22 offset:0
    v_mfma_f32_16x16x32_bf16 v[200:203], a[164:167], v[132:135], v[200:203]
    s_waitcnt lgkmcnt(11)
    ds_read_b64_tr_b16 a[130:131], v22 offset:4096
    v_mfma_f32_16x16x32_bf16 v[200:203], a[168:171], v[136:139], v[200:203]
    s_waitcnt lgkmcnt(10)
    ds_read_b64_tr_b16 a[132:133], v22 offset:8192
    v_mfma_f32_16x16x32_bf16 v[200:203], a[172:175], v[140:143], v[200:203]
    s_waitcnt lgkmcnt(9)
    ds_read_b64_tr_b16 a[134:135], v22 offset:12288
    v_mfma_f32_16x16x32_bf16 v[200:203], a[176:179], v[144:147], v[200:203]
    s_waitcnt lgkmcnt(8)
    ds_read_b64_tr_b16 a[136:137], v22 offset:16384
    v_cvt_pk_bf16_f32 v228, v196, v197
    v_mfma_f32_16x16x32_bf16 v[200:203], a[180:183], v[148:151], v[200:203]
    s_waitcnt lgkmcnt(7)
    ds_read_b64_tr_b16 a[138:139], v22 offset:20480
    v_cvt_pk_bf16_f32 v229, v198, v199
    v_mfma_f32_16x16x32_bf16 v[200:203], a[184:187], v[152:155], v[200:203]
    s_waitcnt lgkmcnt(6)
    ds_read_b64_tr_b16 a[140:141], v22 offset:24576
    v_mfma_f32_16x16x32_bf16 v[200:203], a[188:191], v[156:159], v[200:203]
    ds_read_b64_tr_b16 a[142:143], v22 offset:28672
    v_mfma_f32_16x16x32_bf16 v[204:207], a[160:163], v[160:163], 0
    ds_read_b64_tr_b16 a[144:145], v26 offset:0
    v_mfma_f32_16x16x32_bf16 v[204:207], a[164:167], v[164:167], v[204:207]
    ds_read_b64_tr_b16 a[146:147], v26 offset:4096
    v_mfma_f32_16x16x32_bf16 v[204:207], a[168:171], v[168:171], v[204:207]
    ds_read_b64_tr_b16 a[148:149], v26 offset:8192
    v_mfma_f32_16x16x32_bf16 v[204:207], a[172:175], v[172:175], v[204:207]
    ds_read_b64_tr_b16 a[150:151], v26 offset:12288
    v_mfma_f32_16x16x32_bf16 v[204:207], a[176:179], v[176:179], v[204:207]
    ds_read_b64_tr_b16 a[152:153], v26 offset:16384
    v_cvt_pk_bf16_f32 v226, v200, v201
    v_mfma_f32_16x16x32_bf16 v[204:207], a[180:183], v[180:183], v[204:207]
    s_add_u32 s38, s47, 3072
    ds_read_b64_tr_b16 a[154:155], v26 offset:20480
    v_cvt_pk_bf16_f32 v227, v202, v203
    v_mfma_f32_16x16x32_bf16 v[204:207], a[184:187], v[184:187], v[204:207]
    ds_read_b64_tr_b16 a[156:157], v26 offset:24576
    buffer_store_dwordx4 v[224:227], v56, s[28:31], s38 offen
    v_mfma_f32_16x16x32_bf16 v[204:207], a[188:191], v[188:191], v[204:207]
    s_waitcnt lgkmcnt(13)
    ds_read_b64_tr_b16 a[158:159], v26 offset:28672
    v_mfma_f32_16x16x32_bf16 v[192:195], a[128:131], v[128:131], 0
    s_waitcnt lgkmcnt(12)
    ds_read_b64_tr_b16 a[160:161], v23 offset:0
    v_mfma_f32_16x16x32_bf16 v[192:195], a[132:135], v[132:135], v[192:195]
    s_waitcnt lgkmcnt(11)
    ds_read_b64_tr_b16 a[162:163], v23 offset:4096
    v_mfma_f32_16x16x32_bf16 v[192:195], a[136:139], v[136:139], v[192:195]
    s_waitcnt lgkmcnt(10)
    ds_read_b64_tr_b16 a[164:165], v23 offset:8192
    v_mfma_f32_16x16x32_bf16 v[192:195], a[140:143], v[140:143], v[192:195]
    s_waitcnt lgkmcnt(9)
    ds_read_b64_tr_b16 a[166:167], v23 offset:12288
    v_mfma_f32_16x16x32_bf16 v[192:195], a[144:147], v[144:147], v[192:195]
    s_waitcnt lgkmcnt(8)
    ds_read_b64_tr_b16 a[168:169], v23 offset:16384
    v_cvt_pk_bf16_f32 v230, v204, v205
    v_mfma_f32_16x16x32_bf16 v[192:195], a[148:151], v[148:151], v[192:195]
    s_waitcnt lgkmcnt(7)
    s_add_u32 s38, s47, 297984
    ds_read_b64_tr_b16 a[170:171], v23 offset:20480
    v_cvt_pk_bf16_f32 v231, v206, v207
    v_mfma_f32_16x16x32_bf16 v[192:195], a[152:155], v[152:155], v[192:195]
    s_waitcnt lgkmcnt(6)
    ds_read_b64_tr_b16 a[172:173], v23 offset:24576
    buffer_store_dwordx4 v[228:231], v56, s[28:31], s38 offen
    v_mfma_f32_16x16x32_bf16 v[192:195], a[156:159], v[156:159], v[192:195]
    ds_read_b64_tr_b16 a[174:175], v23 offset:28672
    v_mfma_f32_16x16x32_bf16 v[196:199], a[128:131], v[160:163], 0
    ds_read_b64_tr_b16 a[176:177], v27 offset:0
    v_mfma_f32_16x16x32_bf16 v[196:199], a[132:135], v[164:167], v[196:199]
    ds_read_b64_tr_b16 a[178:179], v27 offset:4096
    v_mfma_f32_16x16x32_bf16 v[196:199], a[136:139], v[168:171], v[196:199]
    ds_read_b64_tr_b16 a[180:181], v27 offset:8192
    v_mfma_f32_16x16x32_bf16 v[196:199], a[140:143], v[172:175], v[196:199]
    ds_read_b64_tr_b16 a[182:183], v27 offset:12288
    v_mfma_f32_16x16x32_bf16 v[196:199], a[144:147], v[176:179], v[196:199]
    ds_read_b64_tr_b16 a[184:185], v27 offset:16384
    v_cvt_pk_bf16_f32 v232, v192, v193
    v_mfma_f32_16x16x32_bf16 v[196:199], a[148:151], v[180:183], v[196:199]
    ds_read_b64_tr_b16 a[186:187], v27 offset:20480
    v_cvt_pk_bf16_f32 v233, v194, v195
    v_mfma_f32_16x16x32_bf16 v[196:199], a[152:155], v[184:187], v[196:199]
    ds_read_b64_tr_b16 a[188:189], v27 offset:24576
    v_mfma_f32_16x16x32_bf16 v[196:199], a[156:159], v[188:191], v[196:199]
    s_waitcnt lgkmcnt(13)
    ds_read_b64_tr_b16 a[190:191], v27 offset:28672
    s_waitcnt vmcnt(25)
    s_barrier
    v_mfma_f32_16x16x32_bf16 v[200:203], a[160:163], v[128:131], 0
    s_waitcnt lgkmcnt(12)
    ds_read_b64_tr_b16 a[128:129], v20 offset:32768
    v_mfma_f32_16x16x32_bf16 v[200:203], a[164:167], v[132:135], v[200:203]
    s_waitcnt lgkmcnt(11)
    s_add_u32 s49, s45, 896
    ds_read_b64_tr_b16 a[130:131], v20 offset:36864
    v_mfma_f32_16x16x32_bf16 v[200:203], a[168:171], v[136:139], v[200:203]
    s_waitcnt lgkmcnt(10)
    s_add_u32 m0, s42, 32768
    ds_read_b64_tr_b16 a[132:133], v20 offset:40960
    v_mfma_f32_16x16x32_bf16 v[200:203], a[172:175], v[140:143], v[200:203]
    s_waitcnt lgkmcnt(9)
    ds_read_b64_tr_b16 a[134:135], v20 offset:45056
    buffer_load_dwordx4 v46, s[20:23], s49 offen lds
    v_mfma_f32_16x16x32_bf16 v[200:203], a[176:179], v[144:147], v[200:203]
    s_waitcnt lgkmcnt(8)
    ds_read_b64_tr_b16 a[136:137], v20 offset:49152
    v_cvt_pk_bf16_f32 v236, v196, v197
    v_mfma_f32_16x16x32_bf16 v[200:203], a[180:183], v[148:151], v[200:203]
    s_waitcnt lgkmcnt(7)
    ds_read_b64_tr_b16 a[138:139], v20 offset:53248
    v_cvt_pk_bf16_f32 v237, v198, v199
    v_mfma_f32_16x16x32_bf16 v[200:203], a[184:187], v[152:155], v[200:203]
    s_waitcnt lgkmcnt(6)
    ds_read_b64_tr_b16 a[140:141], v20 offset:57344
    v_mfma_f32_16x16x32_bf16 v[200:203], a[188:191], v[156:159], v[200:203]
    ds_read_b64_tr_b16 a[142:143], v20 offset:61440
    buffer_load_dwordx4 v47, s[20:23], s49 offen offset:1024 lds
    v_mfma_f32_16x16x32_bf16 v[204:207], a[160:163], v[160:163], 0
    ds_read_b64_tr_b16 a[144:145], v24 offset:32768
    v_mfma_f32_16x16x32_bf16 v[204:207], a[164:167], v[164:167], v[204:207]
    ds_read_b64_tr_b16 a[146:147], v24 offset:36864
    v_mfma_f32_16x16x32_bf16 v[204:207], a[168:171], v[168:171], v[204:207]
    ds_read_b64_tr_b16 a[148:149], v24 offset:40960
    v_mfma_f32_16x16x32_bf16 v[204:207], a[172:175], v[172:175], v[204:207]
    ds_read_b64_tr_b16 a[150:151], v24 offset:45056
    buffer_load_dwordx4 v48, s[20:23], s49 offen offset:2048 lds
    v_mfma_f32_16x16x32_bf16 v[204:207], a[176:179], v[176:179], v[204:207]
    ds_read_b64_tr_b16 a[152:153], v24 offset:49152
    v_cvt_pk_bf16_f32 v234, v200, v201
    v_mfma_f32_16x16x32_bf16 v[204:207], a[180:183], v[180:183], v[204:207]
    s_add_u32 s38, s47, 3584
    ds_read_b64_tr_b16 a[154:155], v24 offset:53248
    v_cvt_pk_bf16_f32 v235, v202, v203
    v_mfma_f32_16x16x32_bf16 v[204:207], a[184:187], v[184:187], v[204:207]
    ds_read_b64_tr_b16 a[156:157], v24 offset:57344
    buffer_store_dwordx4 v[232:235], v56, s[28:31], s38 offen
    v_mfma_f32_16x16x32_bf16 v[204:207], a[188:191], v[188:191], v[204:207]
    s_waitcnt lgkmcnt(13)
    ds_read_b64_tr_b16 a[158:159], v24 offset:61440
    buffer_load_dwordx4 v49, s[20:23], s49 offen offset:3072 lds
    v_mfma_f32_16x16x32_bf16 v[192:195], a[128:131], v[128:131], 0
    s_waitcnt lgkmcnt(12)
    ds_read_b64_tr_b16 a[160:161], v21 offset:32768
    v_mfma_f32_16x16x32_bf16 v[192:195], a[132:135], v[132:135], v[192:195]
    s_waitcnt lgkmcnt(11)
    s_add_u32 s49, s45, 74624
    ds_read_b64_tr_b16 a[162:163], v21 offset:36864
    v_mfma_f32_16x16x32_bf16 v[192:195], a[136:139], v[136:139], v[192:195]
    s_waitcnt lgkmcnt(10)
    s_add_u32 m0, s42, 49152
    ds_read_b64_tr_b16 a[164:165], v21 offset:40960
    v_mfma_f32_16x16x32_bf16 v[192:195], a[140:143], v[140:143], v[192:195]
    s_waitcnt lgkmcnt(9)
    ds_read_b64_tr_b16 a[166:167], v21 offset:45056
    buffer_load_dwordx4 v46, s[20:23], s49 offen lds
    v_mfma_f32_16x16x32_bf16 v[192:195], a[144:147], v[144:147], v[192:195]
    s_waitcnt lgkmcnt(8)
    ds_read_b64_tr_b16 a[168:169], v21 offset:49152
    v_cvt_pk_bf16_f32 v238, v204, v205
    v_mfma_f32_16x16x32_bf16 v[192:195], a[148:151], v[148:151], v[192:195]
    s_waitcnt lgkmcnt(7)
    s_add_u32 s38, s47, 298496
    ds_read_b64_tr_b16 a[170:171], v21 offset:53248
    v_cvt_pk_bf16_f32 v239, v206, v207
    v_mfma_f32_16x16x32_bf16 v[192:195], a[152:155], v[152:155], v[192:195]
    s_waitcnt lgkmcnt(6)
    ds_read_b64_tr_b16 a[172:173], v21 offset:57344
    buffer_store_dwordx4 v[236:239], v56, s[28:31], s38 offen
    v_mfma_f32_16x16x32_bf16 v[192:195], a[156:159], v[156:159], v[192:195]
    ds_read_b64_tr_b16 a[174:175], v21 offset:61440
    buffer_load_dwordx4 v47, s[20:23], s49 offen offset:1024 lds
    v_mfma_f32_16x16x32_bf16 v[196:199], a[128:131], v[160:163], 0
    ds_read_b64_tr_b16 a[176:177], v25 offset:32768
    v_mfma_f32_16x16x32_bf16 v[196:199], a[132:135], v[164:167], v[196:199]
    ds_read_b64_tr_b16 a[178:179], v25 offset:36864
    v_mfma_f32_16x16x32_bf16 v[196:199], a[136:139], v[168:171], v[196:199]
    ds_read_b64_tr_b16 a[180:181], v25 offset:40960
    v_mfma_f32_16x16x32_bf16 v[196:199], a[140:143], v[172:175], v[196:199]
    ds_read_b64_tr_b16 a[182:183], v25 offset:45056
    buffer_load_dwordx4 v48, s[20:23], s49 offen offset:2048 lds
    v_mfma_f32_16x16x32_bf16 v[196:199], a[144:147], v[176:179], v[196:199]
    ds_read_b64_tr_b16 a[184:185], v25 offset:49152
    v_cvt_pk_bf16_f32 v224, v192, v193
    v_mfma_f32_16x16x32_bf16 v[196:199], a[148:151], v[180:183], v[196:199]
    ds_read_b64_tr_b16 a[186:187], v25 offset:53248
    v_cvt_pk_bf16_f32 v225, v194, v195
    v_mfma_f32_16x16x32_bf16 v[196:199], a[152:155], v[184:187], v[196:199]
    ds_read_b64_tr_b16 a[188:189], v25 offset:57344
    v_mfma_f32_16x16x32_bf16 v[196:199], a[156:159], v[188:191], v[196:199]
    s_waitcnt lgkmcnt(13)
    ds_read_b64_tr_b16 a[190:191], v25 offset:61440
    buffer_load_dwordx4 v49, s[20:23], s49 offen offset:3072 lds
    v_mfma_f32_16x16x32_bf16 v[200:203], a[160:163], v[128:131], 0
    s_waitcnt lgkmcnt(12)
    ds_read_b64_tr_b16 a[128:129], v22 offset:32768
    v_mfma_f32_16x16x32_bf16 v[200:203], a[164:167], v[132:135], v[200:203]
    s_waitcnt lgkmcnt(11)
    ds_read_b64_tr_b16 a[130:131], v22 offset:36864
    v_mfma_f32_16x16x32_bf16 v[200:203], a[168:171], v[136:139], v[200:203]
    s_waitcnt lgkmcnt(10)
    ds_read_b64_tr_b16 a[132:133], v22 offset:40960
    v_mfma_f32_16x16x32_bf16 v[200:203], a[172:175], v[140:143], v[200:203]
    s_waitcnt lgkmcnt(9)
    ds_read_b64_tr_b16 a[134:135], v22 offset:45056
    v_mfma_f32_16x16x32_bf16 v[200:203], a[176:179], v[144:147], v[200:203]
    s_waitcnt lgkmcnt(8)
    ds_read_b64_tr_b16 a[136:137], v22 offset:49152
    v_cvt_pk_bf16_f32 v228, v196, v197
    v_mfma_f32_16x16x32_bf16 v[200:203], a[180:183], v[148:151], v[200:203]
    s_waitcnt lgkmcnt(7)
    ds_read_b64_tr_b16 a[138:139], v22 offset:53248
    v_cvt_pk_bf16_f32 v229, v198, v199
    v_mfma_f32_16x16x32_bf16 v[200:203], a[184:187], v[152:155], v[200:203]
    s_waitcnt lgkmcnt(6)
    ds_read_b64_tr_b16 a[140:141], v22 offset:57344
    v_mfma_f32_16x16x32_bf16 v[200:203], a[188:191], v[156:159], v[200:203]
    ds_read_b64_tr_b16 a[142:143], v22 offset:61440
    v_mfma_f32_16x16x32_bf16 v[204:207], a[160:163], v[160:163], 0
    ds_read_b64_tr_b16 a[144:145], v26 offset:32768
    v_mfma_f32_16x16x32_bf16 v[204:207], a[164:167], v[164:167], v[204:207]
    ds_read_b64_tr_b16 a[146:147], v26 offset:36864
    v_mfma_f32_16x16x32_bf16 v[204:207], a[168:171], v[168:171], v[204:207]
    ds_read_b64_tr_b16 a[148:149], v26 offset:40960
    v_mfma_f32_16x16x32_bf16 v[204:207], a[172:175], v[172:175], v[204:207]
    ds_read_b64_tr_b16 a[150:151], v26 offset:45056
    v_mfma_f32_16x16x32_bf16 v[204:207], a[176:179], v[176:179], v[204:207]
    ds_read_b64_tr_b16 a[152:153], v26 offset:49152
    v_cvt_pk_bf16_f32 v226, v200, v201
    v_mfma_f32_16x16x32_bf16 v[204:207], a[180:183], v[180:183], v[204:207]
    s_add_u32 s38, s47, 4096
    ds_read_b64_tr_b16 a[154:155], v26 offset:53248
    v_cvt_pk_bf16_f32 v227, v202, v203
    v_mfma_f32_16x16x32_bf16 v[204:207], a[184:187], v[184:187], v[204:207]
    ds_read_b64_tr_b16 a[156:157], v26 offset:57344
    buffer_store_dwordx4 v[224:227], v56, s[28:31], s38 offen
    v_mfma_f32_16x16x32_bf16 v[204:207], a[188:191], v[188:191], v[204:207]
    s_waitcnt lgkmcnt(13)
    ds_read_b64_tr_b16 a[158:159], v26 offset:61440
    v_mfma_f32_16x16x32_bf16 v[192:195], a[128:131], v[128:131], 0
    s_waitcnt lgkmcnt(12)
    ds_read_b64_tr_b16 a[160:161], v23 offset:32768
    v_mfma_f32_16x16x32_bf16 v[192:195], a[132:135], v[132:135], v[192:195]
    s_waitcnt lgkmcnt(11)
    ds_read_b64_tr_b16 a[162:163], v23 offset:36864
    v_mfma_f32_16x16x32_bf16 v[192:195], a[136:139], v[136:139], v[192:195]
    s_waitcnt lgkmcnt(10)
    ds_read_b64_tr_b16 a[164:165], v23 offset:40960
    v_mfma_f32_16x16x32_bf16 v[192:195], a[140:143], v[140:143], v[192:195]
    s_waitcnt lgkmcnt(9)
    ds_read_b64_tr_b16 a[166:167], v23 offset:45056
    v_mfma_f32_16x16x32_bf16 v[192:195], a[144:147], v[144:147], v[192:195]
    s_waitcnt lgkmcnt(8)
    ds_read_b64_tr_b16 a[168:169], v23 offset:49152
    v_cvt_pk_bf16_f32 v230, v204, v205
    v_mfma_f32_16x16x32_bf16 v[192:195], a[148:151], v[148:151], v[192:195]
    s_waitcnt lgkmcnt(7)
    s_add_u32 s38, s47, 299008
    ds_read_b64_tr_b16 a[170:171], v23 offset:53248
    v_cvt_pk_bf16_f32 v231, v206, v207
    v_mfma_f32_16x16x32_bf16 v[192:195], a[152:155], v[152:155], v[192:195]
    s_waitcnt lgkmcnt(6)
    ds_read_b64_tr_b16 a[172:173], v23 offset:57344
    buffer_store_dwordx4 v[228:231], v56, s[28:31], s38 offen
    v_mfma_f32_16x16x32_bf16 v[192:195], a[156:159], v[156:159], v[192:195]
    ds_read_b64_tr_b16 a[174:175], v23 offset:61440
    v_mfma_f32_16x16x32_bf16 v[196:199], a[128:131], v[160:163], 0
    ds_read_b64_tr_b16 a[176:177], v27 offset:32768
    v_mfma_f32_16x16x32_bf16 v[196:199], a[132:135], v[164:167], v[196:199]
    ds_read_b64_tr_b16 a[178:179], v27 offset:36864
    v_mfma_f32_16x16x32_bf16 v[196:199], a[136:139], v[168:171], v[196:199]
    ds_read_b64_tr_b16 a[180:181], v27 offset:40960
    v_mfma_f32_16x16x32_bf16 v[196:199], a[140:143], v[172:175], v[196:199]
    ds_read_b64_tr_b16 a[182:183], v27 offset:45056
    v_mfma_f32_16x16x32_bf16 v[196:199], a[144:147], v[176:179], v[196:199]
    ds_read_b64_tr_b16 a[184:185], v27 offset:49152
    v_cvt_pk_bf16_f32 v232, v192, v193
    v_mfma_f32_16x16x32_bf16 v[196:199], a[148:151], v[180:183], v[196:199]
    ds_read_b64_tr_b16 a[186:187], v27 offset:53248
    v_cvt_pk_bf16_f32 v233, v194, v195
    v_mfma_f32_16x16x32_bf16 v[196:199], a[152:155], v[184:187], v[196:199]
    ds_read_b64_tr_b16 a[188:189], v27 offset:57344
    v_mfma_f32_16x16x32_bf16 v[196:199], a[156:159], v[188:191], v[196:199]
    s_waitcnt lgkmcnt(13)
    ds_read_b64_tr_b16 a[190:191], v27 offset:61440
    s_waitcnt vmcnt(26)
    s_barrier
    v_mfma_f32_16x16x32_bf16 v[200:203], a[160:163], v[128:131], 0
    s_waitcnt lgkmcnt(12)
    ds_read_b64_tr_b16 a[128:129], v28 offset:0
    v_mfma_f32_16x16x32_bf16 v[200:203], a[164:167], v[132:135], v[200:203]
    s_waitcnt lgkmcnt(11)
    s_add_u32 s49, s45, 1024
    ds_read_b64_tr_b16 a[130:131], v28 offset:4096
    v_mfma_f32_16x16x32_bf16 v[200:203], a[168:171], v[136:139], v[200:203]
    s_waitcnt lgkmcnt(10)
    s_add_u32 m0, s42, 65536
    ds_read_b64_tr_b16 a[132:133], v28 offset:8192
    v_mfma_f32_16x16x32_bf16 v[200:203], a[172:175], v[140:143], v[200:203]
    s_waitcnt lgkmcnt(9)
    ds_read_b64_tr_b16 a[134:135], v28 offset:12288
    buffer_load_dwordx4 v46, s[20:23], s49 offen lds
    v_mfma_f32_16x16x32_bf16 v[200:203], a[176:179], v[144:147], v[200:203]
    s_waitcnt lgkmcnt(8)
    ds_read_b64_tr_b16 a[136:137], v28 offset:16384
    v_cvt_pk_bf16_f32 v236, v196, v197
    v_mfma_f32_16x16x32_bf16 v[200:203], a[180:183], v[148:151], v[200:203]
    s_waitcnt lgkmcnt(7)
    ds_read_b64_tr_b16 a[138:139], v28 offset:20480
    v_cvt_pk_bf16_f32 v237, v198, v199
    v_mfma_f32_16x16x32_bf16 v[200:203], a[184:187], v[152:155], v[200:203]
    s_waitcnt lgkmcnt(6)
    ds_read_b64_tr_b16 a[140:141], v28 offset:24576
    v_mfma_f32_16x16x32_bf16 v[200:203], a[188:191], v[156:159], v[200:203]
    ds_read_b64_tr_b16 a[142:143], v28 offset:28672
    buffer_load_dwordx4 v47, s[20:23], s49 offen offset:1024 lds
    v_mfma_f32_16x16x32_bf16 v[204:207], a[160:163], v[160:163], 0
    ds_read_b64_tr_b16 a[144:145], v32 offset:0
    v_mfma_f32_16x16x32_bf16 v[204:207], a[164:167], v[164:167], v[204:207]
    ds_read_b64_tr_b16 a[146:147], v32 offset:4096
    v_mfma_f32_16x16x32_bf16 v[204:207], a[168:171], v[168:171], v[204:207]
    ds_read_b64_tr_b16 a[148:149], v32 offset:8192
    v_mfma_f32_16x16x32_bf16 v[204:207], a[172:175], v[172:175], v[204:207]
    ds_read_b64_tr_b16 a[150:151], v32 offset:12288
    buffer_load_dwordx4 v48, s[20:23], s49 offen offset:2048 lds
    v_mfma_f32_16x16x32_bf16 v[204:207], a[176:179], v[176:179], v[204:207]
    ds_read_b64_tr_b16 a[152:153], v32 offset:16384
    v_cvt_pk_bf16_f32 v234, v200, v201
    v_mfma_f32_16x16x32_bf16 v[204:207], a[180:183], v[180:183], v[204:207]
    s_add_u32 s38, s47, 4608
    ds_read_b64_tr_b16 a[154:155], v32 offset:20480
    v_cvt_pk_bf16_f32 v235, v202, v203
    v_mfma_f32_16x16x32_bf16 v[204:207], a[184:187], v[184:187], v[204:207]
    ds_read_b64_tr_b16 a[156:157], v32 offset:24576
    buffer_store_dwordx4 v[232:235], v56, s[28:31], s38 offen
    v_mfma_f32_16x16x32_bf16 v[204:207], a[188:191], v[188:191], v[204:207]
    s_waitcnt lgkmcnt(13)
    ds_read_b64_tr_b16 a[158:159], v32 offset:28672
    buffer_load_dwordx4 v49, s[20:23], s49 offen offset:3072 lds
    v_mfma_f32_16x16x32_bf16 v[192:195], a[128:131], v[128:131], 0
    s_waitcnt lgkmcnt(12)
    ds_read_b64_tr_b16 a[160:161], v29 offset:0
    v_mfma_f32_16x16x32_bf16 v[192:195], a[132:135], v[132:135], v[192:195]
    s_waitcnt lgkmcnt(11)
    s_add_u32 s49, s45, 74752
    ds_read_b64_tr_b16 a[162:163], v29 offset:4096
    v_mfma_f32_16x16x32_bf16 v[192:195], a[136:139], v[136:139], v[192:195]
    s_waitcnt lgkmcnt(10)
    s_add_u32 m0, s42, 81920
    ds_read_b64_tr_b16 a[164:165], v29 offset:8192
    v_mfma_f32_16x16x32_bf16 v[192:195], a[140:143], v[140:143], v[192:195]
    s_waitcnt lgkmcnt(9)
    ds_read_b64_tr_b16 a[166:167], v29 offset:12288
    buffer_load_dwordx4 v46, s[20:23], s49 offen lds
    v_mfma_f32_16x16x32_bf16 v[192:195], a[144:147], v[144:147], v[192:195]
    s_waitcnt lgkmcnt(8)
    ds_read_b64_tr_b16 a[168:169], v29 offset:16384
    v_cvt_pk_bf16_f32 v238, v204, v205
    v_mfma_f32_16x16x32_bf16 v[192:195], a[148:151], v[148:151], v[192:195]
    s_waitcnt lgkmcnt(7)
    s_add_u32 s38, s47, 299520
    ds_read_b64_tr_b16 a[170:171], v29 offset:20480
    v_cvt_pk_bf16_f32 v239, v206, v207
    v_mfma_f32_16x16x32_bf16 v[192:195], a[152:155], v[152:155], v[192:195]
    s_waitcnt lgkmcnt(6)
    ds_read_b64_tr_b16 a[172:173], v29 offset:24576
    buffer_store_dwordx4 v[236:239], v56, s[28:31], s38 offen
    v_mfma_f32_16x16x32_bf16 v[192:195], a[156:159], v[156:159], v[192:195]
    ds_read_b64_tr_b16 a[174:175], v29 offset:28672
    buffer_load_dwordx4 v47, s[20:23], s49 offen offset:1024 lds
    v_mfma_f32_16x16x32_bf16 v[196:199], a[128:131], v[160:163], 0
    ds_read_b64_tr_b16 a[176:177], v33 offset:0
    v_mfma_f32_16x16x32_bf16 v[196:199], a[132:135], v[164:167], v[196:199]
    ds_read_b64_tr_b16 a[178:179], v33 offset:4096
    v_mfma_f32_16x16x32_bf16 v[196:199], a[136:139], v[168:171], v[196:199]
    ds_read_b64_tr_b16 a[180:181], v33 offset:8192
    v_mfma_f32_16x16x32_bf16 v[196:199], a[140:143], v[172:175], v[196:199]
    ds_read_b64_tr_b16 a[182:183], v33 offset:12288
    buffer_load_dwordx4 v48, s[20:23], s49 offen offset:2048 lds
    v_mfma_f32_16x16x32_bf16 v[196:199], a[144:147], v[176:179], v[196:199]
    ds_read_b64_tr_b16 a[184:185], v33 offset:16384
    v_cvt_pk_bf16_f32 v224, v192, v193
    v_mfma_f32_16x16x32_bf16 v[196:199], a[148:151], v[180:183], v[196:199]
    ds_read_b64_tr_b16 a[186:187], v33 offset:20480
    v_cvt_pk_bf16_f32 v225, v194, v195
    v_mfma_f32_16x16x32_bf16 v[196:199], a[152:155], v[184:187], v[196:199]
    ds_read_b64_tr_b16 a[188:189], v33 offset:24576
    v_mfma_f32_16x16x32_bf16 v[196:199], a[156:159], v[188:191], v[196:199]
    s_waitcnt lgkmcnt(13)
    ds_read_b64_tr_b16 a[190:191], v33 offset:28672
    buffer_load_dwordx4 v49, s[20:23], s49 offen offset:3072 lds
    v_mfma_f32_16x16x32_bf16 v[200:203], a[160:163], v[128:131], 0
    s_waitcnt lgkmcnt(12)
    ds_read_b64_tr_b16 a[128:129], v30 offset:0
    v_mfma_f32_16x16x32_bf16 v[200:203], a[164:167], v[132:135], v[200:203]
    s_waitcnt lgkmcnt(11)
    ds_read_b64_tr_b16 a[130:131], v30 offset:4096
    v_mfma_f32_16x16x32_bf16 v[200:203], a[168:171], v[136:139], v[200:203]
    s_waitcnt lgkmcnt(10)
    ds_read_b64_tr_b16 a[132:133], v30 offset:8192
    v_mfma_f32_16x16x32_bf16 v[200:203], a[172:175], v[140:143], v[200:203]
    s_waitcnt lgkmcnt(9)
    ds_read_b64_tr_b16 a[134:135], v30 offset:12288
    v_mfma_f32_16x16x32_bf16 v[200:203], a[176:179], v[144:147], v[200:203]
    s_waitcnt lgkmcnt(8)
    ds_read_b64_tr_b16 a[136:137], v30 offset:16384
    v_cvt_pk_bf16_f32 v228, v196, v197
    v_mfma_f32_16x16x32_bf16 v[200:203], a[180:183], v[148:151], v[200:203]
    s_waitcnt lgkmcnt(7)
    ds_read_b64_tr_b16 a[138:139], v30 offset:20480
    v_cvt_pk_bf16_f32 v229, v198, v199
    v_mfma_f32_16x16x32_bf16 v[200:203], a[184:187], v[152:155], v[200:203]
    s_waitcnt lgkmcnt(6)
    ds_read_b64_tr_b16 a[140:141], v30 offset:24576
    v_mfma_f32_16x16x32_bf16 v[200:203], a[188:191], v[156:159], v[200:203]
    ds_read_b64_tr_b16 a[142:143], v30 offset:28672
    v_mfma_f32_16x16x32_bf16 v[204:207], a[160:163], v[160:163], 0
    ds_read_b64_tr_b16 a[144:145], v34 offset:0
    v_mfma_f32_16x16x32_bf16 v[204:207], a[164:167], v[164:167], v[204:207]
    ds_read_b64_tr_b16 a[146:147], v34 offset:4096
    v_mfma_f32_16x16x32_bf16 v[204:207], a[168:171], v[168:171], v[204:207]
    ds_read_b64_tr_b16 a[148:149], v34 offset:8192
    v_mfma_f32_16x16x32_bf16 v[204:207], a[172:175], v[172:175], v[204:207]
    ds_read_b64_tr_b16 a[150:151], v34 offset:12288
    v_mfma_f32_16x16x32_bf16 v[204:207], a[176:179], v[176:179], v[204:207]
    ds_read_b64_tr_b16 a[152:153], v34 offset:16384
    v_cvt_pk_bf16_f32 v226, v200, v201
    v_mfma_f32_16x16x32_bf16 v[204:207], a[180:183], v[180:183], v[204:207]
    s_add_u32 s38, s47, 5120
    ds_read_b64_tr_b16 a[154:155], v34 offset:20480
    v_cvt_pk_bf16_f32 v227, v202, v203
    v_mfma_f32_16x16x32_bf16 v[204:207], a[184:187], v[184:187], v[204:207]
    ds_read_b64_tr_b16 a[156:157], v34 offset:24576
    buffer_store_dwordx4 v[224:227], v56, s[28:31], s38 offen
    v_mfma_f32_16x16x32_bf16 v[204:207], a[188:191], v[188:191], v[204:207]
    s_waitcnt lgkmcnt(13)
    ds_read_b64_tr_b16 a[158:159], v34 offset:28672
    v_mfma_f32_16x16x32_bf16 v[192:195], a[128:131], v[128:131], 0
    s_waitcnt lgkmcnt(12)
    ds_read_b64_tr_b16 a[160:161], v31 offset:0
    v_mfma_f32_16x16x32_bf16 v[192:195], a[132:135], v[132:135], v[192:195]
    s_waitcnt lgkmcnt(11)
    ds_read_b64_tr_b16 a[162:163], v31 offset:4096
    v_mfma_f32_16x16x32_bf16 v[192:195], a[136:139], v[136:139], v[192:195]
    s_waitcnt lgkmcnt(10)
    ds_read_b64_tr_b16 a[164:165], v31 offset:8192
    v_mfma_f32_16x16x32_bf16 v[192:195], a[140:143], v[140:143], v[192:195]
    s_waitcnt lgkmcnt(9)
    ds_read_b64_tr_b16 a[166:167], v31 offset:12288
    v_mfma_f32_16x16x32_bf16 v[192:195], a[144:147], v[144:147], v[192:195]
    s_waitcnt lgkmcnt(8)
    ds_read_b64_tr_b16 a[168:169], v31 offset:16384
    v_cvt_pk_bf16_f32 v230, v204, v205
    v_mfma_f32_16x16x32_bf16 v[192:195], a[148:151], v[148:151], v[192:195]
    s_waitcnt lgkmcnt(7)
    s_add_u32 s38, s47, 300032
    ds_read_b64_tr_b16 a[170:171], v31 offset:20480
    v_cvt_pk_bf16_f32 v231, v206, v207
    v_mfma_f32_16x16x32_bf16 v[192:195], a[152:155], v[152:155], v[192:195]
    s_waitcnt lgkmcnt(6)
    ds_read_b64_tr_b16 a[172:173], v31 offset:24576
    buffer_store_dwordx4 v[228:231], v56, s[28:31], s38 offen
    v_mfma_f32_16x16x32_bf16 v[192:195], a[156:159], v[156:159], v[192:195]
    ds_read_b64_tr_b16 a[174:175], v31 offset:28672
    v_mfma_f32_16x16x32_bf16 v[196:199], a[128:131], v[160:163], 0
    ds_read_b64_tr_b16 a[176:177], v35 offset:0
    v_mfma_f32_16x16x32_bf16 v[196:199], a[132:135], v[164:167], v[196:199]
    ds_read_b64_tr_b16 a[178:179], v35 offset:4096
    v_mfma_f32_16x16x32_bf16 v[196:199], a[136:139], v[168:171], v[196:199]
    ds_read_b64_tr_b16 a[180:181], v35 offset:8192
    v_mfma_f32_16x16x32_bf16 v[196:199], a[140:143], v[172:175], v[196:199]
    ds_read_b64_tr_b16 a[182:183], v35 offset:12288
    v_mfma_f32_16x16x32_bf16 v[196:199], a[144:147], v[176:179], v[196:199]
    ds_read_b64_tr_b16 a[184:185], v35 offset:16384
    v_cvt_pk_bf16_f32 v232, v192, v193
    v_mfma_f32_16x16x32_bf16 v[196:199], a[148:151], v[180:183], v[196:199]
    ds_read_b64_tr_b16 a[186:187], v35 offset:20480
    v_cvt_pk_bf16_f32 v233, v194, v195
    v_mfma_f32_16x16x32_bf16 v[196:199], a[152:155], v[184:187], v[196:199]
    ds_read_b64_tr_b16 a[188:189], v35 offset:24576
    v_mfma_f32_16x16x32_bf16 v[196:199], a[156:159], v[188:191], v[196:199]
    s_waitcnt lgkmcnt(13)
    ds_read_b64_tr_b16 a[190:191], v35 offset:28672
    s_waitcnt vmcnt(26)
    s_barrier
    v_mfma_f32_16x16x32_bf16 v[200:203], a[160:163], v[128:131], 0
    s_waitcnt lgkmcnt(12)
    ds_read_b64_tr_b16 a[128:129], v12 offset:0
    v_mfma_f32_16x16x32_bf16 v[200:203], a[164:167], v[132:135], v[200:203]
    s_waitcnt lgkmcnt(11)
    ds_read_b64_tr_b16 a[130:131], v12 offset:4096
    v_mfma_f32_16x16x32_bf16 v[200:203], a[168:171], v[136:139], v[200:203]
    s_waitcnt lgkmcnt(10)
    ds_read_b64_tr_b16 a[132:133], v12 offset:8192
    v_mfma_f32_16x16x32_bf16 v[200:203], a[172:175], v[140:143], v[200:203]
    s_waitcnt lgkmcnt(9)
    ds_read_b64_tr_b16 a[134:135], v12 offset:12288
    v_mfma_f32_16x16x32_bf16 v[200:203], a[176:179], v[144:147], v[200:203]
    s_waitcnt lgkmcnt(8)
    ds_read_b64_tr_b16 a[136:137], v12 offset:16384
    v_cvt_pk_bf16_f32 v236, v196, v197
    v_mfma_f32_16x16x32_bf16 v[200:203], a[180:183], v[148:151], v[200:203]
    s_waitcnt lgkmcnt(7)
    ds_read_b64_tr_b16 a[138:139], v12 offset:20480
    v_cvt_pk_bf16_f32 v237, v198, v199
    v_mfma_f32_16x16x32_bf16 v[200:203], a[184:187], v[152:155], v[200:203]
    s_waitcnt lgkmcnt(6)
    ds_read_b64_tr_b16 a[140:141], v12 offset:24576
    v_mfma_f32_16x16x32_bf16 v[200:203], a[188:191], v[156:159], v[200:203]
    ds_read_b64_tr_b16 a[142:143], v12 offset:28672
    v_mfma_f32_16x16x32_bf16 v[204:207], a[160:163], v[160:163], 0
    ds_read_b64_tr_b16 a[144:145], v16 offset:0
    v_mfma_f32_16x16x32_bf16 v[204:207], a[164:167], v[164:167], v[204:207]
    ds_read_b64_tr_b16 a[146:147], v16 offset:4096
    v_mfma_f32_16x16x32_bf16 v[204:207], a[168:171], v[168:171], v[204:207]
    ds_read_b64_tr_b16 a[148:149], v16 offset:8192
    v_mfma_f32_16x16x32_bf16 v[204:207], a[172:175], v[172:175], v[204:207]
    ds_read_b64_tr_b16 a[150:151], v16 offset:12288
    v_mfma_f32_16x16x32_bf16 v[204:207], a[176:179], v[176:179], v[204:207]
    ds_read_b64_tr_b16 a[152:153], v16 offset:16384
    v_cvt_pk_bf16_f32 v234, v200, v201
    v_mfma_f32_16x16x32_bf16 v[204:207], a[180:183], v[180:183], v[204:207]
    s_add_u32 s38, s47, 5632
    ds_read_b64_tr_b16 a[154:155], v16 offset:20480
    v_cvt_pk_bf16_f32 v235, v202, v203
    v_mfma_f32_16x16x32_bf16 v[204:207], a[184:187], v[184:187], v[204:207]
    ds_read_b64_tr_b16 a[156:157], v16 offset:24576
    buffer_store_dwordx4 v[232:235], v56, s[28:31], s38 offen
    v_mfma_f32_16x16x32_bf16 v[204:207], a[188:191], v[188:191], v[204:207]
    s_waitcnt lgkmcnt(13)
    ds_read_b64_tr_b16 a[158:159], v16 offset:28672
    v_mfma_f32_16x16x32_bf16 v[192:195], a[128:131], v[128:131], 0
    s_waitcnt lgkmcnt(12)
    ds_read_b64_tr_b16 a[160:161], v13 offset:0
    v_mfma_f32_16x16x32_bf16 v[192:195], a[132:135], v[132:135], v[192:195]
    s_waitcnt lgkmcnt(11)
    ds_read_b64_tr_b16 a[162:163], v13 offset:4096
    v_mfma_f32_16x16x32_bf16 v[192:195], a[136:139], v[136:139], v[192:195]
    s_waitcnt lgkmcnt(10)
    ds_read_b64_tr_b16 a[164:165], v13 offset:8192
    v_mfma_f32_16x16x32_bf16 v[192:195], a[140:143], v[140:143], v[192:195]
    s_waitcnt lgkmcnt(9)
    ds_read_b64_tr_b16 a[166:167], v13 offset:12288
    v_mfma_f32_16x16x32_bf16 v[192:195], a[144:147], v[144:147], v[192:195]
    s_waitcnt lgkmcnt(8)
    ds_read_b64_tr_b16 a[168:169], v13 offset:16384
    v_cvt_pk_bf16_f32 v238, v204, v205
    v_mfma_f32_16x16x32_bf16 v[192:195], a[148:151], v[148:151], v[192:195]
    s_waitcnt lgkmcnt(7)
    s_add_u32 s38, s47, 300544
    ds_read_b64_tr_b16 a[170:171], v13 offset:20480
    v_cvt_pk_bf16_f32 v239, v206, v207
    v_mfma_f32_16x16x32_bf16 v[192:195], a[152:155], v[152:155], v[192:195]
    s_waitcnt lgkmcnt(6)
    ds_read_b64_tr_b16 a[172:173], v13 offset:24576
    buffer_store_dwordx4 v[236:239], v56, s[28:31], s38 offen
    v_mfma_f32_16x16x32_bf16 v[192:195], a[156:159], v[156:159], v[192:195]
    ds_read_b64_tr_b16 a[174:175], v13 offset:28672
    v_mfma_f32_16x16x32_bf16 v[196:199], a[128:131], v[160:163], 0
    ds_read_b64_tr_b16 a[176:177], v17 offset:0
    v_mfma_f32_16x16x32_bf16 v[196:199], a[132:135], v[164:167], v[196:199]
    ds_read_b64_tr_b16 a[178:179], v17 offset:4096
    v_mfma_f32_16x16x32_bf16 v[196:199], a[136:139], v[168:171], v[196:199]
    ds_read_b64_tr_b16 a[180:181], v17 offset:8192
    v_mfma_f32_16x16x32_bf16 v[196:199], a[140:143], v[172:175], v[196:199]
    ds_read_b64_tr_b16 a[182:183], v17 offset:12288
    v_mfma_f32_16x16x32_bf16 v[196:199], a[144:147], v[176:179], v[196:199]
    ds_read_b64_tr_b16 a[184:185], v17 offset:16384
    v_cvt_pk_bf16_f32 v224, v192, v193
    v_mfma_f32_16x16x32_bf16 v[196:199], a[148:151], v[180:183], v[196:199]
    ds_read_b64_tr_b16 a[186:187], v17 offset:20480
    v_cvt_pk_bf16_f32 v225, v194, v195
    v_mfma_f32_16x16x32_bf16 v[196:199], a[152:155], v[184:187], v[196:199]
    ds_read_b64_tr_b16 a[188:189], v17 offset:24576
    v_mfma_f32_16x16x32_bf16 v[196:199], a[156:159], v[188:191], v[196:199]
    s_waitcnt lgkmcnt(13)
    ds_read_b64_tr_b16 a[190:191], v17 offset:28672
    v_mfma_f32_16x16x32_bf16 v[200:203], a[160:163], v[128:131], 0
    s_waitcnt lgkmcnt(12)
    ds_read_b64_tr_b16 a[128:129], v14 offset:0
    v_mfma_f32_16x16x32_bf16 v[200:203], a[164:167], v[132:135], v[200:203]
    s_waitcnt lgkmcnt(11)
    ds_read_b64_tr_b16 a[130:131], v14 offset:4096
    v_mfma_f32_16x16x32_bf16 v[200:203], a[168:171], v[136:139], v[200:203]
    s_waitcnt lgkmcnt(10)
    ds_read_b64_tr_b16 a[132:133], v14 offset:8192
    v_mfma_f32_16x16x32_bf16 v[200:203], a[172:175], v[140:143], v[200:203]
    s_waitcnt lgkmcnt(9)
    ds_read_b64_tr_b16 a[134:135], v14 offset:12288
    v_mfma_f32_16x16x32_bf16 v[200:203], a[176:179], v[144:147], v[200:203]
    s_waitcnt lgkmcnt(8)
    ds_read_b64_tr_b16 a[136:137], v14 offset:16384
    v_cvt_pk_bf16_f32 v228, v196, v197
    v_mfma_f32_16x16x32_bf16 v[200:203], a[180:183], v[148:151], v[200:203]
    s_waitcnt lgkmcnt(7)
    ds_read_b64_tr_b16 a[138:139], v14 offset:20480
    v_cvt_pk_bf16_f32 v229, v198, v199
    v_mfma_f32_16x16x32_bf16 v[200:203], a[184:187], v[152:155], v[200:203]
    s_waitcnt lgkmcnt(6)
    ds_read_b64_tr_b16 a[140:141], v14 offset:24576
    v_mfma_f32_16x16x32_bf16 v[200:203], a[188:191], v[156:159], v[200:203]
    ds_read_b64_tr_b16 a[142:143], v14 offset:28672
    v_mfma_f32_16x16x32_bf16 v[204:207], a[160:163], v[160:163], 0
    ds_read_b64_tr_b16 a[144:145], v18 offset:0
    v_mfma_f32_16x16x32_bf16 v[204:207], a[164:167], v[164:167], v[204:207]
    ds_read_b64_tr_b16 a[146:147], v18 offset:4096
    v_mfma_f32_16x16x32_bf16 v[204:207], a[168:171], v[168:171], v[204:207]
    ds_read_b64_tr_b16 a[148:149], v18 offset:8192
    v_mfma_f32_16x16x32_bf16 v[204:207], a[172:175], v[172:175], v[204:207]
    ds_read_b64_tr_b16 a[150:151], v18 offset:12288
    v_mfma_f32_16x16x32_bf16 v[204:207], a[176:179], v[176:179], v[204:207]
    ds_read_b64_tr_b16 a[152:153], v18 offset:16384
    v_cvt_pk_bf16_f32 v226, v200, v201
    v_mfma_f32_16x16x32_bf16 v[204:207], a[180:183], v[180:183], v[204:207]
    s_add_u32 s38, s47, 6144
    ds_read_b64_tr_b16 a[154:155], v18 offset:20480
    v_cvt_pk_bf16_f32 v227, v202, v203
    v_mfma_f32_16x16x32_bf16 v[204:207], a[184:187], v[184:187], v[204:207]
    ds_read_b64_tr_b16 a[156:157], v18 offset:24576
    buffer_store_dwordx4 v[224:227], v56, s[28:31], s38 offen
    v_mfma_f32_16x16x32_bf16 v[204:207], a[188:191], v[188:191], v[204:207]
    s_waitcnt lgkmcnt(13)
    ds_read_b64_tr_b16 a[158:159], v18 offset:28672
    v_mfma_f32_16x16x32_bf16 v[192:195], a[128:131], v[128:131], 0
    s_waitcnt lgkmcnt(12)
    ds_read_b64_tr_b16 a[160:161], v15 offset:0
    v_mfma_f32_16x16x32_bf16 v[192:195], a[132:135], v[132:135], v[192:195]
    s_waitcnt lgkmcnt(11)
    ds_read_b64_tr_b16 a[162:163], v15 offset:4096
    v_mfma_f32_16x16x32_bf16 v[192:195], a[136:139], v[136:139], v[192:195]
    s_waitcnt lgkmcnt(10)
    ds_read_b64_tr_b16 a[164:165], v15 offset:8192
    v_mfma_f32_16x16x32_bf16 v[192:195], a[140:143], v[140:143], v[192:195]
    s_waitcnt lgkmcnt(9)
    ds_read_b64_tr_b16 a[166:167], v15 offset:12288
    v_mfma_f32_16x16x32_bf16 v[192:195], a[144:147], v[144:147], v[192:195]
    s_waitcnt lgkmcnt(8)
    ds_read_b64_tr_b16 a[168:169], v15 offset:16384
    v_cvt_pk_bf16_f32 v230, v204, v205
    v_mfma_f32_16x16x32_bf16 v[192:195], a[148:151], v[148:151], v[192:195]
    s_waitcnt lgkmcnt(7)
    s_add_u32 s38, s47, 301056
    ds_read_b64_tr_b16 a[170:171], v15 offset:20480
    v_cvt_pk_bf16_f32 v231, v206, v207
    v_mfma_f32_16x16x32_bf16 v[192:195], a[152:155], v[152:155], v[192:195]
    s_waitcnt lgkmcnt(6)
    ds_read_b64_tr_b16 a[172:173], v15 offset:24576
    buffer_store_dwordx4 v[228:231], v56, s[28:31], s38 offen
    v_mfma_f32_16x16x32_bf16 v[192:195], a[156:159], v[156:159], v[192:195]
    ds_read_b64_tr_b16 a[174:175], v15 offset:28672
    v_mfma_f32_16x16x32_bf16 v[196:199], a[128:131], v[160:163], 0
    ds_read_b64_tr_b16 a[176:177], v19 offset:0
    v_mfma_f32_16x16x32_bf16 v[196:199], a[132:135], v[164:167], v[196:199]
    ds_read_b64_tr_b16 a[178:179], v19 offset:4096
    v_mfma_f32_16x16x32_bf16 v[196:199], a[136:139], v[168:171], v[196:199]
    ds_read_b64_tr_b16 a[180:181], v19 offset:8192
    v_mfma_f32_16x16x32_bf16 v[196:199], a[140:143], v[172:175], v[196:199]
    ds_read_b64_tr_b16 a[182:183], v19 offset:12288
    v_mfma_f32_16x16x32_bf16 v[196:199], a[144:147], v[176:179], v[196:199]
    ds_read_b64_tr_b16 a[184:185], v19 offset:16384
    v_cvt_pk_bf16_f32 v232, v192, v193
    v_mfma_f32_16x16x32_bf16 v[196:199], a[148:151], v[180:183], v[196:199]
    ds_read_b64_tr_b16 a[186:187], v19 offset:20480
    v_cvt_pk_bf16_f32 v233, v194, v195
    v_mfma_f32_16x16x32_bf16 v[196:199], a[152:155], v[184:187], v[196:199]
    ds_read_b64_tr_b16 a[188:189], v19 offset:24576
    v_mfma_f32_16x16x32_bf16 v[196:199], a[156:159], v[188:191], v[196:199]
    s_waitcnt lgkmcnt(13)
    ds_read_b64_tr_b16 a[190:191], v19 offset:28672
    s_waitcnt vmcnt(18)
    s_barrier
    v_mfma_f32_16x16x32_bf16 v[200:203], a[160:163], v[128:131], 0
    s_waitcnt lgkmcnt(12)
    ds_read_b64_tr_b16 a[128:129], v12 offset:32768
    v_mfma_f32_16x16x32_bf16 v[200:203], a[164:167], v[132:135], v[200:203]
    s_waitcnt lgkmcnt(11)
    ds_read_b64_tr_b16 a[130:131], v12 offset:36864
    v_mfma_f32_16x16x32_bf16 v[200:203], a[168:171], v[136:139], v[200:203]
    s_waitcnt lgkmcnt(10)
    ds_read_b64_tr_b16 a[132:133], v12 offset:40960
    v_mfma_f32_16x16x32_bf16 v[200:203], a[172:175], v[140:143], v[200:203]
    s_waitcnt lgkmcnt(9)
    ds_read_b64_tr_b16 a[134:135], v12 offset:45056
    v_mfma_f32_16x16x32_bf16 v[200:203], a[176:179], v[144:147], v[200:203]
    s_waitcnt lgkmcnt(8)
    ds_read_b64_tr_b16 a[136:137], v12 offset:49152
    v_cvt_pk_bf16_f32 v236, v196, v197
    v_mfma_f32_16x16x32_bf16 v[200:203], a[180:183], v[148:151], v[200:203]
    s_waitcnt lgkmcnt(7)
    ds_read_b64_tr_b16 a[138:139], v12 offset:53248
    v_cvt_pk_bf16_f32 v237, v198, v199
    v_mfma_f32_16x16x32_bf16 v[200:203], a[184:187], v[152:155], v[200:203]
    s_waitcnt lgkmcnt(6)
    ds_read_b64_tr_b16 a[140:141], v12 offset:57344
    v_mfma_f32_16x16x32_bf16 v[200:203], a[188:191], v[156:159], v[200:203]
    ds_read_b64_tr_b16 a[142:143], v12 offset:61440
    v_mfma_f32_16x16x32_bf16 v[204:207], a[160:163], v[160:163], 0
    ds_read_b64_tr_b16 a[144:145], v16 offset:32768
    v_mfma_f32_16x16x32_bf16 v[204:207], a[164:167], v[164:167], v[204:207]
    ds_read_b64_tr_b16 a[146:147], v16 offset:36864
    v_mfma_f32_16x16x32_bf16 v[204:207], a[168:171], v[168:171], v[204:207]
    ds_read_b64_tr_b16 a[148:149], v16 offset:40960
    v_mfma_f32_16x16x32_bf16 v[204:207], a[172:175], v[172:175], v[204:207]
    ds_read_b64_tr_b16 a[150:151], v16 offset:45056
    v_mfma_f32_16x16x32_bf16 v[204:207], a[176:179], v[176:179], v[204:207]
    ds_read_b64_tr_b16 a[152:153], v16 offset:49152
    v_cvt_pk_bf16_f32 v234, v200, v201
    v_mfma_f32_16x16x32_bf16 v[204:207], a[180:183], v[180:183], v[204:207]
    s_add_u32 s38, s47, 6656
    ds_read_b64_tr_b16 a[154:155], v16 offset:53248
    v_cvt_pk_bf16_f32 v235, v202, v203
    v_mfma_f32_16x16x32_bf16 v[204:207], a[184:187], v[184:187], v[204:207]
    ds_read_b64_tr_b16 a[156:157], v16 offset:57344
    buffer_store_dwordx4 v[232:235], v56, s[28:31], s38 offen
    v_mfma_f32_16x16x32_bf16 v[204:207], a[188:191], v[188:191], v[204:207]
    s_waitcnt lgkmcnt(13)
    ds_read_b64_tr_b16 a[158:159], v16 offset:61440
    v_mfma_f32_16x16x32_bf16 v[192:195], a[128:131], v[128:131], 0
    s_waitcnt lgkmcnt(12)
    ds_read_b64_tr_b16 a[160:161], v13 offset:32768
    v_mfma_f32_16x16x32_bf16 v[192:195], a[132:135], v[132:135], v[192:195]
    s_waitcnt lgkmcnt(11)
    ds_read_b64_tr_b16 a[162:163], v13 offset:36864
    v_mfma_f32_16x16x32_bf16 v[192:195], a[136:139], v[136:139], v[192:195]
    s_waitcnt lgkmcnt(10)
    ds_read_b64_tr_b16 a[164:165], v13 offset:40960
    v_mfma_f32_16x16x32_bf16 v[192:195], a[140:143], v[140:143], v[192:195]
    s_waitcnt lgkmcnt(9)
    ds_read_b64_tr_b16 a[166:167], v13 offset:45056
    v_mfma_f32_16x16x32_bf16 v[192:195], a[144:147], v[144:147], v[192:195]
    s_waitcnt lgkmcnt(8)
    ds_read_b64_tr_b16 a[168:169], v13 offset:49152
    v_cvt_pk_bf16_f32 v238, v204, v205
    v_mfma_f32_16x16x32_bf16 v[192:195], a[148:151], v[148:151], v[192:195]
    s_waitcnt lgkmcnt(7)
    s_add_u32 s38, s47, 301568
    ds_read_b64_tr_b16 a[170:171], v13 offset:53248
    v_cvt_pk_bf16_f32 v239, v206, v207
    v_mfma_f32_16x16x32_bf16 v[192:195], a[152:155], v[152:155], v[192:195]
    s_waitcnt lgkmcnt(6)
    ds_read_b64_tr_b16 a[172:173], v13 offset:57344
    buffer_store_dwordx4 v[236:239], v56, s[28:31], s38 offen
    v_mfma_f32_16x16x32_bf16 v[192:195], a[156:159], v[156:159], v[192:195]
    ds_read_b64_tr_b16 a[174:175], v13 offset:61440
    v_mfma_f32_16x16x32_bf16 v[196:199], a[128:131], v[160:163], 0
    ds_read_b64_tr_b16 a[176:177], v17 offset:32768
    v_mfma_f32_16x16x32_bf16 v[196:199], a[132:135], v[164:167], v[196:199]
    ds_read_b64_tr_b16 a[178:179], v17 offset:36864
    v_mfma_f32_16x16x32_bf16 v[196:199], a[136:139], v[168:171], v[196:199]
    ds_read_b64_tr_b16 a[180:181], v17 offset:40960
    v_mfma_f32_16x16x32_bf16 v[196:199], a[140:143], v[172:175], v[196:199]
    ds_read_b64_tr_b16 a[182:183], v17 offset:45056
    v_mfma_f32_16x16x32_bf16 v[196:199], a[144:147], v[176:179], v[196:199]
    ds_read_b64_tr_b16 a[184:185], v17 offset:49152
    v_cvt_pk_bf16_f32 v224, v192, v193
    v_mfma_f32_16x16x32_bf16 v[196:199], a[148:151], v[180:183], v[196:199]
    ds_read_b64_tr_b16 a[186:187], v17 offset:53248
    v_cvt_pk_bf16_f32 v225, v194, v195
    v_mfma_f32_16x16x32_bf16 v[196:199], a[152:155], v[184:187], v[196:199]
    ds_read_b64_tr_b16 a[188:189], v17 offset:57344
    v_mfma_f32_16x16x32_bf16 v[196:199], a[156:159], v[188:191], v[196:199]
    s_waitcnt lgkmcnt(13)
    ds_read_b64_tr_b16 a[190:191], v17 offset:61440
    v_mfma_f32_16x16x32_bf16 v[200:203], a[160:163], v[128:131], 0
    s_waitcnt lgkmcnt(12)
    ds_read_b64_tr_b16 a[128:129], v14 offset:32768
    v_mfma_f32_16x16x32_bf16 v[200:203], a[164:167], v[132:135], v[200:203]
    s_waitcnt lgkmcnt(11)
    ds_read_b64_tr_b16 a[130:131], v14 offset:36864
    v_mfma_f32_16x16x32_bf16 v[200:203], a[168:171], v[136:139], v[200:203]
    s_waitcnt lgkmcnt(10)
    ds_read_b64_tr_b16 a[132:133], v14 offset:40960
    v_mfma_f32_16x16x32_bf16 v[200:203], a[172:175], v[140:143], v[200:203]
    s_waitcnt lgkmcnt(9)
    ds_read_b64_tr_b16 a[134:135], v14 offset:45056
    v_mfma_f32_16x16x32_bf16 v[200:203], a[176:179], v[144:147], v[200:203]
    s_waitcnt lgkmcnt(8)
    ds_read_b64_tr_b16 a[136:137], v14 offset:49152
    v_cvt_pk_bf16_f32 v228, v196, v197
    v_mfma_f32_16x16x32_bf16 v[200:203], a[180:183], v[148:151], v[200:203]
    s_waitcnt lgkmcnt(7)
    ds_read_b64_tr_b16 a[138:139], v14 offset:53248
    v_cvt_pk_bf16_f32 v229, v198, v199
    v_mfma_f32_16x16x32_bf16 v[200:203], a[184:187], v[152:155], v[200:203]
    s_waitcnt lgkmcnt(6)
    ds_read_b64_tr_b16 a[140:141], v14 offset:57344
    v_mfma_f32_16x16x32_bf16 v[200:203], a[188:191], v[156:159], v[200:203]
    ds_read_b64_tr_b16 a[142:143], v14 offset:61440
    v_mfma_f32_16x16x32_bf16 v[204:207], a[160:163], v[160:163], 0
    ds_read_b64_tr_b16 a[144:145], v18 offset:32768
    v_mfma_f32_16x16x32_bf16 v[204:207], a[164:167], v[164:167], v[204:207]
    ds_read_b64_tr_b16 a[146:147], v18 offset:36864
    v_mfma_f32_16x16x32_bf16 v[204:207], a[168:171], v[168:171], v[204:207]
    ds_read_b64_tr_b16 a[148:149], v18 offset:40960
    v_mfma_f32_16x16x32_bf16 v[204:207], a[172:175], v[172:175], v[204:207]
    ds_read_b64_tr_b16 a[150:151], v18 offset:45056
    v_mfma_f32_16x16x32_bf16 v[204:207], a[176:179], v[176:179], v[204:207]
    ds_read_b64_tr_b16 a[152:153], v18 offset:49152
    v_cvt_pk_bf16_f32 v226, v200, v201
    v_mfma_f32_16x16x32_bf16 v[204:207], a[180:183], v[180:183], v[204:207]
    s_add_u32 s38, s47, 7168
    ds_read_b64_tr_b16 a[154:155], v18 offset:53248
    v_cvt_pk_bf16_f32 v227, v202, v203
    v_mfma_f32_16x16x32_bf16 v[204:207], a[184:187], v[184:187], v[204:207]
    ds_read_b64_tr_b16 a[156:157], v18 offset:57344
    buffer_store_dwordx4 v[224:227], v56, s[28:31], s38 offen
    v_mfma_f32_16x16x32_bf16 v[204:207], a[188:191], v[188:191], v[204:207]
    s_waitcnt lgkmcnt(13)
    ds_read_b64_tr_b16 a[158:159], v18 offset:61440
    v_mfma_f32_16x16x32_bf16 v[192:195], a[128:131], v[128:131], 0
    s_waitcnt lgkmcnt(12)
    ds_read_b64_tr_b16 a[160:161], v15 offset:32768
    v_mfma_f32_16x16x32_bf16 v[192:195], a[132:135], v[132:135], v[192:195]
    s_waitcnt lgkmcnt(11)
    ds_read_b64_tr_b16 a[162:163], v15 offset:36864
    v_mfma_f32_16x16x32_bf16 v[192:195], a[136:139], v[136:139], v[192:195]
    s_waitcnt lgkmcnt(10)
    ds_read_b64_tr_b16 a[164:165], v15 offset:40960
    v_mfma_f32_16x16x32_bf16 v[192:195], a[140:143], v[140:143], v[192:195]
    s_waitcnt lgkmcnt(9)
    ds_read_b64_tr_b16 a[166:167], v15 offset:45056
    v_mfma_f32_16x16x32_bf16 v[192:195], a[144:147], v[144:147], v[192:195]
    s_waitcnt lgkmcnt(8)
    ds_read_b64_tr_b16 a[168:169], v15 offset:49152
    v_cvt_pk_bf16_f32 v230, v204, v205
    v_mfma_f32_16x16x32_bf16 v[192:195], a[148:151], v[148:151], v[192:195]
    s_waitcnt lgkmcnt(7)
    s_add_u32 s38, s47, 302080
    ds_read_b64_tr_b16 a[170:171], v15 offset:53248
    v_cvt_pk_bf16_f32 v231, v206, v207
    v_mfma_f32_16x16x32_bf16 v[192:195], a[152:155], v[152:155], v[192:195]
    s_waitcnt lgkmcnt(6)
    ds_read_b64_tr_b16 a[172:173], v15 offset:57344
    buffer_store_dwordx4 v[228:231], v56, s[28:31], s38 offen
    v_mfma_f32_16x16x32_bf16 v[192:195], a[156:159], v[156:159], v[192:195]
    ds_read_b64_tr_b16 a[174:175], v15 offset:61440
    v_mfma_f32_16x16x32_bf16 v[196:199], a[128:131], v[160:163], 0
    ds_read_b64_tr_b16 a[176:177], v19 offset:32768
    v_mfma_f32_16x16x32_bf16 v[196:199], a[132:135], v[164:167], v[196:199]
    ds_read_b64_tr_b16 a[178:179], v19 offset:36864
    v_mfma_f32_16x16x32_bf16 v[196:199], a[136:139], v[168:171], v[196:199]
    ds_read_b64_tr_b16 a[180:181], v19 offset:40960
    v_mfma_f32_16x16x32_bf16 v[196:199], a[140:143], v[172:175], v[196:199]
    ds_read_b64_tr_b16 a[182:183], v19 offset:45056
    v_mfma_f32_16x16x32_bf16 v[196:199], a[144:147], v[176:179], v[196:199]
    ds_read_b64_tr_b16 a[184:185], v19 offset:49152
    v_cvt_pk_bf16_f32 v232, v192, v193
    v_mfma_f32_16x16x32_bf16 v[196:199], a[148:151], v[180:183], v[196:199]
    ds_read_b64_tr_b16 a[186:187], v19 offset:53248
    v_cvt_pk_bf16_f32 v233, v194, v195
    v_mfma_f32_16x16x32_bf16 v[196:199], a[152:155], v[184:187], v[196:199]
    ds_read_b64_tr_b16 a[188:189], v19 offset:57344
    v_mfma_f32_16x16x32_bf16 v[196:199], a[156:159], v[188:191], v[196:199]
    s_waitcnt lgkmcnt(13)
    ds_read_b64_tr_b16 a[190:191], v19 offset:61440
    s_waitcnt vmcnt(10)
    s_barrier
    v_mfma_f32_16x16x32_bf16 v[200:203], a[160:163], v[128:131], 0
    s_waitcnt lgkmcnt(12)
    ds_read_b64_tr_b16 a[128:129], v20 offset:0
    v_mfma_f32_16x16x32_bf16 v[200:203], a[164:167], v[132:135], v[200:203]
    s_waitcnt lgkmcnt(11)
    ds_read_b64_tr_b16 a[130:131], v20 offset:4096
    v_mfma_f32_16x16x32_bf16 v[200:203], a[168:171], v[136:139], v[200:203]
    s_waitcnt lgkmcnt(10)
    ds_read_b64_tr_b16 a[132:133], v20 offset:8192
    v_mfma_f32_16x16x32_bf16 v[200:203], a[172:175], v[140:143], v[200:203]
    s_waitcnt lgkmcnt(9)
    ds_read_b64_tr_b16 a[134:135], v20 offset:12288
    v_mfma_f32_16x16x32_bf16 v[200:203], a[176:179], v[144:147], v[200:203]
    s_waitcnt lgkmcnt(8)
    ds_read_b64_tr_b16 a[136:137], v20 offset:16384
    v_cvt_pk_bf16_f32 v236, v196, v197
    v_mfma_f32_16x16x32_bf16 v[200:203], a[180:183], v[148:151], v[200:203]
    s_waitcnt lgkmcnt(7)
    ds_read_b64_tr_b16 a[138:139], v20 offset:20480
    v_cvt_pk_bf16_f32 v237, v198, v199
    v_mfma_f32_16x16x32_bf16 v[200:203], a[184:187], v[152:155], v[200:203]
    s_waitcnt lgkmcnt(6)
    ds_read_b64_tr_b16 a[140:141], v20 offset:24576
    v_mfma_f32_16x16x32_bf16 v[200:203], a[188:191], v[156:159], v[200:203]
    ds_read_b64_tr_b16 a[142:143], v20 offset:28672
    v_mfma_f32_16x16x32_bf16 v[204:207], a[160:163], v[160:163], 0
    ds_read_b64_tr_b16 a[144:145], v24 offset:0
    v_mfma_f32_16x16x32_bf16 v[204:207], a[164:167], v[164:167], v[204:207]
    ds_read_b64_tr_b16 a[146:147], v24 offset:4096
    v_mfma_f32_16x16x32_bf16 v[204:207], a[168:171], v[168:171], v[204:207]
    ds_read_b64_tr_b16 a[148:149], v24 offset:8192
    v_mfma_f32_16x16x32_bf16 v[204:207], a[172:175], v[172:175], v[204:207]
    ds_read_b64_tr_b16 a[150:151], v24 offset:12288
    v_mfma_f32_16x16x32_bf16 v[204:207], a[176:179], v[176:179], v[204:207]
    ds_read_b64_tr_b16 a[152:153], v24 offset:16384
    v_cvt_pk_bf16_f32 v234, v200, v201
    v_mfma_f32_16x16x32_bf16 v[204:207], a[180:183], v[180:183], v[204:207]
    s_add_u32 s38, s47, 7680
    ds_read_b64_tr_b16 a[154:155], v24 offset:20480
    v_cvt_pk_bf16_f32 v235, v202, v203
    v_mfma_f32_16x16x32_bf16 v[204:207], a[184:187], v[184:187], v[204:207]
    ds_read_b64_tr_b16 a[156:157], v24 offset:24576
    buffer_store_dwordx4 v[232:235], v56, s[28:31], s38 offen
    v_mfma_f32_16x16x32_bf16 v[204:207], a[188:191], v[188:191], v[204:207]
    s_waitcnt lgkmcnt(13)
    ds_read_b64_tr_b16 a[158:159], v24 offset:28672
    v_mfma_f32_16x16x32_bf16 v[192:195], a[128:131], v[128:131], 0
    s_waitcnt lgkmcnt(12)
    ds_read_b64_tr_b16 a[160:161], v21 offset:0
    v_mfma_f32_16x16x32_bf16 v[192:195], a[132:135], v[132:135], v[192:195]
    s_waitcnt lgkmcnt(11)
    ds_read_b64_tr_b16 a[162:163], v21 offset:4096
    v_mfma_f32_16x16x32_bf16 v[192:195], a[136:139], v[136:139], v[192:195]
    s_waitcnt lgkmcnt(10)
    ds_read_b64_tr_b16 a[164:165], v21 offset:8192
    v_mfma_f32_16x16x32_bf16 v[192:195], a[140:143], v[140:143], v[192:195]
    s_waitcnt lgkmcnt(9)
    ds_read_b64_tr_b16 a[166:167], v21 offset:12288
    v_mfma_f32_16x16x32_bf16 v[192:195], a[144:147], v[144:147], v[192:195]
    s_waitcnt lgkmcnt(8)
    ds_read_b64_tr_b16 a[168:169], v21 offset:16384
    v_cvt_pk_bf16_f32 v238, v204, v205
    v_mfma_f32_16x16x32_bf16 v[192:195], a[148:151], v[148:151], v[192:195]
    s_waitcnt lgkmcnt(7)
    s_add_u32 s38, s47, 302592
    ds_read_b64_tr_b16 a[170:171], v21 offset:20480
    v_cvt_pk_bf16_f32 v239, v206, v207
    v_mfma_f32_16x16x32_bf16 v[192:195], a[152:155], v[152:155], v[192:195]
    s_waitcnt lgkmcnt(6)
    ds_read_b64_tr_b16 a[172:173], v21 offset:24576
    buffer_store_dwordx4 v[236:239], v56, s[28:31], s38 offen
    v_mfma_f32_16x16x32_bf16 v[192:195], a[156:159], v[156:159], v[192:195]
    ds_read_b64_tr_b16 a[174:175], v21 offset:28672
    v_mfma_f32_16x16x32_bf16 v[196:199], a[128:131], v[160:163], 0
    ds_read_b64_tr_b16 a[176:177], v25 offset:0
    v_mfma_f32_16x16x32_bf16 v[196:199], a[132:135], v[164:167], v[196:199]
    ds_read_b64_tr_b16 a[178:179], v25 offset:4096
    v_mfma_f32_16x16x32_bf16 v[196:199], a[136:139], v[168:171], v[196:199]
    ds_read_b64_tr_b16 a[180:181], v25 offset:8192
    v_mfma_f32_16x16x32_bf16 v[196:199], a[140:143], v[172:175], v[196:199]
    ds_read_b64_tr_b16 a[182:183], v25 offset:12288
    v_mfma_f32_16x16x32_bf16 v[196:199], a[144:147], v[176:179], v[196:199]
    ds_read_b64_tr_b16 a[184:185], v25 offset:16384
    v_cvt_pk_bf16_f32 v224, v192, v193
    v_mfma_f32_16x16x32_bf16 v[196:199], a[148:151], v[180:183], v[196:199]
    ds_read_b64_tr_b16 a[186:187], v25 offset:20480
    v_cvt_pk_bf16_f32 v225, v194, v195
    v_mfma_f32_16x16x32_bf16 v[196:199], a[152:155], v[184:187], v[196:199]
    ds_read_b64_tr_b16 a[188:189], v25 offset:24576
    v_mfma_f32_16x16x32_bf16 v[196:199], a[156:159], v[188:191], v[196:199]
    s_waitcnt lgkmcnt(13)
    ds_read_b64_tr_b16 a[190:191], v25 offset:28672
    v_mfma_f32_16x16x32_bf16 v[200:203], a[160:163], v[128:131], 0
    s_waitcnt lgkmcnt(12)
    ds_read_b64_tr_b16 a[128:129], v22 offset:0
    v_mfma_f32_16x16x32_bf16 v[200:203], a[164:167], v[132:135], v[200:203]
    s_waitcnt lgkmcnt(11)
    ds_read_b64_tr_b16 a[130:131], v22 offset:4096
    v_mfma_f32_16x16x32_bf16 v[200:203], a[168:171], v[136:139], v[200:203]
    s_waitcnt lgkmcnt(10)
    ds_read_b64_tr_b16 a[132:133], v22 offset:8192
    v_mfma_f32_16x16x32_bf16 v[200:203], a[172:175], v[140:143], v[200:203]
    s_waitcnt lgkmcnt(9)
    ds_read_b64_tr_b16 a[134:135], v22 offset:12288
    v_mfma_f32_16x16x32_bf16 v[200:203], a[176:179], v[144:147], v[200:203]
    s_waitcnt lgkmcnt(8)
    ds_read_b64_tr_b16 a[136:137], v22 offset:16384
    v_cvt_pk_bf16_f32 v228, v196, v197
    v_mfma_f32_16x16x32_bf16 v[200:203], a[180:183], v[148:151], v[200:203]
    s_waitcnt lgkmcnt(7)
    ds_read_b64_tr_b16 a[138:139], v22 offset:20480
    v_cvt_pk_bf16_f32 v229, v198, v199
    v_mfma_f32_16x16x32_bf16 v[200:203], a[184:187], v[152:155], v[200:203]
    s_waitcnt lgkmcnt(6)
    ds_read_b64_tr_b16 a[140:141], v22 offset:24576
    v_mfma_f32_16x16x32_bf16 v[200:203], a[188:191], v[156:159], v[200:203]
    ds_read_b64_tr_b16 a[142:143], v22 offset:28672
    v_mfma_f32_16x16x32_bf16 v[204:207], a[160:163], v[160:163], 0
    ds_read_b64_tr_b16 a[144:145], v26 offset:0
    v_mfma_f32_16x16x32_bf16 v[204:207], a[164:167], v[164:167], v[204:207]
    ds_read_b64_tr_b16 a[146:147], v26 offset:4096
    v_mfma_f32_16x16x32_bf16 v[204:207], a[168:171], v[168:171], v[204:207]
    ds_read_b64_tr_b16 a[148:149], v26 offset:8192
    v_mfma_f32_16x16x32_bf16 v[204:207], a[172:175], v[172:175], v[204:207]
    ds_read_b64_tr_b16 a[150:151], v26 offset:12288
    v_mfma_f32_16x16x32_bf16 v[204:207], a[176:179], v[176:179], v[204:207]
    ds_read_b64_tr_b16 a[152:153], v26 offset:16384
    v_cvt_pk_bf16_f32 v226, v200, v201
    v_mfma_f32_16x16x32_bf16 v[204:207], a[180:183], v[180:183], v[204:207]
    s_add_u32 s38, s47, 8192
    ds_read_b64_tr_b16 a[154:155], v26 offset:20480
    v_cvt_pk_bf16_f32 v227, v202, v203
    v_mfma_f32_16x16x32_bf16 v[204:207], a[184:187], v[184:187], v[204:207]
    ds_read_b64_tr_b16 a[156:157], v26 offset:24576
    buffer_store_dwordx4 v[224:227], v56, s[28:31], s38 offen
    v_mfma_f32_16x16x32_bf16 v[204:207], a[188:191], v[188:191], v[204:207]
    s_waitcnt lgkmcnt(13)
    ds_read_b64_tr_b16 a[158:159], v26 offset:28672
    v_mfma_f32_16x16x32_bf16 v[192:195], a[128:131], v[128:131], 0
    s_waitcnt lgkmcnt(12)
    ds_read_b64_tr_b16 a[160:161], v23 offset:0
    v_mfma_f32_16x16x32_bf16 v[192:195], a[132:135], v[132:135], v[192:195]
    s_waitcnt lgkmcnt(11)
    ds_read_b64_tr_b16 a[162:163], v23 offset:4096
    v_mfma_f32_16x16x32_bf16 v[192:195], a[136:139], v[136:139], v[192:195]
    s_waitcnt lgkmcnt(10)
    ds_read_b64_tr_b16 a[164:165], v23 offset:8192
    v_mfma_f32_16x16x32_bf16 v[192:195], a[140:143], v[140:143], v[192:195]
    s_waitcnt lgkmcnt(9)
    ds_read_b64_tr_b16 a[166:167], v23 offset:12288
    v_mfma_f32_16x16x32_bf16 v[192:195], a[144:147], v[144:147], v[192:195]
    s_waitcnt lgkmcnt(8)
    ds_read_b64_tr_b16 a[168:169], v23 offset:16384
    v_cvt_pk_bf16_f32 v230, v204, v205
    v_mfma_f32_16x16x32_bf16 v[192:195], a[148:151], v[148:151], v[192:195]
    s_waitcnt lgkmcnt(7)
    s_add_u32 s38, s47, 303104
    ds_read_b64_tr_b16 a[170:171], v23 offset:20480
    v_cvt_pk_bf16_f32 v231, v206, v207
    v_mfma_f32_16x16x32_bf16 v[192:195], a[152:155], v[152:155], v[192:195]
    s_waitcnt lgkmcnt(6)
    ds_read_b64_tr_b16 a[172:173], v23 offset:24576
    buffer_store_dwordx4 v[228:231], v56, s[28:31], s38 offen
    v_mfma_f32_16x16x32_bf16 v[192:195], a[156:159], v[156:159], v[192:195]
    ds_read_b64_tr_b16 a[174:175], v23 offset:28672
    v_mfma_f32_16x16x32_bf16 v[196:199], a[128:131], v[160:163], 0
    ds_read_b64_tr_b16 a[176:177], v27 offset:0
    v_mfma_f32_16x16x32_bf16 v[196:199], a[132:135], v[164:167], v[196:199]
    ds_read_b64_tr_b16 a[178:179], v27 offset:4096
    v_mfma_f32_16x16x32_bf16 v[196:199], a[136:139], v[168:171], v[196:199]
    ds_read_b64_tr_b16 a[180:181], v27 offset:8192
    v_mfma_f32_16x16x32_bf16 v[196:199], a[140:143], v[172:175], v[196:199]
    ds_read_b64_tr_b16 a[182:183], v27 offset:12288
    v_mfma_f32_16x16x32_bf16 v[196:199], a[144:147], v[176:179], v[196:199]
    ds_read_b64_tr_b16 a[184:185], v27 offset:16384
    v_cvt_pk_bf16_f32 v232, v192, v193
    v_mfma_f32_16x16x32_bf16 v[196:199], a[148:151], v[180:183], v[196:199]
    ds_read_b64_tr_b16 a[186:187], v27 offset:20480
    v_cvt_pk_bf16_f32 v233, v194, v195
    v_mfma_f32_16x16x32_bf16 v[196:199], a[152:155], v[184:187], v[196:199]
    ds_read_b64_tr_b16 a[188:189], v27 offset:24576
    v_mfma_f32_16x16x32_bf16 v[196:199], a[156:159], v[188:191], v[196:199]
    s_waitcnt lgkmcnt(13)
    ds_read_b64_tr_b16 a[190:191], v27 offset:28672
    v_mfma_f32_16x16x32_bf16 v[200:203], a[160:163], v[128:131], 0
    s_waitcnt lgkmcnt(12)
    v_mfma_f32_16x16x32_bf16 v[200:203], a[164:167], v[132:135], v[200:203]
    s_waitcnt lgkmcnt(10)
    v_mfma_f32_16x16x32_bf16 v[200:203], a[168:171], v[136:139], v[200:203]
    s_waitcnt lgkmcnt(8)
    v_mfma_f32_16x16x32_bf16 v[200:203], a[172:175], v[140:143], v[200:203]
    s_waitcnt lgkmcnt(6)
    v_mfma_f32_16x16x32_bf16 v[200:203], a[176:179], v[144:147], v[200:203]
    s_waitcnt lgkmcnt(4)
    v_cvt_pk_bf16_f32 v236, v196, v197
    v_mfma_f32_16x16x32_bf16 v[200:203], a[180:183], v[148:151], v[200:203]
    s_waitcnt lgkmcnt(2)
    v_cvt_pk_bf16_f32 v237, v198, v199
    v_mfma_f32_16x16x32_bf16 v[200:203], a[184:187], v[152:155], v[200:203]
    s_waitcnt lgkmcnt(0)
    v_mfma_f32_16x16x32_bf16 v[200:203], a[188:191], v[156:159], v[200:203]
    v_mfma_f32_16x16x32_bf16 v[204:207], a[160:163], v[160:163], 0
    v_mfma_f32_16x16x32_bf16 v[204:207], a[164:167], v[164:167], v[204:207]
    v_mfma_f32_16x16x32_bf16 v[204:207], a[168:171], v[168:171], v[204:207]
    v_mfma_f32_16x16x32_bf16 v[204:207], a[172:175], v[172:175], v[204:207]
    v_mfma_f32_16x16x32_bf16 v[204:207], a[176:179], v[176:179], v[204:207]
    s_nop 2
    v_cvt_pk_bf16_f32 v234, v200, v201
    v_mfma_f32_16x16x32_bf16 v[204:207], a[180:183], v[180:183], v[204:207]
    s_add_u32 s38, s47, 8704
    v_cvt_pk_bf16_f32 v235, v202, v203
    v_mfma_f32_16x16x32_bf16 v[204:207], a[184:187], v[184:187], v[204:207]
    buffer_store_dwordx4 v[232:235], v56, s[28:31], s38 offen
    v_mfma_f32_16x16x32_bf16 v[204:207], a[188:191], v[188:191], v[204:207]
    s_nop 7
    v_cvt_pk_bf16_f32 v238, v204, v205
    s_add_u32 s38, s47, 303616
    v_cvt_pk_bf16_f32 v239, v206, v207
    buffer_store_dwordx4 v[236:239], v56, s[28:31], s38 offen
    s_endpgm
Lattn_redo:
    s_waitcnt vmcnt(0) lgkmcnt(0)
    s_barrier
    v_mov_b32 v232, 0xff800000
    v_mov_b32 v233, 0xff800000
    v_mov_b32 v234, 0xff800000
    v_mov_b32 v235, 0xff800000
    s_mov_b32 s40, 0
    s_mov_b32 s48, -1
Lattn_redo_loop:
    s_add_u32 m0, s42, 0
    s_nop 0
    buffer_load_dwordx4 v36, s[8:11], s40 offen lds
    buffer_load_dwordx4 v37, s[8:11], s40 offen offset:1024 lds
    buffer_load_dwordx4 v38, s[8:11], s40 offen offset:2048 lds
    buffer_load_dwordx4 v39, s[8:11], s40 offen offset:3072 lds
    s_add_u32 s40, s40, 16384
    s_waitcnt vmcnt(0) lgkmcnt(0)
    s_barrier
    ds_read_b128 a[208:211], v8 offset:0
    ds_read_b128 a[212:215], v9 offset:0
    ds_read_b128 a[216:219], v10 offset:0
    ds_read_b128 a[220:223], v11 offset:0
    s_waitcnt lgkmcnt(3)
    v_mfma_f32_16x16x32_bf16 v[216:219], a[208:211], v[64:67], 0
    s_waitcnt lgkmcnt(2)
    v_mfma_f32_16x16x32_bf16 v[216:219], a[212:215], v[68:71], v[216:219]
    s_waitcnt lgkmcnt(1)
    v_mfma_f32_16x16x32_bf16 v[216:219], a[216:219], v[72:75], v[216:219]
    s_waitcnt lgkmcnt(0)
    v_mfma_f32_16x16x32_bf16 v[216:219], a[220:223], v[76:79], v[216:219]
    v_mfma_f32_16x16x32_bf16 v[220:223], a[208:211], v[80:83], 0
    v_mfma_f32_16x16x32_bf16 v[220:223], a[212:215], v[84:87], v[220:223]
    v_mfma_f32_16x16x32_bf16 v[220:223], a[216:219], v[88:91], v[220:223]
    v_mfma_f32_16x16x32_bf16 v[220:223], a[220:223], v[92:95], v[220:223]
    v_mfma_f32_16x16x32_bf16 v[224:227], a[208:211], v[96:99], 0
    v_mfma_f32_16x16x32_bf16 v[224:227], a[212:215], v[100:103], v[224:227]
    v_mfma_f32_16x16x32_bf16 v[224:227], a[216:219], v[104:107], v[224:227]
    v_mfma_f32_16x16x32_bf16 v[224:227], a[220:223], v[108:111], v[224:227]
    v_mfma_f32_16x16x32_bf16 v[228:231], a[208:211], v[112:115], 0
    v_mfma_f32_16x16x32_bf16 v[228:231], a[212:215], v[116:119], v[228:231]
    v_mfma_f32_16x16x32_bf16 v[228:231], a[216:219], v[120:123], v[228:231]
    v_mfma_f32_16x16x32_bf16 v[228:231], a[220:223], v[124:127], v[228:231]
    v_max3_f32 v232, v232, v216, v217
    v_max3_f32 v232, v232, v218, v219
    v_max3_f32 v233, v233, v220, v221
    v_max3_f32 v233, v233, v222, v223
    v_max3_f32 v234, v234, v224, v225
    v_max3_f32 v234, v234, v226, v227
    s_nop 1
    v_max3_f32 v235, v235, v228, v229
    v_max3_f32 v235, v235, v230, v231
    ds_read_b128 a[224:227], v8 offset:4096
    ds_read_b128 a[228:231], v9 offset:4096
    ds_read_b128 a[232:235], v10 offset:4096
    ds_read_b128 a[236:239], v11 offset:4096
    s_waitcnt lgkmcnt(3)
    v_mfma_f32_16x16x32_bf16 v[216:219], a[224:227], v[64:67], 0
    s_waitcnt lgkmcnt(2)
    v_mfma_f32_16x16x32_bf16 v[216:219], a[228:231], v[68:71], v[216:219]
    s_waitcnt lgkmcnt(1)
    v_mfma_f32_16x16x32_bf16 v[216:219], a[232:235], v[72:75], v[216:219]
    s_waitcnt lgkmcnt(0)
    v_mfma_f32_16x16x32_bf16 v[216:219], a[236:239], v[76:79], v[216:219]
    v_mfma_f32_16x16x32_bf16 v[220:223], a[224:227], v[80:83], 0
    v_mfma_f32_16x16x32_bf16 v[220:223], a[228:231], v[84:87], v[220:223]
    v_mfma_f32_16x16x32_bf16 v[220:223], a[232:235], v[88:91], v[220:223]
    v_mfma_f32_16x16x32_bf16 v[220:223], a[236:239], v[92:95], v[220:223]
    v_mfma_f32_16x16x32_bf16 v[224:227], a[224:227], v[96:99], 0
    v_mfma_f32_16x16x32_bf16 v[224:227], a[228:231], v[100:103], v[224:227]
    v_mfma_f32_16x16x32_bf16 v[224:227], a[232:235], v[104:107], v[224:227]
    v_mfma_f32_16x16x32_bf16 v[224:227], a[236:239], v[108:111], v[224:227]
    v_mfma_f32_16x16x32_bf16 v[228:231], a[224:227], v[112:115], 0
    v_mfma_f32_16x16x32_bf16 v[228:231], a[228:231], v[116:119], v[228:231]
    v_mfma_f32_16x16x32_bf16 v[228:231], a[232:235], v[120:123], v[228:231]
    v_mfma_f32_16x16x32_bf16 v[228:231], a[236:239], v[124:127], v[228:231]
    v_max3_f32 v232, v232, v216, v217
    v_max3_f32 v232, v232, v218, v219
    v_max3_f32 v233, v233, v220, v221
    v_max3_f32 v233, v233, v222, v223
    v_max3_f32 v234, v234, v224, v225
    v_max3_f32 v234, v234, v226, v227
    s_nop 1
    v_max3_f32 v235, v235, v228, v229
    v_max3_f32 v235, v235, v230, v231
    ds_read_b128 a[208:211], v8 offset:8192
    ds_read_b128 a[212:215], v9 offset:8192
    ds_read_b128 a[216:219], v10 offset:8192
    ds_read_b128 a[220:223], v11 offset:8192
    s_waitcnt lgkmcnt(3)
    v_mfma_f32_16x16x32_bf16 v[216:219], a[208:211], v[64:67], 0
    s_waitcnt lgkmcnt(2)
    v_mfma_f32_16x16x32_bf16 v[216:219], a[212:215], v[68:71], v[216:219]
    s_waitcnt lgkmcnt(1)
    v_mfma_f32_16x16x32_bf16 v[216:219], a[216:219], v[72:75], v[216:219]
    s_waitcnt lgkmcnt(0)
    v_mfma_f32_16x16x32_bf16 v[216:219], a[220:223], v[76:79], v[216:219]
    v_mfma_f32_16x16x32_bf16 v[220:223], a[208:211], v[80:83], 0
    v_mfma_f32_16x16x32_bf16 v[220:223], a[212:215], v[84:87], v[220:223]
    v_mfma_f32_16x16x32_bf16 v[220:223], a[216:219], v[88:91], v[220:223]
    v_mfma_f32_16x16x32_bf16 v[220:223], a[220:223], v[92:95], v[220:223]
    v_mfma_f32_16x16x32_bf16 v[224:227], a[208:211], v[96:99], 0
    v_mfma_f32_16x16x32_bf16 v[224:227], a[212:215], v[100:103], v[224:227]
    v_mfma_f32_16x16x32_bf16 v[224:227], a[216:219], v[104:107], v[224:227]
    v_mfma_f32_16x16x32_bf16 v[224:227], a[220:223], v[108:111], v[224:227]
    v_mfma_f32_16x16x32_bf16 v[228:231], a[208:211], v[112:115], 0
    v_mfma_f32_16x16x32_bf16 v[228:231], a[212:215], v[116:119], v[228:231]
    v_mfma_f32_16x16x32_bf16 v[228:231], a[216:219], v[120:123], v[228:231]
    v_mfma_f32_16x16x32_bf16 v[228:231], a[220:223], v[124:127], v[228:231]
    v_max3_f32 v232, v232, v216, v217
    v_max3_f32 v232, v232, v218, v219
    v_max3_f32 v233, v233, v220, v221
    v_max3_f32 v233, v233, v222, v223
    v_max3_f32 v234, v234, v224, v225
    v_max3_f32 v234, v234, v226, v227
    s_nop 1
    v_max3_f32 v235, v235, v228, v229
    v_max3_f32 v235, v235, v230, v231
    ds_read_b128 a[224:227], v8 offset:12288
    ds_read_b128 a[228:231], v9 offset:12288
    ds_read_b128 a[232:235], v10 offset:12288
    ds_read_b128 a[236:239], v11 offset:12288
    s_waitcnt lgkmcnt(3)
    v_mfma_f32_16x16x32_bf16 v[216:219], a[224:227], v[64:67], 0
    s_waitcnt lgkmcnt(2)
    v_mfma_f32_16x16x32_bf16 v[216:219], a[228:231], v[68:71], v[216:219]
    s_waitcnt lgkmcnt(1)
    v_mfma_f32_16x16x32_bf16 v[216:219], a[232:235], v[72:75], v[216:219]
    s_waitcnt lgkmcnt(0)
    v_mfma_f32_16x16x32_bf16 v[216:219], a[236:239], v[76:79], v[216:219]
    v_mfma_f32_16x16x32_bf16 v[220:223], a[224:227], v[80:83], 0
    v_mfma_f32_16x16x32_bf16 v[220:223], a[228:231], v[84:87], v[220:223]
    v_mfma_f32_16x16x32_bf16 v[220:223], a[232:235], v[88:91], v[220:223]
    v_mfma_f32_16x16x32_bf16 v[220:223], a[236:239], v[92:95], v[220:223]
    v_mfma_f32_16x16x32_bf16 v[224:227], a[224:227], v[96:99], 0
    v_mfma_f32_16x16x32_bf16 v[224:227], a[228:231], v[100:103], v[224:227]
    v_mfma_f32_16x16x32_bf16 v[224:227], a[232:235], v[104:107], v[224:227]
    v_mfma_f32_16x16x32_bf16 v[224:227], a[236:239], v[108:111], v[224:227]
    v_mfma_f32_16x16x32_bf16 v[228:231], a[224:227], v[112:115], 0
    v_mfma_f32_16x16x32_bf16 v[228:231], a[228:231], v[116:119], v[228:231]
    v_mfma_f32_16x16x32_bf16 v[228:231], a[232:235], v[120:123], v[228:231]
    v_mfma_f32_16x16x32_bf16 v[228:231], a[236:239], v[124:127], v[228:231]
    v_max3_f32 v232, v232, v216, v217
    v_max3_f32 v232, v232, v218, v219
    v_max3_f32 v233, v233, v220, v221
    v_max3_f32 v233, v233, v222, v223
    v_max3_f32 v234, v234, v224, v225
    v_max3_f32 v234, v234, v226, v227
    s_nop 1
    v_max3_f32 v235, v235, v228, v229
    v_max3_f32 v235, v235, v230, v231
    s_barrier
    s_cmp_lt_u32 s40, 524288
    s_cbranch_scc1 Lattn_redo_loop
    v_mov_b32 v236, v232
    v_mov_b32 v237, v233
    v_mov_b32 v238, v234
    v_mov_b32 v239, v235
    v_permlane16_swap_b32 v232, v236
    v_permlane16_swap_b32 v233, v237
    v_permlane16_swap_b32 v234, v238
    v_permlane16_swap_b32 v235, v239
    v_max_f32 v232, v232, v236
    v_max_f32 v233, v233, v237
    v_max_f32 v234, v234, v238
    v_max_f32 v235, v235, v239
    v_mov_b32 v236, v232
    v_mov_b32 v237, v233
    v_mov_b32 v238, v234
    v_mov_b32 v239, v235
    v_permlane32_swap_b32 v232, v236
    v_permlane32_swap_b32 v233, v237
    v_permlane32_swap_b32 v234, v238
    v_permlane32_swap_b32 v235, v239
    v_max_f32 v232, v232, v236
    v_max_f32 v233, v233, v237
    v_max_f32 v234, v234, v238
    v_max_f32 v235, v235, v239
    v_sub_f32 v192, 0, v232
    v_sub_f32 v193, 0, v232
    v_sub_f32 v194, 0, v232
    v_sub_f32 v195, 0, v232
    v_sub_f32 v196, 0, v233
    v_sub_f32 v197, 0, v233
    v_sub_f32 v198, 0, v233
    v_sub_f32 v199, 0, v233
    v_sub_f32 v200, 0, v234
    v_sub_f32 v201, 0, v234
    v_sub_f32 v202, 0, v234
    v_sub_f32 v203, 0, v234
    v_sub_f32 v204, 0, v235
    v_sub_f32 v205, 0, v235
    v_sub_f32 v206, 0, v235
    v_sub_f32 v207, 0, v235
    s_mov_b32 s40, 0
    s_mov_b32 s41, 0
    s_add_u32 m0, s42, 0
    s_nop 0
    buffer_load_dwordx4 v36, s[8:11], s40 offen lds
    buffer_load_dwordx4 v37, s[8:11], s40 offen offset:1024 lds
    buffer_load_dwordx4 v38, s[8:11], s40 offen offset:2048 lds
    buffer_load_dwordx4 v39, s[8:11], s40 offen offset:3072 lds
    s_add_u32 s40, s40, 16384
    s_add_u32 m0, s42, 16384
    s_nop 0
    buffer_load_dwordx4 v36, s[8:11], s40 offen lds
    buffer_load_dwordx4 v37, s[8:11], s40 offen offset:1024 lds
    buffer_load_dwordx4 v38, s[8:11], s40 offen offset:2048 lds
    buffer_load_dwordx4 v39, s[8:11], s40 offen offset:3072 lds
    s_add_u32 s40, s40, 16384
    s_add_u32 m0, s42, 32768
    s_nop 0
    buffer_load_dwordx4 v36, s[8:11], s40 offen lds
    buffer_load_dwordx4 v37, s[8:11], s40 offen offset:1024 lds
    buffer_load_dwordx4 v38, s[8:11], s40 offen offset:2048 lds
    buffer_load_dwordx4 v39, s[8:11], s40 offen offset:3072 lds
    s_add_u32 s40, s40, 16384
    s_add_u32 m0, s42, 65536
    s_nop 0
    buffer_load_dwordx4 v40, s[12:15], s41 offen lds
    buffer_load_dwordx4 v41, s[12:15], s41 offen offset:1024 lds
    buffer_load_dwordx4 v40, s[12:15], s41 offen offset:2048 lds
    buffer_load_dwordx4 v41, s[12:15], s41 offen offset:3072 lds
    s_add_u32 s41, s41, 16384
    s_add_u32 m0, s42, 81920
    s_nop 0
    buffer_load_dwordx4 v40, s[12:15], s41 offen lds
    buffer_load_dwordx4 v41, s[12:15], s41 offen offset:1024 lds
    buffer_load_dwordx4 v40, s[12:15], s41 offen offset:2048 lds
    buffer_load_dwordx4 v41, s[12:15], s41 offen offset:3072 lds
    s_add_u32 s41, s41, 16384
    v_accvgpr_write_b32 a0, 0
    v_accvgpr_write_b32 a1, 0
    v_accvgpr_write_b32 a2, 0
    v_accvgpr_write_b32 a3, 0
    v_accvgpr_write_b32 a4, 0
    v_accvgpr_write_b32 a5, 0
    v_accvgpr_write_b32 a6, 0
    v_accvgpr_write_b32 a7, 0
    v_accvgpr_write_b32 a8, 0
    v_accvgpr_write_b32 a9, 0
    v_accvgpr_write_b32 a10, 0
    v_accvgpr_write_b32 a11, 0
    v_accvgpr_write_b32 a12, 0
    v_accvgpr_write_b32 a13, 0
    v_accvgpr_write_b32 a14, 0
    v_accvgpr_write_b32 a15, 0
    v_accvgpr_write_b32 a16, 0
    v_accvgpr_write_b32 a17, 0
    v_accvgpr_write_b32 a18, 0
    v_accvgpr_write_b32 a19, 0
    v_accvgpr_write_b32 a20, 0
    v_accvgpr_write_b32 a21, 0
    v_accvgpr_write_b32 a22, 0
    v_accvgpr_write_b32 a23, 0
    v_accvgpr_write_b32 a24, 0
    v_accvgpr_write_b32 a25, 0
    v_accvgpr_write_b32 a26, 0
    v_accvgpr_write_b32 a27, 0
    v_accvgpr_write_b32 a28, 0
    v_accvgpr_write_b32 a29, 0
    v_accvgpr_write_b32 a30, 0
    v_accvgpr_write_b32 a31, 0
    v_accvgpr_write_b32 a32, 0
    v_accvgpr_write_b32 a33, 0
    v_accvgpr_write_b32 a34, 0
    v_accvgpr_write_b32 a35, 0
    v_accvgpr_write_b32 a36, 0
    v_accvgpr_write_b32 a37, 0
    v_accvgpr_write_b32 a38, 0
    v_accvgpr_write_b32 a39, 0
    v_accvgpr_write_b32 a40, 0
    v_accvgpr_write_b32 a41, 0
    v_accvgpr_write_b32 a42, 0
    v_accvgpr_write_b32 a43, 0
    v_accvgpr_write_b32 a44, 0
    v_accvgpr_write_b32 a45, 0
    v_accvgpr_write_b32 a46, 0
    v_accvgpr_write_b32 a47, 0
    v_accvgpr_write_b32 a48, 0
    v_accvgpr_write_b32 a49, 0
    v_accvgpr_write_b32 a50, 0
    v_accvgpr_write_b32 a51, 0
    v_accvgpr_write_b32 a52, 0
    v_accvgpr_write_b32 a53, 0
    v_accvgpr_write_b32 a54, 0
    v_accvgpr_write_b32 a55, 0
    v_accvgpr_write_b32 a56, 0
    v_accvgpr_write_b32 a57, 0
    v_accvgpr_write_b32 a58, 0
    v_accvgpr_write_b32 a59, 0
    v_accvgpr_write_b32 a60, 0
    v_accvgpr_write_b32 a61, 0
    v_accvgpr_write_b32 a62, 0
    v_accvgpr_write_b32 a63, 0
    v_accvgpr_write_b32 a64, 0
    v_accvgpr_write_b32 a65, 0
    v_accvgpr_write_b32 a66, 0
    v_accvgpr_write_b32 a67, 0
    v_accvgpr_write_b32 a68, 0
    v_accvgpr_write_b32 a69, 0
    v_accvgpr_write_b32 a70, 0
    v_accvgpr_write_b32 a71, 0
    v_accvgpr_write_b32 a72, 0
    v_accvgpr_write_b32 a73, 0
    v_accvgpr_write_b32 a74, 0
    v_accvgpr_write_b32 a75, 0
    v_accvgpr_write_b32 a76, 0
    v_accvgpr_write_b32 a77, 0
    v_accvgpr_write_b32 a78, 0
    v_accvgpr_write_b32 a79, 0
    v_accvgpr_write_b32 a80, 0
    v_accvgpr_write_b32 a81, 0
    v_accvgpr_write_b32 a82, 0
    v_accvgpr_write_b32 a83, 0
    v_accvgpr_write_b32 a84, 0
    v_accvgpr_write_b32 a85, 0
    v_accvgpr_write_b32 a86, 0
    v_accvgpr_write_b32 a87, 0
    v_accvgpr_write_b32 a88, 0
    v_accvgpr_write_b32 a89, 0
    v_accvgpr_write_b32 a90, 0
    v_accvgpr_write_b32 a91, 0
    v_accvgpr_write_b32 a92, 0
    v_accvgpr_write_b32 a93, 0
    v_accvgpr_write_b32 a94, 0
    v_accvgpr_write_b32 a95, 0
    v_accvgpr_write_b32 a96, 0
    v_accvgpr_write_b32 a97, 0
    v_accvgpr_write_b32 a98, 0
    v_accvgpr_write_b32 a99, 0
    v_accvgpr_write_b32 a100, 0
    v_accvgpr_write_b32 a101, 0
    v_accvgpr_write_b32 a102, 0
    v_accvgpr_write_b32 a103, 0
    v_accvgpr_write_b32 a104, 0
    v_accvgpr_write_b32 a105, 0
    v_accvgpr_write_b32 a106, 0
    v_accvgpr_write_b32 a107, 0
    v_accvgpr_write_b32 a108, 0
    v_accvgpr_write_b32 a109, 0
    v_accvgpr_write_b32 a110, 0
    v_accvgpr_write_b32 a111, 0
    v_accvgpr_write_b32 a112, 0
    v_accvgpr_write_b32 a113, 0
    v_accvgpr_write_b32 a114, 0
    v_accvgpr_write_b32 a115, 0
    v_accvgpr_write_b32 a116, 0
    v_accvgpr_write_b32 a117, 0
    v_accvgpr_write_b32 a118, 0
    v_accvgpr_write_b32 a119, 0
    v_accvgpr_write_b32 a120, 0
    v_accvgpr_write_b32 a121, 0
    v_accvgpr_write_b32 a122, 0
    v_accvgpr_write_b32 a123, 0
    v_accvgpr_write_b32 a124, 0
    v_accvgpr_write_b32 a125, 0
    v_accvgpr_write_b32 a126, 0
    v_accvgpr_write_b32 a127, 0
    v_accvgpr_write_b32 a192, 0
    v_accvgpr_write_b32 a193, 0
    v_accvgpr_write_b32 a194, 0
    v_accvgpr_write_b32 a195, 0
    v_accvgpr_write_b32 a196, 0
    v_accvgpr_write_b32 a197, 0
    v_accvgpr_write_b32 a198, 0
    v_accvgpr_write_b32 a199, 0
    v_accvgpr_write_b32 a200, 0
    v_accvgpr_write_b32 a201, 0
    v_accvgpr_write_b32 a202, 0
    v_accvgpr_write_b32 a203, 0
    v_accvgpr_write_b32 a204, 0
    v_accvgpr_write_b32 a205, 0
    v_accvgpr_write_b32 a206, 0
    v_accvgpr_write_b32 a207, 0
    s_waitcnt vmcnt(0) lgkmcnt(0)
    s_barrier
    ds_read_b128 a[208:211], v8 offset:0
    ds_read_b128 a[212:215], v9 offset:0
    ds_read_b128 a[216:219], v10 offset:0
    ds_read_b128 a[220:223], v11 offset:0
    ds_read_b128 a[224:227], v8 offset:4096
    s_waitcnt vmcnt(0) lgkmcnt(0)
    s_branch Lattn_stage0
Lattn_end:
    s_endpgm
.globl post_kernel
.p2align 8
.type post_kernel,@function
post_kernel:
    s_cmp_ge_u32 s2, 256
    s_cbranch_scc1 Lpost_end
    s_load_dwordx2 s[4:5], s[0:1], 0
    s_load_dwordx2 s[6:7], s[0:1], 112
    s_load_dwordx2 s[36:37], s[0:1], 48
    s_load_dwordx2 s[40:41], s[0:1], 96
    v_and_b32 v1, 7, v0
    v_lshrrev_b32 v2, 5, v0
    v_lshlrev_b32 v2, 6, v2
    v_and_b32 v3, 24, v0
    v_add_u32 v2, v2, v3
    s_lshl_b32 s3, s2, 3
    v_add_u32 v3, s3, v1
    v_mul_u32_u24 v3, 1152, v3
    v_add_u32 v3, v3, v2
    v_lshlrev_b32 v5, 7, v1
    v_lshrrev_b32 v4, 6, v0
    v_lshl_add_u32 v4, v4, 2, v5
    v_lshlrev_b32 v6, 1, v2
    v_lshlrev_b32 v7, 4, v0
    s_mul_i32 s31, s2, 147456
    s_waitcnt lgkmcnt(0)
    s_add_u32 s16, s6, 10485760
    s_addc_u32 s17, s7, 0
    s_mov_b32 s18, 37748736
    s_mov_b32 s19, 0x20000
    buffer_load_dwordx4 v[64:67], v7, s[16:19], s31 offen
    s_add_u32 s31, s31, 9216
    buffer_load_dwordx4 v[68:71], v7, s[16:19], s31 offen
    s_add_u32 s31, s31, 9216
    buffer_load_dwordx4 v[72:75], v7, s[16:19], s31 offen
    s_add_u32 s31, s31, 9216
    buffer_load_dwordx4 v[76:79], v7, s[16:19], s31 offen
    s_add_u32 s31, s31, 9216
    buffer_load_dwordx4 v[80:83], v7, s[16:19], s31 offen
    s_add_u32 s31, s31, 9216
    buffer_load_dwordx4 v[84:87], v7, s[16:19], s31 offen
    s_add_u32 s31, s31, 9216
    buffer_load_dwordx4 v[88:91], v7, s[16:19], s31 offen
    s_add_u32 s31, s31, 9216
    buffer_load_dwordx4 v[92:95], v7, s[16:19], s31 offen
    s_add_u32 s31, s31, 9216
    buffer_load_dwordx4 v[96:99], v7, s[16:19], s31 offen
    s_add_u32 s31, s31, 9216
    buffer_load_dwordx4 v[100:103], v7, s[16:19], s31 offen
    s_add_u32 s31, s31, 9216
    buffer_load_dwordx4 v[104:107], v7, s[16:19], s31 offen
    s_add_u32 s31, s31, 9216
    buffer_load_dwordx4 v[108:111], v7, s[16:19], s31 offen
    s_add_u32 s31, s31, 9216
    buffer_load_dwordx4 v[112:115], v7, s[16:19], s31 offen
    s_add_u32 s31, s31, 9216
    buffer_load_dwordx4 v[116:119], v7, s[16:19], s31 offen
    s_add_u32 s31, s31, 9216
    buffer_load_dwordx4 v[120:123], v7, s[16:19], s31 offen
    s_add_u32 s31, s31, 9216
    buffer_load_dwordx4 v[124:127], v7, s[16:19], s31 offen
    s_mov_b32 s8, s4
    s_mov_b32 s9, s5
    s_mov_b32 s10, 2359296
    s_mov_b32 s11, 0x20000
    s_mov_b32 s12, s6
    s_mov_b32 s13, s7
    s_mov_b32 s14, 13824
    s_mov_b32 s15, 0x20000
    s_add_u32 s20, s6, 2621440
    s_addc_u32 s21, s7, 0
    s_mov_b32 s22, 2359296
    s_mov_b32 s23, 0x20000
    s_add_u32 s24, s6, 5242880
    s_addc_u32 s25, s7, 0
    s_mov_b32 s26, 2359296
    s_mov_b32 s27, 0x20000
    s_add_u32 s32, s6, 32768
    s_addc_u32 s33, s7, 0
    s_mov_b32 s34, 16384
    s_mov_b32 s35, 0x20000
    s_mov_b32 s38, 1152
    s_mov_b32 s39, 0x20000
    s_mov_b32 s42, 2359296
    s_mov_b32 s43, 0x20000
    buffer_load_dwordx2 v[8:9], v3, s[8:11], 0 offen
    buffer_load_dwordx2 v[10:11], v3, s[8:11], 0 offen offset:32
    s_mov_b32 s30, 4608
    buffer_load_dwordx4 v[24:27], v6, s[12:15], s30 offen
    buffer_load_dwordx4 v[28:31], v6, s[12:15], s30 offen offset:64
    s_mov_b32 s30, 6912
    buffer_load_dwordx4 v[32:35], v6, s[12:15], s30 offen
    buffer_load_dwordx4 v[36:39], v6, s[12:15], s30 offen offset:64
    s_mov_b32 s30, 9216
    buffer_load_dwordx4 v[40:43], v6, s[12:15], s30 offen
    buffer_load_dwordx4 v[44:47], v6, s[12:15], s30 offen offset:64
    s_mov_b32 s30, 11520
    buffer_load_dwordx4 v[48:51], v6, s[12:15], s30 offen
    buffer_load_dwordx4 v[52:55], v6, s[12:15], s30 offen offset:64
    buffer_load_dwordx2 v[12:13], v2, s[36:39], 0 offen
    buffer_load_dwordx2 v[14:15], v2, s[36:39], 0 offen offset:32
    s_waitcnt vmcnt(27)
    v_lshlrev_b32 v56, 16, v64
    v_and_b32 v57, 0xffff0000, v64
    v_lshlrev_b32 v58, 16, v65
    v_and_b32 v59, 0xffff0000, v65
    v_lshlrev_b32 v60, 16, v66
    v_and_b32 v61, 0xffff0000, v66
    v_lshlrev_b32 v62, 16, v67
    v_and_b32 v63, 0xffff0000, v67
    s_waitcnt vmcnt(26)
    v_lshlrev_b32 v16, 16, v68
    v_and_b32 v17, 0xffff0000, v68
    v_lshlrev_b32 v18, 16, v69
    v_and_b32 v19, 0xffff0000, v69
    v_lshlrev_b32 v20, 16, v70
    v_and_b32 v21, 0xffff0000, v70
    v_lshlrev_b32 v22, 16, v71
    v_and_b32 v23, 0xffff0000, v71
    v_pk_add_f32 v[56:57], v[56:57], v[16:17]
    v_pk_add_f32 v[58:59], v[58:59], v[18:19]
    v_pk_add_f32 v[60:61], v[60:61], v[20:21]
    v_pk_add_f32 v[62:63], v[62:63], v[22:23]
    s_waitcnt vmcnt(25)
    v_lshlrev_b32 v16, 16, v72
    v_and_b32 v17, 0xffff0000, v72
    v_lshlrev_b32 v18, 16, v73
    v_and_b32 v19, 0xffff0000, v73
    v_lshlrev_b32 v20, 16, v74
    v_and_b32 v21, 0xffff0000, v74
    v_lshlrev_b32 v22, 16, v75
    v_and_b32 v23, 0xffff0000, v75
    v_pk_add_f32 v[56:57], v[56:57], v[16:17]
    v_pk_add_f32 v[58:59], v[58:59], v[18:19]
    v_pk_add_f32 v[60:61], v[60:61], v[20:21]
    v_pk_add_f32 v[62:63], v[62:63], v[22:23]
    s_waitcnt vmcnt(24)
    v_lshlrev_b32 v16, 16, v76
    v_and_b32 v17, 0xffff0000, v76
    v_lshlrev_b32 v18, 16, v77
    v_and_b32 v19, 0xffff0000, v77
    v_lshlrev_b32 v20, 16, v78
    v_and_b32 v21, 0xffff0000, v78
    v_lshlrev_b32 v22, 16, v79
    v_and_b32 v23, 0xffff0000, v79
    v_pk_add_f32 v[56:57], v[56:57], v[16:17]
    v_pk_add_f32 v[58:59], v[58:59], v[18:19]
    v_pk_add_f32 v[60:61], v[60:61], v[20:21]
    v_pk_add_f32 v[62:63], v[62:63], v[22:23]
    s_waitcnt vmcnt(23)
    v_lshlrev_b32 v16, 16, v80
    v_and_b32 v17, 0xffff0000, v80
    v_lshlrev_b32 v18, 16, v81
    v_and_b32 v19, 0xffff0000, v81
    v_lshlrev_b32 v20, 16, v82
    v_and_b32 v21, 0xffff0000, v82
    v_lshlrev_b32 v22, 16, v83
    v_and_b32 v23, 0xffff0000, v83
    v_pk_add_f32 v[56:57], v[56:57], v[16:17]
    v_pk_add_f32 v[58:59], v[58:59], v[18:19]
    v_pk_add_f32 v[60:61], v[60:61], v[20:21]
    v_pk_add_f32 v[62:63], v[62:63], v[22:23]
    s_waitcnt vmcnt(22)
    v_lshlrev_b32 v16, 16, v84
    v_and_b32 v17, 0xffff0000, v84
    v_lshlrev_b32 v18, 16, v85
    v_and_b32 v19, 0xffff0000, v85
    v_lshlrev_b32 v20, 16, v86
    v_and_b32 v21, 0xffff0000, v86
    v_lshlrev_b32 v22, 16, v87
    v_and_b32 v23, 0xffff0000, v87
    v_pk_add_f32 v[56:57], v[56:57], v[16:17]
    v_pk_add_f32 v[58:59], v[58:59], v[18:19]
    v_pk_add_f32 v[60:61], v[60:61], v[20:21]
    v_pk_add_f32 v[62:63], v[62:63], v[22:23]
    s_waitcnt vmcnt(21)
    v_lshlrev_b32 v16, 16, v88
    v_and_b32 v17, 0xffff0000, v88
    v_lshlrev_b32 v18, 16, v89
    v_and_b32 v19, 0xffff0000, v89
    v_lshlrev_b32 v20, 16, v90
    v_and_b32 v21, 0xffff0000, v90
    v_lshlrev_b32 v22, 16, v91
    v_and_b32 v23, 0xffff0000, v91
    v_pk_add_f32 v[56:57], v[56:57], v[16:17]
    v_pk_add_f32 v[58:59], v[58:59], v[18:19]
    v_pk_add_f32 v[60:61], v[60:61], v[20:21]
    v_pk_add_f32 v[62:63], v[62:63], v[22:23]
    s_waitcnt vmcnt(20)
    v_lshlrev_b32 v16, 16, v92
    v_and_b32 v17, 0xffff0000, v92
    v_lshlrev_b32 v18, 16, v93
    v_and_b32 v19, 0xffff0000, v93
    v_lshlrev_b32 v20, 16, v94
    v_and_b32 v21, 0xffff0000, v94
    v_lshlrev_b32 v22, 16, v95
    v_and_b32 v23, 0xffff0000, v95
    v_pk_add_f32 v[56:57], v[56:57], v[16:17]
    v_pk_add_f32 v[58:59], v[58:59], v[18:19]
    v_pk_add_f32 v[60:61], v[60:61], v[20:21]
    v_pk_add_f32 v[62:63], v[62:63], v[22:23]
    s_waitcnt vmcnt(19)
    v_lshlrev_b32 v16, 16, v96
    v_and_b32 v17, 0xffff0000, v96
    v_lshlrev_b32 v18, 16, v97
    v_and_b32 v19, 0xffff0000, v97
    v_lshlrev_b32 v20, 16, v98
    v_and_b32 v21, 0xffff0000, v98
    v_lshlrev_b32 v22, 16, v99
    v_and_b32 v23, 0xffff0000, v99
    v_pk_add_f32 v[56:57], v[56:57], v[16:17]
    v_pk_add_f32 v[58:59], v[58:59], v[18:19]
    v_pk_add_f32 v[60:61], v[60:61], v[20:21]
    v_pk_add_f32 v[62:63], v[62:63], v[22:23]
    s_waitcnt vmcnt(18)
    v_lshlrev_b32 v16, 16, v100
    v_and_b32 v17, 0xffff0000, v100
    v_lshlrev_b32 v18, 16, v101
    v_and_b32 v19, 0xffff0000, v101
    v_lshlrev_b32 v20, 16, v102
    v_and_b32 v21, 0xffff0000, v102
    v_lshlrev_b32 v22, 16, v103
    v_and_b32 v23, 0xffff0000, v103
    v_pk_add_f32 v[56:57], v[56:57], v[16:17]
    v_pk_add_f32 v[58:59], v[58:59], v[18:19]
    v_pk_add_f32 v[60:61], v[60:61], v[20:21]
    v_pk_add_f32 v[62:63], v[62:63], v[22:23]
    s_waitcnt vmcnt(17)
    v_lshlrev_b32 v16, 16, v104
    v_and_b32 v17, 0xffff0000, v104
    v_lshlrev_b32 v18, 16, v105
    v_and_b32 v19, 0xffff0000, v105
    v_lshlrev_b32 v20, 16, v106
    v_and_b32 v21, 0xffff0000, v106
    v_lshlrev_b32 v22, 16, v107
    v_and_b32 v23, 0xffff0000, v107
    v_pk_add_f32 v[56:57], v[56:57], v[16:17]
    v_pk_add_f32 v[58:59], v[58:59], v[18:19]
    v_pk_add_f32 v[60:61], v[60:61], v[20:21]
    v_pk_add_f32 v[62:63], v[62:63], v[22:23]
    s_waitcnt vmcnt(16)
    v_lshlrev_b32 v16, 16, v108
    v_and_b32 v17, 0xffff0000, v108
    v_lshlrev_b32 v18, 16, v109
    v_and_b32 v19, 0xffff0000, v109
    v_lshlrev_b32 v20, 16, v110
    v_and_b32 v21, 0xffff0000, v110
    v_lshlrev_b32 v22, 16, v111
    v_and_b32 v23, 0xffff0000, v111
    v_pk_add_f32 v[56:57], v[56:57], v[16:17]
    v_pk_add_f32 v[58:59], v[58:59], v[18:19]
    v_pk_add_f32 v[60:61], v[60:61], v[20:21]
    v_pk_add_f32 v[62:63], v[62:63], v[22:23]
    s_waitcnt vmcnt(15)
    v_lshlrev_b32 v16, 16, v112
    v_and_b32 v17, 0xffff0000, v112
    v_lshlrev_b32 v18, 16, v113
    v_and_b32 v19, 0xffff0000, v113
    v_lshlrev_b32 v20, 16, v114
    v_and_b32 v21, 0xffff0000, v114
    v_lshlrev_b32 v22, 16, v115
    v_and_b32 v23, 0xffff0000, v115
    v_pk_add_f32 v[56:57], v[56:57], v[16:17]
    v_pk_add_f32 v[58:59], v[58:59], v[18:19]
    v_pk_add_f32 v[60:61], v[60:61], v[20:21]
    v_pk_add_f32 v[62:63], v[62:63], v[22:23]
    s_waitcnt vmcnt(14)
    v_lshlrev_b32 v16, 16, v116
    v_and_b32 v17, 0xffff0000, v116
    v_lshlrev_b32 v18, 16, v117
    v_and_b32 v19, 0xffff0000, v117
    v_lshlrev_b32 v20, 16, v118
    v_and_b32 v21, 0xffff0000, v118
    v_lshlrev_b32 v22, 16, v119
    v_and_b32 v23, 0xffff0000, v119
    v_pk_add_f32 v[56:57], v[56:57], v[16:17]
    v_pk_add_f32 v[58:59], v[58:59], v[18:19]
    v_pk_add_f32 v[60:61], v[60:61], v[20:21]
    v_pk_add_f32 v[62:63], v[62:63], v[22:23]
    s_waitcnt vmcnt(13)
    v_lshlrev_b32 v16, 16, v120
    v_and_b32 v17, 0xffff0000, v120
    v_lshlrev_b32 v18, 16, v121
    v_and_b32 v19, 0xffff0000, v121
    v_lshlrev_b32 v20, 16, v122
    v_and_b32 v21, 0xffff0000, v122
    v_lshlrev_b32 v22, 16, v123
    v_and_b32 v23, 0xffff0000, v123
    v_pk_add_f32 v[56:57], v[56:57], v[16:17]
    v_pk_add_f32 v[58:59], v[58:59], v[18:19]
    v_pk_add_f32 v[60:61], v[60:61], v[20:21]
    v_pk_add_f32 v[62:63], v[62:63], v[22:23]
    s_waitcnt vmcnt(12)
    v_lshlrev_b32 v16, 16, v124
    v_and_b32 v17, 0xffff0000, v124
    v_lshlrev_b32 v18, 16, v125
    v_and_b32 v19, 0xffff0000, v125
    v_lshlrev_b32 v20, 16, v126
    v_and_b32 v21, 0xffff0000, v126
    v_lshlrev_b32 v22, 16, v127
    v_and_b32 v23, 0xffff0000, v127
    v_pk_add_f32 v[56:57], v[56:57], v[16:17]
    v_pk_add_f32 v[58:59], v[58:59], v[18:19]
    v_pk_add_f32 v[60:61], v[60:61], v[20:21]
    v_pk_add_f32 v[62:63], v[62:63], v[22:23]
    v_cvt_pk_bf16_f32 v64, v56, v57
    v_lshlrev_b32 v56, 16, v64
    v_and_b32 v57, 0xffff0000, v64
    v_cvt_pk_bf16_f32 v64, v58, v59
    v_lshlrev_b32 v58, 16, v64
    v_and_b32 v59, 0xffff0000, v64
    v_cvt_pk_bf16_f32 v64, v60, v61
    v_lshlrev_b32 v60, 16, v64
    v_and_b32 v61, 0xffff0000, v64
    v_cvt_pk_bf16_f32 v64, v62, v63
    v_lshlrev_b32 v62, 16, v64
    v_and_b32 v63, 0xffff0000, v64
    s_waitcnt vmcnt(8)
    v_mul_f32 v56, v24, v56
    v_mul_f32 v57, v25, v57
    v_mul_f32 v58, v26, v58
    v_mul_f32 v59, v27, v59
    v_mul_f32 v60, v28, v60
    v_mul_f32 v61, v29, v61
    v_mul_f32 v62, v30, v62
    v_mul_f32 v63, v31, v63
    v_cvt_pk_bf16_f32 v64, v56, v57
    v_lshlrev_b32 v56, 16, v64
    v_and_b32 v57, 0xffff0000, v64
    v_cvt_pk_bf16_f32 v64, v58, v59
    v_lshlrev_b32 v58, 16, v64
    v_and_b32 v59, 0xffff0000, v64
    v_cvt_pk_bf16_f32 v64, v60, v61
    v_lshlrev_b32 v60, 16, v64
    v_and_b32 v61, 0xffff0000, v64
    v_cvt_pk_bf16_f32 v64, v62, v63
    v_lshlrev_b32 v62, 16, v64
    v_and_b32 v63, 0xffff0000, v64
    v_lshlrev_b32 v16, 16, v8
    v_and_b32 v17, 0xffff0000, v8
    v_lshlrev_b32 v18, 16, v9
    v_and_b32 v19, 0xffff0000, v9
    v_lshlrev_b32 v20, 16, v10
    v_and_b32 v21, 0xffff0000, v10
    v_lshlrev_b32 v22, 16, v11
    v_and_b32 v23, 0xffff0000, v11
    v_add_f32 v16, v16, v56
    v_add_f32 v17, v17, v57
    v_add_f32 v18, v18, v58
    v_add_f32 v19, v19, v59
    v_add_f32 v20, v20, v60
    v_add_f32 v21, v21, v61
    v_add_f32 v22, v22, v62
    v_add_f32 v23, v23, v63
    v_cvt_pk_bf16_f32 v8, v16, v17
    v_cvt_pk_bf16_f32 v9, v18, v19
    v_cvt_pk_bf16_f32 v10, v20, v21
    v_cvt_pk_bf16_f32 v11, v22, v23
    v_lshlrev_b32 v16, 16, v8
    v_and_b32 v17, 0xffff0000, v8
    v_lshlrev_b32 v18, 16, v9
    v_and_b32 v19, 0xffff0000, v9
    v_lshlrev_b32 v20, 16, v10
    v_and_b32 v21, 0xffff0000, v10
    v_lshlrev_b32 v22, 16, v11
    v_and_b32 v23, 0xffff0000, v11
    s_waitcnt vmcnt(0)
    buffer_store_dwordx2 v[8:9], v3, s[24:27], 0 offen
    buffer_store_dwordx2 v[10:11], v3, s[24:27], 0 offen offset:32
    v_add_f32 v64, v16, v17
    v_add_f32 v64, v64, v18
    v_add_f32 v64, v64, v19
    v_add_f32 v64, v64, v20
    v_add_f32 v64, v64, v21
    v_add_f32 v64, v64, v22
    v_add_f32 v64, v64, v23
    s_nop 1
    v_add_f32_dpp v64, v64, v64 row_ror:8 row_mask:0xf bank_mask:0xf
    v_mov_b32 v66, v64
    s_nop 1
    v_permlane16_swap_b32 v64, v66
    s_nop 1
    v_add_f32 v64, v64, v66
    v_mov_b32 v66, v64
    s_nop 1
    v_permlane32_swap_b32 v64, v66
    s_nop 1
    v_add_f32 v64, v64, v66
    v_mul_f32 v64, 0x3c800000, v64
    v_sub_f32 v88, v16, v64
    v_sub_f32 v89, v17, v64
    v_sub_f32 v90, v18, v64
    v_sub_f32 v91, v19, v64
    v_sub_f32 v92, v20, v64
    v_sub_f32 v93, v21, v64
    v_sub_f32 v94, v22, v64
    v_sub_f32 v95, v23, v64
    v_mul_f32 v65, v88, v88
    v_fmac_f32 v65, v89, v89
    v_fmac_f32 v65, v90, v90
    v_fmac_f32 v65, v91, v91
    v_fmac_f32 v65, v92, v92
    v_fmac_f32 v65, v93, v93
    v_fmac_f32 v65, v94, v94
    v_fmac_f32 v65, v95, v95
    s_nop 1
    v_add_f32_dpp v65, v65, v65 row_ror:8 row_mask:0xf bank_mask:0xf
    v_mov_b32 v66, v65
    s_nop 1
    v_permlane16_swap_b32 v65, v66
    s_nop 1
    v_add_f32 v65, v65, v66
    v_mov_b32 v66, v65
    s_nop 1
    v_permlane32_swap_b32 v65, v66
    s_nop 1
    v_add_f32 v65, v65, v66
    ds_write2_b32 v4, v64, v65 offset0:0 offset1:16
    s_waitcnt lgkmcnt(0)
    s_barrier
    ds_read_b128 v[68:71], v5
    ds_read_b128 v[72:75], v5 offset:16
    ds_read_b32 v76, v5 offset:32
    ds_read_b128 v[80:83], v5 offset:64
    ds_read_b128 v[84:87], v5 offset:80
    ds_read_b32 v88, v5 offset:96
    s_waitcnt lgkmcnt(3)
    v_add_f32 v64, v68, v69
    v_add_f32 v64, v64, v70
    v_add_f32 v64, v64, v71
    v_add_f32 v64, v64, v72
    v_add_f32 v64, v64, v73
    v_add_f32 v64, v64, v74
    v_add_f32 v64, v64, v75
    v_add_f32 v64, v64, v76
    v_mul_f32 v64, 0x3de38e39, v64
    v_sub_f32 v68, v68, v64
    v_sub_f32 v69, v69, v64
    v_sub_f32 v70, v70, v64
    v_sub_f32 v71, v71, v64
    v_sub_f32 v72, v72, v64
    v_sub_f32 v73, v73, v64
    v_sub_f32 v74, v74, v64
    v_sub_f32 v75, v75, v64
    v_sub_f32 v76, v76, v64
    v_mul_f32 v66, v68, v68
    v_fmac_f32 v66, v69, v69
    v_fmac_f32 v66, v70, v70
    v_fmac_f32 v66, v71, v71
    v_fmac_f32 v66, v72, v72
    v_fmac_f32 v66, v73, v73
    v_fmac_f32 v66, v74, v74
    v_fmac_f32 v66, v75, v75
    v_fmac_f32 v66, v76, v76
    s_waitcnt lgkmcnt(0)
    v_add_f32 v65, v80, v81
    v_add_f32 v65, v65, v82
    v_add_f32 v65, v65, v83
    v_add_f32 v65, v65, v84
    v_add_f32 v65, v65, v85
    v_add_f32 v65, v65, v86
    v_add_f32 v65, v65, v87
    v_add_f32 v65, v65, v88
    v_fmac_f32 v65, 0x42800000, v66
    v_mul_f32 v65, 0x3ae38e39, v65
    v_cvt_pk_bf16_f32 v66, v64, v65
    v_lshlrev_b32 v64, 16, v66
    v_and_b32 v65, 0xffff0000, v66
    v_add_f32 v65, 0x3727c5ac, v65
    v_cvt_pk_bf16_f32 v65, v65, v65
    v_and_b32 v65, 0xffff0000, v65
    v_sqrt_f32 v65, v65
    s_nop 0
    v_cvt_pk_bf16_f32 v65, v65, v65
    v_and_b32 v65, 0xffff0000, v65
    v_rcp_f32 v65, v65
    v_sub_f32 v88, v16, v64
    v_sub_f32 v89, v17, v64
    v_sub_f32 v90, v18, v64
    v_sub_f32 v91, v19, v64
    v_sub_f32 v92, v20, v64
    v_sub_f32 v93, v21, v64
    v_sub_f32 v94, v22, v64
    v_sub_f32 v95, v23, v64
    v_cvt_pk_bf16_f32 v66, v88, v89
    v_lshlrev_b32 v88, 16, v66
    v_and_b32 v89, 0xffff0000, v66
    v_cvt_pk_bf16_f32 v66, v90, v91
    v_lshlrev_b32 v90, 16, v66
    v_and_b32 v91, 0xffff0000, v66
    v_cvt_pk_bf16_f32 v66, v92, v93
    v_lshlrev_b32 v92, 16, v66
    v_and_b32 v93, 0xffff0000, v66
    v_cvt_pk_bf16_f32 v66, v94, v95
    v_lshlrev_b32 v94, 16, v66
    v_and_b32 v95, 0xffff0000, v66
    v_mul_f32 v88, v88, v65
    v_mul_f32 v89, v89, v65
    v_mul_f32 v90, v90, v65
    v_mul_f32 v91, v91, v65
    v_mul_f32 v92, v92, v65
    v_mul_f32 v93, v93, v65
    v_mul_f32 v94, v94, v65
    v_mul_f32 v95, v95, v65
    v_cvt_pk_bf16_f32 v66, v88, v89
    v_lshlrev_b32 v88, 16, v66
    v_and_b32 v89, 0xffff0000, v66
    v_cvt_pk_bf16_f32 v66, v90, v91
    v_lshlrev_b32 v90, 16, v66
    v_and_b32 v91, 0xffff0000, v66
    v_cvt_pk_bf16_f32 v66, v92, v93
    v_lshlrev_b32 v92, 16, v66
    v_and_b32 v93, 0xffff0000, v66
    v_cvt_pk_bf16_f32 v66, v94, v95
    v_lshlrev_b32 v94, 16, v66
    v_and_b32 v95, 0xffff0000, v66
    v_add_f32 v40, 1.0, v40
    v_add_f32 v41, 1.0, v41
    v_add_f32 v42, 1.0, v42
    v_add_f32 v43, 1.0, v43
    v_add_f32 v44, 1.0, v44
    v_add_f32 v45, 1.0, v45
    v_add_f32 v46, 1.0, v46
    v_add_f32 v47, 1.0, v47
    v_cvt_pk_bf16_f32 v66, v40, v41
    v_lshlrev_b32 v40, 16, v66
    v_and_b32 v41, 0xffff0000, v66
    v_cvt_pk_bf16_f32 v66, v42, v43
    v_lshlrev_b32 v42, 16, v66
    v_and_b32 v43, 0xffff0000, v66
    v_cvt_pk_bf16_f32 v66, v44, v45
    v_lshlrev_b32 v44, 16, v66
    v_and_b32 v45, 0xffff0000, v66
    v_cvt_pk_bf16_f32 v66, v46, v47
    v_lshlrev_b32 v46, 16, v66
    v_and_b32 v47, 0xffff0000, v66
    v_mul_f32 v88, v88, v40
    v_mul_f32 v89, v89, v41
    v_mul_f32 v90, v90, v42
    v_mul_f32 v91, v91, v43
    v_mul_f32 v92, v92, v44
    v_mul_f32 v93, v93, v45
    v_mul_f32 v94, v94, v46
    v_mul_f32 v95, v95, v47
    v_cvt_pk_bf16_f32 v66, v88, v89
    v_lshlrev_b32 v88, 16, v66
    v_and_b32 v89, 0xffff0000, v66
    v_cvt_pk_bf16_f32 v66, v90, v91
    v_lshlrev_b32 v90, 16, v66
    v_and_b32 v91, 0xffff0000, v66
    v_cvt_pk_bf16_f32 v66, v92, v93
    v_lshlrev_b32 v92, 16, v66
    v_and_b32 v93, 0xffff0000, v66
    v_cvt_pk_bf16_f32 v66, v94, v95
    v_lshlrev_b32 v94, 16, v66
    v_and_b32 v95, 0xffff0000, v66
    v_add_f32 v88, v88, v32
    v_add_f32 v89, v89, v33
    v_add_f32 v90, v90, v34
    v_add_f32 v91, v91, v35
    v_add_f32 v92, v92, v36
    v_add_f32 v93, v93, v37
    v_add_f32 v94, v94, v38
    v_add_f32 v95, v95, v39
    v_cvt_pk_bf16_f32 v100, v88, v89
    v_cvt_pk_bf16_f32 v101, v90, v91
    v_cvt_pk_bf16_f32 v102, v92, v93
    v_cvt_pk_bf16_f32 v103, v94, v95
    v_lshlrev_b32 v88, 16, v100
    v_and_b32 v89, 0xffff0000, v100
    v_lshlrev_b32 v90, 16, v101
    v_and_b32 v91, 0xffff0000, v101
    v_lshlrev_b32 v92, 16, v102
    v_and_b32 v93, 0xffff0000, v102
    v_lshlrev_b32 v94, 16, v103
    v_and_b32 v95, 0xffff0000, v103
    buffer_store_dwordx2 v[100:101], v3, s[20:23], 0 offen
    buffer_store_dwordx2 v[102:103], v3, s[20:23], 0 offen offset:32
    v_lshlrev_b32 v24, 16, v12
    v_and_b32 v25, 0xffff0000, v12
    v_lshlrev_b32 v26, 16, v13
    v_and_b32 v27, 0xffff0000, v13
    v_lshlrev_b32 v28, 16, v14
    v_and_b32 v29, 0xffff0000, v14
    v_lshlrev_b32 v30, 16, v15
    v_and_b32 v31, 0xffff0000, v15
    v_mul_f32 v64, v24, v88
    v_fmac_f32 v64, v25, v89
    v_fmac_f32 v64, v26, v90
    v_fmac_f32 v64, v27, v91
    v_fmac_f32 v64, v28, v92
    v_fmac_f32 v64, v29, v93
    v_fmac_f32 v64, v30, v94
    v_fmac_f32 v64, v31, v95
    s_nop 1
    v_add_f32_dpp v64, v64, v64 row_ror:8 row_mask:0xf bank_mask:0xf
    v_mov_b32 v65, v64
    s_nop 1
    v_permlane16_swap_b32 v64, v65
    s_nop 1
    v_add_f32 v64, v64, v65
    v_mov_b32 v65, v64
    s_nop 1
    v_permlane32_swap_b32 v64, v65
    s_nop 1
    v_add_f32 v64, v64, v65
    ds_write_b32 v4, v64 offset:1024
    v_mul_f32 v48, v48, v88
    v_mul_f32 v49, v49, v89
    v_mul_f32 v50, v50, v90
    v_mul_f32 v51, v51, v91
    v_mul_f32 v52, v52, v92
    v_mul_f32 v53, v53, v93
    v_mul_f32 v54, v54, v94
    v_mul_f32 v55, v55, v95
    v_cvt_pk_bf16_f32 v65, v48, v49
    v_lshlrev_b32 v48, 16, v65
    v_and_b32 v49, 0xffff0000, v65
    v_cvt_pk_bf16_f32 v65, v50, v51
    v_lshlrev_b32 v50, 16, v65
    v_and_b32 v51, 0xffff0000, v65
    v_cvt_pk_bf16_f32 v65, v52, v53
    v_lshlrev_b32 v52, 16, v65
    v_and_b32 v53, 0xffff0000, v65
    v_cvt_pk_bf16_f32 v65, v54, v55
    v_lshlrev_b32 v54, 16, v65
    v_and_b32 v55, 0xffff0000, v65
    v_add_f32 v48, v16, v48
    v_add_f32 v49, v17, v49
    v_add_f32 v50, v18, v50
    v_add_f32 v51, v19, v51
    v_add_f32 v52, v20, v52
    v_add_f32 v53, v21, v53
    v_add_f32 v54, v22, v54
    v_add_f32 v55, v23, v55
    v_cvt_pk_bf16_f32 v104, v48, v49
    v_cvt_pk_bf16_f32 v105, v50, v51
    v_cvt_pk_bf16_f32 v106, v52, v53
    v_cvt_pk_bf16_f32 v107, v54, v55
    buffer_store_dwordx2 v[104:105], v3, s[40:43], 0 offen
    buffer_store_dwordx2 v[106:107], v3, s[40:43], 0 offen offset:32
    s_waitcnt lgkmcnt(0)
    s_barrier
    v_cmp_gt_u32 vcc, 8, v0
    s_and_saveexec_b64 s[44:45], vcc
    s_cbranch_execz Lpost_end
    ds_read_b128 v[68:71], v5 offset:1024
    ds_read_b128 v[72:75], v5 offset:1040
    ds_read_b32 v76, v5 offset:1056
    v_add_u32 v66, s3, v1
    v_lshlrev_b32 v67, 2, v66
    s_waitcnt lgkmcnt(0)
    v_add_f32 v64, v68, v69
    v_add_f32 v64, v64, v70
    v_add_f32 v64, v64, v71
    v_add_f32 v64, v64, v72
    v_add_f32 v64, v64, v73
    v_add_f32 v64, v64, v74
    v_add_f32 v64, v64, v75
    v_add_f32 v64, v64, v76
    v_ashrrev_i32 v65, 31, v64
    v_or_b32 v65, 0x80000000, v65
    v_xor_b32 v65, v65, v64
    v_and_b32 v65, 0xfffff800, v65
    v_sub_u32 v66, 2047, v66
    v_or_b32 v65, v65, v66
    buffer_store_dword v65, v67, s[32:35], 0 offen
    s_movk_i32 s30, 0x2000
    buffer_store_dword v64, v67, s[32:35], s30 offen
Lpost_end:
    s_endpgm
.globl ffn_kernel
.p2align 8
.type ffn_kernel,@function
ffn_kernel:
    s_cmp_ge_u32 s2, 144
    s_cbranch_scc1 Lffn_end
    s_load_dwordx4 s[4:7], s[0:1], 56
    s_load_dwordx2 s[16:17], s[0:1], 72
    s_load_dwordx2 s[28:29], s[0:1], 112
    v_and_b32 v1, 3, v0
    v_lshrrev_b32 v2, 2, v0
    v_mul_u32_u24 v3, 9216, v2
    v_lshl_add_u32 v3, v1, 4, v3
    s_lshl_b32 s3, s2, 6
    v_add_u32 v3, s3, v3
    v_mul_u32_u24 v4, 911, v0
    v_lshrrev_b32 v4, 16, v4
    v_mul_u32_u24 v5, 72, v4
    v_sub_u32 v5, v0, v5
    v_mul_u32_u24 v6, 4608, v4
    v_lshl_add_u32 v6, v5, 4, v6
    v_and_b32 v7, 63, v0
    s_waitcnt lgkmcnt(0)
    s_add_u32 s32, s28, 32768
    s_addc_u32 s33, s29, 0
    s_mov_b32 s34, 16384
    s_mov_b32 s35, 0x20000
    v_lshlrev_b32 v96, 4, v7
    s_movk_i32 s30, 0x1000
    buffer_load_dwordx4 v[64:67], v96, s[32:35], 0 offen offset:0
    buffer_load_dwordx4 v[68:71], v96, s[32:35], 0 offen offset:1024
    buffer_load_dwordx4 v[72:75], v96, s[32:35], 0 offen offset:2048
    buffer_load_dwordx4 v[76:79], v96, s[32:35], 0 offen offset:3072
    buffer_load_dwordx4 v[80:83], v96, s[32:35], s30 offen offset:0
    buffer_load_dwordx4 v[84:87], v96, s[32:35], s30 offen offset:1024
    buffer_load_dwordx4 v[88:91], v96, s[32:35], s30 offen offset:2048
    buffer_load_dwordx4 v[92:95], v96, s[32:35], s30 offen offset:3072
    s_mov_b32 s8, s4
    s_mov_b32 s9, s5
    s_mov_b32 s10, 5308416
    s_mov_b32 s11, 0x20000
    s_mov_b32 s12, s6
    s_mov_b32 s13, s7
    s_mov_b32 s14, 5308416
    s_mov_b32 s15, 0x20000
    s_mov_b32 s18, 5308416
    s_mov_b32 s19, 0x20000
    s_add_u32 s20, s28, 2621440
    s_addc_u32 s21, s29, 0
    s_mov_b32 s22, 2359296
    s_mov_b32 s23, 0x20000
    s_add_u32 s24, s28, 7864320
    s_addc_u32 s25, s29, 0
    s_mov_b32 s26, 663616
    s_mov_b32 s27, 0x20000
    s_mov_b32 s30, 0
    buffer_load_dwordx4 v[16:19], v3, s[8:11], s30 offen
    buffer_load_dwordx4 v[32:35], v3, s[12:15], s30 offen
    s_mov_b32 s30, 1327104
    buffer_load_dwordx4 v[20:23], v3, s[8:11], s30 offen
    buffer_load_dwordx4 v[36:39], v3, s[12:15], s30 offen
    s_mov_b32 s30, 2654208
    buffer_load_dwordx4 v[24:27], v3, s[8:11], s30 offen
    buffer_load_dwordx4 v[40:43], v3, s[12:15], s30 offen
    s_mov_b32 s30, 3981312
    buffer_load_dwordx4 v[28:31], v3, s[8:11], s30 offen
    buffer_load_dwordx4 v[44:47], v3, s[12:15], s30 offen
    s_mul_i32 s30, s2, 36864
    buffer_load_dwordx4 v[48:51], v6, s[16:19], s30 offen offset:0
    buffer_load_dwordx4 v[52:55], v6, s[16:19], s30 offen offset:1152
    buffer_load_dwordx4 v[56:59], v6, s[16:19], s30 offen offset:2304
    buffer_load_dwordx4 v[60:63], v6, s[16:19], s30 offen offset:3456
    s_waitcnt vmcnt(12)
    v_max_u32 v96, v64, v65
    v_min_u32 v97, v64, v65
    v_med3_u32 v97, v96, v97, v66
    v_max_u32 v96, v96, v66
    v_med3_u32 v97, v96, v97, v67
    v_max_u32 v96, v96, v67
    v_med3_u32 v97, v96, v97, v68
    v_max_u32 v96, v96, v68
    v_med3_u32 v97, v96, v97, v69
    v_max_u32 v96, v96, v69
    v_med3_u32 v97, v96, v97, v70
    v_max_u32 v96, v96, v70
    v_med3_u32 v97, v96, v97, v71
    v_max_u32 v96, v96, v71
    v_med3_u32 v97, v96, v97, v72
    v_max_u32 v96, v96, v72
    v_med3_u32 v97, v96, v97, v73
    v_max_u32 v96, v96, v73
    v_med3_u32 v97, v96, v97, v74
    v_max_u32 v96, v96, v74
    v_med3_u32 v97, v96, v97, v75
    v_max_u32 v96, v96, v75
    v_med3_u32 v97, v96, v97, v76
    v_max_u32 v96, v96, v76
    v_med3_u32 v97, v96, v97, v77
    v_max_u32 v96, v96, v77
    v_med3_u32 v97, v96, v97, v78
    v_max_u32 v96, v96, v78
    v_med3_u32 v97, v96, v97, v79
    v_max_u32 v96, v96, v79
    v_med3_u32 v97, v96, v97, v80
    v_max_u32 v96, v96, v80
    v_med3_u32 v97, v96, v97, v81
    v_max_u32 v96, v96, v81
    v_med3_u32 v97, v96, v97, v82
    v_max_u32 v96, v96, v82
    v_med3_u32 v97, v96, v97, v83
    v_max_u32 v96, v96, v83
    v_med3_u32 v97, v96, v97, v84
    v_max_u32 v96, v96, v84
    v_med3_u32 v97, v96, v97, v85
    v_max_u32 v96, v96, v85
    v_med3_u32 v97, v96, v97, v86
    v_max_u32 v96, v96, v86
    v_med3_u32 v97, v96, v97, v87
    v_max_u32 v96, v96, v87
    v_med3_u32 v97, v96, v97, v88
    v_max_u32 v96, v96, v88
    v_med3_u32 v97, v96, v97, v89
    v_max_u32 v96, v96, v89
    v_med3_u32 v97, v96, v97, v90
    v_max_u32 v96, v96, v90
    v_med3_u32 v97, v96, v97, v91
    v_max_u32 v96, v96, v91
    v_med3_u32 v97, v96, v97, v92
    v_max_u32 v96, v96, v92
    v_med3_u32 v97, v96, v97, v93
    v_max_u32 v96, v96, v93
    v_med3_u32 v97, v96, v97, v94
    v_max_u32 v96, v96, v94
    v_med3_u32 v97, v96, v97, v95
    v_max_u32 v96, v96, v95
    s_nop 1
    v_mov_b32_dpp v98, v96 row_ror:1 row_mask:0xf bank_mask:0xf
    v_mov_b32_dpp v99, v97 row_ror:1 row_mask:0xf bank_mask:0xf
    v_min_u32 v64, v96, v98
    v_max_u32 v96, v96, v98
    v_max3_u32 v97, v64, v97, v99
    s_nop 1
    v_mov_b32_dpp v98, v96 row_ror:2 row_mask:0xf bank_mask:0xf
    v_mov_b32_dpp v99, v97 row_ror:2 row_mask:0xf bank_mask:0xf
    v_min_u32 v64, v96, v98
    v_max_u32 v96, v96, v98
    v_max3_u32 v97, v64, v97, v99
    s_nop 1
    v_mov_b32_dpp v98, v96 row_ror:4 row_mask:0xf bank_mask:0xf
    v_mov_b32_dpp v99, v97 row_ror:4 row_mask:0xf bank_mask:0xf
    v_min_u32 v64, v96, v98
    v_max_u32 v96, v96, v98
    v_max3_u32 v97, v64, v97, v99
    s_nop 1
    v_mov_b32_dpp v98, v96 row_ror:8 row_mask:0xf bank_mask:0xf
    v_mov_b32_dpp v99, v97 row_ror:8 row_mask:0xf bank_mask:0xf
    v_min_u32 v64, v96, v98
    v_max_u32 v96, v96, v98
    v_max3_u32 v97, v64, v97, v99
    v_mov_b32 v98, v96
    v_mov_b32 v99, v97
    s_nop 1
    v_permlane16_swap_b32 v96, v98
    v_permlane16_swap_b32 v97, v99
    s_nop 1
    v_min_u32 v64, v96, v98
    v_max_u32 v96, v96, v98
    v_max3_u32 v97, v64, v97, v99
    v_mov_b32 v98, v96
    v_mov_b32 v99, v97
    s_nop 1
    v_permlane32_swap_b32 v96, v98
    v_permlane32_swap_b32 v97, v99
    s_nop 1
    v_min_u32 v64, v96, v98
    v_max_u32 v96, v96, v98
    v_max3_u32 v97, v64, v97, v99
    s_nop 0
    v_readfirstlane_b32 s46, v96
    v_readfirstlane_b32 s47, v97
    s_nop 3
    s_and_b32 s46, s46, 0x7ff
    s_and_b32 s47, s47, 0x7ff
    s_sub_u32 s46, 2047, s46
    s_sub_u32 s47, 2047, s47
    s_mul_i32 s48, s46, 1152
    s_mul_i32 s49, s47, 1152
    v_lshlrev_b32 v2, 1, v2
    buffer_load_ushort v8, v2, s[20:23], s48 offen offset:0
    buffer_load_ushort v9, v2, s[20:23], s48 offen offset:288
    buffer_load_ushort v10, v2, s[20:23], s48 offen offset:576
    buffer_load_ushort v11, v2, s[20:23], s48 offen offset:864
    buffer_load_ushort v12, v2, s[20:23], s49 offen offset:0
    buffer_load_ushort v13, v2, s[20:23], s49 offen offset:288
    buffer_load_ushort v14, v2, s[20:23], s49 offen offset:576
    buffer_load_ushort v15, v2, s[20:23], s49 offen offset:864
    s_waitcnt vmcnt(0)
    v_lshlrev_b32 v8, 16, v8
    v_lshlrev_b32 v9, 16, v9
    v_lshlrev_b32 v10, 16, v10
    v_lshlrev_b32 v11, 16, v11
    v_lshlrev_b32 v12, 16, v12
    v_lshlrev_b32 v13, 16, v13
    v_lshlrev_b32 v14, 16, v14
    v_lshlrev_b32 v15, 16, v15
    v_lshlrev_b32 v96, 16, v16
    v_and_b32 v97, 0xffff0000, v16
    v_lshlrev_b32 v98, 16, v17
    v_and_b32 v99, 0xffff0000, v17
    v_lshlrev_b32 v100, 16, v18
    v_and_b32 v101, 0xffff0000, v18
    v_lshlrev_b32 v102, 16, v19
    v_and_b32 v103, 0xffff0000, v19
    v_mul_f32 v64, v8, v96
    v_mul_f32 v65, v8, v97
    v_mul_f32 v66, v8, v98
    v_mul_f32 v67, v8, v99
    v_mul_f32 v68, v8, v100
    v_mul_f32 v69, v8, v101
    v_mul_f32 v70, v8, v102
    v_mul_f32 v71, v8, v103
    v_mul_f32 v72, v12, v96
    v_mul_f32 v73, v12, v97
    v_mul_f32 v74, v12, v98
    v_mul_f32 v75, v12, v99
    v_mul_f32 v76, v12, v100
    v_mul_f32 v77, v12, v101
    v_mul_f32 v78, v12, v102
    v_mul_f32 v79, v12, v103
    v_lshlrev_b32 v96, 16, v20
    v_and_b32 v97, 0xffff0000, v20
    v_lshlrev_b32 v98, 16, v21
    v_and_b32 v99, 0xffff0000, v21
    v_lshlrev_b32 v100, 16, v22
    v_and_b32 v101, 0xffff0000, v22
    v_lshlrev_b32 v102, 16, v23
    v_and_b32 v103, 0xffff0000, v23
    v_fmac_f32 v64, v9, v96
    v_fmac_f32 v65, v9, v97
    v_fmac_f32 v66, v9, v98
    v_fmac_f32 v67, v9, v99
    v_fmac_f32 v68, v9, v100
    v_fmac_f32 v69, v9, v101
    v_fmac_f32 v70, v9, v102
    v_fmac_f32 v71, v9, v103
    v_fmac_f32 v72, v13, v96
    v_fmac_f32 v73, v13, v97
    v_fmac_f32 v74, v13, v98
    v_fmac_f32 v75, v13, v99
    v_fmac_f32 v76, v13, v100
    v_fmac_f32 v77, v13, v101
    v_fmac_f32 v78, v13, v102
    v_fmac_f32 v79, v13, v103
    v_lshlrev_b32 v96, 16, v24
    v_and_b32 v97, 0xffff0000, v24
    v_lshlrev_b32 v98, 16, v25
    v_and_b32 v99, 0xffff0000, v25
    v_lshlrev_b32 v100, 16, v26
    v_and_b32 v101, 0xffff0000, v26
    v_lshlrev_b32 v102, 16, v27
    v_and_b32 v103, 0xffff0000, v27
    v_fmac_f32 v64, v10, v96
    v_fmac_f32 v65, v10, v97
    v_fmac_f32 v66, v10, v98
    v_fmac_f32 v67, v10, v99
    v_fmac_f32 v68, v10, v100
    v_fmac_f32 v69, v10, v101
    v_fmac_f32 v70, v10, v102
    v_fmac_f32 v71, v10, v103
    v_fmac_f32 v72, v14, v96
    v_fmac_f32 v73, v14, v97
    v_fmac_f32 v74, v14, v98
    v_fmac_f32 v75, v14, v99
    v_fmac_f32 v76, v14, v100
    v_fmac_f32 v77, v14, v101
    v_fmac_f32 v78, v14, v102
    v_fmac_f32 v79, v14, v103
    v_lshlrev_b32 v96, 16, v28
    v_and_b32 v97, 0xffff0000, v28
    v_lshlrev_b32 v98, 16, v29
    v_and_b32 v99, 0xffff0000, v29
    v_lshlrev_b32 v100, 16, v30
    v_and_b32 v101, 0xffff0000, v30
    v_lshlrev_b32 v102, 16, v31
    v_and_b32 v103, 0xffff0000, v31
    v_fmac_f32 v64, v11, v96
    v_fmac_f32 v65, v11, v97
    v_fmac_f32 v66, v11, v98
    v_fmac_f32 v67, v11, v99
    v_fmac_f32 v68, v11, v100
    v_fmac_f32 v69, v11, v101
    v_fmac_f32 v70, v11, v102
    v_fmac_f32 v71, v11, v103
    v_fmac_f32 v72, v15, v96
    v_fmac_f32 v73, v15, v97
    v_fmac_f32 v74, v15, v98
    v_fmac_f32 v75, v15, v99
    v_fmac_f32 v76, v15, v100
    v_fmac_f32 v77, v15, v101
    v_fmac_f32 v78, v15, v102
    v_fmac_f32 v79, v15, v103
    v_lshlrev_b32 v96, 16, v32
    v_and_b32 v97, 0xffff0000, v32
    v_lshlrev_b32 v98, 16, v33
    v_and_b32 v99, 0xffff0000, v33
    v_lshlrev_b32 v100, 16, v34
    v_and_b32 v101, 0xffff0000, v34
    v_lshlrev_b32 v102, 16, v35
    v_and_b32 v103, 0xffff0000, v35
    v_mul_f32 v80, v8, v96
    v_mul_f32 v81, v8, v97
    v_mul_f32 v82, v8, v98
    v_mul_f32 v83, v8, v99
    v_mul_f32 v84, v8, v100
    v_mul_f32 v85, v8, v101
    v_mul_f32 v86, v8, v102
    v_mul_f32 v87, v8, v103
    v_mul_f32 v88, v12, v96
    v_mul_f32 v89, v12, v97
    v_mul_f32 v90, v12, v98
    v_mul_f32 v91, v12, v99
    v_mul_f32 v92, v12, v100
    v_mul_f32 v93, v12, v101
    v_mul_f32 v94, v12, v102
    v_mul_f32 v95, v12, v103
    v_lshlrev_b32 v96, 16, v36
    v_and_b32 v97, 0xffff0000, v36
    v_lshlrev_b32 v98, 16, v37
    v_and_b32 v99, 0xffff0000, v37
    v_lshlrev_b32 v100, 16, v38
    v_and_b32 v101, 0xffff0000, v38
    v_lshlrev_b32 v102, 16, v39
    v_and_b32 v103, 0xffff0000, v39
    v_fmac_f32 v80, v9, v96
    v_fmac_f32 v81, v9, v97
    v_fmac_f32 v82, v9, v98
    v_fmac_f32 v83, v9, v99
    v_fmac_f32 v84, v9, v100
    v_fmac_f32 v85, v9, v101
    v_fmac_f32 v86, v9, v102
    v_fmac_f32 v87, v9, v103
    v_fmac_f32 v88, v13, v96
    v_fmac_f32 v89, v13, v97
    v_fmac_f32 v90, v13, v98
    v_fmac_f32 v91, v13, v99
    v_fmac_f32 v92, v13, v100
    v_fmac_f32 v93, v13, v101
    v_fmac_f32 v94, v13, v102
    v_fmac_f32 v95, v13, v103
    v_lshlrev_b32 v96, 16, v40
    v_and_b32 v97, 0xffff0000, v40
    v_lshlrev_b32 v98, 16, v41
    v_and_b32 v99, 0xffff0000, v41
    v_lshlrev_b32 v100, 16, v42
    v_and_b32 v101, 0xffff0000, v42
    v_lshlrev_b32 v102, 16, v43
    v_and_b32 v103, 0xffff0000, v43
    v_fmac_f32 v80, v10, v96
    v_fmac_f32 v81, v10, v97
    v_fmac_f32 v82, v10, v98
    v_fmac_f32 v83, v10, v99
    v_fmac_f32 v84, v10, v100
    v_fmac_f32 v85, v10, v101
    v_fmac_f32 v86, v10, v102
    v_fmac_f32 v87, v10, v103
    v_fmac_f32 v88, v14, v96
    v_fmac_f32 v89, v14, v97
    v_fmac_f32 v90, v14, v98
    v_fmac_f32 v91, v14, v99
    v_fmac_f32 v92, v14, v100
    v_fmac_f32 v93, v14, v101
    v_fmac_f32 v94, v14, v102
    v_fmac_f32 v95, v14, v103
    v_lshlrev_b32 v96, 16, v44
    v_and_b32 v97, 0xffff0000, v44
    v_lshlrev_b32 v98, 16, v45
    v_and_b32 v99, 0xffff0000, v45
    v_lshlrev_b32 v100, 16, v46
    v_and_b32 v101, 0xffff0000, v46
    v_lshlrev_b32 v102, 16, v47
    v_and_b32 v103, 0xffff0000, v47
    v_fmac_f32 v80, v11, v96
    v_fmac_f32 v81, v11, v97
    v_fmac_f32 v82, v11, v98
    v_fmac_f32 v83, v11, v99
    v_fmac_f32 v84, v11, v100
    v_fmac_f32 v85, v11, v101
    v_fmac_f32 v86, v11, v102
    v_fmac_f32 v87, v11, v103
    v_fmac_f32 v88, v15, v96
    v_fmac_f32 v89, v15, v97
    v_fmac_f32 v90, v15, v98
    v_fmac_f32 v91, v15, v99
    v_fmac_f32 v92, v15, v100
    v_fmac_f32 v93, v15, v101
    v_fmac_f32 v94, v15, v102
    v_fmac_f32 v95, v15, v103
    s_nop 1
    v_permlane32_swap_b32 v64, v80
    v_permlane32_swap_b32 v65, v81
    v_permlane32_swap_b32 v66, v82
    v_permlane32_swap_b32 v67, v83
    v_permlane32_swap_b32 v68, v84
    v_permlane32_swap_b32 v69, v85
    v_permlane32_swap_b32 v70, v86
    v_permlane32_swap_b32 v71, v87
    v_permlane32_swap_b32 v72, v88
    v_permlane32_swap_b32 v73, v89
    v_permlane32_swap_b32 v74, v90
    v_permlane32_swap_b32 v75, v91
    v_permlane32_swap_b32 v76, v92
    v_permlane32_swap_b32 v77, v93
    v_permlane32_swap_b32 v78, v94
    v_permlane32_swap_b32 v79, v95
    s_nop 1
    v_add_f32 v64, v64, v80
    v_add_f32 v65, v65, v81
    v_add_f32 v66, v66, v82
    v_add_f32 v67, v67, v83
    v_add_f32 v68, v68, v84
    v_add_f32 v69, v69, v85
    v_add_f32 v70, v70, v86
    v_add_f32 v71, v71, v87
    v_add_f32 v72, v72, v88
    v_add_f32 v73, v73, v89
    v_add_f32 v74, v74, v90
    v_add_f32 v75, v75, v91
    v_add_f32 v76, v76, v92
    v_add_f32 v77, v77, v93
    v_add_f32 v78, v78, v94
    v_add_f32 v79, v79, v95
    s_nop 1
    v_permlane16_swap_b32 v64, v72
    v_permlane16_swap_b32 v65, v73
    v_permlane16_swap_b32 v66, v74
    v_permlane16_swap_b32 v67, v75
    v_permlane16_swap_b32 v68, v76
    v_permlane16_swap_b32 v69, v77
    v_permlane16_swap_b32 v70, v78
    v_permlane16_swap_b32 v71, v79
    s_nop 1
    v_add_f32 v64, v64, v72
    v_add_f32 v65, v65, v73
    v_add_f32 v66, v66, v74
    v_add_f32 v67, v67, v75
    v_add_f32 v68, v68, v76
    v_add_f32 v69, v69, v77
    v_add_f32 v70, v70, v78
    v_add_f32 v71, v71, v79
    s_nop 1
    v_add_f32_dpp v64, v64, v64 row_ror:4 row_mask:0xf bank_mask:0xf
    v_add_f32_dpp v65, v65, v65 row_ror:4 row_mask:0xf bank_mask:0xf
    v_add_f32_dpp v66, v66, v66 row_ror:4 row_mask:0xf bank_mask:0xf
    v_add_f32_dpp v67, v67, v67 row_ror:4 row_mask:0xf bank_mask:0xf
    v_add_f32_dpp v68, v68, v68 row_ror:4 row_mask:0xf bank_mask:0xf
    v_add_f32_dpp v69, v69, v69 row_ror:4 row_mask:0xf bank_mask:0xf
    v_add_f32_dpp v70, v70, v70 row_ror:4 row_mask:0xf bank_mask:0xf
    v_add_f32_dpp v71, v71, v71 row_ror:4 row_mask:0xf bank_mask:0xf
    s_nop 1
    v_add_f32_dpp v64, v64, v64 row_ror:8 row_mask:0xf bank_mask:0xf
    v_add_f32_dpp v65, v65, v65 row_ror:8 row_mask:0xf bank_mask:0xf
    v_add_f32_dpp v66, v66, v66 row_ror:8 row_mask:0xf bank_mask:0xf
    v_add_f32_dpp v67, v67, v67 row_ror:8 row_mask:0xf bank_mask:0xf
    v_add_f32_dpp v68, v68, v68 row_ror:8 row_mask:0xf bank_mask:0xf
    v_add_f32_dpp v69, v69, v69 row_ror:8 row_mask:0xf bank_mask:0xf
    v_add_f32_dpp v70, v70, v70 row_ror:8 row_mask:0xf bank_mask:0xf
    v_add_f32_dpp v71, v71, v71 row_ror:8 row_mask:0xf bank_mask:0xf
    v_lshrrev_b32 v8, 4, v0
    v_lshlrev_b32 v8, 7, v8
    v_lshl_add_u32 v8, v1, 5, v8
    ds_write_b128 v8, v[64:67]
    ds_write_b128 v8, v[68:71] offset:16
    s_waitcnt lgkmcnt(0)
    s_barrier
    v_lshlrev_b32 v8, 2, v7
    ds_read2st64_b32 v[64:65], v8 offset0:0 offset1:1
    ds_read2st64_b32 v[66:67], v8 offset0:2 offset1:3
    ds_read2st64_b32 v[68:69], v8 offset0:4 offset1:5
    ds_read2st64_b32 v[70:71], v8 offset0:6 offset1:7
    ds_read2st64_b32 v[72:73], v8 offset0:8 offset1:9
    ds_read2st64_b32 v[74:75], v8 offset0:10 offset1:11
    ds_read2st64_b32 v[76:77], v8 offset0:12 offset1:13
    ds_read2st64_b32 v[78:79], v8 offset0:14 offset1:15
    ds_read2st64_b32 v[80:81], v8 offset0:16 offset1:17
    s_waitcnt lgkmcnt(0)
    v_pk_add_f32 v[64:65], v[64:65], v[66:67]
    v_pk_add_f32 v[64:65], v[64:65], v[68:69]
    v_pk_add_f32 v[64:65], v[64:65], v[70:71]
    v_pk_add_f32 v[64:65], v[64:65], v[72:73]
    v_pk_add_f32 v[64:65], v[64:65], v[74:75]
    v_pk_add_f32 v[64:65], v[64:65], v[76:77]
    v_pk_add_f32 v[64:65], v[64:65], v[78:79]
    v_pk_add_f32 v[64:65], v[64:65], v[80:81]
    v_cvt_pk_bf16_f32 v66, v64, v65
    v_lshlrev_b32 v64, 16, v66
    v_and_b32 v65, 0xffff0000, v66
    v_mul_f32 v66, 0xbfb8aa3b, v64
    v_min_f32 v66, 0x42fc0000, v66
    v_exp_f32 v66, v66
    s_nop 0
    v_add_f32 v66, 1.0, v66
    v_rcp_f32 v67, v66
    s_nop 0
    v_mul_f32 v68, v64, v67
    v_fma_f32 v66, -v68, v66, v64
    v_fma_f32 v64, v66, v67, v68
    v_cvt_pk_bf16_f32 v64, v64, v64
    v_and_b32 v64, 0xffff0000, v64
    v_mul_f32 v64, v64, v65
    v_cvt_pk_bf16_f32 v64, v64, v64
    v_and_b32 v64, 0xffff0000, v64
    v_lshlrev_b32 v9, 4, v4
    ds_bpermute_b32 v68, v9, v64 offset:0
    ds_bpermute_b32 v69, v9, v64 offset:4
    ds_bpermute_b32 v70, v9, v64 offset:8
    ds_bpermute_b32 v71, v9, v64 offset:12
    ds_bpermute_b32 v72, v9, v64 offset:128
    ds_bpermute_b32 v73, v9, v64 offset:132
    ds_bpermute_b32 v74, v9, v64 offset:136
    ds_bpermute_b32 v75, v9, v64 offset:140
    s_waitcnt lgkmcnt(0)
    v_lshlrev_b32 v96, 16, v48
    v_and_b32 v97, 0xffff0000, v48
    v_lshlrev_b32 v98, 16, v49
    v_and_b32 v99, 0xffff0000, v49
    v_lshlrev_b32 v100, 16, v50
    v_and_b32 v101, 0xffff0000, v50
    v_lshlrev_b32 v102, 16, v51
    v_and_b32 v103, 0xffff0000, v51
    v_mul_f32 v80, v68, v96
    v_mul_f32 v81, v68, v97
    v_mul_f32 v82, v68, v98
    v_mul_f32 v83, v68, v99
    v_mul_f32 v84, v68, v100
    v_mul_f32 v85, v68, v101
    v_mul_f32 v86, v68, v102
    v_mul_f32 v87, v68, v103
    v_mul_f32 v88, v72, v96
    v_mul_f32 v89, v72, v97
    v_mul_f32 v90, v72, v98
    v_mul_f32 v91, v72, v99
    v_mul_f32 v92, v72, v100
    v_mul_f32 v93, v72, v101
    v_mul_f32 v94, v72, v102
    v_mul_f32 v95, v72, v103
    v_lshlrev_b32 v96, 16, v52
    v_and_b32 v97, 0xffff0000, v52
    v_lshlrev_b32 v98, 16, v53
    v_and_b32 v99, 0xffff0000, v53
    v_lshlrev_b32 v100, 16, v54
    v_and_b32 v101, 0xffff0000, v54
    v_lshlrev_b32 v102, 16, v55
    v_and_b32 v103, 0xffff0000, v55
    v_fmac_f32 v80, v69, v96
    v_fmac_f32 v81, v69, v97
    v_fmac_f32 v82, v69, v98
    v_fmac_f32 v83, v69, v99
    v_fmac_f32 v84, v69, v100
    v_fmac_f32 v85, v69, v101
    v_fmac_f32 v86, v69, v102
    v_fmac_f32 v87, v69, v103
    v_fmac_f32 v88, v73, v96
    v_fmac_f32 v89, v73, v97
    v_fmac_f32 v90, v73, v98
    v_fmac_f32 v91, v73, v99
    v_fmac_f32 v92, v73, v100
    v_fmac_f32 v93, v73, v101
    v_fmac_f32 v94, v73, v102
    v_fmac_f32 v95, v73, v103
    v_lshlrev_b32 v96, 16, v56
    v_and_b32 v97, 0xffff0000, v56
    v_lshlrev_b32 v98, 16, v57
    v_and_b32 v99, 0xffff0000, v57
    v_lshlrev_b32 v100, 16, v58
    v_and_b32 v101, 0xffff0000, v58
    v_lshlrev_b32 v102, 16, v59
    v_and_b32 v103, 0xffff0000, v59
    v_fmac_f32 v80, v70, v96
    v_fmac_f32 v81, v70, v97
    v_fmac_f32 v82, v70, v98
    v_fmac_f32 v83, v70, v99
    v_fmac_f32 v84, v70, v100
    v_fmac_f32 v85, v70, v101
    v_fmac_f32 v86, v70, v102
    v_fmac_f32 v87, v70, v103
    v_fmac_f32 v88, v74, v96
    v_fmac_f32 v89, v74, v97
    v_fmac_f32 v90, v74, v98
    v_fmac_f32 v91, v74, v99
    v_fmac_f32 v92, v74, v100
    v_fmac_f32 v93, v74, v101
    v_fmac_f32 v94, v74, v102
    v_fmac_f32 v95, v74, v103
    v_lshlrev_b32 v96, 16, v60
    v_and_b32 v97, 0xffff0000, v60
    v_lshlrev_b32 v98, 16, v61
    v_and_b32 v99, 0xffff0000, v61
    v_lshlrev_b32 v100, 16, v62
    v_and_b32 v101, 0xffff0000, v62
    v_lshlrev_b32 v102, 16, v63
    v_and_b32 v103, 0xffff0000, v63
    v_fmac_f32 v80, v71, v96
    v_fmac_f32 v81, v71, v97
    v_fmac_f32 v82, v71, v98
    v_fmac_f32 v83, v71, v99
    v_fmac_f32 v84, v71, v100
    v_fmac_f32 v85, v71, v101
    v_fmac_f32 v86, v71, v102
    v_fmac_f32 v87, v71, v103
    v_fmac_f32 v88, v75, v96
    v_fmac_f32 v89, v75, v97
    v_fmac_f32 v90, v75, v98
    v_fmac_f32 v91, v75, v99
    v_fmac_f32 v92, v75, v100
    v_fmac_f32 v93, v75, v101
    v_fmac_f32 v94, v75, v102
    v_fmac_f32 v95, v75, v103
    v_mul_u32_u24 v8, 4608, v4
    v_lshl_add_u32 v8, v5, 5, v8
    ds_write_b128 v8, v[80:83] offset:8192
    ds_write_b128 v8, v[84:87] offset:8208
    ds_write_b128 v8, v[88:91] offset:10496
    ds_write_b128 v8, v[92:95] offset:10512
    s_waitcnt lgkmcnt(0)
    s_barrier
    v_lshlrev_b32 v8, 3, v0
    ds_read_b64 v[64:65], v8 offset:8192
    ds_read_b64 v[66:67], v8 offset:12800
    ds_read_b64 v[68:69], v8 offset:17408
    ds_read_b64 v[70:71], v8 offset:22016
    ds_read_b64 v[72:73], v8 offset:26624
    ds_read_b64 v[74:75], v8 offset:31232
    ds_read_b64 v[76:77], v8 offset:35840
    ds_read_b64 v[78:79], v8 offset:40448
    s_mul_i32 s30, s2, 4608
    s_waitcnt lgkmcnt(0)
    v_pk_add_f32 v[64:65], v[64:65], v[66:67]
    v_pk_add_f32 v[64:65], v[64:65], v[68:69]
    v_pk_add_f32 v[64:65], v[64:65], v[70:71]
    v_pk_add_f32 v[64:65], v[64:65], v[72:73]
    v_pk_add_f32 v[64:65], v[64:65], v[74:75]
    v_pk_add_f32 v[64:65], v[64:65], v[76:77]
    v_pk_add_f32 v[64:65], v[64:65], v[78:79]
    buffer_store_dwordx2 v[64:65], v8, s[24:27], s30 offen
    s_cmp_lg_u32 s2, 0
    s_cbranch_scc1 Lffn_end
    v_mov_b32 v66, s46
    v_mov_b32 v67, s47
    v_mov_b32 v8, 663552
    buffer_store_dwordx2 v[66:67], v8, s[24:27], 0 offen
Lffn_end:
    s_endpgm
.globl fin_kernel
.p2align 8
.type fin_kernel,@function
fin_kernel:
    s_cmp_ge_u32 s2, 36
    s_cbranch_scc1 Lfin_end
    s_load_dwordx2 s[28:29], s[0:1], 112
    s_load_dwordx2 s[40:41], s[0:1], 96
    v_and_b32 v1, 7, v0
    v_lshrrev_b32 v2, 3, v0
    v_mul_u32_u24 v3, 4608, v2
    v_lshl_add_u32 v3, v1, 4, v3
    s_lshl_b32 s3, s2, 7
    v_add_u32 v3, s3, v3
    s_cmp_ge_u32 s2, 18
    s_cselect_b32 s4, 1, 0
    s_mul_i32 s5, s4, 18
    s_sub_u32 s5, s2, s5
    s_waitcnt lgkmcnt(0)
    s_add_u32 s24, s28, 7864320
    s_addc_u32 s25, s29, 0
    s_mov_b32 s26, 663616
    s_mov_b32 s27, 0x20000
    s_lshl_b32 s6, s4, 2
    s_add_u32 s6, s6, 663552
    s_buffer_load_dword s7, s[24:27], s6
    s_mov_b32 s30, 0
    buffer_load_dwordx4 v[8:11], v3, s[24:27], s30 offen
    s_mov_b32 s30, 110592
    buffer_load_dwordx4 v[12:15], v3, s[24:27], s30 offen
    s_mov_b32 s30, 221184
    buffer_load_dwordx4 v[16:19], v3, s[24:27], s30 offen
    s_mov_b32 s30, 331776
    buffer_load_dwordx4 v[20:23], v3, s[24:27], s30 offen
    s_mov_b32 s30, 442368
    buffer_load_dwordx4 v[24:27], v3, s[24:27], s30 offen
    s_mov_b32 s30, 552960
    buffer_load_dwordx4 v[28:31], v3, s[24:27], s30 offen
    s_mov_b32 s12, s28
    s_mov_b32 s13, s29
    s_mov_b32 s14, 13824
    s_mov_b32 s15, 0x20000
    s_add_u32 s16, s28, 5242880
    s_addc_u32 s17, s29, 0
    s_mov_b32 s18, 2359296
    s_mov_b32 s19, 0x20000
    s_add_u32 s20, s28, 2621440
    s_addc_u32 s21, s29, 0
    s_mov_b32 s22, 2359296
    s_mov_b32 s23, 0x20000
    s_add_u32 s32, s28, 32768
    s_addc_u32 s33, s29, 0
    s_mov_b32 s34, 16384
    s_mov_b32 s35, 0x20000
    s_mov_b32 s42, 2359296
    s_mov_b32 s43, 0x20000
    v_and_b32 v4, 31, v0
    v_lshlrev_b32 v5, 2, v4
    v_lshlrev_b32 v6, 1, v4
    s_lshl_b32 s8, s5, 7
    s_add_u32 s8, s8, 11520
    buffer_load_dword v34, v5, s[12:15], s8 offen
    s_waitcnt lgkmcnt(0)
    s_and_b32 s7, s7, 0x7ff
    s_mul_i32 s9, s7, 1152
    s_lshl_b32 s10, s5, 6
    s_add_u32 s9, s9, s10
    s_lshl_b32 s10, s7, 2
    s_add_u32 s10, s10, 0x2000
    s_buffer_load_dword s11, s[32:35], s10
    buffer_load_ushort v32, v6, s[16:19], s9 offen
    buffer_load_ushort v33, v6, s[20:23], s9 offen
    s_waitcnt vmcnt(3)
    v_pk_add_f32 v[8:9], v[8:9], v[12:13]
    v_pk_add_f32 v[10:11], v[10:11], v[14:15]
    v_pk_add_f32 v[8:9], v[8:9], v[16:17]
    v_pk_add_f32 v[10:11], v[10:11], v[18:19]
    v_pk_add_f32 v[8:9], v[8:9], v[20:21]
    v_pk_add_f32 v[10:11], v[10:11], v[22:23]
    v_pk_add_f32 v[8:9], v[8:9], v[24:25]
    v_pk_add_f32 v[10:11], v[10:11], v[26:27]
    v_pk_add_f32 v[8:9], v[8:9], v[28:29]
    v_pk_add_f32 v[10:11], v[10:11], v[30:31]
    s_nop 1
    v_add_f32_dpp v8, v8, v8 row_ror:8 row_mask:0xf bank_mask:0xf
    v_add_f32_dpp v9, v9, v9 row_ror:8 row_mask:0xf bank_mask:0xf
    v_add_f32_dpp v10, v10, v10 row_ror:8 row_mask:0xf bank_mask:0xf
    v_add_f32_dpp v11, v11, v11 row_ror:8 row_mask:0xf bank_mask:0xf
    v_mov_b32 v12, v8
    v_mov_b32 v13, v9
    v_mov_b32 v14, v10
    v_mov_b32 v15, v11
    s_nop 1
    v_permlane16_swap_b32 v8, v12
    v_permlane16_swap_b32 v9, v13
    v_permlane16_swap_b32 v10, v14
    v_permlane16_swap_b32 v11, v15
    s_nop 1
    v_add_f32 v8, v8, v12
    v_add_f32 v9, v9, v13
    v_add_f32 v10, v10, v14
    v_add_f32 v11, v11, v15
    v_mov_b32 v12, v8
    v_mov_b32 v13, v9
    v_mov_b32 v14, v10
    v_mov_b32 v15, v11
    s_nop 1
    v_permlane32_swap_b32 v8, v12
    v_permlane32_swap_b32 v9, v13
    v_permlane32_swap_b32 v10, v14
    v_permlane32_swap_b32 v11, v15
    s_nop 1
    v_add_f32 v8, v8, v12
    v_add_f32 v9, v9, v13
    v_add_f32 v10, v10, v14
    v_add_f32 v11, v11, v15
    v_lshrrev_b32 v7, 6, v0
    v_lshlrev_b32 v7, 7, v7
    v_lshl_add_u32 v7, v1, 4, v7
    ds_write_b128 v7, v[8:11]
    s_waitcnt lgkmcnt(0)
    s_barrier
    v_cmp_gt_u32 vcc, 32, v0
    s_and_saveexec_b64 s[44:45], vcc
    s_cbranch_execz Lfin_end
    ds_read2_b32 v[8:9], v5 offset0:0 offset1:32
    ds_read_b32 v10, v5 offset:256
    v_mov_b32 v12, s11
    v_cvt_pk_bf16_f32 v12, v12, v12
    v_and_b32 v12, 0xffff0000, v12
    v_mul_f32 v12, 0xbfb8aa3b, v12
    v_exp_f32 v12, v12
    s_nop 0
    v_add_f32 v12, 1.0, v12
    v_rcp_f32 v12, v12
    s_nop 0
    v_cvt_pk_bf16_f32 v12, v12, v12
    v_and_b32 v12, 0xffff0000, v12
    s_waitcnt vmcnt(0) lgkmcnt(0)
    v_add_f32 v8, v8, v9
    v_add_f32 v8, v8, v10
    v_cvt_pk_bf16_f32 v8, v8, v8
    v_and_b32 v8, 0xffff0000, v8
    v_mul_f32 v8, v8, v12
    v_cvt_pk_bf16_f32 v8, v8, v8
    v_and_b32 v8, 0xffff0000, v8
    v_lshlrev_b32 v33, 16, v33
    v_lshlrev_b32 v32, 16, v32
    v_add_f32 v8, v33, v8
    v_cvt_pk_bf16_f32 v8, v8, v8
    v_and_b32 v8, 0xffff0000, v8
    v_mul_f32 v8, v34, v8
    v_cvt_pk_bf16_f32 v8, v8, v8
    v_and_b32 v8, 0xffff0000, v8
    v_add_f32 v8, v32, v8
    v_cvt_pk_bf16_f32 v8, v8, v8
    buffer_store_short v8, v6, s[40:43], s9 offen
Lfin_end:
    s_endpgm
.section .rodata,"a"
.p2align 6
.amdhsa_kernel mod_kernel
  .amdhsa_next_free_vgpr 72
  .amdhsa_next_free_sgpr 102
  .amdhsa_accum_offset 72
  .amdhsa_group_segment_fixed_size 0
  .amdhsa_kernarg_size 120
  .amdhsa_user_sgpr_count 2
  .amdhsa_user_sgpr_kernarg_segment_ptr 1
  .amdhsa_system_sgpr_workgroup_id_x 1
  .amdhsa_float_denorm_mode_32 3
.end_amdhsa_kernel
.p2align 6
.amdhsa_kernel ln1_kernel
  .amdhsa_next_free_vgpr 72
  .amdhsa_next_free_sgpr 102
  .amdhsa_accum_offset 72
  .amdhsa_group_segment_fixed_size 0
  .amdhsa_kernarg_size 120
  .amdhsa_user_sgpr_count 2
  .amdhsa_user_sgpr_kernarg_segment_ptr 1
  .amdhsa_system_sgpr_workgroup_id_x 1
  .amdhsa_float_denorm_mode_32 3
.end_amdhsa_kernel
.p2align 6
.amdhsa_kernel attn_kernel
  .amdhsa_next_free_vgpr 512
  .amdhsa_next_free_sgpr 102
  .amdhsa_accum_offset 256
  .amdhsa_group_segment_fixed_size 0
  .amdhsa_kernarg_size 120
  .amdhsa_user_sgpr_count 2
  .amdhsa_user_sgpr_kernarg_segment_ptr 1
  .amdhsa_system_sgpr_workgroup_id_x 1
  .amdhsa_float_denorm_mode_32 3
.end_amdhsa_kernel
.p2align 6
.amdhsa_kernel post_kernel
  .amdhsa_next_free_vgpr 128
  .amdhsa_next_free_sgpr 102
  .amdhsa_accum_offset 128
  .amdhsa_group_segment_fixed_size 0
  .amdhsa_kernarg_size 120
  .amdhsa_user_sgpr_count 2
  .amdhsa_user_sgpr_kernarg_segment_ptr 1
  .amdhsa_system_sgpr_workgroup_id_x 1
  .amdhsa_float_denorm_mode_32 3
.end_amdhsa_kernel
.p2align 6
.amdhsa_kernel ffn_kernel
  .amdhsa_next_free_vgpr 104
  .amdhsa_next_free_sgpr 102
  .amdhsa_accum_offset 104
  .amdhsa_group_segment_fixed_size 0
  .amdhsa_kernarg_size 120
  .amdhsa_user_sgpr_count 2
  .amdhsa_user_sgpr_kernarg_segment_ptr 1
  .amdhsa_system_sgpr_workgroup_id_x 1
  .amdhsa_float_denorm_mode_32 3
.end_amdhsa_kernel
.p2align 6
.amdhsa_kernel fin_kernel
  .amdhsa_next_free_vgpr 40
  .amdhsa_next_free_sgpr 102
  .amdhsa_accum_offset 40
  .amdhsa_group_segment_fixed_size 0
  .amdhsa_kernarg_size 120
  .amdhsa_user_sgpr_count 2
  .amdhsa_user_sgpr_kernarg_segment_ptr 1
  .amdhsa_system_sgpr_workgroup_id_x 1
  .amdhsa_float_denorm_mode_32 3
.end_amdhsa_kernel
```

```asm
; @launch kernel=mod_kernel grid=(108,1,1) block=(256,1,1) lds=512
; @launch kernel=ln1_kernel grid=(256,1,1) block=(576,1,1) lds=1024
; @launch kernel=attn_kernel grid=(256,1,1) block=(256,1,1) lds=163840
; @launch kernel=post_kernel grid=(256,1,1) block=(576,1,1) lds=2048
; @launch kernel=ffn_kernel grid=(144,1,1) block=(576,1,1) lds=45056
; @launch kernel=fin_kernel grid=(36,1,1) block=(192,1,1) lds=512
.amdgcn_target "amdgcn-amd-amdhsa--gfx950"
.text
.globl mod_kernel
.p2align 8
.type mod_kernel,@function
mod_kernel:
    s_cmp_ge_u32 s2, 108
    s_cbranch_scc1 Lmod_end
    s_load_dwordx4 s[4:7], s[0:1], 80
    s_load_dwordx2 s[16:17], s[0:1], 112
    v_and_b32 v1, 3, v0
    v_lshrrev_b32 v2, 2, v0
    v_mul_u32_u24 v3, 6912, v2
    s_lshl_b32 s3, s2, 6
    v_lshl_add_u32 v3, v1, 4, v3
    v_add_u32 v3, s3, v3
    v_lshlrev_b32 v4, 1, v2
    s_waitcnt lgkmcnt(0)
    s_mov_b32 s8, s4
    s_mov_b32 s9, s5
    s_mov_b32 s10, 1152
    s_mov_b32 s11, 0x20000
    s_mov_b32 s12, s6
    s_mov_b32 s13, s7
    s_mov_b32 s14, 3981312
    s_mov_b32 s15, 0x20000
    s_mov_b32 s18, 13824
    s_mov_b32 s19, 0x20000
    buffer_load_ushort v8, v4, s[8:11], 0 offen offset:0
    buffer_load_ushort v9, v4, s[8:11], 0 offen offset:128
    buffer_load_ushort v10, v4, s[8:11], 0 offen offset:256
    buffer_load_ushort v11, v4, s[8:11], 0 offen offset:384
    buffer_load_ushort v12, v4, s[8:11], 0 offen offset:512
    buffer_load_ushort v13, v4, s[8:11], 0 offen offset:640
    buffer_load_ushort v14, v4, s[8:11], 0 offen offset:768
    buffer_load_ushort v15, v4, s[8:11], 0 offen offset:896
    buffer_load_ushort v16, v4, s[8:11], 0 offen offset:1024
    s_mov_b32 s20, 0
    buffer_load_dwordx4 v[20:23], v3, s[12:15], s20 offen
    s_mov_b32 s20, 442368
    buffer_load_dwordx4 v[24:27], v3, s[12:15], s20 offen
    s_mov_b32 s20, 884736
    buffer_load_dwordx4 v[28:31], v3, s[12:15], s20 offen
    s_mov_b32 s20, 1327104
    buffer_load_dwordx4 v[32:35], v3, s[12:15], s20 offen
    s_mov_b32 s20, 1769472
    buffer_load_dwordx4 v[36:39], v3, s[12:15], s20 offen
    s_mov_b32 s20, 2211840
    buffer_load_dwordx4 v[40:43], v3, s[12:15], s20 offen
    s_mov_b32 s20, 2654208
    buffer_load_dwordx4 v[44:47], v3, s[12:15], s20 offen
    s_mov_b32 s20, 3096576
    buffer_load_dwordx4 v[48:51], v3, s[12:15], s20 offen
    s_mov_b32 s20, 3538944
    buffer_load_dwordx4 v[52:55], v3, s[12:15], s20 offen
    s_waitcnt vmcnt(9)
    v_lshlrev_b32 v8, 16, v8
    v_mul_f32 v5, 0xbfb8aa3b, v8
    v_min_f32 v5, 0x42fc0000, v5
    v_exp_f32 v5, v5
    s_nop 0
    v_add_f32 v5, 1.0, v5
    v_rcp_f32 v6, v5
    s_nop 0
    v_mul_f32 v7, v8, v6
    v_fma_f32 v5, -v7, v5, v8
    v_fma_f32 v8, v5, v6, v7
    v_cvt_pk_bf16_f32 v8, v8, v8
    v_and_b32 v8, 0xffff0000, v8
    v_lshlrev_b32 v9, 16, v9
    v_mul_f32 v5, 0xbfb8aa3b, v9
    v_min_f32 v5, 0x42fc0000, v5
    v_exp_f32 v5, v5
    s_nop 0
    v_add_f32 v5, 1.0, v5
    v_rcp_f32 v6, v5
    s_nop 0
    v_mul_f32 v7, v9, v6
    v_fma_f32 v5, -v7, v5, v9
    v_fma_f32 v9, v5, v6, v7
    v_cvt_pk_bf16_f32 v9, v9, v9
    v_and_b32 v9, 0xffff0000, v9
    v_lshlrev_b32 v10, 16, v10
    v_mul_f32 v5, 0xbfb8aa3b, v10
    v_min_f32 v5, 0x42fc0000, v5
    v_exp_f32 v5, v5
    s_nop 0
    v_add_f32 v5, 1.0, v5
    v_rcp_f32 v6, v5
    s_nop 0
    v_mul_f32 v7, v10, v6
    v_fma_f32 v5, -v7, v5, v10
    v_fma_f32 v10, v5, v6, v7
    v_cvt_pk_bf16_f32 v10, v10, v10
    v_and_b32 v10, 0xffff0000, v10
    v_lshlrev_b32 v11, 16, v11
    v_mul_f32 v5, 0xbfb8aa3b, v11
    v_min_f32 v5, 0x42fc0000, v5
    v_exp_f32 v5, v5
    s_nop 0
    v_add_f32 v5, 1.0, v5
    v_rcp_f32 v6, v5
    s_nop 0
    v_mul_f32 v7, v11, v6
    v_fma_f32 v5, -v7, v5, v11
    v_fma_f32 v11, v5, v6, v7
    v_cvt_pk_bf16_f32 v11, v11, v11
    v_and_b32 v11, 0xffff0000, v11
    v_lshlrev_b32 v12, 16, v12
    v_mul_f32 v5, 0xbfb8aa3b, v12
    v_min_f32 v5, 0x42fc0000, v5
    v_exp_f32 v5, v5
    s_nop 0
    v_add_f32 v5, 1.0, v5
    v_rcp_f32 v6, v5
    s_nop 0
    v_mul_f32 v7, v12, v6
    v_fma_f32 v5, -v7, v5, v12
    v_fma_f32 v12, v5, v6, v7
    v_cvt_pk_bf16_f32 v12, v12, v12
    v_and_b32 v12, 0xffff0000, v12
    v_lshlrev_b32 v13, 16, v13
    v_mul_f32 v5, 0xbfb8aa3b, v13
    v_min_f32 v5, 0x42fc0000, v5
    v_exp_f32 v5, v5
    s_nop 0
    v_add_f32 v5, 1.0, v5
    v_rcp_f32 v6, v5
    s_nop 0
    v_mul_f32 v7, v13, v6
    v_fma_f32 v5, -v7, v5, v13
    v_fma_f32 v13, v5, v6, v7
    v_cvt_pk_bf16_f32 v13, v13, v13
    v_and_b32 v13, 0xffff0000, v13
    v_lshlrev_b32 v14, 16, v14
    v_mul_f32 v5, 0xbfb8aa3b, v14
    v_min_f32 v5, 0x42fc0000, v5
    v_exp_f32 v5, v5
    s_nop 0
    v_add_f32 v5, 1.0, v5
    v_rcp_f32 v6, v5
    s_nop 0
    v_mul_f32 v7, v14, v6
    v_fma_f32 v5, -v7, v5, v14
    v_fma_f32 v14, v5, v6, v7
    v_cvt_pk_bf16_f32 v14, v14, v14
    v_and_b32 v14, 0xffff0000, v14
    v_lshlrev_b32 v15, 16, v15
    v_mul_f32 v5, 0xbfb8aa3b, v15
    v_min_f32 v5, 0x42fc0000, v5
    v_exp_f32 v5, v5
    s_nop 0
    v_add_f32 v5, 1.0, v5
    v_rcp_f32 v6, v5
    s_nop 0
    v_mul_f32 v7, v15, v6
    v_fma_f32 v5, -v7, v5, v15
    v_fma_f32 v15, v5, v6, v7
    v_cvt_pk_bf16_f32 v15, v15, v15
    v_and_b32 v15, 0xffff0000, v15
    v_lshlrev_b32 v16, 16, v16
    v_mul_f32 v5, 0xbfb8aa3b, v16
    v_min_f32 v5, 0x42fc0000, v5
    v_exp_f32 v5, v5
    s_nop 0
    v_add_f32 v5, 1.0, v5
    v_rcp_f32 v6, v5
    s_nop 0
    v_mul_f32 v7, v16, v6
    v_fma_f32 v5, -v7, v5, v16
    v_fma_f32 v16, v5, v6, v7
    v_cvt_pk_bf16_f32 v16, v16, v16
    v_and_b32 v16, 0xffff0000, v16
    s_waitcnt vmcnt(8)
    v_lshlrev_b32 v64, 16, v20
    v_and_b32 v65, 0xffff0000, v20
    v_lshlrev_b32 v66, 16, v21
    v_and_b32 v67, 0xffff0000, v21
    v_lshlrev_b32 v68, 16, v22
    v_and_b32 v69, 0xffff0000, v22
    v_lshlrev_b32 v70, 16, v23
    v_and_b32 v71, 0xffff0000, v23
    v_mul_f32 v56, v8, v64
    v_mul_f32 v57, v8, v65
    v_mul_f32 v58, v8, v66
    v_mul_f32 v59, v8, v67
    v_mul_f32 v60, v8, v68
    v_mul_f32 v61, v8, v69
    v_mul_f32 v62, v8, v70
    v_mul_f32 v63, v8, v71
    s_waitcnt vmcnt(7)
    v_lshlrev_b32 v64, 16, v24
    v_and_b32 v65, 0xffff0000, v24
    v_lshlrev_b32 v66, 16, v25
    v_and_b32 v67, 0xffff0000, v25
    v_lshlrev_b32 v68, 16, v26
    v_and_b32 v69, 0xffff0000, v26
    v_lshlrev_b32 v70, 16, v27
    v_and_b32 v71, 0xffff0000, v27
    v_fmac_f32 v56, v9, v64
    v_fmac_f32 v57, v9, v65
    v_fmac_f32 v58, v9, v66
    v_fmac_f32 v59, v9, v67
    v_fmac_f32 v60, v9, v68
    v_fmac_f32 v61, v9, v69
    v_fmac_f32 v62, v9, v70
    v_fmac_f32 v63, v9, v71
    s_waitcnt vmcnt(6)
    v_lshlrev_b32 v64, 16, v28
    v_and_b32 v65, 0xffff0000, v28
    v_lshlrev_b32 v66, 16, v29
    v_and_b32 v67, 0xffff0000, v29
    v_lshlrev_b32 v68, 16, v30
    v_and_b32 v69, 0xffff0000, v30
    v_lshlrev_b32 v70, 16, v31
    v_and_b32 v71, 0xffff0000, v31
    v_fmac_f32 v56, v10, v64
    v_fmac_f32 v57, v10, v65
    v_fmac_f32 v58, v10, v66
    v_fmac_f32 v59, v10, v67
    v_fmac_f32 v60, v10, v68
    v_fmac_f32 v61, v10, v69
    v_fmac_f32 v62, v10, v70
    v_fmac_f32 v63, v10, v71
    s_waitcnt vmcnt(5)
    v_lshlrev_b32 v64, 16, v32
    v_and_b32 v65, 0xffff0000, v32
    v_lshlrev_b32 v66, 16, v33
    v_and_b32 v67, 0xffff0000, v33
    v_lshlrev_b32 v68, 16, v34
    v_and_b32 v69, 0xffff0000, v34
    v_lshlrev_b32 v70, 16, v35
    v_and_b32 v71, 0xffff0000, v35
    v_fmac_f32 v56, v11, v64
    v_fmac_f32 v57, v11, v65
    v_fmac_f32 v58, v11, v66
    v_fmac_f32 v59, v11, v67
    v_fmac_f32 v60, v11, v68
    v_fmac_f32 v61, v11, v69
    v_fmac_f32 v62, v11, v70
    v_fmac_f32 v63, v11, v71
    s_waitcnt vmcnt(4)
    v_lshlrev_b32 v64, 16, v36
    v_and_b32 v65, 0xffff0000, v36
    v_lshlrev_b32 v66, 16, v37
    v_and_b32 v67, 0xffff0000, v37
    v_lshlrev_b32 v68, 16, v38
    v_and_b32 v69, 0xffff0000, v38
    v_lshlrev_b32 v70, 16, v39
    v_and_b32 v71, 0xffff0000, v39
    v_fmac_f32 v56, v12, v64
    v_fmac_f32 v57, v12, v65
    v_fmac_f32 v58, v12, v66
    v_fmac_f32 v59, v12, v67
    v_fmac_f32 v60, v12, v68
    v_fmac_f32 v61, v12, v69
    v_fmac_f32 v62, v12, v70
    v_fmac_f32 v63, v12, v71
    s_waitcnt vmcnt(3)
    v_lshlrev_b32 v64, 16, v40
    v_and_b32 v65, 0xffff0000, v40
    v_lshlrev_b32 v66, 16, v41
    v_and_b32 v67, 0xffff0000, v41
    v_lshlrev_b32 v68, 16, v42
    v_and_b32 v69, 0xffff0000, v42
    v_lshlrev_b32 v70, 16, v43
    v_and_b32 v71, 0xffff0000, v43
    v_fmac_f32 v56, v13, v64
    v_fmac_f32 v57, v13, v65
    v_fmac_f32 v58, v13, v66
    v_fmac_f32 v59, v13, v67
    v_fmac_f32 v60, v13, v68
    v_fmac_f32 v61, v13, v69
    v_fmac_f32 v62, v13, v70
    v_fmac_f32 v63, v13, v71
    s_waitcnt vmcnt(2)
    v_lshlrev_b32 v64, 16, v44
    v_and_b32 v65, 0xffff0000, v44
    v_lshlrev_b32 v66, 16, v45
    v_and_b32 v67, 0xffff0000, v45
    v_lshlrev_b32 v68, 16, v46
    v_and_b32 v69, 0xffff0000, v46
    v_lshlrev_b32 v70, 16, v47
    v_and_b32 v71, 0xffff0000, v47
    v_fmac_f32 v56, v14, v64
    v_fmac_f32 v57, v14, v65
    v_fmac_f32 v58, v14, v66
    v_fmac_f32 v59, v14, v67
    v_fmac_f32 v60, v14, v68
    v_fmac_f32 v61, v14, v69
    v_fmac_f32 v62, v14, v70
    v_fmac_f32 v63, v14, v71
    s_waitcnt vmcnt(1)
    v_lshlrev_b32 v64, 16, v48
    v_and_b32 v65, 0xffff0000, v48
    v_lshlrev_b32 v66, 16, v49
    v_and_b32 v67, 0xffff0000, v49
    v_lshlrev_b32 v68, 16, v50
    v_and_b32 v69, 0xffff0000, v50
    v_lshlrev_b32 v70, 16, v51
    v_and_b32 v71, 0xffff0000, v51
    v_fmac_f32 v56, v15, v64
    v_fmac_f32 v57, v15, v65
    v_fmac_f32 v58, v15, v66
    v_fmac_f32 v59, v15, v67
    v_fmac_f32 v60, v15, v68
    v_fmac_f32 v61, v15, v69
    v_fmac_f32 v62, v15, v70
    v_fmac_f32 v63, v15, v71
    s_waitcnt vmcnt(0)
    v_lshlrev_b32 v64, 16, v52
    v_and_b32 v65, 0xffff0000, v52
    v_lshlrev_b32 v66, 16, v53
    v_and_b32 v67, 0xffff0000, v53
    v_lshlrev_b32 v68, 16, v54
    v_and_b32 v69, 0xffff0000, v54
    v_lshlrev_b32 v70, 16, v55
    v_and_b32 v71, 0xffff0000, v55
    v_fmac_f32 v56, v16, v64
    v_fmac_f32 v57, v16, v65
    v_fmac_f32 v58, v16, v66
    v_fmac_f32 v59, v16, v67
    v_fmac_f32 v60, v16, v68
    v_fmac_f32 v61, v16, v69
    v_fmac_f32 v62, v16, v70
    v_fmac_f32 v63, v16, v71
    s_nop 1
    v_add_f32_dpp v56, v56, v56 row_ror:4 row_mask:0xf bank_mask:0xf
    v_add_f32_dpp v57, v57, v57 row_ror:4 row_mask:0xf bank_mask:0xf
    v_add_f32_dpp v58, v58, v58 row_ror:4 row_mask:0xf bank_mask:0xf
    v_add_f32_dpp v59, v59, v59 row_ror:4 row_mask:0xf bank_mask:0xf
    v_add_f32_dpp v60, v60, v60 row_ror:4 row_mask:0xf bank_mask:0xf
    v_add_f32_dpp v61, v61, v61 row_ror:4 row_mask:0xf bank_mask:0xf
    v_add_f32_dpp v62, v62, v62 row_ror:4 row_mask:0xf bank_mask:0xf
    v_add_f32_dpp v63, v63, v63 row_ror:4 row_mask:0xf bank_mask:0xf
    s_nop 1
    v_add_f32_dpp v56, v56, v56 row_ror:8 row_mask:0xf bank_mask:0xf
    v_add_f32_dpp v57, v57, v57 row_ror:8 row_mask:0xf bank_mask:0xf
    v_add_f32_dpp v58, v58, v58 row_ror:8 row_mask:0xf bank_mask:0xf
    v_add_f32_dpp v59, v59, v59 row_ror:8 row_mask:0xf bank_mask:0xf
    v_add_f32_dpp v60, v60, v60 row_ror:8 row_mask:0xf bank_mask:0xf
    v_add_f32_dpp v61, v61, v61 row_ror:8 row_mask:0xf bank_mask:0xf
    v_add_f32_dpp v62, v62, v62 row_ror:8 row_mask:0xf bank_mask:0xf
    v_add_f32_dpp v63, v63, v63 row_ror:8 row_mask:0xf bank_mask:0xf
    v_mov_b32 v64, v56
    v_mov_b32 v65, v57
    v_mov_b32 v66, v58
    v_mov_b32 v67, v59
    v_mov_b32 v68, v60
    v_mov_b32 v69, v61
    v_mov_b32 v70, v62
    v_mov_b32 v71, v63
    s_nop 1
    v_permlane16_swap_b32 v56, v64
    v_permlane16_swap_b32 v57, v65
    v_permlane16_swap_b32 v58, v66
    v_permlane16_swap_b32 v59, v67
    v_permlane16_swap_b32 v60, v68
    v_permlane16_swap_b32 v61, v69
    v_permlane16_swap_b32 v62, v70
    v_permlane16_swap_b32 v63, v71
    s_nop 1
    v_add_f32 v56, v56, v64
    v_add_f32 v57, v57, v65
    v_add_f32 v58, v58, v66
    v_add_f32 v59, v59, v67
    v_add_f32 v60, v60, v68
    v_add_f32 v61, v61, v69
    v_add_f32 v62, v62, v70
    v_add_f32 v63, v63, v71
    v_mov_b32 v64, v56
    v_mov_b32 v65, v57
    v_mov_b32 v66, v58
    v_mov_b32 v67, v59
    v_mov_b32 v68, v60
    v_mov_b32 v69, v61
    v_mov_b32 v70, v62
    v_mov_b32 v71, v63
    s_nop 1
    v_permlane32_swap_b32 v56, v64
    v_permlane32_swap_b32 v57, v65
    v_permlane32_swap_b32 v58, v66
    v_permlane32_swap_b32 v59, v67
    v_permlane32_swap_b32 v60, v68
    v_permlane32_swap_b32 v61, v69
    v_permlane32_swap_b32 v62, v70
    v_permlane32_swap_b32 v63, v71
    s_nop 1
    v_add_f32 v56, v56, v64
    v_add_f32 v57, v57, v65
    v_add_f32 v58, v58, v66
    v_add_f32 v59, v59, v67
    v_add_f32 v60, v60, v68
    v_add_f32 v61, v61, v69
    v_add_f32 v62, v62, v70
    v_add_f32 v63, v63, v71
    v_lshrrev_b32 v5, 6, v0
    v_lshlrev_b32 v5, 7, v5
    v_lshl_add_u32 v5, v1, 5, v5
    ds_write_b128 v5, v[56:59]
    ds_write_b128 v5, v[60:63] offset:16
    s_waitcnt lgkmcnt(0)
    s_barrier
    v_cmp_gt_u32 vcc, 32, v0
    s_and_saveexec_b64 s[22:23], vcc
    s_cbranch_execz Lmod_end
    v_lshlrev_b32 v5, 2, v0
    ds_read2_b32 v[6:7], v5 offset0:0 offset1:32
    ds_read2_b32 v[8:9], v5 offset0:64 offset1:96
    s_lshl_b32 s3, s2, 7
    s_waitcnt lgkmcnt(0)
    v_add_f32 v6, v6, v7
    v_add_f32 v8, v8, v9
    v_add_f32 v6, v6, v8
    v_cvt_pk_bf16_f32 v6, v6, v6
    v_and_b32 v6, 0xffff0000, v6
    buffer_store_dword v6, v5, s[16:19], s3 offen
Lmod_end:
    s_endpgm
.globl ln1_kernel
.p2align 8
.type ln1_kernel,@function
ln1_kernel:
    s_cmp_ge_u32 s2, 256
    s_cbranch_scc1 Lln1_end
    s_load_dwordx2 s[4:5], s[0:1], 0
    s_load_dwordx2 s[6:7], s[0:1], 112
    v_and_b32 v1, 7, v0
    v_lshrrev_b32 v2, 5, v0
    v_lshlrev_b32 v2, 6, v2
    v_and_b32 v3, 24, v0
    v_add_u32 v2, v2, v3
    s_lshl_b32 s3, s2, 3
    v_add_u32 v3, s3, v1
    v_mul_u32_u24 v3, 1152, v3
    v_add_u32 v3, v3, v2
    v_lshlrev_b32 v5, 7, v1
    v_lshrrev_b32 v4, 6, v0
    v_lshl_add_u32 v4, v4, 2, v5
    v_lshlrev_b32 v6, 1, v2
    s_waitcnt lgkmcnt(0)
    s_mov_b32 s8, s4
    s_mov_b32 s9, s5
    s_mov_b32 s10, 2359296
    s_mov_b32 s11, 0x20000
    s_mov_b32 s12, s6
    s_mov_b32 s13, s7
    s_mov_b32 s14, 13824
    s_mov_b32 s15, 0x20000
    s_add_u32 s16, s6, 65536
    s_addc_u32 s17, s7, 0
    s_mov_b32 s18, 2359296
    s_mov_b32 s19, 0x20000
    buffer_load_dwordx2 v[8:9], v3, s[8:11], 0 offen
    buffer_load_dwordx2 v[10:11], v3, s[8:11], 0 offen offset:32
    s_mov_b32 s30, 0
    buffer_load_dwordx4 v[24:27], v6, s[12:15], s30 offen
    buffer_load_dwordx4 v[28:31], v6, s[12:15], s30 offen offset:64
    s_mov_b32 s30, 2304
    buffer_load_dwordx4 v[32:35], v6, s[12:15], s30 offen
    buffer_load_dwordx4 v[36:39], v6, s[12:15], s30 offen offset:64
    s_lshr_b32 s20, s2, 1
    s_mul_i32 s20, s20, 18432
    s_and_b32 s21, s2, 1
    s_lshl_b32 s21, s21, 7
    s_add_u32 s20, s20, s21
    v_lshrrev_b32 v7, 3, v0
    v_lshlrev_b32 v7, 8, v7
    v_lshl_add_u32 v7, v1, 4, v7
    s_waitcnt vmcnt(4)
    v_lshlrev_b32 v16, 16, v8
    v_and_b32 v17, 0xffff0000, v8
    v_lshlrev_b32 v18, 16, v9
    v_and_b32 v19, 0xffff0000, v9
    v_lshlrev_b32 v20, 16, v10
    v_and_b32 v21, 0xffff0000, v10
    v_lshlrev_b32 v22, 16, v11
    v_and_b32 v23, 0xffff0000, v11
    v_add_f32 v40, v16, v17
    v_add_f32 v40, v40, v18
    v_add_f32 v40, v40, v19
    v_add_f32 v40, v40, v20
    v_add_f32 v40, v40, v21
    v_add_f32 v40, v40, v22
    v_add_f32 v40, v40, v23
    s_nop 1
    v_add_f32_dpp v40, v40, v40 row_ror:8 row_mask:0xf bank_mask:0xf
    v_mov_b32 v42, v40
    s_nop 1
    v_permlane16_swap_b32 v40, v42
    s_nop 1
    v_add_f32 v40, v40, v42
    v_mov_b32 v42, v40
    s_nop 1
    v_permlane32_swap_b32 v40, v42
    s_nop 1
    v_add_f32 v40, v40, v42
    v_mul_f32 v40, 0x3c800000, v40
    v_sub_f32 v64, v16, v40
    v_sub_f32 v65, v17, v40
    v_sub_f32 v66, v18, v40
    v_sub_f32 v67, v19, v40
    v_sub_f32 v68, v20, v40
    v_sub_f32 v69, v21, v40
    v_sub_f32 v70, v22, v40
    v_sub_f32 v71, v23, v40
    v_mul_f32 v41, v64, v64
    v_fmac_f32 v41, v65, v65
    v_fmac_f32 v41, v66, v66
    v_fmac_f32 v41, v67, v67
    v_fmac_f32 v41, v68, v68
    v_fmac_f32 v41, v69, v69
    v_fmac_f32 v41, v70, v70
    v_fmac_f32 v41, v71, v71
    s_nop 1
    v_add_f32_dpp v41, v41, v41 row_ror:8 row_mask:0xf bank_mask:0xf
    v_mov_b32 v42, v41
    s_nop 1
    v_permlane16_swap_b32 v41, v42
    s_nop 1
    v_add_f32 v41, v41, v42
    v_mov_b32 v42, v41
    s_nop 1
    v_permlane32_swap_b32 v41, v42
    s_nop 1
    v_add_f32 v41, v41, v42
    ds_write2_b32 v4, v40, v41 offset0:0 offset1:16
    s_waitcnt lgkmcnt(0)
    s_barrier
    ds_read_b128 v[44:47], v5
    ds_read_b128 v[48:51], v5 offset:16
    ds_read_b32 v52, v5 offset:32
    ds_read_b128 v[56:59], v5 offset:64
    ds_read_b128 v[60:63], v5 offset:80
    ds_read_b32 v64, v5 offset:96
    s_waitcnt lgkmcnt(3)
    v_add_f32 v40, v44, v45
    v_add_f32 v40, v40, v46
    v_add_f32 v40, v40, v47
    v_add_f32 v40, v40, v48
    v_add_f32 v40, v40, v49
    v_add_f32 v40, v40, v50
    v_add_f32 v40, v40, v51
    v_add_f32 v40, v40, v52
    v_mul_f32 v40, 0x3de38e39, v40
    v_sub_f32 v44, v44, v40
    v_sub_f32 v45, v45, v40
    v_sub_f32 v46, v46, v40
    v_sub_f32 v47, v47, v40
    v_sub_f32 v48, v48, v40
    v_sub_f32 v49, v49, v40
    v_sub_f32 v50, v50, v40
    v_sub_f32 v51, v51, v40
    v_sub_f32 v52, v52, v40
    v_mul_f32 v42, v44, v44
    v_fmac_f32 v42, v45, v45
    v_fmac_f32 v42, v46, v46
    v_fmac_f32 v42, v47, v47
    v_fmac_f32 v42, v48, v48
    v_fmac_f32 v42, v49, v49
    v_fmac_f32 v42, v50, v50
    v_fmac_f32 v42, v51, v51
    v_fmac_f32 v42, v52, v52
    s_waitcnt lgkmcnt(0)
    v_add_f32 v41, v56, v57
    v_add_f32 v41, v41, v58
    v_add_f32 v41, v41, v59
    v_add_f32 v41, v41, v60
    v_add_f32 v41, v41, v61
    v_add_f32 v41, v41, v62
    v_add_f32 v41, v41, v63
    v_add_f32 v41, v41, v64
    v_fmac_f32 v41, 0x42800000, v42
    v_mul_f32 v41, 0x3ae38e39, v41
    v_cvt_pk_bf16_f32 v42, v40, v41
    v_lshlrev_b32 v40, 16, v42
    v_and_b32 v41, 0xffff0000, v42
    v_add_f32 v41, 0x3727c5ac, v41
    v_cvt_pk_bf16_f32 v41, v41, v41
    v_and_b32 v41, 0xffff0000, v41
    v_sqrt_f32 v41, v41
    s_nop 0
    v_cvt_pk_bf16_f32 v41, v41, v41
    v_and_b32 v41, 0xffff0000, v41
    v_rcp_f32 v41, v41
    s_waitcnt vmcnt(0)
    v_sub_f32 v64, v16, v40
    v_sub_f32 v65, v17, v40
    v_sub_f32 v66, v18, v40
    v_sub_f32 v67, v19, v40
    v_sub_f32 v68, v20, v40
    v_sub_f32 v69, v21, v40
    v_sub_f32 v70, v22, v40
    v_sub_f32 v71, v23, v40
    v_cvt_pk_bf16_f32 v42, v64, v65
    v_lshlrev_b32 v64, 16, v42
    v_and_b32 v65, 0xffff0000, v42
    v_cvt_pk_bf16_f32 v42, v66, v67
    v_lshlrev_b32 v66, 16, v42
    v_and_b32 v67, 0xffff0000, v42
    v_cvt_pk_bf16_f32 v42, v68, v69
    v_lshlrev_b32 v68, 16, v42
    v_and_b32 v69, 0xffff0000, v42
    v_cvt_pk_bf16_f32 v42, v70, v71
    v_lshlrev_b32 v70, 16, v42
    v_and_b32 v71, 0xffff0000, v42
    v_mul_f32 v64, v64, v41
    v_mul_f32 v65, v65, v41
    v_mul_f32 v66, v66, v41
    v_mul_f32 v67, v67, v41
    v_mul_f32 v68, v68, v41
    v_mul_f32 v69, v69, v41
    v_mul_f32 v70, v70, v41
    v_mul_f32 v71, v71, v41
    v_cvt_pk_bf16_f32 v42, v64, v65
    v_lshlrev_b32 v64, 16, v42
    v_and_b32 v65, 0xffff0000, v42
    v_cvt_pk_bf16_f32 v42, v66, v67
    v_lshlrev_b32 v66, 16, v42
    v_and_b32 v67, 0xffff0000, v42
    v_cvt_pk_bf16_f32 v42, v68, v69
    v_lshlrev_b32 v68, 16, v42
    v_and_b32 v69, 0xffff0000, v42
    v_cvt_pk_bf16_f32 v42, v70, v71
    v_lshlrev_b32 v70, 16, v42
    v_and_b32 v71, 0xffff0000, v42
    v_add_f32 v32, 1.0, v32
    v_add_f32 v33, 1.0, v33
    v_add_f32 v34, 1.0, v34
    v_add_f32 v35, 1.0, v35
    v_add_f32 v36, 1.0, v36
    v_add_f32 v37, 1.0, v37
    v_add_f32 v38, 1.0, v38
    v_add_f32 v39, 1.0, v39
    v_cvt_pk_bf16_f32 v42, v32, v33
    v_lshlrev_b32 v32, 16, v42
    v_and_b32 v33, 0xffff0000, v42
    v_cvt_pk_bf16_f32 v42, v34, v35
    v_lshlrev_b32 v34, 16, v42
    v_and_b32 v35, 0xffff0000, v42
    v_cvt_pk_bf16_f32 v42, v36, v37
    v_lshlrev_b32 v36, 16, v42
    v_and_b32 v37, 0xffff0000, v42
    v_cvt_pk_bf16_f32 v42, v38, v39
    v_lshlrev_b32 v38, 16, v42
    v_and_b32 v39, 0xffff0000, v42
    v_mul_f32 v64, v64, v32
    v_mul_f32 v65, v65, v33
    v_mul_f32 v66, v66, v34
    v_mul_f32 v67, v67, v35
    v_mul_f32 v68, v68, v36
    v_mul_f32 v69, v69, v37
    v_mul_f32 v70, v70, v38
    v_mul_f32 v71, v71, v39
    v_cvt_pk_bf16_f32 v42, v64, v65
    v_lshlrev_b32 v64, 16, v42
    v_and_b32 v65, 0xffff0000, v42
    v_cvt_pk_bf16_f32 v42, v66, v67
    v_lshlrev_b32 v66, 16, v42
    v_and_b32 v67, 0xffff0000, v42
    v_cvt_pk_bf16_f32 v42, v68, v69
    v_lshlrev_b32 v68, 16, v42
    v_and_b32 v69, 0xffff0000, v42
    v_cvt_pk_bf16_f32 v42, v70, v71
    v_lshlrev_b32 v70, 16, v42
    v_and_b32 v71, 0xffff0000, v42
    v_add_f32 v64, v64, v24
    v_add_f32 v65, v65, v25
    v_add_f32 v66, v66, v26
    v_add_f32 v67, v67, v27
    v_add_f32 v68, v68, v28
    v_add_f32 v69, v69, v29
    v_add_f32 v70, v70, v30
    v_add_f32 v71, v71, v31
    v_cvt_pk_bf16_f32 v8, v64, v65
    v_cvt_pk_bf16_f32 v9, v66, v67
    v_cvt_pk_bf16_f32 v10, v68, v69
    v_cvt_pk_bf16_f32 v11, v70, v71
    buffer_store_dwordx4 v[8:11], v7, s[16:19], s20 offen
Lln1_end:
    s_endpgm
.globl attn_kernel
.p2align 8
.type attn_kernel,@function
attn_kernel:
    s_cmp_ge_u32 s2, 256
    s_cbranch_scc1 Lattn_end
    s_load_dwordx8 s[52:59], s[0:1], 8
    s_load_dwordx2 s[50:51], s[0:1], 112
    s_load_dwordx4 s[80:83], s[0:1], 56
    s_load_dwordx2 s[84:85], s[0:1], 72
    s_getpc_b64 s[32:33]
Lattn_pc:
    s_mov_b32 s34, Lattn_end-Lattn_pc
    s_mov_b32 s35, 0x20000
    v_lshlrev_b32 v2, 6, v0
    v_lshrrev_b32 v3, 6, v0
    v_and_b32 v1, 63, v0
    v_readfirstlane_b32 s3, v3
    s_mov_b32 s49, 0
    buffer_load_dword v216, v2, s[32:35], s49 offen
    s_mov_b32 s49, 16384
    buffer_load_dword v217, v2, s[32:35], s49 offen
    s_mov_b32 s49, 32768
    buffer_load_dword v218, v2, s[32:35], s49 offen
    s_mov_b32 s49, 49152
    buffer_load_dword v219, v2, s[32:35], s49 offen
    s_and_b32 s4, s2, 7
    s_lshl_b32 s4, s4, 1
    s_bfe_u32 s5, s2, 0x10003
    s_add_u32 s4, s4, s5
    s_lshr_b32 s5, s2, 4
    s_lshl_b32 s42, s3, 12
    v_lshrrev_b32 v2, 4, v1
    v_and_b32 v3, 15, v1
    v_lshlrev_b32 v51, 4, v1
    s_lshl_b32 s6, s5, 2
    s_add_u32 s6, s6, s3
    s_mul_i32 s46, s6, 36864
    s_lshl_b32 s44, s4, 9
    s_mul_i32 s45, s4, 294912
    s_lshl_b32 s7, s3, 4
    v_add_u32 v4, s7, v2
    v_lshlrev_b32 v5, 1, v2
    v_xor_b32 v5, v5, v3
    v_xor_b32 v6, 8, v5
    v_lshlrev_b32 v7, 13, v4
    v_lshl_add_u32 v42, v5, 4, v7
    v_lshl_add_u32 v43, v6, 4, v7
    v_add_u32 v44, 63488, v42
    v_add_u32 v45, 95232, v43
    v_add_u32 v43, 31744, v43
    s_waitcnt lgkmcnt(0)
    s_mov_b32 s16, s56
    s_mov_b32 s17, s57
    s_mov_b32 s18, 4718592
    s_mov_b32 s19, 0x20000
    s_add_u32 s24, s50, 65536
    s_addc_u32 s25, s51, 0
    s_mov_b32 s26, 2359296
    s_mov_b32 s27, 0x20000
    s_add_u32 s49, s46, 0
    buffer_load_dwordx4 a[0:3], v51, s[24:27], s49 offen
    buffer_load_dwordx4 a[8:11], v51, s[24:27], s49 offen offset:1024
    s_add_u32 s49, s46, 18432
    buffer_load_dwordx4 a[4:7], v51, s[24:27], s49 offen
    buffer_load_dwordx4 a[12:15], v51, s[24:27], s49 offen offset:1024
    s_add_u32 s49, s44, 0
    s_add_u32 m0, s42, 32768
    s_nop 0
    buffer_load_dwordx4 v42, s[16:19], s49 offen lds
    buffer_load_dwordx4 v43, s[16:19], s49 offen offset:1024 lds
    buffer_load_dwordx4 v44, s[16:19], s49 offen offset:2048 lds
    buffer_load_dwordx4 v45, s[16:19], s49 offen offset:3072 lds
    s_add_u32 s49, s44, 256
    s_add_u32 m0, s42, 49152
    s_nop 0
    buffer_load_dwordx4 v42, s[16:19], s49 offen lds
    buffer_load_dwordx4 v43, s[16:19], s49 offen offset:1024 lds
    buffer_load_dwordx4 v44, s[16:19], s49 offen offset:2048 lds
    buffer_load_dwordx4 v45, s[16:19], s49 offen offset:3072 lds
    s_add_u32 s49, s46, 2048
    buffer_load_dwordx4 a[16:19], v51, s[24:27], s49 offen
    buffer_load_dwordx4 a[24:27], v51, s[24:27], s49 offen offset:1024
    s_add_u32 s49, s46, 20480
    buffer_load_dwordx4 a[20:23], v51, s[24:27], s49 offen
    buffer_load_dwordx4 a[28:31], v51, s[24:27], s49 offen offset:1024
    s_add_u32 s49, s44, 524288
    s_add_u32 m0, s42, 65536
    s_nop 0
    buffer_load_dwordx4 v42, s[16:19], s49 offen lds
    buffer_load_dwordx4 v43, s[16:19], s49 offen offset:1024 lds
    buffer_load_dwordx4 v44, s[16:19], s49 offen offset:2048 lds
    buffer_load_dwordx4 v45, s[16:19], s49 offen offset:3072 lds
    s_add_u32 s49, s44, 524544
    s_add_u32 m0, s42, 81920
    s_nop 0
    buffer_load_dwordx4 v42, s[16:19], s49 offen lds
    buffer_load_dwordx4 v43, s[16:19], s49 offen offset:1024 lds
    buffer_load_dwordx4 v44, s[16:19], s49 offen offset:2048 lds
    buffer_load_dwordx4 v45, s[16:19], s49 offen offset:3072 lds
    s_add_u32 s49, s46, 4096
    buffer_load_dwordx4 a[32:35], v51, s[24:27], s49 offen
    buffer_load_dwordx4 a[40:43], v51, s[24:27], s49 offen offset:1024
    s_add_u32 s49, s46, 22528
    buffer_load_dwordx4 a[36:39], v51, s[24:27], s49 offen
    buffer_load_dwordx4 a[44:47], v51, s[24:27], s49 offen offset:1024
    s_add_u32 s49, s44, 1048576
    s_add_u32 m0, s42, 98304
    s_nop 0
    buffer_load_dwordx4 v42, s[16:19], s49 offen lds
    buffer_load_dwordx4 v43, s[16:19], s49 offen offset:1024 lds
    buffer_load_dwordx4 v44, s[16:19], s49 offen offset:2048 lds
    buffer_load_dwordx4 v45, s[16:19], s49 offen offset:3072 lds
    s_add_u32 s49, s44, 1048832
    s_add_u32 m0, s42, 114688
    s_nop 0
    buffer_load_dwordx4 v42, s[16:19], s49 offen lds
    buffer_load_dwordx4 v43, s[16:19], s49 offen offset:1024 lds
    buffer_load_dwordx4 v44, s[16:19], s49 offen offset:2048 lds
    buffer_load_dwordx4 v45, s[16:19], s49 offen offset:3072 lds
    s_add_u32 s49, s46, 6144
    buffer_load_dwordx4 a[48:51], v51, s[24:27], s49 offen
    buffer_load_dwordx4 a[56:59], v51, s[24:27], s49 offen offset:1024
    s_add_u32 s49, s46, 24576
    buffer_load_dwordx4 a[52:55], v51, s[24:27], s49 offen
    buffer_load_dwordx4 a[60:63], v51, s[24:27], s49 offen offset:1024
    s_add_u32 s49, s44, 1572864
    s_add_u32 m0, s42, 131072
    s_nop 0
    buffer_load_dwordx4 v42, s[16:19], s49 offen lds
    buffer_load_dwordx4 v43, s[16:19], s49 offen offset:1024 lds
    buffer_load_dwordx4 v44, s[16:19], s49 offen offset:2048 lds
    buffer_load_dwordx4 v45, s[16:19], s49 offen offset:3072 lds
    s_add_u32 s49, s44, 1573120
    s_add_u32 m0, s42, 147456
    s_nop 0
    buffer_load_dwordx4 v42, s[16:19], s49 offen lds
    buffer_load_dwordx4 v43, s[16:19], s49 offen offset:1024 lds
    buffer_load_dwordx4 v44, s[16:19], s49 offen offset:2048 lds
    buffer_load_dwordx4 v45, s[16:19], s49 offen offset:3072 lds
    s_lshl_b32 s7, s4, 19
    s_add_u32 s8, s52, s7
    s_addc_u32 s9, s53, 0
    s_mov_b32 s10, 524288
    s_mov_b32 s11, 0x20000
    s_add_u32 s12, s54, s7
    s_addc_u32 s13, s55, 0
    s_mov_b32 s14, 524288
    s_mov_b32 s15, 0x20000
    s_mov_b32 s20, s58
    s_mov_b32 s21, s59
    s_mov_b32 s22, 4718592
    s_mov_b32 s23, 0x20000
    s_add_u32 s28, s50, 10485760
    s_addc_u32 s29, s51, 0
    s_mov_b32 s30, 37748736
    s_mov_b32 s31, 0x20000
    v_lshlrev_b32 v7, 8, v4
    v_lshl_add_u32 v40, v5, 4, v7
    v_lshl_add_u32 v41, v6, 4, v7
    v_xor_b32 v224, v3, v2
    v_lshl_add_u32 v36, v224, 4, v7
    v_xor_b32 v37, 64, v36
    v_xor_b32 v38, 128, v36
    v_xor_b32 v39, 192, v36
    v_lshrrev_b32 v7, 3, v5
    v_lshl_add_u32 v7, v7, 7, v4
    v_mul_u32_u24 v7, 1152, v7
    v_and_b32 v225, 7, v5
    v_lshl_add_u32 v46, v225, 4, v7
    v_lshrrev_b32 v7, 3, v6
    v_lshl_add_u32 v7, v7, 7, v4
    v_mul_u32_u24 v7, 1152, v7
    v_and_b32 v225, 7, v6
    v_lshl_add_u32 v47, v225, 4, v7
    v_add_u32 v48, 7168, v46
    v_add_u32 v49, 10752, v47
    v_add_u32 v47, 3584, v47
    v_lshlrev_b32 v7, 8, v3
    v_lshl_add_u32 v8, v224, 4, v7
    v_xor_b32 v9, 64, v8
    v_xor_b32 v10, 128, v8
    v_xor_b32 v11, 192, v8
    v_lshrrev_b32 v5, 2, v1
    v_and_b32 v6, 7, v5
    v_lshlrev_b32 v6, 5, v6
    v_lshl_add_u32 v6, v5, 8, v6
    v_and_b32 v7, 3, v1
    v_lshl_add_u32 v12, v7, 3, v6
    v_xor_b32 v13, 32, v12
    v_xor_b32 v14, 64, v12
    v_xor_b32 v15, 96, v12
    v_xor_b32 v16, 128, v12
    v_xor_b32 v17, 160, v12
    v_xor_b32 v18, 192, v12
    v_xor_b32 v19, 224, v12
    v_add_u32 v20, 65536, v12
    v_add_u32 v21, 65536, v13
    v_add_u32 v22, 65536, v14
    v_add_u32 v23, 65536, v15
    v_add_u32 v24, 65536, v16
    v_add_u32 v25, 65536, v17
    v_add_u32 v26, 65536, v18
    v_add_u32 v27, 65536, v19
    v_add_u32 v28, 131072, v12
    v_add_u32 v29, 131072, v13
    v_add_u32 v30, 131072, v14
    v_add_u32 v31, 131072, v15
    v_add_u32 v32, 131072, v16
    v_add_u32 v33, 131072, v17
    v_add_u32 v34, 131072, v18
    v_add_u32 v35, 131072, v19
    v_mov_b32 v52, 0x3f803f80
    v_mov_b32 v53, 0x3f803f80
    v_mov_b32 v54, 0x3f803f80
    v_mov_b32 v55, 0x3f803f80
    v_and_b32 v5, 1, v1
    v_mul_u32_u24 v5, 0xaaaa, v5
    v_add_u32 v5, 0x4444, v5
    v_lshl_add_u32 v50, v5, 16, v5
    v_lshrrev_b32 v5, 3, v3
    v_mul_u32_u24 v5, 147456, v5
    v_lshl_add_u32 v5, v2, 7, v5
    v_and_b32 v6, 7, v3
    v_lshl_add_u32 v56, v6, 4, v5
    s_mul_i32 s47, s6, 589824
    s_mul_i32 s7, s4, 9216
    s_add_u32 s47, s47, s7
    s_mov_b32 s32, s82
    s_mov_b32 s33, s83
    s_mov_b32 s34, 5308416
    s_mov_b32 s35, 0x20000
    s_mov_b32 s82, 5308416
    s_mov_b32 s83, 0x20000
    s_mov_b32 s86, 5308416
    s_mov_b32 s87, 0x20000
    s_lshl_b32 s7, s2, 2
    s_add_u32 s7, s7, s3
    s_mul_i32 s7, s7, 768
    v_min_u32 v5, 11, v1
    v_lshl_add_u32 v57, v5, 6, s7
    s_mov_b32 s39, 0
    s_mov_b32 s40, 0
    s_mov_b32 s41, 0
    s_mov_b32 s48, 0
    s_waitcnt vmcnt(36)
    s_barrier
    ds_read_b64_tr_b16 a[160:161], v12 offset:32768
    ds_read_b64_tr_b16 a[162:163], v12 offset:36864
    ds_read_b64_tr_b16 a[164:165], v12 offset:40960
    ds_read_b64_tr_b16 a[166:167], v12 offset:45056
    ds_read_b64_tr_b16 a[168:169], v13 offset:32768
    ds_read_b64_tr_b16 a[170:171], v13 offset:36864
    ds_read_b64_tr_b16 a[172:173], v13 offset:40960
    ds_read_b64_tr_b16 a[174:175], v13 offset:45056
    ds_read_b64_tr_b16 a[176:177], v14 offset:32768
    ds_read_b64_tr_b16 a[178:179], v14 offset:36864
    ds_read_b64_tr_b16 a[180:181], v14 offset:40960
    ds_read_b64_tr_b16 a[182:183], v14 offset:45056
    s_waitcnt lgkmcnt(10)
    v_mfma_f32_16x16x32_bf16 v[128:131], a[160:163], a[0:3], 0
    s_waitcnt lgkmcnt(8)
    ds_read_b64_tr_b16 a[184:185], v15 offset:32768
    v_mfma_f32_16x16x32_bf16 v[128:131], a[164:167], a[8:11], v[128:131]
    ds_read_b64_tr_b16 a[186:187], v15 offset:36864
    v_mfma_f32_16x16x32_bf16 v[132:135], a[160:163], a[4:7], 0
    s_add_u32 s49, s46, 8192
    ds_read_b64_tr_b16 a[188:189], v15 offset:40960
    v_mfma_f32_16x16x32_bf16 v[132:135], a[164:167], a[12:15], v[132:135]
    s_waitcnt lgkmcnt(9)
    ds_read_b64_tr_b16 a[190:191], v15 offset:45056
    buffer_load_dwordx4 a[64:67], v51, s[24:27], s49 offen
    v_mfma_f32_16x16x32_bf16 v[136:139], a[168:171], a[0:3], 0
    s_waitcnt lgkmcnt(8)
    ds_read_b64_tr_b16 a[160:161], v16 offset:32768
    v_mfma_f32_16x16x32_bf16 v[136:139], a[172:175], a[8:11], v[136:139]
    ds_read_b64_tr_b16 a[162:163], v16 offset:36864
    v_mfma_f32_16x16x32_bf16 v[140:143], a[168:171], a[4:7], 0
    ds_read_b64_tr_b16 a[164:165], v16 offset:40960
    v_mfma_f32_16x16x32_bf16 v[140:143], a[172:175], a[12:15], v[140:143]
    s_waitcnt lgkmcnt(9)
    ds_read_b64_tr_b16 a[166:167], v16 offset:45056
    buffer_load_dwordx4 a[72:75], v51, s[24:27], s49 offen offset:1024
    v_mfma_f32_16x16x32_bf16 v[144:147], a[176:179], a[0:3], 0
    s_waitcnt lgkmcnt(8)
    ds_read_b64_tr_b16 a[168:169], v17 offset:32768
    v_mfma_f32_16x16x32_bf16 v[144:147], a[180:183], a[8:11], v[144:147]
    ds_read_b64_tr_b16 a[170:171], v17 offset:36864
    v_mfma_f32_16x16x32_bf16 v[148:151], a[176:179], a[4:7], 0
    s_add_u32 s49, s46, 26624
    ds_read_b64_tr_b16 a[172:173], v17 offset:40960
    v_mfma_f32_16x16x32_bf16 v[148:151], a[180:183], a[12:15], v[148:151]
    s_waitcnt lgkmcnt(9)
    ds_read_b64_tr_b16 a[174:175], v17 offset:45056
    buffer_load_dwordx4 a[68:71], v51, s[24:27], s49 offen
    v_mfma_f32_16x16x32_bf16 v[152:155], a[184:187], a[0:3], 0
    s_waitcnt lgkmcnt(8)
    ds_read_b64_tr_b16 a[176:177], v18 offset:32768
    v_mfma_f32_16x16x32_bf16 v[152:155], a[188:191], a[8:11], v[152:155]
    ds_read_b64_tr_b16 a[178:179], v18 offset:36864
    v_mfma_f32_16x16x32_bf16 v[156:159], a[184:187], a[4:7], 0
    ds_read_b64_tr_b16 a[180:181], v18 offset:40960
    v_mfma_f32_16x16x32_bf16 v[156:159], a[188:191], a[12:15], v[156:159]
    s_waitcnt lgkmcnt(9)
    ds_read_b64_tr_b16 a[182:183], v18 offset:45056
    buffer_load_dwordx4 a[76:79], v51, s[24:27], s49 offen offset:1024
    v_mfma_f32_16x16x32_bf16 v[160:163], a[160:163], a[0:3], 0
    s_waitcnt lgkmcnt(8)
    ds_read_b64_tr_b16 a[184:185], v19 offset:32768
    v_mfma_f32_16x16x32_bf16 v[160:163], a[164:167], a[8:11], v[160:163]
    s_add_u32 s49, s44, 2097152
    ds_read_b64_tr_b16 a[186:187], v19 offset:36864
    v_mfma_f32_16x16x32_bf16 v[164:167], a[160:163], a[4:7], 0
    s_add_u32 m0, s42, 0
    ds_read_b64_tr_b16 a[188:189], v19 offset:40960
    v_mfma_f32_16x16x32_bf16 v[164:167], a[164:167], a[12:15], v[164:167]
    s_waitcnt lgkmcnt(9)
    ds_read_b64_tr_b16 a[190:191], v19 offset:45056
    buffer_load_dwordx4 v42, s[16:19], s49 offen lds
    v_mfma_f32_16x16x32_bf16 v[168:171], a[168:171], a[0:3], 0
    s_waitcnt lgkmcnt(8)
    ds_read_b64_tr_b16 a[160:161], v12 offset:49152
    v_mfma_f32_16x16x32_bf16 v[168:171], a[172:175], a[8:11], v[168:171]
    ds_read_b64_tr_b16 a[162:163], v12 offset:53248
    v_mfma_f32_16x16x32_bf16 v[172:175], a[168:171], a[4:7], 0
    ds_read_b64_tr_b16 a[164:165], v12 offset:57344
    v_mfma_f32_16x16x32_bf16 v[172:175], a[172:175], a[12:15], v[172:175]
    s_waitcnt lgkmcnt(9)
    ds_read_b64_tr_b16 a[166:167], v12 offset:61440
    buffer_load_dwordx4 v43, s[16:19], s49 offen offset:1024 lds
    v_mfma_f32_16x16x32_bf16 v[176:179], a[176:179], a[0:3], 0
    s_waitcnt lgkmcnt(8)
    ds_read_b64_tr_b16 a[168:169], v13 offset:49152
    v_mfma_f32_16x16x32_bf16 v[176:179], a[180:183], a[8:11], v[176:179]
    ds_read_b64_tr_b16 a[170:171], v13 offset:53248
    v_mfma_f32_16x16x32_bf16 v[180:183], a[176:179], a[4:7], 0
    ds_read_b64_tr_b16 a[172:173], v13 offset:57344
    v_mfma_f32_16x16x32_bf16 v[180:183], a[180:183], a[12:15], v[180:183]
    s_waitcnt lgkmcnt(9)
    ds_read_b64_tr_b16 a[174:175], v13 offset:61440
    buffer_load_dwordx4 v44, s[16:19], s49 offen offset:2048 lds
    v_mfma_f32_16x16x32_bf16 v[184:187], a[184:187], a[0:3], 0
    s_waitcnt lgkmcnt(8)
    ds_read_b64_tr_b16 a[176:177], v14 offset:49152
    v_mfma_f32_16x16x32_bf16 v[184:187], a[188:191], a[8:11], v[184:187]
    ds_read_b64_tr_b16 a[178:179], v14 offset:53248
    v_mfma_f32_16x16x32_bf16 v[188:191], a[184:187], a[4:7], 0
    ds_read_b64_tr_b16 a[180:181], v14 offset:57344
    v_mfma_f32_16x16x32_bf16 v[188:191], a[188:191], a[12:15], v[188:191]
    s_waitcnt lgkmcnt(9)
    ds_read_b64_tr_b16 a[182:183], v14 offset:61440
    buffer_load_dwordx4 v45, s[16:19], s49 offen offset:3072 lds
    v_mfma_f32_16x16x32_bf16 v[192:195], a[160:163], a[0:3], 0
    s_waitcnt lgkmcnt(8)
    ds_read_b64_tr_b16 a[184:185], v15 offset:49152
    v_mfma_f32_16x16x32_bf16 v[192:195], a[164:167], a[8:11], v[192:195]
    s_add_u32 s49, s44, 2097408
    ds_read_b64_tr_b16 a[186:187], v15 offset:53248
    v_mfma_f32_16x16x32_bf16 v[196:199], a[160:163], a[4:7], 0
    s_add_u32 m0, s42, 16384
    ds_read_b64_tr_b16 a[188:189], v15 offset:57344
    v_mfma_f32_16x16x32_bf16 v[196:199], a[164:167], a[12:15], v[196:199]
    s_waitcnt lgkmcnt(9)
    ds_read_b64_tr_b16 a[190:191], v15 offset:61440
    buffer_load_dwordx4 v42, s[16:19], s49 offen lds
    v_mfma_f32_16x16x32_bf16 v[200:203], a[168:171], a[0:3], 0
    s_waitcnt lgkmcnt(8)
    ds_read_b64_tr_b16 a[160:161], v16 offset:49152
    v_mfma_f32_16x16x32_bf16 v[200:203], a[172:175], a[8:11], v[200:203]
    ds_read_b64_tr_b16 a[162:163], v16 offset:53248
    v_mfma_f32_16x16x32_bf16 v[204:207], a[168:171], a[4:7], 0
    ds_read_b64_tr_b16 a[164:165], v16 offset:57344
    v_mfma_f32_16x16x32_bf16 v[204:207], a[172:175], a[12:15], v[204:207]
    s_waitcnt lgkmcnt(9)
    ds_read_b64_tr_b16 a[166:167], v16 offset:61440
    buffer_load_dwordx4 v43, s[16:19], s49 offen offset:1024 lds
    v_mfma_f32_16x16x32_bf16 v[208:211], a[176:179], a[0:3], 0
    s_waitcnt lgkmcnt(8)
    ds_read_b64_tr_b16 a[168:169], v17 offset:49152
    v_mfma_f32_16x16x32_bf16 v[208:211], a[180:183], a[8:11], v[208:211]
    ds_read_b64_tr_b16 a[170:171], v17 offset:53248
    v_mfma_f32_16x16x32_bf16 v[212:215], a[176:179], a[4:7], 0
    ds_read_b64_tr_b16 a[172:173], v17 offset:57344
    v_mfma_f32_16x16x32_bf16 v[212:215], a[180:183], a[12:15], v[212:215]
    s_waitcnt lgkmcnt(9)
    ds_read_b64_tr_b16 a[174:175], v17 offset:61440
    buffer_load_dwordx4 v44, s[16:19], s49 offen offset:2048 lds
    v_mfma_f32_16x16x32_bf16 v[216:219], a[184:187], a[0:3], 0
    s_waitcnt lgkmcnt(8)
    ds_read_b64_tr_b16 a[176:177], v18 offset:49152
    v_mfma_f32_16x16x32_bf16 v[216:219], a[188:191], a[8:11], v[216:219]
    ds_read_b64_tr_b16 a[178:179], v18 offset:53248
    v_mfma_f32_16x16x32_bf16 v[220:223], a[184:187], a[4:7], 0
    ds_read_b64_tr_b16 a[180:181], v18 offset:57344
    v_mfma_f32_16x16x32_bf16 v[220:223], a[188:191], a[12:15], v[220:223]
    s_waitcnt lgkmcnt(9)
    ds_read_b64_tr_b16 a[182:183], v18 offset:61440
    buffer_load_dwordx4 v45, s[16:19], s49 offen offset:3072 lds
    v_mfma_f32_16x16x32_bf16 v[224:227], a[160:163], a[0:3], 0
    s_waitcnt lgkmcnt(8)
    ds_read_b64_tr_b16 a[184:185], v19 offset:49152
    v_mfma_f32_16x16x32_bf16 v[224:227], a[164:167], a[8:11], v[224:227]
    ds_read_b64_tr_b16 a[186:187], v19 offset:53248
    v_mfma_f32_16x16x32_bf16 v[228:231], a[160:163], a[4:7], 0
    ds_read_b64_tr_b16 a[188:189], v19 offset:57344
    v_mfma_f32_16x16x32_bf16 v[228:231], a[164:167], a[12:15], v[228:231]
    s_waitcnt lgkmcnt(9)
    ds_read_b64_tr_b16 a[190:191], v19 offset:61440
    s_waitcnt vmcnt(36)
    s_barrier
    v_mfma_f32_16x16x32_bf16 v[232:235], a[168:171], a[0:3], 0
    s_waitcnt lgkmcnt(8)
    ds_read_b64_tr_b16 a[160:161], v20 offset:0
    v_mfma_f32_16x16x32_bf16 v[232:235], a[172:175], a[8:11], v[232:235]
    ds_read_b64_tr_b16 a[162:163], v20 offset:4096
    v_mfma_f32_16x16x32_bf16 v[236:239], a[168:171], a[4:7], 0
    ds_read_b64_tr_b16 a[164:165], v20 offset:8192
    v_mfma_f32_16x16x32_bf16 v[236:239], a[172:175], a[12:15], v[236:239]
    s_waitcnt lgkmcnt(9)
    ds_read_b64_tr_b16 a[166:167], v20 offset:12288
    v_mfma_f32_16x16x32_bf16 v[240:243], a[176:179], a[0:3], 0
    s_waitcnt lgkmcnt(8)
    ds_read_b64_tr_b16 a[168:169], v21 offset:0
    v_mfma_f32_16x16x32_bf16 v[240:243], a[180:183], a[8:11], v[240:243]
    ds_read_b64_tr_b16 a[170:171], v21 offset:4096
    v_mfma_f32_16x16x32_bf16 v[244:247], a[176:179], a[4:7], 0
    ds_read_b64_tr_b16 a[172:173], v21 offset:8192
    v_mfma_f32_16x16x32_bf16 v[244:247], a[180:183], a[12:15], v[244:247]
    s_waitcnt lgkmcnt(9)
    ds_read_b64_tr_b16 a[174:175], v21 offset:12288
    v_mfma_f32_16x16x32_bf16 v[248:251], a[184:187], a[0:3], 0
    s_waitcnt lgkmcnt(8)
    ds_read_b64_tr_b16 a[176:177], v22 offset:0
    v_mfma_f32_16x16x32_bf16 v[248:251], a[188:191], a[8:11], v[248:251]
    ds_read_b64_tr_b16 a[178:179], v22 offset:4096
    v_mfma_f32_16x16x32_bf16 v[252:255], a[184:187], a[4:7], 0
    ds_read_b64_tr_b16 a[180:181], v22 offset:8192
    v_mfma_f32_16x16x32_bf16 v[252:255], a[188:191], a[12:15], v[252:255]
    s_waitcnt lgkmcnt(9)
    ds_read_b64_tr_b16 a[182:183], v22 offset:12288
    v_mfma_f32_16x16x32_bf16 v[128:131], a[160:163], a[16:19], v[128:131]
    s_waitcnt lgkmcnt(8)
    ds_read_b64_tr_b16 a[184:185], v23 offset:0
    v_mfma_f32_16x16x32_bf16 v[128:131], a[164:167], a[24:27], v[128:131]
    ds_read_b64_tr_b16 a[186:187], v23 offset:4096
    v_mfma_f32_16x16x32_bf16 v[132:135], a[160:163], a[20:23], v[132:135]
    ds_read_b64_tr_b16 a[188:189], v23 offset:8192
    v_mfma_f32_16x16x32_bf16 v[132:135], a[164:167], a[28:31], v[132:135]
    s_waitcnt lgkmcnt(9)
    ds_read_b64_tr_b16 a[190:191], v23 offset:12288
    v_mfma_f32_16x16x32_bf16 v[136:139], a[168:171], a[16:19], v[136:139]
    s_waitcnt lgkmcnt(8)
    ds_read_b64_tr_b16 a[160:161], v24 offset:0
    v_mfma_f32_16x16x32_bf16 v[136:139], a[172:175], a[24:27], v[136:139]
    ds_read_b64_tr_b16 a[162:163], v24 offset:4096
    v_mfma_f32_16x16x32_bf16 v[140:143], a[168:171], a[20:23], v[140:143]
    ds_read_b64_tr_b16 a[164:165], v24 offset:8192
    v_mfma_f32_16x16x32_bf16 v[140:143], a[172:175], a[28:31], v[140:143]
    s_waitcnt lgkmcnt(9)
    ds_read_b64_tr_b16 a[166:167], v24 offset:12288
    v_mfma_f32_16x16x32_bf16 v[144:147], a[176:179], a[16:19], v[144:147]
    s_waitcnt lgkmcnt(8)
    ds_read_b64_tr_b16 a[168:169], v25 offset:0
    v_mfma_f32_16x16x32_bf16 v[144:147], a[180:183], a[24:27], v[144:147]
    ds_read_b64_tr_b16 a[170:171], v25 offset:4096
    v_mfma_f32_16x16x32_bf16 v[148:151], a[176:179], a[20:23], v[148:151]
    ds_read_b64_tr_b16 a[172:173], v25 offset:8192
    v_mfma_f32_16x16x32_bf16 v[148:151], a[180:183], a[28:31], v[148:151]
    s_waitcnt lgkmcnt(9)
    ds_read_b64_tr_b16 a[174:175], v25 offset:12288
    v_mfma_f32_16x16x32_bf16 v[152:155], a[184:187], a[16:19], v[152:155]
    s_waitcnt lgkmcnt(8)
    ds_read_b64_tr_b16 a[176:177], v26 offset:0
    v_mfma_f32_16x16x32_bf16 v[152:155], a[188:191], a[24:27], v[152:155]
    ds_read_b64_tr_b16 a[178:179], v26 offset:4096
    v_mfma_f32_16x16x32_bf16 v[156:159], a[184:187], a[20:23], v[156:159]
    ds_read_b64_tr_b16 a[180:181], v26 offset:8192
    v_mfma_f32_16x16x32_bf16 v[156:159], a[188:191], a[28:31], v[156:159]
    s_waitcnt lgkmcnt(9)
    ds_read_b64_tr_b16 a[182:183], v26 offset:12288
    v_mfma_f32_16x16x32_bf16 v[160:163], a[160:163], a[16:19], v[160:163]
    s_waitcnt lgkmcnt(8)
    ds_read_b64_tr_b16 a[184:185], v27 offset:0
    v_mfma_f32_16x16x32_bf16 v[160:163], a[164:167], a[24:27], v[160:163]
    ds_read_b64_tr_b16 a[186:187], v27 offset:4096
    v_mfma_f32_16x16x32_bf16 v[164:167], a[160:163], a[20:23], v[164:167]
    ds_read_b64_tr_b16 a[188:189], v27 offset:8192
    v_mfma_f32_16x16x32_bf16 v[164:167], a[164:167], a[28:31], v[164:167]
    s_waitcnt lgkmcnt(9)
    ds_read_b64_tr_b16 a[190:191], v27 offset:12288
    v_mfma_f32_16x16x32_bf16 v[168:171], a[168:171], a[16:19], v[168:171]
    s_waitcnt lgkmcnt(8)
    ds_read_b64_tr_b16 a[160:161], v20 offset:16384
    v_mfma_f32_16x16x32_bf16 v[168:171], a[172:175], a[24:27], v[168:171]
    ds_read_b64_tr_b16 a[162:163], v20 offset:20480
    v_mfma_f32_16x16x32_bf16 v[172:175], a[168:171], a[20:23], v[172:175]
    ds_read_b64_tr_b16 a[164:165], v20 offset:24576
    v_mfma_f32_16x16x32_bf16 v[172:175], a[172:175], a[28:31], v[172:175]
    s_waitcnt lgkmcnt(9)
    ds_read_b64_tr_b16 a[166:167], v20 offset:28672
    v_mfma_f32_16x16x32_bf16 v[176:179], a[176:179], a[16:19], v[176:179]
    s_waitcnt lgkmcnt(8)
    ds_read_b64_tr_b16 a[168:169], v21 offset:16384
    v_mfma_f32_16x16x32_bf16 v[176:179], a[180:183], a[24:27], v[176:179]
    ds_read_b64_tr_b16 a[170:171], v21 offset:20480
    v_mfma_f32_16x16x32_bf16 v[180:183], a[176:179], a[20:23], v[180:183]
    ds_read_b64_tr_b16 a[172:173], v21 offset:24576
    v_mfma_f32_16x16x32_bf16 v[180:183], a[180:183], a[28:31], v[180:183]
    s_waitcnt lgkmcnt(9)
    ds_read_b64_tr_b16 a[174:175], v21 offset:28672
    v_mfma_f32_16x16x32_bf16 v[184:187], a[184:187], a[16:19], v[184:187]
    s_waitcnt lgkmcnt(8)
    ds_read_b64_tr_b16 a[176:177], v22 offset:16384
    v_mfma_f32_16x16x32_bf16 v[184:187], a[188:191], a[24:27], v[184:187]
    ds_read_b64_tr_b16 a[178:179], v22 offset:20480
    v_mfma_f32_16x16x32_bf16 v[188:191], a[184:187], a[20:23], v[188:191]
    ds_read_b64_tr_b16 a[180:181], v22 offset:24576
    v_mfma_f32_16x16x32_bf16 v[188:191], a[188:191], a[28:31], v[188:191]
    s_waitcnt lgkmcnt(9)
    ds_read_b64_tr_b16 a[182:183], v22 offset:28672
    v_mfma_f32_16x16x32_bf16 v[192:195], a[160:163], a[16:19], v[192:195]
    s_waitcnt lgkmcnt(8)
    ds_read_b64_tr_b16 a[184:185], v23 offset:16384
    v_mfma_f32_16x16x32_bf16 v[192:195], a[164:167], a[24:27], v[192:195]
    ds_read_b64_tr_b16 a[186:187], v23 offset:20480
    v_mfma_f32_16x16x32_bf16 v[196:199], a[160:163], a[20:23], v[196:199]
    ds_read_b64_tr_b16 a[188:189], v23 offset:24576
    v_mfma_f32_16x16x32_bf16 v[196:199], a[164:167], a[28:31], v[196:199]
    s_waitcnt lgkmcnt(9)
    ds_read_b64_tr_b16 a[190:191], v23 offset:28672
    v_mfma_f32_16x16x32_bf16 v[200:203], a[168:171], a[16:19], v[200:203]
    s_waitcnt lgkmcnt(8)
    ds_read_b64_tr_b16 a[160:161], v24 offset:16384
    v_mfma_f32_16x16x32_bf16 v[200:203], a[172:175], a[24:27], v[200:203]
    ds_read_b64_tr_b16 a[162:163], v24 offset:20480
    v_mfma_f32_16x16x32_bf16 v[204:207], a[168:171], a[20:23], v[204:207]
    ds_read_b64_tr_b16 a[164:165], v24 offset:24576
    v_mfma_f32_16x16x32_bf16 v[204:207], a[172:175], a[28:31], v[204:207]
    s_waitcnt lgkmcnt(9)
    ds_read_b64_tr_b16 a[166:167], v24 offset:28672
    v_mfma_f32_16x16x32_bf16 v[208:211], a[176:179], a[16:19], v[208:211]
    s_waitcnt lgkmcnt(8)
    ds_read_b64_tr_b16 a[168:169], v25 offset:16384
    v_mfma_f32_16x16x32_bf16 v[208:211], a[180:183], a[24:27], v[208:211]
    ds_read_b64_tr_b16 a[170:171], v25 offset:20480
    v_mfma_f32_16x16x32_bf16 v[212:215], a[176:179], a[20:23], v[212:215]
    ds_read_b64_tr_b16 a[172:173], v25 offset:24576
    v_mfma_f32_16x16x32_bf16 v[212:215], a[180:183], a[28:31], v[212:215]
    s_waitcnt lgkmcnt(9)
    ds_read_b64_tr_b16 a[174:175], v25 offset:28672
    v_mfma_f32_16x16x32_bf16 v[216:219], a[184:187], a[16:19], v[216:219]
    s_waitcnt lgkmcnt(8)
    ds_read_b64_tr_b16 a[176:177], v26 offset:16384
    v_mfma_f32_16x16x32_bf16 v[216:219], a[188:191], a[24:27], v[216:219]
    ds_read_b64_tr_b16 a[178:179], v26 offset:20480
    v_mfma_f32_16x16x32_bf16 v[220:223], a[184:187], a[20:23], v[220:223]
    ds_read_b64_tr_b16 a[180:181], v26 offset:24576
    v_mfma_f32_16x16x32_bf16 v[220:223], a[188:191], a[28:31], v[220:223]
    s_waitcnt lgkmcnt(9)
    ds_read_b64_tr_b16 a[182:183], v26 offset:28672
    v_mfma_f32_16x16x32_bf16 v[224:227], a[160:163], a[16:19], v[224:227]
    s_waitcnt lgkmcnt(8)
    ds_read_b64_tr_b16 a[184:185], v27 offset:16384
    v_mfma_f32_16x16x32_bf16 v[224:227], a[164:167], a[24:27], v[224:227]
    ds_read_b64_tr_b16 a[186:187], v27 offset:20480
    v_mfma_f32_16x16x32_bf16 v[228:231], a[160:163], a[20:23], v[228:231]
    ds_read_b64_tr_b16 a[188:189], v27 offset:24576
    v_mfma_f32_16x16x32_bf16 v[228:231], a[164:167], a[28:31], v[228:231]
    s_waitcnt lgkmcnt(9)
    ds_read_b64_tr_b16 a[190:191], v27 offset:28672
    s_waitcnt vmcnt(24)
    s_barrier
    v_mfma_f32_16x16x32_bf16 v[232:235], a[168:171], a[16:19], v[232:235]
    s_waitcnt lgkmcnt(8)
    ds_read_b64_tr_b16 a[160:161], v20 offset:32768
    v_mfma_f32_16x16x32_bf16 v[232:235], a[172:175], a[24:27], v[232:235]
    ds_read_b64_tr_b16 a[162:163], v20 offset:36864
    v_mfma_f32_16x16x32_bf16 v[236:239], a[168:171], a[20:23], v[236:239]
    s_add_u32 s49, s46, 10240
    ds_read_b64_tr_b16 a[164:165], v20 offset:40960
    v_mfma_f32_16x16x32_bf16 v[236:239], a[172:175], a[28:31], v[236:239]
    s_waitcnt lgkmcnt(9)
    ds_read_b64_tr_b16 a[166:167], v20 offset:45056
    buffer_load_dwordx4 a[80:83], v51, s[24:27], s49 offen
    v_mfma_f32_16x16x32_bf16 v[240:243], a[176:179], a[16:19], v[240:243]
    s_waitcnt lgkmcnt(8)
    ds_read_b64_tr_b16 a[168:169], v21 offset:32768
    v_mfma_f32_16x16x32_bf16 v[240:243], a[180:183], a[24:27], v[240:243]
    ds_read_b64_tr_b16 a[170:171], v21 offset:36864
    v_mfma_f32_16x16x32_bf16 v[244:247], a[176:179], a[20:23], v[244:247]
    ds_read_b64_tr_b16 a[172:173], v21 offset:40960
    v_mfma_f32_16x16x32_bf16 v[244:247], a[180:183], a[28:31], v[244:247]
    s_waitcnt lgkmcnt(9)
    ds_read_b64_tr_b16 a[174:175], v21 offset:45056
    buffer_load_dwordx4 a[88:91], v51, s[24:27], s49 offen offset:1024
    v_mfma_f32_16x16x32_bf16 v[248:251], a[184:187], a[16:19], v[248:251]
    s_waitcnt lgkmcnt(8)
    ds_read_b64_tr_b16 a[176:177], v22 offset:32768
    v_mfma_f32_16x16x32_bf16 v[248:251], a[188:191], a[24:27], v[248:251]
    ds_read_b64_tr_b16 a[178:179], v22 offset:36864
    v_mfma_f32_16x16x32_bf16 v[252:255], a[184:187], a[20:23], v[252:255]
    s_add_u32 s49, s46, 28672
    ds_read_b64_tr_b16 a[180:181], v22 offset:40960
    v_mfma_f32_16x16x32_bf16 v[252:255], a[188:191], a[28:31], v[252:255]
    s_waitcnt lgkmcnt(9)
    ds_read_b64_tr_b16 a[182:183], v22 offset:45056
    buffer_load_dwordx4 a[84:87], v51, s[24:27], s49 offen
    v_mfma_f32_16x16x32_bf16 v[128:131], a[160:163], a[32:35], v[128:131]
    s_waitcnt lgkmcnt(8)
    ds_read_b64_tr_b16 a[184:185], v23 offset:32768
    v_mfma_f32_16x16x32_bf16 v[128:131], a[164:167], a[40:43], v[128:131]
    ds_read_b64_tr_b16 a[186:187], v23 offset:36864
    v_mfma_f32_16x16x32_bf16 v[132:135], a[160:163], a[36:39], v[132:135]
    ds_read_b64_tr_b16 a[188:189], v23 offset:40960
    v_mfma_f32_16x16x32_bf16 v[132:135], a[164:167], a[44:47], v[132:135]
    s_waitcnt lgkmcnt(9)
    ds_read_b64_tr_b16 a[190:191], v23 offset:45056
    buffer_load_dwordx4 a[92:95], v51, s[24:27], s49 offen offset:1024
    v_mfma_f32_16x16x32_bf16 v[136:139], a[168:171], a[32:35], v[136:139]
    s_waitcnt lgkmcnt(8)
    ds_read_b64_tr_b16 a[160:161], v24 offset:32768
    v_mfma_f32_16x16x32_bf16 v[136:139], a[172:175], a[40:43], v[136:139]
    s_add_u32 s49, s44, 2621440
    ds_read_b64_tr_b16 a[162:163], v24 offset:36864
    v_mfma_f32_16x16x32_bf16 v[140:143], a[168:171], a[36:39], v[140:143]
    s_add_u32 m0, s42, 32768
    ds_read_b64_tr_b16 a[164:165], v24 offset:40960
    v_mfma_f32_16x16x32_bf16 v[140:143], a[172:175], a[44:47], v[140:143]
    s_waitcnt lgkmcnt(9)
    ds_read_b64_tr_b16 a[166:167], v24 offset:45056
    buffer_load_dwordx4 v42, s[16:19], s49 offen lds
    v_mfma_f32_16x16x32_bf16 v[144:147], a[176:179], a[32:35], v[144:147]
    s_waitcnt lgkmcnt(8)
    ds_read_b64_tr_b16 a[168:169], v25 offset:32768
    v_mfma_f32_16x16x32_bf16 v[144:147], a[180:183], a[40:43], v[144:147]
    ds_read_b64_tr_b16 a[170:171], v25 offset:36864
    v_mfma_f32_16x16x32_bf16 v[148:151], a[176:179], a[36:39], v[148:151]
    ds_read_b64_tr_b16 a[172:173], v25 offset:40960
    v_mfma_f32_16x16x32_bf16 v[148:151], a[180:183], a[44:47], v[148:151]
    s_waitcnt lgkmcnt(9)
    ds_read_b64_tr_b16 a[174:175], v25 offset:45056
    buffer_load_dwordx4 v43, s[16:19], s49 offen offset:1024 lds
    v_mfma_f32_16x16x32_bf16 v[152:155], a[184:187], a[32:35], v[152:155]
    s_waitcnt lgkmcnt(8)
    ds_read_b64_tr_b16 a[176:177], v26 offset:32768
    v_mfma_f32_16x16x32_bf16 v[152:155], a[188:191], a[40:43], v[152:155]
    ds_read_b64_tr_b16 a[178:179], v26 offset:36864
    v_mfma_f32_16x16x32_bf16 v[156:159], a[184:187], a[36:39], v[156:159]
    ds_read_b64_tr_b16 a[180:181], v26 offset:40960
    v_mfma_f32_16x16x32_bf16 v[156:159], a[188:191], a[44:47], v[156:159]
    s_waitcnt lgkmcnt(9)
    ds_read_b64_tr_b16 a[182:183], v26 offset:45056
    buffer_load_dwordx4 v44, s[16:19], s49 offen offset:2048 lds
    v_mfma_f32_16x16x32_bf16 v[160:163], a[160:163], a[32:35], v[160:163]
    s_waitcnt lgkmcnt(8)
    ds_read_b64_tr_b16 a[184:185], v27 offset:32768
    v_mfma_f32_16x16x32_bf16 v[160:163], a[164:167], a[40:43], v[160:163]
    ds_read_b64_tr_b16 a[186:187], v27 offset:36864
    v_mfma_f32_16x16x32_bf16 v[164:167], a[160:163], a[36:39], v[164:167]
    ds_read_b64_tr_b16 a[188:189], v27 offset:40960
    v_mfma_f32_16x16x32_bf16 v[164:167], a[164:167], a[44:47], v[164:167]
    s_waitcnt lgkmcnt(9)
    ds_read_b64_tr_b16 a[190:191], v27 offset:45056
    buffer_load_dwordx4 v45, s[16:19], s49 offen offset:3072 lds
    v_mfma_f32_16x16x32_bf16 v[168:171], a[168:171], a[32:35], v[168:171]
    s_waitcnt lgkmcnt(8)
    ds_read_b64_tr_b16 a[160:161], v20 offset:49152
    v_mfma_f32_16x16x32_bf16 v[168:171], a[172:175], a[40:43], v[168:171]
    s_add_u32 s49, s44, 2621696
    ds_read_b64_tr_b16 a[162:163], v20 offset:53248
    v_mfma_f32_16x16x32_bf16 v[172:175], a[168:171], a[36:39], v[172:175]
    s_add_u32 m0, s42, 49152
    ds_read_b64_tr_b16 a[164:165], v20 offset:57344
    v_mfma_f32_16x16x32_bf16 v[172:175], a[172:175], a[44:47], v[172:175]
    s_waitcnt lgkmcnt(9)
    ds_read_b64_tr_b16 a[166:167], v20 offset:61440
    buffer_load_dwordx4 v42, s[16:19], s49 offen lds
    v_mfma_f32_16x16x32_bf16 v[176:179], a[176:179], a[32:35], v[176:179]
    s_waitcnt lgkmcnt(8)
    ds_read_b64_tr_b16 a[168:169], v21 offset:49152
    v_mfma_f32_16x16x32_bf16 v[176:179], a[180:183], a[40:43], v[176:179]
    ds_read_b64_tr_b16 a[170:171], v21 offset:53248
    v_mfma_f32_16x16x32_bf16 v[180:183], a[176:179], a[36:39], v[180:183]
    ds_read_b64_tr_b16 a[172:173], v21 offset:57344
    v_mfma_f32_16x16x32_bf16 v[180:183], a[180:183], a[44:47], v[180:183]
    s_waitcnt lgkmcnt(9)
    ds_read_b64_tr_b16 a[174:175], v21 offset:61440
    buffer_load_dwordx4 v43, s[16:19], s49 offen offset:1024 lds
    v_mfma_f32_16x16x32_bf16 v[184:187], a[184:187], a[32:35], v[184:187]
    s_waitcnt lgkmcnt(8)
    ds_read_b64_tr_b16 a[176:177], v22 offset:49152
    v_mfma_f32_16x16x32_bf16 v[184:187], a[188:191], a[40:43], v[184:187]
    ds_read_b64_tr_b16 a[178:179], v22 offset:53248
    v_mfma_f32_16x16x32_bf16 v[188:191], a[184:187], a[36:39], v[188:191]
    ds_read_b64_tr_b16 a[180:181], v22 offset:57344
    v_mfma_f32_16x16x32_bf16 v[188:191], a[188:191], a[44:47], v[188:191]
    s_waitcnt lgkmcnt(9)
    ds_read_b64_tr_b16 a[182:183], v22 offset:61440
    buffer_load_dwordx4 v44, s[16:19], s49 offen offset:2048 lds
    v_mfma_f32_16x16x32_bf16 v[192:195], a[160:163], a[32:35], v[192:195]
    s_waitcnt lgkmcnt(8)
    ds_read_b64_tr_b16 a[184:185], v23 offset:49152
    v_mfma_f32_16x16x32_bf16 v[192:195], a[164:167], a[40:43], v[192:195]
    ds_read_b64_tr_b16 a[186:187], v23 offset:53248
    v_mfma_f32_16x16x32_bf16 v[196:199], a[160:163], a[36:39], v[196:199]
    ds_read_b64_tr_b16 a[188:189], v23 offset:57344
    v_mfma_f32_16x16x32_bf16 v[196:199], a[164:167], a[44:47], v[196:199]
    s_waitcnt lgkmcnt(9)
    ds_read_b64_tr_b16 a[190:191], v23 offset:61440
    buffer_load_dwordx4 v45, s[16:19], s49 offen offset:3072 lds
    v_mfma_f32_16x16x32_bf16 v[200:203], a[168:171], a[32:35], v[200:203]
    s_waitcnt lgkmcnt(8)
    ds_read_b64_tr_b16 a[160:161], v24 offset:49152
    v_mfma_f32_16x16x32_bf16 v[200:203], a[172:175], a[40:43], v[200:203]
    ds_read_b64_tr_b16 a[162:163], v24 offset:53248
    v_mfma_f32_16x16x32_bf16 v[204:207], a[168:171], a[36:39], v[204:207]
    ds_read_b64_tr_b16 a[164:165], v24 offset:57344
    v_mfma_f32_16x16x32_bf16 v[204:207], a[172:175], a[44:47], v[204:207]
    s_waitcnt lgkmcnt(9)
    ds_read_b64_tr_b16 a[166:167], v24 offset:61440
    v_mfma_f32_16x16x32_bf16 v[208:211], a[176:179], a[32:35], v[208:211]
    s_waitcnt lgkmcnt(8)
    ds_read_b64_tr_b16 a[168:169], v25 offset:49152
    v_mfma_f32_16x16x32_bf16 v[208:211], a[180:183], a[40:43], v[208:211]
    ds_read_b64_tr_b16 a[170:171], v25 offset:53248
    v_mfma_f32_16x16x32_bf16 v[212:215], a[176:179], a[36:39], v[212:215]
    ds_read_b64_tr_b16 a[172:173], v25 offset:57344
    v_mfma_f32_16x16x32_bf16 v[212:215], a[180:183], a[44:47], v[212:215]
    s_waitcnt lgkmcnt(9)
    ds_read_b64_tr_b16 a[174:175], v25 offset:61440
    v_mfma_f32_16x16x32_bf16 v[216:219], a[184:187], a[32:35], v[216:219]
    s_waitcnt lgkmcnt(8)
    ds_read_b64_tr_b16 a[176:177], v26 offset:49152
    v_mfma_f32_16x16x32_bf16 v[216:219], a[188:191], a[40:43], v[216:219]
    ds_read_b64_tr_b16 a[178:179], v26 offset:53248
    v_mfma_f32_16x16x32_bf16 v[220:223], a[184:187], a[36:39], v[220:223]
    ds_read_b64_tr_b16 a[180:181], v26 offset:57344
    v_mfma_f32_16x16x32_bf16 v[220:223], a[188:191], a[44:47], v[220:223]
    s_waitcnt lgkmcnt(9)
    ds_read_b64_tr_b16 a[182:183], v26 offset:61440
    v_mfma_f32_16x16x32_bf16 v[224:227], a[160:163], a[32:35], v[224:227]
    s_waitcnt lgkmcnt(8)
    ds_read_b64_tr_b16 a[184:185], v27 offset:49152
    v_mfma_f32_16x16x32_bf16 v[224:227], a[164:167], a[40:43], v[224:227]
    ds_read_b64_tr_b16 a[186:187], v27 offset:53248
    v_mfma_f32_16x16x32_bf16 v[228:231], a[160:163], a[36:39], v[228:231]
    ds_read_b64_tr_b16 a[188:189], v27 offset:57344
    v_mfma_f32_16x16x32_bf16 v[228:231], a[164:167], a[44:47], v[228:231]
    s_waitcnt lgkmcnt(9)
    ds_read_b64_tr_b16 a[190:191], v27 offset:61440
    s_waitcnt vmcnt(24)
    s_barrier
    v_mfma_f32_16x16x32_bf16 v[232:235], a[168:171], a[32:35], v[232:235]
    s_waitcnt lgkmcnt(8)
    ds_read_b64_tr_b16 a[160:161], v28 offset:0
    v_mfma_f32_16x16x32_bf16 v[232:235], a[172:175], a[40:43], v[232:235]
    ds_read_b64_tr_b16 a[162:163], v28 offset:4096
    v_mfma_f32_16x16x32_bf16 v[236:239], a[168:171], a[36:39], v[236:239]
    s_add_u32 s49, s46, 12288
    ds_read_b64_tr_b16 a[164:165], v28 offset:8192
    v_mfma_f32_16x16x32_bf16 v[236:239], a[172:175], a[44:47], v[236:239]
    s_waitcnt lgkmcnt(9)
    ds_read_b64_tr_b16 a[166:167], v28 offset:12288
    buffer_load_dwordx4 a[96:99], v51, s[24:27], s49 offen
    v_mfma_f32_16x16x32_bf16 v[240:243], a[176:179], a[32:35], v[240:243]
    s_waitcnt lgkmcnt(8)
    ds_read_b64_tr_b16 a[168:169], v29 offset:0
    v_mfma_f32_16x16x32_bf16 v[240:243], a[180:183], a[40:43], v[240:243]
    ds_read_b64_tr_b16 a[170:171], v29 offset:4096
    v_mfma_f32_16x16x32_bf16 v[244:247], a[176:179], a[36:39], v[244:247]
    ds_read_b64_tr_b16 a[172:173], v29 offset:8192
    v_mfma_f32_16x16x32_bf16 v[244:247], a[180:183], a[44:47], v[244:247]
    s_waitcnt lgkmcnt(9)
    ds_read_b64_tr_b16 a[174:175], v29 offset:12288
    buffer_load_dwordx4 a[104:107], v51, s[24:27], s49 offen offset:1024
    v_mfma_f32_16x16x32_bf16 v[248:251], a[184:187], a[32:35], v[248:251]
    s_waitcnt lgkmcnt(8)
    ds_read_b64_tr_b16 a[176:177], v30 offset:0
    v_mfma_f32_16x16x32_bf16 v[248:251], a[188:191], a[40:43], v[248:251]
    ds_read_b64_tr_b16 a[178:179], v30 offset:4096
    v_mfma_f32_16x16x32_bf16 v[252:255], a[184:187], a[36:39], v[252:255]
    s_add_u32 s49, s46, 30720
    ds_read_b64_tr_b16 a[180:181], v30 offset:8192
    v_mfma_f32_16x16x32_bf16 v[252:255], a[188:191], a[44:47], v[252:255]
    s_waitcnt lgkmcnt(9)
    ds_read_b64_tr_b16 a[182:183], v30 offset:12288
    buffer_load_dwordx4 a[100:103], v51, s[24:27], s49 offen
    v_mfma_f32_16x16x32_bf16 v[128:131], a[160:163], a[48:51], v[128:131]
    s_waitcnt lgkmcnt(8)
    ds_read_b64_tr_b16 a[184:185], v31 offset:0
    v_mfma_f32_16x16x32_bf16 v[128:131], a[164:167], a[56:59], v[128:131]
    ds_read_b64_tr_b16 a[186:187], v31 offset:4096
    v_mfma_f32_16x16x32_bf16 v[132:135], a[160:163], a[52:55], v[132:135]
    ds_read_b64_tr_b16 a[188:189], v31 offset:8192
    v_mfma_f32_16x16x32_bf16 v[132:135], a[164:167], a[60:63], v[132:135]
    s_waitcnt lgkmcnt(9)
    ds_read_b64_tr_b16 a[190:191], v31 offset:12288
    buffer_load_dwordx4 a[108:111], v51, s[24:27], s49 offen offset:1024
    v_mfma_f32_16x16x32_bf16 v[136:139], a[168:171], a[48:51], v[136:139]
    s_waitcnt lgkmcnt(8)
    ds_read_b64_tr_b16 a[160:161], v32 offset:0
    v_mfma_f32_16x16x32_bf16 v[136:139], a[172:175], a[56:59], v[136:139]
    s_add_u32 s49, s44, 3145728
    ds_read_b64_tr_b16 a[162:163], v32 offset:4096
    v_mfma_f32_16x16x32_bf16 v[140:143], a[168:171], a[52:55], v[140:143]
    s_add_u32 m0, s42, 65536
    ds_read_b64_tr_b16 a[164:165], v32 offset:8192
    v_mfma_f32_16x16x32_bf16 v[140:143], a[172:175], a[60:63], v[140:143]
    s_waitcnt lgkmcnt(9)
    ds_read_b64_tr_b16 a[166:167], v32 offset:12288
    buffer_load_dwordx4 v42, s[16:19], s49 offen lds
    v_mfma_f32_16x16x32_bf16 v[144:147], a[176:179], a[48:51], v[144:147]
    s_waitcnt lgkmcnt(8)
    ds_read_b64_tr_b16 a[168:169], v33 offset:0
    v_mfma_f32_16x16x32_bf16 v[144:147], a[180:183], a[56:59], v[144:147]
    ds_read_b64_tr_b16 a[170:171], v33 offset:4096
    v_mfma_f32_16x16x32_bf16 v[148:151], a[176:179], a[52:55], v[148:151]
    ds_read_b64_tr_b16 a[172:173], v33 offset:8192
    v_mfma_f32_16x16x32_bf16 v[148:151], a[180:183], a[60:63], v[148:151]
    s_waitcnt lgkmcnt(9)
    ds_read_b64_tr_b16 a[174:175], v33 offset:12288
    buffer_load_dwordx4 v43, s[16:19], s49 offen offset:1024 lds
    v_mfma_f32_16x16x32_bf16 v[152:155], a[184:187], a[48:51], v[152:155]
    s_waitcnt lgkmcnt(8)
    ds_read_b64_tr_b16 a[176:177], v34 offset:0
    v_mfma_f32_16x16x32_bf16 v[152:155], a[188:191], a[56:59], v[152:155]
    ds_read_b64_tr_b16 a[178:179], v34 offset:4096
    v_mfma_f32_16x16x32_bf16 v[156:159], a[184:187], a[52:55], v[156:159]
    ds_read_b64_tr_b16 a[180:181], v34 offset:8192
    v_mfma_f32_16x16x32_bf16 v[156:159], a[188:191], a[60:63], v[156:159]
    s_waitcnt lgkmcnt(9)
    ds_read_b64_tr_b16 a[182:183], v34 offset:12288
    buffer_load_dwordx4 v44, s[16:19], s49 offen offset:2048 lds
    v_mfma_f32_16x16x32_bf16 v[160:163], a[160:163], a[48:51], v[160:163]
    s_waitcnt lgkmcnt(8)
    ds_read_b64_tr_b16 a[184:185], v35 offset:0
    v_mfma_f32_16x16x32_bf16 v[160:163], a[164:167], a[56:59], v[160:163]
    ds_read_b64_tr_b16 a[186:187], v35 offset:4096
    v_mfma_f32_16x16x32_bf16 v[164:167], a[160:163], a[52:55], v[164:167]
    ds_read_b64_tr_b16 a[188:189], v35 offset:8192
    v_mfma_f32_16x16x32_bf16 v[164:167], a[164:167], a[60:63], v[164:167]
    s_waitcnt lgkmcnt(9)
    ds_read_b64_tr_b16 a[190:191], v35 offset:12288
    buffer_load_dwordx4 v45, s[16:19], s49 offen offset:3072 lds
    v_mfma_f32_16x16x32_bf16 v[168:171], a[168:171], a[48:51], v[168:171]
    s_waitcnt lgkmcnt(8)
    ds_read_b64_tr_b16 a[160:161], v28 offset:16384
    v_mfma_f32_16x16x32_bf16 v[168:171], a[172:175], a[56:59], v[168:171]
    s_add_u32 s49, s44, 3145984
    ds_read_b64_tr_b16 a[162:163], v28 offset:20480
    v_mfma_f32_16x16x32_bf16 v[172:175], a[168:171], a[52:55], v[172:175]
    s_add_u32 m0, s42, 81920
    ds_read_b64_tr_b16 a[164:165], v28 offset:24576
    v_mfma_f32_16x16x32_bf16 v[172:175], a[172:175], a[60:63], v[172:175]
    s_waitcnt lgkmcnt(9)
    ds_read_b64_tr_b16 a[166:167], v28 offset:28672
    buffer_load_dwordx4 v42, s[16:19], s49 offen lds
    v_mfma_f32_16x16x32_bf16 v[176:179], a[176:179], a[48:51], v[176:179]
    s_waitcnt lgkmcnt(8)
    ds_read_b64_tr_b16 a[168:169], v29 offset:16384
    v_mfma_f32_16x16x32_bf16 v[176:179], a[180:183], a[56:59], v[176:179]
    ds_read_b64_tr_b16 a[170:171], v29 offset:20480
    v_mfma_f32_16x16x32_bf16 v[180:183], a[176:179], a[52:55], v[180:183]
    ds_read_b64_tr_b16 a[172:173], v29 offset:24576
    v_mfma_f32_16x16x32_bf16 v[180:183], a[180:183], a[60:63], v[180:183]
    s_waitcnt lgkmcnt(9)
    ds_read_b64_tr_b16 a[174:175], v29 offset:28672
    buffer_load_dwordx4 v43, s[16:19], s49 offen offset:1024 lds
    v_mfma_f32_16x16x32_bf16 v[184:187], a[184:187], a[48:51], v[184:187]
    s_waitcnt lgkmcnt(8)
    ds_read_b64_tr_b16 a[176:177], v30 offset:16384
    v_mfma_f32_16x16x32_bf16 v[184:187], a[188:191], a[56:59], v[184:187]
    ds_read_b64_tr_b16 a[178:179], v30 offset:20480
    v_mfma_f32_16x16x32_bf16 v[188:191], a[184:187], a[52:55], v[188:191]
    ds_read_b64_tr_b16 a[180:181], v30 offset:24576
    v_mfma_f32_16x16x32_bf16 v[188:191], a[188:191], a[60:63], v[188:191]
    s_waitcnt lgkmcnt(9)
    ds_read_b64_tr_b16 a[182:183], v30 offset:28672
    buffer_load_dwordx4 v44, s[16:19], s49 offen offset:2048 lds
    v_mfma_f32_16x16x32_bf16 v[192:195], a[160:163], a[48:51], v[192:195]
    s_waitcnt lgkmcnt(8)
    ds_read_b64_tr_b16 a[184:185], v31 offset:16384
    v_mfma_f32_16x16x32_bf16 v[192:195], a[164:167], a[56:59], v[192:195]
    ds_read_b64_tr_b16 a[186:187], v31 offset:20480
    v_mfma_f32_16x16x32_bf16 v[196:199], a[160:163], a[52:55], v[196:199]
    ds_read_b64_tr_b16 a[188:189], v31 offset:24576
    v_mfma_f32_16x16x32_bf16 v[196:199], a[164:167], a[60:63], v[196:199]
    s_waitcnt lgkmcnt(9)
    ds_read_b64_tr_b16 a[190:191], v31 offset:28672
    buffer_load_dwordx4 v45, s[16:19], s49 offen offset:3072 lds
    v_mfma_f32_16x16x32_bf16 v[200:203], a[168:171], a[48:51], v[200:203]
    s_waitcnt lgkmcnt(8)
    ds_read_b64_tr_b16 a[160:161], v32 offset:16384
    v_mfma_f32_16x16x32_bf16 v[200:203], a[172:175], a[56:59], v[200:203]
    ds_read_b64_tr_b16 a[162:163], v32 offset:20480
    v_mfma_f32_16x16x32_bf16 v[204:207], a[168:171], a[52:55], v[204:207]
    ds_read_b64_tr_b16 a[164:165], v32 offset:24576
    v_mfma_f32_16x16x32_bf16 v[204:207], a[172:175], a[60:63], v[204:207]
    s_waitcnt lgkmcnt(9)
    ds_read_b64_tr_b16 a[166:167], v32 offset:28672
    v_mfma_f32_16x16x32_bf16 v[208:211], a[176:179], a[48:51], v[208:211]
    s_waitcnt lgkmcnt(8)
    ds_read_b64_tr_b16 a[168:169], v33 offset:16384
    v_mfma_f32_16x16x32_bf16 v[208:211], a[180:183], a[56:59], v[208:211]
    ds_read_b64_tr_b16 a[170:171], v33 offset:20480
    v_mfma_f32_16x16x32_bf16 v[212:215], a[176:179], a[52:55], v[212:215]
    ds_read_b64_tr_b16 a[172:173], v33 offset:24576
    v_mfma_f32_16x16x32_bf16 v[212:215], a[180:183], a[60:63], v[212:215]
    s_waitcnt lgkmcnt(9)
    ds_read_b64_tr_b16 a[174:175], v33 offset:28672
    v_mfma_f32_16x16x32_bf16 v[216:219], a[184:187], a[48:51], v[216:219]
    s_waitcnt lgkmcnt(8)
    ds_read_b64_tr_b16 a[176:177], v34 offset:16384
    v_mfma_f32_16x16x32_bf16 v[216:219], a[188:191], a[56:59], v[216:219]
    ds_read_b64_tr_b16 a[178:179], v34 offset:20480
    v_mfma_f32_16x16x32_bf16 v[220:223], a[184:187], a[52:55], v[220:223]
    ds_read_b64_tr_b16 a[180:181], v34 offset:24576
    v_mfma_f32_16x16x32_bf16 v[220:223], a[188:191], a[60:63], v[220:223]
    s_waitcnt lgkmcnt(9)
    ds_read_b64_tr_b16 a[182:183], v34 offset:28672
    v_mfma_f32_16x16x32_bf16 v[224:227], a[160:163], a[48:51], v[224:227]
    s_waitcnt lgkmcnt(8)
    ds_read_b64_tr_b16 a[184:185], v35 offset:16384
    v_mfma_f32_16x16x32_bf16 v[224:227], a[164:167], a[56:59], v[224:227]
    ds_read_b64_tr_b16 a[186:187], v35 offset:20480
    v_mfma_f32_16x16x32_bf16 v[228:231], a[160:163], a[52:55], v[228:231]
    ds_read_b64_tr_b16 a[188:189], v35 offset:24576
    v_mfma_f32_16x16x32_bf16 v[228:231], a[164:167], a[60:63], v[228:231]
    s_waitcnt lgkmcnt(9)
    ds_read_b64_tr_b16 a[190:191], v35 offset:28672
    s_waitcnt vmcnt(24)
    s_barrier
    v_mfma_f32_16x16x32_bf16 v[232:235], a[168:171], a[48:51], v[232:235]
    s_waitcnt lgkmcnt(8)
    ds_read_b64_tr_b16 a[160:161], v12 offset:0
    v_mfma_f32_16x16x32_bf16 v[232:235], a[172:175], a[56:59], v[232:235]
    ds_read_b64_tr_b16 a[162:163], v12 offset:4096
    v_mfma_f32_16x16x32_bf16 v[236:239], a[168:171], a[52:55], v[236:239]
    s_add_u32 s49, s46, 14336
    ds_read_b64_tr_b16 a[164:165], v12 offset:8192
    v_mfma_f32_16x16x32_bf16 v[236:239], a[172:175], a[60:63], v[236:239]
    s_waitcnt lgkmcnt(9)
    ds_read_b64_tr_b16 a[166:167], v12 offset:12288
    buffer_load_dwordx4 a[112:115], v51, s[24:27], s49 offen
    v_mfma_f32_16x16x32_bf16 v[240:243], a[176:179], a[48:51], v[240:243]
    s_waitcnt lgkmcnt(8)
    ds_read_b64_tr_b16 a[168:169], v13 offset:0
    v_mfma_f32_16x16x32_bf16 v[240:243], a[180:183], a[56:59], v[240:243]
    ds_read_b64_tr_b16 a[170:171], v13 offset:4096
    v_mfma_f32_16x16x32_bf16 v[244:247], a[176:179], a[52:55], v[244:247]
    ds_read_b64_tr_b16 a[172:173], v13 offset:8192
    v_mfma_f32_16x16x32_bf16 v[244:247], a[180:183], a[60:63], v[244:247]
    s_waitcnt lgkmcnt(9)
    ds_read_b64_tr_b16 a[174:175], v13 offset:12288
    buffer_load_dwordx4 a[120:123], v51, s[24:27], s49 offen offset:1024
    v_mfma_f32_16x16x32_bf16 v[248:251], a[184:187], a[48:51], v[248:251]
    s_waitcnt lgkmcnt(8)
    ds_read_b64_tr_b16 a[176:177], v14 offset:0
    v_mfma_f32_16x16x32_bf16 v[248:251], a[188:191], a[56:59], v[248:251]
    ds_read_b64_tr_b16 a[178:179], v14 offset:4096
    v_mfma_f32_16x16x32_bf16 v[252:255], a[184:187], a[52:55], v[252:255]
    s_add_u32 s49, s46, 32768
    ds_read_b64_tr_b16 a[180:181], v14 offset:8192
    v_mfma_f32_16x16x32_bf16 v[252:255], a[188:191], a[60:63], v[252:255]
    s_waitcnt lgkmcnt(9)
    ds_read_b64_tr_b16 a[182:183], v14 offset:12288
    buffer_load_dwordx4 a[116:119], v51, s[24:27], s49 offen
    v_mfma_f32_16x16x32_bf16 v[128:131], a[160:163], a[64:67], v[128:131]
    s_waitcnt lgkmcnt(8)
    ds_read_b64_tr_b16 a[184:185], v15 offset:0
    v_mfma_f32_16x16x32_bf16 v[128:131], a[164:167], a[72:75], v[128:131]
    ds_read_b64_tr_b16 a[186:187], v15 offset:4096
    v_mfma_f32_16x16x32_bf16 v[132:135], a[160:163], a[68:71], v[132:135]
    ds_read_b64_tr_b16 a[188:189], v15 offset:8192
    v_mfma_f32_16x16x32_bf16 v[132:135], a[164:167], a[76:79], v[132:135]
    s_waitcnt lgkmcnt(9)
    ds_read_b64_tr_b16 a[190:191], v15 offset:12288
    buffer_load_dwordx4 a[124:127], v51, s[24:27], s49 offen offset:1024
    v_mfma_f32_16x16x32_bf16 v[136:139], a[168:171], a[64:67], v[136:139]
    s_waitcnt lgkmcnt(8)
    ds_read_b64_tr_b16 a[160:161], v16 offset:0
    v_mfma_f32_16x16x32_bf16 v[136:139], a[172:175], a[72:75], v[136:139]
    s_add_u32 s49, s44, 3670016
    ds_read_b64_tr_b16 a[162:163], v16 offset:4096
    v_mfma_f32_16x16x32_bf16 v[140:143], a[168:171], a[68:71], v[140:143]
    s_add_u32 m0, s42, 98304
    ds_read_b64_tr_b16 a[164:165], v16 offset:8192
    v_mfma_f32_16x16x32_bf16 v[140:143], a[172:175], a[76:79], v[140:143]
    s_waitcnt lgkmcnt(9)
    ds_read_b64_tr_b16 a[166:167], v16 offset:12288
    buffer_load_dwordx4 v42, s[16:19], s49 offen lds
    v_mfma_f32_16x16x32_bf16 v[144:147], a[176:179], a[64:67], v[144:147]
    s_waitcnt lgkmcnt(8)
    ds_read_b64_tr_b16 a[168:169], v17 offset:0
    v_mfma_f32_16x16x32_bf16 v[144:147], a[180:183], a[72:75], v[144:147]
    ds_read_b64_tr_b16 a[170:171], v17 offset:4096
    v_mfma_f32_16x16x32_bf16 v[148:151], a[176:179], a[68:71], v[148:151]
    ds_read_b64_tr_b16 a[172:173], v17 offset:8192
    v_mfma_f32_16x16x32_bf16 v[148:151], a[180:183], a[76:79], v[148:151]
    s_waitcnt lgkmcnt(9)
    ds_read_b64_tr_b16 a[174:175], v17 offset:12288
    buffer_load_dwordx4 v43, s[16:19], s49 offen offset:1024 lds
    v_mfma_f32_16x16x32_bf16 v[152:155], a[184:187], a[64:67], v[152:155]
    s_waitcnt lgkmcnt(8)
    ds_read_b64_tr_b16 a[176:177], v18 offset:0
    v_mfma_f32_16x16x32_bf16 v[152:155], a[188:191], a[72:75], v[152:155]
    ds_read_b64_tr_b16 a[178:179], v18 offset:4096
    v_mfma_f32_16x16x32_bf16 v[156:159], a[184:187], a[68:71], v[156:159]
    ds_read_b64_tr_b16 a[180:181], v18 offset:8192
    v_mfma_f32_16x16x32_bf16 v[156:159], a[188:191], a[76:79], v[156:159]
    s_waitcnt lgkmcnt(9)
    ds_read_b64_tr_b16 a[182:183], v18 offset:12288
    buffer_load_dwordx4 v44, s[16:19], s49 offen offset:2048 lds
    v_mfma_f32_16x16x32_bf16 v[160:163], a[160:163], a[64:67], v[160:163]
    s_waitcnt lgkmcnt(8)
    ds_read_b64_tr_b16 a[184:185], v19 offset:0
    v_mfma_f32_16x16x32_bf16 v[160:163], a[164:167], a[72:75], v[160:163]
    ds_read_b64_tr_b16 a[186:187], v19 offset:4096
    v_mfma_f32_16x16x32_bf16 v[164:167], a[160:163], a[68:71], v[164:167]
    ds_read_b64_tr_b16 a[188:189], v19 offset:8192
    v_mfma_f32_16x16x32_bf16 v[164:167], a[164:167], a[76:79], v[164:167]
    s_waitcnt lgkmcnt(9)
    ds_read_b64_tr_b16 a[190:191], v19 offset:12288
    buffer_load_dwordx4 v45, s[16:19], s49 offen offset:3072 lds
    v_mfma_f32_16x16x32_bf16 v[168:171], a[168:171], a[64:67], v[168:171]
    s_waitcnt lgkmcnt(8)
    ds_read_b64_tr_b16 a[160:161], v12 offset:16384
    v_mfma_f32_16x16x32_bf16 v[168:171], a[172:175], a[72:75], v[168:171]
    s_add_u32 s49, s44, 3670272
    ds_read_b64_tr_b16 a[162:163], v12 offset:20480
    v_mfma_f32_16x16x32_bf16 v[172:175], a[168:171], a[68:71], v[172:175]
    s_add_u32 m0, s42, 114688
    ds_read_b64_tr_b16 a[164:165], v12 offset:24576
    v_mfma_f32_16x16x32_bf16 v[172:175], a[172:175], a[76:79], v[172:175]
    s_waitcnt lgkmcnt(9)
    ds_read_b64_tr_b16 a[166:167], v12 offset:28672
    buffer_load_dwordx4 v42, s[16:19], s49 offen lds
    v_mfma_f32_16x16x32_bf16 v[176:179], a[176:179], a[64:67], v[176:179]
    s_waitcnt lgkmcnt(8)
    ds_read_b64_tr_b16 a[168:169], v13 offset:16384
    v_mfma_f32_16x16x32_bf16 v[176:179], a[180:183], a[72:75], v[176:179]
    ds_read_b64_tr_b16 a[170:171], v13 offset:20480
    v_mfma_f32_16x16x32_bf16 v[180:183], a[176:179], a[68:71], v[180:183]
    ds_read_b64_tr_b16 a[172:173], v13 offset:24576
    v_mfma_f32_16x16x32_bf16 v[180:183], a[180:183], a[76:79], v[180:183]
    s_waitcnt lgkmcnt(9)
    ds_read_b64_tr_b16 a[174:175], v13 offset:28672
    buffer_load_dwordx4 v43, s[16:19], s49 offen offset:1024 lds
    v_mfma_f32_16x16x32_bf16 v[184:187], a[184:187], a[64:67], v[184:187]
    s_waitcnt lgkmcnt(8)
    ds_read_b64_tr_b16 a[176:177], v14 offset:16384
    v_mfma_f32_16x16x32_bf16 v[184:187], a[188:191], a[72:75], v[184:187]
    ds_read_b64_tr_b16 a[178:179], v14 offset:20480
    v_mfma_f32_16x16x32_bf16 v[188:191], a[184:187], a[68:71], v[188:191]
    ds_read_b64_tr_b16 a[180:181], v14 offset:24576
    v_mfma_f32_16x16x32_bf16 v[188:191], a[188:191], a[76:79], v[188:191]
    s_waitcnt lgkmcnt(9)
    ds_read_b64_tr_b16 a[182:183], v14 offset:28672
    buffer_load_dwordx4 v44, s[16:19], s49 offen offset:2048 lds
    v_mfma_f32_16x16x32_bf16 v[192:195], a[160:163], a[64:67], v[192:195]
    s_waitcnt lgkmcnt(8)
    ds_read_b64_tr_b16 a[184:185], v15 offset:16384
    v_mfma_f32_16x16x32_bf16 v[192:195], a[164:167], a[72:75], v[192:195]
    ds_read_b64_tr_b16 a[186:187], v15 offset:20480
    v_mfma_f32_16x16x32_bf16 v[196:199], a[160:163], a[68:71], v[196:199]
    ds_read_b64_tr_b16 a[188:189], v15 offset:24576
    v_mfma_f32_16x16x32_bf16 v[196:199], a[164:167], a[76:79], v[196:199]
    s_waitcnt lgkmcnt(9)
    ds_read_b64_tr_b16 a[190:191], v15 offset:28672
    buffer_load_dwordx4 v45, s[16:19], s49 offen offset:3072 lds
    v_mfma_f32_16x16x32_bf16 v[200:203], a[168:171], a[64:67], v[200:203]
    s_waitcnt lgkmcnt(8)
    ds_read_b64_tr_b16 a[160:161], v16 offset:16384
    v_mfma_f32_16x16x32_bf16 v[200:203], a[172:175], a[72:75], v[200:203]
    ds_read_b64_tr_b16 a[162:163], v16 offset:20480
    v_mfma_f32_16x16x32_bf16 v[204:207], a[168:171], a[68:71], v[204:207]
    ds_read_b64_tr_b16 a[164:165], v16 offset:24576
    v_mfma_f32_16x16x32_bf16 v[204:207], a[172:175], a[76:79], v[204:207]
    s_waitcnt lgkmcnt(9)
    ds_read_b64_tr_b16 a[166:167], v16 offset:28672
    v_mfma_f32_16x16x32_bf16 v[208:211], a[176:179], a[64:67], v[208:211]
    s_waitcnt lgkmcnt(8)
    ds_read_b64_tr_b16 a[168:169], v17 offset:16384
    v_mfma_f32_16x16x32_bf16 v[208:211], a[180:183], a[72:75], v[208:211]
    ds_read_b64_tr_b16 a[170:171], v17 offset:20480
    v_mfma_f32_16x16x32_bf16 v[212:215], a[176:179], a[68:71], v[212:215]
    ds_read_b64_tr_b16 a[172:173], v17 offset:24576
    v_mfma_f32_16x16x32_bf16 v[212:215], a[180:183], a[76:79], v[212:215]
    s_waitcnt lgkmcnt(9)
    ds_read_b64_tr_b16 a[174:175], v17 offset:28672
    v_mfma_f32_16x16x32_bf16 v[216:219], a[184:187], a[64:67], v[216:219]
    s_waitcnt lgkmcnt(8)
    ds_read_b64_tr_b16 a[176:177], v18 offset:16384
    v_mfma_f32_16x16x32_bf16 v[216:219], a[188:191], a[72:75], v[216:219]
    ds_read_b64_tr_b16 a[178:179], v18 offset:20480
    v_mfma_f32_16x16x32_bf16 v[220:223], a[184:187], a[68:71], v[220:223]
    ds_read_b64_tr_b16 a[180:181], v18 offset:24576
    v_mfma_f32_16x16x32_bf16 v[220:223], a[188:191], a[76:79], v[220:223]
    s_waitcnt lgkmcnt(9)
    ds_read_b64_tr_b16 a[182:183], v18 offset:28672
    v_mfma_f32_16x16x32_bf16 v[224:227], a[160:163], a[64:67], v[224:227]
    s_waitcnt lgkmcnt(8)
    ds_read_b64_tr_b16 a[184:185], v19 offset:16384
    v_mfma_f32_16x16x32_bf16 v[224:227], a[164:167], a[72:75], v[224:227]
    ds_read_b64_tr_b16 a[186:187], v19 offset:20480
    v_mfma_f32_16x16x32_bf16 v[228:231], a[160:163], a[68:71], v[228:231]
    ds_read_b64_tr_b16 a[188:189], v19 offset:24576
    v_mfma_f32_16x16x32_bf16 v[228:231], a[164:167], a[76:79], v[228:231]
    s_waitcnt lgkmcnt(9)
    ds_read_b64_tr_b16 a[190:191], v19 offset:28672
    s_waitcnt vmcnt(24)
    s_barrier
    v_mfma_f32_16x16x32_bf16 v[232:235], a[168:171], a[64:67], v[232:235]
    s_waitcnt lgkmcnt(8)
    ds_read_b64_tr_b16 a[160:161], v12 offset:32768
    v_mfma_f32_16x16x32_bf16 v[232:235], a[172:175], a[72:75], v[232:235]
    ds_read_b64_tr_b16 a[162:163], v12 offset:36864
    v_mfma_f32_16x16x32_bf16 v[236:239], a[168:171], a[68:71], v[236:239]
    s_add_u32 s49, s46, 16384
    ds_read_b64_tr_b16 a[164:165], v12 offset:40960
    v_mfma_f32_16x16x32_bf16 v[236:239], a[172:175], a[76:79], v[236:239]
    s_waitcnt lgkmcnt(9)
    ds_read_b64_tr_b16 a[166:167], v12 offset:45056
    buffer_load_dwordx4 a[128:131], v51, s[24:27], s49 offen
    v_mfma_f32_16x16x32_bf16 v[240:243], a[176:179], a[64:67], v[240:243]
    s_waitcnt lgkmcnt(8)
    ds_read_b64_tr_b16 a[168:169], v13 offset:32768
    v_mfma_f32_16x16x32_bf16 v[240:243], a[180:183], a[72:75], v[240:243]
    ds_read_b64_tr_b16 a[170:171], v13 offset:36864
    v_mfma_f32_16x16x32_bf16 v[244:247], a[176:179], a[68:71], v[244:247]
    ds_read_b64_tr_b16 a[172:173], v13 offset:40960
    v_mfma_f32_16x16x32_bf16 v[244:247], a[180:183], a[76:79], v[244:247]
    s_waitcnt lgkmcnt(9)
    ds_read_b64_tr_b16 a[174:175], v13 offset:45056
    buffer_load_dwordx4 a[136:139], v51, s[24:27], s49 offen offset:1024
    v_mfma_f32_16x16x32_bf16 v[248:251], a[184:187], a[64:67], v[248:251]
    s_waitcnt lgkmcnt(8)
    ds_read_b64_tr_b16 a[176:177], v14 offset:32768
    v_mfma_f32_16x16x32_bf16 v[248:251], a[188:191], a[72:75], v[248:251]
    ds_read_b64_tr_b16 a[178:179], v14 offset:36864
    v_mfma_f32_16x16x32_bf16 v[252:255], a[184:187], a[68:71], v[252:255]
    s_add_u32 s49, s46, 34816
    ds_read_b64_tr_b16 a[180:181], v14 offset:40960
    v_mfma_f32_16x16x32_bf16 v[252:255], a[188:191], a[76:79], v[252:255]
    s_waitcnt lgkmcnt(9)
    ds_read_b64_tr_b16 a[182:183], v14 offset:45056
    buffer_load_dwordx4 a[132:135], v51, s[24:27], s49 offen
    v_mfma_f32_16x16x32_bf16 v[128:131], a[160:163], a[80:83], v[128:131]
    s_waitcnt lgkmcnt(8)
    ds_read_b64_tr_b16 a[184:185], v15 offset:32768
    v_mfma_f32_16x16x32_bf16 v[128:131], a[164:167], a[88:91], v[128:131]
    ds_read_b64_tr_b16 a[186:187], v15 offset:36864
    v_mfma_f32_16x16x32_bf16 v[132:135], a[160:163], a[84:87], v[132:135]
    ds_read_b64_tr_b16 a[188:189], v15 offset:40960
    v_mfma_f32_16x16x32_bf16 v[132:135], a[164:167], a[92:95], v[132:135]
    s_waitcnt lgkmcnt(9)
    ds_read_b64_tr_b16 a[190:191], v15 offset:45056
    buffer_load_dwordx4 a[140:143], v51, s[24:27], s49 offen offset:1024
    v_mfma_f32_16x16x32_bf16 v[136:139], a[168:171], a[80:83], v[136:139]
    s_waitcnt lgkmcnt(8)
    ds_read_b64_tr_b16 a[160:161], v16 offset:32768
    v_mfma_f32_16x16x32_bf16 v[136:139], a[172:175], a[88:91], v[136:139]
    s_add_u32 s49, s44, 4194304
    ds_read_b64_tr_b16 a[162:163], v16 offset:36864
    v_mfma_f32_16x16x32_bf16 v[140:143], a[168:171], a[84:87], v[140:143]
    s_add_u32 m0, s42, 131072
    ds_read_b64_tr_b16 a[164:165], v16 offset:40960
    v_mfma_f32_16x16x32_bf16 v[140:143], a[172:175], a[92:95], v[140:143]
    s_waitcnt lgkmcnt(9)
    ds_read_b64_tr_b16 a[166:167], v16 offset:45056
    buffer_load_dwordx4 v42, s[16:19], s49 offen lds
    v_mfma_f32_16x16x32_bf16 v[144:147], a[176:179], a[80:83], v[144:147]
    s_waitcnt lgkmcnt(8)
    ds_read_b64_tr_b16 a[168:169], v17 offset:32768
    v_mfma_f32_16x16x32_bf16 v[144:147], a[180:183], a[88:91], v[144:147]
    ds_read_b64_tr_b16 a[170:171], v17 offset:36864
    v_mfma_f32_16x16x32_bf16 v[148:151], a[176:179], a[84:87], v[148:151]
    ds_read_b64_tr_b16 a[172:173], v17 offset:40960
    v_mfma_f32_16x16x32_bf16 v[148:151], a[180:183], a[92:95], v[148:151]
    s_waitcnt lgkmcnt(9)
    ds_read_b64_tr_b16 a[174:175], v17 offset:45056
    buffer_load_dwordx4 v43, s[16:19], s49 offen offset:1024 lds
    v_mfma_f32_16x16x32_bf16 v[152:155], a[184:187], a[80:83], v[152:155]
    s_waitcnt lgkmcnt(8)
    ds_read_b64_tr_b16 a[176:177], v18 offset:32768
    v_mfma_f32_16x16x32_bf16 v[152:155], a[188:191], a[88:91], v[152:155]
    ds_read_b64_tr_b16 a[178:179], v18 offset:36864
    v_mfma_f32_16x16x32_bf16 v[156:159], a[184:187], a[84:87], v[156:159]
    ds_read_b64_tr_b16 a[180:181], v18 offset:40960
    v_mfma_f32_16x16x32_bf16 v[156:159], a[188:191], a[92:95], v[156:159]
    s_waitcnt lgkmcnt(9)
    ds_read_b64_tr_b16 a[182:183], v18 offset:45056
    buffer_load_dwordx4 v44, s[16:19], s49 offen offset:2048 lds
    v_mfma_f32_16x16x32_bf16 v[160:163], a[160:163], a[80:83], v[160:163]
    s_waitcnt lgkmcnt(8)
    ds_read_b64_tr_b16 a[184:185], v19 offset:32768
    v_mfma_f32_16x16x32_bf16 v[160:163], a[164:167], a[88:91], v[160:163]
    ds_read_b64_tr_b16 a[186:187], v19 offset:36864
    v_mfma_f32_16x16x32_bf16 v[164:167], a[160:163], a[84:87], v[164:167]
    ds_read_b64_tr_b16 a[188:189], v19 offset:40960
    v_mfma_f32_16x16x32_bf16 v[164:167], a[164:167], a[92:95], v[164:167]
    s_waitcnt lgkmcnt(9)
    ds_read_b64_tr_b16 a[190:191], v19 offset:45056
    buffer_load_dwordx4 v45, s[16:19], s49 offen offset:3072 lds
    v_mfma_f32_16x16x32_bf16 v[168:171], a[168:171], a[80:83], v[168:171]
    s_waitcnt lgkmcnt(8)
    ds_read_b64_tr_b16 a[160:161], v12 offset:49152
    v_mfma_f32_16x16x32_bf16 v[168:171], a[172:175], a[88:91], v[168:171]
    s_add_u32 s49, s44, 4194560
    ds_read_b64_tr_b16 a[162:163], v12 offset:53248
    v_mfma_f32_16x16x32_bf16 v[172:175], a[168:171], a[84:87], v[172:175]
    s_add_u32 m0, s42, 147456
    ds_read_b64_tr_b16 a[164:165], v12 offset:57344
    v_mfma_f32_16x16x32_bf16 v[172:175], a[172:175], a[92:95], v[172:175]
    s_waitcnt lgkmcnt(9)
    ds_read_b64_tr_b16 a[166:167], v12 offset:61440
    buffer_load_dwordx4 v42, s[16:19], s49 offen lds
    v_mfma_f32_16x16x32_bf16 v[176:179], a[176:179], a[80:83], v[176:179]
    s_waitcnt lgkmcnt(8)
    ds_read_b64_tr_b16 a[168:169], v13 offset:49152
    v_mfma_f32_16x16x32_bf16 v[176:179], a[180:183], a[88:91], v[176:179]
    ds_read_b64_tr_b16 a[170:171], v13 offset:53248
    v_mfma_f32_16x16x32_bf16 v[180:183], a[176:179], a[84:87], v[180:183]
    ds_read_b64_tr_b16 a[172:173], v13 offset:57344
    v_mfma_f32_16x16x32_bf16 v[180:183], a[180:183], a[92:95], v[180:183]
    s_waitcnt lgkmcnt(9)
    ds_read_b64_tr_b16 a[174:175], v13 offset:61440
    buffer_load_dwordx4 v43, s[16:19], s49 offen offset:1024 lds
    v_mfma_f32_16x16x32_bf16 v[184:187], a[184:187], a[80:83], v[184:187]
    s_waitcnt lgkmcnt(8)
    ds_read_b64_tr_b16 a[176:177], v14 offset:49152
    v_mfma_f32_16x16x32_bf16 v[184:187], a[188:191], a[88:91], v[184:187]
    ds_read_b64_tr_b16 a[178:179], v14 offset:53248
    v_mfma_f32_16x16x32_bf16 v[188:191], a[184:187], a[84:87], v[188:191]
    ds_read_b64_tr_b16 a[180:181], v14 offset:57344
    v_mfma_f32_16x16x32_bf16 v[188:191], a[188:191], a[92:95], v[188:191]
    s_waitcnt lgkmcnt(9)
    ds_read_b64_tr_b16 a[182:183], v14 offset:61440
    buffer_load_dwordx4 v44, s[16:19], s49 offen offset:2048 lds
    v_mfma_f32_16x16x32_bf16 v[192:195], a[160:163], a[80:83], v[192:195]
    s_waitcnt lgkmcnt(8)
    ds_read_b64_tr_b16 a[184:185], v15 offset:49152
    v_mfma_f32_16x16x32_bf16 v[192:195], a[164:167], a[88:91], v[192:195]
    ds_read_b64_tr_b16 a[186:187], v15 offset:53248
    v_mfma_f32_16x16x32_bf16 v[196:199], a[160:163], a[84:87], v[196:199]
    ds_read_b64_tr_b16 a[188:189], v15 offset:57344
    v_mfma_f32_16x16x32_bf16 v[196:199], a[164:167], a[92:95], v[196:199]
    s_waitcnt lgkmcnt(9)
    ds_read_b64_tr_b16 a[190:191], v15 offset:61440
    buffer_load_dwordx4 v45, s[16:19], s49 offen offset:3072 lds
    v_mfma_f32_16x16x32_bf16 v[200:203], a[168:171], a[80:83], v[200:203]
    s_waitcnt lgkmcnt(8)
    ds_read_b64_tr_b16 a[160:161], v16 offset:49152
    v_mfma_f32_16x16x32_bf16 v[200:203], a[172:175], a[88:91], v[200:203]
    ds_read_b64_tr_b16 a[162:163], v16 offset:53248
    v_mfma_f32_16x16x32_bf16 v[204:207], a[168:171], a[84:87], v[204:207]
    ds_read_b64_tr_b16 a[164:165], v16 offset:57344
    v_mfma_f32_16x16x32_bf16 v[204:207], a[172:175], a[92:95], v[204:207]
    s_waitcnt lgkmcnt(9)
    ds_read_b64_tr_b16 a[166:167], v16 offset:61440
    v_mfma_f32_16x16x32_bf16 v[208:211], a[176:179], a[80:83], v[208:211]
    s_waitcnt lgkmcnt(8)
    ds_read_b64_tr_b16 a[168:169], v17 offset:49152
    v_mfma_f32_16x16x32_bf16 v[208:211], a[180:183], a[88:91], v[208:211]
    ds_read_b64_tr_b16 a[170:171], v17 offset:53248
    v_mfma_f32_16x16x32_bf16 v[212:215], a[176:179], a[84:87], v[212:215]
    ds_read_b64_tr_b16 a[172:173], v17 offset:57344
    v_mfma_f32_16x16x32_bf16 v[212:215], a[180:183], a[92:95], v[212:215]
    s_waitcnt lgkmcnt(9)
    ds_read_b64_tr_b16 a[174:175], v17 offset:61440
    v_mfma_f32_16x16x32_bf16 v[216:219], a[184:187], a[80:83], v[216:219]
    s_waitcnt lgkmcnt(8)
    ds_read_b64_tr_b16 a[176:177], v18 offset:49152
    v_mfma_f32_16x16x32_bf16 v[216:219], a[188:191], a[88:91], v[216:219]
    ds_read_b64_tr_b16 a[178:179], v18 offset:53248
    v_mfma_f32_16x16x32_bf16 v[220:223], a[184:187], a[84:87], v[220:223]
    ds_read_b64_tr_b16 a[180:181], v18 offset:57344
    v_mfma_f32_16x16x32_bf16 v[220:223], a[188:191], a[92:95], v[220:223]
    s_waitcnt lgkmcnt(9)
    ds_read_b64_tr_b16 a[182:183], v18 offset:61440
    v_mfma_f32_16x16x32_bf16 v[224:227], a[160:163], a[80:83], v[224:227]
    s_waitcnt lgkmcnt(8)
    ds_read_b64_tr_b16 a[184:185], v19 offset:49152
    v_mfma_f32_16x16x32_bf16 v[224:227], a[164:167], a[88:91], v[224:227]
    ds_read_b64_tr_b16 a[186:187], v19 offset:53248
    v_mfma_f32_16x16x32_bf16 v[228:231], a[160:163], a[84:87], v[228:231]
    ds_read_b64_tr_b16 a[188:189], v19 offset:57344
    v_mfma_f32_16x16x32_bf16 v[228:231], a[164:167], a[92:95], v[228:231]
    s_waitcnt lgkmcnt(9)
    ds_read_b64_tr_b16 a[190:191], v19 offset:61440
    s_waitcnt vmcnt(24)
    s_barrier
    v_mfma_f32_16x16x32_bf16 v[232:235], a[168:171], a[80:83], v[232:235]
    s_waitcnt lgkmcnt(8)
    ds_read_b64_tr_b16 a[160:161], v20 offset:0
    v_mfma_f32_16x16x32_bf16 v[232:235], a[172:175], a[88:91], v[232:235]
    ds_read_b64_tr_b16 a[162:163], v20 offset:4096
    v_mfma_f32_16x16x32_bf16 v[236:239], a[168:171], a[84:87], v[236:239]
    s_add_u32 m0, s42, 0
    ds_read_b64_tr_b16 a[164:165], v20 offset:8192
    v_mfma_f32_16x16x32_bf16 v[236:239], a[172:175], a[92:95], v[236:239]
    s_waitcnt lgkmcnt(9)
    ds_read_b64_tr_b16 a[166:167], v20 offset:12288
    buffer_load_dwordx4 v36, s[8:11], s40 offen lds
    v_mfma_f32_16x16x32_bf16 v[240:243], a[176:179], a[80:83], v[240:243]
    s_waitcnt lgkmcnt(8)
    ds_read_b64_tr_b16 a[168:169], v21 offset:0
    v_mfma_f32_16x16x32_bf16 v[240:243], a[180:183], a[88:91], v[240:243]
    ds_read_b64_tr_b16 a[170:171], v21 offset:4096
    v_mfma_f32_16x16x32_bf16 v[244:247], a[176:179], a[84:87], v[244:247]
    ds_read_b64_tr_b16 a[172:173], v21 offset:8192
    v_mfma_f32_16x16x32_bf16 v[244:247], a[180:183], a[92:95], v[244:247]
    s_waitcnt lgkmcnt(9)
    ds_read_b64_tr_b16 a[174:175], v21 offset:12288
    buffer_load_dwordx4 v37, s[8:11], s40 offen offset:1024 lds
    v_mfma_f32_16x16x32_bf16 v[248:251], a[184:187], a[80:83], v[248:251]
    s_waitcnt lgkmcnt(8)
    ds_read_b64_tr_b16 a[176:177], v22 offset:0
    v_mfma_f32_16x16x32_bf16 v[248:251], a[188:191], a[88:91], v[248:251]
    ds_read_b64_tr_b16 a[178:179], v22 offset:4096
    v_mfma_f32_16x16x32_bf16 v[252:255], a[184:187], a[84:87], v[252:255]
    ds_read_b64_tr_b16 a[180:181], v22 offset:8192
    v_mfma_f32_16x16x32_bf16 v[252:255], a[188:191], a[92:95], v[252:255]
    s_waitcnt lgkmcnt(9)
    ds_read_b64_tr_b16 a[182:183], v22 offset:12288
    buffer_load_dwordx4 v38, s[8:11], s40 offen offset:2048 lds
    v_mfma_f32_16x16x32_bf16 v[128:131], a[160:163], a[96:99], v[128:131]
    s_waitcnt lgkmcnt(8)
    ds_read_b64_tr_b16 a[184:185], v23 offset:0
    v_mfma_f32_16x16x32_bf16 v[128:131], a[164:167], a[104:107], v[128:131]
    ds_read_b64_tr_b16 a[186:187], v23 offset:4096
    v_mfma_f32_16x16x32_bf16 v[132:135], a[160:163], a[100:103], v[132:135]
    ds_read_b64_tr_b16 a[188:189], v23 offset:8192
    v_mfma_f32_16x16x32_bf16 v[132:135], a[164:167], a[108:111], v[132:135]
    s_waitcnt lgkmcnt(9)
    ds_read_b64_tr_b16 a[190:191], v23 offset:12288
    buffer_load_dwordx4 v39, s[8:11], s40 offen offset:3072 lds
    v_mfma_f32_16x16x32_bf16 v[136:139], a[168:171], a[96:99], v[136:139]
    s_waitcnt lgkmcnt(8)
    s_add_u32 s40, s40, 16384
    ds_read_b64_tr_b16 a[160:161], v24 offset:0
    v_mfma_f32_16x16x32_bf16 v[136:139], a[172:175], a[104:107], v[136:139]
    ds_read_b64_tr_b16 a[162:163], v24 offset:4096
    v_mfma_f32_16x16x32_bf16 v[140:143], a[168:171], a[100:103], v[140:143]
    s_add_u32 m0, s42, 16384
    ds_read_b64_tr_b16 a[164:165], v24 offset:8192
    v_mfma_f32_16x16x32_bf16 v[140:143], a[172:175], a[108:111], v[140:143]
    s_waitcnt lgkmcnt(9)
    ds_read_b64_tr_b16 a[166:167], v24 offset:12288
    buffer_load_dwordx4 v36, s[8:11], s40 offen lds
    v_mfma_f32_16x16x32_bf16 v[144:147], a[176:179], a[96:99], v[144:147]
    s_waitcnt lgkmcnt(8)
    ds_read_b64_tr_b16 a[168:169], v25 offset:0
    v_mfma_f32_16x16x32_bf16 v[144:147], a[180:183], a[104:107], v[144:147]
    ds_read_b64_tr_b16 a[170:171], v25 offset:4096
    v_mfma_f32_16x16x32_bf16 v[148:151], a[176:179], a[100:103], v[148:151]
    ds_read_b64_tr_b16 a[172:173], v25 offset:8192
    v_mfma_f32_16x16x32_bf16 v[148:151], a[180:183], a[108:111], v[148:151]
    s_waitcnt lgkmcnt(9)
    ds_read_b64_tr_b16 a[174:175], v25 offset:12288
    buffer_load_dwordx4 v37, s[8:11], s40 offen offset:1024 lds
    v_mfma_f32_16x16x32_bf16 v[152:155], a[184:187], a[96:99], v[152:155]
    s_waitcnt lgkmcnt(8)
    ds_read_b64_tr_b16 a[176:177], v26 offset:0
    v_mfma_f32_16x16x32_bf16 v[152:155], a[188:191], a[104:107], v[152:155]
    ds_read_b64_tr_b16 a[178:179], v26 offset:4096
    v_mfma_f32_16x16x32_bf16 v[156:159], a[184:187], a[100:103], v[156:159]
    ds_read_b64_tr_b16 a[180:181], v26 offset:8192
    v_mfma_f32_16x16x32_bf16 v[156:159], a[188:191], a[108:111], v[156:159]
    s_waitcnt lgkmcnt(9)
    ds_read_b64_tr_b16 a[182:183], v26 offset:12288
    buffer_load_dwordx4 v38, s[8:11], s40 offen offset:2048 lds
    v_mfma_f32_16x16x32_bf16 v[160:163], a[160:163], a[96:99], v[160:163]
    s_waitcnt lgkmcnt(8)
    ds_read_b64_tr_b16 a[184:185], v27 offset:0
    v_mfma_f32_16x16x32_bf16 v[160:163], a[164:167], a[104:107], v[160:163]
    ds_read_b64_tr_b16 a[186:187], v27 offset:4096
    v_mfma_f32_16x16x32_bf16 v[164:167], a[160:163], a[100:103], v[164:167]
    ds_read_b64_tr_b16 a[188:189], v27 offset:8192
    v_mfma_f32_16x16x32_bf16 v[164:167], a[164:167], a[108:111], v[164:167]
    s_waitcnt lgkmcnt(9)
    ds_read_b64_tr_b16 a[190:191], v27 offset:12288
    buffer_load_dwordx4 v39, s[8:11], s40 offen offset:3072 lds
    v_mfma_f32_16x16x32_bf16 v[168:171], a[168:171], a[96:99], v[168:171]
    s_waitcnt lgkmcnt(8)
    s_add_u32 s40, s40, 16384
    ds_read_b64_tr_b16 a[160:161], v20 offset:16384
    v_mfma_f32_16x16x32_bf16 v[168:171], a[172:175], a[104:107], v[168:171]
    ds_read_b64_tr_b16 a[162:163], v20 offset:20480
    v_mfma_f32_16x16x32_bf16 v[172:175], a[168:171], a[100:103], v[172:175]
    ds_read_b64_tr_b16 a[164:165], v20 offset:24576
    v_mfma_f32_16x16x32_bf16 v[172:175], a[172:175], a[108:111], v[172:175]
    s_waitcnt lgkmcnt(9)
    ds_read_b64_tr_b16 a[166:167], v20 offset:28672
    v_mfma_f32_16x16x32_bf16 v[176:179], a[176:179], a[96:99], v[176:179]
    s_waitcnt lgkmcnt(8)
    ds_read_b64_tr_b16 a[168:169], v21 offset:16384
    v_mfma_f32_16x16x32_bf16 v[176:179], a[180:183], a[104:107], v[176:179]
    ds_read_b64_tr_b16 a[170:171], v21 offset:20480
    v_mfma_f32_16x16x32_bf16 v[180:183], a[176:179], a[100:103], v[180:183]
    ds_read_b64_tr_b16 a[172:173], v21 offset:24576
    v_mfma_f32_16x16x32_bf16 v[180:183], a[180:183], a[108:111], v[180:183]
    s_waitcnt lgkmcnt(9)
    ds_read_b64_tr_b16 a[174:175], v21 offset:28672
    v_mfma_f32_16x16x32_bf16 v[184:187], a[184:187], a[96:99], v[184:187]
    s_waitcnt lgkmcnt(8)
    ds_read_b64_tr_b16 a[176:177], v22 offset:16384
    v_mfma_f32_16x16x32_bf16 v[184:187], a[188:191], a[104:107], v[184:187]
    ds_read_b64_tr_b16 a[178:179], v22 offset:20480
    v_mfma_f32_16x16x32_bf16 v[188:191], a[184:187], a[100:103], v[188:191]
    ds_read_b64_tr_b16 a[180:181], v22 offset:24576
    v_mfma_f32_16x16x32_bf16 v[188:191], a[188:191], a[108:111], v[188:191]
    s_waitcnt lgkmcnt(9)
    ds_read_b64_tr_b16 a[182:183], v22 offset:28672
    v_mfma_f32_16x16x32_bf16 v[192:195], a[160:163], a[96:99], v[192:195]
    s_waitcnt lgkmcnt(8)
    ds_read_b64_tr_b16 a[184:185], v23 offset:16384
    v_accvgpr_write_b32 a0, 0
    v_mfma_f32_16x16x32_bf16 v[192:195], a[164:167], a[104:107], v[192:195]
    ds_read_b64_tr_b16 a[186:187], v23 offset:20480
    v_accvgpr_write_b32 a1, 0
    v_mfma_f32_16x16x32_bf16 v[196:199], a[160:163], a[100:103], v[196:199]
    ds_read_b64_tr_b16 a[188:189], v23 offset:24576
    v_accvgpr_write_b32 a2, 0
    v_mfma_f32_16x16x32_bf16 v[196:199], a[164:167], a[108:111], v[196:199]
    s_waitcnt lgkmcnt(9)
    ds_read_b64_tr_b16 a[190:191], v23 offset:28672
    v_accvgpr_write_b32 a3, 0
    v_mfma_f32_16x16x32_bf16 v[200:203], a[168:171], a[96:99], v[200:203]
    s_waitcnt lgkmcnt(8)
    ds_read_b64_tr_b16 a[160:161], v24 offset:16384
    v_accvgpr_write_b32 a4, 0
    v_mfma_f32_16x16x32_bf16 v[200:203], a[172:175], a[104:107], v[200:203]
    ds_read_b64_tr_b16 a[162:163], v24 offset:20480
    v_accvgpr_write_b32 a5, 0
    v_mfma_f32_16x16x32_bf16 v[204:207], a[168:171], a[100:103], v[204:207]
    ds_read_b64_tr_b16 a[164:165], v24 offset:24576
    v_accvgpr_write_b32 a6, 0
    v_mfma_f32_16x16x32_bf16 v[204:207], a[172:175], a[108:111], v[204:207]
    s_waitcnt lgkmcnt(9)
    ds_read_b64_tr_b16 a[166:167], v24 offset:28672
    v_accvgpr_write_b32 a7, 0
    v_mfma_f32_16x16x32_bf16 v[208:211], a[176:179], a[96:99], v[208:211]
    s_waitcnt lgkmcnt(8)
    ds_read_b64_tr_b16 a[168:169], v25 offset:16384
    v_accvgpr_write_b32 a8, 0
    v_mfma_f32_16x16x32_bf16 v[208:211], a[180:183], a[104:107], v[208:211]
    ds_read_b64_tr_b16 a[170:171], v25 offset:20480
    v_accvgpr_write_b32 a9, 0
    v_mfma_f32_16x16x32_bf16 v[212:215], a[176:179], a[100:103], v[212:215]
    ds_read_b64_tr_b16 a[172:173], v25 offset:24576
    v_accvgpr_write_b32 a10, 0
    v_mfma_f32_16x16x32_bf16 v[212:215], a[180:183], a[108:111], v[212:215]
    s_waitcnt lgkmcnt(9)
    ds_read_b64_tr_b16 a[174:175], v25 offset:28672
    v_accvgpr_write_b32 a11, 0
    v_mfma_f32_16x16x32_bf16 v[216:219], a[184:187], a[96:99], v[216:219]
    s_waitcnt lgkmcnt(8)
    ds_read_b64_tr_b16 a[176:177], v26 offset:16384
    v_accvgpr_write_b32 a12, 0
    v_mfma_f32_16x16x32_bf16 v[216:219], a[188:191], a[104:107], v[216:219]
    ds_read_b64_tr_b16 a[178:179], v26 offset:20480
    v_accvgpr_write_b32 a13, 0
    v_mfma_f32_16x16x32_bf16 v[220:223], a[184:187], a[100:103], v[220:223]
    ds_read_b64_tr_b16 a[180:181], v26 offset:24576
    v_accvgpr_write_b32 a14, 0
    v_mfma_f32_16x16x32_bf16 v[220:223], a[188:191], a[108:111], v[220:223]
    s_waitcnt lgkmcnt(9)
    ds_read_b64_tr_b16 a[182:183], v26 offset:28672
    v_accvgpr_write_b32 a15, 0
    v_mfma_f32_16x16x32_bf16 v[224:227], a[160:163], a[96:99], v[224:227]
    s_waitcnt lgkmcnt(8)
    ds_read_b64_tr_b16 a[184:185], v27 offset:16384
    v_accvgpr_write_b32 a16, 0
    v_mfma_f32_16x16x32_bf16 v[224:227], a[164:167], a[104:107], v[224:227]
    ds_read_b64_tr_b16 a[186:187], v27 offset:20480
    v_accvgpr_write_b32 a17, 0
    v_mfma_f32_16x16x32_bf16 v[228:231], a[160:163], a[100:103], v[228:231]
    ds_read_b64_tr_b16 a[188:189], v27 offset:24576
    v_accvgpr_write_b32 a18, 0
    v_mfma_f32_16x16x32_bf16 v[228:231], a[164:167], a[108:111], v[228:231]
    s_waitcnt lgkmcnt(9)
    ds_read_b64_tr_b16 a[190:191], v27 offset:28672
    v_accvgpr_write_b32 a19, 0
    s_waitcnt vmcnt(20)
    s_barrier
    v_mfma_f32_16x16x32_bf16 v[232:235], a[168:171], a[96:99], v[232:235]
    s_waitcnt lgkmcnt(8)
    ds_read_b64_tr_b16 a[160:161], v20 offset:32768
    v_accvgpr_write_b32 a20, 0
    v_mfma_f32_16x16x32_bf16 v[232:235], a[172:175], a[104:107], v[232:235]
    ds_read_b64_tr_b16 a[162:163], v20 offset:36864
    v_accvgpr_write_b32 a21, 0
    v_mfma_f32_16x16x32_bf16 v[236:239], a[168:171], a[100:103], v[236:239]
    s_add_u32 m0, s42, 32768
    ds_read_b64_tr_b16 a[164:165], v20 offset:40960
    v_accvgpr_write_b32 a22, 0
    v_mfma_f32_16x16x32_bf16 v[236:239], a[172:175], a[108:111], v[236:239]
    s_waitcnt lgkmcnt(9)
    ds_read_b64_tr_b16 a[166:167], v20 offset:45056
    buffer_load_dwordx4 v36, s[8:11], s40 offen lds
    v_mfma_f32_16x16x32_bf16 v[240:243], a[176:179], a[96:99], v[240:243]
    s_waitcnt lgkmcnt(8)
    ds_read_b64_tr_b16 a[168:169], v21 offset:32768
    v_accvgpr_write_b32 a23, 0
    v_mfma_f32_16x16x32_bf16 v[240:243], a[180:183], a[104:107], v[240:243]
    ds_read_b64_tr_b16 a[170:171], v21 offset:36864
    v_accvgpr_write_b32 a24, 0
    v_mfma_f32_16x16x32_bf16 v[244:247], a[176:179], a[100:103], v[244:247]
    ds_read_b64_tr_b16 a[172:173], v21 offset:40960
    v_accvgpr_write_b32 a25, 0
    v_mfma_f32_16x16x32_bf16 v[244:247], a[180:183], a[108:111], v[244:247]
    s_waitcnt lgkmcnt(9)
    ds_read_b64_tr_b16 a[174:175], v21 offset:45056
    buffer_load_dwordx4 v37, s[8:11], s40 offen offset:1024 lds
    v_mfma_f32_16x16x32_bf16 v[248:251], a[184:187], a[96:99], v[248:251]
    s_waitcnt lgkmcnt(8)
    ds_read_b64_tr_b16 a[176:177], v22 offset:32768
    v_accvgpr_write_b32 a26, 0
    v_mfma_f32_16x16x32_bf16 v[248:251], a[188:191], a[104:107], v[248:251]
    ds_read_b64_tr_b16 a[178:179], v22 offset:36864
    v_accvgpr_write_b32 a27, 0
    v_mfma_f32_16x16x32_bf16 v[252:255], a[184:187], a[100:103], v[252:255]
    ds_read_b64_tr_b16 a[180:181], v22 offset:40960
    v_accvgpr_write_b32 a28, 0
    v_mfma_f32_16x16x32_bf16 v[252:255], a[188:191], a[108:111], v[252:255]
    s_waitcnt lgkmcnt(9)
    ds_read_b64_tr_b16 a[182:183], v22 offset:45056
    buffer_load_dwordx4 v38, s[8:11], s40 offen offset:2048 lds
    v_mfma_f32_16x16x32_bf16 v[128:131], a[160:163], a[112:115], v[128:131]
    s_waitcnt lgkmcnt(8)
    ds_read_b64_tr_b16 a[184:185], v23 offset:32768
    v_accvgpr_write_b32 a29, 0
    v_mfma_f32_16x16x32_bf16 v[128:131], a[164:167], a[120:123], v[128:131]
    ds_read_b64_tr_b16 a[186:187], v23 offset:36864
    v_accvgpr_write_b32 a30, 0
    v_mfma_f32_16x16x32_bf16 v[132:135], a[160:163], a[116:119], v[132:135]
    ds_read_b64_tr_b16 a[188:189], v23 offset:40960
    v_accvgpr_write_b32 a31, 0
    v_mfma_f32_16x16x32_bf16 v[132:135], a[164:167], a[124:127], v[132:135]
    s_waitcnt lgkmcnt(9)
    ds_read_b64_tr_b16 a[190:191], v23 offset:45056
    buffer_load_dwordx4 v39, s[8:11], s40 offen offset:3072 lds
    v_mfma_f32_16x16x32_bf16 v[136:139], a[168:171], a[112:115], v[136:139]
    s_waitcnt lgkmcnt(8)
    s_add_u32 s40, s40, 16384
    ds_read_b64_tr_b16 a[160:161], v24 offset:32768
    v_accvgpr_write_b32 a32, 0
    v_mfma_f32_16x16x32_bf16 v[136:139], a[172:175], a[120:123], v[136:139]
    ds_read_b64_tr_b16 a[162:163], v24 offset:36864
    v_accvgpr_write_b32 a33, 0
    v_mfma_f32_16x16x32_bf16 v[140:143], a[168:171], a[116:119], v[140:143]
    ds_read_b64_tr_b16 a[164:165], v24 offset:40960
    v_accvgpr_write_b32 a34, 0
    v_mfma_f32_16x16x32_bf16 v[140:143], a[172:175], a[124:127], v[140:143]
    s_waitcnt lgkmcnt(9)
    ds_read_b64_tr_b16 a[166:167], v24 offset:45056
    v_accvgpr_write_b32 a35, 0
    v_mfma_f32_16x16x32_bf16 v[144:147], a[176:179], a[112:115], v[144:147]
    s_waitcnt lgkmcnt(8)
    ds_read_b64_tr_b16 a[168:169], v25 offset:32768
    v_accvgpr_write_b32 a36, 0
    v_mfma_f32_16x16x32_bf16 v[144:147], a[180:183], a[120:123], v[144:147]
    ds_read_b64_tr_b16 a[170:171], v25 offset:36864
    v_accvgpr_write_b32 a37, 0
    v_mfma_f32_16x16x32_bf16 v[148:151], a[176:179], a[116:119], v[148:151]
    ds_read_b64_tr_b16 a[172:173], v25 offset:40960
    v_accvgpr_write_b32 a38, 0
    v_mfma_f32_16x16x32_bf16 v[148:151], a[180:183], a[124:127], v[148:151]
    s_waitcnt lgkmcnt(9)
    ds_read_b64_tr_b16 a[174:175], v25 offset:45056
    v_accvgpr_write_b32 a39, 0
    v_mfma_f32_16x16x32_bf16 v[152:155], a[184:187], a[112:115], v[152:155]
    s_waitcnt lgkmcnt(8)
    ds_read_b64_tr_b16 a[176:177], v26 offset:32768
    v_accvgpr_write_b32 a40, 0
    v_mfma_f32_16x16x32_bf16 v[152:155], a[188:191], a[120:123], v[152:155]
    ds_read_b64_tr_b16 a[178:179], v26 offset:36864
    v_accvgpr_write_b32 a41, 0
    v_mfma_f32_16x16x32_bf16 v[156:159], a[184:187], a[116:119], v[156:159]
    ds_read_b64_tr_b16 a[180:181], v26 offset:40960
    v_accvgpr_write_b32 a42, 0
    v_mfma_f32_16x16x32_bf16 v[156:159], a[188:191], a[124:127], v[156:159]
    s_waitcnt lgkmcnt(9)
    ds_read_b64_tr_b16 a[182:183], v26 offset:45056
    v_accvgpr_write_b32 a43, 0
    v_mfma_f32_16x16x32_bf16 v[160:163], a[160:163], a[112:115], v[160:163]
    s_waitcnt lgkmcnt(8)
    ds_read_b64_tr_b16 a[184:185], v27 offset:32768
    v_accvgpr_write_b32 a44, 0
    v_mfma_f32_16x16x32_bf16 v[160:163], a[164:167], a[120:123], v[160:163]
    ds_read_b64_tr_b16 a[186:187], v27 offset:36864
    v_accvgpr_write_b32 a45, 0
    v_mfma_f32_16x16x32_bf16 v[164:167], a[160:163], a[116:119], v[164:167]
    ds_read_b64_tr_b16 a[188:189], v27 offset:40960
    v_accvgpr_write_b32 a46, 0
    v_mfma_f32_16x16x32_bf16 v[164:167], a[164:167], a[124:127], v[164:167]
    s_waitcnt lgkmcnt(9)
    ds_read_b64_tr_b16 a[190:191], v27 offset:45056
    v_accvgpr_write_b32 a47, 0
    v_mfma_f32_16x16x32_bf16 v[168:171], a[168:171], a[112:115], v[168:171]
    s_waitcnt lgkmcnt(8)
    ds_read_b64_tr_b16 a[160:161], v20 offset:49152
    v_accvgpr_write_b32 a48, 0
    v_mfma_f32_16x16x32_bf16 v[168:171], a[172:175], a[120:123], v[168:171]
    ds_read_b64_tr_b16 a[162:163], v20 offset:53248
    v_accvgpr_write_b32 a49, 0
    v_mfma_f32_16x16x32_bf16 v[172:175], a[168:171], a[116:119], v[172:175]
    ds_read_b64_tr_b16 a[164:165], v20 offset:57344
    v_accvgpr_write_b32 a50, 0
    v_mfma_f32_16x16x32_bf16 v[172:175], a[172:175], a[124:127], v[172:175]
    s_waitcnt lgkmcnt(9)
    ds_read_b64_tr_b16 a[166:167], v20 offset:61440
    v_accvgpr_write_b32 a51, 0
    v_mfma_f32_16x16x32_bf16 v[176:179], a[176:179], a[112:115], v[176:179]
    s_waitcnt lgkmcnt(8)
    ds_read_b64_tr_b16 a[168:169], v21 offset:49152
    v_accvgpr_write_b32 a52, 0
    v_mfma_f32_16x16x32_bf16 v[176:179], a[180:183], a[120:123], v[176:179]
    ds_read_b64_tr_b16 a[170:171], v21 offset:53248
    v_accvgpr_write_b32 a53, 0
    v_mfma_f32_16x16x32_bf16 v[180:183], a[176:179], a[116:119], v[180:183]
    ds_read_b64_tr_b16 a[172:173], v21 offset:57344
    v_accvgpr_write_b32 a54, 0
    v_mfma_f32_16x16x32_bf16 v[180:183], a[180:183], a[124:127], v[180:183]
    s_waitcnt lgkmcnt(9)
    ds_read_b64_tr_b16 a[174:175], v21 offset:61440
    v_accvgpr_write_b32 a55, 0
    v_mfma_f32_16x16x32_bf16 v[184:187], a[184:187], a[112:115], v[184:187]
    s_waitcnt lgkmcnt(8)
    ds_read_b64_tr_b16 a[176:177], v22 offset:49152
    v_accvgpr_write_b32 a56, 0
    v_mfma_f32_16x16x32_bf16 v[184:187], a[188:191], a[120:123], v[184:187]
    ds_read_b64_tr_b16 a[178:179], v22 offset:53248
    v_accvgpr_write_b32 a57, 0
    v_mfma_f32_16x16x32_bf16 v[188:191], a[184:187], a[116:119], v[188:191]
    ds_read_b64_tr_b16 a[180:181], v22 offset:57344
    v_accvgpr_write_b32 a58, 0
    v_mfma_f32_16x16x32_bf16 v[188:191], a[188:191], a[124:127], v[188:191]
    s_waitcnt lgkmcnt(9)
    ds_read_b64_tr_b16 a[182:183], v22 offset:61440
    v_accvgpr_write_b32 a59, 0
    v_mfma_f32_16x16x32_bf16 v[192:195], a[160:163], a[112:115], v[192:195]
    s_waitcnt lgkmcnt(8)
    ds_read_b64_tr_b16 a[184:185], v23 offset:49152
    v_accvgpr_write_b32 a60, 0
    v_mfma_f32_16x16x32_bf16 v[192:195], a[164:167], a[120:123], v[192:195]
    ds_read_b64_tr_b16 a[186:187], v23 offset:53248
    v_accvgpr_write_b32 a61, 0
    v_mfma_f32_16x16x32_bf16 v[196:199], a[160:163], a[116:119], v[196:199]
    ds_read_b64_tr_b16 a[188:189], v23 offset:57344
    v_accvgpr_write_b32 a62, 0
    v_mfma_f32_16x16x32_bf16 v[196:199], a[164:167], a[124:127], v[196:199]
    s_waitcnt lgkmcnt(9)
    ds_read_b64_tr_b16 a[190:191], v23 offset:61440
    v_accvgpr_write_b32 a63, 0
    v_mfma_f32_16x16x32_bf16 v[200:203], a[168:171], a[112:115], v[200:203]
    s_waitcnt lgkmcnt(8)
    ds_read_b64_tr_b16 a[160:161], v24 offset:49152
    v_accvgpr_write_b32 a64, 0
    v_mfma_f32_16x16x32_bf16 v[200:203], a[172:175], a[120:123], v[200:203]
    ds_read_b64_tr_b16 a[162:163], v24 offset:53248
    v_accvgpr_write_b32 a65, 0
    v_mfma_f32_16x16x32_bf16 v[204:207], a[168:171], a[116:119], v[204:207]
    ds_read_b64_tr_b16 a[164:165], v24 offset:57344
    v_accvgpr_write_b32 a66, 0
    v_mfma_f32_16x16x32_bf16 v[204:207], a[172:175], a[124:127], v[204:207]
    s_waitcnt lgkmcnt(9)
    ds_read_b64_tr_b16 a[166:167], v24 offset:61440
    v_accvgpr_write_b32 a67, 0
    v_mfma_f32_16x16x32_bf16 v[208:211], a[176:179], a[112:115], v[208:211]
    s_waitcnt lgkmcnt(8)
    ds_read_b64_tr_b16 a[168:169], v25 offset:49152
    v_accvgpr_write_b32 a68, 0
    v_mfma_f32_16x16x32_bf16 v[208:211], a[180:183], a[120:123], v[208:211]
    ds_read_b64_tr_b16 a[170:171], v25 offset:53248
    v_accvgpr_write_b32 a69, 0
    v_mfma_f32_16x16x32_bf16 v[212:215], a[176:179], a[116:119], v[212:215]
    ds_read_b64_tr_b16 a[172:173], v25 offset:57344
    v_accvgpr_write_b32 a70, 0
    v_mfma_f32_16x16x32_bf16 v[212:215], a[180:183], a[124:127], v[212:215]
    s_waitcnt lgkmcnt(9)
    ds_read_b64_tr_b16 a[174:175], v25 offset:61440
    v_accvgpr_write_b32 a71, 0
    v_mfma_f32_16x16x32_bf16 v[216:219], a[184:187], a[112:115], v[216:219]
    s_waitcnt lgkmcnt(8)
    ds_read_b64_tr_b16 a[176:177], v26 offset:49152
    v_accvgpr_write_b32 a72, 0
    v_mfma_f32_16x16x32_bf16 v[216:219], a[188:191], a[120:123], v[216:219]
    ds_read_b64_tr_b16 a[178:179], v26 offset:53248
    v_accvgpr_write_b32 a73, 0
    v_mfma_f32_16x16x32_bf16 v[220:223], a[184:187], a[116:119], v[220:223]
    ds_read_b64_tr_b16 a[180:181], v26 offset:57344
    v_accvgpr_write_b32 a74, 0
    v_mfma_f32_16x16x32_bf16 v[220:223], a[188:191], a[124:127], v[220:223]
    s_waitcnt lgkmcnt(9)
    ds_read_b64_tr_b16 a[182:183], v26 offset:61440
    v_accvgpr_write_b32 a75, 0
    v_mfma_f32_16x16x32_bf16 v[224:227], a[160:163], a[112:115], v[224:227]
    s_waitcnt lgkmcnt(8)
    ds_read_b64_tr_b16 a[184:185], v27 offset:49152
    v_accvgpr_write_b32 a76, 0
    v_mfma_f32_16x16x32_bf16 v[224:227], a[164:167], a[120:123], v[224:227]
    ds_read_b64_tr_b16 a[186:187], v27 offset:53248
    v_accvgpr_write_b32 a77, 0
    v_mfma_f32_16x16x32_bf16 v[228:231], a[160:163], a[116:119], v[228:231]
    ds_read_b64_tr_b16 a[188:189], v27 offset:57344
    v_accvgpr_write_b32 a78, 0
    v_mfma_f32_16x16x32_bf16 v[228:231], a[164:167], a[124:127], v[228:231]
    s_waitcnt lgkmcnt(9)
    ds_read_b64_tr_b16 a[190:191], v27 offset:61440
    v_accvgpr_write_b32 a79, 0
    s_waitcnt vmcnt(12)
    s_barrier
    v_mfma_f32_16x16x32_bf16 v[232:235], a[168:171], a[112:115], v[232:235]
    s_waitcnt lgkmcnt(8)
    ds_read_b64_tr_b16 a[160:161], v28 offset:0
    v_accvgpr_write_b32 a80, 0
    v_mfma_f32_16x16x32_bf16 v[232:235], a[172:175], a[120:123], v[232:235]
    ds_read_b64_tr_b16 a[162:163], v28 offset:4096
    v_accvgpr_write_b32 a81, 0
    v_mfma_f32_16x16x32_bf16 v[236:239], a[168:171], a[116:119], v[236:239]
    s_add_u32 m0, s42, 65536
    ds_read_b64_tr_b16 a[164:165], v28 offset:8192
    v_accvgpr_write_b32 a82, 0
    v_mfma_f32_16x16x32_bf16 v[236:239], a[172:175], a[124:127], v[236:239]
    s_waitcnt lgkmcnt(9)
    ds_read_b64_tr_b16 a[166:167], v28 offset:12288
    buffer_load_dwordx4 v40, s[12:15], s41 offen lds
    v_mfma_f32_16x16x32_bf16 v[240:243], a[176:179], a[112:115], v[240:243]
    s_waitcnt lgkmcnt(8)
    ds_read_b64_tr_b16 a[168:169], v29 offset:0
    v_accvgpr_write_b32 a83, 0
    v_mfma_f32_16x16x32_bf16 v[240:243], a[180:183], a[120:123], v[240:243]
    ds_read_b64_tr_b16 a[170:171], v29 offset:4096
    v_accvgpr_write_b32 a84, 0
    v_mfma_f32_16x16x32_bf16 v[244:247], a[176:179], a[116:119], v[244:247]
    ds_read_b64_tr_b16 a[172:173], v29 offset:8192
    v_accvgpr_write_b32 a85, 0
    v_mfma_f32_16x16x32_bf16 v[244:247], a[180:183], a[124:127], v[244:247]
    s_waitcnt lgkmcnt(9)
    ds_read_b64_tr_b16 a[174:175], v29 offset:12288
    buffer_load_dwordx4 v41, s[12:15], s41 offen offset:1024 lds
    v_mfma_f32_16x16x32_bf16 v[248:251], a[184:187], a[112:115], v[248:251]
    s_waitcnt lgkmcnt(8)
    ds_read_b64_tr_b16 a[176:177], v30 offset:0
    v_accvgpr_write_b32 a86, 0
    v_mfma_f32_16x16x32_bf16 v[248:251], a[188:191], a[120:123], v[248:251]
    ds_read_b64_tr_b16 a[178:179], v30 offset:4096
    v_accvgpr_write_b32 a87, 0
    v_mfma_f32_16x16x32_bf16 v[252:255], a[184:187], a[116:119], v[252:255]
    ds_read_b64_tr_b16 a[180:181], v30 offset:8192
    v_accvgpr_write_b32 a88, 0
    v_mfma_f32_16x16x32_bf16 v[252:255], a[188:191], a[124:127], v[252:255]
    s_waitcnt lgkmcnt(9)
    ds_read_b64_tr_b16 a[182:183], v30 offset:12288
    buffer_load_dwordx4 v40, s[12:15], s41 offen offset:2048 lds
    v_mfma_f32_16x16x32_bf16 v[128:131], a[160:163], a[128:131], v[128:131]
    s_waitcnt lgkmcnt(8)
    ds_read_b64_tr_b16 a[184:185], v31 offset:0
    v_accvgpr_write_b32 a89, 0
    v_mfma_f32_16x16x32_bf16 v[128:131], a[164:167], a[136:139], v[128:131]
    ds_read_b64_tr_b16 a[186:187], v31 offset:4096
    v_accvgpr_write_b32 a90, 0
    v_mfma_f32_16x16x32_bf16 v[132:135], a[160:163], a[132:135], v[132:135]
    ds_read_b64_tr_b16 a[188:189], v31 offset:8192
    v_accvgpr_write_b32 a91, 0
    v_mfma_f32_16x16x32_bf16 v[132:135], a[164:167], a[140:143], v[132:135]
    s_waitcnt lgkmcnt(9)
    ds_read_b64_tr_b16 a[190:191], v31 offset:12288
    buffer_load_dwordx4 v41, s[12:15], s41 offen offset:3072 lds
    v_mfma_f32_16x16x32_bf16 v[136:139], a[168:171], a[128:131], v[136:139]
    s_waitcnt lgkmcnt(8)
    s_add_u32 s41, s41, 16384
    ds_read_b64_tr_b16 a[160:161], v32 offset:0
    v_accvgpr_write_b32 a92, 0
    v_mfma_f32_16x16x32_bf16 v[136:139], a[172:175], a[136:139], v[136:139]
    ds_read_b64_tr_b16 a[162:163], v32 offset:4096
    v_accvgpr_write_b32 a93, 0
    v_mfma_f32_16x16x32_bf16 v[140:143], a[168:171], a[132:135], v[140:143]
    s_add_u32 m0, s42, 81920
    ds_read_b64_tr_b16 a[164:165], v32 offset:8192
    v_accvgpr_write_b32 a94, 0
    v_mfma_f32_16x16x32_bf16 v[140:143], a[172:175], a[140:143], v[140:143]
    s_waitcnt lgkmcnt(9)
    ds_read_b64_tr_b16 a[166:167], v32 offset:12288
    buffer_load_dwordx4 v40, s[12:15], s41 offen lds
    v_mfma_f32_16x16x32_bf16 v[144:147], a[176:179], a[128:131], v[144:147]
    s_waitcnt lgkmcnt(8)
    ds_read_b64_tr_b16 a[168:169], v33 offset:0
    v_accvgpr_write_b32 a95, 0
    v_mfma_f32_16x16x32_bf16 v[144:147], a[180:183], a[136:139], v[144:147]
    ds_read_b64_tr_b16 a[170:171], v33 offset:4096
    v_accvgpr_write_b32 a96, 0
    v_mfma_f32_16x16x32_bf16 v[148:151], a[176:179], a[132:135], v[148:151]
    ds_read_b64_tr_b16 a[172:173], v33 offset:8192
    v_accvgpr_write_b32 a97, 0
    v_mfma_f32_16x16x32_bf16 v[148:151], a[180:183], a[140:143], v[148:151]
    s_waitcnt lgkmcnt(9)
    ds_read_b64_tr_b16 a[174:175], v33 offset:12288
    buffer_load_dwordx4 v41, s[12:15], s41 offen offset:1024 lds
    v_mfma_f32_16x16x32_bf16 v[152:155], a[184:187], a[128:131], v[152:155]
    s_waitcnt lgkmcnt(8)
    ds_read_b64_tr_b16 a[176:177], v34 offset:0
    v_accvgpr_write_b32 a98, 0
    v_mfma_f32_16x16x32_bf16 v[152:155], a[188:191], a[136:139], v[152:155]
    ds_read_b64_tr_b16 a[178:179], v34 offset:4096
    v_accvgpr_write_b32 a99, 0
    v_mfma_f32_16x16x32_bf16 v[156:159], a[184:187], a[132:135], v[156:159]
    ds_read_b64_tr_b16 a[180:181], v34 offset:8192
    v_accvgpr_write_b32 a100, 0
    v_mfma_f32_16x16x32_bf16 v[156:159], a[188:191], a[140:143], v[156:159]
    s_waitcnt lgkmcnt(9)
    ds_read_b64_tr_b16 a[182:183], v34 offset:12288
    buffer_load_dwordx4 v40, s[12:15], s41 offen offset:2048 lds
    v_mfma_f32_16x16x32_bf16 v[160:163], a[160:163], a[128:131], v[160:163]
    s_waitcnt lgkmcnt(8)
    ds_read_b64_tr_b16 a[184:185], v35 offset:0
    v_accvgpr_write_b32 a101, 0
    v_mfma_f32_16x16x32_bf16 v[160:163], a[164:167], a[136:139], v[160:163]
    ds_read_b64_tr_b16 a[186:187], v35 offset:4096
    v_accvgpr_write_b32 a102, 0
    v_mfma_f32_16x16x32_bf16 v[164:167], a[160:163], a[132:135], v[164:167]
    ds_read_b64_tr_b16 a[188:189], v35 offset:8192
    v_accvgpr_write_b32 a103, 0
    v_mfma_f32_16x16x32_bf16 v[164:167], a[164:167], a[140:143], v[164:167]
    s_waitcnt lgkmcnt(9)
    ds_read_b64_tr_b16 a[190:191], v35 offset:12288
    buffer_load_dwordx4 v41, s[12:15], s41 offen offset:3072 lds
    v_mfma_f32_16x16x32_bf16 v[168:171], a[168:171], a[128:131], v[168:171]
    s_waitcnt lgkmcnt(8)
    s_add_u32 s41, s41, 16384
    ds_read_b64_tr_b16 a[160:161], v28 offset:16384
    v_accvgpr_write_b32 a104, 0
    v_mfma_f32_16x16x32_bf16 v[168:171], a[172:175], a[136:139], v[168:171]
    ds_read_b64_tr_b16 a[162:163], v28 offset:20480
    v_accvgpr_write_b32 a105, 0
    v_mfma_f32_16x16x32_bf16 v[172:175], a[168:171], a[132:135], v[172:175]
    ds_read_b64_tr_b16 a[164:165], v28 offset:24576
    v_accvgpr_write_b32 a106, 0
    v_mfma_f32_16x16x32_bf16 v[172:175], a[172:175], a[140:143], v[172:175]
    s_waitcnt lgkmcnt(9)
    ds_read_b64_tr_b16 a[166:167], v28 offset:28672
    v_accvgpr_write_b32 a107, 0
    v_mfma_f32_16x16x32_bf16 v[176:179], a[176:179], a[128:131], v[176:179]
    s_waitcnt lgkmcnt(8)
    ds_read_b64_tr_b16 a[168:169], v29 offset:16384
    v_accvgpr_write_b32 a108, 0
    v_mfma_f32_16x16x32_bf16 v[176:179], a[180:183], a[136:139], v[176:179]
    ds_read_b64_tr_b16 a[170:171], v29 offset:20480
    v_accvgpr_write_b32 a109, 0
    v_mfma_f32_16x16x32_bf16 v[180:183], a[176:179], a[132:135], v[180:183]
    ds_read_b64_tr_b16 a[172:173], v29 offset:24576
    v_accvgpr_write_b32 a110, 0
    v_mfma_f32_16x16x32_bf16 v[180:183], a[180:183], a[140:143], v[180:183]
    s_waitcnt lgkmcnt(9)
    ds_read_b64_tr_b16 a[174:175], v29 offset:28672
    v_accvgpr_write_b32 a111, 0
    v_mfma_f32_16x16x32_bf16 v[184:187], a[184:187], a[128:131], v[184:187]
    s_waitcnt lgkmcnt(8)
    ds_read_b64_tr_b16 a[176:177], v30 offset:16384
    v_accvgpr_write_b32 a192, 0
    v_mfma_f32_16x16x32_bf16 v[184:187], a[188:191], a[136:139], v[184:187]
    ds_read_b64_tr_b16 a[178:179], v30 offset:20480
    v_accvgpr_write_b32 a193, 0
    v_mfma_f32_16x16x32_bf16 v[188:191], a[184:187], a[132:135], v[188:191]
    ds_read_b64_tr_b16 a[180:181], v30 offset:24576
    v_accvgpr_write_b32 a194, 0
    v_mfma_f32_16x16x32_bf16 v[188:191], a[188:191], a[140:143], v[188:191]
    s_waitcnt lgkmcnt(9)
    ds_read_b64_tr_b16 a[182:183], v30 offset:28672
    v_accvgpr_write_b32 a195, 0
    v_mfma_f32_16x16x32_bf16 v[192:195], a[160:163], a[128:131], v[192:195]
    s_waitcnt lgkmcnt(8)
    ds_read_b64_tr_b16 a[184:185], v31 offset:16384
    v_accvgpr_write_b32 a196, 0
    v_mfma_f32_16x16x32_bf16 v[192:195], a[164:167], a[136:139], v[192:195]
    ds_read_b64_tr_b16 a[186:187], v31 offset:20480
    v_accvgpr_write_b32 a197, 0
    v_mfma_f32_16x16x32_bf16 v[196:199], a[160:163], a[132:135], v[196:199]
    ds_read_b64_tr_b16 a[188:189], v31 offset:24576
    v_accvgpr_write_b32 a198, 0
    v_mfma_f32_16x16x32_bf16 v[196:199], a[164:167], a[140:143], v[196:199]
    s_waitcnt lgkmcnt(9)
    ds_read_b64_tr_b16 a[190:191], v31 offset:28672
    v_accvgpr_write_b32 a199, 0
    v_mfma_f32_16x16x32_bf16 v[200:203], a[168:171], a[128:131], v[200:203]
    s_waitcnt lgkmcnt(8)
    ds_read_b64_tr_b16 a[160:161], v32 offset:16384
    v_accvgpr_write_b32 a200, 0
    v_mfma_f32_16x16x32_bf16 v[200:203], a[172:175], a[136:139], v[200:203]
    ds_read_b64_tr_b16 a[162:163], v32 offset:20480
    v_accvgpr_write_b32 a201, 0
    v_mfma_f32_16x16x32_bf16 v[204:207], a[168:171], a[132:135], v[204:207]
    ds_read_b64_tr_b16 a[164:165], v32 offset:24576
    v_accvgpr_write_b32 a202, 0
    v_mfma_f32_16x16x32_bf16 v[204:207], a[172:175], a[140:143], v[204:207]
    s_waitcnt lgkmcnt(9)
    ds_read_b64_tr_b16 a[166:167], v32 offset:28672
    v_accvgpr_write_b32 a203, 0
    v_mfma_f32_16x16x32_bf16 v[208:211], a[176:179], a[128:131], v[208:211]
    s_waitcnt lgkmcnt(8)
    ds_read_b64_tr_b16 a[168:169], v33 offset:16384
    v_accvgpr_write_b32 a204, 0
    v_mfma_f32_16x16x32_bf16 v[208:211], a[180:183], a[136:139], v[208:211]
    ds_read_b64_tr_b16 a[170:171], v33 offset:20480
    v_accvgpr_write_b32 a205, 0
    v_mfma_f32_16x16x32_bf16 v[212:215], a[176:179], a[132:135], v[212:215]
    ds_read_b64_tr_b16 a[172:173], v33 offset:24576
    v_accvgpr_write_b32 a206, 0
    v_mfma_f32_16x16x32_bf16 v[212:215], a[180:183], a[140:143], v[212:215]
    s_waitcnt lgkmcnt(9)
    ds_read_b64_tr_b16 a[174:175], v33 offset:28672
    v_accvgpr_write_b32 a207, 0
    v_mfma_f32_16x16x32_bf16 v[216:219], a[184:187], a[128:131], v[216:219]
    s_waitcnt lgkmcnt(8)
    ds_read_b64_tr_b16 a[176:177], v34 offset:16384
    v_accvgpr_write_b32 a112, 0
    v_mfma_f32_16x16x32_bf16 v[216:219], a[188:191], a[136:139], v[216:219]
    ds_read_b64_tr_b16 a[178:179], v34 offset:20480
    v_accvgpr_write_b32 a113, 0
    v_mfma_f32_16x16x32_bf16 v[220:223], a[184:187], a[132:135], v[220:223]
    ds_read_b64_tr_b16 a[180:181], v34 offset:24576
    v_accvgpr_write_b32 a114, 0
    v_mfma_f32_16x16x32_bf16 v[220:223], a[188:191], a[140:143], v[220:223]
    s_waitcnt lgkmcnt(9)
    ds_read_b64_tr_b16 a[182:183], v34 offset:28672
    v_accvgpr_write_b32 a115, 0
    v_mfma_f32_16x16x32_bf16 v[224:227], a[160:163], a[128:131], v[224:227]
    s_waitcnt lgkmcnt(8)
    ds_read_b64_tr_b16 a[184:185], v35 offset:16384
    v_accvgpr_write_b32 a116, 0
    v_mfma_f32_16x16x32_bf16 v[224:227], a[164:167], a[136:139], v[224:227]
    ds_read_b64_tr_b16 a[186:187], v35 offset:20480
    v_accvgpr_write_b32 a117, 0
    v_mfma_f32_16x16x32_bf16 v[228:231], a[160:163], a[132:135], v[228:231]
    ds_read_b64_tr_b16 a[188:189], v35 offset:24576
    v_accvgpr_write_b32 a118, 0
    v_mfma_f32_16x16x32_bf16 v[228:231], a[164:167], a[140:143], v[228:231]
    s_waitcnt lgkmcnt(9)
    ds_read_b64_tr_b16 a[190:191], v35 offset:28672
    v_accvgpr_write_b32 a119, 0
    v_mfma_f32_16x16x32_bf16 v[232:235], a[168:171], a[128:131], v[232:235]
    s_waitcnt lgkmcnt(8)
    v_accvgpr_write_b32 a120, 0
    v_mfma_f32_16x16x32_bf16 v[232:235], a[172:175], a[136:139], v[232:235]
    v_accvgpr_write_b32 a121, 0
    v_mfma_f32_16x16x32_bf16 v[236:239], a[168:171], a[132:135], v[236:239]
    v_accvgpr_write_b32 a122, 0
    v_mfma_f32_16x16x32_bf16 v[236:239], a[172:175], a[140:143], v[236:239]
    s_waitcnt lgkmcnt(6)
    v_accvgpr_write_b32 a123, 0
    s_waitcnt vmcnt(16)
    s_barrier
    v_mfma_f32_16x16x32_bf16 v[240:243], a[176:179], a[128:131], v[240:243]
    s_waitcnt lgkmcnt(4)
    ds_read_b128 a[208:211], v8 offset:0
    v_accvgpr_write_b32 a124, 0
    v_mfma_f32_16x16x32_bf16 v[240:243], a[180:183], a[136:139], v[240:243]
    ds_read_b128 a[212:215], v9 offset:0
    v_accvgpr_write_b32 a125, 0
    v_mfma_f32_16x16x32_bf16 v[244:247], a[176:179], a[132:135], v[244:247]
    ds_read_b128 a[216:219], v10 offset:0
    v_accvgpr_write_b32 a126, 0
    v_mfma_f32_16x16x32_bf16 v[244:247], a[180:183], a[140:143], v[244:247]
    s_waitcnt lgkmcnt(5)
    ds_read_b128 a[220:223], v11 offset:0
    v_accvgpr_write_b32 a127, 0
    v_mfma_f32_16x16x32_bf16 v[248:251], a[184:187], a[128:131], v[248:251]
    s_waitcnt lgkmcnt(4)
    ds_read_b128 a[224:227], v8 offset:4096
    v_mfma_f32_16x16x32_bf16 v[248:251], a[188:191], a[136:139], v[248:251]
    v_mfma_f32_16x16x32_bf16 v[252:255], a[184:187], a[132:135], v[252:255]
    v_mfma_f32_16x16x32_bf16 v[252:255], a[188:191], a[140:143], v[252:255]
    s_waitcnt lgkmcnt(4)
    s_mov_b32 s36, 1040356334
    s_mov_b32 s37, 1040356334
    v_pk_mul_f32 v[128:129], v[128:129], s[36:37]
    v_pk_mul_f32 v[130:131], v[130:131], s[36:37]
    v_pk_mul_f32 v[136:137], v[136:137], s[36:37]
    v_pk_mul_f32 v[138:139], v[138:139], s[36:37]
    v_cvt_pk_bf16_f32 v64, v128, v129
    v_cvt_pk_bf16_f32 v65, v130, v131
    v_cvt_pk_bf16_f32 v66, v136, v137
    v_cvt_pk_bf16_f32 v67, v138, v139
    v_pk_mul_f32 v[132:133], v[132:133], s[36:37]
    v_pk_mul_f32 v[134:135], v[134:135], s[36:37]
    v_pk_mul_f32 v[140:141], v[140:141], s[36:37]
    v_pk_mul_f32 v[142:143], v[142:143], s[36:37]
    v_cvt_pk_bf16_f32 v80, v132, v133
    v_cvt_pk_bf16_f32 v81, v134, v135
    v_cvt_pk_bf16_f32 v82, v140, v141
    v_cvt_pk_bf16_f32 v83, v142, v143
    v_permlane32_swap_b32 v64, v66
    v_permlane32_swap_b32 v65, v67
    v_permlane32_swap_b32 v80, v82
    v_permlane32_swap_b32 v81, v83
    v_permlane16_swap_b32 v64, v66
    v_permlane16_swap_b32 v65, v67
    v_permlane16_swap_b32 v80, v82
    v_permlane16_swap_b32 v81, v83
    v_pk_mul_f32 v[144:145], v[144:145], s[36:37]
    v_pk_mul_f32 v[146:147], v[146:147], s[36:37]
    v_pk_mul_f32 v[152:153], v[152:153], s[36:37]
    v_pk_mul_f32 v[154:155], v[154:155], s[36:37]
    v_cvt_pk_bf16_f32 v68, v144, v145
    v_cvt_pk_bf16_f32 v69, v146, v147
    v_cvt_pk_bf16_f32 v70, v152, v153
    v_cvt_pk_bf16_f32 v71, v154, v155
    v_pk_mul_f32 v[148:149], v[148:149], s[36:37]
    v_pk_mul_f32 v[150:151], v[150:151], s[36:37]
    v_pk_mul_f32 v[156:157], v[156:157], s[36:37]
    v_pk_mul_f32 v[158:159], v[158:159], s[36:37]
    v_cvt_pk_bf16_f32 v84, v148, v149
    v_cvt_pk_bf16_f32 v85, v150, v151
    v_cvt_pk_bf16_f32 v86, v156, v157
    v_cvt_pk_bf16_f32 v87, v158, v159
    v_permlane32_swap_b32 v68, v70
    v_permlane32_swap_b32 v69, v71
    v_permlane32_swap_b32 v84, v86
    v_permlane32_swap_b32 v85, v87
    v_permlane16_swap_b32 v68, v70
    v_permlane16_swap_b32 v69, v71
    v_permlane16_swap_b32 v84, v86
    v_permlane16_swap_b32 v85, v87
    v_pk_mul_f32 v[160:161], v[160:161], s[36:37]
    v_pk_mul_f32 v[162:163], v[162:163], s[36:37]
    v_pk_mul_f32 v[168:169], v[168:169], s[36:37]
    v_pk_mul_f32 v[170:171], v[170:171], s[36:37]
    v_cvt_pk_bf16_f32 v72, v160, v161
    v_cvt_pk_bf16_f32 v73, v162, v163
    v_cvt_pk_bf16_f32 v74, v168, v169
    v_cvt_pk_bf16_f32 v75, v170, v171
    v_pk_mul_f32 v[164:165], v[164:165], s[36:37]
    v_pk_mul_f32 v[166:167], v[166:167], s[36:37]
    v_pk_mul_f32 v[172:173], v[172:173], s[36:37]
    v_pk_mul_f32 v[174:175], v[174:175], s[36:37]
    v_cvt_pk_bf16_f32 v88, v164, v165
    v_cvt_pk_bf16_f32 v89, v166, v167
    v_cvt_pk_bf16_f32 v90, v172, v173
    v_cvt_pk_bf16_f32 v91, v174, v175
    v_permlane32_swap_b32 v72, v74
    v_permlane32_swap_b32 v73, v75
    v_permlane32_swap_b32 v88, v90
    v_permlane32_swap_b32 v89, v91
    v_permlane16_swap_b32 v72, v74
    v_permlane16_swap_b32 v73, v75
    v_permlane16_swap_b32 v88, v90
    v_permlane16_swap_b32 v89, v91
    v_pk_mul_f32 v[176:177], v[176:177], s[36:37]
    v_pk_mul_f32 v[178:179], v[178:179], s[36:37]
    v_pk_mul_f32 v[184:185], v[184:185], s[36:37]
    v_pk_mul_f32 v[186:187], v[186:187], s[36:37]
    v_cvt_pk_bf16_f32 v76, v176, v177
    v_cvt_pk_bf16_f32 v77, v178, v179
    v_cvt_pk_bf16_f32 v78, v184, v185
    v_cvt_pk_bf16_f32 v79, v186, v187
    v_pk_mul_f32 v[180:181], v[180:181], s[36:37]
    v_pk_mul_f32 v[182:183], v[182:183], s[36:37]
    v_pk_mul_f32 v[188:189], v[188:189], s[36:37]
    v_pk_mul_f32 v[190:191], v[190:191], s[36:37]
    v_cvt_pk_bf16_f32 v92, v180, v181
    v_cvt_pk_bf16_f32 v93, v182, v183
    v_cvt_pk_bf16_f32 v94, v188, v189
    v_cvt_pk_bf16_f32 v95, v190, v191
    v_permlane32_swap_b32 v76, v78
    v_permlane32_swap_b32 v77, v79
    v_permlane32_swap_b32 v92, v94
    v_permlane32_swap_b32 v93, v95
    v_permlane16_swap_b32 v76, v78
    v_permlane16_swap_b32 v77, v79
    v_permlane16_swap_b32 v92, v94
    v_permlane16_swap_b32 v93, v95
    v_pk_mul_f32 v[192:193], v[192:193], s[36:37]
    v_pk_mul_f32 v[194:195], v[194:195], s[36:37]
    v_pk_mul_f32 v[200:201], v[200:201], s[36:37]
    v_pk_mul_f32 v[202:203], v[202:203], s[36:37]
    v_cvt_pk_bf16_f32 v96, v192, v193
    v_cvt_pk_bf16_f32 v97, v194, v195
    v_cvt_pk_bf16_f32 v98, v200, v201
    v_cvt_pk_bf16_f32 v99, v202, v203
    v_pk_mul_f32 v[196:197], v[196:197], s[36:37]
    v_pk_mul_f32 v[198:199], v[198:199], s[36:37]
    v_pk_mul_f32 v[204:205], v[204:205], s[36:37]
    v_pk_mul_f32 v[206:207], v[206:207], s[36:37]
    v_cvt_pk_bf16_f32 v112, v196, v197
    v_cvt_pk_bf16_f32 v113, v198, v199
    v_cvt_pk_bf16_f32 v114, v204, v205
    v_cvt_pk_bf16_f32 v115, v206, v207
    v_permlane32_swap_b32 v96, v98
    v_permlane32_swap_b32 v97, v99
    v_permlane32_swap_b32 v112, v114
    v_permlane32_swap_b32 v113, v115
    v_permlane16_swap_b32 v96, v98
    v_permlane16_swap_b32 v97, v99
    v_permlane16_swap_b32 v112, v114
    v_permlane16_swap_b32 v113, v115
    v_pk_mul_f32 v[208:209], v[208:209], s[36:37]
    v_pk_mul_f32 v[210:211], v[210:211], s[36:37]
    v_pk_mul_f32 v[216:217], v[216:217], s[36:37]
    v_pk_mul_f32 v[218:219], v[218:219], s[36:37]
    v_cvt_pk_bf16_f32 v100, v208, v209
    v_cvt_pk_bf16_f32 v101, v210, v211
    v_cvt_pk_bf16_f32 v102, v216, v217
    v_cvt_pk_bf16_f32 v103, v218, v219
    v_pk_mul_f32 v[212:213], v[212:213], s[36:37]
    v_pk_mul_f32 v[214:215], v[214:215], s[36:37]
    v_pk_mul_f32 v[220:221], v[220:221], s[36:37]
    v_pk_mul_f32 v[222:223], v[222:223], s[36:37]
    v_cvt_pk_bf16_f32 v116, v212, v213
    v_cvt_pk_bf16_f32 v117, v214, v215
    v_cvt_pk_bf16_f32 v118, v220, v221
    v_cvt_pk_bf16_f32 v119, v222, v223
    v_permlane32_swap_b32 v100, v102
    v_permlane32_swap_b32 v101, v103
    v_permlane32_swap_b32 v116, v118
    v_permlane32_swap_b32 v117, v119
    v_permlane16_swap_b32 v100, v102
    v_permlane16_swap_b32 v101, v103
    v_permlane16_swap_b32 v116, v118
    v_permlane16_swap_b32 v117, v119
    v_pk_mul_f32 v[224:225], v[224:225], s[36:37]
    v_pk_mul_f32 v[226:227], v[226:227], s[36:37]
    v_pk_mul_f32 v[232:233], v[232:233], s[36:37]
    v_pk_mul_f32 v[234:235], v[234:235], s[36:37]
    v_cvt_pk_bf16_f32 v104, v224, v225
    v_cvt_pk_bf16_f32 v105, v226, v227
    v_cvt_pk_bf16_f32 v106, v232, v233
    v_cvt_pk_bf16_f32 v107, v234, v235
    v_pk_mul_f32 v[228:229], v[228:229], s[36:37]
    v_pk_mul_f32 v[230:231], v[230:231], s[36:37]
    v_pk_mul_f32 v[236:237], v[236:237], s[36:37]
    v_pk_mul_f32 v[238:239], v[238:239], s[36:37]
    v_cvt_pk_bf16_f32 v120, v228, v229
    v_cvt_pk_bf16_f32 v121, v230, v231
    v_cvt_pk_bf16_f32 v122, v236, v237
    v_cvt_pk_bf16_f32 v123, v238, v239
    v_permlane32_swap_b32 v104, v106
    v_permlane32_swap_b32 v105, v107
    v_permlane32_swap_b32 v120, v122
    v_permlane32_swap_b32 v121, v123
    v_permlane16_swap_b32 v104, v106
    v_permlane16_swap_b32 v105, v107
    v_permlane16_swap_b32 v120, v122
    v_permlane16_swap_b32 v121, v123
    v_pk_mul_f32 v[240:241], v[240:241], s[36:37]
    v_pk_mul_f32 v[242:243], v[242:243], s[36:37]
    v_pk_mul_f32 v[248:249], v[248:249], s[36:37]
    v_pk_mul_f32 v[250:251], v[250:251], s[36:37]
    v_cvt_pk_bf16_f32 v108, v240, v241
    v_cvt_pk_bf16_f32 v109, v242, v243
    v_cvt_pk_bf16_f32 v110, v248, v249
    v_cvt_pk_bf16_f32 v111, v250, v251
    v_pk_mul_f32 v[244:245], v[244:245], s[36:37]
    v_pk_mul_f32 v[246:247], v[246:247], s[36:37]
    v_pk_mul_f32 v[252:253], v[252:253], s[36:37]
    v_pk_mul_f32 v[254:255], v[254:255], s[36:37]
    v_cvt_pk_bf16_f32 v124, v244, v245
    v_cvt_pk_bf16_f32 v125, v246, v247
    v_cvt_pk_bf16_f32 v126, v252, v253
    v_cvt_pk_bf16_f32 v127, v254, v255
    v_permlane32_swap_b32 v108, v110
    v_permlane32_swap_b32 v109, v111
    v_permlane32_swap_b32 v124, v126
    v_permlane32_swap_b32 v125, v127
    v_permlane16_swap_b32 v108, v110
    v_permlane16_swap_b32 v109, v111
    v_permlane16_swap_b32 v124, v126
    v_permlane16_swap_b32 v125, v127
    v_mfma_f32_16x16x32_bf16 v[216:219], a[208:211], v[64:67], 0
    s_waitcnt lgkmcnt(3)
    v_mfma_f32_16x16x32_bf16 v[216:219], a[212:215], v[68:71], v[216:219]
    s_waitcnt lgkmcnt(2)
    v_mfma_f32_16x16x32_bf16 v[216:219], a[216:219], v[72:75], v[216:219]
    s_waitcnt lgkmcnt(1)
    v_mfma_f32_16x16x32_bf16 v[216:219], a[220:223], v[76:79], v[216:219]
    v_mfma_f32_16x16x32_bf16 v[220:223], a[208:211], v[80:83], 0
    v_mfma_f32_16x16x32_bf16 v[220:223], a[212:215], v[84:87], v[220:223]
    v_mfma_f32_16x16x32_bf16 v[220:223], a[216:219], v[88:91], v[220:223]
    v_mfma_f32_16x16x32_bf16 v[220:223], a[220:223], v[92:95], v[220:223]
    v_mfma_f32_16x16x32_bf16 v[224:227], a[208:211], v[96:99], 0
    v_mfma_f32_16x16x32_bf16 v[224:227], a[212:215], v[100:103], v[224:227]
    v_mfma_f32_16x16x32_bf16 v[224:227], a[216:219], v[104:107], v[224:227]
    v_mfma_f32_16x16x32_bf16 v[224:227], a[220:223], v[108:111], v[224:227]
    v_mfma_f32_16x16x32_bf16 v[228:231], a[208:211], v[112:115], 0
    v_mfma_f32_16x16x32_bf16 v[228:231], a[212:215], v[116:119], v[228:231]
    v_mfma_f32_16x16x32_bf16 v[228:231], a[216:219], v[120:123], v[228:231]
    v_mfma_f32_16x16x32_bf16 v[228:231], a[220:223], v[124:127], v[228:231]
    v_max3_f32 v232, v216, v217, v218
    v_max_f32 v232, v232, v219
    v_max3_f32 v233, v220, v221, v222
    v_max_f32 v233, v233, v223
    v_max3_f32 v234, v224, v225, v226
    v_max_f32 v234, v234, v227
    s_nop 1
    v_max3_f32 v235, v228, v229, v230
    v_max_f32 v235, v235, v231
    v_mov_b32 v236, v232
    v_mov_b32 v237, v233
    v_mov_b32 v238, v234
    v_mov_b32 v239, v235
    v_permlane16_swap_b32 v232, v236
    v_permlane16_swap_b32 v233, v237
    v_permlane16_swap_b32 v234, v238
    v_permlane16_swap_b32 v235, v239
    v_max_f32 v232, v232, v236
    v_max_f32 v233, v233, v237
    v_max_f32 v234, v234, v238
    v_max_f32 v235, v235, v239
    v_mov_b32 v236, v232
    v_mov_b32 v237, v233
    v_mov_b32 v238, v234
    v_mov_b32 v239, v235
    v_permlane32_swap_b32 v232, v236
    v_permlane32_swap_b32 v233, v237
    v_permlane32_swap_b32 v234, v238
    v_permlane32_swap_b32 v235, v239
    v_max_f32 v232, v232, v236
    v_max_f32 v233, v233, v237
    v_max_f32 v234, v234, v238
    v_max_f32 v235, v235, v239
    v_sub_f32 v192, 0, v232
    v_sub_f32 v193, 0, v232
    v_sub_f32 v194, 0, v232
    v_sub_f32 v195, 0, v232
    v_sub_f32 v196, 0, v233
    v_sub_f32 v197, 0, v233
    v_sub_f32 v198, 0, v233
    v_sub_f32 v199, 0, v233
    v_sub_f32 v200, 0, v234
    v_sub_f32 v201, 0, v234
    v_sub_f32 v202, 0, v234
    v_sub_f32 v203, 0, v234
    v_sub_f32 v204, 0, v235
    v_sub_f32 v205, 0, v235
    v_sub_f32 v206, 0, v235
    v_sub_f32 v207, 0, v235
Lattn_stage0:
    s_mov_b32 s43, 7
    v_mfma_f32_16x16x32_bf16 v[208:211], a[208:211], v[64:67], v[192:195]
    v_mfma_f32_16x16x32_bf16 v[208:211], a[212:215], v[68:71], v[208:211]
    v_mfma_f32_16x16x32_bf16 v[208:211], a[216:219], v[72:75], v[208:211]
    v_mfma_f32_16x16x32_bf16 v[208:211], a[220:223], v[76:79], v[208:211]
    ds_read_b128 a[228:231], v9 offset:4096
    v_mfma_f32_16x16x32_bf16 v[212:215], a[208:211], v[80:83], v[196:199]
    s_nop 5
    v_exp_f32 v208, v208
    v_mfma_f32_16x16x32_bf16 v[212:215], a[212:215], v[84:87], v[212:215]
    v_exp_f32 v209, v209
    v_mfma_f32_16x16x32_bf16 v[212:215], a[216:219], v[88:91], v[212:215]
    v_exp_f32 v210, v210
    v_mfma_f32_16x16x32_bf16 v[212:215], a[220:223], v[92:95], v[212:215]
    v_exp_f32 v211, v211
    v_cvt_pk_bf16_f32 v128, v208, v209
    ds_read_b128 a[232:235], v10 offset:4096
    v_cvt_pk_bf16_f32 v129, v210, v211
    v_mfma_f32_16x16x32_bf16 v[208:211], a[208:211], v[96:99], v[200:203]
    s_nop 2
    v_exp_f32 v212, v212
    v_mfma_f32_16x16x32_bf16 v[208:211], a[212:215], v[100:103], v[208:211]
    v_exp_f32 v213, v213
    v_mfma_f32_16x16x32_bf16 v[208:211], a[216:219], v[104:107], v[208:211]
    v_exp_f32 v214, v214
    v_mfma_f32_16x16x32_bf16 v[208:211], a[220:223], v[108:111], v[208:211]
    v_exp_f32 v215, v215
    v_cvt_pk_bf16_f32 v136, v212, v213
    ds_read_b128 a[236:239], v11 offset:4096
    v_cvt_pk_bf16_f32 v137, v214, v215
    s_mul_i32 s49, s5, 18432
    s_add_u32 s49, s49, s45
    v_lshlrev_b32 v220, 6, v0
    v_mfma_f32_16x16x32_bf16 v[212:215], a[208:211], v[112:115], v[204:207]
    v_exp_f32 v208, v208
    v_mfma_f32_16x16x32_bf16 v[212:215], a[212:215], v[116:119], v[212:215]
    v_exp_f32 v209, v209
    v_mfma_f32_16x16x32_bf16 v[212:215], a[216:219], v[120:123], v[212:215]
    v_exp_f32 v210, v210
    v_mfma_f32_16x16x32_bf16 v[212:215], a[220:223], v[124:127], v[212:215]
    s_waitcnt lgkmcnt(3)
    v_exp_f32 v211, v211
    v_cvt_pk_bf16_f32 v144, v208, v209
    ds_read_b128 a[208:211], v8 offset:8192
    v_cvt_pk_bf16_f32 v145, v210, v211
    buffer_load_dword v221, v220, s[20:23], s49 offen
    v_mfma_f32_16x16x32_bf16 v[208:211], a[224:227], v[64:67], v[192:195]
    s_waitcnt lgkmcnt(3)
    v_exp_f32 v212, v212
    v_mfma_f32_16x16x32_bf16 v[208:211], a[228:231], v[68:71], v[208:211]
    s_waitcnt lgkmcnt(2)
    v_exp_f32 v213, v213
    v_mfma_f32_16x16x32_bf16 v[208:211], a[232:235], v[72:75], v[208:211]
    s_waitcnt lgkmcnt(1)
    v_exp_f32 v214, v214
    v_mfma_f32_16x16x32_bf16 v[208:211], a[236:239], v[76:79], v[208:211]
    v_exp_f32 v215, v215
    v_cvt_pk_bf16_f32 v152, v212, v213
    ds_read_b128 a[212:215], v9 offset:8192
    v_cvt_pk_bf16_f32 v153, v214, v215
    s_add_u32 s49, s49, 16384
    v_mfma_f32_16x16x32_bf16 v[212:215], a[224:227], v[80:83], v[196:199]
    s_nop 1
    v_exp_f32 v208, v208
    v_mfma_f32_16x16x32_bf16 v[212:215], a[228:231], v[84:87], v[212:215]
    v_exp_f32 v209, v209
    v_mfma_f32_16x16x32_bf16 v[212:215], a[232:235], v[88:91], v[212:215]
    v_exp_f32 v210, v210
    v_mfma_f32_16x16x32_bf16 v[212:215], a[236:239], v[92:95], v[212:215]
    v_exp_f32 v211, v211
    v_cvt_pk_bf16_f32 v130, v208, v209
    ds_read_b128 a[216:219], v10 offset:8192
    v_cvt_pk_bf16_f32 v131, v210, v211
    buffer_load_dword v222, v220, s[20:23], s49 offen
    v_mfma_f32_16x16x32_bf16 v[208:211], a[224:227], v[96:99], v[200:203]
    s_nop 1
    v_exp_f32 v212, v212
    v_mfma_f32_16x16x32_bf16 v[208:211], a[228:231], v[100:103], v[208:211]
    v_exp_f32 v213, v213
    v_mfma_f32_16x16x32_bf16 v[208:211], a[232:235], v[104:107], v[208:211]
    v_exp_f32 v214, v214
    v_mfma_f32_16x16x32_bf16 v[208:211], a[236:239], v[108:111], v[208:211]
    v_exp_f32 v215, v215
    v_cvt_pk_bf16_f32 v138, v212, v213
    ds_read_b128 a[220:223], v11 offset:8192
    v_cvt_pk_bf16_f32 v139, v214, v215
    v_mfma_f32_16x16x32_bf16 v[212:215], a[224:227], v[112:115], v[204:207]
    s_nop 2
    v_exp_f32 v208, v208
    v_mfma_f32_16x16x32_bf16 v[212:215], a[228:231], v[116:119], v[212:215]
    v_exp_f32 v209, v209
    v_mfma_f32_16x16x32_bf16 v[212:215], a[232:235], v[120:123], v[212:215]
    v_exp_f32 v210, v210
    v_mfma_f32_16x16x32_bf16 v[212:215], a[236:239], v[124:127], v[212:215]
    s_waitcnt lgkmcnt(3)
    v_exp_f32 v211, v211
    v_cvt_pk_bf16_f32 v146, v208, v209
    ds_read_b128 a[224:227], v8 offset:12288
    v_cvt_pk_bf16_f32 v147, v210, v211
    v_mfma_f32_16x16x32_bf16 v[208:211], a[208:211], v[64:67], v[192:195]
    s_waitcnt lgkmcnt(3)
    s_nop 0
    v_exp_f32 v212, v212
    v_mfma_f32_16x16x32_bf16 v[208:211], a[212:215], v[68:71], v[208:211]
    s_waitcnt lgkmcnt(2)
    v_exp_f32 v213, v213
    v_mfma_f32_16x16x32_bf16 v[208:211], a[216:219], v[72:75], v[208:211]
    s_waitcnt lgkmcnt(1)
    v_exp_f32 v214, v214
    v_mfma_f32_16x16x32_bf16 v[208:211], a[220:223], v[76:79], v[208:211]
    v_exp_f32 v215, v215
    v_cvt_pk_bf16_f32 v154, v212, v213
    ds_read_b128 a[228:231], v9 offset:12288
    v_cvt_pk_bf16_f32 v155, v214, v215
    v_mfma_f32_16x16x32_bf16 v[212:215], a[208:211], v[80:83], v[196:199]
    s_nop 2
    v_exp_f32 v208, v208
    v_mfma_f32_16x16x32_bf16 v[212:215], a[212:215], v[84:87], v[212:215]
    v_exp_f32 v209, v209
    v_mfma_f32_16x16x32_bf16 v[212:215], a[216:219], v[88:91], v[212:215]
    v_exp_f32 v210, v210
    v_mfma_f32_16x16x32_bf16 v[212:215], a[220:223], v[92:95], v[212:215]
    v_exp_f32 v211, v211
    v_cvt_pk_bf16_f32 v132, v208, v209
    ds_read_b128 a[232:235], v10 offset:12288
    v_cvt_pk_bf16_f32 v133, v210, v211
    v_mfma_f32_16x16x32_bf16 v[208:211], a[208:211], v[96:99], v[200:203]
    s_nop 2
    v_exp_f32 v212, v212
    v_mfma_f32_16x16x32_bf16 v[208:211], a[212:215], v[100:103], v[208:211]
    v_exp_f32 v213, v213
    v_mfma_f32_16x16x32_bf16 v[208:211], a[216:219], v[104:107], v[208:211]
    v_exp_f32 v214, v214
    v_mfma_f32_16x16x32_bf16 v[208:211], a[220:223], v[108:111], v[208:211]
    v_exp_f32 v215, v215
    v_cvt_pk_bf16_f32 v140, v212, v213
    ds_read_b128 a[236:239], v11 offset:12288
    v_cvt_pk_bf16_f32 v141, v214, v215
    s_waitcnt vmcnt(6)
    s_barrier
    v_mfma_f32_16x16x32_bf16 v[212:215], a[208:211], v[112:115], v[204:207]
    s_nop 0
    v_exp_f32 v208, v208
    v_mfma_f32_16x16x32_bf16 v[212:215], a[212:215], v[116:119], v[212:215]
    s_add_u32 m0, s42, 49152
    v_exp_f32 v209, v209
    v_mfma_f32_16x16x32_bf16 v[212:215], a[216:219], v[120:123], v[212:215]
    v_exp_f32 v210, v210
    v_mfma_f32_16x16x32_bf16 v[212:215], a[220:223], v[124:127], v[212:215]
    s_waitcnt lgkmcnt(3)
    v_exp_f32 v211, v211
    v_cvt_pk_bf16_f32 v148, v208, v209
    ds_read_b128 a[208:211], v8 offset:16384
    v_cvt_pk_bf16_f32 v149, v210, v211
    buffer_load_dwordx4 v36, s[8:11], s40 offen lds
    v_mfma_f32_16x16x32_bf16 v[208:211], a[224:227], v[64:67], v[192:195]
    s_waitcnt lgkmcnt(3)
    v_exp_f32 v212, v212
    v_mfma_f32_16x16x32_bf16 v[208:211], a[228:231], v[68:71], v[208:211]
    s_waitcnt lgkmcnt(2)
    v_exp_f32 v213, v213
    v_mfma_f32_16x16x32_bf16 v[208:211], a[232:235], v[72:75], v[208:211]
    s_waitcnt lgkmcnt(1)
    v_exp_f32 v214, v214
    v_mfma_f32_16x16x32_bf16 v[208:211], a[236:239], v[76:79], v[208:211]
    v_exp_f32 v215, v215
    v_cvt_pk_bf16_f32 v156, v212, v213
    ds_read_b128 a[212:215], v9 offset:16384
    v_cvt_pk_bf16_f32 v157, v214, v215
    v_mfma_f32_16x16x32_bf16 v[212:215], a[224:227], v[80:83], v[196:199]
    s_nop 2
    v_exp_f32 v208, v208
    v_mfma_f32_16x16x32_bf16 v[212:215], a[228:231], v[84:87], v[212:215]
    v_exp_f32 v209, v209
    v_mfma_f32_16x16x32_bf16 v[212:215], a[232:235], v[88:91], v[212:215]
    v_exp_f32 v210, v210
    v_mfma_f32_16x16x32_bf16 v[212:215], a[236:239], v[92:95], v[212:215]
    v_exp_f32 v211, v211
    ds_read_b64_tr_b16 a[160:161], v20 offset:0
    v_cvt_pk_bf16_f32 v134, v208, v209
    ds_read_b64_tr_b16 a[162:163], v20 offset:4096
    ds_read_b128 a[216:219], v10 offset:16384
    v_cvt_pk_bf16_f32 v135, v210, v211
    buffer_load_dwordx4 v37, s[8:11], s40 offen offset:1024 lds
    v_mfma_f32_16x16x32_bf16 v[208:211], a[224:227], v[96:99], v[200:203]
    v_exp_f32 v212, v212
    v_mfma_f32_16x16x32_bf16 v[208:211], a[228:231], v[100:103], v[208:211]
    v_exp_f32 v213, v213
    v_mfma_f32_16x16x32_bf16 v[208:211], a[232:235], v[104:107], v[208:211]
    v_exp_f32 v214, v214
    v_mfma_f32_16x16x32_bf16 v[208:211], a[236:239], v[108:111], v[208:211]
    v_exp_f32 v215, v215
    ds_read_b64_tr_b16 a[164:165], v20 offset:8192
    v_cvt_pk_bf16_f32 v142, v212, v213
    ds_read_b64_tr_b16 a[166:167], v20 offset:12288
    ds_read_b128 a[220:223], v11 offset:16384
    v_cvt_pk_bf16_f32 v143, v214, v215
    v_mfma_f32_16x16x32_bf16 v[212:215], a[224:227], v[112:115], v[204:207]
    s_nop 0
    v_exp_f32 v208, v208
    v_mfma_f32_16x16x32_bf16 v[212:215], a[228:231], v[116:119], v[212:215]
    v_exp_f32 v209, v209
    v_mfma_f32_16x16x32_bf16 v[212:215], a[232:235], v[120:123], v[212:215]
    v_exp_f32 v210, v210
    v_mfma_f32_16x16x32_bf16 v[212:215], a[236:239], v[124:127], v[212:215]
    v_exp_f32 v211, v211
    ds_read_b64_tr_b16 a[168:169], v21 offset:0
    v_cvt_pk_bf16_f32 v150, v208, v209
    ds_read_b64_tr_b16 a[170:171], v21 offset:4096
    ds_read_b128 a[224:227], v8 offset:20480
    v_cvt_pk_bf16_f32 v151, v210, v211
    s_waitcnt lgkmcnt(3)
    buffer_load_dwordx4 v38, s[8:11], s40 offen offset:2048 lds
Lattn_loop:
    v_mfma_f32_16x16x32_bf16 v[208:211], a[208:211], v[64:67], v[192:195]
    v_exp_f32 v212, v212
    v_mfma_f32_16x16x32_bf16 v[208:211], a[212:215], v[68:71], v[208:211]
    v_exp_f32 v213, v213
    v_mfma_f32_16x16x32_bf16 v[208:211], a[216:219], v[72:75], v[208:211]
    v_exp_f32 v214, v214
    v_mfma_f32_16x16x32_bf16 v[208:211], a[220:223], v[76:79], v[208:211]
    v_exp_f32 v215, v215
    v_mfma_f32_16x16x32_bf16 a[0:3], a[160:163], v[128:131], a[0:3]
    ds_read_b64_tr_b16 a[172:173], v21 offset:8192
    v_cvt_pk_bf16_f32 v158, v212, v213
    v_mfma_f32_16x16x32_bf16 a[0:3], a[164:167], v[132:135], a[0:3]
    ds_read_b64_tr_b16 a[174:175], v21 offset:12288
    v_mfma_f32_16x16x32_bf16 a[4:7], a[160:163], v[136:139], a[4:7]
    ds_read_b128 a[228:231], v9 offset:20480
    v_cvt_pk_bf16_f32 v159, v214, v215
    v_mfma_f32_16x16x32_bf16 a[4:7], a[164:167], v[140:143], a[4:7]
    v_mfma_f32_16x16x32_bf16 v[212:215], a[208:211], v[80:83], v[196:199]
    v_exp_f32 v208, v208
    v_mfma_f32_16x16x32_bf16 v[212:215], a[212:215], v[84:87], v[212:215]
    v_exp_f32 v209, v209
    v_mfma_f32_16x16x32_bf16 v[212:215], a[216:219], v[88:91], v[212:215]
    v_exp_f32 v210, v210
    v_mfma_f32_16x16x32_bf16 v[212:215], a[220:223], v[92:95], v[212:215]
    v_exp_f32 v211, v211
    v_mfma_f32_16x16x32_bf16 a[8:11], a[160:163], v[144:147], a[8:11]
    ds_read_b64_tr_b16 a[176:177], v22 offset:0
    v_cvt_pk_bf16_f32 v160, v208, v209
    v_mfma_f32_16x16x32_bf16 a[8:11], a[164:167], v[148:151], a[8:11]
    ds_read_b64_tr_b16 a[178:179], v22 offset:4096
    v_mfma_f32_16x16x32_bf16 a[12:15], a[160:163], v[152:155], a[12:15]
    ds_read_b128 a[232:235], v10 offset:20480
    v_cvt_pk_bf16_f32 v161, v210, v211
    v_mfma_f32_16x16x32_bf16 a[12:15], a[164:167], v[156:159], a[12:15]
    s_waitcnt lgkmcnt(3)
    buffer_load_dwordx4 v39, s[8:11], s40 offen offset:3072 lds
    v_mfma_f32_16x16x32_bf16 v[208:211], a[208:211], v[96:99], v[200:203]
    v_exp_f32 v212, v212
    v_mfma_f32_16x16x32_bf16 v[208:211], a[212:215], v[100:103], v[208:211]
    s_add_u32 s40, s40, 16384
    v_exp_f32 v213, v213
    v_mfma_f32_16x16x32_bf16 v[208:211], a[216:219], v[104:107], v[208:211]
    v_exp_f32 v214, v214
    v_mfma_f32_16x16x32_bf16 v[208:211], a[220:223], v[108:111], v[208:211]
    v_exp_f32 v215, v215
    v_mfma_f32_16x16x32_bf16 a[16:19], a[168:171], v[128:131], a[16:19]
    ds_read_b64_tr_b16 a[180:181], v22 offset:8192
    v_cvt_pk_bf16_f32 v168, v212, v213
    v_mfma_f32_16x16x32_bf16 a[16:19], a[172:175], v[132:135], a[16:19]
    ds_read_b64_tr_b16 a[182:183], v22 offset:12288
    v_mfma_f32_16x16x32_bf16 a[20:23], a[168:171], v[136:139], a[20:23]
    ds_read_b128 a[236:239], v11 offset:20480
    v_cvt_pk_bf16_f32 v169, v214, v215
    v_mfma_f32_16x16x32_bf16 a[20:23], a[172:175], v[140:143], a[20:23]
    v_smfmac_f32_16x16x64_bf16 a[192:195], v[52:55], v[128:135], v50
    v_mfma_f32_16x16x32_bf16 v[212:215], a[208:211], v[112:115], v[204:207]
    v_exp_f32 v208, v208
    v_mfma_f32_16x16x32_bf16 v[212:215], a[212:215], v[116:119], v[212:215]
    s_add_u32 m0, s42, 98304
    v_exp_f32 v209, v209
    v_mfma_f32_16x16x32_bf16 v[212:215], a[216:219], v[120:123], v[212:215]
    v_exp_f32 v210, v210
    v_mfma_f32_16x16x32_bf16 v[212:215], a[220:223], v[124:127], v[212:215]
    v_exp_f32 v211, v211
    v_mfma_f32_16x16x32_bf16 a[24:27], a[168:171], v[144:147], a[24:27]
    ds_read_b64_tr_b16 a[184:185], v23 offset:0
    v_cvt_pk_bf16_f32 v176, v208, v209
    v_mfma_f32_16x16x32_bf16 a[24:27], a[172:175], v[148:151], a[24:27]
    ds_read_b64_tr_b16 a[186:187], v23 offset:4096
    v_mfma_f32_16x16x32_bf16 a[28:31], a[168:171], v[152:155], a[28:31]
    ds_read_b128 a[208:211], v8 offset:24576
    v_cvt_pk_bf16_f32 v177, v210, v211
    v_mfma_f32_16x16x32_bf16 a[28:31], a[172:175], v[156:159], a[28:31]
    s_waitcnt lgkmcnt(3)
    buffer_load_dwordx4 v40, s[12:15], s41 offen lds
    v_mfma_f32_16x16x32_bf16 v[208:211], a[224:227], v[64:67], v[192:195]
    v_exp_f32 v212, v212
    v_mfma_f32_16x16x32_bf16 v[208:211], a[228:231], v[68:71], v[208:211]
    v_exp_f32 v213, v213
    v_mfma_f32_16x16x32_bf16 v[208:211], a[232:235], v[72:75], v[208:211]
    v_exp_f32 v214, v214
    v_mfma_f32_16x16x32_bf16 v[208:211], a[236:239], v[76:79], v[208:211]
    v_exp_f32 v215, v215
    v_mfma_f32_16x16x32_bf16 a[32:35], a[176:179], v[128:131], a[32:35]
    ds_read_b64_tr_b16 a[188:189], v23 offset:8192
    v_cvt_pk_bf16_f32 v184, v212, v213
    v_mfma_f32_16x16x32_bf16 a[32:35], a[180:183], v[132:135], a[32:35]
    ds_read_b64_tr_b16 a[190:191], v23 offset:12288
    v_mfma_f32_16x16x32_bf16 a[36:39], a[176:179], v[136:139], a[36:39]
    ds_read_b128 a[212:215], v9 offset:24576
    v_cvt_pk_bf16_f32 v185, v214, v215
    v_mfma_f32_16x16x32_bf16 a[36:39], a[180:183], v[140:143], a[36:39]
    v_smfmac_f32_16x16x64_bf16 a[196:199], v[52:55], v[136:143], v50
    v_mfma_f32_16x16x32_bf16 v[212:215], a[224:227], v[80:83], v[196:199]
    v_exp_f32 v208, v208
    v_mfma_f32_16x16x32_bf16 v[212:215], a[228:231], v[84:87], v[212:215]
    v_exp_f32 v209, v209
    v_mfma_f32_16x16x32_bf16 v[212:215], a[232:235], v[88:91], v[212:215]
    v_exp_f32 v210, v210
    v_mfma_f32_16x16x32_bf16 v[212:215], a[236:239], v[92:95], v[212:215]
    v_exp_f32 v211, v211
    v_mfma_f32_16x16x32_bf16 a[40:43], a[176:179], v[144:147], a[40:43]
    ds_read_b64_tr_b16 a[160:161], v24 offset:0
    v_cvt_pk_bf16_f32 v162, v208, v209
    v_mfma_f32_16x16x32_bf16 a[40:43], a[180:183], v[148:151], a[40:43]
    ds_read_b64_tr_b16 a[162:163], v24 offset:4096
    v_mfma_f32_16x16x32_bf16 a[44:47], a[176:179], v[152:155], a[44:47]
    ds_read_b128 a[216:219], v10 offset:24576
    v_cvt_pk_bf16_f32 v163, v210, v211
    v_mfma_f32_16x16x32_bf16 a[44:47], a[180:183], v[156:159], a[44:47]
    s_waitcnt lgkmcnt(3)
    buffer_load_dwordx4 v41, s[12:15], s41 offen offset:1024 lds
    v_mfma_f32_16x16x32_bf16 v[208:211], a[224:227], v[96:99], v[200:203]
    v_exp_f32 v212, v212
    v_mfma_f32_16x16x32_bf16 v[208:211], a[228:231], v[100:103], v[208:211]
    v_exp_f32 v213, v213
    v_mfma_f32_16x16x32_bf16 v[208:211], a[232:235], v[104:107], v[208:211]
    v_exp_f32 v214, v214
    v_mfma_f32_16x16x32_bf16 v[208:211], a[236:239], v[108:111], v[208:211]
    v_exp_f32 v215, v215
    v_mfma_f32_16x16x32_bf16 a[48:51], a[184:187], v[128:131], a[48:51]
    ds_read_b64_tr_b16 a[164:165], v24 offset:8192
    v_cvt_pk_bf16_f32 v170, v212, v213
    v_mfma_f32_16x16x32_bf16 a[48:51], a[188:191], v[132:135], a[48:51]
    ds_read_b64_tr_b16 a[166:167], v24 offset:12288
    v_mfma_f32_16x16x32_bf16 a[52:55], a[184:187], v[136:139], a[52:55]
    ds_read_b128 a[220:223], v11 offset:24576
    v_cvt_pk_bf16_f32 v171, v214, v215
    v_mfma_f32_16x16x32_bf16 a[52:55], a[188:191], v[140:143], a[52:55]
    v_smfmac_f32_16x16x64_bf16 a[200:203], v[52:55], v[144:151], v50
    v_mfma_f32_16x16x32_bf16 v[212:215], a[224:227], v[112:115], v[204:207]
    v_exp_f32 v208, v208
    v_mfma_f32_16x16x32_bf16 v[212:215], a[228:231], v[116:119], v[212:215]
    v_exp_f32 v209, v209
    v_mfma_f32_16x16x32_bf16 v[212:215], a[232:235], v[120:123], v[212:215]
    v_exp_f32 v210, v210
    v_mfma_f32_16x16x32_bf16 v[212:215], a[236:239], v[124:127], v[212:215]
    v_exp_f32 v211, v211
    v_mfma_f32_16x16x32_bf16 a[56:59], a[184:187], v[144:147], a[56:59]
    ds_read_b64_tr_b16 a[168:169], v25 offset:0
    v_cvt_pk_bf16_f32 v178, v208, v209
    v_mfma_f32_16x16x32_bf16 a[56:59], a[188:191], v[148:151], a[56:59]
    ds_read_b64_tr_b16 a[170:171], v25 offset:4096
    v_mfma_f32_16x16x32_bf16 a[60:63], a[184:187], v[152:155], a[60:63]
    ds_read_b128 a[224:227], v8 offset:28672
    v_cvt_pk_bf16_f32 v179, v210, v211
    v_mfma_f32_16x16x32_bf16 a[60:63], a[188:191], v[156:159], a[60:63]
    s_waitcnt lgkmcnt(3)
    buffer_load_dwordx4 v40, s[12:15], s41 offen offset:2048 lds
    v_mfma_f32_16x16x32_bf16 v[208:211], a[208:211], v[64:67], v[192:195]
    v_exp_f32 v212, v212
    v_mfma_f32_16x16x32_bf16 v[208:211], a[212:215], v[68:71], v[208:211]
    v_exp_f32 v213, v213
    v_mfma_f32_16x16x32_bf16 v[208:211], a[216:219], v[72:75], v[208:211]
    v_exp_f32 v214, v214
    v_mfma_f32_16x16x32_bf16 v[208:211], a[220:223], v[76:79], v[208:211]
    v_exp_f32 v215, v215
    v_mfma_f32_16x16x32_bf16 a[64:67], a[160:163], v[128:131], a[64:67]
    ds_read_b64_tr_b16 a[172:173], v25 offset:8192
    v_cvt_pk_bf16_f32 v186, v212, v213
    v_mfma_f32_16x16x32_bf16 a[64:67], a[164:167], v[132:135], a[64:67]
    ds_read_b64_tr_b16 a[174:175], v25 offset:12288
    v_mfma_f32_16x16x32_bf16 a[68:71], a[160:163], v[136:139], a[68:71]
    ds_read_b128 a[228:231], v9 offset:28672
    v_cvt_pk_bf16_f32 v187, v214, v215
    v_mfma_f32_16x16x32_bf16 a[68:71], a[164:167], v[140:143], a[68:71]
    v_smfmac_f32_16x16x64_bf16 a[204:207], v[52:55], v[152:159], v50
    v_mfma_f32_16x16x32_bf16 v[212:215], a[208:211], v[80:83], v[196:199]
    v_exp_f32 v208, v208
    v_mfma_f32_16x16x32_bf16 v[212:215], a[212:215], v[84:87], v[212:215]
    v_exp_f32 v209, v209
    v_mfma_f32_16x16x32_bf16 v[212:215], a[216:219], v[88:91], v[212:215]
    v_exp_f32 v210, v210
    v_mfma_f32_16x16x32_bf16 v[212:215], a[220:223], v[92:95], v[212:215]
    v_exp_f32 v211, v211
    v_mfma_f32_16x16x32_bf16 a[72:75], a[160:163], v[144:147], a[72:75]
    ds_read_b64_tr_b16 a[176:177], v26 offset:0
    v_cvt_pk_bf16_f32 v164, v208, v209
    v_mfma_f32_16x16x32_bf16 a[72:75], a[164:167], v[148:151], a[72:75]
    ds_read_b64_tr_b16 a[178:179], v26 offset:4096
    v_mfma_f32_16x16x32_bf16 a[76:79], a[160:163], v[152:155], a[76:79]
    ds_read_b128 a[232:235], v10 offset:28672
    v_cvt_pk_bf16_f32 v165, v210, v211
    v_mfma_f32_16x16x32_bf16 a[76:79], a[164:167], v[156:159], a[76:79]
    s_waitcnt lgkmcnt(3)
    buffer_load_dwordx4 v41, s[12:15], s41 offen offset:3072 lds
    v_mfma_f32_16x16x32_bf16 v[208:211], a[208:211], v[96:99], v[200:203]
    v_exp_f32 v212, v212
    v_mfma_f32_16x16x32_bf16 v[208:211], a[212:215], v[100:103], v[208:211]
    s_add_u32 s41, s41, 16384
    v_exp_f32 v213, v213
    v_mfma_f32_16x16x32_bf16 v[208:211], a[216:219], v[104:107], v[208:211]
    v_exp_f32 v214, v214
    v_mfma_f32_16x16x32_bf16 v[208:211], a[220:223], v[108:111], v[208:211]
    v_exp_f32 v215, v215
    v_mfma_f32_16x16x32_bf16 a[80:83], a[168:171], v[128:131], a[80:83]
    ds_read_b64_tr_b16 a[180:181], v26 offset:8192
    v_cvt_pk_bf16_f32 v172, v212, v213
    v_mfma_f32_16x16x32_bf16 a[80:83], a[172:175], v[132:135], a[80:83]
    ds_read_b64_tr_b16 a[182:183], v26 offset:12288
    v_mfma_f32_16x16x32_bf16 a[84:87], a[168:171], v[136:139], a[84:87]
    ds_read_b128 a[236:239], v11 offset:28672
    v_cvt_pk_bf16_f32 v173, v214, v215
    v_mfma_f32_16x16x32_bf16 a[84:87], a[172:175], v[140:143], a[84:87]
    s_waitcnt vmcnt(8)
    s_barrier
    v_mfma_f32_16x16x32_bf16 v[212:215], a[208:211], v[112:115], v[204:207]
    v_exp_f32 v208, v208
    v_mfma_f32_16x16x32_bf16 v[212:215], a[212:215], v[116:119], v[212:215]
    s_add_u32 m0, s42, 0
    v_exp_f32 v209, v209
    v_mfma_f32_16x16x32_bf16 v[212:215], a[216:219], v[120:123], v[212:215]
    v_exp_f32 v210, v210
    v_mfma_f32_16x16x32_bf16 v[212:215], a[220:223], v[124:127], v[212:215]
    v_exp_f32 v211, v211
    v_mfma_f32_16x16x32_bf16 a[88:91], a[168:171], v[144:147], a[88:91]
    ds_read_b64_tr_b16 a[184:185], v27 offset:0
    v_cvt_pk_bf16_f32 v180, v208, v209
    v_mfma_f32_16x16x32_bf16 a[88:91], a[172:175], v[148:151], a[88:91]
    ds_read_b64_tr_b16 a[186:187], v27 offset:4096
    v_mfma_f32_16x16x32_bf16 a[92:95], a[168:171], v[152:155], a[92:95]
    ds_read_b128 a[208:211], v8 offset:32768
    v_cvt_pk_bf16_f32 v181, v210, v211
    v_mfma_f32_16x16x32_bf16 a[92:95], a[172:175], v[156:159], a[92:95]
    s_waitcnt lgkmcnt(3)
    buffer_load_dwordx4 v36, s[8:11], s40 offen lds
    v_mfma_f32_16x16x32_bf16 v[208:211], a[224:227], v[64:67], v[192:195]
    v_exp_f32 v212, v212
    v_mfma_f32_16x16x32_bf16 v[208:211], a[228:231], v[68:71], v[208:211]
    v_exp_f32 v213, v213
    v_mfma_f32_16x16x32_bf16 v[208:211], a[232:235], v[72:75], v[208:211]
    v_exp_f32 v214, v214
    v_mfma_f32_16x16x32_bf16 v[208:211], a[236:239], v[76:79], v[208:211]
    v_exp_f32 v215, v215
    v_mfma_f32_16x16x32_bf16 a[96:99], a[176:179], v[128:131], a[96:99]
    ds_read_b64_tr_b16 a[188:189], v27 offset:8192
    v_cvt_pk_bf16_f32 v188, v212, v213
    v_mfma_f32_16x16x32_bf16 a[96:99], a[180:183], v[132:135], a[96:99]
    ds_read_b64_tr_b16 a[190:191], v27 offset:12288
    v_mfma_f32_16x16x32_bf16 a[100:103], a[176:179], v[136:139], a[100:103]
    ds_read_b128 a[212:215], v9 offset:32768
    v_cvt_pk_bf16_f32 v189, v214, v215
    v_mfma_f32_16x16x32_bf16 a[100:103], a[180:183], v[140:143], a[100:103]
    buffer_load_dword v217, v57, s[32:35], s39 offen
    v_mfma_f32_16x16x32_bf16 v[212:215], a[224:227], v[80:83], v[196:199]
    v_exp_f32 v208, v208
    v_mfma_f32_16x16x32_bf16 v[212:215], a[228:231], v[84:87], v[212:215]
    v_exp_f32 v209, v209
    v_mfma_f32_16x16x32_bf16 v[212:215], a[232:235], v[88:91], v[212:215]
    v_exp_f32 v210, v210
    v_mfma_f32_16x16x32_bf16 v[212:215], a[236:239], v[92:95], v[212:215]
    v_exp_f32 v211, v211
    v_mfma_f32_16x16x32_bf16 a[104:107], a[176:179], v[144:147], a[104:107]
    ds_read_b64_tr_b16 a[160:161], v20 offset:16384
    v_cvt_pk_bf16_f32 v166, v208, v209
    v_mfma_f32_16x16x32_bf16 a[104:107], a[180:183], v[148:151], a[104:107]
    ds_read_b64_tr_b16 a[162:163], v20 offset:20480
    v_mfma_f32_16x16x32_bf16 a[108:111], a[176:179], v[152:155], a[108:111]
    ds_read_b128 a[216:219], v10 offset:32768
    v_cvt_pk_bf16_f32 v167, v210, v211
    v_mfma_f32_16x16x32_bf16 a[108:111], a[180:183], v[156:159], a[108:111]
    s_waitcnt lgkmcnt(3)
    buffer_load_dwordx4 v37, s[8:11], s40 offen offset:1024 lds
    v_mfma_f32_16x16x32_bf16 v[208:211], a[224:227], v[96:99], v[200:203]
    v_exp_f32 v212, v212
    v_mfma_f32_16x16x32_bf16 v[208:211], a[228:231], v[100:103], v[208:211]
    v_exp_f32 v213, v213
    v_mfma_f32_16x16x32_bf16 v[208:211], a[232:235], v[104:107], v[208:211]
    v_exp_f32 v214, v214
    v_mfma_f32_16x16x32_bf16 v[208:211], a[236:239], v[108:111], v[208:211]
    v_exp_f32 v215, v215
    v_mfma_f32_16x16x32_bf16 a[112:115], a[184:187], v[128:131], a[112:115]
    ds_read_b64_tr_b16 a[164:165], v20 offset:24576
    v_cvt_pk_bf16_f32 v174, v212, v213
    v_mfma_f32_16x16x32_bf16 a[112:115], a[188:191], v[132:135], a[112:115]
    ds_read_b64_tr_b16 a[166:167], v20 offset:28672
    v_mfma_f32_16x16x32_bf16 a[116:119], a[184:187], v[136:139], a[116:119]
    ds_read_b128 a[220:223], v11 offset:32768
    v_cvt_pk_bf16_f32 v175, v214, v215
    v_mfma_f32_16x16x32_bf16 a[116:119], a[188:191], v[140:143], a[116:119]
    v_mfma_f32_16x16x32_bf16 v[212:215], a[224:227], v[112:115], v[204:207]
    v_exp_f32 v208, v208
    v_mfma_f32_16x16x32_bf16 v[212:215], a[228:231], v[116:119], v[212:215]
    v_exp_f32 v209, v209
    v_mfma_f32_16x16x32_bf16 v[212:215], a[232:235], v[120:123], v[212:215]
    v_exp_f32 v210, v210
    v_mfma_f32_16x16x32_bf16 v[212:215], a[236:239], v[124:127], v[212:215]
    v_exp_f32 v211, v211
    v_mfma_f32_16x16x32_bf16 a[120:123], a[184:187], v[144:147], a[120:123]
    ds_read_b64_tr_b16 a[168:169], v21 offset:16384
    v_cvt_pk_bf16_f32 v182, v208, v209
    v_mfma_f32_16x16x32_bf16 a[120:123], a[188:191], v[148:151], a[120:123]
    ds_read_b64_tr_b16 a[170:171], v21 offset:20480
    v_mfma_f32_16x16x32_bf16 a[124:127], a[184:187], v[152:155], a[124:127]
    ds_read_b128 a[224:227], v8 offset:36864
    v_cvt_pk_bf16_f32 v183, v210, v211
    v_mfma_f32_16x16x32_bf16 a[124:127], a[188:191], v[156:159], a[124:127]
    s_waitcnt lgkmcnt(3)
    buffer_load_dwordx4 v38, s[8:11], s40 offen offset:2048 lds
    v_mfma_f32_16x16x32_bf16 v[208:211], a[208:211], v[64:67], v[192:195]
    v_exp_f32 v212, v212
    v_mfma_f32_16x16x32_bf16 v[208:211], a[212:215], v[68:71], v[208:211]
    v_exp_f32 v213, v213
    v_mfma_f32_16x16x32_bf16 v[208:211], a[216:219], v[72:75], v[208:211]
    v_exp_f32 v214, v214
    v_mfma_f32_16x16x32_bf16 v[208:211], a[220:223], v[76:79], v[208:211]
    v_exp_f32 v215, v215
    v_mfma_f32_16x16x32_bf16 a[0:3], a[160:163], v[160:163], a[0:3]
    ds_read_b64_tr_b16 a[172:173], v21 offset:24576
    v_cvt_pk_bf16_f32 v190, v212, v213
    v_mfma_f32_16x16x32_bf16 a[0:3], a[164:167], v[164:167], a[0:3]
    ds_read_b64_tr_b16 a[174:175], v21 offset:28672
    v_mfma_f32_16x16x32_bf16 a[4:7], a[160:163], v[168:171], a[4:7]
    ds_read_b128 a[228:231], v9 offset:36864
    v_cvt_pk_bf16_f32 v191, v214, v215
    v_mfma_f32_16x16x32_bf16 a[4:7], a[164:167], v[172:175], a[4:7]
    v_mfma_f32_16x16x32_bf16 v[212:215], a[208:211], v[80:83], v[196:199]
    v_exp_f32 v208, v208
    v_mfma_f32_16x16x32_bf16 v[212:215], a[212:215], v[84:87], v[212:215]
    v_exp_f32 v209, v209
    v_mfma_f32_16x16x32_bf16 v[212:215], a[216:219], v[88:91], v[212:215]
    v_exp_f32 v210, v210
    v_mfma_f32_16x16x32_bf16 v[212:215], a[220:223], v[92:95], v[212:215]
    v_exp_f32 v211, v211
    v_mfma_f32_16x16x32_bf16 a[8:11], a[160:163], v[176:179], a[8:11]
    ds_read_b64_tr_b16 a[176:177], v22 offset:16384
    v_cvt_pk_bf16_f32 v128, v208, v209
    v_mfma_f32_16x16x32_bf16 a[8:11], a[164:167], v[180:183], a[8:11]
    ds_read_b64_tr_b16 a[178:179], v22 offset:20480
    v_mfma_f32_16x16x32_bf16 a[12:15], a[160:163], v[184:187], a[12:15]
    ds_read_b128 a[232:235], v10 offset:36864
    v_cvt_pk_bf16_f32 v129, v210, v211
    v_mfma_f32_16x16x32_bf16 a[12:15], a[164:167], v[188:191], a[12:15]
    s_waitcnt lgkmcnt(3)
    buffer_load_dwordx4 v39, s[8:11], s40 offen offset:3072 lds
    v_mfma_f32_16x16x32_bf16 v[208:211], a[208:211], v[96:99], v[200:203]
    v_exp_f32 v212, v212
    v_mfma_f32_16x16x32_bf16 v[208:211], a[212:215], v[100:103], v[208:211]
    s_add_u32 s40, s40, 16384
    v_exp_f32 v213, v213
    v_mfma_f32_16x16x32_bf16 v[208:211], a[216:219], v[104:107], v[208:211]
    v_exp_f32 v214, v214
    v_mfma_f32_16x16x32_bf16 v[208:211], a[220:223], v[108:111], v[208:211]
    v_exp_f32 v215, v215
    v_mfma_f32_16x16x32_bf16 a[16:19], a[168:171], v[160:163], a[16:19]
    ds_read_b64_tr_b16 a[180:181], v22 offset:24576
    v_cvt_pk_bf16_f32 v136, v212, v213
    v_mfma_f32_16x16x32_bf16 a[16:19], a[172:175], v[164:167], a[16:19]
    ds_read_b64_tr_b16 a[182:183], v22 offset:28672
    v_mfma_f32_16x16x32_bf16 a[20:23], a[168:171], v[168:171], a[20:23]
    ds_read_b128 a[236:239], v11 offset:36864
    v_cvt_pk_bf16_f32 v137, v214, v215
    v_mfma_f32_16x16x32_bf16 a[20:23], a[172:175], v[172:175], a[20:23]
    v_smfmac_f32_16x16x64_bf16 a[192:195], v[52:55], v[160:167], v50
    v_mfma_f32_16x16x32_bf16 v[212:215], a[208:211], v[112:115], v[204:207]
    v_exp_f32 v208, v208
    v_mfma_f32_16x16x32_bf16 v[212:215], a[212:215], v[116:119], v[212:215]
    s_add_u32 m0, s42, 114688
    v_exp_f32 v209, v209
    v_mfma_f32_16x16x32_bf16 v[212:215], a[216:219], v[120:123], v[212:215]
    v_exp_f32 v210, v210
    v_mfma_f32_16x16x32_bf16 v[212:215], a[220:223], v[124:127], v[212:215]
    v_exp_f32 v211, v211
    v_mfma_f32_16x16x32_bf16 a[24:27], a[168:171], v[176:179], a[24:27]
    ds_read_b64_tr_b16 a[184:185], v23 offset:16384
    v_cvt_pk_bf16_f32 v144, v208, v209
    v_mfma_f32_16x16x32_bf16 a[24:27], a[172:175], v[180:183], a[24:27]
    ds_read_b64_tr_b16 a[186:187], v23 offset:20480
    v_mfma_f32_16x16x32_bf16 a[28:31], a[168:171], v[184:187], a[28:31]
    ds_read_b128 a[208:211], v8 offset:40960
    v_cvt_pk_bf16_f32 v145, v210, v211
    v_mfma_f32_16x16x32_bf16 a[28:31], a[172:175], v[188:191], a[28:31]
    s_waitcnt lgkmcnt(3)
    buffer_load_dwordx4 v40, s[12:15], s41 offen lds
    v_mfma_f32_16x16x32_bf16 v[208:211], a[224:227], v[64:67], v[192:195]
    v_exp_f32 v212, v212
    v_mfma_f32_16x16x32_bf16 v[208:211], a[228:231], v[68:71], v[208:211]
    v_exp_f32 v213, v213
    v_mfma_f32_16x16x32_bf16 v[208:211], a[232:235], v[72:75], v[208:211]
    v_exp_f32 v214, v214
    v_mfma_f32_16x16x32_bf16 v[208:211], a[236:239], v[76:79], v[208:211]
    v_exp_f32 v215, v215
    v_mfma_f32_16x16x32_bf16 a[32:35], a[176:179], v[160:163], a[32:35]
    ds_read_b64_tr_b16 a[188:189], v23 offset:24576
    v_cvt_pk_bf16_f32 v152, v212, v213
    v_mfma_f32_16x16x32_bf16 a[32:35], a[180:183], v[164:167], a[32:35]
    ds_read_b64_tr_b16 a[190:191], v23 offset:28672
    v_mfma_f32_16x16x32_bf16 a[36:39], a[176:179], v[168:171], a[36:39]
    ds_read_b128 a[212:215], v9 offset:40960
    v_cvt_pk_bf16_f32 v153, v214, v215
    v_mfma_f32_16x16x32_bf16 a[36:39], a[180:183], v[172:175], a[36:39]
    v_smfmac_f32_16x16x64_bf16 a[196:199], v[52:55], v[168:175], v50
    v_mfma_f32_16x16x32_bf16 v[212:215], a[224:227], v[80:83], v[196:199]
    v_exp_f32 v208, v208
    v_mfma_f32_16x16x32_bf16 v[212:215], a[228:231], v[84:87], v[212:215]
    v_exp_f32 v209, v209
    v_mfma_f32_16x16x32_bf16 v[212:215], a[232:235], v[88:91], v[212:215]
    v_exp_f32 v210, v210
    v_mfma_f32_16x16x32_bf16 v[212:215], a[236:239], v[92:95], v[212:215]
    v_exp_f32 v211, v211
    v_mfma_f32_16x16x32_bf16 a[40:43], a[176:179], v[176:179], a[40:43]
    ds_read_b64_tr_b16 a[160:161], v24 offset:16384
    v_cvt_pk_bf16_f32 v130, v208, v209
    v_mfma_f32_16x16x32_bf16 a[40:43], a[180:183], v[180:183], a[40:43]
    ds_read_b64_tr_b16 a[162:163], v24 offset:20480
    v_mfma_f32_16x16x32_bf16 a[44:47], a[176:179], v[184:187], a[44:47]
    ds_read_b128 a[216:219], v10 offset:40960
    v_cvt_pk_bf16_f32 v131, v210, v211
    v_mfma_f32_16x16x32_bf16 a[44:47], a[180:183], v[188:191], a[44:47]
    s_waitcnt lgkmcnt(3)
    buffer_load_dwordx4 v41, s[12:15], s41 offen offset:1024 lds
    v_mfma_f32_16x16x32_bf16 v[208:211], a[224:227], v[96:99], v[200:203]
    v_exp_f32 v212, v212
    v_mfma_f32_16x16x32_bf16 v[208:211], a[228:231], v[100:103], v[208:211]
    v_exp_f32 v213, v213
    v_mfma_f32_16x16x32_bf16 v[208:211], a[232:235], v[104:107], v[208:211]
    v_exp_f32 v214, v214
    v_mfma_f32_16x16x32_bf16 v[208:211], a[236:239], v[108:111], v[208:211]
    v_exp_f32 v215, v215
    v_mfma_f32_16x16x32_bf16 a[48:51], a[184:187], v[160:163], a[48:51]
    ds_read_b64_tr_b16 a[164:165], v24 offset:24576
    v_cvt_pk_bf16_f32 v138, v212, v213
    v_mfma_f32_16x16x32_bf16 a[48:51], a[188:191], v[164:167], a[48:51]
    ds_read_b64_tr_b16 a[166:167], v24 offset:28672
    v_mfma_f32_16x16x32_bf16 a[52:55], a[184:187], v[168:171], a[52:55]
    ds_read_b128 a[220:223], v11 offset:40960
    v_cvt_pk_bf16_f32 v139, v214, v215
    v_mfma_f32_16x16x32_bf16 a[52:55], a[188:191], v[172:175], a[52:55]
    v_smfmac_f32_16x16x64_bf16 a[200:203], v[52:55], v[176:183], v50
    v_mfma_f32_16x16x32_bf16 v[212:215], a[224:227], v[112:115], v[204:207]
    v_exp_f32 v208, v208
    v_mfma_f32_16x16x32_bf16 v[212:215], a[228:231], v[116:119], v[212:215]
    v_exp_f32 v209, v209
    v_mfma_f32_16x16x32_bf16 v[212:215], a[232:235], v[120:123], v[212:215]
    v_exp_f32 v210, v210
    v_mfma_f32_16x16x32_bf16 v[212:215], a[236:239], v[124:127], v[212:215]
    v_exp_f32 v211, v211
    v_mfma_f32_16x16x32_bf16 a[56:59], a[184:187], v[176:179], a[56:59]
    ds_read_b64_tr_b16 a[168:169], v25 offset:16384
    v_cvt_pk_bf16_f32 v146, v208, v209
    v_mfma_f32_16x16x32_bf16 a[56:59], a[188:191], v[180:183], a[56:59]
    ds_read_b64_tr_b16 a[170:171], v25 offset:20480
    v_mfma_f32_16x16x32_bf16 a[60:63], a[184:187], v[184:187], a[60:63]
    ds_read_b128 a[224:227], v8 offset:45056
    v_cvt_pk_bf16_f32 v147, v210, v211
    v_mfma_f32_16x16x32_bf16 a[60:63], a[188:191], v[188:191], a[60:63]
    s_waitcnt lgkmcnt(3)
    buffer_load_dwordx4 v40, s[12:15], s41 offen offset:2048 lds
    v_mfma_f32_16x16x32_bf16 v[208:211], a[208:211], v[64:67], v[192:195]
    v_exp_f32 v212, v212
    v_mfma_f32_16x16x32_bf16 v[208:211], a[212:215], v[68:71], v[208:211]
    v_exp_f32 v213, v213
    v_mfma_f32_16x16x32_bf16 v[208:211], a[216:219], v[72:75], v[208:211]
    v_exp_f32 v214, v214
    v_mfma_f32_16x16x32_bf16 v[208:211], a[220:223], v[76:79], v[208:211]
    v_exp_f32 v215, v215
    v_mfma_f32_16x16x32_bf16 a[64:67], a[160:163], v[160:163], a[64:67]
    ds_read_b64_tr_b16 a[172:173], v25 offset:24576
    v_cvt_pk_bf16_f32 v154, v212, v213
    v_mfma_f32_16x16x32_bf16 a[64:67], a[164:167], v[164:167], a[64:67]
    ds_read_b64_tr_b16 a[174:175], v25 offset:28672
    v_mfma_f32_16x16x32_bf16 a[68:71], a[160:163], v[168:171], a[68:71]
    ds_read_b128 a[228:231], v9 offset:45056
    v_cvt_pk_bf16_f32 v155, v214, v215
    v_mfma_f32_16x16x32_bf16 a[68:71], a[164:167], v[172:175], a[68:71]
    v_smfmac_f32_16x16x64_bf16 a[204:207], v[52:55], v[184:191], v50
    v_mfma_f32_16x16x32_bf16 v[212:215], a[208:211], v[80:83], v[196:199]
    v_exp_f32 v208, v208
    v_mfma_f32_16x16x32_bf16 v[212:215], a[212:215], v[84:87], v[212:215]
    v_exp_f32 v209, v209
    v_mfma_f32_16x16x32_bf16 v[212:215], a[216:219], v[88:91], v[212:215]
    v_exp_f32 v210, v210
    v_mfma_f32_16x16x32_bf16 v[212:215], a[220:223], v[92:95], v[212:215]
    v_exp_f32 v211, v211
    v_mfma_f32_16x16x32_bf16 a[72:75], a[160:163], v[176:179], a[72:75]
    ds_read_b64_tr_b16 a[176:177], v26 offset:16384
    v_cvt_pk_bf16_f32 v132, v208, v209
    v_mfma_f32_16x16x32_bf16 a[72:75], a[164:167], v[180:183], a[72:75]
    ds_read_b64_tr_b16 a[178:179], v26 offset:20480
    v_mfma_f32_16x16x32_bf16 a[76:79], a[160:163], v[184:187], a[76:79]
    ds_read_b128 a[232:235], v10 offset:45056
    v_cvt_pk_bf16_f32 v133, v210, v211
    v_mfma_f32_16x16x32_bf16 a[76:79], a[164:167], v[188:191], a[76:79]
    s_waitcnt lgkmcnt(3)
    buffer_load_dwordx4 v41, s[12:15], s41 offen offset:3072 lds
    v_mfma_f32_16x16x32_bf16 v[208:211], a[208:211], v[96:99], v[200:203]
    v_exp_f32 v212, v212
    v_mfma_f32_16x16x32_bf16 v[208:211], a[212:215], v[100:103], v[208:211]
    s_add_u32 s41, s41, 16384
    v_exp_f32 v213, v213
    v_mfma_f32_16x16x32_bf16 v[208:211], a[216:219], v[104:107], v[208:211]
    v_exp_f32 v214, v214
    v_mfma_f32_16x16x32_bf16 v[208:211], a[220:223], v[108:111], v[208:211]
    v_exp_f32 v215, v215
    v_mfma_f32_16x16x32_bf16 a[80:83], a[168:171], v[160:163], a[80:83]
    ds_read_b64_tr_b16 a[180:181], v26 offset:24576
    v_cvt_pk_bf16_f32 v140, v212, v213
    v_mfma_f32_16x16x32_bf16 a[80:83], a[172:175], v[164:167], a[80:83]
    ds_read_b64_tr_b16 a[182:183], v26 offset:28672
    v_mfma_f32_16x16x32_bf16 a[84:87], a[168:171], v[168:171], a[84:87]
    ds_read_b128 a[236:239], v11 offset:45056
    v_cvt_pk_bf16_f32 v141, v214, v215
    v_mfma_f32_16x16x32_bf16 a[84:87], a[172:175], v[172:175], a[84:87]
    s_waitcnt vmcnt(9)
    s_barrier
    v_mfma_f32_16x16x32_bf16 v[212:215], a[208:211], v[112:115], v[204:207]
    v_exp_f32 v208, v208
    v_mfma_f32_16x16x32_bf16 v[212:215], a[212:215], v[116:119], v[212:215]
    s_add_u32 m0, s42, 16384
    v_exp_f32 v209, v209
    v_mfma_f32_16x16x32_bf16 v[212:215], a[216:219], v[120:123], v[212:215]
    v_exp_f32 v210, v210
    v_mfma_f32_16x16x32_bf16 v[212:215], a[220:223], v[124:127], v[212:215]
    v_exp_f32 v211, v211
    v_mfma_f32_16x16x32_bf16 a[88:91], a[168:171], v[176:179], a[88:91]
    ds_read_b64_tr_b16 a[184:185], v27 offset:16384
    v_cvt_pk_bf16_f32 v148, v208, v209
    v_mfma_f32_16x16x32_bf16 a[88:91], a[172:175], v[180:183], a[88:91]
    ds_read_b64_tr_b16 a[186:187], v27 offset:20480
    v_mfma_f32_16x16x32_bf16 a[92:95], a[168:171], v[184:187], a[92:95]
    ds_read_b128 a[208:211], v8 offset:49152
    v_cvt_pk_bf16_f32 v149, v210, v211
    v_mfma_f32_16x16x32_bf16 a[92:95], a[172:175], v[188:191], a[92:95]
    s_waitcnt lgkmcnt(3)
    buffer_load_dwordx4 v36, s[8:11], s40 offen lds
    v_mfma_f32_16x16x32_bf16 v[208:211], a[224:227], v[64:67], v[192:195]
    v_exp_f32 v212, v212
    v_mfma_f32_16x16x32_bf16 v[208:211], a[228:231], v[68:71], v[208:211]
    v_exp_f32 v213, v213
    v_mfma_f32_16x16x32_bf16 v[208:211], a[232:235], v[72:75], v[208:211]
    v_exp_f32 v214, v214
    v_mfma_f32_16x16x32_bf16 v[208:211], a[236:239], v[76:79], v[208:211]
    v_exp_f32 v215, v215
    v_mfma_f32_16x16x32_bf16 a[96:99], a[176:179], v[160:163], a[96:99]
    ds_read_b64_tr_b16 a[188:189], v27 offset:24576
    v_cvt_pk_bf16_f32 v156, v212, v213
    v_mfma_f32_16x16x32_bf16 a[96:99], a[180:183], v[164:167], a[96:99]
    ds_read_b64_tr_b16 a[190:191], v27 offset:28672
    v_mfma_f32_16x16x32_bf16 a[100:103], a[176:179], v[168:171], a[100:103]
    ds_read_b128 a[212:215], v9 offset:49152
    v_cvt_pk_bf16_f32 v157, v214, v215
    v_mfma_f32_16x16x32_bf16 a[100:103], a[180:183], v[172:175], a[100:103]
    buffer_load_dword v218, v57, s[80:83], s39 offen
    v_mfma_f32_16x16x32_bf16 v[212:215], a[224:227], v[80:83], v[196:199]
    v_exp_f32 v208, v208
    v_mfma_f32_16x16x32_bf16 v[212:215], a[228:231], v[84:87], v[212:215]
    v_exp_f32 v209, v209
    v_mfma_f32_16x16x32_bf16 v[212:215], a[232:235], v[88:91], v[212:215]
    v_exp_f32 v210, v210
    v_mfma_f32_16x16x32_bf16 v[212:215], a[236:239], v[92:95], v[212:215]
    v_exp_f32 v211, v211
    v_mfma_f32_16x16x32_bf16 a[104:107], a[176:179], v[176:179], a[104:107]
    ds_read_b64_tr_b16 a[160:161], v20 offset:32768
    v_cvt_pk_bf16_f32 v134, v208, v209
    v_mfma_f32_16x16x32_bf16 a[104:107], a[180:183], v[180:183], a[104:107]
    ds_read_b64_tr_b16 a[162:163], v20 offset:36864
    v_mfma_f32_16x16x32_bf16 a[108:111], a[176:179], v[184:187], a[108:111]
    ds_read_b128 a[216:219], v10 offset:49152
    v_cvt_pk_bf16_f32 v135, v210, v211
    v_mfma_f32_16x16x32_bf16 a[108:111], a[180:183], v[188:191], a[108:111]
    s_waitcnt lgkmcnt(3)
    buffer_load_dwordx4 v37, s[8:11], s40 offen offset:1024 lds
    v_mfma_f32_16x16x32_bf16 v[208:211], a[224:227], v[96:99], v[200:203]
    v_exp_f32 v212, v212
    v_mfma_f32_16x16x32_bf16 v[208:211], a[228:231], v[100:103], v[208:211]
    v_exp_f32 v213, v213
    v_mfma_f32_16x16x32_bf16 v[208:211], a[232:235], v[104:107], v[208:211]
    v_exp_f32 v214, v214
    v_mfma_f32_16x16x32_bf16 v[208:211], a[236:239], v[108:111], v[208:211]
    v_exp_f32 v215, v215
    v_mfma_f32_16x16x32_bf16 a[112:115], a[184:187], v[160:163], a[112:115]
    ds_read_b64_tr_b16 a[164:165], v20 offset:40960
    v_cvt_pk_bf16_f32 v142, v212, v213
    v_mfma_f32_16x16x32_bf16 a[112:115], a[188:191], v[164:167], a[112:115]
    ds_read_b64_tr_b16 a[166:167], v20 offset:45056
    v_mfma_f32_16x16x32_bf16 a[116:119], a[184:187], v[168:171], a[116:119]
    ds_read_b128 a[220:223], v11 offset:49152
    v_cvt_pk_bf16_f32 v143, v214, v215
    v_mfma_f32_16x16x32_bf16 a[116:119], a[188:191], v[172:175], a[116:119]
    v_mfma_f32_16x16x32_bf16 v[212:215], a[224:227], v[112:115], v[204:207]
    v_exp_f32 v208, v208
    v_mfma_f32_16x16x32_bf16 v[212:215], a[228:231], v[116:119], v[212:215]
    v_exp_f32 v209, v209
    v_mfma_f32_16x16x32_bf16 v[212:215], a[232:235], v[120:123], v[212:215]
    v_exp_f32 v210, v210
    v_mfma_f32_16x16x32_bf16 v[212:215], a[236:239], v[124:127], v[212:215]
    v_exp_f32 v211, v211
    v_mfma_f32_16x16x32_bf16 a[120:123], a[184:187], v[176:179], a[120:123]
    ds_read_b64_tr_b16 a[168:169], v21 offset:32768
    v_cvt_pk_bf16_f32 v150, v208, v209
    v_mfma_f32_16x16x32_bf16 a[120:123], a[188:191], v[180:183], a[120:123]
    ds_read_b64_tr_b16 a[170:171], v21 offset:36864
    v_mfma_f32_16x16x32_bf16 a[124:127], a[184:187], v[184:187], a[124:127]
    ds_read_b128 a[224:227], v8 offset:53248
    v_cvt_pk_bf16_f32 v151, v210, v211
    v_mfma_f32_16x16x32_bf16 a[124:127], a[188:191], v[188:191], a[124:127]
    s_waitcnt lgkmcnt(3)
    buffer_load_dwordx4 v38, s[8:11], s40 offen offset:2048 lds
    v_mfma_f32_16x16x32_bf16 v[208:211], a[208:211], v[64:67], v[192:195]
    v_exp_f32 v212, v212
    v_mfma_f32_16x16x32_bf16 v[208:211], a[212:215], v[68:71], v[208:211]
    v_exp_f32 v213, v213
    v_mfma_f32_16x16x32_bf16 v[208:211], a[216:219], v[72:75], v[208:211]
    v_exp_f32 v214, v214
    v_mfma_f32_16x16x32_bf16 v[208:211], a[220:223], v[76:79], v[208:211]
    v_exp_f32 v215, v215
    v_mfma_f32_16x16x32_bf16 a[0:3], a[160:163], v[128:131], a[0:3]
    ds_read_b64_tr_b16 a[172:173], v21 offset:40960
    v_cvt_pk_bf16_f32 v158, v212, v213
    v_mfma_f32_16x16x32_bf16 a[0:3], a[164:167], v[132:135], a[0:3]
    ds_read_b64_tr_b16 a[174:175], v21 offset:45056
    v_mfma_f32_16x16x32_bf16 a[4:7], a[160:163], v[136:139], a[4:7]
    ds_read_b128 a[228:231], v9 offset:53248
    v_cvt_pk_bf16_f32 v159, v214, v215
    v_mfma_f32_16x16x32_bf16 a[4:7], a[164:167], v[140:143], a[4:7]
    v_mfma_f32_16x16x32_bf16 v[212:215], a[208:211], v[80:83], v[196:199]
    v_exp_f32 v208, v208
    v_mfma_f32_16x16x32_bf16 v[212:215], a[212:215], v[84:87], v[212:215]
    v_exp_f32 v209, v209
    v_mfma_f32_16x16x32_bf16 v[212:215], a[216:219], v[88:91], v[212:215]
    v_exp_f32 v210, v210
    v_mfma_f32_16x16x32_bf16 v[212:215], a[220:223], v[92:95], v[212:215]
    v_exp_f32 v211, v211
    v_mfma_f32_16x16x32_bf16 a[8:11], a[160:163], v[144:147], a[8:11]
    ds_read_b64_tr_b16 a[176:177], v22 offset:32768
    v_cvt_pk_bf16_f32 v160, v208, v209
    v_mfma_f32_16x16x32_bf16 a[8:11], a[164:167], v[148:151], a[8:11]
    ds_read_b64_tr_b16 a[178:179], v22 offset:36864
    v_mfma_f32_16x16x32_bf16 a[12:15], a[160:163], v[152:155], a[12:15]
    ds_read_b128 a[232:235], v10 offset:53248
    v_cvt_pk_bf16_f32 v161, v210, v211
    v_mfma_f32_16x16x32_bf16 a[12:15], a[164:167], v[156:159], a[12:15]
    s_waitcnt lgkmcnt(3)
    buffer_load_dwordx4 v39, s[8:11], s40 offen offset:3072 lds
    v_mfma_f32_16x16x32_bf16 v[208:211], a[208:211], v[96:99], v[200:203]
    v_exp_f32 v212, v212
    v_mfma_f32_16x16x32_bf16 v[208:211], a[212:215], v[100:103], v[208:211]
    s_add_u32 s40, s40, 16384
    v_exp_f32 v213, v213
    v_mfma_f32_16x16x32_bf16 v[208:211], a[216:219], v[104:107], v[208:211]
    v_exp_f32 v214, v214
    v_mfma_f32_16x16x32_bf16 v[208:211], a[220:223], v[108:111], v[208:211]
    v_exp_f32 v215, v215
    v_mfma_f32_16x16x32_bf16 a[16:19], a[168:171], v[128:131], a[16:19]
    ds_read_b64_tr_b16 a[180:181], v22 offset:40960
    v_cvt_pk_bf16_f32 v168, v212, v213
    v_mfma_f32_16x16x32_bf16 a[16:19], a[172:175], v[132:135], a[16:19]
    ds_read_b64_tr_b16 a[182:183], v22 offset:45056
    v_mfma_f32_16x16x32_bf16 a[20:23], a[168:171], v[136:139], a[20:23]
    ds_read_b128 a[236:239], v11 offset:53248
    v_cvt_pk_bf16_f32 v169, v214, v215
    v_mfma_f32_16x16x32_bf16 a[20:23], a[172:175], v[140:143], a[20:23]
    v_smfmac_f32_16x16x64_bf16 a[192:195], v[52:55], v[128:135], v50
    v_mfma_f32_16x16x32_bf16 v[212:215], a[208:211], v[112:115], v[204:207]
    v_exp_f32 v208, v208
    v_mfma_f32_16x16x32_bf16 v[212:215], a[212:215], v[116:119], v[212:215]
    s_add_u32 m0, s42, 65536
    v_exp_f32 v209, v209
    v_mfma_f32_16x16x32_bf16 v[212:215], a[216:219], v[120:123], v[212:215]
    v_exp_f32 v210, v210
    v_mfma_f32_16x16x32_bf16 v[212:215], a[220:223], v[124:127], v[212:215]
    v_exp_f32 v211, v211
    v_mfma_f32_16x16x32_bf16 a[24:27], a[168:171], v[144:147], a[24:27]
    ds_read_b64_tr_b16 a[184:185], v23 offset:32768
    v_cvt_pk_bf16_f32 v176, v208, v209
    v_mfma_f32_16x16x32_bf16 a[24:27], a[172:175], v[148:151], a[24:27]
    ds_read_b64_tr_b16 a[186:187], v23 offset:36864
    v_mfma_f32_16x16x32_bf16 a[28:31], a[168:171], v[152:155], a[28:31]
    ds_read_b128 a[208:211], v8 offset:57344
    v_cvt_pk_bf16_f32 v177, v210, v211
    v_mfma_f32_16x16x32_bf16 a[28:31], a[172:175], v[156:159], a[28:31]
    s_waitcnt lgkmcnt(3)
    buffer_load_dwordx4 v40, s[12:15], s41 offen lds
    v_mfma_f32_16x16x32_bf16 v[208:211], a[224:227], v[64:67], v[192:195]
    v_exp_f32 v212, v212
    v_mfma_f32_16x16x32_bf16 v[208:211], a[228:231], v[68:71], v[208:211]
    v_exp_f32 v213, v213
    v_mfma_f32_16x16x32_bf16 v[208:211], a[232:235], v[72:75], v[208:211]
    v_exp_f32 v214, v214
    v_mfma_f32_16x16x32_bf16 v[208:211], a[236:239], v[76:79], v[208:211]
    v_exp_f32 v215, v215
    v_mfma_f32_16x16x32_bf16 a[32:35], a[176:179], v[128:131], a[32:35]
    ds_read_b64_tr_b16 a[188:189], v23 offset:40960
    v_cvt_pk_bf16_f32 v184, v212, v213
    v_mfma_f32_16x16x32_bf16 a[32:35], a[180:183], v[132:135], a[32:35]
    ds_read_b64_tr_b16 a[190:191], v23 offset:45056
    v_mfma_f32_16x16x32_bf16 a[36:39], a[176:179], v[136:139], a[36:39]
    ds_read_b128 a[212:215], v9 offset:57344
    v_cvt_pk_bf16_f32 v185, v214, v215
    v_mfma_f32_16x16x32_bf16 a[36:39], a[180:183], v[140:143], a[36:39]
    v_smfmac_f32_16x16x64_bf16 a[196:199], v[52:55], v[136:143], v50
    v_mfma_f32_16x16x32_bf16 v[212:215], a[224:227], v[80:83], v[196:199]
    v_exp_f32 v208, v208
    v_mfma_f32_16x16x32_bf16 v[212:215], a[228:231], v[84:87], v[212:215]
    v_exp_f32 v209, v209
    v_mfma_f32_16x16x32_bf16 v[212:215], a[232:235], v[88:91], v[212:215]
    v_exp_f32 v210, v210
    v_mfma_f32_16x16x32_bf16 v[212:215], a[236:239], v[92:95], v[212:215]
    v_exp_f32 v211, v211
    v_mfma_f32_16x16x32_bf16 a[40:43], a[176:179], v[144:147], a[40:43]
    ds_read_b64_tr_b16 a[160:161], v24 offset:32768
    v_cvt_pk_bf16_f32 v162, v208, v209
    v_mfma_f32_16x16x32_bf16 a[40:43], a[180:183], v[148:151], a[40:43]
    ds_read_b64_tr_b16 a[162:163], v24 offset:36864
    v_mfma_f32_16x16x32_bf16 a[44:47], a[176:179], v[152:155], a[44:47]
    ds_read_b128 a[216:219], v10 offset:57344
    v_cvt_pk_bf16_f32 v163, v210, v211
    v_mfma_f32_16x16x32_bf16 a[44:47], a[180:183], v[156:159], a[44:47]
    s_waitcnt lgkmcnt(3)
    buffer_load_dwordx4 v41, s[12:15], s41 offen offset:1024 lds
    v_mfma_f32_16x16x32_bf16 v[208:211], a[224:227], v[96:99], v[200:203]
    v_exp_f32 v212, v212
    v_mfma_f32_16x16x32_bf16 v[208:211], a[228:231], v[100:103], v[208:211]
    v_exp_f32 v213, v213
    v_mfma_f32_16x16x32_bf16 v[208:211], a[232:235], v[104:107], v[208:211]
    v_exp_f32 v214, v214
    v_mfma_f32_16x16x32_bf16 v[208:211], a[236:239], v[108:111], v[208:211]
    v_exp_f32 v215, v215
    v_mfma_f32_16x16x32_bf16 a[48:51], a[184:187], v[128:131], a[48:51]
    ds_read_b64_tr_b16 a[164:165], v24 offset:40960
    v_cvt_pk_bf16_f32 v170, v212, v213
    v_mfma_f32_16x16x32_bf16 a[48:51], a[188:191], v[132:135], a[48:51]
    ds_read_b64_tr_b16 a[166:167], v24 offset:45056
    v_mfma_f32_16x16x32_bf16 a[52:55], a[184:187], v[136:139], a[52:55]
    ds_read_b128 a[220:223], v11 offset:57344
    v_cvt_pk_bf16_f32 v171, v214, v215
    v_mfma_f32_16x16x32_bf16 a[52:55], a[188:191], v[140:143], a[52:55]
    v_smfmac_f32_16x16x64_bf16 a[200:203], v[52:55], v[144:151], v50
    v_mfma_f32_16x16x32_bf16 v[212:215], a[224:227], v[112:115], v[204:207]
    v_exp_f32 v208, v208
    v_mfma_f32_16x16x32_bf16 v[212:215], a[228:231], v[116:119], v[212:215]
    v_exp_f32 v209, v209
    v_mfma_f32_16x16x32_bf16 v[212:215], a[232:235], v[120:123], v[212:215]
    v_exp_f32 v210, v210
    v_mfma_f32_16x16x32_bf16 v[212:215], a[236:239], v[124:127], v[212:215]
    v_exp_f32 v211, v211
    v_mfma_f32_16x16x32_bf16 a[56:59], a[184:187], v[144:147], a[56:59]
    ds_read_b64_tr_b16 a[168:169], v25 offset:32768
    v_cvt_pk_bf16_f32 v178, v208, v209
    v_mfma_f32_16x16x32_bf16 a[56:59], a[188:191], v[148:151], a[56:59]
    ds_read_b64_tr_b16 a[170:171], v25 offset:36864
    v_mfma_f32_16x16x32_bf16 a[60:63], a[184:187], v[152:155], a[60:63]
    ds_read_b128 a[224:227], v8 offset:61440
    v_cvt_pk_bf16_f32 v179, v210, v211
    v_mfma_f32_16x16x32_bf16 a[60:63], a[188:191], v[156:159], a[60:63]
    s_waitcnt lgkmcnt(3)
    buffer_load_dwordx4 v40, s[12:15], s41 offen offset:2048 lds
    v_mfma_f32_16x16x32_bf16 v[208:211], a[208:211], v[64:67], v[192:195]
    v_exp_f32 v212, v212
    v_mfma_f32_16x16x32_bf16 v[208:211], a[212:215], v[68:71], v[208:211]
    v_exp_f32 v213, v213
    v_mfma_f32_16x16x32_bf16 v[208:211], a[216:219], v[72:75], v[208:211]
    v_exp_f32 v214, v214
    v_mfma_f32_16x16x32_bf16 v[208:211], a[220:223], v[76:79], v[208:211]
    v_exp_f32 v215, v215
    v_mfma_f32_16x16x32_bf16 a[64:67], a[160:163], v[128:131], a[64:67]
    ds_read_b64_tr_b16 a[172:173], v25 offset:40960
    v_cvt_pk_bf16_f32 v186, v212, v213
    v_mfma_f32_16x16x32_bf16 a[64:67], a[164:167], v[132:135], a[64:67]
    ds_read_b64_tr_b16 a[174:175], v25 offset:45056
    v_mfma_f32_16x16x32_bf16 a[68:71], a[160:163], v[136:139], a[68:71]
    ds_read_b128 a[228:231], v9 offset:61440
    v_cvt_pk_bf16_f32 v187, v214, v215
    v_mfma_f32_16x16x32_bf16 a[68:71], a[164:167], v[140:143], a[68:71]
    v_smfmac_f32_16x16x64_bf16 a[204:207], v[52:55], v[152:159], v50
    v_mfma_f32_16x16x32_bf16 v[212:215], a[208:211], v[80:83], v[196:199]
    v_exp_f32 v208, v208
    v_mfma_f32_16x16x32_bf16 v[212:215], a[212:215], v[84:87], v[212:215]
    v_exp_f32 v209, v209
    v_mfma_f32_16x16x32_bf16 v[212:215], a[216:219], v[88:91], v[212:215]
    v_exp_f32 v210, v210
    v_mfma_f32_16x16x32_bf16 v[212:215], a[220:223], v[92:95], v[212:215]
    v_exp_f32 v211, v211
    v_mfma_f32_16x16x32_bf16 a[72:75], a[160:163], v[144:147], a[72:75]
    ds_read_b64_tr_b16 a[176:177], v26 offset:32768
    v_cvt_pk_bf16_f32 v164, v208, v209
    v_mfma_f32_16x16x32_bf16 a[72:75], a[164:167], v[148:151], a[72:75]
    ds_read_b64_tr_b16 a[178:179], v26 offset:36864
    v_mfma_f32_16x16x32_bf16 a[76:79], a[160:163], v[152:155], a[76:79]
    ds_read_b128 a[232:235], v10 offset:61440
    v_cvt_pk_bf16_f32 v165, v210, v211
    v_mfma_f32_16x16x32_bf16 a[76:79], a[164:167], v[156:159], a[76:79]
    s_waitcnt lgkmcnt(3)
    buffer_load_dwordx4 v41, s[12:15], s41 offen offset:3072 lds
    v_mfma_f32_16x16x32_bf16 v[208:211], a[208:211], v[96:99], v[200:203]
    v_exp_f32 v212, v212
    v_mfma_f32_16x16x32_bf16 v[208:211], a[212:215], v[100:103], v[208:211]
    s_add_u32 s41, s41, 16384
    v_exp_f32 v213, v213
    v_mfma_f32_16x16x32_bf16 v[208:211], a[216:219], v[104:107], v[208:211]
    v_exp_f32 v214, v214
    v_mfma_f32_16x16x32_bf16 v[208:211], a[220:223], v[108:111], v[208:211]
    v_exp_f32 v215, v215
    v_mfma_f32_16x16x32_bf16 a[80:83], a[168:171], v[128:131], a[80:83]
    ds_read_b64_tr_b16 a[180:181], v26 offset:40960
    v_cvt_pk_bf16_f32 v172, v212, v213
    v_mfma_f32_16x16x32_bf16 a[80:83], a[172:175], v[132:135], a[80:83]
    ds_read_b64_tr_b16 a[182:183], v26 offset:45056
    v_mfma_f32_16x16x32_bf16 a[84:87], a[168:171], v[136:139], a[84:87]
    ds_read_b128 a[236:239], v11 offset:61440
    v_cvt_pk_bf16_f32 v173, v214, v215
    v_mfma_f32_16x16x32_bf16 a[84:87], a[172:175], v[140:143], a[84:87]
    s_waitcnt vmcnt(9)
    s_barrier
    v_mfma_f32_16x16x32_bf16 v[212:215], a[208:211], v[112:115], v[204:207]
    v_exp_f32 v208, v208
    v_mfma_f32_16x16x32_bf16 v[212:215], a[212:215], v[116:119], v[212:215]
    s_add_u32 m0, s42, 32768
    v_exp_f32 v209, v209
    v_mfma_f32_16x16x32_bf16 v[212:215], a[216:219], v[120:123], v[212:215]
    v_exp_f32 v210, v210
    v_mfma_f32_16x16x32_bf16 v[212:215], a[220:223], v[124:127], v[212:215]
    v_exp_f32 v211, v211
    v_mfma_f32_16x16x32_bf16 a[88:91], a[168:171], v[144:147], a[88:91]
    ds_read_b64_tr_b16 a[184:185], v27 offset:32768
    v_cvt_pk_bf16_f32 v180, v208, v209
    v_mfma_f32_16x16x32_bf16 a[88:91], a[172:175], v[148:151], a[88:91]
    ds_read_b64_tr_b16 a[186:187], v27 offset:36864
    v_mfma_f32_16x16x32_bf16 a[92:95], a[168:171], v[152:155], a[92:95]
    ds_read_b128 a[208:211], v8 offset:0
    v_cvt_pk_bf16_f32 v181, v210, v211
    v_mfma_f32_16x16x32_bf16 a[92:95], a[172:175], v[156:159], a[92:95]
    s_waitcnt lgkmcnt(3)
    buffer_load_dwordx4 v36, s[8:11], s40 offen lds
    v_mfma_f32_16x16x32_bf16 v[208:211], a[224:227], v[64:67], v[192:195]
    v_exp_f32 v212, v212
    v_mfma_f32_16x16x32_bf16 v[208:211], a[228:231], v[68:71], v[208:211]
    v_exp_f32 v213, v213
    v_mfma_f32_16x16x32_bf16 v[208:211], a[232:235], v[72:75], v[208:211]
    v_exp_f32 v214, v214
    v_mfma_f32_16x16x32_bf16 v[208:211], a[236:239], v[76:79], v[208:211]
    v_exp_f32 v215, v215
    v_mfma_f32_16x16x32_bf16 a[96:99], a[176:179], v[128:131], a[96:99]
    ds_read_b64_tr_b16 a[188:189], v27 offset:40960
    v_cvt_pk_bf16_f32 v188, v212, v213
    v_mfma_f32_16x16x32_bf16 a[96:99], a[180:183], v[132:135], a[96:99]
    ds_read_b64_tr_b16 a[190:191], v27 offset:45056
    v_mfma_f32_16x16x32_bf16 a[100:103], a[176:179], v[136:139], a[100:103]
    ds_read_b128 a[212:215], v9 offset:0
    v_cvt_pk_bf16_f32 v189, v214, v215
    v_mfma_f32_16x16x32_bf16 a[100:103], a[180:183], v[140:143], a[100:103]
    buffer_load_dword v219, v57, s[84:87], s39 offen
    v_mfma_f32_16x16x32_bf16 v[212:215], a[224:227], v[80:83], v[196:199]
    v_exp_f32 v208, v208
    v_mfma_f32_16x16x32_bf16 v[212:215], a[228:231], v[84:87], v[212:215]
    v_exp_f32 v209, v209
    v_mfma_f32_16x16x32_bf16 v[212:215], a[232:235], v[88:91], v[212:215]
    v_exp_f32 v210, v210
    v_mfma_f32_16x16x32_bf16 v[212:215], a[236:239], v[92:95], v[212:215]
    v_exp_f32 v211, v211
    v_mfma_f32_16x16x32_bf16 a[104:107], a[176:179], v[144:147], a[104:107]
    ds_read_b64_tr_b16 a[160:161], v20 offset:49152
    v_cvt_pk_bf16_f32 v166, v208, v209
    v_mfma_f32_16x16x32_bf16 a[104:107], a[180:183], v[148:151], a[104:107]
    ds_read_b64_tr_b16 a[162:163], v20 offset:53248
    v_mfma_f32_16x16x32_bf16 a[108:111], a[176:179], v[152:155], a[108:111]
    ds_read_b128 a[216:219], v10 offset:0
    v_cvt_pk_bf16_f32 v167, v210, v211
    v_mfma_f32_16x16x32_bf16 a[108:111], a[180:183], v[156:159], a[108:111]
    s_waitcnt lgkmcnt(3)
    buffer_load_dwordx4 v37, s[8:11], s40 offen offset:1024 lds
    v_mfma_f32_16x16x32_bf16 v[208:211], a[224:227], v[96:99], v[200:203]
    v_exp_f32 v212, v212
    v_mfma_f32_16x16x32_bf16 v[208:211], a[228:231], v[100:103], v[208:211]
    v_exp_f32 v213, v213
    v_mfma_f32_16x16x32_bf16 v[208:211], a[232:235], v[104:107], v[208:211]
    v_exp_f32 v214, v214
    v_mfma_f32_16x16x32_bf16 v[208:211], a[236:239], v[108:111], v[208:211]
    v_exp_f32 v215, v215
    v_mfma_f32_16x16x32_bf16 a[112:115], a[184:187], v[128:131], a[112:115]
    ds_read_b64_tr_b16 a[164:165], v20 offset:57344
    v_cvt_pk_bf16_f32 v174, v212, v213
    v_mfma_f32_16x16x32_bf16 a[112:115], a[188:191], v[132:135], a[112:115]
    ds_read_b64_tr_b16 a[166:167], v20 offset:61440
    v_mfma_f32_16x16x32_bf16 a[116:119], a[184:187], v[136:139], a[116:119]
    ds_read_b128 a[220:223], v11 offset:0
    v_cvt_pk_bf16_f32 v175, v214, v215
    v_mfma_f32_16x16x32_bf16 a[116:119], a[188:191], v[140:143], a[116:119]
    v_mfma_f32_16x16x32_bf16 v[212:215], a[224:227], v[112:115], v[204:207]
    v_exp_f32 v208, v208
    v_mfma_f32_16x16x32_bf16 v[212:215], a[228:231], v[116:119], v[212:215]
    v_exp_f32 v209, v209
    v_mfma_f32_16x16x32_bf16 v[212:215], a[232:235], v[120:123], v[212:215]
    v_exp_f32 v210, v210
    v_mfma_f32_16x16x32_bf16 v[212:215], a[236:239], v[124:127], v[212:215]
    v_exp_f32 v211, v211
    v_mfma_f32_16x16x32_bf16 a[120:123], a[184:187], v[144:147], a[120:123]
    ds_read_b64_tr_b16 a[168:169], v21 offset:49152
    v_cvt_pk_bf16_f32 v182, v208, v209
    v_mfma_f32_16x16x32_bf16 a[120:123], a[188:191], v[148:151], a[120:123]
    ds_read_b64_tr_b16 a[170:171], v21 offset:53248
    v_mfma_f32_16x16x32_bf16 a[124:127], a[184:187], v[152:155], a[124:127]
    ds_read_b128 a[224:227], v8 offset:4096
    v_cvt_pk_bf16_f32 v183, v210, v211
    v_mfma_f32_16x16x32_bf16 a[124:127], a[188:191], v[156:159], a[124:127]
    s_waitcnt lgkmcnt(3)
    buffer_load_dwordx4 v38, s[8:11], s40 offen offset:2048 lds
    v_mfma_f32_16x16x32_bf16 v[208:211], a[208:211], v[64:67], v[192:195]
    v_exp_f32 v212, v212
    v_mfma_f32_16x16x32_bf16 v[208:211], a[212:215], v[68:71], v[208:211]
    v_exp_f32 v213, v213
    v_mfma_f32_16x16x32_bf16 v[208:211], a[216:219], v[72:75], v[208:211]
    v_exp_f32 v214, v214
    v_mfma_f32_16x16x32_bf16 v[208:211], a[220:223], v[76:79], v[208:211]
    v_exp_f32 v215, v215
    v_mfma_f32_16x16x32_bf16 a[0:3], a[160:163], v[160:163], a[0:3]
    ds_read_b64_tr_b16 a[172:173], v21 offset:57344
    v_cvt_pk_bf16_f32 v190, v212, v213
    v_mfma_f32_16x16x32_bf16 a[0:3], a[164:167], v[164:167], a[0:3]
    ds_read_b64_tr_b16 a[174:175], v21 offset:61440
    v_mfma_f32_16x16x32_bf16 a[4:7], a[160:163], v[168:171], a[4:7]
    ds_read_b128 a[228:231], v9 offset:4096
    v_cvt_pk_bf16_f32 v191, v214, v215
    v_mfma_f32_16x16x32_bf16 a[4:7], a[164:167], v[172:175], a[4:7]
    v_mfma_f32_16x16x32_bf16 v[212:215], a[208:211], v[80:83], v[196:199]
    v_exp_f32 v208, v208
    v_mfma_f32_16x16x32_bf16 v[212:215], a[212:215], v[84:87], v[212:215]
    v_exp_f32 v209, v209
    v_mfma_f32_16x16x32_bf16 v[212:215], a[216:219], v[88:91], v[212:215]
    v_exp_f32 v210, v210
    v_mfma_f32_16x16x32_bf16 v[212:215], a[220:223], v[92:95], v[212:215]
    v_exp_f32 v211, v211
    v_mfma_f32_16x16x32_bf16 a[8:11], a[160:163], v[176:179], a[8:11]
    ds_read_b64_tr_b16 a[176:177], v22 offset:49152
    v_cvt_pk_bf16_f32 v128, v208, v209
    v_mfma_f32_16x16x32_bf16 a[8:11], a[164:167], v[180:183], a[8:11]
    ds_read_b64_tr_b16 a[178:179], v22 offset:53248
    v_mfma_f32_16x16x32_bf16 a[12:15], a[160:163], v[184:187], a[12:15]
    ds_read_b128 a[232:235], v10 offset:4096
    v_cvt_pk_bf16_f32 v129, v210, v211
    v_mfma_f32_16x16x32_bf16 a[12:15], a[164:167], v[188:191], a[12:15]
    s_waitcnt lgkmcnt(3)
    buffer_load_dwordx4 v39, s[8:11], s40 offen offset:3072 lds
    v_mfma_f32_16x16x32_bf16 v[208:211], a[208:211], v[96:99], v[200:203]
    v_exp_f32 v212, v212
    v_mfma_f32_16x16x32_bf16 v[208:211], a[212:215], v[100:103], v[208:211]
    s_add_u32 s40, s40, 16384
    v_exp_f32 v213, v213
    v_mfma_f32_16x16x32_bf16 v[208:211], a[216:219], v[104:107], v[208:211]
    v_exp_f32 v214, v214
    v_mfma_f32_16x16x32_bf16 v[208:211], a[220:223], v[108:111], v[208:211]
    v_exp_f32 v215, v215
    v_mfma_f32_16x16x32_bf16 a[16:19], a[168:171], v[160:163], a[16:19]
    ds_read_b64_tr_b16 a[180:181], v22 offset:57344
    v_cvt_pk_bf16_f32 v136, v212, v213
    v_mfma_f32_16x16x32_bf16 a[16:19], a[172:175], v[164:167], a[16:19]
    ds_read_b64_tr_b16 a[182:183], v22 offset:61440
    v_mfma_f32_16x16x32_bf16 a[20:23], a[168:171], v[168:171], a[20:23]
    ds_read_b128 a[236:239], v11 offset:4096
    v_cvt_pk_bf16_f32 v137, v214, v215
    v_mfma_f32_16x16x32_bf16 a[20:23], a[172:175], v[172:175], a[20:23]
    v_smfmac_f32_16x16x64_bf16 a[192:195], v[52:55], v[160:167], v50
    v_mfma_f32_16x16x32_bf16 v[212:215], a[208:211], v[112:115], v[204:207]
    v_exp_f32 v208, v208
    v_mfma_f32_16x16x32_bf16 v[212:215], a[212:215], v[116:119], v[212:215]
    s_add_u32 m0, s42, 81920
    v_exp_f32 v209, v209
    v_mfma_f32_16x16x32_bf16 v[212:215], a[216:219], v[120:123], v[212:215]
    v_exp_f32 v210, v210
    v_mfma_f32_16x16x32_bf16 v[212:215], a[220:223], v[124:127], v[212:215]
    v_exp_f32 v211, v211
    v_mfma_f32_16x16x32_bf16 a[24:27], a[168:171], v[176:179], a[24:27]
    ds_read_b64_tr_b16 a[184:185], v23 offset:49152
    v_cvt_pk_bf16_f32 v144, v208, v209
    v_mfma_f32_16x16x32_bf16 a[24:27], a[172:175], v[180:183], a[24:27]
    ds_read_b64_tr_b16 a[186:187], v23 offset:53248
    v_mfma_f32_16x16x32_bf16 a[28:31], a[168:171], v[184:187], a[28:31]
    ds_read_b128 a[208:211], v8 offset:8192
    v_cvt_pk_bf16_f32 v145, v210, v211
    v_mfma_f32_16x16x32_bf16 a[28:31], a[172:175], v[188:191], a[28:31]
    s_waitcnt lgkmcnt(3)
    buffer_load_dwordx4 v40, s[12:15], s41 offen lds
    v_mfma_f32_16x16x32_bf16 v[208:211], a[224:227], v[64:67], v[192:195]
    v_exp_f32 v212, v212
    v_mfma_f32_16x16x32_bf16 v[208:211], a[228:231], v[68:71], v[208:211]
    v_exp_f32 v213, v213
    v_mfma_f32_16x16x32_bf16 v[208:211], a[232:235], v[72:75], v[208:211]
    v_exp_f32 v214, v214
    v_mfma_f32_16x16x32_bf16 v[208:211], a[236:239], v[76:79], v[208:211]
    v_exp_f32 v215, v215
    v_mfma_f32_16x16x32_bf16 a[32:35], a[176:179], v[160:163], a[32:35]
    ds_read_b64_tr_b16 a[188:189], v23 offset:57344
    v_cvt_pk_bf16_f32 v152, v212, v213
    v_mfma_f32_16x16x32_bf16 a[32:35], a[180:183], v[164:167], a[32:35]
    ds_read_b64_tr_b16 a[190:191], v23 offset:61440
    v_mfma_f32_16x16x32_bf16 a[36:39], a[176:179], v[168:171], a[36:39]
    ds_read_b128 a[212:215], v9 offset:8192
    v_cvt_pk_bf16_f32 v153, v214, v215
    v_mfma_f32_16x16x32_bf16 a[36:39], a[180:183], v[172:175], a[36:39]
    v_smfmac_f32_16x16x64_bf16 a[196:199], v[52:55], v[168:175], v50
    v_mfma_f32_16x16x32_bf16 v[212:215], a[224:227], v[80:83], v[196:199]
    v_exp_f32 v208, v208
    v_mfma_f32_16x16x32_bf16 v[212:215], a[228:231], v[84:87], v[212:215]
    v_exp_f32 v209, v209
    v_mfma_f32_16x16x32_bf16 v[212:215], a[232:235], v[88:91], v[212:215]
    v_exp_f32 v210, v210
    v_mfma_f32_16x16x32_bf16 v[212:215], a[236:239], v[92:95], v[212:215]
    v_exp_f32 v211, v211
    v_mfma_f32_16x16x32_bf16 a[40:43], a[176:179], v[176:179], a[40:43]
    ds_read_b64_tr_b16 a[160:161], v24 offset:49152
    v_cvt_pk_bf16_f32 v130, v208, v209
    v_mfma_f32_16x16x32_bf16 a[40:43], a[180:183], v[180:183], a[40:43]
    ds_read_b64_tr_b16 a[162:163], v24 offset:53248
    v_mfma_f32_16x16x32_bf16 a[44:47], a[176:179], v[184:187], a[44:47]
    ds_read_b128 a[216:219], v10 offset:8192
    v_cvt_pk_bf16_f32 v131, v210, v211
    v_mfma_f32_16x16x32_bf16 a[44:47], a[180:183], v[188:191], a[44:47]
    s_waitcnt lgkmcnt(3)
    buffer_load_dwordx4 v41, s[12:15], s41 offen offset:1024 lds
    v_mfma_f32_16x16x32_bf16 v[208:211], a[224:227], v[96:99], v[200:203]
    v_exp_f32 v212, v212
    v_mfma_f32_16x16x32_bf16 v[208:211], a[228:231], v[100:103], v[208:211]
    v_exp_f32 v213, v213
    v_mfma_f32_16x16x32_bf16 v[208:211], a[232:235], v[104:107], v[208:211]
    v_exp_f32 v214, v214
    v_mfma_f32_16x16x32_bf16 v[208:211], a[236:239], v[108:111], v[208:211]
    v_exp_f32 v215, v215
    v_mfma_f32_16x16x32_bf16 a[48:51], a[184:187], v[160:163], a[48:51]
    ds_read_b64_tr_b16 a[164:165], v24 offset:57344
    v_cvt_pk_bf16_f32 v138, v212, v213
    v_mfma_f32_16x16x32_bf16 a[48:51], a[188:191], v[164:167], a[48:51]
    ds_read_b64_tr_b16 a[166:167], v24 offset:61440
    v_mfma_f32_16x16x32_bf16 a[52:55], a[184:187], v[168:171], a[52:55]
    ds_read_b128 a[220:223], v11 offset:8192
    v_cvt_pk_bf16_f32 v139, v214, v215
    v_mfma_f32_16x16x32_bf16 a[52:55], a[188:191], v[172:175], a[52:55]
    v_smfmac_f32_16x16x64_bf16 a[200:203], v[52:55], v[176:183], v50
    v_mfma_f32_16x16x32_bf16 v[212:215], a[224:227], v[112:115], v[204:207]
    v_exp_f32 v208, v208
    v_mfma_f32_16x16x32_bf16 v[212:215], a[228:231], v[116:119], v[212:215]
    v_exp_f32 v209, v209
    v_mfma_f32_16x16x32_bf16 v[212:215], a[232:235], v[120:123], v[212:215]
    v_exp_f32 v210, v210
    v_mfma_f32_16x16x32_bf16 v[212:215], a[236:239], v[124:127], v[212:215]
    v_exp_f32 v211, v211
    v_mfma_f32_16x16x32_bf16 a[56:59], a[184:187], v[176:179], a[56:59]
    ds_read_b64_tr_b16 a[168:169], v25 offset:49152
    v_cvt_pk_bf16_f32 v146, v208, v209
    v_mfma_f32_16x16x32_bf16 a[56:59], a[188:191], v[180:183], a[56:59]
    ds_read_b64_tr_b16 a[170:171], v25 offset:53248
    v_mfma_f32_16x16x32_bf16 a[60:63], a[184:187], v[184:187], a[60:63]
    ds_read_b128 a[224:227], v8 offset:12288
    v_cvt_pk_bf16_f32 v147, v210, v211
    v_mfma_f32_16x16x32_bf16 a[60:63], a[188:191], v[188:191], a[60:63]
    s_waitcnt lgkmcnt(3)
    buffer_load_dwordx4 v40, s[12:15], s41 offen offset:2048 lds
    v_mfma_f32_16x16x32_bf16 v[208:211], a[208:211], v[64:67], v[192:195]
    v_exp_f32 v212, v212
    v_mfma_f32_16x16x32_bf16 v[208:211], a[212:215], v[68:71], v[208:211]
    v_exp_f32 v213, v213
    v_mfma_f32_16x16x32_bf16 v[208:211], a[216:219], v[72:75], v[208:211]
    v_exp_f32 v214, v214
    v_mfma_f32_16x16x32_bf16 v[208:211], a[220:223], v[76:79], v[208:211]
    v_exp_f32 v215, v215
    v_mfma_f32_16x16x32_bf16 a[64:67], a[160:163], v[160:163], a[64:67]
    ds_read_b64_tr_b16 a[172:173], v25 offset:57344
    v_cvt_pk_bf16_f32 v154, v212, v213
    v_mfma_f32_16x16x32_bf16 a[64:67], a[164:167], v[164:167], a[64:67]
    ds_read_b64_tr_b16 a[174:175], v25 offset:61440
    v_mfma_f32_16x16x32_bf16 a[68:71], a[160:163], v[168:171], a[68:71]
    ds_read_b128 a[228:231], v9 offset:12288
    v_cvt_pk_bf16_f32 v155, v214, v215
    v_mfma_f32_16x16x32_bf16 a[68:71], a[164:167], v[172:175], a[68:71]
    v_smfmac_f32_16x16x64_bf16 a[204:207], v[52:55], v[184:191], v50
    v_mfma_f32_16x16x32_bf16 v[212:215], a[208:211], v[80:83], v[196:199]
    v_exp_f32 v208, v208
    v_mfma_f32_16x16x32_bf16 v[212:215], a[212:215], v[84:87], v[212:215]
    v_exp_f32 v209, v209
    v_mfma_f32_16x16x32_bf16 v[212:215], a[216:219], v[88:91], v[212:215]
    v_exp_f32 v210, v210
    v_mfma_f32_16x16x32_bf16 v[212:215], a[220:223], v[92:95], v[212:215]
    v_exp_f32 v211, v211
    v_mfma_f32_16x16x32_bf16 a[72:75], a[160:163], v[176:179], a[72:75]
    ds_read_b64_tr_b16 a[176:177], v26 offset:49152
    v_cvt_pk_bf16_f32 v132, v208, v209
    v_mfma_f32_16x16x32_bf16 a[72:75], a[164:167], v[180:183], a[72:75]
    ds_read_b64_tr_b16 a[178:179], v26 offset:53248
    v_mfma_f32_16x16x32_bf16 a[76:79], a[160:163], v[184:187], a[76:79]
    ds_read_b128 a[232:235], v10 offset:12288
    v_cvt_pk_bf16_f32 v133, v210, v211
    v_mfma_f32_16x16x32_bf16 a[76:79], a[164:167], v[188:191], a[76:79]
    s_waitcnt lgkmcnt(3)
    buffer_load_dwordx4 v41, s[12:15], s41 offen offset:3072 lds
    v_mfma_f32_16x16x32_bf16 v[208:211], a[208:211], v[96:99], v[200:203]
    v_exp_f32 v212, v212
    v_mfma_f32_16x16x32_bf16 v[208:211], a[212:215], v[100:103], v[208:211]
    s_add_u32 s41, s41, 16384
    v_exp_f32 v213, v213
    v_mfma_f32_16x16x32_bf16 v[208:211], a[216:219], v[104:107], v[208:211]
    v_exp_f32 v214, v214
    v_mfma_f32_16x16x32_bf16 v[208:211], a[220:223], v[108:111], v[208:211]
    v_exp_f32 v215, v215
    v_mfma_f32_16x16x32_bf16 a[80:83], a[168:171], v[160:163], a[80:83]
    ds_read_b64_tr_b16 a[180:181], v26 offset:57344
    v_cvt_pk_bf16_f32 v140, v212, v213
    v_mfma_f32_16x16x32_bf16 a[80:83], a[172:175], v[164:167], a[80:83]
    ds_read_b64_tr_b16 a[182:183], v26 offset:61440
    v_mfma_f32_16x16x32_bf16 a[84:87], a[168:171], v[168:171], a[84:87]
    ds_read_b128 a[236:239], v11 offset:12288
    v_cvt_pk_bf16_f32 v141, v214, v215
    v_mfma_f32_16x16x32_bf16 a[84:87], a[172:175], v[172:175], a[84:87]
    s_waitcnt vmcnt(9)
    s_barrier
    v_mfma_f32_16x16x32_bf16 v[212:215], a[208:211], v[112:115], v[204:207]
    v_exp_f32 v208, v208
    v_mfma_f32_16x16x32_bf16 v[212:215], a[212:215], v[116:119], v[212:215]
    s_add_u32 m0, s42, 49152
    v_exp_f32 v209, v209
    v_mfma_f32_16x16x32_bf16 v[212:215], a[216:219], v[120:123], v[212:215]
    v_exp_f32 v210, v210
    v_mfma_f32_16x16x32_bf16 v[212:215], a[220:223], v[124:127], v[212:215]
    v_exp_f32 v211, v211
    v_mfma_f32_16x16x32_bf16 a[88:91], a[168:171], v[176:179], a[88:91]
    ds_read_b64_tr_b16 a[184:185], v27 offset:49152
    v_cvt_pk_bf16_f32 v148, v208, v209
    v_mfma_f32_16x16x32_bf16 a[88:91], a[172:175], v[180:183], a[88:91]
    ds_read_b64_tr_b16 a[186:187], v27 offset:53248
    v_mfma_f32_16x16x32_bf16 a[92:95], a[168:171], v[184:187], a[92:95]
    ds_read_b128 a[208:211], v8 offset:16384
    v_cvt_pk_bf16_f32 v149, v210, v211
    v_mfma_f32_16x16x32_bf16 a[92:95], a[172:175], v[188:191], a[92:95]
    s_waitcnt lgkmcnt(3)
    buffer_load_dwordx4 v36, s[8:11], s40 offen lds
    v_mfma_f32_16x16x32_bf16 v[208:211], a[224:227], v[64:67], v[192:195]
    v_exp_f32 v212, v212
    v_mfma_f32_16x16x32_bf16 v[208:211], a[228:231], v[68:71], v[208:211]
    v_exp_f32 v213, v213
    v_mfma_f32_16x16x32_bf16 v[208:211], a[232:235], v[72:75], v[208:211]
    v_exp_f32 v214, v214
    v_mfma_f32_16x16x32_bf16 v[208:211], a[236:239], v[76:79], v[208:211]
    v_exp_f32 v215, v215
    v_mfma_f32_16x16x32_bf16 a[96:99], a[176:179], v[160:163], a[96:99]
    ds_read_b64_tr_b16 a[188:189], v27 offset:57344
    v_cvt_pk_bf16_f32 v156, v212, v213
    v_mfma_f32_16x16x32_bf16 a[96:99], a[180:183], v[164:167], a[96:99]
    ds_read_b64_tr_b16 a[190:191], v27 offset:61440
    v_mfma_f32_16x16x32_bf16 a[100:103], a[176:179], v[168:171], a[100:103]
    ds_read_b128 a[212:215], v9 offset:16384
    v_cvt_pk_bf16_f32 v157, v214, v215
    v_mfma_f32_16x16x32_bf16 a[100:103], a[180:183], v[172:175], a[100:103]
    v_mfma_f32_16x16x32_bf16 v[212:215], a[224:227], v[80:83], v[196:199]
    v_exp_f32 v208, v208
    v_mfma_f32_16x16x32_bf16 v[212:215], a[228:231], v[84:87], v[212:215]
    s_add_u32 s39, s39, 786432
    v_exp_f32 v209, v209
    v_mfma_f32_16x16x32_bf16 v[212:215], a[232:235], v[88:91], v[212:215]
    v_exp_f32 v210, v210
    v_mfma_f32_16x16x32_bf16 v[212:215], a[236:239], v[92:95], v[212:215]
    v_exp_f32 v211, v211
    v_mfma_f32_16x16x32_bf16 a[104:107], a[176:179], v[176:179], a[104:107]
    ds_read_b64_tr_b16 a[160:161], v20 offset:0
    v_cvt_pk_bf16_f32 v134, v208, v209
    v_mfma_f32_16x16x32_bf16 a[104:107], a[180:183], v[180:183], a[104:107]
    ds_read_b64_tr_b16 a[162:163], v20 offset:4096
    v_mfma_f32_16x16x32_bf16 a[108:111], a[176:179], v[184:187], a[108:111]
    ds_read_b128 a[216:219], v10 offset:16384
    v_cvt_pk_bf16_f32 v135, v210, v211
    v_mfma_f32_16x16x32_bf16 a[108:111], a[180:183], v[188:191], a[108:111]
    s_waitcnt lgkmcnt(3)
    buffer_load_dwordx4 v37, s[8:11], s40 offen offset:1024 lds
    v_mfma_f32_16x16x32_bf16 v[208:211], a[224:227], v[96:99], v[200:203]
    v_exp_f32 v212, v212
    v_mfma_f32_16x16x32_bf16 v[208:211], a[228:231], v[100:103], v[208:211]
    v_exp_f32 v213, v213
    v_mfma_f32_16x16x32_bf16 v[208:211], a[232:235], v[104:107], v[208:211]
    v_exp_f32 v214, v214
    v_mfma_f32_16x16x32_bf16 v[208:211], a[236:239], v[108:111], v[208:211]
    v_exp_f32 v215, v215
    v_mfma_f32_16x16x32_bf16 a[112:115], a[184:187], v[160:163], a[112:115]
    ds_read_b64_tr_b16 a[164:165], v20 offset:8192
    v_cvt_pk_bf16_f32 v142, v212, v213
    v_mfma_f32_16x16x32_bf16 a[112:115], a[188:191], v[164:167], a[112:115]
    ds_read_b64_tr_b16 a[166:167], v20 offset:12288
    v_mfma_f32_16x16x32_bf16 a[116:119], a[184:187], v[168:171], a[116:119]
    ds_read_b128 a[220:223], v11 offset:16384
    v_cvt_pk_bf16_f32 v143, v214, v215
    v_mfma_f32_16x16x32_bf16 a[116:119], a[188:191], v[172:175], a[116:119]
    v_mfma_f32_16x16x32_bf16 v[212:215], a[224:227], v[112:115], v[204:207]
    v_exp_f32 v208, v208
    v_mfma_f32_16x16x32_bf16 v[212:215], a[228:231], v[116:119], v[212:215]
    v_exp_f32 v209, v209
    v_mfma_f32_16x16x32_bf16 v[212:215], a[232:235], v[120:123], v[212:215]
    v_exp_f32 v210, v210
    v_mfma_f32_16x16x32_bf16 v[212:215], a[236:239], v[124:127], v[212:215]
    v_exp_f32 v211, v211
    v_mfma_f32_16x16x32_bf16 a[120:123], a[184:187], v[176:179], a[120:123]
    ds_read_b64_tr_b16 a[168:169], v21 offset:0
    v_cvt_pk_bf16_f32 v150, v208, v209
    v_mfma_f32_16x16x32_bf16 a[120:123], a[188:191], v[180:183], a[120:123]
    ds_read_b64_tr_b16 a[170:171], v21 offset:4096
    v_mfma_f32_16x16x32_bf16 a[124:127], a[184:187], v[184:187], a[124:127]
    ds_read_b128 a[224:227], v8 offset:20480
    v_cvt_pk_bf16_f32 v151, v210, v211
    v_mfma_f32_16x16x32_bf16 a[124:127], a[188:191], v[188:191], a[124:127]
    s_waitcnt lgkmcnt(3)
    buffer_load_dwordx4 v38, s[8:11], s40 offen offset:2048 lds
    s_sub_u32 s43, s43, 1
    s_cmp_lg_u32 s43, 0
    s_cbranch_scc1 Lattn_loop
    v_mfma_f32_16x16x32_bf16 v[208:211], a[208:211], v[64:67], v[192:195]
    v_exp_f32 v212, v212
    v_mfma_f32_16x16x32_bf16 v[208:211], a[212:215], v[68:71], v[208:211]
    v_exp_f32 v213, v213
    v_mfma_f32_16x16x32_bf16 v[208:211], a[216:219], v[72:75], v[208:211]
    v_exp_f32 v214, v214
    v_mfma_f32_16x16x32_bf16 v[208:211], a[220:223], v[76:79], v[208:211]
    v_exp_f32 v215, v215
    v_mfma_f32_16x16x32_bf16 a[0:3], a[160:163], v[128:131], a[0:3]
    ds_read_b64_tr_b16 a[172:173], v21 offset:8192
    v_cvt_pk_bf16_f32 v158, v212, v213
    v_mfma_f32_16x16x32_bf16 a[0:3], a[164:167], v[132:135], a[0:3]
    ds_read_b64_tr_b16 a[174:175], v21 offset:12288
    v_mfma_f32_16x16x32_bf16 a[4:7], a[160:163], v[136:139], a[4:7]
    ds_read_b128 a[228:231], v9 offset:20480
    v_cvt_pk_bf16_f32 v159, v214, v215
    v_mfma_f32_16x16x32_bf16 a[4:7], a[164:167], v[140:143], a[4:7]
    v_mfma_f32_16x16x32_bf16 v[212:215], a[208:211], v[80:83], v[196:199]
    v_exp_f32 v208, v208
    v_mfma_f32_16x16x32_bf16 v[212:215], a[212:215], v[84:87], v[212:215]
    v_exp_f32 v209, v209
    v_mfma_f32_16x16x32_bf16 v[212:215], a[216:219], v[88:91], v[212:215]
    v_exp_f32 v210, v210
    v_mfma_f32_16x16x32_bf16 v[212:215], a[220:223], v[92:95], v[212:215]
    v_exp_f32 v211, v211
    v_mfma_f32_16x16x32_bf16 a[8:11], a[160:163], v[144:147], a[8:11]
    ds_read_b64_tr_b16 a[176:177], v22 offset:0
    v_cvt_pk_bf16_f32 v160, v208, v209
    v_mfma_f32_16x16x32_bf16 a[8:11], a[164:167], v[148:151], a[8:11]
    ds_read_b64_tr_b16 a[178:179], v22 offset:4096
    v_mfma_f32_16x16x32_bf16 a[12:15], a[160:163], v[152:155], a[12:15]
    ds_read_b128 a[232:235], v10 offset:20480
    v_cvt_pk_bf16_f32 v161, v210, v211
    v_mfma_f32_16x16x32_bf16 a[12:15], a[164:167], v[156:159], a[12:15]
    s_waitcnt lgkmcnt(3)
    buffer_load_dwordx4 v39, s[8:11], s40 offen offset:3072 lds
    v_mfma_f32_16x16x32_bf16 v[208:211], a[208:211], v[96:99], v[200:203]
    v_exp_f32 v212, v212
    v_mfma_f32_16x16x32_bf16 v[208:211], a[212:215], v[100:103], v[208:211]
    s_add_u32 s40, s40, 16384
    v_exp_f32 v213, v213
    v_mfma_f32_16x16x32_bf16 v[208:211], a[216:219], v[104:107], v[208:211]
    v_exp_f32 v214, v214
    v_mfma_f32_16x16x32_bf16 v[208:211], a[220:223], v[108:111], v[208:211]
    v_exp_f32 v215, v215
    v_mfma_f32_16x16x32_bf16 a[16:19], a[168:171], v[128:131], a[16:19]
    ds_read_b64_tr_b16 a[180:181], v22 offset:8192
    v_cvt_pk_bf16_f32 v168, v212, v213
    v_mfma_f32_16x16x32_bf16 a[16:19], a[172:175], v[132:135], a[16:19]
    ds_read_b64_tr_b16 a[182:183], v22 offset:12288
    v_mfma_f32_16x16x32_bf16 a[20:23], a[168:171], v[136:139], a[20:23]
    ds_read_b128 a[236:239], v11 offset:20480
    v_cvt_pk_bf16_f32 v169, v214, v215
    v_mfma_f32_16x16x32_bf16 a[20:23], a[172:175], v[140:143], a[20:23]
    v_smfmac_f32_16x16x64_bf16 a[192:195], v[52:55], v[128:135], v50
    v_mfma_f32_16x16x32_bf16 v[212:215], a[208:211], v[112:115], v[204:207]
    v_exp_f32 v208, v208
    v_mfma_f32_16x16x32_bf16 v[212:215], a[212:215], v[116:119], v[212:215]
    s_add_u32 m0, s42, 98304
    v_exp_f32 v209, v209
    v_mfma_f32_16x16x32_bf16 v[212:215], a[216:219], v[120:123], v[212:215]
    v_exp_f32 v210, v210
    v_mfma_f32_16x16x32_bf16 v[212:215], a[220:223], v[124:127], v[212:215]
    v_exp_f32 v211, v211
    v_mfma_f32_16x16x32_bf16 a[24:27], a[168:171], v[144:147], a[24:27]
    ds_read_b64_tr_b16 a[184:185], v23 offset:0
    v_cvt_pk_bf16_f32 v176, v208, v209
    v_mfma_f32_16x16x32_bf16 a[24:27], a[172:175], v[148:151], a[24:27]
    ds_read_b64_tr_b16 a[186:187], v23 offset:4096
    v_mfma_f32_16x16x32_bf16 a[28:31], a[168:171], v[152:155], a[28:31]
    ds_read_b128 a[208:211], v8 offset:24576
    v_cvt_pk_bf16_f32 v177, v210, v211
    v_mfma_f32_16x16x32_bf16 a[28:31], a[172:175], v[156:159], a[28:31]
    s_waitcnt lgkmcnt(3)
    buffer_load_dwordx4 v40, s[12:15], s41 offen lds
    v_mfma_f32_16x16x32_bf16 v[208:211], a[224:227], v[64:67], v[192:195]
    v_exp_f32 v212, v212
    v_mfma_f32_16x16x32_bf16 v[208:211], a[228:231], v[68:71], v[208:211]
    v_exp_f32 v213, v213
    v_mfma_f32_16x16x32_bf16 v[208:211], a[232:235], v[72:75], v[208:211]
    v_exp_f32 v214, v214
    v_mfma_f32_16x16x32_bf16 v[208:211], a[236:239], v[76:79], v[208:211]
    v_exp_f32 v215, v215
    v_mfma_f32_16x16x32_bf16 a[32:35], a[176:179], v[128:131], a[32:35]
    ds_read_b64_tr_b16 a[188:189], v23 offset:8192
    v_cvt_pk_bf16_f32 v184, v212, v213
    v_mfma_f32_16x16x32_bf16 a[32:35], a[180:183], v[132:135], a[32:35]
    ds_read_b64_tr_b16 a[190:191], v23 offset:12288
    v_mfma_f32_16x16x32_bf16 a[36:39], a[176:179], v[136:139], a[36:39]
    ds_read_b128 a[212:215], v9 offset:24576
    v_cvt_pk_bf16_f32 v185, v214, v215
    v_mfma_f32_16x16x32_bf16 a[36:39], a[180:183], v[140:143], a[36:39]
    v_smfmac_f32_16x16x64_bf16 a[196:199], v[52:55], v[136:143], v50
    v_mfma_f32_16x16x32_bf16 v[212:215], a[224:227], v[80:83], v[196:199]
    v_exp_f32 v208, v208
    v_mfma_f32_16x16x32_bf16 v[212:215], a[228:231], v[84:87], v[212:215]
    v_exp_f32 v209, v209
    v_mfma_f32_16x16x32_bf16 v[212:215], a[232:235], v[88:91], v[212:215]
    v_exp_f32 v210, v210
    v_mfma_f32_16x16x32_bf16 v[212:215], a[236:239], v[92:95], v[212:215]
    v_exp_f32 v211, v211
    v_mfma_f32_16x16x32_bf16 a[40:43], a[176:179], v[144:147], a[40:43]
    ds_read_b64_tr_b16 a[160:161], v24 offset:0
    v_cvt_pk_bf16_f32 v162, v208, v209
    v_mfma_f32_16x16x32_bf16 a[40:43], a[180:183], v[148:151], a[40:43]
    ds_read_b64_tr_b16 a[162:163], v24 offset:4096
    v_mfma_f32_16x16x32_bf16 a[44:47], a[176:179], v[152:155], a[44:47]
    ds_read_b128 a[216:219], v10 offset:24576
    v_cvt_pk_bf16_f32 v163, v210, v211
    v_mfma_f32_16x16x32_bf16 a[44:47], a[180:183], v[156:159], a[44:47]
    s_waitcnt lgkmcnt(3)
    buffer_load_dwordx4 v41, s[12:15], s41 offen offset:1024 lds
    v_mfma_f32_16x16x32_bf16 v[208:211], a[224:227], v[96:99], v[200:203]
    v_exp_f32 v212, v212
    v_mfma_f32_16x16x32_bf16 v[208:211], a[228:231], v[100:103], v[208:211]
    v_exp_f32 v213, v213
    v_mfma_f32_16x16x32_bf16 v[208:211], a[232:235], v[104:107], v[208:211]
    v_exp_f32 v214, v214
    v_mfma_f32_16x16x32_bf16 v[208:211], a[236:239], v[108:111], v[208:211]
    v_exp_f32 v215, v215
    v_mfma_f32_16x16x32_bf16 a[48:51], a[184:187], v[128:131], a[48:51]
    ds_read_b64_tr_b16 a[164:165], v24 offset:8192
    v_cvt_pk_bf16_f32 v170, v212, v213
    v_mfma_f32_16x16x32_bf16 a[48:51], a[188:191], v[132:135], a[48:51]
    ds_read_b64_tr_b16 a[166:167], v24 offset:12288
    v_mfma_f32_16x16x32_bf16 a[52:55], a[184:187], v[136:139], a[52:55]
    ds_read_b128 a[220:223], v11 offset:24576
    v_cvt_pk_bf16_f32 v171, v214, v215
    v_mfma_f32_16x16x32_bf16 a[52:55], a[188:191], v[140:143], a[52:55]
    v_smfmac_f32_16x16x64_bf16 a[200:203], v[52:55], v[144:151], v50
    v_mfma_f32_16x16x32_bf16 v[212:215], a[224:227], v[112:115], v[204:207]
    v_exp_f32 v208, v208
    v_mfma_f32_16x16x32_bf16 v[212:215], a[228:231], v[116:119], v[212:215]
    v_exp_f32 v209, v209
    v_mfma_f32_16x16x32_bf16 v[212:215], a[232:235], v[120:123], v[212:215]
    v_exp_f32 v210, v210
    v_mfma_f32_16x16x32_bf16 v[212:215], a[236:239], v[124:127], v[212:215]
    v_exp_f32 v211, v211
    v_mfma_f32_16x16x32_bf16 a[56:59], a[184:187], v[144:147], a[56:59]
    ds_read_b64_tr_b16 a[168:169], v25 offset:0
    v_cvt_pk_bf16_f32 v178, v208, v209
    v_mfma_f32_16x16x32_bf16 a[56:59], a[188:191], v[148:151], a[56:59]
    ds_read_b64_tr_b16 a[170:171], v25 offset:4096
    v_mfma_f32_16x16x32_bf16 a[60:63], a[184:187], v[152:155], a[60:63]
    ds_read_b128 a[224:227], v8 offset:28672
    v_cvt_pk_bf16_f32 v179, v210, v211
    v_mfma_f32_16x16x32_bf16 a[60:63], a[188:191], v[156:159], a[60:63]
    s_waitcnt lgkmcnt(3)
    buffer_load_dwordx4 v40, s[12:15], s41 offen offset:2048 lds
    v_mfma_f32_16x16x32_bf16 v[208:211], a[208:211], v[64:67], v[192:195]
    v_exp_f32 v212, v212
    v_mfma_f32_16x16x32_bf16 v[208:211], a[212:215], v[68:71], v[208:211]
    v_exp_f32 v213, v213
    v_mfma_f32_16x16x32_bf16 v[208:211], a[216:219], v[72:75], v[208:211]
    v_exp_f32 v214, v214
    v_mfma_f32_16x16x32_bf16 v[208:211], a[220:223], v[76:79], v[208:211]
    v_exp_f32 v215, v215
    v_mfma_f32_16x16x32_bf16 a[64:67], a[160:163], v[128:131], a[64:67]
    ds_read_b64_tr_b16 a[172:173], v25 offset:8192
    v_cvt_pk_bf16_f32 v186, v212, v213
    v_mfma_f32_16x16x32_bf16 a[64:67], a[164:167], v[132:135], a[64:67]
    ds_read_b64_tr_b16 a[174:175], v25 offset:12288
    v_mfma_f32_16x16x32_bf16 a[68:71], a[160:163], v[136:139], a[68:71]
    ds_read_b128 a[228:231], v9 offset:28672
    v_cvt_pk_bf16_f32 v187, v214, v215
    v_mfma_f32_16x16x32_bf16 a[68:71], a[164:167], v[140:143], a[68:71]
    v_smfmac_f32_16x16x64_bf16 a[204:207], v[52:55], v[152:159], v50
    v_mfma_f32_16x16x32_bf16 v[212:215], a[208:211], v[80:83], v[196:199]
    v_exp_f32 v208, v208
    v_mfma_f32_16x16x32_bf16 v[212:215], a[212:215], v[84:87], v[212:215]
    v_exp_f32 v209, v209
    v_mfma_f32_16x16x32_bf16 v[212:215], a[216:219], v[88:91], v[212:215]
    v_exp_f32 v210, v210
    v_mfma_f32_16x16x32_bf16 v[212:215], a[220:223], v[92:95], v[212:215]
    v_exp_f32 v211, v211
    v_mfma_f32_16x16x32_bf16 a[72:75], a[160:163], v[144:147], a[72:75]
    ds_read_b64_tr_b16 a[176:177], v26 offset:0
    v_cvt_pk_bf16_f32 v164, v208, v209
    v_mfma_f32_16x16x32_bf16 a[72:75], a[164:167], v[148:151], a[72:75]
    ds_read_b64_tr_b16 a[178:179], v26 offset:4096
    v_mfma_f32_16x16x32_bf16 a[76:79], a[160:163], v[152:155], a[76:79]
    ds_read_b128 a[232:235], v10 offset:28672
    v_cvt_pk_bf16_f32 v165, v210, v211
    v_mfma_f32_16x16x32_bf16 a[76:79], a[164:167], v[156:159], a[76:79]
    s_waitcnt lgkmcnt(3)
    buffer_load_dwordx4 v41, s[12:15], s41 offen offset:3072 lds
    v_mfma_f32_16x16x32_bf16 v[208:211], a[208:211], v[96:99], v[200:203]
    v_exp_f32 v212, v212
    v_mfma_f32_16x16x32_bf16 v[208:211], a[212:215], v[100:103], v[208:211]
    s_add_u32 s41, s41, 16384
    v_exp_f32 v213, v213
    v_mfma_f32_16x16x32_bf16 v[208:211], a[216:219], v[104:107], v[208:211]
    v_exp_f32 v214, v214
    v_mfma_f32_16x16x32_bf16 v[208:211], a[220:223], v[108:111], v[208:211]
    v_exp_f32 v215, v215
    v_mfma_f32_16x16x32_bf16 a[80:83], a[168:171], v[128:131], a[80:83]
    ds_read_b64_tr_b16 a[180:181], v26 offset:8192
    v_cvt_pk_bf16_f32 v172, v212, v213
    v_mfma_f32_16x16x32_bf16 a[80:83], a[172:175], v[132:135], a[80:83]
    ds_read_b64_tr_b16 a[182:183], v26 offset:12288
    v_mfma_f32_16x16x32_bf16 a[84:87], a[168:171], v[136:139], a[84:87]
    ds_read_b128 a[236:239], v11 offset:28672
    v_cvt_pk_bf16_f32 v173, v214, v215
    v_mfma_f32_16x16x32_bf16 a[84:87], a[172:175], v[140:143], a[84:87]
    s_waitcnt vmcnt(8)
    s_barrier
    v_mfma_f32_16x16x32_bf16 v[212:215], a[208:211], v[112:115], v[204:207]
    v_exp_f32 v208, v208
    v_mfma_f32_16x16x32_bf16 v[212:215], a[212:215], v[116:119], v[212:215]
    s_add_u32 s49, s45, 0
    v_exp_f32 v209, v209
    v_mfma_f32_16x16x32_bf16 v[212:215], a[216:219], v[120:123], v[212:215]
    s_add_u32 m0, s42, 131072
    v_exp_f32 v210, v210
    v_mfma_f32_16x16x32_bf16 v[212:215], a[220:223], v[124:127], v[212:215]
    v_exp_f32 v211, v211
    v_mfma_f32_16x16x32_bf16 a[88:91], a[168:171], v[144:147], a[88:91]
    ds_read_b64_tr_b16 a[184:185], v27 offset:0
    v_cvt_pk_bf16_f32 v180, v208, v209
    v_mfma_f32_16x16x32_bf16 a[88:91], a[172:175], v[148:151], a[88:91]
    ds_read_b64_tr_b16 a[186:187], v27 offset:4096
    v_mfma_f32_16x16x32_bf16 a[92:95], a[168:171], v[152:155], a[92:95]
    ds_read_b128 a[208:211], v8 offset:32768
    v_cvt_pk_bf16_f32 v181, v210, v211
    v_mfma_f32_16x16x32_bf16 a[92:95], a[172:175], v[156:159], a[92:95]
    s_waitcnt lgkmcnt(3)
    buffer_load_dwordx4 v46, s[20:23], s49 offen lds
    v_mfma_f32_16x16x32_bf16 v[208:211], a[224:227], v[64:67], v[192:195]
    v_exp_f32 v212, v212
    v_mfma_f32_16x16x32_bf16 v[208:211], a[228:231], v[68:71], v[208:211]
    v_exp_f32 v213, v213
    v_mfma_f32_16x16x32_bf16 v[208:211], a[232:235], v[72:75], v[208:211]
    v_exp_f32 v214, v214
    v_mfma_f32_16x16x32_bf16 v[208:211], a[236:239], v[76:79], v[208:211]
    v_exp_f32 v215, v215
    v_mfma_f32_16x16x32_bf16 a[96:99], a[176:179], v[128:131], a[96:99]
    ds_read_b64_tr_b16 a[188:189], v27 offset:8192
    v_cvt_pk_bf16_f32 v188, v212, v213
    v_mfma_f32_16x16x32_bf16 a[96:99], a[180:183], v[132:135], a[96:99]
    ds_read_b64_tr_b16 a[190:191], v27 offset:12288
    v_mfma_f32_16x16x32_bf16 a[100:103], a[176:179], v[136:139], a[100:103]
    ds_read_b128 a[212:215], v9 offset:32768
    v_cvt_pk_bf16_f32 v189, v214, v215
    v_mfma_f32_16x16x32_bf16 a[100:103], a[180:183], v[140:143], a[100:103]
    v_mfma_f32_16x16x32_bf16 v[212:215], a[224:227], v[80:83], v[196:199]
    v_exp_f32 v208, v208
    v_mfma_f32_16x16x32_bf16 v[212:215], a[228:231], v[84:87], v[212:215]
    v_exp_f32 v209, v209
    v_mfma_f32_16x16x32_bf16 v[212:215], a[232:235], v[88:91], v[212:215]
    v_exp_f32 v210, v210
    v_mfma_f32_16x16x32_bf16 v[212:215], a[236:239], v[92:95], v[212:215]
    v_exp_f32 v211, v211
    v_mfma_f32_16x16x32_bf16 a[104:107], a[176:179], v[144:147], a[104:107]
    ds_read_b64_tr_b16 a[160:161], v20 offset:16384
    v_cvt_pk_bf16_f32 v166, v208, v209
    v_mfma_f32_16x16x32_bf16 a[104:107], a[180:183], v[148:151], a[104:107]
    ds_read_b64_tr_b16 a[162:163], v20 offset:20480
    v_mfma_f32_16x16x32_bf16 a[108:111], a[176:179], v[152:155], a[108:111]
    ds_read_b128 a[216:219], v10 offset:32768
    v_cvt_pk_bf16_f32 v167, v210, v211
    v_mfma_f32_16x16x32_bf16 a[108:111], a[180:183], v[156:159], a[108:111]
    s_waitcnt lgkmcnt(3)
    buffer_load_dwordx4 v47, s[20:23], s49 offen offset:1024 lds
    v_mfma_f32_16x16x32_bf16 v[208:211], a[224:227], v[96:99], v[200:203]
    v_exp_f32 v212, v212
    v_mfma_f32_16x16x32_bf16 v[208:211], a[228:231], v[100:103], v[208:211]
    v_exp_f32 v213, v213
    v_mfma_f32_16x16x32_bf16 v[208:211], a[232:235], v[104:107], v[208:211]
    v_exp_f32 v214, v214
    v_mfma_f32_16x16x32_bf16 v[208:211], a[236:239], v[108:111], v[208:211]
    v_exp_f32 v215, v215
    v_mfma_f32_16x16x32_bf16 a[112:115], a[184:187], v[128:131], a[112:115]
    ds_read_b64_tr_b16 a[164:165], v20 offset:24576
    v_cvt_pk_bf16_f32 v174, v212, v213
    v_mfma_f32_16x16x32_bf16 a[112:115], a[188:191], v[132:135], a[112:115]
    ds_read_b64_tr_b16 a[166:167], v20 offset:28672
    v_mfma_f32_16x16x32_bf16 a[116:119], a[184:187], v[136:139], a[116:119]
    ds_read_b128 a[220:223], v11 offset:32768
    v_cvt_pk_bf16_f32 v175, v214, v215
    v_mfma_f32_16x16x32_bf16 a[116:119], a[188:191], v[140:143], a[116:119]
    v_mfma_f32_16x16x32_bf16 v[212:215], a[224:227], v[112:115], v[204:207]
    v_exp_f32 v208, v208
    v_mfma_f32_16x16x32_bf16 v[212:215], a[228:231], v[116:119], v[212:215]
    v_exp_f32 v209, v209
    v_mfma_f32_16x16x32_bf16 v[212:215], a[232:235], v[120:123], v[212:215]
    v_exp_f32 v210, v210
    v_mfma_f32_16x16x32_bf16 v[212:215], a[236:239], v[124:127], v[212:215]
    v_exp_f32 v211, v211
    v_mfma_f32_16x16x32_bf16 a[120:123], a[184:187], v[144:147], a[120:123]
    ds_read_b64_tr_b16 a[168:169], v21 offset:16384
    v_cvt_pk_bf16_f32 v182, v208, v209
    v_mfma_f32_16x16x32_bf16 a[120:123], a[188:191], v[148:151], a[120:123]
    ds_read_b64_tr_b16 a[170:171], v21 offset:20480
    v_mfma_f32_16x16x32_bf16 a[124:127], a[184:187], v[152:155], a[124:127]
    ds_read_b128 a[224:227], v8 offset:36864
    v_cvt_pk_bf16_f32 v183, v210, v211
    v_mfma_f32_16x16x32_bf16 a[124:127], a[188:191], v[156:159], a[124:127]
    s_waitcnt lgkmcnt(3)
    buffer_load_dwordx4 v48, s[20:23], s49 offen offset:2048 lds
    v_mfma_f32_16x16x32_bf16 v[208:211], a[208:211], v[64:67], v[192:195]
    v_exp_f32 v212, v212
    v_mfma_f32_16x16x32_bf16 v[208:211], a[212:215], v[68:71], v[208:211]
    v_exp_f32 v213, v213
    v_mfma_f32_16x16x32_bf16 v[208:211], a[216:219], v[72:75], v[208:211]
    v_exp_f32 v214, v214
    v_mfma_f32_16x16x32_bf16 v[208:211], a[220:223], v[76:79], v[208:211]
    v_exp_f32 v215, v215
    v_mfma_f32_16x16x32_bf16 a[0:3], a[160:163], v[160:163], a[0:3]
    ds_read_b64_tr_b16 a[172:173], v21 offset:24576
    v_cvt_pk_bf16_f32 v190, v212, v213
    v_mfma_f32_16x16x32_bf16 a[0:3], a[164:167], v[164:167], a[0:3]
    ds_read_b64_tr_b16 a[174:175], v21 offset:28672
    v_mfma_f32_16x16x32_bf16 a[4:7], a[160:163], v[168:171], a[4:7]
    ds_read_b128 a[228:231], v9 offset:36864
    v_cvt_pk_bf16_f32 v191, v214, v215
    v_mfma_f32_16x16x32_bf16 a[4:7], a[164:167], v[172:175], a[4:7]
    v_mfma_f32_16x16x32_bf16 v[212:215], a[208:211], v[80:83], v[196:199]
    v_exp_f32 v208, v208
    v_mfma_f32_16x16x32_bf16 v[212:215], a[212:215], v[84:87], v[212:215]
    v_exp_f32 v209, v209
    v_mfma_f32_16x16x32_bf16 v[212:215], a[216:219], v[88:91], v[212:215]
    v_exp_f32 v210, v210
    v_mfma_f32_16x16x32_bf16 v[212:215], a[220:223], v[92:95], v[212:215]
    v_exp_f32 v211, v211
    v_mfma_f32_16x16x32_bf16 a[8:11], a[160:163], v[176:179], a[8:11]
    ds_read_b64_tr_b16 a[176:177], v22 offset:16384
    v_cvt_pk_bf16_f32 v128, v208, v209
    v_mfma_f32_16x16x32_bf16 a[8:11], a[164:167], v[180:183], a[8:11]
    ds_read_b64_tr_b16 a[178:179], v22 offset:20480
    v_mfma_f32_16x16x32_bf16 a[12:15], a[160:163], v[184:187], a[12:15]
    ds_read_b128 a[232:235], v10 offset:36864
    v_cvt_pk_bf16_f32 v129, v210, v211
    v_mfma_f32_16x16x32_bf16 a[12:15], a[164:167], v[188:191], a[12:15]
    s_waitcnt lgkmcnt(3)
    buffer_load_dwordx4 v49, s[20:23], s49 offen offset:3072 lds
    v_mfma_f32_16x16x32_bf16 v[208:211], a[208:211], v[96:99], v[200:203]
    v_exp_f32 v212, v212
    v_mfma_f32_16x16x32_bf16 v[208:211], a[212:215], v[100:103], v[208:211]
    v_exp_f32 v213, v213
    v_mfma_f32_16x16x32_bf16 v[208:211], a[216:219], v[104:107], v[208:211]
    v_exp_f32 v214, v214
    v_mfma_f32_16x16x32_bf16 v[208:211], a[220:223], v[108:111], v[208:211]
    v_exp_f32 v215, v215
    v_mfma_f32_16x16x32_bf16 a[16:19], a[168:171], v[160:163], a[16:19]
    ds_read_b64_tr_b16 a[180:181], v22 offset:24576
    v_cvt_pk_bf16_f32 v136, v212, v213
    v_mfma_f32_16x16x32_bf16 a[16:19], a[172:175], v[164:167], a[16:19]
    ds_read_b64_tr_b16 a[182:183], v22 offset:28672
    v_mfma_f32_16x16x32_bf16 a[20:23], a[168:171], v[168:171], a[20:23]
    ds_read_b128 a[236:239], v11 offset:36864
    v_cvt_pk_bf16_f32 v137, v214, v215
    v_mfma_f32_16x16x32_bf16 a[20:23], a[172:175], v[172:175], a[20:23]
    v_smfmac_f32_16x16x64_bf16 a[192:195], v[52:55], v[160:167], v50
    v_mfma_f32_16x16x32_bf16 v[212:215], a[208:211], v[112:115], v[204:207]
    v_exp_f32 v208, v208
    v_mfma_f32_16x16x32_bf16 v[212:215], a[212:215], v[116:119], v[212:215]
    s_add_u32 m0, s42, 114688
    v_exp_f32 v209, v209
    v_mfma_f32_16x16x32_bf16 v[212:215], a[216:219], v[120:123], v[212:215]
    v_exp_f32 v210, v210
    v_mfma_f32_16x16x32_bf16 v[212:215], a[220:223], v[124:127], v[212:215]
    v_exp_f32 v211, v211
    v_mfma_f32_16x16x32_bf16 a[24:27], a[168:171], v[176:179], a[24:27]
    ds_read_b64_tr_b16 a[184:185], v23 offset:16384
    v_cvt_pk_bf16_f32 v144, v208, v209
    v_mfma_f32_16x16x32_bf16 a[24:27], a[172:175], v[180:183], a[24:27]
    ds_read_b64_tr_b16 a[186:187], v23 offset:20480
    v_mfma_f32_16x16x32_bf16 a[28:31], a[168:171], v[184:187], a[28:31]
    ds_read_b128 a[208:211], v8 offset:40960
    v_cvt_pk_bf16_f32 v145, v210, v211
    v_mfma_f32_16x16x32_bf16 a[28:31], a[172:175], v[188:191], a[28:31]
    s_waitcnt lgkmcnt(3)
    buffer_load_dwordx4 v40, s[12:15], s41 offen lds
    v_mfma_f32_16x16x32_bf16 v[208:211], a[224:227], v[64:67], v[192:195]
    v_exp_f32 v212, v212
    v_mfma_f32_16x16x32_bf16 v[208:211], a[228:231], v[68:71], v[208:211]
    v_exp_f32 v213, v213
    v_mfma_f32_16x16x32_bf16 v[208:211], a[232:235], v[72:75], v[208:211]
    v_exp_f32 v214, v214
    v_mfma_f32_16x16x32_bf16 v[208:211], a[236:239], v[76:79], v[208:211]
    v_exp_f32 v215, v215
    v_mfma_f32_16x16x32_bf16 a[32:35], a[176:179], v[160:163], a[32:35]
    ds_read_b64_tr_b16 a[188:189], v23 offset:24576
    v_cvt_pk_bf16_f32 v152, v212, v213
    v_mfma_f32_16x16x32_bf16 a[32:35], a[180:183], v[164:167], a[32:35]
    ds_read_b64_tr_b16 a[190:191], v23 offset:28672
    v_mfma_f32_16x16x32_bf16 a[36:39], a[176:179], v[168:171], a[36:39]
    ds_read_b128 a[212:215], v9 offset:40960
    v_cvt_pk_bf16_f32 v153, v214, v215
    v_mfma_f32_16x16x32_bf16 a[36:39], a[180:183], v[172:175], a[36:39]
    v_smfmac_f32_16x16x64_bf16 a[196:199], v[52:55], v[168:175], v50
    v_mfma_f32_16x16x32_bf16 v[212:215], a[224:227], v[80:83], v[196:199]
    v_exp_f32 v208, v208
    v_mfma_f32_16x16x32_bf16 v[212:215], a[228:231], v[84:87], v[212:215]
    v_exp_f32 v209, v209
    v_mfma_f32_16x16x32_bf16 v[212:215], a[232:235], v[88:91], v[212:215]
    v_exp_f32 v210, v210
    v_mfma_f32_16x16x32_bf16 v[212:215], a[236:239], v[92:95], v[212:215]
    v_exp_f32 v211, v211
    v_mfma_f32_16x16x32_bf16 a[40:43], a[176:179], v[176:179], a[40:43]
    ds_read_b64_tr_b16 a[160:161], v24 offset:16384
    v_cvt_pk_bf16_f32 v130, v208, v209
    v_mfma_f32_16x16x32_bf16 a[40:43], a[180:183], v[180:183], a[40:43]
    ds_read_b64_tr_b16 a[162:163], v24 offset:20480
    v_mfma_f32_16x16x32_bf16 a[44:47], a[176:179], v[184:187], a[44:47]
    ds_read_b128 a[216:219], v10 offset:40960
    v_cvt_pk_bf16_f32 v131, v210, v211
    v_mfma_f32_16x16x32_bf16 a[44:47], a[180:183], v[188:191], a[44:47]
    s_waitcnt lgkmcnt(3)
    buffer_load_dwordx4 v41, s[12:15], s41 offen offset:1024 lds
    v_mfma_f32_16x16x32_bf16 v[208:211], a[224:227], v[96:99], v[200:203]
    v_exp_f32 v212, v212
    v_mfma_f32_16x16x32_bf16 v[208:211], a[228:231], v[100:103], v[208:211]
    v_exp_f32 v213, v213
    v_mfma_f32_16x16x32_bf16 v[208:211], a[232:235], v[104:107], v[208:211]
    v_exp_f32 v214, v214
    v_mfma_f32_16x16x32_bf16 v[208:211], a[236:239], v[108:111], v[208:211]
    v_exp_f32 v215, v215
    v_mfma_f32_16x16x32_bf16 a[48:51], a[184:187], v[160:163], a[48:51]
    ds_read_b64_tr_b16 a[164:165], v24 offset:24576
    v_cvt_pk_bf16_f32 v138, v212, v213
    v_mfma_f32_16x16x32_bf16 a[48:51], a[188:191], v[164:167], a[48:51]
    ds_read_b64_tr_b16 a[166:167], v24 offset:28672
    v_mfma_f32_16x16x32_bf16 a[52:55], a[184:187], v[168:171], a[52:55]
    ds_read_b128 a[220:223], v11 offset:40960
    v_cvt_pk_bf16_f32 v139, v214, v215
    v_mfma_f32_16x16x32_bf16 a[52:55], a[188:191], v[172:175], a[52:55]
    v_smfmac_f32_16x16x64_bf16 a[200:203], v[52:55], v[176:183], v50
    v_mfma_f32_16x16x32_bf16 v[212:215], a[224:227], v[112:115], v[204:207]
    v_exp_f32 v208, v208
    v_mfma_f32_16x16x32_bf16 v[212:215], a[228:231], v[116:119], v[212:215]
    v_exp_f32 v209, v209
    v_mfma_f32_16x16x32_bf16 v[212:215], a[232:235], v[120:123], v[212:215]
    v_exp_f32 v210, v210
    v_mfma_f32_16x16x32_bf16 v[212:215], a[236:239], v[124:127], v[212:215]
    v_exp_f32 v211, v211
    v_mfma_f32_16x16x32_bf16 a[56:59], a[184:187], v[176:179], a[56:59]
    ds_read_b64_tr_b16 a[168:169], v25 offset:16384
    v_cvt_pk_bf16_f32 v146, v208, v209
    v_mfma_f32_16x16x32_bf16 a[56:59], a[188:191], v[180:183], a[56:59]
    ds_read_b64_tr_b16 a[170:171], v25 offset:20480
    v_mfma_f32_16x16x32_bf16 a[60:63], a[184:187], v[184:187], a[60:63]
    ds_read_b128 a[224:227], v8 offset:45056
    v_cvt_pk_bf16_f32 v147, v210, v211
    v_mfma_f32_16x16x32_bf16 a[60:63], a[188:191], v[188:191], a[60:63]
    s_waitcnt lgkmcnt(3)
    buffer_load_dwordx4 v40, s[12:15], s41 offen offset:2048 lds
    v_mfma_f32_16x16x32_bf16 v[208:211], a[208:211], v[64:67], v[192:195]
    v_exp_f32 v212, v212
    v_mfma_f32_16x16x32_bf16 v[208:211], a[212:215], v[68:71], v[208:211]
    v_exp_f32 v213, v213
    v_mfma_f32_16x16x32_bf16 v[208:211], a[216:219], v[72:75], v[208:211]
    v_exp_f32 v214, v214
    v_mfma_f32_16x16x32_bf16 v[208:211], a[220:223], v[76:79], v[208:211]
    v_exp_f32 v215, v215
    v_mfma_f32_16x16x32_bf16 a[64:67], a[160:163], v[160:163], a[64:67]
    ds_read_b64_tr_b16 a[172:173], v25 offset:24576
    v_cvt_pk_bf16_f32 v154, v212, v213
    v_mfma_f32_16x16x32_bf16 a[64:67], a[164:167], v[164:167], a[64:67]
    ds_read_b64_tr_b16 a[174:175], v25 offset:28672
    v_mfma_f32_16x16x32_bf16 a[68:71], a[160:163], v[168:171], a[68:71]
    ds_read_b128 a[228:231], v9 offset:45056
    v_cvt_pk_bf16_f32 v155, v214, v215
    v_mfma_f32_16x16x32_bf16 a[68:71], a[164:167], v[172:175], a[68:71]
    v_smfmac_f32_16x16x64_bf16 a[204:207], v[52:55], v[184:191], v50
    v_mfma_f32_16x16x32_bf16 v[212:215], a[208:211], v[80:83], v[196:199]
    v_exp_f32 v208, v208
    v_mfma_f32_16x16x32_bf16 v[212:215], a[212:215], v[84:87], v[212:215]
    v_exp_f32 v209, v209
    v_mfma_f32_16x16x32_bf16 v[212:215], a[216:219], v[88:91], v[212:215]
    v_exp_f32 v210, v210
    v_mfma_f32_16x16x32_bf16 v[212:215], a[220:223], v[92:95], v[212:215]
    v_exp_f32 v211, v211
    v_mfma_f32_16x16x32_bf16 a[72:75], a[160:163], v[176:179], a[72:75]
    ds_read_b64_tr_b16 a[176:177], v26 offset:16384
    v_cvt_pk_bf16_f32 v132, v208, v209
    v_mfma_f32_16x16x32_bf16 a[72:75], a[164:167], v[180:183], a[72:75]
    ds_read_b64_tr_b16 a[178:179], v26 offset:20480
    v_mfma_f32_16x16x32_bf16 a[76:79], a[160:163], v[184:187], a[76:79]
    ds_read_b128 a[232:235], v10 offset:45056
    v_cvt_pk_bf16_f32 v133, v210, v211
    v_mfma_f32_16x16x32_bf16 a[76:79], a[164:167], v[188:191], a[76:79]
    s_waitcnt lgkmcnt(3)
    buffer_load_dwordx4 v41, s[12:15], s41 offen offset:3072 lds
    v_mfma_f32_16x16x32_bf16 v[208:211], a[208:211], v[96:99], v[200:203]
    v_exp_f32 v212, v212
    v_mfma_f32_16x16x32_bf16 v[208:211], a[212:215], v[100:103], v[208:211]
    s_add_u32 s41, s41, 16384
    v_exp_f32 v213, v213
    v_mfma_f32_16x16x32_bf16 v[208:211], a[216:219], v[104:107], v[208:211]
    v_exp_f32 v214, v214
    v_mfma_f32_16x16x32_bf16 v[208:211], a[220:223], v[108:111], v[208:211]
    v_exp_f32 v215, v215
    v_mfma_f32_16x16x32_bf16 a[80:83], a[168:171], v[160:163], a[80:83]
    ds_read_b64_tr_b16 a[180:181], v26 offset:24576
    v_cvt_pk_bf16_f32 v140, v212, v213
    v_mfma_f32_16x16x32_bf16 a[80:83], a[172:175], v[164:167], a[80:83]
    ds_read_b64_tr_b16 a[182:183], v26 offset:28672
    v_mfma_f32_16x16x32_bf16 a[84:87], a[168:171], v[168:171], a[84:87]
    ds_read_b128 a[236:239], v11 offset:45056
    v_cvt_pk_bf16_f32 v141, v214, v215
    v_mfma_f32_16x16x32_bf16 a[84:87], a[172:175], v[172:175], a[84:87]
    s_waitcnt vmcnt(8)
    s_barrier
    v_mfma_f32_16x16x32_bf16 v[212:215], a[208:211], v[112:115], v[204:207]
    v_exp_f32 v208, v208
    v_mfma_f32_16x16x32_bf16 v[212:215], a[212:215], v[116:119], v[212:215]
    s_add_u32 s49, s45, 73728
    v_exp_f32 v209, v209
    v_mfma_f32_16x16x32_bf16 v[212:215], a[216:219], v[120:123], v[212:215]
    s_add_u32 m0, s42, 147456
    v_exp_f32 v210, v210
    v_mfma_f32_16x16x32_bf16 v[212:215], a[220:223], v[124:127], v[212:215]
    v_exp_f32 v211, v211
    v_mfma_f32_16x16x32_bf16 a[88:91], a[168:171], v[176:179], a[88:91]
    ds_read_b64_tr_b16 a[184:185], v27 offset:16384
    v_cvt_pk_bf16_f32 v148, v208, v209
    v_mfma_f32_16x16x32_bf16 a[88:91], a[172:175], v[180:183], a[88:91]
    ds_read_b64_tr_b16 a[186:187], v27 offset:20480
    v_mfma_f32_16x16x32_bf16 a[92:95], a[168:171], v[184:187], a[92:95]
    ds_read_b128 a[208:211], v8 offset:49152
    v_cvt_pk_bf16_f32 v149, v210, v211
    v_mfma_f32_16x16x32_bf16 a[92:95], a[172:175], v[188:191], a[92:95]
    s_waitcnt lgkmcnt(3)
    buffer_load_dwordx4 v46, s[20:23], s49 offen lds
    v_mfma_f32_16x16x32_bf16 v[208:211], a[224:227], v[64:67], v[192:195]
    v_exp_f32 v212, v212
    v_mfma_f32_16x16x32_bf16 v[208:211], a[228:231], v[68:71], v[208:211]
    v_exp_f32 v213, v213
    v_mfma_f32_16x16x32_bf16 v[208:211], a[232:235], v[72:75], v[208:211]
    v_exp_f32 v214, v214
    v_mfma_f32_16x16x32_bf16 v[208:211], a[236:239], v[76:79], v[208:211]
    v_exp_f32 v215, v215
    v_mfma_f32_16x16x32_bf16 a[96:99], a[176:179], v[160:163], a[96:99]
    ds_read_b64_tr_b16 a[188:189], v27 offset:24576
    v_cvt_pk_bf16_f32 v156, v212, v213
    v_mfma_f32_16x16x32_bf16 a[96:99], a[180:183], v[164:167], a[96:99]
    ds_read_b64_tr_b16 a[190:191], v27 offset:28672
    v_mfma_f32_16x16x32_bf16 a[100:103], a[176:179], v[168:171], a[100:103]
    ds_read_b128 a[212:215], v9 offset:49152
    v_cvt_pk_bf16_f32 v157, v214, v215
    v_mfma_f32_16x16x32_bf16 a[100:103], a[180:183], v[172:175], a[100:103]
    v_mfma_f32_16x16x32_bf16 v[212:215], a[224:227], v[80:83], v[196:199]
    v_exp_f32 v208, v208
    v_mfma_f32_16x16x32_bf16 v[212:215], a[228:231], v[84:87], v[212:215]
    v_exp_f32 v209, v209
    v_mfma_f32_16x16x32_bf16 v[212:215], a[232:235], v[88:91], v[212:215]
    v_exp_f32 v210, v210
    v_mfma_f32_16x16x32_bf16 v[212:215], a[236:239], v[92:95], v[212:215]
    v_exp_f32 v211, v211
    v_mfma_f32_16x16x32_bf16 a[104:107], a[176:179], v[176:179], a[104:107]
    ds_read_b64_tr_b16 a[160:161], v20 offset:32768
    v_cvt_pk_bf16_f32 v134, v208, v209
    v_mfma_f32_16x16x32_bf16 a[104:107], a[180:183], v[180:183], a[104:107]
    ds_read_b64_tr_b16 a[162:163], v20 offset:36864
    v_mfma_f32_16x16x32_bf16 a[108:111], a[176:179], v[184:187], a[108:111]
    ds_read_b128 a[216:219], v10 offset:49152
    v_cvt_pk_bf16_f32 v135, v210, v211
    v_mfma_f32_16x16x32_bf16 a[108:111], a[180:183], v[188:191], a[108:111]
    s_waitcnt lgkmcnt(3)
    buffer_load_dwordx4 v47, s[20:23], s49 offen offset:1024 lds
    v_mfma_f32_16x16x32_bf16 v[208:211], a[224:227], v[96:99], v[200:203]
    v_exp_f32 v212, v212
    v_mfma_f32_16x16x32_bf16 v[208:211], a[228:231], v[100:103], v[208:211]
    v_exp_f32 v213, v213
    v_mfma_f32_16x16x32_bf16 v[208:211], a[232:235], v[104:107], v[208:211]
    v_exp_f32 v214, v214
    v_mfma_f32_16x16x32_bf16 v[208:211], a[236:239], v[108:111], v[208:211]
    v_exp_f32 v215, v215
    v_mfma_f32_16x16x32_bf16 a[112:115], a[184:187], v[160:163], a[112:115]
    ds_read_b64_tr_b16 a[164:165], v20 offset:40960
    v_cvt_pk_bf16_f32 v142, v212, v213
    v_mfma_f32_16x16x32_bf16 a[112:115], a[188:191], v[164:167], a[112:115]
    ds_read_b64_tr_b16 a[166:167], v20 offset:45056
    v_mfma_f32_16x16x32_bf16 a[116:119], a[184:187], v[168:171], a[116:119]
    ds_read_b128 a[220:223], v11 offset:49152
    v_cvt_pk_bf16_f32 v143, v214, v215
    v_mfma_f32_16x16x32_bf16 a[116:119], a[188:191], v[172:175], a[116:119]
    v_mfma_f32_16x16x32_bf16 v[212:215], a[224:227], v[112:115], v[204:207]
    v_exp_f32 v208, v208
    v_mfma_f32_16x16x32_bf16 v[212:215], a[228:231], v[116:119], v[212:215]
    v_exp_f32 v209, v209
    v_mfma_f32_16x16x32_bf16 v[212:215], a[232:235], v[120:123], v[212:215]
    v_exp_f32 v210, v210
    v_mfma_f32_16x16x32_bf16 v[212:215], a[236:239], v[124:127], v[212:215]
    v_exp_f32 v211, v211
    v_mfma_f32_16x16x32_bf16 a[120:123], a[184:187], v[176:179], a[120:123]
    ds_read_b64_tr_b16 a[168:169], v21 offset:32768
    v_cvt_pk_bf16_f32 v150, v208, v209
    v_mfma_f32_16x16x32_bf16 a[120:123], a[188:191], v[180:183], a[120:123]
    ds_read_b64_tr_b16 a[170:171], v21 offset:36864
    v_mfma_f32_16x16x32_bf16 a[124:127], a[184:187], v[184:187], a[124:127]
    ds_read_b128 a[224:227], v8 offset:53248
    v_cvt_pk_bf16_f32 v151, v210, v211
    v_mfma_f32_16x16x32_bf16 a[124:127], a[188:191], v[188:191], a[124:127]
    s_waitcnt lgkmcnt(3)
    buffer_load_dwordx4 v48, s[20:23], s49 offen offset:2048 lds
    v_mfma_f32_16x16x32_bf16 v[208:211], a[208:211], v[64:67], v[192:195]
    v_exp_f32 v212, v212
    v_mfma_f32_16x16x32_bf16 v[208:211], a[212:215], v[68:71], v[208:211]
    v_exp_f32 v213, v213
    v_mfma_f32_16x16x32_bf16 v[208:211], a[216:219], v[72:75], v[208:211]
    v_exp_f32 v214, v214
    v_mfma_f32_16x16x32_bf16 v[208:211], a[220:223], v[76:79], v[208:211]
    v_exp_f32 v215, v215
    v_mfma_f32_16x16x32_bf16 a[0:3], a[160:163], v[128:131], a[0:3]
    ds_read_b64_tr_b16 a[172:173], v21 offset:40960
    v_cvt_pk_bf16_f32 v158, v212, v213
    v_mfma_f32_16x16x32_bf16 a[0:3], a[164:167], v[132:135], a[0:3]
    ds_read_b64_tr_b16 a[174:175], v21 offset:45056
    v_mfma_f32_16x16x32_bf16 a[4:7], a[160:163], v[136:139], a[4:7]
    ds_read_b128 a[228:231], v9 offset:53248
    v_cvt_pk_bf16_f32 v159, v214, v215
    v_mfma_f32_16x16x32_bf16 a[4:7], a[164:167], v[140:143], a[4:7]
    v_mfma_f32_16x16x32_bf16 v[212:215], a[208:211], v[80:83], v[196:199]
    v_exp_f32 v208, v208
    v_mfma_f32_16x16x32_bf16 v[212:215], a[212:215], v[84:87], v[212:215]
    v_exp_f32 v209, v209
    v_mfma_f32_16x16x32_bf16 v[212:215], a[216:219], v[88:91], v[212:215]
    v_exp_f32 v210, v210
    v_mfma_f32_16x16x32_bf16 v[212:215], a[220:223], v[92:95], v[212:215]
    v_exp_f32 v211, v211
    v_mfma_f32_16x16x32_bf16 a[8:11], a[160:163], v[144:147], a[8:11]
    ds_read_b64_tr_b16 a[176:177], v22 offset:32768
    v_cvt_pk_bf16_f32 v160, v208, v209
    v_mfma_f32_16x16x32_bf16 a[8:11], a[164:167], v[148:151], a[8:11]
    ds_read_b64_tr_b16 a[178:179], v22 offset:36864
    v_mfma_f32_16x16x32_bf16 a[12:15], a[160:163], v[152:155], a[12:15]
    ds_read_b128 a[232:235], v10 offset:53248
    v_cvt_pk_bf16_f32 v161, v210, v211
    v_mfma_f32_16x16x32_bf16 a[12:15], a[164:167], v[156:159], a[12:15]
    s_waitcnt lgkmcnt(3)
    buffer_load_dwordx4 v49, s[20:23], s49 offen offset:3072 lds
    v_mfma_f32_16x16x32_bf16 v[208:211], a[208:211], v[96:99], v[200:203]
    v_exp_f32 v212, v212
    v_mfma_f32_16x16x32_bf16 v[208:211], a[212:215], v[100:103], v[208:211]
    v_exp_f32 v213, v213
    v_mfma_f32_16x16x32_bf16 v[208:211], a[216:219], v[104:107], v[208:211]
    v_exp_f32 v214, v214
    v_mfma_f32_16x16x32_bf16 v[208:211], a[220:223], v[108:111], v[208:211]
    v_exp_f32 v215, v215
    v_mfma_f32_16x16x32_bf16 a[16:19], a[168:171], v[128:131], a[16:19]
    ds_read_b64_tr_b16 a[180:181], v22 offset:40960
    v_cvt_pk_bf16_f32 v168, v212, v213
    v_mfma_f32_16x16x32_bf16 a[16:19], a[172:175], v[132:135], a[16:19]
    ds_read_b64_tr_b16 a[182:183], v22 offset:45056
    v_mfma_f32_16x16x32_bf16 a[20:23], a[168:171], v[136:139], a[20:23]
    ds_read_b128 a[236:239], v11 offset:53248
    v_cvt_pk_bf16_f32 v169, v214, v215
    v_mfma_f32_16x16x32_bf16 a[20:23], a[172:175], v[140:143], a[20:23]
    v_smfmac_f32_16x16x64_bf16 a[192:195], v[52:55], v[128:135], v50
    v_mfma_f32_16x16x32_bf16 v[212:215], a[208:211], v[112:115], v[204:207]
    v_exp_f32 v208, v208
    v_mfma_f32_16x16x32_bf16 v[212:215], a[212:215], v[116:119], v[212:215]
    s_add_u32 s49, s45, 128
    v_exp_f32 v209, v209
    v_mfma_f32_16x16x32_bf16 v[212:215], a[216:219], v[120:123], v[212:215]
    s_add_u32 m0, s42, 0
    v_exp_f32 v210, v210
    v_mfma_f32_16x16x32_bf16 v[212:215], a[220:223], v[124:127], v[212:215]
    v_exp_f32 v211, v211
    v_mfma_f32_16x16x32_bf16 a[24:27], a[168:171], v[144:147], a[24:27]
    ds_read_b64_tr_b16 a[184:185], v23 offset:32768
    v_cvt_pk_bf16_f32 v176, v208, v209
    v_mfma_f32_16x16x32_bf16 a[24:27], a[172:175], v[148:151], a[24:27]
    ds_read_b64_tr_b16 a[186:187], v23 offset:36864
    v_mfma_f32_16x16x32_bf16 a[28:31], a[168:171], v[152:155], a[28:31]
    ds_read_b128 a[208:211], v8 offset:57344
    v_cvt_pk_bf16_f32 v177, v210, v211
    v_mfma_f32_16x16x32_bf16 a[28:31], a[172:175], v[156:159], a[28:31]
    s_waitcnt lgkmcnt(3)
    buffer_load_dwordx4 v46, s[20:23], s49 offen lds
    v_mfma_f32_16x16x32_bf16 v[208:211], a[224:227], v[64:67], v[192:195]
    v_exp_f32 v212, v212
    v_mfma_f32_16x16x32_bf16 v[208:211], a[228:231], v[68:71], v[208:211]
    v_exp_f32 v213, v213
    v_mfma_f32_16x16x32_bf16 v[208:211], a[232:235], v[72:75], v[208:211]
    v_exp_f32 v214, v214
    v_mfma_f32_16x16x32_bf16 v[208:211], a[236:239], v[76:79], v[208:211]
    v_exp_f32 v215, v215
    v_mfma_f32_16x16x32_bf16 a[32:35], a[176:179], v[128:131], a[32:35]
    ds_read_b64_tr_b16 a[188:189], v23 offset:40960
    v_cvt_pk_bf16_f32 v184, v212, v213
    v_mfma_f32_16x16x32_bf16 a[32:35], a[180:183], v[132:135], a[32:35]
    ds_read_b64_tr_b16 a[190:191], v23 offset:45056
    v_mfma_f32_16x16x32_bf16 a[36:39], a[176:179], v[136:139], a[36:39]
    ds_read_b128 a[212:215], v9 offset:57344
    v_cvt_pk_bf16_f32 v185, v214, v215
    v_mfma_f32_16x16x32_bf16 a[36:39], a[180:183], v[140:143], a[36:39]
    v_smfmac_f32_16x16x64_bf16 a[196:199], v[52:55], v[136:143], v50
    v_mfma_f32_16x16x32_bf16 v[212:215], a[224:227], v[80:83], v[196:199]
    v_exp_f32 v208, v208
    v_mfma_f32_16x16x32_bf16 v[212:215], a[228:231], v[84:87], v[212:215]
    v_exp_f32 v209, v209
    v_mfma_f32_16x16x32_bf16 v[212:215], a[232:235], v[88:91], v[212:215]
    v_exp_f32 v210, v210
    v_mfma_f32_16x16x32_bf16 v[212:215], a[236:239], v[92:95], v[212:215]
    v_exp_f32 v211, v211
    v_mfma_f32_16x16x32_bf16 a[40:43], a[176:179], v[144:147], a[40:43]
    ds_read_b64_tr_b16 a[160:161], v24 offset:32768
    v_cvt_pk_bf16_f32 v162, v208, v209
    v_mfma_f32_16x16x32_bf16 a[40:43], a[180:183], v[148:151], a[40:43]
    ds_read_b64_tr_b16 a[162:163], v24 offset:36864
    v_mfma_f32_16x16x32_bf16 a[44:47], a[176:179], v[152:155], a[44:47]
    ds_read_b128 a[216:219], v10 offset:57344
    v_cvt_pk_bf16_f32 v163, v210, v211
    v_mfma_f32_16x16x32_bf16 a[44:47], a[180:183], v[156:159], a[44:47]
    s_waitcnt lgkmcnt(3)
    buffer_load_dwordx4 v47, s[20:23], s49 offen offset:1024 lds
    v_mfma_f32_16x16x32_bf16 v[208:211], a[224:227], v[96:99], v[200:203]
    v_exp_f32 v212, v212
    v_mfma_f32_16x16x32_bf16 v[208:211], a[228:231], v[100:103], v[208:211]
    v_exp_f32 v213, v213
    v_mfma_f32_16x16x32_bf16 v[208:211], a[232:235], v[104:107], v[208:211]
    v_exp_f32 v214, v214
    v_mfma_f32_16x16x32_bf16 v[208:211], a[236:239], v[108:111], v[208:211]
    v_exp_f32 v215, v215
    v_mfma_f32_16x16x32_bf16 a[48:51], a[184:187], v[128:131], a[48:51]
    ds_read_b64_tr_b16 a[164:165], v24 offset:40960
    v_cvt_pk_bf16_f32 v170, v212, v213
    v_mfma_f32_16x16x32_bf16 a[48:51], a[188:191], v[132:135], a[48:51]
    ds_read_b64_tr_b16 a[166:167], v24 offset:45056
    v_mfma_f32_16x16x32_bf16 a[52:55], a[184:187], v[136:139], a[52:55]
    ds_read_b128 a[220:223], v11 offset:57344
    v_cvt_pk_bf16_f32 v171, v214, v215
    v_mfma_f32_16x16x32_bf16 a[52:55], a[188:191], v[140:143], a[52:55]
    v_smfmac_f32_16x16x64_bf16 a[200:203], v[52:55], v[144:151], v50
    v_mfma_f32_16x16x32_bf16 v[212:215], a[224:227], v[112:115], v[204:207]
    v_exp_f32 v208, v208
    v_mfma_f32_16x16x32_bf16 v[212:215], a[228:231], v[116:119], v[212:215]
    v_exp_f32 v209, v209
    v_mfma_f32_16x16x32_bf16 v[212:215], a[232:235], v[120:123], v[212:215]
    v_exp_f32 v210, v210
    v_mfma_f32_16x16x32_bf16 v[212:215], a[236:239], v[124:127], v[212:215]
    v_exp_f32 v211, v211
    v_mfma_f32_16x16x32_bf16 a[56:59], a[184:187], v[144:147], a[56:59]
    ds_read_b64_tr_b16 a[168:169], v25 offset:32768
    v_cvt_pk_bf16_f32 v178, v208, v209
    v_mfma_f32_16x16x32_bf16 a[56:59], a[188:191], v[148:151], a[56:59]
    ds_read_b64_tr_b16 a[170:171], v25 offset:36864
    v_mfma_f32_16x16x32_bf16 a[60:63], a[184:187], v[152:155], a[60:63]
    ds_read_b128 a[224:227], v8 offset:61440
    v_cvt_pk_bf16_f32 v179, v210, v211
    v_mfma_f32_16x16x32_bf16 a[60:63], a[188:191], v[156:159], a[60:63]
    s_waitcnt lgkmcnt(3)
    buffer_load_dwordx4 v48, s[20:23], s49 offen offset:2048 lds
    v_mfma_f32_16x16x32_bf16 v[208:211], a[208:211], v[64:67], v[192:195]
    v_exp_f32 v212, v212
    v_mfma_f32_16x16x32_bf16 v[208:211], a[212:215], v[68:71], v[208:211]
    v_exp_f32 v213, v213
    v_mfma_f32_16x16x32_bf16 v[208:211], a[216:219], v[72:75], v[208:211]
    v_exp_f32 v214, v214
    v_mfma_f32_16x16x32_bf16 v[208:211], a[220:223], v[76:79], v[208:211]
    v_exp_f32 v215, v215
    v_mfma_f32_16x16x32_bf16 a[64:67], a[160:163], v[128:131], a[64:67]
    ds_read_b64_tr_b16 a[172:173], v25 offset:40960
    v_cvt_pk_bf16_f32 v186, v212, v213
    v_mfma_f32_16x16x32_bf16 a[64:67], a[164:167], v[132:135], a[64:67]
    ds_read_b64_tr_b16 a[174:175], v25 offset:45056
    v_mfma_f32_16x16x32_bf16 a[68:71], a[160:163], v[136:139], a[68:71]
    ds_read_b128 a[228:231], v9 offset:61440
    v_cvt_pk_bf16_f32 v187, v214, v215
    v_mfma_f32_16x16x32_bf16 a[68:71], a[164:167], v[140:143], a[68:71]
    v_smfmac_f32_16x16x64_bf16 a[204:207], v[52:55], v[152:159], v50
    v_mfma_f32_16x16x32_bf16 v[212:215], a[208:211], v[80:83], v[196:199]
    v_exp_f32 v208, v208
    v_mfma_f32_16x16x32_bf16 v[212:215], a[212:215], v[84:87], v[212:215]
    v_exp_f32 v209, v209
    v_mfma_f32_16x16x32_bf16 v[212:215], a[216:219], v[88:91], v[212:215]
    v_exp_f32 v210, v210
    v_mfma_f32_16x16x32_bf16 v[212:215], a[220:223], v[92:95], v[212:215]
    v_exp_f32 v211, v211
    v_mfma_f32_16x16x32_bf16 a[72:75], a[160:163], v[144:147], a[72:75]
    ds_read_b64_tr_b16 a[176:177], v26 offset:32768
    v_cvt_pk_bf16_f32 v164, v208, v209
    v_mfma_f32_16x16x32_bf16 a[72:75], a[164:167], v[148:151], a[72:75]
    ds_read_b64_tr_b16 a[178:179], v26 offset:36864
    v_mfma_f32_16x16x32_bf16 a[76:79], a[160:163], v[152:155], a[76:79]
    ds_read_b128 a[232:235], v10 offset:61440
    v_cvt_pk_bf16_f32 v165, v210, v211
    v_mfma_f32_16x16x32_bf16 a[76:79], a[164:167], v[156:159], a[76:79]
    s_waitcnt lgkmcnt(3)
    buffer_load_dwordx4 v49, s[20:23], s49 offen offset:3072 lds
    v_mfma_f32_16x16x32_bf16 v[208:211], a[208:211], v[96:99], v[200:203]
    v_exp_f32 v212, v212
    v_mfma_f32_16x16x32_bf16 v[208:211], a[212:215], v[100:103], v[208:211]
    v_exp_f32 v213, v213
    v_mfma_f32_16x16x32_bf16 v[208:211], a[216:219], v[104:107], v[208:211]
    v_exp_f32 v214, v214
    v_mfma_f32_16x16x32_bf16 v[208:211], a[220:223], v[108:111], v[208:211]
    v_exp_f32 v215, v215
    v_mfma_f32_16x16x32_bf16 a[80:83], a[168:171], v[128:131], a[80:83]
    ds_read_b64_tr_b16 a[180:181], v26 offset:40960
    v_cvt_pk_bf16_f32 v172, v212, v213
    v_mfma_f32_16x16x32_bf16 a[80:83], a[172:175], v[132:135], a[80:83]
    ds_read_b64_tr_b16 a[182:183], v26 offset:45056
    v_mfma_f32_16x16x32_bf16 a[84:87], a[168:171], v[136:139], a[84:87]
    ds_read_b128 a[236:239], v11 offset:61440
    v_cvt_pk_bf16_f32 v173, v214, v215
    v_mfma_f32_16x16x32_bf16 a[84:87], a[172:175], v[140:143], a[84:87]
    s_waitcnt vmcnt(8)
    s_barrier
    v_mfma_f32_16x16x32_bf16 v[212:215], a[208:211], v[112:115], v[204:207]
    v_exp_f32 v208, v208
    v_mfma_f32_16x16x32_bf16 v[212:215], a[212:215], v[116:119], v[212:215]
    s_add_u32 s49, s45, 73856
    v_exp_f32 v209, v209
    v_mfma_f32_16x16x32_bf16 v[212:215], a[216:219], v[120:123], v[212:215]
    s_add_u32 m0, s42, 16384
    v_exp_f32 v210, v210
    v_mfma_f32_16x16x32_bf16 v[212:215], a[220:223], v[124:127], v[212:215]
    v_exp_f32 v211, v211
    v_mfma_f32_16x16x32_bf16 a[88:91], a[168:171], v[144:147], a[88:91]
    ds_read_b64_tr_b16 a[184:185], v27 offset:32768
    v_cvt_pk_bf16_f32 v180, v208, v209
    v_mfma_f32_16x16x32_bf16 a[88:91], a[172:175], v[148:151], a[88:91]
    ds_read_b64_tr_b16 a[186:187], v27 offset:36864
    v_mfma_f32_16x16x32_bf16 a[92:95], a[168:171], v[152:155], a[92:95]
    v_cvt_pk_bf16_f32 v181, v210, v211
    v_mfma_f32_16x16x32_bf16 a[92:95], a[172:175], v[156:159], a[92:95]
    s_waitcnt lgkmcnt(3)
    buffer_load_dwordx4 v46, s[20:23], s49 offen lds
    v_mfma_f32_16x16x32_bf16 v[208:211], a[224:227], v[64:67], v[192:195]
    v_exp_f32 v212, v212
    v_mfma_f32_16x16x32_bf16 v[208:211], a[228:231], v[68:71], v[208:211]
    v_exp_f32 v213, v213
    v_mfma_f32_16x16x32_bf16 v[208:211], a[232:235], v[72:75], v[208:211]
    s_waitcnt lgkmcnt(2)
    v_exp_f32 v214, v214
    v_mfma_f32_16x16x32_bf16 v[208:211], a[236:239], v[76:79], v[208:211]
    v_exp_f32 v215, v215
    v_mfma_f32_16x16x32_bf16 a[96:99], a[176:179], v[128:131], a[96:99]
    ds_read_b64_tr_b16 a[188:189], v27 offset:40960
    v_cvt_pk_bf16_f32 v188, v212, v213
    v_mfma_f32_16x16x32_bf16 a[96:99], a[180:183], v[132:135], a[96:99]
    ds_read_b64_tr_b16 a[190:191], v27 offset:45056
    v_mfma_f32_16x16x32_bf16 a[100:103], a[176:179], v[136:139], a[100:103]
    v_cvt_pk_bf16_f32 v189, v214, v215
    v_mfma_f32_16x16x32_bf16 a[100:103], a[180:183], v[140:143], a[100:103]
    v_mfma_f32_16x16x32_bf16 v[212:215], a[224:227], v[80:83], v[196:199]
    v_exp_f32 v208, v208
    v_mfma_f32_16x16x32_bf16 v[212:215], a[228:231], v[84:87], v[212:215]
    v_exp_f32 v209, v209
    v_mfma_f32_16x16x32_bf16 v[212:215], a[232:235], v[88:91], v[212:215]
    v_exp_f32 v210, v210
    v_mfma_f32_16x16x32_bf16 v[212:215], a[236:239], v[92:95], v[212:215]
    v_exp_f32 v211, v211
    v_mfma_f32_16x16x32_bf16 a[104:107], a[176:179], v[144:147], a[104:107]
    ds_read_b64_tr_b16 a[160:161], v20 offset:49152
    v_cvt_pk_bf16_f32 v166, v208, v209
    v_mfma_f32_16x16x32_bf16 a[104:107], a[180:183], v[148:151], a[104:107]
    ds_read_b64_tr_b16 a[162:163], v20 offset:53248
    v_mfma_f32_16x16x32_bf16 a[108:111], a[176:179], v[152:155], a[108:111]
    v_cvt_pk_bf16_f32 v167, v210, v211
    v_mfma_f32_16x16x32_bf16 a[108:111], a[180:183], v[156:159], a[108:111]
    s_waitcnt lgkmcnt(3)
    buffer_load_dwordx4 v47, s[20:23], s49 offen offset:1024 lds
    v_mfma_f32_16x16x32_bf16 v[208:211], a[224:227], v[96:99], v[200:203]
    v_exp_f32 v212, v212
    v_mfma_f32_16x16x32_bf16 v[208:211], a[228:231], v[100:103], v[208:211]
    v_exp_f32 v213, v213
    v_mfma_f32_16x16x32_bf16 v[208:211], a[232:235], v[104:107], v[208:211]
    v_exp_f32 v214, v214
    v_mfma_f32_16x16x32_bf16 v[208:211], a[236:239], v[108:111], v[208:211]
    v_exp_f32 v215, v215
    v_mfma_f32_16x16x32_bf16 a[112:115], a[184:187], v[128:131], a[112:115]
    s_waitcnt lgkmcnt(2)
    ds_read_b64_tr_b16 a[164:165], v20 offset:57344
    v_cvt_pk_bf16_f32 v174, v212, v213
    v_mfma_f32_16x16x32_bf16 a[112:115], a[188:191], v[132:135], a[112:115]
    ds_read_b64_tr_b16 a[166:167], v20 offset:61440
    v_mfma_f32_16x16x32_bf16 a[116:119], a[184:187], v[136:139], a[116:119]
    v_cvt_pk_bf16_f32 v175, v214, v215
    v_mfma_f32_16x16x32_bf16 a[116:119], a[188:191], v[140:143], a[116:119]
    v_mfma_f32_16x16x32_bf16 v[212:215], a[224:227], v[112:115], v[204:207]
    v_exp_f32 v208, v208
    v_mfma_f32_16x16x32_bf16 v[212:215], a[228:231], v[116:119], v[212:215]
    v_exp_f32 v209, v209
    v_mfma_f32_16x16x32_bf16 v[212:215], a[232:235], v[120:123], v[212:215]
    v_exp_f32 v210, v210
    v_mfma_f32_16x16x32_bf16 v[212:215], a[236:239], v[124:127], v[212:215]
    v_exp_f32 v211, v211
    v_mfma_f32_16x16x32_bf16 a[120:123], a[184:187], v[144:147], a[120:123]
    ds_read_b64_tr_b16 a[168:169], v21 offset:49152
    v_cvt_pk_bf16_f32 v182, v208, v209
    v_mfma_f32_16x16x32_bf16 a[120:123], a[188:191], v[148:151], a[120:123]
    ds_read_b64_tr_b16 a[170:171], v21 offset:53248
    v_mfma_f32_16x16x32_bf16 a[124:127], a[184:187], v[152:155], a[124:127]
    v_cvt_pk_bf16_f32 v183, v210, v211
    v_mfma_f32_16x16x32_bf16 a[124:127], a[188:191], v[156:159], a[124:127]
    s_waitcnt lgkmcnt(3)
    buffer_load_dwordx4 v48, s[20:23], s49 offen offset:2048 lds
    v_exp_f32 v212, v212
    v_exp_f32 v213, v213
    v_exp_f32 v214, v214
    v_exp_f32 v215, v215
    v_mfma_f32_16x16x32_bf16 a[0:3], a[160:163], v[160:163], a[0:3]
    s_waitcnt lgkmcnt(2)
    ds_read_b64_tr_b16 a[172:173], v21 offset:57344
    v_cvt_pk_bf16_f32 v190, v212, v213
    v_mfma_f32_16x16x32_bf16 a[0:3], a[164:167], v[164:167], a[0:3]
    ds_read_b64_tr_b16 a[174:175], v21 offset:61440
    v_mfma_f32_16x16x32_bf16 a[4:7], a[160:163], v[168:171], a[4:7]
    v_cvt_pk_bf16_f32 v191, v214, v215
    v_mfma_f32_16x16x32_bf16 a[4:7], a[164:167], v[172:175], a[4:7]
    v_mfma_f32_16x16x32_bf16 a[8:11], a[160:163], v[176:179], a[8:11]
    ds_read_b64_tr_b16 a[176:177], v22 offset:49152
    v_mfma_f32_16x16x32_bf16 a[8:11], a[164:167], v[180:183], a[8:11]
    ds_read_b64_tr_b16 a[178:179], v22 offset:53248
    v_mfma_f32_16x16x32_bf16 a[12:15], a[160:163], v[184:187], a[12:15]
    v_mfma_f32_16x16x32_bf16 a[12:15], a[164:167], v[188:191], a[12:15]
    buffer_load_dwordx4 v49, s[20:23], s49 offen offset:3072 lds
    v_smfmac_f32_16x16x64_bf16 a[192:195], v[52:55], v[160:167], v50
    s_waitcnt lgkmcnt(4)
    v_mfma_f32_16x16x32_bf16 a[16:19], a[168:171], v[160:163], a[16:19]
    s_waitcnt lgkmcnt(2)
    ds_read_b64_tr_b16 a[180:181], v22 offset:57344
    v_mfma_f32_16x16x32_bf16 a[16:19], a[172:175], v[164:167], a[16:19]
    ds_read_b64_tr_b16 a[182:183], v22 offset:61440
    v_mfma_f32_16x16x32_bf16 a[20:23], a[168:171], v[168:171], a[20:23]
    v_mfma_f32_16x16x32_bf16 a[20:23], a[172:175], v[172:175], a[20:23]
    v_smfmac_f32_16x16x64_bf16 a[196:199], v[52:55], v[168:175], v50
    s_add_u32 s49, s45, 256
    s_add_u32 m0, s42, 32768
    v_mfma_f32_16x16x32_bf16 a[24:27], a[168:171], v[176:179], a[24:27]
    ds_read_b64_tr_b16 a[184:185], v23 offset:49152
    v_mfma_f32_16x16x32_bf16 a[24:27], a[172:175], v[180:183], a[24:27]
    ds_read_b64_tr_b16 a[186:187], v23 offset:53248
    v_mfma_f32_16x16x32_bf16 a[28:31], a[168:171], v[184:187], a[28:31]
    v_mfma_f32_16x16x32_bf16 a[28:31], a[172:175], v[188:191], a[28:31]
    buffer_load_dwordx4 v46, s[20:23], s49 offen lds
    v_smfmac_f32_16x16x64_bf16 a[200:203], v[52:55], v[176:183], v50
    s_waitcnt lgkmcnt(4)
    v_mfma_f32_16x16x32_bf16 a[32:35], a[176:179], v[160:163], a[32:35]
    s_waitcnt lgkmcnt(2)
    ds_read_b64_tr_b16 a[188:189], v23 offset:57344
    v_mfma_f32_16x16x32_bf16 a[32:35], a[180:183], v[164:167], a[32:35]
    ds_read_b64_tr_b16 a[190:191], v23 offset:61440
    v_mfma_f32_16x16x32_bf16 a[36:39], a[176:179], v[168:171], a[36:39]
    v_mfma_f32_16x16x32_bf16 a[36:39], a[180:183], v[172:175], a[36:39]
    v_smfmac_f32_16x16x64_bf16 a[204:207], v[52:55], v[184:191], v50
    v_mfma_f32_16x16x32_bf16 a[40:43], a[176:179], v[176:179], a[40:43]
    ds_read_b64_tr_b16 a[160:161], v24 offset:49152
    v_mfma_f32_16x16x32_bf16 a[40:43], a[180:183], v[180:183], a[40:43]
    ds_read_b64_tr_b16 a[162:163], v24 offset:53248
    v_mfma_f32_16x16x32_bf16 a[44:47], a[176:179], v[184:187], a[44:47]
    v_mfma_f32_16x16x32_bf16 a[44:47], a[180:183], v[188:191], a[44:47]
    s_waitcnt lgkmcnt(4)
    buffer_load_dwordx4 v47, s[20:23], s49 offen offset:1024 lds
    v_mfma_f32_16x16x32_bf16 a[48:51], a[184:187], v[160:163], a[48:51]
    s_waitcnt lgkmcnt(2)
    ds_read_b64_tr_b16 a[164:165], v24 offset:57344
    v_accvgpr_read_b32 v216, a192
    v_mfma_f32_16x16x32_bf16 a[48:51], a[188:191], v[164:167], a[48:51]
    ds_read_b64_tr_b16 a[166:167], v24 offset:61440
    v_accvgpr_read_b32 v217, a193
    v_mfma_f32_16x16x32_bf16 a[52:55], a[184:187], v[168:171], a[52:55]
    v_accvgpr_read_b32 v218, a196
    v_accvgpr_read_b32 v219, a197
    v_mfma_f32_16x16x32_bf16 a[52:55], a[188:191], v[172:175], a[52:55]
    v_accvgpr_read_b32 v220, a200
    v_accvgpr_read_b32 v221, a201
    v_mfma_f32_16x16x32_bf16 a[56:59], a[184:187], v[176:179], a[56:59]
    ds_read_b64_tr_b16 a[168:169], v25 offset:49152
    v_accvgpr_read_b32 v222, a204
    v_mfma_f32_16x16x32_bf16 a[56:59], a[188:191], v[180:183], a[56:59]
    ds_read_b64_tr_b16 a[170:171], v25 offset:53248
    v_accvgpr_read_b32 v223, a205
    v_mfma_f32_16x16x32_bf16 a[60:63], a[184:187], v[184:187], a[60:63]
    v_add_f32 v58, v216, v217
    v_add_f32 v59, v218, v219
    v_mfma_f32_16x16x32_bf16 a[60:63], a[188:191], v[188:191], a[60:63]
    s_waitcnt lgkmcnt(4)
    buffer_load_dwordx4 v48, s[20:23], s49 offen offset:2048 lds
    v_add_f32 v60, v220, v221
    v_add_f32 v61, v222, v223
    v_mfma_f32_16x16x32_bf16 a[64:67], a[160:163], v[160:163], a[64:67]
    s_waitcnt lgkmcnt(2)
    ds_read_b64_tr_b16 a[172:173], v25 offset:57344
    v_add_f32 v216, v58, v59
    v_mfma_f32_16x16x32_bf16 a[64:67], a[164:167], v[164:167], a[64:67]
    ds_read_b64_tr_b16 a[174:175], v25 offset:61440
    v_add_f32 v217, v60, v61
    v_mfma_f32_16x16x32_bf16 a[68:71], a[160:163], v[168:171], a[68:71]
    v_add_f32 v216, v216, v217
    v_cmp_ngt_f32 vcc, 1602224128, v216
    v_mfma_f32_16x16x32_bf16 a[68:71], a[164:167], v[172:175], a[68:71]
    v_rcp_f32 v58, v58
    v_rcp_f32 v59, v59
    v_mfma_f32_16x16x32_bf16 a[72:75], a[160:163], v[176:179], a[72:75]
    ds_read_b64_tr_b16 a[176:177], v26 offset:49152
    v_rcp_f32 v60, v60
    v_mfma_f32_16x16x32_bf16 a[72:75], a[164:167], v[180:183], a[72:75]
    ds_read_b64_tr_b16 a[178:179], v26 offset:53248
    v_rcp_f32 v61, v61
    v_mfma_f32_16x16x32_bf16 a[76:79], a[160:163], v[184:187], a[76:79]
    v_mov_b32 v228, 81920
    s_or_b32 s36, vcc_lo, vcc_hi
    v_mfma_f32_16x16x32_bf16 a[76:79], a[164:167], v[188:191], a[76:79]
    s_waitcnt lgkmcnt(4)
    buffer_load_dwordx4 v49, s[20:23], s49 offen offset:3072 lds
    v_mov_b32 v218, s36
    s_lshl_b32 s37, s3, 2
    v_mfma_f32_16x16x32_bf16 a[80:83], a[168:171], v[160:163], a[80:83]
    s_waitcnt lgkmcnt(2)
    ds_read_b64_tr_b16 a[180:181], v26 offset:57344
    v_add_u32 v219, s37, v228
    ds_write_b32 v219, v218
    v_mfma_f32_16x16x32_bf16 a[80:83], a[172:175], v[164:167], a[80:83]
    ds_read_b64_tr_b16 a[182:183], v26 offset:61440
    v_mfma_f32_16x16x32_bf16 a[84:87], a[168:171], v[168:171], a[84:87]
    v_mfma_f32_16x16x32_bf16 a[84:87], a[172:175], v[172:175], a[84:87]
    s_waitcnt lgkmcnt(1)
    s_waitcnt vmcnt(12)
    s_barrier
    v_mfma_f32_16x16x32_bf16 a[88:91], a[168:171], v[176:179], a[88:91]
    ds_read_b64_tr_b16 a[184:185], v27 offset:49152
    v_mfma_f32_16x16x32_bf16 a[88:91], a[172:175], v[180:183], a[88:91]
    ds_read_b64_tr_b16 a[186:187], v27 offset:53248
    v_mfma_f32_16x16x32_bf16 a[92:95], a[168:171], v[184:187], a[92:95]
    ds_read_b128 v[224:227], v228
    v_mfma_f32_16x16x32_bf16 a[92:95], a[172:175], v[188:191], a[92:95]
    s_add_u32 s49, s45, 73984
    v_mfma_f32_16x16x32_bf16 a[96:99], a[176:179], v[160:163], a[96:99]
    s_waitcnt lgkmcnt(3)
    s_add_u32 m0, s42, 49152
    ds_read_b64_tr_b16 a[188:189], v27 offset:57344
    v_mfma_f32_16x16x32_bf16 a[96:99], a[180:183], v[164:167], a[96:99]
    ds_read_b64_tr_b16 a[190:191], v27 offset:61440
    buffer_load_dwordx4 v46, s[20:23], s49 offen lds
    v_mfma_f32_16x16x32_bf16 a[100:103], a[176:179], v[168:171], a[100:103]
    v_mfma_f32_16x16x32_bf16 a[100:103], a[180:183], v[172:175], a[100:103]
    buffer_load_dwordx4 v47, s[20:23], s49 offen offset:1024 lds
    v_mfma_f32_16x16x32_bf16 a[104:107], a[176:179], v[176:179], a[104:107]
    v_mfma_f32_16x16x32_bf16 a[104:107], a[180:183], v[180:183], a[104:107]
    buffer_load_dwordx4 v48, s[20:23], s49 offen offset:2048 lds
    v_mfma_f32_16x16x32_bf16 a[108:111], a[176:179], v[184:187], a[108:111]
    v_mfma_f32_16x16x32_bf16 a[108:111], a[180:183], v[188:191], a[108:111]
    s_waitcnt lgkmcnt(3)
    buffer_load_dwordx4 v49, s[20:23], s49 offen offset:3072 lds
    s_add_u32 s49, s45, 384
    v_mfma_f32_16x16x32_bf16 a[112:115], a[184:187], v[160:163], a[112:115]
    s_waitcnt lgkmcnt(0)
    s_add_u32 m0, s42, 65536
    v_mfma_f32_16x16x32_bf16 a[112:115], a[188:191], v[164:167], a[112:115]
    buffer_load_dwordx4 v46, s[20:23], s49 offen lds
    v_mfma_f32_16x16x32_bf16 a[116:119], a[184:187], v[168:171], a[116:119]
    v_mfma_f32_16x16x32_bf16 a[116:119], a[188:191], v[172:175], a[116:119]
    buffer_load_dwordx4 v47, s[20:23], s49 offen offset:1024 lds
    v_mfma_f32_16x16x32_bf16 a[120:123], a[184:187], v[176:179], a[120:123]
    v_mfma_f32_16x16x32_bf16 a[120:123], a[188:191], v[180:183], a[120:123]
    buffer_load_dwordx4 v48, s[20:23], s49 offen offset:2048 lds
    v_mfma_f32_16x16x32_bf16 a[124:127], a[184:187], v[184:187], a[124:127]
    v_mfma_f32_16x16x32_bf16 a[124:127], a[188:191], v[188:191], a[124:127]
    buffer_load_dwordx4 v49, s[20:23], s49 offen offset:3072 lds
    v_or3_b32 v224, v224, v225, v226
    v_or_b32 v224, v224, v227
    s_nop 0
    v_readfirstlane_b32 s36, v224
    ds_read_b64_tr_b16 a[128:129], v28 offset:0
    ds_read_b64_tr_b16 a[130:131], v28 offset:4096
    ds_read_b64_tr_b16 a[132:133], v28 offset:8192
    ds_read_b64_tr_b16 a[134:135], v28 offset:12288
    ds_read_b64_tr_b16 a[136:137], v28 offset:16384
    ds_read_b64_tr_b16 a[138:139], v28 offset:20480
    ds_read_b64_tr_b16 a[140:141], v28 offset:24576
    ds_read_b64_tr_b16 a[142:143], v28 offset:28672
    ds_read_b64_tr_b16 a[144:145], v32 offset:0
    ds_read_b64_tr_b16 a[146:147], v32 offset:4096
    ds_read_b64_tr_b16 a[148:149], v32 offset:8192
    ds_read_b64_tr_b16 a[150:151], v32 offset:12288
    ds_read_b64_tr_b16 a[152:153], v32 offset:16384
    ds_read_b64_tr_b16 a[154:155], v32 offset:20480
    ds_read_b64_tr_b16 a[156:157], v32 offset:24576
    ds_read_b64_tr_b16 a[158:159], v32 offset:28672
    s_andn2_b32 s36, s36, s48
    s_cbranch_scc1 Lattn_redo
    v_accvgpr_read_b32 v216, a0
    v_accvgpr_read_b32 v217, a1
    v_accvgpr_read_b32 v218, a2
    v_accvgpr_read_b32 v219, a3
    v_pk_mul_f32 v[216:217], v[216:217], v[58:59] op_sel:[0,0] op_sel_hi:[1,0]
    v_pk_mul_f32 v[218:219], v[218:219], v[58:59] op_sel:[0,0] op_sel_hi:[1,0]
    v_cvt_pk_bf16_f32 v128, v216, v217
    v_cvt_pk_bf16_f32 v129, v218, v219
    v_accvgpr_read_b32 v220, a4
    v_accvgpr_read_b32 v221, a5
    v_accvgpr_read_b32 v222, a6
    v_accvgpr_read_b32 v223, a7
    v_pk_mul_f32 v[220:221], v[220:221], v[58:59] op_sel:[0,1] op_sel_hi:[1,1]
    v_pk_mul_f32 v[222:223], v[222:223], v[58:59] op_sel:[0,1] op_sel_hi:[1,1]
    v_cvt_pk_bf16_f32 v160, v220, v221
    v_cvt_pk_bf16_f32 v161, v222, v223
    v_accvgpr_read_b32 v224, a8
    v_accvgpr_read_b32 v225, a9
    v_accvgpr_read_b32 v226, a10
    v_accvgpr_read_b32 v227, a11
    v_pk_mul_f32 v[224:225], v[224:225], v[60:61] op_sel:[0,0] op_sel_hi:[1,0]
    v_pk_mul_f32 v[226:227], v[226:227], v[60:61] op_sel:[0,0] op_sel_hi:[1,0]
    v_cvt_pk_bf16_f32 v144, v224, v225
    v_cvt_pk_bf16_f32 v145, v226, v227
    v_accvgpr_read_b32 v228, a12
    v_accvgpr_read_b32 v229, a13
    v_accvgpr_read_b32 v230, a14
    v_accvgpr_read_b32 v231, a15
    v_pk_mul_f32 v[228:229], v[228:229], v[60:61] op_sel:[0,1] op_sel_hi:[1,1]
    v_pk_mul_f32 v[230:231], v[230:231], v[60:61] op_sel:[0,1] op_sel_hi:[1,1]
    v_cvt_pk_bf16_f32 v176, v228, v229
    v_cvt_pk_bf16_f32 v177, v230, v231
    v_accvgpr_read_b32 v216, a16
    v_accvgpr_read_b32 v217, a17
    v_accvgpr_read_b32 v218, a18
    v_accvgpr_read_b32 v219, a19
    v_pk_mul_f32 v[216:217], v[216:217], v[58:59] op_sel:[0,0] op_sel_hi:[1,0]
    v_pk_mul_f32 v[218:219], v[218:219], v[58:59] op_sel:[0,0] op_sel_hi:[1,0]
    v_cvt_pk_bf16_f32 v130, v216, v217
    v_cvt_pk_bf16_f32 v131, v218, v219
    v_accvgpr_read_b32 v220, a20
    v_accvgpr_read_b32 v221, a21
    v_accvgpr_read_b32 v222, a22
    v_accvgpr_read_b32 v223, a23
    v_pk_mul_f32 v[220:221], v[220:221], v[58:59] op_sel:[0,1] op_sel_hi:[1,1]
    v_pk_mul_f32 v[222:223], v[222:223], v[58:59] op_sel:[0,1] op_sel_hi:[1,1]
    v_cvt_pk_bf16_f32 v162, v220, v221
    v_cvt_pk_bf16_f32 v163, v222, v223
    v_accvgpr_read_b32 v224, a24
    v_accvgpr_read_b32 v225, a25
    v_accvgpr_read_b32 v226, a26
    v_accvgpr_read_b32 v227, a27
    v_pk_mul_f32 v[224:225], v[224:225], v[60:61] op_sel:[0,0] op_sel_hi:[1,0]
    v_pk_mul_f32 v[226:227], v[226:227], v[60:61] op_sel:[0,0] op_sel_hi:[1,0]
    v_cvt_pk_bf16_f32 v146, v224, v225
    v_cvt_pk_bf16_f32 v147, v226, v227
    v_accvgpr_read_b32 v228, a28
    v_accvgpr_read_b32 v229, a29
    v_accvgpr_read_b32 v230, a30
    v_accvgpr_read_b32 v231, a31
    v_pk_mul_f32 v[228:229], v[228:229], v[60:61] op_sel:[0,1] op_sel_hi:[1,1]
    v_pk_mul_f32 v[230:231], v[230:231], v[60:61] op_sel:[0,1] op_sel_hi:[1,1]
    v_cvt_pk_bf16_f32 v178, v228, v229
    v_cvt_pk_bf16_f32 v179, v230, v231
    v_accvgpr_read_b32 v216, a32
    v_accvgpr_read_b32 v217, a33
    v_accvgpr_read_b32 v218, a34
    v_accvgpr_read_b32 v219, a35
    v_pk_mul_f32 v[216:217], v[216:217], v[58:59] op_sel:[0,0] op_sel_hi:[1,0]
    v_pk_mul_f32 v[218:219], v[218:219], v[58:59] op_sel:[0,0] op_sel_hi:[1,0]
    v_cvt_pk_bf16_f32 v132, v216, v217
    v_cvt_pk_bf16_f32 v133, v218, v219
    v_accvgpr_read_b32 v220, a36
    v_accvgpr_read_b32 v221, a37
    v_accvgpr_read_b32 v222, a38
    v_accvgpr_read_b32 v223, a39
    v_pk_mul_f32 v[220:221], v[220:221], v[58:59] op_sel:[0,1] op_sel_hi:[1,1]
    v_pk_mul_f32 v[222:223], v[222:223], v[58:59] op_sel:[0,1] op_sel_hi:[1,1]
    v_cvt_pk_bf16_f32 v164, v220, v221
    v_cvt_pk_bf16_f32 v165, v222, v223
    v_accvgpr_read_b32 v224, a40
    v_accvgpr_read_b32 v225, a41
    v_accvgpr_read_b32 v226, a42
    v_accvgpr_read_b32 v227, a43
    v_pk_mul_f32 v[224:225], v[224:225], v[60:61] op_sel:[0,0] op_sel_hi:[1,0]
    v_pk_mul_f32 v[226:227], v[226:227], v[60:61] op_sel:[0,0] op_sel_hi:[1,0]
    v_cvt_pk_bf16_f32 v148, v224, v225
    v_cvt_pk_bf16_f32 v149, v226, v227
    v_accvgpr_read_b32 v228, a44
    v_accvgpr_read_b32 v229, a45
    v_accvgpr_read_b32 v230, a46
    v_accvgpr_read_b32 v231, a47
    v_pk_mul_f32 v[228:229], v[228:229], v[60:61] op_sel:[0,1] op_sel_hi:[1,1]
    v_pk_mul_f32 v[230:231], v[230:231], v[60:61] op_sel:[0,1] op_sel_hi:[1,1]
    v_cvt_pk_bf16_f32 v180, v228, v229
    v_cvt_pk_bf16_f32 v181, v230, v231
    v_accvgpr_read_b32 v216, a48
    v_accvgpr_read_b32 v217, a49
    v_accvgpr_read_b32 v218, a50
    v_accvgpr_read_b32 v219, a51
    v_pk_mul_f32 v[216:217], v[216:217], v[58:59] op_sel:[0,0] op_sel_hi:[1,0]
    v_pk_mul_f32 v[218:219], v[218:219], v[58:59] op_sel:[0,0] op_sel_hi:[1,0]
    v_cvt_pk_bf16_f32 v134, v216, v217
    v_cvt_pk_bf16_f32 v135, v218, v219
    v_accvgpr_read_b32 v220, a52
    v_accvgpr_read_b32 v221, a53
    v_accvgpr_read_b32 v222, a54
    v_accvgpr_read_b32 v223, a55
    v_pk_mul_f32 v[220:221], v[220:221], v[58:59] op_sel:[0,1] op_sel_hi:[1,1]
    v_pk_mul_f32 v[222:223], v[222:223], v[58:59] op_sel:[0,1] op_sel_hi:[1,1]
    v_cvt_pk_bf16_f32 v166, v220, v221
    v_cvt_pk_bf16_f32 v167, v222, v223
    v_accvgpr_read_b32 v224, a56
    v_accvgpr_read_b32 v225, a57
    v_accvgpr_read_b32 v226, a58
    v_accvgpr_read_b32 v227, a59
    v_pk_mul_f32 v[224:225], v[224:225], v[60:61] op_sel:[0,0] op_sel_hi:[1,0]
    v_pk_mul_f32 v[226:227], v[226:227], v[60:61] op_sel:[0,0] op_sel_hi:[1,0]
    v_cvt_pk_bf16_f32 v150, v224, v225
    v_cvt_pk_bf16_f32 v151, v226, v227
    v_accvgpr_read_b32 v228, a60
    v_accvgpr_read_b32 v229, a61
    v_accvgpr_read_b32 v230, a62
    v_accvgpr_read_b32 v231, a63
    v_pk_mul_f32 v[228:229], v[228:229], v[60:61] op_sel:[0,1] op_sel_hi:[1,1]
    v_pk_mul_f32 v[230:231], v[230:231], v[60:61] op_sel:[0,1] op_sel_hi:[1,1]
    v_cvt_pk_bf16_f32 v182, v228, v229
    v_cvt_pk_bf16_f32 v183, v230, v231
    v_accvgpr_read_b32 v216, a64
    v_accvgpr_read_b32 v217, a65
    v_accvgpr_read_b32 v218, a66
    v_accvgpr_read_b32 v219, a67
    v_pk_mul_f32 v[216:217], v[216:217], v[58:59] op_sel:[0,0] op_sel_hi:[1,0]
    v_pk_mul_f32 v[218:219], v[218:219], v[58:59] op_sel:[0,0] op_sel_hi:[1,0]
    v_cvt_pk_bf16_f32 v136, v216, v217
    v_cvt_pk_bf16_f32 v137, v218, v219
    v_accvgpr_read_b32 v220, a68
    v_accvgpr_read_b32 v221, a69
    v_accvgpr_read_b32 v222, a70
    v_accvgpr_read_b32 v223, a71
    v_pk_mul_f32 v[220:221], v[220:221], v[58:59] op_sel:[0,1] op_sel_hi:[1,1]
    v_pk_mul_f32 v[222:223], v[222:223], v[58:59] op_sel:[0,1] op_sel_hi:[1,1]
    v_cvt_pk_bf16_f32 v168, v220, v221
    v_cvt_pk_bf16_f32 v169, v222, v223
    v_accvgpr_read_b32 v224, a72
    v_accvgpr_read_b32 v225, a73
    v_accvgpr_read_b32 v226, a74
    v_accvgpr_read_b32 v227, a75
    v_pk_mul_f32 v[224:225], v[224:225], v[60:61] op_sel:[0,0] op_sel_hi:[1,0]
    v_pk_mul_f32 v[226:227], v[226:227], v[60:61] op_sel:[0,0] op_sel_hi:[1,0]
    v_cvt_pk_bf16_f32 v152, v224, v225
    v_cvt_pk_bf16_f32 v153, v226, v227
    v_accvgpr_read_b32 v228, a76
    v_accvgpr_read_b32 v229, a77
    v_accvgpr_read_b32 v230, a78
    v_accvgpr_read_b32 v231, a79
    v_pk_mul_f32 v[228:229], v[228:229], v[60:61] op_sel:[0,1] op_sel_hi:[1,1]
    v_pk_mul_f32 v[230:231], v[230:231], v[60:61] op_sel:[0,1] op_sel_hi:[1,1]
    v_cvt_pk_bf16_f32 v184, v228, v229
    v_cvt_pk_bf16_f32 v185, v230, v231
    v_accvgpr_read_b32 v216, a80
    v_accvgpr_read_b32 v217, a81
    v_accvgpr_read_b32 v218, a82
    v_accvgpr_read_b32 v219, a83
    v_pk_mul_f32 v[216:217], v[216:217], v[58:59] op_sel:[0,0] op_sel_hi:[1,0]
    v_pk_mul_f32 v[218:219], v[218:219], v[58:59] op_sel:[0,0] op_sel_hi:[1,0]
    v_cvt_pk_bf16_f32 v138, v216, v217
    v_cvt_pk_bf16_f32 v139, v218, v219
    v_accvgpr_read_b32 v220, a84
    v_accvgpr_read_b32 v221, a85
    v_accvgpr_read_b32 v222, a86
    v_accvgpr_read_b32 v223, a87
    v_pk_mul_f32 v[220:221], v[220:221], v[58:59] op_sel:[0,1] op_sel_hi:[1,1]
    v_pk_mul_f32 v[222:223], v[222:223], v[58:59] op_sel:[0,1] op_sel_hi:[1,1]
    v_cvt_pk_bf16_f32 v170, v220, v221
    v_cvt_pk_bf16_f32 v171, v222, v223
    v_accvgpr_read_b32 v224, a88
    v_accvgpr_read_b32 v225, a89
    v_accvgpr_read_b32 v226, a90
    v_accvgpr_read_b32 v227, a91
    v_pk_mul_f32 v[224:225], v[224:225], v[60:61] op_sel:[0,0] op_sel_hi:[1,0]
    v_pk_mul_f32 v[226:227], v[226:227], v[60:61] op_sel:[0,0] op_sel_hi:[1,0]
    v_cvt_pk_bf16_f32 v154, v224, v225
    v_cvt_pk_bf16_f32 v155, v226, v227
    v_accvgpr_read_b32 v228, a92
    v_accvgpr_read_b32 v229, a93
    v_accvgpr_read_b32 v230, a94
    v_accvgpr_read_b32 v231, a95
    v_pk_mul_f32 v[228:229], v[228:229], v[60:61] op_sel:[0,1] op_sel_hi:[1,1]
    v_pk_mul_f32 v[230:231], v[230:231], v[60:61] op_sel:[0,1] op_sel_hi:[1,1]
    v_cvt_pk_bf16_f32 v186, v228, v229
    v_cvt_pk_bf16_f32 v187, v230, v231
    v_accvgpr_read_b32 v216, a96
    v_accvgpr_read_b32 v217, a97
    v_accvgpr_read_b32 v218, a98
    v_accvgpr_read_b32 v219, a99
    v_pk_mul_f32 v[216:217], v[216:217], v[58:59] op_sel:[0,0] op_sel_hi:[1,0]
    v_pk_mul_f32 v[218:219], v[218:219], v[58:59] op_sel:[0,0] op_sel_hi:[1,0]
    v_cvt_pk_bf16_f32 v140, v216, v217
    v_cvt_pk_bf16_f32 v141, v218, v219
    v_accvgpr_read_b32 v220, a100
    v_accvgpr_read_b32 v221, a101
    v_accvgpr_read_b32 v222, a102
    v_accvgpr_read_b32 v223, a103
    v_pk_mul_f32 v[220:221], v[220:221], v[58:59] op_sel:[0,1] op_sel_hi:[1,1]
    v_pk_mul_f32 v[222:223], v[222:223], v[58:59] op_sel:[0,1] op_sel_hi:[1,1]
    v_cvt_pk_bf16_f32 v172, v220, v221
    v_cvt_pk_bf16_f32 v173, v222, v223
    v_accvgpr_read_b32 v224, a104
    v_accvgpr_read_b32 v225, a105
    v_accvgpr_read_b32 v226, a106
    v_accvgpr_read_b32 v227, a107
    v_pk_mul_f32 v[224:225], v[224:225], v[60:61] op_sel:[0,0] op_sel_hi:[1,0]
    v_pk_mul_f32 v[226:227], v[226:227], v[60:61] op_sel:[0,0] op_sel_hi:[1,0]
    v_cvt_pk_bf16_f32 v156, v224, v225
    v_cvt_pk_bf16_f32 v157, v226, v227
    v_accvgpr_read_b32 v228, a108
    v_accvgpr_read_b32 v229, a109
    v_accvgpr_read_b32 v230, a110
    v_accvgpr_read_b32 v231, a111
    v_pk_mul_f32 v[228:229], v[228:229], v[60:61] op_sel:[0,1] op_sel_hi:[1,1]
    v_pk_mul_f32 v[230:231], v[230:231], v[60:61] op_sel:[0,1] op_sel_hi:[1,1]
    v_cvt_pk_bf16_f32 v188, v228, v229
    v_cvt_pk_bf16_f32 v189, v230, v231
    v_accvgpr_read_b32 v216, a112
    v_accvgpr_read_b32 v217, a113
    v_accvgpr_read_b32 v218, a114
    v_accvgpr_read_b32 v219, a115
    v_pk_mul_f32 v[216:217], v[216:217], v[58:59] op_sel:[0,0] op_sel_hi:[1,0]
    v_pk_mul_f32 v[218:219], v[218:219], v[58:59] op_sel:[0,0] op_sel_hi:[1,0]
    v_cvt_pk_bf16_f32 v142, v216, v217
    v_cvt_pk_bf16_f32 v143, v218, v219
    v_accvgpr_read_b32 v220, a116
    v_accvgpr_read_b32 v221, a117
    v_accvgpr_read_b32 v222, a118
    v_accvgpr_read_b32 v223, a119
    v_pk_mul_f32 v[220:221], v[220:221], v[58:59] op_sel:[0,1] op_sel_hi:[1,1]
    v_pk_mul_f32 v[222:223], v[222:223], v[58:59] op_sel:[0,1] op_sel_hi:[1,1]
    v_cvt_pk_bf16_f32 v174, v220, v221
    v_cvt_pk_bf16_f32 v175, v222, v223
    v_accvgpr_read_b32 v224, a120
    v_accvgpr_read_b32 v225, a121
    v_accvgpr_read_b32 v226, a122
    v_accvgpr_read_b32 v227, a123
    v_pk_mul_f32 v[224:225], v[224:225], v[60:61] op_sel:[0,0] op_sel_hi:[1,0]
    v_pk_mul_f32 v[226:227], v[226:227], v[60:61] op_sel:[0,0] op_sel_hi:[1,0]
    v_cvt_pk_bf16_f32 v158, v224, v225
    v_cvt_pk_bf16_f32 v159, v226, v227
    v_accvgpr_read_b32 v228, a124
    v_accvgpr_read_b32 v229, a125
    v_accvgpr_read_b32 v230, a126
    v_accvgpr_read_b32 v231, a127
    v_pk_mul_f32 v[228:229], v[228:229], v[60:61] op_sel:[0,1] op_sel_hi:[1,1]
    v_pk_mul_f32 v[230:231], v[230:231], v[60:61] op_sel:[0,1] op_sel_hi:[1,1]
    v_cvt_pk_bf16_f32 v190, v228, v229
    v_cvt_pk_bf16_f32 v191, v230, v231
    s_waitcnt lgkmcnt(14)
    v_mfma_f32_16x16x32_bf16 v[192:195], a[128:131], v[128:131], 0
    s_waitcnt lgkmcnt(12)
    ds_read_b64_tr_b16 a[160:161], v29 offset:0
    v_mfma_f32_16x16x32_bf16 v[192:195], a[132:135], v[132:135], v[192:195]
    s_waitcnt lgkmcnt(11)
    ds_read_b64_tr_b16 a[162:163], v29 offset:4096
    v_mfma_f32_16x16x32_bf16 v[192:195], a[136:139], v[136:139], v[192:195]
    s_waitcnt lgkmcnt(10)
    ds_read_b64_tr_b16 a[164:165], v29 offset:8192
    v_mfma_f32_16x16x32_bf16 v[192:195], a[140:143], v[140:143], v[192:195]
    s_waitcnt lgkmcnt(9)
    ds_read_b64_tr_b16 a[166:167], v29 offset:12288
    v_mfma_f32_16x16x32_bf16 v[192:195], a[144:147], v[144:147], v[192:195]
    s_waitcnt lgkmcnt(8)
    ds_read_b64_tr_b16 a[168:169], v29 offset:16384
    v_mfma_f32_16x16x32_bf16 v[192:195], a[148:151], v[148:151], v[192:195]
    s_waitcnt lgkmcnt(7)
    ds_read_b64_tr_b16 a[170:171], v29 offset:20480
    v_mfma_f32_16x16x32_bf16 v[192:195], a[152:155], v[152:155], v[192:195]
    s_waitcnt lgkmcnt(6)
    ds_read_b64_tr_b16 a[172:173], v29 offset:24576
    v_mfma_f32_16x16x32_bf16 v[192:195], a[156:159], v[156:159], v[192:195]
    ds_read_b64_tr_b16 a[174:175], v29 offset:28672
    v_mfma_f32_16x16x32_bf16 v[196:199], a[128:131], v[160:163], 0
    ds_read_b64_tr_b16 a[176:177], v33 offset:0
    v_mfma_f32_16x16x32_bf16 v[196:199], a[132:135], v[164:167], v[196:199]
    ds_read_b64_tr_b16 a[178:179], v33 offset:4096
    v_mfma_f32_16x16x32_bf16 v[196:199], a[136:139], v[168:171], v[196:199]
    ds_read_b64_tr_b16 a[180:181], v33 offset:8192
    v_mfma_f32_16x16x32_bf16 v[196:199], a[140:143], v[172:175], v[196:199]
    ds_read_b64_tr_b16 a[182:183], v33 offset:12288
    v_mfma_f32_16x16x32_bf16 v[196:199], a[144:147], v[176:179], v[196:199]
    ds_read_b64_tr_b16 a[184:185], v33 offset:16384
    v_cvt_pk_bf16_f32 v224, v192, v193
    v_mfma_f32_16x16x32_bf16 v[196:199], a[148:151], v[180:183], v[196:199]
    ds_read_b64_tr_b16 a[186:187], v33 offset:20480
    v_cvt_pk_bf16_f32 v225, v194, v195
    v_mfma_f32_16x16x32_bf16 v[196:199], a[152:155], v[184:187], v[196:199]
    ds_read_b64_tr_b16 a[188:189], v33 offset:24576
    v_mfma_f32_16x16x32_bf16 v[196:199], a[156:159], v[188:191], v[196:199]
    s_waitcnt lgkmcnt(13)
    ds_read_b64_tr_b16 a[190:191], v33 offset:28672
    v_mfma_f32_16x16x32_bf16 v[200:203], a[160:163], v[128:131], 0
    s_waitcnt lgkmcnt(12)
    ds_read_b64_tr_b16 a[128:129], v30 offset:0
    v_mfma_f32_16x16x32_bf16 v[200:203], a[164:167], v[132:135], v[200:203]
    s_waitcnt lgkmcnt(11)
    ds_read_b64_tr_b16 a[130:131], v30 offset:4096
    v_mfma_f32_16x16x32_bf16 v[200:203], a[168:171], v[136:139], v[200:203]
    s_waitcnt lgkmcnt(10)
    ds_read_b64_tr_b16 a[132:133], v30 offset:8192
    v_mfma_f32_16x16x32_bf16 v[200:203], a[172:175], v[140:143], v[200:203]
    s_waitcnt lgkmcnt(9)
    ds_read_b64_tr_b16 a[134:135], v30 offset:12288
    v_mfma_f32_16x16x32_bf16 v[200:203], a[176:179], v[144:147], v[200:203]
    s_waitcnt lgkmcnt(8)
    ds_read_b64_tr_b16 a[136:137], v30 offset:16384
    v_cvt_pk_bf16_f32 v228, v196, v197
    v_mfma_f32_16x16x32_bf16 v[200:203], a[180:183], v[148:151], v[200:203]
    s_waitcnt lgkmcnt(7)
    ds_read_b64_tr_b16 a[138:139], v30 offset:20480
    v_cvt_pk_bf16_f32 v229, v198, v199
    v_mfma_f32_16x16x32_bf16 v[200:203], a[184:187], v[152:155], v[200:203]
    s_waitcnt lgkmcnt(6)
    ds_read_b64_tr_b16 a[140:141], v30 offset:24576
    v_mfma_f32_16x16x32_bf16 v[200:203], a[188:191], v[156:159], v[200:203]
    ds_read_b64_tr_b16 a[142:143], v30 offset:28672
    v_mfma_f32_16x16x32_bf16 v[204:207], a[160:163], v[160:163], 0
    ds_read_b64_tr_b16 a[144:145], v34 offset:0
    v_mfma_f32_16x16x32_bf16 v[204:207], a[164:167], v[164:167], v[204:207]
    ds_read_b64_tr_b16 a[146:147], v34 offset:4096
    v_mfma_f32_16x16x32_bf16 v[204:207], a[168:171], v[168:171], v[204:207]
    ds_read_b64_tr_b16 a[148:149], v34 offset:8192
    v_mfma_f32_16x16x32_bf16 v[204:207], a[172:175], v[172:175], v[204:207]
    ds_read_b64_tr_b16 a[150:151], v34 offset:12288
    v_mfma_f32_16x16x32_bf16 v[204:207], a[176:179], v[176:179], v[204:207]
    ds_read_b64_tr_b16 a[152:153], v34 offset:16384
    v_cvt_pk_bf16_f32 v226, v200, v201
    v_mfma_f32_16x16x32_bf16 v[204:207], a[180:183], v[180:183], v[204:207]
    s_add_u32 s38, s47, 0
    ds_read_b64_tr_b16 a[154:155], v34 offset:20480
    v_cvt_pk_bf16_f32 v227, v202, v203
    v_mfma_f32_16x16x32_bf16 v[204:207], a[184:187], v[184:187], v[204:207]
    ds_read_b64_tr_b16 a[156:157], v34 offset:24576
    buffer_store_dwordx4 v[224:227], v56, s[28:31], s38 offen sc1
    v_mfma_f32_16x16x32_bf16 v[204:207], a[188:191], v[188:191], v[204:207]
    s_waitcnt lgkmcnt(13)
    ds_read_b64_tr_b16 a[158:159], v34 offset:28672
    v_mfma_f32_16x16x32_bf16 v[192:195], a[128:131], v[128:131], 0
    s_waitcnt lgkmcnt(12)
    ds_read_b64_tr_b16 a[160:161], v31 offset:0
    v_mfma_f32_16x16x32_bf16 v[192:195], a[132:135], v[132:135], v[192:195]
    s_waitcnt lgkmcnt(11)
    ds_read_b64_tr_b16 a[162:163], v31 offset:4096
    v_mfma_f32_16x16x32_bf16 v[192:195], a[136:139], v[136:139], v[192:195]
    s_waitcnt lgkmcnt(10)
    ds_read_b64_tr_b16 a[164:165], v31 offset:8192
    v_mfma_f32_16x16x32_bf16 v[192:195], a[140:143], v[140:143], v[192:195]
    s_waitcnt lgkmcnt(9)
    ds_read_b64_tr_b16 a[166:167], v31 offset:12288
    v_mfma_f32_16x16x32_bf16 v[192:195], a[144:147], v[144:147], v[192:195]
    s_waitcnt lgkmcnt(8)
    ds_read_b64_tr_b16 a[168:169], v31 offset:16384
    v_cvt_pk_bf16_f32 v230, v204, v205
    v_mfma_f32_16x16x32_bf16 v[192:195], a[148:151], v[148:151], v[192:195]
    s_waitcnt lgkmcnt(7)
    s_add_u32 s38, s47, 294912
    ds_read_b64_tr_b16 a[170:171], v31 offset:20480
    v_cvt_pk_bf16_f32 v231, v206, v207
    v_mfma_f32_16x16x32_bf16 v[192:195], a[152:155], v[152:155], v[192:195]
    s_waitcnt lgkmcnt(6)
    ds_read_b64_tr_b16 a[172:173], v31 offset:24576
    buffer_store_dwordx4 v[228:231], v56, s[28:31], s38 offen sc1
    v_mfma_f32_16x16x32_bf16 v[192:195], a[156:159], v[156:159], v[192:195]
    ds_read_b64_tr_b16 a[174:175], v31 offset:28672
    v_mfma_f32_16x16x32_bf16 v[196:199], a[128:131], v[160:163], 0
    ds_read_b64_tr_b16 a[176:177], v35 offset:0
    v_mfma_f32_16x16x32_bf16 v[196:199], a[132:135], v[164:167], v[196:199]
    ds_read_b64_tr_b16 a[178:179], v35 offset:4096
    v_mfma_f32_16x16x32_bf16 v[196:199], a[136:139], v[168:171], v[196:199]
    ds_read_b64_tr_b16 a[180:181], v35 offset:8192
    v_mfma_f32_16x16x32_bf16 v[196:199], a[140:143], v[172:175], v[196:199]
    ds_read_b64_tr_b16 a[182:183], v35 offset:12288
    v_mfma_f32_16x16x32_bf16 v[196:199], a[144:147], v[176:179], v[196:199]
    ds_read_b64_tr_b16 a[184:185], v35 offset:16384
    v_cvt_pk_bf16_f32 v232, v192, v193
    v_mfma_f32_16x16x32_bf16 v[196:199], a[148:151], v[180:183], v[196:199]
    ds_read_b64_tr_b16 a[186:187], v35 offset:20480
    v_cvt_pk_bf16_f32 v233, v194, v195
    v_mfma_f32_16x16x32_bf16 v[196:199], a[152:155], v[184:187], v[196:199]
    ds_read_b64_tr_b16 a[188:189], v35 offset:24576
    v_mfma_f32_16x16x32_bf16 v[196:199], a[156:159], v[188:191], v[196:199]
    s_waitcnt lgkmcnt(13)
    ds_read_b64_tr_b16 a[190:191], v35 offset:28672
    s_waitcnt vmcnt(14)
    s_barrier
    v_mfma_f32_16x16x32_bf16 v[200:203], a[160:163], v[128:131], 0
    s_waitcnt lgkmcnt(12)
    ds_read_b64_tr_b16 a[128:129], v12 offset:0
    v_mfma_f32_16x16x32_bf16 v[200:203], a[164:167], v[132:135], v[200:203]
    s_waitcnt lgkmcnt(11)
    s_add_u32 s49, s45, 74112
    ds_read_b64_tr_b16 a[130:131], v12 offset:4096
    v_mfma_f32_16x16x32_bf16 v[200:203], a[168:171], v[136:139], v[200:203]
    s_waitcnt lgkmcnt(10)
    s_add_u32 m0, s42, 81920
    ds_read_b64_tr_b16 a[132:133], v12 offset:8192
    v_mfma_f32_16x16x32_bf16 v[200:203], a[172:175], v[140:143], v[200:203]
    s_waitcnt lgkmcnt(9)
    ds_read_b64_tr_b16 a[134:135], v12 offset:12288
    buffer_load_dwordx4 v46, s[20:23], s49 offen lds
    v_mfma_f32_16x16x32_bf16 v[200:203], a[176:179], v[144:147], v[200:203]
    s_waitcnt lgkmcnt(8)
    ds_read_b64_tr_b16 a[136:137], v12 offset:16384
    v_cvt_pk_bf16_f32 v236, v196, v197
    v_mfma_f32_16x16x32_bf16 v[200:203], a[180:183], v[148:151], v[200:203]
    s_waitcnt lgkmcnt(7)
    ds_read_b64_tr_b16 a[138:139], v12 offset:20480
    v_cvt_pk_bf16_f32 v237, v198, v199
    v_mfma_f32_16x16x32_bf16 v[200:203], a[184:187], v[152:155], v[200:203]
    s_waitcnt lgkmcnt(6)
    ds_read_b64_tr_b16 a[140:141], v12 offset:24576
    v_mfma_f32_16x16x32_bf16 v[200:203], a[188:191], v[156:159], v[200:203]
    ds_read_b64_tr_b16 a[142:143], v12 offset:28672
    buffer_load_dwordx4 v47, s[20:23], s49 offen offset:1024 lds
    v_mfma_f32_16x16x32_bf16 v[204:207], a[160:163], v[160:163], 0
    ds_read_b64_tr_b16 a[144:145], v16 offset:0
    v_mfma_f32_16x16x32_bf16 v[204:207], a[164:167], v[164:167], v[204:207]
    ds_read_b64_tr_b16 a[146:147], v16 offset:4096
    v_mfma_f32_16x16x32_bf16 v[204:207], a[168:171], v[168:171], v[204:207]
    ds_read_b64_tr_b16 a[148:149], v16 offset:8192
    v_mfma_f32_16x16x32_bf16 v[204:207], a[172:175], v[172:175], v[204:207]
    ds_read_b64_tr_b16 a[150:151], v16 offset:12288
    buffer_load_dwordx4 v48, s[20:23], s49 offen offset:2048 lds
    v_mfma_f32_16x16x32_bf16 v[204:207], a[176:179], v[176:179], v[204:207]
    ds_read_b64_tr_b16 a[152:153], v16 offset:16384
    v_cvt_pk_bf16_f32 v234, v200, v201
    v_mfma_f32_16x16x32_bf16 v[204:207], a[180:183], v[180:183], v[204:207]
    s_add_u32 s38, s47, 512
    ds_read_b64_tr_b16 a[154:155], v16 offset:20480
    v_cvt_pk_bf16_f32 v235, v202, v203
    v_mfma_f32_16x16x32_bf16 v[204:207], a[184:187], v[184:187], v[204:207]
    ds_read_b64_tr_b16 a[156:157], v16 offset:24576
    buffer_store_dwordx4 v[232:235], v56, s[28:31], s38 offen sc1
    v_mfma_f32_16x16x32_bf16 v[204:207], a[188:191], v[188:191], v[204:207]
    s_waitcnt lgkmcnt(13)
    ds_read_b64_tr_b16 a[158:159], v16 offset:28672
    buffer_load_dwordx4 v49, s[20:23], s49 offen offset:3072 lds
    v_mfma_f32_16x16x32_bf16 v[192:195], a[128:131], v[128:131], 0
    s_waitcnt lgkmcnt(12)
    ds_read_b64_tr_b16 a[160:161], v13 offset:0
    v_mfma_f32_16x16x32_bf16 v[192:195], a[132:135], v[132:135], v[192:195]
    s_waitcnt lgkmcnt(11)
    s_add_u32 s49, s45, 512
    ds_read_b64_tr_b16 a[162:163], v13 offset:4096
    v_mfma_f32_16x16x32_bf16 v[192:195], a[136:139], v[136:139], v[192:195]
    s_waitcnt lgkmcnt(10)
    s_add_u32 m0, s42, 98304
    ds_read_b64_tr_b16 a[164:165], v13 offset:8192
    v_mfma_f32_16x16x32_bf16 v[192:195], a[140:143], v[140:143], v[192:195]
    s_waitcnt lgkmcnt(9)
    ds_read_b64_tr_b16 a[166:167], v13 offset:12288
    buffer_load_dwordx4 v46, s[20:23], s49 offen lds
    v_mfma_f32_16x16x32_bf16 v[192:195], a[144:147], v[144:147], v[192:195]
    s_waitcnt lgkmcnt(8)
    ds_read_b64_tr_b16 a[168:169], v13 offset:16384
    v_cvt_pk_bf16_f32 v238, v204, v205
    v_mfma_f32_16x16x32_bf16 v[192:195], a[148:151], v[148:151], v[192:195]
    s_waitcnt lgkmcnt(7)
    s_add_u32 s38, s47, 295424
    ds_read_b64_tr_b16 a[170:171], v13 offset:20480
    v_cvt_pk_bf16_f32 v239, v206, v207
    v_mfma_f32_16x16x32_bf16 v[192:195], a[152:155], v[152:155], v[192:195]
    s_waitcnt lgkmcnt(6)
    ds_read_b64_tr_b16 a[172:173], v13 offset:24576
    buffer_store_dwordx4 v[236:239], v56, s[28:31], s38 offen sc1
    v_mfma_f32_16x16x32_bf16 v[192:195], a[156:159], v[156:159], v[192:195]
    ds_read_b64_tr_b16 a[174:175], v13 offset:28672
    buffer_load_dwordx4 v47, s[20:23], s49 offen offset:1024 lds
    v_mfma_f32_16x16x32_bf16 v[196:199], a[128:131], v[160:163], 0
    ds_read_b64_tr_b16 a[176:177], v17 offset:0
    v_mfma_f32_16x16x32_bf16 v[196:199], a[132:135], v[164:167], v[196:199]
    ds_read_b64_tr_b16 a[178:179], v17 offset:4096
    v_mfma_f32_16x16x32_bf16 v[196:199], a[136:139], v[168:171], v[196:199]
    ds_read_b64_tr_b16 a[180:181], v17 offset:8192
    v_mfma_f32_16x16x32_bf16 v[196:199], a[140:143], v[172:175], v[196:199]
    ds_read_b64_tr_b16 a[182:183], v17 offset:12288
    buffer_load_dwordx4 v48, s[20:23], s49 offen offset:2048 lds
    v_mfma_f32_16x16x32_bf16 v[196:199], a[144:147], v[176:179], v[196:199]
    ds_read_b64_tr_b16 a[184:185], v17 offset:16384
    v_cvt_pk_bf16_f32 v224, v192, v193
    v_mfma_f32_16x16x32_bf16 v[196:199], a[148:151], v[180:183], v[196:199]
    ds_read_b64_tr_b16 a[186:187], v17 offset:20480
    v_cvt_pk_bf16_f32 v225, v194, v195
    v_mfma_f32_16x16x32_bf16 v[196:199], a[152:155], v[184:187], v[196:199]
    ds_read_b64_tr_b16 a[188:189], v17 offset:24576
    v_mfma_f32_16x16x32_bf16 v[196:199], a[156:159], v[188:191], v[196:199]
    s_waitcnt lgkmcnt(13)
    ds_read_b64_tr_b16 a[190:191], v17 offset:28672
    buffer_load_dwordx4 v49, s[20:23], s49 offen offset:3072 lds
    v_mfma_f32_16x16x32_bf16 v[200:203], a[160:163], v[128:131], 0
    s_waitcnt lgkmcnt(12)
    ds_read_b64_tr_b16 a[128:129], v14 offset:0
    v_mfma_f32_16x16x32_bf16 v[200:203], a[164:167], v[132:135], v[200:203]
    s_waitcnt lgkmcnt(11)
    s_add_u32 s49, s45, 74240
    ds_read_b64_tr_b16 a[130:131], v14 offset:4096
    v_mfma_f32_16x16x32_bf16 v[200:203], a[168:171], v[136:139], v[200:203]
    s_waitcnt lgkmcnt(10)
    s_add_u32 m0, s42, 114688
    ds_read_b64_tr_b16 a[132:133], v14 offset:8192
    v_mfma_f32_16x16x32_bf16 v[200:203], a[172:175], v[140:143], v[200:203]
    s_waitcnt lgkmcnt(9)
    ds_read_b64_tr_b16 a[134:135], v14 offset:12288
    buffer_load_dwordx4 v46, s[20:23], s49 offen lds
    v_mfma_f32_16x16x32_bf16 v[200:203], a[176:179], v[144:147], v[200:203]
    s_waitcnt lgkmcnt(8)
    ds_read_b64_tr_b16 a[136:137], v14 offset:16384
    v_cvt_pk_bf16_f32 v228, v196, v197
    v_mfma_f32_16x16x32_bf16 v[200:203], a[180:183], v[148:151], v[200:203]
    s_waitcnt lgkmcnt(7)
    ds_read_b64_tr_b16 a[138:139], v14 offset:20480
    v_cvt_pk_bf16_f32 v229, v198, v199
    v_mfma_f32_16x16x32_bf16 v[200:203], a[184:187], v[152:155], v[200:203]
    s_waitcnt lgkmcnt(6)
    ds_read_b64_tr_b16 a[140:141], v14 offset:24576
    v_mfma_f32_16x16x32_bf16 v[200:203], a[188:191], v[156:159], v[200:203]
    ds_read_b64_tr_b16 a[142:143], v14 offset:28672
    buffer_load_dwordx4 v47, s[20:23], s49 offen offset:1024 lds
    v_mfma_f32_16x16x32_bf16 v[204:207], a[160:163], v[160:163], 0
    ds_read_b64_tr_b16 a[144:145], v18 offset:0
    v_mfma_f32_16x16x32_bf16 v[204:207], a[164:167], v[164:167], v[204:207]
    ds_read_b64_tr_b16 a[146:147], v18 offset:4096
    v_mfma_f32_16x16x32_bf16 v[204:207], a[168:171], v[168:171], v[204:207]
    ds_read_b64_tr_b16 a[148:149], v18 offset:8192
    v_mfma_f32_16x16x32_bf16 v[204:207], a[172:175], v[172:175], v[204:207]
    ds_read_b64_tr_b16 a[150:151], v18 offset:12288
    buffer_load_dwordx4 v48, s[20:23], s49 offen offset:2048 lds
    v_mfma_f32_16x16x32_bf16 v[204:207], a[176:179], v[176:179], v[204:207]
    ds_read_b64_tr_b16 a[152:153], v18 offset:16384
    v_cvt_pk_bf16_f32 v226, v200, v201
    v_mfma_f32_16x16x32_bf16 v[204:207], a[180:183], v[180:183], v[204:207]
    s_add_u32 s38, s47, 1024
    ds_read_b64_tr_b16 a[154:155], v18 offset:20480
    v_cvt_pk_bf16_f32 v227, v202, v203
    v_mfma_f32_16x16x32_bf16 v[204:207], a[184:187], v[184:187], v[204:207]
    ds_read_b64_tr_b16 a[156:157], v18 offset:24576
    buffer_store_dwordx4 v[224:227], v56, s[28:31], s38 offen sc1
    v_mfma_f32_16x16x32_bf16 v[204:207], a[188:191], v[188:191], v[204:207]
    s_waitcnt lgkmcnt(13)
    ds_read_b64_tr_b16 a[158:159], v18 offset:28672
    buffer_load_dwordx4 v49, s[20:23], s49 offen offset:3072 lds
    v_mfma_f32_16x16x32_bf16 v[192:195], a[128:131], v[128:131], 0
    s_waitcnt lgkmcnt(12)
    ds_read_b64_tr_b16 a[160:161], v15 offset:0
    v_mfma_f32_16x16x32_bf16 v[192:195], a[132:135], v[132:135], v[192:195]
    s_waitcnt lgkmcnt(11)
    ds_read_b64_tr_b16 a[162:163], v15 offset:4096
    v_mfma_f32_16x16x32_bf16 v[192:195], a[136:139], v[136:139], v[192:195]
    s_waitcnt lgkmcnt(10)
    ds_read_b64_tr_b16 a[164:165], v15 offset:8192
    v_mfma_f32_16x16x32_bf16 v[192:195], a[140:143], v[140:143], v[192:195]
    s_waitcnt lgkmcnt(9)
    ds_read_b64_tr_b16 a[166:167], v15 offset:12288
    v_mfma_f32_16x16x32_bf16 v[192:195], a[144:147], v[144:147], v[192:195]
    s_waitcnt lgkmcnt(8)
    ds_read_b64_tr_b16 a[168:169], v15 offset:16384
    v_cvt_pk_bf16_f32 v230, v204, v205
    v_mfma_f32_16x16x32_bf16 v[192:195], a[148:151], v[148:151], v[192:195]
    s_waitcnt lgkmcnt(7)
    s_add_u32 s38, s47, 295936
    ds_read_b64_tr_b16 a[170:171], v15 offset:20480
    v_cvt_pk_bf16_f32 v231, v206, v207
    v_mfma_f32_16x16x32_bf16 v[192:195], a[152:155], v[152:155], v[192:195]
    s_waitcnt lgkmcnt(6)
    ds_read_b64_tr_b16 a[172:173], v15 offset:24576
    buffer_store_dwordx4 v[228:231], v56, s[28:31], s38 offen sc1
    v_mfma_f32_16x16x32_bf16 v[192:195], a[156:159], v[156:159], v[192:195]
    ds_read_b64_tr_b16 a[174:175], v15 offset:28672
    v_mfma_f32_16x16x32_bf16 v[196:199], a[128:131], v[160:163], 0
    ds_read_b64_tr_b16 a[176:177], v19 offset:0
    v_mfma_f32_16x16x32_bf16 v[196:199], a[132:135], v[164:167], v[196:199]
    ds_read_b64_tr_b16 a[178:179], v19 offset:4096
    v_mfma_f32_16x16x32_bf16 v[196:199], a[136:139], v[168:171], v[196:199]
    ds_read_b64_tr_b16 a[180:181], v19 offset:8192
    v_mfma_f32_16x16x32_bf16 v[196:199], a[140:143], v[172:175], v[196:199]
    ds_read_b64_tr_b16 a[182:183], v19 offset:12288
    v_mfma_f32_16x16x32_bf16 v[196:199], a[144:147], v[176:179], v[196:199]
    ds_read_b64_tr_b16 a[184:185], v19 offset:16384
    v_cvt_pk_bf16_f32 v232, v192, v193
    v_mfma_f32_16x16x32_bf16 v[196:199], a[148:151], v[180:183], v[196:199]
    ds_read_b64_tr_b16 a[186:187], v19 offset:20480
    v_cvt_pk_bf16_f32 v233, v194, v195
    v_mfma_f32_16x16x32_bf16 v[196:199], a[152:155], v[184:187], v[196:199]
    ds_read_b64_tr_b16 a[188:189], v19 offset:24576
    v_mfma_f32_16x16x32_bf16 v[196:199], a[156:159], v[188:191], v[196:199]
    s_waitcnt lgkmcnt(13)
    ds_read_b64_tr_b16 a[190:191], v19 offset:28672
    s_waitcnt vmcnt(22)
    s_barrier
    v_mfma_f32_16x16x32_bf16 v[200:203], a[160:163], v[128:131], 0
    s_waitcnt lgkmcnt(12)
    ds_read_b64_tr_b16 a[128:129], v12 offset:32768
    v_mfma_f32_16x16x32_bf16 v[200:203], a[164:167], v[132:135], v[200:203]
    s_waitcnt lgkmcnt(11)
    s_add_u32 s49, s45, 640
    ds_read_b64_tr_b16 a[130:131], v12 offset:36864
    v_mfma_f32_16x16x32_bf16 v[200:203], a[168:171], v[136:139], v[200:203]
    s_waitcnt lgkmcnt(10)
    s_add_u32 m0, s42, 131072
    ds_read_b64_tr_b16 a[132:133], v12 offset:40960
    v_mfma_f32_16x16x32_bf16 v[200:203], a[172:175], v[140:143], v[200:203]
    s_waitcnt lgkmcnt(9)
    ds_read_b64_tr_b16 a[134:135], v12 offset:45056
    buffer_load_dwordx4 v46, s[20:23], s49 offen lds
    v_mfma_f32_16x16x32_bf16 v[200:203], a[176:179], v[144:147], v[200:203]
    s_waitcnt lgkmcnt(8)
    ds_read_b64_tr_b16 a[136:137], v12 offset:49152
    v_cvt_pk_bf16_f32 v236, v196, v197
    v_mfma_f32_16x16x32_bf16 v[200:203], a[180:183], v[148:151], v[200:203]
    s_waitcnt lgkmcnt(7)
    ds_read_b64_tr_b16 a[138:139], v12 offset:53248
    v_cvt_pk_bf16_f32 v237, v198, v199
    v_mfma_f32_16x16x32_bf16 v[200:203], a[184:187], v[152:155], v[200:203]
    s_waitcnt lgkmcnt(6)
    ds_read_b64_tr_b16 a[140:141], v12 offset:57344
    v_mfma_f32_16x16x32_bf16 v[200:203], a[188:191], v[156:159], v[200:203]
    ds_read_b64_tr_b16 a[142:143], v12 offset:61440
    buffer_load_dwordx4 v47, s[20:23], s49 offen offset:1024 lds
    v_mfma_f32_16x16x32_bf16 v[204:207], a[160:163], v[160:163], 0
    ds_read_b64_tr_b16 a[144:145], v16 offset:32768
    v_mfma_f32_16x16x32_bf16 v[204:207], a[164:167], v[164:167], v[204:207]
    ds_read_b64_tr_b16 a[146:147], v16 offset:36864
    v_mfma_f32_16x16x32_bf16 v[204:207], a[168:171], v[168:171], v[204:207]
    ds_read_b64_tr_b16 a[148:149], v16 offset:40960
    v_mfma_f32_16x16x32_bf16 v[204:207], a[172:175], v[172:175], v[204:207]
    ds_read_b64_tr_b16 a[150:151], v16 offset:45056
    buffer_load_dwordx4 v48, s[20:23], s49 offen offset:2048 lds
    v_mfma_f32_16x16x32_bf16 v[204:207], a[176:179], v[176:179], v[204:207]
    ds_read_b64_tr_b16 a[152:153], v16 offset:49152
    v_cvt_pk_bf16_f32 v234, v200, v201
    v_mfma_f32_16x16x32_bf16 v[204:207], a[180:183], v[180:183], v[204:207]
    s_add_u32 s38, s47, 1536
    ds_read_b64_tr_b16 a[154:155], v16 offset:53248
    v_cvt_pk_bf16_f32 v235, v202, v203
    v_mfma_f32_16x16x32_bf16 v[204:207], a[184:187], v[184:187], v[204:207]
    ds_read_b64_tr_b16 a[156:157], v16 offset:57344
    buffer_store_dwordx4 v[232:235], v56, s[28:31], s38 offen sc1
    v_mfma_f32_16x16x32_bf16 v[204:207], a[188:191], v[188:191], v[204:207]
    s_waitcnt lgkmcnt(13)
    ds_read_b64_tr_b16 a[158:159], v16 offset:61440
    buffer_load_dwordx4 v49, s[20:23], s49 offen offset:3072 lds
    v_mfma_f32_16x16x32_bf16 v[192:195], a[128:131], v[128:131], 0
    s_waitcnt lgkmcnt(12)
    ds_read_b64_tr_b16 a[160:161], v13 offset:32768
    v_mfma_f32_16x16x32_bf16 v[192:195], a[132:135], v[132:135], v[192:195]
    s_waitcnt lgkmcnt(11)
    s_add_u32 s49, s45, 74368
    ds_read_b64_tr_b16 a[162:163], v13 offset:36864
    v_mfma_f32_16x16x32_bf16 v[192:195], a[136:139], v[136:139], v[192:195]
    s_waitcnt lgkmcnt(10)
    s_add_u32 m0, s42, 147456
    ds_read_b64_tr_b16 a[164:165], v13 offset:40960
    v_mfma_f32_16x16x32_bf16 v[192:195], a[140:143], v[140:143], v[192:195]
    s_waitcnt lgkmcnt(9)
    ds_read_b64_tr_b16 a[166:167], v13 offset:45056
    buffer_load_dwordx4 v46, s[20:23], s49 offen lds
    v_mfma_f32_16x16x32_bf16 v[192:195], a[144:147], v[144:147], v[192:195]
    s_waitcnt lgkmcnt(8)
    ds_read_b64_tr_b16 a[168:169], v13 offset:49152
    v_cvt_pk_bf16_f32 v238, v204, v205
    v_mfma_f32_16x16x32_bf16 v[192:195], a[148:151], v[148:151], v[192:195]
    s_waitcnt lgkmcnt(7)
    s_add_u32 s38, s47, 296448
    ds_read_b64_tr_b16 a[170:171], v13 offset:53248
    v_cvt_pk_bf16_f32 v239, v206, v207
    v_mfma_f32_16x16x32_bf16 v[192:195], a[152:155], v[152:155], v[192:195]
    s_waitcnt lgkmcnt(6)
    ds_read_b64_tr_b16 a[172:173], v13 offset:57344
    buffer_store_dwordx4 v[236:239], v56, s[28:31], s38 offen sc1
    v_mfma_f32_16x16x32_bf16 v[192:195], a[156:159], v[156:159], v[192:195]
    ds_read_b64_tr_b16 a[174:175], v13 offset:61440
    buffer_load_dwordx4 v47, s[20:23], s49 offen offset:1024 lds
    v_mfma_f32_16x16x32_bf16 v[196:199], a[128:131], v[160:163], 0
    ds_read_b64_tr_b16 a[176:177], v17 offset:32768
    v_mfma_f32_16x16x32_bf16 v[196:199], a[132:135], v[164:167], v[196:199]
    ds_read_b64_tr_b16 a[178:179], v17 offset:36864
    v_mfma_f32_16x16x32_bf16 v[196:199], a[136:139], v[168:171], v[196:199]
    ds_read_b64_tr_b16 a[180:181], v17 offset:40960
    v_mfma_f32_16x16x32_bf16 v[196:199], a[140:143], v[172:175], v[196:199]
    ds_read_b64_tr_b16 a[182:183], v17 offset:45056
    buffer_load_dwordx4 v48, s[20:23], s49 offen offset:2048 lds
    v_mfma_f32_16x16x32_bf16 v[196:199], a[144:147], v[176:179], v[196:199]
    ds_read_b64_tr_b16 a[184:185], v17 offset:49152
    v_cvt_pk_bf16_f32 v224, v192, v193
    v_mfma_f32_16x16x32_bf16 v[196:199], a[148:151], v[180:183], v[196:199]
    ds_read_b64_tr_b16 a[186:187], v17 offset:53248
    v_cvt_pk_bf16_f32 v225, v194, v195
    v_mfma_f32_16x16x32_bf16 v[196:199], a[152:155], v[184:187], v[196:199]
    ds_read_b64_tr_b16 a[188:189], v17 offset:57344
    v_mfma_f32_16x16x32_bf16 v[196:199], a[156:159], v[188:191], v[196:199]
    s_waitcnt lgkmcnt(13)
    ds_read_b64_tr_b16 a[190:191], v17 offset:61440
    buffer_load_dwordx4 v49, s[20:23], s49 offen offset:3072 lds
    v_mfma_f32_16x16x32_bf16 v[200:203], a[160:163], v[128:131], 0
    s_waitcnt lgkmcnt(12)
    ds_read_b64_tr_b16 a[128:129], v14 offset:32768
    v_mfma_f32_16x16x32_bf16 v[200:203], a[164:167], v[132:135], v[200:203]
    s_waitcnt lgkmcnt(11)
    ds_read_b64_tr_b16 a[130:131], v14 offset:36864
    v_mfma_f32_16x16x32_bf16 v[200:203], a[168:171], v[136:139], v[200:203]
    s_waitcnt lgkmcnt(10)
    ds_read_b64_tr_b16 a[132:133], v14 offset:40960
    v_mfma_f32_16x16x32_bf16 v[200:203], a[172:175], v[140:143], v[200:203]
    s_waitcnt lgkmcnt(9)
    ds_read_b64_tr_b16 a[134:135], v14 offset:45056
    v_mfma_f32_16x16x32_bf16 v[200:203], a[176:179], v[144:147], v[200:203]
    s_waitcnt lgkmcnt(8)
    ds_read_b64_tr_b16 a[136:137], v14 offset:49152
    v_cvt_pk_bf16_f32 v228, v196, v197
    v_mfma_f32_16x16x32_bf16 v[200:203], a[180:183], v[148:151], v[200:203]
    s_waitcnt lgkmcnt(7)
    ds_read_b64_tr_b16 a[138:139], v14 offset:53248
    v_cvt_pk_bf16_f32 v229, v198, v199
    v_mfma_f32_16x16x32_bf16 v[200:203], a[184:187], v[152:155], v[200:203]
    s_waitcnt lgkmcnt(6)
    ds_read_b64_tr_b16 a[140:141], v14 offset:57344
    v_mfma_f32_16x16x32_bf16 v[200:203], a[188:191], v[156:159], v[200:203]
    ds_read_b64_tr_b16 a[142:143], v14 offset:61440
    v_mfma_f32_16x16x32_bf16 v[204:207], a[160:163], v[160:163], 0
    ds_read_b64_tr_b16 a[144:145], v18 offset:32768
    v_mfma_f32_16x16x32_bf16 v[204:207], a[164:167], v[164:167], v[204:207]
    ds_read_b64_tr_b16 a[146:147], v18 offset:36864
    v_mfma_f32_16x16x32_bf16 v[204:207], a[168:171], v[168:171], v[204:207]
    ds_read_b64_tr_b16 a[148:149], v18 offset:40960
    v_mfma_f32_16x16x32_bf16 v[204:207], a[172:175], v[172:175], v[204:207]
    ds_read_b64_tr_b16 a[150:151], v18 offset:45056
    v_mfma_f32_16x16x32_bf16 v[204:207], a[176:179], v[176:179], v[204:207]
    ds_read_b64_tr_b16 a[152:153], v18 offset:49152
    v_cvt_pk_bf16_f32 v226, v200, v201
    v_mfma_f32_16x16x32_bf16 v[204:207], a[180:183], v[180:183], v[204:207]
    s_add_u32 s38, s47, 2048
    ds_read_b64_tr_b16 a[154:155], v18 offset:53248
    v_cvt_pk_bf16_f32 v227, v202, v203
    v_mfma_f32_16x16x32_bf16 v[204:207], a[184:187], v[184:187], v[204:207]
    ds_read_b64_tr_b16 a[156:157], v18 offset:57344
    buffer_store_dwordx4 v[224:227], v56, s[28:31], s38 offen sc1
    v_mfma_f32_16x16x32_bf16 v[204:207], a[188:191], v[188:191], v[204:207]
    s_waitcnt lgkmcnt(13)
    ds_read_b64_tr_b16 a[158:159], v18 offset:61440
    v_mfma_f32_16x16x32_bf16 v[192:195], a[128:131], v[128:131], 0
    s_waitcnt lgkmcnt(12)
    ds_read_b64_tr_b16 a[160:161], v15 offset:32768
    v_mfma_f32_16x16x32_bf16 v[192:195], a[132:135], v[132:135], v[192:195]
    s_waitcnt lgkmcnt(11)
    ds_read_b64_tr_b16 a[162:163], v15 offset:36864
    v_mfma_f32_16x16x32_bf16 v[192:195], a[136:139], v[136:139], v[192:195]
    s_waitcnt lgkmcnt(10)
    ds_read_b64_tr_b16 a[164:165], v15 offset:40960
    v_mfma_f32_16x16x32_bf16 v[192:195], a[140:143], v[140:143], v[192:195]
    s_waitcnt lgkmcnt(9)
    ds_read_b64_tr_b16 a[166:167], v15 offset:45056
    v_mfma_f32_16x16x32_bf16 v[192:195], a[144:147], v[144:147], v[192:195]
    s_waitcnt lgkmcnt(8)
    ds_read_b64_tr_b16 a[168:169], v15 offset:49152
    v_cvt_pk_bf16_f32 v230, v204, v205
    v_mfma_f32_16x16x32_bf16 v[192:195], a[148:151], v[148:151], v[192:195]
    s_waitcnt lgkmcnt(7)
    s_add_u32 s38, s47, 296960
    ds_read_b64_tr_b16 a[170:171], v15 offset:53248
    v_cvt_pk_bf16_f32 v231, v206, v207
    v_mfma_f32_16x16x32_bf16 v[192:195], a[152:155], v[152:155], v[192:195]
    s_waitcnt lgkmcnt(6)
    ds_read_b64_tr_b16 a[172:173], v15 offset:57344
    buffer_store_dwordx4 v[228:231], v56, s[28:31], s38 offen sc1
    v_mfma_f32_16x16x32_bf16 v[192:195], a[156:159], v[156:159], v[192:195]
    ds_read_b64_tr_b16 a[174:175], v15 offset:61440
    v_mfma_f32_16x16x32_bf16 v[196:199], a[128:131], v[160:163], 0
    ds_read_b64_tr_b16 a[176:177], v19 offset:32768
    v_mfma_f32_16x16x32_bf16 v[196:199], a[132:135], v[164:167], v[196:199]
    ds_read_b64_tr_b16 a[178:179], v19 offset:36864
    v_mfma_f32_16x16x32_bf16 v[196:199], a[136:139], v[168:171], v[196:199]
    ds_read_b64_tr_b16 a[180:181], v19 offset:40960
    v_mfma_f32_16x16x32_bf16 v[196:199], a[140:143], v[172:175], v[196:199]
    ds_read_b64_tr_b16 a[182:183], v19 offset:45056
    v_mfma_f32_16x16x32_bf16 v[196:199], a[144:147], v[176:179], v[196:199]
    ds_read_b64_tr_b16 a[184:185], v19 offset:49152
    v_cvt_pk_bf16_f32 v232, v192, v193
    v_mfma_f32_16x16x32_bf16 v[196:199], a[148:151], v[180:183], v[196:199]
    ds_read_b64_tr_b16 a[186:187], v19 offset:53248
    v_cvt_pk_bf16_f32 v233, v194, v195
    v_mfma_f32_16x16x32_bf16 v[196:199], a[152:155], v[184:187], v[196:199]
    ds_read_b64_tr_b16 a[188:189], v19 offset:57344
    v_mfma_f32_16x16x32_bf16 v[196:199], a[156:159], v[188:191], v[196:199]
    s_waitcnt lgkmcnt(13)
    ds_read_b64_tr_b16 a[190:191], v19 offset:61440
    s_waitcnt vmcnt(23)
    s_barrier
    v_mfma_f32_16x16x32_bf16 v[200:203], a[160:163], v[128:131], 0
    s_waitcnt lgkmcnt(12)
    ds_read_b64_tr_b16 a[128:129], v20 offset:0
    v_mfma_f32_16x16x32_bf16 v[200:203], a[164:167], v[132:135], v[200:203]
    s_waitcnt lgkmcnt(11)
    s_add_u32 s49, s45, 768
    ds_read_b64_tr_b16 a[130:131], v20 offset:4096
    v_mfma_f32_16x16x32_bf16 v[200:203], a[168:171], v[136:139], v[200:203]
    s_waitcnt lgkmcnt(10)
    s_add_u32 m0, s42, 0
    ds_read_b64_tr_b16 a[132:133], v20 offset:8192
    v_mfma_f32_16x16x32_bf16 v[200:203], a[172:175], v[140:143], v[200:203]
    s_waitcnt lgkmcnt(9)
    ds_read_b64_tr_b16 a[134:135], v20 offset:12288
    buffer_load_dwordx4 v46, s[20:23], s49 offen lds
    v_mfma_f32_16x16x32_bf16 v[200:203], a[176:179], v[144:147], v[200:203]
    s_waitcnt lgkmcnt(8)
    ds_read_b64_tr_b16 a[136:137], v20 offset:16384
    v_cvt_pk_bf16_f32 v236, v196, v197
    v_mfma_f32_16x16x32_bf16 v[200:203], a[180:183], v[148:151], v[200:203]
    s_waitcnt lgkmcnt(7)
    ds_read_b64_tr_b16 a[138:139], v20 offset:20480
    v_cvt_pk_bf16_f32 v237, v198, v199
    v_mfma_f32_16x16x32_bf16 v[200:203], a[184:187], v[152:155], v[200:203]
    s_waitcnt lgkmcnt(6)
    ds_read_b64_tr_b16 a[140:141], v20 offset:24576
    v_mfma_f32_16x16x32_bf16 v[200:203], a[188:191], v[156:159], v[200:203]
    ds_read_b64_tr_b16 a[142:143], v20 offset:28672
    buffer_load_dwordx4 v47, s[20:23], s49 offen offset:1024 lds
    v_mfma_f32_16x16x32_bf16 v[204:207], a[160:163], v[160:163], 0
    ds_read_b64_tr_b16 a[144:145], v24 offset:0
    v_mfma_f32_16x16x32_bf16 v[204:207], a[164:167], v[164:167], v[204:207]
    ds_read_b64_tr_b16 a[146:147], v24 offset:4096
    v_mfma_f32_16x16x32_bf16 v[204:207], a[168:171], v[168:171], v[204:207]
    ds_read_b64_tr_b16 a[148:149], v24 offset:8192
    v_mfma_f32_16x16x32_bf16 v[204:207], a[172:175], v[172:175], v[204:207]
    ds_read_b64_tr_b16 a[150:151], v24 offset:12288
    buffer_load_dwordx4 v48, s[20:23], s49 offen offset:2048 lds
    v_mfma_f32_16x16x32_bf16 v[204:207], a[176:179], v[176:179], v[204:207]
    ds_read_b64_tr_b16 a[152:153], v24 offset:16384
    v_cvt_pk_bf16_f32 v234, v200, v201
    v_mfma_f32_16x16x32_bf16 v[204:207], a[180:183], v[180:183], v[204:207]
    s_add_u32 s38, s47, 2560
    ds_read_b64_tr_b16 a[154:155], v24 offset:20480
    v_cvt_pk_bf16_f32 v235, v202, v203
    v_mfma_f32_16x16x32_bf16 v[204:207], a[184:187], v[184:187], v[204:207]
    ds_read_b64_tr_b16 a[156:157], v24 offset:24576
    buffer_store_dwordx4 v[232:235], v56, s[28:31], s38 offen sc1
    v_mfma_f32_16x16x32_bf16 v[204:207], a[188:191], v[188:191], v[204:207]
    s_waitcnt lgkmcnt(13)
    ds_read_b64_tr_b16 a[158:159], v24 offset:28672
    buffer_load_dwordx4 v49, s[20:23], s49 offen offset:3072 lds
    v_mfma_f32_16x16x32_bf16 v[192:195], a[128:131], v[128:131], 0
    s_waitcnt lgkmcnt(12)
    ds_read_b64_tr_b16 a[160:161], v21 offset:0
    v_mfma_f32_16x16x32_bf16 v[192:195], a[132:135], v[132:135], v[192:195]
    s_waitcnt lgkmcnt(11)
    s_add_u32 s49, s45, 74496
    ds_read_b64_tr_b16 a[162:163], v21 offset:4096
    v_mfma_f32_16x16x32_bf16 v[192:195], a[136:139], v[136:139], v[192:195]
    s_waitcnt lgkmcnt(10)
    s_add_u32 m0, s42, 16384
    ds_read_b64_tr_b16 a[164:165], v21 offset:8192
    v_mfma_f32_16x16x32_bf16 v[192:195], a[140:143], v[140:143], v[192:195]
    s_waitcnt lgkmcnt(9)
    ds_read_b64_tr_b16 a[166:167], v21 offset:12288
    buffer_load_dwordx4 v46, s[20:23], s49 offen lds
    v_mfma_f32_16x16x32_bf16 v[192:195], a[144:147], v[144:147], v[192:195]
    s_waitcnt lgkmcnt(8)
    ds_read_b64_tr_b16 a[168:169], v21 offset:16384
    v_cvt_pk_bf16_f32 v238, v204, v205
    v_mfma_f32_16x16x32_bf16 v[192:195], a[148:151], v[148:151], v[192:195]
    s_waitcnt lgkmcnt(7)
    s_add_u32 s38, s47, 297472
    ds_read_b64_tr_b16 a[170:171], v21 offset:20480
    v_cvt_pk_bf16_f32 v239, v206, v207
    v_mfma_f32_16x16x32_bf16 v[192:195], a[152:155], v[152:155], v[192:195]
    s_waitcnt lgkmcnt(6)
    ds_read_b64_tr_b16 a[172:173], v21 offset:24576
    buffer_store_dwordx4 v[236:239], v56, s[28:31], s38 offen sc1
    v_mfma_f32_16x16x32_bf16 v[192:195], a[156:159], v[156:159], v[192:195]
    ds_read_b64_tr_b16 a[174:175], v21 offset:28672
    buffer_load_dwordx4 v47, s[20:23], s49 offen offset:1024 lds
    v_mfma_f32_16x16x32_bf16 v[196:199], a[128:131], v[160:163], 0
    ds_read_b64_tr_b16 a[176:177], v25 offset:0
    v_mfma_f32_16x16x32_bf16 v[196:199], a[132:135], v[164:167], v[196:199]
    ds_read_b64_tr_b16 a[178:179], v25 offset:4096
    v_mfma_f32_16x16x32_bf16 v[196:199], a[136:139], v[168:171], v[196:199]
    ds_read_b64_tr_b16 a[180:181], v25 offset:8192
    v_mfma_f32_16x16x32_bf16 v[196:199], a[140:143], v[172:175], v[196:199]
    ds_read_b64_tr_b16 a[182:183], v25 offset:12288
    buffer_load_dwordx4 v48, s[20:23], s49 offen offset:2048 lds
    v_mfma_f32_16x16x32_bf16 v[196:199], a[144:147], v[176:179], v[196:199]
    ds_read_b64_tr_b16 a[184:185], v25 offset:16384
    v_cvt_pk_bf16_f32 v224, v192, v193
    v_mfma_f32_16x16x32_bf16 v[196:199], a[148:151], v[180:183], v[196:199]
    ds_read_b64_tr_b16 a[186:187], v25 offset:20480
    v_cvt_pk_bf16_f32 v225, v194, v195
    v_mfma_f32_16x16x32_bf16 v[196:199], a[152:155], v[184:187], v[196:199]
    ds_read_b64_tr_b16 a[188:189], v25 offset:24576
    v_mfma_f32_16x16x32_bf16 v[196:199], a[156:159], v[188:191], v[196:199]
    s_waitcnt lgkmcnt(13)
    ds_read_b64_tr_b16 a[190:191], v25 offset:28672
    buffer_load_dwordx4 v49, s[20:23], s49 offen offset:3072 lds
    v_mfma_f32_16x16x32_bf16 v[200:203], a[160:163], v[128:131], 0
    s_waitcnt lgkmcnt(12)
    ds_read_b64_tr_b16 a[128:129], v22 offset:0
    v_mfma_f32_16x16x32_bf16 v[200:203], a[164:167], v[132:135], v[200:203]
    s_waitcnt lgkmcnt(11)
    ds_read_b64_tr_b16 a[130:131], v22 offset:4096
    v_mfma_f32_16x16x32_bf16 v[200:203], a[168:171], v[136:139], v[200:203]
    s_waitcnt lgkmcnt(10)
    ds_read_b64_tr_b16 a[132:133], v22 offset:8192
    v_mfma_f32_16x16x32_bf16 v[200:203], a[172:175], v[140:143], v[200:203]
    s_waitcnt lgkmcnt(9)
    ds_read_b64_tr_b16 a[134:135], v22 offset:12288
    v_mfma_f32_16x16x32_bf16 v[200:203], a[176:179], v[144:147], v[200:203]
    s_waitcnt lgkmcnt(8)
    ds_read_b64_tr_b16 a[136:137], v22 offset:16384
    v_cvt_pk_bf16_f32 v228, v196, v197
    v_mfma_f32_16x16x32_bf16 v[200:203], a[180:183], v[148:151], v[200:203]
    s_waitcnt lgkmcnt(7)
    ds_read_b64_tr_b16 a[138:139], v22 offset:20480
    v_cvt_pk_bf16_f32 v229, v198, v199
    v_mfma_f32_16x16x32_bf16 v[200:203], a[184:187], v[152:155], v[200:203]
    s_waitcnt lgkmcnt(6)
    ds_read_b64_tr_b16 a[140:141], v22 offset:24576
    v_mfma_f32_16x16x32_bf16 v[200:203], a[188:191], v[156:159], v[200:203]
    ds_read_b64_tr_b16 a[142:143], v22 offset:28672
    v_mfma_f32_16x16x32_bf16 v[204:207], a[160:163], v[160:163], 0
    ds_read_b64_tr_b16 a[144:145], v26 offset:0
    v_mfma_f32_16x16x32_bf16 v[204:207], a[164:167], v[164:167], v[204:207]
    ds_read_b64_tr_b16 a[146:147], v26 offset:4096
    v_mfma_f32_16x16x32_bf16 v[204:207], a[168:171], v[168:171], v[204:207]
    ds_read_b64_tr_b16 a[148:149], v26 offset:8192
    v_mfma_f32_16x16x32_bf16 v[204:207], a[172:175], v[172:175], v[204:207]
    ds_read_b64_tr_b16 a[150:151], v26 offset:12288
    v_mfma_f32_16x16x32_bf16 v[204:207], a[176:179], v[176:179], v[204:207]
    ds_read_b64_tr_b16 a[152:153], v26 offset:16384
    v_cvt_pk_bf16_f32 v226, v200, v201
    v_mfma_f32_16x16x32_bf16 v[204:207], a[180:183], v[180:183], v[204:207]
    s_add_u32 s38, s47, 3072
    ds_read_b64_tr_b16 a[154:155], v26 offset:20480
    v_cvt_pk_bf16_f32 v227, v202, v203
    v_mfma_f32_16x16x32_bf16 v[204:207], a[184:187], v[184:187], v[204:207]
    ds_read_b64_tr_b16 a[156:157], v26 offset:24576
    buffer_store_dwordx4 v[224:227], v56, s[28:31], s38 offen sc1
    v_mfma_f32_16x16x32_bf16 v[204:207], a[188:191], v[188:191], v[204:207]
    s_waitcnt lgkmcnt(13)
    ds_read_b64_tr_b16 a[158:159], v26 offset:28672
    v_mfma_f32_16x16x32_bf16 v[192:195], a[128:131], v[128:131], 0
    s_waitcnt lgkmcnt(12)
    ds_read_b64_tr_b16 a[160:161], v23 offset:0
    v_mfma_f32_16x16x32_bf16 v[192:195], a[132:135], v[132:135], v[192:195]
    s_waitcnt lgkmcnt(11)
    ds_read_b64_tr_b16 a[162:163], v23 offset:4096
    v_mfma_f32_16x16x32_bf16 v[192:195], a[136:139], v[136:139], v[192:195]
    s_waitcnt lgkmcnt(10)
    ds_read_b64_tr_b16 a[164:165], v23 offset:8192
    v_mfma_f32_16x16x32_bf16 v[192:195], a[140:143], v[140:143], v[192:195]
    s_waitcnt lgkmcnt(9)
    ds_read_b64_tr_b16 a[166:167], v23 offset:12288
    v_mfma_f32_16x16x32_bf16 v[192:195], a[144:147], v[144:147], v[192:195]
    s_waitcnt lgkmcnt(8)
    ds_read_b64_tr_b16 a[168:169], v23 offset:16384
    v_cvt_pk_bf16_f32 v230, v204, v205
    v_mfma_f32_16x16x32_bf16 v[192:195], a[148:151], v[148:151], v[192:195]
    s_waitcnt lgkmcnt(7)
    s_add_u32 s38, s47, 297984
    ds_read_b64_tr_b16 a[170:171], v23 offset:20480
    v_cvt_pk_bf16_f32 v231, v206, v207
    v_mfma_f32_16x16x32_bf16 v[192:195], a[152:155], v[152:155], v[192:195]
    s_waitcnt lgkmcnt(6)
    ds_read_b64_tr_b16 a[172:173], v23 offset:24576
    buffer_store_dwordx4 v[228:231], v56, s[28:31], s38 offen sc1
    v_mfma_f32_16x16x32_bf16 v[192:195], a[156:159], v[156:159], v[192:195]
    ds_read_b64_tr_b16 a[174:175], v23 offset:28672
    v_mfma_f32_16x16x32_bf16 v[196:199], a[128:131], v[160:163], 0
    ds_read_b64_tr_b16 a[176:177], v27 offset:0
    v_mfma_f32_16x16x32_bf16 v[196:199], a[132:135], v[164:167], v[196:199]
    ds_read_b64_tr_b16 a[178:179], v27 offset:4096
    v_mfma_f32_16x16x32_bf16 v[196:199], a[136:139], v[168:171], v[196:199]
    ds_read_b64_tr_b16 a[180:181], v27 offset:8192
    v_mfma_f32_16x16x32_bf16 v[196:199], a[140:143], v[172:175], v[196:199]
    ds_read_b64_tr_b16 a[182:183], v27 offset:12288
    v_mfma_f32_16x16x32_bf16 v[196:199], a[144:147], v[176:179], v[196:199]
    ds_read_b64_tr_b16 a[184:185], v27 offset:16384
    v_cvt_pk_bf16_f32 v232, v192, v193
    v_mfma_f32_16x16x32_bf16 v[196:199], a[148:151], v[180:183], v[196:199]
    ds_read_b64_tr_b16 a[186:187], v27 offset:20480
    v_cvt_pk_bf16_f32 v233, v194, v195
    v_mfma_f32_16x16x32_bf16 v[196:199], a[152:155], v[184:187], v[196:199]
    ds_read_b64_tr_b16 a[188:189], v27 offset:24576
    v_mfma_f32_16x16x32_bf16 v[196:199], a[156:159], v[188:191], v[196:199]
    s_waitcnt lgkmcnt(13)
    ds_read_b64_tr_b16 a[190:191], v27 offset:28672
    s_waitcnt vmcnt(25)
    s_barrier
    v_mfma_f32_16x16x32_bf16 v[200:203], a[160:163], v[128:131], 0
    s_waitcnt lgkmcnt(12)
    ds_read_b64_tr_b16 a[128:129], v20 offset:32768
    v_mfma_f32_16x16x32_bf16 v[200:203], a[164:167], v[132:135], v[200:203]
    s_waitcnt lgkmcnt(11)
    s_add_u32 s49, s45, 896
    ds_read_b64_tr_b16 a[130:131], v20 offset:36864
    v_mfma_f32_16x16x32_bf16 v[200:203], a[168:171], v[136:139], v[200:203]
    s_waitcnt lgkmcnt(10)
    s_add_u32 m0, s42, 32768
    ds_read_b64_tr_b16 a[132:133], v20 offset:40960
    v_mfma_f32_16x16x32_bf16 v[200:203], a[172:175], v[140:143], v[200:203]
    s_waitcnt lgkmcnt(9)
    ds_read_b64_tr_b16 a[134:135], v20 offset:45056
    buffer_load_dwordx4 v46, s[20:23], s49 offen lds
    v_mfma_f32_16x16x32_bf16 v[200:203], a[176:179], v[144:147], v[200:203]
    s_waitcnt lgkmcnt(8)
    ds_read_b64_tr_b16 a[136:137], v20 offset:49152
    v_cvt_pk_bf16_f32 v236, v196, v197
    v_mfma_f32_16x16x32_bf16 v[200:203], a[180:183], v[148:151], v[200:203]
    s_waitcnt lgkmcnt(7)
    ds_read_b64_tr_b16 a[138:139], v20 offset:53248
    v_cvt_pk_bf16_f32 v237, v198, v199
    v_mfma_f32_16x16x32_bf16 v[200:203], a[184:187], v[152:155], v[200:203]
    s_waitcnt lgkmcnt(6)
    ds_read_b64_tr_b16 a[140:141], v20 offset:57344
    v_mfma_f32_16x16x32_bf16 v[200:203], a[188:191], v[156:159], v[200:203]
    ds_read_b64_tr_b16 a[142:143], v20 offset:61440
    buffer_load_dwordx4 v47, s[20:23], s49 offen offset:1024 lds
    v_mfma_f32_16x16x32_bf16 v[204:207], a[160:163], v[160:163], 0
    ds_read_b64_tr_b16 a[144:145], v24 offset:32768
    v_mfma_f32_16x16x32_bf16 v[204:207], a[164:167], v[164:167], v[204:207]
    ds_read_b64_tr_b16 a[146:147], v24 offset:36864
    v_mfma_f32_16x16x32_bf16 v[204:207], a[168:171], v[168:171], v[204:207]
    ds_read_b64_tr_b16 a[148:149], v24 offset:40960
    v_mfma_f32_16x16x32_bf16 v[204:207], a[172:175], v[172:175], v[204:207]
    ds_read_b64_tr_b16 a[150:151], v24 offset:45056
    buffer_load_dwordx4 v48, s[20:23], s49 offen offset:2048 lds
    v_mfma_f32_16x16x32_bf16 v[204:207], a[176:179], v[176:179], v[204:207]
    ds_read_b64_tr_b16 a[152:153], v24 offset:49152
    v_cvt_pk_bf16_f32 v234, v200, v201
    v_mfma_f32_16x16x32_bf16 v[204:207], a[180:183], v[180:183], v[204:207]
    s_add_u32 s38, s47, 3584
    ds_read_b64_tr_b16 a[154:155], v24 offset:53248
    v_cvt_pk_bf16_f32 v235, v202, v203
    v_mfma_f32_16x16x32_bf16 v[204:207], a[184:187], v[184:187], v[204:207]
    ds_read_b64_tr_b16 a[156:157], v24 offset:57344
    buffer_store_dwordx4 v[232:235], v56, s[28:31], s38 offen sc1
    v_mfma_f32_16x16x32_bf16 v[204:207], a[188:191], v[188:191], v[204:207]
    s_waitcnt lgkmcnt(13)
    ds_read_b64_tr_b16 a[158:159], v24 offset:61440
    buffer_load_dwordx4 v49, s[20:23], s49 offen offset:3072 lds
    v_mfma_f32_16x16x32_bf16 v[192:195], a[128:131], v[128:131], 0
    s_waitcnt lgkmcnt(12)
    ds_read_b64_tr_b16 a[160:161], v21 offset:32768
    v_mfma_f32_16x16x32_bf16 v[192:195], a[132:135], v[132:135], v[192:195]
    s_waitcnt lgkmcnt(11)
    s_add_u32 s49, s45, 74624
    ds_read_b64_tr_b16 a[162:163], v21 offset:36864
    v_mfma_f32_16x16x32_bf16 v[192:195], a[136:139], v[136:139], v[192:195]
    s_waitcnt lgkmcnt(10)
    s_add_u32 m0, s42, 49152
    ds_read_b64_tr_b16 a[164:165], v21 offset:40960
    v_mfma_f32_16x16x32_bf16 v[192:195], a[140:143], v[140:143], v[192:195]
    s_waitcnt lgkmcnt(9)
    ds_read_b64_tr_b16 a[166:167], v21 offset:45056
    buffer_load_dwordx4 v46, s[20:23], s49 offen lds
    v_mfma_f32_16x16x32_bf16 v[192:195], a[144:147], v[144:147], v[192:195]
    s_waitcnt lgkmcnt(8)
    ds_read_b64_tr_b16 a[168:169], v21 offset:49152
    v_cvt_pk_bf16_f32 v238, v204, v205
    v_mfma_f32_16x16x32_bf16 v[192:195], a[148:151], v[148:151], v[192:195]
    s_waitcnt lgkmcnt(7)
    s_add_u32 s38, s47, 298496
    ds_read_b64_tr_b16 a[170:171], v21 offset:53248
    v_cvt_pk_bf16_f32 v239, v206, v207
    v_mfma_f32_16x16x32_bf16 v[192:195], a[152:155], v[152:155], v[192:195]
    s_waitcnt lgkmcnt(6)
    ds_read_b64_tr_b16 a[172:173], v21 offset:57344
    buffer_store_dwordx4 v[236:239], v56, s[28:31], s38 offen sc1
    v_mfma_f32_16x16x32_bf16 v[192:195], a[156:159], v[156:159], v[192:195]
    ds_read_b64_tr_b16 a[174:175], v21 offset:61440
    buffer_load_dwordx4 v47, s[20:23], s49 offen offset:1024 lds
    v_mfma_f32_16x16x32_bf16 v[196:199], a[128:131], v[160:163], 0
    ds_read_b64_tr_b16 a[176:177], v25 offset:32768
    v_mfma_f32_16x16x32_bf16 v[196:199], a[132:135], v[164:167], v[196:199]
    ds_read_b64_tr_b16 a[178:179], v25 offset:36864
    v_mfma_f32_16x16x32_bf16 v[196:199], a[136:139], v[168:171], v[196:199]
    ds_read_b64_tr_b16 a[180:181], v25 offset:40960
    v_mfma_f32_16x16x32_bf16 v[196:199], a[140:143], v[172:175], v[196:199]
    ds_read_b64_tr_b16 a[182:183], v25 offset:45056
    buffer_load_dwordx4 v48, s[20:23], s49 offen offset:2048 lds
    v_mfma_f32_16x16x32_bf16 v[196:199], a[144:147], v[176:179], v[196:199]
    ds_read_b64_tr_b16 a[184:185], v25 offset:49152
    v_cvt_pk_bf16_f32 v224, v192, v193
    v_mfma_f32_16x16x32_bf16 v[196:199], a[148:151], v[180:183], v[196:199]
    ds_read_b64_tr_b16 a[186:187], v25 offset:53248
    v_cvt_pk_bf16_f32 v225, v194, v195
    v_mfma_f32_16x16x32_bf16 v[196:199], a[152:155], v[184:187], v[196:199]
    ds_read_b64_tr_b16 a[188:189], v25 offset:57344
    v_mfma_f32_16x16x32_bf16 v[196:199], a[156:159], v[188:191], v[196:199]
    s_waitcnt lgkmcnt(13)
    ds_read_b64_tr_b16 a[190:191], v25 offset:61440
    buffer_load_dwordx4 v49, s[20:23], s49 offen offset:3072 lds
    v_mfma_f32_16x16x32_bf16 v[200:203], a[160:163], v[128:131], 0
    s_waitcnt lgkmcnt(12)
    ds_read_b64_tr_b16 a[128:129], v22 offset:32768
    v_mfma_f32_16x16x32_bf16 v[200:203], a[164:167], v[132:135], v[200:203]
    s_waitcnt lgkmcnt(11)
    ds_read_b64_tr_b16 a[130:131], v22 offset:36864
    v_mfma_f32_16x16x32_bf16 v[200:203], a[168:171], v[136:139], v[200:203]
    s_waitcnt lgkmcnt(10)
    ds_read_b64_tr_b16 a[132:133], v22 offset:40960
    v_mfma_f32_16x16x32_bf16 v[200:203], a[172:175], v[140:143], v[200:203]
    s_waitcnt lgkmcnt(9)
    ds_read_b64_tr_b16 a[134:135], v22 offset:45056
    v_mfma_f32_16x16x32_bf16 v[200:203], a[176:179], v[144:147], v[200:203]
    s_waitcnt lgkmcnt(8)
    ds_read_b64_tr_b16 a[136:137], v22 offset:49152
    v_cvt_pk_bf16_f32 v228, v196, v197
    v_mfma_f32_16x16x32_bf16 v[200:203], a[180:183], v[148:151], v[200:203]
    s_waitcnt lgkmcnt(7)
    ds_read_b64_tr_b16 a[138:139], v22 offset:53248
    v_cvt_pk_bf16_f32 v229, v198, v199
    v_mfma_f32_16x16x32_bf16 v[200:203], a[184:187], v[152:155], v[200:203]
    s_waitcnt lgkmcnt(6)
    ds_read_b64_tr_b16 a[140:141], v22 offset:57344
    v_mfma_f32_16x16x32_bf16 v[200:203], a[188:191], v[156:159], v[200:203]
    ds_read_b64_tr_b16 a[142:143], v22 offset:61440
    v_mfma_f32_16x16x32_bf16 v[204:207], a[160:163], v[160:163], 0
    ds_read_b64_tr_b16 a[144:145], v26 offset:32768
    v_mfma_f32_16x16x32_bf16 v[204:207], a[164:167], v[164:167], v[204:207]
    ds_read_b64_tr_b16 a[146:147], v26 offset:36864
    v_mfma_f32_16x16x32_bf16 v[204:207], a[168:171], v[168:171], v[204:207]
    ds_read_b64_tr_b16 a[148:149], v26 offset:40960
    v_mfma_f32_16x16x32_bf16 v[204:207], a[172:175], v[172:175], v[204:207]
    ds_read_b64_tr_b16 a[150:151], v26 offset:45056
    v_mfma_f32_16x16x32_bf16 v[204:207], a[176:179], v[176:179], v[204:207]
    ds_read_b64_tr_b16 a[152:153], v26 offset:49152
    v_cvt_pk_bf16_f32 v226, v200, v201
    v_mfma_f32_16x16x32_bf16 v[204:207], a[180:183], v[180:183], v[204:207]
    s_add_u32 s38, s47, 4096
    ds_read_b64_tr_b16 a[154:155], v26 offset:53248
    v_cvt_pk_bf16_f32 v227, v202, v203
    v_mfma_f32_16x16x32_bf16 v[204:207], a[184:187], v[184:187], v[204:207]
    ds_read_b64_tr_b16 a[156:157], v26 offset:57344
    buffer_store_dwordx4 v[224:227], v56, s[28:31], s38 offen sc1
    v_mfma_f32_16x16x32_bf16 v[204:207], a[188:191], v[188:191], v[204:207]
    s_waitcnt lgkmcnt(13)
    ds_read_b64_tr_b16 a[158:159], v26 offset:61440
    v_mfma_f32_16x16x32_bf16 v[192:195], a[128:131], v[128:131], 0
    s_waitcnt lgkmcnt(12)
    ds_read_b64_tr_b16 a[160:161], v23 offset:32768
    v_mfma_f32_16x16x32_bf16 v[192:195], a[132:135], v[132:135], v[192:195]
    s_waitcnt lgkmcnt(11)
    ds_read_b64_tr_b16 a[162:163], v23 offset:36864
    v_mfma_f32_16x16x32_bf16 v[192:195], a[136:139], v[136:139], v[192:195]
    s_waitcnt lgkmcnt(10)
    ds_read_b64_tr_b16 a[164:165], v23 offset:40960
    v_mfma_f32_16x16x32_bf16 v[192:195], a[140:143], v[140:143], v[192:195]
    s_waitcnt lgkmcnt(9)
    ds_read_b64_tr_b16 a[166:167], v23 offset:45056
    v_mfma_f32_16x16x32_bf16 v[192:195], a[144:147], v[144:147], v[192:195]
    s_waitcnt lgkmcnt(8)
    ds_read_b64_tr_b16 a[168:169], v23 offset:49152
    v_cvt_pk_bf16_f32 v230, v204, v205
    v_mfma_f32_16x16x32_bf16 v[192:195], a[148:151], v[148:151], v[192:195]
    s_waitcnt lgkmcnt(7)
    s_add_u32 s38, s47, 299008
    ds_read_b64_tr_b16 a[170:171], v23 offset:53248
    v_cvt_pk_bf16_f32 v231, v206, v207
    v_mfma_f32_16x16x32_bf16 v[192:195], a[152:155], v[152:155], v[192:195]
    s_waitcnt lgkmcnt(6)
    ds_read_b64_tr_b16 a[172:173], v23 offset:57344
    buffer_store_dwordx4 v[228:231], v56, s[28:31], s38 offen sc1
    v_mfma_f32_16x16x32_bf16 v[192:195], a[156:159], v[156:159], v[192:195]
    ds_read_b64_tr_b16 a[174:175], v23 offset:61440
    v_mfma_f32_16x16x32_bf16 v[196:199], a[128:131], v[160:163], 0
    ds_read_b64_tr_b16 a[176:177], v27 offset:32768
    v_mfma_f32_16x16x32_bf16 v[196:199], a[132:135], v[164:167], v[196:199]
    ds_read_b64_tr_b16 a[178:179], v27 offset:36864
    v_mfma_f32_16x16x32_bf16 v[196:199], a[136:139], v[168:171], v[196:199]
    ds_read_b64_tr_b16 a[180:181], v27 offset:40960
    v_mfma_f32_16x16x32_bf16 v[196:199], a[140:143], v[172:175], v[196:199]
    ds_read_b64_tr_b16 a[182:183], v27 offset:45056
    v_mfma_f32_16x16x32_bf16 v[196:199], a[144:147], v[176:179], v[196:199]
    ds_read_b64_tr_b16 a[184:185], v27 offset:49152
    v_cvt_pk_bf16_f32 v232, v192, v193
    v_mfma_f32_16x16x32_bf16 v[196:199], a[148:151], v[180:183], v[196:199]
    ds_read_b64_tr_b16 a[186:187], v27 offset:53248
    v_cvt_pk_bf16_f32 v233, v194, v195
    v_mfma_f32_16x16x32_bf16 v[196:199], a[152:155], v[184:187], v[196:199]
    ds_read_b64_tr_b16 a[188:189], v27 offset:57344
    v_mfma_f32_16x16x32_bf16 v[196:199], a[156:159], v[188:191], v[196:199]
    s_waitcnt lgkmcnt(13)
    ds_read_b64_tr_b16 a[190:191], v27 offset:61440
    s_waitcnt vmcnt(26)
    s_barrier
    v_mfma_f32_16x16x32_bf16 v[200:203], a[160:163], v[128:131], 0
    s_waitcnt lgkmcnt(12)
    ds_read_b64_tr_b16 a[128:129], v28 offset:0
    v_mfma_f32_16x16x32_bf16 v[200:203], a[164:167], v[132:135], v[200:203]
    s_waitcnt lgkmcnt(11)
    s_add_u32 s49, s45, 1024
    ds_read_b64_tr_b16 a[130:131], v28 offset:4096
    v_mfma_f32_16x16x32_bf16 v[200:203], a[168:171], v[136:139], v[200:203]
    s_waitcnt lgkmcnt(10)
    s_add_u32 m0, s42, 65536
    ds_read_b64_tr_b16 a[132:133], v28 offset:8192
    v_mfma_f32_16x16x32_bf16 v[200:203], a[172:175], v[140:143], v[200:203]
    s_waitcnt lgkmcnt(9)
    ds_read_b64_tr_b16 a[134:135], v28 offset:12288
    buffer_load_dwordx4 v46, s[20:23], s49 offen lds
    v_mfma_f32_16x16x32_bf16 v[200:203], a[176:179], v[144:147], v[200:203]
    s_waitcnt lgkmcnt(8)
    ds_read_b64_tr_b16 a[136:137], v28 offset:16384
    v_cvt_pk_bf16_f32 v236, v196, v197
    v_mfma_f32_16x16x32_bf16 v[200:203], a[180:183], v[148:151], v[200:203]
    s_waitcnt lgkmcnt(7)
    ds_read_b64_tr_b16 a[138:139], v28 offset:20480
    v_cvt_pk_bf16_f32 v237, v198, v199
    v_mfma_f32_16x16x32_bf16 v[200:203], a[184:187], v[152:155], v[200:203]
    s_waitcnt lgkmcnt(6)
    ds_read_b64_tr_b16 a[140:141], v28 offset:24576
    v_mfma_f32_16x16x32_bf16 v[200:203], a[188:191], v[156:159], v[200:203]
    ds_read_b64_tr_b16 a[142:143], v28 offset:28672
    buffer_load_dwordx4 v47, s[20:23], s49 offen offset:1024 lds
    v_mfma_f32_16x16x32_bf16 v[204:207], a[160:163], v[160:163], 0
    ds_read_b64_tr_b16 a[144:145], v32 offset:0
    v_mfma_f32_16x16x32_bf16 v[204:207], a[164:167], v[164:167], v[204:207]
    ds_read_b64_tr_b16 a[146:147], v32 offset:4096
    v_mfma_f32_16x16x32_bf16 v[204:207], a[168:171], v[168:171], v[204:207]
    ds_read_b64_tr_b16 a[148:149], v32 offset:8192
    v_mfma_f32_16x16x32_bf16 v[204:207], a[172:175], v[172:175], v[204:207]
    ds_read_b64_tr_b16 a[150:151], v32 offset:12288
    buffer_load_dwordx4 v48, s[20:23], s49 offen offset:2048 lds
    v_mfma_f32_16x16x32_bf16 v[204:207], a[176:179], v[176:179], v[204:207]
    ds_read_b64_tr_b16 a[152:153], v32 offset:16384
    v_cvt_pk_bf16_f32 v234, v200, v201
    v_mfma_f32_16x16x32_bf16 v[204:207], a[180:183], v[180:183], v[204:207]
    s_add_u32 s38, s47, 4608
    ds_read_b64_tr_b16 a[154:155], v32 offset:20480
    v_cvt_pk_bf16_f32 v235, v202, v203
    v_mfma_f32_16x16x32_bf16 v[204:207], a[184:187], v[184:187], v[204:207]
    ds_read_b64_tr_b16 a[156:157], v32 offset:24576
    buffer_store_dwordx4 v[232:235], v56, s[28:31], s38 offen sc1
    v_mfma_f32_16x16x32_bf16 v[204:207], a[188:191], v[188:191], v[204:207]
    s_waitcnt lgkmcnt(13)
    ds_read_b64_tr_b16 a[158:159], v32 offset:28672
    buffer_load_dwordx4 v49, s[20:23], s49 offen offset:3072 lds
    v_mfma_f32_16x16x32_bf16 v[192:195], a[128:131], v[128:131], 0
    s_waitcnt lgkmcnt(12)
    ds_read_b64_tr_b16 a[160:161], v29 offset:0
    v_mfma_f32_16x16x32_bf16 v[192:195], a[132:135], v[132:135], v[192:195]
    s_waitcnt lgkmcnt(11)
    s_add_u32 s49, s45, 74752
    ds_read_b64_tr_b16 a[162:163], v29 offset:4096
    v_mfma_f32_16x16x32_bf16 v[192:195], a[136:139], v[136:139], v[192:195]
    s_waitcnt lgkmcnt(10)
    s_add_u32 m0, s42, 81920
    ds_read_b64_tr_b16 a[164:165], v29 offset:8192
    v_mfma_f32_16x16x32_bf16 v[192:195], a[140:143], v[140:143], v[192:195]
    s_waitcnt lgkmcnt(9)
    ds_read_b64_tr_b16 a[166:167], v29 offset:12288
    buffer_load_dwordx4 v46, s[20:23], s49 offen lds
    v_mfma_f32_16x16x32_bf16 v[192:195], a[144:147], v[144:147], v[192:195]
    s_waitcnt lgkmcnt(8)
    ds_read_b64_tr_b16 a[168:169], v29 offset:16384
    v_cvt_pk_bf16_f32 v238, v204, v205
    v_mfma_f32_16x16x32_bf16 v[192:195], a[148:151], v[148:151], v[192:195]
    s_waitcnt lgkmcnt(7)
    s_add_u32 s38, s47, 299520
    ds_read_b64_tr_b16 a[170:171], v29 offset:20480
    v_cvt_pk_bf16_f32 v239, v206, v207
    v_mfma_f32_16x16x32_bf16 v[192:195], a[152:155], v[152:155], v[192:195]
    s_waitcnt lgkmcnt(6)
    ds_read_b64_tr_b16 a[172:173], v29 offset:24576
    buffer_store_dwordx4 v[236:239], v56, s[28:31], s38 offen sc1
    v_mfma_f32_16x16x32_bf16 v[192:195], a[156:159], v[156:159], v[192:195]
    ds_read_b64_tr_b16 a[174:175], v29 offset:28672
    buffer_load_dwordx4 v47, s[20:23], s49 offen offset:1024 lds
    v_mfma_f32_16x16x32_bf16 v[196:199], a[128:131], v[160:163], 0
    ds_read_b64_tr_b16 a[176:177], v33 offset:0
    v_mfma_f32_16x16x32_bf16 v[196:199], a[132:135], v[164:167], v[196:199]
    ds_read_b64_tr_b16 a[178:179], v33 offset:4096
    v_mfma_f32_16x16x32_bf16 v[196:199], a[136:139], v[168:171], v[196:199]
    ds_read_b64_tr_b16 a[180:181], v33 offset:8192
    v_mfma_f32_16x16x32_bf16 v[196:199], a[140:143], v[172:175], v[196:199]
    ds_read_b64_tr_b16 a[182:183], v33 offset:12288
    buffer_load_dwordx4 v48, s[20:23], s49 offen offset:2048 lds
    v_mfma_f32_16x16x32_bf16 v[196:199], a[144:147], v[176:179], v[196:199]
    ds_read_b64_tr_b16 a[184:185], v33 offset:16384
    v_cvt_pk_bf16_f32 v224, v192, v193
    v_mfma_f32_16x16x32_bf16 v[196:199], a[148:151], v[180:183], v[196:199]
    ds_read_b64_tr_b16 a[186:187], v33 offset:20480
    v_cvt_pk_bf16_f32 v225, v194, v195
    v_mfma_f32_16x16x32_bf16 v[196:199], a[152:155], v[184:187], v[196:199]
    ds_read_b64_tr_b16 a[188:189], v33 offset:24576
    v_mfma_f32_16x16x32_bf16 v[196:199], a[156:159], v[188:191], v[196:199]
    s_waitcnt lgkmcnt(13)
    ds_read_b64_tr_b16 a[190:191], v33 offset:28672
    buffer_load_dwordx4 v49, s[20:23], s49 offen offset:3072 lds
    v_mfma_f32_16x16x32_bf16 v[200:203], a[160:163], v[128:131], 0
    s_waitcnt lgkmcnt(12)
    ds_read_b64_tr_b16 a[128:129], v30 offset:0
    v_mfma_f32_16x16x32_bf16 v[200:203], a[164:167], v[132:135], v[200:203]
    s_waitcnt lgkmcnt(11)
    ds_read_b64_tr_b16 a[130:131], v30 offset:4096
    v_mfma_f32_16x16x32_bf16 v[200:203], a[168:171], v[136:139], v[200:203]
    s_waitcnt lgkmcnt(10)
    ds_read_b64_tr_b16 a[132:133], v30 offset:8192
    v_mfma_f32_16x16x32_bf16 v[200:203], a[172:175], v[140:143], v[200:203]
    s_waitcnt lgkmcnt(9)
    ds_read_b64_tr_b16 a[134:135], v30 offset:12288
    v_mfma_f32_16x16x32_bf16 v[200:203], a[176:179], v[144:147], v[200:203]
    s_waitcnt lgkmcnt(8)
    ds_read_b64_tr_b16 a[136:137], v30 offset:16384
    v_cvt_pk_bf16_f32 v228, v196, v197
    v_mfma_f32_16x16x32_bf16 v[200:203], a[180:183], v[148:151], v[200:203]
    s_waitcnt lgkmcnt(7)
    ds_read_b64_tr_b16 a[138:139], v30 offset:20480
    v_cvt_pk_bf16_f32 v229, v198, v199
    v_mfma_f32_16x16x32_bf16 v[200:203], a[184:187], v[152:155], v[200:203]
    s_waitcnt lgkmcnt(6)
    ds_read_b64_tr_b16 a[140:141], v30 offset:24576
    v_mfma_f32_16x16x32_bf16 v[200:203], a[188:191], v[156:159], v[200:203]
    ds_read_b64_tr_b16 a[142:143], v30 offset:28672
    v_mfma_f32_16x16x32_bf16 v[204:207], a[160:163], v[160:163], 0
    ds_read_b64_tr_b16 a[144:145], v34 offset:0
    v_mfma_f32_16x16x32_bf16 v[204:207], a[164:167], v[164:167], v[204:207]
    ds_read_b64_tr_b16 a[146:147], v34 offset:4096
    v_mfma_f32_16x16x32_bf16 v[204:207], a[168:171], v[168:171], v[204:207]
    ds_read_b64_tr_b16 a[148:149], v34 offset:8192
    v_mfma_f32_16x16x32_bf16 v[204:207], a[172:175], v[172:175], v[204:207]
    ds_read_b64_tr_b16 a[150:151], v34 offset:12288
    v_mfma_f32_16x16x32_bf16 v[204:207], a[176:179], v[176:179], v[204:207]
    ds_read_b64_tr_b16 a[152:153], v34 offset:16384
    v_cvt_pk_bf16_f32 v226, v200, v201
    v_mfma_f32_16x16x32_bf16 v[204:207], a[180:183], v[180:183], v[204:207]
    s_add_u32 s38, s47, 5120
    ds_read_b64_tr_b16 a[154:155], v34 offset:20480
    v_cvt_pk_bf16_f32 v227, v202, v203
    v_mfma_f32_16x16x32_bf16 v[204:207], a[184:187], v[184:187], v[204:207]
    ds_read_b64_tr_b16 a[156:157], v34 offset:24576
    buffer_store_dwordx4 v[224:227], v56, s[28:31], s38 offen sc1
    v_mfma_f32_16x16x32_bf16 v[204:207], a[188:191], v[188:191], v[204:207]
    s_waitcnt lgkmcnt(13)
    ds_read_b64_tr_b16 a[158:159], v34 offset:28672
    v_mfma_f32_16x16x32_bf16 v[192:195], a[128:131], v[128:131], 0
    s_waitcnt lgkmcnt(12)
    ds_read_b64_tr_b16 a[160:161], v31 offset:0
    v_mfma_f32_16x16x32_bf16 v[192:195], a[132:135], v[132:135], v[192:195]
    s_waitcnt lgkmcnt(11)
    ds_read_b64_tr_b16 a[162:163], v31 offset:4096
    v_mfma_f32_16x16x32_bf16 v[192:195], a[136:139], v[136:139], v[192:195]
    s_waitcnt lgkmcnt(10)
    ds_read_b64_tr_b16 a[164:165], v31 offset:8192
    v_mfma_f32_16x16x32_bf16 v[192:195], a[140:143], v[140:143], v[192:195]
    s_waitcnt lgkmcnt(9)
    ds_read_b64_tr_b16 a[166:167], v31 offset:12288
    v_mfma_f32_16x16x32_bf16 v[192:195], a[144:147], v[144:147], v[192:195]
    s_waitcnt lgkmcnt(8)
    ds_read_b64_tr_b16 a[168:169], v31 offset:16384
    v_cvt_pk_bf16_f32 v230, v204, v205
    v_mfma_f32_16x16x32_bf16 v[192:195], a[148:151], v[148:151], v[192:195]
    s_waitcnt lgkmcnt(7)
    s_add_u32 s38, s47, 300032
    ds_read_b64_tr_b16 a[170:171], v31 offset:20480
    v_cvt_pk_bf16_f32 v231, v206, v207
    v_mfma_f32_16x16x32_bf16 v[192:195], a[152:155], v[152:155], v[192:195]
    s_waitcnt lgkmcnt(6)
    ds_read_b64_tr_b16 a[172:173], v31 offset:24576
    buffer_store_dwordx4 v[228:231], v56, s[28:31], s38 offen sc1
    v_mfma_f32_16x16x32_bf16 v[192:195], a[156:159], v[156:159], v[192:195]
    ds_read_b64_tr_b16 a[174:175], v31 offset:28672
    v_mfma_f32_16x16x32_bf16 v[196:199], a[128:131], v[160:163], 0
    ds_read_b64_tr_b16 a[176:177], v35 offset:0
    v_mfma_f32_16x16x32_bf16 v[196:199], a[132:135], v[164:167], v[196:199]
    ds_read_b64_tr_b16 a[178:179], v35 offset:4096
    v_mfma_f32_16x16x32_bf16 v[196:199], a[136:139], v[168:171], v[196:199]
    ds_read_b64_tr_b16 a[180:181], v35 offset:8192
    v_mfma_f32_16x16x32_bf16 v[196:199], a[140:143], v[172:175], v[196:199]
    ds_read_b64_tr_b16 a[182:183], v35 offset:12288
    v_mfma_f32_16x16x32_bf16 v[196:199], a[144:147], v[176:179], v[196:199]
    ds_read_b64_tr_b16 a[184:185], v35 offset:16384
    v_cvt_pk_bf16_f32 v232, v192, v193
    v_mfma_f32_16x16x32_bf16 v[196:199], a[148:151], v[180:183], v[196:199]
    ds_read_b64_tr_b16 a[186:187], v35 offset:20480
    v_cvt_pk_bf16_f32 v233, v194, v195
    v_mfma_f32_16x16x32_bf16 v[196:199], a[152:155], v[184:187], v[196:199]
    ds_read_b64_tr_b16 a[188:189], v35 offset:24576
    v_mfma_f32_16x16x32_bf16 v[196:199], a[156:159], v[188:191], v[196:199]
    s_waitcnt lgkmcnt(13)
    ds_read_b64_tr_b16 a[190:191], v35 offset:28672
    s_waitcnt vmcnt(26)
    s_barrier
    v_mfma_f32_16x16x32_bf16 v[200:203], a[160:163], v[128:131], 0
    s_waitcnt lgkmcnt(12)
    ds_read_b64_tr_b16 a[128:129], v12 offset:0
    v_mfma_f32_16x16x32_bf16 v[200:203], a[164:167], v[132:135], v[200:203]
    s_waitcnt lgkmcnt(11)
    ds_read_b64_tr_b16 a[130:131], v12 offset:4096
    v_mfma_f32_16x16x32_bf16 v[200:203], a[168:171], v[136:139], v[200:203]
    s_waitcnt lgkmcnt(10)
    ds_read_b64_tr_b16 a[132:133], v12 offset:8192
    v_mfma_f32_16x16x32_bf16 v[200:203], a[172:175], v[140:143], v[200:203]
    s_waitcnt lgkmcnt(9)
    ds_read_b64_tr_b16 a[134:135], v12 offset:12288
    v_mfma_f32_16x16x32_bf16 v[200:203], a[176:179], v[144:147], v[200:203]
    s_waitcnt lgkmcnt(8)
    ds_read_b64_tr_b16 a[136:137], v12 offset:16384
    v_cvt_pk_bf16_f32 v236, v196, v197
    v_mfma_f32_16x16x32_bf16 v[200:203], a[180:183], v[148:151], v[200:203]
    s_waitcnt lgkmcnt(7)
    ds_read_b64_tr_b16 a[138:139], v12 offset:20480
    v_cvt_pk_bf16_f32 v237, v198, v199
    v_mfma_f32_16x16x32_bf16 v[200:203], a[184:187], v[152:155], v[200:203]
    s_waitcnt lgkmcnt(6)
    ds_read_b64_tr_b16 a[140:141], v12 offset:24576
    v_mfma_f32_16x16x32_bf16 v[200:203], a[188:191], v[156:159], v[200:203]
    ds_read_b64_tr_b16 a[142:143], v12 offset:28672
    v_mfma_f32_16x16x32_bf16 v[204:207], a[160:163], v[160:163], 0
    ds_read_b64_tr_b16 a[144:145], v16 offset:0
    v_mfma_f32_16x16x32_bf16 v[204:207], a[164:167], v[164:167], v[204:207]
    ds_read_b64_tr_b16 a[146:147], v16 offset:4096
    v_mfma_f32_16x16x32_bf16 v[204:207], a[168:171], v[168:171], v[204:207]
    ds_read_b64_tr_b16 a[148:149], v16 offset:8192
    v_mfma_f32_16x16x32_bf16 v[204:207], a[172:175], v[172:175], v[204:207]
    ds_read_b64_tr_b16 a[150:151], v16 offset:12288
    v_mfma_f32_16x16x32_bf16 v[204:207], a[176:179], v[176:179], v[204:207]
    ds_read_b64_tr_b16 a[152:153], v16 offset:16384
    v_cvt_pk_bf16_f32 v234, v200, v201
    v_mfma_f32_16x16x32_bf16 v[204:207], a[180:183], v[180:183], v[204:207]
    s_add_u32 s38, s47, 5632
    ds_read_b64_tr_b16 a[154:155], v16 offset:20480
    v_cvt_pk_bf16_f32 v235, v202, v203
    v_mfma_f32_16x16x32_bf16 v[204:207], a[184:187], v[184:187], v[204:207]
    ds_read_b64_tr_b16 a[156:157], v16 offset:24576
    buffer_store_dwordx4 v[232:235], v56, s[28:31], s38 offen sc1
    v_mfma_f32_16x16x32_bf16 v[204:207], a[188:191], v[188:191], v[204:207]
    s_waitcnt lgkmcnt(13)
    ds_read_b64_tr_b16 a[158:159], v16 offset:28672
    v_mfma_f32_16x16x32_bf16 v[192:195], a[128:131], v[128:131], 0
    s_waitcnt lgkmcnt(12)
    ds_read_b64_tr_b16 a[160:161], v13 offset:0
    v_mfma_f32_16x16x32_bf16 v[192:195], a[132:135], v[132:135], v[192:195]
    s_waitcnt lgkmcnt(11)
    ds_read_b64_tr_b16 a[162:163], v13 offset:4096
    v_mfma_f32_16x16x32_bf16 v[192:195], a[136:139], v[136:139], v[192:195]
    s_waitcnt lgkmcnt(10)
    ds_read_b64_tr_b16 a[164:165], v13 offset:8192
    v_mfma_f32_16x16x32_bf16 v[192:195], a[140:143], v[140:143], v[192:195]
    s_waitcnt lgkmcnt(9)
    ds_read_b64_tr_b16 a[166:167], v13 offset:12288
    v_mfma_f32_16x16x32_bf16 v[192:195], a[144:147], v[144:147], v[192:195]
    s_waitcnt lgkmcnt(8)
    ds_read_b64_tr_b16 a[168:169], v13 offset:16384
    v_cvt_pk_bf16_f32 v238, v204, v205
    v_mfma_f32_16x16x32_bf16 v[192:195], a[148:151], v[148:151], v[192:195]
    s_waitcnt lgkmcnt(7)
    s_add_u32 s38, s47, 300544
    ds_read_b64_tr_b16 a[170:171], v13 offset:20480
    v_cvt_pk_bf16_f32 v239, v206, v207
    v_mfma_f32_16x16x32_bf16 v[192:195], a[152:155], v[152:155], v[192:195]
    s_waitcnt lgkmcnt(6)
    ds_read_b64_tr_b16 a[172:173], v13 offset:24576
    buffer_store_dwordx4 v[236:239], v56, s[28:31], s38 offen sc1
    v_mfma_f32_16x16x32_bf16 v[192:195], a[156:159], v[156:159], v[192:195]
    ds_read_b64_tr_b16 a[174:175], v13 offset:28672
    v_mfma_f32_16x16x32_bf16 v[196:199], a[128:131], v[160:163], 0
    ds_read_b64_tr_b16 a[176:177], v17 offset:0
    v_mfma_f32_16x16x32_bf16 v[196:199], a[132:135], v[164:167], v[196:199]
    ds_read_b64_tr_b16 a[178:179], v17 offset:4096
    v_mfma_f32_16x16x32_bf16 v[196:199], a[136:139], v[168:171], v[196:199]
    ds_read_b64_tr_b16 a[180:181], v17 offset:8192
    v_mfma_f32_16x16x32_bf16 v[196:199], a[140:143], v[172:175], v[196:199]
    ds_read_b64_tr_b16 a[182:183], v17 offset:12288
    v_mfma_f32_16x16x32_bf16 v[196:199], a[144:147], v[176:179], v[196:199]
    ds_read_b64_tr_b16 a[184:185], v17 offset:16384
    v_cvt_pk_bf16_f32 v224, v192, v193
    v_mfma_f32_16x16x32_bf16 v[196:199], a[148:151], v[180:183], v[196:199]
    ds_read_b64_tr_b16 a[186:187], v17 offset:20480
    v_cvt_pk_bf16_f32 v225, v194, v195
    v_mfma_f32_16x16x32_bf16 v[196:199], a[152:155], v[184:187], v[196:199]
    ds_read_b64_tr_b16 a[188:189], v17 offset:24576
    v_mfma_f32_16x16x32_bf16 v[196:199], a[156:159], v[188:191], v[196:199]
    s_waitcnt lgkmcnt(13)
    ds_read_b64_tr_b16 a[190:191], v17 offset:28672
    v_mfma_f32_16x16x32_bf16 v[200:203], a[160:163], v[128:131], 0
    s_waitcnt lgkmcnt(12)
    ds_read_b64_tr_b16 a[128:129], v14 offset:0
    v_mfma_f32_16x16x32_bf16 v[200:203], a[164:167], v[132:135], v[200:203]
    s_waitcnt lgkmcnt(11)
    ds_read_b64_tr_b16 a[130:131], v14 offset:4096
    v_mfma_f32_16x16x32_bf16 v[200:203], a[168:171], v[136:139], v[200:203]
    s_waitcnt lgkmcnt(10)
    ds_read_b64_tr_b16 a[132:133], v14 offset:8192
    v_mfma_f32_16x16x32_bf16 v[200:203], a[172:175], v[140:143], v[200:203]
    s_waitcnt lgkmcnt(9)
    ds_read_b64_tr_b16 a[134:135], v14 offset:12288
    v_mfma_f32_16x16x32_bf16 v[200:203], a[176:179], v[144:147], v[200:203]
    s_waitcnt lgkmcnt(8)
    ds_read_b64_tr_b16 a[136:137], v14 offset:16384
    v_cvt_pk_bf16_f32 v228, v196, v197
    v_mfma_f32_16x16x32_bf16 v[200:203], a[180:183], v[148:151], v[200:203]
    s_waitcnt lgkmcnt(7)
    ds_read_b64_tr_b16 a[138:139], v14 offset:20480
    v_cvt_pk_bf16_f32 v229, v198, v199
    v_mfma_f32_16x16x32_bf16 v[200:203], a[184:187], v[152:155], v[200:203]
    s_waitcnt lgkmcnt(6)
    ds_read_b64_tr_b16 a[140:141], v14 offset:24576
    v_mfma_f32_16x16x32_bf16 v[200:203], a[188:191], v[156:159], v[200:203]
    ds_read_b64_tr_b16 a[142:143], v14 offset:28672
    v_mfma_f32_16x16x32_bf16 v[204:207], a[160:163], v[160:163], 0
    ds_read_b64_tr_b16 a[144:145], v18 offset:0
    v_mfma_f32_16x16x32_bf16 v[204:207], a[164:167], v[164:167], v[204:207]
    ds_read_b64_tr_b16 a[146:147], v18 offset:4096
    v_mfma_f32_16x16x32_bf16 v[204:207], a[168:171], v[168:171], v[204:207]
    ds_read_b64_tr_b16 a[148:149], v18 offset:8192
    v_mfma_f32_16x16x32_bf16 v[204:207], a[172:175], v[172:175], v[204:207]
    ds_read_b64_tr_b16 a[150:151], v18 offset:12288
    v_mfma_f32_16x16x32_bf16 v[204:207], a[176:179], v[176:179], v[204:207]
    ds_read_b64_tr_b16 a[152:153], v18 offset:16384
    v_cvt_pk_bf16_f32 v226, v200, v201
    v_mfma_f32_16x16x32_bf16 v[204:207], a[180:183], v[180:183], v[204:207]
    s_add_u32 s38, s47, 6144
    ds_read_b64_tr_b16 a[154:155], v18 offset:20480
    v_cvt_pk_bf16_f32 v227, v202, v203
    v_mfma_f32_16x16x32_bf16 v[204:207], a[184:187], v[184:187], v[204:207]
    ds_read_b64_tr_b16 a[156:157], v18 offset:24576
    buffer_store_dwordx4 v[224:227], v56, s[28:31], s38 offen sc1
    v_mfma_f32_16x16x32_bf16 v[204:207], a[188:191], v[188:191], v[204:207]
    s_waitcnt lgkmcnt(13)
    ds_read_b64_tr_b16 a[158:159], v18 offset:28672
    v_mfma_f32_16x16x32_bf16 v[192:195], a[128:131], v[128:131], 0
    s_waitcnt lgkmcnt(12)
    ds_read_b64_tr_b16 a[160:161], v15 offset:0
    v_mfma_f32_16x16x32_bf16 v[192:195], a[132:135], v[132:135], v[192:195]
    s_waitcnt lgkmcnt(11)
    ds_read_b64_tr_b16 a[162:163], v15 offset:4096
    v_mfma_f32_16x16x32_bf16 v[192:195], a[136:139], v[136:139], v[192:195]
    s_waitcnt lgkmcnt(10)
    ds_read_b64_tr_b16 a[164:165], v15 offset:8192
    v_mfma_f32_16x16x32_bf16 v[192:195], a[140:143], v[140:143], v[192:195]
    s_waitcnt lgkmcnt(9)
    ds_read_b64_tr_b16 a[166:167], v15 offset:12288
    v_mfma_f32_16x16x32_bf16 v[192:195], a[144:147], v[144:147], v[192:195]
    s_waitcnt lgkmcnt(8)
    ds_read_b64_tr_b16 a[168:169], v15 offset:16384
    v_cvt_pk_bf16_f32 v230, v204, v205
    v_mfma_f32_16x16x32_bf16 v[192:195], a[148:151], v[148:151], v[192:195]
    s_waitcnt lgkmcnt(7)
    s_add_u32 s38, s47, 301056
    ds_read_b64_tr_b16 a[170:171], v15 offset:20480
    v_cvt_pk_bf16_f32 v231, v206, v207
    v_mfma_f32_16x16x32_bf16 v[192:195], a[152:155], v[152:155], v[192:195]
    s_waitcnt lgkmcnt(6)
    ds_read_b64_tr_b16 a[172:173], v15 offset:24576
    buffer_store_dwordx4 v[228:231], v56, s[28:31], s38 offen sc1
    v_mfma_f32_16x16x32_bf16 v[192:195], a[156:159], v[156:159], v[192:195]
    ds_read_b64_tr_b16 a[174:175], v15 offset:28672
    v_mfma_f32_16x16x32_bf16 v[196:199], a[128:131], v[160:163], 0
    ds_read_b64_tr_b16 a[176:177], v19 offset:0
    v_mfma_f32_16x16x32_bf16 v[196:199], a[132:135], v[164:167], v[196:199]
    ds_read_b64_tr_b16 a[178:179], v19 offset:4096
    v_mfma_f32_16x16x32_bf16 v[196:199], a[136:139], v[168:171], v[196:199]
    ds_read_b64_tr_b16 a[180:181], v19 offset:8192
    v_mfma_f32_16x16x32_bf16 v[196:199], a[140:143], v[172:175], v[196:199]
    ds_read_b64_tr_b16 a[182:183], v19 offset:12288
    v_mfma_f32_16x16x32_bf16 v[196:199], a[144:147], v[176:179], v[196:199]
    ds_read_b64_tr_b16 a[184:185], v19 offset:16384
    v_cvt_pk_bf16_f32 v232, v192, v193
    v_mfma_f32_16x16x32_bf16 v[196:199], a[148:151], v[180:183], v[196:199]
    ds_read_b64_tr_b16 a[186:187], v19 offset:20480
    v_cvt_pk_bf16_f32 v233, v194, v195
    v_mfma_f32_16x16x32_bf16 v[196:199], a[152:155], v[184:187], v[196:199]
    ds_read_b64_tr_b16 a[188:189], v19 offset:24576
    v_mfma_f32_16x16x32_bf16 v[196:199], a[156:159], v[188:191], v[196:199]
    s_waitcnt lgkmcnt(13)
    ds_read_b64_tr_b16 a[190:191], v19 offset:28672
    s_waitcnt vmcnt(18)
    s_barrier
    v_mfma_f32_16x16x32_bf16 v[200:203], a[160:163], v[128:131], 0
    s_waitcnt lgkmcnt(12)
    ds_read_b64_tr_b16 a[128:129], v12 offset:32768
    v_mfma_f32_16x16x32_bf16 v[200:203], a[164:167], v[132:135], v[200:203]
    s_waitcnt lgkmcnt(11)
    ds_read_b64_tr_b16 a[130:131], v12 offset:36864
    v_mfma_f32_16x16x32_bf16 v[200:203], a[168:171], v[136:139], v[200:203]
    s_waitcnt lgkmcnt(10)
    ds_read_b64_tr_b16 a[132:133], v12 offset:40960
    v_mfma_f32_16x16x32_bf16 v[200:203], a[172:175], v[140:143], v[200:203]
    s_waitcnt lgkmcnt(9)
    ds_read_b64_tr_b16 a[134:135], v12 offset:45056
    v_mfma_f32_16x16x32_bf16 v[200:203], a[176:179], v[144:147], v[200:203]
    s_waitcnt lgkmcnt(8)
    ds_read_b64_tr_b16 a[136:137], v12 offset:49152
    v_cvt_pk_bf16_f32 v236, v196, v197
    v_mfma_f32_16x16x32_bf16 v[200:203], a[180:183], v[148:151], v[200:203]
    s_waitcnt lgkmcnt(7)
    ds_read_b64_tr_b16 a[138:139], v12 offset:53248
    v_cvt_pk_bf16_f32 v237, v198, v199
    v_mfma_f32_16x16x32_bf16 v[200:203], a[184:187], v[152:155], v[200:203]
    s_waitcnt lgkmcnt(6)
    ds_read_b64_tr_b16 a[140:141], v12 offset:57344
    v_mfma_f32_16x16x32_bf16 v[200:203], a[188:191], v[156:159], v[200:203]
    ds_read_b64_tr_b16 a[142:143], v12 offset:61440
    v_mfma_f32_16x16x32_bf16 v[204:207], a[160:163], v[160:163], 0
    ds_read_b64_tr_b16 a[144:145], v16 offset:32768
    v_mfma_f32_16x16x32_bf16 v[204:207], a[164:167], v[164:167], v[204:207]
    ds_read_b64_tr_b16 a[146:147], v16 offset:36864
    v_mfma_f32_16x16x32_bf16 v[204:207], a[168:171], v[168:171], v[204:207]
    ds_read_b64_tr_b16 a[148:149], v16 offset:40960
    v_mfma_f32_16x16x32_bf16 v[204:207], a[172:175], v[172:175], v[204:207]
    ds_read_b64_tr_b16 a[150:151], v16 offset:45056
    v_mfma_f32_16x16x32_bf16 v[204:207], a[176:179], v[176:179], v[204:207]
    ds_read_b64_tr_b16 a[152:153], v16 offset:49152
    v_cvt_pk_bf16_f32 v234, v200, v201
    v_mfma_f32_16x16x32_bf16 v[204:207], a[180:183], v[180:183], v[204:207]
    s_add_u32 s38, s47, 6656
    ds_read_b64_tr_b16 a[154:155], v16 offset:53248
    v_cvt_pk_bf16_f32 v235, v202, v203
    v_mfma_f32_16x16x32_bf16 v[204:207], a[184:187], v[184:187], v[204:207]
    ds_read_b64_tr_b16 a[156:157], v16 offset:57344
    buffer_store_dwordx4 v[232:235], v56, s[28:31], s38 offen sc1
    v_mfma_f32_16x16x32_bf16 v[204:207], a[188:191], v[188:191], v[204:207]
    s_waitcnt lgkmcnt(13)
    ds_read_b64_tr_b16 a[158:159], v16 offset:61440
    v_mfma_f32_16x16x32_bf16 v[192:195], a[128:131], v[128:131], 0
    s_waitcnt lgkmcnt(12)
    ds_read_b64_tr_b16 a[160:161], v13 offset:32768
    v_mfma_f32_16x16x32_bf16 v[192:195], a[132:135], v[132:135], v[192:195]
    s_waitcnt lgkmcnt(11)
    ds_read_b64_tr_b16 a[162:163], v13 offset:36864
    v_mfma_f32_16x16x32_bf16 v[192:195], a[136:139], v[136:139], v[192:195]
    s_waitcnt lgkmcnt(10)
    ds_read_b64_tr_b16 a[164:165], v13 offset:40960
    v_mfma_f32_16x16x32_bf16 v[192:195], a[140:143], v[140:143], v[192:195]
    s_waitcnt lgkmcnt(9)
    ds_read_b64_tr_b16 a[166:167], v13 offset:45056
    v_mfma_f32_16x16x32_bf16 v[192:195], a[144:147], v[144:147], v[192:195]
    s_waitcnt lgkmcnt(8)
    ds_read_b64_tr_b16 a[168:169], v13 offset:49152
    v_cvt_pk_bf16_f32 v238, v204, v205
    v_mfma_f32_16x16x32_bf16 v[192:195], a[148:151], v[148:151], v[192:195]
    s_waitcnt lgkmcnt(7)
    s_add_u32 s38, s47, 301568
    ds_read_b64_tr_b16 a[170:171], v13 offset:53248
    v_cvt_pk_bf16_f32 v239, v206, v207
    v_mfma_f32_16x16x32_bf16 v[192:195], a[152:155], v[152:155], v[192:195]
    s_waitcnt lgkmcnt(6)
    ds_read_b64_tr_b16 a[172:173], v13 offset:57344
    buffer_store_dwordx4 v[236:239], v56, s[28:31], s38 offen sc1
    v_mfma_f32_16x16x32_bf16 v[192:195], a[156:159], v[156:159], v[192:195]
    ds_read_b64_tr_b16 a[174:175], v13 offset:61440
    v_mfma_f32_16x16x32_bf16 v[196:199], a[128:131], v[160:163], 0
    ds_read_b64_tr_b16 a[176:177], v17 offset:32768
    v_mfma_f32_16x16x32_bf16 v[196:199], a[132:135], v[164:167], v[196:199]
    ds_read_b64_tr_b16 a[178:179], v17 offset:36864
    v_mfma_f32_16x16x32_bf16 v[196:199], a[136:139], v[168:171], v[196:199]
    ds_read_b64_tr_b16 a[180:181], v17 offset:40960
    v_mfma_f32_16x16x32_bf16 v[196:199], a[140:143], v[172:175], v[196:199]
    ds_read_b64_tr_b16 a[182:183], v17 offset:45056
    v_mfma_f32_16x16x32_bf16 v[196:199], a[144:147], v[176:179], v[196:199]
    ds_read_b64_tr_b16 a[184:185], v17 offset:49152
    v_cvt_pk_bf16_f32 v224, v192, v193
    v_mfma_f32_16x16x32_bf16 v[196:199], a[148:151], v[180:183], v[196:199]
    ds_read_b64_tr_b16 a[186:187], v17 offset:53248
    v_cvt_pk_bf16_f32 v225, v194, v195
    v_mfma_f32_16x16x32_bf16 v[196:199], a[152:155], v[184:187], v[196:199]
    ds_read_b64_tr_b16 a[188:189], v17 offset:57344
    v_mfma_f32_16x16x32_bf16 v[196:199], a[156:159], v[188:191], v[196:199]
    s_waitcnt lgkmcnt(13)
    ds_read_b64_tr_b16 a[190:191], v17 offset:61440
    v_mfma_f32_16x16x32_bf16 v[200:203], a[160:163], v[128:131], 0
    s_waitcnt lgkmcnt(12)
    ds_read_b64_tr_b16 a[128:129], v14 offset:32768
    v_mfma_f32_16x16x32_bf16 v[200:203], a[164:167], v[132:135], v[200:203]
    s_waitcnt lgkmcnt(11)
    ds_read_b64_tr_b16 a[130:131], v14 offset:36864
    v_mfma_f32_16x16x32_bf16 v[200:203], a[168:171], v[136:139], v[200:203]
    s_waitcnt lgkmcnt(10)
    ds_read_b64_tr_b16 a[132:133], v14 offset:40960
    v_mfma_f32_16x16x32_bf16 v[200:203], a[172:175], v[140:143], v[200:203]
    s_waitcnt lgkmcnt(9)
    ds_read_b64_tr_b16 a[134:135], v14 offset:45056
    v_mfma_f32_16x16x32_bf16 v[200:203], a[176:179], v[144:147], v[200:203]
    s_waitcnt lgkmcnt(8)
    ds_read_b64_tr_b16 a[136:137], v14 offset:49152
    v_cvt_pk_bf16_f32 v228, v196, v197
    v_mfma_f32_16x16x32_bf16 v[200:203], a[180:183], v[148:151], v[200:203]
    s_waitcnt lgkmcnt(7)
    ds_read_b64_tr_b16 a[138:139], v14 offset:53248
    v_cvt_pk_bf16_f32 v229, v198, v199
    v_mfma_f32_16x16x32_bf16 v[200:203], a[184:187], v[152:155], v[200:203]
    s_waitcnt lgkmcnt(6)
    ds_read_b64_tr_b16 a[140:141], v14 offset:57344
    v_mfma_f32_16x16x32_bf16 v[200:203], a[188:191], v[156:159], v[200:203]
    ds_read_b64_tr_b16 a[142:143], v14 offset:61440
    v_mfma_f32_16x16x32_bf16 v[204:207], a[160:163], v[160:163], 0
    ds_read_b64_tr_b16 a[144:145], v18 offset:32768
    v_mfma_f32_16x16x32_bf16 v[204:207], a[164:167], v[164:167], v[204:207]
    ds_read_b64_tr_b16 a[146:147], v18 offset:36864
    v_mfma_f32_16x16x32_bf16 v[204:207], a[168:171], v[168:171], v[204:207]
    ds_read_b64_tr_b16 a[148:149], v18 offset:40960
    v_mfma_f32_16x16x32_bf16 v[204:207], a[172:175], v[172:175], v[204:207]
    ds_read_b64_tr_b16 a[150:151], v18 offset:45056
    v_mfma_f32_16x16x32_bf16 v[204:207], a[176:179], v[176:179], v[204:207]
    ds_read_b64_tr_b16 a[152:153], v18 offset:49152
    v_cvt_pk_bf16_f32 v226, v200, v201
    v_mfma_f32_16x16x32_bf16 v[204:207], a[180:183], v[180:183], v[204:207]
    s_add_u32 s38, s47, 7168
    ds_read_b64_tr_b16 a[154:155], v18 offset:53248
    v_cvt_pk_bf16_f32 v227, v202, v203
    v_mfma_f32_16x16x32_bf16 v[204:207], a[184:187], v[184:187], v[204:207]
    ds_read_b64_tr_b16 a[156:157], v18 offset:57344
    buffer_store_dwordx4 v[224:227], v56, s[28:31], s38 offen sc1
    v_mfma_f32_16x16x32_bf16 v[204:207], a[188:191], v[188:191], v[204:207]
    s_waitcnt lgkmcnt(13)
    ds_read_b64_tr_b16 a[158:159], v18 offset:61440
    v_mfma_f32_16x16x32_bf16 v[192:195], a[128:131], v[128:131], 0
    s_waitcnt lgkmcnt(12)
    ds_read_b64_tr_b16 a[160:161], v15 offset:32768
    v_mfma_f32_16x16x32_bf16 v[192:195], a[132:135], v[132:135], v[192:195]
    s_waitcnt lgkmcnt(11)
    ds_read_b64_tr_b16 a[162:163], v15 offset:36864
    v_mfma_f32_16x16x32_bf16 v[192:195], a[136:139], v[136:139], v[192:195]
    s_waitcnt lgkmcnt(10)
    ds_read_b64_tr_b16 a[164:165], v15 offset:40960
    v_mfma_f32_16x16x32_bf16 v[192:195], a[140:143], v[140:143], v[192:195]
    s_waitcnt lgkmcnt(9)
    ds_read_b64_tr_b16 a[166:167], v15 offset:45056
    v_mfma_f32_16x16x32_bf16 v[192:195], a[144:147], v[144:147], v[192:195]
    s_waitcnt lgkmcnt(8)
    ds_read_b64_tr_b16 a[168:169], v15 offset:49152
    v_cvt_pk_bf16_f32 v230, v204, v205
    v_mfma_f32_16x16x32_bf16 v[192:195], a[148:151], v[148:151], v[192:195]
    s_waitcnt lgkmcnt(7)
    s_add_u32 s38, s47, 302080
    ds_read_b64_tr_b16 a[170:171], v15 offset:53248
    v_cvt_pk_bf16_f32 v231, v206, v207
    v_mfma_f32_16x16x32_bf16 v[192:195], a[152:155], v[152:155], v[192:195]
    s_waitcnt lgkmcnt(6)
    ds_read_b64_tr_b16 a[172:173], v15 offset:57344
    buffer_store_dwordx4 v[228:231], v56, s[28:31], s38 offen sc1
    v_mfma_f32_16x16x32_bf16 v[192:195], a[156:159], v[156:159], v[192:195]
    ds_read_b64_tr_b16 a[174:175], v15 offset:61440
    v_mfma_f32_16x16x32_bf16 v[196:199], a[128:131], v[160:163], 0
    ds_read_b64_tr_b16 a[176:177], v19 offset:32768
    v_mfma_f32_16x16x32_bf16 v[196:199], a[132:135], v[164:167], v[196:199]
    ds_read_b64_tr_b16 a[178:179], v19 offset:36864
    v_mfma_f32_16x16x32_bf16 v[196:199], a[136:139], v[168:171], v[196:199]
    ds_read_b64_tr_b16 a[180:181], v19 offset:40960
    v_mfma_f32_16x16x32_bf16 v[196:199], a[140:143], v[172:175], v[196:199]
    ds_read_b64_tr_b16 a[182:183], v19 offset:45056
    v_mfma_f32_16x16x32_bf16 v[196:199], a[144:147], v[176:179], v[196:199]
    ds_read_b64_tr_b16 a[184:185], v19 offset:49152
    v_cvt_pk_bf16_f32 v232, v192, v193
    v_mfma_f32_16x16x32_bf16 v[196:199], a[148:151], v[180:183], v[196:199]
    ds_read_b64_tr_b16 a[186:187], v19 offset:53248
    v_cvt_pk_bf16_f32 v233, v194, v195
    v_mfma_f32_16x16x32_bf16 v[196:199], a[152:155], v[184:187], v[196:199]
    ds_read_b64_tr_b16 a[188:189], v19 offset:57344
    v_mfma_f32_16x16x32_bf16 v[196:199], a[156:159], v[188:191], v[196:199]
    s_waitcnt lgkmcnt(13)
    ds_read_b64_tr_b16 a[190:191], v19 offset:61440
    s_waitcnt vmcnt(10)
    s_barrier
    v_mfma_f32_16x16x32_bf16 v[200:203], a[160:163], v[128:131], 0
    s_waitcnt lgkmcnt(12)
    ds_read_b64_tr_b16 a[128:129], v20 offset:0
    v_mfma_f32_16x16x32_bf16 v[200:203], a[164:167], v[132:135], v[200:203]
    s_waitcnt lgkmcnt(11)
    ds_read_b64_tr_b16 a[130:131], v20 offset:4096
    v_mfma_f32_16x16x32_bf16 v[200:203], a[168:171], v[136:139], v[200:203]
    s_waitcnt lgkmcnt(10)
    ds_read_b64_tr_b16 a[132:133], v20 offset:8192
    v_mfma_f32_16x16x32_bf16 v[200:203], a[172:175], v[140:143], v[200:203]
    s_waitcnt lgkmcnt(9)
    ds_read_b64_tr_b16 a[134:135], v20 offset:12288
    v_mfma_f32_16x16x32_bf16 v[200:203], a[176:179], v[144:147], v[200:203]
    s_waitcnt lgkmcnt(8)
    ds_read_b64_tr_b16 a[136:137], v20 offset:16384
    v_cvt_pk_bf16_f32 v236, v196, v197
    v_mfma_f32_16x16x32_bf16 v[200:203], a[180:183], v[148:151], v[200:203]
    s_waitcnt lgkmcnt(7)
    ds_read_b64_tr_b16 a[138:139], v20 offset:20480
    v_cvt_pk_bf16_f32 v237, v198, v199
    v_mfma_f32_16x16x32_bf16 v[200:203], a[184:187], v[152:155], v[200:203]
    s_waitcnt lgkmcnt(6)
    ds_read_b64_tr_b16 a[140:141], v20 offset:24576
    v_mfma_f32_16x16x32_bf16 v[200:203], a[188:191], v[156:159], v[200:203]
    ds_read_b64_tr_b16 a[142:143], v20 offset:28672
    v_mfma_f32_16x16x32_bf16 v[204:207], a[160:163], v[160:163], 0
    ds_read_b64_tr_b16 a[144:145], v24 offset:0
    v_mfma_f32_16x16x32_bf16 v[204:207], a[164:167], v[164:167], v[204:207]
    ds_read_b64_tr_b16 a[146:147], v24 offset:4096
    v_mfma_f32_16x16x32_bf16 v[204:207], a[168:171], v[168:171], v[204:207]
    ds_read_b64_tr_b16 a[148:149], v24 offset:8192
    v_mfma_f32_16x16x32_bf16 v[204:207], a[172:175], v[172:175], v[204:207]
    ds_read_b64_tr_b16 a[150:151], v24 offset:12288
    v_mfma_f32_16x16x32_bf16 v[204:207], a[176:179], v[176:179], v[204:207]
    ds_read_b64_tr_b16 a[152:153], v24 offset:16384
    v_cvt_pk_bf16_f32 v234, v200, v201
    v_mfma_f32_16x16x32_bf16 v[204:207], a[180:183], v[180:183], v[204:207]
    s_add_u32 s38, s47, 7680
    ds_read_b64_tr_b16 a[154:155], v24 offset:20480
    v_cvt_pk_bf16_f32 v235, v202, v203
    v_mfma_f32_16x16x32_bf16 v[204:207], a[184:187], v[184:187], v[204:207]
    ds_read_b64_tr_b16 a[156:157], v24 offset:24576
    buffer_store_dwordx4 v[232:235], v56, s[28:31], s38 offen sc1
    v_mfma_f32_16x16x32_bf16 v[204:207], a[188:191], v[188:191], v[204:207]
    s_waitcnt lgkmcnt(13)
    ds_read_b64_tr_b16 a[158:159], v24 offset:28672
    v_mfma_f32_16x16x32_bf16 v[192:195], a[128:131], v[128:131], 0
    s_waitcnt lgkmcnt(12)
    ds_read_b64_tr_b16 a[160:161], v21 offset:0
    v_mfma_f32_16x16x32_bf16 v[192:195], a[132:135], v[132:135], v[192:195]
    s_waitcnt lgkmcnt(11)
    ds_read_b64_tr_b16 a[162:163], v21 offset:4096
    v_mfma_f32_16x16x32_bf16 v[192:195], a[136:139], v[136:139], v[192:195]
    s_waitcnt lgkmcnt(10)
    ds_read_b64_tr_b16 a[164:165], v21 offset:8192
    v_mfma_f32_16x16x32_bf16 v[192:195], a[140:143], v[140:143], v[192:195]
    s_waitcnt lgkmcnt(9)
    ds_read_b64_tr_b16 a[166:167], v21 offset:12288
    v_mfma_f32_16x16x32_bf16 v[192:195], a[144:147], v[144:147], v[192:195]
    s_waitcnt lgkmcnt(8)
    ds_read_b64_tr_b16 a[168:169], v21 offset:16384
    v_cvt_pk_bf16_f32 v238, v204, v205
    v_mfma_f32_16x16x32_bf16 v[192:195], a[148:151], v[148:151], v[192:195]
    s_waitcnt lgkmcnt(7)
    s_add_u32 s38, s47, 302592
    ds_read_b64_tr_b16 a[170:171], v21 offset:20480
    v_cvt_pk_bf16_f32 v239, v206, v207
    v_mfma_f32_16x16x32_bf16 v[192:195], a[152:155], v[152:155], v[192:195]
    s_waitcnt lgkmcnt(6)
    ds_read_b64_tr_b16 a[172:173], v21 offset:24576
    buffer_store_dwordx4 v[236:239], v56, s[28:31], s38 offen sc1
    v_mfma_f32_16x16x32_bf16 v[192:195], a[156:159], v[156:159], v[192:195]
    ds_read_b64_tr_b16 a[174:175], v21 offset:28672
    v_mfma_f32_16x16x32_bf16 v[196:199], a[128:131], v[160:163], 0
    ds_read_b64_tr_b16 a[176:177], v25 offset:0
    v_mfma_f32_16x16x32_bf16 v[196:199], a[132:135], v[164:167], v[196:199]
    ds_read_b64_tr_b16 a[178:179], v25 offset:4096
    v_mfma_f32_16x16x32_bf16 v[196:199], a[136:139], v[168:171], v[196:199]
    ds_read_b64_tr_b16 a[180:181], v25 offset:8192
    v_mfma_f32_16x16x32_bf16 v[196:199], a[140:143], v[172:175], v[196:199]
    ds_read_b64_tr_b16 a[182:183], v25 offset:12288
    v_mfma_f32_16x16x32_bf16 v[196:199], a[144:147], v[176:179], v[196:199]
    ds_read_b64_tr_b16 a[184:185], v25 offset:16384
    v_cvt_pk_bf16_f32 v224, v192, v193
    v_mfma_f32_16x16x32_bf16 v[196:199], a[148:151], v[180:183], v[196:199]
    ds_read_b64_tr_b16 a[186:187], v25 offset:20480
    v_cvt_pk_bf16_f32 v225, v194, v195
    v_mfma_f32_16x16x32_bf16 v[196:199], a[152:155], v[184:187], v[196:199]
    ds_read_b64_tr_b16 a[188:189], v25 offset:24576
    v_mfma_f32_16x16x32_bf16 v[196:199], a[156:159], v[188:191], v[196:199]
    s_waitcnt lgkmcnt(13)
    ds_read_b64_tr_b16 a[190:191], v25 offset:28672
    v_mfma_f32_16x16x32_bf16 v[200:203], a[160:163], v[128:131], 0
    s_waitcnt lgkmcnt(12)
    ds_read_b64_tr_b16 a[128:129], v22 offset:0
    v_mfma_f32_16x16x32_bf16 v[200:203], a[164:167], v[132:135], v[200:203]
    s_waitcnt lgkmcnt(11)
    ds_read_b64_tr_b16 a[130:131], v22 offset:4096
    v_mfma_f32_16x16x32_bf16 v[200:203], a[168:171], v[136:139], v[200:203]
    s_waitcnt lgkmcnt(10)
    ds_read_b64_tr_b16 a[132:133], v22 offset:8192
    v_mfma_f32_16x16x32_bf16 v[200:203], a[172:175], v[140:143], v[200:203]
    s_waitcnt lgkmcnt(9)
    ds_read_b64_tr_b16 a[134:135], v22 offset:12288
    v_mfma_f32_16x16x32_bf16 v[200:203], a[176:179], v[144:147], v[200:203]
    s_waitcnt lgkmcnt(8)
    ds_read_b64_tr_b16 a[136:137], v22 offset:16384
    v_cvt_pk_bf16_f32 v228, v196, v197
    v_mfma_f32_16x16x32_bf16 v[200:203], a[180:183], v[148:151], v[200:203]
    s_waitcnt lgkmcnt(7)
    ds_read_b64_tr_b16 a[138:139], v22 offset:20480
    v_cvt_pk_bf16_f32 v229, v198, v199
    v_mfma_f32_16x16x32_bf16 v[200:203], a[184:187], v[152:155], v[200:203]
    s_waitcnt lgkmcnt(6)
    ds_read_b64_tr_b16 a[140:141], v22 offset:24576
    v_mfma_f32_16x16x32_bf16 v[200:203], a[188:191], v[156:159], v[200:203]
    ds_read_b64_tr_b16 a[142:143], v22 offset:28672
    v_mfma_f32_16x16x32_bf16 v[204:207], a[160:163], v[160:163], 0
    ds_read_b64_tr_b16 a[144:145], v26 offset:0
    v_mfma_f32_16x16x32_bf16 v[204:207], a[164:167], v[164:167], v[204:207]
    ds_read_b64_tr_b16 a[146:147], v26 offset:4096
    v_mfma_f32_16x16x32_bf16 v[204:207], a[168:171], v[168:171], v[204:207]
    ds_read_b64_tr_b16 a[148:149], v26 offset:8192
    v_mfma_f32_16x16x32_bf16 v[204:207], a[172:175], v[172:175], v[204:207]
    ds_read_b64_tr_b16 a[150:151], v26 offset:12288
    v_mfma_f32_16x16x32_bf16 v[204:207], a[176:179], v[176:179], v[204:207]
    ds_read_b64_tr_b16 a[152:153], v26 offset:16384
    v_cvt_pk_bf16_f32 v226, v200, v201
    v_mfma_f32_16x16x32_bf16 v[204:207], a[180:183], v[180:183], v[204:207]
    s_add_u32 s38, s47, 8192
    ds_read_b64_tr_b16 a[154:155], v26 offset:20480
    v_cvt_pk_bf16_f32 v227, v202, v203
    v_mfma_f32_16x16x32_bf16 v[204:207], a[184:187], v[184:187], v[204:207]
    ds_read_b64_tr_b16 a[156:157], v26 offset:24576
    buffer_store_dwordx4 v[224:227], v56, s[28:31], s38 offen sc1
    v_mfma_f32_16x16x32_bf16 v[204:207], a[188:191], v[188:191], v[204:207]
    s_waitcnt lgkmcnt(13)
    ds_read_b64_tr_b16 a[158:159], v26 offset:28672
    v_mfma_f32_16x16x32_bf16 v[192:195], a[128:131], v[128:131], 0
    s_waitcnt lgkmcnt(12)
    ds_read_b64_tr_b16 a[160:161], v23 offset:0
    v_mfma_f32_16x16x32_bf16 v[192:195], a[132:135], v[132:135], v[192:195]
    s_waitcnt lgkmcnt(11)
    ds_read_b64_tr_b16 a[162:163], v23 offset:4096
    v_mfma_f32_16x16x32_bf16 v[192:195], a[136:139], v[136:139], v[192:195]
    s_waitcnt lgkmcnt(10)
    ds_read_b64_tr_b16 a[164:165], v23 offset:8192
    v_mfma_f32_16x16x32_bf16 v[192:195], a[140:143], v[140:143], v[192:195]
    s_waitcnt lgkmcnt(9)
    ds_read_b64_tr_b16 a[166:167], v23 offset:12288
    v_mfma_f32_16x16x32_bf16 v[192:195], a[144:147], v[144:147], v[192:195]
    s_waitcnt lgkmcnt(8)
    ds_read_b64_tr_b16 a[168:169], v23 offset:16384
    v_cvt_pk_bf16_f32 v230, v204, v205
    v_mfma_f32_16x16x32_bf16 v[192:195], a[148:151], v[148:151], v[192:195]
    s_waitcnt lgkmcnt(7)
    s_add_u32 s38, s47, 303104
    ds_read_b64_tr_b16 a[170:171], v23 offset:20480
    v_cvt_pk_bf16_f32 v231, v206, v207
    v_mfma_f32_16x16x32_bf16 v[192:195], a[152:155], v[152:155], v[192:195]
    s_waitcnt lgkmcnt(6)
    ds_read_b64_tr_b16 a[172:173], v23 offset:24576
    buffer_store_dwordx4 v[228:231], v56, s[28:31], s38 offen sc1
    v_mfma_f32_16x16x32_bf16 v[192:195], a[156:159], v[156:159], v[192:195]
    ds_read_b64_tr_b16 a[174:175], v23 offset:28672
    v_mfma_f32_16x16x32_bf16 v[196:199], a[128:131], v[160:163], 0
    ds_read_b64_tr_b16 a[176:177], v27 offset:0
    v_mfma_f32_16x16x32_bf16 v[196:199], a[132:135], v[164:167], v[196:199]
    ds_read_b64_tr_b16 a[178:179], v27 offset:4096
    v_mfma_f32_16x16x32_bf16 v[196:199], a[136:139], v[168:171], v[196:199]
    ds_read_b64_tr_b16 a[180:181], v27 offset:8192
    v_mfma_f32_16x16x32_bf16 v[196:199], a[140:143], v[172:175], v[196:199]
    ds_read_b64_tr_b16 a[182:183], v27 offset:12288
    v_mfma_f32_16x16x32_bf16 v[196:199], a[144:147], v[176:179], v[196:199]
    ds_read_b64_tr_b16 a[184:185], v27 offset:16384
    v_cvt_pk_bf16_f32 v232, v192, v193
    v_mfma_f32_16x16x32_bf16 v[196:199], a[148:151], v[180:183], v[196:199]
    ds_read_b64_tr_b16 a[186:187], v27 offset:20480
    v_cvt_pk_bf16_f32 v233, v194, v195
    v_mfma_f32_16x16x32_bf16 v[196:199], a[152:155], v[184:187], v[196:199]
    ds_read_b64_tr_b16 a[188:189], v27 offset:24576
    v_mfma_f32_16x16x32_bf16 v[196:199], a[156:159], v[188:191], v[196:199]
    s_waitcnt lgkmcnt(13)
    ds_read_b64_tr_b16 a[190:191], v27 offset:28672
    v_mfma_f32_16x16x32_bf16 v[200:203], a[160:163], v[128:131], 0
    s_waitcnt lgkmcnt(12)
    v_mfma_f32_16x16x32_bf16 v[200:203], a[164:167], v[132:135], v[200:203]
    s_waitcnt lgkmcnt(10)
    v_mfma_f32_16x16x32_bf16 v[200:203], a[168:171], v[136:139], v[200:203]
    s_waitcnt lgkmcnt(8)
    v_mfma_f32_16x16x32_bf16 v[200:203], a[172:175], v[140:143], v[200:203]
    s_waitcnt lgkmcnt(6)
    v_mfma_f32_16x16x32_bf16 v[200:203], a[176:179], v[144:147], v[200:203]
    s_waitcnt lgkmcnt(4)
    v_cvt_pk_bf16_f32 v236, v196, v197
    v_mfma_f32_16x16x32_bf16 v[200:203], a[180:183], v[148:151], v[200:203]
    s_waitcnt lgkmcnt(2)
    v_cvt_pk_bf16_f32 v237, v198, v199
    v_mfma_f32_16x16x32_bf16 v[200:203], a[184:187], v[152:155], v[200:203]
    s_waitcnt lgkmcnt(0)
    v_mfma_f32_16x16x32_bf16 v[200:203], a[188:191], v[156:159], v[200:203]
    v_mfma_f32_16x16x32_bf16 v[204:207], a[160:163], v[160:163], 0
    v_mfma_f32_16x16x32_bf16 v[204:207], a[164:167], v[164:167], v[204:207]
    v_mfma_f32_16x16x32_bf16 v[204:207], a[168:171], v[168:171], v[204:207]
    v_mfma_f32_16x16x32_bf16 v[204:207], a[172:175], v[172:175], v[204:207]
    v_mfma_f32_16x16x32_bf16 v[204:207], a[176:179], v[176:179], v[204:207]
    s_nop 2
    v_cvt_pk_bf16_f32 v234, v200, v201
    v_mfma_f32_16x16x32_bf16 v[204:207], a[180:183], v[180:183], v[204:207]
    s_add_u32 s38, s47, 8704
    v_cvt_pk_bf16_f32 v235, v202, v203
    v_mfma_f32_16x16x32_bf16 v[204:207], a[184:187], v[184:187], v[204:207]
    buffer_store_dwordx4 v[232:235], v56, s[28:31], s38 offen sc1
    v_mfma_f32_16x16x32_bf16 v[204:207], a[188:191], v[188:191], v[204:207]
    s_nop 7
    v_cvt_pk_bf16_f32 v238, v204, v205
    s_add_u32 s38, s47, 303616
    v_cvt_pk_bf16_f32 v239, v206, v207
    buffer_store_dwordx4 v[236:239], v56, s[28:31], s38 offen sc1
    s_endpgm
Lattn_redo:
    s_waitcnt vmcnt(0) lgkmcnt(0)
    s_barrier
    v_mov_b32 v232, 0xff800000
    v_mov_b32 v233, 0xff800000
    v_mov_b32 v234, 0xff800000
    v_mov_b32 v235, 0xff800000
    s_mov_b32 s40, 0
    s_mov_b32 s48, -1
Lattn_redo_loop:
    s_add_u32 m0, s42, 0
    s_nop 0
    buffer_load_dwordx4 v36, s[8:11], s40 offen lds
    buffer_load_dwordx4 v37, s[8:11], s40 offen offset:1024 lds
    buffer_load_dwordx4 v38, s[8:11], s40 offen offset:2048 lds
    buffer_load_dwordx4 v39, s[8:11], s40 offen offset:3072 lds
    s_add_u32 s40, s40, 16384
    s_waitcnt vmcnt(0) lgkmcnt(0)
    s_barrier
    ds_read_b128 a[208:211], v8 offset:0
    ds_read_b128 a[212:215], v9 offset:0
    ds_read_b128 a[216:219], v10 offset:0
    ds_read_b128 a[220:223], v11 offset:0
    s_waitcnt lgkmcnt(3)
    v_mfma_f32_16x16x32_bf16 v[216:219], a[208:211], v[64:67], 0
    s_waitcnt lgkmcnt(2)
    v_mfma_f32_16x16x32_bf16 v[216:219], a[212:215], v[68:71], v[216:219]
    s_waitcnt lgkmcnt(1)
    v_mfma_f32_16x16x32_bf16 v[216:219], a[216:219], v[72:75], v[216:219]
    s_waitcnt lgkmcnt(0)
    v_mfma_f32_16x16x32_bf16 v[216:219], a[220:223], v[76:79], v[216:219]
    v_mfma_f32_16x16x32_bf16 v[220:223], a[208:211], v[80:83], 0
    v_mfma_f32_16x16x32_bf16 v[220:223], a[212:215], v[84:87], v[220:223]
    v_mfma_f32_16x16x32_bf16 v[220:223], a[216:219], v[88:91], v[220:223]
    v_mfma_f32_16x16x32_bf16 v[220:223], a[220:223], v[92:95], v[220:223]
    v_mfma_f32_16x16x32_bf16 v[224:227], a[208:211], v[96:99], 0
    v_mfma_f32_16x16x32_bf16 v[224:227], a[212:215], v[100:103], v[224:227]
    v_mfma_f32_16x16x32_bf16 v[224:227], a[216:219], v[104:107], v[224:227]
    v_mfma_f32_16x16x32_bf16 v[224:227], a[220:223], v[108:111], v[224:227]
    v_mfma_f32_16x16x32_bf16 v[228:231], a[208:211], v[112:115], 0
    v_mfma_f32_16x16x32_bf16 v[228:231], a[212:215], v[116:119], v[228:231]
    v_mfma_f32_16x16x32_bf16 v[228:231], a[216:219], v[120:123], v[228:231]
    v_mfma_f32_16x16x32_bf16 v[228:231], a[220:223], v[124:127], v[228:231]
    v_max3_f32 v232, v232, v216, v217
    v_max3_f32 v232, v232, v218, v219
    v_max3_f32 v233, v233, v220, v221
    v_max3_f32 v233, v233, v222, v223
    v_max3_f32 v234, v234, v224, v225
    v_max3_f32 v234, v234, v226, v227
    s_nop 1
    v_max3_f32 v235, v235, v228, v229
    v_max3_f32 v235, v235, v230, v231
    ds_read_b128 a[224:227], v8 offset:4096
    ds_read_b128 a[228:231], v9 offset:4096
    ds_read_b128 a[232:235], v10 offset:4096
    ds_read_b128 a[236:239], v11 offset:4096
    s_waitcnt lgkmcnt(3)
    v_mfma_f32_16x16x32_bf16 v[216:219], a[224:227], v[64:67], 0
    s_waitcnt lgkmcnt(2)
    v_mfma_f32_16x16x32_bf16 v[216:219], a[228:231], v[68:71], v[216:219]
    s_waitcnt lgkmcnt(1)
    v_mfma_f32_16x16x32_bf16 v[216:219], a[232:235], v[72:75], v[216:219]
    s_waitcnt lgkmcnt(0)
    v_mfma_f32_16x16x32_bf16 v[216:219], a[236:239], v[76:79], v[216:219]
    v_mfma_f32_16x16x32_bf16 v[220:223], a[224:227], v[80:83], 0
    v_mfma_f32_16x16x32_bf16 v[220:223], a[228:231], v[84:87], v[220:223]
    v_mfma_f32_16x16x32_bf16 v[220:223], a[232:235], v[88:91], v[220:223]
    v_mfma_f32_16x16x32_bf16 v[220:223], a[236:239], v[92:95], v[220:223]
    v_mfma_f32_16x16x32_bf16 v[224:227], a[224:227], v[96:99], 0
    v_mfma_f32_16x16x32_bf16 v[224:227], a[228:231], v[100:103], v[224:227]
    v_mfma_f32_16x16x32_bf16 v[224:227], a[232:235], v[104:107], v[224:227]
    v_mfma_f32_16x16x32_bf16 v[224:227], a[236:239], v[108:111], v[224:227]
    v_mfma_f32_16x16x32_bf16 v[228:231], a[224:227], v[112:115], 0
    v_mfma_f32_16x16x32_bf16 v[228:231], a[228:231], v[116:119], v[228:231]
    v_mfma_f32_16x16x32_bf16 v[228:231], a[232:235], v[120:123], v[228:231]
    v_mfma_f32_16x16x32_bf16 v[228:231], a[236:239], v[124:127], v[228:231]
    v_max3_f32 v232, v232, v216, v217
    v_max3_f32 v232, v232, v218, v219
    v_max3_f32 v233, v233, v220, v221
    v_max3_f32 v233, v233, v222, v223
    v_max3_f32 v234, v234, v224, v225
    v_max3_f32 v234, v234, v226, v227
    s_nop 1
    v_max3_f32 v235, v235, v228, v229
    v_max3_f32 v235, v235, v230, v231
    ds_read_b128 a[208:211], v8 offset:8192
    ds_read_b128 a[212:215], v9 offset:8192
    ds_read_b128 a[216:219], v10 offset:8192
    ds_read_b128 a[220:223], v11 offset:8192
    s_waitcnt lgkmcnt(3)
    v_mfma_f32_16x16x32_bf16 v[216:219], a[208:211], v[64:67], 0
    s_waitcnt lgkmcnt(2)
    v_mfma_f32_16x16x32_bf16 v[216:219], a[212:215], v[68:71], v[216:219]
    s_waitcnt lgkmcnt(1)
    v_mfma_f32_16x16x32_bf16 v[216:219], a[216:219], v[72:75], v[216:219]
    s_waitcnt lgkmcnt(0)
    v_mfma_f32_16x16x32_bf16 v[216:219], a[220:223], v[76:79], v[216:219]
    v_mfma_f32_16x16x32_bf16 v[220:223], a[208:211], v[80:83], 0
    v_mfma_f32_16x16x32_bf16 v[220:223], a[212:215], v[84:87], v[220:223]
    v_mfma_f32_16x16x32_bf16 v[220:223], a[216:219], v[88:91], v[220:223]
    v_mfma_f32_16x16x32_bf16 v[220:223], a[220:223], v[92:95], v[220:223]
    v_mfma_f32_16x16x32_bf16 v[224:227], a[208:211], v[96:99], 0
    v_mfma_f32_16x16x32_bf16 v[224:227], a[212:215], v[100:103], v[224:227]
    v_mfma_f32_16x16x32_bf16 v[224:227], a[216:219], v[104:107], v[224:227]
    v_mfma_f32_16x16x32_bf16 v[224:227], a[220:223], v[108:111], v[224:227]
    v_mfma_f32_16x16x32_bf16 v[228:231], a[208:211], v[112:115], 0
    v_mfma_f32_16x16x32_bf16 v[228:231], a[212:215], v[116:119], v[228:231]
    v_mfma_f32_16x16x32_bf16 v[228:231], a[216:219], v[120:123], v[228:231]
    v_mfma_f32_16x16x32_bf16 v[228:231], a[220:223], v[124:127], v[228:231]
    v_max3_f32 v232, v232, v216, v217
    v_max3_f32 v232, v232, v218, v219
    v_max3_f32 v233, v233, v220, v221
    v_max3_f32 v233, v233, v222, v223
    v_max3_f32 v234, v234, v224, v225
    v_max3_f32 v234, v234, v226, v227
    s_nop 1
    v_max3_f32 v235, v235, v228, v229
    v_max3_f32 v235, v235, v230, v231
    ds_read_b128 a[224:227], v8 offset:12288
    ds_read_b128 a[228:231], v9 offset:12288
    ds_read_b128 a[232:235], v10 offset:12288
    ds_read_b128 a[236:239], v11 offset:12288
    s_waitcnt lgkmcnt(3)
    v_mfma_f32_16x16x32_bf16 v[216:219], a[224:227], v[64:67], 0
    s_waitcnt lgkmcnt(2)
    v_mfma_f32_16x16x32_bf16 v[216:219], a[228:231], v[68:71], v[216:219]
    s_waitcnt lgkmcnt(1)
    v_mfma_f32_16x16x32_bf16 v[216:219], a[232:235], v[72:75], v[216:219]
    s_waitcnt lgkmcnt(0)
    v_mfma_f32_16x16x32_bf16 v[216:219], a[236:239], v[76:79], v[216:219]
    v_mfma_f32_16x16x32_bf16 v[220:223], a[224:227], v[80:83], 0
    v_mfma_f32_16x16x32_bf16 v[220:223], a[228:231], v[84:87], v[220:223]
    v_mfma_f32_16x16x32_bf16 v[220:223], a[232:235], v[88:91], v[220:223]
    v_mfma_f32_16x16x32_bf16 v[220:223], a[236:239], v[92:95], v[220:223]
    v_mfma_f32_16x16x32_bf16 v[224:227], a[224:227], v[96:99], 0
    v_mfma_f32_16x16x32_bf16 v[224:227], a[228:231], v[100:103], v[224:227]
    v_mfma_f32_16x16x32_bf16 v[224:227], a[232:235], v[104:107], v[224:227]
    v_mfma_f32_16x16x32_bf16 v[224:227], a[236:239], v[108:111], v[224:227]
    v_mfma_f32_16x16x32_bf16 v[228:231], a[224:227], v[112:115], 0
    v_mfma_f32_16x16x32_bf16 v[228:231], a[228:231], v[116:119], v[228:231]
    v_mfma_f32_16x16x32_bf16 v[228:231], a[232:235], v[120:123], v[228:231]
    v_mfma_f32_16x16x32_bf16 v[228:231], a[236:239], v[124:127], v[228:231]
    v_max3_f32 v232, v232, v216, v217
    v_max3_f32 v232, v232, v218, v219
    v_max3_f32 v233, v233, v220, v221
    v_max3_f32 v233, v233, v222, v223
    v_max3_f32 v234, v234, v224, v225
    v_max3_f32 v234, v234, v226, v227
    s_nop 1
    v_max3_f32 v235, v235, v228, v229
    v_max3_f32 v235, v235, v230, v231
    s_barrier
    s_cmp_lt_u32 s40, 524288
    s_cbranch_scc1 Lattn_redo_loop
    v_mov_b32 v236, v232
    v_mov_b32 v237, v233
    v_mov_b32 v238, v234
    v_mov_b32 v239, v235
    v_permlane16_swap_b32 v232, v236
    v_permlane16_swap_b32 v233, v237
    v_permlane16_swap_b32 v234, v238
    v_permlane16_swap_b32 v235, v239
    v_max_f32 v232, v232, v236
    v_max_f32 v233, v233, v237
    v_max_f32 v234, v234, v238
    v_max_f32 v235, v235, v239
    v_mov_b32 v236, v232
    v_mov_b32 v237, v233
    v_mov_b32 v238, v234
    v_mov_b32 v239, v235
    v_permlane32_swap_b32 v232, v236
    v_permlane32_swap_b32 v233, v237
    v_permlane32_swap_b32 v234, v238
    v_permlane32_swap_b32 v235, v239
    v_max_f32 v232, v232, v236
    v_max_f32 v233, v233, v237
    v_max_f32 v234, v234, v238
    v_max_f32 v235, v235, v239
    v_sub_f32 v192, 0, v232
    v_sub_f32 v193, 0, v232
    v_sub_f32 v194, 0, v232
    v_sub_f32 v195, 0, v232
    v_sub_f32 v196, 0, v233
    v_sub_f32 v197, 0, v233
    v_sub_f32 v198, 0, v233
    v_sub_f32 v199, 0, v233
    v_sub_f32 v200, 0, v234
    v_sub_f32 v201, 0, v234
    v_sub_f32 v202, 0, v234
    v_sub_f32 v203, 0, v234
    v_sub_f32 v204, 0, v235
    v_sub_f32 v205, 0, v235
    v_sub_f32 v206, 0, v235
    v_sub_f32 v207, 0, v235
    s_mov_b32 s40, 0
    s_mov_b32 s41, 0
    s_add_u32 m0, s42, 0
    s_nop 0
    buffer_load_dwordx4 v36, s[8:11], s40 offen lds
    buffer_load_dwordx4 v37, s[8:11], s40 offen offset:1024 lds
    buffer_load_dwordx4 v38, s[8:11], s40 offen offset:2048 lds
    buffer_load_dwordx4 v39, s[8:11], s40 offen offset:3072 lds
    s_add_u32 s40, s40, 16384
    s_add_u32 m0, s42, 16384
    s_nop 0
    buffer_load_dwordx4 v36, s[8:11], s40 offen lds
    buffer_load_dwordx4 v37, s[8:11], s40 offen offset:1024 lds
    buffer_load_dwordx4 v38, s[8:11], s40 offen offset:2048 lds
    buffer_load_dwordx4 v39, s[8:11], s40 offen offset:3072 lds
    s_add_u32 s40, s40, 16384
    s_add_u32 m0, s42, 32768
    s_nop 0
    buffer_load_dwordx4 v36, s[8:11], s40 offen lds
    buffer_load_dwordx4 v37, s[8:11], s40 offen offset:1024 lds
    buffer_load_dwordx4 v38, s[8:11], s40 offen offset:2048 lds
    buffer_load_dwordx4 v39, s[8:11], s40 offen offset:3072 lds
    s_add_u32 s40, s40, 16384
    s_add_u32 m0, s42, 65536
    s_nop 0
    buffer_load_dwordx4 v40, s[12:15], s41 offen lds
    buffer_load_dwordx4 v41, s[12:15], s41 offen offset:1024 lds
    buffer_load_dwordx4 v40, s[12:15], s41 offen offset:2048 lds
    buffer_load_dwordx4 v41, s[12:15], s41 offen offset:3072 lds
    s_add_u32 s41, s41, 16384
    s_add_u32 m0, s42, 81920
    s_nop 0
    buffer_load_dwordx4 v40, s[12:15], s41 offen lds
    buffer_load_dwordx4 v41, s[12:15], s41 offen offset:1024 lds
    buffer_load_dwordx4 v40, s[12:15], s41 offen offset:2048 lds
    buffer_load_dwordx4 v41, s[12:15], s41 offen offset:3072 lds
    s_add_u32 s41, s41, 16384
    v_accvgpr_write_b32 a0, 0
    v_accvgpr_write_b32 a1, 0
    v_accvgpr_write_b32 a2, 0
    v_accvgpr_write_b32 a3, 0
    v_accvgpr_write_b32 a4, 0
    v_accvgpr_write_b32 a5, 0
    v_accvgpr_write_b32 a6, 0
    v_accvgpr_write_b32 a7, 0
    v_accvgpr_write_b32 a8, 0
    v_accvgpr_write_b32 a9, 0
    v_accvgpr_write_b32 a10, 0
    v_accvgpr_write_b32 a11, 0
    v_accvgpr_write_b32 a12, 0
    v_accvgpr_write_b32 a13, 0
    v_accvgpr_write_b32 a14, 0
    v_accvgpr_write_b32 a15, 0
    v_accvgpr_write_b32 a16, 0
    v_accvgpr_write_b32 a17, 0
    v_accvgpr_write_b32 a18, 0
    v_accvgpr_write_b32 a19, 0
    v_accvgpr_write_b32 a20, 0
    v_accvgpr_write_b32 a21, 0
    v_accvgpr_write_b32 a22, 0
    v_accvgpr_write_b32 a23, 0
    v_accvgpr_write_b32 a24, 0
    v_accvgpr_write_b32 a25, 0
    v_accvgpr_write_b32 a26, 0
    v_accvgpr_write_b32 a27, 0
    v_accvgpr_write_b32 a28, 0
    v_accvgpr_write_b32 a29, 0
    v_accvgpr_write_b32 a30, 0
    v_accvgpr_write_b32 a31, 0
    v_accvgpr_write_b32 a32, 0
    v_accvgpr_write_b32 a33, 0
    v_accvgpr_write_b32 a34, 0
    v_accvgpr_write_b32 a35, 0
    v_accvgpr_write_b32 a36, 0
    v_accvgpr_write_b32 a37, 0
    v_accvgpr_write_b32 a38, 0
    v_accvgpr_write_b32 a39, 0
    v_accvgpr_write_b32 a40, 0
    v_accvgpr_write_b32 a41, 0
    v_accvgpr_write_b32 a42, 0
    v_accvgpr_write_b32 a43, 0
    v_accvgpr_write_b32 a44, 0
    v_accvgpr_write_b32 a45, 0
    v_accvgpr_write_b32 a46, 0
    v_accvgpr_write_b32 a47, 0
    v_accvgpr_write_b32 a48, 0
    v_accvgpr_write_b32 a49, 0
    v_accvgpr_write_b32 a50, 0
    v_accvgpr_write_b32 a51, 0
    v_accvgpr_write_b32 a52, 0
    v_accvgpr_write_b32 a53, 0
    v_accvgpr_write_b32 a54, 0
    v_accvgpr_write_b32 a55, 0
    v_accvgpr_write_b32 a56, 0
    v_accvgpr_write_b32 a57, 0
    v_accvgpr_write_b32 a58, 0
    v_accvgpr_write_b32 a59, 0
    v_accvgpr_write_b32 a60, 0
    v_accvgpr_write_b32 a61, 0
    v_accvgpr_write_b32 a62, 0
    v_accvgpr_write_b32 a63, 0
    v_accvgpr_write_b32 a64, 0
    v_accvgpr_write_b32 a65, 0
    v_accvgpr_write_b32 a66, 0
    v_accvgpr_write_b32 a67, 0
    v_accvgpr_write_b32 a68, 0
    v_accvgpr_write_b32 a69, 0
    v_accvgpr_write_b32 a70, 0
    v_accvgpr_write_b32 a71, 0
    v_accvgpr_write_b32 a72, 0
    v_accvgpr_write_b32 a73, 0
    v_accvgpr_write_b32 a74, 0
    v_accvgpr_write_b32 a75, 0
    v_accvgpr_write_b32 a76, 0
    v_accvgpr_write_b32 a77, 0
    v_accvgpr_write_b32 a78, 0
    v_accvgpr_write_b32 a79, 0
    v_accvgpr_write_b32 a80, 0
    v_accvgpr_write_b32 a81, 0
    v_accvgpr_write_b32 a82, 0
    v_accvgpr_write_b32 a83, 0
    v_accvgpr_write_b32 a84, 0
    v_accvgpr_write_b32 a85, 0
    v_accvgpr_write_b32 a86, 0
    v_accvgpr_write_b32 a87, 0
    v_accvgpr_write_b32 a88, 0
    v_accvgpr_write_b32 a89, 0
    v_accvgpr_write_b32 a90, 0
    v_accvgpr_write_b32 a91, 0
    v_accvgpr_write_b32 a92, 0
    v_accvgpr_write_b32 a93, 0
    v_accvgpr_write_b32 a94, 0
    v_accvgpr_write_b32 a95, 0
    v_accvgpr_write_b32 a96, 0
    v_accvgpr_write_b32 a97, 0
    v_accvgpr_write_b32 a98, 0
    v_accvgpr_write_b32 a99, 0
    v_accvgpr_write_b32 a100, 0
    v_accvgpr_write_b32 a101, 0
    v_accvgpr_write_b32 a102, 0
    v_accvgpr_write_b32 a103, 0
    v_accvgpr_write_b32 a104, 0
    v_accvgpr_write_b32 a105, 0
    v_accvgpr_write_b32 a106, 0
    v_accvgpr_write_b32 a107, 0
    v_accvgpr_write_b32 a108, 0
    v_accvgpr_write_b32 a109, 0
    v_accvgpr_write_b32 a110, 0
    v_accvgpr_write_b32 a111, 0
    v_accvgpr_write_b32 a112, 0
    v_accvgpr_write_b32 a113, 0
    v_accvgpr_write_b32 a114, 0
    v_accvgpr_write_b32 a115, 0
    v_accvgpr_write_b32 a116, 0
    v_accvgpr_write_b32 a117, 0
    v_accvgpr_write_b32 a118, 0
    v_accvgpr_write_b32 a119, 0
    v_accvgpr_write_b32 a120, 0
    v_accvgpr_write_b32 a121, 0
    v_accvgpr_write_b32 a122, 0
    v_accvgpr_write_b32 a123, 0
    v_accvgpr_write_b32 a124, 0
    v_accvgpr_write_b32 a125, 0
    v_accvgpr_write_b32 a126, 0
    v_accvgpr_write_b32 a127, 0
    v_accvgpr_write_b32 a192, 0
    v_accvgpr_write_b32 a193, 0
    v_accvgpr_write_b32 a194, 0
    v_accvgpr_write_b32 a195, 0
    v_accvgpr_write_b32 a196, 0
    v_accvgpr_write_b32 a197, 0
    v_accvgpr_write_b32 a198, 0
    v_accvgpr_write_b32 a199, 0
    v_accvgpr_write_b32 a200, 0
    v_accvgpr_write_b32 a201, 0
    v_accvgpr_write_b32 a202, 0
    v_accvgpr_write_b32 a203, 0
    v_accvgpr_write_b32 a204, 0
    v_accvgpr_write_b32 a205, 0
    v_accvgpr_write_b32 a206, 0
    v_accvgpr_write_b32 a207, 0
    s_waitcnt vmcnt(0) lgkmcnt(0)
    s_barrier
    ds_read_b128 a[208:211], v8 offset:0
    ds_read_b128 a[212:215], v9 offset:0
    ds_read_b128 a[216:219], v10 offset:0
    ds_read_b128 a[220:223], v11 offset:0
    ds_read_b128 a[224:227], v8 offset:4096
    s_waitcnt vmcnt(0) lgkmcnt(0)
    s_branch Lattn_stage0
Lattn_end:
    s_endpgm
.globl post_kernel
.p2align 8
.type post_kernel,@function
post_kernel:
    s_cmp_ge_u32 s2, 256
    s_cbranch_scc1 Lpost_end
    s_load_dwordx2 s[4:5], s[0:1], 0
    s_load_dwordx2 s[6:7], s[0:1], 112
    s_load_dwordx2 s[36:37], s[0:1], 48
    s_load_dwordx2 s[40:41], s[0:1], 96
    v_and_b32 v1, 7, v0
    v_lshrrev_b32 v2, 5, v0
    v_lshlrev_b32 v2, 6, v2
    v_and_b32 v3, 24, v0
    v_add_u32 v2, v2, v3
    s_lshl_b32 s3, s2, 3
    v_add_u32 v3, s3, v1
    v_mul_u32_u24 v3, 1152, v3
    v_add_u32 v3, v3, v2
    v_lshlrev_b32 v5, 7, v1
    v_lshrrev_b32 v4, 6, v0
    v_lshl_add_u32 v4, v4, 2, v5
    v_lshlrev_b32 v6, 1, v2
    v_lshlrev_b32 v7, 4, v0
    s_mul_i32 s31, s2, 147456
    s_waitcnt lgkmcnt(0)
    s_add_u32 s16, s6, 10485760
    s_addc_u32 s17, s7, 0
    s_mov_b32 s18, 37748736
    s_mov_b32 s19, 0x20000
    buffer_load_dwordx4 v[64:67], v7, s[16:19], s31 offen
    s_add_u32 s31, s31, 9216
    buffer_load_dwordx4 v[68:71], v7, s[16:19], s31 offen
    s_add_u32 s31, s31, 9216
    buffer_load_dwordx4 v[72:75], v7, s[16:19], s31 offen
    s_add_u32 s31, s31, 9216
    buffer_load_dwordx4 v[76:79], v7, s[16:19], s31 offen
    s_add_u32 s31, s31, 9216
    buffer_load_dwordx4 v[80:83], v7, s[16:19], s31 offen
    s_add_u32 s31, s31, 9216
    buffer_load_dwordx4 v[84:87], v7, s[16:19], s31 offen
    s_add_u32 s31, s31, 9216
    buffer_load_dwordx4 v[88:91], v7, s[16:19], s31 offen
    s_add_u32 s31, s31, 9216
    buffer_load_dwordx4 v[92:95], v7, s[16:19], s31 offen
    s_add_u32 s31, s31, 9216
    buffer_load_dwordx4 v[96:99], v7, s[16:19], s31 offen
    s_add_u32 s31, s31, 9216
    buffer_load_dwordx4 v[100:103], v7, s[16:19], s31 offen
    s_add_u32 s31, s31, 9216
    buffer_load_dwordx4 v[104:107], v7, s[16:19], s31 offen
    s_add_u32 s31, s31, 9216
    buffer_load_dwordx4 v[108:111], v7, s[16:19], s31 offen
    s_add_u32 s31, s31, 9216
    buffer_load_dwordx4 v[112:115], v7, s[16:19], s31 offen
    s_add_u32 s31, s31, 9216
    buffer_load_dwordx4 v[116:119], v7, s[16:19], s31 offen
    s_add_u32 s31, s31, 9216
    buffer_load_dwordx4 v[120:123], v7, s[16:19], s31 offen
    s_add_u32 s31, s31, 9216
    buffer_load_dwordx4 v[124:127], v7, s[16:19], s31 offen
    s_mov_b32 s8, s4
    s_mov_b32 s9, s5
    s_mov_b32 s10, 2359296
    s_mov_b32 s11, 0x20000
    s_mov_b32 s12, s6
    s_mov_b32 s13, s7
    s_mov_b32 s14, 13824
    s_mov_b32 s15, 0x20000
    s_add_u32 s20, s6, 2621440
    s_addc_u32 s21, s7, 0
    s_mov_b32 s22, 2359296
    s_mov_b32 s23, 0x20000
    s_add_u32 s24, s6, 5242880
    s_addc_u32 s25, s7, 0
    s_mov_b32 s26, 2359296
    s_mov_b32 s27, 0x20000
    s_add_u32 s32, s6, 32768
    s_addc_u32 s33, s7, 0
    s_mov_b32 s34, 16384
    s_mov_b32 s35, 0x20000
    s_mov_b32 s38, 1152
    s_mov_b32 s39, 0x20000
    s_mov_b32 s42, 2359296
    s_mov_b32 s43, 0x20000
    buffer_load_dwordx2 v[8:9], v3, s[8:11], 0 offen
    buffer_load_dwordx2 v[10:11], v3, s[8:11], 0 offen offset:32
    s_mov_b32 s30, 4608
    buffer_load_dwordx4 v[24:27], v6, s[12:15], s30 offen
    buffer_load_dwordx4 v[28:31], v6, s[12:15], s30 offen offset:64
    s_mov_b32 s30, 6912
    buffer_load_dwordx4 v[32:35], v6, s[12:15], s30 offen
    buffer_load_dwordx4 v[36:39], v6, s[12:15], s30 offen offset:64
    s_mov_b32 s30, 9216
    buffer_load_dwordx4 v[40:43], v6, s[12:15], s30 offen
    buffer_load_dwordx4 v[44:47], v6, s[12:15], s30 offen offset:64
    s_mov_b32 s30, 11520
    buffer_load_dwordx4 v[48:51], v6, s[12:15], s30 offen
    buffer_load_dwordx4 v[52:55], v6, s[12:15], s30 offen offset:64
    buffer_load_dwordx2 v[12:13], v2, s[36:39], 0 offen
    buffer_load_dwordx2 v[14:15], v2, s[36:39], 0 offen offset:32
    s_waitcnt vmcnt(27)
    v_lshlrev_b32 v56, 16, v64
    v_and_b32 v57, 0xffff0000, v64
    v_lshlrev_b32 v58, 16, v65
    v_and_b32 v59, 0xffff0000, v65
    v_lshlrev_b32 v60, 16, v66
    v_and_b32 v61, 0xffff0000, v66
    v_lshlrev_b32 v62, 16, v67
    v_and_b32 v63, 0xffff0000, v67
    s_waitcnt vmcnt(26)
    v_lshlrev_b32 v16, 16, v68
    v_and_b32 v17, 0xffff0000, v68
    v_lshlrev_b32 v18, 16, v69
    v_and_b32 v19, 0xffff0000, v69
    v_lshlrev_b32 v20, 16, v70
    v_and_b32 v21, 0xffff0000, v70
    v_lshlrev_b32 v22, 16, v71
    v_and_b32 v23, 0xffff0000, v71
    v_pk_add_f32 v[56:57], v[56:57], v[16:17]
    v_pk_add_f32 v[58:59], v[58:59], v[18:19]
    v_pk_add_f32 v[60:61], v[60:61], v[20:21]
    v_pk_add_f32 v[62:63], v[62:63], v[22:23]
    s_waitcnt vmcnt(25)
    v_lshlrev_b32 v16, 16, v72
    v_and_b32 v17, 0xffff0000, v72
    v_lshlrev_b32 v18, 16, v73
    v_and_b32 v19, 0xffff0000, v73
    v_lshlrev_b32 v20, 16, v74
    v_and_b32 v21, 0xffff0000, v74
    v_lshlrev_b32 v22, 16, v75
    v_and_b32 v23, 0xffff0000, v75
    v_pk_add_f32 v[56:57], v[56:57], v[16:17]
    v_pk_add_f32 v[58:59], v[58:59], v[18:19]
    v_pk_add_f32 v[60:61], v[60:61], v[20:21]
    v_pk_add_f32 v[62:63], v[62:63], v[22:23]
    s_waitcnt vmcnt(24)
    v_lshlrev_b32 v16, 16, v76
    v_and_b32 v17, 0xffff0000, v76
    v_lshlrev_b32 v18, 16, v77
    v_and_b32 v19, 0xffff0000, v77
    v_lshlrev_b32 v20, 16, v78
    v_and_b32 v21, 0xffff0000, v78
    v_lshlrev_b32 v22, 16, v79
    v_and_b32 v23, 0xffff0000, v79
    v_pk_add_f32 v[56:57], v[56:57], v[16:17]
    v_pk_add_f32 v[58:59], v[58:59], v[18:19]
    v_pk_add_f32 v[60:61], v[60:61], v[20:21]
    v_pk_add_f32 v[62:63], v[62:63], v[22:23]
    s_waitcnt vmcnt(23)
    v_lshlrev_b32 v16, 16, v80
    v_and_b32 v17, 0xffff0000, v80
    v_lshlrev_b32 v18, 16, v81
    v_and_b32 v19, 0xffff0000, v81
    v_lshlrev_b32 v20, 16, v82
    v_and_b32 v21, 0xffff0000, v82
    v_lshlrev_b32 v22, 16, v83
    v_and_b32 v23, 0xffff0000, v83
    v_pk_add_f32 v[56:57], v[56:57], v[16:17]
    v_pk_add_f32 v[58:59], v[58:59], v[18:19]
    v_pk_add_f32 v[60:61], v[60:61], v[20:21]
    v_pk_add_f32 v[62:63], v[62:63], v[22:23]
    s_waitcnt vmcnt(22)
    v_lshlrev_b32 v16, 16, v84
    v_and_b32 v17, 0xffff0000, v84
    v_lshlrev_b32 v18, 16, v85
    v_and_b32 v19, 0xffff0000, v85
    v_lshlrev_b32 v20, 16, v86
    v_and_b32 v21, 0xffff0000, v86
    v_lshlrev_b32 v22, 16, v87
    v_and_b32 v23, 0xffff0000, v87
    v_pk_add_f32 v[56:57], v[56:57], v[16:17]
    v_pk_add_f32 v[58:59], v[58:59], v[18:19]
    v_pk_add_f32 v[60:61], v[60:61], v[20:21]
    v_pk_add_f32 v[62:63], v[62:63], v[22:23]
    s_waitcnt vmcnt(21)
    v_lshlrev_b32 v16, 16, v88
    v_and_b32 v17, 0xffff0000, v88
    v_lshlrev_b32 v18, 16, v89
    v_and_b32 v19, 0xffff0000, v89
    v_lshlrev_b32 v20, 16, v90
    v_and_b32 v21, 0xffff0000, v90
    v_lshlrev_b32 v22, 16, v91
    v_and_b32 v23, 0xffff0000, v91
    v_pk_add_f32 v[56:57], v[56:57], v[16:17]
    v_pk_add_f32 v[58:59], v[58:59], v[18:19]
    v_pk_add_f32 v[60:61], v[60:61], v[20:21]
    v_pk_add_f32 v[62:63], v[62:63], v[22:23]
    s_waitcnt vmcnt(20)
    v_lshlrev_b32 v16, 16, v92
    v_and_b32 v17, 0xffff0000, v92
    v_lshlrev_b32 v18, 16, v93
    v_and_b32 v19, 0xffff0000, v93
    v_lshlrev_b32 v20, 16, v94
    v_and_b32 v21, 0xffff0000, v94
    v_lshlrev_b32 v22, 16, v95
    v_and_b32 v23, 0xffff0000, v95
    v_pk_add_f32 v[56:57], v[56:57], v[16:17]
    v_pk_add_f32 v[58:59], v[58:59], v[18:19]
    v_pk_add_f32 v[60:61], v[60:61], v[20:21]
    v_pk_add_f32 v[62:63], v[62:63], v[22:23]
    s_waitcnt vmcnt(19)
    v_lshlrev_b32 v16, 16, v96
    v_and_b32 v17, 0xffff0000, v96
    v_lshlrev_b32 v18, 16, v97
    v_and_b32 v19, 0xffff0000, v97
    v_lshlrev_b32 v20, 16, v98
    v_and_b32 v21, 0xffff0000, v98
    v_lshlrev_b32 v22, 16, v99
    v_and_b32 v23, 0xffff0000, v99
    v_pk_add_f32 v[56:57], v[56:57], v[16:17]
    v_pk_add_f32 v[58:59], v[58:59], v[18:19]
    v_pk_add_f32 v[60:61], v[60:61], v[20:21]
    v_pk_add_f32 v[62:63], v[62:63], v[22:23]
    s_waitcnt vmcnt(18)
    v_lshlrev_b32 v16, 16, v100
    v_and_b32 v17, 0xffff0000, v100
    v_lshlrev_b32 v18, 16, v101
    v_and_b32 v19, 0xffff0000, v101
    v_lshlrev_b32 v20, 16, v102
    v_and_b32 v21, 0xffff0000, v102
    v_lshlrev_b32 v22, 16, v103
    v_and_b32 v23, 0xffff0000, v103
    v_pk_add_f32 v[56:57], v[56:57], v[16:17]
    v_pk_add_f32 v[58:59], v[58:59], v[18:19]
    v_pk_add_f32 v[60:61], v[60:61], v[20:21]
    v_pk_add_f32 v[62:63], v[62:63], v[22:23]
    s_waitcnt vmcnt(17)
    v_lshlrev_b32 v16, 16, v104
    v_and_b32 v17, 0xffff0000, v104
    v_lshlrev_b32 v18, 16, v105
    v_and_b32 v19, 0xffff0000, v105
    v_lshlrev_b32 v20, 16, v106
    v_and_b32 v21, 0xffff0000, v106
    v_lshlrev_b32 v22, 16, v107
    v_and_b32 v23, 0xffff0000, v107
    v_pk_add_f32 v[56:57], v[56:57], v[16:17]
    v_pk_add_f32 v[58:59], v[58:59], v[18:19]
    v_pk_add_f32 v[60:61], v[60:61], v[20:21]
    v_pk_add_f32 v[62:63], v[62:63], v[22:23]
    s_waitcnt vmcnt(16)
    v_lshlrev_b32 v16, 16, v108
    v_and_b32 v17, 0xffff0000, v108
    v_lshlrev_b32 v18, 16, v109
    v_and_b32 v19, 0xffff0000, v109
    v_lshlrev_b32 v20, 16, v110
    v_and_b32 v21, 0xffff0000, v110
    v_lshlrev_b32 v22, 16, v111
    v_and_b32 v23, 0xffff0000, v111
    v_pk_add_f32 v[56:57], v[56:57], v[16:17]
    v_pk_add_f32 v[58:59], v[58:59], v[18:19]
    v_pk_add_f32 v[60:61], v[60:61], v[20:21]
    v_pk_add_f32 v[62:63], v[62:63], v[22:23]
    s_waitcnt vmcnt(15)
    v_lshlrev_b32 v16, 16, v112
    v_and_b32 v17, 0xffff0000, v112
    v_lshlrev_b32 v18, 16, v113
    v_and_b32 v19, 0xffff0000, v113
    v_lshlrev_b32 v20, 16, v114
    v_and_b32 v21, 0xffff0000, v114
    v_lshlrev_b32 v22, 16, v115
    v_and_b32 v23, 0xffff0000, v115
    v_pk_add_f32 v[56:57], v[56:57], v[16:17]
    v_pk_add_f32 v[58:59], v[58:59], v[18:19]
    v_pk_add_f32 v[60:61], v[60:61], v[20:21]
    v_pk_add_f32 v[62:63], v[62:63], v[22:23]
    s_waitcnt vmcnt(14)
    v_lshlrev_b32 v16, 16, v116
    v_and_b32 v17, 0xffff0000, v116
    v_lshlrev_b32 v18, 16, v117
    v_and_b32 v19, 0xffff0000, v117
    v_lshlrev_b32 v20, 16, v118
    v_and_b32 v21, 0xffff0000, v118
    v_lshlrev_b32 v22, 16, v119
    v_and_b32 v23, 0xffff0000, v119
    v_pk_add_f32 v[56:57], v[56:57], v[16:17]
    v_pk_add_f32 v[58:59], v[58:59], v[18:19]
    v_pk_add_f32 v[60:61], v[60:61], v[20:21]
    v_pk_add_f32 v[62:63], v[62:63], v[22:23]
    s_waitcnt vmcnt(13)
    v_lshlrev_b32 v16, 16, v120
    v_and_b32 v17, 0xffff0000, v120
    v_lshlrev_b32 v18, 16, v121
    v_and_b32 v19, 0xffff0000, v121
    v_lshlrev_b32 v20, 16, v122
    v_and_b32 v21, 0xffff0000, v122
    v_lshlrev_b32 v22, 16, v123
    v_and_b32 v23, 0xffff0000, v123
    v_pk_add_f32 v[56:57], v[56:57], v[16:17]
    v_pk_add_f32 v[58:59], v[58:59], v[18:19]
    v_pk_add_f32 v[60:61], v[60:61], v[20:21]
    v_pk_add_f32 v[62:63], v[62:63], v[22:23]
    s_waitcnt vmcnt(12)
    v_lshlrev_b32 v16, 16, v124
    v_and_b32 v17, 0xffff0000, v124
    v_lshlrev_b32 v18, 16, v125
    v_and_b32 v19, 0xffff0000, v125
    v_lshlrev_b32 v20, 16, v126
    v_and_b32 v21, 0xffff0000, v126
    v_lshlrev_b32 v22, 16, v127
    v_and_b32 v23, 0xffff0000, v127
    v_pk_add_f32 v[56:57], v[56:57], v[16:17]
    v_pk_add_f32 v[58:59], v[58:59], v[18:19]
    v_pk_add_f32 v[60:61], v[60:61], v[20:21]
    v_pk_add_f32 v[62:63], v[62:63], v[22:23]
    v_cvt_pk_bf16_f32 v64, v56, v57
    v_lshlrev_b32 v56, 16, v64
    v_and_b32 v57, 0xffff0000, v64
    v_cvt_pk_bf16_f32 v64, v58, v59
    v_lshlrev_b32 v58, 16, v64
    v_and_b32 v59, 0xffff0000, v64
    v_cvt_pk_bf16_f32 v64, v60, v61
    v_lshlrev_b32 v60, 16, v64
    v_and_b32 v61, 0xffff0000, v64
    v_cvt_pk_bf16_f32 v64, v62, v63
    v_lshlrev_b32 v62, 16, v64
    v_and_b32 v63, 0xffff0000, v64
    s_waitcnt vmcnt(8)
    v_mul_f32 v56, v24, v56
    v_mul_f32 v57, v25, v57
    v_mul_f32 v58, v26, v58
    v_mul_f32 v59, v27, v59
    v_mul_f32 v60, v28, v60
    v_mul_f32 v61, v29, v61
    v_mul_f32 v62, v30, v62
    v_mul_f32 v63, v31, v63
    v_cvt_pk_bf16_f32 v64, v56, v57
    v_lshlrev_b32 v56, 16, v64
    v_and_b32 v57, 0xffff0000, v64
    v_cvt_pk_bf16_f32 v64, v58, v59
    v_lshlrev_b32 v58, 16, v64
    v_and_b32 v59, 0xffff0000, v64
    v_cvt_pk_bf16_f32 v64, v60, v61
    v_lshlrev_b32 v60, 16, v64
    v_and_b32 v61, 0xffff0000, v64
    v_cvt_pk_bf16_f32 v64, v62, v63
    v_lshlrev_b32 v62, 16, v64
    v_and_b32 v63, 0xffff0000, v64
    v_lshlrev_b32 v16, 16, v8
    v_and_b32 v17, 0xffff0000, v8
    v_lshlrev_b32 v18, 16, v9
    v_and_b32 v19, 0xffff0000, v9
    v_lshlrev_b32 v20, 16, v10
    v_and_b32 v21, 0xffff0000, v10
    v_lshlrev_b32 v22, 16, v11
    v_and_b32 v23, 0xffff0000, v11
    v_add_f32 v16, v16, v56
    v_add_f32 v17, v17, v57
    v_add_f32 v18, v18, v58
    v_add_f32 v19, v19, v59
    v_add_f32 v20, v20, v60
    v_add_f32 v21, v21, v61
    v_add_f32 v22, v22, v62
    v_add_f32 v23, v23, v63
    v_cvt_pk_bf16_f32 v8, v16, v17
    v_cvt_pk_bf16_f32 v9, v18, v19
    v_cvt_pk_bf16_f32 v10, v20, v21
    v_cvt_pk_bf16_f32 v11, v22, v23
    v_lshlrev_b32 v16, 16, v8
    v_and_b32 v17, 0xffff0000, v8
    v_lshlrev_b32 v18, 16, v9
    v_and_b32 v19, 0xffff0000, v9
    v_lshlrev_b32 v20, 16, v10
    v_and_b32 v21, 0xffff0000, v10
    v_lshlrev_b32 v22, 16, v11
    v_and_b32 v23, 0xffff0000, v11
    s_waitcnt vmcnt(0)
    buffer_store_dwordx2 v[8:9], v3, s[24:27], 0 offen
    buffer_store_dwordx2 v[10:11], v3, s[24:27], 0 offen offset:32
    v_add_f32 v64, v16, v17
    v_add_f32 v64, v64, v18
    v_add_f32 v64, v64, v19
    v_add_f32 v64, v64, v20
    v_add_f32 v64, v64, v21
    v_add_f32 v64, v64, v22
    v_add_f32 v64, v64, v23
    s_nop 1
    v_add_f32_dpp v64, v64, v64 row_ror:8 row_mask:0xf bank_mask:0xf
    v_mov_b32 v66, v64
    s_nop 1
    v_permlane16_swap_b32 v64, v66
    s_nop 1
    v_add_f32 v64, v64, v66
    v_mov_b32 v66, v64
    s_nop 1
    v_permlane32_swap_b32 v64, v66
    s_nop 1
    v_add_f32 v64, v64, v66
    v_mul_f32 v64, 0x3c800000, v64
    v_sub_f32 v88, v16, v64
    v_sub_f32 v89, v17, v64
    v_sub_f32 v90, v18, v64
    v_sub_f32 v91, v19, v64
    v_sub_f32 v92, v20, v64
    v_sub_f32 v93, v21, v64
    v_sub_f32 v94, v22, v64
    v_sub_f32 v95, v23, v64
    v_mul_f32 v65, v88, v88
    v_fmac_f32 v65, v89, v89
    v_fmac_f32 v65, v90, v90
    v_fmac_f32 v65, v91, v91
    v_fmac_f32 v65, v92, v92
    v_fmac_f32 v65, v93, v93
    v_fmac_f32 v65, v94, v94
    v_fmac_f32 v65, v95, v95
    s_nop 1
    v_add_f32_dpp v65, v65, v65 row_ror:8 row_mask:0xf bank_mask:0xf
    v_mov_b32 v66, v65
    s_nop 1
    v_permlane16_swap_b32 v65, v66
    s_nop 1
    v_add_f32 v65, v65, v66
    v_mov_b32 v66, v65
    s_nop 1
    v_permlane32_swap_b32 v65, v66
    s_nop 1
    v_add_f32 v65, v65, v66
    ds_write2_b32 v4, v64, v65 offset0:0 offset1:16
    s_waitcnt lgkmcnt(0)
    s_barrier
    ds_read_b128 v[68:71], v5
    ds_read_b128 v[72:75], v5 offset:16
    ds_read_b32 v76, v5 offset:32
    ds_read_b128 v[80:83], v5 offset:64
    ds_read_b128 v[84:87], v5 offset:80
    ds_read_b32 v88, v5 offset:96
    s_waitcnt lgkmcnt(3)
    v_add_f32 v64, v68, v69
    v_add_f32 v64, v64, v70
    v_add_f32 v64, v64, v71
    v_add_f32 v64, v64, v72
    v_add_f32 v64, v64, v73
    v_add_f32 v64, v64, v74
    v_add_f32 v64, v64, v75
    v_add_f32 v64, v64, v76
    v_mul_f32 v64, 0x3de38e39, v64
    v_sub_f32 v68, v68, v64
    v_sub_f32 v69, v69, v64
    v_sub_f32 v70, v70, v64
    v_sub_f32 v71, v71, v64
    v_sub_f32 v72, v72, v64
    v_sub_f32 v73, v73, v64
    v_sub_f32 v74, v74, v64
    v_sub_f32 v75, v75, v64
    v_sub_f32 v76, v76, v64
    v_mul_f32 v66, v68, v68
    v_fmac_f32 v66, v69, v69
    v_fmac_f32 v66, v70, v70
    v_fmac_f32 v66, v71, v71
    v_fmac_f32 v66, v72, v72
    v_fmac_f32 v66, v73, v73
    v_fmac_f32 v66, v74, v74
    v_fmac_f32 v66, v75, v75
    v_fmac_f32 v66, v76, v76
    s_waitcnt lgkmcnt(0)
    v_add_f32 v65, v80, v81
    v_add_f32 v65, v65, v82
    v_add_f32 v65, v65, v83
    v_add_f32 v65, v65, v84
    v_add_f32 v65, v65, v85
    v_add_f32 v65, v65, v86
    v_add_f32 v65, v65, v87
    v_add_f32 v65, v65, v88
    v_fmac_f32 v65, 0x42800000, v66
    v_mul_f32 v65, 0x3ae38e39, v65
    v_cvt_pk_bf16_f32 v66, v64, v65
    v_lshlrev_b32 v64, 16, v66
    v_and_b32 v65, 0xffff0000, v66
    v_add_f32 v65, 0x3727c5ac, v65
    v_cvt_pk_bf16_f32 v65, v65, v65
    v_and_b32 v65, 0xffff0000, v65
    v_sqrt_f32 v65, v65
    s_nop 0
    v_cvt_pk_bf16_f32 v65, v65, v65
    v_and_b32 v65, 0xffff0000, v65
    v_rcp_f32 v65, v65
    v_sub_f32 v88, v16, v64
    v_sub_f32 v89, v17, v64
    v_sub_f32 v90, v18, v64
    v_sub_f32 v91, v19, v64
    v_sub_f32 v92, v20, v64
    v_sub_f32 v93, v21, v64
    v_sub_f32 v94, v22, v64
    v_sub_f32 v95, v23, v64
    v_cvt_pk_bf16_f32 v66, v88, v89
    v_lshlrev_b32 v88, 16, v66
    v_and_b32 v89, 0xffff0000, v66
    v_cvt_pk_bf16_f32 v66, v90, v91
    v_lshlrev_b32 v90, 16, v66
    v_and_b32 v91, 0xffff0000, v66
    v_cvt_pk_bf16_f32 v66, v92, v93
    v_lshlrev_b32 v92, 16, v66
    v_and_b32 v93, 0xffff0000, v66
    v_cvt_pk_bf16_f32 v66, v94, v95
    v_lshlrev_b32 v94, 16, v66
    v_and_b32 v95, 0xffff0000, v66
    v_mul_f32 v88, v88, v65
    v_mul_f32 v89, v89, v65
    v_mul_f32 v90, v90, v65
    v_mul_f32 v91, v91, v65
    v_mul_f32 v92, v92, v65
    v_mul_f32 v93, v93, v65
    v_mul_f32 v94, v94, v65
    v_mul_f32 v95, v95, v65
    v_cvt_pk_bf16_f32 v66, v88, v89
    v_lshlrev_b32 v88, 16, v66
    v_and_b32 v89, 0xffff0000, v66
    v_cvt_pk_bf16_f32 v66, v90, v91
    v_lshlrev_b32 v90, 16, v66
    v_and_b32 v91, 0xffff0000, v66
    v_cvt_pk_bf16_f32 v66, v92, v93
    v_lshlrev_b32 v92, 16, v66
    v_and_b32 v93, 0xffff0000, v66
    v_cvt_pk_bf16_f32 v66, v94, v95
    v_lshlrev_b32 v94, 16, v66
    v_and_b32 v95, 0xffff0000, v66
    v_add_f32 v40, 1.0, v40
    v_add_f32 v41, 1.0, v41
    v_add_f32 v42, 1.0, v42
    v_add_f32 v43, 1.0, v43
    v_add_f32 v44, 1.0, v44
    v_add_f32 v45, 1.0, v45
    v_add_f32 v46, 1.0, v46
    v_add_f32 v47, 1.0, v47
    v_cvt_pk_bf16_f32 v66, v40, v41
    v_lshlrev_b32 v40, 16, v66
    v_and_b32 v41, 0xffff0000, v66
    v_cvt_pk_bf16_f32 v66, v42, v43
    v_lshlrev_b32 v42, 16, v66
    v_and_b32 v43, 0xffff0000, v66
    v_cvt_pk_bf16_f32 v66, v44, v45
    v_lshlrev_b32 v44, 16, v66
    v_and_b32 v45, 0xffff0000, v66
    v_cvt_pk_bf16_f32 v66, v46, v47
    v_lshlrev_b32 v46, 16, v66
    v_and_b32 v47, 0xffff0000, v66
    v_mul_f32 v88, v88, v40
    v_mul_f32 v89, v89, v41
    v_mul_f32 v90, v90, v42
    v_mul_f32 v91, v91, v43
    v_mul_f32 v92, v92, v44
    v_mul_f32 v93, v93, v45
    v_mul_f32 v94, v94, v46
    v_mul_f32 v95, v95, v47
    v_cvt_pk_bf16_f32 v66, v88, v89
    v_lshlrev_b32 v88, 16, v66
    v_and_b32 v89, 0xffff0000, v66
    v_cvt_pk_bf16_f32 v66, v90, v91
    v_lshlrev_b32 v90, 16, v66
    v_and_b32 v91, 0xffff0000, v66
    v_cvt_pk_bf16_f32 v66, v92, v93
    v_lshlrev_b32 v92, 16, v66
    v_and_b32 v93, 0xffff0000, v66
    v_cvt_pk_bf16_f32 v66, v94, v95
    v_lshlrev_b32 v94, 16, v66
    v_and_b32 v95, 0xffff0000, v66
    v_add_f32 v88, v88, v32
    v_add_f32 v89, v89, v33
    v_add_f32 v90, v90, v34
    v_add_f32 v91, v91, v35
    v_add_f32 v92, v92, v36
    v_add_f32 v93, v93, v37
    v_add_f32 v94, v94, v38
    v_add_f32 v95, v95, v39
    v_cvt_pk_bf16_f32 v100, v88, v89
    v_cvt_pk_bf16_f32 v101, v90, v91
    v_cvt_pk_bf16_f32 v102, v92, v93
    v_cvt_pk_bf16_f32 v103, v94, v95
    v_lshlrev_b32 v88, 16, v100
    v_and_b32 v89, 0xffff0000, v100
    v_lshlrev_b32 v90, 16, v101
    v_and_b32 v91, 0xffff0000, v101
    v_lshlrev_b32 v92, 16, v102
    v_and_b32 v93, 0xffff0000, v102
    v_lshlrev_b32 v94, 16, v103
    v_and_b32 v95, 0xffff0000, v103
    buffer_store_dwordx2 v[100:101], v3, s[20:23], 0 offen
    buffer_store_dwordx2 v[102:103], v3, s[20:23], 0 offen offset:32
    v_lshlrev_b32 v24, 16, v12
    v_and_b32 v25, 0xffff0000, v12
    v_lshlrev_b32 v26, 16, v13
    v_and_b32 v27, 0xffff0000, v13
    v_lshlrev_b32 v28, 16, v14
    v_and_b32 v29, 0xffff0000, v14
    v_lshlrev_b32 v30, 16, v15
    v_and_b32 v31, 0xffff0000, v15
    v_mul_f32 v64, v24, v88
    v_fmac_f32 v64, v25, v89
    v_fmac_f32 v64, v26, v90
    v_fmac_f32 v64, v27, v91
    v_fmac_f32 v64, v28, v92
    v_fmac_f32 v64, v29, v93
    v_fmac_f32 v64, v30, v94
    v_fmac_f32 v64, v31, v95
    s_nop 1
    v_add_f32_dpp v64, v64, v64 row_ror:8 row_mask:0xf bank_mask:0xf
    v_mov_b32 v65, v64
    s_nop 1
    v_permlane16_swap_b32 v64, v65
    s_nop 1
    v_add_f32 v64, v64, v65
    v_mov_b32 v65, v64
    s_nop 1
    v_permlane32_swap_b32 v64, v65
    s_nop 1
    v_add_f32 v64, v64, v65
    ds_write_b32 v4, v64 offset:1024
    v_mul_f32 v48, v48, v88
    v_mul_f32 v49, v49, v89
    v_mul_f32 v50, v50, v90
    v_mul_f32 v51, v51, v91
    v_mul_f32 v52, v52, v92
    v_mul_f32 v53, v53, v93
    v_mul_f32 v54, v54, v94
    v_mul_f32 v55, v55, v95
    v_cvt_pk_bf16_f32 v65, v48, v49
    v_lshlrev_b32 v48, 16, v65
    v_and_b32 v49, 0xffff0000, v65
    v_cvt_pk_bf16_f32 v65, v50, v51
    v_lshlrev_b32 v50, 16, v65
    v_and_b32 v51, 0xffff0000, v65
    v_cvt_pk_bf16_f32 v65, v52, v53
    v_lshlrev_b32 v52, 16, v65
    v_and_b32 v53, 0xffff0000, v65
    v_cvt_pk_bf16_f32 v65, v54, v55
    v_lshlrev_b32 v54, 16, v65
    v_and_b32 v55, 0xffff0000, v65
    v_add_f32 v48, v16, v48
    v_add_f32 v49, v17, v49
    v_add_f32 v50, v18, v50
    v_add_f32 v51, v19, v51
    v_add_f32 v52, v20, v52
    v_add_f32 v53, v21, v53
    v_add_f32 v54, v22, v54
    v_add_f32 v55, v23, v55
    v_cvt_pk_bf16_f32 v104, v48, v49
    v_cvt_pk_bf16_f32 v105, v50, v51
    v_cvt_pk_bf16_f32 v106, v52, v53
    v_cvt_pk_bf16_f32 v107, v54, v55
    buffer_store_dwordx2 v[104:105], v3, s[40:43], 0 offen
    buffer_store_dwordx2 v[106:107], v3, s[40:43], 0 offen offset:32
    s_waitcnt lgkmcnt(0)
    s_barrier
    v_cmp_gt_u32 vcc, 8, v0
    s_and_saveexec_b64 s[44:45], vcc
    s_cbranch_execz Lpost_end
    ds_read_b128 v[68:71], v5 offset:1024
    ds_read_b128 v[72:75], v5 offset:1040
    ds_read_b32 v76, v5 offset:1056
    v_add_u32 v66, s3, v1
    v_lshlrev_b32 v67, 2, v66
    s_waitcnt lgkmcnt(0)
    v_add_f32 v64, v68, v69
    v_add_f32 v64, v64, v70
    v_add_f32 v64, v64, v71
    v_add_f32 v64, v64, v72
    v_add_f32 v64, v64, v73
    v_add_f32 v64, v64, v74
    v_add_f32 v64, v64, v75
    v_add_f32 v64, v64, v76
    v_ashrrev_i32 v65, 31, v64
    v_or_b32 v65, 0x80000000, v65
    v_xor_b32 v65, v65, v64
    v_and_b32 v65, 0xfffff800, v65
    v_sub_u32 v66, 2047, v66
    v_or_b32 v65, v65, v66
    buffer_store_dword v65, v67, s[32:35], 0 offen
    s_movk_i32 s30, 0x2000
    buffer_store_dword v64, v67, s[32:35], s30 offen
Lpost_end:
    s_endpgm
.globl ffn_kernel
.p2align 8
.type ffn_kernel,@function
ffn_kernel:
    s_cmp_ge_u32 s2, 144
    s_cbranch_scc1 Lffn_end
    s_load_dwordx4 s[4:7], s[0:1], 56
    s_load_dwordx2 s[16:17], s[0:1], 72
    s_load_dwordx2 s[28:29], s[0:1], 112
    v_and_b32 v1, 3, v0
    v_lshrrev_b32 v2, 2, v0
    v_mul_u32_u24 v3, 9216, v2
    v_lshl_add_u32 v3, v1, 4, v3
    s_lshl_b32 s3, s2, 6
    v_add_u32 v3, s3, v3
    v_mul_u32_u24 v4, 911, v0
    v_lshrrev_b32 v4, 16, v4
    v_mul_u32_u24 v5, 72, v4
    v_sub_u32 v5, v0, v5
    v_mul_u32_u24 v6, 4608, v4
    v_lshl_add_u32 v6, v5, 4, v6
    v_and_b32 v7, 63, v0
    s_waitcnt lgkmcnt(0)
    s_add_u32 s32, s28, 32768
    s_addc_u32 s33, s29, 0
    s_mov_b32 s34, 16384
    s_mov_b32 s35, 0x20000
    v_lshlrev_b32 v96, 4, v7
    s_movk_i32 s30, 0x1000
    buffer_load_dwordx4 v[64:67], v96, s[32:35], 0 offen offset:0
    buffer_load_dwordx4 v[68:71], v96, s[32:35], 0 offen offset:1024
    buffer_load_dwordx4 v[72:75], v96, s[32:35], 0 offen offset:2048
    buffer_load_dwordx4 v[76:79], v96, s[32:35], 0 offen offset:3072
    buffer_load_dwordx4 v[80:83], v96, s[32:35], s30 offen offset:0
    buffer_load_dwordx4 v[84:87], v96, s[32:35], s30 offen offset:1024
    buffer_load_dwordx4 v[88:91], v96, s[32:35], s30 offen offset:2048
    buffer_load_dwordx4 v[92:95], v96, s[32:35], s30 offen offset:3072
    s_mov_b32 s8, s4
    s_mov_b32 s9, s5
    s_mov_b32 s10, 5308416
    s_mov_b32 s11, 0x20000
    s_mov_b32 s12, s6
    s_mov_b32 s13, s7
    s_mov_b32 s14, 5308416
    s_mov_b32 s15, 0x20000
    s_mov_b32 s18, 5308416
    s_mov_b32 s19, 0x20000
    s_add_u32 s20, s28, 2621440
    s_addc_u32 s21, s29, 0
    s_mov_b32 s22, 2359296
    s_mov_b32 s23, 0x20000
    s_add_u32 s24, s28, 7864320
    s_addc_u32 s25, s29, 0
    s_mov_b32 s26, 663616
    s_mov_b32 s27, 0x20000
    s_mov_b32 s30, 0
    buffer_load_dwordx4 v[16:19], v3, s[8:11], s30 offen
    buffer_load_dwordx4 v[32:35], v3, s[12:15], s30 offen
    s_mov_b32 s30, 1327104
    buffer_load_dwordx4 v[20:23], v3, s[8:11], s30 offen
    buffer_load_dwordx4 v[36:39], v3, s[12:15], s30 offen
    s_mov_b32 s30, 2654208
    buffer_load_dwordx4 v[24:27], v3, s[8:11], s30 offen
    buffer_load_dwordx4 v[40:43], v3, s[12:15], s30 offen
    s_mov_b32 s30, 3981312
    buffer_load_dwordx4 v[28:31], v3, s[8:11], s30 offen
    buffer_load_dwordx4 v[44:47], v3, s[12:15], s30 offen
    s_mul_i32 s30, s2, 36864
    buffer_load_dwordx4 v[48:51], v6, s[16:19], s30 offen offset:0
    buffer_load_dwordx4 v[52:55], v6, s[16:19], s30 offen offset:1152
    buffer_load_dwordx4 v[56:59], v6, s[16:19], s30 offen offset:2304
    buffer_load_dwordx4 v[60:63], v6, s[16:19], s30 offen offset:3456
    s_waitcnt vmcnt(12)
    v_max_u32 v96, v64, v65
    v_min_u32 v97, v64, v65
    v_med3_u32 v97, v96, v97, v66
    v_max_u32 v96, v96, v66
    v_med3_u32 v97, v96, v97, v67
    v_max_u32 v96, v96, v67
    v_med3_u32 v97, v96, v97, v68
    v_max_u32 v96, v96, v68
    v_med3_u32 v97, v96, v97, v69
    v_max_u32 v96, v96, v69
    v_med3_u32 v97, v96, v97, v70
    v_max_u32 v96, v96, v70
    v_med3_u32 v97, v96, v97, v71
    v_max_u32 v96, v96, v71
    v_med3_u32 v97, v96, v97, v72
    v_max_u32 v96, v96, v72
    v_med3_u32 v97, v96, v97, v73
    v_max_u32 v96, v96, v73
    v_med3_u32 v97, v96, v97, v74
    v_max_u32 v96, v96, v74
    v_med3_u32 v97, v96, v97, v75
    v_max_u32 v96, v96, v75
    v_med3_u32 v97, v96, v97, v76
    v_max_u32 v96, v96, v76
    v_med3_u32 v97, v96, v97, v77
    v_max_u32 v96, v96, v77
    v_med3_u32 v97, v96, v97, v78
    v_max_u32 v96, v96, v78
    v_med3_u32 v97, v96, v97, v79
    v_max_u32 v96, v96, v79
    v_med3_u32 v97, v96, v97, v80
    v_max_u32 v96, v96, v80
    v_med3_u32 v97, v96, v97, v81
    v_max_u32 v96, v96, v81
    v_med3_u32 v97, v96, v97, v82
    v_max_u32 v96, v96, v82
    v_med3_u32 v97, v96, v97, v83
    v_max_u32 v96, v96, v83
    v_med3_u32 v97, v96, v97, v84
    v_max_u32 v96, v96, v84
    v_med3_u32 v97, v96, v97, v85
    v_max_u32 v96, v96, v85
    v_med3_u32 v97, v96, v97, v86
    v_max_u32 v96, v96, v86
    v_med3_u32 v97, v96, v97, v87
    v_max_u32 v96, v96, v87
    v_med3_u32 v97, v96, v97, v88
    v_max_u32 v96, v96, v88
    v_med3_u32 v97, v96, v97, v89
    v_max_u32 v96, v96, v89
    v_med3_u32 v97, v96, v97, v90
    v_max_u32 v96, v96, v90
    v_med3_u32 v97, v96, v97, v91
    v_max_u32 v96, v96, v91
    v_med3_u32 v97, v96, v97, v92
    v_max_u32 v96, v96, v92
    v_med3_u32 v97, v96, v97, v93
    v_max_u32 v96, v96, v93
    v_med3_u32 v97, v96, v97, v94
    v_max_u32 v96, v96, v94
    v_med3_u32 v97, v96, v97, v95
    v_max_u32 v96, v96, v95
    s_nop 1
    v_mov_b32_dpp v98, v96 row_ror:1 row_mask:0xf bank_mask:0xf
    v_mov_b32_dpp v99, v97 row_ror:1 row_mask:0xf bank_mask:0xf
    v_min_u32 v64, v96, v98
    v_max_u32 v96, v96, v98
    v_max3_u32 v97, v64, v97, v99
    s_nop 1
    v_mov_b32_dpp v98, v96 row_ror:2 row_mask:0xf bank_mask:0xf
    v_mov_b32_dpp v99, v97 row_ror:2 row_mask:0xf bank_mask:0xf
    v_min_u32 v64, v96, v98
    v_max_u32 v96, v96, v98
    v_max3_u32 v97, v64, v97, v99
    s_nop 1
    v_mov_b32_dpp v98, v96 row_ror:4 row_mask:0xf bank_mask:0xf
    v_mov_b32_dpp v99, v97 row_ror:4 row_mask:0xf bank_mask:0xf
    v_min_u32 v64, v96, v98
    v_max_u32 v96, v96, v98
    v_max3_u32 v97, v64, v97, v99
    s_nop 1
    v_mov_b32_dpp v98, v96 row_ror:8 row_mask:0xf bank_mask:0xf
    v_mov_b32_dpp v99, v97 row_ror:8 row_mask:0xf bank_mask:0xf
    v_min_u32 v64, v96, v98
    v_max_u32 v96, v96, v98
    v_max3_u32 v97, v64, v97, v99
    v_mov_b32 v98, v96
    v_mov_b32 v99, v97
    s_nop 1
    v_permlane16_swap_b32 v96, v98
    v_permlane16_swap_b32 v97, v99
    s_nop 1
    v_min_u32 v64, v96, v98
    v_max_u32 v96, v96, v98
    v_max3_u32 v97, v64, v97, v99
    v_mov_b32 v98, v96
    v_mov_b32 v99, v97
    s_nop 1
    v_permlane32_swap_b32 v96, v98
    v_permlane32_swap_b32 v97, v99
    s_nop 1
    v_min_u32 v64, v96, v98
    v_max_u32 v96, v96, v98
    v_max3_u32 v97, v64, v97, v99
    s_nop 0
    v_readfirstlane_b32 s46, v96
    v_readfirstlane_b32 s47, v97
    s_nop 3
    s_and_b32 s46, s46, 0x7ff
    s_and_b32 s47, s47, 0x7ff
    s_sub_u32 s46, 2047, s46
    s_sub_u32 s47, 2047, s47
    s_mul_i32 s48, s46, 1152
    s_mul_i32 s49, s47, 1152
    v_lshlrev_b32 v2, 1, v2
    buffer_load_ushort v8, v2, s[20:23], s48 offen offset:0
    buffer_load_ushort v9, v2, s[20:23], s48 offen offset:288
    buffer_load_ushort v10, v2, s[20:23], s48 offen offset:576
    buffer_load_ushort v11, v2, s[20:23], s48 offen offset:864
    buffer_load_ushort v12, v2, s[20:23], s49 offen offset:0
    buffer_load_ushort v13, v2, s[20:23], s49 offen offset:288
    buffer_load_ushort v14, v2, s[20:23], s49 offen offset:576
    buffer_load_ushort v15, v2, s[20:23], s49 offen offset:864
    s_waitcnt vmcnt(0)
    v_lshlrev_b32 v8, 16, v8
    v_lshlrev_b32 v9, 16, v9
    v_lshlrev_b32 v10, 16, v10
    v_lshlrev_b32 v11, 16, v11
    v_lshlrev_b32 v12, 16, v12
    v_lshlrev_b32 v13, 16, v13
    v_lshlrev_b32 v14, 16, v14
    v_lshlrev_b32 v15, 16, v15
    v_lshlrev_b32 v96, 16, v16
    v_and_b32 v97, 0xffff0000, v16
    v_lshlrev_b32 v98, 16, v17
    v_and_b32 v99, 0xffff0000, v17
    v_lshlrev_b32 v100, 16, v18
    v_and_b32 v101, 0xffff0000, v18
    v_lshlrev_b32 v102, 16, v19
    v_and_b32 v103, 0xffff0000, v19
    v_mul_f32 v64, v8, v96
    v_mul_f32 v65, v8, v97
    v_mul_f32 v66, v8, v98
    v_mul_f32 v67, v8, v99
    v_mul_f32 v68, v8, v100
    v_mul_f32 v69, v8, v101
    v_mul_f32 v70, v8, v102
    v_mul_f32 v71, v8, v103
    v_mul_f32 v72, v12, v96
    v_mul_f32 v73, v12, v97
    v_mul_f32 v74, v12, v98
    v_mul_f32 v75, v12, v99
    v_mul_f32 v76, v12, v100
    v_mul_f32 v77, v12, v101
    v_mul_f32 v78, v12, v102
    v_mul_f32 v79, v12, v103
    v_lshlrev_b32 v96, 16, v20
    v_and_b32 v97, 0xffff0000, v20
    v_lshlrev_b32 v98, 16, v21
    v_and_b32 v99, 0xffff0000, v21
    v_lshlrev_b32 v100, 16, v22
    v_and_b32 v101, 0xffff0000, v22
    v_lshlrev_b32 v102, 16, v23
    v_and_b32 v103, 0xffff0000, v23
    v_fmac_f32 v64, v9, v96
    v_fmac_f32 v65, v9, v97
    v_fmac_f32 v66, v9, v98
    v_fmac_f32 v67, v9, v99
    v_fmac_f32 v68, v9, v100
    v_fmac_f32 v69, v9, v101
    v_fmac_f32 v70, v9, v102
    v_fmac_f32 v71, v9, v103
    v_fmac_f32 v72, v13, v96
    v_fmac_f32 v73, v13, v97
    v_fmac_f32 v74, v13, v98
    v_fmac_f32 v75, v13, v99
    v_fmac_f32 v76, v13, v100
    v_fmac_f32 v77, v13, v101
    v_fmac_f32 v78, v13, v102
    v_fmac_f32 v79, v13, v103
    v_lshlrev_b32 v96, 16, v24
    v_and_b32 v97, 0xffff0000, v24
    v_lshlrev_b32 v98, 16, v25
    v_and_b32 v99, 0xffff0000, v25
    v_lshlrev_b32 v100, 16, v26
    v_and_b32 v101, 0xffff0000, v26
    v_lshlrev_b32 v102, 16, v27
    v_and_b32 v103, 0xffff0000, v27
    v_fmac_f32 v64, v10, v96
    v_fmac_f32 v65, v10, v97
    v_fmac_f32 v66, v10, v98
    v_fmac_f32 v67, v10, v99
    v_fmac_f32 v68, v10, v100
    v_fmac_f32 v69, v10, v101
    v_fmac_f32 v70, v10, v102
    v_fmac_f32 v71, v10, v103
    v_fmac_f32 v72, v14, v96
    v_fmac_f32 v73, v14, v97
    v_fmac_f32 v74, v14, v98
    v_fmac_f32 v75, v14, v99
    v_fmac_f32 v76, v14, v100
    v_fmac_f32 v77, v14, v101
    v_fmac_f32 v78, v14, v102
    v_fmac_f32 v79, v14, v103
    v_lshlrev_b32 v96, 16, v28
    v_and_b32 v97, 0xffff0000, v28
    v_lshlrev_b32 v98, 16, v29
    v_and_b32 v99, 0xffff0000, v29
    v_lshlrev_b32 v100, 16, v30
    v_and_b32 v101, 0xffff0000, v30
    v_lshlrev_b32 v102, 16, v31
    v_and_b32 v103, 0xffff0000, v31
    v_fmac_f32 v64, v11, v96
    v_fmac_f32 v65, v11, v97
    v_fmac_f32 v66, v11, v98
    v_fmac_f32 v67, v11, v99
    v_fmac_f32 v68, v11, v100
    v_fmac_f32 v69, v11, v101
    v_fmac_f32 v70, v11, v102
    v_fmac_f32 v71, v11, v103
    v_fmac_f32 v72, v15, v96
    v_fmac_f32 v73, v15, v97
    v_fmac_f32 v74, v15, v98
    v_fmac_f32 v75, v15, v99
    v_fmac_f32 v76, v15, v100
    v_fmac_f32 v77, v15, v101
    v_fmac_f32 v78, v15, v102
    v_fmac_f32 v79, v15, v103
    v_lshlrev_b32 v96, 16, v32
    v_and_b32 v97, 0xffff0000, v32
    v_lshlrev_b32 v98, 16, v33
    v_and_b32 v99, 0xffff0000, v33
    v_lshlrev_b32 v100, 16, v34
    v_and_b32 v101, 0xffff0000, v34
    v_lshlrev_b32 v102, 16, v35
    v_and_b32 v103, 0xffff0000, v35
    v_mul_f32 v80, v8, v96
    v_mul_f32 v81, v8, v97
    v_mul_f32 v82, v8, v98
    v_mul_f32 v83, v8, v99
    v_mul_f32 v84, v8, v100
    v_mul_f32 v85, v8, v101
    v_mul_f32 v86, v8, v102
    v_mul_f32 v87, v8, v103
    v_mul_f32 v88, v12, v96
    v_mul_f32 v89, v12, v97
    v_mul_f32 v90, v12, v98
    v_mul_f32 v91, v12, v99
    v_mul_f32 v92, v12, v100
    v_mul_f32 v93, v12, v101
    v_mul_f32 v94, v12, v102
    v_mul_f32 v95, v12, v103
    v_lshlrev_b32 v96, 16, v36
    v_and_b32 v97, 0xffff0000, v36
    v_lshlrev_b32 v98, 16, v37
    v_and_b32 v99, 0xffff0000, v37
    v_lshlrev_b32 v100, 16, v38
    v_and_b32 v101, 0xffff0000, v38
    v_lshlrev_b32 v102, 16, v39
    v_and_b32 v103, 0xffff0000, v39
    v_fmac_f32 v80, v9, v96
    v_fmac_f32 v81, v9, v97
    v_fmac_f32 v82, v9, v98
    v_fmac_f32 v83, v9, v99
    v_fmac_f32 v84, v9, v100
    v_fmac_f32 v85, v9, v101
    v_fmac_f32 v86, v9, v102
    v_fmac_f32 v87, v9, v103
    v_fmac_f32 v88, v13, v96
    v_fmac_f32 v89, v13, v97
    v_fmac_f32 v90, v13, v98
    v_fmac_f32 v91, v13, v99
    v_fmac_f32 v92, v13, v100
    v_fmac_f32 v93, v13, v101
    v_fmac_f32 v94, v13, v102
    v_fmac_f32 v95, v13, v103
    v_lshlrev_b32 v96, 16, v40
    v_and_b32 v97, 0xffff0000, v40
    v_lshlrev_b32 v98, 16, v41
    v_and_b32 v99, 0xffff0000, v41
    v_lshlrev_b32 v100, 16, v42
    v_and_b32 v101, 0xffff0000, v42
    v_lshlrev_b32 v102, 16, v43
    v_and_b32 v103, 0xffff0000, v43
    v_fmac_f32 v80, v10, v96
    v_fmac_f32 v81, v10, v97
    v_fmac_f32 v82, v10, v98
    v_fmac_f32 v83, v10, v99
    v_fmac_f32 v84, v10, v100
    v_fmac_f32 v85, v10, v101
    v_fmac_f32 v86, v10, v102
    v_fmac_f32 v87, v10, v103
    v_fmac_f32 v88, v14, v96
    v_fmac_f32 v89, v14, v97
    v_fmac_f32 v90, v14, v98
    v_fmac_f32 v91, v14, v99
    v_fmac_f32 v92, v14, v100
    v_fmac_f32 v93, v14, v101
    v_fmac_f32 v94, v14, v102
    v_fmac_f32 v95, v14, v103
    v_lshlrev_b32 v96, 16, v44
    v_and_b32 v97, 0xffff0000, v44
    v_lshlrev_b32 v98, 16, v45
    v_and_b32 v99, 0xffff0000, v45
    v_lshlrev_b32 v100, 16, v46
    v_and_b32 v101, 0xffff0000, v46
    v_lshlrev_b32 v102, 16, v47
    v_and_b32 v103, 0xffff0000, v47
    v_fmac_f32 v80, v11, v96
    v_fmac_f32 v81, v11, v97
    v_fmac_f32 v82, v11, v98
    v_fmac_f32 v83, v11, v99
    v_fmac_f32 v84, v11, v100
    v_fmac_f32 v85, v11, v101
    v_fmac_f32 v86, v11, v102
    v_fmac_f32 v87, v11, v103
    v_fmac_f32 v88, v15, v96
    v_fmac_f32 v89, v15, v97
    v_fmac_f32 v90, v15, v98
    v_fmac_f32 v91, v15, v99
    v_fmac_f32 v92, v15, v100
    v_fmac_f32 v93, v15, v101
    v_fmac_f32 v94, v15, v102
    v_fmac_f32 v95, v15, v103
    s_nop 1
    v_permlane32_swap_b32 v64, v80
    v_permlane32_swap_b32 v65, v81
    v_permlane32_swap_b32 v66, v82
    v_permlane32_swap_b32 v67, v83
    v_permlane32_swap_b32 v68, v84
    v_permlane32_swap_b32 v69, v85
    v_permlane32_swap_b32 v70, v86
    v_permlane32_swap_b32 v71, v87
    v_permlane32_swap_b32 v72, v88
    v_permlane32_swap_b32 v73, v89
    v_permlane32_swap_b32 v74, v90
    v_permlane32_swap_b32 v75, v91
    v_permlane32_swap_b32 v76, v92
    v_permlane32_swap_b32 v77, v93
    v_permlane32_swap_b32 v78, v94
    v_permlane32_swap_b32 v79, v95
    s_nop 1
    v_add_f32 v64, v64, v80
    v_add_f32 v65, v65, v81
    v_add_f32 v66, v66, v82
    v_add_f32 v67, v67, v83
    v_add_f32 v68, v68, v84
    v_add_f32 v69, v69, v85
    v_add_f32 v70, v70, v86
    v_add_f32 v71, v71, v87
    v_add_f32 v72, v72, v88
    v_add_f32 v73, v73, v89
    v_add_f32 v74, v74, v90
    v_add_f32 v75, v75, v91
    v_add_f32 v76, v76, v92
    v_add_f32 v77, v77, v93
    v_add_f32 v78, v78, v94
    v_add_f32 v79, v79, v95
    s_nop 1
    v_permlane16_swap_b32 v64, v72
    v_permlane16_swap_b32 v65, v73
    v_permlane16_swap_b32 v66, v74
    v_permlane16_swap_b32 v67, v75
    v_permlane16_swap_b32 v68, v76
    v_permlane16_swap_b32 v69, v77
    v_permlane16_swap_b32 v70, v78
    v_permlane16_swap_b32 v71, v79
    s_nop 1
    v_add_f32 v64, v64, v72
    v_add_f32 v65, v65, v73
    v_add_f32 v66, v66, v74
    v_add_f32 v67, v67, v75
    v_add_f32 v68, v68, v76
    v_add_f32 v69, v69, v77
    v_add_f32 v70, v70, v78
    v_add_f32 v71, v71, v79
    s_nop 1
    v_add_f32_dpp v64, v64, v64 row_ror:4 row_mask:0xf bank_mask:0xf
    v_add_f32_dpp v65, v65, v65 row_ror:4 row_mask:0xf bank_mask:0xf
    v_add_f32_dpp v66, v66, v66 row_ror:4 row_mask:0xf bank_mask:0xf
    v_add_f32_dpp v67, v67, v67 row_ror:4 row_mask:0xf bank_mask:0xf
    v_add_f32_dpp v68, v68, v68 row_ror:4 row_mask:0xf bank_mask:0xf
    v_add_f32_dpp v69, v69, v69 row_ror:4 row_mask:0xf bank_mask:0xf
    v_add_f32_dpp v70, v70, v70 row_ror:4 row_mask:0xf bank_mask:0xf
    v_add_f32_dpp v71, v71, v71 row_ror:4 row_mask:0xf bank_mask:0xf
    s_nop 1
    v_add_f32_dpp v64, v64, v64 row_ror:8 row_mask:0xf bank_mask:0xf
    v_add_f32_dpp v65, v65, v65 row_ror:8 row_mask:0xf bank_mask:0xf
    v_add_f32_dpp v66, v66, v66 row_ror:8 row_mask:0xf bank_mask:0xf
    v_add_f32_dpp v67, v67, v67 row_ror:8 row_mask:0xf bank_mask:0xf
    v_add_f32_dpp v68, v68, v68 row_ror:8 row_mask:0xf bank_mask:0xf
    v_add_f32_dpp v69, v69, v69 row_ror:8 row_mask:0xf bank_mask:0xf
    v_add_f32_dpp v70, v70, v70 row_ror:8 row_mask:0xf bank_mask:0xf
    v_add_f32_dpp v71, v71, v71 row_ror:8 row_mask:0xf bank_mask:0xf
    v_lshrrev_b32 v8, 4, v0
    v_lshlrev_b32 v8, 7, v8
    v_lshl_add_u32 v8, v1, 5, v8
    ds_write_b128 v8, v[64:67]
    ds_write_b128 v8, v[68:71] offset:16
    s_waitcnt lgkmcnt(0)
    s_barrier
    v_lshlrev_b32 v8, 2, v7
    ds_read2st64_b32 v[64:65], v8 offset0:0 offset1:1
    ds_read2st64_b32 v[66:67], v8 offset0:2 offset1:3
    ds_read2st64_b32 v[68:69], v8 offset0:4 offset1:5
    ds_read2st64_b32 v[70:71], v8 offset0:6 offset1:7
    ds_read2st64_b32 v[72:73], v8 offset0:8 offset1:9
    ds_read2st64_b32 v[74:75], v8 offset0:10 offset1:11
    ds_read2st64_b32 v[76:77], v8 offset0:12 offset1:13
    ds_read2st64_b32 v[78:79], v8 offset0:14 offset1:15
    ds_read2st64_b32 v[80:81], v8 offset0:16 offset1:17
    s_waitcnt lgkmcnt(0)
    v_pk_add_f32 v[64:65], v[64:65], v[66:67]
    v_pk_add_f32 v[64:65], v[64:65], v[68:69]
    v_pk_add_f32 v[64:65], v[64:65], v[70:71]
    v_pk_add_f32 v[64:65], v[64:65], v[72:73]
    v_pk_add_f32 v[64:65], v[64:65], v[74:75]
    v_pk_add_f32 v[64:65], v[64:65], v[76:77]
    v_pk_add_f32 v[64:65], v[64:65], v[78:79]
    v_pk_add_f32 v[64:65], v[64:65], v[80:81]
    v_cvt_pk_bf16_f32 v66, v64, v65
    v_lshlrev_b32 v64, 16, v66
    v_and_b32 v65, 0xffff0000, v66
    v_mul_f32 v66, 0xbfb8aa3b, v64
    v_min_f32 v66, 0x42fc0000, v66
    v_exp_f32 v66, v66
    s_nop 0
    v_add_f32 v66, 1.0, v66
    v_rcp_f32 v67, v66
    s_nop 0
    v_mul_f32 v68, v64, v67
    v_fma_f32 v66, -v68, v66, v64
    v_fma_f32 v64, v66, v67, v68
    v_cvt_pk_bf16_f32 v64, v64, v64
    v_and_b32 v64, 0xffff0000, v64
    v_mul_f32 v64, v64, v65
    v_cvt_pk_bf16_f32 v64, v64, v64
    v_and_b32 v64, 0xffff0000, v64
    v_lshlrev_b32 v9, 4, v4
    ds_bpermute_b32 v68, v9, v64 offset:0
    ds_bpermute_b32 v69, v9, v64 offset:4
    ds_bpermute_b32 v70, v9, v64 offset:8
    ds_bpermute_b32 v71, v9, v64 offset:12
    ds_bpermute_b32 v72, v9, v64 offset:128
    ds_bpermute_b32 v73, v9, v64 offset:132
    ds_bpermute_b32 v74, v9, v64 offset:136
    ds_bpermute_b32 v75, v9, v64 offset:140
    s_waitcnt lgkmcnt(0)
    v_lshlrev_b32 v96, 16, v48
    v_and_b32 v97, 0xffff0000, v48
    v_lshlrev_b32 v98, 16, v49
    v_and_b32 v99, 0xffff0000, v49
    v_lshlrev_b32 v100, 16, v50
    v_and_b32 v101, 0xffff0000, v50
    v_lshlrev_b32 v102, 16, v51
    v_and_b32 v103, 0xffff0000, v51
    v_mul_f32 v80, v68, v96
    v_mul_f32 v81, v68, v97
    v_mul_f32 v82, v68, v98
    v_mul_f32 v83, v68, v99
    v_mul_f32 v84, v68, v100
    v_mul_f32 v85, v68, v101
    v_mul_f32 v86, v68, v102
    v_mul_f32 v87, v68, v103
    v_mul_f32 v88, v72, v96
    v_mul_f32 v89, v72, v97
    v_mul_f32 v90, v72, v98
    v_mul_f32 v91, v72, v99
    v_mul_f32 v92, v72, v100
    v_mul_f32 v93, v72, v101
    v_mul_f32 v94, v72, v102
    v_mul_f32 v95, v72, v103
    v_lshlrev_b32 v96, 16, v52
    v_and_b32 v97, 0xffff0000, v52
    v_lshlrev_b32 v98, 16, v53
    v_and_b32 v99, 0xffff0000, v53
    v_lshlrev_b32 v100, 16, v54
    v_and_b32 v101, 0xffff0000, v54
    v_lshlrev_b32 v102, 16, v55
    v_and_b32 v103, 0xffff0000, v55
    v_fmac_f32 v80, v69, v96
    v_fmac_f32 v81, v69, v97
    v_fmac_f32 v82, v69, v98
    v_fmac_f32 v83, v69, v99
    v_fmac_f32 v84, v69, v100
    v_fmac_f32 v85, v69, v101
    v_fmac_f32 v86, v69, v102
    v_fmac_f32 v87, v69, v103
    v_fmac_f32 v88, v73, v96
    v_fmac_f32 v89, v73, v97
    v_fmac_f32 v90, v73, v98
    v_fmac_f32 v91, v73, v99
    v_fmac_f32 v92, v73, v100
    v_fmac_f32 v93, v73, v101
    v_fmac_f32 v94, v73, v102
    v_fmac_f32 v95, v73, v103
    v_lshlrev_b32 v96, 16, v56
    v_and_b32 v97, 0xffff0000, v56
    v_lshlrev_b32 v98, 16, v57
    v_and_b32 v99, 0xffff0000, v57
    v_lshlrev_b32 v100, 16, v58
    v_and_b32 v101, 0xffff0000, v58
    v_lshlrev_b32 v102, 16, v59
    v_and_b32 v103, 0xffff0000, v59
    v_fmac_f32 v80, v70, v96
    v_fmac_f32 v81, v70, v97
    v_fmac_f32 v82, v70, v98
    v_fmac_f32 v83, v70, v99
    v_fmac_f32 v84, v70, v100
    v_fmac_f32 v85, v70, v101
    v_fmac_f32 v86, v70, v102
    v_fmac_f32 v87, v70, v103
    v_fmac_f32 v88, v74, v96
    v_fmac_f32 v89, v74, v97
    v_fmac_f32 v90, v74, v98
    v_fmac_f32 v91, v74, v99
    v_fmac_f32 v92, v74, v100
    v_fmac_f32 v93, v74, v101
    v_fmac_f32 v94, v74, v102
    v_fmac_f32 v95, v74, v103
    v_lshlrev_b32 v96, 16, v60
    v_and_b32 v97, 0xffff0000, v60
    v_lshlrev_b32 v98, 16, v61
    v_and_b32 v99, 0xffff0000, v61
    v_lshlrev_b32 v100, 16, v62
    v_and_b32 v101, 0xffff0000, v62
    v_lshlrev_b32 v102, 16, v63
    v_and_b32 v103, 0xffff0000, v63
    v_fmac_f32 v80, v71, v96
    v_fmac_f32 v81, v71, v97
    v_fmac_f32 v82, v71, v98
    v_fmac_f32 v83, v71, v99
    v_fmac_f32 v84, v71, v100
    v_fmac_f32 v85, v71, v101
    v_fmac_f32 v86, v71, v102
    v_fmac_f32 v87, v71, v103
    v_fmac_f32 v88, v75, v96
    v_fmac_f32 v89, v75, v97
    v_fmac_f32 v90, v75, v98
    v_fmac_f32 v91, v75, v99
    v_fmac_f32 v92, v75, v100
    v_fmac_f32 v93, v75, v101
    v_fmac_f32 v94, v75, v102
    v_fmac_f32 v95, v75, v103
    v_mul_u32_u24 v8, 4608, v4
    v_lshl_add_u32 v8, v5, 5, v8
    ds_write_b128 v8, v[80:83] offset:8192
    ds_write_b128 v8, v[84:87] offset:8208
    ds_write_b128 v8, v[88:91] offset:10496
    ds_write_b128 v8, v[92:95] offset:10512
    s_waitcnt lgkmcnt(0)
    s_barrier
    v_lshlrev_b32 v8, 3, v0
    ds_read_b64 v[64:65], v8 offset:8192
    ds_read_b64 v[66:67], v8 offset:12800
    ds_read_b64 v[68:69], v8 offset:17408
    ds_read_b64 v[70:71], v8 offset:22016
    ds_read_b64 v[72:73], v8 offset:26624
    ds_read_b64 v[74:75], v8 offset:31232
    ds_read_b64 v[76:77], v8 offset:35840
    ds_read_b64 v[78:79], v8 offset:40448
    s_mul_i32 s30, s2, 4608
    s_waitcnt lgkmcnt(0)
    v_pk_add_f32 v[64:65], v[64:65], v[66:67]
    v_pk_add_f32 v[64:65], v[64:65], v[68:69]
    v_pk_add_f32 v[64:65], v[64:65], v[70:71]
    v_pk_add_f32 v[64:65], v[64:65], v[72:73]
    v_pk_add_f32 v[64:65], v[64:65], v[74:75]
    v_pk_add_f32 v[64:65], v[64:65], v[76:77]
    v_pk_add_f32 v[64:65], v[64:65], v[78:79]
    buffer_store_dwordx2 v[64:65], v8, s[24:27], s30 offen
    s_cmp_lg_u32 s2, 0
    s_cbranch_scc1 Lffn_end
    v_mov_b32 v66, s46
    v_mov_b32 v67, s47
    v_mov_b32 v8, 663552
    buffer_store_dwordx2 v[66:67], v8, s[24:27], 0 offen
Lffn_end:
    s_endpgm
.globl fin_kernel
.p2align 8
.type fin_kernel,@function
fin_kernel:
    s_cmp_ge_u32 s2, 36
    s_cbranch_scc1 Lfin_end
    s_load_dwordx2 s[28:29], s[0:1], 112
    s_load_dwordx2 s[40:41], s[0:1], 96
    v_and_b32 v1, 7, v0
    v_lshrrev_b32 v2, 3, v0
    v_mul_u32_u24 v3, 4608, v2
    v_lshl_add_u32 v3, v1, 4, v3
    s_lshl_b32 s3, s2, 7
    v_add_u32 v3, s3, v3
    s_cmp_ge_u32 s2, 18
    s_cselect_b32 s4, 1, 0
    s_mul_i32 s5, s4, 18
    s_sub_u32 s5, s2, s5
    s_waitcnt lgkmcnt(0)
    s_add_u32 s24, s28, 7864320
    s_addc_u32 s25, s29, 0
    s_mov_b32 s26, 663616
    s_mov_b32 s27, 0x20000
    s_lshl_b32 s6, s4, 2
    s_add_u32 s6, s6, 663552
    s_buffer_load_dword s7, s[24:27], s6
    s_mov_b32 s30, 0
    buffer_load_dwordx4 v[8:11], v3, s[24:27], s30 offen
    s_mov_b32 s30, 110592
    buffer_load_dwordx4 v[12:15], v3, s[24:27], s30 offen
    s_mov_b32 s30, 221184
    buffer_load_dwordx4 v[16:19], v3, s[24:27], s30 offen
    s_mov_b32 s30, 331776
    buffer_load_dwordx4 v[20:23], v3, s[24:27], s30 offen
    s_mov_b32 s30, 442368
    buffer_load_dwordx4 v[24:27], v3, s[24:27], s30 offen
    s_mov_b32 s30, 552960
    buffer_load_dwordx4 v[28:31], v3, s[24:27], s30 offen
    s_mov_b32 s12, s28
    s_mov_b32 s13, s29
    s_mov_b32 s14, 13824
    s_mov_b32 s15, 0x20000
    s_add_u32 s16, s28, 5242880
    s_addc_u32 s17, s29, 0
    s_mov_b32 s18, 2359296
    s_mov_b32 s19, 0x20000
    s_add_u32 s20, s28, 2621440
    s_addc_u32 s21, s29, 0
    s_mov_b32 s22, 2359296
    s_mov_b32 s23, 0x20000
    s_add_u32 s32, s28, 32768
    s_addc_u32 s33, s29, 0
    s_mov_b32 s34, 16384
    s_mov_b32 s35, 0x20000
    s_mov_b32 s42, 2359296
    s_mov_b32 s43, 0x20000
    v_and_b32 v4, 31, v0
    v_lshlrev_b32 v5, 2, v4
    v_lshlrev_b32 v6, 1, v4
    s_lshl_b32 s8, s5, 7
    s_add_u32 s8, s8, 11520
    buffer_load_dword v34, v5, s[12:15], s8 offen
    s_waitcnt lgkmcnt(0)
    s_and_b32 s7, s7, 0x7ff
    s_mul_i32 s9, s7, 1152
    s_lshl_b32 s10, s5, 6
    s_add_u32 s9, s9, s10
    s_lshl_b32 s10, s7, 2
    s_add_u32 s10, s10, 0x2000
    s_buffer_load_dword s11, s[32:35], s10
    buffer_load_ushort v32, v6, s[16:19], s9 offen
    buffer_load_ushort v33, v6, s[20:23], s9 offen
    s_waitcnt vmcnt(3)
    v_pk_add_f32 v[8:9], v[8:9], v[12:13]
    v_pk_add_f32 v[10:11], v[10:11], v[14:15]
    v_pk_add_f32 v[8:9], v[8:9], v[16:17]
    v_pk_add_f32 v[10:11], v[10:11], v[18:19]
    v_pk_add_f32 v[8:9], v[8:9], v[20:21]
    v_pk_add_f32 v[10:11], v[10:11], v[22:23]
    v_pk_add_f32 v[8:9], v[8:9], v[24:25]
    v_pk_add_f32 v[10:11], v[10:11], v[26:27]
    v_pk_add_f32 v[8:9], v[8:9], v[28:29]
    v_pk_add_f32 v[10:11], v[10:11], v[30:31]
    s_nop 1
    v_add_f32_dpp v8, v8, v8 row_ror:8 row_mask:0xf bank_mask:0xf
    v_add_f32_dpp v9, v9, v9 row_ror:8 row_mask:0xf bank_mask:0xf
    v_add_f32_dpp v10, v10, v10 row_ror:8 row_mask:0xf bank_mask:0xf
    v_add_f32_dpp v11, v11, v11 row_ror:8 row_mask:0xf bank_mask:0xf
    v_mov_b32 v12, v8
    v_mov_b32 v13, v9
    v_mov_b32 v14, v10
    v_mov_b32 v15, v11
    s_nop 1
    v_permlane16_swap_b32 v8, v12
    v_permlane16_swap_b32 v9, v13
    v_permlane16_swap_b32 v10, v14
    v_permlane16_swap_b32 v11, v15
    s_nop 1
    v_add_f32 v8, v8, v12
    v_add_f32 v9, v9, v13
    v_add_f32 v10, v10, v14
    v_add_f32 v11, v11, v15
    v_mov_b32 v12, v8
    v_mov_b32 v13, v9
    v_mov_b32 v14, v10
    v_mov_b32 v15, v11
    s_nop 1
    v_permlane32_swap_b32 v8, v12
    v_permlane32_swap_b32 v9, v13
    v_permlane32_swap_b32 v10, v14
    v_permlane32_swap_b32 v11, v15
    s_nop 1
    v_add_f32 v8, v8, v12
    v_add_f32 v9, v9, v13
    v_add_f32 v10, v10, v14
    v_add_f32 v11, v11, v15
    v_lshrrev_b32 v7, 6, v0
    v_lshlrev_b32 v7, 7, v7
    v_lshl_add_u32 v7, v1, 4, v7
    ds_write_b128 v7, v[8:11]
    s_waitcnt lgkmcnt(0)
    s_barrier
    v_cmp_gt_u32 vcc, 32, v0
    s_and_saveexec_b64 s[44:45], vcc
    s_cbranch_execz Lfin_end
    ds_read2_b32 v[8:9], v5 offset0:0 offset1:32
    ds_read_b32 v10, v5 offset:256
    v_mov_b32 v12, s11
    v_cvt_pk_bf16_f32 v12, v12, v12
    v_and_b32 v12, 0xffff0000, v12
    v_mul_f32 v12, 0xbfb8aa3b, v12
    v_exp_f32 v12, v12
    s_nop 0
    v_add_f32 v12, 1.0, v12
    v_rcp_f32 v12, v12
    s_nop 0
    v_cvt_pk_bf16_f32 v12, v12, v12
    v_and_b32 v12, 0xffff0000, v12
    s_waitcnt vmcnt(0) lgkmcnt(0)
    v_add_f32 v8, v8, v9
    v_add_f32 v8, v8, v10
    v_cvt_pk_bf16_f32 v8, v8, v8
    v_and_b32 v8, 0xffff0000, v8
    v_mul_f32 v8, v8, v12
    v_cvt_pk_bf16_f32 v8, v8, v8
    v_and_b32 v8, 0xffff0000, v8
    v_lshlrev_b32 v33, 16, v33
    v_lshlrev_b32 v32, 16, v32
    v_add_f32 v8, v33, v8
    v_cvt_pk_bf16_f32 v8, v8, v8
    v_and_b32 v8, 0xffff0000, v8
    v_mul_f32 v8, v34, v8
    v_cvt_pk_bf16_f32 v8, v8, v8
    v_and_b32 v8, 0xffff0000, v8
    v_add_f32 v8, v32, v8
    v_cvt_pk_bf16_f32 v8, v8, v8
    buffer_store_short v8, v6, s[40:43], s9 offen
Lfin_end:
    s_endpgm
.section .rodata,"a"
.p2align 6
.amdhsa_kernel mod_kernel
  .amdhsa_next_free_vgpr 72
  .amdhsa_next_free_sgpr 102
  .amdhsa_accum_offset 72
  .amdhsa_group_segment_fixed_size 0
  .amdhsa_kernarg_size 120
  .amdhsa_user_sgpr_count 2
  .amdhsa_user_sgpr_kernarg_segment_ptr 1
  .amdhsa_system_sgpr_workgroup_id_x 1
  .amdhsa_float_denorm_mode_32 3
.end_amdhsa_kernel
.p2align 6
.amdhsa_kernel ln1_kernel
  .amdhsa_next_free_vgpr 72
  .amdhsa_next_free_sgpr 102
  .amdhsa_accum_offset 72
  .amdhsa_group_segment_fixed_size 0
  .amdhsa_kernarg_size 120
  .amdhsa_user_sgpr_count 2
  .amdhsa_user_sgpr_kernarg_segment_ptr 1
  .amdhsa_system_sgpr_workgroup_id_x 1
  .amdhsa_float_denorm_mode_32 3
.end_amdhsa_kernel
.p2align 6
.amdhsa_kernel attn_kernel
  .amdhsa_next_free_vgpr 512
  .amdhsa_next_free_sgpr 102
  .amdhsa_accum_offset 256
  .amdhsa_group_segment_fixed_size 0
  .amdhsa_kernarg_size 120
  .amdhsa_user_sgpr_count 2
  .amdhsa_user_sgpr_kernarg_segment_ptr 1
  .amdhsa_system_sgpr_workgroup_id_x 1
  .amdhsa_float_denorm_mode_32 3
.end_amdhsa_kernel
.p2align 6
.amdhsa_kernel post_kernel
  .amdhsa_next_free_vgpr 128
  .amdhsa_next_free_sgpr 102
  .amdhsa_accum_offset 128
  .amdhsa_group_segment_fixed_size 0
  .amdhsa_kernarg_size 120
  .amdhsa_user_sgpr_count 2
  .amdhsa_user_sgpr_kernarg_segment_ptr 1
  .amdhsa_system_sgpr_workgroup_id_x 1
  .amdhsa_float_denorm_mode_32 3
.end_amdhsa_kernel
.p2align 6
.amdhsa_kernel ffn_kernel
  .amdhsa_next_free_vgpr 104
  .amdhsa_next_free_sgpr 102
  .amdhsa_accum_offset 104
  .amdhsa_group_segment_fixed_size 0
  .amdhsa_kernarg_size 120
  .amdhsa_user_sgpr_count 2
  .amdhsa_user_sgpr_kernarg_segment_ptr 1
  .amdhsa_system_sgpr_workgroup_id_x 1
  .amdhsa_float_denorm_mode_32 3
.end_amdhsa_kernel
.p2align 6
.amdhsa_kernel fin_kernel
  .amdhsa_next_free_vgpr 40
  .amdhsa_next_free_sgpr 102
  .amdhsa_accum_offset 40
  .amdhsa_group_segment_fixed_size 0
  .amdhsa_kernarg_size 120
  .amdhsa_user_sgpr_count 2
  .amdhsa_user_sgpr_kernarg_segment_ptr 1
  .amdhsa_system_sgpr_workgroup_id_x 1
  .amdhsa_float_denorm_mode_32 3
.end_amdhsa_kernel
```

```asm
; @launch kernel=mod_kernel grid=(108,1,1) block=(256,1,1) lds=512
; @launch kernel=ln1_kernel grid=(256,1,1) block=(576,1,1) lds=1024
; @launch kernel=attn_kernel grid=(256,1,1) block=(256,1,1) lds=163840
.amdgcn_target "amdgcn-amd-amdhsa--gfx950"
.text
.globl mod_kernel
.p2align 8
.type mod_kernel,@function
mod_kernel:
    s_cmp_ge_u32 s2, 108
    s_cbranch_scc1 Lmod_end
    s_load_dwordx4 s[4:7], s[0:1], 80
    s_load_dwordx2 s[16:17], s[0:1], 112
    v_and_b32 v1, 3, v0
    v_lshrrev_b32 v2, 2, v0
    v_mul_u32_u24 v3, 6912, v2
    s_lshl_b32 s3, s2, 6
    v_lshl_add_u32 v3, v1, 4, v3
    v_add_u32 v3, s3, v3
    v_lshlrev_b32 v4, 1, v2
    s_waitcnt lgkmcnt(0)
    s_mov_b32 s8, s4
    s_mov_b32 s9, s5
    s_mov_b32 s10, 1152
    s_mov_b32 s11, 0x20000
    s_mov_b32 s12, s6
    s_mov_b32 s13, s7
    s_mov_b32 s14, 3981312
    s_mov_b32 s15, 0x20000
    s_mov_b32 s18, 23296
    s_mov_b32 s19, 0x20000
    buffer_load_ushort v8, v4, s[8:11], 0 offen offset:0
    buffer_load_ushort v9, v4, s[8:11], 0 offen offset:128
    buffer_load_ushort v10, v4, s[8:11], 0 offen offset:256
    buffer_load_ushort v11, v4, s[8:11], 0 offen offset:384
    buffer_load_ushort v12, v4, s[8:11], 0 offen offset:512
    buffer_load_ushort v13, v4, s[8:11], 0 offen offset:640
    buffer_load_ushort v14, v4, s[8:11], 0 offen offset:768
    buffer_load_ushort v15, v4, s[8:11], 0 offen offset:896
    buffer_load_ushort v16, v4, s[8:11], 0 offen offset:1024
    s_mov_b32 s20, 0
    buffer_load_dwordx4 v[20:23], v3, s[12:15], s20 offen
    s_mov_b32 s20, 442368
    buffer_load_dwordx4 v[24:27], v3, s[12:15], s20 offen
    s_mov_b32 s20, 884736
    buffer_load_dwordx4 v[28:31], v3, s[12:15], s20 offen
    s_mov_b32 s20, 1327104
    buffer_load_dwordx4 v[32:35], v3, s[12:15], s20 offen
    s_mov_b32 s20, 1769472
    buffer_load_dwordx4 v[36:39], v3, s[12:15], s20 offen
    s_mov_b32 s20, 2211840
    buffer_load_dwordx4 v[40:43], v3, s[12:15], s20 offen
    s_mov_b32 s20, 2654208
    buffer_load_dwordx4 v[44:47], v3, s[12:15], s20 offen
    s_mov_b32 s20, 3096576
    buffer_load_dwordx4 v[48:51], v3, s[12:15], s20 offen
    s_mov_b32 s20, 3538944
    buffer_load_dwordx4 v[52:55], v3, s[12:15], s20 offen
    s_waitcnt vmcnt(9)
    v_lshlrev_b32 v8, 16, v8
    v_mul_f32 v5, 0xbfb8aa3b, v8
    v_min_f32 v5, 0x42fc0000, v5
    v_exp_f32 v5, v5
    s_nop 0
    v_add_f32 v5, 1.0, v5
    v_rcp_f32 v6, v5
    s_nop 0
    v_mul_f32 v7, v8, v6
    v_fma_f32 v5, -v7, v5, v8
    v_fma_f32 v8, v5, v6, v7
    v_cvt_pk_bf16_f32 v8, v8, v8
    v_and_b32 v8, 0xffff0000, v8
    v_lshlrev_b32 v9, 16, v9
    v_mul_f32 v5, 0xbfb8aa3b, v9
    v_min_f32 v5, 0x42fc0000, v5
    v_exp_f32 v5, v5
    s_nop 0
    v_add_f32 v5, 1.0, v5
    v_rcp_f32 v6, v5
    s_nop 0
    v_mul_f32 v7, v9, v6
    v_fma_f32 v5, -v7, v5, v9
    v_fma_f32 v9, v5, v6, v7
    v_cvt_pk_bf16_f32 v9, v9, v9
    v_and_b32 v9, 0xffff0000, v9
    v_lshlrev_b32 v10, 16, v10
    v_mul_f32 v5, 0xbfb8aa3b, v10
    v_min_f32 v5, 0x42fc0000, v5
    v_exp_f32 v5, v5
    s_nop 0
    v_add_f32 v5, 1.0, v5
    v_rcp_f32 v6, v5
    s_nop 0
    v_mul_f32 v7, v10, v6
    v_fma_f32 v5, -v7, v5, v10
    v_fma_f32 v10, v5, v6, v7
    v_cvt_pk_bf16_f32 v10, v10, v10
    v_and_b32 v10, 0xffff0000, v10
    v_lshlrev_b32 v11, 16, v11
    v_mul_f32 v5, 0xbfb8aa3b, v11
    v_min_f32 v5, 0x42fc0000, v5
    v_exp_f32 v5, v5
    s_nop 0
    v_add_f32 v5, 1.0, v5
    v_rcp_f32 v6, v5
    s_nop 0
    v_mul_f32 v7, v11, v6
    v_fma_f32 v5, -v7, v5, v11
    v_fma_f32 v11, v5, v6, v7
    v_cvt_pk_bf16_f32 v11, v11, v11
    v_and_b32 v11, 0xffff0000, v11
    v_lshlrev_b32 v12, 16, v12
    v_mul_f32 v5, 0xbfb8aa3b, v12
    v_min_f32 v5, 0x42fc0000, v5
    v_exp_f32 v5, v5
    s_nop 0
    v_add_f32 v5, 1.0, v5
    v_rcp_f32 v6, v5
    s_nop 0
    v_mul_f32 v7, v12, v6
    v_fma_f32 v5, -v7, v5, v12
    v_fma_f32 v12, v5, v6, v7
    v_cvt_pk_bf16_f32 v12, v12, v12
    v_and_b32 v12, 0xffff0000, v12
    v_lshlrev_b32 v13, 16, v13
    v_mul_f32 v5, 0xbfb8aa3b, v13
    v_min_f32 v5, 0x42fc0000, v5
    v_exp_f32 v5, v5
    s_nop 0
    v_add_f32 v5, 1.0, v5
    v_rcp_f32 v6, v5
    s_nop 0
    v_mul_f32 v7, v13, v6
    v_fma_f32 v5, -v7, v5, v13
    v_fma_f32 v13, v5, v6, v7
    v_cvt_pk_bf16_f32 v13, v13, v13
    v_and_b32 v13, 0xffff0000, v13
    v_lshlrev_b32 v14, 16, v14
    v_mul_f32 v5, 0xbfb8aa3b, v14
    v_min_f32 v5, 0x42fc0000, v5
    v_exp_f32 v5, v5
    s_nop 0
    v_add_f32 v5, 1.0, v5
    v_rcp_f32 v6, v5
    s_nop 0
    v_mul_f32 v7, v14, v6
    v_fma_f32 v5, -v7, v5, v14
    v_fma_f32 v14, v5, v6, v7
    v_cvt_pk_bf16_f32 v14, v14, v14
    v_and_b32 v14, 0xffff0000, v14
    v_lshlrev_b32 v15, 16, v15
    v_mul_f32 v5, 0xbfb8aa3b, v15
    v_min_f32 v5, 0x42fc0000, v5
    v_exp_f32 v5, v5
    s_nop 0
    v_add_f32 v5, 1.0, v5
    v_rcp_f32 v6, v5
    s_nop 0
    v_mul_f32 v7, v15, v6
    v_fma_f32 v5, -v7, v5, v15
    v_fma_f32 v15, v5, v6, v7
    v_cvt_pk_bf16_f32 v15, v15, v15
    v_and_b32 v15, 0xffff0000, v15
    v_lshlrev_b32 v16, 16, v16
    v_mul_f32 v5, 0xbfb8aa3b, v16
    v_min_f32 v5, 0x42fc0000, v5
    v_exp_f32 v5, v5
    s_nop 0
    v_add_f32 v5, 1.0, v5
    v_rcp_f32 v6, v5
    s_nop 0
    v_mul_f32 v7, v16, v6
    v_fma_f32 v5, -v7, v5, v16
    v_fma_f32 v16, v5, v6, v7
    v_cvt_pk_bf16_f32 v16, v16, v16
    v_and_b32 v16, 0xffff0000, v16
    s_waitcnt vmcnt(8)
    v_lshlrev_b32 v64, 16, v20
    v_and_b32 v65, 0xffff0000, v20
    v_lshlrev_b32 v66, 16, v21
    v_and_b32 v67, 0xffff0000, v21
    v_lshlrev_b32 v68, 16, v22
    v_and_b32 v69, 0xffff0000, v22
    v_lshlrev_b32 v70, 16, v23
    v_and_b32 v71, 0xffff0000, v23
    v_mul_f32 v56, v8, v64
    v_mul_f32 v57, v8, v65
    v_mul_f32 v58, v8, v66
    v_mul_f32 v59, v8, v67
    v_mul_f32 v60, v8, v68
    v_mul_f32 v61, v8, v69
    v_mul_f32 v62, v8, v70
    v_mul_f32 v63, v8, v71
    s_waitcnt vmcnt(7)
    v_lshlrev_b32 v64, 16, v24
    v_and_b32 v65, 0xffff0000, v24
    v_lshlrev_b32 v66, 16, v25
    v_and_b32 v67, 0xffff0000, v25
    v_lshlrev_b32 v68, 16, v26
    v_and_b32 v69, 0xffff0000, v26
    v_lshlrev_b32 v70, 16, v27
    v_and_b32 v71, 0xffff0000, v27
    v_fmac_f32 v56, v9, v64
    v_fmac_f32 v57, v9, v65
    v_fmac_f32 v58, v9, v66
    v_fmac_f32 v59, v9, v67
    v_fmac_f32 v60, v9, v68
    v_fmac_f32 v61, v9, v69
    v_fmac_f32 v62, v9, v70
    v_fmac_f32 v63, v9, v71
    s_waitcnt vmcnt(6)
    v_lshlrev_b32 v64, 16, v28
    v_and_b32 v65, 0xffff0000, v28
    v_lshlrev_b32 v66, 16, v29
    v_and_b32 v67, 0xffff0000, v29
    v_lshlrev_b32 v68, 16, v30
    v_and_b32 v69, 0xffff0000, v30
    v_lshlrev_b32 v70, 16, v31
    v_and_b32 v71, 0xffff0000, v31
    v_fmac_f32 v56, v10, v64
    v_fmac_f32 v57, v10, v65
    v_fmac_f32 v58, v10, v66
    v_fmac_f32 v59, v10, v67
    v_fmac_f32 v60, v10, v68
    v_fmac_f32 v61, v10, v69
    v_fmac_f32 v62, v10, v70
    v_fmac_f32 v63, v10, v71
    s_waitcnt vmcnt(5)
    v_lshlrev_b32 v64, 16, v32
    v_and_b32 v65, 0xffff0000, v32
    v_lshlrev_b32 v66, 16, v33
    v_and_b32 v67, 0xffff0000, v33
    v_lshlrev_b32 v68, 16, v34
    v_and_b32 v69, 0xffff0000, v34
    v_lshlrev_b32 v70, 16, v35
    v_and_b32 v71, 0xffff0000, v35
    v_fmac_f32 v56, v11, v64
    v_fmac_f32 v57, v11, v65
    v_fmac_f32 v58, v11, v66
    v_fmac_f32 v59, v11, v67
    v_fmac_f32 v60, v11, v68
    v_fmac_f32 v61, v11, v69
    v_fmac_f32 v62, v11, v70
    v_fmac_f32 v63, v11, v71
    s_waitcnt vmcnt(4)
    v_lshlrev_b32 v64, 16, v36
    v_and_b32 v65, 0xffff0000, v36
    v_lshlrev_b32 v66, 16, v37
    v_and_b32 v67, 0xffff0000, v37
    v_lshlrev_b32 v68, 16, v38
    v_and_b32 v69, 0xffff0000, v38
    v_lshlrev_b32 v70, 16, v39
    v_and_b32 v71, 0xffff0000, v39
    v_fmac_f32 v56, v12, v64
    v_fmac_f32 v57, v12, v65
    v_fmac_f32 v58, v12, v66
    v_fmac_f32 v59, v12, v67
    v_fmac_f32 v60, v12, v68
    v_fmac_f32 v61, v12, v69
    v_fmac_f32 v62, v12, v70
    v_fmac_f32 v63, v12, v71
    s_waitcnt vmcnt(3)
    v_lshlrev_b32 v64, 16, v40
    v_and_b32 v65, 0xffff0000, v40
    v_lshlrev_b32 v66, 16, v41
    v_and_b32 v67, 0xffff0000, v41
    v_lshlrev_b32 v68, 16, v42
    v_and_b32 v69, 0xffff0000, v42
    v_lshlrev_b32 v70, 16, v43
    v_and_b32 v71, 0xffff0000, v43
    v_fmac_f32 v56, v13, v64
    v_fmac_f32 v57, v13, v65
    v_fmac_f32 v58, v13, v66
    v_fmac_f32 v59, v13, v67
    v_fmac_f32 v60, v13, v68
    v_fmac_f32 v61, v13, v69
    v_fmac_f32 v62, v13, v70
    v_fmac_f32 v63, v13, v71
    s_waitcnt vmcnt(2)
    v_lshlrev_b32 v64, 16, v44
    v_and_b32 v65, 0xffff0000, v44
    v_lshlrev_b32 v66, 16, v45
    v_and_b32 v67, 0xffff0000, v45
    v_lshlrev_b32 v68, 16, v46
    v_and_b32 v69, 0xffff0000, v46
    v_lshlrev_b32 v70, 16, v47
    v_and_b32 v71, 0xffff0000, v47
    v_fmac_f32 v56, v14, v64
    v_fmac_f32 v57, v14, v65
    v_fmac_f32 v58, v14, v66
    v_fmac_f32 v59, v14, v67
    v_fmac_f32 v60, v14, v68
    v_fmac_f32 v61, v14, v69
    v_fmac_f32 v62, v14, v70
    v_fmac_f32 v63, v14, v71
    s_waitcnt vmcnt(1)
    v_lshlrev_b32 v64, 16, v48
    v_and_b32 v65, 0xffff0000, v48
    v_lshlrev_b32 v66, 16, v49
    v_and_b32 v67, 0xffff0000, v49
    v_lshlrev_b32 v68, 16, v50
    v_and_b32 v69, 0xffff0000, v50
    v_lshlrev_b32 v70, 16, v51
    v_and_b32 v71, 0xffff0000, v51
    v_fmac_f32 v56, v15, v64
    v_fmac_f32 v57, v15, v65
    v_fmac_f32 v58, v15, v66
    v_fmac_f32 v59, v15, v67
    v_fmac_f32 v60, v15, v68
    v_fmac_f32 v61, v15, v69
    v_fmac_f32 v62, v15, v70
    v_fmac_f32 v63, v15, v71
    s_waitcnt vmcnt(0)
    v_lshlrev_b32 v64, 16, v52
    v_and_b32 v65, 0xffff0000, v52
    v_lshlrev_b32 v66, 16, v53
    v_and_b32 v67, 0xffff0000, v53
    v_lshlrev_b32 v68, 16, v54
    v_and_b32 v69, 0xffff0000, v54
    v_lshlrev_b32 v70, 16, v55
    v_and_b32 v71, 0xffff0000, v55
    v_fmac_f32 v56, v16, v64
    v_fmac_f32 v57, v16, v65
    v_fmac_f32 v58, v16, v66
    v_fmac_f32 v59, v16, v67
    v_fmac_f32 v60, v16, v68
    v_fmac_f32 v61, v16, v69
    v_fmac_f32 v62, v16, v70
    v_fmac_f32 v63, v16, v71
    s_nop 1
    v_add_f32_dpp v56, v56, v56 row_ror:4 row_mask:0xf bank_mask:0xf
    v_add_f32_dpp v57, v57, v57 row_ror:4 row_mask:0xf bank_mask:0xf
    v_add_f32_dpp v58, v58, v58 row_ror:4 row_mask:0xf bank_mask:0xf
    v_add_f32_dpp v59, v59, v59 row_ror:4 row_mask:0xf bank_mask:0xf
    v_add_f32_dpp v60, v60, v60 row_ror:4 row_mask:0xf bank_mask:0xf
    v_add_f32_dpp v61, v61, v61 row_ror:4 row_mask:0xf bank_mask:0xf
    v_add_f32_dpp v62, v62, v62 row_ror:4 row_mask:0xf bank_mask:0xf
    v_add_f32_dpp v63, v63, v63 row_ror:4 row_mask:0xf bank_mask:0xf
    s_nop 1
    v_add_f32_dpp v56, v56, v56 row_ror:8 row_mask:0xf bank_mask:0xf
    v_add_f32_dpp v57, v57, v57 row_ror:8 row_mask:0xf bank_mask:0xf
    v_add_f32_dpp v58, v58, v58 row_ror:8 row_mask:0xf bank_mask:0xf
    v_add_f32_dpp v59, v59, v59 row_ror:8 row_mask:0xf bank_mask:0xf
    v_add_f32_dpp v60, v60, v60 row_ror:8 row_mask:0xf bank_mask:0xf
    v_add_f32_dpp v61, v61, v61 row_ror:8 row_mask:0xf bank_mask:0xf
    v_add_f32_dpp v62, v62, v62 row_ror:8 row_mask:0xf bank_mask:0xf
    v_add_f32_dpp v63, v63, v63 row_ror:8 row_mask:0xf bank_mask:0xf
    v_mov_b32 v64, v56
    v_mov_b32 v65, v57
    v_mov_b32 v66, v58
    v_mov_b32 v67, v59
    v_mov_b32 v68, v60
    v_mov_b32 v69, v61
    v_mov_b32 v70, v62
    v_mov_b32 v71, v63
    s_nop 1
    v_permlane16_swap_b32 v56, v64
    v_permlane16_swap_b32 v57, v65
    v_permlane16_swap_b32 v58, v66
    v_permlane16_swap_b32 v59, v67
    v_permlane16_swap_b32 v60, v68
    v_permlane16_swap_b32 v61, v69
    v_permlane16_swap_b32 v62, v70
    v_permlane16_swap_b32 v63, v71
    s_nop 1
    v_add_f32 v56, v56, v64
    v_add_f32 v57, v57, v65
    v_add_f32 v58, v58, v66
    v_add_f32 v59, v59, v67
    v_add_f32 v60, v60, v68
    v_add_f32 v61, v61, v69
    v_add_f32 v62, v62, v70
    v_add_f32 v63, v63, v71
    v_mov_b32 v64, v56
    v_mov_b32 v65, v57
    v_mov_b32 v66, v58
    v_mov_b32 v67, v59
    v_mov_b32 v68, v60
    v_mov_b32 v69, v61
    v_mov_b32 v70, v62
    v_mov_b32 v71, v63
    s_nop 1
    v_permlane32_swap_b32 v56, v64
    v_permlane32_swap_b32 v57, v65
    v_permlane32_swap_b32 v58, v66
    v_permlane32_swap_b32 v59, v67
    v_permlane32_swap_b32 v60, v68
    v_permlane32_swap_b32 v61, v69
    v_permlane32_swap_b32 v62, v70
    v_permlane32_swap_b32 v63, v71
    s_nop 1
    v_add_f32 v56, v56, v64
    v_add_f32 v57, v57, v65
    v_add_f32 v58, v58, v66
    v_add_f32 v59, v59, v67
    v_add_f32 v60, v60, v68
    v_add_f32 v61, v61, v69
    v_add_f32 v62, v62, v70
    v_add_f32 v63, v63, v71
    v_lshrrev_b32 v5, 6, v0
    v_lshlrev_b32 v5, 7, v5
    v_lshl_add_u32 v5, v1, 5, v5
    ds_write_b128 v5, v[56:59]
    ds_write_b128 v5, v[60:63] offset:16
    s_waitcnt lgkmcnt(0)
    s_barrier
    v_cmp_gt_u32 vcc, 32, v0
    s_and_saveexec_b64 s[22:23], vcc
    s_cbranch_execz Lmod_end
    v_lshlrev_b32 v5, 2, v0
    ds_read2_b32 v[6:7], v5 offset0:0 offset1:32
    ds_read2_b32 v[8:9], v5 offset0:64 offset1:96
    s_lshl_b32 s3, s2, 7
    s_waitcnt lgkmcnt(0)
    v_add_f32 v6, v6, v7
    v_add_f32 v8, v8, v9
    v_add_f32 v6, v6, v8
    v_cvt_pk_bf16_f32 v6, v6, v6
    v_and_b32 v6, 0xffff0000, v6
    buffer_store_dword v6, v5, s[16:19], s3 offen
    s_mul_i32 s20, s2, 3641
    s_lshr_b32 s20, s20, 16
    s_cmp_eq_u32 s20, 1
    s_cselect_b32 s21, 1.0, 0
    s_cmp_eq_u32 s20, 4
    s_cselect_b32 s21, 1.0, s21
    v_add_f32 v7, s21, v6
    v_cvt_pk_bf16_f32 v7, v7, v7
    v_bfe_u32 v8, v0, 2, 2
    v_lshlrev_b32 v8, 4, v8
    v_lshrrev_b32 v9, 4, v0
    v_lshl_add_u32 v8, v9, 3, v8
    v_lshl_add_u32 v8, v1, 1, v8
    s_lshl_b32 s3, s2, 6
    s_add_u32 s3, s3, 16384
    buffer_store_short v7, v8, s[16:19], s3 offen
Lmod_end:
    s_endpgm
.globl ln1_kernel
.p2align 8
.type ln1_kernel,@function
ln1_kernel:
    s_cmp_ge_u32 s2, 256
    s_cbranch_scc1 Lln1_end
    s_load_dwordx2 s[4:5], s[0:1], 0
    s_load_dwordx2 s[6:7], s[0:1], 112
    v_and_b32 v1, 7, v0
    v_lshrrev_b32 v2, 5, v0
    v_lshlrev_b32 v2, 6, v2
    v_and_b32 v3, 24, v0
    v_add_u32 v2, v2, v3
    s_lshl_b32 s3, s2, 3
    v_add_u32 v3, s3, v1
    v_mul_u32_u24 v3, 1152, v3
    v_add_u32 v3, v3, v2
    v_lshlrev_b32 v5, 7, v1
    v_lshrrev_b32 v4, 6, v0
    v_lshl_add_u32 v4, v4, 2, v5
    v_lshlrev_b32 v6, 1, v2
    s_waitcnt lgkmcnt(0)
    s_mov_b32 s8, s4
    s_mov_b32 s9, s5
    s_mov_b32 s10, 2359296
    s_mov_b32 s11, 0x20000
    s_mov_b32 s12, s6
    s_mov_b32 s13, s7
    s_mov_b32 s14, 13824
    s_mov_b32 s15, 0x20000
    s_add_u32 s16, s6, 65536
    s_addc_u32 s17, s7, 0
    s_mov_b32 s18, 2359296
    s_mov_b32 s19, 0x20000
    buffer_load_dwordx2 v[8:9], v3, s[8:11], 0 offen
    buffer_load_dwordx2 v[10:11], v3, s[8:11], 0 offen offset:32
    s_mov_b32 s30, 0
    buffer_load_dwordx4 v[24:27], v6, s[12:15], s30 offen
    buffer_load_dwordx4 v[28:31], v6, s[12:15], s30 offen offset:64
    s_mov_b32 s30, 2304
    buffer_load_dwordx4 v[32:35], v6, s[12:15], s30 offen
    buffer_load_dwordx4 v[36:39], v6, s[12:15], s30 offen offset:64
    s_add_u32 s24, s6, 7856128
    s_addc_u32 s25, s7, 0
    s_mov_b32 s26, 671744
    s_mov_b32 s27, 0x20000
    s_mul_i32 s20, s2, 4608
    v_lshlrev_b32 v7, 3, v0
    v_mov_b32 v12, -1
    v_mov_b32 v13, -1
    buffer_store_dwordx2 v[12:13], v7, s[24:27], s20 offen
    s_lshr_b32 s20, s2, 1
    s_mul_i32 s20, s20, 18432
    s_and_b32 s21, s2, 1
    s_lshl_b32 s21, s21, 7
    s_add_u32 s20, s20, s21
    v_lshrrev_b32 v7, 3, v0
    v_lshlrev_b32 v7, 8, v7
    v_lshl_add_u32 v7, v1, 4, v7
    s_waitcnt vmcnt(5)
    v_lshlrev_b32 v16, 16, v8
    v_and_b32 v17, 0xffff0000, v8
    v_lshlrev_b32 v18, 16, v9
    v_and_b32 v19, 0xffff0000, v9
    v_lshlrev_b32 v20, 16, v10
    v_and_b32 v21, 0xffff0000, v10
    v_lshlrev_b32 v22, 16, v11
    v_and_b32 v23, 0xffff0000, v11
    v_add_f32 v40, v16, v17
    v_add_f32 v40, v40, v18
    v_add_f32 v40, v40, v19
    v_add_f32 v40, v40, v20
    v_add_f32 v40, v40, v21
    v_add_f32 v40, v40, v22
    v_add_f32 v40, v40, v23
    s_nop 1
    v_add_f32_dpp v40, v40, v40 row_ror:8 row_mask:0xf bank_mask:0xf
    v_mov_b32 v42, v40
    s_nop 1
    v_permlane16_swap_b32 v40, v42
    s_nop 1
    v_add_f32 v40, v40, v42
    v_mov_b32 v42, v40
    s_nop 1
    v_permlane32_swap_b32 v40, v42
    s_nop 1
    v_add_f32 v40, v40, v42
    v_mul_f32 v40, 0x3c800000, v40
    v_sub_f32 v64, v16, v40
    v_sub_f32 v65, v17, v40
    v_sub_f32 v66, v18, v40
    v_sub_f32 v67, v19, v40
    v_sub_f32 v68, v20, v40
    v_sub_f32 v69, v21, v40
    v_sub_f32 v70, v22, v40
    v_sub_f32 v71, v23, v40
    v_mul_f32 v41, v64, v64
    v_fmac_f32 v41, v65, v65
    v_fmac_f32 v41, v66, v66
    v_fmac_f32 v41, v67, v67
    v_fmac_f32 v41, v68, v68
    v_fmac_f32 v41, v69, v69
    v_fmac_f32 v41, v70, v70
    v_fmac_f32 v41, v71, v71
    s_nop 1
    v_add_f32_dpp v41, v41, v41 row_ror:8 row_mask:0xf bank_mask:0xf
    v_mov_b32 v42, v41
    s_nop 1
    v_permlane16_swap_b32 v41, v42
    s_nop 1
    v_add_f32 v41, v41, v42
    v_mov_b32 v42, v41
    s_nop 1
    v_permlane32_swap_b32 v41, v42
    s_nop 1
    v_add_f32 v41, v41, v42
    ds_write2_b32 v4, v40, v41 offset0:0 offset1:16
    s_waitcnt lgkmcnt(0)
    s_barrier
    ds_read_b128 v[44:47], v5
    ds_read_b128 v[48:51], v5 offset:16
    ds_read_b32 v52, v5 offset:32
    ds_read_b128 v[56:59], v5 offset:64
    ds_read_b128 v[60:63], v5 offset:80
    ds_read_b32 v64, v5 offset:96
    s_waitcnt lgkmcnt(3)
    v_add_f32 v40, v44, v45
    v_add_f32 v40, v40, v46
    v_add_f32 v40, v40, v47
    v_add_f32 v40, v40, v48
    v_add_f32 v40, v40, v49
    v_add_f32 v40, v40, v50
    v_add_f32 v40, v40, v51
    v_add_f32 v40, v40, v52
    v_mul_f32 v40, 0x3de38e39, v40
    v_sub_f32 v44, v44, v40
    v_sub_f32 v45, v45, v40
    v_sub_f32 v46, v46, v40
    v_sub_f32 v47, v47, v40
    v_sub_f32 v48, v48, v40
    v_sub_f32 v49, v49, v40
    v_sub_f32 v50, v50, v40
    v_sub_f32 v51, v51, v40
    v_sub_f32 v52, v52, v40
    v_mul_f32 v42, v44, v44
    v_fmac_f32 v42, v45, v45
    v_fmac_f32 v42, v46, v46
    v_fmac_f32 v42, v47, v47
    v_fmac_f32 v42, v48, v48
    v_fmac_f32 v42, v49, v49
    v_fmac_f32 v42, v50, v50
    v_fmac_f32 v42, v51, v51
    v_fmac_f32 v42, v52, v52
    s_waitcnt lgkmcnt(0)
    v_add_f32 v41, v56, v57
    v_add_f32 v41, v41, v58
    v_add_f32 v41, v41, v59
    v_add_f32 v41, v41, v60
    v_add_f32 v41, v41, v61
    v_add_f32 v41, v41, v62
    v_add_f32 v41, v41, v63
    v_add_f32 v41, v41, v64
    v_fmac_f32 v41, 0x42800000, v42
    v_mul_f32 v41, 0x3ae38e39, v41
    v_cvt_pk_bf16_f32 v42, v40, v41
    v_lshlrev_b32 v40, 16, v42
    v_and_b32 v41, 0xffff0000, v42
    v_add_f32 v41, 0x3727c5ac, v41
    v_cvt_pk_bf16_f32 v41, v41, v41
    v_and_b32 v41, 0xffff0000, v41
    v_sqrt_f32 v41, v41
    s_nop 0
    v_cvt_pk_bf16_f32 v41, v41, v41
    v_and_b32 v41, 0xffff0000, v41
    v_rcp_f32 v41, v41
    s_waitcnt vmcnt(0)
    v_sub_f32 v64, v16, v40
    v_sub_f32 v65, v17, v40
    v_sub_f32 v66, v18, v40
    v_sub_f32 v67, v19, v40
    v_sub_f32 v68, v20, v40
    v_sub_f32 v69, v21, v40
    v_sub_f32 v70, v22, v40
    v_sub_f32 v71, v23, v40
    v_cvt_pk_bf16_f32 v42, v64, v65
    v_lshlrev_b32 v64, 16, v42
    v_and_b32 v65, 0xffff0000, v42
    v_cvt_pk_bf16_f32 v42, v66, v67
    v_lshlrev_b32 v66, 16, v42
    v_and_b32 v67, 0xffff0000, v42
    v_cvt_pk_bf16_f32 v42, v68, v69
    v_lshlrev_b32 v68, 16, v42
    v_and_b32 v69, 0xffff0000, v42
    v_cvt_pk_bf16_f32 v42, v70, v71
    v_lshlrev_b32 v70, 16, v42
    v_and_b32 v71, 0xffff0000, v42
    v_mul_f32 v64, v64, v41
    v_mul_f32 v65, v65, v41
    v_mul_f32 v66, v66, v41
    v_mul_f32 v67, v67, v41
    v_mul_f32 v68, v68, v41
    v_mul_f32 v69, v69, v41
    v_mul_f32 v70, v70, v41
    v_mul_f32 v71, v71, v41
    v_cvt_pk_bf16_f32 v42, v64, v65
    v_lshlrev_b32 v64, 16, v42
    v_and_b32 v65, 0xffff0000, v42
    v_cvt_pk_bf16_f32 v42, v66, v67
    v_lshlrev_b32 v66, 16, v42
    v_and_b32 v67, 0xffff0000, v42
    v_cvt_pk_bf16_f32 v42, v68, v69
    v_lshlrev_b32 v68, 16, v42
    v_and_b32 v69, 0xffff0000, v42
    v_cvt_pk_bf16_f32 v42, v70, v71
    v_lshlrev_b32 v70, 16, v42
    v_and_b32 v71, 0xffff0000, v42
    v_add_f32 v32, 1.0, v32
    v_add_f32 v33, 1.0, v33
    v_add_f32 v34, 1.0, v34
    v_add_f32 v35, 1.0, v35
    v_add_f32 v36, 1.0, v36
    v_add_f32 v37, 1.0, v37
    v_add_f32 v38, 1.0, v38
    v_add_f32 v39, 1.0, v39
    v_cvt_pk_bf16_f32 v42, v32, v33
    v_lshlrev_b32 v32, 16, v42
    v_and_b32 v33, 0xffff0000, v42
    v_cvt_pk_bf16_f32 v42, v34, v35
    v_lshlrev_b32 v34, 16, v42
    v_and_b32 v35, 0xffff0000, v42
    v_cvt_pk_bf16_f32 v42, v36, v37
    v_lshlrev_b32 v36, 16, v42
    v_and_b32 v37, 0xffff0000, v42
    v_cvt_pk_bf16_f32 v42, v38, v39
    v_lshlrev_b32 v38, 16, v42
    v_and_b32 v39, 0xffff0000, v42
    v_mul_f32 v64, v64, v32
    v_mul_f32 v65, v65, v33
    v_mul_f32 v66, v66, v34
    v_mul_f32 v67, v67, v35
    v_mul_f32 v68, v68, v36
    v_mul_f32 v69, v69, v37
    v_mul_f32 v70, v70, v38
    v_mul_f32 v71, v71, v39
    v_cvt_pk_bf16_f32 v42, v64, v65
    v_lshlrev_b32 v64, 16, v42
    v_and_b32 v65, 0xffff0000, v42
    v_cvt_pk_bf16_f32 v42, v66, v67
    v_lshlrev_b32 v66, 16, v42
    v_and_b32 v67, 0xffff0000, v42
    v_cvt_pk_bf16_f32 v42, v68, v69
    v_lshlrev_b32 v68, 16, v42
    v_and_b32 v69, 0xffff0000, v42
    v_cvt_pk_bf16_f32 v42, v70, v71
    v_lshlrev_b32 v70, 16, v42
    v_and_b32 v71, 0xffff0000, v42
    v_add_f32 v64, v64, v24
    v_add_f32 v65, v65, v25
    v_add_f32 v66, v66, v26
    v_add_f32 v67, v67, v27
    v_add_f32 v68, v68, v28
    v_add_f32 v69, v69, v29
    v_add_f32 v70, v70, v30
    v_add_f32 v71, v71, v31
    v_cvt_pk_bf16_f32 v8, v64, v65
    v_cvt_pk_bf16_f32 v9, v66, v67
    v_cvt_pk_bf16_f32 v10, v68, v69
    v_cvt_pk_bf16_f32 v11, v70, v71
    buffer_store_dwordx4 v[8:11], v7, s[16:19], s20 offen
Lln1_end:
    s_endpgm
.globl attn_kernel
.p2align 8
.type attn_kernel,@function
attn_kernel:
    s_cmp_ge_u32 s2, 256
    s_cbranch_scc1 Lattn_end
    s_load_dwordx8 s[52:59], s[0:1], 8
    s_load_dwordx2 s[50:51], s[0:1], 112
    s_load_dwordx4 s[80:83], s[0:1], 56
    s_load_dwordx2 s[84:85], s[0:1], 72
    s_getpc_b64 s[32:33]
Lattn_pc:
    s_mov_b32 s34, Lattn_end-Lattn_pc
    s_mov_b32 s35, 0x20000
    v_lshlrev_b32 v2, 6, v0
    v_lshrrev_b32 v3, 6, v0
    v_and_b32 v1, 63, v0
    v_readfirstlane_b32 s3, v3
    s_mov_b32 s49, 0
    buffer_load_dword v216, v2, s[32:35], s49 offen
    s_mov_b32 s49, 16384
    buffer_load_dword v217, v2, s[32:35], s49 offen
    s_mov_b32 s49, 32768
    buffer_load_dword v218, v2, s[32:35], s49 offen
    s_mov_b32 s49, 49152
    buffer_load_dword v219, v2, s[32:35], s49 offen
    s_and_b32 s4, s2, 7
    s_lshl_b32 s4, s4, 1
    s_bfe_u32 s5, s2, 0x10003
    s_add_u32 s4, s4, s5
    s_lshr_b32 s5, s2, 4
    s_lshl_b32 s42, s3, 12
    v_lshrrev_b32 v2, 4, v1
    v_and_b32 v3, 15, v1
    v_lshlrev_b32 v51, 4, v1
    s_lshl_b32 s6, s5, 2
    s_add_u32 s6, s6, s3
    s_mul_i32 s46, s6, 36864
    s_lshl_b32 s44, s4, 9
    s_mul_i32 s45, s4, 294912
    s_lshl_b32 s7, s3, 4
    v_add_u32 v4, s7, v2
    v_lshlrev_b32 v5, 1, v2
    v_xor_b32 v5, v5, v3
    v_xor_b32 v6, 8, v5
    v_lshlrev_b32 v7, 13, v4
    v_lshl_add_u32 v42, v5, 4, v7
    v_lshl_add_u32 v43, v6, 4, v7
    v_add_u32 v44, 63488, v42
    v_add_u32 v45, 95232, v43
    v_add_u32 v43, 31744, v43
    s_waitcnt lgkmcnt(0)
    s_mov_b32 s16, s56
    s_mov_b32 s17, s57
    s_mov_b32 s18, 4718592
    s_mov_b32 s19, 0x20000
    s_add_u32 s24, s50, 65536
    s_addc_u32 s25, s51, 0
    s_mov_b32 s26, 2359296
    s_mov_b32 s27, 0x20000
    s_add_u32 s49, s46, 0
    buffer_load_dwordx4 a[0:3], v51, s[24:27], s49 offen
    buffer_load_dwordx4 a[8:11], v51, s[24:27], s49 offen offset:1024
    s_add_u32 s49, s46, 18432
    buffer_load_dwordx4 a[4:7], v51, s[24:27], s49 offen
    buffer_load_dwordx4 a[12:15], v51, s[24:27], s49 offen offset:1024
    s_add_u32 s49, s44, 0
    s_add_u32 m0, s42, 32768
    s_nop 0
    buffer_load_dwordx4 v42, s[16:19], s49 offen lds
    buffer_load_dwordx4 v43, s[16:19], s49 offen offset:1024 lds
    buffer_load_dwordx4 v44, s[16:19], s49 offen offset:2048 lds
    buffer_load_dwordx4 v45, s[16:19], s49 offen offset:3072 lds
    s_add_u32 s49, s44, 256
    s_add_u32 m0, s42, 49152
    s_nop 0
    buffer_load_dwordx4 v42, s[16:19], s49 offen lds
    buffer_load_dwordx4 v43, s[16:19], s49 offen offset:1024 lds
    buffer_load_dwordx4 v44, s[16:19], s49 offen offset:2048 lds
    buffer_load_dwordx4 v45, s[16:19], s49 offen offset:3072 lds
    s_add_u32 s49, s46, 2048
    buffer_load_dwordx4 a[16:19], v51, s[24:27], s49 offen
    buffer_load_dwordx4 a[24:27], v51, s[24:27], s49 offen offset:1024
    s_add_u32 s49, s46, 20480
    buffer_load_dwordx4 a[20:23], v51, s[24:27], s49 offen
    buffer_load_dwordx4 a[28:31], v51, s[24:27], s49 offen offset:1024
    s_add_u32 s49, s44, 524288
    s_add_u32 m0, s42, 65536
    s_nop 0
    buffer_load_dwordx4 v42, s[16:19], s49 offen lds
    buffer_load_dwordx4 v43, s[16:19], s49 offen offset:1024 lds
    buffer_load_dwordx4 v44, s[16:19], s49 offen offset:2048 lds
    buffer_load_dwordx4 v45, s[16:19], s49 offen offset:3072 lds
    s_add_u32 s49, s44, 524544
    s_add_u32 m0, s42, 81920
    s_nop 0
    buffer_load_dwordx4 v42, s[16:19], s49 offen lds
    buffer_load_dwordx4 v43, s[16:19], s49 offen offset:1024 lds
    buffer_load_dwordx4 v44, s[16:19], s49 offen offset:2048 lds
    buffer_load_dwordx4 v45, s[16:19], s49 offen offset:3072 lds
    s_add_u32 s49, s46, 4096
    buffer_load_dwordx4 a[32:35], v51, s[24:27], s49 offen
    buffer_load_dwordx4 a[40:43], v51, s[24:27], s49 offen offset:1024
    s_add_u32 s49, s46, 22528
    buffer_load_dwordx4 a[36:39], v51, s[24:27], s49 offen
    buffer_load_dwordx4 a[44:47], v51, s[24:27], s49 offen offset:1024
    s_add_u32 s49, s44, 1048576
    s_add_u32 m0, s42, 98304
    s_nop 0
    buffer_load_dwordx4 v42, s[16:19], s49 offen lds
    buffer_load_dwordx4 v43, s[16:19], s49 offen offset:1024 lds
    buffer_load_dwordx4 v44, s[16:19], s49 offen offset:2048 lds
    buffer_load_dwordx4 v45, s[16:19], s49 offen offset:3072 lds
    s_add_u32 s49, s44, 1048832
    s_add_u32 m0, s42, 114688
    s_nop 0
    buffer_load_dwordx4 v42, s[16:19], s49 offen lds
    buffer_load_dwordx4 v43, s[16:19], s49 offen offset:1024 lds
    buffer_load_dwordx4 v44, s[16:19], s49 offen offset:2048 lds
    buffer_load_dwordx4 v45, s[16:19], s49 offen offset:3072 lds
    s_add_u32 s49, s46, 6144
    buffer_load_dwordx4 a[48:51], v51, s[24:27], s49 offen
    buffer_load_dwordx4 a[56:59], v51, s[24:27], s49 offen offset:1024
    s_add_u32 s49, s46, 24576
    buffer_load_dwordx4 a[52:55], v51, s[24:27], s49 offen
    buffer_load_dwordx4 a[60:63], v51, s[24:27], s49 offen offset:1024
    s_add_u32 s49, s44, 1572864
    s_add_u32 m0, s42, 131072
    s_nop 0
    buffer_load_dwordx4 v42, s[16:19], s49 offen lds
    buffer_load_dwordx4 v43, s[16:19], s49 offen offset:1024 lds
    buffer_load_dwordx4 v44, s[16:19], s49 offen offset:2048 lds
    buffer_load_dwordx4 v45, s[16:19], s49 offen offset:3072 lds
    s_add_u32 s49, s44, 1573120
    s_add_u32 m0, s42, 147456
    s_nop 0
    buffer_load_dwordx4 v42, s[16:19], s49 offen lds
    buffer_load_dwordx4 v43, s[16:19], s49 offen offset:1024 lds
    buffer_load_dwordx4 v44, s[16:19], s49 offen offset:2048 lds
    buffer_load_dwordx4 v45, s[16:19], s49 offen offset:3072 lds
    s_lshl_b32 s7, s4, 19
    s_add_u32 s8, s52, s7
    s_addc_u32 s9, s53, 0
    s_mov_b32 s10, 524288
    s_mov_b32 s11, 0x20000
    s_add_u32 s12, s54, s7
    s_addc_u32 s13, s55, 0
    s_mov_b32 s14, 524288
    s_mov_b32 s15, 0x20000
    s_mov_b32 s20, s58
    s_mov_b32 s21, s59
    s_mov_b32 s22, 4718592
    s_mov_b32 s23, 0x20000
    s_add_u32 s28, s50, 10485760
    s_addc_u32 s29, s51, 0
    s_mov_b32 s30, 37748736
    s_mov_b32 s31, 0x20000
    v_lshlrev_b32 v7, 8, v4
    v_lshl_add_u32 v40, v5, 4, v7
    v_lshl_add_u32 v41, v6, 4, v7
    v_xor_b32 v224, v3, v2
    v_lshl_add_u32 v36, v224, 4, v7
    v_xor_b32 v37, 64, v36
    v_xor_b32 v38, 128, v36
    v_xor_b32 v39, 192, v36
    v_lshrrev_b32 v7, 3, v5
    v_lshl_add_u32 v7, v7, 7, v4
    v_mul_u32_u24 v7, 1152, v7
    v_and_b32 v225, 7, v5
    v_lshl_add_u32 v46, v225, 4, v7
    v_lshrrev_b32 v7, 3, v6
    v_lshl_add_u32 v7, v7, 7, v4
    v_mul_u32_u24 v7, 1152, v7
    v_and_b32 v225, 7, v6
    v_lshl_add_u32 v47, v225, 4, v7
    v_add_u32 v48, 7168, v46
    v_add_u32 v49, 10752, v47
    v_add_u32 v47, 3584, v47
    v_lshlrev_b32 v7, 8, v3
    v_lshl_add_u32 v8, v224, 4, v7
    v_xor_b32 v9, 64, v8
    v_xor_b32 v10, 128, v8
    v_xor_b32 v11, 192, v8
    v_lshrrev_b32 v5, 2, v1
    v_and_b32 v6, 7, v5
    v_lshlrev_b32 v6, 5, v6
    v_lshl_add_u32 v6, v5, 8, v6
    v_and_b32 v7, 3, v1
    v_lshl_add_u32 v12, v7, 3, v6
    v_xor_b32 v13, 32, v12
    v_xor_b32 v14, 64, v12
    v_xor_b32 v15, 96, v12
    v_xor_b32 v16, 128, v12
    v_xor_b32 v17, 160, v12
    v_xor_b32 v18, 192, v12
    v_xor_b32 v19, 224, v12
    v_add_u32 v20, 65536, v12
    v_add_u32 v21, 65536, v13
    v_add_u32 v22, 65536, v14
    v_add_u32 v23, 65536, v15
    v_add_u32 v24, 65536, v16
    v_add_u32 v25, 65536, v17
    v_add_u32 v26, 65536, v18
    v_add_u32 v27, 65536, v19
    v_add_u32 v28, 131072, v12
    v_add_u32 v29, 131072, v13
    v_add_u32 v30, 131072, v14
    v_add_u32 v31, 131072, v15
    v_add_u32 v32, 131072, v16
    v_add_u32 v33, 131072, v17
    v_add_u32 v34, 131072, v18
    v_add_u32 v35, 131072, v19
    v_mov_b32 v52, 0x3f803f80
    v_mov_b32 v53, 0x3f803f80
    v_mov_b32 v54, 0x3f803f80
    v_mov_b32 v55, 0x3f803f80
    v_and_b32 v5, 1, v1
    v_mul_u32_u24 v5, 0xaaaa, v5
    v_add_u32 v5, 0x4444, v5
    v_lshl_add_u32 v50, v5, 16, v5
    v_lshrrev_b32 v5, 1, v3
    v_mul_u32_u24 v5, 36864, v5
    v_lshl_add_u32 v5, v2, 5, v5
    v_and_b32 v6, 1, v3
    v_lshl_add_u32 v56, v6, 4, v5
    s_mul_i32 s47, s6, 589824
    s_mul_i32 s7, s4, 2304
    s_add_u32 s47, s47, s7
    s_mov_b32 s32, s82
    s_mov_b32 s33, s83
    s_mov_b32 s34, 5308416
    s_mov_b32 s35, 0x20000
    s_mov_b32 s82, 5308416
    s_mov_b32 s83, 0x20000
    s_mov_b32 s86, 5308416
    s_mov_b32 s87, 0x20000
    s_lshr_b32 s7, s2, 3
    s_mul_i32 s7, s7, 18
    s_add_u32 s7, s7, s3
    s_and_b32 s36, s2, 7
    s_mul_i32 s37, s36, 576
    s_add_u32 s37, s37, s7
    s_mul_i32 s37, s37, 1152
    s_mul_i32 s7, s7, 9216
    s_mul_i32 s36, s36, 1152
    s_add_u32 s7, s7, s36
    v_min_u32 v5, 17, v1
    v_lshl_add_u32 v57, v5, 6, s7
    v_lshl_add_u32 v62, v5, 6, s37
    s_mov_b32 s40, 0
    s_mov_b32 s41, 0
    s_mov_b32 s48, 0
    s_waitcnt vmcnt(36)
    s_barrier
    ds_read_b64_tr_b16 a[160:161], v12 offset:32768
    ds_read_b64_tr_b16 a[162:163], v12 offset:36864
    ds_read_b64_tr_b16 a[164:165], v12 offset:40960
    ds_read_b64_tr_b16 a[166:167], v12 offset:45056
    ds_read_b64_tr_b16 a[168:169], v13 offset:32768
    ds_read_b64_tr_b16 a[170:171], v13 offset:36864
    ds_read_b64_tr_b16 a[172:173], v13 offset:40960
    ds_read_b64_tr_b16 a[174:175], v13 offset:45056
    ds_read_b64_tr_b16 a[176:177], v14 offset:32768
    ds_read_b64_tr_b16 a[178:179], v14 offset:36864
    ds_read_b64_tr_b16 a[180:181], v14 offset:40960
    ds_read_b64_tr_b16 a[182:183], v14 offset:45056
    s_waitcnt lgkmcnt(10)
    v_mfma_f32_16x16x32_bf16 v[128:131], a[160:163], a[0:3], 0
    s_waitcnt lgkmcnt(8)
    ds_read_b64_tr_b16 a[184:185], v15 offset:32768
    v_mfma_f32_16x16x32_bf16 v[128:131], a[164:167], a[8:11], v[128:131]
    ds_read_b64_tr_b16 a[186:187], v15 offset:36864
    v_mfma_f32_16x16x32_bf16 v[132:135], a[160:163], a[4:7], 0
    s_add_u32 s49, s46, 8192
    ds_read_b64_tr_b16 a[188:189], v15 offset:40960
    v_mfma_f32_16x16x32_bf16 v[132:135], a[164:167], a[12:15], v[132:135]
    s_waitcnt lgkmcnt(9)
    ds_read_b64_tr_b16 a[190:191], v15 offset:45056
    buffer_load_dwordx4 a[64:67], v51, s[24:27], s49 offen
    v_mfma_f32_16x16x32_bf16 v[136:139], a[168:171], a[0:3], 0
    s_waitcnt lgkmcnt(8)
    ds_read_b64_tr_b16 a[160:161], v16 offset:32768
    v_mfma_f32_16x16x32_bf16 v[136:139], a[172:175], a[8:11], v[136:139]
    ds_read_b64_tr_b16 a[162:163], v16 offset:36864
    v_mfma_f32_16x16x32_bf16 v[140:143], a[168:171], a[4:7], 0
    ds_read_b64_tr_b16 a[164:165], v16 offset:40960
    v_mfma_f32_16x16x32_bf16 v[140:143], a[172:175], a[12:15], v[140:143]
    s_waitcnt lgkmcnt(9)
    ds_read_b64_tr_b16 a[166:167], v16 offset:45056
    buffer_load_dwordx4 a[72:75], v51, s[24:27], s49 offen offset:1024
    v_mfma_f32_16x16x32_bf16 v[144:147], a[176:179], a[0:3], 0
    s_waitcnt lgkmcnt(8)
    ds_read_b64_tr_b16 a[168:169], v17 offset:32768
    v_mfma_f32_16x16x32_bf16 v[144:147], a[180:183], a[8:11], v[144:147]
    ds_read_b64_tr_b16 a[170:171], v17 offset:36864
    v_mfma_f32_16x16x32_bf16 v[148:151], a[176:179], a[4:7], 0
    s_add_u32 s49, s46, 26624
    ds_read_b64_tr_b16 a[172:173], v17 offset:40960
    v_mfma_f32_16x16x32_bf16 v[148:151], a[180:183], a[12:15], v[148:151]
    s_waitcnt lgkmcnt(9)
    ds_read_b64_tr_b16 a[174:175], v17 offset:45056
    buffer_load_dwordx4 a[68:71], v51, s[24:27], s49 offen
    v_mfma_f32_16x16x32_bf16 v[152:155], a[184:187], a[0:3], 0
    s_waitcnt lgkmcnt(8)
    ds_read_b64_tr_b16 a[176:177], v18 offset:32768
    v_mfma_f32_16x16x32_bf16 v[152:155], a[188:191], a[8:11], v[152:155]
    ds_read_b64_tr_b16 a[178:179], v18 offset:36864
    v_mfma_f32_16x16x32_bf16 v[156:159], a[184:187], a[4:7], 0
    ds_read_b64_tr_b16 a[180:181], v18 offset:40960
    v_mfma_f32_16x16x32_bf16 v[156:159], a[188:191], a[12:15], v[156:159]
    s_waitcnt lgkmcnt(9)
    ds_read_b64_tr_b16 a[182:183], v18 offset:45056
    buffer_load_dwordx4 a[76:79], v51, s[24:27], s49 offen offset:1024
    v_mfma_f32_16x16x32_bf16 v[160:163], a[160:163], a[0:3], 0
    s_waitcnt lgkmcnt(8)
    ds_read_b64_tr_b16 a[184:185], v19 offset:32768
    v_mfma_f32_16x16x32_bf16 v[160:163], a[164:167], a[8:11], v[160:163]
    s_add_u32 s49, s44, 2097152
    ds_read_b64_tr_b16 a[186:187], v19 offset:36864
    v_mfma_f32_16x16x32_bf16 v[164:167], a[160:163], a[4:7], 0
    s_add_u32 m0, s42, 0
    ds_read_b64_tr_b16 a[188:189], v19 offset:40960
    v_mfma_f32_16x16x32_bf16 v[164:167], a[164:167], a[12:15], v[164:167]
    s_waitcnt lgkmcnt(9)
    ds_read_b64_tr_b16 a[190:191], v19 offset:45056
    buffer_load_dwordx4 v42, s[16:19], s49 offen lds
    v_mfma_f32_16x16x32_bf16 v[168:171], a[168:171], a[0:3], 0
    s_waitcnt lgkmcnt(8)
    ds_read_b64_tr_b16 a[160:161], v12 offset:49152
    v_mfma_f32_16x16x32_bf16 v[168:171], a[172:175], a[8:11], v[168:171]
    ds_read_b64_tr_b16 a[162:163], v12 offset:53248
    v_mfma_f32_16x16x32_bf16 v[172:175], a[168:171], a[4:7], 0
    ds_read_b64_tr_b16 a[164:165], v12 offset:57344
    v_mfma_f32_16x16x32_bf16 v[172:175], a[172:175], a[12:15], v[172:175]
    s_waitcnt lgkmcnt(9)
    ds_read_b64_tr_b16 a[166:167], v12 offset:61440
    buffer_load_dwordx4 v43, s[16:19], s49 offen offset:1024 lds
    v_mfma_f32_16x16x32_bf16 v[176:179], a[176:179], a[0:3], 0
    s_waitcnt lgkmcnt(8)
    ds_read_b64_tr_b16 a[168:169], v13 offset:49152
    v_mfma_f32_16x16x32_bf16 v[176:179], a[180:183], a[8:11], v[176:179]
    ds_read_b64_tr_b16 a[170:171], v13 offset:53248
    v_mfma_f32_16x16x32_bf16 v[180:183], a[176:179], a[4:7], 0
    ds_read_b64_tr_b16 a[172:173], v13 offset:57344
    v_mfma_f32_16x16x32_bf16 v[180:183], a[180:183], a[12:15], v[180:183]
    s_waitcnt lgkmcnt(9)
    ds_read_b64_tr_b16 a[174:175], v13 offset:61440
    buffer_load_dwordx4 v44, s[16:19], s49 offen offset:2048 lds
    v_mfma_f32_16x16x32_bf16 v[184:187], a[184:187], a[0:3], 0
    s_waitcnt lgkmcnt(8)
    ds_read_b64_tr_b16 a[176:177], v14 offset:49152
    v_mfma_f32_16x16x32_bf16 v[184:187], a[188:191], a[8:11], v[184:187]
    ds_read_b64_tr_b16 a[178:179], v14 offset:53248
    v_mfma_f32_16x16x32_bf16 v[188:191], a[184:187], a[4:7], 0
    ds_read_b64_tr_b16 a[180:181], v14 offset:57344
    v_mfma_f32_16x16x32_bf16 v[188:191], a[188:191], a[12:15], v[188:191]
    s_waitcnt lgkmcnt(9)
    ds_read_b64_tr_b16 a[182:183], v14 offset:61440
    buffer_load_dwordx4 v45, s[16:19], s49 offen offset:3072 lds
    v_mfma_f32_16x16x32_bf16 v[192:195], a[160:163], a[0:3], 0
    s_waitcnt lgkmcnt(8)
    ds_read_b64_tr_b16 a[184:185], v15 offset:49152
    v_mfma_f32_16x16x32_bf16 v[192:195], a[164:167], a[8:11], v[192:195]
    s_add_u32 s49, s44, 2097408
    ds_read_b64_tr_b16 a[186:187], v15 offset:53248
    v_mfma_f32_16x16x32_bf16 v[196:199], a[160:163], a[4:7], 0
    s_add_u32 m0, s42, 16384
    ds_read_b64_tr_b16 a[188:189], v15 offset:57344
    v_mfma_f32_16x16x32_bf16 v[196:199], a[164:167], a[12:15], v[196:199]
    s_waitcnt lgkmcnt(9)
    ds_read_b64_tr_b16 a[190:191], v15 offset:61440
    buffer_load_dwordx4 v42, s[16:19], s49 offen lds
    v_mfma_f32_16x16x32_bf16 v[200:203], a[168:171], a[0:3], 0
    s_waitcnt lgkmcnt(8)
    ds_read_b64_tr_b16 a[160:161], v16 offset:49152
    v_mfma_f32_16x16x32_bf16 v[200:203], a[172:175], a[8:11], v[200:203]
    ds_read_b64_tr_b16 a[162:163], v16 offset:53248
    v_mfma_f32_16x16x32_bf16 v[204:207], a[168:171], a[4:7], 0
    ds_read_b64_tr_b16 a[164:165], v16 offset:57344
    v_mfma_f32_16x16x32_bf16 v[204:207], a[172:175], a[12:15], v[204:207]
    s_waitcnt lgkmcnt(9)
    ds_read_b64_tr_b16 a[166:167], v16 offset:61440
    buffer_load_dwordx4 v43, s[16:19], s49 offen offset:1024 lds
    v_mfma_f32_16x16x32_bf16 v[208:211], a[176:179], a[0:3], 0
    s_waitcnt lgkmcnt(8)
    ds_read_b64_tr_b16 a[168:169], v17 offset:49152
    v_mfma_f32_16x16x32_bf16 v[208:211], a[180:183], a[8:11], v[208:211]
    ds_read_b64_tr_b16 a[170:171], v17 offset:53248
    v_mfma_f32_16x16x32_bf16 v[212:215], a[176:179], a[4:7], 0
    ds_read_b64_tr_b16 a[172:173], v17 offset:57344
    v_mfma_f32_16x16x32_bf16 v[212:215], a[180:183], a[12:15], v[212:215]
    s_waitcnt lgkmcnt(9)
    ds_read_b64_tr_b16 a[174:175], v17 offset:61440
    buffer_load_dwordx4 v44, s[16:19], s49 offen offset:2048 lds
    v_mfma_f32_16x16x32_bf16 v[216:219], a[184:187], a[0:3], 0
    s_waitcnt lgkmcnt(8)
    ds_read_b64_tr_b16 a[176:177], v18 offset:49152
    v_mfma_f32_16x16x32_bf16 v[216:219], a[188:191], a[8:11], v[216:219]
    ds_read_b64_tr_b16 a[178:179], v18 offset:53248
    v_mfma_f32_16x16x32_bf16 v[220:223], a[184:187], a[4:7], 0
    ds_read_b64_tr_b16 a[180:181], v18 offset:57344
    v_mfma_f32_16x16x32_bf16 v[220:223], a[188:191], a[12:15], v[220:223]
    s_waitcnt lgkmcnt(9)
    ds_read_b64_tr_b16 a[182:183], v18 offset:61440
    buffer_load_dwordx4 v45, s[16:19], s49 offen offset:3072 lds
    v_mfma_f32_16x16x32_bf16 v[224:227], a[160:163], a[0:3], 0
    s_waitcnt lgkmcnt(8)
    ds_read_b64_tr_b16 a[184:185], v19 offset:49152
    v_mfma_f32_16x16x32_bf16 v[224:227], a[164:167], a[8:11], v[224:227]
    ds_read_b64_tr_b16 a[186:187], v19 offset:53248
    v_mfma_f32_16x16x32_bf16 v[228:231], a[160:163], a[4:7], 0
    ds_read_b64_tr_b16 a[188:189], v19 offset:57344
    v_mfma_f32_16x16x32_bf16 v[228:231], a[164:167], a[12:15], v[228:231]
    s_waitcnt lgkmcnt(9)
    ds_read_b64_tr_b16 a[190:191], v19 offset:61440
    s_waitcnt vmcnt(36)
    s_barrier
    v_mfma_f32_16x16x32_bf16 v[232:235], a[168:171], a[0:3], 0
    s_waitcnt lgkmcnt(8)
    ds_read_b64_tr_b16 a[160:161], v20 offset:0
    v_mfma_f32_16x16x32_bf16 v[232:235], a[172:175], a[8:11], v[232:235]
    ds_read_b64_tr_b16 a[162:163], v20 offset:4096
    v_mfma_f32_16x16x32_bf16 v[236:239], a[168:171], a[4:7], 0
    ds_read_b64_tr_b16 a[164:165], v20 offset:8192
    v_mfma_f32_16x16x32_bf16 v[236:239], a[172:175], a[12:15], v[236:239]
    s_waitcnt lgkmcnt(9)
    ds_read_b64_tr_b16 a[166:167], v20 offset:12288
    v_mfma_f32_16x16x32_bf16 v[240:243], a[176:179], a[0:3], 0
    s_waitcnt lgkmcnt(8)
    ds_read_b64_tr_b16 a[168:169], v21 offset:0
    v_mfma_f32_16x16x32_bf16 v[240:243], a[180:183], a[8:11], v[240:243]
    ds_read_b64_tr_b16 a[170:171], v21 offset:4096
    v_mfma_f32_16x16x32_bf16 v[244:247], a[176:179], a[4:7], 0
    ds_read_b64_tr_b16 a[172:173], v21 offset:8192
    v_mfma_f32_16x16x32_bf16 v[244:247], a[180:183], a[12:15], v[244:247]
    s_waitcnt lgkmcnt(9)
    ds_read_b64_tr_b16 a[174:175], v21 offset:12288
    v_mfma_f32_16x16x32_bf16 v[248:251], a[184:187], a[0:3], 0
    s_waitcnt lgkmcnt(8)
    ds_read_b64_tr_b16 a[176:177], v22 offset:0
    v_mfma_f32_16x16x32_bf16 v[248:251], a[188:191], a[8:11], v[248:251]
    ds_read_b64_tr_b16 a[178:179], v22 offset:4096
    v_mfma_f32_16x16x32_bf16 v[252:255], a[184:187], a[4:7], 0
    ds_read_b64_tr_b16 a[180:181], v22 offset:8192
    v_mfma_f32_16x16x32_bf16 v[252:255], a[188:191], a[12:15], v[252:255]
    s_waitcnt lgkmcnt(9)
    ds_read_b64_tr_b16 a[182:183], v22 offset:12288
    v_mfma_f32_16x16x32_bf16 v[128:131], a[160:163], a[16:19], v[128:131]
    s_waitcnt lgkmcnt(8)
    ds_read_b64_tr_b16 a[184:185], v23 offset:0
    v_mfma_f32_16x16x32_bf16 v[128:131], a[164:167], a[24:27], v[128:131]
    ds_read_b64_tr_b16 a[186:187], v23 offset:4096
    v_mfma_f32_16x16x32_bf16 v[132:135], a[160:163], a[20:23], v[132:135]
    ds_read_b64_tr_b16 a[188:189], v23 offset:8192
    v_mfma_f32_16x16x32_bf16 v[132:135], a[164:167], a[28:31], v[132:135]
    s_waitcnt lgkmcnt(9)
    ds_read_b64_tr_b16 a[190:191], v23 offset:12288
    v_mfma_f32_16x16x32_bf16 v[136:139], a[168:171], a[16:19], v[136:139]
    s_waitcnt lgkmcnt(8)
    ds_read_b64_tr_b16 a[160:161], v24 offset:0
    v_mfma_f32_16x16x32_bf16 v[136:139], a[172:175], a[24:27], v[136:139]
    ds_read_b64_tr_b16 a[162:163], v24 offset:4096
    v_mfma_f32_16x16x32_bf16 v[140:143], a[168:171], a[20:23], v[140:143]
    ds_read_b64_tr_b16 a[164:165], v24 offset:8192
    v_mfma_f32_16x16x32_bf16 v[140:143], a[172:175], a[28:31], v[140:143]
    s_waitcnt lgkmcnt(9)
    ds_read_b64_tr_b16 a[166:167], v24 offset:12288
    v_mfma_f32_16x16x32_bf16 v[144:147], a[176:179], a[16:19], v[144:147]
    s_waitcnt lgkmcnt(8)
    ds_read_b64_tr_b16 a[168:169], v25 offset:0
    v_mfma_f32_16x16x32_bf16 v[144:147], a[180:183], a[24:27], v[144:147]
    ds_read_b64_tr_b16 a[170:171], v25 offset:4096
    v_mfma_f32_16x16x32_bf16 v[148:151], a[176:179], a[20:23], v[148:151]
    ds_read_b64_tr_b16 a[172:173], v25 offset:8192
    v_mfma_f32_16x16x32_bf16 v[148:151], a[180:183], a[28:31], v[148:151]
    s_waitcnt lgkmcnt(9)
    ds_read_b64_tr_b16 a[174:175], v25 offset:12288
    v_mfma_f32_16x16x32_bf16 v[152:155], a[184:187], a[16:19], v[152:155]
    s_waitcnt lgkmcnt(8)
    ds_read_b64_tr_b16 a[176:177], v26 offset:0
    v_mfma_f32_16x16x32_bf16 v[152:155], a[188:191], a[24:27], v[152:155]
    ds_read_b64_tr_b16 a[178:179], v26 offset:4096
    v_mfma_f32_16x16x32_bf16 v[156:159], a[184:187], a[20:23], v[156:159]
    ds_read_b64_tr_b16 a[180:181], v26 offset:8192
    v_mfma_f32_16x16x32_bf16 v[156:159], a[188:191], a[28:31], v[156:159]
    s_waitcnt lgkmcnt(9)
    ds_read_b64_tr_b16 a[182:183], v26 offset:12288
    v_mfma_f32_16x16x32_bf16 v[160:163], a[160:163], a[16:19], v[160:163]
    s_waitcnt lgkmcnt(8)
    ds_read_b64_tr_b16 a[184:185], v27 offset:0
    v_mfma_f32_16x16x32_bf16 v[160:163], a[164:167], a[24:27], v[160:163]
    ds_read_b64_tr_b16 a[186:187], v27 offset:4096
    v_mfma_f32_16x16x32_bf16 v[164:167], a[160:163], a[20:23], v[164:167]
    ds_read_b64_tr_b16 a[188:189], v27 offset:8192
    v_mfma_f32_16x16x32_bf16 v[164:167], a[164:167], a[28:31], v[164:167]
    s_waitcnt lgkmcnt(9)
    ds_read_b64_tr_b16 a[190:191], v27 offset:12288
    v_mfma_f32_16x16x32_bf16 v[168:171], a[168:171], a[16:19], v[168:171]
    s_waitcnt lgkmcnt(8)
    ds_read_b64_tr_b16 a[160:161], v20 offset:16384
    v_mfma_f32_16x16x32_bf16 v[168:171], a[172:175], a[24:27], v[168:171]
    ds_read_b64_tr_b16 a[162:163], v20 offset:20480
    v_mfma_f32_16x16x32_bf16 v[172:175], a[168:171], a[20:23], v[172:175]
    ds_read_b64_tr_b16 a[164:165], v20 offset:24576
    v_mfma_f32_16x16x32_bf16 v[172:175], a[172:175], a[28:31], v[172:175]
    s_waitcnt lgkmcnt(9)
    ds_read_b64_tr_b16 a[166:167], v20 offset:28672
    v_mfma_f32_16x16x32_bf16 v[176:179], a[176:179], a[16:19], v[176:179]
    s_waitcnt lgkmcnt(8)
    ds_read_b64_tr_b16 a[168:169], v21 offset:16384
    v_mfma_f32_16x16x32_bf16 v[176:179], a[180:183], a[24:27], v[176:179]
    ds_read_b64_tr_b16 a[170:171], v21 offset:20480
    v_mfma_f32_16x16x32_bf16 v[180:183], a[176:179], a[20:23], v[180:183]
    ds_read_b64_tr_b16 a[172:173], v21 offset:24576
    v_mfma_f32_16x16x32_bf16 v[180:183], a[180:183], a[28:31], v[180:183]
    s_waitcnt lgkmcnt(9)
    ds_read_b64_tr_b16 a[174:175], v21 offset:28672
    v_mfma_f32_16x16x32_bf16 v[184:187], a[184:187], a[16:19], v[184:187]
    s_waitcnt lgkmcnt(8)
    ds_read_b64_tr_b16 a[176:177], v22 offset:16384
    v_mfma_f32_16x16x32_bf16 v[184:187], a[188:191], a[24:27], v[184:187]
    ds_read_b64_tr_b16 a[178:179], v22 offset:20480
    v_mfma_f32_16x16x32_bf16 v[188:191], a[184:187], a[20:23], v[188:191]
    ds_read_b64_tr_b16 a[180:181], v22 offset:24576
    v_mfma_f32_16x16x32_bf16 v[188:191], a[188:191], a[28:31], v[188:191]
    s_waitcnt lgkmcnt(9)
    ds_read_b64_tr_b16 a[182:183], v22 offset:28672
    v_mfma_f32_16x16x32_bf16 v[192:195], a[160:163], a[16:19], v[192:195]
    s_waitcnt lgkmcnt(8)
    ds_read_b64_tr_b16 a[184:185], v23 offset:16384
    v_mfma_f32_16x16x32_bf16 v[192:195], a[164:167], a[24:27], v[192:195]
    ds_read_b64_tr_b16 a[186:187], v23 offset:20480
    v_mfma_f32_16x16x32_bf16 v[196:199], a[160:163], a[20:23], v[196:199]
    ds_read_b64_tr_b16 a[188:189], v23 offset:24576
    v_mfma_f32_16x16x32_bf16 v[196:199], a[164:167], a[28:31], v[196:199]
    s_waitcnt lgkmcnt(9)
    ds_read_b64_tr_b16 a[190:191], v23 offset:28672
    v_mfma_f32_16x16x32_bf16 v[200:203], a[168:171], a[16:19], v[200:203]
    s_waitcnt lgkmcnt(8)
    ds_read_b64_tr_b16 a[160:161], v24 offset:16384
    v_mfma_f32_16x16x32_bf16 v[200:203], a[172:175], a[24:27], v[200:203]
    ds_read_b64_tr_b16 a[162:163], v24 offset:20480
    v_mfma_f32_16x16x32_bf16 v[204:207], a[168:171], a[20:23], v[204:207]
    ds_read_b64_tr_b16 a[164:165], v24 offset:24576
    v_mfma_f32_16x16x32_bf16 v[204:207], a[172:175], a[28:31], v[204:207]
    s_waitcnt lgkmcnt(9)
    ds_read_b64_tr_b16 a[166:167], v24 offset:28672
    v_mfma_f32_16x16x32_bf16 v[208:211], a[176:179], a[16:19], v[208:211]
    s_waitcnt lgkmcnt(8)
    ds_read_b64_tr_b16 a[168:169], v25 offset:16384
    v_mfma_f32_16x16x32_bf16 v[208:211], a[180:183], a[24:27], v[208:211]
    ds_read_b64_tr_b16 a[170:171], v25 offset:20480
    v_mfma_f32_16x16x32_bf16 v[212:215], a[176:179], a[20:23], v[212:215]
    ds_read_b64_tr_b16 a[172:173], v25 offset:24576
    v_mfma_f32_16x16x32_bf16 v[212:215], a[180:183], a[28:31], v[212:215]
    s_waitcnt lgkmcnt(9)
    ds_read_b64_tr_b16 a[174:175], v25 offset:28672
    v_mfma_f32_16x16x32_bf16 v[216:219], a[184:187], a[16:19], v[216:219]
    s_waitcnt lgkmcnt(8)
    ds_read_b64_tr_b16 a[176:177], v26 offset:16384
    v_mfma_f32_16x16x32_bf16 v[216:219], a[188:191], a[24:27], v[216:219]
    ds_read_b64_tr_b16 a[178:179], v26 offset:20480
    v_mfma_f32_16x16x32_bf16 v[220:223], a[184:187], a[20:23], v[220:223]
    ds_read_b64_tr_b16 a[180:181], v26 offset:24576
    v_mfma_f32_16x16x32_bf16 v[220:223], a[188:191], a[28:31], v[220:223]
    s_waitcnt lgkmcnt(9)
    ds_read_b64_tr_b16 a[182:183], v26 offset:28672
    v_mfma_f32_16x16x32_bf16 v[224:227], a[160:163], a[16:19], v[224:227]
    s_waitcnt lgkmcnt(8)
    ds_read_b64_tr_b16 a[184:185], v27 offset:16384
    v_mfma_f32_16x16x32_bf16 v[224:227], a[164:167], a[24:27], v[224:227]
    ds_read_b64_tr_b16 a[186:187], v27 offset:20480
    v_mfma_f32_16x16x32_bf16 v[228:231], a[160:163], a[20:23], v[228:231]
    ds_read_b64_tr_b16 a[188:189], v27 offset:24576
    v_mfma_f32_16x16x32_bf16 v[228:231], a[164:167], a[28:31], v[228:231]
    s_waitcnt lgkmcnt(9)
    ds_read_b64_tr_b16 a[190:191], v27 offset:28672
    s_waitcnt vmcnt(24)
    s_barrier
    v_mfma_f32_16x16x32_bf16 v[232:235], a[168:171], a[16:19], v[232:235]
    s_waitcnt lgkmcnt(8)
    ds_read_b64_tr_b16 a[160:161], v20 offset:32768
    v_mfma_f32_16x16x32_bf16 v[232:235], a[172:175], a[24:27], v[232:235]
    ds_read_b64_tr_b16 a[162:163], v20 offset:36864
    v_mfma_f32_16x16x32_bf16 v[236:239], a[168:171], a[20:23], v[236:239]
    s_add_u32 s49, s46, 10240
    ds_read_b64_tr_b16 a[164:165], v20 offset:40960
    v_mfma_f32_16x16x32_bf16 v[236:239], a[172:175], a[28:31], v[236:239]
    s_waitcnt lgkmcnt(9)
    ds_read_b64_tr_b16 a[166:167], v20 offset:45056
    buffer_load_dwordx4 a[80:83], v51, s[24:27], s49 offen
    v_mfma_f32_16x16x32_bf16 v[240:243], a[176:179], a[16:19], v[240:243]
    s_waitcnt lgkmcnt(8)
    ds_read_b64_tr_b16 a[168:169], v21 offset:32768
    v_mfma_f32_16x16x32_bf16 v[240:243], a[180:183], a[24:27], v[240:243]
    ds_read_b64_tr_b16 a[170:171], v21 offset:36864
    v_mfma_f32_16x16x32_bf16 v[244:247], a[176:179], a[20:23], v[244:247]
    ds_read_b64_tr_b16 a[172:173], v21 offset:40960
    v_mfma_f32_16x16x32_bf16 v[244:247], a[180:183], a[28:31], v[244:247]
    s_waitcnt lgkmcnt(9)
    ds_read_b64_tr_b16 a[174:175], v21 offset:45056
    buffer_load_dwordx4 a[88:91], v51, s[24:27], s49 offen offset:1024
    v_mfma_f32_16x16x32_bf16 v[248:251], a[184:187], a[16:19], v[248:251]
    s_waitcnt lgkmcnt(8)
    ds_read_b64_tr_b16 a[176:177], v22 offset:32768
    v_mfma_f32_16x16x32_bf16 v[248:251], a[188:191], a[24:27], v[248:251]
    ds_read_b64_tr_b16 a[178:179], v22 offset:36864
    v_mfma_f32_16x16x32_bf16 v[252:255], a[184:187], a[20:23], v[252:255]
    s_add_u32 s49, s46, 28672
    ds_read_b64_tr_b16 a[180:181], v22 offset:40960
    v_mfma_f32_16x16x32_bf16 v[252:255], a[188:191], a[28:31], v[252:255]
    s_waitcnt lgkmcnt(9)
    ds_read_b64_tr_b16 a[182:183], v22 offset:45056
    buffer_load_dwordx4 a[84:87], v51, s[24:27], s49 offen
    v_mfma_f32_16x16x32_bf16 v[128:131], a[160:163], a[32:35], v[128:131]
    s_waitcnt lgkmcnt(8)
    ds_read_b64_tr_b16 a[184:185], v23 offset:32768
    v_mfma_f32_16x16x32_bf16 v[128:131], a[164:167], a[40:43], v[128:131]
    ds_read_b64_tr_b16 a[186:187], v23 offset:36864
    v_mfma_f32_16x16x32_bf16 v[132:135], a[160:163], a[36:39], v[132:135]
    ds_read_b64_tr_b16 a[188:189], v23 offset:40960
    v_mfma_f32_16x16x32_bf16 v[132:135], a[164:167], a[44:47], v[132:135]
    s_waitcnt lgkmcnt(9)
    ds_read_b64_tr_b16 a[190:191], v23 offset:45056
    buffer_load_dwordx4 a[92:95], v51, s[24:27], s49 offen offset:1024
    v_mfma_f32_16x16x32_bf16 v[136:139], a[168:171], a[32:35], v[136:139]
    s_waitcnt lgkmcnt(8)
    ds_read_b64_tr_b16 a[160:161], v24 offset:32768
    v_mfma_f32_16x16x32_bf16 v[136:139], a[172:175], a[40:43], v[136:139]
    s_add_u32 s49, s44, 2621440
    ds_read_b64_tr_b16 a[162:163], v24 offset:36864
    v_mfma_f32_16x16x32_bf16 v[140:143], a[168:171], a[36:39], v[140:143]
    s_add_u32 m0, s42, 32768
    ds_read_b64_tr_b16 a[164:165], v24 offset:40960
    v_mfma_f32_16x16x32_bf16 v[140:143], a[172:175], a[44:47], v[140:143]
    s_waitcnt lgkmcnt(9)
    ds_read_b64_tr_b16 a[166:167], v24 offset:45056
    buffer_load_dwordx4 v42, s[16:19], s49 offen lds
    v_mfma_f32_16x16x32_bf16 v[144:147], a[176:179], a[32:35], v[144:147]
    s_waitcnt lgkmcnt(8)
    ds_read_b64_tr_b16 a[168:169], v25 offset:32768
    v_mfma_f32_16x16x32_bf16 v[144:147], a[180:183], a[40:43], v[144:147]
    ds_read_b64_tr_b16 a[170:171], v25 offset:36864
    v_mfma_f32_16x16x32_bf16 v[148:151], a[176:179], a[36:39], v[148:151]
    ds_read_b64_tr_b16 a[172:173], v25 offset:40960
    v_mfma_f32_16x16x32_bf16 v[148:151], a[180:183], a[44:47], v[148:151]
    s_waitcnt lgkmcnt(9)
    ds_read_b64_tr_b16 a[174:175], v25 offset:45056
    buffer_load_dwordx4 v43, s[16:19], s49 offen offset:1024 lds
    v_mfma_f32_16x16x32_bf16 v[152:155], a[184:187], a[32:35], v[152:155]
    s_waitcnt lgkmcnt(8)
    ds_read_b64_tr_b16 a[176:177], v26 offset:32768
    v_mfma_f32_16x16x32_bf16 v[152:155], a[188:191], a[40:43], v[152:155]
    ds_read_b64_tr_b16 a[178:179], v26 offset:36864
    v_mfma_f32_16x16x32_bf16 v[156:159], a[184:187], a[36:39], v[156:159]
    ds_read_b64_tr_b16 a[180:181], v26 offset:40960
    v_mfma_f32_16x16x32_bf16 v[156:159], a[188:191], a[44:47], v[156:159]
    s_waitcnt lgkmcnt(9)
    ds_read_b64_tr_b16 a[182:183], v26 offset:45056
    buffer_load_dwordx4 v44, s[16:19], s49 offen offset:2048 lds
    v_mfma_f32_16x16x32_bf16 v[160:163], a[160:163], a[32:35], v[160:163]
    s_waitcnt lgkmcnt(8)
    ds_read_b64_tr_b16 a[184:185], v27 offset:32768
    v_mfma_f32_16x16x32_bf16 v[160:163], a[164:167], a[40:43], v[160:163]
    ds_read_b64_tr_b16 a[186:187], v27 offset:36864
    v_mfma_f32_16x16x32_bf16 v[164:167], a[160:163], a[36:39], v[164:167]
    ds_read_b64_tr_b16 a[188:189], v27 offset:40960
    v_mfma_f32_16x16x32_bf16 v[164:167], a[164:167], a[44:47], v[164:167]
    s_waitcnt lgkmcnt(9)
    ds_read_b64_tr_b16 a[190:191], v27 offset:45056
    buffer_load_dwordx4 v45, s[16:19], s49 offen offset:3072 lds
    v_mfma_f32_16x16x32_bf16 v[168:171], a[168:171], a[32:35], v[168:171]
    s_waitcnt lgkmcnt(8)
    ds_read_b64_tr_b16 a[160:161], v20 offset:49152
    v_mfma_f32_16x16x32_bf16 v[168:171], a[172:175], a[40:43], v[168:171]
    s_add_u32 s49, s44, 2621696
    ds_read_b64_tr_b16 a[162:163], v20 offset:53248
    v_mfma_f32_16x16x32_bf16 v[172:175], a[168:171], a[36:39], v[172:175]
    s_add_u32 m0, s42, 49152
    ds_read_b64_tr_b16 a[164:165], v20 offset:57344
    v_mfma_f32_16x16x32_bf16 v[172:175], a[172:175], a[44:47], v[172:175]
    s_waitcnt lgkmcnt(9)
    ds_read_b64_tr_b16 a[166:167], v20 offset:61440
    buffer_load_dwordx4 v42, s[16:19], s49 offen lds
    v_mfma_f32_16x16x32_bf16 v[176:179], a[176:179], a[32:35], v[176:179]
    s_waitcnt lgkmcnt(8)
    ds_read_b64_tr_b16 a[168:169], v21 offset:49152
    v_mfma_f32_16x16x32_bf16 v[176:179], a[180:183], a[40:43], v[176:179]
    ds_read_b64_tr_b16 a[170:171], v21 offset:53248
    v_mfma_f32_16x16x32_bf16 v[180:183], a[176:179], a[36:39], v[180:183]
    ds_read_b64_tr_b16 a[172:173], v21 offset:57344
    v_mfma_f32_16x16x32_bf16 v[180:183], a[180:183], a[44:47], v[180:183]
    s_waitcnt lgkmcnt(9)
    ds_read_b64_tr_b16 a[174:175], v21 offset:61440
    buffer_load_dwordx4 v43, s[16:19], s49 offen offset:1024 lds
    v_mfma_f32_16x16x32_bf16 v[184:187], a[184:187], a[32:35], v[184:187]
    s_waitcnt lgkmcnt(8)
    ds_read_b64_tr_b16 a[176:177], v22 offset:49152
    v_mfma_f32_16x16x32_bf16 v[184:187], a[188:191], a[40:43], v[184:187]
    ds_read_b64_tr_b16 a[178:179], v22 offset:53248
    v_mfma_f32_16x16x32_bf16 v[188:191], a[184:187], a[36:39], v[188:191]
    ds_read_b64_tr_b16 a[180:181], v22 offset:57344
    v_mfma_f32_16x16x32_bf16 v[188:191], a[188:191], a[44:47], v[188:191]
    s_waitcnt lgkmcnt(9)
    ds_read_b64_tr_b16 a[182:183], v22 offset:61440
    buffer_load_dwordx4 v44, s[16:19], s49 offen offset:2048 lds
    v_mfma_f32_16x16x32_bf16 v[192:195], a[160:163], a[32:35], v[192:195]
    s_waitcnt lgkmcnt(8)
    ds_read_b64_tr_b16 a[184:185], v23 offset:49152
    v_mfma_f32_16x16x32_bf16 v[192:195], a[164:167], a[40:43], v[192:195]
    ds_read_b64_tr_b16 a[186:187], v23 offset:53248
    v_mfma_f32_16x16x32_bf16 v[196:199], a[160:163], a[36:39], v[196:199]
    ds_read_b64_tr_b16 a[188:189], v23 offset:57344
    v_mfma_f32_16x16x32_bf16 v[196:199], a[164:167], a[44:47], v[196:199]
    s_waitcnt lgkmcnt(9)
    ds_read_b64_tr_b16 a[190:191], v23 offset:61440
    buffer_load_dwordx4 v45, s[16:19], s49 offen offset:3072 lds
    v_mfma_f32_16x16x32_bf16 v[200:203], a[168:171], a[32:35], v[200:203]
    s_waitcnt lgkmcnt(8)
    ds_read_b64_tr_b16 a[160:161], v24 offset:49152
    v_mfma_f32_16x16x32_bf16 v[200:203], a[172:175], a[40:43], v[200:203]
    ds_read_b64_tr_b16 a[162:163], v24 offset:53248
    v_mfma_f32_16x16x32_bf16 v[204:207], a[168:171], a[36:39], v[204:207]
    ds_read_b64_tr_b16 a[164:165], v24 offset:57344
    v_mfma_f32_16x16x32_bf16 v[204:207], a[172:175], a[44:47], v[204:207]
    s_waitcnt lgkmcnt(9)
    ds_read_b64_tr_b16 a[166:167], v24 offset:61440
    v_mfma_f32_16x16x32_bf16 v[208:211], a[176:179], a[32:35], v[208:211]
    s_waitcnt lgkmcnt(8)
    ds_read_b64_tr_b16 a[168:169], v25 offset:49152
    v_mfma_f32_16x16x32_bf16 v[208:211], a[180:183], a[40:43], v[208:211]
    ds_read_b64_tr_b16 a[170:171], v25 offset:53248
    v_mfma_f32_16x16x32_bf16 v[212:215], a[176:179], a[36:39], v[212:215]
    ds_read_b64_tr_b16 a[172:173], v25 offset:57344
    v_mfma_f32_16x16x32_bf16 v[212:215], a[180:183], a[44:47], v[212:215]
    s_waitcnt lgkmcnt(9)
    ds_read_b64_tr_b16 a[174:175], v25 offset:61440
    v_mfma_f32_16x16x32_bf16 v[216:219], a[184:187], a[32:35], v[216:219]
    s_waitcnt lgkmcnt(8)
    ds_read_b64_tr_b16 a[176:177], v26 offset:49152
    v_mfma_f32_16x16x32_bf16 v[216:219], a[188:191], a[40:43], v[216:219]
    ds_read_b64_tr_b16 a[178:179], v26 offset:53248
    v_mfma_f32_16x16x32_bf16 v[220:223], a[184:187], a[36:39], v[220:223]
    ds_read_b64_tr_b16 a[180:181], v26 offset:57344
    v_mfma_f32_16x16x32_bf16 v[220:223], a[188:191], a[44:47], v[220:223]
    s_waitcnt lgkmcnt(9)
    ds_read_b64_tr_b16 a[182:183], v26 offset:61440
    v_mfma_f32_16x16x32_bf16 v[224:227], a[160:163], a[32:35], v[224:227]
    s_waitcnt lgkmcnt(8)
    ds_read_b64_tr_b16 a[184:185], v27 offset:49152
    v_mfma_f32_16x16x32_bf16 v[224:227], a[164:167], a[40:43], v[224:227]
    ds_read_b64_tr_b16 a[186:187], v27 offset:53248
    v_mfma_f32_16x16x32_bf16 v[228:231], a[160:163], a[36:39], v[228:231]
    ds_read_b64_tr_b16 a[188:189], v27 offset:57344
    v_mfma_f32_16x16x32_bf16 v[228:231], a[164:167], a[44:47], v[228:231]
    s_waitcnt lgkmcnt(9)
    ds_read_b64_tr_b16 a[190:191], v27 offset:61440
    s_waitcnt vmcnt(24)
    s_barrier
    v_mfma_f32_16x16x32_bf16 v[232:235], a[168:171], a[32:35], v[232:235]
    s_waitcnt lgkmcnt(8)
    ds_read_b64_tr_b16 a[160:161], v28 offset:0
    v_mfma_f32_16x16x32_bf16 v[232:235], a[172:175], a[40:43], v[232:235]
    ds_read_b64_tr_b16 a[162:163], v28 offset:4096
    v_mfma_f32_16x16x32_bf16 v[236:239], a[168:171], a[36:39], v[236:239]
    s_add_u32 s49, s46, 12288
    ds_read_b64_tr_b16 a[164:165], v28 offset:8192
    v_mfma_f32_16x16x32_bf16 v[236:239], a[172:175], a[44:47], v[236:239]
    s_waitcnt lgkmcnt(9)
    ds_read_b64_tr_b16 a[166:167], v28 offset:12288
    buffer_load_dwordx4 a[96:99], v51, s[24:27], s49 offen
    v_mfma_f32_16x16x32_bf16 v[240:243], a[176:179], a[32:35], v[240:243]
    s_waitcnt lgkmcnt(8)
    ds_read_b64_tr_b16 a[168:169], v29 offset:0
    v_mfma_f32_16x16x32_bf16 v[240:243], a[180:183], a[40:43], v[240:243]
    ds_read_b64_tr_b16 a[170:171], v29 offset:4096
    v_mfma_f32_16x16x32_bf16 v[244:247], a[176:179], a[36:39], v[244:247]
    ds_read_b64_tr_b16 a[172:173], v29 offset:8192
    v_mfma_f32_16x16x32_bf16 v[244:247], a[180:183], a[44:47], v[244:247]
    s_waitcnt lgkmcnt(9)
    ds_read_b64_tr_b16 a[174:175], v29 offset:12288
    buffer_load_dwordx4 a[104:107], v51, s[24:27], s49 offen offset:1024
    v_mfma_f32_16x16x32_bf16 v[248:251], a[184:187], a[32:35], v[248:251]
    s_waitcnt lgkmcnt(8)
    ds_read_b64_tr_b16 a[176:177], v30 offset:0
    v_mfma_f32_16x16x32_bf16 v[248:251], a[188:191], a[40:43], v[248:251]
    ds_read_b64_tr_b16 a[178:179], v30 offset:4096
    v_mfma_f32_16x16x32_bf16 v[252:255], a[184:187], a[36:39], v[252:255]
    s_add_u32 s49, s46, 30720
    ds_read_b64_tr_b16 a[180:181], v30 offset:8192
    v_mfma_f32_16x16x32_bf16 v[252:255], a[188:191], a[44:47], v[252:255]
    s_waitcnt lgkmcnt(9)
    ds_read_b64_tr_b16 a[182:183], v30 offset:12288
    buffer_load_dwordx4 a[100:103], v51, s[24:27], s49 offen
    v_mfma_f32_16x16x32_bf16 v[128:131], a[160:163], a[48:51], v[128:131]
    s_waitcnt lgkmcnt(8)
    ds_read_b64_tr_b16 a[184:185], v31 offset:0
    v_mfma_f32_16x16x32_bf16 v[128:131], a[164:167], a[56:59], v[128:131]
    ds_read_b64_tr_b16 a[186:187], v31 offset:4096
    v_mfma_f32_16x16x32_bf16 v[132:135], a[160:163], a[52:55], v[132:135]
    ds_read_b64_tr_b16 a[188:189], v31 offset:8192
    v_mfma_f32_16x16x32_bf16 v[132:135], a[164:167], a[60:63], v[132:135]
    s_waitcnt lgkmcnt(9)
    ds_read_b64_tr_b16 a[190:191], v31 offset:12288
    buffer_load_dwordx4 a[108:111], v51, s[24:27], s49 offen offset:1024
    v_mfma_f32_16x16x32_bf16 v[136:139], a[168:171], a[48:51], v[136:139]
    s_waitcnt lgkmcnt(8)
    ds_read_b64_tr_b16 a[160:161], v32 offset:0
    v_mfma_f32_16x16x32_bf16 v[136:139], a[172:175], a[56:59], v[136:139]
    s_add_u32 s49, s44, 3145728
    ds_read_b64_tr_b16 a[162:163], v32 offset:4096
    v_mfma_f32_16x16x32_bf16 v[140:143], a[168:171], a[52:55], v[140:143]
    s_add_u32 m0, s42, 65536
    ds_read_b64_tr_b16 a[164:165], v32 offset:8192
    v_mfma_f32_16x16x32_bf16 v[140:143], a[172:175], a[60:63], v[140:143]
    s_waitcnt lgkmcnt(9)
    ds_read_b64_tr_b16 a[166:167], v32 offset:12288
    buffer_load_dwordx4 v42, s[16:19], s49 offen lds
    v_mfma_f32_16x16x32_bf16 v[144:147], a[176:179], a[48:51], v[144:147]
    s_waitcnt lgkmcnt(8)
    ds_read_b64_tr_b16 a[168:169], v33 offset:0
    v_mfma_f32_16x16x32_bf16 v[144:147], a[180:183], a[56:59], v[144:147]
    ds_read_b64_tr_b16 a[170:171], v33 offset:4096
    v_mfma_f32_16x16x32_bf16 v[148:151], a[176:179], a[52:55], v[148:151]
    ds_read_b64_tr_b16 a[172:173], v33 offset:8192
    v_mfma_f32_16x16x32_bf16 v[148:151], a[180:183], a[60:63], v[148:151]
    s_waitcnt lgkmcnt(9)
    ds_read_b64_tr_b16 a[174:175], v33 offset:12288
    buffer_load_dwordx4 v43, s[16:19], s49 offen offset:1024 lds
    v_mfma_f32_16x16x32_bf16 v[152:155], a[184:187], a[48:51], v[152:155]
    s_waitcnt lgkmcnt(8)
    ds_read_b64_tr_b16 a[176:177], v34 offset:0
    v_mfma_f32_16x16x32_bf16 v[152:155], a[188:191], a[56:59], v[152:155]
    ds_read_b64_tr_b16 a[178:179], v34 offset:4096
    v_mfma_f32_16x16x32_bf16 v[156:159], a[184:187], a[52:55], v[156:159]
    ds_read_b64_tr_b16 a[180:181], v34 offset:8192
    v_mfma_f32_16x16x32_bf16 v[156:159], a[188:191], a[60:63], v[156:159]
    s_waitcnt lgkmcnt(9)
    ds_read_b64_tr_b16 a[182:183], v34 offset:12288
    buffer_load_dwordx4 v44, s[16:19], s49 offen offset:2048 lds
    v_mfma_f32_16x16x32_bf16 v[160:163], a[160:163], a[48:51], v[160:163]
    s_waitcnt lgkmcnt(8)
    ds_read_b64_tr_b16 a[184:185], v35 offset:0
    v_mfma_f32_16x16x32_bf16 v[160:163], a[164:167], a[56:59], v[160:163]
    ds_read_b64_tr_b16 a[186:187], v35 offset:4096
    v_mfma_f32_16x16x32_bf16 v[164:167], a[160:163], a[52:55], v[164:167]
    ds_read_b64_tr_b16 a[188:189], v35 offset:8192
    v_mfma_f32_16x16x32_bf16 v[164:167], a[164:167], a[60:63], v[164:167]
    s_waitcnt lgkmcnt(9)
    ds_read_b64_tr_b16 a[190:191], v35 offset:12288
    buffer_load_dwordx4 v45, s[16:19], s49 offen offset:3072 lds
    v_mfma_f32_16x16x32_bf16 v[168:171], a[168:171], a[48:51], v[168:171]
    s_waitcnt lgkmcnt(8)
    ds_read_b64_tr_b16 a[160:161], v28 offset:16384
    v_mfma_f32_16x16x32_bf16 v[168:171], a[172:175], a[56:59], v[168:171]
    s_add_u32 s49, s44, 3145984
    ds_read_b64_tr_b16 a[162:163], v28 offset:20480
    v_mfma_f32_16x16x32_bf16 v[172:175], a[168:171], a[52:55], v[172:175]
    s_add_u32 m0, s42, 81920
    ds_read_b64_tr_b16 a[164:165], v28 offset:24576
    v_mfma_f32_16x16x32_bf16 v[172:175], a[172:175], a[60:63], v[172:175]
    s_waitcnt lgkmcnt(9)
    ds_read_b64_tr_b16 a[166:167], v28 offset:28672
    buffer_load_dwordx4 v42, s[16:19], s49 offen lds
    v_mfma_f32_16x16x32_bf16 v[176:179], a[176:179], a[48:51], v[176:179]
    s_waitcnt lgkmcnt(8)
    ds_read_b64_tr_b16 a[168:169], v29 offset:16384
    v_mfma_f32_16x16x32_bf16 v[176:179], a[180:183], a[56:59], v[176:179]
    ds_read_b64_tr_b16 a[170:171], v29 offset:20480
    v_mfma_f32_16x16x32_bf16 v[180:183], a[176:179], a[52:55], v[180:183]
    ds_read_b64_tr_b16 a[172:173], v29 offset:24576
    v_mfma_f32_16x16x32_bf16 v[180:183], a[180:183], a[60:63], v[180:183]
    s_waitcnt lgkmcnt(9)
    ds_read_b64_tr_b16 a[174:175], v29 offset:28672
    buffer_load_dwordx4 v43, s[16:19], s49 offen offset:1024 lds
    v_mfma_f32_16x16x32_bf16 v[184:187], a[184:187], a[48:51], v[184:187]
    s_waitcnt lgkmcnt(8)
    ds_read_b64_tr_b16 a[176:177], v30 offset:16384
    v_mfma_f32_16x16x32_bf16 v[184:187], a[188:191], a[56:59], v[184:187]
    ds_read_b64_tr_b16 a[178:179], v30 offset:20480
    v_mfma_f32_16x16x32_bf16 v[188:191], a[184:187], a[52:55], v[188:191]
    ds_read_b64_tr_b16 a[180:181], v30 offset:24576
    v_mfma_f32_16x16x32_bf16 v[188:191], a[188:191], a[60:63], v[188:191]
    s_waitcnt lgkmcnt(9)
    ds_read_b64_tr_b16 a[182:183], v30 offset:28672
    buffer_load_dwordx4 v44, s[16:19], s49 offen offset:2048 lds
    v_mfma_f32_16x16x32_bf16 v[192:195], a[160:163], a[48:51], v[192:195]
    s_waitcnt lgkmcnt(8)
    ds_read_b64_tr_b16 a[184:185], v31 offset:16384
    v_mfma_f32_16x16x32_bf16 v[192:195], a[164:167], a[56:59], v[192:195]
    ds_read_b64_tr_b16 a[186:187], v31 offset:20480
    v_mfma_f32_16x16x32_bf16 v[196:199], a[160:163], a[52:55], v[196:199]
    ds_read_b64_tr_b16 a[188:189], v31 offset:24576
    v_mfma_f32_16x16x32_bf16 v[196:199], a[164:167], a[60:63], v[196:199]
    s_waitcnt lgkmcnt(9)
    ds_read_b64_tr_b16 a[190:191], v31 offset:28672
    buffer_load_dwordx4 v45, s[16:19], s49 offen offset:3072 lds
    v_mfma_f32_16x16x32_bf16 v[200:203], a[168:171], a[48:51], v[200:203]
    s_waitcnt lgkmcnt(8)
    ds_read_b64_tr_b16 a[160:161], v32 offset:16384
    v_mfma_f32_16x16x32_bf16 v[200:203], a[172:175], a[56:59], v[200:203]
    ds_read_b64_tr_b16 a[162:163], v32 offset:20480
    v_mfma_f32_16x16x32_bf16 v[204:207], a[168:171], a[52:55], v[204:207]
    ds_read_b64_tr_b16 a[164:165], v32 offset:24576
    v_mfma_f32_16x16x32_bf16 v[204:207], a[172:175], a[60:63], v[204:207]
    s_waitcnt lgkmcnt(9)
    ds_read_b64_tr_b16 a[166:167], v32 offset:28672
    v_mfma_f32_16x16x32_bf16 v[208:211], a[176:179], a[48:51], v[208:211]
    s_waitcnt lgkmcnt(8)
    ds_read_b64_tr_b16 a[168:169], v33 offset:16384
    v_mfma_f32_16x16x32_bf16 v[208:211], a[180:183], a[56:59], v[208:211]
    ds_read_b64_tr_b16 a[170:171], v33 offset:20480
    v_mfma_f32_16x16x32_bf16 v[212:215], a[176:179], a[52:55], v[212:215]
    ds_read_b64_tr_b16 a[172:173], v33 offset:24576
    v_mfma_f32_16x16x32_bf16 v[212:215], a[180:183], a[60:63], v[212:215]
    s_waitcnt lgkmcnt(9)
    ds_read_b64_tr_b16 a[174:175], v33 offset:28672
    v_mfma_f32_16x16x32_bf16 v[216:219], a[184:187], a[48:51], v[216:219]
    s_waitcnt lgkmcnt(8)
    ds_read_b64_tr_b16 a[176:177], v34 offset:16384
    v_mfma_f32_16x16x32_bf16 v[216:219], a[188:191], a[56:59], v[216:219]
    ds_read_b64_tr_b16 a[178:179], v34 offset:20480
    v_mfma_f32_16x16x32_bf16 v[220:223], a[184:187], a[52:55], v[220:223]
    ds_read_b64_tr_b16 a[180:181], v34 offset:24576
    v_mfma_f32_16x16x32_bf16 v[220:223], a[188:191], a[60:63], v[220:223]
    s_waitcnt lgkmcnt(9)
    ds_read_b64_tr_b16 a[182:183], v34 offset:28672
    v_mfma_f32_16x16x32_bf16 v[224:227], a[160:163], a[48:51], v[224:227]
    s_waitcnt lgkmcnt(8)
    ds_read_b64_tr_b16 a[184:185], v35 offset:16384
    v_mfma_f32_16x16x32_bf16 v[224:227], a[164:167], a[56:59], v[224:227]
    ds_read_b64_tr_b16 a[186:187], v35 offset:20480
    v_mfma_f32_16x16x32_bf16 v[228:231], a[160:163], a[52:55], v[228:231]
    ds_read_b64_tr_b16 a[188:189], v35 offset:24576
    v_mfma_f32_16x16x32_bf16 v[228:231], a[164:167], a[60:63], v[228:231]
    s_waitcnt lgkmcnt(9)
    ds_read_b64_tr_b16 a[190:191], v35 offset:28672
    s_waitcnt vmcnt(24)
    s_barrier
    v_mfma_f32_16x16x32_bf16 v[232:235], a[168:171], a[48:51], v[232:235]
    s_waitcnt lgkmcnt(8)
    ds_read_b64_tr_b16 a[160:161], v12 offset:0
    v_mfma_f32_16x16x32_bf16 v[232:235], a[172:175], a[56:59], v[232:235]
    ds_read_b64_tr_b16 a[162:163], v12 offset:4096
    v_mfma_f32_16x16x32_bf16 v[236:239], a[168:171], a[52:55], v[236:239]
    s_add_u32 s49, s46, 14336
    ds_read_b64_tr_b16 a[164:165], v12 offset:8192
    v_mfma_f32_16x16x32_bf16 v[236:239], a[172:175], a[60:63], v[236:239]
    s_waitcnt lgkmcnt(9)
    ds_read_b64_tr_b16 a[166:167], v12 offset:12288
    buffer_load_dwordx4 a[112:115], v51, s[24:27], s49 offen
    v_mfma_f32_16x16x32_bf16 v[240:243], a[176:179], a[48:51], v[240:243]
    s_waitcnt lgkmcnt(8)
    ds_read_b64_tr_b16 a[168:169], v13 offset:0
    v_mfma_f32_16x16x32_bf16 v[240:243], a[180:183], a[56:59], v[240:243]
    ds_read_b64_tr_b16 a[170:171], v13 offset:4096
    v_mfma_f32_16x16x32_bf16 v[244:247], a[176:179], a[52:55], v[244:247]
    ds_read_b64_tr_b16 a[172:173], v13 offset:8192
    v_mfma_f32_16x16x32_bf16 v[244:247], a[180:183], a[60:63], v[244:247]
    s_waitcnt lgkmcnt(9)
    ds_read_b64_tr_b16 a[174:175], v13 offset:12288
    buffer_load_dwordx4 a[120:123], v51, s[24:27], s49 offen offset:1024
    v_mfma_f32_16x16x32_bf16 v[248:251], a[184:187], a[48:51], v[248:251]
    s_waitcnt lgkmcnt(8)
    ds_read_b64_tr_b16 a[176:177], v14 offset:0
    v_mfma_f32_16x16x32_bf16 v[248:251], a[188:191], a[56:59], v[248:251]
    ds_read_b64_tr_b16 a[178:179], v14 offset:4096
    v_mfma_f32_16x16x32_bf16 v[252:255], a[184:187], a[52:55], v[252:255]
    s_add_u32 s49, s46, 32768
    ds_read_b64_tr_b16 a[180:181], v14 offset:8192
    v_mfma_f32_16x16x32_bf16 v[252:255], a[188:191], a[60:63], v[252:255]
    s_waitcnt lgkmcnt(9)
    ds_read_b64_tr_b16 a[182:183], v14 offset:12288
    buffer_load_dwordx4 a[116:119], v51, s[24:27], s49 offen
    v_mfma_f32_16x16x32_bf16 v[128:131], a[160:163], a[64:67], v[128:131]
    s_waitcnt lgkmcnt(8)
    ds_read_b64_tr_b16 a[184:185], v15 offset:0
    v_mfma_f32_16x16x32_bf16 v[128:131], a[164:167], a[72:75], v[128:131]
    ds_read_b64_tr_b16 a[186:187], v15 offset:4096
    v_mfma_f32_16x16x32_bf16 v[132:135], a[160:163], a[68:71], v[132:135]
    ds_read_b64_tr_b16 a[188:189], v15 offset:8192
    v_mfma_f32_16x16x32_bf16 v[132:135], a[164:167], a[76:79], v[132:135]
    s_waitcnt lgkmcnt(9)
    ds_read_b64_tr_b16 a[190:191], v15 offset:12288
    buffer_load_dwordx4 a[124:127], v51, s[24:27], s49 offen offset:1024
    v_mfma_f32_16x16x32_bf16 v[136:139], a[168:171], a[64:67], v[136:139]
    s_waitcnt lgkmcnt(8)
    ds_read_b64_tr_b16 a[160:161], v16 offset:0
    v_mfma_f32_16x16x32_bf16 v[136:139], a[172:175], a[72:75], v[136:139]
    s_add_u32 s49, s44, 3670016
    ds_read_b64_tr_b16 a[162:163], v16 offset:4096
    v_mfma_f32_16x16x32_bf16 v[140:143], a[168:171], a[68:71], v[140:143]
    s_add_u32 m0, s42, 98304
    ds_read_b64_tr_b16 a[164:165], v16 offset:8192
    v_mfma_f32_16x16x32_bf16 v[140:143], a[172:175], a[76:79], v[140:143]
    s_waitcnt lgkmcnt(9)
    ds_read_b64_tr_b16 a[166:167], v16 offset:12288
    buffer_load_dwordx4 v42, s[16:19], s49 offen lds
    v_mfma_f32_16x16x32_bf16 v[144:147], a[176:179], a[64:67], v[144:147]
    s_waitcnt lgkmcnt(8)
    ds_read_b64_tr_b16 a[168:169], v17 offset:0
    v_mfma_f32_16x16x32_bf16 v[144:147], a[180:183], a[72:75], v[144:147]
    ds_read_b64_tr_b16 a[170:171], v17 offset:4096
    v_mfma_f32_16x16x32_bf16 v[148:151], a[176:179], a[68:71], v[148:151]
    ds_read_b64_tr_b16 a[172:173], v17 offset:8192
    v_mfma_f32_16x16x32_bf16 v[148:151], a[180:183], a[76:79], v[148:151]
    s_waitcnt lgkmcnt(9)
    ds_read_b64_tr_b16 a[174:175], v17 offset:12288
    buffer_load_dwordx4 v43, s[16:19], s49 offen offset:1024 lds
    v_mfma_f32_16x16x32_bf16 v[152:155], a[184:187], a[64:67], v[152:155]
    s_waitcnt lgkmcnt(8)
    ds_read_b64_tr_b16 a[176:177], v18 offset:0
    v_mfma_f32_16x16x32_bf16 v[152:155], a[188:191], a[72:75], v[152:155]
    ds_read_b64_tr_b16 a[178:179], v18 offset:4096
    v_mfma_f32_16x16x32_bf16 v[156:159], a[184:187], a[68:71], v[156:159]
    ds_read_b64_tr_b16 a[180:181], v18 offset:8192
    v_mfma_f32_16x16x32_bf16 v[156:159], a[188:191], a[76:79], v[156:159]
    s_waitcnt lgkmcnt(9)
    ds_read_b64_tr_b16 a[182:183], v18 offset:12288
    buffer_load_dwordx4 v44, s[16:19], s49 offen offset:2048 lds
    v_mfma_f32_16x16x32_bf16 v[160:163], a[160:163], a[64:67], v[160:163]
    s_waitcnt lgkmcnt(8)
    ds_read_b64_tr_b16 a[184:185], v19 offset:0
    v_mfma_f32_16x16x32_bf16 v[160:163], a[164:167], a[72:75], v[160:163]
    ds_read_b64_tr_b16 a[186:187], v19 offset:4096
    v_mfma_f32_16x16x32_bf16 v[164:167], a[160:163], a[68:71], v[164:167]
    ds_read_b64_tr_b16 a[188:189], v19 offset:8192
    v_mfma_f32_16x16x32_bf16 v[164:167], a[164:167], a[76:79], v[164:167]
    s_waitcnt lgkmcnt(9)
    ds_read_b64_tr_b16 a[190:191], v19 offset:12288
    buffer_load_dwordx4 v45, s[16:19], s49 offen offset:3072 lds
    v_mfma_f32_16x16x32_bf16 v[168:171], a[168:171], a[64:67], v[168:171]
    s_waitcnt lgkmcnt(8)
    ds_read_b64_tr_b16 a[160:161], v12 offset:16384
    v_mfma_f32_16x16x32_bf16 v[168:171], a[172:175], a[72:75], v[168:171]
    s_add_u32 s49, s44, 3670272
    ds_read_b64_tr_b16 a[162:163], v12 offset:20480
    v_mfma_f32_16x16x32_bf16 v[172:175], a[168:171], a[68:71], v[172:175]
    s_add_u32 m0, s42, 114688
    ds_read_b64_tr_b16 a[164:165], v12 offset:24576
    v_mfma_f32_16x16x32_bf16 v[172:175], a[172:175], a[76:79], v[172:175]
    s_waitcnt lgkmcnt(9)
    ds_read_b64_tr_b16 a[166:167], v12 offset:28672
    buffer_load_dwordx4 v42, s[16:19], s49 offen lds
    v_mfma_f32_16x16x32_bf16 v[176:179], a[176:179], a[64:67], v[176:179]
    s_waitcnt lgkmcnt(8)
    ds_read_b64_tr_b16 a[168:169], v13 offset:16384
    v_mfma_f32_16x16x32_bf16 v[176:179], a[180:183], a[72:75], v[176:179]
    ds_read_b64_tr_b16 a[170:171], v13 offset:20480
    v_mfma_f32_16x16x32_bf16 v[180:183], a[176:179], a[68:71], v[180:183]
    ds_read_b64_tr_b16 a[172:173], v13 offset:24576
    v_mfma_f32_16x16x32_bf16 v[180:183], a[180:183], a[76:79], v[180:183]
    s_waitcnt lgkmcnt(9)
    ds_read_b64_tr_b16 a[174:175], v13 offset:28672
    buffer_load_dwordx4 v43, s[16:19], s49 offen offset:1024 lds
    v_mfma_f32_16x16x32_bf16 v[184:187], a[184:187], a[64:67], v[184:187]
    s_waitcnt lgkmcnt(8)
    ds_read_b64_tr_b16 a[176:177], v14 offset:16384
    v_mfma_f32_16x16x32_bf16 v[184:187], a[188:191], a[72:75], v[184:187]
    ds_read_b64_tr_b16 a[178:179], v14 offset:20480
    v_mfma_f32_16x16x32_bf16 v[188:191], a[184:187], a[68:71], v[188:191]
    ds_read_b64_tr_b16 a[180:181], v14 offset:24576
    v_mfma_f32_16x16x32_bf16 v[188:191], a[188:191], a[76:79], v[188:191]
    s_waitcnt lgkmcnt(9)
    ds_read_b64_tr_b16 a[182:183], v14 offset:28672
    buffer_load_dwordx4 v44, s[16:19], s49 offen offset:2048 lds
    v_mfma_f32_16x16x32_bf16 v[192:195], a[160:163], a[64:67], v[192:195]
    s_waitcnt lgkmcnt(8)
    ds_read_b64_tr_b16 a[184:185], v15 offset:16384
    v_mfma_f32_16x16x32_bf16 v[192:195], a[164:167], a[72:75], v[192:195]
    ds_read_b64_tr_b16 a[186:187], v15 offset:20480
    v_mfma_f32_16x16x32_bf16 v[196:199], a[160:163], a[68:71], v[196:199]
    ds_read_b64_tr_b16 a[188:189], v15 offset:24576
    v_mfma_f32_16x16x32_bf16 v[196:199], a[164:167], a[76:79], v[196:199]
    s_waitcnt lgkmcnt(9)
    ds_read_b64_tr_b16 a[190:191], v15 offset:28672
    buffer_load_dwordx4 v45, s[16:19], s49 offen offset:3072 lds
    v_mfma_f32_16x16x32_bf16 v[200:203], a[168:171], a[64:67], v[200:203]
    s_waitcnt lgkmcnt(8)
    ds_read_b64_tr_b16 a[160:161], v16 offset:16384
    v_mfma_f32_16x16x32_bf16 v[200:203], a[172:175], a[72:75], v[200:203]
    ds_read_b64_tr_b16 a[162:163], v16 offset:20480
    v_mfma_f32_16x16x32_bf16 v[204:207], a[168:171], a[68:71], v[204:207]
    ds_read_b64_tr_b16 a[164:165], v16 offset:24576
    v_mfma_f32_16x16x32_bf16 v[204:207], a[172:175], a[76:79], v[204:207]
    s_waitcnt lgkmcnt(9)
    ds_read_b64_tr_b16 a[166:167], v16 offset:28672
    v_mfma_f32_16x16x32_bf16 v[208:211], a[176:179], a[64:67], v[208:211]
    s_waitcnt lgkmcnt(8)
    ds_read_b64_tr_b16 a[168:169], v17 offset:16384
    v_mfma_f32_16x16x32_bf16 v[208:211], a[180:183], a[72:75], v[208:211]
    ds_read_b64_tr_b16 a[170:171], v17 offset:20480
    v_mfma_f32_16x16x32_bf16 v[212:215], a[176:179], a[68:71], v[212:215]
    ds_read_b64_tr_b16 a[172:173], v17 offset:24576
    v_mfma_f32_16x16x32_bf16 v[212:215], a[180:183], a[76:79], v[212:215]
    s_waitcnt lgkmcnt(9)
    ds_read_b64_tr_b16 a[174:175], v17 offset:28672
    v_mfma_f32_16x16x32_bf16 v[216:219], a[184:187], a[64:67], v[216:219]
    s_waitcnt lgkmcnt(8)
    ds_read_b64_tr_b16 a[176:177], v18 offset:16384
    v_mfma_f32_16x16x32_bf16 v[216:219], a[188:191], a[72:75], v[216:219]
    ds_read_b64_tr_b16 a[178:179], v18 offset:20480
    v_mfma_f32_16x16x32_bf16 v[220:223], a[184:187], a[68:71], v[220:223]
    ds_read_b64_tr_b16 a[180:181], v18 offset:24576
    v_mfma_f32_16x16x32_bf16 v[220:223], a[188:191], a[76:79], v[220:223]
    s_waitcnt lgkmcnt(9)
    ds_read_b64_tr_b16 a[182:183], v18 offset:28672
    v_mfma_f32_16x16x32_bf16 v[224:227], a[160:163], a[64:67], v[224:227]
    s_waitcnt lgkmcnt(8)
    ds_read_b64_tr_b16 a[184:185], v19 offset:16384
    v_mfma_f32_16x16x32_bf16 v[224:227], a[164:167], a[72:75], v[224:227]
    ds_read_b64_tr_b16 a[186:187], v19 offset:20480
    v_mfma_f32_16x16x32_bf16 v[228:231], a[160:163], a[68:71], v[228:231]
    ds_read_b64_tr_b16 a[188:189], v19 offset:24576
    v_mfma_f32_16x16x32_bf16 v[228:231], a[164:167], a[76:79], v[228:231]
    s_waitcnt lgkmcnt(9)
    ds_read_b64_tr_b16 a[190:191], v19 offset:28672
    s_waitcnt vmcnt(24)
    s_barrier
    v_mfma_f32_16x16x32_bf16 v[232:235], a[168:171], a[64:67], v[232:235]
    s_waitcnt lgkmcnt(8)
    ds_read_b64_tr_b16 a[160:161], v12 offset:32768
    v_mfma_f32_16x16x32_bf16 v[232:235], a[172:175], a[72:75], v[232:235]
    ds_read_b64_tr_b16 a[162:163], v12 offset:36864
    v_mfma_f32_16x16x32_bf16 v[236:239], a[168:171], a[68:71], v[236:239]
    s_add_u32 s49, s46, 16384
    ds_read_b64_tr_b16 a[164:165], v12 offset:40960
    v_mfma_f32_16x16x32_bf16 v[236:239], a[172:175], a[76:79], v[236:239]
    s_waitcnt lgkmcnt(9)
    ds_read_b64_tr_b16 a[166:167], v12 offset:45056
    buffer_load_dwordx4 a[128:131], v51, s[24:27], s49 offen
    v_mfma_f32_16x16x32_bf16 v[240:243], a[176:179], a[64:67], v[240:243]
    s_waitcnt lgkmcnt(8)
    ds_read_b64_tr_b16 a[168:169], v13 offset:32768
    v_mfma_f32_16x16x32_bf16 v[240:243], a[180:183], a[72:75], v[240:243]
    ds_read_b64_tr_b16 a[170:171], v13 offset:36864
    v_mfma_f32_16x16x32_bf16 v[244:247], a[176:179], a[68:71], v[244:247]
    ds_read_b64_tr_b16 a[172:173], v13 offset:40960
    v_mfma_f32_16x16x32_bf16 v[244:247], a[180:183], a[76:79], v[244:247]
    s_waitcnt lgkmcnt(9)
    ds_read_b64_tr_b16 a[174:175], v13 offset:45056
    buffer_load_dwordx4 a[136:139], v51, s[24:27], s49 offen offset:1024
    v_mfma_f32_16x16x32_bf16 v[248:251], a[184:187], a[64:67], v[248:251]
    s_waitcnt lgkmcnt(8)
    ds_read_b64_tr_b16 a[176:177], v14 offset:32768
    v_mfma_f32_16x16x32_bf16 v[248:251], a[188:191], a[72:75], v[248:251]
    ds_read_b64_tr_b16 a[178:179], v14 offset:36864
    v_mfma_f32_16x16x32_bf16 v[252:255], a[184:187], a[68:71], v[252:255]
    s_add_u32 s49, s46, 34816
    ds_read_b64_tr_b16 a[180:181], v14 offset:40960
    v_mfma_f32_16x16x32_bf16 v[252:255], a[188:191], a[76:79], v[252:255]
    s_waitcnt lgkmcnt(9)
    ds_read_b64_tr_b16 a[182:183], v14 offset:45056
    buffer_load_dwordx4 a[132:135], v51, s[24:27], s49 offen
    v_mfma_f32_16x16x32_bf16 v[128:131], a[160:163], a[80:83], v[128:131]
    s_waitcnt lgkmcnt(8)
    ds_read_b64_tr_b16 a[184:185], v15 offset:32768
    v_mfma_f32_16x16x32_bf16 v[128:131], a[164:167], a[88:91], v[128:131]
    ds_read_b64_tr_b16 a[186:187], v15 offset:36864
    v_mfma_f32_16x16x32_bf16 v[132:135], a[160:163], a[84:87], v[132:135]
    ds_read_b64_tr_b16 a[188:189], v15 offset:40960
    v_mfma_f32_16x16x32_bf16 v[132:135], a[164:167], a[92:95], v[132:135]
    s_waitcnt lgkmcnt(9)
    ds_read_b64_tr_b16 a[190:191], v15 offset:45056
    buffer_load_dwordx4 a[140:143], v51, s[24:27], s49 offen offset:1024
    v_mfma_f32_16x16x32_bf16 v[136:139], a[168:171], a[80:83], v[136:139]
    s_waitcnt lgkmcnt(8)
    ds_read_b64_tr_b16 a[160:161], v16 offset:32768
    v_mfma_f32_16x16x32_bf16 v[136:139], a[172:175], a[88:91], v[136:139]
    s_add_u32 s49, s44, 4194304
    ds_read_b64_tr_b16 a[162:163], v16 offset:36864
    v_mfma_f32_16x16x32_bf16 v[140:143], a[168:171], a[84:87], v[140:143]
    s_add_u32 m0, s42, 131072
    ds_read_b64_tr_b16 a[164:165], v16 offset:40960
    v_mfma_f32_16x16x32_bf16 v[140:143], a[172:175], a[92:95], v[140:143]
    s_waitcnt lgkmcnt(9)
    ds_read_b64_tr_b16 a[166:167], v16 offset:45056
    buffer_load_dwordx4 v42, s[16:19], s49 offen lds
    v_mfma_f32_16x16x32_bf16 v[144:147], a[176:179], a[80:83], v[144:147]
    s_waitcnt lgkmcnt(8)
    ds_read_b64_tr_b16 a[168:169], v17 offset:32768
    v_mfma_f32_16x16x32_bf16 v[144:147], a[180:183], a[88:91], v[144:147]
    ds_read_b64_tr_b16 a[170:171], v17 offset:36864
    v_mfma_f32_16x16x32_bf16 v[148:151], a[176:179], a[84:87], v[148:151]
    ds_read_b64_tr_b16 a[172:173], v17 offset:40960
    v_mfma_f32_16x16x32_bf16 v[148:151], a[180:183], a[92:95], v[148:151]
    s_waitcnt lgkmcnt(9)
    ds_read_b64_tr_b16 a[174:175], v17 offset:45056
    buffer_load_dwordx4 v43, s[16:19], s49 offen offset:1024 lds
    v_mfma_f32_16x16x32_bf16 v[152:155], a[184:187], a[80:83], v[152:155]
    s_waitcnt lgkmcnt(8)
    ds_read_b64_tr_b16 a[176:177], v18 offset:32768
    v_mfma_f32_16x16x32_bf16 v[152:155], a[188:191], a[88:91], v[152:155]
    ds_read_b64_tr_b16 a[178:179], v18 offset:36864
    v_mfma_f32_16x16x32_bf16 v[156:159], a[184:187], a[84:87], v[156:159]
    ds_read_b64_tr_b16 a[180:181], v18 offset:40960
    v_mfma_f32_16x16x32_bf16 v[156:159], a[188:191], a[92:95], v[156:159]
    s_waitcnt lgkmcnt(9)
    ds_read_b64_tr_b16 a[182:183], v18 offset:45056
    buffer_load_dwordx4 v44, s[16:19], s49 offen offset:2048 lds
    v_mfma_f32_16x16x32_bf16 v[160:163], a[160:163], a[80:83], v[160:163]
    s_waitcnt lgkmcnt(8)
    ds_read_b64_tr_b16 a[184:185], v19 offset:32768
    v_mfma_f32_16x16x32_bf16 v[160:163], a[164:167], a[88:91], v[160:163]
    ds_read_b64_tr_b16 a[186:187], v19 offset:36864
    v_mfma_f32_16x16x32_bf16 v[164:167], a[160:163], a[84:87], v[164:167]
    ds_read_b64_tr_b16 a[188:189], v19 offset:40960
    v_mfma_f32_16x16x32_bf16 v[164:167], a[164:167], a[92:95], v[164:167]
    s_waitcnt lgkmcnt(9)
    ds_read_b64_tr_b16 a[190:191], v19 offset:45056
    buffer_load_dwordx4 v45, s[16:19], s49 offen offset:3072 lds
    v_mfma_f32_16x16x32_bf16 v[168:171], a[168:171], a[80:83], v[168:171]
    s_waitcnt lgkmcnt(8)
    ds_read_b64_tr_b16 a[160:161], v12 offset:49152
    v_mfma_f32_16x16x32_bf16 v[168:171], a[172:175], a[88:91], v[168:171]
    s_add_u32 s49, s44, 4194560
    ds_read_b64_tr_b16 a[162:163], v12 offset:53248
    v_mfma_f32_16x16x32_bf16 v[172:175], a[168:171], a[84:87], v[172:175]
    s_add_u32 m0, s42, 147456
    ds_read_b64_tr_b16 a[164:165], v12 offset:57344
    v_mfma_f32_16x16x32_bf16 v[172:175], a[172:175], a[92:95], v[172:175]
    s_waitcnt lgkmcnt(9)
    ds_read_b64_tr_b16 a[166:167], v12 offset:61440
    buffer_load_dwordx4 v42, s[16:19], s49 offen lds
    v_mfma_f32_16x16x32_bf16 v[176:179], a[176:179], a[80:83], v[176:179]
    s_waitcnt lgkmcnt(8)
    ds_read_b64_tr_b16 a[168:169], v13 offset:49152
    v_mfma_f32_16x16x32_bf16 v[176:179], a[180:183], a[88:91], v[176:179]
    ds_read_b64_tr_b16 a[170:171], v13 offset:53248
    v_mfma_f32_16x16x32_bf16 v[180:183], a[176:179], a[84:87], v[180:183]
    ds_read_b64_tr_b16 a[172:173], v13 offset:57344
    v_mfma_f32_16x16x32_bf16 v[180:183], a[180:183], a[92:95], v[180:183]
    s_waitcnt lgkmcnt(9)
    ds_read_b64_tr_b16 a[174:175], v13 offset:61440
    buffer_load_dwordx4 v43, s[16:19], s49 offen offset:1024 lds
    v_mfma_f32_16x16x32_bf16 v[184:187], a[184:187], a[80:83], v[184:187]
    s_waitcnt lgkmcnt(8)
    ds_read_b64_tr_b16 a[176:177], v14 offset:49152
    v_mfma_f32_16x16x32_bf16 v[184:187], a[188:191], a[88:91], v[184:187]
    ds_read_b64_tr_b16 a[178:179], v14 offset:53248
    v_mfma_f32_16x16x32_bf16 v[188:191], a[184:187], a[84:87], v[188:191]
    ds_read_b64_tr_b16 a[180:181], v14 offset:57344
    v_mfma_f32_16x16x32_bf16 v[188:191], a[188:191], a[92:95], v[188:191]
    s_waitcnt lgkmcnt(9)
    ds_read_b64_tr_b16 a[182:183], v14 offset:61440
    buffer_load_dwordx4 v44, s[16:19], s49 offen offset:2048 lds
    v_mfma_f32_16x16x32_bf16 v[192:195], a[160:163], a[80:83], v[192:195]
    s_waitcnt lgkmcnt(8)
    ds_read_b64_tr_b16 a[184:185], v15 offset:49152
    v_mfma_f32_16x16x32_bf16 v[192:195], a[164:167], a[88:91], v[192:195]
    ds_read_b64_tr_b16 a[186:187], v15 offset:53248
    v_mfma_f32_16x16x32_bf16 v[196:199], a[160:163], a[84:87], v[196:199]
    ds_read_b64_tr_b16 a[188:189], v15 offset:57344
    v_mfma_f32_16x16x32_bf16 v[196:199], a[164:167], a[92:95], v[196:199]
    s_waitcnt lgkmcnt(9)
    ds_read_b64_tr_b16 a[190:191], v15 offset:61440
    buffer_load_dwordx4 v45, s[16:19], s49 offen offset:3072 lds
    v_mfma_f32_16x16x32_bf16 v[200:203], a[168:171], a[80:83], v[200:203]
    s_waitcnt lgkmcnt(8)
    ds_read_b64_tr_b16 a[160:161], v16 offset:49152
    v_mfma_f32_16x16x32_bf16 v[200:203], a[172:175], a[88:91], v[200:203]
    ds_read_b64_tr_b16 a[162:163], v16 offset:53248
    v_mfma_f32_16x16x32_bf16 v[204:207], a[168:171], a[84:87], v[204:207]
    ds_read_b64_tr_b16 a[164:165], v16 offset:57344
    v_mfma_f32_16x16x32_bf16 v[204:207], a[172:175], a[92:95], v[204:207]
    s_waitcnt lgkmcnt(9)
    ds_read_b64_tr_b16 a[166:167], v16 offset:61440
    v_mfma_f32_16x16x32_bf16 v[208:211], a[176:179], a[80:83], v[208:211]
    s_waitcnt lgkmcnt(8)
    ds_read_b64_tr_b16 a[168:169], v17 offset:49152
    v_mfma_f32_16x16x32_bf16 v[208:211], a[180:183], a[88:91], v[208:211]
    ds_read_b64_tr_b16 a[170:171], v17 offset:53248
    v_mfma_f32_16x16x32_bf16 v[212:215], a[176:179], a[84:87], v[212:215]
    ds_read_b64_tr_b16 a[172:173], v17 offset:57344
    v_mfma_f32_16x16x32_bf16 v[212:215], a[180:183], a[92:95], v[212:215]
    s_waitcnt lgkmcnt(9)
    ds_read_b64_tr_b16 a[174:175], v17 offset:61440
    v_mfma_f32_16x16x32_bf16 v[216:219], a[184:187], a[80:83], v[216:219]
    s_waitcnt lgkmcnt(8)
    ds_read_b64_tr_b16 a[176:177], v18 offset:49152
    v_mfma_f32_16x16x32_bf16 v[216:219], a[188:191], a[88:91], v[216:219]
    ds_read_b64_tr_b16 a[178:179], v18 offset:53248
    v_mfma_f32_16x16x32_bf16 v[220:223], a[184:187], a[84:87], v[220:223]
    ds_read_b64_tr_b16 a[180:181], v18 offset:57344
    v_mfma_f32_16x16x32_bf16 v[220:223], a[188:191], a[92:95], v[220:223]
    s_waitcnt lgkmcnt(9)
    ds_read_b64_tr_b16 a[182:183], v18 offset:61440
    v_mfma_f32_16x16x32_bf16 v[224:227], a[160:163], a[80:83], v[224:227]
    s_waitcnt lgkmcnt(8)
    ds_read_b64_tr_b16 a[184:185], v19 offset:49152
    v_mfma_f32_16x16x32_bf16 v[224:227], a[164:167], a[88:91], v[224:227]
    ds_read_b64_tr_b16 a[186:187], v19 offset:53248
    v_mfma_f32_16x16x32_bf16 v[228:231], a[160:163], a[84:87], v[228:231]
    ds_read_b64_tr_b16 a[188:189], v19 offset:57344
    v_mfma_f32_16x16x32_bf16 v[228:231], a[164:167], a[92:95], v[228:231]
    s_waitcnt lgkmcnt(9)
    ds_read_b64_tr_b16 a[190:191], v19 offset:61440
    s_waitcnt vmcnt(24)
    s_barrier
    v_mfma_f32_16x16x32_bf16 v[232:235], a[168:171], a[80:83], v[232:235]
    s_waitcnt lgkmcnt(8)
    ds_read_b64_tr_b16 a[160:161], v20 offset:0
    v_mfma_f32_16x16x32_bf16 v[232:235], a[172:175], a[88:91], v[232:235]
    ds_read_b64_tr_b16 a[162:163], v20 offset:4096
    v_mfma_f32_16x16x32_bf16 v[236:239], a[168:171], a[84:87], v[236:239]
    s_add_u32 m0, s42, 0
    ds_read_b64_tr_b16 a[164:165], v20 offset:8192
    v_mfma_f32_16x16x32_bf16 v[236:239], a[172:175], a[92:95], v[236:239]
    s_waitcnt lgkmcnt(9)
    ds_read_b64_tr_b16 a[166:167], v20 offset:12288
    buffer_load_dwordx4 v36, s[8:11], s40 offen lds
    v_mfma_f32_16x16x32_bf16 v[240:243], a[176:179], a[80:83], v[240:243]
    s_waitcnt lgkmcnt(8)
    ds_read_b64_tr_b16 a[168:169], v21 offset:0
    v_mfma_f32_16x16x32_bf16 v[240:243], a[180:183], a[88:91], v[240:243]
    ds_read_b64_tr_b16 a[170:171], v21 offset:4096
    v_mfma_f32_16x16x32_bf16 v[244:247], a[176:179], a[84:87], v[244:247]
    ds_read_b64_tr_b16 a[172:173], v21 offset:8192
    v_mfma_f32_16x16x32_bf16 v[244:247], a[180:183], a[92:95], v[244:247]
    s_waitcnt lgkmcnt(9)
    ds_read_b64_tr_b16 a[174:175], v21 offset:12288
    buffer_load_dwordx4 v37, s[8:11], s40 offen offset:1024 lds
    v_mfma_f32_16x16x32_bf16 v[248:251], a[184:187], a[80:83], v[248:251]
    s_waitcnt lgkmcnt(8)
    ds_read_b64_tr_b16 a[176:177], v22 offset:0
    v_mfma_f32_16x16x32_bf16 v[248:251], a[188:191], a[88:91], v[248:251]
    ds_read_b64_tr_b16 a[178:179], v22 offset:4096
    v_mfma_f32_16x16x32_bf16 v[252:255], a[184:187], a[84:87], v[252:255]
    ds_read_b64_tr_b16 a[180:181], v22 offset:8192
    v_mfma_f32_16x16x32_bf16 v[252:255], a[188:191], a[92:95], v[252:255]
    s_waitcnt lgkmcnt(9)
    ds_read_b64_tr_b16 a[182:183], v22 offset:12288
    buffer_load_dwordx4 v38, s[8:11], s40 offen offset:2048 lds
    v_mfma_f32_16x16x32_bf16 v[128:131], a[160:163], a[96:99], v[128:131]
    s_waitcnt lgkmcnt(8)
    ds_read_b64_tr_b16 a[184:185], v23 offset:0
    v_mfma_f32_16x16x32_bf16 v[128:131], a[164:167], a[104:107], v[128:131]
    ds_read_b64_tr_b16 a[186:187], v23 offset:4096
    v_mfma_f32_16x16x32_bf16 v[132:135], a[160:163], a[100:103], v[132:135]
    ds_read_b64_tr_b16 a[188:189], v23 offset:8192
    v_mfma_f32_16x16x32_bf16 v[132:135], a[164:167], a[108:111], v[132:135]
    s_waitcnt lgkmcnt(9)
    ds_read_b64_tr_b16 a[190:191], v23 offset:12288
    buffer_load_dwordx4 v39, s[8:11], s40 offen offset:3072 lds
    v_mfma_f32_16x16x32_bf16 v[136:139], a[168:171], a[96:99], v[136:139]
    s_waitcnt lgkmcnt(8)
    s_add_u32 s40, s40, 16384
    ds_read_b64_tr_b16 a[160:161], v24 offset:0
    v_mfma_f32_16x16x32_bf16 v[136:139], a[172:175], a[104:107], v[136:139]
    ds_read_b64_tr_b16 a[162:163], v24 offset:4096
    v_mfma_f32_16x16x32_bf16 v[140:143], a[168:171], a[100:103], v[140:143]
    s_add_u32 m0, s42, 16384
    ds_read_b64_tr_b16 a[164:165], v24 offset:8192
    v_mfma_f32_16x16x32_bf16 v[140:143], a[172:175], a[108:111], v[140:143]
    s_waitcnt lgkmcnt(9)
    ds_read_b64_tr_b16 a[166:167], v24 offset:12288
    buffer_load_dwordx4 v36, s[8:11], s40 offen lds
    v_mfma_f32_16x16x32_bf16 v[144:147], a[176:179], a[96:99], v[144:147]
    s_waitcnt lgkmcnt(8)
    ds_read_b64_tr_b16 a[168:169], v25 offset:0
    v_mfma_f32_16x16x32_bf16 v[144:147], a[180:183], a[104:107], v[144:147]
    ds_read_b64_tr_b16 a[170:171], v25 offset:4096
    v_mfma_f32_16x16x32_bf16 v[148:151], a[176:179], a[100:103], v[148:151]
    ds_read_b64_tr_b16 a[172:173], v25 offset:8192
    v_mfma_f32_16x16x32_bf16 v[148:151], a[180:183], a[108:111], v[148:151]
    s_waitcnt lgkmcnt(9)
    ds_read_b64_tr_b16 a[174:175], v25 offset:12288
    buffer_load_dwordx4 v37, s[8:11], s40 offen offset:1024 lds
    v_mfma_f32_16x16x32_bf16 v[152:155], a[184:187], a[96:99], v[152:155]
    s_waitcnt lgkmcnt(8)
    ds_read_b64_tr_b16 a[176:177], v26 offset:0
    v_mfma_f32_16x16x32_bf16 v[152:155], a[188:191], a[104:107], v[152:155]
    ds_read_b64_tr_b16 a[178:179], v26 offset:4096
    v_mfma_f32_16x16x32_bf16 v[156:159], a[184:187], a[100:103], v[156:159]
    ds_read_b64_tr_b16 a[180:181], v26 offset:8192
    v_mfma_f32_16x16x32_bf16 v[156:159], a[188:191], a[108:111], v[156:159]
    s_waitcnt lgkmcnt(9)
    ds_read_b64_tr_b16 a[182:183], v26 offset:12288
    buffer_load_dwordx4 v38, s[8:11], s40 offen offset:2048 lds
    v_mfma_f32_16x16x32_bf16 v[160:163], a[160:163], a[96:99], v[160:163]
    s_waitcnt lgkmcnt(8)
    ds_read_b64_tr_b16 a[184:185], v27 offset:0
    v_mfma_f32_16x16x32_bf16 v[160:163], a[164:167], a[104:107], v[160:163]
    ds_read_b64_tr_b16 a[186:187], v27 offset:4096
    v_mfma_f32_16x16x32_bf16 v[164:167], a[160:163], a[100:103], v[164:167]
    ds_read_b64_tr_b16 a[188:189], v27 offset:8192
    v_mfma_f32_16x16x32_bf16 v[164:167], a[164:167], a[108:111], v[164:167]
    s_waitcnt lgkmcnt(9)
    ds_read_b64_tr_b16 a[190:191], v27 offset:12288
    buffer_load_dwordx4 v39, s[8:11], s40 offen offset:3072 lds
    v_mfma_f32_16x16x32_bf16 v[168:171], a[168:171], a[96:99], v[168:171]
    s_waitcnt lgkmcnt(8)
    s_add_u32 s40, s40, 16384
    ds_read_b64_tr_b16 a[160:161], v20 offset:16384
    v_mfma_f32_16x16x32_bf16 v[168:171], a[172:175], a[104:107], v[168:171]
    ds_read_b64_tr_b16 a[162:163], v20 offset:20480
    v_mfma_f32_16x16x32_bf16 v[172:175], a[168:171], a[100:103], v[172:175]
    ds_read_b64_tr_b16 a[164:165], v20 offset:24576
    v_mfma_f32_16x16x32_bf16 v[172:175], a[172:175], a[108:111], v[172:175]
    s_waitcnt lgkmcnt(9)
    ds_read_b64_tr_b16 a[166:167], v20 offset:28672
    v_mfma_f32_16x16x32_bf16 v[176:179], a[176:179], a[96:99], v[176:179]
    s_waitcnt lgkmcnt(8)
    ds_read_b64_tr_b16 a[168:169], v21 offset:16384
    v_mfma_f32_16x16x32_bf16 v[176:179], a[180:183], a[104:107], v[176:179]
    ds_read_b64_tr_b16 a[170:171], v21 offset:20480
    v_mfma_f32_16x16x32_bf16 v[180:183], a[176:179], a[100:103], v[180:183]
    ds_read_b64_tr_b16 a[172:173], v21 offset:24576
    v_mfma_f32_16x16x32_bf16 v[180:183], a[180:183], a[108:111], v[180:183]
    s_waitcnt lgkmcnt(9)
    ds_read_b64_tr_b16 a[174:175], v21 offset:28672
    v_mfma_f32_16x16x32_bf16 v[184:187], a[184:187], a[96:99], v[184:187]
    s_waitcnt lgkmcnt(8)
    ds_read_b64_tr_b16 a[176:177], v22 offset:16384
    v_mfma_f32_16x16x32_bf16 v[184:187], a[188:191], a[104:107], v[184:187]
    ds_read_b64_tr_b16 a[178:179], v22 offset:20480
    v_mfma_f32_16x16x32_bf16 v[188:191], a[184:187], a[100:103], v[188:191]
    ds_read_b64_tr_b16 a[180:181], v22 offset:24576
    v_mfma_f32_16x16x32_bf16 v[188:191], a[188:191], a[108:111], v[188:191]
    s_waitcnt lgkmcnt(9)
    ds_read_b64_tr_b16 a[182:183], v22 offset:28672
    v_mfma_f32_16x16x32_bf16 v[192:195], a[160:163], a[96:99], v[192:195]
    s_waitcnt lgkmcnt(8)
    ds_read_b64_tr_b16 a[184:185], v23 offset:16384
    v_accvgpr_write_b32 a0, 0
    v_mfma_f32_16x16x32_bf16 v[192:195], a[164:167], a[104:107], v[192:195]
    ds_read_b64_tr_b16 a[186:187], v23 offset:20480
    v_accvgpr_write_b32 a1, 0
    v_mfma_f32_16x16x32_bf16 v[196:199], a[160:163], a[100:103], v[196:199]
    ds_read_b64_tr_b16 a[188:189], v23 offset:24576
    v_accvgpr_write_b32 a2, 0
    v_mfma_f32_16x16x32_bf16 v[196:199], a[164:167], a[108:111], v[196:199]
    s_waitcnt lgkmcnt(9)
    ds_read_b64_tr_b16 a[190:191], v23 offset:28672
    v_accvgpr_write_b32 a3, 0
    v_mfma_f32_16x16x32_bf16 v[200:203], a[168:171], a[96:99], v[200:203]
    s_waitcnt lgkmcnt(8)
    ds_read_b64_tr_b16 a[160:161], v24 offset:16384
    v_accvgpr_write_b32 a4, 0
    v_mfma_f32_16x16x32_bf16 v[200:203], a[172:175], a[104:107], v[200:203]
    ds_read_b64_tr_b16 a[162:163], v24 offset:20480
    v_accvgpr_write_b32 a5, 0
    v_mfma_f32_16x16x32_bf16 v[204:207], a[168:171], a[100:103], v[204:207]
    ds_read_b64_tr_b16 a[164:165], v24 offset:24576
    v_accvgpr_write_b32 a6, 0
    v_mfma_f32_16x16x32_bf16 v[204:207], a[172:175], a[108:111], v[204:207]
    s_waitcnt lgkmcnt(9)
    ds_read_b64_tr_b16 a[166:167], v24 offset:28672
    v_accvgpr_write_b32 a7, 0
    v_mfma_f32_16x16x32_bf16 v[208:211], a[176:179], a[96:99], v[208:211]
    s_waitcnt lgkmcnt(8)
    ds_read_b64_tr_b16 a[168:169], v25 offset:16384
    v_accvgpr_write_b32 a8, 0
    v_mfma_f32_16x16x32_bf16 v[208:211], a[180:183], a[104:107], v[208:211]
    ds_read_b64_tr_b16 a[170:171], v25 offset:20480
    v_accvgpr_write_b32 a9, 0
    v_mfma_f32_16x16x32_bf16 v[212:215], a[176:179], a[100:103], v[212:215]
    ds_read_b64_tr_b16 a[172:173], v25 offset:24576
    v_accvgpr_write_b32 a10, 0
    v_mfma_f32_16x16x32_bf16 v[212:215], a[180:183], a[108:111], v[212:215]
    s_waitcnt lgkmcnt(9)
    ds_read_b64_tr_b16 a[174:175], v25 offset:28672
    v_accvgpr_write_b32 a11, 0
    v_mfma_f32_16x16x32_bf16 v[216:219], a[184:187], a[96:99], v[216:219]
    s_waitcnt lgkmcnt(8)
    ds_read_b64_tr_b16 a[176:177], v26 offset:16384
    v_accvgpr_write_b32 a12, 0
    v_mfma_f32_16x16x32_bf16 v[216:219], a[188:191], a[104:107], v[216:219]
    ds_read_b64_tr_b16 a[178:179], v26 offset:20480
    v_accvgpr_write_b32 a13, 0
    v_mfma_f32_16x16x32_bf16 v[220:223], a[184:187], a[100:103], v[220:223]
    ds_read_b64_tr_b16 a[180:181], v26 offset:24576
    v_accvgpr_write_b32 a14, 0
    v_mfma_f32_16x16x32_bf16 v[220:223], a[188:191], a[108:111], v[220:223]
    s_waitcnt lgkmcnt(9)
    ds_read_b64_tr_b16 a[182:183], v26 offset:28672
    v_accvgpr_write_b32 a15, 0
    v_mfma_f32_16x16x32_bf16 v[224:227], a[160:163], a[96:99], v[224:227]
    s_waitcnt lgkmcnt(8)
    ds_read_b64_tr_b16 a[184:185], v27 offset:16384
    v_accvgpr_write_b32 a16, 0
    v_mfma_f32_16x16x32_bf16 v[224:227], a[164:167], a[104:107], v[224:227]
    ds_read_b64_tr_b16 a[186:187], v27 offset:20480
    v_accvgpr_write_b32 a17, 0
    v_mfma_f32_16x16x32_bf16 v[228:231], a[160:163], a[100:103], v[228:231]
    ds_read_b64_tr_b16 a[188:189], v27 offset:24576
    v_accvgpr_write_b32 a18, 0
    v_mfma_f32_16x16x32_bf16 v[228:231], a[164:167], a[108:111], v[228:231]
    s_waitcnt lgkmcnt(9)
    ds_read_b64_tr_b16 a[190:191], v27 offset:28672
    v_accvgpr_write_b32 a19, 0
    s_waitcnt vmcnt(20)
    s_barrier
    v_mfma_f32_16x16x32_bf16 v[232:235], a[168:171], a[96:99], v[232:235]
    s_waitcnt lgkmcnt(8)
    ds_read_b64_tr_b16 a[160:161], v20 offset:32768
    v_accvgpr_write_b32 a20, 0
    v_mfma_f32_16x16x32_bf16 v[232:235], a[172:175], a[104:107], v[232:235]
    ds_read_b64_tr_b16 a[162:163], v20 offset:36864
    v_accvgpr_write_b32 a21, 0
    v_mfma_f32_16x16x32_bf16 v[236:239], a[168:171], a[100:103], v[236:239]
    s_add_u32 m0, s42, 32768
    ds_read_b64_tr_b16 a[164:165], v20 offset:40960
    v_accvgpr_write_b32 a22, 0
    v_mfma_f32_16x16x32_bf16 v[236:239], a[172:175], a[108:111], v[236:239]
    s_waitcnt lgkmcnt(9)
    ds_read_b64_tr_b16 a[166:167], v20 offset:45056
    buffer_load_dwordx4 v36, s[8:11], s40 offen lds
    v_mfma_f32_16x16x32_bf16 v[240:243], a[176:179], a[96:99], v[240:243]
    s_waitcnt lgkmcnt(8)
    ds_read_b64_tr_b16 a[168:169], v21 offset:32768
    v_accvgpr_write_b32 a23, 0
    v_mfma_f32_16x16x32_bf16 v[240:243], a[180:183], a[104:107], v[240:243]
    ds_read_b64_tr_b16 a[170:171], v21 offset:36864
    v_accvgpr_write_b32 a24, 0
    v_mfma_f32_16x16x32_bf16 v[244:247], a[176:179], a[100:103], v[244:247]
    ds_read_b64_tr_b16 a[172:173], v21 offset:40960
    v_accvgpr_write_b32 a25, 0
    v_mfma_f32_16x16x32_bf16 v[244:247], a[180:183], a[108:111], v[244:247]
    s_waitcnt lgkmcnt(9)
    ds_read_b64_tr_b16 a[174:175], v21 offset:45056
    buffer_load_dwordx4 v37, s[8:11], s40 offen offset:1024 lds
    v_mfma_f32_16x16x32_bf16 v[248:251], a[184:187], a[96:99], v[248:251]
    s_waitcnt lgkmcnt(8)
    ds_read_b64_tr_b16 a[176:177], v22 offset:32768
    v_accvgpr_write_b32 a26, 0
    v_mfma_f32_16x16x32_bf16 v[248:251], a[188:191], a[104:107], v[248:251]
    ds_read_b64_tr_b16 a[178:179], v22 offset:36864
    v_accvgpr_write_b32 a27, 0
    v_mfma_f32_16x16x32_bf16 v[252:255], a[184:187], a[100:103], v[252:255]
    ds_read_b64_tr_b16 a[180:181], v22 offset:40960
    v_accvgpr_write_b32 a28, 0
    v_mfma_f32_16x16x32_bf16 v[252:255], a[188:191], a[108:111], v[252:255]
    s_waitcnt lgkmcnt(9)
    ds_read_b64_tr_b16 a[182:183], v22 offset:45056
    buffer_load_dwordx4 v38, s[8:11], s40 offen offset:2048 lds
    v_mfma_f32_16x16x32_bf16 v[128:131], a[160:163], a[112:115], v[128:131]
    s_waitcnt lgkmcnt(8)
    ds_read_b64_tr_b16 a[184:185], v23 offset:32768
    v_accvgpr_write_b32 a29, 0
    v_mfma_f32_16x16x32_bf16 v[128:131], a[164:167], a[120:123], v[128:131]
    ds_read_b64_tr_b16 a[186:187], v23 offset:36864
    v_accvgpr_write_b32 a30, 0
    v_mfma_f32_16x16x32_bf16 v[132:135], a[160:163], a[116:119], v[132:135]
    ds_read_b64_tr_b16 a[188:189], v23 offset:40960
    v_accvgpr_write_b32 a31, 0
    v_mfma_f32_16x16x32_bf16 v[132:135], a[164:167], a[124:127], v[132:135]
    s_waitcnt lgkmcnt(9)
    ds_read_b64_tr_b16 a[190:191], v23 offset:45056
    buffer_load_dwordx4 v39, s[8:11], s40 offen offset:3072 lds
    v_mfma_f32_16x16x32_bf16 v[136:139], a[168:171], a[112:115], v[136:139]
    s_waitcnt lgkmcnt(8)
    s_add_u32 s40, s40, 16384
    ds_read_b64_tr_b16 a[160:161], v24 offset:32768
    v_accvgpr_write_b32 a32, 0
    v_mfma_f32_16x16x32_bf16 v[136:139], a[172:175], a[120:123], v[136:139]
    ds_read_b64_tr_b16 a[162:163], v24 offset:36864
    v_accvgpr_write_b32 a33, 0
    v_mfma_f32_16x16x32_bf16 v[140:143], a[168:171], a[116:119], v[140:143]
    ds_read_b64_tr_b16 a[164:165], v24 offset:40960
    v_accvgpr_write_b32 a34, 0
    v_mfma_f32_16x16x32_bf16 v[140:143], a[172:175], a[124:127], v[140:143]
    s_waitcnt lgkmcnt(9)
    ds_read_b64_tr_b16 a[166:167], v24 offset:45056
    v_accvgpr_write_b32 a35, 0
    v_mfma_f32_16x16x32_bf16 v[144:147], a[176:179], a[112:115], v[144:147]
    s_waitcnt lgkmcnt(8)
    ds_read_b64_tr_b16 a[168:169], v25 offset:32768
    v_accvgpr_write_b32 a36, 0
    v_mfma_f32_16x16x32_bf16 v[144:147], a[180:183], a[120:123], v[144:147]
    ds_read_b64_tr_b16 a[170:171], v25 offset:36864
    v_accvgpr_write_b32 a37, 0
    v_mfma_f32_16x16x32_bf16 v[148:151], a[176:179], a[116:119], v[148:151]
    ds_read_b64_tr_b16 a[172:173], v25 offset:40960
    v_accvgpr_write_b32 a38, 0
    v_mfma_f32_16x16x32_bf16 v[148:151], a[180:183], a[124:127], v[148:151]
    s_waitcnt lgkmcnt(9)
    ds_read_b64_tr_b16 a[174:175], v25 offset:45056
    v_accvgpr_write_b32 a39, 0
    v_mfma_f32_16x16x32_bf16 v[152:155], a[184:187], a[112:115], v[152:155]
    s_waitcnt lgkmcnt(8)
    ds_read_b64_tr_b16 a[176:177], v26 offset:32768
    v_accvgpr_write_b32 a40, 0
    v_mfma_f32_16x16x32_bf16 v[152:155], a[188:191], a[120:123], v[152:155]
    ds_read_b64_tr_b16 a[178:179], v26 offset:36864
    v_accvgpr_write_b32 a41, 0
    v_mfma_f32_16x16x32_bf16 v[156:159], a[184:187], a[116:119], v[156:159]
    ds_read_b64_tr_b16 a[180:181], v26 offset:40960
    v_accvgpr_write_b32 a42, 0
    v_mfma_f32_16x16x32_bf16 v[156:159], a[188:191], a[124:127], v[156:159]
    s_waitcnt lgkmcnt(9)
    ds_read_b64_tr_b16 a[182:183], v26 offset:45056
    v_accvgpr_write_b32 a43, 0
    v_mfma_f32_16x16x32_bf16 v[160:163], a[160:163], a[112:115], v[160:163]
    s_waitcnt lgkmcnt(8)
    ds_read_b64_tr_b16 a[184:185], v27 offset:32768
    v_accvgpr_write_b32 a44, 0
    v_mfma_f32_16x16x32_bf16 v[160:163], a[164:167], a[120:123], v[160:163]
    ds_read_b64_tr_b16 a[186:187], v27 offset:36864
    v_accvgpr_write_b32 a45, 0
    v_mfma_f32_16x16x32_bf16 v[164:167], a[160:163], a[116:119], v[164:167]
    ds_read_b64_tr_b16 a[188:189], v27 offset:40960
    v_accvgpr_write_b32 a46, 0
    v_mfma_f32_16x16x32_bf16 v[164:167], a[164:167], a[124:127], v[164:167]
    s_waitcnt lgkmcnt(9)
    ds_read_b64_tr_b16 a[190:191], v27 offset:45056
    v_accvgpr_write_b32 a47, 0
    v_mfma_f32_16x16x32_bf16 v[168:171], a[168:171], a[112:115], v[168:171]
    s_waitcnt lgkmcnt(8)
    ds_read_b64_tr_b16 a[160:161], v20 offset:49152
    v_accvgpr_write_b32 a48, 0
    v_mfma_f32_16x16x32_bf16 v[168:171], a[172:175], a[120:123], v[168:171]
    ds_read_b64_tr_b16 a[162:163], v20 offset:53248
    v_accvgpr_write_b32 a49, 0
    v_mfma_f32_16x16x32_bf16 v[172:175], a[168:171], a[116:119], v[172:175]
    ds_read_b64_tr_b16 a[164:165], v20 offset:57344
    v_accvgpr_write_b32 a50, 0
    v_mfma_f32_16x16x32_bf16 v[172:175], a[172:175], a[124:127], v[172:175]
    s_waitcnt lgkmcnt(9)
    ds_read_b64_tr_b16 a[166:167], v20 offset:61440
    v_accvgpr_write_b32 a51, 0
    v_mfma_f32_16x16x32_bf16 v[176:179], a[176:179], a[112:115], v[176:179]
    s_waitcnt lgkmcnt(8)
    ds_read_b64_tr_b16 a[168:169], v21 offset:49152
    v_accvgpr_write_b32 a52, 0
    v_mfma_f32_16x16x32_bf16 v[176:179], a[180:183], a[120:123], v[176:179]
    ds_read_b64_tr_b16 a[170:171], v21 offset:53248
    v_accvgpr_write_b32 a53, 0
    v_mfma_f32_16x16x32_bf16 v[180:183], a[176:179], a[116:119], v[180:183]
    ds_read_b64_tr_b16 a[172:173], v21 offset:57344
    v_accvgpr_write_b32 a54, 0
    v_mfma_f32_16x16x32_bf16 v[180:183], a[180:183], a[124:127], v[180:183]
    s_waitcnt lgkmcnt(9)
    ds_read_b64_tr_b16 a[174:175], v21 offset:61440
    v_accvgpr_write_b32 a55, 0
    v_mfma_f32_16x16x32_bf16 v[184:187], a[184:187], a[112:115], v[184:187]
    s_waitcnt lgkmcnt(8)
    ds_read_b64_tr_b16 a[176:177], v22 offset:49152
    v_accvgpr_write_b32 a56, 0
    v_mfma_f32_16x16x32_bf16 v[184:187], a[188:191], a[120:123], v[184:187]
    ds_read_b64_tr_b16 a[178:179], v22 offset:53248
    v_accvgpr_write_b32 a57, 0
    v_mfma_f32_16x16x32_bf16 v[188:191], a[184:187], a[116:119], v[188:191]
    ds_read_b64_tr_b16 a[180:181], v22 offset:57344
    v_accvgpr_write_b32 a58, 0
    v_mfma_f32_16x16x32_bf16 v[188:191], a[188:191], a[124:127], v[188:191]
    s_waitcnt lgkmcnt(9)
    ds_read_b64_tr_b16 a[182:183], v22 offset:61440
    v_accvgpr_write_b32 a59, 0
    v_mfma_f32_16x16x32_bf16 v[192:195], a[160:163], a[112:115], v[192:195]
    s_waitcnt lgkmcnt(8)
    ds_read_b64_tr_b16 a[184:185], v23 offset:49152
    v_accvgpr_write_b32 a60, 0
    v_mfma_f32_16x16x32_bf16 v[192:195], a[164:167], a[120:123], v[192:195]
    ds_read_b64_tr_b16 a[186:187], v23 offset:53248
    v_accvgpr_write_b32 a61, 0
    v_mfma_f32_16x16x32_bf16 v[196:199], a[160:163], a[116:119], v[196:199]
    ds_read_b64_tr_b16 a[188:189], v23 offset:57344
    v_accvgpr_write_b32 a62, 0
    v_mfma_f32_16x16x32_bf16 v[196:199], a[164:167], a[124:127], v[196:199]
    s_waitcnt lgkmcnt(9)
    ds_read_b64_tr_b16 a[190:191], v23 offset:61440
    v_accvgpr_write_b32 a63, 0
    v_mfma_f32_16x16x32_bf16 v[200:203], a[168:171], a[112:115], v[200:203]
    s_waitcnt lgkmcnt(8)
    ds_read_b64_tr_b16 a[160:161], v24 offset:49152
    v_accvgpr_write_b32 a64, 0
    v_mfma_f32_16x16x32_bf16 v[200:203], a[172:175], a[120:123], v[200:203]
    ds_read_b64_tr_b16 a[162:163], v24 offset:53248
    v_accvgpr_write_b32 a65, 0
    v_mfma_f32_16x16x32_bf16 v[204:207], a[168:171], a[116:119], v[204:207]
    ds_read_b64_tr_b16 a[164:165], v24 offset:57344
    v_accvgpr_write_b32 a66, 0
    v_mfma_f32_16x16x32_bf16 v[204:207], a[172:175], a[124:127], v[204:207]
    s_waitcnt lgkmcnt(9)
    ds_read_b64_tr_b16 a[166:167], v24 offset:61440
    v_accvgpr_write_b32 a67, 0
    v_mfma_f32_16x16x32_bf16 v[208:211], a[176:179], a[112:115], v[208:211]
    s_waitcnt lgkmcnt(8)
    ds_read_b64_tr_b16 a[168:169], v25 offset:49152
    v_accvgpr_write_b32 a68, 0
    v_mfma_f32_16x16x32_bf16 v[208:211], a[180:183], a[120:123], v[208:211]
    ds_read_b64_tr_b16 a[170:171], v25 offset:53248
    v_accvgpr_write_b32 a69, 0
    v_mfma_f32_16x16x32_bf16 v[212:215], a[176:179], a[116:119], v[212:215]
    ds_read_b64_tr_b16 a[172:173], v25 offset:57344
    v_accvgpr_write_b32 a70, 0
    v_mfma_f32_16x16x32_bf16 v[212:215], a[180:183], a[124:127], v[212:215]
    s_waitcnt lgkmcnt(9)
    ds_read_b64_tr_b16 a[174:175], v25 offset:61440
    v_accvgpr_write_b32 a71, 0
    v_mfma_f32_16x16x32_bf16 v[216:219], a[184:187], a[112:115], v[216:219]
    s_waitcnt lgkmcnt(8)
    ds_read_b64_tr_b16 a[176:177], v26 offset:49152
    v_accvgpr_write_b32 a72, 0
    v_mfma_f32_16x16x32_bf16 v[216:219], a[188:191], a[120:123], v[216:219]
    ds_read_b64_tr_b16 a[178:179], v26 offset:53248
    v_accvgpr_write_b32 a73, 0
    v_mfma_f32_16x16x32_bf16 v[220:223], a[184:187], a[116:119], v[220:223]
    ds_read_b64_tr_b16 a[180:181], v26 offset:57344
    v_accvgpr_write_b32 a74, 0
    v_mfma_f32_16x16x32_bf16 v[220:223], a[188:191], a[124:127], v[220:223]
    s_waitcnt lgkmcnt(9)
    ds_read_b64_tr_b16 a[182:183], v26 offset:61440
    v_accvgpr_write_b32 a75, 0
    v_mfma_f32_16x16x32_bf16 v[224:227], a[160:163], a[112:115], v[224:227]
    s_waitcnt lgkmcnt(8)
    ds_read_b64_tr_b16 a[184:185], v27 offset:49152
    v_accvgpr_write_b32 a76, 0
    v_mfma_f32_16x16x32_bf16 v[224:227], a[164:167], a[120:123], v[224:227]
    ds_read_b64_tr_b16 a[186:187], v27 offset:53248
    v_accvgpr_write_b32 a77, 0
    v_mfma_f32_16x16x32_bf16 v[228:231], a[160:163], a[116:119], v[228:231]
    ds_read_b64_tr_b16 a[188:189], v27 offset:57344
    v_accvgpr_write_b32 a78, 0
    v_mfma_f32_16x16x32_bf16 v[228:231], a[164:167], a[124:127], v[228:231]
    s_waitcnt lgkmcnt(9)
    ds_read_b64_tr_b16 a[190:191], v27 offset:61440
    v_accvgpr_write_b32 a79, 0
    s_waitcnt vmcnt(12)
    s_barrier
    v_mfma_f32_16x16x32_bf16 v[232:235], a[168:171], a[112:115], v[232:235]
    s_waitcnt lgkmcnt(8)
    ds_read_b64_tr_b16 a[160:161], v28 offset:0
    v_accvgpr_write_b32 a80, 0
    v_mfma_f32_16x16x32_bf16 v[232:235], a[172:175], a[120:123], v[232:235]
    ds_read_b64_tr_b16 a[162:163], v28 offset:4096
    v_accvgpr_write_b32 a81, 0
    v_mfma_f32_16x16x32_bf16 v[236:239], a[168:171], a[116:119], v[236:239]
    s_add_u32 m0, s42, 65536
    ds_read_b64_tr_b16 a[164:165], v28 offset:8192
    v_accvgpr_write_b32 a82, 0
    v_mfma_f32_16x16x32_bf16 v[236:239], a[172:175], a[124:127], v[236:239]
    s_waitcnt lgkmcnt(9)
    ds_read_b64_tr_b16 a[166:167], v28 offset:12288
    buffer_load_dwordx4 v40, s[12:15], s41 offen lds
    v_mfma_f32_16x16x32_bf16 v[240:243], a[176:179], a[112:115], v[240:243]
    s_waitcnt lgkmcnt(8)
    ds_read_b64_tr_b16 a[168:169], v29 offset:0
    v_accvgpr_write_b32 a83, 0
    v_mfma_f32_16x16x32_bf16 v[240:243], a[180:183], a[120:123], v[240:243]
    ds_read_b64_tr_b16 a[170:171], v29 offset:4096
    v_accvgpr_write_b32 a84, 0
    v_mfma_f32_16x16x32_bf16 v[244:247], a[176:179], a[116:119], v[244:247]
    ds_read_b64_tr_b16 a[172:173], v29 offset:8192
    v_accvgpr_write_b32 a85, 0
    v_mfma_f32_16x16x32_bf16 v[244:247], a[180:183], a[124:127], v[244:247]
    s_waitcnt lgkmcnt(9)
    ds_read_b64_tr_b16 a[174:175], v29 offset:12288
    buffer_load_dwordx4 v41, s[12:15], s41 offen offset:1024 lds
    v_mfma_f32_16x16x32_bf16 v[248:251], a[184:187], a[112:115], v[248:251]
    s_waitcnt lgkmcnt(8)
    ds_read_b64_tr_b16 a[176:177], v30 offset:0
    v_accvgpr_write_b32 a86, 0
    v_mfma_f32_16x16x32_bf16 v[248:251], a[188:191], a[120:123], v[248:251]
    ds_read_b64_tr_b16 a[178:179], v30 offset:4096
    v_accvgpr_write_b32 a87, 0
    v_mfma_f32_16x16x32_bf16 v[252:255], a[184:187], a[116:119], v[252:255]
    ds_read_b64_tr_b16 a[180:181], v30 offset:8192
    v_accvgpr_write_b32 a88, 0
    v_mfma_f32_16x16x32_bf16 v[252:255], a[188:191], a[124:127], v[252:255]
    s_waitcnt lgkmcnt(9)
    ds_read_b64_tr_b16 a[182:183], v30 offset:12288
    buffer_load_dwordx4 v40, s[12:15], s41 offen offset:2048 lds
    v_mfma_f32_16x16x32_bf16 v[128:131], a[160:163], a[128:131], v[128:131]
    s_waitcnt lgkmcnt(8)
    ds_read_b64_tr_b16 a[184:185], v31 offset:0
    v_accvgpr_write_b32 a89, 0
    v_mfma_f32_16x16x32_bf16 v[128:131], a[164:167], a[136:139], v[128:131]
    ds_read_b64_tr_b16 a[186:187], v31 offset:4096
    v_accvgpr_write_b32 a90, 0
    v_mfma_f32_16x16x32_bf16 v[132:135], a[160:163], a[132:135], v[132:135]
    ds_read_b64_tr_b16 a[188:189], v31 offset:8192
    v_accvgpr_write_b32 a91, 0
    v_mfma_f32_16x16x32_bf16 v[132:135], a[164:167], a[140:143], v[132:135]
    s_waitcnt lgkmcnt(9)
    ds_read_b64_tr_b16 a[190:191], v31 offset:12288
    buffer_load_dwordx4 v41, s[12:15], s41 offen offset:3072 lds
    v_mfma_f32_16x16x32_bf16 v[136:139], a[168:171], a[128:131], v[136:139]
    s_waitcnt lgkmcnt(8)
    s_add_u32 s41, s41, 16384
    ds_read_b64_tr_b16 a[160:161], v32 offset:0
    v_accvgpr_write_b32 a92, 0
    v_mfma_f32_16x16x32_bf16 v[136:139], a[172:175], a[136:139], v[136:139]
    ds_read_b64_tr_b16 a[162:163], v32 offset:4096
    v_accvgpr_write_b32 a93, 0
    v_mfma_f32_16x16x32_bf16 v[140:143], a[168:171], a[132:135], v[140:143]
    s_add_u32 m0, s42, 81920
    ds_read_b64_tr_b16 a[164:165], v32 offset:8192
    v_accvgpr_write_b32 a94, 0
    v_mfma_f32_16x16x32_bf16 v[140:143], a[172:175], a[140:143], v[140:143]
    s_waitcnt lgkmcnt(9)
    ds_read_b64_tr_b16 a[166:167], v32 offset:12288
    buffer_load_dwordx4 v40, s[12:15], s41 offen lds
    v_mfma_f32_16x16x32_bf16 v[144:147], a[176:179], a[128:131], v[144:147]
    s_waitcnt lgkmcnt(8)
    ds_read_b64_tr_b16 a[168:169], v33 offset:0
    v_accvgpr_write_b32 a95, 0
    v_mfma_f32_16x16x32_bf16 v[144:147], a[180:183], a[136:139], v[144:147]
    ds_read_b64_tr_b16 a[170:171], v33 offset:4096
    v_accvgpr_write_b32 a96, 0
    v_mfma_f32_16x16x32_bf16 v[148:151], a[176:179], a[132:135], v[148:151]
    ds_read_b64_tr_b16 a[172:173], v33 offset:8192
    v_accvgpr_write_b32 a97, 0
    v_mfma_f32_16x16x32_bf16 v[148:151], a[180:183], a[140:143], v[148:151]
    s_waitcnt lgkmcnt(9)
    ds_read_b64_tr_b16 a[174:175], v33 offset:12288
    buffer_load_dwordx4 v41, s[12:15], s41 offen offset:1024 lds
    v_mfma_f32_16x16x32_bf16 v[152:155], a[184:187], a[128:131], v[152:155]
    s_waitcnt lgkmcnt(8)
    ds_read_b64_tr_b16 a[176:177], v34 offset:0
    v_accvgpr_write_b32 a98, 0
    v_mfma_f32_16x16x32_bf16 v[152:155], a[188:191], a[136:139], v[152:155]
    ds_read_b64_tr_b16 a[178:179], v34 offset:4096
    v_accvgpr_write_b32 a99, 0
    v_mfma_f32_16x16x32_bf16 v[156:159], a[184:187], a[132:135], v[156:159]
    ds_read_b64_tr_b16 a[180:181], v34 offset:8192
    v_accvgpr_write_b32 a100, 0
    v_mfma_f32_16x16x32_bf16 v[156:159], a[188:191], a[140:143], v[156:159]
    s_waitcnt lgkmcnt(9)
    ds_read_b64_tr_b16 a[182:183], v34 offset:12288
    buffer_load_dwordx4 v40, s[12:15], s41 offen offset:2048 lds
    v_mfma_f32_16x16x32_bf16 v[160:163], a[160:163], a[128:131], v[160:163]
    s_waitcnt lgkmcnt(8)
    ds_read_b64_tr_b16 a[184:185], v35 offset:0
    v_accvgpr_write_b32 a101, 0
    v_mfma_f32_16x16x32_bf16 v[160:163], a[164:167], a[136:139], v[160:163]
    ds_read_b64_tr_b16 a[186:187], v35 offset:4096
    v_accvgpr_write_b32 a102, 0
    v_mfma_f32_16x16x32_bf16 v[164:167], a[160:163], a[132:135], v[164:167]
    ds_read_b64_tr_b16 a[188:189], v35 offset:8192
    v_accvgpr_write_b32 a103, 0
    v_mfma_f32_16x16x32_bf16 v[164:167], a[164:167], a[140:143], v[164:167]
    s_waitcnt lgkmcnt(9)
    ds_read_b64_tr_b16 a[190:191], v35 offset:12288
    buffer_load_dwordx4 v41, s[12:15], s41 offen offset:3072 lds
    v_mfma_f32_16x16x32_bf16 v[168:171], a[168:171], a[128:131], v[168:171]
    s_waitcnt lgkmcnt(8)
    s_add_u32 s41, s41, 16384
    ds_read_b64_tr_b16 a[160:161], v28 offset:16384
    v_accvgpr_write_b32 a104, 0
    v_mfma_f32_16x16x32_bf16 v[168:171], a[172:175], a[136:139], v[168:171]
    ds_read_b64_tr_b16 a[162:163], v28 offset:20480
    v_accvgpr_write_b32 a105, 0
    v_mfma_f32_16x16x32_bf16 v[172:175], a[168:171], a[132:135], v[172:175]
    ds_read_b64_tr_b16 a[164:165], v28 offset:24576
    v_accvgpr_write_b32 a106, 0
    v_mfma_f32_16x16x32_bf16 v[172:175], a[172:175], a[140:143], v[172:175]
    s_waitcnt lgkmcnt(9)
    ds_read_b64_tr_b16 a[166:167], v28 offset:28672
    v_accvgpr_write_b32 a107, 0
    v_mfma_f32_16x16x32_bf16 v[176:179], a[176:179], a[128:131], v[176:179]
    s_waitcnt lgkmcnt(8)
    ds_read_b64_tr_b16 a[168:169], v29 offset:16384
    v_accvgpr_write_b32 a108, 0
    v_mfma_f32_16x16x32_bf16 v[176:179], a[180:183], a[136:139], v[176:179]
    ds_read_b64_tr_b16 a[170:171], v29 offset:20480
    v_accvgpr_write_b32 a109, 0
    v_mfma_f32_16x16x32_bf16 v[180:183], a[176:179], a[132:135], v[180:183]
    ds_read_b64_tr_b16 a[172:173], v29 offset:24576
    v_accvgpr_write_b32 a110, 0
    v_mfma_f32_16x16x32_bf16 v[180:183], a[180:183], a[140:143], v[180:183]
    s_waitcnt lgkmcnt(9)
    ds_read_b64_tr_b16 a[174:175], v29 offset:28672
    v_accvgpr_write_b32 a111, 0
    v_mfma_f32_16x16x32_bf16 v[184:187], a[184:187], a[128:131], v[184:187]
    s_waitcnt lgkmcnt(8)
    ds_read_b64_tr_b16 a[176:177], v30 offset:16384
    v_accvgpr_write_b32 a192, 0
    v_mfma_f32_16x16x32_bf16 v[184:187], a[188:191], a[136:139], v[184:187]
    ds_read_b64_tr_b16 a[178:179], v30 offset:20480
    v_accvgpr_write_b32 a193, 0
    v_mfma_f32_16x16x32_bf16 v[188:191], a[184:187], a[132:135], v[188:191]
    ds_read_b64_tr_b16 a[180:181], v30 offset:24576
    v_accvgpr_write_b32 a194, 0
    v_mfma_f32_16x16x32_bf16 v[188:191], a[188:191], a[140:143], v[188:191]
    s_waitcnt lgkmcnt(9)
    ds_read_b64_tr_b16 a[182:183], v30 offset:28672
    v_accvgpr_write_b32 a195, 0
    v_mfma_f32_16x16x32_bf16 v[192:195], a[160:163], a[128:131], v[192:195]
    s_waitcnt lgkmcnt(8)
    ds_read_b64_tr_b16 a[184:185], v31 offset:16384
    v_accvgpr_write_b32 a196, 0
    v_mfma_f32_16x16x32_bf16 v[192:195], a[164:167], a[136:139], v[192:195]
    ds_read_b64_tr_b16 a[186:187], v31 offset:20480
    v_accvgpr_write_b32 a197, 0
    v_mfma_f32_16x16x32_bf16 v[196:199], a[160:163], a[132:135], v[196:199]
    ds_read_b64_tr_b16 a[188:189], v31 offset:24576
    v_accvgpr_write_b32 a198, 0
    v_mfma_f32_16x16x32_bf16 v[196:199], a[164:167], a[140:143], v[196:199]
    s_waitcnt lgkmcnt(9)
    ds_read_b64_tr_b16 a[190:191], v31 offset:28672
    v_accvgpr_write_b32 a199, 0
    v_mfma_f32_16x16x32_bf16 v[200:203], a[168:171], a[128:131], v[200:203]
    s_waitcnt lgkmcnt(8)
    ds_read_b64_tr_b16 a[160:161], v32 offset:16384
    v_accvgpr_write_b32 a200, 0
    v_mfma_f32_16x16x32_bf16 v[200:203], a[172:175], a[136:139], v[200:203]
    ds_read_b64_tr_b16 a[162:163], v32 offset:20480
    v_accvgpr_write_b32 a201, 0
    v_mfma_f32_16x16x32_bf16 v[204:207], a[168:171], a[132:135], v[204:207]
    ds_read_b64_tr_b16 a[164:165], v32 offset:24576
    v_accvgpr_write_b32 a202, 0
    v_mfma_f32_16x16x32_bf16 v[204:207], a[172:175], a[140:143], v[204:207]
    s_waitcnt lgkmcnt(9)
    ds_read_b64_tr_b16 a[166:167], v32 offset:28672
    v_accvgpr_write_b32 a203, 0
    v_mfma_f32_16x16x32_bf16 v[208:211], a[176:179], a[128:131], v[208:211]
    s_waitcnt lgkmcnt(8)
    ds_read_b64_tr_b16 a[168:169], v33 offset:16384
    v_accvgpr_write_b32 a204, 0
    v_mfma_f32_16x16x32_bf16 v[208:211], a[180:183], a[136:139], v[208:211]
    ds_read_b64_tr_b16 a[170:171], v33 offset:20480
    v_accvgpr_write_b32 a205, 0
    v_mfma_f32_16x16x32_bf16 v[212:215], a[176:179], a[132:135], v[212:215]
    ds_read_b64_tr_b16 a[172:173], v33 offset:24576
    v_accvgpr_write_b32 a206, 0
    v_mfma_f32_16x16x32_bf16 v[212:215], a[180:183], a[140:143], v[212:215]
    s_waitcnt lgkmcnt(9)
    ds_read_b64_tr_b16 a[174:175], v33 offset:28672
    v_accvgpr_write_b32 a207, 0
    v_mfma_f32_16x16x32_bf16 v[216:219], a[184:187], a[128:131], v[216:219]
    s_waitcnt lgkmcnt(8)
    ds_read_b64_tr_b16 a[176:177], v34 offset:16384
    v_accvgpr_write_b32 a112, 0
    v_mfma_f32_16x16x32_bf16 v[216:219], a[188:191], a[136:139], v[216:219]
    ds_read_b64_tr_b16 a[178:179], v34 offset:20480
    v_accvgpr_write_b32 a113, 0
    v_mfma_f32_16x16x32_bf16 v[220:223], a[184:187], a[132:135], v[220:223]
    ds_read_b64_tr_b16 a[180:181], v34 offset:24576
    v_accvgpr_write_b32 a114, 0
    v_mfma_f32_16x16x32_bf16 v[220:223], a[188:191], a[140:143], v[220:223]
    s_waitcnt lgkmcnt(9)
    ds_read_b64_tr_b16 a[182:183], v34 offset:28672
    v_accvgpr_write_b32 a115, 0
    v_mfma_f32_16x16x32_bf16 v[224:227], a[160:163], a[128:131], v[224:227]
    s_waitcnt lgkmcnt(8)
    ds_read_b64_tr_b16 a[184:185], v35 offset:16384
    v_accvgpr_write_b32 a116, 0
    v_mfma_f32_16x16x32_bf16 v[224:227], a[164:167], a[136:139], v[224:227]
    ds_read_b64_tr_b16 a[186:187], v35 offset:20480
    v_accvgpr_write_b32 a117, 0
    v_mfma_f32_16x16x32_bf16 v[228:231], a[160:163], a[132:135], v[228:231]
    ds_read_b64_tr_b16 a[188:189], v35 offset:24576
    v_accvgpr_write_b32 a118, 0
    v_mfma_f32_16x16x32_bf16 v[228:231], a[164:167], a[140:143], v[228:231]
    s_waitcnt lgkmcnt(9)
    ds_read_b64_tr_b16 a[190:191], v35 offset:28672
    v_accvgpr_write_b32 a119, 0
    v_mfma_f32_16x16x32_bf16 v[232:235], a[168:171], a[128:131], v[232:235]
    s_waitcnt lgkmcnt(8)
    v_accvgpr_write_b32 a120, 0
    v_mfma_f32_16x16x32_bf16 v[232:235], a[172:175], a[136:139], v[232:235]
    v_accvgpr_write_b32 a121, 0
    v_mfma_f32_16x16x32_bf16 v[236:239], a[168:171], a[132:135], v[236:239]
    v_accvgpr_write_b32 a122, 0
    v_mfma_f32_16x16x32_bf16 v[236:239], a[172:175], a[140:143], v[236:239]
    s_waitcnt lgkmcnt(6)
    v_accvgpr_write_b32 a123, 0
    s_waitcnt vmcnt(16)
    s_barrier
    v_mfma_f32_16x16x32_bf16 v[240:243], a[176:179], a[128:131], v[240:243]
    s_waitcnt lgkmcnt(4)
    ds_read_b128 a[208:211], v8 offset:0
    v_accvgpr_write_b32 a124, 0
    v_mfma_f32_16x16x32_bf16 v[240:243], a[180:183], a[136:139], v[240:243]
    ds_read_b128 a[212:215], v9 offset:0
    v_accvgpr_write_b32 a125, 0
    v_mfma_f32_16x16x32_bf16 v[244:247], a[176:179], a[132:135], v[244:247]
    ds_read_b128 a[216:219], v10 offset:0
    v_accvgpr_write_b32 a126, 0
    v_mfma_f32_16x16x32_bf16 v[244:247], a[180:183], a[140:143], v[244:247]
    s_waitcnt lgkmcnt(5)
    ds_read_b128 a[220:223], v11 offset:0
    v_accvgpr_write_b32 a127, 0
    v_mfma_f32_16x16x32_bf16 v[248:251], a[184:187], a[128:131], v[248:251]
    s_waitcnt lgkmcnt(4)
    ds_read_b128 a[224:227], v8 offset:4096
    v_mfma_f32_16x16x32_bf16 v[248:251], a[188:191], a[136:139], v[248:251]
    v_mfma_f32_16x16x32_bf16 v[252:255], a[184:187], a[132:135], v[252:255]
    v_mfma_f32_16x16x32_bf16 v[252:255], a[188:191], a[140:143], v[252:255]
    s_waitcnt lgkmcnt(4)
    s_mov_b32 s36, 1040356334
    s_mov_b32 s37, 1040356334
    v_pk_mul_f32 v[128:129], v[128:129], s[36:37]
    v_pk_mul_f32 v[130:131], v[130:131], s[36:37]
    v_pk_mul_f32 v[136:137], v[136:137], s[36:37]
    v_pk_mul_f32 v[138:139], v[138:139], s[36:37]
    v_cvt_pk_bf16_f32 v64, v128, v129
    v_cvt_pk_bf16_f32 v65, v130, v131
    v_cvt_pk_bf16_f32 v66, v136, v137
    v_cvt_pk_bf16_f32 v67, v138, v139
    v_pk_mul_f32 v[132:133], v[132:133], s[36:37]
    v_pk_mul_f32 v[134:135], v[134:135], s[36:37]
    v_pk_mul_f32 v[140:141], v[140:141], s[36:37]
    v_pk_mul_f32 v[142:143], v[142:143], s[36:37]
    v_cvt_pk_bf16_f32 v80, v132, v133
    v_cvt_pk_bf16_f32 v81, v134, v135
    v_cvt_pk_bf16_f32 v82, v140, v141
    v_cvt_pk_bf16_f32 v83, v142, v143
    v_permlane32_swap_b32 v64, v66
    v_permlane32_swap_b32 v65, v67
    v_permlane32_swap_b32 v80, v82
    v_permlane32_swap_b32 v81, v83
    v_permlane16_swap_b32 v64, v66
    v_permlane16_swap_b32 v65, v67
    v_permlane16_swap_b32 v80, v82
    v_permlane16_swap_b32 v81, v83
    v_pk_mul_f32 v[144:145], v[144:145], s[36:37]
    v_pk_mul_f32 v[146:147], v[146:147], s[36:37]
    v_pk_mul_f32 v[152:153], v[152:153], s[36:37]
    v_pk_mul_f32 v[154:155], v[154:155], s[36:37]
    v_cvt_pk_bf16_f32 v68, v144, v145
    v_cvt_pk_bf16_f32 v69, v146, v147
    v_cvt_pk_bf16_f32 v70, v152, v153
    v_cvt_pk_bf16_f32 v71, v154, v155
    v_pk_mul_f32 v[148:149], v[148:149], s[36:37]
    v_pk_mul_f32 v[150:151], v[150:151], s[36:37]
    v_pk_mul_f32 v[156:157], v[156:157], s[36:37]
    v_pk_mul_f32 v[158:159], v[158:159], s[36:37]
    v_cvt_pk_bf16_f32 v84, v148, v149
    v_cvt_pk_bf16_f32 v85, v150, v151
    v_cvt_pk_bf16_f32 v86, v156, v157
    v_cvt_pk_bf16_f32 v87, v158, v159
    v_permlane32_swap_b32 v68, v70
    v_permlane32_swap_b32 v69, v71
    v_permlane32_swap_b32 v84, v86
    v_permlane32_swap_b32 v85, v87
    v_permlane16_swap_b32 v68, v70
    v_permlane16_swap_b32 v69, v71
    v_permlane16_swap_b32 v84, v86
    v_permlane16_swap_b32 v85, v87
    v_pk_mul_f32 v[160:161], v[160:161], s[36:37]
    v_pk_mul_f32 v[162:163], v[162:163], s[36:37]
    v_pk_mul_f32 v[168:169], v[168:169], s[36:37]
    v_pk_mul_f32 v[170:171], v[170:171], s[36:37]
    v_cvt_pk_bf16_f32 v72, v160, v161
    v_cvt_pk_bf16_f32 v73, v162, v163
    v_cvt_pk_bf16_f32 v74, v168, v169
    v_cvt_pk_bf16_f32 v75, v170, v171
    v_pk_mul_f32 v[164:165], v[164:165], s[36:37]
    v_pk_mul_f32 v[166:167], v[166:167], s[36:37]
    v_pk_mul_f32 v[172:173], v[172:173], s[36:37]
    v_pk_mul_f32 v[174:175], v[174:175], s[36:37]
    v_cvt_pk_bf16_f32 v88, v164, v165
    v_cvt_pk_bf16_f32 v89, v166, v167
    v_cvt_pk_bf16_f32 v90, v172, v173
    v_cvt_pk_bf16_f32 v91, v174, v175
    v_permlane32_swap_b32 v72, v74
    v_permlane32_swap_b32 v73, v75
    v_permlane32_swap_b32 v88, v90
    v_permlane32_swap_b32 v89, v91
    v_permlane16_swap_b32 v72, v74
    v_permlane16_swap_b32 v73, v75
    v_permlane16_swap_b32 v88, v90
    v_permlane16_swap_b32 v89, v91
    v_pk_mul_f32 v[176:177], v[176:177], s[36:37]
    v_pk_mul_f32 v[178:179], v[178:179], s[36:37]
    v_pk_mul_f32 v[184:185], v[184:185], s[36:37]
    v_pk_mul_f32 v[186:187], v[186:187], s[36:37]
    v_cvt_pk_bf16_f32 v76, v176, v177
    v_cvt_pk_bf16_f32 v77, v178, v179
    v_cvt_pk_bf16_f32 v78, v184, v185
    v_cvt_pk_bf16_f32 v79, v186, v187
    v_pk_mul_f32 v[180:181], v[180:181], s[36:37]
    v_pk_mul_f32 v[182:183], v[182:183], s[36:37]
    v_pk_mul_f32 v[188:189], v[188:189], s[36:37]
    v_pk_mul_f32 v[190:191], v[190:191], s[36:37]
    v_cvt_pk_bf16_f32 v92, v180, v181
    v_cvt_pk_bf16_f32 v93, v182, v183
    v_cvt_pk_bf16_f32 v94, v188, v189
    v_cvt_pk_bf16_f32 v95, v190, v191
    v_permlane32_swap_b32 v76, v78
    v_permlane32_swap_b32 v77, v79
    v_permlane32_swap_b32 v92, v94
    v_permlane32_swap_b32 v93, v95
    v_permlane16_swap_b32 v76, v78
    v_permlane16_swap_b32 v77, v79
    v_permlane16_swap_b32 v92, v94
    v_permlane16_swap_b32 v93, v95
    v_pk_mul_f32 v[192:193], v[192:193], s[36:37]
    v_pk_mul_f32 v[194:195], v[194:195], s[36:37]
    v_pk_mul_f32 v[200:201], v[200:201], s[36:37]
    v_pk_mul_f32 v[202:203], v[202:203], s[36:37]
    v_cvt_pk_bf16_f32 v96, v192, v193
    v_cvt_pk_bf16_f32 v97, v194, v195
    v_cvt_pk_bf16_f32 v98, v200, v201
    v_cvt_pk_bf16_f32 v99, v202, v203
    v_pk_mul_f32 v[196:197], v[196:197], s[36:37]
    v_pk_mul_f32 v[198:199], v[198:199], s[36:37]
    v_pk_mul_f32 v[204:205], v[204:205], s[36:37]
    v_pk_mul_f32 v[206:207], v[206:207], s[36:37]
    v_cvt_pk_bf16_f32 v112, v196, v197
    v_cvt_pk_bf16_f32 v113, v198, v199
    v_cvt_pk_bf16_f32 v114, v204, v205
    v_cvt_pk_bf16_f32 v115, v206, v207
    v_permlane32_swap_b32 v96, v98
    v_permlane32_swap_b32 v97, v99
    v_permlane32_swap_b32 v112, v114
    v_permlane32_swap_b32 v113, v115
    v_permlane16_swap_b32 v96, v98
    v_permlane16_swap_b32 v97, v99
    v_permlane16_swap_b32 v112, v114
    v_permlane16_swap_b32 v113, v115
    v_pk_mul_f32 v[208:209], v[208:209], s[36:37]
    v_pk_mul_f32 v[210:211], v[210:211], s[36:37]
    v_pk_mul_f32 v[216:217], v[216:217], s[36:37]
    v_pk_mul_f32 v[218:219], v[218:219], s[36:37]
    v_cvt_pk_bf16_f32 v100, v208, v209
    v_cvt_pk_bf16_f32 v101, v210, v211
    v_cvt_pk_bf16_f32 v102, v216, v217
    v_cvt_pk_bf16_f32 v103, v218, v219
    v_pk_mul_f32 v[212:213], v[212:213], s[36:37]
    v_pk_mul_f32 v[214:215], v[214:215], s[36:37]
    v_pk_mul_f32 v[220:221], v[220:221], s[36:37]
    v_pk_mul_f32 v[222:223], v[222:223], s[36:37]
    v_cvt_pk_bf16_f32 v116, v212, v213
    v_cvt_pk_bf16_f32 v117, v214, v215
    v_cvt_pk_bf16_f32 v118, v220, v221
    v_cvt_pk_bf16_f32 v119, v222, v223
    v_permlane32_swap_b32 v100, v102
    v_permlane32_swap_b32 v101, v103
    v_permlane32_swap_b32 v116, v118
    v_permlane32_swap_b32 v117, v119
    v_permlane16_swap_b32 v100, v102
    v_permlane16_swap_b32 v101, v103
    v_permlane16_swap_b32 v116, v118
    v_permlane16_swap_b32 v117, v119
    v_pk_mul_f32 v[224:225], v[224:225], s[36:37]
    v_pk_mul_f32 v[226:227], v[226:227], s[36:37]
    v_pk_mul_f32 v[232:233], v[232:233], s[36:37]
    v_pk_mul_f32 v[234:235], v[234:235], s[36:37]
    v_cvt_pk_bf16_f32 v104, v224, v225
    v_cvt_pk_bf16_f32 v105, v226, v227
    v_cvt_pk_bf16_f32 v106, v232, v233
    v_cvt_pk_bf16_f32 v107, v234, v235
    v_pk_mul_f32 v[228:229], v[228:229], s[36:37]
    v_pk_mul_f32 v[230:231], v[230:231], s[36:37]
    v_pk_mul_f32 v[236:237], v[236:237], s[36:37]
    v_pk_mul_f32 v[238:239], v[238:239], s[36:37]
    v_cvt_pk_bf16_f32 v120, v228, v229
    v_cvt_pk_bf16_f32 v121, v230, v231
    v_cvt_pk_bf16_f32 v122, v236, v237
    v_cvt_pk_bf16_f32 v123, v238, v239
    v_permlane32_swap_b32 v104, v106
    v_permlane32_swap_b32 v105, v107
    v_permlane32_swap_b32 v120, v122
    v_permlane32_swap_b32 v121, v123
    v_permlane16_swap_b32 v104, v106
    v_permlane16_swap_b32 v105, v107
    v_permlane16_swap_b32 v120, v122
    v_permlane16_swap_b32 v121, v123
    v_pk_mul_f32 v[240:241], v[240:241], s[36:37]
    v_pk_mul_f32 v[242:243], v[242:243], s[36:37]
    v_pk_mul_f32 v[248:249], v[248:249], s[36:37]
    v_pk_mul_f32 v[250:251], v[250:251], s[36:37]
    v_cvt_pk_bf16_f32 v108, v240, v241
    v_cvt_pk_bf16_f32 v109, v242, v243
    v_cvt_pk_bf16_f32 v110, v248, v249
    v_cvt_pk_bf16_f32 v111, v250, v251
    v_pk_mul_f32 v[244:245], v[244:245], s[36:37]
    v_pk_mul_f32 v[246:247], v[246:247], s[36:37]
    v_pk_mul_f32 v[252:253], v[252:253], s[36:37]
    v_pk_mul_f32 v[254:255], v[254:255], s[36:37]
    v_cvt_pk_bf16_f32 v124, v244, v245
    v_cvt_pk_bf16_f32 v125, v246, v247
    v_cvt_pk_bf16_f32 v126, v252, v253
    v_cvt_pk_bf16_f32 v127, v254, v255
    v_permlane32_swap_b32 v108, v110
    v_permlane32_swap_b32 v109, v111
    v_permlane32_swap_b32 v124, v126
    v_permlane32_swap_b32 v125, v127
    v_permlane16_swap_b32 v108, v110
    v_permlane16_swap_b32 v109, v111
    v_permlane16_swap_b32 v124, v126
    v_permlane16_swap_b32 v125, v127
    v_mfma_f32_16x16x32_bf16 v[216:219], a[208:211], v[64:67], 0
    s_waitcnt lgkmcnt(3)
    v_mfma_f32_16x16x32_bf16 v[216:219], a[212:215], v[68:71], v[216:219]
    s_waitcnt lgkmcnt(2)
    v_mfma_f32_16x16x32_bf16 v[216:219], a[216:219], v[72:75], v[216:219]
    s_waitcnt lgkmcnt(1)
    v_mfma_f32_16x16x32_bf16 v[216:219], a[220:223], v[76:79], v[216:219]
    v_mfma_f32_16x16x32_bf16 v[220:223], a[208:211], v[80:83], 0
    v_mfma_f32_16x16x32_bf16 v[220:223], a[212:215], v[84:87], v[220:223]
    v_mfma_f32_16x16x32_bf16 v[220:223], a[216:219], v[88:91], v[220:223]
    v_mfma_f32_16x16x32_bf16 v[220:223], a[220:223], v[92:95], v[220:223]
    v_mfma_f32_16x16x32_bf16 v[224:227], a[208:211], v[96:99], 0
    v_mfma_f32_16x16x32_bf16 v[224:227], a[212:215], v[100:103], v[224:227]
    v_mfma_f32_16x16x32_bf16 v[224:227], a[216:219], v[104:107], v[224:227]
    v_mfma_f32_16x16x32_bf16 v[224:227], a[220:223], v[108:111], v[224:227]
    v_mfma_f32_16x16x32_bf16 v[228:231], a[208:211], v[112:115], 0
    v_mfma_f32_16x16x32_bf16 v[228:231], a[212:215], v[116:119], v[228:231]
    v_mfma_f32_16x16x32_bf16 v[228:231], a[216:219], v[120:123], v[228:231]
    v_mfma_f32_16x16x32_bf16 v[228:231], a[220:223], v[124:127], v[228:231]
    v_max3_f32 v232, v216, v217, v218
    v_max_f32 v232, v232, v219
    v_max3_f32 v233, v220, v221, v222
    v_max_f32 v233, v233, v223
    v_max3_f32 v234, v224, v225, v226
    v_max_f32 v234, v234, v227
    s_nop 1
    v_max3_f32 v235, v228, v229, v230
    v_max_f32 v235, v235, v231
    v_mov_b32 v236, v232
    v_mov_b32 v237, v233
    v_mov_b32 v238, v234
    v_mov_b32 v239, v235
    v_permlane16_swap_b32 v232, v236
    v_permlane16_swap_b32 v233, v237
    v_permlane16_swap_b32 v234, v238
    v_permlane16_swap_b32 v235, v239
    v_max_f32 v232, v232, v236
    v_max_f32 v233, v233, v237
    v_max_f32 v234, v234, v238
    v_max_f32 v235, v235, v239
    v_mov_b32 v236, v232
    v_mov_b32 v237, v233
    v_mov_b32 v238, v234
    v_mov_b32 v239, v235
    v_permlane32_swap_b32 v232, v236
    v_permlane32_swap_b32 v233, v237
    v_permlane32_swap_b32 v234, v238
    v_permlane32_swap_b32 v235, v239
    v_max_f32 v232, v232, v236
    v_max_f32 v233, v233, v237
    v_max_f32 v234, v234, v238
    v_max_f32 v235, v235, v239
    v_sub_f32 v192, 3250585600, v232
    v_sub_f32 v193, 3250585600, v232
    v_sub_f32 v194, 3250585600, v232
    v_sub_f32 v195, 3250585600, v232
    v_sub_f32 v196, 3250585600, v233
    v_sub_f32 v197, 3250585600, v233
    v_sub_f32 v198, 3250585600, v233
    v_sub_f32 v199, 3250585600, v233
    v_sub_f32 v200, 3250585600, v234
    v_sub_f32 v201, 3250585600, v234
    v_sub_f32 v202, 3250585600, v234
    v_sub_f32 v203, 3250585600, v234
    v_sub_f32 v204, 3250585600, v235
    v_sub_f32 v205, 3250585600, v235
    v_sub_f32 v206, 3250585600, v235
    v_sub_f32 v207, 3250585600, v235
Lattn_stage0:
    s_mov_b32 s43, 7
    v_mfma_f32_16x16x32_bf16 v[208:211], a[208:211], v[64:67], v[192:195]
    v_mfma_f32_16x16x32_bf16 v[208:211], a[212:215], v[68:71], v[208:211]
    v_mfma_f32_16x16x32_bf16 v[208:211], a[216:219], v[72:75], v[208:211]
    v_mfma_f32_16x16x32_bf16 v[208:211], a[220:223], v[76:79], v[208:211]
    ds_read_b128 a[228:231], v9 offset:4096
    v_mfma_f32_16x16x32_bf16 v[212:215], a[208:211], v[80:83], v[196:199]
    s_nop 5
    v_exp_f32 v208, v208
    v_mfma_f32_16x16x32_bf16 v[212:215], a[212:215], v[84:87], v[212:215]
    v_exp_f32 v209, v209
    v_mfma_f32_16x16x32_bf16 v[212:215], a[216:219], v[88:91], v[212:215]
    v_exp_f32 v210, v210
    v_mfma_f32_16x16x32_bf16 v[212:215], a[220:223], v[92:95], v[212:215]
    v_exp_f32 v211, v211
    v_cvt_pk_bf16_f32 v128, v208, v209
    ds_read_b128 a[232:235], v10 offset:4096
    v_cvt_pk_bf16_f32 v129, v210, v211
    v_mfma_f32_16x16x32_bf16 v[208:211], a[208:211], v[96:99], v[200:203]
    s_nop 2
    v_exp_f32 v212, v212
    v_mfma_f32_16x16x32_bf16 v[208:211], a[212:215], v[100:103], v[208:211]
    v_exp_f32 v213, v213
    v_mfma_f32_16x16x32_bf16 v[208:211], a[216:219], v[104:107], v[208:211]
    v_exp_f32 v214, v214
    v_mfma_f32_16x16x32_bf16 v[208:211], a[220:223], v[108:111], v[208:211]
    v_exp_f32 v215, v215
    v_cvt_pk_bf16_f32 v136, v212, v213
    ds_read_b128 a[236:239], v11 offset:4096
    v_cvt_pk_bf16_f32 v137, v214, v215
    s_mul_i32 s49, s5, 18432
    s_add_u32 s49, s49, s45
    v_lshlrev_b32 v220, 6, v0
    v_mfma_f32_16x16x32_bf16 v[212:215], a[208:211], v[112:115], v[204:207]
    v_exp_f32 v208, v208
    v_mfma_f32_16x16x32_bf16 v[212:215], a[212:215], v[116:119], v[212:215]
    v_exp_f32 v209, v209
    v_mfma_f32_16x16x32_bf16 v[212:215], a[216:219], v[120:123], v[212:215]
    v_exp_f32 v210, v210
    v_mfma_f32_16x16x32_bf16 v[212:215], a[220:223], v[124:127], v[212:215]
    s_waitcnt lgkmcnt(3)
    v_exp_f32 v211, v211
    v_cvt_pk_bf16_f32 v144, v208, v209
    ds_read_b128 a[208:211], v8 offset:8192
    v_cvt_pk_bf16_f32 v145, v210, v211
    buffer_load_dword v221, v220, s[20:23], s49 offen
    v_mfma_f32_16x16x32_bf16 v[208:211], a[224:227], v[64:67], v[192:195]
    s_waitcnt lgkmcnt(3)
    v_exp_f32 v212, v212
    v_mfma_f32_16x16x32_bf16 v[208:211], a[228:231], v[68:71], v[208:211]
    s_waitcnt lgkmcnt(2)
    v_exp_f32 v213, v213
    v_mfma_f32_16x16x32_bf16 v[208:211], a[232:235], v[72:75], v[208:211]
    s_waitcnt lgkmcnt(1)
    v_exp_f32 v214, v214
    v_mfma_f32_16x16x32_bf16 v[208:211], a[236:239], v[76:79], v[208:211]
    v_exp_f32 v215, v215
    v_cvt_pk_bf16_f32 v152, v212, v213
    ds_read_b128 a[212:215], v9 offset:8192
    v_cvt_pk_bf16_f32 v153, v214, v215
    s_add_u32 s49, s49, 16384
    v_mfma_f32_16x16x32_bf16 v[212:215], a[224:227], v[80:83], v[196:199]
    s_nop 1
    v_exp_f32 v208, v208
    v_mfma_f32_16x16x32_bf16 v[212:215], a[228:231], v[84:87], v[212:215]
    v_exp_f32 v209, v209
    v_mfma_f32_16x16x32_bf16 v[212:215], a[232:235], v[88:91], v[212:215]
    v_exp_f32 v210, v210
    v_mfma_f32_16x16x32_bf16 v[212:215], a[236:239], v[92:95], v[212:215]
    v_exp_f32 v211, v211
    v_cvt_pk_bf16_f32 v130, v208, v209
    ds_read_b128 a[216:219], v10 offset:8192
    v_cvt_pk_bf16_f32 v131, v210, v211
    buffer_load_dword v222, v220, s[20:23], s49 offen
    v_mfma_f32_16x16x32_bf16 v[208:211], a[224:227], v[96:99], v[200:203]
    s_nop 1
    v_exp_f32 v212, v212
    v_mfma_f32_16x16x32_bf16 v[208:211], a[228:231], v[100:103], v[208:211]
    v_exp_f32 v213, v213
    v_mfma_f32_16x16x32_bf16 v[208:211], a[232:235], v[104:107], v[208:211]
    v_exp_f32 v214, v214
    v_mfma_f32_16x16x32_bf16 v[208:211], a[236:239], v[108:111], v[208:211]
    v_exp_f32 v215, v215
    v_cvt_pk_bf16_f32 v138, v212, v213
    ds_read_b128 a[220:223], v11 offset:8192
    v_cvt_pk_bf16_f32 v139, v214, v215
    s_mov_b32 s39, 221184
    s_mov_b32 s38, 27648
    v_mfma_f32_16x16x32_bf16 v[212:215], a[224:227], v[112:115], v[204:207]
    s_nop 0
    v_exp_f32 v208, v208
    v_mfma_f32_16x16x32_bf16 v[212:215], a[228:231], v[116:119], v[212:215]
    v_exp_f32 v209, v209
    v_mfma_f32_16x16x32_bf16 v[212:215], a[232:235], v[120:123], v[212:215]
    v_exp_f32 v210, v210
    v_mfma_f32_16x16x32_bf16 v[212:215], a[236:239], v[124:127], v[212:215]
    s_waitcnt lgkmcnt(3)
    v_exp_f32 v211, v211
    v_cvt_pk_bf16_f32 v146, v208, v209
    ds_read_b128 a[224:227], v8 offset:12288
    v_cvt_pk_bf16_f32 v147, v210, v211
    v_mfma_f32_16x16x32_bf16 v[208:211], a[208:211], v[64:67], v[192:195]
    s_waitcnt lgkmcnt(3)
    s_nop 0
    v_exp_f32 v212, v212
    v_mfma_f32_16x16x32_bf16 v[208:211], a[212:215], v[68:71], v[208:211]
    s_waitcnt lgkmcnt(2)
    v_exp_f32 v213, v213
    v_mfma_f32_16x16x32_bf16 v[208:211], a[216:219], v[72:75], v[208:211]
    s_waitcnt lgkmcnt(1)
    v_exp_f32 v214, v214
    v_mfma_f32_16x16x32_bf16 v[208:211], a[220:223], v[76:79], v[208:211]
    v_exp_f32 v215, v215
    v_cvt_pk_bf16_f32 v154, v212, v213
    ds_read_b128 a[228:231], v9 offset:12288
    v_cvt_pk_bf16_f32 v155, v214, v215
    v_mfma_f32_16x16x32_bf16 v[212:215], a[208:211], v[80:83], v[196:199]
    s_nop 2
    v_exp_f32 v208, v208
    v_mfma_f32_16x16x32_bf16 v[212:215], a[212:215], v[84:87], v[212:215]
    v_exp_f32 v209, v209
    v_mfma_f32_16x16x32_bf16 v[212:215], a[216:219], v[88:91], v[212:215]
    v_exp_f32 v210, v210
    v_mfma_f32_16x16x32_bf16 v[212:215], a[220:223], v[92:95], v[212:215]
    v_exp_f32 v211, v211
    v_cvt_pk_bf16_f32 v132, v208, v209
    ds_read_b128 a[232:235], v10 offset:12288
    v_cvt_pk_bf16_f32 v133, v210, v211
    v_mfma_f32_16x16x32_bf16 v[208:211], a[208:211], v[96:99], v[200:203]
    s_nop 2
    v_exp_f32 v212, v212
    v_mfma_f32_16x16x32_bf16 v[208:211], a[212:215], v[100:103], v[208:211]
    v_exp_f32 v213, v213
    v_mfma_f32_16x16x32_bf16 v[208:211], a[216:219], v[104:107], v[208:211]
    v_exp_f32 v214, v214
    v_mfma_f32_16x16x32_bf16 v[208:211], a[220:223], v[108:111], v[208:211]
    v_exp_f32 v215, v215
    v_cvt_pk_bf16_f32 v140, v212, v213
    ds_read_b128 a[236:239], v11 offset:12288
    v_cvt_pk_bf16_f32 v141, v214, v215
    s_waitcnt vmcnt(6)
    s_barrier
    v_mfma_f32_16x16x32_bf16 v[212:215], a[208:211], v[112:115], v[204:207]
    s_nop 0
    v_exp_f32 v208, v208
    v_mfma_f32_16x16x32_bf16 v[212:215], a[212:215], v[116:119], v[212:215]
    s_add_u32 m0, s42, 49152
    v_exp_f32 v209, v209
    v_mfma_f32_16x16x32_bf16 v[212:215], a[216:219], v[120:123], v[212:215]
    v_exp_f32 v210, v210
    v_mfma_f32_16x16x32_bf16 v[212:215], a[220:223], v[124:127], v[212:215]
    s_waitcnt lgkmcnt(3)
    v_exp_f32 v211, v211
    v_cvt_pk_bf16_f32 v148, v208, v209
    ds_read_b128 a[208:211], v8 offset:16384
    v_cvt_pk_bf16_f32 v149, v210, v211
    buffer_load_dwordx4 v36, s[8:11], s40 offen lds
    v_mfma_f32_16x16x32_bf16 v[208:211], a[224:227], v[64:67], v[192:195]
    s_waitcnt lgkmcnt(3)
    v_exp_f32 v212, v212
    v_mfma_f32_16x16x32_bf16 v[208:211], a[228:231], v[68:71], v[208:211]
    s_waitcnt lgkmcnt(2)
    v_exp_f32 v213, v213
    v_mfma_f32_16x16x32_bf16 v[208:211], a[232:235], v[72:75], v[208:211]
    s_waitcnt lgkmcnt(1)
    v_exp_f32 v214, v214
    v_mfma_f32_16x16x32_bf16 v[208:211], a[236:239], v[76:79], v[208:211]
    v_exp_f32 v215, v215
    v_cvt_pk_bf16_f32 v156, v212, v213
    ds_read_b128 a[212:215], v9 offset:16384
    v_cvt_pk_bf16_f32 v157, v214, v215
    v_mfma_f32_16x16x32_bf16 v[212:215], a[224:227], v[80:83], v[196:199]
    s_nop 2
    v_exp_f32 v208, v208
    v_mfma_f32_16x16x32_bf16 v[212:215], a[228:231], v[84:87], v[212:215]
    v_exp_f32 v209, v209
    v_mfma_f32_16x16x32_bf16 v[212:215], a[232:235], v[88:91], v[212:215]
    v_exp_f32 v210, v210
    v_mfma_f32_16x16x32_bf16 v[212:215], a[236:239], v[92:95], v[212:215]
    v_exp_f32 v211, v211
    ds_read_b64_tr_b16 a[160:161], v20 offset:0
    v_cvt_pk_bf16_f32 v134, v208, v209
    ds_read_b64_tr_b16 a[162:163], v20 offset:4096
    ds_read_b128 a[216:219], v10 offset:16384
    v_cvt_pk_bf16_f32 v135, v210, v211
    buffer_load_dwordx4 v37, s[8:11], s40 offen offset:1024 lds
    v_mfma_f32_16x16x32_bf16 v[208:211], a[224:227], v[96:99], v[200:203]
    v_exp_f32 v212, v212
    v_mfma_f32_16x16x32_bf16 v[208:211], a[228:231], v[100:103], v[208:211]
    v_exp_f32 v213, v213
    v_mfma_f32_16x16x32_bf16 v[208:211], a[232:235], v[104:107], v[208:211]
    v_exp_f32 v214, v214
    v_mfma_f32_16x16x32_bf16 v[208:211], a[236:239], v[108:111], v[208:211]
    v_exp_f32 v215, v215
    ds_read_b64_tr_b16 a[164:165], v20 offset:8192
    v_cvt_pk_bf16_f32 v142, v212, v213
    ds_read_b64_tr_b16 a[166:167], v20 offset:12288
    ds_read_b128 a[220:223], v11 offset:16384
    v_cvt_pk_bf16_f32 v143, v214, v215
    v_mfma_f32_16x16x32_bf16 v[212:215], a[224:227], v[112:115], v[204:207]
    s_nop 0
    v_exp_f32 v208, v208
    v_mfma_f32_16x16x32_bf16 v[212:215], a[228:231], v[116:119], v[212:215]
    v_exp_f32 v209, v209
    v_mfma_f32_16x16x32_bf16 v[212:215], a[232:235], v[120:123], v[212:215]
    v_exp_f32 v210, v210
    v_mfma_f32_16x16x32_bf16 v[212:215], a[236:239], v[124:127], v[212:215]
    v_exp_f32 v211, v211
    ds_read_b64_tr_b16 a[168:169], v21 offset:0
    v_cvt_pk_bf16_f32 v150, v208, v209
    ds_read_b64_tr_b16 a[170:171], v21 offset:4096
    ds_read_b128 a[224:227], v8 offset:20480
    v_cvt_pk_bf16_f32 v151, v210, v211
    s_waitcnt lgkmcnt(3)
    buffer_load_dwordx4 v38, s[8:11], s40 offen offset:2048 lds
Lattn_loop:
    v_mfma_f32_16x16x32_bf16 v[208:211], a[208:211], v[64:67], v[192:195]
    v_exp_f32 v212, v212
    v_mfma_f32_16x16x32_bf16 v[208:211], a[212:215], v[68:71], v[208:211]
    v_exp_f32 v213, v213
    v_mfma_f32_16x16x32_bf16 v[208:211], a[216:219], v[72:75], v[208:211]
    v_exp_f32 v214, v214
    v_mfma_f32_16x16x32_bf16 v[208:211], a[220:223], v[76:79], v[208:211]
    v_exp_f32 v215, v215
    v_mfma_f32_16x16x32_bf16 a[0:3], a[160:163], v[128:131], a[0:3]
    ds_read_b64_tr_b16 a[172:173], v21 offset:8192
    v_cvt_pk_bf16_f32 v158, v212, v213
    v_mfma_f32_16x16x32_bf16 a[0:3], a[164:167], v[132:135], a[0:3]
    ds_read_b64_tr_b16 a[174:175], v21 offset:12288
    v_mfma_f32_16x16x32_bf16 a[4:7], a[160:163], v[136:139], a[4:7]
    ds_read_b128 a[228:231], v9 offset:20480
    v_cvt_pk_bf16_f32 v159, v214, v215
    v_mfma_f32_16x16x32_bf16 a[4:7], a[164:167], v[140:143], a[4:7]
    v_mfma_f32_16x16x32_bf16 v[212:215], a[208:211], v[80:83], v[196:199]
    v_exp_f32 v208, v208
    v_mfma_f32_16x16x32_bf16 v[212:215], a[212:215], v[84:87], v[212:215]
    v_exp_f32 v209, v209
    v_mfma_f32_16x16x32_bf16 v[212:215], a[216:219], v[88:91], v[212:215]
    v_exp_f32 v210, v210
    v_mfma_f32_16x16x32_bf16 v[212:215], a[220:223], v[92:95], v[212:215]
    v_exp_f32 v211, v211
    v_mfma_f32_16x16x32_bf16 a[8:11], a[160:163], v[144:147], a[8:11]
    ds_read_b64_tr_b16 a[176:177], v22 offset:0
    v_cvt_pk_bf16_f32 v160, v208, v209
    v_mfma_f32_16x16x32_bf16 a[8:11], a[164:167], v[148:151], a[8:11]
    ds_read_b64_tr_b16 a[178:179], v22 offset:4096
    v_mfma_f32_16x16x32_bf16 a[12:15], a[160:163], v[152:155], a[12:15]
    ds_read_b128 a[232:235], v10 offset:20480
    v_cvt_pk_bf16_f32 v161, v210, v211
    v_mfma_f32_16x16x32_bf16 a[12:15], a[164:167], v[156:159], a[12:15]
    s_waitcnt lgkmcnt(3)
    buffer_load_dwordx4 v39, s[8:11], s40 offen offset:3072 lds
    v_mfma_f32_16x16x32_bf16 v[208:211], a[208:211], v[96:99], v[200:203]
    v_exp_f32 v212, v212
    v_mfma_f32_16x16x32_bf16 v[208:211], a[212:215], v[100:103], v[208:211]
    s_add_u32 s40, s40, 16384
    v_exp_f32 v213, v213
    v_mfma_f32_16x16x32_bf16 v[208:211], a[216:219], v[104:107], v[208:211]
    v_exp_f32 v214, v214
    v_mfma_f32_16x16x32_bf16 v[208:211], a[220:223], v[108:111], v[208:211]
    v_exp_f32 v215, v215
    v_mfma_f32_16x16x32_bf16 a[16:19], a[168:171], v[128:131], a[16:19]
    ds_read_b64_tr_b16 a[180:181], v22 offset:8192
    v_cvt_pk_bf16_f32 v168, v212, v213
    v_mfma_f32_16x16x32_bf16 a[16:19], a[172:175], v[132:135], a[16:19]
    ds_read_b64_tr_b16 a[182:183], v22 offset:12288
    v_mfma_f32_16x16x32_bf16 a[20:23], a[168:171], v[136:139], a[20:23]
    ds_read_b128 a[236:239], v11 offset:20480
    v_cvt_pk_bf16_f32 v169, v214, v215
    v_mfma_f32_16x16x32_bf16 a[20:23], a[172:175], v[140:143], a[20:23]
    v_smfmac_f32_16x16x64_bf16 a[192:195], v[52:55], v[128:135], v50
    v_mfma_f32_16x16x32_bf16 v[212:215], a[208:211], v[112:115], v[204:207]
    v_exp_f32 v208, v208
    v_mfma_f32_16x16x32_bf16 v[212:215], a[212:215], v[116:119], v[212:215]
    s_add_u32 m0, s42, 98304
    v_exp_f32 v209, v209
    v_mfma_f32_16x16x32_bf16 v[212:215], a[216:219], v[120:123], v[212:215]
    v_exp_f32 v210, v210
    v_mfma_f32_16x16x32_bf16 v[212:215], a[220:223], v[124:127], v[212:215]
    v_exp_f32 v211, v211
    v_mfma_f32_16x16x32_bf16 a[24:27], a[168:171], v[144:147], a[24:27]
    ds_read_b64_tr_b16 a[184:185], v23 offset:0
    v_cvt_pk_bf16_f32 v176, v208, v209
    v_mfma_f32_16x16x32_bf16 a[24:27], a[172:175], v[148:151], a[24:27]
    ds_read_b64_tr_b16 a[186:187], v23 offset:4096
    v_mfma_f32_16x16x32_bf16 a[28:31], a[168:171], v[152:155], a[28:31]
    ds_read_b128 a[208:211], v8 offset:24576
    v_cvt_pk_bf16_f32 v177, v210, v211
    v_mfma_f32_16x16x32_bf16 a[28:31], a[172:175], v[156:159], a[28:31]
    s_waitcnt lgkmcnt(3)
    buffer_load_dwordx4 v40, s[12:15], s41 offen lds
    v_mfma_f32_16x16x32_bf16 v[208:211], a[224:227], v[64:67], v[192:195]
    v_exp_f32 v212, v212
    v_mfma_f32_16x16x32_bf16 v[208:211], a[228:231], v[68:71], v[208:211]
    v_exp_f32 v213, v213
    v_mfma_f32_16x16x32_bf16 v[208:211], a[232:235], v[72:75], v[208:211]
    v_exp_f32 v214, v214
    v_mfma_f32_16x16x32_bf16 v[208:211], a[236:239], v[76:79], v[208:211]
    v_exp_f32 v215, v215
    v_mfma_f32_16x16x32_bf16 a[32:35], a[176:179], v[128:131], a[32:35]
    ds_read_b64_tr_b16 a[188:189], v23 offset:8192
    v_cvt_pk_bf16_f32 v184, v212, v213
    v_mfma_f32_16x16x32_bf16 a[32:35], a[180:183], v[132:135], a[32:35]
    ds_read_b64_tr_b16 a[190:191], v23 offset:12288
    v_mfma_f32_16x16x32_bf16 a[36:39], a[176:179], v[136:139], a[36:39]
    ds_read_b128 a[212:215], v9 offset:24576
    v_cvt_pk_bf16_f32 v185, v214, v215
    v_mfma_f32_16x16x32_bf16 a[36:39], a[180:183], v[140:143], a[36:39]
    v_smfmac_f32_16x16x64_bf16 a[196:199], v[52:55], v[136:143], v50
    v_mfma_f32_16x16x32_bf16 v[212:215], a[224:227], v[80:83], v[196:199]
    v_exp_f32 v208, v208
    v_mfma_f32_16x16x32_bf16 v[212:215], a[228:231], v[84:87], v[212:215]
    v_exp_f32 v209, v209
    v_mfma_f32_16x16x32_bf16 v[212:215], a[232:235], v[88:91], v[212:215]
    v_exp_f32 v210, v210
    v_mfma_f32_16x16x32_bf16 v[212:215], a[236:239], v[92:95], v[212:215]
    v_exp_f32 v211, v211
    v_mfma_f32_16x16x32_bf16 a[40:43], a[176:179], v[144:147], a[40:43]
    ds_read_b64_tr_b16 a[160:161], v24 offset:0
    v_cvt_pk_bf16_f32 v162, v208, v209
    v_mfma_f32_16x16x32_bf16 a[40:43], a[180:183], v[148:151], a[40:43]
    ds_read_b64_tr_b16 a[162:163], v24 offset:4096
    v_mfma_f32_16x16x32_bf16 a[44:47], a[176:179], v[152:155], a[44:47]
    ds_read_b128 a[216:219], v10 offset:24576
    v_cvt_pk_bf16_f32 v163, v210, v211
    v_mfma_f32_16x16x32_bf16 a[44:47], a[180:183], v[156:159], a[44:47]
    s_waitcnt lgkmcnt(3)
    buffer_load_dwordx4 v41, s[12:15], s41 offen offset:1024 lds
    v_mfma_f32_16x16x32_bf16 v[208:211], a[224:227], v[96:99], v[200:203]
    v_exp_f32 v212, v212
    v_mfma_f32_16x16x32_bf16 v[208:211], a[228:231], v[100:103], v[208:211]
    v_exp_f32 v213, v213
    v_mfma_f32_16x16x32_bf16 v[208:211], a[232:235], v[104:107], v[208:211]
    v_exp_f32 v214, v214
    v_mfma_f32_16x16x32_bf16 v[208:211], a[236:239], v[108:111], v[208:211]
    v_exp_f32 v215, v215
    v_mfma_f32_16x16x32_bf16 a[48:51], a[184:187], v[128:131], a[48:51]
    ds_read_b64_tr_b16 a[164:165], v24 offset:8192
    v_cvt_pk_bf16_f32 v170, v212, v213
    v_mfma_f32_16x16x32_bf16 a[48:51], a[188:191], v[132:135], a[48:51]
    ds_read_b64_tr_b16 a[166:167], v24 offset:12288
    v_mfma_f32_16x16x32_bf16 a[52:55], a[184:187], v[136:139], a[52:55]
    ds_read_b128 a[220:223], v11 offset:24576
    v_cvt_pk_bf16_f32 v171, v214, v215
    v_mfma_f32_16x16x32_bf16 a[52:55], a[188:191], v[140:143], a[52:55]
    v_smfmac_f32_16x16x64_bf16 a[200:203], v[52:55], v[144:151], v50
    v_mfma_f32_16x16x32_bf16 v[212:215], a[224:227], v[112:115], v[204:207]
    v_exp_f32 v208, v208
    v_mfma_f32_16x16x32_bf16 v[212:215], a[228:231], v[116:119], v[212:215]
    v_exp_f32 v209, v209
    v_mfma_f32_16x16x32_bf16 v[212:215], a[232:235], v[120:123], v[212:215]
    v_exp_f32 v210, v210
    v_mfma_f32_16x16x32_bf16 v[212:215], a[236:239], v[124:127], v[212:215]
    v_exp_f32 v211, v211
    v_mfma_f32_16x16x32_bf16 a[56:59], a[184:187], v[144:147], a[56:59]
    ds_read_b64_tr_b16 a[168:169], v25 offset:0
    v_cvt_pk_bf16_f32 v178, v208, v209
    v_mfma_f32_16x16x32_bf16 a[56:59], a[188:191], v[148:151], a[56:59]
    ds_read_b64_tr_b16 a[170:171], v25 offset:4096
    v_mfma_f32_16x16x32_bf16 a[60:63], a[184:187], v[152:155], a[60:63]
    ds_read_b128 a[224:227], v8 offset:28672
    v_cvt_pk_bf16_f32 v179, v210, v211
    v_mfma_f32_16x16x32_bf16 a[60:63], a[188:191], v[156:159], a[60:63]
    s_waitcnt lgkmcnt(3)
    buffer_load_dwordx4 v40, s[12:15], s41 offen offset:2048 lds
    v_mfma_f32_16x16x32_bf16 v[208:211], a[208:211], v[64:67], v[192:195]
    v_exp_f32 v212, v212
    v_mfma_f32_16x16x32_bf16 v[208:211], a[212:215], v[68:71], v[208:211]
    v_exp_f32 v213, v213
    v_mfma_f32_16x16x32_bf16 v[208:211], a[216:219], v[72:75], v[208:211]
    v_exp_f32 v214, v214
    v_mfma_f32_16x16x32_bf16 v[208:211], a[220:223], v[76:79], v[208:211]
    v_exp_f32 v215, v215
    v_mfma_f32_16x16x32_bf16 a[64:67], a[160:163], v[128:131], a[64:67]
    ds_read_b64_tr_b16 a[172:173], v25 offset:8192
    v_cvt_pk_bf16_f32 v186, v212, v213
    v_mfma_f32_16x16x32_bf16 a[64:67], a[164:167], v[132:135], a[64:67]
    ds_read_b64_tr_b16 a[174:175], v25 offset:12288
    v_mfma_f32_16x16x32_bf16 a[68:71], a[160:163], v[136:139], a[68:71]
    ds_read_b128 a[228:231], v9 offset:28672
    v_cvt_pk_bf16_f32 v187, v214, v215
    v_mfma_f32_16x16x32_bf16 a[68:71], a[164:167], v[140:143], a[68:71]
    v_smfmac_f32_16x16x64_bf16 a[204:207], v[52:55], v[152:159], v50
    v_mfma_f32_16x16x32_bf16 v[212:215], a[208:211], v[80:83], v[196:199]
    v_exp_f32 v208, v208
    v_mfma_f32_16x16x32_bf16 v[212:215], a[212:215], v[84:87], v[212:215]
    v_exp_f32 v209, v209
    v_mfma_f32_16x16x32_bf16 v[212:215], a[216:219], v[88:91], v[212:215]
    v_exp_f32 v210, v210
    v_mfma_f32_16x16x32_bf16 v[212:215], a[220:223], v[92:95], v[212:215]
    v_exp_f32 v211, v211
    v_mfma_f32_16x16x32_bf16 a[72:75], a[160:163], v[144:147], a[72:75]
    ds_read_b64_tr_b16 a[176:177], v26 offset:0
    v_cvt_pk_bf16_f32 v164, v208, v209
    v_mfma_f32_16x16x32_bf16 a[72:75], a[164:167], v[148:151], a[72:75]
    ds_read_b64_tr_b16 a[178:179], v26 offset:4096
    v_mfma_f32_16x16x32_bf16 a[76:79], a[160:163], v[152:155], a[76:79]
    ds_read_b128 a[232:235], v10 offset:28672
    v_cvt_pk_bf16_f32 v165, v210, v211
    v_mfma_f32_16x16x32_bf16 a[76:79], a[164:167], v[156:159], a[76:79]
    s_waitcnt lgkmcnt(3)
    buffer_load_dwordx4 v41, s[12:15], s41 offen offset:3072 lds
    v_mfma_f32_16x16x32_bf16 v[208:211], a[208:211], v[96:99], v[200:203]
    v_exp_f32 v212, v212
    v_mfma_f32_16x16x32_bf16 v[208:211], a[212:215], v[100:103], v[208:211]
    s_add_u32 s41, s41, 16384
    v_exp_f32 v213, v213
    v_mfma_f32_16x16x32_bf16 v[208:211], a[216:219], v[104:107], v[208:211]
    v_exp_f32 v214, v214
    v_mfma_f32_16x16x32_bf16 v[208:211], a[220:223], v[108:111], v[208:211]
    v_exp_f32 v215, v215
    v_mfma_f32_16x16x32_bf16 a[80:83], a[168:171], v[128:131], a[80:83]
    ds_read_b64_tr_b16 a[180:181], v26 offset:8192
    v_cvt_pk_bf16_f32 v172, v212, v213
    v_mfma_f32_16x16x32_bf16 a[80:83], a[172:175], v[132:135], a[80:83]
    ds_read_b64_tr_b16 a[182:183], v26 offset:12288
    v_mfma_f32_16x16x32_bf16 a[84:87], a[168:171], v[136:139], a[84:87]
    ds_read_b128 a[236:239], v11 offset:28672
    v_cvt_pk_bf16_f32 v173, v214, v215
    v_mfma_f32_16x16x32_bf16 a[84:87], a[172:175], v[140:143], a[84:87]
    s_waitcnt vmcnt(8)
    s_barrier
    v_mfma_f32_16x16x32_bf16 v[212:215], a[208:211], v[112:115], v[204:207]
    v_exp_f32 v208, v208
    v_mfma_f32_16x16x32_bf16 v[212:215], a[212:215], v[116:119], v[212:215]
    s_add_u32 m0, s42, 0
    v_exp_f32 v209, v209
    v_mfma_f32_16x16x32_bf16 v[212:215], a[216:219], v[120:123], v[212:215]
    v_exp_f32 v210, v210
    v_mfma_f32_16x16x32_bf16 v[212:215], a[220:223], v[124:127], v[212:215]
    v_exp_f32 v211, v211
    v_mfma_f32_16x16x32_bf16 a[88:91], a[168:171], v[144:147], a[88:91]
    ds_read_b64_tr_b16 a[184:185], v27 offset:0
    v_cvt_pk_bf16_f32 v180, v208, v209
    v_mfma_f32_16x16x32_bf16 a[88:91], a[172:175], v[148:151], a[88:91]
    ds_read_b64_tr_b16 a[186:187], v27 offset:4096
    v_mfma_f32_16x16x32_bf16 a[92:95], a[168:171], v[152:155], a[92:95]
    ds_read_b128 a[208:211], v8 offset:32768
    v_cvt_pk_bf16_f32 v181, v210, v211
    v_mfma_f32_16x16x32_bf16 a[92:95], a[172:175], v[156:159], a[92:95]
    s_waitcnt lgkmcnt(3)
    buffer_load_dwordx4 v36, s[8:11], s40 offen lds
    v_mfma_f32_16x16x32_bf16 v[208:211], a[224:227], v[64:67], v[192:195]
    v_exp_f32 v212, v212
    v_mfma_f32_16x16x32_bf16 v[208:211], a[228:231], v[68:71], v[208:211]
    v_exp_f32 v213, v213
    v_mfma_f32_16x16x32_bf16 v[208:211], a[232:235], v[72:75], v[208:211]
    v_exp_f32 v214, v214
    v_mfma_f32_16x16x32_bf16 v[208:211], a[236:239], v[76:79], v[208:211]
    v_exp_f32 v215, v215
    v_mfma_f32_16x16x32_bf16 a[96:99], a[176:179], v[128:131], a[96:99]
    ds_read_b64_tr_b16 a[188:189], v27 offset:8192
    v_cvt_pk_bf16_f32 v188, v212, v213
    v_mfma_f32_16x16x32_bf16 a[96:99], a[180:183], v[132:135], a[96:99]
    ds_read_b64_tr_b16 a[190:191], v27 offset:12288
    v_mfma_f32_16x16x32_bf16 a[100:103], a[176:179], v[136:139], a[100:103]
    ds_read_b128 a[212:215], v9 offset:32768
    v_cvt_pk_bf16_f32 v189, v214, v215
    v_mfma_f32_16x16x32_bf16 a[100:103], a[180:183], v[140:143], a[100:103]
    buffer_load_dword v217, v57, s[32:35], s39 offen
    v_mfma_f32_16x16x32_bf16 v[212:215], a[224:227], v[80:83], v[196:199]
    v_exp_f32 v208, v208
    v_mfma_f32_16x16x32_bf16 v[212:215], a[228:231], v[84:87], v[212:215]
    v_exp_f32 v209, v209
    v_mfma_f32_16x16x32_bf16 v[212:215], a[232:235], v[88:91], v[212:215]
    v_exp_f32 v210, v210
    v_mfma_f32_16x16x32_bf16 v[212:215], a[236:239], v[92:95], v[212:215]
    v_exp_f32 v211, v211
    v_mfma_f32_16x16x32_bf16 a[104:107], a[176:179], v[144:147], a[104:107]
    ds_read_b64_tr_b16 a[160:161], v20 offset:16384
    v_cvt_pk_bf16_f32 v166, v208, v209
    v_mfma_f32_16x16x32_bf16 a[104:107], a[180:183], v[148:151], a[104:107]
    ds_read_b64_tr_b16 a[162:163], v20 offset:20480
    v_mfma_f32_16x16x32_bf16 a[108:111], a[176:179], v[152:155], a[108:111]
    ds_read_b128 a[216:219], v10 offset:32768
    v_cvt_pk_bf16_f32 v167, v210, v211
    v_mfma_f32_16x16x32_bf16 a[108:111], a[180:183], v[156:159], a[108:111]
    s_waitcnt lgkmcnt(3)
    buffer_load_dwordx4 v37, s[8:11], s40 offen offset:1024 lds
    v_mfma_f32_16x16x32_bf16 v[208:211], a[224:227], v[96:99], v[200:203]
    v_exp_f32 v212, v212
    v_mfma_f32_16x16x32_bf16 v[208:211], a[228:231], v[100:103], v[208:211]
    v_exp_f32 v213, v213
    v_mfma_f32_16x16x32_bf16 v[208:211], a[232:235], v[104:107], v[208:211]
    v_exp_f32 v214, v214
    v_mfma_f32_16x16x32_bf16 v[208:211], a[236:239], v[108:111], v[208:211]
    v_exp_f32 v215, v215
    v_mfma_f32_16x16x32_bf16 a[112:115], a[184:187], v[128:131], a[112:115]
    ds_read_b64_tr_b16 a[164:165], v20 offset:24576
    v_cvt_pk_bf16_f32 v174, v212, v213
    v_mfma_f32_16x16x32_bf16 a[112:115], a[188:191], v[132:135], a[112:115]
    ds_read_b64_tr_b16 a[166:167], v20 offset:28672
    v_mfma_f32_16x16x32_bf16 a[116:119], a[184:187], v[136:139], a[116:119]
    ds_read_b128 a[220:223], v11 offset:32768
    v_cvt_pk_bf16_f32 v175, v214, v215
    v_mfma_f32_16x16x32_bf16 a[116:119], a[188:191], v[140:143], a[116:119]
    v_mfma_f32_16x16x32_bf16 v[212:215], a[224:227], v[112:115], v[204:207]
    v_exp_f32 v208, v208
    v_mfma_f32_16x16x32_bf16 v[212:215], a[228:231], v[116:119], v[212:215]
    v_exp_f32 v209, v209
    v_mfma_f32_16x16x32_bf16 v[212:215], a[232:235], v[120:123], v[212:215]
    v_exp_f32 v210, v210
    v_mfma_f32_16x16x32_bf16 v[212:215], a[236:239], v[124:127], v[212:215]
    v_exp_f32 v211, v211
    v_mfma_f32_16x16x32_bf16 a[120:123], a[184:187], v[144:147], a[120:123]
    ds_read_b64_tr_b16 a[168:169], v21 offset:16384
    v_cvt_pk_bf16_f32 v182, v208, v209
    v_mfma_f32_16x16x32_bf16 a[120:123], a[188:191], v[148:151], a[120:123]
    ds_read_b64_tr_b16 a[170:171], v21 offset:20480
    v_mfma_f32_16x16x32_bf16 a[124:127], a[184:187], v[152:155], a[124:127]
    ds_read_b128 a[224:227], v8 offset:36864
    v_cvt_pk_bf16_f32 v183, v210, v211
    v_mfma_f32_16x16x32_bf16 a[124:127], a[188:191], v[156:159], a[124:127]
    s_waitcnt lgkmcnt(3)
    buffer_load_dwordx4 v38, s[8:11], s40 offen offset:2048 lds
    v_mfma_f32_16x16x32_bf16 v[208:211], a[208:211], v[64:67], v[192:195]
    v_exp_f32 v212, v212
    v_mfma_f32_16x16x32_bf16 v[208:211], a[212:215], v[68:71], v[208:211]
    v_exp_f32 v213, v213
    v_mfma_f32_16x16x32_bf16 v[208:211], a[216:219], v[72:75], v[208:211]
    v_exp_f32 v214, v214
    v_mfma_f32_16x16x32_bf16 v[208:211], a[220:223], v[76:79], v[208:211]
    v_exp_f32 v215, v215
    v_mfma_f32_16x16x32_bf16 a[0:3], a[160:163], v[160:163], a[0:3]
    ds_read_b64_tr_b16 a[172:173], v21 offset:24576
    v_cvt_pk_bf16_f32 v190, v212, v213
    v_mfma_f32_16x16x32_bf16 a[0:3], a[164:167], v[164:167], a[0:3]
    ds_read_b64_tr_b16 a[174:175], v21 offset:28672
    v_mfma_f32_16x16x32_bf16 a[4:7], a[160:163], v[168:171], a[4:7]
    ds_read_b128 a[228:231], v9 offset:36864
    v_cvt_pk_bf16_f32 v191, v214, v215
    v_mfma_f32_16x16x32_bf16 a[4:7], a[164:167], v[172:175], a[4:7]
    v_mfma_f32_16x16x32_bf16 v[212:215], a[208:211], v[80:83], v[196:199]
    v_exp_f32 v208, v208
    v_mfma_f32_16x16x32_bf16 v[212:215], a[212:215], v[84:87], v[212:215]
    v_exp_f32 v209, v209
    v_mfma_f32_16x16x32_bf16 v[212:215], a[216:219], v[88:91], v[212:215]
    v_exp_f32 v210, v210
    v_mfma_f32_16x16x32_bf16 v[212:215], a[220:223], v[92:95], v[212:215]
    v_exp_f32 v211, v211
    v_mfma_f32_16x16x32_bf16 a[8:11], a[160:163], v[176:179], a[8:11]
    ds_read_b64_tr_b16 a[176:177], v22 offset:16384
    v_cvt_pk_bf16_f32 v128, v208, v209
    v_mfma_f32_16x16x32_bf16 a[8:11], a[164:167], v[180:183], a[8:11]
    ds_read_b64_tr_b16 a[178:179], v22 offset:20480
    v_mfma_f32_16x16x32_bf16 a[12:15], a[160:163], v[184:187], a[12:15]
    ds_read_b128 a[232:235], v10 offset:36864
    v_cvt_pk_bf16_f32 v129, v210, v211
    v_mfma_f32_16x16x32_bf16 a[12:15], a[164:167], v[188:191], a[12:15]
    s_waitcnt lgkmcnt(3)
    buffer_load_dwordx4 v39, s[8:11], s40 offen offset:3072 lds
    v_mfma_f32_16x16x32_bf16 v[208:211], a[208:211], v[96:99], v[200:203]
    v_exp_f32 v212, v212
    v_mfma_f32_16x16x32_bf16 v[208:211], a[212:215], v[100:103], v[208:211]
    s_add_u32 s40, s40, 16384
    v_exp_f32 v213, v213
    v_mfma_f32_16x16x32_bf16 v[208:211], a[216:219], v[104:107], v[208:211]
    v_exp_f32 v214, v214
    v_mfma_f32_16x16x32_bf16 v[208:211], a[220:223], v[108:111], v[208:211]
    v_exp_f32 v215, v215
    v_mfma_f32_16x16x32_bf16 a[16:19], a[168:171], v[160:163], a[16:19]
    ds_read_b64_tr_b16 a[180:181], v22 offset:24576
    v_cvt_pk_bf16_f32 v136, v212, v213
    v_mfma_f32_16x16x32_bf16 a[16:19], a[172:175], v[164:167], a[16:19]
    ds_read_b64_tr_b16 a[182:183], v22 offset:28672
    v_mfma_f32_16x16x32_bf16 a[20:23], a[168:171], v[168:171], a[20:23]
    ds_read_b128 a[236:239], v11 offset:36864
    v_cvt_pk_bf16_f32 v137, v214, v215
    v_mfma_f32_16x16x32_bf16 a[20:23], a[172:175], v[172:175], a[20:23]
    v_smfmac_f32_16x16x64_bf16 a[192:195], v[52:55], v[160:167], v50
    v_mfma_f32_16x16x32_bf16 v[212:215], a[208:211], v[112:115], v[204:207]
    v_exp_f32 v208, v208
    v_mfma_f32_16x16x32_bf16 v[212:215], a[212:215], v[116:119], v[212:215]
    s_add_u32 m0, s42, 114688
    v_exp_f32 v209, v209
    v_mfma_f32_16x16x32_bf16 v[212:215], a[216:219], v[120:123], v[212:215]
    v_exp_f32 v210, v210
    v_mfma_f32_16x16x32_bf16 v[212:215], a[220:223], v[124:127], v[212:215]
    v_exp_f32 v211, v211
    v_mfma_f32_16x16x32_bf16 a[24:27], a[168:171], v[176:179], a[24:27]
    ds_read_b64_tr_b16 a[184:185], v23 offset:16384
    v_cvt_pk_bf16_f32 v144, v208, v209
    v_mfma_f32_16x16x32_bf16 a[24:27], a[172:175], v[180:183], a[24:27]
    ds_read_b64_tr_b16 a[186:187], v23 offset:20480
    v_mfma_f32_16x16x32_bf16 a[28:31], a[168:171], v[184:187], a[28:31]
    ds_read_b128 a[208:211], v8 offset:40960
    v_cvt_pk_bf16_f32 v145, v210, v211
    v_mfma_f32_16x16x32_bf16 a[28:31], a[172:175], v[188:191], a[28:31]
    s_waitcnt lgkmcnt(3)
    buffer_load_dwordx4 v40, s[12:15], s41 offen lds
    v_mfma_f32_16x16x32_bf16 v[208:211], a[224:227], v[64:67], v[192:195]
    v_exp_f32 v212, v212
    v_mfma_f32_16x16x32_bf16 v[208:211], a[228:231], v[68:71], v[208:211]
    v_exp_f32 v213, v213
    v_mfma_f32_16x16x32_bf16 v[208:211], a[232:235], v[72:75], v[208:211]
    v_exp_f32 v214, v214
    v_mfma_f32_16x16x32_bf16 v[208:211], a[236:239], v[76:79], v[208:211]
    v_exp_f32 v215, v215
    v_mfma_f32_16x16x32_bf16 a[32:35], a[176:179], v[160:163], a[32:35]
    ds_read_b64_tr_b16 a[188:189], v23 offset:24576
    v_cvt_pk_bf16_f32 v152, v212, v213
    v_mfma_f32_16x16x32_bf16 a[32:35], a[180:183], v[164:167], a[32:35]
    ds_read_b64_tr_b16 a[190:191], v23 offset:28672
    v_mfma_f32_16x16x32_bf16 a[36:39], a[176:179], v[168:171], a[36:39]
    ds_read_b128 a[212:215], v9 offset:40960
    v_cvt_pk_bf16_f32 v153, v214, v215
    v_mfma_f32_16x16x32_bf16 a[36:39], a[180:183], v[172:175], a[36:39]
    v_smfmac_f32_16x16x64_bf16 a[196:199], v[52:55], v[168:175], v50
    v_mfma_f32_16x16x32_bf16 v[212:215], a[224:227], v[80:83], v[196:199]
    v_exp_f32 v208, v208
    v_mfma_f32_16x16x32_bf16 v[212:215], a[228:231], v[84:87], v[212:215]
    v_exp_f32 v209, v209
    v_mfma_f32_16x16x32_bf16 v[212:215], a[232:235], v[88:91], v[212:215]
    v_exp_f32 v210, v210
    v_mfma_f32_16x16x32_bf16 v[212:215], a[236:239], v[92:95], v[212:215]
    v_exp_f32 v211, v211
    v_mfma_f32_16x16x32_bf16 a[40:43], a[176:179], v[176:179], a[40:43]
    ds_read_b64_tr_b16 a[160:161], v24 offset:16384
    v_cvt_pk_bf16_f32 v130, v208, v209
    v_mfma_f32_16x16x32_bf16 a[40:43], a[180:183], v[180:183], a[40:43]
    ds_read_b64_tr_b16 a[162:163], v24 offset:20480
    v_mfma_f32_16x16x32_bf16 a[44:47], a[176:179], v[184:187], a[44:47]
    ds_read_b128 a[216:219], v10 offset:40960
    v_cvt_pk_bf16_f32 v131, v210, v211
    v_mfma_f32_16x16x32_bf16 a[44:47], a[180:183], v[188:191], a[44:47]
    s_waitcnt lgkmcnt(3)
    buffer_load_dwordx4 v41, s[12:15], s41 offen offset:1024 lds
    v_mfma_f32_16x16x32_bf16 v[208:211], a[224:227], v[96:99], v[200:203]
    v_exp_f32 v212, v212
    v_mfma_f32_16x16x32_bf16 v[208:211], a[228:231], v[100:103], v[208:211]
    v_exp_f32 v213, v213
    v_mfma_f32_16x16x32_bf16 v[208:211], a[232:235], v[104:107], v[208:211]
    v_exp_f32 v214, v214
    v_mfma_f32_16x16x32_bf16 v[208:211], a[236:239], v[108:111], v[208:211]
    v_exp_f32 v215, v215
    v_mfma_f32_16x16x32_bf16 a[48:51], a[184:187], v[160:163], a[48:51]
    ds_read_b64_tr_b16 a[164:165], v24 offset:24576
    v_cvt_pk_bf16_f32 v138, v212, v213
    v_mfma_f32_16x16x32_bf16 a[48:51], a[188:191], v[164:167], a[48:51]
    ds_read_b64_tr_b16 a[166:167], v24 offset:28672
    v_mfma_f32_16x16x32_bf16 a[52:55], a[184:187], v[168:171], a[52:55]
    ds_read_b128 a[220:223], v11 offset:40960
    v_cvt_pk_bf16_f32 v139, v214, v215
    v_mfma_f32_16x16x32_bf16 a[52:55], a[188:191], v[172:175], a[52:55]
    v_smfmac_f32_16x16x64_bf16 a[200:203], v[52:55], v[176:183], v50
    v_mfma_f32_16x16x32_bf16 v[212:215], a[224:227], v[112:115], v[204:207]
    v_exp_f32 v208, v208
    v_mfma_f32_16x16x32_bf16 v[212:215], a[228:231], v[116:119], v[212:215]
    v_exp_f32 v209, v209
    v_mfma_f32_16x16x32_bf16 v[212:215], a[232:235], v[120:123], v[212:215]
    v_exp_f32 v210, v210
    v_mfma_f32_16x16x32_bf16 v[212:215], a[236:239], v[124:127], v[212:215]
    v_exp_f32 v211, v211
    v_mfma_f32_16x16x32_bf16 a[56:59], a[184:187], v[176:179], a[56:59]
    ds_read_b64_tr_b16 a[168:169], v25 offset:16384
    v_cvt_pk_bf16_f32 v146, v208, v209
    v_mfma_f32_16x16x32_bf16 a[56:59], a[188:191], v[180:183], a[56:59]
    ds_read_b64_tr_b16 a[170:171], v25 offset:20480
    v_mfma_f32_16x16x32_bf16 a[60:63], a[184:187], v[184:187], a[60:63]
    ds_read_b128 a[224:227], v8 offset:45056
    v_cvt_pk_bf16_f32 v147, v210, v211
    v_mfma_f32_16x16x32_bf16 a[60:63], a[188:191], v[188:191], a[60:63]
    s_waitcnt lgkmcnt(3)
    buffer_load_dwordx4 v40, s[12:15], s41 offen offset:2048 lds
    v_mfma_f32_16x16x32_bf16 v[208:211], a[208:211], v[64:67], v[192:195]
    v_exp_f32 v212, v212
    v_mfma_f32_16x16x32_bf16 v[208:211], a[212:215], v[68:71], v[208:211]
    v_exp_f32 v213, v213
    v_mfma_f32_16x16x32_bf16 v[208:211], a[216:219], v[72:75], v[208:211]
    v_exp_f32 v214, v214
    v_mfma_f32_16x16x32_bf16 v[208:211], a[220:223], v[76:79], v[208:211]
    v_exp_f32 v215, v215
    v_mfma_f32_16x16x32_bf16 a[64:67], a[160:163], v[160:163], a[64:67]
    ds_read_b64_tr_b16 a[172:173], v25 offset:24576
    v_cvt_pk_bf16_f32 v154, v212, v213
    v_mfma_f32_16x16x32_bf16 a[64:67], a[164:167], v[164:167], a[64:67]
    ds_read_b64_tr_b16 a[174:175], v25 offset:28672
    v_mfma_f32_16x16x32_bf16 a[68:71], a[160:163], v[168:171], a[68:71]
    ds_read_b128 a[228:231], v9 offset:45056
    v_cvt_pk_bf16_f32 v155, v214, v215
    v_mfma_f32_16x16x32_bf16 a[68:71], a[164:167], v[172:175], a[68:71]
    v_smfmac_f32_16x16x64_bf16 a[204:207], v[52:55], v[184:191], v50
    v_mfma_f32_16x16x32_bf16 v[212:215], a[208:211], v[80:83], v[196:199]
    v_exp_f32 v208, v208
    v_mfma_f32_16x16x32_bf16 v[212:215], a[212:215], v[84:87], v[212:215]
    v_exp_f32 v209, v209
    v_mfma_f32_16x16x32_bf16 v[212:215], a[216:219], v[88:91], v[212:215]
    v_exp_f32 v210, v210
    v_mfma_f32_16x16x32_bf16 v[212:215], a[220:223], v[92:95], v[212:215]
    v_exp_f32 v211, v211
    v_mfma_f32_16x16x32_bf16 a[72:75], a[160:163], v[176:179], a[72:75]
    ds_read_b64_tr_b16 a[176:177], v26 offset:16384
    v_cvt_pk_bf16_f32 v132, v208, v209
    v_mfma_f32_16x16x32_bf16 a[72:75], a[164:167], v[180:183], a[72:75]
    ds_read_b64_tr_b16 a[178:179], v26 offset:20480
    v_mfma_f32_16x16x32_bf16 a[76:79], a[160:163], v[184:187], a[76:79]
    ds_read_b128 a[232:235], v10 offset:45056
    v_cvt_pk_bf16_f32 v133, v210, v211
    v_mfma_f32_16x16x32_bf16 a[76:79], a[164:167], v[188:191], a[76:79]
    s_waitcnt lgkmcnt(3)
    buffer_load_dwordx4 v41, s[12:15], s41 offen offset:3072 lds
    v_mfma_f32_16x16x32_bf16 v[208:211], a[208:211], v[96:99], v[200:203]
    v_exp_f32 v212, v212
    v_mfma_f32_16x16x32_bf16 v[208:211], a[212:215], v[100:103], v[208:211]
    s_add_u32 s41, s41, 16384
    v_exp_f32 v213, v213
    v_mfma_f32_16x16x32_bf16 v[208:211], a[216:219], v[104:107], v[208:211]
    v_exp_f32 v214, v214
    v_mfma_f32_16x16x32_bf16 v[208:211], a[220:223], v[108:111], v[208:211]
    v_exp_f32 v215, v215
    v_mfma_f32_16x16x32_bf16 a[80:83], a[168:171], v[160:163], a[80:83]
    ds_read_b64_tr_b16 a[180:181], v26 offset:24576
    v_cvt_pk_bf16_f32 v140, v212, v213
    v_mfma_f32_16x16x32_bf16 a[80:83], a[172:175], v[164:167], a[80:83]
    ds_read_b64_tr_b16 a[182:183], v26 offset:28672
    v_mfma_f32_16x16x32_bf16 a[84:87], a[168:171], v[168:171], a[84:87]
    ds_read_b128 a[236:239], v11 offset:45056
    v_cvt_pk_bf16_f32 v141, v214, v215
    v_mfma_f32_16x16x32_bf16 a[84:87], a[172:175], v[172:175], a[84:87]
    s_waitcnt vmcnt(9)
    s_barrier
    v_mfma_f32_16x16x32_bf16 v[212:215], a[208:211], v[112:115], v[204:207]
    v_exp_f32 v208, v208
    v_mfma_f32_16x16x32_bf16 v[212:215], a[212:215], v[116:119], v[212:215]
    s_add_u32 m0, s42, 16384
    v_exp_f32 v209, v209
    v_mfma_f32_16x16x32_bf16 v[212:215], a[216:219], v[120:123], v[212:215]
    v_exp_f32 v210, v210
    v_mfma_f32_16x16x32_bf16 v[212:215], a[220:223], v[124:127], v[212:215]
    v_exp_f32 v211, v211
    v_mfma_f32_16x16x32_bf16 a[88:91], a[168:171], v[176:179], a[88:91]
    ds_read_b64_tr_b16 a[184:185], v27 offset:16384
    v_cvt_pk_bf16_f32 v148, v208, v209
    v_mfma_f32_16x16x32_bf16 a[88:91], a[172:175], v[180:183], a[88:91]
    ds_read_b64_tr_b16 a[186:187], v27 offset:20480
    v_mfma_f32_16x16x32_bf16 a[92:95], a[168:171], v[184:187], a[92:95]
    ds_read_b128 a[208:211], v8 offset:49152
    v_cvt_pk_bf16_f32 v149, v210, v211
    v_mfma_f32_16x16x32_bf16 a[92:95], a[172:175], v[188:191], a[92:95]
    s_waitcnt lgkmcnt(3)
    buffer_load_dwordx4 v36, s[8:11], s40 offen lds
    v_mfma_f32_16x16x32_bf16 v[208:211], a[224:227], v[64:67], v[192:195]
    v_exp_f32 v212, v212
    v_mfma_f32_16x16x32_bf16 v[208:211], a[228:231], v[68:71], v[208:211]
    v_exp_f32 v213, v213
    v_mfma_f32_16x16x32_bf16 v[208:211], a[232:235], v[72:75], v[208:211]
    v_exp_f32 v214, v214
    v_mfma_f32_16x16x32_bf16 v[208:211], a[236:239], v[76:79], v[208:211]
    v_exp_f32 v215, v215
    v_mfma_f32_16x16x32_bf16 a[96:99], a[176:179], v[160:163], a[96:99]
    ds_read_b64_tr_b16 a[188:189], v27 offset:24576
    v_cvt_pk_bf16_f32 v156, v212, v213
    v_mfma_f32_16x16x32_bf16 a[96:99], a[180:183], v[164:167], a[96:99]
    ds_read_b64_tr_b16 a[190:191], v27 offset:28672
    v_mfma_f32_16x16x32_bf16 a[100:103], a[176:179], v[168:171], a[100:103]
    ds_read_b128 a[212:215], v9 offset:49152
    v_cvt_pk_bf16_f32 v157, v214, v215
    v_mfma_f32_16x16x32_bf16 a[100:103], a[180:183], v[172:175], a[100:103]
    buffer_load_dword v218, v57, s[80:83], s39 offen
    v_mfma_f32_16x16x32_bf16 v[212:215], a[224:227], v[80:83], v[196:199]
    v_exp_f32 v208, v208
    v_mfma_f32_16x16x32_bf16 v[212:215], a[228:231], v[84:87], v[212:215]
    v_exp_f32 v209, v209
    v_mfma_f32_16x16x32_bf16 v[212:215], a[232:235], v[88:91], v[212:215]
    v_exp_f32 v210, v210
    v_mfma_f32_16x16x32_bf16 v[212:215], a[236:239], v[92:95], v[212:215]
    v_exp_f32 v211, v211
    v_mfma_f32_16x16x32_bf16 a[104:107], a[176:179], v[176:179], a[104:107]
    ds_read_b64_tr_b16 a[160:161], v20 offset:32768
    v_cvt_pk_bf16_f32 v134, v208, v209
    v_mfma_f32_16x16x32_bf16 a[104:107], a[180:183], v[180:183], a[104:107]
    ds_read_b64_tr_b16 a[162:163], v20 offset:36864
    v_mfma_f32_16x16x32_bf16 a[108:111], a[176:179], v[184:187], a[108:111]
    ds_read_b128 a[216:219], v10 offset:49152
    v_cvt_pk_bf16_f32 v135, v210, v211
    v_mfma_f32_16x16x32_bf16 a[108:111], a[180:183], v[188:191], a[108:111]
    s_waitcnt lgkmcnt(3)
    buffer_load_dwordx4 v37, s[8:11], s40 offen offset:1024 lds
    v_mfma_f32_16x16x32_bf16 v[208:211], a[224:227], v[96:99], v[200:203]
    v_exp_f32 v212, v212
    v_mfma_f32_16x16x32_bf16 v[208:211], a[228:231], v[100:103], v[208:211]
    v_exp_f32 v213, v213
    v_mfma_f32_16x16x32_bf16 v[208:211], a[232:235], v[104:107], v[208:211]
    v_exp_f32 v214, v214
    v_mfma_f32_16x16x32_bf16 v[208:211], a[236:239], v[108:111], v[208:211]
    v_exp_f32 v215, v215
    v_mfma_f32_16x16x32_bf16 a[112:115], a[184:187], v[160:163], a[112:115]
    ds_read_b64_tr_b16 a[164:165], v20 offset:40960
    v_cvt_pk_bf16_f32 v142, v212, v213
    v_mfma_f32_16x16x32_bf16 a[112:115], a[188:191], v[164:167], a[112:115]
    ds_read_b64_tr_b16 a[166:167], v20 offset:45056
    v_mfma_f32_16x16x32_bf16 a[116:119], a[184:187], v[168:171], a[116:119]
    ds_read_b128 a[220:223], v11 offset:49152
    v_cvt_pk_bf16_f32 v143, v214, v215
    v_mfma_f32_16x16x32_bf16 a[116:119], a[188:191], v[172:175], a[116:119]
    v_mfma_f32_16x16x32_bf16 v[212:215], a[224:227], v[112:115], v[204:207]
    v_exp_f32 v208, v208
    v_mfma_f32_16x16x32_bf16 v[212:215], a[228:231], v[116:119], v[212:215]
    v_exp_f32 v209, v209
    v_mfma_f32_16x16x32_bf16 v[212:215], a[232:235], v[120:123], v[212:215]
    v_exp_f32 v210, v210
    v_mfma_f32_16x16x32_bf16 v[212:215], a[236:239], v[124:127], v[212:215]
    v_exp_f32 v211, v211
    v_mfma_f32_16x16x32_bf16 a[120:123], a[184:187], v[176:179], a[120:123]
    ds_read_b64_tr_b16 a[168:169], v21 offset:32768
    v_cvt_pk_bf16_f32 v150, v208, v209
    v_mfma_f32_16x16x32_bf16 a[120:123], a[188:191], v[180:183], a[120:123]
    ds_read_b64_tr_b16 a[170:171], v21 offset:36864
    v_mfma_f32_16x16x32_bf16 a[124:127], a[184:187], v[184:187], a[124:127]
    ds_read_b128 a[224:227], v8 offset:53248
    v_cvt_pk_bf16_f32 v151, v210, v211
    v_mfma_f32_16x16x32_bf16 a[124:127], a[188:191], v[188:191], a[124:127]
    s_waitcnt lgkmcnt(3)
    buffer_load_dwordx4 v38, s[8:11], s40 offen offset:2048 lds
    v_mfma_f32_16x16x32_bf16 v[208:211], a[208:211], v[64:67], v[192:195]
    v_exp_f32 v212, v212
    v_mfma_f32_16x16x32_bf16 v[208:211], a[212:215], v[68:71], v[208:211]
    v_exp_f32 v213, v213
    v_mfma_f32_16x16x32_bf16 v[208:211], a[216:219], v[72:75], v[208:211]
    v_exp_f32 v214, v214
    v_mfma_f32_16x16x32_bf16 v[208:211], a[220:223], v[76:79], v[208:211]
    v_exp_f32 v215, v215
    v_mfma_f32_16x16x32_bf16 a[0:3], a[160:163], v[128:131], a[0:3]
    ds_read_b64_tr_b16 a[172:173], v21 offset:40960
    v_cvt_pk_bf16_f32 v158, v212, v213
    v_mfma_f32_16x16x32_bf16 a[0:3], a[164:167], v[132:135], a[0:3]
    ds_read_b64_tr_b16 a[174:175], v21 offset:45056
    v_mfma_f32_16x16x32_bf16 a[4:7], a[160:163], v[136:139], a[4:7]
    ds_read_b128 a[228:231], v9 offset:53248
    v_cvt_pk_bf16_f32 v159, v214, v215
    v_mfma_f32_16x16x32_bf16 a[4:7], a[164:167], v[140:143], a[4:7]
    v_mfma_f32_16x16x32_bf16 v[212:215], a[208:211], v[80:83], v[196:199]
    v_exp_f32 v208, v208
    v_mfma_f32_16x16x32_bf16 v[212:215], a[212:215], v[84:87], v[212:215]
    v_exp_f32 v209, v209
    v_mfma_f32_16x16x32_bf16 v[212:215], a[216:219], v[88:91], v[212:215]
    v_exp_f32 v210, v210
    v_mfma_f32_16x16x32_bf16 v[212:215], a[220:223], v[92:95], v[212:215]
    v_exp_f32 v211, v211
    v_mfma_f32_16x16x32_bf16 a[8:11], a[160:163], v[144:147], a[8:11]
    ds_read_b64_tr_b16 a[176:177], v22 offset:32768
    v_cvt_pk_bf16_f32 v160, v208, v209
    v_mfma_f32_16x16x32_bf16 a[8:11], a[164:167], v[148:151], a[8:11]
    ds_read_b64_tr_b16 a[178:179], v22 offset:36864
    v_mfma_f32_16x16x32_bf16 a[12:15], a[160:163], v[152:155], a[12:15]
    ds_read_b128 a[232:235], v10 offset:53248
    v_cvt_pk_bf16_f32 v161, v210, v211
    v_mfma_f32_16x16x32_bf16 a[12:15], a[164:167], v[156:159], a[12:15]
    s_waitcnt lgkmcnt(3)
    buffer_load_dwordx4 v39, s[8:11], s40 offen offset:3072 lds
    v_mfma_f32_16x16x32_bf16 v[208:211], a[208:211], v[96:99], v[200:203]
    v_exp_f32 v212, v212
    v_mfma_f32_16x16x32_bf16 v[208:211], a[212:215], v[100:103], v[208:211]
    s_add_u32 s40, s40, 16384
    v_exp_f32 v213, v213
    v_mfma_f32_16x16x32_bf16 v[208:211], a[216:219], v[104:107], v[208:211]
    v_exp_f32 v214, v214
    v_mfma_f32_16x16x32_bf16 v[208:211], a[220:223], v[108:111], v[208:211]
    v_exp_f32 v215, v215
    v_mfma_f32_16x16x32_bf16 a[16:19], a[168:171], v[128:131], a[16:19]
    ds_read_b64_tr_b16 a[180:181], v22 offset:40960
    v_cvt_pk_bf16_f32 v168, v212, v213
    v_mfma_f32_16x16x32_bf16 a[16:19], a[172:175], v[132:135], a[16:19]
    ds_read_b64_tr_b16 a[182:183], v22 offset:45056
    v_mfma_f32_16x16x32_bf16 a[20:23], a[168:171], v[136:139], a[20:23]
    ds_read_b128 a[236:239], v11 offset:53248
    v_cvt_pk_bf16_f32 v169, v214, v215
    v_mfma_f32_16x16x32_bf16 a[20:23], a[172:175], v[140:143], a[20:23]
    v_smfmac_f32_16x16x64_bf16 a[192:195], v[52:55], v[128:135], v50
    v_mfma_f32_16x16x32_bf16 v[212:215], a[208:211], v[112:115], v[204:207]
    v_exp_f32 v208, v208
    v_mfma_f32_16x16x32_bf16 v[212:215], a[212:215], v[116:119], v[212:215]
    s_add_u32 m0, s42, 65536
    v_exp_f32 v209, v209
    v_mfma_f32_16x16x32_bf16 v[212:215], a[216:219], v[120:123], v[212:215]
    v_exp_f32 v210, v210
    v_mfma_f32_16x16x32_bf16 v[212:215], a[220:223], v[124:127], v[212:215]
    v_exp_f32 v211, v211
    v_mfma_f32_16x16x32_bf16 a[24:27], a[168:171], v[144:147], a[24:27]
    ds_read_b64_tr_b16 a[184:185], v23 offset:32768
    v_cvt_pk_bf16_f32 v176, v208, v209
    v_mfma_f32_16x16x32_bf16 a[24:27], a[172:175], v[148:151], a[24:27]
    ds_read_b64_tr_b16 a[186:187], v23 offset:36864
    v_mfma_f32_16x16x32_bf16 a[28:31], a[168:171], v[152:155], a[28:31]
    ds_read_b128 a[208:211], v8 offset:57344
    v_cvt_pk_bf16_f32 v177, v210, v211
    v_mfma_f32_16x16x32_bf16 a[28:31], a[172:175], v[156:159], a[28:31]
    s_waitcnt lgkmcnt(3)
    buffer_load_dwordx4 v40, s[12:15], s41 offen lds
    v_mfma_f32_16x16x32_bf16 v[208:211], a[224:227], v[64:67], v[192:195]
    v_exp_f32 v212, v212
    v_mfma_f32_16x16x32_bf16 v[208:211], a[228:231], v[68:71], v[208:211]
    v_exp_f32 v213, v213
    v_mfma_f32_16x16x32_bf16 v[208:211], a[232:235], v[72:75], v[208:211]
    v_exp_f32 v214, v214
    v_mfma_f32_16x16x32_bf16 v[208:211], a[236:239], v[76:79], v[208:211]
    v_exp_f32 v215, v215
    v_mfma_f32_16x16x32_bf16 a[32:35], a[176:179], v[128:131], a[32:35]
    ds_read_b64_tr_b16 a[188:189], v23 offset:40960
    v_cvt_pk_bf16_f32 v184, v212, v213
    v_mfma_f32_16x16x32_bf16 a[32:35], a[180:183], v[132:135], a[32:35]
    ds_read_b64_tr_b16 a[190:191], v23 offset:45056
    v_mfma_f32_16x16x32_bf16 a[36:39], a[176:179], v[136:139], a[36:39]
    ds_read_b128 a[212:215], v9 offset:57344
    v_cvt_pk_bf16_f32 v185, v214, v215
    v_mfma_f32_16x16x32_bf16 a[36:39], a[180:183], v[140:143], a[36:39]
    v_smfmac_f32_16x16x64_bf16 a[196:199], v[52:55], v[136:143], v50
    v_mfma_f32_16x16x32_bf16 v[212:215], a[224:227], v[80:83], v[196:199]
    v_exp_f32 v208, v208
    v_mfma_f32_16x16x32_bf16 v[212:215], a[228:231], v[84:87], v[212:215]
    v_exp_f32 v209, v209
    v_mfma_f32_16x16x32_bf16 v[212:215], a[232:235], v[88:91], v[212:215]
    v_exp_f32 v210, v210
    v_mfma_f32_16x16x32_bf16 v[212:215], a[236:239], v[92:95], v[212:215]
    v_exp_f32 v211, v211
    v_mfma_f32_16x16x32_bf16 a[40:43], a[176:179], v[144:147], a[40:43]
    ds_read_b64_tr_b16 a[160:161], v24 offset:32768
    v_cvt_pk_bf16_f32 v162, v208, v209
    v_mfma_f32_16x16x32_bf16 a[40:43], a[180:183], v[148:151], a[40:43]
    ds_read_b64_tr_b16 a[162:163], v24 offset:36864
    v_mfma_f32_16x16x32_bf16 a[44:47], a[176:179], v[152:155], a[44:47]
    ds_read_b128 a[216:219], v10 offset:57344
    v_cvt_pk_bf16_f32 v163, v210, v211
    v_mfma_f32_16x16x32_bf16 a[44:47], a[180:183], v[156:159], a[44:47]
    s_waitcnt lgkmcnt(3)
    buffer_load_dwordx4 v41, s[12:15], s41 offen offset:1024 lds
    v_mfma_f32_16x16x32_bf16 v[208:211], a[224:227], v[96:99], v[200:203]
    v_exp_f32 v212, v212
    v_mfma_f32_16x16x32_bf16 v[208:211], a[228:231], v[100:103], v[208:211]
    v_exp_f32 v213, v213
    v_mfma_f32_16x16x32_bf16 v[208:211], a[232:235], v[104:107], v[208:211]
    v_exp_f32 v214, v214
    v_mfma_f32_16x16x32_bf16 v[208:211], a[236:239], v[108:111], v[208:211]
    v_exp_f32 v215, v215
    v_mfma_f32_16x16x32_bf16 a[48:51], a[184:187], v[128:131], a[48:51]
    ds_read_b64_tr_b16 a[164:165], v24 offset:40960
    v_cvt_pk_bf16_f32 v170, v212, v213
    v_mfma_f32_16x16x32_bf16 a[48:51], a[188:191], v[132:135], a[48:51]
    ds_read_b64_tr_b16 a[166:167], v24 offset:45056
    v_mfma_f32_16x16x32_bf16 a[52:55], a[184:187], v[136:139], a[52:55]
    ds_read_b128 a[220:223], v11 offset:57344
    v_cvt_pk_bf16_f32 v171, v214, v215
    v_mfma_f32_16x16x32_bf16 a[52:55], a[188:191], v[140:143], a[52:55]
    v_smfmac_f32_16x16x64_bf16 a[200:203], v[52:55], v[144:151], v50
    v_mfma_f32_16x16x32_bf16 v[212:215], a[224:227], v[112:115], v[204:207]
    v_exp_f32 v208, v208
    v_mfma_f32_16x16x32_bf16 v[212:215], a[228:231], v[116:119], v[212:215]
    v_exp_f32 v209, v209
    v_mfma_f32_16x16x32_bf16 v[212:215], a[232:235], v[120:123], v[212:215]
    v_exp_f32 v210, v210
    v_mfma_f32_16x16x32_bf16 v[212:215], a[236:239], v[124:127], v[212:215]
    v_exp_f32 v211, v211
    v_mfma_f32_16x16x32_bf16 a[56:59], a[184:187], v[144:147], a[56:59]
    ds_read_b64_tr_b16 a[168:169], v25 offset:32768
    v_cvt_pk_bf16_f32 v178, v208, v209
    v_mfma_f32_16x16x32_bf16 a[56:59], a[188:191], v[148:151], a[56:59]
    ds_read_b64_tr_b16 a[170:171], v25 offset:36864
    v_mfma_f32_16x16x32_bf16 a[60:63], a[184:187], v[152:155], a[60:63]
    ds_read_b128 a[224:227], v8 offset:61440
    v_cvt_pk_bf16_f32 v179, v210, v211
    v_mfma_f32_16x16x32_bf16 a[60:63], a[188:191], v[156:159], a[60:63]
    s_waitcnt lgkmcnt(3)
    buffer_load_dwordx4 v40, s[12:15], s41 offen offset:2048 lds
    v_mfma_f32_16x16x32_bf16 v[208:211], a[208:211], v[64:67], v[192:195]
    v_exp_f32 v212, v212
    v_mfma_f32_16x16x32_bf16 v[208:211], a[212:215], v[68:71], v[208:211]
    v_exp_f32 v213, v213
    v_mfma_f32_16x16x32_bf16 v[208:211], a[216:219], v[72:75], v[208:211]
    v_exp_f32 v214, v214
    v_mfma_f32_16x16x32_bf16 v[208:211], a[220:223], v[76:79], v[208:211]
    v_exp_f32 v215, v215
    v_mfma_f32_16x16x32_bf16 a[64:67], a[160:163], v[128:131], a[64:67]
    ds_read_b64_tr_b16 a[172:173], v25 offset:40960
    v_cvt_pk_bf16_f32 v186, v212, v213
    v_mfma_f32_16x16x32_bf16 a[64:67], a[164:167], v[132:135], a[64:67]
    ds_read_b64_tr_b16 a[174:175], v25 offset:45056
    v_mfma_f32_16x16x32_bf16 a[68:71], a[160:163], v[136:139], a[68:71]
    ds_read_b128 a[228:231], v9 offset:61440
    v_cvt_pk_bf16_f32 v187, v214, v215
    v_mfma_f32_16x16x32_bf16 a[68:71], a[164:167], v[140:143], a[68:71]
    v_smfmac_f32_16x16x64_bf16 a[204:207], v[52:55], v[152:159], v50
    v_mfma_f32_16x16x32_bf16 v[212:215], a[208:211], v[80:83], v[196:199]
    v_exp_f32 v208, v208
    v_mfma_f32_16x16x32_bf16 v[212:215], a[212:215], v[84:87], v[212:215]
    v_exp_f32 v209, v209
    v_mfma_f32_16x16x32_bf16 v[212:215], a[216:219], v[88:91], v[212:215]
    v_exp_f32 v210, v210
    v_mfma_f32_16x16x32_bf16 v[212:215], a[220:223], v[92:95], v[212:215]
    v_exp_f32 v211, v211
    v_mfma_f32_16x16x32_bf16 a[72:75], a[160:163], v[144:147], a[72:75]
    ds_read_b64_tr_b16 a[176:177], v26 offset:32768
    v_cvt_pk_bf16_f32 v164, v208, v209
    v_mfma_f32_16x16x32_bf16 a[72:75], a[164:167], v[148:151], a[72:75]
    ds_read_b64_tr_b16 a[178:179], v26 offset:36864
    v_mfma_f32_16x16x32_bf16 a[76:79], a[160:163], v[152:155], a[76:79]
    ds_read_b128 a[232:235], v10 offset:61440
    v_cvt_pk_bf16_f32 v165, v210, v211
    v_mfma_f32_16x16x32_bf16 a[76:79], a[164:167], v[156:159], a[76:79]
    s_waitcnt lgkmcnt(3)
    buffer_load_dwordx4 v41, s[12:15], s41 offen offset:3072 lds
    v_mfma_f32_16x16x32_bf16 v[208:211], a[208:211], v[96:99], v[200:203]
    v_exp_f32 v212, v212
    v_mfma_f32_16x16x32_bf16 v[208:211], a[212:215], v[100:103], v[208:211]
    s_add_u32 s41, s41, 16384
    v_exp_f32 v213, v213
    v_mfma_f32_16x16x32_bf16 v[208:211], a[216:219], v[104:107], v[208:211]
    v_exp_f32 v214, v214
    v_mfma_f32_16x16x32_bf16 v[208:211], a[220:223], v[108:111], v[208:211]
    v_exp_f32 v215, v215
    v_mfma_f32_16x16x32_bf16 a[80:83], a[168:171], v[128:131], a[80:83]
    ds_read_b64_tr_b16 a[180:181], v26 offset:40960
    v_cvt_pk_bf16_f32 v172, v212, v213
    v_mfma_f32_16x16x32_bf16 a[80:83], a[172:175], v[132:135], a[80:83]
    ds_read_b64_tr_b16 a[182:183], v26 offset:45056
    v_mfma_f32_16x16x32_bf16 a[84:87], a[168:171], v[136:139], a[84:87]
    ds_read_b128 a[236:239], v11 offset:61440
    v_cvt_pk_bf16_f32 v173, v214, v215
    v_mfma_f32_16x16x32_bf16 a[84:87], a[172:175], v[140:143], a[84:87]
    s_waitcnt vmcnt(9)
    s_barrier
    v_mfma_f32_16x16x32_bf16 v[212:215], a[208:211], v[112:115], v[204:207]
    v_exp_f32 v208, v208
    v_mfma_f32_16x16x32_bf16 v[212:215], a[212:215], v[116:119], v[212:215]
    s_add_u32 m0, s42, 32768
    v_exp_f32 v209, v209
    v_mfma_f32_16x16x32_bf16 v[212:215], a[216:219], v[120:123], v[212:215]
    v_exp_f32 v210, v210
    v_mfma_f32_16x16x32_bf16 v[212:215], a[220:223], v[124:127], v[212:215]
    v_exp_f32 v211, v211
    v_mfma_f32_16x16x32_bf16 a[88:91], a[168:171], v[144:147], a[88:91]
    ds_read_b64_tr_b16 a[184:185], v27 offset:32768
    v_cvt_pk_bf16_f32 v180, v208, v209
    v_mfma_f32_16x16x32_bf16 a[88:91], a[172:175], v[148:151], a[88:91]
    ds_read_b64_tr_b16 a[186:187], v27 offset:36864
    v_mfma_f32_16x16x32_bf16 a[92:95], a[168:171], v[152:155], a[92:95]
    ds_read_b128 a[208:211], v8 offset:0
    v_cvt_pk_bf16_f32 v181, v210, v211
    v_mfma_f32_16x16x32_bf16 a[92:95], a[172:175], v[156:159], a[92:95]
    s_waitcnt lgkmcnt(3)
    buffer_load_dwordx4 v36, s[8:11], s40 offen lds
    v_mfma_f32_16x16x32_bf16 v[208:211], a[224:227], v[64:67], v[192:195]
    v_exp_f32 v212, v212
    v_mfma_f32_16x16x32_bf16 v[208:211], a[228:231], v[68:71], v[208:211]
    v_exp_f32 v213, v213
    v_mfma_f32_16x16x32_bf16 v[208:211], a[232:235], v[72:75], v[208:211]
    v_exp_f32 v214, v214
    v_mfma_f32_16x16x32_bf16 v[208:211], a[236:239], v[76:79], v[208:211]
    v_exp_f32 v215, v215
    v_mfma_f32_16x16x32_bf16 a[96:99], a[176:179], v[128:131], a[96:99]
    ds_read_b64_tr_b16 a[188:189], v27 offset:40960
    v_cvt_pk_bf16_f32 v188, v212, v213
    v_mfma_f32_16x16x32_bf16 a[96:99], a[180:183], v[132:135], a[96:99]
    ds_read_b64_tr_b16 a[190:191], v27 offset:45056
    v_mfma_f32_16x16x32_bf16 a[100:103], a[176:179], v[136:139], a[100:103]
    ds_read_b128 a[212:215], v9 offset:0
    v_cvt_pk_bf16_f32 v189, v214, v215
    v_mfma_f32_16x16x32_bf16 a[100:103], a[180:183], v[140:143], a[100:103]
    buffer_load_dword v219, v62, s[84:87], s38 offen
    v_mfma_f32_16x16x32_bf16 v[212:215], a[224:227], v[80:83], v[196:199]
    v_exp_f32 v208, v208
    v_mfma_f32_16x16x32_bf16 v[212:215], a[228:231], v[84:87], v[212:215]
    v_exp_f32 v209, v209
    v_mfma_f32_16x16x32_bf16 v[212:215], a[232:235], v[88:91], v[212:215]
    v_exp_f32 v210, v210
    v_mfma_f32_16x16x32_bf16 v[212:215], a[236:239], v[92:95], v[212:215]
    v_exp_f32 v211, v211
    v_mfma_f32_16x16x32_bf16 a[104:107], a[176:179], v[144:147], a[104:107]
    ds_read_b64_tr_b16 a[160:161], v20 offset:49152
    v_cvt_pk_bf16_f32 v166, v208, v209
    v_mfma_f32_16x16x32_bf16 a[104:107], a[180:183], v[148:151], a[104:107]
    ds_read_b64_tr_b16 a[162:163], v20 offset:53248
    v_mfma_f32_16x16x32_bf16 a[108:111], a[176:179], v[152:155], a[108:111]
    ds_read_b128 a[216:219], v10 offset:0
    v_cvt_pk_bf16_f32 v167, v210, v211
    v_mfma_f32_16x16x32_bf16 a[108:111], a[180:183], v[156:159], a[108:111]
    s_waitcnt lgkmcnt(3)
    buffer_load_dwordx4 v37, s[8:11], s40 offen offset:1024 lds
    v_mfma_f32_16x16x32_bf16 v[208:211], a[224:227], v[96:99], v[200:203]
    v_exp_f32 v212, v212
    v_mfma_f32_16x16x32_bf16 v[208:211], a[228:231], v[100:103], v[208:211]
    v_exp_f32 v213, v213
    v_mfma_f32_16x16x32_bf16 v[208:211], a[232:235], v[104:107], v[208:211]
    v_exp_f32 v214, v214
    v_mfma_f32_16x16x32_bf16 v[208:211], a[236:239], v[108:111], v[208:211]
    v_exp_f32 v215, v215
    v_mfma_f32_16x16x32_bf16 a[112:115], a[184:187], v[128:131], a[112:115]
    ds_read_b64_tr_b16 a[164:165], v20 offset:57344
    v_cvt_pk_bf16_f32 v174, v212, v213
    v_mfma_f32_16x16x32_bf16 a[112:115], a[188:191], v[132:135], a[112:115]
    ds_read_b64_tr_b16 a[166:167], v20 offset:61440
    v_mfma_f32_16x16x32_bf16 a[116:119], a[184:187], v[136:139], a[116:119]
    ds_read_b128 a[220:223], v11 offset:0
    v_cvt_pk_bf16_f32 v175, v214, v215
    v_mfma_f32_16x16x32_bf16 a[116:119], a[188:191], v[140:143], a[116:119]
    v_mfma_f32_16x16x32_bf16 v[212:215], a[224:227], v[112:115], v[204:207]
    v_exp_f32 v208, v208
    v_mfma_f32_16x16x32_bf16 v[212:215], a[228:231], v[116:119], v[212:215]
    v_exp_f32 v209, v209
    v_mfma_f32_16x16x32_bf16 v[212:215], a[232:235], v[120:123], v[212:215]
    v_exp_f32 v210, v210
    v_mfma_f32_16x16x32_bf16 v[212:215], a[236:239], v[124:127], v[212:215]
    v_exp_f32 v211, v211
    v_mfma_f32_16x16x32_bf16 a[120:123], a[184:187], v[144:147], a[120:123]
    ds_read_b64_tr_b16 a[168:169], v21 offset:49152
    v_cvt_pk_bf16_f32 v182, v208, v209
    v_mfma_f32_16x16x32_bf16 a[120:123], a[188:191], v[148:151], a[120:123]
    ds_read_b64_tr_b16 a[170:171], v21 offset:53248
    v_mfma_f32_16x16x32_bf16 a[124:127], a[184:187], v[152:155], a[124:127]
    ds_read_b128 a[224:227], v8 offset:4096
    v_cvt_pk_bf16_f32 v183, v210, v211
    v_mfma_f32_16x16x32_bf16 a[124:127], a[188:191], v[156:159], a[124:127]
    s_waitcnt lgkmcnt(3)
    buffer_load_dwordx4 v38, s[8:11], s40 offen offset:2048 lds
    v_mfma_f32_16x16x32_bf16 v[208:211], a[208:211], v[64:67], v[192:195]
    v_exp_f32 v212, v212
    v_mfma_f32_16x16x32_bf16 v[208:211], a[212:215], v[68:71], v[208:211]
    v_exp_f32 v213, v213
    v_mfma_f32_16x16x32_bf16 v[208:211], a[216:219], v[72:75], v[208:211]
    v_exp_f32 v214, v214
    v_mfma_f32_16x16x32_bf16 v[208:211], a[220:223], v[76:79], v[208:211]
    v_exp_f32 v215, v215
    v_mfma_f32_16x16x32_bf16 a[0:3], a[160:163], v[160:163], a[0:3]
    ds_read_b64_tr_b16 a[172:173], v21 offset:57344
    v_cvt_pk_bf16_f32 v190, v212, v213
    v_mfma_f32_16x16x32_bf16 a[0:3], a[164:167], v[164:167], a[0:3]
    ds_read_b64_tr_b16 a[174:175], v21 offset:61440
    v_mfma_f32_16x16x32_bf16 a[4:7], a[160:163], v[168:171], a[4:7]
    ds_read_b128 a[228:231], v9 offset:4096
    v_cvt_pk_bf16_f32 v191, v214, v215
    v_mfma_f32_16x16x32_bf16 a[4:7], a[164:167], v[172:175], a[4:7]
    v_mfma_f32_16x16x32_bf16 v[212:215], a[208:211], v[80:83], v[196:199]
    v_exp_f32 v208, v208
    v_mfma_f32_16x16x32_bf16 v[212:215], a[212:215], v[84:87], v[212:215]
    v_exp_f32 v209, v209
    v_mfma_f32_16x16x32_bf16 v[212:215], a[216:219], v[88:91], v[212:215]
    v_exp_f32 v210, v210
    v_mfma_f32_16x16x32_bf16 v[212:215], a[220:223], v[92:95], v[212:215]
    v_exp_f32 v211, v211
    v_mfma_f32_16x16x32_bf16 a[8:11], a[160:163], v[176:179], a[8:11]
    ds_read_b64_tr_b16 a[176:177], v22 offset:49152
    v_cvt_pk_bf16_f32 v128, v208, v209
    v_mfma_f32_16x16x32_bf16 a[8:11], a[164:167], v[180:183], a[8:11]
    ds_read_b64_tr_b16 a[178:179], v22 offset:53248
    v_mfma_f32_16x16x32_bf16 a[12:15], a[160:163], v[184:187], a[12:15]
    ds_read_b128 a[232:235], v10 offset:4096
    v_cvt_pk_bf16_f32 v129, v210, v211
    v_mfma_f32_16x16x32_bf16 a[12:15], a[164:167], v[188:191], a[12:15]
    s_waitcnt lgkmcnt(3)
    buffer_load_dwordx4 v39, s[8:11], s40 offen offset:3072 lds
    v_mfma_f32_16x16x32_bf16 v[208:211], a[208:211], v[96:99], v[200:203]
    v_exp_f32 v212, v212
    v_mfma_f32_16x16x32_bf16 v[208:211], a[212:215], v[100:103], v[208:211]
    s_add_u32 s40, s40, 16384
    v_exp_f32 v213, v213
    v_mfma_f32_16x16x32_bf16 v[208:211], a[216:219], v[104:107], v[208:211]
    v_exp_f32 v214, v214
    v_mfma_f32_16x16x32_bf16 v[208:211], a[220:223], v[108:111], v[208:211]
    v_exp_f32 v215, v215
    v_mfma_f32_16x16x32_bf16 a[16:19], a[168:171], v[160:163], a[16:19]
    ds_read_b64_tr_b16 a[180:181], v22 offset:57344
    v_cvt_pk_bf16_f32 v136, v212, v213
    v_mfma_f32_16x16x32_bf16 a[16:19], a[172:175], v[164:167], a[16:19]
    ds_read_b64_tr_b16 a[182:183], v22 offset:61440
    v_mfma_f32_16x16x32_bf16 a[20:23], a[168:171], v[168:171], a[20:23]
    ds_read_b128 a[236:239], v11 offset:4096
    v_cvt_pk_bf16_f32 v137, v214, v215
    v_mfma_f32_16x16x32_bf16 a[20:23], a[172:175], v[172:175], a[20:23]
    v_smfmac_f32_16x16x64_bf16 a[192:195], v[52:55], v[160:167], v50
    v_mfma_f32_16x16x32_bf16 v[212:215], a[208:211], v[112:115], v[204:207]
    v_exp_f32 v208, v208
    v_mfma_f32_16x16x32_bf16 v[212:215], a[212:215], v[116:119], v[212:215]
    s_add_u32 m0, s42, 81920
    v_exp_f32 v209, v209
    v_mfma_f32_16x16x32_bf16 v[212:215], a[216:219], v[120:123], v[212:215]
    v_exp_f32 v210, v210
    v_mfma_f32_16x16x32_bf16 v[212:215], a[220:223], v[124:127], v[212:215]
    v_exp_f32 v211, v211
    v_mfma_f32_16x16x32_bf16 a[24:27], a[168:171], v[176:179], a[24:27]
    ds_read_b64_tr_b16 a[184:185], v23 offset:49152
    v_cvt_pk_bf16_f32 v144, v208, v209
    v_mfma_f32_16x16x32_bf16 a[24:27], a[172:175], v[180:183], a[24:27]
    ds_read_b64_tr_b16 a[186:187], v23 offset:53248
    v_mfma_f32_16x16x32_bf16 a[28:31], a[168:171], v[184:187], a[28:31]
    ds_read_b128 a[208:211], v8 offset:8192
    v_cvt_pk_bf16_f32 v145, v210, v211
    v_mfma_f32_16x16x32_bf16 a[28:31], a[172:175], v[188:191], a[28:31]
    s_waitcnt lgkmcnt(3)
    buffer_load_dwordx4 v40, s[12:15], s41 offen lds
    v_mfma_f32_16x16x32_bf16 v[208:211], a[224:227], v[64:67], v[192:195]
    v_exp_f32 v212, v212
    v_mfma_f32_16x16x32_bf16 v[208:211], a[228:231], v[68:71], v[208:211]
    v_exp_f32 v213, v213
    v_mfma_f32_16x16x32_bf16 v[208:211], a[232:235], v[72:75], v[208:211]
    v_exp_f32 v214, v214
    v_mfma_f32_16x16x32_bf16 v[208:211], a[236:239], v[76:79], v[208:211]
    v_exp_f32 v215, v215
    v_mfma_f32_16x16x32_bf16 a[32:35], a[176:179], v[160:163], a[32:35]
    ds_read_b64_tr_b16 a[188:189], v23 offset:57344
    v_cvt_pk_bf16_f32 v152, v212, v213
    v_mfma_f32_16x16x32_bf16 a[32:35], a[180:183], v[164:167], a[32:35]
    ds_read_b64_tr_b16 a[190:191], v23 offset:61440
    v_mfma_f32_16x16x32_bf16 a[36:39], a[176:179], v[168:171], a[36:39]
    ds_read_b128 a[212:215], v9 offset:8192
    v_cvt_pk_bf16_f32 v153, v214, v215
    v_mfma_f32_16x16x32_bf16 a[36:39], a[180:183], v[172:175], a[36:39]
    v_smfmac_f32_16x16x64_bf16 a[196:199], v[52:55], v[168:175], v50
    v_mfma_f32_16x16x32_bf16 v[212:215], a[224:227], v[80:83], v[196:199]
    v_exp_f32 v208, v208
    v_mfma_f32_16x16x32_bf16 v[212:215], a[228:231], v[84:87], v[212:215]
    v_exp_f32 v209, v209
    v_mfma_f32_16x16x32_bf16 v[212:215], a[232:235], v[88:91], v[212:215]
    v_exp_f32 v210, v210
    v_mfma_f32_16x16x32_bf16 v[212:215], a[236:239], v[92:95], v[212:215]
    v_exp_f32 v211, v211
    v_mfma_f32_16x16x32_bf16 a[40:43], a[176:179], v[176:179], a[40:43]
    ds_read_b64_tr_b16 a[160:161], v24 offset:49152
    v_cvt_pk_bf16_f32 v130, v208, v209
    v_mfma_f32_16x16x32_bf16 a[40:43], a[180:183], v[180:183], a[40:43]
    ds_read_b64_tr_b16 a[162:163], v24 offset:53248
    v_mfma_f32_16x16x32_bf16 a[44:47], a[176:179], v[184:187], a[44:47]
    ds_read_b128 a[216:219], v10 offset:8192
    v_cvt_pk_bf16_f32 v131, v210, v211
    v_mfma_f32_16x16x32_bf16 a[44:47], a[180:183], v[188:191], a[44:47]
    s_waitcnt lgkmcnt(3)
    buffer_load_dwordx4 v41, s[12:15], s41 offen offset:1024 lds
    v_mfma_f32_16x16x32_bf16 v[208:211], a[224:227], v[96:99], v[200:203]
    v_exp_f32 v212, v212
    v_mfma_f32_16x16x32_bf16 v[208:211], a[228:231], v[100:103], v[208:211]
    v_exp_f32 v213, v213
    v_mfma_f32_16x16x32_bf16 v[208:211], a[232:235], v[104:107], v[208:211]
    v_exp_f32 v214, v214
    v_mfma_f32_16x16x32_bf16 v[208:211], a[236:239], v[108:111], v[208:211]
    v_exp_f32 v215, v215
    v_mfma_f32_16x16x32_bf16 a[48:51], a[184:187], v[160:163], a[48:51]
    ds_read_b64_tr_b16 a[164:165], v24 offset:57344
    v_cvt_pk_bf16_f32 v138, v212, v213
    v_mfma_f32_16x16x32_bf16 a[48:51], a[188:191], v[164:167], a[48:51]
    ds_read_b64_tr_b16 a[166:167], v24 offset:61440
    v_mfma_f32_16x16x32_bf16 a[52:55], a[184:187], v[168:171], a[52:55]
    ds_read_b128 a[220:223], v11 offset:8192
    v_cvt_pk_bf16_f32 v139, v214, v215
    v_mfma_f32_16x16x32_bf16 a[52:55], a[188:191], v[172:175], a[52:55]
    v_smfmac_f32_16x16x64_bf16 a[200:203], v[52:55], v[176:183], v50
    v_mfma_f32_16x16x32_bf16 v[212:215], a[224:227], v[112:115], v[204:207]
    v_exp_f32 v208, v208
    v_mfma_f32_16x16x32_bf16 v[212:215], a[228:231], v[116:119], v[212:215]
    v_exp_f32 v209, v209
    v_mfma_f32_16x16x32_bf16 v[212:215], a[232:235], v[120:123], v[212:215]
    v_exp_f32 v210, v210
    v_mfma_f32_16x16x32_bf16 v[212:215], a[236:239], v[124:127], v[212:215]
    v_exp_f32 v211, v211
    v_mfma_f32_16x16x32_bf16 a[56:59], a[184:187], v[176:179], a[56:59]
    ds_read_b64_tr_b16 a[168:169], v25 offset:49152
    v_cvt_pk_bf16_f32 v146, v208, v209
    v_mfma_f32_16x16x32_bf16 a[56:59], a[188:191], v[180:183], a[56:59]
    ds_read_b64_tr_b16 a[170:171], v25 offset:53248
    v_mfma_f32_16x16x32_bf16 a[60:63], a[184:187], v[184:187], a[60:63]
    ds_read_b128 a[224:227], v8 offset:12288
    v_cvt_pk_bf16_f32 v147, v210, v211
    v_mfma_f32_16x16x32_bf16 a[60:63], a[188:191], v[188:191], a[60:63]
    s_waitcnt lgkmcnt(3)
    buffer_load_dwordx4 v40, s[12:15], s41 offen offset:2048 lds
    v_mfma_f32_16x16x32_bf16 v[208:211], a[208:211], v[64:67], v[192:195]
    v_exp_f32 v212, v212
    v_mfma_f32_16x16x32_bf16 v[208:211], a[212:215], v[68:71], v[208:211]
    v_exp_f32 v213, v213
    v_mfma_f32_16x16x32_bf16 v[208:211], a[216:219], v[72:75], v[208:211]
    v_exp_f32 v214, v214
    v_mfma_f32_16x16x32_bf16 v[208:211], a[220:223], v[76:79], v[208:211]
    v_exp_f32 v215, v215
    v_mfma_f32_16x16x32_bf16 a[64:67], a[160:163], v[160:163], a[64:67]
    ds_read_b64_tr_b16 a[172:173], v25 offset:57344
    v_cvt_pk_bf16_f32 v154, v212, v213
    v_mfma_f32_16x16x32_bf16 a[64:67], a[164:167], v[164:167], a[64:67]
    ds_read_b64_tr_b16 a[174:175], v25 offset:61440
    v_mfma_f32_16x16x32_bf16 a[68:71], a[160:163], v[168:171], a[68:71]
    ds_read_b128 a[228:231], v9 offset:12288
    v_cvt_pk_bf16_f32 v155, v214, v215
    v_mfma_f32_16x16x32_bf16 a[68:71], a[164:167], v[172:175], a[68:71]
    v_smfmac_f32_16x16x64_bf16 a[204:207], v[52:55], v[184:191], v50
    v_mfma_f32_16x16x32_bf16 v[212:215], a[208:211], v[80:83], v[196:199]
    v_exp_f32 v208, v208
    v_mfma_f32_16x16x32_bf16 v[212:215], a[212:215], v[84:87], v[212:215]
    v_exp_f32 v209, v209
    v_mfma_f32_16x16x32_bf16 v[212:215], a[216:219], v[88:91], v[212:215]
    v_exp_f32 v210, v210
    v_mfma_f32_16x16x32_bf16 v[212:215], a[220:223], v[92:95], v[212:215]
    v_exp_f32 v211, v211
    v_mfma_f32_16x16x32_bf16 a[72:75], a[160:163], v[176:179], a[72:75]
    ds_read_b64_tr_b16 a[176:177], v26 offset:49152
    v_cvt_pk_bf16_f32 v132, v208, v209
    v_mfma_f32_16x16x32_bf16 a[72:75], a[164:167], v[180:183], a[72:75]
    ds_read_b64_tr_b16 a[178:179], v26 offset:53248
    v_mfma_f32_16x16x32_bf16 a[76:79], a[160:163], v[184:187], a[76:79]
    ds_read_b128 a[232:235], v10 offset:12288
    v_cvt_pk_bf16_f32 v133, v210, v211
    v_mfma_f32_16x16x32_bf16 a[76:79], a[164:167], v[188:191], a[76:79]
    s_waitcnt lgkmcnt(3)
    buffer_load_dwordx4 v41, s[12:15], s41 offen offset:3072 lds
    v_mfma_f32_16x16x32_bf16 v[208:211], a[208:211], v[96:99], v[200:203]
    v_exp_f32 v212, v212
    v_mfma_f32_16x16x32_bf16 v[208:211], a[212:215], v[100:103], v[208:211]
    s_add_u32 s41, s41, 16384
    v_exp_f32 v213, v213
    v_mfma_f32_16x16x32_bf16 v[208:211], a[216:219], v[104:107], v[208:211]
    v_exp_f32 v214, v214
    v_mfma_f32_16x16x32_bf16 v[208:211], a[220:223], v[108:111], v[208:211]
    v_exp_f32 v215, v215
    v_mfma_f32_16x16x32_bf16 a[80:83], a[168:171], v[160:163], a[80:83]
    ds_read_b64_tr_b16 a[180:181], v26 offset:57344
    v_cvt_pk_bf16_f32 v140, v212, v213
    v_mfma_f32_16x16x32_bf16 a[80:83], a[172:175], v[164:167], a[80:83]
    ds_read_b64_tr_b16 a[182:183], v26 offset:61440
    v_mfma_f32_16x16x32_bf16 a[84:87], a[168:171], v[168:171], a[84:87]
    ds_read_b128 a[236:239], v11 offset:12288
    v_cvt_pk_bf16_f32 v141, v214, v215
    v_mfma_f32_16x16x32_bf16 a[84:87], a[172:175], v[172:175], a[84:87]
    s_waitcnt vmcnt(9)
    s_barrier
    v_mfma_f32_16x16x32_bf16 v[212:215], a[208:211], v[112:115], v[204:207]
    v_exp_f32 v208, v208
    v_mfma_f32_16x16x32_bf16 v[212:215], a[212:215], v[116:119], v[212:215]
    s_add_u32 m0, s42, 49152
    v_exp_f32 v209, v209
    v_mfma_f32_16x16x32_bf16 v[212:215], a[216:219], v[120:123], v[212:215]
    v_exp_f32 v210, v210
    v_mfma_f32_16x16x32_bf16 v[212:215], a[220:223], v[124:127], v[212:215]
    v_exp_f32 v211, v211
    v_mfma_f32_16x16x32_bf16 a[88:91], a[168:171], v[176:179], a[88:91]
    ds_read_b64_tr_b16 a[184:185], v27 offset:49152
    v_cvt_pk_bf16_f32 v148, v208, v209
    v_mfma_f32_16x16x32_bf16 a[88:91], a[172:175], v[180:183], a[88:91]
    ds_read_b64_tr_b16 a[186:187], v27 offset:53248
    v_mfma_f32_16x16x32_bf16 a[92:95], a[168:171], v[184:187], a[92:95]
    ds_read_b128 a[208:211], v8 offset:16384
    v_cvt_pk_bf16_f32 v149, v210, v211
    v_mfma_f32_16x16x32_bf16 a[92:95], a[172:175], v[188:191], a[92:95]
    s_waitcnt lgkmcnt(3)
    buffer_load_dwordx4 v36, s[8:11], s40 offen lds
    v_mfma_f32_16x16x32_bf16 v[208:211], a[224:227], v[64:67], v[192:195]
    v_exp_f32 v212, v212
    v_mfma_f32_16x16x32_bf16 v[208:211], a[228:231], v[68:71], v[208:211]
    v_exp_f32 v213, v213
    v_mfma_f32_16x16x32_bf16 v[208:211], a[232:235], v[72:75], v[208:211]
    v_exp_f32 v214, v214
    v_mfma_f32_16x16x32_bf16 v[208:211], a[236:239], v[76:79], v[208:211]
    v_exp_f32 v215, v215
    v_mfma_f32_16x16x32_bf16 a[96:99], a[176:179], v[160:163], a[96:99]
    ds_read_b64_tr_b16 a[188:189], v27 offset:57344
    v_cvt_pk_bf16_f32 v156, v212, v213
    v_mfma_f32_16x16x32_bf16 a[96:99], a[180:183], v[164:167], a[96:99]
    ds_read_b64_tr_b16 a[190:191], v27 offset:61440
    v_mfma_f32_16x16x32_bf16 a[100:103], a[176:179], v[168:171], a[100:103]
    ds_read_b128 a[212:215], v9 offset:16384
    v_cvt_pk_bf16_f32 v157, v214, v215
    v_mfma_f32_16x16x32_bf16 a[100:103], a[180:183], v[172:175], a[100:103]
    v_mfma_f32_16x16x32_bf16 v[212:215], a[224:227], v[80:83], v[196:199]
    v_exp_f32 v208, v208
    v_mfma_f32_16x16x32_bf16 v[212:215], a[228:231], v[84:87], v[212:215]
    s_sub_u32 s39, s39, 36864
    v_exp_f32 v209, v209
    v_mfma_f32_16x16x32_bf16 v[212:215], a[232:235], v[88:91], v[212:215]
    s_sub_u32 s38, s38, 4608
    v_exp_f32 v210, v210
    v_mfma_f32_16x16x32_bf16 v[212:215], a[236:239], v[92:95], v[212:215]
    v_exp_f32 v211, v211
    v_mfma_f32_16x16x32_bf16 a[104:107], a[176:179], v[176:179], a[104:107]
    ds_read_b64_tr_b16 a[160:161], v20 offset:0
    v_cvt_pk_bf16_f32 v134, v208, v209
    v_mfma_f32_16x16x32_bf16 a[104:107], a[180:183], v[180:183], a[104:107]
    ds_read_b64_tr_b16 a[162:163], v20 offset:4096
    v_mfma_f32_16x16x32_bf16 a[108:111], a[176:179], v[184:187], a[108:111]
    ds_read_b128 a[216:219], v10 offset:16384
    v_cvt_pk_bf16_f32 v135, v210, v211
    v_mfma_f32_16x16x32_bf16 a[108:111], a[180:183], v[188:191], a[108:111]
    s_waitcnt lgkmcnt(3)
    buffer_load_dwordx4 v37, s[8:11], s40 offen offset:1024 lds
    v_mfma_f32_16x16x32_bf16 v[208:211], a[224:227], v[96:99], v[200:203]
    v_exp_f32 v212, v212
    v_mfma_f32_16x16x32_bf16 v[208:211], a[228:231], v[100:103], v[208:211]
    v_exp_f32 v213, v213
    v_mfma_f32_16x16x32_bf16 v[208:211], a[232:235], v[104:107], v[208:211]
    v_exp_f32 v214, v214
    v_mfma_f32_16x16x32_bf16 v[208:211], a[236:239], v[108:111], v[208:211]
    v_exp_f32 v215, v215
    v_mfma_f32_16x16x32_bf16 a[112:115], a[184:187], v[160:163], a[112:115]
    ds_read_b64_tr_b16 a[164:165], v20 offset:8192
    v_cvt_pk_bf16_f32 v142, v212, v213
    v_mfma_f32_16x16x32_bf16 a[112:115], a[188:191], v[164:167], a[112:115]
    ds_read_b64_tr_b16 a[166:167], v20 offset:12288
    v_mfma_f32_16x16x32_bf16 a[116:119], a[184:187], v[168:171], a[116:119]
    ds_read_b128 a[220:223], v11 offset:16384
    v_cvt_pk_bf16_f32 v143, v214, v215
    v_mfma_f32_16x16x32_bf16 a[116:119], a[188:191], v[172:175], a[116:119]
    v_mfma_f32_16x16x32_bf16 v[212:215], a[224:227], v[112:115], v[204:207]
    v_exp_f32 v208, v208
    v_mfma_f32_16x16x32_bf16 v[212:215], a[228:231], v[116:119], v[212:215]
    v_exp_f32 v209, v209
    v_mfma_f32_16x16x32_bf16 v[212:215], a[232:235], v[120:123], v[212:215]
    v_exp_f32 v210, v210
    v_mfma_f32_16x16x32_bf16 v[212:215], a[236:239], v[124:127], v[212:215]
    v_exp_f32 v211, v211
    v_mfma_f32_16x16x32_bf16 a[120:123], a[184:187], v[176:179], a[120:123]
    ds_read_b64_tr_b16 a[168:169], v21 offset:0
    v_cvt_pk_bf16_f32 v150, v208, v209
    v_mfma_f32_16x16x32_bf16 a[120:123], a[188:191], v[180:183], a[120:123]
    ds_read_b64_tr_b16 a[170:171], v21 offset:4096
    v_mfma_f32_16x16x32_bf16 a[124:127], a[184:187], v[184:187], a[124:127]
    ds_read_b128 a[224:227], v8 offset:20480
    v_cvt_pk_bf16_f32 v151, v210, v211
    v_mfma_f32_16x16x32_bf16 a[124:127], a[188:191], v[188:191], a[124:127]
    s_waitcnt lgkmcnt(3)
    buffer_load_dwordx4 v38, s[8:11], s40 offen offset:2048 lds
    s_sub_u32 s43, s43, 1
    s_cmp_lg_u32 s43, 0
    s_cbranch_scc1 Lattn_loop
    v_mfma_f32_16x16x32_bf16 v[208:211], a[208:211], v[64:67], v[192:195]
    v_exp_f32 v212, v212
    v_mfma_f32_16x16x32_bf16 v[208:211], a[212:215], v[68:71], v[208:211]
    v_exp_f32 v213, v213
    v_mfma_f32_16x16x32_bf16 v[208:211], a[216:219], v[72:75], v[208:211]
    v_exp_f32 v214, v214
    v_mfma_f32_16x16x32_bf16 v[208:211], a[220:223], v[76:79], v[208:211]
    v_exp_f32 v215, v215
    v_mfma_f32_16x16x32_bf16 a[0:3], a[160:163], v[128:131], a[0:3]
    ds_read_b64_tr_b16 a[172:173], v21 offset:8192
    v_cvt_pk_bf16_f32 v158, v212, v213
    v_mfma_f32_16x16x32_bf16 a[0:3], a[164:167], v[132:135], a[0:3]
    ds_read_b64_tr_b16 a[174:175], v21 offset:12288
    v_mfma_f32_16x16x32_bf16 a[4:7], a[160:163], v[136:139], a[4:7]
    ds_read_b128 a[228:231], v9 offset:20480
    v_cvt_pk_bf16_f32 v159, v214, v215
    v_mfma_f32_16x16x32_bf16 a[4:7], a[164:167], v[140:143], a[4:7]
    v_mfma_f32_16x16x32_bf16 v[212:215], a[208:211], v[80:83], v[196:199]
    v_exp_f32 v208, v208
    v_mfma_f32_16x16x32_bf16 v[212:215], a[212:215], v[84:87], v[212:215]
    v_exp_f32 v209, v209
    v_mfma_f32_16x16x32_bf16 v[212:215], a[216:219], v[88:91], v[212:215]
    v_exp_f32 v210, v210
    v_mfma_f32_16x16x32_bf16 v[212:215], a[220:223], v[92:95], v[212:215]
    v_exp_f32 v211, v211
    v_mfma_f32_16x16x32_bf16 a[8:11], a[160:163], v[144:147], a[8:11]
    ds_read_b64_tr_b16 a[176:177], v22 offset:0
    v_cvt_pk_bf16_f32 v160, v208, v209
    v_mfma_f32_16x16x32_bf16 a[8:11], a[164:167], v[148:151], a[8:11]
    ds_read_b64_tr_b16 a[178:179], v22 offset:4096
    v_mfma_f32_16x16x32_bf16 a[12:15], a[160:163], v[152:155], a[12:15]
    ds_read_b128 a[232:235], v10 offset:20480
    v_cvt_pk_bf16_f32 v161, v210, v211
    v_mfma_f32_16x16x32_bf16 a[12:15], a[164:167], v[156:159], a[12:15]
    s_waitcnt lgkmcnt(3)
    buffer_load_dwordx4 v39, s[8:11], s40 offen offset:3072 lds
    v_mfma_f32_16x16x32_bf16 v[208:211], a[208:211], v[96:99], v[200:203]
    v_exp_f32 v212, v212
    v_mfma_f32_16x16x32_bf16 v[208:211], a[212:215], v[100:103], v[208:211]
    s_add_u32 s40, s40, 16384
    v_exp_f32 v213, v213
    v_mfma_f32_16x16x32_bf16 v[208:211], a[216:219], v[104:107], v[208:211]
    v_exp_f32 v214, v214
    v_mfma_f32_16x16x32_bf16 v[208:211], a[220:223], v[108:111], v[208:211]
    v_exp_f32 v215, v215
    v_mfma_f32_16x16x32_bf16 a[16:19], a[168:171], v[128:131], a[16:19]
    ds_read_b64_tr_b16 a[180:181], v22 offset:8192
    v_cvt_pk_bf16_f32 v168, v212, v213
    v_mfma_f32_16x16x32_bf16 a[16:19], a[172:175], v[132:135], a[16:19]
    ds_read_b64_tr_b16 a[182:183], v22 offset:12288
    v_mfma_f32_16x16x32_bf16 a[20:23], a[168:171], v[136:139], a[20:23]
    ds_read_b128 a[236:239], v11 offset:20480
    v_cvt_pk_bf16_f32 v169, v214, v215
    v_mfma_f32_16x16x32_bf16 a[20:23], a[172:175], v[140:143], a[20:23]
    v_smfmac_f32_16x16x64_bf16 a[192:195], v[52:55], v[128:135], v50
    v_mfma_f32_16x16x32_bf16 v[212:215], a[208:211], v[112:115], v[204:207]
    v_exp_f32 v208, v208
    v_mfma_f32_16x16x32_bf16 v[212:215], a[212:215], v[116:119], v[212:215]
    s_add_u32 m0, s42, 98304
    v_exp_f32 v209, v209
    v_mfma_f32_16x16x32_bf16 v[212:215], a[216:219], v[120:123], v[212:215]
    v_exp_f32 v210, v210
    v_mfma_f32_16x16x32_bf16 v[212:215], a[220:223], v[124:127], v[212:215]
    v_exp_f32 v211, v211
    v_mfma_f32_16x16x32_bf16 a[24:27], a[168:171], v[144:147], a[24:27]
    ds_read_b64_tr_b16 a[184:185], v23 offset:0
    v_cvt_pk_bf16_f32 v176, v208, v209
    v_mfma_f32_16x16x32_bf16 a[24:27], a[172:175], v[148:151], a[24:27]
    ds_read_b64_tr_b16 a[186:187], v23 offset:4096
    v_mfma_f32_16x16x32_bf16 a[28:31], a[168:171], v[152:155], a[28:31]
    ds_read_b128 a[208:211], v8 offset:24576
    v_cvt_pk_bf16_f32 v177, v210, v211
    v_mfma_f32_16x16x32_bf16 a[28:31], a[172:175], v[156:159], a[28:31]
    s_waitcnt lgkmcnt(3)
    buffer_load_dwordx4 v40, s[12:15], s41 offen lds
    v_mfma_f32_16x16x32_bf16 v[208:211], a[224:227], v[64:67], v[192:195]
    v_exp_f32 v212, v212
    v_mfma_f32_16x16x32_bf16 v[208:211], a[228:231], v[68:71], v[208:211]
    v_exp_f32 v213, v213
    v_mfma_f32_16x16x32_bf16 v[208:211], a[232:235], v[72:75], v[208:211]
    v_exp_f32 v214, v214
    v_mfma_f32_16x16x32_bf16 v[208:211], a[236:239], v[76:79], v[208:211]
    v_exp_f32 v215, v215
    v_mfma_f32_16x16x32_bf16 a[32:35], a[176:179], v[128:131], a[32:35]
    ds_read_b64_tr_b16 a[188:189], v23 offset:8192
    v_cvt_pk_bf16_f32 v184, v212, v213
    v_mfma_f32_16x16x32_bf16 a[32:35], a[180:183], v[132:135], a[32:35]
    ds_read_b64_tr_b16 a[190:191], v23 offset:12288
    v_mfma_f32_16x16x32_bf16 a[36:39], a[176:179], v[136:139], a[36:39]
    ds_read_b128 a[212:215], v9 offset:24576
    v_cvt_pk_bf16_f32 v185, v214, v215
    v_mfma_f32_16x16x32_bf16 a[36:39], a[180:183], v[140:143], a[36:39]
    v_smfmac_f32_16x16x64_bf16 a[196:199], v[52:55], v[136:143], v50
    v_mfma_f32_16x16x32_bf16 v[212:215], a[224:227], v[80:83], v[196:199]
    v_exp_f32 v208, v208
    v_mfma_f32_16x16x32_bf16 v[212:215], a[228:231], v[84:87], v[212:215]
    v_exp_f32 v209, v209
    v_mfma_f32_16x16x32_bf16 v[212:215], a[232:235], v[88:91], v[212:215]
    v_exp_f32 v210, v210
    v_mfma_f32_16x16x32_bf16 v[212:215], a[236:239], v[92:95], v[212:215]
    v_exp_f32 v211, v211
    v_mfma_f32_16x16x32_bf16 a[40:43], a[176:179], v[144:147], a[40:43]
    ds_read_b64_tr_b16 a[160:161], v24 offset:0
    v_cvt_pk_bf16_f32 v162, v208, v209
    v_mfma_f32_16x16x32_bf16 a[40:43], a[180:183], v[148:151], a[40:43]
    ds_read_b64_tr_b16 a[162:163], v24 offset:4096
    v_mfma_f32_16x16x32_bf16 a[44:47], a[176:179], v[152:155], a[44:47]
    ds_read_b128 a[216:219], v10 offset:24576
    v_cvt_pk_bf16_f32 v163, v210, v211
    v_mfma_f32_16x16x32_bf16 a[44:47], a[180:183], v[156:159], a[44:47]
    s_waitcnt lgkmcnt(3)
    buffer_load_dwordx4 v41, s[12:15], s41 offen offset:1024 lds
    v_mfma_f32_16x16x32_bf16 v[208:211], a[224:227], v[96:99], v[200:203]
    v_exp_f32 v212, v212
    v_mfma_f32_16x16x32_bf16 v[208:211], a[228:231], v[100:103], v[208:211]
    v_exp_f32 v213, v213
    v_mfma_f32_16x16x32_bf16 v[208:211], a[232:235], v[104:107], v[208:211]
    v_exp_f32 v214, v214
    v_mfma_f32_16x16x32_bf16 v[208:211], a[236:239], v[108:111], v[208:211]
    v_exp_f32 v215, v215
    v_mfma_f32_16x16x32_bf16 a[48:51], a[184:187], v[128:131], a[48:51]
    ds_read_b64_tr_b16 a[164:165], v24 offset:8192
    v_cvt_pk_bf16_f32 v170, v212, v213
    v_mfma_f32_16x16x32_bf16 a[48:51], a[188:191], v[132:135], a[48:51]
    ds_read_b64_tr_b16 a[166:167], v24 offset:12288
    v_mfma_f32_16x16x32_bf16 a[52:55], a[184:187], v[136:139], a[52:55]
    ds_read_b128 a[220:223], v11 offset:24576
    v_cvt_pk_bf16_f32 v171, v214, v215
    v_mfma_f32_16x16x32_bf16 a[52:55], a[188:191], v[140:143], a[52:55]
    v_smfmac_f32_16x16x64_bf16 a[200:203], v[52:55], v[144:151], v50
    v_mfma_f32_16x16x32_bf16 v[212:215], a[224:227], v[112:115], v[204:207]
    v_exp_f32 v208, v208
    v_mfma_f32_16x16x32_bf16 v[212:215], a[228:231], v[116:119], v[212:215]
    v_exp_f32 v209, v209
    v_mfma_f32_16x16x32_bf16 v[212:215], a[232:235], v[120:123], v[212:215]
    v_exp_f32 v210, v210
    v_mfma_f32_16x16x32_bf16 v[212:215], a[236:239], v[124:127], v[212:215]
    v_exp_f32 v211, v211
    v_mfma_f32_16x16x32_bf16 a[56:59], a[184:187], v[144:147], a[56:59]
    ds_read_b64_tr_b16 a[168:169], v25 offset:0
    v_cvt_pk_bf16_f32 v178, v208, v209
    v_mfma_f32_16x16x32_bf16 a[56:59], a[188:191], v[148:151], a[56:59]
    ds_read_b64_tr_b16 a[170:171], v25 offset:4096
    v_mfma_f32_16x16x32_bf16 a[60:63], a[184:187], v[152:155], a[60:63]
    ds_read_b128 a[224:227], v8 offset:28672
    v_cvt_pk_bf16_f32 v179, v210, v211
    v_mfma_f32_16x16x32_bf16 a[60:63], a[188:191], v[156:159], a[60:63]
    s_waitcnt lgkmcnt(3)
    buffer_load_dwordx4 v40, s[12:15], s41 offen offset:2048 lds
    v_mfma_f32_16x16x32_bf16 v[208:211], a[208:211], v[64:67], v[192:195]
    v_exp_f32 v212, v212
    v_mfma_f32_16x16x32_bf16 v[208:211], a[212:215], v[68:71], v[208:211]
    v_exp_f32 v213, v213
    v_mfma_f32_16x16x32_bf16 v[208:211], a[216:219], v[72:75], v[208:211]
    v_exp_f32 v214, v214
    v_mfma_f32_16x16x32_bf16 v[208:211], a[220:223], v[76:79], v[208:211]
    v_exp_f32 v215, v215
    v_mfma_f32_16x16x32_bf16 a[64:67], a[160:163], v[128:131], a[64:67]
    ds_read_b64_tr_b16 a[172:173], v25 offset:8192
    v_cvt_pk_bf16_f32 v186, v212, v213
    v_mfma_f32_16x16x32_bf16 a[64:67], a[164:167], v[132:135], a[64:67]
    ds_read_b64_tr_b16 a[174:175], v25 offset:12288
    v_mfma_f32_16x16x32_bf16 a[68:71], a[160:163], v[136:139], a[68:71]
    ds_read_b128 a[228:231], v9 offset:28672
    v_cvt_pk_bf16_f32 v187, v214, v215
    v_mfma_f32_16x16x32_bf16 a[68:71], a[164:167], v[140:143], a[68:71]
    v_smfmac_f32_16x16x64_bf16 a[204:207], v[52:55], v[152:159], v50
    v_mfma_f32_16x16x32_bf16 v[212:215], a[208:211], v[80:83], v[196:199]
    v_exp_f32 v208, v208
    v_mfma_f32_16x16x32_bf16 v[212:215], a[212:215], v[84:87], v[212:215]
    v_exp_f32 v209, v209
    v_mfma_f32_16x16x32_bf16 v[212:215], a[216:219], v[88:91], v[212:215]
    v_exp_f32 v210, v210
    v_mfma_f32_16x16x32_bf16 v[212:215], a[220:223], v[92:95], v[212:215]
    v_exp_f32 v211, v211
    v_mfma_f32_16x16x32_bf16 a[72:75], a[160:163], v[144:147], a[72:75]
    ds_read_b64_tr_b16 a[176:177], v26 offset:0
    v_cvt_pk_bf16_f32 v164, v208, v209
    v_mfma_f32_16x16x32_bf16 a[72:75], a[164:167], v[148:151], a[72:75]
    ds_read_b64_tr_b16 a[178:179], v26 offset:4096
    v_mfma_f32_16x16x32_bf16 a[76:79], a[160:163], v[152:155], a[76:79]
    ds_read_b128 a[232:235], v10 offset:28672
    v_cvt_pk_bf16_f32 v165, v210, v211
    v_mfma_f32_16x16x32_bf16 a[76:79], a[164:167], v[156:159], a[76:79]
    s_waitcnt lgkmcnt(3)
    buffer_load_dwordx4 v41, s[12:15], s41 offen offset:3072 lds
    v_mfma_f32_16x16x32_bf16 v[208:211], a[208:211], v[96:99], v[200:203]
    v_exp_f32 v212, v212
    v_mfma_f32_16x16x32_bf16 v[208:211], a[212:215], v[100:103], v[208:211]
    s_add_u32 s41, s41, 16384
    v_exp_f32 v213, v213
    v_mfma_f32_16x16x32_bf16 v[208:211], a[216:219], v[104:107], v[208:211]
    v_exp_f32 v214, v214
    v_mfma_f32_16x16x32_bf16 v[208:211], a[220:223], v[108:111], v[208:211]
    v_exp_f32 v215, v215
    v_mfma_f32_16x16x32_bf16 a[80:83], a[168:171], v[128:131], a[80:83]
    ds_read_b64_tr_b16 a[180:181], v26 offset:8192
    v_cvt_pk_bf16_f32 v172, v212, v213
    v_mfma_f32_16x16x32_bf16 a[80:83], a[172:175], v[132:135], a[80:83]
    ds_read_b64_tr_b16 a[182:183], v26 offset:12288
    v_mfma_f32_16x16x32_bf16 a[84:87], a[168:171], v[136:139], a[84:87]
    ds_read_b128 a[236:239], v11 offset:28672
    v_cvt_pk_bf16_f32 v173, v214, v215
    v_mfma_f32_16x16x32_bf16 a[84:87], a[172:175], v[140:143], a[84:87]
    s_waitcnt vmcnt(8)
    s_barrier
    v_mfma_f32_16x16x32_bf16 v[212:215], a[208:211], v[112:115], v[204:207]
    v_exp_f32 v208, v208
    v_mfma_f32_16x16x32_bf16 v[212:215], a[212:215], v[116:119], v[212:215]
    s_add_u32 s49, s45, 0
    v_exp_f32 v209, v209
    v_mfma_f32_16x16x32_bf16 v[212:215], a[216:219], v[120:123], v[212:215]
    s_add_u32 m0, s42, 131072
    v_exp_f32 v210, v210
    v_mfma_f32_16x16x32_bf16 v[212:215], a[220:223], v[124:127], v[212:215]
    v_exp_f32 v211, v211
    v_mfma_f32_16x16x32_bf16 a[88:91], a[168:171], v[144:147], a[88:91]
    ds_read_b64_tr_b16 a[184:185], v27 offset:0
    v_cvt_pk_bf16_f32 v180, v208, v209
    v_mfma_f32_16x16x32_bf16 a[88:91], a[172:175], v[148:151], a[88:91]
    ds_read_b64_tr_b16 a[186:187], v27 offset:4096
    v_mfma_f32_16x16x32_bf16 a[92:95], a[168:171], v[152:155], a[92:95]
    ds_read_b128 a[208:211], v8 offset:32768
    v_cvt_pk_bf16_f32 v181, v210, v211
    v_mfma_f32_16x16x32_bf16 a[92:95], a[172:175], v[156:159], a[92:95]
    s_waitcnt lgkmcnt(3)
    buffer_load_dwordx4 v46, s[20:23], s49 offen lds
    v_mfma_f32_16x16x32_bf16 v[208:211], a[224:227], v[64:67], v[192:195]
    v_exp_f32 v212, v212
    v_mfma_f32_16x16x32_bf16 v[208:211], a[228:231], v[68:71], v[208:211]
    v_exp_f32 v213, v213
    v_mfma_f32_16x16x32_bf16 v[208:211], a[232:235], v[72:75], v[208:211]
    v_exp_f32 v214, v214
    v_mfma_f32_16x16x32_bf16 v[208:211], a[236:239], v[76:79], v[208:211]
    v_exp_f32 v215, v215
    v_mfma_f32_16x16x32_bf16 a[96:99], a[176:179], v[128:131], a[96:99]
    ds_read_b64_tr_b16 a[188:189], v27 offset:8192
    v_cvt_pk_bf16_f32 v188, v212, v213
    v_mfma_f32_16x16x32_bf16 a[96:99], a[180:183], v[132:135], a[96:99]
    ds_read_b64_tr_b16 a[190:191], v27 offset:12288
    v_mfma_f32_16x16x32_bf16 a[100:103], a[176:179], v[136:139], a[100:103]
    ds_read_b128 a[212:215], v9 offset:32768
    v_cvt_pk_bf16_f32 v189, v214, v215
    v_mfma_f32_16x16x32_bf16 a[100:103], a[180:183], v[140:143], a[100:103]
    v_mfma_f32_16x16x32_bf16 v[212:215], a[224:227], v[80:83], v[196:199]
    v_exp_f32 v208, v208
    v_mfma_f32_16x16x32_bf16 v[212:215], a[228:231], v[84:87], v[212:215]
    v_exp_f32 v209, v209
    v_mfma_f32_16x16x32_bf16 v[212:215], a[232:235], v[88:91], v[212:215]
    v_exp_f32 v210, v210
    v_mfma_f32_16x16x32_bf16 v[212:215], a[236:239], v[92:95], v[212:215]
    v_exp_f32 v211, v211
    v_mfma_f32_16x16x32_bf16 a[104:107], a[176:179], v[144:147], a[104:107]
    ds_read_b64_tr_b16 a[160:161], v20 offset:16384
    v_cvt_pk_bf16_f32 v166, v208, v209
    v_mfma_f32_16x16x32_bf16 a[104:107], a[180:183], v[148:151], a[104:107]
    ds_read_b64_tr_b16 a[162:163], v20 offset:20480
    v_mfma_f32_16x16x32_bf16 a[108:111], a[176:179], v[152:155], a[108:111]
    ds_read_b128 a[216:219], v10 offset:32768
    v_cvt_pk_bf16_f32 v167, v210, v211
    v_mfma_f32_16x16x32_bf16 a[108:111], a[180:183], v[156:159], a[108:111]
    s_waitcnt lgkmcnt(3)
    buffer_load_dwordx4 v47, s[20:23], s49 offen offset:1024 lds
    v_mfma_f32_16x16x32_bf16 v[208:211], a[224:227], v[96:99], v[200:203]
    v_exp_f32 v212, v212
    v_mfma_f32_16x16x32_bf16 v[208:211], a[228:231], v[100:103], v[208:211]
    v_exp_f32 v213, v213
    v_mfma_f32_16x16x32_bf16 v[208:211], a[232:235], v[104:107], v[208:211]
    v_exp_f32 v214, v214
    v_mfma_f32_16x16x32_bf16 v[208:211], a[236:239], v[108:111], v[208:211]
    v_exp_f32 v215, v215
    v_mfma_f32_16x16x32_bf16 a[112:115], a[184:187], v[128:131], a[112:115]
    ds_read_b64_tr_b16 a[164:165], v20 offset:24576
    v_cvt_pk_bf16_f32 v174, v212, v213
    v_mfma_f32_16x16x32_bf16 a[112:115], a[188:191], v[132:135], a[112:115]
    ds_read_b64_tr_b16 a[166:167], v20 offset:28672
    v_mfma_f32_16x16x32_bf16 a[116:119], a[184:187], v[136:139], a[116:119]
    ds_read_b128 a[220:223], v11 offset:32768
    v_cvt_pk_bf16_f32 v175, v214, v215
    v_mfma_f32_16x16x32_bf16 a[116:119], a[188:191], v[140:143], a[116:119]
    v_mfma_f32_16x16x32_bf16 v[212:215], a[224:227], v[112:115], v[204:207]
    v_exp_f32 v208, v208
    v_mfma_f32_16x16x32_bf16 v[212:215], a[228:231], v[116:119], v[212:215]
    v_exp_f32 v209, v209
    v_mfma_f32_16x16x32_bf16 v[212:215], a[232:235], v[120:123], v[212:215]
    v_exp_f32 v210, v210
    v_mfma_f32_16x16x32_bf16 v[212:215], a[236:239], v[124:127], v[212:215]
    v_exp_f32 v211, v211
    v_mfma_f32_16x16x32_bf16 a[120:123], a[184:187], v[144:147], a[120:123]
    ds_read_b64_tr_b16 a[168:169], v21 offset:16384
    v_cvt_pk_bf16_f32 v182, v208, v209
    v_mfma_f32_16x16x32_bf16 a[120:123], a[188:191], v[148:151], a[120:123]
    ds_read_b64_tr_b16 a[170:171], v21 offset:20480
    v_mfma_f32_16x16x32_bf16 a[124:127], a[184:187], v[152:155], a[124:127]
    ds_read_b128 a[224:227], v8 offset:36864
    v_cvt_pk_bf16_f32 v183, v210, v211
    v_mfma_f32_16x16x32_bf16 a[124:127], a[188:191], v[156:159], a[124:127]
    s_waitcnt lgkmcnt(3)
    buffer_load_dwordx4 v48, s[20:23], s49 offen offset:2048 lds
    v_mfma_f32_16x16x32_bf16 v[208:211], a[208:211], v[64:67], v[192:195]
    v_exp_f32 v212, v212
    v_mfma_f32_16x16x32_bf16 v[208:211], a[212:215], v[68:71], v[208:211]
    v_exp_f32 v213, v213
    v_mfma_f32_16x16x32_bf16 v[208:211], a[216:219], v[72:75], v[208:211]
    v_exp_f32 v214, v214
    v_mfma_f32_16x16x32_bf16 v[208:211], a[220:223], v[76:79], v[208:211]
    v_exp_f32 v215, v215
    v_mfma_f32_16x16x32_bf16 a[0:3], a[160:163], v[160:163], a[0:3]
    ds_read_b64_tr_b16 a[172:173], v21 offset:24576
    v_cvt_pk_bf16_f32 v190, v212, v213
    v_mfma_f32_16x16x32_bf16 a[0:3], a[164:167], v[164:167], a[0:3]
    ds_read_b64_tr_b16 a[174:175], v21 offset:28672
    v_mfma_f32_16x16x32_bf16 a[4:7], a[160:163], v[168:171], a[4:7]
    ds_read_b128 a[228:231], v9 offset:36864
    v_cvt_pk_bf16_f32 v191, v214, v215
    v_mfma_f32_16x16x32_bf16 a[4:7], a[164:167], v[172:175], a[4:7]
    v_mfma_f32_16x16x32_bf16 v[212:215], a[208:211], v[80:83], v[196:199]
    v_exp_f32 v208, v208
    v_mfma_f32_16x16x32_bf16 v[212:215], a[212:215], v[84:87], v[212:215]
    v_exp_f32 v209, v209
    v_mfma_f32_16x16x32_bf16 v[212:215], a[216:219], v[88:91], v[212:215]
    v_exp_f32 v210, v210
    v_mfma_f32_16x16x32_bf16 v[212:215], a[220:223], v[92:95], v[212:215]
    v_exp_f32 v211, v211
    v_mfma_f32_16x16x32_bf16 a[8:11], a[160:163], v[176:179], a[8:11]
    ds_read_b64_tr_b16 a[176:177], v22 offset:16384
    v_cvt_pk_bf16_f32 v128, v208, v209
    v_mfma_f32_16x16x32_bf16 a[8:11], a[164:167], v[180:183], a[8:11]
    ds_read_b64_tr_b16 a[178:179], v22 offset:20480
    v_mfma_f32_16x16x32_bf16 a[12:15], a[160:163], v[184:187], a[12:15]
    ds_read_b128 a[232:235], v10 offset:36864
    v_cvt_pk_bf16_f32 v129, v210, v211
    v_mfma_f32_16x16x32_bf16 a[12:15], a[164:167], v[188:191], a[12:15]
    s_waitcnt lgkmcnt(3)
    buffer_load_dwordx4 v49, s[20:23], s49 offen offset:3072 lds
    v_mfma_f32_16x16x32_bf16 v[208:211], a[208:211], v[96:99], v[200:203]
    v_exp_f32 v212, v212
    v_mfma_f32_16x16x32_bf16 v[208:211], a[212:215], v[100:103], v[208:211]
    v_exp_f32 v213, v213
    v_mfma_f32_16x16x32_bf16 v[208:211], a[216:219], v[104:107], v[208:211]
    v_exp_f32 v214, v214
    v_mfma_f32_16x16x32_bf16 v[208:211], a[220:223], v[108:111], v[208:211]
    v_exp_f32 v215, v215
    v_mfma_f32_16x16x32_bf16 a[16:19], a[168:171], v[160:163], a[16:19]
    ds_read_b64_tr_b16 a[180:181], v22 offset:24576
    v_cvt_pk_bf16_f32 v136, v212, v213
    v_mfma_f32_16x16x32_bf16 a[16:19], a[172:175], v[164:167], a[16:19]
    ds_read_b64_tr_b16 a[182:183], v22 offset:28672
    v_mfma_f32_16x16x32_bf16 a[20:23], a[168:171], v[168:171], a[20:23]
    ds_read_b128 a[236:239], v11 offset:36864
    v_cvt_pk_bf16_f32 v137, v214, v215
    v_mfma_f32_16x16x32_bf16 a[20:23], a[172:175], v[172:175], a[20:23]
    v_smfmac_f32_16x16x64_bf16 a[192:195], v[52:55], v[160:167], v50
    v_mfma_f32_16x16x32_bf16 v[212:215], a[208:211], v[112:115], v[204:207]
    v_exp_f32 v208, v208
    v_mfma_f32_16x16x32_bf16 v[212:215], a[212:215], v[116:119], v[212:215]
    s_add_u32 m0, s42, 114688
    v_exp_f32 v209, v209
    v_mfma_f32_16x16x32_bf16 v[212:215], a[216:219], v[120:123], v[212:215]
    v_exp_f32 v210, v210
    v_mfma_f32_16x16x32_bf16 v[212:215], a[220:223], v[124:127], v[212:215]
    v_exp_f32 v211, v211
    v_mfma_f32_16x16x32_bf16 a[24:27], a[168:171], v[176:179], a[24:27]
    ds_read_b64_tr_b16 a[184:185], v23 offset:16384
    v_cvt_pk_bf16_f32 v144, v208, v209
    v_mfma_f32_16x16x32_bf16 a[24:27], a[172:175], v[180:183], a[24:27]
    ds_read_b64_tr_b16 a[186:187], v23 offset:20480
    v_mfma_f32_16x16x32_bf16 a[28:31], a[168:171], v[184:187], a[28:31]
    ds_read_b128 a[208:211], v8 offset:40960
    v_cvt_pk_bf16_f32 v145, v210, v211
    v_mfma_f32_16x16x32_bf16 a[28:31], a[172:175], v[188:191], a[28:31]
    s_waitcnt lgkmcnt(3)
    buffer_load_dwordx4 v40, s[12:15], s41 offen lds
    v_mfma_f32_16x16x32_bf16 v[208:211], a[224:227], v[64:67], v[192:195]
    v_exp_f32 v212, v212
    v_mfma_f32_16x16x32_bf16 v[208:211], a[228:231], v[68:71], v[208:211]
    v_exp_f32 v213, v213
    v_mfma_f32_16x16x32_bf16 v[208:211], a[232:235], v[72:75], v[208:211]
    v_exp_f32 v214, v214
    v_mfma_f32_16x16x32_bf16 v[208:211], a[236:239], v[76:79], v[208:211]
    v_exp_f32 v215, v215
    v_mfma_f32_16x16x32_bf16 a[32:35], a[176:179], v[160:163], a[32:35]
    ds_read_b64_tr_b16 a[188:189], v23 offset:24576
    v_cvt_pk_bf16_f32 v152, v212, v213
    v_mfma_f32_16x16x32_bf16 a[32:35], a[180:183], v[164:167], a[32:35]
    ds_read_b64_tr_b16 a[190:191], v23 offset:28672
    v_mfma_f32_16x16x32_bf16 a[36:39], a[176:179], v[168:171], a[36:39]
    ds_read_b128 a[212:215], v9 offset:40960
    v_cvt_pk_bf16_f32 v153, v214, v215
    v_mfma_f32_16x16x32_bf16 a[36:39], a[180:183], v[172:175], a[36:39]
    v_smfmac_f32_16x16x64_bf16 a[196:199], v[52:55], v[168:175], v50
    v_mfma_f32_16x16x32_bf16 v[212:215], a[224:227], v[80:83], v[196:199]
    v_exp_f32 v208, v208
    v_mfma_f32_16x16x32_bf16 v[212:215], a[228:231], v[84:87], v[212:215]
    v_exp_f32 v209, v209
    v_mfma_f32_16x16x32_bf16 v[212:215], a[232:235], v[88:91], v[212:215]
    v_exp_f32 v210, v210
    v_mfma_f32_16x16x32_bf16 v[212:215], a[236:239], v[92:95], v[212:215]
    v_exp_f32 v211, v211
    v_mfma_f32_16x16x32_bf16 a[40:43], a[176:179], v[176:179], a[40:43]
    ds_read_b64_tr_b16 a[160:161], v24 offset:16384
    v_cvt_pk_bf16_f32 v130, v208, v209
    v_mfma_f32_16x16x32_bf16 a[40:43], a[180:183], v[180:183], a[40:43]
    ds_read_b64_tr_b16 a[162:163], v24 offset:20480
    v_mfma_f32_16x16x32_bf16 a[44:47], a[176:179], v[184:187], a[44:47]
    ds_read_b128 a[216:219], v10 offset:40960
    v_cvt_pk_bf16_f32 v131, v210, v211
    v_mfma_f32_16x16x32_bf16 a[44:47], a[180:183], v[188:191], a[44:47]
    s_waitcnt lgkmcnt(3)
    buffer_load_dwordx4 v41, s[12:15], s41 offen offset:1024 lds
    v_mfma_f32_16x16x32_bf16 v[208:211], a[224:227], v[96:99], v[200:203]
    v_exp_f32 v212, v212
    v_mfma_f32_16x16x32_bf16 v[208:211], a[228:231], v[100:103], v[208:211]
    v_exp_f32 v213, v213
    v_mfma_f32_16x16x32_bf16 v[208:211], a[232:235], v[104:107], v[208:211]
    v_exp_f32 v214, v214
    v_mfma_f32_16x16x32_bf16 v[208:211], a[236:239], v[108:111], v[208:211]
    v_exp_f32 v215, v215
    v_mfma_f32_16x16x32_bf16 a[48:51], a[184:187], v[160:163], a[48:51]
    ds_read_b64_tr_b16 a[164:165], v24 offset:24576
    v_cvt_pk_bf16_f32 v138, v212, v213
    v_mfma_f32_16x16x32_bf16 a[48:51], a[188:191], v[164:167], a[48:51]
    ds_read_b64_tr_b16 a[166:167], v24 offset:28672
    v_mfma_f32_16x16x32_bf16 a[52:55], a[184:187], v[168:171], a[52:55]
    ds_read_b128 a[220:223], v11 offset:40960
    v_cvt_pk_bf16_f32 v139, v214, v215
    v_mfma_f32_16x16x32_bf16 a[52:55], a[188:191], v[172:175], a[52:55]
    v_smfmac_f32_16x16x64_bf16 a[200:203], v[52:55], v[176:183], v50
    v_mfma_f32_16x16x32_bf16 v[212:215], a[224:227], v[112:115], v[204:207]
    v_exp_f32 v208, v208
    v_mfma_f32_16x16x32_bf16 v[212:215], a[228:231], v[116:119], v[212:215]
    v_exp_f32 v209, v209
    v_mfma_f32_16x16x32_bf16 v[212:215], a[232:235], v[120:123], v[212:215]
    v_exp_f32 v210, v210
    v_mfma_f32_16x16x32_bf16 v[212:215], a[236:239], v[124:127], v[212:215]
    v_exp_f32 v211, v211
    v_mfma_f32_16x16x32_bf16 a[56:59], a[184:187], v[176:179], a[56:59]
    ds_read_b64_tr_b16 a[168:169], v25 offset:16384
    v_cvt_pk_bf16_f32 v146, v208, v209
    v_mfma_f32_16x16x32_bf16 a[56:59], a[188:191], v[180:183], a[56:59]
    ds_read_b64_tr_b16 a[170:171], v25 offset:20480
    v_mfma_f32_16x16x32_bf16 a[60:63], a[184:187], v[184:187], a[60:63]
    ds_read_b128 a[224:227], v8 offset:45056
    v_cvt_pk_bf16_f32 v147, v210, v211
    v_mfma_f32_16x16x32_bf16 a[60:63], a[188:191], v[188:191], a[60:63]
    s_waitcnt lgkmcnt(3)
    buffer_load_dwordx4 v40, s[12:15], s41 offen offset:2048 lds
    v_mfma_f32_16x16x32_bf16 v[208:211], a[208:211], v[64:67], v[192:195]
    v_exp_f32 v212, v212
    v_mfma_f32_16x16x32_bf16 v[208:211], a[212:215], v[68:71], v[208:211]
    v_exp_f32 v213, v213
    v_mfma_f32_16x16x32_bf16 v[208:211], a[216:219], v[72:75], v[208:211]
    v_exp_f32 v214, v214
    v_mfma_f32_16x16x32_bf16 v[208:211], a[220:223], v[76:79], v[208:211]
    v_exp_f32 v215, v215
    v_mfma_f32_16x16x32_bf16 a[64:67], a[160:163], v[160:163], a[64:67]
    ds_read_b64_tr_b16 a[172:173], v25 offset:24576
    v_cvt_pk_bf16_f32 v154, v212, v213
    v_mfma_f32_16x16x32_bf16 a[64:67], a[164:167], v[164:167], a[64:67]
    ds_read_b64_tr_b16 a[174:175], v25 offset:28672
    v_mfma_f32_16x16x32_bf16 a[68:71], a[160:163], v[168:171], a[68:71]
    ds_read_b128 a[228:231], v9 offset:45056
    v_cvt_pk_bf16_f32 v155, v214, v215
    v_mfma_f32_16x16x32_bf16 a[68:71], a[164:167], v[172:175], a[68:71]
    v_smfmac_f32_16x16x64_bf16 a[204:207], v[52:55], v[184:191], v50
    v_mfma_f32_16x16x32_bf16 v[212:215], a[208:211], v[80:83], v[196:199]
    v_exp_f32 v208, v208
    v_mfma_f32_16x16x32_bf16 v[212:215], a[212:215], v[84:87], v[212:215]
    v_exp_f32 v209, v209
    v_mfma_f32_16x16x32_bf16 v[212:215], a[216:219], v[88:91], v[212:215]
    v_exp_f32 v210, v210
    v_mfma_f32_16x16x32_bf16 v[212:215], a[220:223], v[92:95], v[212:215]
    v_exp_f32 v211, v211
    v_mfma_f32_16x16x32_bf16 a[72:75], a[160:163], v[176:179], a[72:75]
    ds_read_b64_tr_b16 a[176:177], v26 offset:16384
    v_cvt_pk_bf16_f32 v132, v208, v209
    v_mfma_f32_16x16x32_bf16 a[72:75], a[164:167], v[180:183], a[72:75]
    ds_read_b64_tr_b16 a[178:179], v26 offset:20480
    v_mfma_f32_16x16x32_bf16 a[76:79], a[160:163], v[184:187], a[76:79]
    ds_read_b128 a[232:235], v10 offset:45056
    v_cvt_pk_bf16_f32 v133, v210, v211
    v_mfma_f32_16x16x32_bf16 a[76:79], a[164:167], v[188:191], a[76:79]
    s_waitcnt lgkmcnt(3)
    buffer_load_dwordx4 v41, s[12:15], s41 offen offset:3072 lds
    v_mfma_f32_16x16x32_bf16 v[208:211], a[208:211], v[96:99], v[200:203]
    v_exp_f32 v212, v212
    v_mfma_f32_16x16x32_bf16 v[208:211], a[212:215], v[100:103], v[208:211]
    s_add_u32 s41, s41, 16384
    v_exp_f32 v213, v213
    v_mfma_f32_16x16x32_bf16 v[208:211], a[216:219], v[104:107], v[208:211]
    v_exp_f32 v214, v214
    v_mfma_f32_16x16x32_bf16 v[208:211], a[220:223], v[108:111], v[208:211]
    v_exp_f32 v215, v215
    v_mfma_f32_16x16x32_bf16 a[80:83], a[168:171], v[160:163], a[80:83]
    ds_read_b64_tr_b16 a[180:181], v26 offset:24576
    v_cvt_pk_bf16_f32 v140, v212, v213
    v_mfma_f32_16x16x32_bf16 a[80:83], a[172:175], v[164:167], a[80:83]
    ds_read_b64_tr_b16 a[182:183], v26 offset:28672
    v_mfma_f32_16x16x32_bf16 a[84:87], a[168:171], v[168:171], a[84:87]
    ds_read_b128 a[236:239], v11 offset:45056
    v_cvt_pk_bf16_f32 v141, v214, v215
    v_mfma_f32_16x16x32_bf16 a[84:87], a[172:175], v[172:175], a[84:87]
    s_waitcnt vmcnt(8)
    s_barrier
    v_mfma_f32_16x16x32_bf16 v[212:215], a[208:211], v[112:115], v[204:207]
    v_exp_f32 v208, v208
    v_mfma_f32_16x16x32_bf16 v[212:215], a[212:215], v[116:119], v[212:215]
    s_add_u32 s49, s45, 73728
    v_exp_f32 v209, v209
    v_mfma_f32_16x16x32_bf16 v[212:215], a[216:219], v[120:123], v[212:215]
    s_add_u32 m0, s42, 147456
    v_exp_f32 v210, v210
    v_mfma_f32_16x16x32_bf16 v[212:215], a[220:223], v[124:127], v[212:215]
    v_exp_f32 v211, v211
    v_mfma_f32_16x16x32_bf16 a[88:91], a[168:171], v[176:179], a[88:91]
    ds_read_b64_tr_b16 a[184:185], v27 offset:16384
    v_cvt_pk_bf16_f32 v148, v208, v209
    v_mfma_f32_16x16x32_bf16 a[88:91], a[172:175], v[180:183], a[88:91]
    ds_read_b64_tr_b16 a[186:187], v27 offset:20480
    v_mfma_f32_16x16x32_bf16 a[92:95], a[168:171], v[184:187], a[92:95]
    ds_read_b128 a[208:211], v8 offset:49152
    v_cvt_pk_bf16_f32 v149, v210, v211
    v_mfma_f32_16x16x32_bf16 a[92:95], a[172:175], v[188:191], a[92:95]
    s_waitcnt lgkmcnt(3)
    buffer_load_dwordx4 v46, s[20:23], s49 offen lds
    v_mfma_f32_16x16x32_bf16 v[208:211], a[224:227], v[64:67], v[192:195]
    v_exp_f32 v212, v212
    v_mfma_f32_16x16x32_bf16 v[208:211], a[228:231], v[68:71], v[208:211]
    v_exp_f32 v213, v213
    v_mfma_f32_16x16x32_bf16 v[208:211], a[232:235], v[72:75], v[208:211]
    v_exp_f32 v214, v214
    v_mfma_f32_16x16x32_bf16 v[208:211], a[236:239], v[76:79], v[208:211]
    v_exp_f32 v215, v215
    v_mfma_f32_16x16x32_bf16 a[96:99], a[176:179], v[160:163], a[96:99]
    ds_read_b64_tr_b16 a[188:189], v27 offset:24576
    v_cvt_pk_bf16_f32 v156, v212, v213
    v_mfma_f32_16x16x32_bf16 a[96:99], a[180:183], v[164:167], a[96:99]
    ds_read_b64_tr_b16 a[190:191], v27 offset:28672
    v_mfma_f32_16x16x32_bf16 a[100:103], a[176:179], v[168:171], a[100:103]
    ds_read_b128 a[212:215], v9 offset:49152
    v_cvt_pk_bf16_f32 v157, v214, v215
    v_mfma_f32_16x16x32_bf16 a[100:103], a[180:183], v[172:175], a[100:103]
    v_mfma_f32_16x16x32_bf16 v[212:215], a[224:227], v[80:83], v[196:199]
    v_exp_f32 v208, v208
    v_mfma_f32_16x16x32_bf16 v[212:215], a[228:231], v[84:87], v[212:215]
    v_exp_f32 v209, v209
    v_mfma_f32_16x16x32_bf16 v[212:215], a[232:235], v[88:91], v[212:215]
    v_exp_f32 v210, v210
    v_mfma_f32_16x16x32_bf16 v[212:215], a[236:239], v[92:95], v[212:215]
    v_exp_f32 v211, v211
    v_mfma_f32_16x16x32_bf16 a[104:107], a[176:179], v[176:179], a[104:107]
    ds_read_b64_tr_b16 a[160:161], v20 offset:32768
    v_cvt_pk_bf16_f32 v134, v208, v209
    v_mfma_f32_16x16x32_bf16 a[104:107], a[180:183], v[180:183], a[104:107]
    ds_read_b64_tr_b16 a[162:163], v20 offset:36864
    v_mfma_f32_16x16x32_bf16 a[108:111], a[176:179], v[184:187], a[108:111]
    ds_read_b128 a[216:219], v10 offset:49152
    v_cvt_pk_bf16_f32 v135, v210, v211
    v_mfma_f32_16x16x32_bf16 a[108:111], a[180:183], v[188:191], a[108:111]
    s_waitcnt lgkmcnt(3)
    buffer_load_dwordx4 v47, s[20:23], s49 offen offset:1024 lds
    v_mfma_f32_16x16x32_bf16 v[208:211], a[224:227], v[96:99], v[200:203]
    v_exp_f32 v212, v212
    v_mfma_f32_16x16x32_bf16 v[208:211], a[228:231], v[100:103], v[208:211]
    v_exp_f32 v213, v213
    v_mfma_f32_16x16x32_bf16 v[208:211], a[232:235], v[104:107], v[208:211]
    v_exp_f32 v214, v214
    v_mfma_f32_16x16x32_bf16 v[208:211], a[236:239], v[108:111], v[208:211]
    v_exp_f32 v215, v215
    v_mfma_f32_16x16x32_bf16 a[112:115], a[184:187], v[160:163], a[112:115]
    ds_read_b64_tr_b16 a[164:165], v20 offset:40960
    v_cvt_pk_bf16_f32 v142, v212, v213
    v_mfma_f32_16x16x32_bf16 a[112:115], a[188:191], v[164:167], a[112:115]
    ds_read_b64_tr_b16 a[166:167], v20 offset:45056
    v_mfma_f32_16x16x32_bf16 a[116:119], a[184:187], v[168:171], a[116:119]
    ds_read_b128 a[220:223], v11 offset:49152
    v_cvt_pk_bf16_f32 v143, v214, v215
    v_mfma_f32_16x16x32_bf16 a[116:119], a[188:191], v[172:175], a[116:119]
    v_mfma_f32_16x16x32_bf16 v[212:215], a[224:227], v[112:115], v[204:207]
    v_exp_f32 v208, v208
    v_mfma_f32_16x16x32_bf16 v[212:215], a[228:231], v[116:119], v[212:215]
    v_exp_f32 v209, v209
    v_mfma_f32_16x16x32_bf16 v[212:215], a[232:235], v[120:123], v[212:215]
    v_exp_f32 v210, v210
    v_mfma_f32_16x16x32_bf16 v[212:215], a[236:239], v[124:127], v[212:215]
    v_exp_f32 v211, v211
    v_mfma_f32_16x16x32_bf16 a[120:123], a[184:187], v[176:179], a[120:123]
    ds_read_b64_tr_b16 a[168:169], v21 offset:32768
    v_cvt_pk_bf16_f32 v150, v208, v209
    v_mfma_f32_16x16x32_bf16 a[120:123], a[188:191], v[180:183], a[120:123]
    ds_read_b64_tr_b16 a[170:171], v21 offset:36864
    v_mfma_f32_16x16x32_bf16 a[124:127], a[184:187], v[184:187], a[124:127]
    ds_read_b128 a[224:227], v8 offset:53248
    v_cvt_pk_bf16_f32 v151, v210, v211
    v_mfma_f32_16x16x32_bf16 a[124:127], a[188:191], v[188:191], a[124:127]
    s_waitcnt lgkmcnt(3)
    buffer_load_dwordx4 v48, s[20:23], s49 offen offset:2048 lds
    v_mfma_f32_16x16x32_bf16 v[208:211], a[208:211], v[64:67], v[192:195]
    v_exp_f32 v212, v212
    v_mfma_f32_16x16x32_bf16 v[208:211], a[212:215], v[68:71], v[208:211]
    v_exp_f32 v213, v213
    v_mfma_f32_16x16x32_bf16 v[208:211], a[216:219], v[72:75], v[208:211]
    v_exp_f32 v214, v214
    v_mfma_f32_16x16x32_bf16 v[208:211], a[220:223], v[76:79], v[208:211]
    v_exp_f32 v215, v215
    v_mfma_f32_16x16x32_bf16 a[0:3], a[160:163], v[128:131], a[0:3]
    ds_read_b64_tr_b16 a[172:173], v21 offset:40960
    v_cvt_pk_bf16_f32 v158, v212, v213
    v_mfma_f32_16x16x32_bf16 a[0:3], a[164:167], v[132:135], a[0:3]
    ds_read_b64_tr_b16 a[174:175], v21 offset:45056
    v_mfma_f32_16x16x32_bf16 a[4:7], a[160:163], v[136:139], a[4:7]
    ds_read_b128 a[228:231], v9 offset:53248
    v_cvt_pk_bf16_f32 v159, v214, v215
    v_mfma_f32_16x16x32_bf16 a[4:7], a[164:167], v[140:143], a[4:7]
    v_mfma_f32_16x16x32_bf16 v[212:215], a[208:211], v[80:83], v[196:199]
    v_exp_f32 v208, v208
    v_mfma_f32_16x16x32_bf16 v[212:215], a[212:215], v[84:87], v[212:215]
    v_exp_f32 v209, v209
    v_mfma_f32_16x16x32_bf16 v[212:215], a[216:219], v[88:91], v[212:215]
    v_exp_f32 v210, v210
    v_mfma_f32_16x16x32_bf16 v[212:215], a[220:223], v[92:95], v[212:215]
    v_exp_f32 v211, v211
    v_mfma_f32_16x16x32_bf16 a[8:11], a[160:163], v[144:147], a[8:11]
    ds_read_b64_tr_b16 a[176:177], v22 offset:32768
    v_cvt_pk_bf16_f32 v160, v208, v209
    v_mfma_f32_16x16x32_bf16 a[8:11], a[164:167], v[148:151], a[8:11]
    ds_read_b64_tr_b16 a[178:179], v22 offset:36864
    v_mfma_f32_16x16x32_bf16 a[12:15], a[160:163], v[152:155], a[12:15]
    ds_read_b128 a[232:235], v10 offset:53248
    v_cvt_pk_bf16_f32 v161, v210, v211
    v_mfma_f32_16x16x32_bf16 a[12:15], a[164:167], v[156:159], a[12:15]
    s_waitcnt lgkmcnt(3)
    buffer_load_dwordx4 v49, s[20:23], s49 offen offset:3072 lds
    v_mfma_f32_16x16x32_bf16 v[208:211], a[208:211], v[96:99], v[200:203]
    v_exp_f32 v212, v212
    v_mfma_f32_16x16x32_bf16 v[208:211], a[212:215], v[100:103], v[208:211]
    v_exp_f32 v213, v213
    v_mfma_f32_16x16x32_bf16 v[208:211], a[216:219], v[104:107], v[208:211]
    v_exp_f32 v214, v214
    v_mfma_f32_16x16x32_bf16 v[208:211], a[220:223], v[108:111], v[208:211]
    v_exp_f32 v215, v215
    v_mfma_f32_16x16x32_bf16 a[16:19], a[168:171], v[128:131], a[16:19]
    ds_read_b64_tr_b16 a[180:181], v22 offset:40960
    v_cvt_pk_bf16_f32 v168, v212, v213
    v_mfma_f32_16x16x32_bf16 a[16:19], a[172:175], v[132:135], a[16:19]
    ds_read_b64_tr_b16 a[182:183], v22 offset:45056
    v_mfma_f32_16x16x32_bf16 a[20:23], a[168:171], v[136:139], a[20:23]
    ds_read_b128 a[236:239], v11 offset:53248
    v_cvt_pk_bf16_f32 v169, v214, v215
    v_mfma_f32_16x16x32_bf16 a[20:23], a[172:175], v[140:143], a[20:23]
    v_smfmac_f32_16x16x64_bf16 a[192:195], v[52:55], v[128:135], v50
    v_mfma_f32_16x16x32_bf16 v[212:215], a[208:211], v[112:115], v[204:207]
    v_exp_f32 v208, v208
    v_mfma_f32_16x16x32_bf16 v[212:215], a[212:215], v[116:119], v[212:215]
    s_add_u32 s49, s45, 128
    v_exp_f32 v209, v209
    v_mfma_f32_16x16x32_bf16 v[212:215], a[216:219], v[120:123], v[212:215]
    s_add_u32 m0, s42, 0
    v_exp_f32 v210, v210
    v_mfma_f32_16x16x32_bf16 v[212:215], a[220:223], v[124:127], v[212:215]
    v_exp_f32 v211, v211
    v_mfma_f32_16x16x32_bf16 a[24:27], a[168:171], v[144:147], a[24:27]
    ds_read_b64_tr_b16 a[184:185], v23 offset:32768
    v_cvt_pk_bf16_f32 v176, v208, v209
    v_mfma_f32_16x16x32_bf16 a[24:27], a[172:175], v[148:151], a[24:27]
    ds_read_b64_tr_b16 a[186:187], v23 offset:36864
    v_mfma_f32_16x16x32_bf16 a[28:31], a[168:171], v[152:155], a[28:31]
    ds_read_b128 a[208:211], v8 offset:57344
    v_cvt_pk_bf16_f32 v177, v210, v211
    v_mfma_f32_16x16x32_bf16 a[28:31], a[172:175], v[156:159], a[28:31]
    s_waitcnt lgkmcnt(3)
    buffer_load_dwordx4 v46, s[20:23], s49 offen lds
    v_mfma_f32_16x16x32_bf16 v[208:211], a[224:227], v[64:67], v[192:195]
    v_exp_f32 v212, v212
    v_mfma_f32_16x16x32_bf16 v[208:211], a[228:231], v[68:71], v[208:211]
    v_exp_f32 v213, v213
    v_mfma_f32_16x16x32_bf16 v[208:211], a[232:235], v[72:75], v[208:211]
    v_exp_f32 v214, v214
    v_mfma_f32_16x16x32_bf16 v[208:211], a[236:239], v[76:79], v[208:211]
    v_exp_f32 v215, v215
    v_mfma_f32_16x16x32_bf16 a[32:35], a[176:179], v[128:131], a[32:35]
    ds_read_b64_tr_b16 a[188:189], v23 offset:40960
    v_cvt_pk_bf16_f32 v184, v212, v213
    v_mfma_f32_16x16x32_bf16 a[32:35], a[180:183], v[132:135], a[32:35]
    ds_read_b64_tr_b16 a[190:191], v23 offset:45056
    v_mfma_f32_16x16x32_bf16 a[36:39], a[176:179], v[136:139], a[36:39]
    ds_read_b128 a[212:215], v9 offset:57344
    v_cvt_pk_bf16_f32 v185, v214, v215
    v_mfma_f32_16x16x32_bf16 a[36:39], a[180:183], v[140:143], a[36:39]
    v_smfmac_f32_16x16x64_bf16 a[196:199], v[52:55], v[136:143], v50
    v_mfma_f32_16x16x32_bf16 v[212:215], a[224:227], v[80:83], v[196:199]
    v_exp_f32 v208, v208
    v_mfma_f32_16x16x32_bf16 v[212:215], a[228:231], v[84:87], v[212:215]
    v_exp_f32 v209, v209
    v_mfma_f32_16x16x32_bf16 v[212:215], a[232:235], v[88:91], v[212:215]
    v_exp_f32 v210, v210
    v_mfma_f32_16x16x32_bf16 v[212:215], a[236:239], v[92:95], v[212:215]
    v_exp_f32 v211, v211
    v_mfma_f32_16x16x32_bf16 a[40:43], a[176:179], v[144:147], a[40:43]
    ds_read_b64_tr_b16 a[160:161], v24 offset:32768
    v_cvt_pk_bf16_f32 v162, v208, v209
    v_mfma_f32_16x16x32_bf16 a[40:43], a[180:183], v[148:151], a[40:43]
    ds_read_b64_tr_b16 a[162:163], v24 offset:36864
    v_mfma_f32_16x16x32_bf16 a[44:47], a[176:179], v[152:155], a[44:47]
    ds_read_b128 a[216:219], v10 offset:57344
    v_cvt_pk_bf16_f32 v163, v210, v211
    v_mfma_f32_16x16x32_bf16 a[44:47], a[180:183], v[156:159], a[44:47]
    s_waitcnt lgkmcnt(3)
    buffer_load_dwordx4 v47, s[20:23], s49 offen offset:1024 lds
    v_mfma_f32_16x16x32_bf16 v[208:211], a[224:227], v[96:99], v[200:203]
    v_exp_f32 v212, v212
    v_mfma_f32_16x16x32_bf16 v[208:211], a[228:231], v[100:103], v[208:211]
    v_exp_f32 v213, v213
    v_mfma_f32_16x16x32_bf16 v[208:211], a[232:235], v[104:107], v[208:211]
    v_exp_f32 v214, v214
    v_mfma_f32_16x16x32_bf16 v[208:211], a[236:239], v[108:111], v[208:211]
    v_exp_f32 v215, v215
    v_mfma_f32_16x16x32_bf16 a[48:51], a[184:187], v[128:131], a[48:51]
    ds_read_b64_tr_b16 a[164:165], v24 offset:40960
    v_cvt_pk_bf16_f32 v170, v212, v213
    v_mfma_f32_16x16x32_bf16 a[48:51], a[188:191], v[132:135], a[48:51]
    ds_read_b64_tr_b16 a[166:167], v24 offset:45056
    v_mfma_f32_16x16x32_bf16 a[52:55], a[184:187], v[136:139], a[52:55]
    ds_read_b128 a[220:223], v11 offset:57344
    v_cvt_pk_bf16_f32 v171, v214, v215
    v_mfma_f32_16x16x32_bf16 a[52:55], a[188:191], v[140:143], a[52:55]
    v_smfmac_f32_16x16x64_bf16 a[200:203], v[52:55], v[144:151], v50
    v_mfma_f32_16x16x32_bf16 v[212:215], a[224:227], v[112:115], v[204:207]
    v_exp_f32 v208, v208
    v_mfma_f32_16x16x32_bf16 v[212:215], a[228:231], v[116:119], v[212:215]
    v_exp_f32 v209, v209
    v_mfma_f32_16x16x32_bf16 v[212:215], a[232:235], v[120:123], v[212:215]
    v_exp_f32 v210, v210
    v_mfma_f32_16x16x32_bf16 v[212:215], a[236:239], v[124:127], v[212:215]
    v_exp_f32 v211, v211
    v_mfma_f32_16x16x32_bf16 a[56:59], a[184:187], v[144:147], a[56:59]
    ds_read_b64_tr_b16 a[168:169], v25 offset:32768
    v_cvt_pk_bf16_f32 v178, v208, v209
    v_mfma_f32_16x16x32_bf16 a[56:59], a[188:191], v[148:151], a[56:59]
    ds_read_b64_tr_b16 a[170:171], v25 offset:36864
    v_mfma_f32_16x16x32_bf16 a[60:63], a[184:187], v[152:155], a[60:63]
    ds_read_b128 a[224:227], v8 offset:61440
    v_cvt_pk_bf16_f32 v179, v210, v211
    v_mfma_f32_16x16x32_bf16 a[60:63], a[188:191], v[156:159], a[60:63]
    s_waitcnt lgkmcnt(3)
    buffer_load_dwordx4 v48, s[20:23], s49 offen offset:2048 lds
    v_mfma_f32_16x16x32_bf16 v[208:211], a[208:211], v[64:67], v[192:195]
    v_exp_f32 v212, v212
    v_mfma_f32_16x16x32_bf16 v[208:211], a[212:215], v[68:71], v[208:211]
    v_exp_f32 v213, v213
    v_mfma_f32_16x16x32_bf16 v[208:211], a[216:219], v[72:75], v[208:211]
    v_exp_f32 v214, v214
    v_mfma_f32_16x16x32_bf16 v[208:211], a[220:223], v[76:79], v[208:211]
    v_exp_f32 v215, v215
    v_mfma_f32_16x16x32_bf16 a[64:67], a[160:163], v[128:131], a[64:67]
    ds_read_b64_tr_b16 a[172:173], v25 offset:40960
    v_cvt_pk_bf16_f32 v186, v212, v213
    v_mfma_f32_16x16x32_bf16 a[64:67], a[164:167], v[132:135], a[64:67]
    ds_read_b64_tr_b16 a[174:175], v25 offset:45056
    v_mfma_f32_16x16x32_bf16 a[68:71], a[160:163], v[136:139], a[68:71]
    ds_read_b128 a[228:231], v9 offset:61440
    v_cvt_pk_bf16_f32 v187, v214, v215
    v_mfma_f32_16x16x32_bf16 a[68:71], a[164:167], v[140:143], a[68:71]
    v_smfmac_f32_16x16x64_bf16 a[204:207], v[52:55], v[152:159], v50
    v_mfma_f32_16x16x32_bf16 v[212:215], a[208:211], v[80:83], v[196:199]
    v_exp_f32 v208, v208
    v_mfma_f32_16x16x32_bf16 v[212:215], a[212:215], v[84:87], v[212:215]
    v_exp_f32 v209, v209
    v_mfma_f32_16x16x32_bf16 v[212:215], a[216:219], v[88:91], v[212:215]
    v_exp_f32 v210, v210
    v_mfma_f32_16x16x32_bf16 v[212:215], a[220:223], v[92:95], v[212:215]
    v_exp_f32 v211, v211
    v_mfma_f32_16x16x32_bf16 a[72:75], a[160:163], v[144:147], a[72:75]
    ds_read_b64_tr_b16 a[176:177], v26 offset:32768
    v_cvt_pk_bf16_f32 v164, v208, v209
    v_mfma_f32_16x16x32_bf16 a[72:75], a[164:167], v[148:151], a[72:75]
    ds_read_b64_tr_b16 a[178:179], v26 offset:36864
    v_mfma_f32_16x16x32_bf16 a[76:79], a[160:163], v[152:155], a[76:79]
    ds_read_b128 a[232:235], v10 offset:61440
    v_cvt_pk_bf16_f32 v165, v210, v211
    v_mfma_f32_16x16x32_bf16 a[76:79], a[164:167], v[156:159], a[76:79]
    s_waitcnt lgkmcnt(3)
    buffer_load_dwordx4 v49, s[20:23], s49 offen offset:3072 lds
    v_mfma_f32_16x16x32_bf16 v[208:211], a[208:211], v[96:99], v[200:203]
    v_exp_f32 v212, v212
    v_mfma_f32_16x16x32_bf16 v[208:211], a[212:215], v[100:103], v[208:211]
    v_exp_f32 v213, v213
    v_mfma_f32_16x16x32_bf16 v[208:211], a[216:219], v[104:107], v[208:211]
    v_exp_f32 v214, v214
    v_mfma_f32_16x16x32_bf16 v[208:211], a[220:223], v[108:111], v[208:211]
    v_exp_f32 v215, v215
    v_mfma_f32_16x16x32_bf16 a[80:83], a[168:171], v[128:131], a[80:83]
    ds_read_b64_tr_b16 a[180:181], v26 offset:40960
    v_cvt_pk_bf16_f32 v172, v212, v213
    v_mfma_f32_16x16x32_bf16 a[80:83], a[172:175], v[132:135], a[80:83]
    ds_read_b64_tr_b16 a[182:183], v26 offset:45056
    v_mfma_f32_16x16x32_bf16 a[84:87], a[168:171], v[136:139], a[84:87]
    ds_read_b128 a[236:239], v11 offset:61440
    v_cvt_pk_bf16_f32 v173, v214, v215
    v_mfma_f32_16x16x32_bf16 a[84:87], a[172:175], v[140:143], a[84:87]
    s_waitcnt vmcnt(8)
    s_barrier
    v_mfma_f32_16x16x32_bf16 v[212:215], a[208:211], v[112:115], v[204:207]
    v_exp_f32 v208, v208
    v_mfma_f32_16x16x32_bf16 v[212:215], a[212:215], v[116:119], v[212:215]
    s_add_u32 s49, s45, 73856
    v_exp_f32 v209, v209
    v_mfma_f32_16x16x32_bf16 v[212:215], a[216:219], v[120:123], v[212:215]
    s_add_u32 m0, s42, 16384
    v_exp_f32 v210, v210
    v_mfma_f32_16x16x32_bf16 v[212:215], a[220:223], v[124:127], v[212:215]
    v_exp_f32 v211, v211
    v_mfma_f32_16x16x32_bf16 a[88:91], a[168:171], v[144:147], a[88:91]
    ds_read_b64_tr_b16 a[184:185], v27 offset:32768
    v_cvt_pk_bf16_f32 v180, v208, v209
    v_mfma_f32_16x16x32_bf16 a[88:91], a[172:175], v[148:151], a[88:91]
    ds_read_b64_tr_b16 a[186:187], v27 offset:36864
    v_mfma_f32_16x16x32_bf16 a[92:95], a[168:171], v[152:155], a[92:95]
    v_cvt_pk_bf16_f32 v181, v210, v211
    v_mfma_f32_16x16x32_bf16 a[92:95], a[172:175], v[156:159], a[92:95]
    s_waitcnt lgkmcnt(3)
    buffer_load_dwordx4 v46, s[20:23], s49 offen lds
    v_mfma_f32_16x16x32_bf16 v[208:211], a[224:227], v[64:67], v[192:195]
    v_exp_f32 v212, v212
    v_mfma_f32_16x16x32_bf16 v[208:211], a[228:231], v[68:71], v[208:211]
    v_exp_f32 v213, v213
    v_mfma_f32_16x16x32_bf16 v[208:211], a[232:235], v[72:75], v[208:211]
    s_waitcnt lgkmcnt(2)
    v_exp_f32 v214, v214
    v_mfma_f32_16x16x32_bf16 v[208:211], a[236:239], v[76:79], v[208:211]
    v_exp_f32 v215, v215
    v_mfma_f32_16x16x32_bf16 a[96:99], a[176:179], v[128:131], a[96:99]
    ds_read_b64_tr_b16 a[188:189], v27 offset:40960
    v_cvt_pk_bf16_f32 v188, v212, v213
    v_mfma_f32_16x16x32_bf16 a[96:99], a[180:183], v[132:135], a[96:99]
    ds_read_b64_tr_b16 a[190:191], v27 offset:45056
    v_mfma_f32_16x16x32_bf16 a[100:103], a[176:179], v[136:139], a[100:103]
    v_cvt_pk_bf16_f32 v189, v214, v215
    v_mfma_f32_16x16x32_bf16 a[100:103], a[180:183], v[140:143], a[100:103]
    v_mfma_f32_16x16x32_bf16 v[212:215], a[224:227], v[80:83], v[196:199]
    v_exp_f32 v208, v208
    v_mfma_f32_16x16x32_bf16 v[212:215], a[228:231], v[84:87], v[212:215]
    v_exp_f32 v209, v209
    v_mfma_f32_16x16x32_bf16 v[212:215], a[232:235], v[88:91], v[212:215]
    v_exp_f32 v210, v210
    v_mfma_f32_16x16x32_bf16 v[212:215], a[236:239], v[92:95], v[212:215]
    v_exp_f32 v211, v211
    v_mfma_f32_16x16x32_bf16 a[104:107], a[176:179], v[144:147], a[104:107]
    ds_read_b64_tr_b16 a[160:161], v20 offset:49152
    v_cvt_pk_bf16_f32 v166, v208, v209
    v_mfma_f32_16x16x32_bf16 a[104:107], a[180:183], v[148:151], a[104:107]
    ds_read_b64_tr_b16 a[162:163], v20 offset:53248
    v_mfma_f32_16x16x32_bf16 a[108:111], a[176:179], v[152:155], a[108:111]
    v_cvt_pk_bf16_f32 v167, v210, v211
    v_mfma_f32_16x16x32_bf16 a[108:111], a[180:183], v[156:159], a[108:111]
    s_waitcnt lgkmcnt(3)
    buffer_load_dwordx4 v47, s[20:23], s49 offen offset:1024 lds
    v_mfma_f32_16x16x32_bf16 v[208:211], a[224:227], v[96:99], v[200:203]
    v_exp_f32 v212, v212
    v_mfma_f32_16x16x32_bf16 v[208:211], a[228:231], v[100:103], v[208:211]
    v_exp_f32 v213, v213
    v_mfma_f32_16x16x32_bf16 v[208:211], a[232:235], v[104:107], v[208:211]
    v_exp_f32 v214, v214
    v_mfma_f32_16x16x32_bf16 v[208:211], a[236:239], v[108:111], v[208:211]
    v_exp_f32 v215, v215
    v_mfma_f32_16x16x32_bf16 a[112:115], a[184:187], v[128:131], a[112:115]
    s_waitcnt lgkmcnt(2)
    ds_read_b64_tr_b16 a[164:165], v20 offset:57344
    v_cvt_pk_bf16_f32 v174, v212, v213
    v_mfma_f32_16x16x32_bf16 a[112:115], a[188:191], v[132:135], a[112:115]
    ds_read_b64_tr_b16 a[166:167], v20 offset:61440
    v_mfma_f32_16x16x32_bf16 a[116:119], a[184:187], v[136:139], a[116:119]
    v_cvt_pk_bf16_f32 v175, v214, v215
    v_mfma_f32_16x16x32_bf16 a[116:119], a[188:191], v[140:143], a[116:119]
    v_mfma_f32_16x16x32_bf16 v[212:215], a[224:227], v[112:115], v[204:207]
    v_exp_f32 v208, v208
    v_mfma_f32_16x16x32_bf16 v[212:215], a[228:231], v[116:119], v[212:215]
    v_exp_f32 v209, v209
    v_mfma_f32_16x16x32_bf16 v[212:215], a[232:235], v[120:123], v[212:215]
    v_exp_f32 v210, v210
    v_mfma_f32_16x16x32_bf16 v[212:215], a[236:239], v[124:127], v[212:215]
    v_exp_f32 v211, v211
    v_mfma_f32_16x16x32_bf16 a[120:123], a[184:187], v[144:147], a[120:123]
    ds_read_b64_tr_b16 a[168:169], v21 offset:49152
    v_cvt_pk_bf16_f32 v182, v208, v209
    v_mfma_f32_16x16x32_bf16 a[120:123], a[188:191], v[148:151], a[120:123]
    ds_read_b64_tr_b16 a[170:171], v21 offset:53248
    v_mfma_f32_16x16x32_bf16 a[124:127], a[184:187], v[152:155], a[124:127]
    v_cvt_pk_bf16_f32 v183, v210, v211
    v_mfma_f32_16x16x32_bf16 a[124:127], a[188:191], v[156:159], a[124:127]
    s_waitcnt lgkmcnt(3)
    buffer_load_dwordx4 v48, s[20:23], s49 offen offset:2048 lds
    v_exp_f32 v212, v212
    v_exp_f32 v213, v213
    v_exp_f32 v214, v214
    v_exp_f32 v215, v215
    v_mfma_f32_16x16x32_bf16 a[0:3], a[160:163], v[160:163], a[0:3]
    s_waitcnt lgkmcnt(2)
    ds_read_b64_tr_b16 a[172:173], v21 offset:57344
    v_cvt_pk_bf16_f32 v190, v212, v213
    v_mfma_f32_16x16x32_bf16 a[0:3], a[164:167], v[164:167], a[0:3]
    ds_read_b64_tr_b16 a[174:175], v21 offset:61440
    v_mfma_f32_16x16x32_bf16 a[4:7], a[160:163], v[168:171], a[4:7]
    v_cvt_pk_bf16_f32 v191, v214, v215
    v_mfma_f32_16x16x32_bf16 a[4:7], a[164:167], v[172:175], a[4:7]
    v_mfma_f32_16x16x32_bf16 a[8:11], a[160:163], v[176:179], a[8:11]
    ds_read_b64_tr_b16 a[176:177], v22 offset:49152
    v_mfma_f32_16x16x32_bf16 a[8:11], a[164:167], v[180:183], a[8:11]
    ds_read_b64_tr_b16 a[178:179], v22 offset:53248
    v_mfma_f32_16x16x32_bf16 a[12:15], a[160:163], v[184:187], a[12:15]
    v_mfma_f32_16x16x32_bf16 a[12:15], a[164:167], v[188:191], a[12:15]
    buffer_load_dwordx4 v49, s[20:23], s49 offen offset:3072 lds
    v_smfmac_f32_16x16x64_bf16 a[192:195], v[52:55], v[160:167], v50
    s_waitcnt lgkmcnt(4)
    v_mfma_f32_16x16x32_bf16 a[16:19], a[168:171], v[160:163], a[16:19]
    s_waitcnt lgkmcnt(2)
    ds_read_b64_tr_b16 a[180:181], v22 offset:57344
    v_mfma_f32_16x16x32_bf16 a[16:19], a[172:175], v[164:167], a[16:19]
    ds_read_b64_tr_b16 a[182:183], v22 offset:61440
    v_mfma_f32_16x16x32_bf16 a[20:23], a[168:171], v[168:171], a[20:23]
    v_mfma_f32_16x16x32_bf16 a[20:23], a[172:175], v[172:175], a[20:23]
    v_smfmac_f32_16x16x64_bf16 a[196:199], v[52:55], v[168:175], v50
    s_add_u32 s49, s45, 256
    s_add_u32 m0, s42, 32768
    v_mfma_f32_16x16x32_bf16 a[24:27], a[168:171], v[176:179], a[24:27]
    ds_read_b64_tr_b16 a[184:185], v23 offset:49152
    v_mfma_f32_16x16x32_bf16 a[24:27], a[172:175], v[180:183], a[24:27]
    ds_read_b64_tr_b16 a[186:187], v23 offset:53248
    v_mfma_f32_16x16x32_bf16 a[28:31], a[168:171], v[184:187], a[28:31]
    v_mfma_f32_16x16x32_bf16 a[28:31], a[172:175], v[188:191], a[28:31]
    buffer_load_dwordx4 v46, s[20:23], s49 offen lds
    v_smfmac_f32_16x16x64_bf16 a[200:203], v[52:55], v[176:183], v50
    s_waitcnt lgkmcnt(4)
    v_mfma_f32_16x16x32_bf16 a[32:35], a[176:179], v[160:163], a[32:35]
    s_waitcnt lgkmcnt(2)
    ds_read_b64_tr_b16 a[188:189], v23 offset:57344
    v_mfma_f32_16x16x32_bf16 a[32:35], a[180:183], v[164:167], a[32:35]
    ds_read_b64_tr_b16 a[190:191], v23 offset:61440
    v_mfma_f32_16x16x32_bf16 a[36:39], a[176:179], v[168:171], a[36:39]
    v_mfma_f32_16x16x32_bf16 a[36:39], a[180:183], v[172:175], a[36:39]
    v_smfmac_f32_16x16x64_bf16 a[204:207], v[52:55], v[184:191], v50
    v_mfma_f32_16x16x32_bf16 a[40:43], a[176:179], v[176:179], a[40:43]
    ds_read_b64_tr_b16 a[160:161], v24 offset:49152
    v_mfma_f32_16x16x32_bf16 a[40:43], a[180:183], v[180:183], a[40:43]
    ds_read_b64_tr_b16 a[162:163], v24 offset:53248
    v_mfma_f32_16x16x32_bf16 a[44:47], a[176:179], v[184:187], a[44:47]
    v_mfma_f32_16x16x32_bf16 a[44:47], a[180:183], v[188:191], a[44:47]
    s_waitcnt lgkmcnt(4)
    buffer_load_dwordx4 v47, s[20:23], s49 offen offset:1024 lds
    v_mfma_f32_16x16x32_bf16 a[48:51], a[184:187], v[160:163], a[48:51]
    s_waitcnt lgkmcnt(2)
    ds_read_b64_tr_b16 a[164:165], v24 offset:57344
    v_accvgpr_read_b32 v216, a192
    v_mfma_f32_16x16x32_bf16 a[48:51], a[188:191], v[164:167], a[48:51]
    ds_read_b64_tr_b16 a[166:167], v24 offset:61440
    v_accvgpr_read_b32 v217, a193
    v_mfma_f32_16x16x32_bf16 a[52:55], a[184:187], v[168:171], a[52:55]
    v_accvgpr_read_b32 v218, a196
    v_accvgpr_read_b32 v219, a197
    v_mfma_f32_16x16x32_bf16 a[52:55], a[188:191], v[172:175], a[52:55]
    v_accvgpr_read_b32 v220, a200
    v_accvgpr_read_b32 v221, a201
    v_mfma_f32_16x16x32_bf16 a[56:59], a[184:187], v[176:179], a[56:59]
    ds_read_b64_tr_b16 a[168:169], v25 offset:49152
    v_accvgpr_read_b32 v222, a204
    v_mfma_f32_16x16x32_bf16 a[56:59], a[188:191], v[180:183], a[56:59]
    ds_read_b64_tr_b16 a[170:171], v25 offset:53248
    v_accvgpr_read_b32 v223, a205
    v_mfma_f32_16x16x32_bf16 a[60:63], a[184:187], v[184:187], a[60:63]
    v_add_f32 v58, v216, v217
    v_add_f32 v59, v218, v219
    v_mfma_f32_16x16x32_bf16 a[60:63], a[188:191], v[188:191], a[60:63]
    s_waitcnt lgkmcnt(4)
    buffer_load_dwordx4 v48, s[20:23], s49 offen offset:2048 lds
    v_add_f32 v60, v220, v221
    v_add_f32 v61, v222, v223
    v_mfma_f32_16x16x32_bf16 a[64:67], a[160:163], v[160:163], a[64:67]
    s_waitcnt lgkmcnt(2)
    ds_read_b64_tr_b16 a[172:173], v25 offset:57344
    v_add_f32 v216, v58, v59
    v_mfma_f32_16x16x32_bf16 a[64:67], a[164:167], v[164:167], a[64:67]
    ds_read_b64_tr_b16 a[174:175], v25 offset:61440
    v_add_f32 v217, v60, v61
    v_mfma_f32_16x16x32_bf16 a[68:71], a[160:163], v[168:171], a[68:71]
    v_add_f32 v216, v216, v217
    v_cmp_ngt_f32 vcc, 1669332992, v216
    v_mfma_f32_16x16x32_bf16 a[68:71], a[164:167], v[172:175], a[68:71]
    v_rcp_f32 v58, v58
    v_rcp_f32 v59, v59
    v_mfma_f32_16x16x32_bf16 a[72:75], a[160:163], v[176:179], a[72:75]
    ds_read_b64_tr_b16 a[176:177], v26 offset:49152
    v_rcp_f32 v60, v60
    v_mfma_f32_16x16x32_bf16 a[72:75], a[164:167], v[180:183], a[72:75]
    ds_read_b64_tr_b16 a[178:179], v26 offset:53248
    v_rcp_f32 v61, v61
    v_mfma_f32_16x16x32_bf16 a[76:79], a[160:163], v[184:187], a[76:79]
    v_mov_b32 v228, 81920
    s_or_b32 s36, vcc_lo, vcc_hi
    v_mfma_f32_16x16x32_bf16 a[76:79], a[164:167], v[188:191], a[76:79]
    s_waitcnt lgkmcnt(4)
    buffer_load_dwordx4 v49, s[20:23], s49 offen offset:3072 lds
    v_mov_b32 v218, s36
    s_lshl_b32 s37, s3, 2
    v_mfma_f32_16x16x32_bf16 a[80:83], a[168:171], v[160:163], a[80:83]
    s_waitcnt lgkmcnt(2)
    ds_read_b64_tr_b16 a[180:181], v26 offset:57344
    v_add_u32 v219, s37, v228
    ds_write_b32 v219, v218
    v_mfma_f32_16x16x32_bf16 a[80:83], a[172:175], v[164:167], a[80:83]
    ds_read_b64_tr_b16 a[182:183], v26 offset:61440
    v_mfma_f32_16x16x32_bf16 a[84:87], a[168:171], v[168:171], a[84:87]
    v_mfma_f32_16x16x32_bf16 a[84:87], a[172:175], v[172:175], a[84:87]
    s_waitcnt lgkmcnt(1)
    s_waitcnt vmcnt(12)
    s_barrier
    v_mfma_f32_16x16x32_bf16 a[88:91], a[168:171], v[176:179], a[88:91]
    ds_read_b64_tr_b16 a[184:185], v27 offset:49152
    v_mfma_f32_16x16x32_bf16 a[88:91], a[172:175], v[180:183], a[88:91]
    ds_read_b64_tr_b16 a[186:187], v27 offset:53248
    v_mfma_f32_16x16x32_bf16 a[92:95], a[168:171], v[184:187], a[92:95]
    ds_read_b128 v[224:227], v228
    v_mfma_f32_16x16x32_bf16 a[92:95], a[172:175], v[188:191], a[92:95]
    s_add_u32 s49, s45, 73984
    v_mfma_f32_16x16x32_bf16 a[96:99], a[176:179], v[160:163], a[96:99]
    s_waitcnt lgkmcnt(3)
    s_add_u32 m0, s42, 49152
    ds_read_b64_tr_b16 a[188:189], v27 offset:57344
    v_mfma_f32_16x16x32_bf16 a[96:99], a[180:183], v[164:167], a[96:99]
    ds_read_b64_tr_b16 a[190:191], v27 offset:61440
    buffer_load_dwordx4 v46, s[20:23], s49 offen lds
    v_mfma_f32_16x16x32_bf16 a[100:103], a[176:179], v[168:171], a[100:103]
    v_mfma_f32_16x16x32_bf16 a[100:103], a[180:183], v[172:175], a[100:103]
    buffer_load_dwordx4 v47, s[20:23], s49 offen offset:1024 lds
    v_mfma_f32_16x16x32_bf16 a[104:107], a[176:179], v[176:179], a[104:107]
    v_mfma_f32_16x16x32_bf16 a[104:107], a[180:183], v[180:183], a[104:107]
    buffer_load_dwordx4 v48, s[20:23], s49 offen offset:2048 lds
    v_mfma_f32_16x16x32_bf16 a[108:111], a[176:179], v[184:187], a[108:111]
    v_mfma_f32_16x16x32_bf16 a[108:111], a[180:183], v[188:191], a[108:111]
    s_waitcnt lgkmcnt(3)
    buffer_load_dwordx4 v49, s[20:23], s49 offen offset:3072 lds
    s_add_u32 s49, s45, 384
    v_mfma_f32_16x16x32_bf16 a[112:115], a[184:187], v[160:163], a[112:115]
    s_waitcnt lgkmcnt(0)
    s_add_u32 m0, s42, 65536
    v_mfma_f32_16x16x32_bf16 a[112:115], a[188:191], v[164:167], a[112:115]
    buffer_load_dwordx4 v46, s[20:23], s49 offen lds
    v_mfma_f32_16x16x32_bf16 a[116:119], a[184:187], v[168:171], a[116:119]
    v_mfma_f32_16x16x32_bf16 a[116:119], a[188:191], v[172:175], a[116:119]
    buffer_load_dwordx4 v47, s[20:23], s49 offen offset:1024 lds
    v_mfma_f32_16x16x32_bf16 a[120:123], a[184:187], v[176:179], a[120:123]
    v_mfma_f32_16x16x32_bf16 a[120:123], a[188:191], v[180:183], a[120:123]
    buffer_load_dwordx4 v48, s[20:23], s49 offen offset:2048 lds
    v_mfma_f32_16x16x32_bf16 a[124:127], a[184:187], v[184:187], a[124:127]
    v_mfma_f32_16x16x32_bf16 a[124:127], a[188:191], v[188:191], a[124:127]
    buffer_load_dwordx4 v49, s[20:23], s49 offen offset:3072 lds
    v_or3_b32 v224, v224, v225, v226
    v_or_b32 v224, v224, v227
    s_nop 0
    v_readfirstlane_b32 s36, v224
    ds_read_b64_tr_b16 a[128:129], v28 offset:0
    ds_read_b64_tr_b16 a[130:131], v28 offset:4096
    ds_read_b64_tr_b16 a[132:133], v28 offset:8192
    ds_read_b64_tr_b16 a[134:135], v28 offset:12288
    ds_read_b64_tr_b16 a[136:137], v28 offset:16384
    ds_read_b64_tr_b16 a[138:139], v28 offset:20480
    ds_read_b64_tr_b16 a[140:141], v28 offset:24576
    ds_read_b64_tr_b16 a[142:143], v28 offset:28672
    ds_read_b64_tr_b16 a[144:145], v32 offset:0
    ds_read_b64_tr_b16 a[146:147], v32 offset:4096
    ds_read_b64_tr_b16 a[148:149], v32 offset:8192
    ds_read_b64_tr_b16 a[150:151], v32 offset:12288
    ds_read_b64_tr_b16 a[152:153], v32 offset:16384
    ds_read_b64_tr_b16 a[154:155], v32 offset:20480
    ds_read_b64_tr_b16 a[156:157], v32 offset:24576
    ds_read_b64_tr_b16 a[158:159], v32 offset:28672
    s_andn2_b32 s36, s36, s48
    s_cbranch_scc1 Lattn_redo
    v_accvgpr_read_b32 v216, a0
    v_accvgpr_read_b32 v217, a1
    v_accvgpr_read_b32 v218, a2
    v_accvgpr_read_b32 v219, a3
    v_pk_mul_f32 v[216:217], v[216:217], v[58:59] op_sel:[0,0] op_sel_hi:[1,0]
    v_pk_mul_f32 v[218:219], v[218:219], v[58:59] op_sel:[0,0] op_sel_hi:[1,0]
    v_cvt_pk_bf16_f32 v128, v216, v217
    v_cvt_pk_bf16_f32 v129, v218, v219
    v_accvgpr_read_b32 v220, a4
    v_accvgpr_read_b32 v221, a5
    v_accvgpr_read_b32 v222, a6
    v_accvgpr_read_b32 v223, a7
    v_pk_mul_f32 v[220:221], v[220:221], v[58:59] op_sel:[0,1] op_sel_hi:[1,1]
    v_pk_mul_f32 v[222:223], v[222:223], v[58:59] op_sel:[0,1] op_sel_hi:[1,1]
    v_cvt_pk_bf16_f32 v160, v220, v221
    v_cvt_pk_bf16_f32 v161, v222, v223
    v_accvgpr_read_b32 v224, a8
    v_accvgpr_read_b32 v225, a9
    v_accvgpr_read_b32 v226, a10
    v_accvgpr_read_b32 v227, a11
    v_pk_mul_f32 v[224:225], v[224:225], v[60:61] op_sel:[0,0] op_sel_hi:[1,0]
    v_pk_mul_f32 v[226:227], v[226:227], v[60:61] op_sel:[0,0] op_sel_hi:[1,0]
    v_cvt_pk_bf16_f32 v144, v224, v225
    v_cvt_pk_bf16_f32 v145, v226, v227
    v_accvgpr_read_b32 v228, a12
    v_accvgpr_read_b32 v229, a13
    v_accvgpr_read_b32 v230, a14
    v_accvgpr_read_b32 v231, a15
    v_pk_mul_f32 v[228:229], v[228:229], v[60:61] op_sel:[0,1] op_sel_hi:[1,1]
    v_pk_mul_f32 v[230:231], v[230:231], v[60:61] op_sel:[0,1] op_sel_hi:[1,1]
    v_cvt_pk_bf16_f32 v176, v228, v229
    v_cvt_pk_bf16_f32 v177, v230, v231
    v_accvgpr_read_b32 v216, a16
    v_accvgpr_read_b32 v217, a17
    v_accvgpr_read_b32 v218, a18
    v_accvgpr_read_b32 v219, a19
    v_pk_mul_f32 v[216:217], v[216:217], v[58:59] op_sel:[0,0] op_sel_hi:[1,0]
    v_pk_mul_f32 v[218:219], v[218:219], v[58:59] op_sel:[0,0] op_sel_hi:[1,0]
    v_cvt_pk_bf16_f32 v130, v216, v217
    v_cvt_pk_bf16_f32 v131, v218, v219
    v_accvgpr_read_b32 v220, a20
    v_accvgpr_read_b32 v221, a21
    v_accvgpr_read_b32 v222, a22
    v_accvgpr_read_b32 v223, a23
    v_pk_mul_f32 v[220:221], v[220:221], v[58:59] op_sel:[0,1] op_sel_hi:[1,1]
    v_pk_mul_f32 v[222:223], v[222:223], v[58:59] op_sel:[0,1] op_sel_hi:[1,1]
    v_cvt_pk_bf16_f32 v162, v220, v221
    v_cvt_pk_bf16_f32 v163, v222, v223
    v_accvgpr_read_b32 v224, a24
    v_accvgpr_read_b32 v225, a25
    v_accvgpr_read_b32 v226, a26
    v_accvgpr_read_b32 v227, a27
    v_pk_mul_f32 v[224:225], v[224:225], v[60:61] op_sel:[0,0] op_sel_hi:[1,0]
    v_pk_mul_f32 v[226:227], v[226:227], v[60:61] op_sel:[0,0] op_sel_hi:[1,0]
    v_cvt_pk_bf16_f32 v146, v224, v225
    v_cvt_pk_bf16_f32 v147, v226, v227
    v_accvgpr_read_b32 v228, a28
    v_accvgpr_read_b32 v229, a29
    v_accvgpr_read_b32 v230, a30
    v_accvgpr_read_b32 v231, a31
    v_pk_mul_f32 v[228:229], v[228:229], v[60:61] op_sel:[0,1] op_sel_hi:[1,1]
    v_pk_mul_f32 v[230:231], v[230:231], v[60:61] op_sel:[0,1] op_sel_hi:[1,1]
    v_cvt_pk_bf16_f32 v178, v228, v229
    v_cvt_pk_bf16_f32 v179, v230, v231
    v_accvgpr_read_b32 v216, a32
    v_accvgpr_read_b32 v217, a33
    v_accvgpr_read_b32 v218, a34
    v_accvgpr_read_b32 v219, a35
    v_pk_mul_f32 v[216:217], v[216:217], v[58:59] op_sel:[0,0] op_sel_hi:[1,0]
    v_pk_mul_f32 v[218:219], v[218:219], v[58:59] op_sel:[0,0] op_sel_hi:[1,0]
    v_cvt_pk_bf16_f32 v132, v216, v217
    v_cvt_pk_bf16_f32 v133, v218, v219
    v_accvgpr_read_b32 v220, a36
    v_accvgpr_read_b32 v221, a37
    v_accvgpr_read_b32 v222, a38
    v_accvgpr_read_b32 v223, a39
    v_pk_mul_f32 v[220:221], v[220:221], v[58:59] op_sel:[0,1] op_sel_hi:[1,1]
    v_pk_mul_f32 v[222:223], v[222:223], v[58:59] op_sel:[0,1] op_sel_hi:[1,1]
    v_cvt_pk_bf16_f32 v164, v220, v221
    v_cvt_pk_bf16_f32 v165, v222, v223
    v_accvgpr_read_b32 v224, a40
    v_accvgpr_read_b32 v225, a41
    v_accvgpr_read_b32 v226, a42
    v_accvgpr_read_b32 v227, a43
    v_pk_mul_f32 v[224:225], v[224:225], v[60:61] op_sel:[0,0] op_sel_hi:[1,0]
    v_pk_mul_f32 v[226:227], v[226:227], v[60:61] op_sel:[0,0] op_sel_hi:[1,0]
    v_cvt_pk_bf16_f32 v148, v224, v225
    v_cvt_pk_bf16_f32 v149, v226, v227
    v_accvgpr_read_b32 v228, a44
    v_accvgpr_read_b32 v229, a45
    v_accvgpr_read_b32 v230, a46
    v_accvgpr_read_b32 v231, a47
    v_pk_mul_f32 v[228:229], v[228:229], v[60:61] op_sel:[0,1] op_sel_hi:[1,1]
    v_pk_mul_f32 v[230:231], v[230:231], v[60:61] op_sel:[0,1] op_sel_hi:[1,1]
    v_cvt_pk_bf16_f32 v180, v228, v229
    v_cvt_pk_bf16_f32 v181, v230, v231
    v_accvgpr_read_b32 v216, a48
    v_accvgpr_read_b32 v217, a49
    v_accvgpr_read_b32 v218, a50
    v_accvgpr_read_b32 v219, a51
    v_pk_mul_f32 v[216:217], v[216:217], v[58:59] op_sel:[0,0] op_sel_hi:[1,0]
    v_pk_mul_f32 v[218:219], v[218:219], v[58:59] op_sel:[0,0] op_sel_hi:[1,0]
    v_cvt_pk_bf16_f32 v134, v216, v217
    v_cvt_pk_bf16_f32 v135, v218, v219
    v_accvgpr_read_b32 v220, a52
    v_accvgpr_read_b32 v221, a53
    v_accvgpr_read_b32 v222, a54
    v_accvgpr_read_b32 v223, a55
    v_pk_mul_f32 v[220:221], v[220:221], v[58:59] op_sel:[0,1] op_sel_hi:[1,1]
    v_pk_mul_f32 v[222:223], v[222:223], v[58:59] op_sel:[0,1] op_sel_hi:[1,1]
    v_cvt_pk_bf16_f32 v166, v220, v221
    v_cvt_pk_bf16_f32 v167, v222, v223
    v_accvgpr_read_b32 v224, a56
    v_accvgpr_read_b32 v225, a57
    v_accvgpr_read_b32 v226, a58
    v_accvgpr_read_b32 v227, a59
    v_pk_mul_f32 v[224:225], v[224:225], v[60:61] op_sel:[0,0] op_sel_hi:[1,0]
    v_pk_mul_f32 v[226:227], v[226:227], v[60:61] op_sel:[0,0] op_sel_hi:[1,0]
    v_cvt_pk_bf16_f32 v150, v224, v225
    v_cvt_pk_bf16_f32 v151, v226, v227
    v_accvgpr_read_b32 v228, a60
    v_accvgpr_read_b32 v229, a61
    v_accvgpr_read_b32 v230, a62
    v_accvgpr_read_b32 v231, a63
    v_pk_mul_f32 v[228:229], v[228:229], v[60:61] op_sel:[0,1] op_sel_hi:[1,1]
    v_pk_mul_f32 v[230:231], v[230:231], v[60:61] op_sel:[0,1] op_sel_hi:[1,1]
    v_cvt_pk_bf16_f32 v182, v228, v229
    v_cvt_pk_bf16_f32 v183, v230, v231
    v_accvgpr_read_b32 v216, a64
    v_accvgpr_read_b32 v217, a65
    v_accvgpr_read_b32 v218, a66
    v_accvgpr_read_b32 v219, a67
    v_pk_mul_f32 v[216:217], v[216:217], v[58:59] op_sel:[0,0] op_sel_hi:[1,0]
    v_pk_mul_f32 v[218:219], v[218:219], v[58:59] op_sel:[0,0] op_sel_hi:[1,0]
    v_cvt_pk_bf16_f32 v136, v216, v217
    v_cvt_pk_bf16_f32 v137, v218, v219
    v_accvgpr_read_b32 v220, a68
    v_accvgpr_read_b32 v221, a69
    v_accvgpr_read_b32 v222, a70
    v_accvgpr_read_b32 v223, a71
    v_pk_mul_f32 v[220:221], v[220:221], v[58:59] op_sel:[0,1] op_sel_hi:[1,1]
    v_pk_mul_f32 v[222:223], v[222:223], v[58:59] op_sel:[0,1] op_sel_hi:[1,1]
    v_cvt_pk_bf16_f32 v168, v220, v221
    v_cvt_pk_bf16_f32 v169, v222, v223
    v_accvgpr_read_b32 v224, a72
    v_accvgpr_read_b32 v225, a73
    v_accvgpr_read_b32 v226, a74
    v_accvgpr_read_b32 v227, a75
    v_pk_mul_f32 v[224:225], v[224:225], v[60:61] op_sel:[0,0] op_sel_hi:[1,0]
    v_pk_mul_f32 v[226:227], v[226:227], v[60:61] op_sel:[0,0] op_sel_hi:[1,0]
    v_cvt_pk_bf16_f32 v152, v224, v225
    v_cvt_pk_bf16_f32 v153, v226, v227
    v_accvgpr_read_b32 v228, a76
    v_accvgpr_read_b32 v229, a77
    v_accvgpr_read_b32 v230, a78
    v_accvgpr_read_b32 v231, a79
    v_pk_mul_f32 v[228:229], v[228:229], v[60:61] op_sel:[0,1] op_sel_hi:[1,1]
    v_pk_mul_f32 v[230:231], v[230:231], v[60:61] op_sel:[0,1] op_sel_hi:[1,1]
    v_cvt_pk_bf16_f32 v184, v228, v229
    v_cvt_pk_bf16_f32 v185, v230, v231
    v_accvgpr_read_b32 v216, a80
    v_accvgpr_read_b32 v217, a81
    v_accvgpr_read_b32 v218, a82
    v_accvgpr_read_b32 v219, a83
    v_pk_mul_f32 v[216:217], v[216:217], v[58:59] op_sel:[0,0] op_sel_hi:[1,0]
    v_pk_mul_f32 v[218:219], v[218:219], v[58:59] op_sel:[0,0] op_sel_hi:[1,0]
    v_cvt_pk_bf16_f32 v138, v216, v217
    v_cvt_pk_bf16_f32 v139, v218, v219
    v_accvgpr_read_b32 v220, a84
    v_accvgpr_read_b32 v221, a85
    v_accvgpr_read_b32 v222, a86
    v_accvgpr_read_b32 v223, a87
    v_pk_mul_f32 v[220:221], v[220:221], v[58:59] op_sel:[0,1] op_sel_hi:[1,1]
    v_pk_mul_f32 v[222:223], v[222:223], v[58:59] op_sel:[0,1] op_sel_hi:[1,1]
    v_cvt_pk_bf16_f32 v170, v220, v221
    v_cvt_pk_bf16_f32 v171, v222, v223
    v_accvgpr_read_b32 v224, a88
    v_accvgpr_read_b32 v225, a89
    v_accvgpr_read_b32 v226, a90
    v_accvgpr_read_b32 v227, a91
    v_pk_mul_f32 v[224:225], v[224:225], v[60:61] op_sel:[0,0] op_sel_hi:[1,0]
    v_pk_mul_f32 v[226:227], v[226:227], v[60:61] op_sel:[0,0] op_sel_hi:[1,0]
    v_cvt_pk_bf16_f32 v154, v224, v225
    v_cvt_pk_bf16_f32 v155, v226, v227
    v_accvgpr_read_b32 v228, a92
    v_accvgpr_read_b32 v229, a93
    v_accvgpr_read_b32 v230, a94
    v_accvgpr_read_b32 v231, a95
    v_pk_mul_f32 v[228:229], v[228:229], v[60:61] op_sel:[0,1] op_sel_hi:[1,1]
    v_pk_mul_f32 v[230:231], v[230:231], v[60:61] op_sel:[0,1] op_sel_hi:[1,1]
    v_cvt_pk_bf16_f32 v186, v228, v229
    v_cvt_pk_bf16_f32 v187, v230, v231
    v_accvgpr_read_b32 v216, a96
    v_accvgpr_read_b32 v217, a97
    v_accvgpr_read_b32 v218, a98
    v_accvgpr_read_b32 v219, a99
    v_pk_mul_f32 v[216:217], v[216:217], v[58:59] op_sel:[0,0] op_sel_hi:[1,0]
    v_pk_mul_f32 v[218:219], v[218:219], v[58:59] op_sel:[0,0] op_sel_hi:[1,0]
    v_cvt_pk_bf16_f32 v140, v216, v217
    v_cvt_pk_bf16_f32 v141, v218, v219
    v_accvgpr_read_b32 v220, a100
    v_accvgpr_read_b32 v221, a101
    v_accvgpr_read_b32 v222, a102
    v_accvgpr_read_b32 v223, a103
    v_pk_mul_f32 v[220:221], v[220:221], v[58:59] op_sel:[0,1] op_sel_hi:[1,1]
    v_pk_mul_f32 v[222:223], v[222:223], v[58:59] op_sel:[0,1] op_sel_hi:[1,1]
    v_cvt_pk_bf16_f32 v172, v220, v221
    v_cvt_pk_bf16_f32 v173, v222, v223
    v_accvgpr_read_b32 v224, a104
    v_accvgpr_read_b32 v225, a105
    v_accvgpr_read_b32 v226, a106
    v_accvgpr_read_b32 v227, a107
    v_pk_mul_f32 v[224:225], v[224:225], v[60:61] op_sel:[0,0] op_sel_hi:[1,0]
    v_pk_mul_f32 v[226:227], v[226:227], v[60:61] op_sel:[0,0] op_sel_hi:[1,0]
    v_cvt_pk_bf16_f32 v156, v224, v225
    v_cvt_pk_bf16_f32 v157, v226, v227
    v_accvgpr_read_b32 v228, a108
    v_accvgpr_read_b32 v229, a109
    v_accvgpr_read_b32 v230, a110
    v_accvgpr_read_b32 v231, a111
    v_pk_mul_f32 v[228:229], v[228:229], v[60:61] op_sel:[0,1] op_sel_hi:[1,1]
    v_pk_mul_f32 v[230:231], v[230:231], v[60:61] op_sel:[0,1] op_sel_hi:[1,1]
    v_cvt_pk_bf16_f32 v188, v228, v229
    v_cvt_pk_bf16_f32 v189, v230, v231
    v_accvgpr_read_b32 v216, a112
    v_accvgpr_read_b32 v217, a113
    v_accvgpr_read_b32 v218, a114
    v_accvgpr_read_b32 v219, a115
    v_pk_mul_f32 v[216:217], v[216:217], v[58:59] op_sel:[0,0] op_sel_hi:[1,0]
    v_pk_mul_f32 v[218:219], v[218:219], v[58:59] op_sel:[0,0] op_sel_hi:[1,0]
    v_cvt_pk_bf16_f32 v142, v216, v217
    v_cvt_pk_bf16_f32 v143, v218, v219
    v_accvgpr_read_b32 v220, a116
    v_accvgpr_read_b32 v221, a117
    v_accvgpr_read_b32 v222, a118
    v_accvgpr_read_b32 v223, a119
    v_pk_mul_f32 v[220:221], v[220:221], v[58:59] op_sel:[0,1] op_sel_hi:[1,1]
    v_pk_mul_f32 v[222:223], v[222:223], v[58:59] op_sel:[0,1] op_sel_hi:[1,1]
    v_cvt_pk_bf16_f32 v174, v220, v221
    v_cvt_pk_bf16_f32 v175, v222, v223
    v_accvgpr_read_b32 v224, a120
    v_accvgpr_read_b32 v225, a121
    v_accvgpr_read_b32 v226, a122
    v_accvgpr_read_b32 v227, a123
    v_pk_mul_f32 v[224:225], v[224:225], v[60:61] op_sel:[0,0] op_sel_hi:[1,0]
    v_pk_mul_f32 v[226:227], v[226:227], v[60:61] op_sel:[0,0] op_sel_hi:[1,0]
    v_cvt_pk_bf16_f32 v158, v224, v225
    v_cvt_pk_bf16_f32 v159, v226, v227
    v_accvgpr_read_b32 v228, a124
    v_accvgpr_read_b32 v229, a125
    v_accvgpr_read_b32 v230, a126
    v_accvgpr_read_b32 v231, a127
    v_pk_mul_f32 v[228:229], v[228:229], v[60:61] op_sel:[0,1] op_sel_hi:[1,1]
    v_pk_mul_f32 v[230:231], v[230:231], v[60:61] op_sel:[0,1] op_sel_hi:[1,1]
    v_cvt_pk_bf16_f32 v190, v228, v229
    v_cvt_pk_bf16_f32 v191, v230, v231
    s_waitcnt lgkmcnt(14)
    v_mfma_f32_16x16x32_bf16 v[192:195], a[128:131], v[128:131], 0
    s_waitcnt lgkmcnt(12)
    ds_read_b64_tr_b16 a[160:161], v29 offset:0
    v_mfma_f32_16x16x32_bf16 v[192:195], a[132:135], v[132:135], v[192:195]
    s_waitcnt lgkmcnt(11)
    ds_read_b64_tr_b16 a[162:163], v29 offset:4096
    v_mfma_f32_16x16x32_bf16 v[192:195], a[136:139], v[136:139], v[192:195]
    s_waitcnt lgkmcnt(10)
    ds_read_b64_tr_b16 a[164:165], v29 offset:8192
    v_lshrrev_b32 v2, 2, v0
    v_mfma_f32_16x16x32_bf16 v[192:195], a[140:143], v[140:143], v[192:195]
    s_waitcnt lgkmcnt(9)
    ds_read_b64_tr_b16 a[166:167], v29 offset:12288
    v_mfma_f32_16x16x32_bf16 v[192:195], a[144:147], v[144:147], v[192:195]
    s_waitcnt lgkmcnt(8)
    ds_read_b64_tr_b16 a[168:169], v29 offset:16384
    v_mfma_f32_16x16x32_bf16 v[192:195], a[148:151], v[148:151], v[192:195]
    s_waitcnt lgkmcnt(7)
    ds_read_b64_tr_b16 a[170:171], v29 offset:20480
    v_mfma_f32_16x16x32_bf16 v[192:195], a[152:155], v[152:155], v[192:195]
    s_waitcnt lgkmcnt(6)
    ds_read_b64_tr_b16 a[172:173], v29 offset:24576
    v_mfma_f32_16x16x32_bf16 v[192:195], a[156:159], v[156:159], v[192:195]
    ds_read_b64_tr_b16 a[174:175], v29 offset:28672
    v_mfma_f32_16x16x32_bf16 v[196:199], a[128:131], v[160:163], 0
    ds_read_b64_tr_b16 a[176:177], v33 offset:0
    v_mfma_f32_16x16x32_bf16 v[196:199], a[132:135], v[164:167], v[196:199]
    ds_read_b64_tr_b16 a[178:179], v33 offset:4096
    v_mfma_f32_16x16x32_bf16 v[196:199], a[136:139], v[168:171], v[196:199]
    ds_read_b64_tr_b16 a[180:181], v33 offset:8192
    v_mul_u32_u24 v2, 9216, v2
    v_mfma_f32_16x16x32_bf16 v[196:199], a[140:143], v[172:175], v[196:199]
    ds_read_b64_tr_b16 a[182:183], v33 offset:12288
    v_mfma_f32_16x16x32_bf16 v[196:199], a[144:147], v[176:179], v[196:199]
    ds_read_b64_tr_b16 a[184:185], v33 offset:16384
    v_cvt_pk_bf16_f32 v224, v192, v193
    v_mfma_f32_16x16x32_bf16 v[196:199], a[148:151], v[180:183], v[196:199]
    ds_read_b64_tr_b16 a[186:187], v33 offset:20480
    v_cvt_pk_bf16_f32 v225, v194, v195
    v_mfma_f32_16x16x32_bf16 v[196:199], a[152:155], v[184:187], v[196:199]
    ds_read_b64_tr_b16 a[188:189], v33 offset:24576
    v_mfma_f32_16x16x32_bf16 v[196:199], a[156:159], v[188:191], v[196:199]
    s_waitcnt lgkmcnt(13)
    ds_read_b64_tr_b16 a[190:191], v33 offset:28672
    v_mfma_f32_16x16x32_bf16 v[200:203], a[160:163], v[128:131], 0
    s_waitcnt lgkmcnt(12)
    ds_read_b64_tr_b16 a[128:129], v30 offset:0
    v_mfma_f32_16x16x32_bf16 v[200:203], a[164:167], v[132:135], v[200:203]
    s_waitcnt lgkmcnt(11)
    ds_read_b64_tr_b16 a[130:131], v30 offset:4096
    v_mfma_f32_16x16x32_bf16 v[200:203], a[168:171], v[136:139], v[200:203]
    s_waitcnt lgkmcnt(10)
    ds_read_b64_tr_b16 a[132:133], v30 offset:8192
    v_and_b32 v3, 3, v0
    v_mfma_f32_16x16x32_bf16 v[200:203], a[172:175], v[140:143], v[200:203]
    s_waitcnt lgkmcnt(9)
    ds_read_b64_tr_b16 a[134:135], v30 offset:12288
    v_mfma_f32_16x16x32_bf16 v[200:203], a[176:179], v[144:147], v[200:203]
    s_waitcnt lgkmcnt(8)
    ds_read_b64_tr_b16 a[136:137], v30 offset:16384
    v_cvt_pk_bf16_f32 v228, v196, v197
    v_mfma_f32_16x16x32_bf16 v[200:203], a[180:183], v[148:151], v[200:203]
    s_waitcnt lgkmcnt(7)
    ds_read_b64_tr_b16 a[138:139], v30 offset:20480
    v_cvt_pk_bf16_f32 v229, v198, v199
    v_mfma_f32_16x16x32_bf16 v[200:203], a[184:187], v[152:155], v[200:203]
    s_waitcnt lgkmcnt(6)
    ds_read_b64_tr_b16 a[140:141], v30 offset:24576
    v_mfma_f32_16x16x32_bf16 v[200:203], a[188:191], v[156:159], v[200:203]
    ds_read_b64_tr_b16 a[142:143], v30 offset:28672
    v_mfma_f32_16x16x32_bf16 v[204:207], a[160:163], v[160:163], 0
    ds_read_b64_tr_b16 a[144:145], v34 offset:0
    v_mfma_f32_16x16x32_bf16 v[204:207], a[164:167], v[164:167], v[204:207]
    ds_read_b64_tr_b16 a[146:147], v34 offset:4096
    v_mfma_f32_16x16x32_bf16 v[204:207], a[168:171], v[168:171], v[204:207]
    ds_read_b64_tr_b16 a[148:149], v34 offset:8192
    v_lshl_add_u32 v57, v3, 4, v2
    v_mfma_f32_16x16x32_bf16 v[204:207], a[172:175], v[172:175], v[204:207]
    ds_read_b64_tr_b16 a[150:151], v34 offset:12288
    v_mfma_f32_16x16x32_bf16 v[204:207], a[176:179], v[176:179], v[204:207]
    ds_read_b64_tr_b16 a[152:153], v34 offset:16384
    v_cvt_pk_bf16_f32 v226, v200, v201
    v_mfma_f32_16x16x32_bf16 v[204:207], a[180:183], v[180:183], v[204:207]
    s_add_u32 s38, s47, 0
    ds_read_b64_tr_b16 a[154:155], v34 offset:20480
    v_cvt_pk_bf16_f32 v227, v202, v203
    v_mfma_f32_16x16x32_bf16 v[204:207], a[184:187], v[184:187], v[204:207]
    ds_read_b64_tr_b16 a[156:157], v34 offset:24576
    buffer_store_dwordx4 v[224:227], v56, s[28:31], s38 offen sc1
    v_mfma_f32_16x16x32_bf16 v[204:207], a[188:191], v[188:191], v[204:207]
    s_waitcnt lgkmcnt(13)
    ds_read_b64_tr_b16 a[158:159], v34 offset:28672
    v_mfma_f32_16x16x32_bf16 v[192:195], a[128:131], v[128:131], 0
    s_waitcnt lgkmcnt(12)
    ds_read_b64_tr_b16 a[160:161], v31 offset:0
    v_mfma_f32_16x16x32_bf16 v[192:195], a[132:135], v[132:135], v[192:195]
    s_waitcnt lgkmcnt(11)
    ds_read_b64_tr_b16 a[162:163], v31 offset:4096
    v_mfma_f32_16x16x32_bf16 v[192:195], a[136:139], v[136:139], v[192:195]
    s_waitcnt lgkmcnt(10)
    ds_read_b64_tr_b16 a[164:165], v31 offset:8192
    v_lshlrev_b32 v62, 4, v0
    v_mfma_f32_16x16x32_bf16 v[192:195], a[140:143], v[140:143], v[192:195]
    s_waitcnt lgkmcnt(9)
    ds_read_b64_tr_b16 a[166:167], v31 offset:12288
    v_mfma_f32_16x16x32_bf16 v[192:195], a[144:147], v[144:147], v[192:195]
    s_waitcnt lgkmcnt(8)
    ds_read_b64_tr_b16 a[168:169], v31 offset:16384
    v_cvt_pk_bf16_f32 v230, v204, v205
    v_mfma_f32_16x16x32_bf16 v[192:195], a[148:151], v[148:151], v[192:195]
    s_waitcnt lgkmcnt(7)
    s_add_u32 s38, s47, 294912
    ds_read_b64_tr_b16 a[170:171], v31 offset:20480
    v_cvt_pk_bf16_f32 v231, v206, v207
    v_mfma_f32_16x16x32_bf16 v[192:195], a[152:155], v[152:155], v[192:195]
    s_waitcnt lgkmcnt(6)
    ds_read_b64_tr_b16 a[172:173], v31 offset:24576
    buffer_store_dwordx4 v[228:231], v56, s[28:31], s38 offen sc1
    v_mfma_f32_16x16x32_bf16 v[192:195], a[156:159], v[156:159], v[192:195]
    ds_read_b64_tr_b16 a[174:175], v31 offset:28672
    v_mfma_f32_16x16x32_bf16 v[196:199], a[128:131], v[160:163], 0
    ds_read_b64_tr_b16 a[176:177], v35 offset:0
    v_mfma_f32_16x16x32_bf16 v[196:199], a[132:135], v[164:167], v[196:199]
    ds_read_b64_tr_b16 a[178:179], v35 offset:4096
    v_mfma_f32_16x16x32_bf16 v[196:199], a[136:139], v[168:171], v[196:199]
    ds_read_b64_tr_b16 a[180:181], v35 offset:8192
    v_mfma_f32_16x16x32_bf16 v[196:199], a[140:143], v[172:175], v[196:199]
    ds_read_b64_tr_b16 a[182:183], v35 offset:12288
    v_mfma_f32_16x16x32_bf16 v[196:199], a[144:147], v[176:179], v[196:199]
    ds_read_b64_tr_b16 a[184:185], v35 offset:16384
    v_cvt_pk_bf16_f32 v232, v192, v193
    v_mfma_f32_16x16x32_bf16 v[196:199], a[148:151], v[180:183], v[196:199]
    ds_read_b64_tr_b16 a[186:187], v35 offset:20480
    v_cvt_pk_bf16_f32 v233, v194, v195
    v_mfma_f32_16x16x32_bf16 v[196:199], a[152:155], v[184:187], v[196:199]
    ds_read_b64_tr_b16 a[188:189], v35 offset:24576
    v_mfma_f32_16x16x32_bf16 v[196:199], a[156:159], v[188:191], v[196:199]
    s_waitcnt lgkmcnt(13)
    ds_read_b64_tr_b16 a[190:191], v35 offset:28672
    s_waitcnt vmcnt(14)
    s_barrier
    v_mfma_f32_16x16x32_bf16 v[200:203], a[160:163], v[128:131], 0
    s_waitcnt lgkmcnt(12)
    ds_read_b64_tr_b16 a[128:129], v12 offset:0
    v_mfma_f32_16x16x32_bf16 v[200:203], a[164:167], v[132:135], v[200:203]
    s_waitcnt lgkmcnt(11)
    s_add_u32 s49, s45, 74112
    ds_read_b64_tr_b16 a[130:131], v12 offset:4096
    v_mfma_f32_16x16x32_bf16 v[200:203], a[168:171], v[136:139], v[200:203]
    s_waitcnt lgkmcnt(10)
    s_add_u32 m0, s42, 81920
    ds_read_b64_tr_b16 a[132:133], v12 offset:8192
    v_mfma_f32_16x16x32_bf16 v[200:203], a[172:175], v[140:143], v[200:203]
    s_waitcnt lgkmcnt(9)
    ds_read_b64_tr_b16 a[134:135], v12 offset:12288
    buffer_load_dwordx4 v46, s[20:23], s49 offen lds
    v_mfma_f32_16x16x32_bf16 v[200:203], a[176:179], v[144:147], v[200:203]
    s_waitcnt lgkmcnt(8)
    ds_read_b64_tr_b16 a[136:137], v12 offset:16384
    v_cvt_pk_bf16_f32 v236, v196, v197
    v_mfma_f32_16x16x32_bf16 v[200:203], a[180:183], v[148:151], v[200:203]
    s_waitcnt lgkmcnt(7)
    ds_read_b64_tr_b16 a[138:139], v12 offset:20480
    v_cvt_pk_bf16_f32 v237, v198, v199
    v_mfma_f32_16x16x32_bf16 v[200:203], a[184:187], v[152:155], v[200:203]
    s_waitcnt lgkmcnt(6)
    ds_read_b64_tr_b16 a[140:141], v12 offset:24576
    v_mfma_f32_16x16x32_bf16 v[200:203], a[188:191], v[156:159], v[200:203]
    ds_read_b64_tr_b16 a[142:143], v12 offset:28672
    buffer_load_dwordx4 v47, s[20:23], s49 offen offset:1024 lds
    v_mfma_f32_16x16x32_bf16 v[204:207], a[160:163], v[160:163], 0
    ds_read_b64_tr_b16 a[144:145], v16 offset:0
    v_mfma_f32_16x16x32_bf16 v[204:207], a[164:167], v[164:167], v[204:207]
    ds_read_b64_tr_b16 a[146:147], v16 offset:4096
    v_mfma_f32_16x16x32_bf16 v[204:207], a[168:171], v[168:171], v[204:207]
    ds_read_b64_tr_b16 a[148:149], v16 offset:8192
    v_mfma_f32_16x16x32_bf16 v[204:207], a[172:175], v[172:175], v[204:207]
    ds_read_b64_tr_b16 a[150:151], v16 offset:12288
    buffer_load_dwordx4 v48, s[20:23], s49 offen offset:2048 lds
    v_mfma_f32_16x16x32_bf16 v[204:207], a[176:179], v[176:179], v[204:207]
    ds_read_b64_tr_b16 a[152:153], v16 offset:16384
    v_cvt_pk_bf16_f32 v234, v200, v201
    v_mfma_f32_16x16x32_bf16 v[204:207], a[180:183], v[180:183], v[204:207]
    s_add_u32 s38, s47, 128
    ds_read_b64_tr_b16 a[154:155], v16 offset:20480
    v_cvt_pk_bf16_f32 v235, v202, v203
    v_mfma_f32_16x16x32_bf16 v[204:207], a[184:187], v[184:187], v[204:207]
    ds_read_b64_tr_b16 a[156:157], v16 offset:24576
    buffer_store_dwordx4 v[232:235], v56, s[28:31], s38 offen sc1
    v_mfma_f32_16x16x32_bf16 v[204:207], a[188:191], v[188:191], v[204:207]
    s_waitcnt lgkmcnt(13)
    ds_read_b64_tr_b16 a[158:159], v16 offset:28672
    buffer_load_dwordx4 v49, s[20:23], s49 offen offset:3072 lds
    v_mfma_f32_16x16x32_bf16 v[192:195], a[128:131], v[128:131], 0
    s_waitcnt lgkmcnt(12)
    ds_read_b64_tr_b16 a[160:161], v13 offset:0
    v_mfma_f32_16x16x32_bf16 v[192:195], a[132:135], v[132:135], v[192:195]
    s_waitcnt lgkmcnt(11)
    s_add_u32 s49, s45, 512
    ds_read_b64_tr_b16 a[162:163], v13 offset:4096
    v_mfma_f32_16x16x32_bf16 v[192:195], a[136:139], v[136:139], v[192:195]
    s_waitcnt lgkmcnt(10)
    s_add_u32 m0, s42, 98304
    ds_read_b64_tr_b16 a[164:165], v13 offset:8192
    v_mfma_f32_16x16x32_bf16 v[192:195], a[140:143], v[140:143], v[192:195]
    s_waitcnt lgkmcnt(9)
    ds_read_b64_tr_b16 a[166:167], v13 offset:12288
    buffer_load_dwordx4 v46, s[20:23], s49 offen lds
    v_mfma_f32_16x16x32_bf16 v[192:195], a[144:147], v[144:147], v[192:195]
    s_waitcnt lgkmcnt(8)
    ds_read_b64_tr_b16 a[168:169], v13 offset:16384
    v_cvt_pk_bf16_f32 v238, v204, v205
    v_mfma_f32_16x16x32_bf16 v[192:195], a[148:151], v[148:151], v[192:195]
    s_waitcnt lgkmcnt(7)
    s_add_u32 s38, s47, 295040
    ds_read_b64_tr_b16 a[170:171], v13 offset:20480
    v_cvt_pk_bf16_f32 v239, v206, v207
    v_mfma_f32_16x16x32_bf16 v[192:195], a[152:155], v[152:155], v[192:195]
    s_waitcnt lgkmcnt(6)
    ds_read_b64_tr_b16 a[172:173], v13 offset:24576
    buffer_store_dwordx4 v[236:239], v56, s[28:31], s38 offen sc1
    v_mfma_f32_16x16x32_bf16 v[192:195], a[156:159], v[156:159], v[192:195]
    ds_read_b64_tr_b16 a[174:175], v13 offset:28672
    buffer_load_dwordx4 v47, s[20:23], s49 offen offset:1024 lds
    v_mfma_f32_16x16x32_bf16 v[196:199], a[128:131], v[160:163], 0
    ds_read_b64_tr_b16 a[176:177], v17 offset:0
    v_mfma_f32_16x16x32_bf16 v[196:199], a[132:135], v[164:167], v[196:199]
    ds_read_b64_tr_b16 a[178:179], v17 offset:4096
    v_mfma_f32_16x16x32_bf16 v[196:199], a[136:139], v[168:171], v[196:199]
    ds_read_b64_tr_b16 a[180:181], v17 offset:8192
    v_mfma_f32_16x16x32_bf16 v[196:199], a[140:143], v[172:175], v[196:199]
    ds_read_b64_tr_b16 a[182:183], v17 offset:12288
    buffer_load_dwordx4 v48, s[20:23], s49 offen offset:2048 lds
    v_mfma_f32_16x16x32_bf16 v[196:199], a[144:147], v[176:179], v[196:199]
    ds_read_b64_tr_b16 a[184:185], v17 offset:16384
    v_cvt_pk_bf16_f32 v224, v192, v193
    v_mfma_f32_16x16x32_bf16 v[196:199], a[148:151], v[180:183], v[196:199]
    ds_read_b64_tr_b16 a[186:187], v17 offset:20480
    v_cvt_pk_bf16_f32 v225, v194, v195
    v_mfma_f32_16x16x32_bf16 v[196:199], a[152:155], v[184:187], v[196:199]
    ds_read_b64_tr_b16 a[188:189], v17 offset:24576
    v_mfma_f32_16x16x32_bf16 v[196:199], a[156:159], v[188:191], v[196:199]
    s_waitcnt lgkmcnt(13)
    ds_read_b64_tr_b16 a[190:191], v17 offset:28672
    buffer_load_dwordx4 v49, s[20:23], s49 offen offset:3072 lds
    v_mfma_f32_16x16x32_bf16 v[200:203], a[160:163], v[128:131], 0
    s_waitcnt lgkmcnt(12)
    ds_read_b64_tr_b16 a[128:129], v14 offset:0
    v_mfma_f32_16x16x32_bf16 v[200:203], a[164:167], v[132:135], v[200:203]
    s_waitcnt lgkmcnt(11)
    s_add_u32 s49, s45, 74240
    ds_read_b64_tr_b16 a[130:131], v14 offset:4096
    v_mfma_f32_16x16x32_bf16 v[200:203], a[168:171], v[136:139], v[200:203]
    s_waitcnt lgkmcnt(10)
    s_add_u32 m0, s42, 114688
    ds_read_b64_tr_b16 a[132:133], v14 offset:8192
    v_mfma_f32_16x16x32_bf16 v[200:203], a[172:175], v[140:143], v[200:203]
    s_waitcnt lgkmcnt(9)
    ds_read_b64_tr_b16 a[134:135], v14 offset:12288
    buffer_load_dwordx4 v46, s[20:23], s49 offen lds
    v_mfma_f32_16x16x32_bf16 v[200:203], a[176:179], v[144:147], v[200:203]
    s_waitcnt lgkmcnt(8)
    ds_read_b64_tr_b16 a[136:137], v14 offset:16384
    v_cvt_pk_bf16_f32 v228, v196, v197
    v_mfma_f32_16x16x32_bf16 v[200:203], a[180:183], v[148:151], v[200:203]
    s_waitcnt lgkmcnt(7)
    ds_read_b64_tr_b16 a[138:139], v14 offset:20480
    v_cvt_pk_bf16_f32 v229, v198, v199
    v_mfma_f32_16x16x32_bf16 v[200:203], a[184:187], v[152:155], v[200:203]
    s_waitcnt lgkmcnt(6)
    ds_read_b64_tr_b16 a[140:141], v14 offset:24576
    v_mfma_f32_16x16x32_bf16 v[200:203], a[188:191], v[156:159], v[200:203]
    ds_read_b64_tr_b16 a[142:143], v14 offset:28672
    buffer_load_dwordx4 v47, s[20:23], s49 offen offset:1024 lds
    v_mfma_f32_16x16x32_bf16 v[204:207], a[160:163], v[160:163], 0
    ds_read_b64_tr_b16 a[144:145], v18 offset:0
    v_mfma_f32_16x16x32_bf16 v[204:207], a[164:167], v[164:167], v[204:207]
    ds_read_b64_tr_b16 a[146:147], v18 offset:4096
    v_mfma_f32_16x16x32_bf16 v[204:207], a[168:171], v[168:171], v[204:207]
    ds_read_b64_tr_b16 a[148:149], v18 offset:8192
    v_mfma_f32_16x16x32_bf16 v[204:207], a[172:175], v[172:175], v[204:207]
    ds_read_b64_tr_b16 a[150:151], v18 offset:12288
    buffer_load_dwordx4 v48, s[20:23], s49 offen offset:2048 lds
    v_mfma_f32_16x16x32_bf16 v[204:207], a[176:179], v[176:179], v[204:207]
    ds_read_b64_tr_b16 a[152:153], v18 offset:16384
    v_cvt_pk_bf16_f32 v226, v200, v201
    v_mfma_f32_16x16x32_bf16 v[204:207], a[180:183], v[180:183], v[204:207]
    s_add_u32 s38, s47, 256
    ds_read_b64_tr_b16 a[154:155], v18 offset:20480
    v_cvt_pk_bf16_f32 v227, v202, v203
    v_mfma_f32_16x16x32_bf16 v[204:207], a[184:187], v[184:187], v[204:207]
    ds_read_b64_tr_b16 a[156:157], v18 offset:24576
    buffer_store_dwordx4 v[224:227], v56, s[28:31], s38 offen sc1
    v_mfma_f32_16x16x32_bf16 v[204:207], a[188:191], v[188:191], v[204:207]
    s_waitcnt lgkmcnt(13)
    ds_read_b64_tr_b16 a[158:159], v18 offset:28672
    buffer_load_dwordx4 v49, s[20:23], s49 offen offset:3072 lds
    v_mfma_f32_16x16x32_bf16 v[192:195], a[128:131], v[128:131], 0
    s_waitcnt lgkmcnt(12)
    ds_read_b64_tr_b16 a[160:161], v15 offset:0
    v_mfma_f32_16x16x32_bf16 v[192:195], a[132:135], v[132:135], v[192:195]
    s_waitcnt lgkmcnt(11)
    ds_read_b64_tr_b16 a[162:163], v15 offset:4096
    v_mfma_f32_16x16x32_bf16 v[192:195], a[136:139], v[136:139], v[192:195]
    s_waitcnt lgkmcnt(10)
    ds_read_b64_tr_b16 a[164:165], v15 offset:8192
    v_mfma_f32_16x16x32_bf16 v[192:195], a[140:143], v[140:143], v[192:195]
    s_waitcnt lgkmcnt(9)
    ds_read_b64_tr_b16 a[166:167], v15 offset:12288
    v_mfma_f32_16x16x32_bf16 v[192:195], a[144:147], v[144:147], v[192:195]
    s_waitcnt lgkmcnt(8)
    ds_read_b64_tr_b16 a[168:169], v15 offset:16384
    v_cvt_pk_bf16_f32 v230, v204, v205
    v_mfma_f32_16x16x32_bf16 v[192:195], a[148:151], v[148:151], v[192:195]
    s_waitcnt lgkmcnt(7)
    s_add_u32 s38, s47, 295168
    ds_read_b64_tr_b16 a[170:171], v15 offset:20480
    v_cvt_pk_bf16_f32 v231, v206, v207
    v_mfma_f32_16x16x32_bf16 v[192:195], a[152:155], v[152:155], v[192:195]
    s_waitcnt lgkmcnt(6)
    ds_read_b64_tr_b16 a[172:173], v15 offset:24576
    buffer_store_dwordx4 v[228:231], v56, s[28:31], s38 offen sc1
    v_mfma_f32_16x16x32_bf16 v[192:195], a[156:159], v[156:159], v[192:195]
    ds_read_b64_tr_b16 a[174:175], v15 offset:28672
    v_mfma_f32_16x16x32_bf16 v[196:199], a[128:131], v[160:163], 0
    ds_read_b64_tr_b16 a[176:177], v19 offset:0
    v_mfma_f32_16x16x32_bf16 v[196:199], a[132:135], v[164:167], v[196:199]
    ds_read_b64_tr_b16 a[178:179], v19 offset:4096
    v_mfma_f32_16x16x32_bf16 v[196:199], a[136:139], v[168:171], v[196:199]
    ds_read_b64_tr_b16 a[180:181], v19 offset:8192
    v_mfma_f32_16x16x32_bf16 v[196:199], a[140:143], v[172:175], v[196:199]
    ds_read_b64_tr_b16 a[182:183], v19 offset:12288
    v_mfma_f32_16x16x32_bf16 v[196:199], a[144:147], v[176:179], v[196:199]
    ds_read_b64_tr_b16 a[184:185], v19 offset:16384
    v_cvt_pk_bf16_f32 v232, v192, v193
    v_mfma_f32_16x16x32_bf16 v[196:199], a[148:151], v[180:183], v[196:199]
    ds_read_b64_tr_b16 a[186:187], v19 offset:20480
    v_cvt_pk_bf16_f32 v233, v194, v195
    v_mfma_f32_16x16x32_bf16 v[196:199], a[152:155], v[184:187], v[196:199]
    ds_read_b64_tr_b16 a[188:189], v19 offset:24576
    v_mfma_f32_16x16x32_bf16 v[196:199], a[156:159], v[188:191], v[196:199]
    s_waitcnt lgkmcnt(13)
    ds_read_b64_tr_b16 a[190:191], v19 offset:28672
    s_waitcnt vmcnt(22)
    s_barrier
    v_mfma_f32_16x16x32_bf16 v[200:203], a[160:163], v[128:131], 0
    s_waitcnt lgkmcnt(12)
    ds_read_b64_tr_b16 a[128:129], v12 offset:32768
    v_mfma_f32_16x16x32_bf16 v[200:203], a[164:167], v[132:135], v[200:203]
    s_waitcnt lgkmcnt(11)
    s_add_u32 s49, s45, 640
    ds_read_b64_tr_b16 a[130:131], v12 offset:36864
    v_mfma_f32_16x16x32_bf16 v[200:203], a[168:171], v[136:139], v[200:203]
    s_waitcnt lgkmcnt(10)
    s_add_u32 m0, s42, 131072
    ds_read_b64_tr_b16 a[132:133], v12 offset:40960
    v_mfma_f32_16x16x32_bf16 v[200:203], a[172:175], v[140:143], v[200:203]
    s_waitcnt lgkmcnt(9)
    ds_read_b64_tr_b16 a[134:135], v12 offset:45056
    buffer_load_dwordx4 v46, s[20:23], s49 offen lds
    v_mfma_f32_16x16x32_bf16 v[200:203], a[176:179], v[144:147], v[200:203]
    s_waitcnt lgkmcnt(8)
    ds_read_b64_tr_b16 a[136:137], v12 offset:49152
    v_cvt_pk_bf16_f32 v236, v196, v197
    v_mfma_f32_16x16x32_bf16 v[200:203], a[180:183], v[148:151], v[200:203]
    s_waitcnt lgkmcnt(7)
    ds_read_b64_tr_b16 a[138:139], v12 offset:53248
    v_cvt_pk_bf16_f32 v237, v198, v199
    v_mfma_f32_16x16x32_bf16 v[200:203], a[184:187], v[152:155], v[200:203]
    s_waitcnt lgkmcnt(6)
    ds_read_b64_tr_b16 a[140:141], v12 offset:57344
    v_mfma_f32_16x16x32_bf16 v[200:203], a[188:191], v[156:159], v[200:203]
    ds_read_b64_tr_b16 a[142:143], v12 offset:61440
    buffer_load_dwordx4 v47, s[20:23], s49 offen offset:1024 lds
    v_mfma_f32_16x16x32_bf16 v[204:207], a[160:163], v[160:163], 0
    ds_read_b64_tr_b16 a[144:145], v16 offset:32768
    v_mfma_f32_16x16x32_bf16 v[204:207], a[164:167], v[164:167], v[204:207]
    ds_read_b64_tr_b16 a[146:147], v16 offset:36864
    v_mfma_f32_16x16x32_bf16 v[204:207], a[168:171], v[168:171], v[204:207]
    ds_read_b64_tr_b16 a[148:149], v16 offset:40960
    v_mfma_f32_16x16x32_bf16 v[204:207], a[172:175], v[172:175], v[204:207]
    ds_read_b64_tr_b16 a[150:151], v16 offset:45056
    buffer_load_dwordx4 v48, s[20:23], s49 offen offset:2048 lds
    v_mfma_f32_16x16x32_bf16 v[204:207], a[176:179], v[176:179], v[204:207]
    ds_read_b64_tr_b16 a[152:153], v16 offset:49152
    v_cvt_pk_bf16_f32 v234, v200, v201
    v_mfma_f32_16x16x32_bf16 v[204:207], a[180:183], v[180:183], v[204:207]
    s_add_u32 s38, s47, 384
    ds_read_b64_tr_b16 a[154:155], v16 offset:53248
    v_cvt_pk_bf16_f32 v235, v202, v203
    v_mfma_f32_16x16x32_bf16 v[204:207], a[184:187], v[184:187], v[204:207]
    ds_read_b64_tr_b16 a[156:157], v16 offset:57344
    buffer_store_dwordx4 v[232:235], v56, s[28:31], s38 offen sc1
    v_mfma_f32_16x16x32_bf16 v[204:207], a[188:191], v[188:191], v[204:207]
    s_waitcnt lgkmcnt(13)
    ds_read_b64_tr_b16 a[158:159], v16 offset:61440
    buffer_load_dwordx4 v49, s[20:23], s49 offen offset:3072 lds
    v_mfma_f32_16x16x32_bf16 v[192:195], a[128:131], v[128:131], 0
    s_waitcnt lgkmcnt(12)
    ds_read_b64_tr_b16 a[160:161], v13 offset:32768
    v_mfma_f32_16x16x32_bf16 v[192:195], a[132:135], v[132:135], v[192:195]
    s_waitcnt lgkmcnt(11)
    s_add_u32 s49, s45, 74368
    ds_read_b64_tr_b16 a[162:163], v13 offset:36864
    v_mfma_f32_16x16x32_bf16 v[192:195], a[136:139], v[136:139], v[192:195]
    s_waitcnt lgkmcnt(10)
    s_add_u32 m0, s42, 147456
    ds_read_b64_tr_b16 a[164:165], v13 offset:40960
    v_mfma_f32_16x16x32_bf16 v[192:195], a[140:143], v[140:143], v[192:195]
    s_waitcnt lgkmcnt(9)
    ds_read_b64_tr_b16 a[166:167], v13 offset:45056
    buffer_load_dwordx4 v46, s[20:23], s49 offen lds
    v_mfma_f32_16x16x32_bf16 v[192:195], a[144:147], v[144:147], v[192:195]
    s_waitcnt lgkmcnt(8)
    ds_read_b64_tr_b16 a[168:169], v13 offset:49152
    v_cvt_pk_bf16_f32 v238, v204, v205
    v_mfma_f32_16x16x32_bf16 v[192:195], a[148:151], v[148:151], v[192:195]
    s_waitcnt lgkmcnt(7)
    s_add_u32 s38, s47, 295296
    ds_read_b64_tr_b16 a[170:171], v13 offset:53248
    v_cvt_pk_bf16_f32 v239, v206, v207
    v_mfma_f32_16x16x32_bf16 v[192:195], a[152:155], v[152:155], v[192:195]
    s_waitcnt lgkmcnt(6)
    ds_read_b64_tr_b16 a[172:173], v13 offset:57344
    buffer_store_dwordx4 v[236:239], v56, s[28:31], s38 offen sc1
    v_mfma_f32_16x16x32_bf16 v[192:195], a[156:159], v[156:159], v[192:195]
    ds_read_b64_tr_b16 a[174:175], v13 offset:61440
    buffer_load_dwordx4 v47, s[20:23], s49 offen offset:1024 lds
    v_mfma_f32_16x16x32_bf16 v[196:199], a[128:131], v[160:163], 0
    ds_read_b64_tr_b16 a[176:177], v17 offset:32768
    v_mfma_f32_16x16x32_bf16 v[196:199], a[132:135], v[164:167], v[196:199]
    ds_read_b64_tr_b16 a[178:179], v17 offset:36864
    v_mfma_f32_16x16x32_bf16 v[196:199], a[136:139], v[168:171], v[196:199]
    ds_read_b64_tr_b16 a[180:181], v17 offset:40960
    v_mfma_f32_16x16x32_bf16 v[196:199], a[140:143], v[172:175], v[196:199]
    ds_read_b64_tr_b16 a[182:183], v17 offset:45056
    buffer_load_dwordx4 v48, s[20:23], s49 offen offset:2048 lds
    v_mfma_f32_16x16x32_bf16 v[196:199], a[144:147], v[176:179], v[196:199]
    ds_read_b64_tr_b16 a[184:185], v17 offset:49152
    v_cvt_pk_bf16_f32 v224, v192, v193
    v_mfma_f32_16x16x32_bf16 v[196:199], a[148:151], v[180:183], v[196:199]
    ds_read_b64_tr_b16 a[186:187], v17 offset:53248
    v_cvt_pk_bf16_f32 v225, v194, v195
    v_mfma_f32_16x16x32_bf16 v[196:199], a[152:155], v[184:187], v[196:199]
    ds_read_b64_tr_b16 a[188:189], v17 offset:57344
    v_mfma_f32_16x16x32_bf16 v[196:199], a[156:159], v[188:191], v[196:199]
    s_waitcnt lgkmcnt(13)
    ds_read_b64_tr_b16 a[190:191], v17 offset:61440
    buffer_load_dwordx4 v49, s[20:23], s49 offen offset:3072 lds
    v_mfma_f32_16x16x32_bf16 v[200:203], a[160:163], v[128:131], 0
    s_waitcnt lgkmcnt(12)
    ds_read_b64_tr_b16 a[128:129], v14 offset:32768
    v_mfma_f32_16x16x32_bf16 v[200:203], a[164:167], v[132:135], v[200:203]
    s_waitcnt lgkmcnt(11)
    ds_read_b64_tr_b16 a[130:131], v14 offset:36864
    v_mfma_f32_16x16x32_bf16 v[200:203], a[168:171], v[136:139], v[200:203]
    s_waitcnt lgkmcnt(10)
    ds_read_b64_tr_b16 a[132:133], v14 offset:40960
    v_mfma_f32_16x16x32_bf16 v[200:203], a[172:175], v[140:143], v[200:203]
    s_waitcnt lgkmcnt(9)
    ds_read_b64_tr_b16 a[134:135], v14 offset:45056
    v_mfma_f32_16x16x32_bf16 v[200:203], a[176:179], v[144:147], v[200:203]
    s_waitcnt lgkmcnt(8)
    ds_read_b64_tr_b16 a[136:137], v14 offset:49152
    v_cvt_pk_bf16_f32 v228, v196, v197
    v_mfma_f32_16x16x32_bf16 v[200:203], a[180:183], v[148:151], v[200:203]
    s_waitcnt lgkmcnt(7)
    ds_read_b64_tr_b16 a[138:139], v14 offset:53248
    v_cvt_pk_bf16_f32 v229, v198, v199
    v_mfma_f32_16x16x32_bf16 v[200:203], a[184:187], v[152:155], v[200:203]
    s_waitcnt lgkmcnt(6)
    ds_read_b64_tr_b16 a[140:141], v14 offset:57344
    v_mfma_f32_16x16x32_bf16 v[200:203], a[188:191], v[156:159], v[200:203]
    ds_read_b64_tr_b16 a[142:143], v14 offset:61440
    v_mfma_f32_16x16x32_bf16 v[204:207], a[160:163], v[160:163], 0
    ds_read_b64_tr_b16 a[144:145], v18 offset:32768
    v_mfma_f32_16x16x32_bf16 v[204:207], a[164:167], v[164:167], v[204:207]
    ds_read_b64_tr_b16 a[146:147], v18 offset:36864
    v_mfma_f32_16x16x32_bf16 v[204:207], a[168:171], v[168:171], v[204:207]
    ds_read_b64_tr_b16 a[148:149], v18 offset:40960
    v_mfma_f32_16x16x32_bf16 v[204:207], a[172:175], v[172:175], v[204:207]
    ds_read_b64_tr_b16 a[150:151], v18 offset:45056
    v_mfma_f32_16x16x32_bf16 v[204:207], a[176:179], v[176:179], v[204:207]
    ds_read_b64_tr_b16 a[152:153], v18 offset:49152
    v_cvt_pk_bf16_f32 v226, v200, v201
    v_mfma_f32_16x16x32_bf16 v[204:207], a[180:183], v[180:183], v[204:207]
    s_add_u32 s38, s47, 512
    ds_read_b64_tr_b16 a[154:155], v18 offset:53248
    v_cvt_pk_bf16_f32 v227, v202, v203
    v_mfma_f32_16x16x32_bf16 v[204:207], a[184:187], v[184:187], v[204:207]
    ds_read_b64_tr_b16 a[156:157], v18 offset:57344
    buffer_store_dwordx4 v[224:227], v56, s[28:31], s38 offen sc1
    v_mfma_f32_16x16x32_bf16 v[204:207], a[188:191], v[188:191], v[204:207]
    s_waitcnt lgkmcnt(13)
    ds_read_b64_tr_b16 a[158:159], v18 offset:61440
    v_mfma_f32_16x16x32_bf16 v[192:195], a[128:131], v[128:131], 0
    s_waitcnt lgkmcnt(12)
    ds_read_b64_tr_b16 a[160:161], v15 offset:32768
    v_mfma_f32_16x16x32_bf16 v[192:195], a[132:135], v[132:135], v[192:195]
    s_waitcnt lgkmcnt(11)
    ds_read_b64_tr_b16 a[162:163], v15 offset:36864
    v_mfma_f32_16x16x32_bf16 v[192:195], a[136:139], v[136:139], v[192:195]
    s_waitcnt lgkmcnt(10)
    ds_read_b64_tr_b16 a[164:165], v15 offset:40960
    v_mfma_f32_16x16x32_bf16 v[192:195], a[140:143], v[140:143], v[192:195]
    s_waitcnt lgkmcnt(9)
    ds_read_b64_tr_b16 a[166:167], v15 offset:45056
    v_mfma_f32_16x16x32_bf16 v[192:195], a[144:147], v[144:147], v[192:195]
    s_waitcnt lgkmcnt(8)
    ds_read_b64_tr_b16 a[168:169], v15 offset:49152
    v_cvt_pk_bf16_f32 v230, v204, v205
    v_mfma_f32_16x16x32_bf16 v[192:195], a[148:151], v[148:151], v[192:195]
    s_waitcnt lgkmcnt(7)
    s_add_u32 s38, s47, 295424
    ds_read_b64_tr_b16 a[170:171], v15 offset:53248
    v_cvt_pk_bf16_f32 v231, v206, v207
    v_mfma_f32_16x16x32_bf16 v[192:195], a[152:155], v[152:155], v[192:195]
    s_waitcnt lgkmcnt(6)
    ds_read_b64_tr_b16 a[172:173], v15 offset:57344
    buffer_store_dwordx4 v[228:231], v56, s[28:31], s38 offen sc1
    v_mfma_f32_16x16x32_bf16 v[192:195], a[156:159], v[156:159], v[192:195]
    ds_read_b64_tr_b16 a[174:175], v15 offset:61440
    v_mfma_f32_16x16x32_bf16 v[196:199], a[128:131], v[160:163], 0
    ds_read_b64_tr_b16 a[176:177], v19 offset:32768
    v_mfma_f32_16x16x32_bf16 v[196:199], a[132:135], v[164:167], v[196:199]
    ds_read_b64_tr_b16 a[178:179], v19 offset:36864
    v_mfma_f32_16x16x32_bf16 v[196:199], a[136:139], v[168:171], v[196:199]
    ds_read_b64_tr_b16 a[180:181], v19 offset:40960
    v_mfma_f32_16x16x32_bf16 v[196:199], a[140:143], v[172:175], v[196:199]
    ds_read_b64_tr_b16 a[182:183], v19 offset:45056
    v_mfma_f32_16x16x32_bf16 v[196:199], a[144:147], v[176:179], v[196:199]
    ds_read_b64_tr_b16 a[184:185], v19 offset:49152
    v_cvt_pk_bf16_f32 v232, v192, v193
    v_mfma_f32_16x16x32_bf16 v[196:199], a[148:151], v[180:183], v[196:199]
    ds_read_b64_tr_b16 a[186:187], v19 offset:53248
    v_cvt_pk_bf16_f32 v233, v194, v195
    v_mfma_f32_16x16x32_bf16 v[196:199], a[152:155], v[184:187], v[196:199]
    ds_read_b64_tr_b16 a[188:189], v19 offset:57344
    v_mfma_f32_16x16x32_bf16 v[196:199], a[156:159], v[188:191], v[196:199]
    s_waitcnt lgkmcnt(13)
    ds_read_b64_tr_b16 a[190:191], v19 offset:61440
    s_waitcnt vmcnt(23)
    s_barrier
    v_mfma_f32_16x16x32_bf16 v[200:203], a[160:163], v[128:131], 0
    s_waitcnt lgkmcnt(12)
    ds_read_b64_tr_b16 a[128:129], v20 offset:0
    v_mfma_f32_16x16x32_bf16 v[200:203], a[164:167], v[132:135], v[200:203]
    s_waitcnt lgkmcnt(11)
    s_add_u32 s49, s45, 768
    ds_read_b64_tr_b16 a[130:131], v20 offset:4096
    v_mfma_f32_16x16x32_bf16 v[200:203], a[168:171], v[136:139], v[200:203]
    s_waitcnt lgkmcnt(10)
    s_add_u32 m0, s42, 0
    ds_read_b64_tr_b16 a[132:133], v20 offset:8192
    v_mfma_f32_16x16x32_bf16 v[200:203], a[172:175], v[140:143], v[200:203]
    s_waitcnt lgkmcnt(9)
    ds_read_b64_tr_b16 a[134:135], v20 offset:12288
    buffer_load_dwordx4 v46, s[20:23], s49 offen lds
    v_mfma_f32_16x16x32_bf16 v[200:203], a[176:179], v[144:147], v[200:203]
    s_waitcnt lgkmcnt(8)
    ds_read_b64_tr_b16 a[136:137], v20 offset:16384
    v_cvt_pk_bf16_f32 v236, v196, v197
    v_mfma_f32_16x16x32_bf16 v[200:203], a[180:183], v[148:151], v[200:203]
    s_waitcnt lgkmcnt(7)
    ds_read_b64_tr_b16 a[138:139], v20 offset:20480
    v_cvt_pk_bf16_f32 v237, v198, v199
    v_mfma_f32_16x16x32_bf16 v[200:203], a[184:187], v[152:155], v[200:203]
    s_waitcnt lgkmcnt(6)
    ds_read_b64_tr_b16 a[140:141], v20 offset:24576
    v_mfma_f32_16x16x32_bf16 v[200:203], a[188:191], v[156:159], v[200:203]
    ds_read_b64_tr_b16 a[142:143], v20 offset:28672
    buffer_load_dwordx4 v47, s[20:23], s49 offen offset:1024 lds
    v_mfma_f32_16x16x32_bf16 v[204:207], a[160:163], v[160:163], 0
    ds_read_b64_tr_b16 a[144:145], v24 offset:0
    v_mfma_f32_16x16x32_bf16 v[204:207], a[164:167], v[164:167], v[204:207]
    ds_read_b64_tr_b16 a[146:147], v24 offset:4096
    v_mfma_f32_16x16x32_bf16 v[204:207], a[168:171], v[168:171], v[204:207]
    ds_read_b64_tr_b16 a[148:149], v24 offset:8192
    v_mfma_f32_16x16x32_bf16 v[204:207], a[172:175], v[172:175], v[204:207]
    ds_read_b64_tr_b16 a[150:151], v24 offset:12288
    buffer_load_dwordx4 v48, s[20:23], s49 offen offset:2048 lds
    v_mfma_f32_16x16x32_bf16 v[204:207], a[176:179], v[176:179], v[204:207]
    ds_read_b64_tr_b16 a[152:153], v24 offset:16384
    v_cvt_pk_bf16_f32 v234, v200, v201
    v_mfma_f32_16x16x32_bf16 v[204:207], a[180:183], v[180:183], v[204:207]
    s_add_u32 s38, s47, 640
    ds_read_b64_tr_b16 a[154:155], v24 offset:20480
    v_cvt_pk_bf16_f32 v235, v202, v203
    v_mfma_f32_16x16x32_bf16 v[204:207], a[184:187], v[184:187], v[204:207]
    ds_read_b64_tr_b16 a[156:157], v24 offset:24576
    buffer_store_dwordx4 v[232:235], v56, s[28:31], s38 offen sc1
    v_mfma_f32_16x16x32_bf16 v[204:207], a[188:191], v[188:191], v[204:207]
    s_waitcnt lgkmcnt(13)
    ds_read_b64_tr_b16 a[158:159], v24 offset:28672
    buffer_load_dwordx4 v49, s[20:23], s49 offen offset:3072 lds
    v_mfma_f32_16x16x32_bf16 v[192:195], a[128:131], v[128:131], 0
    s_waitcnt lgkmcnt(12)
    ds_read_b64_tr_b16 a[160:161], v21 offset:0
    v_mfma_f32_16x16x32_bf16 v[192:195], a[132:135], v[132:135], v[192:195]
    s_waitcnt lgkmcnt(11)
    s_add_u32 s49, s45, 74496
    ds_read_b64_tr_b16 a[162:163], v21 offset:4096
    v_mfma_f32_16x16x32_bf16 v[192:195], a[136:139], v[136:139], v[192:195]
    s_waitcnt lgkmcnt(10)
    s_add_u32 m0, s42, 16384
    ds_read_b64_tr_b16 a[164:165], v21 offset:8192
    v_mfma_f32_16x16x32_bf16 v[192:195], a[140:143], v[140:143], v[192:195]
    s_waitcnt lgkmcnt(9)
    ds_read_b64_tr_b16 a[166:167], v21 offset:12288
    buffer_load_dwordx4 v46, s[20:23], s49 offen lds
    v_mfma_f32_16x16x32_bf16 v[192:195], a[144:147], v[144:147], v[192:195]
    s_waitcnt lgkmcnt(8)
    ds_read_b64_tr_b16 a[168:169], v21 offset:16384
    v_cvt_pk_bf16_f32 v238, v204, v205
    v_mfma_f32_16x16x32_bf16 v[192:195], a[148:151], v[148:151], v[192:195]
    s_waitcnt lgkmcnt(7)
    s_add_u32 s38, s47, 295552
    ds_read_b64_tr_b16 a[170:171], v21 offset:20480
    v_cvt_pk_bf16_f32 v239, v206, v207
    v_mfma_f32_16x16x32_bf16 v[192:195], a[152:155], v[152:155], v[192:195]
    s_waitcnt lgkmcnt(6)
    ds_read_b64_tr_b16 a[172:173], v21 offset:24576
    buffer_store_dwordx4 v[236:239], v56, s[28:31], s38 offen sc1
    v_mfma_f32_16x16x32_bf16 v[192:195], a[156:159], v[156:159], v[192:195]
    ds_read_b64_tr_b16 a[174:175], v21 offset:28672
    buffer_load_dwordx4 v47, s[20:23], s49 offen offset:1024 lds
    v_mfma_f32_16x16x32_bf16 v[196:199], a[128:131], v[160:163], 0
    ds_read_b64_tr_b16 a[176:177], v25 offset:0
    v_mfma_f32_16x16x32_bf16 v[196:199], a[132:135], v[164:167], v[196:199]
    ds_read_b64_tr_b16 a[178:179], v25 offset:4096
    v_mfma_f32_16x16x32_bf16 v[196:199], a[136:139], v[168:171], v[196:199]
    ds_read_b64_tr_b16 a[180:181], v25 offset:8192
    v_mfma_f32_16x16x32_bf16 v[196:199], a[140:143], v[172:175], v[196:199]
    ds_read_b64_tr_b16 a[182:183], v25 offset:12288
    buffer_load_dwordx4 v48, s[20:23], s49 offen offset:2048 lds
    v_mfma_f32_16x16x32_bf16 v[196:199], a[144:147], v[176:179], v[196:199]
    ds_read_b64_tr_b16 a[184:185], v25 offset:16384
    v_cvt_pk_bf16_f32 v224, v192, v193
    v_mfma_f32_16x16x32_bf16 v[196:199], a[148:151], v[180:183], v[196:199]
    ds_read_b64_tr_b16 a[186:187], v25 offset:20480
    v_cvt_pk_bf16_f32 v225, v194, v195
    v_mfma_f32_16x16x32_bf16 v[196:199], a[152:155], v[184:187], v[196:199]
    ds_read_b64_tr_b16 a[188:189], v25 offset:24576
    v_mfma_f32_16x16x32_bf16 v[196:199], a[156:159], v[188:191], v[196:199]
    s_waitcnt lgkmcnt(13)
    ds_read_b64_tr_b16 a[190:191], v25 offset:28672
    buffer_load_dwordx4 v49, s[20:23], s49 offen offset:3072 lds
    v_mfma_f32_16x16x32_bf16 v[200:203], a[160:163], v[128:131], 0
    s_waitcnt lgkmcnt(12)
    ds_read_b64_tr_b16 a[128:129], v22 offset:0
    v_mfma_f32_16x16x32_bf16 v[200:203], a[164:167], v[132:135], v[200:203]
    s_waitcnt lgkmcnt(11)
    ds_read_b64_tr_b16 a[130:131], v22 offset:4096
    v_mfma_f32_16x16x32_bf16 v[200:203], a[168:171], v[136:139], v[200:203]
    s_waitcnt lgkmcnt(10)
    ds_read_b64_tr_b16 a[132:133], v22 offset:8192
    v_mfma_f32_16x16x32_bf16 v[200:203], a[172:175], v[140:143], v[200:203]
    s_waitcnt lgkmcnt(9)
    ds_read_b64_tr_b16 a[134:135], v22 offset:12288
    v_mfma_f32_16x16x32_bf16 v[200:203], a[176:179], v[144:147], v[200:203]
    s_waitcnt lgkmcnt(8)
    ds_read_b64_tr_b16 a[136:137], v22 offset:16384
    v_cvt_pk_bf16_f32 v228, v196, v197
    v_mfma_f32_16x16x32_bf16 v[200:203], a[180:183], v[148:151], v[200:203]
    s_waitcnt lgkmcnt(7)
    ds_read_b64_tr_b16 a[138:139], v22 offset:20480
    v_cvt_pk_bf16_f32 v229, v198, v199
    v_mfma_f32_16x16x32_bf16 v[200:203], a[184:187], v[152:155], v[200:203]
    s_waitcnt lgkmcnt(6)
    ds_read_b64_tr_b16 a[140:141], v22 offset:24576
    v_mfma_f32_16x16x32_bf16 v[200:203], a[188:191], v[156:159], v[200:203]
    ds_read_b64_tr_b16 a[142:143], v22 offset:28672
    v_mfma_f32_16x16x32_bf16 v[204:207], a[160:163], v[160:163], 0
    ds_read_b64_tr_b16 a[144:145], v26 offset:0
    v_mfma_f32_16x16x32_bf16 v[204:207], a[164:167], v[164:167], v[204:207]
    ds_read_b64_tr_b16 a[146:147], v26 offset:4096
    v_mfma_f32_16x16x32_bf16 v[204:207], a[168:171], v[168:171], v[204:207]
    ds_read_b64_tr_b16 a[148:149], v26 offset:8192
    v_mfma_f32_16x16x32_bf16 v[204:207], a[172:175], v[172:175], v[204:207]
    ds_read_b64_tr_b16 a[150:151], v26 offset:12288
    v_mfma_f32_16x16x32_bf16 v[204:207], a[176:179], v[176:179], v[204:207]
    ds_read_b64_tr_b16 a[152:153], v26 offset:16384
    v_cvt_pk_bf16_f32 v226, v200, v201
    v_mfma_f32_16x16x32_bf16 v[204:207], a[180:183], v[180:183], v[204:207]
    s_add_u32 s38, s47, 768
    ds_read_b64_tr_b16 a[154:155], v26 offset:20480
    v_cvt_pk_bf16_f32 v227, v202, v203
    v_mfma_f32_16x16x32_bf16 v[204:207], a[184:187], v[184:187], v[204:207]
    ds_read_b64_tr_b16 a[156:157], v26 offset:24576
    buffer_store_dwordx4 v[224:227], v56, s[28:31], s38 offen sc1
    v_mfma_f32_16x16x32_bf16 v[204:207], a[188:191], v[188:191], v[204:207]
    s_waitcnt lgkmcnt(13)
    ds_read_b64_tr_b16 a[158:159], v26 offset:28672
    v_mfma_f32_16x16x32_bf16 v[192:195], a[128:131], v[128:131], 0
    s_waitcnt lgkmcnt(12)
    ds_read_b64_tr_b16 a[160:161], v23 offset:0
    v_mfma_f32_16x16x32_bf16 v[192:195], a[132:135], v[132:135], v[192:195]
    s_waitcnt lgkmcnt(11)
    ds_read_b64_tr_b16 a[162:163], v23 offset:4096
    v_mfma_f32_16x16x32_bf16 v[192:195], a[136:139], v[136:139], v[192:195]
    s_waitcnt lgkmcnt(10)
    ds_read_b64_tr_b16 a[164:165], v23 offset:8192
    v_mfma_f32_16x16x32_bf16 v[192:195], a[140:143], v[140:143], v[192:195]
    s_waitcnt lgkmcnt(9)
    ds_read_b64_tr_b16 a[166:167], v23 offset:12288
    v_mfma_f32_16x16x32_bf16 v[192:195], a[144:147], v[144:147], v[192:195]
    s_waitcnt lgkmcnt(8)
    ds_read_b64_tr_b16 a[168:169], v23 offset:16384
    v_cvt_pk_bf16_f32 v230, v204, v205
    v_mfma_f32_16x16x32_bf16 v[192:195], a[148:151], v[148:151], v[192:195]
    s_waitcnt lgkmcnt(7)
    s_add_u32 s38, s47, 295680
    ds_read_b64_tr_b16 a[170:171], v23 offset:20480
    v_cvt_pk_bf16_f32 v231, v206, v207
    v_mfma_f32_16x16x32_bf16 v[192:195], a[152:155], v[152:155], v[192:195]
    s_waitcnt lgkmcnt(6)
    ds_read_b64_tr_b16 a[172:173], v23 offset:24576
    buffer_store_dwordx4 v[228:231], v56, s[28:31], s38 offen sc1
    v_mfma_f32_16x16x32_bf16 v[192:195], a[156:159], v[156:159], v[192:195]
    ds_read_b64_tr_b16 a[174:175], v23 offset:28672
    v_mfma_f32_16x16x32_bf16 v[196:199], a[128:131], v[160:163], 0
    ds_read_b64_tr_b16 a[176:177], v27 offset:0
    v_mfma_f32_16x16x32_bf16 v[196:199], a[132:135], v[164:167], v[196:199]
    ds_read_b64_tr_b16 a[178:179], v27 offset:4096
    v_mfma_f32_16x16x32_bf16 v[196:199], a[136:139], v[168:171], v[196:199]
    ds_read_b64_tr_b16 a[180:181], v27 offset:8192
    v_mfma_f32_16x16x32_bf16 v[196:199], a[140:143], v[172:175], v[196:199]
    ds_read_b64_tr_b16 a[182:183], v27 offset:12288
    v_mfma_f32_16x16x32_bf16 v[196:199], a[144:147], v[176:179], v[196:199]
    ds_read_b64_tr_b16 a[184:185], v27 offset:16384
    v_cvt_pk_bf16_f32 v232, v192, v193
    v_mfma_f32_16x16x32_bf16 v[196:199], a[148:151], v[180:183], v[196:199]
    ds_read_b64_tr_b16 a[186:187], v27 offset:20480
    v_cvt_pk_bf16_f32 v233, v194, v195
    v_mfma_f32_16x16x32_bf16 v[196:199], a[152:155], v[184:187], v[196:199]
    ds_read_b64_tr_b16 a[188:189], v27 offset:24576
    v_mfma_f32_16x16x32_bf16 v[196:199], a[156:159], v[188:191], v[196:199]
    s_waitcnt lgkmcnt(13)
    ds_read_b64_tr_b16 a[190:191], v27 offset:28672
    s_waitcnt vmcnt(25)
    s_barrier
    v_mfma_f32_16x16x32_bf16 v[200:203], a[160:163], v[128:131], 0
    s_waitcnt lgkmcnt(12)
    ds_read_b64_tr_b16 a[128:129], v20 offset:32768
    v_mfma_f32_16x16x32_bf16 v[200:203], a[164:167], v[132:135], v[200:203]
    s_waitcnt lgkmcnt(11)
    s_add_u32 s49, s45, 896
    ds_read_b64_tr_b16 a[130:131], v20 offset:36864
    v_mfma_f32_16x16x32_bf16 v[200:203], a[168:171], v[136:139], v[200:203]
    s_waitcnt lgkmcnt(10)
    s_add_u32 m0, s42, 32768
    ds_read_b64_tr_b16 a[132:133], v20 offset:40960
    v_mfma_f32_16x16x32_bf16 v[200:203], a[172:175], v[140:143], v[200:203]
    s_waitcnt lgkmcnt(9)
    ds_read_b64_tr_b16 a[134:135], v20 offset:45056
    buffer_load_dwordx4 v46, s[20:23], s49 offen lds
    v_mfma_f32_16x16x32_bf16 v[200:203], a[176:179], v[144:147], v[200:203]
    s_waitcnt lgkmcnt(8)
    ds_read_b64_tr_b16 a[136:137], v20 offset:49152
    v_cvt_pk_bf16_f32 v236, v196, v197
    v_mfma_f32_16x16x32_bf16 v[200:203], a[180:183], v[148:151], v[200:203]
    s_waitcnt lgkmcnt(7)
    ds_read_b64_tr_b16 a[138:139], v20 offset:53248
    v_cvt_pk_bf16_f32 v237, v198, v199
    v_mfma_f32_16x16x32_bf16 v[200:203], a[184:187], v[152:155], v[200:203]
    s_waitcnt lgkmcnt(6)
    ds_read_b64_tr_b16 a[140:141], v20 offset:57344
    v_mfma_f32_16x16x32_bf16 v[200:203], a[188:191], v[156:159], v[200:203]
    ds_read_b64_tr_b16 a[142:143], v20 offset:61440
    buffer_load_dwordx4 v47, s[20:23], s49 offen offset:1024 lds
    v_mfma_f32_16x16x32_bf16 v[204:207], a[160:163], v[160:163], 0
    ds_read_b64_tr_b16 a[144:145], v24 offset:32768
    v_mfma_f32_16x16x32_bf16 v[204:207], a[164:167], v[164:167], v[204:207]
    ds_read_b64_tr_b16 a[146:147], v24 offset:36864
    v_mfma_f32_16x16x32_bf16 v[204:207], a[168:171], v[168:171], v[204:207]
    ds_read_b64_tr_b16 a[148:149], v24 offset:40960
    v_mfma_f32_16x16x32_bf16 v[204:207], a[172:175], v[172:175], v[204:207]
    ds_read_b64_tr_b16 a[150:151], v24 offset:45056
    buffer_load_dwordx4 v48, s[20:23], s49 offen offset:2048 lds
    v_mfma_f32_16x16x32_bf16 v[204:207], a[176:179], v[176:179], v[204:207]
    ds_read_b64_tr_b16 a[152:153], v24 offset:49152
    v_cvt_pk_bf16_f32 v234, v200, v201
    v_mfma_f32_16x16x32_bf16 v[204:207], a[180:183], v[180:183], v[204:207]
    s_add_u32 s38, s47, 896
    ds_read_b64_tr_b16 a[154:155], v24 offset:53248
    v_cvt_pk_bf16_f32 v235, v202, v203
    v_mfma_f32_16x16x32_bf16 v[204:207], a[184:187], v[184:187], v[204:207]
    ds_read_b64_tr_b16 a[156:157], v24 offset:57344
    buffer_store_dwordx4 v[232:235], v56, s[28:31], s38 offen sc1
    v_mfma_f32_16x16x32_bf16 v[204:207], a[188:191], v[188:191], v[204:207]
    s_waitcnt lgkmcnt(13)
    ds_read_b64_tr_b16 a[158:159], v24 offset:61440
    buffer_load_dwordx4 v49, s[20:23], s49 offen offset:3072 lds
    v_mfma_f32_16x16x32_bf16 v[192:195], a[128:131], v[128:131], 0
    s_waitcnt lgkmcnt(12)
    ds_read_b64_tr_b16 a[160:161], v21 offset:32768
    v_mfma_f32_16x16x32_bf16 v[192:195], a[132:135], v[132:135], v[192:195]
    s_waitcnt lgkmcnt(11)
    s_add_u32 s49, s45, 74624
    ds_read_b64_tr_b16 a[162:163], v21 offset:36864
    v_mfma_f32_16x16x32_bf16 v[192:195], a[136:139], v[136:139], v[192:195]
    s_waitcnt lgkmcnt(10)
    s_add_u32 m0, s42, 49152
    ds_read_b64_tr_b16 a[164:165], v21 offset:40960
    v_mfma_f32_16x16x32_bf16 v[192:195], a[140:143], v[140:143], v[192:195]
    s_waitcnt lgkmcnt(9)
    ds_read_b64_tr_b16 a[166:167], v21 offset:45056
    buffer_load_dwordx4 v46, s[20:23], s49 offen lds
    v_mfma_f32_16x16x32_bf16 v[192:195], a[144:147], v[144:147], v[192:195]
    s_waitcnt lgkmcnt(8)
    ds_read_b64_tr_b16 a[168:169], v21 offset:49152
    v_cvt_pk_bf16_f32 v238, v204, v205
    v_mfma_f32_16x16x32_bf16 v[192:195], a[148:151], v[148:151], v[192:195]
    s_waitcnt lgkmcnt(7)
    s_add_u32 s38, s47, 295808
    ds_read_b64_tr_b16 a[170:171], v21 offset:53248
    v_cvt_pk_bf16_f32 v239, v206, v207
    v_mfma_f32_16x16x32_bf16 v[192:195], a[152:155], v[152:155], v[192:195]
    s_waitcnt lgkmcnt(6)
    ds_read_b64_tr_b16 a[172:173], v21 offset:57344
    buffer_store_dwordx4 v[236:239], v56, s[28:31], s38 offen sc1
    v_mfma_f32_16x16x32_bf16 v[192:195], a[156:159], v[156:159], v[192:195]
    ds_read_b64_tr_b16 a[174:175], v21 offset:61440
    buffer_load_dwordx4 v47, s[20:23], s49 offen offset:1024 lds
    v_mfma_f32_16x16x32_bf16 v[196:199], a[128:131], v[160:163], 0
    ds_read_b64_tr_b16 a[176:177], v25 offset:32768
    v_mfma_f32_16x16x32_bf16 v[196:199], a[132:135], v[164:167], v[196:199]
    ds_read_b64_tr_b16 a[178:179], v25 offset:36864
    v_mfma_f32_16x16x32_bf16 v[196:199], a[136:139], v[168:171], v[196:199]
    ds_read_b64_tr_b16 a[180:181], v25 offset:40960
    v_mfma_f32_16x16x32_bf16 v[196:199], a[140:143], v[172:175], v[196:199]
    ds_read_b64_tr_b16 a[182:183], v25 offset:45056
    buffer_load_dwordx4 v48, s[20:23], s49 offen offset:2048 lds
    v_mfma_f32_16x16x32_bf16 v[196:199], a[144:147], v[176:179], v[196:199]
    ds_read_b64_tr_b16 a[184:185], v25 offset:49152
    v_cvt_pk_bf16_f32 v224, v192, v193
    v_mfma_f32_16x16x32_bf16 v[196:199], a[148:151], v[180:183], v[196:199]
    ds_read_b64_tr_b16 a[186:187], v25 offset:53248
    v_cvt_pk_bf16_f32 v225, v194, v195
    v_mfma_f32_16x16x32_bf16 v[196:199], a[152:155], v[184:187], v[196:199]
    ds_read_b64_tr_b16 a[188:189], v25 offset:57344
    v_mfma_f32_16x16x32_bf16 v[196:199], a[156:159], v[188:191], v[196:199]
    s_waitcnt lgkmcnt(13)
    ds_read_b64_tr_b16 a[190:191], v25 offset:61440
    buffer_load_dwordx4 v49, s[20:23], s49 offen offset:3072 lds
    v_mfma_f32_16x16x32_bf16 v[200:203], a[160:163], v[128:131], 0
    s_waitcnt lgkmcnt(12)
    ds_read_b64_tr_b16 a[128:129], v22 offset:32768
    v_mfma_f32_16x16x32_bf16 v[200:203], a[164:167], v[132:135], v[200:203]
    s_waitcnt lgkmcnt(11)
    ds_read_b64_tr_b16 a[130:131], v22 offset:36864
    v_mfma_f32_16x16x32_bf16 v[200:203], a[168:171], v[136:139], v[200:203]
    s_waitcnt lgkmcnt(10)
    ds_read_b64_tr_b16 a[132:133], v22 offset:40960
    v_mfma_f32_16x16x32_bf16 v[200:203], a[172:175], v[140:143], v[200:203]
    s_waitcnt lgkmcnt(9)
    ds_read_b64_tr_b16 a[134:135], v22 offset:45056
    v_mfma_f32_16x16x32_bf16 v[200:203], a[176:179], v[144:147], v[200:203]
    s_waitcnt lgkmcnt(8)
    ds_read_b64_tr_b16 a[136:137], v22 offset:49152
    v_cvt_pk_bf16_f32 v228, v196, v197
    v_mfma_f32_16x16x32_bf16 v[200:203], a[180:183], v[148:151], v[200:203]
    s_waitcnt lgkmcnt(7)
    ds_read_b64_tr_b16 a[138:139], v22 offset:53248
    v_cvt_pk_bf16_f32 v229, v198, v199
    v_mfma_f32_16x16x32_bf16 v[200:203], a[184:187], v[152:155], v[200:203]
    s_waitcnt lgkmcnt(6)
    ds_read_b64_tr_b16 a[140:141], v22 offset:57344
    v_mfma_f32_16x16x32_bf16 v[200:203], a[188:191], v[156:159], v[200:203]
    ds_read_b64_tr_b16 a[142:143], v22 offset:61440
    v_mfma_f32_16x16x32_bf16 v[204:207], a[160:163], v[160:163], 0
    ds_read_b64_tr_b16 a[144:145], v26 offset:32768
    v_mfma_f32_16x16x32_bf16 v[204:207], a[164:167], v[164:167], v[204:207]
    ds_read_b64_tr_b16 a[146:147], v26 offset:36864
    v_mfma_f32_16x16x32_bf16 v[204:207], a[168:171], v[168:171], v[204:207]
    ds_read_b64_tr_b16 a[148:149], v26 offset:40960
    v_mfma_f32_16x16x32_bf16 v[204:207], a[172:175], v[172:175], v[204:207]
    ds_read_b64_tr_b16 a[150:151], v26 offset:45056
    v_mfma_f32_16x16x32_bf16 v[204:207], a[176:179], v[176:179], v[204:207]
    ds_read_b64_tr_b16 a[152:153], v26 offset:49152
    v_cvt_pk_bf16_f32 v226, v200, v201
    v_mfma_f32_16x16x32_bf16 v[204:207], a[180:183], v[180:183], v[204:207]
    s_add_u32 s38, s47, 1024
    ds_read_b64_tr_b16 a[154:155], v26 offset:53248
    v_cvt_pk_bf16_f32 v227, v202, v203
    v_mfma_f32_16x16x32_bf16 v[204:207], a[184:187], v[184:187], v[204:207]
    ds_read_b64_tr_b16 a[156:157], v26 offset:57344
    buffer_store_dwordx4 v[224:227], v56, s[28:31], s38 offen sc1
    v_mfma_f32_16x16x32_bf16 v[204:207], a[188:191], v[188:191], v[204:207]
    s_waitcnt lgkmcnt(13)
    ds_read_b64_tr_b16 a[158:159], v26 offset:61440
    v_mfma_f32_16x16x32_bf16 v[192:195], a[128:131], v[128:131], 0
    s_waitcnt lgkmcnt(12)
    ds_read_b64_tr_b16 a[160:161], v23 offset:32768
    v_mfma_f32_16x16x32_bf16 v[192:195], a[132:135], v[132:135], v[192:195]
    s_waitcnt lgkmcnt(11)
    ds_read_b64_tr_b16 a[162:163], v23 offset:36864
    v_mfma_f32_16x16x32_bf16 v[192:195], a[136:139], v[136:139], v[192:195]
    s_waitcnt lgkmcnt(10)
    ds_read_b64_tr_b16 a[164:165], v23 offset:40960
    v_mfma_f32_16x16x32_bf16 v[192:195], a[140:143], v[140:143], v[192:195]
    s_waitcnt lgkmcnt(9)
    ds_read_b64_tr_b16 a[166:167], v23 offset:45056
    v_mfma_f32_16x16x32_bf16 v[192:195], a[144:147], v[144:147], v[192:195]
    s_waitcnt lgkmcnt(8)
    ds_read_b64_tr_b16 a[168:169], v23 offset:49152
    v_cvt_pk_bf16_f32 v230, v204, v205
    v_mfma_f32_16x16x32_bf16 v[192:195], a[148:151], v[148:151], v[192:195]
    s_waitcnt lgkmcnt(7)
    s_add_u32 s38, s47, 295936
    ds_read_b64_tr_b16 a[170:171], v23 offset:53248
    v_cvt_pk_bf16_f32 v231, v206, v207
    v_mfma_f32_16x16x32_bf16 v[192:195], a[152:155], v[152:155], v[192:195]
    s_waitcnt lgkmcnt(6)
    ds_read_b64_tr_b16 a[172:173], v23 offset:57344
    buffer_store_dwordx4 v[228:231], v56, s[28:31], s38 offen sc1
    v_mfma_f32_16x16x32_bf16 v[192:195], a[156:159], v[156:159], v[192:195]
    ds_read_b64_tr_b16 a[174:175], v23 offset:61440
    v_mfma_f32_16x16x32_bf16 v[196:199], a[128:131], v[160:163], 0
    ds_read_b64_tr_b16 a[176:177], v27 offset:32768
    v_mfma_f32_16x16x32_bf16 v[196:199], a[132:135], v[164:167], v[196:199]
    ds_read_b64_tr_b16 a[178:179], v27 offset:36864
    v_mfma_f32_16x16x32_bf16 v[196:199], a[136:139], v[168:171], v[196:199]
    ds_read_b64_tr_b16 a[180:181], v27 offset:40960
    v_mfma_f32_16x16x32_bf16 v[196:199], a[140:143], v[172:175], v[196:199]
    ds_read_b64_tr_b16 a[182:183], v27 offset:45056
    v_mfma_f32_16x16x32_bf16 v[196:199], a[144:147], v[176:179], v[196:199]
    ds_read_b64_tr_b16 a[184:185], v27 offset:49152
    v_cvt_pk_bf16_f32 v232, v192, v193
    v_mfma_f32_16x16x32_bf16 v[196:199], a[148:151], v[180:183], v[196:199]
    ds_read_b64_tr_b16 a[186:187], v27 offset:53248
    v_cvt_pk_bf16_f32 v233, v194, v195
    v_mfma_f32_16x16x32_bf16 v[196:199], a[152:155], v[184:187], v[196:199]
    ds_read_b64_tr_b16 a[188:189], v27 offset:57344
    v_mfma_f32_16x16x32_bf16 v[196:199], a[156:159], v[188:191], v[196:199]
    s_waitcnt lgkmcnt(13)
    ds_read_b64_tr_b16 a[190:191], v27 offset:61440
    s_waitcnt vmcnt(26)
    s_barrier
    v_mfma_f32_16x16x32_bf16 v[200:203], a[160:163], v[128:131], 0
    s_waitcnt lgkmcnt(12)
    ds_read_b64_tr_b16 a[128:129], v28 offset:0
    v_mfma_f32_16x16x32_bf16 v[200:203], a[164:167], v[132:135], v[200:203]
    s_waitcnt lgkmcnt(11)
    s_add_u32 s49, s45, 1024
    ds_read_b64_tr_b16 a[130:131], v28 offset:4096
    v_mfma_f32_16x16x32_bf16 v[200:203], a[168:171], v[136:139], v[200:203]
    s_waitcnt lgkmcnt(10)
    s_add_u32 m0, s42, 65536
    ds_read_b64_tr_b16 a[132:133], v28 offset:8192
    v_mfma_f32_16x16x32_bf16 v[200:203], a[172:175], v[140:143], v[200:203]
    s_waitcnt lgkmcnt(9)
    ds_read_b64_tr_b16 a[134:135], v28 offset:12288
    buffer_load_dwordx4 v46, s[20:23], s49 offen lds
    v_mfma_f32_16x16x32_bf16 v[200:203], a[176:179], v[144:147], v[200:203]
    s_waitcnt lgkmcnt(8)
    ds_read_b64_tr_b16 a[136:137], v28 offset:16384
    v_cvt_pk_bf16_f32 v236, v196, v197
    v_mfma_f32_16x16x32_bf16 v[200:203], a[180:183], v[148:151], v[200:203]
    s_waitcnt lgkmcnt(7)
    ds_read_b64_tr_b16 a[138:139], v28 offset:20480
    v_cvt_pk_bf16_f32 v237, v198, v199
    v_mfma_f32_16x16x32_bf16 v[200:203], a[184:187], v[152:155], v[200:203]
    s_waitcnt lgkmcnt(6)
    ds_read_b64_tr_b16 a[140:141], v28 offset:24576
    v_mfma_f32_16x16x32_bf16 v[200:203], a[188:191], v[156:159], v[200:203]
    ds_read_b64_tr_b16 a[142:143], v28 offset:28672
    buffer_load_dwordx4 v47, s[20:23], s49 offen offset:1024 lds
    v_mfma_f32_16x16x32_bf16 v[204:207], a[160:163], v[160:163], 0
    ds_read_b64_tr_b16 a[144:145], v32 offset:0
    v_mfma_f32_16x16x32_bf16 v[204:207], a[164:167], v[164:167], v[204:207]
    ds_read_b64_tr_b16 a[146:147], v32 offset:4096
    v_mfma_f32_16x16x32_bf16 v[204:207], a[168:171], v[168:171], v[204:207]
    ds_read_b64_tr_b16 a[148:149], v32 offset:8192
    v_mfma_f32_16x16x32_bf16 v[204:207], a[172:175], v[172:175], v[204:207]
    ds_read_b64_tr_b16 a[150:151], v32 offset:12288
    buffer_load_dwordx4 v48, s[20:23], s49 offen offset:2048 lds
    v_mfma_f32_16x16x32_bf16 v[204:207], a[176:179], v[176:179], v[204:207]
    ds_read_b64_tr_b16 a[152:153], v32 offset:16384
    v_cvt_pk_bf16_f32 v234, v200, v201
    v_mfma_f32_16x16x32_bf16 v[204:207], a[180:183], v[180:183], v[204:207]
    s_add_u32 s38, s47, 1152
    ds_read_b64_tr_b16 a[154:155], v32 offset:20480
    v_cvt_pk_bf16_f32 v235, v202, v203
    v_mfma_f32_16x16x32_bf16 v[204:207], a[184:187], v[184:187], v[204:207]
    ds_read_b64_tr_b16 a[156:157], v32 offset:24576
    buffer_store_dwordx4 v[232:235], v56, s[28:31], s38 offen sc1
    v_mfma_f32_16x16x32_bf16 v[204:207], a[188:191], v[188:191], v[204:207]
    s_waitcnt lgkmcnt(13)
    ds_read_b64_tr_b16 a[158:159], v32 offset:28672
    buffer_load_dwordx4 v49, s[20:23], s49 offen offset:3072 lds
    v_mfma_f32_16x16x32_bf16 v[192:195], a[128:131], v[128:131], 0
    s_waitcnt lgkmcnt(12)
    ds_read_b64_tr_b16 a[160:161], v29 offset:0
    v_mfma_f32_16x16x32_bf16 v[192:195], a[132:135], v[132:135], v[192:195]
    s_waitcnt lgkmcnt(11)
    s_add_u32 s49, s45, 74752
    ds_read_b64_tr_b16 a[162:163], v29 offset:4096
    v_mfma_f32_16x16x32_bf16 v[192:195], a[136:139], v[136:139], v[192:195]
    s_waitcnt lgkmcnt(10)
    s_add_u32 m0, s42, 81920
    ds_read_b64_tr_b16 a[164:165], v29 offset:8192
    v_mfma_f32_16x16x32_bf16 v[192:195], a[140:143], v[140:143], v[192:195]
    s_waitcnt lgkmcnt(9)
    ds_read_b64_tr_b16 a[166:167], v29 offset:12288
    buffer_load_dwordx4 v46, s[20:23], s49 offen lds
    v_mfma_f32_16x16x32_bf16 v[192:195], a[144:147], v[144:147], v[192:195]
    s_waitcnt lgkmcnt(8)
    ds_read_b64_tr_b16 a[168:169], v29 offset:16384
    v_cvt_pk_bf16_f32 v238, v204, v205
    v_mfma_f32_16x16x32_bf16 v[192:195], a[148:151], v[148:151], v[192:195]
    s_waitcnt lgkmcnt(7)
    s_add_u32 s38, s47, 296064
    ds_read_b64_tr_b16 a[170:171], v29 offset:20480
    v_cvt_pk_bf16_f32 v239, v206, v207
    v_mfma_f32_16x16x32_bf16 v[192:195], a[152:155], v[152:155], v[192:195]
    s_waitcnt lgkmcnt(6)
    ds_read_b64_tr_b16 a[172:173], v29 offset:24576
    buffer_store_dwordx4 v[236:239], v56, s[28:31], s38 offen sc1
    v_mfma_f32_16x16x32_bf16 v[192:195], a[156:159], v[156:159], v[192:195]
    ds_read_b64_tr_b16 a[174:175], v29 offset:28672
    buffer_load_dwordx4 v47, s[20:23], s49 offen offset:1024 lds
    v_mfma_f32_16x16x32_bf16 v[196:199], a[128:131], v[160:163], 0
    ds_read_b64_tr_b16 a[176:177], v33 offset:0
    v_mfma_f32_16x16x32_bf16 v[196:199], a[132:135], v[164:167], v[196:199]
    ds_read_b64_tr_b16 a[178:179], v33 offset:4096
    v_mfma_f32_16x16x32_bf16 v[196:199], a[136:139], v[168:171], v[196:199]
    ds_read_b64_tr_b16 a[180:181], v33 offset:8192
    v_mfma_f32_16x16x32_bf16 v[196:199], a[140:143], v[172:175], v[196:199]
    ds_read_b64_tr_b16 a[182:183], v33 offset:12288
    buffer_load_dwordx4 v48, s[20:23], s49 offen offset:2048 lds
    v_mfma_f32_16x16x32_bf16 v[196:199], a[144:147], v[176:179], v[196:199]
    ds_read_b64_tr_b16 a[184:185], v33 offset:16384
    v_cvt_pk_bf16_f32 v224, v192, v193
    v_mfma_f32_16x16x32_bf16 v[196:199], a[148:151], v[180:183], v[196:199]
    ds_read_b64_tr_b16 a[186:187], v33 offset:20480
    v_cvt_pk_bf16_f32 v225, v194, v195
    v_mfma_f32_16x16x32_bf16 v[196:199], a[152:155], v[184:187], v[196:199]
    ds_read_b64_tr_b16 a[188:189], v33 offset:24576
    v_mfma_f32_16x16x32_bf16 v[196:199], a[156:159], v[188:191], v[196:199]
    s_waitcnt lgkmcnt(13)
    ds_read_b64_tr_b16 a[190:191], v33 offset:28672
    buffer_load_dwordx4 v49, s[20:23], s49 offen offset:3072 lds
    v_mfma_f32_16x16x32_bf16 v[200:203], a[160:163], v[128:131], 0
    s_waitcnt lgkmcnt(12)
    ds_read_b64_tr_b16 a[128:129], v30 offset:0
    v_mfma_f32_16x16x32_bf16 v[200:203], a[164:167], v[132:135], v[200:203]
    s_waitcnt lgkmcnt(11)
    ds_read_b64_tr_b16 a[130:131], v30 offset:4096
    v_mfma_f32_16x16x32_bf16 v[200:203], a[168:171], v[136:139], v[200:203]
    s_waitcnt lgkmcnt(10)
    ds_read_b64_tr_b16 a[132:133], v30 offset:8192
    v_mfma_f32_16x16x32_bf16 v[200:203], a[172:175], v[140:143], v[200:203]
    s_waitcnt lgkmcnt(9)
    ds_read_b64_tr_b16 a[134:135], v30 offset:12288
    v_mfma_f32_16x16x32_bf16 v[200:203], a[176:179], v[144:147], v[200:203]
    s_waitcnt lgkmcnt(8)
    ds_read_b64_tr_b16 a[136:137], v30 offset:16384
    v_cvt_pk_bf16_f32 v228, v196, v197
    v_mfma_f32_16x16x32_bf16 v[200:203], a[180:183], v[148:151], v[200:203]
    s_waitcnt lgkmcnt(7)
    ds_read_b64_tr_b16 a[138:139], v30 offset:20480
    v_cvt_pk_bf16_f32 v229, v198, v199
    v_mfma_f32_16x16x32_bf16 v[200:203], a[184:187], v[152:155], v[200:203]
    s_waitcnt lgkmcnt(6)
    ds_read_b64_tr_b16 a[140:141], v30 offset:24576
    s_lshr_b32 s6, s2, 3
    v_mfma_f32_16x16x32_bf16 v[200:203], a[188:191], v[156:159], v[200:203]
    ds_read_b64_tr_b16 a[142:143], v30 offset:28672
    v_mfma_f32_16x16x32_bf16 v[204:207], a[160:163], v[160:163], 0
    ds_read_b64_tr_b16 a[144:145], v34 offset:0
    s_and_b32 s7, s2, 7
    v_mfma_f32_16x16x32_bf16 v[204:207], a[164:167], v[164:167], v[204:207]
    ds_read_b64_tr_b16 a[146:147], v34 offset:4096
    v_mfma_f32_16x16x32_bf16 v[204:207], a[168:171], v[168:171], v[204:207]
    ds_read_b64_tr_b16 a[148:149], v34 offset:8192
    s_mul_i32 s7, s7, 18
    v_mfma_f32_16x16x32_bf16 v[204:207], a[172:175], v[172:175], v[204:207]
    ds_read_b64_tr_b16 a[150:151], v34 offset:12288
    v_mfma_f32_16x16x32_bf16 v[204:207], a[176:179], v[176:179], v[204:207]
    ds_read_b64_tr_b16 a[152:153], v34 offset:16384
    v_cvt_pk_bf16_f32 v226, v200, v201
    s_add_u32 s7, s7, s6
    v_mfma_f32_16x16x32_bf16 v[204:207], a[180:183], v[180:183], v[204:207]
    s_add_u32 s38, s47, 1280
    ds_read_b64_tr_b16 a[154:155], v34 offset:20480
    v_cvt_pk_bf16_f32 v227, v202, v203
    v_mfma_f32_16x16x32_bf16 v[204:207], a[184:187], v[184:187], v[204:207]
    ds_read_b64_tr_b16 a[156:157], v34 offset:24576
    buffer_store_dwordx4 v[224:227], v56, s[28:31], s38 offen sc1
    s_lshl_b32 s36, s7, 6
    v_mfma_f32_16x16x32_bf16 v[204:207], a[188:191], v[188:191], v[204:207]
    s_waitcnt lgkmcnt(13)
    ds_read_b64_tr_b16 a[158:159], v34 offset:28672
    v_mfma_f32_16x16x32_bf16 v[192:195], a[128:131], v[128:131], 0
    s_waitcnt lgkmcnt(12)
    ds_read_b64_tr_b16 a[160:161], v31 offset:0
    s_mul_i32 s37, s7, 36864
    v_mfma_f32_16x16x32_bf16 v[192:195], a[132:135], v[132:135], v[192:195]
    s_waitcnt lgkmcnt(11)
    ds_read_b64_tr_b16 a[162:163], v31 offset:4096
    v_mfma_f32_16x16x32_bf16 v[192:195], a[136:139], v[136:139], v[192:195]
    s_waitcnt lgkmcnt(10)
    ds_read_b64_tr_b16 a[164:165], v31 offset:8192
    s_lshl_b32 s39, s3, 10
    v_mfma_f32_16x16x32_bf16 v[192:195], a[140:143], v[140:143], v[192:195]
    s_waitcnt lgkmcnt(9)
    ds_read_b64_tr_b16 a[166:167], v31 offset:12288
    v_mfma_f32_16x16x32_bf16 v[192:195], a[144:147], v[144:147], v[192:195]
    s_waitcnt lgkmcnt(8)
    ds_read_b64_tr_b16 a[168:169], v31 offset:16384
    v_cvt_pk_bf16_f32 v230, v204, v205
    s_cmp_lt_u32 s6, 18
    s_cselect_b32 s34, 5308416, 0
    v_mfma_f32_16x16x32_bf16 v[192:195], a[148:151], v[148:151], v[192:195]
    s_waitcnt lgkmcnt(7)
    s_add_u32 s38, s47, 296192
    ds_read_b64_tr_b16 a[170:171], v31 offset:20480
    v_cvt_pk_bf16_f32 v231, v206, v207
    v_mfma_f32_16x16x32_bf16 v[192:195], a[152:155], v[152:155], v[192:195]
    s_waitcnt lgkmcnt(6)
    ds_read_b64_tr_b16 a[172:173], v31 offset:24576
    buffer_store_dwordx4 v[228:231], v56, s[28:31], s38 offen sc1
    s_mov_b32 s82, s34
    v_mfma_f32_16x16x32_bf16 v[192:195], a[156:159], v[156:159], v[192:195]
    ds_read_b64_tr_b16 a[174:175], v31 offset:28672
    v_mfma_f32_16x16x32_bf16 v[196:199], a[128:131], v[160:163], 0
    ds_read_b64_tr_b16 a[176:177], v35 offset:0
    s_mov_b32 s86, s34
    v_mfma_f32_16x16x32_bf16 v[196:199], a[132:135], v[164:167], v[196:199]
    ds_read_b64_tr_b16 a[178:179], v35 offset:4096
    v_mfma_f32_16x16x32_bf16 v[196:199], a[136:139], v[168:171], v[196:199]
    ds_read_b64_tr_b16 a[180:181], v35 offset:8192
    v_mfma_f32_16x16x32_bf16 v[196:199], a[140:143], v[172:175], v[196:199]
    ds_read_b64_tr_b16 a[182:183], v35 offset:12288
    v_mfma_f32_16x16x32_bf16 v[196:199], a[144:147], v[176:179], v[196:199]
    ds_read_b64_tr_b16 a[184:185], v35 offset:16384
    v_cvt_pk_bf16_f32 v232, v192, v193
    v_mfma_f32_16x16x32_bf16 v[196:199], a[148:151], v[180:183], v[196:199]
    ds_read_b64_tr_b16 a[186:187], v35 offset:20480
    v_cvt_pk_bf16_f32 v233, v194, v195
    v_mfma_f32_16x16x32_bf16 v[196:199], a[152:155], v[184:187], v[196:199]
    ds_read_b64_tr_b16 a[188:189], v35 offset:24576
    v_mfma_f32_16x16x32_bf16 v[196:199], a[156:159], v[188:191], v[196:199]
    s_waitcnt lgkmcnt(13)
    ds_read_b64_tr_b16 a[190:191], v35 offset:28672
    s_waitcnt vmcnt(26)
    s_barrier
    v_mfma_f32_16x16x32_bf16 v[200:203], a[160:163], v[128:131], 0
    s_waitcnt lgkmcnt(12)
    ds_read_b64_tr_b16 a[128:129], v12 offset:0
    v_mfma_f32_16x16x32_bf16 v[200:203], a[164:167], v[132:135], v[200:203]
    s_waitcnt lgkmcnt(11)
    s_add_u32 s49, s36, 0
    ds_read_b64_tr_b16 a[130:131], v12 offset:4096
    v_mfma_f32_16x16x32_bf16 v[200:203], a[168:171], v[136:139], v[200:203]
    s_waitcnt lgkmcnt(10)
    s_add_u32 m0, s39, 98304
    ds_read_b64_tr_b16 a[132:133], v12 offset:8192
    v_mfma_f32_16x16x32_bf16 v[200:203], a[172:175], v[140:143], v[200:203]
    s_waitcnt lgkmcnt(9)
    ds_read_b64_tr_b16 a[134:135], v12 offset:12288
    buffer_load_dwordx4 v57, s[80:83], s49 offen lds
    v_mfma_f32_16x16x32_bf16 v[200:203], a[176:179], v[144:147], v[200:203]
    s_waitcnt lgkmcnt(8)
    ds_read_b64_tr_b16 a[136:137], v12 offset:16384
    v_cvt_pk_bf16_f32 v236, v196, v197
    v_mfma_f32_16x16x32_bf16 v[200:203], a[180:183], v[148:151], v[200:203]
    s_waitcnt lgkmcnt(7)
    s_add_u32 s49, s36, 589824
    ds_read_b64_tr_b16 a[138:139], v12 offset:20480
    v_cvt_pk_bf16_f32 v237, v198, v199
    v_mfma_f32_16x16x32_bf16 v[200:203], a[184:187], v[152:155], v[200:203]
    s_waitcnt lgkmcnt(6)
    s_add_u32 m0, s39, 102400
    ds_read_b64_tr_b16 a[140:141], v12 offset:24576
    v_mfma_f32_16x16x32_bf16 v[200:203], a[188:191], v[156:159], v[200:203]
    ds_read_b64_tr_b16 a[142:143], v12 offset:28672
    buffer_load_dwordx4 v57, s[80:83], s49 offen lds
    v_mfma_f32_16x16x32_bf16 v[204:207], a[160:163], v[160:163], 0
    ds_read_b64_tr_b16 a[144:145], v16 offset:0
    v_mfma_f32_16x16x32_bf16 v[204:207], a[164:167], v[164:167], v[204:207]
    s_add_u32 s49, s36, 1179648
    ds_read_b64_tr_b16 a[146:147], v16 offset:4096
    v_mfma_f32_16x16x32_bf16 v[204:207], a[168:171], v[168:171], v[204:207]
    s_add_u32 m0, s39, 106496
    ds_read_b64_tr_b16 a[148:149], v16 offset:8192
    v_mfma_f32_16x16x32_bf16 v[204:207], a[172:175], v[172:175], v[204:207]
    ds_read_b64_tr_b16 a[150:151], v16 offset:12288
    buffer_load_dwordx4 v57, s[80:83], s49 offen lds
    v_mfma_f32_16x16x32_bf16 v[204:207], a[176:179], v[176:179], v[204:207]
    ds_read_b64_tr_b16 a[152:153], v16 offset:16384
    v_cvt_pk_bf16_f32 v234, v200, v201
    v_mfma_f32_16x16x32_bf16 v[204:207], a[180:183], v[180:183], v[204:207]
    s_add_u32 s38, s47, 1408
    s_add_u32 s49, s36, 1769472
    ds_read_b64_tr_b16 a[154:155], v16 offset:20480
    v_cvt_pk_bf16_f32 v235, v202, v203
    v_mfma_f32_16x16x32_bf16 v[204:207], a[184:187], v[184:187], v[204:207]
    s_add_u32 m0, s39, 110592
    ds_read_b64_tr_b16 a[156:157], v16 offset:24576
    buffer_store_dwordx4 v[232:235], v56, s[28:31], s38 offen sc1
    v_mfma_f32_16x16x32_bf16 v[204:207], a[188:191], v[188:191], v[204:207]
    s_waitcnt lgkmcnt(13)
    ds_read_b64_tr_b16 a[158:159], v16 offset:28672
    buffer_load_dwordx4 v57, s[80:83], s49 offen lds
    v_mfma_f32_16x16x32_bf16 v[192:195], a[128:131], v[128:131], 0
    s_waitcnt lgkmcnt(12)
    ds_read_b64_tr_b16 a[160:161], v13 offset:0
    v_mfma_f32_16x16x32_bf16 v[192:195], a[132:135], v[132:135], v[192:195]
    s_waitcnt lgkmcnt(11)
    s_add_u32 s49, s36, 2359296
    ds_read_b64_tr_b16 a[162:163], v13 offset:4096
    v_mfma_f32_16x16x32_bf16 v[192:195], a[136:139], v[136:139], v[192:195]
    s_waitcnt lgkmcnt(10)
    s_add_u32 m0, s39, 114688
    ds_read_b64_tr_b16 a[164:165], v13 offset:8192
    v_mfma_f32_16x16x32_bf16 v[192:195], a[140:143], v[140:143], v[192:195]
    s_waitcnt lgkmcnt(9)
    ds_read_b64_tr_b16 a[166:167], v13 offset:12288
    buffer_load_dwordx4 v57, s[80:83], s49 offen lds
    v_mfma_f32_16x16x32_bf16 v[192:195], a[144:147], v[144:147], v[192:195]
    s_waitcnt lgkmcnt(8)
    ds_read_b64_tr_b16 a[168:169], v13 offset:16384
    v_cvt_pk_bf16_f32 v238, v204, v205
    v_mfma_f32_16x16x32_bf16 v[192:195], a[148:151], v[148:151], v[192:195]
    s_waitcnt lgkmcnt(7)
    s_add_u32 s38, s47, 296320
    s_add_u32 s49, s36, 2949120
    ds_read_b64_tr_b16 a[170:171], v13 offset:20480
    v_cvt_pk_bf16_f32 v239, v206, v207
    v_mfma_f32_16x16x32_bf16 v[192:195], a[152:155], v[152:155], v[192:195]
    s_waitcnt lgkmcnt(6)
    s_add_u32 m0, s39, 118784
    ds_read_b64_tr_b16 a[172:173], v13 offset:24576
    buffer_store_dwordx4 v[236:239], v56, s[28:31], s38 offen sc1
    v_mfma_f32_16x16x32_bf16 v[192:195], a[156:159], v[156:159], v[192:195]
    ds_read_b64_tr_b16 a[174:175], v13 offset:28672
    buffer_load_dwordx4 v57, s[80:83], s49 offen lds
    v_mfma_f32_16x16x32_bf16 v[196:199], a[128:131], v[160:163], 0
    ds_read_b64_tr_b16 a[176:177], v17 offset:0
    v_mfma_f32_16x16x32_bf16 v[196:199], a[132:135], v[164:167], v[196:199]
    s_add_u32 s49, s36, 3538944
    ds_read_b64_tr_b16 a[178:179], v17 offset:4096
    v_mfma_f32_16x16x32_bf16 v[196:199], a[136:139], v[168:171], v[196:199]
    s_add_u32 m0, s39, 122880
    ds_read_b64_tr_b16 a[180:181], v17 offset:8192
    v_mfma_f32_16x16x32_bf16 v[196:199], a[140:143], v[172:175], v[196:199]
    ds_read_b64_tr_b16 a[182:183], v17 offset:12288
    buffer_load_dwordx4 v57, s[80:83], s49 offen lds
    v_mfma_f32_16x16x32_bf16 v[196:199], a[144:147], v[176:179], v[196:199]
    ds_read_b64_tr_b16 a[184:185], v17 offset:16384
    v_cvt_pk_bf16_f32 v224, v192, v193
    v_mfma_f32_16x16x32_bf16 v[196:199], a[148:151], v[180:183], v[196:199]
    s_add_u32 s49, s36, 4128768
    ds_read_b64_tr_b16 a[186:187], v17 offset:20480
    v_cvt_pk_bf16_f32 v225, v194, v195
    v_mfma_f32_16x16x32_bf16 v[196:199], a[152:155], v[184:187], v[196:199]
    s_add_u32 m0, s39, 126976
    ds_read_b64_tr_b16 a[188:189], v17 offset:24576
    v_mfma_f32_16x16x32_bf16 v[196:199], a[156:159], v[188:191], v[196:199]
    s_waitcnt lgkmcnt(13)
    ds_read_b64_tr_b16 a[190:191], v17 offset:28672
    buffer_load_dwordx4 v57, s[80:83], s49 offen lds
    v_mfma_f32_16x16x32_bf16 v[200:203], a[160:163], v[128:131], 0
    s_waitcnt lgkmcnt(12)
    ds_read_b64_tr_b16 a[128:129], v14 offset:0
    v_mfma_f32_16x16x32_bf16 v[200:203], a[164:167], v[132:135], v[200:203]
    s_waitcnt lgkmcnt(11)
    ds_read_b64_tr_b16 a[130:131], v14 offset:4096
    v_mfma_f32_16x16x32_bf16 v[200:203], a[168:171], v[136:139], v[200:203]
    s_waitcnt lgkmcnt(10)
    ds_read_b64_tr_b16 a[132:133], v14 offset:8192
    v_mfma_f32_16x16x32_bf16 v[200:203], a[172:175], v[140:143], v[200:203]
    s_waitcnt lgkmcnt(9)
    ds_read_b64_tr_b16 a[134:135], v14 offset:12288
    v_mfma_f32_16x16x32_bf16 v[200:203], a[176:179], v[144:147], v[200:203]
    s_waitcnt lgkmcnt(8)
    ds_read_b64_tr_b16 a[136:137], v14 offset:16384
    v_cvt_pk_bf16_f32 v228, v196, v197
    v_mfma_f32_16x16x32_bf16 v[200:203], a[180:183], v[148:151], v[200:203]
    s_waitcnt lgkmcnt(7)
    ds_read_b64_tr_b16 a[138:139], v14 offset:20480
    v_cvt_pk_bf16_f32 v229, v198, v199
    v_mfma_f32_16x16x32_bf16 v[200:203], a[184:187], v[152:155], v[200:203]
    s_waitcnt lgkmcnt(6)
    ds_read_b64_tr_b16 a[140:141], v14 offset:24576
    v_mfma_f32_16x16x32_bf16 v[200:203], a[188:191], v[156:159], v[200:203]
    ds_read_b64_tr_b16 a[142:143], v14 offset:28672
    v_mfma_f32_16x16x32_bf16 v[204:207], a[160:163], v[160:163], 0
    ds_read_b64_tr_b16 a[144:145], v18 offset:0
    v_mfma_f32_16x16x32_bf16 v[204:207], a[164:167], v[164:167], v[204:207]
    ds_read_b64_tr_b16 a[146:147], v18 offset:4096
    v_mfma_f32_16x16x32_bf16 v[204:207], a[168:171], v[168:171], v[204:207]
    ds_read_b64_tr_b16 a[148:149], v18 offset:8192
    v_mfma_f32_16x16x32_bf16 v[204:207], a[172:175], v[172:175], v[204:207]
    ds_read_b64_tr_b16 a[150:151], v18 offset:12288
    v_mfma_f32_16x16x32_bf16 v[204:207], a[176:179], v[176:179], v[204:207]
    ds_read_b64_tr_b16 a[152:153], v18 offset:16384
    v_cvt_pk_bf16_f32 v226, v200, v201
    v_mfma_f32_16x16x32_bf16 v[204:207], a[180:183], v[180:183], v[204:207]
    s_add_u32 s38, s47, 1536
    ds_read_b64_tr_b16 a[154:155], v18 offset:20480
    v_cvt_pk_bf16_f32 v227, v202, v203
    v_mfma_f32_16x16x32_bf16 v[204:207], a[184:187], v[184:187], v[204:207]
    ds_read_b64_tr_b16 a[156:157], v18 offset:24576
    buffer_store_dwordx4 v[224:227], v56, s[28:31], s38 offen sc1
    v_mfma_f32_16x16x32_bf16 v[204:207], a[188:191], v[188:191], v[204:207]
    s_waitcnt lgkmcnt(13)
    ds_read_b64_tr_b16 a[158:159], v18 offset:28672
    v_mfma_f32_16x16x32_bf16 v[192:195], a[128:131], v[128:131], 0
    s_waitcnt lgkmcnt(12)
    ds_read_b64_tr_b16 a[160:161], v15 offset:0
    v_mfma_f32_16x16x32_bf16 v[192:195], a[132:135], v[132:135], v[192:195]
    s_waitcnt lgkmcnt(11)
    ds_read_b64_tr_b16 a[162:163], v15 offset:4096
    v_mfma_f32_16x16x32_bf16 v[192:195], a[136:139], v[136:139], v[192:195]
    s_waitcnt lgkmcnt(10)
    ds_read_b64_tr_b16 a[164:165], v15 offset:8192
    v_mfma_f32_16x16x32_bf16 v[192:195], a[140:143], v[140:143], v[192:195]
    s_waitcnt lgkmcnt(9)
    ds_read_b64_tr_b16 a[166:167], v15 offset:12288
    v_mfma_f32_16x16x32_bf16 v[192:195], a[144:147], v[144:147], v[192:195]
    s_waitcnt lgkmcnt(8)
    ds_read_b64_tr_b16 a[168:169], v15 offset:16384
    v_cvt_pk_bf16_f32 v230, v204, v205
    v_mfma_f32_16x16x32_bf16 v[192:195], a[148:151], v[148:151], v[192:195]
    s_waitcnt lgkmcnt(7)
    s_add_u32 s38, s47, 296448
    ds_read_b64_tr_b16 a[170:171], v15 offset:20480
    v_cvt_pk_bf16_f32 v231, v206, v207
    v_mfma_f32_16x16x32_bf16 v[192:195], a[152:155], v[152:155], v[192:195]
    s_waitcnt lgkmcnt(6)
    ds_read_b64_tr_b16 a[172:173], v15 offset:24576
    buffer_store_dwordx4 v[228:231], v56, s[28:31], s38 offen sc1
    v_mfma_f32_16x16x32_bf16 v[192:195], a[156:159], v[156:159], v[192:195]
    ds_read_b64_tr_b16 a[174:175], v15 offset:28672
    v_mfma_f32_16x16x32_bf16 v[196:199], a[128:131], v[160:163], 0
    ds_read_b64_tr_b16 a[176:177], v19 offset:0
    v_mfma_f32_16x16x32_bf16 v[196:199], a[132:135], v[164:167], v[196:199]
    ds_read_b64_tr_b16 a[178:179], v19 offset:4096
    v_mfma_f32_16x16x32_bf16 v[196:199], a[136:139], v[168:171], v[196:199]
    ds_read_b64_tr_b16 a[180:181], v19 offset:8192
    v_mfma_f32_16x16x32_bf16 v[196:199], a[140:143], v[172:175], v[196:199]
    ds_read_b64_tr_b16 a[182:183], v19 offset:12288
    v_mfma_f32_16x16x32_bf16 v[196:199], a[144:147], v[176:179], v[196:199]
    ds_read_b64_tr_b16 a[184:185], v19 offset:16384
    v_cvt_pk_bf16_f32 v232, v192, v193
    v_mfma_f32_16x16x32_bf16 v[196:199], a[148:151], v[180:183], v[196:199]
    ds_read_b64_tr_b16 a[186:187], v19 offset:20480
    v_cvt_pk_bf16_f32 v233, v194, v195
    v_mfma_f32_16x16x32_bf16 v[196:199], a[152:155], v[184:187], v[196:199]
    ds_read_b64_tr_b16 a[188:189], v19 offset:24576
    v_mfma_f32_16x16x32_bf16 v[196:199], a[156:159], v[188:191], v[196:199]
    s_waitcnt lgkmcnt(13)
    ds_read_b64_tr_b16 a[190:191], v19 offset:28672
    s_waitcnt vmcnt(26)
    s_barrier
    v_mfma_f32_16x16x32_bf16 v[200:203], a[160:163], v[128:131], 0
    s_waitcnt lgkmcnt(12)
    ds_read_b64_tr_b16 a[128:129], v12 offset:32768
    v_mfma_f32_16x16x32_bf16 v[200:203], a[164:167], v[132:135], v[200:203]
    s_waitcnt lgkmcnt(11)
    s_add_u32 s49, s36, 4718592
    ds_read_b64_tr_b16 a[130:131], v12 offset:36864
    v_mfma_f32_16x16x32_bf16 v[200:203], a[168:171], v[136:139], v[200:203]
    s_waitcnt lgkmcnt(10)
    s_add_u32 m0, s39, 131072
    ds_read_b64_tr_b16 a[132:133], v12 offset:40960
    v_mfma_f32_16x16x32_bf16 v[200:203], a[172:175], v[140:143], v[200:203]
    s_waitcnt lgkmcnt(9)
    ds_read_b64_tr_b16 a[134:135], v12 offset:45056
    buffer_load_dwordx4 v57, s[80:83], s49 offen lds
    v_mfma_f32_16x16x32_bf16 v[200:203], a[176:179], v[144:147], v[200:203]
    s_waitcnt lgkmcnt(8)
    ds_read_b64_tr_b16 a[136:137], v12 offset:49152
    v_cvt_pk_bf16_f32 v236, v196, v197
    v_mfma_f32_16x16x32_bf16 v[200:203], a[180:183], v[148:151], v[200:203]
    s_waitcnt lgkmcnt(7)
    s_add_u32 s49, s36, 0
    ds_read_b64_tr_b16 a[138:139], v12 offset:53248
    v_cvt_pk_bf16_f32 v237, v198, v199
    v_mfma_f32_16x16x32_bf16 v[200:203], a[184:187], v[152:155], v[200:203]
    s_waitcnt lgkmcnt(6)
    s_add_u32 m0, s39, 135168
    ds_read_b64_tr_b16 a[140:141], v12 offset:57344
    v_mfma_f32_16x16x32_bf16 v[200:203], a[188:191], v[156:159], v[200:203]
    ds_read_b64_tr_b16 a[142:143], v12 offset:61440
    buffer_load_dwordx4 v57, s[32:35], s49 offen lds
    v_mfma_f32_16x16x32_bf16 v[204:207], a[160:163], v[160:163], 0
    ds_read_b64_tr_b16 a[144:145], v16 offset:32768
    v_mfma_f32_16x16x32_bf16 v[204:207], a[164:167], v[164:167], v[204:207]
    s_add_u32 s49, s36, 589824
    ds_read_b64_tr_b16 a[146:147], v16 offset:36864
    v_mfma_f32_16x16x32_bf16 v[204:207], a[168:171], v[168:171], v[204:207]
    s_add_u32 m0, s39, 139264
    ds_read_b64_tr_b16 a[148:149], v16 offset:40960
    v_mfma_f32_16x16x32_bf16 v[204:207], a[172:175], v[172:175], v[204:207]
    ds_read_b64_tr_b16 a[150:151], v16 offset:45056
    buffer_load_dwordx4 v57, s[32:35], s49 offen lds
    v_mfma_f32_16x16x32_bf16 v[204:207], a[176:179], v[176:179], v[204:207]
    ds_read_b64_tr_b16 a[152:153], v16 offset:49152
    v_cvt_pk_bf16_f32 v234, v200, v201
    v_mfma_f32_16x16x32_bf16 v[204:207], a[180:183], v[180:183], v[204:207]
    s_add_u32 s38, s47, 1664
    s_add_u32 s49, s36, 1179648
    ds_read_b64_tr_b16 a[154:155], v16 offset:53248
    v_cvt_pk_bf16_f32 v235, v202, v203
    v_mfma_f32_16x16x32_bf16 v[204:207], a[184:187], v[184:187], v[204:207]
    s_add_u32 m0, s39, 143360
    ds_read_b64_tr_b16 a[156:157], v16 offset:57344
    buffer_store_dwordx4 v[232:235], v56, s[28:31], s38 offen sc1
    v_mfma_f32_16x16x32_bf16 v[204:207], a[188:191], v[188:191], v[204:207]
    s_waitcnt lgkmcnt(13)
    ds_read_b64_tr_b16 a[158:159], v16 offset:61440
    buffer_load_dwordx4 v57, s[32:35], s49 offen lds
    v_mfma_f32_16x16x32_bf16 v[192:195], a[128:131], v[128:131], 0
    s_waitcnt lgkmcnt(12)
    ds_read_b64_tr_b16 a[160:161], v13 offset:32768
    v_mfma_f32_16x16x32_bf16 v[192:195], a[132:135], v[132:135], v[192:195]
    s_waitcnt lgkmcnt(11)
    s_add_u32 s49, s36, 1769472
    ds_read_b64_tr_b16 a[162:163], v13 offset:36864
    v_mfma_f32_16x16x32_bf16 v[192:195], a[136:139], v[136:139], v[192:195]
    s_waitcnt lgkmcnt(10)
    s_add_u32 m0, s39, 147456
    ds_read_b64_tr_b16 a[164:165], v13 offset:40960
    v_mfma_f32_16x16x32_bf16 v[192:195], a[140:143], v[140:143], v[192:195]
    s_waitcnt lgkmcnt(9)
    ds_read_b64_tr_b16 a[166:167], v13 offset:45056
    buffer_load_dwordx4 v57, s[32:35], s49 offen lds
    v_mfma_f32_16x16x32_bf16 v[192:195], a[144:147], v[144:147], v[192:195]
    s_waitcnt lgkmcnt(8)
    ds_read_b64_tr_b16 a[168:169], v13 offset:49152
    v_cvt_pk_bf16_f32 v238, v204, v205
    v_mfma_f32_16x16x32_bf16 v[192:195], a[148:151], v[148:151], v[192:195]
    s_waitcnt lgkmcnt(7)
    s_add_u32 s38, s47, 296576
    s_add_u32 s49, s36, 2359296
    ds_read_b64_tr_b16 a[170:171], v13 offset:53248
    v_cvt_pk_bf16_f32 v239, v206, v207
    v_mfma_f32_16x16x32_bf16 v[192:195], a[152:155], v[152:155], v[192:195]
    s_waitcnt lgkmcnt(6)
    s_add_u32 m0, s39, 151552
    ds_read_b64_tr_b16 a[172:173], v13 offset:57344
    buffer_store_dwordx4 v[236:239], v56, s[28:31], s38 offen sc1
    v_mfma_f32_16x16x32_bf16 v[192:195], a[156:159], v[156:159], v[192:195]
    ds_read_b64_tr_b16 a[174:175], v13 offset:61440
    buffer_load_dwordx4 v57, s[32:35], s49 offen lds
    v_mfma_f32_16x16x32_bf16 v[196:199], a[128:131], v[160:163], 0
    ds_read_b64_tr_b16 a[176:177], v17 offset:32768
    v_mfma_f32_16x16x32_bf16 v[196:199], a[132:135], v[164:167], v[196:199]
    s_add_u32 s49, s36, 2949120
    ds_read_b64_tr_b16 a[178:179], v17 offset:36864
    v_mfma_f32_16x16x32_bf16 v[196:199], a[136:139], v[168:171], v[196:199]
    s_add_u32 m0, s39, 155648
    ds_read_b64_tr_b16 a[180:181], v17 offset:40960
    v_mfma_f32_16x16x32_bf16 v[196:199], a[140:143], v[172:175], v[196:199]
    ds_read_b64_tr_b16 a[182:183], v17 offset:45056
    buffer_load_dwordx4 v57, s[32:35], s49 offen lds
    v_mfma_f32_16x16x32_bf16 v[196:199], a[144:147], v[176:179], v[196:199]
    ds_read_b64_tr_b16 a[184:185], v17 offset:49152
    v_cvt_pk_bf16_f32 v224, v192, v193
    v_mfma_f32_16x16x32_bf16 v[196:199], a[148:151], v[180:183], v[196:199]
    s_add_u32 s49, s36, 3538944
    ds_read_b64_tr_b16 a[186:187], v17 offset:53248
    v_cvt_pk_bf16_f32 v225, v194, v195
    v_mfma_f32_16x16x32_bf16 v[196:199], a[152:155], v[184:187], v[196:199]
    s_add_u32 m0, s39, 159744
    ds_read_b64_tr_b16 a[188:189], v17 offset:57344
    v_mfma_f32_16x16x32_bf16 v[196:199], a[156:159], v[188:191], v[196:199]
    s_waitcnt lgkmcnt(13)
    ds_read_b64_tr_b16 a[190:191], v17 offset:61440
    buffer_load_dwordx4 v57, s[32:35], s49 offen lds
    v_mfma_f32_16x16x32_bf16 v[200:203], a[160:163], v[128:131], 0
    s_waitcnt lgkmcnt(12)
    ds_read_b64_tr_b16 a[128:129], v14 offset:32768
    v_mfma_f32_16x16x32_bf16 v[200:203], a[164:167], v[132:135], v[200:203]
    s_waitcnt lgkmcnt(11)
    ds_read_b64_tr_b16 a[130:131], v14 offset:36864
    v_mfma_f32_16x16x32_bf16 v[200:203], a[168:171], v[136:139], v[200:203]
    s_waitcnt lgkmcnt(10)
    ds_read_b64_tr_b16 a[132:133], v14 offset:40960
    v_mfma_f32_16x16x32_bf16 v[200:203], a[172:175], v[140:143], v[200:203]
    s_waitcnt lgkmcnt(9)
    ds_read_b64_tr_b16 a[134:135], v14 offset:45056
    v_mfma_f32_16x16x32_bf16 v[200:203], a[176:179], v[144:147], v[200:203]
    s_waitcnt lgkmcnt(8)
    ds_read_b64_tr_b16 a[136:137], v14 offset:49152
    v_cvt_pk_bf16_f32 v228, v196, v197
    v_mfma_f32_16x16x32_bf16 v[200:203], a[180:183], v[148:151], v[200:203]
    s_waitcnt lgkmcnt(7)
    ds_read_b64_tr_b16 a[138:139], v14 offset:53248
    v_cvt_pk_bf16_f32 v229, v198, v199
    v_mfma_f32_16x16x32_bf16 v[200:203], a[184:187], v[152:155], v[200:203]
    s_waitcnt lgkmcnt(6)
    ds_read_b64_tr_b16 a[140:141], v14 offset:57344
    v_mfma_f32_16x16x32_bf16 v[200:203], a[188:191], v[156:159], v[200:203]
    ds_read_b64_tr_b16 a[142:143], v14 offset:61440
    v_mfma_f32_16x16x32_bf16 v[204:207], a[160:163], v[160:163], 0
    ds_read_b64_tr_b16 a[144:145], v18 offset:32768
    v_mfma_f32_16x16x32_bf16 v[204:207], a[164:167], v[164:167], v[204:207]
    ds_read_b64_tr_b16 a[146:147], v18 offset:36864
    v_mfma_f32_16x16x32_bf16 v[204:207], a[168:171], v[168:171], v[204:207]
    ds_read_b64_tr_b16 a[148:149], v18 offset:40960
    v_mfma_f32_16x16x32_bf16 v[204:207], a[172:175], v[172:175], v[204:207]
    ds_read_b64_tr_b16 a[150:151], v18 offset:45056
    v_mfma_f32_16x16x32_bf16 v[204:207], a[176:179], v[176:179], v[204:207]
    ds_read_b64_tr_b16 a[152:153], v18 offset:49152
    v_cvt_pk_bf16_f32 v226, v200, v201
    v_mfma_f32_16x16x32_bf16 v[204:207], a[180:183], v[180:183], v[204:207]
    s_add_u32 s38, s47, 1792
    ds_read_b64_tr_b16 a[154:155], v18 offset:53248
    v_cvt_pk_bf16_f32 v227, v202, v203
    v_mfma_f32_16x16x32_bf16 v[204:207], a[184:187], v[184:187], v[204:207]
    ds_read_b64_tr_b16 a[156:157], v18 offset:57344
    buffer_store_dwordx4 v[224:227], v56, s[28:31], s38 offen sc1
    v_mfma_f32_16x16x32_bf16 v[204:207], a[188:191], v[188:191], v[204:207]
    s_waitcnt lgkmcnt(13)
    ds_read_b64_tr_b16 a[158:159], v18 offset:61440
    v_mfma_f32_16x16x32_bf16 v[192:195], a[128:131], v[128:131], 0
    s_waitcnt lgkmcnt(12)
    ds_read_b64_tr_b16 a[160:161], v15 offset:32768
    v_mfma_f32_16x16x32_bf16 v[192:195], a[132:135], v[132:135], v[192:195]
    s_waitcnt lgkmcnt(11)
    ds_read_b64_tr_b16 a[162:163], v15 offset:36864
    v_mfma_f32_16x16x32_bf16 v[192:195], a[136:139], v[136:139], v[192:195]
    s_waitcnt lgkmcnt(10)
    ds_read_b64_tr_b16 a[164:165], v15 offset:40960
    v_mfma_f32_16x16x32_bf16 v[192:195], a[140:143], v[140:143], v[192:195]
    s_waitcnt lgkmcnt(9)
    ds_read_b64_tr_b16 a[166:167], v15 offset:45056
    v_mfma_f32_16x16x32_bf16 v[192:195], a[144:147], v[144:147], v[192:195]
    s_waitcnt lgkmcnt(8)
    ds_read_b64_tr_b16 a[168:169], v15 offset:49152
    v_cvt_pk_bf16_f32 v230, v204, v205
    v_mfma_f32_16x16x32_bf16 v[192:195], a[148:151], v[148:151], v[192:195]
    s_waitcnt lgkmcnt(7)
    s_add_u32 s38, s47, 296704
    ds_read_b64_tr_b16 a[170:171], v15 offset:53248
    v_cvt_pk_bf16_f32 v231, v206, v207
    v_mfma_f32_16x16x32_bf16 v[192:195], a[152:155], v[152:155], v[192:195]
    s_waitcnt lgkmcnt(6)
    ds_read_b64_tr_b16 a[172:173], v15 offset:57344
    buffer_store_dwordx4 v[228:231], v56, s[28:31], s38 offen sc1
    v_mfma_f32_16x16x32_bf16 v[192:195], a[156:159], v[156:159], v[192:195]
    ds_read_b64_tr_b16 a[174:175], v15 offset:61440
    v_mfma_f32_16x16x32_bf16 v[196:199], a[128:131], v[160:163], 0
    ds_read_b64_tr_b16 a[176:177], v19 offset:32768
    v_mfma_f32_16x16x32_bf16 v[196:199], a[132:135], v[164:167], v[196:199]
    ds_read_b64_tr_b16 a[178:179], v19 offset:36864
    v_mfma_f32_16x16x32_bf16 v[196:199], a[136:139], v[168:171], v[196:199]
    ds_read_b64_tr_b16 a[180:181], v19 offset:40960
    v_mfma_f32_16x16x32_bf16 v[196:199], a[140:143], v[172:175], v[196:199]
    ds_read_b64_tr_b16 a[182:183], v19 offset:45056
    v_mfma_f32_16x16x32_bf16 v[196:199], a[144:147], v[176:179], v[196:199]
    ds_read_b64_tr_b16 a[184:185], v19 offset:49152
    v_cvt_pk_bf16_f32 v232, v192, v193
    v_mfma_f32_16x16x32_bf16 v[196:199], a[148:151], v[180:183], v[196:199]
    ds_read_b64_tr_b16 a[186:187], v19 offset:53248
    v_cvt_pk_bf16_f32 v233, v194, v195
    v_mfma_f32_16x16x32_bf16 v[196:199], a[152:155], v[184:187], v[196:199]
    ds_read_b64_tr_b16 a[188:189], v19 offset:57344
    v_mfma_f32_16x16x32_bf16 v[196:199], a[156:159], v[188:191], v[196:199]
    ds_read_b64_tr_b16 a[190:191], v19 offset:61440
    s_waitcnt vmcnt(26)
    s_waitcnt lgkmcnt(0)
    s_barrier
    v_mfma_f32_16x16x32_bf16 v[200:203], a[160:163], v[128:131], 0
    ds_read_b64_tr_b16 a[128:129], v20 offset:0
    v_mfma_f32_16x16x32_bf16 v[200:203], a[164:167], v[132:135], v[200:203]
    s_add_u32 s49, s36, 4128768
    ds_read_b64_tr_b16 a[130:131], v20 offset:4096
    v_mfma_f32_16x16x32_bf16 v[200:203], a[168:171], v[136:139], v[200:203]
    s_add_u32 m0, s39, 36864
    ds_read_b64_tr_b16 a[132:133], v20 offset:8192
    v_mfma_f32_16x16x32_bf16 v[200:203], a[172:175], v[140:143], v[200:203]
    ds_read_b64_tr_b16 a[134:135], v20 offset:12288
    buffer_load_dwordx4 v57, s[32:35], s49 offen lds
    v_mfma_f32_16x16x32_bf16 v[200:203], a[176:179], v[144:147], v[200:203]
    ds_read_b64_tr_b16 a[136:137], v20 offset:16384
    v_cvt_pk_bf16_f32 v236, v196, v197
    v_mfma_f32_16x16x32_bf16 v[200:203], a[180:183], v[148:151], v[200:203]
    s_add_u32 s49, s36, 4718592
    ds_read_b64_tr_b16 a[138:139], v20 offset:20480
    v_cvt_pk_bf16_f32 v237, v198, v199
    v_mfma_f32_16x16x32_bf16 v[200:203], a[184:187], v[152:155], v[200:203]
    s_add_u32 m0, s39, 40960
    ds_read_b64_tr_b16 a[140:141], v20 offset:24576
    v_mfma_f32_16x16x32_bf16 v[200:203], a[188:191], v[156:159], v[200:203]
    ds_read_b64_tr_b16 a[142:143], v20 offset:28672
    buffer_load_dwordx4 v57, s[32:35], s49 offen lds
    v_mfma_f32_16x16x32_bf16 v[204:207], a[160:163], v[160:163], 0
    ds_read_b64_tr_b16 a[144:145], v24 offset:0
    v_mfma_f32_16x16x32_bf16 v[204:207], a[164:167], v[164:167], v[204:207]
    s_add_u32 s49, s37, 0
    ds_read_b64_tr_b16 a[146:147], v24 offset:4096
    v_mfma_f32_16x16x32_bf16 v[204:207], a[168:171], v[168:171], v[204:207]
    s_add_u32 m0, s39, 0
    ds_read_b64_tr_b16 a[148:149], v24 offset:8192
    v_mfma_f32_16x16x32_bf16 v[204:207], a[172:175], v[172:175], v[204:207]
    ds_read_b64_tr_b16 a[150:151], v24 offset:12288
    buffer_load_dwordx4 v62, s[84:87], s49 offen lds
    v_mfma_f32_16x16x32_bf16 v[204:207], a[176:179], v[176:179], v[204:207]
    ds_read_b64_tr_b16 a[152:153], v24 offset:16384
    v_cvt_pk_bf16_f32 v234, v200, v201
    v_mfma_f32_16x16x32_bf16 v[204:207], a[180:183], v[180:183], v[204:207]
    s_add_u32 s38, s47, 1920
    s_add_u32 s49, s37, 4096
    ds_read_b64_tr_b16 a[154:155], v24 offset:20480
    v_cvt_pk_bf16_f32 v235, v202, v203
    v_mfma_f32_16x16x32_bf16 v[204:207], a[184:187], v[184:187], v[204:207]
    s_add_u32 m0, s39, 4096
    ds_read_b64_tr_b16 a[156:157], v24 offset:24576
    buffer_store_dwordx4 v[232:235], v56, s[28:31], s38 offen sc1
    v_mfma_f32_16x16x32_bf16 v[204:207], a[188:191], v[188:191], v[204:207]
    s_waitcnt lgkmcnt(13)
    ds_read_b64_tr_b16 a[158:159], v24 offset:28672
    buffer_load_dwordx4 v62, s[84:87], s49 offen lds
    v_mfma_f32_16x16x32_bf16 v[192:195], a[128:131], v[128:131], 0
    s_waitcnt lgkmcnt(12)
    ds_read_b64_tr_b16 a[160:161], v21 offset:0
    v_mfma_f32_16x16x32_bf16 v[192:195], a[132:135], v[132:135], v[192:195]
    s_waitcnt lgkmcnt(11)
    s_add_u32 s49, s37, 8192
    ds_read_b64_tr_b16 a[162:163], v21 offset:4096
    v_mfma_f32_16x16x32_bf16 v[192:195], a[136:139], v[136:139], v[192:195]
    s_waitcnt lgkmcnt(10)
    s_add_u32 m0, s39, 8192
    ds_read_b64_tr_b16 a[164:165], v21 offset:8192
    v_mfma_f32_16x16x32_bf16 v[192:195], a[140:143], v[140:143], v[192:195]
    s_waitcnt lgkmcnt(9)
    ds_read_b64_tr_b16 a[166:167], v21 offset:12288
    buffer_load_dwordx4 v62, s[84:87], s49 offen lds
    v_mfma_f32_16x16x32_bf16 v[192:195], a[144:147], v[144:147], v[192:195]
    s_waitcnt lgkmcnt(8)
    ds_read_b64_tr_b16 a[168:169], v21 offset:16384
    v_cvt_pk_bf16_f32 v238, v204, v205
    v_mfma_f32_16x16x32_bf16 v[192:195], a[148:151], v[148:151], v[192:195]
    s_waitcnt lgkmcnt(7)
    s_add_u32 s38, s47, 296832
    s_add_u32 s49, s37, 12288
    ds_read_b64_tr_b16 a[170:171], v21 offset:20480
    v_cvt_pk_bf16_f32 v239, v206, v207
    v_mfma_f32_16x16x32_bf16 v[192:195], a[152:155], v[152:155], v[192:195]
    s_waitcnt lgkmcnt(6)
    s_add_u32 m0, s39, 12288
    ds_read_b64_tr_b16 a[172:173], v21 offset:24576
    buffer_store_dwordx4 v[236:239], v56, s[28:31], s38 offen sc1
    v_mfma_f32_16x16x32_bf16 v[192:195], a[156:159], v[156:159], v[192:195]
    ds_read_b64_tr_b16 a[174:175], v21 offset:28672
    buffer_load_dwordx4 v62, s[84:87], s49 offen lds
    v_mfma_f32_16x16x32_bf16 v[196:199], a[128:131], v[160:163], 0
    ds_read_b64_tr_b16 a[176:177], v25 offset:0
    v_mfma_f32_16x16x32_bf16 v[196:199], a[132:135], v[164:167], v[196:199]
    s_add_u32 s49, s37, 16384
    ds_read_b64_tr_b16 a[178:179], v25 offset:4096
    v_mfma_f32_16x16x32_bf16 v[196:199], a[136:139], v[168:171], v[196:199]
    s_add_u32 m0, s39, 16384
    ds_read_b64_tr_b16 a[180:181], v25 offset:8192
    v_mfma_f32_16x16x32_bf16 v[196:199], a[140:143], v[172:175], v[196:199]
    ds_read_b64_tr_b16 a[182:183], v25 offset:12288
    buffer_load_dwordx4 v62, s[84:87], s49 offen lds
    v_mfma_f32_16x16x32_bf16 v[196:199], a[144:147], v[176:179], v[196:199]
    ds_read_b64_tr_b16 a[184:185], v25 offset:16384
    v_cvt_pk_bf16_f32 v224, v192, v193
    v_mfma_f32_16x16x32_bf16 v[196:199], a[148:151], v[180:183], v[196:199]
    s_add_u32 s49, s37, 20480
    ds_read_b64_tr_b16 a[186:187], v25 offset:20480
    v_cvt_pk_bf16_f32 v225, v194, v195
    v_mfma_f32_16x16x32_bf16 v[196:199], a[152:155], v[184:187], v[196:199]
    s_add_u32 m0, s39, 20480
    ds_read_b64_tr_b16 a[188:189], v25 offset:24576
    v_mfma_f32_16x16x32_bf16 v[196:199], a[156:159], v[188:191], v[196:199]
    s_waitcnt lgkmcnt(13)
    ds_read_b64_tr_b16 a[190:191], v25 offset:28672
    buffer_load_dwordx4 v62, s[84:87], s49 offen lds
    v_mfma_f32_16x16x32_bf16 v[200:203], a[160:163], v[128:131], 0
    s_waitcnt lgkmcnt(12)
    ds_read_b64_tr_b16 a[128:129], v22 offset:0
    v_mfma_f32_16x16x32_bf16 v[200:203], a[164:167], v[132:135], v[200:203]
    s_waitcnt lgkmcnt(11)
    s_add_u32 s49, s37, 24576
    ds_read_b64_tr_b16 a[130:131], v22 offset:4096
    v_mfma_f32_16x16x32_bf16 v[200:203], a[168:171], v[136:139], v[200:203]
    s_waitcnt lgkmcnt(10)
    s_add_u32 m0, s39, 24576
    ds_read_b64_tr_b16 a[132:133], v22 offset:8192
    v_mfma_f32_16x16x32_bf16 v[200:203], a[172:175], v[140:143], v[200:203]
    s_waitcnt lgkmcnt(9)
    ds_read_b64_tr_b16 a[134:135], v22 offset:12288
    buffer_load_dwordx4 v62, s[84:87], s49 offen lds
    v_mfma_f32_16x16x32_bf16 v[200:203], a[176:179], v[144:147], v[200:203]
    s_waitcnt lgkmcnt(8)
    ds_read_b64_tr_b16 a[136:137], v22 offset:16384
    v_cvt_pk_bf16_f32 v228, v196, v197
    v_mfma_f32_16x16x32_bf16 v[200:203], a[180:183], v[148:151], v[200:203]
    s_waitcnt lgkmcnt(7)
    s_add_u32 s49, s37, 28672
    ds_read_b64_tr_b16 a[138:139], v22 offset:20480
    v_cvt_pk_bf16_f32 v229, v198, v199
    v_mfma_f32_16x16x32_bf16 v[200:203], a[184:187], v[152:155], v[200:203]
    s_waitcnt lgkmcnt(6)
    s_add_u32 m0, s39, 28672
    ds_read_b64_tr_b16 a[140:141], v22 offset:24576
    v_mfma_f32_16x16x32_bf16 v[200:203], a[188:191], v[156:159], v[200:203]
    ds_read_b64_tr_b16 a[142:143], v22 offset:28672
    buffer_load_dwordx4 v62, s[84:87], s49 offen lds
    v_mfma_f32_16x16x32_bf16 v[204:207], a[160:163], v[160:163], 0
    ds_read_b64_tr_b16 a[144:145], v26 offset:0
    v_mfma_f32_16x16x32_bf16 v[204:207], a[164:167], v[164:167], v[204:207]
    s_add_u32 s49, s37, 32768
    ds_read_b64_tr_b16 a[146:147], v26 offset:4096
    v_mfma_f32_16x16x32_bf16 v[204:207], a[168:171], v[168:171], v[204:207]
    s_add_u32 m0, s39, 32768
    ds_read_b64_tr_b16 a[148:149], v26 offset:8192
    v_mfma_f32_16x16x32_bf16 v[204:207], a[172:175], v[172:175], v[204:207]
    ds_read_b64_tr_b16 a[150:151], v26 offset:12288
    buffer_load_dwordx4 v62, s[84:87], s49 offen lds
    v_mfma_f32_16x16x32_bf16 v[204:207], a[176:179], v[176:179], v[204:207]
    ds_read_b64_tr_b16 a[152:153], v26 offset:16384
    v_cvt_pk_bf16_f32 v226, v200, v201
    v_mfma_f32_16x16x32_bf16 v[204:207], a[180:183], v[180:183], v[204:207]
    s_add_u32 s38, s47, 2048
    ds_read_b64_tr_b16 a[154:155], v26 offset:20480
    v_cvt_pk_bf16_f32 v227, v202, v203
    v_mfma_f32_16x16x32_bf16 v[204:207], a[184:187], v[184:187], v[204:207]
    ds_read_b64_tr_b16 a[156:157], v26 offset:24576
    buffer_store_dwordx4 v[224:227], v56, s[28:31], s38 offen sc1
    v_mfma_f32_16x16x32_bf16 v[204:207], a[188:191], v[188:191], v[204:207]
    s_waitcnt lgkmcnt(13)
    ds_read_b64_tr_b16 a[158:159], v26 offset:28672
    v_mfma_f32_16x16x32_bf16 v[192:195], a[128:131], v[128:131], 0
    s_waitcnt lgkmcnt(12)
    ds_read_b64_tr_b16 a[160:161], v23 offset:0
    v_mfma_f32_16x16x32_bf16 v[192:195], a[132:135], v[132:135], v[192:195]
    s_waitcnt lgkmcnt(11)
    ds_read_b64_tr_b16 a[162:163], v23 offset:4096
    v_mfma_f32_16x16x32_bf16 v[192:195], a[136:139], v[136:139], v[192:195]
    s_waitcnt lgkmcnt(10)
    ds_read_b64_tr_b16 a[164:165], v23 offset:8192
    v_mfma_f32_16x16x32_bf16 v[192:195], a[140:143], v[140:143], v[192:195]
    s_waitcnt lgkmcnt(9)
    ds_read_b64_tr_b16 a[166:167], v23 offset:12288
    v_mfma_f32_16x16x32_bf16 v[192:195], a[144:147], v[144:147], v[192:195]
    s_waitcnt lgkmcnt(8)
    ds_read_b64_tr_b16 a[168:169], v23 offset:16384
    v_cvt_pk_bf16_f32 v230, v204, v205
    v_mfma_f32_16x16x32_bf16 v[192:195], a[148:151], v[148:151], v[192:195]
    s_waitcnt lgkmcnt(7)
    s_add_u32 s38, s47, 296960
    ds_read_b64_tr_b16 a[170:171], v23 offset:20480
    v_cvt_pk_bf16_f32 v231, v206, v207
    v_mfma_f32_16x16x32_bf16 v[192:195], a[152:155], v[152:155], v[192:195]
    s_waitcnt lgkmcnt(6)
    ds_read_b64_tr_b16 a[172:173], v23 offset:24576
    buffer_store_dwordx4 v[228:231], v56, s[28:31], s38 offen sc1
    v_mfma_f32_16x16x32_bf16 v[192:195], a[156:159], v[156:159], v[192:195]
    ds_read_b64_tr_b16 a[174:175], v23 offset:28672
    v_mfma_f32_16x16x32_bf16 v[196:199], a[128:131], v[160:163], 0
    ds_read_b64_tr_b16 a[176:177], v27 offset:0
    v_mfma_f32_16x16x32_bf16 v[196:199], a[132:135], v[164:167], v[196:199]
    ds_read_b64_tr_b16 a[178:179], v27 offset:4096
    v_mfma_f32_16x16x32_bf16 v[196:199], a[136:139], v[168:171], v[196:199]
    ds_read_b64_tr_b16 a[180:181], v27 offset:8192
    v_mfma_f32_16x16x32_bf16 v[196:199], a[140:143], v[172:175], v[196:199]
    ds_read_b64_tr_b16 a[182:183], v27 offset:12288
    v_mfma_f32_16x16x32_bf16 v[196:199], a[144:147], v[176:179], v[196:199]
    ds_read_b64_tr_b16 a[184:185], v27 offset:16384
    v_cvt_pk_bf16_f32 v232, v192, v193
    v_mfma_f32_16x16x32_bf16 v[196:199], a[148:151], v[180:183], v[196:199]
    ds_read_b64_tr_b16 a[186:187], v27 offset:20480
    v_cvt_pk_bf16_f32 v233, v194, v195
    v_mfma_f32_16x16x32_bf16 v[196:199], a[152:155], v[184:187], v[196:199]
    ds_read_b64_tr_b16 a[188:189], v27 offset:24576
    v_mfma_f32_16x16x32_bf16 v[196:199], a[156:159], v[188:191], v[196:199]
    s_waitcnt lgkmcnt(13)
    ds_read_b64_tr_b16 a[190:191], v27 offset:28672
    v_mfma_f32_16x16x32_bf16 v[200:203], a[160:163], v[128:131], 0
    s_waitcnt lgkmcnt(12)
    v_mfma_f32_16x16x32_bf16 v[200:203], a[164:167], v[132:135], v[200:203]
    s_waitcnt lgkmcnt(10)
    v_mfma_f32_16x16x32_bf16 v[200:203], a[168:171], v[136:139], v[200:203]
    s_waitcnt lgkmcnt(8)
    v_mfma_f32_16x16x32_bf16 v[200:203], a[172:175], v[140:143], v[200:203]
    s_waitcnt lgkmcnt(6)
    v_mfma_f32_16x16x32_bf16 v[200:203], a[176:179], v[144:147], v[200:203]
    s_waitcnt lgkmcnt(4)
    v_cvt_pk_bf16_f32 v236, v196, v197
    v_mfma_f32_16x16x32_bf16 v[200:203], a[180:183], v[148:151], v[200:203]
    s_waitcnt lgkmcnt(2)
    v_cvt_pk_bf16_f32 v237, v198, v199
    v_mfma_f32_16x16x32_bf16 v[200:203], a[184:187], v[152:155], v[200:203]
    s_waitcnt lgkmcnt(0)
    v_mfma_f32_16x16x32_bf16 v[200:203], a[188:191], v[156:159], v[200:203]
    v_mfma_f32_16x16x32_bf16 v[204:207], a[160:163], v[160:163], 0
    v_mfma_f32_16x16x32_bf16 v[204:207], a[164:167], v[164:167], v[204:207]
    v_mfma_f32_16x16x32_bf16 v[204:207], a[168:171], v[168:171], v[204:207]
    v_mfma_f32_16x16x32_bf16 v[204:207], a[172:175], v[172:175], v[204:207]
    v_mfma_f32_16x16x32_bf16 v[204:207], a[176:179], v[176:179], v[204:207]
    s_nop 2
    v_cvt_pk_bf16_f32 v234, v200, v201
    v_mfma_f32_16x16x32_bf16 v[204:207], a[180:183], v[180:183], v[204:207]
    s_add_u32 s38, s47, 2176
    v_cvt_pk_bf16_f32 v235, v202, v203
    v_mfma_f32_16x16x32_bf16 v[204:207], a[184:187], v[184:187], v[204:207]
    buffer_store_dwordx4 v[232:235], v56, s[28:31], s38 offen sc1
    v_mfma_f32_16x16x32_bf16 v[204:207], a[188:191], v[188:191], v[204:207]
    s_nop 7
    v_cvt_pk_bf16_f32 v238, v204, v205
    s_add_u32 s38, s47, 297088
    v_cvt_pk_bf16_f32 v239, v206, v207
    buffer_store_dwordx4 v[236:239], v56, s[28:31], s38 offen sc1
    s_lshl_b32 s40, s5, 4
    s_add_u32 s40, s40, s4
    s_load_dwordx2 s[52:53], s[0:1], 0
    s_load_dwordx2 s[54:55], s[0:1], 96
    s_load_dwordx2 s[56:57], s[0:1], 48
    s_add_u32 s24, s50, 7856128
    s_addc_u32 s25, s51, 0
    s_mov_b32 s26, 4096
    s_mov_b32 s27, 0x20000
    s_lshl_b32 s36, s5, 8
    s_lshl_b32 s37, s3, 6
    s_add_u32 s37, s37, s36
    s_lshl_b32 s38, s4, 2
    s_add_u32 s37, s37, s38
    s_lshr_b32 s38, s4, 2
    s_lshl_b32 s38, s38, 6
    s_add_u32 s39, s38, s36
    v_mov_b32 v14, 0
    v_and_b32 v15, 15, v1
    v_lshlrev_b32 v15, 2, v15
    s_waitcnt lgkmcnt(0)
    v_and_b32 v8, 31, v1
    v_lshrrev_b32 v9, 5, v1
    v_cmp_gt_u32 vcc, 24, v8
    v_mov_b32 v10, 2147483648
    s_lshl_b32 s43, s40, 3
    s_lshl_b32 s44, s3, 1
    s_add_u32 s43, s43, s44
    v_cndmask_b32 v10, v10, 0, vcc
    v_add_u32 v7, s43, v9
    v_lshl_add_u32 v5, v8, 4, v10
    v_lshl_add_u32 v11, v9, 4, v10
    v_lshl_add_u32 v2, v8, 5, v11
    s_mul_i32 s44, s43, 18432
    v_lshrrev_b32 v11, 2, v8
    v_lshl_add_u32 v11, v11, 6, v10
    v_and_b32 v12, 3, v8
    v_lshl_add_u32 v3, v12, 3, v11
    v_mul_u32_u24 v11, 1152, v7
    v_add_u32 v4, v11, v3
    v_add_u32 v6, v11, v5
    s_lshr_b32 s41, s2, 3
    s_and_b32 s42, s2, 7
    s_mov_b32 s8, s50
    s_mov_b32 s9, s51
    s_mov_b32 s10, 10485760
    s_mov_b32 s11, 0x20000
    s_mov_b32 s12, s52
    s_mov_b32 s13, s53
    s_mov_b32 s14, 2359296
    s_mov_b32 s15, 0x20000
    s_mov_b32 s16, s54
    s_mov_b32 s17, s55
    s_mov_b32 s18, 2359296
    s_mov_b32 s19, 0x20000
    s_mov_b32 s20, s56
    s_mov_b32 s21, s57
    s_mov_b32 s22, 1152
    s_mov_b32 s23, 0x20000
    s_add_u32 s32, s50, 7864320
    s_addc_u32 s33, s51, 0
    s_mov_b32 s34, 663552
    s_mov_b32 s35, 0x20000
    buffer_load_dwordx2 v[40:41], v4, s[12:15], 0 offen offset:0
    buffer_load_dwordx2 v[42:43], v4, s[12:15], 0 offen offset:32
    buffer_load_dwordx2 v[44:45], v4, s[12:15], 0 offen offset:384
    buffer_load_dwordx2 v[46:47], v4, s[12:15], 0 offen offset:416
    buffer_load_dwordx2 v[48:49], v4, s[12:15], 0 offen offset:768
    buffer_load_dwordx2 v[50:51], v4, s[12:15], 0 offen offset:800
    s_mov_b32 s45, 18688
    buffer_load_dwordx4 v[52:55], v5, s[8:11], s45 offen offset:0
    buffer_load_dwordx4 v[56:59], v5, s[8:11], s45 offen offset:384
    buffer_load_dwordx4 v[60:63], v5, s[8:11], s45 offen offset:768
    s_mov_b32 s45, 20992
    buffer_load_dwordx4 v[64:67], v5, s[8:11], s45 offen offset:0
    buffer_load_dwordx4 v[68:71], v5, s[8:11], s45 offen offset:384
    buffer_load_dwordx4 v[72:75], v5, s[8:11], s45 offen offset:768
    s_mov_b32 s45, 19840
    buffer_load_dwordx4 v[76:79], v5, s[8:11], s45 offen offset:0
    buffer_load_dwordx4 v[80:83], v5, s[8:11], s45 offen offset:384
    buffer_load_dwordx4 v[84:87], v5, s[8:11], s45 offen offset:768
    buffer_load_dwordx2 v[88:89], v3, s[20:23], 0 offen offset:0
    buffer_load_dwordx2 v[90:91], v3, s[20:23], 0 offen offset:32
    buffer_load_dwordx2 v[92:93], v3, s[20:23], 0 offen offset:384
    buffer_load_dwordx2 v[94:95], v3, s[20:23], 0 offen offset:416
    buffer_load_dwordx2 v[96:97], v3, s[20:23], 0 offen offset:768
    buffer_load_dwordx2 v[98:99], v3, s[20:23], 0 offen offset:800
    s_mov_b32 s45, 22144
    buffer_load_dwordx4 v[100:103], v5, s[8:11], s45 offen offset:0
    buffer_load_dwordx4 v[104:107], v5, s[8:11], s45 offen offset:384
    buffer_load_dwordx4 v[108:111], v5, s[8:11], s45 offen offset:768
    s_waitcnt vmcnt(24)
    s_mov_b64 exec, 1
    buffer_store_dword v14, v14, s[24:27], s37 offen sc1
    s_mov_b64 exec, -1
    v_lshrrev_b32 v8, 4, v1
    v_bfe_u32 v9, v1, 2, 2
    v_cmp_eq_u32 s[36:37], v8, v9
    v_and_b32 v8, 1, v1
    v_lshlrev_b32 v8, 4, v8
    v_mov_b32 v9, 0x3f80
    v_lshlrev_b32 v8, v8, v9
    v_cndmask_b32 v8, 0, v8, s[36:37]
    v_bfe_i32 v9, v1, 1, 1
    v_mov_b32 v32, 0
    v_mov_b32 v33, 0
    v_mov_b32 v36, 0
    v_mov_b32 v37, 0
    v_and_b32 v35, v8, v9
    v_xor_b32 v34, v8, v35
    s_waitcnt vmcnt(24)
    v_lshlrev_b32 v112, 16, v40
    v_and_b32 v113, 0xffff0000, v40
    v_lshlrev_b32 v114, 16, v41
    v_and_b32 v115, 0xffff0000, v41
    s_waitcnt vmcnt(23)
    v_lshlrev_b32 v116, 16, v42
    v_and_b32 v117, 0xffff0000, v42
    v_lshlrev_b32 v118, 16, v43
    v_and_b32 v119, 0xffff0000, v43
    s_waitcnt vmcnt(22)
    v_lshlrev_b32 v120, 16, v44
    v_and_b32 v121, 0xffff0000, v44
    v_lshlrev_b32 v122, 16, v45
    v_and_b32 v123, 0xffff0000, v45
    s_waitcnt vmcnt(21)
    v_lshlrev_b32 v124, 16, v46
    v_and_b32 v125, 0xffff0000, v46
    v_lshlrev_b32 v126, 16, v47
    v_and_b32 v127, 0xffff0000, v47
    s_waitcnt vmcnt(20)
    v_lshlrev_b32 v128, 16, v48
    v_and_b32 v129, 0xffff0000, v48
    v_lshlrev_b32 v130, 16, v49
    v_and_b32 v131, 0xffff0000, v49
    s_waitcnt vmcnt(19)
    v_lshlrev_b32 v132, 16, v50
    v_and_b32 v133, 0xffff0000, v50
    v_lshlrev_b32 v134, 16, v51
    v_and_b32 v135, 0xffff0000, v51
    s_waitcnt vmcnt(18)
    v_lshlrev_b32 v136, 16, v52
    v_and_b32 v137, 0xffff0000, v52
    v_lshlrev_b32 v138, 16, v53
    v_and_b32 v139, 0xffff0000, v53
    v_lshlrev_b32 v140, 16, v54
    v_and_b32 v141, 0xffff0000, v54
    v_lshlrev_b32 v142, 16, v55
    v_and_b32 v143, 0xffff0000, v55
    s_waitcnt vmcnt(17)
    v_lshlrev_b32 v144, 16, v56
    v_and_b32 v145, 0xffff0000, v56
    v_lshlrev_b32 v146, 16, v57
    v_and_b32 v147, 0xffff0000, v57
    v_lshlrev_b32 v148, 16, v58
    v_and_b32 v149, 0xffff0000, v58
    v_lshlrev_b32 v150, 16, v59
    v_and_b32 v151, 0xffff0000, v59
    s_waitcnt vmcnt(16)
    v_lshlrev_b32 v152, 16, v60
    v_and_b32 v153, 0xffff0000, v60
    v_lshlrev_b32 v154, 16, v61
    v_and_b32 v155, 0xffff0000, v61
    v_lshlrev_b32 v156, 16, v62
    v_and_b32 v157, 0xffff0000, v62
    v_lshlrev_b32 v158, 16, v63
    v_and_b32 v159, 0xffff0000, v63
    s_waitcnt vmcnt(15)
    v_lshlrev_b32 v160, 16, v64
    v_and_b32 v161, 0xffff0000, v64
    v_lshlrev_b32 v162, 16, v65
    v_and_b32 v163, 0xffff0000, v65
    v_lshlrev_b32 v164, 16, v66
    v_and_b32 v165, 0xffff0000, v66
    v_lshlrev_b32 v166, 16, v67
    v_and_b32 v167, 0xffff0000, v67
    s_waitcnt vmcnt(14)
    v_lshlrev_b32 v168, 16, v68
    v_and_b32 v169, 0xffff0000, v68
    v_lshlrev_b32 v170, 16, v69
    v_and_b32 v171, 0xffff0000, v69
    v_lshlrev_b32 v172, 16, v70
    v_and_b32 v173, 0xffff0000, v70
    v_lshlrev_b32 v174, 16, v71
    v_and_b32 v175, 0xffff0000, v71
    s_waitcnt vmcnt(13)
    v_lshlrev_b32 v176, 16, v72
    v_and_b32 v177, 0xffff0000, v72
    v_lshlrev_b32 v178, 16, v73
    v_and_b32 v179, 0xffff0000, v73
    v_lshlrev_b32 v180, 16, v74
    v_and_b32 v181, 0xffff0000, v74
    v_lshlrev_b32 v182, 16, v75
    v_and_b32 v183, 0xffff0000, v75
    s_waitcnt vmcnt(12)
    v_lshlrev_b32 v184, 16, v76
    v_and_b32 v185, 0xffff0000, v76
    v_lshlrev_b32 v186, 16, v77
    v_and_b32 v187, 0xffff0000, v77
    v_lshlrev_b32 v188, 16, v78
    v_and_b32 v189, 0xffff0000, v78
    v_lshlrev_b32 v190, 16, v79
    v_and_b32 v191, 0xffff0000, v79
    s_waitcnt vmcnt(11)
    v_lshlrev_b32 v192, 16, v80
    v_and_b32 v193, 0xffff0000, v80
    v_lshlrev_b32 v194, 16, v81
    v_and_b32 v195, 0xffff0000, v81
    v_lshlrev_b32 v196, 16, v82
    v_and_b32 v197, 0xffff0000, v82
    v_lshlrev_b32 v198, 16, v83
    v_and_b32 v199, 0xffff0000, v83
    s_waitcnt vmcnt(10)
    v_lshlrev_b32 v200, 16, v84
    v_and_b32 v201, 0xffff0000, v84
    v_lshlrev_b32 v202, 16, v85
    v_and_b32 v203, 0xffff0000, v85
    v_lshlrev_b32 v204, 16, v86
    v_and_b32 v205, 0xffff0000, v86
    v_lshlrev_b32 v206, 16, v87
    v_and_b32 v207, 0xffff0000, v87
    s_waitcnt vmcnt(9)
    v_lshlrev_b32 v208, 16, v88
    v_and_b32 v209, 0xffff0000, v88
    v_lshlrev_b32 v210, 16, v89
    v_and_b32 v211, 0xffff0000, v89
    s_waitcnt vmcnt(8)
    v_lshlrev_b32 v212, 16, v90
    v_and_b32 v213, 0xffff0000, v90
    v_lshlrev_b32 v214, 16, v91
    v_and_b32 v215, 0xffff0000, v91
    s_waitcnt vmcnt(7)
    v_lshlrev_b32 v216, 16, v92
    v_and_b32 v217, 0xffff0000, v92
    v_lshlrev_b32 v218, 16, v93
    v_and_b32 v219, 0xffff0000, v93
    s_waitcnt vmcnt(6)
    v_lshlrev_b32 v220, 16, v94
    v_and_b32 v221, 0xffff0000, v94
    v_lshlrev_b32 v222, 16, v95
    v_and_b32 v223, 0xffff0000, v95
    s_waitcnt vmcnt(5)
    v_lshlrev_b32 v224, 16, v96
    v_and_b32 v225, 0xffff0000, v96
    v_lshlrev_b32 v226, 16, v97
    v_and_b32 v227, 0xffff0000, v97
    s_waitcnt vmcnt(4)
    v_lshlrev_b32 v228, 16, v98
    v_and_b32 v229, 0xffff0000, v98
    v_lshlrev_b32 v230, 16, v99
    v_and_b32 v231, 0xffff0000, v99
    s_waitcnt vmcnt(3)
    v_lshlrev_b32 v232, 16, v100
    v_and_b32 v233, 0xffff0000, v100
    v_lshlrev_b32 v234, 16, v101
    v_and_b32 v235, 0xffff0000, v101
    v_lshlrev_b32 v236, 16, v102
    v_and_b32 v237, 0xffff0000, v102
    v_lshlrev_b32 v238, 16, v103
    v_and_b32 v239, 0xffff0000, v103
    s_waitcnt vmcnt(2)
    v_lshlrev_b32 v240, 16, v104
    v_and_b32 v241, 0xffff0000, v104
    v_lshlrev_b32 v242, 16, v105
    v_and_b32 v243, 0xffff0000, v105
    v_lshlrev_b32 v244, 16, v106
    v_and_b32 v245, 0xffff0000, v106
    v_lshlrev_b32 v246, 16, v107
    v_and_b32 v247, 0xffff0000, v107
    s_waitcnt vmcnt(1)
    v_lshlrev_b32 v248, 16, v108
    v_and_b32 v249, 0xffff0000, v108
    v_lshlrev_b32 v250, 16, v109
    v_and_b32 v251, 0xffff0000, v109
    v_lshlrev_b32 v252, 16, v110
    v_and_b32 v253, 0xffff0000, v110
    v_lshlrev_b32 v254, 16, v111
    v_and_b32 v255, 0xffff0000, v111
    s_mov_b32 s48, 16384
Ltail_pollp:
    buffer_load_dword v14, v15, s[24:27], s39 offen sc1
    s_sub_u32 s48, s48, 1
    s_cbranch_scc1 Ltail_gotp
    s_waitcnt vmcnt(0) lgkmcnt(0)
    v_cmp_ne_u32 s[36:37], 0, v14
    s_cmp_lg_u64 s[36:37], 0
    s_cbranch_scc1 Ltail_pollp
Ltail_gotp:
    buffer_load_dwordx4 a[0:3], v2, s[28:31], s44 offen offset:0 sc1
    buffer_load_dwordx4 a[4:7], v2, s[28:31], s44 offen offset:768 sc1
    buffer_load_dwordx4 a[8:11], v2, s[28:31], s44 offen offset:1536 sc1
    s_add_u32 s44, s44, 2304
    buffer_load_dwordx4 a[12:15], v2, s[28:31], s44 offen offset:0 sc1
    buffer_load_dwordx4 a[16:19], v2, s[28:31], s44 offen offset:768 sc1
    buffer_load_dwordx4 a[20:23], v2, s[28:31], s44 offen offset:1536 sc1
    s_add_u32 s44, s44, 2304
    buffer_load_dwordx4 a[24:27], v2, s[28:31], s44 offen offset:0 sc1
    buffer_load_dwordx4 a[28:31], v2, s[28:31], s44 offen offset:768 sc1
    buffer_load_dwordx4 a[32:35], v2, s[28:31], s44 offen offset:1536 sc1
    s_add_u32 s44, s44, 2304
    buffer_load_dwordx4 a[36:39], v2, s[28:31], s44 offen offset:0 sc1
    buffer_load_dwordx4 a[40:43], v2, s[28:31], s44 offen offset:768 sc1
    buffer_load_dwordx4 a[44:47], v2, s[28:31], s44 offen offset:1536 sc1
    s_add_u32 s44, s44, 2304
    buffer_load_dwordx4 a[48:51], v2, s[28:31], s44 offen offset:0 sc1
    buffer_load_dwordx4 a[52:55], v2, s[28:31], s44 offen offset:768 sc1
    buffer_load_dwordx4 a[56:59], v2, s[28:31], s44 offen offset:1536 sc1
    s_add_u32 s44, s44, 2304
    buffer_load_dwordx4 a[60:63], v2, s[28:31], s44 offen offset:0 sc1
    buffer_load_dwordx4 a[64:67], v2, s[28:31], s44 offen offset:768 sc1
    buffer_load_dwordx4 a[68:71], v2, s[28:31], s44 offen offset:1536 sc1
    s_add_u32 s44, s44, 2304
    buffer_load_dwordx4 a[72:75], v2, s[28:31], s44 offen offset:0 sc1
    buffer_load_dwordx4 a[76:79], v2, s[28:31], s44 offen offset:768 sc1
    buffer_load_dwordx4 a[80:83], v2, s[28:31], s44 offen offset:1536 sc1
    s_add_u32 s44, s44, 2304
    buffer_load_dwordx4 a[84:87], v2, s[28:31], s44 offen offset:0 sc1
    buffer_load_dwordx4 a[88:91], v2, s[28:31], s44 offen offset:768 sc1
    buffer_load_dwordx4 a[92:95], v2, s[28:31], s44 offen offset:1536 sc1
    s_add_u32 s44, s44, 2304
    buffer_load_dwordx4 a[96:99], v2, s[28:31], s44 offen offset:0 sc1
    buffer_load_dwordx4 a[100:103], v2, s[28:31], s44 offen offset:768 sc1
    buffer_load_dwordx4 a[104:107], v2, s[28:31], s44 offen offset:1536 sc1
    s_add_u32 s44, s44, 2304
    buffer_load_dwordx4 a[108:111], v2, s[28:31], s44 offen offset:0 sc1
    buffer_load_dwordx4 a[112:115], v2, s[28:31], s44 offen offset:768 sc1
    buffer_load_dwordx4 a[116:119], v2, s[28:31], s44 offen offset:1536 sc1
    s_add_u32 s44, s44, 2304
    buffer_load_dwordx4 a[120:123], v2, s[28:31], s44 offen offset:0 sc1
    buffer_load_dwordx4 a[124:127], v2, s[28:31], s44 offen offset:768 sc1
    buffer_load_dwordx4 a[128:131], v2, s[28:31], s44 offen offset:1536 sc1
    s_add_u32 s44, s44, 2304
    buffer_load_dwordx4 a[132:135], v2, s[28:31], s44 offen offset:0 sc1
    buffer_load_dwordx4 a[136:139], v2, s[28:31], s44 offen offset:768 sc1
    buffer_load_dwordx4 a[140:143], v2, s[28:31], s44 offen offset:1536 sc1
    s_add_u32 s44, s44, 2304
    buffer_load_dwordx4 a[144:147], v2, s[28:31], s44 offen offset:0 sc1
    buffer_load_dwordx4 a[148:151], v2, s[28:31], s44 offen offset:768 sc1
    buffer_load_dwordx4 a[152:155], v2, s[28:31], s44 offen offset:1536 sc1
    s_add_u32 s44, s44, 2304
    buffer_load_dwordx4 a[156:159], v2, s[28:31], s44 offen offset:0 sc1
    buffer_load_dwordx4 a[160:163], v2, s[28:31], s44 offen offset:768 sc1
    buffer_load_dwordx4 a[164:167], v2, s[28:31], s44 offen offset:1536 sc1
    s_add_u32 s44, s44, 2304
    buffer_load_dwordx4 a[168:171], v2, s[28:31], s44 offen offset:0 sc1
    buffer_load_dwordx4 a[172:175], v2, s[28:31], s44 offen offset:768 sc1
    buffer_load_dwordx4 a[176:179], v2, s[28:31], s44 offen offset:1536 sc1
    s_add_u32 s44, s44, 2304
    buffer_load_dwordx4 a[180:183], v2, s[28:31], s44 offen offset:0 sc1
    buffer_load_dwordx4 a[184:187], v2, s[28:31], s44 offen offset:768 sc1
    buffer_load_dwordx4 a[188:191], v2, s[28:31], s44 offen offset:1536 sc1
    s_waitcnt vmcnt(47)
    v_mfma_f32_16x16x32_bf16 v[8:11], v[34:37], a[0:3], 0
    v_mfma_f32_16x16x32_bf16 v[12:15], v[32:35], a[0:3], 0
    s_waitcnt vmcnt(46)
    v_mfma_f32_16x16x32_bf16 v[16:19], v[34:37], a[4:7], 0
    v_mfma_f32_16x16x32_bf16 v[20:23], v[32:35], a[4:7], 0
    s_waitcnt vmcnt(45)
    v_mfma_f32_16x16x32_bf16 v[24:27], v[34:37], a[8:11], 0
    v_mfma_f32_16x16x32_bf16 v[28:31], v[32:35], a[8:11], 0
    s_waitcnt vmcnt(44)
    v_mfma_f32_16x16x32_bf16 v[8:11], v[34:37], a[12:15], v[8:11]
    v_mfma_f32_16x16x32_bf16 v[12:15], v[32:35], a[12:15], v[12:15]
    s_waitcnt vmcnt(43)
    v_mfma_f32_16x16x32_bf16 v[16:19], v[34:37], a[16:19], v[16:19]
    v_mfma_f32_16x16x32_bf16 v[20:23], v[32:35], a[16:19], v[20:23]
    s_waitcnt vmcnt(42)
    v_mfma_f32_16x16x32_bf16 v[24:27], v[34:37], a[20:23], v[24:27]
    v_mfma_f32_16x16x32_bf16 v[28:31], v[32:35], a[20:23], v[28:31]
    s_waitcnt vmcnt(41)
    v_mfma_f32_16x16x32_bf16 v[8:11], v[34:37], a[24:27], v[8:11]
    v_mfma_f32_16x16x32_bf16 v[12:15], v[32:35], a[24:27], v[12:15]
    s_waitcnt vmcnt(40)
    v_mfma_f32_16x16x32_bf16 v[16:19], v[34:37], a[28:31], v[16:19]
    v_mfma_f32_16x16x32_bf16 v[20:23], v[32:35], a[28:31], v[20:23]
    s_waitcnt vmcnt(39)
    v_mfma_f32_16x16x32_bf16 v[24:27], v[34:37], a[32:35], v[24:27]
    v_mfma_f32_16x16x32_bf16 v[28:31], v[32:35], a[32:35], v[28:31]
    s_waitcnt vmcnt(38)
    v_mfma_f32_16x16x32_bf16 v[8:11], v[34:37], a[36:39], v[8:11]
    v_mfma_f32_16x16x32_bf16 v[12:15], v[32:35], a[36:39], v[12:15]
    s_waitcnt vmcnt(37)
    v_mfma_f32_16x16x32_bf16 v[16:19], v[34:37], a[40:43], v[16:19]
    v_mfma_f32_16x16x32_bf16 v[20:23], v[32:35], a[40:43], v[20:23]
    s_waitcnt vmcnt(36)
    v_mfma_f32_16x16x32_bf16 v[24:27], v[34:37], a[44:47], v[24:27]
    v_mfma_f32_16x16x32_bf16 v[28:31], v[32:35], a[44:47], v[28:31]
    s_waitcnt vmcnt(35)
    v_mfma_f32_16x16x32_bf16 v[8:11], v[34:37], a[48:51], v[8:11]
    v_mfma_f32_16x16x32_bf16 v[12:15], v[32:35], a[48:51], v[12:15]
    s_waitcnt vmcnt(34)
    v_mfma_f32_16x16x32_bf16 v[16:19], v[34:37], a[52:55], v[16:19]
    v_mfma_f32_16x16x32_bf16 v[20:23], v[32:35], a[52:55], v[20:23]
    s_waitcnt vmcnt(33)
    v_mfma_f32_16x16x32_bf16 v[24:27], v[34:37], a[56:59], v[24:27]
    v_mfma_f32_16x16x32_bf16 v[28:31], v[32:35], a[56:59], v[28:31]
    s_waitcnt vmcnt(32)
    v_mfma_f32_16x16x32_bf16 v[8:11], v[34:37], a[60:63], v[8:11]
    v_mfma_f32_16x16x32_bf16 v[12:15], v[32:35], a[60:63], v[12:15]
    s_waitcnt vmcnt(31)
    v_mfma_f32_16x16x32_bf16 v[16:19], v[34:37], a[64:67], v[16:19]
    v_mfma_f32_16x16x32_bf16 v[20:23], v[32:35], a[64:67], v[20:23]
    s_waitcnt vmcnt(30)
    v_mfma_f32_16x16x32_bf16 v[24:27], v[34:37], a[68:71], v[24:27]
    v_mfma_f32_16x16x32_bf16 v[28:31], v[32:35], a[68:71], v[28:31]
    s_waitcnt vmcnt(29)
    v_mfma_f32_16x16x32_bf16 v[8:11], v[34:37], a[72:75], v[8:11]
    v_mfma_f32_16x16x32_bf16 v[12:15], v[32:35], a[72:75], v[12:15]
    s_waitcnt vmcnt(28)
    v_mfma_f32_16x16x32_bf16 v[16:19], v[34:37], a[76:79], v[16:19]
    v_mfma_f32_16x16x32_bf16 v[20:23], v[32:35], a[76:79], v[20:23]
    s_waitcnt vmcnt(27)
    v_mfma_f32_16x16x32_bf16 v[24:27], v[34:37], a[80:83], v[24:27]
    v_mfma_f32_16x16x32_bf16 v[28:31], v[32:35], a[80:83], v[28:31]
    s_waitcnt vmcnt(26)
    v_mfma_f32_16x16x32_bf16 v[8:11], v[34:37], a[84:87], v[8:11]
    v_mfma_f32_16x16x32_bf16 v[12:15], v[32:35], a[84:87], v[12:15]
    s_waitcnt vmcnt(25)
    v_mfma_f32_16x16x32_bf16 v[16:19], v[34:37], a[88:91], v[16:19]
    v_mfma_f32_16x16x32_bf16 v[20:23], v[32:35], a[88:91], v[20:23]
    s_waitcnt vmcnt(24)
    v_mfma_f32_16x16x32_bf16 v[24:27], v[34:37], a[92:95], v[24:27]
    v_mfma_f32_16x16x32_bf16 v[28:31], v[32:35], a[92:95], v[28:31]
    s_waitcnt vmcnt(23)
    v_mfma_f32_16x16x32_bf16 v[8:11], v[34:37], a[96:99], v[8:11]
    v_mfma_f32_16x16x32_bf16 v[12:15], v[32:35], a[96:99], v[12:15]
    s_waitcnt vmcnt(22)
    v_mfma_f32_16x16x32_bf16 v[16:19], v[34:37], a[100:103], v[16:19]
    v_mfma_f32_16x16x32_bf16 v[20:23], v[32:35], a[100:103], v[20:23]
    s_waitcnt vmcnt(21)
    v_mfma_f32_16x16x32_bf16 v[24:27], v[34:37], a[104:107], v[24:27]
    v_mfma_f32_16x16x32_bf16 v[28:31], v[32:35], a[104:107], v[28:31]
    s_waitcnt vmcnt(20)
    v_mfma_f32_16x16x32_bf16 v[8:11], v[34:37], a[108:111], v[8:11]
    v_mfma_f32_16x16x32_bf16 v[12:15], v[32:35], a[108:111], v[12:15]
    s_waitcnt vmcnt(19)
    v_mfma_f32_16x16x32_bf16 v[16:19], v[34:37], a[112:115], v[16:19]
    v_mfma_f32_16x16x32_bf16 v[20:23], v[32:35], a[112:115], v[20:23]
    s_waitcnt vmcnt(18)
    v_mfma_f32_16x16x32_bf16 v[24:27], v[34:37], a[116:119], v[24:27]
    v_mfma_f32_16x16x32_bf16 v[28:31], v[32:35], a[116:119], v[28:31]
    s_waitcnt vmcnt(17)
    v_mfma_f32_16x16x32_bf16 v[8:11], v[34:37], a[120:123], v[8:11]
    v_mfma_f32_16x16x32_bf16 v[12:15], v[32:35], a[120:123], v[12:15]
    s_waitcnt vmcnt(16)
    v_mfma_f32_16x16x32_bf16 v[16:19], v[34:37], a[124:127], v[16:19]
    v_mfma_f32_16x16x32_bf16 v[20:23], v[32:35], a[124:127], v[20:23]
    s_waitcnt vmcnt(15)
    v_mfma_f32_16x16x32_bf16 v[24:27], v[34:37], a[128:131], v[24:27]
    v_mfma_f32_16x16x32_bf16 v[28:31], v[32:35], a[128:131], v[28:31]
    s_waitcnt vmcnt(14)
    v_mfma_f32_16x16x32_bf16 v[8:11], v[34:37], a[132:135], v[8:11]
    v_mfma_f32_16x16x32_bf16 v[12:15], v[32:35], a[132:135], v[12:15]
    s_waitcnt vmcnt(13)
    v_mfma_f32_16x16x32_bf16 v[16:19], v[34:37], a[136:139], v[16:19]
    v_mfma_f32_16x16x32_bf16 v[20:23], v[32:35], a[136:139], v[20:23]
    s_waitcnt vmcnt(12)
    v_mfma_f32_16x16x32_bf16 v[24:27], v[34:37], a[140:143], v[24:27]
    v_mfma_f32_16x16x32_bf16 v[28:31], v[32:35], a[140:143], v[28:31]
    s_waitcnt vmcnt(11)
    v_mfma_f32_16x16x32_bf16 v[8:11], v[34:37], a[144:147], v[8:11]
    v_mfma_f32_16x16x32_bf16 v[12:15], v[32:35], a[144:147], v[12:15]
    s_waitcnt vmcnt(10)
    v_mfma_f32_16x16x32_bf16 v[16:19], v[34:37], a[148:151], v[16:19]
    v_mfma_f32_16x16x32_bf16 v[20:23], v[32:35], a[148:151], v[20:23]
    s_waitcnt vmcnt(9)
    v_mfma_f32_16x16x32_bf16 v[24:27], v[34:37], a[152:155], v[24:27]
    v_mfma_f32_16x16x32_bf16 v[28:31], v[32:35], a[152:155], v[28:31]
    s_waitcnt vmcnt(8)
    v_mfma_f32_16x16x32_bf16 v[8:11], v[34:37], a[156:159], v[8:11]
    v_mfma_f32_16x16x32_bf16 v[12:15], v[32:35], a[156:159], v[12:15]
    s_waitcnt vmcnt(7)
    v_mfma_f32_16x16x32_bf16 v[16:19], v[34:37], a[160:163], v[16:19]
    v_mfma_f32_16x16x32_bf16 v[20:23], v[32:35], a[160:163], v[20:23]
    s_waitcnt vmcnt(6)
    v_mfma_f32_16x16x32_bf16 v[24:27], v[34:37], a[164:167], v[24:27]
    v_mfma_f32_16x16x32_bf16 v[28:31], v[32:35], a[164:167], v[28:31]
    s_waitcnt vmcnt(5)
    v_mfma_f32_16x16x32_bf16 v[8:11], v[34:37], a[168:171], v[8:11]
    v_mfma_f32_16x16x32_bf16 v[12:15], v[32:35], a[168:171], v[12:15]
    s_waitcnt vmcnt(4)
    v_mfma_f32_16x16x32_bf16 v[16:19], v[34:37], a[172:175], v[16:19]
    v_mfma_f32_16x16x32_bf16 v[20:23], v[32:35], a[172:175], v[20:23]
    s_waitcnt vmcnt(3)
    v_mfma_f32_16x16x32_bf16 v[24:27], v[34:37], a[176:179], v[24:27]
    v_mfma_f32_16x16x32_bf16 v[28:31], v[32:35], a[176:179], v[28:31]
    s_waitcnt vmcnt(2)
    v_mfma_f32_16x16x32_bf16 v[8:11], v[34:37], a[180:183], v[8:11]
    v_mfma_f32_16x16x32_bf16 v[12:15], v[32:35], a[180:183], v[12:15]
    s_waitcnt vmcnt(1)
    v_mfma_f32_16x16x32_bf16 v[16:19], v[34:37], a[184:187], v[16:19]
    v_mfma_f32_16x16x32_bf16 v[20:23], v[32:35], a[184:187], v[20:23]
    s_waitcnt vmcnt(0)
    v_mfma_f32_16x16x32_bf16 v[24:27], v[34:37], a[188:191], v[24:27]
    v_mfma_f32_16x16x32_bf16 v[28:31], v[32:35], a[188:191], v[28:31]
    s_nop 0
    v_pk_fma_f32 v[112:113], v[136:137], v[8:9], v[112:113]
    v_pk_fma_f32 v[114:115], v[138:139], v[10:11], v[114:115]
    v_pk_fma_f32 v[116:117], v[140:141], v[12:13], v[116:117]
    v_pk_fma_f32 v[118:119], v[142:143], v[14:15], v[118:119]
    v_pk_fma_f32 v[120:121], v[144:145], v[16:17], v[120:121]
    v_pk_fma_f32 v[122:123], v[146:147], v[18:19], v[122:123]
    v_pk_fma_f32 v[124:125], v[148:149], v[20:21], v[124:125]
    v_pk_fma_f32 v[126:127], v[150:151], v[22:23], v[126:127]
    v_pk_fma_f32 v[128:129], v[152:153], v[24:25], v[128:129]
    v_pk_fma_f32 v[130:131], v[154:155], v[26:27], v[130:131]
    v_pk_fma_f32 v[132:133], v[156:157], v[28:29], v[132:133]
    v_pk_fma_f32 v[134:135], v[158:159], v[30:31], v[134:135]
    v_cvt_pk_bf16_f32 v64, v112, v113
    v_cvt_pk_bf16_f32 v65, v114, v115
    v_cvt_pk_bf16_f32 v66, v116, v117
    v_cvt_pk_bf16_f32 v67, v118, v119
    v_cvt_pk_bf16_f32 v68, v120, v121
    v_cvt_pk_bf16_f32 v69, v122, v123
    v_cvt_pk_bf16_f32 v70, v124, v125
    v_cvt_pk_bf16_f32 v71, v126, v127
    v_cvt_pk_bf16_f32 v72, v128, v129
    v_cvt_pk_bf16_f32 v73, v130, v131
    v_cvt_pk_bf16_f32 v74, v132, v133
    v_cvt_pk_bf16_f32 v75, v134, v135
    v_lshlrev_b32 v112, 16, v64
    v_and_b32 v113, 0xffff0000, v64
    v_lshlrev_b32 v114, 16, v65
    v_and_b32 v115, 0xffff0000, v65
    v_lshlrev_b32 v116, 16, v66
    v_and_b32 v117, 0xffff0000, v66
    v_lshlrev_b32 v118, 16, v67
    v_and_b32 v119, 0xffff0000, v67
    v_lshlrev_b32 v120, 16, v68
    v_and_b32 v121, 0xffff0000, v68
    v_lshlrev_b32 v122, 16, v69
    v_and_b32 v123, 0xffff0000, v69
    v_lshlrev_b32 v124, 16, v70
    v_and_b32 v125, 0xffff0000, v70
    v_lshlrev_b32 v126, 16, v71
    v_and_b32 v127, 0xffff0000, v71
    v_lshlrev_b32 v128, 16, v72
    v_and_b32 v129, 0xffff0000, v72
    v_lshlrev_b32 v130, 16, v73
    v_and_b32 v131, 0xffff0000, v73
    v_lshlrev_b32 v132, 16, v74
    v_and_b32 v133, 0xffff0000, v74
    v_lshlrev_b32 v134, 16, v75
    v_and_b32 v135, 0xffff0000, v75
    s_mov_b32 s45, 5242880
    buffer_store_dwordx4 v[64:67], v6, s[8:11], s45 offen offset:0 sc1
    buffer_store_dwordx4 v[68:71], v6, s[8:11], s45 offen offset:384 sc1
    buffer_store_dwordx4 v[72:75], v6, s[8:11], s45 offen offset:768 sc1
    v_pk_add_f32 v[56:57], v[112:113], v[114:115]
    v_pk_add_f32 v[58:59], v[116:117], v[118:119]
    v_pk_add_f32 v[56:57], v[56:57], v[120:121]
    v_pk_add_f32 v[58:59], v[58:59], v[122:123]
    v_pk_add_f32 v[56:57], v[56:57], v[124:125]
    v_pk_add_f32 v[58:59], v[58:59], v[126:127]
    v_pk_add_f32 v[56:57], v[56:57], v[128:129]
    v_pk_add_f32 v[58:59], v[58:59], v[130:131]
    v_pk_add_f32 v[56:57], v[56:57], v[132:133]
    v_pk_add_f32 v[58:59], v[58:59], v[134:135]
    v_pk_add_f32 v[56:57], v[56:57], v[58:59]
    v_add_f32 v56, v56, v57
    s_nop 1
    v_add_f32_dpp v56, v56, v56 row_ror:1 row_mask:0xf bank_mask:0xf
    s_nop 1
    v_add_f32_dpp v56, v56, v56 row_ror:2 row_mask:0xf bank_mask:0xf
    s_nop 1
    v_add_f32_dpp v56, v56, v56 row_ror:4 row_mask:0xf bank_mask:0xf
    s_nop 1
    v_add_f32_dpp v56, v56, v56 row_ror:8 row_mask:0xf bank_mask:0xf
    v_mov_b32 v60, v56
    s_nop 1
    v_permlane16_swap_b32 v56, v60
    s_nop 0
    v_add_f32 v56, v56, v60
    v_mul_f32 v56, 0x3ae38e39, v56
    v_pk_add_f32 v[88:89], v[112:113], v[56:57] op_sel_hi:[1,0] neg_lo:[0,1] neg_hi:[0,1]
    v_pk_add_f32 v[90:91], v[114:115], v[56:57] op_sel_hi:[1,0] neg_lo:[0,1] neg_hi:[0,1]
    v_pk_add_f32 v[92:93], v[116:117], v[56:57] op_sel_hi:[1,0] neg_lo:[0,1] neg_hi:[0,1]
    v_pk_add_f32 v[94:95], v[118:119], v[56:57] op_sel_hi:[1,0] neg_lo:[0,1] neg_hi:[0,1]
    v_pk_add_f32 v[96:97], v[120:121], v[56:57] op_sel_hi:[1,0] neg_lo:[0,1] neg_hi:[0,1]
    v_pk_add_f32 v[98:99], v[122:123], v[56:57] op_sel_hi:[1,0] neg_lo:[0,1] neg_hi:[0,1]
    v_pk_add_f32 v[100:101], v[124:125], v[56:57] op_sel_hi:[1,0] neg_lo:[0,1] neg_hi:[0,1]
    v_pk_add_f32 v[102:103], v[126:127], v[56:57] op_sel_hi:[1,0] neg_lo:[0,1] neg_hi:[0,1]
    v_pk_add_f32 v[104:105], v[128:129], v[56:57] op_sel_hi:[1,0] neg_lo:[0,1] neg_hi:[0,1]
    v_pk_add_f32 v[106:107], v[130:131], v[56:57] op_sel_hi:[1,0] neg_lo:[0,1] neg_hi:[0,1]
    v_pk_add_f32 v[108:109], v[132:133], v[56:57] op_sel_hi:[1,0] neg_lo:[0,1] neg_hi:[0,1]
    v_pk_add_f32 v[110:111], v[134:135], v[56:57] op_sel_hi:[1,0] neg_lo:[0,1] neg_hi:[0,1]
    v_pk_mul_f32 v[58:59], v[88:89], v[88:89]
    v_pk_mul_f32 v[60:61], v[90:91], v[90:91]
    v_pk_fma_f32 v[58:59], v[92:93], v[92:93], v[58:59]
    v_pk_fma_f32 v[60:61], v[94:95], v[94:95], v[60:61]
    v_pk_fma_f32 v[58:59], v[96:97], v[96:97], v[58:59]
    v_pk_fma_f32 v[60:61], v[98:99], v[98:99], v[60:61]
    v_pk_fma_f32 v[58:59], v[100:101], v[100:101], v[58:59]
    v_pk_fma_f32 v[60:61], v[102:103], v[102:103], v[60:61]
    v_pk_fma_f32 v[58:59], v[104:105], v[104:105], v[58:59]
    v_pk_fma_f32 v[60:61], v[106:107], v[106:107], v[60:61]
    v_pk_fma_f32 v[58:59], v[108:109], v[108:109], v[58:59]
    v_pk_fma_f32 v[60:61], v[110:111], v[110:111], v[60:61]
    v_pk_add_f32 v[58:59], v[58:59], v[60:61]
    v_add_f32 v58, v58, v59
    v_cndmask_b32 v58, 0, v58, vcc
    s_nop 1
    v_add_f32_dpp v58, v58, v58 row_ror:1 row_mask:0xf bank_mask:0xf
    s_nop 1
    v_add_f32_dpp v58, v58, v58 row_ror:2 row_mask:0xf bank_mask:0xf
    s_nop 1
    v_add_f32_dpp v58, v58, v58 row_ror:4 row_mask:0xf bank_mask:0xf
    s_nop 1
    v_add_f32_dpp v58, v58, v58 row_ror:8 row_mask:0xf bank_mask:0xf
    v_mov_b32 v60, v58
    s_nop 1
    v_permlane16_swap_b32 v58, v60
    s_nop 0
    v_add_f32 v58, v58, v60
    v_mul_f32 v58, 0x3ae38e39, v58
    v_cvt_pk_bf16_f32 v60, v56, v58
    v_and_b32 v58, 0xffff0000, v60
    v_lshlrev_b32 v60, 16, v60
    v_add_f32 v58, 0x3727c5ac, v58
    v_sub_f32 v56, v56, v60
    v_cvt_pk_bf16_f32 v58, v58, v58
    v_and_b32 v58, 0xffff0000, v58
    v_sqrt_f32 v58, v58
    s_nop 0
    v_cvt_pk_bf16_f32 v58, v58, v58
    v_and_b32 v58, 0xffff0000, v58
    v_rcp_f32 v58, v58
    s_nop 0
    v_mul_f32 v56, v56, v58
    v_pk_fma_f32 v[88:89], v[88:89], v[58:59], v[56:57] op_sel_hi:[1,0,0]
    v_pk_fma_f32 v[90:91], v[90:91], v[58:59], v[56:57] op_sel_hi:[1,0,0]
    v_pk_fma_f32 v[92:93], v[92:93], v[58:59], v[56:57] op_sel_hi:[1,0,0]
    v_pk_fma_f32 v[94:95], v[94:95], v[58:59], v[56:57] op_sel_hi:[1,0,0]
    v_pk_fma_f32 v[96:97], v[96:97], v[58:59], v[56:57] op_sel_hi:[1,0,0]
    v_pk_fma_f32 v[98:99], v[98:99], v[58:59], v[56:57] op_sel_hi:[1,0,0]
    v_pk_fma_f32 v[100:101], v[100:101], v[58:59], v[56:57] op_sel_hi:[1,0,0]
    v_pk_fma_f32 v[102:103], v[102:103], v[58:59], v[56:57] op_sel_hi:[1,0,0]
    v_pk_fma_f32 v[104:105], v[104:105], v[58:59], v[56:57] op_sel_hi:[1,0,0]
    v_pk_fma_f32 v[106:107], v[106:107], v[58:59], v[56:57] op_sel_hi:[1,0,0]
    v_pk_fma_f32 v[108:109], v[108:109], v[58:59], v[56:57] op_sel_hi:[1,0,0]
    v_pk_fma_f32 v[110:111], v[110:111], v[58:59], v[56:57] op_sel_hi:[1,0,0]
    v_pk_fma_f32 v[88:89], v[88:89], v[160:161], v[184:185]
    v_pk_fma_f32 v[90:91], v[90:91], v[162:163], v[186:187]
    v_pk_fma_f32 v[92:93], v[92:93], v[164:165], v[188:189]
    v_pk_fma_f32 v[94:95], v[94:95], v[166:167], v[190:191]
    v_pk_fma_f32 v[96:97], v[96:97], v[168:169], v[192:193]
    v_pk_fma_f32 v[98:99], v[98:99], v[170:171], v[194:195]
    v_pk_fma_f32 v[100:101], v[100:101], v[172:173], v[196:197]
    v_pk_fma_f32 v[102:103], v[102:103], v[174:175], v[198:199]
    v_pk_fma_f32 v[104:105], v[104:105], v[176:177], v[200:201]
    v_pk_fma_f32 v[106:107], v[106:107], v[178:179], v[202:203]
    v_pk_fma_f32 v[108:109], v[108:109], v[180:181], v[204:205]
    v_pk_fma_f32 v[110:111], v[110:111], v[182:183], v[206:207]
    v_cvt_pk_bf16_f32 v76, v88, v89
    v_cvt_pk_bf16_f32 v77, v90, v91
    v_cvt_pk_bf16_f32 v78, v92, v93
    v_cvt_pk_bf16_f32 v79, v94, v95
    v_cvt_pk_bf16_f32 v80, v96, v97
    v_cvt_pk_bf16_f32 v81, v98, v99
    v_cvt_pk_bf16_f32 v82, v100, v101
    v_cvt_pk_bf16_f32 v83, v102, v103
    v_cvt_pk_bf16_f32 v84, v104, v105
    v_cvt_pk_bf16_f32 v85, v106, v107
    v_cvt_pk_bf16_f32 v86, v108, v109
    v_cvt_pk_bf16_f32 v87, v110, v111
    s_mov_b32 s45, 2621440
    buffer_store_dwordx4 v[76:79], v6, s[8:11], s45 offen offset:0 sc1
    buffer_store_dwordx4 v[80:83], v6, s[8:11], s45 offen offset:384 sc1
    buffer_store_dwordx4 v[84:87], v6, s[8:11], s45 offen offset:768 sc1
    v_lshlrev_b32 v88, 16, v76
    v_and_b32 v89, 0xffff0000, v76
    v_lshlrev_b32 v90, 16, v77
    v_and_b32 v91, 0xffff0000, v77
    v_lshlrev_b32 v92, 16, v78
    v_and_b32 v93, 0xffff0000, v78
    v_lshlrev_b32 v94, 16, v79
    v_and_b32 v95, 0xffff0000, v79
    v_lshlrev_b32 v96, 16, v80
    v_and_b32 v97, 0xffff0000, v80
    v_lshlrev_b32 v98, 16, v81
    v_and_b32 v99, 0xffff0000, v81
    v_lshlrev_b32 v100, 16, v82
    v_and_b32 v101, 0xffff0000, v82
    v_lshlrev_b32 v102, 16, v83
    v_and_b32 v103, 0xffff0000, v83
    v_lshlrev_b32 v104, 16, v84
    v_and_b32 v105, 0xffff0000, v84
    v_lshlrev_b32 v106, 16, v85
    v_and_b32 v107, 0xffff0000, v85
    v_lshlrev_b32 v108, 16, v86
    v_and_b32 v109, 0xffff0000, v86
    v_lshlrev_b32 v110, 16, v87
    v_and_b32 v111, 0xffff0000, v87
    v_pk_mul_f32 v[58:59], v[88:89], v[208:209]
    v_pk_mul_f32 v[60:61], v[90:91], v[210:211]
    v_pk_fma_f32 v[58:59], v[92:93], v[212:213], v[58:59]
    v_pk_fma_f32 v[60:61], v[94:95], v[214:215], v[60:61]
    v_pk_fma_f32 v[58:59], v[96:97], v[216:217], v[58:59]
    v_pk_fma_f32 v[60:61], v[98:99], v[218:219], v[60:61]
    v_pk_fma_f32 v[58:59], v[100:101], v[220:221], v[58:59]
    v_pk_fma_f32 v[60:61], v[102:103], v[222:223], v[60:61]
    v_pk_fma_f32 v[58:59], v[104:105], v[224:225], v[58:59]
    v_pk_fma_f32 v[60:61], v[106:107], v[226:227], v[60:61]
    v_pk_fma_f32 v[58:59], v[108:109], v[228:229], v[58:59]
    v_pk_fma_f32 v[60:61], v[110:111], v[230:231], v[60:61]
    v_pk_add_f32 v[58:59], v[58:59], v[60:61]
    v_add_f32 v58, v58, v59
    s_nop 1
    v_add_f32_dpp v58, v58, v58 row_ror:1 row_mask:0xf bank_mask:0xf
    s_nop 1
    v_add_f32_dpp v58, v58, v58 row_ror:2 row_mask:0xf bank_mask:0xf
    s_nop 1
    v_add_f32_dpp v58, v58, v58 row_ror:4 row_mask:0xf bank_mask:0xf
    s_nop 1
    v_add_f32_dpp v58, v58, v58 row_ror:8 row_mask:0xf bank_mask:0xf
    v_mov_b32 v60, v58
    s_nop 1
    v_permlane16_swap_b32 v58, v60
    s_nop 0
    v_add_f32 v58, v58, v60
    v_lshlrev_b32 v56, 2, v7
    s_mov_b32 exec_lo, 1
    s_mov_b32 exec_hi, 1
    s_mov_b32 s45, 32768
    buffer_store_dword v58, v56, s[8:11], s45 offen sc1
    v_ashrrev_i32 v60, 31, v58
    v_or_b32 v60, 0x80000000, v60
    v_xor_b32 v60, v60, v58
    v_and_b32 v60, 0xfffff800, v60
    v_min_u32 v60, 0xfffff000, v60
    v_sub_u32 v61, 2047, v7
    v_or_b32 v60, v60, v61
    v_and_b32 v61, 28, v56
    v_add_u32 v61, 53248, v61
    ds_write_b32 v61, v60
    s_mov_b64 exec, -1
    v_pk_mul_f32 v[232:233], v[232:233], v[88:89]
    v_pk_mul_f32 v[234:235], v[234:235], v[90:91]
    v_pk_mul_f32 v[236:237], v[236:237], v[92:93]
    v_pk_mul_f32 v[238:239], v[238:239], v[94:95]
    v_pk_mul_f32 v[240:241], v[240:241], v[96:97]
    v_pk_mul_f32 v[242:243], v[242:243], v[98:99]
    v_pk_mul_f32 v[244:245], v[244:245], v[100:101]
    v_pk_mul_f32 v[246:247], v[246:247], v[102:103]
    v_pk_mul_f32 v[248:249], v[248:249], v[104:105]
    v_pk_mul_f32 v[250:251], v[250:251], v[106:107]
    v_pk_mul_f32 v[252:253], v[252:253], v[108:109]
    v_pk_mul_f32 v[254:255], v[254:255], v[110:111]
    v_cvt_pk_bf16_f32 v40, v232, v233
    v_cvt_pk_bf16_f32 v41, v234, v235
    v_cvt_pk_bf16_f32 v42, v236, v237
    v_cvt_pk_bf16_f32 v43, v238, v239
    v_cvt_pk_bf16_f32 v44, v240, v241
    v_cvt_pk_bf16_f32 v45, v242, v243
    v_cvt_pk_bf16_f32 v46, v244, v245
    v_cvt_pk_bf16_f32 v47, v246, v247
    v_cvt_pk_bf16_f32 v48, v248, v249
    v_cvt_pk_bf16_f32 v49, v250, v251
    v_cvt_pk_bf16_f32 v50, v252, v253
    v_cvt_pk_bf16_f32 v51, v254, v255
    v_lshlrev_b32 v232, 16, v40
    v_and_b32 v233, 0xffff0000, v40
    v_lshlrev_b32 v234, 16, v41
    v_and_b32 v235, 0xffff0000, v41
    v_lshlrev_b32 v236, 16, v42
    v_and_b32 v237, 0xffff0000, v42
    v_lshlrev_b32 v238, 16, v43
    v_and_b32 v239, 0xffff0000, v43
    v_lshlrev_b32 v240, 16, v44
    v_and_b32 v241, 0xffff0000, v44
    v_lshlrev_b32 v242, 16, v45
    v_and_b32 v243, 0xffff0000, v45
    v_lshlrev_b32 v244, 16, v46
    v_and_b32 v245, 0xffff0000, v46
    v_lshlrev_b32 v246, 16, v47
    v_and_b32 v247, 0xffff0000, v47
    v_lshlrev_b32 v248, 16, v48
    v_and_b32 v249, 0xffff0000, v48
    v_lshlrev_b32 v250, 16, v49
    v_and_b32 v251, 0xffff0000, v49
    v_lshlrev_b32 v252, 16, v50
    v_and_b32 v253, 0xffff0000, v50
    v_lshlrev_b32 v254, 16, v51
    v_and_b32 v255, 0xffff0000, v51
    v_pk_add_f32 v[232:233], v[232:233], v[112:113]
    v_pk_add_f32 v[234:235], v[234:235], v[114:115]
    v_pk_add_f32 v[236:237], v[236:237], v[116:117]
    v_pk_add_f32 v[238:239], v[238:239], v[118:119]
    v_pk_add_f32 v[240:241], v[240:241], v[120:121]
    v_pk_add_f32 v[242:243], v[242:243], v[122:123]
    v_pk_add_f32 v[244:245], v[244:245], v[124:125]
    v_pk_add_f32 v[246:247], v[246:247], v[126:127]
    v_pk_add_f32 v[248:249], v[248:249], v[128:129]
    v_pk_add_f32 v[250:251], v[250:251], v[130:131]
    v_pk_add_f32 v[252:253], v[252:253], v[132:133]
    v_pk_add_f32 v[254:255], v[254:255], v[134:135]
    v_cvt_pk_bf16_f32 v40, v232, v233
    v_cvt_pk_bf16_f32 v41, v234, v235
    v_cvt_pk_bf16_f32 v42, v236, v237
    v_cvt_pk_bf16_f32 v43, v238, v239
    v_cvt_pk_bf16_f32 v44, v240, v241
    v_cvt_pk_bf16_f32 v45, v242, v243
    v_cvt_pk_bf16_f32 v46, v244, v245
    v_cvt_pk_bf16_f32 v47, v246, v247
    v_cvt_pk_bf16_f32 v48, v248, v249
    v_cvt_pk_bf16_f32 v49, v250, v251
    v_cvt_pk_bf16_f32 v50, v252, v253
    v_cvt_pk_bf16_f32 v51, v254, v255
    s_waitcnt vmcnt(0) lgkmcnt(0)
    s_barrier
    s_cmp_lg_u32 s3, 0
    s_cbranch_scc1 Ltail_notw0
    v_mov_b32 v20, 53248
    ds_read_b128 v[24:27], v20
    ds_read_b128 v[28:31], v20 offset:16
    s_lshl_b32 s45, s40, 3
    s_add_u32 s45, s45, 7860224
    v_mov_b32 v21, 0
    s_waitcnt lgkmcnt(1)
    v_max_u32 v16, v24, v25
    v_min_u32 v17, v24, v25
    v_med3_u32 v17, v16, v17, v26
    v_max_u32 v16, v16, v26
    v_med3_u32 v17, v16, v17, v27
    v_max_u32 v16, v16, v27
    s_waitcnt lgkmcnt(0)
    v_med3_u32 v17, v16, v17, v28
    v_max_u32 v16, v16, v28
    v_med3_u32 v17, v16, v17, v29
    v_max_u32 v16, v16, v29
    v_med3_u32 v17, v16, v17, v30
    v_max_u32 v16, v16, v30
    v_med3_u32 v17, v16, v17, v31
    v_max_u32 v16, v16, v31
    s_mov_b64 exec, 1
    buffer_store_dwordx2 v[16:17], v21, s[8:11], s45 offen sc1
    s_mov_b64 exec, -1
Ltail_notw0:
    s_mov_b32 s38, 135168
    s_mov_b32 s39, 8192
    v_lshrrev_b32 v9, 2, v1
    v_and_b32 v10, 3, v1
    v_lshlrev_b32 v10, 3, v10
    s_and_b32 s45, s3, 1
    s_lshl_b32 s45, s45, 5
    v_lshl_add_u32 v11, v9, 6, v10
    v_add_u32 v11, s45, v11
    s_cmp_lt_u32 s3, 2
    s_cselect_b32 s44, 98304, s38
    s_cselect_b32 s45, 98304, s39
    v_add_u32 v12, s45, v11
    v_add_u32 v11, s44, v11
    ds_read_b64_tr_b16 a[0:1], v11 offset:0
    ds_read_b64_tr_b16 a[2:3], v11 offset:1024
    ds_read_b64_tr_b16 a[4:5], v11 offset:2048
    ds_read_b64_tr_b16 a[6:7], v11 offset:3072
    ds_read_b64_tr_b16 a[8:9], v11 offset:4096
    ds_read_b64_tr_b16 a[10:11], v11 offset:5120
    ds_read_b64_tr_b16 a[12:13], v11 offset:6144
    ds_read_b64_tr_b16 a[14:15], v11 offset:7168
    ds_read_b64_tr_b16 a[16:17], v11 offset:8192
    ds_read_b64_tr_b16 a[18:19], v11 offset:9216
    ds_read_b64_tr_b16 a[20:21], v11 offset:10240
    ds_read_b64_tr_b16 a[22:23], v11 offset:11264
    ds_read_b64_tr_b16 a[24:25], v11 offset:12288
    ds_read_b64_tr_b16 a[26:27], v11 offset:13312
    ds_read_b64_tr_b16 a[28:29], v11 offset:14336
    ds_read_b64_tr_b16 a[30:31], v11 offset:15360
    ds_read_b64_tr_b16 a[32:33], v11 offset:16384
    ds_read_b64_tr_b16 a[34:35], v11 offset:17408
    ds_read_b64_tr_b16 a[36:37], v11 offset:18432
    ds_read_b64_tr_b16 a[38:39], v11 offset:19456
    ds_read_b64_tr_b16 a[40:41], v11 offset:20480
    ds_read_b64_tr_b16 a[42:43], v11 offset:21504
    ds_read_b64_tr_b16 a[44:45], v11 offset:22528
    ds_read_b64_tr_b16 a[46:47], v11 offset:23552
    ds_read_b64_tr_b16 a[48:49], v11 offset:24576
    ds_read_b64_tr_b16 a[50:51], v11 offset:25600
    ds_read_b64_tr_b16 a[52:53], v11 offset:26624
    ds_read_b64_tr_b16 a[54:55], v11 offset:27648
    ds_read_b64_tr_b16 a[56:57], v12 offset:28672
    ds_read_b64_tr_b16 a[58:59], v12 offset:29696
    ds_read_b64_tr_b16 a[60:61], v12 offset:30720
    ds_read_b64_tr_b16 a[62:63], v12 offset:31744
    ds_read_b64_tr_b16 a[64:65], v12 offset:32768
    ds_read_b64_tr_b16 a[66:67], v12 offset:33792
    ds_read_b64_tr_b16 a[68:69], v12 offset:34816
    ds_read_b64_tr_b16 a[70:71], v12 offset:35840
    v_mul_u32_u24 v12, 1152, v9
    s_lshl_b32 s44, s3, 7
    s_add_u32 s44, s44, 0
    v_add3_u32 v12, v12, v10, s44
    ds_read_b64_tr_b16 a[72:73], v12 offset:0
    ds_read_b64_tr_b16 a[74:75], v12 offset:18432
    ds_read_b64_tr_b16 a[76:77], v12 offset:32
    ds_read_b64_tr_b16 a[78:79], v12 offset:18464
    ds_read_b64_tr_b16 a[80:81], v12 offset:64
    ds_read_b64_tr_b16 a[82:83], v12 offset:18496
    ds_read_b64_tr_b16 a[84:85], v12 offset:96
    ds_read_b64_tr_b16 a[86:87], v12 offset:18528
    ds_read_b64_tr_b16 a[88:89], v12 offset:512
    ds_read_b64_tr_b16 a[90:91], v12 offset:18944
    ds_read_b64_tr_b16 a[92:93], v12 offset:544
    ds_read_b64_tr_b16 a[94:95], v12 offset:18976
    ds_read_b64_tr_b16 a[96:97], v12 offset:576
    ds_read_b64_tr_b16 a[98:99], v12 offset:19008
    ds_read_b64_tr_b16 a[100:101], v12 offset:608
    ds_read_b64_tr_b16 a[102:103], v12 offset:19040
    ds_read_b64_tr_b16 a[104:105], v12 offset:1024
    ds_read_b64_tr_b16 a[106:107], v12 offset:19456
    ds_read_b64_tr_b16 a[108:109], v12 offset:1056
    ds_read_b64_tr_b16 a[110:111], v12 offset:19488
    ds_read_b64_tr_b16 a[112:113], v12 offset:1088
    ds_read_b64_tr_b16 a[114:115], v12 offset:19520
    ds_read_b64_tr_b16 a[116:117], v12 offset:1120
    ds_read_b64_tr_b16 a[118:119], v12 offset:19552
    v_lshlrev_b32 v13, 4, v1
    v_add_u32 v13, 49152, v13
    s_lshl_b32 s44, s3, 10
    v_add_u32 v14, s44, v13
    v_bfe_u32 v15, v1, 2, 2
    v_cmp_eq_u32 s[52:53], 0, v15
    v_cmp_eq_u32 s[54:55], 1, v15
    v_cmp_eq_u32 s[56:57], 2, v15
    v_cmp_eq_u32 s[58:59], 3, v15
    s_mul_i32 s43, s42, 18
    s_add_u32 s43, s43, s41
    s_lshl_b32 s43, s43, 9
    s_mul_i32 s44, s3, 73728
    s_add_u32 s43, s43, s44
    v_lshlrev_b32 v15, 3, v1
    s_cmp_lg_u32 s3, 0
    s_cbranch_scc1 Ltail_join
    v_lshlrev_b32 v22, 4, v1
    v_mov_b32 v20, 53248
    s_mov_b32 s45, 7860224
    s_mov_b32 s48, 16384
Ltail_pollk:
    buffer_load_dwordx4 v[24:27], v22, s[8:11], s45 offen sc1
    buffer_load_dwordx4 v[28:31], v22, s[8:11], s45 offen offset:1024 sc1
    s_sub_u32 s48, s48, 1
    s_cbranch_scc1 Ltail_gotk
    s_waitcnt vmcnt(0) lgkmcnt(0)
    v_max_u32 v16, v24, v25
    v_min_u32 v17, v24, v25
    v_med3_u32 v17, v16, v17, v26
    v_max_u32 v16, v16, v26
    v_med3_u32 v17, v16, v17, v27
    v_max_u32 v16, v16, v27
    v_med3_u32 v17, v16, v17, v28
    v_max_u32 v16, v16, v28
    v_med3_u32 v17, v16, v17, v29
    v_max_u32 v16, v16, v29
    v_med3_u32 v17, v16, v17, v30
    v_max_u32 v16, v16, v30
    v_med3_u32 v17, v16, v17, v31
    v_max_u32 v16, v16, v31
    v_cmp_eq_u32 vcc, -1, v16
    s_cbranch_vccnz Ltail_pollk
Ltail_gotk:
    s_waitcnt vmcnt(0) lgkmcnt(0)
    v_mov_b32_dpp v18, v16 row_ror:1 row_mask:0xf bank_mask:0xf
    v_mov_b32_dpp v19, v17 row_ror:1 row_mask:0xf bank_mask:0xf
    v_min_u32 v23, v16, v18
    v_max_u32 v16, v16, v18
    v_max3_u32 v17, v23, v17, v19
    s_nop 0
    v_mov_b32_dpp v18, v16 row_ror:2 row_mask:0xf bank_mask:0xf
    v_mov_b32_dpp v19, v17 row_ror:2 row_mask:0xf bank_mask:0xf
    v_min_u32 v23, v16, v18
    v_max_u32 v16, v16, v18
    v_max3_u32 v17, v23, v17, v19
    s_nop 0
    v_mov_b32_dpp v18, v16 row_ror:4 row_mask:0xf bank_mask:0xf
    v_mov_b32_dpp v19, v17 row_ror:4 row_mask:0xf bank_mask:0xf
    v_min_u32 v23, v16, v18
    v_max_u32 v16, v16, v18
    v_max3_u32 v17, v23, v17, v19
    s_nop 0
    v_mov_b32_dpp v18, v16 row_ror:8 row_mask:0xf bank_mask:0xf
    v_mov_b32_dpp v19, v17 row_ror:8 row_mask:0xf bank_mask:0xf
    v_min_u32 v23, v16, v18
    v_max_u32 v16, v16, v18
    v_max3_u32 v17, v23, v17, v19
    v_mov_b32 v18, v16
    v_mov_b32 v19, v17
    s_nop 0
    v_permlane16_swap_b32 v16, v18
    v_permlane16_swap_b32 v17, v19
    v_min_u32 v23, v16, v18
    v_max_u32 v16, v16, v18
    v_max3_u32 v17, v23, v17, v19
    v_mov_b32 v18, v16
    v_mov_b32 v19, v17
    s_nop 0
    v_permlane32_swap_b32 v16, v18
    v_permlane32_swap_b32 v17, v19
    v_min_u32 v23, v16, v18
    v_max_u32 v16, v16, v18
    v_max3_u32 v17, v23, v17, v19
    v_and_b32 v16, 0x7ff, v16
    v_and_b32 v17, 0x7ff, v17
    v_sub_u32 v16, 2047, v16
    v_sub_u32 v17, 2047, v17
    ds_write_b64 v20, v[16:17] offset:64
Ltail_join:
    s_waitcnt vmcnt(0) lgkmcnt(0)
    s_barrier
    v_mov_b32 v8, 53312
    ds_read_b64 v[8:9], v8
    s_waitcnt lgkmcnt(0)
    v_readfirstlane_b32 s46, v8
    v_readfirstlane_b32 s47, v9
    s_cmp_ge_u32 s41, 18
    s_cbranch_scc1 Ltail_noffn
    s_mul_i32 s44, s46, 1152
    s_mul_i32 s45, s47, 1152
    s_sub_u32 s45, s45, s44
    v_and_b32 v8, 1, v1
    v_mul_lo_u32 v8, v8, s45
    v_and_b32 v9, 48, v1
    v_add3_u32 v8, v8, v9, s44
    s_mov_b32 s45, 2621440
    buffer_load_dwordx4 a[128:131], v8, s[8:11], s45 offen offset:0 sc1
    buffer_load_dwordx4 a[132:135], v8, s[8:11], s45 offen offset:64 sc1
    buffer_load_dwordx4 a[136:139], v8, s[8:11], s45 offen offset:128 sc1
    buffer_load_dwordx4 a[140:143], v8, s[8:11], s45 offen offset:192 sc1
    buffer_load_dwordx4 a[144:147], v8, s[8:11], s45 offen offset:256 sc1
    buffer_load_dwordx4 a[148:151], v8, s[8:11], s45 offen offset:320 sc1
    buffer_load_dwordx4 a[152:155], v8, s[8:11], s45 offen offset:384 sc1
    buffer_load_dwordx4 a[156:159], v8, s[8:11], s45 offen offset:448 sc1
    buffer_load_dwordx4 a[160:163], v8, s[8:11], s45 offen offset:512 sc1
    buffer_load_dwordx4 a[164:167], v8, s[8:11], s45 offen offset:576 sc1
    buffer_load_dwordx4 a[168:171], v8, s[8:11], s45 offen offset:640 sc1
    buffer_load_dwordx4 a[172:175], v8, s[8:11], s45 offen offset:704 sc1
    buffer_load_dwordx4 a[176:179], v8, s[8:11], s45 offen offset:768 sc1
    buffer_load_dwordx4 a[180:183], v8, s[8:11], s45 offen offset:832 sc1
    buffer_load_dwordx4 a[184:187], v8, s[8:11], s45 offen offset:896 sc1
    buffer_load_dwordx4 a[188:191], v8, s[8:11], s45 offen offset:960 sc1
    buffer_load_dwordx4 a[192:195], v8, s[8:11], s45 offen offset:1024 sc1
    buffer_load_dwordx4 a[196:199], v8, s[8:11], s45 offen offset:1088 sc1
    v_cmp_ne_u32 vcc, s46, v7
    v_cmp_ne_u32 s[36:37], s47, v7
    v_mov_b32 v31, 2147483648
    s_and_b64 vcc, vcc, s[36:37]
    s_nop 1
    v_cndmask_b32 v31, v31, v4, vcc
    buffer_store_dwordx2 v[40:41], v31, s[16:19], 0 offen offset:0
    buffer_store_dwordx2 v[42:43], v31, s[16:19], 0 offen offset:32
    buffer_store_dwordx2 v[44:45], v31, s[16:19], 0 offen offset:384
    buffer_store_dwordx2 v[46:47], v31, s[16:19], 0 offen offset:416
    buffer_store_dwordx2 v[48:49], v31, s[16:19], 0 offen offset:768
    buffer_store_dwordx2 v[50:51], v31, s[16:19], 0 offen offset:800
    s_waitcnt lgkmcnt(0)
    s_waitcnt vmcnt(23)
    v_mfma_f32_16x16x32_bf16 v[16:19], a[0:3], a[128:131], 0
    s_waitcnt vmcnt(22)
    v_mfma_f32_16x16x32_bf16 v[20:23], a[4:7], a[132:135], 0
    s_waitcnt vmcnt(21)
    v_mfma_f32_16x16x32_bf16 v[16:19], a[8:11], a[136:139], v[16:19]
    s_waitcnt vmcnt(20)
    v_mfma_f32_16x16x32_bf16 v[20:23], a[12:15], a[140:143], v[20:23]
    s_waitcnt vmcnt(19)
    v_mfma_f32_16x16x32_bf16 v[16:19], a[16:19], a[144:147], v[16:19]
    s_waitcnt vmcnt(18)
    v_mfma_f32_16x16x32_bf16 v[20:23], a[20:23], a[148:151], v[20:23]
    s_waitcnt vmcnt(17)
    v_mfma_f32_16x16x32_bf16 v[16:19], a[24:27], a[152:155], v[16:19]
    s_waitcnt vmcnt(16)
    v_mfma_f32_16x16x32_bf16 v[20:23], a[28:31], a[156:159], v[20:23]
    s_waitcnt vmcnt(15)
    v_mfma_f32_16x16x32_bf16 v[16:19], a[32:35], a[160:163], v[16:19]
    s_waitcnt vmcnt(14)
    v_mfma_f32_16x16x32_bf16 v[20:23], a[36:39], a[164:167], v[20:23]
    s_waitcnt vmcnt(13)
    v_mfma_f32_16x16x32_bf16 v[16:19], a[40:43], a[168:171], v[16:19]
    s_waitcnt vmcnt(12)
    v_mfma_f32_16x16x32_bf16 v[20:23], a[44:47], a[172:175], v[20:23]
    s_waitcnt vmcnt(11)
    v_mfma_f32_16x16x32_bf16 v[16:19], a[48:51], a[176:179], v[16:19]
    s_waitcnt vmcnt(10)
    v_mfma_f32_16x16x32_bf16 v[20:23], a[52:55], a[180:183], v[20:23]
    s_waitcnt vmcnt(9)
    v_mfma_f32_16x16x32_bf16 v[16:19], a[56:59], a[184:187], v[16:19]
    s_waitcnt vmcnt(8)
    v_mfma_f32_16x16x32_bf16 v[20:23], a[60:63], a[188:191], v[20:23]
    s_waitcnt vmcnt(7)
    v_mfma_f32_16x16x32_bf16 v[16:19], a[64:67], a[192:195], v[16:19]
    s_waitcnt vmcnt(6)
    v_mfma_f32_16x16x32_bf16 v[20:23], a[68:71], a[196:199], v[20:23]
    s_nop 7
    v_pk_add_f32 v[16:17], v[16:17], v[20:21]
    v_pk_add_f32 v[18:19], v[18:19], v[22:23]
    ds_write_b128 v14, v[16:19]
    s_waitcnt lgkmcnt(0)
    s_barrier
    ds_read_b128 v[16:19], v13 offset:0
    ds_read_b128 v[20:23], v13 offset:1024
    ds_read_b128 v[24:27], v13 offset:2048
    ds_read_b128 v[28:31], v13 offset:3072
    s_mov_b32 s36, 0xbfb8aa3b
    s_mov_b32 s37, 0xbfb8aa3b
    s_waitcnt lgkmcnt(3)
    v_cvt_pk_bf16_f32 v32, v16, v17
    v_cvt_pk_bf16_f32 v33, v18, v19
    s_waitcnt lgkmcnt(2)
    v_cvt_pk_bf16_f32 v34, v20, v21
    v_cvt_pk_bf16_f32 v35, v22, v23
    v_lshlrev_b32 v16, 16, v32
    v_and_b32 v17, 0xffff0000, v32
    v_lshlrev_b32 v18, 16, v33
    v_and_b32 v19, 0xffff0000, v33
    v_lshlrev_b32 v20, 16, v34
    v_and_b32 v21, 0xffff0000, v34
    v_lshlrev_b32 v22, 16, v35
    v_and_b32 v23, 0xffff0000, v35
    v_pk_mul_f32 v[32:33], v[16:17], s[36:37]
    v_pk_mul_f32 v[34:35], v[18:19], s[36:37]
    v_pk_mul_f32 v[36:37], v[20:21], s[36:37]
    v_pk_mul_f32 v[38:39], v[22:23], s[36:37]
    v_exp_f32 v32, v32
    v_exp_f32 v33, v33
    v_exp_f32 v34, v34
    v_exp_f32 v35, v35
    v_exp_f32 v36, v36
    v_exp_f32 v37, v37
    v_exp_f32 v38, v38
    v_exp_f32 v39, v39
    s_waitcnt lgkmcnt(1)
    v_cvt_pk_bf16_f32 v60, v24, v25
    v_cvt_pk_bf16_f32 v61, v26, v27
    s_waitcnt lgkmcnt(0)
    v_cvt_pk_bf16_f32 v62, v28, v29
    v_cvt_pk_bf16_f32 v63, v30, v31
    v_pk_add_f32 v[32:33], v[32:33], 1.0 op_sel_hi:[1,0]
    v_pk_add_f32 v[34:35], v[34:35], 1.0 op_sel_hi:[1,0]
    v_pk_add_f32 v[36:37], v[36:37], 1.0 op_sel_hi:[1,0]
    v_pk_add_f32 v[38:39], v[38:39], 1.0 op_sel_hi:[1,0]
    v_rcp_f32 v32, v32
    v_rcp_f32 v33, v33
    v_rcp_f32 v34, v34
    v_rcp_f32 v35, v35
    v_rcp_f32 v36, v36
    v_rcp_f32 v37, v37
    v_rcp_f32 v38, v38
    v_rcp_f32 v39, v39
    v_lshlrev_b32 v24, 16, v60
    v_and_b32 v25, 0xffff0000, v60
    v_lshlrev_b32 v26, 16, v61
    v_and_b32 v27, 0xffff0000, v61
    v_lshlrev_b32 v28, 16, v62
    v_and_b32 v29, 0xffff0000, v62
    v_lshlrev_b32 v30, 16, v63
    v_and_b32 v31, 0xffff0000, v63
    v_pk_mul_f32 v[16:17], v[16:17], v[32:33]
    v_pk_mul_f32 v[18:19], v[18:19], v[34:35]
    v_pk_mul_f32 v[20:21], v[20:21], v[36:37]
    v_pk_mul_f32 v[22:23], v[22:23], v[38:39]
    v_cvt_pk_bf16_f32 v32, v16, v17
    v_cvt_pk_bf16_f32 v33, v18, v19
    v_cvt_pk_bf16_f32 v34, v20, v21
    v_cvt_pk_bf16_f32 v35, v22, v23
    v_lshlrev_b32 v16, 16, v32
    v_and_b32 v17, 0xffff0000, v32
    v_lshlrev_b32 v18, 16, v33
    v_and_b32 v19, 0xffff0000, v33
    v_lshlrev_b32 v20, 16, v34
    v_and_b32 v21, 0xffff0000, v34
    v_lshlrev_b32 v22, 16, v35
    v_and_b32 v23, 0xffff0000, v35
    v_pk_mul_f32 v[16:17], v[16:17], v[24:25]
    v_pk_mul_f32 v[18:19], v[18:19], v[26:27]
    v_pk_mul_f32 v[20:21], v[20:21], v[28:29]
    v_pk_mul_f32 v[22:23], v[22:23], v[30:31]
    v_cvt_pk_bf16_f32 v32, v16, v17
    v_cvt_pk_bf16_f32 v33, v18, v19
    v_cvt_pk_bf16_f32 v34, v20, v21
    v_cvt_pk_bf16_f32 v35, v22, v23
    v_cndmask_b32 v64, 0, v32, s[52:53]
    v_cndmask_b32 v65, 0, v33, s[52:53]
    v_cndmask_b32 v66, 0, v34, s[52:53]
    v_cndmask_b32 v67, 0, v35, s[52:53]
    v_cndmask_b32 v68, 0, v32, s[54:55]
    v_cndmask_b32 v69, 0, v33, s[54:55]
    v_cndmask_b32 v70, 0, v34, s[54:55]
    v_cndmask_b32 v71, 0, v35, s[54:55]
    v_cndmask_b32 v72, 0, v32, s[56:57]
    v_cndmask_b32 v73, 0, v33, s[56:57]
    v_cndmask_b32 v74, 0, v34, s[56:57]
    v_cndmask_b32 v75, 0, v35, s[56:57]
    v_cndmask_b32 v76, 0, v32, s[58:59]
    v_cndmask_b32 v77, 0, v33, s[58:59]
    v_cndmask_b32 v78, 0, v34, s[58:59]
    v_cndmask_b32 v79, 0, v35, s[58:59]
    v_mfma_f32_16x16x32_bf16 v[16:19], v[64:67], a[72:75], 0
    v_mfma_f32_16x16x32_bf16 v[16:19], v[68:71], a[76:79], v[16:19]
    v_mfma_f32_16x16x32_bf16 v[16:19], v[72:75], a[80:83], v[16:19]
    v_mfma_f32_16x16x32_bf16 v[16:19], v[76:79], a[84:87], v[16:19]
    v_mfma_f32_16x16x32_bf16 v[20:23], v[64:67], a[88:91], 0
    v_mfma_f32_16x16x32_bf16 v[20:23], v[68:71], a[92:95], v[20:23]
    v_mfma_f32_16x16x32_bf16 v[20:23], v[72:75], a[96:99], v[20:23]
    v_mfma_f32_16x16x32_bf16 v[20:23], v[76:79], a[100:103], v[20:23]
    v_mfma_f32_16x16x32_bf16 v[24:27], v[64:67], a[104:107], 0
    v_mfma_f32_16x16x32_bf16 v[24:27], v[68:71], a[108:111], v[24:27]
    v_mfma_f32_16x16x32_bf16 v[24:27], v[72:75], a[112:115], v[24:27]
    v_mfma_f32_16x16x32_bf16 v[24:27], v[76:79], a[116:119], v[24:27]
    v_min_u32 v16, -2, v16
    v_min_u32 v17, -2, v17
    buffer_store_dwordx2 v[16:17], v15, s[32:35], s43 offen sc1
    s_add_u32 s43, s43, 294912
    v_min_u32 v20, -2, v20
    v_min_u32 v21, -2, v21
    buffer_store_dwordx2 v[20:21], v15, s[32:35], s43 offen sc1
    s_add_u32 s43, s43, 294912
    v_min_u32 v24, -2, v24
    v_min_u32 v25, -2, v25
    buffer_store_dwordx2 v[24:25], v15, s[32:35], s43 offen sc1
    s_branch Ltail_done
Ltail_noffn:
    s_cmp_lt_u32 s41, 27
    s_cselect_b32 s36, s3, 1
    s_cmp_eq_u32 s36, 0
    s_cbranch_scc1 Ltail_final
    v_cmp_ne_u32 vcc, s46, v7
    v_cmp_ne_u32 s[36:37], s47, v7
    v_mov_b32 v31, 2147483648
    s_and_b64 vcc, vcc, s[36:37]
    s_nop 1
    v_cndmask_b32 v31, v31, v4, vcc
    buffer_store_dwordx2 v[40:41], v31, s[16:19], 0 offen offset:0
    buffer_store_dwordx2 v[42:43], v31, s[16:19], 0 offen offset:32
    buffer_store_dwordx2 v[44:45], v31, s[16:19], 0 offen offset:384
    buffer_store_dwordx2 v[46:47], v31, s[16:19], 0 offen offset:416
    buffer_store_dwordx2 v[48:49], v31, s[16:19], 0 offen offset:768
    buffer_store_dwordx2 v[50:51], v31, s[16:19], 0 offen offset:800
    s_branch Ltail_done
Ltail_final:
    s_mul_i32 s43, s42, 9
    s_add_u32 s43, s43, s41
    s_sub_u32 s43, s43, 18
    v_bfe_u32 v8, v1, 2, 1
    v_cmp_eq_u32 vcc, 1, v8
    v_mov_b32 v9, s46
    v_mov_b32 v10, s47
    v_and_b32 v11, 3, v1
    v_cndmask_b32 v9, v9, v10, vcc
    s_lshr_b32 s44, s43, 2
    s_lshl_b32 s44, s44, 6
    s_and_b32 s45, s43, 1
    s_lshl_b32 s45, s45, 5
    s_add_u32 s44, s44, s45
    s_and_b32 s45, s43, 2
    s_lshl_b32 s45, s45, 2
    s_add_u32 s44, s44, s45
    v_lshrrev_b32 v12, 1, v11
    v_lshl_add_u32 v12, v12, 4, s44
    v_and_b32 v13, 1, v11
    v_lshl_add_u32 v12, v13, 2, v12
    v_mul_u32_u24 v13, 1152, v9
    v_add_u32 v14, v13, v12
    v_lshlrev_b32 v15, 2, v9
    s_mov_b32 s45, 5242880
    buffer_load_dword v16, v14, s[8:11], s45 offen sc1
    s_mov_b32 s45, 2621440
    buffer_load_dword v17, v14, s[8:11], s45 offen sc1
    s_mov_b32 s45, 22144
    buffer_load_dword v18, v12, s[8:11], s45 offen
    s_mov_b32 s45, 32768
    buffer_load_dword v19, v15, s[8:11], s45 offen sc1
    s_lshl_b32 s45, s43, 4
    v_lshl_add_u32 v13, v11, 2, v13
    v_add_u32 v13, s45, v13
    v_lshrrev_b32 v14, 2, v1
    v_lshlrev_b32 v14, 9, v14
    v_lshl_add_u32 v14, v11, 4, v14
    s_lshr_b32 s44, s43, 3
    s_mul_i32 s44, s44, 73728
    s_and_b32 s45, s43, 7
    s_lshl_b32 s45, s45, 6
    s_add_u32 s44, s44, s45
    v_cmp_ne_u32 vcc, s46, v7
    v_cmp_ne_u32 s[36:37], s47, v7
    v_mov_b32 v31, 2147483648
    s_and_b64 vcc, vcc, s[36:37]
    s_nop 1
    v_cndmask_b32 v31, v31, v4, vcc
    buffer_store_dwordx2 v[40:41], v31, s[16:19], 0 offen offset:0
    buffer_store_dwordx2 v[42:43], v31, s[16:19], 0 offen offset:32
    buffer_store_dwordx2 v[44:45], v31, s[16:19], 0 offen offset:384
    buffer_store_dwordx2 v[46:47], v31, s[16:19], 0 offen offset:416
    buffer_store_dwordx2 v[48:49], v31, s[16:19], 0 offen offset:768
    buffer_store_dwordx2 v[50:51], v31, s[16:19], 0 offen offset:800
    v_cmp_eq_u32 s[36:37], 1, v8
    s_waitcnt vmcnt(6)
    v_cvt_pk_bf16_f32 v19, v19, v19
    v_and_b32 v19, 0xffff0000, v19
    v_mul_f32 v19, 0xbfb8aa3b, v19
    v_exp_f32 v19, v19
    v_lshlrev_b32 v20, 16, v16
    v_and_b32 v21, 0xffff0000, v16
    v_lshlrev_b32 v22, 16, v17
    v_and_b32 v23, 0xffff0000, v17
    v_lshlrev_b32 v24, 16, v18
    v_and_b32 v25, 0xffff0000, v18
    v_add_f32 v19, 1.0, v19
    v_rcp_f32 v19, v19
    s_mov_b32 s48, 16384
    v_cvt_pk_bf16_f32 v19, v19, v19
    v_and_b32 v19, 0xffff0000, v19
Ltail_polly:
    s_add_u32 s45, s44, 0
    buffer_load_dwordx4 v[64:67], v14, s[32:35], s45 offen sc1
    s_add_u32 s45, s44, 8192
    buffer_load_dwordx4 v[68:71], v14, s[32:35], s45 offen sc1
    s_add_u32 s45, s44, 16384
    buffer_load_dwordx4 v[72:75], v14, s[32:35], s45 offen sc1
    s_add_u32 s45, s44, 24576
    buffer_load_dwordx4 v[76:79], v14, s[32:35], s45 offen sc1
    s_add_u32 s45, s44, 32768
    buffer_load_dwordx4 v[80:83], v14, s[32:35], s45 offen sc1
    s_add_u32 s45, s44, 40960
    buffer_load_dwordx4 v[84:87], v14, s[32:35], s45 offen sc1
    s_add_u32 s45, s44, 49152
    buffer_load_dwordx4 v[88:91], v14, s[32:35], s45 offen sc1
    s_add_u32 s45, s44, 57344
    buffer_load_dwordx4 v[92:95], v14, s[32:35], s45 offen sc1
    s_add_u32 s45, s44, 65536
    buffer_load_dwordx4 v[96:99], v14, s[32:35], s45 offen sc1
    s_sub_u32 s48, s48, 1
    s_cbranch_scc1 Ltail_goty
    s_waitcnt vmcnt(8)
    v_max3_u32 v26, v64, v65, v66
    s_waitcnt vmcnt(7)
    v_max3_u32 v26, v26, v67, v68
    v_max3_u32 v26, v26, v69, v70
    s_waitcnt vmcnt(6)
    v_max3_u32 v26, v26, v71, v72
    v_max3_u32 v26, v26, v73, v74
    s_waitcnt vmcnt(5)
    v_max3_u32 v26, v26, v75, v76
    v_max3_u32 v26, v26, v77, v78
    s_waitcnt vmcnt(4)
    v_max3_u32 v26, v26, v79, v80
    v_max3_u32 v26, v26, v81, v82
    s_waitcnt vmcnt(3)
    v_max3_u32 v26, v26, v83, v84
    v_max3_u32 v26, v26, v85, v86
    s_waitcnt vmcnt(2)
    v_max3_u32 v26, v26, v87, v88
    v_max3_u32 v26, v26, v89, v90
    s_waitcnt vmcnt(1)
    v_max3_u32 v26, v26, v91, v92
    v_max3_u32 v26, v26, v93, v94
    s_waitcnt vmcnt(0)
    v_max3_u32 v26, v26, v95, v96
    v_max3_u32 v26, v26, v97, v98
    v_max_u32 v26, v26, v99
    v_cmp_eq_u32 vcc, -1, v26
    s_cbranch_vccnz Ltail_polly
Ltail_goty:
    s_waitcnt vmcnt(0) lgkmcnt(0)
    v_pk_add_f32 v[64:65], v[64:65], v[68:69]
    v_pk_add_f32 v[66:67], v[66:67], v[70:71]
    v_pk_add_f32 v[64:65], v[64:65], v[72:73]
    v_pk_add_f32 v[66:67], v[66:67], v[74:75]
    v_pk_add_f32 v[64:65], v[64:65], v[76:77]
    v_pk_add_f32 v[66:67], v[66:67], v[78:79]
    v_pk_add_f32 v[64:65], v[64:65], v[80:81]
    v_pk_add_f32 v[66:67], v[66:67], v[82:83]
    v_pk_add_f32 v[64:65], v[64:65], v[84:85]
    v_pk_add_f32 v[66:67], v[66:67], v[86:87]
    v_pk_add_f32 v[64:65], v[64:65], v[88:89]
    v_pk_add_f32 v[66:67], v[66:67], v[90:91]
    v_pk_add_f32 v[64:65], v[64:65], v[92:93]
    v_pk_add_f32 v[66:67], v[66:67], v[94:95]
    v_pk_add_f32 v[64:65], v[64:65], v[96:97]
    v_pk_add_f32 v[66:67], v[66:67], v[98:99]
    s_nop 0
    v_add_f32_dpp v64, v64, v64 row_ror:4 row_mask:0xf bank_mask:0xf
    v_add_f32_dpp v65, v65, v65 row_ror:4 row_mask:0xf bank_mask:0xf
    v_add_f32_dpp v66, v66, v66 row_ror:4 row_mask:0xf bank_mask:0xf
    v_add_f32_dpp v67, v67, v67 row_ror:4 row_mask:0xf bank_mask:0xf
    v_add_f32_dpp v64, v64, v64 row_ror:8 row_mask:0xf bank_mask:0xf
    v_add_f32_dpp v65, v65, v65 row_ror:8 row_mask:0xf bank_mask:0xf
    v_add_f32_dpp v66, v66, v66 row_ror:8 row_mask:0xf bank_mask:0xf
    v_add_f32_dpp v67, v67, v67 row_ror:8 row_mask:0xf bank_mask:0xf
    v_mov_b32 v68, v64
    v_mov_b32 v69, v65
    v_mov_b32 v70, v66
    v_mov_b32 v71, v67
    v_permlane16_swap_b32 v64, v68
    v_permlane16_swap_b32 v65, v69
    v_permlane16_swap_b32 v66, v70
    v_permlane16_swap_b32 v67, v71
    v_add_f32 v64, v64, v68
    v_add_f32 v65, v65, v69
    v_add_f32 v66, v66, v70
    v_add_f32 v67, v67, v71
    v_mov_b32 v68, v64
    v_mov_b32 v69, v65
    v_mov_b32 v70, v66
    v_mov_b32 v71, v67
    v_permlane32_swap_b32 v64, v68
    v_permlane32_swap_b32 v65, v69
    v_permlane32_swap_b32 v66, v70
    v_permlane32_swap_b32 v67, v71
    v_add_f32 v64, v64, v68
    v_add_f32 v65, v65, v69
    v_add_f32 v66, v66, v70
    v_add_f32 v67, v67, v71
    v_cndmask_b32 v26, v64, v65, s[36:37]
    v_cndmask_b32 v27, v66, v67, s[36:37]
    v_cvt_pk_bf16_f32 v28, v26, v27
    v_lshlrev_b32 v26, 16, v28
    v_and_b32 v27, 0xffff0000, v28
    v_mul_f32 v26, v26, v19
    v_mul_f32 v27, v27, v19
    v_cvt_pk_bf16_f32 v28, v26, v27
    v_lshlrev_b32 v26, 16, v28
    v_and_b32 v27, 0xffff0000, v28
    v_pk_add_f32 v[26:27], v[26:27], v[22:23]
    v_cvt_pk_bf16_f32 v28, v26, v27
    v_lshlrev_b32 v26, 16, v28
    v_and_b32 v27, 0xffff0000, v28
    v_pk_mul_f32 v[26:27], v[26:27], v[24:25]
    v_cvt_pk_bf16_f32 v28, v26, v27
    v_lshlrev_b32 v26, 16, v28
    v_and_b32 v27, 0xffff0000, v28
    v_pk_add_f32 v[26:27], v[26:27], v[20:21]
    v_cvt_pk_bf16_f32 v28, v26, v27
    s_mov_b64 exec, 0xff
    buffer_store_dword v28, v13, s[16:19], 0 offen
Ltail_done:
    s_endpgm
Lattn_redo:
    s_waitcnt vmcnt(0) lgkmcnt(0)
    s_barrier
    v_mov_b32 v232, 0xff800000
    v_mov_b32 v233, 0xff800000
    v_mov_b32 v234, 0xff800000
    v_mov_b32 v235, 0xff800000
    s_mov_b32 s40, 0
    s_mov_b32 s48, -1
Lattn_redo_loop:
    s_add_u32 m0, s42, 0
    s_nop 0
    buffer_load_dwordx4 v36, s[8:11], s40 offen lds
    buffer_load_dwordx4 v37, s[8:11], s40 offen offset:1024 lds
    buffer_load_dwordx4 v38, s[8:11], s40 offen offset:2048 lds
    buffer_load_dwordx4 v39, s[8:11], s40 offen offset:3072 lds
    s_add_u32 s40, s40, 16384
    s_waitcnt vmcnt(0) lgkmcnt(0)
    s_barrier
    ds_read_b128 a[208:211], v8 offset:0
    ds_read_b128 a[212:215], v9 offset:0
    ds_read_b128 a[216:219], v10 offset:0
    ds_read_b128 a[220:223], v11 offset:0
    s_waitcnt lgkmcnt(3)
    v_mfma_f32_16x16x32_bf16 v[216:219], a[208:211], v[64:67], 0
    s_waitcnt lgkmcnt(2)
    v_mfma_f32_16x16x32_bf16 v[216:219], a[212:215], v[68:71], v[216:219]
    s_waitcnt lgkmcnt(1)
    v_mfma_f32_16x16x32_bf16 v[216:219], a[216:219], v[72:75], v[216:219]
    s_waitcnt lgkmcnt(0)
    v_mfma_f32_16x16x32_bf16 v[216:219], a[220:223], v[76:79], v[216:219]
    v_mfma_f32_16x16x32_bf16 v[220:223], a[208:211], v[80:83], 0
    v_mfma_f32_16x16x32_bf16 v[220:223], a[212:215], v[84:87], v[220:223]
    v_mfma_f32_16x16x32_bf16 v[220:223], a[216:219], v[88:91], v[220:223]
    v_mfma_f32_16x16x32_bf16 v[220:223], a[220:223], v[92:95], v[220:223]
    v_mfma_f32_16x16x32_bf16 v[224:227], a[208:211], v[96:99], 0
    v_mfma_f32_16x16x32_bf16 v[224:227], a[212:215], v[100:103], v[224:227]
    v_mfma_f32_16x16x32_bf16 v[224:227], a[216:219], v[104:107], v[224:227]
    v_mfma_f32_16x16x32_bf16 v[224:227], a[220:223], v[108:111], v[224:227]
    v_mfma_f32_16x16x32_bf16 v[228:231], a[208:211], v[112:115], 0
    v_mfma_f32_16x16x32_bf16 v[228:231], a[212:215], v[116:119], v[228:231]
    v_mfma_f32_16x16x32_bf16 v[228:231], a[216:219], v[120:123], v[228:231]
    v_mfma_f32_16x16x32_bf16 v[228:231], a[220:223], v[124:127], v[228:231]
    v_max3_f32 v232, v232, v216, v217
    v_max3_f32 v232, v232, v218, v219
    v_max3_f32 v233, v233, v220, v221
    v_max3_f32 v233, v233, v222, v223
    v_max3_f32 v234, v234, v224, v225
    v_max3_f32 v234, v234, v226, v227
    s_nop 1
    v_max3_f32 v235, v235, v228, v229
    v_max3_f32 v235, v235, v230, v231
    ds_read_b128 a[224:227], v8 offset:4096
    ds_read_b128 a[228:231], v9 offset:4096
    ds_read_b128 a[232:235], v10 offset:4096
    ds_read_b128 a[236:239], v11 offset:4096
    s_waitcnt lgkmcnt(3)
    v_mfma_f32_16x16x32_bf16 v[216:219], a[224:227], v[64:67], 0
    s_waitcnt lgkmcnt(2)
    v_mfma_f32_16x16x32_bf16 v[216:219], a[228:231], v[68:71], v[216:219]
    s_waitcnt lgkmcnt(1)
    v_mfma_f32_16x16x32_bf16 v[216:219], a[232:235], v[72:75], v[216:219]
    s_waitcnt lgkmcnt(0)
    v_mfma_f32_16x16x32_bf16 v[216:219], a[236:239], v[76:79], v[216:219]
    v_mfma_f32_16x16x32_bf16 v[220:223], a[224:227], v[80:83], 0
    v_mfma_f32_16x16x32_bf16 v[220:223], a[228:231], v[84:87], v[220:223]
    v_mfma_f32_16x16x32_bf16 v[220:223], a[232:235], v[88:91], v[220:223]
    v_mfma_f32_16x16x32_bf16 v[220:223], a[236:239], v[92:95], v[220:223]
    v_mfma_f32_16x16x32_bf16 v[224:227], a[224:227], v[96:99], 0
    v_mfma_f32_16x16x32_bf16 v[224:227], a[228:231], v[100:103], v[224:227]
    v_mfma_f32_16x16x32_bf16 v[224:227], a[232:235], v[104:107], v[224:227]
    v_mfma_f32_16x16x32_bf16 v[224:227], a[236:239], v[108:111], v[224:227]
    v_mfma_f32_16x16x32_bf16 v[228:231], a[224:227], v[112:115], 0
    v_mfma_f32_16x16x32_bf16 v[228:231], a[228:231], v[116:119], v[228:231]
    v_mfma_f32_16x16x32_bf16 v[228:231], a[232:235], v[120:123], v[228:231]
    v_mfma_f32_16x16x32_bf16 v[228:231], a[236:239], v[124:127], v[228:231]
    v_max3_f32 v232, v232, v216, v217
    v_max3_f32 v232, v232, v218, v219
    v_max3_f32 v233, v233, v220, v221
    v_max3_f32 v233, v233, v222, v223
    v_max3_f32 v234, v234, v224, v225
    v_max3_f32 v234, v234, v226, v227
    s_nop 1
    v_max3_f32 v235, v235, v228, v229
    v_max3_f32 v235, v235, v230, v231
    ds_read_b128 a[208:211], v8 offset:8192
    ds_read_b128 a[212:215], v9 offset:8192
    ds_read_b128 a[216:219], v10 offset:8192
    ds_read_b128 a[220:223], v11 offset:8192
    s_waitcnt lgkmcnt(3)
    v_mfma_f32_16x16x32_bf16 v[216:219], a[208:211], v[64:67], 0
    s_waitcnt lgkmcnt(2)
    v_mfma_f32_16x16x32_bf16 v[216:219], a[212:215], v[68:71], v[216:219]
    s_waitcnt lgkmcnt(1)
    v_mfma_f32_16x16x32_bf16 v[216:219], a[216:219], v[72:75], v[216:219]
    s_waitcnt lgkmcnt(0)
    v_mfma_f32_16x16x32_bf16 v[216:219], a[220:223], v[76:79], v[216:219]
    v_mfma_f32_16x16x32_bf16 v[220:223], a[208:211], v[80:83], 0
    v_mfma_f32_16x16x32_bf16 v[220:223], a[212:215], v[84:87], v[220:223]
    v_mfma_f32_16x16x32_bf16 v[220:223], a[216:219], v[88:91], v[220:223]
    v_mfma_f32_16x16x32_bf16 v[220:223], a[220:223], v[92:95], v[220:223]
    v_mfma_f32_16x16x32_bf16 v[224:227], a[208:211], v[96:99], 0
    v_mfma_f32_16x16x32_bf16 v[224:227], a[212:215], v[100:103], v[224:227]
    v_mfma_f32_16x16x32_bf16 v[224:227], a[216:219], v[104:107], v[224:227]
    v_mfma_f32_16x16x32_bf16 v[224:227], a[220:223], v[108:111], v[224:227]
    v_mfma_f32_16x16x32_bf16 v[228:231], a[208:211], v[112:115], 0
    v_mfma_f32_16x16x32_bf16 v[228:231], a[212:215], v[116:119], v[228:231]
    v_mfma_f32_16x16x32_bf16 v[228:231], a[216:219], v[120:123], v[228:231]
    v_mfma_f32_16x16x32_bf16 v[228:231], a[220:223], v[124:127], v[228:231]
    v_max3_f32 v232, v232, v216, v217
    v_max3_f32 v232, v232, v218, v219
    v_max3_f32 v233, v233, v220, v221
    v_max3_f32 v233, v233, v222, v223
    v_max3_f32 v234, v234, v224, v225
    v_max3_f32 v234, v234, v226, v227
    s_nop 1
    v_max3_f32 v235, v235, v228, v229
    v_max3_f32 v235, v235, v230, v231
    ds_read_b128 a[224:227], v8 offset:12288
    ds_read_b128 a[228:231], v9 offset:12288
    ds_read_b128 a[232:235], v10 offset:12288
    ds_read_b128 a[236:239], v11 offset:12288
    s_waitcnt lgkmcnt(3)
    v_mfma_f32_16x16x32_bf16 v[216:219], a[224:227], v[64:67], 0
    s_waitcnt lgkmcnt(2)
    v_mfma_f32_16x16x32_bf16 v[216:219], a[228:231], v[68:71], v[216:219]
    s_waitcnt lgkmcnt(1)
    v_mfma_f32_16x16x32_bf16 v[216:219], a[232:235], v[72:75], v[216:219]
    s_waitcnt lgkmcnt(0)
    v_mfma_f32_16x16x32_bf16 v[216:219], a[236:239], v[76:79], v[216:219]
    v_mfma_f32_16x16x32_bf16 v[220:223], a[224:227], v[80:83], 0
    v_mfma_f32_16x16x32_bf16 v[220:223], a[228:231], v[84:87], v[220:223]
    v_mfma_f32_16x16x32_bf16 v[220:223], a[232:235], v[88:91], v[220:223]
    v_mfma_f32_16x16x32_bf16 v[220:223], a[236:239], v[92:95], v[220:223]
    v_mfma_f32_16x16x32_bf16 v[224:227], a[224:227], v[96:99], 0
    v_mfma_f32_16x16x32_bf16 v[224:227], a[228:231], v[100:103], v[224:227]
    v_mfma_f32_16x16x32_bf16 v[224:227], a[232:235], v[104:107], v[224:227]
    v_mfma_f32_16x16x32_bf16 v[224:227], a[236:239], v[108:111], v[224:227]
    v_mfma_f32_16x16x32_bf16 v[228:231], a[224:227], v[112:115], 0
    v_mfma_f32_16x16x32_bf16 v[228:231], a[228:231], v[116:119], v[228:231]
    v_mfma_f32_16x16x32_bf16 v[228:231], a[232:235], v[120:123], v[228:231]
    v_mfma_f32_16x16x32_bf16 v[228:231], a[236:239], v[124:127], v[228:231]
    v_max3_f32 v232, v232, v216, v217
    v_max3_f32 v232, v232, v218, v219
    v_max3_f32 v233, v233, v220, v221
    v_max3_f32 v233, v233, v222, v223
    v_max3_f32 v234, v234, v224, v225
    v_max3_f32 v234, v234, v226, v227
    s_nop 1
    v_max3_f32 v235, v235, v228, v229
    v_max3_f32 v235, v235, v230, v231
    s_barrier
    s_cmp_lt_u32 s40, 524288
    s_cbranch_scc1 Lattn_redo_loop
    v_mov_b32 v236, v232
    v_mov_b32 v237, v233
    v_mov_b32 v238, v234
    v_mov_b32 v239, v235
    v_permlane16_swap_b32 v232, v236
    v_permlane16_swap_b32 v233, v237
    v_permlane16_swap_b32 v234, v238
    v_permlane16_swap_b32 v235, v239
    v_max_f32 v232, v232, v236
    v_max_f32 v233, v233, v237
    v_max_f32 v234, v234, v238
    v_max_f32 v235, v235, v239
    v_mov_b32 v236, v232
    v_mov_b32 v237, v233
    v_mov_b32 v238, v234
    v_mov_b32 v239, v235
    v_permlane32_swap_b32 v232, v236
    v_permlane32_swap_b32 v233, v237
    v_permlane32_swap_b32 v234, v238
    v_permlane32_swap_b32 v235, v239
    v_max_f32 v232, v232, v236
    v_max_f32 v233, v233, v237
    v_max_f32 v234, v234, v238
    v_max_f32 v235, v235, v239
    v_sub_f32 v192, 0, v232
    v_sub_f32 v193, 0, v232
    v_sub_f32 v194, 0, v232
    v_sub_f32 v195, 0, v232
    v_sub_f32 v196, 0, v233
    v_sub_f32 v197, 0, v233
    v_sub_f32 v198, 0, v233
    v_sub_f32 v199, 0, v233
    v_sub_f32 v200, 0, v234
    v_sub_f32 v201, 0, v234
    v_sub_f32 v202, 0, v234
    v_sub_f32 v203, 0, v234
    v_sub_f32 v204, 0, v235
    v_sub_f32 v205, 0, v235
    v_sub_f32 v206, 0, v235
    v_sub_f32 v207, 0, v235
    s_mov_b32 s40, 0
    s_mov_b32 s41, 0
    s_add_u32 m0, s42, 0
    s_nop 0
    buffer_load_dwordx4 v36, s[8:11], s40 offen lds
    buffer_load_dwordx4 v37, s[8:11], s40 offen offset:1024 lds
    buffer_load_dwordx4 v38, s[8:11], s40 offen offset:2048 lds
    buffer_load_dwordx4 v39, s[8:11], s40 offen offset:3072 lds
    s_add_u32 s40, s40, 16384
    s_add_u32 m0, s42, 16384
    s_nop 0
    buffer_load_dwordx4 v36, s[8:11], s40 offen lds
    buffer_load_dwordx4 v37, s[8:11], s40 offen offset:1024 lds
    buffer_load_dwordx4 v38, s[8:11], s40 offen offset:2048 lds
    buffer_load_dwordx4 v39, s[8:11], s40 offen offset:3072 lds
    s_add_u32 s40, s40, 16384
    s_add_u32 m0, s42, 32768
    s_nop 0
    buffer_load_dwordx4 v36, s[8:11], s40 offen lds
    buffer_load_dwordx4 v37, s[8:11], s40 offen offset:1024 lds
    buffer_load_dwordx4 v38, s[8:11], s40 offen offset:2048 lds
    buffer_load_dwordx4 v39, s[8:11], s40 offen offset:3072 lds
    s_add_u32 s40, s40, 16384
    s_add_u32 m0, s42, 65536
    s_nop 0
    buffer_load_dwordx4 v40, s[12:15], s41 offen lds
    buffer_load_dwordx4 v41, s[12:15], s41 offen offset:1024 lds
    buffer_load_dwordx4 v40, s[12:15], s41 offen offset:2048 lds
    buffer_load_dwordx4 v41, s[12:15], s41 offen offset:3072 lds
    s_add_u32 s41, s41, 16384
    s_add_u32 m0, s42, 81920
    s_nop 0
    buffer_load_dwordx4 v40, s[12:15], s41 offen lds
    buffer_load_dwordx4 v41, s[12:15], s41 offen offset:1024 lds
    buffer_load_dwordx4 v40, s[12:15], s41 offen offset:2048 lds
    buffer_load_dwordx4 v41, s[12:15], s41 offen offset:3072 lds
    s_add_u32 s41, s41, 16384
    v_accvgpr_write_b32 a0, 0
    v_accvgpr_write_b32 a1, 0
    v_accvgpr_write_b32 a2, 0
    v_accvgpr_write_b32 a3, 0
    v_accvgpr_write_b32 a4, 0
    v_accvgpr_write_b32 a5, 0
    v_accvgpr_write_b32 a6, 0
    v_accvgpr_write_b32 a7, 0
    v_accvgpr_write_b32 a8, 0
    v_accvgpr_write_b32 a9, 0
    v_accvgpr_write_b32 a10, 0
    v_accvgpr_write_b32 a11, 0
    v_accvgpr_write_b32 a12, 0
    v_accvgpr_write_b32 a13, 0
    v_accvgpr_write_b32 a14, 0
    v_accvgpr_write_b32 a15, 0
    v_accvgpr_write_b32 a16, 0
    v_accvgpr_write_b32 a17, 0
    v_accvgpr_write_b32 a18, 0
    v_accvgpr_write_b32 a19, 0
    v_accvgpr_write_b32 a20, 0
    v_accvgpr_write_b32 a21, 0
    v_accvgpr_write_b32 a22, 0
    v_accvgpr_write_b32 a23, 0
    v_accvgpr_write_b32 a24, 0
    v_accvgpr_write_b32 a25, 0
    v_accvgpr_write_b32 a26, 0
    v_accvgpr_write_b32 a27, 0
    v_accvgpr_write_b32 a28, 0
    v_accvgpr_write_b32 a29, 0
    v_accvgpr_write_b32 a30, 0
    v_accvgpr_write_b32 a31, 0
    v_accvgpr_write_b32 a32, 0
    v_accvgpr_write_b32 a33, 0
    v_accvgpr_write_b32 a34, 0
    v_accvgpr_write_b32 a35, 0
    v_accvgpr_write_b32 a36, 0
    v_accvgpr_write_b32 a37, 0
    v_accvgpr_write_b32 a38, 0
    v_accvgpr_write_b32 a39, 0
    v_accvgpr_write_b32 a40, 0
    v_accvgpr_write_b32 a41, 0
    v_accvgpr_write_b32 a42, 0
    v_accvgpr_write_b32 a43, 0
    v_accvgpr_write_b32 a44, 0
    v_accvgpr_write_b32 a45, 0
    v_accvgpr_write_b32 a46, 0
    v_accvgpr_write_b32 a47, 0
    v_accvgpr_write_b32 a48, 0
    v_accvgpr_write_b32 a49, 0
    v_accvgpr_write_b32 a50, 0
    v_accvgpr_write_b32 a51, 0
    v_accvgpr_write_b32 a52, 0
    v_accvgpr_write_b32 a53, 0
    v_accvgpr_write_b32 a54, 0
    v_accvgpr_write_b32 a55, 0
    v_accvgpr_write_b32 a56, 0
    v_accvgpr_write_b32 a57, 0
    v_accvgpr_write_b32 a58, 0
    v_accvgpr_write_b32 a59, 0
    v_accvgpr_write_b32 a60, 0
    v_accvgpr_write_b32 a61, 0
    v_accvgpr_write_b32 a62, 0
    v_accvgpr_write_b32 a63, 0
    v_accvgpr_write_b32 a64, 0
    v_accvgpr_write_b32 a65, 0
    v_accvgpr_write_b32 a66, 0
    v_accvgpr_write_b32 a67, 0
    v_accvgpr_write_b32 a68, 0
    v_accvgpr_write_b32 a69, 0
    v_accvgpr_write_b32 a70, 0
    v_accvgpr_write_b32 a71, 0
    v_accvgpr_write_b32 a72, 0
    v_accvgpr_write_b32 a73, 0
    v_accvgpr_write_b32 a74, 0
    v_accvgpr_write_b32 a75, 0
    v_accvgpr_write_b32 a76, 0
    v_accvgpr_write_b32 a77, 0
    v_accvgpr_write_b32 a78, 0
    v_accvgpr_write_b32 a79, 0
    v_accvgpr_write_b32 a80, 0
    v_accvgpr_write_b32 a81, 0
    v_accvgpr_write_b32 a82, 0
    v_accvgpr_write_b32 a83, 0
    v_accvgpr_write_b32 a84, 0
    v_accvgpr_write_b32 a85, 0
    v_accvgpr_write_b32 a86, 0
    v_accvgpr_write_b32 a87, 0
    v_accvgpr_write_b32 a88, 0
    v_accvgpr_write_b32 a89, 0
    v_accvgpr_write_b32 a90, 0
    v_accvgpr_write_b32 a91, 0
    v_accvgpr_write_b32 a92, 0
    v_accvgpr_write_b32 a93, 0
    v_accvgpr_write_b32 a94, 0
    v_accvgpr_write_b32 a95, 0
    v_accvgpr_write_b32 a96, 0
    v_accvgpr_write_b32 a97, 0
    v_accvgpr_write_b32 a98, 0
    v_accvgpr_write_b32 a99, 0
    v_accvgpr_write_b32 a100, 0
    v_accvgpr_write_b32 a101, 0
    v_accvgpr_write_b32 a102, 0
    v_accvgpr_write_b32 a103, 0
    v_accvgpr_write_b32 a104, 0
    v_accvgpr_write_b32 a105, 0
    v_accvgpr_write_b32 a106, 0
    v_accvgpr_write_b32 a107, 0
    v_accvgpr_write_b32 a108, 0
    v_accvgpr_write_b32 a109, 0
    v_accvgpr_write_b32 a110, 0
    v_accvgpr_write_b32 a111, 0
    v_accvgpr_write_b32 a112, 0
    v_accvgpr_write_b32 a113, 0
    v_accvgpr_write_b32 a114, 0
    v_accvgpr_write_b32 a115, 0
    v_accvgpr_write_b32 a116, 0
    v_accvgpr_write_b32 a117, 0
    v_accvgpr_write_b32 a118, 0
    v_accvgpr_write_b32 a119, 0
    v_accvgpr_write_b32 a120, 0
    v_accvgpr_write_b32 a121, 0
    v_accvgpr_write_b32 a122, 0
    v_accvgpr_write_b32 a123, 0
    v_accvgpr_write_b32 a124, 0
    v_accvgpr_write_b32 a125, 0
    v_accvgpr_write_b32 a126, 0
    v_accvgpr_write_b32 a127, 0
    v_accvgpr_write_b32 a192, 0
    v_accvgpr_write_b32 a193, 0
    v_accvgpr_write_b32 a194, 0
    v_accvgpr_write_b32 a195, 0
    v_accvgpr_write_b32 a196, 0
    v_accvgpr_write_b32 a197, 0
    v_accvgpr_write_b32 a198, 0
    v_accvgpr_write_b32 a199, 0
    v_accvgpr_write_b32 a200, 0
    v_accvgpr_write_b32 a201, 0
    v_accvgpr_write_b32 a202, 0
    v_accvgpr_write_b32 a203, 0
    v_accvgpr_write_b32 a204, 0
    v_accvgpr_write_b32 a205, 0
    v_accvgpr_write_b32 a206, 0
    v_accvgpr_write_b32 a207, 0
    s_waitcnt vmcnt(0) lgkmcnt(0)
    s_barrier
    ds_read_b128 a[208:211], v8 offset:0
    ds_read_b128 a[212:215], v9 offset:0
    ds_read_b128 a[216:219], v10 offset:0
    ds_read_b128 a[220:223], v11 offset:0
    ds_read_b128 a[224:227], v8 offset:4096
    s_waitcnt vmcnt(0) lgkmcnt(0)
    s_branch Lattn_stage0
Lattn_end:
    s_endpgm
.section .rodata,"a"
.p2align 6
.amdhsa_kernel mod_kernel
  .amdhsa_next_free_vgpr 72
  .amdhsa_next_free_sgpr 102
  .amdhsa_accum_offset 72
  .amdhsa_group_segment_fixed_size 0
  .amdhsa_kernarg_size 120
  .amdhsa_user_sgpr_count 2
  .amdhsa_user_sgpr_kernarg_segment_ptr 1
  .amdhsa_system_sgpr_workgroup_id_x 1
  .amdhsa_float_denorm_mode_32 3
.end_amdhsa_kernel
.p2align 6
.amdhsa_kernel ln1_kernel
  .amdhsa_next_free_vgpr 72
  .amdhsa_next_free_sgpr 102
  .amdhsa_accum_offset 72
  .amdhsa_group_segment_fixed_size 0
  .amdhsa_kernarg_size 120
  .amdhsa_user_sgpr_count 2
  .amdhsa_user_sgpr_kernarg_segment_ptr 1
  .amdhsa_system_sgpr_workgroup_id_x 1
  .amdhsa_float_denorm_mode_32 3
.end_amdhsa_kernel
.p2align 6
.amdhsa_kernel attn_kernel
  .amdhsa_next_free_vgpr 512
  .amdhsa_next_free_sgpr 102
  .amdhsa_accum_offset 256
  .amdhsa_group_segment_fixed_size 0
  .amdhsa_kernarg_size 120
  .amdhsa_user_sgpr_count 2
  .amdhsa_user_sgpr_kernarg_segment_ptr 1
  .amdhsa_system_sgpr_workgroup_id_x 1
  .amdhsa_float_denorm_mode_32 3
.end_amdhsa_kernel
```

```asm
; @launch grid=(256,1,1) block=(256,1,1) lds=163840
.amdgcn_target "amdgcn-amd-amdhsa--gfx950"
.text
.globl adaLN_cond__gqa_block_cached__moe_arch_mod__prompt_kernel
.p2align 8
.type adaLN_cond__gqa_block_cached__moe_arch_mod__prompt_kernel,@function
adaLN_cond__gqa_block_cached__moe_arch_mod__prompt_kernel:
    s_cmp_ge_u32 s2, 256
    s_cbranch_scc1 Lattn_end
    s_load_dwordx2 s[8:9], s[0:1], 80
    s_load_dwordx2 s[12:13], s[0:1], 88
    s_load_dwordx2 s[20:21], s[0:1], 0
    s_load_dwordx2 s[50:51], s[0:1], 112
    s_load_dwordx8 s[52:59], s[0:1], 8
    s_load_dwordx4 s[80:83], s[0:1], 56
    s_load_dwordx2 s[84:85], s[0:1], 72
    s_load_dwordx2 s[88:89], s[0:1], 104
    s_getpc_b64 s[32:33]
Lattn_pc:
    s_mov_b32 s34, Lattn_end-Lattn_pc
    s_mov_b32 s35, 0x20000
    s_lshr_b32 s6, s2, 3
    s_lshl_b32 s7, s6, 6
    v_lshrrev_b32 v3, 6, v0
    v_and_b32 v1, 63, v0
    v_lshrrev_b32 v2, 2, v0
    v_lshlrev_b32 v2, 11, v2
    v_readfirstlane_b32 s3, v3
    buffer_load_dword v240, v2, s[32:35], s7 offen
    s_and_b32 s7, s2, 7
    s_lshl_b32 s4, s7, 1
    s_and_b32 s5, s6, 1
    s_add_u32 s4, s4, s5
    s_lshr_b32 s5, s2, 4
    s_mul_i32 s38, s7, 27
    s_add_u32 s38, s38, s6
    s_cmp_lt_u32 s6, 27
    s_cselect_b32 s14, 3981312, 0
    s_cselect_b32 s39, 0, 2147483648
    s_mov_b32 s15, 0x20000
    s_mov_b32 s10, 1152
    s_mov_b32 s11, 0x20000
    s_mov_b32 s22, 2359296
    s_mov_b32 s23, 0x20000
    v_and_b32 v64, 0xfe, v0
    v_mul_u32_u24 v65, 3456, v64
    v_and_b32 v2, 1, v0
    v_lshl_add_u32 v65, v2, 4, v65
    s_lshl_b32 s36, s38, 5
    v_and_b32 v4, 31, v1
    v_lshrrev_b32 v5, 5, v1
    v_cmp_gt_u32 vcc, 24, v4
    v_mov_b32 v6, 2147483648
    s_lshl_b32 s7, s5, 4
    s_add_u32 s7, s7, s4
    s_lshl_b32 s7, s7, 2
    s_add_u32 s7, s7, s3
    v_cndmask_b32 v6, v6, 0, vcc
    s_mul_i32 s37, s7, 2304
    v_lshrrev_b32 v7, 2, v4
    v_lshl_add_u32 v7, v7, 6, v6
    v_and_b32 v2, 3, v4
    v_lshl_add_u32 v7, v2, 3, v7
    v_mul_u32_u24 v2, 1152, v5
    v_add_u32 v66, v7, v2
    s_waitcnt lgkmcnt(0)
    s_load_dword s94, s[50:51], 24576
    buffer_load_ushort v80, v64, s[8:11], 0 offen offset:0
    buffer_load_ushort v81, v64, s[8:11], 0 offen offset:256
    buffer_load_ushort v82, v64, s[8:11], 0 offen offset:512
    buffer_load_ushort v83, v64, s[8:11], 0 offen offset:768
    buffer_load_ushort v84, v64, s[8:11], 0 offen offset:1024
    buffer_load_dwordx4 v[88:91], v65, s[12:15], s36 offen
    s_add_u32 s36, s36, 884736
    buffer_load_dwordx4 v[92:95], v65, s[12:15], s36 offen
    s_add_u32 s36, s36, 884736
    buffer_load_dwordx4 v[96:99], v65, s[12:15], s36 offen
    s_add_u32 s36, s36, 884736
    buffer_load_dwordx4 v[100:103], v65, s[12:15], s36 offen
    s_add_u32 s36, s36, 884736
    buffer_load_dwordx4 v[104:107], v65, s[12:15], s36 offen
    buffer_load_dwordx2 v[108:109], v66, s[20:23], s37 offen offset:0
    buffer_load_dwordx2 v[110:111], v66, s[20:23], s37 offen offset:32
    buffer_load_dwordx2 v[112:113], v66, s[20:23], s37 offen offset:384
    buffer_load_dwordx2 v[114:115], v66, s[20:23], s37 offen offset:416
    buffer_load_dwordx2 v[116:117], v66, s[20:23], s37 offen offset:768
    buffer_load_dwordx2 v[118:119], v66, s[20:23], s37 offen offset:800
    s_mov_b32 s16, s56
    s_mov_b32 s17, s57
    s_mov_b32 s18, 4718592
    s_mov_b32 s19, 0x20000
    s_lshl_b32 s44, s4, 9
    s_mul_i32 s36, s5, 294912
    s_add_u32 s36, s36, s44
    v_min_u32 v2, 143, v0
    v_lshrrev_b32 v3, 2, v2
    v_and_b32 v2, 3, v2
    v_lshlrev_b32 v2, 7, v2
    v_lshl_add_u32 v2, v3, 13, v2
    buffer_load_dword v241, v2, s[16:19], s36 offen
    s_add_u32 s92, s37, 65536
    v_lshl_add_u32 v7, v5, 4, v6
    v_lshl_add_u32 v67, v4, 5, v7
    v_min_u32 v4, 23, v4
    v_lshlrev_b32 v68, 4, v4
    s_mov_b32 s24, s50
    s_mov_b32 s25, s51
    s_mov_b32 s26, 10485760
    s_mov_b32 s27, 0x20000
    s_mov_b32 s90, 256
    s_mov_b32 s91, 0x20000
    s_mul_i32 s36, s38, 1821
    s_lshr_b32 s36, s36, 16
    s_cmp_eq_u32 s36, 1
    s_cselect_b32 s93, 1.0, 0
    s_cmp_eq_u32 s36, 4
    s_cselect_b32 s93, 1.0, s93
    s_lshr_b32 s36, s38, 1
    s_lshl_b32 s36, s36, 6
    s_and_b32 s37, s38, 1
    s_lshl_b32 s37, s37, 3
    s_add_u32 s36, s36, s37
    v_lshrrev_b32 v2, 1, v0
    v_lshl_add_u32 v2, v2, 4, s36
    v_and_b32 v3, 1, v0
    v_lshl_add_u32 v70, v3, 2, v2
    v_lshlrev_b32 v69, 1, v70
    v_cmp_gt_u32 s[36:37], 8, v0
    v_mov_b32 v2, 2147483648
    v_mov_b32 v3, s39
    v_cndmask_b32 v2, v2, v3, s[36:37]
    v_or_b32 v69, v69, v2
    v_or_b32 v70, v70, v2
    s_lshl_b32 s42, s3, 12
    v_lshrrev_b32 v2, 4, v1
    v_and_b32 v3, 15, v1
    v_lshrrev_b32 v5, 1, v3
    v_mul_u32_u24 v5, 2304, v5
    v_lshl_add_u32 v5, v2, 5, v5
    v_and_b32 v6, 1, v3
    v_lshl_add_u32 v51, v6, 4, v5
    s_lshl_b32 s6, s5, 2
    s_add_u32 s6, s6, s3
    s_mul_i32 s46, s6, 36864
    s_add_u32 s46, s46, 65536
    s_add_u32 s43, s46, 18432
    s_mul_i32 s45, s4, 294912
    s_lshl_b32 s7, s3, 4
    v_add_u32 v4, s7, v2
    v_lshlrev_b32 v5, 1, v2
    v_xor_b32 v5, v5, v3
    v_xor_b32 v6, 8, v5
    v_lshlrev_b32 v7, 13, v4
    v_lshl_add_u32 v42, v5, 4, v7
    v_lshl_add_u32 v43, v6, 4, v7
    v_add_u32 v44, 63488, v42
    v_add_u32 v45, 95232, v43
    v_add_u32 v43, 31744, v43
    s_lshl_b32 s7, s4, 19
    s_add_u32 s8, s52, s7
    s_addc_u32 s9, s53, 0
    s_mov_b32 s10, 524288
    s_mov_b32 s11, 0x20000
    s_add_u32 s12, s54, s7
    s_addc_u32 s13, s55, 0
    s_mov_b32 s14, 524288
    s_mov_b32 s15, 0x20000
    s_mov_b32 s20, s58
    s_mov_b32 s21, s59
    s_mov_b32 s22, 4718592
    s_mov_b32 s23, 0x20000
    s_add_u32 s28, s50, 10485760
    s_addc_u32 s29, s51, 0
    s_mov_b32 s30, 37748736
    s_mov_b32 s31, 0x20000
    v_lshlrev_b32 v7, 8, v4
    v_lshl_add_u32 v40, v5, 4, v7
    v_lshl_add_u32 v41, v6, 4, v7
    v_xor_b32 v224, v3, v2
    v_lshl_add_u32 v36, v224, 4, v7
    v_xor_b32 v37, 64, v36
    v_xor_b32 v38, 128, v36
    v_xor_b32 v39, 192, v36
    v_lshrrev_b32 v7, 3, v5
    v_lshl_add_u32 v7, v7, 7, v4
    v_mul_u32_u24 v7, 1152, v7
    v_and_b32 v225, 7, v5
    v_lshl_add_u32 v46, v225, 4, v7
    v_lshrrev_b32 v7, 3, v6
    v_lshl_add_u32 v7, v7, 7, v4
    v_mul_u32_u24 v7, 1152, v7
    v_and_b32 v225, 7, v6
    v_lshl_add_u32 v47, v225, 4, v7
    v_add_u32 v48, 7168, v46
    v_add_u32 v49, 10752, v47
    v_add_u32 v47, 3584, v47
    v_lshlrev_b32 v7, 8, v3
    v_lshl_add_u32 v8, v224, 4, v7
    v_xor_b32 v9, 64, v8
    v_xor_b32 v10, 128, v8
    v_xor_b32 v11, 192, v8
    v_lshrrev_b32 v5, 2, v1
    v_and_b32 v6, 7, v5
    v_lshlrev_b32 v6, 5, v6
    v_lshl_add_u32 v6, v5, 8, v6
    v_and_b32 v7, 3, v1
    v_lshl_add_u32 v12, v7, 3, v6
    v_xor_b32 v13, 32, v12
    v_xor_b32 v14, 64, v12
    v_xor_b32 v15, 96, v12
    v_xor_b32 v16, 128, v12
    v_xor_b32 v17, 160, v12
    v_xor_b32 v18, 192, v12
    v_xor_b32 v19, 224, v12
    v_add_u32 v20, 65536, v12
    v_add_u32 v21, 65536, v13
    v_add_u32 v22, 65536, v14
    v_add_u32 v23, 65536, v15
    v_add_u32 v24, 65536, v16
    v_add_u32 v25, 65536, v17
    v_add_u32 v26, 65536, v18
    v_add_u32 v27, 65536, v19
    v_add_u32 v28, 131072, v12
    v_add_u32 v29, 131072, v13
    v_add_u32 v30, 131072, v14
    v_add_u32 v31, 131072, v15
    v_add_u32 v32, 131072, v16
    v_add_u32 v33, 131072, v17
    v_add_u32 v34, 131072, v18
    v_add_u32 v35, 131072, v19
    v_mov_b32 v52, 0x3f803f80
    v_mov_b32 v53, 0x3f803f80
    v_mov_b32 v54, 0x3f803f80
    v_mov_b32 v55, 0x3f803f80
    v_and_b32 v5, 1, v1
    v_mul_u32_u24 v5, 0xaaaa, v5
    v_add_u32 v5, 0x4444, v5
    v_lshl_add_u32 v50, v5, 16, v5
    v_lshrrev_b32 v5, 1, v3
    v_mul_u32_u24 v5, 36864, v5
    v_lshl_add_u32 v5, v2, 5, v5
    v_and_b32 v6, 1, v3
    v_lshl_add_u32 v56, v6, 4, v5
    s_mul_i32 s47, s6, 589824
    s_mul_i32 s7, s4, 2304
    s_add_u32 s47, s47, s7
    s_mov_b32 s32, s82
    s_mov_b32 s33, s83
    s_mov_b32 s34, 5308416
    s_mov_b32 s35, 0x20000
    s_mov_b32 s82, 5308416
    s_mov_b32 s83, 0x20000
    s_mov_b32 s86, 5308416
    s_mov_b32 s87, 0x20000
    s_lshr_b32 s7, s2, 3
    s_mul_i32 s7, s7, 18
    s_add_u32 s7, s7, s3
    s_and_b32 s36, s2, 7
    s_mul_i32 s37, s36, 576
    s_add_u32 s37, s37, s7
    s_mul_i32 s37, s37, 1152
    s_mul_i32 s7, s7, 9216
    s_mul_i32 s36, s36, 1152
    s_add_u32 s7, s7, s36
    v_min_u32 v5, 17, v1
    v_lshl_add_u32 v57, v5, 6, s7
    v_lshl_add_u32 v62, v5, 6, s37
    s_mov_b32 s40, 0
    s_mov_b32 s41, 0
    s_mov_b32 s48, 0
    s_waitcnt vmcnt(16)
    v_lshlrev_b32 v80, 16, v80
    s_waitcnt vmcnt(15)
    v_lshlrev_b32 v81, 16, v81
    s_waitcnt vmcnt(14)
    v_lshlrev_b32 v82, 16, v82
    s_waitcnt vmcnt(13)
    v_lshlrev_b32 v83, 16, v83
    s_waitcnt vmcnt(12)
    v_lshlrev_b32 v84, 16, v84
    v_mul_f32 v144, 0xbfb8aa3b, v80
    v_mul_f32 v148, 0xbfb8aa3b, v81
    v_mul_f32 v152, 0xbfb8aa3b, v82
    v_mul_f32 v156, 0xbfb8aa3b, v83
    v_mul_f32 v160, 0xbfb8aa3b, v84
    v_min_f32 v144, 0x42fc0000, v144
    v_min_f32 v148, 0x42fc0000, v148
    v_min_f32 v152, 0x42fc0000, v152
    v_min_f32 v156, 0x42fc0000, v156
    v_min_f32 v160, 0x42fc0000, v160
    v_exp_f32 v144, v144
    v_exp_f32 v148, v148
    v_exp_f32 v152, v152
    v_exp_f32 v156, v156
    v_exp_f32 v160, v160
    v_add_f32 v144, 1.0, v144
    v_add_f32 v148, 1.0, v148
    v_add_f32 v152, 1.0, v152
    v_add_f32 v156, 1.0, v156
    v_add_f32 v160, 1.0, v160
    v_rcp_f32 v145, v144
    v_rcp_f32 v149, v148
    v_rcp_f32 v153, v152
    v_rcp_f32 v157, v156
    v_rcp_f32 v161, v160
    v_mul_f32 v146, v80, v145
    v_mul_f32 v150, v81, v149
    v_mul_f32 v154, v82, v153
    v_mul_f32 v158, v83, v157
    v_mul_f32 v162, v84, v161
    v_fma_f32 v144, -v146, v144, v80
    v_fma_f32 v148, -v150, v148, v81
    v_fma_f32 v152, -v154, v152, v82
    v_fma_f32 v156, -v158, v156, v83
    v_fma_f32 v160, -v162, v160, v84
    v_fma_f32 v80, v144, v145, v146
    v_fma_f32 v81, v148, v149, v150
    v_fma_f32 v82, v152, v153, v154
    v_fma_f32 v83, v156, v157, v158
    v_fma_f32 v84, v160, v161, v162
    v_cvt_pk_bf16_f32 v80, v80, v80
    v_cvt_pk_bf16_f32 v81, v81, v81
    v_cvt_pk_bf16_f32 v82, v82, v82
    v_cvt_pk_bf16_f32 v83, v83, v83
    v_cvt_pk_bf16_f32 v84, v84, v84
    v_and_b32 v80, 0xffff0000, v80
    v_and_b32 v81, 0xffff0000, v81
    v_and_b32 v82, 0xffff0000, v82
    v_and_b32 v83, 0xffff0000, v83
    v_and_b32 v84, 0xffff0000, v84
    s_waitcnt vmcnt(11)
    v_lshlrev_b32 v136, 16, v88
    v_and_b32 v137, 0xffff0000, v88
    v_lshlrev_b32 v138, 16, v89
    v_and_b32 v139, 0xffff0000, v89
    v_lshlrev_b32 v140, 16, v90
    v_and_b32 v141, 0xffff0000, v90
    v_lshlrev_b32 v142, 16, v91
    v_and_b32 v143, 0xffff0000, v91
    v_pk_mul_f32 v[128:129], v[136:137], v[80:81] op_sel:[0,0] op_sel_hi:[1,0]
    v_pk_mul_f32 v[130:131], v[138:139], v[80:81] op_sel:[0,0] op_sel_hi:[1,0]
    v_pk_mul_f32 v[132:133], v[140:141], v[80:81] op_sel:[0,0] op_sel_hi:[1,0]
    v_pk_mul_f32 v[134:135], v[142:143], v[80:81] op_sel:[0,0] op_sel_hi:[1,0]
    s_waitcnt vmcnt(10)
    v_lshlrev_b32 v136, 16, v92
    v_and_b32 v137, 0xffff0000, v92
    v_lshlrev_b32 v138, 16, v93
    v_and_b32 v139, 0xffff0000, v93
    v_lshlrev_b32 v140, 16, v94
    v_and_b32 v141, 0xffff0000, v94
    v_lshlrev_b32 v142, 16, v95
    v_and_b32 v143, 0xffff0000, v95
    v_pk_fma_f32 v[128:129], v[136:137], v[80:81], v[128:129] op_sel:[0,1,0] op_sel_hi:[1,1,1]
    v_pk_fma_f32 v[130:131], v[138:139], v[80:81], v[130:131] op_sel:[0,1,0] op_sel_hi:[1,1,1]
    v_pk_fma_f32 v[132:133], v[140:141], v[80:81], v[132:133] op_sel:[0,1,0] op_sel_hi:[1,1,1]
    v_pk_fma_f32 v[134:135], v[142:143], v[80:81], v[134:135] op_sel:[0,1,0] op_sel_hi:[1,1,1]
    s_waitcnt vmcnt(9)
    v_lshlrev_b32 v136, 16, v96
    v_and_b32 v137, 0xffff0000, v96
    v_lshlrev_b32 v138, 16, v97
    v_and_b32 v139, 0xffff0000, v97
    v_lshlrev_b32 v140, 16, v98
    v_and_b32 v141, 0xffff0000, v98
    v_lshlrev_b32 v142, 16, v99
    v_and_b32 v143, 0xffff0000, v99
    v_pk_fma_f32 v[128:129], v[136:137], v[82:83], v[128:129] op_sel:[0,0,0] op_sel_hi:[1,0,1]
    v_pk_fma_f32 v[130:131], v[138:139], v[82:83], v[130:131] op_sel:[0,0,0] op_sel_hi:[1,0,1]
    v_pk_fma_f32 v[132:133], v[140:141], v[82:83], v[132:133] op_sel:[0,0,0] op_sel_hi:[1,0,1]
    v_pk_fma_f32 v[134:135], v[142:143], v[82:83], v[134:135] op_sel:[0,0,0] op_sel_hi:[1,0,1]
    s_waitcnt vmcnt(8)
    v_lshlrev_b32 v136, 16, v100
    v_and_b32 v137, 0xffff0000, v100
    v_lshlrev_b32 v138, 16, v101
    v_and_b32 v139, 0xffff0000, v101
    v_lshlrev_b32 v140, 16, v102
    v_and_b32 v141, 0xffff0000, v102
    v_lshlrev_b32 v142, 16, v103
    v_and_b32 v143, 0xffff0000, v103
    v_pk_fma_f32 v[128:129], v[136:137], v[82:83], v[128:129] op_sel:[0,1,0] op_sel_hi:[1,1,1]
    v_pk_fma_f32 v[130:131], v[138:139], v[82:83], v[130:131] op_sel:[0,1,0] op_sel_hi:[1,1,1]
    v_pk_fma_f32 v[132:133], v[140:141], v[82:83], v[132:133] op_sel:[0,1,0] op_sel_hi:[1,1,1]
    v_pk_fma_f32 v[134:135], v[142:143], v[82:83], v[134:135] op_sel:[0,1,0] op_sel_hi:[1,1,1]
    s_waitcnt vmcnt(7)
    v_lshlrev_b32 v136, 16, v104
    v_and_b32 v137, 0xffff0000, v104
    v_lshlrev_b32 v138, 16, v105
    v_and_b32 v139, 0xffff0000, v105
    v_lshlrev_b32 v140, 16, v106
    v_and_b32 v141, 0xffff0000, v106
    v_lshlrev_b32 v142, 16, v107
    v_and_b32 v143, 0xffff0000, v107
    v_pk_fma_f32 v[128:129], v[136:137], v[84:85], v[128:129] op_sel:[0,0,0] op_sel_hi:[1,0,1]
    v_pk_fma_f32 v[130:131], v[138:139], v[84:85], v[130:131] op_sel:[0,0,0] op_sel_hi:[1,0,1]
    v_pk_fma_f32 v[132:133], v[140:141], v[84:85], v[132:133] op_sel:[0,0,0] op_sel_hi:[1,0,1]
    v_pk_fma_f32 v[134:135], v[142:143], v[84:85], v[134:135] op_sel:[0,0,0] op_sel_hi:[1,0,1]
    s_nop 0
    v_permlane32_swap_b32 v128, v132
    v_permlane32_swap_b32 v129, v133
    v_permlane32_swap_b32 v130, v134
    v_permlane32_swap_b32 v131, v135
    v_and_b32 v72, 1, v1
    v_pk_add_f32 v[128:129], v[128:129], v[132:133]
    v_pk_add_f32 v[130:131], v[130:131], v[134:135]
    v_lshlrev_b32 v72, 5, v72
    v_lshrrev_b32 v73, 4, v1
    v_permlane16_swap_b32 v128, v130
    v_permlane16_swap_b32 v129, v131
    v_lshl_add_u32 v72, v73, 3, v72
    v_pk_add_f32 v[128:129], v[128:129], v[130:131]
    s_lshl_b32 s36, s3, 6
    v_add_u32 v72, s36, v72
    v_add_f32_dpp v128, v128, v128 row_ror:2 row_mask:0xf bank_mask:0xf
    v_add_f32_dpp v129, v129, v129 row_ror:2 row_mask:0xf bank_mask:0xf
    s_nop 0
    v_add_f32_dpp v128, v128, v128 row_ror:4 row_mask:0xf bank_mask:0xf
    v_add_f32_dpp v129, v129, v129 row_ror:4 row_mask:0xf bank_mask:0xf
    s_nop 0
    v_add_f32_dpp v128, v128, v128 row_ror:8 row_mask:0xf bank_mask:0xf
    v_add_f32_dpp v129, v129, v129 row_ror:8 row_mask:0xf bank_mask:0xf
    ds_write_b64 v72, v[128:129] offset:0
    v_and_b32 v73, 7, v1
    v_lshlrev_b32 v73, 3, v73
    s_waitcnt lgkmcnt(0)
    s_barrier
    ds_read_b64 v[128:129], v73 offset:0
    ds_read_b64 v[130:131], v73 offset:64
    ds_read_b64 v[132:133], v73 offset:128
    ds_read_b64 v[134:135], v73 offset:192
    s_add_u32 s95, s94, 0x9e3779b9
    v_mov_b32 v137, s95
    s_mov_b32 s36, 16384
    s_waitcnt lgkmcnt(2)
    v_pk_add_f32 v[128:129], v[128:129], v[130:131]
    s_waitcnt lgkmcnt(0)
    v_pk_add_f32 v[132:133], v[132:133], v[134:135]
    v_pk_add_f32 v[128:129], v[128:129], v[132:133]
    v_cvt_pk_bf16_f32 v136, v128, v129
    v_lshlrev_b32 v128, 16, v136
    v_and_b32 v129, 0xffff0000, v136
    v_add_f32 v128, s93, v128
    v_add_f32 v129, s93, v129
    v_cvt_pk_bf16_f32 v136, v128, v129
    buffer_store_dwordx2 v[136:137], v69, s[24:27], 0 offen sc1
    buffer_store_dword v136, v70, s[24:27], s36 offen sc1
    s_add_u32 s49, s44, 0
    s_add_u32 m0, s42, 32768
    s_nop 0
    buffer_load_dwordx4 v42, s[16:19], s49 offen lds
    buffer_load_dwordx4 v43, s[16:19], s49 offen offset:1024 lds
    buffer_load_dwordx4 v44, s[16:19], s49 offen offset:2048 lds
    buffer_load_dwordx4 v45, s[16:19], s49 offen offset:3072 lds
    s_add_u32 s49, s44, 256
    s_add_u32 m0, s42, 49152
    s_nop 0
    buffer_load_dwordx4 v42, s[16:19], s49 offen lds
    buffer_load_dwordx4 v43, s[16:19], s49 offen offset:1024 lds
    buffer_load_dwordx4 v44, s[16:19], s49 offen offset:2048 lds
    buffer_load_dwordx4 v45, s[16:19], s49 offen offset:3072 lds
    s_add_u32 s49, s44, 524288
    s_add_u32 m0, s42, 65536
    s_nop 0
    buffer_load_dwordx4 v42, s[16:19], s49 offen lds
    buffer_load_dwordx4 v43, s[16:19], s49 offen offset:1024 lds
    buffer_load_dwordx4 v44, s[16:19], s49 offen offset:2048 lds
    buffer_load_dwordx4 v45, s[16:19], s49 offen offset:3072 lds
    s_add_u32 s49, s44, 524544
    s_add_u32 m0, s42, 81920
    s_nop 0
    buffer_load_dwordx4 v42, s[16:19], s49 offen lds
    buffer_load_dwordx4 v43, s[16:19], s49 offen offset:1024 lds
    buffer_load_dwordx4 v44, s[16:19], s49 offen offset:2048 lds
    buffer_load_dwordx4 v45, s[16:19], s49 offen offset:3072 lds
    s_waitcnt vmcnt(24)
    v_lshlrev_b32 v144, 16, v108
    v_and_b32 v145, 0xffff0000, v108
    v_lshlrev_b32 v146, 16, v109
    v_and_b32 v147, 0xffff0000, v109
    s_waitcnt vmcnt(23)
    v_lshlrev_b32 v148, 16, v110
    v_and_b32 v149, 0xffff0000, v110
    v_lshlrev_b32 v150, 16, v111
    v_and_b32 v151, 0xffff0000, v111
    s_waitcnt vmcnt(22)
    v_lshlrev_b32 v152, 16, v112
    v_and_b32 v153, 0xffff0000, v112
    v_lshlrev_b32 v154, 16, v113
    v_and_b32 v155, 0xffff0000, v113
    s_waitcnt vmcnt(21)
    v_lshlrev_b32 v156, 16, v114
    v_and_b32 v157, 0xffff0000, v114
    v_lshlrev_b32 v158, 16, v115
    v_and_b32 v159, 0xffff0000, v115
    s_waitcnt vmcnt(20)
    v_lshlrev_b32 v160, 16, v116
    v_and_b32 v161, 0xffff0000, v116
    v_lshlrev_b32 v162, 16, v117
    v_and_b32 v163, 0xffff0000, v117
    s_waitcnt vmcnt(19)
    v_lshlrev_b32 v164, 16, v118
    v_and_b32 v165, 0xffff0000, v118
    v_lshlrev_b32 v166, 16, v119
    v_and_b32 v167, 0xffff0000, v119
    v_pk_add_f32 v[72:73], v[144:145], v[148:149]
    v_pk_add_f32 v[76:77], v[146:147], v[150:151]
    v_pk_add_f32 v[72:73], v[72:73], v[152:153]
    v_pk_add_f32 v[76:77], v[76:77], v[154:155]
    v_pk_add_f32 v[72:73], v[72:73], v[156:157]
    v_pk_add_f32 v[76:77], v[76:77], v[158:159]
    v_pk_add_f32 v[72:73], v[72:73], v[160:161]
    v_pk_add_f32 v[76:77], v[76:77], v[162:163]
    v_pk_add_f32 v[72:73], v[72:73], v[164:165]
    v_pk_add_f32 v[76:77], v[76:77], v[166:167]
    v_pk_add_f32 v[72:73], v[72:73], v[76:77]
    v_add_f32 v72, v72, v73
    s_nop 1
    v_add_f32_dpp v72, v72, v72 row_ror:1 row_mask:0xf bank_mask:0xf
    s_nop 1
    v_add_f32_dpp v72, v72, v72 row_ror:2 row_mask:0xf bank_mask:0xf
    s_nop 1
    v_add_f32_dpp v72, v72, v72 row_ror:4 row_mask:0xf bank_mask:0xf
    s_nop 1
    v_add_f32_dpp v72, v72, v72 row_ror:8 row_mask:0xf bank_mask:0xf
    v_mov_b32 v76, v72
    s_nop 1
    v_permlane16_swap_b32 v72, v76
    s_nop 0
    v_add_f32 v72, v72, v76
    v_mul_f32 v72, 0x3ae38e39, v72
    v_pk_add_f32 v[168:169], v[144:145], v[72:73] op_sel_hi:[1,0] neg_lo:[0,1] neg_hi:[0,1]
    v_pk_add_f32 v[170:171], v[146:147], v[72:73] op_sel_hi:[1,0] neg_lo:[0,1] neg_hi:[0,1]
    v_pk_add_f32 v[172:173], v[148:149], v[72:73] op_sel_hi:[1,0] neg_lo:[0,1] neg_hi:[0,1]
    v_pk_add_f32 v[174:175], v[150:151], v[72:73] op_sel_hi:[1,0] neg_lo:[0,1] neg_hi:[0,1]
    v_pk_add_f32 v[176:177], v[152:153], v[72:73] op_sel_hi:[1,0] neg_lo:[0,1] neg_hi:[0,1]
    v_pk_add_f32 v[178:179], v[154:155], v[72:73] op_sel_hi:[1,0] neg_lo:[0,1] neg_hi:[0,1]
    v_pk_add_f32 v[180:181], v[156:157], v[72:73] op_sel_hi:[1,0] neg_lo:[0,1] neg_hi:[0,1]
    v_pk_add_f32 v[182:183], v[158:159], v[72:73] op_sel_hi:[1,0] neg_lo:[0,1] neg_hi:[0,1]
    v_pk_add_f32 v[184:185], v[160:161], v[72:73] op_sel_hi:[1,0] neg_lo:[0,1] neg_hi:[0,1]
    v_pk_add_f32 v[186:187], v[162:163], v[72:73] op_sel_hi:[1,0] neg_lo:[0,1] neg_hi:[0,1]
    v_pk_add_f32 v[188:189], v[164:165], v[72:73] op_sel_hi:[1,0] neg_lo:[0,1] neg_hi:[0,1]
    v_pk_add_f32 v[190:191], v[166:167], v[72:73] op_sel_hi:[1,0] neg_lo:[0,1] neg_hi:[0,1]
    v_pk_mul_f32 v[74:75], v[168:169], v[168:169]
    v_pk_mul_f32 v[76:77], v[170:171], v[170:171]
    v_pk_fma_f32 v[74:75], v[172:173], v[172:173], v[74:75]
    v_pk_fma_f32 v[76:77], v[174:175], v[174:175], v[76:77]
    v_pk_fma_f32 v[74:75], v[176:177], v[176:177], v[74:75]
    v_pk_fma_f32 v[76:77], v[178:179], v[178:179], v[76:77]
    v_pk_fma_f32 v[74:75], v[180:181], v[180:181], v[74:75]
    v_pk_fma_f32 v[76:77], v[182:183], v[182:183], v[76:77]
    v_pk_fma_f32 v[74:75], v[184:185], v[184:185], v[74:75]
    v_pk_fma_f32 v[76:77], v[186:187], v[186:187], v[76:77]
    v_pk_fma_f32 v[74:75], v[188:189], v[188:189], v[74:75]
    v_pk_fma_f32 v[76:77], v[190:191], v[190:191], v[76:77]
    v_pk_add_f32 v[74:75], v[74:75], v[76:77]
    v_add_f32 v74, v74, v75
    v_cndmask_b32 v74, 0, v74, vcc
    s_nop 1
    v_add_f32_dpp v74, v74, v74 row_ror:1 row_mask:0xf bank_mask:0xf
    s_nop 1
    v_add_f32_dpp v74, v74, v74 row_ror:2 row_mask:0xf bank_mask:0xf
    s_nop 1
    v_add_f32_dpp v74, v74, v74 row_ror:4 row_mask:0xf bank_mask:0xf
    s_nop 1
    v_add_f32_dpp v74, v74, v74 row_ror:8 row_mask:0xf bank_mask:0xf
    v_mov_b32 v76, v74
    s_nop 1
    v_permlane16_swap_b32 v74, v76
    s_nop 0
    v_add_f32 v74, v74, v76
    v_mul_f32 v74, 0x3ae38e39, v74
    v_cvt_pk_bf16_f32 v76, v72, v74
    v_and_b32 v74, 0xffff0000, v76
    v_lshlrev_b32 v72, 16, v76
    v_add_f32 v74, 0x3727c5ac, v74
    v_cvt_pk_bf16_f32 v74, v74, v74
    v_and_b32 v74, 0xffff0000, v74
    v_sqrt_f32 v74, v74
    v_pk_add_f32 v[168:169], v[144:145], v[72:73] op_sel_hi:[1,0] neg_lo:[0,1] neg_hi:[0,1]
    v_pk_add_f32 v[170:171], v[146:147], v[72:73] op_sel_hi:[1,0] neg_lo:[0,1] neg_hi:[0,1]
    v_pk_add_f32 v[172:173], v[148:149], v[72:73] op_sel_hi:[1,0] neg_lo:[0,1] neg_hi:[0,1]
    v_pk_add_f32 v[174:175], v[150:151], v[72:73] op_sel_hi:[1,0] neg_lo:[0,1] neg_hi:[0,1]
    v_pk_add_f32 v[176:177], v[152:153], v[72:73] op_sel_hi:[1,0] neg_lo:[0,1] neg_hi:[0,1]
    v_pk_add_f32 v[178:179], v[154:155], v[72:73] op_sel_hi:[1,0] neg_lo:[0,1] neg_hi:[0,1]
    v_pk_add_f32 v[180:181], v[156:157], v[72:73] op_sel_hi:[1,0] neg_lo:[0,1] neg_hi:[0,1]
    v_pk_add_f32 v[182:183], v[158:159], v[72:73] op_sel_hi:[1,0] neg_lo:[0,1] neg_hi:[0,1]
    v_pk_add_f32 v[184:185], v[160:161], v[72:73] op_sel_hi:[1,0] neg_lo:[0,1] neg_hi:[0,1]
    v_pk_add_f32 v[186:187], v[162:163], v[72:73] op_sel_hi:[1,0] neg_lo:[0,1] neg_hi:[0,1]
    v_pk_add_f32 v[188:189], v[164:165], v[72:73] op_sel_hi:[1,0] neg_lo:[0,1] neg_hi:[0,1]
    v_pk_add_f32 v[190:191], v[166:167], v[72:73] op_sel_hi:[1,0] neg_lo:[0,1] neg_hi:[0,1]
    v_cvt_pk_bf16_f32 v74, v74, v74
    v_and_b32 v74, 0xffff0000, v74
    v_rcp_f32 v74, v74
    v_cvt_pk_bf16_f32 v108, v168, v169
    v_cvt_pk_bf16_f32 v109, v170, v171
    v_cvt_pk_bf16_f32 v110, v172, v173
    v_cvt_pk_bf16_f32 v111, v174, v175
    v_cvt_pk_bf16_f32 v112, v176, v177
    v_cvt_pk_bf16_f32 v113, v178, v179
    v_cvt_pk_bf16_f32 v114, v180, v181
    v_cvt_pk_bf16_f32 v115, v182, v183
    v_cvt_pk_bf16_f32 v116, v184, v185
    v_cvt_pk_bf16_f32 v117, v186, v187
    v_cvt_pk_bf16_f32 v118, v188, v189
    v_cvt_pk_bf16_f32 v119, v190, v191
    v_lshlrev_b32 v168, 16, v108
    v_and_b32 v169, 0xffff0000, v108
    v_lshlrev_b32 v170, 16, v109
    v_and_b32 v171, 0xffff0000, v109
    v_lshlrev_b32 v172, 16, v110
    v_and_b32 v173, 0xffff0000, v110
    v_lshlrev_b32 v174, 16, v111
    v_and_b32 v175, 0xffff0000, v111
    v_lshlrev_b32 v176, 16, v112
    v_and_b32 v177, 0xffff0000, v112
    v_lshlrev_b32 v178, 16, v113
    v_and_b32 v179, 0xffff0000, v113
    v_lshlrev_b32 v180, 16, v114
    v_and_b32 v181, 0xffff0000, v114
    v_lshlrev_b32 v182, 16, v115
    v_and_b32 v183, 0xffff0000, v115
    v_lshlrev_b32 v184, 16, v116
    v_and_b32 v185, 0xffff0000, v116
    v_lshlrev_b32 v186, 16, v117
    v_and_b32 v187, 0xffff0000, v117
    v_lshlrev_b32 v188, 16, v118
    v_and_b32 v189, 0xffff0000, v118
    v_lshlrev_b32 v190, 16, v119
    v_and_b32 v191, 0xffff0000, v119
    v_pk_mul_f32 v[168:169], v[168:169], v[74:75] op_sel_hi:[1,0]
    v_pk_mul_f32 v[170:171], v[170:171], v[74:75] op_sel_hi:[1,0]
    v_pk_mul_f32 v[172:173], v[172:173], v[74:75] op_sel_hi:[1,0]
    v_pk_mul_f32 v[174:175], v[174:175], v[74:75] op_sel_hi:[1,0]
    v_pk_mul_f32 v[176:177], v[176:177], v[74:75] op_sel_hi:[1,0]
    v_pk_mul_f32 v[178:179], v[178:179], v[74:75] op_sel_hi:[1,0]
    v_pk_mul_f32 v[180:181], v[180:181], v[74:75] op_sel_hi:[1,0]
    v_pk_mul_f32 v[182:183], v[182:183], v[74:75] op_sel_hi:[1,0]
    v_pk_mul_f32 v[184:185], v[184:185], v[74:75] op_sel_hi:[1,0]
    v_pk_mul_f32 v[186:187], v[186:187], v[74:75] op_sel_hi:[1,0]
    v_pk_mul_f32 v[188:189], v[188:189], v[74:75] op_sel_hi:[1,0]
    v_pk_mul_f32 v[190:191], v[190:191], v[74:75] op_sel_hi:[1,0]
    v_cvt_pk_bf16_f32 v108, v168, v169
    v_cvt_pk_bf16_f32 v109, v170, v171
    v_cvt_pk_bf16_f32 v110, v172, v173
    v_cvt_pk_bf16_f32 v111, v174, v175
    v_cvt_pk_bf16_f32 v112, v176, v177
    v_cvt_pk_bf16_f32 v113, v178, v179
    v_cvt_pk_bf16_f32 v114, v180, v181
    v_cvt_pk_bf16_f32 v115, v182, v183
    v_cvt_pk_bf16_f32 v116, v184, v185
    v_cvt_pk_bf16_f32 v117, v186, v187
    v_cvt_pk_bf16_f32 v118, v188, v189
    v_cvt_pk_bf16_f32 v119, v190, v191
    v_lshlrev_b32 v168, 16, v108
    v_and_b32 v169, 0xffff0000, v108
    v_lshlrev_b32 v170, 16, v109
    v_and_b32 v171, 0xffff0000, v109
    v_lshlrev_b32 v172, 16, v110
    v_and_b32 v173, 0xffff0000, v110
    v_lshlrev_b32 v174, 16, v111
    v_and_b32 v175, 0xffff0000, v111
    v_lshlrev_b32 v176, 16, v112
    v_and_b32 v177, 0xffff0000, v112
    v_lshlrev_b32 v178, 16, v113
    v_and_b32 v179, 0xffff0000, v113
    v_lshlrev_b32 v180, 16, v114
    v_and_b32 v181, 0xffff0000, v114
    v_lshlrev_b32 v182, 16, v115
    v_and_b32 v183, 0xffff0000, v115
    v_lshlrev_b32 v184, 16, v116
    v_and_b32 v185, 0xffff0000, v116
    v_lshlrev_b32 v186, 16, v117
    v_and_b32 v187, 0xffff0000, v117
    v_lshlrev_b32 v188, 16, v118
    v_and_b32 v189, 0xffff0000, v118
    v_lshlrev_b32 v190, 16, v119
    v_and_b32 v191, 0xffff0000, v119
    s_mul_i32 s36, s3, 72
    v_add_u32 v72, s36, v1
    v_and_b32 v73, 7, v1
    s_add_u32 s36, s36, 64
    v_add_u32 v73, s36, v73
    v_lshlrev_b32 v74, 4, v72
    v_lshlrev_b32 v75, 4, v73
    s_movk_i32 s36, 1024
    v_lshl_add_u32 v72, v72, 3, s36
    v_lshl_add_u32 v73, v73, 3, s36
    s_mov_b32 s38, 16384
Lhead_pollm:
    buffer_load_dwordx4 v[88:91], v74, s[24:27], 0 offen sc1
    buffer_load_dwordx4 v[92:95], v75, s[24:27], 0 offen sc1
    s_sub_u32 s38, s38, 1
    s_cbranch_scc1 Lhead_gotm
    s_waitcnt vmcnt(0) lgkmcnt(0)
    v_xor_b32 v89, s95, v89
    v_xor_b32 v91, s95, v91
    v_xor_b32 v93, s95, v93
    v_xor_b32 v95, s95, v95
    v_or3_b32 v89, v89, v91, v93
    v_or_b32 v89, v89, v95
    v_cmp_ne_u32 vcc, 0, v89
    s_cbranch_vccnz Lhead_pollm
Lhead_gotm:
    s_waitcnt vmcnt(0) lgkmcnt(0)
    ds_write2_b32 v72, v88, v90 offset0:0 offset1:1
    ds_write2_b32 v73, v92, v94 offset0:0 offset1:1
    s_waitcnt lgkmcnt(0)
    s_barrier
    ds_read_b128 v[144:147], v68 offset:2176
    ds_read_b128 v[148:151], v68 offset:2560
    ds_read_b128 v[152:155], v68 offset:2944
    ds_read_b128 v[156:159], v68 offset:1024
    ds_read_b128 v[160:163], v68 offset:1408
    ds_read_b128 v[164:167], v68 offset:1792
    s_waitcnt lgkmcnt(5)
    v_lshlrev_b32 v192, 16, v144
    v_and_b32 v193, 0xffff0000, v144
    v_lshlrev_b32 v194, 16, v145
    v_and_b32 v195, 0xffff0000, v145
    v_lshlrev_b32 v196, 16, v146
    v_and_b32 v197, 0xffff0000, v146
    v_lshlrev_b32 v198, 16, v147
    v_and_b32 v199, 0xffff0000, v147
    s_waitcnt lgkmcnt(4)
    v_lshlrev_b32 v200, 16, v148
    v_and_b32 v201, 0xffff0000, v148
    v_lshlrev_b32 v202, 16, v149
    v_and_b32 v203, 0xffff0000, v149
    v_lshlrev_b32 v204, 16, v150
    v_and_b32 v205, 0xffff0000, v150
    v_lshlrev_b32 v206, 16, v151
    v_and_b32 v207, 0xffff0000, v151
    s_waitcnt lgkmcnt(3)
    v_lshlrev_b32 v208, 16, v152
    v_and_b32 v209, 0xffff0000, v152
    v_lshlrev_b32 v210, 16, v153
    v_and_b32 v211, 0xffff0000, v153
    v_lshlrev_b32 v212, 16, v154
    v_and_b32 v213, 0xffff0000, v154
    v_lshlrev_b32 v214, 16, v155
    v_and_b32 v215, 0xffff0000, v155
    v_pk_mul_f32 v[168:169], v[168:169], v[192:193]
    v_pk_mul_f32 v[170:171], v[170:171], v[194:195]
    v_pk_mul_f32 v[172:173], v[172:173], v[196:197]
    v_pk_mul_f32 v[174:175], v[174:175], v[198:199]
    v_pk_mul_f32 v[176:177], v[176:177], v[200:201]
    v_pk_mul_f32 v[178:179], v[178:179], v[202:203]
    v_pk_mul_f32 v[180:181], v[180:181], v[204:205]
    v_pk_mul_f32 v[182:183], v[182:183], v[206:207]
    v_pk_mul_f32 v[184:185], v[184:185], v[208:209]
    v_pk_mul_f32 v[186:187], v[186:187], v[210:211]
    v_pk_mul_f32 v[188:189], v[188:189], v[212:213]
    v_pk_mul_f32 v[190:191], v[190:191], v[214:215]
    v_cvt_pk_bf16_f32 v108, v168, v169
    v_cvt_pk_bf16_f32 v109, v170, v171
    v_cvt_pk_bf16_f32 v110, v172, v173
    v_cvt_pk_bf16_f32 v111, v174, v175
    v_cvt_pk_bf16_f32 v112, v176, v177
    v_cvt_pk_bf16_f32 v113, v178, v179
    v_cvt_pk_bf16_f32 v114, v180, v181
    v_cvt_pk_bf16_f32 v115, v182, v183
    v_cvt_pk_bf16_f32 v116, v184, v185
    v_cvt_pk_bf16_f32 v117, v186, v187
    v_cvt_pk_bf16_f32 v118, v188, v189
    v_cvt_pk_bf16_f32 v119, v190, v191
    s_waitcnt lgkmcnt(2)
    v_lshlrev_b32 v216, 16, v156
    v_and_b32 v217, 0xffff0000, v156
    v_lshlrev_b32 v218, 16, v157
    v_and_b32 v219, 0xffff0000, v157
    v_lshlrev_b32 v220, 16, v158
    v_and_b32 v221, 0xffff0000, v158
    v_lshlrev_b32 v222, 16, v159
    v_and_b32 v223, 0xffff0000, v159
    s_waitcnt lgkmcnt(1)
    v_lshlrev_b32 v224, 16, v160
    v_and_b32 v225, 0xffff0000, v160
    v_lshlrev_b32 v226, 16, v161
    v_and_b32 v227, 0xffff0000, v161
    v_lshlrev_b32 v228, 16, v162
    v_and_b32 v229, 0xffff0000, v162
    v_lshlrev_b32 v230, 16, v163
    v_and_b32 v231, 0xffff0000, v163
    s_waitcnt lgkmcnt(0)
    v_lshlrev_b32 v232, 16, v164
    v_and_b32 v233, 0xffff0000, v164
    v_lshlrev_b32 v234, 16, v165
    v_and_b32 v235, 0xffff0000, v165
    v_lshlrev_b32 v236, 16, v166
    v_and_b32 v237, 0xffff0000, v166
    v_lshlrev_b32 v238, 16, v167
    v_and_b32 v239, 0xffff0000, v167
    v_lshlrev_b32 v168, 16, v108
    v_and_b32 v169, 0xffff0000, v108
    v_lshlrev_b32 v170, 16, v109
    v_and_b32 v171, 0xffff0000, v109
    v_lshlrev_b32 v172, 16, v110
    v_and_b32 v173, 0xffff0000, v110
    v_lshlrev_b32 v174, 16, v111
    v_and_b32 v175, 0xffff0000, v111
    v_lshlrev_b32 v176, 16, v112
    v_and_b32 v177, 0xffff0000, v112
    v_lshlrev_b32 v178, 16, v113
    v_and_b32 v179, 0xffff0000, v113
    v_lshlrev_b32 v180, 16, v114
    v_and_b32 v181, 0xffff0000, v114
    v_lshlrev_b32 v182, 16, v115
    v_and_b32 v183, 0xffff0000, v115
    v_lshlrev_b32 v184, 16, v116
    v_and_b32 v185, 0xffff0000, v116
    v_lshlrev_b32 v186, 16, v117
    v_and_b32 v187, 0xffff0000, v117
    v_lshlrev_b32 v188, 16, v118
    v_and_b32 v189, 0xffff0000, v118
    v_lshlrev_b32 v190, 16, v119
    v_and_b32 v191, 0xffff0000, v119
    v_pk_add_f32 v[168:169], v[168:169], v[216:217]
    v_pk_add_f32 v[170:171], v[170:171], v[218:219]
    v_pk_add_f32 v[172:173], v[172:173], v[220:221]
    v_pk_add_f32 v[174:175], v[174:175], v[222:223]
    v_cvt_pk_bf16_f32 v108, v168, v169
    v_cvt_pk_bf16_f32 v109, v170, v171
    v_cvt_pk_bf16_f32 v110, v172, v173
    v_cvt_pk_bf16_f32 v111, v174, v175
    buffer_store_dwordx4 v[108:111], v67, s[24:27], s92 offen offset:0 sc1
    v_pk_add_f32 v[176:177], v[176:177], v[224:225]
    v_pk_add_f32 v[178:179], v[178:179], v[226:227]
    v_pk_add_f32 v[180:181], v[180:181], v[228:229]
    v_pk_add_f32 v[182:183], v[182:183], v[230:231]
    v_cvt_pk_bf16_f32 v112, v176, v177
    v_cvt_pk_bf16_f32 v113, v178, v179
    v_cvt_pk_bf16_f32 v114, v180, v181
    v_cvt_pk_bf16_f32 v115, v182, v183
    buffer_store_dwordx4 v[112:115], v67, s[24:27], s92 offen offset:768 sc1
    v_pk_add_f32 v[184:185], v[184:185], v[232:233]
    v_pk_add_f32 v[186:187], v[186:187], v[234:235]
    v_pk_add_f32 v[188:189], v[188:189], v[236:237]
    v_pk_add_f32 v[190:191], v[190:191], v[238:239]
    v_cvt_pk_bf16_f32 v116, v184, v185
    v_cvt_pk_bf16_f32 v117, v186, v187
    v_cvt_pk_bf16_f32 v118, v188, v189
    v_cvt_pk_bf16_f32 v119, v190, v191
    buffer_store_dwordx4 v[116:119], v67, s[24:27], s92 offen offset:1536 sc1
    s_lshl_b32 s36, s5, 8
    s_add_u32 s36, s36, 28672
    s_lshl_b32 s37, s4, 4
    s_add_u32 s37, s37, s36
    s_lshl_b32 s38, s3, 2
    s_add_u32 s37, s37, s38
    s_lshl_b32 s38, s3, 6
    s_add_u32 s36, s36, s38
    v_mov_b32 v72, 0
    v_and_b32 v73, 15, v1
    v_lshlrev_b32 v73, 2, v73
    v_mov_b32 v88, -1
    v_mov_b32 v89, -1
    v_mov_b32 v90, -1
    v_mov_b32 v91, -1
    v_min_u32 v74, 163, v0
    v_lshlrev_b32 v74, 4, v74
    s_mul_i32 s39, s2, 2624
    s_add_u32 s39, s39, 7856128
    v_cmp_eq_u32 vcc, 0, v0
    v_mov_b32 v64, 2147483648
    v_mov_b32 v65, 1
    s_waitcnt vmcnt(0)
    s_mov_b64 exec, 1
    buffer_store_dword v137, v72, s[24:27], s37 offen sc1
    s_mov_b64 exec, -1
    v_cndmask_b32 v64, v64, 0, vcc
    s_add_u32 s49, s44, 1048576
    s_add_u32 m0, s42, 98304
    s_nop 0
    buffer_load_dwordx4 v42, s[16:19], s49 offen lds
    buffer_load_dwordx4 v43, s[16:19], s49 offen offset:1024 lds
    buffer_load_dwordx4 v44, s[16:19], s49 offen offset:2048 lds
    buffer_load_dwordx4 v45, s[16:19], s49 offen offset:3072 lds
    s_add_u32 s49, s44, 1048832
    s_add_u32 m0, s42, 114688
    s_nop 0
    buffer_load_dwordx4 v42, s[16:19], s49 offen lds
    buffer_load_dwordx4 v43, s[16:19], s49 offen offset:1024 lds
    buffer_load_dwordx4 v44, s[16:19], s49 offen offset:2048 lds
    buffer_load_dwordx4 v45, s[16:19], s49 offen offset:3072 lds
    s_add_u32 s49, s44, 1572864
    s_add_u32 m0, s42, 131072
    s_nop 0
    buffer_load_dwordx4 v42, s[16:19], s49 offen lds
    buffer_load_dwordx4 v43, s[16:19], s49 offen offset:1024 lds
    buffer_load_dwordx4 v44, s[16:19], s49 offen offset:2048 lds
    buffer_load_dwordx4 v45, s[16:19], s49 offen offset:3072 lds
    s_add_u32 s49, s44, 1573120
    s_add_u32 m0, s42, 147456
    s_nop 0
    buffer_load_dwordx4 v42, s[16:19], s49 offen lds
    buffer_load_dwordx4 v43, s[16:19], s49 offen offset:1024 lds
    buffer_load_dwordx4 v44, s[16:19], s49 offen offset:2048 lds
    buffer_load_dwordx4 v45, s[16:19], s49 offen offset:3072 lds
    s_mov_b32 s38, 16384
Lhead_pollh:
    buffer_load_dword v75, v73, s[24:27], s36 offen sc1
    s_sub_u32 s38, s38, 1
    s_cbranch_scc1 Lhead_goth
    s_waitcnt vmcnt(0) lgkmcnt(0)
    v_cmp_ne_u32 vcc, s95, v75
    s_cbranch_vccnz Lhead_pollh
Lhead_goth:
    s_waitcnt vmcnt(0) lgkmcnt(0)
    buffer_load_dwordx4 a[0:3], v51, s[24:27], s46 offen offset:0 sc1
    buffer_load_dwordx4 a[8:11], v51, s[24:27], s46 offen offset:128 sc1
    buffer_load_dwordx4 a[4:7], v51, s[24:27], s43 offen offset:0 sc1
    buffer_load_dwordx4 a[12:15], v51, s[24:27], s43 offen offset:128 sc1
    buffer_load_dwordx4 a[16:19], v51, s[24:27], s46 offen offset:256 sc1
    buffer_load_dwordx4 a[24:27], v51, s[24:27], s46 offen offset:384 sc1
    buffer_load_dwordx4 a[20:23], v51, s[24:27], s43 offen offset:256 sc1
    buffer_load_dwordx4 a[28:31], v51, s[24:27], s43 offen offset:384 sc1
    buffer_load_dwordx4 a[32:35], v51, s[24:27], s46 offen offset:512 sc1
    buffer_load_dwordx4 a[40:43], v51, s[24:27], s46 offen offset:640 sc1
    buffer_load_dwordx4 a[36:39], v51, s[24:27], s43 offen offset:512 sc1
    buffer_load_dwordx4 a[44:47], v51, s[24:27], s43 offen offset:640 sc1
    buffer_store_dwordx4 v[88:91], v74, s[24:27], s39 offen sc1
    s_barrier
    ds_read_b64_tr_b16 a[160:161], v12 offset:32768
    ds_read_b64_tr_b16 a[162:163], v12 offset:36864
    ds_read_b64_tr_b16 a[164:165], v12 offset:40960
    ds_read_b64_tr_b16 a[166:167], v12 offset:45056
    ds_read_b64_tr_b16 a[168:169], v13 offset:32768
    ds_read_b64_tr_b16 a[170:171], v13 offset:36864
    ds_read_b64_tr_b16 a[172:173], v13 offset:40960
    ds_read_b64_tr_b16 a[174:175], v13 offset:45056
    ds_read_b64_tr_b16 a[176:177], v14 offset:32768
    ds_read_b64_tr_b16 a[178:179], v14 offset:36864
    ds_read_b64_tr_b16 a[180:181], v14 offset:40960
    ds_read_b64_tr_b16 a[182:183], v14 offset:45056
    s_waitcnt lgkmcnt(10)
    s_waitcnt vmcnt(12)
    v_mfma_f32_16x16x32_bf16 v[128:131], a[160:163], a[0:3], 0
    s_waitcnt vmcnt(11)
    s_waitcnt lgkmcnt(8)
    ds_read_b64_tr_b16 a[184:185], v15 offset:32768
    v_mfma_f32_16x16x32_bf16 v[128:131], a[164:167], a[8:11], v[128:131]
    s_waitcnt vmcnt(10)
    ds_read_b64_tr_b16 a[186:187], v15 offset:36864
    v_mfma_f32_16x16x32_bf16 v[132:135], a[160:163], a[4:7], 0
    s_waitcnt vmcnt(9)
    ds_read_b64_tr_b16 a[188:189], v15 offset:40960
    v_mfma_f32_16x16x32_bf16 v[132:135], a[164:167], a[12:15], v[132:135]
    s_waitcnt lgkmcnt(9)
    ds_read_b64_tr_b16 a[190:191], v15 offset:45056
    buffer_load_dwordx4 a[48:51], v51, s[24:27], s46 offen offset:768 sc1
    v_mfma_f32_16x16x32_bf16 v[136:139], a[168:171], a[0:3], 0
    s_waitcnt lgkmcnt(8)
    ds_read_b64_tr_b16 a[160:161], v16 offset:32768
    v_mfma_f32_16x16x32_bf16 v[136:139], a[172:175], a[8:11], v[136:139]
    ds_read_b64_tr_b16 a[162:163], v16 offset:36864
    v_mfma_f32_16x16x32_bf16 v[140:143], a[168:171], a[4:7], 0
    ds_read_b64_tr_b16 a[164:165], v16 offset:40960
    v_mfma_f32_16x16x32_bf16 v[140:143], a[172:175], a[12:15], v[140:143]
    s_waitcnt lgkmcnt(9)
    ds_read_b64_tr_b16 a[166:167], v16 offset:45056
    buffer_load_dwordx4 a[56:59], v51, s[24:27], s46 offen offset:896 sc1
    v_mfma_f32_16x16x32_bf16 v[144:147], a[176:179], a[0:3], 0
    s_waitcnt lgkmcnt(8)
    ds_read_b64_tr_b16 a[168:169], v17 offset:32768
    v_mfma_f32_16x16x32_bf16 v[144:147], a[180:183], a[8:11], v[144:147]
    ds_read_b64_tr_b16 a[170:171], v17 offset:36864
    v_mfma_f32_16x16x32_bf16 v[148:151], a[176:179], a[4:7], 0
    ds_read_b64_tr_b16 a[172:173], v17 offset:40960
    v_mfma_f32_16x16x32_bf16 v[148:151], a[180:183], a[12:15], v[148:151]
    s_waitcnt lgkmcnt(9)
    ds_read_b64_tr_b16 a[174:175], v17 offset:45056
    buffer_load_dwordx4 a[52:55], v51, s[24:27], s43 offen offset:768 sc1
    v_mfma_f32_16x16x32_bf16 v[152:155], a[184:187], a[0:3], 0
    s_waitcnt lgkmcnt(8)
    ds_read_b64_tr_b16 a[176:177], v18 offset:32768
    v_mfma_f32_16x16x32_bf16 v[152:155], a[188:191], a[8:11], v[152:155]
    ds_read_b64_tr_b16 a[178:179], v18 offset:36864
    v_mfma_f32_16x16x32_bf16 v[156:159], a[184:187], a[4:7], 0
    ds_read_b64_tr_b16 a[180:181], v18 offset:40960
    v_mfma_f32_16x16x32_bf16 v[156:159], a[188:191], a[12:15], v[156:159]
    s_waitcnt lgkmcnt(9)
    ds_read_b64_tr_b16 a[182:183], v18 offset:45056
    buffer_load_dwordx4 a[60:63], v51, s[24:27], s43 offen offset:896 sc1
    v_mfma_f32_16x16x32_bf16 v[160:163], a[160:163], a[0:3], 0
    s_waitcnt lgkmcnt(8)
    ds_read_b64_tr_b16 a[184:185], v19 offset:32768
    v_mfma_f32_16x16x32_bf16 v[160:163], a[164:167], a[8:11], v[160:163]
    s_add_u32 s49, s44, 2097152
    ds_read_b64_tr_b16 a[186:187], v19 offset:36864
    v_mfma_f32_16x16x32_bf16 v[164:167], a[160:163], a[4:7], 0
    s_add_u32 m0, s42, 0
    ds_read_b64_tr_b16 a[188:189], v19 offset:40960
    v_mfma_f32_16x16x32_bf16 v[164:167], a[164:167], a[12:15], v[164:167]
    s_waitcnt lgkmcnt(9)
    ds_read_b64_tr_b16 a[190:191], v19 offset:45056
    buffer_load_dwordx4 v42, s[16:19], s49 offen lds
    v_mfma_f32_16x16x32_bf16 v[168:171], a[168:171], a[0:3], 0
    s_waitcnt lgkmcnt(8)
    ds_read_b64_tr_b16 a[160:161], v12 offset:49152
    v_mfma_f32_16x16x32_bf16 v[168:171], a[172:175], a[8:11], v[168:171]
    ds_read_b64_tr_b16 a[162:163], v12 offset:53248
    v_mfma_f32_16x16x32_bf16 v[172:175], a[168:171], a[4:7], 0
    ds_read_b64_tr_b16 a[164:165], v12 offset:57344
    v_mfma_f32_16x16x32_bf16 v[172:175], a[172:175], a[12:15], v[172:175]
    s_waitcnt lgkmcnt(9)
    ds_read_b64_tr_b16 a[166:167], v12 offset:61440
    buffer_load_dwordx4 v43, s[16:19], s49 offen offset:1024 lds
    v_mfma_f32_16x16x32_bf16 v[176:179], a[176:179], a[0:3], 0
    s_waitcnt lgkmcnt(8)
    ds_read_b64_tr_b16 a[168:169], v13 offset:49152
    v_mfma_f32_16x16x32_bf16 v[176:179], a[180:183], a[8:11], v[176:179]
    ds_read_b64_tr_b16 a[170:171], v13 offset:53248
    v_mfma_f32_16x16x32_bf16 v[180:183], a[176:179], a[4:7], 0
    ds_read_b64_tr_b16 a[172:173], v13 offset:57344
    v_mfma_f32_16x16x32_bf16 v[180:183], a[180:183], a[12:15], v[180:183]
    s_waitcnt lgkmcnt(9)
    ds_read_b64_tr_b16 a[174:175], v13 offset:61440
    buffer_load_dwordx4 v44, s[16:19], s49 offen offset:2048 lds
    v_mfma_f32_16x16x32_bf16 v[184:187], a[184:187], a[0:3], 0
    s_waitcnt lgkmcnt(8)
    ds_read_b64_tr_b16 a[176:177], v14 offset:49152
    v_mfma_f32_16x16x32_bf16 v[184:187], a[188:191], a[8:11], v[184:187]
    ds_read_b64_tr_b16 a[178:179], v14 offset:53248
    v_mfma_f32_16x16x32_bf16 v[188:191], a[184:187], a[4:7], 0
    ds_read_b64_tr_b16 a[180:181], v14 offset:57344
    v_mfma_f32_16x16x32_bf16 v[188:191], a[188:191], a[12:15], v[188:191]
    s_waitcnt lgkmcnt(9)
    ds_read_b64_tr_b16 a[182:183], v14 offset:61440
    buffer_load_dwordx4 v45, s[16:19], s49 offen offset:3072 lds
    v_mfma_f32_16x16x32_bf16 v[192:195], a[160:163], a[0:3], 0
    s_waitcnt lgkmcnt(8)
    ds_read_b64_tr_b16 a[184:185], v15 offset:49152
    v_mfma_f32_16x16x32_bf16 v[192:195], a[164:167], a[8:11], v[192:195]
    s_add_u32 s49, s44, 2097408
    ds_read_b64_tr_b16 a[186:187], v15 offset:53248
    v_mfma_f32_16x16x32_bf16 v[196:199], a[160:163], a[4:7], 0
    s_add_u32 m0, s42, 16384
    ds_read_b64_tr_b16 a[188:189], v15 offset:57344
    v_mfma_f32_16x16x32_bf16 v[196:199], a[164:167], a[12:15], v[196:199]
    s_waitcnt lgkmcnt(9)
    ds_read_b64_tr_b16 a[190:191], v15 offset:61440
    buffer_load_dwordx4 v42, s[16:19], s49 offen lds
    v_mfma_f32_16x16x32_bf16 v[200:203], a[168:171], a[0:3], 0
    s_waitcnt lgkmcnt(8)
    ds_read_b64_tr_b16 a[160:161], v16 offset:49152
    v_mfma_f32_16x16x32_bf16 v[200:203], a[172:175], a[8:11], v[200:203]
    ds_read_b64_tr_b16 a[162:163], v16 offset:53248
    v_mfma_f32_16x16x32_bf16 v[204:207], a[168:171], a[4:7], 0
    ds_read_b64_tr_b16 a[164:165], v16 offset:57344
    v_mfma_f32_16x16x32_bf16 v[204:207], a[172:175], a[12:15], v[204:207]
    s_waitcnt lgkmcnt(9)
    ds_read_b64_tr_b16 a[166:167], v16 offset:61440
    buffer_load_dwordx4 v43, s[16:19], s49 offen offset:1024 lds
    v_mfma_f32_16x16x32_bf16 v[208:211], a[176:179], a[0:3], 0
    s_waitcnt lgkmcnt(8)
    ds_read_b64_tr_b16 a[168:169], v17 offset:49152
    v_mfma_f32_16x16x32_bf16 v[208:211], a[180:183], a[8:11], v[208:211]
    ds_read_b64_tr_b16 a[170:171], v17 offset:53248
    v_mfma_f32_16x16x32_bf16 v[212:215], a[176:179], a[4:7], 0
    ds_read_b64_tr_b16 a[172:173], v17 offset:57344
    v_mfma_f32_16x16x32_bf16 v[212:215], a[180:183], a[12:15], v[212:215]
    s_waitcnt lgkmcnt(9)
    ds_read_b64_tr_b16 a[174:175], v17 offset:61440
    buffer_load_dwordx4 v44, s[16:19], s49 offen offset:2048 lds
    v_mfma_f32_16x16x32_bf16 v[216:219], a[184:187], a[0:3], 0
    s_waitcnt lgkmcnt(8)
    ds_read_b64_tr_b16 a[176:177], v18 offset:49152
    v_mfma_f32_16x16x32_bf16 v[216:219], a[188:191], a[8:11], v[216:219]
    ds_read_b64_tr_b16 a[178:179], v18 offset:53248
    v_mfma_f32_16x16x32_bf16 v[220:223], a[184:187], a[4:7], 0
    ds_read_b64_tr_b16 a[180:181], v18 offset:57344
    v_mfma_f32_16x16x32_bf16 v[220:223], a[188:191], a[12:15], v[220:223]
    s_waitcnt lgkmcnt(9)
    ds_read_b64_tr_b16 a[182:183], v18 offset:61440
    buffer_load_dwordx4 v45, s[16:19], s49 offen offset:3072 lds
    v_mfma_f32_16x16x32_bf16 v[224:227], a[160:163], a[0:3], 0
    s_waitcnt lgkmcnt(8)
    ds_read_b64_tr_b16 a[184:185], v19 offset:49152
    v_mfma_f32_16x16x32_bf16 v[224:227], a[164:167], a[8:11], v[224:227]
    ds_read_b64_tr_b16 a[186:187], v19 offset:53248
    v_mfma_f32_16x16x32_bf16 v[228:231], a[160:163], a[4:7], 0
    ds_read_b64_tr_b16 a[188:189], v19 offset:57344
    v_mfma_f32_16x16x32_bf16 v[228:231], a[164:167], a[12:15], v[228:231]
    s_waitcnt lgkmcnt(9)
    ds_read_b64_tr_b16 a[190:191], v19 offset:61440
    s_barrier
    v_mfma_f32_16x16x32_bf16 v[232:235], a[168:171], a[0:3], 0
    s_waitcnt lgkmcnt(8)
    ds_read_b64_tr_b16 a[160:161], v20 offset:0
    v_mfma_f32_16x16x32_bf16 v[232:235], a[172:175], a[8:11], v[232:235]
    ds_read_b64_tr_b16 a[162:163], v20 offset:4096
    v_mfma_f32_16x16x32_bf16 v[236:239], a[168:171], a[4:7], 0
    ds_read_b64_tr_b16 a[164:165], v20 offset:8192
    v_mfma_f32_16x16x32_bf16 v[236:239], a[172:175], a[12:15], v[236:239]
    s_waitcnt lgkmcnt(9)
    ds_read_b64_tr_b16 a[166:167], v20 offset:12288
    buffer_load_dwordx4 a[64:67], v51, s[24:27], s46 offen offset:1024 sc1
    v_mfma_f32_16x16x32_bf16 v[240:243], a[176:179], a[0:3], 0
    s_waitcnt lgkmcnt(8)
    ds_read_b64_tr_b16 a[168:169], v21 offset:0
    v_mfma_f32_16x16x32_bf16 v[240:243], a[180:183], a[8:11], v[240:243]
    ds_read_b64_tr_b16 a[170:171], v21 offset:4096
    v_mfma_f32_16x16x32_bf16 v[244:247], a[176:179], a[4:7], 0
    ds_read_b64_tr_b16 a[172:173], v21 offset:8192
    v_mfma_f32_16x16x32_bf16 v[244:247], a[180:183], a[12:15], v[244:247]
    s_waitcnt lgkmcnt(9)
    ds_read_b64_tr_b16 a[174:175], v21 offset:12288
    buffer_load_dwordx4 a[72:75], v51, s[24:27], s46 offen offset:1152 sc1
    v_mfma_f32_16x16x32_bf16 v[248:251], a[184:187], a[0:3], 0
    s_waitcnt lgkmcnt(8)
    ds_read_b64_tr_b16 a[176:177], v22 offset:0
    v_mfma_f32_16x16x32_bf16 v[248:251], a[188:191], a[8:11], v[248:251]
    ds_read_b64_tr_b16 a[178:179], v22 offset:4096
    v_mfma_f32_16x16x32_bf16 v[252:255], a[184:187], a[4:7], 0
    ds_read_b64_tr_b16 a[180:181], v22 offset:8192
    v_mfma_f32_16x16x32_bf16 v[252:255], a[188:191], a[12:15], v[252:255]
    s_waitcnt vmcnt(22)
    s_waitcnt lgkmcnt(9)
    ds_read_b64_tr_b16 a[182:183], v22 offset:12288
    buffer_load_dwordx4 a[68:71], v51, s[24:27], s43 offen offset:1024 sc1
    v_mfma_f32_16x16x32_bf16 v[128:131], a[160:163], a[16:19], v[128:131]
    s_waitcnt vmcnt(22)
    s_waitcnt lgkmcnt(8)
    ds_read_b64_tr_b16 a[184:185], v23 offset:0
    v_mfma_f32_16x16x32_bf16 v[128:131], a[164:167], a[24:27], v[128:131]
    s_waitcnt vmcnt(21)
    ds_read_b64_tr_b16 a[186:187], v23 offset:4096
    v_mfma_f32_16x16x32_bf16 v[132:135], a[160:163], a[20:23], v[132:135]
    s_waitcnt vmcnt(20)
    ds_read_b64_tr_b16 a[188:189], v23 offset:8192
    v_mfma_f32_16x16x32_bf16 v[132:135], a[164:167], a[28:31], v[132:135]
    s_waitcnt lgkmcnt(9)
    ds_read_b64_tr_b16 a[190:191], v23 offset:12288
    buffer_load_dwordx4 a[76:79], v51, s[24:27], s43 offen offset:1152 sc1
    v_mfma_f32_16x16x32_bf16 v[136:139], a[168:171], a[16:19], v[136:139]
    s_waitcnt lgkmcnt(8)
    ds_read_b64_tr_b16 a[160:161], v24 offset:0
    v_mfma_f32_16x16x32_bf16 v[136:139], a[172:175], a[24:27], v[136:139]
    ds_read_b64_tr_b16 a[162:163], v24 offset:4096
    v_mfma_f32_16x16x32_bf16 v[140:143], a[168:171], a[20:23], v[140:143]
    ds_read_b64_tr_b16 a[164:165], v24 offset:8192
    v_mfma_f32_16x16x32_bf16 v[140:143], a[172:175], a[28:31], v[140:143]
    s_waitcnt lgkmcnt(9)
    ds_read_b64_tr_b16 a[166:167], v24 offset:12288
    buffer_load_dwordx4 a[80:83], v51, s[24:27], s46 offen offset:1280 sc1
    v_mfma_f32_16x16x32_bf16 v[144:147], a[176:179], a[16:19], v[144:147]
    s_waitcnt lgkmcnt(8)
    ds_read_b64_tr_b16 a[168:169], v25 offset:0
    v_mfma_f32_16x16x32_bf16 v[144:147], a[180:183], a[24:27], v[144:147]
    ds_read_b64_tr_b16 a[170:171], v25 offset:4096
    v_mfma_f32_16x16x32_bf16 v[148:151], a[176:179], a[20:23], v[148:151]
    ds_read_b64_tr_b16 a[172:173], v25 offset:8192
    v_mfma_f32_16x16x32_bf16 v[148:151], a[180:183], a[28:31], v[148:151]
    s_waitcnt lgkmcnt(9)
    ds_read_b64_tr_b16 a[174:175], v25 offset:12288
    buffer_load_dwordx4 a[88:91], v51, s[24:27], s46 offen offset:1408 sc1
    v_mfma_f32_16x16x32_bf16 v[152:155], a[184:187], a[16:19], v[152:155]
    s_waitcnt lgkmcnt(8)
    ds_read_b64_tr_b16 a[176:177], v26 offset:0
    v_mfma_f32_16x16x32_bf16 v[152:155], a[188:191], a[24:27], v[152:155]
    ds_read_b64_tr_b16 a[178:179], v26 offset:4096
    v_mfma_f32_16x16x32_bf16 v[156:159], a[184:187], a[20:23], v[156:159]
    ds_read_b64_tr_b16 a[180:181], v26 offset:8192
    v_mfma_f32_16x16x32_bf16 v[156:159], a[188:191], a[28:31], v[156:159]
    s_waitcnt lgkmcnt(9)
    ds_read_b64_tr_b16 a[182:183], v26 offset:12288
    buffer_load_dwordx4 a[84:87], v51, s[24:27], s43 offen offset:1280 sc1
    v_mfma_f32_16x16x32_bf16 v[160:163], a[160:163], a[16:19], v[160:163]
    s_waitcnt lgkmcnt(8)
    ds_read_b64_tr_b16 a[184:185], v27 offset:0
    v_mfma_f32_16x16x32_bf16 v[160:163], a[164:167], a[24:27], v[160:163]
    ds_read_b64_tr_b16 a[186:187], v27 offset:4096
    v_mfma_f32_16x16x32_bf16 v[164:167], a[160:163], a[20:23], v[164:167]
    ds_read_b64_tr_b16 a[188:189], v27 offset:8192
    v_mfma_f32_16x16x32_bf16 v[164:167], a[164:167], a[28:31], v[164:167]
    s_waitcnt lgkmcnt(9)
    ds_read_b64_tr_b16 a[190:191], v27 offset:12288
    buffer_load_dwordx4 a[92:95], v51, s[24:27], s43 offen offset:1408 sc1
    v_mfma_f32_16x16x32_bf16 v[168:171], a[168:171], a[16:19], v[168:171]
    s_waitcnt lgkmcnt(8)
    ds_read_b64_tr_b16 a[160:161], v20 offset:16384
    v_mfma_f32_16x16x32_bf16 v[168:171], a[172:175], a[24:27], v[168:171]
    ds_read_b64_tr_b16 a[162:163], v20 offset:20480
    v_mfma_f32_16x16x32_bf16 v[172:175], a[168:171], a[20:23], v[172:175]
    ds_read_b64_tr_b16 a[164:165], v20 offset:24576
    v_mfma_f32_16x16x32_bf16 v[172:175], a[172:175], a[28:31], v[172:175]
    s_waitcnt lgkmcnt(9)
    ds_read_b64_tr_b16 a[166:167], v20 offset:28672
    buffer_load_dwordx4 a[96:99], v51, s[24:27], s46 offen offset:1536 sc1
    v_mfma_f32_16x16x32_bf16 v[176:179], a[176:179], a[16:19], v[176:179]
    s_waitcnt lgkmcnt(8)
    ds_read_b64_tr_b16 a[168:169], v21 offset:16384
    v_mfma_f32_16x16x32_bf16 v[176:179], a[180:183], a[24:27], v[176:179]
    ds_read_b64_tr_b16 a[170:171], v21 offset:20480
    v_mfma_f32_16x16x32_bf16 v[180:183], a[176:179], a[20:23], v[180:183]
    ds_read_b64_tr_b16 a[172:173], v21 offset:24576
    v_mfma_f32_16x16x32_bf16 v[180:183], a[180:183], a[28:31], v[180:183]
    s_waitcnt lgkmcnt(9)
    ds_read_b64_tr_b16 a[174:175], v21 offset:28672
    buffer_load_dwordx4 a[104:107], v51, s[24:27], s46 offen offset:1664 sc1
    v_mfma_f32_16x16x32_bf16 v[184:187], a[184:187], a[16:19], v[184:187]
    s_waitcnt lgkmcnt(8)
    ds_read_b64_tr_b16 a[176:177], v22 offset:16384
    v_mfma_f32_16x16x32_bf16 v[184:187], a[188:191], a[24:27], v[184:187]
    ds_read_b64_tr_b16 a[178:179], v22 offset:20480
    v_mfma_f32_16x16x32_bf16 v[188:191], a[184:187], a[20:23], v[188:191]
    ds_read_b64_tr_b16 a[180:181], v22 offset:24576
    v_mfma_f32_16x16x32_bf16 v[188:191], a[188:191], a[28:31], v[188:191]
    s_waitcnt lgkmcnt(9)
    ds_read_b64_tr_b16 a[182:183], v22 offset:28672
    buffer_load_dwordx4 a[100:103], v51, s[24:27], s43 offen offset:1536 sc1
    v_mfma_f32_16x16x32_bf16 v[192:195], a[160:163], a[16:19], v[192:195]
    s_waitcnt lgkmcnt(8)
    ds_read_b64_tr_b16 a[184:185], v23 offset:16384
    v_mfma_f32_16x16x32_bf16 v[192:195], a[164:167], a[24:27], v[192:195]
    ds_read_b64_tr_b16 a[186:187], v23 offset:20480
    v_mfma_f32_16x16x32_bf16 v[196:199], a[160:163], a[20:23], v[196:199]
    ds_read_b64_tr_b16 a[188:189], v23 offset:24576
    v_mfma_f32_16x16x32_bf16 v[196:199], a[164:167], a[28:31], v[196:199]
    s_waitcnt lgkmcnt(9)
    ds_read_b64_tr_b16 a[190:191], v23 offset:28672
    buffer_load_dwordx4 a[108:111], v51, s[24:27], s43 offen offset:1664 sc1
    v_mfma_f32_16x16x32_bf16 v[200:203], a[168:171], a[16:19], v[200:203]
    s_waitcnt lgkmcnt(8)
    ds_read_b64_tr_b16 a[160:161], v24 offset:16384
    v_mfma_f32_16x16x32_bf16 v[200:203], a[172:175], a[24:27], v[200:203]
    ds_read_b64_tr_b16 a[162:163], v24 offset:20480
    v_mfma_f32_16x16x32_bf16 v[204:207], a[168:171], a[20:23], v[204:207]
    ds_read_b64_tr_b16 a[164:165], v24 offset:24576
    v_mfma_f32_16x16x32_bf16 v[204:207], a[172:175], a[28:31], v[204:207]
    s_waitcnt lgkmcnt(9)
    ds_read_b64_tr_b16 a[166:167], v24 offset:28672
    v_mfma_f32_16x16x32_bf16 v[208:211], a[176:179], a[16:19], v[208:211]
    s_waitcnt lgkmcnt(8)
    ds_read_b64_tr_b16 a[168:169], v25 offset:16384
    v_mfma_f32_16x16x32_bf16 v[208:211], a[180:183], a[24:27], v[208:211]
    ds_read_b64_tr_b16 a[170:171], v25 offset:20480
    v_mfma_f32_16x16x32_bf16 v[212:215], a[176:179], a[20:23], v[212:215]
    ds_read_b64_tr_b16 a[172:173], v25 offset:24576
    v_mfma_f32_16x16x32_bf16 v[212:215], a[180:183], a[28:31], v[212:215]
    s_waitcnt lgkmcnt(9)
    ds_read_b64_tr_b16 a[174:175], v25 offset:28672
    v_mfma_f32_16x16x32_bf16 v[216:219], a[184:187], a[16:19], v[216:219]
    s_waitcnt lgkmcnt(8)
    ds_read_b64_tr_b16 a[176:177], v26 offset:16384
    v_mfma_f32_16x16x32_bf16 v[216:219], a[188:191], a[24:27], v[216:219]
    ds_read_b64_tr_b16 a[178:179], v26 offset:20480
    v_mfma_f32_16x16x32_bf16 v[220:223], a[184:187], a[20:23], v[220:223]
    ds_read_b64_tr_b16 a[180:181], v26 offset:24576
    v_mfma_f32_16x16x32_bf16 v[220:223], a[188:191], a[28:31], v[220:223]
    s_waitcnt lgkmcnt(9)
    ds_read_b64_tr_b16 a[182:183], v26 offset:28672
    v_mfma_f32_16x16x32_bf16 v[224:227], a[160:163], a[16:19], v[224:227]
    s_waitcnt lgkmcnt(8)
    ds_read_b64_tr_b16 a[184:185], v27 offset:16384
    v_mfma_f32_16x16x32_bf16 v[224:227], a[164:167], a[24:27], v[224:227]
    ds_read_b64_tr_b16 a[186:187], v27 offset:20480
    v_mfma_f32_16x16x32_bf16 v[228:231], a[160:163], a[20:23], v[228:231]
    ds_read_b64_tr_b16 a[188:189], v27 offset:24576
    v_mfma_f32_16x16x32_bf16 v[228:231], a[164:167], a[28:31], v[228:231]
    s_waitcnt lgkmcnt(9)
    ds_read_b64_tr_b16 a[190:191], v27 offset:28672
    s_barrier
    v_mfma_f32_16x16x32_bf16 v[232:235], a[168:171], a[16:19], v[232:235]
    s_waitcnt lgkmcnt(8)
    ds_read_b64_tr_b16 a[160:161], v20 offset:32768
    v_mfma_f32_16x16x32_bf16 v[232:235], a[172:175], a[24:27], v[232:235]
    ds_read_b64_tr_b16 a[162:163], v20 offset:36864
    v_mfma_f32_16x16x32_bf16 v[236:239], a[168:171], a[20:23], v[236:239]
    ds_read_b64_tr_b16 a[164:165], v20 offset:40960
    v_mfma_f32_16x16x32_bf16 v[236:239], a[172:175], a[28:31], v[236:239]
    s_waitcnt lgkmcnt(9)
    ds_read_b64_tr_b16 a[166:167], v20 offset:45056
    buffer_load_dwordx4 a[112:115], v51, s[24:27], s46 offen offset:1792 sc1
    v_mfma_f32_16x16x32_bf16 v[240:243], a[176:179], a[16:19], v[240:243]
    s_waitcnt lgkmcnt(8)
    ds_read_b64_tr_b16 a[168:169], v21 offset:32768
    v_mfma_f32_16x16x32_bf16 v[240:243], a[180:183], a[24:27], v[240:243]
    ds_read_b64_tr_b16 a[170:171], v21 offset:36864
    v_mfma_f32_16x16x32_bf16 v[244:247], a[176:179], a[20:23], v[244:247]
    ds_read_b64_tr_b16 a[172:173], v21 offset:40960
    v_mfma_f32_16x16x32_bf16 v[244:247], a[180:183], a[28:31], v[244:247]
    s_waitcnt lgkmcnt(9)
    ds_read_b64_tr_b16 a[174:175], v21 offset:45056
    buffer_load_dwordx4 a[120:123], v51, s[24:27], s46 offen offset:1920 sc1
    v_mfma_f32_16x16x32_bf16 v[248:251], a[184:187], a[16:19], v[248:251]
    s_waitcnt lgkmcnt(8)
    ds_read_b64_tr_b16 a[176:177], v22 offset:32768
    v_mfma_f32_16x16x32_bf16 v[248:251], a[188:191], a[24:27], v[248:251]
    ds_read_b64_tr_b16 a[178:179], v22 offset:36864
    v_mfma_f32_16x16x32_bf16 v[252:255], a[184:187], a[20:23], v[252:255]
    ds_read_b64_tr_b16 a[180:181], v22 offset:40960
    v_mfma_f32_16x16x32_bf16 v[252:255], a[188:191], a[28:31], v[252:255]
    s_waitcnt vmcnt(30)
    s_waitcnt lgkmcnt(9)
    ds_read_b64_tr_b16 a[182:183], v22 offset:45056
    buffer_load_dwordx4 a[116:119], v51, s[24:27], s43 offen offset:1792 sc1
    v_mfma_f32_16x16x32_bf16 v[128:131], a[160:163], a[32:35], v[128:131]
    s_waitcnt vmcnt(30)
    s_waitcnt lgkmcnt(8)
    ds_read_b64_tr_b16 a[184:185], v23 offset:32768
    v_mfma_f32_16x16x32_bf16 v[128:131], a[164:167], a[40:43], v[128:131]
    s_waitcnt vmcnt(29)
    ds_read_b64_tr_b16 a[186:187], v23 offset:36864
    v_mfma_f32_16x16x32_bf16 v[132:135], a[160:163], a[36:39], v[132:135]
    s_waitcnt vmcnt(28)
    ds_read_b64_tr_b16 a[188:189], v23 offset:40960
    v_mfma_f32_16x16x32_bf16 v[132:135], a[164:167], a[44:47], v[132:135]
    s_waitcnt lgkmcnt(9)
    ds_read_b64_tr_b16 a[190:191], v23 offset:45056
    buffer_load_dwordx4 a[124:127], v51, s[24:27], s43 offen offset:1920 sc1
    v_mfma_f32_16x16x32_bf16 v[136:139], a[168:171], a[32:35], v[136:139]
    s_waitcnt lgkmcnt(8)
    ds_read_b64_tr_b16 a[160:161], v24 offset:32768
    v_mfma_f32_16x16x32_bf16 v[136:139], a[172:175], a[40:43], v[136:139]
    s_add_u32 s49, s44, 2621440
    ds_read_b64_tr_b16 a[162:163], v24 offset:36864
    v_mfma_f32_16x16x32_bf16 v[140:143], a[168:171], a[36:39], v[140:143]
    s_add_u32 m0, s42, 32768
    ds_read_b64_tr_b16 a[164:165], v24 offset:40960
    v_mfma_f32_16x16x32_bf16 v[140:143], a[172:175], a[44:47], v[140:143]
    s_waitcnt lgkmcnt(9)
    ds_read_b64_tr_b16 a[166:167], v24 offset:45056
    buffer_load_dwordx4 v42, s[16:19], s49 offen lds
    v_mfma_f32_16x16x32_bf16 v[144:147], a[176:179], a[32:35], v[144:147]
    s_waitcnt lgkmcnt(8)
    ds_read_b64_tr_b16 a[168:169], v25 offset:32768
    v_mfma_f32_16x16x32_bf16 v[144:147], a[180:183], a[40:43], v[144:147]
    ds_read_b64_tr_b16 a[170:171], v25 offset:36864
    v_mfma_f32_16x16x32_bf16 v[148:151], a[176:179], a[36:39], v[148:151]
    ds_read_b64_tr_b16 a[172:173], v25 offset:40960
    v_mfma_f32_16x16x32_bf16 v[148:151], a[180:183], a[44:47], v[148:151]
    s_waitcnt lgkmcnt(9)
    ds_read_b64_tr_b16 a[174:175], v25 offset:45056
    buffer_load_dwordx4 v43, s[16:19], s49 offen offset:1024 lds
    v_mfma_f32_16x16x32_bf16 v[152:155], a[184:187], a[32:35], v[152:155]
    s_waitcnt lgkmcnt(8)
    ds_read_b64_tr_b16 a[176:177], v26 offset:32768
    v_mfma_f32_16x16x32_bf16 v[152:155], a[188:191], a[40:43], v[152:155]
    ds_read_b64_tr_b16 a[178:179], v26 offset:36864
    v_mfma_f32_16x16x32_bf16 v[156:159], a[184:187], a[36:39], v[156:159]
    ds_read_b64_tr_b16 a[180:181], v26 offset:40960
    v_mfma_f32_16x16x32_bf16 v[156:159], a[188:191], a[44:47], v[156:159]
    s_waitcnt lgkmcnt(9)
    ds_read_b64_tr_b16 a[182:183], v26 offset:45056
    buffer_load_dwordx4 v44, s[16:19], s49 offen offset:2048 lds
    v_mfma_f32_16x16x32_bf16 v[160:163], a[160:163], a[32:35], v[160:163]
    s_waitcnt lgkmcnt(8)
    ds_read_b64_tr_b16 a[184:185], v27 offset:32768
    v_mfma_f32_16x16x32_bf16 v[160:163], a[164:167], a[40:43], v[160:163]
    ds_read_b64_tr_b16 a[186:187], v27 offset:36864
    v_mfma_f32_16x16x32_bf16 v[164:167], a[160:163], a[36:39], v[164:167]
    ds_read_b64_tr_b16 a[188:189], v27 offset:40960
    v_mfma_f32_16x16x32_bf16 v[164:167], a[164:167], a[44:47], v[164:167]
    s_waitcnt lgkmcnt(9)
    ds_read_b64_tr_b16 a[190:191], v27 offset:45056
    buffer_load_dwordx4 v45, s[16:19], s49 offen offset:3072 lds
    v_mfma_f32_16x16x32_bf16 v[168:171], a[168:171], a[32:35], v[168:171]
    s_waitcnt lgkmcnt(8)
    ds_read_b64_tr_b16 a[160:161], v20 offset:49152
    v_mfma_f32_16x16x32_bf16 v[168:171], a[172:175], a[40:43], v[168:171]
    s_add_u32 s49, s44, 2621696
    ds_read_b64_tr_b16 a[162:163], v20 offset:53248
    v_mfma_f32_16x16x32_bf16 v[172:175], a[168:171], a[36:39], v[172:175]
    s_add_u32 m0, s42, 49152
    ds_read_b64_tr_b16 a[164:165], v20 offset:57344
    v_mfma_f32_16x16x32_bf16 v[172:175], a[172:175], a[44:47], v[172:175]
    s_waitcnt lgkmcnt(9)
    ds_read_b64_tr_b16 a[166:167], v20 offset:61440
    buffer_load_dwordx4 v42, s[16:19], s49 offen lds
    v_mfma_f32_16x16x32_bf16 v[176:179], a[176:179], a[32:35], v[176:179]
    s_waitcnt lgkmcnt(8)
    ds_read_b64_tr_b16 a[168:169], v21 offset:49152
    v_mfma_f32_16x16x32_bf16 v[176:179], a[180:183], a[40:43], v[176:179]
    ds_read_b64_tr_b16 a[170:171], v21 offset:53248
    v_mfma_f32_16x16x32_bf16 v[180:183], a[176:179], a[36:39], v[180:183]
    ds_read_b64_tr_b16 a[172:173], v21 offset:57344
    v_mfma_f32_16x16x32_bf16 v[180:183], a[180:183], a[44:47], v[180:183]
    s_waitcnt lgkmcnt(9)
    ds_read_b64_tr_b16 a[174:175], v21 offset:61440
    buffer_load_dwordx4 v43, s[16:19], s49 offen offset:1024 lds
    v_mfma_f32_16x16x32_bf16 v[184:187], a[184:187], a[32:35], v[184:187]
    s_waitcnt lgkmcnt(8)
    ds_read_b64_tr_b16 a[176:177], v22 offset:49152
    v_mfma_f32_16x16x32_bf16 v[184:187], a[188:191], a[40:43], v[184:187]
    ds_read_b64_tr_b16 a[178:179], v22 offset:53248
    v_mfma_f32_16x16x32_bf16 v[188:191], a[184:187], a[36:39], v[188:191]
    ds_read_b64_tr_b16 a[180:181], v22 offset:57344
    v_mfma_f32_16x16x32_bf16 v[188:191], a[188:191], a[44:47], v[188:191]
    s_waitcnt lgkmcnt(9)
    ds_read_b64_tr_b16 a[182:183], v22 offset:61440
    buffer_load_dwordx4 v44, s[16:19], s49 offen offset:2048 lds
    v_mfma_f32_16x16x32_bf16 v[192:195], a[160:163], a[32:35], v[192:195]
    s_waitcnt lgkmcnt(8)
    ds_read_b64_tr_b16 a[184:185], v23 offset:49152
    v_mfma_f32_16x16x32_bf16 v[192:195], a[164:167], a[40:43], v[192:195]
    ds_read_b64_tr_b16 a[186:187], v23 offset:53248
    v_mfma_f32_16x16x32_bf16 v[196:199], a[160:163], a[36:39], v[196:199]
    ds_read_b64_tr_b16 a[188:189], v23 offset:57344
    v_mfma_f32_16x16x32_bf16 v[196:199], a[164:167], a[44:47], v[196:199]
    s_waitcnt lgkmcnt(9)
    ds_read_b64_tr_b16 a[190:191], v23 offset:61440
    buffer_load_dwordx4 v45, s[16:19], s49 offen offset:3072 lds
    v_mfma_f32_16x16x32_bf16 v[200:203], a[168:171], a[32:35], v[200:203]
    s_waitcnt lgkmcnt(8)
    ds_read_b64_tr_b16 a[160:161], v24 offset:49152
    v_mfma_f32_16x16x32_bf16 v[200:203], a[172:175], a[40:43], v[200:203]
    ds_read_b64_tr_b16 a[162:163], v24 offset:53248
    v_mfma_f32_16x16x32_bf16 v[204:207], a[168:171], a[36:39], v[204:207]
    ds_read_b64_tr_b16 a[164:165], v24 offset:57344
    v_mfma_f32_16x16x32_bf16 v[204:207], a[172:175], a[44:47], v[204:207]
    s_waitcnt lgkmcnt(9)
    ds_read_b64_tr_b16 a[166:167], v24 offset:61440
    v_mfma_f32_16x16x32_bf16 v[208:211], a[176:179], a[32:35], v[208:211]
    s_waitcnt lgkmcnt(8)
    ds_read_b64_tr_b16 a[168:169], v25 offset:49152
    v_mfma_f32_16x16x32_bf16 v[208:211], a[180:183], a[40:43], v[208:211]
    ds_read_b64_tr_b16 a[170:171], v25 offset:53248
    v_mfma_f32_16x16x32_bf16 v[212:215], a[176:179], a[36:39], v[212:215]
    ds_read_b64_tr_b16 a[172:173], v25 offset:57344
    v_mfma_f32_16x16x32_bf16 v[212:215], a[180:183], a[44:47], v[212:215]
    s_waitcnt lgkmcnt(9)
    ds_read_b64_tr_b16 a[174:175], v25 offset:61440
    v_mfma_f32_16x16x32_bf16 v[216:219], a[184:187], a[32:35], v[216:219]
    s_waitcnt lgkmcnt(8)
    ds_read_b64_tr_b16 a[176:177], v26 offset:49152
    v_mfma_f32_16x16x32_bf16 v[216:219], a[188:191], a[40:43], v[216:219]
    ds_read_b64_tr_b16 a[178:179], v26 offset:53248
    v_mfma_f32_16x16x32_bf16 v[220:223], a[184:187], a[36:39], v[220:223]
    ds_read_b64_tr_b16 a[180:181], v26 offset:57344
    v_mfma_f32_16x16x32_bf16 v[220:223], a[188:191], a[44:47], v[220:223]
    s_waitcnt lgkmcnt(9)
    ds_read_b64_tr_b16 a[182:183], v26 offset:61440
    v_mfma_f32_16x16x32_bf16 v[224:227], a[160:163], a[32:35], v[224:227]
    s_waitcnt lgkmcnt(8)
    ds_read_b64_tr_b16 a[184:185], v27 offset:49152
    v_mfma_f32_16x16x32_bf16 v[224:227], a[164:167], a[40:43], v[224:227]
    ds_read_b64_tr_b16 a[186:187], v27 offset:53248
    v_mfma_f32_16x16x32_bf16 v[228:231], a[160:163], a[36:39], v[228:231]
    ds_read_b64_tr_b16 a[188:189], v27 offset:57344
    v_mfma_f32_16x16x32_bf16 v[228:231], a[164:167], a[44:47], v[228:231]
    s_waitcnt lgkmcnt(9)
    ds_read_b64_tr_b16 a[190:191], v27 offset:61440
    s_barrier
    v_mfma_f32_16x16x32_bf16 v[232:235], a[168:171], a[32:35], v[232:235]
    s_waitcnt lgkmcnt(8)
    ds_read_b64_tr_b16 a[160:161], v28 offset:0
    v_mfma_f32_16x16x32_bf16 v[232:235], a[172:175], a[40:43], v[232:235]
    ds_read_b64_tr_b16 a[162:163], v28 offset:4096
    v_mfma_f32_16x16x32_bf16 v[236:239], a[168:171], a[36:39], v[236:239]
    ds_read_b64_tr_b16 a[164:165], v28 offset:8192
    v_mfma_f32_16x16x32_bf16 v[236:239], a[172:175], a[44:47], v[236:239]
    s_waitcnt lgkmcnt(9)
    ds_read_b64_tr_b16 a[166:167], v28 offset:12288
    buffer_load_dwordx4 a[128:131], v51, s[24:27], s46 offen offset:2048 sc1
    v_mfma_f32_16x16x32_bf16 v[240:243], a[176:179], a[32:35], v[240:243]
    s_waitcnt lgkmcnt(8)
    ds_read_b64_tr_b16 a[168:169], v29 offset:0
    v_mfma_f32_16x16x32_bf16 v[240:243], a[180:183], a[40:43], v[240:243]
    ds_read_b64_tr_b16 a[170:171], v29 offset:4096
    v_mfma_f32_16x16x32_bf16 v[244:247], a[176:179], a[36:39], v[244:247]
    ds_read_b64_tr_b16 a[172:173], v29 offset:8192
    v_mfma_f32_16x16x32_bf16 v[244:247], a[180:183], a[44:47], v[244:247]
    s_waitcnt lgkmcnt(9)
    ds_read_b64_tr_b16 a[174:175], v29 offset:12288
    buffer_load_dwordx4 a[136:139], v51, s[24:27], s46 offen offset:2176 sc1
    v_mfma_f32_16x16x32_bf16 v[248:251], a[184:187], a[32:35], v[248:251]
    s_waitcnt lgkmcnt(8)
    ds_read_b64_tr_b16 a[176:177], v30 offset:0
    v_mfma_f32_16x16x32_bf16 v[248:251], a[188:191], a[40:43], v[248:251]
    ds_read_b64_tr_b16 a[178:179], v30 offset:4096
    v_mfma_f32_16x16x32_bf16 v[252:255], a[184:187], a[36:39], v[252:255]
    ds_read_b64_tr_b16 a[180:181], v30 offset:8192
    v_mfma_f32_16x16x32_bf16 v[252:255], a[188:191], a[44:47], v[252:255]
    s_waitcnt vmcnt(37)
    s_waitcnt lgkmcnt(9)
    ds_read_b64_tr_b16 a[182:183], v30 offset:12288
    buffer_load_dwordx4 a[132:135], v51, s[24:27], s43 offen offset:2048 sc1
    v_mfma_f32_16x16x32_bf16 v[128:131], a[160:163], a[48:51], v[128:131]
    s_waitcnt vmcnt(37)
    s_waitcnt lgkmcnt(8)
    ds_read_b64_tr_b16 a[184:185], v31 offset:0
    v_mfma_f32_16x16x32_bf16 v[128:131], a[164:167], a[56:59], v[128:131]
    s_waitcnt vmcnt(36)
    ds_read_b64_tr_b16 a[186:187], v31 offset:4096
    v_mfma_f32_16x16x32_bf16 v[132:135], a[160:163], a[52:55], v[132:135]
    s_waitcnt vmcnt(35)
    ds_read_b64_tr_b16 a[188:189], v31 offset:8192
    v_mfma_f32_16x16x32_bf16 v[132:135], a[164:167], a[60:63], v[132:135]
    s_waitcnt lgkmcnt(9)
    ds_read_b64_tr_b16 a[190:191], v31 offset:12288
    buffer_load_dwordx4 a[140:143], v51, s[24:27], s43 offen offset:2176 sc1
    v_mfma_f32_16x16x32_bf16 v[136:139], a[168:171], a[48:51], v[136:139]
    s_waitcnt lgkmcnt(8)
    ds_read_b64_tr_b16 a[160:161], v32 offset:0
    v_mfma_f32_16x16x32_bf16 v[136:139], a[172:175], a[56:59], v[136:139]
    s_add_u32 s49, s44, 3145728
    ds_read_b64_tr_b16 a[162:163], v32 offset:4096
    v_mfma_f32_16x16x32_bf16 v[140:143], a[168:171], a[52:55], v[140:143]
    s_add_u32 m0, s42, 65536
    ds_read_b64_tr_b16 a[164:165], v32 offset:8192
    v_mfma_f32_16x16x32_bf16 v[140:143], a[172:175], a[60:63], v[140:143]
    s_waitcnt lgkmcnt(9)
    ds_read_b64_tr_b16 a[166:167], v32 offset:12288
    buffer_load_dwordx4 v42, s[16:19], s49 offen lds
    v_mfma_f32_16x16x32_bf16 v[144:147], a[176:179], a[48:51], v[144:147]
    s_waitcnt lgkmcnt(8)
    ds_read_b64_tr_b16 a[168:169], v33 offset:0
    v_mfma_f32_16x16x32_bf16 v[144:147], a[180:183], a[56:59], v[144:147]
    ds_read_b64_tr_b16 a[170:171], v33 offset:4096
    v_mfma_f32_16x16x32_bf16 v[148:151], a[176:179], a[52:55], v[148:151]
    ds_read_b64_tr_b16 a[172:173], v33 offset:8192
    v_mfma_f32_16x16x32_bf16 v[148:151], a[180:183], a[60:63], v[148:151]
    s_waitcnt lgkmcnt(9)
    ds_read_b64_tr_b16 a[174:175], v33 offset:12288
    buffer_load_dwordx4 v43, s[16:19], s49 offen offset:1024 lds
    v_mfma_f32_16x16x32_bf16 v[152:155], a[184:187], a[48:51], v[152:155]
    s_waitcnt lgkmcnt(8)
    ds_read_b64_tr_b16 a[176:177], v34 offset:0
    v_mfma_f32_16x16x32_bf16 v[152:155], a[188:191], a[56:59], v[152:155]
    ds_read_b64_tr_b16 a[178:179], v34 offset:4096
    v_mfma_f32_16x16x32_bf16 v[156:159], a[184:187], a[52:55], v[156:159]
    ds_read_b64_tr_b16 a[180:181], v34 offset:8192
    v_mfma_f32_16x16x32_bf16 v[156:159], a[188:191], a[60:63], v[156:159]
    s_waitcnt lgkmcnt(9)
    ds_read_b64_tr_b16 a[182:183], v34 offset:12288
    buffer_load_dwordx4 v44, s[16:19], s49 offen offset:2048 lds
    v_mfma_f32_16x16x32_bf16 v[160:163], a[160:163], a[48:51], v[160:163]
    s_waitcnt lgkmcnt(8)
    ds_read_b64_tr_b16 a[184:185], v35 offset:0
    v_mfma_f32_16x16x32_bf16 v[160:163], a[164:167], a[56:59], v[160:163]
    ds_read_b64_tr_b16 a[186:187], v35 offset:4096
    v_mfma_f32_16x16x32_bf16 v[164:167], a[160:163], a[52:55], v[164:167]
    ds_read_b64_tr_b16 a[188:189], v35 offset:8192
    v_mfma_f32_16x16x32_bf16 v[164:167], a[164:167], a[60:63], v[164:167]
    s_waitcnt lgkmcnt(9)
    ds_read_b64_tr_b16 a[190:191], v35 offset:12288
    buffer_load_dwordx4 v45, s[16:19], s49 offen offset:3072 lds
    v_mfma_f32_16x16x32_bf16 v[168:171], a[168:171], a[48:51], v[168:171]
    s_waitcnt lgkmcnt(8)
    ds_read_b64_tr_b16 a[160:161], v28 offset:16384
    v_mfma_f32_16x16x32_bf16 v[168:171], a[172:175], a[56:59], v[168:171]
    s_add_u32 s49, s44, 3145984
    ds_read_b64_tr_b16 a[162:163], v28 offset:20480
    v_mfma_f32_16x16x32_bf16 v[172:175], a[168:171], a[52:55], v[172:175]
    s_add_u32 m0, s42, 81920
    ds_read_b64_tr_b16 a[164:165], v28 offset:24576
    v_mfma_f32_16x16x32_bf16 v[172:175], a[172:175], a[60:63], v[172:175]
    s_waitcnt lgkmcnt(9)
    ds_read_b64_tr_b16 a[166:167], v28 offset:28672
    buffer_load_dwordx4 v42, s[16:19], s49 offen lds
    v_mfma_f32_16x16x32_bf16 v[176:179], a[176:179], a[48:51], v[176:179]
    s_waitcnt lgkmcnt(8)
    ds_read_b64_tr_b16 a[168:169], v29 offset:16384
    v_mfma_f32_16x16x32_bf16 v[176:179], a[180:183], a[56:59], v[176:179]
    ds_read_b64_tr_b16 a[170:171], v29 offset:20480
    v_mfma_f32_16x16x32_bf16 v[180:183], a[176:179], a[52:55], v[180:183]
    ds_read_b64_tr_b16 a[172:173], v29 offset:24576
    v_mfma_f32_16x16x32_bf16 v[180:183], a[180:183], a[60:63], v[180:183]
    s_waitcnt lgkmcnt(9)
    ds_read_b64_tr_b16 a[174:175], v29 offset:28672
    buffer_load_dwordx4 v43, s[16:19], s49 offen offset:1024 lds
    v_mfma_f32_16x16x32_bf16 v[184:187], a[184:187], a[48:51], v[184:187]
    s_waitcnt lgkmcnt(8)
    ds_read_b64_tr_b16 a[176:177], v30 offset:16384
    v_mfma_f32_16x16x32_bf16 v[184:187], a[188:191], a[56:59], v[184:187]
    ds_read_b64_tr_b16 a[178:179], v30 offset:20480
    v_mfma_f32_16x16x32_bf16 v[188:191], a[184:187], a[52:55], v[188:191]
    ds_read_b64_tr_b16 a[180:181], v30 offset:24576
    v_mfma_f32_16x16x32_bf16 v[188:191], a[188:191], a[60:63], v[188:191]
    s_waitcnt lgkmcnt(9)
    ds_read_b64_tr_b16 a[182:183], v30 offset:28672
    buffer_load_dwordx4 v44, s[16:19], s49 offen offset:2048 lds
    v_mfma_f32_16x16x32_bf16 v[192:195], a[160:163], a[48:51], v[192:195]
    s_waitcnt lgkmcnt(8)
    ds_read_b64_tr_b16 a[184:185], v31 offset:16384
    v_mfma_f32_16x16x32_bf16 v[192:195], a[164:167], a[56:59], v[192:195]
    ds_read_b64_tr_b16 a[186:187], v31 offset:20480
    v_mfma_f32_16x16x32_bf16 v[196:199], a[160:163], a[52:55], v[196:199]
    ds_read_b64_tr_b16 a[188:189], v31 offset:24576
    v_mfma_f32_16x16x32_bf16 v[196:199], a[164:167], a[60:63], v[196:199]
    s_waitcnt lgkmcnt(9)
    ds_read_b64_tr_b16 a[190:191], v31 offset:28672
    buffer_load_dwordx4 v45, s[16:19], s49 offen offset:3072 lds
    v_mfma_f32_16x16x32_bf16 v[200:203], a[168:171], a[48:51], v[200:203]
    s_waitcnt lgkmcnt(8)
    ds_read_b64_tr_b16 a[160:161], v32 offset:16384
    v_mfma_f32_16x16x32_bf16 v[200:203], a[172:175], a[56:59], v[200:203]
    ds_read_b64_tr_b16 a[162:163], v32 offset:20480
    v_mfma_f32_16x16x32_bf16 v[204:207], a[168:171], a[52:55], v[204:207]
    ds_read_b64_tr_b16 a[164:165], v32 offset:24576
    v_mfma_f32_16x16x32_bf16 v[204:207], a[172:175], a[60:63], v[204:207]
    s_waitcnt lgkmcnt(9)
    ds_read_b64_tr_b16 a[166:167], v32 offset:28672
    v_mfma_f32_16x16x32_bf16 v[208:211], a[176:179], a[48:51], v[208:211]
    s_waitcnt lgkmcnt(8)
    ds_read_b64_tr_b16 a[168:169], v33 offset:16384
    v_mfma_f32_16x16x32_bf16 v[208:211], a[180:183], a[56:59], v[208:211]
    ds_read_b64_tr_b16 a[170:171], v33 offset:20480
    v_mfma_f32_16x16x32_bf16 v[212:215], a[176:179], a[52:55], v[212:215]
    ds_read_b64_tr_b16 a[172:173], v33 offset:24576
    v_mfma_f32_16x16x32_bf16 v[212:215], a[180:183], a[60:63], v[212:215]
    s_waitcnt lgkmcnt(9)
    ds_read_b64_tr_b16 a[174:175], v33 offset:28672
    v_mfma_f32_16x16x32_bf16 v[216:219], a[184:187], a[48:51], v[216:219]
    s_waitcnt lgkmcnt(8)
    ds_read_b64_tr_b16 a[176:177], v34 offset:16384
    v_mfma_f32_16x16x32_bf16 v[216:219], a[188:191], a[56:59], v[216:219]
    ds_read_b64_tr_b16 a[178:179], v34 offset:20480
    v_mfma_f32_16x16x32_bf16 v[220:223], a[184:187], a[52:55], v[220:223]
    ds_read_b64_tr_b16 a[180:181], v34 offset:24576
    v_mfma_f32_16x16x32_bf16 v[220:223], a[188:191], a[60:63], v[220:223]
    s_waitcnt lgkmcnt(9)
    ds_read_b64_tr_b16 a[182:183], v34 offset:28672
    v_mfma_f32_16x16x32_bf16 v[224:227], a[160:163], a[48:51], v[224:227]
    s_waitcnt lgkmcnt(8)
    ds_read_b64_tr_b16 a[184:185], v35 offset:16384
    v_mfma_f32_16x16x32_bf16 v[224:227], a[164:167], a[56:59], v[224:227]
    ds_read_b64_tr_b16 a[186:187], v35 offset:20480
    v_mfma_f32_16x16x32_bf16 v[228:231], a[160:163], a[52:55], v[228:231]
    ds_read_b64_tr_b16 a[188:189], v35 offset:24576
    v_mfma_f32_16x16x32_bf16 v[228:231], a[164:167], a[60:63], v[228:231]
    s_waitcnt lgkmcnt(9)
    ds_read_b64_tr_b16 a[190:191], v35 offset:28672
    s_waitcnt vmcnt(36)
    s_barrier
    v_mfma_f32_16x16x32_bf16 v[232:235], a[168:171], a[48:51], v[232:235]
    s_waitcnt lgkmcnt(8)
    ds_read_b64_tr_b16 a[160:161], v12 offset:0
    v_mfma_f32_16x16x32_bf16 v[232:235], a[172:175], a[56:59], v[232:235]
    s_add_u32 s49, s44, 3670016
    ds_read_b64_tr_b16 a[162:163], v12 offset:4096
    v_mfma_f32_16x16x32_bf16 v[236:239], a[168:171], a[52:55], v[236:239]
    s_add_u32 m0, s42, 98304
    ds_read_b64_tr_b16 a[164:165], v12 offset:8192
    v_mfma_f32_16x16x32_bf16 v[236:239], a[172:175], a[60:63], v[236:239]
    s_waitcnt lgkmcnt(9)
    ds_read_b64_tr_b16 a[166:167], v12 offset:12288
    buffer_load_dwordx4 v42, s[16:19], s49 offen lds
    v_mfma_f32_16x16x32_bf16 v[240:243], a[176:179], a[48:51], v[240:243]
    s_waitcnt lgkmcnt(8)
    ds_read_b64_tr_b16 a[168:169], v13 offset:0
    v_mfma_f32_16x16x32_bf16 v[240:243], a[180:183], a[56:59], v[240:243]
    ds_read_b64_tr_b16 a[170:171], v13 offset:4096
    v_mfma_f32_16x16x32_bf16 v[244:247], a[176:179], a[52:55], v[244:247]
    ds_read_b64_tr_b16 a[172:173], v13 offset:8192
    v_mfma_f32_16x16x32_bf16 v[244:247], a[180:183], a[60:63], v[244:247]
    s_waitcnt lgkmcnt(9)
    ds_read_b64_tr_b16 a[174:175], v13 offset:12288
    buffer_load_dwordx4 v43, s[16:19], s49 offen offset:1024 lds
    v_mfma_f32_16x16x32_bf16 v[248:251], a[184:187], a[48:51], v[248:251]
    s_waitcnt lgkmcnt(8)
    ds_read_b64_tr_b16 a[176:177], v14 offset:0
    v_mfma_f32_16x16x32_bf16 v[248:251], a[188:191], a[56:59], v[248:251]
    ds_read_b64_tr_b16 a[178:179], v14 offset:4096
    v_mfma_f32_16x16x32_bf16 v[252:255], a[184:187], a[52:55], v[252:255]
    ds_read_b64_tr_b16 a[180:181], v14 offset:8192
    v_mfma_f32_16x16x32_bf16 v[252:255], a[188:191], a[60:63], v[252:255]
    s_waitcnt vmcnt(37)
    s_waitcnt lgkmcnt(9)
    ds_read_b64_tr_b16 a[182:183], v14 offset:12288
    buffer_load_dwordx4 v44, s[16:19], s49 offen offset:2048 lds
    v_mfma_f32_16x16x32_bf16 v[128:131], a[160:163], a[64:67], v[128:131]
    s_waitcnt vmcnt(37)
    s_waitcnt lgkmcnt(8)
    ds_read_b64_tr_b16 a[184:185], v15 offset:0
    v_mfma_f32_16x16x32_bf16 v[128:131], a[164:167], a[72:75], v[128:131]
    s_waitcnt vmcnt(36)
    ds_read_b64_tr_b16 a[186:187], v15 offset:4096
    v_mfma_f32_16x16x32_bf16 v[132:135], a[160:163], a[68:71], v[132:135]
    s_waitcnt vmcnt(35)
    ds_read_b64_tr_b16 a[188:189], v15 offset:8192
    v_mfma_f32_16x16x32_bf16 v[132:135], a[164:167], a[76:79], v[132:135]
    s_waitcnt lgkmcnt(9)
    ds_read_b64_tr_b16 a[190:191], v15 offset:12288
    buffer_load_dwordx4 v45, s[16:19], s49 offen offset:3072 lds
    v_mfma_f32_16x16x32_bf16 v[136:139], a[168:171], a[64:67], v[136:139]
    s_waitcnt lgkmcnt(8)
    ds_read_b64_tr_b16 a[160:161], v16 offset:0
    v_mfma_f32_16x16x32_bf16 v[136:139], a[172:175], a[72:75], v[136:139]
    s_add_u32 s49, s44, 3670272
    ds_read_b64_tr_b16 a[162:163], v16 offset:4096
    v_mfma_f32_16x16x32_bf16 v[140:143], a[168:171], a[68:71], v[140:143]
    s_add_u32 m0, s42, 114688
    ds_read_b64_tr_b16 a[164:165], v16 offset:8192
    v_mfma_f32_16x16x32_bf16 v[140:143], a[172:175], a[76:79], v[140:143]
    s_waitcnt lgkmcnt(9)
    ds_read_b64_tr_b16 a[166:167], v16 offset:12288
    buffer_load_dwordx4 v42, s[16:19], s49 offen lds
    v_mfma_f32_16x16x32_bf16 v[144:147], a[176:179], a[64:67], v[144:147]
    s_waitcnt lgkmcnt(8)
    ds_read_b64_tr_b16 a[168:169], v17 offset:0
    v_mfma_f32_16x16x32_bf16 v[144:147], a[180:183], a[72:75], v[144:147]
    ds_read_b64_tr_b16 a[170:171], v17 offset:4096
    v_mfma_f32_16x16x32_bf16 v[148:151], a[176:179], a[68:71], v[148:151]
    ds_read_b64_tr_b16 a[172:173], v17 offset:8192
    v_mfma_f32_16x16x32_bf16 v[148:151], a[180:183], a[76:79], v[148:151]
    s_waitcnt lgkmcnt(9)
    ds_read_b64_tr_b16 a[174:175], v17 offset:12288
    buffer_load_dwordx4 v43, s[16:19], s49 offen offset:1024 lds
    v_mfma_f32_16x16x32_bf16 v[152:155], a[184:187], a[64:67], v[152:155]
    s_waitcnt lgkmcnt(8)
    ds_read_b64_tr_b16 a[176:177], v18 offset:0
    v_mfma_f32_16x16x32_bf16 v[152:155], a[188:191], a[72:75], v[152:155]
    ds_read_b64_tr_b16 a[178:179], v18 offset:4096
    v_mfma_f32_16x16x32_bf16 v[156:159], a[184:187], a[68:71], v[156:159]
    ds_read_b64_tr_b16 a[180:181], v18 offset:8192
    v_mfma_f32_16x16x32_bf16 v[156:159], a[188:191], a[76:79], v[156:159]
    s_waitcnt lgkmcnt(9)
    ds_read_b64_tr_b16 a[182:183], v18 offset:12288
    buffer_load_dwordx4 v44, s[16:19], s49 offen offset:2048 lds
    v_mfma_f32_16x16x32_bf16 v[160:163], a[160:163], a[64:67], v[160:163]
    s_waitcnt lgkmcnt(8)
    ds_read_b64_tr_b16 a[184:185], v19 offset:0
    v_mfma_f32_16x16x32_bf16 v[160:163], a[164:167], a[72:75], v[160:163]
    ds_read_b64_tr_b16 a[186:187], v19 offset:4096
    v_mfma_f32_16x16x32_bf16 v[164:167], a[160:163], a[68:71], v[164:167]
    ds_read_b64_tr_b16 a[188:189], v19 offset:8192
    v_mfma_f32_16x16x32_bf16 v[164:167], a[164:167], a[76:79], v[164:167]
    s_waitcnt lgkmcnt(9)
    ds_read_b64_tr_b16 a[190:191], v19 offset:12288
    buffer_load_dwordx4 v45, s[16:19], s49 offen offset:3072 lds
    v_mfma_f32_16x16x32_bf16 v[168:171], a[168:171], a[64:67], v[168:171]
    s_waitcnt lgkmcnt(8)
    ds_read_b64_tr_b16 a[160:161], v12 offset:16384
    v_mfma_f32_16x16x32_bf16 v[168:171], a[172:175], a[72:75], v[168:171]
    ds_read_b64_tr_b16 a[162:163], v12 offset:20480
    v_mfma_f32_16x16x32_bf16 v[172:175], a[168:171], a[68:71], v[172:175]
    ds_read_b64_tr_b16 a[164:165], v12 offset:24576
    v_mfma_f32_16x16x32_bf16 v[172:175], a[172:175], a[76:79], v[172:175]
    s_waitcnt lgkmcnt(9)
    ds_read_b64_tr_b16 a[166:167], v12 offset:28672
    buffer_atomic_add v65, v64, s[88:91], 0 offen sc1
    v_mfma_f32_16x16x32_bf16 v[176:179], a[176:179], a[64:67], v[176:179]
    s_waitcnt lgkmcnt(8)
    ds_read_b64_tr_b16 a[168:169], v13 offset:16384
    v_mfma_f32_16x16x32_bf16 v[176:179], a[180:183], a[72:75], v[176:179]
    ds_read_b64_tr_b16 a[170:171], v13 offset:20480
    v_mfma_f32_16x16x32_bf16 v[180:183], a[176:179], a[68:71], v[180:183]
    ds_read_b64_tr_b16 a[172:173], v13 offset:24576
    v_mfma_f32_16x16x32_bf16 v[180:183], a[180:183], a[76:79], v[180:183]
    s_waitcnt lgkmcnt(9)
    ds_read_b64_tr_b16 a[174:175], v13 offset:28672
    v_mfma_f32_16x16x32_bf16 v[184:187], a[184:187], a[64:67], v[184:187]
    s_waitcnt lgkmcnt(8)
    ds_read_b64_tr_b16 a[176:177], v14 offset:16384
    v_mfma_f32_16x16x32_bf16 v[184:187], a[188:191], a[72:75], v[184:187]
    ds_read_b64_tr_b16 a[178:179], v14 offset:20480
    v_mfma_f32_16x16x32_bf16 v[188:191], a[184:187], a[68:71], v[188:191]
    ds_read_b64_tr_b16 a[180:181], v14 offset:24576
    v_mfma_f32_16x16x32_bf16 v[188:191], a[188:191], a[76:79], v[188:191]
    s_waitcnt lgkmcnt(9)
    ds_read_b64_tr_b16 a[182:183], v14 offset:28672
    v_mfma_f32_16x16x32_bf16 v[192:195], a[160:163], a[64:67], v[192:195]
    s_waitcnt lgkmcnt(8)
    ds_read_b64_tr_b16 a[184:185], v15 offset:16384
    v_mfma_f32_16x16x32_bf16 v[192:195], a[164:167], a[72:75], v[192:195]
    ds_read_b64_tr_b16 a[186:187], v15 offset:20480
    v_mfma_f32_16x16x32_bf16 v[196:199], a[160:163], a[68:71], v[196:199]
    ds_read_b64_tr_b16 a[188:189], v15 offset:24576
    v_mfma_f32_16x16x32_bf16 v[196:199], a[164:167], a[76:79], v[196:199]
    s_waitcnt lgkmcnt(9)
    ds_read_b64_tr_b16 a[190:191], v15 offset:28672
    v_mfma_f32_16x16x32_bf16 v[200:203], a[168:171], a[64:67], v[200:203]
    s_waitcnt lgkmcnt(8)
    ds_read_b64_tr_b16 a[160:161], v16 offset:16384
    v_mfma_f32_16x16x32_bf16 v[200:203], a[172:175], a[72:75], v[200:203]
    ds_read_b64_tr_b16 a[162:163], v16 offset:20480
    v_mfma_f32_16x16x32_bf16 v[204:207], a[168:171], a[68:71], v[204:207]
    ds_read_b64_tr_b16 a[164:165], v16 offset:24576
    v_mfma_f32_16x16x32_bf16 v[204:207], a[172:175], a[76:79], v[204:207]
    s_waitcnt lgkmcnt(9)
    ds_read_b64_tr_b16 a[166:167], v16 offset:28672
    v_mfma_f32_16x16x32_bf16 v[208:211], a[176:179], a[64:67], v[208:211]
    s_waitcnt lgkmcnt(8)
    ds_read_b64_tr_b16 a[168:169], v17 offset:16384
    v_mfma_f32_16x16x32_bf16 v[208:211], a[180:183], a[72:75], v[208:211]
    ds_read_b64_tr_b16 a[170:171], v17 offset:20480
    v_mfma_f32_16x16x32_bf16 v[212:215], a[176:179], a[68:71], v[212:215]
    ds_read_b64_tr_b16 a[172:173], v17 offset:24576
    v_mfma_f32_16x16x32_bf16 v[212:215], a[180:183], a[76:79], v[212:215]
    s_waitcnt lgkmcnt(9)
    ds_read_b64_tr_b16 a[174:175], v17 offset:28672
    v_mfma_f32_16x16x32_bf16 v[216:219], a[184:187], a[64:67], v[216:219]
    s_waitcnt lgkmcnt(8)
    ds_read_b64_tr_b16 a[176:177], v18 offset:16384
    v_mfma_f32_16x16x32_bf16 v[216:219], a[188:191], a[72:75], v[216:219]
    ds_read_b64_tr_b16 a[178:179], v18 offset:20480
    v_mfma_f32_16x16x32_bf16 v[220:223], a[184:187], a[68:71], v[220:223]
    ds_read_b64_tr_b16 a[180:181], v18 offset:24576
    v_mfma_f32_16x16x32_bf16 v[220:223], a[188:191], a[76:79], v[220:223]
    s_waitcnt lgkmcnt(9)
    ds_read_b64_tr_b16 a[182:183], v18 offset:28672
    v_mfma_f32_16x16x32_bf16 v[224:227], a[160:163], a[64:67], v[224:227]
    s_waitcnt lgkmcnt(8)
    ds_read_b64_tr_b16 a[184:185], v19 offset:16384
    v_mfma_f32_16x16x32_bf16 v[224:227], a[164:167], a[72:75], v[224:227]
    ds_read_b64_tr_b16 a[186:187], v19 offset:20480
    v_mfma_f32_16x16x32_bf16 v[228:231], a[160:163], a[68:71], v[228:231]
    ds_read_b64_tr_b16 a[188:189], v19 offset:24576
    v_mfma_f32_16x16x32_bf16 v[228:231], a[164:167], a[76:79], v[228:231]
    s_waitcnt lgkmcnt(9)
    ds_read_b64_tr_b16 a[190:191], v19 offset:28672
    s_waitcnt vmcnt(21)
    s_barrier
    v_mfma_f32_16x16x32_bf16 v[232:235], a[168:171], a[64:67], v[232:235]
    s_waitcnt lgkmcnt(8)
    ds_read_b64_tr_b16 a[160:161], v12 offset:32768
    v_mfma_f32_16x16x32_bf16 v[232:235], a[172:175], a[72:75], v[232:235]
    s_add_u32 s49, s44, 4194304
    ds_read_b64_tr_b16 a[162:163], v12 offset:36864
    v_mfma_f32_16x16x32_bf16 v[236:239], a[168:171], a[68:71], v[236:239]
    s_add_u32 m0, s42, 131072
    ds_read_b64_tr_b16 a[164:165], v12 offset:40960
    v_mfma_f32_16x16x32_bf16 v[236:239], a[172:175], a[76:79], v[236:239]
    s_waitcnt lgkmcnt(9)
    ds_read_b64_tr_b16 a[166:167], v12 offset:45056
    buffer_load_dwordx4 v42, s[16:19], s49 offen lds
    v_mfma_f32_16x16x32_bf16 v[240:243], a[176:179], a[64:67], v[240:243]
    s_waitcnt lgkmcnt(8)
    ds_read_b64_tr_b16 a[168:169], v13 offset:32768
    v_mfma_f32_16x16x32_bf16 v[240:243], a[180:183], a[72:75], v[240:243]
    ds_read_b64_tr_b16 a[170:171], v13 offset:36864
    v_mfma_f32_16x16x32_bf16 v[244:247], a[176:179], a[68:71], v[244:247]
    ds_read_b64_tr_b16 a[172:173], v13 offset:40960
    v_mfma_f32_16x16x32_bf16 v[244:247], a[180:183], a[76:79], v[244:247]
    s_waitcnt lgkmcnt(9)
    ds_read_b64_tr_b16 a[174:175], v13 offset:45056
    buffer_load_dwordx4 v43, s[16:19], s49 offen offset:1024 lds
    v_mfma_f32_16x16x32_bf16 v[248:251], a[184:187], a[64:67], v[248:251]
    s_waitcnt lgkmcnt(8)
    ds_read_b64_tr_b16 a[176:177], v14 offset:32768
    v_mfma_f32_16x16x32_bf16 v[248:251], a[188:191], a[72:75], v[248:251]
    ds_read_b64_tr_b16 a[178:179], v14 offset:36864
    v_mfma_f32_16x16x32_bf16 v[252:255], a[184:187], a[68:71], v[252:255]
    ds_read_b64_tr_b16 a[180:181], v14 offset:40960
    v_mfma_f32_16x16x32_bf16 v[252:255], a[188:191], a[76:79], v[252:255]
    s_waitcnt lgkmcnt(9)
    ds_read_b64_tr_b16 a[182:183], v14 offset:45056
    buffer_load_dwordx4 v44, s[16:19], s49 offen offset:2048 lds
    v_mfma_f32_16x16x32_bf16 v[128:131], a[160:163], a[80:83], v[128:131]
    s_waitcnt lgkmcnt(8)
    ds_read_b64_tr_b16 a[184:185], v15 offset:32768
    v_mfma_f32_16x16x32_bf16 v[128:131], a[164:167], a[88:91], v[128:131]
    ds_read_b64_tr_b16 a[186:187], v15 offset:36864
    v_mfma_f32_16x16x32_bf16 v[132:135], a[160:163], a[84:87], v[132:135]
    ds_read_b64_tr_b16 a[188:189], v15 offset:40960
    v_mfma_f32_16x16x32_bf16 v[132:135], a[164:167], a[92:95], v[132:135]
    s_waitcnt lgkmcnt(9)
    ds_read_b64_tr_b16 a[190:191], v15 offset:45056
    buffer_load_dwordx4 v45, s[16:19], s49 offen offset:3072 lds
    v_mfma_f32_16x16x32_bf16 v[136:139], a[168:171], a[80:83], v[136:139]
    s_waitcnt lgkmcnt(8)
    ds_read_b64_tr_b16 a[160:161], v16 offset:32768
    v_mfma_f32_16x16x32_bf16 v[136:139], a[172:175], a[88:91], v[136:139]
    s_add_u32 s49, s44, 4194560
    ds_read_b64_tr_b16 a[162:163], v16 offset:36864
    v_mfma_f32_16x16x32_bf16 v[140:143], a[168:171], a[84:87], v[140:143]
    s_add_u32 m0, s42, 147456
    ds_read_b64_tr_b16 a[164:165], v16 offset:40960
    v_mfma_f32_16x16x32_bf16 v[140:143], a[172:175], a[92:95], v[140:143]
    s_waitcnt lgkmcnt(9)
    ds_read_b64_tr_b16 a[166:167], v16 offset:45056
    buffer_load_dwordx4 v42, s[16:19], s49 offen lds
    v_mfma_f32_16x16x32_bf16 v[144:147], a[176:179], a[80:83], v[144:147]
    s_waitcnt lgkmcnt(8)
    ds_read_b64_tr_b16 a[168:169], v17 offset:32768
    v_mfma_f32_16x16x32_bf16 v[144:147], a[180:183], a[88:91], v[144:147]
    ds_read_b64_tr_b16 a[170:171], v17 offset:36864
    v_mfma_f32_16x16x32_bf16 v[148:151], a[176:179], a[84:87], v[148:151]
    ds_read_b64_tr_b16 a[172:173], v17 offset:40960
    v_mfma_f32_16x16x32_bf16 v[148:151], a[180:183], a[92:95], v[148:151]
    s_waitcnt lgkmcnt(9)
    ds_read_b64_tr_b16 a[174:175], v17 offset:45056
    buffer_load_dwordx4 v43, s[16:19], s49 offen offset:1024 lds
    v_mfma_f32_16x16x32_bf16 v[152:155], a[184:187], a[80:83], v[152:155]
    s_waitcnt lgkmcnt(8)
    ds_read_b64_tr_b16 a[176:177], v18 offset:32768
    v_mfma_f32_16x16x32_bf16 v[152:155], a[188:191], a[88:91], v[152:155]
    ds_read_b64_tr_b16 a[178:179], v18 offset:36864
    v_mfma_f32_16x16x32_bf16 v[156:159], a[184:187], a[84:87], v[156:159]
    ds_read_b64_tr_b16 a[180:181], v18 offset:40960
    v_mfma_f32_16x16x32_bf16 v[156:159], a[188:191], a[92:95], v[156:159]
    s_waitcnt lgkmcnt(9)
    ds_read_b64_tr_b16 a[182:183], v18 offset:45056
    buffer_load_dwordx4 v44, s[16:19], s49 offen offset:2048 lds
    v_mfma_f32_16x16x32_bf16 v[160:163], a[160:163], a[80:83], v[160:163]
    s_waitcnt lgkmcnt(8)
    ds_read_b64_tr_b16 a[184:185], v19 offset:32768
    v_mfma_f32_16x16x32_bf16 v[160:163], a[164:167], a[88:91], v[160:163]
    ds_read_b64_tr_b16 a[186:187], v19 offset:36864
    v_mfma_f32_16x16x32_bf16 v[164:167], a[160:163], a[84:87], v[164:167]
    ds_read_b64_tr_b16 a[188:189], v19 offset:40960
    v_mfma_f32_16x16x32_bf16 v[164:167], a[164:167], a[92:95], v[164:167]
    s_waitcnt lgkmcnt(9)
    ds_read_b64_tr_b16 a[190:191], v19 offset:45056
    buffer_load_dwordx4 v45, s[16:19], s49 offen offset:3072 lds
    v_mfma_f32_16x16x32_bf16 v[168:171], a[168:171], a[80:83], v[168:171]
    s_waitcnt lgkmcnt(8)
    ds_read_b64_tr_b16 a[160:161], v12 offset:49152
    v_mfma_f32_16x16x32_bf16 v[168:171], a[172:175], a[88:91], v[168:171]
    ds_read_b64_tr_b16 a[162:163], v12 offset:53248
    v_mfma_f32_16x16x32_bf16 v[172:175], a[168:171], a[84:87], v[172:175]
    ds_read_b64_tr_b16 a[164:165], v12 offset:57344
    v_mfma_f32_16x16x32_bf16 v[172:175], a[172:175], a[92:95], v[172:175]
    s_waitcnt lgkmcnt(9)
    ds_read_b64_tr_b16 a[166:167], v12 offset:61440
    v_mfma_f32_16x16x32_bf16 v[176:179], a[176:179], a[80:83], v[176:179]
    s_waitcnt lgkmcnt(8)
    ds_read_b64_tr_b16 a[168:169], v13 offset:49152
    v_mfma_f32_16x16x32_bf16 v[176:179], a[180:183], a[88:91], v[176:179]
    ds_read_b64_tr_b16 a[170:171], v13 offset:53248
    v_mfma_f32_16x16x32_bf16 v[180:183], a[176:179], a[84:87], v[180:183]
    ds_read_b64_tr_b16 a[172:173], v13 offset:57344
    v_mfma_f32_16x16x32_bf16 v[180:183], a[180:183], a[92:95], v[180:183]
    s_waitcnt lgkmcnt(9)
    ds_read_b64_tr_b16 a[174:175], v13 offset:61440
    v_mfma_f32_16x16x32_bf16 v[184:187], a[184:187], a[80:83], v[184:187]
    s_waitcnt lgkmcnt(8)
    ds_read_b64_tr_b16 a[176:177], v14 offset:49152
    v_mfma_f32_16x16x32_bf16 v[184:187], a[188:191], a[88:91], v[184:187]
    ds_read_b64_tr_b16 a[178:179], v14 offset:53248
    v_mfma_f32_16x16x32_bf16 v[188:191], a[184:187], a[84:87], v[188:191]
    ds_read_b64_tr_b16 a[180:181], v14 offset:57344
    v_mfma_f32_16x16x32_bf16 v[188:191], a[188:191], a[92:95], v[188:191]
    s_waitcnt lgkmcnt(9)
    ds_read_b64_tr_b16 a[182:183], v14 offset:61440
    v_mfma_f32_16x16x32_bf16 v[192:195], a[160:163], a[80:83], v[192:195]
    s_waitcnt lgkmcnt(8)
    ds_read_b64_tr_b16 a[184:185], v15 offset:49152
    v_mfma_f32_16x16x32_bf16 v[192:195], a[164:167], a[88:91], v[192:195]
    ds_read_b64_tr_b16 a[186:187], v15 offset:53248
    v_mfma_f32_16x16x32_bf16 v[196:199], a[160:163], a[84:87], v[196:199]
    ds_read_b64_tr_b16 a[188:189], v15 offset:57344
    v_mfma_f32_16x16x32_bf16 v[196:199], a[164:167], a[92:95], v[196:199]
    s_waitcnt lgkmcnt(9)
    ds_read_b64_tr_b16 a[190:191], v15 offset:61440
    v_mfma_f32_16x16x32_bf16 v[200:203], a[168:171], a[80:83], v[200:203]
    s_waitcnt lgkmcnt(8)
    ds_read_b64_tr_b16 a[160:161], v16 offset:49152
    v_mfma_f32_16x16x32_bf16 v[200:203], a[172:175], a[88:91], v[200:203]
    ds_read_b64_tr_b16 a[162:163], v16 offset:53248
    v_mfma_f32_16x16x32_bf16 v[204:207], a[168:171], a[84:87], v[204:207]
    ds_read_b64_tr_b16 a[164:165], v16 offset:57344
    v_mfma_f32_16x16x32_bf16 v[204:207], a[172:175], a[92:95], v[204:207]
    s_waitcnt lgkmcnt(9)
    ds_read_b64_tr_b16 a[166:167], v16 offset:61440
    v_mfma_f32_16x16x32_bf16 v[208:211], a[176:179], a[80:83], v[208:211]
    s_waitcnt lgkmcnt(8)
    ds_read_b64_tr_b16 a[168:169], v17 offset:49152
    v_mfma_f32_16x16x32_bf16 v[208:211], a[180:183], a[88:91], v[208:211]
    ds_read_b64_tr_b16 a[170:171], v17 offset:53248
    v_mfma_f32_16x16x32_bf16 v[212:215], a[176:179], a[84:87], v[212:215]
    ds_read_b64_tr_b16 a[172:173], v17 offset:57344
    v_mfma_f32_16x16x32_bf16 v[212:215], a[180:183], a[92:95], v[212:215]
    s_waitcnt lgkmcnt(9)
    ds_read_b64_tr_b16 a[174:175], v17 offset:61440
    v_mfma_f32_16x16x32_bf16 v[216:219], a[184:187], a[80:83], v[216:219]
    s_waitcnt lgkmcnt(8)
    ds_read_b64_tr_b16 a[176:177], v18 offset:49152
    v_mfma_f32_16x16x32_bf16 v[216:219], a[188:191], a[88:91], v[216:219]
    ds_read_b64_tr_b16 a[178:179], v18 offset:53248
    v_mfma_f32_16x16x32_bf16 v[220:223], a[184:187], a[84:87], v[220:223]
    ds_read_b64_tr_b16 a[180:181], v18 offset:57344
    v_mfma_f32_16x16x32_bf16 v[220:223], a[188:191], a[92:95], v[220:223]
    s_waitcnt lgkmcnt(9)
    ds_read_b64_tr_b16 a[182:183], v18 offset:61440
    v_mfma_f32_16x16x32_bf16 v[224:227], a[160:163], a[80:83], v[224:227]
    s_waitcnt lgkmcnt(8)
    ds_read_b64_tr_b16 a[184:185], v19 offset:49152
    v_mfma_f32_16x16x32_bf16 v[224:227], a[164:167], a[88:91], v[224:227]
    ds_read_b64_tr_b16 a[186:187], v19 offset:53248
    v_mfma_f32_16x16x32_bf16 v[228:231], a[160:163], a[84:87], v[228:231]
    ds_read_b64_tr_b16 a[188:189], v19 offset:57344
    v_mfma_f32_16x16x32_bf16 v[228:231], a[164:167], a[92:95], v[228:231]
    s_waitcnt lgkmcnt(9)
    ds_read_b64_tr_b16 a[190:191], v19 offset:61440
    s_waitcnt vmcnt(17)
    s_barrier
    v_mfma_f32_16x16x32_bf16 v[232:235], a[168:171], a[80:83], v[232:235]
    s_waitcnt lgkmcnt(8)
    ds_read_b64_tr_b16 a[160:161], v20 offset:0
    v_mfma_f32_16x16x32_bf16 v[232:235], a[172:175], a[88:91], v[232:235]
    ds_read_b64_tr_b16 a[162:163], v20 offset:4096
    v_mfma_f32_16x16x32_bf16 v[236:239], a[168:171], a[84:87], v[236:239]
    s_add_u32 m0, s42, 0
    ds_read_b64_tr_b16 a[164:165], v20 offset:8192
    v_mfma_f32_16x16x32_bf16 v[236:239], a[172:175], a[92:95], v[236:239]
    s_waitcnt lgkmcnt(9)
    ds_read_b64_tr_b16 a[166:167], v20 offset:12288
    buffer_load_dwordx4 v36, s[8:11], s40 offen lds
    v_mfma_f32_16x16x32_bf16 v[240:243], a[176:179], a[80:83], v[240:243]
    s_waitcnt lgkmcnt(8)
    ds_read_b64_tr_b16 a[168:169], v21 offset:0
    v_mfma_f32_16x16x32_bf16 v[240:243], a[180:183], a[88:91], v[240:243]
    ds_read_b64_tr_b16 a[170:171], v21 offset:4096
    v_mfma_f32_16x16x32_bf16 v[244:247], a[176:179], a[84:87], v[244:247]
    ds_read_b64_tr_b16 a[172:173], v21 offset:8192
    v_mfma_f32_16x16x32_bf16 v[244:247], a[180:183], a[92:95], v[244:247]
    s_waitcnt lgkmcnt(9)
    ds_read_b64_tr_b16 a[174:175], v21 offset:12288
    buffer_load_dwordx4 v37, s[8:11], s40 offen offset:1024 lds
    v_mfma_f32_16x16x32_bf16 v[248:251], a[184:187], a[80:83], v[248:251]
    s_waitcnt lgkmcnt(8)
    ds_read_b64_tr_b16 a[176:177], v22 offset:0
    v_mfma_f32_16x16x32_bf16 v[248:251], a[188:191], a[88:91], v[248:251]
    ds_read_b64_tr_b16 a[178:179], v22 offset:4096
    v_mfma_f32_16x16x32_bf16 v[252:255], a[184:187], a[84:87], v[252:255]
    ds_read_b64_tr_b16 a[180:181], v22 offset:8192
    v_mfma_f32_16x16x32_bf16 v[252:255], a[188:191], a[92:95], v[252:255]
    s_waitcnt lgkmcnt(9)
    ds_read_b64_tr_b16 a[182:183], v22 offset:12288
    buffer_load_dwordx4 v38, s[8:11], s40 offen offset:2048 lds
    v_mfma_f32_16x16x32_bf16 v[128:131], a[160:163], a[96:99], v[128:131]
    s_waitcnt lgkmcnt(8)
    ds_read_b64_tr_b16 a[184:185], v23 offset:0
    v_mfma_f32_16x16x32_bf16 v[128:131], a[164:167], a[104:107], v[128:131]
    ds_read_b64_tr_b16 a[186:187], v23 offset:4096
    v_mfma_f32_16x16x32_bf16 v[132:135], a[160:163], a[100:103], v[132:135]
    ds_read_b64_tr_b16 a[188:189], v23 offset:8192
    v_mfma_f32_16x16x32_bf16 v[132:135], a[164:167], a[108:111], v[132:135]
    s_waitcnt lgkmcnt(9)
    ds_read_b64_tr_b16 a[190:191], v23 offset:12288
    buffer_load_dwordx4 v39, s[8:11], s40 offen offset:3072 lds
    v_mfma_f32_16x16x32_bf16 v[136:139], a[168:171], a[96:99], v[136:139]
    s_waitcnt lgkmcnt(8)
    s_add_u32 s40, s40, 16384
    ds_read_b64_tr_b16 a[160:161], v24 offset:0
    v_mfma_f32_16x16x32_bf16 v[136:139], a[172:175], a[104:107], v[136:139]
    ds_read_b64_tr_b16 a[162:163], v24 offset:4096
    v_mfma_f32_16x16x32_bf16 v[140:143], a[168:171], a[100:103], v[140:143]
    s_add_u32 m0, s42, 16384
    ds_read_b64_tr_b16 a[164:165], v24 offset:8192
    v_mfma_f32_16x16x32_bf16 v[140:143], a[172:175], a[108:111], v[140:143]
    s_waitcnt lgkmcnt(9)
    ds_read_b64_tr_b16 a[166:167], v24 offset:12288
    buffer_load_dwordx4 v36, s[8:11], s40 offen lds
    v_mfma_f32_16x16x32_bf16 v[144:147], a[176:179], a[96:99], v[144:147]
    s_waitcnt lgkmcnt(8)
    ds_read_b64_tr_b16 a[168:169], v25 offset:0
    v_mfma_f32_16x16x32_bf16 v[144:147], a[180:183], a[104:107], v[144:147]
    ds_read_b64_tr_b16 a[170:171], v25 offset:4096
    v_mfma_f32_16x16x32_bf16 v[148:151], a[176:179], a[100:103], v[148:151]
    ds_read_b64_tr_b16 a[172:173], v25 offset:8192
    v_mfma_f32_16x16x32_bf16 v[148:151], a[180:183], a[108:111], v[148:151]
    s_waitcnt lgkmcnt(9)
    ds_read_b64_tr_b16 a[174:175], v25 offset:12288
    buffer_load_dwordx4 v37, s[8:11], s40 offen offset:1024 lds
    v_mfma_f32_16x16x32_bf16 v[152:155], a[184:187], a[96:99], v[152:155]
    s_waitcnt lgkmcnt(8)
    ds_read_b64_tr_b16 a[176:177], v26 offset:0
    v_mfma_f32_16x16x32_bf16 v[152:155], a[188:191], a[104:107], v[152:155]
    ds_read_b64_tr_b16 a[178:179], v26 offset:4096
    v_mfma_f32_16x16x32_bf16 v[156:159], a[184:187], a[100:103], v[156:159]
    ds_read_b64_tr_b16 a[180:181], v26 offset:8192
    v_mfma_f32_16x16x32_bf16 v[156:159], a[188:191], a[108:111], v[156:159]
    s_waitcnt lgkmcnt(9)
    ds_read_b64_tr_b16 a[182:183], v26 offset:12288
    buffer_load_dwordx4 v38, s[8:11], s40 offen offset:2048 lds
    v_mfma_f32_16x16x32_bf16 v[160:163], a[160:163], a[96:99], v[160:163]
    s_waitcnt lgkmcnt(8)
    ds_read_b64_tr_b16 a[184:185], v27 offset:0
    v_mfma_f32_16x16x32_bf16 v[160:163], a[164:167], a[104:107], v[160:163]
    ds_read_b64_tr_b16 a[186:187], v27 offset:4096
    v_mfma_f32_16x16x32_bf16 v[164:167], a[160:163], a[100:103], v[164:167]
    ds_read_b64_tr_b16 a[188:189], v27 offset:8192
    v_mfma_f32_16x16x32_bf16 v[164:167], a[164:167], a[108:111], v[164:167]
    s_waitcnt lgkmcnt(9)
    ds_read_b64_tr_b16 a[190:191], v27 offset:12288
    buffer_load_dwordx4 v39, s[8:11], s40 offen offset:3072 lds
    v_mfma_f32_16x16x32_bf16 v[168:171], a[168:171], a[96:99], v[168:171]
    s_waitcnt lgkmcnt(8)
    s_add_u32 s40, s40, 16384
    ds_read_b64_tr_b16 a[160:161], v20 offset:16384
    v_mfma_f32_16x16x32_bf16 v[168:171], a[172:175], a[104:107], v[168:171]
    ds_read_b64_tr_b16 a[162:163], v20 offset:20480
    v_mfma_f32_16x16x32_bf16 v[172:175], a[168:171], a[100:103], v[172:175]
    ds_read_b64_tr_b16 a[164:165], v20 offset:24576
    v_mfma_f32_16x16x32_bf16 v[172:175], a[172:175], a[108:111], v[172:175]
    s_waitcnt lgkmcnt(9)
    ds_read_b64_tr_b16 a[166:167], v20 offset:28672
    v_mfma_f32_16x16x32_bf16 v[176:179], a[176:179], a[96:99], v[176:179]
    s_waitcnt lgkmcnt(8)
    ds_read_b64_tr_b16 a[168:169], v21 offset:16384
    v_mfma_f32_16x16x32_bf16 v[176:179], a[180:183], a[104:107], v[176:179]
    ds_read_b64_tr_b16 a[170:171], v21 offset:20480
    v_mfma_f32_16x16x32_bf16 v[180:183], a[176:179], a[100:103], v[180:183]
    ds_read_b64_tr_b16 a[172:173], v21 offset:24576
    v_mfma_f32_16x16x32_bf16 v[180:183], a[180:183], a[108:111], v[180:183]
    s_waitcnt lgkmcnt(9)
    ds_read_b64_tr_b16 a[174:175], v21 offset:28672
    v_mfma_f32_16x16x32_bf16 v[184:187], a[184:187], a[96:99], v[184:187]
    s_waitcnt lgkmcnt(8)
    ds_read_b64_tr_b16 a[176:177], v22 offset:16384
    v_mfma_f32_16x16x32_bf16 v[184:187], a[188:191], a[104:107], v[184:187]
    ds_read_b64_tr_b16 a[178:179], v22 offset:20480
    v_mfma_f32_16x16x32_bf16 v[188:191], a[184:187], a[100:103], v[188:191]
    ds_read_b64_tr_b16 a[180:181], v22 offset:24576
    v_mfma_f32_16x16x32_bf16 v[188:191], a[188:191], a[108:111], v[188:191]
    s_waitcnt lgkmcnt(9)
    ds_read_b64_tr_b16 a[182:183], v22 offset:28672
    v_mfma_f32_16x16x32_bf16 v[192:195], a[160:163], a[96:99], v[192:195]
    s_waitcnt lgkmcnt(8)
    ds_read_b64_tr_b16 a[184:185], v23 offset:16384
    v_accvgpr_write_b32 a0, 0
    v_mfma_f32_16x16x32_bf16 v[192:195], a[164:167], a[104:107], v[192:195]
    ds_read_b64_tr_b16 a[186:187], v23 offset:20480
    v_accvgpr_write_b32 a1, 0
    v_mfma_f32_16x16x32_bf16 v[196:199], a[160:163], a[100:103], v[196:199]
    ds_read_b64_tr_b16 a[188:189], v23 offset:24576
    v_accvgpr_write_b32 a2, 0
    v_mfma_f32_16x16x32_bf16 v[196:199], a[164:167], a[108:111], v[196:199]
    s_waitcnt lgkmcnt(9)
    ds_read_b64_tr_b16 a[190:191], v23 offset:28672
    v_accvgpr_write_b32 a3, 0
    v_mfma_f32_16x16x32_bf16 v[200:203], a[168:171], a[96:99], v[200:203]
    s_waitcnt lgkmcnt(8)
    ds_read_b64_tr_b16 a[160:161], v24 offset:16384
    v_accvgpr_write_b32 a4, 0
    v_mfma_f32_16x16x32_bf16 v[200:203], a[172:175], a[104:107], v[200:203]
    ds_read_b64_tr_b16 a[162:163], v24 offset:20480
    v_accvgpr_write_b32 a5, 0
    v_mfma_f32_16x16x32_bf16 v[204:207], a[168:171], a[100:103], v[204:207]
    ds_read_b64_tr_b16 a[164:165], v24 offset:24576
    v_accvgpr_write_b32 a6, 0
    v_mfma_f32_16x16x32_bf16 v[204:207], a[172:175], a[108:111], v[204:207]
    s_waitcnt lgkmcnt(9)
    ds_read_b64_tr_b16 a[166:167], v24 offset:28672
    v_accvgpr_write_b32 a7, 0
    v_mfma_f32_16x16x32_bf16 v[208:211], a[176:179], a[96:99], v[208:211]
    s_waitcnt lgkmcnt(8)
    ds_read_b64_tr_b16 a[168:169], v25 offset:16384
    v_accvgpr_write_b32 a8, 0
    v_mfma_f32_16x16x32_bf16 v[208:211], a[180:183], a[104:107], v[208:211]
    ds_read_b64_tr_b16 a[170:171], v25 offset:20480
    v_accvgpr_write_b32 a9, 0
    v_mfma_f32_16x16x32_bf16 v[212:215], a[176:179], a[100:103], v[212:215]
    ds_read_b64_tr_b16 a[172:173], v25 offset:24576
    v_accvgpr_write_b32 a10, 0
    v_mfma_f32_16x16x32_bf16 v[212:215], a[180:183], a[108:111], v[212:215]
    s_waitcnt lgkmcnt(9)
    ds_read_b64_tr_b16 a[174:175], v25 offset:28672
    v_accvgpr_write_b32 a11, 0
    v_mfma_f32_16x16x32_bf16 v[216:219], a[184:187], a[96:99], v[216:219]
    s_waitcnt lgkmcnt(8)
    ds_read_b64_tr_b16 a[176:177], v26 offset:16384
    v_accvgpr_write_b32 a12, 0
    v_mfma_f32_16x16x32_bf16 v[216:219], a[188:191], a[104:107], v[216:219]
    ds_read_b64_tr_b16 a[178:179], v26 offset:20480
    v_accvgpr_write_b32 a13, 0
    v_mfma_f32_16x16x32_bf16 v[220:223], a[184:187], a[100:103], v[220:223]
    ds_read_b64_tr_b16 a[180:181], v26 offset:24576
    v_accvgpr_write_b32 a14, 0
    v_mfma_f32_16x16x32_bf16 v[220:223], a[188:191], a[108:111], v[220:223]
    s_waitcnt lgkmcnt(9)
    ds_read_b64_tr_b16 a[182:183], v26 offset:28672
    v_accvgpr_write_b32 a15, 0
    v_mfma_f32_16x16x32_bf16 v[224:227], a[160:163], a[96:99], v[224:227]
    s_waitcnt lgkmcnt(8)
    ds_read_b64_tr_b16 a[184:185], v27 offset:16384
    v_accvgpr_write_b32 a16, 0
    v_mfma_f32_16x16x32_bf16 v[224:227], a[164:167], a[104:107], v[224:227]
    ds_read_b64_tr_b16 a[186:187], v27 offset:20480
    v_accvgpr_write_b32 a17, 0
    v_mfma_f32_16x16x32_bf16 v[228:231], a[160:163], a[100:103], v[228:231]
    ds_read_b64_tr_b16 a[188:189], v27 offset:24576
    v_accvgpr_write_b32 a18, 0
    v_mfma_f32_16x16x32_bf16 v[228:231], a[164:167], a[108:111], v[228:231]
    s_waitcnt lgkmcnt(9)
    ds_read_b64_tr_b16 a[190:191], v27 offset:28672
    v_accvgpr_write_b32 a19, 0
    s_waitcnt vmcnt(17)
    s_barrier
    v_mfma_f32_16x16x32_bf16 v[232:235], a[168:171], a[96:99], v[232:235]
    s_waitcnt lgkmcnt(8)
    ds_read_b64_tr_b16 a[160:161], v20 offset:32768
    v_accvgpr_write_b32 a20, 0
    v_mfma_f32_16x16x32_bf16 v[232:235], a[172:175], a[104:107], v[232:235]
    ds_read_b64_tr_b16 a[162:163], v20 offset:36864
    v_accvgpr_write_b32 a21, 0
    v_mfma_f32_16x16x32_bf16 v[236:239], a[168:171], a[100:103], v[236:239]
    s_add_u32 m0, s42, 32768
    ds_read_b64_tr_b16 a[164:165], v20 offset:40960
    v_accvgpr_write_b32 a22, 0
    v_mfma_f32_16x16x32_bf16 v[236:239], a[172:175], a[108:111], v[236:239]
    s_waitcnt lgkmcnt(9)
    ds_read_b64_tr_b16 a[166:167], v20 offset:45056
    buffer_load_dwordx4 v36, s[8:11], s40 offen lds
    v_mfma_f32_16x16x32_bf16 v[240:243], a[176:179], a[96:99], v[240:243]
    s_waitcnt lgkmcnt(8)
    ds_read_b64_tr_b16 a[168:169], v21 offset:32768
    v_accvgpr_write_b32 a23, 0
    v_mfma_f32_16x16x32_bf16 v[240:243], a[180:183], a[104:107], v[240:243]
    ds_read_b64_tr_b16 a[170:171], v21 offset:36864
    v_accvgpr_write_b32 a24, 0
    v_mfma_f32_16x16x32_bf16 v[244:247], a[176:179], a[100:103], v[244:247]
    ds_read_b64_tr_b16 a[172:173], v21 offset:40960
    v_accvgpr_write_b32 a25, 0
    v_mfma_f32_16x16x32_bf16 v[244:247], a[180:183], a[108:111], v[244:247]
    s_waitcnt lgkmcnt(9)
    ds_read_b64_tr_b16 a[174:175], v21 offset:45056
    buffer_load_dwordx4 v37, s[8:11], s40 offen offset:1024 lds
    v_mfma_f32_16x16x32_bf16 v[248:251], a[184:187], a[96:99], v[248:251]
    s_waitcnt lgkmcnt(8)
    ds_read_b64_tr_b16 a[176:177], v22 offset:32768
    v_accvgpr_write_b32 a26, 0
    v_mfma_f32_16x16x32_bf16 v[248:251], a[188:191], a[104:107], v[248:251]
    ds_read_b64_tr_b16 a[178:179], v22 offset:36864
    v_accvgpr_write_b32 a27, 0
    v_mfma_f32_16x16x32_bf16 v[252:255], a[184:187], a[100:103], v[252:255]
    ds_read_b64_tr_b16 a[180:181], v22 offset:40960
    v_accvgpr_write_b32 a28, 0
    v_mfma_f32_16x16x32_bf16 v[252:255], a[188:191], a[108:111], v[252:255]
    s_waitcnt lgkmcnt(9)
    ds_read_b64_tr_b16 a[182:183], v22 offset:45056
    buffer_load_dwordx4 v38, s[8:11], s40 offen offset:2048 lds
    v_mfma_f32_16x16x32_bf16 v[128:131], a[160:163], a[112:115], v[128:131]
    s_waitcnt lgkmcnt(8)
    ds_read_b64_tr_b16 a[184:185], v23 offset:32768
    v_accvgpr_write_b32 a29, 0
    v_mfma_f32_16x16x32_bf16 v[128:131], a[164:167], a[120:123], v[128:131]
    ds_read_b64_tr_b16 a[186:187], v23 offset:36864
    v_accvgpr_write_b32 a30, 0
    v_mfma_f32_16x16x32_bf16 v[132:135], a[160:163], a[116:119], v[132:135]
    ds_read_b64_tr_b16 a[188:189], v23 offset:40960
    v_accvgpr_write_b32 a31, 0
    v_mfma_f32_16x16x32_bf16 v[132:135], a[164:167], a[124:127], v[132:135]
    s_waitcnt lgkmcnt(9)
    ds_read_b64_tr_b16 a[190:191], v23 offset:45056
    buffer_load_dwordx4 v39, s[8:11], s40 offen offset:3072 lds
    v_mfma_f32_16x16x32_bf16 v[136:139], a[168:171], a[112:115], v[136:139]
    s_waitcnt lgkmcnt(8)
    s_add_u32 s40, s40, 16384
    ds_read_b64_tr_b16 a[160:161], v24 offset:32768
    v_accvgpr_write_b32 a32, 0
    v_mfma_f32_16x16x32_bf16 v[136:139], a[172:175], a[120:123], v[136:139]
    ds_read_b64_tr_b16 a[162:163], v24 offset:36864
    v_accvgpr_write_b32 a33, 0
    v_mfma_f32_16x16x32_bf16 v[140:143], a[168:171], a[116:119], v[140:143]
    ds_read_b64_tr_b16 a[164:165], v24 offset:40960
    v_accvgpr_write_b32 a34, 0
    v_mfma_f32_16x16x32_bf16 v[140:143], a[172:175], a[124:127], v[140:143]
    s_waitcnt lgkmcnt(9)
    ds_read_b64_tr_b16 a[166:167], v24 offset:45056
    v_accvgpr_write_b32 a35, 0
    v_mfma_f32_16x16x32_bf16 v[144:147], a[176:179], a[112:115], v[144:147]
    s_waitcnt lgkmcnt(8)
    ds_read_b64_tr_b16 a[168:169], v25 offset:32768
    v_accvgpr_write_b32 a36, 0
    v_mfma_f32_16x16x32_bf16 v[144:147], a[180:183], a[120:123], v[144:147]
    ds_read_b64_tr_b16 a[170:171], v25 offset:36864
    v_accvgpr_write_b32 a37, 0
    v_mfma_f32_16x16x32_bf16 v[148:151], a[176:179], a[116:119], v[148:151]
    ds_read_b64_tr_b16 a[172:173], v25 offset:40960
    v_accvgpr_write_b32 a38, 0
    v_mfma_f32_16x16x32_bf16 v[148:151], a[180:183], a[124:127], v[148:151]
    s_waitcnt lgkmcnt(9)
    ds_read_b64_tr_b16 a[174:175], v25 offset:45056
    v_accvgpr_write_b32 a39, 0
    v_mfma_f32_16x16x32_bf16 v[152:155], a[184:187], a[112:115], v[152:155]
    s_waitcnt lgkmcnt(8)
    ds_read_b64_tr_b16 a[176:177], v26 offset:32768
    v_accvgpr_write_b32 a40, 0
    v_mfma_f32_16x16x32_bf16 v[152:155], a[188:191], a[120:123], v[152:155]
    ds_read_b64_tr_b16 a[178:179], v26 offset:36864
    v_accvgpr_write_b32 a41, 0
    v_mfma_f32_16x16x32_bf16 v[156:159], a[184:187], a[116:119], v[156:159]
    ds_read_b64_tr_b16 a[180:181], v26 offset:40960
    v_accvgpr_write_b32 a42, 0
    v_mfma_f32_16x16x32_bf16 v[156:159], a[188:191], a[124:127], v[156:159]
    s_waitcnt lgkmcnt(9)
    ds_read_b64_tr_b16 a[182:183], v26 offset:45056
    v_accvgpr_write_b32 a43, 0
    v_mfma_f32_16x16x32_bf16 v[160:163], a[160:163], a[112:115], v[160:163]
    s_waitcnt lgkmcnt(8)
    ds_read_b64_tr_b16 a[184:185], v27 offset:32768
    v_accvgpr_write_b32 a44, 0
    v_mfma_f32_16x16x32_bf16 v[160:163], a[164:167], a[120:123], v[160:163]
    ds_read_b64_tr_b16 a[186:187], v27 offset:36864
    v_accvgpr_write_b32 a45, 0
    v_mfma_f32_16x16x32_bf16 v[164:167], a[160:163], a[116:119], v[164:167]
    ds_read_b64_tr_b16 a[188:189], v27 offset:40960
    v_accvgpr_write_b32 a46, 0
    v_mfma_f32_16x16x32_bf16 v[164:167], a[164:167], a[124:127], v[164:167]
    s_waitcnt lgkmcnt(9)
    ds_read_b64_tr_b16 a[190:191], v27 offset:45056
    v_accvgpr_write_b32 a47, 0
    v_mfma_f32_16x16x32_bf16 v[168:171], a[168:171], a[112:115], v[168:171]
    s_waitcnt lgkmcnt(8)
    ds_read_b64_tr_b16 a[160:161], v20 offset:49152
    v_accvgpr_write_b32 a48, 0
    v_mfma_f32_16x16x32_bf16 v[168:171], a[172:175], a[120:123], v[168:171]
    ds_read_b64_tr_b16 a[162:163], v20 offset:53248
    v_accvgpr_write_b32 a49, 0
    v_mfma_f32_16x16x32_bf16 v[172:175], a[168:171], a[116:119], v[172:175]
    ds_read_b64_tr_b16 a[164:165], v20 offset:57344
    v_accvgpr_write_b32 a50, 0
    v_mfma_f32_16x16x32_bf16 v[172:175], a[172:175], a[124:127], v[172:175]
    s_waitcnt lgkmcnt(9)
    ds_read_b64_tr_b16 a[166:167], v20 offset:61440
    v_accvgpr_write_b32 a51, 0
    v_mfma_f32_16x16x32_bf16 v[176:179], a[176:179], a[112:115], v[176:179]
    s_waitcnt lgkmcnt(8)
    ds_read_b64_tr_b16 a[168:169], v21 offset:49152
    v_accvgpr_write_b32 a52, 0
    v_mfma_f32_16x16x32_bf16 v[176:179], a[180:183], a[120:123], v[176:179]
    ds_read_b64_tr_b16 a[170:171], v21 offset:53248
    v_accvgpr_write_b32 a53, 0
    v_mfma_f32_16x16x32_bf16 v[180:183], a[176:179], a[116:119], v[180:183]
    ds_read_b64_tr_b16 a[172:173], v21 offset:57344
    v_accvgpr_write_b32 a54, 0
    v_mfma_f32_16x16x32_bf16 v[180:183], a[180:183], a[124:127], v[180:183]
    s_waitcnt lgkmcnt(9)
    ds_read_b64_tr_b16 a[174:175], v21 offset:61440
    v_accvgpr_write_b32 a55, 0
    v_mfma_f32_16x16x32_bf16 v[184:187], a[184:187], a[112:115], v[184:187]
    s_waitcnt lgkmcnt(8)
    ds_read_b64_tr_b16 a[176:177], v22 offset:49152
    v_accvgpr_write_b32 a56, 0
    v_mfma_f32_16x16x32_bf16 v[184:187], a[188:191], a[120:123], v[184:187]
    ds_read_b64_tr_b16 a[178:179], v22 offset:53248
    v_accvgpr_write_b32 a57, 0
    v_mfma_f32_16x16x32_bf16 v[188:191], a[184:187], a[116:119], v[188:191]
    ds_read_b64_tr_b16 a[180:181], v22 offset:57344
    v_accvgpr_write_b32 a58, 0
    v_mfma_f32_16x16x32_bf16 v[188:191], a[188:191], a[124:127], v[188:191]
    s_waitcnt lgkmcnt(9)
    ds_read_b64_tr_b16 a[182:183], v22 offset:61440
    v_accvgpr_write_b32 a59, 0
    v_mfma_f32_16x16x32_bf16 v[192:195], a[160:163], a[112:115], v[192:195]
    s_waitcnt lgkmcnt(8)
    ds_read_b64_tr_b16 a[184:185], v23 offset:49152
    v_accvgpr_write_b32 a60, 0
    v_mfma_f32_16x16x32_bf16 v[192:195], a[164:167], a[120:123], v[192:195]
    ds_read_b64_tr_b16 a[186:187], v23 offset:53248
    v_accvgpr_write_b32 a61, 0
    v_mfma_f32_16x16x32_bf16 v[196:199], a[160:163], a[116:119], v[196:199]
    ds_read_b64_tr_b16 a[188:189], v23 offset:57344
    v_accvgpr_write_b32 a62, 0
    v_mfma_f32_16x16x32_bf16 v[196:199], a[164:167], a[124:127], v[196:199]
    s_waitcnt lgkmcnt(9)
    ds_read_b64_tr_b16 a[190:191], v23 offset:61440
    v_accvgpr_write_b32 a63, 0
    v_mfma_f32_16x16x32_bf16 v[200:203], a[168:171], a[112:115], v[200:203]
    s_waitcnt lgkmcnt(8)
    ds_read_b64_tr_b16 a[160:161], v24 offset:49152
    v_accvgpr_write_b32 a64, 0
    v_mfma_f32_16x16x32_bf16 v[200:203], a[172:175], a[120:123], v[200:203]
    ds_read_b64_tr_b16 a[162:163], v24 offset:53248
    v_accvgpr_write_b32 a65, 0
    v_mfma_f32_16x16x32_bf16 v[204:207], a[168:171], a[116:119], v[204:207]
    ds_read_b64_tr_b16 a[164:165], v24 offset:57344
    v_accvgpr_write_b32 a66, 0
    v_mfma_f32_16x16x32_bf16 v[204:207], a[172:175], a[124:127], v[204:207]
    s_waitcnt lgkmcnt(9)
    ds_read_b64_tr_b16 a[166:167], v24 offset:61440
    v_accvgpr_write_b32 a67, 0
    v_mfma_f32_16x16x32_bf16 v[208:211], a[176:179], a[112:115], v[208:211]
    s_waitcnt lgkmcnt(8)
    ds_read_b64_tr_b16 a[168:169], v25 offset:49152
    v_accvgpr_write_b32 a68, 0
    v_mfma_f32_16x16x32_bf16 v[208:211], a[180:183], a[120:123], v[208:211]
    ds_read_b64_tr_b16 a[170:171], v25 offset:53248
    v_accvgpr_write_b32 a69, 0
    v_mfma_f32_16x16x32_bf16 v[212:215], a[176:179], a[116:119], v[212:215]
    ds_read_b64_tr_b16 a[172:173], v25 offset:57344
    v_accvgpr_write_b32 a70, 0
    v_mfma_f32_16x16x32_bf16 v[212:215], a[180:183], a[124:127], v[212:215]
    s_waitcnt lgkmcnt(9)
    ds_read_b64_tr_b16 a[174:175], v25 offset:61440
    v_accvgpr_write_b32 a71, 0
    v_mfma_f32_16x16x32_bf16 v[216:219], a[184:187], a[112:115], v[216:219]
    s_waitcnt lgkmcnt(8)
    ds_read_b64_tr_b16 a[176:177], v26 offset:49152
    v_accvgpr_write_b32 a72, 0
    v_mfma_f32_16x16x32_bf16 v[216:219], a[188:191], a[120:123], v[216:219]
    ds_read_b64_tr_b16 a[178:179], v26 offset:53248
    v_accvgpr_write_b32 a73, 0
    v_mfma_f32_16x16x32_bf16 v[220:223], a[184:187], a[116:119], v[220:223]
    ds_read_b64_tr_b16 a[180:181], v26 offset:57344
    v_accvgpr_write_b32 a74, 0
    v_mfma_f32_16x16x32_bf16 v[220:223], a[188:191], a[124:127], v[220:223]
    s_waitcnt lgkmcnt(9)
    ds_read_b64_tr_b16 a[182:183], v26 offset:61440
    v_accvgpr_write_b32 a75, 0
    v_mfma_f32_16x16x32_bf16 v[224:227], a[160:163], a[112:115], v[224:227]
    s_waitcnt lgkmcnt(8)
    ds_read_b64_tr_b16 a[184:185], v27 offset:49152
    v_accvgpr_write_b32 a76, 0
    v_mfma_f32_16x16x32_bf16 v[224:227], a[164:167], a[120:123], v[224:227]
    ds_read_b64_tr_b16 a[186:187], v27 offset:53248
    v_accvgpr_write_b32 a77, 0
    v_mfma_f32_16x16x32_bf16 v[228:231], a[160:163], a[116:119], v[228:231]
    ds_read_b64_tr_b16 a[188:189], v27 offset:57344
    v_accvgpr_write_b32 a78, 0
    v_mfma_f32_16x16x32_bf16 v[228:231], a[164:167], a[124:127], v[228:231]
    s_waitcnt lgkmcnt(9)
    ds_read_b64_tr_b16 a[190:191], v27 offset:61440
    v_accvgpr_write_b32 a79, 0
    s_waitcnt vmcnt(12)
    s_barrier
    v_mfma_f32_16x16x32_bf16 v[232:235], a[168:171], a[112:115], v[232:235]
    s_waitcnt lgkmcnt(8)
    ds_read_b64_tr_b16 a[160:161], v28 offset:0
    v_accvgpr_write_b32 a80, 0
    v_mfma_f32_16x16x32_bf16 v[232:235], a[172:175], a[120:123], v[232:235]
    ds_read_b64_tr_b16 a[162:163], v28 offset:4096
    v_accvgpr_write_b32 a81, 0
    v_mfma_f32_16x16x32_bf16 v[236:239], a[168:171], a[116:119], v[236:239]
    s_add_u32 m0, s42, 65536
    ds_read_b64_tr_b16 a[164:165], v28 offset:8192
    v_accvgpr_write_b32 a82, 0
    v_mfma_f32_16x16x32_bf16 v[236:239], a[172:175], a[124:127], v[236:239]
    s_waitcnt lgkmcnt(9)
    ds_read_b64_tr_b16 a[166:167], v28 offset:12288
    buffer_load_dwordx4 v40, s[12:15], s41 offen lds
    v_mfma_f32_16x16x32_bf16 v[240:243], a[176:179], a[112:115], v[240:243]
    s_waitcnt lgkmcnt(8)
    ds_read_b64_tr_b16 a[168:169], v29 offset:0
    v_accvgpr_write_b32 a83, 0
    v_mfma_f32_16x16x32_bf16 v[240:243], a[180:183], a[120:123], v[240:243]
    ds_read_b64_tr_b16 a[170:171], v29 offset:4096
    v_accvgpr_write_b32 a84, 0
    v_mfma_f32_16x16x32_bf16 v[244:247], a[176:179], a[116:119], v[244:247]
    ds_read_b64_tr_b16 a[172:173], v29 offset:8192
    v_accvgpr_write_b32 a85, 0
    v_mfma_f32_16x16x32_bf16 v[244:247], a[180:183], a[124:127], v[244:247]
    s_waitcnt lgkmcnt(9)
    ds_read_b64_tr_b16 a[174:175], v29 offset:12288
    buffer_load_dwordx4 v41, s[12:15], s41 offen offset:1024 lds
    v_mfma_f32_16x16x32_bf16 v[248:251], a[184:187], a[112:115], v[248:251]
    s_waitcnt lgkmcnt(8)
    ds_read_b64_tr_b16 a[176:177], v30 offset:0
    v_accvgpr_write_b32 a86, 0
    v_mfma_f32_16x16x32_bf16 v[248:251], a[188:191], a[120:123], v[248:251]
    ds_read_b64_tr_b16 a[178:179], v30 offset:4096
    v_accvgpr_write_b32 a87, 0
    v_mfma_f32_16x16x32_bf16 v[252:255], a[184:187], a[116:119], v[252:255]
    ds_read_b64_tr_b16 a[180:181], v30 offset:8192
    v_accvgpr_write_b32 a88, 0
    v_mfma_f32_16x16x32_bf16 v[252:255], a[188:191], a[124:127], v[252:255]
    s_waitcnt lgkmcnt(9)
    ds_read_b64_tr_b16 a[182:183], v30 offset:12288
    buffer_load_dwordx4 v40, s[12:15], s41 offen offset:2048 lds
    v_mfma_f32_16x16x32_bf16 v[128:131], a[160:163], a[128:131], v[128:131]
    s_waitcnt lgkmcnt(8)
    ds_read_b64_tr_b16 a[184:185], v31 offset:0
    v_accvgpr_write_b32 a89, 0
    v_mfma_f32_16x16x32_bf16 v[128:131], a[164:167], a[136:139], v[128:131]
    ds_read_b64_tr_b16 a[186:187], v31 offset:4096
    v_accvgpr_write_b32 a90, 0
    v_mfma_f32_16x16x32_bf16 v[132:135], a[160:163], a[132:135], v[132:135]
    ds_read_b64_tr_b16 a[188:189], v31 offset:8192
    v_accvgpr_write_b32 a91, 0
    v_mfma_f32_16x16x32_bf16 v[132:135], a[164:167], a[140:143], v[132:135]
    s_waitcnt lgkmcnt(9)
    ds_read_b64_tr_b16 a[190:191], v31 offset:12288
    buffer_load_dwordx4 v41, s[12:15], s41 offen offset:3072 lds
    v_mfma_f32_16x16x32_bf16 v[136:139], a[168:171], a[128:131], v[136:139]
    s_waitcnt lgkmcnt(8)
    s_add_u32 s41, s41, 16384
    ds_read_b64_tr_b16 a[160:161], v32 offset:0
    v_accvgpr_write_b32 a92, 0
    v_mfma_f32_16x16x32_bf16 v[136:139], a[172:175], a[136:139], v[136:139]
    ds_read_b64_tr_b16 a[162:163], v32 offset:4096
    v_accvgpr_write_b32 a93, 0
    v_mfma_f32_16x16x32_bf16 v[140:143], a[168:171], a[132:135], v[140:143]
    s_add_u32 m0, s42, 81920
    ds_read_b64_tr_b16 a[164:165], v32 offset:8192
    v_accvgpr_write_b32 a94, 0
    v_mfma_f32_16x16x32_bf16 v[140:143], a[172:175], a[140:143], v[140:143]
    s_waitcnt lgkmcnt(9)
    ds_read_b64_tr_b16 a[166:167], v32 offset:12288
    buffer_load_dwordx4 v40, s[12:15], s41 offen lds
    v_mfma_f32_16x16x32_bf16 v[144:147], a[176:179], a[128:131], v[144:147]
    s_waitcnt lgkmcnt(8)
    ds_read_b64_tr_b16 a[168:169], v33 offset:0
    v_accvgpr_write_b32 a95, 0
    v_mfma_f32_16x16x32_bf16 v[144:147], a[180:183], a[136:139], v[144:147]
    ds_read_b64_tr_b16 a[170:171], v33 offset:4096
    v_accvgpr_write_b32 a96, 0
    v_mfma_f32_16x16x32_bf16 v[148:151], a[176:179], a[132:135], v[148:151]
    ds_read_b64_tr_b16 a[172:173], v33 offset:8192
    v_accvgpr_write_b32 a97, 0
    v_mfma_f32_16x16x32_bf16 v[148:151], a[180:183], a[140:143], v[148:151]
    s_waitcnt lgkmcnt(9)
    ds_read_b64_tr_b16 a[174:175], v33 offset:12288
    buffer_load_dwordx4 v41, s[12:15], s41 offen offset:1024 lds
    v_mfma_f32_16x16x32_bf16 v[152:155], a[184:187], a[128:131], v[152:155]
    s_waitcnt lgkmcnt(8)
    ds_read_b64_tr_b16 a[176:177], v34 offset:0
    v_accvgpr_write_b32 a98, 0
    v_mfma_f32_16x16x32_bf16 v[152:155], a[188:191], a[136:139], v[152:155]
    ds_read_b64_tr_b16 a[178:179], v34 offset:4096
    v_accvgpr_write_b32 a99, 0
    v_mfma_f32_16x16x32_bf16 v[156:159], a[184:187], a[132:135], v[156:159]
    ds_read_b64_tr_b16 a[180:181], v34 offset:8192
    v_accvgpr_write_b32 a100, 0
    v_mfma_f32_16x16x32_bf16 v[156:159], a[188:191], a[140:143], v[156:159]
    s_waitcnt lgkmcnt(9)
    ds_read_b64_tr_b16 a[182:183], v34 offset:12288
    buffer_load_dwordx4 v40, s[12:15], s41 offen offset:2048 lds
    v_mfma_f32_16x16x32_bf16 v[160:163], a[160:163], a[128:131], v[160:163]
    s_waitcnt lgkmcnt(8)
    ds_read_b64_tr_b16 a[184:185], v35 offset:0
    v_accvgpr_write_b32 a101, 0
    v_mfma_f32_16x16x32_bf16 v[160:163], a[164:167], a[136:139], v[160:163]
    ds_read_b64_tr_b16 a[186:187], v35 offset:4096
    v_accvgpr_write_b32 a102, 0
    v_mfma_f32_16x16x32_bf16 v[164:167], a[160:163], a[132:135], v[164:167]
    ds_read_b64_tr_b16 a[188:189], v35 offset:8192
    v_accvgpr_write_b32 a103, 0
    v_mfma_f32_16x16x32_bf16 v[164:167], a[164:167], a[140:143], v[164:167]
    s_waitcnt lgkmcnt(9)
    ds_read_b64_tr_b16 a[190:191], v35 offset:12288
    buffer_load_dwordx4 v41, s[12:15], s41 offen offset:3072 lds
    v_mfma_f32_16x16x32_bf16 v[168:171], a[168:171], a[128:131], v[168:171]
    s_waitcnt lgkmcnt(8)
    s_add_u32 s41, s41, 16384
    ds_read_b64_tr_b16 a[160:161], v28 offset:16384
    v_accvgpr_write_b32 a104, 0
    v_mfma_f32_16x16x32_bf16 v[168:171], a[172:175], a[136:139], v[168:171]
    ds_read_b64_tr_b16 a[162:163], v28 offset:20480
    v_accvgpr_write_b32 a105, 0
    v_mfma_f32_16x16x32_bf16 v[172:175], a[168:171], a[132:135], v[172:175]
    ds_read_b64_tr_b16 a[164:165], v28 offset:24576
    v_accvgpr_write_b32 a106, 0
    v_mfma_f32_16x16x32_bf16 v[172:175], a[172:175], a[140:143], v[172:175]
    s_waitcnt lgkmcnt(9)
    ds_read_b64_tr_b16 a[166:167], v28 offset:28672
    v_accvgpr_write_b32 a107, 0
    v_mfma_f32_16x16x32_bf16 v[176:179], a[176:179], a[128:131], v[176:179]
    s_waitcnt lgkmcnt(8)
    ds_read_b64_tr_b16 a[168:169], v29 offset:16384
    v_accvgpr_write_b32 a108, 0
    v_mfma_f32_16x16x32_bf16 v[176:179], a[180:183], a[136:139], v[176:179]
    ds_read_b64_tr_b16 a[170:171], v29 offset:20480
    v_accvgpr_write_b32 a109, 0
    v_mfma_f32_16x16x32_bf16 v[180:183], a[176:179], a[132:135], v[180:183]
    ds_read_b64_tr_b16 a[172:173], v29 offset:24576
    v_accvgpr_write_b32 a110, 0
    v_mfma_f32_16x16x32_bf16 v[180:183], a[180:183], a[140:143], v[180:183]
    s_waitcnt lgkmcnt(9)
    ds_read_b64_tr_b16 a[174:175], v29 offset:28672
    v_accvgpr_write_b32 a111, 0
    v_mfma_f32_16x16x32_bf16 v[184:187], a[184:187], a[128:131], v[184:187]
    s_waitcnt lgkmcnt(8)
    ds_read_b64_tr_b16 a[176:177], v30 offset:16384
    v_accvgpr_write_b32 a192, 0
    v_mfma_f32_16x16x32_bf16 v[184:187], a[188:191], a[136:139], v[184:187]
    ds_read_b64_tr_b16 a[178:179], v30 offset:20480
    v_accvgpr_write_b32 a193, 0
    v_mfma_f32_16x16x32_bf16 v[188:191], a[184:187], a[132:135], v[188:191]
    ds_read_b64_tr_b16 a[180:181], v30 offset:24576
    v_accvgpr_write_b32 a194, 0
    v_mfma_f32_16x16x32_bf16 v[188:191], a[188:191], a[140:143], v[188:191]
    s_waitcnt lgkmcnt(9)
    ds_read_b64_tr_b16 a[182:183], v30 offset:28672
    v_accvgpr_write_b32 a195, 0
    v_mfma_f32_16x16x32_bf16 v[192:195], a[160:163], a[128:131], v[192:195]
    s_waitcnt lgkmcnt(8)
    ds_read_b64_tr_b16 a[184:185], v31 offset:16384
    v_accvgpr_write_b32 a196, 0
    v_mfma_f32_16x16x32_bf16 v[192:195], a[164:167], a[136:139], v[192:195]
    ds_read_b64_tr_b16 a[186:187], v31 offset:20480
    v_accvgpr_write_b32 a197, 0
    v_mfma_f32_16x16x32_bf16 v[196:199], a[160:163], a[132:135], v[196:199]
    ds_read_b64_tr_b16 a[188:189], v31 offset:24576
    v_accvgpr_write_b32 a198, 0
    v_mfma_f32_16x16x32_bf16 v[196:199], a[164:167], a[140:143], v[196:199]
    s_waitcnt lgkmcnt(9)
    ds_read_b64_tr_b16 a[190:191], v31 offset:28672
    v_accvgpr_write_b32 a199, 0
    v_mfma_f32_16x16x32_bf16 v[200:203], a[168:171], a[128:131], v[200:203]
    s_waitcnt lgkmcnt(8)
    ds_read_b64_tr_b16 a[160:161], v32 offset:16384
    v_accvgpr_write_b32 a200, 0
    v_mfma_f32_16x16x32_bf16 v[200:203], a[172:175], a[136:139], v[200:203]
    ds_read_b64_tr_b16 a[162:163], v32 offset:20480
    v_accvgpr_write_b32 a201, 0
    v_mfma_f32_16x16x32_bf16 v[204:207], a[168:171], a[132:135], v[204:207]
    ds_read_b64_tr_b16 a[164:165], v32 offset:24576
    v_accvgpr_write_b32 a202, 0
    v_mfma_f32_16x16x32_bf16 v[204:207], a[172:175], a[140:143], v[204:207]
    s_waitcnt lgkmcnt(9)
    ds_read_b64_tr_b16 a[166:167], v32 offset:28672
    v_accvgpr_write_b32 a203, 0
    v_mfma_f32_16x16x32_bf16 v[208:211], a[176:179], a[128:131], v[208:211]
    s_waitcnt lgkmcnt(8)
    ds_read_b64_tr_b16 a[168:169], v33 offset:16384
    v_accvgpr_write_b32 a204, 0
    v_mfma_f32_16x16x32_bf16 v[208:211], a[180:183], a[136:139], v[208:211]
    ds_read_b64_tr_b16 a[170:171], v33 offset:20480
    v_accvgpr_write_b32 a205, 0
    v_mfma_f32_16x16x32_bf16 v[212:215], a[176:179], a[132:135], v[212:215]
    ds_read_b64_tr_b16 a[172:173], v33 offset:24576
    v_accvgpr_write_b32 a206, 0
    v_mfma_f32_16x16x32_bf16 v[212:215], a[180:183], a[140:143], v[212:215]
    s_waitcnt lgkmcnt(9)
    ds_read_b64_tr_b16 a[174:175], v33 offset:28672
    v_accvgpr_write_b32 a207, 0
    v_mfma_f32_16x16x32_bf16 v[216:219], a[184:187], a[128:131], v[216:219]
    s_waitcnt lgkmcnt(8)
    ds_read_b64_tr_b16 a[176:177], v34 offset:16384
    v_accvgpr_write_b32 a112, 0
    v_mfma_f32_16x16x32_bf16 v[216:219], a[188:191], a[136:139], v[216:219]
    ds_read_b64_tr_b16 a[178:179], v34 offset:20480
    v_accvgpr_write_b32 a113, 0
    v_mfma_f32_16x16x32_bf16 v[220:223], a[184:187], a[132:135], v[220:223]
    ds_read_b64_tr_b16 a[180:181], v34 offset:24576
    v_accvgpr_write_b32 a114, 0
    v_mfma_f32_16x16x32_bf16 v[220:223], a[188:191], a[140:143], v[220:223]
    s_waitcnt lgkmcnt(9)
    ds_read_b64_tr_b16 a[182:183], v34 offset:28672
    v_accvgpr_write_b32 a115, 0
    v_mfma_f32_16x16x32_bf16 v[224:227], a[160:163], a[128:131], v[224:227]
    s_waitcnt lgkmcnt(8)
    ds_read_b64_tr_b16 a[184:185], v35 offset:16384
    v_accvgpr_write_b32 a116, 0
    v_mfma_f32_16x16x32_bf16 v[224:227], a[164:167], a[136:139], v[224:227]
    ds_read_b64_tr_b16 a[186:187], v35 offset:20480
    v_accvgpr_write_b32 a117, 0
    v_mfma_f32_16x16x32_bf16 v[228:231], a[160:163], a[132:135], v[228:231]
    ds_read_b64_tr_b16 a[188:189], v35 offset:24576
    v_accvgpr_write_b32 a118, 0
    v_mfma_f32_16x16x32_bf16 v[228:231], a[164:167], a[140:143], v[228:231]
    s_waitcnt lgkmcnt(9)
    ds_read_b64_tr_b16 a[190:191], v35 offset:28672
    v_accvgpr_write_b32 a119, 0
    v_mfma_f32_16x16x32_bf16 v[232:235], a[168:171], a[128:131], v[232:235]
    s_waitcnt lgkmcnt(8)
    v_accvgpr_write_b32 a120, 0
    v_mfma_f32_16x16x32_bf16 v[232:235], a[172:175], a[136:139], v[232:235]
    v_accvgpr_write_b32 a121, 0
    v_mfma_f32_16x16x32_bf16 v[236:239], a[168:171], a[132:135], v[236:239]
    v_accvgpr_write_b32 a122, 0
    v_mfma_f32_16x16x32_bf16 v[236:239], a[172:175], a[140:143], v[236:239]
    s_waitcnt lgkmcnt(6)
    v_accvgpr_write_b32 a123, 0
    s_waitcnt vmcnt(16)
    s_barrier
    v_mfma_f32_16x16x32_bf16 v[240:243], a[176:179], a[128:131], v[240:243]
    s_waitcnt lgkmcnt(4)
    ds_read_b128 a[208:211], v8 offset:0
    v_accvgpr_write_b32 a124, 0
    v_mfma_f32_16x16x32_bf16 v[240:243], a[180:183], a[136:139], v[240:243]
    ds_read_b128 a[212:215], v9 offset:0
    v_accvgpr_write_b32 a125, 0
    v_mfma_f32_16x16x32_bf16 v[244:247], a[176:179], a[132:135], v[244:247]
    ds_read_b128 a[216:219], v10 offset:0
    v_accvgpr_write_b32 a126, 0
    v_mfma_f32_16x16x32_bf16 v[244:247], a[180:183], a[140:143], v[244:247]
    s_waitcnt lgkmcnt(5)
    ds_read_b128 a[220:223], v11 offset:0
    v_accvgpr_write_b32 a127, 0
    v_mfma_f32_16x16x32_bf16 v[248:251], a[184:187], a[128:131], v[248:251]
    s_waitcnt lgkmcnt(4)
    ds_read_b128 a[224:227], v8 offset:4096
    v_mfma_f32_16x16x32_bf16 v[248:251], a[188:191], a[136:139], v[248:251]
    v_mfma_f32_16x16x32_bf16 v[252:255], a[184:187], a[132:135], v[252:255]
    v_mfma_f32_16x16x32_bf16 v[252:255], a[188:191], a[140:143], v[252:255]
    s_waitcnt lgkmcnt(4)
    s_mov_b32 s36, 1040356334
    s_mov_b32 s37, 1040356334
    v_pk_mul_f32 v[128:129], v[128:129], s[36:37]
    v_pk_mul_f32 v[130:131], v[130:131], s[36:37]
    v_pk_mul_f32 v[136:137], v[136:137], s[36:37]
    v_pk_mul_f32 v[138:139], v[138:139], s[36:37]
    v_cvt_pk_bf16_f32 v64, v128, v129
    v_cvt_pk_bf16_f32 v65, v130, v131
    v_cvt_pk_bf16_f32 v66, v136, v137
    v_cvt_pk_bf16_f32 v67, v138, v139
    v_pk_mul_f32 v[132:133], v[132:133], s[36:37]
    v_pk_mul_f32 v[134:135], v[134:135], s[36:37]
    v_pk_mul_f32 v[140:141], v[140:141], s[36:37]
    v_pk_mul_f32 v[142:143], v[142:143], s[36:37]
    v_cvt_pk_bf16_f32 v80, v132, v133
    v_cvt_pk_bf16_f32 v81, v134, v135
    v_cvt_pk_bf16_f32 v82, v140, v141
    v_cvt_pk_bf16_f32 v83, v142, v143
    v_permlane32_swap_b32 v64, v66
    v_permlane32_swap_b32 v65, v67
    v_permlane32_swap_b32 v80, v82
    v_permlane32_swap_b32 v81, v83
    v_permlane16_swap_b32 v64, v66
    v_permlane16_swap_b32 v65, v67
    v_permlane16_swap_b32 v80, v82
    v_permlane16_swap_b32 v81, v83
    v_pk_mul_f32 v[144:145], v[144:145], s[36:37]
    v_pk_mul_f32 v[146:147], v[146:147], s[36:37]
    v_pk_mul_f32 v[152:153], v[152:153], s[36:37]
    v_pk_mul_f32 v[154:155], v[154:155], s[36:37]
    v_cvt_pk_bf16_f32 v68, v144, v145
    v_cvt_pk_bf16_f32 v69, v146, v147
    v_cvt_pk_bf16_f32 v70, v152, v153
    v_cvt_pk_bf16_f32 v71, v154, v155
    v_pk_mul_f32 v[148:149], v[148:149], s[36:37]
    v_pk_mul_f32 v[150:151], v[150:151], s[36:37]
    v_pk_mul_f32 v[156:157], v[156:157], s[36:37]
    v_pk_mul_f32 v[158:159], v[158:159], s[36:37]
    v_cvt_pk_bf16_f32 v84, v148, v149
    v_cvt_pk_bf16_f32 v85, v150, v151
    v_cvt_pk_bf16_f32 v86, v156, v157
    v_cvt_pk_bf16_f32 v87, v158, v159
    v_permlane32_swap_b32 v68, v70
    v_permlane32_swap_b32 v69, v71
    v_permlane32_swap_b32 v84, v86
    v_permlane32_swap_b32 v85, v87
    v_permlane16_swap_b32 v68, v70
    v_permlane16_swap_b32 v69, v71
    v_permlane16_swap_b32 v84, v86
    v_permlane16_swap_b32 v85, v87
    v_pk_mul_f32 v[160:161], v[160:161], s[36:37]
    v_pk_mul_f32 v[162:163], v[162:163], s[36:37]
    v_pk_mul_f32 v[168:169], v[168:169], s[36:37]
    v_pk_mul_f32 v[170:171], v[170:171], s[36:37]
    v_cvt_pk_bf16_f32 v72, v160, v161
    v_cvt_pk_bf16_f32 v73, v162, v163
    v_cvt_pk_bf16_f32 v74, v168, v169
    v_cvt_pk_bf16_f32 v75, v170, v171
    v_pk_mul_f32 v[164:165], v[164:165], s[36:37]
    v_pk_mul_f32 v[166:167], v[166:167], s[36:37]
    v_pk_mul_f32 v[172:173], v[172:173], s[36:37]
    v_pk_mul_f32 v[174:175], v[174:175], s[36:37]
    v_cvt_pk_bf16_f32 v88, v164, v165
    v_cvt_pk_bf16_f32 v89, v166, v167
    v_cvt_pk_bf16_f32 v90, v172, v173
    v_cvt_pk_bf16_f32 v91, v174, v175
    v_permlane32_swap_b32 v72, v74
    v_permlane32_swap_b32 v73, v75
    v_permlane32_swap_b32 v88, v90
    v_permlane32_swap_b32 v89, v91
    v_permlane16_swap_b32 v72, v74
    v_permlane16_swap_b32 v73, v75
    v_permlane16_swap_b32 v88, v90
    v_permlane16_swap_b32 v89, v91
    v_pk_mul_f32 v[176:177], v[176:177], s[36:37]
    v_pk_mul_f32 v[178:179], v[178:179], s[36:37]
    v_pk_mul_f32 v[184:185], v[184:185], s[36:37]
    v_pk_mul_f32 v[186:187], v[186:187], s[36:37]
    v_cvt_pk_bf16_f32 v76, v176, v177
    v_cvt_pk_bf16_f32 v77, v178, v179
    v_cvt_pk_bf16_f32 v78, v184, v185
    v_cvt_pk_bf16_f32 v79, v186, v187
    v_pk_mul_f32 v[180:181], v[180:181], s[36:37]
    v_pk_mul_f32 v[182:183], v[182:183], s[36:37]
    v_pk_mul_f32 v[188:189], v[188:189], s[36:37]
    v_pk_mul_f32 v[190:191], v[190:191], s[36:37]
    v_cvt_pk_bf16_f32 v92, v180, v181
    v_cvt_pk_bf16_f32 v93, v182, v183
    v_cvt_pk_bf16_f32 v94, v188, v189
    v_cvt_pk_bf16_f32 v95, v190, v191
    v_permlane32_swap_b32 v76, v78
    v_permlane32_swap_b32 v77, v79
    v_permlane32_swap_b32 v92, v94
    v_permlane32_swap_b32 v93, v95
    v_permlane16_swap_b32 v76, v78
    v_permlane16_swap_b32 v77, v79
    v_permlane16_swap_b32 v92, v94
    v_permlane16_swap_b32 v93, v95
    v_pk_mul_f32 v[192:193], v[192:193], s[36:37]
    v_pk_mul_f32 v[194:195], v[194:195], s[36:37]
    v_pk_mul_f32 v[200:201], v[200:201], s[36:37]
    v_pk_mul_f32 v[202:203], v[202:203], s[36:37]
    v_cvt_pk_bf16_f32 v96, v192, v193
    v_cvt_pk_bf16_f32 v97, v194, v195
    v_cvt_pk_bf16_f32 v98, v200, v201
    v_cvt_pk_bf16_f32 v99, v202, v203
    v_pk_mul_f32 v[196:197], v[196:197], s[36:37]
    v_pk_mul_f32 v[198:199], v[198:199], s[36:37]
    v_pk_mul_f32 v[204:205], v[204:205], s[36:37]
    v_pk_mul_f32 v[206:207], v[206:207], s[36:37]
    v_cvt_pk_bf16_f32 v112, v196, v197
    v_cvt_pk_bf16_f32 v113, v198, v199
    v_cvt_pk_bf16_f32 v114, v204, v205
    v_cvt_pk_bf16_f32 v115, v206, v207
    v_permlane32_swap_b32 v96, v98
    v_permlane32_swap_b32 v97, v99
    v_permlane32_swap_b32 v112, v114
    v_permlane32_swap_b32 v113, v115
    v_permlane16_swap_b32 v96, v98
    v_permlane16_swap_b32 v97, v99
    v_permlane16_swap_b32 v112, v114
    v_permlane16_swap_b32 v113, v115
    v_pk_mul_f32 v[208:209], v[208:209], s[36:37]
    v_pk_mul_f32 v[210:211], v[210:211], s[36:37]
    v_pk_mul_f32 v[216:217], v[216:217], s[36:37]
    v_pk_mul_f32 v[218:219], v[218:219], s[36:37]
    v_cvt_pk_bf16_f32 v100, v208, v209
    v_cvt_pk_bf16_f32 v101, v210, v211
    v_cvt_pk_bf16_f32 v102, v216, v217
    v_cvt_pk_bf16_f32 v103, v218, v219
    v_pk_mul_f32 v[212:213], v[212:213], s[36:37]
    v_pk_mul_f32 v[214:215], v[214:215], s[36:37]
    v_pk_mul_f32 v[220:221], v[220:221], s[36:37]
    v_pk_mul_f32 v[222:223], v[222:223], s[36:37]
    v_cvt_pk_bf16_f32 v116, v212, v213
    v_cvt_pk_bf16_f32 v117, v214, v215
    v_cvt_pk_bf16_f32 v118, v220, v221
    v_cvt_pk_bf16_f32 v119, v222, v223
    v_permlane32_swap_b32 v100, v102
    v_permlane32_swap_b32 v101, v103
    v_permlane32_swap_b32 v116, v118
    v_permlane32_swap_b32 v117, v119
    v_permlane16_swap_b32 v100, v102
    v_permlane16_swap_b32 v101, v103
    v_permlane16_swap_b32 v116, v118
    v_permlane16_swap_b32 v117, v119
    v_pk_mul_f32 v[224:225], v[224:225], s[36:37]
    v_pk_mul_f32 v[226:227], v[226:227], s[36:37]
    v_pk_mul_f32 v[232:233], v[232:233], s[36:37]
    v_pk_mul_f32 v[234:235], v[234:235], s[36:37]
    v_cvt_pk_bf16_f32 v104, v224, v225
    v_cvt_pk_bf16_f32 v105, v226, v227
    v_cvt_pk_bf16_f32 v106, v232, v233
    v_cvt_pk_bf16_f32 v107, v234, v235
    v_pk_mul_f32 v[228:229], v[228:229], s[36:37]
    v_pk_mul_f32 v[230:231], v[230:231], s[36:37]
    v_pk_mul_f32 v[236:237], v[236:237], s[36:37]
    v_pk_mul_f32 v[238:239], v[238:239], s[36:37]
    v_cvt_pk_bf16_f32 v120, v228, v229
    v_cvt_pk_bf16_f32 v121, v230, v231
    v_cvt_pk_bf16_f32 v122, v236, v237
    v_cvt_pk_bf16_f32 v123, v238, v239
    v_permlane32_swap_b32 v104, v106
    v_permlane32_swap_b32 v105, v107
    v_permlane32_swap_b32 v120, v122
    v_permlane32_swap_b32 v121, v123
    v_permlane16_swap_b32 v104, v106
    v_permlane16_swap_b32 v105, v107
    v_permlane16_swap_b32 v120, v122
    v_permlane16_swap_b32 v121, v123
    v_pk_mul_f32 v[240:241], v[240:241], s[36:37]
    v_pk_mul_f32 v[242:243], v[242:243], s[36:37]
    v_pk_mul_f32 v[248:249], v[248:249], s[36:37]
    v_pk_mul_f32 v[250:251], v[250:251], s[36:37]
    v_cvt_pk_bf16_f32 v108, v240, v241
    v_cvt_pk_bf16_f32 v109, v242, v243
    v_cvt_pk_bf16_f32 v110, v248, v249
    v_cvt_pk_bf16_f32 v111, v250, v251
    v_pk_mul_f32 v[244:245], v[244:245], s[36:37]
    v_pk_mul_f32 v[246:247], v[246:247], s[36:37]
    v_pk_mul_f32 v[252:253], v[252:253], s[36:37]
    v_pk_mul_f32 v[254:255], v[254:255], s[36:37]
    v_cvt_pk_bf16_f32 v124, v244, v245
    v_cvt_pk_bf16_f32 v125, v246, v247
    v_cvt_pk_bf16_f32 v126, v252, v253
    v_cvt_pk_bf16_f32 v127, v254, v255
    v_permlane32_swap_b32 v108, v110
    v_permlane32_swap_b32 v109, v111
    v_permlane32_swap_b32 v124, v126
    v_permlane32_swap_b32 v125, v127
    v_permlane16_swap_b32 v108, v110
    v_permlane16_swap_b32 v109, v111
    v_permlane16_swap_b32 v124, v126
    v_permlane16_swap_b32 v125, v127
    v_mfma_f32_16x16x32_bf16 v[216:219], a[208:211], v[64:67], 0
    s_waitcnt lgkmcnt(3)
    v_mfma_f32_16x16x32_bf16 v[216:219], a[212:215], v[68:71], v[216:219]
    s_waitcnt lgkmcnt(2)
    v_mfma_f32_16x16x32_bf16 v[216:219], a[216:219], v[72:75], v[216:219]
    s_waitcnt lgkmcnt(1)
    v_mfma_f32_16x16x32_bf16 v[216:219], a[220:223], v[76:79], v[216:219]
    v_mfma_f32_16x16x32_bf16 v[220:223], a[208:211], v[80:83], 0
    v_mfma_f32_16x16x32_bf16 v[220:223], a[212:215], v[84:87], v[220:223]
    v_mfma_f32_16x16x32_bf16 v[220:223], a[216:219], v[88:91], v[220:223]
    v_mfma_f32_16x16x32_bf16 v[220:223], a[220:223], v[92:95], v[220:223]
    v_mfma_f32_16x16x32_bf16 v[224:227], a[208:211], v[96:99], 0
    v_mfma_f32_16x16x32_bf16 v[224:227], a[212:215], v[100:103], v[224:227]
    v_mfma_f32_16x16x32_bf16 v[224:227], a[216:219], v[104:107], v[224:227]
    v_mfma_f32_16x16x32_bf16 v[224:227], a[220:223], v[108:111], v[224:227]
    v_mfma_f32_16x16x32_bf16 v[228:231], a[208:211], v[112:115], 0
    v_mfma_f32_16x16x32_bf16 v[228:231], a[212:215], v[116:119], v[228:231]
    v_mfma_f32_16x16x32_bf16 v[228:231], a[216:219], v[120:123], v[228:231]
    v_mfma_f32_16x16x32_bf16 v[228:231], a[220:223], v[124:127], v[228:231]
    v_max3_f32 v232, v216, v217, v218
    v_max_f32 v232, v232, v219
    v_max3_f32 v233, v220, v221, v222
    v_max_f32 v233, v233, v223
    v_max3_f32 v234, v224, v225, v226
    v_max_f32 v234, v234, v227
    s_nop 1
    v_max3_f32 v235, v228, v229, v230
    v_max_f32 v235, v235, v231
    v_mov_b32 v236, v232
    v_mov_b32 v237, v233
    v_mov_b32 v238, v234
    v_mov_b32 v239, v235
    v_permlane16_swap_b32 v232, v236
    v_permlane16_swap_b32 v233, v237
    v_permlane16_swap_b32 v234, v238
    v_permlane16_swap_b32 v235, v239
    v_max_f32 v232, v232, v236
    v_max_f32 v233, v233, v237
    v_max_f32 v234, v234, v238
    v_max_f32 v235, v235, v239
    v_mov_b32 v236, v232
    v_mov_b32 v237, v233
    v_mov_b32 v238, v234
    v_mov_b32 v239, v235
    v_permlane32_swap_b32 v232, v236
    v_permlane32_swap_b32 v233, v237
    v_permlane32_swap_b32 v234, v238
    v_permlane32_swap_b32 v235, v239
    v_max_f32 v232, v232, v236
    v_max_f32 v233, v233, v237
    v_max_f32 v234, v234, v238
    v_max_f32 v235, v235, v239
    v_sub_f32 v192, 3250585600, v232
    v_sub_f32 v193, 3250585600, v232
    v_sub_f32 v194, 3250585600, v232
    v_sub_f32 v195, 3250585600, v232
    v_sub_f32 v196, 3250585600, v233
    v_sub_f32 v197, 3250585600, v233
    v_sub_f32 v198, 3250585600, v233
    v_sub_f32 v199, 3250585600, v233
    v_sub_f32 v200, 3250585600, v234
    v_sub_f32 v201, 3250585600, v234
    v_sub_f32 v202, 3250585600, v234
    v_sub_f32 v203, 3250585600, v234
    v_sub_f32 v204, 3250585600, v235
    v_sub_f32 v205, 3250585600, v235
    v_sub_f32 v206, 3250585600, v235
    v_sub_f32 v207, 3250585600, v235
Lattn_stage0:
    s_mov_b32 s43, 7
    v_mfma_f32_16x16x32_bf16 v[208:211], a[208:211], v[64:67], v[192:195]
    v_mfma_f32_16x16x32_bf16 v[208:211], a[212:215], v[68:71], v[208:211]
    v_mfma_f32_16x16x32_bf16 v[208:211], a[216:219], v[72:75], v[208:211]
    v_mfma_f32_16x16x32_bf16 v[208:211], a[220:223], v[76:79], v[208:211]
    ds_read_b128 a[228:231], v9 offset:4096
    v_mfma_f32_16x16x32_bf16 v[212:215], a[208:211], v[80:83], v[196:199]
    s_nop 5
    v_exp_f32 v208, v208
    v_mfma_f32_16x16x32_bf16 v[212:215], a[212:215], v[84:87], v[212:215]
    v_exp_f32 v209, v209
    v_mfma_f32_16x16x32_bf16 v[212:215], a[216:219], v[88:91], v[212:215]
    v_exp_f32 v210, v210
    v_mfma_f32_16x16x32_bf16 v[212:215], a[220:223], v[92:95], v[212:215]
    v_exp_f32 v211, v211
    v_cvt_pk_bf16_f32 v128, v208, v209
    ds_read_b128 a[232:235], v10 offset:4096
    v_cvt_pk_bf16_f32 v129, v210, v211
    v_mfma_f32_16x16x32_bf16 v[208:211], a[208:211], v[96:99], v[200:203]
    s_nop 2
    v_exp_f32 v212, v212
    v_mfma_f32_16x16x32_bf16 v[208:211], a[212:215], v[100:103], v[208:211]
    v_exp_f32 v213, v213
    v_mfma_f32_16x16x32_bf16 v[208:211], a[216:219], v[104:107], v[208:211]
    v_exp_f32 v214, v214
    v_mfma_f32_16x16x32_bf16 v[208:211], a[220:223], v[108:111], v[208:211]
    v_exp_f32 v215, v215
    v_cvt_pk_bf16_f32 v136, v212, v213
    ds_read_b128 a[236:239], v11 offset:4096
    v_cvt_pk_bf16_f32 v137, v214, v215
    s_mul_i32 s49, s5, 18432
    s_add_u32 s49, s49, s45
    v_lshlrev_b32 v220, 6, v0
    v_mfma_f32_16x16x32_bf16 v[212:215], a[208:211], v[112:115], v[204:207]
    v_exp_f32 v208, v208
    v_mfma_f32_16x16x32_bf16 v[212:215], a[212:215], v[116:119], v[212:215]
    v_exp_f32 v209, v209
    v_mfma_f32_16x16x32_bf16 v[212:215], a[216:219], v[120:123], v[212:215]
    v_exp_f32 v210, v210
    v_mfma_f32_16x16x32_bf16 v[212:215], a[220:223], v[124:127], v[212:215]
    s_waitcnt lgkmcnt(3)
    v_exp_f32 v211, v211
    v_cvt_pk_bf16_f32 v144, v208, v209
    ds_read_b128 a[208:211], v8 offset:8192
    v_cvt_pk_bf16_f32 v145, v210, v211
    buffer_load_dword v221, v220, s[20:23], s49 offen
    v_mfma_f32_16x16x32_bf16 v[208:211], a[224:227], v[64:67], v[192:195]
    s_waitcnt lgkmcnt(3)
    v_exp_f32 v212, v212
    v_mfma_f32_16x16x32_bf16 v[208:211], a[228:231], v[68:71], v[208:211]
    s_waitcnt lgkmcnt(2)
    v_exp_f32 v213, v213
    v_mfma_f32_16x16x32_bf16 v[208:211], a[232:235], v[72:75], v[208:211]
    s_waitcnt lgkmcnt(1)
    v_exp_f32 v214, v214
    v_mfma_f32_16x16x32_bf16 v[208:211], a[236:239], v[76:79], v[208:211]
    v_exp_f32 v215, v215
    v_cvt_pk_bf16_f32 v152, v212, v213
    ds_read_b128 a[212:215], v9 offset:8192
    v_cvt_pk_bf16_f32 v153, v214, v215
    s_add_u32 s49, s49, 16384
    v_mfma_f32_16x16x32_bf16 v[212:215], a[224:227], v[80:83], v[196:199]
    s_nop 1
    v_exp_f32 v208, v208
    v_mfma_f32_16x16x32_bf16 v[212:215], a[228:231], v[84:87], v[212:215]
    v_exp_f32 v209, v209
    v_mfma_f32_16x16x32_bf16 v[212:215], a[232:235], v[88:91], v[212:215]
    v_exp_f32 v210, v210
    v_mfma_f32_16x16x32_bf16 v[212:215], a[236:239], v[92:95], v[212:215]
    v_exp_f32 v211, v211
    v_cvt_pk_bf16_f32 v130, v208, v209
    ds_read_b128 a[216:219], v10 offset:8192
    v_cvt_pk_bf16_f32 v131, v210, v211
    buffer_load_dword v222, v220, s[20:23], s49 offen
    v_mfma_f32_16x16x32_bf16 v[208:211], a[224:227], v[96:99], v[200:203]
    s_nop 1
    v_exp_f32 v212, v212
    v_mfma_f32_16x16x32_bf16 v[208:211], a[228:231], v[100:103], v[208:211]
    v_exp_f32 v213, v213
    v_mfma_f32_16x16x32_bf16 v[208:211], a[232:235], v[104:107], v[208:211]
    v_exp_f32 v214, v214
    v_mfma_f32_16x16x32_bf16 v[208:211], a[236:239], v[108:111], v[208:211]
    v_exp_f32 v215, v215
    v_cvt_pk_bf16_f32 v138, v212, v213
    ds_read_b128 a[220:223], v11 offset:8192
    v_cvt_pk_bf16_f32 v139, v214, v215
    s_mov_b32 s39, 221184
    s_mov_b32 s38, 27648
    v_mfma_f32_16x16x32_bf16 v[212:215], a[224:227], v[112:115], v[204:207]
    s_nop 0
    v_exp_f32 v208, v208
    v_mfma_f32_16x16x32_bf16 v[212:215], a[228:231], v[116:119], v[212:215]
    v_exp_f32 v209, v209
    v_mfma_f32_16x16x32_bf16 v[212:215], a[232:235], v[120:123], v[212:215]
    v_exp_f32 v210, v210
    v_mfma_f32_16x16x32_bf16 v[212:215], a[236:239], v[124:127], v[212:215]
    s_waitcnt lgkmcnt(3)
    v_exp_f32 v211, v211
    v_cvt_pk_bf16_f32 v146, v208, v209
    ds_read_b128 a[224:227], v8 offset:12288
    v_cvt_pk_bf16_f32 v147, v210, v211
    v_mfma_f32_16x16x32_bf16 v[208:211], a[208:211], v[64:67], v[192:195]
    s_waitcnt lgkmcnt(3)
    s_nop 0
    v_exp_f32 v212, v212
    v_mfma_f32_16x16x32_bf16 v[208:211], a[212:215], v[68:71], v[208:211]
    s_waitcnt lgkmcnt(2)
    v_exp_f32 v213, v213
    v_mfma_f32_16x16x32_bf16 v[208:211], a[216:219], v[72:75], v[208:211]
    s_waitcnt lgkmcnt(1)
    v_exp_f32 v214, v214
    v_mfma_f32_16x16x32_bf16 v[208:211], a[220:223], v[76:79], v[208:211]
    v_exp_f32 v215, v215
    v_cvt_pk_bf16_f32 v154, v212, v213
    ds_read_b128 a[228:231], v9 offset:12288
    v_cvt_pk_bf16_f32 v155, v214, v215
    v_mfma_f32_16x16x32_bf16 v[212:215], a[208:211], v[80:83], v[196:199]
    s_nop 2
    v_exp_f32 v208, v208
    v_mfma_f32_16x16x32_bf16 v[212:215], a[212:215], v[84:87], v[212:215]
    v_exp_f32 v209, v209
    v_mfma_f32_16x16x32_bf16 v[212:215], a[216:219], v[88:91], v[212:215]
    v_exp_f32 v210, v210
    v_mfma_f32_16x16x32_bf16 v[212:215], a[220:223], v[92:95], v[212:215]
    v_exp_f32 v211, v211
    v_cvt_pk_bf16_f32 v132, v208, v209
    ds_read_b128 a[232:235], v10 offset:12288
    v_cvt_pk_bf16_f32 v133, v210, v211
    v_mfma_f32_16x16x32_bf16 v[208:211], a[208:211], v[96:99], v[200:203]
    s_nop 2
    v_exp_f32 v212, v212
    v_mfma_f32_16x16x32_bf16 v[208:211], a[212:215], v[100:103], v[208:211]
    v_exp_f32 v213, v213
    v_mfma_f32_16x16x32_bf16 v[208:211], a[216:219], v[104:107], v[208:211]
    v_exp_f32 v214, v214
    v_mfma_f32_16x16x32_bf16 v[208:211], a[220:223], v[108:111], v[208:211]
    v_exp_f32 v215, v215
    v_cvt_pk_bf16_f32 v140, v212, v213
    ds_read_b128 a[236:239], v11 offset:12288
    v_cvt_pk_bf16_f32 v141, v214, v215
    s_waitcnt vmcnt(6)
    s_barrier
    v_mfma_f32_16x16x32_bf16 v[212:215], a[208:211], v[112:115], v[204:207]
    s_nop 0
    v_exp_f32 v208, v208
    v_mfma_f32_16x16x32_bf16 v[212:215], a[212:215], v[116:119], v[212:215]
    s_add_u32 m0, s42, 49152
    v_exp_f32 v209, v209
    v_mfma_f32_16x16x32_bf16 v[212:215], a[216:219], v[120:123], v[212:215]
    v_exp_f32 v210, v210
    v_mfma_f32_16x16x32_bf16 v[212:215], a[220:223], v[124:127], v[212:215]
    s_waitcnt lgkmcnt(3)
    v_exp_f32 v211, v211
    v_cvt_pk_bf16_f32 v148, v208, v209
    ds_read_b128 a[208:211], v8 offset:16384
    v_cvt_pk_bf16_f32 v149, v210, v211
    buffer_load_dwordx4 v36, s[8:11], s40 offen lds
    v_mfma_f32_16x16x32_bf16 v[208:211], a[224:227], v[64:67], v[192:195]
    s_waitcnt lgkmcnt(3)
    v_exp_f32 v212, v212
    v_mfma_f32_16x16x32_bf16 v[208:211], a[228:231], v[68:71], v[208:211]
    s_waitcnt lgkmcnt(2)
    v_exp_f32 v213, v213
    v_mfma_f32_16x16x32_bf16 v[208:211], a[232:235], v[72:75], v[208:211]
    s_waitcnt lgkmcnt(1)
    v_exp_f32 v214, v214
    v_mfma_f32_16x16x32_bf16 v[208:211], a[236:239], v[76:79], v[208:211]
    v_exp_f32 v215, v215
    v_cvt_pk_bf16_f32 v156, v212, v213
    ds_read_b128 a[212:215], v9 offset:16384
    v_cvt_pk_bf16_f32 v157, v214, v215
    v_mfma_f32_16x16x32_bf16 v[212:215], a[224:227], v[80:83], v[196:199]
    s_nop 2
    v_exp_f32 v208, v208
    v_mfma_f32_16x16x32_bf16 v[212:215], a[228:231], v[84:87], v[212:215]
    v_exp_f32 v209, v209
    v_mfma_f32_16x16x32_bf16 v[212:215], a[232:235], v[88:91], v[212:215]
    v_exp_f32 v210, v210
    v_mfma_f32_16x16x32_bf16 v[212:215], a[236:239], v[92:95], v[212:215]
    v_exp_f32 v211, v211
    ds_read_b64_tr_b16 a[160:161], v20 offset:0
    v_cvt_pk_bf16_f32 v134, v208, v209
    ds_read_b64_tr_b16 a[162:163], v20 offset:4096
    ds_read_b128 a[216:219], v10 offset:16384
    v_cvt_pk_bf16_f32 v135, v210, v211
    buffer_load_dwordx4 v37, s[8:11], s40 offen offset:1024 lds
    v_mfma_f32_16x16x32_bf16 v[208:211], a[224:227], v[96:99], v[200:203]
    v_exp_f32 v212, v212
    v_mfma_f32_16x16x32_bf16 v[208:211], a[228:231], v[100:103], v[208:211]
    v_exp_f32 v213, v213
    v_mfma_f32_16x16x32_bf16 v[208:211], a[232:235], v[104:107], v[208:211]
    v_exp_f32 v214, v214
    v_mfma_f32_16x16x32_bf16 v[208:211], a[236:239], v[108:111], v[208:211]
    v_exp_f32 v215, v215
    ds_read_b64_tr_b16 a[164:165], v20 offset:8192
    v_cvt_pk_bf16_f32 v142, v212, v213
    ds_read_b64_tr_b16 a[166:167], v20 offset:12288
    ds_read_b128 a[220:223], v11 offset:16384
    v_cvt_pk_bf16_f32 v143, v214, v215
    v_mfma_f32_16x16x32_bf16 v[212:215], a[224:227], v[112:115], v[204:207]
    s_nop 0
    v_exp_f32 v208, v208
    v_mfma_f32_16x16x32_bf16 v[212:215], a[228:231], v[116:119], v[212:215]
    v_exp_f32 v209, v209
    v_mfma_f32_16x16x32_bf16 v[212:215], a[232:235], v[120:123], v[212:215]
    v_exp_f32 v210, v210
    v_mfma_f32_16x16x32_bf16 v[212:215], a[236:239], v[124:127], v[212:215]
    v_exp_f32 v211, v211
    ds_read_b64_tr_b16 a[168:169], v21 offset:0
    v_cvt_pk_bf16_f32 v150, v208, v209
    ds_read_b64_tr_b16 a[170:171], v21 offset:4096
    ds_read_b128 a[224:227], v8 offset:20480
    v_cvt_pk_bf16_f32 v151, v210, v211
    s_waitcnt lgkmcnt(3)
    buffer_load_dwordx4 v38, s[8:11], s40 offen offset:2048 lds
Lattn_loop:
    v_mfma_f32_16x16x32_bf16 v[208:211], a[208:211], v[64:67], v[192:195]
    v_exp_f32 v212, v212
    v_mfma_f32_16x16x32_bf16 v[208:211], a[212:215], v[68:71], v[208:211]
    v_exp_f32 v213, v213
    v_mfma_f32_16x16x32_bf16 v[208:211], a[216:219], v[72:75], v[208:211]
    v_exp_f32 v214, v214
    v_mfma_f32_16x16x32_bf16 v[208:211], a[220:223], v[76:79], v[208:211]
    v_exp_f32 v215, v215
    v_mfma_f32_16x16x32_bf16 a[0:3], a[160:163], v[128:131], a[0:3]
    ds_read_b64_tr_b16 a[172:173], v21 offset:8192
    v_cvt_pk_bf16_f32 v158, v212, v213
    v_mfma_f32_16x16x32_bf16 a[0:3], a[164:167], v[132:135], a[0:3]
    ds_read_b64_tr_b16 a[174:175], v21 offset:12288
    v_mfma_f32_16x16x32_bf16 a[4:7], a[160:163], v[136:139], a[4:7]
    ds_read_b128 a[228:231], v9 offset:20480
    v_cvt_pk_bf16_f32 v159, v214, v215
    v_mfma_f32_16x16x32_bf16 a[4:7], a[164:167], v[140:143], a[4:7]
    v_mfma_f32_16x16x32_bf16 v[212:215], a[208:211], v[80:83], v[196:199]
    v_exp_f32 v208, v208
    v_mfma_f32_16x16x32_bf16 v[212:215], a[212:215], v[84:87], v[212:215]
    v_exp_f32 v209, v209
    v_mfma_f32_16x16x32_bf16 v[212:215], a[216:219], v[88:91], v[212:215]
    v_exp_f32 v210, v210
    v_mfma_f32_16x16x32_bf16 v[212:215], a[220:223], v[92:95], v[212:215]
    v_exp_f32 v211, v211
    v_mfma_f32_16x16x32_bf16 a[8:11], a[160:163], v[144:147], a[8:11]
    ds_read_b64_tr_b16 a[176:177], v22 offset:0
    v_cvt_pk_bf16_f32 v160, v208, v209
    v_mfma_f32_16x16x32_bf16 a[8:11], a[164:167], v[148:151], a[8:11]
    ds_read_b64_tr_b16 a[178:179], v22 offset:4096
    v_mfma_f32_16x16x32_bf16 a[12:15], a[160:163], v[152:155], a[12:15]
    ds_read_b128 a[232:235], v10 offset:20480
    v_cvt_pk_bf16_f32 v161, v210, v211
    v_mfma_f32_16x16x32_bf16 a[12:15], a[164:167], v[156:159], a[12:15]
    s_waitcnt lgkmcnt(3)
    buffer_load_dwordx4 v39, s[8:11], s40 offen offset:3072 lds
    v_mfma_f32_16x16x32_bf16 v[208:211], a[208:211], v[96:99], v[200:203]
    v_exp_f32 v212, v212
    v_mfma_f32_16x16x32_bf16 v[208:211], a[212:215], v[100:103], v[208:211]
    s_add_u32 s40, s40, 16384
    v_exp_f32 v213, v213
    v_mfma_f32_16x16x32_bf16 v[208:211], a[216:219], v[104:107], v[208:211]
    v_exp_f32 v214, v214
    v_mfma_f32_16x16x32_bf16 v[208:211], a[220:223], v[108:111], v[208:211]
    v_exp_f32 v215, v215
    v_mfma_f32_16x16x32_bf16 a[16:19], a[168:171], v[128:131], a[16:19]
    ds_read_b64_tr_b16 a[180:181], v22 offset:8192
    v_cvt_pk_bf16_f32 v168, v212, v213
    v_mfma_f32_16x16x32_bf16 a[16:19], a[172:175], v[132:135], a[16:19]
    ds_read_b64_tr_b16 a[182:183], v22 offset:12288
    v_mfma_f32_16x16x32_bf16 a[20:23], a[168:171], v[136:139], a[20:23]
    ds_read_b128 a[236:239], v11 offset:20480
    v_cvt_pk_bf16_f32 v169, v214, v215
    v_mfma_f32_16x16x32_bf16 a[20:23], a[172:175], v[140:143], a[20:23]
    v_smfmac_f32_16x16x64_bf16 a[192:195], v[52:55], v[128:135], v50
    v_mfma_f32_16x16x32_bf16 v[212:215], a[208:211], v[112:115], v[204:207]
    v_exp_f32 v208, v208
    v_mfma_f32_16x16x32_bf16 v[212:215], a[212:215], v[116:119], v[212:215]
    s_add_u32 m0, s42, 98304
    v_exp_f32 v209, v209
    v_mfma_f32_16x16x32_bf16 v[212:215], a[216:219], v[120:123], v[212:215]
    v_exp_f32 v210, v210
    v_mfma_f32_16x16x32_bf16 v[212:215], a[220:223], v[124:127], v[212:215]
    v_exp_f32 v211, v211
    v_mfma_f32_16x16x32_bf16 a[24:27], a[168:171], v[144:147], a[24:27]
    ds_read_b64_tr_b16 a[184:185], v23 offset:0
    v_cvt_pk_bf16_f32 v176, v208, v209
    v_mfma_f32_16x16x32_bf16 a[24:27], a[172:175], v[148:151], a[24:27]
    ds_read_b64_tr_b16 a[186:187], v23 offset:4096
    v_mfma_f32_16x16x32_bf16 a[28:31], a[168:171], v[152:155], a[28:31]
    ds_read_b128 a[208:211], v8 offset:24576
    v_cvt_pk_bf16_f32 v177, v210, v211
    v_mfma_f32_16x16x32_bf16 a[28:31], a[172:175], v[156:159], a[28:31]
    s_waitcnt lgkmcnt(3)
    buffer_load_dwordx4 v40, s[12:15], s41 offen lds
    v_mfma_f32_16x16x32_bf16 v[208:211], a[224:227], v[64:67], v[192:195]
    v_exp_f32 v212, v212
    v_mfma_f32_16x16x32_bf16 v[208:211], a[228:231], v[68:71], v[208:211]
    v_exp_f32 v213, v213
    v_mfma_f32_16x16x32_bf16 v[208:211], a[232:235], v[72:75], v[208:211]
    v_exp_f32 v214, v214
    v_mfma_f32_16x16x32_bf16 v[208:211], a[236:239], v[76:79], v[208:211]
    v_exp_f32 v215, v215
    v_mfma_f32_16x16x32_bf16 a[32:35], a[176:179], v[128:131], a[32:35]
    ds_read_b64_tr_b16 a[188:189], v23 offset:8192
    v_cvt_pk_bf16_f32 v184, v212, v213
    v_mfma_f32_16x16x32_bf16 a[32:35], a[180:183], v[132:135], a[32:35]
    ds_read_b64_tr_b16 a[190:191], v23 offset:12288
    v_mfma_f32_16x16x32_bf16 a[36:39], a[176:179], v[136:139], a[36:39]
    ds_read_b128 a[212:215], v9 offset:24576
    v_cvt_pk_bf16_f32 v185, v214, v215
    v_mfma_f32_16x16x32_bf16 a[36:39], a[180:183], v[140:143], a[36:39]
    v_smfmac_f32_16x16x64_bf16 a[196:199], v[52:55], v[136:143], v50
    v_mfma_f32_16x16x32_bf16 v[212:215], a[224:227], v[80:83], v[196:199]
    v_exp_f32 v208, v208
    v_mfma_f32_16x16x32_bf16 v[212:215], a[228:231], v[84:87], v[212:215]
    v_exp_f32 v209, v209
    v_mfma_f32_16x16x32_bf16 v[212:215], a[232:235], v[88:91], v[212:215]
    v_exp_f32 v210, v210
    v_mfma_f32_16x16x32_bf16 v[212:215], a[236:239], v[92:95], v[212:215]
    v_exp_f32 v211, v211
    v_mfma_f32_16x16x32_bf16 a[40:43], a[176:179], v[144:147], a[40:43]
    ds_read_b64_tr_b16 a[160:161], v24 offset:0
    v_cvt_pk_bf16_f32 v162, v208, v209
    v_mfma_f32_16x16x32_bf16 a[40:43], a[180:183], v[148:151], a[40:43]
    ds_read_b64_tr_b16 a[162:163], v24 offset:4096
    v_mfma_f32_16x16x32_bf16 a[44:47], a[176:179], v[152:155], a[44:47]
    ds_read_b128 a[216:219], v10 offset:24576
    v_cvt_pk_bf16_f32 v163, v210, v211
    v_mfma_f32_16x16x32_bf16 a[44:47], a[180:183], v[156:159], a[44:47]
    s_waitcnt lgkmcnt(3)
    buffer_load_dwordx4 v41, s[12:15], s41 offen offset:1024 lds
    v_mfma_f32_16x16x32_bf16 v[208:211], a[224:227], v[96:99], v[200:203]
    v_exp_f32 v212, v212
    v_mfma_f32_16x16x32_bf16 v[208:211], a[228:231], v[100:103], v[208:211]
    v_exp_f32 v213, v213
    v_mfma_f32_16x16x32_bf16 v[208:211], a[232:235], v[104:107], v[208:211]
    v_exp_f32 v214, v214
    v_mfma_f32_16x16x32_bf16 v[208:211], a[236:239], v[108:111], v[208:211]
    v_exp_f32 v215, v215
    v_mfma_f32_16x16x32_bf16 a[48:51], a[184:187], v[128:131], a[48:51]
    ds_read_b64_tr_b16 a[164:165], v24 offset:8192
    v_cvt_pk_bf16_f32 v170, v212, v213
    v_mfma_f32_16x16x32_bf16 a[48:51], a[188:191], v[132:135], a[48:51]
    ds_read_b64_tr_b16 a[166:167], v24 offset:12288
    v_mfma_f32_16x16x32_bf16 a[52:55], a[184:187], v[136:139], a[52:55]
    ds_read_b128 a[220:223], v11 offset:24576
    v_cvt_pk_bf16_f32 v171, v214, v215
    v_mfma_f32_16x16x32_bf16 a[52:55], a[188:191], v[140:143], a[52:55]
    v_smfmac_f32_16x16x64_bf16 a[200:203], v[52:55], v[144:151], v50
    v_mfma_f32_16x16x32_bf16 v[212:215], a[224:227], v[112:115], v[204:207]
    v_exp_f32 v208, v208
    v_mfma_f32_16x16x32_bf16 v[212:215], a[228:231], v[116:119], v[212:215]
    v_exp_f32 v209, v209
    v_mfma_f32_16x16x32_bf16 v[212:215], a[232:235], v[120:123], v[212:215]
    v_exp_f32 v210, v210
    v_mfma_f32_16x16x32_bf16 v[212:215], a[236:239], v[124:127], v[212:215]
    v_exp_f32 v211, v211
    v_mfma_f32_16x16x32_bf16 a[56:59], a[184:187], v[144:147], a[56:59]
    ds_read_b64_tr_b16 a[168:169], v25 offset:0
    v_cvt_pk_bf16_f32 v178, v208, v209
    v_mfma_f32_16x16x32_bf16 a[56:59], a[188:191], v[148:151], a[56:59]
    ds_read_b64_tr_b16 a[170:171], v25 offset:4096
    v_mfma_f32_16x16x32_bf16 a[60:63], a[184:187], v[152:155], a[60:63]
    ds_read_b128 a[224:227], v8 offset:28672
    v_cvt_pk_bf16_f32 v179, v210, v211
    v_mfma_f32_16x16x32_bf16 a[60:63], a[188:191], v[156:159], a[60:63]
    s_waitcnt lgkmcnt(3)
    buffer_load_dwordx4 v40, s[12:15], s41 offen offset:2048 lds
    v_mfma_f32_16x16x32_bf16 v[208:211], a[208:211], v[64:67], v[192:195]
    v_exp_f32 v212, v212
    v_mfma_f32_16x16x32_bf16 v[208:211], a[212:215], v[68:71], v[208:211]
    v_exp_f32 v213, v213
    v_mfma_f32_16x16x32_bf16 v[208:211], a[216:219], v[72:75], v[208:211]
    v_exp_f32 v214, v214
    v_mfma_f32_16x16x32_bf16 v[208:211], a[220:223], v[76:79], v[208:211]
    v_exp_f32 v215, v215
    v_mfma_f32_16x16x32_bf16 a[64:67], a[160:163], v[128:131], a[64:67]
    ds_read_b64_tr_b16 a[172:173], v25 offset:8192
    v_cvt_pk_bf16_f32 v186, v212, v213
    v_mfma_f32_16x16x32_bf16 a[64:67], a[164:167], v[132:135], a[64:67]
    ds_read_b64_tr_b16 a[174:175], v25 offset:12288
    v_mfma_f32_16x16x32_bf16 a[68:71], a[160:163], v[136:139], a[68:71]
    ds_read_b128 a[228:231], v9 offset:28672
    v_cvt_pk_bf16_f32 v187, v214, v215
    v_mfma_f32_16x16x32_bf16 a[68:71], a[164:167], v[140:143], a[68:71]
    v_smfmac_f32_16x16x64_bf16 a[204:207], v[52:55], v[152:159], v50
    v_mfma_f32_16x16x32_bf16 v[212:215], a[208:211], v[80:83], v[196:199]
    v_exp_f32 v208, v208
    v_mfma_f32_16x16x32_bf16 v[212:215], a[212:215], v[84:87], v[212:215]
    v_exp_f32 v209, v209
    v_mfma_f32_16x16x32_bf16 v[212:215], a[216:219], v[88:91], v[212:215]
    v_exp_f32 v210, v210
    v_mfma_f32_16x16x32_bf16 v[212:215], a[220:223], v[92:95], v[212:215]
    v_exp_f32 v211, v211
    v_mfma_f32_16x16x32_bf16 a[72:75], a[160:163], v[144:147], a[72:75]
    ds_read_b64_tr_b16 a[176:177], v26 offset:0
    v_cvt_pk_bf16_f32 v164, v208, v209
    v_mfma_f32_16x16x32_bf16 a[72:75], a[164:167], v[148:151], a[72:75]
    ds_read_b64_tr_b16 a[178:179], v26 offset:4096
    v_mfma_f32_16x16x32_bf16 a[76:79], a[160:163], v[152:155], a[76:79]
    ds_read_b128 a[232:235], v10 offset:28672
    v_cvt_pk_bf16_f32 v165, v210, v211
    v_mfma_f32_16x16x32_bf16 a[76:79], a[164:167], v[156:159], a[76:79]
    s_waitcnt lgkmcnt(3)
    buffer_load_dwordx4 v41, s[12:15], s41 offen offset:3072 lds
    v_mfma_f32_16x16x32_bf16 v[208:211], a[208:211], v[96:99], v[200:203]
    v_exp_f32 v212, v212
    v_mfma_f32_16x16x32_bf16 v[208:211], a[212:215], v[100:103], v[208:211]
    s_add_u32 s41, s41, 16384
    v_exp_f32 v213, v213
    v_mfma_f32_16x16x32_bf16 v[208:211], a[216:219], v[104:107], v[208:211]
    v_exp_f32 v214, v214
    v_mfma_f32_16x16x32_bf16 v[208:211], a[220:223], v[108:111], v[208:211]
    v_exp_f32 v215, v215
    v_mfma_f32_16x16x32_bf16 a[80:83], a[168:171], v[128:131], a[80:83]
    ds_read_b64_tr_b16 a[180:181], v26 offset:8192
    v_cvt_pk_bf16_f32 v172, v212, v213
    v_mfma_f32_16x16x32_bf16 a[80:83], a[172:175], v[132:135], a[80:83]
    ds_read_b64_tr_b16 a[182:183], v26 offset:12288
    v_mfma_f32_16x16x32_bf16 a[84:87], a[168:171], v[136:139], a[84:87]
    ds_read_b128 a[236:239], v11 offset:28672
    v_cvt_pk_bf16_f32 v173, v214, v215
    v_mfma_f32_16x16x32_bf16 a[84:87], a[172:175], v[140:143], a[84:87]
    s_waitcnt vmcnt(8)
    s_barrier
    v_mfma_f32_16x16x32_bf16 v[212:215], a[208:211], v[112:115], v[204:207]
    v_exp_f32 v208, v208
    v_mfma_f32_16x16x32_bf16 v[212:215], a[212:215], v[116:119], v[212:215]
    s_add_u32 m0, s42, 0
    v_exp_f32 v209, v209
    v_mfma_f32_16x16x32_bf16 v[212:215], a[216:219], v[120:123], v[212:215]
    v_exp_f32 v210, v210
    v_mfma_f32_16x16x32_bf16 v[212:215], a[220:223], v[124:127], v[212:215]
    v_exp_f32 v211, v211
    v_mfma_f32_16x16x32_bf16 a[88:91], a[168:171], v[144:147], a[88:91]
    ds_read_b64_tr_b16 a[184:185], v27 offset:0
    v_cvt_pk_bf16_f32 v180, v208, v209
    v_mfma_f32_16x16x32_bf16 a[88:91], a[172:175], v[148:151], a[88:91]
    ds_read_b64_tr_b16 a[186:187], v27 offset:4096
    v_mfma_f32_16x16x32_bf16 a[92:95], a[168:171], v[152:155], a[92:95]
    ds_read_b128 a[208:211], v8 offset:32768
    v_cvt_pk_bf16_f32 v181, v210, v211
    v_mfma_f32_16x16x32_bf16 a[92:95], a[172:175], v[156:159], a[92:95]
    s_waitcnt lgkmcnt(3)
    buffer_load_dwordx4 v36, s[8:11], s40 offen lds
    v_mfma_f32_16x16x32_bf16 v[208:211], a[224:227], v[64:67], v[192:195]
    v_exp_f32 v212, v212
    v_mfma_f32_16x16x32_bf16 v[208:211], a[228:231], v[68:71], v[208:211]
    v_exp_f32 v213, v213
    v_mfma_f32_16x16x32_bf16 v[208:211], a[232:235], v[72:75], v[208:211]
    v_exp_f32 v214, v214
    v_mfma_f32_16x16x32_bf16 v[208:211], a[236:239], v[76:79], v[208:211]
    v_exp_f32 v215, v215
    v_mfma_f32_16x16x32_bf16 a[96:99], a[176:179], v[128:131], a[96:99]
    ds_read_b64_tr_b16 a[188:189], v27 offset:8192
    v_cvt_pk_bf16_f32 v188, v212, v213
    v_mfma_f32_16x16x32_bf16 a[96:99], a[180:183], v[132:135], a[96:99]
    ds_read_b64_tr_b16 a[190:191], v27 offset:12288
    v_mfma_f32_16x16x32_bf16 a[100:103], a[176:179], v[136:139], a[100:103]
    ds_read_b128 a[212:215], v9 offset:32768
    v_cvt_pk_bf16_f32 v189, v214, v215
    v_mfma_f32_16x16x32_bf16 a[100:103], a[180:183], v[140:143], a[100:103]
    buffer_load_dword v217, v57, s[32:35], s39 offen
    v_mfma_f32_16x16x32_bf16 v[212:215], a[224:227], v[80:83], v[196:199]
    v_exp_f32 v208, v208
    v_mfma_f32_16x16x32_bf16 v[212:215], a[228:231], v[84:87], v[212:215]
    v_exp_f32 v209, v209
    v_mfma_f32_16x16x32_bf16 v[212:215], a[232:235], v[88:91], v[212:215]
    v_exp_f32 v210, v210
    v_mfma_f32_16x16x32_bf16 v[212:215], a[236:239], v[92:95], v[212:215]
    v_exp_f32 v211, v211
    v_mfma_f32_16x16x32_bf16 a[104:107], a[176:179], v[144:147], a[104:107]
    ds_read_b64_tr_b16 a[160:161], v20 offset:16384
    v_cvt_pk_bf16_f32 v166, v208, v209
    v_mfma_f32_16x16x32_bf16 a[104:107], a[180:183], v[148:151], a[104:107]
    ds_read_b64_tr_b16 a[162:163], v20 offset:20480
    v_mfma_f32_16x16x32_bf16 a[108:111], a[176:179], v[152:155], a[108:111]
    ds_read_b128 a[216:219], v10 offset:32768
    v_cvt_pk_bf16_f32 v167, v210, v211
    v_mfma_f32_16x16x32_bf16 a[108:111], a[180:183], v[156:159], a[108:111]
    s_waitcnt lgkmcnt(3)
    buffer_load_dwordx4 v37, s[8:11], s40 offen offset:1024 lds
    v_mfma_f32_16x16x32_bf16 v[208:211], a[224:227], v[96:99], v[200:203]
    v_exp_f32 v212, v212
    v_mfma_f32_16x16x32_bf16 v[208:211], a[228:231], v[100:103], v[208:211]
    v_exp_f32 v213, v213
    v_mfma_f32_16x16x32_bf16 v[208:211], a[232:235], v[104:107], v[208:211]
    v_exp_f32 v214, v214
    v_mfma_f32_16x16x32_bf16 v[208:211], a[236:239], v[108:111], v[208:211]
    v_exp_f32 v215, v215
    v_mfma_f32_16x16x32_bf16 a[112:115], a[184:187], v[128:131], a[112:115]
    ds_read_b64_tr_b16 a[164:165], v20 offset:24576
    v_cvt_pk_bf16_f32 v174, v212, v213
    v_mfma_f32_16x16x32_bf16 a[112:115], a[188:191], v[132:135], a[112:115]
    ds_read_b64_tr_b16 a[166:167], v20 offset:28672
    v_mfma_f32_16x16x32_bf16 a[116:119], a[184:187], v[136:139], a[116:119]
    ds_read_b128 a[220:223], v11 offset:32768
    v_cvt_pk_bf16_f32 v175, v214, v215
    v_mfma_f32_16x16x32_bf16 a[116:119], a[188:191], v[140:143], a[116:119]
    v_mfma_f32_16x16x32_bf16 v[212:215], a[224:227], v[112:115], v[204:207]
    v_exp_f32 v208, v208
    v_mfma_f32_16x16x32_bf16 v[212:215], a[228:231], v[116:119], v[212:215]
    v_exp_f32 v209, v209
    v_mfma_f32_16x16x32_bf16 v[212:215], a[232:235], v[120:123], v[212:215]
    v_exp_f32 v210, v210
    v_mfma_f32_16x16x32_bf16 v[212:215], a[236:239], v[124:127], v[212:215]
    v_exp_f32 v211, v211
    v_mfma_f32_16x16x32_bf16 a[120:123], a[184:187], v[144:147], a[120:123]
    ds_read_b64_tr_b16 a[168:169], v21 offset:16384
    v_cvt_pk_bf16_f32 v182, v208, v209
    v_mfma_f32_16x16x32_bf16 a[120:123], a[188:191], v[148:151], a[120:123]
    ds_read_b64_tr_b16 a[170:171], v21 offset:20480
    v_mfma_f32_16x16x32_bf16 a[124:127], a[184:187], v[152:155], a[124:127]
    ds_read_b128 a[224:227], v8 offset:36864
    v_cvt_pk_bf16_f32 v183, v210, v211
    v_mfma_f32_16x16x32_bf16 a[124:127], a[188:191], v[156:159], a[124:127]
    s_waitcnt lgkmcnt(3)
    buffer_load_dwordx4 v38, s[8:11], s40 offen offset:2048 lds
    v_mfma_f32_16x16x32_bf16 v[208:211], a[208:211], v[64:67], v[192:195]
    v_exp_f32 v212, v212
    v_mfma_f32_16x16x32_bf16 v[208:211], a[212:215], v[68:71], v[208:211]
    v_exp_f32 v213, v213
    v_mfma_f32_16x16x32_bf16 v[208:211], a[216:219], v[72:75], v[208:211]
    v_exp_f32 v214, v214
    v_mfma_f32_16x16x32_bf16 v[208:211], a[220:223], v[76:79], v[208:211]
    v_exp_f32 v215, v215
    v_mfma_f32_16x16x32_bf16 a[0:3], a[160:163], v[160:163], a[0:3]
    ds_read_b64_tr_b16 a[172:173], v21 offset:24576
    v_cvt_pk_bf16_f32 v190, v212, v213
    v_mfma_f32_16x16x32_bf16 a[0:3], a[164:167], v[164:167], a[0:3]
    ds_read_b64_tr_b16 a[174:175], v21 offset:28672
    v_mfma_f32_16x16x32_bf16 a[4:7], a[160:163], v[168:171], a[4:7]
    ds_read_b128 a[228:231], v9 offset:36864
    v_cvt_pk_bf16_f32 v191, v214, v215
    v_mfma_f32_16x16x32_bf16 a[4:7], a[164:167], v[172:175], a[4:7]
    v_mfma_f32_16x16x32_bf16 v[212:215], a[208:211], v[80:83], v[196:199]
    v_exp_f32 v208, v208
    v_mfma_f32_16x16x32_bf16 v[212:215], a[212:215], v[84:87], v[212:215]
    v_exp_f32 v209, v209
    v_mfma_f32_16x16x32_bf16 v[212:215], a[216:219], v[88:91], v[212:215]
    v_exp_f32 v210, v210
    v_mfma_f32_16x16x32_bf16 v[212:215], a[220:223], v[92:95], v[212:215]
    v_exp_f32 v211, v211
    v_mfma_f32_16x16x32_bf16 a[8:11], a[160:163], v[176:179], a[8:11]
    ds_read_b64_tr_b16 a[176:177], v22 offset:16384
    v_cvt_pk_bf16_f32 v128, v208, v209
    v_mfma_f32_16x16x32_bf16 a[8:11], a[164:167], v[180:183], a[8:11]
    ds_read_b64_tr_b16 a[178:179], v22 offset:20480
    v_mfma_f32_16x16x32_bf16 a[12:15], a[160:163], v[184:187], a[12:15]
    ds_read_b128 a[232:235], v10 offset:36864
    v_cvt_pk_bf16_f32 v129, v210, v211
    v_mfma_f32_16x16x32_bf16 a[12:15], a[164:167], v[188:191], a[12:15]
    s_waitcnt lgkmcnt(3)
    buffer_load_dwordx4 v39, s[8:11], s40 offen offset:3072 lds
    v_mfma_f32_16x16x32_bf16 v[208:211], a[208:211], v[96:99], v[200:203]
    v_exp_f32 v212, v212
    v_mfma_f32_16x16x32_bf16 v[208:211], a[212:215], v[100:103], v[208:211]
    s_add_u32 s40, s40, 16384
    v_exp_f32 v213, v213
    v_mfma_f32_16x16x32_bf16 v[208:211], a[216:219], v[104:107], v[208:211]
    v_exp_f32 v214, v214
    v_mfma_f32_16x16x32_bf16 v[208:211], a[220:223], v[108:111], v[208:211]
    v_exp_f32 v215, v215
    v_mfma_f32_16x16x32_bf16 a[16:19], a[168:171], v[160:163], a[16:19]
    ds_read_b64_tr_b16 a[180:181], v22 offset:24576
    v_cvt_pk_bf16_f32 v136, v212, v213
    v_mfma_f32_16x16x32_bf16 a[16:19], a[172:175], v[164:167], a[16:19]
    ds_read_b64_tr_b16 a[182:183], v22 offset:28672
    v_mfma_f32_16x16x32_bf16 a[20:23], a[168:171], v[168:171], a[20:23]
    ds_read_b128 a[236:239], v11 offset:36864
    v_cvt_pk_bf16_f32 v137, v214, v215
    v_mfma_f32_16x16x32_bf16 a[20:23], a[172:175], v[172:175], a[20:23]
    v_smfmac_f32_16x16x64_bf16 a[192:195], v[52:55], v[160:167], v50
    v_mfma_f32_16x16x32_bf16 v[212:215], a[208:211], v[112:115], v[204:207]
    v_exp_f32 v208, v208
    v_mfma_f32_16x16x32_bf16 v[212:215], a[212:215], v[116:119], v[212:215]
    s_add_u32 m0, s42, 114688
    v_exp_f32 v209, v209
    v_mfma_f32_16x16x32_bf16 v[212:215], a[216:219], v[120:123], v[212:215]
    v_exp_f32 v210, v210
    v_mfma_f32_16x16x32_bf16 v[212:215], a[220:223], v[124:127], v[212:215]
    v_exp_f32 v211, v211
    v_mfma_f32_16x16x32_bf16 a[24:27], a[168:171], v[176:179], a[24:27]
    ds_read_b64_tr_b16 a[184:185], v23 offset:16384
    v_cvt_pk_bf16_f32 v144, v208, v209
    v_mfma_f32_16x16x32_bf16 a[24:27], a[172:175], v[180:183], a[24:27]
    ds_read_b64_tr_b16 a[186:187], v23 offset:20480
    v_mfma_f32_16x16x32_bf16 a[28:31], a[168:171], v[184:187], a[28:31]
    ds_read_b128 a[208:211], v8 offset:40960
    v_cvt_pk_bf16_f32 v145, v210, v211
    v_mfma_f32_16x16x32_bf16 a[28:31], a[172:175], v[188:191], a[28:31]
    s_waitcnt lgkmcnt(3)
    buffer_load_dwordx4 v40, s[12:15], s41 offen lds
    v_mfma_f32_16x16x32_bf16 v[208:211], a[224:227], v[64:67], v[192:195]
    v_exp_f32 v212, v212
    v_mfma_f32_16x16x32_bf16 v[208:211], a[228:231], v[68:71], v[208:211]
    v_exp_f32 v213, v213
    v_mfma_f32_16x16x32_bf16 v[208:211], a[232:235], v[72:75], v[208:211]
    v_exp_f32 v214, v214
    v_mfma_f32_16x16x32_bf16 v[208:211], a[236:239], v[76:79], v[208:211]
    v_exp_f32 v215, v215
    v_mfma_f32_16x16x32_bf16 a[32:35], a[176:179], v[160:163], a[32:35]
    ds_read_b64_tr_b16 a[188:189], v23 offset:24576
    v_cvt_pk_bf16_f32 v152, v212, v213
    v_mfma_f32_16x16x32_bf16 a[32:35], a[180:183], v[164:167], a[32:35]
    ds_read_b64_tr_b16 a[190:191], v23 offset:28672
    v_mfma_f32_16x16x32_bf16 a[36:39], a[176:179], v[168:171], a[36:39]
    ds_read_b128 a[212:215], v9 offset:40960
    v_cvt_pk_bf16_f32 v153, v214, v215
    v_mfma_f32_16x16x32_bf16 a[36:39], a[180:183], v[172:175], a[36:39]
    v_smfmac_f32_16x16x64_bf16 a[196:199], v[52:55], v[168:175], v50
    v_mfma_f32_16x16x32_bf16 v[212:215], a[224:227], v[80:83], v[196:199]
    v_exp_f32 v208, v208
    v_mfma_f32_16x16x32_bf16 v[212:215], a[228:231], v[84:87], v[212:215]
    v_exp_f32 v209, v209
    v_mfma_f32_16x16x32_bf16 v[212:215], a[232:235], v[88:91], v[212:215]
    v_exp_f32 v210, v210
    v_mfma_f32_16x16x32_bf16 v[212:215], a[236:239], v[92:95], v[212:215]
    v_exp_f32 v211, v211
    v_mfma_f32_16x16x32_bf16 a[40:43], a[176:179], v[176:179], a[40:43]
    ds_read_b64_tr_b16 a[160:161], v24 offset:16384
    v_cvt_pk_bf16_f32 v130, v208, v209
    v_mfma_f32_16x16x32_bf16 a[40:43], a[180:183], v[180:183], a[40:43]
    ds_read_b64_tr_b16 a[162:163], v24 offset:20480
    v_mfma_f32_16x16x32_bf16 a[44:47], a[176:179], v[184:187], a[44:47]
    ds_read_b128 a[216:219], v10 offset:40960
    v_cvt_pk_bf16_f32 v131, v210, v211
    v_mfma_f32_16x16x32_bf16 a[44:47], a[180:183], v[188:191], a[44:47]
    s_waitcnt lgkmcnt(3)
    buffer_load_dwordx4 v41, s[12:15], s41 offen offset:1024 lds
    v_mfma_f32_16x16x32_bf16 v[208:211], a[224:227], v[96:99], v[200:203]
    v_exp_f32 v212, v212
    v_mfma_f32_16x16x32_bf16 v[208:211], a[228:231], v[100:103], v[208:211]
    v_exp_f32 v213, v213
    v_mfma_f32_16x16x32_bf16 v[208:211], a[232:235], v[104:107], v[208:211]
    v_exp_f32 v214, v214
    v_mfma_f32_16x16x32_bf16 v[208:211], a[236:239], v[108:111], v[208:211]
    v_exp_f32 v215, v215
    v_mfma_f32_16x16x32_bf16 a[48:51], a[184:187], v[160:163], a[48:51]
    ds_read_b64_tr_b16 a[164:165], v24 offset:24576
    v_cvt_pk_bf16_f32 v138, v212, v213
    v_mfma_f32_16x16x32_bf16 a[48:51], a[188:191], v[164:167], a[48:51]
    ds_read_b64_tr_b16 a[166:167], v24 offset:28672
    v_mfma_f32_16x16x32_bf16 a[52:55], a[184:187], v[168:171], a[52:55]
    ds_read_b128 a[220:223], v11 offset:40960
    v_cvt_pk_bf16_f32 v139, v214, v215
    v_mfma_f32_16x16x32_bf16 a[52:55], a[188:191], v[172:175], a[52:55]
    v_smfmac_f32_16x16x64_bf16 a[200:203], v[52:55], v[176:183], v50
    v_mfma_f32_16x16x32_bf16 v[212:215], a[224:227], v[112:115], v[204:207]
    v_exp_f32 v208, v208
    v_mfma_f32_16x16x32_bf16 v[212:215], a[228:231], v[116:119], v[212:215]
    v_exp_f32 v209, v209
    v_mfma_f32_16x16x32_bf16 v[212:215], a[232:235], v[120:123], v[212:215]
    v_exp_f32 v210, v210
    v_mfma_f32_16x16x32_bf16 v[212:215], a[236:239], v[124:127], v[212:215]
    v_exp_f32 v211, v211
    v_mfma_f32_16x16x32_bf16 a[56:59], a[184:187], v[176:179], a[56:59]
    ds_read_b64_tr_b16 a[168:169], v25 offset:16384
    v_cvt_pk_bf16_f32 v146, v208, v209
    v_mfma_f32_16x16x32_bf16 a[56:59], a[188:191], v[180:183], a[56:59]
    ds_read_b64_tr_b16 a[170:171], v25 offset:20480
    v_mfma_f32_16x16x32_bf16 a[60:63], a[184:187], v[184:187], a[60:63]
    ds_read_b128 a[224:227], v8 offset:45056
    v_cvt_pk_bf16_f32 v147, v210, v211
    v_mfma_f32_16x16x32_bf16 a[60:63], a[188:191], v[188:191], a[60:63]
    s_waitcnt lgkmcnt(3)
    buffer_load_dwordx4 v40, s[12:15], s41 offen offset:2048 lds
    v_mfma_f32_16x16x32_bf16 v[208:211], a[208:211], v[64:67], v[192:195]
    v_exp_f32 v212, v212
    v_mfma_f32_16x16x32_bf16 v[208:211], a[212:215], v[68:71], v[208:211]
    v_exp_f32 v213, v213
    v_mfma_f32_16x16x32_bf16 v[208:211], a[216:219], v[72:75], v[208:211]
    v_exp_f32 v214, v214
    v_mfma_f32_16x16x32_bf16 v[208:211], a[220:223], v[76:79], v[208:211]
    v_exp_f32 v215, v215
    v_mfma_f32_16x16x32_bf16 a[64:67], a[160:163], v[160:163], a[64:67]
    ds_read_b64_tr_b16 a[172:173], v25 offset:24576
    v_cvt_pk_bf16_f32 v154, v212, v213
    v_mfma_f32_16x16x32_bf16 a[64:67], a[164:167], v[164:167], a[64:67]
    ds_read_b64_tr_b16 a[174:175], v25 offset:28672
    v_mfma_f32_16x16x32_bf16 a[68:71], a[160:163], v[168:171], a[68:71]
    ds_read_b128 a[228:231], v9 offset:45056
    v_cvt_pk_bf16_f32 v155, v214, v215
    v_mfma_f32_16x16x32_bf16 a[68:71], a[164:167], v[172:175], a[68:71]
    v_smfmac_f32_16x16x64_bf16 a[204:207], v[52:55], v[184:191], v50
    v_mfma_f32_16x16x32_bf16 v[212:215], a[208:211], v[80:83], v[196:199]
    v_exp_f32 v208, v208
    v_mfma_f32_16x16x32_bf16 v[212:215], a[212:215], v[84:87], v[212:215]
    v_exp_f32 v209, v209
    v_mfma_f32_16x16x32_bf16 v[212:215], a[216:219], v[88:91], v[212:215]
    v_exp_f32 v210, v210
    v_mfma_f32_16x16x32_bf16 v[212:215], a[220:223], v[92:95], v[212:215]
    v_exp_f32 v211, v211
    v_mfma_f32_16x16x32_bf16 a[72:75], a[160:163], v[176:179], a[72:75]
    ds_read_b64_tr_b16 a[176:177], v26 offset:16384
    v_cvt_pk_bf16_f32 v132, v208, v209
    v_mfma_f32_16x16x32_bf16 a[72:75], a[164:167], v[180:183], a[72:75]
    ds_read_b64_tr_b16 a[178:179], v26 offset:20480
    v_mfma_f32_16x16x32_bf16 a[76:79], a[160:163], v[184:187], a[76:79]
    ds_read_b128 a[232:235], v10 offset:45056
    v_cvt_pk_bf16_f32 v133, v210, v211
    v_mfma_f32_16x16x32_bf16 a[76:79], a[164:167], v[188:191], a[76:79]
    s_waitcnt lgkmcnt(3)
    buffer_load_dwordx4 v41, s[12:15], s41 offen offset:3072 lds
    v_mfma_f32_16x16x32_bf16 v[208:211], a[208:211], v[96:99], v[200:203]
    v_exp_f32 v212, v212
    v_mfma_f32_16x16x32_bf16 v[208:211], a[212:215], v[100:103], v[208:211]
    s_add_u32 s41, s41, 16384
    v_exp_f32 v213, v213
    v_mfma_f32_16x16x32_bf16 v[208:211], a[216:219], v[104:107], v[208:211]
    v_exp_f32 v214, v214
    v_mfma_f32_16x16x32_bf16 v[208:211], a[220:223], v[108:111], v[208:211]
    v_exp_f32 v215, v215
    v_mfma_f32_16x16x32_bf16 a[80:83], a[168:171], v[160:163], a[80:83]
    ds_read_b64_tr_b16 a[180:181], v26 offset:24576
    v_cvt_pk_bf16_f32 v140, v212, v213
    v_mfma_f32_16x16x32_bf16 a[80:83], a[172:175], v[164:167], a[80:83]
    ds_read_b64_tr_b16 a[182:183], v26 offset:28672
    v_mfma_f32_16x16x32_bf16 a[84:87], a[168:171], v[168:171], a[84:87]
    ds_read_b128 a[236:239], v11 offset:45056
    v_cvt_pk_bf16_f32 v141, v214, v215
    v_mfma_f32_16x16x32_bf16 a[84:87], a[172:175], v[172:175], a[84:87]
    s_waitcnt vmcnt(9)
    s_barrier
    v_mfma_f32_16x16x32_bf16 v[212:215], a[208:211], v[112:115], v[204:207]
    v_exp_f32 v208, v208
    v_mfma_f32_16x16x32_bf16 v[212:215], a[212:215], v[116:119], v[212:215]
    s_add_u32 m0, s42, 16384
    v_exp_f32 v209, v209
    v_mfma_f32_16x16x32_bf16 v[212:215], a[216:219], v[120:123], v[212:215]
    v_exp_f32 v210, v210
    v_mfma_f32_16x16x32_bf16 v[212:215], a[220:223], v[124:127], v[212:215]
    v_exp_f32 v211, v211
    v_mfma_f32_16x16x32_bf16 a[88:91], a[168:171], v[176:179], a[88:91]
    ds_read_b64_tr_b16 a[184:185], v27 offset:16384
    v_cvt_pk_bf16_f32 v148, v208, v209
    v_mfma_f32_16x16x32_bf16 a[88:91], a[172:175], v[180:183], a[88:91]
    ds_read_b64_tr_b16 a[186:187], v27 offset:20480
    v_mfma_f32_16x16x32_bf16 a[92:95], a[168:171], v[184:187], a[92:95]
    ds_read_b128 a[208:211], v8 offset:49152
    v_cvt_pk_bf16_f32 v149, v210, v211
    v_mfma_f32_16x16x32_bf16 a[92:95], a[172:175], v[188:191], a[92:95]
    s_waitcnt lgkmcnt(3)
    buffer_load_dwordx4 v36, s[8:11], s40 offen lds
    v_mfma_f32_16x16x32_bf16 v[208:211], a[224:227], v[64:67], v[192:195]
    v_exp_f32 v212, v212
    v_mfma_f32_16x16x32_bf16 v[208:211], a[228:231], v[68:71], v[208:211]
    v_exp_f32 v213, v213
    v_mfma_f32_16x16x32_bf16 v[208:211], a[232:235], v[72:75], v[208:211]
    v_exp_f32 v214, v214
    v_mfma_f32_16x16x32_bf16 v[208:211], a[236:239], v[76:79], v[208:211]
    v_exp_f32 v215, v215
    v_mfma_f32_16x16x32_bf16 a[96:99], a[176:179], v[160:163], a[96:99]
    ds_read_b64_tr_b16 a[188:189], v27 offset:24576
    v_cvt_pk_bf16_f32 v156, v212, v213
    v_mfma_f32_16x16x32_bf16 a[96:99], a[180:183], v[164:167], a[96:99]
    ds_read_b64_tr_b16 a[190:191], v27 offset:28672
    v_mfma_f32_16x16x32_bf16 a[100:103], a[176:179], v[168:171], a[100:103]
    ds_read_b128 a[212:215], v9 offset:49152
    v_cvt_pk_bf16_f32 v157, v214, v215
    v_mfma_f32_16x16x32_bf16 a[100:103], a[180:183], v[172:175], a[100:103]
    buffer_load_dword v218, v57, s[80:83], s39 offen
    v_mfma_f32_16x16x32_bf16 v[212:215], a[224:227], v[80:83], v[196:199]
    v_exp_f32 v208, v208
    v_mfma_f32_16x16x32_bf16 v[212:215], a[228:231], v[84:87], v[212:215]
    v_exp_f32 v209, v209
    v_mfma_f32_16x16x32_bf16 v[212:215], a[232:235], v[88:91], v[212:215]
    v_exp_f32 v210, v210
    v_mfma_f32_16x16x32_bf16 v[212:215], a[236:239], v[92:95], v[212:215]
    v_exp_f32 v211, v211
    v_mfma_f32_16x16x32_bf16 a[104:107], a[176:179], v[176:179], a[104:107]
    ds_read_b64_tr_b16 a[160:161], v20 offset:32768
    v_cvt_pk_bf16_f32 v134, v208, v209
    v_mfma_f32_16x16x32_bf16 a[104:107], a[180:183], v[180:183], a[104:107]
    ds_read_b64_tr_b16 a[162:163], v20 offset:36864
    v_mfma_f32_16x16x32_bf16 a[108:111], a[176:179], v[184:187], a[108:111]
    ds_read_b128 a[216:219], v10 offset:49152
    v_cvt_pk_bf16_f32 v135, v210, v211
    v_mfma_f32_16x16x32_bf16 a[108:111], a[180:183], v[188:191], a[108:111]
    s_waitcnt lgkmcnt(3)
    buffer_load_dwordx4 v37, s[8:11], s40 offen offset:1024 lds
    v_mfma_f32_16x16x32_bf16 v[208:211], a[224:227], v[96:99], v[200:203]
    v_exp_f32 v212, v212
    v_mfma_f32_16x16x32_bf16 v[208:211], a[228:231], v[100:103], v[208:211]
    v_exp_f32 v213, v213
    v_mfma_f32_16x16x32_bf16 v[208:211], a[232:235], v[104:107], v[208:211]
    v_exp_f32 v214, v214
    v_mfma_f32_16x16x32_bf16 v[208:211], a[236:239], v[108:111], v[208:211]
    v_exp_f32 v215, v215
    v_mfma_f32_16x16x32_bf16 a[112:115], a[184:187], v[160:163], a[112:115]
    ds_read_b64_tr_b16 a[164:165], v20 offset:40960
    v_cvt_pk_bf16_f32 v142, v212, v213
    v_mfma_f32_16x16x32_bf16 a[112:115], a[188:191], v[164:167], a[112:115]
    ds_read_b64_tr_b16 a[166:167], v20 offset:45056
    v_mfma_f32_16x16x32_bf16 a[116:119], a[184:187], v[168:171], a[116:119]
    ds_read_b128 a[220:223], v11 offset:49152
    v_cvt_pk_bf16_f32 v143, v214, v215
    v_mfma_f32_16x16x32_bf16 a[116:119], a[188:191], v[172:175], a[116:119]
    v_mfma_f32_16x16x32_bf16 v[212:215], a[224:227], v[112:115], v[204:207]
    v_exp_f32 v208, v208
    v_mfma_f32_16x16x32_bf16 v[212:215], a[228:231], v[116:119], v[212:215]
    v_exp_f32 v209, v209
    v_mfma_f32_16x16x32_bf16 v[212:215], a[232:235], v[120:123], v[212:215]
    v_exp_f32 v210, v210
    v_mfma_f32_16x16x32_bf16 v[212:215], a[236:239], v[124:127], v[212:215]
    v_exp_f32 v211, v211
    v_mfma_f32_16x16x32_bf16 a[120:123], a[184:187], v[176:179], a[120:123]
    ds_read_b64_tr_b16 a[168:169], v21 offset:32768
    v_cvt_pk_bf16_f32 v150, v208, v209
    v_mfma_f32_16x16x32_bf16 a[120:123], a[188:191], v[180:183], a[120:123]
    ds_read_b64_tr_b16 a[170:171], v21 offset:36864
    v_mfma_f32_16x16x32_bf16 a[124:127], a[184:187], v[184:187], a[124:127]
    ds_read_b128 a[224:227], v8 offset:53248
    v_cvt_pk_bf16_f32 v151, v210, v211
    v_mfma_f32_16x16x32_bf16 a[124:127], a[188:191], v[188:191], a[124:127]
    s_waitcnt lgkmcnt(3)
    buffer_load_dwordx4 v38, s[8:11], s40 offen offset:2048 lds
    v_mfma_f32_16x16x32_bf16 v[208:211], a[208:211], v[64:67], v[192:195]
    v_exp_f32 v212, v212
    v_mfma_f32_16x16x32_bf16 v[208:211], a[212:215], v[68:71], v[208:211]
    v_exp_f32 v213, v213
    v_mfma_f32_16x16x32_bf16 v[208:211], a[216:219], v[72:75], v[208:211]
    v_exp_f32 v214, v214
    v_mfma_f32_16x16x32_bf16 v[208:211], a[220:223], v[76:79], v[208:211]
    v_exp_f32 v215, v215
    v_mfma_f32_16x16x32_bf16 a[0:3], a[160:163], v[128:131], a[0:3]
    ds_read_b64_tr_b16 a[172:173], v21 offset:40960
    v_cvt_pk_bf16_f32 v158, v212, v213
    v_mfma_f32_16x16x32_bf16 a[0:3], a[164:167], v[132:135], a[0:3]
    ds_read_b64_tr_b16 a[174:175], v21 offset:45056
    v_mfma_f32_16x16x32_bf16 a[4:7], a[160:163], v[136:139], a[4:7]
    ds_read_b128 a[228:231], v9 offset:53248
    v_cvt_pk_bf16_f32 v159, v214, v215
    v_mfma_f32_16x16x32_bf16 a[4:7], a[164:167], v[140:143], a[4:7]
    v_mfma_f32_16x16x32_bf16 v[212:215], a[208:211], v[80:83], v[196:199]
    v_exp_f32 v208, v208
    v_mfma_f32_16x16x32_bf16 v[212:215], a[212:215], v[84:87], v[212:215]
    v_exp_f32 v209, v209
    v_mfma_f32_16x16x32_bf16 v[212:215], a[216:219], v[88:91], v[212:215]
    v_exp_f32 v210, v210
    v_mfma_f32_16x16x32_bf16 v[212:215], a[220:223], v[92:95], v[212:215]
    v_exp_f32 v211, v211
    v_mfma_f32_16x16x32_bf16 a[8:11], a[160:163], v[144:147], a[8:11]
    ds_read_b64_tr_b16 a[176:177], v22 offset:32768
    v_cvt_pk_bf16_f32 v160, v208, v209
    v_mfma_f32_16x16x32_bf16 a[8:11], a[164:167], v[148:151], a[8:11]
    ds_read_b64_tr_b16 a[178:179], v22 offset:36864
    v_mfma_f32_16x16x32_bf16 a[12:15], a[160:163], v[152:155], a[12:15]
    ds_read_b128 a[232:235], v10 offset:53248
    v_cvt_pk_bf16_f32 v161, v210, v211
    v_mfma_f32_16x16x32_bf16 a[12:15], a[164:167], v[156:159], a[12:15]
    s_waitcnt lgkmcnt(3)
    buffer_load_dwordx4 v39, s[8:11], s40 offen offset:3072 lds
    v_mfma_f32_16x16x32_bf16 v[208:211], a[208:211], v[96:99], v[200:203]
    v_exp_f32 v212, v212
    v_mfma_f32_16x16x32_bf16 v[208:211], a[212:215], v[100:103], v[208:211]
    s_add_u32 s40, s40, 16384
    v_exp_f32 v213, v213
    v_mfma_f32_16x16x32_bf16 v[208:211], a[216:219], v[104:107], v[208:211]
    v_exp_f32 v214, v214
    v_mfma_f32_16x16x32_bf16 v[208:211], a[220:223], v[108:111], v[208:211]
    v_exp_f32 v215, v215
    v_mfma_f32_16x16x32_bf16 a[16:19], a[168:171], v[128:131], a[16:19]
    ds_read_b64_tr_b16 a[180:181], v22 offset:40960
    v_cvt_pk_bf16_f32 v168, v212, v213
    v_mfma_f32_16x16x32_bf16 a[16:19], a[172:175], v[132:135], a[16:19]
    ds_read_b64_tr_b16 a[182:183], v22 offset:45056
    v_mfma_f32_16x16x32_bf16 a[20:23], a[168:171], v[136:139], a[20:23]
    ds_read_b128 a[236:239], v11 offset:53248
    v_cvt_pk_bf16_f32 v169, v214, v215
    v_mfma_f32_16x16x32_bf16 a[20:23], a[172:175], v[140:143], a[20:23]
    v_smfmac_f32_16x16x64_bf16 a[192:195], v[52:55], v[128:135], v50
    v_mfma_f32_16x16x32_bf16 v[212:215], a[208:211], v[112:115], v[204:207]
    v_exp_f32 v208, v208
    v_mfma_f32_16x16x32_bf16 v[212:215], a[212:215], v[116:119], v[212:215]
    s_add_u32 m0, s42, 65536
    v_exp_f32 v209, v209
    v_mfma_f32_16x16x32_bf16 v[212:215], a[216:219], v[120:123], v[212:215]
    v_exp_f32 v210, v210
    v_mfma_f32_16x16x32_bf16 v[212:215], a[220:223], v[124:127], v[212:215]
    v_exp_f32 v211, v211
    v_mfma_f32_16x16x32_bf16 a[24:27], a[168:171], v[144:147], a[24:27]
    ds_read_b64_tr_b16 a[184:185], v23 offset:32768
    v_cvt_pk_bf16_f32 v176, v208, v209
    v_mfma_f32_16x16x32_bf16 a[24:27], a[172:175], v[148:151], a[24:27]
    ds_read_b64_tr_b16 a[186:187], v23 offset:36864
    v_mfma_f32_16x16x32_bf16 a[28:31], a[168:171], v[152:155], a[28:31]
    ds_read_b128 a[208:211], v8 offset:57344
    v_cvt_pk_bf16_f32 v177, v210, v211
    v_mfma_f32_16x16x32_bf16 a[28:31], a[172:175], v[156:159], a[28:31]
    s_waitcnt lgkmcnt(3)
    buffer_load_dwordx4 v40, s[12:15], s41 offen lds
    v_mfma_f32_16x16x32_bf16 v[208:211], a[224:227], v[64:67], v[192:195]
    v_exp_f32 v212, v212
    v_mfma_f32_16x16x32_bf16 v[208:211], a[228:231], v[68:71], v[208:211]
    v_exp_f32 v213, v213
    v_mfma_f32_16x16x32_bf16 v[208:211], a[232:235], v[72:75], v[208:211]
    v_exp_f32 v214, v214
    v_mfma_f32_16x16x32_bf16 v[208:211], a[236:239], v[76:79], v[208:211]
    v_exp_f32 v215, v215
    v_mfma_f32_16x16x32_bf16 a[32:35], a[176:179], v[128:131], a[32:35]
    ds_read_b64_tr_b16 a[188:189], v23 offset:40960
    v_cvt_pk_bf16_f32 v184, v212, v213
    v_mfma_f32_16x16x32_bf16 a[32:35], a[180:183], v[132:135], a[32:35]
    ds_read_b64_tr_b16 a[190:191], v23 offset:45056
    v_mfma_f32_16x16x32_bf16 a[36:39], a[176:179], v[136:139], a[36:39]
    ds_read_b128 a[212:215], v9 offset:57344
    v_cvt_pk_bf16_f32 v185, v214, v215
    v_mfma_f32_16x16x32_bf16 a[36:39], a[180:183], v[140:143], a[36:39]
    v_smfmac_f32_16x16x64_bf16 a[196:199], v[52:55], v[136:143], v50
    v_mfma_f32_16x16x32_bf16 v[212:215], a[224:227], v[80:83], v[196:199]
    v_exp_f32 v208, v208
    v_mfma_f32_16x16x32_bf16 v[212:215], a[228:231], v[84:87], v[212:215]
    v_exp_f32 v209, v209
    v_mfma_f32_16x16x32_bf16 v[212:215], a[232:235], v[88:91], v[212:215]
    v_exp_f32 v210, v210
    v_mfma_f32_16x16x32_bf16 v[212:215], a[236:239], v[92:95], v[212:215]
    v_exp_f32 v211, v211
    v_mfma_f32_16x16x32_bf16 a[40:43], a[176:179], v[144:147], a[40:43]
    ds_read_b64_tr_b16 a[160:161], v24 offset:32768
    v_cvt_pk_bf16_f32 v162, v208, v209
    v_mfma_f32_16x16x32_bf16 a[40:43], a[180:183], v[148:151], a[40:43]
    ds_read_b64_tr_b16 a[162:163], v24 offset:36864
    v_mfma_f32_16x16x32_bf16 a[44:47], a[176:179], v[152:155], a[44:47]
    ds_read_b128 a[216:219], v10 offset:57344
    v_cvt_pk_bf16_f32 v163, v210, v211
    v_mfma_f32_16x16x32_bf16 a[44:47], a[180:183], v[156:159], a[44:47]
    s_waitcnt lgkmcnt(3)
    buffer_load_dwordx4 v41, s[12:15], s41 offen offset:1024 lds
    v_mfma_f32_16x16x32_bf16 v[208:211], a[224:227], v[96:99], v[200:203]
    v_exp_f32 v212, v212
    v_mfma_f32_16x16x32_bf16 v[208:211], a[228:231], v[100:103], v[208:211]
    v_exp_f32 v213, v213
    v_mfma_f32_16x16x32_bf16 v[208:211], a[232:235], v[104:107], v[208:211]
    v_exp_f32 v214, v214
    v_mfma_f32_16x16x32_bf16 v[208:211], a[236:239], v[108:111], v[208:211]
    v_exp_f32 v215, v215
    v_mfma_f32_16x16x32_bf16 a[48:51], a[184:187], v[128:131], a[48:51]
    ds_read_b64_tr_b16 a[164:165], v24 offset:40960
    v_cvt_pk_bf16_f32 v170, v212, v213
    v_mfma_f32_16x16x32_bf16 a[48:51], a[188:191], v[132:135], a[48:51]
    ds_read_b64_tr_b16 a[166:167], v24 offset:45056
    v_mfma_f32_16x16x32_bf16 a[52:55], a[184:187], v[136:139], a[52:55]
    ds_read_b128 a[220:223], v11 offset:57344
    v_cvt_pk_bf16_f32 v171, v214, v215
    v_mfma_f32_16x16x32_bf16 a[52:55], a[188:191], v[140:143], a[52:55]
    v_smfmac_f32_16x16x64_bf16 a[200:203], v[52:55], v[144:151], v50
    v_mfma_f32_16x16x32_bf16 v[212:215], a[224:227], v[112:115], v[204:207]
    v_exp_f32 v208, v208
    v_mfma_f32_16x16x32_bf16 v[212:215], a[228:231], v[116:119], v[212:215]
    v_exp_f32 v209, v209
    v_mfma_f32_16x16x32_bf16 v[212:215], a[232:235], v[120:123], v[212:215]
    v_exp_f32 v210, v210
    v_mfma_f32_16x16x32_bf16 v[212:215], a[236:239], v[124:127], v[212:215]
    v_exp_f32 v211, v211
    v_mfma_f32_16x16x32_bf16 a[56:59], a[184:187], v[144:147], a[56:59]
    ds_read_b64_tr_b16 a[168:169], v25 offset:32768
    v_cvt_pk_bf16_f32 v178, v208, v209
    v_mfma_f32_16x16x32_bf16 a[56:59], a[188:191], v[148:151], a[56:59]
    ds_read_b64_tr_b16 a[170:171], v25 offset:36864
    v_mfma_f32_16x16x32_bf16 a[60:63], a[184:187], v[152:155], a[60:63]
    ds_read_b128 a[224:227], v8 offset:61440
    v_cvt_pk_bf16_f32 v179, v210, v211
    v_mfma_f32_16x16x32_bf16 a[60:63], a[188:191], v[156:159], a[60:63]
    s_waitcnt lgkmcnt(3)
    buffer_load_dwordx4 v40, s[12:15], s41 offen offset:2048 lds
    v_mfma_f32_16x16x32_bf16 v[208:211], a[208:211], v[64:67], v[192:195]
    v_exp_f32 v212, v212
    v_mfma_f32_16x16x32_bf16 v[208:211], a[212:215], v[68:71], v[208:211]
    v_exp_f32 v213, v213
    v_mfma_f32_16x16x32_bf16 v[208:211], a[216:219], v[72:75], v[208:211]
    v_exp_f32 v214, v214
    v_mfma_f32_16x16x32_bf16 v[208:211], a[220:223], v[76:79], v[208:211]
    v_exp_f32 v215, v215
    v_mfma_f32_16x16x32_bf16 a[64:67], a[160:163], v[128:131], a[64:67]
    ds_read_b64_tr_b16 a[172:173], v25 offset:40960
    v_cvt_pk_bf16_f32 v186, v212, v213
    v_mfma_f32_16x16x32_bf16 a[64:67], a[164:167], v[132:135], a[64:67]
    ds_read_b64_tr_b16 a[174:175], v25 offset:45056
    v_mfma_f32_16x16x32_bf16 a[68:71], a[160:163], v[136:139], a[68:71]
    ds_read_b128 a[228:231], v9 offset:61440
    v_cvt_pk_bf16_f32 v187, v214, v215
    v_mfma_f32_16x16x32_bf16 a[68:71], a[164:167], v[140:143], a[68:71]
    v_smfmac_f32_16x16x64_bf16 a[204:207], v[52:55], v[152:159], v50
    v_mfma_f32_16x16x32_bf16 v[212:215], a[208:211], v[80:83], v[196:199]
    v_exp_f32 v208, v208
    v_mfma_f32_16x16x32_bf16 v[212:215], a[212:215], v[84:87], v[212:215]
    v_exp_f32 v209, v209
    v_mfma_f32_16x16x32_bf16 v[212:215], a[216:219], v[88:91], v[212:215]
    v_exp_f32 v210, v210
    v_mfma_f32_16x16x32_bf16 v[212:215], a[220:223], v[92:95], v[212:215]
    v_exp_f32 v211, v211
    v_mfma_f32_16x16x32_bf16 a[72:75], a[160:163], v[144:147], a[72:75]
    ds_read_b64_tr_b16 a[176:177], v26 offset:32768
    v_cvt_pk_bf16_f32 v164, v208, v209
    v_mfma_f32_16x16x32_bf16 a[72:75], a[164:167], v[148:151], a[72:75]
    ds_read_b64_tr_b16 a[178:179], v26 offset:36864
    v_mfma_f32_16x16x32_bf16 a[76:79], a[160:163], v[152:155], a[76:79]
    ds_read_b128 a[232:235], v10 offset:61440
    v_cvt_pk_bf16_f32 v165, v210, v211
    v_mfma_f32_16x16x32_bf16 a[76:79], a[164:167], v[156:159], a[76:79]
    s_waitcnt lgkmcnt(3)
    buffer_load_dwordx4 v41, s[12:15], s41 offen offset:3072 lds
    v_mfma_f32_16x16x32_bf16 v[208:211], a[208:211], v[96:99], v[200:203]
    v_exp_f32 v212, v212
    v_mfma_f32_16x16x32_bf16 v[208:211], a[212:215], v[100:103], v[208:211]
    s_add_u32 s41, s41, 16384
    v_exp_f32 v213, v213
    v_mfma_f32_16x16x32_bf16 v[208:211], a[216:219], v[104:107], v[208:211]
    v_exp_f32 v214, v214
    v_mfma_f32_16x16x32_bf16 v[208:211], a[220:223], v[108:111], v[208:211]
    v_exp_f32 v215, v215
    v_mfma_f32_16x16x32_bf16 a[80:83], a[168:171], v[128:131], a[80:83]
    ds_read_b64_tr_b16 a[180:181], v26 offset:40960
    v_cvt_pk_bf16_f32 v172, v212, v213
    v_mfma_f32_16x16x32_bf16 a[80:83], a[172:175], v[132:135], a[80:83]
    ds_read_b64_tr_b16 a[182:183], v26 offset:45056
    v_mfma_f32_16x16x32_bf16 a[84:87], a[168:171], v[136:139], a[84:87]
    ds_read_b128 a[236:239], v11 offset:61440
    v_cvt_pk_bf16_f32 v173, v214, v215
    v_mfma_f32_16x16x32_bf16 a[84:87], a[172:175], v[140:143], a[84:87]
    s_waitcnt vmcnt(9)
    s_barrier
    v_mfma_f32_16x16x32_bf16 v[212:215], a[208:211], v[112:115], v[204:207]
    v_exp_f32 v208, v208
    v_mfma_f32_16x16x32_bf16 v[212:215], a[212:215], v[116:119], v[212:215]
    s_add_u32 m0, s42, 32768
    v_exp_f32 v209, v209
    v_mfma_f32_16x16x32_bf16 v[212:215], a[216:219], v[120:123], v[212:215]
    v_exp_f32 v210, v210
    v_mfma_f32_16x16x32_bf16 v[212:215], a[220:223], v[124:127], v[212:215]
    v_exp_f32 v211, v211
    v_mfma_f32_16x16x32_bf16 a[88:91], a[168:171], v[144:147], a[88:91]
    ds_read_b64_tr_b16 a[184:185], v27 offset:32768
    v_cvt_pk_bf16_f32 v180, v208, v209
    v_mfma_f32_16x16x32_bf16 a[88:91], a[172:175], v[148:151], a[88:91]
    ds_read_b64_tr_b16 a[186:187], v27 offset:36864
    v_mfma_f32_16x16x32_bf16 a[92:95], a[168:171], v[152:155], a[92:95]
    ds_read_b128 a[208:211], v8 offset:0
    v_cvt_pk_bf16_f32 v181, v210, v211
    v_mfma_f32_16x16x32_bf16 a[92:95], a[172:175], v[156:159], a[92:95]
    s_waitcnt lgkmcnt(3)
    buffer_load_dwordx4 v36, s[8:11], s40 offen lds
    v_mfma_f32_16x16x32_bf16 v[208:211], a[224:227], v[64:67], v[192:195]
    v_exp_f32 v212, v212
    v_mfma_f32_16x16x32_bf16 v[208:211], a[228:231], v[68:71], v[208:211]
    v_exp_f32 v213, v213
    v_mfma_f32_16x16x32_bf16 v[208:211], a[232:235], v[72:75], v[208:211]
    v_exp_f32 v214, v214
    v_mfma_f32_16x16x32_bf16 v[208:211], a[236:239], v[76:79], v[208:211]
    v_exp_f32 v215, v215
    v_mfma_f32_16x16x32_bf16 a[96:99], a[176:179], v[128:131], a[96:99]
    ds_read_b64_tr_b16 a[188:189], v27 offset:40960
    v_cvt_pk_bf16_f32 v188, v212, v213
    v_mfma_f32_16x16x32_bf16 a[96:99], a[180:183], v[132:135], a[96:99]
    ds_read_b64_tr_b16 a[190:191], v27 offset:45056
    v_mfma_f32_16x16x32_bf16 a[100:103], a[176:179], v[136:139], a[100:103]
    ds_read_b128 a[212:215], v9 offset:0
    v_cvt_pk_bf16_f32 v189, v214, v215
    v_mfma_f32_16x16x32_bf16 a[100:103], a[180:183], v[140:143], a[100:103]
    buffer_load_dword v219, v62, s[84:87], s38 offen
    v_mfma_f32_16x16x32_bf16 v[212:215], a[224:227], v[80:83], v[196:199]
    v_exp_f32 v208, v208
    v_mfma_f32_16x16x32_bf16 v[212:215], a[228:231], v[84:87], v[212:215]
    v_exp_f32 v209, v209
    v_mfma_f32_16x16x32_bf16 v[212:215], a[232:235], v[88:91], v[212:215]
    v_exp_f32 v210, v210
    v_mfma_f32_16x16x32_bf16 v[212:215], a[236:239], v[92:95], v[212:215]
    v_exp_f32 v211, v211
    v_mfma_f32_16x16x32_bf16 a[104:107], a[176:179], v[144:147], a[104:107]
    ds_read_b64_tr_b16 a[160:161], v20 offset:49152
    v_cvt_pk_bf16_f32 v166, v208, v209
    v_mfma_f32_16x16x32_bf16 a[104:107], a[180:183], v[148:151], a[104:107]
    ds_read_b64_tr_b16 a[162:163], v20 offset:53248
    v_mfma_f32_16x16x32_bf16 a[108:111], a[176:179], v[152:155], a[108:111]
    ds_read_b128 a[216:219], v10 offset:0
    v_cvt_pk_bf16_f32 v167, v210, v211
    v_mfma_f32_16x16x32_bf16 a[108:111], a[180:183], v[156:159], a[108:111]
    s_waitcnt lgkmcnt(3)
    buffer_load_dwordx4 v37, s[8:11], s40 offen offset:1024 lds
    v_mfma_f32_16x16x32_bf16 v[208:211], a[224:227], v[96:99], v[200:203]
    v_exp_f32 v212, v212
    v_mfma_f32_16x16x32_bf16 v[208:211], a[228:231], v[100:103], v[208:211]
    v_exp_f32 v213, v213
    v_mfma_f32_16x16x32_bf16 v[208:211], a[232:235], v[104:107], v[208:211]
    v_exp_f32 v214, v214
    v_mfma_f32_16x16x32_bf16 v[208:211], a[236:239], v[108:111], v[208:211]
    v_exp_f32 v215, v215
    v_mfma_f32_16x16x32_bf16 a[112:115], a[184:187], v[128:131], a[112:115]
    ds_read_b64_tr_b16 a[164:165], v20 offset:57344
    v_cvt_pk_bf16_f32 v174, v212, v213
    v_mfma_f32_16x16x32_bf16 a[112:115], a[188:191], v[132:135], a[112:115]
    ds_read_b64_tr_b16 a[166:167], v20 offset:61440
    v_mfma_f32_16x16x32_bf16 a[116:119], a[184:187], v[136:139], a[116:119]
    ds_read_b128 a[220:223], v11 offset:0
    v_cvt_pk_bf16_f32 v175, v214, v215
    v_mfma_f32_16x16x32_bf16 a[116:119], a[188:191], v[140:143], a[116:119]
    v_mfma_f32_16x16x32_bf16 v[212:215], a[224:227], v[112:115], v[204:207]
    v_exp_f32 v208, v208
    v_mfma_f32_16x16x32_bf16 v[212:215], a[228:231], v[116:119], v[212:215]
    v_exp_f32 v209, v209
    v_mfma_f32_16x16x32_bf16 v[212:215], a[232:235], v[120:123], v[212:215]
    v_exp_f32 v210, v210
    v_mfma_f32_16x16x32_bf16 v[212:215], a[236:239], v[124:127], v[212:215]
    v_exp_f32 v211, v211
    v_mfma_f32_16x16x32_bf16 a[120:123], a[184:187], v[144:147], a[120:123]
    ds_read_b64_tr_b16 a[168:169], v21 offset:49152
    v_cvt_pk_bf16_f32 v182, v208, v209
    v_mfma_f32_16x16x32_bf16 a[120:123], a[188:191], v[148:151], a[120:123]
    ds_read_b64_tr_b16 a[170:171], v21 offset:53248
    v_mfma_f32_16x16x32_bf16 a[124:127], a[184:187], v[152:155], a[124:127]
    ds_read_b128 a[224:227], v8 offset:4096
    v_cvt_pk_bf16_f32 v183, v210, v211
    v_mfma_f32_16x16x32_bf16 a[124:127], a[188:191], v[156:159], a[124:127]
    s_waitcnt lgkmcnt(3)
    buffer_load_dwordx4 v38, s[8:11], s40 offen offset:2048 lds
    v_mfma_f32_16x16x32_bf16 v[208:211], a[208:211], v[64:67], v[192:195]
    v_exp_f32 v212, v212
    v_mfma_f32_16x16x32_bf16 v[208:211], a[212:215], v[68:71], v[208:211]
    v_exp_f32 v213, v213
    v_mfma_f32_16x16x32_bf16 v[208:211], a[216:219], v[72:75], v[208:211]
    v_exp_f32 v214, v214
    v_mfma_f32_16x16x32_bf16 v[208:211], a[220:223], v[76:79], v[208:211]
    v_exp_f32 v215, v215
    v_mfma_f32_16x16x32_bf16 a[0:3], a[160:163], v[160:163], a[0:3]
    ds_read_b64_tr_b16 a[172:173], v21 offset:57344
    v_cvt_pk_bf16_f32 v190, v212, v213
    v_mfma_f32_16x16x32_bf16 a[0:3], a[164:167], v[164:167], a[0:3]
    ds_read_b64_tr_b16 a[174:175], v21 offset:61440
    v_mfma_f32_16x16x32_bf16 a[4:7], a[160:163], v[168:171], a[4:7]
    ds_read_b128 a[228:231], v9 offset:4096
    v_cvt_pk_bf16_f32 v191, v214, v215
    v_mfma_f32_16x16x32_bf16 a[4:7], a[164:167], v[172:175], a[4:7]
    v_mfma_f32_16x16x32_bf16 v[212:215], a[208:211], v[80:83], v[196:199]
    v_exp_f32 v208, v208
    v_mfma_f32_16x16x32_bf16 v[212:215], a[212:215], v[84:87], v[212:215]
    v_exp_f32 v209, v209
    v_mfma_f32_16x16x32_bf16 v[212:215], a[216:219], v[88:91], v[212:215]
    v_exp_f32 v210, v210
    v_mfma_f32_16x16x32_bf16 v[212:215], a[220:223], v[92:95], v[212:215]
    v_exp_f32 v211, v211
    v_mfma_f32_16x16x32_bf16 a[8:11], a[160:163], v[176:179], a[8:11]
    ds_read_b64_tr_b16 a[176:177], v22 offset:49152
    v_cvt_pk_bf16_f32 v128, v208, v209
    v_mfma_f32_16x16x32_bf16 a[8:11], a[164:167], v[180:183], a[8:11]
    ds_read_b64_tr_b16 a[178:179], v22 offset:53248
    v_mfma_f32_16x16x32_bf16 a[12:15], a[160:163], v[184:187], a[12:15]
    ds_read_b128 a[232:235], v10 offset:4096
    v_cvt_pk_bf16_f32 v129, v210, v211
    v_mfma_f32_16x16x32_bf16 a[12:15], a[164:167], v[188:191], a[12:15]
    s_waitcnt lgkmcnt(3)
    buffer_load_dwordx4 v39, s[8:11], s40 offen offset:3072 lds
    v_mfma_f32_16x16x32_bf16 v[208:211], a[208:211], v[96:99], v[200:203]
    v_exp_f32 v212, v212
    v_mfma_f32_16x16x32_bf16 v[208:211], a[212:215], v[100:103], v[208:211]
    s_add_u32 s40, s40, 16384
    v_exp_f32 v213, v213
    v_mfma_f32_16x16x32_bf16 v[208:211], a[216:219], v[104:107], v[208:211]
    v_exp_f32 v214, v214
    v_mfma_f32_16x16x32_bf16 v[208:211], a[220:223], v[108:111], v[208:211]
    v_exp_f32 v215, v215
    v_mfma_f32_16x16x32_bf16 a[16:19], a[168:171], v[160:163], a[16:19]
    ds_read_b64_tr_b16 a[180:181], v22 offset:57344
    v_cvt_pk_bf16_f32 v136, v212, v213
    v_mfma_f32_16x16x32_bf16 a[16:19], a[172:175], v[164:167], a[16:19]
    ds_read_b64_tr_b16 a[182:183], v22 offset:61440
    v_mfma_f32_16x16x32_bf16 a[20:23], a[168:171], v[168:171], a[20:23]
    ds_read_b128 a[236:239], v11 offset:4096
    v_cvt_pk_bf16_f32 v137, v214, v215
    v_mfma_f32_16x16x32_bf16 a[20:23], a[172:175], v[172:175], a[20:23]
    v_smfmac_f32_16x16x64_bf16 a[192:195], v[52:55], v[160:167], v50
    v_mfma_f32_16x16x32_bf16 v[212:215], a[208:211], v[112:115], v[204:207]
    v_exp_f32 v208, v208
    v_mfma_f32_16x16x32_bf16 v[212:215], a[212:215], v[116:119], v[212:215]
    s_add_u32 m0, s42, 81920
    v_exp_f32 v209, v209
    v_mfma_f32_16x16x32_bf16 v[212:215], a[216:219], v[120:123], v[212:215]
    v_exp_f32 v210, v210
    v_mfma_f32_16x16x32_bf16 v[212:215], a[220:223], v[124:127], v[212:215]
    v_exp_f32 v211, v211
    v_mfma_f32_16x16x32_bf16 a[24:27], a[168:171], v[176:179], a[24:27]
    ds_read_b64_tr_b16 a[184:185], v23 offset:49152
    v_cvt_pk_bf16_f32 v144, v208, v209
    v_mfma_f32_16x16x32_bf16 a[24:27], a[172:175], v[180:183], a[24:27]
    ds_read_b64_tr_b16 a[186:187], v23 offset:53248
    v_mfma_f32_16x16x32_bf16 a[28:31], a[168:171], v[184:187], a[28:31]
    ds_read_b128 a[208:211], v8 offset:8192
    v_cvt_pk_bf16_f32 v145, v210, v211
    v_mfma_f32_16x16x32_bf16 a[28:31], a[172:175], v[188:191], a[28:31]
    s_waitcnt lgkmcnt(3)
    buffer_load_dwordx4 v40, s[12:15], s41 offen lds
    v_mfma_f32_16x16x32_bf16 v[208:211], a[224:227], v[64:67], v[192:195]
    v_exp_f32 v212, v212
    v_mfma_f32_16x16x32_bf16 v[208:211], a[228:231], v[68:71], v[208:211]
    v_exp_f32 v213, v213
    v_mfma_f32_16x16x32_bf16 v[208:211], a[232:235], v[72:75], v[208:211]
    v_exp_f32 v214, v214
    v_mfma_f32_16x16x32_bf16 v[208:211], a[236:239], v[76:79], v[208:211]
    v_exp_f32 v215, v215
    v_mfma_f32_16x16x32_bf16 a[32:35], a[176:179], v[160:163], a[32:35]
    ds_read_b64_tr_b16 a[188:189], v23 offset:57344
    v_cvt_pk_bf16_f32 v152, v212, v213
    v_mfma_f32_16x16x32_bf16 a[32:35], a[180:183], v[164:167], a[32:35]
    ds_read_b64_tr_b16 a[190:191], v23 offset:61440
    v_mfma_f32_16x16x32_bf16 a[36:39], a[176:179], v[168:171], a[36:39]
    ds_read_b128 a[212:215], v9 offset:8192
    v_cvt_pk_bf16_f32 v153, v214, v215
    v_mfma_f32_16x16x32_bf16 a[36:39], a[180:183], v[172:175], a[36:39]
    v_smfmac_f32_16x16x64_bf16 a[196:199], v[52:55], v[168:175], v50
    v_mfma_f32_16x16x32_bf16 v[212:215], a[224:227], v[80:83], v[196:199]
    v_exp_f32 v208, v208
    v_mfma_f32_16x16x32_bf16 v[212:215], a[228:231], v[84:87], v[212:215]
    v_exp_f32 v209, v209
    v_mfma_f32_16x16x32_bf16 v[212:215], a[232:235], v[88:91], v[212:215]
    v_exp_f32 v210, v210
    v_mfma_f32_16x16x32_bf16 v[212:215], a[236:239], v[92:95], v[212:215]
    v_exp_f32 v211, v211
    v_mfma_f32_16x16x32_bf16 a[40:43], a[176:179], v[176:179], a[40:43]
    ds_read_b64_tr_b16 a[160:161], v24 offset:49152
    v_cvt_pk_bf16_f32 v130, v208, v209
    v_mfma_f32_16x16x32_bf16 a[40:43], a[180:183], v[180:183], a[40:43]
    ds_read_b64_tr_b16 a[162:163], v24 offset:53248
    v_mfma_f32_16x16x32_bf16 a[44:47], a[176:179], v[184:187], a[44:47]
    ds_read_b128 a[216:219], v10 offset:8192
    v_cvt_pk_bf16_f32 v131, v210, v211
    v_mfma_f32_16x16x32_bf16 a[44:47], a[180:183], v[188:191], a[44:47]
    s_waitcnt lgkmcnt(3)
    buffer_load_dwordx4 v41, s[12:15], s41 offen offset:1024 lds
    v_mfma_f32_16x16x32_bf16 v[208:211], a[224:227], v[96:99], v[200:203]
    v_exp_f32 v212, v212
    v_mfma_f32_16x16x32_bf16 v[208:211], a[228:231], v[100:103], v[208:211]
    v_exp_f32 v213, v213
    v_mfma_f32_16x16x32_bf16 v[208:211], a[232:235], v[104:107], v[208:211]
    v_exp_f32 v214, v214
    v_mfma_f32_16x16x32_bf16 v[208:211], a[236:239], v[108:111], v[208:211]
    v_exp_f32 v215, v215
    v_mfma_f32_16x16x32_bf16 a[48:51], a[184:187], v[160:163], a[48:51]
    ds_read_b64_tr_b16 a[164:165], v24 offset:57344
    v_cvt_pk_bf16_f32 v138, v212, v213
    v_mfma_f32_16x16x32_bf16 a[48:51], a[188:191], v[164:167], a[48:51]
    ds_read_b64_tr_b16 a[166:167], v24 offset:61440
    v_mfma_f32_16x16x32_bf16 a[52:55], a[184:187], v[168:171], a[52:55]
    ds_read_b128 a[220:223], v11 offset:8192
    v_cvt_pk_bf16_f32 v139, v214, v215
    v_mfma_f32_16x16x32_bf16 a[52:55], a[188:191], v[172:175], a[52:55]
    v_smfmac_f32_16x16x64_bf16 a[200:203], v[52:55], v[176:183], v50
    v_mfma_f32_16x16x32_bf16 v[212:215], a[224:227], v[112:115], v[204:207]
    v_exp_f32 v208, v208
    v_mfma_f32_16x16x32_bf16 v[212:215], a[228:231], v[116:119], v[212:215]
    v_exp_f32 v209, v209
    v_mfma_f32_16x16x32_bf16 v[212:215], a[232:235], v[120:123], v[212:215]
    v_exp_f32 v210, v210
    v_mfma_f32_16x16x32_bf16 v[212:215], a[236:239], v[124:127], v[212:215]
    v_exp_f32 v211, v211
    v_mfma_f32_16x16x32_bf16 a[56:59], a[184:187], v[176:179], a[56:59]
    ds_read_b64_tr_b16 a[168:169], v25 offset:49152
    v_cvt_pk_bf16_f32 v146, v208, v209
    v_mfma_f32_16x16x32_bf16 a[56:59], a[188:191], v[180:183], a[56:59]
    ds_read_b64_tr_b16 a[170:171], v25 offset:53248
    v_mfma_f32_16x16x32_bf16 a[60:63], a[184:187], v[184:187], a[60:63]
    ds_read_b128 a[224:227], v8 offset:12288
    v_cvt_pk_bf16_f32 v147, v210, v211
    v_mfma_f32_16x16x32_bf16 a[60:63], a[188:191], v[188:191], a[60:63]
    s_waitcnt lgkmcnt(3)
    buffer_load_dwordx4 v40, s[12:15], s41 offen offset:2048 lds
    v_mfma_f32_16x16x32_bf16 v[208:211], a[208:211], v[64:67], v[192:195]
    v_exp_f32 v212, v212
    v_mfma_f32_16x16x32_bf16 v[208:211], a[212:215], v[68:71], v[208:211]
    v_exp_f32 v213, v213
    v_mfma_f32_16x16x32_bf16 v[208:211], a[216:219], v[72:75], v[208:211]
    v_exp_f32 v214, v214
    v_mfma_f32_16x16x32_bf16 v[208:211], a[220:223], v[76:79], v[208:211]
    v_exp_f32 v215, v215
    v_mfma_f32_16x16x32_bf16 a[64:67], a[160:163], v[160:163], a[64:67]
    ds_read_b64_tr_b16 a[172:173], v25 offset:57344
    v_cvt_pk_bf16_f32 v154, v212, v213
    v_mfma_f32_16x16x32_bf16 a[64:67], a[164:167], v[164:167], a[64:67]
    ds_read_b64_tr_b16 a[174:175], v25 offset:61440
    v_mfma_f32_16x16x32_bf16 a[68:71], a[160:163], v[168:171], a[68:71]
    ds_read_b128 a[228:231], v9 offset:12288
    v_cvt_pk_bf16_f32 v155, v214, v215
    v_mfma_f32_16x16x32_bf16 a[68:71], a[164:167], v[172:175], a[68:71]
    v_smfmac_f32_16x16x64_bf16 a[204:207], v[52:55], v[184:191], v50
    v_mfma_f32_16x16x32_bf16 v[212:215], a[208:211], v[80:83], v[196:199]
    v_exp_f32 v208, v208
    v_mfma_f32_16x16x32_bf16 v[212:215], a[212:215], v[84:87], v[212:215]
    v_exp_f32 v209, v209
    v_mfma_f32_16x16x32_bf16 v[212:215], a[216:219], v[88:91], v[212:215]
    v_exp_f32 v210, v210
    v_mfma_f32_16x16x32_bf16 v[212:215], a[220:223], v[92:95], v[212:215]
    v_exp_f32 v211, v211
    v_mfma_f32_16x16x32_bf16 a[72:75], a[160:163], v[176:179], a[72:75]
    ds_read_b64_tr_b16 a[176:177], v26 offset:49152
    v_cvt_pk_bf16_f32 v132, v208, v209
    v_mfma_f32_16x16x32_bf16 a[72:75], a[164:167], v[180:183], a[72:75]
    ds_read_b64_tr_b16 a[178:179], v26 offset:53248
    v_mfma_f32_16x16x32_bf16 a[76:79], a[160:163], v[184:187], a[76:79]
    ds_read_b128 a[232:235], v10 offset:12288
    v_cvt_pk_bf16_f32 v133, v210, v211
    v_mfma_f32_16x16x32_bf16 a[76:79], a[164:167], v[188:191], a[76:79]
    s_waitcnt lgkmcnt(3)
    buffer_load_dwordx4 v41, s[12:15], s41 offen offset:3072 lds
    v_mfma_f32_16x16x32_bf16 v[208:211], a[208:211], v[96:99], v[200:203]
    v_exp_f32 v212, v212
    v_mfma_f32_16x16x32_bf16 v[208:211], a[212:215], v[100:103], v[208:211]
    s_add_u32 s41, s41, 16384
    v_exp_f32 v213, v213
    v_mfma_f32_16x16x32_bf16 v[208:211], a[216:219], v[104:107], v[208:211]
    v_exp_f32 v214, v214
    v_mfma_f32_16x16x32_bf16 v[208:211], a[220:223], v[108:111], v[208:211]
    v_exp_f32 v215, v215
    v_mfma_f32_16x16x32_bf16 a[80:83], a[168:171], v[160:163], a[80:83]
    ds_read_b64_tr_b16 a[180:181], v26 offset:57344
    v_cvt_pk_bf16_f32 v140, v212, v213
    v_mfma_f32_16x16x32_bf16 a[80:83], a[172:175], v[164:167], a[80:83]
    ds_read_b64_tr_b16 a[182:183], v26 offset:61440
    v_mfma_f32_16x16x32_bf16 a[84:87], a[168:171], v[168:171], a[84:87]
    ds_read_b128 a[236:239], v11 offset:12288
    v_cvt_pk_bf16_f32 v141, v214, v215
    v_mfma_f32_16x16x32_bf16 a[84:87], a[172:175], v[172:175], a[84:87]
    s_waitcnt vmcnt(9)
    s_barrier
    v_mfma_f32_16x16x32_bf16 v[212:215], a[208:211], v[112:115], v[204:207]
    v_exp_f32 v208, v208
    v_mfma_f32_16x16x32_bf16 v[212:215], a[212:215], v[116:119], v[212:215]
    s_add_u32 m0, s42, 49152
    v_exp_f32 v209, v209
    v_mfma_f32_16x16x32_bf16 v[212:215], a[216:219], v[120:123], v[212:215]
    v_exp_f32 v210, v210
    v_mfma_f32_16x16x32_bf16 v[212:215], a[220:223], v[124:127], v[212:215]
    v_exp_f32 v211, v211
    v_mfma_f32_16x16x32_bf16 a[88:91], a[168:171], v[176:179], a[88:91]
    ds_read_b64_tr_b16 a[184:185], v27 offset:49152
    v_cvt_pk_bf16_f32 v148, v208, v209
    v_mfma_f32_16x16x32_bf16 a[88:91], a[172:175], v[180:183], a[88:91]
    ds_read_b64_tr_b16 a[186:187], v27 offset:53248
    v_mfma_f32_16x16x32_bf16 a[92:95], a[168:171], v[184:187], a[92:95]
    ds_read_b128 a[208:211], v8 offset:16384
    v_cvt_pk_bf16_f32 v149, v210, v211
    v_mfma_f32_16x16x32_bf16 a[92:95], a[172:175], v[188:191], a[92:95]
    s_waitcnt lgkmcnt(3)
    buffer_load_dwordx4 v36, s[8:11], s40 offen lds
    v_mfma_f32_16x16x32_bf16 v[208:211], a[224:227], v[64:67], v[192:195]
    v_exp_f32 v212, v212
    v_mfma_f32_16x16x32_bf16 v[208:211], a[228:231], v[68:71], v[208:211]
    v_exp_f32 v213, v213
    v_mfma_f32_16x16x32_bf16 v[208:211], a[232:235], v[72:75], v[208:211]
    v_exp_f32 v214, v214
    v_mfma_f32_16x16x32_bf16 v[208:211], a[236:239], v[76:79], v[208:211]
    v_exp_f32 v215, v215
    v_mfma_f32_16x16x32_bf16 a[96:99], a[176:179], v[160:163], a[96:99]
    ds_read_b64_tr_b16 a[188:189], v27 offset:57344
    v_cvt_pk_bf16_f32 v156, v212, v213
    v_mfma_f32_16x16x32_bf16 a[96:99], a[180:183], v[164:167], a[96:99]
    ds_read_b64_tr_b16 a[190:191], v27 offset:61440
    v_mfma_f32_16x16x32_bf16 a[100:103], a[176:179], v[168:171], a[100:103]
    ds_read_b128 a[212:215], v9 offset:16384
    v_cvt_pk_bf16_f32 v157, v214, v215
    v_mfma_f32_16x16x32_bf16 a[100:103], a[180:183], v[172:175], a[100:103]
    v_mfma_f32_16x16x32_bf16 v[212:215], a[224:227], v[80:83], v[196:199]
    v_exp_f32 v208, v208
    v_mfma_f32_16x16x32_bf16 v[212:215], a[228:231], v[84:87], v[212:215]
    s_sub_u32 s39, s39, 36864
    v_exp_f32 v209, v209
    v_mfma_f32_16x16x32_bf16 v[212:215], a[232:235], v[88:91], v[212:215]
    s_sub_u32 s38, s38, 4608
    v_exp_f32 v210, v210
    v_mfma_f32_16x16x32_bf16 v[212:215], a[236:239], v[92:95], v[212:215]
    v_exp_f32 v211, v211
    v_mfma_f32_16x16x32_bf16 a[104:107], a[176:179], v[176:179], a[104:107]
    ds_read_b64_tr_b16 a[160:161], v20 offset:0
    v_cvt_pk_bf16_f32 v134, v208, v209
    v_mfma_f32_16x16x32_bf16 a[104:107], a[180:183], v[180:183], a[104:107]
    ds_read_b64_tr_b16 a[162:163], v20 offset:4096
    v_mfma_f32_16x16x32_bf16 a[108:111], a[176:179], v[184:187], a[108:111]
    ds_read_b128 a[216:219], v10 offset:16384
    v_cvt_pk_bf16_f32 v135, v210, v211
    v_mfma_f32_16x16x32_bf16 a[108:111], a[180:183], v[188:191], a[108:111]
    s_waitcnt lgkmcnt(3)
    buffer_load_dwordx4 v37, s[8:11], s40 offen offset:1024 lds
    v_mfma_f32_16x16x32_bf16 v[208:211], a[224:227], v[96:99], v[200:203]
    v_exp_f32 v212, v212
    v_mfma_f32_16x16x32_bf16 v[208:211], a[228:231], v[100:103], v[208:211]
    v_exp_f32 v213, v213
    v_mfma_f32_16x16x32_bf16 v[208:211], a[232:235], v[104:107], v[208:211]
    v_exp_f32 v214, v214
    v_mfma_f32_16x16x32_bf16 v[208:211], a[236:239], v[108:111], v[208:211]
    v_exp_f32 v215, v215
    v_mfma_f32_16x16x32_bf16 a[112:115], a[184:187], v[160:163], a[112:115]
    ds_read_b64_tr_b16 a[164:165], v20 offset:8192
    v_cvt_pk_bf16_f32 v142, v212, v213
    v_mfma_f32_16x16x32_bf16 a[112:115], a[188:191], v[164:167], a[112:115]
    ds_read_b64_tr_b16 a[166:167], v20 offset:12288
    v_mfma_f32_16x16x32_bf16 a[116:119], a[184:187], v[168:171], a[116:119]
    ds_read_b128 a[220:223], v11 offset:16384
    v_cvt_pk_bf16_f32 v143, v214, v215
    v_mfma_f32_16x16x32_bf16 a[116:119], a[188:191], v[172:175], a[116:119]
    v_mfma_f32_16x16x32_bf16 v[212:215], a[224:227], v[112:115], v[204:207]
    v_exp_f32 v208, v208
    v_mfma_f32_16x16x32_bf16 v[212:215], a[228:231], v[116:119], v[212:215]
    v_exp_f32 v209, v209
    v_mfma_f32_16x16x32_bf16 v[212:215], a[232:235], v[120:123], v[212:215]
    v_exp_f32 v210, v210
    v_mfma_f32_16x16x32_bf16 v[212:215], a[236:239], v[124:127], v[212:215]
    v_exp_f32 v211, v211
    v_mfma_f32_16x16x32_bf16 a[120:123], a[184:187], v[176:179], a[120:123]
    ds_read_b64_tr_b16 a[168:169], v21 offset:0
    v_cvt_pk_bf16_f32 v150, v208, v209
    v_mfma_f32_16x16x32_bf16 a[120:123], a[188:191], v[180:183], a[120:123]
    ds_read_b64_tr_b16 a[170:171], v21 offset:4096
    v_mfma_f32_16x16x32_bf16 a[124:127], a[184:187], v[184:187], a[124:127]
    ds_read_b128 a[224:227], v8 offset:20480
    v_cvt_pk_bf16_f32 v151, v210, v211
    v_mfma_f32_16x16x32_bf16 a[124:127], a[188:191], v[188:191], a[124:127]
    s_waitcnt lgkmcnt(3)
    buffer_load_dwordx4 v38, s[8:11], s40 offen offset:2048 lds
    s_sub_u32 s43, s43, 1
    s_cmp_lg_u32 s43, 0
    s_cbranch_scc1 Lattn_loop
    v_mfma_f32_16x16x32_bf16 v[208:211], a[208:211], v[64:67], v[192:195]
    v_exp_f32 v212, v212
    v_mfma_f32_16x16x32_bf16 v[208:211], a[212:215], v[68:71], v[208:211]
    v_exp_f32 v213, v213
    v_mfma_f32_16x16x32_bf16 v[208:211], a[216:219], v[72:75], v[208:211]
    v_exp_f32 v214, v214
    v_mfma_f32_16x16x32_bf16 v[208:211], a[220:223], v[76:79], v[208:211]
    v_exp_f32 v215, v215
    v_mfma_f32_16x16x32_bf16 a[0:3], a[160:163], v[128:131], a[0:3]
    ds_read_b64_tr_b16 a[172:173], v21 offset:8192
    v_cvt_pk_bf16_f32 v158, v212, v213
    v_mfma_f32_16x16x32_bf16 a[0:3], a[164:167], v[132:135], a[0:3]
    ds_read_b64_tr_b16 a[174:175], v21 offset:12288
    v_mfma_f32_16x16x32_bf16 a[4:7], a[160:163], v[136:139], a[4:7]
    ds_read_b128 a[228:231], v9 offset:20480
    v_cvt_pk_bf16_f32 v159, v214, v215
    v_mfma_f32_16x16x32_bf16 a[4:7], a[164:167], v[140:143], a[4:7]
    v_mfma_f32_16x16x32_bf16 v[212:215], a[208:211], v[80:83], v[196:199]
    v_exp_f32 v208, v208
    v_mfma_f32_16x16x32_bf16 v[212:215], a[212:215], v[84:87], v[212:215]
    v_exp_f32 v209, v209
    v_mfma_f32_16x16x32_bf16 v[212:215], a[216:219], v[88:91], v[212:215]
    v_exp_f32 v210, v210
    v_mfma_f32_16x16x32_bf16 v[212:215], a[220:223], v[92:95], v[212:215]
    v_exp_f32 v211, v211
    v_mfma_f32_16x16x32_bf16 a[8:11], a[160:163], v[144:147], a[8:11]
    ds_read_b64_tr_b16 a[176:177], v22 offset:0
    v_cvt_pk_bf16_f32 v160, v208, v209
    v_mfma_f32_16x16x32_bf16 a[8:11], a[164:167], v[148:151], a[8:11]
    ds_read_b64_tr_b16 a[178:179], v22 offset:4096
    v_mfma_f32_16x16x32_bf16 a[12:15], a[160:163], v[152:155], a[12:15]
    ds_read_b128 a[232:235], v10 offset:20480
    v_cvt_pk_bf16_f32 v161, v210, v211
    v_mfma_f32_16x16x32_bf16 a[12:15], a[164:167], v[156:159], a[12:15]
    s_waitcnt lgkmcnt(3)
    buffer_load_dwordx4 v39, s[8:11], s40 offen offset:3072 lds
    v_mfma_f32_16x16x32_bf16 v[208:211], a[208:211], v[96:99], v[200:203]
    v_exp_f32 v212, v212
    v_mfma_f32_16x16x32_bf16 v[208:211], a[212:215], v[100:103], v[208:211]
    s_add_u32 s40, s40, 16384
    v_exp_f32 v213, v213
    v_mfma_f32_16x16x32_bf16 v[208:211], a[216:219], v[104:107], v[208:211]
    v_exp_f32 v214, v214
    v_mfma_f32_16x16x32_bf16 v[208:211], a[220:223], v[108:111], v[208:211]
    v_exp_f32 v215, v215
    v_mfma_f32_16x16x32_bf16 a[16:19], a[168:171], v[128:131], a[16:19]
    ds_read_b64_tr_b16 a[180:181], v22 offset:8192
    v_cvt_pk_bf16_f32 v168, v212, v213
    v_mfma_f32_16x16x32_bf16 a[16:19], a[172:175], v[132:135], a[16:19]
    ds_read_b64_tr_b16 a[182:183], v22 offset:12288
    v_mfma_f32_16x16x32_bf16 a[20:23], a[168:171], v[136:139], a[20:23]
    ds_read_b128 a[236:239], v11 offset:20480
    v_cvt_pk_bf16_f32 v169, v214, v215
    v_mfma_f32_16x16x32_bf16 a[20:23], a[172:175], v[140:143], a[20:23]
    v_smfmac_f32_16x16x64_bf16 a[192:195], v[52:55], v[128:135], v50
    v_mfma_f32_16x16x32_bf16 v[212:215], a[208:211], v[112:115], v[204:207]
    v_exp_f32 v208, v208
    v_mfma_f32_16x16x32_bf16 v[212:215], a[212:215], v[116:119], v[212:215]
    s_add_u32 m0, s42, 98304
    v_exp_f32 v209, v209
    v_mfma_f32_16x16x32_bf16 v[212:215], a[216:219], v[120:123], v[212:215]
    v_exp_f32 v210, v210
    v_mfma_f32_16x16x32_bf16 v[212:215], a[220:223], v[124:127], v[212:215]
    v_exp_f32 v211, v211
    v_mfma_f32_16x16x32_bf16 a[24:27], a[168:171], v[144:147], a[24:27]
    ds_read_b64_tr_b16 a[184:185], v23 offset:0
    v_cvt_pk_bf16_f32 v176, v208, v209
    v_mfma_f32_16x16x32_bf16 a[24:27], a[172:175], v[148:151], a[24:27]
    ds_read_b64_tr_b16 a[186:187], v23 offset:4096
    v_mfma_f32_16x16x32_bf16 a[28:31], a[168:171], v[152:155], a[28:31]
    ds_read_b128 a[208:211], v8 offset:24576
    v_cvt_pk_bf16_f32 v177, v210, v211
    v_mfma_f32_16x16x32_bf16 a[28:31], a[172:175], v[156:159], a[28:31]
    s_waitcnt lgkmcnt(3)
    buffer_load_dwordx4 v40, s[12:15], s41 offen lds
    v_mfma_f32_16x16x32_bf16 v[208:211], a[224:227], v[64:67], v[192:195]
    v_exp_f32 v212, v212
    v_mfma_f32_16x16x32_bf16 v[208:211], a[228:231], v[68:71], v[208:211]
    v_exp_f32 v213, v213
    v_mfma_f32_16x16x32_bf16 v[208:211], a[232:235], v[72:75], v[208:211]
    v_exp_f32 v214, v214
    v_mfma_f32_16x16x32_bf16 v[208:211], a[236:239], v[76:79], v[208:211]
    v_exp_f32 v215, v215
    v_mfma_f32_16x16x32_bf16 a[32:35], a[176:179], v[128:131], a[32:35]
    ds_read_b64_tr_b16 a[188:189], v23 offset:8192
    v_cvt_pk_bf16_f32 v184, v212, v213
    v_mfma_f32_16x16x32_bf16 a[32:35], a[180:183], v[132:135], a[32:35]
    ds_read_b64_tr_b16 a[190:191], v23 offset:12288
    v_mfma_f32_16x16x32_bf16 a[36:39], a[176:179], v[136:139], a[36:39]
    ds_read_b128 a[212:215], v9 offset:24576
    v_cvt_pk_bf16_f32 v185, v214, v215
    v_mfma_f32_16x16x32_bf16 a[36:39], a[180:183], v[140:143], a[36:39]
    v_smfmac_f32_16x16x64_bf16 a[196:199], v[52:55], v[136:143], v50
    v_mfma_f32_16x16x32_bf16 v[212:215], a[224:227], v[80:83], v[196:199]
    v_exp_f32 v208, v208
    v_mfma_f32_16x16x32_bf16 v[212:215], a[228:231], v[84:87], v[212:215]
    v_exp_f32 v209, v209
    v_mfma_f32_16x16x32_bf16 v[212:215], a[232:235], v[88:91], v[212:215]
    v_exp_f32 v210, v210
    v_mfma_f32_16x16x32_bf16 v[212:215], a[236:239], v[92:95], v[212:215]
    v_exp_f32 v211, v211
    v_mfma_f32_16x16x32_bf16 a[40:43], a[176:179], v[144:147], a[40:43]
    ds_read_b64_tr_b16 a[160:161], v24 offset:0
    v_cvt_pk_bf16_f32 v162, v208, v209
    v_mfma_f32_16x16x32_bf16 a[40:43], a[180:183], v[148:151], a[40:43]
    ds_read_b64_tr_b16 a[162:163], v24 offset:4096
    v_mfma_f32_16x16x32_bf16 a[44:47], a[176:179], v[152:155], a[44:47]
    ds_read_b128 a[216:219], v10 offset:24576
    v_cvt_pk_bf16_f32 v163, v210, v211
    v_mfma_f32_16x16x32_bf16 a[44:47], a[180:183], v[156:159], a[44:47]
    s_waitcnt lgkmcnt(3)
    buffer_load_dwordx4 v41, s[12:15], s41 offen offset:1024 lds
    v_mfma_f32_16x16x32_bf16 v[208:211], a[224:227], v[96:99], v[200:203]
    v_exp_f32 v212, v212
    v_mfma_f32_16x16x32_bf16 v[208:211], a[228:231], v[100:103], v[208:211]
    v_exp_f32 v213, v213
    v_mfma_f32_16x16x32_bf16 v[208:211], a[232:235], v[104:107], v[208:211]
    v_exp_f32 v214, v214
    v_mfma_f32_16x16x32_bf16 v[208:211], a[236:239], v[108:111], v[208:211]
    v_exp_f32 v215, v215
    v_mfma_f32_16x16x32_bf16 a[48:51], a[184:187], v[128:131], a[48:51]
    ds_read_b64_tr_b16 a[164:165], v24 offset:8192
    v_cvt_pk_bf16_f32 v170, v212, v213
    v_mfma_f32_16x16x32_bf16 a[48:51], a[188:191], v[132:135], a[48:51]
    ds_read_b64_tr_b16 a[166:167], v24 offset:12288
    v_mfma_f32_16x16x32_bf16 a[52:55], a[184:187], v[136:139], a[52:55]
    ds_read_b128 a[220:223], v11 offset:24576
    v_cvt_pk_bf16_f32 v171, v214, v215
    v_mfma_f32_16x16x32_bf16 a[52:55], a[188:191], v[140:143], a[52:55]
    v_smfmac_f32_16x16x64_bf16 a[200:203], v[52:55], v[144:151], v50
    v_mfma_f32_16x16x32_bf16 v[212:215], a[224:227], v[112:115], v[204:207]
    v_exp_f32 v208, v208
    v_mfma_f32_16x16x32_bf16 v[212:215], a[228:231], v[116:119], v[212:215]
    v_exp_f32 v209, v209
    v_mfma_f32_16x16x32_bf16 v[212:215], a[232:235], v[120:123], v[212:215]
    v_exp_f32 v210, v210
    v_mfma_f32_16x16x32_bf16 v[212:215], a[236:239], v[124:127], v[212:215]
    v_exp_f32 v211, v211
    v_mfma_f32_16x16x32_bf16 a[56:59], a[184:187], v[144:147], a[56:59]
    ds_read_b64_tr_b16 a[168:169], v25 offset:0
    v_cvt_pk_bf16_f32 v178, v208, v209
    v_mfma_f32_16x16x32_bf16 a[56:59], a[188:191], v[148:151], a[56:59]
    ds_read_b64_tr_b16 a[170:171], v25 offset:4096
    v_mfma_f32_16x16x32_bf16 a[60:63], a[184:187], v[152:155], a[60:63]
    ds_read_b128 a[224:227], v8 offset:28672
    v_cvt_pk_bf16_f32 v179, v210, v211
    v_mfma_f32_16x16x32_bf16 a[60:63], a[188:191], v[156:159], a[60:63]
    s_waitcnt lgkmcnt(3)
    buffer_load_dwordx4 v40, s[12:15], s41 offen offset:2048 lds
    v_mfma_f32_16x16x32_bf16 v[208:211], a[208:211], v[64:67], v[192:195]
    v_exp_f32 v212, v212
    v_mfma_f32_16x16x32_bf16 v[208:211], a[212:215], v[68:71], v[208:211]
    v_exp_f32 v213, v213
    v_mfma_f32_16x16x32_bf16 v[208:211], a[216:219], v[72:75], v[208:211]
    v_exp_f32 v214, v214
    v_mfma_f32_16x16x32_bf16 v[208:211], a[220:223], v[76:79], v[208:211]
    v_exp_f32 v215, v215
    v_mfma_f32_16x16x32_bf16 a[64:67], a[160:163], v[128:131], a[64:67]
    ds_read_b64_tr_b16 a[172:173], v25 offset:8192
    v_cvt_pk_bf16_f32 v186, v212, v213
    v_mfma_f32_16x16x32_bf16 a[64:67], a[164:167], v[132:135], a[64:67]
    ds_read_b64_tr_b16 a[174:175], v25 offset:12288
    v_mfma_f32_16x16x32_bf16 a[68:71], a[160:163], v[136:139], a[68:71]
    ds_read_b128 a[228:231], v9 offset:28672
    v_cvt_pk_bf16_f32 v187, v214, v215
    v_mfma_f32_16x16x32_bf16 a[68:71], a[164:167], v[140:143], a[68:71]
    v_smfmac_f32_16x16x64_bf16 a[204:207], v[52:55], v[152:159], v50
    v_mfma_f32_16x16x32_bf16 v[212:215], a[208:211], v[80:83], v[196:199]
    v_exp_f32 v208, v208
    v_mfma_f32_16x16x32_bf16 v[212:215], a[212:215], v[84:87], v[212:215]
    v_exp_f32 v209, v209
    v_mfma_f32_16x16x32_bf16 v[212:215], a[216:219], v[88:91], v[212:215]
    v_exp_f32 v210, v210
    v_mfma_f32_16x16x32_bf16 v[212:215], a[220:223], v[92:95], v[212:215]
    v_exp_f32 v211, v211
    v_mfma_f32_16x16x32_bf16 a[72:75], a[160:163], v[144:147], a[72:75]
    ds_read_b64_tr_b16 a[176:177], v26 offset:0
    v_cvt_pk_bf16_f32 v164, v208, v209
    v_mfma_f32_16x16x32_bf16 a[72:75], a[164:167], v[148:151], a[72:75]
    ds_read_b64_tr_b16 a[178:179], v26 offset:4096
    v_mfma_f32_16x16x32_bf16 a[76:79], a[160:163], v[152:155], a[76:79]
    ds_read_b128 a[232:235], v10 offset:28672
    v_cvt_pk_bf16_f32 v165, v210, v211
    v_mfma_f32_16x16x32_bf16 a[76:79], a[164:167], v[156:159], a[76:79]
    s_waitcnt lgkmcnt(3)
    buffer_load_dwordx4 v41, s[12:15], s41 offen offset:3072 lds
    v_mfma_f32_16x16x32_bf16 v[208:211], a[208:211], v[96:99], v[200:203]
    v_exp_f32 v212, v212
    v_mfma_f32_16x16x32_bf16 v[208:211], a[212:215], v[100:103], v[208:211]
    s_add_u32 s41, s41, 16384
    v_exp_f32 v213, v213
    v_mfma_f32_16x16x32_bf16 v[208:211], a[216:219], v[104:107], v[208:211]
    v_exp_f32 v214, v214
    v_mfma_f32_16x16x32_bf16 v[208:211], a[220:223], v[108:111], v[208:211]
    v_exp_f32 v215, v215
    v_mfma_f32_16x16x32_bf16 a[80:83], a[168:171], v[128:131], a[80:83]
    ds_read_b64_tr_b16 a[180:181], v26 offset:8192
    v_cvt_pk_bf16_f32 v172, v212, v213
    v_mfma_f32_16x16x32_bf16 a[80:83], a[172:175], v[132:135], a[80:83]
    ds_read_b64_tr_b16 a[182:183], v26 offset:12288
    v_mfma_f32_16x16x32_bf16 a[84:87], a[168:171], v[136:139], a[84:87]
    ds_read_b128 a[236:239], v11 offset:28672
    v_cvt_pk_bf16_f32 v173, v214, v215
    v_mfma_f32_16x16x32_bf16 a[84:87], a[172:175], v[140:143], a[84:87]
    s_waitcnt vmcnt(8)
    s_barrier
    v_mfma_f32_16x16x32_bf16 v[212:215], a[208:211], v[112:115], v[204:207]
    v_exp_f32 v208, v208
    v_mfma_f32_16x16x32_bf16 v[212:215], a[212:215], v[116:119], v[212:215]
    s_add_u32 s49, s45, 0
    v_exp_f32 v209, v209
    v_mfma_f32_16x16x32_bf16 v[212:215], a[216:219], v[120:123], v[212:215]
    s_add_u32 m0, s42, 131072
    v_exp_f32 v210, v210
    v_mfma_f32_16x16x32_bf16 v[212:215], a[220:223], v[124:127], v[212:215]
    v_exp_f32 v211, v211
    v_mfma_f32_16x16x32_bf16 a[88:91], a[168:171], v[144:147], a[88:91]
    ds_read_b64_tr_b16 a[184:185], v27 offset:0
    v_cvt_pk_bf16_f32 v180, v208, v209
    v_mfma_f32_16x16x32_bf16 a[88:91], a[172:175], v[148:151], a[88:91]
    ds_read_b64_tr_b16 a[186:187], v27 offset:4096
    v_mfma_f32_16x16x32_bf16 a[92:95], a[168:171], v[152:155], a[92:95]
    ds_read_b128 a[208:211], v8 offset:32768
    v_cvt_pk_bf16_f32 v181, v210, v211
    v_mfma_f32_16x16x32_bf16 a[92:95], a[172:175], v[156:159], a[92:95]
    s_waitcnt lgkmcnt(3)
    buffer_load_dwordx4 v46, s[20:23], s49 offen lds
    v_mfma_f32_16x16x32_bf16 v[208:211], a[224:227], v[64:67], v[192:195]
    v_exp_f32 v212, v212
    v_mfma_f32_16x16x32_bf16 v[208:211], a[228:231], v[68:71], v[208:211]
    v_exp_f32 v213, v213
    v_mfma_f32_16x16x32_bf16 v[208:211], a[232:235], v[72:75], v[208:211]
    v_exp_f32 v214, v214
    v_mfma_f32_16x16x32_bf16 v[208:211], a[236:239], v[76:79], v[208:211]
    v_exp_f32 v215, v215
    v_mfma_f32_16x16x32_bf16 a[96:99], a[176:179], v[128:131], a[96:99]
    ds_read_b64_tr_b16 a[188:189], v27 offset:8192
    v_cvt_pk_bf16_f32 v188, v212, v213
    v_mfma_f32_16x16x32_bf16 a[96:99], a[180:183], v[132:135], a[96:99]
    ds_read_b64_tr_b16 a[190:191], v27 offset:12288
    v_mfma_f32_16x16x32_bf16 a[100:103], a[176:179], v[136:139], a[100:103]
    ds_read_b128 a[212:215], v9 offset:32768
    v_cvt_pk_bf16_f32 v189, v214, v215
    v_mfma_f32_16x16x32_bf16 a[100:103], a[180:183], v[140:143], a[100:103]
    v_mfma_f32_16x16x32_bf16 v[212:215], a[224:227], v[80:83], v[196:199]
    v_exp_f32 v208, v208
    v_mfma_f32_16x16x32_bf16 v[212:215], a[228:231], v[84:87], v[212:215]
    v_exp_f32 v209, v209
    v_mfma_f32_16x16x32_bf16 v[212:215], a[232:235], v[88:91], v[212:215]
    v_exp_f32 v210, v210
    v_mfma_f32_16x16x32_bf16 v[212:215], a[236:239], v[92:95], v[212:215]
    v_exp_f32 v211, v211
    v_mfma_f32_16x16x32_bf16 a[104:107], a[176:179], v[144:147], a[104:107]
    ds_read_b64_tr_b16 a[160:161], v20 offset:16384
    v_cvt_pk_bf16_f32 v166, v208, v209
    v_mfma_f32_16x16x32_bf16 a[104:107], a[180:183], v[148:151], a[104:107]
    ds_read_b64_tr_b16 a[162:163], v20 offset:20480
    v_mfma_f32_16x16x32_bf16 a[108:111], a[176:179], v[152:155], a[108:111]
    ds_read_b128 a[216:219], v10 offset:32768
    v_cvt_pk_bf16_f32 v167, v210, v211
    v_mfma_f32_16x16x32_bf16 a[108:111], a[180:183], v[156:159], a[108:111]
    s_waitcnt lgkmcnt(3)
    buffer_load_dwordx4 v47, s[20:23], s49 offen offset:1024 lds
    v_mfma_f32_16x16x32_bf16 v[208:211], a[224:227], v[96:99], v[200:203]
    v_exp_f32 v212, v212
    v_mfma_f32_16x16x32_bf16 v[208:211], a[228:231], v[100:103], v[208:211]
    v_exp_f32 v213, v213
    v_mfma_f32_16x16x32_bf16 v[208:211], a[232:235], v[104:107], v[208:211]
    v_exp_f32 v214, v214
    v_mfma_f32_16x16x32_bf16 v[208:211], a[236:239], v[108:111], v[208:211]
    v_exp_f32 v215, v215
    v_mfma_f32_16x16x32_bf16 a[112:115], a[184:187], v[128:131], a[112:115]
    ds_read_b64_tr_b16 a[164:165], v20 offset:24576
    v_cvt_pk_bf16_f32 v174, v212, v213
    v_mfma_f32_16x16x32_bf16 a[112:115], a[188:191], v[132:135], a[112:115]
    ds_read_b64_tr_b16 a[166:167], v20 offset:28672
    v_mfma_f32_16x16x32_bf16 a[116:119], a[184:187], v[136:139], a[116:119]
    ds_read_b128 a[220:223], v11 offset:32768
    v_cvt_pk_bf16_f32 v175, v214, v215
    v_mfma_f32_16x16x32_bf16 a[116:119], a[188:191], v[140:143], a[116:119]
    v_mfma_f32_16x16x32_bf16 v[212:215], a[224:227], v[112:115], v[204:207]
    v_exp_f32 v208, v208
    v_mfma_f32_16x16x32_bf16 v[212:215], a[228:231], v[116:119], v[212:215]
    v_exp_f32 v209, v209
    v_mfma_f32_16x16x32_bf16 v[212:215], a[232:235], v[120:123], v[212:215]
    v_exp_f32 v210, v210
    v_mfma_f32_16x16x32_bf16 v[212:215], a[236:239], v[124:127], v[212:215]
    v_exp_f32 v211, v211
    v_mfma_f32_16x16x32_bf16 a[120:123], a[184:187], v[144:147], a[120:123]
    ds_read_b64_tr_b16 a[168:169], v21 offset:16384
    v_cvt_pk_bf16_f32 v182, v208, v209
    v_mfma_f32_16x16x32_bf16 a[120:123], a[188:191], v[148:151], a[120:123]
    ds_read_b64_tr_b16 a[170:171], v21 offset:20480
    v_mfma_f32_16x16x32_bf16 a[124:127], a[184:187], v[152:155], a[124:127]
    ds_read_b128 a[224:227], v8 offset:36864
    v_cvt_pk_bf16_f32 v183, v210, v211
    v_mfma_f32_16x16x32_bf16 a[124:127], a[188:191], v[156:159], a[124:127]
    s_waitcnt lgkmcnt(3)
    buffer_load_dwordx4 v48, s[20:23], s49 offen offset:2048 lds
    v_mfma_f32_16x16x32_bf16 v[208:211], a[208:211], v[64:67], v[192:195]
    v_exp_f32 v212, v212
    v_mfma_f32_16x16x32_bf16 v[208:211], a[212:215], v[68:71], v[208:211]
    v_exp_f32 v213, v213
    v_mfma_f32_16x16x32_bf16 v[208:211], a[216:219], v[72:75], v[208:211]
    v_exp_f32 v214, v214
    v_mfma_f32_16x16x32_bf16 v[208:211], a[220:223], v[76:79], v[208:211]
    v_exp_f32 v215, v215
    v_mfma_f32_16x16x32_bf16 a[0:3], a[160:163], v[160:163], a[0:3]
    ds_read_b64_tr_b16 a[172:173], v21 offset:24576
    v_cvt_pk_bf16_f32 v190, v212, v213
    v_mfma_f32_16x16x32_bf16 a[0:3], a[164:167], v[164:167], a[0:3]
    ds_read_b64_tr_b16 a[174:175], v21 offset:28672
    v_mfma_f32_16x16x32_bf16 a[4:7], a[160:163], v[168:171], a[4:7]
    ds_read_b128 a[228:231], v9 offset:36864
    v_cvt_pk_bf16_f32 v191, v214, v215
    v_mfma_f32_16x16x32_bf16 a[4:7], a[164:167], v[172:175], a[4:7]
    v_mov_b32 v63, 0
    v_mfma_f32_16x16x32_bf16 v[212:215], a[208:211], v[80:83], v[196:199]
    v_exp_f32 v208, v208
    v_mfma_f32_16x16x32_bf16 v[212:215], a[212:215], v[84:87], v[212:215]
    v_exp_f32 v209, v209
    v_mfma_f32_16x16x32_bf16 v[212:215], a[216:219], v[88:91], v[212:215]
    v_exp_f32 v210, v210
    v_mfma_f32_16x16x32_bf16 v[212:215], a[220:223], v[92:95], v[212:215]
    v_exp_f32 v211, v211
    v_mfma_f32_16x16x32_bf16 a[8:11], a[160:163], v[176:179], a[8:11]
    ds_read_b64_tr_b16 a[176:177], v22 offset:16384
    v_cvt_pk_bf16_f32 v128, v208, v209
    v_mfma_f32_16x16x32_bf16 a[8:11], a[164:167], v[180:183], a[8:11]
    ds_read_b64_tr_b16 a[178:179], v22 offset:20480
    v_mfma_f32_16x16x32_bf16 a[12:15], a[160:163], v[184:187], a[12:15]
    ds_read_b128 a[232:235], v10 offset:36864
    v_cvt_pk_bf16_f32 v129, v210, v211
    v_mfma_f32_16x16x32_bf16 a[12:15], a[164:167], v[188:191], a[12:15]
    s_waitcnt lgkmcnt(3)
    buffer_load_dwordx4 v49, s[20:23], s49 offen offset:3072 lds
    v_mfma_f32_16x16x32_bf16 v[208:211], a[208:211], v[96:99], v[200:203]
    v_exp_f32 v212, v212
    v_mfma_f32_16x16x32_bf16 v[208:211], a[212:215], v[100:103], v[208:211]
    v_exp_f32 v213, v213
    v_mfma_f32_16x16x32_bf16 v[208:211], a[216:219], v[104:107], v[208:211]
    v_exp_f32 v214, v214
    v_mfma_f32_16x16x32_bf16 v[208:211], a[220:223], v[108:111], v[208:211]
    v_exp_f32 v215, v215
    v_mfma_f32_16x16x32_bf16 a[16:19], a[168:171], v[160:163], a[16:19]
    ds_read_b64_tr_b16 a[180:181], v22 offset:24576
    v_cvt_pk_bf16_f32 v136, v212, v213
    v_mfma_f32_16x16x32_bf16 a[16:19], a[172:175], v[164:167], a[16:19]
    ds_read_b64_tr_b16 a[182:183], v22 offset:28672
    v_mfma_f32_16x16x32_bf16 a[20:23], a[168:171], v[168:171], a[20:23]
    ds_read_b128 a[236:239], v11 offset:36864
    v_cvt_pk_bf16_f32 v137, v214, v215
    v_mfma_f32_16x16x32_bf16 a[20:23], a[172:175], v[172:175], a[20:23]
    v_smfmac_f32_16x16x64_bf16 a[192:195], v[52:55], v[160:167], v50
    v_mfma_f32_16x16x32_bf16 v[212:215], a[208:211], v[112:115], v[204:207]
    v_exp_f32 v208, v208
    v_mfma_f32_16x16x32_bf16 v[212:215], a[212:215], v[116:119], v[212:215]
    s_add_u32 m0, s42, 114688
    v_exp_f32 v209, v209
    v_mfma_f32_16x16x32_bf16 v[212:215], a[216:219], v[120:123], v[212:215]
    v_exp_f32 v210, v210
    v_mfma_f32_16x16x32_bf16 v[212:215], a[220:223], v[124:127], v[212:215]
    v_exp_f32 v211, v211
    v_mfma_f32_16x16x32_bf16 a[24:27], a[168:171], v[176:179], a[24:27]
    ds_read_b64_tr_b16 a[184:185], v23 offset:16384
    v_cvt_pk_bf16_f32 v144, v208, v209
    v_mfma_f32_16x16x32_bf16 a[24:27], a[172:175], v[180:183], a[24:27]
    ds_read_b64_tr_b16 a[186:187], v23 offset:20480
    v_mfma_f32_16x16x32_bf16 a[28:31], a[168:171], v[184:187], a[28:31]
    ds_read_b128 a[208:211], v8 offset:40960
    v_cvt_pk_bf16_f32 v145, v210, v211
    v_mfma_f32_16x16x32_bf16 a[28:31], a[172:175], v[188:191], a[28:31]
    s_waitcnt lgkmcnt(3)
    buffer_load_dwordx4 v40, s[12:15], s41 offen lds
    v_mfma_f32_16x16x32_bf16 v[208:211], a[224:227], v[64:67], v[192:195]
    v_exp_f32 v212, v212
    v_mfma_f32_16x16x32_bf16 v[208:211], a[228:231], v[68:71], v[208:211]
    v_exp_f32 v213, v213
    v_mfma_f32_16x16x32_bf16 v[208:211], a[232:235], v[72:75], v[208:211]
    v_exp_f32 v214, v214
    v_mfma_f32_16x16x32_bf16 v[208:211], a[236:239], v[76:79], v[208:211]
    v_exp_f32 v215, v215
    v_mfma_f32_16x16x32_bf16 a[32:35], a[176:179], v[160:163], a[32:35]
    ds_read_b64_tr_b16 a[188:189], v23 offset:24576
    v_cvt_pk_bf16_f32 v152, v212, v213
    v_mfma_f32_16x16x32_bf16 a[32:35], a[180:183], v[164:167], a[32:35]
    ds_read_b64_tr_b16 a[190:191], v23 offset:28672
    v_mfma_f32_16x16x32_bf16 a[36:39], a[176:179], v[168:171], a[36:39]
    ds_read_b128 a[212:215], v9 offset:40960
    v_cvt_pk_bf16_f32 v153, v214, v215
    v_mfma_f32_16x16x32_bf16 a[36:39], a[180:183], v[172:175], a[36:39]
    v_smfmac_f32_16x16x64_bf16 a[196:199], v[52:55], v[168:175], v50
    v_mfma_f32_16x16x32_bf16 v[212:215], a[224:227], v[80:83], v[196:199]
    v_exp_f32 v208, v208
    v_mfma_f32_16x16x32_bf16 v[212:215], a[228:231], v[84:87], v[212:215]
    v_exp_f32 v209, v209
    v_mfma_f32_16x16x32_bf16 v[212:215], a[232:235], v[88:91], v[212:215]
    v_exp_f32 v210, v210
    v_mfma_f32_16x16x32_bf16 v[212:215], a[236:239], v[92:95], v[212:215]
    v_exp_f32 v211, v211
    v_mfma_f32_16x16x32_bf16 a[40:43], a[176:179], v[176:179], a[40:43]
    ds_read_b64_tr_b16 a[160:161], v24 offset:16384
    v_cvt_pk_bf16_f32 v130, v208, v209
    v_mfma_f32_16x16x32_bf16 a[40:43], a[180:183], v[180:183], a[40:43]
    ds_read_b64_tr_b16 a[162:163], v24 offset:20480
    v_mfma_f32_16x16x32_bf16 a[44:47], a[176:179], v[184:187], a[44:47]
    ds_read_b128 a[216:219], v10 offset:40960
    v_cvt_pk_bf16_f32 v131, v210, v211
    v_mfma_f32_16x16x32_bf16 a[44:47], a[180:183], v[188:191], a[44:47]
    s_waitcnt lgkmcnt(3)
    buffer_load_dwordx4 v41, s[12:15], s41 offen offset:1024 lds
    v_mfma_f32_16x16x32_bf16 v[208:211], a[224:227], v[96:99], v[200:203]
    v_exp_f32 v212, v212
    v_mfma_f32_16x16x32_bf16 v[208:211], a[228:231], v[100:103], v[208:211]
    v_exp_f32 v213, v213
    v_mfma_f32_16x16x32_bf16 v[208:211], a[232:235], v[104:107], v[208:211]
    v_exp_f32 v214, v214
    v_mfma_f32_16x16x32_bf16 v[208:211], a[236:239], v[108:111], v[208:211]
    v_exp_f32 v215, v215
    v_mfma_f32_16x16x32_bf16 a[48:51], a[184:187], v[160:163], a[48:51]
    ds_read_b64_tr_b16 a[164:165], v24 offset:24576
    v_cvt_pk_bf16_f32 v138, v212, v213
    v_mfma_f32_16x16x32_bf16 a[48:51], a[188:191], v[164:167], a[48:51]
    ds_read_b64_tr_b16 a[166:167], v24 offset:28672
    v_mfma_f32_16x16x32_bf16 a[52:55], a[184:187], v[168:171], a[52:55]
    ds_read_b128 a[220:223], v11 offset:40960
    v_cvt_pk_bf16_f32 v139, v214, v215
    v_mfma_f32_16x16x32_bf16 a[52:55], a[188:191], v[172:175], a[52:55]
    v_smfmac_f32_16x16x64_bf16 a[200:203], v[52:55], v[176:183], v50
    v_mfma_f32_16x16x32_bf16 v[212:215], a[224:227], v[112:115], v[204:207]
    v_exp_f32 v208, v208
    v_mfma_f32_16x16x32_bf16 v[212:215], a[228:231], v[116:119], v[212:215]
    v_exp_f32 v209, v209
    v_mfma_f32_16x16x32_bf16 v[212:215], a[232:235], v[120:123], v[212:215]
    v_exp_f32 v210, v210
    v_mfma_f32_16x16x32_bf16 v[212:215], a[236:239], v[124:127], v[212:215]
    v_exp_f32 v211, v211
    v_mfma_f32_16x16x32_bf16 a[56:59], a[184:187], v[176:179], a[56:59]
    ds_read_b64_tr_b16 a[168:169], v25 offset:16384
    v_cvt_pk_bf16_f32 v146, v208, v209
    v_mfma_f32_16x16x32_bf16 a[56:59], a[188:191], v[180:183], a[56:59]
    ds_read_b64_tr_b16 a[170:171], v25 offset:20480
    v_mfma_f32_16x16x32_bf16 a[60:63], a[184:187], v[184:187], a[60:63]
    ds_read_b128 a[224:227], v8 offset:45056
    v_cvt_pk_bf16_f32 v147, v210, v211
    v_mfma_f32_16x16x32_bf16 a[60:63], a[188:191], v[188:191], a[60:63]
    s_waitcnt lgkmcnt(3)
    buffer_load_dwordx4 v40, s[12:15], s41 offen offset:2048 lds
    v_mfma_f32_16x16x32_bf16 v[208:211], a[208:211], v[64:67], v[192:195]
    v_exp_f32 v212, v212
    v_mfma_f32_16x16x32_bf16 v[208:211], a[212:215], v[68:71], v[208:211]
    v_exp_f32 v213, v213
    v_mfma_f32_16x16x32_bf16 v[208:211], a[216:219], v[72:75], v[208:211]
    v_exp_f32 v214, v214
    v_mfma_f32_16x16x32_bf16 v[208:211], a[220:223], v[76:79], v[208:211]
    v_exp_f32 v215, v215
    v_mfma_f32_16x16x32_bf16 a[64:67], a[160:163], v[160:163], a[64:67]
    ds_read_b64_tr_b16 a[172:173], v25 offset:24576
    v_cvt_pk_bf16_f32 v154, v212, v213
    v_mfma_f32_16x16x32_bf16 a[64:67], a[164:167], v[164:167], a[64:67]
    ds_read_b64_tr_b16 a[174:175], v25 offset:28672
    v_mfma_f32_16x16x32_bf16 a[68:71], a[160:163], v[168:171], a[68:71]
    ds_read_b128 a[228:231], v9 offset:45056
    v_cvt_pk_bf16_f32 v155, v214, v215
    v_mfma_f32_16x16x32_bf16 a[68:71], a[164:167], v[172:175], a[68:71]
    v_smfmac_f32_16x16x64_bf16 a[204:207], v[52:55], v[184:191], v50
    v_mfma_f32_16x16x32_bf16 v[212:215], a[208:211], v[80:83], v[196:199]
    v_exp_f32 v208, v208
    v_mfma_f32_16x16x32_bf16 v[212:215], a[212:215], v[84:87], v[212:215]
    v_exp_f32 v209, v209
    v_mfma_f32_16x16x32_bf16 v[212:215], a[216:219], v[88:91], v[212:215]
    v_exp_f32 v210, v210
    v_mfma_f32_16x16x32_bf16 v[212:215], a[220:223], v[92:95], v[212:215]
    v_exp_f32 v211, v211
    v_mfma_f32_16x16x32_bf16 a[72:75], a[160:163], v[176:179], a[72:75]
    ds_read_b64_tr_b16 a[176:177], v26 offset:16384
    v_cvt_pk_bf16_f32 v132, v208, v209
    v_mfma_f32_16x16x32_bf16 a[72:75], a[164:167], v[180:183], a[72:75]
    ds_read_b64_tr_b16 a[178:179], v26 offset:20480
    v_mfma_f32_16x16x32_bf16 a[76:79], a[160:163], v[184:187], a[76:79]
    ds_read_b128 a[232:235], v10 offset:45056
    v_cvt_pk_bf16_f32 v133, v210, v211
    v_mfma_f32_16x16x32_bf16 a[76:79], a[164:167], v[188:191], a[76:79]
    s_waitcnt lgkmcnt(3)
    buffer_load_dwordx4 v41, s[12:15], s41 offen offset:3072 lds
    v_mfma_f32_16x16x32_bf16 v[208:211], a[208:211], v[96:99], v[200:203]
    v_exp_f32 v212, v212
    v_mfma_f32_16x16x32_bf16 v[208:211], a[212:215], v[100:103], v[208:211]
    s_add_u32 s41, s41, 16384
    v_exp_f32 v213, v213
    v_mfma_f32_16x16x32_bf16 v[208:211], a[216:219], v[104:107], v[208:211]
    v_exp_f32 v214, v214
    v_mfma_f32_16x16x32_bf16 v[208:211], a[220:223], v[108:111], v[208:211]
    v_exp_f32 v215, v215
    v_mfma_f32_16x16x32_bf16 a[80:83], a[168:171], v[160:163], a[80:83]
    ds_read_b64_tr_b16 a[180:181], v26 offset:24576
    v_cvt_pk_bf16_f32 v140, v212, v213
    v_mfma_f32_16x16x32_bf16 a[80:83], a[172:175], v[164:167], a[80:83]
    ds_read_b64_tr_b16 a[182:183], v26 offset:28672
    v_mfma_f32_16x16x32_bf16 a[84:87], a[168:171], v[168:171], a[84:87]
    ds_read_b128 a[236:239], v11 offset:45056
    v_cvt_pk_bf16_f32 v141, v214, v215
    v_mfma_f32_16x16x32_bf16 a[84:87], a[172:175], v[172:175], a[84:87]
    s_waitcnt vmcnt(8)
    s_barrier
    v_mfma_f32_16x16x32_bf16 v[212:215], a[208:211], v[112:115], v[204:207]
    v_exp_f32 v208, v208
    v_mfma_f32_16x16x32_bf16 v[212:215], a[212:215], v[116:119], v[212:215]
    s_add_u32 s49, s45, 73728
    v_exp_f32 v209, v209
    v_mfma_f32_16x16x32_bf16 v[212:215], a[216:219], v[120:123], v[212:215]
    s_add_u32 m0, s42, 147456
    v_exp_f32 v210, v210
    v_mfma_f32_16x16x32_bf16 v[212:215], a[220:223], v[124:127], v[212:215]
    v_exp_f32 v211, v211
    v_mfma_f32_16x16x32_bf16 a[88:91], a[168:171], v[176:179], a[88:91]
    ds_read_b64_tr_b16 a[184:185], v27 offset:16384
    v_cvt_pk_bf16_f32 v148, v208, v209
    v_mfma_f32_16x16x32_bf16 a[88:91], a[172:175], v[180:183], a[88:91]
    ds_read_b64_tr_b16 a[186:187], v27 offset:20480
    v_mfma_f32_16x16x32_bf16 a[92:95], a[168:171], v[184:187], a[92:95]
    ds_read_b128 a[208:211], v8 offset:49152
    v_cvt_pk_bf16_f32 v149, v210, v211
    v_mfma_f32_16x16x32_bf16 a[92:95], a[172:175], v[188:191], a[92:95]
    s_waitcnt lgkmcnt(3)
    buffer_load_dwordx4 v46, s[20:23], s49 offen lds
    v_mfma_f32_16x16x32_bf16 v[208:211], a[224:227], v[64:67], v[192:195]
    v_exp_f32 v212, v212
    v_mfma_f32_16x16x32_bf16 v[208:211], a[228:231], v[68:71], v[208:211]
    v_exp_f32 v213, v213
    v_mfma_f32_16x16x32_bf16 v[208:211], a[232:235], v[72:75], v[208:211]
    v_exp_f32 v214, v214
    v_mfma_f32_16x16x32_bf16 v[208:211], a[236:239], v[76:79], v[208:211]
    v_exp_f32 v215, v215
    v_mfma_f32_16x16x32_bf16 a[96:99], a[176:179], v[160:163], a[96:99]
    ds_read_b64_tr_b16 a[188:189], v27 offset:24576
    v_cvt_pk_bf16_f32 v156, v212, v213
    v_mfma_f32_16x16x32_bf16 a[96:99], a[180:183], v[164:167], a[96:99]
    ds_read_b64_tr_b16 a[190:191], v27 offset:28672
    v_mfma_f32_16x16x32_bf16 a[100:103], a[176:179], v[168:171], a[100:103]
    ds_read_b128 a[212:215], v9 offset:49152
    v_cvt_pk_bf16_f32 v157, v214, v215
    v_mfma_f32_16x16x32_bf16 a[100:103], a[180:183], v[172:175], a[100:103]
    buffer_load_dword v63, v63, s[88:91], 0 offen sc1
    v_mfma_f32_16x16x32_bf16 v[212:215], a[224:227], v[80:83], v[196:199]
    v_exp_f32 v208, v208
    v_mfma_f32_16x16x32_bf16 v[212:215], a[228:231], v[84:87], v[212:215]
    v_exp_f32 v209, v209
    v_mfma_f32_16x16x32_bf16 v[212:215], a[232:235], v[88:91], v[212:215]
    v_exp_f32 v210, v210
    v_mfma_f32_16x16x32_bf16 v[212:215], a[236:239], v[92:95], v[212:215]
    v_exp_f32 v211, v211
    v_mfma_f32_16x16x32_bf16 a[104:107], a[176:179], v[176:179], a[104:107]
    ds_read_b64_tr_b16 a[160:161], v20 offset:32768
    v_cvt_pk_bf16_f32 v134, v208, v209
    v_mfma_f32_16x16x32_bf16 a[104:107], a[180:183], v[180:183], a[104:107]
    ds_read_b64_tr_b16 a[162:163], v20 offset:36864
    v_mfma_f32_16x16x32_bf16 a[108:111], a[176:179], v[184:187], a[108:111]
    ds_read_b128 a[216:219], v10 offset:49152
    v_cvt_pk_bf16_f32 v135, v210, v211
    v_mfma_f32_16x16x32_bf16 a[108:111], a[180:183], v[188:191], a[108:111]
    s_waitcnt lgkmcnt(3)
    buffer_load_dwordx4 v47, s[20:23], s49 offen offset:1024 lds
    v_mfma_f32_16x16x32_bf16 v[208:211], a[224:227], v[96:99], v[200:203]
    v_exp_f32 v212, v212
    v_mfma_f32_16x16x32_bf16 v[208:211], a[228:231], v[100:103], v[208:211]
    v_exp_f32 v213, v213
    v_mfma_f32_16x16x32_bf16 v[208:211], a[232:235], v[104:107], v[208:211]
    v_exp_f32 v214, v214
    v_mfma_f32_16x16x32_bf16 v[208:211], a[236:239], v[108:111], v[208:211]
    v_exp_f32 v215, v215
    v_mfma_f32_16x16x32_bf16 a[112:115], a[184:187], v[160:163], a[112:115]
    ds_read_b64_tr_b16 a[164:165], v20 offset:40960
    v_cvt_pk_bf16_f32 v142, v212, v213
    v_mfma_f32_16x16x32_bf16 a[112:115], a[188:191], v[164:167], a[112:115]
    ds_read_b64_tr_b16 a[166:167], v20 offset:45056
    v_mfma_f32_16x16x32_bf16 a[116:119], a[184:187], v[168:171], a[116:119]
    ds_read_b128 a[220:223], v11 offset:49152
    v_cvt_pk_bf16_f32 v143, v214, v215
    v_mfma_f32_16x16x32_bf16 a[116:119], a[188:191], v[172:175], a[116:119]
    v_mfma_f32_16x16x32_bf16 v[212:215], a[224:227], v[112:115], v[204:207]
    v_exp_f32 v208, v208
    v_mfma_f32_16x16x32_bf16 v[212:215], a[228:231], v[116:119], v[212:215]
    v_exp_f32 v209, v209
    v_mfma_f32_16x16x32_bf16 v[212:215], a[232:235], v[120:123], v[212:215]
    v_exp_f32 v210, v210
    v_mfma_f32_16x16x32_bf16 v[212:215], a[236:239], v[124:127], v[212:215]
    v_exp_f32 v211, v211
    v_mfma_f32_16x16x32_bf16 a[120:123], a[184:187], v[176:179], a[120:123]
    ds_read_b64_tr_b16 a[168:169], v21 offset:32768
    v_cvt_pk_bf16_f32 v150, v208, v209
    v_mfma_f32_16x16x32_bf16 a[120:123], a[188:191], v[180:183], a[120:123]
    ds_read_b64_tr_b16 a[170:171], v21 offset:36864
    v_mfma_f32_16x16x32_bf16 a[124:127], a[184:187], v[184:187], a[124:127]
    ds_read_b128 a[224:227], v8 offset:53248
    v_cvt_pk_bf16_f32 v151, v210, v211
    v_mfma_f32_16x16x32_bf16 a[124:127], a[188:191], v[188:191], a[124:127]
    s_waitcnt lgkmcnt(3)
    buffer_load_dwordx4 v48, s[20:23], s49 offen offset:2048 lds
    v_mfma_f32_16x16x32_bf16 v[208:211], a[208:211], v[64:67], v[192:195]
    v_exp_f32 v212, v212
    v_mfma_f32_16x16x32_bf16 v[208:211], a[212:215], v[68:71], v[208:211]
    v_exp_f32 v213, v213
    v_mfma_f32_16x16x32_bf16 v[208:211], a[216:219], v[72:75], v[208:211]
    v_exp_f32 v214, v214
    v_mfma_f32_16x16x32_bf16 v[208:211], a[220:223], v[76:79], v[208:211]
    v_exp_f32 v215, v215
    v_mfma_f32_16x16x32_bf16 a[0:3], a[160:163], v[128:131], a[0:3]
    ds_read_b64_tr_b16 a[172:173], v21 offset:40960
    v_cvt_pk_bf16_f32 v158, v212, v213
    v_mfma_f32_16x16x32_bf16 a[0:3], a[164:167], v[132:135], a[0:3]
    ds_read_b64_tr_b16 a[174:175], v21 offset:45056
    v_mfma_f32_16x16x32_bf16 a[4:7], a[160:163], v[136:139], a[4:7]
    ds_read_b128 a[228:231], v9 offset:53248
    v_cvt_pk_bf16_f32 v159, v214, v215
    v_mfma_f32_16x16x32_bf16 a[4:7], a[164:167], v[140:143], a[4:7]
    v_mfma_f32_16x16x32_bf16 v[212:215], a[208:211], v[80:83], v[196:199]
    v_exp_f32 v208, v208
    v_mfma_f32_16x16x32_bf16 v[212:215], a[212:215], v[84:87], v[212:215]
    v_exp_f32 v209, v209
    v_mfma_f32_16x16x32_bf16 v[212:215], a[216:219], v[88:91], v[212:215]
    v_exp_f32 v210, v210
    v_mfma_f32_16x16x32_bf16 v[212:215], a[220:223], v[92:95], v[212:215]
    v_exp_f32 v211, v211
    v_mfma_f32_16x16x32_bf16 a[8:11], a[160:163], v[144:147], a[8:11]
    ds_read_b64_tr_b16 a[176:177], v22 offset:32768
    v_cvt_pk_bf16_f32 v160, v208, v209
    v_mfma_f32_16x16x32_bf16 a[8:11], a[164:167], v[148:151], a[8:11]
    ds_read_b64_tr_b16 a[178:179], v22 offset:36864
    v_mfma_f32_16x16x32_bf16 a[12:15], a[160:163], v[152:155], a[12:15]
    ds_read_b128 a[232:235], v10 offset:53248
    v_cvt_pk_bf16_f32 v161, v210, v211
    v_mfma_f32_16x16x32_bf16 a[12:15], a[164:167], v[156:159], a[12:15]
    s_waitcnt lgkmcnt(3)
    buffer_load_dwordx4 v49, s[20:23], s49 offen offset:3072 lds
    v_mfma_f32_16x16x32_bf16 v[208:211], a[208:211], v[96:99], v[200:203]
    v_exp_f32 v212, v212
    v_mfma_f32_16x16x32_bf16 v[208:211], a[212:215], v[100:103], v[208:211]
    v_exp_f32 v213, v213
    v_mfma_f32_16x16x32_bf16 v[208:211], a[216:219], v[104:107], v[208:211]
    v_exp_f32 v214, v214
    v_mfma_f32_16x16x32_bf16 v[208:211], a[220:223], v[108:111], v[208:211]
    v_exp_f32 v215, v215
    v_mfma_f32_16x16x32_bf16 a[16:19], a[168:171], v[128:131], a[16:19]
    ds_read_b64_tr_b16 a[180:181], v22 offset:40960
    v_cvt_pk_bf16_f32 v168, v212, v213
    v_mfma_f32_16x16x32_bf16 a[16:19], a[172:175], v[132:135], a[16:19]
    ds_read_b64_tr_b16 a[182:183], v22 offset:45056
    v_mfma_f32_16x16x32_bf16 a[20:23], a[168:171], v[136:139], a[20:23]
    ds_read_b128 a[236:239], v11 offset:53248
    v_cvt_pk_bf16_f32 v169, v214, v215
    v_mfma_f32_16x16x32_bf16 a[20:23], a[172:175], v[140:143], a[20:23]
    v_smfmac_f32_16x16x64_bf16 a[192:195], v[52:55], v[128:135], v50
    v_mfma_f32_16x16x32_bf16 v[212:215], a[208:211], v[112:115], v[204:207]
    v_exp_f32 v208, v208
    v_mfma_f32_16x16x32_bf16 v[212:215], a[212:215], v[116:119], v[212:215]
    s_add_u32 s49, s45, 128
    v_exp_f32 v209, v209
    v_mfma_f32_16x16x32_bf16 v[212:215], a[216:219], v[120:123], v[212:215]
    s_add_u32 m0, s42, 0
    v_exp_f32 v210, v210
    v_mfma_f32_16x16x32_bf16 v[212:215], a[220:223], v[124:127], v[212:215]
    v_exp_f32 v211, v211
    v_mfma_f32_16x16x32_bf16 a[24:27], a[168:171], v[144:147], a[24:27]
    ds_read_b64_tr_b16 a[184:185], v23 offset:32768
    v_cvt_pk_bf16_f32 v176, v208, v209
    v_mfma_f32_16x16x32_bf16 a[24:27], a[172:175], v[148:151], a[24:27]
    ds_read_b64_tr_b16 a[186:187], v23 offset:36864
    v_mfma_f32_16x16x32_bf16 a[28:31], a[168:171], v[152:155], a[28:31]
    ds_read_b128 a[208:211], v8 offset:57344
    v_cvt_pk_bf16_f32 v177, v210, v211
    v_mfma_f32_16x16x32_bf16 a[28:31], a[172:175], v[156:159], a[28:31]
    s_waitcnt lgkmcnt(3)
    buffer_load_dwordx4 v46, s[20:23], s49 offen lds
    v_mfma_f32_16x16x32_bf16 v[208:211], a[224:227], v[64:67], v[192:195]
    v_exp_f32 v212, v212
    v_mfma_f32_16x16x32_bf16 v[208:211], a[228:231], v[68:71], v[208:211]
    v_exp_f32 v213, v213
    v_mfma_f32_16x16x32_bf16 v[208:211], a[232:235], v[72:75], v[208:211]
    v_exp_f32 v214, v214
    v_mfma_f32_16x16x32_bf16 v[208:211], a[236:239], v[76:79], v[208:211]
    v_exp_f32 v215, v215
    v_mfma_f32_16x16x32_bf16 a[32:35], a[176:179], v[128:131], a[32:35]
    ds_read_b64_tr_b16 a[188:189], v23 offset:40960
    v_cvt_pk_bf16_f32 v184, v212, v213
    v_mfma_f32_16x16x32_bf16 a[32:35], a[180:183], v[132:135], a[32:35]
    ds_read_b64_tr_b16 a[190:191], v23 offset:45056
    v_mfma_f32_16x16x32_bf16 a[36:39], a[176:179], v[136:139], a[36:39]
    ds_read_b128 a[212:215], v9 offset:57344
    v_cvt_pk_bf16_f32 v185, v214, v215
    v_mfma_f32_16x16x32_bf16 a[36:39], a[180:183], v[140:143], a[36:39]
    v_smfmac_f32_16x16x64_bf16 a[196:199], v[52:55], v[136:143], v50
    v_mfma_f32_16x16x32_bf16 v[212:215], a[224:227], v[80:83], v[196:199]
    v_exp_f32 v208, v208
    v_mfma_f32_16x16x32_bf16 v[212:215], a[228:231], v[84:87], v[212:215]
    v_exp_f32 v209, v209
    v_mfma_f32_16x16x32_bf16 v[212:215], a[232:235], v[88:91], v[212:215]
    v_exp_f32 v210, v210
    v_mfma_f32_16x16x32_bf16 v[212:215], a[236:239], v[92:95], v[212:215]
    v_exp_f32 v211, v211
    v_mfma_f32_16x16x32_bf16 a[40:43], a[176:179], v[144:147], a[40:43]
    ds_read_b64_tr_b16 a[160:161], v24 offset:32768
    v_cvt_pk_bf16_f32 v162, v208, v209
    v_mfma_f32_16x16x32_bf16 a[40:43], a[180:183], v[148:151], a[40:43]
    ds_read_b64_tr_b16 a[162:163], v24 offset:36864
    v_mfma_f32_16x16x32_bf16 a[44:47], a[176:179], v[152:155], a[44:47]
    ds_read_b128 a[216:219], v10 offset:57344
    v_cvt_pk_bf16_f32 v163, v210, v211
    v_mfma_f32_16x16x32_bf16 a[44:47], a[180:183], v[156:159], a[44:47]
    s_waitcnt lgkmcnt(3)
    buffer_load_dwordx4 v47, s[20:23], s49 offen offset:1024 lds
    v_mfma_f32_16x16x32_bf16 v[208:211], a[224:227], v[96:99], v[200:203]
    v_exp_f32 v212, v212
    v_mfma_f32_16x16x32_bf16 v[208:211], a[228:231], v[100:103], v[208:211]
    v_exp_f32 v213, v213
    v_mfma_f32_16x16x32_bf16 v[208:211], a[232:235], v[104:107], v[208:211]
    v_exp_f32 v214, v214
    v_mfma_f32_16x16x32_bf16 v[208:211], a[236:239], v[108:111], v[208:211]
    v_exp_f32 v215, v215
    v_mfma_f32_16x16x32_bf16 a[48:51], a[184:187], v[128:131], a[48:51]
    ds_read_b64_tr_b16 a[164:165], v24 offset:40960
    v_cvt_pk_bf16_f32 v170, v212, v213
    v_mfma_f32_16x16x32_bf16 a[48:51], a[188:191], v[132:135], a[48:51]
    ds_read_b64_tr_b16 a[166:167], v24 offset:45056
    v_mfma_f32_16x16x32_bf16 a[52:55], a[184:187], v[136:139], a[52:55]
    ds_read_b128 a[220:223], v11 offset:57344
    v_cvt_pk_bf16_f32 v171, v214, v215
    v_mfma_f32_16x16x32_bf16 a[52:55], a[188:191], v[140:143], a[52:55]
    v_smfmac_f32_16x16x64_bf16 a[200:203], v[52:55], v[144:151], v50
    v_mfma_f32_16x16x32_bf16 v[212:215], a[224:227], v[112:115], v[204:207]
    v_exp_f32 v208, v208
    v_mfma_f32_16x16x32_bf16 v[212:215], a[228:231], v[116:119], v[212:215]
    v_exp_f32 v209, v209
    v_mfma_f32_16x16x32_bf16 v[212:215], a[232:235], v[120:123], v[212:215]
    v_exp_f32 v210, v210
    v_mfma_f32_16x16x32_bf16 v[212:215], a[236:239], v[124:127], v[212:215]
    v_exp_f32 v211, v211
    v_mfma_f32_16x16x32_bf16 a[56:59], a[184:187], v[144:147], a[56:59]
    ds_read_b64_tr_b16 a[168:169], v25 offset:32768
    v_cvt_pk_bf16_f32 v178, v208, v209
    v_mfma_f32_16x16x32_bf16 a[56:59], a[188:191], v[148:151], a[56:59]
    ds_read_b64_tr_b16 a[170:171], v25 offset:36864
    v_mfma_f32_16x16x32_bf16 a[60:63], a[184:187], v[152:155], a[60:63]
    ds_read_b128 a[224:227], v8 offset:61440
    v_cvt_pk_bf16_f32 v179, v210, v211
    v_mfma_f32_16x16x32_bf16 a[60:63], a[188:191], v[156:159], a[60:63]
    s_waitcnt lgkmcnt(3)
    buffer_load_dwordx4 v48, s[20:23], s49 offen offset:2048 lds
    v_mfma_f32_16x16x32_bf16 v[208:211], a[208:211], v[64:67], v[192:195]
    v_exp_f32 v212, v212
    v_mfma_f32_16x16x32_bf16 v[208:211], a[212:215], v[68:71], v[208:211]
    v_exp_f32 v213, v213
    v_mfma_f32_16x16x32_bf16 v[208:211], a[216:219], v[72:75], v[208:211]
    v_exp_f32 v214, v214
    v_mfma_f32_16x16x32_bf16 v[208:211], a[220:223], v[76:79], v[208:211]
    v_exp_f32 v215, v215
    v_mfma_f32_16x16x32_bf16 a[64:67], a[160:163], v[128:131], a[64:67]
    ds_read_b64_tr_b16 a[172:173], v25 offset:40960
    v_cvt_pk_bf16_f32 v186, v212, v213
    v_mfma_f32_16x16x32_bf16 a[64:67], a[164:167], v[132:135], a[64:67]
    ds_read_b64_tr_b16 a[174:175], v25 offset:45056
    v_mfma_f32_16x16x32_bf16 a[68:71], a[160:163], v[136:139], a[68:71]
    ds_read_b128 a[228:231], v9 offset:61440
    v_cvt_pk_bf16_f32 v187, v214, v215
    v_mfma_f32_16x16x32_bf16 a[68:71], a[164:167], v[140:143], a[68:71]
    v_smfmac_f32_16x16x64_bf16 a[204:207], v[52:55], v[152:159], v50
    v_mfma_f32_16x16x32_bf16 v[212:215], a[208:211], v[80:83], v[196:199]
    v_exp_f32 v208, v208
    v_mfma_f32_16x16x32_bf16 v[212:215], a[212:215], v[84:87], v[212:215]
    v_exp_f32 v209, v209
    v_mfma_f32_16x16x32_bf16 v[212:215], a[216:219], v[88:91], v[212:215]
    v_exp_f32 v210, v210
    v_mfma_f32_16x16x32_bf16 v[212:215], a[220:223], v[92:95], v[212:215]
    v_exp_f32 v211, v211
    v_mfma_f32_16x16x32_bf16 a[72:75], a[160:163], v[144:147], a[72:75]
    ds_read_b64_tr_b16 a[176:177], v26 offset:32768
    v_cvt_pk_bf16_f32 v164, v208, v209
    v_mfma_f32_16x16x32_bf16 a[72:75], a[164:167], v[148:151], a[72:75]
    ds_read_b64_tr_b16 a[178:179], v26 offset:36864
    v_mfma_f32_16x16x32_bf16 a[76:79], a[160:163], v[152:155], a[76:79]
    ds_read_b128 a[232:235], v10 offset:61440
    v_cvt_pk_bf16_f32 v165, v210, v211
    v_mfma_f32_16x16x32_bf16 a[76:79], a[164:167], v[156:159], a[76:79]
    s_waitcnt lgkmcnt(3)
    buffer_load_dwordx4 v49, s[20:23], s49 offen offset:3072 lds
    v_mfma_f32_16x16x32_bf16 v[208:211], a[208:211], v[96:99], v[200:203]
    v_exp_f32 v212, v212
    v_mfma_f32_16x16x32_bf16 v[208:211], a[212:215], v[100:103], v[208:211]
    v_exp_f32 v213, v213
    v_mfma_f32_16x16x32_bf16 v[208:211], a[216:219], v[104:107], v[208:211]
    v_exp_f32 v214, v214
    v_mfma_f32_16x16x32_bf16 v[208:211], a[220:223], v[108:111], v[208:211]
    v_exp_f32 v215, v215
    v_mfma_f32_16x16x32_bf16 a[80:83], a[168:171], v[128:131], a[80:83]
    ds_read_b64_tr_b16 a[180:181], v26 offset:40960
    v_cvt_pk_bf16_f32 v172, v212, v213
    v_mfma_f32_16x16x32_bf16 a[80:83], a[172:175], v[132:135], a[80:83]
    ds_read_b64_tr_b16 a[182:183], v26 offset:45056
    v_mfma_f32_16x16x32_bf16 a[84:87], a[168:171], v[136:139], a[84:87]
    ds_read_b128 a[236:239], v11 offset:61440
    v_cvt_pk_bf16_f32 v173, v214, v215
    v_mfma_f32_16x16x32_bf16 a[84:87], a[172:175], v[140:143], a[84:87]
    s_waitcnt vmcnt(9)
    s_barrier
    v_mfma_f32_16x16x32_bf16 v[212:215], a[208:211], v[112:115], v[204:207]
    v_exp_f32 v208, v208
    v_mfma_f32_16x16x32_bf16 v[212:215], a[212:215], v[116:119], v[212:215]
    s_add_u32 s49, s45, 73856
    v_exp_f32 v209, v209
    v_mfma_f32_16x16x32_bf16 v[212:215], a[216:219], v[120:123], v[212:215]
    s_add_u32 m0, s42, 16384
    v_exp_f32 v210, v210
    v_mfma_f32_16x16x32_bf16 v[212:215], a[220:223], v[124:127], v[212:215]
    v_exp_f32 v211, v211
    v_mfma_f32_16x16x32_bf16 a[88:91], a[168:171], v[144:147], a[88:91]
    ds_read_b64_tr_b16 a[184:185], v27 offset:32768
    v_cvt_pk_bf16_f32 v180, v208, v209
    v_mfma_f32_16x16x32_bf16 a[88:91], a[172:175], v[148:151], a[88:91]
    ds_read_b64_tr_b16 a[186:187], v27 offset:36864
    v_mfma_f32_16x16x32_bf16 a[92:95], a[168:171], v[152:155], a[92:95]
    v_cvt_pk_bf16_f32 v181, v210, v211
    v_mfma_f32_16x16x32_bf16 a[92:95], a[172:175], v[156:159], a[92:95]
    s_waitcnt lgkmcnt(3)
    buffer_load_dwordx4 v46, s[20:23], s49 offen lds
    v_mfma_f32_16x16x32_bf16 v[208:211], a[224:227], v[64:67], v[192:195]
    v_exp_f32 v212, v212
    v_mfma_f32_16x16x32_bf16 v[208:211], a[228:231], v[68:71], v[208:211]
    v_exp_f32 v213, v213
    v_mfma_f32_16x16x32_bf16 v[208:211], a[232:235], v[72:75], v[208:211]
    s_waitcnt lgkmcnt(2)
    v_exp_f32 v214, v214
    v_mfma_f32_16x16x32_bf16 v[208:211], a[236:239], v[76:79], v[208:211]
    v_exp_f32 v215, v215
    v_mfma_f32_16x16x32_bf16 a[96:99], a[176:179], v[128:131], a[96:99]
    ds_read_b64_tr_b16 a[188:189], v27 offset:40960
    v_cvt_pk_bf16_f32 v188, v212, v213
    v_mfma_f32_16x16x32_bf16 a[96:99], a[180:183], v[132:135], a[96:99]
    ds_read_b64_tr_b16 a[190:191], v27 offset:45056
    v_mfma_f32_16x16x32_bf16 a[100:103], a[176:179], v[136:139], a[100:103]
    v_cvt_pk_bf16_f32 v189, v214, v215
    v_mfma_f32_16x16x32_bf16 a[100:103], a[180:183], v[140:143], a[100:103]
    v_mfma_f32_16x16x32_bf16 v[212:215], a[224:227], v[80:83], v[196:199]
    v_exp_f32 v208, v208
    v_mfma_f32_16x16x32_bf16 v[212:215], a[228:231], v[84:87], v[212:215]
    v_exp_f32 v209, v209
    v_mfma_f32_16x16x32_bf16 v[212:215], a[232:235], v[88:91], v[212:215]
    v_exp_f32 v210, v210
    v_mfma_f32_16x16x32_bf16 v[212:215], a[236:239], v[92:95], v[212:215]
    v_exp_f32 v211, v211
    v_mfma_f32_16x16x32_bf16 a[104:107], a[176:179], v[144:147], a[104:107]
    ds_read_b64_tr_b16 a[160:161], v20 offset:49152
    v_cvt_pk_bf16_f32 v166, v208, v209
    v_mfma_f32_16x16x32_bf16 a[104:107], a[180:183], v[148:151], a[104:107]
    ds_read_b64_tr_b16 a[162:163], v20 offset:53248
    v_mfma_f32_16x16x32_bf16 a[108:111], a[176:179], v[152:155], a[108:111]
    v_cvt_pk_bf16_f32 v167, v210, v211
    v_mfma_f32_16x16x32_bf16 a[108:111], a[180:183], v[156:159], a[108:111]
    s_waitcnt lgkmcnt(3)
    buffer_load_dwordx4 v47, s[20:23], s49 offen offset:1024 lds
    v_mfma_f32_16x16x32_bf16 v[208:211], a[224:227], v[96:99], v[200:203]
    v_exp_f32 v212, v212
    v_mfma_f32_16x16x32_bf16 v[208:211], a[228:231], v[100:103], v[208:211]
    v_exp_f32 v213, v213
    v_mfma_f32_16x16x32_bf16 v[208:211], a[232:235], v[104:107], v[208:211]
    v_exp_f32 v214, v214
    v_mfma_f32_16x16x32_bf16 v[208:211], a[236:239], v[108:111], v[208:211]
    v_exp_f32 v215, v215
    v_mfma_f32_16x16x32_bf16 a[112:115], a[184:187], v[128:131], a[112:115]
    s_waitcnt lgkmcnt(2)
    ds_read_b64_tr_b16 a[164:165], v20 offset:57344
    v_cvt_pk_bf16_f32 v174, v212, v213
    v_mfma_f32_16x16x32_bf16 a[112:115], a[188:191], v[132:135], a[112:115]
    ds_read_b64_tr_b16 a[166:167], v20 offset:61440
    v_mfma_f32_16x16x32_bf16 a[116:119], a[184:187], v[136:139], a[116:119]
    v_cvt_pk_bf16_f32 v175, v214, v215
    v_mfma_f32_16x16x32_bf16 a[116:119], a[188:191], v[140:143], a[116:119]
    v_mfma_f32_16x16x32_bf16 v[212:215], a[224:227], v[112:115], v[204:207]
    v_exp_f32 v208, v208
    v_mfma_f32_16x16x32_bf16 v[212:215], a[228:231], v[116:119], v[212:215]
    v_exp_f32 v209, v209
    v_mfma_f32_16x16x32_bf16 v[212:215], a[232:235], v[120:123], v[212:215]
    v_exp_f32 v210, v210
    v_mfma_f32_16x16x32_bf16 v[212:215], a[236:239], v[124:127], v[212:215]
    v_exp_f32 v211, v211
    v_mfma_f32_16x16x32_bf16 a[120:123], a[184:187], v[144:147], a[120:123]
    ds_read_b64_tr_b16 a[168:169], v21 offset:49152
    v_cvt_pk_bf16_f32 v182, v208, v209
    v_mfma_f32_16x16x32_bf16 a[120:123], a[188:191], v[148:151], a[120:123]
    ds_read_b64_tr_b16 a[170:171], v21 offset:53248
    v_mfma_f32_16x16x32_bf16 a[124:127], a[184:187], v[152:155], a[124:127]
    v_cvt_pk_bf16_f32 v183, v210, v211
    v_mfma_f32_16x16x32_bf16 a[124:127], a[188:191], v[156:159], a[124:127]
    s_waitcnt lgkmcnt(3)
    buffer_load_dwordx4 v48, s[20:23], s49 offen offset:2048 lds
    v_exp_f32 v212, v212
    v_exp_f32 v213, v213
    v_exp_f32 v214, v214
    v_exp_f32 v215, v215
    v_mfma_f32_16x16x32_bf16 a[0:3], a[160:163], v[160:163], a[0:3]
    s_waitcnt lgkmcnt(2)
    ds_read_b64_tr_b16 a[172:173], v21 offset:57344
    v_cvt_pk_bf16_f32 v190, v212, v213
    v_mfma_f32_16x16x32_bf16 a[0:3], a[164:167], v[164:167], a[0:3]
    ds_read_b64_tr_b16 a[174:175], v21 offset:61440
    v_mfma_f32_16x16x32_bf16 a[4:7], a[160:163], v[168:171], a[4:7]
    v_cvt_pk_bf16_f32 v191, v214, v215
    v_mfma_f32_16x16x32_bf16 a[4:7], a[164:167], v[172:175], a[4:7]
    v_mfma_f32_16x16x32_bf16 a[8:11], a[160:163], v[176:179], a[8:11]
    ds_read_b64_tr_b16 a[176:177], v22 offset:49152
    v_mfma_f32_16x16x32_bf16 a[8:11], a[164:167], v[180:183], a[8:11]
    ds_read_b64_tr_b16 a[178:179], v22 offset:53248
    v_mfma_f32_16x16x32_bf16 a[12:15], a[160:163], v[184:187], a[12:15]
    v_mfma_f32_16x16x32_bf16 a[12:15], a[164:167], v[188:191], a[12:15]
    buffer_load_dwordx4 v49, s[20:23], s49 offen offset:3072 lds
    v_smfmac_f32_16x16x64_bf16 a[192:195], v[52:55], v[160:167], v50
    s_waitcnt lgkmcnt(4)
    v_mfma_f32_16x16x32_bf16 a[16:19], a[168:171], v[160:163], a[16:19]
    s_waitcnt lgkmcnt(2)
    ds_read_b64_tr_b16 a[180:181], v22 offset:57344
    v_mfma_f32_16x16x32_bf16 a[16:19], a[172:175], v[164:167], a[16:19]
    ds_read_b64_tr_b16 a[182:183], v22 offset:61440
    v_mfma_f32_16x16x32_bf16 a[20:23], a[168:171], v[168:171], a[20:23]
    v_mfma_f32_16x16x32_bf16 a[20:23], a[172:175], v[172:175], a[20:23]
    v_smfmac_f32_16x16x64_bf16 a[196:199], v[52:55], v[168:175], v50
    s_add_u32 s49, s45, 256
    s_add_u32 m0, s42, 32768
    v_mfma_f32_16x16x32_bf16 a[24:27], a[168:171], v[176:179], a[24:27]
    ds_read_b64_tr_b16 a[184:185], v23 offset:49152
    v_mfma_f32_16x16x32_bf16 a[24:27], a[172:175], v[180:183], a[24:27]
    ds_read_b64_tr_b16 a[186:187], v23 offset:53248
    v_mfma_f32_16x16x32_bf16 a[28:31], a[168:171], v[184:187], a[28:31]
    v_mfma_f32_16x16x32_bf16 a[28:31], a[172:175], v[188:191], a[28:31]
    buffer_load_dwordx4 v46, s[20:23], s49 offen lds
    v_smfmac_f32_16x16x64_bf16 a[200:203], v[52:55], v[176:183], v50
    s_waitcnt lgkmcnt(4)
    v_mfma_f32_16x16x32_bf16 a[32:35], a[176:179], v[160:163], a[32:35]
    s_waitcnt lgkmcnt(2)
    ds_read_b64_tr_b16 a[188:189], v23 offset:57344
    v_mfma_f32_16x16x32_bf16 a[32:35], a[180:183], v[164:167], a[32:35]
    ds_read_b64_tr_b16 a[190:191], v23 offset:61440
    v_mfma_f32_16x16x32_bf16 a[36:39], a[176:179], v[168:171], a[36:39]
    v_mfma_f32_16x16x32_bf16 a[36:39], a[180:183], v[172:175], a[36:39]
    v_smfmac_f32_16x16x64_bf16 a[204:207], v[52:55], v[184:191], v50
    v_mfma_f32_16x16x32_bf16 a[40:43], a[176:179], v[176:179], a[40:43]
    ds_read_b64_tr_b16 a[160:161], v24 offset:49152
    v_mfma_f32_16x16x32_bf16 a[40:43], a[180:183], v[180:183], a[40:43]
    ds_read_b64_tr_b16 a[162:163], v24 offset:53248
    v_mfma_f32_16x16x32_bf16 a[44:47], a[176:179], v[184:187], a[44:47]
    v_mfma_f32_16x16x32_bf16 a[44:47], a[180:183], v[188:191], a[44:47]
    s_waitcnt lgkmcnt(4)
    buffer_load_dwordx4 v47, s[20:23], s49 offen offset:1024 lds
    v_mfma_f32_16x16x32_bf16 a[48:51], a[184:187], v[160:163], a[48:51]
    s_waitcnt lgkmcnt(2)
    ds_read_b64_tr_b16 a[164:165], v24 offset:57344
    v_accvgpr_read_b32 v216, a192
    v_mfma_f32_16x16x32_bf16 a[48:51], a[188:191], v[164:167], a[48:51]
    ds_read_b64_tr_b16 a[166:167], v24 offset:61440
    v_accvgpr_read_b32 v217, a193
    v_mfma_f32_16x16x32_bf16 a[52:55], a[184:187], v[168:171], a[52:55]
    v_accvgpr_read_b32 v218, a196
    v_accvgpr_read_b32 v219, a197
    v_mfma_f32_16x16x32_bf16 a[52:55], a[188:191], v[172:175], a[52:55]
    v_accvgpr_read_b32 v220, a200
    v_accvgpr_read_b32 v221, a201
    v_mfma_f32_16x16x32_bf16 a[56:59], a[184:187], v[176:179], a[56:59]
    ds_read_b64_tr_b16 a[168:169], v25 offset:49152
    v_accvgpr_read_b32 v222, a204
    v_mfma_f32_16x16x32_bf16 a[56:59], a[188:191], v[180:183], a[56:59]
    ds_read_b64_tr_b16 a[170:171], v25 offset:53248
    v_accvgpr_read_b32 v223, a205
    v_mfma_f32_16x16x32_bf16 a[60:63], a[184:187], v[184:187], a[60:63]
    v_add_f32 v58, v216, v217
    v_add_f32 v59, v218, v219
    v_mfma_f32_16x16x32_bf16 a[60:63], a[188:191], v[188:191], a[60:63]
    s_waitcnt lgkmcnt(4)
    buffer_load_dwordx4 v48, s[20:23], s49 offen offset:2048 lds
    v_add_f32 v60, v220, v221
    v_add_f32 v61, v222, v223
    v_mfma_f32_16x16x32_bf16 a[64:67], a[160:163], v[160:163], a[64:67]
    s_waitcnt lgkmcnt(2)
    ds_read_b64_tr_b16 a[172:173], v25 offset:57344
    v_add_f32 v216, v58, v59
    v_mfma_f32_16x16x32_bf16 a[64:67], a[164:167], v[164:167], a[64:67]
    ds_read_b64_tr_b16 a[174:175], v25 offset:61440
    v_add_f32 v217, v60, v61
    v_mfma_f32_16x16x32_bf16 a[68:71], a[160:163], v[168:171], a[68:71]
    v_add_f32 v216, v216, v217
    v_cmp_ngt_f32 vcc, 1669332992, v216
    v_mfma_f32_16x16x32_bf16 a[68:71], a[164:167], v[172:175], a[68:71]
    v_rcp_f32 v58, v58
    v_rcp_f32 v59, v59
    v_mfma_f32_16x16x32_bf16 a[72:75], a[160:163], v[176:179], a[72:75]
    ds_read_b64_tr_b16 a[176:177], v26 offset:49152
    v_rcp_f32 v60, v60
    v_mfma_f32_16x16x32_bf16 a[72:75], a[164:167], v[180:183], a[72:75]
    ds_read_b64_tr_b16 a[178:179], v26 offset:53248
    v_rcp_f32 v61, v61
    v_mfma_f32_16x16x32_bf16 a[76:79], a[160:163], v[184:187], a[76:79]
    v_mov_b32 v228, 81920
    s_or_b32 s36, vcc_lo, vcc_hi
    v_mfma_f32_16x16x32_bf16 a[76:79], a[164:167], v[188:191], a[76:79]
    s_waitcnt lgkmcnt(4)
    buffer_load_dwordx4 v49, s[20:23], s49 offen offset:3072 lds
    v_mov_b32 v218, s36
    s_lshl_b32 s37, s3, 2
    v_mfma_f32_16x16x32_bf16 a[80:83], a[168:171], v[160:163], a[80:83]
    s_waitcnt lgkmcnt(2)
    ds_read_b64_tr_b16 a[180:181], v26 offset:57344
    v_add_u32 v219, s37, v228
    ds_write_b32 v219, v218
    v_mfma_f32_16x16x32_bf16 a[80:83], a[172:175], v[164:167], a[80:83]
    ds_read_b64_tr_b16 a[182:183], v26 offset:61440
    v_mfma_f32_16x16x32_bf16 a[84:87], a[168:171], v[168:171], a[84:87]
    v_mfma_f32_16x16x32_bf16 a[84:87], a[172:175], v[172:175], a[84:87]
    s_waitcnt lgkmcnt(1)
    s_waitcnt vmcnt(12)
    s_barrier
    v_mfma_f32_16x16x32_bf16 a[88:91], a[168:171], v[176:179], a[88:91]
    ds_read_b64_tr_b16 a[184:185], v27 offset:49152
    v_mfma_f32_16x16x32_bf16 a[88:91], a[172:175], v[180:183], a[88:91]
    ds_read_b64_tr_b16 a[186:187], v27 offset:53248
    v_mfma_f32_16x16x32_bf16 a[92:95], a[168:171], v[184:187], a[92:95]
    ds_read_b128 v[224:227], v228
    v_mfma_f32_16x16x32_bf16 a[92:95], a[172:175], v[188:191], a[92:95]
    s_add_u32 s49, s45, 73984
    v_mfma_f32_16x16x32_bf16 a[96:99], a[176:179], v[160:163], a[96:99]
    s_waitcnt lgkmcnt(3)
    s_add_u32 m0, s42, 49152
    ds_read_b64_tr_b16 a[188:189], v27 offset:57344
    v_mfma_f32_16x16x32_bf16 a[96:99], a[180:183], v[164:167], a[96:99]
    ds_read_b64_tr_b16 a[190:191], v27 offset:61440
    buffer_load_dwordx4 v46, s[20:23], s49 offen lds
    v_mfma_f32_16x16x32_bf16 a[100:103], a[176:179], v[168:171], a[100:103]
    v_mfma_f32_16x16x32_bf16 a[100:103], a[180:183], v[172:175], a[100:103]
    buffer_load_dwordx4 v47, s[20:23], s49 offen offset:1024 lds
    v_mfma_f32_16x16x32_bf16 a[104:107], a[176:179], v[176:179], a[104:107]
    v_mfma_f32_16x16x32_bf16 a[104:107], a[180:183], v[180:183], a[104:107]
    buffer_load_dwordx4 v48, s[20:23], s49 offen offset:2048 lds
    v_mfma_f32_16x16x32_bf16 a[108:111], a[176:179], v[184:187], a[108:111]
    v_mfma_f32_16x16x32_bf16 a[108:111], a[180:183], v[188:191], a[108:111]
    s_waitcnt lgkmcnt(3)
    buffer_load_dwordx4 v49, s[20:23], s49 offen offset:3072 lds
    s_add_u32 s49, s45, 384
    v_mfma_f32_16x16x32_bf16 a[112:115], a[184:187], v[160:163], a[112:115]
    s_waitcnt lgkmcnt(0)
    s_add_u32 m0, s42, 65536
    v_mfma_f32_16x16x32_bf16 a[112:115], a[188:191], v[164:167], a[112:115]
    buffer_load_dwordx4 v46, s[20:23], s49 offen lds
    v_mfma_f32_16x16x32_bf16 a[116:119], a[184:187], v[168:171], a[116:119]
    v_mfma_f32_16x16x32_bf16 a[116:119], a[188:191], v[172:175], a[116:119]
    buffer_load_dwordx4 v47, s[20:23], s49 offen offset:1024 lds
    v_mfma_f32_16x16x32_bf16 a[120:123], a[184:187], v[176:179], a[120:123]
    v_mfma_f32_16x16x32_bf16 a[120:123], a[188:191], v[180:183], a[120:123]
    buffer_load_dwordx4 v48, s[20:23], s49 offen offset:2048 lds
    v_mfma_f32_16x16x32_bf16 a[124:127], a[184:187], v[184:187], a[124:127]
    v_mfma_f32_16x16x32_bf16 a[124:127], a[188:191], v[188:191], a[124:127]
    buffer_load_dwordx4 v49, s[20:23], s49 offen offset:3072 lds
    v_or3_b32 v224, v224, v225, v226
    v_or_b32 v224, v224, v227
    s_nop 0
    v_readfirstlane_b32 s36, v224
    v_readfirstlane_b32 s37, v63
    ds_read_b64_tr_b16 a[128:129], v28 offset:0
    ds_read_b64_tr_b16 a[130:131], v28 offset:4096
    ds_read_b64_tr_b16 a[132:133], v28 offset:8192
    ds_read_b64_tr_b16 a[134:135], v28 offset:12288
    ds_read_b64_tr_b16 a[136:137], v28 offset:16384
    ds_read_b64_tr_b16 a[138:139], v28 offset:20480
    ds_read_b64_tr_b16 a[140:141], v28 offset:24576
    ds_read_b64_tr_b16 a[142:143], v28 offset:28672
    ds_read_b64_tr_b16 a[144:145], v32 offset:0
    ds_read_b64_tr_b16 a[146:147], v32 offset:4096
    ds_read_b64_tr_b16 a[148:149], v32 offset:8192
    ds_read_b64_tr_b16 a[150:151], v32 offset:12288
    ds_read_b64_tr_b16 a[152:153], v32 offset:16384
    ds_read_b64_tr_b16 a[154:155], v32 offset:20480
    ds_read_b64_tr_b16 a[156:157], v32 offset:24576
    ds_read_b64_tr_b16 a[158:159], v32 offset:28672
    s_andn2_b32 s36, s36, s48
    s_cbranch_scc1 Lattn_redo
    s_cmp_lg_u32 s37, 256
    s_cbranch_scc1 Lattn_armwait
Lattn_armed:
    v_accvgpr_read_b32 v216, a0
    v_accvgpr_read_b32 v217, a1
    v_accvgpr_read_b32 v218, a2
    v_accvgpr_read_b32 v219, a3
    v_pk_mul_f32 v[216:217], v[216:217], v[58:59] op_sel:[0,0] op_sel_hi:[1,0]
    v_pk_mul_f32 v[218:219], v[218:219], v[58:59] op_sel:[0,0] op_sel_hi:[1,0]
    v_cvt_pk_bf16_f32 v128, v216, v217
    v_cvt_pk_bf16_f32 v129, v218, v219
    v_accvgpr_read_b32 v220, a4
    v_accvgpr_read_b32 v221, a5
    v_accvgpr_read_b32 v222, a6
    v_accvgpr_read_b32 v223, a7
    v_pk_mul_f32 v[220:221], v[220:221], v[58:59] op_sel:[0,1] op_sel_hi:[1,1]
    v_pk_mul_f32 v[222:223], v[222:223], v[58:59] op_sel:[0,1] op_sel_hi:[1,1]
    v_cvt_pk_bf16_f32 v160, v220, v221
    v_cvt_pk_bf16_f32 v161, v222, v223
    v_accvgpr_read_b32 v224, a8
    v_accvgpr_read_b32 v225, a9
    v_accvgpr_read_b32 v226, a10
    v_accvgpr_read_b32 v227, a11
    v_pk_mul_f32 v[224:225], v[224:225], v[60:61] op_sel:[0,0] op_sel_hi:[1,0]
    v_pk_mul_f32 v[226:227], v[226:227], v[60:61] op_sel:[0,0] op_sel_hi:[1,0]
    v_cvt_pk_bf16_f32 v144, v224, v225
    v_cvt_pk_bf16_f32 v145, v226, v227
    v_accvgpr_read_b32 v228, a12
    v_accvgpr_read_b32 v229, a13
    v_accvgpr_read_b32 v230, a14
    v_accvgpr_read_b32 v231, a15
    v_pk_mul_f32 v[228:229], v[228:229], v[60:61] op_sel:[0,1] op_sel_hi:[1,1]
    v_pk_mul_f32 v[230:231], v[230:231], v[60:61] op_sel:[0,1] op_sel_hi:[1,1]
    v_cvt_pk_bf16_f32 v176, v228, v229
    v_cvt_pk_bf16_f32 v177, v230, v231
    v_accvgpr_read_b32 v216, a16
    v_accvgpr_read_b32 v217, a17
    v_accvgpr_read_b32 v218, a18
    v_accvgpr_read_b32 v219, a19
    v_pk_mul_f32 v[216:217], v[216:217], v[58:59] op_sel:[0,0] op_sel_hi:[1,0]
    v_pk_mul_f32 v[218:219], v[218:219], v[58:59] op_sel:[0,0] op_sel_hi:[1,0]
    v_cvt_pk_bf16_f32 v130, v216, v217
    v_cvt_pk_bf16_f32 v131, v218, v219
    v_accvgpr_read_b32 v220, a20
    v_accvgpr_read_b32 v221, a21
    v_accvgpr_read_b32 v222, a22
    v_accvgpr_read_b32 v223, a23
    v_pk_mul_f32 v[220:221], v[220:221], v[58:59] op_sel:[0,1] op_sel_hi:[1,1]
    v_pk_mul_f32 v[222:223], v[222:223], v[58:59] op_sel:[0,1] op_sel_hi:[1,1]
    v_cvt_pk_bf16_f32 v162, v220, v221
    v_cvt_pk_bf16_f32 v163, v222, v223
    v_accvgpr_read_b32 v224, a24
    v_accvgpr_read_b32 v225, a25
    v_accvgpr_read_b32 v226, a26
    v_accvgpr_read_b32 v227, a27
    v_pk_mul_f32 v[224:225], v[224:225], v[60:61] op_sel:[0,0] op_sel_hi:[1,0]
    v_pk_mul_f32 v[226:227], v[226:227], v[60:61] op_sel:[0,0] op_sel_hi:[1,0]
    v_cvt_pk_bf16_f32 v146, v224, v225
    v_cvt_pk_bf16_f32 v147, v226, v227
    v_accvgpr_read_b32 v228, a28
    v_accvgpr_read_b32 v229, a29
    v_accvgpr_read_b32 v230, a30
    v_accvgpr_read_b32 v231, a31
    v_pk_mul_f32 v[228:229], v[228:229], v[60:61] op_sel:[0,1] op_sel_hi:[1,1]
    v_pk_mul_f32 v[230:231], v[230:231], v[60:61] op_sel:[0,1] op_sel_hi:[1,1]
    v_cvt_pk_bf16_f32 v178, v228, v229
    v_cvt_pk_bf16_f32 v179, v230, v231
    v_accvgpr_read_b32 v216, a32
    v_accvgpr_read_b32 v217, a33
    v_accvgpr_read_b32 v218, a34
    v_accvgpr_read_b32 v219, a35
    v_pk_mul_f32 v[216:217], v[216:217], v[58:59] op_sel:[0,0] op_sel_hi:[1,0]
    v_pk_mul_f32 v[218:219], v[218:219], v[58:59] op_sel:[0,0] op_sel_hi:[1,0]
    v_cvt_pk_bf16_f32 v132, v216, v217
    v_cvt_pk_bf16_f32 v133, v218, v219
    v_accvgpr_read_b32 v220, a36
    v_accvgpr_read_b32 v221, a37
    v_accvgpr_read_b32 v222, a38
    v_accvgpr_read_b32 v223, a39
    v_pk_mul_f32 v[220:221], v[220:221], v[58:59] op_sel:[0,1] op_sel_hi:[1,1]
    v_pk_mul_f32 v[222:223], v[222:223], v[58:59] op_sel:[0,1] op_sel_hi:[1,1]
    v_cvt_pk_bf16_f32 v164, v220, v221
    v_cvt_pk_bf16_f32 v165, v222, v223
    v_accvgpr_read_b32 v224, a40
    v_accvgpr_read_b32 v225, a41
    v_accvgpr_read_b32 v226, a42
    v_accvgpr_read_b32 v227, a43
    v_pk_mul_f32 v[224:225], v[224:225], v[60:61] op_sel:[0,0] op_sel_hi:[1,0]
    v_pk_mul_f32 v[226:227], v[226:227], v[60:61] op_sel:[0,0] op_sel_hi:[1,0]
    v_cvt_pk_bf16_f32 v148, v224, v225
    v_cvt_pk_bf16_f32 v149, v226, v227
    v_accvgpr_read_b32 v228, a44
    v_accvgpr_read_b32 v229, a45
    v_accvgpr_read_b32 v230, a46
    v_accvgpr_read_b32 v231, a47
    v_pk_mul_f32 v[228:229], v[228:229], v[60:61] op_sel:[0,1] op_sel_hi:[1,1]
    v_pk_mul_f32 v[230:231], v[230:231], v[60:61] op_sel:[0,1] op_sel_hi:[1,1]
    v_cvt_pk_bf16_f32 v180, v228, v229
    v_cvt_pk_bf16_f32 v181, v230, v231
    v_accvgpr_read_b32 v216, a48
    v_accvgpr_read_b32 v217, a49
    v_accvgpr_read_b32 v218, a50
    v_accvgpr_read_b32 v219, a51
    v_pk_mul_f32 v[216:217], v[216:217], v[58:59] op_sel:[0,0] op_sel_hi:[1,0]
    v_pk_mul_f32 v[218:219], v[218:219], v[58:59] op_sel:[0,0] op_sel_hi:[1,0]
    v_cvt_pk_bf16_f32 v134, v216, v217
    v_cvt_pk_bf16_f32 v135, v218, v219
    v_accvgpr_read_b32 v220, a52
    v_accvgpr_read_b32 v221, a53
    v_accvgpr_read_b32 v222, a54
    v_accvgpr_read_b32 v223, a55
    v_pk_mul_f32 v[220:221], v[220:221], v[58:59] op_sel:[0,1] op_sel_hi:[1,1]
    v_pk_mul_f32 v[222:223], v[222:223], v[58:59] op_sel:[0,1] op_sel_hi:[1,1]
    v_cvt_pk_bf16_f32 v166, v220, v221
    v_cvt_pk_bf16_f32 v167, v222, v223
    v_accvgpr_read_b32 v224, a56
    v_accvgpr_read_b32 v225, a57
    v_accvgpr_read_b32 v226, a58
    v_accvgpr_read_b32 v227, a59
    v_pk_mul_f32 v[224:225], v[224:225], v[60:61] op_sel:[0,0] op_sel_hi:[1,0]
    v_pk_mul_f32 v[226:227], v[226:227], v[60:61] op_sel:[0,0] op_sel_hi:[1,0]
    v_cvt_pk_bf16_f32 v150, v224, v225
    v_cvt_pk_bf16_f32 v151, v226, v227
    v_accvgpr_read_b32 v228, a60
    v_accvgpr_read_b32 v229, a61
    v_accvgpr_read_b32 v230, a62
    v_accvgpr_read_b32 v231, a63
    v_pk_mul_f32 v[228:229], v[228:229], v[60:61] op_sel:[0,1] op_sel_hi:[1,1]
    v_pk_mul_f32 v[230:231], v[230:231], v[60:61] op_sel:[0,1] op_sel_hi:[1,1]
    v_cvt_pk_bf16_f32 v182, v228, v229
    v_cvt_pk_bf16_f32 v183, v230, v231
    v_accvgpr_read_b32 v216, a64
    v_accvgpr_read_b32 v217, a65
    v_accvgpr_read_b32 v218, a66
    v_accvgpr_read_b32 v219, a67
    v_pk_mul_f32 v[216:217], v[216:217], v[58:59] op_sel:[0,0] op_sel_hi:[1,0]
    v_pk_mul_f32 v[218:219], v[218:219], v[58:59] op_sel:[0,0] op_sel_hi:[1,0]
    v_cvt_pk_bf16_f32 v136, v216, v217
    v_cvt_pk_bf16_f32 v137, v218, v219
    v_accvgpr_read_b32 v220, a68
    v_accvgpr_read_b32 v221, a69
    v_accvgpr_read_b32 v222, a70
    v_accvgpr_read_b32 v223, a71
    v_pk_mul_f32 v[220:221], v[220:221], v[58:59] op_sel:[0,1] op_sel_hi:[1,1]
    v_pk_mul_f32 v[222:223], v[222:223], v[58:59] op_sel:[0,1] op_sel_hi:[1,1]
    v_cvt_pk_bf16_f32 v168, v220, v221
    v_cvt_pk_bf16_f32 v169, v222, v223
    v_accvgpr_read_b32 v224, a72
    v_accvgpr_read_b32 v225, a73
    v_accvgpr_read_b32 v226, a74
    v_accvgpr_read_b32 v227, a75
    v_pk_mul_f32 v[224:225], v[224:225], v[60:61] op_sel:[0,0] op_sel_hi:[1,0]
    v_pk_mul_f32 v[226:227], v[226:227], v[60:61] op_sel:[0,0] op_sel_hi:[1,0]
    v_cvt_pk_bf16_f32 v152, v224, v225
    v_cvt_pk_bf16_f32 v153, v226, v227
    v_accvgpr_read_b32 v228, a76
    v_accvgpr_read_b32 v229, a77
    v_accvgpr_read_b32 v230, a78
    v_accvgpr_read_b32 v231, a79
    v_pk_mul_f32 v[228:229], v[228:229], v[60:61] op_sel:[0,1] op_sel_hi:[1,1]
    v_pk_mul_f32 v[230:231], v[230:231], v[60:61] op_sel:[0,1] op_sel_hi:[1,1]
    v_cvt_pk_bf16_f32 v184, v228, v229
    v_cvt_pk_bf16_f32 v185, v230, v231
    v_accvgpr_read_b32 v216, a80
    v_accvgpr_read_b32 v217, a81
    v_accvgpr_read_b32 v218, a82
    v_accvgpr_read_b32 v219, a83
    v_pk_mul_f32 v[216:217], v[216:217], v[58:59] op_sel:[0,0] op_sel_hi:[1,0]
    v_pk_mul_f32 v[218:219], v[218:219], v[58:59] op_sel:[0,0] op_sel_hi:[1,0]
    v_cvt_pk_bf16_f32 v138, v216, v217
    v_cvt_pk_bf16_f32 v139, v218, v219
    v_accvgpr_read_b32 v220, a84
    v_accvgpr_read_b32 v221, a85
    v_accvgpr_read_b32 v222, a86
    v_accvgpr_read_b32 v223, a87
    v_pk_mul_f32 v[220:221], v[220:221], v[58:59] op_sel:[0,1] op_sel_hi:[1,1]
    v_pk_mul_f32 v[222:223], v[222:223], v[58:59] op_sel:[0,1] op_sel_hi:[1,1]
    v_cvt_pk_bf16_f32 v170, v220, v221
    v_cvt_pk_bf16_f32 v171, v222, v223
    v_accvgpr_read_b32 v224, a88
    v_accvgpr_read_b32 v225, a89
    v_accvgpr_read_b32 v226, a90
    v_accvgpr_read_b32 v227, a91
    v_pk_mul_f32 v[224:225], v[224:225], v[60:61] op_sel:[0,0] op_sel_hi:[1,0]
    v_pk_mul_f32 v[226:227], v[226:227], v[60:61] op_sel:[0,0] op_sel_hi:[1,0]
    v_cvt_pk_bf16_f32 v154, v224, v225
    v_cvt_pk_bf16_f32 v155, v226, v227
    v_accvgpr_read_b32 v228, a92
    v_accvgpr_read_b32 v229, a93
    v_accvgpr_read_b32 v230, a94
    v_accvgpr_read_b32 v231, a95
    v_pk_mul_f32 v[228:229], v[228:229], v[60:61] op_sel:[0,1] op_sel_hi:[1,1]
    v_pk_mul_f32 v[230:231], v[230:231], v[60:61] op_sel:[0,1] op_sel_hi:[1,1]
    v_cvt_pk_bf16_f32 v186, v228, v229
    v_cvt_pk_bf16_f32 v187, v230, v231
    v_accvgpr_read_b32 v216, a96
    v_accvgpr_read_b32 v217, a97
    v_accvgpr_read_b32 v218, a98
    v_accvgpr_read_b32 v219, a99
    v_pk_mul_f32 v[216:217], v[216:217], v[58:59] op_sel:[0,0] op_sel_hi:[1,0]
    v_pk_mul_f32 v[218:219], v[218:219], v[58:59] op_sel:[0,0] op_sel_hi:[1,0]
    v_cvt_pk_bf16_f32 v140, v216, v217
    v_cvt_pk_bf16_f32 v141, v218, v219
    v_accvgpr_read_b32 v220, a100
    v_accvgpr_read_b32 v221, a101
    v_accvgpr_read_b32 v222, a102
    v_accvgpr_read_b32 v223, a103
    v_pk_mul_f32 v[220:221], v[220:221], v[58:59] op_sel:[0,1] op_sel_hi:[1,1]
    v_pk_mul_f32 v[222:223], v[222:223], v[58:59] op_sel:[0,1] op_sel_hi:[1,1]
    v_cvt_pk_bf16_f32 v172, v220, v221
    v_cvt_pk_bf16_f32 v173, v222, v223
    v_accvgpr_read_b32 v224, a104
    v_accvgpr_read_b32 v225, a105
    v_accvgpr_read_b32 v226, a106
    v_accvgpr_read_b32 v227, a107
    v_pk_mul_f32 v[224:225], v[224:225], v[60:61] op_sel:[0,0] op_sel_hi:[1,0]
    v_pk_mul_f32 v[226:227], v[226:227], v[60:61] op_sel:[0,0] op_sel_hi:[1,0]
    v_cvt_pk_bf16_f32 v156, v224, v225
    v_cvt_pk_bf16_f32 v157, v226, v227
    v_accvgpr_read_b32 v228, a108
    v_accvgpr_read_b32 v229, a109
    v_accvgpr_read_b32 v230, a110
    v_accvgpr_read_b32 v231, a111
    v_pk_mul_f32 v[228:229], v[228:229], v[60:61] op_sel:[0,1] op_sel_hi:[1,1]
    v_pk_mul_f32 v[230:231], v[230:231], v[60:61] op_sel:[0,1] op_sel_hi:[1,1]
    v_cvt_pk_bf16_f32 v188, v228, v229
    v_cvt_pk_bf16_f32 v189, v230, v231
    v_accvgpr_read_b32 v216, a112
    v_accvgpr_read_b32 v217, a113
    v_accvgpr_read_b32 v218, a114
    v_accvgpr_read_b32 v219, a115
    v_pk_mul_f32 v[216:217], v[216:217], v[58:59] op_sel:[0,0] op_sel_hi:[1,0]
    v_pk_mul_f32 v[218:219], v[218:219], v[58:59] op_sel:[0,0] op_sel_hi:[1,0]
    v_cvt_pk_bf16_f32 v142, v216, v217
    v_cvt_pk_bf16_f32 v143, v218, v219
    v_accvgpr_read_b32 v220, a116
    v_accvgpr_read_b32 v221, a117
    v_accvgpr_read_b32 v222, a118
    v_accvgpr_read_b32 v223, a119
    v_pk_mul_f32 v[220:221], v[220:221], v[58:59] op_sel:[0,1] op_sel_hi:[1,1]
    v_pk_mul_f32 v[222:223], v[222:223], v[58:59] op_sel:[0,1] op_sel_hi:[1,1]
    v_cvt_pk_bf16_f32 v174, v220, v221
    v_cvt_pk_bf16_f32 v175, v222, v223
    v_accvgpr_read_b32 v224, a120
    v_accvgpr_read_b32 v225, a121
    v_accvgpr_read_b32 v226, a122
    v_accvgpr_read_b32 v227, a123
    v_pk_mul_f32 v[224:225], v[224:225], v[60:61] op_sel:[0,0] op_sel_hi:[1,0]
    v_pk_mul_f32 v[226:227], v[226:227], v[60:61] op_sel:[0,0] op_sel_hi:[1,0]
    v_cvt_pk_bf16_f32 v158, v224, v225
    v_cvt_pk_bf16_f32 v159, v226, v227
    v_accvgpr_read_b32 v228, a124
    v_accvgpr_read_b32 v229, a125
    v_accvgpr_read_b32 v230, a126
    v_accvgpr_read_b32 v231, a127
    v_pk_mul_f32 v[228:229], v[228:229], v[60:61] op_sel:[0,1] op_sel_hi:[1,1]
    v_pk_mul_f32 v[230:231], v[230:231], v[60:61] op_sel:[0,1] op_sel_hi:[1,1]
    v_cvt_pk_bf16_f32 v190, v228, v229
    v_cvt_pk_bf16_f32 v191, v230, v231
    s_waitcnt lgkmcnt(14)
    v_mfma_f32_16x16x32_bf16 v[192:195], a[128:131], v[128:131], 0
    s_waitcnt lgkmcnt(12)
    ds_read_b64_tr_b16 a[160:161], v29 offset:0
    v_mfma_f32_16x16x32_bf16 v[192:195], a[132:135], v[132:135], v[192:195]
    s_waitcnt lgkmcnt(11)
    ds_read_b64_tr_b16 a[162:163], v29 offset:4096
    v_mfma_f32_16x16x32_bf16 v[192:195], a[136:139], v[136:139], v[192:195]
    s_waitcnt lgkmcnt(10)
    ds_read_b64_tr_b16 a[164:165], v29 offset:8192
    v_lshrrev_b32 v2, 2, v0
    v_mfma_f32_16x16x32_bf16 v[192:195], a[140:143], v[140:143], v[192:195]
    s_waitcnt lgkmcnt(9)
    ds_read_b64_tr_b16 a[166:167], v29 offset:12288
    v_mfma_f32_16x16x32_bf16 v[192:195], a[144:147], v[144:147], v[192:195]
    s_waitcnt lgkmcnt(8)
    ds_read_b64_tr_b16 a[168:169], v29 offset:16384
    v_mfma_f32_16x16x32_bf16 v[192:195], a[148:151], v[148:151], v[192:195]
    s_waitcnt lgkmcnt(7)
    ds_read_b64_tr_b16 a[170:171], v29 offset:20480
    v_mfma_f32_16x16x32_bf16 v[192:195], a[152:155], v[152:155], v[192:195]
    s_waitcnt lgkmcnt(6)
    ds_read_b64_tr_b16 a[172:173], v29 offset:24576
    v_mfma_f32_16x16x32_bf16 v[192:195], a[156:159], v[156:159], v[192:195]
    ds_read_b64_tr_b16 a[174:175], v29 offset:28672
    v_mfma_f32_16x16x32_bf16 v[196:199], a[128:131], v[160:163], 0
    ds_read_b64_tr_b16 a[176:177], v33 offset:0
    v_mfma_f32_16x16x32_bf16 v[196:199], a[132:135], v[164:167], v[196:199]
    ds_read_b64_tr_b16 a[178:179], v33 offset:4096
    v_mfma_f32_16x16x32_bf16 v[196:199], a[136:139], v[168:171], v[196:199]
    ds_read_b64_tr_b16 a[180:181], v33 offset:8192
    v_mul_u32_u24 v2, 9216, v2
    v_mfma_f32_16x16x32_bf16 v[196:199], a[140:143], v[172:175], v[196:199]
    ds_read_b64_tr_b16 a[182:183], v33 offset:12288
    v_mfma_f32_16x16x32_bf16 v[196:199], a[144:147], v[176:179], v[196:199]
    ds_read_b64_tr_b16 a[184:185], v33 offset:16384
    v_cvt_pk_bf16_f32 v224, v192, v193
    v_mfma_f32_16x16x32_bf16 v[196:199], a[148:151], v[180:183], v[196:199]
    ds_read_b64_tr_b16 a[186:187], v33 offset:20480
    v_cvt_pk_bf16_f32 v225, v194, v195
    v_mfma_f32_16x16x32_bf16 v[196:199], a[152:155], v[184:187], v[196:199]
    ds_read_b64_tr_b16 a[188:189], v33 offset:24576
    v_mfma_f32_16x16x32_bf16 v[196:199], a[156:159], v[188:191], v[196:199]
    s_waitcnt lgkmcnt(13)
    ds_read_b64_tr_b16 a[190:191], v33 offset:28672
    v_mfma_f32_16x16x32_bf16 v[200:203], a[160:163], v[128:131], 0
    s_waitcnt lgkmcnt(12)
    ds_read_b64_tr_b16 a[128:129], v30 offset:0
    v_mfma_f32_16x16x32_bf16 v[200:203], a[164:167], v[132:135], v[200:203]
    s_waitcnt lgkmcnt(11)
    ds_read_b64_tr_b16 a[130:131], v30 offset:4096
    v_mfma_f32_16x16x32_bf16 v[200:203], a[168:171], v[136:139], v[200:203]
    s_waitcnt lgkmcnt(10)
    ds_read_b64_tr_b16 a[132:133], v30 offset:8192
    v_and_b32 v3, 3, v0
    v_mfma_f32_16x16x32_bf16 v[200:203], a[172:175], v[140:143], v[200:203]
    s_waitcnt lgkmcnt(9)
    ds_read_b64_tr_b16 a[134:135], v30 offset:12288
    v_mfma_f32_16x16x32_bf16 v[200:203], a[176:179], v[144:147], v[200:203]
    s_waitcnt lgkmcnt(8)
    ds_read_b64_tr_b16 a[136:137], v30 offset:16384
    v_cvt_pk_bf16_f32 v228, v196, v197
    v_mfma_f32_16x16x32_bf16 v[200:203], a[180:183], v[148:151], v[200:203]
    s_waitcnt lgkmcnt(7)
    ds_read_b64_tr_b16 a[138:139], v30 offset:20480
    v_cvt_pk_bf16_f32 v229, v198, v199
    v_mfma_f32_16x16x32_bf16 v[200:203], a[184:187], v[152:155], v[200:203]
    s_waitcnt lgkmcnt(6)
    ds_read_b64_tr_b16 a[140:141], v30 offset:24576
    v_mfma_f32_16x16x32_bf16 v[200:203], a[188:191], v[156:159], v[200:203]
    ds_read_b64_tr_b16 a[142:143], v30 offset:28672
    v_mfma_f32_16x16x32_bf16 v[204:207], a[160:163], v[160:163], 0
    ds_read_b64_tr_b16 a[144:145], v34 offset:0
    v_mfma_f32_16x16x32_bf16 v[204:207], a[164:167], v[164:167], v[204:207]
    ds_read_b64_tr_b16 a[146:147], v34 offset:4096
    v_mfma_f32_16x16x32_bf16 v[204:207], a[168:171], v[168:171], v[204:207]
    ds_read_b64_tr_b16 a[148:149], v34 offset:8192
    v_lshl_add_u32 v57, v3, 4, v2
    v_mfma_f32_16x16x32_bf16 v[204:207], a[172:175], v[172:175], v[204:207]
    ds_read_b64_tr_b16 a[150:151], v34 offset:12288
    v_mfma_f32_16x16x32_bf16 v[204:207], a[176:179], v[176:179], v[204:207]
    ds_read_b64_tr_b16 a[152:153], v34 offset:16384
    v_cvt_pk_bf16_f32 v226, v200, v201
    v_mfma_f32_16x16x32_bf16 v[204:207], a[180:183], v[180:183], v[204:207]
    s_add_u32 s38, s47, 0
    ds_read_b64_tr_b16 a[154:155], v34 offset:20480
    v_cvt_pk_bf16_f32 v227, v202, v203
    v_mfma_f32_16x16x32_bf16 v[204:207], a[184:187], v[184:187], v[204:207]
    ds_read_b64_tr_b16 a[156:157], v34 offset:24576
    buffer_store_dwordx4 v[224:227], v56, s[28:31], s38 offen sc1
    v_mfma_f32_16x16x32_bf16 v[204:207], a[188:191], v[188:191], v[204:207]
    s_waitcnt lgkmcnt(13)
    ds_read_b64_tr_b16 a[158:159], v34 offset:28672
    v_mfma_f32_16x16x32_bf16 v[192:195], a[128:131], v[128:131], 0
    s_waitcnt lgkmcnt(12)
    ds_read_b64_tr_b16 a[160:161], v31 offset:0
    v_mfma_f32_16x16x32_bf16 v[192:195], a[132:135], v[132:135], v[192:195]
    s_waitcnt lgkmcnt(11)
    ds_read_b64_tr_b16 a[162:163], v31 offset:4096
    v_mfma_f32_16x16x32_bf16 v[192:195], a[136:139], v[136:139], v[192:195]
    s_waitcnt lgkmcnt(10)
    ds_read_b64_tr_b16 a[164:165], v31 offset:8192
    v_lshlrev_b32 v62, 4, v0
    v_mfma_f32_16x16x32_bf16 v[192:195], a[140:143], v[140:143], v[192:195]
    s_waitcnt lgkmcnt(9)
    ds_read_b64_tr_b16 a[166:167], v31 offset:12288
    v_mfma_f32_16x16x32_bf16 v[192:195], a[144:147], v[144:147], v[192:195]
    s_waitcnt lgkmcnt(8)
    ds_read_b64_tr_b16 a[168:169], v31 offset:16384
    v_cvt_pk_bf16_f32 v230, v204, v205
    v_mfma_f32_16x16x32_bf16 v[192:195], a[148:151], v[148:151], v[192:195]
    s_waitcnt lgkmcnt(7)
    s_add_u32 s38, s47, 294912
    ds_read_b64_tr_b16 a[170:171], v31 offset:20480
    v_cvt_pk_bf16_f32 v231, v206, v207
    v_mfma_f32_16x16x32_bf16 v[192:195], a[152:155], v[152:155], v[192:195]
    s_waitcnt lgkmcnt(6)
    ds_read_b64_tr_b16 a[172:173], v31 offset:24576
    buffer_store_dwordx4 v[228:231], v56, s[28:31], s38 offen sc1
    v_mfma_f32_16x16x32_bf16 v[192:195], a[156:159], v[156:159], v[192:195]
    ds_read_b64_tr_b16 a[174:175], v31 offset:28672
    v_mfma_f32_16x16x32_bf16 v[196:199], a[128:131], v[160:163], 0
    ds_read_b64_tr_b16 a[176:177], v35 offset:0
    v_mfma_f32_16x16x32_bf16 v[196:199], a[132:135], v[164:167], v[196:199]
    ds_read_b64_tr_b16 a[178:179], v35 offset:4096
    v_mfma_f32_16x16x32_bf16 v[196:199], a[136:139], v[168:171], v[196:199]
    ds_read_b64_tr_b16 a[180:181], v35 offset:8192
    v_mfma_f32_16x16x32_bf16 v[196:199], a[140:143], v[172:175], v[196:199]
    ds_read_b64_tr_b16 a[182:183], v35 offset:12288
    v_mfma_f32_16x16x32_bf16 v[196:199], a[144:147], v[176:179], v[196:199]
    ds_read_b64_tr_b16 a[184:185], v35 offset:16384
    v_cvt_pk_bf16_f32 v232, v192, v193
    v_mfma_f32_16x16x32_bf16 v[196:199], a[148:151], v[180:183], v[196:199]
    ds_read_b64_tr_b16 a[186:187], v35 offset:20480
    v_cvt_pk_bf16_f32 v233, v194, v195
    v_mfma_f32_16x16x32_bf16 v[196:199], a[152:155], v[184:187], v[196:199]
    ds_read_b64_tr_b16 a[188:189], v35 offset:24576
    v_mfma_f32_16x16x32_bf16 v[196:199], a[156:159], v[188:191], v[196:199]
    s_waitcnt lgkmcnt(13)
    ds_read_b64_tr_b16 a[190:191], v35 offset:28672
    s_waitcnt vmcnt(14)
    s_barrier
    v_mfma_f32_16x16x32_bf16 v[200:203], a[160:163], v[128:131], 0
    s_waitcnt lgkmcnt(12)
    ds_read_b64_tr_b16 a[128:129], v12 offset:0
    v_mfma_f32_16x16x32_bf16 v[200:203], a[164:167], v[132:135], v[200:203]
    s_waitcnt lgkmcnt(11)
    s_add_u32 s49, s45, 74112
    ds_read_b64_tr_b16 a[130:131], v12 offset:4096
    v_mfma_f32_16x16x32_bf16 v[200:203], a[168:171], v[136:139], v[200:203]
    s_waitcnt lgkmcnt(10)
    s_add_u32 m0, s42, 81920
    ds_read_b64_tr_b16 a[132:133], v12 offset:8192
    v_mfma_f32_16x16x32_bf16 v[200:203], a[172:175], v[140:143], v[200:203]
    s_waitcnt lgkmcnt(9)
    ds_read_b64_tr_b16 a[134:135], v12 offset:12288
    buffer_load_dwordx4 v46, s[20:23], s49 offen lds
    v_mfma_f32_16x16x32_bf16 v[200:203], a[176:179], v[144:147], v[200:203]
    s_waitcnt lgkmcnt(8)
    ds_read_b64_tr_b16 a[136:137], v12 offset:16384
    v_cvt_pk_bf16_f32 v236, v196, v197
    v_mfma_f32_16x16x32_bf16 v[200:203], a[180:183], v[148:151], v[200:203]
    s_waitcnt lgkmcnt(7)
    ds_read_b64_tr_b16 a[138:139], v12 offset:20480
    v_cvt_pk_bf16_f32 v237, v198, v199
    v_mfma_f32_16x16x32_bf16 v[200:203], a[184:187], v[152:155], v[200:203]
    s_waitcnt lgkmcnt(6)
    ds_read_b64_tr_b16 a[140:141], v12 offset:24576
    v_mfma_f32_16x16x32_bf16 v[200:203], a[188:191], v[156:159], v[200:203]
    ds_read_b64_tr_b16 a[142:143], v12 offset:28672
    buffer_load_dwordx4 v47, s[20:23], s49 offen offset:1024 lds
    v_mfma_f32_16x16x32_bf16 v[204:207], a[160:163], v[160:163], 0
    ds_read_b64_tr_b16 a[144:145], v16 offset:0
    v_mfma_f32_16x16x32_bf16 v[204:207], a[164:167], v[164:167], v[204:207]
    ds_read_b64_tr_b16 a[146:147], v16 offset:4096
    v_mfma_f32_16x16x32_bf16 v[204:207], a[168:171], v[168:171], v[204:207]
    ds_read_b64_tr_b16 a[148:149], v16 offset:8192
    v_mfma_f32_16x16x32_bf16 v[204:207], a[172:175], v[172:175], v[204:207]
    ds_read_b64_tr_b16 a[150:151], v16 offset:12288
    buffer_load_dwordx4 v48, s[20:23], s49 offen offset:2048 lds
    v_mfma_f32_16x16x32_bf16 v[204:207], a[176:179], v[176:179], v[204:207]
    ds_read_b64_tr_b16 a[152:153], v16 offset:16384
    v_cvt_pk_bf16_f32 v234, v200, v201
    v_mfma_f32_16x16x32_bf16 v[204:207], a[180:183], v[180:183], v[204:207]
    s_add_u32 s38, s47, 128
    ds_read_b64_tr_b16 a[154:155], v16 offset:20480
    v_cvt_pk_bf16_f32 v235, v202, v203
    v_mfma_f32_16x16x32_bf16 v[204:207], a[184:187], v[184:187], v[204:207]
    ds_read_b64_tr_b16 a[156:157], v16 offset:24576
    buffer_store_dwordx4 v[232:235], v56, s[28:31], s38 offen sc1
    v_mfma_f32_16x16x32_bf16 v[204:207], a[188:191], v[188:191], v[204:207]
    s_waitcnt lgkmcnt(13)
    ds_read_b64_tr_b16 a[158:159], v16 offset:28672
    buffer_load_dwordx4 v49, s[20:23], s49 offen offset:3072 lds
    v_mfma_f32_16x16x32_bf16 v[192:195], a[128:131], v[128:131], 0
    s_waitcnt lgkmcnt(12)
    ds_read_b64_tr_b16 a[160:161], v13 offset:0
    v_mfma_f32_16x16x32_bf16 v[192:195], a[132:135], v[132:135], v[192:195]
    s_waitcnt lgkmcnt(11)
    s_add_u32 s49, s45, 512
    ds_read_b64_tr_b16 a[162:163], v13 offset:4096
    v_mfma_f32_16x16x32_bf16 v[192:195], a[136:139], v[136:139], v[192:195]
    s_waitcnt lgkmcnt(10)
    s_add_u32 m0, s42, 98304
    ds_read_b64_tr_b16 a[164:165], v13 offset:8192
    v_mfma_f32_16x16x32_bf16 v[192:195], a[140:143], v[140:143], v[192:195]
    s_waitcnt lgkmcnt(9)
    ds_read_b64_tr_b16 a[166:167], v13 offset:12288
    buffer_load_dwordx4 v46, s[20:23], s49 offen lds
    v_mfma_f32_16x16x32_bf16 v[192:195], a[144:147], v[144:147], v[192:195]
    s_waitcnt lgkmcnt(8)
    ds_read_b64_tr_b16 a[168:169], v13 offset:16384
    v_cvt_pk_bf16_f32 v238, v204, v205
    v_mfma_f32_16x16x32_bf16 v[192:195], a[148:151], v[148:151], v[192:195]
    s_waitcnt lgkmcnt(7)
    s_add_u32 s38, s47, 295040
    ds_read_b64_tr_b16 a[170:171], v13 offset:20480
    v_cvt_pk_bf16_f32 v239, v206, v207
    v_mfma_f32_16x16x32_bf16 v[192:195], a[152:155], v[152:155], v[192:195]
    s_waitcnt lgkmcnt(6)
    ds_read_b64_tr_b16 a[172:173], v13 offset:24576
    buffer_store_dwordx4 v[236:239], v56, s[28:31], s38 offen sc1
    v_mfma_f32_16x16x32_bf16 v[192:195], a[156:159], v[156:159], v[192:195]
    ds_read_b64_tr_b16 a[174:175], v13 offset:28672
    buffer_load_dwordx4 v47, s[20:23], s49 offen offset:1024 lds
    v_mfma_f32_16x16x32_bf16 v[196:199], a[128:131], v[160:163], 0
    ds_read_b64_tr_b16 a[176:177], v17 offset:0
    v_mfma_f32_16x16x32_bf16 v[196:199], a[132:135], v[164:167], v[196:199]
    ds_read_b64_tr_b16 a[178:179], v17 offset:4096
    v_mfma_f32_16x16x32_bf16 v[196:199], a[136:139], v[168:171], v[196:199]
    ds_read_b64_tr_b16 a[180:181], v17 offset:8192
    v_mfma_f32_16x16x32_bf16 v[196:199], a[140:143], v[172:175], v[196:199]
    ds_read_b64_tr_b16 a[182:183], v17 offset:12288
    buffer_load_dwordx4 v48, s[20:23], s49 offen offset:2048 lds
    v_mfma_f32_16x16x32_bf16 v[196:199], a[144:147], v[176:179], v[196:199]
    ds_read_b64_tr_b16 a[184:185], v17 offset:16384
    v_cvt_pk_bf16_f32 v224, v192, v193
    v_mfma_f32_16x16x32_bf16 v[196:199], a[148:151], v[180:183], v[196:199]
    ds_read_b64_tr_b16 a[186:187], v17 offset:20480
    v_cvt_pk_bf16_f32 v225, v194, v195
    v_mfma_f32_16x16x32_bf16 v[196:199], a[152:155], v[184:187], v[196:199]
    ds_read_b64_tr_b16 a[188:189], v17 offset:24576
    v_mfma_f32_16x16x32_bf16 v[196:199], a[156:159], v[188:191], v[196:199]
    s_waitcnt lgkmcnt(13)
    ds_read_b64_tr_b16 a[190:191], v17 offset:28672
    buffer_load_dwordx4 v49, s[20:23], s49 offen offset:3072 lds
    v_mfma_f32_16x16x32_bf16 v[200:203], a[160:163], v[128:131], 0
    s_waitcnt lgkmcnt(12)
    ds_read_b64_tr_b16 a[128:129], v14 offset:0
    v_mfma_f32_16x16x32_bf16 v[200:203], a[164:167], v[132:135], v[200:203]
    s_waitcnt lgkmcnt(11)
    s_add_u32 s49, s45, 74240
    ds_read_b64_tr_b16 a[130:131], v14 offset:4096
    v_mfma_f32_16x16x32_bf16 v[200:203], a[168:171], v[136:139], v[200:203]
    s_waitcnt lgkmcnt(10)
    s_add_u32 m0, s42, 114688
    ds_read_b64_tr_b16 a[132:133], v14 offset:8192
    v_mfma_f32_16x16x32_bf16 v[200:203], a[172:175], v[140:143], v[200:203]
    s_waitcnt lgkmcnt(9)
    ds_read_b64_tr_b16 a[134:135], v14 offset:12288
    buffer_load_dwordx4 v46, s[20:23], s49 offen lds
    v_mfma_f32_16x16x32_bf16 v[200:203], a[176:179], v[144:147], v[200:203]
    s_waitcnt lgkmcnt(8)
    ds_read_b64_tr_b16 a[136:137], v14 offset:16384
    v_cvt_pk_bf16_f32 v228, v196, v197
    v_mfma_f32_16x16x32_bf16 v[200:203], a[180:183], v[148:151], v[200:203]
    s_waitcnt lgkmcnt(7)
    ds_read_b64_tr_b16 a[138:139], v14 offset:20480
    v_cvt_pk_bf16_f32 v229, v198, v199
    v_mfma_f32_16x16x32_bf16 v[200:203], a[184:187], v[152:155], v[200:203]
    s_waitcnt lgkmcnt(6)
    ds_read_b64_tr_b16 a[140:141], v14 offset:24576
    v_mfma_f32_16x16x32_bf16 v[200:203], a[188:191], v[156:159], v[200:203]
    ds_read_b64_tr_b16 a[142:143], v14 offset:28672
    buffer_load_dwordx4 v47, s[20:23], s49 offen offset:1024 lds
    v_mfma_f32_16x16x32_bf16 v[204:207], a[160:163], v[160:163], 0
    ds_read_b64_tr_b16 a[144:145], v18 offset:0
    v_mfma_f32_16x16x32_bf16 v[204:207], a[164:167], v[164:167], v[204:207]
    ds_read_b64_tr_b16 a[146:147], v18 offset:4096
    v_mfma_f32_16x16x32_bf16 v[204:207], a[168:171], v[168:171], v[204:207]
    ds_read_b64_tr_b16 a[148:149], v18 offset:8192
    v_mfma_f32_16x16x32_bf16 v[204:207], a[172:175], v[172:175], v[204:207]
    ds_read_b64_tr_b16 a[150:151], v18 offset:12288
    buffer_load_dwordx4 v48, s[20:23], s49 offen offset:2048 lds
    v_mfma_f32_16x16x32_bf16 v[204:207], a[176:179], v[176:179], v[204:207]
    ds_read_b64_tr_b16 a[152:153], v18 offset:16384
    v_cvt_pk_bf16_f32 v226, v200, v201
    v_mfma_f32_16x16x32_bf16 v[204:207], a[180:183], v[180:183], v[204:207]
    s_add_u32 s38, s47, 256
    ds_read_b64_tr_b16 a[154:155], v18 offset:20480
    v_cvt_pk_bf16_f32 v227, v202, v203
    v_mfma_f32_16x16x32_bf16 v[204:207], a[184:187], v[184:187], v[204:207]
    ds_read_b64_tr_b16 a[156:157], v18 offset:24576
    buffer_store_dwordx4 v[224:227], v56, s[28:31], s38 offen sc1
    v_mfma_f32_16x16x32_bf16 v[204:207], a[188:191], v[188:191], v[204:207]
    s_waitcnt lgkmcnt(13)
    ds_read_b64_tr_b16 a[158:159], v18 offset:28672
    buffer_load_dwordx4 v49, s[20:23], s49 offen offset:3072 lds
    v_mfma_f32_16x16x32_bf16 v[192:195], a[128:131], v[128:131], 0
    s_waitcnt lgkmcnt(12)
    ds_read_b64_tr_b16 a[160:161], v15 offset:0
    v_mfma_f32_16x16x32_bf16 v[192:195], a[132:135], v[132:135], v[192:195]
    s_waitcnt lgkmcnt(11)
    ds_read_b64_tr_b16 a[162:163], v15 offset:4096
    v_mfma_f32_16x16x32_bf16 v[192:195], a[136:139], v[136:139], v[192:195]
    s_waitcnt lgkmcnt(10)
    ds_read_b64_tr_b16 a[164:165], v15 offset:8192
    v_mfma_f32_16x16x32_bf16 v[192:195], a[140:143], v[140:143], v[192:195]
    s_waitcnt lgkmcnt(9)
    ds_read_b64_tr_b16 a[166:167], v15 offset:12288
    v_mfma_f32_16x16x32_bf16 v[192:195], a[144:147], v[144:147], v[192:195]
    s_waitcnt lgkmcnt(8)
    ds_read_b64_tr_b16 a[168:169], v15 offset:16384
    v_cvt_pk_bf16_f32 v230, v204, v205
    v_mfma_f32_16x16x32_bf16 v[192:195], a[148:151], v[148:151], v[192:195]
    s_waitcnt lgkmcnt(7)
    s_add_u32 s38, s47, 295168
    ds_read_b64_tr_b16 a[170:171], v15 offset:20480
    v_cvt_pk_bf16_f32 v231, v206, v207
    v_mfma_f32_16x16x32_bf16 v[192:195], a[152:155], v[152:155], v[192:195]
    s_waitcnt lgkmcnt(6)
    ds_read_b64_tr_b16 a[172:173], v15 offset:24576
    buffer_store_dwordx4 v[228:231], v56, s[28:31], s38 offen sc1
    v_mfma_f32_16x16x32_bf16 v[192:195], a[156:159], v[156:159], v[192:195]
    ds_read_b64_tr_b16 a[174:175], v15 offset:28672
    v_mfma_f32_16x16x32_bf16 v[196:199], a[128:131], v[160:163], 0
    ds_read_b64_tr_b16 a[176:177], v19 offset:0
    v_mfma_f32_16x16x32_bf16 v[196:199], a[132:135], v[164:167], v[196:199]
    ds_read_b64_tr_b16 a[178:179], v19 offset:4096
    v_mfma_f32_16x16x32_bf16 v[196:199], a[136:139], v[168:171], v[196:199]
    ds_read_b64_tr_b16 a[180:181], v19 offset:8192
    v_mfma_f32_16x16x32_bf16 v[196:199], a[140:143], v[172:175], v[196:199]
    ds_read_b64_tr_b16 a[182:183], v19 offset:12288
    v_mfma_f32_16x16x32_bf16 v[196:199], a[144:147], v[176:179], v[196:199]
    ds_read_b64_tr_b16 a[184:185], v19 offset:16384
    v_cvt_pk_bf16_f32 v232, v192, v193
    v_mfma_f32_16x16x32_bf16 v[196:199], a[148:151], v[180:183], v[196:199]
    ds_read_b64_tr_b16 a[186:187], v19 offset:20480
    v_cvt_pk_bf16_f32 v233, v194, v195
    v_mfma_f32_16x16x32_bf16 v[196:199], a[152:155], v[184:187], v[196:199]
    ds_read_b64_tr_b16 a[188:189], v19 offset:24576
    v_mfma_f32_16x16x32_bf16 v[196:199], a[156:159], v[188:191], v[196:199]
    s_waitcnt lgkmcnt(13)
    ds_read_b64_tr_b16 a[190:191], v19 offset:28672
    s_waitcnt vmcnt(22)
    s_barrier
    v_mfma_f32_16x16x32_bf16 v[200:203], a[160:163], v[128:131], 0
    s_waitcnt lgkmcnt(12)
    ds_read_b64_tr_b16 a[128:129], v12 offset:32768
    v_mfma_f32_16x16x32_bf16 v[200:203], a[164:167], v[132:135], v[200:203]
    s_waitcnt lgkmcnt(11)
    s_add_u32 s49, s45, 640
    ds_read_b64_tr_b16 a[130:131], v12 offset:36864
    v_mfma_f32_16x16x32_bf16 v[200:203], a[168:171], v[136:139], v[200:203]
    s_waitcnt lgkmcnt(10)
    s_add_u32 m0, s42, 131072
    ds_read_b64_tr_b16 a[132:133], v12 offset:40960
    v_mfma_f32_16x16x32_bf16 v[200:203], a[172:175], v[140:143], v[200:203]
    s_waitcnt lgkmcnt(9)
    ds_read_b64_tr_b16 a[134:135], v12 offset:45056
    buffer_load_dwordx4 v46, s[20:23], s49 offen lds
    v_mfma_f32_16x16x32_bf16 v[200:203], a[176:179], v[144:147], v[200:203]
    s_waitcnt lgkmcnt(8)
    ds_read_b64_tr_b16 a[136:137], v12 offset:49152
    v_cvt_pk_bf16_f32 v236, v196, v197
    v_mfma_f32_16x16x32_bf16 v[200:203], a[180:183], v[148:151], v[200:203]
    s_waitcnt lgkmcnt(7)
    ds_read_b64_tr_b16 a[138:139], v12 offset:53248
    v_cvt_pk_bf16_f32 v237, v198, v199
    v_mfma_f32_16x16x32_bf16 v[200:203], a[184:187], v[152:155], v[200:203]
    s_waitcnt lgkmcnt(6)
    ds_read_b64_tr_b16 a[140:141], v12 offset:57344
    v_mfma_f32_16x16x32_bf16 v[200:203], a[188:191], v[156:159], v[200:203]
    ds_read_b64_tr_b16 a[142:143], v12 offset:61440
    buffer_load_dwordx4 v47, s[20:23], s49 offen offset:1024 lds
    v_mfma_f32_16x16x32_bf16 v[204:207], a[160:163], v[160:163], 0
    ds_read_b64_tr_b16 a[144:145], v16 offset:32768
    v_mfma_f32_16x16x32_bf16 v[204:207], a[164:167], v[164:167], v[204:207]
    ds_read_b64_tr_b16 a[146:147], v16 offset:36864
    v_mfma_f32_16x16x32_bf16 v[204:207], a[168:171], v[168:171], v[204:207]
    ds_read_b64_tr_b16 a[148:149], v16 offset:40960
    v_mfma_f32_16x16x32_bf16 v[204:207], a[172:175], v[172:175], v[204:207]
    ds_read_b64_tr_b16 a[150:151], v16 offset:45056
    buffer_load_dwordx4 v48, s[20:23], s49 offen offset:2048 lds
    v_mfma_f32_16x16x32_bf16 v[204:207], a[176:179], v[176:179], v[204:207]
    ds_read_b64_tr_b16 a[152:153], v16 offset:49152
    v_cvt_pk_bf16_f32 v234, v200, v201
    v_mfma_f32_16x16x32_bf16 v[204:207], a[180:183], v[180:183], v[204:207]
    s_add_u32 s38, s47, 384
    ds_read_b64_tr_b16 a[154:155], v16 offset:53248
    v_cvt_pk_bf16_f32 v235, v202, v203
    v_mfma_f32_16x16x32_bf16 v[204:207], a[184:187], v[184:187], v[204:207]
    ds_read_b64_tr_b16 a[156:157], v16 offset:57344
    buffer_store_dwordx4 v[232:235], v56, s[28:31], s38 offen sc1
    v_mfma_f32_16x16x32_bf16 v[204:207], a[188:191], v[188:191], v[204:207]
    s_waitcnt lgkmcnt(13)
    ds_read_b64_tr_b16 a[158:159], v16 offset:61440
    buffer_load_dwordx4 v49, s[20:23], s49 offen offset:3072 lds
    v_mfma_f32_16x16x32_bf16 v[192:195], a[128:131], v[128:131], 0
    s_waitcnt lgkmcnt(12)
    ds_read_b64_tr_b16 a[160:161], v13 offset:32768
    v_mfma_f32_16x16x32_bf16 v[192:195], a[132:135], v[132:135], v[192:195]
    s_waitcnt lgkmcnt(11)
    s_add_u32 s49, s45, 74368
    ds_read_b64_tr_b16 a[162:163], v13 offset:36864
    v_mfma_f32_16x16x32_bf16 v[192:195], a[136:139], v[136:139], v[192:195]
    s_waitcnt lgkmcnt(10)
    s_add_u32 m0, s42, 147456
    ds_read_b64_tr_b16 a[164:165], v13 offset:40960
    v_mfma_f32_16x16x32_bf16 v[192:195], a[140:143], v[140:143], v[192:195]
    s_waitcnt lgkmcnt(9)
    ds_read_b64_tr_b16 a[166:167], v13 offset:45056
    buffer_load_dwordx4 v46, s[20:23], s49 offen lds
    v_mfma_f32_16x16x32_bf16 v[192:195], a[144:147], v[144:147], v[192:195]
    s_waitcnt lgkmcnt(8)
    ds_read_b64_tr_b16 a[168:169], v13 offset:49152
    v_cvt_pk_bf16_f32 v238, v204, v205
    v_mfma_f32_16x16x32_bf16 v[192:195], a[148:151], v[148:151], v[192:195]
    s_waitcnt lgkmcnt(7)
    s_add_u32 s38, s47, 295296
    ds_read_b64_tr_b16 a[170:171], v13 offset:53248
    v_cvt_pk_bf16_f32 v239, v206, v207
    v_mfma_f32_16x16x32_bf16 v[192:195], a[152:155], v[152:155], v[192:195]
    s_waitcnt lgkmcnt(6)
    ds_read_b64_tr_b16 a[172:173], v13 offset:57344
    buffer_store_dwordx4 v[236:239], v56, s[28:31], s38 offen sc1
    v_mfma_f32_16x16x32_bf16 v[192:195], a[156:159], v[156:159], v[192:195]
    ds_read_b64_tr_b16 a[174:175], v13 offset:61440
    buffer_load_dwordx4 v47, s[20:23], s49 offen offset:1024 lds
    v_mfma_f32_16x16x32_bf16 v[196:199], a[128:131], v[160:163], 0
    ds_read_b64_tr_b16 a[176:177], v17 offset:32768
    v_mfma_f32_16x16x32_bf16 v[196:199], a[132:135], v[164:167], v[196:199]
    ds_read_b64_tr_b16 a[178:179], v17 offset:36864
    v_mfma_f32_16x16x32_bf16 v[196:199], a[136:139], v[168:171], v[196:199]
    ds_read_b64_tr_b16 a[180:181], v17 offset:40960
    v_mfma_f32_16x16x32_bf16 v[196:199], a[140:143], v[172:175], v[196:199]
    ds_read_b64_tr_b16 a[182:183], v17 offset:45056
    buffer_load_dwordx4 v48, s[20:23], s49 offen offset:2048 lds
    v_mfma_f32_16x16x32_bf16 v[196:199], a[144:147], v[176:179], v[196:199]
    ds_read_b64_tr_b16 a[184:185], v17 offset:49152
    v_cvt_pk_bf16_f32 v224, v192, v193
    v_mfma_f32_16x16x32_bf16 v[196:199], a[148:151], v[180:183], v[196:199]
    ds_read_b64_tr_b16 a[186:187], v17 offset:53248
    v_cvt_pk_bf16_f32 v225, v194, v195
    v_mfma_f32_16x16x32_bf16 v[196:199], a[152:155], v[184:187], v[196:199]
    ds_read_b64_tr_b16 a[188:189], v17 offset:57344
    v_mfma_f32_16x16x32_bf16 v[196:199], a[156:159], v[188:191], v[196:199]
    s_waitcnt lgkmcnt(13)
    ds_read_b64_tr_b16 a[190:191], v17 offset:61440
    buffer_load_dwordx4 v49, s[20:23], s49 offen offset:3072 lds
    v_mfma_f32_16x16x32_bf16 v[200:203], a[160:163], v[128:131], 0
    s_waitcnt lgkmcnt(12)
    ds_read_b64_tr_b16 a[128:129], v14 offset:32768
    v_mfma_f32_16x16x32_bf16 v[200:203], a[164:167], v[132:135], v[200:203]
    s_waitcnt lgkmcnt(11)
    ds_read_b64_tr_b16 a[130:131], v14 offset:36864
    v_mfma_f32_16x16x32_bf16 v[200:203], a[168:171], v[136:139], v[200:203]
    s_waitcnt lgkmcnt(10)
    ds_read_b64_tr_b16 a[132:133], v14 offset:40960
    v_mfma_f32_16x16x32_bf16 v[200:203], a[172:175], v[140:143], v[200:203]
    s_waitcnt lgkmcnt(9)
    ds_read_b64_tr_b16 a[134:135], v14 offset:45056
    v_mfma_f32_16x16x32_bf16 v[200:203], a[176:179], v[144:147], v[200:203]
    s_waitcnt lgkmcnt(8)
    ds_read_b64_tr_b16 a[136:137], v14 offset:49152
    v_cvt_pk_bf16_f32 v228, v196, v197
    v_mfma_f32_16x16x32_bf16 v[200:203], a[180:183], v[148:151], v[200:203]
    s_waitcnt lgkmcnt(7)
    ds_read_b64_tr_b16 a[138:139], v14 offset:53248
    v_cvt_pk_bf16_f32 v229, v198, v199
    v_mfma_f32_16x16x32_bf16 v[200:203], a[184:187], v[152:155], v[200:203]
    s_waitcnt lgkmcnt(6)
    ds_read_b64_tr_b16 a[140:141], v14 offset:57344
    v_mfma_f32_16x16x32_bf16 v[200:203], a[188:191], v[156:159], v[200:203]
    ds_read_b64_tr_b16 a[142:143], v14 offset:61440
    v_mfma_f32_16x16x32_bf16 v[204:207], a[160:163], v[160:163], 0
    ds_read_b64_tr_b16 a[144:145], v18 offset:32768
    v_mfma_f32_16x16x32_bf16 v[204:207], a[164:167], v[164:167], v[204:207]
    ds_read_b64_tr_b16 a[146:147], v18 offset:36864
    v_mfma_f32_16x16x32_bf16 v[204:207], a[168:171], v[168:171], v[204:207]
    ds_read_b64_tr_b16 a[148:149], v18 offset:40960
    v_mfma_f32_16x16x32_bf16 v[204:207], a[172:175], v[172:175], v[204:207]
    ds_read_b64_tr_b16 a[150:151], v18 offset:45056
    v_mfma_f32_16x16x32_bf16 v[204:207], a[176:179], v[176:179], v[204:207]
    ds_read_b64_tr_b16 a[152:153], v18 offset:49152
    v_cvt_pk_bf16_f32 v226, v200, v201
    v_mfma_f32_16x16x32_bf16 v[204:207], a[180:183], v[180:183], v[204:207]
    s_add_u32 s38, s47, 512
    ds_read_b64_tr_b16 a[154:155], v18 offset:53248
    v_cvt_pk_bf16_f32 v227, v202, v203
    v_mfma_f32_16x16x32_bf16 v[204:207], a[184:187], v[184:187], v[204:207]
    ds_read_b64_tr_b16 a[156:157], v18 offset:57344
    buffer_store_dwordx4 v[224:227], v56, s[28:31], s38 offen sc1
    v_mfma_f32_16x16x32_bf16 v[204:207], a[188:191], v[188:191], v[204:207]
    s_waitcnt lgkmcnt(13)
    ds_read_b64_tr_b16 a[158:159], v18 offset:61440
    v_mfma_f32_16x16x32_bf16 v[192:195], a[128:131], v[128:131], 0
    s_waitcnt lgkmcnt(12)
    ds_read_b64_tr_b16 a[160:161], v15 offset:32768
    v_mfma_f32_16x16x32_bf16 v[192:195], a[132:135], v[132:135], v[192:195]
    s_waitcnt lgkmcnt(11)
    ds_read_b64_tr_b16 a[162:163], v15 offset:36864
    v_mfma_f32_16x16x32_bf16 v[192:195], a[136:139], v[136:139], v[192:195]
    s_waitcnt lgkmcnt(10)
    ds_read_b64_tr_b16 a[164:165], v15 offset:40960
    v_mfma_f32_16x16x32_bf16 v[192:195], a[140:143], v[140:143], v[192:195]
    s_waitcnt lgkmcnt(9)
    ds_read_b64_tr_b16 a[166:167], v15 offset:45056
    v_mfma_f32_16x16x32_bf16 v[192:195], a[144:147], v[144:147], v[192:195]
    s_waitcnt lgkmcnt(8)
    ds_read_b64_tr_b16 a[168:169], v15 offset:49152
    v_cvt_pk_bf16_f32 v230, v204, v205
    v_mfma_f32_16x16x32_bf16 v[192:195], a[148:151], v[148:151], v[192:195]
    s_waitcnt lgkmcnt(7)
    s_add_u32 s38, s47, 295424
    ds_read_b64_tr_b16 a[170:171], v15 offset:53248
    v_cvt_pk_bf16_f32 v231, v206, v207
    v_mfma_f32_16x16x32_bf16 v[192:195], a[152:155], v[152:155], v[192:195]
    s_waitcnt lgkmcnt(6)
    ds_read_b64_tr_b16 a[172:173], v15 offset:57344
    buffer_store_dwordx4 v[228:231], v56, s[28:31], s38 offen sc1
    v_mfma_f32_16x16x32_bf16 v[192:195], a[156:159], v[156:159], v[192:195]
    ds_read_b64_tr_b16 a[174:175], v15 offset:61440
    v_mfma_f32_16x16x32_bf16 v[196:199], a[128:131], v[160:163], 0
    ds_read_b64_tr_b16 a[176:177], v19 offset:32768
    v_mfma_f32_16x16x32_bf16 v[196:199], a[132:135], v[164:167], v[196:199]
    ds_read_b64_tr_b16 a[178:179], v19 offset:36864
    v_mfma_f32_16x16x32_bf16 v[196:199], a[136:139], v[168:171], v[196:199]
    ds_read_b64_tr_b16 a[180:181], v19 offset:40960
    v_mfma_f32_16x16x32_bf16 v[196:199], a[140:143], v[172:175], v[196:199]
    ds_read_b64_tr_b16 a[182:183], v19 offset:45056
    v_mfma_f32_16x16x32_bf16 v[196:199], a[144:147], v[176:179], v[196:199]
    ds_read_b64_tr_b16 a[184:185], v19 offset:49152
    v_cvt_pk_bf16_f32 v232, v192, v193
    v_mfma_f32_16x16x32_bf16 v[196:199], a[148:151], v[180:183], v[196:199]
    ds_read_b64_tr_b16 a[186:187], v19 offset:53248
    v_cvt_pk_bf16_f32 v233, v194, v195
    v_mfma_f32_16x16x32_bf16 v[196:199], a[152:155], v[184:187], v[196:199]
    ds_read_b64_tr_b16 a[188:189], v19 offset:57344
    v_mfma_f32_16x16x32_bf16 v[196:199], a[156:159], v[188:191], v[196:199]
    s_waitcnt lgkmcnt(13)
    ds_read_b64_tr_b16 a[190:191], v19 offset:61440
    s_waitcnt vmcnt(23)
    s_barrier
    v_mfma_f32_16x16x32_bf16 v[200:203], a[160:163], v[128:131], 0
    s_waitcnt lgkmcnt(12)
    ds_read_b64_tr_b16 a[128:129], v20 offset:0
    v_mfma_f32_16x16x32_bf16 v[200:203], a[164:167], v[132:135], v[200:203]
    s_waitcnt lgkmcnt(11)
    s_add_u32 s49, s45, 768
    ds_read_b64_tr_b16 a[130:131], v20 offset:4096
    v_mfma_f32_16x16x32_bf16 v[200:203], a[168:171], v[136:139], v[200:203]
    s_waitcnt lgkmcnt(10)
    s_add_u32 m0, s42, 0
    ds_read_b64_tr_b16 a[132:133], v20 offset:8192
    v_mfma_f32_16x16x32_bf16 v[200:203], a[172:175], v[140:143], v[200:203]
    s_waitcnt lgkmcnt(9)
    ds_read_b64_tr_b16 a[134:135], v20 offset:12288
    buffer_load_dwordx4 v46, s[20:23], s49 offen lds
    v_mfma_f32_16x16x32_bf16 v[200:203], a[176:179], v[144:147], v[200:203]
    s_waitcnt lgkmcnt(8)
    ds_read_b64_tr_b16 a[136:137], v20 offset:16384
    v_cvt_pk_bf16_f32 v236, v196, v197
    v_mfma_f32_16x16x32_bf16 v[200:203], a[180:183], v[148:151], v[200:203]
    s_waitcnt lgkmcnt(7)
    ds_read_b64_tr_b16 a[138:139], v20 offset:20480
    v_cvt_pk_bf16_f32 v237, v198, v199
    v_mfma_f32_16x16x32_bf16 v[200:203], a[184:187], v[152:155], v[200:203]
    s_waitcnt lgkmcnt(6)
    ds_read_b64_tr_b16 a[140:141], v20 offset:24576
    v_mfma_f32_16x16x32_bf16 v[200:203], a[188:191], v[156:159], v[200:203]
    ds_read_b64_tr_b16 a[142:143], v20 offset:28672
    buffer_load_dwordx4 v47, s[20:23], s49 offen offset:1024 lds
    v_mfma_f32_16x16x32_bf16 v[204:207], a[160:163], v[160:163], 0
    ds_read_b64_tr_b16 a[144:145], v24 offset:0
    v_mfma_f32_16x16x32_bf16 v[204:207], a[164:167], v[164:167], v[204:207]
    ds_read_b64_tr_b16 a[146:147], v24 offset:4096
    v_mfma_f32_16x16x32_bf16 v[204:207], a[168:171], v[168:171], v[204:207]
    ds_read_b64_tr_b16 a[148:149], v24 offset:8192
    v_mfma_f32_16x16x32_bf16 v[204:207], a[172:175], v[172:175], v[204:207]
    ds_read_b64_tr_b16 a[150:151], v24 offset:12288
    buffer_load_dwordx4 v48, s[20:23], s49 offen offset:2048 lds
    v_mfma_f32_16x16x32_bf16 v[204:207], a[176:179], v[176:179], v[204:207]
    ds_read_b64_tr_b16 a[152:153], v24 offset:16384
    v_cvt_pk_bf16_f32 v234, v200, v201
    v_mfma_f32_16x16x32_bf16 v[204:207], a[180:183], v[180:183], v[204:207]
    s_add_u32 s38, s47, 640
    ds_read_b64_tr_b16 a[154:155], v24 offset:20480
    v_cvt_pk_bf16_f32 v235, v202, v203
    v_mfma_f32_16x16x32_bf16 v[204:207], a[184:187], v[184:187], v[204:207]
    ds_read_b64_tr_b16 a[156:157], v24 offset:24576
    buffer_store_dwordx4 v[232:235], v56, s[28:31], s38 offen sc1
    v_mfma_f32_16x16x32_bf16 v[204:207], a[188:191], v[188:191], v[204:207]
    s_waitcnt lgkmcnt(13)
    ds_read_b64_tr_b16 a[158:159], v24 offset:28672
    buffer_load_dwordx4 v49, s[20:23], s49 offen offset:3072 lds
    v_mfma_f32_16x16x32_bf16 v[192:195], a[128:131], v[128:131], 0
    s_waitcnt lgkmcnt(12)
    ds_read_b64_tr_b16 a[160:161], v21 offset:0
    v_mfma_f32_16x16x32_bf16 v[192:195], a[132:135], v[132:135], v[192:195]
    s_waitcnt lgkmcnt(11)
    s_add_u32 s49, s45, 74496
    ds_read_b64_tr_b16 a[162:163], v21 offset:4096
    v_mfma_f32_16x16x32_bf16 v[192:195], a[136:139], v[136:139], v[192:195]
    s_waitcnt lgkmcnt(10)
    s_add_u32 m0, s42, 16384
    ds_read_b64_tr_b16 a[164:165], v21 offset:8192
    v_mfma_f32_16x16x32_bf16 v[192:195], a[140:143], v[140:143], v[192:195]
    s_waitcnt lgkmcnt(9)
    ds_read_b64_tr_b16 a[166:167], v21 offset:12288
    buffer_load_dwordx4 v46, s[20:23], s49 offen lds
    v_mfma_f32_16x16x32_bf16 v[192:195], a[144:147], v[144:147], v[192:195]
    s_waitcnt lgkmcnt(8)
    ds_read_b64_tr_b16 a[168:169], v21 offset:16384
    v_cvt_pk_bf16_f32 v238, v204, v205
    v_mfma_f32_16x16x32_bf16 v[192:195], a[148:151], v[148:151], v[192:195]
    s_waitcnt lgkmcnt(7)
    s_add_u32 s38, s47, 295552
    ds_read_b64_tr_b16 a[170:171], v21 offset:20480
    v_cvt_pk_bf16_f32 v239, v206, v207
    v_mfma_f32_16x16x32_bf16 v[192:195], a[152:155], v[152:155], v[192:195]
    s_waitcnt lgkmcnt(6)
    ds_read_b64_tr_b16 a[172:173], v21 offset:24576
    buffer_store_dwordx4 v[236:239], v56, s[28:31], s38 offen sc1
    v_mfma_f32_16x16x32_bf16 v[192:195], a[156:159], v[156:159], v[192:195]
    ds_read_b64_tr_b16 a[174:175], v21 offset:28672
    buffer_load_dwordx4 v47, s[20:23], s49 offen offset:1024 lds
    v_mfma_f32_16x16x32_bf16 v[196:199], a[128:131], v[160:163], 0
    ds_read_b64_tr_b16 a[176:177], v25 offset:0
    v_mfma_f32_16x16x32_bf16 v[196:199], a[132:135], v[164:167], v[196:199]
    ds_read_b64_tr_b16 a[178:179], v25 offset:4096
    v_mfma_f32_16x16x32_bf16 v[196:199], a[136:139], v[168:171], v[196:199]
    ds_read_b64_tr_b16 a[180:181], v25 offset:8192
    v_mfma_f32_16x16x32_bf16 v[196:199], a[140:143], v[172:175], v[196:199]
    ds_read_b64_tr_b16 a[182:183], v25 offset:12288
    buffer_load_dwordx4 v48, s[20:23], s49 offen offset:2048 lds
    v_mfma_f32_16x16x32_bf16 v[196:199], a[144:147], v[176:179], v[196:199]
    ds_read_b64_tr_b16 a[184:185], v25 offset:16384
    v_cvt_pk_bf16_f32 v224, v192, v193
    v_mfma_f32_16x16x32_bf16 v[196:199], a[148:151], v[180:183], v[196:199]
    ds_read_b64_tr_b16 a[186:187], v25 offset:20480
    v_cvt_pk_bf16_f32 v225, v194, v195
    v_mfma_f32_16x16x32_bf16 v[196:199], a[152:155], v[184:187], v[196:199]
    ds_read_b64_tr_b16 a[188:189], v25 offset:24576
    v_mfma_f32_16x16x32_bf16 v[196:199], a[156:159], v[188:191], v[196:199]
    s_waitcnt lgkmcnt(13)
    ds_read_b64_tr_b16 a[190:191], v25 offset:28672
    buffer_load_dwordx4 v49, s[20:23], s49 offen offset:3072 lds
    v_mfma_f32_16x16x32_bf16 v[200:203], a[160:163], v[128:131], 0
    s_waitcnt lgkmcnt(12)
    ds_read_b64_tr_b16 a[128:129], v22 offset:0
    v_mfma_f32_16x16x32_bf16 v[200:203], a[164:167], v[132:135], v[200:203]
    s_waitcnt lgkmcnt(11)
    ds_read_b64_tr_b16 a[130:131], v22 offset:4096
    v_mfma_f32_16x16x32_bf16 v[200:203], a[168:171], v[136:139], v[200:203]
    s_waitcnt lgkmcnt(10)
    ds_read_b64_tr_b16 a[132:133], v22 offset:8192
    v_mfma_f32_16x16x32_bf16 v[200:203], a[172:175], v[140:143], v[200:203]
    s_waitcnt lgkmcnt(9)
    ds_read_b64_tr_b16 a[134:135], v22 offset:12288
    v_mfma_f32_16x16x32_bf16 v[200:203], a[176:179], v[144:147], v[200:203]
    s_waitcnt lgkmcnt(8)
    ds_read_b64_tr_b16 a[136:137], v22 offset:16384
    v_cvt_pk_bf16_f32 v228, v196, v197
    v_mfma_f32_16x16x32_bf16 v[200:203], a[180:183], v[148:151], v[200:203]
    s_waitcnt lgkmcnt(7)
    ds_read_b64_tr_b16 a[138:139], v22 offset:20480
    v_cvt_pk_bf16_f32 v229, v198, v199
    v_mfma_f32_16x16x32_bf16 v[200:203], a[184:187], v[152:155], v[200:203]
    s_waitcnt lgkmcnt(6)
    ds_read_b64_tr_b16 a[140:141], v22 offset:24576
    v_mfma_f32_16x16x32_bf16 v[200:203], a[188:191], v[156:159], v[200:203]
    ds_read_b64_tr_b16 a[142:143], v22 offset:28672
    v_mfma_f32_16x16x32_bf16 v[204:207], a[160:163], v[160:163], 0
    ds_read_b64_tr_b16 a[144:145], v26 offset:0
    v_mfma_f32_16x16x32_bf16 v[204:207], a[164:167], v[164:167], v[204:207]
    ds_read_b64_tr_b16 a[146:147], v26 offset:4096
    v_mfma_f32_16x16x32_bf16 v[204:207], a[168:171], v[168:171], v[204:207]
    ds_read_b64_tr_b16 a[148:149], v26 offset:8192
    v_mfma_f32_16x16x32_bf16 v[204:207], a[172:175], v[172:175], v[204:207]
    ds_read_b64_tr_b16 a[150:151], v26 offset:12288
    v_mfma_f32_16x16x32_bf16 v[204:207], a[176:179], v[176:179], v[204:207]
    ds_read_b64_tr_b16 a[152:153], v26 offset:16384
    v_cvt_pk_bf16_f32 v226, v200, v201
    v_mfma_f32_16x16x32_bf16 v[204:207], a[180:183], v[180:183], v[204:207]
    s_add_u32 s38, s47, 768
    ds_read_b64_tr_b16 a[154:155], v26 offset:20480
    v_cvt_pk_bf16_f32 v227, v202, v203
    v_mfma_f32_16x16x32_bf16 v[204:207], a[184:187], v[184:187], v[204:207]
    ds_read_b64_tr_b16 a[156:157], v26 offset:24576
    buffer_store_dwordx4 v[224:227], v56, s[28:31], s38 offen sc1
    v_mfma_f32_16x16x32_bf16 v[204:207], a[188:191], v[188:191], v[204:207]
    s_waitcnt lgkmcnt(13)
    ds_read_b64_tr_b16 a[158:159], v26 offset:28672
    v_mfma_f32_16x16x32_bf16 v[192:195], a[128:131], v[128:131], 0
    s_waitcnt lgkmcnt(12)
    ds_read_b64_tr_b16 a[160:161], v23 offset:0
    v_mfma_f32_16x16x32_bf16 v[192:195], a[132:135], v[132:135], v[192:195]
    s_waitcnt lgkmcnt(11)
    ds_read_b64_tr_b16 a[162:163], v23 offset:4096
    v_mfma_f32_16x16x32_bf16 v[192:195], a[136:139], v[136:139], v[192:195]
    s_waitcnt lgkmcnt(10)
    ds_read_b64_tr_b16 a[164:165], v23 offset:8192
    v_mfma_f32_16x16x32_bf16 v[192:195], a[140:143], v[140:143], v[192:195]
    s_waitcnt lgkmcnt(9)
    ds_read_b64_tr_b16 a[166:167], v23 offset:12288
    v_mfma_f32_16x16x32_bf16 v[192:195], a[144:147], v[144:147], v[192:195]
    s_waitcnt lgkmcnt(8)
    ds_read_b64_tr_b16 a[168:169], v23 offset:16384
    v_cvt_pk_bf16_f32 v230, v204, v205
    v_mfma_f32_16x16x32_bf16 v[192:195], a[148:151], v[148:151], v[192:195]
    s_waitcnt lgkmcnt(7)
    s_add_u32 s38, s47, 295680
    ds_read_b64_tr_b16 a[170:171], v23 offset:20480
    v_cvt_pk_bf16_f32 v231, v206, v207
    v_mfma_f32_16x16x32_bf16 v[192:195], a[152:155], v[152:155], v[192:195]
    s_waitcnt lgkmcnt(6)
    ds_read_b64_tr_b16 a[172:173], v23 offset:24576
    buffer_store_dwordx4 v[228:231], v56, s[28:31], s38 offen sc1
    v_mfma_f32_16x16x32_bf16 v[192:195], a[156:159], v[156:159], v[192:195]
    ds_read_b64_tr_b16 a[174:175], v23 offset:28672
    v_mfma_f32_16x16x32_bf16 v[196:199], a[128:131], v[160:163], 0
    ds_read_b64_tr_b16 a[176:177], v27 offset:0
    v_mfma_f32_16x16x32_bf16 v[196:199], a[132:135], v[164:167], v[196:199]
    ds_read_b64_tr_b16 a[178:179], v27 offset:4096
    v_mfma_f32_16x16x32_bf16 v[196:199], a[136:139], v[168:171], v[196:199]
    ds_read_b64_tr_b16 a[180:181], v27 offset:8192
    v_mfma_f32_16x16x32_bf16 v[196:199], a[140:143], v[172:175], v[196:199]
    ds_read_b64_tr_b16 a[182:183], v27 offset:12288
    v_mfma_f32_16x16x32_bf16 v[196:199], a[144:147], v[176:179], v[196:199]
    ds_read_b64_tr_b16 a[184:185], v27 offset:16384
    v_cvt_pk_bf16_f32 v232, v192, v193
    v_mfma_f32_16x16x32_bf16 v[196:199], a[148:151], v[180:183], v[196:199]
    ds_read_b64_tr_b16 a[186:187], v27 offset:20480
    v_cvt_pk_bf16_f32 v233, v194, v195
    v_mfma_f32_16x16x32_bf16 v[196:199], a[152:155], v[184:187], v[196:199]
    ds_read_b64_tr_b16 a[188:189], v27 offset:24576
    v_mfma_f32_16x16x32_bf16 v[196:199], a[156:159], v[188:191], v[196:199]
    s_waitcnt lgkmcnt(13)
    ds_read_b64_tr_b16 a[190:191], v27 offset:28672
    s_waitcnt vmcnt(25)
    s_barrier
    v_mfma_f32_16x16x32_bf16 v[200:203], a[160:163], v[128:131], 0
    s_waitcnt lgkmcnt(12)
    ds_read_b64_tr_b16 a[128:129], v20 offset:32768
    v_mfma_f32_16x16x32_bf16 v[200:203], a[164:167], v[132:135], v[200:203]
    s_waitcnt lgkmcnt(11)
    s_add_u32 s49, s45, 896
    ds_read_b64_tr_b16 a[130:131], v20 offset:36864
    v_mfma_f32_16x16x32_bf16 v[200:203], a[168:171], v[136:139], v[200:203]
    s_waitcnt lgkmcnt(10)
    s_add_u32 m0, s42, 32768
    ds_read_b64_tr_b16 a[132:133], v20 offset:40960
    v_mfma_f32_16x16x32_bf16 v[200:203], a[172:175], v[140:143], v[200:203]
    s_waitcnt lgkmcnt(9)
    ds_read_b64_tr_b16 a[134:135], v20 offset:45056
    buffer_load_dwordx4 v46, s[20:23], s49 offen lds
    v_mfma_f32_16x16x32_bf16 v[200:203], a[176:179], v[144:147], v[200:203]
    s_waitcnt lgkmcnt(8)
    ds_read_b64_tr_b16 a[136:137], v20 offset:49152
    v_cvt_pk_bf16_f32 v236, v196, v197
    v_mfma_f32_16x16x32_bf16 v[200:203], a[180:183], v[148:151], v[200:203]
    s_waitcnt lgkmcnt(7)
    ds_read_b64_tr_b16 a[138:139], v20 offset:53248
    v_cvt_pk_bf16_f32 v237, v198, v199
    v_mfma_f32_16x16x32_bf16 v[200:203], a[184:187], v[152:155], v[200:203]
    s_waitcnt lgkmcnt(6)
    ds_read_b64_tr_b16 a[140:141], v20 offset:57344
    v_mfma_f32_16x16x32_bf16 v[200:203], a[188:191], v[156:159], v[200:203]
    ds_read_b64_tr_b16 a[142:143], v20 offset:61440
    buffer_load_dwordx4 v47, s[20:23], s49 offen offset:1024 lds
    v_mfma_f32_16x16x32_bf16 v[204:207], a[160:163], v[160:163], 0
    ds_read_b64_tr_b16 a[144:145], v24 offset:32768
    v_mfma_f32_16x16x32_bf16 v[204:207], a[164:167], v[164:167], v[204:207]
    ds_read_b64_tr_b16 a[146:147], v24 offset:36864
    v_mfma_f32_16x16x32_bf16 v[204:207], a[168:171], v[168:171], v[204:207]
    ds_read_b64_tr_b16 a[148:149], v24 offset:40960
    v_mfma_f32_16x16x32_bf16 v[204:207], a[172:175], v[172:175], v[204:207]
    ds_read_b64_tr_b16 a[150:151], v24 offset:45056
    buffer_load_dwordx4 v48, s[20:23], s49 offen offset:2048 lds
    v_mfma_f32_16x16x32_bf16 v[204:207], a[176:179], v[176:179], v[204:207]
    ds_read_b64_tr_b16 a[152:153], v24 offset:49152
    v_cvt_pk_bf16_f32 v234, v200, v201
    v_mfma_f32_16x16x32_bf16 v[204:207], a[180:183], v[180:183], v[204:207]
    s_add_u32 s38, s47, 896
    ds_read_b64_tr_b16 a[154:155], v24 offset:53248
    v_cvt_pk_bf16_f32 v235, v202, v203
    v_mfma_f32_16x16x32_bf16 v[204:207], a[184:187], v[184:187], v[204:207]
    ds_read_b64_tr_b16 a[156:157], v24 offset:57344
    buffer_store_dwordx4 v[232:235], v56, s[28:31], s38 offen sc1
    v_mfma_f32_16x16x32_bf16 v[204:207], a[188:191], v[188:191], v[204:207]
    s_waitcnt lgkmcnt(13)
    ds_read_b64_tr_b16 a[158:159], v24 offset:61440
    buffer_load_dwordx4 v49, s[20:23], s49 offen offset:3072 lds
    v_mfma_f32_16x16x32_bf16 v[192:195], a[128:131], v[128:131], 0
    s_waitcnt lgkmcnt(12)
    ds_read_b64_tr_b16 a[160:161], v21 offset:32768
    v_mfma_f32_16x16x32_bf16 v[192:195], a[132:135], v[132:135], v[192:195]
    s_waitcnt lgkmcnt(11)
    s_add_u32 s49, s45, 74624
    ds_read_b64_tr_b16 a[162:163], v21 offset:36864
    v_mfma_f32_16x16x32_bf16 v[192:195], a[136:139], v[136:139], v[192:195]
    s_waitcnt lgkmcnt(10)
    s_add_u32 m0, s42, 49152
    ds_read_b64_tr_b16 a[164:165], v21 offset:40960
    v_mfma_f32_16x16x32_bf16 v[192:195], a[140:143], v[140:143], v[192:195]
    s_waitcnt lgkmcnt(9)
    ds_read_b64_tr_b16 a[166:167], v21 offset:45056
    buffer_load_dwordx4 v46, s[20:23], s49 offen lds
    v_mfma_f32_16x16x32_bf16 v[192:195], a[144:147], v[144:147], v[192:195]
    s_waitcnt lgkmcnt(8)
    ds_read_b64_tr_b16 a[168:169], v21 offset:49152
    v_cvt_pk_bf16_f32 v238, v204, v205
    v_mfma_f32_16x16x32_bf16 v[192:195], a[148:151], v[148:151], v[192:195]
    s_waitcnt lgkmcnt(7)
    s_add_u32 s38, s47, 295808
    ds_read_b64_tr_b16 a[170:171], v21 offset:53248
    v_cvt_pk_bf16_f32 v239, v206, v207
    v_mfma_f32_16x16x32_bf16 v[192:195], a[152:155], v[152:155], v[192:195]
    s_waitcnt lgkmcnt(6)
    ds_read_b64_tr_b16 a[172:173], v21 offset:57344
    buffer_store_dwordx4 v[236:239], v56, s[28:31], s38 offen sc1
    v_mfma_f32_16x16x32_bf16 v[192:195], a[156:159], v[156:159], v[192:195]
    ds_read_b64_tr_b16 a[174:175], v21 offset:61440
    buffer_load_dwordx4 v47, s[20:23], s49 offen offset:1024 lds
    v_mfma_f32_16x16x32_bf16 v[196:199], a[128:131], v[160:163], 0
    ds_read_b64_tr_b16 a[176:177], v25 offset:32768
    v_mfma_f32_16x16x32_bf16 v[196:199], a[132:135], v[164:167], v[196:199]
    ds_read_b64_tr_b16 a[178:179], v25 offset:36864
    v_mfma_f32_16x16x32_bf16 v[196:199], a[136:139], v[168:171], v[196:199]
    ds_read_b64_tr_b16 a[180:181], v25 offset:40960
    v_mfma_f32_16x16x32_bf16 v[196:199], a[140:143], v[172:175], v[196:199]
    ds_read_b64_tr_b16 a[182:183], v25 offset:45056
    buffer_load_dwordx4 v48, s[20:23], s49 offen offset:2048 lds
    v_mfma_f32_16x16x32_bf16 v[196:199], a[144:147], v[176:179], v[196:199]
    ds_read_b64_tr_b16 a[184:185], v25 offset:49152
    v_cvt_pk_bf16_f32 v224, v192, v193
    v_mfma_f32_16x16x32_bf16 v[196:199], a[148:151], v[180:183], v[196:199]
    ds_read_b64_tr_b16 a[186:187], v25 offset:53248
    v_cvt_pk_bf16_f32 v225, v194, v195
    v_mfma_f32_16x16x32_bf16 v[196:199], a[152:155], v[184:187], v[196:199]
    ds_read_b64_tr_b16 a[188:189], v25 offset:57344
    v_mfma_f32_16x16x32_bf16 v[196:199], a[156:159], v[188:191], v[196:199]
    s_waitcnt lgkmcnt(13)
    ds_read_b64_tr_b16 a[190:191], v25 offset:61440
    buffer_load_dwordx4 v49, s[20:23], s49 offen offset:3072 lds
    v_mfma_f32_16x16x32_bf16 v[200:203], a[160:163], v[128:131], 0
    s_waitcnt lgkmcnt(12)
    ds_read_b64_tr_b16 a[128:129], v22 offset:32768
    v_mfma_f32_16x16x32_bf16 v[200:203], a[164:167], v[132:135], v[200:203]
    s_waitcnt lgkmcnt(11)
    ds_read_b64_tr_b16 a[130:131], v22 offset:36864
    v_mfma_f32_16x16x32_bf16 v[200:203], a[168:171], v[136:139], v[200:203]
    s_waitcnt lgkmcnt(10)
    ds_read_b64_tr_b16 a[132:133], v22 offset:40960
    v_mfma_f32_16x16x32_bf16 v[200:203], a[172:175], v[140:143], v[200:203]
    s_waitcnt lgkmcnt(9)
    ds_read_b64_tr_b16 a[134:135], v22 offset:45056
    v_mfma_f32_16x16x32_bf16 v[200:203], a[176:179], v[144:147], v[200:203]
    s_waitcnt lgkmcnt(8)
    ds_read_b64_tr_b16 a[136:137], v22 offset:49152
    v_cvt_pk_bf16_f32 v228, v196, v197
    v_mfma_f32_16x16x32_bf16 v[200:203], a[180:183], v[148:151], v[200:203]
    s_waitcnt lgkmcnt(7)
    ds_read_b64_tr_b16 a[138:139], v22 offset:53248
    v_cvt_pk_bf16_f32 v229, v198, v199
    v_mfma_f32_16x16x32_bf16 v[200:203], a[184:187], v[152:155], v[200:203]
    s_waitcnt lgkmcnt(6)
    ds_read_b64_tr_b16 a[140:141], v22 offset:57344
    v_mfma_f32_16x16x32_bf16 v[200:203], a[188:191], v[156:159], v[200:203]
    ds_read_b64_tr_b16 a[142:143], v22 offset:61440
    v_mfma_f32_16x16x32_bf16 v[204:207], a[160:163], v[160:163], 0
    ds_read_b64_tr_b16 a[144:145], v26 offset:32768
    v_mfma_f32_16x16x32_bf16 v[204:207], a[164:167], v[164:167], v[204:207]
    ds_read_b64_tr_b16 a[146:147], v26 offset:36864
    v_mfma_f32_16x16x32_bf16 v[204:207], a[168:171], v[168:171], v[204:207]
    ds_read_b64_tr_b16 a[148:149], v26 offset:40960
    v_mfma_f32_16x16x32_bf16 v[204:207], a[172:175], v[172:175], v[204:207]
    ds_read_b64_tr_b16 a[150:151], v26 offset:45056
    v_mfma_f32_16x16x32_bf16 v[204:207], a[176:179], v[176:179], v[204:207]
    ds_read_b64_tr_b16 a[152:153], v26 offset:49152
    v_cvt_pk_bf16_f32 v226, v200, v201
    v_mfma_f32_16x16x32_bf16 v[204:207], a[180:183], v[180:183], v[204:207]
    s_add_u32 s38, s47, 1024
    ds_read_b64_tr_b16 a[154:155], v26 offset:53248
    v_cvt_pk_bf16_f32 v227, v202, v203
    v_mfma_f32_16x16x32_bf16 v[204:207], a[184:187], v[184:187], v[204:207]
    ds_read_b64_tr_b16 a[156:157], v26 offset:57344
    buffer_store_dwordx4 v[224:227], v56, s[28:31], s38 offen sc1
    v_mfma_f32_16x16x32_bf16 v[204:207], a[188:191], v[188:191], v[204:207]
    s_waitcnt lgkmcnt(13)
    ds_read_b64_tr_b16 a[158:159], v26 offset:61440
    v_mfma_f32_16x16x32_bf16 v[192:195], a[128:131], v[128:131], 0
    s_waitcnt lgkmcnt(12)
    ds_read_b64_tr_b16 a[160:161], v23 offset:32768
    v_mfma_f32_16x16x32_bf16 v[192:195], a[132:135], v[132:135], v[192:195]
    s_waitcnt lgkmcnt(11)
    ds_read_b64_tr_b16 a[162:163], v23 offset:36864
    v_mfma_f32_16x16x32_bf16 v[192:195], a[136:139], v[136:139], v[192:195]
    s_waitcnt lgkmcnt(10)
    ds_read_b64_tr_b16 a[164:165], v23 offset:40960
    v_mfma_f32_16x16x32_bf16 v[192:195], a[140:143], v[140:143], v[192:195]
    s_waitcnt lgkmcnt(9)
    ds_read_b64_tr_b16 a[166:167], v23 offset:45056
    v_mfma_f32_16x16x32_bf16 v[192:195], a[144:147], v[144:147], v[192:195]
    s_waitcnt lgkmcnt(8)
    ds_read_b64_tr_b16 a[168:169], v23 offset:49152
    v_cvt_pk_bf16_f32 v230, v204, v205
    v_mfma_f32_16x16x32_bf16 v[192:195], a[148:151], v[148:151], v[192:195]
    s_waitcnt lgkmcnt(7)
    s_add_u32 s38, s47, 295936
    ds_read_b64_tr_b16 a[170:171], v23 offset:53248
    v_cvt_pk_bf16_f32 v231, v206, v207
    v_mfma_f32_16x16x32_bf16 v[192:195], a[152:155], v[152:155], v[192:195]
    s_waitcnt lgkmcnt(6)
    ds_read_b64_tr_b16 a[172:173], v23 offset:57344
    buffer_store_dwordx4 v[228:231], v56, s[28:31], s38 offen sc1
    v_mfma_f32_16x16x32_bf16 v[192:195], a[156:159], v[156:159], v[192:195]
    ds_read_b64_tr_b16 a[174:175], v23 offset:61440
    v_mfma_f32_16x16x32_bf16 v[196:199], a[128:131], v[160:163], 0
    ds_read_b64_tr_b16 a[176:177], v27 offset:32768
    v_mfma_f32_16x16x32_bf16 v[196:199], a[132:135], v[164:167], v[196:199]
    ds_read_b64_tr_b16 a[178:179], v27 offset:36864
    v_mfma_f32_16x16x32_bf16 v[196:199], a[136:139], v[168:171], v[196:199]
    ds_read_b64_tr_b16 a[180:181], v27 offset:40960
    v_mfma_f32_16x16x32_bf16 v[196:199], a[140:143], v[172:175], v[196:199]
    ds_read_b64_tr_b16 a[182:183], v27 offset:45056
    v_mfma_f32_16x16x32_bf16 v[196:199], a[144:147], v[176:179], v[196:199]
    ds_read_b64_tr_b16 a[184:185], v27 offset:49152
    v_cvt_pk_bf16_f32 v232, v192, v193
    v_mfma_f32_16x16x32_bf16 v[196:199], a[148:151], v[180:183], v[196:199]
    ds_read_b64_tr_b16 a[186:187], v27 offset:53248
    v_cvt_pk_bf16_f32 v233, v194, v195
    v_mfma_f32_16x16x32_bf16 v[196:199], a[152:155], v[184:187], v[196:199]
    ds_read_b64_tr_b16 a[188:189], v27 offset:57344
    v_mfma_f32_16x16x32_bf16 v[196:199], a[156:159], v[188:191], v[196:199]
    s_waitcnt lgkmcnt(13)
    ds_read_b64_tr_b16 a[190:191], v27 offset:61440
    s_waitcnt vmcnt(26)
    s_barrier
    v_mfma_f32_16x16x32_bf16 v[200:203], a[160:163], v[128:131], 0
    s_waitcnt lgkmcnt(12)
    ds_read_b64_tr_b16 a[128:129], v28 offset:0
    v_mfma_f32_16x16x32_bf16 v[200:203], a[164:167], v[132:135], v[200:203]
    s_waitcnt lgkmcnt(11)
    s_add_u32 s49, s45, 1024
    ds_read_b64_tr_b16 a[130:131], v28 offset:4096
    v_mfma_f32_16x16x32_bf16 v[200:203], a[168:171], v[136:139], v[200:203]
    s_waitcnt lgkmcnt(10)
    s_add_u32 m0, s42, 65536
    ds_read_b64_tr_b16 a[132:133], v28 offset:8192
    v_mfma_f32_16x16x32_bf16 v[200:203], a[172:175], v[140:143], v[200:203]
    s_waitcnt lgkmcnt(9)
    ds_read_b64_tr_b16 a[134:135], v28 offset:12288
    buffer_load_dwordx4 v46, s[20:23], s49 offen lds
    v_mfma_f32_16x16x32_bf16 v[200:203], a[176:179], v[144:147], v[200:203]
    s_waitcnt lgkmcnt(8)
    ds_read_b64_tr_b16 a[136:137], v28 offset:16384
    v_cvt_pk_bf16_f32 v236, v196, v197
    v_mfma_f32_16x16x32_bf16 v[200:203], a[180:183], v[148:151], v[200:203]
    s_waitcnt lgkmcnt(7)
    ds_read_b64_tr_b16 a[138:139], v28 offset:20480
    v_cvt_pk_bf16_f32 v237, v198, v199
    v_mfma_f32_16x16x32_bf16 v[200:203], a[184:187], v[152:155], v[200:203]
    s_waitcnt lgkmcnt(6)
    ds_read_b64_tr_b16 a[140:141], v28 offset:24576
    v_mfma_f32_16x16x32_bf16 v[200:203], a[188:191], v[156:159], v[200:203]
    ds_read_b64_tr_b16 a[142:143], v28 offset:28672
    buffer_load_dwordx4 v47, s[20:23], s49 offen offset:1024 lds
    v_mfma_f32_16x16x32_bf16 v[204:207], a[160:163], v[160:163], 0
    ds_read_b64_tr_b16 a[144:145], v32 offset:0
    v_mfma_f32_16x16x32_bf16 v[204:207], a[164:167], v[164:167], v[204:207]
    ds_read_b64_tr_b16 a[146:147], v32 offset:4096
    v_mfma_f32_16x16x32_bf16 v[204:207], a[168:171], v[168:171], v[204:207]
    ds_read_b64_tr_b16 a[148:149], v32 offset:8192
    v_mfma_f32_16x16x32_bf16 v[204:207], a[172:175], v[172:175], v[204:207]
    ds_read_b64_tr_b16 a[150:151], v32 offset:12288
    buffer_load_dwordx4 v48, s[20:23], s49 offen offset:2048 lds
    v_mfma_f32_16x16x32_bf16 v[204:207], a[176:179], v[176:179], v[204:207]
    ds_read_b64_tr_b16 a[152:153], v32 offset:16384
    v_cvt_pk_bf16_f32 v234, v200, v201
    v_mfma_f32_16x16x32_bf16 v[204:207], a[180:183], v[180:183], v[204:207]
    s_add_u32 s38, s47, 1152
    ds_read_b64_tr_b16 a[154:155], v32 offset:20480
    v_cvt_pk_bf16_f32 v235, v202, v203
    v_mfma_f32_16x16x32_bf16 v[204:207], a[184:187], v[184:187], v[204:207]
    ds_read_b64_tr_b16 a[156:157], v32 offset:24576
    buffer_store_dwordx4 v[232:235], v56, s[28:31], s38 offen sc1
    v_mfma_f32_16x16x32_bf16 v[204:207], a[188:191], v[188:191], v[204:207]
    s_waitcnt lgkmcnt(13)
    ds_read_b64_tr_b16 a[158:159], v32 offset:28672
    buffer_load_dwordx4 v49, s[20:23], s49 offen offset:3072 lds
    v_mfma_f32_16x16x32_bf16 v[192:195], a[128:131], v[128:131], 0
    s_waitcnt lgkmcnt(12)
    ds_read_b64_tr_b16 a[160:161], v29 offset:0
    v_mfma_f32_16x16x32_bf16 v[192:195], a[132:135], v[132:135], v[192:195]
    s_waitcnt lgkmcnt(11)
    s_add_u32 s49, s45, 74752
    ds_read_b64_tr_b16 a[162:163], v29 offset:4096
    v_mfma_f32_16x16x32_bf16 v[192:195], a[136:139], v[136:139], v[192:195]
    s_waitcnt lgkmcnt(10)
    s_add_u32 m0, s42, 81920
    ds_read_b64_tr_b16 a[164:165], v29 offset:8192
    v_mfma_f32_16x16x32_bf16 v[192:195], a[140:143], v[140:143], v[192:195]
    s_waitcnt lgkmcnt(9)
    ds_read_b64_tr_b16 a[166:167], v29 offset:12288
    buffer_load_dwordx4 v46, s[20:23], s49 offen lds
    v_mfma_f32_16x16x32_bf16 v[192:195], a[144:147], v[144:147], v[192:195]
    s_waitcnt lgkmcnt(8)
    ds_read_b64_tr_b16 a[168:169], v29 offset:16384
    v_cvt_pk_bf16_f32 v238, v204, v205
    v_mfma_f32_16x16x32_bf16 v[192:195], a[148:151], v[148:151], v[192:195]
    s_waitcnt lgkmcnt(7)
    s_add_u32 s38, s47, 296064
    ds_read_b64_tr_b16 a[170:171], v29 offset:20480
    v_cvt_pk_bf16_f32 v239, v206, v207
    v_mfma_f32_16x16x32_bf16 v[192:195], a[152:155], v[152:155], v[192:195]
    s_waitcnt lgkmcnt(6)
    ds_read_b64_tr_b16 a[172:173], v29 offset:24576
    buffer_store_dwordx4 v[236:239], v56, s[28:31], s38 offen sc1
    v_mfma_f32_16x16x32_bf16 v[192:195], a[156:159], v[156:159], v[192:195]
    ds_read_b64_tr_b16 a[174:175], v29 offset:28672
    buffer_load_dwordx4 v47, s[20:23], s49 offen offset:1024 lds
    v_mfma_f32_16x16x32_bf16 v[196:199], a[128:131], v[160:163], 0
    ds_read_b64_tr_b16 a[176:177], v33 offset:0
    v_mfma_f32_16x16x32_bf16 v[196:199], a[132:135], v[164:167], v[196:199]
    ds_read_b64_tr_b16 a[178:179], v33 offset:4096
    v_mfma_f32_16x16x32_bf16 v[196:199], a[136:139], v[168:171], v[196:199]
    ds_read_b64_tr_b16 a[180:181], v33 offset:8192
    v_mfma_f32_16x16x32_bf16 v[196:199], a[140:143], v[172:175], v[196:199]
    ds_read_b64_tr_b16 a[182:183], v33 offset:12288
    buffer_load_dwordx4 v48, s[20:23], s49 offen offset:2048 lds
    v_mfma_f32_16x16x32_bf16 v[196:199], a[144:147], v[176:179], v[196:199]
    ds_read_b64_tr_b16 a[184:185], v33 offset:16384
    v_cvt_pk_bf16_f32 v224, v192, v193
    v_mfma_f32_16x16x32_bf16 v[196:199], a[148:151], v[180:183], v[196:199]
    ds_read_b64_tr_b16 a[186:187], v33 offset:20480
    v_cvt_pk_bf16_f32 v225, v194, v195
    v_mfma_f32_16x16x32_bf16 v[196:199], a[152:155], v[184:187], v[196:199]
    ds_read_b64_tr_b16 a[188:189], v33 offset:24576
    v_mfma_f32_16x16x32_bf16 v[196:199], a[156:159], v[188:191], v[196:199]
    s_waitcnt lgkmcnt(13)
    ds_read_b64_tr_b16 a[190:191], v33 offset:28672
    buffer_load_dwordx4 v49, s[20:23], s49 offen offset:3072 lds
    v_mfma_f32_16x16x32_bf16 v[200:203], a[160:163], v[128:131], 0
    s_waitcnt lgkmcnt(12)
    ds_read_b64_tr_b16 a[128:129], v30 offset:0
    v_mfma_f32_16x16x32_bf16 v[200:203], a[164:167], v[132:135], v[200:203]
    s_waitcnt lgkmcnt(11)
    ds_read_b64_tr_b16 a[130:131], v30 offset:4096
    v_mfma_f32_16x16x32_bf16 v[200:203], a[168:171], v[136:139], v[200:203]
    s_waitcnt lgkmcnt(10)
    ds_read_b64_tr_b16 a[132:133], v30 offset:8192
    v_mfma_f32_16x16x32_bf16 v[200:203], a[172:175], v[140:143], v[200:203]
    s_waitcnt lgkmcnt(9)
    ds_read_b64_tr_b16 a[134:135], v30 offset:12288
    v_mfma_f32_16x16x32_bf16 v[200:203], a[176:179], v[144:147], v[200:203]
    s_waitcnt lgkmcnt(8)
    ds_read_b64_tr_b16 a[136:137], v30 offset:16384
    v_cvt_pk_bf16_f32 v228, v196, v197
    v_mfma_f32_16x16x32_bf16 v[200:203], a[180:183], v[148:151], v[200:203]
    s_waitcnt lgkmcnt(7)
    ds_read_b64_tr_b16 a[138:139], v30 offset:20480
    v_cvt_pk_bf16_f32 v229, v198, v199
    v_mfma_f32_16x16x32_bf16 v[200:203], a[184:187], v[152:155], v[200:203]
    s_waitcnt lgkmcnt(6)
    ds_read_b64_tr_b16 a[140:141], v30 offset:24576
    s_lshr_b32 s6, s2, 3
    v_mfma_f32_16x16x32_bf16 v[200:203], a[188:191], v[156:159], v[200:203]
    ds_read_b64_tr_b16 a[142:143], v30 offset:28672
    v_mfma_f32_16x16x32_bf16 v[204:207], a[160:163], v[160:163], 0
    ds_read_b64_tr_b16 a[144:145], v34 offset:0
    s_and_b32 s7, s2, 7
    v_mfma_f32_16x16x32_bf16 v[204:207], a[164:167], v[164:167], v[204:207]
    ds_read_b64_tr_b16 a[146:147], v34 offset:4096
    v_mfma_f32_16x16x32_bf16 v[204:207], a[168:171], v[168:171], v[204:207]
    ds_read_b64_tr_b16 a[148:149], v34 offset:8192
    s_mul_i32 s7, s7, 18
    v_mfma_f32_16x16x32_bf16 v[204:207], a[172:175], v[172:175], v[204:207]
    ds_read_b64_tr_b16 a[150:151], v34 offset:12288
    v_mfma_f32_16x16x32_bf16 v[204:207], a[176:179], v[176:179], v[204:207]
    ds_read_b64_tr_b16 a[152:153], v34 offset:16384
    v_cvt_pk_bf16_f32 v226, v200, v201
    s_add_u32 s7, s7, s6
    v_mfma_f32_16x16x32_bf16 v[204:207], a[180:183], v[180:183], v[204:207]
    s_add_u32 s38, s47, 1280
    ds_read_b64_tr_b16 a[154:155], v34 offset:20480
    v_cvt_pk_bf16_f32 v227, v202, v203
    v_mfma_f32_16x16x32_bf16 v[204:207], a[184:187], v[184:187], v[204:207]
    ds_read_b64_tr_b16 a[156:157], v34 offset:24576
    buffer_store_dwordx4 v[224:227], v56, s[28:31], s38 offen sc1
    s_lshl_b32 s36, s7, 6
    v_mfma_f32_16x16x32_bf16 v[204:207], a[188:191], v[188:191], v[204:207]
    s_waitcnt lgkmcnt(13)
    ds_read_b64_tr_b16 a[158:159], v34 offset:28672
    v_mfma_f32_16x16x32_bf16 v[192:195], a[128:131], v[128:131], 0
    s_waitcnt lgkmcnt(12)
    ds_read_b64_tr_b16 a[160:161], v31 offset:0
    s_mul_i32 s37, s7, 36864
    v_mfma_f32_16x16x32_bf16 v[192:195], a[132:135], v[132:135], v[192:195]
    s_waitcnt lgkmcnt(11)
    ds_read_b64_tr_b16 a[162:163], v31 offset:4096
    v_mfma_f32_16x16x32_bf16 v[192:195], a[136:139], v[136:139], v[192:195]
    s_waitcnt lgkmcnt(10)
    ds_read_b64_tr_b16 a[164:165], v31 offset:8192
    s_lshl_b32 s39, s3, 10
    v_mfma_f32_16x16x32_bf16 v[192:195], a[140:143], v[140:143], v[192:195]
    s_waitcnt lgkmcnt(9)
    ds_read_b64_tr_b16 a[166:167], v31 offset:12288
    v_mfma_f32_16x16x32_bf16 v[192:195], a[144:147], v[144:147], v[192:195]
    s_waitcnt lgkmcnt(8)
    ds_read_b64_tr_b16 a[168:169], v31 offset:16384
    v_cvt_pk_bf16_f32 v230, v204, v205
    s_cmp_lt_u32 s6, 18
    s_cselect_b32 s34, 5308416, 0
    v_mfma_f32_16x16x32_bf16 v[192:195], a[148:151], v[148:151], v[192:195]
    s_waitcnt lgkmcnt(7)
    s_add_u32 s38, s47, 296192
    ds_read_b64_tr_b16 a[170:171], v31 offset:20480
    v_cvt_pk_bf16_f32 v231, v206, v207
    v_mfma_f32_16x16x32_bf16 v[192:195], a[152:155], v[152:155], v[192:195]
    s_waitcnt lgkmcnt(6)
    ds_read_b64_tr_b16 a[172:173], v31 offset:24576
    buffer_store_dwordx4 v[228:231], v56, s[28:31], s38 offen sc1
    s_mov_b32 s82, s34
    v_mfma_f32_16x16x32_bf16 v[192:195], a[156:159], v[156:159], v[192:195]
    ds_read_b64_tr_b16 a[174:175], v31 offset:28672
    v_mfma_f32_16x16x32_bf16 v[196:199], a[128:131], v[160:163], 0
    ds_read_b64_tr_b16 a[176:177], v35 offset:0
    s_mov_b32 s86, s34
    v_mfma_f32_16x16x32_bf16 v[196:199], a[132:135], v[164:167], v[196:199]
    ds_read_b64_tr_b16 a[178:179], v35 offset:4096
    v_mfma_f32_16x16x32_bf16 v[196:199], a[136:139], v[168:171], v[196:199]
    ds_read_b64_tr_b16 a[180:181], v35 offset:8192
    v_mfma_f32_16x16x32_bf16 v[196:199], a[140:143], v[172:175], v[196:199]
    ds_read_b64_tr_b16 a[182:183], v35 offset:12288
    v_mfma_f32_16x16x32_bf16 v[196:199], a[144:147], v[176:179], v[196:199]
    ds_read_b64_tr_b16 a[184:185], v35 offset:16384
    v_cvt_pk_bf16_f32 v232, v192, v193
    v_mfma_f32_16x16x32_bf16 v[196:199], a[148:151], v[180:183], v[196:199]
    ds_read_b64_tr_b16 a[186:187], v35 offset:20480
    v_cvt_pk_bf16_f32 v233, v194, v195
    v_mfma_f32_16x16x32_bf16 v[196:199], a[152:155], v[184:187], v[196:199]
    ds_read_b64_tr_b16 a[188:189], v35 offset:24576
    v_mfma_f32_16x16x32_bf16 v[196:199], a[156:159], v[188:191], v[196:199]
    s_waitcnt lgkmcnt(13)
    ds_read_b64_tr_b16 a[190:191], v35 offset:28672
    s_waitcnt vmcnt(26)
    s_barrier
    v_mfma_f32_16x16x32_bf16 v[200:203], a[160:163], v[128:131], 0
    s_waitcnt lgkmcnt(12)
    ds_read_b64_tr_b16 a[128:129], v12 offset:0
    v_mfma_f32_16x16x32_bf16 v[200:203], a[164:167], v[132:135], v[200:203]
    s_waitcnt lgkmcnt(11)
    s_add_u32 s49, s36, 0
    ds_read_b64_tr_b16 a[130:131], v12 offset:4096
    v_mfma_f32_16x16x32_bf16 v[200:203], a[168:171], v[136:139], v[200:203]
    s_waitcnt lgkmcnt(10)
    s_add_u32 m0, s39, 98304
    ds_read_b64_tr_b16 a[132:133], v12 offset:8192
    v_mfma_f32_16x16x32_bf16 v[200:203], a[172:175], v[140:143], v[200:203]
    s_waitcnt lgkmcnt(9)
    ds_read_b64_tr_b16 a[134:135], v12 offset:12288
    buffer_load_dwordx4 v57, s[80:83], s49 offen lds
    v_mfma_f32_16x16x32_bf16 v[200:203], a[176:179], v[144:147], v[200:203]
    s_waitcnt lgkmcnt(8)
    ds_read_b64_tr_b16 a[136:137], v12 offset:16384
    v_cvt_pk_bf16_f32 v236, v196, v197
    v_mfma_f32_16x16x32_bf16 v[200:203], a[180:183], v[148:151], v[200:203]
    s_waitcnt lgkmcnt(7)
    s_add_u32 s49, s36, 589824
    ds_read_b64_tr_b16 a[138:139], v12 offset:20480
    v_cvt_pk_bf16_f32 v237, v198, v199
    v_mfma_f32_16x16x32_bf16 v[200:203], a[184:187], v[152:155], v[200:203]
    s_waitcnt lgkmcnt(6)
    s_add_u32 m0, s39, 102400
    ds_read_b64_tr_b16 a[140:141], v12 offset:24576
    v_mfma_f32_16x16x32_bf16 v[200:203], a[188:191], v[156:159], v[200:203]
    ds_read_b64_tr_b16 a[142:143], v12 offset:28672
    buffer_load_dwordx4 v57, s[80:83], s49 offen lds
    v_mfma_f32_16x16x32_bf16 v[204:207], a[160:163], v[160:163], 0
    ds_read_b64_tr_b16 a[144:145], v16 offset:0
    v_mfma_f32_16x16x32_bf16 v[204:207], a[164:167], v[164:167], v[204:207]
    s_add_u32 s49, s36, 1179648
    ds_read_b64_tr_b16 a[146:147], v16 offset:4096
    v_mfma_f32_16x16x32_bf16 v[204:207], a[168:171], v[168:171], v[204:207]
    s_add_u32 m0, s39, 106496
    ds_read_b64_tr_b16 a[148:149], v16 offset:8192
    v_mfma_f32_16x16x32_bf16 v[204:207], a[172:175], v[172:175], v[204:207]
    ds_read_b64_tr_b16 a[150:151], v16 offset:12288
    buffer_load_dwordx4 v57, s[80:83], s49 offen lds
    v_mfma_f32_16x16x32_bf16 v[204:207], a[176:179], v[176:179], v[204:207]
    ds_read_b64_tr_b16 a[152:153], v16 offset:16384
    v_cvt_pk_bf16_f32 v234, v200, v201
    v_mfma_f32_16x16x32_bf16 v[204:207], a[180:183], v[180:183], v[204:207]
    s_add_u32 s38, s47, 1408
    s_add_u32 s49, s36, 1769472
    ds_read_b64_tr_b16 a[154:155], v16 offset:20480
    v_cvt_pk_bf16_f32 v235, v202, v203
    v_mfma_f32_16x16x32_bf16 v[204:207], a[184:187], v[184:187], v[204:207]
    s_add_u32 m0, s39, 110592
    ds_read_b64_tr_b16 a[156:157], v16 offset:24576
    buffer_store_dwordx4 v[232:235], v56, s[28:31], s38 offen sc1
    v_mfma_f32_16x16x32_bf16 v[204:207], a[188:191], v[188:191], v[204:207]
    s_waitcnt lgkmcnt(13)
    ds_read_b64_tr_b16 a[158:159], v16 offset:28672
    buffer_load_dwordx4 v57, s[80:83], s49 offen lds
    v_mfma_f32_16x16x32_bf16 v[192:195], a[128:131], v[128:131], 0
    s_waitcnt lgkmcnt(12)
    ds_read_b64_tr_b16 a[160:161], v13 offset:0
    v_mfma_f32_16x16x32_bf16 v[192:195], a[132:135], v[132:135], v[192:195]
    s_waitcnt lgkmcnt(11)
    s_add_u32 s49, s36, 2359296
    ds_read_b64_tr_b16 a[162:163], v13 offset:4096
    v_mfma_f32_16x16x32_bf16 v[192:195], a[136:139], v[136:139], v[192:195]
    s_waitcnt lgkmcnt(10)
    s_add_u32 m0, s39, 114688
    ds_read_b64_tr_b16 a[164:165], v13 offset:8192
    v_mfma_f32_16x16x32_bf16 v[192:195], a[140:143], v[140:143], v[192:195]
    s_waitcnt lgkmcnt(9)
    ds_read_b64_tr_b16 a[166:167], v13 offset:12288
    buffer_load_dwordx4 v57, s[80:83], s49 offen lds
    v_mfma_f32_16x16x32_bf16 v[192:195], a[144:147], v[144:147], v[192:195]
    s_waitcnt lgkmcnt(8)
    ds_read_b64_tr_b16 a[168:169], v13 offset:16384
    v_cvt_pk_bf16_f32 v238, v204, v205
    v_mfma_f32_16x16x32_bf16 v[192:195], a[148:151], v[148:151], v[192:195]
    s_waitcnt lgkmcnt(7)
    s_add_u32 s38, s47, 296320
    s_add_u32 s49, s36, 2949120
    ds_read_b64_tr_b16 a[170:171], v13 offset:20480
    v_cvt_pk_bf16_f32 v239, v206, v207
    v_mfma_f32_16x16x32_bf16 v[192:195], a[152:155], v[152:155], v[192:195]
    s_waitcnt lgkmcnt(6)
    s_add_u32 m0, s39, 118784
    ds_read_b64_tr_b16 a[172:173], v13 offset:24576
    buffer_store_dwordx4 v[236:239], v56, s[28:31], s38 offen sc1
    v_mfma_f32_16x16x32_bf16 v[192:195], a[156:159], v[156:159], v[192:195]
    ds_read_b64_tr_b16 a[174:175], v13 offset:28672
    buffer_load_dwordx4 v57, s[80:83], s49 offen lds
    v_mfma_f32_16x16x32_bf16 v[196:199], a[128:131], v[160:163], 0
    ds_read_b64_tr_b16 a[176:177], v17 offset:0
    v_mfma_f32_16x16x32_bf16 v[196:199], a[132:135], v[164:167], v[196:199]
    s_add_u32 s49, s36, 3538944
    ds_read_b64_tr_b16 a[178:179], v17 offset:4096
    v_mfma_f32_16x16x32_bf16 v[196:199], a[136:139], v[168:171], v[196:199]
    s_add_u32 m0, s39, 122880
    ds_read_b64_tr_b16 a[180:181], v17 offset:8192
    v_mfma_f32_16x16x32_bf16 v[196:199], a[140:143], v[172:175], v[196:199]
    ds_read_b64_tr_b16 a[182:183], v17 offset:12288
    buffer_load_dwordx4 v57, s[80:83], s49 offen lds
    v_mfma_f32_16x16x32_bf16 v[196:199], a[144:147], v[176:179], v[196:199]
    ds_read_b64_tr_b16 a[184:185], v17 offset:16384
    v_cvt_pk_bf16_f32 v224, v192, v193
    v_mfma_f32_16x16x32_bf16 v[196:199], a[148:151], v[180:183], v[196:199]
    s_add_u32 s49, s36, 4128768
    ds_read_b64_tr_b16 a[186:187], v17 offset:20480
    v_cvt_pk_bf16_f32 v225, v194, v195
    v_mfma_f32_16x16x32_bf16 v[196:199], a[152:155], v[184:187], v[196:199]
    s_add_u32 m0, s39, 126976
    ds_read_b64_tr_b16 a[188:189], v17 offset:24576
    v_mfma_f32_16x16x32_bf16 v[196:199], a[156:159], v[188:191], v[196:199]
    s_waitcnt lgkmcnt(13)
    ds_read_b64_tr_b16 a[190:191], v17 offset:28672
    buffer_load_dwordx4 v57, s[80:83], s49 offen lds
    v_mfma_f32_16x16x32_bf16 v[200:203], a[160:163], v[128:131], 0
    s_waitcnt lgkmcnt(12)
    ds_read_b64_tr_b16 a[128:129], v14 offset:0
    v_mfma_f32_16x16x32_bf16 v[200:203], a[164:167], v[132:135], v[200:203]
    s_waitcnt lgkmcnt(11)
    ds_read_b64_tr_b16 a[130:131], v14 offset:4096
    v_mfma_f32_16x16x32_bf16 v[200:203], a[168:171], v[136:139], v[200:203]
    s_waitcnt lgkmcnt(10)
    ds_read_b64_tr_b16 a[132:133], v14 offset:8192
    v_mfma_f32_16x16x32_bf16 v[200:203], a[172:175], v[140:143], v[200:203]
    s_waitcnt lgkmcnt(9)
    ds_read_b64_tr_b16 a[134:135], v14 offset:12288
    v_mfma_f32_16x16x32_bf16 v[200:203], a[176:179], v[144:147], v[200:203]
    s_waitcnt lgkmcnt(8)
    ds_read_b64_tr_b16 a[136:137], v14 offset:16384
    v_cvt_pk_bf16_f32 v228, v196, v197
    v_mfma_f32_16x16x32_bf16 v[200:203], a[180:183], v[148:151], v[200:203]
    s_waitcnt lgkmcnt(7)
    ds_read_b64_tr_b16 a[138:139], v14 offset:20480
    v_cvt_pk_bf16_f32 v229, v198, v199
    v_mfma_f32_16x16x32_bf16 v[200:203], a[184:187], v[152:155], v[200:203]
    s_waitcnt lgkmcnt(6)
    ds_read_b64_tr_b16 a[140:141], v14 offset:24576
    v_mfma_f32_16x16x32_bf16 v[200:203], a[188:191], v[156:159], v[200:203]
    ds_read_b64_tr_b16 a[142:143], v14 offset:28672
    v_mfma_f32_16x16x32_bf16 v[204:207], a[160:163], v[160:163], 0
    ds_read_b64_tr_b16 a[144:145], v18 offset:0
    v_mfma_f32_16x16x32_bf16 v[204:207], a[164:167], v[164:167], v[204:207]
    ds_read_b64_tr_b16 a[146:147], v18 offset:4096
    v_mfma_f32_16x16x32_bf16 v[204:207], a[168:171], v[168:171], v[204:207]
    ds_read_b64_tr_b16 a[148:149], v18 offset:8192
    v_mfma_f32_16x16x32_bf16 v[204:207], a[172:175], v[172:175], v[204:207]
    ds_read_b64_tr_b16 a[150:151], v18 offset:12288
    v_mfma_f32_16x16x32_bf16 v[204:207], a[176:179], v[176:179], v[204:207]
    ds_read_b64_tr_b16 a[152:153], v18 offset:16384
    v_cvt_pk_bf16_f32 v226, v200, v201
    v_mfma_f32_16x16x32_bf16 v[204:207], a[180:183], v[180:183], v[204:207]
    s_add_u32 s38, s47, 1536
    ds_read_b64_tr_b16 a[154:155], v18 offset:20480
    v_cvt_pk_bf16_f32 v227, v202, v203
    v_mfma_f32_16x16x32_bf16 v[204:207], a[184:187], v[184:187], v[204:207]
    ds_read_b64_tr_b16 a[156:157], v18 offset:24576
    buffer_store_dwordx4 v[224:227], v56, s[28:31], s38 offen sc1
    v_mfma_f32_16x16x32_bf16 v[204:207], a[188:191], v[188:191], v[204:207]
    s_waitcnt lgkmcnt(13)
    ds_read_b64_tr_b16 a[158:159], v18 offset:28672
    v_mfma_f32_16x16x32_bf16 v[192:195], a[128:131], v[128:131], 0
    s_waitcnt lgkmcnt(12)
    ds_read_b64_tr_b16 a[160:161], v15 offset:0
    v_mfma_f32_16x16x32_bf16 v[192:195], a[132:135], v[132:135], v[192:195]
    s_waitcnt lgkmcnt(11)
    ds_read_b64_tr_b16 a[162:163], v15 offset:4096
    v_mfma_f32_16x16x32_bf16 v[192:195], a[136:139], v[136:139], v[192:195]
    s_waitcnt lgkmcnt(10)
    ds_read_b64_tr_b16 a[164:165], v15 offset:8192
    v_mfma_f32_16x16x32_bf16 v[192:195], a[140:143], v[140:143], v[192:195]
    s_waitcnt lgkmcnt(9)
    ds_read_b64_tr_b16 a[166:167], v15 offset:12288
    v_mfma_f32_16x16x32_bf16 v[192:195], a[144:147], v[144:147], v[192:195]
    s_waitcnt lgkmcnt(8)
    ds_read_b64_tr_b16 a[168:169], v15 offset:16384
    v_cvt_pk_bf16_f32 v230, v204, v205
    v_mfma_f32_16x16x32_bf16 v[192:195], a[148:151], v[148:151], v[192:195]
    s_waitcnt lgkmcnt(7)
    s_add_u32 s38, s47, 296448
    ds_read_b64_tr_b16 a[170:171], v15 offset:20480
    v_cvt_pk_bf16_f32 v231, v206, v207
    v_mfma_f32_16x16x32_bf16 v[192:195], a[152:155], v[152:155], v[192:195]
    s_waitcnt lgkmcnt(6)
    ds_read_b64_tr_b16 a[172:173], v15 offset:24576
    buffer_store_dwordx4 v[228:231], v56, s[28:31], s38 offen sc1
    v_mfma_f32_16x16x32_bf16 v[192:195], a[156:159], v[156:159], v[192:195]
    ds_read_b64_tr_b16 a[174:175], v15 offset:28672
    v_mfma_f32_16x16x32_bf16 v[196:199], a[128:131], v[160:163], 0
    ds_read_b64_tr_b16 a[176:177], v19 offset:0
    v_mfma_f32_16x16x32_bf16 v[196:199], a[132:135], v[164:167], v[196:199]
    ds_read_b64_tr_b16 a[178:179], v19 offset:4096
    v_mfma_f32_16x16x32_bf16 v[196:199], a[136:139], v[168:171], v[196:199]
    ds_read_b64_tr_b16 a[180:181], v19 offset:8192
    v_mfma_f32_16x16x32_bf16 v[196:199], a[140:143], v[172:175], v[196:199]
    ds_read_b64_tr_b16 a[182:183], v19 offset:12288
    v_mfma_f32_16x16x32_bf16 v[196:199], a[144:147], v[176:179], v[196:199]
    ds_read_b64_tr_b16 a[184:185], v19 offset:16384
    v_cvt_pk_bf16_f32 v232, v192, v193
    v_mfma_f32_16x16x32_bf16 v[196:199], a[148:151], v[180:183], v[196:199]
    ds_read_b64_tr_b16 a[186:187], v19 offset:20480
    v_cvt_pk_bf16_f32 v233, v194, v195
    v_mfma_f32_16x16x32_bf16 v[196:199], a[152:155], v[184:187], v[196:199]
    ds_read_b64_tr_b16 a[188:189], v19 offset:24576
    v_mfma_f32_16x16x32_bf16 v[196:199], a[156:159], v[188:191], v[196:199]
    s_waitcnt lgkmcnt(13)
    ds_read_b64_tr_b16 a[190:191], v19 offset:28672
    s_waitcnt vmcnt(26)
    s_barrier
    v_mfma_f32_16x16x32_bf16 v[200:203], a[160:163], v[128:131], 0
    s_waitcnt lgkmcnt(12)
    ds_read_b64_tr_b16 a[128:129], v12 offset:32768
    v_mfma_f32_16x16x32_bf16 v[200:203], a[164:167], v[132:135], v[200:203]
    s_waitcnt lgkmcnt(11)
    s_add_u32 s49, s36, 4718592
    ds_read_b64_tr_b16 a[130:131], v12 offset:36864
    v_mfma_f32_16x16x32_bf16 v[200:203], a[168:171], v[136:139], v[200:203]
    s_waitcnt lgkmcnt(10)
    s_add_u32 m0, s39, 131072
    ds_read_b64_tr_b16 a[132:133], v12 offset:40960
    v_mfma_f32_16x16x32_bf16 v[200:203], a[172:175], v[140:143], v[200:203]
    s_waitcnt lgkmcnt(9)
    ds_read_b64_tr_b16 a[134:135], v12 offset:45056
    buffer_load_dwordx4 v57, s[80:83], s49 offen lds
    v_mfma_f32_16x16x32_bf16 v[200:203], a[176:179], v[144:147], v[200:203]
    s_waitcnt lgkmcnt(8)
    ds_read_b64_tr_b16 a[136:137], v12 offset:49152
    v_cvt_pk_bf16_f32 v236, v196, v197
    v_mfma_f32_16x16x32_bf16 v[200:203], a[180:183], v[148:151], v[200:203]
    s_waitcnt lgkmcnt(7)
    s_add_u32 s49, s36, 0
    ds_read_b64_tr_b16 a[138:139], v12 offset:53248
    v_cvt_pk_bf16_f32 v237, v198, v199
    v_mfma_f32_16x16x32_bf16 v[200:203], a[184:187], v[152:155], v[200:203]
    s_waitcnt lgkmcnt(6)
    s_add_u32 m0, s39, 135168
    ds_read_b64_tr_b16 a[140:141], v12 offset:57344
    v_mfma_f32_16x16x32_bf16 v[200:203], a[188:191], v[156:159], v[200:203]
    ds_read_b64_tr_b16 a[142:143], v12 offset:61440
    buffer_load_dwordx4 v57, s[32:35], s49 offen lds
    v_mfma_f32_16x16x32_bf16 v[204:207], a[160:163], v[160:163], 0
    ds_read_b64_tr_b16 a[144:145], v16 offset:32768
    v_mfma_f32_16x16x32_bf16 v[204:207], a[164:167], v[164:167], v[204:207]
    s_add_u32 s49, s36, 589824
    ds_read_b64_tr_b16 a[146:147], v16 offset:36864
    v_mfma_f32_16x16x32_bf16 v[204:207], a[168:171], v[168:171], v[204:207]
    s_add_u32 m0, s39, 139264
    ds_read_b64_tr_b16 a[148:149], v16 offset:40960
    v_mfma_f32_16x16x32_bf16 v[204:207], a[172:175], v[172:175], v[204:207]
    ds_read_b64_tr_b16 a[150:151], v16 offset:45056
    buffer_load_dwordx4 v57, s[32:35], s49 offen lds
    v_mfma_f32_16x16x32_bf16 v[204:207], a[176:179], v[176:179], v[204:207]
    ds_read_b64_tr_b16 a[152:153], v16 offset:49152
    v_cvt_pk_bf16_f32 v234, v200, v201
    v_mfma_f32_16x16x32_bf16 v[204:207], a[180:183], v[180:183], v[204:207]
    s_add_u32 s38, s47, 1664
    s_add_u32 s49, s36, 1179648
    ds_read_b64_tr_b16 a[154:155], v16 offset:53248
    v_cvt_pk_bf16_f32 v235, v202, v203
    v_mfma_f32_16x16x32_bf16 v[204:207], a[184:187], v[184:187], v[204:207]
    s_add_u32 m0, s39, 143360
    ds_read_b64_tr_b16 a[156:157], v16 offset:57344
    buffer_store_dwordx4 v[232:235], v56, s[28:31], s38 offen sc1
    v_mfma_f32_16x16x32_bf16 v[204:207], a[188:191], v[188:191], v[204:207]
    s_waitcnt lgkmcnt(13)
    ds_read_b64_tr_b16 a[158:159], v16 offset:61440
    buffer_load_dwordx4 v57, s[32:35], s49 offen lds
    v_mfma_f32_16x16x32_bf16 v[192:195], a[128:131], v[128:131], 0
    s_waitcnt lgkmcnt(12)
    ds_read_b64_tr_b16 a[160:161], v13 offset:32768
    v_mfma_f32_16x16x32_bf16 v[192:195], a[132:135], v[132:135], v[192:195]
    s_waitcnt lgkmcnt(11)
    s_add_u32 s49, s36, 1769472
    ds_read_b64_tr_b16 a[162:163], v13 offset:36864
    v_mfma_f32_16x16x32_bf16 v[192:195], a[136:139], v[136:139], v[192:195]
    s_waitcnt lgkmcnt(10)
    s_add_u32 m0, s39, 147456
    ds_read_b64_tr_b16 a[164:165], v13 offset:40960
    v_mfma_f32_16x16x32_bf16 v[192:195], a[140:143], v[140:143], v[192:195]
    s_waitcnt lgkmcnt(9)
    ds_read_b64_tr_b16 a[166:167], v13 offset:45056
    buffer_load_dwordx4 v57, s[32:35], s49 offen lds
    v_mfma_f32_16x16x32_bf16 v[192:195], a[144:147], v[144:147], v[192:195]
    s_waitcnt lgkmcnt(8)
    ds_read_b64_tr_b16 a[168:169], v13 offset:49152
    v_cvt_pk_bf16_f32 v238, v204, v205
    v_mfma_f32_16x16x32_bf16 v[192:195], a[148:151], v[148:151], v[192:195]
    s_waitcnt lgkmcnt(7)
    s_add_u32 s38, s47, 296576
    s_add_u32 s49, s36, 2359296
    ds_read_b64_tr_b16 a[170:171], v13 offset:53248
    v_cvt_pk_bf16_f32 v239, v206, v207
    v_mfma_f32_16x16x32_bf16 v[192:195], a[152:155], v[152:155], v[192:195]
    s_waitcnt lgkmcnt(6)
    s_add_u32 m0, s39, 151552
    ds_read_b64_tr_b16 a[172:173], v13 offset:57344
    buffer_store_dwordx4 v[236:239], v56, s[28:31], s38 offen sc1
    v_mfma_f32_16x16x32_bf16 v[192:195], a[156:159], v[156:159], v[192:195]
    ds_read_b64_tr_b16 a[174:175], v13 offset:61440
    buffer_load_dwordx4 v57, s[32:35], s49 offen lds
    v_mfma_f32_16x16x32_bf16 v[196:199], a[128:131], v[160:163], 0
    ds_read_b64_tr_b16 a[176:177], v17 offset:32768
    v_mfma_f32_16x16x32_bf16 v[196:199], a[132:135], v[164:167], v[196:199]
    s_add_u32 s49, s36, 2949120
    ds_read_b64_tr_b16 a[178:179], v17 offset:36864
    v_mfma_f32_16x16x32_bf16 v[196:199], a[136:139], v[168:171], v[196:199]
    s_add_u32 m0, s39, 155648
    ds_read_b64_tr_b16 a[180:181], v17 offset:40960
    v_mfma_f32_16x16x32_bf16 v[196:199], a[140:143], v[172:175], v[196:199]
    ds_read_b64_tr_b16 a[182:183], v17 offset:45056
    buffer_load_dwordx4 v57, s[32:35], s49 offen lds
    v_mfma_f32_16x16x32_bf16 v[196:199], a[144:147], v[176:179], v[196:199]
    ds_read_b64_tr_b16 a[184:185], v17 offset:49152
    v_cvt_pk_bf16_f32 v224, v192, v193
    v_mfma_f32_16x16x32_bf16 v[196:199], a[148:151], v[180:183], v[196:199]
    s_add_u32 s49, s36, 3538944
    ds_read_b64_tr_b16 a[186:187], v17 offset:53248
    v_cvt_pk_bf16_f32 v225, v194, v195
    v_mfma_f32_16x16x32_bf16 v[196:199], a[152:155], v[184:187], v[196:199]
    s_add_u32 m0, s39, 159744
    ds_read_b64_tr_b16 a[188:189], v17 offset:57344
    v_mfma_f32_16x16x32_bf16 v[196:199], a[156:159], v[188:191], v[196:199]
    s_waitcnt lgkmcnt(13)
    ds_read_b64_tr_b16 a[190:191], v17 offset:61440
    buffer_load_dwordx4 v57, s[32:35], s49 offen lds
    v_mfma_f32_16x16x32_bf16 v[200:203], a[160:163], v[128:131], 0
    s_waitcnt lgkmcnt(12)
    ds_read_b64_tr_b16 a[128:129], v14 offset:32768
    v_mfma_f32_16x16x32_bf16 v[200:203], a[164:167], v[132:135], v[200:203]
    s_waitcnt lgkmcnt(11)
    ds_read_b64_tr_b16 a[130:131], v14 offset:36864
    v_mfma_f32_16x16x32_bf16 v[200:203], a[168:171], v[136:139], v[200:203]
    s_waitcnt lgkmcnt(10)
    ds_read_b64_tr_b16 a[132:133], v14 offset:40960
    v_mfma_f32_16x16x32_bf16 v[200:203], a[172:175], v[140:143], v[200:203]
    s_waitcnt lgkmcnt(9)
    ds_read_b64_tr_b16 a[134:135], v14 offset:45056
    v_mfma_f32_16x16x32_bf16 v[200:203], a[176:179], v[144:147], v[200:203]
    s_waitcnt lgkmcnt(8)
    ds_read_b64_tr_b16 a[136:137], v14 offset:49152
    v_cvt_pk_bf16_f32 v228, v196, v197
    v_mfma_f32_16x16x32_bf16 v[200:203], a[180:183], v[148:151], v[200:203]
    s_waitcnt lgkmcnt(7)
    ds_read_b64_tr_b16 a[138:139], v14 offset:53248
    v_cvt_pk_bf16_f32 v229, v198, v199
    v_mfma_f32_16x16x32_bf16 v[200:203], a[184:187], v[152:155], v[200:203]
    s_waitcnt lgkmcnt(6)
    ds_read_b64_tr_b16 a[140:141], v14 offset:57344
    v_mfma_f32_16x16x32_bf16 v[200:203], a[188:191], v[156:159], v[200:203]
    ds_read_b64_tr_b16 a[142:143], v14 offset:61440
    v_mfma_f32_16x16x32_bf16 v[204:207], a[160:163], v[160:163], 0
    ds_read_b64_tr_b16 a[144:145], v18 offset:32768
    v_mfma_f32_16x16x32_bf16 v[204:207], a[164:167], v[164:167], v[204:207]
    ds_read_b64_tr_b16 a[146:147], v18 offset:36864
    v_mfma_f32_16x16x32_bf16 v[204:207], a[168:171], v[168:171], v[204:207]
    ds_read_b64_tr_b16 a[148:149], v18 offset:40960
    v_mfma_f32_16x16x32_bf16 v[204:207], a[172:175], v[172:175], v[204:207]
    ds_read_b64_tr_b16 a[150:151], v18 offset:45056
    v_mfma_f32_16x16x32_bf16 v[204:207], a[176:179], v[176:179], v[204:207]
    ds_read_b64_tr_b16 a[152:153], v18 offset:49152
    v_cvt_pk_bf16_f32 v226, v200, v201
    v_mfma_f32_16x16x32_bf16 v[204:207], a[180:183], v[180:183], v[204:207]
    s_add_u32 s38, s47, 1792
    ds_read_b64_tr_b16 a[154:155], v18 offset:53248
    v_cvt_pk_bf16_f32 v227, v202, v203
    v_mfma_f32_16x16x32_bf16 v[204:207], a[184:187], v[184:187], v[204:207]
    ds_read_b64_tr_b16 a[156:157], v18 offset:57344
    buffer_store_dwordx4 v[224:227], v56, s[28:31], s38 offen sc1
    v_mfma_f32_16x16x32_bf16 v[204:207], a[188:191], v[188:191], v[204:207]
    s_waitcnt lgkmcnt(13)
    ds_read_b64_tr_b16 a[158:159], v18 offset:61440
    v_mfma_f32_16x16x32_bf16 v[192:195], a[128:131], v[128:131], 0
    s_waitcnt lgkmcnt(12)
    ds_read_b64_tr_b16 a[160:161], v15 offset:32768
    v_mfma_f32_16x16x32_bf16 v[192:195], a[132:135], v[132:135], v[192:195]
    s_waitcnt lgkmcnt(11)
    ds_read_b64_tr_b16 a[162:163], v15 offset:36864
    v_mfma_f32_16x16x32_bf16 v[192:195], a[136:139], v[136:139], v[192:195]
    s_waitcnt lgkmcnt(10)
    ds_read_b64_tr_b16 a[164:165], v15 offset:40960
    v_mfma_f32_16x16x32_bf16 v[192:195], a[140:143], v[140:143], v[192:195]
    s_waitcnt lgkmcnt(9)
    ds_read_b64_tr_b16 a[166:167], v15 offset:45056
    v_mfma_f32_16x16x32_bf16 v[192:195], a[144:147], v[144:147], v[192:195]
    s_waitcnt lgkmcnt(8)
    ds_read_b64_tr_b16 a[168:169], v15 offset:49152
    v_cvt_pk_bf16_f32 v230, v204, v205
    v_mfma_f32_16x16x32_bf16 v[192:195], a[148:151], v[148:151], v[192:195]
    s_waitcnt lgkmcnt(7)
    s_add_u32 s38, s47, 296704
    ds_read_b64_tr_b16 a[170:171], v15 offset:53248
    v_cvt_pk_bf16_f32 v231, v206, v207
    v_mfma_f32_16x16x32_bf16 v[192:195], a[152:155], v[152:155], v[192:195]
    s_waitcnt lgkmcnt(6)
    ds_read_b64_tr_b16 a[172:173], v15 offset:57344
    buffer_store_dwordx4 v[228:231], v56, s[28:31], s38 offen sc1
    v_mfma_f32_16x16x32_bf16 v[192:195], a[156:159], v[156:159], v[192:195]
    ds_read_b64_tr_b16 a[174:175], v15 offset:61440
    v_mfma_f32_16x16x32_bf16 v[196:199], a[128:131], v[160:163], 0
    ds_read_b64_tr_b16 a[176:177], v19 offset:32768
    v_mfma_f32_16x16x32_bf16 v[196:199], a[132:135], v[164:167], v[196:199]
    ds_read_b64_tr_b16 a[178:179], v19 offset:36864
    v_mfma_f32_16x16x32_bf16 v[196:199], a[136:139], v[168:171], v[196:199]
    ds_read_b64_tr_b16 a[180:181], v19 offset:40960
    v_mfma_f32_16x16x32_bf16 v[196:199], a[140:143], v[172:175], v[196:199]
    ds_read_b64_tr_b16 a[182:183], v19 offset:45056
    v_mfma_f32_16x16x32_bf16 v[196:199], a[144:147], v[176:179], v[196:199]
    ds_read_b64_tr_b16 a[184:185], v19 offset:49152
    v_cvt_pk_bf16_f32 v232, v192, v193
    v_mfma_f32_16x16x32_bf16 v[196:199], a[148:151], v[180:183], v[196:199]
    ds_read_b64_tr_b16 a[186:187], v19 offset:53248
    v_cvt_pk_bf16_f32 v233, v194, v195
    v_mfma_f32_16x16x32_bf16 v[196:199], a[152:155], v[184:187], v[196:199]
    ds_read_b64_tr_b16 a[188:189], v19 offset:57344
    v_mfma_f32_16x16x32_bf16 v[196:199], a[156:159], v[188:191], v[196:199]
    ds_read_b64_tr_b16 a[190:191], v19 offset:61440
    s_waitcnt vmcnt(26)
    s_waitcnt lgkmcnt(0)
    s_barrier
    v_mfma_f32_16x16x32_bf16 v[200:203], a[160:163], v[128:131], 0
    ds_read_b64_tr_b16 a[128:129], v20 offset:0
    v_mfma_f32_16x16x32_bf16 v[200:203], a[164:167], v[132:135], v[200:203]
    s_add_u32 s49, s36, 4128768
    ds_read_b64_tr_b16 a[130:131], v20 offset:4096
    v_mfma_f32_16x16x32_bf16 v[200:203], a[168:171], v[136:139], v[200:203]
    s_add_u32 m0, s39, 36864
    ds_read_b64_tr_b16 a[132:133], v20 offset:8192
    v_mfma_f32_16x16x32_bf16 v[200:203], a[172:175], v[140:143], v[200:203]
    ds_read_b64_tr_b16 a[134:135], v20 offset:12288
    buffer_load_dwordx4 v57, s[32:35], s49 offen lds
    v_mfma_f32_16x16x32_bf16 v[200:203], a[176:179], v[144:147], v[200:203]
    ds_read_b64_tr_b16 a[136:137], v20 offset:16384
    v_cvt_pk_bf16_f32 v236, v196, v197
    v_mfma_f32_16x16x32_bf16 v[200:203], a[180:183], v[148:151], v[200:203]
    s_add_u32 s49, s36, 4718592
    ds_read_b64_tr_b16 a[138:139], v20 offset:20480
    v_cvt_pk_bf16_f32 v237, v198, v199
    v_mfma_f32_16x16x32_bf16 v[200:203], a[184:187], v[152:155], v[200:203]
    s_add_u32 m0, s39, 40960
    ds_read_b64_tr_b16 a[140:141], v20 offset:24576
    v_mfma_f32_16x16x32_bf16 v[200:203], a[188:191], v[156:159], v[200:203]
    ds_read_b64_tr_b16 a[142:143], v20 offset:28672
    buffer_load_dwordx4 v57, s[32:35], s49 offen lds
    v_mfma_f32_16x16x32_bf16 v[204:207], a[160:163], v[160:163], 0
    ds_read_b64_tr_b16 a[144:145], v24 offset:0
    v_mfma_f32_16x16x32_bf16 v[204:207], a[164:167], v[164:167], v[204:207]
    s_add_u32 s49, s37, 0
    ds_read_b64_tr_b16 a[146:147], v24 offset:4096
    v_mfma_f32_16x16x32_bf16 v[204:207], a[168:171], v[168:171], v[204:207]
    s_add_u32 m0, s39, 0
    ds_read_b64_tr_b16 a[148:149], v24 offset:8192
    v_mfma_f32_16x16x32_bf16 v[204:207], a[172:175], v[172:175], v[204:207]
    ds_read_b64_tr_b16 a[150:151], v24 offset:12288
    buffer_load_dwordx4 v62, s[84:87], s49 offen lds
    v_mfma_f32_16x16x32_bf16 v[204:207], a[176:179], v[176:179], v[204:207]
    ds_read_b64_tr_b16 a[152:153], v24 offset:16384
    v_cvt_pk_bf16_f32 v234, v200, v201
    v_mfma_f32_16x16x32_bf16 v[204:207], a[180:183], v[180:183], v[204:207]
    s_add_u32 s38, s47, 1920
    s_add_u32 s49, s37, 4096
    ds_read_b64_tr_b16 a[154:155], v24 offset:20480
    v_cvt_pk_bf16_f32 v235, v202, v203
    v_mfma_f32_16x16x32_bf16 v[204:207], a[184:187], v[184:187], v[204:207]
    s_add_u32 m0, s39, 4096
    ds_read_b64_tr_b16 a[156:157], v24 offset:24576
    buffer_store_dwordx4 v[232:235], v56, s[28:31], s38 offen sc1
    v_mfma_f32_16x16x32_bf16 v[204:207], a[188:191], v[188:191], v[204:207]
    s_waitcnt lgkmcnt(13)
    ds_read_b64_tr_b16 a[158:159], v24 offset:28672
    buffer_load_dwordx4 v62, s[84:87], s49 offen lds
    v_mfma_f32_16x16x32_bf16 v[192:195], a[128:131], v[128:131], 0
    s_waitcnt lgkmcnt(12)
    ds_read_b64_tr_b16 a[160:161], v21 offset:0
    v_mfma_f32_16x16x32_bf16 v[192:195], a[132:135], v[132:135], v[192:195]
    s_waitcnt lgkmcnt(11)
    s_add_u32 s49, s37, 8192
    ds_read_b64_tr_b16 a[162:163], v21 offset:4096
    v_mfma_f32_16x16x32_bf16 v[192:195], a[136:139], v[136:139], v[192:195]
    s_waitcnt lgkmcnt(10)
    s_add_u32 m0, s39, 8192
    ds_read_b64_tr_b16 a[164:165], v21 offset:8192
    v_mfma_f32_16x16x32_bf16 v[192:195], a[140:143], v[140:143], v[192:195]
    s_waitcnt lgkmcnt(9)
    ds_read_b64_tr_b16 a[166:167], v21 offset:12288
    buffer_load_dwordx4 v62, s[84:87], s49 offen lds
    v_mfma_f32_16x16x32_bf16 v[192:195], a[144:147], v[144:147], v[192:195]
    s_waitcnt lgkmcnt(8)
    ds_read_b64_tr_b16 a[168:169], v21 offset:16384
    v_cvt_pk_bf16_f32 v238, v204, v205
    v_mfma_f32_16x16x32_bf16 v[192:195], a[148:151], v[148:151], v[192:195]
    s_waitcnt lgkmcnt(7)
    s_add_u32 s38, s47, 296832
    s_add_u32 s49, s37, 12288
    ds_read_b64_tr_b16 a[170:171], v21 offset:20480
    v_cvt_pk_bf16_f32 v239, v206, v207
    v_mfma_f32_16x16x32_bf16 v[192:195], a[152:155], v[152:155], v[192:195]
    s_waitcnt lgkmcnt(6)
    s_add_u32 m0, s39, 12288
    ds_read_b64_tr_b16 a[172:173], v21 offset:24576
    buffer_store_dwordx4 v[236:239], v56, s[28:31], s38 offen sc1
    v_mfma_f32_16x16x32_bf16 v[192:195], a[156:159], v[156:159], v[192:195]
    ds_read_b64_tr_b16 a[174:175], v21 offset:28672
    buffer_load_dwordx4 v62, s[84:87], s49 offen lds
    v_mfma_f32_16x16x32_bf16 v[196:199], a[128:131], v[160:163], 0
    ds_read_b64_tr_b16 a[176:177], v25 offset:0
    v_mfma_f32_16x16x32_bf16 v[196:199], a[132:135], v[164:167], v[196:199]
    s_add_u32 s49, s37, 16384
    ds_read_b64_tr_b16 a[178:179], v25 offset:4096
    v_mfma_f32_16x16x32_bf16 v[196:199], a[136:139], v[168:171], v[196:199]
    s_add_u32 m0, s39, 16384
    ds_read_b64_tr_b16 a[180:181], v25 offset:8192
    v_mfma_f32_16x16x32_bf16 v[196:199], a[140:143], v[172:175], v[196:199]
    ds_read_b64_tr_b16 a[182:183], v25 offset:12288
    buffer_load_dwordx4 v62, s[84:87], s49 offen lds
    v_mfma_f32_16x16x32_bf16 v[196:199], a[144:147], v[176:179], v[196:199]
    ds_read_b64_tr_b16 a[184:185], v25 offset:16384
    v_cvt_pk_bf16_f32 v224, v192, v193
    v_mfma_f32_16x16x32_bf16 v[196:199], a[148:151], v[180:183], v[196:199]
    s_add_u32 s49, s37, 20480
    ds_read_b64_tr_b16 a[186:187], v25 offset:20480
    v_cvt_pk_bf16_f32 v225, v194, v195
    v_mfma_f32_16x16x32_bf16 v[196:199], a[152:155], v[184:187], v[196:199]
    s_add_u32 m0, s39, 20480
    ds_read_b64_tr_b16 a[188:189], v25 offset:24576
    v_mfma_f32_16x16x32_bf16 v[196:199], a[156:159], v[188:191], v[196:199]
    s_waitcnt lgkmcnt(13)
    ds_read_b64_tr_b16 a[190:191], v25 offset:28672
    buffer_load_dwordx4 v62, s[84:87], s49 offen lds
    v_mfma_f32_16x16x32_bf16 v[200:203], a[160:163], v[128:131], 0
    s_waitcnt lgkmcnt(12)
    ds_read_b64_tr_b16 a[128:129], v22 offset:0
    v_mfma_f32_16x16x32_bf16 v[200:203], a[164:167], v[132:135], v[200:203]
    s_waitcnt lgkmcnt(11)
    s_add_u32 s49, s37, 24576
    ds_read_b64_tr_b16 a[130:131], v22 offset:4096
    v_mfma_f32_16x16x32_bf16 v[200:203], a[168:171], v[136:139], v[200:203]
    s_waitcnt lgkmcnt(10)
    s_add_u32 m0, s39, 24576
    ds_read_b64_tr_b16 a[132:133], v22 offset:8192
    v_mfma_f32_16x16x32_bf16 v[200:203], a[172:175], v[140:143], v[200:203]
    s_waitcnt lgkmcnt(9)
    ds_read_b64_tr_b16 a[134:135], v22 offset:12288
    buffer_load_dwordx4 v62, s[84:87], s49 offen lds
    v_mfma_f32_16x16x32_bf16 v[200:203], a[176:179], v[144:147], v[200:203]
    s_waitcnt lgkmcnt(8)
    ds_read_b64_tr_b16 a[136:137], v22 offset:16384
    v_cvt_pk_bf16_f32 v228, v196, v197
    v_mfma_f32_16x16x32_bf16 v[200:203], a[180:183], v[148:151], v[200:203]
    s_waitcnt lgkmcnt(7)
    s_add_u32 s49, s37, 28672
    ds_read_b64_tr_b16 a[138:139], v22 offset:20480
    v_cvt_pk_bf16_f32 v229, v198, v199
    v_mfma_f32_16x16x32_bf16 v[200:203], a[184:187], v[152:155], v[200:203]
    s_waitcnt lgkmcnt(6)
    s_add_u32 m0, s39, 28672
    ds_read_b64_tr_b16 a[140:141], v22 offset:24576
    v_mfma_f32_16x16x32_bf16 v[200:203], a[188:191], v[156:159], v[200:203]
    ds_read_b64_tr_b16 a[142:143], v22 offset:28672
    buffer_load_dwordx4 v62, s[84:87], s49 offen lds
    v_mfma_f32_16x16x32_bf16 v[204:207], a[160:163], v[160:163], 0
    ds_read_b64_tr_b16 a[144:145], v26 offset:0
    v_mfma_f32_16x16x32_bf16 v[204:207], a[164:167], v[164:167], v[204:207]
    s_add_u32 s49, s37, 32768
    ds_read_b64_tr_b16 a[146:147], v26 offset:4096
    v_mfma_f32_16x16x32_bf16 v[204:207], a[168:171], v[168:171], v[204:207]
    s_add_u32 m0, s39, 32768
    ds_read_b64_tr_b16 a[148:149], v26 offset:8192
    v_mfma_f32_16x16x32_bf16 v[204:207], a[172:175], v[172:175], v[204:207]
    ds_read_b64_tr_b16 a[150:151], v26 offset:12288
    buffer_load_dwordx4 v62, s[84:87], s49 offen lds
    v_mfma_f32_16x16x32_bf16 v[204:207], a[176:179], v[176:179], v[204:207]
    ds_read_b64_tr_b16 a[152:153], v26 offset:16384
    v_cvt_pk_bf16_f32 v226, v200, v201
    v_mfma_f32_16x16x32_bf16 v[204:207], a[180:183], v[180:183], v[204:207]
    s_add_u32 s38, s47, 2048
    ds_read_b64_tr_b16 a[154:155], v26 offset:20480
    v_cvt_pk_bf16_f32 v227, v202, v203
    v_mfma_f32_16x16x32_bf16 v[204:207], a[184:187], v[184:187], v[204:207]
    ds_read_b64_tr_b16 a[156:157], v26 offset:24576
    buffer_store_dwordx4 v[224:227], v56, s[28:31], s38 offen sc1
    v_mfma_f32_16x16x32_bf16 v[204:207], a[188:191], v[188:191], v[204:207]
    s_waitcnt lgkmcnt(13)
    ds_read_b64_tr_b16 a[158:159], v26 offset:28672
    v_mfma_f32_16x16x32_bf16 v[192:195], a[128:131], v[128:131], 0
    s_waitcnt lgkmcnt(12)
    ds_read_b64_tr_b16 a[160:161], v23 offset:0
    v_mfma_f32_16x16x32_bf16 v[192:195], a[132:135], v[132:135], v[192:195]
    s_waitcnt lgkmcnt(11)
    ds_read_b64_tr_b16 a[162:163], v23 offset:4096
    v_mfma_f32_16x16x32_bf16 v[192:195], a[136:139], v[136:139], v[192:195]
    s_waitcnt lgkmcnt(10)
    ds_read_b64_tr_b16 a[164:165], v23 offset:8192
    v_mfma_f32_16x16x32_bf16 v[192:195], a[140:143], v[140:143], v[192:195]
    s_waitcnt lgkmcnt(9)
    ds_read_b64_tr_b16 a[166:167], v23 offset:12288
    v_mfma_f32_16x16x32_bf16 v[192:195], a[144:147], v[144:147], v[192:195]
    s_waitcnt lgkmcnt(8)
    ds_read_b64_tr_b16 a[168:169], v23 offset:16384
    v_cvt_pk_bf16_f32 v230, v204, v205
    v_mfma_f32_16x16x32_bf16 v[192:195], a[148:151], v[148:151], v[192:195]
    s_waitcnt lgkmcnt(7)
    s_add_u32 s38, s47, 296960
    ds_read_b64_tr_b16 a[170:171], v23 offset:20480
    v_cvt_pk_bf16_f32 v231, v206, v207
    v_mfma_f32_16x16x32_bf16 v[192:195], a[152:155], v[152:155], v[192:195]
    s_waitcnt lgkmcnt(6)
    ds_read_b64_tr_b16 a[172:173], v23 offset:24576
    buffer_store_dwordx4 v[228:231], v56, s[28:31], s38 offen sc1
    v_mfma_f32_16x16x32_bf16 v[192:195], a[156:159], v[156:159], v[192:195]
    ds_read_b64_tr_b16 a[174:175], v23 offset:28672
    v_mfma_f32_16x16x32_bf16 v[196:199], a[128:131], v[160:163], 0
    ds_read_b64_tr_b16 a[176:177], v27 offset:0
    v_mfma_f32_16x16x32_bf16 v[196:199], a[132:135], v[164:167], v[196:199]
    ds_read_b64_tr_b16 a[178:179], v27 offset:4096
    v_mfma_f32_16x16x32_bf16 v[196:199], a[136:139], v[168:171], v[196:199]
    ds_read_b64_tr_b16 a[180:181], v27 offset:8192
    v_mfma_f32_16x16x32_bf16 v[196:199], a[140:143], v[172:175], v[196:199]
    ds_read_b64_tr_b16 a[182:183], v27 offset:12288
    v_mfma_f32_16x16x32_bf16 v[196:199], a[144:147], v[176:179], v[196:199]
    ds_read_b64_tr_b16 a[184:185], v27 offset:16384
    v_cvt_pk_bf16_f32 v232, v192, v193
    v_mfma_f32_16x16x32_bf16 v[196:199], a[148:151], v[180:183], v[196:199]
    ds_read_b64_tr_b16 a[186:187], v27 offset:20480
    v_cvt_pk_bf16_f32 v233, v194, v195
    v_mfma_f32_16x16x32_bf16 v[196:199], a[152:155], v[184:187], v[196:199]
    ds_read_b64_tr_b16 a[188:189], v27 offset:24576
    v_mfma_f32_16x16x32_bf16 v[196:199], a[156:159], v[188:191], v[196:199]
    s_waitcnt lgkmcnt(13)
    ds_read_b64_tr_b16 a[190:191], v27 offset:28672
    v_mfma_f32_16x16x32_bf16 v[200:203], a[160:163], v[128:131], 0
    s_waitcnt lgkmcnt(12)
    v_mfma_f32_16x16x32_bf16 v[200:203], a[164:167], v[132:135], v[200:203]
    s_waitcnt lgkmcnt(10)
    v_mfma_f32_16x16x32_bf16 v[200:203], a[168:171], v[136:139], v[200:203]
    s_waitcnt lgkmcnt(8)
    v_mfma_f32_16x16x32_bf16 v[200:203], a[172:175], v[140:143], v[200:203]
    s_waitcnt lgkmcnt(6)
    v_mfma_f32_16x16x32_bf16 v[200:203], a[176:179], v[144:147], v[200:203]
    s_waitcnt lgkmcnt(4)
    v_cvt_pk_bf16_f32 v236, v196, v197
    v_mfma_f32_16x16x32_bf16 v[200:203], a[180:183], v[148:151], v[200:203]
    s_waitcnt lgkmcnt(2)
    v_cvt_pk_bf16_f32 v237, v198, v199
    v_mfma_f32_16x16x32_bf16 v[200:203], a[184:187], v[152:155], v[200:203]
    s_waitcnt lgkmcnt(0)
    v_mfma_f32_16x16x32_bf16 v[200:203], a[188:191], v[156:159], v[200:203]
    v_mfma_f32_16x16x32_bf16 v[204:207], a[160:163], v[160:163], 0
    v_mfma_f32_16x16x32_bf16 v[204:207], a[164:167], v[164:167], v[204:207]
    v_mfma_f32_16x16x32_bf16 v[204:207], a[168:171], v[168:171], v[204:207]
    v_mfma_f32_16x16x32_bf16 v[204:207], a[172:175], v[172:175], v[204:207]
    v_mfma_f32_16x16x32_bf16 v[204:207], a[176:179], v[176:179], v[204:207]
    s_nop 2
    v_cvt_pk_bf16_f32 v234, v200, v201
    v_mfma_f32_16x16x32_bf16 v[204:207], a[180:183], v[180:183], v[204:207]
    s_add_u32 s38, s47, 2176
    v_cvt_pk_bf16_f32 v235, v202, v203
    v_mfma_f32_16x16x32_bf16 v[204:207], a[184:187], v[184:187], v[204:207]
    buffer_store_dwordx4 v[232:235], v56, s[28:31], s38 offen sc1
    v_mfma_f32_16x16x32_bf16 v[204:207], a[188:191], v[188:191], v[204:207]
    s_nop 7
    v_cvt_pk_bf16_f32 v238, v204, v205
    s_add_u32 s38, s47, 297088
    v_cvt_pk_bf16_f32 v239, v206, v207
    buffer_store_dwordx4 v[236:239], v56, s[28:31], s38 offen sc1
    s_lshl_b32 s40, s5, 4
    s_add_u32 s40, s40, s4
    s_load_dwordx2 s[52:53], s[0:1], 0
    s_load_dwordx2 s[54:55], s[0:1], 96
    s_load_dwordx2 s[56:57], s[0:1], 48
    s_add_u32 s24, s50, 7856128
    s_addc_u32 s25, s51, 0
    s_mov_b32 s26, 4096
    s_mov_b32 s27, 0x20000
    s_lshl_b32 s36, s5, 8
    s_lshl_b32 s37, s3, 6
    s_add_u32 s37, s37, s36
    s_lshl_b32 s38, s4, 2
    s_add_u32 s37, s37, s38
    s_lshr_b32 s38, s4, 2
    s_lshl_b32 s38, s38, 6
    s_add_u32 s39, s38, s36
    v_mov_b32 v14, 0
    v_and_b32 v15, 15, v1
    v_lshlrev_b32 v15, 2, v15
    s_waitcnt lgkmcnt(0)
    v_and_b32 v8, 31, v1
    v_lshrrev_b32 v9, 5, v1
    v_cmp_gt_u32 vcc, 24, v8
    v_mov_b32 v10, 2147483648
    s_lshl_b32 s43, s40, 3
    s_lshl_b32 s44, s3, 1
    s_add_u32 s43, s43, s44
    v_cndmask_b32 v10, v10, 0, vcc
    v_add_u32 v7, s43, v9
    v_lshl_add_u32 v5, v8, 4, v10
    v_lshl_add_u32 v11, v9, 4, v10
    v_lshl_add_u32 v2, v8, 5, v11
    s_mul_i32 s44, s43, 18432
    v_lshrrev_b32 v11, 2, v8
    v_lshl_add_u32 v11, v11, 6, v10
    v_and_b32 v12, 3, v8
    v_lshl_add_u32 v3, v12, 3, v11
    v_mul_u32_u24 v11, 1152, v7
    v_add_u32 v4, v11, v3
    v_add_u32 v6, v11, v5
    s_lshr_b32 s41, s2, 3
    s_and_b32 s42, s2, 7
    s_mov_b32 s8, s50
    s_mov_b32 s9, s51
    s_mov_b32 s10, 10485760
    s_mov_b32 s11, 0x20000
    s_mov_b32 s12, s52
    s_mov_b32 s13, s53
    s_mov_b32 s14, 2359296
    s_mov_b32 s15, 0x20000
    s_mov_b32 s16, s54
    s_mov_b32 s17, s55
    s_mov_b32 s18, 2359296
    s_mov_b32 s19, 0x20000
    s_mov_b32 s20, s56
    s_mov_b32 s21, s57
    s_mov_b32 s22, 1152
    s_mov_b32 s23, 0x20000
    s_add_u32 s32, s50, 7864320
    s_addc_u32 s33, s51, 0
    s_mov_b32 s34, 663552
    s_mov_b32 s35, 0x20000
    buffer_load_dwordx2 v[40:41], v4, s[12:15], 0 offen offset:0
    buffer_load_dwordx2 v[42:43], v4, s[12:15], 0 offen offset:32
    buffer_load_dwordx2 v[44:45], v4, s[12:15], 0 offen offset:384
    buffer_load_dwordx2 v[46:47], v4, s[12:15], 0 offen offset:416
    buffer_load_dwordx2 v[48:49], v4, s[12:15], 0 offen offset:768
    buffer_load_dwordx2 v[50:51], v4, s[12:15], 0 offen offset:800
    s_mov_b32 s45, 18688
    buffer_load_dwordx4 v[52:55], v5, s[8:11], s45 offen offset:0 sc1
    buffer_load_dwordx4 v[56:59], v5, s[8:11], s45 offen offset:384 sc1
    buffer_load_dwordx4 v[60:63], v5, s[8:11], s45 offen offset:768 sc1
    s_mov_b32 s45, 20992
    buffer_load_dwordx4 v[64:67], v5, s[8:11], s45 offen offset:0 sc1
    buffer_load_dwordx4 v[68:71], v5, s[8:11], s45 offen offset:384 sc1
    buffer_load_dwordx4 v[72:75], v5, s[8:11], s45 offen offset:768 sc1
    s_mov_b32 s45, 19840
    buffer_load_dwordx4 v[76:79], v5, s[8:11], s45 offen offset:0 sc1
    buffer_load_dwordx4 v[80:83], v5, s[8:11], s45 offen offset:384 sc1
    buffer_load_dwordx4 v[84:87], v5, s[8:11], s45 offen offset:768 sc1
    buffer_load_dwordx2 v[88:89], v3, s[20:23], 0 offen offset:0
    buffer_load_dwordx2 v[90:91], v3, s[20:23], 0 offen offset:32
    buffer_load_dwordx2 v[92:93], v3, s[20:23], 0 offen offset:384
    buffer_load_dwordx2 v[94:95], v3, s[20:23], 0 offen offset:416
    buffer_load_dwordx2 v[96:97], v3, s[20:23], 0 offen offset:768
    buffer_load_dwordx2 v[98:99], v3, s[20:23], 0 offen offset:800
    s_mov_b32 s45, 22144
    buffer_load_dwordx4 v[100:103], v5, s[8:11], s45 offen offset:0 sc1
    buffer_load_dwordx4 v[104:107], v5, s[8:11], s45 offen offset:384 sc1
    buffer_load_dwordx4 v[108:111], v5, s[8:11], s45 offen offset:768 sc1
    s_waitcnt vmcnt(24)
    s_mov_b64 exec, 1
    buffer_store_dword v14, v14, s[24:27], s37 offen sc1
    s_mov_b64 exec, -1
    v_lshrrev_b32 v8, 4, v1
    v_bfe_u32 v9, v1, 2, 2
    v_cmp_eq_u32 s[36:37], v8, v9
    v_and_b32 v8, 1, v1
    v_lshlrev_b32 v8, 4, v8
    v_mov_b32 v9, 0x3f80
    v_lshlrev_b32 v8, v8, v9
    v_cndmask_b32 v8, 0, v8, s[36:37]
    v_bfe_i32 v9, v1, 1, 1
    v_mov_b32 v32, 0
    v_mov_b32 v33, 0
    v_mov_b32 v36, 0
    v_mov_b32 v37, 0
    v_and_b32 v35, v8, v9
    v_xor_b32 v34, v8, v35
    s_waitcnt vmcnt(24)
    v_lshlrev_b32 v112, 16, v40
    v_and_b32 v113, 0xffff0000, v40
    v_lshlrev_b32 v114, 16, v41
    v_and_b32 v115, 0xffff0000, v41
    s_waitcnt vmcnt(23)
    v_lshlrev_b32 v116, 16, v42
    v_and_b32 v117, 0xffff0000, v42
    v_lshlrev_b32 v118, 16, v43
    v_and_b32 v119, 0xffff0000, v43
    s_waitcnt vmcnt(22)
    v_lshlrev_b32 v120, 16, v44
    v_and_b32 v121, 0xffff0000, v44
    v_lshlrev_b32 v122, 16, v45
    v_and_b32 v123, 0xffff0000, v45
    s_waitcnt vmcnt(21)
    v_lshlrev_b32 v124, 16, v46
    v_and_b32 v125, 0xffff0000, v46
    v_lshlrev_b32 v126, 16, v47
    v_and_b32 v127, 0xffff0000, v47
    s_waitcnt vmcnt(20)
    v_lshlrev_b32 v128, 16, v48
    v_and_b32 v129, 0xffff0000, v48
    v_lshlrev_b32 v130, 16, v49
    v_and_b32 v131, 0xffff0000, v49
    s_waitcnt vmcnt(19)
    v_lshlrev_b32 v132, 16, v50
    v_and_b32 v133, 0xffff0000, v50
    v_lshlrev_b32 v134, 16, v51
    v_and_b32 v135, 0xffff0000, v51
    s_waitcnt vmcnt(18)
    v_lshlrev_b32 v136, 16, v52
    v_and_b32 v137, 0xffff0000, v52
    v_lshlrev_b32 v138, 16, v53
    v_and_b32 v139, 0xffff0000, v53
    v_lshlrev_b32 v140, 16, v54
    v_and_b32 v141, 0xffff0000, v54
    v_lshlrev_b32 v142, 16, v55
    v_and_b32 v143, 0xffff0000, v55
    s_waitcnt vmcnt(17)
    v_lshlrev_b32 v144, 16, v56
    v_and_b32 v145, 0xffff0000, v56
    v_lshlrev_b32 v146, 16, v57
    v_and_b32 v147, 0xffff0000, v57
    v_lshlrev_b32 v148, 16, v58
    v_and_b32 v149, 0xffff0000, v58
    v_lshlrev_b32 v150, 16, v59
    v_and_b32 v151, 0xffff0000, v59
    s_waitcnt vmcnt(16)
    v_lshlrev_b32 v152, 16, v60
    v_and_b32 v153, 0xffff0000, v60
    v_lshlrev_b32 v154, 16, v61
    v_and_b32 v155, 0xffff0000, v61
    v_lshlrev_b32 v156, 16, v62
    v_and_b32 v157, 0xffff0000, v62
    v_lshlrev_b32 v158, 16, v63
    v_and_b32 v159, 0xffff0000, v63
    s_waitcnt vmcnt(15)
    v_lshlrev_b32 v160, 16, v64
    v_and_b32 v161, 0xffff0000, v64
    v_lshlrev_b32 v162, 16, v65
    v_and_b32 v163, 0xffff0000, v65
    v_lshlrev_b32 v164, 16, v66
    v_and_b32 v165, 0xffff0000, v66
    v_lshlrev_b32 v166, 16, v67
    v_and_b32 v167, 0xffff0000, v67
    s_waitcnt vmcnt(14)
    v_lshlrev_b32 v168, 16, v68
    v_and_b32 v169, 0xffff0000, v68
    v_lshlrev_b32 v170, 16, v69
    v_and_b32 v171, 0xffff0000, v69
    v_lshlrev_b32 v172, 16, v70
    v_and_b32 v173, 0xffff0000, v70
    v_lshlrev_b32 v174, 16, v71
    v_and_b32 v175, 0xffff0000, v71
    s_waitcnt vmcnt(13)
    v_lshlrev_b32 v176, 16, v72
    v_and_b32 v177, 0xffff0000, v72
    v_lshlrev_b32 v178, 16, v73
    v_and_b32 v179, 0xffff0000, v73
    v_lshlrev_b32 v180, 16, v74
    v_and_b32 v181, 0xffff0000, v74
    v_lshlrev_b32 v182, 16, v75
    v_and_b32 v183, 0xffff0000, v75
    s_waitcnt vmcnt(12)
    v_lshlrev_b32 v184, 16, v76
    v_and_b32 v185, 0xffff0000, v76
    v_lshlrev_b32 v186, 16, v77
    v_and_b32 v187, 0xffff0000, v77
    v_lshlrev_b32 v188, 16, v78
    v_and_b32 v189, 0xffff0000, v78
    v_lshlrev_b32 v190, 16, v79
    v_and_b32 v191, 0xffff0000, v79
    s_waitcnt vmcnt(11)
    v_lshlrev_b32 v192, 16, v80
    v_and_b32 v193, 0xffff0000, v80
    v_lshlrev_b32 v194, 16, v81
    v_and_b32 v195, 0xffff0000, v81
    v_lshlrev_b32 v196, 16, v82
    v_and_b32 v197, 0xffff0000, v82
    v_lshlrev_b32 v198, 16, v83
    v_and_b32 v199, 0xffff0000, v83
    s_waitcnt vmcnt(10)
    v_lshlrev_b32 v200, 16, v84
    v_and_b32 v201, 0xffff0000, v84
    v_lshlrev_b32 v202, 16, v85
    v_and_b32 v203, 0xffff0000, v85
    v_lshlrev_b32 v204, 16, v86
    v_and_b32 v205, 0xffff0000, v86
    v_lshlrev_b32 v206, 16, v87
    v_and_b32 v207, 0xffff0000, v87
    s_waitcnt vmcnt(9)
    v_lshlrev_b32 v208, 16, v88
    v_and_b32 v209, 0xffff0000, v88
    v_lshlrev_b32 v210, 16, v89
    v_and_b32 v211, 0xffff0000, v89
    s_waitcnt vmcnt(8)
    v_lshlrev_b32 v212, 16, v90
    v_and_b32 v213, 0xffff0000, v90
    v_lshlrev_b32 v214, 16, v91
    v_and_b32 v215, 0xffff0000, v91
    s_waitcnt vmcnt(7)
    v_lshlrev_b32 v216, 16, v92
    v_and_b32 v217, 0xffff0000, v92
    v_lshlrev_b32 v218, 16, v93
    v_and_b32 v219, 0xffff0000, v93
    s_waitcnt vmcnt(6)
    v_lshlrev_b32 v220, 16, v94
    v_and_b32 v221, 0xffff0000, v94
    v_lshlrev_b32 v222, 16, v95
    v_and_b32 v223, 0xffff0000, v95
    s_waitcnt vmcnt(5)
    v_lshlrev_b32 v224, 16, v96
    v_and_b32 v225, 0xffff0000, v96
    v_lshlrev_b32 v226, 16, v97
    v_and_b32 v227, 0xffff0000, v97
    s_waitcnt vmcnt(4)
    v_lshlrev_b32 v228, 16, v98
    v_and_b32 v229, 0xffff0000, v98
    v_lshlrev_b32 v230, 16, v99
    v_and_b32 v231, 0xffff0000, v99
    s_waitcnt vmcnt(3)
    v_lshlrev_b32 v232, 16, v100
    v_and_b32 v233, 0xffff0000, v100
    v_lshlrev_b32 v234, 16, v101
    v_and_b32 v235, 0xffff0000, v101
    v_lshlrev_b32 v236, 16, v102
    v_and_b32 v237, 0xffff0000, v102
    v_lshlrev_b32 v238, 16, v103
    v_and_b32 v239, 0xffff0000, v103
    s_waitcnt vmcnt(2)
    v_lshlrev_b32 v240, 16, v104
    v_and_b32 v241, 0xffff0000, v104
    v_lshlrev_b32 v242, 16, v105
    v_and_b32 v243, 0xffff0000, v105
    v_lshlrev_b32 v244, 16, v106
    v_and_b32 v245, 0xffff0000, v106
    v_lshlrev_b32 v246, 16, v107
    v_and_b32 v247, 0xffff0000, v107
    s_waitcnt vmcnt(1)
    v_lshlrev_b32 v248, 16, v108
    v_and_b32 v249, 0xffff0000, v108
    v_lshlrev_b32 v250, 16, v109
    v_and_b32 v251, 0xffff0000, v109
    v_lshlrev_b32 v252, 16, v110
    v_and_b32 v253, 0xffff0000, v110
    v_lshlrev_b32 v254, 16, v111
    v_and_b32 v255, 0xffff0000, v111
    s_mov_b32 s48, 16384
Ltail_pollp:
    buffer_load_dword v14, v15, s[24:27], s39 offen sc1
    s_sub_u32 s48, s48, 1
    s_cbranch_scc1 Ltail_gotp
    s_waitcnt vmcnt(0) lgkmcnt(0)
    v_cmp_ne_u32 s[36:37], 0, v14
    s_cmp_lg_u64 s[36:37], 0
    s_cbranch_scc1 Ltail_pollp
Ltail_gotp:
    buffer_load_dwordx4 a[0:3], v2, s[28:31], s44 offen offset:0 sc1
    buffer_load_dwordx4 a[4:7], v2, s[28:31], s44 offen offset:768 sc1
    buffer_load_dwordx4 a[8:11], v2, s[28:31], s44 offen offset:1536 sc1
    s_add_u32 s44, s44, 2304
    buffer_load_dwordx4 a[12:15], v2, s[28:31], s44 offen offset:0 sc1
    buffer_load_dwordx4 a[16:19], v2, s[28:31], s44 offen offset:768 sc1
    buffer_load_dwordx4 a[20:23], v2, s[28:31], s44 offen offset:1536 sc1
    s_add_u32 s44, s44, 2304
    buffer_load_dwordx4 a[24:27], v2, s[28:31], s44 offen offset:0 sc1
    buffer_load_dwordx4 a[28:31], v2, s[28:31], s44 offen offset:768 sc1
    buffer_load_dwordx4 a[32:35], v2, s[28:31], s44 offen offset:1536 sc1
    s_add_u32 s44, s44, 2304
    buffer_load_dwordx4 a[36:39], v2, s[28:31], s44 offen offset:0 sc1
    buffer_load_dwordx4 a[40:43], v2, s[28:31], s44 offen offset:768 sc1
    buffer_load_dwordx4 a[44:47], v2, s[28:31], s44 offen offset:1536 sc1
    s_add_u32 s44, s44, 2304
    buffer_load_dwordx4 a[48:51], v2, s[28:31], s44 offen offset:0 sc1
    buffer_load_dwordx4 a[52:55], v2, s[28:31], s44 offen offset:768 sc1
    buffer_load_dwordx4 a[56:59], v2, s[28:31], s44 offen offset:1536 sc1
    s_add_u32 s44, s44, 2304
    buffer_load_dwordx4 a[60:63], v2, s[28:31], s44 offen offset:0 sc1
    buffer_load_dwordx4 a[64:67], v2, s[28:31], s44 offen offset:768 sc1
    buffer_load_dwordx4 a[68:71], v2, s[28:31], s44 offen offset:1536 sc1
    s_add_u32 s44, s44, 2304
    buffer_load_dwordx4 a[72:75], v2, s[28:31], s44 offen offset:0 sc1
    buffer_load_dwordx4 a[76:79], v2, s[28:31], s44 offen offset:768 sc1
    buffer_load_dwordx4 a[80:83], v2, s[28:31], s44 offen offset:1536 sc1
    s_add_u32 s44, s44, 2304
    buffer_load_dwordx4 a[84:87], v2, s[28:31], s44 offen offset:0 sc1
    buffer_load_dwordx4 a[88:91], v2, s[28:31], s44 offen offset:768 sc1
    buffer_load_dwordx4 a[92:95], v2, s[28:31], s44 offen offset:1536 sc1
    s_add_u32 s44, s44, 2304
    buffer_load_dwordx4 a[96:99], v2, s[28:31], s44 offen offset:0 sc1
    buffer_load_dwordx4 a[100:103], v2, s[28:31], s44 offen offset:768 sc1
    buffer_load_dwordx4 a[104:107], v2, s[28:31], s44 offen offset:1536 sc1
    s_add_u32 s44, s44, 2304
    buffer_load_dwordx4 a[108:111], v2, s[28:31], s44 offen offset:0 sc1
    buffer_load_dwordx4 a[112:115], v2, s[28:31], s44 offen offset:768 sc1
    buffer_load_dwordx4 a[116:119], v2, s[28:31], s44 offen offset:1536 sc1
    s_add_u32 s44, s44, 2304
    buffer_load_dwordx4 a[120:123], v2, s[28:31], s44 offen offset:0 sc1
    buffer_load_dwordx4 a[124:127], v2, s[28:31], s44 offen offset:768 sc1
    buffer_load_dwordx4 a[128:131], v2, s[28:31], s44 offen offset:1536 sc1
    s_add_u32 s44, s44, 2304
    buffer_load_dwordx4 a[132:135], v2, s[28:31], s44 offen offset:0 sc1
    buffer_load_dwordx4 a[136:139], v2, s[28:31], s44 offen offset:768 sc1
    buffer_load_dwordx4 a[140:143], v2, s[28:31], s44 offen offset:1536 sc1
    s_add_u32 s44, s44, 2304
    buffer_load_dwordx4 a[144:147], v2, s[28:31], s44 offen offset:0 sc1
    buffer_load_dwordx4 a[148:151], v2, s[28:31], s44 offen offset:768 sc1
    buffer_load_dwordx4 a[152:155], v2, s[28:31], s44 offen offset:1536 sc1
    s_add_u32 s44, s44, 2304
    buffer_load_dwordx4 a[156:159], v2, s[28:31], s44 offen offset:0 sc1
    buffer_load_dwordx4 a[160:163], v2, s[28:31], s44 offen offset:768 sc1
    buffer_load_dwordx4 a[164:167], v2, s[28:31], s44 offen offset:1536 sc1
    s_add_u32 s44, s44, 2304
    buffer_load_dwordx4 a[168:171], v2, s[28:31], s44 offen offset:0 sc1
    buffer_load_dwordx4 a[172:175], v2, s[28:31], s44 offen offset:768 sc1
    buffer_load_dwordx4 a[176:179], v2, s[28:31], s44 offen offset:1536 sc1
    s_add_u32 s44, s44, 2304
    buffer_load_dwordx4 a[180:183], v2, s[28:31], s44 offen offset:0 sc1
    buffer_load_dwordx4 a[184:187], v2, s[28:31], s44 offen offset:768 sc1
    buffer_load_dwordx4 a[188:191], v2, s[28:31], s44 offen offset:1536 sc1
    s_waitcnt vmcnt(47)
    v_mfma_f32_16x16x32_bf16 v[8:11], v[34:37], a[0:3], 0
    v_mfma_f32_16x16x32_bf16 v[12:15], v[32:35], a[0:3], 0
    s_waitcnt vmcnt(46)
    v_mfma_f32_16x16x32_bf16 v[16:19], v[34:37], a[4:7], 0
    v_mfma_f32_16x16x32_bf16 v[20:23], v[32:35], a[4:7], 0
    s_waitcnt vmcnt(45)
    v_mfma_f32_16x16x32_bf16 v[24:27], v[34:37], a[8:11], 0
    v_mfma_f32_16x16x32_bf16 v[28:31], v[32:35], a[8:11], 0
    s_waitcnt vmcnt(44)
    v_mfma_f32_16x16x32_bf16 v[8:11], v[34:37], a[12:15], v[8:11]
    v_mfma_f32_16x16x32_bf16 v[12:15], v[32:35], a[12:15], v[12:15]
    s_waitcnt vmcnt(43)
    v_mfma_f32_16x16x32_bf16 v[16:19], v[34:37], a[16:19], v[16:19]
    v_mfma_f32_16x16x32_bf16 v[20:23], v[32:35], a[16:19], v[20:23]
    s_waitcnt vmcnt(42)
    v_mfma_f32_16x16x32_bf16 v[24:27], v[34:37], a[20:23], v[24:27]
    v_mfma_f32_16x16x32_bf16 v[28:31], v[32:35], a[20:23], v[28:31]
    s_waitcnt vmcnt(41)
    v_mfma_f32_16x16x32_bf16 v[8:11], v[34:37], a[24:27], v[8:11]
    v_mfma_f32_16x16x32_bf16 v[12:15], v[32:35], a[24:27], v[12:15]
    s_waitcnt vmcnt(40)
    v_mfma_f32_16x16x32_bf16 v[16:19], v[34:37], a[28:31], v[16:19]
    v_mfma_f32_16x16x32_bf16 v[20:23], v[32:35], a[28:31], v[20:23]
    s_waitcnt vmcnt(39)
    v_mfma_f32_16x16x32_bf16 v[24:27], v[34:37], a[32:35], v[24:27]
    v_mfma_f32_16x16x32_bf16 v[28:31], v[32:35], a[32:35], v[28:31]
    s_waitcnt vmcnt(38)
    v_mfma_f32_16x16x32_bf16 v[8:11], v[34:37], a[36:39], v[8:11]
    v_mfma_f32_16x16x32_bf16 v[12:15], v[32:35], a[36:39], v[12:15]
    s_waitcnt vmcnt(37)
    v_mfma_f32_16x16x32_bf16 v[16:19], v[34:37], a[40:43], v[16:19]
    v_mfma_f32_16x16x32_bf16 v[20:23], v[32:35], a[40:43], v[20:23]
    s_waitcnt vmcnt(36)
    v_mfma_f32_16x16x32_bf16 v[24:27], v[34:37], a[44:47], v[24:27]
    v_mfma_f32_16x16x32_bf16 v[28:31], v[32:35], a[44:47], v[28:31]
    s_waitcnt vmcnt(35)
    v_mfma_f32_16x16x32_bf16 v[8:11], v[34:37], a[48:51], v[8:11]
    v_mfma_f32_16x16x32_bf16 v[12:15], v[32:35], a[48:51], v[12:15]
    s_waitcnt vmcnt(34)
    v_mfma_f32_16x16x32_bf16 v[16:19], v[34:37], a[52:55], v[16:19]
    v_mfma_f32_16x16x32_bf16 v[20:23], v[32:35], a[52:55], v[20:23]
    s_waitcnt vmcnt(33)
    v_mfma_f32_16x16x32_bf16 v[24:27], v[34:37], a[56:59], v[24:27]
    v_mfma_f32_16x16x32_bf16 v[28:31], v[32:35], a[56:59], v[28:31]
    s_waitcnt vmcnt(32)
    v_mfma_f32_16x16x32_bf16 v[8:11], v[34:37], a[60:63], v[8:11]
    v_mfma_f32_16x16x32_bf16 v[12:15], v[32:35], a[60:63], v[12:15]
    s_waitcnt vmcnt(31)
    v_mfma_f32_16x16x32_bf16 v[16:19], v[34:37], a[64:67], v[16:19]
    v_mfma_f32_16x16x32_bf16 v[20:23], v[32:35], a[64:67], v[20:23]
    s_waitcnt vmcnt(30)
    v_mfma_f32_16x16x32_bf16 v[24:27], v[34:37], a[68:71], v[24:27]
    v_mfma_f32_16x16x32_bf16 v[28:31], v[32:35], a[68:71], v[28:31]
    s_waitcnt vmcnt(29)
    v_mfma_f32_16x16x32_bf16 v[8:11], v[34:37], a[72:75], v[8:11]
    v_mfma_f32_16x16x32_bf16 v[12:15], v[32:35], a[72:75], v[12:15]
    s_waitcnt vmcnt(28)
    v_mfma_f32_16x16x32_bf16 v[16:19], v[34:37], a[76:79], v[16:19]
    v_mfma_f32_16x16x32_bf16 v[20:23], v[32:35], a[76:79], v[20:23]
    s_waitcnt vmcnt(27)
    v_mfma_f32_16x16x32_bf16 v[24:27], v[34:37], a[80:83], v[24:27]
    v_mfma_f32_16x16x32_bf16 v[28:31], v[32:35], a[80:83], v[28:31]
    s_waitcnt vmcnt(26)
    v_mfma_f32_16x16x32_bf16 v[8:11], v[34:37], a[84:87], v[8:11]
    v_mfma_f32_16x16x32_bf16 v[12:15], v[32:35], a[84:87], v[12:15]
    s_waitcnt vmcnt(25)
    v_mfma_f32_16x16x32_bf16 v[16:19], v[34:37], a[88:91], v[16:19]
    v_mfma_f32_16x16x32_bf16 v[20:23], v[32:35], a[88:91], v[20:23]
    s_waitcnt vmcnt(24)
    v_mfma_f32_16x16x32_bf16 v[24:27], v[34:37], a[92:95], v[24:27]
    v_mfma_f32_16x16x32_bf16 v[28:31], v[32:35], a[92:95], v[28:31]
    s_waitcnt vmcnt(23)
    v_mfma_f32_16x16x32_bf16 v[8:11], v[34:37], a[96:99], v[8:11]
    v_mfma_f32_16x16x32_bf16 v[12:15], v[32:35], a[96:99], v[12:15]
    s_waitcnt vmcnt(22)
    v_mfma_f32_16x16x32_bf16 v[16:19], v[34:37], a[100:103], v[16:19]
    v_mfma_f32_16x16x32_bf16 v[20:23], v[32:35], a[100:103], v[20:23]
    s_waitcnt vmcnt(21)
    v_mfma_f32_16x16x32_bf16 v[24:27], v[34:37], a[104:107], v[24:27]
    v_mfma_f32_16x16x32_bf16 v[28:31], v[32:35], a[104:107], v[28:31]
    s_waitcnt vmcnt(20)
    v_mfma_f32_16x16x32_bf16 v[8:11], v[34:37], a[108:111], v[8:11]
    v_mfma_f32_16x16x32_bf16 v[12:15], v[32:35], a[108:111], v[12:15]
    s_waitcnt vmcnt(19)
    v_mfma_f32_16x16x32_bf16 v[16:19], v[34:37], a[112:115], v[16:19]
    v_mfma_f32_16x16x32_bf16 v[20:23], v[32:35], a[112:115], v[20:23]
    s_waitcnt vmcnt(18)
    v_mfma_f32_16x16x32_bf16 v[24:27], v[34:37], a[116:119], v[24:27]
    v_mfma_f32_16x16x32_bf16 v[28:31], v[32:35], a[116:119], v[28:31]
    s_waitcnt vmcnt(17)
    v_mfma_f32_16x16x32_bf16 v[8:11], v[34:37], a[120:123], v[8:11]
    v_mfma_f32_16x16x32_bf16 v[12:15], v[32:35], a[120:123], v[12:15]
    s_waitcnt vmcnt(16)
    v_mfma_f32_16x16x32_bf16 v[16:19], v[34:37], a[124:127], v[16:19]
    v_mfma_f32_16x16x32_bf16 v[20:23], v[32:35], a[124:127], v[20:23]
    s_waitcnt vmcnt(15)
    v_mfma_f32_16x16x32_bf16 v[24:27], v[34:37], a[128:131], v[24:27]
    v_mfma_f32_16x16x32_bf16 v[28:31], v[32:35], a[128:131], v[28:31]
    s_waitcnt vmcnt(14)
    v_mfma_f32_16x16x32_bf16 v[8:11], v[34:37], a[132:135], v[8:11]
    v_mfma_f32_16x16x32_bf16 v[12:15], v[32:35], a[132:135], v[12:15]
    s_waitcnt vmcnt(13)
    v_mfma_f32_16x16x32_bf16 v[16:19], v[34:37], a[136:139], v[16:19]
    v_mfma_f32_16x16x32_bf16 v[20:23], v[32:35], a[136:139], v[20:23]
    s_waitcnt vmcnt(12)
    v_mfma_f32_16x16x32_bf16 v[24:27], v[34:37], a[140:143], v[24:27]
    v_mfma_f32_16x16x32_bf16 v[28:31], v[32:35], a[140:143], v[28:31]
    s_waitcnt vmcnt(11)
    v_mfma_f32_16x16x32_bf16 v[8:11], v[34:37], a[144:147], v[8:11]
    v_mfma_f32_16x16x32_bf16 v[12:15], v[32:35], a[144:147], v[12:15]
    s_waitcnt vmcnt(10)
    v_mfma_f32_16x16x32_bf16 v[16:19], v[34:37], a[148:151], v[16:19]
    v_mfma_f32_16x16x32_bf16 v[20:23], v[32:35], a[148:151], v[20:23]
    s_waitcnt vmcnt(9)
    v_mfma_f32_16x16x32_bf16 v[24:27], v[34:37], a[152:155], v[24:27]
    v_mfma_f32_16x16x32_bf16 v[28:31], v[32:35], a[152:155], v[28:31]
    s_waitcnt vmcnt(8)
    v_mfma_f32_16x16x32_bf16 v[8:11], v[34:37], a[156:159], v[8:11]
    v_mfma_f32_16x16x32_bf16 v[12:15], v[32:35], a[156:159], v[12:15]
    s_waitcnt vmcnt(7)
    v_mfma_f32_16x16x32_bf16 v[16:19], v[34:37], a[160:163], v[16:19]
    v_mfma_f32_16x16x32_bf16 v[20:23], v[32:35], a[160:163], v[20:23]
    s_waitcnt vmcnt(6)
    v_mfma_f32_16x16x32_bf16 v[24:27], v[34:37], a[164:167], v[24:27]
    v_mfma_f32_16x16x32_bf16 v[28:31], v[32:35], a[164:167], v[28:31]
    s_waitcnt vmcnt(5)
    v_mfma_f32_16x16x32_bf16 v[8:11], v[34:37], a[168:171], v[8:11]
    v_mfma_f32_16x16x32_bf16 v[12:15], v[32:35], a[168:171], v[12:15]
    s_waitcnt vmcnt(4)
    v_mfma_f32_16x16x32_bf16 v[16:19], v[34:37], a[172:175], v[16:19]
    v_mfma_f32_16x16x32_bf16 v[20:23], v[32:35], a[172:175], v[20:23]
    s_waitcnt vmcnt(3)
    v_mfma_f32_16x16x32_bf16 v[24:27], v[34:37], a[176:179], v[24:27]
    v_mfma_f32_16x16x32_bf16 v[28:31], v[32:35], a[176:179], v[28:31]
    s_waitcnt vmcnt(2)
    v_mfma_f32_16x16x32_bf16 v[8:11], v[34:37], a[180:183], v[8:11]
    v_mfma_f32_16x16x32_bf16 v[12:15], v[32:35], a[180:183], v[12:15]
    s_waitcnt vmcnt(1)
    v_mfma_f32_16x16x32_bf16 v[16:19], v[34:37], a[184:187], v[16:19]
    v_mfma_f32_16x16x32_bf16 v[20:23], v[32:35], a[184:187], v[20:23]
    s_waitcnt vmcnt(0)
    v_mfma_f32_16x16x32_bf16 v[24:27], v[34:37], a[188:191], v[24:27]
    v_mfma_f32_16x16x32_bf16 v[28:31], v[32:35], a[188:191], v[28:31]
    s_nop 0
    v_pk_fma_f32 v[112:113], v[136:137], v[8:9], v[112:113]
    v_pk_fma_f32 v[114:115], v[138:139], v[10:11], v[114:115]
    v_pk_fma_f32 v[116:117], v[140:141], v[12:13], v[116:117]
    v_pk_fma_f32 v[118:119], v[142:143], v[14:15], v[118:119]
    v_pk_fma_f32 v[120:121], v[144:145], v[16:17], v[120:121]
    v_pk_fma_f32 v[122:123], v[146:147], v[18:19], v[122:123]
    v_pk_fma_f32 v[124:125], v[148:149], v[20:21], v[124:125]
    v_pk_fma_f32 v[126:127], v[150:151], v[22:23], v[126:127]
    v_pk_fma_f32 v[128:129], v[152:153], v[24:25], v[128:129]
    v_pk_fma_f32 v[130:131], v[154:155], v[26:27], v[130:131]
    v_pk_fma_f32 v[132:133], v[156:157], v[28:29], v[132:133]
    v_pk_fma_f32 v[134:135], v[158:159], v[30:31], v[134:135]
    v_cvt_pk_bf16_f32 v64, v112, v113
    v_cvt_pk_bf16_f32 v65, v114, v115
    v_cvt_pk_bf16_f32 v66, v116, v117
    v_cvt_pk_bf16_f32 v67, v118, v119
    v_cvt_pk_bf16_f32 v68, v120, v121
    v_cvt_pk_bf16_f32 v69, v122, v123
    v_cvt_pk_bf16_f32 v70, v124, v125
    v_cvt_pk_bf16_f32 v71, v126, v127
    v_cvt_pk_bf16_f32 v72, v128, v129
    v_cvt_pk_bf16_f32 v73, v130, v131
    v_cvt_pk_bf16_f32 v74, v132, v133
    v_cvt_pk_bf16_f32 v75, v134, v135
    v_lshlrev_b32 v112, 16, v64
    v_and_b32 v113, 0xffff0000, v64
    v_lshlrev_b32 v114, 16, v65
    v_and_b32 v115, 0xffff0000, v65
    v_lshlrev_b32 v116, 16, v66
    v_and_b32 v117, 0xffff0000, v66
    v_lshlrev_b32 v118, 16, v67
    v_and_b32 v119, 0xffff0000, v67
    v_lshlrev_b32 v120, 16, v68
    v_and_b32 v121, 0xffff0000, v68
    v_lshlrev_b32 v122, 16, v69
    v_and_b32 v123, 0xffff0000, v69
    v_lshlrev_b32 v124, 16, v70
    v_and_b32 v125, 0xffff0000, v70
    v_lshlrev_b32 v126, 16, v71
    v_and_b32 v127, 0xffff0000, v71
    v_lshlrev_b32 v128, 16, v72
    v_and_b32 v129, 0xffff0000, v72
    v_lshlrev_b32 v130, 16, v73
    v_and_b32 v131, 0xffff0000, v73
    v_lshlrev_b32 v132, 16, v74
    v_and_b32 v133, 0xffff0000, v74
    v_lshlrev_b32 v134, 16, v75
    v_and_b32 v135, 0xffff0000, v75
    s_mov_b32 s45, 5242880
    buffer_store_dwordx4 v[64:67], v6, s[8:11], s45 offen offset:0 sc1
    buffer_store_dwordx4 v[68:71], v6, s[8:11], s45 offen offset:384 sc1
    buffer_store_dwordx4 v[72:75], v6, s[8:11], s45 offen offset:768 sc1
    v_pk_add_f32 v[56:57], v[112:113], v[114:115]
    v_pk_add_f32 v[58:59], v[116:117], v[118:119]
    v_pk_add_f32 v[56:57], v[56:57], v[120:121]
    v_pk_add_f32 v[58:59], v[58:59], v[122:123]
    v_pk_add_f32 v[56:57], v[56:57], v[124:125]
    v_pk_add_f32 v[58:59], v[58:59], v[126:127]
    v_pk_add_f32 v[56:57], v[56:57], v[128:129]
    v_pk_add_f32 v[58:59], v[58:59], v[130:131]
    v_pk_add_f32 v[56:57], v[56:57], v[132:133]
    v_pk_add_f32 v[58:59], v[58:59], v[134:135]
    v_pk_add_f32 v[56:57], v[56:57], v[58:59]
    v_add_f32 v56, v56, v57
    s_nop 1
    v_add_f32_dpp v56, v56, v56 row_ror:1 row_mask:0xf bank_mask:0xf
    s_nop 1
    v_add_f32_dpp v56, v56, v56 row_ror:2 row_mask:0xf bank_mask:0xf
    s_nop 1
    v_add_f32_dpp v56, v56, v56 row_ror:4 row_mask:0xf bank_mask:0xf
    s_nop 1
    v_add_f32_dpp v56, v56, v56 row_ror:8 row_mask:0xf bank_mask:0xf
    v_mov_b32 v60, v56
    s_nop 1
    v_permlane16_swap_b32 v56, v60
    s_nop 0
    v_add_f32 v56, v56, v60
    v_mul_f32 v56, 0x3ae38e39, v56
    v_pk_add_f32 v[88:89], v[112:113], v[56:57] op_sel_hi:[1,0] neg_lo:[0,1] neg_hi:[0,1]
    v_pk_add_f32 v[90:91], v[114:115], v[56:57] op_sel_hi:[1,0] neg_lo:[0,1] neg_hi:[0,1]
    v_pk_add_f32 v[92:93], v[116:117], v[56:57] op_sel_hi:[1,0] neg_lo:[0,1] neg_hi:[0,1]
    v_pk_add_f32 v[94:95], v[118:119], v[56:57] op_sel_hi:[1,0] neg_lo:[0,1] neg_hi:[0,1]
    v_pk_add_f32 v[96:97], v[120:121], v[56:57] op_sel_hi:[1,0] neg_lo:[0,1] neg_hi:[0,1]
    v_pk_add_f32 v[98:99], v[122:123], v[56:57] op_sel_hi:[1,0] neg_lo:[0,1] neg_hi:[0,1]
    v_pk_add_f32 v[100:101], v[124:125], v[56:57] op_sel_hi:[1,0] neg_lo:[0,1] neg_hi:[0,1]
    v_pk_add_f32 v[102:103], v[126:127], v[56:57] op_sel_hi:[1,0] neg_lo:[0,1] neg_hi:[0,1]
    v_pk_add_f32 v[104:105], v[128:129], v[56:57] op_sel_hi:[1,0] neg_lo:[0,1] neg_hi:[0,1]
    v_pk_add_f32 v[106:107], v[130:131], v[56:57] op_sel_hi:[1,0] neg_lo:[0,1] neg_hi:[0,1]
    v_pk_add_f32 v[108:109], v[132:133], v[56:57] op_sel_hi:[1,0] neg_lo:[0,1] neg_hi:[0,1]
    v_pk_add_f32 v[110:111], v[134:135], v[56:57] op_sel_hi:[1,0] neg_lo:[0,1] neg_hi:[0,1]
    v_pk_mul_f32 v[58:59], v[88:89], v[88:89]
    v_pk_mul_f32 v[60:61], v[90:91], v[90:91]
    v_pk_fma_f32 v[58:59], v[92:93], v[92:93], v[58:59]
    v_pk_fma_f32 v[60:61], v[94:95], v[94:95], v[60:61]
    v_pk_fma_f32 v[58:59], v[96:97], v[96:97], v[58:59]
    v_pk_fma_f32 v[60:61], v[98:99], v[98:99], v[60:61]
    v_pk_fma_f32 v[58:59], v[100:101], v[100:101], v[58:59]
    v_pk_fma_f32 v[60:61], v[102:103], v[102:103], v[60:61]
    v_pk_fma_f32 v[58:59], v[104:105], v[104:105], v[58:59]
    v_pk_fma_f32 v[60:61], v[106:107], v[106:107], v[60:61]
    v_pk_fma_f32 v[58:59], v[108:109], v[108:109], v[58:59]
    v_pk_fma_f32 v[60:61], v[110:111], v[110:111], v[60:61]
    v_pk_add_f32 v[58:59], v[58:59], v[60:61]
    v_add_f32 v58, v58, v59
    v_cndmask_b32 v58, 0, v58, vcc
    s_nop 1
    v_add_f32_dpp v58, v58, v58 row_ror:1 row_mask:0xf bank_mask:0xf
    s_nop 1
    v_add_f32_dpp v58, v58, v58 row_ror:2 row_mask:0xf bank_mask:0xf
    s_nop 1
    v_add_f32_dpp v58, v58, v58 row_ror:4 row_mask:0xf bank_mask:0xf
    s_nop 1
    v_add_f32_dpp v58, v58, v58 row_ror:8 row_mask:0xf bank_mask:0xf
    v_mov_b32 v60, v58
    s_nop 1
    v_permlane16_swap_b32 v58, v60
    s_nop 0
    v_add_f32 v58, v58, v60
    v_mul_f32 v58, 0x3ae38e39, v58
    v_cvt_pk_bf16_f32 v60, v56, v58
    v_and_b32 v58, 0xffff0000, v60
    v_lshlrev_b32 v60, 16, v60
    v_add_f32 v58, 0x3727c5ac, v58
    v_sub_f32 v56, v56, v60
    v_cvt_pk_bf16_f32 v58, v58, v58
    v_and_b32 v58, 0xffff0000, v58
    v_sqrt_f32 v58, v58
    s_nop 0
    v_cvt_pk_bf16_f32 v58, v58, v58
    v_and_b32 v58, 0xffff0000, v58
    v_rcp_f32 v58, v58
    s_nop 0
    v_mul_f32 v56, v56, v58
    v_pk_fma_f32 v[88:89], v[88:89], v[58:59], v[56:57] op_sel_hi:[1,0,0]
    v_pk_fma_f32 v[90:91], v[90:91], v[58:59], v[56:57] op_sel_hi:[1,0,0]
    v_pk_fma_f32 v[92:93], v[92:93], v[58:59], v[56:57] op_sel_hi:[1,0,0]
    v_pk_fma_f32 v[94:95], v[94:95], v[58:59], v[56:57] op_sel_hi:[1,0,0]
    v_pk_fma_f32 v[96:97], v[96:97], v[58:59], v[56:57] op_sel_hi:[1,0,0]
    v_pk_fma_f32 v[98:99], v[98:99], v[58:59], v[56:57] op_sel_hi:[1,0,0]
    v_pk_fma_f32 v[100:101], v[100:101], v[58:59], v[56:57] op_sel_hi:[1,0,0]
    v_pk_fma_f32 v[102:103], v[102:103], v[58:59], v[56:57] op_sel_hi:[1,0,0]
    v_pk_fma_f32 v[104:105], v[104:105], v[58:59], v[56:57] op_sel_hi:[1,0,0]
    v_pk_fma_f32 v[106:107], v[106:107], v[58:59], v[56:57] op_sel_hi:[1,0,0]
    v_pk_fma_f32 v[108:109], v[108:109], v[58:59], v[56:57] op_sel_hi:[1,0,0]
    v_pk_fma_f32 v[110:111], v[110:111], v[58:59], v[56:57] op_sel_hi:[1,0,0]
    v_pk_fma_f32 v[88:89], v[88:89], v[160:161], v[184:185]
    v_pk_fma_f32 v[90:91], v[90:91], v[162:163], v[186:187]
    v_pk_fma_f32 v[92:93], v[92:93], v[164:165], v[188:189]
    v_pk_fma_f32 v[94:95], v[94:95], v[166:167], v[190:191]
    v_pk_fma_f32 v[96:97], v[96:97], v[168:169], v[192:193]
    v_pk_fma_f32 v[98:99], v[98:99], v[170:171], v[194:195]
    v_pk_fma_f32 v[100:101], v[100:101], v[172:173], v[196:197]
    v_pk_fma_f32 v[102:103], v[102:103], v[174:175], v[198:199]
    v_pk_fma_f32 v[104:105], v[104:105], v[176:177], v[200:201]
    v_pk_fma_f32 v[106:107], v[106:107], v[178:179], v[202:203]
    v_pk_fma_f32 v[108:109], v[108:109], v[180:181], v[204:205]
    v_pk_fma_f32 v[110:111], v[110:111], v[182:183], v[206:207]
    v_cvt_pk_bf16_f32 v76, v88, v89
    v_cvt_pk_bf16_f32 v77, v90, v91
    v_cvt_pk_bf16_f32 v78, v92, v93
    v_cvt_pk_bf16_f32 v79, v94, v95
    v_cvt_pk_bf16_f32 v80, v96, v97
    v_cvt_pk_bf16_f32 v81, v98, v99
    v_cvt_pk_bf16_f32 v82, v100, v101
    v_cvt_pk_bf16_f32 v83, v102, v103
    v_cvt_pk_bf16_f32 v84, v104, v105
    v_cvt_pk_bf16_f32 v85, v106, v107
    v_cvt_pk_bf16_f32 v86, v108, v109
    v_cvt_pk_bf16_f32 v87, v110, v111
    s_mov_b32 s45, 2621440
    buffer_store_dwordx4 v[76:79], v6, s[8:11], s45 offen offset:0 sc1
    buffer_store_dwordx4 v[80:83], v6, s[8:11], s45 offen offset:384 sc1
    buffer_store_dwordx4 v[84:87], v6, s[8:11], s45 offen offset:768 sc1
    v_lshlrev_b32 v88, 16, v76
    v_and_b32 v89, 0xffff0000, v76
    v_lshlrev_b32 v90, 16, v77
    v_and_b32 v91, 0xffff0000, v77
    v_lshlrev_b32 v92, 16, v78
    v_and_b32 v93, 0xffff0000, v78
    v_lshlrev_b32 v94, 16, v79
    v_and_b32 v95, 0xffff0000, v79
    v_lshlrev_b32 v96, 16, v80
    v_and_b32 v97, 0xffff0000, v80
    v_lshlrev_b32 v98, 16, v81
    v_and_b32 v99, 0xffff0000, v81
    v_lshlrev_b32 v100, 16, v82
    v_and_b32 v101, 0xffff0000, v82
    v_lshlrev_b32 v102, 16, v83
    v_and_b32 v103, 0xffff0000, v83
    v_lshlrev_b32 v104, 16, v84
    v_and_b32 v105, 0xffff0000, v84
    v_lshlrev_b32 v106, 16, v85
    v_and_b32 v107, 0xffff0000, v85
    v_lshlrev_b32 v108, 16, v86
    v_and_b32 v109, 0xffff0000, v86
    v_lshlrev_b32 v110, 16, v87
    v_and_b32 v111, 0xffff0000, v87
    v_pk_mul_f32 v[58:59], v[88:89], v[208:209]
    v_pk_mul_f32 v[60:61], v[90:91], v[210:211]
    v_pk_fma_f32 v[58:59], v[92:93], v[212:213], v[58:59]
    v_pk_fma_f32 v[60:61], v[94:95], v[214:215], v[60:61]
    v_pk_fma_f32 v[58:59], v[96:97], v[216:217], v[58:59]
    v_pk_fma_f32 v[60:61], v[98:99], v[218:219], v[60:61]
    v_pk_fma_f32 v[58:59], v[100:101], v[220:221], v[58:59]
    v_pk_fma_f32 v[60:61], v[102:103], v[222:223], v[60:61]
    v_pk_fma_f32 v[58:59], v[104:105], v[224:225], v[58:59]
    v_pk_fma_f32 v[60:61], v[106:107], v[226:227], v[60:61]
    v_pk_fma_f32 v[58:59], v[108:109], v[228:229], v[58:59]
    v_pk_fma_f32 v[60:61], v[110:111], v[230:231], v[60:61]
    v_pk_add_f32 v[58:59], v[58:59], v[60:61]
    v_add_f32 v58, v58, v59
    s_nop 1
    v_add_f32_dpp v58, v58, v58 row_ror:1 row_mask:0xf bank_mask:0xf
    s_nop 1
    v_add_f32_dpp v58, v58, v58 row_ror:2 row_mask:0xf bank_mask:0xf
    s_nop 1
    v_add_f32_dpp v58, v58, v58 row_ror:4 row_mask:0xf bank_mask:0xf
    s_nop 1
    v_add_f32_dpp v58, v58, v58 row_ror:8 row_mask:0xf bank_mask:0xf
    v_mov_b32 v60, v58
    s_nop 1
    v_permlane16_swap_b32 v58, v60
    s_nop 0
    v_add_f32 v58, v58, v60
    v_lshlrev_b32 v56, 2, v7
    s_mov_b32 exec_lo, 1
    s_mov_b32 exec_hi, 1
    s_mov_b32 s45, 32768
    buffer_store_dword v58, v56, s[8:11], s45 offen sc1
    v_ashrrev_i32 v60, 31, v58
    v_or_b32 v60, 0x80000000, v60
    v_xor_b32 v60, v60, v58
    v_and_b32 v60, 0xfffff800, v60
    v_min_u32 v60, 0xfffff000, v60
    v_sub_u32 v61, 2047, v7
    v_or_b32 v60, v60, v61
    v_and_b32 v61, 28, v56
    v_add_u32 v61, 53248, v61
    ds_write_b32 v61, v60
    s_mov_b64 exec, -1
    v_pk_mul_f32 v[232:233], v[232:233], v[88:89]
    v_pk_mul_f32 v[234:235], v[234:235], v[90:91]
    v_pk_mul_f32 v[236:237], v[236:237], v[92:93]
    v_pk_mul_f32 v[238:239], v[238:239], v[94:95]
    v_pk_mul_f32 v[240:241], v[240:241], v[96:97]
    v_pk_mul_f32 v[242:243], v[242:243], v[98:99]
    v_pk_mul_f32 v[244:245], v[244:245], v[100:101]
    v_pk_mul_f32 v[246:247], v[246:247], v[102:103]
    v_pk_mul_f32 v[248:249], v[248:249], v[104:105]
    v_pk_mul_f32 v[250:251], v[250:251], v[106:107]
    v_pk_mul_f32 v[252:253], v[252:253], v[108:109]
    v_pk_mul_f32 v[254:255], v[254:255], v[110:111]
    v_cvt_pk_bf16_f32 v40, v232, v233
    v_cvt_pk_bf16_f32 v41, v234, v235
    v_cvt_pk_bf16_f32 v42, v236, v237
    v_cvt_pk_bf16_f32 v43, v238, v239
    v_cvt_pk_bf16_f32 v44, v240, v241
    v_cvt_pk_bf16_f32 v45, v242, v243
    v_cvt_pk_bf16_f32 v46, v244, v245
    v_cvt_pk_bf16_f32 v47, v246, v247
    v_cvt_pk_bf16_f32 v48, v248, v249
    v_cvt_pk_bf16_f32 v49, v250, v251
    v_cvt_pk_bf16_f32 v50, v252, v253
    v_cvt_pk_bf16_f32 v51, v254, v255
    v_lshlrev_b32 v232, 16, v40
    v_and_b32 v233, 0xffff0000, v40
    v_lshlrev_b32 v234, 16, v41
    v_and_b32 v235, 0xffff0000, v41
    v_lshlrev_b32 v236, 16, v42
    v_and_b32 v237, 0xffff0000, v42
    v_lshlrev_b32 v238, 16, v43
    v_and_b32 v239, 0xffff0000, v43
    v_lshlrev_b32 v240, 16, v44
    v_and_b32 v241, 0xffff0000, v44
    v_lshlrev_b32 v242, 16, v45
    v_and_b32 v243, 0xffff0000, v45
    v_lshlrev_b32 v244, 16, v46
    v_and_b32 v245, 0xffff0000, v46
    v_lshlrev_b32 v246, 16, v47
    v_and_b32 v247, 0xffff0000, v47
    v_lshlrev_b32 v248, 16, v48
    v_and_b32 v249, 0xffff0000, v48
    v_lshlrev_b32 v250, 16, v49
    v_and_b32 v251, 0xffff0000, v49
    v_lshlrev_b32 v252, 16, v50
    v_and_b32 v253, 0xffff0000, v50
    v_lshlrev_b32 v254, 16, v51
    v_and_b32 v255, 0xffff0000, v51
    v_pk_add_f32 v[232:233], v[232:233], v[112:113]
    v_pk_add_f32 v[234:235], v[234:235], v[114:115]
    v_pk_add_f32 v[236:237], v[236:237], v[116:117]
    v_pk_add_f32 v[238:239], v[238:239], v[118:119]
    v_pk_add_f32 v[240:241], v[240:241], v[120:121]
    v_pk_add_f32 v[242:243], v[242:243], v[122:123]
    v_pk_add_f32 v[244:245], v[244:245], v[124:125]
    v_pk_add_f32 v[246:247], v[246:247], v[126:127]
    v_pk_add_f32 v[248:249], v[248:249], v[128:129]
    v_pk_add_f32 v[250:251], v[250:251], v[130:131]
    v_pk_add_f32 v[252:253], v[252:253], v[132:133]
    v_pk_add_f32 v[254:255], v[254:255], v[134:135]
    v_cvt_pk_bf16_f32 v40, v232, v233
    v_cvt_pk_bf16_f32 v41, v234, v235
    v_cvt_pk_bf16_f32 v42, v236, v237
    v_cvt_pk_bf16_f32 v43, v238, v239
    v_cvt_pk_bf16_f32 v44, v240, v241
    v_cvt_pk_bf16_f32 v45, v242, v243
    v_cvt_pk_bf16_f32 v46, v244, v245
    v_cvt_pk_bf16_f32 v47, v246, v247
    v_cvt_pk_bf16_f32 v48, v248, v249
    v_cvt_pk_bf16_f32 v49, v250, v251
    v_cvt_pk_bf16_f32 v50, v252, v253
    v_cvt_pk_bf16_f32 v51, v254, v255
    s_waitcnt vmcnt(0) lgkmcnt(0)
    s_barrier
    s_cmp_lg_u32 s3, 0
    s_cbranch_scc1 Ltail_notw0
    v_mov_b32 v20, 53248
    ds_read_b128 v[24:27], v20
    ds_read_b128 v[28:31], v20 offset:16
    s_lshl_b32 s45, s40, 3
    s_add_u32 s45, s45, 7860224
    v_mov_b32 v21, 0
    s_waitcnt lgkmcnt(1)
    v_max_u32 v16, v24, v25
    v_min_u32 v17, v24, v25
    v_med3_u32 v17, v16, v17, v26
    v_max_u32 v16, v16, v26
    v_med3_u32 v17, v16, v17, v27
    v_max_u32 v16, v16, v27
    s_waitcnt lgkmcnt(0)
    v_med3_u32 v17, v16, v17, v28
    v_max_u32 v16, v16, v28
    v_med3_u32 v17, v16, v17, v29
    v_max_u32 v16, v16, v29
    v_med3_u32 v17, v16, v17, v30
    v_max_u32 v16, v16, v30
    v_med3_u32 v17, v16, v17, v31
    v_max_u32 v16, v16, v31
    s_mov_b64 exec, 1
    buffer_store_dwordx2 v[16:17], v21, s[8:11], s45 offen sc1
    s_mov_b64 exec, -1
Ltail_notw0:
    s_mov_b32 s38, 135168
    s_mov_b32 s39, 8192
    v_lshrrev_b32 v9, 2, v1
    v_and_b32 v10, 3, v1
    v_lshlrev_b32 v10, 3, v10
    s_and_b32 s45, s3, 1
    s_lshl_b32 s45, s45, 5
    v_lshl_add_u32 v11, v9, 6, v10
    v_add_u32 v11, s45, v11
    s_cmp_lt_u32 s3, 2
    s_cselect_b32 s44, 98304, s38
    s_cselect_b32 s45, 98304, s39
    v_add_u32 v12, s45, v11
    v_add_u32 v11, s44, v11
    ds_read_b64_tr_b16 a[0:1], v11 offset:0
    ds_read_b64_tr_b16 a[2:3], v11 offset:1024
    ds_read_b64_tr_b16 a[4:5], v11 offset:2048
    ds_read_b64_tr_b16 a[6:7], v11 offset:3072
    ds_read_b64_tr_b16 a[8:9], v11 offset:4096
    ds_read_b64_tr_b16 a[10:11], v11 offset:5120
    ds_read_b64_tr_b16 a[12:13], v11 offset:6144
    ds_read_b64_tr_b16 a[14:15], v11 offset:7168
    ds_read_b64_tr_b16 a[16:17], v11 offset:8192
    ds_read_b64_tr_b16 a[18:19], v11 offset:9216
    ds_read_b64_tr_b16 a[20:21], v11 offset:10240
    ds_read_b64_tr_b16 a[22:23], v11 offset:11264
    ds_read_b64_tr_b16 a[24:25], v11 offset:12288
    ds_read_b64_tr_b16 a[26:27], v11 offset:13312
    ds_read_b64_tr_b16 a[28:29], v11 offset:14336
    ds_read_b64_tr_b16 a[30:31], v11 offset:15360
    ds_read_b64_tr_b16 a[32:33], v11 offset:16384
    ds_read_b64_tr_b16 a[34:35], v11 offset:17408
    ds_read_b64_tr_b16 a[36:37], v11 offset:18432
    ds_read_b64_tr_b16 a[38:39], v11 offset:19456
    ds_read_b64_tr_b16 a[40:41], v11 offset:20480
    ds_read_b64_tr_b16 a[42:43], v11 offset:21504
    ds_read_b64_tr_b16 a[44:45], v11 offset:22528
    ds_read_b64_tr_b16 a[46:47], v11 offset:23552
    ds_read_b64_tr_b16 a[48:49], v11 offset:24576
    ds_read_b64_tr_b16 a[50:51], v11 offset:25600
    ds_read_b64_tr_b16 a[52:53], v11 offset:26624
    ds_read_b64_tr_b16 a[54:55], v11 offset:27648
    ds_read_b64_tr_b16 a[56:57], v12 offset:28672
    ds_read_b64_tr_b16 a[58:59], v12 offset:29696
    ds_read_b64_tr_b16 a[60:61], v12 offset:30720
    ds_read_b64_tr_b16 a[62:63], v12 offset:31744
    ds_read_b64_tr_b16 a[64:65], v12 offset:32768
    ds_read_b64_tr_b16 a[66:67], v12 offset:33792
    ds_read_b64_tr_b16 a[68:69], v12 offset:34816
    ds_read_b64_tr_b16 a[70:71], v12 offset:35840
    v_mul_u32_u24 v12, 1152, v9
    s_lshl_b32 s44, s3, 7
    s_add_u32 s44, s44, 0
    v_add3_u32 v12, v12, v10, s44
    ds_read_b64_tr_b16 a[72:73], v12 offset:0
    ds_read_b64_tr_b16 a[74:75], v12 offset:18432
    ds_read_b64_tr_b16 a[76:77], v12 offset:32
    ds_read_b64_tr_b16 a[78:79], v12 offset:18464
    ds_read_b64_tr_b16 a[80:81], v12 offset:64
    ds_read_b64_tr_b16 a[82:83], v12 offset:18496
    ds_read_b64_tr_b16 a[84:85], v12 offset:96
    ds_read_b64_tr_b16 a[86:87], v12 offset:18528
    ds_read_b64_tr_b16 a[88:89], v12 offset:512
    ds_read_b64_tr_b16 a[90:91], v12 offset:18944
    ds_read_b64_tr_b16 a[92:93], v12 offset:544
    ds_read_b64_tr_b16 a[94:95], v12 offset:18976
    ds_read_b64_tr_b16 a[96:97], v12 offset:576
    ds_read_b64_tr_b16 a[98:99], v12 offset:19008
    ds_read_b64_tr_b16 a[100:101], v12 offset:608
    ds_read_b64_tr_b16 a[102:103], v12 offset:19040
    ds_read_b64_tr_b16 a[104:105], v12 offset:1024
    ds_read_b64_tr_b16 a[106:107], v12 offset:19456
    ds_read_b64_tr_b16 a[108:109], v12 offset:1056
    ds_read_b64_tr_b16 a[110:111], v12 offset:19488
    ds_read_b64_tr_b16 a[112:113], v12 offset:1088
    ds_read_b64_tr_b16 a[114:115], v12 offset:19520
    ds_read_b64_tr_b16 a[116:117], v12 offset:1120
    ds_read_b64_tr_b16 a[118:119], v12 offset:19552
    v_lshlrev_b32 v13, 4, v1
    v_add_u32 v13, 49152, v13
    s_lshl_b32 s44, s3, 10
    v_add_u32 v14, s44, v13
    v_bfe_u32 v15, v1, 2, 2
    v_cmp_eq_u32 s[52:53], 0, v15
    v_cmp_eq_u32 s[54:55], 1, v15
    v_cmp_eq_u32 s[56:57], 2, v15
    v_cmp_eq_u32 s[58:59], 3, v15
    s_mul_i32 s43, s42, 18
    s_add_u32 s43, s43, s41
    s_lshl_b32 s43, s43, 9
    s_mul_i32 s44, s3, 73728
    s_add_u32 s43, s43, s44
    v_lshlrev_b32 v15, 3, v1
    s_cmp_lg_u32 s3, 0
    s_cbranch_scc1 Ltail_join
    v_lshlrev_b32 v22, 4, v1
    v_mov_b32 v20, 53248
    s_mov_b32 s45, 7860224
    s_mov_b32 s48, 16384
Ltail_pollk:
    buffer_load_dwordx4 v[24:27], v22, s[8:11], s45 offen sc1
    buffer_load_dwordx4 v[28:31], v22, s[8:11], s45 offen offset:1024 sc1
    s_sub_u32 s48, s48, 1
    s_cbranch_scc1 Ltail_gotk
    s_waitcnt vmcnt(0) lgkmcnt(0)
    v_max_u32 v16, v24, v25
    v_min_u32 v17, v24, v25
    v_med3_u32 v17, v16, v17, v26
    v_max_u32 v16, v16, v26
    v_med3_u32 v17, v16, v17, v27
    v_max_u32 v16, v16, v27
    v_med3_u32 v17, v16, v17, v28
    v_max_u32 v16, v16, v28
    v_med3_u32 v17, v16, v17, v29
    v_max_u32 v16, v16, v29
    v_med3_u32 v17, v16, v17, v30
    v_max_u32 v16, v16, v30
    v_med3_u32 v17, v16, v17, v31
    v_max_u32 v16, v16, v31
    v_cmp_eq_u32 vcc, -1, v16
    s_cbranch_vccnz Ltail_pollk
Ltail_gotk:
    s_waitcnt vmcnt(0) lgkmcnt(0)
    v_mov_b32_dpp v18, v16 row_ror:1 row_mask:0xf bank_mask:0xf
    v_mov_b32_dpp v19, v17 row_ror:1 row_mask:0xf bank_mask:0xf
    v_min_u32 v23, v16, v18
    v_max_u32 v16, v16, v18
    v_max3_u32 v17, v23, v17, v19
    s_nop 0
    v_mov_b32_dpp v18, v16 row_ror:2 row_mask:0xf bank_mask:0xf
    v_mov_b32_dpp v19, v17 row_ror:2 row_mask:0xf bank_mask:0xf
    v_min_u32 v23, v16, v18
    v_max_u32 v16, v16, v18
    v_max3_u32 v17, v23, v17, v19
    s_nop 0
    v_mov_b32_dpp v18, v16 row_ror:4 row_mask:0xf bank_mask:0xf
    v_mov_b32_dpp v19, v17 row_ror:4 row_mask:0xf bank_mask:0xf
    v_min_u32 v23, v16, v18
    v_max_u32 v16, v16, v18
    v_max3_u32 v17, v23, v17, v19
    s_nop 0
    v_mov_b32_dpp v18, v16 row_ror:8 row_mask:0xf bank_mask:0xf
    v_mov_b32_dpp v19, v17 row_ror:8 row_mask:0xf bank_mask:0xf
    v_min_u32 v23, v16, v18
    v_max_u32 v16, v16, v18
    v_max3_u32 v17, v23, v17, v19
    v_mov_b32 v18, v16
    v_mov_b32 v19, v17
    s_nop 0
    v_permlane16_swap_b32 v16, v18
    v_permlane16_swap_b32 v17, v19
    v_min_u32 v23, v16, v18
    v_max_u32 v16, v16, v18
    v_max3_u32 v17, v23, v17, v19
    v_mov_b32 v18, v16
    v_mov_b32 v19, v17
    s_nop 0
    v_permlane32_swap_b32 v16, v18
    v_permlane32_swap_b32 v17, v19
    v_min_u32 v23, v16, v18
    v_max_u32 v16, v16, v18
    v_max3_u32 v17, v23, v17, v19
    v_and_b32 v16, 0x7ff, v16
    v_and_b32 v17, 0x7ff, v17
    v_sub_u32 v16, 2047, v16
    v_sub_u32 v17, 2047, v17
    ds_write_b64 v20, v[16:17] offset:64
    s_cmp_eq_u32 s2, 0
    s_cselect_b32 s45, 24576, -4
    s_add_u32 s36, s94, 1
    v_mov_b32 v18, s36
    v_mov_b32 v19, 0
    s_mov_b64 exec, 1
    buffer_store_dword v18, v19, s[8:11], s45 offen
    s_mov_b64 exec, -1
Ltail_join:
    s_waitcnt lgkmcnt(0)
    s_barrier
    v_mov_b32 v8, 53312
    ds_read_b64 v[8:9], v8
    s_waitcnt lgkmcnt(0)
    v_readfirstlane_b32 s46, v8
    v_readfirstlane_b32 s47, v9
    s_cmp_ge_u32 s41, 18
    s_cbranch_scc1 Ltail_noffn
    s_mul_i32 s44, s46, 1152
    s_mul_i32 s45, s47, 1152
    s_sub_u32 s45, s45, s44
    v_and_b32 v8, 1, v1
    v_mul_lo_u32 v8, v8, s45
    v_and_b32 v9, 48, v1
    v_add3_u32 v8, v8, v9, s44
    s_mov_b32 s45, 2621440
    buffer_load_dwordx4 a[128:131], v8, s[8:11], s45 offen offset:0 sc1
    buffer_load_dwordx4 a[132:135], v8, s[8:11], s45 offen offset:64 sc1
    buffer_load_dwordx4 a[136:139], v8, s[8:11], s45 offen offset:128 sc1
    buffer_load_dwordx4 a[140:143], v8, s[8:11], s45 offen offset:192 sc1
    buffer_load_dwordx4 a[144:147], v8, s[8:11], s45 offen offset:256 sc1
    buffer_load_dwordx4 a[148:151], v8, s[8:11], s45 offen offset:320 sc1
    buffer_load_dwordx4 a[152:155], v8, s[8:11], s45 offen offset:384 sc1
    buffer_load_dwordx4 a[156:159], v8, s[8:11], s45 offen offset:448 sc1
    buffer_load_dwordx4 a[160:163], v8, s[8:11], s45 offen offset:512 sc1
    buffer_load_dwordx4 a[164:167], v8, s[8:11], s45 offen offset:576 sc1
    buffer_load_dwordx4 a[168:171], v8, s[8:11], s45 offen offset:640 sc1
    buffer_load_dwordx4 a[172:175], v8, s[8:11], s45 offen offset:704 sc1
    buffer_load_dwordx4 a[176:179], v8, s[8:11], s45 offen offset:768 sc1
    buffer_load_dwordx4 a[180:183], v8, s[8:11], s45 offen offset:832 sc1
    buffer_load_dwordx4 a[184:187], v8, s[8:11], s45 offen offset:896 sc1
    buffer_load_dwordx4 a[188:191], v8, s[8:11], s45 offen offset:960 sc1
    buffer_load_dwordx4 a[192:195], v8, s[8:11], s45 offen offset:1024 sc1
    buffer_load_dwordx4 a[196:199], v8, s[8:11], s45 offen offset:1088 sc1
    v_cmp_ne_u32 vcc, s46, v7
    v_cmp_ne_u32 s[36:37], s47, v7
    v_mov_b32 v31, 2147483648
    s_and_b64 vcc, vcc, s[36:37]
    s_nop 1
    v_cndmask_b32 v31, v31, v4, vcc
    buffer_store_dwordx2 v[40:41], v31, s[16:19], 0 offen offset:0
    buffer_store_dwordx2 v[42:43], v31, s[16:19], 0 offen offset:32
    buffer_store_dwordx2 v[44:45], v31, s[16:19], 0 offen offset:384
    buffer_store_dwordx2 v[46:47], v31, s[16:19], 0 offen offset:416
    buffer_store_dwordx2 v[48:49], v31, s[16:19], 0 offen offset:768
    buffer_store_dwordx2 v[50:51], v31, s[16:19], 0 offen offset:800
    s_waitcnt lgkmcnt(0)
    s_waitcnt vmcnt(23)
    v_mfma_f32_16x16x32_bf16 v[16:19], a[0:3], a[128:131], 0
    s_waitcnt vmcnt(22)
    v_mfma_f32_16x16x32_bf16 v[20:23], a[4:7], a[132:135], 0
    s_waitcnt vmcnt(21)
    v_mfma_f32_16x16x32_bf16 v[16:19], a[8:11], a[136:139], v[16:19]
    s_waitcnt vmcnt(20)
    v_mfma_f32_16x16x32_bf16 v[20:23], a[12:15], a[140:143], v[20:23]
    s_waitcnt vmcnt(19)
    v_mfma_f32_16x16x32_bf16 v[16:19], a[16:19], a[144:147], v[16:19]
    s_waitcnt vmcnt(18)
    v_mfma_f32_16x16x32_bf16 v[20:23], a[20:23], a[148:151], v[20:23]
    s_waitcnt vmcnt(17)
    v_mfma_f32_16x16x32_bf16 v[16:19], a[24:27], a[152:155], v[16:19]
    s_waitcnt vmcnt(16)
    v_mfma_f32_16x16x32_bf16 v[20:23], a[28:31], a[156:159], v[20:23]
    s_waitcnt vmcnt(15)
    v_mfma_f32_16x16x32_bf16 v[16:19], a[32:35], a[160:163], v[16:19]
    s_waitcnt vmcnt(14)
    v_mfma_f32_16x16x32_bf16 v[20:23], a[36:39], a[164:167], v[20:23]
    s_waitcnt vmcnt(13)
    v_mfma_f32_16x16x32_bf16 v[16:19], a[40:43], a[168:171], v[16:19]
    s_waitcnt vmcnt(12)
    v_mfma_f32_16x16x32_bf16 v[20:23], a[44:47], a[172:175], v[20:23]
    s_waitcnt vmcnt(11)
    v_mfma_f32_16x16x32_bf16 v[16:19], a[48:51], a[176:179], v[16:19]
    s_waitcnt vmcnt(10)
    v_mfma_f32_16x16x32_bf16 v[20:23], a[52:55], a[180:183], v[20:23]
    s_waitcnt vmcnt(9)
    v_mfma_f32_16x16x32_bf16 v[16:19], a[56:59], a[184:187], v[16:19]
    s_waitcnt vmcnt(8)
    v_mfma_f32_16x16x32_bf16 v[20:23], a[60:63], a[188:191], v[20:23]
    s_waitcnt vmcnt(7)
    v_mfma_f32_16x16x32_bf16 v[16:19], a[64:67], a[192:195], v[16:19]
    s_waitcnt vmcnt(6)
    v_mfma_f32_16x16x32_bf16 v[20:23], a[68:71], a[196:199], v[20:23]
    s_nop 7
    v_pk_add_f32 v[16:17], v[16:17], v[20:21]
    v_pk_add_f32 v[18:19], v[18:19], v[22:23]
    ds_write_b128 v14, v[16:19]
    s_waitcnt lgkmcnt(0)
    s_barrier
    ds_read_b128 v[16:19], v13 offset:0
    ds_read_b128 v[20:23], v13 offset:1024
    ds_read_b128 v[24:27], v13 offset:2048
    ds_read_b128 v[28:31], v13 offset:3072
    s_mov_b32 s36, 0xbfb8aa3b
    s_mov_b32 s37, 0xbfb8aa3b
    s_waitcnt lgkmcnt(3)
    v_cvt_pk_bf16_f32 v32, v16, v17
    v_cvt_pk_bf16_f32 v33, v18, v19
    s_waitcnt lgkmcnt(2)
    v_cvt_pk_bf16_f32 v34, v20, v21
    v_cvt_pk_bf16_f32 v35, v22, v23
    v_lshlrev_b32 v16, 16, v32
    v_and_b32 v17, 0xffff0000, v32
    v_lshlrev_b32 v18, 16, v33
    v_and_b32 v19, 0xffff0000, v33
    v_lshlrev_b32 v20, 16, v34
    v_and_b32 v21, 0xffff0000, v34
    v_lshlrev_b32 v22, 16, v35
    v_and_b32 v23, 0xffff0000, v35
    v_pk_mul_f32 v[32:33], v[16:17], s[36:37]
    v_pk_mul_f32 v[34:35], v[18:19], s[36:37]
    v_pk_mul_f32 v[36:37], v[20:21], s[36:37]
    v_pk_mul_f32 v[38:39], v[22:23], s[36:37]
    v_exp_f32 v32, v32
    v_exp_f32 v33, v33
    v_exp_f32 v34, v34
    v_exp_f32 v35, v35
    v_exp_f32 v36, v36
    v_exp_f32 v37, v37
    v_exp_f32 v38, v38
    v_exp_f32 v39, v39
    s_waitcnt lgkmcnt(1)
    v_cvt_pk_bf16_f32 v60, v24, v25
    v_cvt_pk_bf16_f32 v61, v26, v27
    s_waitcnt lgkmcnt(0)
    v_cvt_pk_bf16_f32 v62, v28, v29
    v_cvt_pk_bf16_f32 v63, v30, v31
    v_pk_add_f32 v[32:33], v[32:33], 1.0 op_sel_hi:[1,0]
    v_pk_add_f32 v[34:35], v[34:35], 1.0 op_sel_hi:[1,0]
    v_pk_add_f32 v[36:37], v[36:37], 1.0 op_sel_hi:[1,0]
    v_pk_add_f32 v[38:39], v[38:39], 1.0 op_sel_hi:[1,0]
    v_rcp_f32 v32, v32
    v_rcp_f32 v33, v33
    v_rcp_f32 v34, v34
    v_rcp_f32 v35, v35
    v_rcp_f32 v36, v36
    v_rcp_f32 v37, v37
    v_rcp_f32 v38, v38
    v_rcp_f32 v39, v39
    v_lshlrev_b32 v24, 16, v60
    v_and_b32 v25, 0xffff0000, v60
    v_lshlrev_b32 v26, 16, v61
    v_and_b32 v27, 0xffff0000, v61
    v_lshlrev_b32 v28, 16, v62
    v_and_b32 v29, 0xffff0000, v62
    v_lshlrev_b32 v30, 16, v63
    v_and_b32 v31, 0xffff0000, v63
    v_pk_mul_f32 v[16:17], v[16:17], v[32:33]
    v_pk_mul_f32 v[18:19], v[18:19], v[34:35]
    v_pk_mul_f32 v[20:21], v[20:21], v[36:37]
    v_pk_mul_f32 v[22:23], v[22:23], v[38:39]
    v_cvt_pk_bf16_f32 v32, v16, v17
    v_cvt_pk_bf16_f32 v33, v18, v19
    v_cvt_pk_bf16_f32 v34, v20, v21
    v_cvt_pk_bf16_f32 v35, v22, v23
    v_lshlrev_b32 v16, 16, v32
    v_and_b32 v17, 0xffff0000, v32
    v_lshlrev_b32 v18, 16, v33
    v_and_b32 v19, 0xffff0000, v33
    v_lshlrev_b32 v20, 16, v34
    v_and_b32 v21, 0xffff0000, v34
    v_lshlrev_b32 v22, 16, v35
    v_and_b32 v23, 0xffff0000, v35
    v_pk_mul_f32 v[16:17], v[16:17], v[24:25]
    v_pk_mul_f32 v[18:19], v[18:19], v[26:27]
    v_pk_mul_f32 v[20:21], v[20:21], v[28:29]
    v_pk_mul_f32 v[22:23], v[22:23], v[30:31]
    v_cvt_pk_bf16_f32 v32, v16, v17
    v_cvt_pk_bf16_f32 v33, v18, v19
    v_cvt_pk_bf16_f32 v34, v20, v21
    v_cvt_pk_bf16_f32 v35, v22, v23
    v_cndmask_b32 v64, 0, v32, s[52:53]
    v_cndmask_b32 v65, 0, v33, s[52:53]
    v_cndmask_b32 v66, 0, v34, s[52:53]
    v_cndmask_b32 v67, 0, v35, s[52:53]
    v_cndmask_b32 v68, 0, v32, s[54:55]
    v_cndmask_b32 v69, 0, v33, s[54:55]
    v_cndmask_b32 v70, 0, v34, s[54:55]
    v_cndmask_b32 v71, 0, v35, s[54:55]
    v_cndmask_b32 v72, 0, v32, s[56:57]
    v_cndmask_b32 v73, 0, v33, s[56:57]
    v_cndmask_b32 v74, 0, v34, s[56:57]
    v_cndmask_b32 v75, 0, v35, s[56:57]
    v_cndmask_b32 v76, 0, v32, s[58:59]
    v_cndmask_b32 v77, 0, v33, s[58:59]
    v_cndmask_b32 v78, 0, v34, s[58:59]
    v_cndmask_b32 v79, 0, v35, s[58:59]
    v_mfma_f32_16x16x32_bf16 v[16:19], v[64:67], a[72:75], 0
    v_mfma_f32_16x16x32_bf16 v[16:19], v[68:71], a[76:79], v[16:19]
    v_mfma_f32_16x16x32_bf16 v[16:19], v[72:75], a[80:83], v[16:19]
    v_mfma_f32_16x16x32_bf16 v[16:19], v[76:79], a[84:87], v[16:19]
    v_mfma_f32_16x16x32_bf16 v[20:23], v[64:67], a[88:91], 0
    v_mfma_f32_16x16x32_bf16 v[20:23], v[68:71], a[92:95], v[20:23]
    v_mfma_f32_16x16x32_bf16 v[20:23], v[72:75], a[96:99], v[20:23]
    v_mfma_f32_16x16x32_bf16 v[20:23], v[76:79], a[100:103], v[20:23]
    v_mfma_f32_16x16x32_bf16 v[24:27], v[64:67], a[104:107], 0
    v_mfma_f32_16x16x32_bf16 v[24:27], v[68:71], a[108:111], v[24:27]
    v_mfma_f32_16x16x32_bf16 v[24:27], v[72:75], a[112:115], v[24:27]
    v_mfma_f32_16x16x32_bf16 v[24:27], v[76:79], a[116:119], v[24:27]
    v_min_u32 v16, -2, v16
    v_min_u32 v17, -2, v17
    buffer_store_dwordx2 v[16:17], v15, s[32:35], s43 offen sc1
    s_add_u32 s43, s43, 294912
    v_min_u32 v20, -2, v20
    v_min_u32 v21, -2, v21
    buffer_store_dwordx2 v[20:21], v15, s[32:35], s43 offen sc1
    s_add_u32 s43, s43, 294912
    v_min_u32 v24, -2, v24
    v_min_u32 v25, -2, v25
    buffer_store_dwordx2 v[24:25], v15, s[32:35], s43 offen sc1
    s_branch Ltail_done
Ltail_noffn:
    s_cmp_lt_u32 s41, 27
    s_cselect_b32 s36, s3, 1
    s_cmp_eq_u32 s36, 0
    s_cbranch_scc1 Ltail_final
    v_cmp_ne_u32 vcc, s46, v7
    v_cmp_ne_u32 s[36:37], s47, v7
    v_mov_b32 v31, 2147483648
    s_and_b64 vcc, vcc, s[36:37]
    s_nop 1
    v_cndmask_b32 v31, v31, v4, vcc
    buffer_store_dwordx2 v[40:41], v31, s[16:19], 0 offen offset:0
    buffer_store_dwordx2 v[42:43], v31, s[16:19], 0 offen offset:32
    buffer_store_dwordx2 v[44:45], v31, s[16:19], 0 offen offset:384
    buffer_store_dwordx2 v[46:47], v31, s[16:19], 0 offen offset:416
    buffer_store_dwordx2 v[48:49], v31, s[16:19], 0 offen offset:768
    buffer_store_dwordx2 v[50:51], v31, s[16:19], 0 offen offset:800
    s_branch Ltail_done
Ltail_final:
    s_mul_i32 s43, s42, 9
    s_add_u32 s43, s43, s41
    s_sub_u32 s43, s43, 18
    v_bfe_u32 v8, v1, 2, 1
    v_cmp_eq_u32 vcc, 1, v8
    v_mov_b32 v9, s46
    v_mov_b32 v10, s47
    v_and_b32 v11, 3, v1
    v_cndmask_b32 v9, v9, v10, vcc
    s_lshr_b32 s44, s43, 2
    s_lshl_b32 s44, s44, 6
    s_and_b32 s45, s43, 1
    s_lshl_b32 s45, s45, 5
    s_add_u32 s44, s44, s45
    s_and_b32 s45, s43, 2
    s_lshl_b32 s45, s45, 2
    s_add_u32 s44, s44, s45
    v_lshrrev_b32 v12, 1, v11
    v_lshl_add_u32 v12, v12, 4, s44
    v_and_b32 v13, 1, v11
    v_lshl_add_u32 v12, v13, 2, v12
    v_mul_u32_u24 v13, 1152, v9
    v_add_u32 v14, v13, v12
    v_lshlrev_b32 v15, 2, v9
    s_mov_b32 s45, 5242880
    buffer_load_dword v16, v14, s[8:11], s45 offen sc1
    s_mov_b32 s45, 2621440
    buffer_load_dword v17, v14, s[8:11], s45 offen sc1
    s_mov_b32 s45, 22144
    buffer_load_dword v18, v12, s[8:11], s45 offen sc1
    s_mov_b32 s45, 32768
    buffer_load_dword v19, v15, s[8:11], s45 offen sc1
    s_lshl_b32 s45, s43, 4
    v_lshl_add_u32 v13, v11, 2, v13
    v_add_u32 v13, s45, v13
    v_lshrrev_b32 v14, 2, v1
    v_lshlrev_b32 v14, 9, v14
    v_lshl_add_u32 v14, v11, 4, v14
    s_lshr_b32 s44, s43, 3
    s_mul_i32 s44, s44, 73728
    s_and_b32 s45, s43, 7
    s_lshl_b32 s45, s45, 6
    s_add_u32 s44, s44, s45
    v_cmp_ne_u32 vcc, s46, v7
    v_cmp_ne_u32 s[36:37], s47, v7
    v_mov_b32 v31, 2147483648
    s_and_b64 vcc, vcc, s[36:37]
    s_nop 1
    v_cndmask_b32 v31, v31, v4, vcc
    buffer_store_dwordx2 v[40:41], v31, s[16:19], 0 offen offset:0
    buffer_store_dwordx2 v[42:43], v31, s[16:19], 0 offen offset:32
    buffer_store_dwordx2 v[44:45], v31, s[16:19], 0 offen offset:384
    buffer_store_dwordx2 v[46:47], v31, s[16:19], 0 offen offset:416
    buffer_store_dwordx2 v[48:49], v31, s[16:19], 0 offen offset:768
    buffer_store_dwordx2 v[50:51], v31, s[16:19], 0 offen offset:800
    v_cmp_eq_u32 s[36:37], 1, v8
    s_waitcnt vmcnt(6)
    v_cvt_pk_bf16_f32 v19, v19, v19
    v_and_b32 v19, 0xffff0000, v19
    v_mul_f32 v19, 0xbfb8aa3b, v19
    v_exp_f32 v19, v19
    v_lshlrev_b32 v20, 16, v16
    v_and_b32 v21, 0xffff0000, v16
    v_lshlrev_b32 v22, 16, v17
    v_and_b32 v23, 0xffff0000, v17
    v_lshlrev_b32 v24, 16, v18
    v_and_b32 v25, 0xffff0000, v18
    v_add_f32 v19, 1.0, v19
    v_rcp_f32 v19, v19
    s_mov_b32 s48, 16384
    v_cvt_pk_bf16_f32 v19, v19, v19
    v_and_b32 v19, 0xffff0000, v19
Ltail_polly:
    s_add_u32 s45, s44, 0
    buffer_load_dwordx4 v[64:67], v14, s[32:35], s45 offen sc1
    s_add_u32 s45, s44, 8192
    buffer_load_dwordx4 v[68:71], v14, s[32:35], s45 offen sc1
    s_add_u32 s45, s44, 16384
    buffer_load_dwordx4 v[72:75], v14, s[32:35], s45 offen sc1
    s_add_u32 s45, s44, 24576
    buffer_load_dwordx4 v[76:79], v14, s[32:35], s45 offen sc1
    s_add_u32 s45, s44, 32768
    buffer_load_dwordx4 v[80:83], v14, s[32:35], s45 offen sc1
    s_add_u32 s45, s44, 40960
    buffer_load_dwordx4 v[84:87], v14, s[32:35], s45 offen sc1
    s_add_u32 s45, s44, 49152
    buffer_load_dwordx4 v[88:91], v14, s[32:35], s45 offen sc1
    s_add_u32 s45, s44, 57344
    buffer_load_dwordx4 v[92:95], v14, s[32:35], s45 offen sc1
    s_add_u32 s45, s44, 65536
    buffer_load_dwordx4 v[96:99], v14, s[32:35], s45 offen sc1
    s_sub_u32 s48, s48, 1
    s_cbranch_scc1 Ltail_goty
    s_waitcnt vmcnt(8)
    v_max3_u32 v26, v64, v65, v66
    s_waitcnt vmcnt(7)
    v_max3_u32 v26, v26, v67, v68
    v_max3_u32 v26, v26, v69, v70
    s_waitcnt vmcnt(6)
    v_max3_u32 v26, v26, v71, v72
    v_max3_u32 v26, v26, v73, v74
    s_waitcnt vmcnt(5)
    v_max3_u32 v26, v26, v75, v76
    v_max3_u32 v26, v26, v77, v78
    s_waitcnt vmcnt(4)
    v_max3_u32 v26, v26, v79, v80
    v_max3_u32 v26, v26, v81, v82
    s_waitcnt vmcnt(3)
    v_max3_u32 v26, v26, v83, v84
    v_max3_u32 v26, v26, v85, v86
    s_waitcnt vmcnt(2)
    v_max3_u32 v26, v26, v87, v88
    v_max3_u32 v26, v26, v89, v90
    s_waitcnt vmcnt(1)
    v_max3_u32 v26, v26, v91, v92
    v_max3_u32 v26, v26, v93, v94
    s_waitcnt vmcnt(0)
    v_max3_u32 v26, v26, v95, v96
    v_max3_u32 v26, v26, v97, v98
    v_max_u32 v26, v26, v99
    v_cmp_eq_u32 vcc, -1, v26
    s_cbranch_vccnz Ltail_polly
Ltail_goty:
    s_waitcnt vmcnt(0) lgkmcnt(0)
    v_pk_add_f32 v[64:65], v[64:65], v[68:69]
    v_pk_add_f32 v[66:67], v[66:67], v[70:71]
    v_pk_add_f32 v[64:65], v[64:65], v[72:73]
    v_pk_add_f32 v[66:67], v[66:67], v[74:75]
    v_pk_add_f32 v[64:65], v[64:65], v[76:77]
    v_pk_add_f32 v[66:67], v[66:67], v[78:79]
    v_pk_add_f32 v[64:65], v[64:65], v[80:81]
    v_pk_add_f32 v[66:67], v[66:67], v[82:83]
    v_pk_add_f32 v[64:65], v[64:65], v[84:85]
    v_pk_add_f32 v[66:67], v[66:67], v[86:87]
    v_pk_add_f32 v[64:65], v[64:65], v[88:89]
    v_pk_add_f32 v[66:67], v[66:67], v[90:91]
    v_pk_add_f32 v[64:65], v[64:65], v[92:93]
    v_pk_add_f32 v[66:67], v[66:67], v[94:95]
    v_pk_add_f32 v[64:65], v[64:65], v[96:97]
    v_pk_add_f32 v[66:67], v[66:67], v[98:99]
    s_nop 0
    v_add_f32_dpp v64, v64, v64 row_ror:4 row_mask:0xf bank_mask:0xf
    v_add_f32_dpp v65, v65, v65 row_ror:4 row_mask:0xf bank_mask:0xf
    v_add_f32_dpp v66, v66, v66 row_ror:4 row_mask:0xf bank_mask:0xf
    v_add_f32_dpp v67, v67, v67 row_ror:4 row_mask:0xf bank_mask:0xf
    v_add_f32_dpp v64, v64, v64 row_ror:8 row_mask:0xf bank_mask:0xf
    v_add_f32_dpp v65, v65, v65 row_ror:8 row_mask:0xf bank_mask:0xf
    v_add_f32_dpp v66, v66, v66 row_ror:8 row_mask:0xf bank_mask:0xf
    v_add_f32_dpp v67, v67, v67 row_ror:8 row_mask:0xf bank_mask:0xf
    v_mov_b32 v68, v64
    v_mov_b32 v69, v65
    v_mov_b32 v70, v66
    v_mov_b32 v71, v67
    v_permlane16_swap_b32 v64, v68
    v_permlane16_swap_b32 v65, v69
    v_permlane16_swap_b32 v66, v70
    v_permlane16_swap_b32 v67, v71
    v_add_f32 v64, v64, v68
    v_add_f32 v65, v65, v69
    v_add_f32 v66, v66, v70
    v_add_f32 v67, v67, v71
    v_mov_b32 v68, v64
    v_mov_b32 v69, v65
    v_mov_b32 v70, v66
    v_mov_b32 v71, v67
    v_permlane32_swap_b32 v64, v68
    v_permlane32_swap_b32 v65, v69
    v_permlane32_swap_b32 v66, v70
    v_permlane32_swap_b32 v67, v71
    v_add_f32 v64, v64, v68
    v_add_f32 v65, v65, v69
    v_add_f32 v66, v66, v70
    v_add_f32 v67, v67, v71
    v_cndmask_b32 v26, v64, v65, s[36:37]
    v_cndmask_b32 v27, v66, v67, s[36:37]
    v_cvt_pk_bf16_f32 v28, v26, v27
    v_lshlrev_b32 v26, 16, v28
    v_and_b32 v27, 0xffff0000, v28
    v_mul_f32 v26, v26, v19
    v_mul_f32 v27, v27, v19
    v_cvt_pk_bf16_f32 v28, v26, v27
    v_lshlrev_b32 v26, 16, v28
    v_and_b32 v27, 0xffff0000, v28
    v_pk_add_f32 v[26:27], v[26:27], v[22:23]
    v_cvt_pk_bf16_f32 v28, v26, v27
    v_lshlrev_b32 v26, 16, v28
    v_and_b32 v27, 0xffff0000, v28
    v_pk_mul_f32 v[26:27], v[26:27], v[24:25]
    v_cvt_pk_bf16_f32 v28, v26, v27
    v_lshlrev_b32 v26, 16, v28
    v_and_b32 v27, 0xffff0000, v28
    v_pk_add_f32 v[26:27], v[26:27], v[20:21]
    v_cvt_pk_bf16_f32 v28, v26, v27
    s_mov_b64 exec, 0xff
    buffer_store_dword v28, v13, s[16:19], 0 offen
Ltail_done:
    s_endpgm
Lattn_redo:
    s_waitcnt vmcnt(0) lgkmcnt(0)
    s_barrier
    v_mov_b32 v232, 0xff800000
    v_mov_b32 v233, 0xff800000
    v_mov_b32 v234, 0xff800000
    v_mov_b32 v235, 0xff800000
    s_mov_b32 s40, 0
    s_mov_b32 s48, -1
Lattn_redo_loop:
    s_add_u32 m0, s42, 0
    s_nop 0
    buffer_load_dwordx4 v36, s[8:11], s40 offen lds
    buffer_load_dwordx4 v37, s[8:11], s40 offen offset:1024 lds
    buffer_load_dwordx4 v38, s[8:11], s40 offen offset:2048 lds
    buffer_load_dwordx4 v39, s[8:11], s40 offen offset:3072 lds
    s_add_u32 s40, s40, 16384
    s_waitcnt vmcnt(0) lgkmcnt(0)
    s_barrier
    ds_read_b128 a[208:211], v8 offset:0
    ds_read_b128 a[212:215], v9 offset:0
    ds_read_b128 a[216:219], v10 offset:0
    ds_read_b128 a[220:223], v11 offset:0
    s_waitcnt lgkmcnt(3)
    v_mfma_f32_16x16x32_bf16 v[216:219], a[208:211], v[64:67], 0
    s_waitcnt lgkmcnt(2)
    v_mfma_f32_16x16x32_bf16 v[216:219], a[212:215], v[68:71], v[216:219]
    s_waitcnt lgkmcnt(1)
    v_mfma_f32_16x16x32_bf16 v[216:219], a[216:219], v[72:75], v[216:219]
    s_waitcnt lgkmcnt(0)
    v_mfma_f32_16x16x32_bf16 v[216:219], a[220:223], v[76:79], v[216:219]
    v_mfma_f32_16x16x32_bf16 v[220:223], a[208:211], v[80:83], 0
    v_mfma_f32_16x16x32_bf16 v[220:223], a[212:215], v[84:87], v[220:223]
    v_mfma_f32_16x16x32_bf16 v[220:223], a[216:219], v[88:91], v[220:223]
    v_mfma_f32_16x16x32_bf16 v[220:223], a[220:223], v[92:95], v[220:223]
    v_mfma_f32_16x16x32_bf16 v[224:227], a[208:211], v[96:99], 0
    v_mfma_f32_16x16x32_bf16 v[224:227], a[212:215], v[100:103], v[224:227]
    v_mfma_f32_16x16x32_bf16 v[224:227], a[216:219], v[104:107], v[224:227]
    v_mfma_f32_16x16x32_bf16 v[224:227], a[220:223], v[108:111], v[224:227]
    v_mfma_f32_16x16x32_bf16 v[228:231], a[208:211], v[112:115], 0
    v_mfma_f32_16x16x32_bf16 v[228:231], a[212:215], v[116:119], v[228:231]
    v_mfma_f32_16x16x32_bf16 v[228:231], a[216:219], v[120:123], v[228:231]
    v_mfma_f32_16x16x32_bf16 v[228:231], a[220:223], v[124:127], v[228:231]
    v_max3_f32 v232, v232, v216, v217
    v_max3_f32 v232, v232, v218, v219
    v_max3_f32 v233, v233, v220, v221
    v_max3_f32 v233, v233, v222, v223
    v_max3_f32 v234, v234, v224, v225
    v_max3_f32 v234, v234, v226, v227
    s_nop 1
    v_max3_f32 v235, v235, v228, v229
    v_max3_f32 v235, v235, v230, v231
    ds_read_b128 a[224:227], v8 offset:4096
    ds_read_b128 a[228:231], v9 offset:4096
    ds_read_b128 a[232:235], v10 offset:4096
    ds_read_b128 a[236:239], v11 offset:4096
    s_waitcnt lgkmcnt(3)
    v_mfma_f32_16x16x32_bf16 v[216:219], a[224:227], v[64:67], 0
    s_waitcnt lgkmcnt(2)
    v_mfma_f32_16x16x32_bf16 v[216:219], a[228:231], v[68:71], v[216:219]
    s_waitcnt lgkmcnt(1)
    v_mfma_f32_16x16x32_bf16 v[216:219], a[232:235], v[72:75], v[216:219]
    s_waitcnt lgkmcnt(0)
    v_mfma_f32_16x16x32_bf16 v[216:219], a[236:239], v[76:79], v[216:219]
    v_mfma_f32_16x16x32_bf16 v[220:223], a[224:227], v[80:83], 0
    v_mfma_f32_16x16x32_bf16 v[220:223], a[228:231], v[84:87], v[220:223]
    v_mfma_f32_16x16x32_bf16 v[220:223], a[232:235], v[88:91], v[220:223]
    v_mfma_f32_16x16x32_bf16 v[220:223], a[236:239], v[92:95], v[220:223]
    v_mfma_f32_16x16x32_bf16 v[224:227], a[224:227], v[96:99], 0
    v_mfma_f32_16x16x32_bf16 v[224:227], a[228:231], v[100:103], v[224:227]
    v_mfma_f32_16x16x32_bf16 v[224:227], a[232:235], v[104:107], v[224:227]
    v_mfma_f32_16x16x32_bf16 v[224:227], a[236:239], v[108:111], v[224:227]
    v_mfma_f32_16x16x32_bf16 v[228:231], a[224:227], v[112:115], 0
    v_mfma_f32_16x16x32_bf16 v[228:231], a[228:231], v[116:119], v[228:231]
    v_mfma_f32_16x16x32_bf16 v[228:231], a[232:235], v[120:123], v[228:231]
    v_mfma_f32_16x16x32_bf16 v[228:231], a[236:239], v[124:127], v[228:231]
    v_max3_f32 v232, v232, v216, v217
    v_max3_f32 v232, v232, v218, v219
    v_max3_f32 v233, v233, v220, v221
    v_max3_f32 v233, v233, v222, v223
    v_max3_f32 v234, v234, v224, v225
    v_max3_f32 v234, v234, v226, v227
    s_nop 1
    v_max3_f32 v235, v235, v228, v229
    v_max3_f32 v235, v235, v230, v231
    ds_read_b128 a[208:211], v8 offset:8192
    ds_read_b128 a[212:215], v9 offset:8192
    ds_read_b128 a[216:219], v10 offset:8192
    ds_read_b128 a[220:223], v11 offset:8192
    s_waitcnt lgkmcnt(3)
    v_mfma_f32_16x16x32_bf16 v[216:219], a[208:211], v[64:67], 0
    s_waitcnt lgkmcnt(2)
    v_mfma_f32_16x16x32_bf16 v[216:219], a[212:215], v[68:71], v[216:219]
    s_waitcnt lgkmcnt(1)
    v_mfma_f32_16x16x32_bf16 v[216:219], a[216:219], v[72:75], v[216:219]
    s_waitcnt lgkmcnt(0)
    v_mfma_f32_16x16x32_bf16 v[216:219], a[220:223], v[76:79], v[216:219]
    v_mfma_f32_16x16x32_bf16 v[220:223], a[208:211], v[80:83], 0
    v_mfma_f32_16x16x32_bf16 v[220:223], a[212:215], v[84:87], v[220:223]
    v_mfma_f32_16x16x32_bf16 v[220:223], a[216:219], v[88:91], v[220:223]
    v_mfma_f32_16x16x32_bf16 v[220:223], a[220:223], v[92:95], v[220:223]
    v_mfma_f32_16x16x32_bf16 v[224:227], a[208:211], v[96:99], 0
    v_mfma_f32_16x16x32_bf16 v[224:227], a[212:215], v[100:103], v[224:227]
    v_mfma_f32_16x16x32_bf16 v[224:227], a[216:219], v[104:107], v[224:227]
    v_mfma_f32_16x16x32_bf16 v[224:227], a[220:223], v[108:111], v[224:227]
    v_mfma_f32_16x16x32_bf16 v[228:231], a[208:211], v[112:115], 0
    v_mfma_f32_16x16x32_bf16 v[228:231], a[212:215], v[116:119], v[228:231]
    v_mfma_f32_16x16x32_bf16 v[228:231], a[216:219], v[120:123], v[228:231]
    v_mfma_f32_16x16x32_bf16 v[228:231], a[220:223], v[124:127], v[228:231]
    v_max3_f32 v232, v232, v216, v217
    v_max3_f32 v232, v232, v218, v219
    v_max3_f32 v233, v233, v220, v221
    v_max3_f32 v233, v233, v222, v223
    v_max3_f32 v234, v234, v224, v225
    v_max3_f32 v234, v234, v226, v227
    s_nop 1
    v_max3_f32 v235, v235, v228, v229
    v_max3_f32 v235, v235, v230, v231
    ds_read_b128 a[224:227], v8 offset:12288
    ds_read_b128 a[228:231], v9 offset:12288
    ds_read_b128 a[232:235], v10 offset:12288
    ds_read_b128 a[236:239], v11 offset:12288
    s_waitcnt lgkmcnt(3)
    v_mfma_f32_16x16x32_bf16 v[216:219], a[224:227], v[64:67], 0
    s_waitcnt lgkmcnt(2)
    v_mfma_f32_16x16x32_bf16 v[216:219], a[228:231], v[68:71], v[216:219]
    s_waitcnt lgkmcnt(1)
    v_mfma_f32_16x16x32_bf16 v[216:219], a[232:235], v[72:75], v[216:219]
    s_waitcnt lgkmcnt(0)
    v_mfma_f32_16x16x32_bf16 v[216:219], a[236:239], v[76:79], v[216:219]
    v_mfma_f32_16x16x32_bf16 v[220:223], a[224:227], v[80:83], 0
    v_mfma_f32_16x16x32_bf16 v[220:223], a[228:231], v[84:87], v[220:223]
    v_mfma_f32_16x16x32_bf16 v[220:223], a[232:235], v[88:91], v[220:223]
    v_mfma_f32_16x16x32_bf16 v[220:223], a[236:239], v[92:95], v[220:223]
    v_mfma_f32_16x16x32_bf16 v[224:227], a[224:227], v[96:99], 0
    v_mfma_f32_16x16x32_bf16 v[224:227], a[228:231], v[100:103], v[224:227]
    v_mfma_f32_16x16x32_bf16 v[224:227], a[232:235], v[104:107], v[224:227]
    v_mfma_f32_16x16x32_bf16 v[224:227], a[236:239], v[108:111], v[224:227]
    v_mfma_f32_16x16x32_bf16 v[228:231], a[224:227], v[112:115], 0
    v_mfma_f32_16x16x32_bf16 v[228:231], a[228:231], v[116:119], v[228:231]
    v_mfma_f32_16x16x32_bf16 v[228:231], a[232:235], v[120:123], v[228:231]
    v_mfma_f32_16x16x32_bf16 v[228:231], a[236:239], v[124:127], v[228:231]
    v_max3_f32 v232, v232, v216, v217
    v_max3_f32 v232, v232, v218, v219
    v_max3_f32 v233, v233, v220, v221
    v_max3_f32 v233, v233, v222, v223
    v_max3_f32 v234, v234, v224, v225
    v_max3_f32 v234, v234, v226, v227
    s_nop 1
    v_max3_f32 v235, v235, v228, v229
    v_max3_f32 v235, v235, v230, v231
    s_barrier
    s_cmp_lt_u32 s40, 524288
    s_cbranch_scc1 Lattn_redo_loop
    v_mov_b32 v236, v232
    v_mov_b32 v237, v233
    v_mov_b32 v238, v234
    v_mov_b32 v239, v235
    v_permlane16_swap_b32 v232, v236
    v_permlane16_swap_b32 v233, v237
    v_permlane16_swap_b32 v234, v238
    v_permlane16_swap_b32 v235, v239
    v_max_f32 v232, v232, v236
    v_max_f32 v233, v233, v237
    v_max_f32 v234, v234, v238
    v_max_f32 v235, v235, v239
    v_mov_b32 v236, v232
    v_mov_b32 v237, v233
    v_mov_b32 v238, v234
    v_mov_b32 v239, v235
    v_permlane32_swap_b32 v232, v236
    v_permlane32_swap_b32 v233, v237
    v_permlane32_swap_b32 v234, v238
    v_permlane32_swap_b32 v235, v239
    v_max_f32 v232, v232, v236
    v_max_f32 v233, v233, v237
    v_max_f32 v234, v234, v238
    v_max_f32 v235, v235, v239
    v_sub_f32 v192, 0, v232
    v_sub_f32 v193, 0, v232
    v_sub_f32 v194, 0, v232
    v_sub_f32 v195, 0, v232
    v_sub_f32 v196, 0, v233
    v_sub_f32 v197, 0, v233
    v_sub_f32 v198, 0, v233
    v_sub_f32 v199, 0, v233
    v_sub_f32 v200, 0, v234
    v_sub_f32 v201, 0, v234
    v_sub_f32 v202, 0, v234
    v_sub_f32 v203, 0, v234
    v_sub_f32 v204, 0, v235
    v_sub_f32 v205, 0, v235
    v_sub_f32 v206, 0, v235
    v_sub_f32 v207, 0, v235
    s_mov_b32 s40, 0
    s_mov_b32 s41, 0
    s_add_u32 m0, s42, 0
    s_nop 0
    buffer_load_dwordx4 v36, s[8:11], s40 offen lds
    buffer_load_dwordx4 v37, s[8:11], s40 offen offset:1024 lds
    buffer_load_dwordx4 v38, s[8:11], s40 offen offset:2048 lds
    buffer_load_dwordx4 v39, s[8:11], s40 offen offset:3072 lds
    s_add_u32 s40, s40, 16384
    s_add_u32 m0, s42, 16384
    s_nop 0
    buffer_load_dwordx4 v36, s[8:11], s40 offen lds
    buffer_load_dwordx4 v37, s[8:11], s40 offen offset:1024 lds
    buffer_load_dwordx4 v38, s[8:11], s40 offen offset:2048 lds
    buffer_load_dwordx4 v39, s[8:11], s40 offen offset:3072 lds
    s_add_u32 s40, s40, 16384
    s_add_u32 m0, s42, 32768
    s_nop 0
    buffer_load_dwordx4 v36, s[8:11], s40 offen lds
    buffer_load_dwordx4 v37, s[8:11], s40 offen offset:1024 lds
    buffer_load_dwordx4 v38, s[8:11], s40 offen offset:2048 lds
    buffer_load_dwordx4 v39, s[8:11], s40 offen offset:3072 lds
    s_add_u32 s40, s40, 16384
    s_add_u32 m0, s42, 65536
    s_nop 0
    buffer_load_dwordx4 v40, s[12:15], s41 offen lds
    buffer_load_dwordx4 v41, s[12:15], s41 offen offset:1024 lds
    buffer_load_dwordx4 v40, s[12:15], s41 offen offset:2048 lds
    buffer_load_dwordx4 v41, s[12:15], s41 offen offset:3072 lds
    s_add_u32 s41, s41, 16384
    s_add_u32 m0, s42, 81920
    s_nop 0
    buffer_load_dwordx4 v40, s[12:15], s41 offen lds
    buffer_load_dwordx4 v41, s[12:15], s41 offen offset:1024 lds
    buffer_load_dwordx4 v40, s[12:15], s41 offen offset:2048 lds
    buffer_load_dwordx4 v41, s[12:15], s41 offen offset:3072 lds
    s_add_u32 s41, s41, 16384
    v_accvgpr_write_b32 a0, 0
    v_accvgpr_write_b32 a1, 0
    v_accvgpr_write_b32 a2, 0
    v_accvgpr_write_b32 a3, 0
    v_accvgpr_write_b32 a4, 0
    v_accvgpr_write_b32 a5, 0
    v_accvgpr_write_b32 a6, 0
    v_accvgpr_write_b32 a7, 0
    v_accvgpr_write_b32 a8, 0
    v_accvgpr_write_b32 a9, 0
    v_accvgpr_write_b32 a10, 0
    v_accvgpr_write_b32 a11, 0
    v_accvgpr_write_b32 a12, 0
    v_accvgpr_write_b32 a13, 0
    v_accvgpr_write_b32 a14, 0
    v_accvgpr_write_b32 a15, 0
    v_accvgpr_write_b32 a16, 0
    v_accvgpr_write_b32 a17, 0
    v_accvgpr_write_b32 a18, 0
    v_accvgpr_write_b32 a19, 0
    v_accvgpr_write_b32 a20, 0
    v_accvgpr_write_b32 a21, 0
    v_accvgpr_write_b32 a22, 0
    v_accvgpr_write_b32 a23, 0
    v_accvgpr_write_b32 a24, 0
    v_accvgpr_write_b32 a25, 0
    v_accvgpr_write_b32 a26, 0
    v_accvgpr_write_b32 a27, 0
    v_accvgpr_write_b32 a28, 0
    v_accvgpr_write_b32 a29, 0
    v_accvgpr_write_b32 a30, 0
    v_accvgpr_write_b32 a31, 0
    v_accvgpr_write_b32 a32, 0
    v_accvgpr_write_b32 a33, 0
    v_accvgpr_write_b32 a34, 0
    v_accvgpr_write_b32 a35, 0
    v_accvgpr_write_b32 a36, 0
    v_accvgpr_write_b32 a37, 0
    v_accvgpr_write_b32 a38, 0
    v_accvgpr_write_b32 a39, 0
    v_accvgpr_write_b32 a40, 0
    v_accvgpr_write_b32 a41, 0
    v_accvgpr_write_b32 a42, 0
    v_accvgpr_write_b32 a43, 0
    v_accvgpr_write_b32 a44, 0
    v_accvgpr_write_b32 a45, 0
    v_accvgpr_write_b32 a46, 0
    v_accvgpr_write_b32 a47, 0
    v_accvgpr_write_b32 a48, 0
    v_accvgpr_write_b32 a49, 0
    v_accvgpr_write_b32 a50, 0
    v_accvgpr_write_b32 a51, 0
    v_accvgpr_write_b32 a52, 0
    v_accvgpr_write_b32 a53, 0
    v_accvgpr_write_b32 a54, 0
    v_accvgpr_write_b32 a55, 0
    v_accvgpr_write_b32 a56, 0
    v_accvgpr_write_b32 a57, 0
    v_accvgpr_write_b32 a58, 0
    v_accvgpr_write_b32 a59, 0
    v_accvgpr_write_b32 a60, 0
    v_accvgpr_write_b32 a61, 0
    v_accvgpr_write_b32 a62, 0
    v_accvgpr_write_b32 a63, 0
    v_accvgpr_write_b32 a64, 0
    v_accvgpr_write_b32 a65, 0
    v_accvgpr_write_b32 a66, 0
    v_accvgpr_write_b32 a67, 0
    v_accvgpr_write_b32 a68, 0
    v_accvgpr_write_b32 a69, 0
    v_accvgpr_write_b32 a70, 0
    v_accvgpr_write_b32 a71, 0
    v_accvgpr_write_b32 a72, 0
    v_accvgpr_write_b32 a73, 0
    v_accvgpr_write_b32 a74, 0
    v_accvgpr_write_b32 a75, 0
    v_accvgpr_write_b32 a76, 0
    v_accvgpr_write_b32 a77, 0
    v_accvgpr_write_b32 a78, 0
    v_accvgpr_write_b32 a79, 0
    v_accvgpr_write_b32 a80, 0
    v_accvgpr_write_b32 a81, 0
    v_accvgpr_write_b32 a82, 0
    v_accvgpr_write_b32 a83, 0
    v_accvgpr_write_b32 a84, 0
    v_accvgpr_write_b32 a85, 0
    v_accvgpr_write_b32 a86, 0
    v_accvgpr_write_b32 a87, 0
    v_accvgpr_write_b32 a88, 0
    v_accvgpr_write_b32 a89, 0
    v_accvgpr_write_b32 a90, 0
    v_accvgpr_write_b32 a91, 0
    v_accvgpr_write_b32 a92, 0
    v_accvgpr_write_b32 a93, 0
    v_accvgpr_write_b32 a94, 0
    v_accvgpr_write_b32 a95, 0
    v_accvgpr_write_b32 a96, 0
    v_accvgpr_write_b32 a97, 0
    v_accvgpr_write_b32 a98, 0
    v_accvgpr_write_b32 a99, 0
    v_accvgpr_write_b32 a100, 0
    v_accvgpr_write_b32 a101, 0
    v_accvgpr_write_b32 a102, 0
    v_accvgpr_write_b32 a103, 0
    v_accvgpr_write_b32 a104, 0
    v_accvgpr_write_b32 a105, 0
    v_accvgpr_write_b32 a106, 0
    v_accvgpr_write_b32 a107, 0
    v_accvgpr_write_b32 a108, 0
    v_accvgpr_write_b32 a109, 0
    v_accvgpr_write_b32 a110, 0
    v_accvgpr_write_b32 a111, 0
    v_accvgpr_write_b32 a112, 0
    v_accvgpr_write_b32 a113, 0
    v_accvgpr_write_b32 a114, 0
    v_accvgpr_write_b32 a115, 0
    v_accvgpr_write_b32 a116, 0
    v_accvgpr_write_b32 a117, 0
    v_accvgpr_write_b32 a118, 0
    v_accvgpr_write_b32 a119, 0
    v_accvgpr_write_b32 a120, 0
    v_accvgpr_write_b32 a121, 0
    v_accvgpr_write_b32 a122, 0
    v_accvgpr_write_b32 a123, 0
    v_accvgpr_write_b32 a124, 0
    v_accvgpr_write_b32 a125, 0
    v_accvgpr_write_b32 a126, 0
    v_accvgpr_write_b32 a127, 0
    v_accvgpr_write_b32 a192, 0
    v_accvgpr_write_b32 a193, 0
    v_accvgpr_write_b32 a194, 0
    v_accvgpr_write_b32 a195, 0
    v_accvgpr_write_b32 a196, 0
    v_accvgpr_write_b32 a197, 0
    v_accvgpr_write_b32 a198, 0
    v_accvgpr_write_b32 a199, 0
    v_accvgpr_write_b32 a200, 0
    v_accvgpr_write_b32 a201, 0
    v_accvgpr_write_b32 a202, 0
    v_accvgpr_write_b32 a203, 0
    v_accvgpr_write_b32 a204, 0
    v_accvgpr_write_b32 a205, 0
    v_accvgpr_write_b32 a206, 0
    v_accvgpr_write_b32 a207, 0
    s_waitcnt vmcnt(0) lgkmcnt(0)
    s_barrier
    ds_read_b128 a[208:211], v8 offset:0
    ds_read_b128 a[212:215], v9 offset:0
    ds_read_b128 a[216:219], v10 offset:0
    ds_read_b128 a[220:223], v11 offset:0
    ds_read_b128 a[224:227], v8 offset:4096
    s_waitcnt vmcnt(0) lgkmcnt(0)
    s_branch Lattn_stage0
Lattn_armwait:
    s_mov_b32 s36, 16384
Lattn_armloop:
    v_mov_b32 v63, 0
    buffer_load_dword v63, v63, s[88:91], 0 offen sc1
    s_waitcnt vmcnt(0)
    v_readfirstlane_b32 s37, v63
    s_sub_u32 s36, s36, 1
    s_cbranch_scc1 Lattn_armed
    s_cmp_lg_u32 s37, 256
    s_cbranch_scc1 Lattn_armloop
    s_branch Lattn_armed
Lattn_end:
    s_endpgm
.section .rodata,"a"
.p2align 6
.amdhsa_kernel adaLN_cond__gqa_block_cached__moe_arch_mod__prompt_kernel
  .amdhsa_next_free_vgpr 512
  .amdhsa_next_free_sgpr 102
  .amdhsa_accum_offset 256
  .amdhsa_group_segment_fixed_size 0
  .amdhsa_kernarg_size 120
  .amdhsa_user_sgpr_count 2
  .amdhsa_user_sgpr_kernarg_segment_ptr 1
  .amdhsa_system_sgpr_workgroup_id_x 1
  .amdhsa_float_denorm_mode_32 3
.end_amdhsa_kernel
```

```asm
; @launch grid=(256,1,1) block=(256,1,1) lds=163840
.amdgcn_target "amdgcn-amd-amdhsa--gfx950"
.text
.globl adaLN_cond__gqa_block_cached__moe_arch_mod__prompt_kernel
.p2align 8
.type adaLN_cond__gqa_block_cached__moe_arch_mod__prompt_kernel,@function
adaLN_cond__gqa_block_cached__moe_arch_mod__prompt_kernel:
    s_cmp_ge_u32 s2, 256
    s_cbranch_scc1 Lattn_end
    s_load_dwordx2 s[8:9], s[0:1], 80
    s_load_dwordx2 s[12:13], s[0:1], 88
    s_load_dwordx2 s[20:21], s[0:1], 0
    s_load_dwordx2 s[50:51], s[0:1], 112
    s_load_dwordx8 s[52:59], s[0:1], 8
    s_load_dwordx4 s[80:83], s[0:1], 56
    s_load_dwordx2 s[84:85], s[0:1], 72
    s_load_dwordx2 s[88:89], s[0:1], 104
    s_getpc_b64 s[32:33]
Lattn_pc:
    s_mov_b32 s34, Lattn_end-Lattn_pc
    s_mov_b32 s35, 0x20000
    s_lshr_b32 s6, s2, 3
    s_lshl_b32 s7, s6, 6
    v_lshrrev_b32 v3, 6, v0
    v_and_b32 v1, 63, v0
    v_lshrrev_b32 v2, 2, v0
    v_lshlrev_b32 v2, 11, v2
    v_readfirstlane_b32 s3, v3
    buffer_load_dword v240, v2, s[32:35], s7 offen
    s_and_b32 s7, s2, 7
    s_lshl_b32 s4, s7, 1
    s_and_b32 s5, s6, 1
    s_add_u32 s4, s4, s5
    s_lshr_b32 s5, s2, 4
    s_lshr_b32 s38, s6, 2
    s_lshl_b32 s38, s38, 3
    s_add_u32 s38, s38, s7
    s_cmp_lt_u32 s38, 54
    s_cselect_b32 s39, 0, 2147483648
    s_lshl_b32 s38, s38, 2
    s_and_b32 s36, s6, 3
    s_add_u32 s38, s38, s36
    s_mov_b32 s14, 3981312
    s_mul_i32 s92, s6, 124416
    s_lshl_b32 s36, s7, 7
    s_add_u32 s92, s92, s36
    v_lshrrev_b32 v2, 2, v0
    v_min_u32 v2, 53, v2
    v_mul_u32_u24 v3, 86, v2
    v_lshrrev_b32 v3, 8, v3
    v_mul_u32_u24 v3, 3840, v3
    v_lshl_add_u32 v72, v2, 10, v3
    s_mov_b32 s15, 0x20000
    s_mov_b32 s10, 1152
    s_mov_b32 s11, 0x20000
    s_mov_b32 s22, 2359296
    s_mov_b32 s23, 0x20000
    v_and_b32 v64, 0xfe, v0
    v_mul_u32_u24 v65, 3456, v64
    v_and_b32 v2, 1, v0
    v_lshl_add_u32 v65, v2, 4, v65
    s_lshl_b32 s36, s38, 5
    s_or_b32 s36, s36, s39
    v_and_b32 v4, 31, v1
    v_lshrrev_b32 v5, 5, v1
    v_cmp_gt_u32 vcc, 24, v4
    v_mov_b32 v6, 2147483648
    s_lshl_b32 s7, s5, 4
    s_add_u32 s7, s7, s4
    s_lshl_b32 s7, s7, 2
    s_add_u32 s7, s7, s3
    v_cndmask_b32 v6, v6, 0, vcc
    s_mul_i32 s37, s7, 2304
    v_lshrrev_b32 v7, 2, v4
    v_lshl_add_u32 v7, v7, 6, v6
    v_and_b32 v2, 3, v4
    v_lshl_add_u32 v7, v2, 3, v7
    v_mul_u32_u24 v2, 1152, v5
    v_add_u32 v66, v7, v2
    s_waitcnt lgkmcnt(0)
    s_load_dword s94, s[50:51], 24576
    buffer_load_dword v241, v72, s[12:15], s92 offen
    buffer_load_ushort v80, v64, s[8:11], 0 offen offset:0
    buffer_load_ushort v81, v64, s[8:11], 0 offen offset:256
    buffer_load_ushort v82, v64, s[8:11], 0 offen offset:512
    buffer_load_ushort v83, v64, s[8:11], 0 offen offset:768
    buffer_load_ushort v84, v64, s[8:11], 0 offen offset:1024
    buffer_load_dwordx2 v[108:109], v66, s[20:23], s37 offen offset:0
    buffer_load_dwordx2 v[110:111], v66, s[20:23], s37 offen offset:32
    buffer_load_dwordx2 v[112:113], v66, s[20:23], s37 offen offset:384
    buffer_load_dwordx2 v[114:115], v66, s[20:23], s37 offen offset:416
    buffer_load_dwordx2 v[116:117], v66, s[20:23], s37 offen offset:768
    buffer_load_dwordx2 v[118:119], v66, s[20:23], s37 offen offset:800
    buffer_load_dwordx4 v[88:91], v65, s[12:15], s36 offen
    s_add_u32 s36, s36, 884736
    buffer_load_dwordx4 v[92:95], v65, s[12:15], s36 offen
    s_add_u32 s36, s36, 884736
    buffer_load_dwordx4 v[96:99], v65, s[12:15], s36 offen
    s_add_u32 s36, s36, 884736
    buffer_load_dwordx4 v[100:103], v65, s[12:15], s36 offen
    s_add_u32 s36, s36, 884736
    buffer_load_dwordx4 v[104:107], v65, s[12:15], s36 offen
    s_mov_b32 s16, s56
    s_mov_b32 s17, s57
    s_mov_b32 s18, 4718592
    s_mov_b32 s19, 0x20000
    s_lshl_b32 s44, s4, 9
    s_mul_i32 s36, s5, 294912
    v_min_u32 v2, 143, v0
    v_lshrrev_b32 v3, 2, v2
    v_and_b32 v2, 3, v2
    v_lshl_add_u32 v2, v2, 7, s36
    v_lshl_add_u32 v71, v3, 13, v2
    s_add_u32 s92, s37, 65536
    v_lshl_add_u32 v7, v5, 4, v6
    v_lshl_add_u32 v67, v4, 5, v7
    v_min_u32 v4, 23, v4
    v_lshlrev_b32 v68, 4, v4
    s_mov_b32 s24, s50
    s_mov_b32 s25, s51
    s_mov_b32 s26, 10485760
    s_mov_b32 s27, 0x20000
    s_mov_b32 s90, 256
    s_mov_b32 s91, 0x20000
    s_mul_i32 s36, s38, 1821
    s_lshr_b32 s36, s36, 16
    s_cmp_eq_u32 s36, 1
    s_cselect_b32 s93, 1.0, 0
    s_cmp_eq_u32 s36, 4
    s_cselect_b32 s93, 1.0, s93
    s_lshr_b32 s36, s38, 1
    s_lshl_b32 s36, s36, 6
    s_and_b32 s37, s38, 1
    s_lshl_b32 s37, s37, 3
    s_add_u32 s36, s36, s37
    v_lshrrev_b32 v2, 1, v0
    v_lshl_add_u32 v2, v2, 4, s36
    v_and_b32 v3, 1, v0
    v_lshl_add_u32 v70, v3, 2, v2
    v_lshlrev_b32 v69, 1, v70
    v_cmp_gt_u32 s[36:37], 8, v0
    v_mov_b32 v2, 2147483648
    v_mov_b32 v3, s39
    v_cndmask_b32 v2, v2, v3, s[36:37]
    v_or_b32 v69, v69, v2
    v_or_b32 v70, v70, v2
    s_lshl_b32 s42, s3, 12
    v_lshrrev_b32 v2, 4, v1
    v_and_b32 v3, 15, v1
    v_lshrrev_b32 v5, 1, v3
    v_mul_u32_u24 v5, 2304, v5
    v_lshl_add_u32 v5, v2, 5, v5
    v_and_b32 v6, 1, v3
    v_lshl_add_u32 v51, v6, 4, v5
    s_lshl_b32 s6, s5, 2
    s_add_u32 s6, s6, s3
    s_mul_i32 s46, s6, 36864
    s_add_u32 s46, s46, 65536
    s_add_u32 s43, s46, 18432
    s_mul_i32 s45, s4, 294912
    s_lshl_b32 s7, s3, 4
    v_add_u32 v4, s7, v2
    v_lshlrev_b32 v5, 1, v2
    v_xor_b32 v5, v5, v3
    v_xor_b32 v6, 8, v5
    v_lshlrev_b32 v7, 13, v4
    v_lshl_add_u32 v42, v5, 4, v7
    v_lshl_add_u32 v43, v6, 4, v7
    v_add_u32 v44, 63488, v42
    v_add_u32 v45, 95232, v43
    v_add_u32 v43, 31744, v43
    s_lshl_b32 s7, s4, 19
    s_add_u32 s8, s52, s7
    s_addc_u32 s9, s53, 0
    s_mov_b32 s10, 524288
    s_mov_b32 s11, 0x20000
    s_add_u32 s12, s54, s7
    s_addc_u32 s13, s55, 0
    s_mov_b32 s14, 524288
    s_mov_b32 s15, 0x20000
    s_mov_b32 s20, s58
    s_mov_b32 s21, s59
    s_mov_b32 s22, 4718592
    s_mov_b32 s23, 0x20000
    s_add_u32 s28, s50, 10485760
    s_addc_u32 s29, s51, 0
    s_mov_b32 s30, 37748736
    s_mov_b32 s31, 0x20000
    v_lshlrev_b32 v7, 8, v4
    v_lshl_add_u32 v40, v5, 4, v7
    v_lshl_add_u32 v41, v6, 4, v7
    v_xor_b32 v224, v3, v2
    v_lshl_add_u32 v36, v224, 4, v7
    v_xor_b32 v37, 64, v36
    v_xor_b32 v38, 128, v36
    v_xor_b32 v39, 192, v36
    v_lshrrev_b32 v7, 3, v5
    v_lshl_add_u32 v7, v7, 7, v4
    v_mul_u32_u24 v7, 1152, v7
    v_and_b32 v225, 7, v5
    v_lshl_add_u32 v46, v225, 4, v7
    v_lshrrev_b32 v7, 3, v6
    v_lshl_add_u32 v7, v7, 7, v4
    v_mul_u32_u24 v7, 1152, v7
    v_and_b32 v225, 7, v6
    v_lshl_add_u32 v47, v225, 4, v7
    v_add_u32 v48, 7168, v46
    v_add_u32 v49, 10752, v47
    v_add_u32 v47, 3584, v47
    v_lshlrev_b32 v7, 8, v3
    v_lshl_add_u32 v8, v224, 4, v7
    v_xor_b32 v9, 64, v8
    v_xor_b32 v10, 128, v8
    v_xor_b32 v11, 192, v8
    v_lshrrev_b32 v5, 2, v1
    v_and_b32 v6, 7, v5
    v_lshlrev_b32 v6, 5, v6
    v_lshl_add_u32 v6, v5, 8, v6
    v_and_b32 v7, 3, v1
    v_lshl_add_u32 v12, v7, 3, v6
    v_xor_b32 v13, 32, v12
    v_xor_b32 v14, 64, v12
    v_xor_b32 v15, 96, v12
    v_xor_b32 v16, 128, v12
    v_xor_b32 v17, 160, v12
    v_xor_b32 v18, 192, v12
    v_xor_b32 v19, 224, v12
    v_add_u32 v20, 65536, v12
    v_add_u32 v21, 65536, v13
    v_add_u32 v22, 65536, v14
    v_add_u32 v23, 65536, v15
    v_add_u32 v24, 65536, v16
    v_add_u32 v25, 65536, v17
    v_add_u32 v26, 65536, v18
    v_add_u32 v27, 65536, v19
    v_add_u32 v28, 131072, v12
    v_add_u32 v29, 131072, v13
    v_add_u32 v30, 131072, v14
    v_add_u32 v31, 131072, v15
    v_add_u32 v32, 131072, v16
    v_add_u32 v33, 131072, v17
    v_add_u32 v34, 131072, v18
    v_add_u32 v35, 131072, v19
    v_mov_b32 v52, 0x3f803f80
    v_mov_b32 v53, 0x3f803f80
    v_mov_b32 v54, 0x3f803f80
    v_mov_b32 v55, 0x3f803f80
    v_and_b32 v5, 1, v1
    v_mul_u32_u24 v5, 0xaaaa, v5
    v_add_u32 v5, 0x4444, v5
    v_lshl_add_u32 v50, v5, 16, v5
    v_lshrrev_b32 v5, 1, v3
    v_mul_u32_u24 v5, 36864, v5
    v_lshl_add_u32 v5, v2, 5, v5
    v_and_b32 v6, 1, v3
    v_lshl_add_u32 v56, v6, 4, v5
    s_mul_i32 s47, s6, 589824
    s_mul_i32 s7, s4, 2304
    s_add_u32 s47, s47, s7
    s_mov_b32 s32, s82
    s_mov_b32 s33, s83
    s_mov_b32 s34, 5308416
    s_mov_b32 s35, 0x20000
    s_mov_b32 s82, 5308416
    s_mov_b32 s83, 0x20000
    s_mov_b32 s86, 5308416
    s_mov_b32 s87, 0x20000
    s_lshr_b32 s7, s2, 3
    s_mul_i32 s7, s7, 18
    s_add_u32 s7, s7, s3
    s_and_b32 s36, s2, 7
    s_mul_i32 s37, s36, 576
    s_add_u32 s37, s37, s7
    s_mul_i32 s37, s37, 1152
    s_mul_i32 s7, s7, 9216
    s_mul_i32 s36, s36, 1152
    s_add_u32 s7, s7, s36
    v_min_u32 v5, 17, v1
    v_lshl_add_u32 v57, v5, 6, s7
    v_lshl_add_u32 v62, v5, 6, s37
    s_mov_b32 s40, 0
    s_mov_b32 s41, 0
    s_mov_b32 s48, 0
    s_waitcnt vmcnt(15)
    v_lshlrev_b32 v80, 16, v80
    s_waitcnt vmcnt(14)
    v_lshlrev_b32 v81, 16, v81
    s_waitcnt vmcnt(13)
    v_lshlrev_b32 v82, 16, v82
    s_waitcnt vmcnt(12)
    v_lshlrev_b32 v83, 16, v83
    s_waitcnt vmcnt(11)
    v_lshlrev_b32 v84, 16, v84
    v_mul_f32 v144, 0xbfb8aa3b, v80
    v_mul_f32 v148, 0xbfb8aa3b, v81
    v_mul_f32 v152, 0xbfb8aa3b, v82
    v_mul_f32 v156, 0xbfb8aa3b, v83
    v_mul_f32 v160, 0xbfb8aa3b, v84
    v_min_f32 v144, 0x42fc0000, v144
    v_min_f32 v148, 0x42fc0000, v148
    v_min_f32 v152, 0x42fc0000, v152
    v_min_f32 v156, 0x42fc0000, v156
    v_min_f32 v160, 0x42fc0000, v160
    v_exp_f32 v144, v144
    v_exp_f32 v148, v148
    v_exp_f32 v152, v152
    v_exp_f32 v156, v156
    v_exp_f32 v160, v160
    v_add_f32 v144, 1.0, v144
    v_add_f32 v148, 1.0, v148
    v_add_f32 v152, 1.0, v152
    v_add_f32 v156, 1.0, v156
    v_add_f32 v160, 1.0, v160
    v_rcp_f32 v145, v144
    v_rcp_f32 v149, v148
    v_rcp_f32 v153, v152
    v_rcp_f32 v157, v156
    v_rcp_f32 v161, v160
    v_mul_f32 v146, v80, v145
    v_mul_f32 v150, v81, v149
    v_mul_f32 v154, v82, v153
    v_mul_f32 v158, v83, v157
    v_mul_f32 v162, v84, v161
    v_fma_f32 v144, -v146, v144, v80
    v_fma_f32 v148, -v150, v148, v81
    v_fma_f32 v152, -v154, v152, v82
    v_fma_f32 v156, -v158, v156, v83
    v_fma_f32 v160, -v162, v160, v84
    v_fma_f32 v80, v144, v145, v146
    v_fma_f32 v81, v148, v149, v150
    v_fma_f32 v82, v152, v153, v154
    v_fma_f32 v83, v156, v157, v158
    v_fma_f32 v84, v160, v161, v162
    v_cvt_pk_bf16_f32 v80, v80, v80
    v_cvt_pk_bf16_f32 v81, v81, v81
    v_cvt_pk_bf16_f32 v82, v82, v82
    v_cvt_pk_bf16_f32 v83, v83, v83
    v_cvt_pk_bf16_f32 v84, v84, v84
    v_and_b32 v80, 0xffff0000, v80
    v_and_b32 v81, 0xffff0000, v81
    v_and_b32 v82, 0xffff0000, v82
    v_and_b32 v83, 0xffff0000, v83
    v_and_b32 v84, 0xffff0000, v84
    s_waitcnt vmcnt(4)
    v_lshlrev_b32 v136, 16, v88
    v_and_b32 v137, 0xffff0000, v88
    v_lshlrev_b32 v138, 16, v89
    v_and_b32 v139, 0xffff0000, v89
    v_lshlrev_b32 v140, 16, v90
    v_and_b32 v141, 0xffff0000, v90
    v_lshlrev_b32 v142, 16, v91
    v_and_b32 v143, 0xffff0000, v91
    v_pk_mul_f32 v[128:129], v[136:137], v[80:81] op_sel:[0,0] op_sel_hi:[1,0]
    v_pk_mul_f32 v[130:131], v[138:139], v[80:81] op_sel:[0,0] op_sel_hi:[1,0]
    v_pk_mul_f32 v[132:133], v[140:141], v[80:81] op_sel:[0,0] op_sel_hi:[1,0]
    v_pk_mul_f32 v[134:135], v[142:143], v[80:81] op_sel:[0,0] op_sel_hi:[1,0]
    s_waitcnt vmcnt(3)
    v_lshlrev_b32 v136, 16, v92
    v_and_b32 v137, 0xffff0000, v92
    v_lshlrev_b32 v138, 16, v93
    v_and_b32 v139, 0xffff0000, v93
    v_lshlrev_b32 v140, 16, v94
    v_and_b32 v141, 0xffff0000, v94
    v_lshlrev_b32 v142, 16, v95
    v_and_b32 v143, 0xffff0000, v95
    v_pk_fma_f32 v[128:129], v[136:137], v[80:81], v[128:129] op_sel:[0,1,0] op_sel_hi:[1,1,1]
    v_pk_fma_f32 v[130:131], v[138:139], v[80:81], v[130:131] op_sel:[0,1,0] op_sel_hi:[1,1,1]
    v_pk_fma_f32 v[132:133], v[140:141], v[80:81], v[132:133] op_sel:[0,1,0] op_sel_hi:[1,1,1]
    v_pk_fma_f32 v[134:135], v[142:143], v[80:81], v[134:135] op_sel:[0,1,0] op_sel_hi:[1,1,1]
    s_waitcnt vmcnt(2)
    v_lshlrev_b32 v136, 16, v96
    v_and_b32 v137, 0xffff0000, v96
    v_lshlrev_b32 v138, 16, v97
    v_and_b32 v139, 0xffff0000, v97
    v_lshlrev_b32 v140, 16, v98
    v_and_b32 v141, 0xffff0000, v98
    v_lshlrev_b32 v142, 16, v99
    v_and_b32 v143, 0xffff0000, v99
    v_pk_fma_f32 v[128:129], v[136:137], v[82:83], v[128:129] op_sel:[0,0,0] op_sel_hi:[1,0,1]
    v_pk_fma_f32 v[130:131], v[138:139], v[82:83], v[130:131] op_sel:[0,0,0] op_sel_hi:[1,0,1]
    v_pk_fma_f32 v[132:133], v[140:141], v[82:83], v[132:133] op_sel:[0,0,0] op_sel_hi:[1,0,1]
    v_pk_fma_f32 v[134:135], v[142:143], v[82:83], v[134:135] op_sel:[0,0,0] op_sel_hi:[1,0,1]
    s_waitcnt vmcnt(1)
    v_lshlrev_b32 v136, 16, v100
    v_and_b32 v137, 0xffff0000, v100
    v_lshlrev_b32 v138, 16, v101
    v_and_b32 v139, 0xffff0000, v101
    v_lshlrev_b32 v140, 16, v102
    v_and_b32 v141, 0xffff0000, v102
    v_lshlrev_b32 v142, 16, v103
    v_and_b32 v143, 0xffff0000, v103
    v_pk_fma_f32 v[128:129], v[136:137], v[82:83], v[128:129] op_sel:[0,1,0] op_sel_hi:[1,1,1]
    v_pk_fma_f32 v[130:131], v[138:139], v[82:83], v[130:131] op_sel:[0,1,0] op_sel_hi:[1,1,1]
    v_pk_fma_f32 v[132:133], v[140:141], v[82:83], v[132:133] op_sel:[0,1,0] op_sel_hi:[1,1,1]
    v_pk_fma_f32 v[134:135], v[142:143], v[82:83], v[134:135] op_sel:[0,1,0] op_sel_hi:[1,1,1]
    s_waitcnt vmcnt(0)
    v_lshlrev_b32 v136, 16, v104
    v_and_b32 v137, 0xffff0000, v104
    v_lshlrev_b32 v138, 16, v105
    v_and_b32 v139, 0xffff0000, v105
    v_lshlrev_b32 v140, 16, v106
    v_and_b32 v141, 0xffff0000, v106
    v_lshlrev_b32 v142, 16, v107
    v_and_b32 v143, 0xffff0000, v107
    v_pk_fma_f32 v[128:129], v[136:137], v[84:85], v[128:129] op_sel:[0,0,0] op_sel_hi:[1,0,1]
    v_pk_fma_f32 v[130:131], v[138:139], v[84:85], v[130:131] op_sel:[0,0,0] op_sel_hi:[1,0,1]
    v_pk_fma_f32 v[132:133], v[140:141], v[84:85], v[132:133] op_sel:[0,0,0] op_sel_hi:[1,0,1]
    v_pk_fma_f32 v[134:135], v[142:143], v[84:85], v[134:135] op_sel:[0,0,0] op_sel_hi:[1,0,1]
    buffer_load_dword v242, v71, s[16:19], s44 offen
    v_permlane32_swap_b32 v128, v132
    v_permlane32_swap_b32 v129, v133
    v_permlane32_swap_b32 v130, v134
    v_permlane32_swap_b32 v131, v135
    v_and_b32 v72, 1, v1
    v_pk_add_f32 v[128:129], v[128:129], v[132:133]
    v_pk_add_f32 v[130:131], v[130:131], v[134:135]
    v_lshlrev_b32 v72, 5, v72
    v_lshrrev_b32 v73, 4, v1
    v_permlane16_swap_b32 v128, v130
    v_permlane16_swap_b32 v129, v131
    v_lshl_add_u32 v72, v73, 3, v72
    v_pk_add_f32 v[128:129], v[128:129], v[130:131]
    s_lshl_b32 s36, s3, 6
    v_add_u32 v72, s36, v72
    v_add_f32_dpp v128, v128, v128 row_ror:2 row_mask:0xf bank_mask:0xf
    v_add_f32_dpp v129, v129, v129 row_ror:2 row_mask:0xf bank_mask:0xf
    s_nop 0
    v_add_f32_dpp v128, v128, v128 row_ror:4 row_mask:0xf bank_mask:0xf
    v_add_f32_dpp v129, v129, v129 row_ror:4 row_mask:0xf bank_mask:0xf
    s_nop 0
    v_add_f32_dpp v128, v128, v128 row_ror:8 row_mask:0xf bank_mask:0xf
    v_add_f32_dpp v129, v129, v129 row_ror:8 row_mask:0xf bank_mask:0xf
    ds_write_b64 v72, v[128:129] offset:0
    v_and_b32 v73, 7, v1
    v_lshlrev_b32 v73, 3, v73
    s_waitcnt lgkmcnt(0)
    s_barrier
    ds_read_b64 v[128:129], v73 offset:0
    ds_read_b64 v[130:131], v73 offset:64
    ds_read_b64 v[132:133], v73 offset:128
    ds_read_b64 v[134:135], v73 offset:192
    s_add_u32 s95, s94, 0x9e3779b9
    v_mov_b32 v137, s95
    s_mov_b32 s36, 16384
    s_waitcnt lgkmcnt(2)
    v_pk_add_f32 v[128:129], v[128:129], v[130:131]
    s_waitcnt lgkmcnt(0)
    v_pk_add_f32 v[132:133], v[132:133], v[134:135]
    v_pk_add_f32 v[128:129], v[128:129], v[132:133]
    v_cvt_pk_bf16_f32 v136, v128, v129
    v_lshlrev_b32 v128, 16, v136
    v_and_b32 v129, 0xffff0000, v136
    v_add_f32 v128, s93, v128
    v_add_f32 v129, s93, v129
    v_cvt_pk_bf16_f32 v136, v128, v129
    buffer_store_dwordx2 v[136:137], v69, s[24:27], 0 offen sc1
    buffer_store_dword v136, v70, s[24:27], s36 offen sc1
    v_lshlrev_b32 v144, 16, v108
    v_and_b32 v145, 0xffff0000, v108
    v_lshlrev_b32 v146, 16, v109
    v_and_b32 v147, 0xffff0000, v109
    v_lshlrev_b32 v148, 16, v110
    v_and_b32 v149, 0xffff0000, v110
    v_lshlrev_b32 v150, 16, v111
    v_and_b32 v151, 0xffff0000, v111
    v_lshlrev_b32 v152, 16, v112
    v_and_b32 v153, 0xffff0000, v112
    v_lshlrev_b32 v154, 16, v113
    v_and_b32 v155, 0xffff0000, v113
    v_lshlrev_b32 v156, 16, v114
    v_and_b32 v157, 0xffff0000, v114
    v_lshlrev_b32 v158, 16, v115
    v_and_b32 v159, 0xffff0000, v115
    v_lshlrev_b32 v160, 16, v116
    v_and_b32 v161, 0xffff0000, v116
    v_lshlrev_b32 v162, 16, v117
    v_and_b32 v163, 0xffff0000, v117
    v_lshlrev_b32 v164, 16, v118
    v_and_b32 v165, 0xffff0000, v118
    v_lshlrev_b32 v166, 16, v119
    v_and_b32 v167, 0xffff0000, v119
    v_pk_add_f32 v[72:73], v[144:145], v[148:149]
    v_pk_add_f32 v[76:77], v[146:147], v[150:151]
    v_pk_add_f32 v[72:73], v[72:73], v[152:153]
    v_pk_add_f32 v[76:77], v[76:77], v[154:155]
    v_pk_add_f32 v[72:73], v[72:73], v[156:157]
    v_pk_add_f32 v[76:77], v[76:77], v[158:159]
    v_pk_add_f32 v[72:73], v[72:73], v[160:161]
    v_pk_add_f32 v[76:77], v[76:77], v[162:163]
    v_pk_add_f32 v[72:73], v[72:73], v[164:165]
    v_pk_add_f32 v[76:77], v[76:77], v[166:167]
    v_pk_add_f32 v[72:73], v[72:73], v[76:77]
    v_add_f32 v72, v72, v73
    s_nop 1
    v_add_f32_dpp v72, v72, v72 row_ror:1 row_mask:0xf bank_mask:0xf
    s_nop 1
    v_add_f32_dpp v72, v72, v72 row_ror:2 row_mask:0xf bank_mask:0xf
    s_nop 1
    v_add_f32_dpp v72, v72, v72 row_ror:4 row_mask:0xf bank_mask:0xf
    s_nop 1
    v_add_f32_dpp v72, v72, v72 row_ror:8 row_mask:0xf bank_mask:0xf
    v_mov_b32 v76, v72
    s_nop 1
    v_permlane16_swap_b32 v72, v76
    s_nop 0
    v_add_f32 v72, v72, v76
    v_mul_f32 v72, 0x3ae38e39, v72
    v_pk_add_f32 v[168:169], v[144:145], v[72:73] op_sel_hi:[1,0] neg_lo:[0,1] neg_hi:[0,1]
    v_pk_add_f32 v[170:171], v[146:147], v[72:73] op_sel_hi:[1,0] neg_lo:[0,1] neg_hi:[0,1]
    v_pk_add_f32 v[172:173], v[148:149], v[72:73] op_sel_hi:[1,0] neg_lo:[0,1] neg_hi:[0,1]
    v_pk_add_f32 v[174:175], v[150:151], v[72:73] op_sel_hi:[1,0] neg_lo:[0,1] neg_hi:[0,1]
    v_pk_add_f32 v[176:177], v[152:153], v[72:73] op_sel_hi:[1,0] neg_lo:[0,1] neg_hi:[0,1]
    v_pk_add_f32 v[178:179], v[154:155], v[72:73] op_sel_hi:[1,0] neg_lo:[0,1] neg_hi:[0,1]
    v_pk_add_f32 v[180:181], v[156:157], v[72:73] op_sel_hi:[1,0] neg_lo:[0,1] neg_hi:[0,1]
    v_pk_add_f32 v[182:183], v[158:159], v[72:73] op_sel_hi:[1,0] neg_lo:[0,1] neg_hi:[0,1]
    v_pk_add_f32 v[184:185], v[160:161], v[72:73] op_sel_hi:[1,0] neg_lo:[0,1] neg_hi:[0,1]
    v_pk_add_f32 v[186:187], v[162:163], v[72:73] op_sel_hi:[1,0] neg_lo:[0,1] neg_hi:[0,1]
    v_pk_add_f32 v[188:189], v[164:165], v[72:73] op_sel_hi:[1,0] neg_lo:[0,1] neg_hi:[0,1]
    v_pk_add_f32 v[190:191], v[166:167], v[72:73] op_sel_hi:[1,0] neg_lo:[0,1] neg_hi:[0,1]
    v_pk_mul_f32 v[74:75], v[168:169], v[168:169]
    v_pk_mul_f32 v[76:77], v[170:171], v[170:171]
    v_pk_fma_f32 v[74:75], v[172:173], v[172:173], v[74:75]
    v_pk_fma_f32 v[76:77], v[174:175], v[174:175], v[76:77]
    v_pk_fma_f32 v[74:75], v[176:177], v[176:177], v[74:75]
    v_pk_fma_f32 v[76:77], v[178:179], v[178:179], v[76:77]
    v_pk_fma_f32 v[74:75], v[180:181], v[180:181], v[74:75]
    v_pk_fma_f32 v[76:77], v[182:183], v[182:183], v[76:77]
    v_pk_fma_f32 v[74:75], v[184:185], v[184:185], v[74:75]
    v_pk_fma_f32 v[76:77], v[186:187], v[186:187], v[76:77]
    v_pk_fma_f32 v[74:75], v[188:189], v[188:189], v[74:75]
    v_pk_fma_f32 v[76:77], v[190:191], v[190:191], v[76:77]
    v_pk_add_f32 v[74:75], v[74:75], v[76:77]
    v_add_f32 v74, v74, v75
    v_cndmask_b32 v74, 0, v74, vcc
    s_nop 1
    v_add_f32_dpp v74, v74, v74 row_ror:1 row_mask:0xf bank_mask:0xf
    s_nop 1
    v_add_f32_dpp v74, v74, v74 row_ror:2 row_mask:0xf bank_mask:0xf
    s_nop 1
    v_add_f32_dpp v74, v74, v74 row_ror:4 row_mask:0xf bank_mask:0xf
    s_nop 1
    v_add_f32_dpp v74, v74, v74 row_ror:8 row_mask:0xf bank_mask:0xf
    v_mov_b32 v76, v74
    s_nop 1
    v_permlane16_swap_b32 v74, v76
    s_nop 0
    v_add_f32 v74, v74, v76
    v_mul_f32 v74, 0x3ae38e39, v74
    v_cvt_pk_bf16_f32 v76, v72, v74
    v_and_b32 v74, 0xffff0000, v76
    v_lshlrev_b32 v72, 16, v76
    v_add_f32 v74, 0x3727c5ac, v74
    v_cvt_pk_bf16_f32 v74, v74, v74
    v_and_b32 v74, 0xffff0000, v74
    v_sqrt_f32 v74, v74
    v_pk_add_f32 v[168:169], v[144:145], v[72:73] op_sel_hi:[1,0] neg_lo:[0,1] neg_hi:[0,1]
    v_pk_add_f32 v[170:171], v[146:147], v[72:73] op_sel_hi:[1,0] neg_lo:[0,1] neg_hi:[0,1]
    v_pk_add_f32 v[172:173], v[148:149], v[72:73] op_sel_hi:[1,0] neg_lo:[0,1] neg_hi:[0,1]
    v_pk_add_f32 v[174:175], v[150:151], v[72:73] op_sel_hi:[1,0] neg_lo:[0,1] neg_hi:[0,1]
    v_pk_add_f32 v[176:177], v[152:153], v[72:73] op_sel_hi:[1,0] neg_lo:[0,1] neg_hi:[0,1]
    v_pk_add_f32 v[178:179], v[154:155], v[72:73] op_sel_hi:[1,0] neg_lo:[0,1] neg_hi:[0,1]
    v_pk_add_f32 v[180:181], v[156:157], v[72:73] op_sel_hi:[1,0] neg_lo:[0,1] neg_hi:[0,1]
    v_pk_add_f32 v[182:183], v[158:159], v[72:73] op_sel_hi:[1,0] neg_lo:[0,1] neg_hi:[0,1]
    v_pk_add_f32 v[184:185], v[160:161], v[72:73] op_sel_hi:[1,0] neg_lo:[0,1] neg_hi:[0,1]
    v_pk_add_f32 v[186:187], v[162:163], v[72:73] op_sel_hi:[1,0] neg_lo:[0,1] neg_hi:[0,1]
    v_pk_add_f32 v[188:189], v[164:165], v[72:73] op_sel_hi:[1,0] neg_lo:[0,1] neg_hi:[0,1]
    v_pk_add_f32 v[190:191], v[166:167], v[72:73] op_sel_hi:[1,0] neg_lo:[0,1] neg_hi:[0,1]
    v_cvt_pk_bf16_f32 v74, v74, v74
    v_and_b32 v74, 0xffff0000, v74
    v_rcp_f32 v74, v74
    v_cvt_pk_bf16_f32 v108, v168, v169
    v_cvt_pk_bf16_f32 v109, v170, v171
    v_cvt_pk_bf16_f32 v110, v172, v173
    v_cvt_pk_bf16_f32 v111, v174, v175
    v_cvt_pk_bf16_f32 v112, v176, v177
    v_cvt_pk_bf16_f32 v113, v178, v179
    v_cvt_pk_bf16_f32 v114, v180, v181
    v_cvt_pk_bf16_f32 v115, v182, v183
    v_cvt_pk_bf16_f32 v116, v184, v185
    v_cvt_pk_bf16_f32 v117, v186, v187
    v_cvt_pk_bf16_f32 v118, v188, v189
    v_cvt_pk_bf16_f32 v119, v190, v191
    v_lshlrev_b32 v168, 16, v108
    v_and_b32 v169, 0xffff0000, v108
    v_lshlrev_b32 v170, 16, v109
    v_and_b32 v171, 0xffff0000, v109
    v_lshlrev_b32 v172, 16, v110
    v_and_b32 v173, 0xffff0000, v110
    v_lshlrev_b32 v174, 16, v111
    v_and_b32 v175, 0xffff0000, v111
    v_lshlrev_b32 v176, 16, v112
    v_and_b32 v177, 0xffff0000, v112
    v_lshlrev_b32 v178, 16, v113
    v_and_b32 v179, 0xffff0000, v113
    v_lshlrev_b32 v180, 16, v114
    v_and_b32 v181, 0xffff0000, v114
    v_lshlrev_b32 v182, 16, v115
    v_and_b32 v183, 0xffff0000, v115
    v_lshlrev_b32 v184, 16, v116
    v_and_b32 v185, 0xffff0000, v116
    v_lshlrev_b32 v186, 16, v117
    v_and_b32 v187, 0xffff0000, v117
    v_lshlrev_b32 v188, 16, v118
    v_and_b32 v189, 0xffff0000, v118
    v_lshlrev_b32 v190, 16, v119
    v_and_b32 v191, 0xffff0000, v119
    v_pk_mul_f32 v[168:169], v[168:169], v[74:75] op_sel_hi:[1,0]
    v_pk_mul_f32 v[170:171], v[170:171], v[74:75] op_sel_hi:[1,0]
    v_pk_mul_f32 v[172:173], v[172:173], v[74:75] op_sel_hi:[1,0]
    v_pk_mul_f32 v[174:175], v[174:175], v[74:75] op_sel_hi:[1,0]
    v_pk_mul_f32 v[176:177], v[176:177], v[74:75] op_sel_hi:[1,0]
    v_pk_mul_f32 v[178:179], v[178:179], v[74:75] op_sel_hi:[1,0]
    v_pk_mul_f32 v[180:181], v[180:181], v[74:75] op_sel_hi:[1,0]
    v_pk_mul_f32 v[182:183], v[182:183], v[74:75] op_sel_hi:[1,0]
    v_pk_mul_f32 v[184:185], v[184:185], v[74:75] op_sel_hi:[1,0]
    v_pk_mul_f32 v[186:187], v[186:187], v[74:75] op_sel_hi:[1,0]
    v_pk_mul_f32 v[188:189], v[188:189], v[74:75] op_sel_hi:[1,0]
    v_pk_mul_f32 v[190:191], v[190:191], v[74:75] op_sel_hi:[1,0]
    v_cvt_pk_bf16_f32 v108, v168, v169
    v_cvt_pk_bf16_f32 v109, v170, v171
    v_cvt_pk_bf16_f32 v110, v172, v173
    v_cvt_pk_bf16_f32 v111, v174, v175
    v_cvt_pk_bf16_f32 v112, v176, v177
    v_cvt_pk_bf16_f32 v113, v178, v179
    v_cvt_pk_bf16_f32 v114, v180, v181
    v_cvt_pk_bf16_f32 v115, v182, v183
    v_cvt_pk_bf16_f32 v116, v184, v185
    v_cvt_pk_bf16_f32 v117, v186, v187
    v_cvt_pk_bf16_f32 v118, v188, v189
    v_cvt_pk_bf16_f32 v119, v190, v191
    v_lshlrev_b32 v168, 16, v108
    v_and_b32 v169, 0xffff0000, v108
    v_lshlrev_b32 v170, 16, v109
    v_and_b32 v171, 0xffff0000, v109
    v_lshlrev_b32 v172, 16, v110
    v_and_b32 v173, 0xffff0000, v110
    v_lshlrev_b32 v174, 16, v111
    v_and_b32 v175, 0xffff0000, v111
    v_lshlrev_b32 v176, 16, v112
    v_and_b32 v177, 0xffff0000, v112
    v_lshlrev_b32 v178, 16, v113
    v_and_b32 v179, 0xffff0000, v113
    v_lshlrev_b32 v180, 16, v114
    v_and_b32 v181, 0xffff0000, v114
    v_lshlrev_b32 v182, 16, v115
    v_and_b32 v183, 0xffff0000, v115
    v_lshlrev_b32 v184, 16, v116
    v_and_b32 v185, 0xffff0000, v116
    v_lshlrev_b32 v186, 16, v117
    v_and_b32 v187, 0xffff0000, v117
    v_lshlrev_b32 v188, 16, v118
    v_and_b32 v189, 0xffff0000, v118
    v_lshlrev_b32 v190, 16, v119
    v_and_b32 v191, 0xffff0000, v119
    s_mul_i32 s36, s3, 72
    v_add_u32 v72, s36, v1
    v_and_b32 v73, 7, v1
    s_add_u32 s36, s36, 64
    v_add_u32 v73, s36, v73
    v_lshlrev_b32 v74, 4, v72
    v_lshlrev_b32 v75, 4, v73
    s_movk_i32 s36, 1024
    v_lshl_add_u32 v72, v72, 3, s36
    v_lshl_add_u32 v73, v73, 3, s36
    s_add_u32 s49, s44, 0
    s_add_u32 m0, s42, 32768
    s_nop 0
    buffer_load_dwordx4 v42, s[16:19], s49 offen lds
    buffer_load_dwordx4 v43, s[16:19], s49 offen offset:1024 lds
    buffer_load_dwordx4 v44, s[16:19], s49 offen offset:2048 lds
    buffer_load_dwordx4 v45, s[16:19], s49 offen offset:3072 lds
    s_add_u32 s49, s44, 256
    s_add_u32 m0, s42, 49152
    s_nop 0
    buffer_load_dwordx4 v42, s[16:19], s49 offen lds
    buffer_load_dwordx4 v43, s[16:19], s49 offen offset:1024 lds
    buffer_load_dwordx4 v44, s[16:19], s49 offen offset:2048 lds
    buffer_load_dwordx4 v45, s[16:19], s49 offen offset:3072 lds
    s_mov_b32 s38, 16384
Lhead_pollm:
    buffer_load_dwordx4 v[88:91], v74, s[24:27], 0 offen sc1
    buffer_load_dwordx4 v[92:95], v75, s[24:27], 0 offen sc1
    s_sub_u32 s38, s38, 1
    s_cbranch_scc1 Lhead_gotm
    s_waitcnt vmcnt(0) lgkmcnt(0)
    v_xor_b32 v89, s95, v89
    v_xor_b32 v91, s95, v91
    v_xor_b32 v93, s95, v93
    v_xor_b32 v95, s95, v95
    v_or3_b32 v89, v89, v91, v93
    v_or_b32 v89, v89, v95
    v_cmp_ne_u32 vcc, 0, v89
    s_cbranch_vccnz Lhead_pollm
Lhead_gotm:
    s_waitcnt vmcnt(0) lgkmcnt(0)
    ds_write2_b32 v72, v88, v90 offset0:0 offset1:1
    ds_write2_b32 v73, v92, v94 offset0:0 offset1:1
    s_waitcnt lgkmcnt(0)
    s_barrier
    ds_read_b128 v[144:147], v68 offset:2176
    ds_read_b128 v[148:151], v68 offset:2560
    ds_read_b128 v[152:155], v68 offset:2944
    ds_read_b128 v[156:159], v68 offset:1024
    ds_read_b128 v[160:163], v68 offset:1408
    ds_read_b128 v[164:167], v68 offset:1792
    s_waitcnt lgkmcnt(5)
    v_lshlrev_b32 v192, 16, v144
    v_and_b32 v193, 0xffff0000, v144
    v_lshlrev_b32 v194, 16, v145
    v_and_b32 v195, 0xffff0000, v145
    v_lshlrev_b32 v196, 16, v146
    v_and_b32 v197, 0xffff0000, v146
    v_lshlrev_b32 v198, 16, v147
    v_and_b32 v199, 0xffff0000, v147
    s_waitcnt lgkmcnt(4)
    v_lshlrev_b32 v200, 16, v148
    v_and_b32 v201, 0xffff0000, v148
    v_lshlrev_b32 v202, 16, v149
    v_and_b32 v203, 0xffff0000, v149
    v_lshlrev_b32 v204, 16, v150
    v_and_b32 v205, 0xffff0000, v150
    v_lshlrev_b32 v206, 16, v151
    v_and_b32 v207, 0xffff0000, v151
    s_waitcnt lgkmcnt(3)
    v_lshlrev_b32 v208, 16, v152
    v_and_b32 v209, 0xffff0000, v152
    v_lshlrev_b32 v210, 16, v153
    v_and_b32 v211, 0xffff0000, v153
    v_lshlrev_b32 v212, 16, v154
    v_and_b32 v213, 0xffff0000, v154
    v_lshlrev_b32 v214, 16, v155
    v_and_b32 v215, 0xffff0000, v155
    v_pk_mul_f32 v[168:169], v[168:169], v[192:193]
    v_pk_mul_f32 v[170:171], v[170:171], v[194:195]
    v_pk_mul_f32 v[172:173], v[172:173], v[196:197]
    v_pk_mul_f32 v[174:175], v[174:175], v[198:199]
    v_pk_mul_f32 v[176:177], v[176:177], v[200:201]
    v_pk_mul_f32 v[178:179], v[178:179], v[202:203]
    v_pk_mul_f32 v[180:181], v[180:181], v[204:205]
    v_pk_mul_f32 v[182:183], v[182:183], v[206:207]
    v_pk_mul_f32 v[184:185], v[184:185], v[208:209]
    v_pk_mul_f32 v[186:187], v[186:187], v[210:211]
    v_pk_mul_f32 v[188:189], v[188:189], v[212:213]
    v_pk_mul_f32 v[190:191], v[190:191], v[214:215]
    v_cvt_pk_bf16_f32 v108, v168, v169
    v_cvt_pk_bf16_f32 v109, v170, v171
    v_cvt_pk_bf16_f32 v110, v172, v173
    v_cvt_pk_bf16_f32 v111, v174, v175
    v_cvt_pk_bf16_f32 v112, v176, v177
    v_cvt_pk_bf16_f32 v113, v178, v179
    v_cvt_pk_bf16_f32 v114, v180, v181
    v_cvt_pk_bf16_f32 v115, v182, v183
    v_cvt_pk_bf16_f32 v116, v184, v185
    v_cvt_pk_bf16_f32 v117, v186, v187
    v_cvt_pk_bf16_f32 v118, v188, v189
    v_cvt_pk_bf16_f32 v119, v190, v191
    s_waitcnt lgkmcnt(2)
    v_lshlrev_b32 v216, 16, v156
    v_and_b32 v217, 0xffff0000, v156
    v_lshlrev_b32 v218, 16, v157
    v_and_b32 v219, 0xffff0000, v157
    v_lshlrev_b32 v220, 16, v158
    v_and_b32 v221, 0xffff0000, v158
    v_lshlrev_b32 v222, 16, v159
    v_and_b32 v223, 0xffff0000, v159
    s_waitcnt lgkmcnt(1)
    v_lshlrev_b32 v224, 16, v160
    v_and_b32 v225, 0xffff0000, v160
    v_lshlrev_b32 v226, 16, v161
    v_and_b32 v227, 0xffff0000, v161
    v_lshlrev_b32 v228, 16, v162
    v_and_b32 v229, 0xffff0000, v162
    v_lshlrev_b32 v230, 16, v163
    v_and_b32 v231, 0xffff0000, v163
    s_waitcnt lgkmcnt(0)
    v_lshlrev_b32 v232, 16, v164
    v_and_b32 v233, 0xffff0000, v164
    v_lshlrev_b32 v234, 16, v165
    v_and_b32 v235, 0xffff0000, v165
    v_lshlrev_b32 v236, 16, v166
    v_and_b32 v237, 0xffff0000, v166
    v_lshlrev_b32 v238, 16, v167
    v_and_b32 v239, 0xffff0000, v167
    v_lshlrev_b32 v168, 16, v108
    v_and_b32 v169, 0xffff0000, v108
    v_lshlrev_b32 v170, 16, v109
    v_and_b32 v171, 0xffff0000, v109
    v_lshlrev_b32 v172, 16, v110
    v_and_b32 v173, 0xffff0000, v110
    v_lshlrev_b32 v174, 16, v111
    v_and_b32 v175, 0xffff0000, v111
    v_lshlrev_b32 v176, 16, v112
    v_and_b32 v177, 0xffff0000, v112
    v_lshlrev_b32 v178, 16, v113
    v_and_b32 v179, 0xffff0000, v113
    v_lshlrev_b32 v180, 16, v114
    v_and_b32 v181, 0xffff0000, v114
    v_lshlrev_b32 v182, 16, v115
    v_and_b32 v183, 0xffff0000, v115
    v_lshlrev_b32 v184, 16, v116
    v_and_b32 v185, 0xffff0000, v116
    v_lshlrev_b32 v186, 16, v117
    v_and_b32 v187, 0xffff0000, v117
    v_lshlrev_b32 v188, 16, v118
    v_and_b32 v189, 0xffff0000, v118
    v_lshlrev_b32 v190, 16, v119
    v_and_b32 v191, 0xffff0000, v119
    v_pk_add_f32 v[168:169], v[168:169], v[216:217]
    v_pk_add_f32 v[170:171], v[170:171], v[218:219]
    v_pk_add_f32 v[172:173], v[172:173], v[220:221]
    v_pk_add_f32 v[174:175], v[174:175], v[222:223]
    v_cvt_pk_bf16_f32 v108, v168, v169
    v_cvt_pk_bf16_f32 v109, v170, v171
    v_cvt_pk_bf16_f32 v110, v172, v173
    v_cvt_pk_bf16_f32 v111, v174, v175
    buffer_store_dwordx4 v[108:111], v67, s[24:27], s92 offen offset:0 sc1
    v_pk_add_f32 v[176:177], v[176:177], v[224:225]
    v_pk_add_f32 v[178:179], v[178:179], v[226:227]
    v_pk_add_f32 v[180:181], v[180:181], v[228:229]
    v_pk_add_f32 v[182:183], v[182:183], v[230:231]
    v_cvt_pk_bf16_f32 v112, v176, v177
    v_cvt_pk_bf16_f32 v113, v178, v179
    v_cvt_pk_bf16_f32 v114, v180, v181
    v_cvt_pk_bf16_f32 v115, v182, v183
    buffer_store_dwordx4 v[112:115], v67, s[24:27], s92 offen offset:768 sc1
    v_pk_add_f32 v[184:185], v[184:185], v[232:233]
    v_pk_add_f32 v[186:187], v[186:187], v[234:235]
    v_pk_add_f32 v[188:189], v[188:189], v[236:237]
    v_pk_add_f32 v[190:191], v[190:191], v[238:239]
    v_cvt_pk_bf16_f32 v116, v184, v185
    v_cvt_pk_bf16_f32 v117, v186, v187
    v_cvt_pk_bf16_f32 v118, v188, v189
    v_cvt_pk_bf16_f32 v119, v190, v191
    buffer_store_dwordx4 v[116:119], v67, s[24:27], s92 offen offset:1536 sc1
    s_lshl_b32 s36, s5, 8
    s_add_u32 s36, s36, 28672
    s_lshl_b32 s37, s4, 4
    s_add_u32 s37, s37, s36
    s_lshl_b32 s38, s3, 2
    s_add_u32 s37, s37, s38
    s_lshl_b32 s38, s3, 6
    s_add_u32 s36, s36, s38
    v_mov_b32 v72, 0
    v_and_b32 v73, 15, v1
    v_lshlrev_b32 v73, 2, v73
    v_mov_b32 v88, -1
    v_mov_b32 v89, -1
    v_mov_b32 v90, -1
    v_mov_b32 v91, -1
    v_min_u32 v74, 164, v0
    v_lshlrev_b32 v74, 4, v74
    s_mul_i32 s39, s2, 2640
    s_add_u32 s39, s39, 7852032
    v_cmp_eq_u32 vcc, 0, v0
    v_mov_b32 v64, 2147483648
    v_mov_b32 v65, 1
    s_waitcnt vmcnt(0)
    s_mov_b64 exec, 1
    buffer_store_dword v137, v72, s[24:27], s37 offen sc1
    s_mov_b64 exec, -1
    v_cndmask_b32 v64, v64, 0, vcc
    s_add_u32 s49, s44, 524288
    s_add_u32 m0, s42, 65536
    s_nop 0
    buffer_load_dwordx4 v42, s[16:19], s49 offen lds
    buffer_load_dwordx4 v43, s[16:19], s49 offen offset:1024 lds
    buffer_load_dwordx4 v44, s[16:19], s49 offen offset:2048 lds
    buffer_load_dwordx4 v45, s[16:19], s49 offen offset:3072 lds
    s_add_u32 s49, s44, 524544
    s_add_u32 m0, s42, 81920
    s_nop 0
    buffer_load_dwordx4 v42, s[16:19], s49 offen lds
    buffer_load_dwordx4 v43, s[16:19], s49 offen offset:1024 lds
    buffer_load_dwordx4 v44, s[16:19], s49 offen offset:2048 lds
    buffer_load_dwordx4 v45, s[16:19], s49 offen offset:3072 lds
    s_add_u32 s49, s44, 1048576
    s_add_u32 m0, s42, 98304
    s_nop 0
    buffer_load_dwordx4 v42, s[16:19], s49 offen lds
    buffer_load_dwordx4 v43, s[16:19], s49 offen offset:1024 lds
    buffer_load_dwordx4 v44, s[16:19], s49 offen offset:2048 lds
    buffer_load_dwordx4 v45, s[16:19], s49 offen offset:3072 lds
    s_add_u32 s49, s44, 1048832
    s_add_u32 m0, s42, 114688
    s_nop 0
    buffer_load_dwordx4 v42, s[16:19], s49 offen lds
    buffer_load_dwordx4 v43, s[16:19], s49 offen offset:1024 lds
    buffer_load_dwordx4 v44, s[16:19], s49 offen offset:2048 lds
    buffer_load_dwordx4 v45, s[16:19], s49 offen offset:3072 lds
    s_mov_b32 s38, 16384
Lhead_pollh:
    buffer_load_dword v75, v73, s[24:27], s36 offen sc1
    s_sub_u32 s38, s38, 1
    s_cbranch_scc1 Lhead_goth
    s_waitcnt vmcnt(0) lgkmcnt(0)
    v_cmp_ne_u32 vcc, s95, v75
    s_cbranch_vccnz Lhead_pollh
Lhead_goth:
    s_waitcnt vmcnt(0) lgkmcnt(0)
    buffer_load_dwordx4 a[0:3], v51, s[24:27], s46 offen offset:0 sc1
    buffer_load_dwordx4 a[8:11], v51, s[24:27], s46 offen offset:128 sc1
    buffer_load_dwordx4 a[4:7], v51, s[24:27], s43 offen offset:0 sc1
    buffer_load_dwordx4 a[12:15], v51, s[24:27], s43 offen offset:128 sc1
    buffer_load_dwordx4 a[16:19], v51, s[24:27], s46 offen offset:256 sc1
    buffer_load_dwordx4 a[24:27], v51, s[24:27], s46 offen offset:384 sc1
    buffer_load_dwordx4 a[20:23], v51, s[24:27], s43 offen offset:256 sc1
    buffer_load_dwordx4 a[28:31], v51, s[24:27], s43 offen offset:384 sc1
    buffer_load_dwordx4 a[32:35], v51, s[24:27], s46 offen offset:512 sc1
    buffer_load_dwordx4 a[40:43], v51, s[24:27], s46 offen offset:640 sc1
    buffer_load_dwordx4 a[36:39], v51, s[24:27], s43 offen offset:512 sc1
    buffer_load_dwordx4 a[44:47], v51, s[24:27], s43 offen offset:640 sc1
    s_add_u32 s49, s44, 1572864
    s_add_u32 m0, s42, 131072
    s_nop 0
    buffer_load_dwordx4 v42, s[16:19], s49 offen lds
    buffer_load_dwordx4 v43, s[16:19], s49 offen offset:1024 lds
    buffer_load_dwordx4 v44, s[16:19], s49 offen offset:2048 lds
    buffer_load_dwordx4 v45, s[16:19], s49 offen offset:3072 lds
    s_add_u32 s49, s44, 1573120
    s_add_u32 m0, s42, 147456
    s_nop 0
    buffer_load_dwordx4 v42, s[16:19], s49 offen lds
    buffer_load_dwordx4 v43, s[16:19], s49 offen offset:1024 lds
    buffer_load_dwordx4 v44, s[16:19], s49 offen offset:2048 lds
    buffer_load_dwordx4 v45, s[16:19], s49 offen offset:3072 lds
    buffer_store_dwordx4 v[88:91], v74, s[24:27], s39 offen sc1
    s_add_u32 s36, s92, 2555904
    buffer_store_dwordx4 v[88:91], v67, s[24:27], s36 offen offset:0 sc1
    buffer_store_dwordx4 v[88:91], v67, s[24:27], s36 offen offset:768 sc1
    buffer_store_dwordx4 v[88:91], v67, s[24:27], s36 offen offset:1536 sc1
    s_add_u32 s36, s92, 5177344
    buffer_store_dwordx4 v[88:91], v67, s[24:27], s36 offen offset:0 sc1
    buffer_store_dwordx4 v[88:91], v67, s[24:27], s36 offen offset:768 sc1
    buffer_store_dwordx4 v[88:91], v67, s[24:27], s36 offen offset:1536 sc1
    s_barrier
    ds_read_b64_tr_b16 a[160:161], v12 offset:32768
    ds_read_b64_tr_b16 a[162:163], v12 offset:36864
    ds_read_b64_tr_b16 a[164:165], v12 offset:40960
    ds_read_b64_tr_b16 a[166:167], v12 offset:45056
    ds_read_b64_tr_b16 a[168:169], v13 offset:32768
    ds_read_b64_tr_b16 a[170:171], v13 offset:36864
    ds_read_b64_tr_b16 a[172:173], v13 offset:40960
    ds_read_b64_tr_b16 a[174:175], v13 offset:45056
    ds_read_b64_tr_b16 a[176:177], v14 offset:32768
    ds_read_b64_tr_b16 a[178:179], v14 offset:36864
    ds_read_b64_tr_b16 a[180:181], v14 offset:40960
    ds_read_b64_tr_b16 a[182:183], v14 offset:45056
    s_waitcnt lgkmcnt(10)
    s_waitcnt vmcnt(26)
    v_mfma_f32_16x16x32_bf16 v[128:131], a[160:163], a[0:3], 0
    s_waitcnt vmcnt(25)
    s_waitcnt lgkmcnt(8)
    ds_read_b64_tr_b16 a[184:185], v15 offset:32768
    v_mfma_f32_16x16x32_bf16 v[128:131], a[164:167], a[8:11], v[128:131]
    s_waitcnt vmcnt(24)
    ds_read_b64_tr_b16 a[186:187], v15 offset:36864
    v_mfma_f32_16x16x32_bf16 v[132:135], a[160:163], a[4:7], 0
    s_waitcnt vmcnt(23)
    ds_read_b64_tr_b16 a[188:189], v15 offset:40960
    v_mfma_f32_16x16x32_bf16 v[132:135], a[164:167], a[12:15], v[132:135]
    s_waitcnt lgkmcnt(9)
    ds_read_b64_tr_b16 a[190:191], v15 offset:45056
    buffer_load_dwordx4 a[48:51], v51, s[24:27], s46 offen offset:768 sc1
    v_mfma_f32_16x16x32_bf16 v[136:139], a[168:171], a[0:3], 0
    s_waitcnt lgkmcnt(8)
    ds_read_b64_tr_b16 a[160:161], v16 offset:32768
    v_mfma_f32_16x16x32_bf16 v[136:139], a[172:175], a[8:11], v[136:139]
    ds_read_b64_tr_b16 a[162:163], v16 offset:36864
    v_mfma_f32_16x16x32_bf16 v[140:143], a[168:171], a[4:7], 0
    ds_read_b64_tr_b16 a[164:165], v16 offset:40960
    v_mfma_f32_16x16x32_bf16 v[140:143], a[172:175], a[12:15], v[140:143]
    s_waitcnt lgkmcnt(9)
    ds_read_b64_tr_b16 a[166:167], v16 offset:45056
    buffer_load_dwordx4 a[56:59], v51, s[24:27], s46 offen offset:896 sc1
    v_mfma_f32_16x16x32_bf16 v[144:147], a[176:179], a[0:3], 0
    s_waitcnt lgkmcnt(8)
    ds_read_b64_tr_b16 a[168:169], v17 offset:32768
    v_mfma_f32_16x16x32_bf16 v[144:147], a[180:183], a[8:11], v[144:147]
    ds_read_b64_tr_b16 a[170:171], v17 offset:36864
    v_mfma_f32_16x16x32_bf16 v[148:151], a[176:179], a[4:7], 0
    ds_read_b64_tr_b16 a[172:173], v17 offset:40960
    v_mfma_f32_16x16x32_bf16 v[148:151], a[180:183], a[12:15], v[148:151]
    s_waitcnt lgkmcnt(9)
    ds_read_b64_tr_b16 a[174:175], v17 offset:45056
    buffer_load_dwordx4 a[52:55], v51, s[24:27], s43 offen offset:768 sc1
    v_mfma_f32_16x16x32_bf16 v[152:155], a[184:187], a[0:3], 0
    s_waitcnt lgkmcnt(8)
    ds_read_b64_tr_b16 a[176:177], v18 offset:32768
    v_mfma_f32_16x16x32_bf16 v[152:155], a[188:191], a[8:11], v[152:155]
    ds_read_b64_tr_b16 a[178:179], v18 offset:36864
    v_mfma_f32_16x16x32_bf16 v[156:159], a[184:187], a[4:7], 0
    ds_read_b64_tr_b16 a[180:181], v18 offset:40960
    v_mfma_f32_16x16x32_bf16 v[156:159], a[188:191], a[12:15], v[156:159]
    s_waitcnt lgkmcnt(9)
    ds_read_b64_tr_b16 a[182:183], v18 offset:45056
    buffer_load_dwordx4 a[60:63], v51, s[24:27], s43 offen offset:896 sc1
    v_mfma_f32_16x16x32_bf16 v[160:163], a[160:163], a[0:3], 0
    s_waitcnt lgkmcnt(8)
    ds_read_b64_tr_b16 a[184:185], v19 offset:32768
    v_mfma_f32_16x16x32_bf16 v[160:163], a[164:167], a[8:11], v[160:163]
    s_add_u32 s49, s44, 2097152
    ds_read_b64_tr_b16 a[186:187], v19 offset:36864
    v_mfma_f32_16x16x32_bf16 v[164:167], a[160:163], a[4:7], 0
    s_add_u32 m0, s42, 0
    ds_read_b64_tr_b16 a[188:189], v19 offset:40960
    v_mfma_f32_16x16x32_bf16 v[164:167], a[164:167], a[12:15], v[164:167]
    s_waitcnt lgkmcnt(9)
    ds_read_b64_tr_b16 a[190:191], v19 offset:45056
    buffer_load_dwordx4 v42, s[16:19], s49 offen lds
    v_mfma_f32_16x16x32_bf16 v[168:171], a[168:171], a[0:3], 0
    s_waitcnt lgkmcnt(8)
    ds_read_b64_tr_b16 a[160:161], v12 offset:49152
    v_mfma_f32_16x16x32_bf16 v[168:171], a[172:175], a[8:11], v[168:171]
    ds_read_b64_tr_b16 a[162:163], v12 offset:53248
    v_mfma_f32_16x16x32_bf16 v[172:175], a[168:171], a[4:7], 0
    ds_read_b64_tr_b16 a[164:165], v12 offset:57344
    v_mfma_f32_16x16x32_bf16 v[172:175], a[172:175], a[12:15], v[172:175]
    s_waitcnt lgkmcnt(9)
    ds_read_b64_tr_b16 a[166:167], v12 offset:61440
    buffer_load_dwordx4 v43, s[16:19], s49 offen offset:1024 lds
    v_mfma_f32_16x16x32_bf16 v[176:179], a[176:179], a[0:3], 0
    s_waitcnt lgkmcnt(8)
    ds_read_b64_tr_b16 a[168:169], v13 offset:49152
    v_mfma_f32_16x16x32_bf16 v[176:179], a[180:183], a[8:11], v[176:179]
    ds_read_b64_tr_b16 a[170:171], v13 offset:53248
    v_mfma_f32_16x16x32_bf16 v[180:183], a[176:179], a[4:7], 0
    ds_read_b64_tr_b16 a[172:173], v13 offset:57344
    v_mfma_f32_16x16x32_bf16 v[180:183], a[180:183], a[12:15], v[180:183]
    s_waitcnt lgkmcnt(9)
    ds_read_b64_tr_b16 a[174:175], v13 offset:61440
    buffer_load_dwordx4 v44, s[16:19], s49 offen offset:2048 lds
    v_mfma_f32_16x16x32_bf16 v[184:187], a[184:187], a[0:3], 0
    s_waitcnt lgkmcnt(8)
    ds_read_b64_tr_b16 a[176:177], v14 offset:49152
    v_mfma_f32_16x16x32_bf16 v[184:187], a[188:191], a[8:11], v[184:187]
    ds_read_b64_tr_b16 a[178:179], v14 offset:53248
    v_mfma_f32_16x16x32_bf16 v[188:191], a[184:187], a[4:7], 0
    ds_read_b64_tr_b16 a[180:181], v14 offset:57344
    v_mfma_f32_16x16x32_bf16 v[188:191], a[188:191], a[12:15], v[188:191]
    s_waitcnt lgkmcnt(9)
    ds_read_b64_tr_b16 a[182:183], v14 offset:61440
    buffer_load_dwordx4 v45, s[16:19], s49 offen offset:3072 lds
    v_mfma_f32_16x16x32_bf16 v[192:195], a[160:163], a[0:3], 0
    s_waitcnt lgkmcnt(8)
    ds_read_b64_tr_b16 a[184:185], v15 offset:49152
    v_mfma_f32_16x16x32_bf16 v[192:195], a[164:167], a[8:11], v[192:195]
    s_add_u32 s49, s44, 2097408
    ds_read_b64_tr_b16 a[186:187], v15 offset:53248
    v_mfma_f32_16x16x32_bf16 v[196:199], a[160:163], a[4:7], 0
    s_add_u32 m0, s42, 16384
    ds_read_b64_tr_b16 a[188:189], v15 offset:57344
    v_mfma_f32_16x16x32_bf16 v[196:199], a[164:167], a[12:15], v[196:199]
    s_waitcnt lgkmcnt(9)
    ds_read_b64_tr_b16 a[190:191], v15 offset:61440
    buffer_load_dwordx4 v42, s[16:19], s49 offen lds
    v_mfma_f32_16x16x32_bf16 v[200:203], a[168:171], a[0:3], 0
    s_waitcnt lgkmcnt(8)
    ds_read_b64_tr_b16 a[160:161], v16 offset:49152
    v_mfma_f32_16x16x32_bf16 v[200:203], a[172:175], a[8:11], v[200:203]
    ds_read_b64_tr_b16 a[162:163], v16 offset:53248
    v_mfma_f32_16x16x32_bf16 v[204:207], a[168:171], a[4:7], 0
    ds_read_b64_tr_b16 a[164:165], v16 offset:57344
    v_mfma_f32_16x16x32_bf16 v[204:207], a[172:175], a[12:15], v[204:207]
    s_waitcnt lgkmcnt(9)
    ds_read_b64_tr_b16 a[166:167], v16 offset:61440
    buffer_load_dwordx4 v43, s[16:19], s49 offen offset:1024 lds
    v_mfma_f32_16x16x32_bf16 v[208:211], a[176:179], a[0:3], 0
    s_waitcnt lgkmcnt(8)
    ds_read_b64_tr_b16 a[168:169], v17 offset:49152
    v_mfma_f32_16x16x32_bf16 v[208:211], a[180:183], a[8:11], v[208:211]
    ds_read_b64_tr_b16 a[170:171], v17 offset:53248
    v_mfma_f32_16x16x32_bf16 v[212:215], a[176:179], a[4:7], 0
    ds_read_b64_tr_b16 a[172:173], v17 offset:57344
    v_mfma_f32_16x16x32_bf16 v[212:215], a[180:183], a[12:15], v[212:215]
    s_waitcnt lgkmcnt(9)
    ds_read_b64_tr_b16 a[174:175], v17 offset:61440
    buffer_load_dwordx4 v44, s[16:19], s49 offen offset:2048 lds
    v_mfma_f32_16x16x32_bf16 v[216:219], a[184:187], a[0:3], 0
    s_waitcnt lgkmcnt(8)
    ds_read_b64_tr_b16 a[176:177], v18 offset:49152
    v_mfma_f32_16x16x32_bf16 v[216:219], a[188:191], a[8:11], v[216:219]
    ds_read_b64_tr_b16 a[178:179], v18 offset:53248
    v_mfma_f32_16x16x32_bf16 v[220:223], a[184:187], a[4:7], 0
    ds_read_b64_tr_b16 a[180:181], v18 offset:57344
    v_mfma_f32_16x16x32_bf16 v[220:223], a[188:191], a[12:15], v[220:223]
    s_waitcnt lgkmcnt(9)
    ds_read_b64_tr_b16 a[182:183], v18 offset:61440
    buffer_load_dwordx4 v45, s[16:19], s49 offen offset:3072 lds
    v_mfma_f32_16x16x32_bf16 v[224:227], a[160:163], a[0:3], 0
    s_waitcnt lgkmcnt(8)
    ds_read_b64_tr_b16 a[184:185], v19 offset:49152
    v_mfma_f32_16x16x32_bf16 v[224:227], a[164:167], a[8:11], v[224:227]
    ds_read_b64_tr_b16 a[186:187], v19 offset:53248
    v_mfma_f32_16x16x32_bf16 v[228:231], a[160:163], a[4:7], 0
    ds_read_b64_tr_b16 a[188:189], v19 offset:57344
    v_mfma_f32_16x16x32_bf16 v[228:231], a[164:167], a[12:15], v[228:231]
    s_waitcnt lgkmcnt(9)
    ds_read_b64_tr_b16 a[190:191], v19 offset:61440
    s_barrier
    v_mfma_f32_16x16x32_bf16 v[232:235], a[168:171], a[0:3], 0
    s_waitcnt lgkmcnt(8)
    ds_read_b64_tr_b16 a[160:161], v20 offset:0
    v_mfma_f32_16x16x32_bf16 v[232:235], a[172:175], a[8:11], v[232:235]
    ds_read_b64_tr_b16 a[162:163], v20 offset:4096
    v_mfma_f32_16x16x32_bf16 v[236:239], a[168:171], a[4:7], 0
    ds_read_b64_tr_b16 a[164:165], v20 offset:8192
    v_mfma_f32_16x16x32_bf16 v[236:239], a[172:175], a[12:15], v[236:239]
    s_waitcnt lgkmcnt(9)
    ds_read_b64_tr_b16 a[166:167], v20 offset:12288
    buffer_load_dwordx4 a[64:67], v51, s[24:27], s46 offen offset:1024 sc1
    v_mfma_f32_16x16x32_bf16 v[240:243], a[176:179], a[0:3], 0
    s_waitcnt lgkmcnt(8)
    ds_read_b64_tr_b16 a[168:169], v21 offset:0
    v_mfma_f32_16x16x32_bf16 v[240:243], a[180:183], a[8:11], v[240:243]
    ds_read_b64_tr_b16 a[170:171], v21 offset:4096
    v_mfma_f32_16x16x32_bf16 v[244:247], a[176:179], a[4:7], 0
    ds_read_b64_tr_b16 a[172:173], v21 offset:8192
    v_mfma_f32_16x16x32_bf16 v[244:247], a[180:183], a[12:15], v[244:247]
    s_waitcnt lgkmcnt(9)
    ds_read_b64_tr_b16 a[174:175], v21 offset:12288
    buffer_load_dwordx4 a[72:75], v51, s[24:27], s46 offen offset:1152 sc1
    v_mfma_f32_16x16x32_bf16 v[248:251], a[184:187], a[0:3], 0
    s_waitcnt lgkmcnt(8)
    ds_read_b64_tr_b16 a[176:177], v22 offset:0
    v_mfma_f32_16x16x32_bf16 v[248:251], a[188:191], a[8:11], v[248:251]
    ds_read_b64_tr_b16 a[178:179], v22 offset:4096
    v_mfma_f32_16x16x32_bf16 v[252:255], a[184:187], a[4:7], 0
    ds_read_b64_tr_b16 a[180:181], v22 offset:8192
    v_mfma_f32_16x16x32_bf16 v[252:255], a[188:191], a[12:15], v[252:255]
    s_waitcnt vmcnt(36)
    s_waitcnt lgkmcnt(9)
    ds_read_b64_tr_b16 a[182:183], v22 offset:12288
    buffer_load_dwordx4 a[68:71], v51, s[24:27], s43 offen offset:1024 sc1
    v_mfma_f32_16x16x32_bf16 v[128:131], a[160:163], a[16:19], v[128:131]
    s_waitcnt vmcnt(36)
    s_waitcnt lgkmcnt(8)
    ds_read_b64_tr_b16 a[184:185], v23 offset:0
    v_mfma_f32_16x16x32_bf16 v[128:131], a[164:167], a[24:27], v[128:131]
    s_waitcnt vmcnt(35)
    ds_read_b64_tr_b16 a[186:187], v23 offset:4096
    v_mfma_f32_16x16x32_bf16 v[132:135], a[160:163], a[20:23], v[132:135]
    s_waitcnt vmcnt(34)
    ds_read_b64_tr_b16 a[188:189], v23 offset:8192
    v_mfma_f32_16x16x32_bf16 v[132:135], a[164:167], a[28:31], v[132:135]
    s_waitcnt lgkmcnt(9)
    ds_read_b64_tr_b16 a[190:191], v23 offset:12288
    buffer_load_dwordx4 a[76:79], v51, s[24:27], s43 offen offset:1152 sc1
    v_mfma_f32_16x16x32_bf16 v[136:139], a[168:171], a[16:19], v[136:139]
    s_waitcnt lgkmcnt(8)
    ds_read_b64_tr_b16 a[160:161], v24 offset:0
    v_mfma_f32_16x16x32_bf16 v[136:139], a[172:175], a[24:27], v[136:139]
    ds_read_b64_tr_b16 a[162:163], v24 offset:4096
    v_mfma_f32_16x16x32_bf16 v[140:143], a[168:171], a[20:23], v[140:143]
    ds_read_b64_tr_b16 a[164:165], v24 offset:8192
    v_mfma_f32_16x16x32_bf16 v[140:143], a[172:175], a[28:31], v[140:143]
    s_waitcnt lgkmcnt(9)
    ds_read_b64_tr_b16 a[166:167], v24 offset:12288
    buffer_load_dwordx4 a[80:83], v51, s[24:27], s46 offen offset:1280 sc1
    v_mfma_f32_16x16x32_bf16 v[144:147], a[176:179], a[16:19], v[144:147]
    s_waitcnt lgkmcnt(8)
    ds_read_b64_tr_b16 a[168:169], v25 offset:0
    v_mfma_f32_16x16x32_bf16 v[144:147], a[180:183], a[24:27], v[144:147]
    ds_read_b64_tr_b16 a[170:171], v25 offset:4096
    v_mfma_f32_16x16x32_bf16 v[148:151], a[176:179], a[20:23], v[148:151]
    ds_read_b64_tr_b16 a[172:173], v25 offset:8192
    v_mfma_f32_16x16x32_bf16 v[148:151], a[180:183], a[28:31], v[148:151]
    s_waitcnt lgkmcnt(9)
    ds_read_b64_tr_b16 a[174:175], v25 offset:12288
    buffer_load_dwordx4 a[88:91], v51, s[24:27], s46 offen offset:1408 sc1
    v_mfma_f32_16x16x32_bf16 v[152:155], a[184:187], a[16:19], v[152:155]
    s_waitcnt lgkmcnt(8)
    ds_read_b64_tr_b16 a[176:177], v26 offset:0
    v_mfma_f32_16x16x32_bf16 v[152:155], a[188:191], a[24:27], v[152:155]
    ds_read_b64_tr_b16 a[178:179], v26 offset:4096
    v_mfma_f32_16x16x32_bf16 v[156:159], a[184:187], a[20:23], v[156:159]
    ds_read_b64_tr_b16 a[180:181], v26 offset:8192
    v_mfma_f32_16x16x32_bf16 v[156:159], a[188:191], a[28:31], v[156:159]
    s_waitcnt lgkmcnt(9)
    ds_read_b64_tr_b16 a[182:183], v26 offset:12288
    buffer_load_dwordx4 a[84:87], v51, s[24:27], s43 offen offset:1280 sc1
    v_mfma_f32_16x16x32_bf16 v[160:163], a[160:163], a[16:19], v[160:163]
    s_waitcnt lgkmcnt(8)
    ds_read_b64_tr_b16 a[184:185], v27 offset:0
    v_mfma_f32_16x16x32_bf16 v[160:163], a[164:167], a[24:27], v[160:163]
    ds_read_b64_tr_b16 a[186:187], v27 offset:4096
    v_mfma_f32_16x16x32_bf16 v[164:167], a[160:163], a[20:23], v[164:167]
    ds_read_b64_tr_b16 a[188:189], v27 offset:8192
    v_mfma_f32_16x16x32_bf16 v[164:167], a[164:167], a[28:31], v[164:167]
    s_waitcnt lgkmcnt(9)
    ds_read_b64_tr_b16 a[190:191], v27 offset:12288
    buffer_load_dwordx4 a[92:95], v51, s[24:27], s43 offen offset:1408 sc1
    v_mfma_f32_16x16x32_bf16 v[168:171], a[168:171], a[16:19], v[168:171]
    s_waitcnt lgkmcnt(8)
    ds_read_b64_tr_b16 a[160:161], v20 offset:16384
    v_mfma_f32_16x16x32_bf16 v[168:171], a[172:175], a[24:27], v[168:171]
    ds_read_b64_tr_b16 a[162:163], v20 offset:20480
    v_mfma_f32_16x16x32_bf16 v[172:175], a[168:171], a[20:23], v[172:175]
    ds_read_b64_tr_b16 a[164:165], v20 offset:24576
    v_mfma_f32_16x16x32_bf16 v[172:175], a[172:175], a[28:31], v[172:175]
    s_waitcnt lgkmcnt(9)
    ds_read_b64_tr_b16 a[166:167], v20 offset:28672
    buffer_load_dwordx4 a[96:99], v51, s[24:27], s46 offen offset:1536 sc1
    v_mfma_f32_16x16x32_bf16 v[176:179], a[176:179], a[16:19], v[176:179]
    s_waitcnt lgkmcnt(8)
    ds_read_b64_tr_b16 a[168:169], v21 offset:16384
    v_mfma_f32_16x16x32_bf16 v[176:179], a[180:183], a[24:27], v[176:179]
    ds_read_b64_tr_b16 a[170:171], v21 offset:20480
    v_mfma_f32_16x16x32_bf16 v[180:183], a[176:179], a[20:23], v[180:183]
    ds_read_b64_tr_b16 a[172:173], v21 offset:24576
    v_mfma_f32_16x16x32_bf16 v[180:183], a[180:183], a[28:31], v[180:183]
    s_waitcnt lgkmcnt(9)
    ds_read_b64_tr_b16 a[174:175], v21 offset:28672
    buffer_load_dwordx4 a[104:107], v51, s[24:27], s46 offen offset:1664 sc1
    v_mfma_f32_16x16x32_bf16 v[184:187], a[184:187], a[16:19], v[184:187]
    s_waitcnt lgkmcnt(8)
    ds_read_b64_tr_b16 a[176:177], v22 offset:16384
    v_mfma_f32_16x16x32_bf16 v[184:187], a[188:191], a[24:27], v[184:187]
    ds_read_b64_tr_b16 a[178:179], v22 offset:20480
    v_mfma_f32_16x16x32_bf16 v[188:191], a[184:187], a[20:23], v[188:191]
    ds_read_b64_tr_b16 a[180:181], v22 offset:24576
    v_mfma_f32_16x16x32_bf16 v[188:191], a[188:191], a[28:31], v[188:191]
    s_waitcnt lgkmcnt(9)
    ds_read_b64_tr_b16 a[182:183], v22 offset:28672
    buffer_load_dwordx4 a[100:103], v51, s[24:27], s43 offen offset:1536 sc1
    v_mfma_f32_16x16x32_bf16 v[192:195], a[160:163], a[16:19], v[192:195]
    s_waitcnt lgkmcnt(8)
    ds_read_b64_tr_b16 a[184:185], v23 offset:16384
    v_mfma_f32_16x16x32_bf16 v[192:195], a[164:167], a[24:27], v[192:195]
    ds_read_b64_tr_b16 a[186:187], v23 offset:20480
    v_mfma_f32_16x16x32_bf16 v[196:199], a[160:163], a[20:23], v[196:199]
    ds_read_b64_tr_b16 a[188:189], v23 offset:24576
    v_mfma_f32_16x16x32_bf16 v[196:199], a[164:167], a[28:31], v[196:199]
    s_waitcnt lgkmcnt(9)
    ds_read_b64_tr_b16 a[190:191], v23 offset:28672
    buffer_load_dwordx4 a[108:111], v51, s[24:27], s43 offen offset:1664 sc1
    v_mfma_f32_16x16x32_bf16 v[200:203], a[168:171], a[16:19], v[200:203]
    s_waitcnt lgkmcnt(8)
    ds_read_b64_tr_b16 a[160:161], v24 offset:16384
    v_mfma_f32_16x16x32_bf16 v[200:203], a[172:175], a[24:27], v[200:203]
    ds_read_b64_tr_b16 a[162:163], v24 offset:20480
    v_mfma_f32_16x16x32_bf16 v[204:207], a[168:171], a[20:23], v[204:207]
    ds_read_b64_tr_b16 a[164:165], v24 offset:24576
    v_mfma_f32_16x16x32_bf16 v[204:207], a[172:175], a[28:31], v[204:207]
    s_waitcnt lgkmcnt(9)
    ds_read_b64_tr_b16 a[166:167], v24 offset:28672
    v_mfma_f32_16x16x32_bf16 v[208:211], a[176:179], a[16:19], v[208:211]
    s_waitcnt lgkmcnt(8)
    ds_read_b64_tr_b16 a[168:169], v25 offset:16384
    v_mfma_f32_16x16x32_bf16 v[208:211], a[180:183], a[24:27], v[208:211]
    ds_read_b64_tr_b16 a[170:171], v25 offset:20480
    v_mfma_f32_16x16x32_bf16 v[212:215], a[176:179], a[20:23], v[212:215]
    ds_read_b64_tr_b16 a[172:173], v25 offset:24576
    v_mfma_f32_16x16x32_bf16 v[212:215], a[180:183], a[28:31], v[212:215]
    s_waitcnt lgkmcnt(9)
    ds_read_b64_tr_b16 a[174:175], v25 offset:28672
    v_mfma_f32_16x16x32_bf16 v[216:219], a[184:187], a[16:19], v[216:219]
    s_waitcnt lgkmcnt(8)
    ds_read_b64_tr_b16 a[176:177], v26 offset:16384
    v_mfma_f32_16x16x32_bf16 v[216:219], a[188:191], a[24:27], v[216:219]
    ds_read_b64_tr_b16 a[178:179], v26 offset:20480
    v_mfma_f32_16x16x32_bf16 v[220:223], a[184:187], a[20:23], v[220:223]
    ds_read_b64_tr_b16 a[180:181], v26 offset:24576
    v_mfma_f32_16x16x32_bf16 v[220:223], a[188:191], a[28:31], v[220:223]
    s_waitcnt lgkmcnt(9)
    ds_read_b64_tr_b16 a[182:183], v26 offset:28672
    v_mfma_f32_16x16x32_bf16 v[224:227], a[160:163], a[16:19], v[224:227]
    s_waitcnt lgkmcnt(8)
    ds_read_b64_tr_b16 a[184:185], v27 offset:16384
    v_mfma_f32_16x16x32_bf16 v[224:227], a[164:167], a[24:27], v[224:227]
    ds_read_b64_tr_b16 a[186:187], v27 offset:20480
    v_mfma_f32_16x16x32_bf16 v[228:231], a[160:163], a[20:23], v[228:231]
    ds_read_b64_tr_b16 a[188:189], v27 offset:24576
    v_mfma_f32_16x16x32_bf16 v[228:231], a[164:167], a[28:31], v[228:231]
    s_waitcnt lgkmcnt(9)
    ds_read_b64_tr_b16 a[190:191], v27 offset:28672
    s_barrier
    v_mfma_f32_16x16x32_bf16 v[232:235], a[168:171], a[16:19], v[232:235]
    s_waitcnt lgkmcnt(8)
    ds_read_b64_tr_b16 a[160:161], v20 offset:32768
    v_mfma_f32_16x16x32_bf16 v[232:235], a[172:175], a[24:27], v[232:235]
    ds_read_b64_tr_b16 a[162:163], v20 offset:36864
    v_mfma_f32_16x16x32_bf16 v[236:239], a[168:171], a[20:23], v[236:239]
    ds_read_b64_tr_b16 a[164:165], v20 offset:40960
    v_mfma_f32_16x16x32_bf16 v[236:239], a[172:175], a[28:31], v[236:239]
    s_waitcnt lgkmcnt(9)
    ds_read_b64_tr_b16 a[166:167], v20 offset:45056
    buffer_load_dwordx4 a[112:115], v51, s[24:27], s46 offen offset:1792 sc1
    v_mfma_f32_16x16x32_bf16 v[240:243], a[176:179], a[16:19], v[240:243]
    s_waitcnt lgkmcnt(8)
    ds_read_b64_tr_b16 a[168:169], v21 offset:32768
    v_mfma_f32_16x16x32_bf16 v[240:243], a[180:183], a[24:27], v[240:243]
    ds_read_b64_tr_b16 a[170:171], v21 offset:36864
    v_mfma_f32_16x16x32_bf16 v[244:247], a[176:179], a[20:23], v[244:247]
    ds_read_b64_tr_b16 a[172:173], v21 offset:40960
    v_mfma_f32_16x16x32_bf16 v[244:247], a[180:183], a[28:31], v[244:247]
    s_waitcnt lgkmcnt(9)
    ds_read_b64_tr_b16 a[174:175], v21 offset:45056
    buffer_load_dwordx4 a[120:123], v51, s[24:27], s46 offen offset:1920 sc1
    v_mfma_f32_16x16x32_bf16 v[248:251], a[184:187], a[16:19], v[248:251]
    s_waitcnt lgkmcnt(8)
    ds_read_b64_tr_b16 a[176:177], v22 offset:32768
    v_mfma_f32_16x16x32_bf16 v[248:251], a[188:191], a[24:27], v[248:251]
    ds_read_b64_tr_b16 a[178:179], v22 offset:36864
    v_mfma_f32_16x16x32_bf16 v[252:255], a[184:187], a[20:23], v[252:255]
    ds_read_b64_tr_b16 a[180:181], v22 offset:40960
    v_mfma_f32_16x16x32_bf16 v[252:255], a[188:191], a[28:31], v[252:255]
    s_waitcnt vmcnt(44)
    s_waitcnt lgkmcnt(9)
    ds_read_b64_tr_b16 a[182:183], v22 offset:45056
    buffer_load_dwordx4 a[116:119], v51, s[24:27], s43 offen offset:1792 sc1
    v_mfma_f32_16x16x32_bf16 v[128:131], a[160:163], a[32:35], v[128:131]
    s_waitcnt vmcnt(44)
    s_waitcnt lgkmcnt(8)
    ds_read_b64_tr_b16 a[184:185], v23 offset:32768
    v_mfma_f32_16x16x32_bf16 v[128:131], a[164:167], a[40:43], v[128:131]
    s_waitcnt vmcnt(43)
    ds_read_b64_tr_b16 a[186:187], v23 offset:36864
    v_mfma_f32_16x16x32_bf16 v[132:135], a[160:163], a[36:39], v[132:135]
    s_waitcnt vmcnt(42)
    ds_read_b64_tr_b16 a[188:189], v23 offset:40960
    v_mfma_f32_16x16x32_bf16 v[132:135], a[164:167], a[44:47], v[132:135]
    s_waitcnt lgkmcnt(9)
    ds_read_b64_tr_b16 a[190:191], v23 offset:45056
    buffer_load_dwordx4 a[124:127], v51, s[24:27], s43 offen offset:1920 sc1
    v_mfma_f32_16x16x32_bf16 v[136:139], a[168:171], a[32:35], v[136:139]
    s_waitcnt lgkmcnt(8)
    ds_read_b64_tr_b16 a[160:161], v24 offset:32768
    v_mfma_f32_16x16x32_bf16 v[136:139], a[172:175], a[40:43], v[136:139]
    s_add_u32 s49, s44, 2621440
    ds_read_b64_tr_b16 a[162:163], v24 offset:36864
    v_mfma_f32_16x16x32_bf16 v[140:143], a[168:171], a[36:39], v[140:143]
    s_add_u32 m0, s42, 32768
    ds_read_b64_tr_b16 a[164:165], v24 offset:40960
    v_mfma_f32_16x16x32_bf16 v[140:143], a[172:175], a[44:47], v[140:143]
    s_waitcnt lgkmcnt(9)
    ds_read_b64_tr_b16 a[166:167], v24 offset:45056
    buffer_load_dwordx4 v42, s[16:19], s49 offen lds
    v_mfma_f32_16x16x32_bf16 v[144:147], a[176:179], a[32:35], v[144:147]
    s_waitcnt lgkmcnt(8)
    ds_read_b64_tr_b16 a[168:169], v25 offset:32768
    v_mfma_f32_16x16x32_bf16 v[144:147], a[180:183], a[40:43], v[144:147]
    ds_read_b64_tr_b16 a[170:171], v25 offset:36864
    v_mfma_f32_16x16x32_bf16 v[148:151], a[176:179], a[36:39], v[148:151]
    ds_read_b64_tr_b16 a[172:173], v25 offset:40960
    v_mfma_f32_16x16x32_bf16 v[148:151], a[180:183], a[44:47], v[148:151]
    s_waitcnt lgkmcnt(9)
    ds_read_b64_tr_b16 a[174:175], v25 offset:45056
    buffer_load_dwordx4 v43, s[16:19], s49 offen offset:1024 lds
    v_mfma_f32_16x16x32_bf16 v[152:155], a[184:187], a[32:35], v[152:155]
    s_waitcnt lgkmcnt(8)
    ds_read_b64_tr_b16 a[176:177], v26 offset:32768
    v_mfma_f32_16x16x32_bf16 v[152:155], a[188:191], a[40:43], v[152:155]
    ds_read_b64_tr_b16 a[178:179], v26 offset:36864
    v_mfma_f32_16x16x32_bf16 v[156:159], a[184:187], a[36:39], v[156:159]
    ds_read_b64_tr_b16 a[180:181], v26 offset:40960
    v_mfma_f32_16x16x32_bf16 v[156:159], a[188:191], a[44:47], v[156:159]
    s_waitcnt lgkmcnt(9)
    ds_read_b64_tr_b16 a[182:183], v26 offset:45056
    buffer_load_dwordx4 v44, s[16:19], s49 offen offset:2048 lds
    v_mfma_f32_16x16x32_bf16 v[160:163], a[160:163], a[32:35], v[160:163]
    s_waitcnt lgkmcnt(8)
    ds_read_b64_tr_b16 a[184:185], v27 offset:32768
    v_mfma_f32_16x16x32_bf16 v[160:163], a[164:167], a[40:43], v[160:163]
    ds_read_b64_tr_b16 a[186:187], v27 offset:36864
    v_mfma_f32_16x16x32_bf16 v[164:167], a[160:163], a[36:39], v[164:167]
    ds_read_b64_tr_b16 a[188:189], v27 offset:40960
    v_mfma_f32_16x16x32_bf16 v[164:167], a[164:167], a[44:47], v[164:167]
    s_waitcnt lgkmcnt(9)
    ds_read_b64_tr_b16 a[190:191], v27 offset:45056
    buffer_load_dwordx4 v45, s[16:19], s49 offen offset:3072 lds
    v_mfma_f32_16x16x32_bf16 v[168:171], a[168:171], a[32:35], v[168:171]
    s_waitcnt lgkmcnt(8)
    ds_read_b64_tr_b16 a[160:161], v20 offset:49152
    v_mfma_f32_16x16x32_bf16 v[168:171], a[172:175], a[40:43], v[168:171]
    s_add_u32 s49, s44, 2621696
    ds_read_b64_tr_b16 a[162:163], v20 offset:53248
    v_mfma_f32_16x16x32_bf16 v[172:175], a[168:171], a[36:39], v[172:175]
    s_add_u32 m0, s42, 49152
    ds_read_b64_tr_b16 a[164:165], v20 offset:57344
    v_mfma_f32_16x16x32_bf16 v[172:175], a[172:175], a[44:47], v[172:175]
    s_waitcnt lgkmcnt(9)
    ds_read_b64_tr_b16 a[166:167], v20 offset:61440
    buffer_load_dwordx4 v42, s[16:19], s49 offen lds
    v_mfma_f32_16x16x32_bf16 v[176:179], a[176:179], a[32:35], v[176:179]
    s_waitcnt lgkmcnt(8)
    ds_read_b64_tr_b16 a[168:169], v21 offset:49152
    v_mfma_f32_16x16x32_bf16 v[176:179], a[180:183], a[40:43], v[176:179]
    ds_read_b64_tr_b16 a[170:171], v21 offset:53248
    v_mfma_f32_16x16x32_bf16 v[180:183], a[176:179], a[36:39], v[180:183]
    ds_read_b64_tr_b16 a[172:173], v21 offset:57344
    v_mfma_f32_16x16x32_bf16 v[180:183], a[180:183], a[44:47], v[180:183]
    s_waitcnt lgkmcnt(9)
    ds_read_b64_tr_b16 a[174:175], v21 offset:61440
    buffer_load_dwordx4 v43, s[16:19], s49 offen offset:1024 lds
    v_mfma_f32_16x16x32_bf16 v[184:187], a[184:187], a[32:35], v[184:187]
    s_waitcnt lgkmcnt(8)
    ds_read_b64_tr_b16 a[176:177], v22 offset:49152
    v_mfma_f32_16x16x32_bf16 v[184:187], a[188:191], a[40:43], v[184:187]
    ds_read_b64_tr_b16 a[178:179], v22 offset:53248
    v_mfma_f32_16x16x32_bf16 v[188:191], a[184:187], a[36:39], v[188:191]
    ds_read_b64_tr_b16 a[180:181], v22 offset:57344
    v_mfma_f32_16x16x32_bf16 v[188:191], a[188:191], a[44:47], v[188:191]
    s_waitcnt lgkmcnt(9)
    ds_read_b64_tr_b16 a[182:183], v22 offset:61440
    buffer_load_dwordx4 v44, s[16:19], s49 offen offset:2048 lds
    v_mfma_f32_16x16x32_bf16 v[192:195], a[160:163], a[32:35], v[192:195]
    s_waitcnt lgkmcnt(8)
    ds_read_b64_tr_b16 a[184:185], v23 offset:49152
    v_mfma_f32_16x16x32_bf16 v[192:195], a[164:167], a[40:43], v[192:195]
    ds_read_b64_tr_b16 a[186:187], v23 offset:53248
    v_mfma_f32_16x16x32_bf16 v[196:199], a[160:163], a[36:39], v[196:199]
    ds_read_b64_tr_b16 a[188:189], v23 offset:57344
    v_mfma_f32_16x16x32_bf16 v[196:199], a[164:167], a[44:47], v[196:199]
    s_waitcnt lgkmcnt(9)
    ds_read_b64_tr_b16 a[190:191], v23 offset:61440
    buffer_load_dwordx4 v45, s[16:19], s49 offen offset:3072 lds
    v_mfma_f32_16x16x32_bf16 v[200:203], a[168:171], a[32:35], v[200:203]
    s_waitcnt lgkmcnt(8)
    ds_read_b64_tr_b16 a[160:161], v24 offset:49152
    v_mfma_f32_16x16x32_bf16 v[200:203], a[172:175], a[40:43], v[200:203]
    ds_read_b64_tr_b16 a[162:163], v24 offset:53248
    v_mfma_f32_16x16x32_bf16 v[204:207], a[168:171], a[36:39], v[204:207]
    ds_read_b64_tr_b16 a[164:165], v24 offset:57344
    v_mfma_f32_16x16x32_bf16 v[204:207], a[172:175], a[44:47], v[204:207]
    s_waitcnt lgkmcnt(9)
    ds_read_b64_tr_b16 a[166:167], v24 offset:61440
    v_mfma_f32_16x16x32_bf16 v[208:211], a[176:179], a[32:35], v[208:211]
    s_waitcnt lgkmcnt(8)
    ds_read_b64_tr_b16 a[168:169], v25 offset:49152
    v_mfma_f32_16x16x32_bf16 v[208:211], a[180:183], a[40:43], v[208:211]
    ds_read_b64_tr_b16 a[170:171], v25 offset:53248
    v_mfma_f32_16x16x32_bf16 v[212:215], a[176:179], a[36:39], v[212:215]
    ds_read_b64_tr_b16 a[172:173], v25 offset:57344
    v_mfma_f32_16x16x32_bf16 v[212:215], a[180:183], a[44:47], v[212:215]
    s_waitcnt lgkmcnt(9)
    ds_read_b64_tr_b16 a[174:175], v25 offset:61440
    v_mfma_f32_16x16x32_bf16 v[216:219], a[184:187], a[32:35], v[216:219]
    s_waitcnt lgkmcnt(8)
    ds_read_b64_tr_b16 a[176:177], v26 offset:49152
    v_mfma_f32_16x16x32_bf16 v[216:219], a[188:191], a[40:43], v[216:219]
    ds_read_b64_tr_b16 a[178:179], v26 offset:53248
    v_mfma_f32_16x16x32_bf16 v[220:223], a[184:187], a[36:39], v[220:223]
    ds_read_b64_tr_b16 a[180:181], v26 offset:57344
    v_mfma_f32_16x16x32_bf16 v[220:223], a[188:191], a[44:47], v[220:223]
    s_waitcnt lgkmcnt(9)
    ds_read_b64_tr_b16 a[182:183], v26 offset:61440
    v_mfma_f32_16x16x32_bf16 v[224:227], a[160:163], a[32:35], v[224:227]
    s_waitcnt lgkmcnt(8)
    ds_read_b64_tr_b16 a[184:185], v27 offset:49152
    v_mfma_f32_16x16x32_bf16 v[224:227], a[164:167], a[40:43], v[224:227]
    ds_read_b64_tr_b16 a[186:187], v27 offset:53248
    v_mfma_f32_16x16x32_bf16 v[228:231], a[160:163], a[36:39], v[228:231]
    ds_read_b64_tr_b16 a[188:189], v27 offset:57344
    v_mfma_f32_16x16x32_bf16 v[228:231], a[164:167], a[44:47], v[228:231]
    s_waitcnt lgkmcnt(9)
    ds_read_b64_tr_b16 a[190:191], v27 offset:61440
    s_waitcnt vmcnt(43)
    s_barrier
    v_mfma_f32_16x16x32_bf16 v[232:235], a[168:171], a[32:35], v[232:235]
    s_waitcnt lgkmcnt(8)
    ds_read_b64_tr_b16 a[160:161], v28 offset:0
    v_mfma_f32_16x16x32_bf16 v[232:235], a[172:175], a[40:43], v[232:235]
    ds_read_b64_tr_b16 a[162:163], v28 offset:4096
    v_mfma_f32_16x16x32_bf16 v[236:239], a[168:171], a[36:39], v[236:239]
    ds_read_b64_tr_b16 a[164:165], v28 offset:8192
    v_mfma_f32_16x16x32_bf16 v[236:239], a[172:175], a[44:47], v[236:239]
    s_waitcnt lgkmcnt(9)
    ds_read_b64_tr_b16 a[166:167], v28 offset:12288
    buffer_load_dwordx4 a[128:131], v51, s[24:27], s46 offen offset:2048 sc1
    v_mfma_f32_16x16x32_bf16 v[240:243], a[176:179], a[32:35], v[240:243]
    s_waitcnt lgkmcnt(8)
    ds_read_b64_tr_b16 a[168:169], v29 offset:0
    v_mfma_f32_16x16x32_bf16 v[240:243], a[180:183], a[40:43], v[240:243]
    ds_read_b64_tr_b16 a[170:171], v29 offset:4096
    v_mfma_f32_16x16x32_bf16 v[244:247], a[176:179], a[36:39], v[244:247]
    ds_read_b64_tr_b16 a[172:173], v29 offset:8192
    v_mfma_f32_16x16x32_bf16 v[244:247], a[180:183], a[44:47], v[244:247]
    s_waitcnt lgkmcnt(9)
    ds_read_b64_tr_b16 a[174:175], v29 offset:12288
    buffer_load_dwordx4 a[136:139], v51, s[24:27], s46 offen offset:2176 sc1
    v_mfma_f32_16x16x32_bf16 v[248:251], a[184:187], a[32:35], v[248:251]
    s_waitcnt lgkmcnt(8)
    ds_read_b64_tr_b16 a[176:177], v30 offset:0
    v_mfma_f32_16x16x32_bf16 v[248:251], a[188:191], a[40:43], v[248:251]
    ds_read_b64_tr_b16 a[178:179], v30 offset:4096
    v_mfma_f32_16x16x32_bf16 v[252:255], a[184:187], a[36:39], v[252:255]
    ds_read_b64_tr_b16 a[180:181], v30 offset:8192
    v_mfma_f32_16x16x32_bf16 v[252:255], a[188:191], a[44:47], v[252:255]
    s_waitcnt vmcnt(37)
    s_waitcnt lgkmcnt(9)
    ds_read_b64_tr_b16 a[182:183], v30 offset:12288
    buffer_load_dwordx4 a[132:135], v51, s[24:27], s43 offen offset:2048 sc1
    v_mfma_f32_16x16x32_bf16 v[128:131], a[160:163], a[48:51], v[128:131]
    s_waitcnt vmcnt(37)
    s_waitcnt lgkmcnt(8)
    ds_read_b64_tr_b16 a[184:185], v31 offset:0
    v_mfma_f32_16x16x32_bf16 v[128:131], a[164:167], a[56:59], v[128:131]
    s_waitcnt vmcnt(36)
    ds_read_b64_tr_b16 a[186:187], v31 offset:4096
    v_mfma_f32_16x16x32_bf16 v[132:135], a[160:163], a[52:55], v[132:135]
    s_waitcnt vmcnt(35)
    ds_read_b64_tr_b16 a[188:189], v31 offset:8192
    v_mfma_f32_16x16x32_bf16 v[132:135], a[164:167], a[60:63], v[132:135]
    s_waitcnt lgkmcnt(9)
    ds_read_b64_tr_b16 a[190:191], v31 offset:12288
    buffer_load_dwordx4 a[140:143], v51, s[24:27], s43 offen offset:2176 sc1
    v_mfma_f32_16x16x32_bf16 v[136:139], a[168:171], a[48:51], v[136:139]
    s_waitcnt lgkmcnt(8)
    ds_read_b64_tr_b16 a[160:161], v32 offset:0
    v_mfma_f32_16x16x32_bf16 v[136:139], a[172:175], a[56:59], v[136:139]
    s_add_u32 s49, s44, 3145728
    ds_read_b64_tr_b16 a[162:163], v32 offset:4096
    v_mfma_f32_16x16x32_bf16 v[140:143], a[168:171], a[52:55], v[140:143]
    s_add_u32 m0, s42, 65536
    ds_read_b64_tr_b16 a[164:165], v32 offset:8192
    v_mfma_f32_16x16x32_bf16 v[140:143], a[172:175], a[60:63], v[140:143]
    s_waitcnt lgkmcnt(9)
    ds_read_b64_tr_b16 a[166:167], v32 offset:12288
    buffer_load_dwordx4 v42, s[16:19], s49 offen lds
    v_mfma_f32_16x16x32_bf16 v[144:147], a[176:179], a[48:51], v[144:147]
    s_waitcnt lgkmcnt(8)
    ds_read_b64_tr_b16 a[168:169], v33 offset:0
    v_mfma_f32_16x16x32_bf16 v[144:147], a[180:183], a[56:59], v[144:147]
    ds_read_b64_tr_b16 a[170:171], v33 offset:4096
    v_mfma_f32_16x16x32_bf16 v[148:151], a[176:179], a[52:55], v[148:151]
    ds_read_b64_tr_b16 a[172:173], v33 offset:8192
    v_mfma_f32_16x16x32_bf16 v[148:151], a[180:183], a[60:63], v[148:151]
    s_waitcnt lgkmcnt(9)
    ds_read_b64_tr_b16 a[174:175], v33 offset:12288
    buffer_load_dwordx4 v43, s[16:19], s49 offen offset:1024 lds
    v_mfma_f32_16x16x32_bf16 v[152:155], a[184:187], a[48:51], v[152:155]
    s_waitcnt lgkmcnt(8)
    ds_read_b64_tr_b16 a[176:177], v34 offset:0
    v_mfma_f32_16x16x32_bf16 v[152:155], a[188:191], a[56:59], v[152:155]
    ds_read_b64_tr_b16 a[178:179], v34 offset:4096
    v_mfma_f32_16x16x32_bf16 v[156:159], a[184:187], a[52:55], v[156:159]
    ds_read_b64_tr_b16 a[180:181], v34 offset:8192
    v_mfma_f32_16x16x32_bf16 v[156:159], a[188:191], a[60:63], v[156:159]
    s_waitcnt lgkmcnt(9)
    ds_read_b64_tr_b16 a[182:183], v34 offset:12288
    buffer_load_dwordx4 v44, s[16:19], s49 offen offset:2048 lds
    v_mfma_f32_16x16x32_bf16 v[160:163], a[160:163], a[48:51], v[160:163]
    s_waitcnt lgkmcnt(8)
    ds_read_b64_tr_b16 a[184:185], v35 offset:0
    v_mfma_f32_16x16x32_bf16 v[160:163], a[164:167], a[56:59], v[160:163]
    ds_read_b64_tr_b16 a[186:187], v35 offset:4096
    v_mfma_f32_16x16x32_bf16 v[164:167], a[160:163], a[52:55], v[164:167]
    ds_read_b64_tr_b16 a[188:189], v35 offset:8192
    v_mfma_f32_16x16x32_bf16 v[164:167], a[164:167], a[60:63], v[164:167]
    s_waitcnt lgkmcnt(9)
    ds_read_b64_tr_b16 a[190:191], v35 offset:12288
    buffer_load_dwordx4 v45, s[16:19], s49 offen offset:3072 lds
    v_mfma_f32_16x16x32_bf16 v[168:171], a[168:171], a[48:51], v[168:171]
    s_waitcnt lgkmcnt(8)
    ds_read_b64_tr_b16 a[160:161], v28 offset:16384
    v_mfma_f32_16x16x32_bf16 v[168:171], a[172:175], a[56:59], v[168:171]
    s_add_u32 s49, s44, 3145984
    ds_read_b64_tr_b16 a[162:163], v28 offset:20480
    v_mfma_f32_16x16x32_bf16 v[172:175], a[168:171], a[52:55], v[172:175]
    s_add_u32 m0, s42, 81920
    ds_read_b64_tr_b16 a[164:165], v28 offset:24576
    v_mfma_f32_16x16x32_bf16 v[172:175], a[172:175], a[60:63], v[172:175]
    s_waitcnt lgkmcnt(9)
    ds_read_b64_tr_b16 a[166:167], v28 offset:28672
    buffer_load_dwordx4 v42, s[16:19], s49 offen lds
    v_mfma_f32_16x16x32_bf16 v[176:179], a[176:179], a[48:51], v[176:179]
    s_waitcnt lgkmcnt(8)
    ds_read_b64_tr_b16 a[168:169], v29 offset:16384
    v_mfma_f32_16x16x32_bf16 v[176:179], a[180:183], a[56:59], v[176:179]
    ds_read_b64_tr_b16 a[170:171], v29 offset:20480
    v_mfma_f32_16x16x32_bf16 v[180:183], a[176:179], a[52:55], v[180:183]
    ds_read_b64_tr_b16 a[172:173], v29 offset:24576
    v_mfma_f32_16x16x32_bf16 v[180:183], a[180:183], a[60:63], v[180:183]
    s_waitcnt lgkmcnt(9)
    ds_read_b64_tr_b16 a[174:175], v29 offset:28672
    buffer_load_dwordx4 v43, s[16:19], s49 offen offset:1024 lds
    v_mfma_f32_16x16x32_bf16 v[184:187], a[184:187], a[48:51], v[184:187]
    s_waitcnt lgkmcnt(8)
    ds_read_b64_tr_b16 a[176:177], v30 offset:16384
    v_mfma_f32_16x16x32_bf16 v[184:187], a[188:191], a[56:59], v[184:187]
    ds_read_b64_tr_b16 a[178:179], v30 offset:20480
    v_mfma_f32_16x16x32_bf16 v[188:191], a[184:187], a[52:55], v[188:191]
    ds_read_b64_tr_b16 a[180:181], v30 offset:24576
    v_mfma_f32_16x16x32_bf16 v[188:191], a[188:191], a[60:63], v[188:191]
    s_waitcnt lgkmcnt(9)
    ds_read_b64_tr_b16 a[182:183], v30 offset:28672
    buffer_load_dwordx4 v44, s[16:19], s49 offen offset:2048 lds
    v_mfma_f32_16x16x32_bf16 v[192:195], a[160:163], a[48:51], v[192:195]
    s_waitcnt lgkmcnt(8)
    ds_read_b64_tr_b16 a[184:185], v31 offset:16384
    v_mfma_f32_16x16x32_bf16 v[192:195], a[164:167], a[56:59], v[192:195]
    ds_read_b64_tr_b16 a[186:187], v31 offset:20480
    v_mfma_f32_16x16x32_bf16 v[196:199], a[160:163], a[52:55], v[196:199]
    ds_read_b64_tr_b16 a[188:189], v31 offset:24576
    v_mfma_f32_16x16x32_bf16 v[196:199], a[164:167], a[60:63], v[196:199]
    s_waitcnt lgkmcnt(9)
    ds_read_b64_tr_b16 a[190:191], v31 offset:28672
    buffer_load_dwordx4 v45, s[16:19], s49 offen offset:3072 lds
    v_mfma_f32_16x16x32_bf16 v[200:203], a[168:171], a[48:51], v[200:203]
    s_waitcnt lgkmcnt(8)
    ds_read_b64_tr_b16 a[160:161], v32 offset:16384
    v_mfma_f32_16x16x32_bf16 v[200:203], a[172:175], a[56:59], v[200:203]
    ds_read_b64_tr_b16 a[162:163], v32 offset:20480
    v_mfma_f32_16x16x32_bf16 v[204:207], a[168:171], a[52:55], v[204:207]
    ds_read_b64_tr_b16 a[164:165], v32 offset:24576
    v_mfma_f32_16x16x32_bf16 v[204:207], a[172:175], a[60:63], v[204:207]
    s_waitcnt lgkmcnt(9)
    ds_read_b64_tr_b16 a[166:167], v32 offset:28672
    v_mfma_f32_16x16x32_bf16 v[208:211], a[176:179], a[48:51], v[208:211]
    s_waitcnt lgkmcnt(8)
    ds_read_b64_tr_b16 a[168:169], v33 offset:16384
    v_mfma_f32_16x16x32_bf16 v[208:211], a[180:183], a[56:59], v[208:211]
    ds_read_b64_tr_b16 a[170:171], v33 offset:20480
    v_mfma_f32_16x16x32_bf16 v[212:215], a[176:179], a[52:55], v[212:215]
    ds_read_b64_tr_b16 a[172:173], v33 offset:24576
    v_mfma_f32_16x16x32_bf16 v[212:215], a[180:183], a[60:63], v[212:215]
    s_waitcnt lgkmcnt(9)
    ds_read_b64_tr_b16 a[174:175], v33 offset:28672
    v_mfma_f32_16x16x32_bf16 v[216:219], a[184:187], a[48:51], v[216:219]
    s_waitcnt lgkmcnt(8)
    ds_read_b64_tr_b16 a[176:177], v34 offset:16384
    v_mfma_f32_16x16x32_bf16 v[216:219], a[188:191], a[56:59], v[216:219]
    ds_read_b64_tr_b16 a[178:179], v34 offset:20480
    v_mfma_f32_16x16x32_bf16 v[220:223], a[184:187], a[52:55], v[220:223]
    ds_read_b64_tr_b16 a[180:181], v34 offset:24576
    v_mfma_f32_16x16x32_bf16 v[220:223], a[188:191], a[60:63], v[220:223]
    s_waitcnt lgkmcnt(9)
    ds_read_b64_tr_b16 a[182:183], v34 offset:28672
    v_mfma_f32_16x16x32_bf16 v[224:227], a[160:163], a[48:51], v[224:227]
    s_waitcnt lgkmcnt(8)
    ds_read_b64_tr_b16 a[184:185], v35 offset:16384
    v_mfma_f32_16x16x32_bf16 v[224:227], a[164:167], a[56:59], v[224:227]
    ds_read_b64_tr_b16 a[186:187], v35 offset:20480
    v_mfma_f32_16x16x32_bf16 v[228:231], a[160:163], a[52:55], v[228:231]
    ds_read_b64_tr_b16 a[188:189], v35 offset:24576
    v_mfma_f32_16x16x32_bf16 v[228:231], a[164:167], a[60:63], v[228:231]
    s_waitcnt lgkmcnt(9)
    ds_read_b64_tr_b16 a[190:191], v35 offset:28672
    s_waitcnt vmcnt(36)
    s_barrier
    v_mfma_f32_16x16x32_bf16 v[232:235], a[168:171], a[48:51], v[232:235]
    s_waitcnt lgkmcnt(8)
    ds_read_b64_tr_b16 a[160:161], v12 offset:0
    v_mfma_f32_16x16x32_bf16 v[232:235], a[172:175], a[56:59], v[232:235]
    s_add_u32 s49, s44, 3670016
    ds_read_b64_tr_b16 a[162:163], v12 offset:4096
    v_mfma_f32_16x16x32_bf16 v[236:239], a[168:171], a[52:55], v[236:239]
    s_add_u32 m0, s42, 98304
    ds_read_b64_tr_b16 a[164:165], v12 offset:8192
    v_mfma_f32_16x16x32_bf16 v[236:239], a[172:175], a[60:63], v[236:239]
    s_waitcnt lgkmcnt(9)
    ds_read_b64_tr_b16 a[166:167], v12 offset:12288
    buffer_load_dwordx4 v42, s[16:19], s49 offen lds
    v_mfma_f32_16x16x32_bf16 v[240:243], a[176:179], a[48:51], v[240:243]
    s_waitcnt lgkmcnt(8)
    ds_read_b64_tr_b16 a[168:169], v13 offset:0
    v_mfma_f32_16x16x32_bf16 v[240:243], a[180:183], a[56:59], v[240:243]
    ds_read_b64_tr_b16 a[170:171], v13 offset:4096
    v_mfma_f32_16x16x32_bf16 v[244:247], a[176:179], a[52:55], v[244:247]
    ds_read_b64_tr_b16 a[172:173], v13 offset:8192
    v_mfma_f32_16x16x32_bf16 v[244:247], a[180:183], a[60:63], v[244:247]
    s_waitcnt lgkmcnt(9)
    ds_read_b64_tr_b16 a[174:175], v13 offset:12288
    buffer_load_dwordx4 v43, s[16:19], s49 offen offset:1024 lds
    v_mfma_f32_16x16x32_bf16 v[248:251], a[184:187], a[48:51], v[248:251]
    s_waitcnt lgkmcnt(8)
    ds_read_b64_tr_b16 a[176:177], v14 offset:0
    v_mfma_f32_16x16x32_bf16 v[248:251], a[188:191], a[56:59], v[248:251]
    ds_read_b64_tr_b16 a[178:179], v14 offset:4096
    v_mfma_f32_16x16x32_bf16 v[252:255], a[184:187], a[52:55], v[252:255]
    ds_read_b64_tr_b16 a[180:181], v14 offset:8192
    v_mfma_f32_16x16x32_bf16 v[252:255], a[188:191], a[60:63], v[252:255]
    s_waitcnt vmcnt(37)
    s_waitcnt lgkmcnt(9)
    ds_read_b64_tr_b16 a[182:183], v14 offset:12288
    buffer_load_dwordx4 v44, s[16:19], s49 offen offset:2048 lds
    v_mfma_f32_16x16x32_bf16 v[128:131], a[160:163], a[64:67], v[128:131]
    s_waitcnt vmcnt(37)
    s_waitcnt lgkmcnt(8)
    ds_read_b64_tr_b16 a[184:185], v15 offset:0
    v_mfma_f32_16x16x32_bf16 v[128:131], a[164:167], a[72:75], v[128:131]
    s_waitcnt vmcnt(36)
    ds_read_b64_tr_b16 a[186:187], v15 offset:4096
    v_mfma_f32_16x16x32_bf16 v[132:135], a[160:163], a[68:71], v[132:135]
    s_waitcnt vmcnt(35)
    ds_read_b64_tr_b16 a[188:189], v15 offset:8192
    v_mfma_f32_16x16x32_bf16 v[132:135], a[164:167], a[76:79], v[132:135]
    s_waitcnt lgkmcnt(9)
    ds_read_b64_tr_b16 a[190:191], v15 offset:12288
    buffer_load_dwordx4 v45, s[16:19], s49 offen offset:3072 lds
    v_mfma_f32_16x16x32_bf16 v[136:139], a[168:171], a[64:67], v[136:139]
    s_waitcnt lgkmcnt(8)
    ds_read_b64_tr_b16 a[160:161], v16 offset:0
    v_mfma_f32_16x16x32_bf16 v[136:139], a[172:175], a[72:75], v[136:139]
    s_add_u32 s49, s44, 3670272
    ds_read_b64_tr_b16 a[162:163], v16 offset:4096
    v_mfma_f32_16x16x32_bf16 v[140:143], a[168:171], a[68:71], v[140:143]
    s_add_u32 m0, s42, 114688
    ds_read_b64_tr_b16 a[164:165], v16 offset:8192
    v_mfma_f32_16x16x32_bf16 v[140:143], a[172:175], a[76:79], v[140:143]
    s_waitcnt lgkmcnt(9)
    ds_read_b64_tr_b16 a[166:167], v16 offset:12288
    buffer_load_dwordx4 v42, s[16:19], s49 offen lds
    v_mfma_f32_16x16x32_bf16 v[144:147], a[176:179], a[64:67], v[144:147]
    s_waitcnt lgkmcnt(8)
    ds_read_b64_tr_b16 a[168:169], v17 offset:0
    v_mfma_f32_16x16x32_bf16 v[144:147], a[180:183], a[72:75], v[144:147]
    ds_read_b64_tr_b16 a[170:171], v17 offset:4096
    v_mfma_f32_16x16x32_bf16 v[148:151], a[176:179], a[68:71], v[148:151]
    ds_read_b64_tr_b16 a[172:173], v17 offset:8192
    v_mfma_f32_16x16x32_bf16 v[148:151], a[180:183], a[76:79], v[148:151]
    s_waitcnt lgkmcnt(9)
    ds_read_b64_tr_b16 a[174:175], v17 offset:12288
    buffer_load_dwordx4 v43, s[16:19], s49 offen offset:1024 lds
    v_mfma_f32_16x16x32_bf16 v[152:155], a[184:187], a[64:67], v[152:155]
    s_waitcnt lgkmcnt(8)
    ds_read_b64_tr_b16 a[176:177], v18 offset:0
    v_mfma_f32_16x16x32_bf16 v[152:155], a[188:191], a[72:75], v[152:155]
    ds_read_b64_tr_b16 a[178:179], v18 offset:4096
    v_mfma_f32_16x16x32_bf16 v[156:159], a[184:187], a[68:71], v[156:159]
    ds_read_b64_tr_b16 a[180:181], v18 offset:8192
    v_mfma_f32_16x16x32_bf16 v[156:159], a[188:191], a[76:79], v[156:159]
    s_waitcnt lgkmcnt(9)
    ds_read_b64_tr_b16 a[182:183], v18 offset:12288
    buffer_load_dwordx4 v44, s[16:19], s49 offen offset:2048 lds
    v_mfma_f32_16x16x32_bf16 v[160:163], a[160:163], a[64:67], v[160:163]
    s_waitcnt lgkmcnt(8)
    ds_read_b64_tr_b16 a[184:185], v19 offset:0
    v_mfma_f32_16x16x32_bf16 v[160:163], a[164:167], a[72:75], v[160:163]
    ds_read_b64_tr_b16 a[186:187], v19 offset:4096
    v_mfma_f32_16x16x32_bf16 v[164:167], a[160:163], a[68:71], v[164:167]
    ds_read_b64_tr_b16 a[188:189], v19 offset:8192
    v_mfma_f32_16x16x32_bf16 v[164:167], a[164:167], a[76:79], v[164:167]
    s_waitcnt lgkmcnt(9)
    ds_read_b64_tr_b16 a[190:191], v19 offset:12288
    buffer_load_dwordx4 v45, s[16:19], s49 offen offset:3072 lds
    v_mfma_f32_16x16x32_bf16 v[168:171], a[168:171], a[64:67], v[168:171]
    s_waitcnt lgkmcnt(8)
    ds_read_b64_tr_b16 a[160:161], v12 offset:16384
    v_mfma_f32_16x16x32_bf16 v[168:171], a[172:175], a[72:75], v[168:171]
    ds_read_b64_tr_b16 a[162:163], v12 offset:20480
    v_mfma_f32_16x16x32_bf16 v[172:175], a[168:171], a[68:71], v[172:175]
    ds_read_b64_tr_b16 a[164:165], v12 offset:24576
    v_mfma_f32_16x16x32_bf16 v[172:175], a[172:175], a[76:79], v[172:175]
    s_waitcnt lgkmcnt(9)
    ds_read_b64_tr_b16 a[166:167], v12 offset:28672
    buffer_atomic_add v65, v64, s[88:91], 0 offen sc1
    v_mfma_f32_16x16x32_bf16 v[176:179], a[176:179], a[64:67], v[176:179]
    s_waitcnt lgkmcnt(8)
    ds_read_b64_tr_b16 a[168:169], v13 offset:16384
    v_mfma_f32_16x16x32_bf16 v[176:179], a[180:183], a[72:75], v[176:179]
    ds_read_b64_tr_b16 a[170:171], v13 offset:20480
    v_mfma_f32_16x16x32_bf16 v[180:183], a[176:179], a[68:71], v[180:183]
    ds_read_b64_tr_b16 a[172:173], v13 offset:24576
    v_mfma_f32_16x16x32_bf16 v[180:183], a[180:183], a[76:79], v[180:183]
    s_waitcnt lgkmcnt(9)
    ds_read_b64_tr_b16 a[174:175], v13 offset:28672
    v_mfma_f32_16x16x32_bf16 v[184:187], a[184:187], a[64:67], v[184:187]
    s_waitcnt lgkmcnt(8)
    ds_read_b64_tr_b16 a[176:177], v14 offset:16384
    v_mfma_f32_16x16x32_bf16 v[184:187], a[188:191], a[72:75], v[184:187]
    ds_read_b64_tr_b16 a[178:179], v14 offset:20480
    v_mfma_f32_16x16x32_bf16 v[188:191], a[184:187], a[68:71], v[188:191]
    ds_read_b64_tr_b16 a[180:181], v14 offset:24576
    v_mfma_f32_16x16x32_bf16 v[188:191], a[188:191], a[76:79], v[188:191]
    s_waitcnt lgkmcnt(9)
    ds_read_b64_tr_b16 a[182:183], v14 offset:28672
    v_mfma_f32_16x16x32_bf16 v[192:195], a[160:163], a[64:67], v[192:195]
    s_waitcnt lgkmcnt(8)
    ds_read_b64_tr_b16 a[184:185], v15 offset:16384
    v_mfma_f32_16x16x32_bf16 v[192:195], a[164:167], a[72:75], v[192:195]
    ds_read_b64_tr_b16 a[186:187], v15 offset:20480
    v_mfma_f32_16x16x32_bf16 v[196:199], a[160:163], a[68:71], v[196:199]
    ds_read_b64_tr_b16 a[188:189], v15 offset:24576
    v_mfma_f32_16x16x32_bf16 v[196:199], a[164:167], a[76:79], v[196:199]
    s_waitcnt lgkmcnt(9)
    ds_read_b64_tr_b16 a[190:191], v15 offset:28672
    v_mfma_f32_16x16x32_bf16 v[200:203], a[168:171], a[64:67], v[200:203]
    s_waitcnt lgkmcnt(8)
    ds_read_b64_tr_b16 a[160:161], v16 offset:16384
    v_mfma_f32_16x16x32_bf16 v[200:203], a[172:175], a[72:75], v[200:203]
    ds_read_b64_tr_b16 a[162:163], v16 offset:20480
    v_mfma_f32_16x16x32_bf16 v[204:207], a[168:171], a[68:71], v[204:207]
    ds_read_b64_tr_b16 a[164:165], v16 offset:24576
    v_mfma_f32_16x16x32_bf16 v[204:207], a[172:175], a[76:79], v[204:207]
    s_waitcnt lgkmcnt(9)
    ds_read_b64_tr_b16 a[166:167], v16 offset:28672
    v_mfma_f32_16x16x32_bf16 v[208:211], a[176:179], a[64:67], v[208:211]
    s_waitcnt lgkmcnt(8)
    ds_read_b64_tr_b16 a[168:169], v17 offset:16384
    v_mfma_f32_16x16x32_bf16 v[208:211], a[180:183], a[72:75], v[208:211]
    ds_read_b64_tr_b16 a[170:171], v17 offset:20480
    v_mfma_f32_16x16x32_bf16 v[212:215], a[176:179], a[68:71], v[212:215]
    ds_read_b64_tr_b16 a[172:173], v17 offset:24576
    v_mfma_f32_16x16x32_bf16 v[212:215], a[180:183], a[76:79], v[212:215]
    s_waitcnt lgkmcnt(9)
    ds_read_b64_tr_b16 a[174:175], v17 offset:28672
    v_mfma_f32_16x16x32_bf16 v[216:219], a[184:187], a[64:67], v[216:219]
    s_waitcnt lgkmcnt(8)
    ds_read_b64_tr_b16 a[176:177], v18 offset:16384
    v_mfma_f32_16x16x32_bf16 v[216:219], a[188:191], a[72:75], v[216:219]
    ds_read_b64_tr_b16 a[178:179], v18 offset:20480
    v_mfma_f32_16x16x32_bf16 v[220:223], a[184:187], a[68:71], v[220:223]
    ds_read_b64_tr_b16 a[180:181], v18 offset:24576
    v_mfma_f32_16x16x32_bf16 v[220:223], a[188:191], a[76:79], v[220:223]
    s_waitcnt lgkmcnt(9)
    ds_read_b64_tr_b16 a[182:183], v18 offset:28672
    v_mfma_f32_16x16x32_bf16 v[224:227], a[160:163], a[64:67], v[224:227]
    s_waitcnt lgkmcnt(8)
    ds_read_b64_tr_b16 a[184:185], v19 offset:16384
    v_mfma_f32_16x16x32_bf16 v[224:227], a[164:167], a[72:75], v[224:227]
    ds_read_b64_tr_b16 a[186:187], v19 offset:20480
    v_mfma_f32_16x16x32_bf16 v[228:231], a[160:163], a[68:71], v[228:231]
    ds_read_b64_tr_b16 a[188:189], v19 offset:24576
    v_mfma_f32_16x16x32_bf16 v[228:231], a[164:167], a[76:79], v[228:231]
    s_waitcnt lgkmcnt(9)
    ds_read_b64_tr_b16 a[190:191], v19 offset:28672
    s_waitcnt vmcnt(21)
    s_barrier
    v_mfma_f32_16x16x32_bf16 v[232:235], a[168:171], a[64:67], v[232:235]
    s_waitcnt lgkmcnt(8)
    ds_read_b64_tr_b16 a[160:161], v12 offset:32768
    v_mfma_f32_16x16x32_bf16 v[232:235], a[172:175], a[72:75], v[232:235]
    s_add_u32 s49, s44, 4194304
    ds_read_b64_tr_b16 a[162:163], v12 offset:36864
    v_mfma_f32_16x16x32_bf16 v[236:239], a[168:171], a[68:71], v[236:239]
    s_add_u32 m0, s42, 131072
    ds_read_b64_tr_b16 a[164:165], v12 offset:40960
    v_mfma_f32_16x16x32_bf16 v[236:239], a[172:175], a[76:79], v[236:239]
    s_waitcnt lgkmcnt(9)
    ds_read_b64_tr_b16 a[166:167], v12 offset:45056
    buffer_load_dwordx4 v42, s[16:19], s49 offen lds
    v_mfma_f32_16x16x32_bf16 v[240:243], a[176:179], a[64:67], v[240:243]
    s_waitcnt lgkmcnt(8)
    ds_read_b64_tr_b16 a[168:169], v13 offset:32768
    v_mfma_f32_16x16x32_bf16 v[240:243], a[180:183], a[72:75], v[240:243]
    ds_read_b64_tr_b16 a[170:171], v13 offset:36864
    v_mfma_f32_16x16x32_bf16 v[244:247], a[176:179], a[68:71], v[244:247]
    ds_read_b64_tr_b16 a[172:173], v13 offset:40960
    v_mfma_f32_16x16x32_bf16 v[244:247], a[180:183], a[76:79], v[244:247]
    s_waitcnt lgkmcnt(9)
    ds_read_b64_tr_b16 a[174:175], v13 offset:45056
    buffer_load_dwordx4 v43, s[16:19], s49 offen offset:1024 lds
    v_mfma_f32_16x16x32_bf16 v[248:251], a[184:187], a[64:67], v[248:251]
    s_waitcnt lgkmcnt(8)
    ds_read_b64_tr_b16 a[176:177], v14 offset:32768
    v_mfma_f32_16x16x32_bf16 v[248:251], a[188:191], a[72:75], v[248:251]
    ds_read_b64_tr_b16 a[178:179], v14 offset:36864
    v_mfma_f32_16x16x32_bf16 v[252:255], a[184:187], a[68:71], v[252:255]
    ds_read_b64_tr_b16 a[180:181], v14 offset:40960
    v_mfma_f32_16x16x32_bf16 v[252:255], a[188:191], a[76:79], v[252:255]
    s_waitcnt lgkmcnt(9)
    ds_read_b64_tr_b16 a[182:183], v14 offset:45056
    buffer_load_dwordx4 v44, s[16:19], s49 offen offset:2048 lds
    v_mfma_f32_16x16x32_bf16 v[128:131], a[160:163], a[80:83], v[128:131]
    s_waitcnt lgkmcnt(8)
    ds_read_b64_tr_b16 a[184:185], v15 offset:32768
    v_mfma_f32_16x16x32_bf16 v[128:131], a[164:167], a[88:91], v[128:131]
    ds_read_b64_tr_b16 a[186:187], v15 offset:36864
    v_mfma_f32_16x16x32_bf16 v[132:135], a[160:163], a[84:87], v[132:135]
    ds_read_b64_tr_b16 a[188:189], v15 offset:40960
    v_mfma_f32_16x16x32_bf16 v[132:135], a[164:167], a[92:95], v[132:135]
    s_waitcnt lgkmcnt(9)
    ds_read_b64_tr_b16 a[190:191], v15 offset:45056
    buffer_load_dwordx4 v45, s[16:19], s49 offen offset:3072 lds
    v_mfma_f32_16x16x32_bf16 v[136:139], a[168:171], a[80:83], v[136:139]
    s_waitcnt lgkmcnt(8)
    ds_read_b64_tr_b16 a[160:161], v16 offset:32768
    v_mfma_f32_16x16x32_bf16 v[136:139], a[172:175], a[88:91], v[136:139]
    s_add_u32 s49, s44, 4194560
    ds_read_b64_tr_b16 a[162:163], v16 offset:36864
    v_mfma_f32_16x16x32_bf16 v[140:143], a[168:171], a[84:87], v[140:143]
    s_add_u32 m0, s42, 147456
    ds_read_b64_tr_b16 a[164:165], v16 offset:40960
    v_mfma_f32_16x16x32_bf16 v[140:143], a[172:175], a[92:95], v[140:143]
    s_waitcnt lgkmcnt(9)
    ds_read_b64_tr_b16 a[166:167], v16 offset:45056
    buffer_load_dwordx4 v42, s[16:19], s49 offen lds
    v_mfma_f32_16x16x32_bf16 v[144:147], a[176:179], a[80:83], v[144:147]
    s_waitcnt lgkmcnt(8)
    ds_read_b64_tr_b16 a[168:169], v17 offset:32768
    v_mfma_f32_16x16x32_bf16 v[144:147], a[180:183], a[88:91], v[144:147]
    ds_read_b64_tr_b16 a[170:171], v17 offset:36864
    v_mfma_f32_16x16x32_bf16 v[148:151], a[176:179], a[84:87], v[148:151]
    ds_read_b64_tr_b16 a[172:173], v17 offset:40960
    v_mfma_f32_16x16x32_bf16 v[148:151], a[180:183], a[92:95], v[148:151]
    s_waitcnt lgkmcnt(9)
    ds_read_b64_tr_b16 a[174:175], v17 offset:45056
    buffer_load_dwordx4 v43, s[16:19], s49 offen offset:1024 lds
    v_mfma_f32_16x16x32_bf16 v[152:155], a[184:187], a[80:83], v[152:155]
    s_waitcnt lgkmcnt(8)
    ds_read_b64_tr_b16 a[176:177], v18 offset:32768
    v_mfma_f32_16x16x32_bf16 v[152:155], a[188:191], a[88:91], v[152:155]
    ds_read_b64_tr_b16 a[178:179], v18 offset:36864
    v_mfma_f32_16x16x32_bf16 v[156:159], a[184:187], a[84:87], v[156:159]
    ds_read_b64_tr_b16 a[180:181], v18 offset:40960
    v_mfma_f32_16x16x32_bf16 v[156:159], a[188:191], a[92:95], v[156:159]
    s_waitcnt lgkmcnt(9)
    ds_read_b64_tr_b16 a[182:183], v18 offset:45056
    buffer_load_dwordx4 v44, s[16:19], s49 offen offset:2048 lds
    v_mfma_f32_16x16x32_bf16 v[160:163], a[160:163], a[80:83], v[160:163]
    s_waitcnt lgkmcnt(8)
    ds_read_b64_tr_b16 a[184:185], v19 offset:32768
    v_mfma_f32_16x16x32_bf16 v[160:163], a[164:167], a[88:91], v[160:163]
    ds_read_b64_tr_b16 a[186:187], v19 offset:36864
    v_mfma_f32_16x16x32_bf16 v[164:167], a[160:163], a[84:87], v[164:167]
    ds_read_b64_tr_b16 a[188:189], v19 offset:40960
    v_mfma_f32_16x16x32_bf16 v[164:167], a[164:167], a[92:95], v[164:167]
    s_waitcnt lgkmcnt(9)
    ds_read_b64_tr_b16 a[190:191], v19 offset:45056
    buffer_load_dwordx4 v45, s[16:19], s49 offen offset:3072 lds
    v_mfma_f32_16x16x32_bf16 v[168:171], a[168:171], a[80:83], v[168:171]
    s_waitcnt lgkmcnt(8)
    ds_read_b64_tr_b16 a[160:161], v12 offset:49152
    v_mfma_f32_16x16x32_bf16 v[168:171], a[172:175], a[88:91], v[168:171]
    ds_read_b64_tr_b16 a[162:163], v12 offset:53248
    v_mfma_f32_16x16x32_bf16 v[172:175], a[168:171], a[84:87], v[172:175]
    ds_read_b64_tr_b16 a[164:165], v12 offset:57344
    v_mfma_f32_16x16x32_bf16 v[172:175], a[172:175], a[92:95], v[172:175]
    s_waitcnt lgkmcnt(9)
    ds_read_b64_tr_b16 a[166:167], v12 offset:61440
    v_mfma_f32_16x16x32_bf16 v[176:179], a[176:179], a[80:83], v[176:179]
    s_waitcnt lgkmcnt(8)
    ds_read_b64_tr_b16 a[168:169], v13 offset:49152
    v_mfma_f32_16x16x32_bf16 v[176:179], a[180:183], a[88:91], v[176:179]
    ds_read_b64_tr_b16 a[170:171], v13 offset:53248
    v_mfma_f32_16x16x32_bf16 v[180:183], a[176:179], a[84:87], v[180:183]
    ds_read_b64_tr_b16 a[172:173], v13 offset:57344
    v_mfma_f32_16x16x32_bf16 v[180:183], a[180:183], a[92:95], v[180:183]
    s_waitcnt lgkmcnt(9)
    ds_read_b64_tr_b16 a[174:175], v13 offset:61440
    v_mfma_f32_16x16x32_bf16 v[184:187], a[184:187], a[80:83], v[184:187]
    s_waitcnt lgkmcnt(8)
    ds_read_b64_tr_b16 a[176:177], v14 offset:49152
    v_mfma_f32_16x16x32_bf16 v[184:187], a[188:191], a[88:91], v[184:187]
    ds_read_b64_tr_b16 a[178:179], v14 offset:53248
    v_mfma_f32_16x16x32_bf16 v[188:191], a[184:187], a[84:87], v[188:191]
    ds_read_b64_tr_b16 a[180:181], v14 offset:57344
    v_mfma_f32_16x16x32_bf16 v[188:191], a[188:191], a[92:95], v[188:191]
    s_waitcnt lgkmcnt(9)
    ds_read_b64_tr_b16 a[182:183], v14 offset:61440
    v_mfma_f32_16x16x32_bf16 v[192:195], a[160:163], a[80:83], v[192:195]
    s_waitcnt lgkmcnt(8)
    ds_read_b64_tr_b16 a[184:185], v15 offset:49152
    v_mfma_f32_16x16x32_bf16 v[192:195], a[164:167], a[88:91], v[192:195]
    ds_read_b64_tr_b16 a[186:187], v15 offset:53248
    v_mfma_f32_16x16x32_bf16 v[196:199], a[160:163], a[84:87], v[196:199]
    ds_read_b64_tr_b16 a[188:189], v15 offset:57344
    v_mfma_f32_16x16x32_bf16 v[196:199], a[164:167], a[92:95], v[196:199]
    s_waitcnt lgkmcnt(9)
    ds_read_b64_tr_b16 a[190:191], v15 offset:61440
    v_mfma_f32_16x16x32_bf16 v[200:203], a[168:171], a[80:83], v[200:203]
    s_waitcnt lgkmcnt(8)
    ds_read_b64_tr_b16 a[160:161], v16 offset:49152
    v_mfma_f32_16x16x32_bf16 v[200:203], a[172:175], a[88:91], v[200:203]
    ds_read_b64_tr_b16 a[162:163], v16 offset:53248
    v_mfma_f32_16x16x32_bf16 v[204:207], a[168:171], a[84:87], v[204:207]
    ds_read_b64_tr_b16 a[164:165], v16 offset:57344
    v_mfma_f32_16x16x32_bf16 v[204:207], a[172:175], a[92:95], v[204:207]
    s_waitcnt lgkmcnt(9)
    ds_read_b64_tr_b16 a[166:167], v16 offset:61440
    v_mfma_f32_16x16x32_bf16 v[208:211], a[176:179], a[80:83], v[208:211]
    s_waitcnt lgkmcnt(8)
    ds_read_b64_tr_b16 a[168:169], v17 offset:49152
    v_mfma_f32_16x16x32_bf16 v[208:211], a[180:183], a[88:91], v[208:211]
    ds_read_b64_tr_b16 a[170:171], v17 offset:53248
    v_mfma_f32_16x16x32_bf16 v[212:215], a[176:179], a[84:87], v[212:215]
    ds_read_b64_tr_b16 a[172:173], v17 offset:57344
    v_mfma_f32_16x16x32_bf16 v[212:215], a[180:183], a[92:95], v[212:215]
    s_waitcnt lgkmcnt(9)
    ds_read_b64_tr_b16 a[174:175], v17 offset:61440
    v_mfma_f32_16x16x32_bf16 v[216:219], a[184:187], a[80:83], v[216:219]
    s_waitcnt lgkmcnt(8)
    ds_read_b64_tr_b16 a[176:177], v18 offset:49152
    v_mfma_f32_16x16x32_bf16 v[216:219], a[188:191], a[88:91], v[216:219]
    ds_read_b64_tr_b16 a[178:179], v18 offset:53248
    v_mfma_f32_16x16x32_bf16 v[220:223], a[184:187], a[84:87], v[220:223]
    ds_read_b64_tr_b16 a[180:181], v18 offset:57344
    v_mfma_f32_16x16x32_bf16 v[220:223], a[188:191], a[92:95], v[220:223]
    s_waitcnt lgkmcnt(9)
    ds_read_b64_tr_b16 a[182:183], v18 offset:61440
    v_mfma_f32_16x16x32_bf16 v[224:227], a[160:163], a[80:83], v[224:227]
    s_waitcnt lgkmcnt(8)
    ds_read_b64_tr_b16 a[184:185], v19 offset:49152
    v_mfma_f32_16x16x32_bf16 v[224:227], a[164:167], a[88:91], v[224:227]
    ds_read_b64_tr_b16 a[186:187], v19 offset:53248
    v_mfma_f32_16x16x32_bf16 v[228:231], a[160:163], a[84:87], v[228:231]
    ds_read_b64_tr_b16 a[188:189], v19 offset:57344
    v_mfma_f32_16x16x32_bf16 v[228:231], a[164:167], a[92:95], v[228:231]
    s_waitcnt lgkmcnt(9)
    ds_read_b64_tr_b16 a[190:191], v19 offset:61440
    s_waitcnt vmcnt(17)
    s_barrier
    v_mfma_f32_16x16x32_bf16 v[232:235], a[168:171], a[80:83], v[232:235]
    s_waitcnt lgkmcnt(8)
    ds_read_b64_tr_b16 a[160:161], v20 offset:0
    v_mfma_f32_16x16x32_bf16 v[232:235], a[172:175], a[88:91], v[232:235]
    ds_read_b64_tr_b16 a[162:163], v20 offset:4096
    v_mfma_f32_16x16x32_bf16 v[236:239], a[168:171], a[84:87], v[236:239]
    s_add_u32 m0, s42, 0
    ds_read_b64_tr_b16 a[164:165], v20 offset:8192
    v_mfma_f32_16x16x32_bf16 v[236:239], a[172:175], a[92:95], v[236:239]
    s_waitcnt lgkmcnt(9)
    ds_read_b64_tr_b16 a[166:167], v20 offset:12288
    buffer_load_dwordx4 v36, s[8:11], s40 offen lds
    v_mfma_f32_16x16x32_bf16 v[240:243], a[176:179], a[80:83], v[240:243]
    s_waitcnt lgkmcnt(8)
    ds_read_b64_tr_b16 a[168:169], v21 offset:0
    v_mfma_f32_16x16x32_bf16 v[240:243], a[180:183], a[88:91], v[240:243]
    ds_read_b64_tr_b16 a[170:171], v21 offset:4096
    v_mfma_f32_16x16x32_bf16 v[244:247], a[176:179], a[84:87], v[244:247]
    ds_read_b64_tr_b16 a[172:173], v21 offset:8192
    v_mfma_f32_16x16x32_bf16 v[244:247], a[180:183], a[92:95], v[244:247]
    s_waitcnt lgkmcnt(9)
    ds_read_b64_tr_b16 a[174:175], v21 offset:12288
    buffer_load_dwordx4 v37, s[8:11], s40 offen offset:1024 lds
    v_mfma_f32_16x16x32_bf16 v[248:251], a[184:187], a[80:83], v[248:251]
    s_waitcnt lgkmcnt(8)
    ds_read_b64_tr_b16 a[176:177], v22 offset:0
    v_mfma_f32_16x16x32_bf16 v[248:251], a[188:191], a[88:91], v[248:251]
    ds_read_b64_tr_b16 a[178:179], v22 offset:4096
    v_mfma_f32_16x16x32_bf16 v[252:255], a[184:187], a[84:87], v[252:255]
    ds_read_b64_tr_b16 a[180:181], v22 offset:8192
    v_mfma_f32_16x16x32_bf16 v[252:255], a[188:191], a[92:95], v[252:255]
    s_waitcnt lgkmcnt(9)
    ds_read_b64_tr_b16 a[182:183], v22 offset:12288
    buffer_load_dwordx4 v38, s[8:11], s40 offen offset:2048 lds
    v_mfma_f32_16x16x32_bf16 v[128:131], a[160:163], a[96:99], v[128:131]
    s_waitcnt lgkmcnt(8)
    ds_read_b64_tr_b16 a[184:185], v23 offset:0
    v_mfma_f32_16x16x32_bf16 v[128:131], a[164:167], a[104:107], v[128:131]
    ds_read_b64_tr_b16 a[186:187], v23 offset:4096
    v_mfma_f32_16x16x32_bf16 v[132:135], a[160:163], a[100:103], v[132:135]
    ds_read_b64_tr_b16 a[188:189], v23 offset:8192
    v_mfma_f32_16x16x32_bf16 v[132:135], a[164:167], a[108:111], v[132:135]
    s_waitcnt lgkmcnt(9)
    ds_read_b64_tr_b16 a[190:191], v23 offset:12288
    buffer_load_dwordx4 v39, s[8:11], s40 offen offset:3072 lds
    v_mfma_f32_16x16x32_bf16 v[136:139], a[168:171], a[96:99], v[136:139]
    s_waitcnt lgkmcnt(8)
    s_add_u32 s40, s40, 16384
    ds_read_b64_tr_b16 a[160:161], v24 offset:0
    v_mfma_f32_16x16x32_bf16 v[136:139], a[172:175], a[104:107], v[136:139]
    ds_read_b64_tr_b16 a[162:163], v24 offset:4096
    v_mfma_f32_16x16x32_bf16 v[140:143], a[168:171], a[100:103], v[140:143]
    s_add_u32 m0, s42, 16384
    ds_read_b64_tr_b16 a[164:165], v24 offset:8192
    v_mfma_f32_16x16x32_bf16 v[140:143], a[172:175], a[108:111], v[140:143]
    s_waitcnt lgkmcnt(9)
    ds_read_b64_tr_b16 a[166:167], v24 offset:12288
    buffer_load_dwordx4 v36, s[8:11], s40 offen lds
    v_mfma_f32_16x16x32_bf16 v[144:147], a[176:179], a[96:99], v[144:147]
    s_waitcnt lgkmcnt(8)
    ds_read_b64_tr_b16 a[168:169], v25 offset:0
    v_mfma_f32_16x16x32_bf16 v[144:147], a[180:183], a[104:107], v[144:147]
    ds_read_b64_tr_b16 a[170:171], v25 offset:4096
    v_mfma_f32_16x16x32_bf16 v[148:151], a[176:179], a[100:103], v[148:151]
    ds_read_b64_tr_b16 a[172:173], v25 offset:8192
    v_mfma_f32_16x16x32_bf16 v[148:151], a[180:183], a[108:111], v[148:151]
    s_waitcnt lgkmcnt(9)
    ds_read_b64_tr_b16 a[174:175], v25 offset:12288
    buffer_load_dwordx4 v37, s[8:11], s40 offen offset:1024 lds
    v_mfma_f32_16x16x32_bf16 v[152:155], a[184:187], a[96:99], v[152:155]
    s_waitcnt lgkmcnt(8)
    ds_read_b64_tr_b16 a[176:177], v26 offset:0
    v_mfma_f32_16x16x32_bf16 v[152:155], a[188:191], a[104:107], v[152:155]
    ds_read_b64_tr_b16 a[178:179], v26 offset:4096
    v_mfma_f32_16x16x32_bf16 v[156:159], a[184:187], a[100:103], v[156:159]
    ds_read_b64_tr_b16 a[180:181], v26 offset:8192
    v_mfma_f32_16x16x32_bf16 v[156:159], a[188:191], a[108:111], v[156:159]
    s_waitcnt lgkmcnt(9)
    ds_read_b64_tr_b16 a[182:183], v26 offset:12288
    buffer_load_dwordx4 v38, s[8:11], s40 offen offset:2048 lds
    v_mfma_f32_16x16x32_bf16 v[160:163], a[160:163], a[96:99], v[160:163]
    s_waitcnt lgkmcnt(8)
    ds_read_b64_tr_b16 a[184:185], v27 offset:0
    v_mfma_f32_16x16x32_bf16 v[160:163], a[164:167], a[104:107], v[160:163]
    ds_read_b64_tr_b16 a[186:187], v27 offset:4096
    v_mfma_f32_16x16x32_bf16 v[164:167], a[160:163], a[100:103], v[164:167]
    ds_read_b64_tr_b16 a[188:189], v27 offset:8192
    v_mfma_f32_16x16x32_bf16 v[164:167], a[164:167], a[108:111], v[164:167]
    s_waitcnt lgkmcnt(9)
    ds_read_b64_tr_b16 a[190:191], v27 offset:12288
    buffer_load_dwordx4 v39, s[8:11], s40 offen offset:3072 lds
    v_mfma_f32_16x16x32_bf16 v[168:171], a[168:171], a[96:99], v[168:171]
    s_waitcnt lgkmcnt(8)
    s_add_u32 s40, s40, 16384
    ds_read_b64_tr_b16 a[160:161], v20 offset:16384
    v_mfma_f32_16x16x32_bf16 v[168:171], a[172:175], a[104:107], v[168:171]
    ds_read_b64_tr_b16 a[162:163], v20 offset:20480
    v_mfma_f32_16x16x32_bf16 v[172:175], a[168:171], a[100:103], v[172:175]
    ds_read_b64_tr_b16 a[164:165], v20 offset:24576
    v_mfma_f32_16x16x32_bf16 v[172:175], a[172:175], a[108:111], v[172:175]
    s_waitcnt lgkmcnt(9)
    ds_read_b64_tr_b16 a[166:167], v20 offset:28672
    v_mfma_f32_16x16x32_bf16 v[176:179], a[176:179], a[96:99], v[176:179]
    s_waitcnt lgkmcnt(8)
    ds_read_b64_tr_b16 a[168:169], v21 offset:16384
    v_mfma_f32_16x16x32_bf16 v[176:179], a[180:183], a[104:107], v[176:179]
    ds_read_b64_tr_b16 a[170:171], v21 offset:20480
    v_mfma_f32_16x16x32_bf16 v[180:183], a[176:179], a[100:103], v[180:183]
    ds_read_b64_tr_b16 a[172:173], v21 offset:24576
    v_mfma_f32_16x16x32_bf16 v[180:183], a[180:183], a[108:111], v[180:183]
    s_waitcnt lgkmcnt(9)
    ds_read_b64_tr_b16 a[174:175], v21 offset:28672
    v_mfma_f32_16x16x32_bf16 v[184:187], a[184:187], a[96:99], v[184:187]
    s_waitcnt lgkmcnt(8)
    ds_read_b64_tr_b16 a[176:177], v22 offset:16384
    v_mfma_f32_16x16x32_bf16 v[184:187], a[188:191], a[104:107], v[184:187]
    ds_read_b64_tr_b16 a[178:179], v22 offset:20480
    v_mfma_f32_16x16x32_bf16 v[188:191], a[184:187], a[100:103], v[188:191]
    ds_read_b64_tr_b16 a[180:181], v22 offset:24576
    v_mfma_f32_16x16x32_bf16 v[188:191], a[188:191], a[108:111], v[188:191]
    s_waitcnt lgkmcnt(9)
    ds_read_b64_tr_b16 a[182:183], v22 offset:28672
    v_mfma_f32_16x16x32_bf16 v[192:195], a[160:163], a[96:99], v[192:195]
    s_waitcnt lgkmcnt(8)
    ds_read_b64_tr_b16 a[184:185], v23 offset:16384
    v_accvgpr_write_b32 a0, 0
    v_mfma_f32_16x16x32_bf16 v[192:195], a[164:167], a[104:107], v[192:195]
    ds_read_b64_tr_b16 a[186:187], v23 offset:20480
    v_accvgpr_write_b32 a1, 0
    v_mfma_f32_16x16x32_bf16 v[196:199], a[160:163], a[100:103], v[196:199]
    ds_read_b64_tr_b16 a[188:189], v23 offset:24576
    v_accvgpr_write_b32 a2, 0
    v_mfma_f32_16x16x32_bf16 v[196:199], a[164:167], a[108:111], v[196:199]
    s_waitcnt lgkmcnt(9)
    ds_read_b64_tr_b16 a[190:191], v23 offset:28672
    v_accvgpr_write_b32 a3, 0
    v_mfma_f32_16x16x32_bf16 v[200:203], a[168:171], a[96:99], v[200:203]
    s_waitcnt lgkmcnt(8)
    ds_read_b64_tr_b16 a[160:161], v24 offset:16384
    v_accvgpr_write_b32 a4, 0
    v_mfma_f32_16x16x32_bf16 v[200:203], a[172:175], a[104:107], v[200:203]
    ds_read_b64_tr_b16 a[162:163], v24 offset:20480
    v_accvgpr_write_b32 a5, 0
    v_mfma_f32_16x16x32_bf16 v[204:207], a[168:171], a[100:103], v[204:207]
    ds_read_b64_tr_b16 a[164:165], v24 offset:24576
    v_accvgpr_write_b32 a6, 0
    v_mfma_f32_16x16x32_bf16 v[204:207], a[172:175], a[108:111], v[204:207]
    s_waitcnt lgkmcnt(9)
    ds_read_b64_tr_b16 a[166:167], v24 offset:28672
    v_accvgpr_write_b32 a7, 0
    v_mfma_f32_16x16x32_bf16 v[208:211], a[176:179], a[96:99], v[208:211]
    s_waitcnt lgkmcnt(8)
    ds_read_b64_tr_b16 a[168:169], v25 offset:16384
    v_accvgpr_write_b32 a8, 0
    v_mfma_f32_16x16x32_bf16 v[208:211], a[180:183], a[104:107], v[208:211]
    ds_read_b64_tr_b16 a[170:171], v25 offset:20480
    v_accvgpr_write_b32 a9, 0
    v_mfma_f32_16x16x32_bf16 v[212:215], a[176:179], a[100:103], v[212:215]
    ds_read_b64_tr_b16 a[172:173], v25 offset:24576
    v_accvgpr_write_b32 a10, 0
    v_mfma_f32_16x16x32_bf16 v[212:215], a[180:183], a[108:111], v[212:215]
    s_waitcnt lgkmcnt(9)
    ds_read_b64_tr_b16 a[174:175], v25 offset:28672
    v_accvgpr_write_b32 a11, 0
    v_mfma_f32_16x16x32_bf16 v[216:219], a[184:187], a[96:99], v[216:219]
    s_waitcnt lgkmcnt(8)
    ds_read_b64_tr_b16 a[176:177], v26 offset:16384
    v_accvgpr_write_b32 a12, 0
    v_mfma_f32_16x16x32_bf16 v[216:219], a[188:191], a[104:107], v[216:219]
    ds_read_b64_tr_b16 a[178:179], v26 offset:20480
    v_accvgpr_write_b32 a13, 0
    v_mfma_f32_16x16x32_bf16 v[220:223], a[184:187], a[100:103], v[220:223]
    ds_read_b64_tr_b16 a[180:181], v26 offset:24576
    v_accvgpr_write_b32 a14, 0
    v_mfma_f32_16x16x32_bf16 v[220:223], a[188:191], a[108:111], v[220:223]
    s_waitcnt lgkmcnt(9)
    ds_read_b64_tr_b16 a[182:183], v26 offset:28672
    v_accvgpr_write_b32 a15, 0
    v_mfma_f32_16x16x32_bf16 v[224:227], a[160:163], a[96:99], v[224:227]
    s_waitcnt lgkmcnt(8)
    ds_read_b64_tr_b16 a[184:185], v27 offset:16384
    v_accvgpr_write_b32 a16, 0
    v_mfma_f32_16x16x32_bf16 v[224:227], a[164:167], a[104:107], v[224:227]
    ds_read_b64_tr_b16 a[186:187], v27 offset:20480
    v_accvgpr_write_b32 a17, 0
    v_mfma_f32_16x16x32_bf16 v[228:231], a[160:163], a[100:103], v[228:231]
    ds_read_b64_tr_b16 a[188:189], v27 offset:24576
    v_accvgpr_write_b32 a18, 0
    v_mfma_f32_16x16x32_bf16 v[228:231], a[164:167], a[108:111], v[228:231]
    s_waitcnt lgkmcnt(9)
    ds_read_b64_tr_b16 a[190:191], v27 offset:28672
    v_accvgpr_write_b32 a19, 0
    s_waitcnt vmcnt(17)
    s_barrier
    v_mfma_f32_16x16x32_bf16 v[232:235], a[168:171], a[96:99], v[232:235]
    s_waitcnt lgkmcnt(8)
    ds_read_b64_tr_b16 a[160:161], v20 offset:32768
    v_accvgpr_write_b32 a20, 0
    v_mfma_f32_16x16x32_bf16 v[232:235], a[172:175], a[104:107], v[232:235]
    ds_read_b64_tr_b16 a[162:163], v20 offset:36864
    v_accvgpr_write_b32 a21, 0
    v_mfma_f32_16x16x32_bf16 v[236:239], a[168:171], a[100:103], v[236:239]
    s_add_u32 m0, s42, 32768
    ds_read_b64_tr_b16 a[164:165], v20 offset:40960
    v_accvgpr_write_b32 a22, 0
    v_mfma_f32_16x16x32_bf16 v[236:239], a[172:175], a[108:111], v[236:239]
    s_waitcnt lgkmcnt(9)
    ds_read_b64_tr_b16 a[166:167], v20 offset:45056
    buffer_load_dwordx4 v36, s[8:11], s40 offen lds
    v_mfma_f32_16x16x32_bf16 v[240:243], a[176:179], a[96:99], v[240:243]
    s_waitcnt lgkmcnt(8)
    ds_read_b64_tr_b16 a[168:169], v21 offset:32768
    v_accvgpr_write_b32 a23, 0
    v_mfma_f32_16x16x32_bf16 v[240:243], a[180:183], a[104:107], v[240:243]
    ds_read_b64_tr_b16 a[170:171], v21 offset:36864
    v_accvgpr_write_b32 a24, 0
    v_mfma_f32_16x16x32_bf16 v[244:247], a[176:179], a[100:103], v[244:247]
    ds_read_b64_tr_b16 a[172:173], v21 offset:40960
    v_accvgpr_write_b32 a25, 0
    v_mfma_f32_16x16x32_bf16 v[244:247], a[180:183], a[108:111], v[244:247]
    s_waitcnt lgkmcnt(9)
    ds_read_b64_tr_b16 a[174:175], v21 offset:45056
    buffer_load_dwordx4 v37, s[8:11], s40 offen offset:1024 lds
    v_mfma_f32_16x16x32_bf16 v[248:251], a[184:187], a[96:99], v[248:251]
    s_waitcnt lgkmcnt(8)
    ds_read_b64_tr_b16 a[176:177], v22 offset:32768
    v_accvgpr_write_b32 a26, 0
    v_mfma_f32_16x16x32_bf16 v[248:251], a[188:191], a[104:107], v[248:251]
    ds_read_b64_tr_b16 a[178:179], v22 offset:36864
    v_accvgpr_write_b32 a27, 0
    v_mfma_f32_16x16x32_bf16 v[252:255], a[184:187], a[100:103], v[252:255]
    ds_read_b64_tr_b16 a[180:181], v22 offset:40960
    v_accvgpr_write_b32 a28, 0
    v_mfma_f32_16x16x32_bf16 v[252:255], a[188:191], a[108:111], v[252:255]
    s_waitcnt lgkmcnt(9)
    ds_read_b64_tr_b16 a[182:183], v22 offset:45056
    buffer_load_dwordx4 v38, s[8:11], s40 offen offset:2048 lds
    v_mfma_f32_16x16x32_bf16 v[128:131], a[160:163], a[112:115], v[128:131]
    s_waitcnt lgkmcnt(8)
    ds_read_b64_tr_b16 a[184:185], v23 offset:32768
    v_accvgpr_write_b32 a29, 0
    v_mfma_f32_16x16x32_bf16 v[128:131], a[164:167], a[120:123], v[128:131]
    ds_read_b64_tr_b16 a[186:187], v23 offset:36864
    v_accvgpr_write_b32 a30, 0
    v_mfma_f32_16x16x32_bf16 v[132:135], a[160:163], a[116:119], v[132:135]
    ds_read_b64_tr_b16 a[188:189], v23 offset:40960
    v_accvgpr_write_b32 a31, 0
    v_mfma_f32_16x16x32_bf16 v[132:135], a[164:167], a[124:127], v[132:135]
    s_waitcnt lgkmcnt(9)
    ds_read_b64_tr_b16 a[190:191], v23 offset:45056
    buffer_load_dwordx4 v39, s[8:11], s40 offen offset:3072 lds
    v_mfma_f32_16x16x32_bf16 v[136:139], a[168:171], a[112:115], v[136:139]
    s_waitcnt lgkmcnt(8)
    s_add_u32 s40, s40, 16384
    ds_read_b64_tr_b16 a[160:161], v24 offset:32768
    v_accvgpr_write_b32 a32, 0
    v_mfma_f32_16x16x32_bf16 v[136:139], a[172:175], a[120:123], v[136:139]
    ds_read_b64_tr_b16 a[162:163], v24 offset:36864
    v_accvgpr_write_b32 a33, 0
    v_mfma_f32_16x16x32_bf16 v[140:143], a[168:171], a[116:119], v[140:143]
    ds_read_b64_tr_b16 a[164:165], v24 offset:40960
    v_accvgpr_write_b32 a34, 0
    v_mfma_f32_16x16x32_bf16 v[140:143], a[172:175], a[124:127], v[140:143]
    s_waitcnt lgkmcnt(9)
    ds_read_b64_tr_b16 a[166:167], v24 offset:45056
    v_accvgpr_write_b32 a35, 0
    v_mfma_f32_16x16x32_bf16 v[144:147], a[176:179], a[112:115], v[144:147]
    s_waitcnt lgkmcnt(8)
    ds_read_b64_tr_b16 a[168:169], v25 offset:32768
    v_accvgpr_write_b32 a36, 0
    v_mfma_f32_16x16x32_bf16 v[144:147], a[180:183], a[120:123], v[144:147]
    ds_read_b64_tr_b16 a[170:171], v25 offset:36864
    v_accvgpr_write_b32 a37, 0
    v_mfma_f32_16x16x32_bf16 v[148:151], a[176:179], a[116:119], v[148:151]
    ds_read_b64_tr_b16 a[172:173], v25 offset:40960
    v_accvgpr_write_b32 a38, 0
    v_mfma_f32_16x16x32_bf16 v[148:151], a[180:183], a[124:127], v[148:151]
    s_waitcnt lgkmcnt(9)
    ds_read_b64_tr_b16 a[174:175], v25 offset:45056
    v_accvgpr_write_b32 a39, 0
    v_mfma_f32_16x16x32_bf16 v[152:155], a[184:187], a[112:115], v[152:155]
    s_waitcnt lgkmcnt(8)
    ds_read_b64_tr_b16 a[176:177], v26 offset:32768
    v_accvgpr_write_b32 a40, 0
    v_mfma_f32_16x16x32_bf16 v[152:155], a[188:191], a[120:123], v[152:155]
    ds_read_b64_tr_b16 a[178:179], v26 offset:36864
    v_accvgpr_write_b32 a41, 0
    v_mfma_f32_16x16x32_bf16 v[156:159], a[184:187], a[116:119], v[156:159]
    ds_read_b64_tr_b16 a[180:181], v26 offset:40960
    v_accvgpr_write_b32 a42, 0
    v_mfma_f32_16x16x32_bf16 v[156:159], a[188:191], a[124:127], v[156:159]
    s_waitcnt lgkmcnt(9)
    ds_read_b64_tr_b16 a[182:183], v26 offset:45056
    v_accvgpr_write_b32 a43, 0
    v_mfma_f32_16x16x32_bf16 v[160:163], a[160:163], a[112:115], v[160:163]
    s_waitcnt lgkmcnt(8)
    ds_read_b64_tr_b16 a[184:185], v27 offset:32768
    v_accvgpr_write_b32 a44, 0
    v_mfma_f32_16x16x32_bf16 v[160:163], a[164:167], a[120:123], v[160:163]
    ds_read_b64_tr_b16 a[186:187], v27 offset:36864
    v_accvgpr_write_b32 a45, 0
    v_mfma_f32_16x16x32_bf16 v[164:167], a[160:163], a[116:119], v[164:167]
    ds_read_b64_tr_b16 a[188:189], v27 offset:40960
    v_accvgpr_write_b32 a46, 0
    v_mfma_f32_16x16x32_bf16 v[164:167], a[164:167], a[124:127], v[164:167]
    s_waitcnt lgkmcnt(9)
    ds_read_b64_tr_b16 a[190:191], v27 offset:45056
    v_accvgpr_write_b32 a47, 0
    v_mfma_f32_16x16x32_bf16 v[168:171], a[168:171], a[112:115], v[168:171]
    s_waitcnt lgkmcnt(8)
    ds_read_b64_tr_b16 a[160:161], v20 offset:49152
    v_accvgpr_write_b32 a48, 0
    v_mfma_f32_16x16x32_bf16 v[168:171], a[172:175], a[120:123], v[168:171]
    ds_read_b64_tr_b16 a[162:163], v20 offset:53248
    v_accvgpr_write_b32 a49, 0
    v_mfma_f32_16x16x32_bf16 v[172:175], a[168:171], a[116:119], v[172:175]
    ds_read_b64_tr_b16 a[164:165], v20 offset:57344
    v_accvgpr_write_b32 a50, 0
    v_mfma_f32_16x16x32_bf16 v[172:175], a[172:175], a[124:127], v[172:175]
    s_waitcnt lgkmcnt(9)
    ds_read_b64_tr_b16 a[166:167], v20 offset:61440
    v_accvgpr_write_b32 a51, 0
    v_mfma_f32_16x16x32_bf16 v[176:179], a[176:179], a[112:115], v[176:179]
    s_waitcnt lgkmcnt(8)
    ds_read_b64_tr_b16 a[168:169], v21 offset:49152
    v_accvgpr_write_b32 a52, 0
    v_mfma_f32_16x16x32_bf16 v[176:179], a[180:183], a[120:123], v[176:179]
    ds_read_b64_tr_b16 a[170:171], v21 offset:53248
    v_accvgpr_write_b32 a53, 0
    v_mfma_f32_16x16x32_bf16 v[180:183], a[176:179], a[116:119], v[180:183]
    ds_read_b64_tr_b16 a[172:173], v21 offset:57344
    v_accvgpr_write_b32 a54, 0
    v_mfma_f32_16x16x32_bf16 v[180:183], a[180:183], a[124:127], v[180:183]
    s_waitcnt lgkmcnt(9)
    ds_read_b64_tr_b16 a[174:175], v21 offset:61440
    v_accvgpr_write_b32 a55, 0
    v_mfma_f32_16x16x32_bf16 v[184:187], a[184:187], a[112:115], v[184:187]
    s_waitcnt lgkmcnt(8)
    ds_read_b64_tr_b16 a[176:177], v22 offset:49152
    v_accvgpr_write_b32 a56, 0
    v_mfma_f32_16x16x32_bf16 v[184:187], a[188:191], a[120:123], v[184:187]
    ds_read_b64_tr_b16 a[178:179], v22 offset:53248
    v_accvgpr_write_b32 a57, 0
    v_mfma_f32_16x16x32_bf16 v[188:191], a[184:187], a[116:119], v[188:191]
    ds_read_b64_tr_b16 a[180:181], v22 offset:57344
    v_accvgpr_write_b32 a58, 0
    v_mfma_f32_16x16x32_bf16 v[188:191], a[188:191], a[124:127], v[188:191]
    s_waitcnt lgkmcnt(9)
    ds_read_b64_tr_b16 a[182:183], v22 offset:61440
    v_accvgpr_write_b32 a59, 0
    v_mfma_f32_16x16x32_bf16 v[192:195], a[160:163], a[112:115], v[192:195]
    s_waitcnt lgkmcnt(8)
    ds_read_b64_tr_b16 a[184:185], v23 offset:49152
    v_accvgpr_write_b32 a60, 0
    v_mfma_f32_16x16x32_bf16 v[192:195], a[164:167], a[120:123], v[192:195]
    ds_read_b64_tr_b16 a[186:187], v23 offset:53248
    v_accvgpr_write_b32 a61, 0
    v_mfma_f32_16x16x32_bf16 v[196:199], a[160:163], a[116:119], v[196:199]
    ds_read_b64_tr_b16 a[188:189], v23 offset:57344
    v_accvgpr_write_b32 a62, 0
    v_mfma_f32_16x16x32_bf16 v[196:199], a[164:167], a[124:127], v[196:199]
    s_waitcnt lgkmcnt(9)
    ds_read_b64_tr_b16 a[190:191], v23 offset:61440
    v_accvgpr_write_b32 a63, 0
    v_mfma_f32_16x16x32_bf16 v[200:203], a[168:171], a[112:115], v[200:203]
    s_waitcnt lgkmcnt(8)
    ds_read_b64_tr_b16 a[160:161], v24 offset:49152
    v_accvgpr_write_b32 a64, 0
    v_mfma_f32_16x16x32_bf16 v[200:203], a[172:175], a[120:123], v[200:203]
    ds_read_b64_tr_b16 a[162:163], v24 offset:53248
    v_accvgpr_write_b32 a65, 0
    v_mfma_f32_16x16x32_bf16 v[204:207], a[168:171], a[116:119], v[204:207]
    ds_read_b64_tr_b16 a[164:165], v24 offset:57344
    v_accvgpr_write_b32 a66, 0
    v_mfma_f32_16x16x32_bf16 v[204:207], a[172:175], a[124:127], v[204:207]
    s_waitcnt lgkmcnt(9)
    ds_read_b64_tr_b16 a[166:167], v24 offset:61440
    v_accvgpr_write_b32 a67, 0
    v_mfma_f32_16x16x32_bf16 v[208:211], a[176:179], a[112:115], v[208:211]
    s_waitcnt lgkmcnt(8)
    ds_read_b64_tr_b16 a[168:169], v25 offset:49152
    v_accvgpr_write_b32 a68, 0
    v_mfma_f32_16x16x32_bf16 v[208:211], a[180:183], a[120:123], v[208:211]
    ds_read_b64_tr_b16 a[170:171], v25 offset:53248
    v_accvgpr_write_b32 a69, 0
    v_mfma_f32_16x16x32_bf16 v[212:215], a[176:179], a[116:119], v[212:215]
    ds_read_b64_tr_b16 a[172:173], v25 offset:57344
    v_accvgpr_write_b32 a70, 0
    v_mfma_f32_16x16x32_bf16 v[212:215], a[180:183], a[124:127], v[212:215]
    s_waitcnt lgkmcnt(9)
    ds_read_b64_tr_b16 a[174:175], v25 offset:61440
    v_accvgpr_write_b32 a71, 0
    v_mfma_f32_16x16x32_bf16 v[216:219], a[184:187], a[112:115], v[216:219]
    s_waitcnt lgkmcnt(8)
    ds_read_b64_tr_b16 a[176:177], v26 offset:49152
    v_accvgpr_write_b32 a72, 0
    v_mfma_f32_16x16x32_bf16 v[216:219], a[188:191], a[120:123], v[216:219]
    ds_read_b64_tr_b16 a[178:179], v26 offset:53248
    v_accvgpr_write_b32 a73, 0
    v_mfma_f32_16x16x32_bf16 v[220:223], a[184:187], a[116:119], v[220:223]
    ds_read_b64_tr_b16 a[180:181], v26 offset:57344
    v_accvgpr_write_b32 a74, 0
    v_mfma_f32_16x16x32_bf16 v[220:223], a[188:191], a[124:127], v[220:223]
    s_waitcnt lgkmcnt(9)
    ds_read_b64_tr_b16 a[182:183], v26 offset:61440
    v_accvgpr_write_b32 a75, 0
    v_mfma_f32_16x16x32_bf16 v[224:227], a[160:163], a[112:115], v[224:227]
    s_waitcnt lgkmcnt(8)
    ds_read_b64_tr_b16 a[184:185], v27 offset:49152
    v_accvgpr_write_b32 a76, 0
    v_mfma_f32_16x16x32_bf16 v[224:227], a[164:167], a[120:123], v[224:227]
    ds_read_b64_tr_b16 a[186:187], v27 offset:53248
    v_accvgpr_write_b32 a77, 0
    v_mfma_f32_16x16x32_bf16 v[228:231], a[160:163], a[116:119], v[228:231]
    ds_read_b64_tr_b16 a[188:189], v27 offset:57344
    v_accvgpr_write_b32 a78, 0
    v_mfma_f32_16x16x32_bf16 v[228:231], a[164:167], a[124:127], v[228:231]
    s_waitcnt lgkmcnt(9)
    ds_read_b64_tr_b16 a[190:191], v27 offset:61440
    v_accvgpr_write_b32 a79, 0
    s_waitcnt vmcnt(12)
    s_barrier
    v_mfma_f32_16x16x32_bf16 v[232:235], a[168:171], a[112:115], v[232:235]
    s_waitcnt lgkmcnt(8)
    ds_read_b64_tr_b16 a[160:161], v28 offset:0
    v_accvgpr_write_b32 a80, 0
    v_mfma_f32_16x16x32_bf16 v[232:235], a[172:175], a[120:123], v[232:235]
    ds_read_b64_tr_b16 a[162:163], v28 offset:4096
    v_accvgpr_write_b32 a81, 0
    v_mfma_f32_16x16x32_bf16 v[236:239], a[168:171], a[116:119], v[236:239]
    s_add_u32 m0, s42, 65536
    ds_read_b64_tr_b16 a[164:165], v28 offset:8192
    v_accvgpr_write_b32 a82, 0
    v_mfma_f32_16x16x32_bf16 v[236:239], a[172:175], a[124:127], v[236:239]
    s_waitcnt lgkmcnt(9)
    ds_read_b64_tr_b16 a[166:167], v28 offset:12288
    buffer_load_dwordx4 v40, s[12:15], s41 offen lds
    v_mfma_f32_16x16x32_bf16 v[240:243], a[176:179], a[112:115], v[240:243]
    s_waitcnt lgkmcnt(8)
    ds_read_b64_tr_b16 a[168:169], v29 offset:0
    v_accvgpr_write_b32 a83, 0
    v_mfma_f32_16x16x32_bf16 v[240:243], a[180:183], a[120:123], v[240:243]
    ds_read_b64_tr_b16 a[170:171], v29 offset:4096
    v_accvgpr_write_b32 a84, 0
    v_mfma_f32_16x16x32_bf16 v[244:247], a[176:179], a[116:119], v[244:247]
    ds_read_b64_tr_b16 a[172:173], v29 offset:8192
    v_accvgpr_write_b32 a85, 0
    v_mfma_f32_16x16x32_bf16 v[244:247], a[180:183], a[124:127], v[244:247]
    s_waitcnt lgkmcnt(9)
    ds_read_b64_tr_b16 a[174:175], v29 offset:12288
    buffer_load_dwordx4 v41, s[12:15], s41 offen offset:1024 lds
    v_mfma_f32_16x16x32_bf16 v[248:251], a[184:187], a[112:115], v[248:251]
    s_waitcnt lgkmcnt(8)
    ds_read_b64_tr_b16 a[176:177], v30 offset:0
    v_accvgpr_write_b32 a86, 0
    v_mfma_f32_16x16x32_bf16 v[248:251], a[188:191], a[120:123], v[248:251]
    ds_read_b64_tr_b16 a[178:179], v30 offset:4096
    v_accvgpr_write_b32 a87, 0
    v_mfma_f32_16x16x32_bf16 v[252:255], a[184:187], a[116:119], v[252:255]
    ds_read_b64_tr_b16 a[180:181], v30 offset:8192
    v_accvgpr_write_b32 a88, 0
    v_mfma_f32_16x16x32_bf16 v[252:255], a[188:191], a[124:127], v[252:255]
    s_waitcnt lgkmcnt(9)
    ds_read_b64_tr_b16 a[182:183], v30 offset:12288
    buffer_load_dwordx4 v40, s[12:15], s41 offen offset:2048 lds
    v_mfma_f32_16x16x32_bf16 v[128:131], a[160:163], a[128:131], v[128:131]
    s_waitcnt lgkmcnt(8)
    ds_read_b64_tr_b16 a[184:185], v31 offset:0
    v_accvgpr_write_b32 a89, 0
    v_mfma_f32_16x16x32_bf16 v[128:131], a[164:167], a[136:139], v[128:131]
    ds_read_b64_tr_b16 a[186:187], v31 offset:4096
    v_accvgpr_write_b32 a90, 0
    v_mfma_f32_16x16x32_bf16 v[132:135], a[160:163], a[132:135], v[132:135]
    ds_read_b64_tr_b16 a[188:189], v31 offset:8192
    v_accvgpr_write_b32 a91, 0
    v_mfma_f32_16x16x32_bf16 v[132:135], a[164:167], a[140:143], v[132:135]
    s_waitcnt lgkmcnt(9)
    ds_read_b64_tr_b16 a[190:191], v31 offset:12288
    buffer_load_dwordx4 v41, s[12:15], s41 offen offset:3072 lds
    v_mfma_f32_16x16x32_bf16 v[136:139], a[168:171], a[128:131], v[136:139]
    s_waitcnt lgkmcnt(8)
    s_add_u32 s41, s41, 16384
    ds_read_b64_tr_b16 a[160:161], v32 offset:0
    v_accvgpr_write_b32 a92, 0
    v_mfma_f32_16x16x32_bf16 v[136:139], a[172:175], a[136:139], v[136:139]
    ds_read_b64_tr_b16 a[162:163], v32 offset:4096
    v_accvgpr_write_b32 a93, 0
    v_mfma_f32_16x16x32_bf16 v[140:143], a[168:171], a[132:135], v[140:143]
    s_add_u32 m0, s42, 81920
    ds_read_b64_tr_b16 a[164:165], v32 offset:8192
    v_accvgpr_write_b32 a94, 0
    v_mfma_f32_16x16x32_bf16 v[140:143], a[172:175], a[140:143], v[140:143]
    s_waitcnt lgkmcnt(9)
    ds_read_b64_tr_b16 a[166:167], v32 offset:12288
    buffer_load_dwordx4 v40, s[12:15], s41 offen lds
    v_mfma_f32_16x16x32_bf16 v[144:147], a[176:179], a[128:131], v[144:147]
    s_waitcnt lgkmcnt(8)
    ds_read_b64_tr_b16 a[168:169], v33 offset:0
    v_accvgpr_write_b32 a95, 0
    v_mfma_f32_16x16x32_bf16 v[144:147], a[180:183], a[136:139], v[144:147]
    ds_read_b64_tr_b16 a[170:171], v33 offset:4096
    v_accvgpr_write_b32 a96, 0
    v_mfma_f32_16x16x32_bf16 v[148:151], a[176:179], a[132:135], v[148:151]
    ds_read_b64_tr_b16 a[172:173], v33 offset:8192
    v_accvgpr_write_b32 a97, 0
    v_mfma_f32_16x16x32_bf16 v[148:151], a[180:183], a[140:143], v[148:151]
    s_waitcnt lgkmcnt(9)
    ds_read_b64_tr_b16 a[174:175], v33 offset:12288
    buffer_load_dwordx4 v41, s[12:15], s41 offen offset:1024 lds
    v_mfma_f32_16x16x32_bf16 v[152:155], a[184:187], a[128:131], v[152:155]
    s_waitcnt lgkmcnt(8)
    ds_read_b64_tr_b16 a[176:177], v34 offset:0
    v_accvgpr_write_b32 a98, 0
    v_mfma_f32_16x16x32_bf16 v[152:155], a[188:191], a[136:139], v[152:155]
    ds_read_b64_tr_b16 a[178:179], v34 offset:4096
    v_accvgpr_write_b32 a99, 0
    v_mfma_f32_16x16x32_bf16 v[156:159], a[184:187], a[132:135], v[156:159]
    ds_read_b64_tr_b16 a[180:181], v34 offset:8192
    v_accvgpr_write_b32 a100, 0
    v_mfma_f32_16x16x32_bf16 v[156:159], a[188:191], a[140:143], v[156:159]
    s_waitcnt lgkmcnt(9)
    ds_read_b64_tr_b16 a[182:183], v34 offset:12288
    buffer_load_dwordx4 v40, s[12:15], s41 offen offset:2048 lds
    v_mfma_f32_16x16x32_bf16 v[160:163], a[160:163], a[128:131], v[160:163]
    s_waitcnt lgkmcnt(8)
    ds_read_b64_tr_b16 a[184:185], v35 offset:0
    v_accvgpr_write_b32 a101, 0
    v_mfma_f32_16x16x32_bf16 v[160:163], a[164:167], a[136:139], v[160:163]
    ds_read_b64_tr_b16 a[186:187], v35 offset:4096
    v_accvgpr_write_b32 a102, 0
    v_mfma_f32_16x16x32_bf16 v[164:167], a[160:163], a[132:135], v[164:167]
    ds_read_b64_tr_b16 a[188:189], v35 offset:8192
    v_accvgpr_write_b32 a103, 0
    v_mfma_f32_16x16x32_bf16 v[164:167], a[164:167], a[140:143], v[164:167]
    s_waitcnt lgkmcnt(9)
    ds_read_b64_tr_b16 a[190:191], v35 offset:12288
    buffer_load_dwordx4 v41, s[12:15], s41 offen offset:3072 lds
    v_mfma_f32_16x16x32_bf16 v[168:171], a[168:171], a[128:131], v[168:171]
    s_waitcnt lgkmcnt(8)
    s_add_u32 s41, s41, 16384
    ds_read_b64_tr_b16 a[160:161], v28 offset:16384
    v_accvgpr_write_b32 a104, 0
    v_mfma_f32_16x16x32_bf16 v[168:171], a[172:175], a[136:139], v[168:171]
    ds_read_b64_tr_b16 a[162:163], v28 offset:20480
    v_accvgpr_write_b32 a105, 0
    v_mfma_f32_16x16x32_bf16 v[172:175], a[168:171], a[132:135], v[172:175]
    ds_read_b64_tr_b16 a[164:165], v28 offset:24576
    v_accvgpr_write_b32 a106, 0
    v_mfma_f32_16x16x32_bf16 v[172:175], a[172:175], a[140:143], v[172:175]
    s_waitcnt lgkmcnt(9)
    ds_read_b64_tr_b16 a[166:167], v28 offset:28672
    v_accvgpr_write_b32 a107, 0
    v_mfma_f32_16x16x32_bf16 v[176:179], a[176:179], a[128:131], v[176:179]
    s_waitcnt lgkmcnt(8)
    ds_read_b64_tr_b16 a[168:169], v29 offset:16384
    v_accvgpr_write_b32 a108, 0
    v_mfma_f32_16x16x32_bf16 v[176:179], a[180:183], a[136:139], v[176:179]
    ds_read_b64_tr_b16 a[170:171], v29 offset:20480
    v_accvgpr_write_b32 a109, 0
    v_mfma_f32_16x16x32_bf16 v[180:183], a[176:179], a[132:135], v[180:183]
    ds_read_b64_tr_b16 a[172:173], v29 offset:24576
    v_accvgpr_write_b32 a110, 0
    v_mfma_f32_16x16x32_bf16 v[180:183], a[180:183], a[140:143], v[180:183]
    s_waitcnt lgkmcnt(9)
    ds_read_b64_tr_b16 a[174:175], v29 offset:28672
    v_accvgpr_write_b32 a111, 0
    v_mfma_f32_16x16x32_bf16 v[184:187], a[184:187], a[128:131], v[184:187]
    s_waitcnt lgkmcnt(8)
    ds_read_b64_tr_b16 a[176:177], v30 offset:16384
    v_accvgpr_write_b32 a192, 0
    v_mfma_f32_16x16x32_bf16 v[184:187], a[188:191], a[136:139], v[184:187]
    ds_read_b64_tr_b16 a[178:179], v30 offset:20480
    v_accvgpr_write_b32 a193, 0
    v_mfma_f32_16x16x32_bf16 v[188:191], a[184:187], a[132:135], v[188:191]
    ds_read_b64_tr_b16 a[180:181], v30 offset:24576
    v_accvgpr_write_b32 a194, 0
    v_mfma_f32_16x16x32_bf16 v[188:191], a[188:191], a[140:143], v[188:191]
    s_waitcnt lgkmcnt(9)
    ds_read_b64_tr_b16 a[182:183], v30 offset:28672
    v_accvgpr_write_b32 a195, 0
    v_mfma_f32_16x16x32_bf16 v[192:195], a[160:163], a[128:131], v[192:195]
    s_waitcnt lgkmcnt(8)
    ds_read_b64_tr_b16 a[184:185], v31 offset:16384
    v_accvgpr_write_b32 a196, 0
    v_mfma_f32_16x16x32_bf16 v[192:195], a[164:167], a[136:139], v[192:195]
    ds_read_b64_tr_b16 a[186:187], v31 offset:20480
    v_accvgpr_write_b32 a197, 0
    v_mfma_f32_16x16x32_bf16 v[196:199], a[160:163], a[132:135], v[196:199]
    ds_read_b64_tr_b16 a[188:189], v31 offset:24576
    v_accvgpr_write_b32 a198, 0
    v_mfma_f32_16x16x32_bf16 v[196:199], a[164:167], a[140:143], v[196:199]
    s_waitcnt lgkmcnt(9)
    ds_read_b64_tr_b16 a[190:191], v31 offset:28672
    v_accvgpr_write_b32 a199, 0
    v_mfma_f32_16x16x32_bf16 v[200:203], a[168:171], a[128:131], v[200:203]
    s_waitcnt lgkmcnt(8)
    ds_read_b64_tr_b16 a[160:161], v32 offset:16384
    v_accvgpr_write_b32 a200, 0
    v_mfma_f32_16x16x32_bf16 v[200:203], a[172:175], a[136:139], v[200:203]
    ds_read_b64_tr_b16 a[162:163], v32 offset:20480
    v_accvgpr_write_b32 a201, 0
    v_mfma_f32_16x16x32_bf16 v[204:207], a[168:171], a[132:135], v[204:207]
    ds_read_b64_tr_b16 a[164:165], v32 offset:24576
    v_accvgpr_write_b32 a202, 0
    v_mfma_f32_16x16x32_bf16 v[204:207], a[172:175], a[140:143], v[204:207]
    s_waitcnt lgkmcnt(9)
    ds_read_b64_tr_b16 a[166:167], v32 offset:28672
    v_accvgpr_write_b32 a203, 0
    v_mfma_f32_16x16x32_bf16 v[208:211], a[176:179], a[128:131], v[208:211]
    s_waitcnt lgkmcnt(8)
    ds_read_b64_tr_b16 a[168:169], v33 offset:16384
    v_accvgpr_write_b32 a204, 0
    v_mfma_f32_16x16x32_bf16 v[208:211], a[180:183], a[136:139], v[208:211]
    ds_read_b64_tr_b16 a[170:171], v33 offset:20480
    v_accvgpr_write_b32 a205, 0
    v_mfma_f32_16x16x32_bf16 v[212:215], a[176:179], a[132:135], v[212:215]
    ds_read_b64_tr_b16 a[172:173], v33 offset:24576
    v_accvgpr_write_b32 a206, 0
    v_mfma_f32_16x16x32_bf16 v[212:215], a[180:183], a[140:143], v[212:215]
    s_waitcnt lgkmcnt(9)
    ds_read_b64_tr_b16 a[174:175], v33 offset:28672
    v_accvgpr_write_b32 a207, 0
    v_mfma_f32_16x16x32_bf16 v[216:219], a[184:187], a[128:131], v[216:219]
    s_waitcnt lgkmcnt(8)
    ds_read_b64_tr_b16 a[176:177], v34 offset:16384
    v_accvgpr_write_b32 a112, 0
    v_mfma_f32_16x16x32_bf16 v[216:219], a[188:191], a[136:139], v[216:219]
    ds_read_b64_tr_b16 a[178:179], v34 offset:20480
    v_accvgpr_write_b32 a113, 0
    v_mfma_f32_16x16x32_bf16 v[220:223], a[184:187], a[132:135], v[220:223]
    ds_read_b64_tr_b16 a[180:181], v34 offset:24576
    v_accvgpr_write_b32 a114, 0
    v_mfma_f32_16x16x32_bf16 v[220:223], a[188:191], a[140:143], v[220:223]
    s_waitcnt lgkmcnt(9)
    ds_read_b64_tr_b16 a[182:183], v34 offset:28672
    v_accvgpr_write_b32 a115, 0
    v_mfma_f32_16x16x32_bf16 v[224:227], a[160:163], a[128:131], v[224:227]
    s_waitcnt lgkmcnt(8)
    ds_read_b64_tr_b16 a[184:185], v35 offset:16384
    v_accvgpr_write_b32 a116, 0
    v_mfma_f32_16x16x32_bf16 v[224:227], a[164:167], a[136:139], v[224:227]
    ds_read_b64_tr_b16 a[186:187], v35 offset:20480
    v_accvgpr_write_b32 a117, 0
    v_mfma_f32_16x16x32_bf16 v[228:231], a[160:163], a[132:135], v[228:231]
    ds_read_b64_tr_b16 a[188:189], v35 offset:24576
    v_accvgpr_write_b32 a118, 0
    v_mfma_f32_16x16x32_bf16 v[228:231], a[164:167], a[140:143], v[228:231]
    s_waitcnt lgkmcnt(9)
    ds_read_b64_tr_b16 a[190:191], v35 offset:28672
    v_accvgpr_write_b32 a119, 0
    v_mfma_f32_16x16x32_bf16 v[232:235], a[168:171], a[128:131], v[232:235]
    s_waitcnt lgkmcnt(8)
    v_accvgpr_write_b32 a120, 0
    v_mfma_f32_16x16x32_bf16 v[232:235], a[172:175], a[136:139], v[232:235]
    v_accvgpr_write_b32 a121, 0
    v_mfma_f32_16x16x32_bf16 v[236:239], a[168:171], a[132:135], v[236:239]
    v_accvgpr_write_b32 a122, 0
    v_mfma_f32_16x16x32_bf16 v[236:239], a[172:175], a[140:143], v[236:239]
    s_waitcnt lgkmcnt(6)
    v_accvgpr_write_b32 a123, 0
    s_waitcnt vmcnt(16)
    s_barrier
    v_mfma_f32_16x16x32_bf16 v[240:243], a[176:179], a[128:131], v[240:243]
    s_waitcnt lgkmcnt(4)
    ds_read_b128 a[208:211], v8 offset:0
    v_accvgpr_write_b32 a124, 0
    v_mfma_f32_16x16x32_bf16 v[240:243], a[180:183], a[136:139], v[240:243]
    ds_read_b128 a[212:215], v9 offset:0
    v_accvgpr_write_b32 a125, 0
    v_mfma_f32_16x16x32_bf16 v[244:247], a[176:179], a[132:135], v[244:247]
    ds_read_b128 a[216:219], v10 offset:0
    v_accvgpr_write_b32 a126, 0
    v_mfma_f32_16x16x32_bf16 v[244:247], a[180:183], a[140:143], v[244:247]
    s_waitcnt lgkmcnt(5)
    ds_read_b128 a[220:223], v11 offset:0
    v_accvgpr_write_b32 a127, 0
    v_mfma_f32_16x16x32_bf16 v[248:251], a[184:187], a[128:131], v[248:251]
    s_waitcnt lgkmcnt(4)
    ds_read_b128 a[224:227], v8 offset:4096
    v_mfma_f32_16x16x32_bf16 v[248:251], a[188:191], a[136:139], v[248:251]
    v_mfma_f32_16x16x32_bf16 v[252:255], a[184:187], a[132:135], v[252:255]
    v_mfma_f32_16x16x32_bf16 v[252:255], a[188:191], a[140:143], v[252:255]
    s_waitcnt lgkmcnt(4)
    s_mov_b32 s36, 1040356334
    s_mov_b32 s37, 1040356334
    v_pk_mul_f32 v[128:129], v[128:129], s[36:37]
    v_pk_mul_f32 v[130:131], v[130:131], s[36:37]
    v_pk_mul_f32 v[136:137], v[136:137], s[36:37]
    v_pk_mul_f32 v[138:139], v[138:139], s[36:37]
    v_cvt_pk_bf16_f32 v64, v128, v129
    v_cvt_pk_bf16_f32 v65, v130, v131
    v_cvt_pk_bf16_f32 v66, v136, v137
    v_cvt_pk_bf16_f32 v67, v138, v139
    v_pk_mul_f32 v[132:133], v[132:133], s[36:37]
    v_pk_mul_f32 v[134:135], v[134:135], s[36:37]
    v_pk_mul_f32 v[140:141], v[140:141], s[36:37]
    v_pk_mul_f32 v[142:143], v[142:143], s[36:37]
    v_cvt_pk_bf16_f32 v80, v132, v133
    v_cvt_pk_bf16_f32 v81, v134, v135
    v_cvt_pk_bf16_f32 v82, v140, v141
    v_cvt_pk_bf16_f32 v83, v142, v143
    v_permlane32_swap_b32 v64, v66
    v_permlane32_swap_b32 v65, v67
    v_permlane32_swap_b32 v80, v82
    v_permlane32_swap_b32 v81, v83
    v_permlane16_swap_b32 v64, v66
    v_permlane16_swap_b32 v65, v67
    v_permlane16_swap_b32 v80, v82
    v_permlane16_swap_b32 v81, v83
    v_pk_mul_f32 v[144:145], v[144:145], s[36:37]
    v_pk_mul_f32 v[146:147], v[146:147], s[36:37]
    v_pk_mul_f32 v[152:153], v[152:153], s[36:37]
    v_pk_mul_f32 v[154:155], v[154:155], s[36:37]
    v_cvt_pk_bf16_f32 v68, v144, v145
    v_cvt_pk_bf16_f32 v69, v146, v147
    v_cvt_pk_bf16_f32 v70, v152, v153
    v_cvt_pk_bf16_f32 v71, v154, v155
    v_pk_mul_f32 v[148:149], v[148:149], s[36:37]
    v_pk_mul_f32 v[150:151], v[150:151], s[36:37]
    v_pk_mul_f32 v[156:157], v[156:157], s[36:37]
    v_pk_mul_f32 v[158:159], v[158:159], s[36:37]
    v_cvt_pk_bf16_f32 v84, v148, v149
    v_cvt_pk_bf16_f32 v85, v150, v151
    v_cvt_pk_bf16_f32 v86, v156, v157
    v_cvt_pk_bf16_f32 v87, v158, v159
    v_permlane32_swap_b32 v68, v70
    v_permlane32_swap_b32 v69, v71
    v_permlane32_swap_b32 v84, v86
    v_permlane32_swap_b32 v85, v87
    v_permlane16_swap_b32 v68, v70
    v_permlane16_swap_b32 v69, v71
    v_permlane16_swap_b32 v84, v86
    v_permlane16_swap_b32 v85, v87
    v_pk_mul_f32 v[160:161], v[160:161], s[36:37]
    v_pk_mul_f32 v[162:163], v[162:163], s[36:37]
    v_pk_mul_f32 v[168:169], v[168:169], s[36:37]
    v_pk_mul_f32 v[170:171], v[170:171], s[36:37]
    v_cvt_pk_bf16_f32 v72, v160, v161
    v_cvt_pk_bf16_f32 v73, v162, v163
    v_cvt_pk_bf16_f32 v74, v168, v169
    v_cvt_pk_bf16_f32 v75, v170, v171
    v_pk_mul_f32 v[164:165], v[164:165], s[36:37]
    v_pk_mul_f32 v[166:167], v[166:167], s[36:37]
    v_pk_mul_f32 v[172:173], v[172:173], s[36:37]
    v_pk_mul_f32 v[174:175], v[174:175], s[36:37]
    v_cvt_pk_bf16_f32 v88, v164, v165
    v_cvt_pk_bf16_f32 v89, v166, v167
    v_cvt_pk_bf16_f32 v90, v172, v173
    v_cvt_pk_bf16_f32 v91, v174, v175
    v_permlane32_swap_b32 v72, v74
    v_permlane32_swap_b32 v73, v75
    v_permlane32_swap_b32 v88, v90
    v_permlane32_swap_b32 v89, v91
    v_permlane16_swap_b32 v72, v74
    v_permlane16_swap_b32 v73, v75
    v_permlane16_swap_b32 v88, v90
    v_permlane16_swap_b32 v89, v91
    v_pk_mul_f32 v[176:177], v[176:177], s[36:37]
    v_pk_mul_f32 v[178:179], v[178:179], s[36:37]
    v_pk_mul_f32 v[184:185], v[184:185], s[36:37]
    v_pk_mul_f32 v[186:187], v[186:187], s[36:37]
    v_cvt_pk_bf16_f32 v76, v176, v177
    v_cvt_pk_bf16_f32 v77, v178, v179
    v_cvt_pk_bf16_f32 v78, v184, v185
    v_cvt_pk_bf16_f32 v79, v186, v187
    v_pk_mul_f32 v[180:181], v[180:181], s[36:37]
    v_pk_mul_f32 v[182:183], v[182:183], s[36:37]
    v_pk_mul_f32 v[188:189], v[188:189], s[36:37]
    v_pk_mul_f32 v[190:191], v[190:191], s[36:37]
    v_cvt_pk_bf16_f32 v92, v180, v181
    v_cvt_pk_bf16_f32 v93, v182, v183
    v_cvt_pk_bf16_f32 v94, v188, v189
    v_cvt_pk_bf16_f32 v95, v190, v191
    v_permlane32_swap_b32 v76, v78
    v_permlane32_swap_b32 v77, v79
    v_permlane32_swap_b32 v92, v94
    v_permlane32_swap_b32 v93, v95
    v_permlane16_swap_b32 v76, v78
    v_permlane16_swap_b32 v77, v79
    v_permlane16_swap_b32 v92, v94
    v_permlane16_swap_b32 v93, v95
    v_pk_mul_f32 v[192:193], v[192:193], s[36:37]
    v_pk_mul_f32 v[194:195], v[194:195], s[36:37]
    v_pk_mul_f32 v[200:201], v[200:201], s[36:37]
    v_pk_mul_f32 v[202:203], v[202:203], s[36:37]
    v_cvt_pk_bf16_f32 v96, v192, v193
    v_cvt_pk_bf16_f32 v97, v194, v195
    v_cvt_pk_bf16_f32 v98, v200, v201
    v_cvt_pk_bf16_f32 v99, v202, v203
    v_pk_mul_f32 v[196:197], v[196:197], s[36:37]
    v_pk_mul_f32 v[198:199], v[198:199], s[36:37]
    v_pk_mul_f32 v[204:205], v[204:205], s[36:37]
    v_pk_mul_f32 v[206:207], v[206:207], s[36:37]
    v_cvt_pk_bf16_f32 v112, v196, v197
    v_cvt_pk_bf16_f32 v113, v198, v199
    v_cvt_pk_bf16_f32 v114, v204, v205
    v_cvt_pk_bf16_f32 v115, v206, v207
    v_permlane32_swap_b32 v96, v98
    v_permlane32_swap_b32 v97, v99
    v_permlane32_swap_b32 v112, v114
    v_permlane32_swap_b32 v113, v115
    v_permlane16_swap_b32 v96, v98
    v_permlane16_swap_b32 v97, v99
    v_permlane16_swap_b32 v112, v114
    v_permlane16_swap_b32 v113, v115
    v_pk_mul_f32 v[208:209], v[208:209], s[36:37]
    v_pk_mul_f32 v[210:211], v[210:211], s[36:37]
    v_pk_mul_f32 v[216:217], v[216:217], s[36:37]
    v_pk_mul_f32 v[218:219], v[218:219], s[36:37]
    v_cvt_pk_bf16_f32 v100, v208, v209
    v_cvt_pk_bf16_f32 v101, v210, v211
    v_cvt_pk_bf16_f32 v102, v216, v217
    v_cvt_pk_bf16_f32 v103, v218, v219
    v_pk_mul_f32 v[212:213], v[212:213], s[36:37]
    v_pk_mul_f32 v[214:215], v[214:215], s[36:37]
    v_pk_mul_f32 v[220:221], v[220:221], s[36:37]
    v_pk_mul_f32 v[222:223], v[222:223], s[36:37]
    v_cvt_pk_bf16_f32 v116, v212, v213
    v_cvt_pk_bf16_f32 v117, v214, v215
    v_cvt_pk_bf16_f32 v118, v220, v221
    v_cvt_pk_bf16_f32 v119, v222, v223
    v_permlane32_swap_b32 v100, v102
    v_permlane32_swap_b32 v101, v103
    v_permlane32_swap_b32 v116, v118
    v_permlane32_swap_b32 v117, v119
    v_permlane16_swap_b32 v100, v102
    v_permlane16_swap_b32 v101, v103
    v_permlane16_swap_b32 v116, v118
    v_permlane16_swap_b32 v117, v119
    v_pk_mul_f32 v[224:225], v[224:225], s[36:37]
    v_pk_mul_f32 v[226:227], v[226:227], s[36:37]
    v_pk_mul_f32 v[232:233], v[232:233], s[36:37]
    v_pk_mul_f32 v[234:235], v[234:235], s[36:37]
    v_cvt_pk_bf16_f32 v104, v224, v225
    v_cvt_pk_bf16_f32 v105, v226, v227
    v_cvt_pk_bf16_f32 v106, v232, v233
    v_cvt_pk_bf16_f32 v107, v234, v235
    v_pk_mul_f32 v[228:229], v[228:229], s[36:37]
    v_pk_mul_f32 v[230:231], v[230:231], s[36:37]
    v_pk_mul_f32 v[236:237], v[236:237], s[36:37]
    v_pk_mul_f32 v[238:239], v[238:239], s[36:37]
    v_cvt_pk_bf16_f32 v120, v228, v229
    v_cvt_pk_bf16_f32 v121, v230, v231
    v_cvt_pk_bf16_f32 v122, v236, v237
    v_cvt_pk_bf16_f32 v123, v238, v239
    v_permlane32_swap_b32 v104, v106
    v_permlane32_swap_b32 v105, v107
    v_permlane32_swap_b32 v120, v122
    v_permlane32_swap_b32 v121, v123
    v_permlane16_swap_b32 v104, v106
    v_permlane16_swap_b32 v105, v107
    v_permlane16_swap_b32 v120, v122
    v_permlane16_swap_b32 v121, v123
    v_pk_mul_f32 v[240:241], v[240:241], s[36:37]
    v_pk_mul_f32 v[242:243], v[242:243], s[36:37]
    v_pk_mul_f32 v[248:249], v[248:249], s[36:37]
    v_pk_mul_f32 v[250:251], v[250:251], s[36:37]
    v_cvt_pk_bf16_f32 v108, v240, v241
    v_cvt_pk_bf16_f32 v109, v242, v243
    v_cvt_pk_bf16_f32 v110, v248, v249
    v_cvt_pk_bf16_f32 v111, v250, v251
    v_pk_mul_f32 v[244:245], v[244:245], s[36:37]
    v_pk_mul_f32 v[246:247], v[246:247], s[36:37]
    v_pk_mul_f32 v[252:253], v[252:253], s[36:37]
    v_pk_mul_f32 v[254:255], v[254:255], s[36:37]
    v_cvt_pk_bf16_f32 v124, v244, v245
    v_cvt_pk_bf16_f32 v125, v246, v247
    v_cvt_pk_bf16_f32 v126, v252, v253
    v_cvt_pk_bf16_f32 v127, v254, v255
    v_permlane32_swap_b32 v108, v110
    v_permlane32_swap_b32 v109, v111
    v_permlane32_swap_b32 v124, v126
    v_permlane32_swap_b32 v125, v127
    v_permlane16_swap_b32 v108, v110
    v_permlane16_swap_b32 v109, v111
    v_permlane16_swap_b32 v124, v126
    v_permlane16_swap_b32 v125, v127
    v_mfma_f32_16x16x32_bf16 v[216:219], a[208:211], v[64:67], 0
    s_waitcnt lgkmcnt(3)
    v_mfma_f32_16x16x32_bf16 v[216:219], a[212:215], v[68:71], v[216:219]
    s_waitcnt lgkmcnt(2)
    v_mfma_f32_16x16x32_bf16 v[216:219], a[216:219], v[72:75], v[216:219]
    s_waitcnt lgkmcnt(1)
    v_mfma_f32_16x16x32_bf16 v[216:219], a[220:223], v[76:79], v[216:219]
    v_mfma_f32_16x16x32_bf16 v[220:223], a[208:211], v[80:83], 0
    v_mfma_f32_16x16x32_bf16 v[220:223], a[212:215], v[84:87], v[220:223]
    v_mfma_f32_16x16x32_bf16 v[220:223], a[216:219], v[88:91], v[220:223]
    v_mfma_f32_16x16x32_bf16 v[220:223], a[220:223], v[92:95], v[220:223]
    v_mfma_f32_16x16x32_bf16 v[224:227], a[208:211], v[96:99], 0
    v_mfma_f32_16x16x32_bf16 v[224:227], a[212:215], v[100:103], v[224:227]
    v_mfma_f32_16x16x32_bf16 v[224:227], a[216:219], v[104:107], v[224:227]
    v_mfma_f32_16x16x32_bf16 v[224:227], a[220:223], v[108:111], v[224:227]
    v_mfma_f32_16x16x32_bf16 v[228:231], a[208:211], v[112:115], 0
    v_mfma_f32_16x16x32_bf16 v[228:231], a[212:215], v[116:119], v[228:231]
    v_mfma_f32_16x16x32_bf16 v[228:231], a[216:219], v[120:123], v[228:231]
    v_mfma_f32_16x16x32_bf16 v[228:231], a[220:223], v[124:127], v[228:231]
    v_max3_f32 v232, v216, v217, v218
    v_max_f32 v232, v232, v219
    v_max3_f32 v233, v220, v221, v222
    v_max_f32 v233, v233, v223
    v_max3_f32 v234, v224, v225, v226
    v_max_f32 v234, v234, v227
    s_nop 1
    v_max3_f32 v235, v228, v229, v230
    v_max_f32 v235, v235, v231
    v_mov_b32 v236, v232
    v_mov_b32 v237, v233
    v_mov_b32 v238, v234
    v_mov_b32 v239, v235
    v_permlane16_swap_b32 v232, v236
    v_permlane16_swap_b32 v233, v237
    v_permlane16_swap_b32 v234, v238
    v_permlane16_swap_b32 v235, v239
    v_max_f32 v232, v232, v236
    v_max_f32 v233, v233, v237
    v_max_f32 v234, v234, v238
    v_max_f32 v235, v235, v239
    v_mov_b32 v236, v232
    v_mov_b32 v237, v233
    v_mov_b32 v238, v234
    v_mov_b32 v239, v235
    v_permlane32_swap_b32 v232, v236
    v_permlane32_swap_b32 v233, v237
    v_permlane32_swap_b32 v234, v238
    v_permlane32_swap_b32 v235, v239
    v_max_f32 v232, v232, v236
    v_max_f32 v233, v233, v237
    v_max_f32 v234, v234, v238
    v_max_f32 v235, v235, v239
    v_sub_f32 v192, 3250585600, v232
    v_sub_f32 v193, 3250585600, v232
    v_sub_f32 v194, 3250585600, v232
    v_sub_f32 v195, 3250585600, v232
    v_sub_f32 v196, 3250585600, v233
    v_sub_f32 v197, 3250585600, v233
    v_sub_f32 v198, 3250585600, v233
    v_sub_f32 v199, 3250585600, v233
    v_sub_f32 v200, 3250585600, v234
    v_sub_f32 v201, 3250585600, v234
    v_sub_f32 v202, 3250585600, v234
    v_sub_f32 v203, 3250585600, v234
    v_sub_f32 v204, 3250585600, v235
    v_sub_f32 v205, 3250585600, v235
    v_sub_f32 v206, 3250585600, v235
    v_sub_f32 v207, 3250585600, v235
Lattn_stage0:
    s_mov_b32 s43, 7
    v_mfma_f32_16x16x32_bf16 v[208:211], a[208:211], v[64:67], v[192:195]
    v_mfma_f32_16x16x32_bf16 v[208:211], a[212:215], v[68:71], v[208:211]
    v_mfma_f32_16x16x32_bf16 v[208:211], a[216:219], v[72:75], v[208:211]
    v_mfma_f32_16x16x32_bf16 v[208:211], a[220:223], v[76:79], v[208:211]
    s_lshr_b32 s6, s2, 3
    ds_read_b128 a[228:231], v9 offset:4096
    v_mfma_f32_16x16x32_bf16 v[212:215], a[208:211], v[80:83], v[196:199]
    s_nop 4
    v_exp_f32 v208, v208
    v_mfma_f32_16x16x32_bf16 v[212:215], a[212:215], v[84:87], v[212:215]
    v_exp_f32 v209, v209
    v_mfma_f32_16x16x32_bf16 v[212:215], a[216:219], v[88:91], v[212:215]
    v_exp_f32 v210, v210
    v_mfma_f32_16x16x32_bf16 v[212:215], a[220:223], v[92:95], v[212:215]
    v_exp_f32 v211, v211
    v_cvt_pk_bf16_f32 v128, v208, v209
    s_and_b32 s7, s2, 7
    ds_read_b128 a[232:235], v10 offset:4096
    v_cvt_pk_bf16_f32 v129, v210, v211
    v_mfma_f32_16x16x32_bf16 v[208:211], a[208:211], v[96:99], v[200:203]
    s_nop 1
    v_exp_f32 v212, v212
    v_mfma_f32_16x16x32_bf16 v[208:211], a[212:215], v[100:103], v[208:211]
    v_exp_f32 v213, v213
    v_mfma_f32_16x16x32_bf16 v[208:211], a[216:219], v[104:107], v[208:211]
    v_exp_f32 v214, v214
    v_mfma_f32_16x16x32_bf16 v[208:211], a[220:223], v[108:111], v[208:211]
    v_exp_f32 v215, v215
    v_cvt_pk_bf16_f32 v136, v212, v213
    s_mul_i32 s7, s7, 18
    ds_read_b128 a[236:239], v11 offset:4096
    v_cvt_pk_bf16_f32 v137, v214, v215
    s_mul_i32 s49, s5, 18432
    s_add_u32 s49, s49, s45
    v_lshlrev_b32 v220, 6, v0
    v_mfma_f32_16x16x32_bf16 v[212:215], a[208:211], v[112:115], v[204:207]
    v_exp_f32 v208, v208
    v_mfma_f32_16x16x32_bf16 v[212:215], a[212:215], v[116:119], v[212:215]
    v_exp_f32 v209, v209
    v_mfma_f32_16x16x32_bf16 v[212:215], a[216:219], v[120:123], v[212:215]
    v_exp_f32 v210, v210
    v_mfma_f32_16x16x32_bf16 v[212:215], a[220:223], v[124:127], v[212:215]
    s_waitcnt lgkmcnt(3)
    v_exp_f32 v211, v211
    v_cvt_pk_bf16_f32 v144, v208, v209
    s_add_u32 s7, s7, s6
    ds_read_b128 a[208:211], v8 offset:8192
    v_cvt_pk_bf16_f32 v145, v210, v211
    buffer_load_dword v221, v220, s[20:23], s49 offen
    v_mfma_f32_16x16x32_bf16 v[208:211], a[224:227], v[64:67], v[192:195]
    s_waitcnt lgkmcnt(3)
    v_exp_f32 v212, v212
    v_mfma_f32_16x16x32_bf16 v[208:211], a[228:231], v[68:71], v[208:211]
    s_waitcnt lgkmcnt(2)
    v_exp_f32 v213, v213
    v_mfma_f32_16x16x32_bf16 v[208:211], a[232:235], v[72:75], v[208:211]
    s_waitcnt lgkmcnt(1)
    v_exp_f32 v214, v214
    v_mfma_f32_16x16x32_bf16 v[208:211], a[236:239], v[76:79], v[208:211]
    v_exp_f32 v215, v215
    v_cvt_pk_bf16_f32 v152, v212, v213
    s_lshl_b32 s58, s7, 6
    ds_read_b128 a[212:215], v9 offset:8192
    v_cvt_pk_bf16_f32 v153, v214, v215
    s_add_u32 s49, s49, 16384
    v_mfma_f32_16x16x32_bf16 v[212:215], a[224:227], v[80:83], v[196:199]
    s_nop 0
    v_exp_f32 v208, v208
    v_mfma_f32_16x16x32_bf16 v[212:215], a[228:231], v[84:87], v[212:215]
    v_exp_f32 v209, v209
    v_mfma_f32_16x16x32_bf16 v[212:215], a[232:235], v[88:91], v[212:215]
    v_exp_f32 v210, v210
    v_mfma_f32_16x16x32_bf16 v[212:215], a[236:239], v[92:95], v[212:215]
    v_exp_f32 v211, v211
    v_cvt_pk_bf16_f32 v130, v208, v209
    s_mul_i32 s59, s7, 36864
    ds_read_b128 a[216:219], v10 offset:8192
    v_cvt_pk_bf16_f32 v131, v210, v211
    buffer_load_dword v222, v220, s[20:23], s49 offen
    v_mfma_f32_16x16x32_bf16 v[208:211], a[224:227], v[96:99], v[200:203]
    s_nop 0
    v_exp_f32 v212, v212
    v_mfma_f32_16x16x32_bf16 v[208:211], a[228:231], v[100:103], v[208:211]
    v_exp_f32 v213, v213
    v_mfma_f32_16x16x32_bf16 v[208:211], a[232:235], v[104:107], v[208:211]
    v_exp_f32 v214, v214
    v_mfma_f32_16x16x32_bf16 v[208:211], a[236:239], v[108:111], v[208:211]
    v_exp_f32 v215, v215
    v_cvt_pk_bf16_f32 v138, v212, v213
    s_cmp_lt_u32 s6, 18
    s_cselect_b32 s7, 0, 2147483648
    ds_read_b128 a[220:223], v11 offset:8192
    v_cvt_pk_bf16_f32 v139, v214, v215
    s_mov_b32 s39, 221184
    s_mov_b32 s38, 27648
    v_mfma_f32_16x16x32_bf16 v[212:215], a[224:227], v[112:115], v[204:207]
    v_exp_f32 v208, v208
    v_mfma_f32_16x16x32_bf16 v[212:215], a[228:231], v[116:119], v[212:215]
    v_exp_f32 v209, v209
    v_mfma_f32_16x16x32_bf16 v[212:215], a[232:235], v[120:123], v[212:215]
    v_exp_f32 v210, v210
    v_mfma_f32_16x16x32_bf16 v[212:215], a[236:239], v[124:127], v[212:215]
    s_waitcnt lgkmcnt(3)
    v_exp_f32 v211, v211
    v_cvt_pk_bf16_f32 v146, v208, v209
    s_or_b32 s58, s58, s7
    ds_read_b128 a[224:227], v8 offset:12288
    v_cvt_pk_bf16_f32 v147, v210, v211
    v_mfma_f32_16x16x32_bf16 v[208:211], a[208:211], v[64:67], v[192:195]
    s_waitcnt lgkmcnt(3)
    v_exp_f32 v212, v212
    v_mfma_f32_16x16x32_bf16 v[208:211], a[212:215], v[68:71], v[208:211]
    s_waitcnt lgkmcnt(2)
    v_exp_f32 v213, v213
    v_mfma_f32_16x16x32_bf16 v[208:211], a[216:219], v[72:75], v[208:211]
    s_waitcnt lgkmcnt(1)
    v_exp_f32 v214, v214
    v_mfma_f32_16x16x32_bf16 v[208:211], a[220:223], v[76:79], v[208:211]
    v_exp_f32 v215, v215
    v_cvt_pk_bf16_f32 v154, v212, v213
    s_or_b32 s59, s59, s7
    ds_read_b128 a[228:231], v9 offset:12288
    v_cvt_pk_bf16_f32 v155, v214, v215
    v_mfma_f32_16x16x32_bf16 v[212:215], a[208:211], v[80:83], v[196:199]
    s_nop 1
    v_exp_f32 v208, v208
    v_mfma_f32_16x16x32_bf16 v[212:215], a[212:215], v[84:87], v[212:215]
    v_exp_f32 v209, v209
    v_mfma_f32_16x16x32_bf16 v[212:215], a[216:219], v[88:91], v[212:215]
    v_exp_f32 v210, v210
    v_mfma_f32_16x16x32_bf16 v[212:215], a[220:223], v[92:95], v[212:215]
    v_exp_f32 v211, v211
    v_cvt_pk_bf16_f32 v132, v208, v209
    v_lshrrev_b32 v51, 2, v0
    ds_read_b128 a[232:235], v10 offset:12288
    v_cvt_pk_bf16_f32 v133, v210, v211
    v_mfma_f32_16x16x32_bf16 v[208:211], a[208:211], v[96:99], v[200:203]
    s_nop 1
    v_exp_f32 v212, v212
    v_mfma_f32_16x16x32_bf16 v[208:211], a[212:215], v[100:103], v[208:211]
    v_exp_f32 v213, v213
    v_mfma_f32_16x16x32_bf16 v[208:211], a[216:219], v[104:107], v[208:211]
    v_exp_f32 v214, v214
    v_mfma_f32_16x16x32_bf16 v[208:211], a[220:223], v[108:111], v[208:211]
    v_exp_f32 v215, v215
    v_cvt_pk_bf16_f32 v140, v212, v213
    v_mul_u32_u24 v51, 9216, v51
    ds_read_b128 a[236:239], v11 offset:12288
    v_cvt_pk_bf16_f32 v141, v214, v215
    s_waitcnt vmcnt(6)
    s_barrier
    v_mfma_f32_16x16x32_bf16 v[212:215], a[208:211], v[112:115], v[204:207]
    v_exp_f32 v208, v208
    v_mfma_f32_16x16x32_bf16 v[212:215], a[212:215], v[116:119], v[212:215]
    s_add_u32 m0, s42, 49152
    v_exp_f32 v209, v209
    v_mfma_f32_16x16x32_bf16 v[212:215], a[216:219], v[120:123], v[212:215]
    v_exp_f32 v210, v210
    v_mfma_f32_16x16x32_bf16 v[212:215], a[220:223], v[124:127], v[212:215]
    s_waitcnt lgkmcnt(3)
    v_exp_f32 v211, v211
    v_cvt_pk_bf16_f32 v148, v208, v209
    v_and_b32 v254, 3, v0
    ds_read_b128 a[208:211], v8 offset:16384
    v_cvt_pk_bf16_f32 v149, v210, v211
    buffer_load_dwordx4 v36, s[8:11], s40 offen lds
    v_mfma_f32_16x16x32_bf16 v[208:211], a[224:227], v[64:67], v[192:195]
    s_waitcnt lgkmcnt(3)
    v_exp_f32 v212, v212
    v_mfma_f32_16x16x32_bf16 v[208:211], a[228:231], v[68:71], v[208:211]
    s_waitcnt lgkmcnt(2)
    v_exp_f32 v213, v213
    v_mfma_f32_16x16x32_bf16 v[208:211], a[232:235], v[72:75], v[208:211]
    s_waitcnt lgkmcnt(1)
    v_exp_f32 v214, v214
    v_mfma_f32_16x16x32_bf16 v[208:211], a[236:239], v[76:79], v[208:211]
    v_exp_f32 v215, v215
    v_cvt_pk_bf16_f32 v156, v212, v213
    v_lshl_add_u32 v254, v254, 4, v51
    ds_read_b128 a[212:215], v9 offset:16384
    v_cvt_pk_bf16_f32 v157, v214, v215
    v_mfma_f32_16x16x32_bf16 v[212:215], a[224:227], v[80:83], v[196:199]
    s_nop 1
    v_exp_f32 v208, v208
    v_mfma_f32_16x16x32_bf16 v[212:215], a[228:231], v[84:87], v[212:215]
    v_exp_f32 v209, v209
    v_mfma_f32_16x16x32_bf16 v[212:215], a[232:235], v[88:91], v[212:215]
    v_exp_f32 v210, v210
    v_mfma_f32_16x16x32_bf16 v[212:215], a[236:239], v[92:95], v[212:215]
    v_exp_f32 v211, v211
    ds_read_b64_tr_b16 a[160:161], v20 offset:0
    v_cvt_pk_bf16_f32 v134, v208, v209
    ds_read_b64_tr_b16 a[162:163], v20 offset:4096
    v_lshlrev_b32 v255, 4, v0
    ds_read_b128 a[216:219], v10 offset:16384
    v_cvt_pk_bf16_f32 v135, v210, v211
    buffer_load_dwordx4 v37, s[8:11], s40 offen offset:1024 lds
    v_mfma_f32_16x16x32_bf16 v[208:211], a[224:227], v[96:99], v[200:203]
    v_exp_f32 v212, v212
    v_mfma_f32_16x16x32_bf16 v[208:211], a[228:231], v[100:103], v[208:211]
    v_exp_f32 v213, v213
    v_mfma_f32_16x16x32_bf16 v[208:211], a[232:235], v[104:107], v[208:211]
    v_exp_f32 v214, v214
    v_mfma_f32_16x16x32_bf16 v[208:211], a[236:239], v[108:111], v[208:211]
    v_exp_f32 v215, v215
    ds_read_b64_tr_b16 a[164:165], v20 offset:8192
    v_cvt_pk_bf16_f32 v142, v212, v213
    ds_read_b64_tr_b16 a[166:167], v20 offset:12288
    v_add_u32 v51, 98304, v255
    ds_read_b128 a[220:223], v11 offset:16384
    v_cvt_pk_bf16_f32 v143, v214, v215
    v_mfma_f32_16x16x32_bf16 v[212:215], a[224:227], v[112:115], v[204:207]
    v_exp_f32 v208, v208
    v_mfma_f32_16x16x32_bf16 v[212:215], a[228:231], v[116:119], v[212:215]
    v_exp_f32 v209, v209
    v_mfma_f32_16x16x32_bf16 v[212:215], a[232:235], v[120:123], v[212:215]
    v_exp_f32 v210, v210
    v_mfma_f32_16x16x32_bf16 v[212:215], a[236:239], v[124:127], v[212:215]
    v_exp_f32 v211, v211
    ds_read_b64_tr_b16 a[168:169], v21 offset:0
    v_cvt_pk_bf16_f32 v150, v208, v209
    ds_read_b64_tr_b16 a[170:171], v21 offset:4096
    ds_read_b128 a[224:227], v8 offset:20480
    v_cvt_pk_bf16_f32 v151, v210, v211
    s_waitcnt lgkmcnt(3)
    buffer_load_dwordx4 v38, s[8:11], s40 offen offset:2048 lds
Lattn_loop:
    v_mfma_f32_16x16x32_bf16 v[208:211], a[208:211], v[64:67], v[192:195]
    v_exp_f32 v212, v212
    v_mfma_f32_16x16x32_bf16 v[208:211], a[212:215], v[68:71], v[208:211]
    v_exp_f32 v213, v213
    v_mfma_f32_16x16x32_bf16 v[208:211], a[216:219], v[72:75], v[208:211]
    v_exp_f32 v214, v214
    v_mfma_f32_16x16x32_bf16 v[208:211], a[220:223], v[76:79], v[208:211]
    v_exp_f32 v215, v215
    v_mfma_f32_16x16x32_bf16 a[0:3], a[160:163], v[128:131], a[0:3]
    ds_read_b64_tr_b16 a[172:173], v21 offset:8192
    v_cvt_pk_bf16_f32 v158, v212, v213
    v_mfma_f32_16x16x32_bf16 a[0:3], a[164:167], v[132:135], a[0:3]
    ds_read_b64_tr_b16 a[174:175], v21 offset:12288
    v_mfma_f32_16x16x32_bf16 a[4:7], a[160:163], v[136:139], a[4:7]
    ds_read_b128 a[228:231], v9 offset:20480
    v_cvt_pk_bf16_f32 v159, v214, v215
    v_mfma_f32_16x16x32_bf16 a[4:7], a[164:167], v[140:143], a[4:7]
    v_mfma_f32_16x16x32_bf16 v[212:215], a[208:211], v[80:83], v[196:199]
    v_exp_f32 v208, v208
    v_mfma_f32_16x16x32_bf16 v[212:215], a[212:215], v[84:87], v[212:215]
    v_exp_f32 v209, v209
    v_mfma_f32_16x16x32_bf16 v[212:215], a[216:219], v[88:91], v[212:215]
    v_exp_f32 v210, v210
    v_mfma_f32_16x16x32_bf16 v[212:215], a[220:223], v[92:95], v[212:215]
    v_exp_f32 v211, v211
    v_mfma_f32_16x16x32_bf16 a[8:11], a[160:163], v[144:147], a[8:11]
    ds_read_b64_tr_b16 a[176:177], v22 offset:0
    v_cvt_pk_bf16_f32 v160, v208, v209
    v_mfma_f32_16x16x32_bf16 a[8:11], a[164:167], v[148:151], a[8:11]
    ds_read_b64_tr_b16 a[178:179], v22 offset:4096
    v_mfma_f32_16x16x32_bf16 a[12:15], a[160:163], v[152:155], a[12:15]
    ds_read_b128 a[232:235], v10 offset:20480
    v_cvt_pk_bf16_f32 v161, v210, v211
    v_mfma_f32_16x16x32_bf16 a[12:15], a[164:167], v[156:159], a[12:15]
    s_waitcnt lgkmcnt(3)
    buffer_load_dwordx4 v39, s[8:11], s40 offen offset:3072 lds
    v_mfma_f32_16x16x32_bf16 v[208:211], a[208:211], v[96:99], v[200:203]
    v_exp_f32 v212, v212
    v_mfma_f32_16x16x32_bf16 v[208:211], a[212:215], v[100:103], v[208:211]
    s_add_u32 s40, s40, 16384
    v_exp_f32 v213, v213
    v_mfma_f32_16x16x32_bf16 v[208:211], a[216:219], v[104:107], v[208:211]
    v_exp_f32 v214, v214
    v_mfma_f32_16x16x32_bf16 v[208:211], a[220:223], v[108:111], v[208:211]
    v_exp_f32 v215, v215
    v_mfma_f32_16x16x32_bf16 a[16:19], a[168:171], v[128:131], a[16:19]
    ds_read_b64_tr_b16 a[180:181], v22 offset:8192
    v_cvt_pk_bf16_f32 v168, v212, v213
    v_mfma_f32_16x16x32_bf16 a[16:19], a[172:175], v[132:135], a[16:19]
    ds_read_b64_tr_b16 a[182:183], v22 offset:12288
    v_mfma_f32_16x16x32_bf16 a[20:23], a[168:171], v[136:139], a[20:23]
    ds_read_b128 a[236:239], v11 offset:20480
    v_cvt_pk_bf16_f32 v169, v214, v215
    v_mfma_f32_16x16x32_bf16 a[20:23], a[172:175], v[140:143], a[20:23]
    v_smfmac_f32_16x16x64_bf16 a[192:195], v[52:55], v[128:135], v50
    v_mfma_f32_16x16x32_bf16 v[212:215], a[208:211], v[112:115], v[204:207]
    v_exp_f32 v208, v208
    v_mfma_f32_16x16x32_bf16 v[212:215], a[212:215], v[116:119], v[212:215]
    s_add_u32 m0, s42, 98304
    v_exp_f32 v209, v209
    v_mfma_f32_16x16x32_bf16 v[212:215], a[216:219], v[120:123], v[212:215]
    v_exp_f32 v210, v210
    v_mfma_f32_16x16x32_bf16 v[212:215], a[220:223], v[124:127], v[212:215]
    v_exp_f32 v211, v211
    v_mfma_f32_16x16x32_bf16 a[24:27], a[168:171], v[144:147], a[24:27]
    ds_read_b64_tr_b16 a[184:185], v23 offset:0
    v_cvt_pk_bf16_f32 v176, v208, v209
    v_mfma_f32_16x16x32_bf16 a[24:27], a[172:175], v[148:151], a[24:27]
    ds_read_b64_tr_b16 a[186:187], v23 offset:4096
    v_mfma_f32_16x16x32_bf16 a[28:31], a[168:171], v[152:155], a[28:31]
    ds_read_b128 a[208:211], v8 offset:24576
    v_cvt_pk_bf16_f32 v177, v210, v211
    v_mfma_f32_16x16x32_bf16 a[28:31], a[172:175], v[156:159], a[28:31]
    s_waitcnt lgkmcnt(3)
    buffer_load_dwordx4 v40, s[12:15], s41 offen lds
    v_mfma_f32_16x16x32_bf16 v[208:211], a[224:227], v[64:67], v[192:195]
    v_exp_f32 v212, v212
    v_mfma_f32_16x16x32_bf16 v[208:211], a[228:231], v[68:71], v[208:211]
    v_exp_f32 v213, v213
    v_mfma_f32_16x16x32_bf16 v[208:211], a[232:235], v[72:75], v[208:211]
    v_exp_f32 v214, v214
    v_mfma_f32_16x16x32_bf16 v[208:211], a[236:239], v[76:79], v[208:211]
    v_exp_f32 v215, v215
    v_mfma_f32_16x16x32_bf16 a[32:35], a[176:179], v[128:131], a[32:35]
    ds_read_b64_tr_b16 a[188:189], v23 offset:8192
    v_cvt_pk_bf16_f32 v184, v212, v213
    v_mfma_f32_16x16x32_bf16 a[32:35], a[180:183], v[132:135], a[32:35]
    ds_read_b64_tr_b16 a[190:191], v23 offset:12288
    v_mfma_f32_16x16x32_bf16 a[36:39], a[176:179], v[136:139], a[36:39]
    ds_read_b128 a[212:215], v9 offset:24576
    v_cvt_pk_bf16_f32 v185, v214, v215
    v_mfma_f32_16x16x32_bf16 a[36:39], a[180:183], v[140:143], a[36:39]
    v_smfmac_f32_16x16x64_bf16 a[196:199], v[52:55], v[136:143], v50
    v_mfma_f32_16x16x32_bf16 v[212:215], a[224:227], v[80:83], v[196:199]
    v_exp_f32 v208, v208
    v_mfma_f32_16x16x32_bf16 v[212:215], a[228:231], v[84:87], v[212:215]
    v_exp_f32 v209, v209
    v_mfma_f32_16x16x32_bf16 v[212:215], a[232:235], v[88:91], v[212:215]
    v_exp_f32 v210, v210
    v_mfma_f32_16x16x32_bf16 v[212:215], a[236:239], v[92:95], v[212:215]
    v_exp_f32 v211, v211
    v_mfma_f32_16x16x32_bf16 a[40:43], a[176:179], v[144:147], a[40:43]
    ds_read_b64_tr_b16 a[160:161], v24 offset:0
    v_cvt_pk_bf16_f32 v162, v208, v209
    v_mfma_f32_16x16x32_bf16 a[40:43], a[180:183], v[148:151], a[40:43]
    ds_read_b64_tr_b16 a[162:163], v24 offset:4096
    v_mfma_f32_16x16x32_bf16 a[44:47], a[176:179], v[152:155], a[44:47]
    ds_read_b128 a[216:219], v10 offset:24576
    v_cvt_pk_bf16_f32 v163, v210, v211
    v_mfma_f32_16x16x32_bf16 a[44:47], a[180:183], v[156:159], a[44:47]
    s_waitcnt lgkmcnt(3)
    buffer_load_dwordx4 v41, s[12:15], s41 offen offset:1024 lds
    v_mfma_f32_16x16x32_bf16 v[208:211], a[224:227], v[96:99], v[200:203]
    v_exp_f32 v212, v212
    v_mfma_f32_16x16x32_bf16 v[208:211], a[228:231], v[100:103], v[208:211]
    v_exp_f32 v213, v213
    v_mfma_f32_16x16x32_bf16 v[208:211], a[232:235], v[104:107], v[208:211]
    v_exp_f32 v214, v214
    v_mfma_f32_16x16x32_bf16 v[208:211], a[236:239], v[108:111], v[208:211]
    v_exp_f32 v215, v215
    v_mfma_f32_16x16x32_bf16 a[48:51], a[184:187], v[128:131], a[48:51]
    ds_read_b64_tr_b16 a[164:165], v24 offset:8192
    v_cvt_pk_bf16_f32 v170, v212, v213
    v_mfma_f32_16x16x32_bf16 a[48:51], a[188:191], v[132:135], a[48:51]
    ds_read_b64_tr_b16 a[166:167], v24 offset:12288
    v_mfma_f32_16x16x32_bf16 a[52:55], a[184:187], v[136:139], a[52:55]
    ds_read_b128 a[220:223], v11 offset:24576
    v_cvt_pk_bf16_f32 v171, v214, v215
    v_mfma_f32_16x16x32_bf16 a[52:55], a[188:191], v[140:143], a[52:55]
    v_smfmac_f32_16x16x64_bf16 a[200:203], v[52:55], v[144:151], v50
    v_mfma_f32_16x16x32_bf16 v[212:215], a[224:227], v[112:115], v[204:207]
    v_exp_f32 v208, v208
    v_mfma_f32_16x16x32_bf16 v[212:215], a[228:231], v[116:119], v[212:215]
    v_exp_f32 v209, v209
    v_mfma_f32_16x16x32_bf16 v[212:215], a[232:235], v[120:123], v[212:215]
    v_exp_f32 v210, v210
    v_mfma_f32_16x16x32_bf16 v[212:215], a[236:239], v[124:127], v[212:215]
    v_exp_f32 v211, v211
    v_mfma_f32_16x16x32_bf16 a[56:59], a[184:187], v[144:147], a[56:59]
    ds_read_b64_tr_b16 a[168:169], v25 offset:0
    v_cvt_pk_bf16_f32 v178, v208, v209
    v_mfma_f32_16x16x32_bf16 a[56:59], a[188:191], v[148:151], a[56:59]
    ds_read_b64_tr_b16 a[170:171], v25 offset:4096
    v_mfma_f32_16x16x32_bf16 a[60:63], a[184:187], v[152:155], a[60:63]
    ds_read_b128 a[224:227], v8 offset:28672
    v_cvt_pk_bf16_f32 v179, v210, v211
    v_mfma_f32_16x16x32_bf16 a[60:63], a[188:191], v[156:159], a[60:63]
    s_waitcnt lgkmcnt(3)
    buffer_load_dwordx4 v40, s[12:15], s41 offen offset:2048 lds
    v_mfma_f32_16x16x32_bf16 v[208:211], a[208:211], v[64:67], v[192:195]
    v_exp_f32 v212, v212
    v_mfma_f32_16x16x32_bf16 v[208:211], a[212:215], v[68:71], v[208:211]
    v_exp_f32 v213, v213
    v_mfma_f32_16x16x32_bf16 v[208:211], a[216:219], v[72:75], v[208:211]
    v_exp_f32 v214, v214
    v_mfma_f32_16x16x32_bf16 v[208:211], a[220:223], v[76:79], v[208:211]
    v_exp_f32 v215, v215
    v_mfma_f32_16x16x32_bf16 a[64:67], a[160:163], v[128:131], a[64:67]
    ds_read_b64_tr_b16 a[172:173], v25 offset:8192
    v_cvt_pk_bf16_f32 v186, v212, v213
    v_mfma_f32_16x16x32_bf16 a[64:67], a[164:167], v[132:135], a[64:67]
    ds_read_b64_tr_b16 a[174:175], v25 offset:12288
    v_mfma_f32_16x16x32_bf16 a[68:71], a[160:163], v[136:139], a[68:71]
    ds_read_b128 a[228:231], v9 offset:28672
    v_cvt_pk_bf16_f32 v187, v214, v215
    v_mfma_f32_16x16x32_bf16 a[68:71], a[164:167], v[140:143], a[68:71]
    v_smfmac_f32_16x16x64_bf16 a[204:207], v[52:55], v[152:159], v50
    v_mfma_f32_16x16x32_bf16 v[212:215], a[208:211], v[80:83], v[196:199]
    v_exp_f32 v208, v208
    v_mfma_f32_16x16x32_bf16 v[212:215], a[212:215], v[84:87], v[212:215]
    v_exp_f32 v209, v209
    v_mfma_f32_16x16x32_bf16 v[212:215], a[216:219], v[88:91], v[212:215]
    v_exp_f32 v210, v210
    v_mfma_f32_16x16x32_bf16 v[212:215], a[220:223], v[92:95], v[212:215]
    v_exp_f32 v211, v211
    v_mfma_f32_16x16x32_bf16 a[72:75], a[160:163], v[144:147], a[72:75]
    ds_read_b64_tr_b16 a[176:177], v26 offset:0
    v_cvt_pk_bf16_f32 v164, v208, v209
    v_mfma_f32_16x16x32_bf16 a[72:75], a[164:167], v[148:151], a[72:75]
    ds_read_b64_tr_b16 a[178:179], v26 offset:4096
    v_mfma_f32_16x16x32_bf16 a[76:79], a[160:163], v[152:155], a[76:79]
    ds_read_b128 a[232:235], v10 offset:28672
    v_cvt_pk_bf16_f32 v165, v210, v211
    v_mfma_f32_16x16x32_bf16 a[76:79], a[164:167], v[156:159], a[76:79]
    s_waitcnt lgkmcnt(3)
    buffer_load_dwordx4 v41, s[12:15], s41 offen offset:3072 lds
    v_mfma_f32_16x16x32_bf16 v[208:211], a[208:211], v[96:99], v[200:203]
    v_exp_f32 v212, v212
    v_mfma_f32_16x16x32_bf16 v[208:211], a[212:215], v[100:103], v[208:211]
    s_add_u32 s41, s41, 16384
    v_exp_f32 v213, v213
    v_mfma_f32_16x16x32_bf16 v[208:211], a[216:219], v[104:107], v[208:211]
    v_exp_f32 v214, v214
    v_mfma_f32_16x16x32_bf16 v[208:211], a[220:223], v[108:111], v[208:211]
    v_exp_f32 v215, v215
    v_mfma_f32_16x16x32_bf16 a[80:83], a[168:171], v[128:131], a[80:83]
    ds_read_b64_tr_b16 a[180:181], v26 offset:8192
    v_cvt_pk_bf16_f32 v172, v212, v213
    v_mfma_f32_16x16x32_bf16 a[80:83], a[172:175], v[132:135], a[80:83]
    ds_read_b64_tr_b16 a[182:183], v26 offset:12288
    v_mfma_f32_16x16x32_bf16 a[84:87], a[168:171], v[136:139], a[84:87]
    ds_read_b128 a[236:239], v11 offset:28672
    v_cvt_pk_bf16_f32 v173, v214, v215
    v_mfma_f32_16x16x32_bf16 a[84:87], a[172:175], v[140:143], a[84:87]
    s_waitcnt vmcnt(8)
    s_barrier
    v_mfma_f32_16x16x32_bf16 v[212:215], a[208:211], v[112:115], v[204:207]
    v_exp_f32 v208, v208
    v_mfma_f32_16x16x32_bf16 v[212:215], a[212:215], v[116:119], v[212:215]
    s_add_u32 m0, s42, 0
    v_exp_f32 v209, v209
    v_mfma_f32_16x16x32_bf16 v[212:215], a[216:219], v[120:123], v[212:215]
    v_exp_f32 v210, v210
    v_mfma_f32_16x16x32_bf16 v[212:215], a[220:223], v[124:127], v[212:215]
    v_exp_f32 v211, v211
    v_mfma_f32_16x16x32_bf16 a[88:91], a[168:171], v[144:147], a[88:91]
    ds_read_b64_tr_b16 a[184:185], v27 offset:0
    v_cvt_pk_bf16_f32 v180, v208, v209
    v_mfma_f32_16x16x32_bf16 a[88:91], a[172:175], v[148:151], a[88:91]
    ds_read_b64_tr_b16 a[186:187], v27 offset:4096
    v_mfma_f32_16x16x32_bf16 a[92:95], a[168:171], v[152:155], a[92:95]
    ds_read_b128 a[208:211], v8 offset:32768
    v_cvt_pk_bf16_f32 v181, v210, v211
    v_mfma_f32_16x16x32_bf16 a[92:95], a[172:175], v[156:159], a[92:95]
    s_waitcnt lgkmcnt(3)
    buffer_load_dwordx4 v36, s[8:11], s40 offen lds
    v_mfma_f32_16x16x32_bf16 v[208:211], a[224:227], v[64:67], v[192:195]
    v_exp_f32 v212, v212
    v_mfma_f32_16x16x32_bf16 v[208:211], a[228:231], v[68:71], v[208:211]
    v_exp_f32 v213, v213
    v_mfma_f32_16x16x32_bf16 v[208:211], a[232:235], v[72:75], v[208:211]
    v_exp_f32 v214, v214
    v_mfma_f32_16x16x32_bf16 v[208:211], a[236:239], v[76:79], v[208:211]
    v_exp_f32 v215, v215
    v_mfma_f32_16x16x32_bf16 a[96:99], a[176:179], v[128:131], a[96:99]
    ds_read_b64_tr_b16 a[188:189], v27 offset:8192
    v_cvt_pk_bf16_f32 v188, v212, v213
    v_mfma_f32_16x16x32_bf16 a[96:99], a[180:183], v[132:135], a[96:99]
    ds_read_b64_tr_b16 a[190:191], v27 offset:12288
    v_mfma_f32_16x16x32_bf16 a[100:103], a[176:179], v[136:139], a[100:103]
    ds_read_b128 a[212:215], v9 offset:32768
    v_cvt_pk_bf16_f32 v189, v214, v215
    v_mfma_f32_16x16x32_bf16 a[100:103], a[180:183], v[140:143], a[100:103]
    buffer_load_dword v217, v57, s[32:35], s39 offen
    v_mfma_f32_16x16x32_bf16 v[212:215], a[224:227], v[80:83], v[196:199]
    v_exp_f32 v208, v208
    v_mfma_f32_16x16x32_bf16 v[212:215], a[228:231], v[84:87], v[212:215]
    v_exp_f32 v209, v209
    v_mfma_f32_16x16x32_bf16 v[212:215], a[232:235], v[88:91], v[212:215]
    v_exp_f32 v210, v210
    v_mfma_f32_16x16x32_bf16 v[212:215], a[236:239], v[92:95], v[212:215]
    v_exp_f32 v211, v211
    v_mfma_f32_16x16x32_bf16 a[104:107], a[176:179], v[144:147], a[104:107]
    ds_read_b64_tr_b16 a[160:161], v20 offset:16384
    v_cvt_pk_bf16_f32 v166, v208, v209
    v_mfma_f32_16x16x32_bf16 a[104:107], a[180:183], v[148:151], a[104:107]
    ds_read_b64_tr_b16 a[162:163], v20 offset:20480
    v_mfma_f32_16x16x32_bf16 a[108:111], a[176:179], v[152:155], a[108:111]
    ds_read_b128 a[216:219], v10 offset:32768
    v_cvt_pk_bf16_f32 v167, v210, v211
    v_mfma_f32_16x16x32_bf16 a[108:111], a[180:183], v[156:159], a[108:111]
    s_waitcnt lgkmcnt(3)
    buffer_load_dwordx4 v37, s[8:11], s40 offen offset:1024 lds
    v_mfma_f32_16x16x32_bf16 v[208:211], a[224:227], v[96:99], v[200:203]
    v_exp_f32 v212, v212
    v_mfma_f32_16x16x32_bf16 v[208:211], a[228:231], v[100:103], v[208:211]
    v_exp_f32 v213, v213
    v_mfma_f32_16x16x32_bf16 v[208:211], a[232:235], v[104:107], v[208:211]
    v_exp_f32 v214, v214
    v_mfma_f32_16x16x32_bf16 v[208:211], a[236:239], v[108:111], v[208:211]
    v_exp_f32 v215, v215
    v_mfma_f32_16x16x32_bf16 a[112:115], a[184:187], v[128:131], a[112:115]
    ds_read_b64_tr_b16 a[164:165], v20 offset:24576
    v_cvt_pk_bf16_f32 v174, v212, v213
    v_mfma_f32_16x16x32_bf16 a[112:115], a[188:191], v[132:135], a[112:115]
    ds_read_b64_tr_b16 a[166:167], v20 offset:28672
    v_mfma_f32_16x16x32_bf16 a[116:119], a[184:187], v[136:139], a[116:119]
    ds_read_b128 a[220:223], v11 offset:32768
    v_cvt_pk_bf16_f32 v175, v214, v215
    v_mfma_f32_16x16x32_bf16 a[116:119], a[188:191], v[140:143], a[116:119]
    v_mfma_f32_16x16x32_bf16 v[212:215], a[224:227], v[112:115], v[204:207]
    v_exp_f32 v208, v208
    v_mfma_f32_16x16x32_bf16 v[212:215], a[228:231], v[116:119], v[212:215]
    v_exp_f32 v209, v209
    v_mfma_f32_16x16x32_bf16 v[212:215], a[232:235], v[120:123], v[212:215]
    v_exp_f32 v210, v210
    v_mfma_f32_16x16x32_bf16 v[212:215], a[236:239], v[124:127], v[212:215]
    v_exp_f32 v211, v211
    v_mfma_f32_16x16x32_bf16 a[120:123], a[184:187], v[144:147], a[120:123]
    ds_read_b64_tr_b16 a[168:169], v21 offset:16384
    v_cvt_pk_bf16_f32 v182, v208, v209
    v_mfma_f32_16x16x32_bf16 a[120:123], a[188:191], v[148:151], a[120:123]
    ds_read_b64_tr_b16 a[170:171], v21 offset:20480
    v_mfma_f32_16x16x32_bf16 a[124:127], a[184:187], v[152:155], a[124:127]
    ds_read_b128 a[224:227], v8 offset:36864
    v_cvt_pk_bf16_f32 v183, v210, v211
    v_mfma_f32_16x16x32_bf16 a[124:127], a[188:191], v[156:159], a[124:127]
    s_waitcnt lgkmcnt(3)
    buffer_load_dwordx4 v38, s[8:11], s40 offen offset:2048 lds
    v_mfma_f32_16x16x32_bf16 v[208:211], a[208:211], v[64:67], v[192:195]
    v_exp_f32 v212, v212
    v_mfma_f32_16x16x32_bf16 v[208:211], a[212:215], v[68:71], v[208:211]
    v_exp_f32 v213, v213
    v_mfma_f32_16x16x32_bf16 v[208:211], a[216:219], v[72:75], v[208:211]
    v_exp_f32 v214, v214
    v_mfma_f32_16x16x32_bf16 v[208:211], a[220:223], v[76:79], v[208:211]
    v_exp_f32 v215, v215
    v_mfma_f32_16x16x32_bf16 a[0:3], a[160:163], v[160:163], a[0:3]
    ds_read_b64_tr_b16 a[172:173], v21 offset:24576
    v_cvt_pk_bf16_f32 v190, v212, v213
    v_mfma_f32_16x16x32_bf16 a[0:3], a[164:167], v[164:167], a[0:3]
    ds_read_b64_tr_b16 a[174:175], v21 offset:28672
    v_mfma_f32_16x16x32_bf16 a[4:7], a[160:163], v[168:171], a[4:7]
    ds_read_b128 a[228:231], v9 offset:36864
    v_cvt_pk_bf16_f32 v191, v214, v215
    v_mfma_f32_16x16x32_bf16 a[4:7], a[164:167], v[172:175], a[4:7]
    v_mfma_f32_16x16x32_bf16 v[212:215], a[208:211], v[80:83], v[196:199]
    v_exp_f32 v208, v208
    v_mfma_f32_16x16x32_bf16 v[212:215], a[212:215], v[84:87], v[212:215]
    v_exp_f32 v209, v209
    v_mfma_f32_16x16x32_bf16 v[212:215], a[216:219], v[88:91], v[212:215]
    v_exp_f32 v210, v210
    v_mfma_f32_16x16x32_bf16 v[212:215], a[220:223], v[92:95], v[212:215]
    v_exp_f32 v211, v211
    v_mfma_f32_16x16x32_bf16 a[8:11], a[160:163], v[176:179], a[8:11]
    ds_read_b64_tr_b16 a[176:177], v22 offset:16384
    v_cvt_pk_bf16_f32 v128, v208, v209
    v_mfma_f32_16x16x32_bf16 a[8:11], a[164:167], v[180:183], a[8:11]
    ds_read_b64_tr_b16 a[178:179], v22 offset:20480
    v_mfma_f32_16x16x32_bf16 a[12:15], a[160:163], v[184:187], a[12:15]
    ds_read_b128 a[232:235], v10 offset:36864
    v_cvt_pk_bf16_f32 v129, v210, v211
    v_mfma_f32_16x16x32_bf16 a[12:15], a[164:167], v[188:191], a[12:15]
    s_waitcnt lgkmcnt(3)
    buffer_load_dwordx4 v39, s[8:11], s40 offen offset:3072 lds
    v_mfma_f32_16x16x32_bf16 v[208:211], a[208:211], v[96:99], v[200:203]
    v_exp_f32 v212, v212
    v_mfma_f32_16x16x32_bf16 v[208:211], a[212:215], v[100:103], v[208:211]
    s_add_u32 s40, s40, 16384
    v_exp_f32 v213, v213
    v_mfma_f32_16x16x32_bf16 v[208:211], a[216:219], v[104:107], v[208:211]
    v_exp_f32 v214, v214
    v_mfma_f32_16x16x32_bf16 v[208:211], a[220:223], v[108:111], v[208:211]
    v_exp_f32 v215, v215
    v_mfma_f32_16x16x32_bf16 a[16:19], a[168:171], v[160:163], a[16:19]
    ds_read_b64_tr_b16 a[180:181], v22 offset:24576
    v_cvt_pk_bf16_f32 v136, v212, v213
    v_mfma_f32_16x16x32_bf16 a[16:19], a[172:175], v[164:167], a[16:19]
    ds_read_b64_tr_b16 a[182:183], v22 offset:28672
    v_mfma_f32_16x16x32_bf16 a[20:23], a[168:171], v[168:171], a[20:23]
    ds_read_b128 a[236:239], v11 offset:36864
    v_cvt_pk_bf16_f32 v137, v214, v215
    v_mfma_f32_16x16x32_bf16 a[20:23], a[172:175], v[172:175], a[20:23]
    v_smfmac_f32_16x16x64_bf16 a[192:195], v[52:55], v[160:167], v50
    v_mfma_f32_16x16x32_bf16 v[212:215], a[208:211], v[112:115], v[204:207]
    v_exp_f32 v208, v208
    v_mfma_f32_16x16x32_bf16 v[212:215], a[212:215], v[116:119], v[212:215]
    s_add_u32 m0, s42, 114688
    v_exp_f32 v209, v209
    v_mfma_f32_16x16x32_bf16 v[212:215], a[216:219], v[120:123], v[212:215]
    v_exp_f32 v210, v210
    v_mfma_f32_16x16x32_bf16 v[212:215], a[220:223], v[124:127], v[212:215]
    v_exp_f32 v211, v211
    v_mfma_f32_16x16x32_bf16 a[24:27], a[168:171], v[176:179], a[24:27]
    ds_read_b64_tr_b16 a[184:185], v23 offset:16384
    v_cvt_pk_bf16_f32 v144, v208, v209
    v_mfma_f32_16x16x32_bf16 a[24:27], a[172:175], v[180:183], a[24:27]
    ds_read_b64_tr_b16 a[186:187], v23 offset:20480
    v_mfma_f32_16x16x32_bf16 a[28:31], a[168:171], v[184:187], a[28:31]
    ds_read_b128 a[208:211], v8 offset:40960
    v_cvt_pk_bf16_f32 v145, v210, v211
    v_mfma_f32_16x16x32_bf16 a[28:31], a[172:175], v[188:191], a[28:31]
    s_waitcnt lgkmcnt(3)
    buffer_load_dwordx4 v40, s[12:15], s41 offen lds
    v_mfma_f32_16x16x32_bf16 v[208:211], a[224:227], v[64:67], v[192:195]
    v_exp_f32 v212, v212
    v_mfma_f32_16x16x32_bf16 v[208:211], a[228:231], v[68:71], v[208:211]
    v_exp_f32 v213, v213
    v_mfma_f32_16x16x32_bf16 v[208:211], a[232:235], v[72:75], v[208:211]
    v_exp_f32 v214, v214
    v_mfma_f32_16x16x32_bf16 v[208:211], a[236:239], v[76:79], v[208:211]
    v_exp_f32 v215, v215
    v_mfma_f32_16x16x32_bf16 a[32:35], a[176:179], v[160:163], a[32:35]
    ds_read_b64_tr_b16 a[188:189], v23 offset:24576
    v_cvt_pk_bf16_f32 v152, v212, v213
    v_mfma_f32_16x16x32_bf16 a[32:35], a[180:183], v[164:167], a[32:35]
    ds_read_b64_tr_b16 a[190:191], v23 offset:28672
    v_mfma_f32_16x16x32_bf16 a[36:39], a[176:179], v[168:171], a[36:39]
    ds_read_b128 a[212:215], v9 offset:40960
    v_cvt_pk_bf16_f32 v153, v214, v215
    v_mfma_f32_16x16x32_bf16 a[36:39], a[180:183], v[172:175], a[36:39]
    v_smfmac_f32_16x16x64_bf16 a[196:199], v[52:55], v[168:175], v50
    v_mfma_f32_16x16x32_bf16 v[212:215], a[224:227], v[80:83], v[196:199]
    v_exp_f32 v208, v208
    v_mfma_f32_16x16x32_bf16 v[212:215], a[228:231], v[84:87], v[212:215]
    v_exp_f32 v209, v209
    v_mfma_f32_16x16x32_bf16 v[212:215], a[232:235], v[88:91], v[212:215]
    v_exp_f32 v210, v210
    v_mfma_f32_16x16x32_bf16 v[212:215], a[236:239], v[92:95], v[212:215]
    v_exp_f32 v211, v211
    v_mfma_f32_16x16x32_bf16 a[40:43], a[176:179], v[176:179], a[40:43]
    ds_read_b64_tr_b16 a[160:161], v24 offset:16384
    v_cvt_pk_bf16_f32 v130, v208, v209
    v_mfma_f32_16x16x32_bf16 a[40:43], a[180:183], v[180:183], a[40:43]
    ds_read_b64_tr_b16 a[162:163], v24 offset:20480
    v_mfma_f32_16x16x32_bf16 a[44:47], a[176:179], v[184:187], a[44:47]
    ds_read_b128 a[216:219], v10 offset:40960
    v_cvt_pk_bf16_f32 v131, v210, v211
    v_mfma_f32_16x16x32_bf16 a[44:47], a[180:183], v[188:191], a[44:47]
    s_waitcnt lgkmcnt(3)
    buffer_load_dwordx4 v41, s[12:15], s41 offen offset:1024 lds
    v_mfma_f32_16x16x32_bf16 v[208:211], a[224:227], v[96:99], v[200:203]
    v_exp_f32 v212, v212
    v_mfma_f32_16x16x32_bf16 v[208:211], a[228:231], v[100:103], v[208:211]
    v_exp_f32 v213, v213
    v_mfma_f32_16x16x32_bf16 v[208:211], a[232:235], v[104:107], v[208:211]
    v_exp_f32 v214, v214
    v_mfma_f32_16x16x32_bf16 v[208:211], a[236:239], v[108:111], v[208:211]
    v_exp_f32 v215, v215
    v_mfma_f32_16x16x32_bf16 a[48:51], a[184:187], v[160:163], a[48:51]
    ds_read_b64_tr_b16 a[164:165], v24 offset:24576
    v_cvt_pk_bf16_f32 v138, v212, v213
    v_mfma_f32_16x16x32_bf16 a[48:51], a[188:191], v[164:167], a[48:51]
    ds_read_b64_tr_b16 a[166:167], v24 offset:28672
    v_mfma_f32_16x16x32_bf16 a[52:55], a[184:187], v[168:171], a[52:55]
    ds_read_b128 a[220:223], v11 offset:40960
    v_cvt_pk_bf16_f32 v139, v214, v215
    v_mfma_f32_16x16x32_bf16 a[52:55], a[188:191], v[172:175], a[52:55]
    v_smfmac_f32_16x16x64_bf16 a[200:203], v[52:55], v[176:183], v50
    v_mfma_f32_16x16x32_bf16 v[212:215], a[224:227], v[112:115], v[204:207]
    v_exp_f32 v208, v208
    v_mfma_f32_16x16x32_bf16 v[212:215], a[228:231], v[116:119], v[212:215]
    v_exp_f32 v209, v209
    v_mfma_f32_16x16x32_bf16 v[212:215], a[232:235], v[120:123], v[212:215]
    v_exp_f32 v210, v210
    v_mfma_f32_16x16x32_bf16 v[212:215], a[236:239], v[124:127], v[212:215]
    v_exp_f32 v211, v211
    v_mfma_f32_16x16x32_bf16 a[56:59], a[184:187], v[176:179], a[56:59]
    ds_read_b64_tr_b16 a[168:169], v25 offset:16384
    v_cvt_pk_bf16_f32 v146, v208, v209
    v_mfma_f32_16x16x32_bf16 a[56:59], a[188:191], v[180:183], a[56:59]
    ds_read_b64_tr_b16 a[170:171], v25 offset:20480
    v_mfma_f32_16x16x32_bf16 a[60:63], a[184:187], v[184:187], a[60:63]
    ds_read_b128 a[224:227], v8 offset:45056
    v_cvt_pk_bf16_f32 v147, v210, v211
    v_mfma_f32_16x16x32_bf16 a[60:63], a[188:191], v[188:191], a[60:63]
    s_waitcnt lgkmcnt(3)
    buffer_load_dwordx4 v40, s[12:15], s41 offen offset:2048 lds
    v_mfma_f32_16x16x32_bf16 v[208:211], a[208:211], v[64:67], v[192:195]
    v_exp_f32 v212, v212
    v_mfma_f32_16x16x32_bf16 v[208:211], a[212:215], v[68:71], v[208:211]
    v_exp_f32 v213, v213
    v_mfma_f32_16x16x32_bf16 v[208:211], a[216:219], v[72:75], v[208:211]
    v_exp_f32 v214, v214
    v_mfma_f32_16x16x32_bf16 v[208:211], a[220:223], v[76:79], v[208:211]
    v_exp_f32 v215, v215
    v_mfma_f32_16x16x32_bf16 a[64:67], a[160:163], v[160:163], a[64:67]
    ds_read_b64_tr_b16 a[172:173], v25 offset:24576
    v_cvt_pk_bf16_f32 v154, v212, v213
    v_mfma_f32_16x16x32_bf16 a[64:67], a[164:167], v[164:167], a[64:67]
    ds_read_b64_tr_b16 a[174:175], v25 offset:28672
    v_mfma_f32_16x16x32_bf16 a[68:71], a[160:163], v[168:171], a[68:71]
    ds_read_b128 a[228:231], v9 offset:45056
    v_cvt_pk_bf16_f32 v155, v214, v215
    v_mfma_f32_16x16x32_bf16 a[68:71], a[164:167], v[172:175], a[68:71]
    v_smfmac_f32_16x16x64_bf16 a[204:207], v[52:55], v[184:191], v50
    v_mfma_f32_16x16x32_bf16 v[212:215], a[208:211], v[80:83], v[196:199]
    v_exp_f32 v208, v208
    v_mfma_f32_16x16x32_bf16 v[212:215], a[212:215], v[84:87], v[212:215]
    v_exp_f32 v209, v209
    v_mfma_f32_16x16x32_bf16 v[212:215], a[216:219], v[88:91], v[212:215]
    v_exp_f32 v210, v210
    v_mfma_f32_16x16x32_bf16 v[212:215], a[220:223], v[92:95], v[212:215]
    v_exp_f32 v211, v211
    v_mfma_f32_16x16x32_bf16 a[72:75], a[160:163], v[176:179], a[72:75]
    ds_read_b64_tr_b16 a[176:177], v26 offset:16384
    v_cvt_pk_bf16_f32 v132, v208, v209
    v_mfma_f32_16x16x32_bf16 a[72:75], a[164:167], v[180:183], a[72:75]
    ds_read_b64_tr_b16 a[178:179], v26 offset:20480
    v_mfma_f32_16x16x32_bf16 a[76:79], a[160:163], v[184:187], a[76:79]
    ds_read_b128 a[232:235], v10 offset:45056
    v_cvt_pk_bf16_f32 v133, v210, v211
    v_mfma_f32_16x16x32_bf16 a[76:79], a[164:167], v[188:191], a[76:79]
    s_waitcnt lgkmcnt(3)
    buffer_load_dwordx4 v41, s[12:15], s41 offen offset:3072 lds
    v_mfma_f32_16x16x32_bf16 v[208:211], a[208:211], v[96:99], v[200:203]
    v_exp_f32 v212, v212
    v_mfma_f32_16x16x32_bf16 v[208:211], a[212:215], v[100:103], v[208:211]
    s_add_u32 s41, s41, 16384
    v_exp_f32 v213, v213
    v_mfma_f32_16x16x32_bf16 v[208:211], a[216:219], v[104:107], v[208:211]
    v_exp_f32 v214, v214
    v_mfma_f32_16x16x32_bf16 v[208:211], a[220:223], v[108:111], v[208:211]
    v_exp_f32 v215, v215
    v_mfma_f32_16x16x32_bf16 a[80:83], a[168:171], v[160:163], a[80:83]
    ds_read_b64_tr_b16 a[180:181], v26 offset:24576
    v_cvt_pk_bf16_f32 v140, v212, v213
    v_mfma_f32_16x16x32_bf16 a[80:83], a[172:175], v[164:167], a[80:83]
    ds_read_b64_tr_b16 a[182:183], v26 offset:28672
    v_mfma_f32_16x16x32_bf16 a[84:87], a[168:171], v[168:171], a[84:87]
    ds_read_b128 a[236:239], v11 offset:45056
    v_cvt_pk_bf16_f32 v141, v214, v215
    v_mfma_f32_16x16x32_bf16 a[84:87], a[172:175], v[172:175], a[84:87]
    s_waitcnt vmcnt(9)
    s_barrier
    v_mfma_f32_16x16x32_bf16 v[212:215], a[208:211], v[112:115], v[204:207]
    v_exp_f32 v208, v208
    v_mfma_f32_16x16x32_bf16 v[212:215], a[212:215], v[116:119], v[212:215]
    s_add_u32 m0, s42, 16384
    v_exp_f32 v209, v209
    v_mfma_f32_16x16x32_bf16 v[212:215], a[216:219], v[120:123], v[212:215]
    v_exp_f32 v210, v210
    v_mfma_f32_16x16x32_bf16 v[212:215], a[220:223], v[124:127], v[212:215]
    v_exp_f32 v211, v211
    v_mfma_f32_16x16x32_bf16 a[88:91], a[168:171], v[176:179], a[88:91]
    ds_read_b64_tr_b16 a[184:185], v27 offset:16384
    v_cvt_pk_bf16_f32 v148, v208, v209
    v_mfma_f32_16x16x32_bf16 a[88:91], a[172:175], v[180:183], a[88:91]
    ds_read_b64_tr_b16 a[186:187], v27 offset:20480
    v_mfma_f32_16x16x32_bf16 a[92:95], a[168:171], v[184:187], a[92:95]
    ds_read_b128 a[208:211], v8 offset:49152
    v_cvt_pk_bf16_f32 v149, v210, v211
    v_mfma_f32_16x16x32_bf16 a[92:95], a[172:175], v[188:191], a[92:95]
    s_waitcnt lgkmcnt(3)
    buffer_load_dwordx4 v36, s[8:11], s40 offen lds
    v_mfma_f32_16x16x32_bf16 v[208:211], a[224:227], v[64:67], v[192:195]
    v_exp_f32 v212, v212
    v_mfma_f32_16x16x32_bf16 v[208:211], a[228:231], v[68:71], v[208:211]
    v_exp_f32 v213, v213
    v_mfma_f32_16x16x32_bf16 v[208:211], a[232:235], v[72:75], v[208:211]
    v_exp_f32 v214, v214
    v_mfma_f32_16x16x32_bf16 v[208:211], a[236:239], v[76:79], v[208:211]
    v_exp_f32 v215, v215
    v_mfma_f32_16x16x32_bf16 a[96:99], a[176:179], v[160:163], a[96:99]
    ds_read_b64_tr_b16 a[188:189], v27 offset:24576
    v_cvt_pk_bf16_f32 v156, v212, v213
    v_mfma_f32_16x16x32_bf16 a[96:99], a[180:183], v[164:167], a[96:99]
    ds_read_b64_tr_b16 a[190:191], v27 offset:28672
    v_mfma_f32_16x16x32_bf16 a[100:103], a[176:179], v[168:171], a[100:103]
    ds_read_b128 a[212:215], v9 offset:49152
    v_cvt_pk_bf16_f32 v157, v214, v215
    v_mfma_f32_16x16x32_bf16 a[100:103], a[180:183], v[172:175], a[100:103]
    buffer_load_dword v218, v57, s[80:83], s39 offen
    v_mfma_f32_16x16x32_bf16 v[212:215], a[224:227], v[80:83], v[196:199]
    v_exp_f32 v208, v208
    v_mfma_f32_16x16x32_bf16 v[212:215], a[228:231], v[84:87], v[212:215]
    v_exp_f32 v209, v209
    v_mfma_f32_16x16x32_bf16 v[212:215], a[232:235], v[88:91], v[212:215]
    v_exp_f32 v210, v210
    v_mfma_f32_16x16x32_bf16 v[212:215], a[236:239], v[92:95], v[212:215]
    v_exp_f32 v211, v211
    v_mfma_f32_16x16x32_bf16 a[104:107], a[176:179], v[176:179], a[104:107]
    ds_read_b64_tr_b16 a[160:161], v20 offset:32768
    v_cvt_pk_bf16_f32 v134, v208, v209
    v_mfma_f32_16x16x32_bf16 a[104:107], a[180:183], v[180:183], a[104:107]
    ds_read_b64_tr_b16 a[162:163], v20 offset:36864
    v_mfma_f32_16x16x32_bf16 a[108:111], a[176:179], v[184:187], a[108:111]
    ds_read_b128 a[216:219], v10 offset:49152
    v_cvt_pk_bf16_f32 v135, v210, v211
    v_mfma_f32_16x16x32_bf16 a[108:111], a[180:183], v[188:191], a[108:111]
    s_waitcnt lgkmcnt(3)
    buffer_load_dwordx4 v37, s[8:11], s40 offen offset:1024 lds
    v_mfma_f32_16x16x32_bf16 v[208:211], a[224:227], v[96:99], v[200:203]
    v_exp_f32 v212, v212
    v_mfma_f32_16x16x32_bf16 v[208:211], a[228:231], v[100:103], v[208:211]
    v_exp_f32 v213, v213
    v_mfma_f32_16x16x32_bf16 v[208:211], a[232:235], v[104:107], v[208:211]
    v_exp_f32 v214, v214
    v_mfma_f32_16x16x32_bf16 v[208:211], a[236:239], v[108:111], v[208:211]
    v_exp_f32 v215, v215
    v_mfma_f32_16x16x32_bf16 a[112:115], a[184:187], v[160:163], a[112:115]
    ds_read_b64_tr_b16 a[164:165], v20 offset:40960
    v_cvt_pk_bf16_f32 v142, v212, v213
    v_mfma_f32_16x16x32_bf16 a[112:115], a[188:191], v[164:167], a[112:115]
    ds_read_b64_tr_b16 a[166:167], v20 offset:45056
    v_mfma_f32_16x16x32_bf16 a[116:119], a[184:187], v[168:171], a[116:119]
    ds_read_b128 a[220:223], v11 offset:49152
    v_cvt_pk_bf16_f32 v143, v214, v215
    v_mfma_f32_16x16x32_bf16 a[116:119], a[188:191], v[172:175], a[116:119]
    v_mfma_f32_16x16x32_bf16 v[212:215], a[224:227], v[112:115], v[204:207]
    v_exp_f32 v208, v208
    v_mfma_f32_16x16x32_bf16 v[212:215], a[228:231], v[116:119], v[212:215]
    v_exp_f32 v209, v209
    v_mfma_f32_16x16x32_bf16 v[212:215], a[232:235], v[120:123], v[212:215]
    v_exp_f32 v210, v210
    v_mfma_f32_16x16x32_bf16 v[212:215], a[236:239], v[124:127], v[212:215]
    v_exp_f32 v211, v211
    v_mfma_f32_16x16x32_bf16 a[120:123], a[184:187], v[176:179], a[120:123]
    ds_read_b64_tr_b16 a[168:169], v21 offset:32768
    v_cvt_pk_bf16_f32 v150, v208, v209
    v_mfma_f32_16x16x32_bf16 a[120:123], a[188:191], v[180:183], a[120:123]
    ds_read_b64_tr_b16 a[170:171], v21 offset:36864
    v_mfma_f32_16x16x32_bf16 a[124:127], a[184:187], v[184:187], a[124:127]
    ds_read_b128 a[224:227], v8 offset:53248
    v_cvt_pk_bf16_f32 v151, v210, v211
    v_mfma_f32_16x16x32_bf16 a[124:127], a[188:191], v[188:191], a[124:127]
    s_waitcnt lgkmcnt(3)
    buffer_load_dwordx4 v38, s[8:11], s40 offen offset:2048 lds
    v_mfma_f32_16x16x32_bf16 v[208:211], a[208:211], v[64:67], v[192:195]
    v_exp_f32 v212, v212
    v_mfma_f32_16x16x32_bf16 v[208:211], a[212:215], v[68:71], v[208:211]
    v_exp_f32 v213, v213
    v_mfma_f32_16x16x32_bf16 v[208:211], a[216:219], v[72:75], v[208:211]
    v_exp_f32 v214, v214
    v_mfma_f32_16x16x32_bf16 v[208:211], a[220:223], v[76:79], v[208:211]
    v_exp_f32 v215, v215
    v_mfma_f32_16x16x32_bf16 a[0:3], a[160:163], v[128:131], a[0:3]
    ds_read_b64_tr_b16 a[172:173], v21 offset:40960
    v_cvt_pk_bf16_f32 v158, v212, v213
    v_mfma_f32_16x16x32_bf16 a[0:3], a[164:167], v[132:135], a[0:3]
    ds_read_b64_tr_b16 a[174:175], v21 offset:45056
    v_mfma_f32_16x16x32_bf16 a[4:7], a[160:163], v[136:139], a[4:7]
    ds_read_b128 a[228:231], v9 offset:53248
    v_cvt_pk_bf16_f32 v159, v214, v215
    v_mfma_f32_16x16x32_bf16 a[4:7], a[164:167], v[140:143], a[4:7]
    v_mfma_f32_16x16x32_bf16 v[212:215], a[208:211], v[80:83], v[196:199]
    v_exp_f32 v208, v208
    v_mfma_f32_16x16x32_bf16 v[212:215], a[212:215], v[84:87], v[212:215]
    v_exp_f32 v209, v209
    v_mfma_f32_16x16x32_bf16 v[212:215], a[216:219], v[88:91], v[212:215]
    v_exp_f32 v210, v210
    v_mfma_f32_16x16x32_bf16 v[212:215], a[220:223], v[92:95], v[212:215]
    v_exp_f32 v211, v211
    v_mfma_f32_16x16x32_bf16 a[8:11], a[160:163], v[144:147], a[8:11]
    ds_read_b64_tr_b16 a[176:177], v22 offset:32768
    v_cvt_pk_bf16_f32 v160, v208, v209
    v_mfma_f32_16x16x32_bf16 a[8:11], a[164:167], v[148:151], a[8:11]
    ds_read_b64_tr_b16 a[178:179], v22 offset:36864
    v_mfma_f32_16x16x32_bf16 a[12:15], a[160:163], v[152:155], a[12:15]
    ds_read_b128 a[232:235], v10 offset:53248
    v_cvt_pk_bf16_f32 v161, v210, v211
    v_mfma_f32_16x16x32_bf16 a[12:15], a[164:167], v[156:159], a[12:15]
    s_waitcnt lgkmcnt(3)
    buffer_load_dwordx4 v39, s[8:11], s40 offen offset:3072 lds
    v_mfma_f32_16x16x32_bf16 v[208:211], a[208:211], v[96:99], v[200:203]
    v_exp_f32 v212, v212
    v_mfma_f32_16x16x32_bf16 v[208:211], a[212:215], v[100:103], v[208:211]
    s_add_u32 s40, s40, 16384
    v_exp_f32 v213, v213
    v_mfma_f32_16x16x32_bf16 v[208:211], a[216:219], v[104:107], v[208:211]
    v_exp_f32 v214, v214
    v_mfma_f32_16x16x32_bf16 v[208:211], a[220:223], v[108:111], v[208:211]
    v_exp_f32 v215, v215
    v_mfma_f32_16x16x32_bf16 a[16:19], a[168:171], v[128:131], a[16:19]
    ds_read_b64_tr_b16 a[180:181], v22 offset:40960
    v_cvt_pk_bf16_f32 v168, v212, v213
    v_mfma_f32_16x16x32_bf16 a[16:19], a[172:175], v[132:135], a[16:19]
    ds_read_b64_tr_b16 a[182:183], v22 offset:45056
    v_mfma_f32_16x16x32_bf16 a[20:23], a[168:171], v[136:139], a[20:23]
    ds_read_b128 a[236:239], v11 offset:53248
    v_cvt_pk_bf16_f32 v169, v214, v215
    v_mfma_f32_16x16x32_bf16 a[20:23], a[172:175], v[140:143], a[20:23]
    v_smfmac_f32_16x16x64_bf16 a[192:195], v[52:55], v[128:135], v50
    v_mfma_f32_16x16x32_bf16 v[212:215], a[208:211], v[112:115], v[204:207]
    v_exp_f32 v208, v208
    v_mfma_f32_16x16x32_bf16 v[212:215], a[212:215], v[116:119], v[212:215]
    s_add_u32 m0, s42, 65536
    v_exp_f32 v209, v209
    v_mfma_f32_16x16x32_bf16 v[212:215], a[216:219], v[120:123], v[212:215]
    v_exp_f32 v210, v210
    v_mfma_f32_16x16x32_bf16 v[212:215], a[220:223], v[124:127], v[212:215]
    v_exp_f32 v211, v211
    v_mfma_f32_16x16x32_bf16 a[24:27], a[168:171], v[144:147], a[24:27]
    ds_read_b64_tr_b16 a[184:185], v23 offset:32768
    v_cvt_pk_bf16_f32 v176, v208, v209
    v_mfma_f32_16x16x32_bf16 a[24:27], a[172:175], v[148:151], a[24:27]
    ds_read_b64_tr_b16 a[186:187], v23 offset:36864
    v_mfma_f32_16x16x32_bf16 a[28:31], a[168:171], v[152:155], a[28:31]
    ds_read_b128 a[208:211], v8 offset:57344
    v_cvt_pk_bf16_f32 v177, v210, v211
    v_mfma_f32_16x16x32_bf16 a[28:31], a[172:175], v[156:159], a[28:31]
    s_waitcnt lgkmcnt(3)
    buffer_load_dwordx4 v40, s[12:15], s41 offen lds
    v_mfma_f32_16x16x32_bf16 v[208:211], a[224:227], v[64:67], v[192:195]
    v_exp_f32 v212, v212
    v_mfma_f32_16x16x32_bf16 v[208:211], a[228:231], v[68:71], v[208:211]
    v_exp_f32 v213, v213
    v_mfma_f32_16x16x32_bf16 v[208:211], a[232:235], v[72:75], v[208:211]
    v_exp_f32 v214, v214
    v_mfma_f32_16x16x32_bf16 v[208:211], a[236:239], v[76:79], v[208:211]
    v_exp_f32 v215, v215
    v_mfma_f32_16x16x32_bf16 a[32:35], a[176:179], v[128:131], a[32:35]
    ds_read_b64_tr_b16 a[188:189], v23 offset:40960
    v_cvt_pk_bf16_f32 v184, v212, v213
    v_mfma_f32_16x16x32_bf16 a[32:35], a[180:183], v[132:135], a[32:35]
    ds_read_b64_tr_b16 a[190:191], v23 offset:45056
    v_mfma_f32_16x16x32_bf16 a[36:39], a[176:179], v[136:139], a[36:39]
    ds_read_b128 a[212:215], v9 offset:57344
    v_cvt_pk_bf16_f32 v185, v214, v215
    v_mfma_f32_16x16x32_bf16 a[36:39], a[180:183], v[140:143], a[36:39]
    v_smfmac_f32_16x16x64_bf16 a[196:199], v[52:55], v[136:143], v50
    v_mfma_f32_16x16x32_bf16 v[212:215], a[224:227], v[80:83], v[196:199]
    v_exp_f32 v208, v208
    v_mfma_f32_16x16x32_bf16 v[212:215], a[228:231], v[84:87], v[212:215]
    v_exp_f32 v209, v209
    v_mfma_f32_16x16x32_bf16 v[212:215], a[232:235], v[88:91], v[212:215]
    v_exp_f32 v210, v210
    v_mfma_f32_16x16x32_bf16 v[212:215], a[236:239], v[92:95], v[212:215]
    v_exp_f32 v211, v211
    v_mfma_f32_16x16x32_bf16 a[40:43], a[176:179], v[144:147], a[40:43]
    ds_read_b64_tr_b16 a[160:161], v24 offset:32768
    v_cvt_pk_bf16_f32 v162, v208, v209
    v_mfma_f32_16x16x32_bf16 a[40:43], a[180:183], v[148:151], a[40:43]
    ds_read_b64_tr_b16 a[162:163], v24 offset:36864
    v_mfma_f32_16x16x32_bf16 a[44:47], a[176:179], v[152:155], a[44:47]
    ds_read_b128 a[216:219], v10 offset:57344
    v_cvt_pk_bf16_f32 v163, v210, v211
    v_mfma_f32_16x16x32_bf16 a[44:47], a[180:183], v[156:159], a[44:47]
    s_waitcnt lgkmcnt(3)
    buffer_load_dwordx4 v41, s[12:15], s41 offen offset:1024 lds
    v_mfma_f32_16x16x32_bf16 v[208:211], a[224:227], v[96:99], v[200:203]
    v_exp_f32 v212, v212
    v_mfma_f32_16x16x32_bf16 v[208:211], a[228:231], v[100:103], v[208:211]
    v_exp_f32 v213, v213
    v_mfma_f32_16x16x32_bf16 v[208:211], a[232:235], v[104:107], v[208:211]
    v_exp_f32 v214, v214
    v_mfma_f32_16x16x32_bf16 v[208:211], a[236:239], v[108:111], v[208:211]
    v_exp_f32 v215, v215
    v_mfma_f32_16x16x32_bf16 a[48:51], a[184:187], v[128:131], a[48:51]
    ds_read_b64_tr_b16 a[164:165], v24 offset:40960
    v_cvt_pk_bf16_f32 v170, v212, v213
    v_mfma_f32_16x16x32_bf16 a[48:51], a[188:191], v[132:135], a[48:51]
    ds_read_b64_tr_b16 a[166:167], v24 offset:45056
    v_mfma_f32_16x16x32_bf16 a[52:55], a[184:187], v[136:139], a[52:55]
    ds_read_b128 a[220:223], v11 offset:57344
    v_cvt_pk_bf16_f32 v171, v214, v215
    v_mfma_f32_16x16x32_bf16 a[52:55], a[188:191], v[140:143], a[52:55]
    v_smfmac_f32_16x16x64_bf16 a[200:203], v[52:55], v[144:151], v50
    v_mfma_f32_16x16x32_bf16 v[212:215], a[224:227], v[112:115], v[204:207]
    v_exp_f32 v208, v208
    v_mfma_f32_16x16x32_bf16 v[212:215], a[228:231], v[116:119], v[212:215]
    v_exp_f32 v209, v209
    v_mfma_f32_16x16x32_bf16 v[212:215], a[232:235], v[120:123], v[212:215]
    v_exp_f32 v210, v210
    v_mfma_f32_16x16x32_bf16 v[212:215], a[236:239], v[124:127], v[212:215]
    v_exp_f32 v211, v211
    v_mfma_f32_16x16x32_bf16 a[56:59], a[184:187], v[144:147], a[56:59]
    ds_read_b64_tr_b16 a[168:169], v25 offset:32768
    v_cvt_pk_bf16_f32 v178, v208, v209
    v_mfma_f32_16x16x32_bf16 a[56:59], a[188:191], v[148:151], a[56:59]
    ds_read_b64_tr_b16 a[170:171], v25 offset:36864
    v_mfma_f32_16x16x32_bf16 a[60:63], a[184:187], v[152:155], a[60:63]
    ds_read_b128 a[224:227], v8 offset:61440
    v_cvt_pk_bf16_f32 v179, v210, v211
    v_mfma_f32_16x16x32_bf16 a[60:63], a[188:191], v[156:159], a[60:63]
    s_waitcnt lgkmcnt(3)
    buffer_load_dwordx4 v40, s[12:15], s41 offen offset:2048 lds
    v_mfma_f32_16x16x32_bf16 v[208:211], a[208:211], v[64:67], v[192:195]
    v_exp_f32 v212, v212
    v_mfma_f32_16x16x32_bf16 v[208:211], a[212:215], v[68:71], v[208:211]
    v_exp_f32 v213, v213
    v_mfma_f32_16x16x32_bf16 v[208:211], a[216:219], v[72:75], v[208:211]
    v_exp_f32 v214, v214
    v_mfma_f32_16x16x32_bf16 v[208:211], a[220:223], v[76:79], v[208:211]
    v_exp_f32 v215, v215
    v_mfma_f32_16x16x32_bf16 a[64:67], a[160:163], v[128:131], a[64:67]
    ds_read_b64_tr_b16 a[172:173], v25 offset:40960
    v_cvt_pk_bf16_f32 v186, v212, v213
    v_mfma_f32_16x16x32_bf16 a[64:67], a[164:167], v[132:135], a[64:67]
    ds_read_b64_tr_b16 a[174:175], v25 offset:45056
    v_mfma_f32_16x16x32_bf16 a[68:71], a[160:163], v[136:139], a[68:71]
    ds_read_b128 a[228:231], v9 offset:61440
    v_cvt_pk_bf16_f32 v187, v214, v215
    v_mfma_f32_16x16x32_bf16 a[68:71], a[164:167], v[140:143], a[68:71]
    v_smfmac_f32_16x16x64_bf16 a[204:207], v[52:55], v[152:159], v50
    v_mfma_f32_16x16x32_bf16 v[212:215], a[208:211], v[80:83], v[196:199]
    v_exp_f32 v208, v208
    v_mfma_f32_16x16x32_bf16 v[212:215], a[212:215], v[84:87], v[212:215]
    v_exp_f32 v209, v209
    v_mfma_f32_16x16x32_bf16 v[212:215], a[216:219], v[88:91], v[212:215]
    v_exp_f32 v210, v210
    v_mfma_f32_16x16x32_bf16 v[212:215], a[220:223], v[92:95], v[212:215]
    v_exp_f32 v211, v211
    v_mfma_f32_16x16x32_bf16 a[72:75], a[160:163], v[144:147], a[72:75]
    ds_read_b64_tr_b16 a[176:177], v26 offset:32768
    v_cvt_pk_bf16_f32 v164, v208, v209
    v_mfma_f32_16x16x32_bf16 a[72:75], a[164:167], v[148:151], a[72:75]
    ds_read_b64_tr_b16 a[178:179], v26 offset:36864
    v_mfma_f32_16x16x32_bf16 a[76:79], a[160:163], v[152:155], a[76:79]
    ds_read_b128 a[232:235], v10 offset:61440
    v_cvt_pk_bf16_f32 v165, v210, v211
    v_mfma_f32_16x16x32_bf16 a[76:79], a[164:167], v[156:159], a[76:79]
    s_waitcnt lgkmcnt(3)
    buffer_load_dwordx4 v41, s[12:15], s41 offen offset:3072 lds
    v_mfma_f32_16x16x32_bf16 v[208:211], a[208:211], v[96:99], v[200:203]
    v_exp_f32 v212, v212
    v_mfma_f32_16x16x32_bf16 v[208:211], a[212:215], v[100:103], v[208:211]
    s_add_u32 s41, s41, 16384
    v_exp_f32 v213, v213
    v_mfma_f32_16x16x32_bf16 v[208:211], a[216:219], v[104:107], v[208:211]
    v_exp_f32 v214, v214
    v_mfma_f32_16x16x32_bf16 v[208:211], a[220:223], v[108:111], v[208:211]
    v_exp_f32 v215, v215
    v_mfma_f32_16x16x32_bf16 a[80:83], a[168:171], v[128:131], a[80:83]
    ds_read_b64_tr_b16 a[180:181], v26 offset:40960
    v_cvt_pk_bf16_f32 v172, v212, v213
    v_mfma_f32_16x16x32_bf16 a[80:83], a[172:175], v[132:135], a[80:83]
    ds_read_b64_tr_b16 a[182:183], v26 offset:45056
    v_mfma_f32_16x16x32_bf16 a[84:87], a[168:171], v[136:139], a[84:87]
    ds_read_b128 a[236:239], v11 offset:61440
    v_cvt_pk_bf16_f32 v173, v214, v215
    v_mfma_f32_16x16x32_bf16 a[84:87], a[172:175], v[140:143], a[84:87]
    s_waitcnt vmcnt(9)
    s_barrier
    v_mfma_f32_16x16x32_bf16 v[212:215], a[208:211], v[112:115], v[204:207]
    v_exp_f32 v208, v208
    v_mfma_f32_16x16x32_bf16 v[212:215], a[212:215], v[116:119], v[212:215]
    s_add_u32 m0, s42, 32768
    v_exp_f32 v209, v209
    v_mfma_f32_16x16x32_bf16 v[212:215], a[216:219], v[120:123], v[212:215]
    v_exp_f32 v210, v210
    v_mfma_f32_16x16x32_bf16 v[212:215], a[220:223], v[124:127], v[212:215]
    v_exp_f32 v211, v211
    v_mfma_f32_16x16x32_bf16 a[88:91], a[168:171], v[144:147], a[88:91]
    ds_read_b64_tr_b16 a[184:185], v27 offset:32768
    v_cvt_pk_bf16_f32 v180, v208, v209
    v_mfma_f32_16x16x32_bf16 a[88:91], a[172:175], v[148:151], a[88:91]
    ds_read_b64_tr_b16 a[186:187], v27 offset:36864
    v_mfma_f32_16x16x32_bf16 a[92:95], a[168:171], v[152:155], a[92:95]
    ds_read_b128 a[208:211], v8 offset:0
    v_cvt_pk_bf16_f32 v181, v210, v211
    v_mfma_f32_16x16x32_bf16 a[92:95], a[172:175], v[156:159], a[92:95]
    s_waitcnt lgkmcnt(3)
    buffer_load_dwordx4 v36, s[8:11], s40 offen lds
    v_mfma_f32_16x16x32_bf16 v[208:211], a[224:227], v[64:67], v[192:195]
    v_exp_f32 v212, v212
    v_mfma_f32_16x16x32_bf16 v[208:211], a[228:231], v[68:71], v[208:211]
    v_exp_f32 v213, v213
    v_mfma_f32_16x16x32_bf16 v[208:211], a[232:235], v[72:75], v[208:211]
    v_exp_f32 v214, v214
    v_mfma_f32_16x16x32_bf16 v[208:211], a[236:239], v[76:79], v[208:211]
    v_exp_f32 v215, v215
    v_mfma_f32_16x16x32_bf16 a[96:99], a[176:179], v[128:131], a[96:99]
    ds_read_b64_tr_b16 a[188:189], v27 offset:40960
    v_cvt_pk_bf16_f32 v188, v212, v213
    v_mfma_f32_16x16x32_bf16 a[96:99], a[180:183], v[132:135], a[96:99]
    ds_read_b64_tr_b16 a[190:191], v27 offset:45056
    v_mfma_f32_16x16x32_bf16 a[100:103], a[176:179], v[136:139], a[100:103]
    ds_read_b128 a[212:215], v9 offset:0
    v_cvt_pk_bf16_f32 v189, v214, v215
    v_mfma_f32_16x16x32_bf16 a[100:103], a[180:183], v[140:143], a[100:103]
    buffer_load_dword v219, v62, s[84:87], s38 offen
    v_mfma_f32_16x16x32_bf16 v[212:215], a[224:227], v[80:83], v[196:199]
    v_exp_f32 v208, v208
    v_mfma_f32_16x16x32_bf16 v[212:215], a[228:231], v[84:87], v[212:215]
    v_exp_f32 v209, v209
    v_mfma_f32_16x16x32_bf16 v[212:215], a[232:235], v[88:91], v[212:215]
    v_exp_f32 v210, v210
    v_mfma_f32_16x16x32_bf16 v[212:215], a[236:239], v[92:95], v[212:215]
    v_exp_f32 v211, v211
    v_mfma_f32_16x16x32_bf16 a[104:107], a[176:179], v[144:147], a[104:107]
    ds_read_b64_tr_b16 a[160:161], v20 offset:49152
    v_cvt_pk_bf16_f32 v166, v208, v209
    v_mfma_f32_16x16x32_bf16 a[104:107], a[180:183], v[148:151], a[104:107]
    ds_read_b64_tr_b16 a[162:163], v20 offset:53248
    v_mfma_f32_16x16x32_bf16 a[108:111], a[176:179], v[152:155], a[108:111]
    ds_read_b128 a[216:219], v10 offset:0
    v_cvt_pk_bf16_f32 v167, v210, v211
    v_mfma_f32_16x16x32_bf16 a[108:111], a[180:183], v[156:159], a[108:111]
    s_waitcnt lgkmcnt(3)
    buffer_load_dwordx4 v37, s[8:11], s40 offen offset:1024 lds
    v_mfma_f32_16x16x32_bf16 v[208:211], a[224:227], v[96:99], v[200:203]
    v_exp_f32 v212, v212
    v_mfma_f32_16x16x32_bf16 v[208:211], a[228:231], v[100:103], v[208:211]
    v_exp_f32 v213, v213
    v_mfma_f32_16x16x32_bf16 v[208:211], a[232:235], v[104:107], v[208:211]
    v_exp_f32 v214, v214
    v_mfma_f32_16x16x32_bf16 v[208:211], a[236:239], v[108:111], v[208:211]
    v_exp_f32 v215, v215
    v_mfma_f32_16x16x32_bf16 a[112:115], a[184:187], v[128:131], a[112:115]
    ds_read_b64_tr_b16 a[164:165], v20 offset:57344
    v_cvt_pk_bf16_f32 v174, v212, v213
    v_mfma_f32_16x16x32_bf16 a[112:115], a[188:191], v[132:135], a[112:115]
    ds_read_b64_tr_b16 a[166:167], v20 offset:61440
    v_mfma_f32_16x16x32_bf16 a[116:119], a[184:187], v[136:139], a[116:119]
    ds_read_b128 a[220:223], v11 offset:0
    v_cvt_pk_bf16_f32 v175, v214, v215
    v_mfma_f32_16x16x32_bf16 a[116:119], a[188:191], v[140:143], a[116:119]
    v_mfma_f32_16x16x32_bf16 v[212:215], a[224:227], v[112:115], v[204:207]
    v_exp_f32 v208, v208
    v_mfma_f32_16x16x32_bf16 v[212:215], a[228:231], v[116:119], v[212:215]
    v_exp_f32 v209, v209
    v_mfma_f32_16x16x32_bf16 v[212:215], a[232:235], v[120:123], v[212:215]
    v_exp_f32 v210, v210
    v_mfma_f32_16x16x32_bf16 v[212:215], a[236:239], v[124:127], v[212:215]
    v_exp_f32 v211, v211
    v_mfma_f32_16x16x32_bf16 a[120:123], a[184:187], v[144:147], a[120:123]
    ds_read_b64_tr_b16 a[168:169], v21 offset:49152
    v_cvt_pk_bf16_f32 v182, v208, v209
    v_mfma_f32_16x16x32_bf16 a[120:123], a[188:191], v[148:151], a[120:123]
    ds_read_b64_tr_b16 a[170:171], v21 offset:53248
    v_mfma_f32_16x16x32_bf16 a[124:127], a[184:187], v[152:155], a[124:127]
    ds_read_b128 a[224:227], v8 offset:4096
    v_cvt_pk_bf16_f32 v183, v210, v211
    v_mfma_f32_16x16x32_bf16 a[124:127], a[188:191], v[156:159], a[124:127]
    s_waitcnt lgkmcnt(3)
    buffer_load_dwordx4 v38, s[8:11], s40 offen offset:2048 lds
    v_mfma_f32_16x16x32_bf16 v[208:211], a[208:211], v[64:67], v[192:195]
    v_exp_f32 v212, v212
    v_mfma_f32_16x16x32_bf16 v[208:211], a[212:215], v[68:71], v[208:211]
    v_exp_f32 v213, v213
    v_mfma_f32_16x16x32_bf16 v[208:211], a[216:219], v[72:75], v[208:211]
    v_exp_f32 v214, v214
    v_mfma_f32_16x16x32_bf16 v[208:211], a[220:223], v[76:79], v[208:211]
    v_exp_f32 v215, v215
    v_mfma_f32_16x16x32_bf16 a[0:3], a[160:163], v[160:163], a[0:3]
    ds_read_b64_tr_b16 a[172:173], v21 offset:57344
    v_cvt_pk_bf16_f32 v190, v212, v213
    v_mfma_f32_16x16x32_bf16 a[0:3], a[164:167], v[164:167], a[0:3]
    ds_read_b64_tr_b16 a[174:175], v21 offset:61440
    v_mfma_f32_16x16x32_bf16 a[4:7], a[160:163], v[168:171], a[4:7]
    ds_read_b128 a[228:231], v9 offset:4096
    v_cvt_pk_bf16_f32 v191, v214, v215
    v_mfma_f32_16x16x32_bf16 a[4:7], a[164:167], v[172:175], a[4:7]
    v_mfma_f32_16x16x32_bf16 v[212:215], a[208:211], v[80:83], v[196:199]
    v_exp_f32 v208, v208
    v_mfma_f32_16x16x32_bf16 v[212:215], a[212:215], v[84:87], v[212:215]
    v_exp_f32 v209, v209
    v_mfma_f32_16x16x32_bf16 v[212:215], a[216:219], v[88:91], v[212:215]
    v_exp_f32 v210, v210
    v_mfma_f32_16x16x32_bf16 v[212:215], a[220:223], v[92:95], v[212:215]
    v_exp_f32 v211, v211
    v_mfma_f32_16x16x32_bf16 a[8:11], a[160:163], v[176:179], a[8:11]
    ds_read_b64_tr_b16 a[176:177], v22 offset:49152
    v_cvt_pk_bf16_f32 v128, v208, v209
    v_mfma_f32_16x16x32_bf16 a[8:11], a[164:167], v[180:183], a[8:11]
    ds_read_b64_tr_b16 a[178:179], v22 offset:53248
    v_mfma_f32_16x16x32_bf16 a[12:15], a[160:163], v[184:187], a[12:15]
    ds_read_b128 a[232:235], v10 offset:4096
    v_cvt_pk_bf16_f32 v129, v210, v211
    v_mfma_f32_16x16x32_bf16 a[12:15], a[164:167], v[188:191], a[12:15]
    s_waitcnt lgkmcnt(3)
    buffer_load_dwordx4 v39, s[8:11], s40 offen offset:3072 lds
    v_mfma_f32_16x16x32_bf16 v[208:211], a[208:211], v[96:99], v[200:203]
    v_exp_f32 v212, v212
    v_mfma_f32_16x16x32_bf16 v[208:211], a[212:215], v[100:103], v[208:211]
    s_add_u32 s40, s40, 16384
    v_exp_f32 v213, v213
    v_mfma_f32_16x16x32_bf16 v[208:211], a[216:219], v[104:107], v[208:211]
    v_exp_f32 v214, v214
    v_mfma_f32_16x16x32_bf16 v[208:211], a[220:223], v[108:111], v[208:211]
    v_exp_f32 v215, v215
    v_mfma_f32_16x16x32_bf16 a[16:19], a[168:171], v[160:163], a[16:19]
    ds_read_b64_tr_b16 a[180:181], v22 offset:57344
    v_cvt_pk_bf16_f32 v136, v212, v213
    v_mfma_f32_16x16x32_bf16 a[16:19], a[172:175], v[164:167], a[16:19]
    ds_read_b64_tr_b16 a[182:183], v22 offset:61440
    v_mfma_f32_16x16x32_bf16 a[20:23], a[168:171], v[168:171], a[20:23]
    ds_read_b128 a[236:239], v11 offset:4096
    v_cvt_pk_bf16_f32 v137, v214, v215
    v_mfma_f32_16x16x32_bf16 a[20:23], a[172:175], v[172:175], a[20:23]
    v_smfmac_f32_16x16x64_bf16 a[192:195], v[52:55], v[160:167], v50
    v_mfma_f32_16x16x32_bf16 v[212:215], a[208:211], v[112:115], v[204:207]
    v_exp_f32 v208, v208
    v_mfma_f32_16x16x32_bf16 v[212:215], a[212:215], v[116:119], v[212:215]
    s_add_u32 m0, s42, 81920
    v_exp_f32 v209, v209
    v_mfma_f32_16x16x32_bf16 v[212:215], a[216:219], v[120:123], v[212:215]
    v_exp_f32 v210, v210
    v_mfma_f32_16x16x32_bf16 v[212:215], a[220:223], v[124:127], v[212:215]
    v_exp_f32 v211, v211
    v_mfma_f32_16x16x32_bf16 a[24:27], a[168:171], v[176:179], a[24:27]
    ds_read_b64_tr_b16 a[184:185], v23 offset:49152
    v_cvt_pk_bf16_f32 v144, v208, v209
    v_mfma_f32_16x16x32_bf16 a[24:27], a[172:175], v[180:183], a[24:27]
    ds_read_b64_tr_b16 a[186:187], v23 offset:53248
    v_mfma_f32_16x16x32_bf16 a[28:31], a[168:171], v[184:187], a[28:31]
    ds_read_b128 a[208:211], v8 offset:8192
    v_cvt_pk_bf16_f32 v145, v210, v211
    v_mfma_f32_16x16x32_bf16 a[28:31], a[172:175], v[188:191], a[28:31]
    s_waitcnt lgkmcnt(3)
    buffer_load_dwordx4 v40, s[12:15], s41 offen lds
    v_mfma_f32_16x16x32_bf16 v[208:211], a[224:227], v[64:67], v[192:195]
    v_exp_f32 v212, v212
    v_mfma_f32_16x16x32_bf16 v[208:211], a[228:231], v[68:71], v[208:211]
    v_exp_f32 v213, v213
    v_mfma_f32_16x16x32_bf16 v[208:211], a[232:235], v[72:75], v[208:211]
    v_exp_f32 v214, v214
    v_mfma_f32_16x16x32_bf16 v[208:211], a[236:239], v[76:79], v[208:211]
    v_exp_f32 v215, v215
    v_mfma_f32_16x16x32_bf16 a[32:35], a[176:179], v[160:163], a[32:35]
    ds_read_b64_tr_b16 a[188:189], v23 offset:57344
    v_cvt_pk_bf16_f32 v152, v212, v213
    v_mfma_f32_16x16x32_bf16 a[32:35], a[180:183], v[164:167], a[32:35]
    ds_read_b64_tr_b16 a[190:191], v23 offset:61440
    v_mfma_f32_16x16x32_bf16 a[36:39], a[176:179], v[168:171], a[36:39]
    ds_read_b128 a[212:215], v9 offset:8192
    v_cvt_pk_bf16_f32 v153, v214, v215
    v_mfma_f32_16x16x32_bf16 a[36:39], a[180:183], v[172:175], a[36:39]
    v_smfmac_f32_16x16x64_bf16 a[196:199], v[52:55], v[168:175], v50
    v_mfma_f32_16x16x32_bf16 v[212:215], a[224:227], v[80:83], v[196:199]
    v_exp_f32 v208, v208
    v_mfma_f32_16x16x32_bf16 v[212:215], a[228:231], v[84:87], v[212:215]
    v_exp_f32 v209, v209
    v_mfma_f32_16x16x32_bf16 v[212:215], a[232:235], v[88:91], v[212:215]
    v_exp_f32 v210, v210
    v_mfma_f32_16x16x32_bf16 v[212:215], a[236:239], v[92:95], v[212:215]
    v_exp_f32 v211, v211
    v_mfma_f32_16x16x32_bf16 a[40:43], a[176:179], v[176:179], a[40:43]
    ds_read_b64_tr_b16 a[160:161], v24 offset:49152
    v_cvt_pk_bf16_f32 v130, v208, v209
    v_mfma_f32_16x16x32_bf16 a[40:43], a[180:183], v[180:183], a[40:43]
    ds_read_b64_tr_b16 a[162:163], v24 offset:53248
    v_mfma_f32_16x16x32_bf16 a[44:47], a[176:179], v[184:187], a[44:47]
    ds_read_b128 a[216:219], v10 offset:8192
    v_cvt_pk_bf16_f32 v131, v210, v211
    v_mfma_f32_16x16x32_bf16 a[44:47], a[180:183], v[188:191], a[44:47]
    s_waitcnt lgkmcnt(3)
    buffer_load_dwordx4 v41, s[12:15], s41 offen offset:1024 lds
    v_mfma_f32_16x16x32_bf16 v[208:211], a[224:227], v[96:99], v[200:203]
    v_exp_f32 v212, v212
    v_mfma_f32_16x16x32_bf16 v[208:211], a[228:231], v[100:103], v[208:211]
    v_exp_f32 v213, v213
    v_mfma_f32_16x16x32_bf16 v[208:211], a[232:235], v[104:107], v[208:211]
    v_exp_f32 v214, v214
    v_mfma_f32_16x16x32_bf16 v[208:211], a[236:239], v[108:111], v[208:211]
    v_exp_f32 v215, v215
    v_mfma_f32_16x16x32_bf16 a[48:51], a[184:187], v[160:163], a[48:51]
    ds_read_b64_tr_b16 a[164:165], v24 offset:57344
    v_cvt_pk_bf16_f32 v138, v212, v213
    v_mfma_f32_16x16x32_bf16 a[48:51], a[188:191], v[164:167], a[48:51]
    ds_read_b64_tr_b16 a[166:167], v24 offset:61440
    v_mfma_f32_16x16x32_bf16 a[52:55], a[184:187], v[168:171], a[52:55]
    ds_read_b128 a[220:223], v11 offset:8192
    v_cvt_pk_bf16_f32 v139, v214, v215
    v_mfma_f32_16x16x32_bf16 a[52:55], a[188:191], v[172:175], a[52:55]
    v_smfmac_f32_16x16x64_bf16 a[200:203], v[52:55], v[176:183], v50
    v_mfma_f32_16x16x32_bf16 v[212:215], a[224:227], v[112:115], v[204:207]
    v_exp_f32 v208, v208
    v_mfma_f32_16x16x32_bf16 v[212:215], a[228:231], v[116:119], v[212:215]
    v_exp_f32 v209, v209
    v_mfma_f32_16x16x32_bf16 v[212:215], a[232:235], v[120:123], v[212:215]
    v_exp_f32 v210, v210
    v_mfma_f32_16x16x32_bf16 v[212:215], a[236:239], v[124:127], v[212:215]
    v_exp_f32 v211, v211
    v_mfma_f32_16x16x32_bf16 a[56:59], a[184:187], v[176:179], a[56:59]
    ds_read_b64_tr_b16 a[168:169], v25 offset:49152
    v_cvt_pk_bf16_f32 v146, v208, v209
    v_mfma_f32_16x16x32_bf16 a[56:59], a[188:191], v[180:183], a[56:59]
    ds_read_b64_tr_b16 a[170:171], v25 offset:53248
    v_mfma_f32_16x16x32_bf16 a[60:63], a[184:187], v[184:187], a[60:63]
    ds_read_b128 a[224:227], v8 offset:12288
    v_cvt_pk_bf16_f32 v147, v210, v211
    v_mfma_f32_16x16x32_bf16 a[60:63], a[188:191], v[188:191], a[60:63]
    s_waitcnt lgkmcnt(3)
    buffer_load_dwordx4 v40, s[12:15], s41 offen offset:2048 lds
    v_mfma_f32_16x16x32_bf16 v[208:211], a[208:211], v[64:67], v[192:195]
    v_exp_f32 v212, v212
    v_mfma_f32_16x16x32_bf16 v[208:211], a[212:215], v[68:71], v[208:211]
    v_exp_f32 v213, v213
    v_mfma_f32_16x16x32_bf16 v[208:211], a[216:219], v[72:75], v[208:211]
    v_exp_f32 v214, v214
    v_mfma_f32_16x16x32_bf16 v[208:211], a[220:223], v[76:79], v[208:211]
    v_exp_f32 v215, v215
    v_mfma_f32_16x16x32_bf16 a[64:67], a[160:163], v[160:163], a[64:67]
    ds_read_b64_tr_b16 a[172:173], v25 offset:57344
    v_cvt_pk_bf16_f32 v154, v212, v213
    v_mfma_f32_16x16x32_bf16 a[64:67], a[164:167], v[164:167], a[64:67]
    ds_read_b64_tr_b16 a[174:175], v25 offset:61440
    v_mfma_f32_16x16x32_bf16 a[68:71], a[160:163], v[168:171], a[68:71]
    ds_read_b128 a[228:231], v9 offset:12288
    v_cvt_pk_bf16_f32 v155, v214, v215
    v_mfma_f32_16x16x32_bf16 a[68:71], a[164:167], v[172:175], a[68:71]
    v_smfmac_f32_16x16x64_bf16 a[204:207], v[52:55], v[184:191], v50
    v_mfma_f32_16x16x32_bf16 v[212:215], a[208:211], v[80:83], v[196:199]
    v_exp_f32 v208, v208
    v_mfma_f32_16x16x32_bf16 v[212:215], a[212:215], v[84:87], v[212:215]
    v_exp_f32 v209, v209
    v_mfma_f32_16x16x32_bf16 v[212:215], a[216:219], v[88:91], v[212:215]
    v_exp_f32 v210, v210
    v_mfma_f32_16x16x32_bf16 v[212:215], a[220:223], v[92:95], v[212:215]
    v_exp_f32 v211, v211
    v_mfma_f32_16x16x32_bf16 a[72:75], a[160:163], v[176:179], a[72:75]
    ds_read_b64_tr_b16 a[176:177], v26 offset:49152
    v_cvt_pk_bf16_f32 v132, v208, v209
    v_mfma_f32_16x16x32_bf16 a[72:75], a[164:167], v[180:183], a[72:75]
    ds_read_b64_tr_b16 a[178:179], v26 offset:53248
    v_mfma_f32_16x16x32_bf16 a[76:79], a[160:163], v[184:187], a[76:79]
    ds_read_b128 a[232:235], v10 offset:12288
    v_cvt_pk_bf16_f32 v133, v210, v211
    v_mfma_f32_16x16x32_bf16 a[76:79], a[164:167], v[188:191], a[76:79]
    s_waitcnt lgkmcnt(3)
    buffer_load_dwordx4 v41, s[12:15], s41 offen offset:3072 lds
    v_mfma_f32_16x16x32_bf16 v[208:211], a[208:211], v[96:99], v[200:203]
    v_exp_f32 v212, v212
    v_mfma_f32_16x16x32_bf16 v[208:211], a[212:215], v[100:103], v[208:211]
    s_add_u32 s41, s41, 16384
    v_exp_f32 v213, v213
    v_mfma_f32_16x16x32_bf16 v[208:211], a[216:219], v[104:107], v[208:211]
    v_exp_f32 v214, v214
    v_mfma_f32_16x16x32_bf16 v[208:211], a[220:223], v[108:111], v[208:211]
    v_exp_f32 v215, v215
    v_mfma_f32_16x16x32_bf16 a[80:83], a[168:171], v[160:163], a[80:83]
    ds_read_b64_tr_b16 a[180:181], v26 offset:57344
    v_cvt_pk_bf16_f32 v140, v212, v213
    v_mfma_f32_16x16x32_bf16 a[80:83], a[172:175], v[164:167], a[80:83]
    ds_read_b64_tr_b16 a[182:183], v26 offset:61440
    v_mfma_f32_16x16x32_bf16 a[84:87], a[168:171], v[168:171], a[84:87]
    ds_read_b128 a[236:239], v11 offset:12288
    v_cvt_pk_bf16_f32 v141, v214, v215
    v_mfma_f32_16x16x32_bf16 a[84:87], a[172:175], v[172:175], a[84:87]
    s_waitcnt vmcnt(9)
    s_barrier
    v_mfma_f32_16x16x32_bf16 v[212:215], a[208:211], v[112:115], v[204:207]
    v_exp_f32 v208, v208
    v_mfma_f32_16x16x32_bf16 v[212:215], a[212:215], v[116:119], v[212:215]
    s_add_u32 m0, s42, 49152
    v_exp_f32 v209, v209
    v_mfma_f32_16x16x32_bf16 v[212:215], a[216:219], v[120:123], v[212:215]
    v_exp_f32 v210, v210
    v_mfma_f32_16x16x32_bf16 v[212:215], a[220:223], v[124:127], v[212:215]
    v_exp_f32 v211, v211
    v_mfma_f32_16x16x32_bf16 a[88:91], a[168:171], v[176:179], a[88:91]
    ds_read_b64_tr_b16 a[184:185], v27 offset:49152
    v_cvt_pk_bf16_f32 v148, v208, v209
    v_mfma_f32_16x16x32_bf16 a[88:91], a[172:175], v[180:183], a[88:91]
    ds_read_b64_tr_b16 a[186:187], v27 offset:53248
    v_mfma_f32_16x16x32_bf16 a[92:95], a[168:171], v[184:187], a[92:95]
    ds_read_b128 a[208:211], v8 offset:16384
    v_cvt_pk_bf16_f32 v149, v210, v211
    v_mfma_f32_16x16x32_bf16 a[92:95], a[172:175], v[188:191], a[92:95]
    s_waitcnt lgkmcnt(3)
    buffer_load_dwordx4 v36, s[8:11], s40 offen lds
    v_mfma_f32_16x16x32_bf16 v[208:211], a[224:227], v[64:67], v[192:195]
    v_exp_f32 v212, v212
    v_mfma_f32_16x16x32_bf16 v[208:211], a[228:231], v[68:71], v[208:211]
    v_exp_f32 v213, v213
    v_mfma_f32_16x16x32_bf16 v[208:211], a[232:235], v[72:75], v[208:211]
    v_exp_f32 v214, v214
    v_mfma_f32_16x16x32_bf16 v[208:211], a[236:239], v[76:79], v[208:211]
    v_exp_f32 v215, v215
    v_mfma_f32_16x16x32_bf16 a[96:99], a[176:179], v[160:163], a[96:99]
    ds_read_b64_tr_b16 a[188:189], v27 offset:57344
    v_cvt_pk_bf16_f32 v156, v212, v213
    v_mfma_f32_16x16x32_bf16 a[96:99], a[180:183], v[164:167], a[96:99]
    ds_read_b64_tr_b16 a[190:191], v27 offset:61440
    v_mfma_f32_16x16x32_bf16 a[100:103], a[176:179], v[168:171], a[100:103]
    ds_read_b128 a[212:215], v9 offset:16384
    v_cvt_pk_bf16_f32 v157, v214, v215
    v_mfma_f32_16x16x32_bf16 a[100:103], a[180:183], v[172:175], a[100:103]
    v_mfma_f32_16x16x32_bf16 v[212:215], a[224:227], v[80:83], v[196:199]
    v_exp_f32 v208, v208
    v_mfma_f32_16x16x32_bf16 v[212:215], a[228:231], v[84:87], v[212:215]
    s_sub_u32 s39, s39, 36864
    v_exp_f32 v209, v209
    v_mfma_f32_16x16x32_bf16 v[212:215], a[232:235], v[88:91], v[212:215]
    s_sub_u32 s38, s38, 4608
    v_exp_f32 v210, v210
    v_mfma_f32_16x16x32_bf16 v[212:215], a[236:239], v[92:95], v[212:215]
    v_exp_f32 v211, v211
    v_mfma_f32_16x16x32_bf16 a[104:107], a[176:179], v[176:179], a[104:107]
    ds_read_b64_tr_b16 a[160:161], v20 offset:0
    v_cvt_pk_bf16_f32 v134, v208, v209
    v_mfma_f32_16x16x32_bf16 a[104:107], a[180:183], v[180:183], a[104:107]
    ds_read_b64_tr_b16 a[162:163], v20 offset:4096
    v_mfma_f32_16x16x32_bf16 a[108:111], a[176:179], v[184:187], a[108:111]
    ds_read_b128 a[216:219], v10 offset:16384
    v_cvt_pk_bf16_f32 v135, v210, v211
    v_mfma_f32_16x16x32_bf16 a[108:111], a[180:183], v[188:191], a[108:111]
    s_waitcnt lgkmcnt(3)
    buffer_load_dwordx4 v37, s[8:11], s40 offen offset:1024 lds
    v_mfma_f32_16x16x32_bf16 v[208:211], a[224:227], v[96:99], v[200:203]
    v_exp_f32 v212, v212
    v_mfma_f32_16x16x32_bf16 v[208:211], a[228:231], v[100:103], v[208:211]
    v_exp_f32 v213, v213
    v_mfma_f32_16x16x32_bf16 v[208:211], a[232:235], v[104:107], v[208:211]
    v_exp_f32 v214, v214
    v_mfma_f32_16x16x32_bf16 v[208:211], a[236:239], v[108:111], v[208:211]
    v_exp_f32 v215, v215
    v_mfma_f32_16x16x32_bf16 a[112:115], a[184:187], v[160:163], a[112:115]
    ds_read_b64_tr_b16 a[164:165], v20 offset:8192
    v_cvt_pk_bf16_f32 v142, v212, v213
    v_mfma_f32_16x16x32_bf16 a[112:115], a[188:191], v[164:167], a[112:115]
    ds_read_b64_tr_b16 a[166:167], v20 offset:12288
    v_mfma_f32_16x16x32_bf16 a[116:119], a[184:187], v[168:171], a[116:119]
    ds_read_b128 a[220:223], v11 offset:16384
    v_cvt_pk_bf16_f32 v143, v214, v215
    v_mfma_f32_16x16x32_bf16 a[116:119], a[188:191], v[172:175], a[116:119]
    v_mfma_f32_16x16x32_bf16 v[212:215], a[224:227], v[112:115], v[204:207]
    v_exp_f32 v208, v208
    v_mfma_f32_16x16x32_bf16 v[212:215], a[228:231], v[116:119], v[212:215]
    v_exp_f32 v209, v209
    v_mfma_f32_16x16x32_bf16 v[212:215], a[232:235], v[120:123], v[212:215]
    v_exp_f32 v210, v210
    v_mfma_f32_16x16x32_bf16 v[212:215], a[236:239], v[124:127], v[212:215]
    v_exp_f32 v211, v211
    v_mfma_f32_16x16x32_bf16 a[120:123], a[184:187], v[176:179], a[120:123]
    ds_read_b64_tr_b16 a[168:169], v21 offset:0
    v_cvt_pk_bf16_f32 v150, v208, v209
    v_mfma_f32_16x16x32_bf16 a[120:123], a[188:191], v[180:183], a[120:123]
    ds_read_b64_tr_b16 a[170:171], v21 offset:4096
    v_mfma_f32_16x16x32_bf16 a[124:127], a[184:187], v[184:187], a[124:127]
    ds_read_b128 a[224:227], v8 offset:20480
    v_cvt_pk_bf16_f32 v151, v210, v211
    v_mfma_f32_16x16x32_bf16 a[124:127], a[188:191], v[188:191], a[124:127]
    s_waitcnt lgkmcnt(3)
    buffer_load_dwordx4 v38, s[8:11], s40 offen offset:2048 lds
    s_sub_u32 s43, s43, 1
    s_cmp_lg_u32 s43, 0
    s_cbranch_scc1 Lattn_loop
    v_mfma_f32_16x16x32_bf16 v[208:211], a[208:211], v[64:67], v[192:195]
    v_exp_f32 v212, v212
    v_mfma_f32_16x16x32_bf16 v[208:211], a[212:215], v[68:71], v[208:211]
    v_exp_f32 v213, v213
    v_mfma_f32_16x16x32_bf16 v[208:211], a[216:219], v[72:75], v[208:211]
    v_exp_f32 v214, v214
    v_mfma_f32_16x16x32_bf16 v[208:211], a[220:223], v[76:79], v[208:211]
    s_add_u32 s57, s58, 0
    v_exp_f32 v215, v215
    v_mfma_f32_16x16x32_bf16 a[0:3], a[160:163], v[128:131], a[0:3]
    ds_read_b64_tr_b16 a[172:173], v21 offset:8192
    v_cvt_pk_bf16_f32 v158, v212, v213
    v_mfma_f32_16x16x32_bf16 a[0:3], a[164:167], v[132:135], a[0:3]
    ds_read_b64_tr_b16 a[174:175], v21 offset:12288
    v_mfma_f32_16x16x32_bf16 a[4:7], a[160:163], v[136:139], a[4:7]
    ds_read_b128 a[228:231], v9 offset:20480
    v_cvt_pk_bf16_f32 v159, v214, v215
    v_mfma_f32_16x16x32_bf16 a[4:7], a[164:167], v[140:143], a[4:7]
    buffer_load_dwordx4 a[128:131], v254, s[80:83], s57 offen
    v_mfma_f32_16x16x32_bf16 v[212:215], a[208:211], v[80:83], v[196:199]
    v_exp_f32 v208, v208
    v_mfma_f32_16x16x32_bf16 v[212:215], a[212:215], v[84:87], v[212:215]
    v_exp_f32 v209, v209
    v_mfma_f32_16x16x32_bf16 v[212:215], a[216:219], v[88:91], v[212:215]
    v_exp_f32 v210, v210
    v_mfma_f32_16x16x32_bf16 v[212:215], a[220:223], v[92:95], v[212:215]
    v_exp_f32 v211, v211
    v_mfma_f32_16x16x32_bf16 a[8:11], a[160:163], v[144:147], a[8:11]
    ds_read_b64_tr_b16 a[176:177], v22 offset:0
    v_cvt_pk_bf16_f32 v160, v208, v209
    v_mfma_f32_16x16x32_bf16 a[8:11], a[164:167], v[148:151], a[8:11]
    ds_read_b64_tr_b16 a[178:179], v22 offset:4096
    v_mfma_f32_16x16x32_bf16 a[12:15], a[160:163], v[152:155], a[12:15]
    ds_read_b128 a[232:235], v10 offset:20480
    v_cvt_pk_bf16_f32 v161, v210, v211
    v_mfma_f32_16x16x32_bf16 a[12:15], a[164:167], v[156:159], a[12:15]
    s_waitcnt lgkmcnt(3)
    buffer_load_dwordx4 v39, s[8:11], s40 offen offset:3072 lds
    v_mfma_f32_16x16x32_bf16 v[208:211], a[208:211], v[96:99], v[200:203]
    v_exp_f32 v212, v212
    v_mfma_f32_16x16x32_bf16 v[208:211], a[212:215], v[100:103], v[208:211]
    s_add_u32 s40, s40, 16384
    v_exp_f32 v213, v213
    v_mfma_f32_16x16x32_bf16 v[208:211], a[216:219], v[104:107], v[208:211]
    v_exp_f32 v214, v214
    v_mfma_f32_16x16x32_bf16 v[208:211], a[220:223], v[108:111], v[208:211]
    v_exp_f32 v215, v215
    v_mfma_f32_16x16x32_bf16 a[16:19], a[168:171], v[128:131], a[16:19]
    ds_read_b64_tr_b16 a[180:181], v22 offset:8192
    v_cvt_pk_bf16_f32 v168, v212, v213
    v_mfma_f32_16x16x32_bf16 a[16:19], a[172:175], v[132:135], a[16:19]
    ds_read_b64_tr_b16 a[182:183], v22 offset:12288
    v_mfma_f32_16x16x32_bf16 a[20:23], a[168:171], v[136:139], a[20:23]
    ds_read_b128 a[236:239], v11 offset:20480
    v_cvt_pk_bf16_f32 v169, v214, v215
    v_mfma_f32_16x16x32_bf16 a[20:23], a[172:175], v[140:143], a[20:23]
    v_smfmac_f32_16x16x64_bf16 a[192:195], v[52:55], v[128:135], v50
    v_mfma_f32_16x16x32_bf16 v[212:215], a[208:211], v[112:115], v[204:207]
    v_exp_f32 v208, v208
    v_mfma_f32_16x16x32_bf16 v[212:215], a[212:215], v[116:119], v[212:215]
    s_add_u32 m0, s42, 98304
    v_exp_f32 v209, v209
    v_mfma_f32_16x16x32_bf16 v[212:215], a[216:219], v[120:123], v[212:215]
    v_exp_f32 v210, v210
    v_mfma_f32_16x16x32_bf16 v[212:215], a[220:223], v[124:127], v[212:215]
    v_exp_f32 v211, v211
    v_mfma_f32_16x16x32_bf16 a[24:27], a[168:171], v[144:147], a[24:27]
    ds_read_b64_tr_b16 a[184:185], v23 offset:0
    v_cvt_pk_bf16_f32 v176, v208, v209
    v_mfma_f32_16x16x32_bf16 a[24:27], a[172:175], v[148:151], a[24:27]
    ds_read_b64_tr_b16 a[186:187], v23 offset:4096
    v_mfma_f32_16x16x32_bf16 a[28:31], a[168:171], v[152:155], a[28:31]
    ds_read_b128 a[208:211], v8 offset:24576
    v_cvt_pk_bf16_f32 v177, v210, v211
    v_mfma_f32_16x16x32_bf16 a[28:31], a[172:175], v[156:159], a[28:31]
    s_waitcnt lgkmcnt(3)
    buffer_load_dwordx4 v40, s[12:15], s41 offen lds
    v_mfma_f32_16x16x32_bf16 v[208:211], a[224:227], v[64:67], v[192:195]
    v_exp_f32 v212, v212
    v_mfma_f32_16x16x32_bf16 v[208:211], a[228:231], v[68:71], v[208:211]
    v_exp_f32 v213, v213
    v_mfma_f32_16x16x32_bf16 v[208:211], a[232:235], v[72:75], v[208:211]
    v_exp_f32 v214, v214
    v_mfma_f32_16x16x32_bf16 v[208:211], a[236:239], v[76:79], v[208:211]
    s_add_u32 s57, s58, 589824
    v_exp_f32 v215, v215
    v_mfma_f32_16x16x32_bf16 a[32:35], a[176:179], v[128:131], a[32:35]
    ds_read_b64_tr_b16 a[188:189], v23 offset:8192
    v_cvt_pk_bf16_f32 v184, v212, v213
    v_mfma_f32_16x16x32_bf16 a[32:35], a[180:183], v[132:135], a[32:35]
    ds_read_b64_tr_b16 a[190:191], v23 offset:12288
    v_mfma_f32_16x16x32_bf16 a[36:39], a[176:179], v[136:139], a[36:39]
    ds_read_b128 a[212:215], v9 offset:24576
    v_cvt_pk_bf16_f32 v185, v214, v215
    v_mfma_f32_16x16x32_bf16 a[36:39], a[180:183], v[140:143], a[36:39]
    buffer_load_dwordx4 a[132:135], v254, s[80:83], s57 offen
    v_smfmac_f32_16x16x64_bf16 a[196:199], v[52:55], v[136:143], v50
    v_mfma_f32_16x16x32_bf16 v[212:215], a[224:227], v[80:83], v[196:199]
    v_exp_f32 v208, v208
    v_mfma_f32_16x16x32_bf16 v[212:215], a[228:231], v[84:87], v[212:215]
    v_exp_f32 v209, v209
    v_mfma_f32_16x16x32_bf16 v[212:215], a[232:235], v[88:91], v[212:215]
    v_exp_f32 v210, v210
    v_mfma_f32_16x16x32_bf16 v[212:215], a[236:239], v[92:95], v[212:215]
    v_exp_f32 v211, v211
    v_mfma_f32_16x16x32_bf16 a[40:43], a[176:179], v[144:147], a[40:43]
    ds_read_b64_tr_b16 a[160:161], v24 offset:0
    v_cvt_pk_bf16_f32 v162, v208, v209
    v_mfma_f32_16x16x32_bf16 a[40:43], a[180:183], v[148:151], a[40:43]
    ds_read_b64_tr_b16 a[162:163], v24 offset:4096
    v_mfma_f32_16x16x32_bf16 a[44:47], a[176:179], v[152:155], a[44:47]
    ds_read_b128 a[216:219], v10 offset:24576
    v_cvt_pk_bf16_f32 v163, v210, v211
    v_mfma_f32_16x16x32_bf16 a[44:47], a[180:183], v[156:159], a[44:47]
    s_waitcnt lgkmcnt(3)
    buffer_load_dwordx4 v41, s[12:15], s41 offen offset:1024 lds
    v_mfma_f32_16x16x32_bf16 v[208:211], a[224:227], v[96:99], v[200:203]
    v_exp_f32 v212, v212
    v_mfma_f32_16x16x32_bf16 v[208:211], a[228:231], v[100:103], v[208:211]
    v_exp_f32 v213, v213
    v_mfma_f32_16x16x32_bf16 v[208:211], a[232:235], v[104:107], v[208:211]
    v_exp_f32 v214, v214
    v_mfma_f32_16x16x32_bf16 v[208:211], a[236:239], v[108:111], v[208:211]
    v_exp_f32 v215, v215
    v_mfma_f32_16x16x32_bf16 a[48:51], a[184:187], v[128:131], a[48:51]
    ds_read_b64_tr_b16 a[164:165], v24 offset:8192
    v_cvt_pk_bf16_f32 v170, v212, v213
    v_mfma_f32_16x16x32_bf16 a[48:51], a[188:191], v[132:135], a[48:51]
    ds_read_b64_tr_b16 a[166:167], v24 offset:12288
    v_mfma_f32_16x16x32_bf16 a[52:55], a[184:187], v[136:139], a[52:55]
    ds_read_b128 a[220:223], v11 offset:24576
    v_cvt_pk_bf16_f32 v171, v214, v215
    v_mfma_f32_16x16x32_bf16 a[52:55], a[188:191], v[140:143], a[52:55]
    v_smfmac_f32_16x16x64_bf16 a[200:203], v[52:55], v[144:151], v50
    v_mfma_f32_16x16x32_bf16 v[212:215], a[224:227], v[112:115], v[204:207]
    v_exp_f32 v208, v208
    v_mfma_f32_16x16x32_bf16 v[212:215], a[228:231], v[116:119], v[212:215]
    v_exp_f32 v209, v209
    v_mfma_f32_16x16x32_bf16 v[212:215], a[232:235], v[120:123], v[212:215]
    v_exp_f32 v210, v210
    v_mfma_f32_16x16x32_bf16 v[212:215], a[236:239], v[124:127], v[212:215]
    v_exp_f32 v211, v211
    v_mfma_f32_16x16x32_bf16 a[56:59], a[184:187], v[144:147], a[56:59]
    ds_read_b64_tr_b16 a[168:169], v25 offset:0
    v_cvt_pk_bf16_f32 v178, v208, v209
    v_mfma_f32_16x16x32_bf16 a[56:59], a[188:191], v[148:151], a[56:59]
    ds_read_b64_tr_b16 a[170:171], v25 offset:4096
    v_mfma_f32_16x16x32_bf16 a[60:63], a[184:187], v[152:155], a[60:63]
    ds_read_b128 a[224:227], v8 offset:28672
    v_cvt_pk_bf16_f32 v179, v210, v211
    v_mfma_f32_16x16x32_bf16 a[60:63], a[188:191], v[156:159], a[60:63]
    s_waitcnt lgkmcnt(3)
    buffer_load_dwordx4 v40, s[12:15], s41 offen offset:2048 lds
    v_mfma_f32_16x16x32_bf16 v[208:211], a[208:211], v[64:67], v[192:195]
    v_exp_f32 v212, v212
    v_mfma_f32_16x16x32_bf16 v[208:211], a[212:215], v[68:71], v[208:211]
    v_exp_f32 v213, v213
    v_mfma_f32_16x16x32_bf16 v[208:211], a[216:219], v[72:75], v[208:211]
    v_exp_f32 v214, v214
    v_mfma_f32_16x16x32_bf16 v[208:211], a[220:223], v[76:79], v[208:211]
    s_add_u32 s57, s58, 1179648
    v_exp_f32 v215, v215
    v_mfma_f32_16x16x32_bf16 a[64:67], a[160:163], v[128:131], a[64:67]
    ds_read_b64_tr_b16 a[172:173], v25 offset:8192
    v_cvt_pk_bf16_f32 v186, v212, v213
    v_mfma_f32_16x16x32_bf16 a[64:67], a[164:167], v[132:135], a[64:67]
    ds_read_b64_tr_b16 a[174:175], v25 offset:12288
    v_mfma_f32_16x16x32_bf16 a[68:71], a[160:163], v[136:139], a[68:71]
    ds_read_b128 a[228:231], v9 offset:28672
    v_cvt_pk_bf16_f32 v187, v214, v215
    v_mfma_f32_16x16x32_bf16 a[68:71], a[164:167], v[140:143], a[68:71]
    buffer_load_dwordx4 a[136:139], v254, s[80:83], s57 offen
    v_smfmac_f32_16x16x64_bf16 a[204:207], v[52:55], v[152:159], v50
    v_mfma_f32_16x16x32_bf16 v[212:215], a[208:211], v[80:83], v[196:199]
    v_exp_f32 v208, v208
    v_mfma_f32_16x16x32_bf16 v[212:215], a[212:215], v[84:87], v[212:215]
    v_exp_f32 v209, v209
    v_mfma_f32_16x16x32_bf16 v[212:215], a[216:219], v[88:91], v[212:215]
    v_exp_f32 v210, v210
    v_mfma_f32_16x16x32_bf16 v[212:215], a[220:223], v[92:95], v[212:215]
    v_exp_f32 v211, v211
    v_mfma_f32_16x16x32_bf16 a[72:75], a[160:163], v[144:147], a[72:75]
    ds_read_b64_tr_b16 a[176:177], v26 offset:0
    v_cvt_pk_bf16_f32 v164, v208, v209
    v_mfma_f32_16x16x32_bf16 a[72:75], a[164:167], v[148:151], a[72:75]
    ds_read_b64_tr_b16 a[178:179], v26 offset:4096
    v_mfma_f32_16x16x32_bf16 a[76:79], a[160:163], v[152:155], a[76:79]
    ds_read_b128 a[232:235], v10 offset:28672
    v_cvt_pk_bf16_f32 v165, v210, v211
    v_mfma_f32_16x16x32_bf16 a[76:79], a[164:167], v[156:159], a[76:79]
    s_waitcnt lgkmcnt(3)
    buffer_load_dwordx4 v41, s[12:15], s41 offen offset:3072 lds
    v_mfma_f32_16x16x32_bf16 v[208:211], a[208:211], v[96:99], v[200:203]
    v_exp_f32 v212, v212
    v_mfma_f32_16x16x32_bf16 v[208:211], a[212:215], v[100:103], v[208:211]
    s_add_u32 s41, s41, 16384
    v_exp_f32 v213, v213
    v_mfma_f32_16x16x32_bf16 v[208:211], a[216:219], v[104:107], v[208:211]
    v_exp_f32 v214, v214
    v_mfma_f32_16x16x32_bf16 v[208:211], a[220:223], v[108:111], v[208:211]
    v_exp_f32 v215, v215
    v_mfma_f32_16x16x32_bf16 a[80:83], a[168:171], v[128:131], a[80:83]
    ds_read_b64_tr_b16 a[180:181], v26 offset:8192
    v_cvt_pk_bf16_f32 v172, v212, v213
    v_mfma_f32_16x16x32_bf16 a[80:83], a[172:175], v[132:135], a[80:83]
    ds_read_b64_tr_b16 a[182:183], v26 offset:12288
    v_mfma_f32_16x16x32_bf16 a[84:87], a[168:171], v[136:139], a[84:87]
    ds_read_b128 a[236:239], v11 offset:28672
    v_cvt_pk_bf16_f32 v173, v214, v215
    v_mfma_f32_16x16x32_bf16 a[84:87], a[172:175], v[140:143], a[84:87]
    s_waitcnt vmcnt(11)
    s_barrier
    v_mfma_f32_16x16x32_bf16 v[212:215], a[208:211], v[112:115], v[204:207]
    v_exp_f32 v208, v208
    v_mfma_f32_16x16x32_bf16 v[212:215], a[212:215], v[116:119], v[212:215]
    s_add_u32 s49, s45, 0
    v_exp_f32 v209, v209
    v_mfma_f32_16x16x32_bf16 v[212:215], a[216:219], v[120:123], v[212:215]
    s_add_u32 m0, s42, 131072
    v_exp_f32 v210, v210
    v_mfma_f32_16x16x32_bf16 v[212:215], a[220:223], v[124:127], v[212:215]
    v_exp_f32 v211, v211
    v_mfma_f32_16x16x32_bf16 a[88:91], a[168:171], v[144:147], a[88:91]
    ds_read_b64_tr_b16 a[184:185], v27 offset:0
    v_cvt_pk_bf16_f32 v180, v208, v209
    v_mfma_f32_16x16x32_bf16 a[88:91], a[172:175], v[148:151], a[88:91]
    ds_read_b64_tr_b16 a[186:187], v27 offset:4096
    v_mfma_f32_16x16x32_bf16 a[92:95], a[168:171], v[152:155], a[92:95]
    ds_read_b128 a[208:211], v8 offset:32768
    v_cvt_pk_bf16_f32 v181, v210, v211
    v_mfma_f32_16x16x32_bf16 a[92:95], a[172:175], v[156:159], a[92:95]
    s_waitcnt lgkmcnt(3)
    buffer_load_dwordx4 v46, s[20:23], s49 offen lds
    v_mfma_f32_16x16x32_bf16 v[208:211], a[224:227], v[64:67], v[192:195]
    v_exp_f32 v212, v212
    v_mfma_f32_16x16x32_bf16 v[208:211], a[228:231], v[68:71], v[208:211]
    v_exp_f32 v213, v213
    v_mfma_f32_16x16x32_bf16 v[208:211], a[232:235], v[72:75], v[208:211]
    v_exp_f32 v214, v214
    v_mfma_f32_16x16x32_bf16 v[208:211], a[236:239], v[76:79], v[208:211]
    v_exp_f32 v215, v215
    v_mfma_f32_16x16x32_bf16 a[96:99], a[176:179], v[128:131], a[96:99]
    ds_read_b64_tr_b16 a[188:189], v27 offset:8192
    v_cvt_pk_bf16_f32 v188, v212, v213
    v_mfma_f32_16x16x32_bf16 a[96:99], a[180:183], v[132:135], a[96:99]
    ds_read_b64_tr_b16 a[190:191], v27 offset:12288
    v_mfma_f32_16x16x32_bf16 a[100:103], a[176:179], v[136:139], a[100:103]
    ds_read_b128 a[212:215], v9 offset:32768
    v_cvt_pk_bf16_f32 v189, v214, v215
    v_mfma_f32_16x16x32_bf16 a[100:103], a[180:183], v[140:143], a[100:103]
    v_mfma_f32_16x16x32_bf16 v[212:215], a[224:227], v[80:83], v[196:199]
    v_exp_f32 v208, v208
    v_mfma_f32_16x16x32_bf16 v[212:215], a[228:231], v[84:87], v[212:215]
    v_exp_f32 v209, v209
    v_mfma_f32_16x16x32_bf16 v[212:215], a[232:235], v[88:91], v[212:215]
    v_exp_f32 v210, v210
    v_mfma_f32_16x16x32_bf16 v[212:215], a[236:239], v[92:95], v[212:215]
    v_exp_f32 v211, v211
    v_mfma_f32_16x16x32_bf16 a[104:107], a[176:179], v[144:147], a[104:107]
    ds_read_b64_tr_b16 a[160:161], v20 offset:16384
    v_cvt_pk_bf16_f32 v166, v208, v209
    v_mfma_f32_16x16x32_bf16 a[104:107], a[180:183], v[148:151], a[104:107]
    ds_read_b64_tr_b16 a[162:163], v20 offset:20480
    v_mfma_f32_16x16x32_bf16 a[108:111], a[176:179], v[152:155], a[108:111]
    ds_read_b128 a[216:219], v10 offset:32768
    v_cvt_pk_bf16_f32 v167, v210, v211
    v_mfma_f32_16x16x32_bf16 a[108:111], a[180:183], v[156:159], a[108:111]
    s_waitcnt lgkmcnt(3)
    buffer_load_dwordx4 v47, s[20:23], s49 offen offset:1024 lds
    v_mfma_f32_16x16x32_bf16 v[208:211], a[224:227], v[96:99], v[200:203]
    v_exp_f32 v212, v212
    v_mfma_f32_16x16x32_bf16 v[208:211], a[228:231], v[100:103], v[208:211]
    v_exp_f32 v213, v213
    v_mfma_f32_16x16x32_bf16 v[208:211], a[232:235], v[104:107], v[208:211]
    v_exp_f32 v214, v214
    v_mfma_f32_16x16x32_bf16 v[208:211], a[236:239], v[108:111], v[208:211]
    s_add_u32 s57, s58, 1769472
    v_exp_f32 v215, v215
    v_mfma_f32_16x16x32_bf16 a[112:115], a[184:187], v[128:131], a[112:115]
    ds_read_b64_tr_b16 a[164:165], v20 offset:24576
    v_cvt_pk_bf16_f32 v174, v212, v213
    v_mfma_f32_16x16x32_bf16 a[112:115], a[188:191], v[132:135], a[112:115]
    ds_read_b64_tr_b16 a[166:167], v20 offset:28672
    v_mfma_f32_16x16x32_bf16 a[116:119], a[184:187], v[136:139], a[116:119]
    ds_read_b128 a[220:223], v11 offset:32768
    v_cvt_pk_bf16_f32 v175, v214, v215
    v_mfma_f32_16x16x32_bf16 a[116:119], a[188:191], v[140:143], a[116:119]
    buffer_load_dwordx4 a[140:143], v254, s[80:83], s57 offen
    v_mfma_f32_16x16x32_bf16 v[212:215], a[224:227], v[112:115], v[204:207]
    v_exp_f32 v208, v208
    v_mfma_f32_16x16x32_bf16 v[212:215], a[228:231], v[116:119], v[212:215]
    v_exp_f32 v209, v209
    v_mfma_f32_16x16x32_bf16 v[212:215], a[232:235], v[120:123], v[212:215]
    v_exp_f32 v210, v210
    v_mfma_f32_16x16x32_bf16 v[212:215], a[236:239], v[124:127], v[212:215]
    v_exp_f32 v211, v211
    v_mfma_f32_16x16x32_bf16 a[120:123], a[184:187], v[144:147], a[120:123]
    ds_read_b64_tr_b16 a[168:169], v21 offset:16384
    v_cvt_pk_bf16_f32 v182, v208, v209
    v_mfma_f32_16x16x32_bf16 a[120:123], a[188:191], v[148:151], a[120:123]
    ds_read_b64_tr_b16 a[170:171], v21 offset:20480
    v_mfma_f32_16x16x32_bf16 a[124:127], a[184:187], v[152:155], a[124:127]
    ds_read_b128 a[224:227], v8 offset:36864
    v_cvt_pk_bf16_f32 v183, v210, v211
    v_mfma_f32_16x16x32_bf16 a[124:127], a[188:191], v[156:159], a[124:127]
    s_waitcnt lgkmcnt(3)
    buffer_load_dwordx4 v48, s[20:23], s49 offen offset:2048 lds
    v_mfma_f32_16x16x32_bf16 v[208:211], a[208:211], v[64:67], v[192:195]
    v_exp_f32 v212, v212
    v_mfma_f32_16x16x32_bf16 v[208:211], a[212:215], v[68:71], v[208:211]
    v_exp_f32 v213, v213
    v_mfma_f32_16x16x32_bf16 v[208:211], a[216:219], v[72:75], v[208:211]
    v_exp_f32 v214, v214
    v_mfma_f32_16x16x32_bf16 v[208:211], a[220:223], v[76:79], v[208:211]
    s_add_u32 s57, s58, 2359296
    v_exp_f32 v215, v215
    v_mfma_f32_16x16x32_bf16 a[0:3], a[160:163], v[160:163], a[0:3]
    ds_read_b64_tr_b16 a[172:173], v21 offset:24576
    v_cvt_pk_bf16_f32 v190, v212, v213
    v_mfma_f32_16x16x32_bf16 a[0:3], a[164:167], v[164:167], a[0:3]
    ds_read_b64_tr_b16 a[174:175], v21 offset:28672
    v_mov_b32 v63, 0
    v_mfma_f32_16x16x32_bf16 a[4:7], a[160:163], v[168:171], a[4:7]
    ds_read_b128 a[228:231], v9 offset:36864
    v_cvt_pk_bf16_f32 v191, v214, v215
    v_mfma_f32_16x16x32_bf16 a[4:7], a[164:167], v[172:175], a[4:7]
    buffer_load_dwordx4 a[144:147], v254, s[80:83], s57 offen
    v_mfma_f32_16x16x32_bf16 v[212:215], a[208:211], v[80:83], v[196:199]
    v_exp_f32 v208, v208
    v_mfma_f32_16x16x32_bf16 v[212:215], a[212:215], v[84:87], v[212:215]
    v_exp_f32 v209, v209
    v_mfma_f32_16x16x32_bf16 v[212:215], a[216:219], v[88:91], v[212:215]
    v_exp_f32 v210, v210
    v_mfma_f32_16x16x32_bf16 v[212:215], a[220:223], v[92:95], v[212:215]
    v_exp_f32 v211, v211
    v_mfma_f32_16x16x32_bf16 a[8:11], a[160:163], v[176:179], a[8:11]
    ds_read_b64_tr_b16 a[176:177], v22 offset:16384
    v_cvt_pk_bf16_f32 v128, v208, v209
    v_mfma_f32_16x16x32_bf16 a[8:11], a[164:167], v[180:183], a[8:11]
    ds_read_b64_tr_b16 a[178:179], v22 offset:20480
    v_mfma_f32_16x16x32_bf16 a[12:15], a[160:163], v[184:187], a[12:15]
    ds_read_b128 a[232:235], v10 offset:36864
    v_cvt_pk_bf16_f32 v129, v210, v211
    v_mfma_f32_16x16x32_bf16 a[12:15], a[164:167], v[188:191], a[12:15]
    s_waitcnt lgkmcnt(3)
    buffer_load_dwordx4 v49, s[20:23], s49 offen offset:3072 lds
    v_mfma_f32_16x16x32_bf16 v[208:211], a[208:211], v[96:99], v[200:203]
    v_exp_f32 v212, v212
    v_mfma_f32_16x16x32_bf16 v[208:211], a[212:215], v[100:103], v[208:211]
    v_exp_f32 v213, v213
    v_mfma_f32_16x16x32_bf16 v[208:211], a[216:219], v[104:107], v[208:211]
    v_exp_f32 v214, v214
    v_mfma_f32_16x16x32_bf16 v[208:211], a[220:223], v[108:111], v[208:211]
    v_exp_f32 v215, v215
    v_mfma_f32_16x16x32_bf16 a[16:19], a[168:171], v[160:163], a[16:19]
    ds_read_b64_tr_b16 a[180:181], v22 offset:24576
    v_cvt_pk_bf16_f32 v136, v212, v213
    v_mfma_f32_16x16x32_bf16 a[16:19], a[172:175], v[164:167], a[16:19]
    ds_read_b64_tr_b16 a[182:183], v22 offset:28672
    v_mfma_f32_16x16x32_bf16 a[20:23], a[168:171], v[168:171], a[20:23]
    ds_read_b128 a[236:239], v11 offset:36864
    v_cvt_pk_bf16_f32 v137, v214, v215
    v_mfma_f32_16x16x32_bf16 a[20:23], a[172:175], v[172:175], a[20:23]
    v_smfmac_f32_16x16x64_bf16 a[192:195], v[52:55], v[160:167], v50
    v_mfma_f32_16x16x32_bf16 v[212:215], a[208:211], v[112:115], v[204:207]
    v_exp_f32 v208, v208
    v_mfma_f32_16x16x32_bf16 v[212:215], a[212:215], v[116:119], v[212:215]
    s_add_u32 m0, s42, 114688
    v_exp_f32 v209, v209
    v_mfma_f32_16x16x32_bf16 v[212:215], a[216:219], v[120:123], v[212:215]
    v_exp_f32 v210, v210
    v_mfma_f32_16x16x32_bf16 v[212:215], a[220:223], v[124:127], v[212:215]
    v_exp_f32 v211, v211
    v_mfma_f32_16x16x32_bf16 a[24:27], a[168:171], v[176:179], a[24:27]
    ds_read_b64_tr_b16 a[184:185], v23 offset:16384
    v_cvt_pk_bf16_f32 v144, v208, v209
    v_mfma_f32_16x16x32_bf16 a[24:27], a[172:175], v[180:183], a[24:27]
    ds_read_b64_tr_b16 a[186:187], v23 offset:20480
    v_mfma_f32_16x16x32_bf16 a[28:31], a[168:171], v[184:187], a[28:31]
    ds_read_b128 a[208:211], v8 offset:40960
    v_cvt_pk_bf16_f32 v145, v210, v211
    v_mfma_f32_16x16x32_bf16 a[28:31], a[172:175], v[188:191], a[28:31]
    s_waitcnt lgkmcnt(3)
    buffer_load_dwordx4 v40, s[12:15], s41 offen lds
    v_mfma_f32_16x16x32_bf16 v[208:211], a[224:227], v[64:67], v[192:195]
    v_exp_f32 v212, v212
    v_mfma_f32_16x16x32_bf16 v[208:211], a[228:231], v[68:71], v[208:211]
    v_exp_f32 v213, v213
    v_mfma_f32_16x16x32_bf16 v[208:211], a[232:235], v[72:75], v[208:211]
    v_exp_f32 v214, v214
    v_mfma_f32_16x16x32_bf16 v[208:211], a[236:239], v[76:79], v[208:211]
    s_add_u32 s57, s58, 2949120
    v_exp_f32 v215, v215
    v_mfma_f32_16x16x32_bf16 a[32:35], a[176:179], v[160:163], a[32:35]
    ds_read_b64_tr_b16 a[188:189], v23 offset:24576
    v_cvt_pk_bf16_f32 v152, v212, v213
    v_mfma_f32_16x16x32_bf16 a[32:35], a[180:183], v[164:167], a[32:35]
    ds_read_b64_tr_b16 a[190:191], v23 offset:28672
    v_mfma_f32_16x16x32_bf16 a[36:39], a[176:179], v[168:171], a[36:39]
    ds_read_b128 a[212:215], v9 offset:40960
    v_cvt_pk_bf16_f32 v153, v214, v215
    v_mfma_f32_16x16x32_bf16 a[36:39], a[180:183], v[172:175], a[36:39]
    buffer_load_dwordx4 a[148:151], v254, s[80:83], s57 offen
    v_smfmac_f32_16x16x64_bf16 a[196:199], v[52:55], v[168:175], v50
    v_mfma_f32_16x16x32_bf16 v[212:215], a[224:227], v[80:83], v[196:199]
    v_exp_f32 v208, v208
    v_mfma_f32_16x16x32_bf16 v[212:215], a[228:231], v[84:87], v[212:215]
    v_exp_f32 v209, v209
    v_mfma_f32_16x16x32_bf16 v[212:215], a[232:235], v[88:91], v[212:215]
    v_exp_f32 v210, v210
    v_mfma_f32_16x16x32_bf16 v[212:215], a[236:239], v[92:95], v[212:215]
    v_exp_f32 v211, v211
    v_mfma_f32_16x16x32_bf16 a[40:43], a[176:179], v[176:179], a[40:43]
    ds_read_b64_tr_b16 a[160:161], v24 offset:16384
    v_cvt_pk_bf16_f32 v130, v208, v209
    v_mfma_f32_16x16x32_bf16 a[40:43], a[180:183], v[180:183], a[40:43]
    ds_read_b64_tr_b16 a[162:163], v24 offset:20480
    v_mfma_f32_16x16x32_bf16 a[44:47], a[176:179], v[184:187], a[44:47]
    ds_read_b128 a[216:219], v10 offset:40960
    v_cvt_pk_bf16_f32 v131, v210, v211
    v_mfma_f32_16x16x32_bf16 a[44:47], a[180:183], v[188:191], a[44:47]
    s_waitcnt lgkmcnt(3)
    buffer_load_dwordx4 v41, s[12:15], s41 offen offset:1024 lds
    v_mfma_f32_16x16x32_bf16 v[208:211], a[224:227], v[96:99], v[200:203]
    v_exp_f32 v212, v212
    v_mfma_f32_16x16x32_bf16 v[208:211], a[228:231], v[100:103], v[208:211]
    v_exp_f32 v213, v213
    v_mfma_f32_16x16x32_bf16 v[208:211], a[232:235], v[104:107], v[208:211]
    v_exp_f32 v214, v214
    v_mfma_f32_16x16x32_bf16 v[208:211], a[236:239], v[108:111], v[208:211]
    v_exp_f32 v215, v215
    v_mfma_f32_16x16x32_bf16 a[48:51], a[184:187], v[160:163], a[48:51]
    ds_read_b64_tr_b16 a[164:165], v24 offset:24576
    v_cvt_pk_bf16_f32 v138, v212, v213
    v_mfma_f32_16x16x32_bf16 a[48:51], a[188:191], v[164:167], a[48:51]
    ds_read_b64_tr_b16 a[166:167], v24 offset:28672
    v_mfma_f32_16x16x32_bf16 a[52:55], a[184:187], v[168:171], a[52:55]
    ds_read_b128 a[220:223], v11 offset:40960
    v_cvt_pk_bf16_f32 v139, v214, v215
    v_mfma_f32_16x16x32_bf16 a[52:55], a[188:191], v[172:175], a[52:55]
    v_smfmac_f32_16x16x64_bf16 a[200:203], v[52:55], v[176:183], v50
    v_mfma_f32_16x16x32_bf16 v[212:215], a[224:227], v[112:115], v[204:207]
    v_exp_f32 v208, v208
    v_mfma_f32_16x16x32_bf16 v[212:215], a[228:231], v[116:119], v[212:215]
    v_exp_f32 v209, v209
    v_mfma_f32_16x16x32_bf16 v[212:215], a[232:235], v[120:123], v[212:215]
    v_exp_f32 v210, v210
    v_mfma_f32_16x16x32_bf16 v[212:215], a[236:239], v[124:127], v[212:215]
    v_exp_f32 v211, v211
    v_mfma_f32_16x16x32_bf16 a[56:59], a[184:187], v[176:179], a[56:59]
    ds_read_b64_tr_b16 a[168:169], v25 offset:16384
    v_cvt_pk_bf16_f32 v146, v208, v209
    v_mfma_f32_16x16x32_bf16 a[56:59], a[188:191], v[180:183], a[56:59]
    ds_read_b64_tr_b16 a[170:171], v25 offset:20480
    v_mfma_f32_16x16x32_bf16 a[60:63], a[184:187], v[184:187], a[60:63]
    ds_read_b128 a[224:227], v8 offset:45056
    v_cvt_pk_bf16_f32 v147, v210, v211
    v_mfma_f32_16x16x32_bf16 a[60:63], a[188:191], v[188:191], a[60:63]
    s_waitcnt lgkmcnt(3)
    buffer_load_dwordx4 v40, s[12:15], s41 offen offset:2048 lds
    v_mfma_f32_16x16x32_bf16 v[208:211], a[208:211], v[64:67], v[192:195]
    v_exp_f32 v212, v212
    v_mfma_f32_16x16x32_bf16 v[208:211], a[212:215], v[68:71], v[208:211]
    v_exp_f32 v213, v213
    v_mfma_f32_16x16x32_bf16 v[208:211], a[216:219], v[72:75], v[208:211]
    v_exp_f32 v214, v214
    v_mfma_f32_16x16x32_bf16 v[208:211], a[220:223], v[76:79], v[208:211]
    s_add_u32 s57, s58, 3538944
    v_exp_f32 v215, v215
    v_mfma_f32_16x16x32_bf16 a[64:67], a[160:163], v[160:163], a[64:67]
    ds_read_b64_tr_b16 a[172:173], v25 offset:24576
    v_cvt_pk_bf16_f32 v154, v212, v213
    v_mfma_f32_16x16x32_bf16 a[64:67], a[164:167], v[164:167], a[64:67]
    ds_read_b64_tr_b16 a[174:175], v25 offset:28672
    v_mfma_f32_16x16x32_bf16 a[68:71], a[160:163], v[168:171], a[68:71]
    ds_read_b128 a[228:231], v9 offset:45056
    v_cvt_pk_bf16_f32 v155, v214, v215
    v_mfma_f32_16x16x32_bf16 a[68:71], a[164:167], v[172:175], a[68:71]
    buffer_load_dwordx4 a[152:155], v254, s[80:83], s57 offen
    v_smfmac_f32_16x16x64_bf16 a[204:207], v[52:55], v[184:191], v50
    v_mfma_f32_16x16x32_bf16 v[212:215], a[208:211], v[80:83], v[196:199]
    v_exp_f32 v208, v208
    v_mfma_f32_16x16x32_bf16 v[212:215], a[212:215], v[84:87], v[212:215]
    v_exp_f32 v209, v209
    v_mfma_f32_16x16x32_bf16 v[212:215], a[216:219], v[88:91], v[212:215]
    v_exp_f32 v210, v210
    v_mfma_f32_16x16x32_bf16 v[212:215], a[220:223], v[92:95], v[212:215]
    v_exp_f32 v211, v211
    v_mfma_f32_16x16x32_bf16 a[72:75], a[160:163], v[176:179], a[72:75]
    ds_read_b64_tr_b16 a[176:177], v26 offset:16384
    v_cvt_pk_bf16_f32 v132, v208, v209
    v_mfma_f32_16x16x32_bf16 a[72:75], a[164:167], v[180:183], a[72:75]
    ds_read_b64_tr_b16 a[178:179], v26 offset:20480
    v_mfma_f32_16x16x32_bf16 a[76:79], a[160:163], v[184:187], a[76:79]
    ds_read_b128 a[232:235], v10 offset:45056
    v_cvt_pk_bf16_f32 v133, v210, v211
    v_mfma_f32_16x16x32_bf16 a[76:79], a[164:167], v[188:191], a[76:79]
    s_waitcnt lgkmcnt(3)
    buffer_load_dwordx4 v41, s[12:15], s41 offen offset:3072 lds
    v_mfma_f32_16x16x32_bf16 v[208:211], a[208:211], v[96:99], v[200:203]
    v_exp_f32 v212, v212
    v_mfma_f32_16x16x32_bf16 v[208:211], a[212:215], v[100:103], v[208:211]
    s_add_u32 s41, s41, 16384
    v_exp_f32 v213, v213
    v_mfma_f32_16x16x32_bf16 v[208:211], a[216:219], v[104:107], v[208:211]
    v_exp_f32 v214, v214
    v_mfma_f32_16x16x32_bf16 v[208:211], a[220:223], v[108:111], v[208:211]
    v_exp_f32 v215, v215
    v_mfma_f32_16x16x32_bf16 a[80:83], a[168:171], v[160:163], a[80:83]
    ds_read_b64_tr_b16 a[180:181], v26 offset:24576
    v_cvt_pk_bf16_f32 v140, v212, v213
    v_mfma_f32_16x16x32_bf16 a[80:83], a[172:175], v[164:167], a[80:83]
    ds_read_b64_tr_b16 a[182:183], v26 offset:28672
    v_mfma_f32_16x16x32_bf16 a[84:87], a[168:171], v[168:171], a[84:87]
    ds_read_b128 a[236:239], v11 offset:45056
    v_cvt_pk_bf16_f32 v141, v214, v215
    v_mfma_f32_16x16x32_bf16 a[84:87], a[172:175], v[172:175], a[84:87]
    s_waitcnt vmcnt(12)
    s_barrier
    v_mfma_f32_16x16x32_bf16 v[212:215], a[208:211], v[112:115], v[204:207]
    v_exp_f32 v208, v208
    v_mfma_f32_16x16x32_bf16 v[212:215], a[212:215], v[116:119], v[212:215]
    s_add_u32 s49, s45, 73728
    v_exp_f32 v209, v209
    v_mfma_f32_16x16x32_bf16 v[212:215], a[216:219], v[120:123], v[212:215]
    s_add_u32 m0, s42, 147456
    v_exp_f32 v210, v210
    v_mfma_f32_16x16x32_bf16 v[212:215], a[220:223], v[124:127], v[212:215]
    v_exp_f32 v211, v211
    v_mfma_f32_16x16x32_bf16 a[88:91], a[168:171], v[176:179], a[88:91]
    ds_read_b64_tr_b16 a[184:185], v27 offset:16384
    v_cvt_pk_bf16_f32 v148, v208, v209
    v_mfma_f32_16x16x32_bf16 a[88:91], a[172:175], v[180:183], a[88:91]
    ds_read_b64_tr_b16 a[186:187], v27 offset:20480
    v_mfma_f32_16x16x32_bf16 a[92:95], a[168:171], v[184:187], a[92:95]
    ds_read_b128 a[208:211], v8 offset:49152
    v_cvt_pk_bf16_f32 v149, v210, v211
    v_mfma_f32_16x16x32_bf16 a[92:95], a[172:175], v[188:191], a[92:95]
    s_waitcnt lgkmcnt(3)
    buffer_load_dwordx4 v46, s[20:23], s49 offen lds
    v_mfma_f32_16x16x32_bf16 v[208:211], a[224:227], v[64:67], v[192:195]
    v_exp_f32 v212, v212
    v_mfma_f32_16x16x32_bf16 v[208:211], a[228:231], v[68:71], v[208:211]
    v_exp_f32 v213, v213
    v_mfma_f32_16x16x32_bf16 v[208:211], a[232:235], v[72:75], v[208:211]
    v_exp_f32 v214, v214
    v_mfma_f32_16x16x32_bf16 v[208:211], a[236:239], v[76:79], v[208:211]
    v_exp_f32 v215, v215
    v_mfma_f32_16x16x32_bf16 a[96:99], a[176:179], v[160:163], a[96:99]
    ds_read_b64_tr_b16 a[188:189], v27 offset:24576
    v_cvt_pk_bf16_f32 v156, v212, v213
    v_mfma_f32_16x16x32_bf16 a[96:99], a[180:183], v[164:167], a[96:99]
    ds_read_b64_tr_b16 a[190:191], v27 offset:28672
    v_mfma_f32_16x16x32_bf16 a[100:103], a[176:179], v[168:171], a[100:103]
    ds_read_b128 a[212:215], v9 offset:49152
    v_cvt_pk_bf16_f32 v157, v214, v215
    v_mfma_f32_16x16x32_bf16 a[100:103], a[180:183], v[172:175], a[100:103]
    buffer_load_dword v63, v63, s[88:91], 0 offen sc1
    v_mfma_f32_16x16x32_bf16 v[212:215], a[224:227], v[80:83], v[196:199]
    v_exp_f32 v208, v208
    v_mfma_f32_16x16x32_bf16 v[212:215], a[228:231], v[84:87], v[212:215]
    v_exp_f32 v209, v209
    v_mfma_f32_16x16x32_bf16 v[212:215], a[232:235], v[88:91], v[212:215]
    v_exp_f32 v210, v210
    v_mfma_f32_16x16x32_bf16 v[212:215], a[236:239], v[92:95], v[212:215]
    v_exp_f32 v211, v211
    v_mfma_f32_16x16x32_bf16 a[104:107], a[176:179], v[176:179], a[104:107]
    ds_read_b64_tr_b16 a[160:161], v20 offset:32768
    v_cvt_pk_bf16_f32 v134, v208, v209
    v_mfma_f32_16x16x32_bf16 a[104:107], a[180:183], v[180:183], a[104:107]
    ds_read_b64_tr_b16 a[162:163], v20 offset:36864
    v_mfma_f32_16x16x32_bf16 a[108:111], a[176:179], v[184:187], a[108:111]
    ds_read_b128 a[216:219], v10 offset:49152
    v_cvt_pk_bf16_f32 v135, v210, v211
    v_mfma_f32_16x16x32_bf16 a[108:111], a[180:183], v[188:191], a[108:111]
    s_waitcnt lgkmcnt(3)
    buffer_load_dwordx4 v47, s[20:23], s49 offen offset:1024 lds
    v_mfma_f32_16x16x32_bf16 v[208:211], a[224:227], v[96:99], v[200:203]
    v_exp_f32 v212, v212
    v_mfma_f32_16x16x32_bf16 v[208:211], a[228:231], v[100:103], v[208:211]
    v_exp_f32 v213, v213
    v_mfma_f32_16x16x32_bf16 v[208:211], a[232:235], v[104:107], v[208:211]
    v_exp_f32 v214, v214
    v_mfma_f32_16x16x32_bf16 v[208:211], a[236:239], v[108:111], v[208:211]
    s_add_u32 s57, s58, 4128768
    v_exp_f32 v215, v215
    v_mfma_f32_16x16x32_bf16 a[112:115], a[184:187], v[160:163], a[112:115]
    ds_read_b64_tr_b16 a[164:165], v20 offset:40960
    v_cvt_pk_bf16_f32 v142, v212, v213
    v_mfma_f32_16x16x32_bf16 a[112:115], a[188:191], v[164:167], a[112:115]
    ds_read_b64_tr_b16 a[166:167], v20 offset:45056
    v_mfma_f32_16x16x32_bf16 a[116:119], a[184:187], v[168:171], a[116:119]
    ds_read_b128 a[220:223], v11 offset:49152
    v_cvt_pk_bf16_f32 v143, v214, v215
    v_mfma_f32_16x16x32_bf16 a[116:119], a[188:191], v[172:175], a[116:119]
    buffer_load_dwordx4 a[156:159], v254, s[80:83], s57 offen
    v_mfma_f32_16x16x32_bf16 v[212:215], a[224:227], v[112:115], v[204:207]
    v_exp_f32 v208, v208
    v_mfma_f32_16x16x32_bf16 v[212:215], a[228:231], v[116:119], v[212:215]
    v_exp_f32 v209, v209
    v_mfma_f32_16x16x32_bf16 v[212:215], a[232:235], v[120:123], v[212:215]
    v_exp_f32 v210, v210
    v_mfma_f32_16x16x32_bf16 v[212:215], a[236:239], v[124:127], v[212:215]
    v_exp_f32 v211, v211
    v_mfma_f32_16x16x32_bf16 a[120:123], a[184:187], v[176:179], a[120:123]
    ds_read_b64_tr_b16 a[168:169], v21 offset:32768
    v_cvt_pk_bf16_f32 v150, v208, v209
    v_mfma_f32_16x16x32_bf16 a[120:123], a[188:191], v[180:183], a[120:123]
    ds_read_b64_tr_b16 a[170:171], v21 offset:36864
    v_mfma_f32_16x16x32_bf16 a[124:127], a[184:187], v[184:187], a[124:127]
    ds_read_b128 a[224:227], v8 offset:53248
    v_cvt_pk_bf16_f32 v151, v210, v211
    v_mfma_f32_16x16x32_bf16 a[124:127], a[188:191], v[188:191], a[124:127]
    s_waitcnt lgkmcnt(3)
    buffer_load_dwordx4 v48, s[20:23], s49 offen offset:2048 lds
    v_mfma_f32_16x16x32_bf16 v[208:211], a[208:211], v[64:67], v[192:195]
    v_exp_f32 v212, v212
    v_mfma_f32_16x16x32_bf16 v[208:211], a[212:215], v[68:71], v[208:211]
    v_exp_f32 v213, v213
    v_mfma_f32_16x16x32_bf16 v[208:211], a[216:219], v[72:75], v[208:211]
    v_exp_f32 v214, v214
    v_mfma_f32_16x16x32_bf16 v[208:211], a[220:223], v[76:79], v[208:211]
    s_add_u32 s57, s58, 4718592
    v_exp_f32 v215, v215
    v_mfma_f32_16x16x32_bf16 a[0:3], a[160:163], v[128:131], a[0:3]
    ds_read_b64_tr_b16 a[172:173], v21 offset:40960
    v_cvt_pk_bf16_f32 v158, v212, v213
    v_mfma_f32_16x16x32_bf16 a[0:3], a[164:167], v[132:135], a[0:3]
    ds_read_b64_tr_b16 a[174:175], v21 offset:45056
    v_mfma_f32_16x16x32_bf16 a[4:7], a[160:163], v[136:139], a[4:7]
    ds_read_b128 a[228:231], v9 offset:53248
    v_cvt_pk_bf16_f32 v159, v214, v215
    v_mfma_f32_16x16x32_bf16 a[4:7], a[164:167], v[140:143], a[4:7]
    buffer_load_dwordx4 a[240:243], v254, s[80:83], s57 offen
    v_mfma_f32_16x16x32_bf16 v[212:215], a[208:211], v[80:83], v[196:199]
    v_exp_f32 v208, v208
    v_mfma_f32_16x16x32_bf16 v[212:215], a[212:215], v[84:87], v[212:215]
    v_exp_f32 v209, v209
    v_mfma_f32_16x16x32_bf16 v[212:215], a[216:219], v[88:91], v[212:215]
    v_exp_f32 v210, v210
    v_mfma_f32_16x16x32_bf16 v[212:215], a[220:223], v[92:95], v[212:215]
    v_exp_f32 v211, v211
    v_mfma_f32_16x16x32_bf16 a[8:11], a[160:163], v[144:147], a[8:11]
    ds_read_b64_tr_b16 a[176:177], v22 offset:32768
    v_cvt_pk_bf16_f32 v160, v208, v209
    v_mfma_f32_16x16x32_bf16 a[8:11], a[164:167], v[148:151], a[8:11]
    ds_read_b64_tr_b16 a[178:179], v22 offset:36864
    v_mfma_f32_16x16x32_bf16 a[12:15], a[160:163], v[152:155], a[12:15]
    ds_read_b128 a[232:235], v10 offset:53248
    v_cvt_pk_bf16_f32 v161, v210, v211
    v_mfma_f32_16x16x32_bf16 a[12:15], a[164:167], v[156:159], a[12:15]
    s_waitcnt lgkmcnt(3)
    buffer_load_dwordx4 v49, s[20:23], s49 offen offset:3072 lds
    v_mfma_f32_16x16x32_bf16 v[208:211], a[208:211], v[96:99], v[200:203]
    v_exp_f32 v212, v212
    v_mfma_f32_16x16x32_bf16 v[208:211], a[212:215], v[100:103], v[208:211]
    v_exp_f32 v213, v213
    v_mfma_f32_16x16x32_bf16 v[208:211], a[216:219], v[104:107], v[208:211]
    v_exp_f32 v214, v214
    v_mfma_f32_16x16x32_bf16 v[208:211], a[220:223], v[108:111], v[208:211]
    v_exp_f32 v215, v215
    v_mfma_f32_16x16x32_bf16 a[16:19], a[168:171], v[128:131], a[16:19]
    ds_read_b64_tr_b16 a[180:181], v22 offset:40960
    v_cvt_pk_bf16_f32 v168, v212, v213
    v_mfma_f32_16x16x32_bf16 a[16:19], a[172:175], v[132:135], a[16:19]
    ds_read_b64_tr_b16 a[182:183], v22 offset:45056
    v_mfma_f32_16x16x32_bf16 a[20:23], a[168:171], v[136:139], a[20:23]
    ds_read_b128 a[236:239], v11 offset:53248
    v_cvt_pk_bf16_f32 v169, v214, v215
    v_mfma_f32_16x16x32_bf16 a[20:23], a[172:175], v[140:143], a[20:23]
    v_smfmac_f32_16x16x64_bf16 a[192:195], v[52:55], v[128:135], v50
    v_mfma_f32_16x16x32_bf16 v[212:215], a[208:211], v[112:115], v[204:207]
    v_exp_f32 v208, v208
    v_mfma_f32_16x16x32_bf16 v[212:215], a[212:215], v[116:119], v[212:215]
    s_add_u32 s49, s45, 128
    v_exp_f32 v209, v209
    v_mfma_f32_16x16x32_bf16 v[212:215], a[216:219], v[120:123], v[212:215]
    s_add_u32 m0, s42, 0
    v_exp_f32 v210, v210
    v_mfma_f32_16x16x32_bf16 v[212:215], a[220:223], v[124:127], v[212:215]
    v_exp_f32 v211, v211
    v_mfma_f32_16x16x32_bf16 a[24:27], a[168:171], v[144:147], a[24:27]
    ds_read_b64_tr_b16 a[184:185], v23 offset:32768
    v_cvt_pk_bf16_f32 v176, v208, v209
    v_mfma_f32_16x16x32_bf16 a[24:27], a[172:175], v[148:151], a[24:27]
    ds_read_b64_tr_b16 a[186:187], v23 offset:36864
    v_mfma_f32_16x16x32_bf16 a[28:31], a[168:171], v[152:155], a[28:31]
    ds_read_b128 a[208:211], v8 offset:57344
    v_cvt_pk_bf16_f32 v177, v210, v211
    v_mfma_f32_16x16x32_bf16 a[28:31], a[172:175], v[156:159], a[28:31]
    s_waitcnt lgkmcnt(3)
    buffer_load_dwordx4 v46, s[20:23], s49 offen lds
    v_mfma_f32_16x16x32_bf16 v[208:211], a[224:227], v[64:67], v[192:195]
    v_exp_f32 v212, v212
    v_mfma_f32_16x16x32_bf16 v[208:211], a[228:231], v[68:71], v[208:211]
    v_exp_f32 v213, v213
    v_mfma_f32_16x16x32_bf16 v[208:211], a[232:235], v[72:75], v[208:211]
    v_exp_f32 v214, v214
    v_mfma_f32_16x16x32_bf16 v[208:211], a[236:239], v[76:79], v[208:211]
    s_add_u32 s57, s58, 0
    v_exp_f32 v215, v215
    v_mfma_f32_16x16x32_bf16 a[32:35], a[176:179], v[128:131], a[32:35]
    ds_read_b64_tr_b16 a[188:189], v23 offset:40960
    v_cvt_pk_bf16_f32 v184, v212, v213
    v_mfma_f32_16x16x32_bf16 a[32:35], a[180:183], v[132:135], a[32:35]
    ds_read_b64_tr_b16 a[190:191], v23 offset:45056
    v_mfma_f32_16x16x32_bf16 a[36:39], a[176:179], v[136:139], a[36:39]
    ds_read_b128 a[212:215], v9 offset:57344
    v_cvt_pk_bf16_f32 v185, v214, v215
    v_mfma_f32_16x16x32_bf16 a[36:39], a[180:183], v[140:143], a[36:39]
    buffer_load_dwordx4 a[244:247], v254, s[32:35], s57 offen
    v_smfmac_f32_16x16x64_bf16 a[196:199], v[52:55], v[136:143], v50
    v_mfma_f32_16x16x32_bf16 v[212:215], a[224:227], v[80:83], v[196:199]
    v_exp_f32 v208, v208
    v_mfma_f32_16x16x32_bf16 v[212:215], a[228:231], v[84:87], v[212:215]
    v_exp_f32 v209, v209
    v_mfma_f32_16x16x32_bf16 v[212:215], a[232:235], v[88:91], v[212:215]
    v_exp_f32 v210, v210
    v_mfma_f32_16x16x32_bf16 v[212:215], a[236:239], v[92:95], v[212:215]
    v_exp_f32 v211, v211
    v_mfma_f32_16x16x32_bf16 a[40:43], a[176:179], v[144:147], a[40:43]
    ds_read_b64_tr_b16 a[160:161], v24 offset:32768
    v_cvt_pk_bf16_f32 v162, v208, v209
    v_mfma_f32_16x16x32_bf16 a[40:43], a[180:183], v[148:151], a[40:43]
    ds_read_b64_tr_b16 a[162:163], v24 offset:36864
    v_mfma_f32_16x16x32_bf16 a[44:47], a[176:179], v[152:155], a[44:47]
    ds_read_b128 a[216:219], v10 offset:57344
    v_cvt_pk_bf16_f32 v163, v210, v211
    v_mfma_f32_16x16x32_bf16 a[44:47], a[180:183], v[156:159], a[44:47]
    s_waitcnt lgkmcnt(3)
    buffer_load_dwordx4 v47, s[20:23], s49 offen offset:1024 lds
    v_mfma_f32_16x16x32_bf16 v[208:211], a[224:227], v[96:99], v[200:203]
    v_exp_f32 v212, v212
    v_mfma_f32_16x16x32_bf16 v[208:211], a[228:231], v[100:103], v[208:211]
    v_exp_f32 v213, v213
    v_mfma_f32_16x16x32_bf16 v[208:211], a[232:235], v[104:107], v[208:211]
    v_exp_f32 v214, v214
    v_mfma_f32_16x16x32_bf16 v[208:211], a[236:239], v[108:111], v[208:211]
    v_exp_f32 v215, v215
    v_mfma_f32_16x16x32_bf16 a[48:51], a[184:187], v[128:131], a[48:51]
    ds_read_b64_tr_b16 a[164:165], v24 offset:40960
    v_cvt_pk_bf16_f32 v170, v212, v213
    v_mfma_f32_16x16x32_bf16 a[48:51], a[188:191], v[132:135], a[48:51]
    ds_read_b64_tr_b16 a[166:167], v24 offset:45056
    v_mfma_f32_16x16x32_bf16 a[52:55], a[184:187], v[136:139], a[52:55]
    ds_read_b128 a[220:223], v11 offset:57344
    v_cvt_pk_bf16_f32 v171, v214, v215
    v_mfma_f32_16x16x32_bf16 a[52:55], a[188:191], v[140:143], a[52:55]
    v_smfmac_f32_16x16x64_bf16 a[200:203], v[52:55], v[144:151], v50
    v_mfma_f32_16x16x32_bf16 v[212:215], a[224:227], v[112:115], v[204:207]
    v_exp_f32 v208, v208
    v_mfma_f32_16x16x32_bf16 v[212:215], a[228:231], v[116:119], v[212:215]
    v_exp_f32 v209, v209
    v_mfma_f32_16x16x32_bf16 v[212:215], a[232:235], v[120:123], v[212:215]
    v_exp_f32 v210, v210
    v_mfma_f32_16x16x32_bf16 v[212:215], a[236:239], v[124:127], v[212:215]
    v_exp_f32 v211, v211
    v_mfma_f32_16x16x32_bf16 a[56:59], a[184:187], v[144:147], a[56:59]
    ds_read_b64_tr_b16 a[168:169], v25 offset:32768
    v_cvt_pk_bf16_f32 v178, v208, v209
    v_mfma_f32_16x16x32_bf16 a[56:59], a[188:191], v[148:151], a[56:59]
    ds_read_b64_tr_b16 a[170:171], v25 offset:36864
    v_mfma_f32_16x16x32_bf16 a[60:63], a[184:187], v[152:155], a[60:63]
    ds_read_b128 a[224:227], v8 offset:61440
    v_cvt_pk_bf16_f32 v179, v210, v211
    v_mfma_f32_16x16x32_bf16 a[60:63], a[188:191], v[156:159], a[60:63]
    s_waitcnt lgkmcnt(3)
    buffer_load_dwordx4 v48, s[20:23], s49 offen offset:2048 lds
    v_mfma_f32_16x16x32_bf16 v[208:211], a[208:211], v[64:67], v[192:195]
    v_exp_f32 v212, v212
    v_mfma_f32_16x16x32_bf16 v[208:211], a[212:215], v[68:71], v[208:211]
    v_exp_f32 v213, v213
    v_mfma_f32_16x16x32_bf16 v[208:211], a[216:219], v[72:75], v[208:211]
    v_exp_f32 v214, v214
    v_mfma_f32_16x16x32_bf16 v[208:211], a[220:223], v[76:79], v[208:211]
    s_add_u32 s57, s58, 589824
    v_exp_f32 v215, v215
    v_mfma_f32_16x16x32_bf16 a[64:67], a[160:163], v[128:131], a[64:67]
    ds_read_b64_tr_b16 a[172:173], v25 offset:40960
    v_cvt_pk_bf16_f32 v186, v212, v213
    v_mfma_f32_16x16x32_bf16 a[64:67], a[164:167], v[132:135], a[64:67]
    ds_read_b64_tr_b16 a[174:175], v25 offset:45056
    v_mfma_f32_16x16x32_bf16 a[68:71], a[160:163], v[136:139], a[68:71]
    ds_read_b128 a[228:231], v9 offset:61440
    v_cvt_pk_bf16_f32 v187, v214, v215
    v_mfma_f32_16x16x32_bf16 a[68:71], a[164:167], v[140:143], a[68:71]
    buffer_load_dwordx4 a[248:251], v254, s[32:35], s57 offen
    v_smfmac_f32_16x16x64_bf16 a[204:207], v[52:55], v[152:159], v50
    v_mfma_f32_16x16x32_bf16 v[212:215], a[208:211], v[80:83], v[196:199]
    v_exp_f32 v208, v208
    v_mfma_f32_16x16x32_bf16 v[212:215], a[212:215], v[84:87], v[212:215]
    v_exp_f32 v209, v209
    v_mfma_f32_16x16x32_bf16 v[212:215], a[216:219], v[88:91], v[212:215]
    v_exp_f32 v210, v210
    v_mfma_f32_16x16x32_bf16 v[212:215], a[220:223], v[92:95], v[212:215]
    v_exp_f32 v211, v211
    v_mfma_f32_16x16x32_bf16 a[72:75], a[160:163], v[144:147], a[72:75]
    ds_read_b64_tr_b16 a[176:177], v26 offset:32768
    v_cvt_pk_bf16_f32 v164, v208, v209
    v_mfma_f32_16x16x32_bf16 a[72:75], a[164:167], v[148:151], a[72:75]
    ds_read_b64_tr_b16 a[178:179], v26 offset:36864
    v_mfma_f32_16x16x32_bf16 a[76:79], a[160:163], v[152:155], a[76:79]
    ds_read_b128 a[232:235], v10 offset:61440
    v_cvt_pk_bf16_f32 v165, v210, v211
    v_mfma_f32_16x16x32_bf16 a[76:79], a[164:167], v[156:159], a[76:79]
    s_waitcnt lgkmcnt(3)
    buffer_load_dwordx4 v49, s[20:23], s49 offen offset:3072 lds
    v_mfma_f32_16x16x32_bf16 v[208:211], a[208:211], v[96:99], v[200:203]
    v_exp_f32 v212, v212
    v_mfma_f32_16x16x32_bf16 v[208:211], a[212:215], v[100:103], v[208:211]
    v_exp_f32 v213, v213
    v_mfma_f32_16x16x32_bf16 v[208:211], a[216:219], v[104:107], v[208:211]
    v_exp_f32 v214, v214
    v_mfma_f32_16x16x32_bf16 v[208:211], a[220:223], v[108:111], v[208:211]
    v_exp_f32 v215, v215
    v_mfma_f32_16x16x32_bf16 a[80:83], a[168:171], v[128:131], a[80:83]
    ds_read_b64_tr_b16 a[180:181], v26 offset:40960
    v_cvt_pk_bf16_f32 v172, v212, v213
    v_mfma_f32_16x16x32_bf16 a[80:83], a[172:175], v[132:135], a[80:83]
    ds_read_b64_tr_b16 a[182:183], v26 offset:45056
    v_mfma_f32_16x16x32_bf16 a[84:87], a[168:171], v[136:139], a[84:87]
    ds_read_b128 a[236:239], v11 offset:61440
    v_cvt_pk_bf16_f32 v173, v214, v215
    v_mfma_f32_16x16x32_bf16 a[84:87], a[172:175], v[140:143], a[84:87]
    s_waitcnt vmcnt(13)
    s_barrier
    v_mfma_f32_16x16x32_bf16 v[212:215], a[208:211], v[112:115], v[204:207]
    v_exp_f32 v208, v208
    v_mfma_f32_16x16x32_bf16 v[212:215], a[212:215], v[116:119], v[212:215]
    s_add_u32 s49, s45, 73856
    v_exp_f32 v209, v209
    v_mfma_f32_16x16x32_bf16 v[212:215], a[216:219], v[120:123], v[212:215]
    s_add_u32 m0, s42, 16384
    v_exp_f32 v210, v210
    v_mfma_f32_16x16x32_bf16 v[212:215], a[220:223], v[124:127], v[212:215]
    v_exp_f32 v211, v211
    v_mfma_f32_16x16x32_bf16 a[88:91], a[168:171], v[144:147], a[88:91]
    ds_read_b64_tr_b16 a[184:185], v27 offset:32768
    v_cvt_pk_bf16_f32 v180, v208, v209
    v_mfma_f32_16x16x32_bf16 a[88:91], a[172:175], v[148:151], a[88:91]
    ds_read_b64_tr_b16 a[186:187], v27 offset:36864
    v_mfma_f32_16x16x32_bf16 a[92:95], a[168:171], v[152:155], a[92:95]
    v_cvt_pk_bf16_f32 v181, v210, v211
    v_mfma_f32_16x16x32_bf16 a[92:95], a[172:175], v[156:159], a[92:95]
    s_waitcnt lgkmcnt(3)
    buffer_load_dwordx4 v46, s[20:23], s49 offen lds
    v_mfma_f32_16x16x32_bf16 v[208:211], a[224:227], v[64:67], v[192:195]
    v_exp_f32 v212, v212
    v_mfma_f32_16x16x32_bf16 v[208:211], a[228:231], v[68:71], v[208:211]
    v_exp_f32 v213, v213
    v_mfma_f32_16x16x32_bf16 v[208:211], a[232:235], v[72:75], v[208:211]
    s_waitcnt lgkmcnt(2)
    v_exp_f32 v214, v214
    v_mfma_f32_16x16x32_bf16 v[208:211], a[236:239], v[76:79], v[208:211]
    v_exp_f32 v215, v215
    v_mfma_f32_16x16x32_bf16 a[96:99], a[176:179], v[128:131], a[96:99]
    ds_read_b64_tr_b16 a[188:189], v27 offset:40960
    v_cvt_pk_bf16_f32 v188, v212, v213
    v_mfma_f32_16x16x32_bf16 a[96:99], a[180:183], v[132:135], a[96:99]
    ds_read_b64_tr_b16 a[190:191], v27 offset:45056
    v_mfma_f32_16x16x32_bf16 a[100:103], a[176:179], v[136:139], a[100:103]
    v_cvt_pk_bf16_f32 v189, v214, v215
    v_mfma_f32_16x16x32_bf16 a[100:103], a[180:183], v[140:143], a[100:103]
    v_mfma_f32_16x16x32_bf16 v[212:215], a[224:227], v[80:83], v[196:199]
    v_exp_f32 v208, v208
    v_mfma_f32_16x16x32_bf16 v[212:215], a[228:231], v[84:87], v[212:215]
    v_exp_f32 v209, v209
    v_mfma_f32_16x16x32_bf16 v[212:215], a[232:235], v[88:91], v[212:215]
    v_exp_f32 v210, v210
    v_mfma_f32_16x16x32_bf16 v[212:215], a[236:239], v[92:95], v[212:215]
    v_exp_f32 v211, v211
    v_mfma_f32_16x16x32_bf16 a[104:107], a[176:179], v[144:147], a[104:107]
    ds_read_b64_tr_b16 a[160:161], v20 offset:49152
    v_cvt_pk_bf16_f32 v166, v208, v209
    v_mfma_f32_16x16x32_bf16 a[104:107], a[180:183], v[148:151], a[104:107]
    ds_read_b64_tr_b16 a[162:163], v20 offset:53248
    v_mfma_f32_16x16x32_bf16 a[108:111], a[176:179], v[152:155], a[108:111]
    v_cvt_pk_bf16_f32 v167, v210, v211
    v_mfma_f32_16x16x32_bf16 a[108:111], a[180:183], v[156:159], a[108:111]
    s_waitcnt lgkmcnt(3)
    buffer_load_dwordx4 v47, s[20:23], s49 offen offset:1024 lds
    v_mfma_f32_16x16x32_bf16 v[208:211], a[224:227], v[96:99], v[200:203]
    v_exp_f32 v212, v212
    v_mfma_f32_16x16x32_bf16 v[208:211], a[228:231], v[100:103], v[208:211]
    v_exp_f32 v213, v213
    v_mfma_f32_16x16x32_bf16 v[208:211], a[232:235], v[104:107], v[208:211]
    v_exp_f32 v214, v214
    v_mfma_f32_16x16x32_bf16 v[208:211], a[236:239], v[108:111], v[208:211]
    s_add_u32 s57, s58, 1179648
    v_exp_f32 v215, v215
    v_mfma_f32_16x16x32_bf16 a[112:115], a[184:187], v[128:131], a[112:115]
    s_waitcnt lgkmcnt(2)
    ds_read_b64_tr_b16 a[164:165], v20 offset:57344
    v_cvt_pk_bf16_f32 v174, v212, v213
    v_mfma_f32_16x16x32_bf16 a[112:115], a[188:191], v[132:135], a[112:115]
    ds_read_b64_tr_b16 a[166:167], v20 offset:61440
    v_mfma_f32_16x16x32_bf16 a[116:119], a[184:187], v[136:139], a[116:119]
    v_cvt_pk_bf16_f32 v175, v214, v215
    v_mfma_f32_16x16x32_bf16 a[116:119], a[188:191], v[140:143], a[116:119]
    buffer_load_dwordx4 a[252:255], v254, s[32:35], s57 offen
    v_mfma_f32_16x16x32_bf16 v[212:215], a[224:227], v[112:115], v[204:207]
    v_exp_f32 v208, v208
    v_mfma_f32_16x16x32_bf16 v[212:215], a[228:231], v[116:119], v[212:215]
    v_exp_f32 v209, v209
    v_mfma_f32_16x16x32_bf16 v[212:215], a[232:235], v[120:123], v[212:215]
    v_exp_f32 v210, v210
    v_mfma_f32_16x16x32_bf16 v[212:215], a[236:239], v[124:127], v[212:215]
    v_exp_f32 v211, v211
    v_mfma_f32_16x16x32_bf16 a[120:123], a[184:187], v[144:147], a[120:123]
    ds_read_b64_tr_b16 a[168:169], v21 offset:49152
    v_cvt_pk_bf16_f32 v182, v208, v209
    v_mfma_f32_16x16x32_bf16 a[120:123], a[188:191], v[148:151], a[120:123]
    ds_read_b64_tr_b16 a[170:171], v21 offset:53248
    v_mfma_f32_16x16x32_bf16 a[124:127], a[184:187], v[152:155], a[124:127]
    v_cvt_pk_bf16_f32 v183, v210, v211
    v_mfma_f32_16x16x32_bf16 a[124:127], a[188:191], v[156:159], a[124:127]
    s_waitcnt lgkmcnt(3)
    buffer_load_dwordx4 v48, s[20:23], s49 offen offset:2048 lds
    v_exp_f32 v212, v212
    v_exp_f32 v213, v213
    v_exp_f32 v214, v214
    v_exp_f32 v215, v215
    v_mfma_f32_16x16x32_bf16 a[0:3], a[160:163], v[160:163], a[0:3]
    s_waitcnt lgkmcnt(2)
    ds_read_b64_tr_b16 a[172:173], v21 offset:57344
    v_cvt_pk_bf16_f32 v190, v212, v213
    v_mfma_f32_16x16x32_bf16 a[0:3], a[164:167], v[164:167], a[0:3]
    ds_read_b64_tr_b16 a[174:175], v21 offset:61440
    v_mfma_f32_16x16x32_bf16 a[4:7], a[160:163], v[168:171], a[4:7]
    v_cvt_pk_bf16_f32 v191, v214, v215
    v_mfma_f32_16x16x32_bf16 a[4:7], a[164:167], v[172:175], a[4:7]
    v_mfma_f32_16x16x32_bf16 a[8:11], a[160:163], v[176:179], a[8:11]
    ds_read_b64_tr_b16 a[176:177], v22 offset:49152
    v_mfma_f32_16x16x32_bf16 a[8:11], a[164:167], v[180:183], a[8:11]
    ds_read_b64_tr_b16 a[178:179], v22 offset:53248
    v_mfma_f32_16x16x32_bf16 a[12:15], a[160:163], v[184:187], a[12:15]
    v_mfma_f32_16x16x32_bf16 a[12:15], a[164:167], v[188:191], a[12:15]
    buffer_load_dwordx4 v49, s[20:23], s49 offen offset:3072 lds
    v_smfmac_f32_16x16x64_bf16 a[192:195], v[52:55], v[160:167], v50
    s_waitcnt lgkmcnt(4)
    v_mfma_f32_16x16x32_bf16 a[16:19], a[168:171], v[160:163], a[16:19]
    s_waitcnt lgkmcnt(2)
    ds_read_b64_tr_b16 a[180:181], v22 offset:57344
    v_mfma_f32_16x16x32_bf16 a[16:19], a[172:175], v[164:167], a[16:19]
    ds_read_b64_tr_b16 a[182:183], v22 offset:61440
    v_mfma_f32_16x16x32_bf16 a[20:23], a[168:171], v[168:171], a[20:23]
    v_mfma_f32_16x16x32_bf16 a[20:23], a[172:175], v[172:175], a[20:23]
    v_smfmac_f32_16x16x64_bf16 a[196:199], v[52:55], v[168:175], v50
    s_add_u32 s49, s45, 256
    s_add_u32 m0, s42, 32768
    v_mfma_f32_16x16x32_bf16 a[24:27], a[168:171], v[176:179], a[24:27]
    ds_read_b64_tr_b16 a[184:185], v23 offset:49152
    v_mfma_f32_16x16x32_bf16 a[24:27], a[172:175], v[180:183], a[24:27]
    ds_read_b64_tr_b16 a[186:187], v23 offset:53248
    v_mfma_f32_16x16x32_bf16 a[28:31], a[168:171], v[184:187], a[28:31]
    v_mfma_f32_16x16x32_bf16 a[28:31], a[172:175], v[188:191], a[28:31]
    buffer_load_dwordx4 v46, s[20:23], s49 offen lds
    v_smfmac_f32_16x16x64_bf16 a[200:203], v[52:55], v[176:183], v50
    s_waitcnt lgkmcnt(4)
    v_mfma_f32_16x16x32_bf16 a[32:35], a[176:179], v[160:163], a[32:35]
    s_waitcnt lgkmcnt(2)
    ds_read_b64_tr_b16 a[188:189], v23 offset:57344
    v_mfma_f32_16x16x32_bf16 a[32:35], a[180:183], v[164:167], a[32:35]
    ds_read_b64_tr_b16 a[190:191], v23 offset:61440
    v_mfma_f32_16x16x32_bf16 a[36:39], a[176:179], v[168:171], a[36:39]
    v_mfma_f32_16x16x32_bf16 a[36:39], a[180:183], v[172:175], a[36:39]
    v_smfmac_f32_16x16x64_bf16 a[204:207], v[52:55], v[184:191], v50
    v_mfma_f32_16x16x32_bf16 a[40:43], a[176:179], v[176:179], a[40:43]
    ds_read_b64_tr_b16 a[160:161], v24 offset:49152
    v_mfma_f32_16x16x32_bf16 a[40:43], a[180:183], v[180:183], a[40:43]
    ds_read_b64_tr_b16 a[162:163], v24 offset:53248
    v_mfma_f32_16x16x32_bf16 a[44:47], a[176:179], v[184:187], a[44:47]
    v_mfma_f32_16x16x32_bf16 a[44:47], a[180:183], v[188:191], a[44:47]
    s_waitcnt lgkmcnt(4)
    buffer_load_dwordx4 v47, s[20:23], s49 offen offset:1024 lds
    v_mfma_f32_16x16x32_bf16 a[48:51], a[184:187], v[160:163], a[48:51]
    s_waitcnt lgkmcnt(2)
    ds_read_b64_tr_b16 a[164:165], v24 offset:57344
    v_accvgpr_read_b32 v216, a192
    v_mfma_f32_16x16x32_bf16 a[48:51], a[188:191], v[164:167], a[48:51]
    ds_read_b64_tr_b16 a[166:167], v24 offset:61440
    v_accvgpr_read_b32 v217, a193
    v_mfma_f32_16x16x32_bf16 a[52:55], a[184:187], v[168:171], a[52:55]
    v_accvgpr_read_b32 v218, a196
    v_accvgpr_read_b32 v219, a197
    v_mfma_f32_16x16x32_bf16 a[52:55], a[188:191], v[172:175], a[52:55]
    v_accvgpr_read_b32 v220, a200
    v_accvgpr_read_b32 v221, a201
    v_mfma_f32_16x16x32_bf16 a[56:59], a[184:187], v[176:179], a[56:59]
    ds_read_b64_tr_b16 a[168:169], v25 offset:49152
    v_accvgpr_read_b32 v222, a204
    v_mfma_f32_16x16x32_bf16 a[56:59], a[188:191], v[180:183], a[56:59]
    ds_read_b64_tr_b16 a[170:171], v25 offset:53248
    v_accvgpr_read_b32 v223, a205
    v_mfma_f32_16x16x32_bf16 a[60:63], a[184:187], v[184:187], a[60:63]
    v_add_f32 v58, v216, v217
    v_add_f32 v59, v218, v219
    v_mfma_f32_16x16x32_bf16 a[60:63], a[188:191], v[188:191], a[60:63]
    s_waitcnt lgkmcnt(4)
    buffer_load_dwordx4 v48, s[20:23], s49 offen offset:2048 lds
    v_add_f32 v60, v220, v221
    v_add_f32 v61, v222, v223
    v_mfma_f32_16x16x32_bf16 a[64:67], a[160:163], v[160:163], a[64:67]
    s_waitcnt lgkmcnt(2)
    ds_read_b64_tr_b16 a[172:173], v25 offset:57344
    v_add_f32 v216, v58, v59
    v_mfma_f32_16x16x32_bf16 a[64:67], a[164:167], v[164:167], a[64:67]
    ds_read_b64_tr_b16 a[174:175], v25 offset:61440
    v_add_f32 v217, v60, v61
    v_mfma_f32_16x16x32_bf16 a[68:71], a[160:163], v[168:171], a[68:71]
    v_add_f32 v216, v216, v217
    v_cmp_ngt_f32 vcc, 1669332992, v216
    v_mfma_f32_16x16x32_bf16 a[68:71], a[164:167], v[172:175], a[68:71]
    v_rcp_f32 v58, v58
    v_rcp_f32 v59, v59
    v_mfma_f32_16x16x32_bf16 a[72:75], a[160:163], v[176:179], a[72:75]
    ds_read_b64_tr_b16 a[176:177], v26 offset:49152
    v_rcp_f32 v60, v60
    v_mfma_f32_16x16x32_bf16 a[72:75], a[164:167], v[180:183], a[72:75]
    ds_read_b64_tr_b16 a[178:179], v26 offset:53248
    v_rcp_f32 v61, v61
    v_mfma_f32_16x16x32_bf16 a[76:79], a[160:163], v[184:187], a[76:79]
    v_mov_b32 v228, 81920
    s_or_b32 s36, vcc_lo, vcc_hi
    v_mfma_f32_16x16x32_bf16 a[76:79], a[164:167], v[188:191], a[76:79]
    s_waitcnt lgkmcnt(4)
    buffer_load_dwordx4 v49, s[20:23], s49 offen offset:3072 lds
    v_mov_b32 v218, s36
    s_lshl_b32 s37, s3, 2
    v_mfma_f32_16x16x32_bf16 a[80:83], a[168:171], v[160:163], a[80:83]
    s_waitcnt lgkmcnt(2)
    ds_read_b64_tr_b16 a[180:181], v26 offset:57344
    v_add_u32 v219, s37, v228
    ds_write_b32 v219, v218
    v_mfma_f32_16x16x32_bf16 a[80:83], a[172:175], v[164:167], a[80:83]
    ds_read_b64_tr_b16 a[182:183], v26 offset:61440
    v_mfma_f32_16x16x32_bf16 a[84:87], a[168:171], v[168:171], a[84:87]
    v_mfma_f32_16x16x32_bf16 a[84:87], a[172:175], v[172:175], a[84:87]
    s_waitcnt lgkmcnt(1)
    s_waitcnt vmcnt(15)
    s_barrier
    v_mfma_f32_16x16x32_bf16 a[88:91], a[168:171], v[176:179], a[88:91]
    ds_read_b64_tr_b16 a[184:185], v27 offset:49152
    v_mfma_f32_16x16x32_bf16 a[88:91], a[172:175], v[180:183], a[88:91]
    ds_read_b64_tr_b16 a[186:187], v27 offset:53248
    v_mfma_f32_16x16x32_bf16 a[92:95], a[168:171], v[184:187], a[92:95]
    ds_read_b128 v[224:227], v228
    v_mfma_f32_16x16x32_bf16 a[92:95], a[172:175], v[188:191], a[92:95]
    s_add_u32 s49, s45, 73984
    v_mfma_f32_16x16x32_bf16 a[96:99], a[176:179], v[160:163], a[96:99]
    s_waitcnt lgkmcnt(3)
    s_add_u32 m0, s42, 49152
    ds_read_b64_tr_b16 a[188:189], v27 offset:57344
    v_mfma_f32_16x16x32_bf16 a[96:99], a[180:183], v[164:167], a[96:99]
    ds_read_b64_tr_b16 a[190:191], v27 offset:61440
    buffer_load_dwordx4 v46, s[20:23], s49 offen lds
    v_mfma_f32_16x16x32_bf16 a[100:103], a[176:179], v[168:171], a[100:103]
    v_mfma_f32_16x16x32_bf16 a[100:103], a[180:183], v[172:175], a[100:103]
    buffer_load_dwordx4 v47, s[20:23], s49 offen offset:1024 lds
    v_mfma_f32_16x16x32_bf16 a[104:107], a[176:179], v[176:179], a[104:107]
    v_mfma_f32_16x16x32_bf16 a[104:107], a[180:183], v[180:183], a[104:107]
    buffer_load_dwordx4 v48, s[20:23], s49 offen offset:2048 lds
    v_mfma_f32_16x16x32_bf16 a[108:111], a[176:179], v[184:187], a[108:111]
    v_mfma_f32_16x16x32_bf16 a[108:111], a[180:183], v[188:191], a[108:111]
    s_waitcnt lgkmcnt(3)
    buffer_load_dwordx4 v49, s[20:23], s49 offen offset:3072 lds
    s_add_u32 s49, s45, 384
    v_mfma_f32_16x16x32_bf16 a[112:115], a[184:187], v[160:163], a[112:115]
    s_waitcnt lgkmcnt(0)
    s_add_u32 m0, s42, 65536
    v_mfma_f32_16x16x32_bf16 a[112:115], a[188:191], v[164:167], a[112:115]
    buffer_load_dwordx4 v46, s[20:23], s49 offen lds
    v_mfma_f32_16x16x32_bf16 a[116:119], a[184:187], v[168:171], a[116:119]
    v_mfma_f32_16x16x32_bf16 a[116:119], a[188:191], v[172:175], a[116:119]
    buffer_load_dwordx4 v47, s[20:23], s49 offen offset:1024 lds
    v_mfma_f32_16x16x32_bf16 a[120:123], a[184:187], v[176:179], a[120:123]
    v_mfma_f32_16x16x32_bf16 a[120:123], a[188:191], v[180:183], a[120:123]
    buffer_load_dwordx4 v48, s[20:23], s49 offen offset:2048 lds
    v_mfma_f32_16x16x32_bf16 a[124:127], a[184:187], v[184:187], a[124:127]
    v_mfma_f32_16x16x32_bf16 a[124:127], a[188:191], v[188:191], a[124:127]
    buffer_load_dwordx4 v49, s[20:23], s49 offen offset:3072 lds
    v_or3_b32 v224, v224, v225, v226
    v_or_b32 v224, v224, v227
    s_nop 0
    v_readfirstlane_b32 s36, v224
    v_readfirstlane_b32 s37, v63
    ds_read_b64_tr_b16 a[208:209], v28 offset:0
    ds_read_b64_tr_b16 a[210:211], v28 offset:4096
    ds_read_b64_tr_b16 a[212:213], v28 offset:8192
    ds_read_b64_tr_b16 a[214:215], v28 offset:12288
    ds_read_b64_tr_b16 a[216:217], v28 offset:16384
    ds_read_b64_tr_b16 a[218:219], v28 offset:20480
    ds_read_b64_tr_b16 a[220:221], v28 offset:24576
    ds_read_b64_tr_b16 a[222:223], v28 offset:28672
    ds_read_b64_tr_b16 a[224:225], v32 offset:0
    ds_read_b64_tr_b16 a[226:227], v32 offset:4096
    ds_read_b64_tr_b16 a[228:229], v32 offset:8192
    ds_read_b64_tr_b16 a[230:231], v32 offset:12288
    ds_read_b64_tr_b16 a[232:233], v32 offset:16384
    ds_read_b64_tr_b16 a[234:235], v32 offset:20480
    ds_read_b64_tr_b16 a[236:237], v32 offset:24576
    ds_read_b64_tr_b16 a[238:239], v32 offset:28672
    s_andn2_b32 s36, s36, s48
    s_cbranch_scc1 Lattn_redo
    s_cmp_lt_u32 s37, 256
    s_cbranch_scc1 Lattn_armwait
Lattn_armed:
    v_accvgpr_read_b32 v216, a0
    v_accvgpr_read_b32 v217, a1
    v_accvgpr_read_b32 v218, a2
    v_accvgpr_read_b32 v219, a3
    v_pk_mul_f32 v[216:217], v[216:217], v[58:59] op_sel:[0,0] op_sel_hi:[1,0]
    v_pk_mul_f32 v[218:219], v[218:219], v[58:59] op_sel:[0,0] op_sel_hi:[1,0]
    v_cvt_pk_bf16_f32 v128, v216, v217
    v_cvt_pk_bf16_f32 v129, v218, v219
    v_accvgpr_read_b32 v220, a4
    v_accvgpr_read_b32 v221, a5
    v_accvgpr_read_b32 v222, a6
    v_accvgpr_read_b32 v223, a7
    v_pk_mul_f32 v[220:221], v[220:221], v[58:59] op_sel:[0,1] op_sel_hi:[1,1]
    v_pk_mul_f32 v[222:223], v[222:223], v[58:59] op_sel:[0,1] op_sel_hi:[1,1]
    v_cvt_pk_bf16_f32 v160, v220, v221
    v_cvt_pk_bf16_f32 v161, v222, v223
    v_accvgpr_read_b32 v224, a8
    v_accvgpr_read_b32 v225, a9
    v_accvgpr_read_b32 v226, a10
    v_accvgpr_read_b32 v227, a11
    v_pk_mul_f32 v[224:225], v[224:225], v[60:61] op_sel:[0,0] op_sel_hi:[1,0]
    v_pk_mul_f32 v[226:227], v[226:227], v[60:61] op_sel:[0,0] op_sel_hi:[1,0]
    v_cvt_pk_bf16_f32 v144, v224, v225
    v_cvt_pk_bf16_f32 v145, v226, v227
    s_add_u32 s57, s58, 1769472
    buffer_load_dwordx4 a[0:3], v254, s[32:35], s57 offen
    v_accvgpr_read_b32 v228, a12
    v_accvgpr_read_b32 v229, a13
    v_accvgpr_read_b32 v230, a14
    v_accvgpr_read_b32 v231, a15
    v_pk_mul_f32 v[228:229], v[228:229], v[60:61] op_sel:[0,1] op_sel_hi:[1,1]
    v_pk_mul_f32 v[230:231], v[230:231], v[60:61] op_sel:[0,1] op_sel_hi:[1,1]
    v_cvt_pk_bf16_f32 v176, v228, v229
    v_cvt_pk_bf16_f32 v177, v230, v231
    v_accvgpr_read_b32 v216, a16
    v_accvgpr_read_b32 v217, a17
    v_accvgpr_read_b32 v218, a18
    v_accvgpr_read_b32 v219, a19
    v_pk_mul_f32 v[216:217], v[216:217], v[58:59] op_sel:[0,0] op_sel_hi:[1,0]
    v_pk_mul_f32 v[218:219], v[218:219], v[58:59] op_sel:[0,0] op_sel_hi:[1,0]
    v_cvt_pk_bf16_f32 v130, v216, v217
    v_cvt_pk_bf16_f32 v131, v218, v219
    s_add_u32 s57, s58, 2359296
    buffer_load_dwordx4 a[4:7], v254, s[32:35], s57 offen
    v_accvgpr_read_b32 v220, a20
    v_accvgpr_read_b32 v221, a21
    v_accvgpr_read_b32 v222, a22
    v_accvgpr_read_b32 v223, a23
    v_pk_mul_f32 v[220:221], v[220:221], v[58:59] op_sel:[0,1] op_sel_hi:[1,1]
    v_pk_mul_f32 v[222:223], v[222:223], v[58:59] op_sel:[0,1] op_sel_hi:[1,1]
    v_cvt_pk_bf16_f32 v162, v220, v221
    v_cvt_pk_bf16_f32 v163, v222, v223
    v_accvgpr_read_b32 v224, a24
    v_accvgpr_read_b32 v225, a25
    v_accvgpr_read_b32 v226, a26
    v_accvgpr_read_b32 v227, a27
    v_pk_mul_f32 v[224:225], v[224:225], v[60:61] op_sel:[0,0] op_sel_hi:[1,0]
    v_pk_mul_f32 v[226:227], v[226:227], v[60:61] op_sel:[0,0] op_sel_hi:[1,0]
    v_cvt_pk_bf16_f32 v146, v224, v225
    v_cvt_pk_bf16_f32 v147, v226, v227
    s_add_u32 s57, s58, 2949120
    buffer_load_dwordx4 a[8:11], v254, s[32:35], s57 offen
    v_accvgpr_read_b32 v228, a28
    v_accvgpr_read_b32 v229, a29
    v_accvgpr_read_b32 v230, a30
    v_accvgpr_read_b32 v231, a31
    v_pk_mul_f32 v[228:229], v[228:229], v[60:61] op_sel:[0,1] op_sel_hi:[1,1]
    v_pk_mul_f32 v[230:231], v[230:231], v[60:61] op_sel:[0,1] op_sel_hi:[1,1]
    v_cvt_pk_bf16_f32 v178, v228, v229
    v_cvt_pk_bf16_f32 v179, v230, v231
    v_accvgpr_read_b32 v216, a32
    v_accvgpr_read_b32 v217, a33
    v_accvgpr_read_b32 v218, a34
    v_accvgpr_read_b32 v219, a35
    v_pk_mul_f32 v[216:217], v[216:217], v[58:59] op_sel:[0,0] op_sel_hi:[1,0]
    v_pk_mul_f32 v[218:219], v[218:219], v[58:59] op_sel:[0,0] op_sel_hi:[1,0]
    v_cvt_pk_bf16_f32 v132, v216, v217
    v_cvt_pk_bf16_f32 v133, v218, v219
    s_add_u32 s57, s58, 3538944
    buffer_load_dwordx4 a[12:15], v254, s[32:35], s57 offen
    v_accvgpr_read_b32 v220, a36
    v_accvgpr_read_b32 v221, a37
    v_accvgpr_read_b32 v222, a38
    v_accvgpr_read_b32 v223, a39
    v_pk_mul_f32 v[220:221], v[220:221], v[58:59] op_sel:[0,1] op_sel_hi:[1,1]
    v_pk_mul_f32 v[222:223], v[222:223], v[58:59] op_sel:[0,1] op_sel_hi:[1,1]
    v_cvt_pk_bf16_f32 v164, v220, v221
    v_cvt_pk_bf16_f32 v165, v222, v223
    v_accvgpr_read_b32 v224, a40
    v_accvgpr_read_b32 v225, a41
    v_accvgpr_read_b32 v226, a42
    v_accvgpr_read_b32 v227, a43
    v_pk_mul_f32 v[224:225], v[224:225], v[60:61] op_sel:[0,0] op_sel_hi:[1,0]
    v_pk_mul_f32 v[226:227], v[226:227], v[60:61] op_sel:[0,0] op_sel_hi:[1,0]
    v_cvt_pk_bf16_f32 v148, v224, v225
    v_cvt_pk_bf16_f32 v149, v226, v227
    s_add_u32 s57, s58, 4128768
    buffer_load_dwordx4 a[16:19], v254, s[32:35], s57 offen
    v_accvgpr_read_b32 v228, a44
    v_accvgpr_read_b32 v229, a45
    v_accvgpr_read_b32 v230, a46
    v_accvgpr_read_b32 v231, a47
    v_pk_mul_f32 v[228:229], v[228:229], v[60:61] op_sel:[0,1] op_sel_hi:[1,1]
    v_pk_mul_f32 v[230:231], v[230:231], v[60:61] op_sel:[0,1] op_sel_hi:[1,1]
    v_cvt_pk_bf16_f32 v180, v228, v229
    v_cvt_pk_bf16_f32 v181, v230, v231
    v_accvgpr_read_b32 v216, a48
    v_accvgpr_read_b32 v217, a49
    v_accvgpr_read_b32 v218, a50
    v_accvgpr_read_b32 v219, a51
    v_pk_mul_f32 v[216:217], v[216:217], v[58:59] op_sel:[0,0] op_sel_hi:[1,0]
    v_pk_mul_f32 v[218:219], v[218:219], v[58:59] op_sel:[0,0] op_sel_hi:[1,0]
    v_cvt_pk_bf16_f32 v134, v216, v217
    v_cvt_pk_bf16_f32 v135, v218, v219
    s_add_u32 s57, s58, 4718592
    buffer_load_dwordx4 a[20:23], v254, s[32:35], s57 offen
    v_accvgpr_read_b32 v220, a52
    v_accvgpr_read_b32 v221, a53
    v_accvgpr_read_b32 v222, a54
    v_accvgpr_read_b32 v223, a55
    v_pk_mul_f32 v[220:221], v[220:221], v[58:59] op_sel:[0,1] op_sel_hi:[1,1]
    v_pk_mul_f32 v[222:223], v[222:223], v[58:59] op_sel:[0,1] op_sel_hi:[1,1]
    v_cvt_pk_bf16_f32 v166, v220, v221
    v_cvt_pk_bf16_f32 v167, v222, v223
    v_accvgpr_read_b32 v224, a56
    v_accvgpr_read_b32 v225, a57
    v_accvgpr_read_b32 v226, a58
    v_accvgpr_read_b32 v227, a59
    v_pk_mul_f32 v[224:225], v[224:225], v[60:61] op_sel:[0,0] op_sel_hi:[1,0]
    v_pk_mul_f32 v[226:227], v[226:227], v[60:61] op_sel:[0,0] op_sel_hi:[1,0]
    v_cvt_pk_bf16_f32 v150, v224, v225
    v_cvt_pk_bf16_f32 v151, v226, v227
    s_add_u32 s57, s59, 0
    buffer_load_dwordx4 a[24:27], v255, s[84:87], s57 offen
    v_accvgpr_read_b32 v228, a60
    v_accvgpr_read_b32 v229, a61
    v_accvgpr_read_b32 v230, a62
    v_accvgpr_read_b32 v231, a63
    v_pk_mul_f32 v[228:229], v[228:229], v[60:61] op_sel:[0,1] op_sel_hi:[1,1]
    v_pk_mul_f32 v[230:231], v[230:231], v[60:61] op_sel:[0,1] op_sel_hi:[1,1]
    v_cvt_pk_bf16_f32 v182, v228, v229
    v_cvt_pk_bf16_f32 v183, v230, v231
    v_accvgpr_read_b32 v216, a64
    v_accvgpr_read_b32 v217, a65
    v_accvgpr_read_b32 v218, a66
    v_accvgpr_read_b32 v219, a67
    v_pk_mul_f32 v[216:217], v[216:217], v[58:59] op_sel:[0,0] op_sel_hi:[1,0]
    v_pk_mul_f32 v[218:219], v[218:219], v[58:59] op_sel:[0,0] op_sel_hi:[1,0]
    v_cvt_pk_bf16_f32 v136, v216, v217
    v_cvt_pk_bf16_f32 v137, v218, v219
    v_accvgpr_read_b32 v220, a68
    v_accvgpr_read_b32 v221, a69
    v_accvgpr_read_b32 v222, a70
    v_accvgpr_read_b32 v223, a71
    v_pk_mul_f32 v[220:221], v[220:221], v[58:59] op_sel:[0,1] op_sel_hi:[1,1]
    v_pk_mul_f32 v[222:223], v[222:223], v[58:59] op_sel:[0,1] op_sel_hi:[1,1]
    v_cvt_pk_bf16_f32 v168, v220, v221
    v_cvt_pk_bf16_f32 v169, v222, v223
    s_add_u32 s57, s59, 4096
    buffer_load_dwordx4 a[28:31], v255, s[84:87], s57 offen
    v_accvgpr_read_b32 v224, a72
    v_accvgpr_read_b32 v225, a73
    v_accvgpr_read_b32 v226, a74
    v_accvgpr_read_b32 v227, a75
    v_pk_mul_f32 v[224:225], v[224:225], v[60:61] op_sel:[0,0] op_sel_hi:[1,0]
    v_pk_mul_f32 v[226:227], v[226:227], v[60:61] op_sel:[0,0] op_sel_hi:[1,0]
    v_cvt_pk_bf16_f32 v152, v224, v225
    v_cvt_pk_bf16_f32 v153, v226, v227
    v_accvgpr_read_b32 v228, a76
    v_accvgpr_read_b32 v229, a77
    v_accvgpr_read_b32 v230, a78
    v_accvgpr_read_b32 v231, a79
    v_pk_mul_f32 v[228:229], v[228:229], v[60:61] op_sel:[0,1] op_sel_hi:[1,1]
    v_pk_mul_f32 v[230:231], v[230:231], v[60:61] op_sel:[0,1] op_sel_hi:[1,1]
    v_cvt_pk_bf16_f32 v184, v228, v229
    v_cvt_pk_bf16_f32 v185, v230, v231
    s_add_u32 s57, s59, 8192
    buffer_load_dwordx4 a[32:35], v255, s[84:87], s57 offen
    v_accvgpr_read_b32 v216, a80
    v_accvgpr_read_b32 v217, a81
    v_accvgpr_read_b32 v218, a82
    v_accvgpr_read_b32 v219, a83
    v_pk_mul_f32 v[216:217], v[216:217], v[58:59] op_sel:[0,0] op_sel_hi:[1,0]
    v_pk_mul_f32 v[218:219], v[218:219], v[58:59] op_sel:[0,0] op_sel_hi:[1,0]
    v_cvt_pk_bf16_f32 v138, v216, v217
    v_cvt_pk_bf16_f32 v139, v218, v219
    v_accvgpr_read_b32 v220, a84
    v_accvgpr_read_b32 v221, a85
    v_accvgpr_read_b32 v222, a86
    v_accvgpr_read_b32 v223, a87
    v_pk_mul_f32 v[220:221], v[220:221], v[58:59] op_sel:[0,1] op_sel_hi:[1,1]
    v_pk_mul_f32 v[222:223], v[222:223], v[58:59] op_sel:[0,1] op_sel_hi:[1,1]
    v_cvt_pk_bf16_f32 v170, v220, v221
    v_cvt_pk_bf16_f32 v171, v222, v223
    s_add_u32 s57, s59, 12288
    buffer_load_dwordx4 a[36:39], v255, s[84:87], s57 offen
    v_accvgpr_read_b32 v224, a88
    v_accvgpr_read_b32 v225, a89
    v_accvgpr_read_b32 v226, a90
    v_accvgpr_read_b32 v227, a91
    v_pk_mul_f32 v[224:225], v[224:225], v[60:61] op_sel:[0,0] op_sel_hi:[1,0]
    v_pk_mul_f32 v[226:227], v[226:227], v[60:61] op_sel:[0,0] op_sel_hi:[1,0]
    v_cvt_pk_bf16_f32 v154, v224, v225
    v_cvt_pk_bf16_f32 v155, v226, v227
    v_accvgpr_read_b32 v228, a92
    v_accvgpr_read_b32 v229, a93
    v_accvgpr_read_b32 v230, a94
    v_accvgpr_read_b32 v231, a95
    v_pk_mul_f32 v[228:229], v[228:229], v[60:61] op_sel:[0,1] op_sel_hi:[1,1]
    v_pk_mul_f32 v[230:231], v[230:231], v[60:61] op_sel:[0,1] op_sel_hi:[1,1]
    v_cvt_pk_bf16_f32 v186, v228, v229
    v_cvt_pk_bf16_f32 v187, v230, v231
    s_add_u32 s57, s59, 16384
    buffer_load_dwordx4 a[40:43], v255, s[84:87], s57 offen
    v_accvgpr_read_b32 v216, a96
    v_accvgpr_read_b32 v217, a97
    v_accvgpr_read_b32 v218, a98
    v_accvgpr_read_b32 v219, a99
    v_pk_mul_f32 v[216:217], v[216:217], v[58:59] op_sel:[0,0] op_sel_hi:[1,0]
    v_pk_mul_f32 v[218:219], v[218:219], v[58:59] op_sel:[0,0] op_sel_hi:[1,0]
    v_cvt_pk_bf16_f32 v140, v216, v217
    v_cvt_pk_bf16_f32 v141, v218, v219
    v_accvgpr_read_b32 v220, a100
    v_accvgpr_read_b32 v221, a101
    v_accvgpr_read_b32 v222, a102
    v_accvgpr_read_b32 v223, a103
    v_pk_mul_f32 v[220:221], v[220:221], v[58:59] op_sel:[0,1] op_sel_hi:[1,1]
    v_pk_mul_f32 v[222:223], v[222:223], v[58:59] op_sel:[0,1] op_sel_hi:[1,1]
    v_cvt_pk_bf16_f32 v172, v220, v221
    v_cvt_pk_bf16_f32 v173, v222, v223
    s_add_u32 s57, s59, 20480
    buffer_load_dwordx4 a[44:47], v255, s[84:87], s57 offen
    v_accvgpr_read_b32 v224, a104
    v_accvgpr_read_b32 v225, a105
    v_accvgpr_read_b32 v226, a106
    v_accvgpr_read_b32 v227, a107
    v_pk_mul_f32 v[224:225], v[224:225], v[60:61] op_sel:[0,0] op_sel_hi:[1,0]
    v_pk_mul_f32 v[226:227], v[226:227], v[60:61] op_sel:[0,0] op_sel_hi:[1,0]
    v_cvt_pk_bf16_f32 v156, v224, v225
    v_cvt_pk_bf16_f32 v157, v226, v227
    v_accvgpr_read_b32 v228, a108
    v_accvgpr_read_b32 v229, a109
    v_accvgpr_read_b32 v230, a110
    v_accvgpr_read_b32 v231, a111
    v_pk_mul_f32 v[228:229], v[228:229], v[60:61] op_sel:[0,1] op_sel_hi:[1,1]
    v_pk_mul_f32 v[230:231], v[230:231], v[60:61] op_sel:[0,1] op_sel_hi:[1,1]
    v_cvt_pk_bf16_f32 v188, v228, v229
    v_cvt_pk_bf16_f32 v189, v230, v231
    s_add_u32 s57, s59, 24576
    buffer_load_dwordx4 a[48:51], v255, s[84:87], s57 offen
    v_accvgpr_read_b32 v216, a112
    v_accvgpr_read_b32 v217, a113
    v_accvgpr_read_b32 v218, a114
    v_accvgpr_read_b32 v219, a115
    v_pk_mul_f32 v[216:217], v[216:217], v[58:59] op_sel:[0,0] op_sel_hi:[1,0]
    v_pk_mul_f32 v[218:219], v[218:219], v[58:59] op_sel:[0,0] op_sel_hi:[1,0]
    v_cvt_pk_bf16_f32 v142, v216, v217
    v_cvt_pk_bf16_f32 v143, v218, v219
    v_accvgpr_read_b32 v220, a116
    v_accvgpr_read_b32 v221, a117
    v_accvgpr_read_b32 v222, a118
    v_accvgpr_read_b32 v223, a119
    v_pk_mul_f32 v[220:221], v[220:221], v[58:59] op_sel:[0,1] op_sel_hi:[1,1]
    v_pk_mul_f32 v[222:223], v[222:223], v[58:59] op_sel:[0,1] op_sel_hi:[1,1]
    v_cvt_pk_bf16_f32 v174, v220, v221
    v_cvt_pk_bf16_f32 v175, v222, v223
    s_add_u32 s57, s59, 28672
    buffer_load_dwordx4 a[52:55], v255, s[84:87], s57 offen
    v_accvgpr_read_b32 v224, a120
    v_accvgpr_read_b32 v225, a121
    v_accvgpr_read_b32 v226, a122
    v_accvgpr_read_b32 v227, a123
    v_pk_mul_f32 v[224:225], v[224:225], v[60:61] op_sel:[0,0] op_sel_hi:[1,0]
    v_pk_mul_f32 v[226:227], v[226:227], v[60:61] op_sel:[0,0] op_sel_hi:[1,0]
    v_cvt_pk_bf16_f32 v158, v224, v225
    v_cvt_pk_bf16_f32 v159, v226, v227
    v_accvgpr_read_b32 v228, a124
    v_accvgpr_read_b32 v229, a125
    v_accvgpr_read_b32 v230, a126
    v_accvgpr_read_b32 v231, a127
    v_pk_mul_f32 v[228:229], v[228:229], v[60:61] op_sel:[0,1] op_sel_hi:[1,1]
    v_pk_mul_f32 v[230:231], v[230:231], v[60:61] op_sel:[0,1] op_sel_hi:[1,1]
    v_cvt_pk_bf16_f32 v190, v228, v229
    v_cvt_pk_bf16_f32 v191, v230, v231
    s_add_u32 s57, s59, 32768
    buffer_load_dwordx4 a[56:59], v255, s[84:87], s57 offen
    s_waitcnt lgkmcnt(14)
    v_mfma_f32_16x16x32_bf16 v[192:195], a[208:211], v[128:131], 0
    s_waitcnt lgkmcnt(12)
    ds_read_b64_tr_b16 a[160:161], v29 offset:0
    v_mfma_f32_16x16x32_bf16 v[192:195], a[212:215], v[132:135], v[192:195]
    s_waitcnt lgkmcnt(11)
    ds_read_b64_tr_b16 a[162:163], v29 offset:4096
    v_mfma_f32_16x16x32_bf16 v[192:195], a[216:219], v[136:139], v[192:195]
    s_waitcnt lgkmcnt(10)
    s_load_dwordx2 s[12:13], s[0:1], 0
    ds_read_b64_tr_b16 a[164:165], v29 offset:8192
    v_mfma_f32_16x16x32_bf16 v[192:195], a[220:223], v[140:143], v[192:195]
    s_waitcnt lgkmcnt(9)
    s_load_dwordx2 s[16:17], s[0:1], 96
    ds_read_b64_tr_b16 a[166:167], v29 offset:12288
    v_mfma_f32_16x16x32_bf16 v[192:195], a[224:227], v[144:147], v[192:195]
    s_waitcnt lgkmcnt(8)
    s_load_dwordx2 s[52:53], s[0:1], 48
    ds_read_b64_tr_b16 a[168:169], v29 offset:16384
    v_mfma_f32_16x16x32_bf16 v[192:195], a[228:231], v[148:151], v[192:195]
    s_waitcnt lgkmcnt(7)
    ds_read_b64_tr_b16 a[170:171], v29 offset:20480
    v_mfma_f32_16x16x32_bf16 v[192:195], a[232:235], v[152:155], v[192:195]
    s_waitcnt lgkmcnt(6)
    ds_read_b64_tr_b16 a[172:173], v29 offset:24576
    v_mfma_f32_16x16x32_bf16 v[192:195], a[236:239], v[156:159], v[192:195]
    ds_read_b64_tr_b16 a[174:175], v29 offset:28672
    v_mfma_f32_16x16x32_bf16 v[196:199], a[208:211], v[160:163], 0
    ds_read_b64_tr_b16 a[176:177], v33 offset:0
    v_mfma_f32_16x16x32_bf16 v[196:199], a[212:215], v[164:167], v[196:199]
    ds_read_b64_tr_b16 a[178:179], v33 offset:4096
    v_mfma_f32_16x16x32_bf16 v[196:199], a[216:219], v[168:171], v[196:199]
    ds_read_b64_tr_b16 a[180:181], v33 offset:8192
    v_mfma_f32_16x16x32_bf16 v[196:199], a[220:223], v[172:175], v[196:199]
    ds_read_b64_tr_b16 a[182:183], v33 offset:12288
    v_mfma_f32_16x16x32_bf16 v[196:199], a[224:227], v[176:179], v[196:199]
    ds_read_b64_tr_b16 a[184:185], v33 offset:16384
    v_cvt_pk_bf16_f32 v224, v192, v193
    v_mfma_f32_16x16x32_bf16 v[196:199], a[228:231], v[180:183], v[196:199]
    ds_read_b64_tr_b16 a[186:187], v33 offset:20480
    v_cvt_pk_bf16_f32 v225, v194, v195
    v_mfma_f32_16x16x32_bf16 v[196:199], a[232:235], v[184:187], v[196:199]
    ds_read_b64_tr_b16 a[188:189], v33 offset:24576
    v_mfma_f32_16x16x32_bf16 v[196:199], a[236:239], v[188:191], v[196:199]
    s_waitcnt lgkmcnt(13)
    ds_read_b64_tr_b16 a[190:191], v33 offset:28672
    v_mfma_f32_16x16x32_bf16 v[200:203], a[160:163], v[128:131], 0
    s_waitcnt lgkmcnt(12)
    ds_read_b64_tr_b16 a[208:209], v30 offset:0
    v_mfma_f32_16x16x32_bf16 v[200:203], a[164:167], v[132:135], v[200:203]
    s_waitcnt lgkmcnt(11)
    ds_read_b64_tr_b16 a[210:211], v30 offset:4096
    v_mfma_f32_16x16x32_bf16 v[200:203], a[168:171], v[136:139], v[200:203]
    s_waitcnt lgkmcnt(10)
    ds_read_b64_tr_b16 a[212:213], v30 offset:8192
    v_mfma_f32_16x16x32_bf16 v[200:203], a[172:175], v[140:143], v[200:203]
    s_waitcnt lgkmcnt(9)
    ds_read_b64_tr_b16 a[214:215], v30 offset:12288
    v_mfma_f32_16x16x32_bf16 v[200:203], a[176:179], v[144:147], v[200:203]
    s_waitcnt lgkmcnt(8)
    ds_read_b64_tr_b16 a[216:217], v30 offset:16384
    v_cvt_pk_bf16_f32 v228, v196, v197
    v_mfma_f32_16x16x32_bf16 v[200:203], a[180:183], v[148:151], v[200:203]
    s_waitcnt lgkmcnt(7)
    ds_read_b64_tr_b16 a[218:219], v30 offset:20480
    v_cvt_pk_bf16_f32 v229, v198, v199
    v_mfma_f32_16x16x32_bf16 v[200:203], a[184:187], v[152:155], v[200:203]
    s_waitcnt lgkmcnt(6)
    ds_read_b64_tr_b16 a[220:221], v30 offset:24576
    v_mfma_f32_16x16x32_bf16 v[200:203], a[188:191], v[156:159], v[200:203]
    ds_read_b64_tr_b16 a[222:223], v30 offset:28672
    v_mfma_f32_16x16x32_bf16 v[204:207], a[160:163], v[160:163], 0
    ds_read_b64_tr_b16 a[224:225], v34 offset:0
    v_mfma_f32_16x16x32_bf16 v[204:207], a[164:167], v[164:167], v[204:207]
    ds_read_b64_tr_b16 a[226:227], v34 offset:4096
    v_mfma_f32_16x16x32_bf16 v[204:207], a[168:171], v[168:171], v[204:207]
    ds_read_b64_tr_b16 a[228:229], v34 offset:8192
    v_mfma_f32_16x16x32_bf16 v[204:207], a[172:175], v[172:175], v[204:207]
    ds_read_b64_tr_b16 a[230:231], v34 offset:12288
    v_mfma_f32_16x16x32_bf16 v[204:207], a[176:179], v[176:179], v[204:207]
    ds_read_b64_tr_b16 a[232:233], v34 offset:16384
    v_cvt_pk_bf16_f32 v226, v200, v201
    v_mfma_f32_16x16x32_bf16 v[204:207], a[180:183], v[180:183], v[204:207]
    s_add_u32 s38, s47, 0
    ds_read_b64_tr_b16 a[234:235], v34 offset:20480
    v_cvt_pk_bf16_f32 v227, v202, v203
    v_mfma_f32_16x16x32_bf16 v[204:207], a[184:187], v[184:187], v[204:207]
    ds_read_b64_tr_b16 a[236:237], v34 offset:24576
    buffer_store_dwordx4 v[224:227], v56, s[28:31], s38 offen sc1
    v_mfma_f32_16x16x32_bf16 v[204:207], a[188:191], v[188:191], v[204:207]
    s_waitcnt lgkmcnt(13)
    ds_read_b64_tr_b16 a[238:239], v34 offset:28672
    v_mfma_f32_16x16x32_bf16 v[192:195], a[208:211], v[128:131], 0
    s_waitcnt lgkmcnt(12)
    ds_read_b64_tr_b16 a[160:161], v31 offset:0
    v_mfma_f32_16x16x32_bf16 v[192:195], a[212:215], v[132:135], v[192:195]
    s_waitcnt lgkmcnt(11)
    ds_read_b64_tr_b16 a[162:163], v31 offset:4096
    v_mfma_f32_16x16x32_bf16 v[192:195], a[216:219], v[136:139], v[192:195]
    s_waitcnt lgkmcnt(10)
    ds_read_b64_tr_b16 a[164:165], v31 offset:8192
    v_mfma_f32_16x16x32_bf16 v[192:195], a[220:223], v[140:143], v[192:195]
    s_waitcnt lgkmcnt(9)
    ds_read_b64_tr_b16 a[166:167], v31 offset:12288
    v_mfma_f32_16x16x32_bf16 v[192:195], a[224:227], v[144:147], v[192:195]
    s_waitcnt lgkmcnt(8)
    ds_read_b64_tr_b16 a[168:169], v31 offset:16384
    v_cvt_pk_bf16_f32 v230, v204, v205
    v_mfma_f32_16x16x32_bf16 v[192:195], a[228:231], v[148:151], v[192:195]
    s_waitcnt lgkmcnt(7)
    s_add_u32 s38, s47, 294912
    ds_read_b64_tr_b16 a[170:171], v31 offset:20480
    v_cvt_pk_bf16_f32 v231, v206, v207
    v_mfma_f32_16x16x32_bf16 v[192:195], a[232:235], v[152:155], v[192:195]
    s_waitcnt lgkmcnt(6)
    ds_read_b64_tr_b16 a[172:173], v31 offset:24576
    buffer_store_dwordx4 v[228:231], v56, s[28:31], s38 offen sc1
    v_mfma_f32_16x16x32_bf16 v[192:195], a[236:239], v[156:159], v[192:195]
    ds_read_b64_tr_b16 a[174:175], v31 offset:28672
    v_mfma_f32_16x16x32_bf16 v[196:199], a[208:211], v[160:163], 0
    ds_read_b64_tr_b16 a[176:177], v35 offset:0
    v_mfma_f32_16x16x32_bf16 v[196:199], a[212:215], v[164:167], v[196:199]
    ds_read_b64_tr_b16 a[178:179], v35 offset:4096
    v_mfma_f32_16x16x32_bf16 v[196:199], a[216:219], v[168:171], v[196:199]
    ds_read_b64_tr_b16 a[180:181], v35 offset:8192
    v_mfma_f32_16x16x32_bf16 v[196:199], a[220:223], v[172:175], v[196:199]
    ds_read_b64_tr_b16 a[182:183], v35 offset:12288
    v_mfma_f32_16x16x32_bf16 v[196:199], a[224:227], v[176:179], v[196:199]
    ds_read_b64_tr_b16 a[184:185], v35 offset:16384
    v_cvt_pk_bf16_f32 v232, v192, v193
    v_mfma_f32_16x16x32_bf16 v[196:199], a[228:231], v[180:183], v[196:199]
    ds_read_b64_tr_b16 a[186:187], v35 offset:20480
    v_cvt_pk_bf16_f32 v233, v194, v195
    v_mfma_f32_16x16x32_bf16 v[196:199], a[232:235], v[184:187], v[196:199]
    ds_read_b64_tr_b16 a[188:189], v35 offset:24576
    v_mfma_f32_16x16x32_bf16 v[196:199], a[236:239], v[188:191], v[196:199]
    s_waitcnt lgkmcnt(13)
    ds_read_b64_tr_b16 a[190:191], v35 offset:28672
    s_waitcnt vmcnt(29)
    s_barrier
    v_mfma_f32_16x16x32_bf16 v[200:203], a[160:163], v[128:131], 0
    s_waitcnt lgkmcnt(12)
    ds_read_b64_tr_b16 a[208:209], v12 offset:0
    v_mfma_f32_16x16x32_bf16 v[200:203], a[164:167], v[132:135], v[200:203]
    s_waitcnt lgkmcnt(11)
    s_add_u32 s49, s45, 74112
    ds_read_b64_tr_b16 a[210:211], v12 offset:4096
    v_mfma_f32_16x16x32_bf16 v[200:203], a[168:171], v[136:139], v[200:203]
    s_waitcnt lgkmcnt(10)
    s_add_u32 m0, s42, 81920
    ds_read_b64_tr_b16 a[212:213], v12 offset:8192
    v_mfma_f32_16x16x32_bf16 v[200:203], a[172:175], v[140:143], v[200:203]
    s_waitcnt lgkmcnt(9)
    ds_read_b64_tr_b16 a[214:215], v12 offset:12288
    buffer_load_dwordx4 v46, s[20:23], s49 offen lds
    v_mfma_f32_16x16x32_bf16 v[200:203], a[176:179], v[144:147], v[200:203]
    s_waitcnt lgkmcnt(8)
    ds_read_b64_tr_b16 a[216:217], v12 offset:16384
    v_cvt_pk_bf16_f32 v236, v196, v197
    v_mfma_f32_16x16x32_bf16 v[200:203], a[180:183], v[148:151], v[200:203]
    s_waitcnt lgkmcnt(7)
    ds_read_b64_tr_b16 a[218:219], v12 offset:20480
    v_cvt_pk_bf16_f32 v237, v198, v199
    v_mfma_f32_16x16x32_bf16 v[200:203], a[184:187], v[152:155], v[200:203]
    s_waitcnt lgkmcnt(6)
    ds_read_b64_tr_b16 a[220:221], v12 offset:24576
    v_mfma_f32_16x16x32_bf16 v[200:203], a[188:191], v[156:159], v[200:203]
    ds_read_b64_tr_b16 a[222:223], v12 offset:28672
    buffer_load_dwordx4 v47, s[20:23], s49 offen offset:1024 lds
    v_mfma_f32_16x16x32_bf16 v[204:207], a[160:163], v[160:163], 0
    ds_read_b64_tr_b16 a[224:225], v16 offset:0
    v_mfma_f32_16x16x32_bf16 v[204:207], a[164:167], v[164:167], v[204:207]
    ds_read_b64_tr_b16 a[226:227], v16 offset:4096
    v_mfma_f32_16x16x32_bf16 v[204:207], a[168:171], v[168:171], v[204:207]
    ds_read_b64_tr_b16 a[228:229], v16 offset:8192
    v_mfma_f32_16x16x32_bf16 v[204:207], a[172:175], v[172:175], v[204:207]
    ds_read_b64_tr_b16 a[230:231], v16 offset:12288
    buffer_load_dwordx4 v48, s[20:23], s49 offen offset:2048 lds
    v_mfma_f32_16x16x32_bf16 v[204:207], a[176:179], v[176:179], v[204:207]
    ds_read_b64_tr_b16 a[232:233], v16 offset:16384
    v_cvt_pk_bf16_f32 v234, v200, v201
    v_mfma_f32_16x16x32_bf16 v[204:207], a[180:183], v[180:183], v[204:207]
    s_add_u32 s38, s47, 128
    ds_read_b64_tr_b16 a[234:235], v16 offset:20480
    v_cvt_pk_bf16_f32 v235, v202, v203
    v_mfma_f32_16x16x32_bf16 v[204:207], a[184:187], v[184:187], v[204:207]
    ds_read_b64_tr_b16 a[236:237], v16 offset:24576
    buffer_store_dwordx4 v[232:235], v56, s[28:31], s38 offen sc1
    v_mfma_f32_16x16x32_bf16 v[204:207], a[188:191], v[188:191], v[204:207]
    s_waitcnt lgkmcnt(13)
    ds_read_b64_tr_b16 a[238:239], v16 offset:28672
    buffer_load_dwordx4 v49, s[20:23], s49 offen offset:3072 lds
    v_mfma_f32_16x16x32_bf16 v[192:195], a[208:211], v[128:131], 0
    s_waitcnt lgkmcnt(12)
    ds_read_b64_tr_b16 a[160:161], v13 offset:0
    v_mfma_f32_16x16x32_bf16 v[192:195], a[212:215], v[132:135], v[192:195]
    s_waitcnt lgkmcnt(11)
    s_add_u32 s49, s45, 512
    ds_read_b64_tr_b16 a[162:163], v13 offset:4096
    v_mfma_f32_16x16x32_bf16 v[192:195], a[216:219], v[136:139], v[192:195]
    s_waitcnt lgkmcnt(10)
    s_add_u32 m0, s42, 98304
    ds_read_b64_tr_b16 a[164:165], v13 offset:8192
    v_mfma_f32_16x16x32_bf16 v[192:195], a[220:223], v[140:143], v[192:195]
    s_waitcnt lgkmcnt(9)
    ds_read_b64_tr_b16 a[166:167], v13 offset:12288
    buffer_load_dwordx4 v46, s[20:23], s49 offen lds
    v_mfma_f32_16x16x32_bf16 v[192:195], a[224:227], v[144:147], v[192:195]
    s_waitcnt lgkmcnt(8)
    ds_read_b64_tr_b16 a[168:169], v13 offset:16384
    v_cvt_pk_bf16_f32 v238, v204, v205
    v_mfma_f32_16x16x32_bf16 v[192:195], a[228:231], v[148:151], v[192:195]
    s_waitcnt lgkmcnt(7)
    s_add_u32 s38, s47, 295040
    ds_read_b64_tr_b16 a[170:171], v13 offset:20480
    v_cvt_pk_bf16_f32 v239, v206, v207
    v_mfma_f32_16x16x32_bf16 v[192:195], a[232:235], v[152:155], v[192:195]
    s_waitcnt lgkmcnt(6)
    ds_read_b64_tr_b16 a[172:173], v13 offset:24576
    buffer_store_dwordx4 v[236:239], v56, s[28:31], s38 offen sc1
    v_mfma_f32_16x16x32_bf16 v[192:195], a[236:239], v[156:159], v[192:195]
    ds_read_b64_tr_b16 a[174:175], v13 offset:28672
    buffer_load_dwordx4 v47, s[20:23], s49 offen offset:1024 lds
    v_mfma_f32_16x16x32_bf16 v[196:199], a[208:211], v[160:163], 0
    ds_read_b64_tr_b16 a[176:177], v17 offset:0
    v_mfma_f32_16x16x32_bf16 v[196:199], a[212:215], v[164:167], v[196:199]
    ds_read_b64_tr_b16 a[178:179], v17 offset:4096
    v_mfma_f32_16x16x32_bf16 v[196:199], a[216:219], v[168:171], v[196:199]
    ds_read_b64_tr_b16 a[180:181], v17 offset:8192
    v_mfma_f32_16x16x32_bf16 v[196:199], a[220:223], v[172:175], v[196:199]
    ds_read_b64_tr_b16 a[182:183], v17 offset:12288
    buffer_load_dwordx4 v48, s[20:23], s49 offen offset:2048 lds
    v_mfma_f32_16x16x32_bf16 v[196:199], a[224:227], v[176:179], v[196:199]
    ds_read_b64_tr_b16 a[184:185], v17 offset:16384
    v_cvt_pk_bf16_f32 v224, v192, v193
    v_mfma_f32_16x16x32_bf16 v[196:199], a[228:231], v[180:183], v[196:199]
    ds_read_b64_tr_b16 a[186:187], v17 offset:20480
    v_cvt_pk_bf16_f32 v225, v194, v195
    v_mfma_f32_16x16x32_bf16 v[196:199], a[232:235], v[184:187], v[196:199]
    ds_read_b64_tr_b16 a[188:189], v17 offset:24576
    v_mfma_f32_16x16x32_bf16 v[196:199], a[236:239], v[188:191], v[196:199]
    s_waitcnt lgkmcnt(13)
    ds_read_b64_tr_b16 a[190:191], v17 offset:28672
    buffer_load_dwordx4 v49, s[20:23], s49 offen offset:3072 lds
    v_mfma_f32_16x16x32_bf16 v[200:203], a[160:163], v[128:131], 0
    s_waitcnt lgkmcnt(12)
    ds_read_b64_tr_b16 a[208:209], v14 offset:0
    v_mfma_f32_16x16x32_bf16 v[200:203], a[164:167], v[132:135], v[200:203]
    s_waitcnt lgkmcnt(11)
    s_add_u32 s49, s45, 74240
    ds_read_b64_tr_b16 a[210:211], v14 offset:4096
    v_mfma_f32_16x16x32_bf16 v[200:203], a[168:171], v[136:139], v[200:203]
    s_waitcnt lgkmcnt(10)
    s_add_u32 m0, s42, 114688
    ds_read_b64_tr_b16 a[212:213], v14 offset:8192
    v_mfma_f32_16x16x32_bf16 v[200:203], a[172:175], v[140:143], v[200:203]
    s_waitcnt lgkmcnt(9)
    ds_read_b64_tr_b16 a[214:215], v14 offset:12288
    buffer_load_dwordx4 v46, s[20:23], s49 offen lds
    v_mfma_f32_16x16x32_bf16 v[200:203], a[176:179], v[144:147], v[200:203]
    s_waitcnt lgkmcnt(8)
    ds_read_b64_tr_b16 a[216:217], v14 offset:16384
    v_cvt_pk_bf16_f32 v228, v196, v197
    v_mfma_f32_16x16x32_bf16 v[200:203], a[180:183], v[148:151], v[200:203]
    s_waitcnt lgkmcnt(7)
    ds_read_b64_tr_b16 a[218:219], v14 offset:20480
    v_cvt_pk_bf16_f32 v229, v198, v199
    v_mfma_f32_16x16x32_bf16 v[200:203], a[184:187], v[152:155], v[200:203]
    s_waitcnt lgkmcnt(6)
    ds_read_b64_tr_b16 a[220:221], v14 offset:24576
    v_mfma_f32_16x16x32_bf16 v[200:203], a[188:191], v[156:159], v[200:203]
    ds_read_b64_tr_b16 a[222:223], v14 offset:28672
    buffer_load_dwordx4 v47, s[20:23], s49 offen offset:1024 lds
    v_mfma_f32_16x16x32_bf16 v[204:207], a[160:163], v[160:163], 0
    ds_read_b64_tr_b16 a[224:225], v18 offset:0
    v_mfma_f32_16x16x32_bf16 v[204:207], a[164:167], v[164:167], v[204:207]
    ds_read_b64_tr_b16 a[226:227], v18 offset:4096
    v_mfma_f32_16x16x32_bf16 v[204:207], a[168:171], v[168:171], v[204:207]
    ds_read_b64_tr_b16 a[228:229], v18 offset:8192
    v_mfma_f32_16x16x32_bf16 v[204:207], a[172:175], v[172:175], v[204:207]
    ds_read_b64_tr_b16 a[230:231], v18 offset:12288
    buffer_load_dwordx4 v48, s[20:23], s49 offen offset:2048 lds
    v_mfma_f32_16x16x32_bf16 v[204:207], a[176:179], v[176:179], v[204:207]
    ds_read_b64_tr_b16 a[232:233], v18 offset:16384
    v_cvt_pk_bf16_f32 v226, v200, v201
    v_mfma_f32_16x16x32_bf16 v[204:207], a[180:183], v[180:183], v[204:207]
    s_add_u32 s38, s47, 256
    ds_read_b64_tr_b16 a[234:235], v18 offset:20480
    v_cvt_pk_bf16_f32 v227, v202, v203
    v_mfma_f32_16x16x32_bf16 v[204:207], a[184:187], v[184:187], v[204:207]
    ds_read_b64_tr_b16 a[236:237], v18 offset:24576
    buffer_store_dwordx4 v[224:227], v56, s[28:31], s38 offen sc1
    v_mfma_f32_16x16x32_bf16 v[204:207], a[188:191], v[188:191], v[204:207]
    s_waitcnt lgkmcnt(13)
    ds_read_b64_tr_b16 a[238:239], v18 offset:28672
    buffer_load_dwordx4 v49, s[20:23], s49 offen offset:3072 lds
    v_mfma_f32_16x16x32_bf16 v[192:195], a[208:211], v[128:131], 0
    s_waitcnt lgkmcnt(12)
    ds_read_b64_tr_b16 a[160:161], v15 offset:0
    v_mfma_f32_16x16x32_bf16 v[192:195], a[212:215], v[132:135], v[192:195]
    s_waitcnt lgkmcnt(11)
    ds_read_b64_tr_b16 a[162:163], v15 offset:4096
    v_mfma_f32_16x16x32_bf16 v[192:195], a[216:219], v[136:139], v[192:195]
    s_waitcnt lgkmcnt(10)
    ds_read_b64_tr_b16 a[164:165], v15 offset:8192
    v_mfma_f32_16x16x32_bf16 v[192:195], a[220:223], v[140:143], v[192:195]
    s_waitcnt lgkmcnt(9)
    ds_read_b64_tr_b16 a[166:167], v15 offset:12288
    v_mfma_f32_16x16x32_bf16 v[192:195], a[224:227], v[144:147], v[192:195]
    s_waitcnt lgkmcnt(8)
    ds_read_b64_tr_b16 a[168:169], v15 offset:16384
    v_cvt_pk_bf16_f32 v230, v204, v205
    v_mfma_f32_16x16x32_bf16 v[192:195], a[228:231], v[148:151], v[192:195]
    s_waitcnt lgkmcnt(7)
    s_add_u32 s38, s47, 295168
    ds_read_b64_tr_b16 a[170:171], v15 offset:20480
    v_cvt_pk_bf16_f32 v231, v206, v207
    v_mfma_f32_16x16x32_bf16 v[192:195], a[232:235], v[152:155], v[192:195]
    s_waitcnt lgkmcnt(6)
    ds_read_b64_tr_b16 a[172:173], v15 offset:24576
    buffer_store_dwordx4 v[228:231], v56, s[28:31], s38 offen sc1
    v_mfma_f32_16x16x32_bf16 v[192:195], a[236:239], v[156:159], v[192:195]
    ds_read_b64_tr_b16 a[174:175], v15 offset:28672
    v_mfma_f32_16x16x32_bf16 v[196:199], a[208:211], v[160:163], 0
    ds_read_b64_tr_b16 a[176:177], v19 offset:0
    v_mfma_f32_16x16x32_bf16 v[196:199], a[212:215], v[164:167], v[196:199]
    ds_read_b64_tr_b16 a[178:179], v19 offset:4096
    v_mfma_f32_16x16x32_bf16 v[196:199], a[216:219], v[168:171], v[196:199]
    ds_read_b64_tr_b16 a[180:181], v19 offset:8192
    v_mfma_f32_16x16x32_bf16 v[196:199], a[220:223], v[172:175], v[196:199]
    ds_read_b64_tr_b16 a[182:183], v19 offset:12288
    v_mfma_f32_16x16x32_bf16 v[196:199], a[224:227], v[176:179], v[196:199]
    ds_read_b64_tr_b16 a[184:185], v19 offset:16384
    v_cvt_pk_bf16_f32 v232, v192, v193
    v_mfma_f32_16x16x32_bf16 v[196:199], a[228:231], v[180:183], v[196:199]
    ds_read_b64_tr_b16 a[186:187], v19 offset:20480
    v_cvt_pk_bf16_f32 v233, v194, v195
    v_mfma_f32_16x16x32_bf16 v[196:199], a[232:235], v[184:187], v[196:199]
    ds_read_b64_tr_b16 a[188:189], v19 offset:24576
    v_mfma_f32_16x16x32_bf16 v[196:199], a[236:239], v[188:191], v[196:199]
    s_waitcnt lgkmcnt(13)
    ds_read_b64_tr_b16 a[190:191], v19 offset:28672
    s_waitcnt vmcnt(37)
    s_barrier
    v_mfma_f32_16x16x32_bf16 v[200:203], a[160:163], v[128:131], 0
    s_waitcnt lgkmcnt(12)
    ds_read_b64_tr_b16 a[208:209], v12 offset:32768
    v_mfma_f32_16x16x32_bf16 v[200:203], a[164:167], v[132:135], v[200:203]
    s_waitcnt lgkmcnt(11)
    s_add_u32 s49, s45, 640
    ds_read_b64_tr_b16 a[210:211], v12 offset:36864
    v_mfma_f32_16x16x32_bf16 v[200:203], a[168:171], v[136:139], v[200:203]
    s_waitcnt lgkmcnt(10)
    s_add_u32 m0, s42, 131072
    ds_read_b64_tr_b16 a[212:213], v12 offset:40960
    v_mfma_f32_16x16x32_bf16 v[200:203], a[172:175], v[140:143], v[200:203]
    s_waitcnt lgkmcnt(9)
    ds_read_b64_tr_b16 a[214:215], v12 offset:45056
    buffer_load_dwordx4 v46, s[20:23], s49 offen lds
    v_mfma_f32_16x16x32_bf16 v[200:203], a[176:179], v[144:147], v[200:203]
    s_waitcnt lgkmcnt(8)
    ds_read_b64_tr_b16 a[216:217], v12 offset:49152
    v_cvt_pk_bf16_f32 v236, v196, v197
    v_mfma_f32_16x16x32_bf16 v[200:203], a[180:183], v[148:151], v[200:203]
    s_waitcnt lgkmcnt(7)
    ds_read_b64_tr_b16 a[218:219], v12 offset:53248
    v_cvt_pk_bf16_f32 v237, v198, v199
    v_mfma_f32_16x16x32_bf16 v[200:203], a[184:187], v[152:155], v[200:203]
    s_waitcnt lgkmcnt(6)
    ds_read_b64_tr_b16 a[220:221], v12 offset:57344
    v_mfma_f32_16x16x32_bf16 v[200:203], a[188:191], v[156:159], v[200:203]
    ds_read_b64_tr_b16 a[222:223], v12 offset:61440
    buffer_load_dwordx4 v47, s[20:23], s49 offen offset:1024 lds
    v_mfma_f32_16x16x32_bf16 v[204:207], a[160:163], v[160:163], 0
    ds_read_b64_tr_b16 a[224:225], v16 offset:32768
    v_mfma_f32_16x16x32_bf16 v[204:207], a[164:167], v[164:167], v[204:207]
    ds_read_b64_tr_b16 a[226:227], v16 offset:36864
    v_mfma_f32_16x16x32_bf16 v[204:207], a[168:171], v[168:171], v[204:207]
    ds_read_b64_tr_b16 a[228:229], v16 offset:40960
    v_mfma_f32_16x16x32_bf16 v[204:207], a[172:175], v[172:175], v[204:207]
    ds_read_b64_tr_b16 a[230:231], v16 offset:45056
    buffer_load_dwordx4 v48, s[20:23], s49 offen offset:2048 lds
    v_mfma_f32_16x16x32_bf16 v[204:207], a[176:179], v[176:179], v[204:207]
    ds_read_b64_tr_b16 a[232:233], v16 offset:49152
    v_cvt_pk_bf16_f32 v234, v200, v201
    v_mfma_f32_16x16x32_bf16 v[204:207], a[180:183], v[180:183], v[204:207]
    s_add_u32 s38, s47, 384
    ds_read_b64_tr_b16 a[234:235], v16 offset:53248
    v_cvt_pk_bf16_f32 v235, v202, v203
    v_mfma_f32_16x16x32_bf16 v[204:207], a[184:187], v[184:187], v[204:207]
    ds_read_b64_tr_b16 a[236:237], v16 offset:57344
    buffer_store_dwordx4 v[232:235], v56, s[28:31], s38 offen sc1
    v_mfma_f32_16x16x32_bf16 v[204:207], a[188:191], v[188:191], v[204:207]
    s_waitcnt lgkmcnt(13)
    ds_read_b64_tr_b16 a[238:239], v16 offset:61440
    buffer_load_dwordx4 v49, s[20:23], s49 offen offset:3072 lds
    v_mfma_f32_16x16x32_bf16 v[192:195], a[208:211], v[128:131], 0
    s_waitcnt lgkmcnt(12)
    ds_read_b64_tr_b16 a[160:161], v13 offset:32768
    v_mfma_f32_16x16x32_bf16 v[192:195], a[212:215], v[132:135], v[192:195]
    s_waitcnt lgkmcnt(11)
    s_add_u32 s49, s45, 74368
    ds_read_b64_tr_b16 a[162:163], v13 offset:36864
    v_mfma_f32_16x16x32_bf16 v[192:195], a[216:219], v[136:139], v[192:195]
    s_waitcnt lgkmcnt(10)
    s_add_u32 m0, s42, 147456
    ds_read_b64_tr_b16 a[164:165], v13 offset:40960
    v_mfma_f32_16x16x32_bf16 v[192:195], a[220:223], v[140:143], v[192:195]
    s_waitcnt lgkmcnt(9)
    ds_read_b64_tr_b16 a[166:167], v13 offset:45056
    buffer_load_dwordx4 v46, s[20:23], s49 offen lds
    v_mfma_f32_16x16x32_bf16 v[192:195], a[224:227], v[144:147], v[192:195]
    s_waitcnt lgkmcnt(8)
    ds_read_b64_tr_b16 a[168:169], v13 offset:49152
    v_cvt_pk_bf16_f32 v238, v204, v205
    v_mfma_f32_16x16x32_bf16 v[192:195], a[228:231], v[148:151], v[192:195]
    s_waitcnt lgkmcnt(7)
    s_add_u32 s38, s47, 295296
    ds_read_b64_tr_b16 a[170:171], v13 offset:53248
    v_cvt_pk_bf16_f32 v239, v206, v207
    v_mfma_f32_16x16x32_bf16 v[192:195], a[232:235], v[152:155], v[192:195]
    s_waitcnt lgkmcnt(6)
    ds_read_b64_tr_b16 a[172:173], v13 offset:57344
    buffer_store_dwordx4 v[236:239], v56, s[28:31], s38 offen sc1
    v_mfma_f32_16x16x32_bf16 v[192:195], a[236:239], v[156:159], v[192:195]
    ds_read_b64_tr_b16 a[174:175], v13 offset:61440
    buffer_load_dwordx4 v47, s[20:23], s49 offen offset:1024 lds
    v_mfma_f32_16x16x32_bf16 v[196:199], a[208:211], v[160:163], 0
    ds_read_b64_tr_b16 a[176:177], v17 offset:32768
    v_mfma_f32_16x16x32_bf16 v[196:199], a[212:215], v[164:167], v[196:199]
    ds_read_b64_tr_b16 a[178:179], v17 offset:36864
    v_mfma_f32_16x16x32_bf16 v[196:199], a[216:219], v[168:171], v[196:199]
    ds_read_b64_tr_b16 a[180:181], v17 offset:40960
    v_mfma_f32_16x16x32_bf16 v[196:199], a[220:223], v[172:175], v[196:199]
    ds_read_b64_tr_b16 a[182:183], v17 offset:45056
    buffer_load_dwordx4 v48, s[20:23], s49 offen offset:2048 lds
    v_mfma_f32_16x16x32_bf16 v[196:199], a[224:227], v[176:179], v[196:199]
    ds_read_b64_tr_b16 a[184:185], v17 offset:49152
    v_cvt_pk_bf16_f32 v224, v192, v193
    v_mfma_f32_16x16x32_bf16 v[196:199], a[228:231], v[180:183], v[196:199]
    ds_read_b64_tr_b16 a[186:187], v17 offset:53248
    v_cvt_pk_bf16_f32 v225, v194, v195
    v_mfma_f32_16x16x32_bf16 v[196:199], a[232:235], v[184:187], v[196:199]
    ds_read_b64_tr_b16 a[188:189], v17 offset:57344
    v_mfma_f32_16x16x32_bf16 v[196:199], a[236:239], v[188:191], v[196:199]
    s_waitcnt lgkmcnt(13)
    ds_read_b64_tr_b16 a[190:191], v17 offset:61440
    buffer_load_dwordx4 v49, s[20:23], s49 offen offset:3072 lds
    v_mfma_f32_16x16x32_bf16 v[200:203], a[160:163], v[128:131], 0
    s_waitcnt lgkmcnt(12)
    ds_read_b64_tr_b16 a[208:209], v14 offset:32768
    v_mfma_f32_16x16x32_bf16 v[200:203], a[164:167], v[132:135], v[200:203]
    s_waitcnt lgkmcnt(11)
    ds_read_b64_tr_b16 a[210:211], v14 offset:36864
    v_mfma_f32_16x16x32_bf16 v[200:203], a[168:171], v[136:139], v[200:203]
    s_waitcnt lgkmcnt(10)
    ds_read_b64_tr_b16 a[212:213], v14 offset:40960
    v_mfma_f32_16x16x32_bf16 v[200:203], a[172:175], v[140:143], v[200:203]
    s_waitcnt lgkmcnt(9)
    ds_read_b64_tr_b16 a[214:215], v14 offset:45056
    v_mfma_f32_16x16x32_bf16 v[200:203], a[176:179], v[144:147], v[200:203]
    s_waitcnt lgkmcnt(8)
    ds_read_b64_tr_b16 a[216:217], v14 offset:49152
    v_cvt_pk_bf16_f32 v228, v196, v197
    v_mfma_f32_16x16x32_bf16 v[200:203], a[180:183], v[148:151], v[200:203]
    s_waitcnt lgkmcnt(7)
    ds_read_b64_tr_b16 a[218:219], v14 offset:53248
    v_cvt_pk_bf16_f32 v229, v198, v199
    v_mfma_f32_16x16x32_bf16 v[200:203], a[184:187], v[152:155], v[200:203]
    s_waitcnt lgkmcnt(6)
    ds_read_b64_tr_b16 a[220:221], v14 offset:57344
    v_mfma_f32_16x16x32_bf16 v[200:203], a[188:191], v[156:159], v[200:203]
    ds_read_b64_tr_b16 a[222:223], v14 offset:61440
    v_mfma_f32_16x16x32_bf16 v[204:207], a[160:163], v[160:163], 0
    ds_read_b64_tr_b16 a[224:225], v18 offset:32768
    v_mfma_f32_16x16x32_bf16 v[204:207], a[164:167], v[164:167], v[204:207]
    ds_read_b64_tr_b16 a[226:227], v18 offset:36864
    v_mfma_f32_16x16x32_bf16 v[204:207], a[168:171], v[168:171], v[204:207]
    ds_read_b64_tr_b16 a[228:229], v18 offset:40960
    v_mfma_f32_16x16x32_bf16 v[204:207], a[172:175], v[172:175], v[204:207]
    ds_read_b64_tr_b16 a[230:231], v18 offset:45056
    v_mfma_f32_16x16x32_bf16 v[204:207], a[176:179], v[176:179], v[204:207]
    ds_read_b64_tr_b16 a[232:233], v18 offset:49152
    v_cvt_pk_bf16_f32 v226, v200, v201
    v_mfma_f32_16x16x32_bf16 v[204:207], a[180:183], v[180:183], v[204:207]
    s_add_u32 s38, s47, 512
    ds_read_b64_tr_b16 a[234:235], v18 offset:53248
    v_cvt_pk_bf16_f32 v227, v202, v203
    v_mfma_f32_16x16x32_bf16 v[204:207], a[184:187], v[184:187], v[204:207]
    ds_read_b64_tr_b16 a[236:237], v18 offset:57344
    buffer_store_dwordx4 v[224:227], v56, s[28:31], s38 offen sc1
    v_mfma_f32_16x16x32_bf16 v[204:207], a[188:191], v[188:191], v[204:207]
    s_waitcnt lgkmcnt(13)
    ds_read_b64_tr_b16 a[238:239], v18 offset:61440
    v_mfma_f32_16x16x32_bf16 v[192:195], a[208:211], v[128:131], 0
    s_waitcnt lgkmcnt(12)
    ds_read_b64_tr_b16 a[160:161], v15 offset:32768
    v_mfma_f32_16x16x32_bf16 v[192:195], a[212:215], v[132:135], v[192:195]
    s_waitcnt lgkmcnt(11)
    ds_read_b64_tr_b16 a[162:163], v15 offset:36864
    v_mfma_f32_16x16x32_bf16 v[192:195], a[216:219], v[136:139], v[192:195]
    s_waitcnt lgkmcnt(10)
    ds_read_b64_tr_b16 a[164:165], v15 offset:40960
    v_mfma_f32_16x16x32_bf16 v[192:195], a[220:223], v[140:143], v[192:195]
    s_waitcnt lgkmcnt(9)
    ds_read_b64_tr_b16 a[166:167], v15 offset:45056
    v_mfma_f32_16x16x32_bf16 v[192:195], a[224:227], v[144:147], v[192:195]
    s_waitcnt lgkmcnt(8)
    ds_read_b64_tr_b16 a[168:169], v15 offset:49152
    v_cvt_pk_bf16_f32 v230, v204, v205
    v_mfma_f32_16x16x32_bf16 v[192:195], a[228:231], v[148:151], v[192:195]
    s_waitcnt lgkmcnt(7)
    s_add_u32 s38, s47, 295424
    ds_read_b64_tr_b16 a[170:171], v15 offset:53248
    v_cvt_pk_bf16_f32 v231, v206, v207
    v_mfma_f32_16x16x32_bf16 v[192:195], a[232:235], v[152:155], v[192:195]
    s_waitcnt lgkmcnt(6)
    ds_read_b64_tr_b16 a[172:173], v15 offset:57344
    buffer_store_dwordx4 v[228:231], v56, s[28:31], s38 offen sc1
    v_mfma_f32_16x16x32_bf16 v[192:195], a[236:239], v[156:159], v[192:195]
    ds_read_b64_tr_b16 a[174:175], v15 offset:61440
    v_mfma_f32_16x16x32_bf16 v[196:199], a[208:211], v[160:163], 0
    ds_read_b64_tr_b16 a[176:177], v19 offset:32768
    v_mfma_f32_16x16x32_bf16 v[196:199], a[212:215], v[164:167], v[196:199]
    ds_read_b64_tr_b16 a[178:179], v19 offset:36864
    v_mfma_f32_16x16x32_bf16 v[196:199], a[216:219], v[168:171], v[196:199]
    ds_read_b64_tr_b16 a[180:181], v19 offset:40960
    v_mfma_f32_16x16x32_bf16 v[196:199], a[220:223], v[172:175], v[196:199]
    ds_read_b64_tr_b16 a[182:183], v19 offset:45056
    v_mfma_f32_16x16x32_bf16 v[196:199], a[224:227], v[176:179], v[196:199]
    ds_read_b64_tr_b16 a[184:185], v19 offset:49152
    v_cvt_pk_bf16_f32 v232, v192, v193
    v_mfma_f32_16x16x32_bf16 v[196:199], a[228:231], v[180:183], v[196:199]
    ds_read_b64_tr_b16 a[186:187], v19 offset:53248
    v_cvt_pk_bf16_f32 v233, v194, v195
    v_mfma_f32_16x16x32_bf16 v[196:199], a[232:235], v[184:187], v[196:199]
    ds_read_b64_tr_b16 a[188:189], v19 offset:57344
    v_mfma_f32_16x16x32_bf16 v[196:199], a[236:239], v[188:191], v[196:199]
    s_waitcnt lgkmcnt(13)
    ds_read_b64_tr_b16 a[190:191], v19 offset:61440
    s_waitcnt vmcnt(23)
    s_barrier
    v_mfma_f32_16x16x32_bf16 v[200:203], a[160:163], v[128:131], 0
    s_waitcnt lgkmcnt(12)
    ds_read_b64_tr_b16 a[208:209], v20 offset:0
    v_mfma_f32_16x16x32_bf16 v[200:203], a[164:167], v[132:135], v[200:203]
    s_waitcnt lgkmcnt(11)
    s_add_u32 s49, s45, 768
    ds_read_b64_tr_b16 a[210:211], v20 offset:4096
    v_mfma_f32_16x16x32_bf16 v[200:203], a[168:171], v[136:139], v[200:203]
    s_waitcnt lgkmcnt(10)
    s_add_u32 m0, s42, 0
    ds_read_b64_tr_b16 a[212:213], v20 offset:8192
    v_mfma_f32_16x16x32_bf16 v[200:203], a[172:175], v[140:143], v[200:203]
    s_waitcnt lgkmcnt(9)
    ds_read_b64_tr_b16 a[214:215], v20 offset:12288
    buffer_load_dwordx4 v46, s[20:23], s49 offen lds
    v_mfma_f32_16x16x32_bf16 v[200:203], a[176:179], v[144:147], v[200:203]
    s_waitcnt lgkmcnt(8)
    ds_read_b64_tr_b16 a[216:217], v20 offset:16384
    v_cvt_pk_bf16_f32 v236, v196, v197
    v_mfma_f32_16x16x32_bf16 v[200:203], a[180:183], v[148:151], v[200:203]
    s_waitcnt lgkmcnt(7)
    ds_read_b64_tr_b16 a[218:219], v20 offset:20480
    v_cvt_pk_bf16_f32 v237, v198, v199
    v_mfma_f32_16x16x32_bf16 v[200:203], a[184:187], v[152:155], v[200:203]
    s_waitcnt lgkmcnt(6)
    ds_read_b64_tr_b16 a[220:221], v20 offset:24576
    v_mfma_f32_16x16x32_bf16 v[200:203], a[188:191], v[156:159], v[200:203]
    ds_read_b64_tr_b16 a[222:223], v20 offset:28672
    buffer_load_dwordx4 v47, s[20:23], s49 offen offset:1024 lds
    v_mfma_f32_16x16x32_bf16 v[204:207], a[160:163], v[160:163], 0
    ds_read_b64_tr_b16 a[224:225], v24 offset:0
    v_mfma_f32_16x16x32_bf16 v[204:207], a[164:167], v[164:167], v[204:207]
    ds_read_b64_tr_b16 a[226:227], v24 offset:4096
    v_mfma_f32_16x16x32_bf16 v[204:207], a[168:171], v[168:171], v[204:207]
    ds_read_b64_tr_b16 a[228:229], v24 offset:8192
    v_mfma_f32_16x16x32_bf16 v[204:207], a[172:175], v[172:175], v[204:207]
    ds_read_b64_tr_b16 a[230:231], v24 offset:12288
    buffer_load_dwordx4 v48, s[20:23], s49 offen offset:2048 lds
    v_mfma_f32_16x16x32_bf16 v[204:207], a[176:179], v[176:179], v[204:207]
    ds_read_b64_tr_b16 a[232:233], v24 offset:16384
    v_cvt_pk_bf16_f32 v234, v200, v201
    v_mfma_f32_16x16x32_bf16 v[204:207], a[180:183], v[180:183], v[204:207]
    s_add_u32 s38, s47, 640
    ds_read_b64_tr_b16 a[234:235], v24 offset:20480
    v_cvt_pk_bf16_f32 v235, v202, v203
    v_mfma_f32_16x16x32_bf16 v[204:207], a[184:187], v[184:187], v[204:207]
    ds_read_b64_tr_b16 a[236:237], v24 offset:24576
    buffer_store_dwordx4 v[232:235], v56, s[28:31], s38 offen sc1
    v_mfma_f32_16x16x32_bf16 v[204:207], a[188:191], v[188:191], v[204:207]
    s_waitcnt lgkmcnt(13)
    ds_read_b64_tr_b16 a[238:239], v24 offset:28672
    buffer_load_dwordx4 v49, s[20:23], s49 offen offset:3072 lds
    v_mfma_f32_16x16x32_bf16 v[192:195], a[208:211], v[128:131], 0
    s_waitcnt lgkmcnt(12)
    ds_read_b64_tr_b16 a[160:161], v21 offset:0
    v_mfma_f32_16x16x32_bf16 v[192:195], a[212:215], v[132:135], v[192:195]
    s_waitcnt lgkmcnt(11)
    s_add_u32 s49, s45, 74496
    ds_read_b64_tr_b16 a[162:163], v21 offset:4096
    v_mfma_f32_16x16x32_bf16 v[192:195], a[216:219], v[136:139], v[192:195]
    s_waitcnt lgkmcnt(10)
    s_add_u32 m0, s42, 16384
    ds_read_b64_tr_b16 a[164:165], v21 offset:8192
    v_mfma_f32_16x16x32_bf16 v[192:195], a[220:223], v[140:143], v[192:195]
    s_waitcnt lgkmcnt(9)
    ds_read_b64_tr_b16 a[166:167], v21 offset:12288
    buffer_load_dwordx4 v46, s[20:23], s49 offen lds
    v_mfma_f32_16x16x32_bf16 v[192:195], a[224:227], v[144:147], v[192:195]
    s_waitcnt lgkmcnt(8)
    ds_read_b64_tr_b16 a[168:169], v21 offset:16384
    v_cvt_pk_bf16_f32 v238, v204, v205
    v_mfma_f32_16x16x32_bf16 v[192:195], a[228:231], v[148:151], v[192:195]
    s_waitcnt lgkmcnt(7)
    s_add_u32 s38, s47, 295552
    ds_read_b64_tr_b16 a[170:171], v21 offset:20480
    v_cvt_pk_bf16_f32 v239, v206, v207
    v_mfma_f32_16x16x32_bf16 v[192:195], a[232:235], v[152:155], v[192:195]
    s_waitcnt lgkmcnt(6)
    ds_read_b64_tr_b16 a[172:173], v21 offset:24576
    buffer_store_dwordx4 v[236:239], v56, s[28:31], s38 offen sc1
    v_mfma_f32_16x16x32_bf16 v[192:195], a[236:239], v[156:159], v[192:195]
    ds_read_b64_tr_b16 a[174:175], v21 offset:28672
    buffer_load_dwordx4 v47, s[20:23], s49 offen offset:1024 lds
    v_mfma_f32_16x16x32_bf16 v[196:199], a[208:211], v[160:163], 0
    ds_read_b64_tr_b16 a[176:177], v25 offset:0
    v_mfma_f32_16x16x32_bf16 v[196:199], a[212:215], v[164:167], v[196:199]
    ds_read_b64_tr_b16 a[178:179], v25 offset:4096
    v_mfma_f32_16x16x32_bf16 v[196:199], a[216:219], v[168:171], v[196:199]
    ds_read_b64_tr_b16 a[180:181], v25 offset:8192
    v_mfma_f32_16x16x32_bf16 v[196:199], a[220:223], v[172:175], v[196:199]
    ds_read_b64_tr_b16 a[182:183], v25 offset:12288
    buffer_load_dwordx4 v48, s[20:23], s49 offen offset:2048 lds
    v_mfma_f32_16x16x32_bf16 v[196:199], a[224:227], v[176:179], v[196:199]
    ds_read_b64_tr_b16 a[184:185], v25 offset:16384
    v_cvt_pk_bf16_f32 v224, v192, v193
    v_mfma_f32_16x16x32_bf16 v[196:199], a[228:231], v[180:183], v[196:199]
    ds_read_b64_tr_b16 a[186:187], v25 offset:20480
    v_cvt_pk_bf16_f32 v225, v194, v195
    v_mfma_f32_16x16x32_bf16 v[196:199], a[232:235], v[184:187], v[196:199]
    ds_read_b64_tr_b16 a[188:189], v25 offset:24576
    v_mfma_f32_16x16x32_bf16 v[196:199], a[236:239], v[188:191], v[196:199]
    s_waitcnt lgkmcnt(13)
    ds_read_b64_tr_b16 a[190:191], v25 offset:28672
    buffer_load_dwordx4 v49, s[20:23], s49 offen offset:3072 lds
    v_mfma_f32_16x16x32_bf16 v[200:203], a[160:163], v[128:131], 0
    s_waitcnt lgkmcnt(12)
    ds_read_b64_tr_b16 a[208:209], v22 offset:0
    v_mfma_f32_16x16x32_bf16 v[200:203], a[164:167], v[132:135], v[200:203]
    s_waitcnt lgkmcnt(11)
    ds_read_b64_tr_b16 a[210:211], v22 offset:4096
    v_mfma_f32_16x16x32_bf16 v[200:203], a[168:171], v[136:139], v[200:203]
    s_waitcnt lgkmcnt(10)
    ds_read_b64_tr_b16 a[212:213], v22 offset:8192
    v_mfma_f32_16x16x32_bf16 v[200:203], a[172:175], v[140:143], v[200:203]
    s_waitcnt lgkmcnt(9)
    ds_read_b64_tr_b16 a[214:215], v22 offset:12288
    v_mfma_f32_16x16x32_bf16 v[200:203], a[176:179], v[144:147], v[200:203]
    s_waitcnt lgkmcnt(8)
    ds_read_b64_tr_b16 a[216:217], v22 offset:16384
    v_cvt_pk_bf16_f32 v228, v196, v197
    v_mfma_f32_16x16x32_bf16 v[200:203], a[180:183], v[148:151], v[200:203]
    s_waitcnt lgkmcnt(7)
    ds_read_b64_tr_b16 a[218:219], v22 offset:20480
    v_cvt_pk_bf16_f32 v229, v198, v199
    v_mfma_f32_16x16x32_bf16 v[200:203], a[184:187], v[152:155], v[200:203]
    s_waitcnt lgkmcnt(6)
    ds_read_b64_tr_b16 a[220:221], v22 offset:24576
    v_mfma_f32_16x16x32_bf16 v[200:203], a[188:191], v[156:159], v[200:203]
    ds_read_b64_tr_b16 a[222:223], v22 offset:28672
    v_mfma_f32_16x16x32_bf16 v[204:207], a[160:163], v[160:163], 0
    ds_read_b64_tr_b16 a[224:225], v26 offset:0
    v_mfma_f32_16x16x32_bf16 v[204:207], a[164:167], v[164:167], v[204:207]
    ds_read_b64_tr_b16 a[226:227], v26 offset:4096
    v_mfma_f32_16x16x32_bf16 v[204:207], a[168:171], v[168:171], v[204:207]
    ds_read_b64_tr_b16 a[228:229], v26 offset:8192
    v_mfma_f32_16x16x32_bf16 v[204:207], a[172:175], v[172:175], v[204:207]
    ds_read_b64_tr_b16 a[230:231], v26 offset:12288
    v_mfma_f32_16x16x32_bf16 v[204:207], a[176:179], v[176:179], v[204:207]
    ds_read_b64_tr_b16 a[232:233], v26 offset:16384
    v_cvt_pk_bf16_f32 v226, v200, v201
    v_mfma_f32_16x16x32_bf16 v[204:207], a[180:183], v[180:183], v[204:207]
    s_add_u32 s38, s47, 768
    ds_read_b64_tr_b16 a[234:235], v26 offset:20480
    v_cvt_pk_bf16_f32 v227, v202, v203
    v_mfma_f32_16x16x32_bf16 v[204:207], a[184:187], v[184:187], v[204:207]
    ds_read_b64_tr_b16 a[236:237], v26 offset:24576
    buffer_store_dwordx4 v[224:227], v56, s[28:31], s38 offen sc1
    v_mfma_f32_16x16x32_bf16 v[204:207], a[188:191], v[188:191], v[204:207]
    s_waitcnt lgkmcnt(13)
    ds_read_b64_tr_b16 a[238:239], v26 offset:28672
    v_mfma_f32_16x16x32_bf16 v[192:195], a[208:211], v[128:131], 0
    s_waitcnt lgkmcnt(12)
    ds_read_b64_tr_b16 a[160:161], v23 offset:0
    v_mfma_f32_16x16x32_bf16 v[192:195], a[212:215], v[132:135], v[192:195]
    s_waitcnt lgkmcnt(11)
    ds_read_b64_tr_b16 a[162:163], v23 offset:4096
    v_mfma_f32_16x16x32_bf16 v[192:195], a[216:219], v[136:139], v[192:195]
    s_waitcnt lgkmcnt(10)
    ds_read_b64_tr_b16 a[164:165], v23 offset:8192
    v_mfma_f32_16x16x32_bf16 v[192:195], a[220:223], v[140:143], v[192:195]
    s_waitcnt lgkmcnt(9)
    ds_read_b64_tr_b16 a[166:167], v23 offset:12288
    v_mfma_f32_16x16x32_bf16 v[192:195], a[224:227], v[144:147], v[192:195]
    s_waitcnt lgkmcnt(8)
    ds_read_b64_tr_b16 a[168:169], v23 offset:16384
    v_cvt_pk_bf16_f32 v230, v204, v205
    v_mfma_f32_16x16x32_bf16 v[192:195], a[228:231], v[148:151], v[192:195]
    s_waitcnt lgkmcnt(7)
    s_add_u32 s38, s47, 295680
    ds_read_b64_tr_b16 a[170:171], v23 offset:20480
    v_cvt_pk_bf16_f32 v231, v206, v207
    v_mfma_f32_16x16x32_bf16 v[192:195], a[232:235], v[152:155], v[192:195]
    s_waitcnt lgkmcnt(6)
    ds_read_b64_tr_b16 a[172:173], v23 offset:24576
    buffer_store_dwordx4 v[228:231], v56, s[28:31], s38 offen sc1
    v_mfma_f32_16x16x32_bf16 v[192:195], a[236:239], v[156:159], v[192:195]
    ds_read_b64_tr_b16 a[174:175], v23 offset:28672
    v_mfma_f32_16x16x32_bf16 v[196:199], a[208:211], v[160:163], 0
    ds_read_b64_tr_b16 a[176:177], v27 offset:0
    v_mfma_f32_16x16x32_bf16 v[196:199], a[212:215], v[164:167], v[196:199]
    ds_read_b64_tr_b16 a[178:179], v27 offset:4096
    v_mfma_f32_16x16x32_bf16 v[196:199], a[216:219], v[168:171], v[196:199]
    ds_read_b64_tr_b16 a[180:181], v27 offset:8192
    v_mfma_f32_16x16x32_bf16 v[196:199], a[220:223], v[172:175], v[196:199]
    ds_read_b64_tr_b16 a[182:183], v27 offset:12288
    v_mfma_f32_16x16x32_bf16 v[196:199], a[224:227], v[176:179], v[196:199]
    ds_read_b64_tr_b16 a[184:185], v27 offset:16384
    v_cvt_pk_bf16_f32 v232, v192, v193
    v_mfma_f32_16x16x32_bf16 v[196:199], a[228:231], v[180:183], v[196:199]
    ds_read_b64_tr_b16 a[186:187], v27 offset:20480
    v_cvt_pk_bf16_f32 v233, v194, v195
    v_mfma_f32_16x16x32_bf16 v[196:199], a[232:235], v[184:187], v[196:199]
    ds_read_b64_tr_b16 a[188:189], v27 offset:24576
    v_mfma_f32_16x16x32_bf16 v[196:199], a[236:239], v[188:191], v[196:199]
    s_waitcnt lgkmcnt(13)
    ds_read_b64_tr_b16 a[190:191], v27 offset:28672
    s_waitcnt vmcnt(25)
    s_barrier
    v_mfma_f32_16x16x32_bf16 v[200:203], a[160:163], v[128:131], 0
    s_waitcnt lgkmcnt(12)
    ds_read_b64_tr_b16 a[208:209], v20 offset:32768
    v_mfma_f32_16x16x32_bf16 v[200:203], a[164:167], v[132:135], v[200:203]
    s_waitcnt lgkmcnt(11)
    s_add_u32 s49, s45, 896
    ds_read_b64_tr_b16 a[210:211], v20 offset:36864
    v_mfma_f32_16x16x32_bf16 v[200:203], a[168:171], v[136:139], v[200:203]
    s_waitcnt lgkmcnt(10)
    s_add_u32 m0, s42, 32768
    ds_read_b64_tr_b16 a[212:213], v20 offset:40960
    v_mfma_f32_16x16x32_bf16 v[200:203], a[172:175], v[140:143], v[200:203]
    s_waitcnt lgkmcnt(9)
    ds_read_b64_tr_b16 a[214:215], v20 offset:45056
    buffer_load_dwordx4 v46, s[20:23], s49 offen lds
    v_mfma_f32_16x16x32_bf16 v[200:203], a[176:179], v[144:147], v[200:203]
    s_waitcnt lgkmcnt(8)
    ds_read_b64_tr_b16 a[216:217], v20 offset:49152
    v_cvt_pk_bf16_f32 v236, v196, v197
    v_mfma_f32_16x16x32_bf16 v[200:203], a[180:183], v[148:151], v[200:203]
    s_waitcnt lgkmcnt(7)
    ds_read_b64_tr_b16 a[218:219], v20 offset:53248
    v_cvt_pk_bf16_f32 v237, v198, v199
    v_mfma_f32_16x16x32_bf16 v[200:203], a[184:187], v[152:155], v[200:203]
    s_waitcnt lgkmcnt(6)
    ds_read_b64_tr_b16 a[220:221], v20 offset:57344
    v_mfma_f32_16x16x32_bf16 v[200:203], a[188:191], v[156:159], v[200:203]
    ds_read_b64_tr_b16 a[222:223], v20 offset:61440
    buffer_load_dwordx4 v47, s[20:23], s49 offen offset:1024 lds
    v_mfma_f32_16x16x32_bf16 v[204:207], a[160:163], v[160:163], 0
    ds_read_b64_tr_b16 a[224:225], v24 offset:32768
    v_mfma_f32_16x16x32_bf16 v[204:207], a[164:167], v[164:167], v[204:207]
    ds_read_b64_tr_b16 a[226:227], v24 offset:36864
    v_mfma_f32_16x16x32_bf16 v[204:207], a[168:171], v[168:171], v[204:207]
    ds_read_b64_tr_b16 a[228:229], v24 offset:40960
    v_mfma_f32_16x16x32_bf16 v[204:207], a[172:175], v[172:175], v[204:207]
    ds_read_b64_tr_b16 a[230:231], v24 offset:45056
    buffer_load_dwordx4 v48, s[20:23], s49 offen offset:2048 lds
    v_mfma_f32_16x16x32_bf16 v[204:207], a[176:179], v[176:179], v[204:207]
    ds_read_b64_tr_b16 a[232:233], v24 offset:49152
    v_cvt_pk_bf16_f32 v234, v200, v201
    v_mfma_f32_16x16x32_bf16 v[204:207], a[180:183], v[180:183], v[204:207]
    s_add_u32 s38, s47, 896
    ds_read_b64_tr_b16 a[234:235], v24 offset:53248
    v_cvt_pk_bf16_f32 v235, v202, v203
    v_mfma_f32_16x16x32_bf16 v[204:207], a[184:187], v[184:187], v[204:207]
    ds_read_b64_tr_b16 a[236:237], v24 offset:57344
    buffer_store_dwordx4 v[232:235], v56, s[28:31], s38 offen sc1
    v_mfma_f32_16x16x32_bf16 v[204:207], a[188:191], v[188:191], v[204:207]
    s_waitcnt lgkmcnt(13)
    ds_read_b64_tr_b16 a[238:239], v24 offset:61440
    buffer_load_dwordx4 v49, s[20:23], s49 offen offset:3072 lds
    v_mfma_f32_16x16x32_bf16 v[192:195], a[208:211], v[128:131], 0
    s_waitcnt lgkmcnt(12)
    ds_read_b64_tr_b16 a[160:161], v21 offset:32768
    v_mfma_f32_16x16x32_bf16 v[192:195], a[212:215], v[132:135], v[192:195]
    s_waitcnt lgkmcnt(11)
    s_add_u32 s49, s45, 74624
    ds_read_b64_tr_b16 a[162:163], v21 offset:36864
    v_mfma_f32_16x16x32_bf16 v[192:195], a[216:219], v[136:139], v[192:195]
    s_waitcnt lgkmcnt(10)
    s_add_u32 m0, s42, 49152
    ds_read_b64_tr_b16 a[164:165], v21 offset:40960
    v_mfma_f32_16x16x32_bf16 v[192:195], a[220:223], v[140:143], v[192:195]
    s_waitcnt lgkmcnt(9)
    ds_read_b64_tr_b16 a[166:167], v21 offset:45056
    buffer_load_dwordx4 v46, s[20:23], s49 offen lds
    v_mfma_f32_16x16x32_bf16 v[192:195], a[224:227], v[144:147], v[192:195]
    s_waitcnt lgkmcnt(8)
    ds_read_b64_tr_b16 a[168:169], v21 offset:49152
    v_cvt_pk_bf16_f32 v238, v204, v205
    v_mfma_f32_16x16x32_bf16 v[192:195], a[228:231], v[148:151], v[192:195]
    s_waitcnt lgkmcnt(7)
    s_add_u32 s38, s47, 295808
    ds_read_b64_tr_b16 a[170:171], v21 offset:53248
    v_cvt_pk_bf16_f32 v239, v206, v207
    v_mfma_f32_16x16x32_bf16 v[192:195], a[232:235], v[152:155], v[192:195]
    s_waitcnt lgkmcnt(6)
    ds_read_b64_tr_b16 a[172:173], v21 offset:57344
    buffer_store_dwordx4 v[236:239], v56, s[28:31], s38 offen sc1
    v_mfma_f32_16x16x32_bf16 v[192:195], a[236:239], v[156:159], v[192:195]
    ds_read_b64_tr_b16 a[174:175], v21 offset:61440
    buffer_load_dwordx4 v47, s[20:23], s49 offen offset:1024 lds
    v_mfma_f32_16x16x32_bf16 v[196:199], a[208:211], v[160:163], 0
    ds_read_b64_tr_b16 a[176:177], v25 offset:32768
    v_mfma_f32_16x16x32_bf16 v[196:199], a[212:215], v[164:167], v[196:199]
    ds_read_b64_tr_b16 a[178:179], v25 offset:36864
    v_mfma_f32_16x16x32_bf16 v[196:199], a[216:219], v[168:171], v[196:199]
    ds_read_b64_tr_b16 a[180:181], v25 offset:40960
    v_mfma_f32_16x16x32_bf16 v[196:199], a[220:223], v[172:175], v[196:199]
    ds_read_b64_tr_b16 a[182:183], v25 offset:45056
    buffer_load_dwordx4 v48, s[20:23], s49 offen offset:2048 lds
    v_mfma_f32_16x16x32_bf16 v[196:199], a[224:227], v[176:179], v[196:199]
    ds_read_b64_tr_b16 a[184:185], v25 offset:49152
    v_cvt_pk_bf16_f32 v224, v192, v193
    v_mfma_f32_16x16x32_bf16 v[196:199], a[228:231], v[180:183], v[196:199]
    ds_read_b64_tr_b16 a[186:187], v25 offset:53248
    v_cvt_pk_bf16_f32 v225, v194, v195
    v_mfma_f32_16x16x32_bf16 v[196:199], a[232:235], v[184:187], v[196:199]
    ds_read_b64_tr_b16 a[188:189], v25 offset:57344
    v_mfma_f32_16x16x32_bf16 v[196:199], a[236:239], v[188:191], v[196:199]
    s_waitcnt lgkmcnt(13)
    ds_read_b64_tr_b16 a[190:191], v25 offset:61440
    buffer_load_dwordx4 v49, s[20:23], s49 offen offset:3072 lds
    v_mfma_f32_16x16x32_bf16 v[200:203], a[160:163], v[128:131], 0
    s_waitcnt lgkmcnt(12)
    ds_read_b64_tr_b16 a[208:209], v22 offset:32768
    v_mfma_f32_16x16x32_bf16 v[200:203], a[164:167], v[132:135], v[200:203]
    s_waitcnt lgkmcnt(11)
    ds_read_b64_tr_b16 a[210:211], v22 offset:36864
    v_mfma_f32_16x16x32_bf16 v[200:203], a[168:171], v[136:139], v[200:203]
    s_waitcnt lgkmcnt(10)
    ds_read_b64_tr_b16 a[212:213], v22 offset:40960
    v_mfma_f32_16x16x32_bf16 v[200:203], a[172:175], v[140:143], v[200:203]
    s_waitcnt lgkmcnt(9)
    ds_read_b64_tr_b16 a[214:215], v22 offset:45056
    v_mfma_f32_16x16x32_bf16 v[200:203], a[176:179], v[144:147], v[200:203]
    s_waitcnt lgkmcnt(8)
    ds_read_b64_tr_b16 a[216:217], v22 offset:49152
    v_cvt_pk_bf16_f32 v228, v196, v197
    v_mfma_f32_16x16x32_bf16 v[200:203], a[180:183], v[148:151], v[200:203]
    s_waitcnt lgkmcnt(7)
    ds_read_b64_tr_b16 a[218:219], v22 offset:53248
    v_cvt_pk_bf16_f32 v229, v198, v199
    v_mfma_f32_16x16x32_bf16 v[200:203], a[184:187], v[152:155], v[200:203]
    s_waitcnt lgkmcnt(6)
    ds_read_b64_tr_b16 a[220:221], v22 offset:57344
    v_mfma_f32_16x16x32_bf16 v[200:203], a[188:191], v[156:159], v[200:203]
    ds_read_b64_tr_b16 a[222:223], v22 offset:61440
    v_mfma_f32_16x16x32_bf16 v[204:207], a[160:163], v[160:163], 0
    ds_read_b64_tr_b16 a[224:225], v26 offset:32768
    v_mfma_f32_16x16x32_bf16 v[204:207], a[164:167], v[164:167], v[204:207]
    ds_read_b64_tr_b16 a[226:227], v26 offset:36864
    v_mfma_f32_16x16x32_bf16 v[204:207], a[168:171], v[168:171], v[204:207]
    ds_read_b64_tr_b16 a[228:229], v26 offset:40960
    v_mfma_f32_16x16x32_bf16 v[204:207], a[172:175], v[172:175], v[204:207]
    ds_read_b64_tr_b16 a[230:231], v26 offset:45056
    v_mfma_f32_16x16x32_bf16 v[204:207], a[176:179], v[176:179], v[204:207]
    ds_read_b64_tr_b16 a[232:233], v26 offset:49152
    v_cvt_pk_bf16_f32 v226, v200, v201
    v_mfma_f32_16x16x32_bf16 v[204:207], a[180:183], v[180:183], v[204:207]
    s_add_u32 s38, s47, 1024
    ds_read_b64_tr_b16 a[234:235], v26 offset:53248
    v_cvt_pk_bf16_f32 v227, v202, v203
    v_mfma_f32_16x16x32_bf16 v[204:207], a[184:187], v[184:187], v[204:207]
    ds_read_b64_tr_b16 a[236:237], v26 offset:57344
    buffer_store_dwordx4 v[224:227], v56, s[28:31], s38 offen sc1
    v_mfma_f32_16x16x32_bf16 v[204:207], a[188:191], v[188:191], v[204:207]
    s_waitcnt lgkmcnt(13)
    ds_read_b64_tr_b16 a[238:239], v26 offset:61440
    v_mfma_f32_16x16x32_bf16 v[192:195], a[208:211], v[128:131], 0
    s_waitcnt lgkmcnt(12)
    ds_read_b64_tr_b16 a[160:161], v23 offset:32768
    v_mfma_f32_16x16x32_bf16 v[192:195], a[212:215], v[132:135], v[192:195]
    s_waitcnt lgkmcnt(11)
    ds_read_b64_tr_b16 a[162:163], v23 offset:36864
    v_mfma_f32_16x16x32_bf16 v[192:195], a[216:219], v[136:139], v[192:195]
    s_waitcnt lgkmcnt(10)
    ds_read_b64_tr_b16 a[164:165], v23 offset:40960
    v_mfma_f32_16x16x32_bf16 v[192:195], a[220:223], v[140:143], v[192:195]
    s_waitcnt lgkmcnt(9)
    ds_read_b64_tr_b16 a[166:167], v23 offset:45056
    v_mfma_f32_16x16x32_bf16 v[192:195], a[224:227], v[144:147], v[192:195]
    s_waitcnt lgkmcnt(8)
    ds_read_b64_tr_b16 a[168:169], v23 offset:49152
    v_cvt_pk_bf16_f32 v230, v204, v205
    v_mfma_f32_16x16x32_bf16 v[192:195], a[228:231], v[148:151], v[192:195]
    s_waitcnt lgkmcnt(7)
    s_add_u32 s38, s47, 295936
    ds_read_b64_tr_b16 a[170:171], v23 offset:53248
    v_cvt_pk_bf16_f32 v231, v206, v207
    v_mfma_f32_16x16x32_bf16 v[192:195], a[232:235], v[152:155], v[192:195]
    s_waitcnt lgkmcnt(6)
    ds_read_b64_tr_b16 a[172:173], v23 offset:57344
    buffer_store_dwordx4 v[228:231], v56, s[28:31], s38 offen sc1
    v_mfma_f32_16x16x32_bf16 v[192:195], a[236:239], v[156:159], v[192:195]
    ds_read_b64_tr_b16 a[174:175], v23 offset:61440
    v_mfma_f32_16x16x32_bf16 v[196:199], a[208:211], v[160:163], 0
    ds_read_b64_tr_b16 a[176:177], v27 offset:32768
    v_mfma_f32_16x16x32_bf16 v[196:199], a[212:215], v[164:167], v[196:199]
    ds_read_b64_tr_b16 a[178:179], v27 offset:36864
    v_mfma_f32_16x16x32_bf16 v[196:199], a[216:219], v[168:171], v[196:199]
    ds_read_b64_tr_b16 a[180:181], v27 offset:40960
    v_mfma_f32_16x16x32_bf16 v[196:199], a[220:223], v[172:175], v[196:199]
    ds_read_b64_tr_b16 a[182:183], v27 offset:45056
    v_mfma_f32_16x16x32_bf16 v[196:199], a[224:227], v[176:179], v[196:199]
    ds_read_b64_tr_b16 a[184:185], v27 offset:49152
    v_cvt_pk_bf16_f32 v232, v192, v193
    v_mfma_f32_16x16x32_bf16 v[196:199], a[228:231], v[180:183], v[196:199]
    ds_read_b64_tr_b16 a[186:187], v27 offset:53248
    v_cvt_pk_bf16_f32 v233, v194, v195
    v_mfma_f32_16x16x32_bf16 v[196:199], a[232:235], v[184:187], v[196:199]
    ds_read_b64_tr_b16 a[188:189], v27 offset:57344
    v_mfma_f32_16x16x32_bf16 v[196:199], a[236:239], v[188:191], v[196:199]
    ds_read_b64_tr_b16 a[190:191], v27 offset:61440
    s_waitcnt vmcnt(26)
    s_waitcnt lgkmcnt(0)
    s_barrier
    v_mfma_f32_16x16x32_bf16 v[200:203], a[160:163], v[128:131], 0
    ds_read_b64_tr_b16 a[208:209], v28 offset:0
    v_mfma_f32_16x16x32_bf16 v[200:203], a[164:167], v[132:135], v[200:203]
    s_add_u32 s49, s45, 1024
    ds_read_b64_tr_b16 a[210:211], v28 offset:4096
    v_mfma_f32_16x16x32_bf16 v[200:203], a[168:171], v[136:139], v[200:203]
    s_add_u32 m0, s42, 65536
    ds_read_b64_tr_b16 a[212:213], v28 offset:8192
    v_mfma_f32_16x16x32_bf16 v[200:203], a[172:175], v[140:143], v[200:203]
    ds_read_b64_tr_b16 a[214:215], v28 offset:12288
    buffer_load_dwordx4 v46, s[20:23], s49 offen lds
    v_mfma_f32_16x16x32_bf16 v[200:203], a[176:179], v[144:147], v[200:203]
    ds_read_b64_tr_b16 a[216:217], v28 offset:16384
    v_cvt_pk_bf16_f32 v236, v196, v197
    v_mfma_f32_16x16x32_bf16 v[200:203], a[180:183], v[148:151], v[200:203]
    ds_read_b64_tr_b16 a[218:219], v28 offset:20480
    v_cvt_pk_bf16_f32 v237, v198, v199
    v_mfma_f32_16x16x32_bf16 v[200:203], a[184:187], v[152:155], v[200:203]
    ds_read_b64_tr_b16 a[220:221], v28 offset:24576
    v_mfma_f32_16x16x32_bf16 v[200:203], a[188:191], v[156:159], v[200:203]
    ds_read_b64_tr_b16 a[222:223], v28 offset:28672
    buffer_load_dwordx4 v47, s[20:23], s49 offen offset:1024 lds
    v_mfma_f32_16x16x32_bf16 v[204:207], a[160:163], v[160:163], 0
    ds_read_b64_tr_b16 a[224:225], v32 offset:0
    v_mfma_f32_16x16x32_bf16 v[204:207], a[164:167], v[164:167], v[204:207]
    ds_read_b64_tr_b16 a[226:227], v32 offset:4096
    v_mfma_f32_16x16x32_bf16 v[204:207], a[168:171], v[168:171], v[204:207]
    ds_read_b64_tr_b16 a[228:229], v32 offset:8192
    v_mfma_f32_16x16x32_bf16 v[204:207], a[172:175], v[172:175], v[204:207]
    ds_read_b64_tr_b16 a[230:231], v32 offset:12288
    buffer_load_dwordx4 v48, s[20:23], s49 offen offset:2048 lds
    v_mfma_f32_16x16x32_bf16 v[204:207], a[176:179], v[176:179], v[204:207]
    ds_read_b64_tr_b16 a[232:233], v32 offset:16384
    v_cvt_pk_bf16_f32 v234, v200, v201
    v_mfma_f32_16x16x32_bf16 v[204:207], a[180:183], v[180:183], v[204:207]
    s_add_u32 s38, s47, 1152
    ds_read_b64_tr_b16 a[234:235], v32 offset:20480
    v_cvt_pk_bf16_f32 v235, v202, v203
    v_mfma_f32_16x16x32_bf16 v[204:207], a[184:187], v[184:187], v[204:207]
    ds_read_b64_tr_b16 a[236:237], v32 offset:24576
    buffer_store_dwordx4 v[232:235], v56, s[28:31], s38 offen sc1
    v_mfma_f32_16x16x32_bf16 v[204:207], a[188:191], v[188:191], v[204:207]
    s_waitcnt lgkmcnt(13)
    ds_read_b64_tr_b16 a[238:239], v32 offset:28672
    buffer_load_dwordx4 v49, s[20:23], s49 offen offset:3072 lds
    v_mfma_f32_16x16x32_bf16 v[192:195], a[208:211], v[128:131], 0
    s_waitcnt lgkmcnt(12)
    ds_read_b64_tr_b16 a[160:161], v29 offset:0
    v_mfma_f32_16x16x32_bf16 v[192:195], a[212:215], v[132:135], v[192:195]
    s_waitcnt lgkmcnt(11)
    s_add_u32 s49, s45, 74752
    ds_read_b64_tr_b16 a[162:163], v29 offset:4096
    v_mfma_f32_16x16x32_bf16 v[192:195], a[216:219], v[136:139], v[192:195]
    s_waitcnt lgkmcnt(10)
    s_add_u32 m0, s42, 81920
    ds_read_b64_tr_b16 a[164:165], v29 offset:8192
    v_mfma_f32_16x16x32_bf16 v[192:195], a[220:223], v[140:143], v[192:195]
    s_waitcnt lgkmcnt(9)
    ds_read_b64_tr_b16 a[166:167], v29 offset:12288
    buffer_load_dwordx4 v46, s[20:23], s49 offen lds
    v_mfma_f32_16x16x32_bf16 v[192:195], a[224:227], v[144:147], v[192:195]
    s_waitcnt lgkmcnt(8)
    ds_read_b64_tr_b16 a[168:169], v29 offset:16384
    v_cvt_pk_bf16_f32 v238, v204, v205
    v_mfma_f32_16x16x32_bf16 v[192:195], a[228:231], v[148:151], v[192:195]
    s_waitcnt lgkmcnt(7)
    s_add_u32 s38, s47, 296064
    ds_read_b64_tr_b16 a[170:171], v29 offset:20480
    v_cvt_pk_bf16_f32 v239, v206, v207
    v_mfma_f32_16x16x32_bf16 v[192:195], a[232:235], v[152:155], v[192:195]
    s_waitcnt lgkmcnt(6)
    ds_read_b64_tr_b16 a[172:173], v29 offset:24576
    buffer_store_dwordx4 v[236:239], v56, s[28:31], s38 offen sc1
    v_mfma_f32_16x16x32_bf16 v[192:195], a[236:239], v[156:159], v[192:195]
    ds_read_b64_tr_b16 a[174:175], v29 offset:28672
    buffer_load_dwordx4 v47, s[20:23], s49 offen offset:1024 lds
    v_mfma_f32_16x16x32_bf16 v[196:199], a[208:211], v[160:163], 0
    ds_read_b64_tr_b16 a[176:177], v33 offset:0
    v_mfma_f32_16x16x32_bf16 v[196:199], a[212:215], v[164:167], v[196:199]
    ds_read_b64_tr_b16 a[178:179], v33 offset:4096
    v_mfma_f32_16x16x32_bf16 v[196:199], a[216:219], v[168:171], v[196:199]
    ds_read_b64_tr_b16 a[180:181], v33 offset:8192
    v_mfma_f32_16x16x32_bf16 v[196:199], a[220:223], v[172:175], v[196:199]
    ds_read_b64_tr_b16 a[182:183], v33 offset:12288
    buffer_load_dwordx4 v48, s[20:23], s49 offen offset:2048 lds
    v_mfma_f32_16x16x32_bf16 v[196:199], a[224:227], v[176:179], v[196:199]
    ds_read_b64_tr_b16 a[184:185], v33 offset:16384
    v_cvt_pk_bf16_f32 v224, v192, v193
    v_mfma_f32_16x16x32_bf16 v[196:199], a[228:231], v[180:183], v[196:199]
    ds_read_b64_tr_b16 a[186:187], v33 offset:20480
    v_cvt_pk_bf16_f32 v225, v194, v195
    v_mfma_f32_16x16x32_bf16 v[196:199], a[232:235], v[184:187], v[196:199]
    ds_read_b64_tr_b16 a[188:189], v33 offset:24576
    v_mfma_f32_16x16x32_bf16 v[196:199], a[236:239], v[188:191], v[196:199]
    s_waitcnt lgkmcnt(13)
    ds_read_b64_tr_b16 a[190:191], v33 offset:28672
    buffer_load_dwordx4 v49, s[20:23], s49 offen offset:3072 lds
    v_mfma_f32_16x16x32_bf16 v[200:203], a[160:163], v[128:131], 0
    s_waitcnt lgkmcnt(12)
    ds_read_b64_tr_b16 a[208:209], v30 offset:0
    v_mfma_f32_16x16x32_bf16 v[200:203], a[164:167], v[132:135], v[200:203]
    s_waitcnt lgkmcnt(11)
    ds_read_b64_tr_b16 a[210:211], v30 offset:4096
    v_mfma_f32_16x16x32_bf16 v[200:203], a[168:171], v[136:139], v[200:203]
    s_waitcnt lgkmcnt(10)
    s_lshl_b32 s40, s5, 4
    ds_read_b64_tr_b16 a[212:213], v30 offset:8192
    v_mfma_f32_16x16x32_bf16 v[200:203], a[172:175], v[140:143], v[200:203]
    s_waitcnt lgkmcnt(9)
    s_add_u32 s40, s40, s4
    ds_read_b64_tr_b16 a[214:215], v30 offset:12288
    v_and_b32 v240, 31, v1
    v_mfma_f32_16x16x32_bf16 v[200:203], a[176:179], v[144:147], v[200:203]
    s_waitcnt lgkmcnt(8)
    ds_read_b64_tr_b16 a[216:217], v30 offset:16384
    v_cvt_pk_bf16_f32 v228, v196, v197
    v_mfma_f32_16x16x32_bf16 v[200:203], a[180:183], v[148:151], v[200:203]
    s_waitcnt lgkmcnt(7)
    ds_read_b64_tr_b16 a[218:219], v30 offset:20480
    v_cvt_pk_bf16_f32 v229, v198, v199
    v_mfma_f32_16x16x32_bf16 v[200:203], a[184:187], v[152:155], v[200:203]
    s_waitcnt lgkmcnt(6)
    ds_read_b64_tr_b16 a[220:221], v30 offset:24576
    v_lshrrev_b32 v241, 5, v1
    v_mfma_f32_16x16x32_bf16 v[200:203], a[188:191], v[156:159], v[200:203]
    ds_read_b64_tr_b16 a[222:223], v30 offset:28672
    v_cmp_gt_u32 vcc, 24, v240
    v_mfma_f32_16x16x32_bf16 v[204:207], a[160:163], v[160:163], 0
    ds_read_b64_tr_b16 a[224:225], v34 offset:0
    v_mov_b32 v242, 2147483648
    v_mfma_f32_16x16x32_bf16 v[204:207], a[164:167], v[164:167], v[204:207]
    s_lshl_b32 s43, s40, 3
    ds_read_b64_tr_b16 a[226:227], v34 offset:4096
    v_mfma_f32_16x16x32_bf16 v[204:207], a[168:171], v[168:171], v[204:207]
    s_lshl_b32 s44, s3, 1
    ds_read_b64_tr_b16 a[228:229], v34 offset:8192
    v_mfma_f32_16x16x32_bf16 v[204:207], a[172:175], v[172:175], v[204:207]
    s_add_u32 s43, s43, s44
    ds_read_b64_tr_b16 a[230:231], v34 offset:12288
    v_cndmask_b32 v242, v242, 0, vcc
    v_mfma_f32_16x16x32_bf16 v[204:207], a[176:179], v[176:179], v[204:207]
    ds_read_b64_tr_b16 a[232:233], v34 offset:16384
    v_cvt_pk_bf16_f32 v226, v200, v201
    v_mfma_f32_16x16x32_bf16 v[204:207], a[180:183], v[180:183], v[204:207]
    s_add_u32 s38, s47, 1280
    ds_read_b64_tr_b16 a[234:235], v34 offset:20480
    v_cvt_pk_bf16_f32 v227, v202, v203
    v_mfma_f32_16x16x32_bf16 v[204:207], a[184:187], v[184:187], v[204:207]
    ds_read_b64_tr_b16 a[236:237], v34 offset:24576
    buffer_store_dwordx4 v[224:227], v56, s[28:31], s38 offen sc1
    v_mfma_f32_16x16x32_bf16 v[204:207], a[188:191], v[188:191], v[204:207]
    s_waitcnt lgkmcnt(13)
    ds_read_b64_tr_b16 a[238:239], v34 offset:28672
    v_add_u32 v7, s43, v241
    v_mfma_f32_16x16x32_bf16 v[192:195], a[208:211], v[128:131], 0
    s_waitcnt lgkmcnt(12)
    ds_read_b64_tr_b16 a[160:161], v31 offset:0
    v_lshl_add_u32 v5, v240, 4, v242
    v_mfma_f32_16x16x32_bf16 v[192:195], a[212:215], v[132:135], v[192:195]
    s_waitcnt lgkmcnt(11)
    ds_read_b64_tr_b16 a[162:163], v31 offset:4096
    v_lshl_add_u32 v243, v241, 4, v242
    v_mfma_f32_16x16x32_bf16 v[192:195], a[216:219], v[136:139], v[192:195]
    s_waitcnt lgkmcnt(10)
    ds_read_b64_tr_b16 a[164:165], v31 offset:8192
    v_lshl_add_u32 v2, v240, 5, v243
    v_mfma_f32_16x16x32_bf16 v[192:195], a[220:223], v[140:143], v[192:195]
    s_waitcnt lgkmcnt(9)
    s_mul_i32 s44, s43, 18432
    ds_read_b64_tr_b16 a[166:167], v31 offset:12288
    v_lshrrev_b32 v243, 2, v240
    v_mfma_f32_16x16x32_bf16 v[192:195], a[224:227], v[144:147], v[192:195]
    s_waitcnt lgkmcnt(8)
    ds_read_b64_tr_b16 a[168:169], v31 offset:16384
    v_cvt_pk_bf16_f32 v230, v204, v205
    v_mfma_f32_16x16x32_bf16 v[192:195], a[228:231], v[148:151], v[192:195]
    s_waitcnt lgkmcnt(7)
    s_add_u32 s38, s47, 296192
    ds_read_b64_tr_b16 a[170:171], v31 offset:20480
    v_cvt_pk_bf16_f32 v231, v206, v207
    v_mfma_f32_16x16x32_bf16 v[192:195], a[232:235], v[152:155], v[192:195]
    s_waitcnt lgkmcnt(6)
    ds_read_b64_tr_b16 a[172:173], v31 offset:24576
    buffer_store_dwordx4 v[228:231], v56, s[28:31], s38 offen sc1
    v_mfma_f32_16x16x32_bf16 v[192:195], a[236:239], v[156:159], v[192:195]
    ds_read_b64_tr_b16 a[174:175], v31 offset:28672
    v_lshl_add_u32 v243, v243, 6, v242
    v_mfma_f32_16x16x32_bf16 v[196:199], a[208:211], v[160:163], 0
    ds_read_b64_tr_b16 a[176:177], v35 offset:0
    v_and_b32 v241, 3, v240
    v_mfma_f32_16x16x32_bf16 v[196:199], a[212:215], v[164:167], v[196:199]
    ds_read_b64_tr_b16 a[178:179], v35 offset:4096
    v_lshl_add_u32 v3, v241, 3, v243
    v_mfma_f32_16x16x32_bf16 v[196:199], a[216:219], v[168:171], v[196:199]
    ds_read_b64_tr_b16 a[180:181], v35 offset:8192
    v_mul_u32_u24 v243, 1152, v7
    v_mfma_f32_16x16x32_bf16 v[196:199], a[220:223], v[172:175], v[196:199]
    ds_read_b64_tr_b16 a[182:183], v35 offset:12288
    v_add_u32 v4, v243, v3
    v_mfma_f32_16x16x32_bf16 v[196:199], a[224:227], v[176:179], v[196:199]
    ds_read_b64_tr_b16 a[184:185], v35 offset:16384
    v_cvt_pk_bf16_f32 v232, v192, v193
    v_mfma_f32_16x16x32_bf16 v[196:199], a[228:231], v[180:183], v[196:199]
    ds_read_b64_tr_b16 a[186:187], v35 offset:20480
    v_cvt_pk_bf16_f32 v233, v194, v195
    v_mfma_f32_16x16x32_bf16 v[196:199], a[232:235], v[184:187], v[196:199]
    ds_read_b64_tr_b16 a[188:189], v35 offset:24576
    v_add_u32 v6, v243, v5
    v_mfma_f32_16x16x32_bf16 v[196:199], a[236:239], v[188:191], v[196:199]
    s_waitcnt lgkmcnt(13)
    s_lshr_b32 s41, s2, 3
    ds_read_b64_tr_b16 a[190:191], v35 offset:28672
    s_waitcnt vmcnt(26)
    s_barrier
    v_mfma_f32_16x16x32_bf16 v[200:203], a[160:163], v[128:131], 0
    s_waitcnt lgkmcnt(12)
    s_and_b32 s42, s2, 7
    ds_read_b64_tr_b16 a[208:209], v12 offset:0
    v_mfma_f32_16x16x32_bf16 v[200:203], a[164:167], v[132:135], v[200:203]
    s_waitcnt lgkmcnt(11)
    s_mov_b32 s14, 2359296
    ds_read_b64_tr_b16 a[210:211], v12 offset:4096
    ds_write_b128 v51, a[128:131] offset:0
    v_mfma_f32_16x16x32_bf16 v[200:203], a[168:171], v[136:139], v[200:203]
    s_waitcnt lgkmcnt(11)
    s_mov_b32 s15, 0x20000
    ds_read_b64_tr_b16 a[212:213], v12 offset:8192
    v_mfma_f32_16x16x32_bf16 v[200:203], a[172:175], v[140:143], v[200:203]
    s_waitcnt lgkmcnt(10)
    s_mov_b32 s18, 2359296
    ds_read_b64_tr_b16 a[214:215], v12 offset:12288
    v_mfma_f32_16x16x32_bf16 v[200:203], a[176:179], v[144:147], v[200:203]
    s_waitcnt lgkmcnt(9)
    ds_read_b64_tr_b16 a[216:217], v12 offset:16384
    v_cvt_pk_bf16_f32 v236, v196, v197
    v_mfma_f32_16x16x32_bf16 v[200:203], a[180:183], v[148:151], v[200:203]
    s_waitcnt lgkmcnt(8)
    ds_read_b64_tr_b16 a[218:219], v12 offset:20480
    ds_write_b128 v51, a[132:135] offset:4096
    v_cvt_pk_bf16_f32 v237, v198, v199
    v_mfma_f32_16x16x32_bf16 v[200:203], a[184:187], v[152:155], v[200:203]
    s_waitcnt lgkmcnt(8)
    s_mov_b32 s19, 0x20000
    ds_read_b64_tr_b16 a[220:221], v12 offset:24576
    v_mfma_f32_16x16x32_bf16 v[200:203], a[188:191], v[156:159], v[200:203]
    s_mov_b32 s22, 1152
    ds_read_b64_tr_b16 a[222:223], v12 offset:28672
    v_mfma_f32_16x16x32_bf16 v[204:207], a[160:163], v[160:163], 0
    s_mov_b32 s23, 0x20000
    ds_read_b64_tr_b16 a[224:225], v16 offset:0
    v_mfma_f32_16x16x32_bf16 v[204:207], a[164:167], v[164:167], v[204:207]
    s_mov_b64 s[20:21], s[52:53]
    ds_read_b64_tr_b16 a[226:227], v16 offset:4096
    ds_write_b128 v51, a[136:139] offset:8192
    v_mfma_f32_16x16x32_bf16 v[204:207], a[168:171], v[168:171], v[204:207]
    s_add_u32 s8, s50, 7864320
    s_addc_u32 s9, s51, 0
    ds_read_b64_tr_b16 a[228:229], v16 offset:8192
    v_mfma_f32_16x16x32_bf16 v[204:207], a[172:175], v[172:175], v[204:207]
    s_mov_b32 s10, 663552
    ds_read_b64_tr_b16 a[230:231], v16 offset:12288
    v_mfma_f32_16x16x32_bf16 v[204:207], a[176:179], v[176:179], v[204:207]
    ds_read_b64_tr_b16 a[232:233], v16 offset:16384
    v_cvt_pk_bf16_f32 v234, v200, v201
    v_mfma_f32_16x16x32_bf16 v[204:207], a[180:183], v[180:183], v[204:207]
    s_add_u32 s38, s47, 1408
    ds_read_b64_tr_b16 a[234:235], v16 offset:20480
    ds_write_b128 v51, a[140:143] offset:12288
    v_cvt_pk_bf16_f32 v235, v202, v203
    v_mfma_f32_16x16x32_bf16 v[204:207], a[184:187], v[184:187], v[204:207]
    ds_read_b64_tr_b16 a[236:237], v16 offset:24576
    buffer_store_dwordx4 v[232:235], v56, s[28:31], s38 offen sc1
    v_mfma_f32_16x16x32_bf16 v[204:207], a[188:191], v[188:191], v[204:207]
    s_waitcnt lgkmcnt(15)
    s_mov_b32 s11, 0x20000
    ds_read_b64_tr_b16 a[238:239], v16 offset:28672
    v_mfma_f32_16x16x32_bf16 v[192:195], a[208:211], v[128:131], 0
    s_waitcnt lgkmcnt(15)
    s_lshl_b32 s93, s5, 8
    ds_read_b64_tr_b16 a[160:161], v13 offset:0
    v_mfma_f32_16x16x32_bf16 v[192:195], a[212:215], v[132:135], v[192:195]
    s_waitcnt lgkmcnt(14)
    s_add_u32 s93, s93, 7852032
    ds_read_b64_tr_b16 a[162:163], v13 offset:4096
    ds_write_b128 v51, a[144:147] offset:16384
    v_mfma_f32_16x16x32_bf16 v[192:195], a[216:219], v[136:139], v[192:195]
    s_waitcnt lgkmcnt(13)
    s_lshl_b32 s45, s3, 6
    ds_read_b64_tr_b16 a[164:165], v13 offset:8192
    v_mfma_f32_16x16x32_bf16 v[192:195], a[220:223], v[140:143], v[192:195]
    s_waitcnt lgkmcnt(12)
    s_add_u32 s92, s93, s45
    ds_read_b64_tr_b16 a[166:167], v13 offset:12288
    v_mfma_f32_16x16x32_bf16 v[192:195], a[224:227], v[144:147], v[192:195]
    s_waitcnt lgkmcnt(10)
    ds_read_b64_tr_b16 a[168:169], v13 offset:16384
    v_cvt_pk_bf16_f32 v238, v204, v205
    v_mfma_f32_16x16x32_bf16 v[192:195], a[228:231], v[148:151], v[192:195]
    s_waitcnt lgkmcnt(9)
    s_add_u32 s38, s47, 296320
    ds_read_b64_tr_b16 a[170:171], v13 offset:20480
    ds_write_b128 v51, a[148:151] offset:20480
    v_cvt_pk_bf16_f32 v239, v206, v207
    v_mfma_f32_16x16x32_bf16 v[192:195], a[232:235], v[152:155], v[192:195]
    s_waitcnt lgkmcnt(8)
    ds_read_b64_tr_b16 a[172:173], v13 offset:24576
    buffer_store_dwordx4 v[236:239], v56, s[28:31], s38 offen sc1
    v_mfma_f32_16x16x32_bf16 v[192:195], a[236:239], v[156:159], v[192:195]
    s_lshl_b32 s45, s4, 2
    ds_read_b64_tr_b16 a[174:175], v13 offset:28672
    v_mfma_f32_16x16x32_bf16 v[196:199], a[208:211], v[160:163], 0
    s_add_u32 s92, s92, s45
    ds_read_b64_tr_b16 a[176:177], v17 offset:0
    v_mfma_f32_16x16x32_bf16 v[196:199], a[212:215], v[164:167], v[196:199]
    s_lshr_b32 s45, s4, 2
    ds_read_b64_tr_b16 a[178:179], v17 offset:4096
    ds_write_b128 v51, a[152:155] offset:24576
    v_mfma_f32_16x16x32_bf16 v[196:199], a[216:219], v[168:171], v[196:199]
    s_lshl_b32 s45, s45, 6
    ds_read_b64_tr_b16 a[180:181], v17 offset:8192
    v_mfma_f32_16x16x32_bf16 v[196:199], a[220:223], v[172:175], v[196:199]
    s_add_u32 s93, s93, s45
    ds_read_b64_tr_b16 a[182:183], v17 offset:12288
    v_min_u32 v8, 1, v1
    v_mfma_f32_16x16x32_bf16 v[196:199], a[224:227], v[176:179], v[196:199]
    ds_read_b64_tr_b16 a[184:185], v17 offset:16384
    v_cvt_pk_bf16_f32 v224, v192, v193
    v_mfma_f32_16x16x32_bf16 v[196:199], a[228:231], v[180:183], v[196:199]
    ds_read_b64_tr_b16 a[186:187], v17 offset:20480
    ds_write_b128 v51, a[156:159] offset:28672
    v_cvt_pk_bf16_f32 v225, v194, v195
    v_mfma_f32_16x16x32_bf16 v[196:199], a[232:235], v[184:187], v[196:199]
    ds_read_b64_tr_b16 a[188:189], v17 offset:24576
    v_lshlrev_b32 v8, 31, v8
    v_mfma_f32_16x16x32_bf16 v[196:199], a[236:239], v[188:191], v[196:199]
    s_waitcnt lgkmcnt(15)
    ds_read_b64_tr_b16 a[190:191], v17 offset:28672
    v_and_b32 v9, 15, v1
    v_mfma_f32_16x16x32_bf16 v[200:203], a[160:163], v[128:131], 0
    s_waitcnt lgkmcnt(15)
    ds_read_b64_tr_b16 a[208:209], v14 offset:0
    v_lshlrev_b32 v9, 2, v9
    v_mfma_f32_16x16x32_bf16 v[200:203], a[164:167], v[132:135], v[200:203]
    s_waitcnt lgkmcnt(14)
    ds_read_b64_tr_b16 a[210:211], v14 offset:4096
    v_mov_b32 v10, 0
    v_mfma_f32_16x16x32_bf16 v[200:203], a[168:171], v[136:139], v[200:203]
    s_waitcnt lgkmcnt(12)
    ds_read_b64_tr_b16 a[212:213], v14 offset:8192
    v_lshrrev_b32 v240, 4, v1
    v_mfma_f32_16x16x32_bf16 v[200:203], a[172:175], v[140:143], v[200:203]
    s_waitcnt lgkmcnt(11)
    ds_read_b64_tr_b16 a[214:215], v14 offset:12288
    v_bfe_u32 v241, v1, 2, 2
    v_mfma_f32_16x16x32_bf16 v[200:203], a[176:179], v[144:147], v[200:203]
    s_waitcnt lgkmcnt(9)
    ds_read_b64_tr_b16 a[216:217], v14 offset:16384
    v_cvt_pk_bf16_f32 v228, v196, v197
    v_mfma_f32_16x16x32_bf16 v[200:203], a[180:183], v[148:151], v[200:203]
    s_waitcnt lgkmcnt(8)
    ds_read_b64_tr_b16 a[218:219], v14 offset:20480
    v_cvt_pk_bf16_f32 v229, v198, v199
    v_mfma_f32_16x16x32_bf16 v[200:203], a[184:187], v[152:155], v[200:203]
    s_waitcnt lgkmcnt(6)
    ds_read_b64_tr_b16 a[220:221], v14 offset:24576
    v_cmp_eq_u32 s[54:55], v240, v241
    v_mfma_f32_16x16x32_bf16 v[200:203], a[188:191], v[156:159], v[200:203]
    ds_read_b64_tr_b16 a[222:223], v14 offset:28672
    v_and_b32 v240, 1, v1
    v_mfma_f32_16x16x32_bf16 v[204:207], a[160:163], v[160:163], 0
    ds_read_b64_tr_b16 a[224:225], v18 offset:0
    v_lshlrev_b32 v240, 4, v240
    v_mfma_f32_16x16x32_bf16 v[204:207], a[164:167], v[164:167], v[204:207]
    ds_read_b64_tr_b16 a[226:227], v18 offset:4096
    v_mov_b32 v241, 0x3f80
    v_mfma_f32_16x16x32_bf16 v[204:207], a[168:171], v[168:171], v[204:207]
    ds_read_b64_tr_b16 a[228:229], v18 offset:8192
    v_lshlrev_b32 v240, v240, v241
    v_mfma_f32_16x16x32_bf16 v[204:207], a[172:175], v[172:175], v[204:207]
    ds_read_b64_tr_b16 a[230:231], v18 offset:12288
    v_cndmask_b32 v240, 0, v240, s[54:55]
    v_mfma_f32_16x16x32_bf16 v[204:207], a[176:179], v[176:179], v[204:207]
    ds_read_b64_tr_b16 a[232:233], v18 offset:16384
    v_cvt_pk_bf16_f32 v226, v200, v201
    v_mfma_f32_16x16x32_bf16 v[204:207], a[180:183], v[180:183], v[204:207]
    s_add_u32 s38, s47, 1536
    ds_read_b64_tr_b16 a[234:235], v18 offset:20480
    v_cvt_pk_bf16_f32 v227, v202, v203
    v_mfma_f32_16x16x32_bf16 v[204:207], a[184:187], v[184:187], v[204:207]
    ds_read_b64_tr_b16 a[236:237], v18 offset:24576
    buffer_store_dwordx4 v[224:227], v56, s[28:31], s38 offen sc1
    v_mfma_f32_16x16x32_bf16 v[204:207], a[188:191], v[188:191], v[204:207]
    s_waitcnt lgkmcnt(13)
    ds_read_b64_tr_b16 a[238:239], v18 offset:28672
    v_bfe_i32 v241, v1, 1, 1
    v_mfma_f32_16x16x32_bf16 v[192:195], a[208:211], v[128:131], 0
    s_waitcnt lgkmcnt(12)
    ds_read_b64_tr_b16 a[160:161], v15 offset:0
    v_mov_b32 v248, 0
    v_mfma_f32_16x16x32_bf16 v[192:195], a[212:215], v[132:135], v[192:195]
    s_waitcnt lgkmcnt(11)
    ds_read_b64_tr_b16 a[162:163], v15 offset:4096
    v_mov_b32 v249, 0
    v_mfma_f32_16x16x32_bf16 v[192:195], a[216:219], v[136:139], v[192:195]
    s_waitcnt lgkmcnt(10)
    ds_read_b64_tr_b16 a[164:165], v15 offset:8192
    v_mov_b32 v252, 0
    v_mfma_f32_16x16x32_bf16 v[192:195], a[220:223], v[140:143], v[192:195]
    s_waitcnt lgkmcnt(9)
    ds_read_b64_tr_b16 a[166:167], v15 offset:12288
    v_mov_b32 v253, 0
    v_mfma_f32_16x16x32_bf16 v[192:195], a[224:227], v[144:147], v[192:195]
    s_waitcnt lgkmcnt(8)
    ds_read_b64_tr_b16 a[168:169], v15 offset:16384
    v_cvt_pk_bf16_f32 v230, v204, v205
    v_mfma_f32_16x16x32_bf16 v[192:195], a[228:231], v[148:151], v[192:195]
    s_waitcnt lgkmcnt(7)
    s_add_u32 s38, s47, 296448
    ds_read_b64_tr_b16 a[170:171], v15 offset:20480
    v_cvt_pk_bf16_f32 v231, v206, v207
    v_mfma_f32_16x16x32_bf16 v[192:195], a[232:235], v[152:155], v[192:195]
    s_waitcnt lgkmcnt(6)
    ds_read_b64_tr_b16 a[172:173], v15 offset:24576
    buffer_store_dwordx4 v[228:231], v56, s[28:31], s38 offen sc1
    v_mfma_f32_16x16x32_bf16 v[192:195], a[236:239], v[156:159], v[192:195]
    ds_read_b64_tr_b16 a[174:175], v15 offset:28672
    v_and_b32 v251, v240, v241
    v_mfma_f32_16x16x32_bf16 v[196:199], a[208:211], v[160:163], 0
    ds_read_b64_tr_b16 a[176:177], v19 offset:0
    v_xor_b32 v250, v240, v251
    v_mfma_f32_16x16x32_bf16 v[196:199], a[212:215], v[164:167], v[196:199]
    ds_read_b64_tr_b16 a[178:179], v19 offset:4096
    v_mfma_f32_16x16x32_bf16 v[196:199], a[216:219], v[168:171], v[196:199]
    ds_read_b64_tr_b16 a[180:181], v19 offset:8192
    v_mfma_f32_16x16x32_bf16 v[196:199], a[220:223], v[172:175], v[196:199]
    ds_read_b64_tr_b16 a[182:183], v19 offset:12288
    v_mfma_f32_16x16x32_bf16 v[196:199], a[224:227], v[176:179], v[196:199]
    ds_read_b64_tr_b16 a[184:185], v19 offset:16384
    v_cvt_pk_bf16_f32 v232, v192, v193
    v_mfma_f32_16x16x32_bf16 v[196:199], a[228:231], v[180:183], v[196:199]
    ds_read_b64_tr_b16 a[186:187], v19 offset:20480
    v_cvt_pk_bf16_f32 v233, v194, v195
    v_mfma_f32_16x16x32_bf16 v[196:199], a[232:235], v[184:187], v[196:199]
    s_mov_b32 s45, 18688
    ds_read_b64_tr_b16 a[188:189], v19 offset:24576
    v_mfma_f32_16x16x32_bf16 v[196:199], a[236:239], v[188:191], v[196:199]
    s_waitcnt lgkmcnt(13)
    ds_read_b64_tr_b16 a[190:191], v19 offset:28672
    buffer_load_dwordx4 v[64:67], v5, s[24:27], s45 offen offset:0 sc1
    s_waitcnt vmcnt(19)
    s_barrier
    v_mfma_f32_16x16x32_bf16 v[200:203], a[160:163], v[128:131], 0
    s_waitcnt lgkmcnt(12)
    ds_read_b64_tr_b16 a[208:209], v12 offset:32768
    v_mfma_f32_16x16x32_bf16 v[200:203], a[164:167], v[132:135], v[200:203]
    s_waitcnt lgkmcnt(11)
    ds_read_b64_tr_b16 a[210:211], v12 offset:36864
    ds_write_b128 v51, a[240:243] offset:32768
    v_mfma_f32_16x16x32_bf16 v[200:203], a[168:171], v[136:139], v[200:203]
    s_waitcnt lgkmcnt(11)
    ds_read_b64_tr_b16 a[212:213], v12 offset:40960
    v_mfma_f32_16x16x32_bf16 v[200:203], a[172:175], v[140:143], v[200:203]
    s_waitcnt lgkmcnt(10)
    ds_read_b64_tr_b16 a[214:215], v12 offset:45056
    buffer_load_dwordx4 v[68:71], v5, s[24:27], s45 offen offset:384 sc1
    v_mfma_f32_16x16x32_bf16 v[200:203], a[176:179], v[144:147], v[200:203]
    s_waitcnt lgkmcnt(9)
    ds_read_b64_tr_b16 a[216:217], v12 offset:49152
    v_cvt_pk_bf16_f32 v236, v196, v197
    v_mfma_f32_16x16x32_bf16 v[200:203], a[180:183], v[148:151], v[200:203]
    s_waitcnt lgkmcnt(8)
    ds_read_b64_tr_b16 a[218:219], v12 offset:53248
    ds_write_b128 v51, a[244:247] offset:36864
    v_cvt_pk_bf16_f32 v237, v198, v199
    v_mfma_f32_16x16x32_bf16 v[200:203], a[184:187], v[152:155], v[200:203]
    s_waitcnt lgkmcnt(8)
    ds_read_b64_tr_b16 a[220:221], v12 offset:57344
    v_mfma_f32_16x16x32_bf16 v[200:203], a[188:191], v[156:159], v[200:203]
    ds_read_b64_tr_b16 a[222:223], v12 offset:61440
    buffer_load_dwordx4 v[72:75], v5, s[24:27], s45 offen offset:768 sc1
    v_mfma_f32_16x16x32_bf16 v[204:207], a[160:163], v[160:163], 0
    ds_read_b64_tr_b16 a[224:225], v16 offset:32768
    v_mfma_f32_16x16x32_bf16 v[204:207], a[164:167], v[164:167], v[204:207]
    ds_read_b64_tr_b16 a[226:227], v16 offset:36864
    ds_write_b128 v51, a[248:251] offset:40960
    v_mfma_f32_16x16x32_bf16 v[204:207], a[168:171], v[168:171], v[204:207]
    s_mov_b32 s45, 20992
    ds_read_b64_tr_b16 a[228:229], v16 offset:40960
    v_mfma_f32_16x16x32_bf16 v[204:207], a[172:175], v[172:175], v[204:207]
    ds_read_b64_tr_b16 a[230:231], v16 offset:45056
    buffer_load_dwordx4 v[76:79], v5, s[24:27], s45 offen offset:0 sc1
    v_mfma_f32_16x16x32_bf16 v[204:207], a[176:179], v[176:179], v[204:207]
    ds_read_b64_tr_b16 a[232:233], v16 offset:49152
    v_cvt_pk_bf16_f32 v234, v200, v201
    v_mfma_f32_16x16x32_bf16 v[204:207], a[180:183], v[180:183], v[204:207]
    s_add_u32 s38, s47, 1664
    ds_read_b64_tr_b16 a[234:235], v16 offset:53248
    ds_write_b128 v51, a[252:255] offset:45056
    v_cvt_pk_bf16_f32 v235, v202, v203
    v_mfma_f32_16x16x32_bf16 v[204:207], a[184:187], v[184:187], v[204:207]
    ds_read_b64_tr_b16 a[236:237], v16 offset:57344
    buffer_store_dwordx4 v[232:235], v56, s[28:31], s38 offen sc1
    v_mfma_f32_16x16x32_bf16 v[204:207], a[188:191], v[188:191], v[204:207]
    s_waitcnt lgkmcnt(15)
    ds_read_b64_tr_b16 a[238:239], v16 offset:61440
    buffer_load_dwordx4 v[80:83], v5, s[24:27], s45 offen offset:384 sc1
    v_mfma_f32_16x16x32_bf16 v[192:195], a[208:211], v[128:131], 0
    s_waitcnt lgkmcnt(15)
    ds_read_b64_tr_b16 a[160:161], v13 offset:32768
    v_mfma_f32_16x16x32_bf16 v[192:195], a[212:215], v[132:135], v[192:195]
    s_waitcnt lgkmcnt(14)
    ds_read_b64_tr_b16 a[162:163], v13 offset:36864
    ds_write_b128 v51, a[0:3] offset:49152
    v_mfma_f32_16x16x32_bf16 v[192:195], a[216:219], v[136:139], v[192:195]
    s_waitcnt lgkmcnt(13)
    ds_read_b64_tr_b16 a[164:165], v13 offset:40960
    v_mfma_f32_16x16x32_bf16 v[192:195], a[220:223], v[140:143], v[192:195]
    s_waitcnt lgkmcnt(12)
    ds_read_b64_tr_b16 a[166:167], v13 offset:45056
    buffer_load_dwordx4 v[84:87], v5, s[24:27], s45 offen offset:768 sc1
    v_mfma_f32_16x16x32_bf16 v[192:195], a[224:227], v[144:147], v[192:195]
    s_waitcnt lgkmcnt(10)
    ds_read_b64_tr_b16 a[168:169], v13 offset:49152
    v_cvt_pk_bf16_f32 v238, v204, v205
    v_mfma_f32_16x16x32_bf16 v[192:195], a[228:231], v[148:151], v[192:195]
    s_waitcnt lgkmcnt(9)
    s_add_u32 s38, s47, 296576
    ds_read_b64_tr_b16 a[170:171], v13 offset:53248
    ds_write_b128 v51, a[4:7] offset:53248
    v_cvt_pk_bf16_f32 v239, v206, v207
    v_mfma_f32_16x16x32_bf16 v[192:195], a[232:235], v[152:155], v[192:195]
    s_waitcnt lgkmcnt(8)
    s_mov_b32 s45, 19840
    ds_read_b64_tr_b16 a[172:173], v13 offset:57344
    buffer_store_dwordx4 v[236:239], v56, s[28:31], s38 offen sc1
    v_mfma_f32_16x16x32_bf16 v[192:195], a[236:239], v[156:159], v[192:195]
    ds_read_b64_tr_b16 a[174:175], v13 offset:61440
    buffer_load_dwordx4 v[88:91], v5, s[24:27], s45 offen offset:0 sc1
    v_mfma_f32_16x16x32_bf16 v[196:199], a[208:211], v[160:163], 0
    ds_read_b64_tr_b16 a[176:177], v17 offset:32768
    v_mfma_f32_16x16x32_bf16 v[196:199], a[212:215], v[164:167], v[196:199]
    ds_read_b64_tr_b16 a[178:179], v17 offset:36864
    ds_write_b128 v51, a[8:11] offset:57344
    v_mfma_f32_16x16x32_bf16 v[196:199], a[216:219], v[168:171], v[196:199]
    ds_read_b64_tr_b16 a[180:181], v17 offset:40960
    v_mfma_f32_16x16x32_bf16 v[196:199], a[220:223], v[172:175], v[196:199]
    ds_read_b64_tr_b16 a[182:183], v17 offset:45056
    buffer_load_dwordx4 v[92:95], v5, s[24:27], s45 offen offset:384 sc1
    v_mfma_f32_16x16x32_bf16 v[196:199], a[224:227], v[176:179], v[196:199]
    ds_read_b64_tr_b16 a[184:185], v17 offset:49152
    v_cvt_pk_bf16_f32 v224, v192, v193
    v_mfma_f32_16x16x32_bf16 v[196:199], a[228:231], v[180:183], v[196:199]
    ds_read_b64_tr_b16 a[186:187], v17 offset:53248
    ds_write_b128 v51, a[12:15] offset:61440
    v_cvt_pk_bf16_f32 v225, v194, v195
    v_mfma_f32_16x16x32_bf16 v[196:199], a[232:235], v[184:187], v[196:199]
    ds_read_b64_tr_b16 a[188:189], v17 offset:57344
    v_mfma_f32_16x16x32_bf16 v[196:199], a[236:239], v[188:191], v[196:199]
    s_waitcnt lgkmcnt(15)
    ds_read_b64_tr_b16 a[190:191], v17 offset:61440
    buffer_load_dwordx4 v[96:99], v5, s[24:27], s45 offen offset:768 sc1
    v_mfma_f32_16x16x32_bf16 v[200:203], a[160:163], v[128:131], 0
    s_waitcnt lgkmcnt(15)
    ds_read_b64_tr_b16 a[208:209], v14 offset:32768
    v_mfma_f32_16x16x32_bf16 v[200:203], a[164:167], v[132:135], v[200:203]
    s_waitcnt lgkmcnt(14)
    ds_read_b64_tr_b16 a[210:211], v14 offset:36864
    v_mfma_f32_16x16x32_bf16 v[200:203], a[168:171], v[136:139], v[200:203]
    s_waitcnt lgkmcnt(12)
    s_mov_b32 s45, 22144
    ds_read_b64_tr_b16 a[212:213], v14 offset:40960
    v_mfma_f32_16x16x32_bf16 v[200:203], a[172:175], v[140:143], v[200:203]
    s_waitcnt lgkmcnt(11)
    ds_read_b64_tr_b16 a[214:215], v14 offset:45056
    buffer_load_dwordx4 v[112:115], v5, s[24:27], s45 offen offset:0 sc1
    v_mfma_f32_16x16x32_bf16 v[200:203], a[176:179], v[144:147], v[200:203]
    s_waitcnt lgkmcnt(9)
    ds_read_b64_tr_b16 a[216:217], v14 offset:49152
    v_cvt_pk_bf16_f32 v228, v196, v197
    v_mfma_f32_16x16x32_bf16 v[200:203], a[180:183], v[148:151], v[200:203]
    s_waitcnt lgkmcnt(8)
    ds_read_b64_tr_b16 a[218:219], v14 offset:53248
    v_cvt_pk_bf16_f32 v229, v198, v199
    v_mfma_f32_16x16x32_bf16 v[200:203], a[184:187], v[152:155], v[200:203]
    s_waitcnt lgkmcnt(6)
    ds_read_b64_tr_b16 a[220:221], v14 offset:57344
    v_mfma_f32_16x16x32_bf16 v[200:203], a[188:191], v[156:159], v[200:203]
    ds_read_b64_tr_b16 a[222:223], v14 offset:61440
    buffer_load_dwordx4 v[116:119], v5, s[24:27], s45 offen offset:384 sc1
    v_mfma_f32_16x16x32_bf16 v[204:207], a[160:163], v[160:163], 0
    ds_read_b64_tr_b16 a[224:225], v18 offset:32768
    v_mfma_f32_16x16x32_bf16 v[204:207], a[164:167], v[164:167], v[204:207]
    ds_read_b64_tr_b16 a[226:227], v18 offset:36864
    v_mfma_f32_16x16x32_bf16 v[204:207], a[168:171], v[168:171], v[204:207]
    ds_read_b64_tr_b16 a[228:229], v18 offset:40960
    v_mfma_f32_16x16x32_bf16 v[204:207], a[172:175], v[172:175], v[204:207]
    ds_read_b64_tr_b16 a[230:231], v18 offset:45056
    buffer_load_dwordx4 v[120:123], v5, s[24:27], s45 offen offset:768 sc1
    v_mfma_f32_16x16x32_bf16 v[204:207], a[176:179], v[176:179], v[204:207]
    ds_read_b64_tr_b16 a[232:233], v18 offset:49152
    v_cvt_pk_bf16_f32 v226, v200, v201
    v_mfma_f32_16x16x32_bf16 v[204:207], a[180:183], v[180:183], v[204:207]
    s_add_u32 s38, s47, 1792
    ds_read_b64_tr_b16 a[234:235], v18 offset:53248
    v_cvt_pk_bf16_f32 v227, v202, v203
    v_mfma_f32_16x16x32_bf16 v[204:207], a[184:187], v[184:187], v[204:207]
    ds_read_b64_tr_b16 a[236:237], v18 offset:57344
    buffer_store_dwordx4 v[224:227], v56, s[28:31], s38 offen sc1
    v_mfma_f32_16x16x32_bf16 v[204:207], a[188:191], v[188:191], v[204:207]
    s_waitcnt lgkmcnt(13)
    ds_read_b64_tr_b16 a[238:239], v18 offset:61440
    buffer_load_dwordx2 v[36:37], v4, s[12:15], 0 offen offset:0
    v_mfma_f32_16x16x32_bf16 v[192:195], a[208:211], v[128:131], 0
    s_waitcnt lgkmcnt(12)
    ds_read_b64_tr_b16 a[160:161], v15 offset:32768
    v_mfma_f32_16x16x32_bf16 v[192:195], a[212:215], v[132:135], v[192:195]
    s_waitcnt lgkmcnt(11)
    s_waitcnt vmcnt(18)
    ds_read_b64_tr_b16 a[162:163], v15 offset:36864
    buffer_store_dword v10, v8, s[24:27], s92 offen sc1
    v_mfma_f32_16x16x32_bf16 v[192:195], a[216:219], v[136:139], v[192:195]
    s_waitcnt lgkmcnt(10)
    s_add_u32 s92, s92, 4096
    ds_read_b64_tr_b16 a[164:165], v15 offset:40960
    v_mfma_f32_16x16x32_bf16 v[192:195], a[220:223], v[140:143], v[192:195]
    s_waitcnt lgkmcnt(9)
    ds_read_b64_tr_b16 a[166:167], v15 offset:45056
    buffer_load_dwordx2 v[38:39], v4, s[12:15], 0 offen offset:32
    v_mfma_f32_16x16x32_bf16 v[192:195], a[224:227], v[144:147], v[192:195]
    s_waitcnt lgkmcnt(8)
    ds_read_b64_tr_b16 a[168:169], v15 offset:49152
    v_cvt_pk_bf16_f32 v230, v204, v205
    v_mfma_f32_16x16x32_bf16 v[192:195], a[228:231], v[148:151], v[192:195]
    s_waitcnt lgkmcnt(7)
    s_add_u32 s38, s47, 296704
    ds_read_b64_tr_b16 a[170:171], v15 offset:53248
    v_cvt_pk_bf16_f32 v231, v206, v207
    v_mfma_f32_16x16x32_bf16 v[192:195], a[232:235], v[152:155], v[192:195]
    s_waitcnt lgkmcnt(6)
    ds_read_b64_tr_b16 a[172:173], v15 offset:57344
    buffer_store_dwordx4 v[228:231], v56, s[28:31], s38 offen sc1
    v_mfma_f32_16x16x32_bf16 v[192:195], a[236:239], v[156:159], v[192:195]
    ds_read_b64_tr_b16 a[174:175], v15 offset:61440
    buffer_load_dwordx2 v[40:41], v4, s[12:15], 0 offen offset:384
    v_mfma_f32_16x16x32_bf16 v[196:199], a[208:211], v[160:163], 0
    ds_read_b64_tr_b16 a[176:177], v19 offset:32768
    v_mfma_f32_16x16x32_bf16 v[196:199], a[212:215], v[164:167], v[196:199]
    ds_read_b64_tr_b16 a[178:179], v19 offset:36864
    v_mfma_f32_16x16x32_bf16 v[196:199], a[216:219], v[168:171], v[196:199]
    ds_read_b64_tr_b16 a[180:181], v19 offset:40960
    v_mfma_f32_16x16x32_bf16 v[196:199], a[220:223], v[172:175], v[196:199]
    ds_read_b64_tr_b16 a[182:183], v19 offset:45056
    buffer_load_dwordx2 v[42:43], v4, s[12:15], 0 offen offset:416
    v_mfma_f32_16x16x32_bf16 v[196:199], a[224:227], v[176:179], v[196:199]
    ds_read_b64_tr_b16 a[184:185], v19 offset:49152
    v_cvt_pk_bf16_f32 v232, v192, v193
    v_mfma_f32_16x16x32_bf16 v[196:199], a[228:231], v[180:183], v[196:199]
    ds_read_b64_tr_b16 a[186:187], v19 offset:53248
    v_cvt_pk_bf16_f32 v233, v194, v195
    v_mfma_f32_16x16x32_bf16 v[196:199], a[232:235], v[184:187], v[196:199]
    ds_read_b64_tr_b16 a[188:189], v19 offset:57344
    v_mfma_f32_16x16x32_bf16 v[196:199], a[236:239], v[188:191], v[196:199]
    ds_read_b64_tr_b16 a[190:191], v19 offset:61440
    buffer_load_dwordx2 v[44:45], v4, s[12:15], 0 offen offset:768
    s_waitcnt lgkmcnt(0)
    s_barrier
    v_mfma_f32_16x16x32_bf16 v[200:203], a[160:163], v[128:131], 0
    ds_read_b64_tr_b16 a[208:209], v20 offset:0
    v_mfma_f32_16x16x32_bf16 v[200:203], a[164:167], v[132:135], v[200:203]
    ds_read_b64_tr_b16 a[210:211], v20 offset:4096
    ds_write_b128 v255, a[16:19] offset:36864
    v_mfma_f32_16x16x32_bf16 v[200:203], a[168:171], v[136:139], v[200:203]
    ds_read_b64_tr_b16 a[212:213], v20 offset:8192
    v_mfma_f32_16x16x32_bf16 v[200:203], a[172:175], v[140:143], v[200:203]
    ds_read_b64_tr_b16 a[214:215], v20 offset:12288
    buffer_load_dwordx2 v[46:47], v4, s[12:15], 0 offen offset:800
    v_mfma_f32_16x16x32_bf16 v[200:203], a[176:179], v[144:147], v[200:203]
    ds_read_b64_tr_b16 a[216:217], v20 offset:16384
    v_cvt_pk_bf16_f32 v236, v196, v197
    v_mfma_f32_16x16x32_bf16 v[200:203], a[180:183], v[148:151], v[200:203]
    ds_read_b64_tr_b16 a[218:219], v20 offset:20480
    ds_write_b128 v255, a[20:23] offset:40960
    v_cvt_pk_bf16_f32 v237, v198, v199
    v_mfma_f32_16x16x32_bf16 v[200:203], a[184:187], v[152:155], v[200:203]
    ds_read_b64_tr_b16 a[220:221], v20 offset:24576
    v_mfma_f32_16x16x32_bf16 v[200:203], a[188:191], v[156:159], v[200:203]
    ds_read_b64_tr_b16 a[222:223], v20 offset:28672
    buffer_load_dwordx2 v[100:101], v3, s[20:23], 0 offen offset:0
    v_mfma_f32_16x16x32_bf16 v[204:207], a[160:163], v[160:163], 0
    ds_read_b64_tr_b16 a[224:225], v24 offset:0
    v_mfma_f32_16x16x32_bf16 v[204:207], a[164:167], v[164:167], v[204:207]
    ds_read_b64_tr_b16 a[226:227], v24 offset:4096
    ds_write_b128 v255, a[24:27] offset:0
    v_mfma_f32_16x16x32_bf16 v[204:207], a[168:171], v[168:171], v[204:207]
    ds_read_b64_tr_b16 a[228:229], v24 offset:8192
    v_mfma_f32_16x16x32_bf16 v[204:207], a[172:175], v[172:175], v[204:207]
    ds_read_b64_tr_b16 a[230:231], v24 offset:12288
    buffer_load_dwordx2 v[102:103], v3, s[20:23], 0 offen offset:32
    v_mfma_f32_16x16x32_bf16 v[204:207], a[176:179], v[176:179], v[204:207]
    ds_read_b64_tr_b16 a[232:233], v24 offset:16384
    v_cvt_pk_bf16_f32 v234, v200, v201
    v_mfma_f32_16x16x32_bf16 v[204:207], a[180:183], v[180:183], v[204:207]
    s_add_u32 s38, s47, 1920
    ds_read_b64_tr_b16 a[234:235], v24 offset:20480
    ds_write_b128 v255, a[28:31] offset:4096
    v_cvt_pk_bf16_f32 v235, v202, v203
    v_mfma_f32_16x16x32_bf16 v[204:207], a[184:187], v[184:187], v[204:207]
    ds_read_b64_tr_b16 a[236:237], v24 offset:24576
    buffer_store_dwordx4 v[232:235], v56, s[28:31], s38 offen sc1
    v_mfma_f32_16x16x32_bf16 v[204:207], a[188:191], v[188:191], v[204:207]
    s_waitcnt lgkmcnt(15)
    ds_read_b64_tr_b16 a[238:239], v24 offset:28672
    buffer_load_dwordx2 v[104:105], v3, s[20:23], 0 offen offset:384
    v_mfma_f32_16x16x32_bf16 v[192:195], a[208:211], v[128:131], 0
    s_waitcnt lgkmcnt(15)
    ds_read_b64_tr_b16 a[160:161], v21 offset:0
    v_mfma_f32_16x16x32_bf16 v[192:195], a[212:215], v[132:135], v[192:195]
    s_waitcnt lgkmcnt(14)
    ds_read_b64_tr_b16 a[162:163], v21 offset:4096
    ds_write_b128 v255, a[32:35] offset:8192
    v_mfma_f32_16x16x32_bf16 v[192:195], a[216:219], v[136:139], v[192:195]
    s_waitcnt lgkmcnt(13)
    ds_read_b64_tr_b16 a[164:165], v21 offset:8192
    v_mfma_f32_16x16x32_bf16 v[192:195], a[220:223], v[140:143], v[192:195]
    s_waitcnt lgkmcnt(12)
    ds_read_b64_tr_b16 a[166:167], v21 offset:12288
    buffer_load_dwordx2 v[106:107], v3, s[20:23], 0 offen offset:416
    v_mfma_f32_16x16x32_bf16 v[192:195], a[224:227], v[144:147], v[192:195]
    s_waitcnt lgkmcnt(10)
    ds_read_b64_tr_b16 a[168:169], v21 offset:16384
    v_cvt_pk_bf16_f32 v238, v204, v205
    v_mfma_f32_16x16x32_bf16 v[192:195], a[228:231], v[148:151], v[192:195]
    s_waitcnt lgkmcnt(9)
    s_add_u32 s38, s47, 296832
    ds_read_b64_tr_b16 a[170:171], v21 offset:20480
    ds_write_b128 v255, a[36:39] offset:12288
    v_cvt_pk_bf16_f32 v239, v206, v207
    v_mfma_f32_16x16x32_bf16 v[192:195], a[232:235], v[152:155], v[192:195]
    s_waitcnt lgkmcnt(8)
    ds_read_b64_tr_b16 a[172:173], v21 offset:24576
    buffer_store_dwordx4 v[236:239], v56, s[28:31], s38 offen sc1
    v_mfma_f32_16x16x32_bf16 v[192:195], a[236:239], v[156:159], v[192:195]
    ds_read_b64_tr_b16 a[174:175], v21 offset:28672
    buffer_load_dwordx2 v[108:109], v3, s[20:23], 0 offen offset:768
    v_mfma_f32_16x16x32_bf16 v[196:199], a[208:211], v[160:163], 0
    ds_read_b64_tr_b16 a[176:177], v25 offset:0
    v_mfma_f32_16x16x32_bf16 v[196:199], a[212:215], v[164:167], v[196:199]
    ds_read_b64_tr_b16 a[178:179], v25 offset:4096
    ds_write_b128 v255, a[40:43] offset:16384
    v_mfma_f32_16x16x32_bf16 v[196:199], a[216:219], v[168:171], v[196:199]
    ds_read_b64_tr_b16 a[180:181], v25 offset:8192
    v_mfma_f32_16x16x32_bf16 v[196:199], a[220:223], v[172:175], v[196:199]
    ds_read_b64_tr_b16 a[182:183], v25 offset:12288
    buffer_load_dwordx2 v[110:111], v3, s[20:23], 0 offen offset:800
    v_mfma_f32_16x16x32_bf16 v[196:199], a[224:227], v[176:179], v[196:199]
    ds_read_b64_tr_b16 a[184:185], v25 offset:16384
    v_cvt_pk_bf16_f32 v224, v192, v193
    v_mfma_f32_16x16x32_bf16 v[196:199], a[228:231], v[180:183], v[196:199]
    ds_read_b64_tr_b16 a[186:187], v25 offset:20480
    ds_write_b128 v255, a[44:47] offset:20480
    v_cvt_pk_bf16_f32 v225, v194, v195
    v_mfma_f32_16x16x32_bf16 v[196:199], a[232:235], v[184:187], v[196:199]
    ds_read_b64_tr_b16 a[188:189], v25 offset:24576
    v_mfma_f32_16x16x32_bf16 v[196:199], a[236:239], v[188:191], v[196:199]
    s_waitcnt lgkmcnt(15)
    ds_read_b64_tr_b16 a[190:191], v25 offset:28672
    v_mfma_f32_16x16x32_bf16 v[200:203], a[160:163], v[128:131], 0
    s_waitcnt lgkmcnt(15)
    ds_read_b64_tr_b16 a[208:209], v22 offset:0
    v_mfma_f32_16x16x32_bf16 v[200:203], a[164:167], v[132:135], v[200:203]
    s_waitcnt lgkmcnt(14)
    ds_read_b64_tr_b16 a[210:211], v22 offset:4096
    ds_write_b128 v255, a[48:51] offset:24576
    v_mfma_f32_16x16x32_bf16 v[200:203], a[168:171], v[136:139], v[200:203]
    s_waitcnt lgkmcnt(13)
    ds_read_b64_tr_b16 a[212:213], v22 offset:8192
    v_mfma_f32_16x16x32_bf16 v[200:203], a[172:175], v[140:143], v[200:203]
    s_waitcnt lgkmcnt(12)
    ds_read_b64_tr_b16 a[214:215], v22 offset:12288
    v_mfma_f32_16x16x32_bf16 v[200:203], a[176:179], v[144:147], v[200:203]
    s_waitcnt lgkmcnt(10)
    ds_read_b64_tr_b16 a[216:217], v22 offset:16384
    v_cvt_pk_bf16_f32 v228, v196, v197
    v_mfma_f32_16x16x32_bf16 v[200:203], a[180:183], v[148:151], v[200:203]
    s_waitcnt lgkmcnt(9)
    ds_read_b64_tr_b16 a[218:219], v22 offset:20480
    ds_write_b128 v255, a[52:55] offset:28672
    v_cvt_pk_bf16_f32 v229, v198, v199
    v_mfma_f32_16x16x32_bf16 v[200:203], a[184:187], v[152:155], v[200:203]
    s_waitcnt lgkmcnt(8)
    ds_read_b64_tr_b16 a[220:221], v22 offset:24576
    v_mfma_f32_16x16x32_bf16 v[200:203], a[188:191], v[156:159], v[200:203]
    ds_read_b64_tr_b16 a[222:223], v22 offset:28672
    v_mfma_f32_16x16x32_bf16 v[204:207], a[160:163], v[160:163], 0
    ds_read_b64_tr_b16 a[224:225], v26 offset:0
    v_mfma_f32_16x16x32_bf16 v[204:207], a[164:167], v[164:167], v[204:207]
    ds_read_b64_tr_b16 a[226:227], v26 offset:4096
    ds_write_b128 v255, a[56:59] offset:32768
    v_mfma_f32_16x16x32_bf16 v[204:207], a[168:171], v[168:171], v[204:207]
    ds_read_b64_tr_b16 a[228:229], v26 offset:8192
    v_mfma_f32_16x16x32_bf16 v[204:207], a[172:175], v[172:175], v[204:207]
    ds_read_b64_tr_b16 a[230:231], v26 offset:12288
    v_mfma_f32_16x16x32_bf16 v[204:207], a[176:179], v[176:179], v[204:207]
    ds_read_b64_tr_b16 a[232:233], v26 offset:16384
    v_cvt_pk_bf16_f32 v226, v200, v201
    v_mfma_f32_16x16x32_bf16 v[204:207], a[180:183], v[180:183], v[204:207]
    s_add_u32 s38, s47, 2048
    ds_read_b64_tr_b16 a[234:235], v26 offset:20480
    v_cvt_pk_bf16_f32 v227, v202, v203
    v_mfma_f32_16x16x32_bf16 v[204:207], a[184:187], v[184:187], v[204:207]
    ds_read_b64_tr_b16 a[236:237], v26 offset:24576
    buffer_store_dwordx4 v[224:227], v56, s[28:31], s38 offen sc1
    v_mfma_f32_16x16x32_bf16 v[204:207], a[188:191], v[188:191], v[204:207]
    s_waitcnt lgkmcnt(15)
    ds_read_b64_tr_b16 a[238:239], v26 offset:28672
    v_mfma_f32_16x16x32_bf16 v[192:195], a[208:211], v[128:131], 0
    s_waitcnt lgkmcnt(14)
    ds_read_b64_tr_b16 a[160:161], v23 offset:0
    v_mfma_f32_16x16x32_bf16 v[192:195], a[212:215], v[132:135], v[192:195]
    s_waitcnt lgkmcnt(13)
    ds_read_b64_tr_b16 a[162:163], v23 offset:4096
    v_mfma_f32_16x16x32_bf16 v[192:195], a[216:219], v[136:139], v[192:195]
    s_waitcnt lgkmcnt(11)
    ds_read_b64_tr_b16 a[164:165], v23 offset:8192
    v_mfma_f32_16x16x32_bf16 v[192:195], a[220:223], v[140:143], v[192:195]
    s_waitcnt lgkmcnt(10)
    ds_read_b64_tr_b16 a[166:167], v23 offset:12288
    v_mfma_f32_16x16x32_bf16 v[192:195], a[224:227], v[144:147], v[192:195]
    s_waitcnt lgkmcnt(8)
    ds_read_b64_tr_b16 a[168:169], v23 offset:16384
    v_cvt_pk_bf16_f32 v230, v204, v205
    v_mfma_f32_16x16x32_bf16 v[192:195], a[228:231], v[148:151], v[192:195]
    s_waitcnt lgkmcnt(7)
    s_add_u32 s38, s47, 296960
    ds_read_b64_tr_b16 a[170:171], v23 offset:20480
    v_cvt_pk_bf16_f32 v231, v206, v207
    v_mfma_f32_16x16x32_bf16 v[192:195], a[232:235], v[152:155], v[192:195]
    s_waitcnt lgkmcnt(6)
    ds_read_b64_tr_b16 a[172:173], v23 offset:24576
    buffer_store_dwordx4 v[228:231], v56, s[28:31], s38 offen sc1
    v_mfma_f32_16x16x32_bf16 v[192:195], a[236:239], v[156:159], v[192:195]
    ds_read_b64_tr_b16 a[174:175], v23 offset:28672
    v_mfma_f32_16x16x32_bf16 v[196:199], a[208:211], v[160:163], 0
    ds_read_b64_tr_b16 a[176:177], v27 offset:0
    v_mfma_f32_16x16x32_bf16 v[196:199], a[212:215], v[164:167], v[196:199]
    ds_read_b64_tr_b16 a[178:179], v27 offset:4096
    v_mfma_f32_16x16x32_bf16 v[196:199], a[216:219], v[168:171], v[196:199]
    ds_read_b64_tr_b16 a[180:181], v27 offset:8192
    v_mfma_f32_16x16x32_bf16 v[196:199], a[220:223], v[172:175], v[196:199]
    ds_read_b64_tr_b16 a[182:183], v27 offset:12288
    v_mfma_f32_16x16x32_bf16 v[196:199], a[224:227], v[176:179], v[196:199]
    ds_read_b64_tr_b16 a[184:185], v27 offset:16384
    v_cvt_pk_bf16_f32 v232, v192, v193
    v_mfma_f32_16x16x32_bf16 v[196:199], a[228:231], v[180:183], v[196:199]
    ds_read_b64_tr_b16 a[186:187], v27 offset:20480
    v_cvt_pk_bf16_f32 v233, v194, v195
    v_mfma_f32_16x16x32_bf16 v[196:199], a[232:235], v[184:187], v[196:199]
    ds_read_b64_tr_b16 a[188:189], v27 offset:24576
    v_mfma_f32_16x16x32_bf16 v[196:199], a[236:239], v[188:191], v[196:199]
    s_waitcnt lgkmcnt(13)
    ds_read_b64_tr_b16 a[190:191], v27 offset:28672
    v_mfma_f32_16x16x32_bf16 v[200:203], a[160:163], v[128:131], 0
    s_waitcnt lgkmcnt(12)
    v_mfma_f32_16x16x32_bf16 v[200:203], a[164:167], v[132:135], v[200:203]
    s_waitcnt lgkmcnt(10)
    buffer_load_dword v11, v9, s[24:27], s93 offen sc1
    v_mfma_f32_16x16x32_bf16 v[200:203], a[168:171], v[136:139], v[200:203]
    s_waitcnt lgkmcnt(8)
    v_mfma_f32_16x16x32_bf16 v[200:203], a[172:175], v[140:143], v[200:203]
    s_waitcnt lgkmcnt(6)
    v_mfma_f32_16x16x32_bf16 v[200:203], a[176:179], v[144:147], v[200:203]
    s_waitcnt lgkmcnt(4)
    v_cvt_pk_bf16_f32 v236, v196, v197
    v_mfma_f32_16x16x32_bf16 v[200:203], a[180:183], v[148:151], v[200:203]
    s_waitcnt lgkmcnt(2)
    v_cvt_pk_bf16_f32 v237, v198, v199
    v_mfma_f32_16x16x32_bf16 v[200:203], a[184:187], v[152:155], v[200:203]
    s_waitcnt lgkmcnt(0)
    v_mfma_f32_16x16x32_bf16 v[200:203], a[188:191], v[156:159], v[200:203]
    v_mfma_f32_16x16x32_bf16 v[204:207], a[160:163], v[160:163], 0
    v_mfma_f32_16x16x32_bf16 v[204:207], a[164:167], v[164:167], v[204:207]
    v_mfma_f32_16x16x32_bf16 v[204:207], a[168:171], v[168:171], v[204:207]
    v_mfma_f32_16x16x32_bf16 v[204:207], a[172:175], v[172:175], v[204:207]
    v_mfma_f32_16x16x32_bf16 v[204:207], a[176:179], v[176:179], v[204:207]
    s_nop 2
    v_cvt_pk_bf16_f32 v234, v200, v201
    v_mfma_f32_16x16x32_bf16 v[204:207], a[180:183], v[180:183], v[204:207]
    s_add_u32 s38, s47, 2176
    v_cvt_pk_bf16_f32 v235, v202, v203
    v_mfma_f32_16x16x32_bf16 v[204:207], a[184:187], v[184:187], v[204:207]
    buffer_store_dwordx4 v[232:235], v56, s[28:31], s38 offen sc1
    v_mfma_f32_16x16x32_bf16 v[204:207], a[188:191], v[188:191], v[204:207]
    s_nop 7
    v_cvt_pk_bf16_f32 v238, v204, v205
    s_add_u32 s38, s47, 297088
    v_cvt_pk_bf16_f32 v239, v206, v207
    buffer_store_dwordx4 v[236:239], v56, s[28:31], s38 offen sc1
    s_waitcnt vmcnt(2)
    v_cmp_ne_u32 s[54:55], 0, v11
    s_cmp_lg_u64 s[54:55], 0
    s_cbranch_scc1 Ltail_spin1
Ltail_got1:
    s_add_u32 s93, s93, 4096
    s_add_u32 s45, s44, 0
    buffer_load_dwordx4 a[0:3], v2, s[28:31], s45 offen offset:0 sc1
    s_add_u32 s45, s44, 2304
    buffer_load_dwordx4 a[4:7], v2, s[28:31], s45 offen offset:0 sc1
    s_add_u32 s45, s44, 4608
    buffer_load_dwordx4 a[8:11], v2, s[28:31], s45 offen offset:0 sc1
    s_add_u32 s45, s44, 6912
    buffer_load_dwordx4 a[12:15], v2, s[28:31], s45 offen offset:0 sc1
    s_add_u32 s45, s44, 9216
    buffer_load_dwordx4 a[16:19], v2, s[28:31], s45 offen offset:0 sc1
    s_add_u32 s45, s44, 11520
    buffer_load_dwordx4 a[20:23], v2, s[28:31], s45 offen offset:0 sc1
    s_add_u32 s45, s44, 13824
    buffer_load_dwordx4 a[24:27], v2, s[28:31], s45 offen offset:0 sc1
    s_add_u32 s45, s44, 16128
    buffer_load_dwordx4 a[28:31], v2, s[28:31], s45 offen offset:0 sc1
    s_add_u32 s45, s44, 18432
    buffer_load_dwordx4 a[32:35], v2, s[28:31], s45 offen offset:0 sc1
    s_add_u32 s45, s44, 20736
    buffer_load_dwordx4 a[36:39], v2, s[28:31], s45 offen offset:0 sc1
    s_add_u32 s45, s44, 23040
    buffer_load_dwordx4 a[40:43], v2, s[28:31], s45 offen offset:0 sc1
    s_add_u32 s45, s44, 25344
    buffer_load_dwordx4 a[44:47], v2, s[28:31], s45 offen offset:0 sc1
    v_lshlrev_b32 v12, 16, v36
    v_and_b32 v13, 0xffff0000, v36
    v_lshlrev_b32 v14, 16, v37
    v_and_b32 v15, 0xffff0000, v37
    v_lshlrev_b32 v16, 16, v38
    v_and_b32 v17, 0xffff0000, v38
    v_lshlrev_b32 v18, 16, v39
    v_and_b32 v19, 0xffff0000, v39
    v_lshlrev_b32 v20, 16, v40
    v_and_b32 v21, 0xffff0000, v40
    v_lshlrev_b32 v22, 16, v41
    v_and_b32 v23, 0xffff0000, v41
    v_lshlrev_b32 v24, 16, v42
    v_and_b32 v25, 0xffff0000, v42
    v_lshlrev_b32 v26, 16, v43
    v_and_b32 v27, 0xffff0000, v43
    v_lshlrev_b32 v28, 16, v44
    v_and_b32 v29, 0xffff0000, v44
    v_lshlrev_b32 v30, 16, v45
    v_and_b32 v31, 0xffff0000, v45
    v_lshlrev_b32 v32, 16, v46
    v_and_b32 v33, 0xffff0000, v46
    v_lshlrev_b32 v34, 16, v47
    v_and_b32 v35, 0xffff0000, v47
    v_lshlrev_b32 v128, 16, v64
    v_and_b32 v129, 0xffff0000, v64
    v_lshlrev_b32 v130, 16, v65
    v_and_b32 v131, 0xffff0000, v65
    v_lshlrev_b32 v132, 16, v66
    v_and_b32 v133, 0xffff0000, v66
    v_lshlrev_b32 v134, 16, v67
    v_and_b32 v135, 0xffff0000, v67
    v_lshlrev_b32 v136, 16, v68
    v_and_b32 v137, 0xffff0000, v68
    v_lshlrev_b32 v138, 16, v69
    v_and_b32 v139, 0xffff0000, v69
    v_lshlrev_b32 v140, 16, v70
    v_and_b32 v141, 0xffff0000, v70
    v_lshlrev_b32 v142, 16, v71
    v_and_b32 v143, 0xffff0000, v71
    v_lshlrev_b32 v144, 16, v72
    v_and_b32 v145, 0xffff0000, v72
    v_lshlrev_b32 v146, 16, v73
    v_and_b32 v147, 0xffff0000, v73
    v_lshlrev_b32 v148, 16, v74
    v_and_b32 v149, 0xffff0000, v74
    v_lshlrev_b32 v150, 16, v75
    v_and_b32 v151, 0xffff0000, v75
    v_lshlrev_b32 v152, 16, v76
    v_and_b32 v153, 0xffff0000, v76
    v_lshlrev_b32 v154, 16, v77
    v_and_b32 v155, 0xffff0000, v77
    v_lshlrev_b32 v156, 16, v78
    v_and_b32 v157, 0xffff0000, v78
    v_lshlrev_b32 v158, 16, v79
    v_and_b32 v159, 0xffff0000, v79
    v_lshlrev_b32 v160, 16, v80
    v_and_b32 v161, 0xffff0000, v80
    v_lshlrev_b32 v162, 16, v81
    v_and_b32 v163, 0xffff0000, v81
    v_lshlrev_b32 v164, 16, v82
    v_and_b32 v165, 0xffff0000, v82
    v_lshlrev_b32 v166, 16, v83
    v_and_b32 v167, 0xffff0000, v83
    v_lshlrev_b32 v168, 16, v84
    v_and_b32 v169, 0xffff0000, v84
    v_lshlrev_b32 v170, 16, v85
    v_and_b32 v171, 0xffff0000, v85
    v_lshlrev_b32 v172, 16, v86
    v_and_b32 v173, 0xffff0000, v86
    v_lshlrev_b32 v174, 16, v87
    v_and_b32 v175, 0xffff0000, v87
    v_lshlrev_b32 v176, 16, v88
    v_and_b32 v177, 0xffff0000, v88
    v_lshlrev_b32 v178, 16, v89
    v_and_b32 v179, 0xffff0000, v89
    v_lshlrev_b32 v180, 16, v90
    v_and_b32 v181, 0xffff0000, v90
    v_lshlrev_b32 v182, 16, v91
    v_and_b32 v183, 0xffff0000, v91
    v_lshlrev_b32 v184, 16, v92
    v_and_b32 v185, 0xffff0000, v92
    v_lshlrev_b32 v186, 16, v93
    v_and_b32 v187, 0xffff0000, v93
    v_lshlrev_b32 v188, 16, v94
    v_and_b32 v189, 0xffff0000, v94
    v_lshlrev_b32 v190, 16, v95
    v_and_b32 v191, 0xffff0000, v95
    v_lshlrev_b32 v192, 16, v96
    v_and_b32 v193, 0xffff0000, v96
    v_lshlrev_b32 v194, 16, v97
    v_and_b32 v195, 0xffff0000, v97
    v_lshlrev_b32 v196, 16, v98
    v_and_b32 v197, 0xffff0000, v98
    v_lshlrev_b32 v198, 16, v99
    v_and_b32 v199, 0xffff0000, v99
    s_waitcnt vmcnt(12)
    buffer_store_dword v10, v8, s[24:27], s92 offen sc1
    s_add_u32 s92, s92, 4096
    v_lshlrev_b32 v200, 16, v100
    v_and_b32 v201, 0xffff0000, v100
    v_lshlrev_b32 v202, 16, v101
    v_and_b32 v203, 0xffff0000, v101
    v_lshlrev_b32 v204, 16, v102
    v_and_b32 v205, 0xffff0000, v102
    v_lshlrev_b32 v206, 16, v103
    v_and_b32 v207, 0xffff0000, v103
    v_lshlrev_b32 v208, 16, v104
    v_and_b32 v209, 0xffff0000, v104
    v_lshlrev_b32 v210, 16, v105
    v_and_b32 v211, 0xffff0000, v105
    v_lshlrev_b32 v212, 16, v106
    v_and_b32 v213, 0xffff0000, v106
    v_lshlrev_b32 v214, 16, v107
    v_and_b32 v215, 0xffff0000, v107
    v_lshlrev_b32 v216, 16, v108
    v_and_b32 v217, 0xffff0000, v108
    v_lshlrev_b32 v218, 16, v109
    v_and_b32 v219, 0xffff0000, v109
    v_lshlrev_b32 v220, 16, v110
    v_and_b32 v221, 0xffff0000, v110
    v_lshlrev_b32 v222, 16, v111
    v_and_b32 v223, 0xffff0000, v111
    v_lshlrev_b32 v224, 16, v112
    v_and_b32 v225, 0xffff0000, v112
    v_lshlrev_b32 v226, 16, v113
    v_and_b32 v227, 0xffff0000, v113
    v_lshlrev_b32 v228, 16, v114
    v_and_b32 v229, 0xffff0000, v114
    v_lshlrev_b32 v230, 16, v115
    v_and_b32 v231, 0xffff0000, v115
    v_lshlrev_b32 v232, 16, v116
    v_and_b32 v233, 0xffff0000, v116
    v_lshlrev_b32 v234, 16, v117
    v_and_b32 v235, 0xffff0000, v117
    v_lshlrev_b32 v236, 16, v118
    v_and_b32 v237, 0xffff0000, v118
    v_lshlrev_b32 v238, 16, v119
    v_and_b32 v239, 0xffff0000, v119
    v_lshlrev_b32 v240, 16, v120
    v_and_b32 v241, 0xffff0000, v120
    v_lshlrev_b32 v242, 16, v121
    v_and_b32 v243, 0xffff0000, v121
    v_lshlrev_b32 v244, 16, v122
    v_and_b32 v245, 0xffff0000, v122
    v_lshlrev_b32 v246, 16, v123
    v_and_b32 v247, 0xffff0000, v123
    s_add_u32 s45, s44, 27648
    buffer_load_dwordx4 a[48:51], v2, s[28:31], s45 offen offset:0 sc1
    s_add_u32 s45, s44, 29952
    buffer_load_dwordx4 a[52:55], v2, s[28:31], s45 offen offset:0 sc1
    s_add_u32 s45, s44, 32256
    buffer_load_dwordx4 a[56:59], v2, s[28:31], s45 offen offset:0 sc1
    s_add_u32 s45, s44, 34560
    buffer_load_dwordx4 a[60:63], v2, s[28:31], s45 offen offset:0 sc1
    s_add_u32 s45, s44, 0
    buffer_load_dwordx4 a[64:67], v2, s[28:31], s45 offen offset:768 sc1
    s_add_u32 s45, s44, 2304
    buffer_load_dwordx4 a[68:71], v2, s[28:31], s45 offen offset:768 sc1
    s_add_u32 s45, s44, 4608
    buffer_load_dwordx4 a[72:75], v2, s[28:31], s45 offen offset:768 sc1
    s_add_u32 s45, s44, 6912
    buffer_load_dwordx4 a[76:79], v2, s[28:31], s45 offen offset:768 sc1
    s_add_u32 s45, s44, 9216
    buffer_load_dwordx4 a[80:83], v2, s[28:31], s45 offen offset:768 sc1
    s_add_u32 s45, s44, 11520
    buffer_load_dwordx4 a[84:87], v2, s[28:31], s45 offen offset:768 sc1
    s_add_u32 s45, s44, 13824
    buffer_load_dwordx4 a[88:91], v2, s[28:31], s45 offen offset:768 sc1
    s_add_u32 s45, s44, 16128
    buffer_load_dwordx4 a[92:95], v2, s[28:31], s45 offen offset:768 sc1
    s_add_u32 s45, s44, 18432
    buffer_load_dwordx4 a[96:99], v2, s[28:31], s45 offen offset:768 sc1
    s_add_u32 s45, s44, 20736
    buffer_load_dwordx4 a[100:103], v2, s[28:31], s45 offen offset:768 sc1
    buffer_load_dword v11, v9, s[24:27], s93 offen sc1
    s_add_u32 s45, s44, 23040
    buffer_load_dwordx4 a[104:107], v2, s[28:31], s45 offen offset:768 sc1
    s_add_u32 s45, s44, 25344
    buffer_load_dwordx4 a[108:111], v2, s[28:31], s45 offen offset:768 sc1
    s_add_u32 s45, s44, 27648
    buffer_load_dwordx4 a[112:115], v2, s[28:31], s45 offen offset:768 sc1
    s_add_u32 s45, s44, 29952
    buffer_load_dwordx4 a[116:119], v2, s[28:31], s45 offen offset:768 sc1
    s_add_u32 s45, s44, 32256
    buffer_load_dwordx4 a[120:123], v2, s[28:31], s45 offen offset:768 sc1
    s_add_u32 s45, s44, 34560
    buffer_load_dwordx4 a[124:127], v2, s[28:31], s45 offen offset:768 sc1
    s_waitcnt vmcnt(33)
    v_mfma_f32_16x16x32_bf16 v[64:67], v[250:253], a[0:3], 0
    v_mfma_f32_16x16x32_bf16 v[68:71], v[248:251], a[0:3], 0
    s_waitcnt vmcnt(32)
    v_mfma_f32_16x16x32_bf16 v[64:67], v[250:253], a[4:7], v[64:67]
    v_mfma_f32_16x16x32_bf16 v[68:71], v[248:251], a[4:7], v[68:71]
    s_waitcnt vmcnt(31)
    v_mfma_f32_16x16x32_bf16 v[64:67], v[250:253], a[8:11], v[64:67]
    v_mfma_f32_16x16x32_bf16 v[68:71], v[248:251], a[8:11], v[68:71]
    s_waitcnt vmcnt(30)
    v_mfma_f32_16x16x32_bf16 v[64:67], v[250:253], a[12:15], v[64:67]
    v_mfma_f32_16x16x32_bf16 v[68:71], v[248:251], a[12:15], v[68:71]
    s_waitcnt vmcnt(29)
    v_mfma_f32_16x16x32_bf16 v[64:67], v[250:253], a[16:19], v[64:67]
    v_mfma_f32_16x16x32_bf16 v[68:71], v[248:251], a[16:19], v[68:71]
    s_waitcnt vmcnt(28)
    v_mfma_f32_16x16x32_bf16 v[64:67], v[250:253], a[20:23], v[64:67]
    v_mfma_f32_16x16x32_bf16 v[68:71], v[248:251], a[20:23], v[68:71]
    s_waitcnt vmcnt(27)
    v_mfma_f32_16x16x32_bf16 v[64:67], v[250:253], a[24:27], v[64:67]
    v_mfma_f32_16x16x32_bf16 v[68:71], v[248:251], a[24:27], v[68:71]
    s_waitcnt vmcnt(26)
    v_mfma_f32_16x16x32_bf16 v[64:67], v[250:253], a[28:31], v[64:67]
    v_mfma_f32_16x16x32_bf16 v[68:71], v[248:251], a[28:31], v[68:71]
    s_waitcnt vmcnt(25)
    v_mfma_f32_16x16x32_bf16 v[64:67], v[250:253], a[32:35], v[64:67]
    v_mfma_f32_16x16x32_bf16 v[68:71], v[248:251], a[32:35], v[68:71]
    s_waitcnt vmcnt(24)
    v_mfma_f32_16x16x32_bf16 v[64:67], v[250:253], a[36:39], v[64:67]
    v_mfma_f32_16x16x32_bf16 v[68:71], v[248:251], a[36:39], v[68:71]
    s_waitcnt vmcnt(23)
    v_mfma_f32_16x16x32_bf16 v[64:67], v[250:253], a[40:43], v[64:67]
    v_mfma_f32_16x16x32_bf16 v[68:71], v[248:251], a[40:43], v[68:71]
    s_waitcnt vmcnt(22)
    v_mfma_f32_16x16x32_bf16 v[64:67], v[250:253], a[44:47], v[64:67]
    v_mfma_f32_16x16x32_bf16 v[68:71], v[248:251], a[44:47], v[68:71]
    s_waitcnt vmcnt(20)
    v_mfma_f32_16x16x32_bf16 v[64:67], v[250:253], a[48:51], v[64:67]
    v_mfma_f32_16x16x32_bf16 v[68:71], v[248:251], a[48:51], v[68:71]
    s_waitcnt vmcnt(19)
    v_mfma_f32_16x16x32_bf16 v[64:67], v[250:253], a[52:55], v[64:67]
    v_mfma_f32_16x16x32_bf16 v[68:71], v[248:251], a[52:55], v[68:71]
    s_waitcnt vmcnt(18)
    v_mfma_f32_16x16x32_bf16 v[64:67], v[250:253], a[56:59], v[64:67]
    v_mfma_f32_16x16x32_bf16 v[68:71], v[248:251], a[56:59], v[68:71]
    s_waitcnt vmcnt(17)
    v_mfma_f32_16x16x32_bf16 v[64:67], v[250:253], a[60:63], v[64:67]
    v_mfma_f32_16x16x32_bf16 v[68:71], v[248:251], a[60:63], v[68:71]
    s_nop 6
    v_pk_fma_f32 v[12:13], v[128:129], v[64:65], v[12:13]
    v_pk_fma_f32 v[14:15], v[130:131], v[66:67], v[14:15]
    v_pk_fma_f32 v[16:17], v[132:133], v[68:69], v[16:17]
    v_pk_fma_f32 v[18:19], v[134:135], v[70:71], v[18:19]
    v_cvt_pk_bf16_f32 v112, v12, v13
    v_cvt_pk_bf16_f32 v113, v14, v15
    v_cvt_pk_bf16_f32 v114, v16, v17
    v_cvt_pk_bf16_f32 v115, v18, v19
    v_lshlrev_b32 v12, 16, v112
    v_and_b32 v13, 0xffff0000, v112
    v_lshlrev_b32 v14, 16, v113
    v_and_b32 v15, 0xffff0000, v113
    v_lshlrev_b32 v16, 16, v114
    v_and_b32 v17, 0xffff0000, v114
    v_lshlrev_b32 v18, 16, v115
    v_and_b32 v19, 0xffff0000, v115
    s_mov_b32 s45, 5242880
    buffer_store_dwordx4 v[112:115], v6, s[24:27], s45 offen offset:0 sc1
    v_pk_add_f32 v[48:49], v[12:13], v[14:15]
    v_pk_add_f32 v[50:51], v[16:17], v[18:19]
    s_waitcnt vmcnt(7)
    v_cmp_ne_u32 s[54:55], 0, v11
    s_cmp_lg_u64 s[54:55], 0
    s_cbranch_scc1 Ltail_spin2
Ltail_got2:
    s_add_u32 s93, s93, 4096
    s_add_u32 s45, s44, 0
    buffer_load_dwordx4 a[128:131], v2, s[28:31], s45 offen offset:1536 sc1
    s_add_u32 s45, s44, 2304
    buffer_load_dwordx4 a[132:135], v2, s[28:31], s45 offen offset:1536 sc1
    s_add_u32 s45, s44, 4608
    buffer_load_dwordx4 a[136:139], v2, s[28:31], s45 offen offset:1536 sc1
    s_add_u32 s45, s44, 6912
    buffer_load_dwordx4 a[140:143], v2, s[28:31], s45 offen offset:1536 sc1
    s_add_u32 s45, s44, 9216
    buffer_load_dwordx4 a[144:147], v2, s[28:31], s45 offen offset:1536 sc1
    s_add_u32 s45, s44, 11520
    buffer_load_dwordx4 a[148:151], v2, s[28:31], s45 offen offset:1536 sc1
    s_add_u32 s45, s44, 13824
    buffer_load_dwordx4 a[152:155], v2, s[28:31], s45 offen offset:1536 sc1
    s_add_u32 s45, s44, 16128
    buffer_load_dwordx4 a[156:159], v2, s[28:31], s45 offen offset:1536 sc1
    s_add_u32 s45, s44, 18432
    buffer_load_dwordx4 a[160:163], v2, s[28:31], s45 offen offset:1536 sc1
    s_add_u32 s45, s44, 20736
    buffer_load_dwordx4 a[164:167], v2, s[28:31], s45 offen offset:1536 sc1
    s_add_u32 s45, s44, 23040
    buffer_load_dwordx4 a[168:171], v2, s[28:31], s45 offen offset:1536 sc1
    s_add_u32 s45, s44, 25344
    buffer_load_dwordx4 a[172:175], v2, s[28:31], s45 offen offset:1536 sc1
    s_add_u32 s45, s44, 27648
    buffer_load_dwordx4 a[176:179], v2, s[28:31], s45 offen offset:1536 sc1
    s_add_u32 s45, s44, 29952
    buffer_load_dwordx4 a[180:183], v2, s[28:31], s45 offen offset:1536 sc1
    s_add_u32 s45, s44, 32256
    buffer_load_dwordx4 a[184:187], v2, s[28:31], s45 offen offset:1536 sc1
    s_add_u32 s45, s44, 34560
    buffer_load_dwordx4 a[188:191], v2, s[28:31], s45 offen offset:1536 sc1
    v_mfma_f32_16x16x32_bf16 v[72:75], v[250:253], a[64:67], 0
    v_mfma_f32_16x16x32_bf16 v[76:79], v[248:251], a[64:67], 0
    v_mfma_f32_16x16x32_bf16 v[72:75], v[250:253], a[68:71], v[72:75]
    v_mfma_f32_16x16x32_bf16 v[76:79], v[248:251], a[68:71], v[76:79]
    v_mfma_f32_16x16x32_bf16 v[72:75], v[250:253], a[72:75], v[72:75]
    v_mfma_f32_16x16x32_bf16 v[76:79], v[248:251], a[72:75], v[76:79]
    v_mfma_f32_16x16x32_bf16 v[72:75], v[250:253], a[76:79], v[72:75]
    v_mfma_f32_16x16x32_bf16 v[76:79], v[248:251], a[76:79], v[76:79]
    v_mfma_f32_16x16x32_bf16 v[72:75], v[250:253], a[80:83], v[72:75]
    v_mfma_f32_16x16x32_bf16 v[76:79], v[248:251], a[80:83], v[76:79]
    v_mfma_f32_16x16x32_bf16 v[72:75], v[250:253], a[84:87], v[72:75]
    v_mfma_f32_16x16x32_bf16 v[76:79], v[248:251], a[84:87], v[76:79]
    v_mfma_f32_16x16x32_bf16 v[72:75], v[250:253], a[88:91], v[72:75]
    v_mfma_f32_16x16x32_bf16 v[76:79], v[248:251], a[88:91], v[76:79]
    v_mfma_f32_16x16x32_bf16 v[72:75], v[250:253], a[92:95], v[72:75]
    v_mfma_f32_16x16x32_bf16 v[76:79], v[248:251], a[92:95], v[76:79]
    v_mfma_f32_16x16x32_bf16 v[72:75], v[250:253], a[96:99], v[72:75]
    v_mfma_f32_16x16x32_bf16 v[76:79], v[248:251], a[96:99], v[76:79]
    v_mfma_f32_16x16x32_bf16 v[72:75], v[250:253], a[100:103], v[72:75]
    v_mfma_f32_16x16x32_bf16 v[76:79], v[248:251], a[100:103], v[76:79]
    s_waitcnt vmcnt(22)
    v_mfma_f32_16x16x32_bf16 v[72:75], v[250:253], a[104:107], v[72:75]
    v_mfma_f32_16x16x32_bf16 v[76:79], v[248:251], a[104:107], v[76:79]
    s_waitcnt vmcnt(21)
    v_mfma_f32_16x16x32_bf16 v[72:75], v[250:253], a[108:111], v[72:75]
    v_mfma_f32_16x16x32_bf16 v[76:79], v[248:251], a[108:111], v[76:79]
    s_waitcnt vmcnt(20)
    v_mfma_f32_16x16x32_bf16 v[72:75], v[250:253], a[112:115], v[72:75]
    v_mfma_f32_16x16x32_bf16 v[76:79], v[248:251], a[112:115], v[76:79]
    s_waitcnt vmcnt(19)
    v_mfma_f32_16x16x32_bf16 v[72:75], v[250:253], a[116:119], v[72:75]
    v_mfma_f32_16x16x32_bf16 v[76:79], v[248:251], a[116:119], v[76:79]
    s_waitcnt vmcnt(18)
    v_mfma_f32_16x16x32_bf16 v[72:75], v[250:253], a[120:123], v[72:75]
    v_mfma_f32_16x16x32_bf16 v[76:79], v[248:251], a[120:123], v[76:79]
    s_waitcnt vmcnt(17)
    v_mfma_f32_16x16x32_bf16 v[72:75], v[250:253], a[124:127], v[72:75]
    v_mfma_f32_16x16x32_bf16 v[76:79], v[248:251], a[124:127], v[76:79]
    s_waitcnt vmcnt(15)
    s_nop 5
    v_pk_fma_f32 v[20:21], v[136:137], v[72:73], v[20:21]
    v_pk_fma_f32 v[22:23], v[138:139], v[74:75], v[22:23]
    v_pk_fma_f32 v[24:25], v[140:141], v[76:77], v[24:25]
    v_pk_fma_f32 v[26:27], v[142:143], v[78:79], v[26:27]
    v_cvt_pk_bf16_f32 v116, v20, v21
    v_cvt_pk_bf16_f32 v117, v22, v23
    v_cvt_pk_bf16_f32 v118, v24, v25
    v_cvt_pk_bf16_f32 v119, v26, v27
    v_lshlrev_b32 v20, 16, v116
    v_and_b32 v21, 0xffff0000, v116
    v_lshlrev_b32 v22, 16, v117
    v_and_b32 v23, 0xffff0000, v117
    v_lshlrev_b32 v24, 16, v118
    v_and_b32 v25, 0xffff0000, v118
    v_lshlrev_b32 v26, 16, v119
    v_and_b32 v27, 0xffff0000, v119
    s_mov_b32 s45, 5242880
    buffer_store_dwordx4 v[116:119], v6, s[24:27], s45 offen offset:384 sc1
    v_pk_add_f32 v[48:49], v[48:49], v[20:21]
    v_pk_add_f32 v[50:51], v[50:51], v[22:23]
    v_pk_add_f32 v[48:49], v[48:49], v[24:25]
    v_pk_add_f32 v[50:51], v[50:51], v[26:27]
    v_mfma_f32_16x16x32_bf16 v[80:83], v[250:253], a[128:131], 0
    v_mfma_f32_16x16x32_bf16 v[84:87], v[248:251], a[128:131], 0
    s_waitcnt vmcnt(15)
    v_mfma_f32_16x16x32_bf16 v[80:83], v[250:253], a[132:135], v[80:83]
    v_mfma_f32_16x16x32_bf16 v[84:87], v[248:251], a[132:135], v[84:87]
    s_waitcnt vmcnt(14)
    v_mfma_f32_16x16x32_bf16 v[80:83], v[250:253], a[136:139], v[80:83]
    v_mfma_f32_16x16x32_bf16 v[84:87], v[248:251], a[136:139], v[84:87]
    s_waitcnt vmcnt(13)
    v_mfma_f32_16x16x32_bf16 v[80:83], v[250:253], a[140:143], v[80:83]
    v_mfma_f32_16x16x32_bf16 v[84:87], v[248:251], a[140:143], v[84:87]
    s_waitcnt vmcnt(12)
    v_mfma_f32_16x16x32_bf16 v[80:83], v[250:253], a[144:147], v[80:83]
    v_mfma_f32_16x16x32_bf16 v[84:87], v[248:251], a[144:147], v[84:87]
    s_waitcnt vmcnt(11)
    v_mfma_f32_16x16x32_bf16 v[80:83], v[250:253], a[148:151], v[80:83]
    v_mfma_f32_16x16x32_bf16 v[84:87], v[248:251], a[148:151], v[84:87]
    s_waitcnt vmcnt(10)
    v_mfma_f32_16x16x32_bf16 v[80:83], v[250:253], a[152:155], v[80:83]
    v_mfma_f32_16x16x32_bf16 v[84:87], v[248:251], a[152:155], v[84:87]
    s_waitcnt vmcnt(9)
    v_mfma_f32_16x16x32_bf16 v[80:83], v[250:253], a[156:159], v[80:83]
    v_mfma_f32_16x16x32_bf16 v[84:87], v[248:251], a[156:159], v[84:87]
    s_waitcnt vmcnt(8)
    v_mfma_f32_16x16x32_bf16 v[80:83], v[250:253], a[160:163], v[80:83]
    v_mfma_f32_16x16x32_bf16 v[84:87], v[248:251], a[160:163], v[84:87]
    s_waitcnt vmcnt(7)
    v_mfma_f32_16x16x32_bf16 v[80:83], v[250:253], a[164:167], v[80:83]
    v_mfma_f32_16x16x32_bf16 v[84:87], v[248:251], a[164:167], v[84:87]
    s_waitcnt vmcnt(6)
    v_mfma_f32_16x16x32_bf16 v[80:83], v[250:253], a[168:171], v[80:83]
    v_mfma_f32_16x16x32_bf16 v[84:87], v[248:251], a[168:171], v[84:87]
    s_waitcnt vmcnt(5)
    v_mfma_f32_16x16x32_bf16 v[80:83], v[250:253], a[172:175], v[80:83]
    v_mfma_f32_16x16x32_bf16 v[84:87], v[248:251], a[172:175], v[84:87]
    s_waitcnt vmcnt(4)
    v_mfma_f32_16x16x32_bf16 v[80:83], v[250:253], a[176:179], v[80:83]
    v_mfma_f32_16x16x32_bf16 v[84:87], v[248:251], a[176:179], v[84:87]
    s_waitcnt vmcnt(3)
    v_mfma_f32_16x16x32_bf16 v[80:83], v[250:253], a[180:183], v[80:83]
    v_mfma_f32_16x16x32_bf16 v[84:87], v[248:251], a[180:183], v[84:87]
    s_waitcnt vmcnt(2)
    v_mfma_f32_16x16x32_bf16 v[80:83], v[250:253], a[184:187], v[80:83]
    v_mfma_f32_16x16x32_bf16 v[84:87], v[248:251], a[184:187], v[84:87]
    s_waitcnt vmcnt(1)
    v_mfma_f32_16x16x32_bf16 v[80:83], v[250:253], a[188:191], v[80:83]
    v_mfma_f32_16x16x32_bf16 v[84:87], v[248:251], a[188:191], v[84:87]
    s_nop 6
    v_pk_fma_f32 v[28:29], v[144:145], v[80:81], v[28:29]
    v_pk_fma_f32 v[30:31], v[146:147], v[82:83], v[30:31]
    v_pk_fma_f32 v[32:33], v[148:149], v[84:85], v[32:33]
    v_pk_fma_f32 v[34:35], v[150:151], v[86:87], v[34:35]
    v_cvt_pk_bf16_f32 v120, v28, v29
    v_cvt_pk_bf16_f32 v121, v30, v31
    v_cvt_pk_bf16_f32 v122, v32, v33
    v_cvt_pk_bf16_f32 v123, v34, v35
    v_lshlrev_b32 v28, 16, v120
    v_and_b32 v29, 0xffff0000, v120
    v_lshlrev_b32 v30, 16, v121
    v_and_b32 v31, 0xffff0000, v121
    v_lshlrev_b32 v32, 16, v122
    v_and_b32 v33, 0xffff0000, v122
    v_lshlrev_b32 v34, 16, v123
    v_and_b32 v35, 0xffff0000, v123
    s_mov_b32 s45, 5242880
    buffer_store_dwordx4 v[120:123], v6, s[24:27], s45 offen offset:768 sc1
    v_pk_add_f32 v[48:49], v[48:49], v[28:29]
    v_pk_add_f32 v[50:51], v[50:51], v[30:31]
    v_pk_add_f32 v[48:49], v[48:49], v[32:33]
    v_pk_add_f32 v[50:51], v[50:51], v[34:35]
    v_pk_add_f32 v[48:49], v[48:49], v[50:51]
    v_add_f32 v48, v48, v49
    s_nop 1
    v_add_f32_dpp v48, v48, v48 row_ror:1 row_mask:0xf bank_mask:0xf
    s_nop 1
    v_add_f32_dpp v48, v48, v48 row_ror:2 row_mask:0xf bank_mask:0xf
    s_nop 1
    v_add_f32_dpp v48, v48, v48 row_ror:4 row_mask:0xf bank_mask:0xf
    s_nop 1
    v_add_f32_dpp v48, v48, v48 row_ror:8 row_mask:0xf bank_mask:0xf
    v_mov_b32 v52, v48
    s_nop 1
    v_permlane16_swap_b32 v48, v52
    s_nop 0
    v_add_f32 v48, v48, v52
    v_mul_f32 v48, 0x3ae38e39, v48
    v_pk_add_f32 v[88:89], v[12:13], v[48:49] op_sel_hi:[1,0] neg_lo:[0,1] neg_hi:[0,1]
    v_pk_add_f32 v[90:91], v[14:15], v[48:49] op_sel_hi:[1,0] neg_lo:[0,1] neg_hi:[0,1]
    v_pk_add_f32 v[92:93], v[16:17], v[48:49] op_sel_hi:[1,0] neg_lo:[0,1] neg_hi:[0,1]
    v_pk_add_f32 v[94:95], v[18:19], v[48:49] op_sel_hi:[1,0] neg_lo:[0,1] neg_hi:[0,1]
    v_pk_add_f32 v[96:97], v[20:21], v[48:49] op_sel_hi:[1,0] neg_lo:[0,1] neg_hi:[0,1]
    v_pk_add_f32 v[98:99], v[22:23], v[48:49] op_sel_hi:[1,0] neg_lo:[0,1] neg_hi:[0,1]
    v_pk_add_f32 v[100:101], v[24:25], v[48:49] op_sel_hi:[1,0] neg_lo:[0,1] neg_hi:[0,1]
    v_pk_add_f32 v[102:103], v[26:27], v[48:49] op_sel_hi:[1,0] neg_lo:[0,1] neg_hi:[0,1]
    v_pk_add_f32 v[104:105], v[28:29], v[48:49] op_sel_hi:[1,0] neg_lo:[0,1] neg_hi:[0,1]
    v_pk_add_f32 v[106:107], v[30:31], v[48:49] op_sel_hi:[1,0] neg_lo:[0,1] neg_hi:[0,1]
    v_pk_add_f32 v[108:109], v[32:33], v[48:49] op_sel_hi:[1,0] neg_lo:[0,1] neg_hi:[0,1]
    v_pk_add_f32 v[110:111], v[34:35], v[48:49] op_sel_hi:[1,0] neg_lo:[0,1] neg_hi:[0,1]
    v_pk_mul_f32 v[50:51], v[88:89], v[88:89]
    v_pk_mul_f32 v[52:53], v[90:91], v[90:91]
    v_pk_fma_f32 v[50:51], v[92:93], v[92:93], v[50:51]
    v_pk_fma_f32 v[52:53], v[94:95], v[94:95], v[52:53]
    v_pk_fma_f32 v[50:51], v[96:97], v[96:97], v[50:51]
    v_pk_fma_f32 v[52:53], v[98:99], v[98:99], v[52:53]
    v_pk_fma_f32 v[50:51], v[100:101], v[100:101], v[50:51]
    v_pk_fma_f32 v[52:53], v[102:103], v[102:103], v[52:53]
    v_pk_fma_f32 v[50:51], v[104:105], v[104:105], v[50:51]
    v_pk_fma_f32 v[52:53], v[106:107], v[106:107], v[52:53]
    v_pk_fma_f32 v[50:51], v[108:109], v[108:109], v[50:51]
    v_pk_fma_f32 v[52:53], v[110:111], v[110:111], v[52:53]
    v_pk_add_f32 v[50:51], v[50:51], v[52:53]
    v_add_f32 v50, v50, v51
    v_cndmask_b32 v50, 0, v50, vcc
    s_nop 1
    v_add_f32_dpp v50, v50, v50 row_ror:1 row_mask:0xf bank_mask:0xf
    s_nop 1
    v_add_f32_dpp v50, v50, v50 row_ror:2 row_mask:0xf bank_mask:0xf
    s_nop 1
    v_add_f32_dpp v50, v50, v50 row_ror:4 row_mask:0xf bank_mask:0xf
    s_nop 1
    v_add_f32_dpp v50, v50, v50 row_ror:8 row_mask:0xf bank_mask:0xf
    v_mov_b32 v52, v50
    s_nop 1
    v_permlane16_swap_b32 v50, v52
    s_nop 0
    v_add_f32 v50, v50, v52
    v_mul_f32 v50, 0x3ae38e39, v50
    v_cvt_pk_bf16_f32 v52, v48, v50
    v_and_b32 v50, 0xffff0000, v52
    v_lshlrev_b32 v52, 16, v52
    v_add_f32 v50, 0x3727c5ac, v50
    v_sub_f32 v48, v48, v52
    v_cvt_pk_bf16_f32 v50, v50, v50
    v_and_b32 v50, 0xffff0000, v50
    v_sqrt_f32 v50, v50
    s_nop 0
    v_cvt_pk_bf16_f32 v50, v50, v50
    v_and_b32 v50, 0xffff0000, v50
    v_rcp_f32 v50, v50
    s_mov_b32 s45, 2621440
    v_mul_f32 v48, v48, v50
    v_pk_fma_f32 v[88:89], v[88:89], v[50:51], v[48:49] op_sel_hi:[1,0,0]
    v_pk_fma_f32 v[90:91], v[90:91], v[50:51], v[48:49] op_sel_hi:[1,0,0]
    v_pk_fma_f32 v[92:93], v[92:93], v[50:51], v[48:49] op_sel_hi:[1,0,0]
    v_pk_fma_f32 v[94:95], v[94:95], v[50:51], v[48:49] op_sel_hi:[1,0,0]
    v_pk_fma_f32 v[96:97], v[96:97], v[50:51], v[48:49] op_sel_hi:[1,0,0]
    v_pk_fma_f32 v[98:99], v[98:99], v[50:51], v[48:49] op_sel_hi:[1,0,0]
    v_pk_fma_f32 v[100:101], v[100:101], v[50:51], v[48:49] op_sel_hi:[1,0,0]
    v_pk_fma_f32 v[102:103], v[102:103], v[50:51], v[48:49] op_sel_hi:[1,0,0]
    v_pk_fma_f32 v[104:105], v[104:105], v[50:51], v[48:49] op_sel_hi:[1,0,0]
    v_pk_fma_f32 v[106:107], v[106:107], v[50:51], v[48:49] op_sel_hi:[1,0,0]
    v_pk_fma_f32 v[108:109], v[108:109], v[50:51], v[48:49] op_sel_hi:[1,0,0]
    v_pk_fma_f32 v[110:111], v[110:111], v[50:51], v[48:49] op_sel_hi:[1,0,0]
    v_pk_fma_f32 v[88:89], v[88:89], v[152:153], v[176:177]
    v_pk_fma_f32 v[90:91], v[90:91], v[154:155], v[178:179]
    v_pk_fma_f32 v[92:93], v[92:93], v[156:157], v[180:181]
    v_pk_fma_f32 v[94:95], v[94:95], v[158:159], v[182:183]
    v_pk_fma_f32 v[96:97], v[96:97], v[160:161], v[184:185]
    v_pk_fma_f32 v[98:99], v[98:99], v[162:163], v[186:187]
    v_pk_fma_f32 v[100:101], v[100:101], v[164:165], v[188:189]
    v_pk_fma_f32 v[102:103], v[102:103], v[166:167], v[190:191]
    v_pk_fma_f32 v[104:105], v[104:105], v[168:169], v[192:193]
    v_pk_fma_f32 v[106:107], v[106:107], v[170:171], v[194:195]
    v_pk_fma_f32 v[108:109], v[108:109], v[172:173], v[196:197]
    v_pk_fma_f32 v[110:111], v[110:111], v[174:175], v[198:199]
    v_cvt_pk_bf16_f32 v36, v88, v89
    v_cvt_pk_bf16_f32 v37, v90, v91
    v_cvt_pk_bf16_f32 v38, v92, v93
    v_cvt_pk_bf16_f32 v39, v94, v95
    v_cvt_pk_bf16_f32 v40, v96, v97
    v_cvt_pk_bf16_f32 v41, v98, v99
    v_cvt_pk_bf16_f32 v42, v100, v101
    v_cvt_pk_bf16_f32 v43, v102, v103
    v_cvt_pk_bf16_f32 v44, v104, v105
    v_cvt_pk_bf16_f32 v45, v106, v107
    v_cvt_pk_bf16_f32 v46, v108, v109
    v_cvt_pk_bf16_f32 v47, v110, v111
    buffer_store_dwordx4 v[36:39], v6, s[24:27], s45 offen offset:0 sc1
    buffer_store_dwordx4 v[40:43], v6, s[24:27], s45 offen offset:384 sc1
    buffer_store_dwordx4 v[44:47], v6, s[24:27], s45 offen offset:768 sc1
    v_lshlrev_b32 v88, 16, v36
    v_and_b32 v89, 0xffff0000, v36
    v_lshlrev_b32 v90, 16, v37
    v_and_b32 v91, 0xffff0000, v37
    v_lshlrev_b32 v92, 16, v38
    v_and_b32 v93, 0xffff0000, v38
    v_lshlrev_b32 v94, 16, v39
    v_and_b32 v95, 0xffff0000, v39
    v_lshlrev_b32 v96, 16, v40
    v_and_b32 v97, 0xffff0000, v40
    v_lshlrev_b32 v98, 16, v41
    v_and_b32 v99, 0xffff0000, v41
    v_lshlrev_b32 v100, 16, v42
    v_and_b32 v101, 0xffff0000, v42
    v_lshlrev_b32 v102, 16, v43
    v_and_b32 v103, 0xffff0000, v43
    v_lshlrev_b32 v104, 16, v44
    v_and_b32 v105, 0xffff0000, v44
    v_lshlrev_b32 v106, 16, v45
    v_and_b32 v107, 0xffff0000, v45
    v_lshlrev_b32 v108, 16, v46
    v_and_b32 v109, 0xffff0000, v46
    v_lshlrev_b32 v110, 16, v47
    v_and_b32 v111, 0xffff0000, v47
    v_pk_mul_f32 v[50:51], v[88:89], v[200:201]
    v_pk_mul_f32 v[52:53], v[90:91], v[202:203]
    v_pk_fma_f32 v[50:51], v[92:93], v[204:205], v[50:51]
    v_pk_fma_f32 v[52:53], v[94:95], v[206:207], v[52:53]
    v_pk_fma_f32 v[50:51], v[96:97], v[208:209], v[50:51]
    v_pk_fma_f32 v[52:53], v[98:99], v[210:211], v[52:53]
    v_pk_fma_f32 v[50:51], v[100:101], v[212:213], v[50:51]
    v_pk_fma_f32 v[52:53], v[102:103], v[214:215], v[52:53]
    v_pk_fma_f32 v[50:51], v[104:105], v[216:217], v[50:51]
    v_pk_fma_f32 v[52:53], v[106:107], v[218:219], v[52:53]
    v_pk_fma_f32 v[50:51], v[108:109], v[220:221], v[50:51]
    v_pk_fma_f32 v[52:53], v[110:111], v[222:223], v[52:53]
    v_pk_add_f32 v[50:51], v[50:51], v[52:53]
    v_add_f32 v50, v50, v51
    v_lshlrev_b32 v48, 2, v7
    v_and_b32 v48, 28, v48
    v_sub_u32 v49, 2047, v7
    v_add_f32_dpp v50, v50, v50 row_ror:1 row_mask:0xf bank_mask:0xf
    s_nop 1
    v_add_f32_dpp v50, v50, v50 row_ror:2 row_mask:0xf bank_mask:0xf
    s_nop 1
    v_add_f32_dpp v50, v50, v50 row_ror:4 row_mask:0xf bank_mask:0xf
    s_nop 1
    v_add_f32_dpp v50, v50, v50 row_ror:8 row_mask:0xf bank_mask:0xf
    v_mov_b32 v52, v50
    s_nop 1
    v_permlane16_swap_b32 v50, v52
    s_nop 0
    v_add_f32 v50, v50, v52
    v_ashrrev_i32 v52, 31, v50
    v_or_b32 v52, 0x80000000, v52
    v_xor_b32 v52, v52, v50
    v_and_b32 v52, 0xfffff800, v52
    v_min_u32 v52, 0xfffff000, v52
    v_or_b32 v52, v52, v49
    s_mov_b32 exec_lo, 1
    s_mov_b32 exec_hi, 1
    ds_write_b32 v48, v52 offset:53248
    s_mov_b64 exec, -1
    s_waitcnt lgkmcnt(0)
    s_barrier
    s_cmp_lg_u32 s3, 0
    s_cbranch_scc1 Ltail_notw0
    v_mov_b32 v141, 53248
    ds_read_b128 v[128:131], v141
    ds_read_b128 v[132:135], v141 offset:16
    s_lshl_b32 s45, s40, 3
    s_add_u32 s45, s45, 7860224
    s_mov_b32 s48, 7860224
    v_lshl_add_u32 v140, v1, 4, s48
    s_waitcnt lgkmcnt(1)
    v_max_u32 v136, v128, v129
    v_min_u32 v137, v128, v129
    v_med3_u32 v137, v136, v137, v130
    v_max_u32 v136, v136, v130
    v_med3_u32 v137, v136, v137, v131
    v_max_u32 v136, v136, v131
    s_waitcnt lgkmcnt(0)
    v_med3_u32 v137, v136, v137, v132
    v_max_u32 v136, v136, v132
    v_med3_u32 v137, v136, v137, v133
    v_max_u32 v136, v136, v133
    v_med3_u32 v137, v136, v137, v134
    v_max_u32 v136, v136, v134
    v_med3_u32 v137, v136, v137, v135
    v_max_u32 v136, v136, v135
    buffer_store_dwordx2 v[136:137], v8, s[24:27], s45 offen sc1
Ltail_notw0:
    v_pk_mul_f32 v[224:225], v[224:225], v[88:89]
    v_pk_mul_f32 v[226:227], v[226:227], v[90:91]
    v_pk_mul_f32 v[228:229], v[228:229], v[92:93]
    v_pk_mul_f32 v[230:231], v[230:231], v[94:95]
    v_pk_mul_f32 v[232:233], v[232:233], v[96:97]
    v_pk_mul_f32 v[234:235], v[234:235], v[98:99]
    v_pk_mul_f32 v[236:237], v[236:237], v[100:101]
    v_pk_mul_f32 v[238:239], v[238:239], v[102:103]
    v_pk_mul_f32 v[240:241], v[240:241], v[104:105]
    v_pk_mul_f32 v[242:243], v[242:243], v[106:107]
    v_pk_mul_f32 v[244:245], v[244:245], v[108:109]
    v_pk_mul_f32 v[246:247], v[246:247], v[110:111]
    v_cvt_pk_bf16_f32 v208, v224, v225
    v_cvt_pk_bf16_f32 v209, v226, v227
    v_cvt_pk_bf16_f32 v210, v228, v229
    v_cvt_pk_bf16_f32 v211, v230, v231
    v_cvt_pk_bf16_f32 v212, v232, v233
    v_cvt_pk_bf16_f32 v213, v234, v235
    v_cvt_pk_bf16_f32 v214, v236, v237
    v_cvt_pk_bf16_f32 v215, v238, v239
    v_cvt_pk_bf16_f32 v216, v240, v241
    v_cvt_pk_bf16_f32 v217, v242, v243
    v_cvt_pk_bf16_f32 v218, v244, v245
    v_cvt_pk_bf16_f32 v219, v246, v247
    v_lshlrev_b32 v224, 16, v208
    v_and_b32 v225, 0xffff0000, v208
    v_lshlrev_b32 v226, 16, v209
    v_and_b32 v227, 0xffff0000, v209
    v_lshlrev_b32 v228, 16, v210
    v_and_b32 v229, 0xffff0000, v210
    v_lshlrev_b32 v230, 16, v211
    v_and_b32 v231, 0xffff0000, v211
    v_lshlrev_b32 v232, 16, v212
    v_and_b32 v233, 0xffff0000, v212
    v_lshlrev_b32 v234, 16, v213
    v_and_b32 v235, 0xffff0000, v213
    v_lshlrev_b32 v236, 16, v214
    v_and_b32 v237, 0xffff0000, v214
    v_lshlrev_b32 v238, 16, v215
    v_and_b32 v239, 0xffff0000, v215
    v_lshlrev_b32 v240, 16, v216
    v_and_b32 v241, 0xffff0000, v216
    v_lshlrev_b32 v242, 16, v217
    v_and_b32 v243, 0xffff0000, v217
    v_lshlrev_b32 v244, 16, v218
    v_and_b32 v245, 0xffff0000, v218
    v_lshlrev_b32 v246, 16, v219
    v_and_b32 v247, 0xffff0000, v219
    v_pk_add_f32 v[224:225], v[224:225], v[12:13]
    v_pk_add_f32 v[226:227], v[226:227], v[14:15]
    v_pk_add_f32 v[228:229], v[228:229], v[16:17]
    v_pk_add_f32 v[230:231], v[230:231], v[18:19]
    v_pk_add_f32 v[232:233], v[232:233], v[20:21]
    v_pk_add_f32 v[234:235], v[234:235], v[22:23]
    v_pk_add_f32 v[236:237], v[236:237], v[24:25]
    v_pk_add_f32 v[238:239], v[238:239], v[26:27]
    v_pk_add_f32 v[240:241], v[240:241], v[28:29]
    v_pk_add_f32 v[242:243], v[242:243], v[30:31]
    v_pk_add_f32 v[244:245], v[244:245], v[32:33]
    v_pk_add_f32 v[246:247], v[246:247], v[34:35]
    v_cvt_pk_bf16_f32 v208, v224, v225
    v_cvt_pk_bf16_f32 v209, v226, v227
    v_cvt_pk_bf16_f32 v210, v228, v229
    v_cvt_pk_bf16_f32 v211, v230, v231
    v_cvt_pk_bf16_f32 v212, v232, v233
    v_cvt_pk_bf16_f32 v213, v234, v235
    v_cvt_pk_bf16_f32 v214, v236, v237
    v_cvt_pk_bf16_f32 v215, v238, v239
    v_cvt_pk_bf16_f32 v216, v240, v241
    v_cvt_pk_bf16_f32 v217, v242, v243
    v_cvt_pk_bf16_f32 v218, v244, v245
    v_cvt_pk_bf16_f32 v219, v246, v247
    s_mov_b32 s38, 135168
    s_mov_b32 s39, 8192
    v_lshrrev_b32 v9, 2, v1
    v_and_b32 v10, 3, v1
    v_lshlrev_b32 v10, 3, v10
    s_and_b32 s45, s3, 1
    s_lshl_b32 s45, s45, 5
    v_lshl_add_u32 v11, v9, 6, v10
    v_add_u32 v11, s45, v11
    s_cmp_lt_u32 s3, 2
    s_cselect_b32 s44, 98304, s38
    s_cselect_b32 s45, 98304, s39
    v_add_u32 v12, s45, v11
    v_add_u32 v11, s44, v11
    ds_read_b64_tr_b16 a[0:1], v11 offset:0
    ds_read_b64_tr_b16 a[2:3], v11 offset:1024
    ds_read_b64_tr_b16 a[4:5], v11 offset:2048
    ds_read_b64_tr_b16 a[6:7], v11 offset:3072
    ds_read_b64_tr_b16 a[8:9], v11 offset:4096
    ds_read_b64_tr_b16 a[10:11], v11 offset:5120
    ds_read_b64_tr_b16 a[12:13], v11 offset:6144
    ds_read_b64_tr_b16 a[14:15], v11 offset:7168
    ds_read_b64_tr_b16 a[16:17], v11 offset:8192
    ds_read_b64_tr_b16 a[18:19], v11 offset:9216
    ds_read_b64_tr_b16 a[20:21], v11 offset:10240
    ds_read_b64_tr_b16 a[22:23], v11 offset:11264
    ds_read_b64_tr_b16 a[24:25], v11 offset:12288
    ds_read_b64_tr_b16 a[26:27], v11 offset:13312
    ds_read_b64_tr_b16 a[28:29], v11 offset:14336
    ds_read_b64_tr_b16 a[30:31], v11 offset:15360
    ds_read_b64_tr_b16 a[32:33], v11 offset:16384
    ds_read_b64_tr_b16 a[34:35], v11 offset:17408
    ds_read_b64_tr_b16 a[36:37], v11 offset:18432
    ds_read_b64_tr_b16 a[38:39], v11 offset:19456
    ds_read_b64_tr_b16 a[40:41], v11 offset:20480
    ds_read_b64_tr_b16 a[42:43], v11 offset:21504
    ds_read_b64_tr_b16 a[44:45], v11 offset:22528
    ds_read_b64_tr_b16 a[46:47], v11 offset:23552
    ds_read_b64_tr_b16 a[48:49], v11 offset:24576
    ds_read_b64_tr_b16 a[50:51], v11 offset:25600
    ds_read_b64_tr_b16 a[52:53], v11 offset:26624
    ds_read_b64_tr_b16 a[54:55], v11 offset:27648
    ds_read_b64_tr_b16 a[56:57], v12 offset:28672
    ds_read_b64_tr_b16 a[58:59], v12 offset:29696
    ds_read_b64_tr_b16 a[60:61], v12 offset:30720
    ds_read_b64_tr_b16 a[62:63], v12 offset:31744
    ds_read_b64_tr_b16 a[64:65], v12 offset:32768
    ds_read_b64_tr_b16 a[66:67], v12 offset:33792
    ds_read_b64_tr_b16 a[68:69], v12 offset:34816
    ds_read_b64_tr_b16 a[70:71], v12 offset:35840
    v_mul_u32_u24 v12, 1152, v9
    s_lshl_b32 s44, s3, 7
    s_add_u32 s44, s44, 0
    v_add3_u32 v12, v12, v10, s44
    ds_read_b64_tr_b16 a[72:73], v12 offset:0
    ds_read_b64_tr_b16 a[74:75], v12 offset:18432
    ds_read_b64_tr_b16 a[76:77], v12 offset:32
    ds_read_b64_tr_b16 a[78:79], v12 offset:18464
    ds_read_b64_tr_b16 a[80:81], v12 offset:64
    ds_read_b64_tr_b16 a[82:83], v12 offset:18496
    ds_read_b64_tr_b16 a[84:85], v12 offset:96
    ds_read_b64_tr_b16 a[86:87], v12 offset:18528
    ds_read_b64_tr_b16 a[88:89], v12 offset:512
    ds_read_b64_tr_b16 a[90:91], v12 offset:18944
    ds_read_b64_tr_b16 a[92:93], v12 offset:544
    ds_read_b64_tr_b16 a[94:95], v12 offset:18976
    ds_read_b64_tr_b16 a[96:97], v12 offset:576
    ds_read_b64_tr_b16 a[98:99], v12 offset:19008
    ds_read_b64_tr_b16 a[100:101], v12 offset:608
    ds_read_b64_tr_b16 a[102:103], v12 offset:19040
    ds_read_b64_tr_b16 a[104:105], v12 offset:1024
    ds_read_b64_tr_b16 a[106:107], v12 offset:19456
    ds_read_b64_tr_b16 a[108:109], v12 offset:1056
    ds_read_b64_tr_b16 a[110:111], v12 offset:19488
    ds_read_b64_tr_b16 a[112:113], v12 offset:1088
    ds_read_b64_tr_b16 a[114:115], v12 offset:19520
    ds_read_b64_tr_b16 a[116:117], v12 offset:1120
    ds_read_b64_tr_b16 a[118:119], v12 offset:19552
    v_lshlrev_b32 v13, 4, v1
    v_add_u32 v13, 49152, v13
    s_lshl_b32 s44, s3, 10
    v_add_u32 v14, s44, v13
    v_bfe_u32 v15, v1, 2, 2
    v_cmp_eq_u32 s[52:53], 0, v15
    v_cmp_eq_u32 s[54:55], 1, v15
    v_cmp_eq_u32 s[56:57], 2, v15
    v_cmp_eq_u32 s[58:59], 3, v15
    s_mul_i32 s43, s42, 18
    s_add_u32 s43, s43, s41
    s_lshl_b32 s43, s43, 9
    s_mul_i32 s44, s3, 73728
    s_add_u32 s43, s43, s44
    v_lshlrev_b32 v15, 3, v1
    s_cmp_lg_u32 s3, 0
    s_cbranch_scc1 Ltail_join
    s_mov_b32 s48, 16384
Ltail_pollk:
    buffer_load_dwordx4 v[128:131], v140, s[24:27], 0 offen sc1
    buffer_load_dwordx4 v[132:135], v140, s[24:27], 0 offen offset:1024 sc1
    s_sub_u32 s48, s48, 1
    s_cbranch_scc1 Ltail_gotk
    s_waitcnt vmcnt(0)
    s_waitcnt vmcnt(1)
    v_max_u32 v136, v128, v129
    v_min_u32 v137, v128, v129
    v_med3_u32 v137, v136, v137, v130
    v_max_u32 v136, v136, v130
    v_med3_u32 v137, v136, v137, v131
    v_max_u32 v136, v136, v131
    s_waitcnt vmcnt(0)
    v_med3_u32 v137, v136, v137, v132
    v_max_u32 v136, v136, v132
    v_med3_u32 v137, v136, v137, v133
    v_max_u32 v136, v136, v133
    v_med3_u32 v137, v136, v137, v134
    v_max_u32 v136, v136, v134
    v_med3_u32 v137, v136, v137, v135
    v_max_u32 v136, v136, v135
    v_cmp_eq_u32 vcc, -1, v136
    s_cbranch_vccnz Ltail_pollk
Ltail_gotk:
    s_waitcnt vmcnt(0)
    v_mov_b32_dpp v138, v136 row_ror:1 row_mask:0xf bank_mask:0xf
    v_mov_b32_dpp v139, v137 row_ror:1 row_mask:0xf bank_mask:0xf
    v_min_u32 v142, v136, v138
    v_max_u32 v136, v136, v138
    v_max3_u32 v137, v142, v137, v139
    s_nop 0
    v_mov_b32_dpp v138, v136 row_ror:2 row_mask:0xf bank_mask:0xf
    v_mov_b32_dpp v139, v137 row_ror:2 row_mask:0xf bank_mask:0xf
    v_min_u32 v142, v136, v138
    v_max_u32 v136, v136, v138
    v_max3_u32 v137, v142, v137, v139
    s_nop 0
    v_mov_b32_dpp v138, v136 row_ror:4 row_mask:0xf bank_mask:0xf
    v_mov_b32_dpp v139, v137 row_ror:4 row_mask:0xf bank_mask:0xf
    v_min_u32 v142, v136, v138
    v_max_u32 v136, v136, v138
    v_max3_u32 v137, v142, v137, v139
    s_nop 0
    v_mov_b32_dpp v138, v136 row_ror:8 row_mask:0xf bank_mask:0xf
    v_mov_b32_dpp v139, v137 row_ror:8 row_mask:0xf bank_mask:0xf
    v_min_u32 v142, v136, v138
    v_max_u32 v136, v136, v138
    v_max3_u32 v137, v142, v137, v139
    v_mov_b32 v138, v136
    v_mov_b32 v139, v137
    s_nop 0
    v_permlane16_swap_b32 v136, v138
    v_permlane16_swap_b32 v137, v139
    v_min_u32 v142, v136, v138
    v_max_u32 v136, v136, v138
    v_max3_u32 v137, v142, v137, v139
    v_mov_b32 v138, v136
    v_mov_b32 v139, v137
    s_nop 0
    v_permlane32_swap_b32 v136, v138
    v_permlane32_swap_b32 v137, v139
    v_min_u32 v142, v136, v138
    v_max_u32 v136, v136, v138
    v_max3_u32 v137, v142, v137, v139
    ds_write_b64 v141, v[136:137] offset:64
    s_cmp_eq_u32 s2, 0
    s_cselect_b32 s45, 24576, -4
    s_add_u32 s36, s94, 1
    v_mov_b32 v138, s36
    buffer_store_dword v138, v8, s[24:27], s45 offen
Ltail_join:
    s_waitcnt lgkmcnt(0)
    s_barrier
    v_mov_b32 v8, 53312
    ds_read_b64 v[8:9], v8
    s_waitcnt lgkmcnt(0)
    v_readfirstlane_b32 s92, v8
    v_readfirstlane_b32 s93, v9
    s_andn2_b32 s46, 0x7ff, s92
    s_andn2_b32 s47, 0x7ff, s93
    s_cmp_ge_u32 s41, 18
    s_cbranch_scc1 Ltail_noffn
    s_mul_i32 s44, s46, 1152
    s_mul_i32 s45, s47, 1152
    s_sub_u32 s45, s45, s44
    v_and_b32 v8, 1, v1
    v_mul_lo_u32 v8, v8, s45
    v_and_b32 v9, 48, v1
    v_add3_u32 v8, v8, v9, s44
    s_mov_b32 s45, 2621440
    s_mov_b32 s48, 16384
Ltail_pollh:
    buffer_load_dwordx4 a[120:123], v8, s[24:27], s45 offen offset:0 sc1
    buffer_load_dwordx4 a[124:127], v8, s[24:27], s45 offen offset:64 sc1
    buffer_load_dwordx4 a[128:131], v8, s[24:27], s45 offen offset:128 sc1
    buffer_load_dwordx4 a[132:135], v8, s[24:27], s45 offen offset:192 sc1
    buffer_load_dwordx4 a[136:139], v8, s[24:27], s45 offen offset:256 sc1
    buffer_load_dwordx4 a[140:143], v8, s[24:27], s45 offen offset:320 sc1
    buffer_load_dwordx4 a[144:147], v8, s[24:27], s45 offen offset:384 sc1
    buffer_load_dwordx4 a[148:151], v8, s[24:27], s45 offen offset:448 sc1
    buffer_load_dwordx4 a[152:155], v8, s[24:27], s45 offen offset:512 sc1
    buffer_load_dwordx4 a[156:159], v8, s[24:27], s45 offen offset:576 sc1
    buffer_load_dwordx4 a[160:163], v8, s[24:27], s45 offen offset:640 sc1
    buffer_load_dwordx4 a[164:167], v8, s[24:27], s45 offen offset:704 sc1
    buffer_load_dwordx4 a[168:171], v8, s[24:27], s45 offen offset:768 sc1
    buffer_load_dwordx4 a[172:175], v8, s[24:27], s45 offen offset:832 sc1
    buffer_load_dwordx4 a[176:179], v8, s[24:27], s45 offen offset:896 sc1
    buffer_load_dwordx4 a[180:183], v8, s[24:27], s45 offen offset:960 sc1
    buffer_load_dwordx4 a[184:187], v8, s[24:27], s45 offen offset:1024 sc1
    buffer_load_dwordx4 a[188:191], v8, s[24:27], s45 offen offset:1088 sc1
    s_waitcnt vmcnt(17)
    v_mfma_f32_16x16x32_bf16 v[16:19], a[0:3], a[120:123], 0
    s_waitcnt vmcnt(16)
    v_mfma_f32_16x16x32_bf16 v[20:23], a[4:7], a[124:127], 0
    s_waitcnt vmcnt(15)
    v_mfma_f32_16x16x32_bf16 v[16:19], a[8:11], a[128:131], v[16:19]
    s_waitcnt vmcnt(14)
    v_mfma_f32_16x16x32_bf16 v[20:23], a[12:15], a[132:135], v[20:23]
    s_waitcnt vmcnt(13)
    v_mfma_f32_16x16x32_bf16 v[16:19], a[16:19], a[136:139], v[16:19]
    s_waitcnt vmcnt(12)
    v_mfma_f32_16x16x32_bf16 v[20:23], a[20:23], a[140:143], v[20:23]
    s_waitcnt vmcnt(11)
    v_mfma_f32_16x16x32_bf16 v[16:19], a[24:27], a[144:147], v[16:19]
    s_waitcnt vmcnt(10)
    v_mfma_f32_16x16x32_bf16 v[20:23], a[28:31], a[148:151], v[20:23]
    s_waitcnt vmcnt(9)
    v_mfma_f32_16x16x32_bf16 v[16:19], a[32:35], a[152:155], v[16:19]
    s_waitcnt vmcnt(8)
    v_mfma_f32_16x16x32_bf16 v[20:23], a[36:39], a[156:159], v[20:23]
    s_waitcnt vmcnt(7)
    v_mfma_f32_16x16x32_bf16 v[16:19], a[40:43], a[160:163], v[16:19]
    s_waitcnt vmcnt(6)
    v_mfma_f32_16x16x32_bf16 v[20:23], a[44:47], a[164:167], v[20:23]
    s_waitcnt vmcnt(5)
    v_mfma_f32_16x16x32_bf16 v[16:19], a[48:51], a[168:171], v[16:19]
    s_waitcnt vmcnt(4)
    v_mfma_f32_16x16x32_bf16 v[20:23], a[52:55], a[172:175], v[20:23]
    s_waitcnt vmcnt(3)
    v_mfma_f32_16x16x32_bf16 v[16:19], a[56:59], a[176:179], v[16:19]
    s_waitcnt vmcnt(2)
    v_mfma_f32_16x16x32_bf16 v[20:23], a[60:63], a[180:183], v[20:23]
    s_waitcnt vmcnt(1)
    v_mfma_f32_16x16x32_bf16 v[16:19], a[64:67], a[184:187], v[16:19]
    s_waitcnt vmcnt(0)
    v_mfma_f32_16x16x32_bf16 v[20:23], a[68:71], a[188:191], v[20:23]
    s_sub_u32 s48, s48, 1
    s_nop 6
    v_pk_add_f32 v[16:17], v[16:17], v[20:21]
    v_pk_add_f32 v[18:19], v[18:19], v[22:23]
    s_cbranch_scc1 Ltail_goth
    v_cmp_u_f32 vcc, v16, v16
    s_cbranch_vccnz Ltail_pollh
Ltail_goth:
    ds_write_b128 v14, v[16:19]
    s_waitcnt lgkmcnt(0)
    s_barrier
    ds_read_b128 v[16:19], v13 offset:0
    ds_read_b128 v[20:23], v13 offset:1024
    ds_read_b128 v[24:27], v13 offset:2048
    ds_read_b128 v[28:31], v13 offset:3072
    s_mov_b32 s36, 0xbfb8aa3b
    s_mov_b32 s37, 0xbfb8aa3b
    s_waitcnt lgkmcnt(3)
    v_cvt_pk_bf16_f32 v32, v16, v17
    v_cvt_pk_bf16_f32 v33, v18, v19
    s_waitcnt lgkmcnt(2)
    v_cvt_pk_bf16_f32 v34, v20, v21
    v_cvt_pk_bf16_f32 v35, v22, v23
    v_lshlrev_b32 v16, 16, v32
    v_and_b32 v17, 0xffff0000, v32
    v_lshlrev_b32 v18, 16, v33
    v_and_b32 v19, 0xffff0000, v33
    v_lshlrev_b32 v20, 16, v34
    v_and_b32 v21, 0xffff0000, v34
    v_lshlrev_b32 v22, 16, v35
    v_and_b32 v23, 0xffff0000, v35
    v_pk_mul_f32 v[32:33], v[16:17], s[36:37]
    v_pk_mul_f32 v[34:35], v[18:19], s[36:37]
    v_pk_mul_f32 v[36:37], v[20:21], s[36:37]
    v_pk_mul_f32 v[38:39], v[22:23], s[36:37]
    v_exp_f32 v32, v32
    v_exp_f32 v33, v33
    v_exp_f32 v34, v34
    v_exp_f32 v35, v35
    v_exp_f32 v36, v36
    v_exp_f32 v37, v37
    v_exp_f32 v38, v38
    v_exp_f32 v39, v39
    s_waitcnt lgkmcnt(1)
    v_cvt_pk_bf16_f32 v60, v24, v25
    v_cvt_pk_bf16_f32 v61, v26, v27
    s_waitcnt lgkmcnt(0)
    v_cvt_pk_bf16_f32 v62, v28, v29
    v_cvt_pk_bf16_f32 v63, v30, v31
    v_pk_add_f32 v[32:33], v[32:33], 1.0 op_sel_hi:[1,0]
    v_pk_add_f32 v[34:35], v[34:35], 1.0 op_sel_hi:[1,0]
    v_pk_add_f32 v[36:37], v[36:37], 1.0 op_sel_hi:[1,0]
    v_pk_add_f32 v[38:39], v[38:39], 1.0 op_sel_hi:[1,0]
    v_rcp_f32 v32, v32
    v_rcp_f32 v33, v33
    v_rcp_f32 v34, v34
    v_rcp_f32 v35, v35
    v_rcp_f32 v36, v36
    v_rcp_f32 v37, v37
    v_rcp_f32 v38, v38
    v_rcp_f32 v39, v39
    v_lshlrev_b32 v24, 16, v60
    v_and_b32 v25, 0xffff0000, v60
    v_lshlrev_b32 v26, 16, v61
    v_and_b32 v27, 0xffff0000, v61
    v_lshlrev_b32 v28, 16, v62
    v_and_b32 v29, 0xffff0000, v62
    v_lshlrev_b32 v30, 16, v63
    v_and_b32 v31, 0xffff0000, v63
    v_pk_mul_f32 v[16:17], v[16:17], v[32:33]
    v_pk_mul_f32 v[18:19], v[18:19], v[34:35]
    v_pk_mul_f32 v[20:21], v[20:21], v[36:37]
    v_pk_mul_f32 v[22:23], v[22:23], v[38:39]
    v_cvt_pk_bf16_f32 v32, v16, v17
    v_cvt_pk_bf16_f32 v33, v18, v19
    v_cvt_pk_bf16_f32 v34, v20, v21
    v_cvt_pk_bf16_f32 v35, v22, v23
    v_lshlrev_b32 v16, 16, v32
    v_and_b32 v17, 0xffff0000, v32
    v_lshlrev_b32 v18, 16, v33
    v_and_b32 v19, 0xffff0000, v33
    v_lshlrev_b32 v20, 16, v34
    v_and_b32 v21, 0xffff0000, v34
    v_lshlrev_b32 v22, 16, v35
    v_and_b32 v23, 0xffff0000, v35
    v_pk_mul_f32 v[16:17], v[16:17], v[24:25]
    v_pk_mul_f32 v[18:19], v[18:19], v[26:27]
    v_pk_mul_f32 v[20:21], v[20:21], v[28:29]
    v_pk_mul_f32 v[22:23], v[22:23], v[30:31]
    v_cvt_pk_bf16_f32 v32, v16, v17
    v_cvt_pk_bf16_f32 v33, v18, v19
    v_cvt_pk_bf16_f32 v34, v20, v21
    v_cvt_pk_bf16_f32 v35, v22, v23
    v_cndmask_b32 v64, 0, v32, s[52:53]
    v_cndmask_b32 v65, 0, v33, s[52:53]
    v_cndmask_b32 v66, 0, v34, s[52:53]
    v_cndmask_b32 v67, 0, v35, s[52:53]
    v_cndmask_b32 v68, 0, v32, s[54:55]
    v_cndmask_b32 v69, 0, v33, s[54:55]
    v_cndmask_b32 v70, 0, v34, s[54:55]
    v_cndmask_b32 v71, 0, v35, s[54:55]
    v_cndmask_b32 v72, 0, v32, s[56:57]
    v_cndmask_b32 v73, 0, v33, s[56:57]
    v_cndmask_b32 v74, 0, v34, s[56:57]
    v_cndmask_b32 v75, 0, v35, s[56:57]
    v_cndmask_b32 v76, 0, v32, s[58:59]
    v_cndmask_b32 v77, 0, v33, s[58:59]
    v_cndmask_b32 v78, 0, v34, s[58:59]
    v_cndmask_b32 v79, 0, v35, s[58:59]
    v_mfma_f32_16x16x32_bf16 v[16:19], v[64:67], a[72:75], 0
    v_mfma_f32_16x16x32_bf16 v[16:19], v[68:71], a[76:79], v[16:19]
    v_mfma_f32_16x16x32_bf16 v[16:19], v[72:75], a[80:83], v[16:19]
    v_mfma_f32_16x16x32_bf16 v[16:19], v[76:79], a[84:87], v[16:19]
    v_mfma_f32_16x16x32_bf16 v[20:23], v[64:67], a[88:91], 0
    v_mfma_f32_16x16x32_bf16 v[20:23], v[68:71], a[92:95], v[20:23]
    v_mfma_f32_16x16x32_bf16 v[20:23], v[72:75], a[96:99], v[20:23]
    v_mfma_f32_16x16x32_bf16 v[20:23], v[76:79], a[100:103], v[20:23]
    v_mfma_f32_16x16x32_bf16 v[24:27], v[64:67], a[104:107], 0
    v_mfma_f32_16x16x32_bf16 v[24:27], v[68:71], a[108:111], v[24:27]
    v_mfma_f32_16x16x32_bf16 v[24:27], v[72:75], a[112:115], v[24:27]
    v_mfma_f32_16x16x32_bf16 v[24:27], v[76:79], a[116:119], v[24:27]
    v_min_u32 v16, -2, v16
    v_min_u32 v17, -2, v17
    buffer_store_dwordx2 v[16:17], v15, s[8:11], s43 offen sc1
    s_add_u32 s43, s43, 294912
    v_min_u32 v20, -2, v20
    v_min_u32 v21, -2, v21
    buffer_store_dwordx2 v[20:21], v15, s[8:11], s43 offen sc1
    s_add_u32 s43, s43, 294912
    v_min_u32 v24, -2, v24
    v_min_u32 v25, -2, v25
    buffer_store_dwordx2 v[24:25], v15, s[8:11], s43 offen sc1
    v_cmp_ne_u32 vcc, s46, v7
    v_cmp_ne_u32 s[36:37], s47, v7
    v_mov_b32 v31, 2147483648
    s_and_b64 vcc, vcc, s[36:37]
    s_nop 1
    v_cndmask_b32 v31, v31, v4, vcc
    buffer_store_dwordx2 v[208:209], v31, s[16:19], 0 offen offset:0
    buffer_store_dwordx2 v[210:211], v31, s[16:19], 0 offen offset:32
    buffer_store_dwordx2 v[212:213], v31, s[16:19], 0 offen offset:384
    buffer_store_dwordx2 v[214:215], v31, s[16:19], 0 offen offset:416
    buffer_store_dwordx2 v[216:217], v31, s[16:19], 0 offen offset:768
    buffer_store_dwordx2 v[218:219], v31, s[16:19], 0 offen offset:800
    s_branch Ltail_done
Ltail_noffn:
    s_cmp_lt_u32 s41, 27
    s_cselect_b32 s36, s3, 1
    s_cmp_eq_u32 s36, 0
    s_cbranch_scc1 Ltail_final
    v_cmp_ne_u32 vcc, s46, v7
    v_cmp_ne_u32 s[36:37], s47, v7
    v_mov_b32 v31, 2147483648
    s_and_b64 vcc, vcc, s[36:37]
    s_nop 1
    v_cndmask_b32 v31, v31, v4, vcc
    buffer_store_dwordx2 v[208:209], v31, s[16:19], 0 offen offset:0
    buffer_store_dwordx2 v[210:211], v31, s[16:19], 0 offen offset:32
    buffer_store_dwordx2 v[212:213], v31, s[16:19], 0 offen offset:384
    buffer_store_dwordx2 v[214:215], v31, s[16:19], 0 offen offset:416
    buffer_store_dwordx2 v[216:217], v31, s[16:19], 0 offen offset:768
    buffer_store_dwordx2 v[218:219], v31, s[16:19], 0 offen offset:800
    s_branch Ltail_done
Ltail_final:
    s_mul_i32 s43, s42, 9
    s_add_u32 s43, s43, s41
    s_sub_u32 s43, s43, 18
    v_bfe_u32 v8, v1, 2, 1
    v_cmp_eq_u32 vcc, 1, v8
    v_mov_b32 v9, s46
    v_mov_b32 v10, s47
    v_and_b32 v11, 3, v1
    v_cndmask_b32 v9, v9, v10, vcc
    s_lshr_b32 s44, s43, 2
    s_lshl_b32 s44, s44, 6
    s_and_b32 s45, s43, 1
    s_lshl_b32 s45, s45, 5
    s_add_u32 s44, s44, s45
    s_and_b32 s45, s43, 2
    s_lshl_b32 s45, s45, 2
    s_add_u32 s44, s44, s45
    v_lshrrev_b32 v12, 1, v11
    v_lshl_add_u32 v12, v12, 4, s44
    v_and_b32 v13, 1, v11
    v_lshl_add_u32 v12, v13, 2, v12
    v_mul_u32_u24 v13, 1152, v9
    v_add_u32 v14, v13, v12
    v_add_u32 v15, 2621440, v14
    s_mov_b32 s45, 22144
    buffer_load_dword v18, v12, s[24:27], s45 offen sc1
    v_mov_b32 v19, s92
    v_mov_b32 v10, s93
    v_cndmask_b32 v19, v19, v10, vcc
    v_and_b32 v19, 0xfffff800, v19
    v_or_b32 v19, 0x400, v19
    v_ashrrev_i32 v10, 31, v19
    v_not_b32 v10, v10
    v_or_b32 v10, 0x80000000, v10
    v_xor_b32 v19, v19, v10
    s_lshl_b32 s45, s43, 4
    v_lshl_add_u32 v13, v11, 2, v13
    v_add_u32 v13, s45, v13
    v_lshrrev_b32 v14, 2, v1
    v_lshlrev_b32 v14, 9, v14
    v_lshl_add_u32 v14, v11, 4, v14
    s_lshr_b32 s44, s43, 3
    s_mul_i32 s44, s44, 73728
    s_and_b32 s45, s43, 7
    s_lshl_b32 s45, s45, 6
    s_add_u32 s44, s44, s45
    v_cmp_ne_u32 vcc, s46, v7
    v_cmp_ne_u32 s[36:37], s47, v7
    v_mov_b32 v31, 2147483648
    s_and_b64 vcc, vcc, s[36:37]
    s_nop 1
    v_cndmask_b32 v31, v31, v4, vcc
    buffer_store_dwordx2 v[208:209], v31, s[16:19], 0 offen offset:0
    buffer_store_dwordx2 v[210:211], v31, s[16:19], 0 offen offset:32
    buffer_store_dwordx2 v[212:213], v31, s[16:19], 0 offen offset:384
    buffer_store_dwordx2 v[214:215], v31, s[16:19], 0 offen offset:416
    buffer_store_dwordx2 v[216:217], v31, s[16:19], 0 offen offset:768
    buffer_store_dwordx2 v[218:219], v31, s[16:19], 0 offen offset:800
    v_cmp_eq_u32 s[36:37], 1, v8
    v_cvt_pk_bf16_f32 v19, v19, v19
    v_and_b32 v19, 0xffff0000, v19
    v_mul_f32 v19, 0xbfb8aa3b, v19
    v_exp_f32 v19, v19
    s_waitcnt vmcnt(6)
    v_lshlrev_b32 v24, 16, v18
    v_and_b32 v25, 0xffff0000, v18
    v_add_f32 v19, 1.0, v19
    v_rcp_f32 v19, v19
    s_mov_b32 s48, 16384
    v_cvt_pk_bf16_f32 v19, v19, v19
    v_and_b32 v19, 0xffff0000, v19
Ltail_polly:
    s_add_u32 s45, s44, 0
    buffer_load_dwordx4 v[64:67], v14, s[8:11], s45 offen sc1
    s_add_u32 s45, s44, 8192
    buffer_load_dwordx4 v[68:71], v14, s[8:11], s45 offen sc1
    s_add_u32 s45, s44, 16384
    buffer_load_dwordx4 v[72:75], v14, s[8:11], s45 offen sc1
    s_add_u32 s45, s44, 24576
    buffer_load_dwordx4 v[76:79], v14, s[8:11], s45 offen sc1
    s_add_u32 s45, s44, 32768
    buffer_load_dwordx4 v[80:83], v14, s[8:11], s45 offen sc1
    s_add_u32 s45, s44, 40960
    buffer_load_dwordx4 v[84:87], v14, s[8:11], s45 offen sc1
    s_add_u32 s45, s44, 49152
    buffer_load_dwordx4 v[88:91], v14, s[8:11], s45 offen sc1
    s_add_u32 s45, s44, 57344
    buffer_load_dwordx4 v[92:95], v14, s[8:11], s45 offen sc1
    s_add_u32 s45, s44, 65536
    buffer_load_dwordx4 v[96:99], v14, s[8:11], s45 offen sc1
    s_mov_b32 s45, 2621440
    buffer_load_dword v16, v15, s[24:27], s45 offen sc1
    buffer_load_dword v17, v15, s[24:27], 0 offen sc1
    s_sub_u32 s48, s48, 1
    s_cbranch_scc1 Ltail_goty
    s_waitcnt vmcnt(10)
    v_max3_u32 v26, v64, v65, v66
    s_waitcnt vmcnt(9)
    v_max3_u32 v26, v26, v67, v68
    v_max3_u32 v26, v26, v69, v70
    s_waitcnt vmcnt(8)
    v_max3_u32 v26, v26, v71, v72
    v_max3_u32 v26, v26, v73, v74
    s_waitcnt vmcnt(7)
    v_max3_u32 v26, v26, v75, v76
    v_max3_u32 v26, v26, v77, v78
    s_waitcnt vmcnt(6)
    v_max3_u32 v26, v26, v79, v80
    v_max3_u32 v26, v26, v81, v82
    s_waitcnt vmcnt(5)
    v_max3_u32 v26, v26, v83, v84
    v_max3_u32 v26, v26, v85, v86
    s_waitcnt vmcnt(4)
    v_max3_u32 v26, v26, v87, v88
    v_max3_u32 v26, v26, v89, v90
    s_waitcnt vmcnt(3)
    v_max3_u32 v26, v26, v91, v92
    v_max3_u32 v26, v26, v93, v94
    s_waitcnt vmcnt(2)
    v_max3_u32 v26, v26, v95, v96
    v_max3_u32 v26, v26, v97, v98
    v_max_u32 v26, v26, v99
    s_waitcnt vmcnt(0)
    v_max3_u32 v26, v26, v16, v17
    v_cmp_eq_u32 vcc, -1, v26
    s_cbranch_vccnz Ltail_polly
Ltail_goty:
    s_waitcnt vmcnt(0) lgkmcnt(0)
    v_lshlrev_b32 v20, 16, v16
    v_and_b32 v21, 0xffff0000, v16
    v_lshlrev_b32 v22, 16, v17
    v_and_b32 v23, 0xffff0000, v17
    v_pk_add_f32 v[64:65], v[64:65], v[68:69]
    v_pk_add_f32 v[66:67], v[66:67], v[70:71]
    v_pk_add_f32 v[64:65], v[64:65], v[72:73]
    v_pk_add_f32 v[66:67], v[66:67], v[74:75]
    v_pk_add_f32 v[64:65], v[64:65], v[76:77]
    v_pk_add_f32 v[66:67], v[66:67], v[78:79]
    v_pk_add_f32 v[64:65], v[64:65], v[80:81]
    v_pk_add_f32 v[66:67], v[66:67], v[82:83]
    v_pk_add_f32 v[64:65], v[64:65], v[84:85]
    v_pk_add_f32 v[66:67], v[66:67], v[86:87]
    v_pk_add_f32 v[64:65], v[64:65], v[88:89]
    v_pk_add_f32 v[66:67], v[66:67], v[90:91]
    v_pk_add_f32 v[64:65], v[64:65], v[92:93]
    v_pk_add_f32 v[66:67], v[66:67], v[94:95]
    v_pk_add_f32 v[64:65], v[64:65], v[96:97]
    v_pk_add_f32 v[66:67], v[66:67], v[98:99]
    s_nop 0
    v_add_f32_dpp v64, v64, v64 row_ror:4 row_mask:0xf bank_mask:0xf
    v_add_f32_dpp v65, v65, v65 row_ror:4 row_mask:0xf bank_mask:0xf
    v_add_f32_dpp v66, v66, v66 row_ror:4 row_mask:0xf bank_mask:0xf
    v_add_f32_dpp v67, v67, v67 row_ror:4 row_mask:0xf bank_mask:0xf
    v_add_f32_dpp v64, v64, v64 row_ror:8 row_mask:0xf bank_mask:0xf
    v_add_f32_dpp v65, v65, v65 row_ror:8 row_mask:0xf bank_mask:0xf
    v_add_f32_dpp v66, v66, v66 row_ror:8 row_mask:0xf bank_mask:0xf
    v_add_f32_dpp v67, v67, v67 row_ror:8 row_mask:0xf bank_mask:0xf
    v_mov_b32 v68, v64
    v_mov_b32 v69, v65
    v_mov_b32 v70, v66
    v_mov_b32 v71, v67
    v_permlane16_swap_b32 v64, v68
    v_permlane16_swap_b32 v65, v69
    v_permlane16_swap_b32 v66, v70
    v_permlane16_swap_b32 v67, v71
    v_add_f32 v64, v64, v68
    v_add_f32 v65, v65, v69
    v_add_f32 v66, v66, v70
    v_add_f32 v67, v67, v71
    v_mov_b32 v68, v64
    v_mov_b32 v69, v65
    v_mov_b32 v70, v66
    v_mov_b32 v71, v67
    v_permlane32_swap_b32 v64, v68
    v_permlane32_swap_b32 v65, v69
    v_permlane32_swap_b32 v66, v70
    v_permlane32_swap_b32 v67, v71
    v_add_f32 v64, v64, v68
    v_add_f32 v65, v65, v69
    v_add_f32 v66, v66, v70
    v_add_f32 v67, v67, v71
    v_cndmask_b32 v26, v64, v65, s[36:37]
    v_cndmask_b32 v27, v66, v67, s[36:37]
    v_cvt_pk_bf16_f32 v28, v26, v27
    v_lshlrev_b32 v26, 16, v28
    v_and_b32 v27, 0xffff0000, v28
    v_mul_f32 v26, v26, v19
    v_mul_f32 v27, v27, v19
    v_cvt_pk_bf16_f32 v28, v26, v27
    v_lshlrev_b32 v26, 16, v28
    v_and_b32 v27, 0xffff0000, v28
    v_pk_add_f32 v[26:27], v[26:27], v[22:23]
    v_cvt_pk_bf16_f32 v28, v26, v27
    v_lshlrev_b32 v26, 16, v28
    v_and_b32 v27, 0xffff0000, v28
    v_pk_mul_f32 v[26:27], v[26:27], v[24:25]
    v_cvt_pk_bf16_f32 v28, v26, v27
    v_lshlrev_b32 v26, 16, v28
    v_and_b32 v27, 0xffff0000, v28
    v_pk_add_f32 v[26:27], v[26:27], v[20:21]
    v_cvt_pk_bf16_f32 v28, v26, v27
    s_mov_b64 exec, 0xff
    buffer_store_dword v28, v13, s[16:19], 0 offen
Ltail_done:
    s_endpgm
Ltail_spin1:
    s_mov_b32 s48, 16384
Ltail_spinl1:
    buffer_load_dword v11, v9, s[24:27], s93 offen sc1
    s_waitcnt vmcnt(0)
    v_cmp_ne_u32 s[54:55], 0, v11
    s_sub_u32 s48, s48, 1
    s_cbranch_scc1 Ltail_got1
    s_cmp_lg_u64 s[54:55], 0
    s_cbranch_scc1 Ltail_spinl1
    s_branch Ltail_got1
Ltail_spin2:
    s_mov_b32 s48, 16384
Ltail_spinl2:
    buffer_load_dword v11, v9, s[24:27], s93 offen sc1
    s_waitcnt vmcnt(0)
    v_cmp_ne_u32 s[54:55], 0, v11
    s_sub_u32 s48, s48, 1
    s_cbranch_scc1 Ltail_got2
    s_cmp_lg_u64 s[54:55], 0
    s_cbranch_scc1 Ltail_spinl2
    s_branch Ltail_got2
Lattn_redo:
    s_waitcnt vmcnt(0) lgkmcnt(0)
    s_barrier
    v_mov_b32 v232, 0xff800000
    v_mov_b32 v233, 0xff800000
    v_mov_b32 v234, 0xff800000
    v_mov_b32 v235, 0xff800000
    s_mov_b32 s40, 0
    s_mov_b32 s48, -1
Lattn_redo_loop:
    s_add_u32 m0, s42, 0
    s_nop 0
    buffer_load_dwordx4 v36, s[8:11], s40 offen lds
    buffer_load_dwordx4 v37, s[8:11], s40 offen offset:1024 lds
    buffer_load_dwordx4 v38, s[8:11], s40 offen offset:2048 lds
    buffer_load_dwordx4 v39, s[8:11], s40 offen offset:3072 lds
    s_add_u32 s40, s40, 16384
    s_waitcnt vmcnt(0) lgkmcnt(0)
    s_barrier
    ds_read_b128 a[208:211], v8 offset:0
    ds_read_b128 a[212:215], v9 offset:0
    ds_read_b128 a[216:219], v10 offset:0
    ds_read_b128 a[220:223], v11 offset:0
    s_waitcnt lgkmcnt(3)
    v_mfma_f32_16x16x32_bf16 v[216:219], a[208:211], v[64:67], 0
    s_waitcnt lgkmcnt(2)
    v_mfma_f32_16x16x32_bf16 v[216:219], a[212:215], v[68:71], v[216:219]
    s_waitcnt lgkmcnt(1)
    v_mfma_f32_16x16x32_bf16 v[216:219], a[216:219], v[72:75], v[216:219]
    s_waitcnt lgkmcnt(0)
    v_mfma_f32_16x16x32_bf16 v[216:219], a[220:223], v[76:79], v[216:219]
    v_mfma_f32_16x16x32_bf16 v[220:223], a[208:211], v[80:83], 0
    v_mfma_f32_16x16x32_bf16 v[220:223], a[212:215], v[84:87], v[220:223]
    v_mfma_f32_16x16x32_bf16 v[220:223], a[216:219], v[88:91], v[220:223]
    v_mfma_f32_16x16x32_bf16 v[220:223], a[220:223], v[92:95], v[220:223]
    v_mfma_f32_16x16x32_bf16 v[224:227], a[208:211], v[96:99], 0
    v_mfma_f32_16x16x32_bf16 v[224:227], a[212:215], v[100:103], v[224:227]
    v_mfma_f32_16x16x32_bf16 v[224:227], a[216:219], v[104:107], v[224:227]
    v_mfma_f32_16x16x32_bf16 v[224:227], a[220:223], v[108:111], v[224:227]
    v_mfma_f32_16x16x32_bf16 v[228:231], a[208:211], v[112:115], 0
    v_mfma_f32_16x16x32_bf16 v[228:231], a[212:215], v[116:119], v[228:231]
    v_mfma_f32_16x16x32_bf16 v[228:231], a[216:219], v[120:123], v[228:231]
    v_mfma_f32_16x16x32_bf16 v[228:231], a[220:223], v[124:127], v[228:231]
    v_max3_f32 v232, v232, v216, v217
    v_max3_f32 v232, v232, v218, v219
    v_max3_f32 v233, v233, v220, v221
    v_max3_f32 v233, v233, v222, v223
    v_max3_f32 v234, v234, v224, v225
    v_max3_f32 v234, v234, v226, v227
    s_nop 1
    v_max3_f32 v235, v235, v228, v229
    v_max3_f32 v235, v235, v230, v231
    ds_read_b128 a[224:227], v8 offset:4096
    ds_read_b128 a[228:231], v9 offset:4096
    ds_read_b128 a[232:235], v10 offset:4096
    ds_read_b128 a[236:239], v11 offset:4096
    s_waitcnt lgkmcnt(3)
    v_mfma_f32_16x16x32_bf16 v[216:219], a[224:227], v[64:67], 0
    s_waitcnt lgkmcnt(2)
    v_mfma_f32_16x16x32_bf16 v[216:219], a[228:231], v[68:71], v[216:219]
    s_waitcnt lgkmcnt(1)
    v_mfma_f32_16x16x32_bf16 v[216:219], a[232:235], v[72:75], v[216:219]
    s_waitcnt lgkmcnt(0)
    v_mfma_f32_16x16x32_bf16 v[216:219], a[236:239], v[76:79], v[216:219]
    v_mfma_f32_16x16x32_bf16 v[220:223], a[224:227], v[80:83], 0
    v_mfma_f32_16x16x32_bf16 v[220:223], a[228:231], v[84:87], v[220:223]
    v_mfma_f32_16x16x32_bf16 v[220:223], a[232:235], v[88:91], v[220:223]
    v_mfma_f32_16x16x32_bf16 v[220:223], a[236:239], v[92:95], v[220:223]
    v_mfma_f32_16x16x32_bf16 v[224:227], a[224:227], v[96:99], 0
    v_mfma_f32_16x16x32_bf16 v[224:227], a[228:231], v[100:103], v[224:227]
    v_mfma_f32_16x16x32_bf16 v[224:227], a[232:235], v[104:107], v[224:227]
    v_mfma_f32_16x16x32_bf16 v[224:227], a[236:239], v[108:111], v[224:227]
    v_mfma_f32_16x16x32_bf16 v[228:231], a[224:227], v[112:115], 0
    v_mfma_f32_16x16x32_bf16 v[228:231], a[228:231], v[116:119], v[228:231]
    v_mfma_f32_16x16x32_bf16 v[228:231], a[232:235], v[120:123], v[228:231]
    v_mfma_f32_16x16x32_bf16 v[228:231], a[236:239], v[124:127], v[228:231]
    v_max3_f32 v232, v232, v216, v217
    v_max3_f32 v232, v232, v218, v219
    v_max3_f32 v233, v233, v220, v221
    v_max3_f32 v233, v233, v222, v223
    v_max3_f32 v234, v234, v224, v225
    v_max3_f32 v234, v234, v226, v227
    s_nop 1
    v_max3_f32 v235, v235, v228, v229
    v_max3_f32 v235, v235, v230, v231
    ds_read_b128 a[208:211], v8 offset:8192
    ds_read_b128 a[212:215], v9 offset:8192
    ds_read_b128 a[216:219], v10 offset:8192
    ds_read_b128 a[220:223], v11 offset:8192
    s_waitcnt lgkmcnt(3)
    v_mfma_f32_16x16x32_bf16 v[216:219], a[208:211], v[64:67], 0
    s_waitcnt lgkmcnt(2)
    v_mfma_f32_16x16x32_bf16 v[216:219], a[212:215], v[68:71], v[216:219]
    s_waitcnt lgkmcnt(1)
    v_mfma_f32_16x16x32_bf16 v[216:219], a[216:219], v[72:75], v[216:219]
    s_waitcnt lgkmcnt(0)
    v_mfma_f32_16x16x32_bf16 v[216:219], a[220:223], v[76:79], v[216:219]
    v_mfma_f32_16x16x32_bf16 v[220:223], a[208:211], v[80:83], 0
    v_mfma_f32_16x16x32_bf16 v[220:223], a[212:215], v[84:87], v[220:223]
    v_mfma_f32_16x16x32_bf16 v[220:223], a[216:219], v[88:91], v[220:223]
    v_mfma_f32_16x16x32_bf16 v[220:223], a[220:223], v[92:95], v[220:223]
    v_mfma_f32_16x16x32_bf16 v[224:227], a[208:211], v[96:99], 0
    v_mfma_f32_16x16x32_bf16 v[224:227], a[212:215], v[100:103], v[224:227]
    v_mfma_f32_16x16x32_bf16 v[224:227], a[216:219], v[104:107], v[224:227]
    v_mfma_f32_16x16x32_bf16 v[224:227], a[220:223], v[108:111], v[224:227]
    v_mfma_f32_16x16x32_bf16 v[228:231], a[208:211], v[112:115], 0
    v_mfma_f32_16x16x32_bf16 v[228:231], a[212:215], v[116:119], v[228:231]
    v_mfma_f32_16x16x32_bf16 v[228:231], a[216:219], v[120:123], v[228:231]
    v_mfma_f32_16x16x32_bf16 v[228:231], a[220:223], v[124:127], v[228:231]
    v_max3_f32 v232, v232, v216, v217
    v_max3_f32 v232, v232, v218, v219
    v_max3_f32 v233, v233, v220, v221
    v_max3_f32 v233, v233, v222, v223
    v_max3_f32 v234, v234, v224, v225
    v_max3_f32 v234, v234, v226, v227
    s_nop 1
    v_max3_f32 v235, v235, v228, v229
    v_max3_f32 v235, v235, v230, v231
    ds_read_b128 a[224:227], v8 offset:12288
    ds_read_b128 a[228:231], v9 offset:12288
    ds_read_b128 a[232:235], v10 offset:12288
    ds_read_b128 a[236:239], v11 offset:12288
    s_waitcnt lgkmcnt(3)
    v_mfma_f32_16x16x32_bf16 v[216:219], a[224:227], v[64:67], 0
    s_waitcnt lgkmcnt(2)
    v_mfma_f32_16x16x32_bf16 v[216:219], a[228:231], v[68:71], v[216:219]
    s_waitcnt lgkmcnt(1)
    v_mfma_f32_16x16x32_bf16 v[216:219], a[232:235], v[72:75], v[216:219]
    s_waitcnt lgkmcnt(0)
    v_mfma_f32_16x16x32_bf16 v[216:219], a[236:239], v[76:79], v[216:219]
    v_mfma_f32_16x16x32_bf16 v[220:223], a[224:227], v[80:83], 0
    v_mfma_f32_16x16x32_bf16 v[220:223], a[228:231], v[84:87], v[220:223]
    v_mfma_f32_16x16x32_bf16 v[220:223], a[232:235], v[88:91], v[220:223]
    v_mfma_f32_16x16x32_bf16 v[220:223], a[236:239], v[92:95], v[220:223]
    v_mfma_f32_16x16x32_bf16 v[224:227], a[224:227], v[96:99], 0
    v_mfma_f32_16x16x32_bf16 v[224:227], a[228:231], v[100:103], v[224:227]
    v_mfma_f32_16x16x32_bf16 v[224:227], a[232:235], v[104:107], v[224:227]
    v_mfma_f32_16x16x32_bf16 v[224:227], a[236:239], v[108:111], v[224:227]
    v_mfma_f32_16x16x32_bf16 v[228:231], a[224:227], v[112:115], 0
    v_mfma_f32_16x16x32_bf16 v[228:231], a[228:231], v[116:119], v[228:231]
    v_mfma_f32_16x16x32_bf16 v[228:231], a[232:235], v[120:123], v[228:231]
    v_mfma_f32_16x16x32_bf16 v[228:231], a[236:239], v[124:127], v[228:231]
    v_max3_f32 v232, v232, v216, v217
    v_max3_f32 v232, v232, v218, v219
    v_max3_f32 v233, v233, v220, v221
    v_max3_f32 v233, v233, v222, v223
    v_max3_f32 v234, v234, v224, v225
    v_max3_f32 v234, v234, v226, v227
    s_nop 1
    v_max3_f32 v235, v235, v228, v229
    v_max3_f32 v235, v235, v230, v231
    s_barrier
    s_cmp_lt_u32 s40, 524288
    s_cbranch_scc1 Lattn_redo_loop
    v_mov_b32 v236, v232
    v_mov_b32 v237, v233
    v_mov_b32 v238, v234
    v_mov_b32 v239, v235
    v_permlane16_swap_b32 v232, v236
    v_permlane16_swap_b32 v233, v237
    v_permlane16_swap_b32 v234, v238
    v_permlane16_swap_b32 v235, v239
    v_max_f32 v232, v232, v236
    v_max_f32 v233, v233, v237
    v_max_f32 v234, v234, v238
    v_max_f32 v235, v235, v239
    v_mov_b32 v236, v232
    v_mov_b32 v237, v233
    v_mov_b32 v238, v234
    v_mov_b32 v239, v235
    v_permlane32_swap_b32 v232, v236
    v_permlane32_swap_b32 v233, v237
    v_permlane32_swap_b32 v234, v238
    v_permlane32_swap_b32 v235, v239
    v_max_f32 v232, v232, v236
    v_max_f32 v233, v233, v237
    v_max_f32 v234, v234, v238
    v_max_f32 v235, v235, v239
    v_sub_f32 v192, 0, v232
    v_sub_f32 v193, 0, v232
    v_sub_f32 v194, 0, v232
    v_sub_f32 v195, 0, v232
    v_sub_f32 v196, 0, v233
    v_sub_f32 v197, 0, v233
    v_sub_f32 v198, 0, v233
    v_sub_f32 v199, 0, v233
    v_sub_f32 v200, 0, v234
    v_sub_f32 v201, 0, v234
    v_sub_f32 v202, 0, v234
    v_sub_f32 v203, 0, v234
    v_sub_f32 v204, 0, v235
    v_sub_f32 v205, 0, v235
    v_sub_f32 v206, 0, v235
    v_sub_f32 v207, 0, v235
    s_mov_b32 s40, 0
    s_mov_b32 s41, 0
    s_add_u32 m0, s42, 0
    s_nop 0
    buffer_load_dwordx4 v36, s[8:11], s40 offen lds
    buffer_load_dwordx4 v37, s[8:11], s40 offen offset:1024 lds
    buffer_load_dwordx4 v38, s[8:11], s40 offen offset:2048 lds
    buffer_load_dwordx4 v39, s[8:11], s40 offen offset:3072 lds
    s_add_u32 s40, s40, 16384
    s_add_u32 m0, s42, 16384
    s_nop 0
    buffer_load_dwordx4 v36, s[8:11], s40 offen lds
    buffer_load_dwordx4 v37, s[8:11], s40 offen offset:1024 lds
    buffer_load_dwordx4 v38, s[8:11], s40 offen offset:2048 lds
    buffer_load_dwordx4 v39, s[8:11], s40 offen offset:3072 lds
    s_add_u32 s40, s40, 16384
    s_add_u32 m0, s42, 32768
    s_nop 0
    buffer_load_dwordx4 v36, s[8:11], s40 offen lds
    buffer_load_dwordx4 v37, s[8:11], s40 offen offset:1024 lds
    buffer_load_dwordx4 v38, s[8:11], s40 offen offset:2048 lds
    buffer_load_dwordx4 v39, s[8:11], s40 offen offset:3072 lds
    s_add_u32 s40, s40, 16384
    s_add_u32 m0, s42, 65536
    s_nop 0
    buffer_load_dwordx4 v40, s[12:15], s41 offen lds
    buffer_load_dwordx4 v41, s[12:15], s41 offen offset:1024 lds
    buffer_load_dwordx4 v40, s[12:15], s41 offen offset:2048 lds
    buffer_load_dwordx4 v41, s[12:15], s41 offen offset:3072 lds
    s_add_u32 s41, s41, 16384
    s_add_u32 m0, s42, 81920
    s_nop 0
    buffer_load_dwordx4 v40, s[12:15], s41 offen lds
    buffer_load_dwordx4 v41, s[12:15], s41 offen offset:1024 lds
    buffer_load_dwordx4 v40, s[12:15], s41 offen offset:2048 lds
    buffer_load_dwordx4 v41, s[12:15], s41 offen offset:3072 lds
    s_add_u32 s41, s41, 16384
    v_accvgpr_write_b32 a0, 0
    v_accvgpr_write_b32 a1, 0
    v_accvgpr_write_b32 a2, 0
    v_accvgpr_write_b32 a3, 0
    v_accvgpr_write_b32 a4, 0
    v_accvgpr_write_b32 a5, 0
    v_accvgpr_write_b32 a6, 0
    v_accvgpr_write_b32 a7, 0
    v_accvgpr_write_b32 a8, 0
    v_accvgpr_write_b32 a9, 0
    v_accvgpr_write_b32 a10, 0
    v_accvgpr_write_b32 a11, 0
    v_accvgpr_write_b32 a12, 0
    v_accvgpr_write_b32 a13, 0
    v_accvgpr_write_b32 a14, 0
    v_accvgpr_write_b32 a15, 0
    v_accvgpr_write_b32 a16, 0
    v_accvgpr_write_b32 a17, 0
    v_accvgpr_write_b32 a18, 0
    v_accvgpr_write_b32 a19, 0
    v_accvgpr_write_b32 a20, 0
    v_accvgpr_write_b32 a21, 0
    v_accvgpr_write_b32 a22, 0
    v_accvgpr_write_b32 a23, 0
    v_accvgpr_write_b32 a24, 0
    v_accvgpr_write_b32 a25, 0
    v_accvgpr_write_b32 a26, 0
    v_accvgpr_write_b32 a27, 0
    v_accvgpr_write_b32 a28, 0
    v_accvgpr_write_b32 a29, 0
    v_accvgpr_write_b32 a30, 0
    v_accvgpr_write_b32 a31, 0
    v_accvgpr_write_b32 a32, 0
    v_accvgpr_write_b32 a33, 0
    v_accvgpr_write_b32 a34, 0
    v_accvgpr_write_b32 a35, 0
    v_accvgpr_write_b32 a36, 0
    v_accvgpr_write_b32 a37, 0
    v_accvgpr_write_b32 a38, 0
    v_accvgpr_write_b32 a39, 0
    v_accvgpr_write_b32 a40, 0
    v_accvgpr_write_b32 a41, 0
    v_accvgpr_write_b32 a42, 0
    v_accvgpr_write_b32 a43, 0
    v_accvgpr_write_b32 a44, 0
    v_accvgpr_write_b32 a45, 0
    v_accvgpr_write_b32 a46, 0
    v_accvgpr_write_b32 a47, 0
    v_accvgpr_write_b32 a48, 0
    v_accvgpr_write_b32 a49, 0
    v_accvgpr_write_b32 a50, 0
    v_accvgpr_write_b32 a51, 0
    v_accvgpr_write_b32 a52, 0
    v_accvgpr_write_b32 a53, 0
    v_accvgpr_write_b32 a54, 0
    v_accvgpr_write_b32 a55, 0
    v_accvgpr_write_b32 a56, 0
    v_accvgpr_write_b32 a57, 0
    v_accvgpr_write_b32 a58, 0
    v_accvgpr_write_b32 a59, 0
    v_accvgpr_write_b32 a60, 0
    v_accvgpr_write_b32 a61, 0
    v_accvgpr_write_b32 a62, 0
    v_accvgpr_write_b32 a63, 0
    v_accvgpr_write_b32 a64, 0
    v_accvgpr_write_b32 a65, 0
    v_accvgpr_write_b32 a66, 0
    v_accvgpr_write_b32 a67, 0
    v_accvgpr_write_b32 a68, 0
    v_accvgpr_write_b32 a69, 0
    v_accvgpr_write_b32 a70, 0
    v_accvgpr_write_b32 a71, 0
    v_accvgpr_write_b32 a72, 0
    v_accvgpr_write_b32 a73, 0
    v_accvgpr_write_b32 a74, 0
    v_accvgpr_write_b32 a75, 0
    v_accvgpr_write_b32 a76, 0
    v_accvgpr_write_b32 a77, 0
    v_accvgpr_write_b32 a78, 0
    v_accvgpr_write_b32 a79, 0
    v_accvgpr_write_b32 a80, 0
    v_accvgpr_write_b32 a81, 0
    v_accvgpr_write_b32 a82, 0
    v_accvgpr_write_b32 a83, 0
    v_accvgpr_write_b32 a84, 0
    v_accvgpr_write_b32 a85, 0
    v_accvgpr_write_b32 a86, 0
    v_accvgpr_write_b32 a87, 0
    v_accvgpr_write_b32 a88, 0
    v_accvgpr_write_b32 a89, 0
    v_accvgpr_write_b32 a90, 0
    v_accvgpr_write_b32 a91, 0
    v_accvgpr_write_b32 a92, 0
    v_accvgpr_write_b32 a93, 0
    v_accvgpr_write_b32 a94, 0
    v_accvgpr_write_b32 a95, 0
    v_accvgpr_write_b32 a96, 0
    v_accvgpr_write_b32 a97, 0
    v_accvgpr_write_b32 a98, 0
    v_accvgpr_write_b32 a99, 0
    v_accvgpr_write_b32 a100, 0
    v_accvgpr_write_b32 a101, 0
    v_accvgpr_write_b32 a102, 0
    v_accvgpr_write_b32 a103, 0
    v_accvgpr_write_b32 a104, 0
    v_accvgpr_write_b32 a105, 0
    v_accvgpr_write_b32 a106, 0
    v_accvgpr_write_b32 a107, 0
    v_accvgpr_write_b32 a108, 0
    v_accvgpr_write_b32 a109, 0
    v_accvgpr_write_b32 a110, 0
    v_accvgpr_write_b32 a111, 0
    v_accvgpr_write_b32 a112, 0
    v_accvgpr_write_b32 a113, 0
    v_accvgpr_write_b32 a114, 0
    v_accvgpr_write_b32 a115, 0
    v_accvgpr_write_b32 a116, 0
    v_accvgpr_write_b32 a117, 0
    v_accvgpr_write_b32 a118, 0
    v_accvgpr_write_b32 a119, 0
    v_accvgpr_write_b32 a120, 0
    v_accvgpr_write_b32 a121, 0
    v_accvgpr_write_b32 a122, 0
    v_accvgpr_write_b32 a123, 0
    v_accvgpr_write_b32 a124, 0
    v_accvgpr_write_b32 a125, 0
    v_accvgpr_write_b32 a126, 0
    v_accvgpr_write_b32 a127, 0
    v_accvgpr_write_b32 a192, 0
    v_accvgpr_write_b32 a193, 0
    v_accvgpr_write_b32 a194, 0
    v_accvgpr_write_b32 a195, 0
    v_accvgpr_write_b32 a196, 0
    v_accvgpr_write_b32 a197, 0
    v_accvgpr_write_b32 a198, 0
    v_accvgpr_write_b32 a199, 0
    v_accvgpr_write_b32 a200, 0
    v_accvgpr_write_b32 a201, 0
    v_accvgpr_write_b32 a202, 0
    v_accvgpr_write_b32 a203, 0
    v_accvgpr_write_b32 a204, 0
    v_accvgpr_write_b32 a205, 0
    v_accvgpr_write_b32 a206, 0
    v_accvgpr_write_b32 a207, 0
    s_waitcnt vmcnt(0) lgkmcnt(0)
    s_barrier
    ds_read_b128 a[208:211], v8 offset:0
    ds_read_b128 a[212:215], v9 offset:0
    ds_read_b128 a[216:219], v10 offset:0
    ds_read_b128 a[220:223], v11 offset:0
    ds_read_b128 a[224:227], v8 offset:4096
    s_waitcnt vmcnt(0) lgkmcnt(0)
    s_branch Lattn_stage0
Lattn_armwait:
    s_mov_b32 s36, 16384
Lattn_armloop:
    v_mov_b32 v63, 0
    buffer_load_dword v63, v63, s[88:91], 0 offen sc1
    s_waitcnt vmcnt(0)
    v_readfirstlane_b32 s37, v63
    s_sub_u32 s36, s36, 1
    s_cbranch_scc1 Lattn_armed
    s_cmp_lt_u32 s37, 256
    s_cbranch_scc1 Lattn_armloop
    s_branch Lattn_armed
Lattn_end:
    s_endpgm
.section .rodata,"a"
.p2align 6
.amdhsa_kernel adaLN_cond__gqa_block_cached__moe_arch_mod__prompt_kernel
  .amdhsa_next_free_vgpr 512
  .amdhsa_next_free_sgpr 102
  .amdhsa_accum_offset 256
  .amdhsa_group_segment_fixed_size 0
  .amdhsa_kernarg_size 120
  .amdhsa_user_sgpr_count 2
  .amdhsa_user_sgpr_kernarg_segment_ptr 1
  .amdhsa_system_sgpr_workgroup_id_x 1
  .amdhsa_float_denorm_mode_32 3
.end_amdhsa_kernel
```

```asm
; @launch grid=(256,1,1) block=(256,1,1) lds=163840
.amdgcn_target "amdgcn-amd-amdhsa--gfx950"
.text
.globl adaLN_cond__gqa_block_cached__moe_arch_mod__prompt_kernel
.p2align 8
.type adaLN_cond__gqa_block_cached__moe_arch_mod__prompt_kernel,@function
adaLN_cond__gqa_block_cached__moe_arch_mod__prompt_kernel:
    s_cmp_ge_u32 s2, 256
    s_cbranch_scc1 Lattn_end
    s_load_dwordx2 s[8:9], s[0:1], 80
    s_load_dwordx2 s[12:13], s[0:1], 88
    s_load_dwordx2 s[20:21], s[0:1], 0
    s_load_dwordx2 s[50:51], s[0:1], 112
    s_load_dwordx8 s[52:59], s[0:1], 8
    s_load_dwordx4 s[80:83], s[0:1], 56
    s_load_dwordx2 s[84:85], s[0:1], 72
    s_load_dwordx2 s[88:89], s[0:1], 104
    s_getpc_b64 s[32:33]
Lattn_pc:
    s_mov_b32 s34, Lattn_end-Lattn_pc
    s_mov_b32 s35, 0x20000
    s_lshr_b32 s6, s2, 3
    s_lshl_b32 s7, s6, 6
    v_lshrrev_b32 v3, 6, v0
    v_and_b32 v1, 63, v0
    v_lshrrev_b32 v2, 2, v0
    v_lshlrev_b32 v2, 11, v2
    v_readfirstlane_b32 s3, v3
    buffer_load_dword v240, v2, s[32:35], s7 offen
    s_and_b32 s7, s2, 7
    s_lshl_b32 s4, s7, 1
    s_and_b32 s5, s6, 1
    s_add_u32 s4, s4, s5
    s_lshr_b32 s5, s2, 4
    s_lshr_b32 s38, s6, 2
    s_lshl_b32 s38, s38, 3
    s_add_u32 s38, s38, s7
    s_cmp_lt_u32 s38, 54
    s_cselect_b32 s39, 0, 2147483648
    s_lshl_b32 s38, s38, 2
    s_and_b32 s36, s6, 3
    s_add_u32 s38, s38, s36
    s_mov_b32 s14, 3981312
    s_mul_i32 s92, s6, 124416
    s_lshl_b32 s36, s7, 7
    s_add_u32 s92, s92, s36
    v_lshrrev_b32 v2, 2, v0
    v_min_u32 v2, 53, v2
    v_mul_u32_u24 v3, 86, v2
    v_lshrrev_b32 v3, 8, v3
    v_mul_u32_u24 v3, 3840, v3
    v_lshl_add_u32 v72, v2, 10, v3
    s_mov_b32 s15, 0x20000
    s_mov_b32 s10, 1152
    s_mov_b32 s11, 0x20000
    s_mov_b32 s22, 2359296
    s_mov_b32 s23, 0x20000
    v_and_b32 v64, 0xfe, v0
    v_mul_u32_u24 v65, 3456, v64
    v_and_b32 v2, 1, v0
    v_lshl_add_u32 v65, v2, 4, v65
    s_lshl_b32 s36, s38, 5
    s_or_b32 s36, s36, s39
    v_and_b32 v4, 31, v1
    v_lshrrev_b32 v5, 5, v1
    v_cmp_gt_u32 vcc, 24, v4
    v_mov_b32 v6, 2147483648
    s_lshl_b32 s7, s5, 4
    s_add_u32 s7, s7, s4
    s_lshl_b32 s7, s7, 2
    s_add_u32 s7, s7, s3
    v_cndmask_b32 v6, v6, 0, vcc
    s_mul_i32 s37, s7, 2304
    v_lshrrev_b32 v7, 2, v4
    v_lshl_add_u32 v7, v7, 6, v6
    v_and_b32 v2, 3, v4
    v_lshl_add_u32 v7, v2, 3, v7
    v_mul_u32_u24 v2, 1152, v5
    v_add_u32 v66, v7, v2
    s_waitcnt lgkmcnt(0)
    s_load_dword s94, s[50:51], 24576
    buffer_load_dword v241, v72, s[12:15], s92 offen
    buffer_load_ushort v80, v64, s[8:11], 0 offen offset:0
    buffer_load_ushort v81, v64, s[8:11], 0 offen offset:256
    buffer_load_ushort v82, v64, s[8:11], 0 offen offset:512
    buffer_load_ushort v83, v64, s[8:11], 0 offen offset:768
    buffer_load_ushort v84, v64, s[8:11], 0 offen offset:1024
    buffer_load_dwordx2 v[108:109], v66, s[20:23], s37 offen offset:0
    buffer_load_dwordx2 v[110:111], v66, s[20:23], s37 offen offset:32
    buffer_load_dwordx2 v[112:113], v66, s[20:23], s37 offen offset:384
    buffer_load_dwordx2 v[114:115], v66, s[20:23], s37 offen offset:416
    buffer_load_dwordx2 v[116:117], v66, s[20:23], s37 offen offset:768
    buffer_load_dwordx2 v[118:119], v66, s[20:23], s37 offen offset:800
    buffer_load_dwordx4 v[88:91], v65, s[12:15], s36 offen
    s_add_u32 s36, s36, 884736
    buffer_load_dwordx4 v[92:95], v65, s[12:15], s36 offen
    s_add_u32 s36, s36, 884736
    buffer_load_dwordx4 v[96:99], v65, s[12:15], s36 offen
    s_add_u32 s36, s36, 884736
    buffer_load_dwordx4 v[100:103], v65, s[12:15], s36 offen
    s_add_u32 s36, s36, 884736
    buffer_load_dwordx4 v[104:107], v65, s[12:15], s36 offen
    s_mov_b32 s16, s56
    s_mov_b32 s17, s57
    s_mov_b32 s18, 4718592
    s_mov_b32 s19, 0x20000
    s_lshl_b32 s44, s4, 9
    s_mul_i32 s36, s5, 294912
    v_min_u32 v2, 143, v0
    v_lshrrev_b32 v3, 2, v2
    v_and_b32 v2, 3, v2
    v_lshl_add_u32 v2, v2, 7, s36
    v_lshl_add_u32 v71, v3, 13, v2
    s_add_u32 s92, s37, 65536
    v_lshl_add_u32 v7, v5, 4, v6
    v_lshl_add_u32 v67, v4, 5, v7
    v_min_u32 v4, 23, v4
    v_lshlrev_b32 v68, 4, v4
    s_mov_b32 s24, s50
    s_mov_b32 s25, s51
    s_mov_b32 s26, 10485760
    s_mov_b32 s27, 0x20000
    s_mov_b32 s90, 256
    s_mov_b32 s91, 0x20000
    s_mul_i32 s36, s38, 1821
    s_lshr_b32 s36, s36, 16
    s_cmp_eq_u32 s36, 1
    s_cselect_b32 s93, 1.0, 0
    s_cmp_eq_u32 s36, 4
    s_cselect_b32 s93, 1.0, s93
    s_lshr_b32 s36, s38, 1
    s_lshl_b32 s36, s36, 6
    s_and_b32 s37, s38, 1
    s_lshl_b32 s37, s37, 3
    s_add_u32 s36, s36, s37
    v_lshrrev_b32 v2, 1, v0
    v_lshl_add_u32 v2, v2, 4, s36
    v_and_b32 v3, 1, v0
    v_lshl_add_u32 v70, v3, 2, v2
    v_lshlrev_b32 v69, 1, v70
    v_cmp_gt_u32 s[36:37], 8, v0
    v_mov_b32 v2, 2147483648
    v_mov_b32 v3, s39
    v_cndmask_b32 v2, v2, v3, s[36:37]
    v_or_b32 v69, v69, v2
    v_or_b32 v70, v70, v2
    s_lshl_b32 s42, s3, 12
    v_lshrrev_b32 v2, 4, v1
    v_and_b32 v3, 15, v1
    v_lshrrev_b32 v5, 1, v3
    v_mul_u32_u24 v5, 2304, v5
    v_lshl_add_u32 v5, v2, 5, v5
    v_and_b32 v6, 1, v3
    v_lshl_add_u32 v51, v6, 4, v5
    s_lshl_b32 s6, s5, 2
    s_add_u32 s6, s6, s3
    s_mul_i32 s46, s6, 36864
    s_add_u32 s46, s46, 65536
    s_add_u32 s43, s46, 18432
    s_mul_i32 s45, s4, 294912
    s_lshl_b32 s7, s3, 4
    v_add_u32 v4, s7, v2
    v_lshlrev_b32 v5, 1, v2
    v_xor_b32 v5, v5, v3
    v_xor_b32 v6, 8, v5
    v_lshlrev_b32 v7, 13, v4
    v_lshl_add_u32 v42, v5, 4, v7
    v_lshl_add_u32 v43, v6, 4, v7
    v_add_u32 v44, 63488, v42
    v_add_u32 v45, 95232, v43
    v_add_u32 v43, 31744, v43
    s_lshl_b32 s7, s4, 19
    s_add_u32 s8, s52, s7
    s_addc_u32 s9, s53, 0
    s_mov_b32 s10, 524288
    s_mov_b32 s11, 0x20000
    s_add_u32 s12, s54, s7
    s_addc_u32 s13, s55, 0
    s_mov_b32 s14, 524288
    s_mov_b32 s15, 0x20000
    s_mov_b32 s20, s58
    s_mov_b32 s21, s59
    s_mov_b32 s22, 4718592
    s_mov_b32 s23, 0x20000
    s_add_u32 s28, s50, 10485760
    s_addc_u32 s29, s51, 0
    s_mov_b32 s30, 37748736
    s_mov_b32 s31, 0x20000
    v_lshlrev_b32 v7, 8, v4
    v_lshl_add_u32 v40, v5, 4, v7
    v_lshl_add_u32 v41, v6, 4, v7
    v_xor_b32 v224, v3, v2
    v_lshl_add_u32 v36, v224, 4, v7
    v_xor_b32 v37, 64, v36
    v_xor_b32 v38, 128, v36
    v_xor_b32 v39, 192, v36
    v_lshrrev_b32 v7, 3, v5
    v_lshl_add_u32 v7, v7, 7, v4
    v_mul_u32_u24 v7, 1152, v7
    v_and_b32 v225, 7, v5
    v_lshl_add_u32 v46, v225, 4, v7
    v_lshrrev_b32 v7, 3, v6
    v_lshl_add_u32 v7, v7, 7, v4
    v_mul_u32_u24 v7, 1152, v7
    v_and_b32 v225, 7, v6
    v_lshl_add_u32 v47, v225, 4, v7
    v_add_u32 v48, 7168, v46
    v_add_u32 v49, 10752, v47
    v_add_u32 v47, 3584, v47
    v_lshlrev_b32 v7, 8, v3
    v_lshl_add_u32 v8, v224, 4, v7
    v_xor_b32 v9, 64, v8
    v_xor_b32 v10, 128, v8
    v_xor_b32 v11, 192, v8
    v_lshrrev_b32 v5, 2, v1
    v_and_b32 v6, 7, v5
    v_lshlrev_b32 v6, 5, v6
    v_lshl_add_u32 v6, v5, 8, v6
    v_and_b32 v7, 3, v1
    v_lshl_add_u32 v12, v7, 3, v6
    v_xor_b32 v13, 32, v12
    v_xor_b32 v14, 64, v12
    v_xor_b32 v15, 96, v12
    v_xor_b32 v16, 128, v12
    v_xor_b32 v17, 160, v12
    v_xor_b32 v18, 192, v12
    v_xor_b32 v19, 224, v12
    v_add_u32 v20, 65536, v12
    v_add_u32 v21, 65536, v13
    v_add_u32 v22, 65536, v14
    v_add_u32 v23, 65536, v15
    v_add_u32 v24, 65536, v16
    v_add_u32 v25, 65536, v17
    v_add_u32 v26, 65536, v18
    v_add_u32 v27, 65536, v19
    v_add_u32 v28, 131072, v12
    v_add_u32 v29, 131072, v13
    v_add_u32 v30, 131072, v14
    v_add_u32 v31, 131072, v15
    v_add_u32 v32, 131072, v16
    v_add_u32 v33, 131072, v17
    v_add_u32 v34, 131072, v18
    v_add_u32 v35, 131072, v19
    v_mov_b32 v52, 0x3f803f80
    v_mov_b32 v53, 0x3f803f80
    v_mov_b32 v54, 0x3f803f80
    v_mov_b32 v55, 0x3f803f80
    v_and_b32 v5, 1, v1
    v_mul_u32_u24 v5, 0xaaaa, v5
    v_add_u32 v5, 0x4444, v5
    v_lshl_add_u32 v50, v5, 16, v5
    v_lshrrev_b32 v5, 1, v3
    v_mul_u32_u24 v5, 36864, v5
    v_lshl_add_u32 v5, v2, 5, v5
    v_and_b32 v6, 1, v3
    v_lshl_add_u32 v56, v6, 4, v5
    s_mul_i32 s47, s6, 589824
    s_mul_i32 s7, s4, 2304
    s_add_u32 s47, s47, s7
    s_mov_b32 s32, s82
    s_mov_b32 s33, s83
    s_mov_b32 s34, 5308416
    s_mov_b32 s35, 0x20000
    s_mov_b32 s82, 5308416
    s_mov_b32 s83, 0x20000
    s_mov_b32 s86, 5308416
    s_mov_b32 s87, 0x20000
    s_lshr_b32 s7, s2, 3
    s_mul_i32 s7, s7, 18
    s_add_u32 s7, s7, s3
    s_and_b32 s36, s2, 7
    s_mul_i32 s37, s36, 576
    s_add_u32 s37, s37, s7
    s_mul_i32 s37, s37, 1152
    s_mul_i32 s7, s7, 9216
    s_mul_i32 s36, s36, 1152
    s_add_u32 s7, s7, s36
    v_min_u32 v5, 17, v1
    v_lshl_add_u32 v57, v5, 6, s7
    v_lshl_add_u32 v62, v5, 6, s37
    s_mov_b32 s40, 0
    s_mov_b32 s41, 0
    s_mov_b32 s48, 0
    s_waitcnt vmcnt(15)
    v_lshlrev_b32 v80, 16, v80
    s_waitcnt vmcnt(14)
    v_lshlrev_b32 v81, 16, v81
    s_waitcnt vmcnt(13)
    v_lshlrev_b32 v82, 16, v82
    s_waitcnt vmcnt(12)
    v_lshlrev_b32 v83, 16, v83
    s_waitcnt vmcnt(11)
    v_lshlrev_b32 v84, 16, v84
    v_mul_f32 v144, 0xbfb8aa3b, v80
    v_mul_f32 v148, 0xbfb8aa3b, v81
    v_mul_f32 v152, 0xbfb8aa3b, v82
    v_mul_f32 v156, 0xbfb8aa3b, v83
    v_mul_f32 v160, 0xbfb8aa3b, v84
    v_min_f32 v144, 0x42fc0000, v144
    v_min_f32 v148, 0x42fc0000, v148
    v_min_f32 v152, 0x42fc0000, v152
    v_min_f32 v156, 0x42fc0000, v156
    v_min_f32 v160, 0x42fc0000, v160
    v_exp_f32 v144, v144
    v_exp_f32 v148, v148
    v_exp_f32 v152, v152
    v_exp_f32 v156, v156
    v_exp_f32 v160, v160
    v_add_f32 v144, 1.0, v144
    v_add_f32 v148, 1.0, v148
    v_add_f32 v152, 1.0, v152
    v_add_f32 v156, 1.0, v156
    v_add_f32 v160, 1.0, v160
    v_rcp_f32 v145, v144
    v_rcp_f32 v149, v148
    v_rcp_f32 v153, v152
    v_rcp_f32 v157, v156
    v_rcp_f32 v161, v160
    v_mul_f32 v146, v80, v145
    v_mul_f32 v150, v81, v149
    v_mul_f32 v154, v82, v153
    v_mul_f32 v158, v83, v157
    v_mul_f32 v162, v84, v161
    v_fma_f32 v144, -v146, v144, v80
    v_fma_f32 v148, -v150, v148, v81
    v_fma_f32 v152, -v154, v152, v82
    v_fma_f32 v156, -v158, v156, v83
    v_fma_f32 v160, -v162, v160, v84
    v_fma_f32 v80, v144, v145, v146
    v_fma_f32 v81, v148, v149, v150
    v_fma_f32 v82, v152, v153, v154
    v_fma_f32 v83, v156, v157, v158
    v_fma_f32 v84, v160, v161, v162
    v_cvt_pk_bf16_f32 v80, v80, v80
    v_cvt_pk_bf16_f32 v81, v81, v81
    v_cvt_pk_bf16_f32 v82, v82, v82
    v_cvt_pk_bf16_f32 v83, v83, v83
    v_cvt_pk_bf16_f32 v84, v84, v84
    v_and_b32 v80, 0xffff0000, v80
    v_and_b32 v81, 0xffff0000, v81
    v_and_b32 v82, 0xffff0000, v82
    v_and_b32 v83, 0xffff0000, v83
    v_and_b32 v84, 0xffff0000, v84
    s_waitcnt vmcnt(4)
    v_lshlrev_b32 v136, 16, v88
    v_and_b32 v137, 0xffff0000, v88
    v_lshlrev_b32 v138, 16, v89
    v_and_b32 v139, 0xffff0000, v89
    v_lshlrev_b32 v140, 16, v90
    v_and_b32 v141, 0xffff0000, v90
    v_lshlrev_b32 v142, 16, v91
    v_and_b32 v143, 0xffff0000, v91
    v_pk_mul_f32 v[128:129], v[136:137], v[80:81] op_sel:[0,0] op_sel_hi:[1,0]
    v_pk_mul_f32 v[130:131], v[138:139], v[80:81] op_sel:[0,0] op_sel_hi:[1,0]
    v_pk_mul_f32 v[132:133], v[140:141], v[80:81] op_sel:[0,0] op_sel_hi:[1,0]
    v_pk_mul_f32 v[134:135], v[142:143], v[80:81] op_sel:[0,0] op_sel_hi:[1,0]
    s_waitcnt vmcnt(3)
    v_lshlrev_b32 v136, 16, v92
    v_and_b32 v137, 0xffff0000, v92
    v_lshlrev_b32 v138, 16, v93
    v_and_b32 v139, 0xffff0000, v93
    v_lshlrev_b32 v140, 16, v94
    v_and_b32 v141, 0xffff0000, v94
    v_lshlrev_b32 v142, 16, v95
    v_and_b32 v143, 0xffff0000, v95
    v_pk_fma_f32 v[128:129], v[136:137], v[80:81], v[128:129] op_sel:[0,1,0] op_sel_hi:[1,1,1]
    v_pk_fma_f32 v[130:131], v[138:139], v[80:81], v[130:131] op_sel:[0,1,0] op_sel_hi:[1,1,1]
    v_pk_fma_f32 v[132:133], v[140:141], v[80:81], v[132:133] op_sel:[0,1,0] op_sel_hi:[1,1,1]
    v_pk_fma_f32 v[134:135], v[142:143], v[80:81], v[134:135] op_sel:[0,1,0] op_sel_hi:[1,1,1]
    s_waitcnt vmcnt(2)
    v_lshlrev_b32 v136, 16, v96
    v_and_b32 v137, 0xffff0000, v96
    v_lshlrev_b32 v138, 16, v97
    v_and_b32 v139, 0xffff0000, v97
    v_lshlrev_b32 v140, 16, v98
    v_and_b32 v141, 0xffff0000, v98
    v_lshlrev_b32 v142, 16, v99
    v_and_b32 v143, 0xffff0000, v99
    v_pk_fma_f32 v[128:129], v[136:137], v[82:83], v[128:129] op_sel:[0,0,0] op_sel_hi:[1,0,1]
    v_pk_fma_f32 v[130:131], v[138:139], v[82:83], v[130:131] op_sel:[0,0,0] op_sel_hi:[1,0,1]
    v_pk_fma_f32 v[132:133], v[140:141], v[82:83], v[132:133] op_sel:[0,0,0] op_sel_hi:[1,0,1]
    v_pk_fma_f32 v[134:135], v[142:143], v[82:83], v[134:135] op_sel:[0,0,0] op_sel_hi:[1,0,1]
    s_waitcnt vmcnt(1)
    v_lshlrev_b32 v136, 16, v100
    v_and_b32 v137, 0xffff0000, v100
    v_lshlrev_b32 v138, 16, v101
    v_and_b32 v139, 0xffff0000, v101
    v_lshlrev_b32 v140, 16, v102
    v_and_b32 v141, 0xffff0000, v102
    v_lshlrev_b32 v142, 16, v103
    v_and_b32 v143, 0xffff0000, v103
    v_pk_fma_f32 v[128:129], v[136:137], v[82:83], v[128:129] op_sel:[0,1,0] op_sel_hi:[1,1,1]
    v_pk_fma_f32 v[130:131], v[138:139], v[82:83], v[130:131] op_sel:[0,1,0] op_sel_hi:[1,1,1]
    v_pk_fma_f32 v[132:133], v[140:141], v[82:83], v[132:133] op_sel:[0,1,0] op_sel_hi:[1,1,1]
    v_pk_fma_f32 v[134:135], v[142:143], v[82:83], v[134:135] op_sel:[0,1,0] op_sel_hi:[1,1,1]
    s_waitcnt vmcnt(0)
    v_lshlrev_b32 v136, 16, v104
    v_and_b32 v137, 0xffff0000, v104
    v_lshlrev_b32 v138, 16, v105
    v_and_b32 v139, 0xffff0000, v105
    v_lshlrev_b32 v140, 16, v106
    v_and_b32 v141, 0xffff0000, v106
    v_lshlrev_b32 v142, 16, v107
    v_and_b32 v143, 0xffff0000, v107
    v_pk_fma_f32 v[128:129], v[136:137], v[84:85], v[128:129] op_sel:[0,0,0] op_sel_hi:[1,0,1]
    v_pk_fma_f32 v[130:131], v[138:139], v[84:85], v[130:131] op_sel:[0,0,0] op_sel_hi:[1,0,1]
    v_pk_fma_f32 v[132:133], v[140:141], v[84:85], v[132:133] op_sel:[0,0,0] op_sel_hi:[1,0,1]
    v_pk_fma_f32 v[134:135], v[142:143], v[84:85], v[134:135] op_sel:[0,0,0] op_sel_hi:[1,0,1]
    buffer_load_dword v242, v71, s[16:19], s44 offen
    v_permlane32_swap_b32 v128, v132
    v_permlane32_swap_b32 v129, v133
    v_permlane32_swap_b32 v130, v134
    v_permlane32_swap_b32 v131, v135
    v_and_b32 v72, 1, v1
    v_pk_add_f32 v[128:129], v[128:129], v[132:133]
    v_pk_add_f32 v[130:131], v[130:131], v[134:135]
    v_lshlrev_b32 v72, 5, v72
    v_lshrrev_b32 v73, 4, v1
    v_permlane16_swap_b32 v128, v130
    v_permlane16_swap_b32 v129, v131
    v_lshl_add_u32 v72, v73, 3, v72
    v_pk_add_f32 v[128:129], v[128:129], v[130:131]
    s_lshl_b32 s36, s3, 6
    v_add_u32 v72, s36, v72
    v_add_f32_dpp v128, v128, v128 row_ror:2 row_mask:0xf bank_mask:0xf
    v_add_f32_dpp v129, v129, v129 row_ror:2 row_mask:0xf bank_mask:0xf
    s_nop 0
    v_add_f32_dpp v128, v128, v128 row_ror:4 row_mask:0xf bank_mask:0xf
    v_add_f32_dpp v129, v129, v129 row_ror:4 row_mask:0xf bank_mask:0xf
    s_nop 0
    v_add_f32_dpp v128, v128, v128 row_ror:8 row_mask:0xf bank_mask:0xf
    v_add_f32_dpp v129, v129, v129 row_ror:8 row_mask:0xf bank_mask:0xf
    ds_write_b64 v72, v[128:129] offset:0
    v_and_b32 v73, 7, v1
    v_lshlrev_b32 v73, 3, v73
    s_waitcnt lgkmcnt(0)
    s_barrier
    ds_read_b64 v[128:129], v73 offset:0
    ds_read_b64 v[130:131], v73 offset:64
    ds_read_b64 v[132:133], v73 offset:128
    ds_read_b64 v[134:135], v73 offset:192
    s_add_u32 s95, s94, 0x9e3779b9
    v_mov_b32 v137, s95
    s_mov_b32 s36, 16384
    s_waitcnt lgkmcnt(2)
    v_pk_add_f32 v[128:129], v[128:129], v[130:131]
    s_waitcnt lgkmcnt(0)
    v_pk_add_f32 v[132:133], v[132:133], v[134:135]
    v_pk_add_f32 v[128:129], v[128:129], v[132:133]
    v_cvt_pk_bf16_f32 v136, v128, v129
    v_lshlrev_b32 v128, 16, v136
    v_and_b32 v129, 0xffff0000, v136
    v_add_f32 v128, s93, v128
    v_add_f32 v129, s93, v129
    v_cvt_pk_bf16_f32 v136, v128, v129
    buffer_store_dwordx2 v[136:137], v69, s[24:27], 0 offen sc1
    buffer_store_dword v136, v70, s[24:27], s36 offen sc1
    v_lshlrev_b32 v144, 16, v108
    v_and_b32 v145, 0xffff0000, v108
    v_lshlrev_b32 v146, 16, v109
    v_and_b32 v147, 0xffff0000, v109
    v_lshlrev_b32 v148, 16, v110
    v_and_b32 v149, 0xffff0000, v110
    v_lshlrev_b32 v150, 16, v111
    v_and_b32 v151, 0xffff0000, v111
    v_lshlrev_b32 v152, 16, v112
    v_and_b32 v153, 0xffff0000, v112
    v_lshlrev_b32 v154, 16, v113
    v_and_b32 v155, 0xffff0000, v113
    v_lshlrev_b32 v156, 16, v114
    v_and_b32 v157, 0xffff0000, v114
    v_lshlrev_b32 v158, 16, v115
    v_and_b32 v159, 0xffff0000, v115
    v_lshlrev_b32 v160, 16, v116
    v_and_b32 v161, 0xffff0000, v116
    v_lshlrev_b32 v162, 16, v117
    v_and_b32 v163, 0xffff0000, v117
    v_lshlrev_b32 v164, 16, v118
    v_and_b32 v165, 0xffff0000, v118
    v_lshlrev_b32 v166, 16, v119
    v_and_b32 v167, 0xffff0000, v119
    v_pk_add_f32 v[72:73], v[144:145], v[148:149]
    v_pk_add_f32 v[76:77], v[146:147], v[150:151]
    v_pk_add_f32 v[72:73], v[72:73], v[152:153]
    v_pk_add_f32 v[76:77], v[76:77], v[154:155]
    v_pk_add_f32 v[72:73], v[72:73], v[156:157]
    v_pk_add_f32 v[76:77], v[76:77], v[158:159]
    v_pk_add_f32 v[72:73], v[72:73], v[160:161]
    v_pk_add_f32 v[76:77], v[76:77], v[162:163]
    v_pk_add_f32 v[72:73], v[72:73], v[164:165]
    v_pk_add_f32 v[76:77], v[76:77], v[166:167]
    v_pk_add_f32 v[72:73], v[72:73], v[76:77]
    v_add_f32 v72, v72, v73
    s_nop 1
    v_add_f32_dpp v72, v72, v72 row_ror:1 row_mask:0xf bank_mask:0xf
    s_nop 1
    v_add_f32_dpp v72, v72, v72 row_ror:2 row_mask:0xf bank_mask:0xf
    s_nop 1
    v_add_f32_dpp v72, v72, v72 row_ror:4 row_mask:0xf bank_mask:0xf
    s_nop 1
    v_add_f32_dpp v72, v72, v72 row_ror:8 row_mask:0xf bank_mask:0xf
    v_mov_b32 v76, v72
    s_nop 1
    v_permlane16_swap_b32 v72, v76
    s_nop 0
    v_add_f32 v72, v72, v76
    v_mul_f32 v72, 0x3ae38e39, v72
    v_pk_add_f32 v[168:169], v[144:145], v[72:73] op_sel_hi:[1,0] neg_lo:[0,1] neg_hi:[0,1]
    v_pk_add_f32 v[170:171], v[146:147], v[72:73] op_sel_hi:[1,0] neg_lo:[0,1] neg_hi:[0,1]
    v_pk_add_f32 v[172:173], v[148:149], v[72:73] op_sel_hi:[1,0] neg_lo:[0,1] neg_hi:[0,1]
    v_pk_add_f32 v[174:175], v[150:151], v[72:73] op_sel_hi:[1,0] neg_lo:[0,1] neg_hi:[0,1]
    v_pk_add_f32 v[176:177], v[152:153], v[72:73] op_sel_hi:[1,0] neg_lo:[0,1] neg_hi:[0,1]
    v_pk_add_f32 v[178:179], v[154:155], v[72:73] op_sel_hi:[1,0] neg_lo:[0,1] neg_hi:[0,1]
    v_pk_add_f32 v[180:181], v[156:157], v[72:73] op_sel_hi:[1,0] neg_lo:[0,1] neg_hi:[0,1]
    v_pk_add_f32 v[182:183], v[158:159], v[72:73] op_sel_hi:[1,0] neg_lo:[0,1] neg_hi:[0,1]
    v_pk_add_f32 v[184:185], v[160:161], v[72:73] op_sel_hi:[1,0] neg_lo:[0,1] neg_hi:[0,1]
    v_pk_add_f32 v[186:187], v[162:163], v[72:73] op_sel_hi:[1,0] neg_lo:[0,1] neg_hi:[0,1]
    v_pk_add_f32 v[188:189], v[164:165], v[72:73] op_sel_hi:[1,0] neg_lo:[0,1] neg_hi:[0,1]
    v_pk_add_f32 v[190:191], v[166:167], v[72:73] op_sel_hi:[1,0] neg_lo:[0,1] neg_hi:[0,1]
    v_pk_mul_f32 v[74:75], v[168:169], v[168:169]
    v_pk_mul_f32 v[76:77], v[170:171], v[170:171]
    v_pk_fma_f32 v[74:75], v[172:173], v[172:173], v[74:75]
    v_pk_fma_f32 v[76:77], v[174:175], v[174:175], v[76:77]
    v_pk_fma_f32 v[74:75], v[176:177], v[176:177], v[74:75]
    v_pk_fma_f32 v[76:77], v[178:179], v[178:179], v[76:77]
    v_pk_fma_f32 v[74:75], v[180:181], v[180:181], v[74:75]
    v_pk_fma_f32 v[76:77], v[182:183], v[182:183], v[76:77]
    v_pk_fma_f32 v[74:75], v[184:185], v[184:185], v[74:75]
    v_pk_fma_f32 v[76:77], v[186:187], v[186:187], v[76:77]
    v_pk_fma_f32 v[74:75], v[188:189], v[188:189], v[74:75]
    v_pk_fma_f32 v[76:77], v[190:191], v[190:191], v[76:77]
    v_pk_add_f32 v[74:75], v[74:75], v[76:77]
    v_add_f32 v74, v74, v75
    v_cndmask_b32 v74, 0, v74, vcc
    s_nop 1
    v_add_f32_dpp v74, v74, v74 row_ror:1 row_mask:0xf bank_mask:0xf
    s_nop 1
    v_add_f32_dpp v74, v74, v74 row_ror:2 row_mask:0xf bank_mask:0xf
    s_nop 1
    v_add_f32_dpp v74, v74, v74 row_ror:4 row_mask:0xf bank_mask:0xf
    s_nop 1
    v_add_f32_dpp v74, v74, v74 row_ror:8 row_mask:0xf bank_mask:0xf
    v_mov_b32 v76, v74
    s_nop 1
    v_permlane16_swap_b32 v74, v76
    s_nop 0
    v_add_f32 v74, v74, v76
    v_mul_f32 v74, 0x3ae38e39, v74
    v_cvt_pk_bf16_f32 v76, v72, v74
    v_and_b32 v74, 0xffff0000, v76
    v_lshlrev_b32 v72, 16, v76
    v_add_f32 v74, 0x3727c5ac, v74
    v_cvt_pk_bf16_f32 v74, v74, v74
    v_and_b32 v74, 0xffff0000, v74
    v_sqrt_f32 v74, v74
    v_pk_add_f32 v[168:169], v[144:145], v[72:73] op_sel_hi:[1,0] neg_lo:[0,1] neg_hi:[0,1]
    v_pk_add_f32 v[170:171], v[146:147], v[72:73] op_sel_hi:[1,0] neg_lo:[0,1] neg_hi:[0,1]
    v_pk_add_f32 v[172:173], v[148:149], v[72:73] op_sel_hi:[1,0] neg_lo:[0,1] neg_hi:[0,1]
    v_pk_add_f32 v[174:175], v[150:151], v[72:73] op_sel_hi:[1,0] neg_lo:[0,1] neg_hi:[0,1]
    v_pk_add_f32 v[176:177], v[152:153], v[72:73] op_sel_hi:[1,0] neg_lo:[0,1] neg_hi:[0,1]
    v_pk_add_f32 v[178:179], v[154:155], v[72:73] op_sel_hi:[1,0] neg_lo:[0,1] neg_hi:[0,1]
    v_pk_add_f32 v[180:181], v[156:157], v[72:73] op_sel_hi:[1,0] neg_lo:[0,1] neg_hi:[0,1]
    v_pk_add_f32 v[182:183], v[158:159], v[72:73] op_sel_hi:[1,0] neg_lo:[0,1] neg_hi:[0,1]
    v_pk_add_f32 v[184:185], v[160:161], v[72:73] op_sel_hi:[1,0] neg_lo:[0,1] neg_hi:[0,1]
    v_pk_add_f32 v[186:187], v[162:163], v[72:73] op_sel_hi:[1,0] neg_lo:[0,1] neg_hi:[0,1]
    v_pk_add_f32 v[188:189], v[164:165], v[72:73] op_sel_hi:[1,0] neg_lo:[0,1] neg_hi:[0,1]
    v_pk_add_f32 v[190:191], v[166:167], v[72:73] op_sel_hi:[1,0] neg_lo:[0,1] neg_hi:[0,1]
    v_cvt_pk_bf16_f32 v74, v74, v74
    v_and_b32 v74, 0xffff0000, v74
    v_rcp_f32 v74, v74
    v_cvt_pk_bf16_f32 v108, v168, v169
    v_cvt_pk_bf16_f32 v109, v170, v171
    v_cvt_pk_bf16_f32 v110, v172, v173
    v_cvt_pk_bf16_f32 v111, v174, v175
    v_cvt_pk_bf16_f32 v112, v176, v177
    v_cvt_pk_bf16_f32 v113, v178, v179
    v_cvt_pk_bf16_f32 v114, v180, v181
    v_cvt_pk_bf16_f32 v115, v182, v183
    v_cvt_pk_bf16_f32 v116, v184, v185
    v_cvt_pk_bf16_f32 v117, v186, v187
    v_cvt_pk_bf16_f32 v118, v188, v189
    v_cvt_pk_bf16_f32 v119, v190, v191
    v_lshlrev_b32 v168, 16, v108
    v_and_b32 v169, 0xffff0000, v108
    v_lshlrev_b32 v170, 16, v109
    v_and_b32 v171, 0xffff0000, v109
    v_lshlrev_b32 v172, 16, v110
    v_and_b32 v173, 0xffff0000, v110
    v_lshlrev_b32 v174, 16, v111
    v_and_b32 v175, 0xffff0000, v111
    v_lshlrev_b32 v176, 16, v112
    v_and_b32 v177, 0xffff0000, v112
    v_lshlrev_b32 v178, 16, v113
    v_and_b32 v179, 0xffff0000, v113
    v_lshlrev_b32 v180, 16, v114
    v_and_b32 v181, 0xffff0000, v114
    v_lshlrev_b32 v182, 16, v115
    v_and_b32 v183, 0xffff0000, v115
    v_lshlrev_b32 v184, 16, v116
    v_and_b32 v185, 0xffff0000, v116
    v_lshlrev_b32 v186, 16, v117
    v_and_b32 v187, 0xffff0000, v117
    v_lshlrev_b32 v188, 16, v118
    v_and_b32 v189, 0xffff0000, v118
    v_lshlrev_b32 v190, 16, v119
    v_and_b32 v191, 0xffff0000, v119
    v_pk_mul_f32 v[168:169], v[168:169], v[74:75] op_sel_hi:[1,0]
    v_pk_mul_f32 v[170:171], v[170:171], v[74:75] op_sel_hi:[1,0]
    v_pk_mul_f32 v[172:173], v[172:173], v[74:75] op_sel_hi:[1,0]
    v_pk_mul_f32 v[174:175], v[174:175], v[74:75] op_sel_hi:[1,0]
    v_pk_mul_f32 v[176:177], v[176:177], v[74:75] op_sel_hi:[1,0]
    v_pk_mul_f32 v[178:179], v[178:179], v[74:75] op_sel_hi:[1,0]
    v_pk_mul_f32 v[180:181], v[180:181], v[74:75] op_sel_hi:[1,0]
    v_pk_mul_f32 v[182:183], v[182:183], v[74:75] op_sel_hi:[1,0]
    v_pk_mul_f32 v[184:185], v[184:185], v[74:75] op_sel_hi:[1,0]
    v_pk_mul_f32 v[186:187], v[186:187], v[74:75] op_sel_hi:[1,0]
    v_pk_mul_f32 v[188:189], v[188:189], v[74:75] op_sel_hi:[1,0]
    v_pk_mul_f32 v[190:191], v[190:191], v[74:75] op_sel_hi:[1,0]
    v_cvt_pk_bf16_f32 v108, v168, v169
    v_cvt_pk_bf16_f32 v109, v170, v171
    v_cvt_pk_bf16_f32 v110, v172, v173
    v_cvt_pk_bf16_f32 v111, v174, v175
    v_cvt_pk_bf16_f32 v112, v176, v177
    v_cvt_pk_bf16_f32 v113, v178, v179
    v_cvt_pk_bf16_f32 v114, v180, v181
    v_cvt_pk_bf16_f32 v115, v182, v183
    v_cvt_pk_bf16_f32 v116, v184, v185
    v_cvt_pk_bf16_f32 v117, v186, v187
    v_cvt_pk_bf16_f32 v118, v188, v189
    v_cvt_pk_bf16_f32 v119, v190, v191
    v_lshlrev_b32 v168, 16, v108
    v_and_b32 v169, 0xffff0000, v108
    v_lshlrev_b32 v170, 16, v109
    v_and_b32 v171, 0xffff0000, v109
    v_lshlrev_b32 v172, 16, v110
    v_and_b32 v173, 0xffff0000, v110
    v_lshlrev_b32 v174, 16, v111
    v_and_b32 v175, 0xffff0000, v111
    v_lshlrev_b32 v176, 16, v112
    v_and_b32 v177, 0xffff0000, v112
    v_lshlrev_b32 v178, 16, v113
    v_and_b32 v179, 0xffff0000, v113
    v_lshlrev_b32 v180, 16, v114
    v_and_b32 v181, 0xffff0000, v114
    v_lshlrev_b32 v182, 16, v115
    v_and_b32 v183, 0xffff0000, v115
    v_lshlrev_b32 v184, 16, v116
    v_and_b32 v185, 0xffff0000, v116
    v_lshlrev_b32 v186, 16, v117
    v_and_b32 v187, 0xffff0000, v117
    v_lshlrev_b32 v188, 16, v118
    v_and_b32 v189, 0xffff0000, v118
    v_lshlrev_b32 v190, 16, v119
    v_and_b32 v191, 0xffff0000, v119
    s_mul_i32 s36, s3, 72
    v_add_u32 v72, s36, v1
    v_and_b32 v73, 7, v1
    s_add_u32 s36, s36, 64
    v_add_u32 v73, s36, v73
    v_lshlrev_b32 v74, 4, v72
    v_lshlrev_b32 v75, 4, v73
    s_movk_i32 s36, 1024
    v_lshl_add_u32 v72, v72, 3, s36
    v_lshl_add_u32 v73, v73, 3, s36
    s_add_u32 s49, s44, 0
    s_add_u32 m0, s42, 32768
    s_nop 0
    buffer_load_dwordx4 v42, s[16:19], s49 offen lds
    buffer_load_dwordx4 v43, s[16:19], s49 offen offset:1024 lds
    buffer_load_dwordx4 v44, s[16:19], s49 offen offset:2048 lds
    buffer_load_dwordx4 v45, s[16:19], s49 offen offset:3072 lds
    s_add_u32 s49, s44, 256
    s_add_u32 m0, s42, 49152
    s_nop 0
    buffer_load_dwordx4 v42, s[16:19], s49 offen lds
    buffer_load_dwordx4 v43, s[16:19], s49 offen offset:1024 lds
    buffer_load_dwordx4 v44, s[16:19], s49 offen offset:2048 lds
    buffer_load_dwordx4 v45, s[16:19], s49 offen offset:3072 lds
    s_mov_b64 exec, 0
    s_cmp_eq_u32 s3, 0
    s_cbranch_scc1 Ltour0
    s_cmp_eq_u32 s3, 1
    s_cbranch_scc1 Ltour1
    s_cmp_eq_u32 s3, 2
    s_cbranch_scc1 Ltour2
    s_branch Ltour3
.p2align 12
Lmain:
    s_mov_b64 exec, -1
    s_mov_b32 s38, 16384
Lhead_pollm:
    buffer_load_dwordx4 v[88:91], v74, s[24:27], 0 offen sc1
    buffer_load_dwordx4 v[92:95], v75, s[24:27], 0 offen sc1
    s_sub_u32 s38, s38, 1
    s_cbranch_scc1 Lhead_gotm
    s_waitcnt vmcnt(0) lgkmcnt(0)
    v_xor_b32 v89, s95, v89
    v_xor_b32 v91, s95, v91
    v_xor_b32 v93, s95, v93
    v_xor_b32 v95, s95, v95
    v_or3_b32 v89, v89, v91, v93
    v_or_b32 v89, v89, v95
    v_cmp_ne_u32 vcc, 0, v89
    s_cbranch_vccnz Lhead_pollm
Lhead_gotm:
    s_waitcnt vmcnt(0) lgkmcnt(0)
    ds_write2_b32 v72, v88, v90 offset0:0 offset1:1
    ds_write2_b32 v73, v92, v94 offset0:0 offset1:1
    s_waitcnt lgkmcnt(0)
    s_barrier
    ds_read_b128 v[144:147], v68 offset:2176
    ds_read_b128 v[148:151], v68 offset:2560
    ds_read_b128 v[152:155], v68 offset:2944
    ds_read_b128 v[156:159], v68 offset:1024
    ds_read_b128 v[160:163], v68 offset:1408
    ds_read_b128 v[164:167], v68 offset:1792
    s_waitcnt lgkmcnt(5)
    v_lshlrev_b32 v192, 16, v144
    v_and_b32 v193, 0xffff0000, v144
    v_lshlrev_b32 v194, 16, v145
    v_and_b32 v195, 0xffff0000, v145
    v_lshlrev_b32 v196, 16, v146
    v_and_b32 v197, 0xffff0000, v146
    v_lshlrev_b32 v198, 16, v147
    v_and_b32 v199, 0xffff0000, v147
    s_waitcnt lgkmcnt(4)
    v_lshlrev_b32 v200, 16, v148
    v_and_b32 v201, 0xffff0000, v148
    v_lshlrev_b32 v202, 16, v149
    v_and_b32 v203, 0xffff0000, v149
    v_lshlrev_b32 v204, 16, v150
    v_and_b32 v205, 0xffff0000, v150
    v_lshlrev_b32 v206, 16, v151
    v_and_b32 v207, 0xffff0000, v151
    s_waitcnt lgkmcnt(3)
    v_lshlrev_b32 v208, 16, v152
    v_and_b32 v209, 0xffff0000, v152
    v_lshlrev_b32 v210, 16, v153
    v_and_b32 v211, 0xffff0000, v153
    v_lshlrev_b32 v212, 16, v154
    v_and_b32 v213, 0xffff0000, v154
    v_lshlrev_b32 v214, 16, v155
    v_and_b32 v215, 0xffff0000, v155
    v_pk_mul_f32 v[168:169], v[168:169], v[192:193]
    v_pk_mul_f32 v[170:171], v[170:171], v[194:195]
    v_pk_mul_f32 v[172:173], v[172:173], v[196:197]
    v_pk_mul_f32 v[174:175], v[174:175], v[198:199]
    v_pk_mul_f32 v[176:177], v[176:177], v[200:201]
    v_pk_mul_f32 v[178:179], v[178:179], v[202:203]
    v_pk_mul_f32 v[180:181], v[180:181], v[204:205]
    v_pk_mul_f32 v[182:183], v[182:183], v[206:207]
    v_pk_mul_f32 v[184:185], v[184:185], v[208:209]
    v_pk_mul_f32 v[186:187], v[186:187], v[210:211]
    v_pk_mul_f32 v[188:189], v[188:189], v[212:213]
    v_pk_mul_f32 v[190:191], v[190:191], v[214:215]
    v_cvt_pk_bf16_f32 v108, v168, v169
    v_cvt_pk_bf16_f32 v109, v170, v171
    v_cvt_pk_bf16_f32 v110, v172, v173
    v_cvt_pk_bf16_f32 v111, v174, v175
    v_cvt_pk_bf16_f32 v112, v176, v177
    v_cvt_pk_bf16_f32 v113, v178, v179
    v_cvt_pk_bf16_f32 v114, v180, v181
    v_cvt_pk_bf16_f32 v115, v182, v183
    v_cvt_pk_bf16_f32 v116, v184, v185
    v_cvt_pk_bf16_f32 v117, v186, v187
    v_cvt_pk_bf16_f32 v118, v188, v189
    v_cvt_pk_bf16_f32 v119, v190, v191
    s_waitcnt lgkmcnt(2)
    v_lshlrev_b32 v216, 16, v156
    v_and_b32 v217, 0xffff0000, v156
    v_lshlrev_b32 v218, 16, v157
    v_and_b32 v219, 0xffff0000, v157
    v_lshlrev_b32 v220, 16, v158
    v_and_b32 v221, 0xffff0000, v158
    v_lshlrev_b32 v222, 16, v159
    v_and_b32 v223, 0xffff0000, v159
    s_waitcnt lgkmcnt(1)
    v_lshlrev_b32 v224, 16, v160
    v_and_b32 v225, 0xffff0000, v160
    v_lshlrev_b32 v226, 16, v161
    v_and_b32 v227, 0xffff0000, v161
    v_lshlrev_b32 v228, 16, v162
    v_and_b32 v229, 0xffff0000, v162
    v_lshlrev_b32 v230, 16, v163
    v_and_b32 v231, 0xffff0000, v163
    s_waitcnt lgkmcnt(0)
    v_lshlrev_b32 v232, 16, v164
    v_and_b32 v233, 0xffff0000, v164
    v_lshlrev_b32 v234, 16, v165
    v_and_b32 v235, 0xffff0000, v165
    v_lshlrev_b32 v236, 16, v166
    v_and_b32 v237, 0xffff0000, v166
    v_lshlrev_b32 v238, 16, v167
    v_and_b32 v239, 0xffff0000, v167
    v_lshlrev_b32 v168, 16, v108
    v_and_b32 v169, 0xffff0000, v108
    v_lshlrev_b32 v170, 16, v109
    v_and_b32 v171, 0xffff0000, v109
    v_lshlrev_b32 v172, 16, v110
    v_and_b32 v173, 0xffff0000, v110
    v_lshlrev_b32 v174, 16, v111
    v_and_b32 v175, 0xffff0000, v111
    v_lshlrev_b32 v176, 16, v112
    v_and_b32 v177, 0xffff0000, v112
    v_lshlrev_b32 v178, 16, v113
    v_and_b32 v179, 0xffff0000, v113
    v_lshlrev_b32 v180, 16, v114
    v_and_b32 v181, 0xffff0000, v114
    v_lshlrev_b32 v182, 16, v115
    v_and_b32 v183, 0xffff0000, v115
    v_lshlrev_b32 v184, 16, v116
    v_and_b32 v185, 0xffff0000, v116
    v_lshlrev_b32 v186, 16, v117
    v_and_b32 v187, 0xffff0000, v117
    v_lshlrev_b32 v188, 16, v118
    v_and_b32 v189, 0xffff0000, v118
    v_lshlrev_b32 v190, 16, v119
    v_and_b32 v191, 0xffff0000, v119
    v_pk_add_f32 v[168:169], v[168:169], v[216:217]
    v_pk_add_f32 v[170:171], v[170:171], v[218:219]
    v_pk_add_f32 v[172:173], v[172:173], v[220:221]
    v_pk_add_f32 v[174:175], v[174:175], v[222:223]
    v_cvt_pk_bf16_f32 v108, v168, v169
    v_cvt_pk_bf16_f32 v109, v170, v171
    v_cvt_pk_bf16_f32 v110, v172, v173
    v_cvt_pk_bf16_f32 v111, v174, v175
    buffer_store_dwordx4 v[108:111], v67, s[24:27], s92 offen offset:0 sc1
    v_pk_add_f32 v[176:177], v[176:177], v[224:225]
    v_pk_add_f32 v[178:179], v[178:179], v[226:227]
    v_pk_add_f32 v[180:181], v[180:181], v[228:229]
    v_pk_add_f32 v[182:183], v[182:183], v[230:231]
    v_cvt_pk_bf16_f32 v112, v176, v177
    v_cvt_pk_bf16_f32 v113, v178, v179
    v_cvt_pk_bf16_f32 v114, v180, v181
    v_cvt_pk_bf16_f32 v115, v182, v183
    buffer_store_dwordx4 v[112:115], v67, s[24:27], s92 offen offset:768 sc1
    v_pk_add_f32 v[184:185], v[184:185], v[232:233]
    v_pk_add_f32 v[186:187], v[186:187], v[234:235]
    v_pk_add_f32 v[188:189], v[188:189], v[236:237]
    v_pk_add_f32 v[190:191], v[190:191], v[238:239]
    v_cvt_pk_bf16_f32 v116, v184, v185
    v_cvt_pk_bf16_f32 v117, v186, v187
    v_cvt_pk_bf16_f32 v118, v188, v189
    v_cvt_pk_bf16_f32 v119, v190, v191
    buffer_store_dwordx4 v[116:119], v67, s[24:27], s92 offen offset:1536 sc1
    s_lshl_b32 s36, s5, 13
    s_add_u32 s36, s36, 8650752
    s_lshl_b32 s37, s4, 9
    s_add_u32 s37, s37, s36
    s_lshl_b32 s38, s3, 7
    s_add_u32 s37, s37, s38
    s_lshl_b32 s38, s3, 11
    s_add_u32 s36, s36, s38
    v_mov_b32 v72, 0
    v_and_b32 v73, 15, v1
    v_lshlrev_b32 v73, 7, v73
    v_cmp_gt_u32 vcc, 162, v0
    v_mov_b32 v88, -1
    v_mov_b32 v89, -1
    v_mov_b32 v90, -1
    v_mov_b32 v91, -1
    s_mul_i32 s39, s2, 2592
    s_add_u32 s39, s39, 7864320
    v_lshl_add_u32 v74, v0, 4, s39
    s_lshl_b32 s39, s2, 7
    s_add_u32 s39, s39, 8912896
    v_mov_b32 v75, s39
    v_cndmask_b32 v74, v75, v74, vcc
    v_cmp_eq_u32 vcc, 0, v0
    v_mov_b32 v64, 2147483648
    v_mov_b32 v65, 1
    s_waitcnt vmcnt(0)
    s_mov_b64 exec, 1
    buffer_store_dword v137, v72, s[24:27], s37 offen sc1
    s_mov_b64 exec, -1
    v_cndmask_b32 v64, v64, 0, vcc
    s_add_u32 s49, s44, 524288
    s_add_u32 m0, s42, 65536
    s_nop 0
    buffer_load_dwordx4 v42, s[16:19], s49 offen lds
    buffer_load_dwordx4 v43, s[16:19], s49 offen offset:1024 lds
    buffer_load_dwordx4 v44, s[16:19], s49 offen offset:2048 lds
    buffer_load_dwordx4 v45, s[16:19], s49 offen offset:3072 lds
    s_add_u32 s49, s44, 524544
    s_add_u32 m0, s42, 81920
    s_nop 0
    buffer_load_dwordx4 v42, s[16:19], s49 offen lds
    buffer_load_dwordx4 v43, s[16:19], s49 offen offset:1024 lds
    buffer_load_dwordx4 v44, s[16:19], s49 offen offset:2048 lds
    buffer_load_dwordx4 v45, s[16:19], s49 offen offset:3072 lds
    s_add_u32 s49, s44, 1048576
    s_add_u32 m0, s42, 98304
    s_nop 0
    buffer_load_dwordx4 v42, s[16:19], s49 offen lds
    buffer_load_dwordx4 v43, s[16:19], s49 offen offset:1024 lds
    buffer_load_dwordx4 v44, s[16:19], s49 offen offset:2048 lds
    buffer_load_dwordx4 v45, s[16:19], s49 offen offset:3072 lds
    s_add_u32 s49, s44, 1048832
    s_add_u32 m0, s42, 114688
    s_nop 0
    buffer_load_dwordx4 v42, s[16:19], s49 offen lds
    buffer_load_dwordx4 v43, s[16:19], s49 offen offset:1024 lds
    buffer_load_dwordx4 v44, s[16:19], s49 offen offset:2048 lds
    buffer_load_dwordx4 v45, s[16:19], s49 offen offset:3072 lds
    s_mov_b32 s38, 16384
Lhead_pollh:
    buffer_load_dword v75, v73, s[24:27], s36 offen sc1
    s_sub_u32 s38, s38, 1
    s_cbranch_scc1 Lhead_goth
    s_waitcnt vmcnt(0) lgkmcnt(0)
    v_cmp_ne_u32 vcc, s95, v75
    s_cbranch_vccnz Lhead_pollh
Lhead_goth:
    s_waitcnt vmcnt(0) lgkmcnt(0)
    buffer_load_dwordx4 a[0:3], v51, s[24:27], s46 offen offset:0 sc1
    buffer_load_dwordx4 a[8:11], v51, s[24:27], s46 offen offset:128 sc1
    buffer_load_dwordx4 a[4:7], v51, s[24:27], s43 offen offset:0 sc1
    buffer_load_dwordx4 a[12:15], v51, s[24:27], s43 offen offset:128 sc1
    buffer_load_dwordx4 a[16:19], v51, s[24:27], s46 offen offset:256 sc1
    buffer_load_dwordx4 a[24:27], v51, s[24:27], s46 offen offset:384 sc1
    buffer_load_dwordx4 a[20:23], v51, s[24:27], s43 offen offset:256 sc1
    buffer_load_dwordx4 a[28:31], v51, s[24:27], s43 offen offset:384 sc1
    buffer_load_dwordx4 a[32:35], v51, s[24:27], s46 offen offset:512 sc1
    buffer_load_dwordx4 a[40:43], v51, s[24:27], s46 offen offset:640 sc1
    buffer_load_dwordx4 a[36:39], v51, s[24:27], s43 offen offset:512 sc1
    buffer_load_dwordx4 a[44:47], v51, s[24:27], s43 offen offset:640 sc1
    s_add_u32 s49, s44, 1572864
    s_add_u32 m0, s42, 131072
    s_nop 0
    buffer_load_dwordx4 v42, s[16:19], s49 offen lds
    buffer_load_dwordx4 v43, s[16:19], s49 offen offset:1024 lds
    buffer_load_dwordx4 v44, s[16:19], s49 offen offset:2048 lds
    buffer_load_dwordx4 v45, s[16:19], s49 offen offset:3072 lds
    s_add_u32 s49, s44, 1573120
    s_add_u32 m0, s42, 147456
    s_nop 0
    buffer_load_dwordx4 v42, s[16:19], s49 offen lds
    buffer_load_dwordx4 v43, s[16:19], s49 offen offset:1024 lds
    buffer_load_dwordx4 v44, s[16:19], s49 offen offset:2048 lds
    buffer_load_dwordx4 v45, s[16:19], s49 offen offset:3072 lds
    buffer_store_dwordx4 v[88:91], v74, s[24:27], 0 offen sc1
    s_add_u32 s36, s92, 2555904
    buffer_store_dwordx4 v[88:91], v67, s[24:27], s36 offen offset:0 sc1
    buffer_store_dwordx4 v[88:91], v67, s[24:27], s36 offen offset:768 sc1
    buffer_store_dwordx4 v[88:91], v67, s[24:27], s36 offen offset:1536 sc1
    s_add_u32 s36, s92, 5177344
    buffer_store_dwordx4 v[88:91], v67, s[24:27], s36 offen offset:0 sc1
    buffer_store_dwordx4 v[88:91], v67, s[24:27], s36 offen offset:768 sc1
    buffer_store_dwordx4 v[88:91], v67, s[24:27], s36 offen offset:1536 sc1
    s_barrier
    ds_read_b64_tr_b16 a[160:161], v12 offset:32768
    ds_read_b64_tr_b16 a[162:163], v12 offset:36864
    ds_read_b64_tr_b16 a[164:165], v12 offset:40960
    ds_read_b64_tr_b16 a[166:167], v12 offset:45056
    ds_read_b64_tr_b16 a[168:169], v13 offset:32768
    ds_read_b64_tr_b16 a[170:171], v13 offset:36864
    ds_read_b64_tr_b16 a[172:173], v13 offset:40960
    ds_read_b64_tr_b16 a[174:175], v13 offset:45056
    ds_read_b64_tr_b16 a[176:177], v14 offset:32768
    ds_read_b64_tr_b16 a[178:179], v14 offset:36864
    ds_read_b64_tr_b16 a[180:181], v14 offset:40960
    ds_read_b64_tr_b16 a[182:183], v14 offset:45056
    s_waitcnt lgkmcnt(10)
    s_waitcnt vmcnt(26)
    v_mfma_f32_16x16x32_bf16 v[128:131], a[160:163], a[0:3], 0
    s_waitcnt vmcnt(25)
    s_waitcnt lgkmcnt(8)
    ds_read_b64_tr_b16 a[184:185], v15 offset:32768
    v_mfma_f32_16x16x32_bf16 v[128:131], a[164:167], a[8:11], v[128:131]
    s_waitcnt vmcnt(24)
    ds_read_b64_tr_b16 a[186:187], v15 offset:36864
    v_mfma_f32_16x16x32_bf16 v[132:135], a[160:163], a[4:7], 0
    s_waitcnt vmcnt(23)
    ds_read_b64_tr_b16 a[188:189], v15 offset:40960
    v_mfma_f32_16x16x32_bf16 v[132:135], a[164:167], a[12:15], v[132:135]
    s_waitcnt lgkmcnt(9)
    buffer_load_dwordx4 a[48:51], v51, s[24:27], s46 offen offset:768 sc1
    v_mfma_f32_16x16x32_bf16 v[136:139], a[168:171], a[0:3], 0
    s_waitcnt lgkmcnt(7)
    ds_read_b64_tr_b16 a[190:191], v15 offset:45056
    ds_read_b64_tr_b16 a[160:161], v16 offset:32768
    v_mfma_f32_16x16x32_bf16 v[136:139], a[172:175], a[8:11], v[136:139]
    ds_read_b64_tr_b16 a[162:163], v16 offset:36864
    v_mfma_f32_16x16x32_bf16 v[140:143], a[168:171], a[4:7], 0
    ds_read_b64_tr_b16 a[164:165], v16 offset:40960
    v_mfma_f32_16x16x32_bf16 v[140:143], a[172:175], a[12:15], v[140:143]
    s_waitcnt lgkmcnt(9)
    buffer_load_dwordx4 a[56:59], v51, s[24:27], s46 offen offset:896 sc1
    v_mfma_f32_16x16x32_bf16 v[144:147], a[176:179], a[0:3], 0
    s_waitcnt lgkmcnt(7)
    ds_read_b64_tr_b16 a[166:167], v16 offset:45056
    ds_read_b64_tr_b16 a[168:169], v17 offset:32768
    v_mfma_f32_16x16x32_bf16 v[144:147], a[180:183], a[8:11], v[144:147]
    ds_read_b64_tr_b16 a[170:171], v17 offset:36864
    v_mfma_f32_16x16x32_bf16 v[148:151], a[176:179], a[4:7], 0
    ds_read_b64_tr_b16 a[172:173], v17 offset:40960
    v_mfma_f32_16x16x32_bf16 v[148:151], a[180:183], a[12:15], v[148:151]
    s_waitcnt lgkmcnt(9)
    buffer_load_dwordx4 a[52:55], v51, s[24:27], s43 offen offset:768 sc1
    v_mfma_f32_16x16x32_bf16 v[152:155], a[184:187], a[0:3], 0
    s_waitcnt lgkmcnt(7)
    ds_read_b64_tr_b16 a[174:175], v17 offset:45056
    ds_read_b64_tr_b16 a[176:177], v18 offset:32768
    v_mfma_f32_16x16x32_bf16 v[152:155], a[188:191], a[8:11], v[152:155]
    ds_read_b64_tr_b16 a[178:179], v18 offset:36864
    v_mfma_f32_16x16x32_bf16 v[156:159], a[184:187], a[4:7], 0
    ds_read_b64_tr_b16 a[180:181], v18 offset:40960
    v_mfma_f32_16x16x32_bf16 v[156:159], a[188:191], a[12:15], v[156:159]
    s_waitcnt lgkmcnt(9)
    buffer_load_dwordx4 a[60:63], v51, s[24:27], s43 offen offset:896 sc1
    v_mfma_f32_16x16x32_bf16 v[160:163], a[160:163], a[0:3], 0
    s_waitcnt lgkmcnt(7)
    ds_read_b64_tr_b16 a[182:183], v18 offset:45056
    ds_read_b64_tr_b16 a[184:185], v19 offset:32768
    v_mfma_f32_16x16x32_bf16 v[160:163], a[164:167], a[8:11], v[160:163]
    s_add_u32 s49, s44, 2097152
    ds_read_b64_tr_b16 a[186:187], v19 offset:36864
    v_mfma_f32_16x16x32_bf16 v[164:167], a[160:163], a[4:7], 0
    s_add_u32 m0, s42, 0
    ds_read_b64_tr_b16 a[188:189], v19 offset:40960
    v_mfma_f32_16x16x32_bf16 v[164:167], a[164:167], a[12:15], v[164:167]
    s_waitcnt lgkmcnt(9)
    buffer_load_dwordx4 v42, s[16:19], s49 offen lds
    v_mfma_f32_16x16x32_bf16 v[168:171], a[168:171], a[0:3], 0
    s_waitcnt lgkmcnt(7)
    ds_read_b64_tr_b16 a[190:191], v19 offset:45056
    ds_read_b64_tr_b16 a[160:161], v12 offset:49152
    v_mfma_f32_16x16x32_bf16 v[168:171], a[172:175], a[8:11], v[168:171]
    ds_read_b64_tr_b16 a[162:163], v12 offset:53248
    v_mfma_f32_16x16x32_bf16 v[172:175], a[168:171], a[4:7], 0
    ds_read_b64_tr_b16 a[164:165], v12 offset:57344
    v_mfma_f32_16x16x32_bf16 v[172:175], a[172:175], a[12:15], v[172:175]
    s_waitcnt lgkmcnt(9)
    buffer_load_dwordx4 v43, s[16:19], s49 offen offset:1024 lds
    v_mfma_f32_16x16x32_bf16 v[176:179], a[176:179], a[0:3], 0
    s_waitcnt lgkmcnt(7)
    ds_read_b64_tr_b16 a[166:167], v12 offset:61440
    ds_read_b64_tr_b16 a[168:169], v13 offset:49152
    v_mfma_f32_16x16x32_bf16 v[176:179], a[180:183], a[8:11], v[176:179]
    ds_read_b64_tr_b16 a[170:171], v13 offset:53248
    v_mfma_f32_16x16x32_bf16 v[180:183], a[176:179], a[4:7], 0
    ds_read_b64_tr_b16 a[172:173], v13 offset:57344
    v_mfma_f32_16x16x32_bf16 v[180:183], a[180:183], a[12:15], v[180:183]
    s_waitcnt lgkmcnt(9)
    buffer_load_dwordx4 v44, s[16:19], s49 offen offset:2048 lds
    v_mfma_f32_16x16x32_bf16 v[184:187], a[184:187], a[0:3], 0
    s_waitcnt lgkmcnt(7)
    ds_read_b64_tr_b16 a[174:175], v13 offset:61440
    ds_read_b64_tr_b16 a[176:177], v14 offset:49152
    v_mfma_f32_16x16x32_bf16 v[184:187], a[188:191], a[8:11], v[184:187]
    ds_read_b64_tr_b16 a[178:179], v14 offset:53248
    v_mfma_f32_16x16x32_bf16 v[188:191], a[184:187], a[4:7], 0
    ds_read_b64_tr_b16 a[180:181], v14 offset:57344
    v_mfma_f32_16x16x32_bf16 v[188:191], a[188:191], a[12:15], v[188:191]
    s_waitcnt lgkmcnt(9)
    buffer_load_dwordx4 v45, s[16:19], s49 offen offset:3072 lds
    v_mfma_f32_16x16x32_bf16 v[192:195], a[160:163], a[0:3], 0
    s_waitcnt lgkmcnt(7)
    ds_read_b64_tr_b16 a[182:183], v14 offset:61440
    ds_read_b64_tr_b16 a[184:185], v15 offset:49152
    v_mfma_f32_16x16x32_bf16 v[192:195], a[164:167], a[8:11], v[192:195]
    s_add_u32 s49, s44, 2097408
    ds_read_b64_tr_b16 a[186:187], v15 offset:53248
    v_mfma_f32_16x16x32_bf16 v[196:199], a[160:163], a[4:7], 0
    s_add_u32 m0, s42, 16384
    ds_read_b64_tr_b16 a[188:189], v15 offset:57344
    v_mfma_f32_16x16x32_bf16 v[196:199], a[164:167], a[12:15], v[196:199]
    s_waitcnt lgkmcnt(9)
    buffer_load_dwordx4 v42, s[16:19], s49 offen lds
    v_mfma_f32_16x16x32_bf16 v[200:203], a[168:171], a[0:3], 0
    s_waitcnt lgkmcnt(7)
    ds_read_b64_tr_b16 a[190:191], v15 offset:61440
    ds_read_b64_tr_b16 a[160:161], v16 offset:49152
    v_mfma_f32_16x16x32_bf16 v[200:203], a[172:175], a[8:11], v[200:203]
    ds_read_b64_tr_b16 a[162:163], v16 offset:53248
    v_mfma_f32_16x16x32_bf16 v[204:207], a[168:171], a[4:7], 0
    ds_read_b64_tr_b16 a[164:165], v16 offset:57344
    v_mfma_f32_16x16x32_bf16 v[204:207], a[172:175], a[12:15], v[204:207]
    s_waitcnt lgkmcnt(9)
    buffer_load_dwordx4 v43, s[16:19], s49 offen offset:1024 lds
    v_mfma_f32_16x16x32_bf16 v[208:211], a[176:179], a[0:3], 0
    s_waitcnt lgkmcnt(7)
    ds_read_b64_tr_b16 a[166:167], v16 offset:61440
    ds_read_b64_tr_b16 a[168:169], v17 offset:49152
    v_mfma_f32_16x16x32_bf16 v[208:211], a[180:183], a[8:11], v[208:211]
    ds_read_b64_tr_b16 a[170:171], v17 offset:53248
    v_mfma_f32_16x16x32_bf16 v[212:215], a[176:179], a[4:7], 0
    ds_read_b64_tr_b16 a[172:173], v17 offset:57344
    v_mfma_f32_16x16x32_bf16 v[212:215], a[180:183], a[12:15], v[212:215]
    s_waitcnt lgkmcnt(9)
    buffer_load_dwordx4 v44, s[16:19], s49 offen offset:2048 lds
    v_mfma_f32_16x16x32_bf16 v[216:219], a[184:187], a[0:3], 0
    s_waitcnt lgkmcnt(7)
    ds_read_b64_tr_b16 a[174:175], v17 offset:61440
    ds_read_b64_tr_b16 a[176:177], v18 offset:49152
    v_mfma_f32_16x16x32_bf16 v[216:219], a[188:191], a[8:11], v[216:219]
    ds_read_b64_tr_b16 a[178:179], v18 offset:53248
    v_mfma_f32_16x16x32_bf16 v[220:223], a[184:187], a[4:7], 0
    ds_read_b64_tr_b16 a[180:181], v18 offset:57344
    v_mfma_f32_16x16x32_bf16 v[220:223], a[188:191], a[12:15], v[220:223]
    s_waitcnt lgkmcnt(9)
    buffer_load_dwordx4 v45, s[16:19], s49 offen offset:3072 lds
    v_mfma_f32_16x16x32_bf16 v[224:227], a[160:163], a[0:3], 0
    s_waitcnt lgkmcnt(7)
    ds_read_b64_tr_b16 a[182:183], v18 offset:61440
    ds_read_b64_tr_b16 a[184:185], v19 offset:49152
    v_mfma_f32_16x16x32_bf16 v[224:227], a[164:167], a[8:11], v[224:227]
    ds_read_b64_tr_b16 a[186:187], v19 offset:53248
    v_mfma_f32_16x16x32_bf16 v[228:231], a[160:163], a[4:7], 0
    ds_read_b64_tr_b16 a[188:189], v19 offset:57344
    v_mfma_f32_16x16x32_bf16 v[228:231], a[164:167], a[12:15], v[228:231]
    s_waitcnt lgkmcnt(9)
    ds_read_b64_tr_b16 a[190:191], v19 offset:61440
    s_barrier
    v_mfma_f32_16x16x32_bf16 v[232:235], a[168:171], a[0:3], 0
    s_waitcnt lgkmcnt(8)
    ds_read_b64_tr_b16 a[160:161], v20 offset:0
    v_mfma_f32_16x16x32_bf16 v[232:235], a[172:175], a[8:11], v[232:235]
    ds_read_b64_tr_b16 a[162:163], v20 offset:4096
    v_mfma_f32_16x16x32_bf16 v[236:239], a[168:171], a[4:7], 0
    ds_read_b64_tr_b16 a[164:165], v20 offset:8192
    v_mfma_f32_16x16x32_bf16 v[236:239], a[172:175], a[12:15], v[236:239]
    s_waitcnt lgkmcnt(9)
    buffer_load_dwordx4 a[64:67], v51, s[24:27], s46 offen offset:1024 sc1
    v_mfma_f32_16x16x32_bf16 v[240:243], a[176:179], a[0:3], 0
    s_waitcnt lgkmcnt(7)
    ds_read_b64_tr_b16 a[166:167], v20 offset:12288
    ds_read_b64_tr_b16 a[168:169], v21 offset:0
    v_mfma_f32_16x16x32_bf16 v[240:243], a[180:183], a[8:11], v[240:243]
    ds_read_b64_tr_b16 a[170:171], v21 offset:4096
    v_mfma_f32_16x16x32_bf16 v[244:247], a[176:179], a[4:7], 0
    ds_read_b64_tr_b16 a[172:173], v21 offset:8192
    v_mfma_f32_16x16x32_bf16 v[244:247], a[180:183], a[12:15], v[244:247]
    s_waitcnt lgkmcnt(9)
    buffer_load_dwordx4 a[72:75], v51, s[24:27], s46 offen offset:1152 sc1
    v_mfma_f32_16x16x32_bf16 v[248:251], a[184:187], a[0:3], 0
    s_waitcnt lgkmcnt(7)
    ds_read_b64_tr_b16 a[174:175], v21 offset:12288
    ds_read_b64_tr_b16 a[176:177], v22 offset:0
    v_mfma_f32_16x16x32_bf16 v[248:251], a[188:191], a[8:11], v[248:251]
    ds_read_b64_tr_b16 a[178:179], v22 offset:4096
    v_mfma_f32_16x16x32_bf16 v[252:255], a[184:187], a[4:7], 0
    ds_read_b64_tr_b16 a[180:181], v22 offset:8192
    v_mfma_f32_16x16x32_bf16 v[252:255], a[188:191], a[12:15], v[252:255]
    s_waitcnt vmcnt(36)
    s_waitcnt lgkmcnt(9)
    buffer_load_dwordx4 a[68:71], v51, s[24:27], s43 offen offset:1024 sc1
    v_mfma_f32_16x16x32_bf16 v[128:131], a[160:163], a[16:19], v[128:131]
    s_waitcnt vmcnt(36)
    s_waitcnt lgkmcnt(7)
    ds_read_b64_tr_b16 a[182:183], v22 offset:12288
    ds_read_b64_tr_b16 a[184:185], v23 offset:0
    v_mfma_f32_16x16x32_bf16 v[128:131], a[164:167], a[24:27], v[128:131]
    s_waitcnt vmcnt(35)
    ds_read_b64_tr_b16 a[186:187], v23 offset:4096
    v_mfma_f32_16x16x32_bf16 v[132:135], a[160:163], a[20:23], v[132:135]
    s_waitcnt vmcnt(34)
    ds_read_b64_tr_b16 a[188:189], v23 offset:8192
    v_mfma_f32_16x16x32_bf16 v[132:135], a[164:167], a[28:31], v[132:135]
    s_waitcnt lgkmcnt(9)
    buffer_load_dwordx4 a[76:79], v51, s[24:27], s43 offen offset:1152 sc1
    v_mfma_f32_16x16x32_bf16 v[136:139], a[168:171], a[16:19], v[136:139]
    s_waitcnt lgkmcnt(7)
    ds_read_b64_tr_b16 a[190:191], v23 offset:12288
    ds_read_b64_tr_b16 a[160:161], v24 offset:0
    v_mfma_f32_16x16x32_bf16 v[136:139], a[172:175], a[24:27], v[136:139]
    ds_read_b64_tr_b16 a[162:163], v24 offset:4096
    v_mfma_f32_16x16x32_bf16 v[140:143], a[168:171], a[20:23], v[140:143]
    ds_read_b64_tr_b16 a[164:165], v24 offset:8192
    v_mfma_f32_16x16x32_bf16 v[140:143], a[172:175], a[28:31], v[140:143]
    s_waitcnt lgkmcnt(9)
    buffer_load_dwordx4 a[80:83], v51, s[24:27], s46 offen offset:1280 sc1
    v_mfma_f32_16x16x32_bf16 v[144:147], a[176:179], a[16:19], v[144:147]
    s_waitcnt lgkmcnt(7)
    ds_read_b64_tr_b16 a[166:167], v24 offset:12288
    ds_read_b64_tr_b16 a[168:169], v25 offset:0
    v_mfma_f32_16x16x32_bf16 v[144:147], a[180:183], a[24:27], v[144:147]
    ds_read_b64_tr_b16 a[170:171], v25 offset:4096
    v_mfma_f32_16x16x32_bf16 v[148:151], a[176:179], a[20:23], v[148:151]
    ds_read_b64_tr_b16 a[172:173], v25 offset:8192
    v_mfma_f32_16x16x32_bf16 v[148:151], a[180:183], a[28:31], v[148:151]
    s_waitcnt lgkmcnt(9)
    buffer_load_dwordx4 a[88:91], v51, s[24:27], s46 offen offset:1408 sc1
    v_mfma_f32_16x16x32_bf16 v[152:155], a[184:187], a[16:19], v[152:155]
    s_waitcnt lgkmcnt(7)
    ds_read_b64_tr_b16 a[174:175], v25 offset:12288
    ds_read_b64_tr_b16 a[176:177], v26 offset:0
    v_mfma_f32_16x16x32_bf16 v[152:155], a[188:191], a[24:27], v[152:155]
    ds_read_b64_tr_b16 a[178:179], v26 offset:4096
    v_mfma_f32_16x16x32_bf16 v[156:159], a[184:187], a[20:23], v[156:159]
    ds_read_b64_tr_b16 a[180:181], v26 offset:8192
    v_mfma_f32_16x16x32_bf16 v[156:159], a[188:191], a[28:31], v[156:159]
    s_waitcnt lgkmcnt(9)
    buffer_load_dwordx4 a[84:87], v51, s[24:27], s43 offen offset:1280 sc1
    v_mfma_f32_16x16x32_bf16 v[160:163], a[160:163], a[16:19], v[160:163]
    s_waitcnt lgkmcnt(7)
    ds_read_b64_tr_b16 a[182:183], v26 offset:12288
    ds_read_b64_tr_b16 a[184:185], v27 offset:0
    v_mfma_f32_16x16x32_bf16 v[160:163], a[164:167], a[24:27], v[160:163]
    ds_read_b64_tr_b16 a[186:187], v27 offset:4096
    v_mfma_f32_16x16x32_bf16 v[164:167], a[160:163], a[20:23], v[164:167]
    ds_read_b64_tr_b16 a[188:189], v27 offset:8192
    v_mfma_f32_16x16x32_bf16 v[164:167], a[164:167], a[28:31], v[164:167]
    s_waitcnt lgkmcnt(9)
    buffer_load_dwordx4 a[92:95], v51, s[24:27], s43 offen offset:1408 sc1
    v_mfma_f32_16x16x32_bf16 v[168:171], a[168:171], a[16:19], v[168:171]
    s_waitcnt lgkmcnt(7)
    ds_read_b64_tr_b16 a[190:191], v27 offset:12288
    ds_read_b64_tr_b16 a[160:161], v20 offset:16384
    v_mfma_f32_16x16x32_bf16 v[168:171], a[172:175], a[24:27], v[168:171]
    ds_read_b64_tr_b16 a[162:163], v20 offset:20480
    v_mfma_f32_16x16x32_bf16 v[172:175], a[168:171], a[20:23], v[172:175]
    ds_read_b64_tr_b16 a[164:165], v20 offset:24576
    v_mfma_f32_16x16x32_bf16 v[172:175], a[172:175], a[28:31], v[172:175]
    s_waitcnt lgkmcnt(9)
    buffer_load_dwordx4 a[96:99], v51, s[24:27], s46 offen offset:1536 sc1
    v_mfma_f32_16x16x32_bf16 v[176:179], a[176:179], a[16:19], v[176:179]
    s_waitcnt lgkmcnt(7)
    ds_read_b64_tr_b16 a[166:167], v20 offset:28672
    ds_read_b64_tr_b16 a[168:169], v21 offset:16384
    v_mfma_f32_16x16x32_bf16 v[176:179], a[180:183], a[24:27], v[176:179]
    ds_read_b64_tr_b16 a[170:171], v21 offset:20480
    v_mfma_f32_16x16x32_bf16 v[180:183], a[176:179], a[20:23], v[180:183]
    ds_read_b64_tr_b16 a[172:173], v21 offset:24576
    v_mfma_f32_16x16x32_bf16 v[180:183], a[180:183], a[28:31], v[180:183]
    s_waitcnt lgkmcnt(9)
    buffer_load_dwordx4 a[104:107], v51, s[24:27], s46 offen offset:1664 sc1
    v_mfma_f32_16x16x32_bf16 v[184:187], a[184:187], a[16:19], v[184:187]
    s_waitcnt lgkmcnt(7)
    ds_read_b64_tr_b16 a[174:175], v21 offset:28672
    ds_read_b64_tr_b16 a[176:177], v22 offset:16384
    v_mfma_f32_16x16x32_bf16 v[184:187], a[188:191], a[24:27], v[184:187]
    ds_read_b64_tr_b16 a[178:179], v22 offset:20480
    v_mfma_f32_16x16x32_bf16 v[188:191], a[184:187], a[20:23], v[188:191]
    ds_read_b64_tr_b16 a[180:181], v22 offset:24576
    v_mfma_f32_16x16x32_bf16 v[188:191], a[188:191], a[28:31], v[188:191]
    s_waitcnt lgkmcnt(9)
    buffer_load_dwordx4 a[100:103], v51, s[24:27], s43 offen offset:1536 sc1
    v_mfma_f32_16x16x32_bf16 v[192:195], a[160:163], a[16:19], v[192:195]
    s_waitcnt lgkmcnt(7)
    ds_read_b64_tr_b16 a[182:183], v22 offset:28672
    ds_read_b64_tr_b16 a[184:185], v23 offset:16384
    v_mfma_f32_16x16x32_bf16 v[192:195], a[164:167], a[24:27], v[192:195]
    ds_read_b64_tr_b16 a[186:187], v23 offset:20480
    v_mfma_f32_16x16x32_bf16 v[196:199], a[160:163], a[20:23], v[196:199]
    ds_read_b64_tr_b16 a[188:189], v23 offset:24576
    v_mfma_f32_16x16x32_bf16 v[196:199], a[164:167], a[28:31], v[196:199]
    s_waitcnt lgkmcnt(9)
    buffer_load_dwordx4 a[108:111], v51, s[24:27], s43 offen offset:1664 sc1
    v_mfma_f32_16x16x32_bf16 v[200:203], a[168:171], a[16:19], v[200:203]
    s_waitcnt lgkmcnt(7)
    ds_read_b64_tr_b16 a[190:191], v23 offset:28672
    ds_read_b64_tr_b16 a[160:161], v24 offset:16384
    v_mfma_f32_16x16x32_bf16 v[200:203], a[172:175], a[24:27], v[200:203]
    ds_read_b64_tr_b16 a[162:163], v24 offset:20480
    v_mfma_f32_16x16x32_bf16 v[204:207], a[168:171], a[20:23], v[204:207]
    ds_read_b64_tr_b16 a[164:165], v24 offset:24576
    v_mfma_f32_16x16x32_bf16 v[204:207], a[172:175], a[28:31], v[204:207]
    s_waitcnt lgkmcnt(9)
    ds_read_b64_tr_b16 a[166:167], v24 offset:28672
    v_mfma_f32_16x16x32_bf16 v[208:211], a[176:179], a[16:19], v[208:211]
    s_waitcnt lgkmcnt(8)
    ds_read_b64_tr_b16 a[168:169], v25 offset:16384
    v_mfma_f32_16x16x32_bf16 v[208:211], a[180:183], a[24:27], v[208:211]
    ds_read_b64_tr_b16 a[170:171], v25 offset:20480
    v_mfma_f32_16x16x32_bf16 v[212:215], a[176:179], a[20:23], v[212:215]
    ds_read_b64_tr_b16 a[172:173], v25 offset:24576
    v_mfma_f32_16x16x32_bf16 v[212:215], a[180:183], a[28:31], v[212:215]
    s_waitcnt lgkmcnt(9)
    ds_read_b64_tr_b16 a[174:175], v25 offset:28672
    v_mfma_f32_16x16x32_bf16 v[216:219], a[184:187], a[16:19], v[216:219]
    s_waitcnt lgkmcnt(8)
    ds_read_b64_tr_b16 a[176:177], v26 offset:16384
    v_mfma_f32_16x16x32_bf16 v[216:219], a[188:191], a[24:27], v[216:219]
    ds_read_b64_tr_b16 a[178:179], v26 offset:20480
    v_mfma_f32_16x16x32_bf16 v[220:223], a[184:187], a[20:23], v[220:223]
    ds_read_b64_tr_b16 a[180:181], v26 offset:24576
    v_mfma_f32_16x16x32_bf16 v[220:223], a[188:191], a[28:31], v[220:223]
    s_waitcnt lgkmcnt(9)
    ds_read_b64_tr_b16 a[182:183], v26 offset:28672
    v_mfma_f32_16x16x32_bf16 v[224:227], a[160:163], a[16:19], v[224:227]
    s_waitcnt lgkmcnt(8)
    ds_read_b64_tr_b16 a[184:185], v27 offset:16384
    v_mfma_f32_16x16x32_bf16 v[224:227], a[164:167], a[24:27], v[224:227]
Ltour0:
    s_cbranch_execz Ltour4
    ds_read_b64_tr_b16 a[186:187], v27 offset:20480
    v_mfma_f32_16x16x32_bf16 v[228:231], a[160:163], a[20:23], v[228:231]
    ds_read_b64_tr_b16 a[188:189], v27 offset:24576
    v_mfma_f32_16x16x32_bf16 v[228:231], a[164:167], a[28:31], v[228:231]
    s_waitcnt lgkmcnt(9)
    ds_read_b64_tr_b16 a[190:191], v27 offset:28672
    s_barrier
    v_mfma_f32_16x16x32_bf16 v[232:235], a[168:171], a[16:19], v[232:235]
    s_waitcnt lgkmcnt(8)
    ds_read_b64_tr_b16 a[160:161], v20 offset:32768
    v_mfma_f32_16x16x32_bf16 v[232:235], a[172:175], a[24:27], v[232:235]
    ds_read_b64_tr_b16 a[162:163], v20 offset:36864
    v_mfma_f32_16x16x32_bf16 v[236:239], a[168:171], a[20:23], v[236:239]
    ds_read_b64_tr_b16 a[164:165], v20 offset:40960
    v_mfma_f32_16x16x32_bf16 v[236:239], a[172:175], a[28:31], v[236:239]
    s_waitcnt lgkmcnt(9)
    buffer_load_dwordx4 a[112:115], v51, s[24:27], s46 offen offset:1792 sc1
    v_mfma_f32_16x16x32_bf16 v[240:243], a[176:179], a[16:19], v[240:243]
    s_waitcnt lgkmcnt(7)
    ds_read_b64_tr_b16 a[166:167], v20 offset:45056
    ds_read_b64_tr_b16 a[168:169], v21 offset:32768
    v_mfma_f32_16x16x32_bf16 v[240:243], a[180:183], a[24:27], v[240:243]
    ds_read_b64_tr_b16 a[170:171], v21 offset:36864
    v_mfma_f32_16x16x32_bf16 v[244:247], a[176:179], a[20:23], v[244:247]
    ds_read_b64_tr_b16 a[172:173], v21 offset:40960
    v_mfma_f32_16x16x32_bf16 v[244:247], a[180:183], a[28:31], v[244:247]
    s_waitcnt lgkmcnt(9)
    buffer_load_dwordx4 a[120:123], v51, s[24:27], s46 offen offset:1920 sc1
    v_mfma_f32_16x16x32_bf16 v[248:251], a[184:187], a[16:19], v[248:251]
    s_waitcnt lgkmcnt(7)
    ds_read_b64_tr_b16 a[174:175], v21 offset:45056
    ds_read_b64_tr_b16 a[176:177], v22 offset:32768
    v_mfma_f32_16x16x32_bf16 v[248:251], a[188:191], a[24:27], v[248:251]
    ds_read_b64_tr_b16 a[178:179], v22 offset:36864
    v_mfma_f32_16x16x32_bf16 v[252:255], a[184:187], a[20:23], v[252:255]
    ds_read_b64_tr_b16 a[180:181], v22 offset:40960
    v_mfma_f32_16x16x32_bf16 v[252:255], a[188:191], a[28:31], v[252:255]
    s_waitcnt vmcnt(44)
    s_waitcnt lgkmcnt(9)
    buffer_load_dwordx4 a[116:119], v51, s[24:27], s43 offen offset:1792 sc1
    v_mfma_f32_16x16x32_bf16 v[128:131], a[160:163], a[32:35], v[128:131]
    s_waitcnt vmcnt(44)
    s_waitcnt lgkmcnt(7)
    ds_read_b64_tr_b16 a[182:183], v22 offset:45056
    ds_read_b64_tr_b16 a[184:185], v23 offset:32768
    v_mfma_f32_16x16x32_bf16 v[128:131], a[164:167], a[40:43], v[128:131]
    s_waitcnt vmcnt(43)
    ds_read_b64_tr_b16 a[186:187], v23 offset:36864
    v_mfma_f32_16x16x32_bf16 v[132:135], a[160:163], a[36:39], v[132:135]
    s_waitcnt vmcnt(42)
    ds_read_b64_tr_b16 a[188:189], v23 offset:40960
    v_mfma_f32_16x16x32_bf16 v[132:135], a[164:167], a[44:47], v[132:135]
    s_waitcnt lgkmcnt(9)
    buffer_load_dwordx4 a[124:127], v51, s[24:27], s43 offen offset:1920 sc1
    v_mfma_f32_16x16x32_bf16 v[136:139], a[168:171], a[32:35], v[136:139]
    s_waitcnt lgkmcnt(7)
    ds_read_b64_tr_b16 a[190:191], v23 offset:45056
    ds_read_b64_tr_b16 a[160:161], v24 offset:32768
    v_mfma_f32_16x16x32_bf16 v[136:139], a[172:175], a[40:43], v[136:139]
    s_add_u32 s49, s44, 2621440
    ds_read_b64_tr_b16 a[162:163], v24 offset:36864
    v_mfma_f32_16x16x32_bf16 v[140:143], a[168:171], a[36:39], v[140:143]
    s_add_u32 m0, s42, 32768
    ds_read_b64_tr_b16 a[164:165], v24 offset:40960
    v_mfma_f32_16x16x32_bf16 v[140:143], a[172:175], a[44:47], v[140:143]
    s_waitcnt lgkmcnt(9)
    buffer_load_dwordx4 v42, s[16:19], s49 offen lds
    v_mfma_f32_16x16x32_bf16 v[144:147], a[176:179], a[32:35], v[144:147]
    s_waitcnt lgkmcnt(7)
    ds_read_b64_tr_b16 a[166:167], v24 offset:45056
    ds_read_b64_tr_b16 a[168:169], v25 offset:32768
    v_mfma_f32_16x16x32_bf16 v[144:147], a[180:183], a[40:43], v[144:147]
    ds_read_b64_tr_b16 a[170:171], v25 offset:36864
    v_mfma_f32_16x16x32_bf16 v[148:151], a[176:179], a[36:39], v[148:151]
    ds_read_b64_tr_b16 a[172:173], v25 offset:40960
    v_mfma_f32_16x16x32_bf16 v[148:151], a[180:183], a[44:47], v[148:151]
    s_waitcnt lgkmcnt(9)
    buffer_load_dwordx4 v43, s[16:19], s49 offen offset:1024 lds
    v_mfma_f32_16x16x32_bf16 v[152:155], a[184:187], a[32:35], v[152:155]
    s_waitcnt lgkmcnt(7)
    ds_read_b64_tr_b16 a[174:175], v25 offset:45056
    ds_read_b64_tr_b16 a[176:177], v26 offset:32768
    v_mfma_f32_16x16x32_bf16 v[152:155], a[188:191], a[40:43], v[152:155]
    ds_read_b64_tr_b16 a[178:179], v26 offset:36864
    v_mfma_f32_16x16x32_bf16 v[156:159], a[184:187], a[36:39], v[156:159]
    ds_read_b64_tr_b16 a[180:181], v26 offset:40960
    v_mfma_f32_16x16x32_bf16 v[156:159], a[188:191], a[44:47], v[156:159]
    s_waitcnt lgkmcnt(9)
    buffer_load_dwordx4 v44, s[16:19], s49 offen offset:2048 lds
    v_mfma_f32_16x16x32_bf16 v[160:163], a[160:163], a[32:35], v[160:163]
    s_waitcnt lgkmcnt(7)
    ds_read_b64_tr_b16 a[182:183], v26 offset:45056
    ds_read_b64_tr_b16 a[184:185], v27 offset:32768
    v_mfma_f32_16x16x32_bf16 v[160:163], a[164:167], a[40:43], v[160:163]
    ds_read_b64_tr_b16 a[186:187], v27 offset:36864
    v_mfma_f32_16x16x32_bf16 v[164:167], a[160:163], a[36:39], v[164:167]
    ds_read_b64_tr_b16 a[188:189], v27 offset:40960
    v_mfma_f32_16x16x32_bf16 v[164:167], a[164:167], a[44:47], v[164:167]
    s_waitcnt lgkmcnt(9)
    buffer_load_dwordx4 v45, s[16:19], s49 offen offset:3072 lds
    v_mfma_f32_16x16x32_bf16 v[168:171], a[168:171], a[32:35], v[168:171]
    s_waitcnt lgkmcnt(7)
    ds_read_b64_tr_b16 a[190:191], v27 offset:45056
    ds_read_b64_tr_b16 a[160:161], v20 offset:49152
    v_mfma_f32_16x16x32_bf16 v[168:171], a[172:175], a[40:43], v[168:171]
    s_add_u32 s49, s44, 2621696
    ds_read_b64_tr_b16 a[162:163], v20 offset:53248
    v_mfma_f32_16x16x32_bf16 v[172:175], a[168:171], a[36:39], v[172:175]
    s_add_u32 m0, s42, 49152
    ds_read_b64_tr_b16 a[164:165], v20 offset:57344
    v_mfma_f32_16x16x32_bf16 v[172:175], a[172:175], a[44:47], v[172:175]
    s_waitcnt lgkmcnt(9)
    buffer_load_dwordx4 v42, s[16:19], s49 offen lds
    v_mfma_f32_16x16x32_bf16 v[176:179], a[176:179], a[32:35], v[176:179]
    s_waitcnt lgkmcnt(7)
    ds_read_b64_tr_b16 a[166:167], v20 offset:61440
    ds_read_b64_tr_b16 a[168:169], v21 offset:49152
    v_mfma_f32_16x16x32_bf16 v[176:179], a[180:183], a[40:43], v[176:179]
    ds_read_b64_tr_b16 a[170:171], v21 offset:53248
    v_mfma_f32_16x16x32_bf16 v[180:183], a[176:179], a[36:39], v[180:183]
    ds_read_b64_tr_b16 a[172:173], v21 offset:57344
    v_mfma_f32_16x16x32_bf16 v[180:183], a[180:183], a[44:47], v[180:183]
    s_waitcnt lgkmcnt(9)
    buffer_load_dwordx4 v43, s[16:19], s49 offen offset:1024 lds
    v_mfma_f32_16x16x32_bf16 v[184:187], a[184:187], a[32:35], v[184:187]
    s_waitcnt lgkmcnt(7)
    ds_read_b64_tr_b16 a[174:175], v21 offset:61440
    ds_read_b64_tr_b16 a[176:177], v22 offset:49152
    v_mfma_f32_16x16x32_bf16 v[184:187], a[188:191], a[40:43], v[184:187]
    ds_read_b64_tr_b16 a[178:179], v22 offset:53248
    v_mfma_f32_16x16x32_bf16 v[188:191], a[184:187], a[36:39], v[188:191]
    ds_read_b64_tr_b16 a[180:181], v22 offset:57344
    v_mfma_f32_16x16x32_bf16 v[188:191], a[188:191], a[44:47], v[188:191]
    s_waitcnt lgkmcnt(9)
    buffer_load_dwordx4 v44, s[16:19], s49 offen offset:2048 lds
    v_mfma_f32_16x16x32_bf16 v[192:195], a[160:163], a[32:35], v[192:195]
    s_waitcnt lgkmcnt(7)
    ds_read_b64_tr_b16 a[182:183], v22 offset:61440
    ds_read_b64_tr_b16 a[184:185], v23 offset:49152
    v_mfma_f32_16x16x32_bf16 v[192:195], a[164:167], a[40:43], v[192:195]
    ds_read_b64_tr_b16 a[186:187], v23 offset:53248
    v_mfma_f32_16x16x32_bf16 v[196:199], a[160:163], a[36:39], v[196:199]
    ds_read_b64_tr_b16 a[188:189], v23 offset:57344
    v_mfma_f32_16x16x32_bf16 v[196:199], a[164:167], a[44:47], v[196:199]
    s_waitcnt lgkmcnt(9)
    buffer_load_dwordx4 v45, s[16:19], s49 offen offset:3072 lds
    v_mfma_f32_16x16x32_bf16 v[200:203], a[168:171], a[32:35], v[200:203]
    s_waitcnt lgkmcnt(7)
    ds_read_b64_tr_b16 a[190:191], v23 offset:61440
    ds_read_b64_tr_b16 a[160:161], v24 offset:49152
    v_mfma_f32_16x16x32_bf16 v[200:203], a[172:175], a[40:43], v[200:203]
    ds_read_b64_tr_b16 a[162:163], v24 offset:53248
    v_mfma_f32_16x16x32_bf16 v[204:207], a[168:171], a[36:39], v[204:207]
    ds_read_b64_tr_b16 a[164:165], v24 offset:57344
    v_mfma_f32_16x16x32_bf16 v[204:207], a[172:175], a[44:47], v[204:207]
    s_waitcnt lgkmcnt(9)
    ds_read_b64_tr_b16 a[166:167], v24 offset:61440
    v_mfma_f32_16x16x32_bf16 v[208:211], a[176:179], a[32:35], v[208:211]
    s_waitcnt lgkmcnt(8)
    ds_read_b64_tr_b16 a[168:169], v25 offset:49152
    v_mfma_f32_16x16x32_bf16 v[208:211], a[180:183], a[40:43], v[208:211]
    ds_read_b64_tr_b16 a[170:171], v25 offset:53248
    v_mfma_f32_16x16x32_bf16 v[212:215], a[176:179], a[36:39], v[212:215]
    ds_read_b64_tr_b16 a[172:173], v25 offset:57344
    v_mfma_f32_16x16x32_bf16 v[212:215], a[180:183], a[44:47], v[212:215]
    s_waitcnt lgkmcnt(9)
    ds_read_b64_tr_b16 a[174:175], v25 offset:61440
    v_mfma_f32_16x16x32_bf16 v[216:219], a[184:187], a[32:35], v[216:219]
    s_waitcnt lgkmcnt(8)
    ds_read_b64_tr_b16 a[176:177], v26 offset:49152
    v_mfma_f32_16x16x32_bf16 v[216:219], a[188:191], a[40:43], v[216:219]
    ds_read_b64_tr_b16 a[178:179], v26 offset:53248
    v_mfma_f32_16x16x32_bf16 v[220:223], a[184:187], a[36:39], v[220:223]
    ds_read_b64_tr_b16 a[180:181], v26 offset:57344
    v_mfma_f32_16x16x32_bf16 v[220:223], a[188:191], a[44:47], v[220:223]
    s_waitcnt lgkmcnt(9)
    ds_read_b64_tr_b16 a[182:183], v26 offset:61440
    v_mfma_f32_16x16x32_bf16 v[224:227], a[160:163], a[32:35], v[224:227]
    s_waitcnt lgkmcnt(8)
    ds_read_b64_tr_b16 a[184:185], v27 offset:49152
    v_mfma_f32_16x16x32_bf16 v[224:227], a[164:167], a[40:43], v[224:227]
    ds_read_b64_tr_b16 a[186:187], v27 offset:53248
    v_mfma_f32_16x16x32_bf16 v[228:231], a[160:163], a[36:39], v[228:231]
    ds_read_b64_tr_b16 a[188:189], v27 offset:57344
    v_mfma_f32_16x16x32_bf16 v[228:231], a[164:167], a[44:47], v[228:231]
    s_waitcnt lgkmcnt(9)
    ds_read_b64_tr_b16 a[190:191], v27 offset:61440
    s_waitcnt vmcnt(43)
    s_barrier
    v_mfma_f32_16x16x32_bf16 v[232:235], a[168:171], a[32:35], v[232:235]
    s_waitcnt lgkmcnt(8)
    ds_read_b64_tr_b16 a[160:161], v28 offset:0
    v_mfma_f32_16x16x32_bf16 v[232:235], a[172:175], a[40:43], v[232:235]
    ds_read_b64_tr_b16 a[162:163], v28 offset:4096
    v_mfma_f32_16x16x32_bf16 v[236:239], a[168:171], a[36:39], v[236:239]
    ds_read_b64_tr_b16 a[164:165], v28 offset:8192
    v_mfma_f32_16x16x32_bf16 v[236:239], a[172:175], a[44:47], v[236:239]
    s_waitcnt lgkmcnt(9)
    buffer_load_dwordx4 a[128:131], v51, s[24:27], s46 offen offset:2048 sc1
    v_mfma_f32_16x16x32_bf16 v[240:243], a[176:179], a[32:35], v[240:243]
    s_waitcnt lgkmcnt(7)
    ds_read_b64_tr_b16 a[166:167], v28 offset:12288
    ds_read_b64_tr_b16 a[168:169], v29 offset:0
    v_mfma_f32_16x16x32_bf16 v[240:243], a[180:183], a[40:43], v[240:243]
    ds_read_b64_tr_b16 a[170:171], v29 offset:4096
    v_mfma_f32_16x16x32_bf16 v[244:247], a[176:179], a[36:39], v[244:247]
    ds_read_b64_tr_b16 a[172:173], v29 offset:8192
    v_mfma_f32_16x16x32_bf16 v[244:247], a[180:183], a[44:47], v[244:247]
    s_waitcnt lgkmcnt(9)
    buffer_load_dwordx4 a[136:139], v51, s[24:27], s46 offen offset:2176 sc1
    v_mfma_f32_16x16x32_bf16 v[248:251], a[184:187], a[32:35], v[248:251]
    s_waitcnt lgkmcnt(7)
    ds_read_b64_tr_b16 a[174:175], v29 offset:12288
    ds_read_b64_tr_b16 a[176:177], v30 offset:0
    v_mfma_f32_16x16x32_bf16 v[248:251], a[188:191], a[40:43], v[248:251]
    ds_read_b64_tr_b16 a[178:179], v30 offset:4096
    v_mfma_f32_16x16x32_bf16 v[252:255], a[184:187], a[36:39], v[252:255]
    ds_read_b64_tr_b16 a[180:181], v30 offset:8192
    v_mfma_f32_16x16x32_bf16 v[252:255], a[188:191], a[44:47], v[252:255]
    s_waitcnt vmcnt(37)
    s_waitcnt lgkmcnt(9)
    buffer_load_dwordx4 a[132:135], v51, s[24:27], s43 offen offset:2048 sc1
    v_mfma_f32_16x16x32_bf16 v[128:131], a[160:163], a[48:51], v[128:131]
    s_waitcnt vmcnt(37)
    s_waitcnt lgkmcnt(7)
    ds_read_b64_tr_b16 a[182:183], v30 offset:12288
    ds_read_b64_tr_b16 a[184:185], v31 offset:0
    v_mfma_f32_16x16x32_bf16 v[128:131], a[164:167], a[56:59], v[128:131]
    s_waitcnt vmcnt(36)
    ds_read_b64_tr_b16 a[186:187], v31 offset:4096
    v_mfma_f32_16x16x32_bf16 v[132:135], a[160:163], a[52:55], v[132:135]
    s_waitcnt vmcnt(35)
    ds_read_b64_tr_b16 a[188:189], v31 offset:8192
    v_mfma_f32_16x16x32_bf16 v[132:135], a[164:167], a[60:63], v[132:135]
    s_waitcnt lgkmcnt(9)
    buffer_load_dwordx4 a[140:143], v51, s[24:27], s43 offen offset:2176 sc1
    v_mfma_f32_16x16x32_bf16 v[136:139], a[168:171], a[48:51], v[136:139]
    s_waitcnt lgkmcnt(7)
    ds_read_b64_tr_b16 a[190:191], v31 offset:12288
    ds_read_b64_tr_b16 a[160:161], v32 offset:0
    v_mfma_f32_16x16x32_bf16 v[136:139], a[172:175], a[56:59], v[136:139]
    s_add_u32 s49, s44, 3145728
    ds_read_b64_tr_b16 a[162:163], v32 offset:4096
    v_mfma_f32_16x16x32_bf16 v[140:143], a[168:171], a[52:55], v[140:143]
    s_add_u32 m0, s42, 65536
    ds_read_b64_tr_b16 a[164:165], v32 offset:8192
    v_mfma_f32_16x16x32_bf16 v[140:143], a[172:175], a[60:63], v[140:143]
    s_waitcnt lgkmcnt(9)
    buffer_load_dwordx4 v42, s[16:19], s49 offen lds
    v_mfma_f32_16x16x32_bf16 v[144:147], a[176:179], a[48:51], v[144:147]
    s_waitcnt lgkmcnt(7)
    ds_read_b64_tr_b16 a[166:167], v32 offset:12288
    ds_read_b64_tr_b16 a[168:169], v33 offset:0
    v_mfma_f32_16x16x32_bf16 v[144:147], a[180:183], a[56:59], v[144:147]
    ds_read_b64_tr_b16 a[170:171], v33 offset:4096
    v_mfma_f32_16x16x32_bf16 v[148:151], a[176:179], a[52:55], v[148:151]
    ds_read_b64_tr_b16 a[172:173], v33 offset:8192
    v_mfma_f32_16x16x32_bf16 v[148:151], a[180:183], a[60:63], v[148:151]
    s_waitcnt lgkmcnt(9)
    buffer_load_dwordx4 v43, s[16:19], s49 offen offset:1024 lds
    v_mfma_f32_16x16x32_bf16 v[152:155], a[184:187], a[48:51], v[152:155]
    s_waitcnt lgkmcnt(7)
    ds_read_b64_tr_b16 a[174:175], v33 offset:12288
    ds_read_b64_tr_b16 a[176:177], v34 offset:0
    v_mfma_f32_16x16x32_bf16 v[152:155], a[188:191], a[56:59], v[152:155]
    ds_read_b64_tr_b16 a[178:179], v34 offset:4096
    v_mfma_f32_16x16x32_bf16 v[156:159], a[184:187], a[52:55], v[156:159]
    ds_read_b64_tr_b16 a[180:181], v34 offset:8192
    v_mfma_f32_16x16x32_bf16 v[156:159], a[188:191], a[60:63], v[156:159]
    s_waitcnt lgkmcnt(9)
    buffer_load_dwordx4 v44, s[16:19], s49 offen offset:2048 lds
    v_mfma_f32_16x16x32_bf16 v[160:163], a[160:163], a[48:51], v[160:163]
    s_waitcnt lgkmcnt(7)
    ds_read_b64_tr_b16 a[182:183], v34 offset:12288
    ds_read_b64_tr_b16 a[184:185], v35 offset:0
    v_mfma_f32_16x16x32_bf16 v[160:163], a[164:167], a[56:59], v[160:163]
    ds_read_b64_tr_b16 a[186:187], v35 offset:4096
    v_mfma_f32_16x16x32_bf16 v[164:167], a[160:163], a[52:55], v[164:167]
    ds_read_b64_tr_b16 a[188:189], v35 offset:8192
    v_mfma_f32_16x16x32_bf16 v[164:167], a[164:167], a[60:63], v[164:167]
    s_waitcnt lgkmcnt(9)
    buffer_load_dwordx4 v45, s[16:19], s49 offen offset:3072 lds
    v_mfma_f32_16x16x32_bf16 v[168:171], a[168:171], a[48:51], v[168:171]
    s_waitcnt lgkmcnt(7)
    ds_read_b64_tr_b16 a[190:191], v35 offset:12288
    ds_read_b64_tr_b16 a[160:161], v28 offset:16384
    v_mfma_f32_16x16x32_bf16 v[168:171], a[172:175], a[56:59], v[168:171]
    s_add_u32 s49, s44, 3145984
    ds_read_b64_tr_b16 a[162:163], v28 offset:20480
    v_mfma_f32_16x16x32_bf16 v[172:175], a[168:171], a[52:55], v[172:175]
    s_add_u32 m0, s42, 81920
    ds_read_b64_tr_b16 a[164:165], v28 offset:24576
    v_mfma_f32_16x16x32_bf16 v[172:175], a[172:175], a[60:63], v[172:175]
    s_waitcnt lgkmcnt(9)
    buffer_load_dwordx4 v42, s[16:19], s49 offen lds
    v_mfma_f32_16x16x32_bf16 v[176:179], a[176:179], a[48:51], v[176:179]
    s_waitcnt lgkmcnt(7)
    ds_read_b64_tr_b16 a[166:167], v28 offset:28672
    ds_read_b64_tr_b16 a[168:169], v29 offset:16384
    v_mfma_f32_16x16x32_bf16 v[176:179], a[180:183], a[56:59], v[176:179]
    ds_read_b64_tr_b16 a[170:171], v29 offset:20480
    v_mfma_f32_16x16x32_bf16 v[180:183], a[176:179], a[52:55], v[180:183]
    ds_read_b64_tr_b16 a[172:173], v29 offset:24576
    v_mfma_f32_16x16x32_bf16 v[180:183], a[180:183], a[60:63], v[180:183]
    s_waitcnt lgkmcnt(9)
    buffer_load_dwordx4 v43, s[16:19], s49 offen offset:1024 lds
    v_mfma_f32_16x16x32_bf16 v[184:187], a[184:187], a[48:51], v[184:187]
    s_waitcnt lgkmcnt(7)
    ds_read_b64_tr_b16 a[174:175], v29 offset:28672
    ds_read_b64_tr_b16 a[176:177], v30 offset:16384
    v_mfma_f32_16x16x32_bf16 v[184:187], a[188:191], a[56:59], v[184:187]
    ds_read_b64_tr_b16 a[178:179], v30 offset:20480
    v_mfma_f32_16x16x32_bf16 v[188:191], a[184:187], a[52:55], v[188:191]
    ds_read_b64_tr_b16 a[180:181], v30 offset:24576
    v_mfma_f32_16x16x32_bf16 v[188:191], a[188:191], a[60:63], v[188:191]
    s_waitcnt lgkmcnt(9)
    buffer_load_dwordx4 v44, s[16:19], s49 offen offset:2048 lds
    v_mfma_f32_16x16x32_bf16 v[192:195], a[160:163], a[48:51], v[192:195]
    s_waitcnt lgkmcnt(7)
    ds_read_b64_tr_b16 a[182:183], v30 offset:28672
    ds_read_b64_tr_b16 a[184:185], v31 offset:16384
    v_mfma_f32_16x16x32_bf16 v[192:195], a[164:167], a[56:59], v[192:195]
    ds_read_b64_tr_b16 a[186:187], v31 offset:20480
    v_mfma_f32_16x16x32_bf16 v[196:199], a[160:163], a[52:55], v[196:199]
    ds_read_b64_tr_b16 a[188:189], v31 offset:24576
    v_mfma_f32_16x16x32_bf16 v[196:199], a[164:167], a[60:63], v[196:199]
    s_waitcnt lgkmcnt(9)
    buffer_load_dwordx4 v45, s[16:19], s49 offen offset:3072 lds
    v_mfma_f32_16x16x32_bf16 v[200:203], a[168:171], a[48:51], v[200:203]
    s_waitcnt lgkmcnt(7)
    ds_read_b64_tr_b16 a[190:191], v31 offset:28672
    ds_read_b64_tr_b16 a[160:161], v32 offset:16384
    v_mfma_f32_16x16x32_bf16 v[200:203], a[172:175], a[56:59], v[200:203]
    ds_read_b64_tr_b16 a[162:163], v32 offset:20480
    v_mfma_f32_16x16x32_bf16 v[204:207], a[168:171], a[52:55], v[204:207]
    ds_read_b64_tr_b16 a[164:165], v32 offset:24576
    v_mfma_f32_16x16x32_bf16 v[204:207], a[172:175], a[60:63], v[204:207]
    s_waitcnt lgkmcnt(9)
    ds_read_b64_tr_b16 a[166:167], v32 offset:28672
    v_mfma_f32_16x16x32_bf16 v[208:211], a[176:179], a[48:51], v[208:211]
    s_waitcnt lgkmcnt(8)
    ds_read_b64_tr_b16 a[168:169], v33 offset:16384
    v_mfma_f32_16x16x32_bf16 v[208:211], a[180:183], a[56:59], v[208:211]
    ds_read_b64_tr_b16 a[170:171], v33 offset:20480
    v_mfma_f32_16x16x32_bf16 v[212:215], a[176:179], a[52:55], v[212:215]
    ds_read_b64_tr_b16 a[172:173], v33 offset:24576
    v_mfma_f32_16x16x32_bf16 v[212:215], a[180:183], a[60:63], v[212:215]
    s_waitcnt lgkmcnt(9)
    ds_read_b64_tr_b16 a[174:175], v33 offset:28672
    v_mfma_f32_16x16x32_bf16 v[216:219], a[184:187], a[48:51], v[216:219]
    s_waitcnt lgkmcnt(8)
    ds_read_b64_tr_b16 a[176:177], v34 offset:16384
    v_mfma_f32_16x16x32_bf16 v[216:219], a[188:191], a[56:59], v[216:219]
    ds_read_b64_tr_b16 a[178:179], v34 offset:20480
    v_mfma_f32_16x16x32_bf16 v[220:223], a[184:187], a[52:55], v[220:223]
    ds_read_b64_tr_b16 a[180:181], v34 offset:24576
    v_mfma_f32_16x16x32_bf16 v[220:223], a[188:191], a[60:63], v[220:223]
    s_waitcnt lgkmcnt(9)
    ds_read_b64_tr_b16 a[182:183], v34 offset:28672
    v_mfma_f32_16x16x32_bf16 v[224:227], a[160:163], a[48:51], v[224:227]
    s_waitcnt lgkmcnt(8)
    ds_read_b64_tr_b16 a[184:185], v35 offset:16384
    v_mfma_f32_16x16x32_bf16 v[224:227], a[164:167], a[56:59], v[224:227]
    ds_read_b64_tr_b16 a[186:187], v35 offset:20480
    v_mfma_f32_16x16x32_bf16 v[228:231], a[160:163], a[52:55], v[228:231]
    ds_read_b64_tr_b16 a[188:189], v35 offset:24576
    v_mfma_f32_16x16x32_bf16 v[228:231], a[164:167], a[60:63], v[228:231]
    s_waitcnt lgkmcnt(9)
    ds_read_b64_tr_b16 a[190:191], v35 offset:28672
    s_waitcnt vmcnt(36)
    s_barrier
    v_mfma_f32_16x16x32_bf16 v[232:235], a[168:171], a[48:51], v[232:235]
    s_waitcnt lgkmcnt(8)
    ds_read_b64_tr_b16 a[160:161], v12 offset:0
    v_mfma_f32_16x16x32_bf16 v[232:235], a[172:175], a[56:59], v[232:235]
    s_add_u32 s49, s44, 3670016
    ds_read_b64_tr_b16 a[162:163], v12 offset:4096
    v_mfma_f32_16x16x32_bf16 v[236:239], a[168:171], a[52:55], v[236:239]
    s_add_u32 m0, s42, 98304
    ds_read_b64_tr_b16 a[164:165], v12 offset:8192
    v_mfma_f32_16x16x32_bf16 v[236:239], a[172:175], a[60:63], v[236:239]
    s_waitcnt lgkmcnt(9)
    buffer_load_dwordx4 v42, s[16:19], s49 offen lds
    v_mfma_f32_16x16x32_bf16 v[240:243], a[176:179], a[48:51], v[240:243]
    s_waitcnt lgkmcnt(7)
    ds_read_b64_tr_b16 a[166:167], v12 offset:12288
    ds_read_b64_tr_b16 a[168:169], v13 offset:0
    v_mfma_f32_16x16x32_bf16 v[240:243], a[180:183], a[56:59], v[240:243]
    ds_read_b64_tr_b16 a[170:171], v13 offset:4096
    v_mfma_f32_16x16x32_bf16 v[244:247], a[176:179], a[52:55], v[244:247]
    ds_read_b64_tr_b16 a[172:173], v13 offset:8192
    v_mfma_f32_16x16x32_bf16 v[244:247], a[180:183], a[60:63], v[244:247]
    s_waitcnt lgkmcnt(9)
    buffer_load_dwordx4 v43, s[16:19], s49 offen offset:1024 lds
    v_mfma_f32_16x16x32_bf16 v[248:251], a[184:187], a[48:51], v[248:251]
    s_waitcnt lgkmcnt(7)
    ds_read_b64_tr_b16 a[174:175], v13 offset:12288
    ds_read_b64_tr_b16 a[176:177], v14 offset:0
    v_mfma_f32_16x16x32_bf16 v[248:251], a[188:191], a[56:59], v[248:251]
    ds_read_b64_tr_b16 a[178:179], v14 offset:4096
    v_mfma_f32_16x16x32_bf16 v[252:255], a[184:187], a[52:55], v[252:255]
    ds_read_b64_tr_b16 a[180:181], v14 offset:8192
    v_mfma_f32_16x16x32_bf16 v[252:255], a[188:191], a[60:63], v[252:255]
    s_waitcnt vmcnt(37)
    s_waitcnt lgkmcnt(9)
    buffer_load_dwordx4 v44, s[16:19], s49 offen offset:2048 lds
    v_mfma_f32_16x16x32_bf16 v[128:131], a[160:163], a[64:67], v[128:131]
    s_waitcnt vmcnt(37)
    s_waitcnt lgkmcnt(7)
    ds_read_b64_tr_b16 a[182:183], v14 offset:12288
    ds_read_b64_tr_b16 a[184:185], v15 offset:0
    v_mfma_f32_16x16x32_bf16 v[128:131], a[164:167], a[72:75], v[128:131]
    s_waitcnt vmcnt(36)
    ds_read_b64_tr_b16 a[186:187], v15 offset:4096
    v_mfma_f32_16x16x32_bf16 v[132:135], a[160:163], a[68:71], v[132:135]
    s_waitcnt vmcnt(35)
    ds_read_b64_tr_b16 a[188:189], v15 offset:8192
    v_mfma_f32_16x16x32_bf16 v[132:135], a[164:167], a[76:79], v[132:135]
    s_waitcnt lgkmcnt(9)
    buffer_load_dwordx4 v45, s[16:19], s49 offen offset:3072 lds
    v_mfma_f32_16x16x32_bf16 v[136:139], a[168:171], a[64:67], v[136:139]
    s_waitcnt lgkmcnt(7)
    ds_read_b64_tr_b16 a[190:191], v15 offset:12288
    ds_read_b64_tr_b16 a[160:161], v16 offset:0
    v_mfma_f32_16x16x32_bf16 v[136:139], a[172:175], a[72:75], v[136:139]
    s_add_u32 s49, s44, 3670272
    ds_read_b64_tr_b16 a[162:163], v16 offset:4096
    v_mfma_f32_16x16x32_bf16 v[140:143], a[168:171], a[68:71], v[140:143]
    s_add_u32 m0, s42, 114688
    ds_read_b64_tr_b16 a[164:165], v16 offset:8192
    v_mfma_f32_16x16x32_bf16 v[140:143], a[172:175], a[76:79], v[140:143]
    s_waitcnt lgkmcnt(9)
    buffer_load_dwordx4 v42, s[16:19], s49 offen lds
    v_mfma_f32_16x16x32_bf16 v[144:147], a[176:179], a[64:67], v[144:147]
    s_waitcnt lgkmcnt(7)
    ds_read_b64_tr_b16 a[166:167], v16 offset:12288
    ds_read_b64_tr_b16 a[168:169], v17 offset:0
    v_mfma_f32_16x16x32_bf16 v[144:147], a[180:183], a[72:75], v[144:147]
    ds_read_b64_tr_b16 a[170:171], v17 offset:4096
    v_mfma_f32_16x16x32_bf16 v[148:151], a[176:179], a[68:71], v[148:151]
    ds_read_b64_tr_b16 a[172:173], v17 offset:8192
    v_mfma_f32_16x16x32_bf16 v[148:151], a[180:183], a[76:79], v[148:151]
    s_waitcnt lgkmcnt(9)
    buffer_load_dwordx4 v43, s[16:19], s49 offen offset:1024 lds
    v_mfma_f32_16x16x32_bf16 v[152:155], a[184:187], a[64:67], v[152:155]
    s_waitcnt lgkmcnt(7)
    ds_read_b64_tr_b16 a[174:175], v17 offset:12288
    ds_read_b64_tr_b16 a[176:177], v18 offset:0
    v_mfma_f32_16x16x32_bf16 v[152:155], a[188:191], a[72:75], v[152:155]
    ds_read_b64_tr_b16 a[178:179], v18 offset:4096
    v_mfma_f32_16x16x32_bf16 v[156:159], a[184:187], a[68:71], v[156:159]
    ds_read_b64_tr_b16 a[180:181], v18 offset:8192
    v_mfma_f32_16x16x32_bf16 v[156:159], a[188:191], a[76:79], v[156:159]
    s_waitcnt lgkmcnt(9)
    buffer_load_dwordx4 v44, s[16:19], s49 offen offset:2048 lds
    v_mfma_f32_16x16x32_bf16 v[160:163], a[160:163], a[64:67], v[160:163]
    s_waitcnt lgkmcnt(7)
    ds_read_b64_tr_b16 a[182:183], v18 offset:12288
    ds_read_b64_tr_b16 a[184:185], v19 offset:0
    v_mfma_f32_16x16x32_bf16 v[160:163], a[164:167], a[72:75], v[160:163]
    ds_read_b64_tr_b16 a[186:187], v19 offset:4096
    v_mfma_f32_16x16x32_bf16 v[164:167], a[160:163], a[68:71], v[164:167]
    ds_read_b64_tr_b16 a[188:189], v19 offset:8192
    v_mfma_f32_16x16x32_bf16 v[164:167], a[164:167], a[76:79], v[164:167]
    s_waitcnt lgkmcnt(9)
    buffer_load_dwordx4 v45, s[16:19], s49 offen offset:3072 lds
    v_mfma_f32_16x16x32_bf16 v[168:171], a[168:171], a[64:67], v[168:171]
    s_waitcnt lgkmcnt(7)
    ds_read_b64_tr_b16 a[190:191], v19 offset:12288
    ds_read_b64_tr_b16 a[160:161], v12 offset:16384
    v_mfma_f32_16x16x32_bf16 v[168:171], a[172:175], a[72:75], v[168:171]
    ds_read_b64_tr_b16 a[162:163], v12 offset:20480
    v_mfma_f32_16x16x32_bf16 v[172:175], a[168:171], a[68:71], v[172:175]
    ds_read_b64_tr_b16 a[164:165], v12 offset:24576
    v_mfma_f32_16x16x32_bf16 v[172:175], a[172:175], a[76:79], v[172:175]
    s_waitcnt lgkmcnt(9)
    buffer_atomic_add v65, v64, s[88:91], 0 offen sc1
    v_mfma_f32_16x16x32_bf16 v[176:179], a[176:179], a[64:67], v[176:179]
    s_waitcnt lgkmcnt(7)
    ds_read_b64_tr_b16 a[166:167], v12 offset:28672
    ds_read_b64_tr_b16 a[168:169], v13 offset:16384
    v_mfma_f32_16x16x32_bf16 v[176:179], a[180:183], a[72:75], v[176:179]
    ds_read_b64_tr_b16 a[170:171], v13 offset:20480
    v_mfma_f32_16x16x32_bf16 v[180:183], a[176:179], a[68:71], v[180:183]
    ds_read_b64_tr_b16 a[172:173], v13 offset:24576
    v_mfma_f32_16x16x32_bf16 v[180:183], a[180:183], a[76:79], v[180:183]
    s_waitcnt lgkmcnt(9)
    ds_read_b64_tr_b16 a[174:175], v13 offset:28672
    v_mfma_f32_16x16x32_bf16 v[184:187], a[184:187], a[64:67], v[184:187]
    s_waitcnt lgkmcnt(8)
    ds_read_b64_tr_b16 a[176:177], v14 offset:16384
    v_mfma_f32_16x16x32_bf16 v[184:187], a[188:191], a[72:75], v[184:187]
    ds_read_b64_tr_b16 a[178:179], v14 offset:20480
    v_mfma_f32_16x16x32_bf16 v[188:191], a[184:187], a[68:71], v[188:191]
    ds_read_b64_tr_b16 a[180:181], v14 offset:24576
    v_mfma_f32_16x16x32_bf16 v[188:191], a[188:191], a[76:79], v[188:191]
    s_waitcnt lgkmcnt(9)
    ds_read_b64_tr_b16 a[182:183], v14 offset:28672
    v_mfma_f32_16x16x32_bf16 v[192:195], a[160:163], a[64:67], v[192:195]
    s_waitcnt lgkmcnt(8)
    ds_read_b64_tr_b16 a[184:185], v15 offset:16384
    v_mfma_f32_16x16x32_bf16 v[192:195], a[164:167], a[72:75], v[192:195]
    ds_read_b64_tr_b16 a[186:187], v15 offset:20480
    v_mfma_f32_16x16x32_bf16 v[196:199], a[160:163], a[68:71], v[196:199]
    ds_read_b64_tr_b16 a[188:189], v15 offset:24576
    v_mfma_f32_16x16x32_bf16 v[196:199], a[164:167], a[76:79], v[196:199]
    s_waitcnt lgkmcnt(9)
    ds_read_b64_tr_b16 a[190:191], v15 offset:28672
    v_mfma_f32_16x16x32_bf16 v[200:203], a[168:171], a[64:67], v[200:203]
    s_waitcnt lgkmcnt(8)
    ds_read_b64_tr_b16 a[160:161], v16 offset:16384
    v_mfma_f32_16x16x32_bf16 v[200:203], a[172:175], a[72:75], v[200:203]
    ds_read_b64_tr_b16 a[162:163], v16 offset:20480
    v_mfma_f32_16x16x32_bf16 v[204:207], a[168:171], a[68:71], v[204:207]
    ds_read_b64_tr_b16 a[164:165], v16 offset:24576
    v_mfma_f32_16x16x32_bf16 v[204:207], a[172:175], a[76:79], v[204:207]
    s_waitcnt lgkmcnt(9)
    ds_read_b64_tr_b16 a[166:167], v16 offset:28672
    v_mfma_f32_16x16x32_bf16 v[208:211], a[176:179], a[64:67], v[208:211]
    s_waitcnt lgkmcnt(8)
    ds_read_b64_tr_b16 a[168:169], v17 offset:16384
    v_mfma_f32_16x16x32_bf16 v[208:211], a[180:183], a[72:75], v[208:211]
    ds_read_b64_tr_b16 a[170:171], v17 offset:20480
    v_mfma_f32_16x16x32_bf16 v[212:215], a[176:179], a[68:71], v[212:215]
    ds_read_b64_tr_b16 a[172:173], v17 offset:24576
    v_mfma_f32_16x16x32_bf16 v[212:215], a[180:183], a[76:79], v[212:215]
    s_waitcnt lgkmcnt(9)
    ds_read_b64_tr_b16 a[174:175], v17 offset:28672
    v_mfma_f32_16x16x32_bf16 v[216:219], a[184:187], a[64:67], v[216:219]
    s_waitcnt lgkmcnt(8)
    ds_read_b64_tr_b16 a[176:177], v18 offset:16384
    v_mfma_f32_16x16x32_bf16 v[216:219], a[188:191], a[72:75], v[216:219]
    ds_read_b64_tr_b16 a[178:179], v18 offset:20480
    v_mfma_f32_16x16x32_bf16 v[220:223], a[184:187], a[68:71], v[220:223]
    ds_read_b64_tr_b16 a[180:181], v18 offset:24576
    v_mfma_f32_16x16x32_bf16 v[220:223], a[188:191], a[76:79], v[220:223]
    s_waitcnt lgkmcnt(9)
    ds_read_b64_tr_b16 a[182:183], v18 offset:28672
    v_mfma_f32_16x16x32_bf16 v[224:227], a[160:163], a[64:67], v[224:227]
    s_waitcnt lgkmcnt(8)
    ds_read_b64_tr_b16 a[184:185], v19 offset:16384
    v_mfma_f32_16x16x32_bf16 v[224:227], a[164:167], a[72:75], v[224:227]
    ds_read_b64_tr_b16 a[186:187], v19 offset:20480
    v_mfma_f32_16x16x32_bf16 v[228:231], a[160:163], a[68:71], v[228:231]
    ds_read_b64_tr_b16 a[188:189], v19 offset:24576
    v_mfma_f32_16x16x32_bf16 v[228:231], a[164:167], a[76:79], v[228:231]
    s_waitcnt lgkmcnt(9)
    ds_read_b64_tr_b16 a[190:191], v19 offset:28672
    s_waitcnt vmcnt(21)
    s_barrier
    v_mfma_f32_16x16x32_bf16 v[232:235], a[168:171], a[64:67], v[232:235]
    s_waitcnt lgkmcnt(8)
    ds_read_b64_tr_b16 a[160:161], v12 offset:32768
    v_mfma_f32_16x16x32_bf16 v[232:235], a[172:175], a[72:75], v[232:235]
    s_add_u32 s49, s44, 4194304
    ds_read_b64_tr_b16 a[162:163], v12 offset:36864
    v_mfma_f32_16x16x32_bf16 v[236:239], a[168:171], a[68:71], v[236:239]
    s_add_u32 m0, s42, 131072
    ds_read_b64_tr_b16 a[164:165], v12 offset:40960
    v_mfma_f32_16x16x32_bf16 v[236:239], a[172:175], a[76:79], v[236:239]
    s_waitcnt lgkmcnt(9)
    buffer_load_dwordx4 v42, s[16:19], s49 offen lds
    v_mfma_f32_16x16x32_bf16 v[240:243], a[176:179], a[64:67], v[240:243]
    s_waitcnt lgkmcnt(7)
    ds_read_b64_tr_b16 a[166:167], v12 offset:45056
    ds_read_b64_tr_b16 a[168:169], v13 offset:32768
    v_mfma_f32_16x16x32_bf16 v[240:243], a[180:183], a[72:75], v[240:243]
    ds_read_b64_tr_b16 a[170:171], v13 offset:36864
    v_mfma_f32_16x16x32_bf16 v[244:247], a[176:179], a[68:71], v[244:247]
    ds_read_b64_tr_b16 a[172:173], v13 offset:40960
    v_mfma_f32_16x16x32_bf16 v[244:247], a[180:183], a[76:79], v[244:247]
    s_waitcnt lgkmcnt(9)
    buffer_load_dwordx4 v43, s[16:19], s49 offen offset:1024 lds
    v_mfma_f32_16x16x32_bf16 v[248:251], a[184:187], a[64:67], v[248:251]
    s_waitcnt lgkmcnt(7)
    ds_read_b64_tr_b16 a[174:175], v13 offset:45056
    ds_read_b64_tr_b16 a[176:177], v14 offset:32768
Ltour1:
    s_cbranch_execz Ltour5
    v_mfma_f32_16x16x32_bf16 v[248:251], a[188:191], a[72:75], v[248:251]
    ds_read_b64_tr_b16 a[178:179], v14 offset:36864
    v_mfma_f32_16x16x32_bf16 v[252:255], a[184:187], a[68:71], v[252:255]
    ds_read_b64_tr_b16 a[180:181], v14 offset:40960
    v_mfma_f32_16x16x32_bf16 v[252:255], a[188:191], a[76:79], v[252:255]
    s_waitcnt lgkmcnt(9)
    buffer_load_dwordx4 v44, s[16:19], s49 offen offset:2048 lds
    v_mfma_f32_16x16x32_bf16 v[128:131], a[160:163], a[80:83], v[128:131]
    s_waitcnt lgkmcnt(7)
    ds_read_b64_tr_b16 a[182:183], v14 offset:45056
    ds_read_b64_tr_b16 a[184:185], v15 offset:32768
    v_mfma_f32_16x16x32_bf16 v[128:131], a[164:167], a[88:91], v[128:131]
    ds_read_b64_tr_b16 a[186:187], v15 offset:36864
    v_mfma_f32_16x16x32_bf16 v[132:135], a[160:163], a[84:87], v[132:135]
    ds_read_b64_tr_b16 a[188:189], v15 offset:40960
    v_mfma_f32_16x16x32_bf16 v[132:135], a[164:167], a[92:95], v[132:135]
    s_waitcnt lgkmcnt(9)
    buffer_load_dwordx4 v45, s[16:19], s49 offen offset:3072 lds
    v_mfma_f32_16x16x32_bf16 v[136:139], a[168:171], a[80:83], v[136:139]
    s_waitcnt lgkmcnt(7)
    ds_read_b64_tr_b16 a[190:191], v15 offset:45056
    ds_read_b64_tr_b16 a[160:161], v16 offset:32768
    v_mfma_f32_16x16x32_bf16 v[136:139], a[172:175], a[88:91], v[136:139]
    s_add_u32 s49, s44, 4194560
    ds_read_b64_tr_b16 a[162:163], v16 offset:36864
    v_mfma_f32_16x16x32_bf16 v[140:143], a[168:171], a[84:87], v[140:143]
    s_add_u32 m0, s42, 147456
    ds_read_b64_tr_b16 a[164:165], v16 offset:40960
    v_mfma_f32_16x16x32_bf16 v[140:143], a[172:175], a[92:95], v[140:143]
    s_waitcnt lgkmcnt(9)
    buffer_load_dwordx4 v42, s[16:19], s49 offen lds
    v_mfma_f32_16x16x32_bf16 v[144:147], a[176:179], a[80:83], v[144:147]
    s_waitcnt lgkmcnt(7)
    ds_read_b64_tr_b16 a[166:167], v16 offset:45056
    ds_read_b64_tr_b16 a[168:169], v17 offset:32768
    v_mfma_f32_16x16x32_bf16 v[144:147], a[180:183], a[88:91], v[144:147]
    ds_read_b64_tr_b16 a[170:171], v17 offset:36864
    v_mfma_f32_16x16x32_bf16 v[148:151], a[176:179], a[84:87], v[148:151]
    ds_read_b64_tr_b16 a[172:173], v17 offset:40960
    v_mfma_f32_16x16x32_bf16 v[148:151], a[180:183], a[92:95], v[148:151]
    s_waitcnt lgkmcnt(9)
    buffer_load_dwordx4 v43, s[16:19], s49 offen offset:1024 lds
    v_mfma_f32_16x16x32_bf16 v[152:155], a[184:187], a[80:83], v[152:155]
    s_waitcnt lgkmcnt(7)
    ds_read_b64_tr_b16 a[174:175], v17 offset:45056
    ds_read_b64_tr_b16 a[176:177], v18 offset:32768
    v_mfma_f32_16x16x32_bf16 v[152:155], a[188:191], a[88:91], v[152:155]
    ds_read_b64_tr_b16 a[178:179], v18 offset:36864
    v_mfma_f32_16x16x32_bf16 v[156:159], a[184:187], a[84:87], v[156:159]
    ds_read_b64_tr_b16 a[180:181], v18 offset:40960
    v_mfma_f32_16x16x32_bf16 v[156:159], a[188:191], a[92:95], v[156:159]
    s_waitcnt lgkmcnt(9)
    buffer_load_dwordx4 v44, s[16:19], s49 offen offset:2048 lds
    v_mfma_f32_16x16x32_bf16 v[160:163], a[160:163], a[80:83], v[160:163]
    s_waitcnt lgkmcnt(7)
    ds_read_b64_tr_b16 a[182:183], v18 offset:45056
    ds_read_b64_tr_b16 a[184:185], v19 offset:32768
    v_mfma_f32_16x16x32_bf16 v[160:163], a[164:167], a[88:91], v[160:163]
    ds_read_b64_tr_b16 a[186:187], v19 offset:36864
    v_mfma_f32_16x16x32_bf16 v[164:167], a[160:163], a[84:87], v[164:167]
    ds_read_b64_tr_b16 a[188:189], v19 offset:40960
    v_mfma_f32_16x16x32_bf16 v[164:167], a[164:167], a[92:95], v[164:167]
    s_waitcnt lgkmcnt(9)
    buffer_load_dwordx4 v45, s[16:19], s49 offen offset:3072 lds
    v_mfma_f32_16x16x32_bf16 v[168:171], a[168:171], a[80:83], v[168:171]
    s_waitcnt lgkmcnt(7)
    ds_read_b64_tr_b16 a[190:191], v19 offset:45056
    ds_read_b64_tr_b16 a[160:161], v12 offset:49152
    v_mfma_f32_16x16x32_bf16 v[168:171], a[172:175], a[88:91], v[168:171]
    ds_read_b64_tr_b16 a[162:163], v12 offset:53248
    v_mfma_f32_16x16x32_bf16 v[172:175], a[168:171], a[84:87], v[172:175]
    ds_read_b64_tr_b16 a[164:165], v12 offset:57344
    v_mfma_f32_16x16x32_bf16 v[172:175], a[172:175], a[92:95], v[172:175]
    s_waitcnt lgkmcnt(9)
    ds_read_b64_tr_b16 a[166:167], v12 offset:61440
    v_mfma_f32_16x16x32_bf16 v[176:179], a[176:179], a[80:83], v[176:179]
    s_waitcnt lgkmcnt(8)
    ds_read_b64_tr_b16 a[168:169], v13 offset:49152
    v_mfma_f32_16x16x32_bf16 v[176:179], a[180:183], a[88:91], v[176:179]
    ds_read_b64_tr_b16 a[170:171], v13 offset:53248
    v_mfma_f32_16x16x32_bf16 v[180:183], a[176:179], a[84:87], v[180:183]
    ds_read_b64_tr_b16 a[172:173], v13 offset:57344
    v_mfma_f32_16x16x32_bf16 v[180:183], a[180:183], a[92:95], v[180:183]
    s_waitcnt lgkmcnt(9)
    ds_read_b64_tr_b16 a[174:175], v13 offset:61440
    v_mfma_f32_16x16x32_bf16 v[184:187], a[184:187], a[80:83], v[184:187]
    s_waitcnt lgkmcnt(8)
    ds_read_b64_tr_b16 a[176:177], v14 offset:49152
    v_mfma_f32_16x16x32_bf16 v[184:187], a[188:191], a[88:91], v[184:187]
    ds_read_b64_tr_b16 a[178:179], v14 offset:53248
    v_mfma_f32_16x16x32_bf16 v[188:191], a[184:187], a[84:87], v[188:191]
    ds_read_b64_tr_b16 a[180:181], v14 offset:57344
    v_mfma_f32_16x16x32_bf16 v[188:191], a[188:191], a[92:95], v[188:191]
    s_waitcnt lgkmcnt(9)
    ds_read_b64_tr_b16 a[182:183], v14 offset:61440
    v_mfma_f32_16x16x32_bf16 v[192:195], a[160:163], a[80:83], v[192:195]
    s_waitcnt lgkmcnt(8)
    ds_read_b64_tr_b16 a[184:185], v15 offset:49152
    v_mfma_f32_16x16x32_bf16 v[192:195], a[164:167], a[88:91], v[192:195]
    ds_read_b64_tr_b16 a[186:187], v15 offset:53248
    v_mfma_f32_16x16x32_bf16 v[196:199], a[160:163], a[84:87], v[196:199]
    ds_read_b64_tr_b16 a[188:189], v15 offset:57344
    v_mfma_f32_16x16x32_bf16 v[196:199], a[164:167], a[92:95], v[196:199]
    s_waitcnt lgkmcnt(9)
    ds_read_b64_tr_b16 a[190:191], v15 offset:61440
    v_mfma_f32_16x16x32_bf16 v[200:203], a[168:171], a[80:83], v[200:203]
    s_waitcnt lgkmcnt(8)
    ds_read_b64_tr_b16 a[160:161], v16 offset:49152
    v_mfma_f32_16x16x32_bf16 v[200:203], a[172:175], a[88:91], v[200:203]
    ds_read_b64_tr_b16 a[162:163], v16 offset:53248
    v_mfma_f32_16x16x32_bf16 v[204:207], a[168:171], a[84:87], v[204:207]
    ds_read_b64_tr_b16 a[164:165], v16 offset:57344
    v_mfma_f32_16x16x32_bf16 v[204:207], a[172:175], a[92:95], v[204:207]
    s_waitcnt lgkmcnt(9)
    ds_read_b64_tr_b16 a[166:167], v16 offset:61440
    v_mfma_f32_16x16x32_bf16 v[208:211], a[176:179], a[80:83], v[208:211]
    s_waitcnt lgkmcnt(8)
    ds_read_b64_tr_b16 a[168:169], v17 offset:49152
    v_mfma_f32_16x16x32_bf16 v[208:211], a[180:183], a[88:91], v[208:211]
    ds_read_b64_tr_b16 a[170:171], v17 offset:53248
    v_mfma_f32_16x16x32_bf16 v[212:215], a[176:179], a[84:87], v[212:215]
    ds_read_b64_tr_b16 a[172:173], v17 offset:57344
    v_mfma_f32_16x16x32_bf16 v[212:215], a[180:183], a[92:95], v[212:215]
    s_waitcnt lgkmcnt(9)
    ds_read_b64_tr_b16 a[174:175], v17 offset:61440
    v_mfma_f32_16x16x32_bf16 v[216:219], a[184:187], a[80:83], v[216:219]
    s_waitcnt lgkmcnt(8)
    ds_read_b64_tr_b16 a[176:177], v18 offset:49152
    v_mfma_f32_16x16x32_bf16 v[216:219], a[188:191], a[88:91], v[216:219]
    ds_read_b64_tr_b16 a[178:179], v18 offset:53248
    v_mfma_f32_16x16x32_bf16 v[220:223], a[184:187], a[84:87], v[220:223]
    ds_read_b64_tr_b16 a[180:181], v18 offset:57344
    v_mfma_f32_16x16x32_bf16 v[220:223], a[188:191], a[92:95], v[220:223]
    s_waitcnt lgkmcnt(9)
    ds_read_b64_tr_b16 a[182:183], v18 offset:61440
    v_mfma_f32_16x16x32_bf16 v[224:227], a[160:163], a[80:83], v[224:227]
    s_waitcnt lgkmcnt(8)
    ds_read_b64_tr_b16 a[184:185], v19 offset:49152
    v_mfma_f32_16x16x32_bf16 v[224:227], a[164:167], a[88:91], v[224:227]
    ds_read_b64_tr_b16 a[186:187], v19 offset:53248
    v_mfma_f32_16x16x32_bf16 v[228:231], a[160:163], a[84:87], v[228:231]
    ds_read_b64_tr_b16 a[188:189], v19 offset:57344
    v_mfma_f32_16x16x32_bf16 v[228:231], a[164:167], a[92:95], v[228:231]
    s_waitcnt lgkmcnt(9)
    ds_read_b64_tr_b16 a[190:191], v19 offset:61440
    s_waitcnt vmcnt(17)
    s_barrier
    v_mfma_f32_16x16x32_bf16 v[232:235], a[168:171], a[80:83], v[232:235]
    s_waitcnt lgkmcnt(8)
    ds_read_b64_tr_b16 a[160:161], v20 offset:0
    v_mfma_f32_16x16x32_bf16 v[232:235], a[172:175], a[88:91], v[232:235]
    ds_read_b64_tr_b16 a[162:163], v20 offset:4096
    v_mfma_f32_16x16x32_bf16 v[236:239], a[168:171], a[84:87], v[236:239]
    s_add_u32 m0, s42, 0
    ds_read_b64_tr_b16 a[164:165], v20 offset:8192
    v_mfma_f32_16x16x32_bf16 v[236:239], a[172:175], a[92:95], v[236:239]
    s_waitcnt lgkmcnt(9)
    buffer_load_dwordx4 v36, s[8:11], s40 offen lds
    v_mfma_f32_16x16x32_bf16 v[240:243], a[176:179], a[80:83], v[240:243]
    s_waitcnt lgkmcnt(7)
    ds_read_b64_tr_b16 a[166:167], v20 offset:12288
    ds_read_b64_tr_b16 a[168:169], v21 offset:0
    v_mfma_f32_16x16x32_bf16 v[240:243], a[180:183], a[88:91], v[240:243]
    ds_read_b64_tr_b16 a[170:171], v21 offset:4096
    v_mfma_f32_16x16x32_bf16 v[244:247], a[176:179], a[84:87], v[244:247]
    ds_read_b64_tr_b16 a[172:173], v21 offset:8192
    v_mfma_f32_16x16x32_bf16 v[244:247], a[180:183], a[92:95], v[244:247]
    s_waitcnt lgkmcnt(9)
    buffer_load_dwordx4 v37, s[8:11], s40 offen offset:1024 lds
    v_mfma_f32_16x16x32_bf16 v[248:251], a[184:187], a[80:83], v[248:251]
    s_waitcnt lgkmcnt(7)
    ds_read_b64_tr_b16 a[174:175], v21 offset:12288
    ds_read_b64_tr_b16 a[176:177], v22 offset:0
    v_mfma_f32_16x16x32_bf16 v[248:251], a[188:191], a[88:91], v[248:251]
    ds_read_b64_tr_b16 a[178:179], v22 offset:4096
    v_mfma_f32_16x16x32_bf16 v[252:255], a[184:187], a[84:87], v[252:255]
    ds_read_b64_tr_b16 a[180:181], v22 offset:8192
    v_mfma_f32_16x16x32_bf16 v[252:255], a[188:191], a[92:95], v[252:255]
    s_waitcnt lgkmcnt(9)
    buffer_load_dwordx4 v38, s[8:11], s40 offen offset:2048 lds
    v_mfma_f32_16x16x32_bf16 v[128:131], a[160:163], a[96:99], v[128:131]
    s_waitcnt lgkmcnt(7)
    ds_read_b64_tr_b16 a[182:183], v22 offset:12288
    ds_read_b64_tr_b16 a[184:185], v23 offset:0
    v_mfma_f32_16x16x32_bf16 v[128:131], a[164:167], a[104:107], v[128:131]
    ds_read_b64_tr_b16 a[186:187], v23 offset:4096
    v_mfma_f32_16x16x32_bf16 v[132:135], a[160:163], a[100:103], v[132:135]
    ds_read_b64_tr_b16 a[188:189], v23 offset:8192
    v_mfma_f32_16x16x32_bf16 v[132:135], a[164:167], a[108:111], v[132:135]
    s_waitcnt lgkmcnt(9)
    buffer_load_dwordx4 v39, s[8:11], s40 offen offset:3072 lds
    v_mfma_f32_16x16x32_bf16 v[136:139], a[168:171], a[96:99], v[136:139]
    s_waitcnt lgkmcnt(7)
    s_add_u32 s40, s40, 16384
    ds_read_b64_tr_b16 a[190:191], v23 offset:12288
    ds_read_b64_tr_b16 a[160:161], v24 offset:0
    v_mfma_f32_16x16x32_bf16 v[136:139], a[172:175], a[104:107], v[136:139]
    ds_read_b64_tr_b16 a[162:163], v24 offset:4096
    v_mfma_f32_16x16x32_bf16 v[140:143], a[168:171], a[100:103], v[140:143]
    s_add_u32 m0, s42, 16384
    ds_read_b64_tr_b16 a[164:165], v24 offset:8192
    v_mfma_f32_16x16x32_bf16 v[140:143], a[172:175], a[108:111], v[140:143]
    s_waitcnt lgkmcnt(9)
    buffer_load_dwordx4 v36, s[8:11], s40 offen lds
    v_mfma_f32_16x16x32_bf16 v[144:147], a[176:179], a[96:99], v[144:147]
    s_waitcnt lgkmcnt(7)
    ds_read_b64_tr_b16 a[166:167], v24 offset:12288
    ds_read_b64_tr_b16 a[168:169], v25 offset:0
    v_mfma_f32_16x16x32_bf16 v[144:147], a[180:183], a[104:107], v[144:147]
    ds_read_b64_tr_b16 a[170:171], v25 offset:4096
    v_mfma_f32_16x16x32_bf16 v[148:151], a[176:179], a[100:103], v[148:151]
    ds_read_b64_tr_b16 a[172:173], v25 offset:8192
    v_mfma_f32_16x16x32_bf16 v[148:151], a[180:183], a[108:111], v[148:151]
    s_waitcnt lgkmcnt(9)
    buffer_load_dwordx4 v37, s[8:11], s40 offen offset:1024 lds
    v_mfma_f32_16x16x32_bf16 v[152:155], a[184:187], a[96:99], v[152:155]
    s_waitcnt lgkmcnt(7)
    ds_read_b64_tr_b16 a[174:175], v25 offset:12288
    ds_read_b64_tr_b16 a[176:177], v26 offset:0
    v_mfma_f32_16x16x32_bf16 v[152:155], a[188:191], a[104:107], v[152:155]
    ds_read_b64_tr_b16 a[178:179], v26 offset:4096
    v_mfma_f32_16x16x32_bf16 v[156:159], a[184:187], a[100:103], v[156:159]
    ds_read_b64_tr_b16 a[180:181], v26 offset:8192
    v_mfma_f32_16x16x32_bf16 v[156:159], a[188:191], a[108:111], v[156:159]
    s_waitcnt lgkmcnt(9)
    buffer_load_dwordx4 v38, s[8:11], s40 offen offset:2048 lds
    v_mfma_f32_16x16x32_bf16 v[160:163], a[160:163], a[96:99], v[160:163]
    s_waitcnt lgkmcnt(7)
    ds_read_b64_tr_b16 a[182:183], v26 offset:12288
    ds_read_b64_tr_b16 a[184:185], v27 offset:0
    v_mfma_f32_16x16x32_bf16 v[160:163], a[164:167], a[104:107], v[160:163]
    ds_read_b64_tr_b16 a[186:187], v27 offset:4096
    v_accvgpr_write_b32 a0, 0
    v_mfma_f32_16x16x32_bf16 v[164:167], a[160:163], a[100:103], v[164:167]
    ds_read_b64_tr_b16 a[188:189], v27 offset:8192
    v_accvgpr_write_b32 a1, 0
    v_mfma_f32_16x16x32_bf16 v[164:167], a[164:167], a[108:111], v[164:167]
    s_waitcnt lgkmcnt(9)
    buffer_load_dwordx4 v39, s[8:11], s40 offen offset:3072 lds
    v_mfma_f32_16x16x32_bf16 v[168:171], a[168:171], a[96:99], v[168:171]
    s_waitcnt lgkmcnt(7)
    s_add_u32 s40, s40, 16384
    ds_read_b64_tr_b16 a[190:191], v27 offset:12288
    ds_read_b64_tr_b16 a[160:161], v20 offset:16384
    v_mfma_f32_16x16x32_bf16 v[168:171], a[172:175], a[104:107], v[168:171]
    ds_read_b64_tr_b16 a[162:163], v20 offset:20480
    v_accvgpr_write_b32 a2, 0
    v_mfma_f32_16x16x32_bf16 v[172:175], a[168:171], a[100:103], v[172:175]
    ds_read_b64_tr_b16 a[164:165], v20 offset:24576
    v_accvgpr_write_b32 a3, 0
    v_mfma_f32_16x16x32_bf16 v[172:175], a[172:175], a[108:111], v[172:175]
    s_waitcnt lgkmcnt(9)
    ds_read_b64_tr_b16 a[166:167], v20 offset:28672
    v_accvgpr_write_b32 a4, 0
    v_mfma_f32_16x16x32_bf16 v[176:179], a[176:179], a[96:99], v[176:179]
    s_waitcnt lgkmcnt(8)
    ds_read_b64_tr_b16 a[168:169], v21 offset:16384
    v_accvgpr_write_b32 a5, 0
    v_mfma_f32_16x16x32_bf16 v[176:179], a[180:183], a[104:107], v[176:179]
    ds_read_b64_tr_b16 a[170:171], v21 offset:20480
    v_accvgpr_write_b32 a6, 0
    v_mfma_f32_16x16x32_bf16 v[180:183], a[176:179], a[100:103], v[180:183]
    ds_read_b64_tr_b16 a[172:173], v21 offset:24576
    v_accvgpr_write_b32 a7, 0
    v_mfma_f32_16x16x32_bf16 v[180:183], a[180:183], a[108:111], v[180:183]
    s_waitcnt lgkmcnt(9)
    ds_read_b64_tr_b16 a[174:175], v21 offset:28672
    v_accvgpr_write_b32 a8, 0
    v_mfma_f32_16x16x32_bf16 v[184:187], a[184:187], a[96:99], v[184:187]
    s_waitcnt lgkmcnt(8)
    ds_read_b64_tr_b16 a[176:177], v22 offset:16384
    v_accvgpr_write_b32 a9, 0
    v_mfma_f32_16x16x32_bf16 v[184:187], a[188:191], a[104:107], v[184:187]
    ds_read_b64_tr_b16 a[178:179], v22 offset:20480
    v_accvgpr_write_b32 a10, 0
    v_mfma_f32_16x16x32_bf16 v[188:191], a[184:187], a[100:103], v[188:191]
    ds_read_b64_tr_b16 a[180:181], v22 offset:24576
    v_accvgpr_write_b32 a11, 0
    v_mfma_f32_16x16x32_bf16 v[188:191], a[188:191], a[108:111], v[188:191]
    s_waitcnt lgkmcnt(9)
    ds_read_b64_tr_b16 a[182:183], v22 offset:28672
    v_accvgpr_write_b32 a12, 0
    v_mfma_f32_16x16x32_bf16 v[192:195], a[160:163], a[96:99], v[192:195]
    s_waitcnt lgkmcnt(8)
    ds_read_b64_tr_b16 a[184:185], v23 offset:16384
    v_accvgpr_write_b32 a13, 0
    v_mfma_f32_16x16x32_bf16 v[192:195], a[164:167], a[104:107], v[192:195]
    ds_read_b64_tr_b16 a[186:187], v23 offset:20480
    v_accvgpr_write_b32 a14, 0
    v_mfma_f32_16x16x32_bf16 v[196:199], a[160:163], a[100:103], v[196:199]
    ds_read_b64_tr_b16 a[188:189], v23 offset:24576
    v_accvgpr_write_b32 a15, 0
    v_mfma_f32_16x16x32_bf16 v[196:199], a[164:167], a[108:111], v[196:199]
    s_waitcnt lgkmcnt(9)
    ds_read_b64_tr_b16 a[190:191], v23 offset:28672
    v_accvgpr_write_b32 a16, 0
    v_mfma_f32_16x16x32_bf16 v[200:203], a[168:171], a[96:99], v[200:203]
    s_waitcnt lgkmcnt(8)
    ds_read_b64_tr_b16 a[160:161], v24 offset:16384
    v_accvgpr_write_b32 a17, 0
    v_mfma_f32_16x16x32_bf16 v[200:203], a[172:175], a[104:107], v[200:203]
    ds_read_b64_tr_b16 a[162:163], v24 offset:20480
    v_accvgpr_write_b32 a18, 0
    v_mfma_f32_16x16x32_bf16 v[204:207], a[168:171], a[100:103], v[204:207]
    ds_read_b64_tr_b16 a[164:165], v24 offset:24576
    v_accvgpr_write_b32 a19, 0
    v_mfma_f32_16x16x32_bf16 v[204:207], a[172:175], a[108:111], v[204:207]
    s_waitcnt lgkmcnt(9)
    ds_read_b64_tr_b16 a[166:167], v24 offset:28672
    v_accvgpr_write_b32 a20, 0
    v_mfma_f32_16x16x32_bf16 v[208:211], a[176:179], a[96:99], v[208:211]
    s_waitcnt lgkmcnt(8)
    ds_read_b64_tr_b16 a[168:169], v25 offset:16384
    v_accvgpr_write_b32 a21, 0
    v_mfma_f32_16x16x32_bf16 v[208:211], a[180:183], a[104:107], v[208:211]
    ds_read_b64_tr_b16 a[170:171], v25 offset:20480
    v_accvgpr_write_b32 a22, 0
    v_mfma_f32_16x16x32_bf16 v[212:215], a[176:179], a[100:103], v[212:215]
    ds_read_b64_tr_b16 a[172:173], v25 offset:24576
    v_accvgpr_write_b32 a23, 0
    v_mfma_f32_16x16x32_bf16 v[212:215], a[180:183], a[108:111], v[212:215]
    s_waitcnt lgkmcnt(9)
    ds_read_b64_tr_b16 a[174:175], v25 offset:28672
    v_accvgpr_write_b32 a24, 0
    v_mfma_f32_16x16x32_bf16 v[216:219], a[184:187], a[96:99], v[216:219]
    s_waitcnt lgkmcnt(8)
    ds_read_b64_tr_b16 a[176:177], v26 offset:16384
    v_accvgpr_write_b32 a25, 0
    v_mfma_f32_16x16x32_bf16 v[216:219], a[188:191], a[104:107], v[216:219]
    ds_read_b64_tr_b16 a[178:179], v26 offset:20480
    v_accvgpr_write_b32 a26, 0
    v_mfma_f32_16x16x32_bf16 v[220:223], a[184:187], a[100:103], v[220:223]
    ds_read_b64_tr_b16 a[180:181], v26 offset:24576
    v_accvgpr_write_b32 a27, 0
    v_mfma_f32_16x16x32_bf16 v[220:223], a[188:191], a[108:111], v[220:223]
    s_waitcnt lgkmcnt(9)
    ds_read_b64_tr_b16 a[182:183], v26 offset:28672
    v_accvgpr_write_b32 a28, 0
    v_mfma_f32_16x16x32_bf16 v[224:227], a[160:163], a[96:99], v[224:227]
    s_waitcnt lgkmcnt(8)
    ds_read_b64_tr_b16 a[184:185], v27 offset:16384
    v_accvgpr_write_b32 a29, 0
    v_mfma_f32_16x16x32_bf16 v[224:227], a[164:167], a[104:107], v[224:227]
    ds_read_b64_tr_b16 a[186:187], v27 offset:20480
    v_accvgpr_write_b32 a30, 0
    v_mfma_f32_16x16x32_bf16 v[228:231], a[160:163], a[100:103], v[228:231]
    ds_read_b64_tr_b16 a[188:189], v27 offset:24576
    v_accvgpr_write_b32 a31, 0
    v_mfma_f32_16x16x32_bf16 v[228:231], a[164:167], a[108:111], v[228:231]
    s_waitcnt lgkmcnt(9)
    ds_read_b64_tr_b16 a[190:191], v27 offset:28672
    v_accvgpr_write_b32 a32, 0
    s_waitcnt vmcnt(17)
    s_barrier
    v_mfma_f32_16x16x32_bf16 v[232:235], a[168:171], a[96:99], v[232:235]
    s_waitcnt lgkmcnt(8)
    ds_read_b64_tr_b16 a[160:161], v20 offset:32768
    v_accvgpr_write_b32 a33, 0
    v_mfma_f32_16x16x32_bf16 v[232:235], a[172:175], a[104:107], v[232:235]
    ds_read_b64_tr_b16 a[162:163], v20 offset:36864
    v_accvgpr_write_b32 a34, 0
    v_mfma_f32_16x16x32_bf16 v[236:239], a[168:171], a[100:103], v[236:239]
    s_add_u32 m0, s42, 32768
    ds_read_b64_tr_b16 a[164:165], v20 offset:40960
    v_accvgpr_write_b32 a35, 0
    v_mfma_f32_16x16x32_bf16 v[236:239], a[172:175], a[108:111], v[236:239]
    s_waitcnt lgkmcnt(9)
    buffer_load_dwordx4 v36, s[8:11], s40 offen lds
    v_mfma_f32_16x16x32_bf16 v[240:243], a[176:179], a[96:99], v[240:243]
    s_waitcnt lgkmcnt(7)
    ds_read_b64_tr_b16 a[166:167], v20 offset:45056
    ds_read_b64_tr_b16 a[168:169], v21 offset:32768
    v_mfma_f32_16x16x32_bf16 v[240:243], a[180:183], a[104:107], v[240:243]
    ds_read_b64_tr_b16 a[170:171], v21 offset:36864
    v_accvgpr_write_b32 a36, 0
    v_mfma_f32_16x16x32_bf16 v[244:247], a[176:179], a[100:103], v[244:247]
    ds_read_b64_tr_b16 a[172:173], v21 offset:40960
    v_accvgpr_write_b32 a37, 0
    v_mfma_f32_16x16x32_bf16 v[244:247], a[180:183], a[108:111], v[244:247]
    s_waitcnt lgkmcnt(9)
    buffer_load_dwordx4 v37, s[8:11], s40 offen offset:1024 lds
    v_mfma_f32_16x16x32_bf16 v[248:251], a[184:187], a[96:99], v[248:251]
    s_waitcnt lgkmcnt(7)
    ds_read_b64_tr_b16 a[174:175], v21 offset:45056
    ds_read_b64_tr_b16 a[176:177], v22 offset:32768
    v_mfma_f32_16x16x32_bf16 v[248:251], a[188:191], a[104:107], v[248:251]
    ds_read_b64_tr_b16 a[178:179], v22 offset:36864
    v_accvgpr_write_b32 a38, 0
    v_mfma_f32_16x16x32_bf16 v[252:255], a[184:187], a[100:103], v[252:255]
    ds_read_b64_tr_b16 a[180:181], v22 offset:40960
    v_accvgpr_write_b32 a39, 0
    v_mfma_f32_16x16x32_bf16 v[252:255], a[188:191], a[108:111], v[252:255]
    s_waitcnt lgkmcnt(9)
    buffer_load_dwordx4 v38, s[8:11], s40 offen offset:2048 lds
    v_mfma_f32_16x16x32_bf16 v[128:131], a[160:163], a[112:115], v[128:131]
    s_waitcnt lgkmcnt(7)
    ds_read_b64_tr_b16 a[182:183], v22 offset:45056
    ds_read_b64_tr_b16 a[184:185], v23 offset:32768
    v_mfma_f32_16x16x32_bf16 v[128:131], a[164:167], a[120:123], v[128:131]
    ds_read_b64_tr_b16 a[186:187], v23 offset:36864
    v_accvgpr_write_b32 a40, 0
    v_mfma_f32_16x16x32_bf16 v[132:135], a[160:163], a[116:119], v[132:135]
    ds_read_b64_tr_b16 a[188:189], v23 offset:40960
    v_accvgpr_write_b32 a41, 0
    v_mfma_f32_16x16x32_bf16 v[132:135], a[164:167], a[124:127], v[132:135]
    s_waitcnt lgkmcnt(9)
    buffer_load_dwordx4 v39, s[8:11], s40 offen offset:3072 lds
    v_mfma_f32_16x16x32_bf16 v[136:139], a[168:171], a[112:115], v[136:139]
    s_waitcnt lgkmcnt(7)
    s_add_u32 s40, s40, 16384
    ds_read_b64_tr_b16 a[190:191], v23 offset:45056
    ds_read_b64_tr_b16 a[160:161], v24 offset:32768
    v_mfma_f32_16x16x32_bf16 v[136:139], a[172:175], a[120:123], v[136:139]
    ds_read_b64_tr_b16 a[162:163], v24 offset:36864
    v_accvgpr_write_b32 a42, 0
    v_mfma_f32_16x16x32_bf16 v[140:143], a[168:171], a[116:119], v[140:143]
    ds_read_b64_tr_b16 a[164:165], v24 offset:40960
    v_accvgpr_write_b32 a43, 0
    v_mfma_f32_16x16x32_bf16 v[140:143], a[172:175], a[124:127], v[140:143]
    s_waitcnt lgkmcnt(9)
    ds_read_b64_tr_b16 a[166:167], v24 offset:45056
    v_accvgpr_write_b32 a44, 0
    v_mfma_f32_16x16x32_bf16 v[144:147], a[176:179], a[112:115], v[144:147]
    s_waitcnt lgkmcnt(8)
    ds_read_b64_tr_b16 a[168:169], v25 offset:32768
    v_accvgpr_write_b32 a45, 0
    v_mfma_f32_16x16x32_bf16 v[144:147], a[180:183], a[120:123], v[144:147]
    ds_read_b64_tr_b16 a[170:171], v25 offset:36864
    v_accvgpr_write_b32 a46, 0
    v_mfma_f32_16x16x32_bf16 v[148:151], a[176:179], a[116:119], v[148:151]
    ds_read_b64_tr_b16 a[172:173], v25 offset:40960
    v_accvgpr_write_b32 a47, 0
    v_mfma_f32_16x16x32_bf16 v[148:151], a[180:183], a[124:127], v[148:151]
    s_waitcnt lgkmcnt(9)
    ds_read_b64_tr_b16 a[174:175], v25 offset:45056
    v_accvgpr_write_b32 a48, 0
    v_mfma_f32_16x16x32_bf16 v[152:155], a[184:187], a[112:115], v[152:155]
    s_waitcnt lgkmcnt(8)
    ds_read_b64_tr_b16 a[176:177], v26 offset:32768
    v_accvgpr_write_b32 a49, 0
    v_mfma_f32_16x16x32_bf16 v[152:155], a[188:191], a[120:123], v[152:155]
    ds_read_b64_tr_b16 a[178:179], v26 offset:36864
    v_accvgpr_write_b32 a50, 0
    v_mfma_f32_16x16x32_bf16 v[156:159], a[184:187], a[116:119], v[156:159]
    ds_read_b64_tr_b16 a[180:181], v26 offset:40960
    v_accvgpr_write_b32 a51, 0
    v_mfma_f32_16x16x32_bf16 v[156:159], a[188:191], a[124:127], v[156:159]
    s_waitcnt lgkmcnt(9)
    ds_read_b64_tr_b16 a[182:183], v26 offset:45056
    v_accvgpr_write_b32 a52, 0
    v_mfma_f32_16x16x32_bf16 v[160:163], a[160:163], a[112:115], v[160:163]
    s_waitcnt lgkmcnt(8)
    ds_read_b64_tr_b16 a[184:185], v27 offset:32768
    v_accvgpr_write_b32 a53, 0
    v_mfma_f32_16x16x32_bf16 v[160:163], a[164:167], a[120:123], v[160:163]
    ds_read_b64_tr_b16 a[186:187], v27 offset:36864
    v_accvgpr_write_b32 a54, 0
    v_mfma_f32_16x16x32_bf16 v[164:167], a[160:163], a[116:119], v[164:167]
    ds_read_b64_tr_b16 a[188:189], v27 offset:40960
    v_accvgpr_write_b32 a55, 0
    v_mfma_f32_16x16x32_bf16 v[164:167], a[164:167], a[124:127], v[164:167]
    s_waitcnt lgkmcnt(9)
    ds_read_b64_tr_b16 a[190:191], v27 offset:45056
    v_accvgpr_write_b32 a56, 0
    v_mfma_f32_16x16x32_bf16 v[168:171], a[168:171], a[112:115], v[168:171]
    s_waitcnt lgkmcnt(8)
    ds_read_b64_tr_b16 a[160:161], v20 offset:49152
    v_accvgpr_write_b32 a57, 0
    v_mfma_f32_16x16x32_bf16 v[168:171], a[172:175], a[120:123], v[168:171]
    ds_read_b64_tr_b16 a[162:163], v20 offset:53248
    v_accvgpr_write_b32 a58, 0
    v_mfma_f32_16x16x32_bf16 v[172:175], a[168:171], a[116:119], v[172:175]
    ds_read_b64_tr_b16 a[164:165], v20 offset:57344
    v_accvgpr_write_b32 a59, 0
    v_mfma_f32_16x16x32_bf16 v[172:175], a[172:175], a[124:127], v[172:175]
    s_waitcnt lgkmcnt(9)
    ds_read_b64_tr_b16 a[166:167], v20 offset:61440
    v_accvgpr_write_b32 a60, 0
    v_mfma_f32_16x16x32_bf16 v[176:179], a[176:179], a[112:115], v[176:179]
    s_waitcnt lgkmcnt(8)
    ds_read_b64_tr_b16 a[168:169], v21 offset:49152
    v_accvgpr_write_b32 a61, 0
    v_mfma_f32_16x16x32_bf16 v[176:179], a[180:183], a[120:123], v[176:179]
    ds_read_b64_tr_b16 a[170:171], v21 offset:53248
    v_accvgpr_write_b32 a62, 0
    v_mfma_f32_16x16x32_bf16 v[180:183], a[176:179], a[116:119], v[180:183]
    ds_read_b64_tr_b16 a[172:173], v21 offset:57344
    v_accvgpr_write_b32 a63, 0
    v_mfma_f32_16x16x32_bf16 v[180:183], a[180:183], a[124:127], v[180:183]
    s_waitcnt lgkmcnt(9)
    ds_read_b64_tr_b16 a[174:175], v21 offset:61440
    v_accvgpr_write_b32 a64, 0
    v_mfma_f32_16x16x32_bf16 v[184:187], a[184:187], a[112:115], v[184:187]
    s_waitcnt lgkmcnt(8)
    ds_read_b64_tr_b16 a[176:177], v22 offset:49152
    v_accvgpr_write_b32 a65, 0
    v_mfma_f32_16x16x32_bf16 v[184:187], a[188:191], a[120:123], v[184:187]
    ds_read_b64_tr_b16 a[178:179], v22 offset:53248
    v_accvgpr_write_b32 a66, 0
    v_mfma_f32_16x16x32_bf16 v[188:191], a[184:187], a[116:119], v[188:191]
    ds_read_b64_tr_b16 a[180:181], v22 offset:57344
    v_accvgpr_write_b32 a67, 0
    v_mfma_f32_16x16x32_bf16 v[188:191], a[188:191], a[124:127], v[188:191]
    s_waitcnt lgkmcnt(9)
    ds_read_b64_tr_b16 a[182:183], v22 offset:61440
    v_accvgpr_write_b32 a68, 0
    v_mfma_f32_16x16x32_bf16 v[192:195], a[160:163], a[112:115], v[192:195]
    s_waitcnt lgkmcnt(8)
    ds_read_b64_tr_b16 a[184:185], v23 offset:49152
    v_accvgpr_write_b32 a69, 0
    v_mfma_f32_16x16x32_bf16 v[192:195], a[164:167], a[120:123], v[192:195]
    ds_read_b64_tr_b16 a[186:187], v23 offset:53248
    v_accvgpr_write_b32 a70, 0
    v_mfma_f32_16x16x32_bf16 v[196:199], a[160:163], a[116:119], v[196:199]
    ds_read_b64_tr_b16 a[188:189], v23 offset:57344
    v_accvgpr_write_b32 a71, 0
    v_mfma_f32_16x16x32_bf16 v[196:199], a[164:167], a[124:127], v[196:199]
    s_waitcnt lgkmcnt(9)
    ds_read_b64_tr_b16 a[190:191], v23 offset:61440
    v_accvgpr_write_b32 a72, 0
    v_mfma_f32_16x16x32_bf16 v[200:203], a[168:171], a[112:115], v[200:203]
    s_waitcnt lgkmcnt(8)
    ds_read_b64_tr_b16 a[160:161], v24 offset:49152
    v_accvgpr_write_b32 a73, 0
    v_mfma_f32_16x16x32_bf16 v[200:203], a[172:175], a[120:123], v[200:203]
    ds_read_b64_tr_b16 a[162:163], v24 offset:53248
    v_accvgpr_write_b32 a74, 0
    v_mfma_f32_16x16x32_bf16 v[204:207], a[168:171], a[116:119], v[204:207]
    ds_read_b64_tr_b16 a[164:165], v24 offset:57344
    v_accvgpr_write_b32 a75, 0
    v_mfma_f32_16x16x32_bf16 v[204:207], a[172:175], a[124:127], v[204:207]
    s_waitcnt lgkmcnt(9)
    ds_read_b64_tr_b16 a[166:167], v24 offset:61440
    v_accvgpr_write_b32 a76, 0
    v_mfma_f32_16x16x32_bf16 v[208:211], a[176:179], a[112:115], v[208:211]
    s_waitcnt lgkmcnt(8)
    ds_read_b64_tr_b16 a[168:169], v25 offset:49152
    v_accvgpr_write_b32 a77, 0
    v_mfma_f32_16x16x32_bf16 v[208:211], a[180:183], a[120:123], v[208:211]
    ds_read_b64_tr_b16 a[170:171], v25 offset:53248
    v_accvgpr_write_b32 a78, 0
    v_mfma_f32_16x16x32_bf16 v[212:215], a[176:179], a[116:119], v[212:215]
    ds_read_b64_tr_b16 a[172:173], v25 offset:57344
    v_accvgpr_write_b32 a79, 0
    v_mfma_f32_16x16x32_bf16 v[212:215], a[180:183], a[124:127], v[212:215]
    s_waitcnt lgkmcnt(9)
    ds_read_b64_tr_b16 a[174:175], v25 offset:61440
    v_accvgpr_write_b32 a80, 0
    v_mfma_f32_16x16x32_bf16 v[216:219], a[184:187], a[112:115], v[216:219]
    s_waitcnt lgkmcnt(8)
    ds_read_b64_tr_b16 a[176:177], v26 offset:49152
    v_accvgpr_write_b32 a81, 0
    v_mfma_f32_16x16x32_bf16 v[216:219], a[188:191], a[120:123], v[216:219]
Ltour2:
    s_cbranch_execz Ltour6
    ds_read_b64_tr_b16 a[178:179], v26 offset:53248
    v_accvgpr_write_b32 a82, 0
    v_mfma_f32_16x16x32_bf16 v[220:223], a[184:187], a[116:119], v[220:223]
    ds_read_b64_tr_b16 a[180:181], v26 offset:57344
    v_accvgpr_write_b32 a83, 0
    v_mfma_f32_16x16x32_bf16 v[220:223], a[188:191], a[124:127], v[220:223]
    s_waitcnt lgkmcnt(9)
    ds_read_b64_tr_b16 a[182:183], v26 offset:61440
    v_accvgpr_write_b32 a84, 0
    v_mfma_f32_16x16x32_bf16 v[224:227], a[160:163], a[112:115], v[224:227]
    s_waitcnt lgkmcnt(8)
    ds_read_b64_tr_b16 a[184:185], v27 offset:49152
    v_accvgpr_write_b32 a85, 0
    v_mfma_f32_16x16x32_bf16 v[224:227], a[164:167], a[120:123], v[224:227]
    ds_read_b64_tr_b16 a[186:187], v27 offset:53248
    v_accvgpr_write_b32 a86, 0
    v_mfma_f32_16x16x32_bf16 v[228:231], a[160:163], a[116:119], v[228:231]
    ds_read_b64_tr_b16 a[188:189], v27 offset:57344
    v_accvgpr_write_b32 a87, 0
    v_mfma_f32_16x16x32_bf16 v[228:231], a[164:167], a[124:127], v[228:231]
    s_waitcnt lgkmcnt(9)
    ds_read_b64_tr_b16 a[190:191], v27 offset:61440
    v_accvgpr_write_b32 a88, 0
    s_waitcnt vmcnt(12)
    s_barrier
    v_mfma_f32_16x16x32_bf16 v[232:235], a[168:171], a[112:115], v[232:235]
    s_waitcnt lgkmcnt(8)
    ds_read_b64_tr_b16 a[160:161], v28 offset:0
    v_accvgpr_write_b32 a89, 0
    v_mfma_f32_16x16x32_bf16 v[232:235], a[172:175], a[120:123], v[232:235]
    ds_read_b64_tr_b16 a[162:163], v28 offset:4096
    v_accvgpr_write_b32 a90, 0
    v_mfma_f32_16x16x32_bf16 v[236:239], a[168:171], a[116:119], v[236:239]
    s_add_u32 m0, s42, 65536
    ds_read_b64_tr_b16 a[164:165], v28 offset:8192
    v_accvgpr_write_b32 a91, 0
    v_mfma_f32_16x16x32_bf16 v[236:239], a[172:175], a[124:127], v[236:239]
    s_waitcnt lgkmcnt(9)
    buffer_load_dwordx4 v40, s[12:15], s41 offen lds
    v_mfma_f32_16x16x32_bf16 v[240:243], a[176:179], a[112:115], v[240:243]
    s_waitcnt lgkmcnt(7)
    ds_read_b64_tr_b16 a[166:167], v28 offset:12288
    ds_read_b64_tr_b16 a[168:169], v29 offset:0
    v_mfma_f32_16x16x32_bf16 v[240:243], a[180:183], a[120:123], v[240:243]
    ds_read_b64_tr_b16 a[170:171], v29 offset:4096
    v_accvgpr_write_b32 a92, 0
    v_mfma_f32_16x16x32_bf16 v[244:247], a[176:179], a[116:119], v[244:247]
    ds_read_b64_tr_b16 a[172:173], v29 offset:8192
    v_accvgpr_write_b32 a93, 0
    v_mfma_f32_16x16x32_bf16 v[244:247], a[180:183], a[124:127], v[244:247]
    s_waitcnt lgkmcnt(9)
    buffer_load_dwordx4 v41, s[12:15], s41 offen offset:1024 lds
    v_mfma_f32_16x16x32_bf16 v[248:251], a[184:187], a[112:115], v[248:251]
    s_waitcnt lgkmcnt(7)
    ds_read_b64_tr_b16 a[174:175], v29 offset:12288
    ds_read_b64_tr_b16 a[176:177], v30 offset:0
    v_mfma_f32_16x16x32_bf16 v[248:251], a[188:191], a[120:123], v[248:251]
    ds_read_b64_tr_b16 a[178:179], v30 offset:4096
    v_accvgpr_write_b32 a94, 0
    v_mfma_f32_16x16x32_bf16 v[252:255], a[184:187], a[116:119], v[252:255]
    ds_read_b64_tr_b16 a[180:181], v30 offset:8192
    v_accvgpr_write_b32 a95, 0
    v_mfma_f32_16x16x32_bf16 v[252:255], a[188:191], a[124:127], v[252:255]
    s_waitcnt lgkmcnt(9)
    buffer_load_dwordx4 v40, s[12:15], s41 offen offset:2048 lds
    v_mfma_f32_16x16x32_bf16 v[128:131], a[160:163], a[128:131], v[128:131]
    s_waitcnt lgkmcnt(7)
    ds_read_b64_tr_b16 a[182:183], v30 offset:12288
    ds_read_b64_tr_b16 a[184:185], v31 offset:0
    v_mfma_f32_16x16x32_bf16 v[128:131], a[164:167], a[136:139], v[128:131]
    ds_read_b64_tr_b16 a[186:187], v31 offset:4096
    v_accvgpr_write_b32 a96, 0
    v_mfma_f32_16x16x32_bf16 v[132:135], a[160:163], a[132:135], v[132:135]
    ds_read_b64_tr_b16 a[188:189], v31 offset:8192
    v_accvgpr_write_b32 a97, 0
    v_mfma_f32_16x16x32_bf16 v[132:135], a[164:167], a[140:143], v[132:135]
    s_waitcnt lgkmcnt(9)
    buffer_load_dwordx4 v41, s[12:15], s41 offen offset:3072 lds
    v_mfma_f32_16x16x32_bf16 v[136:139], a[168:171], a[128:131], v[136:139]
    s_waitcnt lgkmcnt(7)
    s_add_u32 s41, s41, 16384
    ds_read_b64_tr_b16 a[190:191], v31 offset:12288
    ds_read_b64_tr_b16 a[160:161], v32 offset:0
    v_mfma_f32_16x16x32_bf16 v[136:139], a[172:175], a[136:139], v[136:139]
    ds_read_b64_tr_b16 a[162:163], v32 offset:4096
    v_accvgpr_write_b32 a98, 0
    v_mfma_f32_16x16x32_bf16 v[140:143], a[168:171], a[132:135], v[140:143]
    s_add_u32 m0, s42, 81920
    ds_read_b64_tr_b16 a[164:165], v32 offset:8192
    v_accvgpr_write_b32 a99, 0
    v_mfma_f32_16x16x32_bf16 v[140:143], a[172:175], a[140:143], v[140:143]
    s_waitcnt lgkmcnt(9)
    buffer_load_dwordx4 v40, s[12:15], s41 offen lds
    v_mfma_f32_16x16x32_bf16 v[144:147], a[176:179], a[128:131], v[144:147]
    s_waitcnt lgkmcnt(7)
    ds_read_b64_tr_b16 a[166:167], v32 offset:12288
    ds_read_b64_tr_b16 a[168:169], v33 offset:0
    v_mfma_f32_16x16x32_bf16 v[144:147], a[180:183], a[136:139], v[144:147]
    ds_read_b64_tr_b16 a[170:171], v33 offset:4096
    v_accvgpr_write_b32 a100, 0
    v_mfma_f32_16x16x32_bf16 v[148:151], a[176:179], a[132:135], v[148:151]
    ds_read_b64_tr_b16 a[172:173], v33 offset:8192
    v_accvgpr_write_b32 a101, 0
    v_mfma_f32_16x16x32_bf16 v[148:151], a[180:183], a[140:143], v[148:151]
    s_waitcnt lgkmcnt(9)
    buffer_load_dwordx4 v41, s[12:15], s41 offen offset:1024 lds
    v_mfma_f32_16x16x32_bf16 v[152:155], a[184:187], a[128:131], v[152:155]
    s_waitcnt lgkmcnt(7)
    ds_read_b64_tr_b16 a[174:175], v33 offset:12288
    ds_read_b64_tr_b16 a[176:177], v34 offset:0
    v_mfma_f32_16x16x32_bf16 v[152:155], a[188:191], a[136:139], v[152:155]
    ds_read_b64_tr_b16 a[178:179], v34 offset:4096
    v_accvgpr_write_b32 a102, 0
    v_mfma_f32_16x16x32_bf16 v[156:159], a[184:187], a[132:135], v[156:159]
    ds_read_b64_tr_b16 a[180:181], v34 offset:8192
    v_accvgpr_write_b32 a103, 0
    v_mfma_f32_16x16x32_bf16 v[156:159], a[188:191], a[140:143], v[156:159]
    s_waitcnt lgkmcnt(9)
    buffer_load_dwordx4 v40, s[12:15], s41 offen offset:2048 lds
    v_mfma_f32_16x16x32_bf16 v[160:163], a[160:163], a[128:131], v[160:163]
    s_waitcnt lgkmcnt(7)
    ds_read_b64_tr_b16 a[182:183], v34 offset:12288
    ds_read_b64_tr_b16 a[184:185], v35 offset:0
    v_mfma_f32_16x16x32_bf16 v[160:163], a[164:167], a[136:139], v[160:163]
    ds_read_b64_tr_b16 a[186:187], v35 offset:4096
    v_accvgpr_write_b32 a104, 0
    v_mfma_f32_16x16x32_bf16 v[164:167], a[160:163], a[132:135], v[164:167]
    ds_read_b64_tr_b16 a[188:189], v35 offset:8192
    v_accvgpr_write_b32 a105, 0
    v_mfma_f32_16x16x32_bf16 v[164:167], a[164:167], a[140:143], v[164:167]
    s_waitcnt lgkmcnt(9)
    buffer_load_dwordx4 v41, s[12:15], s41 offen offset:3072 lds
    v_mfma_f32_16x16x32_bf16 v[168:171], a[168:171], a[128:131], v[168:171]
    s_waitcnt lgkmcnt(7)
    s_add_u32 s41, s41, 16384
    ds_read_b64_tr_b16 a[190:191], v35 offset:12288
    ds_read_b64_tr_b16 a[160:161], v28 offset:16384
    v_mfma_f32_16x16x32_bf16 v[168:171], a[172:175], a[136:139], v[168:171]
    ds_read_b64_tr_b16 a[162:163], v28 offset:20480
    v_accvgpr_write_b32 a106, 0
    v_mfma_f32_16x16x32_bf16 v[172:175], a[168:171], a[132:135], v[172:175]
    ds_read_b64_tr_b16 a[164:165], v28 offset:24576
    v_accvgpr_write_b32 a107, 0
    v_mfma_f32_16x16x32_bf16 v[172:175], a[172:175], a[140:143], v[172:175]
    s_waitcnt lgkmcnt(9)
    ds_read_b64_tr_b16 a[166:167], v28 offset:28672
    v_accvgpr_write_b32 a108, 0
    v_mfma_f32_16x16x32_bf16 v[176:179], a[176:179], a[128:131], v[176:179]
    s_waitcnt lgkmcnt(8)
    ds_read_b64_tr_b16 a[168:169], v29 offset:16384
    v_accvgpr_write_b32 a109, 0
    v_mfma_f32_16x16x32_bf16 v[176:179], a[180:183], a[136:139], v[176:179]
    ds_read_b64_tr_b16 a[170:171], v29 offset:20480
    v_accvgpr_write_b32 a110, 0
    v_mfma_f32_16x16x32_bf16 v[180:183], a[176:179], a[132:135], v[180:183]
    ds_read_b64_tr_b16 a[172:173], v29 offset:24576
    v_accvgpr_write_b32 a111, 0
    v_mfma_f32_16x16x32_bf16 v[180:183], a[180:183], a[140:143], v[180:183]
    s_waitcnt lgkmcnt(9)
    ds_read_b64_tr_b16 a[174:175], v29 offset:28672
    v_accvgpr_write_b32 a192, 0
    v_mfma_f32_16x16x32_bf16 v[184:187], a[184:187], a[128:131], v[184:187]
    s_waitcnt lgkmcnt(8)
    ds_read_b64_tr_b16 a[176:177], v30 offset:16384
    v_accvgpr_write_b32 a193, 0
    v_mfma_f32_16x16x32_bf16 v[184:187], a[188:191], a[136:139], v[184:187]
    ds_read_b64_tr_b16 a[178:179], v30 offset:20480
    v_accvgpr_write_b32 a194, 0
    v_mfma_f32_16x16x32_bf16 v[188:191], a[184:187], a[132:135], v[188:191]
    ds_read_b64_tr_b16 a[180:181], v30 offset:24576
    v_accvgpr_write_b32 a195, 0
    v_mfma_f32_16x16x32_bf16 v[188:191], a[188:191], a[140:143], v[188:191]
    s_waitcnt lgkmcnt(9)
    ds_read_b64_tr_b16 a[182:183], v30 offset:28672
    v_accvgpr_write_b32 a196, 0
    v_mfma_f32_16x16x32_bf16 v[192:195], a[160:163], a[128:131], v[192:195]
    s_waitcnt lgkmcnt(8)
    ds_read_b64_tr_b16 a[184:185], v31 offset:16384
    v_accvgpr_write_b32 a197, 0
    v_mfma_f32_16x16x32_bf16 v[192:195], a[164:167], a[136:139], v[192:195]
    ds_read_b64_tr_b16 a[186:187], v31 offset:20480
    v_accvgpr_write_b32 a198, 0
    v_mfma_f32_16x16x32_bf16 v[196:199], a[160:163], a[132:135], v[196:199]
    ds_read_b64_tr_b16 a[188:189], v31 offset:24576
    v_accvgpr_write_b32 a199, 0
    v_mfma_f32_16x16x32_bf16 v[196:199], a[164:167], a[140:143], v[196:199]
    s_waitcnt lgkmcnt(9)
    ds_read_b64_tr_b16 a[190:191], v31 offset:28672
    v_accvgpr_write_b32 a200, 0
    v_mfma_f32_16x16x32_bf16 v[200:203], a[168:171], a[128:131], v[200:203]
    s_waitcnt lgkmcnt(8)
    ds_read_b64_tr_b16 a[160:161], v32 offset:16384
    v_accvgpr_write_b32 a201, 0
    v_mfma_f32_16x16x32_bf16 v[200:203], a[172:175], a[136:139], v[200:203]
    ds_read_b64_tr_b16 a[162:163], v32 offset:20480
    v_accvgpr_write_b32 a202, 0
    v_mfma_f32_16x16x32_bf16 v[204:207], a[168:171], a[132:135], v[204:207]
    ds_read_b64_tr_b16 a[164:165], v32 offset:24576
    v_accvgpr_write_b32 a203, 0
    v_mfma_f32_16x16x32_bf16 v[204:207], a[172:175], a[140:143], v[204:207]
    s_waitcnt lgkmcnt(9)
    ds_read_b64_tr_b16 a[166:167], v32 offset:28672
    v_accvgpr_write_b32 a204, 0
    v_mfma_f32_16x16x32_bf16 v[208:211], a[176:179], a[128:131], v[208:211]
    s_waitcnt lgkmcnt(8)
    ds_read_b64_tr_b16 a[168:169], v33 offset:16384
    v_accvgpr_write_b32 a205, 0
    v_mfma_f32_16x16x32_bf16 v[208:211], a[180:183], a[136:139], v[208:211]
    ds_read_b64_tr_b16 a[170:171], v33 offset:20480
    v_accvgpr_write_b32 a206, 0
    v_mfma_f32_16x16x32_bf16 v[212:215], a[176:179], a[132:135], v[212:215]
    ds_read_b64_tr_b16 a[172:173], v33 offset:24576
    v_accvgpr_write_b32 a207, 0
    v_mfma_f32_16x16x32_bf16 v[212:215], a[180:183], a[140:143], v[212:215]
    s_waitcnt lgkmcnt(9)
    ds_read_b64_tr_b16 a[174:175], v33 offset:28672
    v_accvgpr_write_b32 a112, 0
    v_mfma_f32_16x16x32_bf16 v[216:219], a[184:187], a[128:131], v[216:219]
    s_waitcnt lgkmcnt(8)
    ds_read_b64_tr_b16 a[176:177], v34 offset:16384
    v_accvgpr_write_b32 a113, 0
    v_mfma_f32_16x16x32_bf16 v[216:219], a[188:191], a[136:139], v[216:219]
    ds_read_b64_tr_b16 a[178:179], v34 offset:20480
    v_accvgpr_write_b32 a114, 0
    v_mfma_f32_16x16x32_bf16 v[220:223], a[184:187], a[132:135], v[220:223]
    ds_read_b64_tr_b16 a[180:181], v34 offset:24576
    v_accvgpr_write_b32 a115, 0
    v_mfma_f32_16x16x32_bf16 v[220:223], a[188:191], a[140:143], v[220:223]
    s_waitcnt lgkmcnt(9)
    ds_read_b64_tr_b16 a[182:183], v34 offset:28672
    v_accvgpr_write_b32 a116, 0
    v_mfma_f32_16x16x32_bf16 v[224:227], a[160:163], a[128:131], v[224:227]
    s_waitcnt lgkmcnt(8)
    ds_read_b64_tr_b16 a[184:185], v35 offset:16384
    v_accvgpr_write_b32 a117, 0
    v_mfma_f32_16x16x32_bf16 v[224:227], a[164:167], a[136:139], v[224:227]
    ds_read_b64_tr_b16 a[186:187], v35 offset:20480
    v_accvgpr_write_b32 a118, 0
    v_mfma_f32_16x16x32_bf16 v[228:231], a[160:163], a[132:135], v[228:231]
    ds_read_b64_tr_b16 a[188:189], v35 offset:24576
    v_accvgpr_write_b32 a119, 0
    v_mfma_f32_16x16x32_bf16 v[228:231], a[164:167], a[140:143], v[228:231]
    s_waitcnt lgkmcnt(9)
    ds_read_b64_tr_b16 a[190:191], v35 offset:28672
    v_accvgpr_write_b32 a120, 0
    v_mfma_f32_16x16x32_bf16 v[232:235], a[168:171], a[128:131], v[232:235]
    s_waitcnt lgkmcnt(8)
    v_accvgpr_write_b32 a121, 0
    v_mfma_f32_16x16x32_bf16 v[232:235], a[172:175], a[136:139], v[232:235]
    v_accvgpr_write_b32 a122, 0
    v_mfma_f32_16x16x32_bf16 v[236:239], a[168:171], a[132:135], v[236:239]
    v_accvgpr_write_b32 a123, 0
    v_mfma_f32_16x16x32_bf16 v[236:239], a[172:175], a[140:143], v[236:239]
    s_waitcnt lgkmcnt(6)
    v_accvgpr_write_b32 a124, 0
    s_waitcnt vmcnt(16)
    s_barrier
    v_mfma_f32_16x16x32_bf16 v[240:243], a[176:179], a[128:131], v[240:243]
    s_waitcnt lgkmcnt(4)
    ds_read_b128 a[208:211], v8 offset:0
    v_accvgpr_write_b32 a125, 0
    v_mfma_f32_16x16x32_bf16 v[240:243], a[180:183], a[136:139], v[240:243]
    ds_read_b128 a[212:215], v9 offset:0
    v_accvgpr_write_b32 a126, 0
    v_mfma_f32_16x16x32_bf16 v[244:247], a[176:179], a[132:135], v[244:247]
    ds_read_b128 a[216:219], v10 offset:0
    v_accvgpr_write_b32 a127, 0
    v_mfma_f32_16x16x32_bf16 v[244:247], a[180:183], a[140:143], v[244:247]
    s_waitcnt lgkmcnt(5)
    ds_read_b128 a[220:223], v11 offset:0
    v_mfma_f32_16x16x32_bf16 v[248:251], a[184:187], a[128:131], v[248:251]
    s_waitcnt lgkmcnt(4)
    ds_read_b128 a[224:227], v8 offset:4096
    v_mfma_f32_16x16x32_bf16 v[248:251], a[188:191], a[136:139], v[248:251]
    v_mfma_f32_16x16x32_bf16 v[252:255], a[184:187], a[132:135], v[252:255]
    v_mfma_f32_16x16x32_bf16 v[252:255], a[188:191], a[140:143], v[252:255]
    s_waitcnt lgkmcnt(4)
    s_mov_b32 s36, 1040356334
    s_mov_b32 s37, 1040356334
    v_pk_mul_f32 v[128:129], v[128:129], s[36:37]
    v_pk_mul_f32 v[130:131], v[130:131], s[36:37]
    v_pk_mul_f32 v[136:137], v[136:137], s[36:37]
    v_pk_mul_f32 v[138:139], v[138:139], s[36:37]
    v_cvt_pk_bf16_f32 v64, v128, v129
    v_cvt_pk_bf16_f32 v65, v130, v131
    v_cvt_pk_bf16_f32 v66, v136, v137
    v_cvt_pk_bf16_f32 v67, v138, v139
    v_pk_mul_f32 v[132:133], v[132:133], s[36:37]
    v_pk_mul_f32 v[134:135], v[134:135], s[36:37]
    v_pk_mul_f32 v[140:141], v[140:141], s[36:37]
    v_pk_mul_f32 v[142:143], v[142:143], s[36:37]
    v_cvt_pk_bf16_f32 v80, v132, v133
    v_cvt_pk_bf16_f32 v81, v134, v135
    v_cvt_pk_bf16_f32 v82, v140, v141
    v_cvt_pk_bf16_f32 v83, v142, v143
    v_permlane32_swap_b32 v64, v66
    v_permlane32_swap_b32 v65, v67
    v_permlane32_swap_b32 v80, v82
    v_permlane32_swap_b32 v81, v83
    v_permlane16_swap_b32 v64, v66
    v_permlane16_swap_b32 v65, v67
    v_permlane16_swap_b32 v80, v82
    v_permlane16_swap_b32 v81, v83
    v_pk_mul_f32 v[144:145], v[144:145], s[36:37]
    v_pk_mul_f32 v[146:147], v[146:147], s[36:37]
    v_pk_mul_f32 v[152:153], v[152:153], s[36:37]
    v_pk_mul_f32 v[154:155], v[154:155], s[36:37]
    v_cvt_pk_bf16_f32 v68, v144, v145
    v_cvt_pk_bf16_f32 v69, v146, v147
    v_cvt_pk_bf16_f32 v70, v152, v153
    v_cvt_pk_bf16_f32 v71, v154, v155
    v_pk_mul_f32 v[148:149], v[148:149], s[36:37]
    v_pk_mul_f32 v[150:151], v[150:151], s[36:37]
    v_pk_mul_f32 v[156:157], v[156:157], s[36:37]
    v_pk_mul_f32 v[158:159], v[158:159], s[36:37]
    v_cvt_pk_bf16_f32 v84, v148, v149
    v_cvt_pk_bf16_f32 v85, v150, v151
    v_cvt_pk_bf16_f32 v86, v156, v157
    v_cvt_pk_bf16_f32 v87, v158, v159
    v_permlane32_swap_b32 v68, v70
    v_permlane32_swap_b32 v69, v71
    v_permlane32_swap_b32 v84, v86
    v_permlane32_swap_b32 v85, v87
    v_permlane16_swap_b32 v68, v70
    v_permlane16_swap_b32 v69, v71
    v_permlane16_swap_b32 v84, v86
    v_permlane16_swap_b32 v85, v87
    v_pk_mul_f32 v[160:161], v[160:161], s[36:37]
    v_pk_mul_f32 v[162:163], v[162:163], s[36:37]
    v_pk_mul_f32 v[168:169], v[168:169], s[36:37]
    v_pk_mul_f32 v[170:171], v[170:171], s[36:37]
    v_cvt_pk_bf16_f32 v72, v160, v161
    v_cvt_pk_bf16_f32 v73, v162, v163
    v_cvt_pk_bf16_f32 v74, v168, v169
    v_cvt_pk_bf16_f32 v75, v170, v171
    v_pk_mul_f32 v[164:165], v[164:165], s[36:37]
    v_pk_mul_f32 v[166:167], v[166:167], s[36:37]
    v_pk_mul_f32 v[172:173], v[172:173], s[36:37]
    v_pk_mul_f32 v[174:175], v[174:175], s[36:37]
    v_cvt_pk_bf16_f32 v88, v164, v165
    v_cvt_pk_bf16_f32 v89, v166, v167
    v_cvt_pk_bf16_f32 v90, v172, v173
    v_cvt_pk_bf16_f32 v91, v174, v175
    v_permlane32_swap_b32 v72, v74
    v_permlane32_swap_b32 v73, v75
    v_permlane32_swap_b32 v88, v90
    v_permlane32_swap_b32 v89, v91
    v_permlane16_swap_b32 v72, v74
    v_permlane16_swap_b32 v73, v75
    v_permlane16_swap_b32 v88, v90
    v_permlane16_swap_b32 v89, v91
    v_pk_mul_f32 v[176:177], v[176:177], s[36:37]
    v_pk_mul_f32 v[178:179], v[178:179], s[36:37]
    v_pk_mul_f32 v[184:185], v[184:185], s[36:37]
    v_pk_mul_f32 v[186:187], v[186:187], s[36:37]
    v_cvt_pk_bf16_f32 v76, v176, v177
    v_cvt_pk_bf16_f32 v77, v178, v179
    v_cvt_pk_bf16_f32 v78, v184, v185
    v_cvt_pk_bf16_f32 v79, v186, v187
    v_pk_mul_f32 v[180:181], v[180:181], s[36:37]
    v_pk_mul_f32 v[182:183], v[182:183], s[36:37]
    v_pk_mul_f32 v[188:189], v[188:189], s[36:37]
    v_pk_mul_f32 v[190:191], v[190:191], s[36:37]
    v_cvt_pk_bf16_f32 v92, v180, v181
    v_cvt_pk_bf16_f32 v93, v182, v183
    v_cvt_pk_bf16_f32 v94, v188, v189
    v_cvt_pk_bf16_f32 v95, v190, v191
    v_permlane32_swap_b32 v76, v78
    v_permlane32_swap_b32 v77, v79
    v_permlane32_swap_b32 v92, v94
    v_permlane32_swap_b32 v93, v95
    v_permlane16_swap_b32 v76, v78
    v_permlane16_swap_b32 v77, v79
    v_permlane16_swap_b32 v92, v94
    v_permlane16_swap_b32 v93, v95
    v_pk_mul_f32 v[192:193], v[192:193], s[36:37]
    v_pk_mul_f32 v[194:195], v[194:195], s[36:37]
    v_pk_mul_f32 v[200:201], v[200:201], s[36:37]
    v_pk_mul_f32 v[202:203], v[202:203], s[36:37]
    v_cvt_pk_bf16_f32 v96, v192, v193
    v_cvt_pk_bf16_f32 v97, v194, v195
    v_cvt_pk_bf16_f32 v98, v200, v201
    v_cvt_pk_bf16_f32 v99, v202, v203
    v_pk_mul_f32 v[196:197], v[196:197], s[36:37]
    v_pk_mul_f32 v[198:199], v[198:199], s[36:37]
    v_pk_mul_f32 v[204:205], v[204:205], s[36:37]
    v_pk_mul_f32 v[206:207], v[206:207], s[36:37]
    v_cvt_pk_bf16_f32 v112, v196, v197
    v_cvt_pk_bf16_f32 v113, v198, v199
    v_cvt_pk_bf16_f32 v114, v204, v205
    v_cvt_pk_bf16_f32 v115, v206, v207
    v_permlane32_swap_b32 v96, v98
    v_permlane32_swap_b32 v97, v99
    v_permlane32_swap_b32 v112, v114
    v_permlane32_swap_b32 v113, v115
    v_permlane16_swap_b32 v96, v98
    v_permlane16_swap_b32 v97, v99
    v_permlane16_swap_b32 v112, v114
    v_permlane16_swap_b32 v113, v115
    v_pk_mul_f32 v[208:209], v[208:209], s[36:37]
    v_pk_mul_f32 v[210:211], v[210:211], s[36:37]
    v_pk_mul_f32 v[216:217], v[216:217], s[36:37]
    v_pk_mul_f32 v[218:219], v[218:219], s[36:37]
    v_cvt_pk_bf16_f32 v100, v208, v209
    v_cvt_pk_bf16_f32 v101, v210, v211
    v_cvt_pk_bf16_f32 v102, v216, v217
    v_cvt_pk_bf16_f32 v103, v218, v219
    v_pk_mul_f32 v[212:213], v[212:213], s[36:37]
    v_pk_mul_f32 v[214:215], v[214:215], s[36:37]
    v_pk_mul_f32 v[220:221], v[220:221], s[36:37]
    v_pk_mul_f32 v[222:223], v[222:223], s[36:37]
    v_cvt_pk_bf16_f32 v116, v212, v213
    v_cvt_pk_bf16_f32 v117, v214, v215
    v_cvt_pk_bf16_f32 v118, v220, v221
    v_cvt_pk_bf16_f32 v119, v222, v223
    v_permlane32_swap_b32 v100, v102
    v_permlane32_swap_b32 v101, v103
    v_permlane32_swap_b32 v116, v118
    v_permlane32_swap_b32 v117, v119
    v_permlane16_swap_b32 v100, v102
    v_permlane16_swap_b32 v101, v103
    v_permlane16_swap_b32 v116, v118
    v_permlane16_swap_b32 v117, v119
    v_pk_mul_f32 v[224:225], v[224:225], s[36:37]
    v_pk_mul_f32 v[226:227], v[226:227], s[36:37]
    v_pk_mul_f32 v[232:233], v[232:233], s[36:37]
    v_pk_mul_f32 v[234:235], v[234:235], s[36:37]
    v_cvt_pk_bf16_f32 v104, v224, v225
    v_cvt_pk_bf16_f32 v105, v226, v227
    v_cvt_pk_bf16_f32 v106, v232, v233
    v_cvt_pk_bf16_f32 v107, v234, v235
    v_pk_mul_f32 v[228:229], v[228:229], s[36:37]
    v_pk_mul_f32 v[230:231], v[230:231], s[36:37]
    v_pk_mul_f32 v[236:237], v[236:237], s[36:37]
    v_pk_mul_f32 v[238:239], v[238:239], s[36:37]
    v_cvt_pk_bf16_f32 v120, v228, v229
    v_cvt_pk_bf16_f32 v121, v230, v231
    v_cvt_pk_bf16_f32 v122, v236, v237
    v_cvt_pk_bf16_f32 v123, v238, v239
    v_permlane32_swap_b32 v104, v106
    v_permlane32_swap_b32 v105, v107
    v_permlane32_swap_b32 v120, v122
    v_permlane32_swap_b32 v121, v123
    v_permlane16_swap_b32 v104, v106
    v_permlane16_swap_b32 v105, v107
    v_permlane16_swap_b32 v120, v122
    v_permlane16_swap_b32 v121, v123
    v_pk_mul_f32 v[240:241], v[240:241], s[36:37]
    v_pk_mul_f32 v[242:243], v[242:243], s[36:37]
    v_pk_mul_f32 v[248:249], v[248:249], s[36:37]
    v_pk_mul_f32 v[250:251], v[250:251], s[36:37]
    v_cvt_pk_bf16_f32 v108, v240, v241
    v_cvt_pk_bf16_f32 v109, v242, v243
    v_cvt_pk_bf16_f32 v110, v248, v249
    v_cvt_pk_bf16_f32 v111, v250, v251
    v_pk_mul_f32 v[244:245], v[244:245], s[36:37]
    v_pk_mul_f32 v[246:247], v[246:247], s[36:37]
    v_pk_mul_f32 v[252:253], v[252:253], s[36:37]
    v_pk_mul_f32 v[254:255], v[254:255], s[36:37]
    v_cvt_pk_bf16_f32 v124, v244, v245
    v_cvt_pk_bf16_f32 v125, v246, v247
    v_cvt_pk_bf16_f32 v126, v252, v253
    v_cvt_pk_bf16_f32 v127, v254, v255
    v_permlane32_swap_b32 v108, v110
    v_permlane32_swap_b32 v109, v111
    v_permlane32_swap_b32 v124, v126
    v_permlane32_swap_b32 v125, v127
    v_permlane16_swap_b32 v108, v110
    v_permlane16_swap_b32 v109, v111
    v_permlane16_swap_b32 v124, v126
    v_permlane16_swap_b32 v125, v127
    v_mfma_f32_16x16x32_bf16 v[216:219], a[208:211], v[64:67], 0
    s_waitcnt lgkmcnt(3)
    v_mfma_f32_16x16x32_bf16 v[216:219], a[212:215], v[68:71], v[216:219]
    s_waitcnt lgkmcnt(2)
    v_mfma_f32_16x16x32_bf16 v[216:219], a[216:219], v[72:75], v[216:219]
    s_waitcnt lgkmcnt(1)
    v_mfma_f32_16x16x32_bf16 v[216:219], a[220:223], v[76:79], v[216:219]
    v_mfma_f32_16x16x32_bf16 v[220:223], a[208:211], v[80:83], 0
    v_mfma_f32_16x16x32_bf16 v[220:223], a[212:215], v[84:87], v[220:223]
    v_mfma_f32_16x16x32_bf16 v[220:223], a[216:219], v[88:91], v[220:223]
    v_mfma_f32_16x16x32_bf16 v[220:223], a[220:223], v[92:95], v[220:223]
    v_mfma_f32_16x16x32_bf16 v[224:227], a[208:211], v[96:99], 0
    v_mfma_f32_16x16x32_bf16 v[224:227], a[212:215], v[100:103], v[224:227]
    v_mfma_f32_16x16x32_bf16 v[224:227], a[216:219], v[104:107], v[224:227]
    v_mfma_f32_16x16x32_bf16 v[224:227], a[220:223], v[108:111], v[224:227]
    v_mfma_f32_16x16x32_bf16 v[228:231], a[208:211], v[112:115], 0
    v_mfma_f32_16x16x32_bf16 v[228:231], a[212:215], v[116:119], v[228:231]
    v_mfma_f32_16x16x32_bf16 v[228:231], a[216:219], v[120:123], v[228:231]
    v_mfma_f32_16x16x32_bf16 v[228:231], a[220:223], v[124:127], v[228:231]
    v_max3_f32 v232, v216, v217, v218
    v_max_f32 v232, v232, v219
    v_max3_f32 v233, v220, v221, v222
    v_max_f32 v233, v233, v223
    v_max3_f32 v234, v224, v225, v226
    v_max_f32 v234, v234, v227
    s_nop 1
    v_max3_f32 v235, v228, v229, v230
    v_max_f32 v235, v235, v231
    v_mov_b32 v236, v232
    v_mov_b32 v237, v233
    v_mov_b32 v238, v234
    v_mov_b32 v239, v235
    v_permlane16_swap_b32 v232, v236
    v_permlane16_swap_b32 v233, v237
    v_permlane16_swap_b32 v234, v238
    v_permlane16_swap_b32 v235, v239
    v_max_f32 v232, v232, v236
    v_max_f32 v233, v233, v237
    v_max_f32 v234, v234, v238
    v_max_f32 v235, v235, v239
    v_mov_b32 v236, v232
    v_mov_b32 v237, v233
    v_mov_b32 v238, v234
    v_mov_b32 v239, v235
    v_permlane32_swap_b32 v232, v236
    v_permlane32_swap_b32 v233, v237
    v_permlane32_swap_b32 v234, v238
    v_permlane32_swap_b32 v235, v239
    v_max_f32 v232, v232, v236
    v_max_f32 v233, v233, v237
    v_max_f32 v234, v234, v238
    v_max_f32 v235, v235, v239
    v_sub_f32 v192, 3250585600, v232
    v_sub_f32 v193, 3250585600, v232
    v_sub_f32 v194, 3250585600, v232
    v_sub_f32 v195, 3250585600, v232
    v_sub_f32 v196, 3250585600, v233
    v_sub_f32 v197, 3250585600, v233
    v_sub_f32 v198, 3250585600, v233
    v_sub_f32 v199, 3250585600, v233
    v_sub_f32 v200, 3250585600, v234
    v_sub_f32 v201, 3250585600, v234
    v_sub_f32 v202, 3250585600, v234
    v_sub_f32 v203, 3250585600, v234
    v_sub_f32 v204, 3250585600, v235
    v_sub_f32 v205, 3250585600, v235
    v_sub_f32 v206, 3250585600, v235
    v_sub_f32 v207, 3250585600, v235
Lattn_stage0:
    s_mov_b32 s43, 7
    v_mfma_f32_16x16x32_bf16 v[208:211], a[208:211], v[64:67], v[192:195]
    v_mfma_f32_16x16x32_bf16 v[208:211], a[212:215], v[68:71], v[208:211]
    v_mfma_f32_16x16x32_bf16 v[208:211], a[216:219], v[72:75], v[208:211]
    v_mfma_f32_16x16x32_bf16 v[208:211], a[220:223], v[76:79], v[208:211]
    s_lshr_b32 s6, s2, 3
    ds_read_b128 a[228:231], v9 offset:4096
    v_mfma_f32_16x16x32_bf16 v[212:215], a[208:211], v[80:83], v[196:199]
    s_nop 4
    v_exp_f32 v208, v208
    v_mfma_f32_16x16x32_bf16 v[212:215], a[212:215], v[84:87], v[212:215]
    v_exp_f32 v209, v209
    v_mfma_f32_16x16x32_bf16 v[212:215], a[216:219], v[88:91], v[212:215]
    v_exp_f32 v210, v210
    v_mfma_f32_16x16x32_bf16 v[212:215], a[220:223], v[92:95], v[212:215]
    v_exp_f32 v211, v211
    v_cvt_pk_bf16_f32 v128, v208, v209
    s_and_b32 s7, s2, 7
    ds_read_b128 a[232:235], v10 offset:4096
    v_cvt_pk_bf16_f32 v129, v210, v211
    v_mfma_f32_16x16x32_bf16 v[208:211], a[208:211], v[96:99], v[200:203]
    s_nop 1
    v_exp_f32 v212, v212
    v_mfma_f32_16x16x32_bf16 v[208:211], a[212:215], v[100:103], v[208:211]
    v_exp_f32 v213, v213
    v_mfma_f32_16x16x32_bf16 v[208:211], a[216:219], v[104:107], v[208:211]
    v_exp_f32 v214, v214
    v_mfma_f32_16x16x32_bf16 v[208:211], a[220:223], v[108:111], v[208:211]
    v_exp_f32 v215, v215
    v_cvt_pk_bf16_f32 v136, v212, v213
    s_mul_i32 s7, s7, 18
    ds_read_b128 a[236:239], v11 offset:4096
    v_cvt_pk_bf16_f32 v137, v214, v215
    s_mul_i32 s49, s5, 18432
    s_add_u32 s49, s49, s45
    v_lshlrev_b32 v220, 6, v0
    v_mfma_f32_16x16x32_bf16 v[212:215], a[208:211], v[112:115], v[204:207]
    v_exp_f32 v208, v208
    v_mfma_f32_16x16x32_bf16 v[212:215], a[212:215], v[116:119], v[212:215]
    v_exp_f32 v209, v209
    v_mfma_f32_16x16x32_bf16 v[212:215], a[216:219], v[120:123], v[212:215]
    v_exp_f32 v210, v210
    v_mfma_f32_16x16x32_bf16 v[212:215], a[220:223], v[124:127], v[212:215]
    s_waitcnt lgkmcnt(3)
    v_exp_f32 v211, v211
    v_cvt_pk_bf16_f32 v144, v208, v209
    s_add_u32 s7, s7, s6
    ds_read_b128 a[208:211], v8 offset:8192
    v_cvt_pk_bf16_f32 v145, v210, v211
    buffer_load_dword v221, v220, s[20:23], s49 offen
    v_mfma_f32_16x16x32_bf16 v[208:211], a[224:227], v[64:67], v[192:195]
    s_waitcnt lgkmcnt(3)
    v_exp_f32 v212, v212
    v_mfma_f32_16x16x32_bf16 v[208:211], a[228:231], v[68:71], v[208:211]
    s_waitcnt lgkmcnt(2)
    v_exp_f32 v213, v213
    v_mfma_f32_16x16x32_bf16 v[208:211], a[232:235], v[72:75], v[208:211]
    s_waitcnt lgkmcnt(1)
    v_exp_f32 v214, v214
    v_mfma_f32_16x16x32_bf16 v[208:211], a[236:239], v[76:79], v[208:211]
Ltour3:
    s_cbranch_execz Ltour7
    v_exp_f32 v215, v215
    v_cvt_pk_bf16_f32 v152, v212, v213
    s_lshl_b32 s58, s7, 6
    ds_read_b128 a[212:215], v9 offset:8192
    v_cvt_pk_bf16_f32 v153, v214, v215
    s_add_u32 s49, s49, 16384
    v_mfma_f32_16x16x32_bf16 v[212:215], a[224:227], v[80:83], v[196:199]
    s_nop 0
    v_exp_f32 v208, v208
    v_mfma_f32_16x16x32_bf16 v[212:215], a[228:231], v[84:87], v[212:215]
    v_exp_f32 v209, v209
    v_mfma_f32_16x16x32_bf16 v[212:215], a[232:235], v[88:91], v[212:215]
    v_exp_f32 v210, v210
    v_mfma_f32_16x16x32_bf16 v[212:215], a[236:239], v[92:95], v[212:215]
    v_exp_f32 v211, v211
    v_cvt_pk_bf16_f32 v130, v208, v209
    s_mul_i32 s59, s7, 36864
    ds_read_b128 a[216:219], v10 offset:8192
    v_cvt_pk_bf16_f32 v131, v210, v211
    buffer_load_dword v222, v220, s[20:23], s49 offen
    v_mfma_f32_16x16x32_bf16 v[208:211], a[224:227], v[96:99], v[200:203]
    s_nop 0
    v_exp_f32 v212, v212
    v_mfma_f32_16x16x32_bf16 v[208:211], a[228:231], v[100:103], v[208:211]
    v_exp_f32 v213, v213
    v_mfma_f32_16x16x32_bf16 v[208:211], a[232:235], v[104:107], v[208:211]
    v_exp_f32 v214, v214
    v_mfma_f32_16x16x32_bf16 v[208:211], a[236:239], v[108:111], v[208:211]
    v_exp_f32 v215, v215
    v_cvt_pk_bf16_f32 v138, v212, v213
    s_cmp_lt_u32 s6, 18
    s_cselect_b32 s7, 0, 2147483648
    ds_read_b128 a[220:223], v11 offset:8192
    v_cvt_pk_bf16_f32 v139, v214, v215
    s_mov_b32 s39, 221184
    s_mov_b32 s38, 27648
    v_mfma_f32_16x16x32_bf16 v[212:215], a[224:227], v[112:115], v[204:207]
    v_exp_f32 v208, v208
    v_mfma_f32_16x16x32_bf16 v[212:215], a[228:231], v[116:119], v[212:215]
    v_exp_f32 v209, v209
    v_mfma_f32_16x16x32_bf16 v[212:215], a[232:235], v[120:123], v[212:215]
    v_exp_f32 v210, v210
    v_mfma_f32_16x16x32_bf16 v[212:215], a[236:239], v[124:127], v[212:215]
    s_waitcnt lgkmcnt(3)
    v_exp_f32 v211, v211
    v_cvt_pk_bf16_f32 v146, v208, v209
    s_or_b32 s58, s58, s7
    ds_read_b128 a[224:227], v8 offset:12288
    v_cvt_pk_bf16_f32 v147, v210, v211
    v_mfma_f32_16x16x32_bf16 v[208:211], a[208:211], v[64:67], v[192:195]
    s_waitcnt lgkmcnt(3)
    v_exp_f32 v212, v212
    v_mfma_f32_16x16x32_bf16 v[208:211], a[212:215], v[68:71], v[208:211]
    s_waitcnt lgkmcnt(2)
    v_exp_f32 v213, v213
    v_mfma_f32_16x16x32_bf16 v[208:211], a[216:219], v[72:75], v[208:211]
    s_waitcnt lgkmcnt(1)
    v_exp_f32 v214, v214
    v_mfma_f32_16x16x32_bf16 v[208:211], a[220:223], v[76:79], v[208:211]
    v_exp_f32 v215, v215
    v_cvt_pk_bf16_f32 v154, v212, v213
    s_or_b32 s59, s59, s7
    ds_read_b128 a[228:231], v9 offset:12288
    v_cvt_pk_bf16_f32 v155, v214, v215
    v_mfma_f32_16x16x32_bf16 v[212:215], a[208:211], v[80:83], v[196:199]
    s_nop 1
    v_exp_f32 v208, v208
    v_mfma_f32_16x16x32_bf16 v[212:215], a[212:215], v[84:87], v[212:215]
    v_exp_f32 v209, v209
    v_mfma_f32_16x16x32_bf16 v[212:215], a[216:219], v[88:91], v[212:215]
    v_exp_f32 v210, v210
    v_mfma_f32_16x16x32_bf16 v[212:215], a[220:223], v[92:95], v[212:215]
    v_exp_f32 v211, v211
    v_cvt_pk_bf16_f32 v132, v208, v209
    v_lshrrev_b32 v51, 2, v0
    ds_read_b128 a[232:235], v10 offset:12288
    v_cvt_pk_bf16_f32 v133, v210, v211
    v_mfma_f32_16x16x32_bf16 v[208:211], a[208:211], v[96:99], v[200:203]
    s_nop 1
    v_exp_f32 v212, v212
    v_mfma_f32_16x16x32_bf16 v[208:211], a[212:215], v[100:103], v[208:211]
    v_exp_f32 v213, v213
    v_mfma_f32_16x16x32_bf16 v[208:211], a[216:219], v[104:107], v[208:211]
    v_exp_f32 v214, v214
    v_mfma_f32_16x16x32_bf16 v[208:211], a[220:223], v[108:111], v[208:211]
    v_exp_f32 v215, v215
    v_cvt_pk_bf16_f32 v140, v212, v213
    v_mul_u32_u24 v51, 9216, v51
    ds_read_b128 a[236:239], v11 offset:12288
    v_cvt_pk_bf16_f32 v141, v214, v215
    s_waitcnt vmcnt(6)
    s_barrier
    v_mfma_f32_16x16x32_bf16 v[212:215], a[208:211], v[112:115], v[204:207]
    v_exp_f32 v208, v208
    v_mfma_f32_16x16x32_bf16 v[212:215], a[212:215], v[116:119], v[212:215]
    s_add_u32 m0, s42, 49152
    v_exp_f32 v209, v209
    v_mfma_f32_16x16x32_bf16 v[212:215], a[216:219], v[120:123], v[212:215]
    v_exp_f32 v210, v210
    v_mfma_f32_16x16x32_bf16 v[212:215], a[220:223], v[124:127], v[212:215]
    s_waitcnt lgkmcnt(3)
    v_exp_f32 v211, v211
    v_cvt_pk_bf16_f32 v148, v208, v209
    v_and_b32 v254, 3, v0
    ds_read_b128 a[208:211], v8 offset:16384
    v_cvt_pk_bf16_f32 v149, v210, v211
    buffer_load_dwordx4 v36, s[8:11], s40 offen lds
    v_mfma_f32_16x16x32_bf16 v[208:211], a[224:227], v[64:67], v[192:195]
    s_waitcnt lgkmcnt(3)
    v_exp_f32 v212, v212
    v_mfma_f32_16x16x32_bf16 v[208:211], a[228:231], v[68:71], v[208:211]
    s_waitcnt lgkmcnt(2)
    v_exp_f32 v213, v213
    v_mfma_f32_16x16x32_bf16 v[208:211], a[232:235], v[72:75], v[208:211]
    s_waitcnt lgkmcnt(1)
    v_exp_f32 v214, v214
    v_mfma_f32_16x16x32_bf16 v[208:211], a[236:239], v[76:79], v[208:211]
    v_exp_f32 v215, v215
    v_cvt_pk_bf16_f32 v156, v212, v213
    v_lshl_add_u32 v254, v254, 4, v51
    ds_read_b128 a[212:215], v9 offset:16384
    v_cvt_pk_bf16_f32 v157, v214, v215
    v_mfma_f32_16x16x32_bf16 v[212:215], a[224:227], v[80:83], v[196:199]
    s_nop 1
    v_exp_f32 v208, v208
    v_mfma_f32_16x16x32_bf16 v[212:215], a[228:231], v[84:87], v[212:215]
    v_exp_f32 v209, v209
    v_mfma_f32_16x16x32_bf16 v[212:215], a[232:235], v[88:91], v[212:215]
    v_exp_f32 v210, v210
    v_mfma_f32_16x16x32_bf16 v[212:215], a[236:239], v[92:95], v[212:215]
    v_exp_f32 v211, v211
    ds_read_b64_tr_b16 a[160:161], v20 offset:0
    v_cvt_pk_bf16_f32 v134, v208, v209
    ds_read_b64_tr_b16 a[162:163], v20 offset:4096
    v_lshlrev_b32 v255, 4, v0
    ds_read_b128 a[216:219], v10 offset:16384
    v_cvt_pk_bf16_f32 v135, v210, v211
    buffer_load_dwordx4 v37, s[8:11], s40 offen offset:1024 lds
    v_mfma_f32_16x16x32_bf16 v[208:211], a[224:227], v[96:99], v[200:203]
    v_exp_f32 v212, v212
    v_mfma_f32_16x16x32_bf16 v[208:211], a[228:231], v[100:103], v[208:211]
    v_exp_f32 v213, v213
    v_mfma_f32_16x16x32_bf16 v[208:211], a[232:235], v[104:107], v[208:211]
    v_exp_f32 v214, v214
    v_mfma_f32_16x16x32_bf16 v[208:211], a[236:239], v[108:111], v[208:211]
    v_exp_f32 v215, v215
    ds_read_b64_tr_b16 a[164:165], v20 offset:8192
    v_cvt_pk_bf16_f32 v142, v212, v213
    ds_read_b64_tr_b16 a[166:167], v20 offset:12288
    v_add_u32 v51, 98304, v255
    ds_read_b128 a[220:223], v11 offset:16384
    v_cvt_pk_bf16_f32 v143, v214, v215
    v_mfma_f32_16x16x32_bf16 v[212:215], a[224:227], v[112:115], v[204:207]
    v_exp_f32 v208, v208
    v_mfma_f32_16x16x32_bf16 v[212:215], a[228:231], v[116:119], v[212:215]
    v_exp_f32 v209, v209
    v_mfma_f32_16x16x32_bf16 v[212:215], a[232:235], v[120:123], v[212:215]
    v_exp_f32 v210, v210
    v_mfma_f32_16x16x32_bf16 v[212:215], a[236:239], v[124:127], v[212:215]
    v_exp_f32 v211, v211
    ds_read_b64_tr_b16 a[168:169], v21 offset:0
    v_cvt_pk_bf16_f32 v150, v208, v209
    ds_read_b64_tr_b16 a[170:171], v21 offset:4096
    ds_read_b128 a[224:227], v8 offset:20480
    v_cvt_pk_bf16_f32 v151, v210, v211
    s_waitcnt lgkmcnt(3)
    buffer_load_dwordx4 v38, s[8:11], s40 offen offset:2048 lds
Lattn_loop:
    v_mfma_f32_16x16x32_bf16 v[208:211], a[208:211], v[64:67], v[192:195]
    v_exp_f32 v212, v212
    v_mfma_f32_16x16x32_bf16 v[208:211], a[212:215], v[68:71], v[208:211]
    v_exp_f32 v213, v213
    v_mfma_f32_16x16x32_bf16 v[208:211], a[216:219], v[72:75], v[208:211]
    v_exp_f32 v214, v214
    v_mfma_f32_16x16x32_bf16 v[208:211], a[220:223], v[76:79], v[208:211]
    v_exp_f32 v215, v215
    v_mfma_f32_16x16x32_bf16 a[0:3], a[160:163], v[128:131], a[0:3]
    ds_read_b64_tr_b16 a[172:173], v21 offset:8192
    v_cvt_pk_bf16_f32 v158, v212, v213
    v_mfma_f32_16x16x32_bf16 a[0:3], a[164:167], v[132:135], a[0:3]
    ds_read_b64_tr_b16 a[174:175], v21 offset:12288
    v_mfma_f32_16x16x32_bf16 a[4:7], a[160:163], v[136:139], a[4:7]
    ds_read_b128 a[228:231], v9 offset:20480
    v_cvt_pk_bf16_f32 v159, v214, v215
    v_mfma_f32_16x16x32_bf16 a[4:7], a[164:167], v[140:143], a[4:7]
    v_mfma_f32_16x16x32_bf16 v[212:215], a[208:211], v[80:83], v[196:199]
    v_exp_f32 v208, v208
    v_mfma_f32_16x16x32_bf16 v[212:215], a[212:215], v[84:87], v[212:215]
    v_exp_f32 v209, v209
    v_mfma_f32_16x16x32_bf16 v[212:215], a[216:219], v[88:91], v[212:215]
    v_exp_f32 v210, v210
    v_mfma_f32_16x16x32_bf16 v[212:215], a[220:223], v[92:95], v[212:215]
    v_exp_f32 v211, v211
    v_mfma_f32_16x16x32_bf16 a[8:11], a[160:163], v[144:147], a[8:11]
    ds_read_b64_tr_b16 a[176:177], v22 offset:0
    v_cvt_pk_bf16_f32 v160, v208, v209
    v_mfma_f32_16x16x32_bf16 a[8:11], a[164:167], v[148:151], a[8:11]
    ds_read_b64_tr_b16 a[178:179], v22 offset:4096
    v_mfma_f32_16x16x32_bf16 a[12:15], a[160:163], v[152:155], a[12:15]
    ds_read_b128 a[232:235], v10 offset:20480
    v_cvt_pk_bf16_f32 v161, v210, v211
    v_mfma_f32_16x16x32_bf16 a[12:15], a[164:167], v[156:159], a[12:15]
    s_waitcnt lgkmcnt(3)
    buffer_load_dwordx4 v39, s[8:11], s40 offen offset:3072 lds
    v_mfma_f32_16x16x32_bf16 v[208:211], a[208:211], v[96:99], v[200:203]
    v_exp_f32 v212, v212
    v_mfma_f32_16x16x32_bf16 v[208:211], a[212:215], v[100:103], v[208:211]
    s_add_u32 s40, s40, 16384
    v_exp_f32 v213, v213
    v_mfma_f32_16x16x32_bf16 v[208:211], a[216:219], v[104:107], v[208:211]
    v_exp_f32 v214, v214
    v_mfma_f32_16x16x32_bf16 v[208:211], a[220:223], v[108:111], v[208:211]
    v_exp_f32 v215, v215
    v_mfma_f32_16x16x32_bf16 a[16:19], a[168:171], v[128:131], a[16:19]
    ds_read_b64_tr_b16 a[180:181], v22 offset:8192
    v_cvt_pk_bf16_f32 v168, v212, v213
    v_mfma_f32_16x16x32_bf16 a[16:19], a[172:175], v[132:135], a[16:19]
    ds_read_b64_tr_b16 a[182:183], v22 offset:12288
    v_mfma_f32_16x16x32_bf16 a[20:23], a[168:171], v[136:139], a[20:23]
    ds_read_b128 a[236:239], v11 offset:20480
    v_cvt_pk_bf16_f32 v169, v214, v215
    v_mfma_f32_16x16x32_bf16 a[20:23], a[172:175], v[140:143], a[20:23]
    v_smfmac_f32_16x16x64_bf16 a[192:195], v[52:55], v[128:135], v50
    v_mfma_f32_16x16x32_bf16 v[212:215], a[208:211], v[112:115], v[204:207]
    v_exp_f32 v208, v208
    v_mfma_f32_16x16x32_bf16 v[212:215], a[212:215], v[116:119], v[212:215]
    s_add_u32 m0, s42, 98304
    v_exp_f32 v209, v209
    v_mfma_f32_16x16x32_bf16 v[212:215], a[216:219], v[120:123], v[212:215]
    v_exp_f32 v210, v210
    v_mfma_f32_16x16x32_bf16 v[212:215], a[220:223], v[124:127], v[212:215]
    v_exp_f32 v211, v211
    v_mfma_f32_16x16x32_bf16 a[24:27], a[168:171], v[144:147], a[24:27]
    ds_read_b64_tr_b16 a[184:185], v23 offset:0
    v_cvt_pk_bf16_f32 v176, v208, v209
    v_mfma_f32_16x16x32_bf16 a[24:27], a[172:175], v[148:151], a[24:27]
    ds_read_b64_tr_b16 a[186:187], v23 offset:4096
    v_mfma_f32_16x16x32_bf16 a[28:31], a[168:171], v[152:155], a[28:31]
    ds_read_b128 a[208:211], v8 offset:24576
    v_cvt_pk_bf16_f32 v177, v210, v211
    v_mfma_f32_16x16x32_bf16 a[28:31], a[172:175], v[156:159], a[28:31]
    s_waitcnt lgkmcnt(3)
    buffer_load_dwordx4 v40, s[12:15], s41 offen lds
    v_mfma_f32_16x16x32_bf16 v[208:211], a[224:227], v[64:67], v[192:195]
    v_exp_f32 v212, v212
    v_mfma_f32_16x16x32_bf16 v[208:211], a[228:231], v[68:71], v[208:211]
    v_exp_f32 v213, v213
    v_mfma_f32_16x16x32_bf16 v[208:211], a[232:235], v[72:75], v[208:211]
    v_exp_f32 v214, v214
    v_mfma_f32_16x16x32_bf16 v[208:211], a[236:239], v[76:79], v[208:211]
    v_exp_f32 v215, v215
    v_mfma_f32_16x16x32_bf16 a[32:35], a[176:179], v[128:131], a[32:35]
    ds_read_b64_tr_b16 a[188:189], v23 offset:8192
    v_cvt_pk_bf16_f32 v184, v212, v213
    v_mfma_f32_16x16x32_bf16 a[32:35], a[180:183], v[132:135], a[32:35]
    ds_read_b64_tr_b16 a[190:191], v23 offset:12288
    v_mfma_f32_16x16x32_bf16 a[36:39], a[176:179], v[136:139], a[36:39]
    ds_read_b128 a[212:215], v9 offset:24576
    v_cvt_pk_bf16_f32 v185, v214, v215
    v_mfma_f32_16x16x32_bf16 a[36:39], a[180:183], v[140:143], a[36:39]
    v_smfmac_f32_16x16x64_bf16 a[196:199], v[52:55], v[136:143], v50
    v_mfma_f32_16x16x32_bf16 v[212:215], a[224:227], v[80:83], v[196:199]
    v_exp_f32 v208, v208
    v_mfma_f32_16x16x32_bf16 v[212:215], a[228:231], v[84:87], v[212:215]
    v_exp_f32 v209, v209
    v_mfma_f32_16x16x32_bf16 v[212:215], a[232:235], v[88:91], v[212:215]
    v_exp_f32 v210, v210
    v_mfma_f32_16x16x32_bf16 v[212:215], a[236:239], v[92:95], v[212:215]
    v_exp_f32 v211, v211
    v_mfma_f32_16x16x32_bf16 a[40:43], a[176:179], v[144:147], a[40:43]
    ds_read_b64_tr_b16 a[160:161], v24 offset:0
    v_cvt_pk_bf16_f32 v162, v208, v209
    v_mfma_f32_16x16x32_bf16 a[40:43], a[180:183], v[148:151], a[40:43]
    ds_read_b64_tr_b16 a[162:163], v24 offset:4096
    v_mfma_f32_16x16x32_bf16 a[44:47], a[176:179], v[152:155], a[44:47]
    ds_read_b128 a[216:219], v10 offset:24576
    v_cvt_pk_bf16_f32 v163, v210, v211
    v_mfma_f32_16x16x32_bf16 a[44:47], a[180:183], v[156:159], a[44:47]
    s_waitcnt lgkmcnt(3)
    buffer_load_dwordx4 v41, s[12:15], s41 offen offset:1024 lds
    v_mfma_f32_16x16x32_bf16 v[208:211], a[224:227], v[96:99], v[200:203]
    v_exp_f32 v212, v212
    v_mfma_f32_16x16x32_bf16 v[208:211], a[228:231], v[100:103], v[208:211]
    v_exp_f32 v213, v213
    v_mfma_f32_16x16x32_bf16 v[208:211], a[232:235], v[104:107], v[208:211]
    v_exp_f32 v214, v214
    v_mfma_f32_16x16x32_bf16 v[208:211], a[236:239], v[108:111], v[208:211]
    v_exp_f32 v215, v215
    v_mfma_f32_16x16x32_bf16 a[48:51], a[184:187], v[128:131], a[48:51]
    ds_read_b64_tr_b16 a[164:165], v24 offset:8192
    v_cvt_pk_bf16_f32 v170, v212, v213
    v_mfma_f32_16x16x32_bf16 a[48:51], a[188:191], v[132:135], a[48:51]
    ds_read_b64_tr_b16 a[166:167], v24 offset:12288
    v_mfma_f32_16x16x32_bf16 a[52:55], a[184:187], v[136:139], a[52:55]
    ds_read_b128 a[220:223], v11 offset:24576
    v_cvt_pk_bf16_f32 v171, v214, v215
    v_mfma_f32_16x16x32_bf16 a[52:55], a[188:191], v[140:143], a[52:55]
    v_smfmac_f32_16x16x64_bf16 a[200:203], v[52:55], v[144:151], v50
    v_mfma_f32_16x16x32_bf16 v[212:215], a[224:227], v[112:115], v[204:207]
    v_exp_f32 v208, v208
    v_mfma_f32_16x16x32_bf16 v[212:215], a[228:231], v[116:119], v[212:215]
    v_exp_f32 v209, v209
    v_mfma_f32_16x16x32_bf16 v[212:215], a[232:235], v[120:123], v[212:215]
    v_exp_f32 v210, v210
    v_mfma_f32_16x16x32_bf16 v[212:215], a[236:239], v[124:127], v[212:215]
    v_exp_f32 v211, v211
    v_mfma_f32_16x16x32_bf16 a[56:59], a[184:187], v[144:147], a[56:59]
    ds_read_b64_tr_b16 a[168:169], v25 offset:0
    v_cvt_pk_bf16_f32 v178, v208, v209
    v_mfma_f32_16x16x32_bf16 a[56:59], a[188:191], v[148:151], a[56:59]
    ds_read_b64_tr_b16 a[170:171], v25 offset:4096
    v_mfma_f32_16x16x32_bf16 a[60:63], a[184:187], v[152:155], a[60:63]
    ds_read_b128 a[224:227], v8 offset:28672
    v_cvt_pk_bf16_f32 v179, v210, v211
    v_mfma_f32_16x16x32_bf16 a[60:63], a[188:191], v[156:159], a[60:63]
    s_waitcnt lgkmcnt(3)
    buffer_load_dwordx4 v40, s[12:15], s41 offen offset:2048 lds
    v_mfma_f32_16x16x32_bf16 v[208:211], a[208:211], v[64:67], v[192:195]
    v_exp_f32 v212, v212
    v_mfma_f32_16x16x32_bf16 v[208:211], a[212:215], v[68:71], v[208:211]
    v_exp_f32 v213, v213
    v_mfma_f32_16x16x32_bf16 v[208:211], a[216:219], v[72:75], v[208:211]
    v_exp_f32 v214, v214
    v_mfma_f32_16x16x32_bf16 v[208:211], a[220:223], v[76:79], v[208:211]
    v_exp_f32 v215, v215
    v_mfma_f32_16x16x32_bf16 a[64:67], a[160:163], v[128:131], a[64:67]
    ds_read_b64_tr_b16 a[172:173], v25 offset:8192
    v_cvt_pk_bf16_f32 v186, v212, v213
    v_mfma_f32_16x16x32_bf16 a[64:67], a[164:167], v[132:135], a[64:67]
    ds_read_b64_tr_b16 a[174:175], v25 offset:12288
    v_mfma_f32_16x16x32_bf16 a[68:71], a[160:163], v[136:139], a[68:71]
    ds_read_b128 a[228:231], v9 offset:28672
    v_cvt_pk_bf16_f32 v187, v214, v215
    v_mfma_f32_16x16x32_bf16 a[68:71], a[164:167], v[140:143], a[68:71]
    v_smfmac_f32_16x16x64_bf16 a[204:207], v[52:55], v[152:159], v50
    v_mfma_f32_16x16x32_bf16 v[212:215], a[208:211], v[80:83], v[196:199]
    v_exp_f32 v208, v208
    v_mfma_f32_16x16x32_bf16 v[212:215], a[212:215], v[84:87], v[212:215]
    v_exp_f32 v209, v209
    v_mfma_f32_16x16x32_bf16 v[212:215], a[216:219], v[88:91], v[212:215]
    v_exp_f32 v210, v210
    v_mfma_f32_16x16x32_bf16 v[212:215], a[220:223], v[92:95], v[212:215]
    v_exp_f32 v211, v211
    v_mfma_f32_16x16x32_bf16 a[72:75], a[160:163], v[144:147], a[72:75]
    ds_read_b64_tr_b16 a[176:177], v26 offset:0
    v_cvt_pk_bf16_f32 v164, v208, v209
    v_mfma_f32_16x16x32_bf16 a[72:75], a[164:167], v[148:151], a[72:75]
    ds_read_b64_tr_b16 a[178:179], v26 offset:4096
    v_mfma_f32_16x16x32_bf16 a[76:79], a[160:163], v[152:155], a[76:79]
    ds_read_b128 a[232:235], v10 offset:28672
    v_cvt_pk_bf16_f32 v165, v210, v211
    v_mfma_f32_16x16x32_bf16 a[76:79], a[164:167], v[156:159], a[76:79]
    s_waitcnt lgkmcnt(3)
    buffer_load_dwordx4 v41, s[12:15], s41 offen offset:3072 lds
    v_mfma_f32_16x16x32_bf16 v[208:211], a[208:211], v[96:99], v[200:203]
    v_exp_f32 v212, v212
    v_mfma_f32_16x16x32_bf16 v[208:211], a[212:215], v[100:103], v[208:211]
    s_add_u32 s41, s41, 16384
    v_exp_f32 v213, v213
    v_mfma_f32_16x16x32_bf16 v[208:211], a[216:219], v[104:107], v[208:211]
    v_exp_f32 v214, v214
    v_mfma_f32_16x16x32_bf16 v[208:211], a[220:223], v[108:111], v[208:211]
    v_exp_f32 v215, v215
    v_mfma_f32_16x16x32_bf16 a[80:83], a[168:171], v[128:131], a[80:83]
    ds_read_b64_tr_b16 a[180:181], v26 offset:8192
    v_cvt_pk_bf16_f32 v172, v212, v213
    v_mfma_f32_16x16x32_bf16 a[80:83], a[172:175], v[132:135], a[80:83]
    ds_read_b64_tr_b16 a[182:183], v26 offset:12288
    v_mfma_f32_16x16x32_bf16 a[84:87], a[168:171], v[136:139], a[84:87]
    ds_read_b128 a[236:239], v11 offset:28672
    v_cvt_pk_bf16_f32 v173, v214, v215
    v_mfma_f32_16x16x32_bf16 a[84:87], a[172:175], v[140:143], a[84:87]
    s_waitcnt vmcnt(8)
    s_barrier
    v_mfma_f32_16x16x32_bf16 v[212:215], a[208:211], v[112:115], v[204:207]
    v_exp_f32 v208, v208
    v_mfma_f32_16x16x32_bf16 v[212:215], a[212:215], v[116:119], v[212:215]
    s_add_u32 m0, s42, 0
    v_exp_f32 v209, v209
    v_mfma_f32_16x16x32_bf16 v[212:215], a[216:219], v[120:123], v[212:215]
    v_exp_f32 v210, v210
    v_mfma_f32_16x16x32_bf16 v[212:215], a[220:223], v[124:127], v[212:215]
    v_exp_f32 v211, v211
    v_mfma_f32_16x16x32_bf16 a[88:91], a[168:171], v[144:147], a[88:91]
    ds_read_b64_tr_b16 a[184:185], v27 offset:0
    v_cvt_pk_bf16_f32 v180, v208, v209
    v_mfma_f32_16x16x32_bf16 a[88:91], a[172:175], v[148:151], a[88:91]
    ds_read_b64_tr_b16 a[186:187], v27 offset:4096
    v_mfma_f32_16x16x32_bf16 a[92:95], a[168:171], v[152:155], a[92:95]
    ds_read_b128 a[208:211], v8 offset:32768
    v_cvt_pk_bf16_f32 v181, v210, v211
    v_mfma_f32_16x16x32_bf16 a[92:95], a[172:175], v[156:159], a[92:95]
    s_waitcnt lgkmcnt(3)
    buffer_load_dwordx4 v36, s[8:11], s40 offen lds
    v_mfma_f32_16x16x32_bf16 v[208:211], a[224:227], v[64:67], v[192:195]
    v_exp_f32 v212, v212
    v_mfma_f32_16x16x32_bf16 v[208:211], a[228:231], v[68:71], v[208:211]
    v_exp_f32 v213, v213
    v_mfma_f32_16x16x32_bf16 v[208:211], a[232:235], v[72:75], v[208:211]
    v_exp_f32 v214, v214
    v_mfma_f32_16x16x32_bf16 v[208:211], a[236:239], v[76:79], v[208:211]
    v_exp_f32 v215, v215
    v_mfma_f32_16x16x32_bf16 a[96:99], a[176:179], v[128:131], a[96:99]
    ds_read_b64_tr_b16 a[188:189], v27 offset:8192
    v_cvt_pk_bf16_f32 v188, v212, v213
    v_mfma_f32_16x16x32_bf16 a[96:99], a[180:183], v[132:135], a[96:99]
    ds_read_b64_tr_b16 a[190:191], v27 offset:12288
    v_mfma_f32_16x16x32_bf16 a[100:103], a[176:179], v[136:139], a[100:103]
    ds_read_b128 a[212:215], v9 offset:32768
    v_cvt_pk_bf16_f32 v189, v214, v215
    v_mfma_f32_16x16x32_bf16 a[100:103], a[180:183], v[140:143], a[100:103]
    buffer_load_dword v217, v57, s[32:35], s39 offen
    v_mfma_f32_16x16x32_bf16 v[212:215], a[224:227], v[80:83], v[196:199]
    v_exp_f32 v208, v208
    v_mfma_f32_16x16x32_bf16 v[212:215], a[228:231], v[84:87], v[212:215]
    v_exp_f32 v209, v209
    v_mfma_f32_16x16x32_bf16 v[212:215], a[232:235], v[88:91], v[212:215]
    v_exp_f32 v210, v210
    v_mfma_f32_16x16x32_bf16 v[212:215], a[236:239], v[92:95], v[212:215]
    v_exp_f32 v211, v211
    v_mfma_f32_16x16x32_bf16 a[104:107], a[176:179], v[144:147], a[104:107]
    ds_read_b64_tr_b16 a[160:161], v20 offset:16384
    v_cvt_pk_bf16_f32 v166, v208, v209
    v_mfma_f32_16x16x32_bf16 a[104:107], a[180:183], v[148:151], a[104:107]
    ds_read_b64_tr_b16 a[162:163], v20 offset:20480
    v_mfma_f32_16x16x32_bf16 a[108:111], a[176:179], v[152:155], a[108:111]
    ds_read_b128 a[216:219], v10 offset:32768
    v_cvt_pk_bf16_f32 v167, v210, v211
    v_mfma_f32_16x16x32_bf16 a[108:111], a[180:183], v[156:159], a[108:111]
    s_waitcnt lgkmcnt(3)
    buffer_load_dwordx4 v37, s[8:11], s40 offen offset:1024 lds
    v_mfma_f32_16x16x32_bf16 v[208:211], a[224:227], v[96:99], v[200:203]
    v_exp_f32 v212, v212
    v_mfma_f32_16x16x32_bf16 v[208:211], a[228:231], v[100:103], v[208:211]
    v_exp_f32 v213, v213
    v_mfma_f32_16x16x32_bf16 v[208:211], a[232:235], v[104:107], v[208:211]
    v_exp_f32 v214, v214
    v_mfma_f32_16x16x32_bf16 v[208:211], a[236:239], v[108:111], v[208:211]
    v_exp_f32 v215, v215
    v_mfma_f32_16x16x32_bf16 a[112:115], a[184:187], v[128:131], a[112:115]
    ds_read_b64_tr_b16 a[164:165], v20 offset:24576
    v_cvt_pk_bf16_f32 v174, v212, v213
    v_mfma_f32_16x16x32_bf16 a[112:115], a[188:191], v[132:135], a[112:115]
    ds_read_b64_tr_b16 a[166:167], v20 offset:28672
    v_mfma_f32_16x16x32_bf16 a[116:119], a[184:187], v[136:139], a[116:119]
    ds_read_b128 a[220:223], v11 offset:32768
    v_cvt_pk_bf16_f32 v175, v214, v215
    v_mfma_f32_16x16x32_bf16 a[116:119], a[188:191], v[140:143], a[116:119]
    v_mfma_f32_16x16x32_bf16 v[212:215], a[224:227], v[112:115], v[204:207]
    v_exp_f32 v208, v208
    v_mfma_f32_16x16x32_bf16 v[212:215], a[228:231], v[116:119], v[212:215]
    v_exp_f32 v209, v209
    v_mfma_f32_16x16x32_bf16 v[212:215], a[232:235], v[120:123], v[212:215]
    v_exp_f32 v210, v210
    v_mfma_f32_16x16x32_bf16 v[212:215], a[236:239], v[124:127], v[212:215]
    v_exp_f32 v211, v211
    v_mfma_f32_16x16x32_bf16 a[120:123], a[184:187], v[144:147], a[120:123]
    ds_read_b64_tr_b16 a[168:169], v21 offset:16384
    v_cvt_pk_bf16_f32 v182, v208, v209
    v_mfma_f32_16x16x32_bf16 a[120:123], a[188:191], v[148:151], a[120:123]
    ds_read_b64_tr_b16 a[170:171], v21 offset:20480
    v_mfma_f32_16x16x32_bf16 a[124:127], a[184:187], v[152:155], a[124:127]
    ds_read_b128 a[224:227], v8 offset:36864
    v_cvt_pk_bf16_f32 v183, v210, v211
    v_mfma_f32_16x16x32_bf16 a[124:127], a[188:191], v[156:159], a[124:127]
    s_waitcnt lgkmcnt(3)
    buffer_load_dwordx4 v38, s[8:11], s40 offen offset:2048 lds
    v_mfma_f32_16x16x32_bf16 v[208:211], a[208:211], v[64:67], v[192:195]
    v_exp_f32 v212, v212
    v_mfma_f32_16x16x32_bf16 v[208:211], a[212:215], v[68:71], v[208:211]
    v_exp_f32 v213, v213
    v_mfma_f32_16x16x32_bf16 v[208:211], a[216:219], v[72:75], v[208:211]
    v_exp_f32 v214, v214
    v_mfma_f32_16x16x32_bf16 v[208:211], a[220:223], v[76:79], v[208:211]
    v_exp_f32 v215, v215
    v_mfma_f32_16x16x32_bf16 a[0:3], a[160:163], v[160:163], a[0:3]
    ds_read_b64_tr_b16 a[172:173], v21 offset:24576
    v_cvt_pk_bf16_f32 v190, v212, v213
    v_mfma_f32_16x16x32_bf16 a[0:3], a[164:167], v[164:167], a[0:3]
    ds_read_b64_tr_b16 a[174:175], v21 offset:28672
    v_mfma_f32_16x16x32_bf16 a[4:7], a[160:163], v[168:171], a[4:7]
    ds_read_b128 a[228:231], v9 offset:36864
    v_cvt_pk_bf16_f32 v191, v214, v215
    v_mfma_f32_16x16x32_bf16 a[4:7], a[164:167], v[172:175], a[4:7]
    v_mfma_f32_16x16x32_bf16 v[212:215], a[208:211], v[80:83], v[196:199]
    v_exp_f32 v208, v208
    v_mfma_f32_16x16x32_bf16 v[212:215], a[212:215], v[84:87], v[212:215]
    v_exp_f32 v209, v209
    v_mfma_f32_16x16x32_bf16 v[212:215], a[216:219], v[88:91], v[212:215]
    v_exp_f32 v210, v210
    v_mfma_f32_16x16x32_bf16 v[212:215], a[220:223], v[92:95], v[212:215]
    v_exp_f32 v211, v211
    v_mfma_f32_16x16x32_bf16 a[8:11], a[160:163], v[176:179], a[8:11]
    ds_read_b64_tr_b16 a[176:177], v22 offset:16384
    v_cvt_pk_bf16_f32 v128, v208, v209
    v_mfma_f32_16x16x32_bf16 a[8:11], a[164:167], v[180:183], a[8:11]
    ds_read_b64_tr_b16 a[178:179], v22 offset:20480
    v_mfma_f32_16x16x32_bf16 a[12:15], a[160:163], v[184:187], a[12:15]
    ds_read_b128 a[232:235], v10 offset:36864
    v_cvt_pk_bf16_f32 v129, v210, v211
    v_mfma_f32_16x16x32_bf16 a[12:15], a[164:167], v[188:191], a[12:15]
    s_waitcnt lgkmcnt(3)
    buffer_load_dwordx4 v39, s[8:11], s40 offen offset:3072 lds
    v_mfma_f32_16x16x32_bf16 v[208:211], a[208:211], v[96:99], v[200:203]
    v_exp_f32 v212, v212
    v_mfma_f32_16x16x32_bf16 v[208:211], a[212:215], v[100:103], v[208:211]
    s_add_u32 s40, s40, 16384
    v_exp_f32 v213, v213
    v_mfma_f32_16x16x32_bf16 v[208:211], a[216:219], v[104:107], v[208:211]
    v_exp_f32 v214, v214
    v_mfma_f32_16x16x32_bf16 v[208:211], a[220:223], v[108:111], v[208:211]
    v_exp_f32 v215, v215
    v_mfma_f32_16x16x32_bf16 a[16:19], a[168:171], v[160:163], a[16:19]
    ds_read_b64_tr_b16 a[180:181], v22 offset:24576
    v_cvt_pk_bf16_f32 v136, v212, v213
    v_mfma_f32_16x16x32_bf16 a[16:19], a[172:175], v[164:167], a[16:19]
    ds_read_b64_tr_b16 a[182:183], v22 offset:28672
    v_mfma_f32_16x16x32_bf16 a[20:23], a[168:171], v[168:171], a[20:23]
    ds_read_b128 a[236:239], v11 offset:36864
    v_cvt_pk_bf16_f32 v137, v214, v215
    v_mfma_f32_16x16x32_bf16 a[20:23], a[172:175], v[172:175], a[20:23]
    v_smfmac_f32_16x16x64_bf16 a[192:195], v[52:55], v[160:167], v50
    v_mfma_f32_16x16x32_bf16 v[212:215], a[208:211], v[112:115], v[204:207]
    v_exp_f32 v208, v208
    v_mfma_f32_16x16x32_bf16 v[212:215], a[212:215], v[116:119], v[212:215]
    s_add_u32 m0, s42, 114688
    v_exp_f32 v209, v209
    v_mfma_f32_16x16x32_bf16 v[212:215], a[216:219], v[120:123], v[212:215]
    v_exp_f32 v210, v210
    v_mfma_f32_16x16x32_bf16 v[212:215], a[220:223], v[124:127], v[212:215]
    v_exp_f32 v211, v211
    v_mfma_f32_16x16x32_bf16 a[24:27], a[168:171], v[176:179], a[24:27]
    ds_read_b64_tr_b16 a[184:185], v23 offset:16384
    v_cvt_pk_bf16_f32 v144, v208, v209
    v_mfma_f32_16x16x32_bf16 a[24:27], a[172:175], v[180:183], a[24:27]
    ds_read_b64_tr_b16 a[186:187], v23 offset:20480
    v_mfma_f32_16x16x32_bf16 a[28:31], a[168:171], v[184:187], a[28:31]
    ds_read_b128 a[208:211], v8 offset:40960
    v_cvt_pk_bf16_f32 v145, v210, v211
    v_mfma_f32_16x16x32_bf16 a[28:31], a[172:175], v[188:191], a[28:31]
    s_waitcnt lgkmcnt(3)
    buffer_load_dwordx4 v40, s[12:15], s41 offen lds
    v_mfma_f32_16x16x32_bf16 v[208:211], a[224:227], v[64:67], v[192:195]
    v_exp_f32 v212, v212
    v_mfma_f32_16x16x32_bf16 v[208:211], a[228:231], v[68:71], v[208:211]
    v_exp_f32 v213, v213
    v_mfma_f32_16x16x32_bf16 v[208:211], a[232:235], v[72:75], v[208:211]
    v_exp_f32 v214, v214
    v_mfma_f32_16x16x32_bf16 v[208:211], a[236:239], v[76:79], v[208:211]
    v_exp_f32 v215, v215
    v_mfma_f32_16x16x32_bf16 a[32:35], a[176:179], v[160:163], a[32:35]
    ds_read_b64_tr_b16 a[188:189], v23 offset:24576
    v_cvt_pk_bf16_f32 v152, v212, v213
    v_mfma_f32_16x16x32_bf16 a[32:35], a[180:183], v[164:167], a[32:35]
    ds_read_b64_tr_b16 a[190:191], v23 offset:28672
    v_mfma_f32_16x16x32_bf16 a[36:39], a[176:179], v[168:171], a[36:39]
    ds_read_b128 a[212:215], v9 offset:40960
    v_cvt_pk_bf16_f32 v153, v214, v215
    v_mfma_f32_16x16x32_bf16 a[36:39], a[180:183], v[172:175], a[36:39]
    v_smfmac_f32_16x16x64_bf16 a[196:199], v[52:55], v[168:175], v50
    v_mfma_f32_16x16x32_bf16 v[212:215], a[224:227], v[80:83], v[196:199]
    v_exp_f32 v208, v208
    v_mfma_f32_16x16x32_bf16 v[212:215], a[228:231], v[84:87], v[212:215]
    v_exp_f32 v209, v209
    v_mfma_f32_16x16x32_bf16 v[212:215], a[232:235], v[88:91], v[212:215]
    v_exp_f32 v210, v210
    v_mfma_f32_16x16x32_bf16 v[212:215], a[236:239], v[92:95], v[212:215]
    v_exp_f32 v211, v211
    v_mfma_f32_16x16x32_bf16 a[40:43], a[176:179], v[176:179], a[40:43]
    ds_read_b64_tr_b16 a[160:161], v24 offset:16384
    v_cvt_pk_bf16_f32 v130, v208, v209
    v_mfma_f32_16x16x32_bf16 a[40:43], a[180:183], v[180:183], a[40:43]
    ds_read_b64_tr_b16 a[162:163], v24 offset:20480
    v_mfma_f32_16x16x32_bf16 a[44:47], a[176:179], v[184:187], a[44:47]
    ds_read_b128 a[216:219], v10 offset:40960
    v_cvt_pk_bf16_f32 v131, v210, v211
    v_mfma_f32_16x16x32_bf16 a[44:47], a[180:183], v[188:191], a[44:47]
    s_waitcnt lgkmcnt(3)
    buffer_load_dwordx4 v41, s[12:15], s41 offen offset:1024 lds
    v_mfma_f32_16x16x32_bf16 v[208:211], a[224:227], v[96:99], v[200:203]
    v_exp_f32 v212, v212
    v_mfma_f32_16x16x32_bf16 v[208:211], a[228:231], v[100:103], v[208:211]
    v_exp_f32 v213, v213
    v_mfma_f32_16x16x32_bf16 v[208:211], a[232:235], v[104:107], v[208:211]
    v_exp_f32 v214, v214
    v_mfma_f32_16x16x32_bf16 v[208:211], a[236:239], v[108:111], v[208:211]
    v_exp_f32 v215, v215
    v_mfma_f32_16x16x32_bf16 a[48:51], a[184:187], v[160:163], a[48:51]
    ds_read_b64_tr_b16 a[164:165], v24 offset:24576
    v_cvt_pk_bf16_f32 v138, v212, v213
    v_mfma_f32_16x16x32_bf16 a[48:51], a[188:191], v[164:167], a[48:51]
    ds_read_b64_tr_b16 a[166:167], v24 offset:28672
    v_mfma_f32_16x16x32_bf16 a[52:55], a[184:187], v[168:171], a[52:55]
    ds_read_b128 a[220:223], v11 offset:40960
    v_cvt_pk_bf16_f32 v139, v214, v215
    v_mfma_f32_16x16x32_bf16 a[52:55], a[188:191], v[172:175], a[52:55]
Ltour4:
    s_cbranch_execz Ltour8
    v_smfmac_f32_16x16x64_bf16 a[200:203], v[52:55], v[176:183], v50
    v_mfma_f32_16x16x32_bf16 v[212:215], a[224:227], v[112:115], v[204:207]
    v_exp_f32 v208, v208
    v_mfma_f32_16x16x32_bf16 v[212:215], a[228:231], v[116:119], v[212:215]
    v_exp_f32 v209, v209
    v_mfma_f32_16x16x32_bf16 v[212:215], a[232:235], v[120:123], v[212:215]
    v_exp_f32 v210, v210
    v_mfma_f32_16x16x32_bf16 v[212:215], a[236:239], v[124:127], v[212:215]
    v_exp_f32 v211, v211
    v_mfma_f32_16x16x32_bf16 a[56:59], a[184:187], v[176:179], a[56:59]
    ds_read_b64_tr_b16 a[168:169], v25 offset:16384
    v_cvt_pk_bf16_f32 v146, v208, v209
    v_mfma_f32_16x16x32_bf16 a[56:59], a[188:191], v[180:183], a[56:59]
    ds_read_b64_tr_b16 a[170:171], v25 offset:20480
    v_mfma_f32_16x16x32_bf16 a[60:63], a[184:187], v[184:187], a[60:63]
    ds_read_b128 a[224:227], v8 offset:45056
    v_cvt_pk_bf16_f32 v147, v210, v211
    v_mfma_f32_16x16x32_bf16 a[60:63], a[188:191], v[188:191], a[60:63]
    s_waitcnt lgkmcnt(3)
    buffer_load_dwordx4 v40, s[12:15], s41 offen offset:2048 lds
    v_mfma_f32_16x16x32_bf16 v[208:211], a[208:211], v[64:67], v[192:195]
    v_exp_f32 v212, v212
    v_mfma_f32_16x16x32_bf16 v[208:211], a[212:215], v[68:71], v[208:211]
    v_exp_f32 v213, v213
    v_mfma_f32_16x16x32_bf16 v[208:211], a[216:219], v[72:75], v[208:211]
    v_exp_f32 v214, v214
    v_mfma_f32_16x16x32_bf16 v[208:211], a[220:223], v[76:79], v[208:211]
    v_exp_f32 v215, v215
    v_mfma_f32_16x16x32_bf16 a[64:67], a[160:163], v[160:163], a[64:67]
    ds_read_b64_tr_b16 a[172:173], v25 offset:24576
    v_cvt_pk_bf16_f32 v154, v212, v213
    v_mfma_f32_16x16x32_bf16 a[64:67], a[164:167], v[164:167], a[64:67]
    ds_read_b64_tr_b16 a[174:175], v25 offset:28672
    v_mfma_f32_16x16x32_bf16 a[68:71], a[160:163], v[168:171], a[68:71]
    ds_read_b128 a[228:231], v9 offset:45056
    v_cvt_pk_bf16_f32 v155, v214, v215
    v_mfma_f32_16x16x32_bf16 a[68:71], a[164:167], v[172:175], a[68:71]
    v_smfmac_f32_16x16x64_bf16 a[204:207], v[52:55], v[184:191], v50
    v_mfma_f32_16x16x32_bf16 v[212:215], a[208:211], v[80:83], v[196:199]
    v_exp_f32 v208, v208
    v_mfma_f32_16x16x32_bf16 v[212:215], a[212:215], v[84:87], v[212:215]
    v_exp_f32 v209, v209
    v_mfma_f32_16x16x32_bf16 v[212:215], a[216:219], v[88:91], v[212:215]
    v_exp_f32 v210, v210
    v_mfma_f32_16x16x32_bf16 v[212:215], a[220:223], v[92:95], v[212:215]
    v_exp_f32 v211, v211
    v_mfma_f32_16x16x32_bf16 a[72:75], a[160:163], v[176:179], a[72:75]
    ds_read_b64_tr_b16 a[176:177], v26 offset:16384
    v_cvt_pk_bf16_f32 v132, v208, v209
    v_mfma_f32_16x16x32_bf16 a[72:75], a[164:167], v[180:183], a[72:75]
    ds_read_b64_tr_b16 a[178:179], v26 offset:20480
    v_mfma_f32_16x16x32_bf16 a[76:79], a[160:163], v[184:187], a[76:79]
    ds_read_b128 a[232:235], v10 offset:45056
    v_cvt_pk_bf16_f32 v133, v210, v211
    v_mfma_f32_16x16x32_bf16 a[76:79], a[164:167], v[188:191], a[76:79]
    s_waitcnt lgkmcnt(3)
    buffer_load_dwordx4 v41, s[12:15], s41 offen offset:3072 lds
    v_mfma_f32_16x16x32_bf16 v[208:211], a[208:211], v[96:99], v[200:203]
    v_exp_f32 v212, v212
    v_mfma_f32_16x16x32_bf16 v[208:211], a[212:215], v[100:103], v[208:211]
    s_add_u32 s41, s41, 16384
    v_exp_f32 v213, v213
    v_mfma_f32_16x16x32_bf16 v[208:211], a[216:219], v[104:107], v[208:211]
    v_exp_f32 v214, v214
    v_mfma_f32_16x16x32_bf16 v[208:211], a[220:223], v[108:111], v[208:211]
    v_exp_f32 v215, v215
    v_mfma_f32_16x16x32_bf16 a[80:83], a[168:171], v[160:163], a[80:83]
    ds_read_b64_tr_b16 a[180:181], v26 offset:24576
    v_cvt_pk_bf16_f32 v140, v212, v213
    v_mfma_f32_16x16x32_bf16 a[80:83], a[172:175], v[164:167], a[80:83]
    ds_read_b64_tr_b16 a[182:183], v26 offset:28672
    v_mfma_f32_16x16x32_bf16 a[84:87], a[168:171], v[168:171], a[84:87]
    ds_read_b128 a[236:239], v11 offset:45056
    v_cvt_pk_bf16_f32 v141, v214, v215
    v_mfma_f32_16x16x32_bf16 a[84:87], a[172:175], v[172:175], a[84:87]
    s_waitcnt vmcnt(9)
    s_barrier
    v_mfma_f32_16x16x32_bf16 v[212:215], a[208:211], v[112:115], v[204:207]
    v_exp_f32 v208, v208
    v_mfma_f32_16x16x32_bf16 v[212:215], a[212:215], v[116:119], v[212:215]
    s_add_u32 m0, s42, 16384
    v_exp_f32 v209, v209
    v_mfma_f32_16x16x32_bf16 v[212:215], a[216:219], v[120:123], v[212:215]
    v_exp_f32 v210, v210
    v_mfma_f32_16x16x32_bf16 v[212:215], a[220:223], v[124:127], v[212:215]
    v_exp_f32 v211, v211
    v_mfma_f32_16x16x32_bf16 a[88:91], a[168:171], v[176:179], a[88:91]
    ds_read_b64_tr_b16 a[184:185], v27 offset:16384
    v_cvt_pk_bf16_f32 v148, v208, v209
    v_mfma_f32_16x16x32_bf16 a[88:91], a[172:175], v[180:183], a[88:91]
    ds_read_b64_tr_b16 a[186:187], v27 offset:20480
    v_mfma_f32_16x16x32_bf16 a[92:95], a[168:171], v[184:187], a[92:95]
    ds_read_b128 a[208:211], v8 offset:49152
    v_cvt_pk_bf16_f32 v149, v210, v211
    v_mfma_f32_16x16x32_bf16 a[92:95], a[172:175], v[188:191], a[92:95]
    s_waitcnt lgkmcnt(3)
    buffer_load_dwordx4 v36, s[8:11], s40 offen lds
    v_mfma_f32_16x16x32_bf16 v[208:211], a[224:227], v[64:67], v[192:195]
    v_exp_f32 v212, v212
    v_mfma_f32_16x16x32_bf16 v[208:211], a[228:231], v[68:71], v[208:211]
    v_exp_f32 v213, v213
    v_mfma_f32_16x16x32_bf16 v[208:211], a[232:235], v[72:75], v[208:211]
    v_exp_f32 v214, v214
    v_mfma_f32_16x16x32_bf16 v[208:211], a[236:239], v[76:79], v[208:211]
    v_exp_f32 v215, v215
    v_mfma_f32_16x16x32_bf16 a[96:99], a[176:179], v[160:163], a[96:99]
    ds_read_b64_tr_b16 a[188:189], v27 offset:24576
    v_cvt_pk_bf16_f32 v156, v212, v213
    v_mfma_f32_16x16x32_bf16 a[96:99], a[180:183], v[164:167], a[96:99]
    ds_read_b64_tr_b16 a[190:191], v27 offset:28672
    v_mfma_f32_16x16x32_bf16 a[100:103], a[176:179], v[168:171], a[100:103]
    ds_read_b128 a[212:215], v9 offset:49152
    v_cvt_pk_bf16_f32 v157, v214, v215
    v_mfma_f32_16x16x32_bf16 a[100:103], a[180:183], v[172:175], a[100:103]
    buffer_load_dword v218, v57, s[80:83], s39 offen
    v_mfma_f32_16x16x32_bf16 v[212:215], a[224:227], v[80:83], v[196:199]
    v_exp_f32 v208, v208
    v_mfma_f32_16x16x32_bf16 v[212:215], a[228:231], v[84:87], v[212:215]
    v_exp_f32 v209, v209
    v_mfma_f32_16x16x32_bf16 v[212:215], a[232:235], v[88:91], v[212:215]
    v_exp_f32 v210, v210
    v_mfma_f32_16x16x32_bf16 v[212:215], a[236:239], v[92:95], v[212:215]
    v_exp_f32 v211, v211
    v_mfma_f32_16x16x32_bf16 a[104:107], a[176:179], v[176:179], a[104:107]
    ds_read_b64_tr_b16 a[160:161], v20 offset:32768
    v_cvt_pk_bf16_f32 v134, v208, v209
    v_mfma_f32_16x16x32_bf16 a[104:107], a[180:183], v[180:183], a[104:107]
    ds_read_b64_tr_b16 a[162:163], v20 offset:36864
    v_mfma_f32_16x16x32_bf16 a[108:111], a[176:179], v[184:187], a[108:111]
    ds_read_b128 a[216:219], v10 offset:49152
    v_cvt_pk_bf16_f32 v135, v210, v211
    v_mfma_f32_16x16x32_bf16 a[108:111], a[180:183], v[188:191], a[108:111]
    s_waitcnt lgkmcnt(3)
    buffer_load_dwordx4 v37, s[8:11], s40 offen offset:1024 lds
    v_mfma_f32_16x16x32_bf16 v[208:211], a[224:227], v[96:99], v[200:203]
    v_exp_f32 v212, v212
    v_mfma_f32_16x16x32_bf16 v[208:211], a[228:231], v[100:103], v[208:211]
    v_exp_f32 v213, v213
    v_mfma_f32_16x16x32_bf16 v[208:211], a[232:235], v[104:107], v[208:211]
    v_exp_f32 v214, v214
    v_mfma_f32_16x16x32_bf16 v[208:211], a[236:239], v[108:111], v[208:211]
    v_exp_f32 v215, v215
    v_mfma_f32_16x16x32_bf16 a[112:115], a[184:187], v[160:163], a[112:115]
    ds_read_b64_tr_b16 a[164:165], v20 offset:40960
    v_cvt_pk_bf16_f32 v142, v212, v213
    v_mfma_f32_16x16x32_bf16 a[112:115], a[188:191], v[164:167], a[112:115]
    ds_read_b64_tr_b16 a[166:167], v20 offset:45056
    v_mfma_f32_16x16x32_bf16 a[116:119], a[184:187], v[168:171], a[116:119]
    ds_read_b128 a[220:223], v11 offset:49152
    v_cvt_pk_bf16_f32 v143, v214, v215
    v_mfma_f32_16x16x32_bf16 a[116:119], a[188:191], v[172:175], a[116:119]
    v_mfma_f32_16x16x32_bf16 v[212:215], a[224:227], v[112:115], v[204:207]
    v_exp_f32 v208, v208
    v_mfma_f32_16x16x32_bf16 v[212:215], a[228:231], v[116:119], v[212:215]
    v_exp_f32 v209, v209
    v_mfma_f32_16x16x32_bf16 v[212:215], a[232:235], v[120:123], v[212:215]
    v_exp_f32 v210, v210
    v_mfma_f32_16x16x32_bf16 v[212:215], a[236:239], v[124:127], v[212:215]
    v_exp_f32 v211, v211
    v_mfma_f32_16x16x32_bf16 a[120:123], a[184:187], v[176:179], a[120:123]
    ds_read_b64_tr_b16 a[168:169], v21 offset:32768
    v_cvt_pk_bf16_f32 v150, v208, v209
    v_mfma_f32_16x16x32_bf16 a[120:123], a[188:191], v[180:183], a[120:123]
    ds_read_b64_tr_b16 a[170:171], v21 offset:36864
    v_mfma_f32_16x16x32_bf16 a[124:127], a[184:187], v[184:187], a[124:127]
    ds_read_b128 a[224:227], v8 offset:53248
    v_cvt_pk_bf16_f32 v151, v210, v211
    v_mfma_f32_16x16x32_bf16 a[124:127], a[188:191], v[188:191], a[124:127]
    s_waitcnt lgkmcnt(3)
    buffer_load_dwordx4 v38, s[8:11], s40 offen offset:2048 lds
    v_mfma_f32_16x16x32_bf16 v[208:211], a[208:211], v[64:67], v[192:195]
    v_exp_f32 v212, v212
    v_mfma_f32_16x16x32_bf16 v[208:211], a[212:215], v[68:71], v[208:211]
    v_exp_f32 v213, v213
    v_mfma_f32_16x16x32_bf16 v[208:211], a[216:219], v[72:75], v[208:211]
    v_exp_f32 v214, v214
    v_mfma_f32_16x16x32_bf16 v[208:211], a[220:223], v[76:79], v[208:211]
    v_exp_f32 v215, v215
    v_mfma_f32_16x16x32_bf16 a[0:3], a[160:163], v[128:131], a[0:3]
    ds_read_b64_tr_b16 a[172:173], v21 offset:40960
    v_cvt_pk_bf16_f32 v158, v212, v213
    v_mfma_f32_16x16x32_bf16 a[0:3], a[164:167], v[132:135], a[0:3]
    ds_read_b64_tr_b16 a[174:175], v21 offset:45056
    v_mfma_f32_16x16x32_bf16 a[4:7], a[160:163], v[136:139], a[4:7]
    ds_read_b128 a[228:231], v9 offset:53248
    v_cvt_pk_bf16_f32 v159, v214, v215
    v_mfma_f32_16x16x32_bf16 a[4:7], a[164:167], v[140:143], a[4:7]
    v_mfma_f32_16x16x32_bf16 v[212:215], a[208:211], v[80:83], v[196:199]
    v_exp_f32 v208, v208
    v_mfma_f32_16x16x32_bf16 v[212:215], a[212:215], v[84:87], v[212:215]
    v_exp_f32 v209, v209
    v_mfma_f32_16x16x32_bf16 v[212:215], a[216:219], v[88:91], v[212:215]
    v_exp_f32 v210, v210
    v_mfma_f32_16x16x32_bf16 v[212:215], a[220:223], v[92:95], v[212:215]
    v_exp_f32 v211, v211
    v_mfma_f32_16x16x32_bf16 a[8:11], a[160:163], v[144:147], a[8:11]
    ds_read_b64_tr_b16 a[176:177], v22 offset:32768
    v_cvt_pk_bf16_f32 v160, v208, v209
    v_mfma_f32_16x16x32_bf16 a[8:11], a[164:167], v[148:151], a[8:11]
    ds_read_b64_tr_b16 a[178:179], v22 offset:36864
    v_mfma_f32_16x16x32_bf16 a[12:15], a[160:163], v[152:155], a[12:15]
    ds_read_b128 a[232:235], v10 offset:53248
    v_cvt_pk_bf16_f32 v161, v210, v211
    v_mfma_f32_16x16x32_bf16 a[12:15], a[164:167], v[156:159], a[12:15]
    s_waitcnt lgkmcnt(3)
    buffer_load_dwordx4 v39, s[8:11], s40 offen offset:3072 lds
    v_mfma_f32_16x16x32_bf16 v[208:211], a[208:211], v[96:99], v[200:203]
    v_exp_f32 v212, v212
    v_mfma_f32_16x16x32_bf16 v[208:211], a[212:215], v[100:103], v[208:211]
    s_add_u32 s40, s40, 16384
    v_exp_f32 v213, v213
    v_mfma_f32_16x16x32_bf16 v[208:211], a[216:219], v[104:107], v[208:211]
    v_exp_f32 v214, v214
    v_mfma_f32_16x16x32_bf16 v[208:211], a[220:223], v[108:111], v[208:211]
    v_exp_f32 v215, v215
    v_mfma_f32_16x16x32_bf16 a[16:19], a[168:171], v[128:131], a[16:19]
    ds_read_b64_tr_b16 a[180:181], v22 offset:40960
    v_cvt_pk_bf16_f32 v168, v212, v213
    v_mfma_f32_16x16x32_bf16 a[16:19], a[172:175], v[132:135], a[16:19]
    ds_read_b64_tr_b16 a[182:183], v22 offset:45056
    v_mfma_f32_16x16x32_bf16 a[20:23], a[168:171], v[136:139], a[20:23]
    ds_read_b128 a[236:239], v11 offset:53248
    v_cvt_pk_bf16_f32 v169, v214, v215
    v_mfma_f32_16x16x32_bf16 a[20:23], a[172:175], v[140:143], a[20:23]
    v_smfmac_f32_16x16x64_bf16 a[192:195], v[52:55], v[128:135], v50
    v_mfma_f32_16x16x32_bf16 v[212:215], a[208:211], v[112:115], v[204:207]
    v_exp_f32 v208, v208
    v_mfma_f32_16x16x32_bf16 v[212:215], a[212:215], v[116:119], v[212:215]
    s_add_u32 m0, s42, 65536
    v_exp_f32 v209, v209
    v_mfma_f32_16x16x32_bf16 v[212:215], a[216:219], v[120:123], v[212:215]
    v_exp_f32 v210, v210
    v_mfma_f32_16x16x32_bf16 v[212:215], a[220:223], v[124:127], v[212:215]
    v_exp_f32 v211, v211
    v_mfma_f32_16x16x32_bf16 a[24:27], a[168:171], v[144:147], a[24:27]
    ds_read_b64_tr_b16 a[184:185], v23 offset:32768
    v_cvt_pk_bf16_f32 v176, v208, v209
    v_mfma_f32_16x16x32_bf16 a[24:27], a[172:175], v[148:151], a[24:27]
    ds_read_b64_tr_b16 a[186:187], v23 offset:36864
    v_mfma_f32_16x16x32_bf16 a[28:31], a[168:171], v[152:155], a[28:31]
    ds_read_b128 a[208:211], v8 offset:57344
    v_cvt_pk_bf16_f32 v177, v210, v211
    v_mfma_f32_16x16x32_bf16 a[28:31], a[172:175], v[156:159], a[28:31]
    s_waitcnt lgkmcnt(3)
    buffer_load_dwordx4 v40, s[12:15], s41 offen lds
    v_mfma_f32_16x16x32_bf16 v[208:211], a[224:227], v[64:67], v[192:195]
    v_exp_f32 v212, v212
    v_mfma_f32_16x16x32_bf16 v[208:211], a[228:231], v[68:71], v[208:211]
    v_exp_f32 v213, v213
    v_mfma_f32_16x16x32_bf16 v[208:211], a[232:235], v[72:75], v[208:211]
    v_exp_f32 v214, v214
    v_mfma_f32_16x16x32_bf16 v[208:211], a[236:239], v[76:79], v[208:211]
    v_exp_f32 v215, v215
    v_mfma_f32_16x16x32_bf16 a[32:35], a[176:179], v[128:131], a[32:35]
    ds_read_b64_tr_b16 a[188:189], v23 offset:40960
    v_cvt_pk_bf16_f32 v184, v212, v213
    v_mfma_f32_16x16x32_bf16 a[32:35], a[180:183], v[132:135], a[32:35]
    ds_read_b64_tr_b16 a[190:191], v23 offset:45056
    v_mfma_f32_16x16x32_bf16 a[36:39], a[176:179], v[136:139], a[36:39]
    ds_read_b128 a[212:215], v9 offset:57344
    v_cvt_pk_bf16_f32 v185, v214, v215
    v_mfma_f32_16x16x32_bf16 a[36:39], a[180:183], v[140:143], a[36:39]
    v_smfmac_f32_16x16x64_bf16 a[196:199], v[52:55], v[136:143], v50
    v_mfma_f32_16x16x32_bf16 v[212:215], a[224:227], v[80:83], v[196:199]
    v_exp_f32 v208, v208
    v_mfma_f32_16x16x32_bf16 v[212:215], a[228:231], v[84:87], v[212:215]
    v_exp_f32 v209, v209
    v_mfma_f32_16x16x32_bf16 v[212:215], a[232:235], v[88:91], v[212:215]
    v_exp_f32 v210, v210
    v_mfma_f32_16x16x32_bf16 v[212:215], a[236:239], v[92:95], v[212:215]
    v_exp_f32 v211, v211
    v_mfma_f32_16x16x32_bf16 a[40:43], a[176:179], v[144:147], a[40:43]
    ds_read_b64_tr_b16 a[160:161], v24 offset:32768
    v_cvt_pk_bf16_f32 v162, v208, v209
    v_mfma_f32_16x16x32_bf16 a[40:43], a[180:183], v[148:151], a[40:43]
    ds_read_b64_tr_b16 a[162:163], v24 offset:36864
    v_mfma_f32_16x16x32_bf16 a[44:47], a[176:179], v[152:155], a[44:47]
    ds_read_b128 a[216:219], v10 offset:57344
    v_cvt_pk_bf16_f32 v163, v210, v211
    v_mfma_f32_16x16x32_bf16 a[44:47], a[180:183], v[156:159], a[44:47]
    s_waitcnt lgkmcnt(3)
    buffer_load_dwordx4 v41, s[12:15], s41 offen offset:1024 lds
    v_mfma_f32_16x16x32_bf16 v[208:211], a[224:227], v[96:99], v[200:203]
    v_exp_f32 v212, v212
    v_mfma_f32_16x16x32_bf16 v[208:211], a[228:231], v[100:103], v[208:211]
    v_exp_f32 v213, v213
    v_mfma_f32_16x16x32_bf16 v[208:211], a[232:235], v[104:107], v[208:211]
    v_exp_f32 v214, v214
    v_mfma_f32_16x16x32_bf16 v[208:211], a[236:239], v[108:111], v[208:211]
    v_exp_f32 v215, v215
    v_mfma_f32_16x16x32_bf16 a[48:51], a[184:187], v[128:131], a[48:51]
    ds_read_b64_tr_b16 a[164:165], v24 offset:40960
    v_cvt_pk_bf16_f32 v170, v212, v213
    v_mfma_f32_16x16x32_bf16 a[48:51], a[188:191], v[132:135], a[48:51]
    ds_read_b64_tr_b16 a[166:167], v24 offset:45056
    v_mfma_f32_16x16x32_bf16 a[52:55], a[184:187], v[136:139], a[52:55]
    ds_read_b128 a[220:223], v11 offset:57344
    v_cvt_pk_bf16_f32 v171, v214, v215
    v_mfma_f32_16x16x32_bf16 a[52:55], a[188:191], v[140:143], a[52:55]
    v_smfmac_f32_16x16x64_bf16 a[200:203], v[52:55], v[144:151], v50
    v_mfma_f32_16x16x32_bf16 v[212:215], a[224:227], v[112:115], v[204:207]
    v_exp_f32 v208, v208
    v_mfma_f32_16x16x32_bf16 v[212:215], a[228:231], v[116:119], v[212:215]
    v_exp_f32 v209, v209
    v_mfma_f32_16x16x32_bf16 v[212:215], a[232:235], v[120:123], v[212:215]
    v_exp_f32 v210, v210
    v_mfma_f32_16x16x32_bf16 v[212:215], a[236:239], v[124:127], v[212:215]
    v_exp_f32 v211, v211
    v_mfma_f32_16x16x32_bf16 a[56:59], a[184:187], v[144:147], a[56:59]
    ds_read_b64_tr_b16 a[168:169], v25 offset:32768
    v_cvt_pk_bf16_f32 v178, v208, v209
    v_mfma_f32_16x16x32_bf16 a[56:59], a[188:191], v[148:151], a[56:59]
    ds_read_b64_tr_b16 a[170:171], v25 offset:36864
    v_mfma_f32_16x16x32_bf16 a[60:63], a[184:187], v[152:155], a[60:63]
    ds_read_b128 a[224:227], v8 offset:61440
    v_cvt_pk_bf16_f32 v179, v210, v211
    v_mfma_f32_16x16x32_bf16 a[60:63], a[188:191], v[156:159], a[60:63]
    s_waitcnt lgkmcnt(3)
    buffer_load_dwordx4 v40, s[12:15], s41 offen offset:2048 lds
    v_mfma_f32_16x16x32_bf16 v[208:211], a[208:211], v[64:67], v[192:195]
    v_exp_f32 v212, v212
    v_mfma_f32_16x16x32_bf16 v[208:211], a[212:215], v[68:71], v[208:211]
    v_exp_f32 v213, v213
    v_mfma_f32_16x16x32_bf16 v[208:211], a[216:219], v[72:75], v[208:211]
    v_exp_f32 v214, v214
    v_mfma_f32_16x16x32_bf16 v[208:211], a[220:223], v[76:79], v[208:211]
    v_exp_f32 v215, v215
    v_mfma_f32_16x16x32_bf16 a[64:67], a[160:163], v[128:131], a[64:67]
    ds_read_b64_tr_b16 a[172:173], v25 offset:40960
    v_cvt_pk_bf16_f32 v186, v212, v213
    v_mfma_f32_16x16x32_bf16 a[64:67], a[164:167], v[132:135], a[64:67]
    ds_read_b64_tr_b16 a[174:175], v25 offset:45056
    v_mfma_f32_16x16x32_bf16 a[68:71], a[160:163], v[136:139], a[68:71]
    ds_read_b128 a[228:231], v9 offset:61440
    v_cvt_pk_bf16_f32 v187, v214, v215
    v_mfma_f32_16x16x32_bf16 a[68:71], a[164:167], v[140:143], a[68:71]
    v_smfmac_f32_16x16x64_bf16 a[204:207], v[52:55], v[152:159], v50
    v_mfma_f32_16x16x32_bf16 v[212:215], a[208:211], v[80:83], v[196:199]
    v_exp_f32 v208, v208
    v_mfma_f32_16x16x32_bf16 v[212:215], a[212:215], v[84:87], v[212:215]
    v_exp_f32 v209, v209
    v_mfma_f32_16x16x32_bf16 v[212:215], a[216:219], v[88:91], v[212:215]
    v_exp_f32 v210, v210
    v_mfma_f32_16x16x32_bf16 v[212:215], a[220:223], v[92:95], v[212:215]
    v_exp_f32 v211, v211
    v_mfma_f32_16x16x32_bf16 a[72:75], a[160:163], v[144:147], a[72:75]
    ds_read_b64_tr_b16 a[176:177], v26 offset:32768
    v_cvt_pk_bf16_f32 v164, v208, v209
    v_mfma_f32_16x16x32_bf16 a[72:75], a[164:167], v[148:151], a[72:75]
    ds_read_b64_tr_b16 a[178:179], v26 offset:36864
    v_mfma_f32_16x16x32_bf16 a[76:79], a[160:163], v[152:155], a[76:79]
    ds_read_b128 a[232:235], v10 offset:61440
    v_cvt_pk_bf16_f32 v165, v210, v211
    v_mfma_f32_16x16x32_bf16 a[76:79], a[164:167], v[156:159], a[76:79]
    s_waitcnt lgkmcnt(3)
    buffer_load_dwordx4 v41, s[12:15], s41 offen offset:3072 lds
    v_mfma_f32_16x16x32_bf16 v[208:211], a[208:211], v[96:99], v[200:203]
    v_exp_f32 v212, v212
    v_mfma_f32_16x16x32_bf16 v[208:211], a[212:215], v[100:103], v[208:211]
    s_add_u32 s41, s41, 16384
    v_exp_f32 v213, v213
    v_mfma_f32_16x16x32_bf16 v[208:211], a[216:219], v[104:107], v[208:211]
    v_exp_f32 v214, v214
    v_mfma_f32_16x16x32_bf16 v[208:211], a[220:223], v[108:111], v[208:211]
    v_exp_f32 v215, v215
    v_mfma_f32_16x16x32_bf16 a[80:83], a[168:171], v[128:131], a[80:83]
    ds_read_b64_tr_b16 a[180:181], v26 offset:40960
    v_cvt_pk_bf16_f32 v172, v212, v213
    v_mfma_f32_16x16x32_bf16 a[80:83], a[172:175], v[132:135], a[80:83]
    ds_read_b64_tr_b16 a[182:183], v26 offset:45056
    v_mfma_f32_16x16x32_bf16 a[84:87], a[168:171], v[136:139], a[84:87]
    ds_read_b128 a[236:239], v11 offset:61440
    v_cvt_pk_bf16_f32 v173, v214, v215
    v_mfma_f32_16x16x32_bf16 a[84:87], a[172:175], v[140:143], a[84:87]
    s_waitcnt vmcnt(9)
    s_barrier
    v_mfma_f32_16x16x32_bf16 v[212:215], a[208:211], v[112:115], v[204:207]
    v_exp_f32 v208, v208
    v_mfma_f32_16x16x32_bf16 v[212:215], a[212:215], v[116:119], v[212:215]
    s_add_u32 m0, s42, 32768
    v_exp_f32 v209, v209
    v_mfma_f32_16x16x32_bf16 v[212:215], a[216:219], v[120:123], v[212:215]
    v_exp_f32 v210, v210
    v_mfma_f32_16x16x32_bf16 v[212:215], a[220:223], v[124:127], v[212:215]
    v_exp_f32 v211, v211
    v_mfma_f32_16x16x32_bf16 a[88:91], a[168:171], v[144:147], a[88:91]
    ds_read_b64_tr_b16 a[184:185], v27 offset:32768
    v_cvt_pk_bf16_f32 v180, v208, v209
    v_mfma_f32_16x16x32_bf16 a[88:91], a[172:175], v[148:151], a[88:91]
    ds_read_b64_tr_b16 a[186:187], v27 offset:36864
    v_mfma_f32_16x16x32_bf16 a[92:95], a[168:171], v[152:155], a[92:95]
    ds_read_b128 a[208:211], v8 offset:0
    v_cvt_pk_bf16_f32 v181, v210, v211
    v_mfma_f32_16x16x32_bf16 a[92:95], a[172:175], v[156:159], a[92:95]
    s_waitcnt lgkmcnt(3)
    buffer_load_dwordx4 v36, s[8:11], s40 offen lds
    v_mfma_f32_16x16x32_bf16 v[208:211], a[224:227], v[64:67], v[192:195]
    v_exp_f32 v212, v212
    v_mfma_f32_16x16x32_bf16 v[208:211], a[228:231], v[68:71], v[208:211]
    v_exp_f32 v213, v213
    v_mfma_f32_16x16x32_bf16 v[208:211], a[232:235], v[72:75], v[208:211]
    v_exp_f32 v214, v214
    v_mfma_f32_16x16x32_bf16 v[208:211], a[236:239], v[76:79], v[208:211]
    v_exp_f32 v215, v215
    v_mfma_f32_16x16x32_bf16 a[96:99], a[176:179], v[128:131], a[96:99]
    ds_read_b64_tr_b16 a[188:189], v27 offset:40960
    v_cvt_pk_bf16_f32 v188, v212, v213
    v_mfma_f32_16x16x32_bf16 a[96:99], a[180:183], v[132:135], a[96:99]
    ds_read_b64_tr_b16 a[190:191], v27 offset:45056
    v_mfma_f32_16x16x32_bf16 a[100:103], a[176:179], v[136:139], a[100:103]
    ds_read_b128 a[212:215], v9 offset:0
    v_cvt_pk_bf16_f32 v189, v214, v215
    v_mfma_f32_16x16x32_bf16 a[100:103], a[180:183], v[140:143], a[100:103]
    buffer_load_dword v219, v62, s[84:87], s38 offen
    v_mfma_f32_16x16x32_bf16 v[212:215], a[224:227], v[80:83], v[196:199]
    v_exp_f32 v208, v208
    v_mfma_f32_16x16x32_bf16 v[212:215], a[228:231], v[84:87], v[212:215]
    v_exp_f32 v209, v209
    v_mfma_f32_16x16x32_bf16 v[212:215], a[232:235], v[88:91], v[212:215]
    v_exp_f32 v210, v210
    v_mfma_f32_16x16x32_bf16 v[212:215], a[236:239], v[92:95], v[212:215]
    v_exp_f32 v211, v211
    v_mfma_f32_16x16x32_bf16 a[104:107], a[176:179], v[144:147], a[104:107]
    ds_read_b64_tr_b16 a[160:161], v20 offset:49152
    v_cvt_pk_bf16_f32 v166, v208, v209
    v_mfma_f32_16x16x32_bf16 a[104:107], a[180:183], v[148:151], a[104:107]
    ds_read_b64_tr_b16 a[162:163], v20 offset:53248
    v_mfma_f32_16x16x32_bf16 a[108:111], a[176:179], v[152:155], a[108:111]
    ds_read_b128 a[216:219], v10 offset:0
    v_cvt_pk_bf16_f32 v167, v210, v211
    v_mfma_f32_16x16x32_bf16 a[108:111], a[180:183], v[156:159], a[108:111]
    s_waitcnt lgkmcnt(3)
    buffer_load_dwordx4 v37, s[8:11], s40 offen offset:1024 lds
    v_mfma_f32_16x16x32_bf16 v[208:211], a[224:227], v[96:99], v[200:203]
    v_exp_f32 v212, v212
    v_mfma_f32_16x16x32_bf16 v[208:211], a[228:231], v[100:103], v[208:211]
    v_exp_f32 v213, v213
    v_mfma_f32_16x16x32_bf16 v[208:211], a[232:235], v[104:107], v[208:211]
    v_exp_f32 v214, v214
    v_mfma_f32_16x16x32_bf16 v[208:211], a[236:239], v[108:111], v[208:211]
    v_exp_f32 v215, v215
    v_mfma_f32_16x16x32_bf16 a[112:115], a[184:187], v[128:131], a[112:115]
    ds_read_b64_tr_b16 a[164:165], v20 offset:57344
    v_cvt_pk_bf16_f32 v174, v212, v213
    v_mfma_f32_16x16x32_bf16 a[112:115], a[188:191], v[132:135], a[112:115]
    ds_read_b64_tr_b16 a[166:167], v20 offset:61440
    v_mfma_f32_16x16x32_bf16 a[116:119], a[184:187], v[136:139], a[116:119]
    ds_read_b128 a[220:223], v11 offset:0
    v_cvt_pk_bf16_f32 v175, v214, v215
    v_mfma_f32_16x16x32_bf16 a[116:119], a[188:191], v[140:143], a[116:119]
    v_mfma_f32_16x16x32_bf16 v[212:215], a[224:227], v[112:115], v[204:207]
    v_exp_f32 v208, v208
    v_mfma_f32_16x16x32_bf16 v[212:215], a[228:231], v[116:119], v[212:215]
    v_exp_f32 v209, v209
    v_mfma_f32_16x16x32_bf16 v[212:215], a[232:235], v[120:123], v[212:215]
    v_exp_f32 v210, v210
    v_mfma_f32_16x16x32_bf16 v[212:215], a[236:239], v[124:127], v[212:215]
    v_exp_f32 v211, v211
    v_mfma_f32_16x16x32_bf16 a[120:123], a[184:187], v[144:147], a[120:123]
    ds_read_b64_tr_b16 a[168:169], v21 offset:49152
    v_cvt_pk_bf16_f32 v182, v208, v209
    v_mfma_f32_16x16x32_bf16 a[120:123], a[188:191], v[148:151], a[120:123]
    ds_read_b64_tr_b16 a[170:171], v21 offset:53248
    v_mfma_f32_16x16x32_bf16 a[124:127], a[184:187], v[152:155], a[124:127]
    ds_read_b128 a[224:227], v8 offset:4096
    v_cvt_pk_bf16_f32 v183, v210, v211
    v_mfma_f32_16x16x32_bf16 a[124:127], a[188:191], v[156:159], a[124:127]
    s_waitcnt lgkmcnt(3)
    buffer_load_dwordx4 v38, s[8:11], s40 offen offset:2048 lds
    v_mfma_f32_16x16x32_bf16 v[208:211], a[208:211], v[64:67], v[192:195]
    v_exp_f32 v212, v212
    v_mfma_f32_16x16x32_bf16 v[208:211], a[212:215], v[68:71], v[208:211]
    v_exp_f32 v213, v213
    v_mfma_f32_16x16x32_bf16 v[208:211], a[216:219], v[72:75], v[208:211]
    v_exp_f32 v214, v214
    v_mfma_f32_16x16x32_bf16 v[208:211], a[220:223], v[76:79], v[208:211]
    v_exp_f32 v215, v215
    v_mfma_f32_16x16x32_bf16 a[0:3], a[160:163], v[160:163], a[0:3]
    ds_read_b64_tr_b16 a[172:173], v21 offset:57344
    v_cvt_pk_bf16_f32 v190, v212, v213
    v_mfma_f32_16x16x32_bf16 a[0:3], a[164:167], v[164:167], a[0:3]
    ds_read_b64_tr_b16 a[174:175], v21 offset:61440
    v_mfma_f32_16x16x32_bf16 a[4:7], a[160:163], v[168:171], a[4:7]
    ds_read_b128 a[228:231], v9 offset:4096
    v_cvt_pk_bf16_f32 v191, v214, v215
    v_mfma_f32_16x16x32_bf16 a[4:7], a[164:167], v[172:175], a[4:7]
    v_mfma_f32_16x16x32_bf16 v[212:215], a[208:211], v[80:83], v[196:199]
    v_exp_f32 v208, v208
    v_mfma_f32_16x16x32_bf16 v[212:215], a[212:215], v[84:87], v[212:215]
    v_exp_f32 v209, v209
    v_mfma_f32_16x16x32_bf16 v[212:215], a[216:219], v[88:91], v[212:215]
    v_exp_f32 v210, v210
    v_mfma_f32_16x16x32_bf16 v[212:215], a[220:223], v[92:95], v[212:215]
    v_exp_f32 v211, v211
    v_mfma_f32_16x16x32_bf16 a[8:11], a[160:163], v[176:179], a[8:11]
    ds_read_b64_tr_b16 a[176:177], v22 offset:49152
    v_cvt_pk_bf16_f32 v128, v208, v209
    v_mfma_f32_16x16x32_bf16 a[8:11], a[164:167], v[180:183], a[8:11]
    ds_read_b64_tr_b16 a[178:179], v22 offset:53248
    v_mfma_f32_16x16x32_bf16 a[12:15], a[160:163], v[184:187], a[12:15]
    ds_read_b128 a[232:235], v10 offset:4096
    v_cvt_pk_bf16_f32 v129, v210, v211
    v_mfma_f32_16x16x32_bf16 a[12:15], a[164:167], v[188:191], a[12:15]
    s_waitcnt lgkmcnt(3)
    buffer_load_dwordx4 v39, s[8:11], s40 offen offset:3072 lds
    v_mfma_f32_16x16x32_bf16 v[208:211], a[208:211], v[96:99], v[200:203]
    v_exp_f32 v212, v212
    v_mfma_f32_16x16x32_bf16 v[208:211], a[212:215], v[100:103], v[208:211]
    s_add_u32 s40, s40, 16384
    v_exp_f32 v213, v213
    v_mfma_f32_16x16x32_bf16 v[208:211], a[216:219], v[104:107], v[208:211]
    v_exp_f32 v214, v214
    v_mfma_f32_16x16x32_bf16 v[208:211], a[220:223], v[108:111], v[208:211]
    v_exp_f32 v215, v215
    v_mfma_f32_16x16x32_bf16 a[16:19], a[168:171], v[160:163], a[16:19]
    ds_read_b64_tr_b16 a[180:181], v22 offset:57344
    v_cvt_pk_bf16_f32 v136, v212, v213
    v_mfma_f32_16x16x32_bf16 a[16:19], a[172:175], v[164:167], a[16:19]
    ds_read_b64_tr_b16 a[182:183], v22 offset:61440
    v_mfma_f32_16x16x32_bf16 a[20:23], a[168:171], v[168:171], a[20:23]
    ds_read_b128 a[236:239], v11 offset:4096
    v_cvt_pk_bf16_f32 v137, v214, v215
    v_mfma_f32_16x16x32_bf16 a[20:23], a[172:175], v[172:175], a[20:23]
    v_smfmac_f32_16x16x64_bf16 a[192:195], v[52:55], v[160:167], v50
    v_mfma_f32_16x16x32_bf16 v[212:215], a[208:211], v[112:115], v[204:207]
    v_exp_f32 v208, v208
    v_mfma_f32_16x16x32_bf16 v[212:215], a[212:215], v[116:119], v[212:215]
    s_add_u32 m0, s42, 81920
    v_exp_f32 v209, v209
    v_mfma_f32_16x16x32_bf16 v[212:215], a[216:219], v[120:123], v[212:215]
    v_exp_f32 v210, v210
    v_mfma_f32_16x16x32_bf16 v[212:215], a[220:223], v[124:127], v[212:215]
    v_exp_f32 v211, v211
    v_mfma_f32_16x16x32_bf16 a[24:27], a[168:171], v[176:179], a[24:27]
    ds_read_b64_tr_b16 a[184:185], v23 offset:49152
    v_cvt_pk_bf16_f32 v144, v208, v209
    v_mfma_f32_16x16x32_bf16 a[24:27], a[172:175], v[180:183], a[24:27]
    ds_read_b64_tr_b16 a[186:187], v23 offset:53248
    v_mfma_f32_16x16x32_bf16 a[28:31], a[168:171], v[184:187], a[28:31]
    ds_read_b128 a[208:211], v8 offset:8192
    v_cvt_pk_bf16_f32 v145, v210, v211
    v_mfma_f32_16x16x32_bf16 a[28:31], a[172:175], v[188:191], a[28:31]
    s_waitcnt lgkmcnt(3)
    buffer_load_dwordx4 v40, s[12:15], s41 offen lds
    v_mfma_f32_16x16x32_bf16 v[208:211], a[224:227], v[64:67], v[192:195]
    v_exp_f32 v212, v212
    v_mfma_f32_16x16x32_bf16 v[208:211], a[228:231], v[68:71], v[208:211]
    v_exp_f32 v213, v213
    v_mfma_f32_16x16x32_bf16 v[208:211], a[232:235], v[72:75], v[208:211]
    v_exp_f32 v214, v214
    v_mfma_f32_16x16x32_bf16 v[208:211], a[236:239], v[76:79], v[208:211]
    v_exp_f32 v215, v215
    v_mfma_f32_16x16x32_bf16 a[32:35], a[176:179], v[160:163], a[32:35]
    ds_read_b64_tr_b16 a[188:189], v23 offset:57344
    v_cvt_pk_bf16_f32 v152, v212, v213
    v_mfma_f32_16x16x32_bf16 a[32:35], a[180:183], v[164:167], a[32:35]
    ds_read_b64_tr_b16 a[190:191], v23 offset:61440
    v_mfma_f32_16x16x32_bf16 a[36:39], a[176:179], v[168:171], a[36:39]
    ds_read_b128 a[212:215], v9 offset:8192
    v_cvt_pk_bf16_f32 v153, v214, v215
    v_mfma_f32_16x16x32_bf16 a[36:39], a[180:183], v[172:175], a[36:39]
    v_smfmac_f32_16x16x64_bf16 a[196:199], v[52:55], v[168:175], v50
    v_mfma_f32_16x16x32_bf16 v[212:215], a[224:227], v[80:83], v[196:199]
    v_exp_f32 v208, v208
    v_mfma_f32_16x16x32_bf16 v[212:215], a[228:231], v[84:87], v[212:215]
    v_exp_f32 v209, v209
    v_mfma_f32_16x16x32_bf16 v[212:215], a[232:235], v[88:91], v[212:215]
    v_exp_f32 v210, v210
    v_mfma_f32_16x16x32_bf16 v[212:215], a[236:239], v[92:95], v[212:215]
    v_exp_f32 v211, v211
    v_mfma_f32_16x16x32_bf16 a[40:43], a[176:179], v[176:179], a[40:43]
    ds_read_b64_tr_b16 a[160:161], v24 offset:49152
    v_cvt_pk_bf16_f32 v130, v208, v209
    v_mfma_f32_16x16x32_bf16 a[40:43], a[180:183], v[180:183], a[40:43]
    ds_read_b64_tr_b16 a[162:163], v24 offset:53248
    v_mfma_f32_16x16x32_bf16 a[44:47], a[176:179], v[184:187], a[44:47]
    ds_read_b128 a[216:219], v10 offset:8192
    v_cvt_pk_bf16_f32 v131, v210, v211
    v_mfma_f32_16x16x32_bf16 a[44:47], a[180:183], v[188:191], a[44:47]
    s_waitcnt lgkmcnt(3)
    buffer_load_dwordx4 v41, s[12:15], s41 offen offset:1024 lds
    v_mfma_f32_16x16x32_bf16 v[208:211], a[224:227], v[96:99], v[200:203]
    v_exp_f32 v212, v212
    v_mfma_f32_16x16x32_bf16 v[208:211], a[228:231], v[100:103], v[208:211]
Ltour5:
    s_cbranch_execz Ltour9
    v_exp_f32 v213, v213
    v_mfma_f32_16x16x32_bf16 v[208:211], a[232:235], v[104:107], v[208:211]
    v_exp_f32 v214, v214
    v_mfma_f32_16x16x32_bf16 v[208:211], a[236:239], v[108:111], v[208:211]
    v_exp_f32 v215, v215
    v_mfma_f32_16x16x32_bf16 a[48:51], a[184:187], v[160:163], a[48:51]
    ds_read_b64_tr_b16 a[164:165], v24 offset:57344
    v_cvt_pk_bf16_f32 v138, v212, v213
    v_mfma_f32_16x16x32_bf16 a[48:51], a[188:191], v[164:167], a[48:51]
    ds_read_b64_tr_b16 a[166:167], v24 offset:61440
    v_mfma_f32_16x16x32_bf16 a[52:55], a[184:187], v[168:171], a[52:55]
    ds_read_b128 a[220:223], v11 offset:8192
    v_cvt_pk_bf16_f32 v139, v214, v215
    v_mfma_f32_16x16x32_bf16 a[52:55], a[188:191], v[172:175], a[52:55]
    v_smfmac_f32_16x16x64_bf16 a[200:203], v[52:55], v[176:183], v50
    v_mfma_f32_16x16x32_bf16 v[212:215], a[224:227], v[112:115], v[204:207]
    v_exp_f32 v208, v208
    v_mfma_f32_16x16x32_bf16 v[212:215], a[228:231], v[116:119], v[212:215]
    v_exp_f32 v209, v209
    v_mfma_f32_16x16x32_bf16 v[212:215], a[232:235], v[120:123], v[212:215]
    v_exp_f32 v210, v210
    v_mfma_f32_16x16x32_bf16 v[212:215], a[236:239], v[124:127], v[212:215]
    v_exp_f32 v211, v211
    v_mfma_f32_16x16x32_bf16 a[56:59], a[184:187], v[176:179], a[56:59]
    ds_read_b64_tr_b16 a[168:169], v25 offset:49152
    v_cvt_pk_bf16_f32 v146, v208, v209
    v_mfma_f32_16x16x32_bf16 a[56:59], a[188:191], v[180:183], a[56:59]
    ds_read_b64_tr_b16 a[170:171], v25 offset:53248
    v_mfma_f32_16x16x32_bf16 a[60:63], a[184:187], v[184:187], a[60:63]
    ds_read_b128 a[224:227], v8 offset:12288
    v_cvt_pk_bf16_f32 v147, v210, v211
    v_mfma_f32_16x16x32_bf16 a[60:63], a[188:191], v[188:191], a[60:63]
    s_waitcnt lgkmcnt(3)
    buffer_load_dwordx4 v40, s[12:15], s41 offen offset:2048 lds
    v_mfma_f32_16x16x32_bf16 v[208:211], a[208:211], v[64:67], v[192:195]
    v_exp_f32 v212, v212
    v_mfma_f32_16x16x32_bf16 v[208:211], a[212:215], v[68:71], v[208:211]
    v_exp_f32 v213, v213
    v_mfma_f32_16x16x32_bf16 v[208:211], a[216:219], v[72:75], v[208:211]
    v_exp_f32 v214, v214
    v_mfma_f32_16x16x32_bf16 v[208:211], a[220:223], v[76:79], v[208:211]
    v_exp_f32 v215, v215
    v_mfma_f32_16x16x32_bf16 a[64:67], a[160:163], v[160:163], a[64:67]
    ds_read_b64_tr_b16 a[172:173], v25 offset:57344
    v_cvt_pk_bf16_f32 v154, v212, v213
    v_mfma_f32_16x16x32_bf16 a[64:67], a[164:167], v[164:167], a[64:67]
    ds_read_b64_tr_b16 a[174:175], v25 offset:61440
    v_mfma_f32_16x16x32_bf16 a[68:71], a[160:163], v[168:171], a[68:71]
    ds_read_b128 a[228:231], v9 offset:12288
    v_cvt_pk_bf16_f32 v155, v214, v215
    v_mfma_f32_16x16x32_bf16 a[68:71], a[164:167], v[172:175], a[68:71]
    v_smfmac_f32_16x16x64_bf16 a[204:207], v[52:55], v[184:191], v50
    v_mfma_f32_16x16x32_bf16 v[212:215], a[208:211], v[80:83], v[196:199]
    v_exp_f32 v208, v208
    v_mfma_f32_16x16x32_bf16 v[212:215], a[212:215], v[84:87], v[212:215]
    v_exp_f32 v209, v209
    v_mfma_f32_16x16x32_bf16 v[212:215], a[216:219], v[88:91], v[212:215]
    v_exp_f32 v210, v210
    v_mfma_f32_16x16x32_bf16 v[212:215], a[220:223], v[92:95], v[212:215]
    v_exp_f32 v211, v211
    v_mfma_f32_16x16x32_bf16 a[72:75], a[160:163], v[176:179], a[72:75]
    ds_read_b64_tr_b16 a[176:177], v26 offset:49152
    v_cvt_pk_bf16_f32 v132, v208, v209
    v_mfma_f32_16x16x32_bf16 a[72:75], a[164:167], v[180:183], a[72:75]
    ds_read_b64_tr_b16 a[178:179], v26 offset:53248
    v_mfma_f32_16x16x32_bf16 a[76:79], a[160:163], v[184:187], a[76:79]
    ds_read_b128 a[232:235], v10 offset:12288
    v_cvt_pk_bf16_f32 v133, v210, v211
    v_mfma_f32_16x16x32_bf16 a[76:79], a[164:167], v[188:191], a[76:79]
    s_waitcnt lgkmcnt(3)
    buffer_load_dwordx4 v41, s[12:15], s41 offen offset:3072 lds
    v_mfma_f32_16x16x32_bf16 v[208:211], a[208:211], v[96:99], v[200:203]
    v_exp_f32 v212, v212
    v_mfma_f32_16x16x32_bf16 v[208:211], a[212:215], v[100:103], v[208:211]
    s_add_u32 s41, s41, 16384
    v_exp_f32 v213, v213
    v_mfma_f32_16x16x32_bf16 v[208:211], a[216:219], v[104:107], v[208:211]
    v_exp_f32 v214, v214
    v_mfma_f32_16x16x32_bf16 v[208:211], a[220:223], v[108:111], v[208:211]
    v_exp_f32 v215, v215
    v_mfma_f32_16x16x32_bf16 a[80:83], a[168:171], v[160:163], a[80:83]
    ds_read_b64_tr_b16 a[180:181], v26 offset:57344
    v_cvt_pk_bf16_f32 v140, v212, v213
    v_mfma_f32_16x16x32_bf16 a[80:83], a[172:175], v[164:167], a[80:83]
    ds_read_b64_tr_b16 a[182:183], v26 offset:61440
    v_mfma_f32_16x16x32_bf16 a[84:87], a[168:171], v[168:171], a[84:87]
    ds_read_b128 a[236:239], v11 offset:12288
    v_cvt_pk_bf16_f32 v141, v214, v215
    v_mfma_f32_16x16x32_bf16 a[84:87], a[172:175], v[172:175], a[84:87]
    s_waitcnt vmcnt(9)
    s_barrier
    v_mfma_f32_16x16x32_bf16 v[212:215], a[208:211], v[112:115], v[204:207]
    v_exp_f32 v208, v208
    v_mfma_f32_16x16x32_bf16 v[212:215], a[212:215], v[116:119], v[212:215]
    s_add_u32 m0, s42, 49152
    v_exp_f32 v209, v209
    v_mfma_f32_16x16x32_bf16 v[212:215], a[216:219], v[120:123], v[212:215]
    v_exp_f32 v210, v210
    v_mfma_f32_16x16x32_bf16 v[212:215], a[220:223], v[124:127], v[212:215]
    v_exp_f32 v211, v211
    v_mfma_f32_16x16x32_bf16 a[88:91], a[168:171], v[176:179], a[88:91]
    ds_read_b64_tr_b16 a[184:185], v27 offset:49152
    v_cvt_pk_bf16_f32 v148, v208, v209
    v_mfma_f32_16x16x32_bf16 a[88:91], a[172:175], v[180:183], a[88:91]
    ds_read_b64_tr_b16 a[186:187], v27 offset:53248
    v_mfma_f32_16x16x32_bf16 a[92:95], a[168:171], v[184:187], a[92:95]
    ds_read_b128 a[208:211], v8 offset:16384
    v_cvt_pk_bf16_f32 v149, v210, v211
    v_mfma_f32_16x16x32_bf16 a[92:95], a[172:175], v[188:191], a[92:95]
    s_waitcnt lgkmcnt(3)
    buffer_load_dwordx4 v36, s[8:11], s40 offen lds
    v_mfma_f32_16x16x32_bf16 v[208:211], a[224:227], v[64:67], v[192:195]
    v_exp_f32 v212, v212
    v_mfma_f32_16x16x32_bf16 v[208:211], a[228:231], v[68:71], v[208:211]
    v_exp_f32 v213, v213
    v_mfma_f32_16x16x32_bf16 v[208:211], a[232:235], v[72:75], v[208:211]
    v_exp_f32 v214, v214
    v_mfma_f32_16x16x32_bf16 v[208:211], a[236:239], v[76:79], v[208:211]
    v_exp_f32 v215, v215
    v_mfma_f32_16x16x32_bf16 a[96:99], a[176:179], v[160:163], a[96:99]
    ds_read_b64_tr_b16 a[188:189], v27 offset:57344
    v_cvt_pk_bf16_f32 v156, v212, v213
    v_mfma_f32_16x16x32_bf16 a[96:99], a[180:183], v[164:167], a[96:99]
    ds_read_b64_tr_b16 a[190:191], v27 offset:61440
    v_mfma_f32_16x16x32_bf16 a[100:103], a[176:179], v[168:171], a[100:103]
    ds_read_b128 a[212:215], v9 offset:16384
    v_cvt_pk_bf16_f32 v157, v214, v215
    v_mfma_f32_16x16x32_bf16 a[100:103], a[180:183], v[172:175], a[100:103]
    v_mfma_f32_16x16x32_bf16 v[212:215], a[224:227], v[80:83], v[196:199]
    v_exp_f32 v208, v208
    v_mfma_f32_16x16x32_bf16 v[212:215], a[228:231], v[84:87], v[212:215]
    s_sub_u32 s39, s39, 36864
    v_exp_f32 v209, v209
    v_mfma_f32_16x16x32_bf16 v[212:215], a[232:235], v[88:91], v[212:215]
    s_sub_u32 s38, s38, 4608
    v_exp_f32 v210, v210
    v_mfma_f32_16x16x32_bf16 v[212:215], a[236:239], v[92:95], v[212:215]
    v_exp_f32 v211, v211
    v_mfma_f32_16x16x32_bf16 a[104:107], a[176:179], v[176:179], a[104:107]
    ds_read_b64_tr_b16 a[160:161], v20 offset:0
    v_cvt_pk_bf16_f32 v134, v208, v209
    v_mfma_f32_16x16x32_bf16 a[104:107], a[180:183], v[180:183], a[104:107]
    ds_read_b64_tr_b16 a[162:163], v20 offset:4096
    v_mfma_f32_16x16x32_bf16 a[108:111], a[176:179], v[184:187], a[108:111]
    ds_read_b128 a[216:219], v10 offset:16384
    v_cvt_pk_bf16_f32 v135, v210, v211
    v_mfma_f32_16x16x32_bf16 a[108:111], a[180:183], v[188:191], a[108:111]
    s_waitcnt lgkmcnt(3)
    buffer_load_dwordx4 v37, s[8:11], s40 offen offset:1024 lds
    v_mfma_f32_16x16x32_bf16 v[208:211], a[224:227], v[96:99], v[200:203]
    v_exp_f32 v212, v212
    v_mfma_f32_16x16x32_bf16 v[208:211], a[228:231], v[100:103], v[208:211]
    v_exp_f32 v213, v213
    v_mfma_f32_16x16x32_bf16 v[208:211], a[232:235], v[104:107], v[208:211]
    v_exp_f32 v214, v214
    v_mfma_f32_16x16x32_bf16 v[208:211], a[236:239], v[108:111], v[208:211]
    v_exp_f32 v215, v215
    v_mfma_f32_16x16x32_bf16 a[112:115], a[184:187], v[160:163], a[112:115]
    ds_read_b64_tr_b16 a[164:165], v20 offset:8192
    v_cvt_pk_bf16_f32 v142, v212, v213
    v_mfma_f32_16x16x32_bf16 a[112:115], a[188:191], v[164:167], a[112:115]
    ds_read_b64_tr_b16 a[166:167], v20 offset:12288
    v_mfma_f32_16x16x32_bf16 a[116:119], a[184:187], v[168:171], a[116:119]
    ds_read_b128 a[220:223], v11 offset:16384
    v_cvt_pk_bf16_f32 v143, v214, v215
    v_mfma_f32_16x16x32_bf16 a[116:119], a[188:191], v[172:175], a[116:119]
    v_mfma_f32_16x16x32_bf16 v[212:215], a[224:227], v[112:115], v[204:207]
    v_exp_f32 v208, v208
    v_mfma_f32_16x16x32_bf16 v[212:215], a[228:231], v[116:119], v[212:215]
    v_exp_f32 v209, v209
    v_mfma_f32_16x16x32_bf16 v[212:215], a[232:235], v[120:123], v[212:215]
    v_exp_f32 v210, v210
    v_mfma_f32_16x16x32_bf16 v[212:215], a[236:239], v[124:127], v[212:215]
    v_exp_f32 v211, v211
    v_mfma_f32_16x16x32_bf16 a[120:123], a[184:187], v[176:179], a[120:123]
    ds_read_b64_tr_b16 a[168:169], v21 offset:0
    v_cvt_pk_bf16_f32 v150, v208, v209
    v_mfma_f32_16x16x32_bf16 a[120:123], a[188:191], v[180:183], a[120:123]
    ds_read_b64_tr_b16 a[170:171], v21 offset:4096
    v_mfma_f32_16x16x32_bf16 a[124:127], a[184:187], v[184:187], a[124:127]
    ds_read_b128 a[224:227], v8 offset:20480
    v_cvt_pk_bf16_f32 v151, v210, v211
    v_mfma_f32_16x16x32_bf16 a[124:127], a[188:191], v[188:191], a[124:127]
    s_waitcnt lgkmcnt(3)
    buffer_load_dwordx4 v38, s[8:11], s40 offen offset:2048 lds
    s_sub_u32 s43, s43, 1
    s_cmp_lg_u32 s43, 0
    s_cbranch_scc1 Lattn_loop
    v_mfma_f32_16x16x32_bf16 v[208:211], a[208:211], v[64:67], v[192:195]
    v_exp_f32 v212, v212
    v_mfma_f32_16x16x32_bf16 v[208:211], a[212:215], v[68:71], v[208:211]
    v_exp_f32 v213, v213
    v_mfma_f32_16x16x32_bf16 v[208:211], a[216:219], v[72:75], v[208:211]
    v_exp_f32 v214, v214
    v_mfma_f32_16x16x32_bf16 v[208:211], a[220:223], v[76:79], v[208:211]
    s_add_u32 s57, s58, 0
    v_exp_f32 v215, v215
    v_mfma_f32_16x16x32_bf16 a[0:3], a[160:163], v[128:131], a[0:3]
    ds_read_b64_tr_b16 a[172:173], v21 offset:8192
    v_cvt_pk_bf16_f32 v158, v212, v213
    v_mfma_f32_16x16x32_bf16 a[0:3], a[164:167], v[132:135], a[0:3]
    ds_read_b64_tr_b16 a[174:175], v21 offset:12288
    v_mfma_f32_16x16x32_bf16 a[4:7], a[160:163], v[136:139], a[4:7]
    ds_read_b128 a[228:231], v9 offset:20480
    v_cvt_pk_bf16_f32 v159, v214, v215
    v_mfma_f32_16x16x32_bf16 a[4:7], a[164:167], v[140:143], a[4:7]
    buffer_load_dwordx4 a[128:131], v254, s[80:83], s57 offen
    v_mfma_f32_16x16x32_bf16 v[212:215], a[208:211], v[80:83], v[196:199]
    v_exp_f32 v208, v208
    v_mfma_f32_16x16x32_bf16 v[212:215], a[212:215], v[84:87], v[212:215]
    v_exp_f32 v209, v209
    v_mfma_f32_16x16x32_bf16 v[212:215], a[216:219], v[88:91], v[212:215]
    v_exp_f32 v210, v210
    v_mfma_f32_16x16x32_bf16 v[212:215], a[220:223], v[92:95], v[212:215]
    v_exp_f32 v211, v211
    v_mfma_f32_16x16x32_bf16 a[8:11], a[160:163], v[144:147], a[8:11]
    ds_read_b64_tr_b16 a[176:177], v22 offset:0
    v_cvt_pk_bf16_f32 v160, v208, v209
    v_mfma_f32_16x16x32_bf16 a[8:11], a[164:167], v[148:151], a[8:11]
    ds_read_b64_tr_b16 a[178:179], v22 offset:4096
    v_mfma_f32_16x16x32_bf16 a[12:15], a[160:163], v[152:155], a[12:15]
    ds_read_b128 a[232:235], v10 offset:20480
    v_cvt_pk_bf16_f32 v161, v210, v211
    v_mfma_f32_16x16x32_bf16 a[12:15], a[164:167], v[156:159], a[12:15]
    s_waitcnt lgkmcnt(3)
    buffer_load_dwordx4 v39, s[8:11], s40 offen offset:3072 lds
    v_mfma_f32_16x16x32_bf16 v[208:211], a[208:211], v[96:99], v[200:203]
    v_exp_f32 v212, v212
    v_mfma_f32_16x16x32_bf16 v[208:211], a[212:215], v[100:103], v[208:211]
    s_add_u32 s40, s40, 16384
    v_exp_f32 v213, v213
    v_mfma_f32_16x16x32_bf16 v[208:211], a[216:219], v[104:107], v[208:211]
    v_exp_f32 v214, v214
    v_mfma_f32_16x16x32_bf16 v[208:211], a[220:223], v[108:111], v[208:211]
    v_exp_f32 v215, v215
    v_mfma_f32_16x16x32_bf16 a[16:19], a[168:171], v[128:131], a[16:19]
    ds_read_b64_tr_b16 a[180:181], v22 offset:8192
    v_cvt_pk_bf16_f32 v168, v212, v213
    v_mfma_f32_16x16x32_bf16 a[16:19], a[172:175], v[132:135], a[16:19]
    ds_read_b64_tr_b16 a[182:183], v22 offset:12288
    v_mfma_f32_16x16x32_bf16 a[20:23], a[168:171], v[136:139], a[20:23]
    ds_read_b128 a[236:239], v11 offset:20480
    v_cvt_pk_bf16_f32 v169, v214, v215
    v_mfma_f32_16x16x32_bf16 a[20:23], a[172:175], v[140:143], a[20:23]
    v_smfmac_f32_16x16x64_bf16 a[192:195], v[52:55], v[128:135], v50
    v_mfma_f32_16x16x32_bf16 v[212:215], a[208:211], v[112:115], v[204:207]
    v_exp_f32 v208, v208
    v_mfma_f32_16x16x32_bf16 v[212:215], a[212:215], v[116:119], v[212:215]
    s_add_u32 m0, s42, 98304
    v_exp_f32 v209, v209
    v_mfma_f32_16x16x32_bf16 v[212:215], a[216:219], v[120:123], v[212:215]
    v_exp_f32 v210, v210
    v_mfma_f32_16x16x32_bf16 v[212:215], a[220:223], v[124:127], v[212:215]
    v_exp_f32 v211, v211
    v_mfma_f32_16x16x32_bf16 a[24:27], a[168:171], v[144:147], a[24:27]
    ds_read_b64_tr_b16 a[184:185], v23 offset:0
    v_cvt_pk_bf16_f32 v176, v208, v209
    v_mfma_f32_16x16x32_bf16 a[24:27], a[172:175], v[148:151], a[24:27]
    ds_read_b64_tr_b16 a[186:187], v23 offset:4096
    v_mfma_f32_16x16x32_bf16 a[28:31], a[168:171], v[152:155], a[28:31]
    ds_read_b128 a[208:211], v8 offset:24576
    v_cvt_pk_bf16_f32 v177, v210, v211
    v_mfma_f32_16x16x32_bf16 a[28:31], a[172:175], v[156:159], a[28:31]
    s_waitcnt lgkmcnt(3)
    buffer_load_dwordx4 v40, s[12:15], s41 offen lds
    v_mfma_f32_16x16x32_bf16 v[208:211], a[224:227], v[64:67], v[192:195]
    v_exp_f32 v212, v212
    v_mfma_f32_16x16x32_bf16 v[208:211], a[228:231], v[68:71], v[208:211]
    v_exp_f32 v213, v213
    v_mfma_f32_16x16x32_bf16 v[208:211], a[232:235], v[72:75], v[208:211]
    v_exp_f32 v214, v214
    v_mfma_f32_16x16x32_bf16 v[208:211], a[236:239], v[76:79], v[208:211]
    s_add_u32 s57, s58, 589824
    v_exp_f32 v215, v215
    v_mfma_f32_16x16x32_bf16 a[32:35], a[176:179], v[128:131], a[32:35]
    ds_read_b64_tr_b16 a[188:189], v23 offset:8192
    v_cvt_pk_bf16_f32 v184, v212, v213
    v_mfma_f32_16x16x32_bf16 a[32:35], a[180:183], v[132:135], a[32:35]
    ds_read_b64_tr_b16 a[190:191], v23 offset:12288
    v_mfma_f32_16x16x32_bf16 a[36:39], a[176:179], v[136:139], a[36:39]
    ds_read_b128 a[212:215], v9 offset:24576
    v_cvt_pk_bf16_f32 v185, v214, v215
    v_mfma_f32_16x16x32_bf16 a[36:39], a[180:183], v[140:143], a[36:39]
    buffer_load_dwordx4 a[132:135], v254, s[80:83], s57 offen
    v_smfmac_f32_16x16x64_bf16 a[196:199], v[52:55], v[136:143], v50
    v_mfma_f32_16x16x32_bf16 v[212:215], a[224:227], v[80:83], v[196:199]
    v_exp_f32 v208, v208
    v_mfma_f32_16x16x32_bf16 v[212:215], a[228:231], v[84:87], v[212:215]
    v_exp_f32 v209, v209
    v_mfma_f32_16x16x32_bf16 v[212:215], a[232:235], v[88:91], v[212:215]
    v_exp_f32 v210, v210
    v_mfma_f32_16x16x32_bf16 v[212:215], a[236:239], v[92:95], v[212:215]
    v_exp_f32 v211, v211
    v_mfma_f32_16x16x32_bf16 a[40:43], a[176:179], v[144:147], a[40:43]
    ds_read_b64_tr_b16 a[160:161], v24 offset:0
    v_cvt_pk_bf16_f32 v162, v208, v209
    v_mfma_f32_16x16x32_bf16 a[40:43], a[180:183], v[148:151], a[40:43]
    ds_read_b64_tr_b16 a[162:163], v24 offset:4096
    v_mfma_f32_16x16x32_bf16 a[44:47], a[176:179], v[152:155], a[44:47]
    ds_read_b128 a[216:219], v10 offset:24576
    v_cvt_pk_bf16_f32 v163, v210, v211
    v_mfma_f32_16x16x32_bf16 a[44:47], a[180:183], v[156:159], a[44:47]
    s_waitcnt lgkmcnt(3)
    buffer_load_dwordx4 v41, s[12:15], s41 offen offset:1024 lds
    v_mfma_f32_16x16x32_bf16 v[208:211], a[224:227], v[96:99], v[200:203]
    v_exp_f32 v212, v212
    v_mfma_f32_16x16x32_bf16 v[208:211], a[228:231], v[100:103], v[208:211]
    v_exp_f32 v213, v213
    v_mfma_f32_16x16x32_bf16 v[208:211], a[232:235], v[104:107], v[208:211]
    v_exp_f32 v214, v214
    v_mfma_f32_16x16x32_bf16 v[208:211], a[236:239], v[108:111], v[208:211]
    v_exp_f32 v215, v215
    v_mfma_f32_16x16x32_bf16 a[48:51], a[184:187], v[128:131], a[48:51]
    ds_read_b64_tr_b16 a[164:165], v24 offset:8192
    v_cvt_pk_bf16_f32 v170, v212, v213
    v_mfma_f32_16x16x32_bf16 a[48:51], a[188:191], v[132:135], a[48:51]
    ds_read_b64_tr_b16 a[166:167], v24 offset:12288
    v_mfma_f32_16x16x32_bf16 a[52:55], a[184:187], v[136:139], a[52:55]
    ds_read_b128 a[220:223], v11 offset:24576
    v_cvt_pk_bf16_f32 v171, v214, v215
    v_mfma_f32_16x16x32_bf16 a[52:55], a[188:191], v[140:143], a[52:55]
    v_smfmac_f32_16x16x64_bf16 a[200:203], v[52:55], v[144:151], v50
    v_mfma_f32_16x16x32_bf16 v[212:215], a[224:227], v[112:115], v[204:207]
    v_exp_f32 v208, v208
    v_mfma_f32_16x16x32_bf16 v[212:215], a[228:231], v[116:119], v[212:215]
    v_exp_f32 v209, v209
    v_mfma_f32_16x16x32_bf16 v[212:215], a[232:235], v[120:123], v[212:215]
    v_exp_f32 v210, v210
    v_mfma_f32_16x16x32_bf16 v[212:215], a[236:239], v[124:127], v[212:215]
    v_exp_f32 v211, v211
    v_mfma_f32_16x16x32_bf16 a[56:59], a[184:187], v[144:147], a[56:59]
    ds_read_b64_tr_b16 a[168:169], v25 offset:0
    v_cvt_pk_bf16_f32 v178, v208, v209
    v_mfma_f32_16x16x32_bf16 a[56:59], a[188:191], v[148:151], a[56:59]
    ds_read_b64_tr_b16 a[170:171], v25 offset:4096
    v_mfma_f32_16x16x32_bf16 a[60:63], a[184:187], v[152:155], a[60:63]
    ds_read_b128 a[224:227], v8 offset:28672
    v_cvt_pk_bf16_f32 v179, v210, v211
    v_mfma_f32_16x16x32_bf16 a[60:63], a[188:191], v[156:159], a[60:63]
    s_waitcnt lgkmcnt(3)
    buffer_load_dwordx4 v40, s[12:15], s41 offen offset:2048 lds
    v_mfma_f32_16x16x32_bf16 v[208:211], a[208:211], v[64:67], v[192:195]
    v_exp_f32 v212, v212
    v_mfma_f32_16x16x32_bf16 v[208:211], a[212:215], v[68:71], v[208:211]
    v_exp_f32 v213, v213
    v_mfma_f32_16x16x32_bf16 v[208:211], a[216:219], v[72:75], v[208:211]
    v_exp_f32 v214, v214
    v_mfma_f32_16x16x32_bf16 v[208:211], a[220:223], v[76:79], v[208:211]
    s_add_u32 s57, s58, 1179648
    v_exp_f32 v215, v215
    v_mfma_f32_16x16x32_bf16 a[64:67], a[160:163], v[128:131], a[64:67]
    ds_read_b64_tr_b16 a[172:173], v25 offset:8192
    v_cvt_pk_bf16_f32 v186, v212, v213
    v_mfma_f32_16x16x32_bf16 a[64:67], a[164:167], v[132:135], a[64:67]
    ds_read_b64_tr_b16 a[174:175], v25 offset:12288
    v_mfma_f32_16x16x32_bf16 a[68:71], a[160:163], v[136:139], a[68:71]
    ds_read_b128 a[228:231], v9 offset:28672
    v_cvt_pk_bf16_f32 v187, v214, v215
    v_mfma_f32_16x16x32_bf16 a[68:71], a[164:167], v[140:143], a[68:71]
    buffer_load_dwordx4 a[136:139], v254, s[80:83], s57 offen
    v_smfmac_f32_16x16x64_bf16 a[204:207], v[52:55], v[152:159], v50
    v_mfma_f32_16x16x32_bf16 v[212:215], a[208:211], v[80:83], v[196:199]
    v_exp_f32 v208, v208
    v_mfma_f32_16x16x32_bf16 v[212:215], a[212:215], v[84:87], v[212:215]
    v_exp_f32 v209, v209
    v_mfma_f32_16x16x32_bf16 v[212:215], a[216:219], v[88:91], v[212:215]
    v_exp_f32 v210, v210
    v_mfma_f32_16x16x32_bf16 v[212:215], a[220:223], v[92:95], v[212:215]
    v_exp_f32 v211, v211
    v_mfma_f32_16x16x32_bf16 a[72:75], a[160:163], v[144:147], a[72:75]
    ds_read_b64_tr_b16 a[176:177], v26 offset:0
    v_cvt_pk_bf16_f32 v164, v208, v209
    v_mfma_f32_16x16x32_bf16 a[72:75], a[164:167], v[148:151], a[72:75]
    ds_read_b64_tr_b16 a[178:179], v26 offset:4096
    v_mfma_f32_16x16x32_bf16 a[76:79], a[160:163], v[152:155], a[76:79]
    ds_read_b128 a[232:235], v10 offset:28672
    v_cvt_pk_bf16_f32 v165, v210, v211
    v_mfma_f32_16x16x32_bf16 a[76:79], a[164:167], v[156:159], a[76:79]
    s_waitcnt lgkmcnt(3)
    buffer_load_dwordx4 v41, s[12:15], s41 offen offset:3072 lds
    v_mfma_f32_16x16x32_bf16 v[208:211], a[208:211], v[96:99], v[200:203]
    v_exp_f32 v212, v212
    v_mfma_f32_16x16x32_bf16 v[208:211], a[212:215], v[100:103], v[208:211]
    s_add_u32 s41, s41, 16384
    v_exp_f32 v213, v213
    v_mfma_f32_16x16x32_bf16 v[208:211], a[216:219], v[104:107], v[208:211]
    v_exp_f32 v214, v214
    v_mfma_f32_16x16x32_bf16 v[208:211], a[220:223], v[108:111], v[208:211]
    v_exp_f32 v215, v215
    v_mfma_f32_16x16x32_bf16 a[80:83], a[168:171], v[128:131], a[80:83]
    ds_read_b64_tr_b16 a[180:181], v26 offset:8192
    v_cvt_pk_bf16_f32 v172, v212, v213
    v_mfma_f32_16x16x32_bf16 a[80:83], a[172:175], v[132:135], a[80:83]
    ds_read_b64_tr_b16 a[182:183], v26 offset:12288
    v_mfma_f32_16x16x32_bf16 a[84:87], a[168:171], v[136:139], a[84:87]
    ds_read_b128 a[236:239], v11 offset:28672
    v_cvt_pk_bf16_f32 v173, v214, v215
    v_mfma_f32_16x16x32_bf16 a[84:87], a[172:175], v[140:143], a[84:87]
    s_waitcnt vmcnt(11)
    s_barrier
    v_mfma_f32_16x16x32_bf16 v[212:215], a[208:211], v[112:115], v[204:207]
    v_exp_f32 v208, v208
    v_mfma_f32_16x16x32_bf16 v[212:215], a[212:215], v[116:119], v[212:215]
    s_add_u32 s49, s45, 0
    v_exp_f32 v209, v209
    v_mfma_f32_16x16x32_bf16 v[212:215], a[216:219], v[120:123], v[212:215]
    s_add_u32 m0, s42, 131072
    v_exp_f32 v210, v210
    v_mfma_f32_16x16x32_bf16 v[212:215], a[220:223], v[124:127], v[212:215]
    v_exp_f32 v211, v211
    v_mfma_f32_16x16x32_bf16 a[88:91], a[168:171], v[144:147], a[88:91]
    ds_read_b64_tr_b16 a[184:185], v27 offset:0
    v_cvt_pk_bf16_f32 v180, v208, v209
    v_mfma_f32_16x16x32_bf16 a[88:91], a[172:175], v[148:151], a[88:91]
    ds_read_b64_tr_b16 a[186:187], v27 offset:4096
    v_mfma_f32_16x16x32_bf16 a[92:95], a[168:171], v[152:155], a[92:95]
    ds_read_b128 a[208:211], v8 offset:32768
    v_cvt_pk_bf16_f32 v181, v210, v211
    v_mfma_f32_16x16x32_bf16 a[92:95], a[172:175], v[156:159], a[92:95]
    s_waitcnt lgkmcnt(3)
    buffer_load_dwordx4 v46, s[20:23], s49 offen lds
    v_mfma_f32_16x16x32_bf16 v[208:211], a[224:227], v[64:67], v[192:195]
    v_exp_f32 v212, v212
    v_mfma_f32_16x16x32_bf16 v[208:211], a[228:231], v[68:71], v[208:211]
    v_exp_f32 v213, v213
    v_mfma_f32_16x16x32_bf16 v[208:211], a[232:235], v[72:75], v[208:211]
    v_exp_f32 v214, v214
    v_mfma_f32_16x16x32_bf16 v[208:211], a[236:239], v[76:79], v[208:211]
    v_exp_f32 v215, v215
    v_mfma_f32_16x16x32_bf16 a[96:99], a[176:179], v[128:131], a[96:99]
    ds_read_b64_tr_b16 a[188:189], v27 offset:8192
    v_cvt_pk_bf16_f32 v188, v212, v213
    v_mfma_f32_16x16x32_bf16 a[96:99], a[180:183], v[132:135], a[96:99]
    ds_read_b64_tr_b16 a[190:191], v27 offset:12288
    v_mfma_f32_16x16x32_bf16 a[100:103], a[176:179], v[136:139], a[100:103]
    ds_read_b128 a[212:215], v9 offset:32768
    v_cvt_pk_bf16_f32 v189, v214, v215
    v_mfma_f32_16x16x32_bf16 a[100:103], a[180:183], v[140:143], a[100:103]
    v_mfma_f32_16x16x32_bf16 v[212:215], a[224:227], v[80:83], v[196:199]
    v_exp_f32 v208, v208
    v_mfma_f32_16x16x32_bf16 v[212:215], a[228:231], v[84:87], v[212:215]
    v_exp_f32 v209, v209
    v_mfma_f32_16x16x32_bf16 v[212:215], a[232:235], v[88:91], v[212:215]
    v_exp_f32 v210, v210
    v_mfma_f32_16x16x32_bf16 v[212:215], a[236:239], v[92:95], v[212:215]
    v_exp_f32 v211, v211
    v_mfma_f32_16x16x32_bf16 a[104:107], a[176:179], v[144:147], a[104:107]
    ds_read_b64_tr_b16 a[160:161], v20 offset:16384
    v_cvt_pk_bf16_f32 v166, v208, v209
    v_mfma_f32_16x16x32_bf16 a[104:107], a[180:183], v[148:151], a[104:107]
    ds_read_b64_tr_b16 a[162:163], v20 offset:20480
    v_mfma_f32_16x16x32_bf16 a[108:111], a[176:179], v[152:155], a[108:111]
    ds_read_b128 a[216:219], v10 offset:32768
    v_cvt_pk_bf16_f32 v167, v210, v211
    v_mfma_f32_16x16x32_bf16 a[108:111], a[180:183], v[156:159], a[108:111]
    s_waitcnt lgkmcnt(3)
    buffer_load_dwordx4 v47, s[20:23], s49 offen offset:1024 lds
    v_mfma_f32_16x16x32_bf16 v[208:211], a[224:227], v[96:99], v[200:203]
    v_exp_f32 v212, v212
    v_mfma_f32_16x16x32_bf16 v[208:211], a[228:231], v[100:103], v[208:211]
    v_exp_f32 v213, v213
    v_mfma_f32_16x16x32_bf16 v[208:211], a[232:235], v[104:107], v[208:211]
    v_exp_f32 v214, v214
    v_mfma_f32_16x16x32_bf16 v[208:211], a[236:239], v[108:111], v[208:211]
    s_add_u32 s57, s58, 1769472
    v_exp_f32 v215, v215
    v_mfma_f32_16x16x32_bf16 a[112:115], a[184:187], v[128:131], a[112:115]
    ds_read_b64_tr_b16 a[164:165], v20 offset:24576
    v_cvt_pk_bf16_f32 v174, v212, v213
    v_mfma_f32_16x16x32_bf16 a[112:115], a[188:191], v[132:135], a[112:115]
    ds_read_b64_tr_b16 a[166:167], v20 offset:28672
    v_mfma_f32_16x16x32_bf16 a[116:119], a[184:187], v[136:139], a[116:119]
    ds_read_b128 a[220:223], v11 offset:32768
    v_cvt_pk_bf16_f32 v175, v214, v215
    v_mfma_f32_16x16x32_bf16 a[116:119], a[188:191], v[140:143], a[116:119]
    buffer_load_dwordx4 a[140:143], v254, s[80:83], s57 offen
    v_mfma_f32_16x16x32_bf16 v[212:215], a[224:227], v[112:115], v[204:207]
    v_exp_f32 v208, v208
    v_mfma_f32_16x16x32_bf16 v[212:215], a[228:231], v[116:119], v[212:215]
    v_exp_f32 v209, v209
    v_mfma_f32_16x16x32_bf16 v[212:215], a[232:235], v[120:123], v[212:215]
    v_exp_f32 v210, v210
    v_mfma_f32_16x16x32_bf16 v[212:215], a[236:239], v[124:127], v[212:215]
    v_exp_f32 v211, v211
    v_mfma_f32_16x16x32_bf16 a[120:123], a[184:187], v[144:147], a[120:123]
    ds_read_b64_tr_b16 a[168:169], v21 offset:16384
    v_cvt_pk_bf16_f32 v182, v208, v209
    v_mfma_f32_16x16x32_bf16 a[120:123], a[188:191], v[148:151], a[120:123]
    ds_read_b64_tr_b16 a[170:171], v21 offset:20480
    v_mfma_f32_16x16x32_bf16 a[124:127], a[184:187], v[152:155], a[124:127]
    ds_read_b128 a[224:227], v8 offset:36864
    v_cvt_pk_bf16_f32 v183, v210, v211
    v_mfma_f32_16x16x32_bf16 a[124:127], a[188:191], v[156:159], a[124:127]
    s_waitcnt lgkmcnt(3)
    buffer_load_dwordx4 v48, s[20:23], s49 offen offset:2048 lds
    v_mfma_f32_16x16x32_bf16 v[208:211], a[208:211], v[64:67], v[192:195]
    v_exp_f32 v212, v212
    v_mfma_f32_16x16x32_bf16 v[208:211], a[212:215], v[68:71], v[208:211]
    v_exp_f32 v213, v213
    v_mfma_f32_16x16x32_bf16 v[208:211], a[216:219], v[72:75], v[208:211]
    v_exp_f32 v214, v214
    v_mfma_f32_16x16x32_bf16 v[208:211], a[220:223], v[76:79], v[208:211]
    s_add_u32 s57, s58, 2359296
    v_exp_f32 v215, v215
    v_mfma_f32_16x16x32_bf16 a[0:3], a[160:163], v[160:163], a[0:3]
    ds_read_b64_tr_b16 a[172:173], v21 offset:24576
    v_cvt_pk_bf16_f32 v190, v212, v213
    v_mfma_f32_16x16x32_bf16 a[0:3], a[164:167], v[164:167], a[0:3]
    ds_read_b64_tr_b16 a[174:175], v21 offset:28672
    v_mov_b32 v63, 0
    v_mfma_f32_16x16x32_bf16 a[4:7], a[160:163], v[168:171], a[4:7]
    ds_read_b128 a[228:231], v9 offset:36864
    v_cvt_pk_bf16_f32 v191, v214, v215
    v_mfma_f32_16x16x32_bf16 a[4:7], a[164:167], v[172:175], a[4:7]
    buffer_load_dwordx4 a[144:147], v254, s[80:83], s57 offen
    v_mfma_f32_16x16x32_bf16 v[212:215], a[208:211], v[80:83], v[196:199]
    v_exp_f32 v208, v208
    v_mfma_f32_16x16x32_bf16 v[212:215], a[212:215], v[84:87], v[212:215]
    v_exp_f32 v209, v209
    v_mfma_f32_16x16x32_bf16 v[212:215], a[216:219], v[88:91], v[212:215]
    v_exp_f32 v210, v210
    v_mfma_f32_16x16x32_bf16 v[212:215], a[220:223], v[92:95], v[212:215]
    v_exp_f32 v211, v211
    v_mfma_f32_16x16x32_bf16 a[8:11], a[160:163], v[176:179], a[8:11]
    ds_read_b64_tr_b16 a[176:177], v22 offset:16384
    v_cvt_pk_bf16_f32 v128, v208, v209
    v_mfma_f32_16x16x32_bf16 a[8:11], a[164:167], v[180:183], a[8:11]
    ds_read_b64_tr_b16 a[178:179], v22 offset:20480
    v_mfma_f32_16x16x32_bf16 a[12:15], a[160:163], v[184:187], a[12:15]
    ds_read_b128 a[232:235], v10 offset:36864
    v_cvt_pk_bf16_f32 v129, v210, v211
    v_mfma_f32_16x16x32_bf16 a[12:15], a[164:167], v[188:191], a[12:15]
    s_waitcnt lgkmcnt(3)
    buffer_load_dwordx4 v49, s[20:23], s49 offen offset:3072 lds
    v_mfma_f32_16x16x32_bf16 v[208:211], a[208:211], v[96:99], v[200:203]
    v_exp_f32 v212, v212
    v_mfma_f32_16x16x32_bf16 v[208:211], a[212:215], v[100:103], v[208:211]
    v_exp_f32 v213, v213
    v_mfma_f32_16x16x32_bf16 v[208:211], a[216:219], v[104:107], v[208:211]
    v_exp_f32 v214, v214
    v_mfma_f32_16x16x32_bf16 v[208:211], a[220:223], v[108:111], v[208:211]
    v_exp_f32 v215, v215
    v_mfma_f32_16x16x32_bf16 a[16:19], a[168:171], v[160:163], a[16:19]
    ds_read_b64_tr_b16 a[180:181], v22 offset:24576
    v_cvt_pk_bf16_f32 v136, v212, v213
    v_mfma_f32_16x16x32_bf16 a[16:19], a[172:175], v[164:167], a[16:19]
    ds_read_b64_tr_b16 a[182:183], v22 offset:28672
    v_mfma_f32_16x16x32_bf16 a[20:23], a[168:171], v[168:171], a[20:23]
    ds_read_b128 a[236:239], v11 offset:36864
    v_cvt_pk_bf16_f32 v137, v214, v215
    v_mfma_f32_16x16x32_bf16 a[20:23], a[172:175], v[172:175], a[20:23]
    v_smfmac_f32_16x16x64_bf16 a[192:195], v[52:55], v[160:167], v50
    v_mfma_f32_16x16x32_bf16 v[212:215], a[208:211], v[112:115], v[204:207]
    v_exp_f32 v208, v208
    v_mfma_f32_16x16x32_bf16 v[212:215], a[212:215], v[116:119], v[212:215]
    s_add_u32 m0, s42, 114688
    v_exp_f32 v209, v209
    v_mfma_f32_16x16x32_bf16 v[212:215], a[216:219], v[120:123], v[212:215]
    v_exp_f32 v210, v210
    v_mfma_f32_16x16x32_bf16 v[212:215], a[220:223], v[124:127], v[212:215]
    v_exp_f32 v211, v211
    v_mfma_f32_16x16x32_bf16 a[24:27], a[168:171], v[176:179], a[24:27]
    ds_read_b64_tr_b16 a[184:185], v23 offset:16384
    v_cvt_pk_bf16_f32 v144, v208, v209
    v_mfma_f32_16x16x32_bf16 a[24:27], a[172:175], v[180:183], a[24:27]
    ds_read_b64_tr_b16 a[186:187], v23 offset:20480
    v_mfma_f32_16x16x32_bf16 a[28:31], a[168:171], v[184:187], a[28:31]
    ds_read_b128 a[208:211], v8 offset:40960
    v_cvt_pk_bf16_f32 v145, v210, v211
    v_mfma_f32_16x16x32_bf16 a[28:31], a[172:175], v[188:191], a[28:31]
    s_waitcnt lgkmcnt(3)
    buffer_load_dwordx4 v40, s[12:15], s41 offen lds
    v_mfma_f32_16x16x32_bf16 v[208:211], a[224:227], v[64:67], v[192:195]
    v_exp_f32 v212, v212
    v_mfma_f32_16x16x32_bf16 v[208:211], a[228:231], v[68:71], v[208:211]
    v_exp_f32 v213, v213
    v_mfma_f32_16x16x32_bf16 v[208:211], a[232:235], v[72:75], v[208:211]
    v_exp_f32 v214, v214
    v_mfma_f32_16x16x32_bf16 v[208:211], a[236:239], v[76:79], v[208:211]
    s_add_u32 s57, s58, 2949120
    v_exp_f32 v215, v215
    v_mfma_f32_16x16x32_bf16 a[32:35], a[176:179], v[160:163], a[32:35]
    ds_read_b64_tr_b16 a[188:189], v23 offset:24576
    v_cvt_pk_bf16_f32 v152, v212, v213
    v_mfma_f32_16x16x32_bf16 a[32:35], a[180:183], v[164:167], a[32:35]
    ds_read_b64_tr_b16 a[190:191], v23 offset:28672
    v_mfma_f32_16x16x32_bf16 a[36:39], a[176:179], v[168:171], a[36:39]
Ltour6:
    s_cbranch_execz Ltour10
    ds_read_b128 a[212:215], v9 offset:40960
    v_cvt_pk_bf16_f32 v153, v214, v215
    v_mfma_f32_16x16x32_bf16 a[36:39], a[180:183], v[172:175], a[36:39]
    buffer_load_dwordx4 a[148:151], v254, s[80:83], s57 offen
    v_smfmac_f32_16x16x64_bf16 a[196:199], v[52:55], v[168:175], v50
    v_mfma_f32_16x16x32_bf16 v[212:215], a[224:227], v[80:83], v[196:199]
    v_exp_f32 v208, v208
    v_mfma_f32_16x16x32_bf16 v[212:215], a[228:231], v[84:87], v[212:215]
    v_exp_f32 v209, v209
    v_mfma_f32_16x16x32_bf16 v[212:215], a[232:235], v[88:91], v[212:215]
    v_exp_f32 v210, v210
    v_mfma_f32_16x16x32_bf16 v[212:215], a[236:239], v[92:95], v[212:215]
    v_exp_f32 v211, v211
    v_mfma_f32_16x16x32_bf16 a[40:43], a[176:179], v[176:179], a[40:43]
    ds_read_b64_tr_b16 a[160:161], v24 offset:16384
    v_cvt_pk_bf16_f32 v130, v208, v209
    v_mfma_f32_16x16x32_bf16 a[40:43], a[180:183], v[180:183], a[40:43]
    ds_read_b64_tr_b16 a[162:163], v24 offset:20480
    v_mfma_f32_16x16x32_bf16 a[44:47], a[176:179], v[184:187], a[44:47]
    ds_read_b128 a[216:219], v10 offset:40960
    v_cvt_pk_bf16_f32 v131, v210, v211
    v_mfma_f32_16x16x32_bf16 a[44:47], a[180:183], v[188:191], a[44:47]
    s_waitcnt lgkmcnt(3)
    buffer_load_dwordx4 v41, s[12:15], s41 offen offset:1024 lds
    v_mfma_f32_16x16x32_bf16 v[208:211], a[224:227], v[96:99], v[200:203]
    v_exp_f32 v212, v212
    v_mfma_f32_16x16x32_bf16 v[208:211], a[228:231], v[100:103], v[208:211]
    v_exp_f32 v213, v213
    v_mfma_f32_16x16x32_bf16 v[208:211], a[232:235], v[104:107], v[208:211]
    v_exp_f32 v214, v214
    v_mfma_f32_16x16x32_bf16 v[208:211], a[236:239], v[108:111], v[208:211]
    v_exp_f32 v215, v215
    v_mfma_f32_16x16x32_bf16 a[48:51], a[184:187], v[160:163], a[48:51]
    ds_read_b64_tr_b16 a[164:165], v24 offset:24576
    v_cvt_pk_bf16_f32 v138, v212, v213
    v_mfma_f32_16x16x32_bf16 a[48:51], a[188:191], v[164:167], a[48:51]
    ds_read_b64_tr_b16 a[166:167], v24 offset:28672
    v_mfma_f32_16x16x32_bf16 a[52:55], a[184:187], v[168:171], a[52:55]
    ds_read_b128 a[220:223], v11 offset:40960
    v_cvt_pk_bf16_f32 v139, v214, v215
    v_mfma_f32_16x16x32_bf16 a[52:55], a[188:191], v[172:175], a[52:55]
    v_smfmac_f32_16x16x64_bf16 a[200:203], v[52:55], v[176:183], v50
    v_mfma_f32_16x16x32_bf16 v[212:215], a[224:227], v[112:115], v[204:207]
    v_exp_f32 v208, v208
    v_mfma_f32_16x16x32_bf16 v[212:215], a[228:231], v[116:119], v[212:215]
    v_exp_f32 v209, v209
    v_mfma_f32_16x16x32_bf16 v[212:215], a[232:235], v[120:123], v[212:215]
    v_exp_f32 v210, v210
    v_mfma_f32_16x16x32_bf16 v[212:215], a[236:239], v[124:127], v[212:215]
    v_exp_f32 v211, v211
    v_mfma_f32_16x16x32_bf16 a[56:59], a[184:187], v[176:179], a[56:59]
    ds_read_b64_tr_b16 a[168:169], v25 offset:16384
    v_cvt_pk_bf16_f32 v146, v208, v209
    v_mfma_f32_16x16x32_bf16 a[56:59], a[188:191], v[180:183], a[56:59]
    ds_read_b64_tr_b16 a[170:171], v25 offset:20480
    v_mfma_f32_16x16x32_bf16 a[60:63], a[184:187], v[184:187], a[60:63]
    ds_read_b128 a[224:227], v8 offset:45056
    v_cvt_pk_bf16_f32 v147, v210, v211
    v_mfma_f32_16x16x32_bf16 a[60:63], a[188:191], v[188:191], a[60:63]
    s_waitcnt lgkmcnt(3)
    buffer_load_dwordx4 v40, s[12:15], s41 offen offset:2048 lds
    v_mfma_f32_16x16x32_bf16 v[208:211], a[208:211], v[64:67], v[192:195]
    v_exp_f32 v212, v212
    v_mfma_f32_16x16x32_bf16 v[208:211], a[212:215], v[68:71], v[208:211]
    v_exp_f32 v213, v213
    v_mfma_f32_16x16x32_bf16 v[208:211], a[216:219], v[72:75], v[208:211]
    v_exp_f32 v214, v214
    v_mfma_f32_16x16x32_bf16 v[208:211], a[220:223], v[76:79], v[208:211]
    s_add_u32 s57, s58, 3538944
    v_exp_f32 v215, v215
    v_mfma_f32_16x16x32_bf16 a[64:67], a[160:163], v[160:163], a[64:67]
    ds_read_b64_tr_b16 a[172:173], v25 offset:24576
    v_cvt_pk_bf16_f32 v154, v212, v213
    v_mfma_f32_16x16x32_bf16 a[64:67], a[164:167], v[164:167], a[64:67]
    ds_read_b64_tr_b16 a[174:175], v25 offset:28672
    v_mfma_f32_16x16x32_bf16 a[68:71], a[160:163], v[168:171], a[68:71]
    ds_read_b128 a[228:231], v9 offset:45056
    v_cvt_pk_bf16_f32 v155, v214, v215
    v_mfma_f32_16x16x32_bf16 a[68:71], a[164:167], v[172:175], a[68:71]
    buffer_load_dwordx4 a[152:155], v254, s[80:83], s57 offen
    v_smfmac_f32_16x16x64_bf16 a[204:207], v[52:55], v[184:191], v50
    v_mfma_f32_16x16x32_bf16 v[212:215], a[208:211], v[80:83], v[196:199]
    v_exp_f32 v208, v208
    v_mfma_f32_16x16x32_bf16 v[212:215], a[212:215], v[84:87], v[212:215]
    v_exp_f32 v209, v209
    v_mfma_f32_16x16x32_bf16 v[212:215], a[216:219], v[88:91], v[212:215]
    v_exp_f32 v210, v210
    v_mfma_f32_16x16x32_bf16 v[212:215], a[220:223], v[92:95], v[212:215]
    v_exp_f32 v211, v211
    v_mfma_f32_16x16x32_bf16 a[72:75], a[160:163], v[176:179], a[72:75]
    ds_read_b64_tr_b16 a[176:177], v26 offset:16384
    v_cvt_pk_bf16_f32 v132, v208, v209
    v_mfma_f32_16x16x32_bf16 a[72:75], a[164:167], v[180:183], a[72:75]
    ds_read_b64_tr_b16 a[178:179], v26 offset:20480
    v_mfma_f32_16x16x32_bf16 a[76:79], a[160:163], v[184:187], a[76:79]
    ds_read_b128 a[232:235], v10 offset:45056
    v_cvt_pk_bf16_f32 v133, v210, v211
    v_mfma_f32_16x16x32_bf16 a[76:79], a[164:167], v[188:191], a[76:79]
    s_waitcnt lgkmcnt(3)
    buffer_load_dwordx4 v41, s[12:15], s41 offen offset:3072 lds
    v_mfma_f32_16x16x32_bf16 v[208:211], a[208:211], v[96:99], v[200:203]
    v_exp_f32 v212, v212
    v_mfma_f32_16x16x32_bf16 v[208:211], a[212:215], v[100:103], v[208:211]
    s_add_u32 s41, s41, 16384
    v_exp_f32 v213, v213
    v_mfma_f32_16x16x32_bf16 v[208:211], a[216:219], v[104:107], v[208:211]
    v_exp_f32 v214, v214
    v_mfma_f32_16x16x32_bf16 v[208:211], a[220:223], v[108:111], v[208:211]
    v_exp_f32 v215, v215
    v_mfma_f32_16x16x32_bf16 a[80:83], a[168:171], v[160:163], a[80:83]
    ds_read_b64_tr_b16 a[180:181], v26 offset:24576
    v_cvt_pk_bf16_f32 v140, v212, v213
    v_mfma_f32_16x16x32_bf16 a[80:83], a[172:175], v[164:167], a[80:83]
    ds_read_b64_tr_b16 a[182:183], v26 offset:28672
    v_mfma_f32_16x16x32_bf16 a[84:87], a[168:171], v[168:171], a[84:87]
    ds_read_b128 a[236:239], v11 offset:45056
    v_cvt_pk_bf16_f32 v141, v214, v215
    v_mfma_f32_16x16x32_bf16 a[84:87], a[172:175], v[172:175], a[84:87]
    s_waitcnt vmcnt(12)
    s_barrier
    v_mfma_f32_16x16x32_bf16 v[212:215], a[208:211], v[112:115], v[204:207]
    v_exp_f32 v208, v208
    v_mfma_f32_16x16x32_bf16 v[212:215], a[212:215], v[116:119], v[212:215]
    s_add_u32 s49, s45, 73728
    v_exp_f32 v209, v209
    v_mfma_f32_16x16x32_bf16 v[212:215], a[216:219], v[120:123], v[212:215]
    s_add_u32 m0, s42, 147456
    v_exp_f32 v210, v210
    v_mfma_f32_16x16x32_bf16 v[212:215], a[220:223], v[124:127], v[212:215]
    v_exp_f32 v211, v211
    v_mfma_f32_16x16x32_bf16 a[88:91], a[168:171], v[176:179], a[88:91]
    ds_read_b64_tr_b16 a[184:185], v27 offset:16384
    v_cvt_pk_bf16_f32 v148, v208, v209
    v_mfma_f32_16x16x32_bf16 a[88:91], a[172:175], v[180:183], a[88:91]
    ds_read_b64_tr_b16 a[186:187], v27 offset:20480
    v_mfma_f32_16x16x32_bf16 a[92:95], a[168:171], v[184:187], a[92:95]
    ds_read_b128 a[208:211], v8 offset:49152
    v_cvt_pk_bf16_f32 v149, v210, v211
    v_mfma_f32_16x16x32_bf16 a[92:95], a[172:175], v[188:191], a[92:95]
    s_waitcnt lgkmcnt(3)
    buffer_load_dwordx4 v46, s[20:23], s49 offen lds
    v_mfma_f32_16x16x32_bf16 v[208:211], a[224:227], v[64:67], v[192:195]
    v_exp_f32 v212, v212
    v_mfma_f32_16x16x32_bf16 v[208:211], a[228:231], v[68:71], v[208:211]
    v_exp_f32 v213, v213
    v_mfma_f32_16x16x32_bf16 v[208:211], a[232:235], v[72:75], v[208:211]
    v_exp_f32 v214, v214
    v_mfma_f32_16x16x32_bf16 v[208:211], a[236:239], v[76:79], v[208:211]
    v_exp_f32 v215, v215
    v_mfma_f32_16x16x32_bf16 a[96:99], a[176:179], v[160:163], a[96:99]
    ds_read_b64_tr_b16 a[188:189], v27 offset:24576
    v_cvt_pk_bf16_f32 v156, v212, v213
    v_mfma_f32_16x16x32_bf16 a[96:99], a[180:183], v[164:167], a[96:99]
    ds_read_b64_tr_b16 a[190:191], v27 offset:28672
    v_mfma_f32_16x16x32_bf16 a[100:103], a[176:179], v[168:171], a[100:103]
    ds_read_b128 a[212:215], v9 offset:49152
    v_cvt_pk_bf16_f32 v157, v214, v215
    v_mfma_f32_16x16x32_bf16 a[100:103], a[180:183], v[172:175], a[100:103]
    buffer_load_dword v63, v63, s[88:91], 0 offen sc1
    v_mfma_f32_16x16x32_bf16 v[212:215], a[224:227], v[80:83], v[196:199]
    v_exp_f32 v208, v208
    v_mfma_f32_16x16x32_bf16 v[212:215], a[228:231], v[84:87], v[212:215]
    v_exp_f32 v209, v209
    v_mfma_f32_16x16x32_bf16 v[212:215], a[232:235], v[88:91], v[212:215]
    v_exp_f32 v210, v210
    v_mfma_f32_16x16x32_bf16 v[212:215], a[236:239], v[92:95], v[212:215]
    v_exp_f32 v211, v211
    v_mfma_f32_16x16x32_bf16 a[104:107], a[176:179], v[176:179], a[104:107]
    ds_read_b64_tr_b16 a[160:161], v20 offset:32768
    v_cvt_pk_bf16_f32 v134, v208, v209
    v_mfma_f32_16x16x32_bf16 a[104:107], a[180:183], v[180:183], a[104:107]
    ds_read_b64_tr_b16 a[162:163], v20 offset:36864
    v_mfma_f32_16x16x32_bf16 a[108:111], a[176:179], v[184:187], a[108:111]
    ds_read_b128 a[216:219], v10 offset:49152
    v_cvt_pk_bf16_f32 v135, v210, v211
    v_mfma_f32_16x16x32_bf16 a[108:111], a[180:183], v[188:191], a[108:111]
    s_waitcnt lgkmcnt(3)
    buffer_load_dwordx4 v47, s[20:23], s49 offen offset:1024 lds
    v_mfma_f32_16x16x32_bf16 v[208:211], a[224:227], v[96:99], v[200:203]
    v_exp_f32 v212, v212
    v_mfma_f32_16x16x32_bf16 v[208:211], a[228:231], v[100:103], v[208:211]
    v_exp_f32 v213, v213
    v_mfma_f32_16x16x32_bf16 v[208:211], a[232:235], v[104:107], v[208:211]
    v_exp_f32 v214, v214
    v_mfma_f32_16x16x32_bf16 v[208:211], a[236:239], v[108:111], v[208:211]
    s_add_u32 s57, s58, 4128768
    v_exp_f32 v215, v215
    v_mfma_f32_16x16x32_bf16 a[112:115], a[184:187], v[160:163], a[112:115]
    ds_read_b64_tr_b16 a[164:165], v20 offset:40960
    v_cvt_pk_bf16_f32 v142, v212, v213
    v_mfma_f32_16x16x32_bf16 a[112:115], a[188:191], v[164:167], a[112:115]
    ds_read_b64_tr_b16 a[166:167], v20 offset:45056
    v_mfma_f32_16x16x32_bf16 a[116:119], a[184:187], v[168:171], a[116:119]
    ds_read_b128 a[220:223], v11 offset:49152
    v_cvt_pk_bf16_f32 v143, v214, v215
    v_mfma_f32_16x16x32_bf16 a[116:119], a[188:191], v[172:175], a[116:119]
    buffer_load_dwordx4 a[156:159], v254, s[80:83], s57 offen
    v_mfma_f32_16x16x32_bf16 v[212:215], a[224:227], v[112:115], v[204:207]
    v_exp_f32 v208, v208
    v_mfma_f32_16x16x32_bf16 v[212:215], a[228:231], v[116:119], v[212:215]
    v_exp_f32 v209, v209
    v_mfma_f32_16x16x32_bf16 v[212:215], a[232:235], v[120:123], v[212:215]
    v_exp_f32 v210, v210
    v_mfma_f32_16x16x32_bf16 v[212:215], a[236:239], v[124:127], v[212:215]
    v_exp_f32 v211, v211
    v_mfma_f32_16x16x32_bf16 a[120:123], a[184:187], v[176:179], a[120:123]
    ds_read_b64_tr_b16 a[168:169], v21 offset:32768
    v_cvt_pk_bf16_f32 v150, v208, v209
    v_mfma_f32_16x16x32_bf16 a[120:123], a[188:191], v[180:183], a[120:123]
    ds_read_b64_tr_b16 a[170:171], v21 offset:36864
    v_mfma_f32_16x16x32_bf16 a[124:127], a[184:187], v[184:187], a[124:127]
    ds_read_b128 a[224:227], v8 offset:53248
    v_cvt_pk_bf16_f32 v151, v210, v211
    v_mfma_f32_16x16x32_bf16 a[124:127], a[188:191], v[188:191], a[124:127]
    s_waitcnt lgkmcnt(3)
    buffer_load_dwordx4 v48, s[20:23], s49 offen offset:2048 lds
    v_mfma_f32_16x16x32_bf16 v[208:211], a[208:211], v[64:67], v[192:195]
    v_exp_f32 v212, v212
    v_mfma_f32_16x16x32_bf16 v[208:211], a[212:215], v[68:71], v[208:211]
    v_exp_f32 v213, v213
    v_mfma_f32_16x16x32_bf16 v[208:211], a[216:219], v[72:75], v[208:211]
    v_exp_f32 v214, v214
    v_mfma_f32_16x16x32_bf16 v[208:211], a[220:223], v[76:79], v[208:211]
    s_add_u32 s57, s58, 4718592
    v_exp_f32 v215, v215
    v_mfma_f32_16x16x32_bf16 a[0:3], a[160:163], v[128:131], a[0:3]
    ds_read_b64_tr_b16 a[172:173], v21 offset:40960
    v_cvt_pk_bf16_f32 v158, v212, v213
    v_mfma_f32_16x16x32_bf16 a[0:3], a[164:167], v[132:135], a[0:3]
    ds_read_b64_tr_b16 a[174:175], v21 offset:45056
    v_mfma_f32_16x16x32_bf16 a[4:7], a[160:163], v[136:139], a[4:7]
    ds_read_b128 a[228:231], v9 offset:53248
    v_cvt_pk_bf16_f32 v159, v214, v215
    v_mfma_f32_16x16x32_bf16 a[4:7], a[164:167], v[140:143], a[4:7]
    buffer_load_dwordx4 a[240:243], v254, s[80:83], s57 offen
    v_mfma_f32_16x16x32_bf16 v[212:215], a[208:211], v[80:83], v[196:199]
    v_exp_f32 v208, v208
    v_mfma_f32_16x16x32_bf16 v[212:215], a[212:215], v[84:87], v[212:215]
    v_exp_f32 v209, v209
    v_mfma_f32_16x16x32_bf16 v[212:215], a[216:219], v[88:91], v[212:215]
    v_exp_f32 v210, v210
    v_mfma_f32_16x16x32_bf16 v[212:215], a[220:223], v[92:95], v[212:215]
    v_exp_f32 v211, v211
    v_mfma_f32_16x16x32_bf16 a[8:11], a[160:163], v[144:147], a[8:11]
    ds_read_b64_tr_b16 a[176:177], v22 offset:32768
    v_cvt_pk_bf16_f32 v160, v208, v209
    v_mfma_f32_16x16x32_bf16 a[8:11], a[164:167], v[148:151], a[8:11]
    ds_read_b64_tr_b16 a[178:179], v22 offset:36864
    v_mfma_f32_16x16x32_bf16 a[12:15], a[160:163], v[152:155], a[12:15]
    ds_read_b128 a[232:235], v10 offset:53248
    v_cvt_pk_bf16_f32 v161, v210, v211
    v_mfma_f32_16x16x32_bf16 a[12:15], a[164:167], v[156:159], a[12:15]
    s_waitcnt lgkmcnt(3)
    buffer_load_dwordx4 v49, s[20:23], s49 offen offset:3072 lds
    v_mfma_f32_16x16x32_bf16 v[208:211], a[208:211], v[96:99], v[200:203]
    v_exp_f32 v212, v212
    v_mfma_f32_16x16x32_bf16 v[208:211], a[212:215], v[100:103], v[208:211]
    v_exp_f32 v213, v213
    v_mfma_f32_16x16x32_bf16 v[208:211], a[216:219], v[104:107], v[208:211]
    v_exp_f32 v214, v214
    v_mfma_f32_16x16x32_bf16 v[208:211], a[220:223], v[108:111], v[208:211]
    v_exp_f32 v215, v215
    v_mfma_f32_16x16x32_bf16 a[16:19], a[168:171], v[128:131], a[16:19]
    ds_read_b64_tr_b16 a[180:181], v22 offset:40960
    v_cvt_pk_bf16_f32 v168, v212, v213
    v_mfma_f32_16x16x32_bf16 a[16:19], a[172:175], v[132:135], a[16:19]
    ds_read_b64_tr_b16 a[182:183], v22 offset:45056
    v_mfma_f32_16x16x32_bf16 a[20:23], a[168:171], v[136:139], a[20:23]
    ds_read_b128 a[236:239], v11 offset:53248
    v_cvt_pk_bf16_f32 v169, v214, v215
    v_mfma_f32_16x16x32_bf16 a[20:23], a[172:175], v[140:143], a[20:23]
    v_smfmac_f32_16x16x64_bf16 a[192:195], v[52:55], v[128:135], v50
    v_mfma_f32_16x16x32_bf16 v[212:215], a[208:211], v[112:115], v[204:207]
    v_exp_f32 v208, v208
    v_mfma_f32_16x16x32_bf16 v[212:215], a[212:215], v[116:119], v[212:215]
    s_add_u32 s49, s45, 128
    v_exp_f32 v209, v209
    v_mfma_f32_16x16x32_bf16 v[212:215], a[216:219], v[120:123], v[212:215]
    s_add_u32 m0, s42, 0
    v_exp_f32 v210, v210
    v_mfma_f32_16x16x32_bf16 v[212:215], a[220:223], v[124:127], v[212:215]
    v_exp_f32 v211, v211
    v_mfma_f32_16x16x32_bf16 a[24:27], a[168:171], v[144:147], a[24:27]
    ds_read_b64_tr_b16 a[184:185], v23 offset:32768
    v_cvt_pk_bf16_f32 v176, v208, v209
    v_mfma_f32_16x16x32_bf16 a[24:27], a[172:175], v[148:151], a[24:27]
    ds_read_b64_tr_b16 a[186:187], v23 offset:36864
    v_mfma_f32_16x16x32_bf16 a[28:31], a[168:171], v[152:155], a[28:31]
    ds_read_b128 a[208:211], v8 offset:57344
    v_cvt_pk_bf16_f32 v177, v210, v211
    v_mfma_f32_16x16x32_bf16 a[28:31], a[172:175], v[156:159], a[28:31]
    s_waitcnt lgkmcnt(3)
    buffer_load_dwordx4 v46, s[20:23], s49 offen lds
    v_mfma_f32_16x16x32_bf16 v[208:211], a[224:227], v[64:67], v[192:195]
    v_exp_f32 v212, v212
    v_mfma_f32_16x16x32_bf16 v[208:211], a[228:231], v[68:71], v[208:211]
    v_exp_f32 v213, v213
    v_mfma_f32_16x16x32_bf16 v[208:211], a[232:235], v[72:75], v[208:211]
    v_exp_f32 v214, v214
    v_mfma_f32_16x16x32_bf16 v[208:211], a[236:239], v[76:79], v[208:211]
    s_add_u32 s57, s58, 0
    v_exp_f32 v215, v215
    v_mfma_f32_16x16x32_bf16 a[32:35], a[176:179], v[128:131], a[32:35]
    ds_read_b64_tr_b16 a[188:189], v23 offset:40960
    v_cvt_pk_bf16_f32 v184, v212, v213
    v_mfma_f32_16x16x32_bf16 a[32:35], a[180:183], v[132:135], a[32:35]
    ds_read_b64_tr_b16 a[190:191], v23 offset:45056
    v_mfma_f32_16x16x32_bf16 a[36:39], a[176:179], v[136:139], a[36:39]
    ds_read_b128 a[212:215], v9 offset:57344
    v_cvt_pk_bf16_f32 v185, v214, v215
    v_mfma_f32_16x16x32_bf16 a[36:39], a[180:183], v[140:143], a[36:39]
    buffer_load_dwordx4 a[244:247], v254, s[32:35], s57 offen
    v_smfmac_f32_16x16x64_bf16 a[196:199], v[52:55], v[136:143], v50
    v_mfma_f32_16x16x32_bf16 v[212:215], a[224:227], v[80:83], v[196:199]
    v_exp_f32 v208, v208
    v_mfma_f32_16x16x32_bf16 v[212:215], a[228:231], v[84:87], v[212:215]
    v_exp_f32 v209, v209
    v_mfma_f32_16x16x32_bf16 v[212:215], a[232:235], v[88:91], v[212:215]
    v_exp_f32 v210, v210
    v_mfma_f32_16x16x32_bf16 v[212:215], a[236:239], v[92:95], v[212:215]
    v_exp_f32 v211, v211
    v_mfma_f32_16x16x32_bf16 a[40:43], a[176:179], v[144:147], a[40:43]
    ds_read_b64_tr_b16 a[160:161], v24 offset:32768
    v_cvt_pk_bf16_f32 v162, v208, v209
    v_mfma_f32_16x16x32_bf16 a[40:43], a[180:183], v[148:151], a[40:43]
    ds_read_b64_tr_b16 a[162:163], v24 offset:36864
    v_mfma_f32_16x16x32_bf16 a[44:47], a[176:179], v[152:155], a[44:47]
    ds_read_b128 a[216:219], v10 offset:57344
    v_cvt_pk_bf16_f32 v163, v210, v211
    v_mfma_f32_16x16x32_bf16 a[44:47], a[180:183], v[156:159], a[44:47]
    s_waitcnt lgkmcnt(3)
    buffer_load_dwordx4 v47, s[20:23], s49 offen offset:1024 lds
    v_mfma_f32_16x16x32_bf16 v[208:211], a[224:227], v[96:99], v[200:203]
    v_exp_f32 v212, v212
    v_mfma_f32_16x16x32_bf16 v[208:211], a[228:231], v[100:103], v[208:211]
    v_exp_f32 v213, v213
    v_mfma_f32_16x16x32_bf16 v[208:211], a[232:235], v[104:107], v[208:211]
    v_exp_f32 v214, v214
    v_mfma_f32_16x16x32_bf16 v[208:211], a[236:239], v[108:111], v[208:211]
    v_exp_f32 v215, v215
    v_mfma_f32_16x16x32_bf16 a[48:51], a[184:187], v[128:131], a[48:51]
    ds_read_b64_tr_b16 a[164:165], v24 offset:40960
    v_cvt_pk_bf16_f32 v170, v212, v213
    v_mfma_f32_16x16x32_bf16 a[48:51], a[188:191], v[132:135], a[48:51]
    ds_read_b64_tr_b16 a[166:167], v24 offset:45056
    v_mfma_f32_16x16x32_bf16 a[52:55], a[184:187], v[136:139], a[52:55]
    ds_read_b128 a[220:223], v11 offset:57344
    v_cvt_pk_bf16_f32 v171, v214, v215
    v_mfma_f32_16x16x32_bf16 a[52:55], a[188:191], v[140:143], a[52:55]
    v_smfmac_f32_16x16x64_bf16 a[200:203], v[52:55], v[144:151], v50
    v_mfma_f32_16x16x32_bf16 v[212:215], a[224:227], v[112:115], v[204:207]
    v_exp_f32 v208, v208
    v_mfma_f32_16x16x32_bf16 v[212:215], a[228:231], v[116:119], v[212:215]
    v_exp_f32 v209, v209
    v_mfma_f32_16x16x32_bf16 v[212:215], a[232:235], v[120:123], v[212:215]
    v_exp_f32 v210, v210
    v_mfma_f32_16x16x32_bf16 v[212:215], a[236:239], v[124:127], v[212:215]
    v_exp_f32 v211, v211
    v_mfma_f32_16x16x32_bf16 a[56:59], a[184:187], v[144:147], a[56:59]
    ds_read_b64_tr_b16 a[168:169], v25 offset:32768
    v_cvt_pk_bf16_f32 v178, v208, v209
    v_mfma_f32_16x16x32_bf16 a[56:59], a[188:191], v[148:151], a[56:59]
    ds_read_b64_tr_b16 a[170:171], v25 offset:36864
    v_mfma_f32_16x16x32_bf16 a[60:63], a[184:187], v[152:155], a[60:63]
    ds_read_b128 a[224:227], v8 offset:61440
    v_cvt_pk_bf16_f32 v179, v210, v211
    v_mfma_f32_16x16x32_bf16 a[60:63], a[188:191], v[156:159], a[60:63]
    s_waitcnt lgkmcnt(3)
    buffer_load_dwordx4 v48, s[20:23], s49 offen offset:2048 lds
    v_mfma_f32_16x16x32_bf16 v[208:211], a[208:211], v[64:67], v[192:195]
    v_exp_f32 v212, v212
    v_mfma_f32_16x16x32_bf16 v[208:211], a[212:215], v[68:71], v[208:211]
    v_exp_f32 v213, v213
    v_mfma_f32_16x16x32_bf16 v[208:211], a[216:219], v[72:75], v[208:211]
    v_exp_f32 v214, v214
    v_mfma_f32_16x16x32_bf16 v[208:211], a[220:223], v[76:79], v[208:211]
    s_add_u32 s57, s58, 589824
    v_exp_f32 v215, v215
    v_mfma_f32_16x16x32_bf16 a[64:67], a[160:163], v[128:131], a[64:67]
    ds_read_b64_tr_b16 a[172:173], v25 offset:40960
    v_cvt_pk_bf16_f32 v186, v212, v213
    v_mfma_f32_16x16x32_bf16 a[64:67], a[164:167], v[132:135], a[64:67]
    ds_read_b64_tr_b16 a[174:175], v25 offset:45056
    v_mfma_f32_16x16x32_bf16 a[68:71], a[160:163], v[136:139], a[68:71]
    ds_read_b128 a[228:231], v9 offset:61440
    v_cvt_pk_bf16_f32 v187, v214, v215
    v_mfma_f32_16x16x32_bf16 a[68:71], a[164:167], v[140:143], a[68:71]
    buffer_load_dwordx4 a[248:251], v254, s[32:35], s57 offen
    v_smfmac_f32_16x16x64_bf16 a[204:207], v[52:55], v[152:159], v50
    v_mfma_f32_16x16x32_bf16 v[212:215], a[208:211], v[80:83], v[196:199]
    v_exp_f32 v208, v208
    v_mfma_f32_16x16x32_bf16 v[212:215], a[212:215], v[84:87], v[212:215]
    v_exp_f32 v209, v209
    v_mfma_f32_16x16x32_bf16 v[212:215], a[216:219], v[88:91], v[212:215]
    v_exp_f32 v210, v210
    v_mfma_f32_16x16x32_bf16 v[212:215], a[220:223], v[92:95], v[212:215]
    v_exp_f32 v211, v211
    v_mfma_f32_16x16x32_bf16 a[72:75], a[160:163], v[144:147], a[72:75]
    ds_read_b64_tr_b16 a[176:177], v26 offset:32768
    v_cvt_pk_bf16_f32 v164, v208, v209
    v_mfma_f32_16x16x32_bf16 a[72:75], a[164:167], v[148:151], a[72:75]
    ds_read_b64_tr_b16 a[178:179], v26 offset:36864
    v_mfma_f32_16x16x32_bf16 a[76:79], a[160:163], v[152:155], a[76:79]
    ds_read_b128 a[232:235], v10 offset:61440
    v_cvt_pk_bf16_f32 v165, v210, v211
    v_mfma_f32_16x16x32_bf16 a[76:79], a[164:167], v[156:159], a[76:79]
    s_waitcnt lgkmcnt(3)
    buffer_load_dwordx4 v49, s[20:23], s49 offen offset:3072 lds
    v_mfma_f32_16x16x32_bf16 v[208:211], a[208:211], v[96:99], v[200:203]
    v_exp_f32 v212, v212
    v_mfma_f32_16x16x32_bf16 v[208:211], a[212:215], v[100:103], v[208:211]
    v_exp_f32 v213, v213
    v_mfma_f32_16x16x32_bf16 v[208:211], a[216:219], v[104:107], v[208:211]
    v_exp_f32 v214, v214
    v_mfma_f32_16x16x32_bf16 v[208:211], a[220:223], v[108:111], v[208:211]
    v_exp_f32 v215, v215
    v_mfma_f32_16x16x32_bf16 a[80:83], a[168:171], v[128:131], a[80:83]
    ds_read_b64_tr_b16 a[180:181], v26 offset:40960
    v_cvt_pk_bf16_f32 v172, v212, v213
    v_mfma_f32_16x16x32_bf16 a[80:83], a[172:175], v[132:135], a[80:83]
    ds_read_b64_tr_b16 a[182:183], v26 offset:45056
    v_mfma_f32_16x16x32_bf16 a[84:87], a[168:171], v[136:139], a[84:87]
    ds_read_b128 a[236:239], v11 offset:61440
    v_cvt_pk_bf16_f32 v173, v214, v215
    v_mfma_f32_16x16x32_bf16 a[84:87], a[172:175], v[140:143], a[84:87]
    s_waitcnt vmcnt(13)
    s_barrier
    v_mfma_f32_16x16x32_bf16 v[212:215], a[208:211], v[112:115], v[204:207]
    v_exp_f32 v208, v208
    v_mfma_f32_16x16x32_bf16 v[212:215], a[212:215], v[116:119], v[212:215]
    s_add_u32 s49, s45, 73856
    v_exp_f32 v209, v209
    v_mfma_f32_16x16x32_bf16 v[212:215], a[216:219], v[120:123], v[212:215]
    s_add_u32 m0, s42, 16384
    v_exp_f32 v210, v210
    v_mfma_f32_16x16x32_bf16 v[212:215], a[220:223], v[124:127], v[212:215]
    v_exp_f32 v211, v211
    v_mfma_f32_16x16x32_bf16 a[88:91], a[168:171], v[144:147], a[88:91]
    ds_read_b64_tr_b16 a[184:185], v27 offset:32768
    v_cvt_pk_bf16_f32 v180, v208, v209
    v_mfma_f32_16x16x32_bf16 a[88:91], a[172:175], v[148:151], a[88:91]
    ds_read_b64_tr_b16 a[186:187], v27 offset:36864
    v_mfma_f32_16x16x32_bf16 a[92:95], a[168:171], v[152:155], a[92:95]
    v_cvt_pk_bf16_f32 v181, v210, v211
    v_mfma_f32_16x16x32_bf16 a[92:95], a[172:175], v[156:159], a[92:95]
    s_waitcnt lgkmcnt(3)
    buffer_load_dwordx4 v46, s[20:23], s49 offen lds
    v_mfma_f32_16x16x32_bf16 v[208:211], a[224:227], v[64:67], v[192:195]
    v_exp_f32 v212, v212
    v_mfma_f32_16x16x32_bf16 v[208:211], a[228:231], v[68:71], v[208:211]
    v_exp_f32 v213, v213
    v_mfma_f32_16x16x32_bf16 v[208:211], a[232:235], v[72:75], v[208:211]
    s_waitcnt lgkmcnt(2)
    v_exp_f32 v214, v214
    v_mfma_f32_16x16x32_bf16 v[208:211], a[236:239], v[76:79], v[208:211]
    v_exp_f32 v215, v215
    v_mfma_f32_16x16x32_bf16 a[96:99], a[176:179], v[128:131], a[96:99]
    ds_read_b64_tr_b16 a[188:189], v27 offset:40960
    v_cvt_pk_bf16_f32 v188, v212, v213
    v_mfma_f32_16x16x32_bf16 a[96:99], a[180:183], v[132:135], a[96:99]
    ds_read_b64_tr_b16 a[190:191], v27 offset:45056
    v_mfma_f32_16x16x32_bf16 a[100:103], a[176:179], v[136:139], a[100:103]
    v_cvt_pk_bf16_f32 v189, v214, v215
    v_mfma_f32_16x16x32_bf16 a[100:103], a[180:183], v[140:143], a[100:103]
    v_mfma_f32_16x16x32_bf16 v[212:215], a[224:227], v[80:83], v[196:199]
    v_exp_f32 v208, v208
    v_mfma_f32_16x16x32_bf16 v[212:215], a[228:231], v[84:87], v[212:215]
    v_exp_f32 v209, v209
    v_mfma_f32_16x16x32_bf16 v[212:215], a[232:235], v[88:91], v[212:215]
    v_exp_f32 v210, v210
    v_mfma_f32_16x16x32_bf16 v[212:215], a[236:239], v[92:95], v[212:215]
    v_exp_f32 v211, v211
    v_mfma_f32_16x16x32_bf16 a[104:107], a[176:179], v[144:147], a[104:107]
    ds_read_b64_tr_b16 a[160:161], v20 offset:49152
    v_cvt_pk_bf16_f32 v166, v208, v209
    v_mfma_f32_16x16x32_bf16 a[104:107], a[180:183], v[148:151], a[104:107]
    ds_read_b64_tr_b16 a[162:163], v20 offset:53248
    v_mfma_f32_16x16x32_bf16 a[108:111], a[176:179], v[152:155], a[108:111]
    v_cvt_pk_bf16_f32 v167, v210, v211
    v_mfma_f32_16x16x32_bf16 a[108:111], a[180:183], v[156:159], a[108:111]
    s_waitcnt lgkmcnt(3)
    buffer_load_dwordx4 v47, s[20:23], s49 offen offset:1024 lds
    v_mfma_f32_16x16x32_bf16 v[208:211], a[224:227], v[96:99], v[200:203]
    v_exp_f32 v212, v212
    v_mfma_f32_16x16x32_bf16 v[208:211], a[228:231], v[100:103], v[208:211]
    v_exp_f32 v213, v213
    v_mfma_f32_16x16x32_bf16 v[208:211], a[232:235], v[104:107], v[208:211]
    v_exp_f32 v214, v214
    v_mfma_f32_16x16x32_bf16 v[208:211], a[236:239], v[108:111], v[208:211]
    s_add_u32 s57, s58, 1179648
    v_exp_f32 v215, v215
    v_mfma_f32_16x16x32_bf16 a[112:115], a[184:187], v[128:131], a[112:115]
    s_waitcnt lgkmcnt(2)
    ds_read_b64_tr_b16 a[164:165], v20 offset:57344
    v_cvt_pk_bf16_f32 v174, v212, v213
    v_mfma_f32_16x16x32_bf16 a[112:115], a[188:191], v[132:135], a[112:115]
    ds_read_b64_tr_b16 a[166:167], v20 offset:61440
    v_mfma_f32_16x16x32_bf16 a[116:119], a[184:187], v[136:139], a[116:119]
    v_cvt_pk_bf16_f32 v175, v214, v215
    v_mfma_f32_16x16x32_bf16 a[116:119], a[188:191], v[140:143], a[116:119]
    buffer_load_dwordx4 a[252:255], v254, s[32:35], s57 offen
    v_mfma_f32_16x16x32_bf16 v[212:215], a[224:227], v[112:115], v[204:207]
    v_exp_f32 v208, v208
    v_mfma_f32_16x16x32_bf16 v[212:215], a[228:231], v[116:119], v[212:215]
    v_exp_f32 v209, v209
    v_mfma_f32_16x16x32_bf16 v[212:215], a[232:235], v[120:123], v[212:215]
    v_exp_f32 v210, v210
    v_mfma_f32_16x16x32_bf16 v[212:215], a[236:239], v[124:127], v[212:215]
    v_exp_f32 v211, v211
    v_mfma_f32_16x16x32_bf16 a[120:123], a[184:187], v[144:147], a[120:123]
    ds_read_b64_tr_b16 a[168:169], v21 offset:49152
    v_cvt_pk_bf16_f32 v182, v208, v209
    v_mfma_f32_16x16x32_bf16 a[120:123], a[188:191], v[148:151], a[120:123]
    ds_read_b64_tr_b16 a[170:171], v21 offset:53248
    v_mfma_f32_16x16x32_bf16 a[124:127], a[184:187], v[152:155], a[124:127]
    v_cvt_pk_bf16_f32 v183, v210, v211
    v_mfma_f32_16x16x32_bf16 a[124:127], a[188:191], v[156:159], a[124:127]
    s_waitcnt lgkmcnt(3)
    buffer_load_dwordx4 v48, s[20:23], s49 offen offset:2048 lds
    v_exp_f32 v212, v212
    v_exp_f32 v213, v213
    v_exp_f32 v214, v214
    v_exp_f32 v215, v215
    v_mfma_f32_16x16x32_bf16 a[0:3], a[160:163], v[160:163], a[0:3]
    s_waitcnt lgkmcnt(2)
    ds_read_b64_tr_b16 a[172:173], v21 offset:57344
    v_cvt_pk_bf16_f32 v190, v212, v213
    v_mfma_f32_16x16x32_bf16 a[0:3], a[164:167], v[164:167], a[0:3]
    ds_read_b64_tr_b16 a[174:175], v21 offset:61440
    v_mfma_f32_16x16x32_bf16 a[4:7], a[160:163], v[168:171], a[4:7]
    v_cvt_pk_bf16_f32 v191, v214, v215
    v_mfma_f32_16x16x32_bf16 a[4:7], a[164:167], v[172:175], a[4:7]
    v_mfma_f32_16x16x32_bf16 a[8:11], a[160:163], v[176:179], a[8:11]
    ds_read_b64_tr_b16 a[176:177], v22 offset:49152
    v_mfma_f32_16x16x32_bf16 a[8:11], a[164:167], v[180:183], a[8:11]
    ds_read_b64_tr_b16 a[178:179], v22 offset:53248
    v_mfma_f32_16x16x32_bf16 a[12:15], a[160:163], v[184:187], a[12:15]
    v_mfma_f32_16x16x32_bf16 a[12:15], a[164:167], v[188:191], a[12:15]
    buffer_load_dwordx4 v49, s[20:23], s49 offen offset:3072 lds
    v_smfmac_f32_16x16x64_bf16 a[192:195], v[52:55], v[160:167], v50
    s_waitcnt lgkmcnt(4)
    v_mfma_f32_16x16x32_bf16 a[16:19], a[168:171], v[160:163], a[16:19]
    s_waitcnt lgkmcnt(2)
    ds_read_b64_tr_b16 a[180:181], v22 offset:57344
    v_mfma_f32_16x16x32_bf16 a[16:19], a[172:175], v[164:167], a[16:19]
    ds_read_b64_tr_b16 a[182:183], v22 offset:61440
    v_mfma_f32_16x16x32_bf16 a[20:23], a[168:171], v[168:171], a[20:23]
    v_mfma_f32_16x16x32_bf16 a[20:23], a[172:175], v[172:175], a[20:23]
    v_smfmac_f32_16x16x64_bf16 a[196:199], v[52:55], v[168:175], v50
    s_add_u32 s49, s45, 256
    s_add_u32 m0, s42, 32768
    v_mfma_f32_16x16x32_bf16 a[24:27], a[168:171], v[176:179], a[24:27]
    ds_read_b64_tr_b16 a[184:185], v23 offset:49152
    v_mfma_f32_16x16x32_bf16 a[24:27], a[172:175], v[180:183], a[24:27]
    ds_read_b64_tr_b16 a[186:187], v23 offset:53248
    v_mfma_f32_16x16x32_bf16 a[28:31], a[168:171], v[184:187], a[28:31]
    v_mfma_f32_16x16x32_bf16 a[28:31], a[172:175], v[188:191], a[28:31]
    buffer_load_dwordx4 v46, s[20:23], s49 offen lds
    v_smfmac_f32_16x16x64_bf16 a[200:203], v[52:55], v[176:183], v50
    s_waitcnt lgkmcnt(4)
    v_mfma_f32_16x16x32_bf16 a[32:35], a[176:179], v[160:163], a[32:35]
    s_waitcnt lgkmcnt(2)
    ds_read_b64_tr_b16 a[188:189], v23 offset:57344
    v_mfma_f32_16x16x32_bf16 a[32:35], a[180:183], v[164:167], a[32:35]
    ds_read_b64_tr_b16 a[190:191], v23 offset:61440
    v_mfma_f32_16x16x32_bf16 a[36:39], a[176:179], v[168:171], a[36:39]
    v_mfma_f32_16x16x32_bf16 a[36:39], a[180:183], v[172:175], a[36:39]
    v_smfmac_f32_16x16x64_bf16 a[204:207], v[52:55], v[184:191], v50
    v_mfma_f32_16x16x32_bf16 a[40:43], a[176:179], v[176:179], a[40:43]
    ds_read_b64_tr_b16 a[160:161], v24 offset:49152
    v_mfma_f32_16x16x32_bf16 a[40:43], a[180:183], v[180:183], a[40:43]
    ds_read_b64_tr_b16 a[162:163], v24 offset:53248
    v_mfma_f32_16x16x32_bf16 a[44:47], a[176:179], v[184:187], a[44:47]
    v_mfma_f32_16x16x32_bf16 a[44:47], a[180:183], v[188:191], a[44:47]
    s_waitcnt lgkmcnt(4)
    buffer_load_dwordx4 v47, s[20:23], s49 offen offset:1024 lds
    v_mfma_f32_16x16x32_bf16 a[48:51], a[184:187], v[160:163], a[48:51]
    s_waitcnt lgkmcnt(2)
    ds_read_b64_tr_b16 a[164:165], v24 offset:57344
    v_accvgpr_read_b32 v216, a192
    v_mfma_f32_16x16x32_bf16 a[48:51], a[188:191], v[164:167], a[48:51]
Ltour7:
    s_cbranch_execz Ltour11
    ds_read_b64_tr_b16 a[166:167], v24 offset:61440
    v_accvgpr_read_b32 v217, a193
    v_mfma_f32_16x16x32_bf16 a[52:55], a[184:187], v[168:171], a[52:55]
    v_accvgpr_read_b32 v218, a196
    v_accvgpr_read_b32 v219, a197
    v_mfma_f32_16x16x32_bf16 a[52:55], a[188:191], v[172:175], a[52:55]
    v_accvgpr_read_b32 v220, a200
    v_accvgpr_read_b32 v221, a201
    v_mfma_f32_16x16x32_bf16 a[56:59], a[184:187], v[176:179], a[56:59]
    ds_read_b64_tr_b16 a[168:169], v25 offset:49152
    v_accvgpr_read_b32 v222, a204
    v_mfma_f32_16x16x32_bf16 a[56:59], a[188:191], v[180:183], a[56:59]
    ds_read_b64_tr_b16 a[170:171], v25 offset:53248
    v_accvgpr_read_b32 v223, a205
    v_mfma_f32_16x16x32_bf16 a[60:63], a[184:187], v[184:187], a[60:63]
    v_add_f32 v58, v216, v217
    v_add_f32 v59, v218, v219
    v_mfma_f32_16x16x32_bf16 a[60:63], a[188:191], v[188:191], a[60:63]
    s_waitcnt lgkmcnt(4)
    buffer_load_dwordx4 v48, s[20:23], s49 offen offset:2048 lds
    v_add_f32 v60, v220, v221
    v_add_f32 v61, v222, v223
    v_mfma_f32_16x16x32_bf16 a[64:67], a[160:163], v[160:163], a[64:67]
    s_waitcnt lgkmcnt(2)
    ds_read_b64_tr_b16 a[172:173], v25 offset:57344
    v_add_f32 v216, v58, v59
    v_mfma_f32_16x16x32_bf16 a[64:67], a[164:167], v[164:167], a[64:67]
    ds_read_b64_tr_b16 a[174:175], v25 offset:61440
    v_add_f32 v217, v60, v61
    v_mfma_f32_16x16x32_bf16 a[68:71], a[160:163], v[168:171], a[68:71]
    v_add_f32 v216, v216, v217
    v_cmp_ngt_f32 vcc, 1669332992, v216
    v_mfma_f32_16x16x32_bf16 a[68:71], a[164:167], v[172:175], a[68:71]
    v_rcp_f32 v58, v58
    v_rcp_f32 v59, v59
    v_mfma_f32_16x16x32_bf16 a[72:75], a[160:163], v[176:179], a[72:75]
    ds_read_b64_tr_b16 a[176:177], v26 offset:49152
    v_rcp_f32 v60, v60
    v_mfma_f32_16x16x32_bf16 a[72:75], a[164:167], v[180:183], a[72:75]
    ds_read_b64_tr_b16 a[178:179], v26 offset:53248
    v_rcp_f32 v61, v61
    v_mfma_f32_16x16x32_bf16 a[76:79], a[160:163], v[184:187], a[76:79]
    v_mov_b32 v228, 81920
    s_or_b32 s36, vcc_lo, vcc_hi
    v_mfma_f32_16x16x32_bf16 a[76:79], a[164:167], v[188:191], a[76:79]
    s_waitcnt lgkmcnt(4)
    buffer_load_dwordx4 v49, s[20:23], s49 offen offset:3072 lds
    v_mov_b32 v218, s36
    s_lshl_b32 s37, s3, 2
    v_mfma_f32_16x16x32_bf16 a[80:83], a[168:171], v[160:163], a[80:83]
    s_waitcnt lgkmcnt(2)
    ds_read_b64_tr_b16 a[180:181], v26 offset:57344
    v_add_u32 v219, s37, v228
    ds_write_b32 v219, v218
    v_mfma_f32_16x16x32_bf16 a[80:83], a[172:175], v[164:167], a[80:83]
    ds_read_b64_tr_b16 a[182:183], v26 offset:61440
    v_mfma_f32_16x16x32_bf16 a[84:87], a[168:171], v[168:171], a[84:87]
    v_mfma_f32_16x16x32_bf16 a[84:87], a[172:175], v[172:175], a[84:87]
    s_waitcnt lgkmcnt(1)
    s_waitcnt vmcnt(15)
    s_barrier
    v_mfma_f32_16x16x32_bf16 a[88:91], a[168:171], v[176:179], a[88:91]
    ds_read_b64_tr_b16 a[184:185], v27 offset:49152
    v_mfma_f32_16x16x32_bf16 a[88:91], a[172:175], v[180:183], a[88:91]
    ds_read_b64_tr_b16 a[186:187], v27 offset:53248
    v_mfma_f32_16x16x32_bf16 a[92:95], a[168:171], v[184:187], a[92:95]
    ds_read_b128 v[224:227], v228
    v_mfma_f32_16x16x32_bf16 a[92:95], a[172:175], v[188:191], a[92:95]
    s_add_u32 s49, s45, 73984
    v_mfma_f32_16x16x32_bf16 a[96:99], a[176:179], v[160:163], a[96:99]
    s_waitcnt lgkmcnt(3)
    s_add_u32 m0, s42, 49152
    ds_read_b64_tr_b16 a[188:189], v27 offset:57344
    v_mfma_f32_16x16x32_bf16 a[96:99], a[180:183], v[164:167], a[96:99]
    buffer_load_dwordx4 v46, s[20:23], s49 offen lds
    v_mfma_f32_16x16x32_bf16 a[100:103], a[176:179], v[168:171], a[100:103]
    ds_read_b64_tr_b16 a[190:191], v27 offset:61440
    v_mfma_f32_16x16x32_bf16 a[100:103], a[180:183], v[172:175], a[100:103]
    buffer_load_dwordx4 v47, s[20:23], s49 offen offset:1024 lds
    v_mfma_f32_16x16x32_bf16 a[104:107], a[176:179], v[176:179], a[104:107]
    v_mfma_f32_16x16x32_bf16 a[104:107], a[180:183], v[180:183], a[104:107]
    buffer_load_dwordx4 v48, s[20:23], s49 offen offset:2048 lds
    v_mfma_f32_16x16x32_bf16 a[108:111], a[176:179], v[184:187], a[108:111]
    v_mfma_f32_16x16x32_bf16 a[108:111], a[180:183], v[188:191], a[108:111]
    s_waitcnt lgkmcnt(3)
    buffer_load_dwordx4 v49, s[20:23], s49 offen offset:3072 lds
    s_add_u32 s49, s45, 384
    v_mfma_f32_16x16x32_bf16 a[112:115], a[184:187], v[160:163], a[112:115]
    s_waitcnt lgkmcnt(0)
    s_add_u32 m0, s42, 65536
    v_mfma_f32_16x16x32_bf16 a[112:115], a[188:191], v[164:167], a[112:115]
    buffer_load_dwordx4 v46, s[20:23], s49 offen lds
    v_mfma_f32_16x16x32_bf16 a[116:119], a[184:187], v[168:171], a[116:119]
    v_mfma_f32_16x16x32_bf16 a[116:119], a[188:191], v[172:175], a[116:119]
    buffer_load_dwordx4 v47, s[20:23], s49 offen offset:1024 lds
    v_mfma_f32_16x16x32_bf16 a[120:123], a[184:187], v[176:179], a[120:123]
    v_mfma_f32_16x16x32_bf16 a[120:123], a[188:191], v[180:183], a[120:123]
    buffer_load_dwordx4 v48, s[20:23], s49 offen offset:2048 lds
    v_mfma_f32_16x16x32_bf16 a[124:127], a[184:187], v[184:187], a[124:127]
    v_mfma_f32_16x16x32_bf16 a[124:127], a[188:191], v[188:191], a[124:127]
    buffer_load_dwordx4 v49, s[20:23], s49 offen offset:3072 lds
    v_or3_b32 v224, v224, v225, v226
    v_or_b32 v224, v224, v227
    s_nop 0
    v_readfirstlane_b32 s36, v224
    v_readfirstlane_b32 s37, v63
    ds_read_b64_tr_b16 a[208:209], v28 offset:0
    ds_read_b64_tr_b16 a[210:211], v28 offset:4096
    ds_read_b64_tr_b16 a[212:213], v28 offset:8192
    ds_read_b64_tr_b16 a[214:215], v28 offset:12288
    ds_read_b64_tr_b16 a[216:217], v28 offset:16384
    ds_read_b64_tr_b16 a[218:219], v28 offset:20480
    ds_read_b64_tr_b16 a[220:221], v28 offset:24576
    ds_read_b64_tr_b16 a[222:223], v28 offset:28672
    ds_read_b64_tr_b16 a[224:225], v32 offset:0
    ds_read_b64_tr_b16 a[226:227], v32 offset:4096
    ds_read_b64_tr_b16 a[228:229], v32 offset:8192
    ds_read_b64_tr_b16 a[230:231], v32 offset:12288
    ds_read_b64_tr_b16 a[232:233], v32 offset:16384
    ds_read_b64_tr_b16 a[234:235], v32 offset:20480
    ds_read_b64_tr_b16 a[236:237], v32 offset:24576
    ds_read_b64_tr_b16 a[238:239], v32 offset:28672
    s_andn2_b32 s36, s36, s48
    s_cbranch_scc1 Lattn_redo
    s_cmp_lt_u32 s37, 256
    s_cbranch_scc1 Lattn_armwait
Lattn_armed:
    v_accvgpr_read_b32 v216, a0
    v_accvgpr_read_b32 v217, a1
    v_accvgpr_read_b32 v218, a2
    v_accvgpr_read_b32 v219, a3
    v_pk_mul_f32 v[216:217], v[216:217], v[58:59] op_sel:[0,0] op_sel_hi:[1,0]
    v_pk_mul_f32 v[218:219], v[218:219], v[58:59] op_sel:[0,0] op_sel_hi:[1,0]
    v_cvt_pk_bf16_f32 v128, v216, v217
    v_cvt_pk_bf16_f32 v129, v218, v219
    v_accvgpr_read_b32 v220, a4
    v_accvgpr_read_b32 v221, a5
    v_accvgpr_read_b32 v222, a6
    v_accvgpr_read_b32 v223, a7
    v_pk_mul_f32 v[220:221], v[220:221], v[58:59] op_sel:[0,1] op_sel_hi:[1,1]
    v_pk_mul_f32 v[222:223], v[222:223], v[58:59] op_sel:[0,1] op_sel_hi:[1,1]
    v_cvt_pk_bf16_f32 v160, v220, v221
    v_cvt_pk_bf16_f32 v161, v222, v223
    v_accvgpr_read_b32 v224, a8
    v_accvgpr_read_b32 v225, a9
    v_accvgpr_read_b32 v226, a10
    v_accvgpr_read_b32 v227, a11
    v_pk_mul_f32 v[224:225], v[224:225], v[60:61] op_sel:[0,0] op_sel_hi:[1,0]
    v_pk_mul_f32 v[226:227], v[226:227], v[60:61] op_sel:[0,0] op_sel_hi:[1,0]
    v_cvt_pk_bf16_f32 v144, v224, v225
    v_cvt_pk_bf16_f32 v145, v226, v227
    s_add_u32 s57, s58, 1769472
    buffer_load_dwordx4 a[0:3], v254, s[32:35], s57 offen
    v_accvgpr_read_b32 v228, a12
    v_accvgpr_read_b32 v229, a13
    v_accvgpr_read_b32 v230, a14
    v_accvgpr_read_b32 v231, a15
    v_pk_mul_f32 v[228:229], v[228:229], v[60:61] op_sel:[0,1] op_sel_hi:[1,1]
    v_pk_mul_f32 v[230:231], v[230:231], v[60:61] op_sel:[0,1] op_sel_hi:[1,1]
    v_cvt_pk_bf16_f32 v176, v228, v229
    v_cvt_pk_bf16_f32 v177, v230, v231
    v_accvgpr_read_b32 v216, a16
    v_accvgpr_read_b32 v217, a17
    v_accvgpr_read_b32 v218, a18
    v_accvgpr_read_b32 v219, a19
    v_pk_mul_f32 v[216:217], v[216:217], v[58:59] op_sel:[0,0] op_sel_hi:[1,0]
    v_pk_mul_f32 v[218:219], v[218:219], v[58:59] op_sel:[0,0] op_sel_hi:[1,0]
    v_cvt_pk_bf16_f32 v130, v216, v217
    v_cvt_pk_bf16_f32 v131, v218, v219
    s_add_u32 s57, s58, 2359296
    buffer_load_dwordx4 a[4:7], v254, s[32:35], s57 offen
    v_accvgpr_read_b32 v220, a20
    v_accvgpr_read_b32 v221, a21
    v_accvgpr_read_b32 v222, a22
    v_accvgpr_read_b32 v223, a23
    v_pk_mul_f32 v[220:221], v[220:221], v[58:59] op_sel:[0,1] op_sel_hi:[1,1]
    v_pk_mul_f32 v[222:223], v[222:223], v[58:59] op_sel:[0,1] op_sel_hi:[1,1]
    v_cvt_pk_bf16_f32 v162, v220, v221
    v_cvt_pk_bf16_f32 v163, v222, v223
    v_accvgpr_read_b32 v224, a24
    v_accvgpr_read_b32 v225, a25
    v_accvgpr_read_b32 v226, a26
    v_accvgpr_read_b32 v227, a27
    v_pk_mul_f32 v[224:225], v[224:225], v[60:61] op_sel:[0,0] op_sel_hi:[1,0]
    v_pk_mul_f32 v[226:227], v[226:227], v[60:61] op_sel:[0,0] op_sel_hi:[1,0]
    v_cvt_pk_bf16_f32 v146, v224, v225
    v_cvt_pk_bf16_f32 v147, v226, v227
    s_add_u32 s57, s58, 2949120
    buffer_load_dwordx4 a[8:11], v254, s[32:35], s57 offen
    v_accvgpr_read_b32 v228, a28
    v_accvgpr_read_b32 v229, a29
    v_accvgpr_read_b32 v230, a30
    v_accvgpr_read_b32 v231, a31
    v_pk_mul_f32 v[228:229], v[228:229], v[60:61] op_sel:[0,1] op_sel_hi:[1,1]
    v_pk_mul_f32 v[230:231], v[230:231], v[60:61] op_sel:[0,1] op_sel_hi:[1,1]
    v_cvt_pk_bf16_f32 v178, v228, v229
    v_cvt_pk_bf16_f32 v179, v230, v231
    v_accvgpr_read_b32 v216, a32
    v_accvgpr_read_b32 v217, a33
    v_accvgpr_read_b32 v218, a34
    v_accvgpr_read_b32 v219, a35
    v_pk_mul_f32 v[216:217], v[216:217], v[58:59] op_sel:[0,0] op_sel_hi:[1,0]
    v_pk_mul_f32 v[218:219], v[218:219], v[58:59] op_sel:[0,0] op_sel_hi:[1,0]
    v_cvt_pk_bf16_f32 v132, v216, v217
    v_cvt_pk_bf16_f32 v133, v218, v219
    s_add_u32 s57, s58, 3538944
    buffer_load_dwordx4 a[12:15], v254, s[32:35], s57 offen
    v_accvgpr_read_b32 v220, a36
    v_accvgpr_read_b32 v221, a37
    v_accvgpr_read_b32 v222, a38
    v_accvgpr_read_b32 v223, a39
    v_pk_mul_f32 v[220:221], v[220:221], v[58:59] op_sel:[0,1] op_sel_hi:[1,1]
    v_pk_mul_f32 v[222:223], v[222:223], v[58:59] op_sel:[0,1] op_sel_hi:[1,1]
    v_cvt_pk_bf16_f32 v164, v220, v221
    v_cvt_pk_bf16_f32 v165, v222, v223
    v_accvgpr_read_b32 v224, a40
    v_accvgpr_read_b32 v225, a41
    v_accvgpr_read_b32 v226, a42
    v_accvgpr_read_b32 v227, a43
    v_pk_mul_f32 v[224:225], v[224:225], v[60:61] op_sel:[0,0] op_sel_hi:[1,0]
    v_pk_mul_f32 v[226:227], v[226:227], v[60:61] op_sel:[0,0] op_sel_hi:[1,0]
    v_cvt_pk_bf16_f32 v148, v224, v225
    v_cvt_pk_bf16_f32 v149, v226, v227
    s_add_u32 s57, s58, 4128768
    buffer_load_dwordx4 a[16:19], v254, s[32:35], s57 offen
    v_accvgpr_read_b32 v228, a44
    v_accvgpr_read_b32 v229, a45
    v_accvgpr_read_b32 v230, a46
    v_accvgpr_read_b32 v231, a47
    v_pk_mul_f32 v[228:229], v[228:229], v[60:61] op_sel:[0,1] op_sel_hi:[1,1]
    v_pk_mul_f32 v[230:231], v[230:231], v[60:61] op_sel:[0,1] op_sel_hi:[1,1]
    v_cvt_pk_bf16_f32 v180, v228, v229
    v_cvt_pk_bf16_f32 v181, v230, v231
    v_accvgpr_read_b32 v216, a48
    v_accvgpr_read_b32 v217, a49
    v_accvgpr_read_b32 v218, a50
    v_accvgpr_read_b32 v219, a51
    v_pk_mul_f32 v[216:217], v[216:217], v[58:59] op_sel:[0,0] op_sel_hi:[1,0]
    v_pk_mul_f32 v[218:219], v[218:219], v[58:59] op_sel:[0,0] op_sel_hi:[1,0]
    v_cvt_pk_bf16_f32 v134, v216, v217
    v_cvt_pk_bf16_f32 v135, v218, v219
    s_add_u32 s57, s58, 4718592
    buffer_load_dwordx4 a[20:23], v254, s[32:35], s57 offen
    v_accvgpr_read_b32 v220, a52
    v_accvgpr_read_b32 v221, a53
    v_accvgpr_read_b32 v222, a54
    v_accvgpr_read_b32 v223, a55
    v_pk_mul_f32 v[220:221], v[220:221], v[58:59] op_sel:[0,1] op_sel_hi:[1,1]
    v_pk_mul_f32 v[222:223], v[222:223], v[58:59] op_sel:[0,1] op_sel_hi:[1,1]
    v_cvt_pk_bf16_f32 v166, v220, v221
    v_cvt_pk_bf16_f32 v167, v222, v223
    v_accvgpr_read_b32 v224, a56
    v_accvgpr_read_b32 v225, a57
    v_accvgpr_read_b32 v226, a58
    v_accvgpr_read_b32 v227, a59
    v_pk_mul_f32 v[224:225], v[224:225], v[60:61] op_sel:[0,0] op_sel_hi:[1,0]
    v_pk_mul_f32 v[226:227], v[226:227], v[60:61] op_sel:[0,0] op_sel_hi:[1,0]
    v_cvt_pk_bf16_f32 v150, v224, v225
    v_cvt_pk_bf16_f32 v151, v226, v227
    s_add_u32 s57, s59, 0
    buffer_load_dwordx4 a[24:27], v255, s[84:87], s57 offen
    v_accvgpr_read_b32 v228, a60
    v_accvgpr_read_b32 v229, a61
    v_accvgpr_read_b32 v230, a62
    v_accvgpr_read_b32 v231, a63
    v_pk_mul_f32 v[228:229], v[228:229], v[60:61] op_sel:[0,1] op_sel_hi:[1,1]
    v_pk_mul_f32 v[230:231], v[230:231], v[60:61] op_sel:[0,1] op_sel_hi:[1,1]
    v_cvt_pk_bf16_f32 v182, v228, v229
    v_cvt_pk_bf16_f32 v183, v230, v231
    v_accvgpr_read_b32 v216, a64
    v_accvgpr_read_b32 v217, a65
    v_accvgpr_read_b32 v218, a66
    v_accvgpr_read_b32 v219, a67
    v_pk_mul_f32 v[216:217], v[216:217], v[58:59] op_sel:[0,0] op_sel_hi:[1,0]
    v_pk_mul_f32 v[218:219], v[218:219], v[58:59] op_sel:[0,0] op_sel_hi:[1,0]
    v_cvt_pk_bf16_f32 v136, v216, v217
    v_cvt_pk_bf16_f32 v137, v218, v219
    v_accvgpr_read_b32 v220, a68
    v_accvgpr_read_b32 v221, a69
    v_accvgpr_read_b32 v222, a70
    v_accvgpr_read_b32 v223, a71
    v_pk_mul_f32 v[220:221], v[220:221], v[58:59] op_sel:[0,1] op_sel_hi:[1,1]
    v_pk_mul_f32 v[222:223], v[222:223], v[58:59] op_sel:[0,1] op_sel_hi:[1,1]
    v_cvt_pk_bf16_f32 v168, v220, v221
    v_cvt_pk_bf16_f32 v169, v222, v223
    s_add_u32 s57, s59, 4096
    buffer_load_dwordx4 a[28:31], v255, s[84:87], s57 offen
    v_accvgpr_read_b32 v224, a72
    v_accvgpr_read_b32 v225, a73
    v_accvgpr_read_b32 v226, a74
    v_accvgpr_read_b32 v227, a75
    v_pk_mul_f32 v[224:225], v[224:225], v[60:61] op_sel:[0,0] op_sel_hi:[1,0]
    v_pk_mul_f32 v[226:227], v[226:227], v[60:61] op_sel:[0,0] op_sel_hi:[1,0]
    v_cvt_pk_bf16_f32 v152, v224, v225
    v_cvt_pk_bf16_f32 v153, v226, v227
    v_accvgpr_read_b32 v228, a76
    v_accvgpr_read_b32 v229, a77
    v_accvgpr_read_b32 v230, a78
    v_accvgpr_read_b32 v231, a79
    v_pk_mul_f32 v[228:229], v[228:229], v[60:61] op_sel:[0,1] op_sel_hi:[1,1]
    v_pk_mul_f32 v[230:231], v[230:231], v[60:61] op_sel:[0,1] op_sel_hi:[1,1]
    v_cvt_pk_bf16_f32 v184, v228, v229
    v_cvt_pk_bf16_f32 v185, v230, v231
    s_add_u32 s57, s59, 8192
    buffer_load_dwordx4 a[32:35], v255, s[84:87], s57 offen
    v_accvgpr_read_b32 v216, a80
    v_accvgpr_read_b32 v217, a81
    v_accvgpr_read_b32 v218, a82
    v_accvgpr_read_b32 v219, a83
    v_pk_mul_f32 v[216:217], v[216:217], v[58:59] op_sel:[0,0] op_sel_hi:[1,0]
    v_pk_mul_f32 v[218:219], v[218:219], v[58:59] op_sel:[0,0] op_sel_hi:[1,0]
    v_cvt_pk_bf16_f32 v138, v216, v217
    v_cvt_pk_bf16_f32 v139, v218, v219
    v_accvgpr_read_b32 v220, a84
    v_accvgpr_read_b32 v221, a85
    v_accvgpr_read_b32 v222, a86
    v_accvgpr_read_b32 v223, a87
    v_pk_mul_f32 v[220:221], v[220:221], v[58:59] op_sel:[0,1] op_sel_hi:[1,1]
    v_pk_mul_f32 v[222:223], v[222:223], v[58:59] op_sel:[0,1] op_sel_hi:[1,1]
    v_cvt_pk_bf16_f32 v170, v220, v221
    v_cvt_pk_bf16_f32 v171, v222, v223
    s_add_u32 s57, s59, 12288
    buffer_load_dwordx4 a[36:39], v255, s[84:87], s57 offen
    v_accvgpr_read_b32 v224, a88
    v_accvgpr_read_b32 v225, a89
    v_accvgpr_read_b32 v226, a90
    v_accvgpr_read_b32 v227, a91
    v_pk_mul_f32 v[224:225], v[224:225], v[60:61] op_sel:[0,0] op_sel_hi:[1,0]
    v_pk_mul_f32 v[226:227], v[226:227], v[60:61] op_sel:[0,0] op_sel_hi:[1,0]
    v_cvt_pk_bf16_f32 v154, v224, v225
    v_cvt_pk_bf16_f32 v155, v226, v227
    v_accvgpr_read_b32 v228, a92
    v_accvgpr_read_b32 v229, a93
    v_accvgpr_read_b32 v230, a94
    v_accvgpr_read_b32 v231, a95
    v_pk_mul_f32 v[228:229], v[228:229], v[60:61] op_sel:[0,1] op_sel_hi:[1,1]
    v_pk_mul_f32 v[230:231], v[230:231], v[60:61] op_sel:[0,1] op_sel_hi:[1,1]
    v_cvt_pk_bf16_f32 v186, v228, v229
    v_cvt_pk_bf16_f32 v187, v230, v231
    s_add_u32 s57, s59, 16384
    buffer_load_dwordx4 a[40:43], v255, s[84:87], s57 offen
    v_accvgpr_read_b32 v216, a96
    v_accvgpr_read_b32 v217, a97
    v_accvgpr_read_b32 v218, a98
    v_accvgpr_read_b32 v219, a99
    v_pk_mul_f32 v[216:217], v[216:217], v[58:59] op_sel:[0,0] op_sel_hi:[1,0]
    v_pk_mul_f32 v[218:219], v[218:219], v[58:59] op_sel:[0,0] op_sel_hi:[1,0]
    v_cvt_pk_bf16_f32 v140, v216, v217
    v_cvt_pk_bf16_f32 v141, v218, v219
    v_accvgpr_read_b32 v220, a100
    v_accvgpr_read_b32 v221, a101
    v_accvgpr_read_b32 v222, a102
    v_accvgpr_read_b32 v223, a103
    v_pk_mul_f32 v[220:221], v[220:221], v[58:59] op_sel:[0,1] op_sel_hi:[1,1]
    v_pk_mul_f32 v[222:223], v[222:223], v[58:59] op_sel:[0,1] op_sel_hi:[1,1]
    v_cvt_pk_bf16_f32 v172, v220, v221
    v_cvt_pk_bf16_f32 v173, v222, v223
    s_add_u32 s57, s59, 20480
    buffer_load_dwordx4 a[44:47], v255, s[84:87], s57 offen
    v_accvgpr_read_b32 v224, a104
    v_accvgpr_read_b32 v225, a105
    v_accvgpr_read_b32 v226, a106
    v_accvgpr_read_b32 v227, a107
    v_pk_mul_f32 v[224:225], v[224:225], v[60:61] op_sel:[0,0] op_sel_hi:[1,0]
    v_pk_mul_f32 v[226:227], v[226:227], v[60:61] op_sel:[0,0] op_sel_hi:[1,0]
    v_cvt_pk_bf16_f32 v156, v224, v225
    v_cvt_pk_bf16_f32 v157, v226, v227
    v_accvgpr_read_b32 v228, a108
    v_accvgpr_read_b32 v229, a109
    v_accvgpr_read_b32 v230, a110
    v_accvgpr_read_b32 v231, a111
    v_pk_mul_f32 v[228:229], v[228:229], v[60:61] op_sel:[0,1] op_sel_hi:[1,1]
    v_pk_mul_f32 v[230:231], v[230:231], v[60:61] op_sel:[0,1] op_sel_hi:[1,1]
    v_cvt_pk_bf16_f32 v188, v228, v229
    v_cvt_pk_bf16_f32 v189, v230, v231
    s_add_u32 s57, s59, 24576
    buffer_load_dwordx4 a[48:51], v255, s[84:87], s57 offen
    v_accvgpr_read_b32 v216, a112
    v_accvgpr_read_b32 v217, a113
    v_accvgpr_read_b32 v218, a114
    v_accvgpr_read_b32 v219, a115
    v_pk_mul_f32 v[216:217], v[216:217], v[58:59] op_sel:[0,0] op_sel_hi:[1,0]
    v_pk_mul_f32 v[218:219], v[218:219], v[58:59] op_sel:[0,0] op_sel_hi:[1,0]
    v_cvt_pk_bf16_f32 v142, v216, v217
    v_cvt_pk_bf16_f32 v143, v218, v219
    v_accvgpr_read_b32 v220, a116
    v_accvgpr_read_b32 v221, a117
    v_accvgpr_read_b32 v222, a118
    v_accvgpr_read_b32 v223, a119
    v_pk_mul_f32 v[220:221], v[220:221], v[58:59] op_sel:[0,1] op_sel_hi:[1,1]
    v_pk_mul_f32 v[222:223], v[222:223], v[58:59] op_sel:[0,1] op_sel_hi:[1,1]
    v_cvt_pk_bf16_f32 v174, v220, v221
    v_cvt_pk_bf16_f32 v175, v222, v223
    s_add_u32 s57, s59, 28672
    buffer_load_dwordx4 a[52:55], v255, s[84:87], s57 offen
    v_accvgpr_read_b32 v224, a120
    v_accvgpr_read_b32 v225, a121
    v_accvgpr_read_b32 v226, a122
    v_accvgpr_read_b32 v227, a123
    v_pk_mul_f32 v[224:225], v[224:225], v[60:61] op_sel:[0,0] op_sel_hi:[1,0]
    v_pk_mul_f32 v[226:227], v[226:227], v[60:61] op_sel:[0,0] op_sel_hi:[1,0]
    v_cvt_pk_bf16_f32 v158, v224, v225
    v_cvt_pk_bf16_f32 v159, v226, v227
    v_accvgpr_read_b32 v228, a124
    v_accvgpr_read_b32 v229, a125
    v_accvgpr_read_b32 v230, a126
    v_accvgpr_read_b32 v231, a127
    v_pk_mul_f32 v[228:229], v[228:229], v[60:61] op_sel:[0,1] op_sel_hi:[1,1]
    v_pk_mul_f32 v[230:231], v[230:231], v[60:61] op_sel:[0,1] op_sel_hi:[1,1]
    v_cvt_pk_bf16_f32 v190, v228, v229
    v_cvt_pk_bf16_f32 v191, v230, v231
    s_add_u32 s57, s59, 32768
    buffer_load_dwordx4 a[56:59], v255, s[84:87], s57 offen
    s_waitcnt lgkmcnt(14)
    v_mfma_f32_16x16x32_bf16 v[192:195], a[208:211], v[128:131], 0
    s_waitcnt lgkmcnt(12)
    ds_read_b64_tr_b16 a[160:161], v29 offset:0
    v_mfma_f32_16x16x32_bf16 v[192:195], a[212:215], v[132:135], v[192:195]
    s_waitcnt lgkmcnt(11)
    ds_read_b64_tr_b16 a[162:163], v29 offset:4096
    v_mfma_f32_16x16x32_bf16 v[192:195], a[216:219], v[136:139], v[192:195]
    s_waitcnt lgkmcnt(10)
    s_load_dwordx2 s[12:13], s[0:1], 0
    ds_read_b64_tr_b16 a[164:165], v29 offset:8192
    v_mfma_f32_16x16x32_bf16 v[192:195], a[220:223], v[140:143], v[192:195]
    s_waitcnt lgkmcnt(9)
    s_load_dwordx2 s[16:17], s[0:1], 96
    ds_read_b64_tr_b16 a[166:167], v29 offset:12288
    v_mfma_f32_16x16x32_bf16 v[192:195], a[224:227], v[144:147], v[192:195]
    s_waitcnt lgkmcnt(8)
    s_load_dwordx2 s[52:53], s[0:1], 48
    ds_read_b64_tr_b16 a[168:169], v29 offset:16384
    v_mfma_f32_16x16x32_bf16 v[192:195], a[228:231], v[148:151], v[192:195]
    s_waitcnt lgkmcnt(7)
    ds_read_b64_tr_b16 a[170:171], v29 offset:20480
    v_mfma_f32_16x16x32_bf16 v[192:195], a[232:235], v[152:155], v[192:195]
    s_waitcnt lgkmcnt(6)
    ds_read_b64_tr_b16 a[172:173], v29 offset:24576
    v_mfma_f32_16x16x32_bf16 v[192:195], a[236:239], v[156:159], v[192:195]
    ds_read_b64_tr_b16 a[174:175], v29 offset:28672
    v_mfma_f32_16x16x32_bf16 v[196:199], a[208:211], v[160:163], 0
    ds_read_b64_tr_b16 a[176:177], v33 offset:0
    v_mfma_f32_16x16x32_bf16 v[196:199], a[212:215], v[164:167], v[196:199]
    ds_read_b64_tr_b16 a[178:179], v33 offset:4096
    v_mfma_f32_16x16x32_bf16 v[196:199], a[216:219], v[168:171], v[196:199]
    ds_read_b64_tr_b16 a[180:181], v33 offset:8192
    v_mfma_f32_16x16x32_bf16 v[196:199], a[220:223], v[172:175], v[196:199]
    ds_read_b64_tr_b16 a[182:183], v33 offset:12288
    v_mfma_f32_16x16x32_bf16 v[196:199], a[224:227], v[176:179], v[196:199]
    ds_read_b64_tr_b16 a[184:185], v33 offset:16384
    v_cvt_pk_bf16_f32 v224, v192, v193
    v_mfma_f32_16x16x32_bf16 v[196:199], a[228:231], v[180:183], v[196:199]
    ds_read_b64_tr_b16 a[186:187], v33 offset:20480
    v_cvt_pk_bf16_f32 v225, v194, v195
    v_mfma_f32_16x16x32_bf16 v[196:199], a[232:235], v[184:187], v[196:199]
    ds_read_b64_tr_b16 a[188:189], v33 offset:24576
    v_mfma_f32_16x16x32_bf16 v[196:199], a[236:239], v[188:191], v[196:199]
    s_waitcnt lgkmcnt(13)
    ds_read_b64_tr_b16 a[190:191], v33 offset:28672
    v_mfma_f32_16x16x32_bf16 v[200:203], a[160:163], v[128:131], 0
    s_waitcnt lgkmcnt(12)
    ds_read_b64_tr_b16 a[208:209], v30 offset:0
    v_mfma_f32_16x16x32_bf16 v[200:203], a[164:167], v[132:135], v[200:203]
    s_waitcnt lgkmcnt(11)
    ds_read_b64_tr_b16 a[210:211], v30 offset:4096
    v_mfma_f32_16x16x32_bf16 v[200:203], a[168:171], v[136:139], v[200:203]
    s_waitcnt lgkmcnt(10)
    ds_read_b64_tr_b16 a[212:213], v30 offset:8192
    v_mfma_f32_16x16x32_bf16 v[200:203], a[172:175], v[140:143], v[200:203]
    s_waitcnt lgkmcnt(9)
    ds_read_b64_tr_b16 a[214:215], v30 offset:12288
    v_mfma_f32_16x16x32_bf16 v[200:203], a[176:179], v[144:147], v[200:203]
    s_waitcnt lgkmcnt(8)
    ds_read_b64_tr_b16 a[216:217], v30 offset:16384
    v_cvt_pk_bf16_f32 v228, v196, v197
    v_mfma_f32_16x16x32_bf16 v[200:203], a[180:183], v[148:151], v[200:203]
    s_waitcnt lgkmcnt(7)
    ds_read_b64_tr_b16 a[218:219], v30 offset:20480
    v_cvt_pk_bf16_f32 v229, v198, v199
    v_mfma_f32_16x16x32_bf16 v[200:203], a[184:187], v[152:155], v[200:203]
    s_waitcnt lgkmcnt(6)
    ds_read_b64_tr_b16 a[220:221], v30 offset:24576
    v_mfma_f32_16x16x32_bf16 v[200:203], a[188:191], v[156:159], v[200:203]
    ds_read_b64_tr_b16 a[222:223], v30 offset:28672
    v_mfma_f32_16x16x32_bf16 v[204:207], a[160:163], v[160:163], 0
    ds_read_b64_tr_b16 a[224:225], v34 offset:0
    v_mfma_f32_16x16x32_bf16 v[204:207], a[164:167], v[164:167], v[204:207]
    ds_read_b64_tr_b16 a[226:227], v34 offset:4096
    v_mfma_f32_16x16x32_bf16 v[204:207], a[168:171], v[168:171], v[204:207]
    ds_read_b64_tr_b16 a[228:229], v34 offset:8192
    v_mfma_f32_16x16x32_bf16 v[204:207], a[172:175], v[172:175], v[204:207]
    ds_read_b64_tr_b16 a[230:231], v34 offset:12288
    v_mfma_f32_16x16x32_bf16 v[204:207], a[176:179], v[176:179], v[204:207]
    ds_read_b64_tr_b16 a[232:233], v34 offset:16384
    v_cvt_pk_bf16_f32 v226, v200, v201
    v_mfma_f32_16x16x32_bf16 v[204:207], a[180:183], v[180:183], v[204:207]
    s_add_u32 s38, s47, 0
    ds_read_b64_tr_b16 a[234:235], v34 offset:20480
    v_cvt_pk_bf16_f32 v227, v202, v203
    v_mfma_f32_16x16x32_bf16 v[204:207], a[184:187], v[184:187], v[204:207]
    buffer_store_dwordx4 v[224:227], v56, s[28:31], s38 offen sc1
    v_mfma_f32_16x16x32_bf16 v[204:207], a[188:191], v[188:191], v[204:207]
    s_waitcnt lgkmcnt(12)
    ds_read_b64_tr_b16 a[236:237], v34 offset:24576
    ds_read_b64_tr_b16 a[238:239], v34 offset:28672
    v_mfma_f32_16x16x32_bf16 v[192:195], a[208:211], v[128:131], 0
    s_waitcnt lgkmcnt(12)
    ds_read_b64_tr_b16 a[160:161], v31 offset:0
    v_mfma_f32_16x16x32_bf16 v[192:195], a[212:215], v[132:135], v[192:195]
    s_waitcnt lgkmcnt(11)
    ds_read_b64_tr_b16 a[162:163], v31 offset:4096
    v_mfma_f32_16x16x32_bf16 v[192:195], a[216:219], v[136:139], v[192:195]
    s_waitcnt lgkmcnt(10)
    ds_read_b64_tr_b16 a[164:165], v31 offset:8192
    v_mfma_f32_16x16x32_bf16 v[192:195], a[220:223], v[140:143], v[192:195]
    s_waitcnt lgkmcnt(9)
    ds_read_b64_tr_b16 a[166:167], v31 offset:12288
    v_mfma_f32_16x16x32_bf16 v[192:195], a[224:227], v[144:147], v[192:195]
    s_waitcnt lgkmcnt(8)
    ds_read_b64_tr_b16 a[168:169], v31 offset:16384
    v_cvt_pk_bf16_f32 v230, v204, v205
    v_mfma_f32_16x16x32_bf16 v[192:195], a[228:231], v[148:151], v[192:195]
    s_waitcnt lgkmcnt(7)
    s_add_u32 s38, s47, 294912
    ds_read_b64_tr_b16 a[170:171], v31 offset:20480
    v_cvt_pk_bf16_f32 v231, v206, v207
    v_mfma_f32_16x16x32_bf16 v[192:195], a[232:235], v[152:155], v[192:195]
    s_waitcnt lgkmcnt(6)
    buffer_store_dwordx4 v[228:231], v56, s[28:31], s38 offen sc1
    v_mfma_f32_16x16x32_bf16 v[192:195], a[236:239], v[156:159], v[192:195]
    ds_read_b64_tr_b16 a[172:173], v31 offset:24576
    ds_read_b64_tr_b16 a[174:175], v31 offset:28672
    v_mfma_f32_16x16x32_bf16 v[196:199], a[208:211], v[160:163], 0
    ds_read_b64_tr_b16 a[176:177], v35 offset:0
    v_mfma_f32_16x16x32_bf16 v[196:199], a[212:215], v[164:167], v[196:199]
    ds_read_b64_tr_b16 a[178:179], v35 offset:4096
    v_mfma_f32_16x16x32_bf16 v[196:199], a[216:219], v[168:171], v[196:199]
    ds_read_b64_tr_b16 a[180:181], v35 offset:8192
    v_mfma_f32_16x16x32_bf16 v[196:199], a[220:223], v[172:175], v[196:199]
    ds_read_b64_tr_b16 a[182:183], v35 offset:12288
    v_mfma_f32_16x16x32_bf16 v[196:199], a[224:227], v[176:179], v[196:199]
Ltour8:
    s_cbranch_execz Ltour12
    ds_read_b64_tr_b16 a[184:185], v35 offset:16384
    v_cvt_pk_bf16_f32 v232, v192, v193
    v_mfma_f32_16x16x32_bf16 v[196:199], a[228:231], v[180:183], v[196:199]
    ds_read_b64_tr_b16 a[186:187], v35 offset:20480
    v_cvt_pk_bf16_f32 v233, v194, v195
    v_mfma_f32_16x16x32_bf16 v[196:199], a[232:235], v[184:187], v[196:199]
    ds_read_b64_tr_b16 a[188:189], v35 offset:24576
    v_mfma_f32_16x16x32_bf16 v[196:199], a[236:239], v[188:191], v[196:199]
    s_waitcnt lgkmcnt(13)
    ds_read_b64_tr_b16 a[190:191], v35 offset:28672
    s_waitcnt vmcnt(29)
    s_barrier
    v_mfma_f32_16x16x32_bf16 v[200:203], a[160:163], v[128:131], 0
    s_waitcnt lgkmcnt(12)
    ds_read_b64_tr_b16 a[208:209], v12 offset:0
    v_mfma_f32_16x16x32_bf16 v[200:203], a[164:167], v[132:135], v[200:203]
    s_waitcnt lgkmcnt(11)
    ds_read_b64_tr_b16 a[210:211], v12 offset:4096
    v_mfma_f32_16x16x32_bf16 v[200:203], a[168:171], v[136:139], v[200:203]
    s_waitcnt lgkmcnt(10)
    ds_read_b64_tr_b16 a[212:213], v12 offset:8192
    v_mfma_f32_16x16x32_bf16 v[200:203], a[172:175], v[140:143], v[200:203]
    s_waitcnt lgkmcnt(9)
    ds_read_b64_tr_b16 a[214:215], v12 offset:12288
    v_mfma_f32_16x16x32_bf16 v[200:203], a[176:179], v[144:147], v[200:203]
    s_waitcnt lgkmcnt(8)
    ds_read_b64_tr_b16 a[216:217], v12 offset:16384
    v_cvt_pk_bf16_f32 v236, v196, v197
    v_mfma_f32_16x16x32_bf16 v[200:203], a[180:183], v[148:151], v[200:203]
    s_waitcnt lgkmcnt(7)
    ds_read_b64_tr_b16 a[218:219], v12 offset:20480
    v_cvt_pk_bf16_f32 v237, v198, v199
    v_mfma_f32_16x16x32_bf16 v[200:203], a[184:187], v[152:155], v[200:203]
    s_waitcnt lgkmcnt(6)
    s_add_u32 s49, s45, 74112
    ds_read_b64_tr_b16 a[220:221], v12 offset:24576
    v_mfma_f32_16x16x32_bf16 v[200:203], a[188:191], v[156:159], v[200:203]
    s_add_u32 m0, s42, 81920
    ds_read_b64_tr_b16 a[222:223], v12 offset:28672
    v_mfma_f32_16x16x32_bf16 v[204:207], a[160:163], v[160:163], 0
    buffer_load_dwordx4 v46, s[20:23], s49 offen lds
    v_mfma_f32_16x16x32_bf16 v[204:207], a[164:167], v[164:167], v[204:207]
    ds_read_b64_tr_b16 a[224:225], v16 offset:0
    ds_read_b64_tr_b16 a[226:227], v16 offset:4096
    v_mfma_f32_16x16x32_bf16 v[204:207], a[168:171], v[168:171], v[204:207]
    buffer_load_dwordx4 v47, s[20:23], s49 offen offset:1024 lds
    v_mfma_f32_16x16x32_bf16 v[204:207], a[172:175], v[172:175], v[204:207]
    ds_read_b64_tr_b16 a[228:229], v16 offset:8192
    ds_read_b64_tr_b16 a[230:231], v16 offset:12288
    v_mfma_f32_16x16x32_bf16 v[204:207], a[176:179], v[176:179], v[204:207]
    ds_read_b64_tr_b16 a[232:233], v16 offset:16384
    v_cvt_pk_bf16_f32 v234, v200, v201
    v_mfma_f32_16x16x32_bf16 v[204:207], a[180:183], v[180:183], v[204:207]
    s_add_u32 s38, s47, 128
    ds_read_b64_tr_b16 a[234:235], v16 offset:20480
    v_cvt_pk_bf16_f32 v235, v202, v203
    v_mfma_f32_16x16x32_bf16 v[204:207], a[184:187], v[184:187], v[204:207]
    buffer_store_dwordx4 v[232:235], v56, s[28:31], s38 offen sc1
    v_mfma_f32_16x16x32_bf16 v[204:207], a[188:191], v[188:191], v[204:207]
    s_waitcnt lgkmcnt(12)
    ds_read_b64_tr_b16 a[236:237], v16 offset:24576
    ds_read_b64_tr_b16 a[238:239], v16 offset:28672
    v_mfma_f32_16x16x32_bf16 v[192:195], a[208:211], v[128:131], 0
    s_waitcnt lgkmcnt(12)
    buffer_load_dwordx4 v48, s[20:23], s49 offen offset:2048 lds
    v_mfma_f32_16x16x32_bf16 v[192:195], a[212:215], v[132:135], v[192:195]
    s_waitcnt lgkmcnt(10)
    ds_read_b64_tr_b16 a[160:161], v13 offset:0
    ds_read_b64_tr_b16 a[162:163], v13 offset:4096
    v_mfma_f32_16x16x32_bf16 v[192:195], a[216:219], v[136:139], v[192:195]
    s_waitcnt lgkmcnt(10)
    buffer_load_dwordx4 v49, s[20:23], s49 offen offset:3072 lds
    v_mfma_f32_16x16x32_bf16 v[192:195], a[220:223], v[140:143], v[192:195]
    s_waitcnt lgkmcnt(8)
    ds_read_b64_tr_b16 a[164:165], v13 offset:8192
    ds_read_b64_tr_b16 a[166:167], v13 offset:12288
    v_mfma_f32_16x16x32_bf16 v[192:195], a[224:227], v[144:147], v[192:195]
    s_waitcnt lgkmcnt(8)
    ds_read_b64_tr_b16 a[168:169], v13 offset:16384
    v_cvt_pk_bf16_f32 v238, v204, v205
    v_mfma_f32_16x16x32_bf16 v[192:195], a[228:231], v[148:151], v[192:195]
    s_waitcnt lgkmcnt(7)
    s_add_u32 s38, s47, 295040
    ds_read_b64_tr_b16 a[170:171], v13 offset:20480
    v_cvt_pk_bf16_f32 v239, v206, v207
    v_mfma_f32_16x16x32_bf16 v[192:195], a[232:235], v[152:155], v[192:195]
    s_waitcnt lgkmcnt(6)
    s_add_u32 s49, s45, 512
    buffer_store_dwordx4 v[236:239], v56, s[28:31], s38 offen sc1
    v_mfma_f32_16x16x32_bf16 v[192:195], a[236:239], v[156:159], v[192:195]
    s_add_u32 m0, s42, 98304
    ds_read_b64_tr_b16 a[172:173], v13 offset:24576
    ds_read_b64_tr_b16 a[174:175], v13 offset:28672
    v_mfma_f32_16x16x32_bf16 v[196:199], a[208:211], v[160:163], 0
    buffer_load_dwordx4 v46, s[20:23], s49 offen lds
    v_mfma_f32_16x16x32_bf16 v[196:199], a[212:215], v[164:167], v[196:199]
    ds_read_b64_tr_b16 a[176:177], v17 offset:0
    ds_read_b64_tr_b16 a[178:179], v17 offset:4096
    v_mfma_f32_16x16x32_bf16 v[196:199], a[216:219], v[168:171], v[196:199]
    buffer_load_dwordx4 v47, s[20:23], s49 offen offset:1024 lds
    v_mfma_f32_16x16x32_bf16 v[196:199], a[220:223], v[172:175], v[196:199]
    ds_read_b64_tr_b16 a[180:181], v17 offset:8192
    ds_read_b64_tr_b16 a[182:183], v17 offset:12288
    v_mfma_f32_16x16x32_bf16 v[196:199], a[224:227], v[176:179], v[196:199]
    ds_read_b64_tr_b16 a[184:185], v17 offset:16384
    v_cvt_pk_bf16_f32 v224, v192, v193
    v_mfma_f32_16x16x32_bf16 v[196:199], a[228:231], v[180:183], v[196:199]
    ds_read_b64_tr_b16 a[186:187], v17 offset:20480
    v_cvt_pk_bf16_f32 v225, v194, v195
    v_mfma_f32_16x16x32_bf16 v[196:199], a[232:235], v[184:187], v[196:199]
    ds_read_b64_tr_b16 a[188:189], v17 offset:24576
    v_mfma_f32_16x16x32_bf16 v[196:199], a[236:239], v[188:191], v[196:199]
    s_waitcnt lgkmcnt(13)
    ds_read_b64_tr_b16 a[190:191], v17 offset:28672
    v_mfma_f32_16x16x32_bf16 v[200:203], a[160:163], v[128:131], 0
    s_waitcnt lgkmcnt(12)
    buffer_load_dwordx4 v48, s[20:23], s49 offen offset:2048 lds
    v_mfma_f32_16x16x32_bf16 v[200:203], a[164:167], v[132:135], v[200:203]
    s_waitcnt lgkmcnt(10)
    ds_read_b64_tr_b16 a[208:209], v14 offset:0
    ds_read_b64_tr_b16 a[210:211], v14 offset:4096
    v_mfma_f32_16x16x32_bf16 v[200:203], a[168:171], v[136:139], v[200:203]
    s_waitcnt lgkmcnt(10)
    buffer_load_dwordx4 v49, s[20:23], s49 offen offset:3072 lds
    v_mfma_f32_16x16x32_bf16 v[200:203], a[172:175], v[140:143], v[200:203]
    s_waitcnt lgkmcnt(8)
    ds_read_b64_tr_b16 a[212:213], v14 offset:8192
    ds_read_b64_tr_b16 a[214:215], v14 offset:12288
    v_mfma_f32_16x16x32_bf16 v[200:203], a[176:179], v[144:147], v[200:203]
    s_waitcnt lgkmcnt(8)
    ds_read_b64_tr_b16 a[216:217], v14 offset:16384
    v_cvt_pk_bf16_f32 v228, v196, v197
    v_mfma_f32_16x16x32_bf16 v[200:203], a[180:183], v[148:151], v[200:203]
    s_waitcnt lgkmcnt(7)
    ds_read_b64_tr_b16 a[218:219], v14 offset:20480
    v_cvt_pk_bf16_f32 v229, v198, v199
    v_mfma_f32_16x16x32_bf16 v[200:203], a[184:187], v[152:155], v[200:203]
    s_waitcnt lgkmcnt(6)
    s_add_u32 s49, s45, 74240
    ds_read_b64_tr_b16 a[220:221], v14 offset:24576
    v_mfma_f32_16x16x32_bf16 v[200:203], a[188:191], v[156:159], v[200:203]
    s_add_u32 m0, s42, 114688
    ds_read_b64_tr_b16 a[222:223], v14 offset:28672
    v_mfma_f32_16x16x32_bf16 v[204:207], a[160:163], v[160:163], 0
    buffer_load_dwordx4 v46, s[20:23], s49 offen lds
    v_mfma_f32_16x16x32_bf16 v[204:207], a[164:167], v[164:167], v[204:207]
    ds_read_b64_tr_b16 a[224:225], v18 offset:0
    ds_read_b64_tr_b16 a[226:227], v18 offset:4096
    v_mfma_f32_16x16x32_bf16 v[204:207], a[168:171], v[168:171], v[204:207]
    buffer_load_dwordx4 v47, s[20:23], s49 offen offset:1024 lds
    v_mfma_f32_16x16x32_bf16 v[204:207], a[172:175], v[172:175], v[204:207]
    ds_read_b64_tr_b16 a[228:229], v18 offset:8192
    ds_read_b64_tr_b16 a[230:231], v18 offset:12288
    v_mfma_f32_16x16x32_bf16 v[204:207], a[176:179], v[176:179], v[204:207]
    ds_read_b64_tr_b16 a[232:233], v18 offset:16384
    v_cvt_pk_bf16_f32 v226, v200, v201
    v_mfma_f32_16x16x32_bf16 v[204:207], a[180:183], v[180:183], v[204:207]
    s_add_u32 s38, s47, 256
    ds_read_b64_tr_b16 a[234:235], v18 offset:20480
    v_cvt_pk_bf16_f32 v227, v202, v203
    v_mfma_f32_16x16x32_bf16 v[204:207], a[184:187], v[184:187], v[204:207]
    buffer_store_dwordx4 v[224:227], v56, s[28:31], s38 offen sc1
    v_mfma_f32_16x16x32_bf16 v[204:207], a[188:191], v[188:191], v[204:207]
    s_waitcnt lgkmcnt(12)
    ds_read_b64_tr_b16 a[236:237], v18 offset:24576
    ds_read_b64_tr_b16 a[238:239], v18 offset:28672
    v_mfma_f32_16x16x32_bf16 v[192:195], a[208:211], v[128:131], 0
    s_waitcnt lgkmcnt(12)
    buffer_load_dwordx4 v48, s[20:23], s49 offen offset:2048 lds
    v_mfma_f32_16x16x32_bf16 v[192:195], a[212:215], v[132:135], v[192:195]
    s_waitcnt lgkmcnt(10)
    ds_read_b64_tr_b16 a[160:161], v15 offset:0
    ds_read_b64_tr_b16 a[162:163], v15 offset:4096
    v_mfma_f32_16x16x32_bf16 v[192:195], a[216:219], v[136:139], v[192:195]
    s_waitcnt lgkmcnt(10)
    buffer_load_dwordx4 v49, s[20:23], s49 offen offset:3072 lds
    v_mfma_f32_16x16x32_bf16 v[192:195], a[220:223], v[140:143], v[192:195]
    s_waitcnt lgkmcnt(8)
    ds_read_b64_tr_b16 a[164:165], v15 offset:8192
    ds_read_b64_tr_b16 a[166:167], v15 offset:12288
    v_mfma_f32_16x16x32_bf16 v[192:195], a[224:227], v[144:147], v[192:195]
    s_waitcnt lgkmcnt(8)
    ds_read_b64_tr_b16 a[168:169], v15 offset:16384
    v_cvt_pk_bf16_f32 v230, v204, v205
    v_mfma_f32_16x16x32_bf16 v[192:195], a[228:231], v[148:151], v[192:195]
    s_waitcnt lgkmcnt(7)
    s_add_u32 s38, s47, 295168
    ds_read_b64_tr_b16 a[170:171], v15 offset:20480
    v_cvt_pk_bf16_f32 v231, v206, v207
    v_mfma_f32_16x16x32_bf16 v[192:195], a[232:235], v[152:155], v[192:195]
    s_waitcnt lgkmcnt(6)
    buffer_store_dwordx4 v[228:231], v56, s[28:31], s38 offen sc1
    v_mfma_f32_16x16x32_bf16 v[192:195], a[236:239], v[156:159], v[192:195]
    ds_read_b64_tr_b16 a[172:173], v15 offset:24576
    ds_read_b64_tr_b16 a[174:175], v15 offset:28672
    v_mfma_f32_16x16x32_bf16 v[196:199], a[208:211], v[160:163], 0
    ds_read_b64_tr_b16 a[176:177], v19 offset:0
    v_mfma_f32_16x16x32_bf16 v[196:199], a[212:215], v[164:167], v[196:199]
    ds_read_b64_tr_b16 a[178:179], v19 offset:4096
    v_mfma_f32_16x16x32_bf16 v[196:199], a[216:219], v[168:171], v[196:199]
    ds_read_b64_tr_b16 a[180:181], v19 offset:8192
    v_mfma_f32_16x16x32_bf16 v[196:199], a[220:223], v[172:175], v[196:199]
    ds_read_b64_tr_b16 a[182:183], v19 offset:12288
    v_mfma_f32_16x16x32_bf16 v[196:199], a[224:227], v[176:179], v[196:199]
    ds_read_b64_tr_b16 a[184:185], v19 offset:16384
    v_cvt_pk_bf16_f32 v232, v192, v193
    v_mfma_f32_16x16x32_bf16 v[196:199], a[228:231], v[180:183], v[196:199]
    ds_read_b64_tr_b16 a[186:187], v19 offset:20480
    v_cvt_pk_bf16_f32 v233, v194, v195
    v_mfma_f32_16x16x32_bf16 v[196:199], a[232:235], v[184:187], v[196:199]
    ds_read_b64_tr_b16 a[188:189], v19 offset:24576
    v_mfma_f32_16x16x32_bf16 v[196:199], a[236:239], v[188:191], v[196:199]
    s_waitcnt lgkmcnt(13)
    ds_read_b64_tr_b16 a[190:191], v19 offset:28672
    s_waitcnt vmcnt(37)
    s_barrier
    v_mfma_f32_16x16x32_bf16 v[200:203], a[160:163], v[128:131], 0
    s_waitcnt lgkmcnt(12)
    ds_read_b64_tr_b16 a[208:209], v12 offset:32768
    v_mfma_f32_16x16x32_bf16 v[200:203], a[164:167], v[132:135], v[200:203]
    s_waitcnt lgkmcnt(11)
    ds_read_b64_tr_b16 a[210:211], v12 offset:36864
    v_mfma_f32_16x16x32_bf16 v[200:203], a[168:171], v[136:139], v[200:203]
    s_waitcnt lgkmcnt(10)
    ds_read_b64_tr_b16 a[212:213], v12 offset:40960
    v_mfma_f32_16x16x32_bf16 v[200:203], a[172:175], v[140:143], v[200:203]
    s_waitcnt lgkmcnt(9)
    ds_read_b64_tr_b16 a[214:215], v12 offset:45056
    v_mfma_f32_16x16x32_bf16 v[200:203], a[176:179], v[144:147], v[200:203]
    s_waitcnt lgkmcnt(8)
    ds_read_b64_tr_b16 a[216:217], v12 offset:49152
    v_cvt_pk_bf16_f32 v236, v196, v197
    v_mfma_f32_16x16x32_bf16 v[200:203], a[180:183], v[148:151], v[200:203]
    s_waitcnt lgkmcnt(7)
    ds_read_b64_tr_b16 a[218:219], v12 offset:53248
    v_cvt_pk_bf16_f32 v237, v198, v199
    v_mfma_f32_16x16x32_bf16 v[200:203], a[184:187], v[152:155], v[200:203]
    s_waitcnt lgkmcnt(6)
    s_add_u32 s49, s45, 640
    ds_read_b64_tr_b16 a[220:221], v12 offset:57344
    v_mfma_f32_16x16x32_bf16 v[200:203], a[188:191], v[156:159], v[200:203]
    s_add_u32 m0, s42, 131072
    ds_read_b64_tr_b16 a[222:223], v12 offset:61440
    v_mfma_f32_16x16x32_bf16 v[204:207], a[160:163], v[160:163], 0
    buffer_load_dwordx4 v46, s[20:23], s49 offen lds
    v_mfma_f32_16x16x32_bf16 v[204:207], a[164:167], v[164:167], v[204:207]
    ds_read_b64_tr_b16 a[224:225], v16 offset:32768
    ds_read_b64_tr_b16 a[226:227], v16 offset:36864
    v_mfma_f32_16x16x32_bf16 v[204:207], a[168:171], v[168:171], v[204:207]
    buffer_load_dwordx4 v47, s[20:23], s49 offen offset:1024 lds
    v_mfma_f32_16x16x32_bf16 v[204:207], a[172:175], v[172:175], v[204:207]
    ds_read_b64_tr_b16 a[228:229], v16 offset:40960
    ds_read_b64_tr_b16 a[230:231], v16 offset:45056
    v_mfma_f32_16x16x32_bf16 v[204:207], a[176:179], v[176:179], v[204:207]
    ds_read_b64_tr_b16 a[232:233], v16 offset:49152
    v_cvt_pk_bf16_f32 v234, v200, v201
    v_mfma_f32_16x16x32_bf16 v[204:207], a[180:183], v[180:183], v[204:207]
    s_add_u32 s38, s47, 384
    ds_read_b64_tr_b16 a[234:235], v16 offset:53248
    v_cvt_pk_bf16_f32 v235, v202, v203
    v_mfma_f32_16x16x32_bf16 v[204:207], a[184:187], v[184:187], v[204:207]
    buffer_store_dwordx4 v[232:235], v56, s[28:31], s38 offen sc1
    v_mfma_f32_16x16x32_bf16 v[204:207], a[188:191], v[188:191], v[204:207]
    s_waitcnt lgkmcnt(12)
    ds_read_b64_tr_b16 a[236:237], v16 offset:57344
    ds_read_b64_tr_b16 a[238:239], v16 offset:61440
    v_mfma_f32_16x16x32_bf16 v[192:195], a[208:211], v[128:131], 0
    s_waitcnt lgkmcnt(12)
    buffer_load_dwordx4 v48, s[20:23], s49 offen offset:2048 lds
    v_mfma_f32_16x16x32_bf16 v[192:195], a[212:215], v[132:135], v[192:195]
    s_waitcnt lgkmcnt(10)
    ds_read_b64_tr_b16 a[160:161], v13 offset:32768
    ds_read_b64_tr_b16 a[162:163], v13 offset:36864
    v_mfma_f32_16x16x32_bf16 v[192:195], a[216:219], v[136:139], v[192:195]
    s_waitcnt lgkmcnt(10)
    buffer_load_dwordx4 v49, s[20:23], s49 offen offset:3072 lds
    v_mfma_f32_16x16x32_bf16 v[192:195], a[220:223], v[140:143], v[192:195]
    s_waitcnt lgkmcnt(8)
    ds_read_b64_tr_b16 a[164:165], v13 offset:40960
    ds_read_b64_tr_b16 a[166:167], v13 offset:45056
    v_mfma_f32_16x16x32_bf16 v[192:195], a[224:227], v[144:147], v[192:195]
    s_waitcnt lgkmcnt(8)
    ds_read_b64_tr_b16 a[168:169], v13 offset:49152
    v_cvt_pk_bf16_f32 v238, v204, v205
    v_mfma_f32_16x16x32_bf16 v[192:195], a[228:231], v[148:151], v[192:195]
    s_waitcnt lgkmcnt(7)
    s_add_u32 s38, s47, 295296
    ds_read_b64_tr_b16 a[170:171], v13 offset:53248
    v_cvt_pk_bf16_f32 v239, v206, v207
    v_mfma_f32_16x16x32_bf16 v[192:195], a[232:235], v[152:155], v[192:195]
    s_waitcnt lgkmcnt(6)
    s_add_u32 s49, s45, 74368
    buffer_store_dwordx4 v[236:239], v56, s[28:31], s38 offen sc1
    v_mfma_f32_16x16x32_bf16 v[192:195], a[236:239], v[156:159], v[192:195]
    s_add_u32 m0, s42, 147456
    ds_read_b64_tr_b16 a[172:173], v13 offset:57344
    ds_read_b64_tr_b16 a[174:175], v13 offset:61440
    v_mfma_f32_16x16x32_bf16 v[196:199], a[208:211], v[160:163], 0
    buffer_load_dwordx4 v46, s[20:23], s49 offen lds
    v_mfma_f32_16x16x32_bf16 v[196:199], a[212:215], v[164:167], v[196:199]
    ds_read_b64_tr_b16 a[176:177], v17 offset:32768
    ds_read_b64_tr_b16 a[178:179], v17 offset:36864
    v_mfma_f32_16x16x32_bf16 v[196:199], a[216:219], v[168:171], v[196:199]
    buffer_load_dwordx4 v47, s[20:23], s49 offen offset:1024 lds
    v_mfma_f32_16x16x32_bf16 v[196:199], a[220:223], v[172:175], v[196:199]
    ds_read_b64_tr_b16 a[180:181], v17 offset:40960
    ds_read_b64_tr_b16 a[182:183], v17 offset:45056
    v_mfma_f32_16x16x32_bf16 v[196:199], a[224:227], v[176:179], v[196:199]
    ds_read_b64_tr_b16 a[184:185], v17 offset:49152
    v_cvt_pk_bf16_f32 v224, v192, v193
    v_mfma_f32_16x16x32_bf16 v[196:199], a[228:231], v[180:183], v[196:199]
    ds_read_b64_tr_b16 a[186:187], v17 offset:53248
    v_cvt_pk_bf16_f32 v225, v194, v195
    v_mfma_f32_16x16x32_bf16 v[196:199], a[232:235], v[184:187], v[196:199]
    ds_read_b64_tr_b16 a[188:189], v17 offset:57344
    v_mfma_f32_16x16x32_bf16 v[196:199], a[236:239], v[188:191], v[196:199]
    s_waitcnt lgkmcnt(13)
    ds_read_b64_tr_b16 a[190:191], v17 offset:61440
    v_mfma_f32_16x16x32_bf16 v[200:203], a[160:163], v[128:131], 0
    s_waitcnt lgkmcnt(12)
    buffer_load_dwordx4 v48, s[20:23], s49 offen offset:2048 lds
    v_mfma_f32_16x16x32_bf16 v[200:203], a[164:167], v[132:135], v[200:203]
    s_waitcnt lgkmcnt(10)
    ds_read_b64_tr_b16 a[208:209], v14 offset:32768
    ds_read_b64_tr_b16 a[210:211], v14 offset:36864
    v_mfma_f32_16x16x32_bf16 v[200:203], a[168:171], v[136:139], v[200:203]
    s_waitcnt lgkmcnt(10)
    buffer_load_dwordx4 v49, s[20:23], s49 offen offset:3072 lds
    v_mfma_f32_16x16x32_bf16 v[200:203], a[172:175], v[140:143], v[200:203]
    s_waitcnt lgkmcnt(8)
    ds_read_b64_tr_b16 a[212:213], v14 offset:40960
    ds_read_b64_tr_b16 a[214:215], v14 offset:45056
    v_mfma_f32_16x16x32_bf16 v[200:203], a[176:179], v[144:147], v[200:203]
    s_waitcnt lgkmcnt(8)
    ds_read_b64_tr_b16 a[216:217], v14 offset:49152
    v_cvt_pk_bf16_f32 v228, v196, v197
    v_mfma_f32_16x16x32_bf16 v[200:203], a[180:183], v[148:151], v[200:203]
    s_waitcnt lgkmcnt(7)
    ds_read_b64_tr_b16 a[218:219], v14 offset:53248
    v_cvt_pk_bf16_f32 v229, v198, v199
    v_mfma_f32_16x16x32_bf16 v[200:203], a[184:187], v[152:155], v[200:203]
    s_waitcnt lgkmcnt(6)
    ds_read_b64_tr_b16 a[220:221], v14 offset:57344
    v_mfma_f32_16x16x32_bf16 v[200:203], a[188:191], v[156:159], v[200:203]
    ds_read_b64_tr_b16 a[222:223], v14 offset:61440
    v_mfma_f32_16x16x32_bf16 v[204:207], a[160:163], v[160:163], 0
    ds_read_b64_tr_b16 a[224:225], v18 offset:32768
    v_mfma_f32_16x16x32_bf16 v[204:207], a[164:167], v[164:167], v[204:207]
    ds_read_b64_tr_b16 a[226:227], v18 offset:36864
    v_mfma_f32_16x16x32_bf16 v[204:207], a[168:171], v[168:171], v[204:207]
    ds_read_b64_tr_b16 a[228:229], v18 offset:40960
    v_mfma_f32_16x16x32_bf16 v[204:207], a[172:175], v[172:175], v[204:207]
    ds_read_b64_tr_b16 a[230:231], v18 offset:45056
    v_mfma_f32_16x16x32_bf16 v[204:207], a[176:179], v[176:179], v[204:207]
    ds_read_b64_tr_b16 a[232:233], v18 offset:49152
    v_cvt_pk_bf16_f32 v226, v200, v201
    v_mfma_f32_16x16x32_bf16 v[204:207], a[180:183], v[180:183], v[204:207]
    s_add_u32 s38, s47, 512
    ds_read_b64_tr_b16 a[234:235], v18 offset:53248
    v_cvt_pk_bf16_f32 v227, v202, v203
    v_mfma_f32_16x16x32_bf16 v[204:207], a[184:187], v[184:187], v[204:207]
    buffer_store_dwordx4 v[224:227], v56, s[28:31], s38 offen sc1
    v_mfma_f32_16x16x32_bf16 v[204:207], a[188:191], v[188:191], v[204:207]
    s_waitcnt lgkmcnt(12)
    ds_read_b64_tr_b16 a[236:237], v18 offset:57344
    ds_read_b64_tr_b16 a[238:239], v18 offset:61440
    v_mfma_f32_16x16x32_bf16 v[192:195], a[208:211], v[128:131], 0
    s_waitcnt lgkmcnt(12)
    ds_read_b64_tr_b16 a[160:161], v15 offset:32768
    v_mfma_f32_16x16x32_bf16 v[192:195], a[212:215], v[132:135], v[192:195]
    s_waitcnt lgkmcnt(11)
    ds_read_b64_tr_b16 a[162:163], v15 offset:36864
    v_mfma_f32_16x16x32_bf16 v[192:195], a[216:219], v[136:139], v[192:195]
    s_waitcnt lgkmcnt(10)
    ds_read_b64_tr_b16 a[164:165], v15 offset:40960
    v_mfma_f32_16x16x32_bf16 v[192:195], a[220:223], v[140:143], v[192:195]
    s_waitcnt lgkmcnt(9)
    ds_read_b64_tr_b16 a[166:167], v15 offset:45056
    v_mfma_f32_16x16x32_bf16 v[192:195], a[224:227], v[144:147], v[192:195]
    s_waitcnt lgkmcnt(8)
    ds_read_b64_tr_b16 a[168:169], v15 offset:49152
    v_cvt_pk_bf16_f32 v230, v204, v205
    v_mfma_f32_16x16x32_bf16 v[192:195], a[228:231], v[148:151], v[192:195]
    s_waitcnt lgkmcnt(7)
    s_add_u32 s38, s47, 295424
    ds_read_b64_tr_b16 a[170:171], v15 offset:53248
    v_cvt_pk_bf16_f32 v231, v206, v207
    v_mfma_f32_16x16x32_bf16 v[192:195], a[232:235], v[152:155], v[192:195]
    s_waitcnt lgkmcnt(6)
    buffer_store_dwordx4 v[228:231], v56, s[28:31], s38 offen sc1
    v_mfma_f32_16x16x32_bf16 v[192:195], a[236:239], v[156:159], v[192:195]
    ds_read_b64_tr_b16 a[172:173], v15 offset:57344
    ds_read_b64_tr_b16 a[174:175], v15 offset:61440
    v_mfma_f32_16x16x32_bf16 v[196:199], a[208:211], v[160:163], 0
    ds_read_b64_tr_b16 a[176:177], v19 offset:32768
    v_mfma_f32_16x16x32_bf16 v[196:199], a[212:215], v[164:167], v[196:199]
    ds_read_b64_tr_b16 a[178:179], v19 offset:36864
    v_mfma_f32_16x16x32_bf16 v[196:199], a[216:219], v[168:171], v[196:199]
    ds_read_b64_tr_b16 a[180:181], v19 offset:40960
    v_mfma_f32_16x16x32_bf16 v[196:199], a[220:223], v[172:175], v[196:199]
    ds_read_b64_tr_b16 a[182:183], v19 offset:45056
    v_mfma_f32_16x16x32_bf16 v[196:199], a[224:227], v[176:179], v[196:199]
    ds_read_b64_tr_b16 a[184:185], v19 offset:49152
    v_cvt_pk_bf16_f32 v232, v192, v193
    v_mfma_f32_16x16x32_bf16 v[196:199], a[228:231], v[180:183], v[196:199]
    ds_read_b64_tr_b16 a[186:187], v19 offset:53248
    v_cvt_pk_bf16_f32 v233, v194, v195
    v_mfma_f32_16x16x32_bf16 v[196:199], a[232:235], v[184:187], v[196:199]
    ds_read_b64_tr_b16 a[188:189], v19 offset:57344
    v_mfma_f32_16x16x32_bf16 v[196:199], a[236:239], v[188:191], v[196:199]
    s_waitcnt lgkmcnt(13)
    ds_read_b64_tr_b16 a[190:191], v19 offset:61440
    s_waitcnt vmcnt(23)
    s_barrier
    v_mfma_f32_16x16x32_bf16 v[200:203], a[160:163], v[128:131], 0
    s_waitcnt lgkmcnt(12)
    ds_read_b64_tr_b16 a[208:209], v20 offset:0
    v_mfma_f32_16x16x32_bf16 v[200:203], a[164:167], v[132:135], v[200:203]
    s_waitcnt lgkmcnt(11)
    ds_read_b64_tr_b16 a[210:211], v20 offset:4096
    v_mfma_f32_16x16x32_bf16 v[200:203], a[168:171], v[136:139], v[200:203]
    s_waitcnt lgkmcnt(10)
    ds_read_b64_tr_b16 a[212:213], v20 offset:8192
    v_mfma_f32_16x16x32_bf16 v[200:203], a[172:175], v[140:143], v[200:203]
    s_waitcnt lgkmcnt(9)
    ds_read_b64_tr_b16 a[214:215], v20 offset:12288
    v_mfma_f32_16x16x32_bf16 v[200:203], a[176:179], v[144:147], v[200:203]
    s_waitcnt lgkmcnt(8)
    ds_read_b64_tr_b16 a[216:217], v20 offset:16384
    v_cvt_pk_bf16_f32 v236, v196, v197
    v_mfma_f32_16x16x32_bf16 v[200:203], a[180:183], v[148:151], v[200:203]
    s_waitcnt lgkmcnt(7)
    ds_read_b64_tr_b16 a[218:219], v20 offset:20480
    v_cvt_pk_bf16_f32 v237, v198, v199
    v_mfma_f32_16x16x32_bf16 v[200:203], a[184:187], v[152:155], v[200:203]
    s_waitcnt lgkmcnt(6)
    s_add_u32 s49, s45, 768
    ds_read_b64_tr_b16 a[220:221], v20 offset:24576
    v_mfma_f32_16x16x32_bf16 v[200:203], a[188:191], v[156:159], v[200:203]
    s_add_u32 m0, s42, 0
    ds_read_b64_tr_b16 a[222:223], v20 offset:28672
    v_mfma_f32_16x16x32_bf16 v[204:207], a[160:163], v[160:163], 0
    buffer_load_dwordx4 v46, s[20:23], s49 offen lds
    v_mfma_f32_16x16x32_bf16 v[204:207], a[164:167], v[164:167], v[204:207]
    ds_read_b64_tr_b16 a[224:225], v24 offset:0
    ds_read_b64_tr_b16 a[226:227], v24 offset:4096
    v_mfma_f32_16x16x32_bf16 v[204:207], a[168:171], v[168:171], v[204:207]
    buffer_load_dwordx4 v47, s[20:23], s49 offen offset:1024 lds
    v_mfma_f32_16x16x32_bf16 v[204:207], a[172:175], v[172:175], v[204:207]
    ds_read_b64_tr_b16 a[228:229], v24 offset:8192
    ds_read_b64_tr_b16 a[230:231], v24 offset:12288
    v_mfma_f32_16x16x32_bf16 v[204:207], a[176:179], v[176:179], v[204:207]
    ds_read_b64_tr_b16 a[232:233], v24 offset:16384
    v_cvt_pk_bf16_f32 v234, v200, v201
    v_mfma_f32_16x16x32_bf16 v[204:207], a[180:183], v[180:183], v[204:207]
    s_add_u32 s38, s47, 640
    ds_read_b64_tr_b16 a[234:235], v24 offset:20480
    v_cvt_pk_bf16_f32 v235, v202, v203
    v_mfma_f32_16x16x32_bf16 v[204:207], a[184:187], v[184:187], v[204:207]
    buffer_store_dwordx4 v[232:235], v56, s[28:31], s38 offen sc1
    v_mfma_f32_16x16x32_bf16 v[204:207], a[188:191], v[188:191], v[204:207]
    s_waitcnt lgkmcnt(12)
    ds_read_b64_tr_b16 a[236:237], v24 offset:24576
    ds_read_b64_tr_b16 a[238:239], v24 offset:28672
    v_mfma_f32_16x16x32_bf16 v[192:195], a[208:211], v[128:131], 0
    s_waitcnt lgkmcnt(12)
    buffer_load_dwordx4 v48, s[20:23], s49 offen offset:2048 lds
    v_mfma_f32_16x16x32_bf16 v[192:195], a[212:215], v[132:135], v[192:195]
    s_waitcnt lgkmcnt(10)
    ds_read_b64_tr_b16 a[160:161], v21 offset:0
    ds_read_b64_tr_b16 a[162:163], v21 offset:4096
    v_mfma_f32_16x16x32_bf16 v[192:195], a[216:219], v[136:139], v[192:195]
    s_waitcnt lgkmcnt(10)
    buffer_load_dwordx4 v49, s[20:23], s49 offen offset:3072 lds
    v_mfma_f32_16x16x32_bf16 v[192:195], a[220:223], v[140:143], v[192:195]
    s_waitcnt lgkmcnt(8)
    ds_read_b64_tr_b16 a[164:165], v21 offset:8192
    ds_read_b64_tr_b16 a[166:167], v21 offset:12288
    v_mfma_f32_16x16x32_bf16 v[192:195], a[224:227], v[144:147], v[192:195]
    s_waitcnt lgkmcnt(8)
    ds_read_b64_tr_b16 a[168:169], v21 offset:16384
    v_cvt_pk_bf16_f32 v238, v204, v205
    v_mfma_f32_16x16x32_bf16 v[192:195], a[228:231], v[148:151], v[192:195]
    s_waitcnt lgkmcnt(7)
    s_add_u32 s38, s47, 295552
    ds_read_b64_tr_b16 a[170:171], v21 offset:20480
    v_cvt_pk_bf16_f32 v239, v206, v207
    v_mfma_f32_16x16x32_bf16 v[192:195], a[232:235], v[152:155], v[192:195]
    s_waitcnt lgkmcnt(6)
    s_add_u32 s49, s45, 74496
    buffer_store_dwordx4 v[236:239], v56, s[28:31], s38 offen sc1
    v_mfma_f32_16x16x32_bf16 v[192:195], a[236:239], v[156:159], v[192:195]
    s_add_u32 m0, s42, 16384
    ds_read_b64_tr_b16 a[172:173], v21 offset:24576
    ds_read_b64_tr_b16 a[174:175], v21 offset:28672
    v_mfma_f32_16x16x32_bf16 v[196:199], a[208:211], v[160:163], 0
    buffer_load_dwordx4 v46, s[20:23], s49 offen lds
    v_mfma_f32_16x16x32_bf16 v[196:199], a[212:215], v[164:167], v[196:199]
    ds_read_b64_tr_b16 a[176:177], v25 offset:0
    ds_read_b64_tr_b16 a[178:179], v25 offset:4096
    v_mfma_f32_16x16x32_bf16 v[196:199], a[216:219], v[168:171], v[196:199]
    buffer_load_dwordx4 v47, s[20:23], s49 offen offset:1024 lds
    v_mfma_f32_16x16x32_bf16 v[196:199], a[220:223], v[172:175], v[196:199]
    ds_read_b64_tr_b16 a[180:181], v25 offset:8192
    ds_read_b64_tr_b16 a[182:183], v25 offset:12288
    v_mfma_f32_16x16x32_bf16 v[196:199], a[224:227], v[176:179], v[196:199]
    ds_read_b64_tr_b16 a[184:185], v25 offset:16384
    v_cvt_pk_bf16_f32 v224, v192, v193
    v_mfma_f32_16x16x32_bf16 v[196:199], a[228:231], v[180:183], v[196:199]
    ds_read_b64_tr_b16 a[186:187], v25 offset:20480
    v_cvt_pk_bf16_f32 v225, v194, v195
    v_mfma_f32_16x16x32_bf16 v[196:199], a[232:235], v[184:187], v[196:199]
    ds_read_b64_tr_b16 a[188:189], v25 offset:24576
    v_mfma_f32_16x16x32_bf16 v[196:199], a[236:239], v[188:191], v[196:199]
    s_waitcnt lgkmcnt(13)
    ds_read_b64_tr_b16 a[190:191], v25 offset:28672
    v_mfma_f32_16x16x32_bf16 v[200:203], a[160:163], v[128:131], 0
    s_waitcnt lgkmcnt(12)
    buffer_load_dwordx4 v48, s[20:23], s49 offen offset:2048 lds
    v_mfma_f32_16x16x32_bf16 v[200:203], a[164:167], v[132:135], v[200:203]
    s_waitcnt lgkmcnt(10)
    ds_read_b64_tr_b16 a[208:209], v22 offset:0
    ds_read_b64_tr_b16 a[210:211], v22 offset:4096
    v_mfma_f32_16x16x32_bf16 v[200:203], a[168:171], v[136:139], v[200:203]
    s_waitcnt lgkmcnt(10)
    buffer_load_dwordx4 v49, s[20:23], s49 offen offset:3072 lds
    v_mfma_f32_16x16x32_bf16 v[200:203], a[172:175], v[140:143], v[200:203]
    s_waitcnt lgkmcnt(8)
    ds_read_b64_tr_b16 a[212:213], v22 offset:8192
    ds_read_b64_tr_b16 a[214:215], v22 offset:12288
    v_mfma_f32_16x16x32_bf16 v[200:203], a[176:179], v[144:147], v[200:203]
    s_waitcnt lgkmcnt(8)
    ds_read_b64_tr_b16 a[216:217], v22 offset:16384
    v_cvt_pk_bf16_f32 v228, v196, v197
    v_mfma_f32_16x16x32_bf16 v[200:203], a[180:183], v[148:151], v[200:203]
    s_waitcnt lgkmcnt(7)
    ds_read_b64_tr_b16 a[218:219], v22 offset:20480
    v_cvt_pk_bf16_f32 v229, v198, v199
    v_mfma_f32_16x16x32_bf16 v[200:203], a[184:187], v[152:155], v[200:203]
    s_waitcnt lgkmcnt(6)
    ds_read_b64_tr_b16 a[220:221], v22 offset:24576
    v_mfma_f32_16x16x32_bf16 v[200:203], a[188:191], v[156:159], v[200:203]
    ds_read_b64_tr_b16 a[222:223], v22 offset:28672
    v_mfma_f32_16x16x32_bf16 v[204:207], a[160:163], v[160:163], 0
    ds_read_b64_tr_b16 a[224:225], v26 offset:0
    v_mfma_f32_16x16x32_bf16 v[204:207], a[164:167], v[164:167], v[204:207]
    ds_read_b64_tr_b16 a[226:227], v26 offset:4096
    v_mfma_f32_16x16x32_bf16 v[204:207], a[168:171], v[168:171], v[204:207]
    ds_read_b64_tr_b16 a[228:229], v26 offset:8192
    v_mfma_f32_16x16x32_bf16 v[204:207], a[172:175], v[172:175], v[204:207]
    ds_read_b64_tr_b16 a[230:231], v26 offset:12288
    v_mfma_f32_16x16x32_bf16 v[204:207], a[176:179], v[176:179], v[204:207]
    ds_read_b64_tr_b16 a[232:233], v26 offset:16384
    v_cvt_pk_bf16_f32 v226, v200, v201
    v_mfma_f32_16x16x32_bf16 v[204:207], a[180:183], v[180:183], v[204:207]
    s_add_u32 s38, s47, 768
    ds_read_b64_tr_b16 a[234:235], v26 offset:20480
    v_cvt_pk_bf16_f32 v227, v202, v203
    v_mfma_f32_16x16x32_bf16 v[204:207], a[184:187], v[184:187], v[204:207]
Ltour9:
    s_cbranch_execz Ltour13
    buffer_store_dwordx4 v[224:227], v56, s[28:31], s38 offen sc1
    v_mfma_f32_16x16x32_bf16 v[204:207], a[188:191], v[188:191], v[204:207]
    s_waitcnt lgkmcnt(12)
    ds_read_b64_tr_b16 a[236:237], v26 offset:24576
    ds_read_b64_tr_b16 a[238:239], v26 offset:28672
    v_mfma_f32_16x16x32_bf16 v[192:195], a[208:211], v[128:131], 0
    s_waitcnt lgkmcnt(12)
    ds_read_b64_tr_b16 a[160:161], v23 offset:0
    v_mfma_f32_16x16x32_bf16 v[192:195], a[212:215], v[132:135], v[192:195]
    s_waitcnt lgkmcnt(11)
    ds_read_b64_tr_b16 a[162:163], v23 offset:4096
    v_mfma_f32_16x16x32_bf16 v[192:195], a[216:219], v[136:139], v[192:195]
    s_waitcnt lgkmcnt(10)
    ds_read_b64_tr_b16 a[164:165], v23 offset:8192
    v_mfma_f32_16x16x32_bf16 v[192:195], a[220:223], v[140:143], v[192:195]
    s_waitcnt lgkmcnt(9)
    ds_read_b64_tr_b16 a[166:167], v23 offset:12288
    v_mfma_f32_16x16x32_bf16 v[192:195], a[224:227], v[144:147], v[192:195]
    s_waitcnt lgkmcnt(8)
    ds_read_b64_tr_b16 a[168:169], v23 offset:16384
    v_cvt_pk_bf16_f32 v230, v204, v205
    v_mfma_f32_16x16x32_bf16 v[192:195], a[228:231], v[148:151], v[192:195]
    s_waitcnt lgkmcnt(7)
    s_add_u32 s38, s47, 295680
    ds_read_b64_tr_b16 a[170:171], v23 offset:20480
    v_cvt_pk_bf16_f32 v231, v206, v207
    v_mfma_f32_16x16x32_bf16 v[192:195], a[232:235], v[152:155], v[192:195]
    s_waitcnt lgkmcnt(6)
    buffer_store_dwordx4 v[228:231], v56, s[28:31], s38 offen sc1
    v_mfma_f32_16x16x32_bf16 v[192:195], a[236:239], v[156:159], v[192:195]
    ds_read_b64_tr_b16 a[172:173], v23 offset:24576
    ds_read_b64_tr_b16 a[174:175], v23 offset:28672
    v_mfma_f32_16x16x32_bf16 v[196:199], a[208:211], v[160:163], 0
    ds_read_b64_tr_b16 a[176:177], v27 offset:0
    v_mfma_f32_16x16x32_bf16 v[196:199], a[212:215], v[164:167], v[196:199]
    ds_read_b64_tr_b16 a[178:179], v27 offset:4096
    v_mfma_f32_16x16x32_bf16 v[196:199], a[216:219], v[168:171], v[196:199]
    ds_read_b64_tr_b16 a[180:181], v27 offset:8192
    v_mfma_f32_16x16x32_bf16 v[196:199], a[220:223], v[172:175], v[196:199]
    ds_read_b64_tr_b16 a[182:183], v27 offset:12288
    v_mfma_f32_16x16x32_bf16 v[196:199], a[224:227], v[176:179], v[196:199]
    ds_read_b64_tr_b16 a[184:185], v27 offset:16384
    v_cvt_pk_bf16_f32 v232, v192, v193
    v_mfma_f32_16x16x32_bf16 v[196:199], a[228:231], v[180:183], v[196:199]
    ds_read_b64_tr_b16 a[186:187], v27 offset:20480
    v_cvt_pk_bf16_f32 v233, v194, v195
    v_mfma_f32_16x16x32_bf16 v[196:199], a[232:235], v[184:187], v[196:199]
    ds_read_b64_tr_b16 a[188:189], v27 offset:24576
    v_mfma_f32_16x16x32_bf16 v[196:199], a[236:239], v[188:191], v[196:199]
    s_waitcnt lgkmcnt(13)
    ds_read_b64_tr_b16 a[190:191], v27 offset:28672
    s_waitcnt vmcnt(25)
    s_barrier
    v_mfma_f32_16x16x32_bf16 v[200:203], a[160:163], v[128:131], 0
    s_waitcnt lgkmcnt(12)
    ds_read_b64_tr_b16 a[208:209], v20 offset:32768
    v_mfma_f32_16x16x32_bf16 v[200:203], a[164:167], v[132:135], v[200:203]
    s_waitcnt lgkmcnt(11)
    ds_read_b64_tr_b16 a[210:211], v20 offset:36864
    v_mfma_f32_16x16x32_bf16 v[200:203], a[168:171], v[136:139], v[200:203]
    s_waitcnt lgkmcnt(10)
    ds_read_b64_tr_b16 a[212:213], v20 offset:40960
    v_mfma_f32_16x16x32_bf16 v[200:203], a[172:175], v[140:143], v[200:203]
    s_waitcnt lgkmcnt(9)
    ds_read_b64_tr_b16 a[214:215], v20 offset:45056
    v_mfma_f32_16x16x32_bf16 v[200:203], a[176:179], v[144:147], v[200:203]
    s_waitcnt lgkmcnt(8)
    ds_read_b64_tr_b16 a[216:217], v20 offset:49152
    v_cvt_pk_bf16_f32 v236, v196, v197
    v_mfma_f32_16x16x32_bf16 v[200:203], a[180:183], v[148:151], v[200:203]
    s_waitcnt lgkmcnt(7)
    ds_read_b64_tr_b16 a[218:219], v20 offset:53248
    v_cvt_pk_bf16_f32 v237, v198, v199
    v_mfma_f32_16x16x32_bf16 v[200:203], a[184:187], v[152:155], v[200:203]
    s_waitcnt lgkmcnt(6)
    s_add_u32 s49, s45, 896
    ds_read_b64_tr_b16 a[220:221], v20 offset:57344
    v_mfma_f32_16x16x32_bf16 v[200:203], a[188:191], v[156:159], v[200:203]
    s_add_u32 m0, s42, 32768
    ds_read_b64_tr_b16 a[222:223], v20 offset:61440
    v_mfma_f32_16x16x32_bf16 v[204:207], a[160:163], v[160:163], 0
    buffer_load_dwordx4 v46, s[20:23], s49 offen lds
    v_mfma_f32_16x16x32_bf16 v[204:207], a[164:167], v[164:167], v[204:207]
    ds_read_b64_tr_b16 a[224:225], v24 offset:32768
    ds_read_b64_tr_b16 a[226:227], v24 offset:36864
    v_mfma_f32_16x16x32_bf16 v[204:207], a[168:171], v[168:171], v[204:207]
    buffer_load_dwordx4 v47, s[20:23], s49 offen offset:1024 lds
    v_mfma_f32_16x16x32_bf16 v[204:207], a[172:175], v[172:175], v[204:207]
    ds_read_b64_tr_b16 a[228:229], v24 offset:40960
    ds_read_b64_tr_b16 a[230:231], v24 offset:45056
    v_mfma_f32_16x16x32_bf16 v[204:207], a[176:179], v[176:179], v[204:207]
    ds_read_b64_tr_b16 a[232:233], v24 offset:49152
    v_cvt_pk_bf16_f32 v234, v200, v201
    v_mfma_f32_16x16x32_bf16 v[204:207], a[180:183], v[180:183], v[204:207]
    s_add_u32 s38, s47, 896
    ds_read_b64_tr_b16 a[234:235], v24 offset:53248
    v_cvt_pk_bf16_f32 v235, v202, v203
    v_mfma_f32_16x16x32_bf16 v[204:207], a[184:187], v[184:187], v[204:207]
    buffer_store_dwordx4 v[232:235], v56, s[28:31], s38 offen sc1
    v_mfma_f32_16x16x32_bf16 v[204:207], a[188:191], v[188:191], v[204:207]
    s_waitcnt lgkmcnt(12)
    ds_read_b64_tr_b16 a[236:237], v24 offset:57344
    ds_read_b64_tr_b16 a[238:239], v24 offset:61440
    v_mfma_f32_16x16x32_bf16 v[192:195], a[208:211], v[128:131], 0
    s_waitcnt lgkmcnt(12)
    buffer_load_dwordx4 v48, s[20:23], s49 offen offset:2048 lds
    v_mfma_f32_16x16x32_bf16 v[192:195], a[212:215], v[132:135], v[192:195]
    s_waitcnt lgkmcnt(10)
    ds_read_b64_tr_b16 a[160:161], v21 offset:32768
    ds_read_b64_tr_b16 a[162:163], v21 offset:36864
    v_mfma_f32_16x16x32_bf16 v[192:195], a[216:219], v[136:139], v[192:195]
    s_waitcnt lgkmcnt(10)
    buffer_load_dwordx4 v49, s[20:23], s49 offen offset:3072 lds
    v_mfma_f32_16x16x32_bf16 v[192:195], a[220:223], v[140:143], v[192:195]
    s_waitcnt lgkmcnt(8)
    ds_read_b64_tr_b16 a[164:165], v21 offset:40960
    ds_read_b64_tr_b16 a[166:167], v21 offset:45056
    v_mfma_f32_16x16x32_bf16 v[192:195], a[224:227], v[144:147], v[192:195]
    s_waitcnt lgkmcnt(8)
    ds_read_b64_tr_b16 a[168:169], v21 offset:49152
    v_cvt_pk_bf16_f32 v238, v204, v205
    v_mfma_f32_16x16x32_bf16 v[192:195], a[228:231], v[148:151], v[192:195]
    s_waitcnt lgkmcnt(7)
    s_add_u32 s38, s47, 295808
    ds_read_b64_tr_b16 a[170:171], v21 offset:53248
    v_cvt_pk_bf16_f32 v239, v206, v207
    v_mfma_f32_16x16x32_bf16 v[192:195], a[232:235], v[152:155], v[192:195]
    s_waitcnt lgkmcnt(6)
    s_add_u32 s49, s45, 74624
    buffer_store_dwordx4 v[236:239], v56, s[28:31], s38 offen sc1
    v_mfma_f32_16x16x32_bf16 v[192:195], a[236:239], v[156:159], v[192:195]
    s_add_u32 m0, s42, 49152
    ds_read_b64_tr_b16 a[172:173], v21 offset:57344
    ds_read_b64_tr_b16 a[174:175], v21 offset:61440
    v_mfma_f32_16x16x32_bf16 v[196:199], a[208:211], v[160:163], 0
    buffer_load_dwordx4 v46, s[20:23], s49 offen lds
    v_mfma_f32_16x16x32_bf16 v[196:199], a[212:215], v[164:167], v[196:199]
    ds_read_b64_tr_b16 a[176:177], v25 offset:32768
    ds_read_b64_tr_b16 a[178:179], v25 offset:36864
    v_mfma_f32_16x16x32_bf16 v[196:199], a[216:219], v[168:171], v[196:199]
    buffer_load_dwordx4 v47, s[20:23], s49 offen offset:1024 lds
    v_mfma_f32_16x16x32_bf16 v[196:199], a[220:223], v[172:175], v[196:199]
    ds_read_b64_tr_b16 a[180:181], v25 offset:40960
    ds_read_b64_tr_b16 a[182:183], v25 offset:45056
    v_mfma_f32_16x16x32_bf16 v[196:199], a[224:227], v[176:179], v[196:199]
    ds_read_b64_tr_b16 a[184:185], v25 offset:49152
    v_cvt_pk_bf16_f32 v224, v192, v193
    v_mfma_f32_16x16x32_bf16 v[196:199], a[228:231], v[180:183], v[196:199]
    ds_read_b64_tr_b16 a[186:187], v25 offset:53248
    v_cvt_pk_bf16_f32 v225, v194, v195
    v_mfma_f32_16x16x32_bf16 v[196:199], a[232:235], v[184:187], v[196:199]
    ds_read_b64_tr_b16 a[188:189], v25 offset:57344
    v_mfma_f32_16x16x32_bf16 v[196:199], a[236:239], v[188:191], v[196:199]
    s_waitcnt lgkmcnt(13)
    ds_read_b64_tr_b16 a[190:191], v25 offset:61440
    v_mfma_f32_16x16x32_bf16 v[200:203], a[160:163], v[128:131], 0
    s_waitcnt lgkmcnt(12)
    buffer_load_dwordx4 v48, s[20:23], s49 offen offset:2048 lds
    v_mfma_f32_16x16x32_bf16 v[200:203], a[164:167], v[132:135], v[200:203]
    s_waitcnt lgkmcnt(10)
    ds_read_b64_tr_b16 a[208:209], v22 offset:32768
    ds_read_b64_tr_b16 a[210:211], v22 offset:36864
    v_mfma_f32_16x16x32_bf16 v[200:203], a[168:171], v[136:139], v[200:203]
    s_waitcnt lgkmcnt(10)
    buffer_load_dwordx4 v49, s[20:23], s49 offen offset:3072 lds
    v_mfma_f32_16x16x32_bf16 v[200:203], a[172:175], v[140:143], v[200:203]
    s_waitcnt lgkmcnt(8)
    ds_read_b64_tr_b16 a[212:213], v22 offset:40960
    ds_read_b64_tr_b16 a[214:215], v22 offset:45056
    v_mfma_f32_16x16x32_bf16 v[200:203], a[176:179], v[144:147], v[200:203]
    s_waitcnt lgkmcnt(8)
    ds_read_b64_tr_b16 a[216:217], v22 offset:49152
    v_cvt_pk_bf16_f32 v228, v196, v197
    v_mfma_f32_16x16x32_bf16 v[200:203], a[180:183], v[148:151], v[200:203]
    s_waitcnt lgkmcnt(7)
    ds_read_b64_tr_b16 a[218:219], v22 offset:53248
    v_cvt_pk_bf16_f32 v229, v198, v199
    v_mfma_f32_16x16x32_bf16 v[200:203], a[184:187], v[152:155], v[200:203]
    s_waitcnt lgkmcnt(6)
    ds_read_b64_tr_b16 a[220:221], v22 offset:57344
    v_mfma_f32_16x16x32_bf16 v[200:203], a[188:191], v[156:159], v[200:203]
    ds_read_b64_tr_b16 a[222:223], v22 offset:61440
    v_mfma_f32_16x16x32_bf16 v[204:207], a[160:163], v[160:163], 0
    ds_read_b64_tr_b16 a[224:225], v26 offset:32768
    v_mfma_f32_16x16x32_bf16 v[204:207], a[164:167], v[164:167], v[204:207]
    ds_read_b64_tr_b16 a[226:227], v26 offset:36864
    v_mfma_f32_16x16x32_bf16 v[204:207], a[168:171], v[168:171], v[204:207]
    ds_read_b64_tr_b16 a[228:229], v26 offset:40960
    v_mfma_f32_16x16x32_bf16 v[204:207], a[172:175], v[172:175], v[204:207]
    ds_read_b64_tr_b16 a[230:231], v26 offset:45056
    v_mfma_f32_16x16x32_bf16 v[204:207], a[176:179], v[176:179], v[204:207]
    ds_read_b64_tr_b16 a[232:233], v26 offset:49152
    v_cvt_pk_bf16_f32 v226, v200, v201
    v_mfma_f32_16x16x32_bf16 v[204:207], a[180:183], v[180:183], v[204:207]
    s_add_u32 s38, s47, 1024
    ds_read_b64_tr_b16 a[234:235], v26 offset:53248
    v_cvt_pk_bf16_f32 v227, v202, v203
    v_mfma_f32_16x16x32_bf16 v[204:207], a[184:187], v[184:187], v[204:207]
    buffer_store_dwordx4 v[224:227], v56, s[28:31], s38 offen sc1
    v_mfma_f32_16x16x32_bf16 v[204:207], a[188:191], v[188:191], v[204:207]
    s_waitcnt lgkmcnt(12)
    ds_read_b64_tr_b16 a[236:237], v26 offset:57344
    ds_read_b64_tr_b16 a[238:239], v26 offset:61440
    v_mfma_f32_16x16x32_bf16 v[192:195], a[208:211], v[128:131], 0
    s_waitcnt lgkmcnt(12)
    ds_read_b64_tr_b16 a[160:161], v23 offset:32768
    v_mfma_f32_16x16x32_bf16 v[192:195], a[212:215], v[132:135], v[192:195]
    s_waitcnt lgkmcnt(11)
    ds_read_b64_tr_b16 a[162:163], v23 offset:36864
    v_mfma_f32_16x16x32_bf16 v[192:195], a[216:219], v[136:139], v[192:195]
    s_waitcnt lgkmcnt(10)
    ds_read_b64_tr_b16 a[164:165], v23 offset:40960
    v_mfma_f32_16x16x32_bf16 v[192:195], a[220:223], v[140:143], v[192:195]
    s_waitcnt lgkmcnt(9)
    ds_read_b64_tr_b16 a[166:167], v23 offset:45056
    v_mfma_f32_16x16x32_bf16 v[192:195], a[224:227], v[144:147], v[192:195]
    s_waitcnt lgkmcnt(8)
    ds_read_b64_tr_b16 a[168:169], v23 offset:49152
    v_cvt_pk_bf16_f32 v230, v204, v205
    v_mfma_f32_16x16x32_bf16 v[192:195], a[228:231], v[148:151], v[192:195]
    s_waitcnt lgkmcnt(7)
    s_add_u32 s38, s47, 295936
    ds_read_b64_tr_b16 a[170:171], v23 offset:53248
    v_cvt_pk_bf16_f32 v231, v206, v207
    v_mfma_f32_16x16x32_bf16 v[192:195], a[232:235], v[152:155], v[192:195]
    s_waitcnt lgkmcnt(6)
    buffer_store_dwordx4 v[228:231], v56, s[28:31], s38 offen sc1
    v_mfma_f32_16x16x32_bf16 v[192:195], a[236:239], v[156:159], v[192:195]
    ds_read_b64_tr_b16 a[172:173], v23 offset:57344
    ds_read_b64_tr_b16 a[174:175], v23 offset:61440
    v_mfma_f32_16x16x32_bf16 v[196:199], a[208:211], v[160:163], 0
    ds_read_b64_tr_b16 a[176:177], v27 offset:32768
    v_mfma_f32_16x16x32_bf16 v[196:199], a[212:215], v[164:167], v[196:199]
    ds_read_b64_tr_b16 a[178:179], v27 offset:36864
    v_mfma_f32_16x16x32_bf16 v[196:199], a[216:219], v[168:171], v[196:199]
    ds_read_b64_tr_b16 a[180:181], v27 offset:40960
    v_mfma_f32_16x16x32_bf16 v[196:199], a[220:223], v[172:175], v[196:199]
    ds_read_b64_tr_b16 a[182:183], v27 offset:45056
    v_mfma_f32_16x16x32_bf16 v[196:199], a[224:227], v[176:179], v[196:199]
    ds_read_b64_tr_b16 a[184:185], v27 offset:49152
    v_cvt_pk_bf16_f32 v232, v192, v193
    v_mfma_f32_16x16x32_bf16 v[196:199], a[228:231], v[180:183], v[196:199]
    ds_read_b64_tr_b16 a[186:187], v27 offset:53248
    v_cvt_pk_bf16_f32 v233, v194, v195
    v_mfma_f32_16x16x32_bf16 v[196:199], a[232:235], v[184:187], v[196:199]
    ds_read_b64_tr_b16 a[188:189], v27 offset:57344
    v_mfma_f32_16x16x32_bf16 v[196:199], a[236:239], v[188:191], v[196:199]
    ds_read_b64_tr_b16 a[190:191], v27 offset:61440
    s_waitcnt vmcnt(26)
    s_waitcnt lgkmcnt(0)
    s_barrier
    v_mfma_f32_16x16x32_bf16 v[200:203], a[160:163], v[128:131], 0
    ds_read_b64_tr_b16 a[208:209], v28 offset:0
    v_mfma_f32_16x16x32_bf16 v[200:203], a[164:167], v[132:135], v[200:203]
    ds_read_b64_tr_b16 a[210:211], v28 offset:4096
    v_mfma_f32_16x16x32_bf16 v[200:203], a[168:171], v[136:139], v[200:203]
    ds_read_b64_tr_b16 a[212:213], v28 offset:8192
    v_mfma_f32_16x16x32_bf16 v[200:203], a[172:175], v[140:143], v[200:203]
    ds_read_b64_tr_b16 a[214:215], v28 offset:12288
    v_mfma_f32_16x16x32_bf16 v[200:203], a[176:179], v[144:147], v[200:203]
    ds_read_b64_tr_b16 a[216:217], v28 offset:16384
    v_cvt_pk_bf16_f32 v236, v196, v197
    v_mfma_f32_16x16x32_bf16 v[200:203], a[180:183], v[148:151], v[200:203]
    ds_read_b64_tr_b16 a[218:219], v28 offset:20480
    v_cvt_pk_bf16_f32 v237, v198, v199
    v_mfma_f32_16x16x32_bf16 v[200:203], a[184:187], v[152:155], v[200:203]
    s_add_u32 s49, s45, 1024
    ds_read_b64_tr_b16 a[220:221], v28 offset:24576
    v_mfma_f32_16x16x32_bf16 v[200:203], a[188:191], v[156:159], v[200:203]
    s_add_u32 m0, s42, 65536
    ds_read_b64_tr_b16 a[222:223], v28 offset:28672
    v_mfma_f32_16x16x32_bf16 v[204:207], a[160:163], v[160:163], 0
    buffer_load_dwordx4 v46, s[20:23], s49 offen lds
    v_mfma_f32_16x16x32_bf16 v[204:207], a[164:167], v[164:167], v[204:207]
    ds_read_b64_tr_b16 a[224:225], v32 offset:0
    ds_read_b64_tr_b16 a[226:227], v32 offset:4096
    v_mfma_f32_16x16x32_bf16 v[204:207], a[168:171], v[168:171], v[204:207]
    buffer_load_dwordx4 v47, s[20:23], s49 offen offset:1024 lds
    v_mfma_f32_16x16x32_bf16 v[204:207], a[172:175], v[172:175], v[204:207]
    ds_read_b64_tr_b16 a[228:229], v32 offset:8192
    ds_read_b64_tr_b16 a[230:231], v32 offset:12288
    v_mfma_f32_16x16x32_bf16 v[204:207], a[176:179], v[176:179], v[204:207]
    ds_read_b64_tr_b16 a[232:233], v32 offset:16384
    v_cvt_pk_bf16_f32 v234, v200, v201
    v_mfma_f32_16x16x32_bf16 v[204:207], a[180:183], v[180:183], v[204:207]
    s_add_u32 s38, s47, 1152
    ds_read_b64_tr_b16 a[234:235], v32 offset:20480
    v_cvt_pk_bf16_f32 v235, v202, v203
    v_mfma_f32_16x16x32_bf16 v[204:207], a[184:187], v[184:187], v[204:207]
    buffer_store_dwordx4 v[232:235], v56, s[28:31], s38 offen sc1
    v_mfma_f32_16x16x32_bf16 v[204:207], a[188:191], v[188:191], v[204:207]
    s_waitcnt lgkmcnt(12)
    ds_read_b64_tr_b16 a[236:237], v32 offset:24576
    ds_read_b64_tr_b16 a[238:239], v32 offset:28672
    v_mfma_f32_16x16x32_bf16 v[192:195], a[208:211], v[128:131], 0
    s_waitcnt lgkmcnt(12)
    buffer_load_dwordx4 v48, s[20:23], s49 offen offset:2048 lds
    v_mfma_f32_16x16x32_bf16 v[192:195], a[212:215], v[132:135], v[192:195]
    s_waitcnt lgkmcnt(10)
    ds_read_b64_tr_b16 a[160:161], v29 offset:0
    ds_read_b64_tr_b16 a[162:163], v29 offset:4096
    v_mfma_f32_16x16x32_bf16 v[192:195], a[216:219], v[136:139], v[192:195]
    s_waitcnt lgkmcnt(10)
    buffer_load_dwordx4 v49, s[20:23], s49 offen offset:3072 lds
    v_mfma_f32_16x16x32_bf16 v[192:195], a[220:223], v[140:143], v[192:195]
    s_waitcnt lgkmcnt(8)
    ds_read_b64_tr_b16 a[164:165], v29 offset:8192
    ds_read_b64_tr_b16 a[166:167], v29 offset:12288
    v_mfma_f32_16x16x32_bf16 v[192:195], a[224:227], v[144:147], v[192:195]
    s_waitcnt lgkmcnt(8)
    ds_read_b64_tr_b16 a[168:169], v29 offset:16384
    v_cvt_pk_bf16_f32 v238, v204, v205
    v_mfma_f32_16x16x32_bf16 v[192:195], a[228:231], v[148:151], v[192:195]
    s_waitcnt lgkmcnt(7)
    s_add_u32 s38, s47, 296064
    ds_read_b64_tr_b16 a[170:171], v29 offset:20480
    v_cvt_pk_bf16_f32 v239, v206, v207
    v_mfma_f32_16x16x32_bf16 v[192:195], a[232:235], v[152:155], v[192:195]
    s_waitcnt lgkmcnt(6)
    s_add_u32 s49, s45, 74752
    buffer_store_dwordx4 v[236:239], v56, s[28:31], s38 offen sc1
    v_mfma_f32_16x16x32_bf16 v[192:195], a[236:239], v[156:159], v[192:195]
    s_add_u32 m0, s42, 81920
    ds_read_b64_tr_b16 a[172:173], v29 offset:24576
    ds_read_b64_tr_b16 a[174:175], v29 offset:28672
    v_mfma_f32_16x16x32_bf16 v[196:199], a[208:211], v[160:163], 0
    buffer_load_dwordx4 v46, s[20:23], s49 offen lds
    v_mfma_f32_16x16x32_bf16 v[196:199], a[212:215], v[164:167], v[196:199]
    ds_read_b64_tr_b16 a[176:177], v33 offset:0
    ds_read_b64_tr_b16 a[178:179], v33 offset:4096
    v_mfma_f32_16x16x32_bf16 v[196:199], a[216:219], v[168:171], v[196:199]
    buffer_load_dwordx4 v47, s[20:23], s49 offen offset:1024 lds
    v_mfma_f32_16x16x32_bf16 v[196:199], a[220:223], v[172:175], v[196:199]
    ds_read_b64_tr_b16 a[180:181], v33 offset:8192
    ds_read_b64_tr_b16 a[182:183], v33 offset:12288
    v_mfma_f32_16x16x32_bf16 v[196:199], a[224:227], v[176:179], v[196:199]
    ds_read_b64_tr_b16 a[184:185], v33 offset:16384
    v_cvt_pk_bf16_f32 v224, v192, v193
    v_mfma_f32_16x16x32_bf16 v[196:199], a[228:231], v[180:183], v[196:199]
    ds_read_b64_tr_b16 a[186:187], v33 offset:20480
    v_cvt_pk_bf16_f32 v225, v194, v195
    v_mfma_f32_16x16x32_bf16 v[196:199], a[232:235], v[184:187], v[196:199]
    ds_read_b64_tr_b16 a[188:189], v33 offset:24576
    v_mfma_f32_16x16x32_bf16 v[196:199], a[236:239], v[188:191], v[196:199]
    s_waitcnt lgkmcnt(13)
    ds_read_b64_tr_b16 a[190:191], v33 offset:28672
    v_mfma_f32_16x16x32_bf16 v[200:203], a[160:163], v[128:131], 0
    s_waitcnt lgkmcnt(12)
    buffer_load_dwordx4 v48, s[20:23], s49 offen offset:2048 lds
    v_mfma_f32_16x16x32_bf16 v[200:203], a[164:167], v[132:135], v[200:203]
    s_waitcnt lgkmcnt(10)
    ds_read_b64_tr_b16 a[208:209], v30 offset:0
    ds_read_b64_tr_b16 a[210:211], v30 offset:4096
    v_mfma_f32_16x16x32_bf16 v[200:203], a[168:171], v[136:139], v[200:203]
    s_waitcnt lgkmcnt(10)
    buffer_load_dwordx4 v49, s[20:23], s49 offen offset:3072 lds
    v_mfma_f32_16x16x32_bf16 v[200:203], a[172:175], v[140:143], v[200:203]
    s_waitcnt lgkmcnt(8)
    ds_read_b64_tr_b16 a[212:213], v30 offset:8192
    ds_read_b64_tr_b16 a[214:215], v30 offset:12288
    v_mfma_f32_16x16x32_bf16 v[200:203], a[176:179], v[144:147], v[200:203]
    s_waitcnt lgkmcnt(8)
    ds_read_b64_tr_b16 a[216:217], v30 offset:16384
    v_cvt_pk_bf16_f32 v228, v196, v197
    v_mfma_f32_16x16x32_bf16 v[200:203], a[180:183], v[148:151], v[200:203]
    s_waitcnt lgkmcnt(7)
    ds_read_b64_tr_b16 a[218:219], v30 offset:20480
    v_cvt_pk_bf16_f32 v229, v198, v199
    v_mfma_f32_16x16x32_bf16 v[200:203], a[184:187], v[152:155], v[200:203]
    s_waitcnt lgkmcnt(6)
    s_lshl_b32 s40, s5, 4
    ds_read_b64_tr_b16 a[220:221], v30 offset:24576
    v_mfma_f32_16x16x32_bf16 v[200:203], a[188:191], v[156:159], v[200:203]
    s_add_u32 s40, s40, s4
    ds_read_b64_tr_b16 a[222:223], v30 offset:28672
    v_and_b32 v240, 31, v1
    v_mfma_f32_16x16x32_bf16 v[204:207], a[160:163], v[160:163], 0
    ds_read_b64_tr_b16 a[224:225], v34 offset:0
    v_lshrrev_b32 v241, 5, v1
    v_mfma_f32_16x16x32_bf16 v[204:207], a[164:167], v[164:167], v[204:207]
    ds_read_b64_tr_b16 a[226:227], v34 offset:4096
    v_cmp_gt_u32 vcc, 24, v240
    v_mfma_f32_16x16x32_bf16 v[204:207], a[168:171], v[168:171], v[204:207]
    ds_read_b64_tr_b16 a[228:229], v34 offset:8192
    v_mov_b32 v242, 2147483648
    v_mfma_f32_16x16x32_bf16 v[204:207], a[172:175], v[172:175], v[204:207]
    s_lshl_b32 s43, s40, 3
    ds_read_b64_tr_b16 a[230:231], v34 offset:12288
    v_mfma_f32_16x16x32_bf16 v[204:207], a[176:179], v[176:179], v[204:207]
    ds_read_b64_tr_b16 a[232:233], v34 offset:16384
    v_cvt_pk_bf16_f32 v226, v200, v201
    v_mfma_f32_16x16x32_bf16 v[204:207], a[180:183], v[180:183], v[204:207]
    s_add_u32 s38, s47, 1280
    ds_read_b64_tr_b16 a[234:235], v34 offset:20480
    v_cvt_pk_bf16_f32 v227, v202, v203
    v_mfma_f32_16x16x32_bf16 v[204:207], a[184:187], v[184:187], v[204:207]
    buffer_store_dwordx4 v[224:227], v56, s[28:31], s38 offen sc1
    v_mfma_f32_16x16x32_bf16 v[204:207], a[188:191], v[188:191], v[204:207]
    s_waitcnt lgkmcnt(12)
    s_lshl_b32 s44, s3, 1
    ds_read_b64_tr_b16 a[236:237], v34 offset:24576
    ds_read_b64_tr_b16 a[238:239], v34 offset:28672
    v_mfma_f32_16x16x32_bf16 v[192:195], a[208:211], v[128:131], 0
    s_waitcnt lgkmcnt(12)
    s_add_u32 s43, s43, s44
    ds_read_b64_tr_b16 a[160:161], v31 offset:0
    v_cndmask_b32 v242, v242, 0, vcc
    v_mfma_f32_16x16x32_bf16 v[192:195], a[212:215], v[132:135], v[192:195]
    s_waitcnt lgkmcnt(11)
    ds_read_b64_tr_b16 a[162:163], v31 offset:4096
    v_add_u32 v7, s43, v241
    v_mfma_f32_16x16x32_bf16 v[192:195], a[216:219], v[136:139], v[192:195]
    s_waitcnt lgkmcnt(10)
    ds_read_b64_tr_b16 a[164:165], v31 offset:8192
    v_lshl_add_u32 v5, v240, 4, v242
    v_mfma_f32_16x16x32_bf16 v[192:195], a[220:223], v[140:143], v[192:195]
    s_waitcnt lgkmcnt(9)
    ds_read_b64_tr_b16 a[166:167], v31 offset:12288
    v_lshl_add_u32 v243, v241, 4, v242
    v_mfma_f32_16x16x32_bf16 v[192:195], a[224:227], v[144:147], v[192:195]
    s_waitcnt lgkmcnt(8)
    ds_read_b64_tr_b16 a[168:169], v31 offset:16384
    v_cvt_pk_bf16_f32 v230, v204, v205
    v_mfma_f32_16x16x32_bf16 v[192:195], a[228:231], v[148:151], v[192:195]
    s_waitcnt lgkmcnt(7)
    s_add_u32 s38, s47, 296192
    ds_read_b64_tr_b16 a[170:171], v31 offset:20480
    v_cvt_pk_bf16_f32 v231, v206, v207
    v_mfma_f32_16x16x32_bf16 v[192:195], a[232:235], v[152:155], v[192:195]
    s_waitcnt lgkmcnt(6)
    buffer_store_dwordx4 v[228:231], v56, s[28:31], s38 offen sc1
    v_mfma_f32_16x16x32_bf16 v[192:195], a[236:239], v[156:159], v[192:195]
    ds_read_b64_tr_b16 a[172:173], v31 offset:24576
    ds_read_b64_tr_b16 a[174:175], v31 offset:28672
    v_mfma_f32_16x16x32_bf16 v[196:199], a[208:211], v[160:163], 0
    ds_read_b64_tr_b16 a[176:177], v35 offset:0
    v_lshl_add_u32 v2, v240, 5, v243
    v_mfma_f32_16x16x32_bf16 v[196:199], a[212:215], v[164:167], v[196:199]
    s_mul_i32 s44, s43, 18432
    ds_read_b64_tr_b16 a[178:179], v35 offset:4096
    v_lshrrev_b32 v243, 2, v240
    v_mfma_f32_16x16x32_bf16 v[196:199], a[216:219], v[168:171], v[196:199]
    ds_read_b64_tr_b16 a[180:181], v35 offset:8192
    v_lshl_add_u32 v243, v243, 6, v242
    v_mfma_f32_16x16x32_bf16 v[196:199], a[220:223], v[172:175], v[196:199]
    ds_read_b64_tr_b16 a[182:183], v35 offset:12288
    v_and_b32 v241, 3, v240
    v_mfma_f32_16x16x32_bf16 v[196:199], a[224:227], v[176:179], v[196:199]
    ds_read_b64_tr_b16 a[184:185], v35 offset:16384
    v_cvt_pk_bf16_f32 v232, v192, v193
    v_mfma_f32_16x16x32_bf16 v[196:199], a[228:231], v[180:183], v[196:199]
    ds_read_b64_tr_b16 a[186:187], v35 offset:20480
    v_cvt_pk_bf16_f32 v233, v194, v195
    v_mfma_f32_16x16x32_bf16 v[196:199], a[232:235], v[184:187], v[196:199]
    ds_read_b64_tr_b16 a[188:189], v35 offset:24576
    v_lshl_add_u32 v3, v241, 3, v243
    v_mfma_f32_16x16x32_bf16 v[196:199], a[236:239], v[188:191], v[196:199]
    s_waitcnt lgkmcnt(13)
    ds_read_b64_tr_b16 a[190:191], v35 offset:28672
    v_mul_u32_u24 v243, 1152, v7
    s_waitcnt vmcnt(26)
    s_barrier
    v_mfma_f32_16x16x32_bf16 v[200:203], a[160:163], v[128:131], 0
    s_waitcnt lgkmcnt(12)
    ds_read_b64_tr_b16 a[208:209], v12 offset:0
    v_add_u32 v4, v243, v3
    v_mfma_f32_16x16x32_bf16 v[200:203], a[164:167], v[132:135], v[200:203]
    s_waitcnt lgkmcnt(11)
    ds_read_b64_tr_b16 a[210:211], v12 offset:4096
    v_add_u32 v6, v243, v5
    v_mfma_f32_16x16x32_bf16 v[200:203], a[168:171], v[136:139], v[200:203]
    s_waitcnt lgkmcnt(10)
    s_lshr_b32 s41, s2, 3
    ds_read_b64_tr_b16 a[212:213], v12 offset:8192
    v_mfma_f32_16x16x32_bf16 v[200:203], a[172:175], v[140:143], v[200:203]
    s_waitcnt lgkmcnt(9)
    s_and_b32 s42, s2, 7
    ds_read_b64_tr_b16 a[214:215], v12 offset:12288
    v_mfma_f32_16x16x32_bf16 v[200:203], a[176:179], v[144:147], v[200:203]
    s_waitcnt lgkmcnt(8)
    ds_read_b64_tr_b16 a[216:217], v12 offset:16384
    v_cvt_pk_bf16_f32 v236, v196, v197
    v_mfma_f32_16x16x32_bf16 v[200:203], a[180:183], v[148:151], v[200:203]
    s_waitcnt lgkmcnt(7)
    ds_read_b64_tr_b16 a[218:219], v12 offset:20480
    v_cvt_pk_bf16_f32 v237, v198, v199
    v_mfma_f32_16x16x32_bf16 v[200:203], a[184:187], v[152:155], v[200:203]
    s_waitcnt lgkmcnt(6)
    s_mov_b32 s14, 2359296
    ds_read_b64_tr_b16 a[220:221], v12 offset:24576
    v_mfma_f32_16x16x32_bf16 v[200:203], a[188:191], v[156:159], v[200:203]
    s_mov_b32 s15, 0x20000
    ds_read_b64_tr_b16 a[222:223], v12 offset:28672
    v_mfma_f32_16x16x32_bf16 v[204:207], a[160:163], v[160:163], 0
    s_mov_b32 s18, 2359296
    ds_read_b64_tr_b16 a[224:225], v16 offset:0
    v_mfma_f32_16x16x32_bf16 v[204:207], a[164:167], v[164:167], v[204:207]
    s_mov_b32 s19, 0x20000
    ds_read_b64_tr_b16 a[226:227], v16 offset:4096
    v_mfma_f32_16x16x32_bf16 v[204:207], a[168:171], v[168:171], v[204:207]
    s_mov_b32 s22, 1152
    ds_read_b64_tr_b16 a[228:229], v16 offset:8192
    v_mfma_f32_16x16x32_bf16 v[204:207], a[172:175], v[172:175], v[204:207]
    s_mov_b32 s23, 0x20000
    ds_read_b64_tr_b16 a[230:231], v16 offset:12288
    v_mfma_f32_16x16x32_bf16 v[204:207], a[176:179], v[176:179], v[204:207]
    ds_read_b64_tr_b16 a[232:233], v16 offset:16384
    v_cvt_pk_bf16_f32 v234, v200, v201
    v_mfma_f32_16x16x32_bf16 v[204:207], a[180:183], v[180:183], v[204:207]
    s_add_u32 s38, s47, 1408
    ds_read_b64_tr_b16 a[234:235], v16 offset:20480
    v_cvt_pk_bf16_f32 v235, v202, v203
    v_mfma_f32_16x16x32_bf16 v[204:207], a[184:187], v[184:187], v[204:207]
    buffer_store_dwordx4 v[232:235], v56, s[28:31], s38 offen sc1
    v_mfma_f32_16x16x32_bf16 v[204:207], a[188:191], v[188:191], v[204:207]
    s_waitcnt lgkmcnt(12)
    s_mov_b64 s[20:21], s[52:53]
    ds_read_b64_tr_b16 a[236:237], v16 offset:24576
    ds_read_b64_tr_b16 a[238:239], v16 offset:28672
    v_mfma_f32_16x16x32_bf16 v[192:195], a[208:211], v[128:131], 0
    s_waitcnt lgkmcnt(12)
    s_add_u32 s8, s50, 7864320
    s_addc_u32 s9, s51, 0
    ds_read_b64_tr_b16 a[160:161], v13 offset:0
    v_mfma_f32_16x16x32_bf16 v[192:195], a[212:215], v[132:135], v[192:195]
    s_waitcnt lgkmcnt(11)
    s_mov_b32 s10, 663552
    ds_read_b64_tr_b16 a[162:163], v13 offset:4096
    v_mfma_f32_16x16x32_bf16 v[192:195], a[216:219], v[136:139], v[192:195]
    s_waitcnt lgkmcnt(10)
    s_mov_b32 s11, 0x20000
    ds_read_b64_tr_b16 a[164:165], v13 offset:8192
    v_mfma_f32_16x16x32_bf16 v[192:195], a[220:223], v[140:143], v[192:195]
    s_waitcnt lgkmcnt(9)
    s_lshl_b32 s93, s5, 13
    ds_read_b64_tr_b16 a[166:167], v13 offset:12288
    v_mfma_f32_16x16x32_bf16 v[192:195], a[224:227], v[144:147], v[192:195]
    s_waitcnt lgkmcnt(8)
    ds_read_b64_tr_b16 a[168:169], v13 offset:16384
    v_cvt_pk_bf16_f32 v238, v204, v205
    v_mfma_f32_16x16x32_bf16 v[192:195], a[228:231], v[148:151], v[192:195]
    s_waitcnt lgkmcnt(7)
    s_add_u32 s38, s47, 296320
    ds_read_b64_tr_b16 a[170:171], v13 offset:20480
    v_cvt_pk_bf16_f32 v239, v206, v207
    v_mfma_f32_16x16x32_bf16 v[192:195], a[232:235], v[152:155], v[192:195]
    s_waitcnt lgkmcnt(6)
    buffer_store_dwordx4 v[236:239], v56, s[28:31], s38 offen sc1
    v_mfma_f32_16x16x32_bf16 v[192:195], a[236:239], v[156:159], v[192:195]
    s_add_u32 s93, s93, 8781824
    ds_read_b64_tr_b16 a[172:173], v13 offset:24576
    ds_read_b64_tr_b16 a[174:175], v13 offset:28672
    v_mfma_f32_16x16x32_bf16 v[196:199], a[208:211], v[160:163], 0
    s_lshl_b32 s45, s3, 11
    ds_read_b64_tr_b16 a[176:177], v17 offset:0
    v_mfma_f32_16x16x32_bf16 v[196:199], a[212:215], v[164:167], v[196:199]
    s_add_u32 s92, s93, s45
    ds_read_b64_tr_b16 a[178:179], v17 offset:4096
    v_mfma_f32_16x16x32_bf16 v[196:199], a[216:219], v[168:171], v[196:199]
    s_lshl_b32 s45, s4, 7
    ds_read_b64_tr_b16 a[180:181], v17 offset:8192
    v_mfma_f32_16x16x32_bf16 v[196:199], a[220:223], v[172:175], v[196:199]
    s_add_u32 s92, s92, s45
    ds_read_b64_tr_b16 a[182:183], v17 offset:12288
    v_mfma_f32_16x16x32_bf16 v[196:199], a[224:227], v[176:179], v[196:199]
    ds_read_b64_tr_b16 a[184:185], v17 offset:16384
    v_cvt_pk_bf16_f32 v224, v192, v193
    v_mfma_f32_16x16x32_bf16 v[196:199], a[228:231], v[180:183], v[196:199]
Ltour10:
    s_cbranch_execz Ltour14
    ds_read_b64_tr_b16 a[186:187], v17 offset:20480
    v_cvt_pk_bf16_f32 v225, v194, v195
    v_mfma_f32_16x16x32_bf16 v[196:199], a[232:235], v[184:187], v[196:199]
    s_lshr_b32 s45, s4, 2
    ds_read_b64_tr_b16 a[188:189], v17 offset:24576
    v_mfma_f32_16x16x32_bf16 v[196:199], a[236:239], v[188:191], v[196:199]
    s_waitcnt lgkmcnt(13)
    s_lshl_b32 s45, s45, 11
    ds_read_b64_tr_b16 a[190:191], v17 offset:28672
    v_mfma_f32_16x16x32_bf16 v[200:203], a[160:163], v[128:131], 0
    s_waitcnt lgkmcnt(12)
    s_add_u32 s93, s93, s45
    ds_read_b64_tr_b16 a[208:209], v14 offset:0
    v_min_u32 v8, 1, v1
    v_mfma_f32_16x16x32_bf16 v[200:203], a[164:167], v[132:135], v[200:203]
    s_waitcnt lgkmcnt(11)
    ds_read_b64_tr_b16 a[210:211], v14 offset:4096
    v_lshlrev_b32 v8, 31, v8
    v_mfma_f32_16x16x32_bf16 v[200:203], a[168:171], v[136:139], v[200:203]
    s_waitcnt lgkmcnt(10)
    ds_read_b64_tr_b16 a[212:213], v14 offset:8192
    v_and_b32 v9, 15, v1
    v_mfma_f32_16x16x32_bf16 v[200:203], a[172:175], v[140:143], v[200:203]
    s_waitcnt lgkmcnt(9)
    ds_read_b64_tr_b16 a[214:215], v14 offset:12288
    v_lshlrev_b32 v9, 7, v9
    v_mfma_f32_16x16x32_bf16 v[200:203], a[176:179], v[144:147], v[200:203]
    s_waitcnt lgkmcnt(8)
    ds_read_b64_tr_b16 a[216:217], v14 offset:16384
    v_cvt_pk_bf16_f32 v228, v196, v197
    v_mfma_f32_16x16x32_bf16 v[200:203], a[180:183], v[148:151], v[200:203]
    s_waitcnt lgkmcnt(7)
    ds_read_b64_tr_b16 a[218:219], v14 offset:20480
    v_cvt_pk_bf16_f32 v229, v198, v199
    v_mfma_f32_16x16x32_bf16 v[200:203], a[184:187], v[152:155], v[200:203]
    s_waitcnt lgkmcnt(6)
    ds_read_b64_tr_b16 a[220:221], v14 offset:24576
    v_mov_b32 v10, s95
    v_mfma_f32_16x16x32_bf16 v[200:203], a[188:191], v[156:159], v[200:203]
    ds_read_b64_tr_b16 a[222:223], v14 offset:28672
    v_lshrrev_b32 v240, 4, v1
    v_mfma_f32_16x16x32_bf16 v[204:207], a[160:163], v[160:163], 0
    ds_read_b64_tr_b16 a[224:225], v18 offset:0
    v_bfe_u32 v241, v1, 2, 2
    v_mfma_f32_16x16x32_bf16 v[204:207], a[164:167], v[164:167], v[204:207]
    ds_read_b64_tr_b16 a[226:227], v18 offset:4096
    v_cmp_eq_u32 s[54:55], v240, v241
    v_mfma_f32_16x16x32_bf16 v[204:207], a[168:171], v[168:171], v[204:207]
    ds_read_b64_tr_b16 a[228:229], v18 offset:8192
    v_and_b32 v240, 1, v1
    v_mfma_f32_16x16x32_bf16 v[204:207], a[172:175], v[172:175], v[204:207]
    ds_read_b64_tr_b16 a[230:231], v18 offset:12288
    v_lshlrev_b32 v240, 4, v240
    v_mfma_f32_16x16x32_bf16 v[204:207], a[176:179], v[176:179], v[204:207]
    ds_read_b64_tr_b16 a[232:233], v18 offset:16384
    v_cvt_pk_bf16_f32 v226, v200, v201
    v_mfma_f32_16x16x32_bf16 v[204:207], a[180:183], v[180:183], v[204:207]
    s_add_u32 s38, s47, 1536
    ds_read_b64_tr_b16 a[234:235], v18 offset:20480
    v_cvt_pk_bf16_f32 v227, v202, v203
    v_mfma_f32_16x16x32_bf16 v[204:207], a[184:187], v[184:187], v[204:207]
    buffer_store_dwordx4 v[224:227], v56, s[28:31], s38 offen sc1
    v_mfma_f32_16x16x32_bf16 v[204:207], a[188:191], v[188:191], v[204:207]
    s_waitcnt lgkmcnt(12)
    ds_read_b64_tr_b16 a[236:237], v18 offset:24576
    ds_read_b64_tr_b16 a[238:239], v18 offset:28672
    v_mfma_f32_16x16x32_bf16 v[192:195], a[208:211], v[128:131], 0
    s_waitcnt lgkmcnt(12)
    ds_read_b64_tr_b16 a[160:161], v15 offset:0
    v_mov_b32 v241, 0x3f80
    v_mfma_f32_16x16x32_bf16 v[192:195], a[212:215], v[132:135], v[192:195]
    s_waitcnt lgkmcnt(11)
    ds_read_b64_tr_b16 a[162:163], v15 offset:4096
    v_lshlrev_b32 v240, v240, v241
    v_mfma_f32_16x16x32_bf16 v[192:195], a[216:219], v[136:139], v[192:195]
    s_waitcnt lgkmcnt(10)
    ds_read_b64_tr_b16 a[164:165], v15 offset:8192
    v_cndmask_b32 v240, 0, v240, s[54:55]
    v_mfma_f32_16x16x32_bf16 v[192:195], a[220:223], v[140:143], v[192:195]
    s_waitcnt lgkmcnt(9)
    ds_read_b64_tr_b16 a[166:167], v15 offset:12288
    v_bfe_i32 v241, v1, 1, 1
    v_mfma_f32_16x16x32_bf16 v[192:195], a[224:227], v[144:147], v[192:195]
    s_waitcnt lgkmcnt(8)
    ds_read_b64_tr_b16 a[168:169], v15 offset:16384
    v_cvt_pk_bf16_f32 v230, v204, v205
    v_mfma_f32_16x16x32_bf16 v[192:195], a[228:231], v[148:151], v[192:195]
    s_waitcnt lgkmcnt(7)
    s_add_u32 s38, s47, 296448
    ds_read_b64_tr_b16 a[170:171], v15 offset:20480
    v_cvt_pk_bf16_f32 v231, v206, v207
    v_mfma_f32_16x16x32_bf16 v[192:195], a[232:235], v[152:155], v[192:195]
    s_waitcnt lgkmcnt(6)
    buffer_store_dwordx4 v[228:231], v56, s[28:31], s38 offen sc1
    v_mfma_f32_16x16x32_bf16 v[192:195], a[236:239], v[156:159], v[192:195]
    ds_read_b64_tr_b16 a[172:173], v15 offset:24576
    ds_read_b64_tr_b16 a[174:175], v15 offset:28672
    v_mfma_f32_16x16x32_bf16 v[196:199], a[208:211], v[160:163], 0
    ds_read_b64_tr_b16 a[176:177], v19 offset:0
    v_mov_b32 v248, 0
    v_mfma_f32_16x16x32_bf16 v[196:199], a[212:215], v[164:167], v[196:199]
    ds_read_b64_tr_b16 a[178:179], v19 offset:4096
    v_mov_b32 v249, 0
    v_mfma_f32_16x16x32_bf16 v[196:199], a[216:219], v[168:171], v[196:199]
    ds_read_b64_tr_b16 a[180:181], v19 offset:8192
    v_mov_b32 v252, 0
    v_mfma_f32_16x16x32_bf16 v[196:199], a[220:223], v[172:175], v[196:199]
    ds_read_b64_tr_b16 a[182:183], v19 offset:12288
    v_mov_b32 v253, 0
    v_mfma_f32_16x16x32_bf16 v[196:199], a[224:227], v[176:179], v[196:199]
    ds_read_b64_tr_b16 a[184:185], v19 offset:16384
    v_cvt_pk_bf16_f32 v232, v192, v193
    v_mfma_f32_16x16x32_bf16 v[196:199], a[228:231], v[180:183], v[196:199]
    ds_read_b64_tr_b16 a[186:187], v19 offset:20480
    v_cvt_pk_bf16_f32 v233, v194, v195
    v_mfma_f32_16x16x32_bf16 v[196:199], a[232:235], v[184:187], v[196:199]
    ds_read_b64_tr_b16 a[188:189], v19 offset:24576
    v_and_b32 v251, v240, v241
    v_mfma_f32_16x16x32_bf16 v[196:199], a[236:239], v[188:191], v[196:199]
    s_waitcnt lgkmcnt(13)
    ds_read_b64_tr_b16 a[190:191], v19 offset:28672
    v_xor_b32 v250, v240, v251
    s_waitcnt vmcnt(18)
    s_barrier
    v_mfma_f32_16x16x32_bf16 v[200:203], a[160:163], v[128:131], 0
    s_waitcnt lgkmcnt(12)
    ds_read_b64_tr_b16 a[208:209], v12 offset:32768
    v_mfma_f32_16x16x32_bf16 v[200:203], a[164:167], v[132:135], v[200:203]
    s_waitcnt lgkmcnt(11)
    s_mov_b32 s45, 18688
    ds_read_b64_tr_b16 a[210:211], v12 offset:36864
    v_mfma_f32_16x16x32_bf16 v[200:203], a[168:171], v[136:139], v[200:203]
    s_waitcnt lgkmcnt(10)
    buffer_load_dwordx4 v[64:67], v5, s[24:27], s45 offen offset:0 sc1
    v_mfma_f32_16x16x32_bf16 v[200:203], a[172:175], v[140:143], v[200:203]
    s_waitcnt lgkmcnt(8)
    ds_read_b64_tr_b16 a[212:213], v12 offset:40960
    ds_read_b64_tr_b16 a[214:215], v12 offset:45056
    v_mfma_f32_16x16x32_bf16 v[200:203], a[176:179], v[144:147], v[200:203]
    s_waitcnt lgkmcnt(8)
    ds_read_b64_tr_b16 a[216:217], v12 offset:49152
    v_cvt_pk_bf16_f32 v236, v196, v197
    v_mfma_f32_16x16x32_bf16 v[200:203], a[180:183], v[148:151], v[200:203]
    s_waitcnt lgkmcnt(7)
    ds_read_b64_tr_b16 a[218:219], v12 offset:53248
    v_cvt_pk_bf16_f32 v237, v198, v199
    v_mfma_f32_16x16x32_bf16 v[200:203], a[184:187], v[152:155], v[200:203]
    s_waitcnt lgkmcnt(6)
    ds_read_b64_tr_b16 a[220:221], v12 offset:57344
    v_mfma_f32_16x16x32_bf16 v[200:203], a[188:191], v[156:159], v[200:203]
    ds_read_b64_tr_b16 a[222:223], v12 offset:61440
    v_mfma_f32_16x16x32_bf16 v[204:207], a[160:163], v[160:163], 0
    buffer_load_dwordx4 v[68:71], v5, s[24:27], s45 offen offset:384 sc1
    v_mfma_f32_16x16x32_bf16 v[204:207], a[164:167], v[164:167], v[204:207]
    ds_read_b64_tr_b16 a[224:225], v16 offset:32768
    ds_read_b64_tr_b16 a[226:227], v16 offset:36864
    v_mfma_f32_16x16x32_bf16 v[204:207], a[168:171], v[168:171], v[204:207]
    buffer_load_dwordx4 v[72:75], v5, s[24:27], s45 offen offset:768 sc1
    v_mfma_f32_16x16x32_bf16 v[204:207], a[172:175], v[172:175], v[204:207]
    ds_read_b64_tr_b16 a[228:229], v16 offset:40960
    ds_read_b64_tr_b16 a[230:231], v16 offset:45056
    v_mfma_f32_16x16x32_bf16 v[204:207], a[176:179], v[176:179], v[204:207]
    ds_read_b64_tr_b16 a[232:233], v16 offset:49152
    v_cvt_pk_bf16_f32 v234, v200, v201
    v_mfma_f32_16x16x32_bf16 v[204:207], a[180:183], v[180:183], v[204:207]
    s_add_u32 s38, s47, 1664
    ds_read_b64_tr_b16 a[234:235], v16 offset:53248
    v_cvt_pk_bf16_f32 v235, v202, v203
    v_mfma_f32_16x16x32_bf16 v[204:207], a[184:187], v[184:187], v[204:207]
    buffer_store_dwordx4 v[232:235], v56, s[28:31], s38 offen sc1
    v_mfma_f32_16x16x32_bf16 v[204:207], a[188:191], v[188:191], v[204:207]
    s_waitcnt lgkmcnt(12)
    s_mov_b32 s45, 20992
    ds_read_b64_tr_b16 a[236:237], v16 offset:57344
    ds_read_b64_tr_b16 a[238:239], v16 offset:61440
    v_mfma_f32_16x16x32_bf16 v[192:195], a[208:211], v[128:131], 0
    s_waitcnt lgkmcnt(12)
    buffer_load_dwordx4 v[76:79], v5, s[24:27], s45 offen offset:0 sc1
    v_mfma_f32_16x16x32_bf16 v[192:195], a[212:215], v[132:135], v[192:195]
    s_waitcnt lgkmcnt(10)
    ds_read_b64_tr_b16 a[160:161], v13 offset:32768
    ds_read_b64_tr_b16 a[162:163], v13 offset:36864
    v_mfma_f32_16x16x32_bf16 v[192:195], a[216:219], v[136:139], v[192:195]
    s_waitcnt lgkmcnt(10)
    buffer_load_dwordx4 v[80:83], v5, s[24:27], s45 offen offset:384 sc1
    v_mfma_f32_16x16x32_bf16 v[192:195], a[220:223], v[140:143], v[192:195]
    s_waitcnt lgkmcnt(8)
    ds_read_b64_tr_b16 a[164:165], v13 offset:40960
    ds_read_b64_tr_b16 a[166:167], v13 offset:45056
    v_mfma_f32_16x16x32_bf16 v[192:195], a[224:227], v[144:147], v[192:195]
    s_waitcnt lgkmcnt(8)
    ds_read_b64_tr_b16 a[168:169], v13 offset:49152
    v_cvt_pk_bf16_f32 v238, v204, v205
    v_mfma_f32_16x16x32_bf16 v[192:195], a[228:231], v[148:151], v[192:195]
    s_waitcnt lgkmcnt(7)
    s_add_u32 s38, s47, 296576
    ds_read_b64_tr_b16 a[170:171], v13 offset:53248
    v_cvt_pk_bf16_f32 v239, v206, v207
    v_mfma_f32_16x16x32_bf16 v[192:195], a[232:235], v[152:155], v[192:195]
    s_waitcnt lgkmcnt(6)
    buffer_store_dwordx4 v[236:239], v56, s[28:31], s38 offen sc1
    v_mfma_f32_16x16x32_bf16 v[192:195], a[236:239], v[156:159], v[192:195]
    ds_read_b64_tr_b16 a[172:173], v13 offset:57344
    ds_read_b64_tr_b16 a[174:175], v13 offset:61440
    v_mfma_f32_16x16x32_bf16 v[196:199], a[208:211], v[160:163], 0
    buffer_load_dwordx4 v[84:87], v5, s[24:27], s45 offen offset:768 sc1
    v_mfma_f32_16x16x32_bf16 v[196:199], a[212:215], v[164:167], v[196:199]
    s_mov_b32 s45, 19840
    ds_read_b64_tr_b16 a[176:177], v17 offset:32768
    ds_read_b64_tr_b16 a[178:179], v17 offset:36864
    v_mfma_f32_16x16x32_bf16 v[196:199], a[216:219], v[168:171], v[196:199]
    buffer_load_dwordx4 v[88:91], v5, s[24:27], s45 offen offset:0 sc1
    v_mfma_f32_16x16x32_bf16 v[196:199], a[220:223], v[172:175], v[196:199]
    ds_read_b64_tr_b16 a[180:181], v17 offset:40960
    ds_read_b64_tr_b16 a[182:183], v17 offset:45056
    v_mfma_f32_16x16x32_bf16 v[196:199], a[224:227], v[176:179], v[196:199]
    ds_read_b64_tr_b16 a[184:185], v17 offset:49152
    v_cvt_pk_bf16_f32 v224, v192, v193
    v_mfma_f32_16x16x32_bf16 v[196:199], a[228:231], v[180:183], v[196:199]
    ds_read_b64_tr_b16 a[186:187], v17 offset:53248
    v_cvt_pk_bf16_f32 v225, v194, v195
    v_mfma_f32_16x16x32_bf16 v[196:199], a[232:235], v[184:187], v[196:199]
    ds_read_b64_tr_b16 a[188:189], v17 offset:57344
    v_mfma_f32_16x16x32_bf16 v[196:199], a[236:239], v[188:191], v[196:199]
    s_waitcnt lgkmcnt(13)
    ds_read_b64_tr_b16 a[190:191], v17 offset:61440
    v_mfma_f32_16x16x32_bf16 v[200:203], a[160:163], v[128:131], 0
    s_waitcnt lgkmcnt(12)
    buffer_load_dwordx4 v[92:95], v5, s[24:27], s45 offen offset:384 sc1
    v_mfma_f32_16x16x32_bf16 v[200:203], a[164:167], v[132:135], v[200:203]
    s_waitcnt lgkmcnt(10)
    ds_read_b64_tr_b16 a[208:209], v14 offset:32768
    ds_read_b64_tr_b16 a[210:211], v14 offset:36864
    v_mfma_f32_16x16x32_bf16 v[200:203], a[168:171], v[136:139], v[200:203]
    s_waitcnt lgkmcnt(10)
    buffer_load_dwordx4 v[96:99], v5, s[24:27], s45 offen offset:768 sc1
    v_mfma_f32_16x16x32_bf16 v[200:203], a[172:175], v[140:143], v[200:203]
    s_waitcnt lgkmcnt(8)
    ds_read_b64_tr_b16 a[212:213], v14 offset:40960
    ds_read_b64_tr_b16 a[214:215], v14 offset:45056
    v_mfma_f32_16x16x32_bf16 v[200:203], a[176:179], v[144:147], v[200:203]
    s_waitcnt lgkmcnt(8)
    ds_read_b64_tr_b16 a[216:217], v14 offset:49152
    v_cvt_pk_bf16_f32 v228, v196, v197
    v_mfma_f32_16x16x32_bf16 v[200:203], a[180:183], v[148:151], v[200:203]
    s_waitcnt lgkmcnt(7)
    ds_read_b64_tr_b16 a[218:219], v14 offset:53248
    v_cvt_pk_bf16_f32 v229, v198, v199
    v_mfma_f32_16x16x32_bf16 v[200:203], a[184:187], v[152:155], v[200:203]
    s_waitcnt lgkmcnt(6)
    ds_read_b64_tr_b16 a[220:221], v14 offset:57344
    v_mfma_f32_16x16x32_bf16 v[200:203], a[188:191], v[156:159], v[200:203]
    s_mov_b32 s45, 22144
    ds_read_b64_tr_b16 a[222:223], v14 offset:61440
    v_mfma_f32_16x16x32_bf16 v[204:207], a[160:163], v[160:163], 0
    buffer_load_dwordx4 v[112:115], v5, s[24:27], s45 offen offset:0 sc1
    v_mfma_f32_16x16x32_bf16 v[204:207], a[164:167], v[164:167], v[204:207]
    ds_read_b64_tr_b16 a[224:225], v18 offset:32768
    ds_read_b64_tr_b16 a[226:227], v18 offset:36864
    v_mfma_f32_16x16x32_bf16 v[204:207], a[168:171], v[168:171], v[204:207]
    buffer_load_dwordx4 v[116:119], v5, s[24:27], s45 offen offset:384 sc1
    v_mfma_f32_16x16x32_bf16 v[204:207], a[172:175], v[172:175], v[204:207]
    ds_read_b64_tr_b16 a[228:229], v18 offset:40960
    ds_read_b64_tr_b16 a[230:231], v18 offset:45056
    v_mfma_f32_16x16x32_bf16 v[204:207], a[176:179], v[176:179], v[204:207]
    ds_read_b64_tr_b16 a[232:233], v18 offset:49152
    v_cvt_pk_bf16_f32 v226, v200, v201
    v_mfma_f32_16x16x32_bf16 v[204:207], a[180:183], v[180:183], v[204:207]
    s_add_u32 s38, s47, 1792
    ds_read_b64_tr_b16 a[234:235], v18 offset:53248
    v_cvt_pk_bf16_f32 v227, v202, v203
    v_mfma_f32_16x16x32_bf16 v[204:207], a[184:187], v[184:187], v[204:207]
    buffer_store_dwordx4 v[224:227], v56, s[28:31], s38 offen sc1
    v_mfma_f32_16x16x32_bf16 v[204:207], a[188:191], v[188:191], v[204:207]
    s_waitcnt lgkmcnt(12)
    ds_read_b64_tr_b16 a[236:237], v18 offset:57344
    ds_read_b64_tr_b16 a[238:239], v18 offset:61440
    v_mfma_f32_16x16x32_bf16 v[192:195], a[208:211], v[128:131], 0
    s_waitcnt lgkmcnt(12)
    s_waitcnt vmcnt(16)
    buffer_store_dword v10, v8, s[24:27], s92 offen sc1
    v_mfma_f32_16x16x32_bf16 v[192:195], a[212:215], v[132:135], v[192:195]
    s_waitcnt lgkmcnt(10)
    s_add_u32 s92, s92, 4
    ds_read_b64_tr_b16 a[160:161], v15 offset:32768
    ds_read_b64_tr_b16 a[162:163], v15 offset:36864
    v_mfma_f32_16x16x32_bf16 v[192:195], a[216:219], v[136:139], v[192:195]
    s_waitcnt lgkmcnt(10)
    buffer_load_dwordx4 v[120:123], v5, s[24:27], s45 offen offset:768 sc1
    v_mfma_f32_16x16x32_bf16 v[192:195], a[220:223], v[140:143], v[192:195]
    s_waitcnt lgkmcnt(8)
    ds_read_b64_tr_b16 a[164:165], v15 offset:40960
    ds_read_b64_tr_b16 a[166:167], v15 offset:45056
    v_mfma_f32_16x16x32_bf16 v[192:195], a[224:227], v[144:147], v[192:195]
    s_waitcnt lgkmcnt(8)
    ds_read_b64_tr_b16 a[168:169], v15 offset:49152
    v_cvt_pk_bf16_f32 v230, v204, v205
    v_mfma_f32_16x16x32_bf16 v[192:195], a[228:231], v[148:151], v[192:195]
    s_waitcnt lgkmcnt(7)
    s_add_u32 s38, s47, 296704
    ds_read_b64_tr_b16 a[170:171], v15 offset:53248
    v_cvt_pk_bf16_f32 v231, v206, v207
    v_mfma_f32_16x16x32_bf16 v[192:195], a[232:235], v[152:155], v[192:195]
    s_waitcnt lgkmcnt(6)
    buffer_store_dwordx4 v[228:231], v56, s[28:31], s38 offen sc1
    v_mfma_f32_16x16x32_bf16 v[192:195], a[236:239], v[156:159], v[192:195]
    ds_read_b64_tr_b16 a[172:173], v15 offset:57344
    ds_read_b64_tr_b16 a[174:175], v15 offset:61440
    v_mfma_f32_16x16x32_bf16 v[196:199], a[208:211], v[160:163], 0
    buffer_load_dwordx2 v[36:37], v4, s[12:15], 0 offen offset:0
    v_mfma_f32_16x16x32_bf16 v[196:199], a[212:215], v[164:167], v[196:199]
    ds_read_b64_tr_b16 a[176:177], v19 offset:32768
    ds_read_b64_tr_b16 a[178:179], v19 offset:36864
    v_mfma_f32_16x16x32_bf16 v[196:199], a[216:219], v[168:171], v[196:199]
    buffer_load_dwordx2 v[38:39], v4, s[12:15], 0 offen offset:32
    v_mfma_f32_16x16x32_bf16 v[196:199], a[220:223], v[172:175], v[196:199]
    ds_read_b64_tr_b16 a[180:181], v19 offset:40960
    ds_read_b64_tr_b16 a[182:183], v19 offset:45056
    v_mfma_f32_16x16x32_bf16 v[196:199], a[224:227], v[176:179], v[196:199]
    ds_read_b64_tr_b16 a[184:185], v19 offset:49152
    v_cvt_pk_bf16_f32 v232, v192, v193
    v_mfma_f32_16x16x32_bf16 v[196:199], a[228:231], v[180:183], v[196:199]
    ds_read_b64_tr_b16 a[186:187], v19 offset:53248
    v_cvt_pk_bf16_f32 v233, v194, v195
    v_mfma_f32_16x16x32_bf16 v[196:199], a[232:235], v[184:187], v[196:199]
    ds_read_b64_tr_b16 a[188:189], v19 offset:57344
    v_mfma_f32_16x16x32_bf16 v[196:199], a[236:239], v[188:191], v[196:199]
    ds_read_b64_tr_b16 a[190:191], v19 offset:61440
    s_waitcnt lgkmcnt(0)
    s_barrier
    v_mfma_f32_16x16x32_bf16 v[200:203], a[160:163], v[128:131], 0
    buffer_load_dwordx2 v[40:41], v4, s[12:15], 0 offen offset:384
    v_mfma_f32_16x16x32_bf16 v[200:203], a[164:167], v[132:135], v[200:203]
    ds_read_b64_tr_b16 a[208:209], v20 offset:0
    ds_read_b64_tr_b16 a[210:211], v20 offset:4096
    v_mfma_f32_16x16x32_bf16 v[200:203], a[168:171], v[136:139], v[200:203]
    buffer_load_dwordx2 v[42:43], v4, s[12:15], 0 offen offset:416
    v_mfma_f32_16x16x32_bf16 v[200:203], a[172:175], v[140:143], v[200:203]
    ds_read_b64_tr_b16 a[212:213], v20 offset:8192
    ds_read_b64_tr_b16 a[214:215], v20 offset:12288
    v_mfma_f32_16x16x32_bf16 v[200:203], a[176:179], v[144:147], v[200:203]
    ds_read_b64_tr_b16 a[216:217], v20 offset:16384
    v_cvt_pk_bf16_f32 v236, v196, v197
    v_mfma_f32_16x16x32_bf16 v[200:203], a[180:183], v[148:151], v[200:203]
    ds_read_b64_tr_b16 a[218:219], v20 offset:20480
    v_cvt_pk_bf16_f32 v237, v198, v199
    v_mfma_f32_16x16x32_bf16 v[200:203], a[184:187], v[152:155], v[200:203]
    ds_read_b64_tr_b16 a[220:221], v20 offset:24576
    v_mfma_f32_16x16x32_bf16 v[200:203], a[188:191], v[156:159], v[200:203]
    ds_read_b64_tr_b16 a[222:223], v20 offset:28672
    v_mfma_f32_16x16x32_bf16 v[204:207], a[160:163], v[160:163], 0
    buffer_load_dwordx2 v[44:45], v4, s[12:15], 0 offen offset:768
    v_mfma_f32_16x16x32_bf16 v[204:207], a[164:167], v[164:167], v[204:207]
    ds_read_b64_tr_b16 a[224:225], v24 offset:0
    ds_read_b64_tr_b16 a[226:227], v24 offset:4096
    v_mfma_f32_16x16x32_bf16 v[204:207], a[168:171], v[168:171], v[204:207]
    buffer_load_dwordx2 v[46:47], v4, s[12:15], 0 offen offset:800
    v_mfma_f32_16x16x32_bf16 v[204:207], a[172:175], v[172:175], v[204:207]
    ds_read_b64_tr_b16 a[228:229], v24 offset:8192
    ds_read_b64_tr_b16 a[230:231], v24 offset:12288
    v_mfma_f32_16x16x32_bf16 v[204:207], a[176:179], v[176:179], v[204:207]
    ds_read_b64_tr_b16 a[232:233], v24 offset:16384
    v_cvt_pk_bf16_f32 v234, v200, v201
    v_mfma_f32_16x16x32_bf16 v[204:207], a[180:183], v[180:183], v[204:207]
    s_add_u32 s38, s47, 1920
    ds_read_b64_tr_b16 a[234:235], v24 offset:20480
    v_cvt_pk_bf16_f32 v235, v202, v203
    v_mfma_f32_16x16x32_bf16 v[204:207], a[184:187], v[184:187], v[204:207]
    buffer_store_dwordx4 v[232:235], v56, s[28:31], s38 offen sc1
    v_mfma_f32_16x16x32_bf16 v[204:207], a[188:191], v[188:191], v[204:207]
    s_waitcnt lgkmcnt(12)
    ds_read_b64_tr_b16 a[236:237], v24 offset:24576
    ds_read_b64_tr_b16 a[238:239], v24 offset:28672
    v_mfma_f32_16x16x32_bf16 v[192:195], a[208:211], v[128:131], 0
    s_waitcnt lgkmcnt(12)
    buffer_load_dwordx2 v[100:101], v3, s[20:23], 0 offen offset:0
    v_mfma_f32_16x16x32_bf16 v[192:195], a[212:215], v[132:135], v[192:195]
    s_waitcnt lgkmcnt(10)
    ds_read_b64_tr_b16 a[160:161], v21 offset:0
    ds_read_b64_tr_b16 a[162:163], v21 offset:4096
    v_mfma_f32_16x16x32_bf16 v[192:195], a[216:219], v[136:139], v[192:195]
    s_waitcnt lgkmcnt(10)
    buffer_load_dwordx2 v[102:103], v3, s[20:23], 0 offen offset:32
    v_mfma_f32_16x16x32_bf16 v[192:195], a[220:223], v[140:143], v[192:195]
    s_waitcnt lgkmcnt(8)
    ds_read_b64_tr_b16 a[164:165], v21 offset:8192
    ds_read_b64_tr_b16 a[166:167], v21 offset:12288
    v_mfma_f32_16x16x32_bf16 v[192:195], a[224:227], v[144:147], v[192:195]
    s_waitcnt lgkmcnt(8)
    ds_read_b64_tr_b16 a[168:169], v21 offset:16384
    v_cvt_pk_bf16_f32 v238, v204, v205
    v_mfma_f32_16x16x32_bf16 v[192:195], a[228:231], v[148:151], v[192:195]
    s_waitcnt lgkmcnt(7)
    s_add_u32 s38, s47, 296832
    ds_read_b64_tr_b16 a[170:171], v21 offset:20480
    v_cvt_pk_bf16_f32 v239, v206, v207
    v_mfma_f32_16x16x32_bf16 v[192:195], a[232:235], v[152:155], v[192:195]
    s_waitcnt lgkmcnt(6)
    buffer_store_dwordx4 v[236:239], v56, s[28:31], s38 offen sc1
    v_mfma_f32_16x16x32_bf16 v[192:195], a[236:239], v[156:159], v[192:195]
    ds_read_b64_tr_b16 a[172:173], v21 offset:24576
    ds_read_b64_tr_b16 a[174:175], v21 offset:28672
    v_mfma_f32_16x16x32_bf16 v[196:199], a[208:211], v[160:163], 0
    buffer_load_dwordx2 v[104:105], v3, s[20:23], 0 offen offset:384
    v_mfma_f32_16x16x32_bf16 v[196:199], a[212:215], v[164:167], v[196:199]
    ds_read_b64_tr_b16 a[176:177], v25 offset:0
    ds_read_b64_tr_b16 a[178:179], v25 offset:4096
    v_mfma_f32_16x16x32_bf16 v[196:199], a[216:219], v[168:171], v[196:199]
    buffer_load_dwordx2 v[106:107], v3, s[20:23], 0 offen offset:416
    v_mfma_f32_16x16x32_bf16 v[196:199], a[220:223], v[172:175], v[196:199]
    ds_read_b64_tr_b16 a[180:181], v25 offset:8192
    ds_read_b64_tr_b16 a[182:183], v25 offset:12288
    v_mfma_f32_16x16x32_bf16 v[196:199], a[224:227], v[176:179], v[196:199]
    ds_read_b64_tr_b16 a[184:185], v25 offset:16384
    v_cvt_pk_bf16_f32 v224, v192, v193
    v_mfma_f32_16x16x32_bf16 v[196:199], a[228:231], v[180:183], v[196:199]
    ds_read_b64_tr_b16 a[186:187], v25 offset:20480
    v_cvt_pk_bf16_f32 v225, v194, v195
    v_mfma_f32_16x16x32_bf16 v[196:199], a[232:235], v[184:187], v[196:199]
    ds_read_b64_tr_b16 a[188:189], v25 offset:24576
    v_mfma_f32_16x16x32_bf16 v[196:199], a[236:239], v[188:191], v[196:199]
    s_waitcnt lgkmcnt(13)
    ds_read_b64_tr_b16 a[190:191], v25 offset:28672
    v_mfma_f32_16x16x32_bf16 v[200:203], a[160:163], v[128:131], 0
    s_waitcnt lgkmcnt(12)
    buffer_load_dwordx2 v[108:109], v3, s[20:23], 0 offen offset:768
    v_mfma_f32_16x16x32_bf16 v[200:203], a[164:167], v[132:135], v[200:203]
    s_waitcnt lgkmcnt(10)
    ds_read_b64_tr_b16 a[208:209], v22 offset:0
    ds_read_b64_tr_b16 a[210:211], v22 offset:4096
    v_mfma_f32_16x16x32_bf16 v[200:203], a[168:171], v[136:139], v[200:203]
    s_waitcnt lgkmcnt(10)
    buffer_load_dwordx2 v[110:111], v3, s[20:23], 0 offen offset:800
    v_mfma_f32_16x16x32_bf16 v[200:203], a[172:175], v[140:143], v[200:203]
    s_waitcnt lgkmcnt(8)
    ds_read_b64_tr_b16 a[212:213], v22 offset:8192
    ds_read_b64_tr_b16 a[214:215], v22 offset:12288
    v_mfma_f32_16x16x32_bf16 v[200:203], a[176:179], v[144:147], v[200:203]
    s_waitcnt lgkmcnt(8)
    ds_read_b64_tr_b16 a[216:217], v22 offset:16384
    v_cvt_pk_bf16_f32 v228, v196, v197
    v_mfma_f32_16x16x32_bf16 v[200:203], a[180:183], v[148:151], v[200:203]
    s_waitcnt lgkmcnt(7)
    ds_read_b64_tr_b16 a[218:219], v22 offset:20480
    v_cvt_pk_bf16_f32 v229, v198, v199
    v_mfma_f32_16x16x32_bf16 v[200:203], a[184:187], v[152:155], v[200:203]
    s_waitcnt lgkmcnt(6)
    ds_read_b64_tr_b16 a[220:221], v22 offset:24576
    v_mfma_f32_16x16x32_bf16 v[200:203], a[188:191], v[156:159], v[200:203]
    ds_read_b64_tr_b16 a[222:223], v22 offset:28672
    v_mfma_f32_16x16x32_bf16 v[204:207], a[160:163], v[160:163], 0
    ds_read_b64_tr_b16 a[224:225], v26 offset:0
    v_mfma_f32_16x16x32_bf16 v[204:207], a[164:167], v[164:167], v[204:207]
    ds_read_b64_tr_b16 a[226:227], v26 offset:4096
    v_mfma_f32_16x16x32_bf16 v[204:207], a[168:171], v[168:171], v[204:207]
    ds_read_b64_tr_b16 a[228:229], v26 offset:8192
    v_mfma_f32_16x16x32_bf16 v[204:207], a[172:175], v[172:175], v[204:207]
    ds_read_b64_tr_b16 a[230:231], v26 offset:12288
    v_mfma_f32_16x16x32_bf16 v[204:207], a[176:179], v[176:179], v[204:207]
    ds_read_b64_tr_b16 a[232:233], v26 offset:16384
    v_cvt_pk_bf16_f32 v226, v200, v201
    v_mfma_f32_16x16x32_bf16 v[204:207], a[180:183], v[180:183], v[204:207]
    s_add_u32 s38, s47, 2048
    ds_read_b64_tr_b16 a[234:235], v26 offset:20480
    v_cvt_pk_bf16_f32 v227, v202, v203
    v_mfma_f32_16x16x32_bf16 v[204:207], a[184:187], v[184:187], v[204:207]
    buffer_store_dwordx4 v[224:227], v56, s[28:31], s38 offen sc1
    v_mfma_f32_16x16x32_bf16 v[204:207], a[188:191], v[188:191], v[204:207]
    s_waitcnt lgkmcnt(12)
    ds_read_b64_tr_b16 a[236:237], v26 offset:24576
    ds_read_b64_tr_b16 a[238:239], v26 offset:28672
    v_mfma_f32_16x16x32_bf16 v[192:195], a[208:211], v[128:131], 0
    s_waitcnt lgkmcnt(12)
    ds_read_b64_tr_b16 a[160:161], v23 offset:0
    v_mfma_f32_16x16x32_bf16 v[192:195], a[212:215], v[132:135], v[192:195]
    s_waitcnt lgkmcnt(11)
    ds_read_b64_tr_b16 a[162:163], v23 offset:4096
    v_mfma_f32_16x16x32_bf16 v[192:195], a[216:219], v[136:139], v[192:195]
    s_waitcnt lgkmcnt(10)
    ds_read_b64_tr_b16 a[164:165], v23 offset:8192
    v_mfma_f32_16x16x32_bf16 v[192:195], a[220:223], v[140:143], v[192:195]
    s_waitcnt lgkmcnt(9)
    ds_read_b64_tr_b16 a[166:167], v23 offset:12288
    v_mfma_f32_16x16x32_bf16 v[192:195], a[224:227], v[144:147], v[192:195]
    s_waitcnt lgkmcnt(8)
    ds_read_b64_tr_b16 a[168:169], v23 offset:16384
    v_cvt_pk_bf16_f32 v230, v204, v205
    v_mfma_f32_16x16x32_bf16 v[192:195], a[228:231], v[148:151], v[192:195]
    s_waitcnt lgkmcnt(7)
    s_add_u32 s38, s47, 296960
    ds_read_b64_tr_b16 a[170:171], v23 offset:20480
    v_cvt_pk_bf16_f32 v231, v206, v207
    v_mfma_f32_16x16x32_bf16 v[192:195], a[232:235], v[152:155], v[192:195]
    s_waitcnt lgkmcnt(6)
    buffer_store_dwordx4 v[228:231], v56, s[28:31], s38 offen sc1
    v_mfma_f32_16x16x32_bf16 v[192:195], a[236:239], v[156:159], v[192:195]
    ds_read_b64_tr_b16 a[172:173], v23 offset:24576
    ds_read_b64_tr_b16 a[174:175], v23 offset:28672
    v_mfma_f32_16x16x32_bf16 v[196:199], a[208:211], v[160:163], 0
    ds_read_b64_tr_b16 a[176:177], v27 offset:0
    v_mfma_f32_16x16x32_bf16 v[196:199], a[212:215], v[164:167], v[196:199]
    ds_read_b64_tr_b16 a[178:179], v27 offset:4096
    v_mfma_f32_16x16x32_bf16 v[196:199], a[216:219], v[168:171], v[196:199]
    ds_read_b64_tr_b16 a[180:181], v27 offset:8192
    v_mfma_f32_16x16x32_bf16 v[196:199], a[220:223], v[172:175], v[196:199]
    ds_read_b64_tr_b16 a[182:183], v27 offset:12288
    v_mfma_f32_16x16x32_bf16 v[196:199], a[224:227], v[176:179], v[196:199]
    ds_read_b64_tr_b16 a[184:185], v27 offset:16384
    v_cvt_pk_bf16_f32 v232, v192, v193
    v_mfma_f32_16x16x32_bf16 v[196:199], a[228:231], v[180:183], v[196:199]
    ds_read_b64_tr_b16 a[186:187], v27 offset:20480
    v_cvt_pk_bf16_f32 v233, v194, v195
    v_mfma_f32_16x16x32_bf16 v[196:199], a[232:235], v[184:187], v[196:199]
    ds_read_b64_tr_b16 a[188:189], v27 offset:24576
    v_mfma_f32_16x16x32_bf16 v[196:199], a[236:239], v[188:191], v[196:199]
    s_waitcnt lgkmcnt(13)
    ds_read_b64_tr_b16 a[190:191], v27 offset:28672
    v_mfma_f32_16x16x32_bf16 v[200:203], a[160:163], v[128:131], 0
    s_waitcnt lgkmcnt(12)
    buffer_load_dword v11, v9, s[24:27], s93 offen sc1
    v_mfma_f32_16x16x32_bf16 v[200:203], a[164:167], v[132:135], v[200:203]
    s_waitcnt lgkmcnt(10)
    v_mfma_f32_16x16x32_bf16 v[200:203], a[168:171], v[136:139], v[200:203]
    s_waitcnt lgkmcnt(8)
    v_mfma_f32_16x16x32_bf16 v[200:203], a[172:175], v[140:143], v[200:203]
    s_waitcnt lgkmcnt(6)
    v_mfma_f32_16x16x32_bf16 v[200:203], a[176:179], v[144:147], v[200:203]
    s_waitcnt lgkmcnt(4)
    v_cvt_pk_bf16_f32 v236, v196, v197
    v_mfma_f32_16x16x32_bf16 v[200:203], a[180:183], v[148:151], v[200:203]
    s_waitcnt lgkmcnt(2)
    v_cvt_pk_bf16_f32 v237, v198, v199
    v_mfma_f32_16x16x32_bf16 v[200:203], a[184:187], v[152:155], v[200:203]
    s_waitcnt lgkmcnt(0)
    v_mfma_f32_16x16x32_bf16 v[200:203], a[188:191], v[156:159], v[200:203]
    v_mfma_f32_16x16x32_bf16 v[204:207], a[160:163], v[160:163], 0
    v_mfma_f32_16x16x32_bf16 v[204:207], a[164:167], v[164:167], v[204:207]
    v_mfma_f32_16x16x32_bf16 v[204:207], a[168:171], v[168:171], v[204:207]
    v_mfma_f32_16x16x32_bf16 v[204:207], a[172:175], v[172:175], v[204:207]
    v_mfma_f32_16x16x32_bf16 v[204:207], a[176:179], v[176:179], v[204:207]
    s_nop 2
    v_cvt_pk_bf16_f32 v234, v200, v201
    v_mfma_f32_16x16x32_bf16 v[204:207], a[180:183], v[180:183], v[204:207]
    s_add_u32 s38, s47, 2176
    v_cvt_pk_bf16_f32 v235, v202, v203
    v_mfma_f32_16x16x32_bf16 v[204:207], a[184:187], v[184:187], v[204:207]
    buffer_store_dwordx4 v[232:235], v56, s[28:31], s38 offen sc1
    v_mfma_f32_16x16x32_bf16 v[204:207], a[188:191], v[188:191], v[204:207]
    s_nop 7
    v_cvt_pk_bf16_f32 v238, v204, v205
    s_add_u32 s38, s47, 297088
    v_cvt_pk_bf16_f32 v239, v206, v207
    buffer_store_dwordx4 v[236:239], v56, s[28:31], s38 offen sc1
    s_waitcnt vmcnt(2)
    v_cmp_ne_u32 s[54:55], s95, v11
    s_cmp_lg_u64 s[54:55], 0
    s_cbranch_scc1 Ltail_spin1
Ltail_got1:
    s_add_u32 s93, s93, 4
    s_add_u32 s45, s44, 0
    buffer_load_dwordx4 a[64:67], v2, s[28:31], s45 offen offset:0 sc1
    s_add_u32 s45, s44, 2304
    buffer_load_dwordx4 a[68:71], v2, s[28:31], s45 offen offset:0 sc1
    s_add_u32 s45, s44, 4608
    buffer_load_dwordx4 a[72:75], v2, s[28:31], s45 offen offset:0 sc1
    s_add_u32 s45, s44, 6912
    buffer_load_dwordx4 a[76:79], v2, s[28:31], s45 offen offset:0 sc1
    s_add_u32 s45, s44, 9216
    buffer_load_dwordx4 a[80:83], v2, s[28:31], s45 offen offset:0 sc1
    s_add_u32 s45, s44, 11520
    buffer_load_dwordx4 a[84:87], v2, s[28:31], s45 offen offset:0 sc1
Ltour11:
    s_cbranch_execz Ltour15
    s_add_u32 s45, s44, 13824
    buffer_load_dwordx4 a[88:91], v2, s[28:31], s45 offen offset:0 sc1
    s_add_u32 s45, s44, 16128
    buffer_load_dwordx4 a[92:95], v2, s[28:31], s45 offen offset:0 sc1
    s_add_u32 s45, s44, 18432
    buffer_load_dwordx4 a[96:99], v2, s[28:31], s45 offen offset:0 sc1
    s_add_u32 s45, s44, 20736
    buffer_load_dwordx4 a[100:103], v2, s[28:31], s45 offen offset:0 sc1
    s_add_u32 s45, s44, 23040
    buffer_load_dwordx4 a[104:107], v2, s[28:31], s45 offen offset:0 sc1
    s_add_u32 s45, s44, 25344
    buffer_load_dwordx4 a[108:111], v2, s[28:31], s45 offen offset:0 sc1
    v_lshlrev_b32 v12, 16, v36
    v_and_b32 v13, 0xffff0000, v36
    v_lshlrev_b32 v14, 16, v37
    v_and_b32 v15, 0xffff0000, v37
    v_lshlrev_b32 v16, 16, v38
    v_and_b32 v17, 0xffff0000, v38
    v_lshlrev_b32 v18, 16, v39
    v_and_b32 v19, 0xffff0000, v39
    v_lshlrev_b32 v20, 16, v40
    v_and_b32 v21, 0xffff0000, v40
    v_lshlrev_b32 v22, 16, v41
    v_and_b32 v23, 0xffff0000, v41
    v_lshlrev_b32 v24, 16, v42
    v_and_b32 v25, 0xffff0000, v42
    v_lshlrev_b32 v26, 16, v43
    v_and_b32 v27, 0xffff0000, v43
    v_lshlrev_b32 v28, 16, v44
    v_and_b32 v29, 0xffff0000, v44
    v_lshlrev_b32 v30, 16, v45
    v_and_b32 v31, 0xffff0000, v45
    v_lshlrev_b32 v32, 16, v46
    v_and_b32 v33, 0xffff0000, v46
    v_lshlrev_b32 v34, 16, v47
    v_and_b32 v35, 0xffff0000, v47
    v_lshlrev_b32 v128, 16, v64
    v_and_b32 v129, 0xffff0000, v64
    v_lshlrev_b32 v130, 16, v65
    v_and_b32 v131, 0xffff0000, v65
    v_lshlrev_b32 v132, 16, v66
    v_and_b32 v133, 0xffff0000, v66
    v_lshlrev_b32 v134, 16, v67
    v_and_b32 v135, 0xffff0000, v67
    v_lshlrev_b32 v136, 16, v68
    v_and_b32 v137, 0xffff0000, v68
    v_lshlrev_b32 v138, 16, v69
    v_and_b32 v139, 0xffff0000, v69
    v_lshlrev_b32 v140, 16, v70
    v_and_b32 v141, 0xffff0000, v70
    v_lshlrev_b32 v142, 16, v71
    v_and_b32 v143, 0xffff0000, v71
    v_lshlrev_b32 v144, 16, v72
    v_and_b32 v145, 0xffff0000, v72
    v_lshlrev_b32 v146, 16, v73
    v_and_b32 v147, 0xffff0000, v73
    v_lshlrev_b32 v148, 16, v74
    v_and_b32 v149, 0xffff0000, v74
    v_lshlrev_b32 v150, 16, v75
    v_and_b32 v151, 0xffff0000, v75
    v_lshlrev_b32 v152, 16, v76
    v_and_b32 v153, 0xffff0000, v76
    v_lshlrev_b32 v154, 16, v77
    v_and_b32 v155, 0xffff0000, v77
    v_lshlrev_b32 v156, 16, v78
    v_and_b32 v157, 0xffff0000, v78
    v_lshlrev_b32 v158, 16, v79
    v_and_b32 v159, 0xffff0000, v79
    v_lshlrev_b32 v160, 16, v80
    v_and_b32 v161, 0xffff0000, v80
    v_lshlrev_b32 v162, 16, v81
    v_and_b32 v163, 0xffff0000, v81
    v_lshlrev_b32 v164, 16, v82
    v_and_b32 v165, 0xffff0000, v82
    v_lshlrev_b32 v166, 16, v83
    v_and_b32 v167, 0xffff0000, v83
    v_lshlrev_b32 v168, 16, v84
    v_and_b32 v169, 0xffff0000, v84
    v_lshlrev_b32 v170, 16, v85
    v_and_b32 v171, 0xffff0000, v85
    v_lshlrev_b32 v172, 16, v86
    v_and_b32 v173, 0xffff0000, v86
    v_lshlrev_b32 v174, 16, v87
    v_and_b32 v175, 0xffff0000, v87
    v_lshlrev_b32 v176, 16, v88
    v_and_b32 v177, 0xffff0000, v88
    v_lshlrev_b32 v178, 16, v89
    v_and_b32 v179, 0xffff0000, v89
    v_lshlrev_b32 v180, 16, v90
    v_and_b32 v181, 0xffff0000, v90
    v_lshlrev_b32 v182, 16, v91
    v_and_b32 v183, 0xffff0000, v91
    v_lshlrev_b32 v184, 16, v92
    v_and_b32 v185, 0xffff0000, v92
    v_lshlrev_b32 v186, 16, v93
    v_and_b32 v187, 0xffff0000, v93
    v_lshlrev_b32 v188, 16, v94
    v_and_b32 v189, 0xffff0000, v94
    v_lshlrev_b32 v190, 16, v95
    v_and_b32 v191, 0xffff0000, v95
    v_lshlrev_b32 v192, 16, v96
    v_and_b32 v193, 0xffff0000, v96
    v_lshlrev_b32 v194, 16, v97
    v_and_b32 v195, 0xffff0000, v97
    v_lshlrev_b32 v196, 16, v98
    v_and_b32 v197, 0xffff0000, v98
    v_lshlrev_b32 v198, 16, v99
    v_and_b32 v199, 0xffff0000, v99
    s_waitcnt vmcnt(12)
    buffer_store_dword v10, v8, s[24:27], s92 offen sc1
    s_add_u32 s92, s92, 4
    v_lshlrev_b32 v200, 16, v100
    v_and_b32 v201, 0xffff0000, v100
    v_lshlrev_b32 v202, 16, v101
    v_and_b32 v203, 0xffff0000, v101
    v_lshlrev_b32 v204, 16, v102
    v_and_b32 v205, 0xffff0000, v102
    v_lshlrev_b32 v206, 16, v103
    v_and_b32 v207, 0xffff0000, v103
    v_lshlrev_b32 v208, 16, v104
    v_and_b32 v209, 0xffff0000, v104
    v_lshlrev_b32 v210, 16, v105
    v_and_b32 v211, 0xffff0000, v105
    v_lshlrev_b32 v212, 16, v106
    v_and_b32 v213, 0xffff0000, v106
    v_lshlrev_b32 v214, 16, v107
    v_and_b32 v215, 0xffff0000, v107
    v_lshlrev_b32 v216, 16, v108
    v_and_b32 v217, 0xffff0000, v108
    v_lshlrev_b32 v218, 16, v109
    v_and_b32 v219, 0xffff0000, v109
    v_lshlrev_b32 v220, 16, v110
    v_and_b32 v221, 0xffff0000, v110
    v_lshlrev_b32 v222, 16, v111
    v_and_b32 v223, 0xffff0000, v111
    v_lshlrev_b32 v224, 16, v112
    v_and_b32 v225, 0xffff0000, v112
    v_lshlrev_b32 v226, 16, v113
    v_and_b32 v227, 0xffff0000, v113
    v_lshlrev_b32 v228, 16, v114
    v_and_b32 v229, 0xffff0000, v114
    v_lshlrev_b32 v230, 16, v115
    v_and_b32 v231, 0xffff0000, v115
    v_lshlrev_b32 v232, 16, v116
    v_and_b32 v233, 0xffff0000, v116
    v_lshlrev_b32 v234, 16, v117
    v_and_b32 v235, 0xffff0000, v117
    v_lshlrev_b32 v236, 16, v118
    v_and_b32 v237, 0xffff0000, v118
    v_lshlrev_b32 v238, 16, v119
    v_and_b32 v239, 0xffff0000, v119
    v_lshlrev_b32 v240, 16, v120
    v_and_b32 v241, 0xffff0000, v120
    v_lshlrev_b32 v242, 16, v121
    v_and_b32 v243, 0xffff0000, v121
    v_lshlrev_b32 v244, 16, v122
    v_and_b32 v245, 0xffff0000, v122
    v_lshlrev_b32 v246, 16, v123
    v_and_b32 v247, 0xffff0000, v123
    s_add_u32 s45, s44, 27648
    buffer_load_dwordx4 a[112:115], v2, s[28:31], s45 offen offset:0 sc1
    s_add_u32 s45, s44, 29952
    buffer_load_dwordx4 a[116:119], v2, s[28:31], s45 offen offset:0 sc1
    s_add_u32 s45, s44, 32256
    buffer_load_dwordx4 a[120:123], v2, s[28:31], s45 offen offset:0 sc1
    s_add_u32 s45, s44, 34560
    buffer_load_dwordx4 a[124:127], v2, s[28:31], s45 offen offset:0 sc1
    s_add_u32 s45, s44, 0
    buffer_load_dwordx4 a[160:163], v2, s[28:31], s45 offen offset:768 sc1
    s_add_u32 s45, s44, 2304
    buffer_load_dwordx4 a[164:167], v2, s[28:31], s45 offen offset:768 sc1
    s_add_u32 s45, s44, 4608
    buffer_load_dwordx4 a[168:171], v2, s[28:31], s45 offen offset:768 sc1
    s_add_u32 s45, s44, 6912
    buffer_load_dwordx4 a[172:175], v2, s[28:31], s45 offen offset:768 sc1
    s_add_u32 s45, s44, 9216
    buffer_load_dwordx4 a[176:179], v2, s[28:31], s45 offen offset:768 sc1
    s_add_u32 s45, s44, 11520
    buffer_load_dwordx4 a[180:183], v2, s[28:31], s45 offen offset:768 sc1
    s_add_u32 s45, s44, 13824
    buffer_load_dwordx4 a[184:187], v2, s[28:31], s45 offen offset:768 sc1
    s_add_u32 s45, s44, 16128
    buffer_load_dwordx4 a[188:191], v2, s[28:31], s45 offen offset:768 sc1
    s_add_u32 s45, s44, 18432
    buffer_load_dwordx4 a[192:195], v2, s[28:31], s45 offen offset:768 sc1
    s_add_u32 s45, s44, 20736
    buffer_load_dwordx4 a[196:199], v2, s[28:31], s45 offen offset:768 sc1
    buffer_load_dword v11, v9, s[24:27], s93 offen sc1
    s_add_u32 s45, s44, 23040
    buffer_load_dwordx4 a[200:203], v2, s[28:31], s45 offen offset:768 sc1
    s_add_u32 s45, s44, 25344
    buffer_load_dwordx4 a[204:207], v2, s[28:31], s45 offen offset:768 sc1
    s_add_u32 s45, s44, 27648
    buffer_load_dwordx4 a[208:211], v2, s[28:31], s45 offen offset:768 sc1
    s_add_u32 s45, s44, 29952
    buffer_load_dwordx4 a[212:215], v2, s[28:31], s45 offen offset:768 sc1
    s_add_u32 s45, s44, 32256
    buffer_load_dwordx4 a[216:219], v2, s[28:31], s45 offen offset:768 sc1
    s_add_u32 s45, s44, 34560
    buffer_load_dwordx4 a[220:223], v2, s[28:31], s45 offen offset:768 sc1
    ds_write_b128 v51, a[128:131] offset:0
    ds_write_b128 v51, a[132:135] offset:4096
    ds_write_b128 v51, a[136:139] offset:8192
    ds_write_b128 v51, a[140:143] offset:12288
    ds_write_b128 v51, a[144:147] offset:16384
    ds_write_b128 v51, a[148:151] offset:20480
    ds_write_b128 v51, a[152:155] offset:24576
    ds_write_b128 v51, a[156:159] offset:28672
    ds_write_b128 v51, a[240:243] offset:32768
    ds_write_b128 v51, a[244:247] offset:36864
    ds_write_b128 v51, a[248:251] offset:40960
    ds_write_b128 v51, a[252:255] offset:45056
    ds_write_b128 v51, a[0:3] offset:49152
    ds_write_b128 v51, a[4:7] offset:53248
    ds_write_b128 v51, a[8:11] offset:57344
    ds_write_b128 v51, a[12:15] offset:61440
    ds_write_b128 v255, a[16:19] offset:36864
    ds_write_b128 v255, a[20:23] offset:40960
    ds_write_b128 v255, a[24:27] offset:0
    ds_write_b128 v255, a[28:31] offset:4096
    ds_write_b128 v255, a[32:35] offset:8192
    ds_write_b128 v255, a[36:39] offset:12288
    ds_write_b128 v255, a[40:43] offset:16384
    ds_write_b128 v255, a[44:47] offset:20480
    ds_write_b128 v255, a[48:51] offset:24576
    ds_write_b128 v255, a[52:55] offset:28672
    ds_write_b128 v255, a[56:59] offset:32768
    s_waitcnt vmcnt(33)
    v_mfma_f32_16x16x32_bf16 v[64:67], v[250:253], a[64:67], 0
    v_mfma_f32_16x16x32_bf16 v[68:71], v[248:251], a[64:67], 0
    s_waitcnt vmcnt(32)
    v_mfma_f32_16x16x32_bf16 v[64:67], v[250:253], a[68:71], v[64:67]
    v_mfma_f32_16x16x32_bf16 v[68:71], v[248:251], a[68:71], v[68:71]
    s_waitcnt vmcnt(31)
    v_mfma_f32_16x16x32_bf16 v[64:67], v[250:253], a[72:75], v[64:67]
    v_mfma_f32_16x16x32_bf16 v[68:71], v[248:251], a[72:75], v[68:71]
    s_waitcnt vmcnt(30)
    v_mfma_f32_16x16x32_bf16 v[64:67], v[250:253], a[76:79], v[64:67]
    v_mfma_f32_16x16x32_bf16 v[68:71], v[248:251], a[76:79], v[68:71]
    s_waitcnt vmcnt(29)
    v_mfma_f32_16x16x32_bf16 v[64:67], v[250:253], a[80:83], v[64:67]
    v_mfma_f32_16x16x32_bf16 v[68:71], v[248:251], a[80:83], v[68:71]
    s_waitcnt vmcnt(28)
    v_mfma_f32_16x16x32_bf16 v[64:67], v[250:253], a[84:87], v[64:67]
    v_mfma_f32_16x16x32_bf16 v[68:71], v[248:251], a[84:87], v[68:71]
    s_waitcnt vmcnt(27)
    v_mfma_f32_16x16x32_bf16 v[64:67], v[250:253], a[88:91], v[64:67]
    v_mfma_f32_16x16x32_bf16 v[68:71], v[248:251], a[88:91], v[68:71]
    s_waitcnt vmcnt(26)
    v_mfma_f32_16x16x32_bf16 v[64:67], v[250:253], a[92:95], v[64:67]
    v_mfma_f32_16x16x32_bf16 v[68:71], v[248:251], a[92:95], v[68:71]
    s_waitcnt vmcnt(25)
    v_mfma_f32_16x16x32_bf16 v[64:67], v[250:253], a[96:99], v[64:67]
    v_mfma_f32_16x16x32_bf16 v[68:71], v[248:251], a[96:99], v[68:71]
    s_waitcnt vmcnt(24)
    v_mfma_f32_16x16x32_bf16 v[64:67], v[250:253], a[100:103], v[64:67]
    v_mfma_f32_16x16x32_bf16 v[68:71], v[248:251], a[100:103], v[68:71]
    s_waitcnt vmcnt(23)
    v_mfma_f32_16x16x32_bf16 v[64:67], v[250:253], a[104:107], v[64:67]
    v_mfma_f32_16x16x32_bf16 v[68:71], v[248:251], a[104:107], v[68:71]
    s_waitcnt vmcnt(22)
    v_mfma_f32_16x16x32_bf16 v[64:67], v[250:253], a[108:111], v[64:67]
    v_mfma_f32_16x16x32_bf16 v[68:71], v[248:251], a[108:111], v[68:71]
    s_waitcnt vmcnt(20)
    v_mfma_f32_16x16x32_bf16 v[64:67], v[250:253], a[112:115], v[64:67]
    v_mfma_f32_16x16x32_bf16 v[68:71], v[248:251], a[112:115], v[68:71]
    s_waitcnt vmcnt(19)
    v_mfma_f32_16x16x32_bf16 v[64:67], v[250:253], a[116:119], v[64:67]
    v_mfma_f32_16x16x32_bf16 v[68:71], v[248:251], a[116:119], v[68:71]
    s_waitcnt vmcnt(18)
    v_mfma_f32_16x16x32_bf16 v[64:67], v[250:253], a[120:123], v[64:67]
    v_mfma_f32_16x16x32_bf16 v[68:71], v[248:251], a[120:123], v[68:71]
    s_waitcnt vmcnt(17)
    v_mfma_f32_16x16x32_bf16 v[64:67], v[250:253], a[124:127], v[64:67]
    v_mfma_f32_16x16x32_bf16 v[68:71], v[248:251], a[124:127], v[68:71]
    s_nop 6
    v_pk_fma_f32 v[12:13], v[128:129], v[64:65], v[12:13]
    v_pk_fma_f32 v[14:15], v[130:131], v[66:67], v[14:15]
    v_pk_fma_f32 v[16:17], v[132:133], v[68:69], v[16:17]
    v_pk_fma_f32 v[18:19], v[134:135], v[70:71], v[18:19]
    v_cvt_pk_bf16_f32 v112, v12, v13
    v_cvt_pk_bf16_f32 v113, v14, v15
    v_cvt_pk_bf16_f32 v114, v16, v17
    v_cvt_pk_bf16_f32 v115, v18, v19
    v_lshlrev_b32 v12, 16, v112
    v_and_b32 v13, 0xffff0000, v112
    v_lshlrev_b32 v14, 16, v113
    v_and_b32 v15, 0xffff0000, v113
    v_lshlrev_b32 v16, 16, v114
    v_and_b32 v17, 0xffff0000, v114
    v_lshlrev_b32 v18, 16, v115
    v_and_b32 v19, 0xffff0000, v115
    s_mov_b32 s45, 5242880
    buffer_store_dwordx4 v[112:115], v6, s[24:27], s45 offen offset:0 sc1
    v_pk_add_f32 v[48:49], v[12:13], v[14:15]
    v_pk_add_f32 v[50:51], v[16:17], v[18:19]
    s_waitcnt vmcnt(7)
    v_cmp_ne_u32 s[54:55], s95, v11
    s_cmp_lg_u64 s[54:55], 0
    s_cbranch_scc1 Ltail_spin2
Ltail_got2:
    s_add_u32 s93, s93, 4
    s_add_u32 s45, s44, 0
    s_waitcnt lgkmcnt(14)
    buffer_load_dwordx4 a[0:3], v2, s[28:31], s45 offen offset:1536 sc1
    s_add_u32 s45, s44, 2304
    s_waitcnt lgkmcnt(13)
    buffer_load_dwordx4 a[4:7], v2, s[28:31], s45 offen offset:1536 sc1
    s_add_u32 s45, s44, 4608
    s_waitcnt lgkmcnt(12)
    buffer_load_dwordx4 a[8:11], v2, s[28:31], s45 offen offset:1536 sc1
    s_add_u32 s45, s44, 6912
    s_waitcnt lgkmcnt(11)
    buffer_load_dwordx4 a[12:15], v2, s[28:31], s45 offen offset:1536 sc1
    s_add_u32 s45, s44, 9216
    s_waitcnt lgkmcnt(10)
    buffer_load_dwordx4 a[16:19], v2, s[28:31], s45 offen offset:1536 sc1
    s_add_u32 s45, s44, 11520
    s_waitcnt lgkmcnt(9)
    buffer_load_dwordx4 a[20:23], v2, s[28:31], s45 offen offset:1536 sc1
    s_add_u32 s45, s44, 13824
    s_waitcnt lgkmcnt(8)
    buffer_load_dwordx4 a[24:27], v2, s[28:31], s45 offen offset:1536 sc1
    s_add_u32 s45, s44, 16128
    s_waitcnt lgkmcnt(7)
    buffer_load_dwordx4 a[28:31], v2, s[28:31], s45 offen offset:1536 sc1
    s_add_u32 s45, s44, 18432
    s_waitcnt lgkmcnt(6)
    buffer_load_dwordx4 a[32:35], v2, s[28:31], s45 offen offset:1536 sc1
    s_add_u32 s45, s44, 20736
    s_waitcnt lgkmcnt(5)
    buffer_load_dwordx4 a[36:39], v2, s[28:31], s45 offen offset:1536 sc1
    s_add_u32 s45, s44, 23040
    s_waitcnt lgkmcnt(4)
    buffer_load_dwordx4 a[40:43], v2, s[28:31], s45 offen offset:1536 sc1
    s_add_u32 s45, s44, 25344
    s_waitcnt lgkmcnt(3)
    buffer_load_dwordx4 a[44:47], v2, s[28:31], s45 offen offset:1536 sc1
    s_add_u32 s45, s44, 27648
    s_waitcnt lgkmcnt(2)
    buffer_load_dwordx4 a[48:51], v2, s[28:31], s45 offen offset:1536 sc1
    s_add_u32 s45, s44, 29952
    s_waitcnt lgkmcnt(1)
    buffer_load_dwordx4 a[52:55], v2, s[28:31], s45 offen offset:1536 sc1
    s_add_u32 s45, s44, 32256
    s_waitcnt lgkmcnt(0)
    buffer_load_dwordx4 a[56:59], v2, s[28:31], s45 offen offset:1536 sc1
    s_add_u32 s45, s44, 34560
    buffer_load_dwordx4 a[60:63], v2, s[28:31], s45 offen offset:1536 sc1
    v_mfma_f32_16x16x32_bf16 v[72:75], v[250:253], a[160:163], 0
    v_mfma_f32_16x16x32_bf16 v[76:79], v[248:251], a[160:163], 0
    v_mfma_f32_16x16x32_bf16 v[72:75], v[250:253], a[164:167], v[72:75]
    v_mfma_f32_16x16x32_bf16 v[76:79], v[248:251], a[164:167], v[76:79]
    v_mfma_f32_16x16x32_bf16 v[72:75], v[250:253], a[168:171], v[72:75]
    v_mfma_f32_16x16x32_bf16 v[76:79], v[248:251], a[168:171], v[76:79]
    v_mfma_f32_16x16x32_bf16 v[72:75], v[250:253], a[172:175], v[72:75]
    v_mfma_f32_16x16x32_bf16 v[76:79], v[248:251], a[172:175], v[76:79]
    v_mfma_f32_16x16x32_bf16 v[72:75], v[250:253], a[176:179], v[72:75]
    v_mfma_f32_16x16x32_bf16 v[76:79], v[248:251], a[176:179], v[76:79]
    v_mfma_f32_16x16x32_bf16 v[72:75], v[250:253], a[180:183], v[72:75]
    v_mfma_f32_16x16x32_bf16 v[76:79], v[248:251], a[180:183], v[76:79]
    v_mfma_f32_16x16x32_bf16 v[72:75], v[250:253], a[184:187], v[72:75]
    v_mfma_f32_16x16x32_bf16 v[76:79], v[248:251], a[184:187], v[76:79]
    v_mfma_f32_16x16x32_bf16 v[72:75], v[250:253], a[188:191], v[72:75]
    v_mfma_f32_16x16x32_bf16 v[76:79], v[248:251], a[188:191], v[76:79]
    v_mfma_f32_16x16x32_bf16 v[72:75], v[250:253], a[192:195], v[72:75]
    v_mfma_f32_16x16x32_bf16 v[76:79], v[248:251], a[192:195], v[76:79]
    v_mfma_f32_16x16x32_bf16 v[72:75], v[250:253], a[196:199], v[72:75]
    v_mfma_f32_16x16x32_bf16 v[76:79], v[248:251], a[196:199], v[76:79]
    s_waitcnt vmcnt(22)
    v_mfma_f32_16x16x32_bf16 v[72:75], v[250:253], a[200:203], v[72:75]
    v_mfma_f32_16x16x32_bf16 v[76:79], v[248:251], a[200:203], v[76:79]
    s_waitcnt vmcnt(21)
    v_mfma_f32_16x16x32_bf16 v[72:75], v[250:253], a[204:207], v[72:75]
    v_mfma_f32_16x16x32_bf16 v[76:79], v[248:251], a[204:207], v[76:79]
    s_waitcnt vmcnt(20)
    v_mfma_f32_16x16x32_bf16 v[72:75], v[250:253], a[208:211], v[72:75]
    v_mfma_f32_16x16x32_bf16 v[76:79], v[248:251], a[208:211], v[76:79]
    s_waitcnt vmcnt(19)
    v_mfma_f32_16x16x32_bf16 v[72:75], v[250:253], a[212:215], v[72:75]
    v_mfma_f32_16x16x32_bf16 v[76:79], v[248:251], a[212:215], v[76:79]
    s_waitcnt vmcnt(18)
    v_mfma_f32_16x16x32_bf16 v[72:75], v[250:253], a[216:219], v[72:75]
    v_mfma_f32_16x16x32_bf16 v[76:79], v[248:251], a[216:219], v[76:79]
    s_waitcnt vmcnt(17)
    v_mfma_f32_16x16x32_bf16 v[72:75], v[250:253], a[220:223], v[72:75]
    v_mfma_f32_16x16x32_bf16 v[76:79], v[248:251], a[220:223], v[76:79]
    s_waitcnt vmcnt(15)
    s_nop 5
    v_pk_fma_f32 v[20:21], v[136:137], v[72:73], v[20:21]
    v_pk_fma_f32 v[22:23], v[138:139], v[74:75], v[22:23]
    v_pk_fma_f32 v[24:25], v[140:141], v[76:77], v[24:25]
    v_pk_fma_f32 v[26:27], v[142:143], v[78:79], v[26:27]
    v_cvt_pk_bf16_f32 v116, v20, v21
    v_cvt_pk_bf16_f32 v117, v22, v23
    v_cvt_pk_bf16_f32 v118, v24, v25
    v_cvt_pk_bf16_f32 v119, v26, v27
    v_lshlrev_b32 v20, 16, v116
    v_and_b32 v21, 0xffff0000, v116
    v_lshlrev_b32 v22, 16, v117
    v_and_b32 v23, 0xffff0000, v117
    v_lshlrev_b32 v24, 16, v118
    v_and_b32 v25, 0xffff0000, v118
    v_lshlrev_b32 v26, 16, v119
    v_and_b32 v27, 0xffff0000, v119
    s_mov_b32 s45, 5242880
    buffer_store_dwordx4 v[116:119], v6, s[24:27], s45 offen offset:384 sc1
    v_pk_add_f32 v[48:49], v[48:49], v[20:21]
    v_pk_add_f32 v[50:51], v[50:51], v[22:23]
    v_pk_add_f32 v[48:49], v[48:49], v[24:25]
    v_pk_add_f32 v[50:51], v[50:51], v[26:27]
    v_mfma_f32_16x16x32_bf16 v[80:83], v[250:253], a[0:3], 0
    v_mfma_f32_16x16x32_bf16 v[84:87], v[248:251], a[0:3], 0
    s_waitcnt vmcnt(15)
    v_mfma_f32_16x16x32_bf16 v[80:83], v[250:253], a[4:7], v[80:83]
    v_mfma_f32_16x16x32_bf16 v[84:87], v[248:251], a[4:7], v[84:87]
    s_waitcnt vmcnt(14)
    v_mfma_f32_16x16x32_bf16 v[80:83], v[250:253], a[8:11], v[80:83]
    v_mfma_f32_16x16x32_bf16 v[84:87], v[248:251], a[8:11], v[84:87]
    s_waitcnt vmcnt(13)
    v_mfma_f32_16x16x32_bf16 v[80:83], v[250:253], a[12:15], v[80:83]
    v_mfma_f32_16x16x32_bf16 v[84:87], v[248:251], a[12:15], v[84:87]
    s_waitcnt vmcnt(12)
    v_mfma_f32_16x16x32_bf16 v[80:83], v[250:253], a[16:19], v[80:83]
    v_mfma_f32_16x16x32_bf16 v[84:87], v[248:251], a[16:19], v[84:87]
    s_waitcnt vmcnt(11)
    v_mfma_f32_16x16x32_bf16 v[80:83], v[250:253], a[20:23], v[80:83]
    v_mfma_f32_16x16x32_bf16 v[84:87], v[248:251], a[20:23], v[84:87]
    s_waitcnt vmcnt(10)
    v_mfma_f32_16x16x32_bf16 v[80:83], v[250:253], a[24:27], v[80:83]
    v_mfma_f32_16x16x32_bf16 v[84:87], v[248:251], a[24:27], v[84:87]
    s_waitcnt vmcnt(9)
    v_mfma_f32_16x16x32_bf16 v[80:83], v[250:253], a[28:31], v[80:83]
    v_mfma_f32_16x16x32_bf16 v[84:87], v[248:251], a[28:31], v[84:87]
    s_waitcnt vmcnt(8)
    v_mfma_f32_16x16x32_bf16 v[80:83], v[250:253], a[32:35], v[80:83]
    v_mfma_f32_16x16x32_bf16 v[84:87], v[248:251], a[32:35], v[84:87]
    s_waitcnt vmcnt(7)
    v_mfma_f32_16x16x32_bf16 v[80:83], v[250:253], a[36:39], v[80:83]
    v_mfma_f32_16x16x32_bf16 v[84:87], v[248:251], a[36:39], v[84:87]
    s_waitcnt vmcnt(6)
    v_mfma_f32_16x16x32_bf16 v[80:83], v[250:253], a[40:43], v[80:83]
    v_mfma_f32_16x16x32_bf16 v[84:87], v[248:251], a[40:43], v[84:87]
    s_waitcnt vmcnt(5)
    v_mfma_f32_16x16x32_bf16 v[80:83], v[250:253], a[44:47], v[80:83]
    v_mfma_f32_16x16x32_bf16 v[84:87], v[248:251], a[44:47], v[84:87]
    s_waitcnt vmcnt(4)
    v_mfma_f32_16x16x32_bf16 v[80:83], v[250:253], a[48:51], v[80:83]
    v_mfma_f32_16x16x32_bf16 v[84:87], v[248:251], a[48:51], v[84:87]
    s_waitcnt vmcnt(3)
    v_mfma_f32_16x16x32_bf16 v[80:83], v[250:253], a[52:55], v[80:83]
    v_mfma_f32_16x16x32_bf16 v[84:87], v[248:251], a[52:55], v[84:87]
    s_waitcnt vmcnt(2)
    v_mfma_f32_16x16x32_bf16 v[80:83], v[250:253], a[56:59], v[80:83]
    v_mfma_f32_16x16x32_bf16 v[84:87], v[248:251], a[56:59], v[84:87]
    s_waitcnt vmcnt(1)
    v_mfma_f32_16x16x32_bf16 v[80:83], v[250:253], a[60:63], v[80:83]
    v_mfma_f32_16x16x32_bf16 v[84:87], v[248:251], a[60:63], v[84:87]
    s_nop 6
    v_pk_fma_f32 v[28:29], v[144:145], v[80:81], v[28:29]
    v_pk_fma_f32 v[30:31], v[146:147], v[82:83], v[30:31]
    v_pk_fma_f32 v[32:33], v[148:149], v[84:85], v[32:33]
    v_pk_fma_f32 v[34:35], v[150:151], v[86:87], v[34:35]
    v_cvt_pk_bf16_f32 v120, v28, v29
    v_cvt_pk_bf16_f32 v121, v30, v31
    v_cvt_pk_bf16_f32 v122, v32, v33
    v_cvt_pk_bf16_f32 v123, v34, v35
    v_lshlrev_b32 v28, 16, v120
    v_and_b32 v29, 0xffff0000, v120
    v_lshlrev_b32 v30, 16, v121
    v_and_b32 v31, 0xffff0000, v121
    v_lshlrev_b32 v32, 16, v122
    v_and_b32 v33, 0xffff0000, v122
    v_lshlrev_b32 v34, 16, v123
    v_and_b32 v35, 0xffff0000, v123
    s_mov_b32 s45, 5242880
    buffer_store_dwordx4 v[120:123], v6, s[24:27], s45 offen offset:768 sc1
    v_pk_add_f32 v[48:49], v[48:49], v[28:29]
    v_pk_add_f32 v[50:51], v[50:51], v[30:31]
    v_pk_add_f32 v[48:49], v[48:49], v[32:33]
    v_pk_add_f32 v[50:51], v[50:51], v[34:35]
    v_pk_add_f32 v[48:49], v[48:49], v[50:51]
    v_add_f32 v48, v48, v49
    s_nop 1
    v_add_f32_dpp v48, v48, v48 row_ror:1 row_mask:0xf bank_mask:0xf
    s_nop 1
    v_add_f32_dpp v48, v48, v48 row_ror:2 row_mask:0xf bank_mask:0xf
    s_nop 1
    v_add_f32_dpp v48, v48, v48 row_ror:4 row_mask:0xf bank_mask:0xf
    s_nop 1
    v_add_f32_dpp v48, v48, v48 row_ror:8 row_mask:0xf bank_mask:0xf
    v_mov_b32 v52, v48
    s_nop 1
    v_permlane16_swap_b32 v48, v52
    s_nop 0
    v_add_f32 v48, v48, v52
    v_mul_f32 v48, 0x3ae38e39, v48
    v_pk_add_f32 v[88:89], v[12:13], v[48:49] op_sel_hi:[1,0] neg_lo:[0,1] neg_hi:[0,1]
    v_pk_add_f32 v[90:91], v[14:15], v[48:49] op_sel_hi:[1,0] neg_lo:[0,1] neg_hi:[0,1]
    v_pk_add_f32 v[92:93], v[16:17], v[48:49] op_sel_hi:[1,0] neg_lo:[0,1] neg_hi:[0,1]
    v_pk_add_f32 v[94:95], v[18:19], v[48:49] op_sel_hi:[1,0] neg_lo:[0,1] neg_hi:[0,1]
    v_pk_add_f32 v[96:97], v[20:21], v[48:49] op_sel_hi:[1,0] neg_lo:[0,1] neg_hi:[0,1]
    v_pk_add_f32 v[98:99], v[22:23], v[48:49] op_sel_hi:[1,0] neg_lo:[0,1] neg_hi:[0,1]
    v_pk_add_f32 v[100:101], v[24:25], v[48:49] op_sel_hi:[1,0] neg_lo:[0,1] neg_hi:[0,1]
    v_pk_add_f32 v[102:103], v[26:27], v[48:49] op_sel_hi:[1,0] neg_lo:[0,1] neg_hi:[0,1]
    v_pk_add_f32 v[104:105], v[28:29], v[48:49] op_sel_hi:[1,0] neg_lo:[0,1] neg_hi:[0,1]
    v_pk_add_f32 v[106:107], v[30:31], v[48:49] op_sel_hi:[1,0] neg_lo:[0,1] neg_hi:[0,1]
    v_pk_add_f32 v[108:109], v[32:33], v[48:49] op_sel_hi:[1,0] neg_lo:[0,1] neg_hi:[0,1]
    v_pk_add_f32 v[110:111], v[34:35], v[48:49] op_sel_hi:[1,0] neg_lo:[0,1] neg_hi:[0,1]
    v_pk_mul_f32 v[50:51], v[88:89], v[88:89]
    v_pk_mul_f32 v[52:53], v[90:91], v[90:91]
    v_pk_fma_f32 v[50:51], v[92:93], v[92:93], v[50:51]
    v_pk_fma_f32 v[52:53], v[94:95], v[94:95], v[52:53]
    v_pk_fma_f32 v[50:51], v[96:97], v[96:97], v[50:51]
    v_pk_fma_f32 v[52:53], v[98:99], v[98:99], v[52:53]
    v_pk_fma_f32 v[50:51], v[100:101], v[100:101], v[50:51]
    v_pk_fma_f32 v[52:53], v[102:103], v[102:103], v[52:53]
    v_pk_fma_f32 v[50:51], v[104:105], v[104:105], v[50:51]
    v_pk_fma_f32 v[52:53], v[106:107], v[106:107], v[52:53]
    v_pk_fma_f32 v[50:51], v[108:109], v[108:109], v[50:51]
    v_pk_fma_f32 v[52:53], v[110:111], v[110:111], v[52:53]
    v_pk_add_f32 v[50:51], v[50:51], v[52:53]
    v_add_f32 v50, v50, v51
    v_cndmask_b32 v50, 0, v50, vcc
    s_nop 1
    v_add_f32_dpp v50, v50, v50 row_ror:1 row_mask:0xf bank_mask:0xf
    s_nop 1
    v_add_f32_dpp v50, v50, v50 row_ror:2 row_mask:0xf bank_mask:0xf
    s_nop 1
    v_add_f32_dpp v50, v50, v50 row_ror:4 row_mask:0xf bank_mask:0xf
    s_nop 1
    v_add_f32_dpp v50, v50, v50 row_ror:8 row_mask:0xf bank_mask:0xf
    v_mov_b32 v52, v50
    s_nop 1
    v_permlane16_swap_b32 v50, v52
    s_nop 0
    v_add_f32 v50, v50, v52
    v_mul_f32 v50, 0x3ae38e39, v50
    v_cvt_pk_bf16_f32 v52, v48, v50
    v_and_b32 v50, 0xffff0000, v52
    v_lshlrev_b32 v52, 16, v52
    v_add_f32 v50, 0x3727c5ac, v50
    v_sub_f32 v48, v48, v52
    v_cvt_pk_bf16_f32 v50, v50, v50
    v_and_b32 v50, 0xffff0000, v50
    v_sqrt_f32 v50, v50
    s_nop 0
    v_cvt_pk_bf16_f32 v50, v50, v50
    v_and_b32 v50, 0xffff0000, v50
    v_rcp_f32 v50, v50
    s_mov_b32 s45, 2621440
    v_mul_f32 v48, v48, v50
    v_pk_fma_f32 v[88:89], v[88:89], v[50:51], v[48:49] op_sel_hi:[1,0,0]
    v_pk_fma_f32 v[90:91], v[90:91], v[50:51], v[48:49] op_sel_hi:[1,0,0]
    v_pk_fma_f32 v[92:93], v[92:93], v[50:51], v[48:49] op_sel_hi:[1,0,0]
    v_pk_fma_f32 v[94:95], v[94:95], v[50:51], v[48:49] op_sel_hi:[1,0,0]
    v_pk_fma_f32 v[96:97], v[96:97], v[50:51], v[48:49] op_sel_hi:[1,0,0]
    v_pk_fma_f32 v[98:99], v[98:99], v[50:51], v[48:49] op_sel_hi:[1,0,0]
    v_pk_fma_f32 v[100:101], v[100:101], v[50:51], v[48:49] op_sel_hi:[1,0,0]
    v_pk_fma_f32 v[102:103], v[102:103], v[50:51], v[48:49] op_sel_hi:[1,0,0]
    v_pk_fma_f32 v[104:105], v[104:105], v[50:51], v[48:49] op_sel_hi:[1,0,0]
    v_pk_fma_f32 v[106:107], v[106:107], v[50:51], v[48:49] op_sel_hi:[1,0,0]
    v_pk_fma_f32 v[108:109], v[108:109], v[50:51], v[48:49] op_sel_hi:[1,0,0]
    v_pk_fma_f32 v[110:111], v[110:111], v[50:51], v[48:49] op_sel_hi:[1,0,0]
    v_pk_fma_f32 v[88:89], v[88:89], v[152:153], v[176:177]
    v_pk_fma_f32 v[90:91], v[90:91], v[154:155], v[178:179]
    v_pk_fma_f32 v[92:93], v[92:93], v[156:157], v[180:181]
    v_pk_fma_f32 v[94:95], v[94:95], v[158:159], v[182:183]
    v_pk_fma_f32 v[96:97], v[96:97], v[160:161], v[184:185]
    v_pk_fma_f32 v[98:99], v[98:99], v[162:163], v[186:187]
    v_pk_fma_f32 v[100:101], v[100:101], v[164:165], v[188:189]
    v_pk_fma_f32 v[102:103], v[102:103], v[166:167], v[190:191]
    v_pk_fma_f32 v[104:105], v[104:105], v[168:169], v[192:193]
    v_pk_fma_f32 v[106:107], v[106:107], v[170:171], v[194:195]
    v_pk_fma_f32 v[108:109], v[108:109], v[172:173], v[196:197]
    v_pk_fma_f32 v[110:111], v[110:111], v[174:175], v[198:199]
    v_cvt_pk_bf16_f32 v36, v88, v89
    v_cvt_pk_bf16_f32 v37, v90, v91
    v_cvt_pk_bf16_f32 v38, v92, v93
    v_cvt_pk_bf16_f32 v39, v94, v95
    v_cvt_pk_bf16_f32 v40, v96, v97
    v_cvt_pk_bf16_f32 v41, v98, v99
    v_cvt_pk_bf16_f32 v42, v100, v101
    v_cvt_pk_bf16_f32 v43, v102, v103
    v_cvt_pk_bf16_f32 v44, v104, v105
    v_cvt_pk_bf16_f32 v45, v106, v107
    v_cvt_pk_bf16_f32 v46, v108, v109
    v_cvt_pk_bf16_f32 v47, v110, v111
    buffer_store_dwordx4 v[36:39], v6, s[24:27], s45 offen offset:0 sc1
    buffer_store_dwordx4 v[40:43], v6, s[24:27], s45 offen offset:384 sc1
    buffer_store_dwordx4 v[44:47], v6, s[24:27], s45 offen offset:768 sc1
    v_lshlrev_b32 v88, 16, v36
    v_and_b32 v89, 0xffff0000, v36
    v_lshlrev_b32 v90, 16, v37
    v_and_b32 v91, 0xffff0000, v37
    v_lshlrev_b32 v92, 16, v38
    v_and_b32 v93, 0xffff0000, v38
    v_lshlrev_b32 v94, 16, v39
    v_and_b32 v95, 0xffff0000, v39
    v_lshlrev_b32 v96, 16, v40
    v_and_b32 v97, 0xffff0000, v40
    v_lshlrev_b32 v98, 16, v41
    v_and_b32 v99, 0xffff0000, v41
Ltour12:
    s_cbranch_execz Ltour16
    v_lshlrev_b32 v100, 16, v42
    v_and_b32 v101, 0xffff0000, v42
    v_lshlrev_b32 v102, 16, v43
    v_and_b32 v103, 0xffff0000, v43
    v_lshlrev_b32 v104, 16, v44
    v_and_b32 v105, 0xffff0000, v44
    v_lshlrev_b32 v106, 16, v45
    v_and_b32 v107, 0xffff0000, v45
    v_lshlrev_b32 v108, 16, v46
    v_and_b32 v109, 0xffff0000, v46
    v_lshlrev_b32 v110, 16, v47
    v_and_b32 v111, 0xffff0000, v47
    v_pk_mul_f32 v[50:51], v[88:89], v[200:201]
    v_pk_mul_f32 v[52:53], v[90:91], v[202:203]
    v_pk_fma_f32 v[50:51], v[92:93], v[204:205], v[50:51]
    v_pk_fma_f32 v[52:53], v[94:95], v[206:207], v[52:53]
    v_pk_fma_f32 v[50:51], v[96:97], v[208:209], v[50:51]
    v_pk_fma_f32 v[52:53], v[98:99], v[210:211], v[52:53]
    v_pk_fma_f32 v[50:51], v[100:101], v[212:213], v[50:51]
    v_pk_fma_f32 v[52:53], v[102:103], v[214:215], v[52:53]
    v_pk_fma_f32 v[50:51], v[104:105], v[216:217], v[50:51]
    v_pk_fma_f32 v[52:53], v[106:107], v[218:219], v[52:53]
    v_pk_fma_f32 v[50:51], v[108:109], v[220:221], v[50:51]
    v_pk_fma_f32 v[52:53], v[110:111], v[222:223], v[52:53]
    v_pk_add_f32 v[50:51], v[50:51], v[52:53]
    v_add_f32 v50, v50, v51
    v_lshlrev_b32 v48, 2, v7
    v_and_b32 v48, 28, v48
    v_sub_u32 v49, 2047, v7
    v_add_f32_dpp v50, v50, v50 row_ror:1 row_mask:0xf bank_mask:0xf
    s_nop 1
    v_add_f32_dpp v50, v50, v50 row_ror:2 row_mask:0xf bank_mask:0xf
    s_nop 1
    v_add_f32_dpp v50, v50, v50 row_ror:4 row_mask:0xf bank_mask:0xf
    s_nop 1
    v_add_f32_dpp v50, v50, v50 row_ror:8 row_mask:0xf bank_mask:0xf
    v_mov_b32 v52, v50
    s_nop 1
    v_permlane16_swap_b32 v50, v52
    s_nop 0
    v_add_f32 v50, v50, v52
    v_ashrrev_i32 v52, 31, v50
    v_or_b32 v52, 0x80000000, v52
    v_xor_b32 v52, v52, v50
    v_and_b32 v52, 0xfffff800, v52
    v_min_u32 v52, 0xfffff000, v52
    v_or_b32 v52, v52, v49
    s_mov_b32 exec_lo, 1
    s_mov_b32 exec_hi, 1
    ds_write_b32 v48, v52 offset:53248
    s_mov_b64 exec, -1
    s_waitcnt lgkmcnt(0)
    s_barrier
    s_cmp_lg_u32 s3, 0
    s_cbranch_scc1 Ltail_notw0
    v_mov_b32 v141, 53248
    ds_read_b128 v[128:131], v141
    ds_read_b128 v[132:135], v141 offset:16
    s_lshl_b32 s45, s2, 7
    s_add_u32 s45, s45, 8912896
    s_waitcnt lgkmcnt(1)
    v_max_u32 v136, v128, v129
    v_min_u32 v137, v128, v129
    v_med3_u32 v137, v136, v137, v130
    v_max_u32 v136, v136, v130
    v_med3_u32 v137, v136, v137, v131
    v_max_u32 v136, v136, v131
    s_waitcnt lgkmcnt(0)
    v_med3_u32 v137, v136, v137, v132
    v_max_u32 v136, v136, v132
    v_med3_u32 v137, v136, v137, v133
    v_max_u32 v136, v136, v133
    v_med3_u32 v137, v136, v137, v134
    v_max_u32 v136, v136, v134
    v_med3_u32 v137, v136, v137, v135
    v_max_u32 v136, v136, v135
    buffer_store_dwordx2 v[136:137], v8, s[24:27], s45 offen sc1
Ltail_notw0:
    v_pk_mul_f32 v[224:225], v[224:225], v[88:89]
    v_pk_mul_f32 v[226:227], v[226:227], v[90:91]
    v_pk_mul_f32 v[228:229], v[228:229], v[92:93]
    v_pk_mul_f32 v[230:231], v[230:231], v[94:95]
    v_pk_mul_f32 v[232:233], v[232:233], v[96:97]
    v_pk_mul_f32 v[234:235], v[234:235], v[98:99]
    v_pk_mul_f32 v[236:237], v[236:237], v[100:101]
    v_pk_mul_f32 v[238:239], v[238:239], v[102:103]
    v_pk_mul_f32 v[240:241], v[240:241], v[104:105]
    v_pk_mul_f32 v[242:243], v[242:243], v[106:107]
    v_pk_mul_f32 v[244:245], v[244:245], v[108:109]
    v_pk_mul_f32 v[246:247], v[246:247], v[110:111]
    v_cvt_pk_bf16_f32 v208, v224, v225
    v_cvt_pk_bf16_f32 v209, v226, v227
    v_cvt_pk_bf16_f32 v210, v228, v229
    v_cvt_pk_bf16_f32 v211, v230, v231
    v_cvt_pk_bf16_f32 v212, v232, v233
    v_cvt_pk_bf16_f32 v213, v234, v235
    v_cvt_pk_bf16_f32 v214, v236, v237
    v_cvt_pk_bf16_f32 v215, v238, v239
    v_cvt_pk_bf16_f32 v216, v240, v241
    v_cvt_pk_bf16_f32 v217, v242, v243
    v_cvt_pk_bf16_f32 v218, v244, v245
    v_cvt_pk_bf16_f32 v219, v246, v247
    v_lshlrev_b32 v224, 16, v208
    v_and_b32 v225, 0xffff0000, v208
    v_lshlrev_b32 v226, 16, v209
    v_and_b32 v227, 0xffff0000, v209
    v_lshlrev_b32 v228, 16, v210
    v_and_b32 v229, 0xffff0000, v210
    v_lshlrev_b32 v230, 16, v211
    v_and_b32 v231, 0xffff0000, v211
    v_lshlrev_b32 v232, 16, v212
    v_and_b32 v233, 0xffff0000, v212
    v_lshlrev_b32 v234, 16, v213
    v_and_b32 v235, 0xffff0000, v213
    v_lshlrev_b32 v236, 16, v214
    v_and_b32 v237, 0xffff0000, v214
    v_lshlrev_b32 v238, 16, v215
    v_and_b32 v239, 0xffff0000, v215
    v_lshlrev_b32 v240, 16, v216
    v_and_b32 v241, 0xffff0000, v216
    v_lshlrev_b32 v242, 16, v217
    v_and_b32 v243, 0xffff0000, v217
    v_lshlrev_b32 v244, 16, v218
    v_and_b32 v245, 0xffff0000, v218
    v_lshlrev_b32 v246, 16, v219
    v_and_b32 v247, 0xffff0000, v219
    v_pk_add_f32 v[224:225], v[224:225], v[12:13]
    v_pk_add_f32 v[226:227], v[226:227], v[14:15]
    v_pk_add_f32 v[228:229], v[228:229], v[16:17]
    v_pk_add_f32 v[230:231], v[230:231], v[18:19]
    v_pk_add_f32 v[232:233], v[232:233], v[20:21]
    v_pk_add_f32 v[234:235], v[234:235], v[22:23]
    v_pk_add_f32 v[236:237], v[236:237], v[24:25]
    v_pk_add_f32 v[238:239], v[238:239], v[26:27]
    v_pk_add_f32 v[240:241], v[240:241], v[28:29]
    v_pk_add_f32 v[242:243], v[242:243], v[30:31]
    v_pk_add_f32 v[244:245], v[244:245], v[32:33]
    v_pk_add_f32 v[246:247], v[246:247], v[34:35]
    v_cvt_pk_bf16_f32 v208, v224, v225
    v_cvt_pk_bf16_f32 v209, v226, v227
    v_cvt_pk_bf16_f32 v210, v228, v229
    v_cvt_pk_bf16_f32 v211, v230, v231
    v_cvt_pk_bf16_f32 v212, v232, v233
    v_cvt_pk_bf16_f32 v213, v234, v235
    v_cvt_pk_bf16_f32 v214, v236, v237
    v_cvt_pk_bf16_f32 v215, v238, v239
    v_cvt_pk_bf16_f32 v216, v240, v241
    v_cvt_pk_bf16_f32 v217, v242, v243
    v_cvt_pk_bf16_f32 v218, v244, v245
    v_cvt_pk_bf16_f32 v219, v246, v247
    s_mov_b32 s38, 135168
    s_mov_b32 s39, 8192
    v_lshrrev_b32 v9, 2, v1
    v_and_b32 v10, 3, v1
    v_lshlrev_b32 v10, 3, v10
    s_and_b32 s45, s3, 1
    s_lshl_b32 s45, s45, 5
    v_lshl_add_u32 v11, v9, 6, v10
    v_add_u32 v11, s45, v11
    s_cmp_lt_u32 s3, 2
    s_cselect_b32 s44, 98304, s38
    s_cselect_b32 s45, 98304, s39
    v_add_u32 v12, s45, v11
    v_add_u32 v11, s44, v11
    ds_read_b64_tr_b16 a[0:1], v11 offset:0
    ds_read_b64_tr_b16 a[2:3], v11 offset:1024
    ds_read_b64_tr_b16 a[4:5], v11 offset:2048
    ds_read_b64_tr_b16 a[6:7], v11 offset:3072
    ds_read_b64_tr_b16 a[8:9], v11 offset:4096
    ds_read_b64_tr_b16 a[10:11], v11 offset:5120
    ds_read_b64_tr_b16 a[12:13], v11 offset:6144
    ds_read_b64_tr_b16 a[14:15], v11 offset:7168
    ds_read_b64_tr_b16 a[16:17], v11 offset:8192
    ds_read_b64_tr_b16 a[18:19], v11 offset:9216
    ds_read_b64_tr_b16 a[20:21], v11 offset:10240
    ds_read_b64_tr_b16 a[22:23], v11 offset:11264
    ds_read_b64_tr_b16 a[24:25], v11 offset:12288
    ds_read_b64_tr_b16 a[26:27], v11 offset:13312
    ds_read_b64_tr_b16 a[28:29], v11 offset:14336
    ds_read_b64_tr_b16 a[30:31], v11 offset:15360
    ds_read_b64_tr_b16 a[32:33], v11 offset:16384
    ds_read_b64_tr_b16 a[34:35], v11 offset:17408
    ds_read_b64_tr_b16 a[36:37], v11 offset:18432
    ds_read_b64_tr_b16 a[38:39], v11 offset:19456
    ds_read_b64_tr_b16 a[40:41], v11 offset:20480
    ds_read_b64_tr_b16 a[42:43], v11 offset:21504
    ds_read_b64_tr_b16 a[44:45], v11 offset:22528
    ds_read_b64_tr_b16 a[46:47], v11 offset:23552
    ds_read_b64_tr_b16 a[48:49], v11 offset:24576
    ds_read_b64_tr_b16 a[50:51], v11 offset:25600
    ds_read_b64_tr_b16 a[52:53], v11 offset:26624
    ds_read_b64_tr_b16 a[54:55], v11 offset:27648
    ds_read_b64_tr_b16 a[56:57], v12 offset:28672
    ds_read_b64_tr_b16 a[58:59], v12 offset:29696
    ds_read_b64_tr_b16 a[60:61], v12 offset:30720
    ds_read_b64_tr_b16 a[62:63], v12 offset:31744
    ds_read_b64_tr_b16 a[64:65], v12 offset:32768
    ds_read_b64_tr_b16 a[66:67], v12 offset:33792
    ds_read_b64_tr_b16 a[68:69], v12 offset:34816
    ds_read_b64_tr_b16 a[70:71], v12 offset:35840
    v_mul_u32_u24 v12, 1152, v9
    s_lshl_b32 s44, s3, 7
    s_add_u32 s44, s44, 0
    v_add3_u32 v12, v12, v10, s44
    ds_read_b64_tr_b16 a[72:73], v12 offset:0
    ds_read_b64_tr_b16 a[74:75], v12 offset:18432
    ds_read_b64_tr_b16 a[76:77], v12 offset:32
    ds_read_b64_tr_b16 a[78:79], v12 offset:18464
    ds_read_b64_tr_b16 a[80:81], v12 offset:64
    ds_read_b64_tr_b16 a[82:83], v12 offset:18496
    ds_read_b64_tr_b16 a[84:85], v12 offset:96
    ds_read_b64_tr_b16 a[86:87], v12 offset:18528
    ds_read_b64_tr_b16 a[88:89], v12 offset:512
    ds_read_b64_tr_b16 a[90:91], v12 offset:18944
    ds_read_b64_tr_b16 a[92:93], v12 offset:544
    ds_read_b64_tr_b16 a[94:95], v12 offset:18976
    ds_read_b64_tr_b16 a[96:97], v12 offset:576
    ds_read_b64_tr_b16 a[98:99], v12 offset:19008
    ds_read_b64_tr_b16 a[100:101], v12 offset:608
    ds_read_b64_tr_b16 a[102:103], v12 offset:19040
    ds_read_b64_tr_b16 a[104:105], v12 offset:1024
    ds_read_b64_tr_b16 a[106:107], v12 offset:19456
    ds_read_b64_tr_b16 a[108:109], v12 offset:1056
    ds_read_b64_tr_b16 a[110:111], v12 offset:19488
    ds_read_b64_tr_b16 a[112:113], v12 offset:1088
    ds_read_b64_tr_b16 a[114:115], v12 offset:19520
    ds_read_b64_tr_b16 a[116:117], v12 offset:1120
    ds_read_b64_tr_b16 a[118:119], v12 offset:19552
    v_lshlrev_b32 v13, 4, v1
    v_add_u32 v13, 49152, v13
    s_lshl_b32 s44, s3, 10
    v_add_u32 v14, s44, v13
    v_bfe_u32 v15, v1, 2, 2
    v_cmp_eq_u32 s[52:53], 0, v15
    v_cmp_eq_u32 s[54:55], 1, v15
    v_cmp_eq_u32 s[56:57], 2, v15
    v_cmp_eq_u32 s[58:59], 3, v15
    s_mul_i32 s43, s42, 18
    s_add_u32 s43, s43, s41
    s_lshl_b32 s43, s43, 9
    s_mul_i32 s44, s3, 73728
    s_add_u32 s43, s43, s44
    v_lshlrev_b32 v15, 3, v1
    v_lshlrev_b32 v140, 7, v0
    s_mov_b32 s45, 8912896
    s_lshl_b32 s36, s3, 3
    v_mov_b32 v141, s36
    s_mov_b32 s48, 16384
Ltail_pollk:
    buffer_load_dwordx2 v[136:137], v140, s[24:27], s45 offen sc1
    s_sub_u32 s48, s48, 1
    s_cbranch_scc1 Ltail_gotk
    s_waitcnt vmcnt(0)
    v_max_u32 v138, v136, v137
    v_cmp_eq_u32 vcc, -1, v138
    s_cbranch_vccnz Ltail_pollk
Ltail_gotk:
    s_waitcnt vmcnt(0)
    v_mov_b32_dpp v138, v136 row_ror:1 row_mask:0xf bank_mask:0xf
    v_mov_b32_dpp v139, v137 row_ror:1 row_mask:0xf bank_mask:0xf
    v_min_u32 v142, v136, v138
    v_max_u32 v136, v136, v138
    v_max3_u32 v137, v142, v137, v139
    s_nop 0
    v_mov_b32_dpp v138, v136 row_ror:2 row_mask:0xf bank_mask:0xf
    v_mov_b32_dpp v139, v137 row_ror:2 row_mask:0xf bank_mask:0xf
    v_min_u32 v142, v136, v138
    v_max_u32 v136, v136, v138
    v_max3_u32 v137, v142, v137, v139
    s_nop 0
    v_mov_b32_dpp v138, v136 row_ror:4 row_mask:0xf bank_mask:0xf
    v_mov_b32_dpp v139, v137 row_ror:4 row_mask:0xf bank_mask:0xf
    v_min_u32 v142, v136, v138
    v_max_u32 v136, v136, v138
    v_max3_u32 v137, v142, v137, v139
    s_nop 0
    v_mov_b32_dpp v138, v136 row_ror:8 row_mask:0xf bank_mask:0xf
    v_mov_b32_dpp v139, v137 row_ror:8 row_mask:0xf bank_mask:0xf
    v_min_u32 v142, v136, v138
    v_max_u32 v136, v136, v138
    v_max3_u32 v137, v142, v137, v139
    v_mov_b32 v138, v136
    v_mov_b32 v139, v137
    s_nop 0
    v_permlane16_swap_b32 v136, v138
    v_permlane16_swap_b32 v137, v139
    v_min_u32 v142, v136, v138
    v_max_u32 v136, v136, v138
    v_max3_u32 v137, v142, v137, v139
    v_mov_b32 v138, v136
    v_mov_b32 v139, v137
    s_nop 0
    v_permlane32_swap_b32 v136, v138
    v_permlane32_swap_b32 v137, v139
    v_min_u32 v142, v136, v138
    v_max_u32 v136, v136, v138
    v_max3_u32 v137, v142, v137, v139
    ds_write_b64 v141, v[136:137] offset:53312
    v_mov_b32 v141, 53312
    s_waitcnt lgkmcnt(0)
    s_barrier
    ds_read_b128 v[128:131], v141
    ds_read_b128 v[132:135], v141 offset:16
    s_or_b32 s36, s2, s3
    s_cselect_b32 s45, -4, 24576
    s_add_u32 s36, s94, 1
    v_mov_b32 v138, s36
    buffer_store_dword v138, v8, s[24:27], s45 offen
    s_waitcnt lgkmcnt(1)
    v_max_u32 v136, v128, v129
    v_min_u32 v137, v128, v129
    v_med3_u32 v137, v136, v137, v130
    v_max_u32 v136, v136, v130
    v_med3_u32 v137, v136, v137, v131
    v_max_u32 v136, v136, v131
    s_waitcnt lgkmcnt(0)
    v_med3_u32 v137, v136, v137, v132
    v_max_u32 v136, v136, v132
    v_med3_u32 v137, v136, v137, v133
    v_max_u32 v136, v136, v133
    v_med3_u32 v137, v136, v137, v134
    v_max_u32 v136, v136, v134
    v_med3_u32 v137, v136, v137, v135
    v_max_u32 v136, v136, v135
    s_nop 0
    v_readfirstlane_b32 s92, v136
    v_readfirstlane_b32 s93, v137
    s_andn2_b32 s46, 0x7ff, s92
    s_andn2_b32 s47, 0x7ff, s93
    s_cmp_ge_u32 s41, 18
    s_cbranch_scc1 Ltail_noffn
    s_mul_i32 s44, s46, 1152
    s_mul_i32 s45, s47, 1152
    s_sub_u32 s45, s45, s44
    v_and_b32 v8, 1, v1
    v_mul_lo_u32 v8, v8, s45
    v_and_b32 v9, 48, v1
    v_add3_u32 v8, v8, v9, s44
    s_mov_b32 s45, 2621440
    s_mov_b32 s48, 16384
Ltail_pollh:
    buffer_load_dwordx4 a[120:123], v8, s[24:27], s45 offen offset:0 sc1
    buffer_load_dwordx4 a[124:127], v8, s[24:27], s45 offen offset:64 sc1
    buffer_load_dwordx4 a[128:131], v8, s[24:27], s45 offen offset:128 sc1
    buffer_load_dwordx4 a[132:135], v8, s[24:27], s45 offen offset:192 sc1
    buffer_load_dwordx4 a[136:139], v8, s[24:27], s45 offen offset:256 sc1
    buffer_load_dwordx4 a[140:143], v8, s[24:27], s45 offen offset:320 sc1
    buffer_load_dwordx4 a[144:147], v8, s[24:27], s45 offen offset:384 sc1
    buffer_load_dwordx4 a[148:151], v8, s[24:27], s45 offen offset:448 sc1
    buffer_load_dwordx4 a[152:155], v8, s[24:27], s45 offen offset:512 sc1
    buffer_load_dwordx4 a[156:159], v8, s[24:27], s45 offen offset:576 sc1
    buffer_load_dwordx4 a[160:163], v8, s[24:27], s45 offen offset:640 sc1
    buffer_load_dwordx4 a[164:167], v8, s[24:27], s45 offen offset:704 sc1
    buffer_load_dwordx4 a[168:171], v8, s[24:27], s45 offen offset:768 sc1
    buffer_load_dwordx4 a[172:175], v8, s[24:27], s45 offen offset:832 sc1
    buffer_load_dwordx4 a[176:179], v8, s[24:27], s45 offen offset:896 sc1
    buffer_load_dwordx4 a[180:183], v8, s[24:27], s45 offen offset:960 sc1
    buffer_load_dwordx4 a[184:187], v8, s[24:27], s45 offen offset:1024 sc1
    buffer_load_dwordx4 a[188:191], v8, s[24:27], s45 offen offset:1088 sc1
    s_waitcnt vmcnt(17)
    v_mfma_f32_16x16x32_bf16 v[16:19], a[0:3], a[120:123], 0
    s_waitcnt vmcnt(16)
    v_mfma_f32_16x16x32_bf16 v[20:23], a[4:7], a[124:127], 0
    s_waitcnt vmcnt(15)
    v_mfma_f32_16x16x32_bf16 v[16:19], a[8:11], a[128:131], v[16:19]
    s_waitcnt vmcnt(14)
    v_mfma_f32_16x16x32_bf16 v[20:23], a[12:15], a[132:135], v[20:23]
    s_waitcnt vmcnt(13)
    v_mfma_f32_16x16x32_bf16 v[16:19], a[16:19], a[136:139], v[16:19]
    s_waitcnt vmcnt(12)
    v_mfma_f32_16x16x32_bf16 v[20:23], a[20:23], a[140:143], v[20:23]
    s_waitcnt vmcnt(11)
    v_mfma_f32_16x16x32_bf16 v[16:19], a[24:27], a[144:147], v[16:19]
    s_waitcnt vmcnt(10)
    v_mfma_f32_16x16x32_bf16 v[20:23], a[28:31], a[148:151], v[20:23]
    s_waitcnt vmcnt(9)
    v_mfma_f32_16x16x32_bf16 v[16:19], a[32:35], a[152:155], v[16:19]
    s_waitcnt vmcnt(8)
    v_mfma_f32_16x16x32_bf16 v[20:23], a[36:39], a[156:159], v[20:23]
    s_waitcnt vmcnt(7)
    v_mfma_f32_16x16x32_bf16 v[16:19], a[40:43], a[160:163], v[16:19]
    s_waitcnt vmcnt(6)
    v_mfma_f32_16x16x32_bf16 v[20:23], a[44:47], a[164:167], v[20:23]
    s_waitcnt vmcnt(5)
    v_mfma_f32_16x16x32_bf16 v[16:19], a[48:51], a[168:171], v[16:19]
    s_waitcnt vmcnt(4)
    v_mfma_f32_16x16x32_bf16 v[20:23], a[52:55], a[172:175], v[20:23]
    s_waitcnt vmcnt(3)
    v_mfma_f32_16x16x32_bf16 v[16:19], a[56:59], a[176:179], v[16:19]
    s_waitcnt vmcnt(2)
    v_mfma_f32_16x16x32_bf16 v[20:23], a[60:63], a[180:183], v[20:23]
    s_waitcnt vmcnt(1)
    v_mfma_f32_16x16x32_bf16 v[16:19], a[64:67], a[184:187], v[16:19]
    s_waitcnt vmcnt(0)
    v_mfma_f32_16x16x32_bf16 v[20:23], a[68:71], a[188:191], v[20:23]
    s_sub_u32 s48, s48, 1
    s_nop 6
    v_pk_add_f32 v[16:17], v[16:17], v[20:21]
    v_pk_add_f32 v[18:19], v[18:19], v[22:23]
    s_cbranch_scc1 Ltail_goth
    v_cmp_u_f32 vcc, v16, v16
    s_cbranch_vccnz Ltail_pollh
Ltail_goth:
    ds_write_b128 v14, v[16:19]
    s_waitcnt lgkmcnt(0)
    s_barrier
    ds_read_b128 v[16:19], v13 offset:0
    ds_read_b128 v[20:23], v13 offset:1024
    ds_read_b128 v[24:27], v13 offset:2048
    ds_read_b128 v[28:31], v13 offset:3072
    s_mov_b32 s36, 0xbfb8aa3b
    s_mov_b32 s37, 0xbfb8aa3b
    s_waitcnt lgkmcnt(3)
    v_cvt_pk_bf16_f32 v32, v16, v17
    v_cvt_pk_bf16_f32 v33, v18, v19
    s_waitcnt lgkmcnt(2)
    v_cvt_pk_bf16_f32 v34, v20, v21
    v_cvt_pk_bf16_f32 v35, v22, v23
    v_lshlrev_b32 v16, 16, v32
    v_and_b32 v17, 0xffff0000, v32
    v_lshlrev_b32 v18, 16, v33
    v_and_b32 v19, 0xffff0000, v33
    v_lshlrev_b32 v20, 16, v34
    v_and_b32 v21, 0xffff0000, v34
    v_lshlrev_b32 v22, 16, v35
    v_and_b32 v23, 0xffff0000, v35
    v_pk_mul_f32 v[32:33], v[16:17], s[36:37]
    v_pk_mul_f32 v[34:35], v[18:19], s[36:37]
    v_pk_mul_f32 v[36:37], v[20:21], s[36:37]
    v_pk_mul_f32 v[38:39], v[22:23], s[36:37]
    v_exp_f32 v32, v32
    v_exp_f32 v33, v33
    v_exp_f32 v34, v34
    v_exp_f32 v35, v35
    v_exp_f32 v36, v36
    v_exp_f32 v37, v37
    v_exp_f32 v38, v38
    v_exp_f32 v39, v39
    s_waitcnt lgkmcnt(1)
    v_cvt_pk_bf16_f32 v60, v24, v25
    v_cvt_pk_bf16_f32 v61, v26, v27
    s_waitcnt lgkmcnt(0)
    v_cvt_pk_bf16_f32 v62, v28, v29
    v_cvt_pk_bf16_f32 v63, v30, v31
    v_pk_add_f32 v[32:33], v[32:33], 1.0 op_sel_hi:[1,0]
    v_pk_add_f32 v[34:35], v[34:35], 1.0 op_sel_hi:[1,0]
    v_pk_add_f32 v[36:37], v[36:37], 1.0 op_sel_hi:[1,0]
    v_pk_add_f32 v[38:39], v[38:39], 1.0 op_sel_hi:[1,0]
    v_rcp_f32 v32, v32
    v_rcp_f32 v33, v33
    v_rcp_f32 v34, v34
    v_rcp_f32 v35, v35
    v_rcp_f32 v36, v36
    v_rcp_f32 v37, v37
    v_rcp_f32 v38, v38
    v_rcp_f32 v39, v39
    v_lshlrev_b32 v24, 16, v60
    v_and_b32 v25, 0xffff0000, v60
    v_lshlrev_b32 v26, 16, v61
    v_and_b32 v27, 0xffff0000, v61
    v_lshlrev_b32 v28, 16, v62
    v_and_b32 v29, 0xffff0000, v62
    v_lshlrev_b32 v30, 16, v63
    v_and_b32 v31, 0xffff0000, v63
    v_pk_mul_f32 v[16:17], v[16:17], v[32:33]
    v_pk_mul_f32 v[18:19], v[18:19], v[34:35]
    v_pk_mul_f32 v[20:21], v[20:21], v[36:37]
    v_pk_mul_f32 v[22:23], v[22:23], v[38:39]
    v_cvt_pk_bf16_f32 v32, v16, v17
    v_cvt_pk_bf16_f32 v33, v18, v19
    v_cvt_pk_bf16_f32 v34, v20, v21
    v_cvt_pk_bf16_f32 v35, v22, v23
    v_lshlrev_b32 v16, 16, v32
    v_and_b32 v17, 0xffff0000, v32
    v_lshlrev_b32 v18, 16, v33
    v_and_b32 v19, 0xffff0000, v33
    v_lshlrev_b32 v20, 16, v34
    v_and_b32 v21, 0xffff0000, v34
    v_lshlrev_b32 v22, 16, v35
    v_and_b32 v23, 0xffff0000, v35
    v_pk_mul_f32 v[16:17], v[16:17], v[24:25]
    v_pk_mul_f32 v[18:19], v[18:19], v[26:27]
    v_pk_mul_f32 v[20:21], v[20:21], v[28:29]
    v_pk_mul_f32 v[22:23], v[22:23], v[30:31]
    v_cvt_pk_bf16_f32 v32, v16, v17
    v_cvt_pk_bf16_f32 v33, v18, v19
    v_cvt_pk_bf16_f32 v34, v20, v21
    v_cvt_pk_bf16_f32 v35, v22, v23
    v_cndmask_b32 v64, 0, v32, s[52:53]
    v_cndmask_b32 v65, 0, v33, s[52:53]
    v_cndmask_b32 v66, 0, v34, s[52:53]
    v_cndmask_b32 v67, 0, v35, s[52:53]
    v_cndmask_b32 v68, 0, v32, s[54:55]
    v_cndmask_b32 v69, 0, v33, s[54:55]
    v_cndmask_b32 v70, 0, v34, s[54:55]
    v_cndmask_b32 v71, 0, v35, s[54:55]
    v_cndmask_b32 v72, 0, v32, s[56:57]
    v_cndmask_b32 v73, 0, v33, s[56:57]
    v_cndmask_b32 v74, 0, v34, s[56:57]
    v_cndmask_b32 v75, 0, v35, s[56:57]
    v_cndmask_b32 v76, 0, v32, s[58:59]
    v_cndmask_b32 v77, 0, v33, s[58:59]
    v_cndmask_b32 v78, 0, v34, s[58:59]
    v_cndmask_b32 v79, 0, v35, s[58:59]
    v_mfma_f32_16x16x32_bf16 v[16:19], v[64:67], a[72:75], 0
    v_mfma_f32_16x16x32_bf16 v[16:19], v[68:71], a[76:79], v[16:19]
    v_mfma_f32_16x16x32_bf16 v[16:19], v[72:75], a[80:83], v[16:19]
    v_mfma_f32_16x16x32_bf16 v[16:19], v[76:79], a[84:87], v[16:19]
    v_mfma_f32_16x16x32_bf16 v[20:23], v[64:67], a[88:91], 0
    v_mfma_f32_16x16x32_bf16 v[20:23], v[68:71], a[92:95], v[20:23]
    v_mfma_f32_16x16x32_bf16 v[20:23], v[72:75], a[96:99], v[20:23]
    v_mfma_f32_16x16x32_bf16 v[20:23], v[76:79], a[100:103], v[20:23]
    v_mfma_f32_16x16x32_bf16 v[24:27], v[64:67], a[104:107], 0
    v_mfma_f32_16x16x32_bf16 v[24:27], v[68:71], a[108:111], v[24:27]
    v_mfma_f32_16x16x32_bf16 v[24:27], v[72:75], a[112:115], v[24:27]
    v_mfma_f32_16x16x32_bf16 v[24:27], v[76:79], a[116:119], v[24:27]
    v_min_u32 v16, -2, v16
    v_min_u32 v17, -2, v17
    buffer_store_dwordx2 v[16:17], v15, s[8:11], s43 offen sc1
    s_add_u32 s43, s43, 294912
    v_min_u32 v20, -2, v20
    v_min_u32 v21, -2, v21
    buffer_store_dwordx2 v[20:21], v15, s[8:11], s43 offen sc1
    s_add_u32 s43, s43, 294912
    v_min_u32 v24, -2, v24
    v_min_u32 v25, -2, v25
    buffer_store_dwordx2 v[24:25], v15, s[8:11], s43 offen sc1
    v_cmp_ne_u32 vcc, s46, v7
    v_cmp_ne_u32 s[36:37], s47, v7
    v_mov_b32 v31, 2147483648
    s_and_b64 vcc, vcc, s[36:37]
    s_nop 1
    v_cndmask_b32 v31, v31, v4, vcc
    buffer_store_dwordx2 v[208:209], v31, s[16:19], 0 offen offset:0
    buffer_store_dwordx2 v[210:211], v31, s[16:19], 0 offen offset:32
    buffer_store_dwordx2 v[212:213], v31, s[16:19], 0 offen offset:384
    buffer_store_dwordx2 v[214:215], v31, s[16:19], 0 offen offset:416
    buffer_store_dwordx2 v[216:217], v31, s[16:19], 0 offen offset:768
    buffer_store_dwordx2 v[218:219], v31, s[16:19], 0 offen offset:800
    s_branch Ltail_done
Ltail_noffn:
Ltour13:
    s_cbranch_execz Ltour17
    s_cmp_lt_u32 s41, 27
    s_cselect_b32 s36, s3, 1
    s_cmp_eq_u32 s36, 0
    s_cbranch_scc1 Ltail_final
    v_cmp_ne_u32 vcc, s46, v7
    v_cmp_ne_u32 s[36:37], s47, v7
    v_mov_b32 v31, 2147483648
    s_and_b64 vcc, vcc, s[36:37]
    s_nop 1
    v_cndmask_b32 v31, v31, v4, vcc
    buffer_store_dwordx2 v[208:209], v31, s[16:19], 0 offen offset:0
    buffer_store_dwordx2 v[210:211], v31, s[16:19], 0 offen offset:32
    buffer_store_dwordx2 v[212:213], v31, s[16:19], 0 offen offset:384
    buffer_store_dwordx2 v[214:215], v31, s[16:19], 0 offen offset:416
    buffer_store_dwordx2 v[216:217], v31, s[16:19], 0 offen offset:768
    buffer_store_dwordx2 v[218:219], v31, s[16:19], 0 offen offset:800
    s_branch Ltail_done
Ltail_final:
Ltour14:
    s_cbranch_execz Lmain
    s_mul_i32 s43, s42, 9
    s_add_u32 s43, s43, s41
    s_sub_u32 s43, s43, 18
    v_bfe_u32 v8, v1, 2, 1
    v_cmp_eq_u32 vcc, 1, v8
    v_mov_b32 v9, s46
    v_mov_b32 v10, s47
    v_and_b32 v11, 3, v1
    v_cndmask_b32 v9, v9, v10, vcc
    s_lshr_b32 s44, s43, 2
    s_lshl_b32 s44, s44, 6
    s_and_b32 s45, s43, 1
    s_lshl_b32 s45, s45, 5
    s_add_u32 s44, s44, s45
    s_and_b32 s45, s43, 2
    s_lshl_b32 s45, s45, 2
    s_add_u32 s44, s44, s45
    v_lshrrev_b32 v12, 1, v11
    v_lshl_add_u32 v12, v12, 4, s44
    v_and_b32 v13, 1, v11
    v_lshl_add_u32 v12, v13, 2, v12
    v_mul_u32_u24 v13, 1152, v9
    v_add_u32 v14, v13, v12
    v_add_u32 v15, 2621440, v14
    s_mov_b32 s45, 22144
    buffer_load_dword v18, v12, s[24:27], s45 offen sc1
    v_mov_b32 v19, s92
    v_mov_b32 v10, s93
    v_cndmask_b32 v19, v19, v10, vcc
    v_and_b32 v19, 0xfffff800, v19
    v_or_b32 v19, 0x400, v19
    v_ashrrev_i32 v10, 31, v19
    v_not_b32 v10, v10
    v_or_b32 v10, 0x80000000, v10
    v_xor_b32 v19, v19, v10
    s_lshl_b32 s45, s43, 4
    v_lshl_add_u32 v13, v11, 2, v13
    v_add_u32 v13, s45, v13
    v_lshrrev_b32 v14, 2, v1
    v_lshlrev_b32 v14, 9, v14
    v_lshl_add_u32 v14, v11, 4, v14
    s_lshr_b32 s44, s43, 3
    s_mul_i32 s44, s44, 73728
    s_and_b32 s45, s43, 7
    s_lshl_b32 s45, s45, 6
    s_add_u32 s44, s44, s45
    v_cmp_ne_u32 vcc, s46, v7
    v_cmp_ne_u32 s[36:37], s47, v7
    v_mov_b32 v31, 2147483648
    s_and_b64 vcc, vcc, s[36:37]
    s_nop 1
    v_cndmask_b32 v31, v31, v4, vcc
    buffer_store_dwordx2 v[208:209], v31, s[16:19], 0 offen offset:0
    buffer_store_dwordx2 v[210:211], v31, s[16:19], 0 offen offset:32
    buffer_store_dwordx2 v[212:213], v31, s[16:19], 0 offen offset:384
    buffer_store_dwordx2 v[214:215], v31, s[16:19], 0 offen offset:416
    buffer_store_dwordx2 v[216:217], v31, s[16:19], 0 offen offset:768
    buffer_store_dwordx2 v[218:219], v31, s[16:19], 0 offen offset:800
    v_cmp_eq_u32 s[36:37], 1, v8
    v_cvt_pk_bf16_f32 v19, v19, v19
    v_and_b32 v19, 0xffff0000, v19
    v_mul_f32 v19, 0xbfb8aa3b, v19
    v_exp_f32 v19, v19
    s_waitcnt vmcnt(6)
    v_lshlrev_b32 v24, 16, v18
    v_and_b32 v25, 0xffff0000, v18
    v_add_f32 v19, 1.0, v19
    v_rcp_f32 v19, v19
    s_mov_b32 s48, 16384
    v_cvt_pk_bf16_f32 v19, v19, v19
    v_and_b32 v19, 0xffff0000, v19
Ltail_polly:
    s_add_u32 s45, s44, 0
    buffer_load_dwordx4 v[64:67], v14, s[8:11], s45 offen sc1
    s_add_u32 s45, s44, 8192
    buffer_load_dwordx4 v[68:71], v14, s[8:11], s45 offen sc1
    s_add_u32 s45, s44, 16384
    buffer_load_dwordx4 v[72:75], v14, s[8:11], s45 offen sc1
    s_add_u32 s45, s44, 24576
    buffer_load_dwordx4 v[76:79], v14, s[8:11], s45 offen sc1
    s_add_u32 s45, s44, 32768
    buffer_load_dwordx4 v[80:83], v14, s[8:11], s45 offen sc1
    s_add_u32 s45, s44, 40960
Ltour15:
    s_cbranch_execz Lmain
    buffer_load_dwordx4 v[84:87], v14, s[8:11], s45 offen sc1
    s_add_u32 s45, s44, 49152
    buffer_load_dwordx4 v[88:91], v14, s[8:11], s45 offen sc1
    s_add_u32 s45, s44, 57344
    buffer_load_dwordx4 v[92:95], v14, s[8:11], s45 offen sc1
    s_add_u32 s45, s44, 65536
    buffer_load_dwordx4 v[96:99], v14, s[8:11], s45 offen sc1
    s_mov_b32 s45, 2621440
    buffer_load_dword v16, v15, s[24:27], s45 offen sc1
    buffer_load_dword v17, v15, s[24:27], 0 offen sc1
    s_sub_u32 s48, s48, 1
    s_cbranch_scc1 Ltail_goty
    s_waitcnt vmcnt(10)
    v_max3_u32 v26, v64, v65, v66
    s_waitcnt vmcnt(9)
    v_max3_u32 v26, v26, v67, v68
    v_max3_u32 v26, v26, v69, v70
    s_waitcnt vmcnt(8)
    v_max3_u32 v26, v26, v71, v72
    v_max3_u32 v26, v26, v73, v74
    s_waitcnt vmcnt(7)
    v_max3_u32 v26, v26, v75, v76
    v_max3_u32 v26, v26, v77, v78
    s_waitcnt vmcnt(6)
    v_max3_u32 v26, v26, v79, v80
    v_max3_u32 v26, v26, v81, v82
    s_waitcnt vmcnt(5)
    v_max3_u32 v26, v26, v83, v84
    v_max3_u32 v26, v26, v85, v86
    s_waitcnt vmcnt(4)
    v_max3_u32 v26, v26, v87, v88
    v_max3_u32 v26, v26, v89, v90
    s_waitcnt vmcnt(3)
    v_max3_u32 v26, v26, v91, v92
    v_max3_u32 v26, v26, v93, v94
    s_waitcnt vmcnt(2)
    v_max3_u32 v26, v26, v95, v96
    v_max3_u32 v26, v26, v97, v98
    v_max_u32 v26, v26, v99
    s_waitcnt vmcnt(0)
    v_max3_u32 v26, v26, v16, v17
    v_cmp_eq_u32 vcc, -1, v26
    s_cbranch_vccnz Ltail_polly
Ltail_goty:
    s_waitcnt vmcnt(0) lgkmcnt(0)
    v_lshlrev_b32 v20, 16, v16
    v_and_b32 v21, 0xffff0000, v16
    v_lshlrev_b32 v22, 16, v17
    v_and_b32 v23, 0xffff0000, v17
    v_pk_add_f32 v[64:65], v[64:65], v[68:69]
    v_pk_add_f32 v[66:67], v[66:67], v[70:71]
    v_pk_add_f32 v[64:65], v[64:65], v[72:73]
    v_pk_add_f32 v[66:67], v[66:67], v[74:75]
    v_pk_add_f32 v[64:65], v[64:65], v[76:77]
    v_pk_add_f32 v[66:67], v[66:67], v[78:79]
    v_pk_add_f32 v[64:65], v[64:65], v[80:81]
    v_pk_add_f32 v[66:67], v[66:67], v[82:83]
    v_pk_add_f32 v[64:65], v[64:65], v[84:85]
    v_pk_add_f32 v[66:67], v[66:67], v[86:87]
    v_pk_add_f32 v[64:65], v[64:65], v[88:89]
    v_pk_add_f32 v[66:67], v[66:67], v[90:91]
    v_pk_add_f32 v[64:65], v[64:65], v[92:93]
    v_pk_add_f32 v[66:67], v[66:67], v[94:95]
    v_pk_add_f32 v[64:65], v[64:65], v[96:97]
    v_pk_add_f32 v[66:67], v[66:67], v[98:99]
    s_nop 0
    v_add_f32_dpp v64, v64, v64 row_ror:4 row_mask:0xf bank_mask:0xf
    v_add_f32_dpp v65, v65, v65 row_ror:4 row_mask:0xf bank_mask:0xf
    v_add_f32_dpp v66, v66, v66 row_ror:4 row_mask:0xf bank_mask:0xf
    v_add_f32_dpp v67, v67, v67 row_ror:4 row_mask:0xf bank_mask:0xf
    v_add_f32_dpp v64, v64, v64 row_ror:8 row_mask:0xf bank_mask:0xf
    v_add_f32_dpp v65, v65, v65 row_ror:8 row_mask:0xf bank_mask:0xf
    v_add_f32_dpp v66, v66, v66 row_ror:8 row_mask:0xf bank_mask:0xf
    v_add_f32_dpp v67, v67, v67 row_ror:8 row_mask:0xf bank_mask:0xf
    v_mov_b32 v68, v64
    v_mov_b32 v69, v65
    v_mov_b32 v70, v66
    v_mov_b32 v71, v67
    v_permlane16_swap_b32 v64, v68
    v_permlane16_swap_b32 v65, v69
    v_permlane16_swap_b32 v66, v70
    v_permlane16_swap_b32 v67, v71
    v_add_f32 v64, v64, v68
    v_add_f32 v65, v65, v69
    v_add_f32 v66, v66, v70
    v_add_f32 v67, v67, v71
    v_mov_b32 v68, v64
    v_mov_b32 v69, v65
    v_mov_b32 v70, v66
    v_mov_b32 v71, v67
    v_permlane32_swap_b32 v64, v68
    v_permlane32_swap_b32 v65, v69
    v_permlane32_swap_b32 v66, v70
    v_permlane32_swap_b32 v67, v71
    v_add_f32 v64, v64, v68
    v_add_f32 v65, v65, v69
    v_add_f32 v66, v66, v70
    v_add_f32 v67, v67, v71
    v_cndmask_b32 v26, v64, v65, s[36:37]
    v_cndmask_b32 v27, v66, v67, s[36:37]
    v_cvt_pk_bf16_f32 v28, v26, v27
    v_lshlrev_b32 v26, 16, v28
    v_and_b32 v27, 0xffff0000, v28
    v_mul_f32 v26, v26, v19
    v_mul_f32 v27, v27, v19
    v_cvt_pk_bf16_f32 v28, v26, v27
    v_lshlrev_b32 v26, 16, v28
    v_and_b32 v27, 0xffff0000, v28
    v_pk_add_f32 v[26:27], v[26:27], v[22:23]
    v_cvt_pk_bf16_f32 v28, v26, v27
    v_lshlrev_b32 v26, 16, v28
    v_and_b32 v27, 0xffff0000, v28
    v_pk_mul_f32 v[26:27], v[26:27], v[24:25]
    v_cvt_pk_bf16_f32 v28, v26, v27
    v_lshlrev_b32 v26, 16, v28
    v_and_b32 v27, 0xffff0000, v28
    v_pk_add_f32 v[26:27], v[26:27], v[20:21]
    v_cvt_pk_bf16_f32 v28, v26, v27
    s_mov_b64 exec, 0xff
    buffer_store_dword v28, v13, s[16:19], 0 offen
Ltail_done:
    s_endpgm
Ltail_spin1:
Ltour16:
    s_cbranch_execz Lmain
    s_mov_b32 s48, 16384
Ltail_spinl1:
    buffer_load_dword v11, v9, s[24:27], s93 offen sc1
    s_waitcnt vmcnt(0)
    v_cmp_ne_u32 s[54:55], s95, v11
    s_sub_u32 s48, s48, 1
    s_cbranch_scc1 Ltail_got1
    s_cmp_lg_u64 s[54:55], 0
    s_cbranch_scc1 Ltail_spinl1
    s_branch Ltail_got1
Ltail_spin2:
Ltour17:
    s_cbranch_execz Lmain
    s_mov_b32 s48, 16384
Ltail_spinl2:
    buffer_load_dword v11, v9, s[24:27], s93 offen sc1
    s_waitcnt vmcnt(0)
    v_cmp_ne_u32 s[54:55], s95, v11
    s_sub_u32 s48, s48, 1
    s_cbranch_scc1 Ltail_got2
    s_cmp_lg_u64 s[54:55], 0
    s_cbranch_scc1 Ltail_spinl2
    s_branch Ltail_got2
Lattn_redo:
    s_waitcnt vmcnt(0) lgkmcnt(0)
    s_barrier
    v_mov_b32 v232, 0xff800000
    v_mov_b32 v233, 0xff800000
    v_mov_b32 v234, 0xff800000
    v_mov_b32 v235, 0xff800000
    s_mov_b32 s40, 0
    s_mov_b32 s48, -1
Lattn_redo_loop:
    s_add_u32 m0, s42, 0
    s_nop 0
    buffer_load_dwordx4 v36, s[8:11], s40 offen lds
    buffer_load_dwordx4 v37, s[8:11], s40 offen offset:1024 lds
    buffer_load_dwordx4 v38, s[8:11], s40 offen offset:2048 lds
    buffer_load_dwordx4 v39, s[8:11], s40 offen offset:3072 lds
    s_add_u32 s40, s40, 16384
    s_waitcnt vmcnt(0) lgkmcnt(0)
    s_barrier
    ds_read_b128 a[208:211], v8 offset:0
    ds_read_b128 a[212:215], v9 offset:0
    ds_read_b128 a[216:219], v10 offset:0
    ds_read_b128 a[220:223], v11 offset:0
    s_waitcnt lgkmcnt(3)
    v_mfma_f32_16x16x32_bf16 v[216:219], a[208:211], v[64:67], 0
    s_waitcnt lgkmcnt(2)
    v_mfma_f32_16x16x32_bf16 v[216:219], a[212:215], v[68:71], v[216:219]
    s_waitcnt lgkmcnt(1)
    v_mfma_f32_16x16x32_bf16 v[216:219], a[216:219], v[72:75], v[216:219]
    s_waitcnt lgkmcnt(0)
    v_mfma_f32_16x16x32_bf16 v[216:219], a[220:223], v[76:79], v[216:219]
    v_mfma_f32_16x16x32_bf16 v[220:223], a[208:211], v[80:83], 0
    v_mfma_f32_16x16x32_bf16 v[220:223], a[212:215], v[84:87], v[220:223]
    v_mfma_f32_16x16x32_bf16 v[220:223], a[216:219], v[88:91], v[220:223]
    v_mfma_f32_16x16x32_bf16 v[220:223], a[220:223], v[92:95], v[220:223]
    v_mfma_f32_16x16x32_bf16 v[224:227], a[208:211], v[96:99], 0
    v_mfma_f32_16x16x32_bf16 v[224:227], a[212:215], v[100:103], v[224:227]
    v_mfma_f32_16x16x32_bf16 v[224:227], a[216:219], v[104:107], v[224:227]
    v_mfma_f32_16x16x32_bf16 v[224:227], a[220:223], v[108:111], v[224:227]
    v_mfma_f32_16x16x32_bf16 v[228:231], a[208:211], v[112:115], 0
    v_mfma_f32_16x16x32_bf16 v[228:231], a[212:215], v[116:119], v[228:231]
    v_mfma_f32_16x16x32_bf16 v[228:231], a[216:219], v[120:123], v[228:231]
    v_mfma_f32_16x16x32_bf16 v[228:231], a[220:223], v[124:127], v[228:231]
    v_max3_f32 v232, v232, v216, v217
    v_max3_f32 v232, v232, v218, v219
    v_max3_f32 v233, v233, v220, v221
    v_max3_f32 v233, v233, v222, v223
    v_max3_f32 v234, v234, v224, v225
    v_max3_f32 v234, v234, v226, v227
    s_nop 1
    v_max3_f32 v235, v235, v228, v229
    v_max3_f32 v235, v235, v230, v231
    ds_read_b128 a[224:227], v8 offset:4096
    ds_read_b128 a[228:231], v9 offset:4096
    ds_read_b128 a[232:235], v10 offset:4096
    ds_read_b128 a[236:239], v11 offset:4096
    s_waitcnt lgkmcnt(3)
    v_mfma_f32_16x16x32_bf16 v[216:219], a[224:227], v[64:67], 0
    s_waitcnt lgkmcnt(2)
    v_mfma_f32_16x16x32_bf16 v[216:219], a[228:231], v[68:71], v[216:219]
    s_waitcnt lgkmcnt(1)
    v_mfma_f32_16x16x32_bf16 v[216:219], a[232:235], v[72:75], v[216:219]
    s_waitcnt lgkmcnt(0)
    v_mfma_f32_16x16x32_bf16 v[216:219], a[236:239], v[76:79], v[216:219]
    v_mfma_f32_16x16x32_bf16 v[220:223], a[224:227], v[80:83], 0
    v_mfma_f32_16x16x32_bf16 v[220:223], a[228:231], v[84:87], v[220:223]
    v_mfma_f32_16x16x32_bf16 v[220:223], a[232:235], v[88:91], v[220:223]
    v_mfma_f32_16x16x32_bf16 v[220:223], a[236:239], v[92:95], v[220:223]
    v_mfma_f32_16x16x32_bf16 v[224:227], a[224:227], v[96:99], 0
    v_mfma_f32_16x16x32_bf16 v[224:227], a[228:231], v[100:103], v[224:227]
    v_mfma_f32_16x16x32_bf16 v[224:227], a[232:235], v[104:107], v[224:227]
    v_mfma_f32_16x16x32_bf16 v[224:227], a[236:239], v[108:111], v[224:227]
    v_mfma_f32_16x16x32_bf16 v[228:231], a[224:227], v[112:115], 0
    v_mfma_f32_16x16x32_bf16 v[228:231], a[228:231], v[116:119], v[228:231]
    v_mfma_f32_16x16x32_bf16 v[228:231], a[232:235], v[120:123], v[228:231]
    v_mfma_f32_16x16x32_bf16 v[228:231], a[236:239], v[124:127], v[228:231]
    v_max3_f32 v232, v232, v216, v217
    v_max3_f32 v232, v232, v218, v219
    v_max3_f32 v233, v233, v220, v221
    v_max3_f32 v233, v233, v222, v223
    v_max3_f32 v234, v234, v224, v225
    v_max3_f32 v234, v234, v226, v227
    s_nop 1
    v_max3_f32 v235, v235, v228, v229
    v_max3_f32 v235, v235, v230, v231
    ds_read_b128 a[208:211], v8 offset:8192
    ds_read_b128 a[212:215], v9 offset:8192
    ds_read_b128 a[216:219], v10 offset:8192
    ds_read_b128 a[220:223], v11 offset:8192
    s_waitcnt lgkmcnt(3)
    v_mfma_f32_16x16x32_bf16 v[216:219], a[208:211], v[64:67], 0
    s_waitcnt lgkmcnt(2)
    v_mfma_f32_16x16x32_bf16 v[216:219], a[212:215], v[68:71], v[216:219]
    s_waitcnt lgkmcnt(1)
    v_mfma_f32_16x16x32_bf16 v[216:219], a[216:219], v[72:75], v[216:219]
    s_waitcnt lgkmcnt(0)
    v_mfma_f32_16x16x32_bf16 v[216:219], a[220:223], v[76:79], v[216:219]
    v_mfma_f32_16x16x32_bf16 v[220:223], a[208:211], v[80:83], 0
    v_mfma_f32_16x16x32_bf16 v[220:223], a[212:215], v[84:87], v[220:223]
    v_mfma_f32_16x16x32_bf16 v[220:223], a[216:219], v[88:91], v[220:223]
    v_mfma_f32_16x16x32_bf16 v[220:223], a[220:223], v[92:95], v[220:223]
    v_mfma_f32_16x16x32_bf16 v[224:227], a[208:211], v[96:99], 0
    v_mfma_f32_16x16x32_bf16 v[224:227], a[212:215], v[100:103], v[224:227]
    v_mfma_f32_16x16x32_bf16 v[224:227], a[216:219], v[104:107], v[224:227]
    v_mfma_f32_16x16x32_bf16 v[224:227], a[220:223], v[108:111], v[224:227]
    v_mfma_f32_16x16x32_bf16 v[228:231], a[208:211], v[112:115], 0
    v_mfma_f32_16x16x32_bf16 v[228:231], a[212:215], v[116:119], v[228:231]
    v_mfma_f32_16x16x32_bf16 v[228:231], a[216:219], v[120:123], v[228:231]
    v_mfma_f32_16x16x32_bf16 v[228:231], a[220:223], v[124:127], v[228:231]
    v_max3_f32 v232, v232, v216, v217
    v_max3_f32 v232, v232, v218, v219
    v_max3_f32 v233, v233, v220, v221
    v_max3_f32 v233, v233, v222, v223
    v_max3_f32 v234, v234, v224, v225
    v_max3_f32 v234, v234, v226, v227
    s_nop 1
    v_max3_f32 v235, v235, v228, v229
    v_max3_f32 v235, v235, v230, v231
    ds_read_b128 a[224:227], v8 offset:12288
    ds_read_b128 a[228:231], v9 offset:12288
    ds_read_b128 a[232:235], v10 offset:12288
    ds_read_b128 a[236:239], v11 offset:12288
    s_waitcnt lgkmcnt(3)
    v_mfma_f32_16x16x32_bf16 v[216:219], a[224:227], v[64:67], 0
    s_waitcnt lgkmcnt(2)
    v_mfma_f32_16x16x32_bf16 v[216:219], a[228:231], v[68:71], v[216:219]
    s_waitcnt lgkmcnt(1)
    v_mfma_f32_16x16x32_bf16 v[216:219], a[232:235], v[72:75], v[216:219]
    s_waitcnt lgkmcnt(0)
    v_mfma_f32_16x16x32_bf16 v[216:219], a[236:239], v[76:79], v[216:219]
    v_mfma_f32_16x16x32_bf16 v[220:223], a[224:227], v[80:83], 0
    v_mfma_f32_16x16x32_bf16 v[220:223], a[228:231], v[84:87], v[220:223]
    v_mfma_f32_16x16x32_bf16 v[220:223], a[232:235], v[88:91], v[220:223]
    v_mfma_f32_16x16x32_bf16 v[220:223], a[236:239], v[92:95], v[220:223]
    v_mfma_f32_16x16x32_bf16 v[224:227], a[224:227], v[96:99], 0
    v_mfma_f32_16x16x32_bf16 v[224:227], a[228:231], v[100:103], v[224:227]
    v_mfma_f32_16x16x32_bf16 v[224:227], a[232:235], v[104:107], v[224:227]
    v_mfma_f32_16x16x32_bf16 v[224:227], a[236:239], v[108:111], v[224:227]
    v_mfma_f32_16x16x32_bf16 v[228:231], a[224:227], v[112:115], 0
    v_mfma_f32_16x16x32_bf16 v[228:231], a[228:231], v[116:119], v[228:231]
    v_mfma_f32_16x16x32_bf16 v[228:231], a[232:235], v[120:123], v[228:231]
    v_mfma_f32_16x16x32_bf16 v[228:231], a[236:239], v[124:127], v[228:231]
    v_max3_f32 v232, v232, v216, v217
    v_max3_f32 v232, v232, v218, v219
    v_max3_f32 v233, v233, v220, v221
    v_max3_f32 v233, v233, v222, v223
    v_max3_f32 v234, v234, v224, v225
    v_max3_f32 v234, v234, v226, v227
    s_nop 1
    v_max3_f32 v235, v235, v228, v229
    v_max3_f32 v235, v235, v230, v231
    s_barrier
    s_cmp_lt_u32 s40, 524288
    s_cbranch_scc1 Lattn_redo_loop
    v_mov_b32 v236, v232
    v_mov_b32 v237, v233
    v_mov_b32 v238, v234
    v_mov_b32 v239, v235
    v_permlane16_swap_b32 v232, v236
    v_permlane16_swap_b32 v233, v237
    v_permlane16_swap_b32 v234, v238
    v_permlane16_swap_b32 v235, v239
    v_max_f32 v232, v232, v236
    v_max_f32 v233, v233, v237
    v_max_f32 v234, v234, v238
    v_max_f32 v235, v235, v239
    v_mov_b32 v236, v232
    v_mov_b32 v237, v233
    v_mov_b32 v238, v234
    v_mov_b32 v239, v235
    v_permlane32_swap_b32 v232, v236
    v_permlane32_swap_b32 v233, v237
    v_permlane32_swap_b32 v234, v238
    v_permlane32_swap_b32 v235, v239
    v_max_f32 v232, v232, v236
    v_max_f32 v233, v233, v237
    v_max_f32 v234, v234, v238
    v_max_f32 v235, v235, v239
    v_sub_f32 v192, 0, v232
    v_sub_f32 v193, 0, v232
    v_sub_f32 v194, 0, v232
    v_sub_f32 v195, 0, v232
    v_sub_f32 v196, 0, v233
    v_sub_f32 v197, 0, v233
    v_sub_f32 v198, 0, v233
    v_sub_f32 v199, 0, v233
    v_sub_f32 v200, 0, v234
    v_sub_f32 v201, 0, v234
    v_sub_f32 v202, 0, v234
    v_sub_f32 v203, 0, v234
    v_sub_f32 v204, 0, v235
    v_sub_f32 v205, 0, v235
    v_sub_f32 v206, 0, v235
    v_sub_f32 v207, 0, v235
    s_mov_b32 s40, 0
    s_mov_b32 s41, 0
    s_add_u32 m0, s42, 0
    s_nop 0
    buffer_load_dwordx4 v36, s[8:11], s40 offen lds
    buffer_load_dwordx4 v37, s[8:11], s40 offen offset:1024 lds
    buffer_load_dwordx4 v38, s[8:11], s40 offen offset:2048 lds
    buffer_load_dwordx4 v39, s[8:11], s40 offen offset:3072 lds
    s_add_u32 s40, s40, 16384
    s_add_u32 m0, s42, 16384
    s_nop 0
    buffer_load_dwordx4 v36, s[8:11], s40 offen lds
    buffer_load_dwordx4 v37, s[8:11], s40 offen offset:1024 lds
    buffer_load_dwordx4 v38, s[8:11], s40 offen offset:2048 lds
    buffer_load_dwordx4 v39, s[8:11], s40 offen offset:3072 lds
    s_add_u32 s40, s40, 16384
    s_add_u32 m0, s42, 32768
    s_nop 0
    buffer_load_dwordx4 v36, s[8:11], s40 offen lds
    buffer_load_dwordx4 v37, s[8:11], s40 offen offset:1024 lds
    buffer_load_dwordx4 v38, s[8:11], s40 offen offset:2048 lds
    buffer_load_dwordx4 v39, s[8:11], s40 offen offset:3072 lds
    s_add_u32 s40, s40, 16384
    s_add_u32 m0, s42, 65536
    s_nop 0
    buffer_load_dwordx4 v40, s[12:15], s41 offen lds
    buffer_load_dwordx4 v41, s[12:15], s41 offen offset:1024 lds
    buffer_load_dwordx4 v40, s[12:15], s41 offen offset:2048 lds
    buffer_load_dwordx4 v41, s[12:15], s41 offen offset:3072 lds
    s_add_u32 s41, s41, 16384
    s_add_u32 m0, s42, 81920
    s_nop 0
    buffer_load_dwordx4 v40, s[12:15], s41 offen lds
    buffer_load_dwordx4 v41, s[12:15], s41 offen offset:1024 lds
    buffer_load_dwordx4 v40, s[12:15], s41 offen offset:2048 lds
    buffer_load_dwordx4 v41, s[12:15], s41 offen offset:3072 lds
    s_add_u32 s41, s41, 16384
    v_accvgpr_write_b32 a0, 0
    v_accvgpr_write_b32 a1, 0
    v_accvgpr_write_b32 a2, 0
    v_accvgpr_write_b32 a3, 0
    v_accvgpr_write_b32 a4, 0
    v_accvgpr_write_b32 a5, 0
    v_accvgpr_write_b32 a6, 0
    v_accvgpr_write_b32 a7, 0
    v_accvgpr_write_b32 a8, 0
    v_accvgpr_write_b32 a9, 0
    v_accvgpr_write_b32 a10, 0
    v_accvgpr_write_b32 a11, 0
    v_accvgpr_write_b32 a12, 0
    v_accvgpr_write_b32 a13, 0
    v_accvgpr_write_b32 a14, 0
    v_accvgpr_write_b32 a15, 0
    v_accvgpr_write_b32 a16, 0
    v_accvgpr_write_b32 a17, 0
    v_accvgpr_write_b32 a18, 0
    v_accvgpr_write_b32 a19, 0
    v_accvgpr_write_b32 a20, 0
    v_accvgpr_write_b32 a21, 0
    v_accvgpr_write_b32 a22, 0
    v_accvgpr_write_b32 a23, 0
    v_accvgpr_write_b32 a24, 0
    v_accvgpr_write_b32 a25, 0
    v_accvgpr_write_b32 a26, 0
    v_accvgpr_write_b32 a27, 0
    v_accvgpr_write_b32 a28, 0
    v_accvgpr_write_b32 a29, 0
    v_accvgpr_write_b32 a30, 0
    v_accvgpr_write_b32 a31, 0
    v_accvgpr_write_b32 a32, 0
    v_accvgpr_write_b32 a33, 0
    v_accvgpr_write_b32 a34, 0
    v_accvgpr_write_b32 a35, 0
    v_accvgpr_write_b32 a36, 0
    v_accvgpr_write_b32 a37, 0
    v_accvgpr_write_b32 a38, 0
    v_accvgpr_write_b32 a39, 0
    v_accvgpr_write_b32 a40, 0
    v_accvgpr_write_b32 a41, 0
    v_accvgpr_write_b32 a42, 0
    v_accvgpr_write_b32 a43, 0
    v_accvgpr_write_b32 a44, 0
    v_accvgpr_write_b32 a45, 0
    v_accvgpr_write_b32 a46, 0
    v_accvgpr_write_b32 a47, 0
    v_accvgpr_write_b32 a48, 0
    v_accvgpr_write_b32 a49, 0
    v_accvgpr_write_b32 a50, 0
    v_accvgpr_write_b32 a51, 0
    v_accvgpr_write_b32 a52, 0
    v_accvgpr_write_b32 a53, 0
    v_accvgpr_write_b32 a54, 0
    v_accvgpr_write_b32 a55, 0
    v_accvgpr_write_b32 a56, 0
    v_accvgpr_write_b32 a57, 0
    v_accvgpr_write_b32 a58, 0
    v_accvgpr_write_b32 a59, 0
    v_accvgpr_write_b32 a60, 0
    v_accvgpr_write_b32 a61, 0
    v_accvgpr_write_b32 a62, 0
    v_accvgpr_write_b32 a63, 0
    v_accvgpr_write_b32 a64, 0
    v_accvgpr_write_b32 a65, 0
    v_accvgpr_write_b32 a66, 0
    v_accvgpr_write_b32 a67, 0
    v_accvgpr_write_b32 a68, 0
    v_accvgpr_write_b32 a69, 0
    v_accvgpr_write_b32 a70, 0
    v_accvgpr_write_b32 a71, 0
    v_accvgpr_write_b32 a72, 0
    v_accvgpr_write_b32 a73, 0
    v_accvgpr_write_b32 a74, 0
    v_accvgpr_write_b32 a75, 0
    v_accvgpr_write_b32 a76, 0
    v_accvgpr_write_b32 a77, 0
    v_accvgpr_write_b32 a78, 0
    v_accvgpr_write_b32 a79, 0
    v_accvgpr_write_b32 a80, 0
    v_accvgpr_write_b32 a81, 0
    v_accvgpr_write_b32 a82, 0
    v_accvgpr_write_b32 a83, 0
    v_accvgpr_write_b32 a84, 0
    v_accvgpr_write_b32 a85, 0
    v_accvgpr_write_b32 a86, 0
    v_accvgpr_write_b32 a87, 0
    v_accvgpr_write_b32 a88, 0
    v_accvgpr_write_b32 a89, 0
    v_accvgpr_write_b32 a90, 0
    v_accvgpr_write_b32 a91, 0
    v_accvgpr_write_b32 a92, 0
    v_accvgpr_write_b32 a93, 0
    v_accvgpr_write_b32 a94, 0
    v_accvgpr_write_b32 a95, 0
    v_accvgpr_write_b32 a96, 0
    v_accvgpr_write_b32 a97, 0
    v_accvgpr_write_b32 a98, 0
    v_accvgpr_write_b32 a99, 0
    v_accvgpr_write_b32 a100, 0
    v_accvgpr_write_b32 a101, 0
    v_accvgpr_write_b32 a102, 0
    v_accvgpr_write_b32 a103, 0
    v_accvgpr_write_b32 a104, 0
    v_accvgpr_write_b32 a105, 0
    v_accvgpr_write_b32 a106, 0
    v_accvgpr_write_b32 a107, 0
    v_accvgpr_write_b32 a108, 0
    v_accvgpr_write_b32 a109, 0
    v_accvgpr_write_b32 a110, 0
    v_accvgpr_write_b32 a111, 0
    v_accvgpr_write_b32 a112, 0
    v_accvgpr_write_b32 a113, 0
    v_accvgpr_write_b32 a114, 0
    v_accvgpr_write_b32 a115, 0
    v_accvgpr_write_b32 a116, 0
    v_accvgpr_write_b32 a117, 0
    v_accvgpr_write_b32 a118, 0
    v_accvgpr_write_b32 a119, 0
    v_accvgpr_write_b32 a120, 0
    v_accvgpr_write_b32 a121, 0
    v_accvgpr_write_b32 a122, 0
    v_accvgpr_write_b32 a123, 0
    v_accvgpr_write_b32 a124, 0
    v_accvgpr_write_b32 a125, 0
    v_accvgpr_write_b32 a126, 0
    v_accvgpr_write_b32 a127, 0
    v_accvgpr_write_b32 a192, 0
    v_accvgpr_write_b32 a193, 0
    v_accvgpr_write_b32 a194, 0
    v_accvgpr_write_b32 a195, 0
    v_accvgpr_write_b32 a196, 0
    v_accvgpr_write_b32 a197, 0
    v_accvgpr_write_b32 a198, 0
    v_accvgpr_write_b32 a199, 0
    v_accvgpr_write_b32 a200, 0
    v_accvgpr_write_b32 a201, 0
    v_accvgpr_write_b32 a202, 0
    v_accvgpr_write_b32 a203, 0
    v_accvgpr_write_b32 a204, 0
    v_accvgpr_write_b32 a205, 0
    v_accvgpr_write_b32 a206, 0
    v_accvgpr_write_b32 a207, 0
    s_waitcnt vmcnt(0) lgkmcnt(0)
    s_barrier
    ds_read_b128 a[208:211], v8 offset:0
    ds_read_b128 a[212:215], v9 offset:0
    ds_read_b128 a[216:219], v10 offset:0
    ds_read_b128 a[220:223], v11 offset:0
    ds_read_b128 a[224:227], v8 offset:4096
    s_waitcnt vmcnt(0) lgkmcnt(0)
    s_branch Lattn_stage0
Lattn_armwait:
    s_mov_b32 s36, 16384
Lattn_armloop:
    v_mov_b32 v63, 0
    buffer_load_dword v63, v63, s[88:91], 0 offen sc1
    s_waitcnt vmcnt(0)
    v_readfirstlane_b32 s37, v63
    s_sub_u32 s36, s36, 1
    s_cbranch_scc1 Lattn_armed
    s_cmp_lt_u32 s37, 256
    s_cbranch_scc1 Lattn_armloop
    s_branch Lattn_armed
Lattn_end:
    s_endpgm
.section .rodata,"a"
.p2align 6
.amdhsa_kernel adaLN_cond__gqa_block_cached__moe_arch_mod__prompt_kernel
  .amdhsa_next_free_vgpr 512
  .amdhsa_next_free_sgpr 102
  .amdhsa_accum_offset 256
  .amdhsa_group_segment_fixed_size 0
  .amdhsa_kernarg_size 120
  .amdhsa_user_sgpr_count 2
  .amdhsa_user_sgpr_kernarg_segment_ptr 1
  .amdhsa_system_sgpr_workgroup_id_x 1
  .amdhsa_float_denorm_mode_32 3
.end_amdhsa_kernel
```

```asm
; @launch grid=(256,1,1) block=(256,1,1) lds=163840
.amdgcn_target "amdgcn-amd-amdhsa--gfx950"
.text
.globl adaLN_cond__gqa_block_cached__moe_arch_mod__prompt_kernel
.p2align 8
.type adaLN_cond__gqa_block_cached__moe_arch_mod__prompt_kernel,@function
adaLN_cond__gqa_block_cached__moe_arch_mod__prompt_kernel:
    s_cmp_ge_u32 s2, 256
    s_cbranch_scc1 Lattn_end
    s_load_dwordx2 s[8:9], s[0:1], 80
    s_load_dwordx2 s[12:13], s[0:1], 88
    s_load_dwordx2 s[20:21], s[0:1], 0
    s_load_dwordx2 s[50:51], s[0:1], 112
    s_load_dwordx8 s[52:59], s[0:1], 8
    s_load_dwordx4 s[80:83], s[0:1], 56
    s_load_dwordx2 s[84:85], s[0:1], 72
    s_load_dwordx2 s[88:89], s[0:1], 104
    s_getpc_b64 s[32:33]
Lattn_pc:
    s_mov_b32 s34, Lattn_end-Lattn_pc
    s_mov_b32 s35, 0x20000
    s_lshr_b32 s6, s2, 3
    s_lshl_b32 s7, s6, 6
    v_lshrrev_b32 v3, 6, v0
    v_and_b32 v1, 63, v0
    v_lshrrev_b32 v2, 2, v0
    v_lshlrev_b32 v2, 11, v2
    v_readfirstlane_b32 s3, v3
    buffer_load_dword v240, v2, s[32:35], s7 offen
    s_and_b32 s7, s2, 7
    s_lshl_b32 s4, s7, 1
    s_and_b32 s5, s6, 1
    s_add_u32 s4, s4, s5
    s_lshr_b32 s5, s2, 4
    s_lshr_b32 s38, s6, 2
    s_lshl_b32 s38, s38, 3
    s_add_u32 s38, s38, s7
    s_cmp_lt_u32 s38, 54
    s_cselect_b32 s39, 0, 2147483648
    s_lshl_b32 s38, s38, 2
    s_and_b32 s36, s6, 3
    s_add_u32 s38, s38, s36
    s_mov_b32 s14, 3981312
    s_mul_i32 s92, s6, 124416
    s_lshl_b32 s36, s7, 7
    s_add_u32 s92, s92, s36
    v_lshrrev_b32 v2, 2, v0
    v_min_u32 v2, 53, v2
    v_mul_u32_u24 v3, 86, v2
    v_lshrrev_b32 v3, 8, v3
    v_mul_u32_u24 v3, 3840, v3
    v_lshl_add_u32 v72, v2, 10, v3
    s_mov_b32 s15, 0x20000
    s_mov_b32 s10, 1152
    s_mov_b32 s11, 0x20000
    s_mov_b32 s22, 2359296
    s_mov_b32 s23, 0x20000
    v_and_b32 v64, 0xfe, v0
    v_mul_u32_u24 v65, 3456, v64
    v_and_b32 v2, 1, v0
    v_lshl_add_u32 v65, v2, 4, v65
    s_lshl_b32 s36, s38, 5
    s_or_b32 s36, s36, s39
    v_and_b32 v4, 31, v1
    v_lshrrev_b32 v5, 5, v1
    v_cmp_gt_u32 vcc, 24, v4
    v_mov_b32 v6, 2147483648
    s_lshl_b32 s7, s5, 4
    s_add_u32 s7, s7, s4
    s_lshl_b32 s7, s7, 2
    s_add_u32 s7, s7, s3
    v_cndmask_b32 v6, v6, 0, vcc
    s_mul_i32 s37, s7, 2304
    v_lshrrev_b32 v7, 2, v4
    v_lshl_add_u32 v7, v7, 6, v6
    v_and_b32 v2, 3, v4
    v_lshl_add_u32 v7, v2, 3, v7
    v_mul_u32_u24 v2, 1152, v5
    v_add_u32 v66, v7, v2
    s_waitcnt lgkmcnt(0)
    s_load_dword s94, s[50:51], 24576
    buffer_load_dword v241, v72, s[12:15], s92 offen
    buffer_load_ushort v80, v64, s[8:11], 0 offen offset:0
    buffer_load_ushort v81, v64, s[8:11], 0 offen offset:256
    buffer_load_ushort v82, v64, s[8:11], 0 offen offset:512
    buffer_load_ushort v83, v64, s[8:11], 0 offen offset:768
    buffer_load_ushort v84, v64, s[8:11], 0 offen offset:1024
    buffer_load_dwordx2 v[108:109], v66, s[20:23], s37 offen offset:0
    buffer_load_dwordx2 v[110:111], v66, s[20:23], s37 offen offset:32
    buffer_load_dwordx2 v[112:113], v66, s[20:23], s37 offen offset:384
    buffer_load_dwordx2 v[114:115], v66, s[20:23], s37 offen offset:416
    buffer_load_dwordx2 v[116:117], v66, s[20:23], s37 offen offset:768
    buffer_load_dwordx2 v[118:119], v66, s[20:23], s37 offen offset:800
    buffer_load_dwordx4 v[88:91], v65, s[12:15], s36 offen
    s_add_u32 s36, s36, 884736
    buffer_load_dwordx4 v[92:95], v65, s[12:15], s36 offen
    s_add_u32 s36, s36, 884736
    buffer_load_dwordx4 v[96:99], v65, s[12:15], s36 offen
    s_add_u32 s36, s36, 884736
    buffer_load_dwordx4 v[100:103], v65, s[12:15], s36 offen
    s_add_u32 s36, s36, 884736
    buffer_load_dwordx4 v[104:107], v65, s[12:15], s36 offen
    s_mov_b32 s16, s56
    s_mov_b32 s17, s57
    s_mov_b32 s18, 4718592
    s_mov_b32 s19, 0x20000
    s_lshl_b32 s44, s4, 9
    s_mul_i32 s36, s5, 294912
    v_min_u32 v2, 143, v0
    v_lshrrev_b32 v3, 2, v2
    v_and_b32 v2, 3, v2
    v_lshl_add_u32 v2, v2, 7, s36
    v_lshl_add_u32 v71, v3, 13, v2
    s_add_u32 s92, s37, 65536
    v_lshl_add_u32 v7, v5, 4, v6
    v_lshl_add_u32 v67, v4, 5, v7
    v_min_u32 v4, 23, v4
    v_lshlrev_b32 v68, 4, v4
    s_mov_b32 s24, s50
    s_mov_b32 s25, s51
    s_mov_b32 s26, 10485760
    s_mov_b32 s27, 0x20000
    s_mov_b32 s90, 256
    s_mov_b32 s91, 0x20000
    s_mul_i32 s36, s38, 1821
    s_lshr_b32 s36, s36, 16
    s_cmp_eq_u32 s36, 1
    s_cselect_b32 s93, 1.0, 0
    s_cmp_eq_u32 s36, 4
    s_cselect_b32 s93, 1.0, s93
    s_lshr_b32 s36, s38, 1
    s_lshl_b32 s36, s36, 6
    s_and_b32 s37, s38, 1
    s_lshl_b32 s37, s37, 3
    s_add_u32 s36, s36, s37
    v_lshrrev_b32 v2, 1, v0
    v_lshl_add_u32 v2, v2, 4, s36
    v_and_b32 v3, 1, v0
    v_lshl_add_u32 v70, v3, 2, v2
    v_lshlrev_b32 v69, 1, v70
    v_cmp_gt_u32 s[36:37], 8, v0
    v_mov_b32 v2, 2147483648
    v_mov_b32 v3, s39
    v_cndmask_b32 v2, v2, v3, s[36:37]
    v_or_b32 v69, v69, v2
    v_or_b32 v70, v70, v2
    s_lshl_b32 s42, s3, 12
    v_lshrrev_b32 v2, 4, v1
    v_and_b32 v3, 15, v1
    v_lshrrev_b32 v5, 1, v3
    v_mul_u32_u24 v5, 2304, v5
    v_lshl_add_u32 v5, v2, 5, v5
    v_and_b32 v6, 1, v3
    v_lshl_add_u32 v51, v6, 4, v5
    s_lshl_b32 s6, s5, 2
    s_add_u32 s6, s6, s3
    s_mul_i32 s46, s6, 36864
    s_add_u32 s46, s46, 65536
    s_add_u32 s43, s46, 18432
    s_mul_i32 s45, s4, 294912
    s_lshl_b32 s7, s3, 4
    v_add_u32 v4, s7, v2
    v_lshlrev_b32 v5, 1, v2
    v_xor_b32 v5, v5, v3
    v_xor_b32 v6, 8, v5
    v_lshlrev_b32 v7, 13, v4
    v_lshl_add_u32 v42, v5, 4, v7
    v_lshl_add_u32 v43, v6, 4, v7
    v_add_u32 v44, 63488, v42
    v_add_u32 v45, 95232, v43
    v_add_u32 v43, 31744, v43
    s_lshl_b32 s7, s4, 19
    s_add_u32 s8, s52, s7
    s_addc_u32 s9, s53, 0
    s_mov_b32 s10, 524288
    s_mov_b32 s11, 0x20000
    s_add_u32 s12, s54, s7
    s_addc_u32 s13, s55, 0
    s_mov_b32 s14, 524288
    s_mov_b32 s15, 0x20000
    s_mov_b32 s20, s58
    s_mov_b32 s21, s59
    s_mov_b32 s22, 4718592
    s_mov_b32 s23, 0x20000
    s_add_u32 s28, s50, 10485760
    s_addc_u32 s29, s51, 0
    s_mov_b32 s30, 37748736
    s_mov_b32 s31, 0x20000
    v_lshlrev_b32 v7, 8, v4
    v_lshl_add_u32 v40, v5, 4, v7
    v_lshl_add_u32 v41, v6, 4, v7
    v_xor_b32 v224, v3, v2
    v_lshl_add_u32 v36, v224, 4, v7
    v_xor_b32 v37, 64, v36
    v_xor_b32 v38, 128, v36
    v_xor_b32 v39, 192, v36
    v_lshrrev_b32 v7, 3, v5
    v_lshl_add_u32 v7, v7, 7, v4
    v_mul_u32_u24 v7, 1152, v7
    v_and_b32 v225, 7, v5
    v_lshl_add_u32 v46, v225, 4, v7
    v_lshrrev_b32 v7, 3, v6
    v_lshl_add_u32 v7, v7, 7, v4
    v_mul_u32_u24 v7, 1152, v7
    v_and_b32 v225, 7, v6
    v_lshl_add_u32 v47, v225, 4, v7
    v_add_u32 v48, 7168, v46
    v_add_u32 v49, 10752, v47
    v_add_u32 v47, 3584, v47
    v_lshlrev_b32 v7, 8, v3
    v_lshl_add_u32 v8, v224, 4, v7
    v_xor_b32 v9, 64, v8
    v_xor_b32 v10, 128, v8
    v_xor_b32 v11, 192, v8
    v_lshrrev_b32 v5, 2, v1
    v_and_b32 v6, 7, v5
    v_lshlrev_b32 v6, 5, v6
    v_lshl_add_u32 v6, v5, 8, v6
    v_and_b32 v7, 3, v1
    v_lshl_add_u32 v12, v7, 3, v6
    v_xor_b32 v13, 32, v12
    v_xor_b32 v14, 64, v12
    v_xor_b32 v15, 96, v12
    v_xor_b32 v16, 128, v12
    v_xor_b32 v17, 160, v12
    v_xor_b32 v18, 192, v12
    v_xor_b32 v19, 224, v12
    v_add_u32 v20, 65536, v12
    v_add_u32 v21, 65536, v13
    v_add_u32 v22, 65536, v14
    v_add_u32 v23, 65536, v15
    v_add_u32 v24, 65536, v16
    v_add_u32 v25, 65536, v17
    v_add_u32 v26, 65536, v18
    v_add_u32 v27, 65536, v19
    v_add_u32 v28, 131072, v12
    v_add_u32 v29, 131072, v13
    v_add_u32 v30, 131072, v14
    v_add_u32 v31, 131072, v15
    v_add_u32 v32, 131072, v16
    v_add_u32 v33, 131072, v17
    v_add_u32 v34, 131072, v18
    v_add_u32 v35, 131072, v19
    v_mov_b32 v52, 0x3f803f80
    v_mov_b32 v53, 0x3f803f80
    v_mov_b32 v54, 0x3f803f80
    v_mov_b32 v55, 0x3f803f80
    v_and_b32 v5, 1, v1
    v_mul_u32_u24 v5, 0xaaaa, v5
    v_add_u32 v5, 0x4444, v5
    v_lshl_add_u32 v50, v5, 16, v5
    v_lshrrev_b32 v5, 1, v3
    v_mul_u32_u24 v5, 36864, v5
    v_lshl_add_u32 v5, v2, 5, v5
    v_and_b32 v6, 1, v3
    v_lshl_add_u32 v56, v6, 4, v5
    s_mul_i32 s47, s6, 589824
    s_mul_i32 s7, s4, 2304
    s_add_u32 s47, s47, s7
    s_mov_b32 s32, s82
    s_mov_b32 s33, s83
    s_mov_b32 s34, 5308416
    s_mov_b32 s35, 0x20000
    s_mov_b32 s82, 5308416
    s_mov_b32 s83, 0x20000
    s_mov_b32 s86, 5308416
    s_mov_b32 s87, 0x20000
    s_lshr_b32 s7, s2, 3
    s_mul_i32 s7, s7, 18
    s_add_u32 s7, s7, s3
    s_and_b32 s36, s2, 7
    s_mul_i32 s37, s36, 576
    s_add_u32 s37, s37, s7
    s_mul_i32 s37, s37, 1152
    s_mul_i32 s7, s7, 9216
    s_mul_i32 s36, s36, 1152
    s_add_u32 s7, s7, s36
    v_min_u32 v5, 17, v1
    v_lshl_add_u32 v57, v5, 6, s7
    v_lshl_add_u32 v62, v5, 6, s37
    s_mov_b32 s40, 0
    s_mov_b32 s41, 0
    s_mov_b32 s48, 0
    s_waitcnt vmcnt(15)
    v_lshlrev_b32 v80, 16, v80
    s_waitcnt vmcnt(14)
    v_lshlrev_b32 v81, 16, v81
    s_waitcnt vmcnt(13)
    v_lshlrev_b32 v82, 16, v82
    s_waitcnt vmcnt(12)
    v_lshlrev_b32 v83, 16, v83
    s_waitcnt vmcnt(11)
    v_lshlrev_b32 v84, 16, v84
    v_mul_f32 v144, 0xbfb8aa3b, v80
    v_mul_f32 v148, 0xbfb8aa3b, v81
    v_mul_f32 v152, 0xbfb8aa3b, v82
    v_mul_f32 v156, 0xbfb8aa3b, v83
    v_mul_f32 v160, 0xbfb8aa3b, v84
    v_min_f32 v144, 0x42fc0000, v144
    v_min_f32 v148, 0x42fc0000, v148
    v_min_f32 v152, 0x42fc0000, v152
    v_min_f32 v156, 0x42fc0000, v156
    v_min_f32 v160, 0x42fc0000, v160
    v_exp_f32 v144, v144
    v_exp_f32 v148, v148
    v_exp_f32 v152, v152
    v_exp_f32 v156, v156
    v_exp_f32 v160, v160
    v_add_f32 v144, 1.0, v144
    v_add_f32 v148, 1.0, v148
    v_add_f32 v152, 1.0, v152
    v_add_f32 v156, 1.0, v156
    v_add_f32 v160, 1.0, v160
    v_rcp_f32 v145, v144
    v_rcp_f32 v149, v148
    v_rcp_f32 v153, v152
    v_rcp_f32 v157, v156
    v_rcp_f32 v161, v160
    v_mul_f32 v146, v80, v145
    v_mul_f32 v150, v81, v149
    v_mul_f32 v154, v82, v153
    v_mul_f32 v158, v83, v157
    v_mul_f32 v162, v84, v161
    v_fma_f32 v144, -v146, v144, v80
    v_fma_f32 v148, -v150, v148, v81
    v_fma_f32 v152, -v154, v152, v82
    v_fma_f32 v156, -v158, v156, v83
    v_fma_f32 v160, -v162, v160, v84
    v_fma_f32 v80, v144, v145, v146
    v_fma_f32 v81, v148, v149, v150
    v_fma_f32 v82, v152, v153, v154
    v_fma_f32 v83, v156, v157, v158
    v_fma_f32 v84, v160, v161, v162
    v_cvt_pk_bf16_f32 v80, v80, v80
    v_cvt_pk_bf16_f32 v81, v81, v81
    v_cvt_pk_bf16_f32 v82, v82, v82
    v_cvt_pk_bf16_f32 v83, v83, v83
    v_cvt_pk_bf16_f32 v84, v84, v84
    v_and_b32 v80, 0xffff0000, v80
    v_and_b32 v81, 0xffff0000, v81
    v_and_b32 v82, 0xffff0000, v82
    v_and_b32 v83, 0xffff0000, v83
    v_and_b32 v84, 0xffff0000, v84
    s_waitcnt vmcnt(4)
    v_lshlrev_b32 v136, 16, v88
    v_and_b32 v137, 0xffff0000, v88
    v_lshlrev_b32 v138, 16, v89
    v_and_b32 v139, 0xffff0000, v89
    v_lshlrev_b32 v140, 16, v90
    v_and_b32 v141, 0xffff0000, v90
    v_lshlrev_b32 v142, 16, v91
    v_and_b32 v143, 0xffff0000, v91
    v_pk_mul_f32 v[128:129], v[136:137], v[80:81] op_sel:[0,0] op_sel_hi:[1,0]
    v_pk_mul_f32 v[130:131], v[138:139], v[80:81] op_sel:[0,0] op_sel_hi:[1,0]
    v_pk_mul_f32 v[132:133], v[140:141], v[80:81] op_sel:[0,0] op_sel_hi:[1,0]
    v_pk_mul_f32 v[134:135], v[142:143], v[80:81] op_sel:[0,0] op_sel_hi:[1,0]
    s_waitcnt vmcnt(3)
    v_lshlrev_b32 v136, 16, v92
    v_and_b32 v137, 0xffff0000, v92
    v_lshlrev_b32 v138, 16, v93
    v_and_b32 v139, 0xffff0000, v93
    v_lshlrev_b32 v140, 16, v94
    v_and_b32 v141, 0xffff0000, v94
    v_lshlrev_b32 v142, 16, v95
    v_and_b32 v143, 0xffff0000, v95
    v_pk_fma_f32 v[128:129], v[136:137], v[80:81], v[128:129] op_sel:[0,1,0] op_sel_hi:[1,1,1]
    v_pk_fma_f32 v[130:131], v[138:139], v[80:81], v[130:131] op_sel:[0,1,0] op_sel_hi:[1,1,1]
    v_pk_fma_f32 v[132:133], v[140:141], v[80:81], v[132:133] op_sel:[0,1,0] op_sel_hi:[1,1,1]
    v_pk_fma_f32 v[134:135], v[142:143], v[80:81], v[134:135] op_sel:[0,1,0] op_sel_hi:[1,1,1]
    s_waitcnt vmcnt(2)
    v_lshlrev_b32 v136, 16, v96
    v_and_b32 v137, 0xffff0000, v96
    v_lshlrev_b32 v138, 16, v97
    v_and_b32 v139, 0xffff0000, v97
    v_lshlrev_b32 v140, 16, v98
    v_and_b32 v141, 0xffff0000, v98
    v_lshlrev_b32 v142, 16, v99
    v_and_b32 v143, 0xffff0000, v99
    v_pk_fma_f32 v[128:129], v[136:137], v[82:83], v[128:129] op_sel:[0,0,0] op_sel_hi:[1,0,1]
    v_pk_fma_f32 v[130:131], v[138:139], v[82:83], v[130:131] op_sel:[0,0,0] op_sel_hi:[1,0,1]
    v_pk_fma_f32 v[132:133], v[140:141], v[82:83], v[132:133] op_sel:[0,0,0] op_sel_hi:[1,0,1]
    v_pk_fma_f32 v[134:135], v[142:143], v[82:83], v[134:135] op_sel:[0,0,0] op_sel_hi:[1,0,1]
    s_waitcnt vmcnt(1)
    v_lshlrev_b32 v136, 16, v100
    v_and_b32 v137, 0xffff0000, v100
    v_lshlrev_b32 v138, 16, v101
    v_and_b32 v139, 0xffff0000, v101
    v_lshlrev_b32 v140, 16, v102
    v_and_b32 v141, 0xffff0000, v102
    v_lshlrev_b32 v142, 16, v103
    v_and_b32 v143, 0xffff0000, v103
    v_pk_fma_f32 v[128:129], v[136:137], v[82:83], v[128:129] op_sel:[0,1,0] op_sel_hi:[1,1,1]
    v_pk_fma_f32 v[130:131], v[138:139], v[82:83], v[130:131] op_sel:[0,1,0] op_sel_hi:[1,1,1]
    v_pk_fma_f32 v[132:133], v[140:141], v[82:83], v[132:133] op_sel:[0,1,0] op_sel_hi:[1,1,1]
    v_pk_fma_f32 v[134:135], v[142:143], v[82:83], v[134:135] op_sel:[0,1,0] op_sel_hi:[1,1,1]
    s_waitcnt vmcnt(0)
    v_lshlrev_b32 v136, 16, v104
    v_and_b32 v137, 0xffff0000, v104
    v_lshlrev_b32 v138, 16, v105
    v_and_b32 v139, 0xffff0000, v105
    v_lshlrev_b32 v140, 16, v106
    v_and_b32 v141, 0xffff0000, v106
    v_lshlrev_b32 v142, 16, v107
    v_and_b32 v143, 0xffff0000, v107
    v_pk_fma_f32 v[128:129], v[136:137], v[84:85], v[128:129] op_sel:[0,0,0] op_sel_hi:[1,0,1]
    v_pk_fma_f32 v[130:131], v[138:139], v[84:85], v[130:131] op_sel:[0,0,0] op_sel_hi:[1,0,1]
    v_pk_fma_f32 v[132:133], v[140:141], v[84:85], v[132:133] op_sel:[0,0,0] op_sel_hi:[1,0,1]
    v_pk_fma_f32 v[134:135], v[142:143], v[84:85], v[134:135] op_sel:[0,0,0] op_sel_hi:[1,0,1]
    buffer_load_dword v242, v71, s[16:19], s44 offen
    v_permlane32_swap_b32 v128, v132
    v_permlane32_swap_b32 v129, v133
    v_permlane32_swap_b32 v130, v134
    v_permlane32_swap_b32 v131, v135
    v_and_b32 v72, 1, v1
    v_pk_add_f32 v[128:129], v[128:129], v[132:133]
    v_pk_add_f32 v[130:131], v[130:131], v[134:135]
    v_lshlrev_b32 v72, 5, v72
    v_lshrrev_b32 v73, 4, v1
    v_permlane16_swap_b32 v128, v130
    v_permlane16_swap_b32 v129, v131
    v_lshl_add_u32 v72, v73, 3, v72
    v_pk_add_f32 v[128:129], v[128:129], v[130:131]
    s_lshl_b32 s36, s3, 6
    v_add_u32 v72, s36, v72
    v_add_f32_dpp v128, v128, v128 row_ror:2 row_mask:0xf bank_mask:0xf
    v_add_f32_dpp v129, v129, v129 row_ror:2 row_mask:0xf bank_mask:0xf
    s_nop 0
    v_add_f32_dpp v128, v128, v128 row_ror:4 row_mask:0xf bank_mask:0xf
    v_add_f32_dpp v129, v129, v129 row_ror:4 row_mask:0xf bank_mask:0xf
    s_nop 0
    v_add_f32_dpp v128, v128, v128 row_ror:8 row_mask:0xf bank_mask:0xf
    v_add_f32_dpp v129, v129, v129 row_ror:8 row_mask:0xf bank_mask:0xf
    ds_write_b64 v72, v[128:129] offset:0
    v_and_b32 v73, 7, v1
    v_lshlrev_b32 v73, 3, v73
    s_waitcnt lgkmcnt(0)
    s_barrier
    ds_read_b64 v[128:129], v73 offset:0
    ds_read_b64 v[130:131], v73 offset:64
    ds_read_b64 v[132:133], v73 offset:128
    ds_read_b64 v[134:135], v73 offset:192
    s_add_u32 s95, s94, 0x9e3779b9
    v_mov_b32 v137, s95
    s_mov_b32 s36, 16384
    s_waitcnt lgkmcnt(2)
    v_pk_add_f32 v[128:129], v[128:129], v[130:131]
    s_waitcnt lgkmcnt(0)
    v_pk_add_f32 v[132:133], v[132:133], v[134:135]
    v_pk_add_f32 v[128:129], v[128:129], v[132:133]
    v_cvt_pk_bf16_f32 v136, v128, v129
    v_lshlrev_b32 v128, 16, v136
    v_and_b32 v129, 0xffff0000, v136
    v_add_f32 v128, s93, v128
    v_add_f32 v129, s93, v129
    v_cvt_pk_bf16_f32 v136, v128, v129
    buffer_store_dwordx2 v[136:137], v69, s[24:27], 0 offen sc1
    buffer_store_dword v136, v70, s[24:27], s36 offen sc1
    v_lshlrev_b32 v144, 16, v108
    v_and_b32 v145, 0xffff0000, v108
    v_lshlrev_b32 v146, 16, v109
    v_and_b32 v147, 0xffff0000, v109
    v_lshlrev_b32 v148, 16, v110
    v_and_b32 v149, 0xffff0000, v110
    v_lshlrev_b32 v150, 16, v111
    v_and_b32 v151, 0xffff0000, v111
    v_lshlrev_b32 v152, 16, v112
    v_and_b32 v153, 0xffff0000, v112
    v_lshlrev_b32 v154, 16, v113
    v_and_b32 v155, 0xffff0000, v113
    v_lshlrev_b32 v156, 16, v114
    v_and_b32 v157, 0xffff0000, v114
    v_lshlrev_b32 v158, 16, v115
    v_and_b32 v159, 0xffff0000, v115
    v_lshlrev_b32 v160, 16, v116
    v_and_b32 v161, 0xffff0000, v116
    v_lshlrev_b32 v162, 16, v117
    v_and_b32 v163, 0xffff0000, v117
    v_lshlrev_b32 v164, 16, v118
    v_and_b32 v165, 0xffff0000, v118
    v_lshlrev_b32 v166, 16, v119
    v_and_b32 v167, 0xffff0000, v119
    v_pk_add_f32 v[72:73], v[144:145], v[148:149]
    v_pk_add_f32 v[76:77], v[146:147], v[150:151]
    v_pk_add_f32 v[72:73], v[72:73], v[152:153]
    v_pk_add_f32 v[76:77], v[76:77], v[154:155]
    v_pk_add_f32 v[72:73], v[72:73], v[156:157]
    v_pk_add_f32 v[76:77], v[76:77], v[158:159]
    v_pk_add_f32 v[72:73], v[72:73], v[160:161]
    v_pk_add_f32 v[76:77], v[76:77], v[162:163]
    v_pk_add_f32 v[72:73], v[72:73], v[164:165]
    v_pk_add_f32 v[76:77], v[76:77], v[166:167]
    v_pk_add_f32 v[72:73], v[72:73], v[76:77]
    v_add_f32 v72, v72, v73
    s_nop 1
    v_add_f32_dpp v72, v72, v72 row_ror:1 row_mask:0xf bank_mask:0xf
    s_nop 1
    v_add_f32_dpp v72, v72, v72 row_ror:2 row_mask:0xf bank_mask:0xf
    s_nop 1
    v_add_f32_dpp v72, v72, v72 row_ror:4 row_mask:0xf bank_mask:0xf
    s_nop 1
    v_add_f32_dpp v72, v72, v72 row_ror:8 row_mask:0xf bank_mask:0xf
    v_mov_b32 v76, v72
    s_nop 1
    v_permlane16_swap_b32 v72, v76
    s_nop 0
    v_add_f32 v72, v72, v76
    v_mul_f32 v72, 0x3ae38e39, v72
    v_pk_add_f32 v[168:169], v[144:145], v[72:73] op_sel_hi:[1,0] neg_lo:[0,1] neg_hi:[0,1]
    v_pk_add_f32 v[170:171], v[146:147], v[72:73] op_sel_hi:[1,0] neg_lo:[0,1] neg_hi:[0,1]
    v_pk_add_f32 v[172:173], v[148:149], v[72:73] op_sel_hi:[1,0] neg_lo:[0,1] neg_hi:[0,1]
    v_pk_add_f32 v[174:175], v[150:151], v[72:73] op_sel_hi:[1,0] neg_lo:[0,1] neg_hi:[0,1]
    v_pk_add_f32 v[176:177], v[152:153], v[72:73] op_sel_hi:[1,0] neg_lo:[0,1] neg_hi:[0,1]
    v_pk_add_f32 v[178:179], v[154:155], v[72:73] op_sel_hi:[1,0] neg_lo:[0,1] neg_hi:[0,1]
    v_pk_add_f32 v[180:181], v[156:157], v[72:73] op_sel_hi:[1,0] neg_lo:[0,1] neg_hi:[0,1]
    v_pk_add_f32 v[182:183], v[158:159], v[72:73] op_sel_hi:[1,0] neg_lo:[0,1] neg_hi:[0,1]
    v_pk_add_f32 v[184:185], v[160:161], v[72:73] op_sel_hi:[1,0] neg_lo:[0,1] neg_hi:[0,1]
    v_pk_add_f32 v[186:187], v[162:163], v[72:73] op_sel_hi:[1,0] neg_lo:[0,1] neg_hi:[0,1]
    v_pk_add_f32 v[188:189], v[164:165], v[72:73] op_sel_hi:[1,0] neg_lo:[0,1] neg_hi:[0,1]
    v_pk_add_f32 v[190:191], v[166:167], v[72:73] op_sel_hi:[1,0] neg_lo:[0,1] neg_hi:[0,1]
    v_pk_mul_f32 v[74:75], v[168:169], v[168:169]
    v_pk_mul_f32 v[76:77], v[170:171], v[170:171]
    v_pk_fma_f32 v[74:75], v[172:173], v[172:173], v[74:75]
    v_pk_fma_f32 v[76:77], v[174:175], v[174:175], v[76:77]
    v_pk_fma_f32 v[74:75], v[176:177], v[176:177], v[74:75]
    v_pk_fma_f32 v[76:77], v[178:179], v[178:179], v[76:77]
    v_pk_fma_f32 v[74:75], v[180:181], v[180:181], v[74:75]
    v_pk_fma_f32 v[76:77], v[182:183], v[182:183], v[76:77]
    v_pk_fma_f32 v[74:75], v[184:185], v[184:185], v[74:75]
    v_pk_fma_f32 v[76:77], v[186:187], v[186:187], v[76:77]
    v_pk_fma_f32 v[74:75], v[188:189], v[188:189], v[74:75]
    v_pk_fma_f32 v[76:77], v[190:191], v[190:191], v[76:77]
    v_pk_add_f32 v[74:75], v[74:75], v[76:77]
    v_add_f32 v74, v74, v75
    v_cndmask_b32 v74, 0, v74, vcc
    s_nop 1
    v_add_f32_dpp v74, v74, v74 row_ror:1 row_mask:0xf bank_mask:0xf
    s_nop 1
    v_add_f32_dpp v74, v74, v74 row_ror:2 row_mask:0xf bank_mask:0xf
    s_nop 1
    v_add_f32_dpp v74, v74, v74 row_ror:4 row_mask:0xf bank_mask:0xf
    s_nop 1
    v_add_f32_dpp v74, v74, v74 row_ror:8 row_mask:0xf bank_mask:0xf
    v_mov_b32 v76, v74
    s_nop 1
    v_permlane16_swap_b32 v74, v76
    s_nop 0
    v_add_f32 v74, v74, v76
    v_mul_f32 v74, 0x3ae38e39, v74
    v_cvt_pk_bf16_f32 v76, v72, v74
    v_and_b32 v74, 0xffff0000, v76
    v_lshlrev_b32 v72, 16, v76
    v_add_f32 v74, 0x3727c5ac, v74
    v_cvt_pk_bf16_f32 v74, v74, v74
    v_and_b32 v74, 0xffff0000, v74
    v_sqrt_f32 v74, v74
    v_pk_add_f32 v[168:169], v[144:145], v[72:73] op_sel_hi:[1,0] neg_lo:[0,1] neg_hi:[0,1]
    v_pk_add_f32 v[170:171], v[146:147], v[72:73] op_sel_hi:[1,0] neg_lo:[0,1] neg_hi:[0,1]
    v_pk_add_f32 v[172:173], v[148:149], v[72:73] op_sel_hi:[1,0] neg_lo:[0,1] neg_hi:[0,1]
    v_pk_add_f32 v[174:175], v[150:151], v[72:73] op_sel_hi:[1,0] neg_lo:[0,1] neg_hi:[0,1]
    v_pk_add_f32 v[176:177], v[152:153], v[72:73] op_sel_hi:[1,0] neg_lo:[0,1] neg_hi:[0,1]
    v_pk_add_f32 v[178:179], v[154:155], v[72:73] op_sel_hi:[1,0] neg_lo:[0,1] neg_hi:[0,1]
    v_pk_add_f32 v[180:181], v[156:157], v[72:73] op_sel_hi:[1,0] neg_lo:[0,1] neg_hi:[0,1]
    v_pk_add_f32 v[182:183], v[158:159], v[72:73] op_sel_hi:[1,0] neg_lo:[0,1] neg_hi:[0,1]
    v_pk_add_f32 v[184:185], v[160:161], v[72:73] op_sel_hi:[1,0] neg_lo:[0,1] neg_hi:[0,1]
    v_pk_add_f32 v[186:187], v[162:163], v[72:73] op_sel_hi:[1,0] neg_lo:[0,1] neg_hi:[0,1]
    v_pk_add_f32 v[188:189], v[164:165], v[72:73] op_sel_hi:[1,0] neg_lo:[0,1] neg_hi:[0,1]
    v_pk_add_f32 v[190:191], v[166:167], v[72:73] op_sel_hi:[1,0] neg_lo:[0,1] neg_hi:[0,1]
    v_cvt_pk_bf16_f32 v74, v74, v74
    v_and_b32 v74, 0xffff0000, v74
    v_rcp_f32 v74, v74
    v_cvt_pk_bf16_f32 v108, v168, v169
    v_cvt_pk_bf16_f32 v109, v170, v171
    v_cvt_pk_bf16_f32 v110, v172, v173
    v_cvt_pk_bf16_f32 v111, v174, v175
    v_cvt_pk_bf16_f32 v112, v176, v177
    v_cvt_pk_bf16_f32 v113, v178, v179
    v_cvt_pk_bf16_f32 v114, v180, v181
    v_cvt_pk_bf16_f32 v115, v182, v183
    v_cvt_pk_bf16_f32 v116, v184, v185
    v_cvt_pk_bf16_f32 v117, v186, v187
    v_cvt_pk_bf16_f32 v118, v188, v189
    v_cvt_pk_bf16_f32 v119, v190, v191
    v_lshlrev_b32 v168, 16, v108
    v_and_b32 v169, 0xffff0000, v108
    v_lshlrev_b32 v170, 16, v109
    v_and_b32 v171, 0xffff0000, v109
    v_lshlrev_b32 v172, 16, v110
    v_and_b32 v173, 0xffff0000, v110
    v_lshlrev_b32 v174, 16, v111
    v_and_b32 v175, 0xffff0000, v111
    v_lshlrev_b32 v176, 16, v112
    v_and_b32 v177, 0xffff0000, v112
    v_lshlrev_b32 v178, 16, v113
    v_and_b32 v179, 0xffff0000, v113
    v_lshlrev_b32 v180, 16, v114
    v_and_b32 v181, 0xffff0000, v114
    v_lshlrev_b32 v182, 16, v115
    v_and_b32 v183, 0xffff0000, v115
    v_lshlrev_b32 v184, 16, v116
    v_and_b32 v185, 0xffff0000, v116
    v_lshlrev_b32 v186, 16, v117
    v_and_b32 v187, 0xffff0000, v117
    v_lshlrev_b32 v188, 16, v118
    v_and_b32 v189, 0xffff0000, v118
    v_lshlrev_b32 v190, 16, v119
    v_and_b32 v191, 0xffff0000, v119
    v_pk_mul_f32 v[168:169], v[168:169], v[74:75] op_sel_hi:[1,0]
    v_pk_mul_f32 v[170:171], v[170:171], v[74:75] op_sel_hi:[1,0]
    v_pk_mul_f32 v[172:173], v[172:173], v[74:75] op_sel_hi:[1,0]
    v_pk_mul_f32 v[174:175], v[174:175], v[74:75] op_sel_hi:[1,0]
    v_pk_mul_f32 v[176:177], v[176:177], v[74:75] op_sel_hi:[1,0]
    v_pk_mul_f32 v[178:179], v[178:179], v[74:75] op_sel_hi:[1,0]
    v_pk_mul_f32 v[180:181], v[180:181], v[74:75] op_sel_hi:[1,0]
    v_pk_mul_f32 v[182:183], v[182:183], v[74:75] op_sel_hi:[1,0]
    v_pk_mul_f32 v[184:185], v[184:185], v[74:75] op_sel_hi:[1,0]
    v_pk_mul_f32 v[186:187], v[186:187], v[74:75] op_sel_hi:[1,0]
    v_pk_mul_f32 v[188:189], v[188:189], v[74:75] op_sel_hi:[1,0]
    v_pk_mul_f32 v[190:191], v[190:191], v[74:75] op_sel_hi:[1,0]
    v_cvt_pk_bf16_f32 v108, v168, v169
    v_cvt_pk_bf16_f32 v109, v170, v171
    v_cvt_pk_bf16_f32 v110, v172, v173
    v_cvt_pk_bf16_f32 v111, v174, v175
    v_cvt_pk_bf16_f32 v112, v176, v177
    v_cvt_pk_bf16_f32 v113, v178, v179
    v_cvt_pk_bf16_f32 v114, v180, v181
    v_cvt_pk_bf16_f32 v115, v182, v183
    v_cvt_pk_bf16_f32 v116, v184, v185
    v_cvt_pk_bf16_f32 v117, v186, v187
    v_cvt_pk_bf16_f32 v118, v188, v189
    v_cvt_pk_bf16_f32 v119, v190, v191
    v_lshlrev_b32 v168, 16, v108
    v_and_b32 v169, 0xffff0000, v108
    v_lshlrev_b32 v170, 16, v109
    v_and_b32 v171, 0xffff0000, v109
    v_lshlrev_b32 v172, 16, v110
    v_and_b32 v173, 0xffff0000, v110
    v_lshlrev_b32 v174, 16, v111
    v_and_b32 v175, 0xffff0000, v111
    v_lshlrev_b32 v176, 16, v112
    v_and_b32 v177, 0xffff0000, v112
    v_lshlrev_b32 v178, 16, v113
    v_and_b32 v179, 0xffff0000, v113
    v_lshlrev_b32 v180, 16, v114
    v_and_b32 v181, 0xffff0000, v114
    v_lshlrev_b32 v182, 16, v115
    v_and_b32 v183, 0xffff0000, v115
    v_lshlrev_b32 v184, 16, v116
    v_and_b32 v185, 0xffff0000, v116
    v_lshlrev_b32 v186, 16, v117
    v_and_b32 v187, 0xffff0000, v117
    v_lshlrev_b32 v188, 16, v118
    v_and_b32 v189, 0xffff0000, v118
    v_lshlrev_b32 v190, 16, v119
    v_and_b32 v191, 0xffff0000, v119
    s_mul_i32 s36, s3, 72
    v_add_u32 v72, s36, v1
    v_and_b32 v73, 7, v1
    s_add_u32 s36, s36, 64
    v_add_u32 v73, s36, v73
    v_lshlrev_b32 v74, 4, v72
    v_lshlrev_b32 v75, 4, v73
    s_movk_i32 s36, 1024
    v_lshl_add_u32 v72, v72, 3, s36
    v_lshl_add_u32 v73, v73, 3, s36
    s_add_u32 s49, s44, 0
    s_add_u32 m0, s42, 32768
    s_nop 0
    buffer_load_dwordx4 v42, s[16:19], s49 offen lds
    buffer_load_dwordx4 v43, s[16:19], s49 offen offset:1024 lds
    buffer_load_dwordx4 v44, s[16:19], s49 offen offset:2048 lds
    buffer_load_dwordx4 v45, s[16:19], s49 offen offset:3072 lds
    s_add_u32 s49, s44, 256
    s_add_u32 m0, s42, 49152
    s_nop 0
    buffer_load_dwordx4 v42, s[16:19], s49 offen lds
    buffer_load_dwordx4 v43, s[16:19], s49 offen offset:1024 lds
    buffer_load_dwordx4 v44, s[16:19], s49 offen offset:2048 lds
    buffer_load_dwordx4 v45, s[16:19], s49 offen offset:3072 lds
Lhead_tour:
    s_mov_b32 s38, 16384
Lhead_pollm:
    buffer_load_dwordx4 v[88:91], v74, s[24:27], 0 offen sc1
    buffer_load_dwordx4 v[92:95], v75, s[24:27], 0 offen sc1
    s_sub_u32 s38, s38, 1
    s_cbranch_scc1 Lhead_gotm
    s_waitcnt vmcnt(0) lgkmcnt(0)
    v_xor_b32 v89, s95, v89
    v_xor_b32 v91, s95, v91
    v_xor_b32 v93, s95, v93
    v_xor_b32 v95, s95, v95
    v_or3_b32 v89, v89, v91, v93
    v_or_b32 v89, v89, v95
    v_cmp_ne_u32 vcc, 0, v89
    s_cbranch_vccnz Lhead_pollm
Lhead_gotm:
    s_waitcnt vmcnt(0) lgkmcnt(0)
    ds_write2_b32 v72, v88, v90 offset0:0 offset1:1
    ds_write2_b32 v73, v92, v94 offset0:0 offset1:1
    s_waitcnt lgkmcnt(0)
    s_barrier
    ds_read_b128 v[144:147], v68 offset:2176
    ds_read_b128 v[148:151], v68 offset:2560
    ds_read_b128 v[152:155], v68 offset:2944
    ds_read_b128 v[156:159], v68 offset:1024
    ds_read_b128 v[160:163], v68 offset:1408
    ds_read_b128 v[164:167], v68 offset:1792
    s_waitcnt lgkmcnt(5)
    v_lshlrev_b32 v192, 16, v144
    v_and_b32 v193, 0xffff0000, v144
    v_lshlrev_b32 v194, 16, v145
    v_and_b32 v195, 0xffff0000, v145
    v_lshlrev_b32 v196, 16, v146
    v_and_b32 v197, 0xffff0000, v146
    v_lshlrev_b32 v198, 16, v147
    v_and_b32 v199, 0xffff0000, v147
    s_waitcnt lgkmcnt(4)
    v_lshlrev_b32 v200, 16, v148
    v_and_b32 v201, 0xffff0000, v148
    v_lshlrev_b32 v202, 16, v149
    v_and_b32 v203, 0xffff0000, v149
    v_lshlrev_b32 v204, 16, v150
    v_and_b32 v205, 0xffff0000, v150
    v_lshlrev_b32 v206, 16, v151
    v_and_b32 v207, 0xffff0000, v151
    s_waitcnt lgkmcnt(3)
    v_lshlrev_b32 v208, 16, v152
    v_and_b32 v209, 0xffff0000, v152
    v_lshlrev_b32 v210, 16, v153
    v_and_b32 v211, 0xffff0000, v153
    v_lshlrev_b32 v212, 16, v154
    v_and_b32 v213, 0xffff0000, v154
    v_lshlrev_b32 v214, 16, v155
    v_and_b32 v215, 0xffff0000, v155
    v_pk_mul_f32 v[168:169], v[168:169], v[192:193]
    v_pk_mul_f32 v[170:171], v[170:171], v[194:195]
    v_pk_mul_f32 v[172:173], v[172:173], v[196:197]
    v_pk_mul_f32 v[174:175], v[174:175], v[198:199]
    v_pk_mul_f32 v[176:177], v[176:177], v[200:201]
    v_pk_mul_f32 v[178:179], v[178:179], v[202:203]
    v_pk_mul_f32 v[180:181], v[180:181], v[204:205]
    v_pk_mul_f32 v[182:183], v[182:183], v[206:207]
    v_pk_mul_f32 v[184:185], v[184:185], v[208:209]
    v_pk_mul_f32 v[186:187], v[186:187], v[210:211]
    v_pk_mul_f32 v[188:189], v[188:189], v[212:213]
    v_pk_mul_f32 v[190:191], v[190:191], v[214:215]
    v_cvt_pk_bf16_f32 v108, v168, v169
    v_cvt_pk_bf16_f32 v109, v170, v171
    v_cvt_pk_bf16_f32 v110, v172, v173
    v_cvt_pk_bf16_f32 v111, v174, v175
    v_cvt_pk_bf16_f32 v112, v176, v177
    v_cvt_pk_bf16_f32 v113, v178, v179
    v_cvt_pk_bf16_f32 v114, v180, v181
    v_cvt_pk_bf16_f32 v115, v182, v183
    v_cvt_pk_bf16_f32 v116, v184, v185
    v_cvt_pk_bf16_f32 v117, v186, v187
    v_cvt_pk_bf16_f32 v118, v188, v189
    v_cvt_pk_bf16_f32 v119, v190, v191
    s_waitcnt lgkmcnt(2)
    v_lshlrev_b32 v216, 16, v156
    v_and_b32 v217, 0xffff0000, v156
    v_lshlrev_b32 v218, 16, v157
    v_and_b32 v219, 0xffff0000, v157
    v_lshlrev_b32 v220, 16, v158
    v_and_b32 v221, 0xffff0000, v158
    v_lshlrev_b32 v222, 16, v159
    v_and_b32 v223, 0xffff0000, v159
    s_waitcnt lgkmcnt(1)
    v_lshlrev_b32 v224, 16, v160
    v_and_b32 v225, 0xffff0000, v160
    v_lshlrev_b32 v226, 16, v161
    v_and_b32 v227, 0xffff0000, v161
    v_lshlrev_b32 v228, 16, v162
    v_and_b32 v229, 0xffff0000, v162
    v_lshlrev_b32 v230, 16, v163
    v_and_b32 v231, 0xffff0000, v163
    s_waitcnt lgkmcnt(0)
    v_lshlrev_b32 v232, 16, v164
    v_and_b32 v233, 0xffff0000, v164
    v_lshlrev_b32 v234, 16, v165
    v_and_b32 v235, 0xffff0000, v165
    v_lshlrev_b32 v236, 16, v166
    v_and_b32 v237, 0xffff0000, v166
    v_lshlrev_b32 v238, 16, v167
    v_and_b32 v239, 0xffff0000, v167
    v_lshlrev_b32 v168, 16, v108
    v_and_b32 v169, 0xffff0000, v108
    v_lshlrev_b32 v170, 16, v109
    v_and_b32 v171, 0xffff0000, v109
    v_lshlrev_b32 v172, 16, v110
    v_and_b32 v173, 0xffff0000, v110
    v_lshlrev_b32 v174, 16, v111
    v_and_b32 v175, 0xffff0000, v111
    v_lshlrev_b32 v176, 16, v112
    v_and_b32 v177, 0xffff0000, v112
    v_lshlrev_b32 v178, 16, v113
    v_and_b32 v179, 0xffff0000, v113
    v_lshlrev_b32 v180, 16, v114
    v_and_b32 v181, 0xffff0000, v114
    v_lshlrev_b32 v182, 16, v115
    v_and_b32 v183, 0xffff0000, v115
    v_lshlrev_b32 v184, 16, v116
    v_and_b32 v185, 0xffff0000, v116
    v_lshlrev_b32 v186, 16, v117
    v_and_b32 v187, 0xffff0000, v117
    v_lshlrev_b32 v188, 16, v118
    v_and_b32 v189, 0xffff0000, v118
    v_lshlrev_b32 v190, 16, v119
    v_and_b32 v191, 0xffff0000, v119
    v_pk_add_f32 v[168:169], v[168:169], v[216:217]
    v_pk_add_f32 v[170:171], v[170:171], v[218:219]
    v_pk_add_f32 v[172:173], v[172:173], v[220:221]
    v_pk_add_f32 v[174:175], v[174:175], v[222:223]
    v_cvt_pk_bf16_f32 v108, v168, v169
    v_cvt_pk_bf16_f32 v109, v170, v171
    v_cvt_pk_bf16_f32 v110, v172, v173
    v_cvt_pk_bf16_f32 v111, v174, v175
    buffer_store_dwordx4 v[108:111], v67, s[24:27], s92 offen offset:0 sc1
    v_pk_add_f32 v[176:177], v[176:177], v[224:225]
    v_pk_add_f32 v[178:179], v[178:179], v[226:227]
    v_pk_add_f32 v[180:181], v[180:181], v[228:229]
    v_pk_add_f32 v[182:183], v[182:183], v[230:231]
    v_cvt_pk_bf16_f32 v112, v176, v177
    v_cvt_pk_bf16_f32 v113, v178, v179
    v_cvt_pk_bf16_f32 v114, v180, v181
    v_cvt_pk_bf16_f32 v115, v182, v183
    buffer_store_dwordx4 v[112:115], v67, s[24:27], s92 offen offset:768 sc1
    v_pk_add_f32 v[184:185], v[184:185], v[232:233]
    v_pk_add_f32 v[186:187], v[186:187], v[234:235]
    v_pk_add_f32 v[188:189], v[188:189], v[236:237]
    v_pk_add_f32 v[190:191], v[190:191], v[238:239]
    v_cvt_pk_bf16_f32 v116, v184, v185
    v_cvt_pk_bf16_f32 v117, v186, v187
    v_cvt_pk_bf16_f32 v118, v188, v189
    v_cvt_pk_bf16_f32 v119, v190, v191
    buffer_store_dwordx4 v[116:119], v67, s[24:27], s92 offen offset:1536 sc1
    s_lshl_b32 s36, s5, 13
    s_add_u32 s36, s36, 8650752
    s_lshl_b32 s37, s4, 9
    s_add_u32 s37, s37, s36
    s_lshl_b32 s38, s3, 7
    s_add_u32 s37, s37, s38
    s_lshl_b32 s38, s3, 11
    s_add_u32 s36, s36, s38
    v_mov_b32 v72, 0
    v_and_b32 v73, 15, v1
    v_lshlrev_b32 v73, 7, v73
    v_cmp_gt_u32 vcc, 162, v0
    v_mov_b32 v88, -1
    v_mov_b32 v89, -1
    v_mov_b32 v90, -1
    v_mov_b32 v91, -1
    s_mul_i32 s39, s2, 2592
    s_add_u32 s39, s39, 7864320
    v_lshl_add_u32 v74, v0, 4, s39
    s_lshl_b32 s39, s2, 7
    s_add_u32 s39, s39, 8912896
    v_mov_b32 v75, s39
    v_cndmask_b32 v74, v75, v74, vcc
    v_cmp_eq_u32 vcc, 0, v0
    v_mov_b32 v64, 2147483648
    v_mov_b32 v65, 1
    s_waitcnt vmcnt(0)
    s_mov_b64 exec, 1
    buffer_store_dword v137, v72, s[24:27], s37 offen sc1
    s_mov_b64 exec, -1
    v_cndmask_b32 v64, v64, 0, vcc
    s_add_u32 s49, s44, 524288
    s_add_u32 m0, s42, 65536
    s_nop 0
    buffer_load_dwordx4 v42, s[16:19], s49 offen lds
    buffer_load_dwordx4 v43, s[16:19], s49 offen offset:1024 lds
    buffer_load_dwordx4 v44, s[16:19], s49 offen offset:2048 lds
    buffer_load_dwordx4 v45, s[16:19], s49 offen offset:3072 lds
    s_add_u32 s49, s44, 524544
    s_add_u32 m0, s42, 81920
    s_nop 0
    buffer_load_dwordx4 v42, s[16:19], s49 offen lds
    buffer_load_dwordx4 v43, s[16:19], s49 offen offset:1024 lds
    buffer_load_dwordx4 v44, s[16:19], s49 offen offset:2048 lds
    buffer_load_dwordx4 v45, s[16:19], s49 offen offset:3072 lds
    s_add_u32 s49, s44, 1048576
    s_add_u32 m0, s42, 98304
    s_nop 0
    buffer_load_dwordx4 v42, s[16:19], s49 offen lds
    buffer_load_dwordx4 v43, s[16:19], s49 offen offset:1024 lds
    buffer_load_dwordx4 v44, s[16:19], s49 offen offset:2048 lds
    buffer_load_dwordx4 v45, s[16:19], s49 offen offset:3072 lds
    s_add_u32 s49, s44, 1048832
    s_add_u32 m0, s42, 114688
    s_nop 0
    buffer_load_dwordx4 v42, s[16:19], s49 offen lds
    buffer_load_dwordx4 v43, s[16:19], s49 offen offset:1024 lds
    buffer_load_dwordx4 v44, s[16:19], s49 offen offset:2048 lds
    buffer_load_dwordx4 v45, s[16:19], s49 offen offset:3072 lds
    s_mov_b32 s38, 16384
Lhead_pollh:
    buffer_load_dword v75, v73, s[24:27], s36 offen sc1
    s_sub_u32 s38, s38, 1
    s_cbranch_scc1 Lhead_goth
    s_waitcnt vmcnt(0) lgkmcnt(0)
    v_cmp_ne_u32 vcc, s95, v75
    s_cbranch_vccnz Lhead_pollh
Lhead_goth:
    s_waitcnt vmcnt(0) lgkmcnt(0)
    buffer_load_dwordx4 a[0:3], v51, s[24:27], s46 offen offset:0 sc1
    buffer_load_dwordx4 a[8:11], v51, s[24:27], s46 offen offset:128 sc1
    buffer_load_dwordx4 a[4:7], v51, s[24:27], s43 offen offset:0 sc1
    buffer_load_dwordx4 a[12:15], v51, s[24:27], s43 offen offset:128 sc1
    buffer_load_dwordx4 a[16:19], v51, s[24:27], s46 offen offset:256 sc1
    buffer_load_dwordx4 a[24:27], v51, s[24:27], s46 offen offset:384 sc1
    buffer_load_dwordx4 a[20:23], v51, s[24:27], s43 offen offset:256 sc1
    buffer_load_dwordx4 a[28:31], v51, s[24:27], s43 offen offset:384 sc1
    buffer_load_dwordx4 a[32:35], v51, s[24:27], s46 offen offset:512 sc1
    buffer_load_dwordx4 a[40:43], v51, s[24:27], s46 offen offset:640 sc1
    buffer_load_dwordx4 a[36:39], v51, s[24:27], s43 offen offset:512 sc1
    buffer_load_dwordx4 a[44:47], v51, s[24:27], s43 offen offset:640 sc1
    s_add_u32 s49, s44, 1572864
    s_add_u32 m0, s42, 131072
    s_nop 0
    buffer_load_dwordx4 v42, s[16:19], s49 offen lds
    buffer_load_dwordx4 v43, s[16:19], s49 offen offset:1024 lds
    buffer_load_dwordx4 v44, s[16:19], s49 offen offset:2048 lds
    buffer_load_dwordx4 v45, s[16:19], s49 offen offset:3072 lds
    s_add_u32 s49, s44, 1573120
    s_add_u32 m0, s42, 147456
    s_nop 0
    buffer_load_dwordx4 v42, s[16:19], s49 offen lds
    buffer_load_dwordx4 v43, s[16:19], s49 offen offset:1024 lds
    buffer_load_dwordx4 v44, s[16:19], s49 offen offset:2048 lds
    buffer_load_dwordx4 v45, s[16:19], s49 offen offset:3072 lds
    buffer_store_dwordx4 v[88:91], v74, s[24:27], 0 offen sc1
    s_add_u32 s36, s92, 2555904
    buffer_store_dwordx4 v[88:91], v67, s[24:27], s36 offen offset:0 sc1
    buffer_store_dwordx4 v[88:91], v67, s[24:27], s36 offen offset:768 sc1
    buffer_store_dwordx4 v[88:91], v67, s[24:27], s36 offen offset:1536 sc1
    s_add_u32 s36, s92, 5177344
    buffer_store_dwordx4 v[88:91], v67, s[24:27], s36 offen offset:0 sc1
    buffer_store_dwordx4 v[88:91], v67, s[24:27], s36 offen offset:768 sc1
    buffer_store_dwordx4 v[88:91], v67, s[24:27], s36 offen offset:1536 sc1
    s_barrier
    ds_read_b64_tr_b16 a[160:161], v12 offset:32768
    ds_read_b64_tr_b16 a[162:163], v12 offset:36864
    ds_read_b64_tr_b16 a[164:165], v12 offset:40960
    ds_read_b64_tr_b16 a[166:167], v12 offset:45056
    ds_read_b64_tr_b16 a[168:169], v13 offset:32768
    ds_read_b64_tr_b16 a[170:171], v13 offset:36864
    ds_read_b64_tr_b16 a[172:173], v13 offset:40960
    ds_read_b64_tr_b16 a[174:175], v13 offset:45056
    ds_read_b64_tr_b16 a[176:177], v14 offset:32768
    ds_read_b64_tr_b16 a[178:179], v14 offset:36864
    ds_read_b64_tr_b16 a[180:181], v14 offset:40960
    ds_read_b64_tr_b16 a[182:183], v14 offset:45056
    s_waitcnt lgkmcnt(10)
    s_waitcnt vmcnt(26)
    v_mfma_f32_16x16x32_bf16 v[128:131], a[160:163], a[0:3], 0
    s_waitcnt vmcnt(25)
    s_waitcnt lgkmcnt(8)
    ds_read_b64_tr_b16 a[184:185], v15 offset:32768
    v_mfma_f32_16x16x32_bf16 v[128:131], a[164:167], a[8:11], v[128:131]
    s_waitcnt vmcnt(24)
    ds_read_b64_tr_b16 a[186:187], v15 offset:36864
    v_mfma_f32_16x16x32_bf16 v[132:135], a[160:163], a[4:7], 0
    s_waitcnt vmcnt(23)
    ds_read_b64_tr_b16 a[188:189], v15 offset:40960
    v_mfma_f32_16x16x32_bf16 v[132:135], a[164:167], a[12:15], v[132:135]
    s_waitcnt lgkmcnt(9)
    buffer_load_dwordx4 a[48:51], v51, s[24:27], s46 offen offset:768 sc1
    v_mfma_f32_16x16x32_bf16 v[136:139], a[168:171], a[0:3], 0
    s_waitcnt lgkmcnt(7)
    ds_read_b64_tr_b16 a[190:191], v15 offset:45056
    ds_read_b64_tr_b16 a[160:161], v16 offset:32768
    v_mfma_f32_16x16x32_bf16 v[136:139], a[172:175], a[8:11], v[136:139]
    ds_read_b64_tr_b16 a[162:163], v16 offset:36864
    v_mfma_f32_16x16x32_bf16 v[140:143], a[168:171], a[4:7], 0
    ds_read_b64_tr_b16 a[164:165], v16 offset:40960
    v_mfma_f32_16x16x32_bf16 v[140:143], a[172:175], a[12:15], v[140:143]
    s_waitcnt lgkmcnt(9)
    buffer_load_dwordx4 a[56:59], v51, s[24:27], s46 offen offset:896 sc1
    v_mfma_f32_16x16x32_bf16 v[144:147], a[176:179], a[0:3], 0
    s_waitcnt lgkmcnt(7)
    ds_read_b64_tr_b16 a[166:167], v16 offset:45056
    ds_read_b64_tr_b16 a[168:169], v17 offset:32768
    v_mfma_f32_16x16x32_bf16 v[144:147], a[180:183], a[8:11], v[144:147]
    ds_read_b64_tr_b16 a[170:171], v17 offset:36864
    v_mfma_f32_16x16x32_bf16 v[148:151], a[176:179], a[4:7], 0
    ds_read_b64_tr_b16 a[172:173], v17 offset:40960
    v_mfma_f32_16x16x32_bf16 v[148:151], a[180:183], a[12:15], v[148:151]
    s_waitcnt lgkmcnt(9)
    buffer_load_dwordx4 a[52:55], v51, s[24:27], s43 offen offset:768 sc1
    v_mfma_f32_16x16x32_bf16 v[152:155], a[184:187], a[0:3], 0
    s_waitcnt lgkmcnt(7)
    ds_read_b64_tr_b16 a[174:175], v17 offset:45056
    ds_read_b64_tr_b16 a[176:177], v18 offset:32768
    v_mfma_f32_16x16x32_bf16 v[152:155], a[188:191], a[8:11], v[152:155]
    ds_read_b64_tr_b16 a[178:179], v18 offset:36864
    v_mfma_f32_16x16x32_bf16 v[156:159], a[184:187], a[4:7], 0
    ds_read_b64_tr_b16 a[180:181], v18 offset:40960
    v_mfma_f32_16x16x32_bf16 v[156:159], a[188:191], a[12:15], v[156:159]
    s_waitcnt lgkmcnt(9)
    buffer_load_dwordx4 a[60:63], v51, s[24:27], s43 offen offset:896 sc1
    v_mfma_f32_16x16x32_bf16 v[160:163], a[160:163], a[0:3], 0
    s_waitcnt lgkmcnt(7)
    ds_read_b64_tr_b16 a[182:183], v18 offset:45056
    ds_read_b64_tr_b16 a[184:185], v19 offset:32768
    v_mfma_f32_16x16x32_bf16 v[160:163], a[164:167], a[8:11], v[160:163]
    s_add_u32 s49, s44, 2097152
    ds_read_b64_tr_b16 a[186:187], v19 offset:36864
    v_mfma_f32_16x16x32_bf16 v[164:167], a[160:163], a[4:7], 0
    s_add_u32 m0, s42, 0
    ds_read_b64_tr_b16 a[188:189], v19 offset:40960
    v_mfma_f32_16x16x32_bf16 v[164:167], a[164:167], a[12:15], v[164:167]
    s_waitcnt lgkmcnt(9)
    buffer_load_dwordx4 v42, s[16:19], s49 offen lds
    v_mfma_f32_16x16x32_bf16 v[168:171], a[168:171], a[0:3], 0
    s_waitcnt lgkmcnt(7)
    ds_read_b64_tr_b16 a[190:191], v19 offset:45056
    ds_read_b64_tr_b16 a[160:161], v12 offset:49152
    v_mfma_f32_16x16x32_bf16 v[168:171], a[172:175], a[8:11], v[168:171]
    ds_read_b64_tr_b16 a[162:163], v12 offset:53248
    v_mfma_f32_16x16x32_bf16 v[172:175], a[168:171], a[4:7], 0
    ds_read_b64_tr_b16 a[164:165], v12 offset:57344
    v_mfma_f32_16x16x32_bf16 v[172:175], a[172:175], a[12:15], v[172:175]
    s_waitcnt lgkmcnt(9)
    buffer_load_dwordx4 v43, s[16:19], s49 offen offset:1024 lds
    v_mfma_f32_16x16x32_bf16 v[176:179], a[176:179], a[0:3], 0
    s_waitcnt lgkmcnt(7)
    ds_read_b64_tr_b16 a[166:167], v12 offset:61440
    ds_read_b64_tr_b16 a[168:169], v13 offset:49152
    v_mfma_f32_16x16x32_bf16 v[176:179], a[180:183], a[8:11], v[176:179]
    ds_read_b64_tr_b16 a[170:171], v13 offset:53248
    v_mfma_f32_16x16x32_bf16 v[180:183], a[176:179], a[4:7], 0
    ds_read_b64_tr_b16 a[172:173], v13 offset:57344
    v_mfma_f32_16x16x32_bf16 v[180:183], a[180:183], a[12:15], v[180:183]
    s_waitcnt lgkmcnt(9)
    buffer_load_dwordx4 v44, s[16:19], s49 offen offset:2048 lds
    v_mfma_f32_16x16x32_bf16 v[184:187], a[184:187], a[0:3], 0
    s_waitcnt lgkmcnt(7)
    ds_read_b64_tr_b16 a[174:175], v13 offset:61440
    ds_read_b64_tr_b16 a[176:177], v14 offset:49152
    v_mfma_f32_16x16x32_bf16 v[184:187], a[188:191], a[8:11], v[184:187]
    ds_read_b64_tr_b16 a[178:179], v14 offset:53248
    v_mfma_f32_16x16x32_bf16 v[188:191], a[184:187], a[4:7], 0
    ds_read_b64_tr_b16 a[180:181], v14 offset:57344
    v_mfma_f32_16x16x32_bf16 v[188:191], a[188:191], a[12:15], v[188:191]
    s_waitcnt lgkmcnt(9)
    buffer_load_dwordx4 v45, s[16:19], s49 offen offset:3072 lds
    v_mfma_f32_16x16x32_bf16 v[192:195], a[160:163], a[0:3], 0
    s_waitcnt lgkmcnt(7)
    ds_read_b64_tr_b16 a[182:183], v14 offset:61440
    ds_read_b64_tr_b16 a[184:185], v15 offset:49152
    v_mfma_f32_16x16x32_bf16 v[192:195], a[164:167], a[8:11], v[192:195]
    s_add_u32 s49, s44, 2097408
    ds_read_b64_tr_b16 a[186:187], v15 offset:53248
    v_mfma_f32_16x16x32_bf16 v[196:199], a[160:163], a[4:7], 0
    s_add_u32 m0, s42, 16384
    ds_read_b64_tr_b16 a[188:189], v15 offset:57344
    v_mfma_f32_16x16x32_bf16 v[196:199], a[164:167], a[12:15], v[196:199]
    s_waitcnt lgkmcnt(9)
    buffer_load_dwordx4 v42, s[16:19], s49 offen lds
    v_mfma_f32_16x16x32_bf16 v[200:203], a[168:171], a[0:3], 0
    s_waitcnt lgkmcnt(7)
    ds_read_b64_tr_b16 a[190:191], v15 offset:61440
    ds_read_b64_tr_b16 a[160:161], v16 offset:49152
    v_mfma_f32_16x16x32_bf16 v[200:203], a[172:175], a[8:11], v[200:203]
    ds_read_b64_tr_b16 a[162:163], v16 offset:53248
    v_mfma_f32_16x16x32_bf16 v[204:207], a[168:171], a[4:7], 0
    ds_read_b64_tr_b16 a[164:165], v16 offset:57344
    v_mfma_f32_16x16x32_bf16 v[204:207], a[172:175], a[12:15], v[204:207]
    s_waitcnt lgkmcnt(9)
    buffer_load_dwordx4 v43, s[16:19], s49 offen offset:1024 lds
    v_mfma_f32_16x16x32_bf16 v[208:211], a[176:179], a[0:3], 0
    s_waitcnt lgkmcnt(7)
    ds_read_b64_tr_b16 a[166:167], v16 offset:61440
    ds_read_b64_tr_b16 a[168:169], v17 offset:49152
    v_mfma_f32_16x16x32_bf16 v[208:211], a[180:183], a[8:11], v[208:211]
    ds_read_b64_tr_b16 a[170:171], v17 offset:53248
    v_mfma_f32_16x16x32_bf16 v[212:215], a[176:179], a[4:7], 0
    ds_read_b64_tr_b16 a[172:173], v17 offset:57344
    v_mfma_f32_16x16x32_bf16 v[212:215], a[180:183], a[12:15], v[212:215]
    s_waitcnt lgkmcnt(9)
    buffer_load_dwordx4 v44, s[16:19], s49 offen offset:2048 lds
    v_mfma_f32_16x16x32_bf16 v[216:219], a[184:187], a[0:3], 0
    s_waitcnt lgkmcnt(7)
    ds_read_b64_tr_b16 a[174:175], v17 offset:61440
    ds_read_b64_tr_b16 a[176:177], v18 offset:49152
    v_mfma_f32_16x16x32_bf16 v[216:219], a[188:191], a[8:11], v[216:219]
    ds_read_b64_tr_b16 a[178:179], v18 offset:53248
    v_mfma_f32_16x16x32_bf16 v[220:223], a[184:187], a[4:7], 0
    ds_read_b64_tr_b16 a[180:181], v18 offset:57344
    v_mfma_f32_16x16x32_bf16 v[220:223], a[188:191], a[12:15], v[220:223]
    s_waitcnt lgkmcnt(9)
    buffer_load_dwordx4 v45, s[16:19], s49 offen offset:3072 lds
    v_mfma_f32_16x16x32_bf16 v[224:227], a[160:163], a[0:3], 0
    s_waitcnt lgkmcnt(7)
    ds_read_b64_tr_b16 a[182:183], v18 offset:61440
    ds_read_b64_tr_b16 a[184:185], v19 offset:49152
    v_mfma_f32_16x16x32_bf16 v[224:227], a[164:167], a[8:11], v[224:227]
    ds_read_b64_tr_b16 a[186:187], v19 offset:53248
    v_mfma_f32_16x16x32_bf16 v[228:231], a[160:163], a[4:7], 0
    ds_read_b64_tr_b16 a[188:189], v19 offset:57344
    v_mfma_f32_16x16x32_bf16 v[228:231], a[164:167], a[12:15], v[228:231]
    s_waitcnt lgkmcnt(9)
    ds_read_b64_tr_b16 a[190:191], v19 offset:61440
    s_barrier
    v_mfma_f32_16x16x32_bf16 v[232:235], a[168:171], a[0:3], 0
    s_waitcnt lgkmcnt(8)
    ds_read_b64_tr_b16 a[160:161], v20 offset:0
    v_mfma_f32_16x16x32_bf16 v[232:235], a[172:175], a[8:11], v[232:235]
    ds_read_b64_tr_b16 a[162:163], v20 offset:4096
    v_mfma_f32_16x16x32_bf16 v[236:239], a[168:171], a[4:7], 0
    ds_read_b64_tr_b16 a[164:165], v20 offset:8192
    v_mfma_f32_16x16x32_bf16 v[236:239], a[172:175], a[12:15], v[236:239]
    s_waitcnt lgkmcnt(9)
    buffer_load_dwordx4 a[64:67], v51, s[24:27], s46 offen offset:1024 sc1
    v_mfma_f32_16x16x32_bf16 v[240:243], a[176:179], a[0:3], 0
    s_waitcnt lgkmcnt(7)
    ds_read_b64_tr_b16 a[166:167], v20 offset:12288
    ds_read_b64_tr_b16 a[168:169], v21 offset:0
    v_mfma_f32_16x16x32_bf16 v[240:243], a[180:183], a[8:11], v[240:243]
    ds_read_b64_tr_b16 a[170:171], v21 offset:4096
    v_mfma_f32_16x16x32_bf16 v[244:247], a[176:179], a[4:7], 0
    ds_read_b64_tr_b16 a[172:173], v21 offset:8192
    v_mfma_f32_16x16x32_bf16 v[244:247], a[180:183], a[12:15], v[244:247]
    s_waitcnt lgkmcnt(9)
    buffer_load_dwordx4 a[72:75], v51, s[24:27], s46 offen offset:1152 sc1
    v_mfma_f32_16x16x32_bf16 v[248:251], a[184:187], a[0:3], 0
    s_waitcnt lgkmcnt(7)
    ds_read_b64_tr_b16 a[174:175], v21 offset:12288
    ds_read_b64_tr_b16 a[176:177], v22 offset:0
    v_mfma_f32_16x16x32_bf16 v[248:251], a[188:191], a[8:11], v[248:251]
    ds_read_b64_tr_b16 a[178:179], v22 offset:4096
    v_mfma_f32_16x16x32_bf16 v[252:255], a[184:187], a[4:7], 0
    ds_read_b64_tr_b16 a[180:181], v22 offset:8192
    v_mfma_f32_16x16x32_bf16 v[252:255], a[188:191], a[12:15], v[252:255]
    s_waitcnt vmcnt(36)
    s_waitcnt lgkmcnt(9)
    buffer_load_dwordx4 a[68:71], v51, s[24:27], s43 offen offset:1024 sc1
    v_mfma_f32_16x16x32_bf16 v[128:131], a[160:163], a[16:19], v[128:131]
    s_waitcnt vmcnt(36)
    s_waitcnt lgkmcnt(7)
    ds_read_b64_tr_b16 a[182:183], v22 offset:12288
    ds_read_b64_tr_b16 a[184:185], v23 offset:0
    v_mfma_f32_16x16x32_bf16 v[128:131], a[164:167], a[24:27], v[128:131]
    s_waitcnt vmcnt(35)
    ds_read_b64_tr_b16 a[186:187], v23 offset:4096
    v_mfma_f32_16x16x32_bf16 v[132:135], a[160:163], a[20:23], v[132:135]
    s_waitcnt vmcnt(34)
    ds_read_b64_tr_b16 a[188:189], v23 offset:8192
    v_mfma_f32_16x16x32_bf16 v[132:135], a[164:167], a[28:31], v[132:135]
    s_waitcnt lgkmcnt(9)
    buffer_load_dwordx4 a[76:79], v51, s[24:27], s43 offen offset:1152 sc1
    v_mfma_f32_16x16x32_bf16 v[136:139], a[168:171], a[16:19], v[136:139]
    s_waitcnt lgkmcnt(7)
    ds_read_b64_tr_b16 a[190:191], v23 offset:12288
    ds_read_b64_tr_b16 a[160:161], v24 offset:0
    v_mfma_f32_16x16x32_bf16 v[136:139], a[172:175], a[24:27], v[136:139]
    ds_read_b64_tr_b16 a[162:163], v24 offset:4096
    v_mfma_f32_16x16x32_bf16 v[140:143], a[168:171], a[20:23], v[140:143]
    ds_read_b64_tr_b16 a[164:165], v24 offset:8192
    v_mfma_f32_16x16x32_bf16 v[140:143], a[172:175], a[28:31], v[140:143]
    s_waitcnt lgkmcnt(9)
    buffer_load_dwordx4 a[80:83], v51, s[24:27], s46 offen offset:1280 sc1
    v_mfma_f32_16x16x32_bf16 v[144:147], a[176:179], a[16:19], v[144:147]
    s_waitcnt lgkmcnt(7)
    ds_read_b64_tr_b16 a[166:167], v24 offset:12288
    ds_read_b64_tr_b16 a[168:169], v25 offset:0
    v_mfma_f32_16x16x32_bf16 v[144:147], a[180:183], a[24:27], v[144:147]
    ds_read_b64_tr_b16 a[170:171], v25 offset:4096
    v_mfma_f32_16x16x32_bf16 v[148:151], a[176:179], a[20:23], v[148:151]
    ds_read_b64_tr_b16 a[172:173], v25 offset:8192
    v_mfma_f32_16x16x32_bf16 v[148:151], a[180:183], a[28:31], v[148:151]
    s_waitcnt lgkmcnt(9)
    buffer_load_dwordx4 a[88:91], v51, s[24:27], s46 offen offset:1408 sc1
    v_mfma_f32_16x16x32_bf16 v[152:155], a[184:187], a[16:19], v[152:155]
    s_waitcnt lgkmcnt(7)
    ds_read_b64_tr_b16 a[174:175], v25 offset:12288
    ds_read_b64_tr_b16 a[176:177], v26 offset:0
    v_mfma_f32_16x16x32_bf16 v[152:155], a[188:191], a[24:27], v[152:155]
    ds_read_b64_tr_b16 a[178:179], v26 offset:4096
    v_mfma_f32_16x16x32_bf16 v[156:159], a[184:187], a[20:23], v[156:159]
    ds_read_b64_tr_b16 a[180:181], v26 offset:8192
    v_mfma_f32_16x16x32_bf16 v[156:159], a[188:191], a[28:31], v[156:159]
    s_waitcnt lgkmcnt(9)
    buffer_load_dwordx4 a[84:87], v51, s[24:27], s43 offen offset:1280 sc1
    v_mfma_f32_16x16x32_bf16 v[160:163], a[160:163], a[16:19], v[160:163]
    s_waitcnt lgkmcnt(7)
    ds_read_b64_tr_b16 a[182:183], v26 offset:12288
    ds_read_b64_tr_b16 a[184:185], v27 offset:0
    v_mfma_f32_16x16x32_bf16 v[160:163], a[164:167], a[24:27], v[160:163]
    ds_read_b64_tr_b16 a[186:187], v27 offset:4096
    v_mfma_f32_16x16x32_bf16 v[164:167], a[160:163], a[20:23], v[164:167]
    ds_read_b64_tr_b16 a[188:189], v27 offset:8192
    v_mfma_f32_16x16x32_bf16 v[164:167], a[164:167], a[28:31], v[164:167]
    s_waitcnt lgkmcnt(9)
    buffer_load_dwordx4 a[92:95], v51, s[24:27], s43 offen offset:1408 sc1
    v_mfma_f32_16x16x32_bf16 v[168:171], a[168:171], a[16:19], v[168:171]
    s_waitcnt lgkmcnt(7)
    ds_read_b64_tr_b16 a[190:191], v27 offset:12288
    ds_read_b64_tr_b16 a[160:161], v20 offset:16384
    v_mfma_f32_16x16x32_bf16 v[168:171], a[172:175], a[24:27], v[168:171]
    ds_read_b64_tr_b16 a[162:163], v20 offset:20480
    v_mfma_f32_16x16x32_bf16 v[172:175], a[168:171], a[20:23], v[172:175]
    ds_read_b64_tr_b16 a[164:165], v20 offset:24576
    v_mfma_f32_16x16x32_bf16 v[172:175], a[172:175], a[28:31], v[172:175]
    s_waitcnt lgkmcnt(9)
    buffer_load_dwordx4 a[96:99], v51, s[24:27], s46 offen offset:1536 sc1
    v_mfma_f32_16x16x32_bf16 v[176:179], a[176:179], a[16:19], v[176:179]
    s_waitcnt lgkmcnt(7)
    ds_read_b64_tr_b16 a[166:167], v20 offset:28672
    ds_read_b64_tr_b16 a[168:169], v21 offset:16384
    v_mfma_f32_16x16x32_bf16 v[176:179], a[180:183], a[24:27], v[176:179]
    ds_read_b64_tr_b16 a[170:171], v21 offset:20480
    v_mfma_f32_16x16x32_bf16 v[180:183], a[176:179], a[20:23], v[180:183]
    ds_read_b64_tr_b16 a[172:173], v21 offset:24576
    v_mfma_f32_16x16x32_bf16 v[180:183], a[180:183], a[28:31], v[180:183]
    s_waitcnt lgkmcnt(9)
    buffer_load_dwordx4 a[104:107], v51, s[24:27], s46 offen offset:1664 sc1
    v_mfma_f32_16x16x32_bf16 v[184:187], a[184:187], a[16:19], v[184:187]
    s_waitcnt lgkmcnt(7)
    ds_read_b64_tr_b16 a[174:175], v21 offset:28672
    ds_read_b64_tr_b16 a[176:177], v22 offset:16384
    v_mfma_f32_16x16x32_bf16 v[184:187], a[188:191], a[24:27], v[184:187]
    ds_read_b64_tr_b16 a[178:179], v22 offset:20480
    v_mfma_f32_16x16x32_bf16 v[188:191], a[184:187], a[20:23], v[188:191]
    ds_read_b64_tr_b16 a[180:181], v22 offset:24576
    v_mfma_f32_16x16x32_bf16 v[188:191], a[188:191], a[28:31], v[188:191]
    s_waitcnt lgkmcnt(9)
    buffer_load_dwordx4 a[100:103], v51, s[24:27], s43 offen offset:1536 sc1
    v_mfma_f32_16x16x32_bf16 v[192:195], a[160:163], a[16:19], v[192:195]
    s_waitcnt lgkmcnt(7)
    ds_read_b64_tr_b16 a[182:183], v22 offset:28672
    ds_read_b64_tr_b16 a[184:185], v23 offset:16384
    v_mfma_f32_16x16x32_bf16 v[192:195], a[164:167], a[24:27], v[192:195]
    ds_read_b64_tr_b16 a[186:187], v23 offset:20480
    v_mfma_f32_16x16x32_bf16 v[196:199], a[160:163], a[20:23], v[196:199]
    ds_read_b64_tr_b16 a[188:189], v23 offset:24576
    v_mfma_f32_16x16x32_bf16 v[196:199], a[164:167], a[28:31], v[196:199]
    s_waitcnt lgkmcnt(9)
    buffer_load_dwordx4 a[108:111], v51, s[24:27], s43 offen offset:1664 sc1
    v_mfma_f32_16x16x32_bf16 v[200:203], a[168:171], a[16:19], v[200:203]
    s_waitcnt lgkmcnt(7)
    ds_read_b64_tr_b16 a[190:191], v23 offset:28672
    ds_read_b64_tr_b16 a[160:161], v24 offset:16384
    v_mfma_f32_16x16x32_bf16 v[200:203], a[172:175], a[24:27], v[200:203]
    ds_read_b64_tr_b16 a[162:163], v24 offset:20480
    v_mfma_f32_16x16x32_bf16 v[204:207], a[168:171], a[20:23], v[204:207]
    ds_read_b64_tr_b16 a[164:165], v24 offset:24576
    v_mfma_f32_16x16x32_bf16 v[204:207], a[172:175], a[28:31], v[204:207]
    s_waitcnt lgkmcnt(9)
    ds_read_b64_tr_b16 a[166:167], v24 offset:28672
    v_mfma_f32_16x16x32_bf16 v[208:211], a[176:179], a[16:19], v[208:211]
    s_waitcnt lgkmcnt(8)
    ds_read_b64_tr_b16 a[168:169], v25 offset:16384
    v_mfma_f32_16x16x32_bf16 v[208:211], a[180:183], a[24:27], v[208:211]
    ds_read_b64_tr_b16 a[170:171], v25 offset:20480
    v_mfma_f32_16x16x32_bf16 v[212:215], a[176:179], a[20:23], v[212:215]
    ds_read_b64_tr_b16 a[172:173], v25 offset:24576
    v_mfma_f32_16x16x32_bf16 v[212:215], a[180:183], a[28:31], v[212:215]
    s_waitcnt lgkmcnt(9)
    ds_read_b64_tr_b16 a[174:175], v25 offset:28672
    v_mfma_f32_16x16x32_bf16 v[216:219], a[184:187], a[16:19], v[216:219]
    s_waitcnt lgkmcnt(8)
    ds_read_b64_tr_b16 a[176:177], v26 offset:16384
    v_mfma_f32_16x16x32_bf16 v[216:219], a[188:191], a[24:27], v[216:219]
    ds_read_b64_tr_b16 a[178:179], v26 offset:20480
    v_mfma_f32_16x16x32_bf16 v[220:223], a[184:187], a[20:23], v[220:223]
    ds_read_b64_tr_b16 a[180:181], v26 offset:24576
    v_mfma_f32_16x16x32_bf16 v[220:223], a[188:191], a[28:31], v[220:223]
    s_waitcnt lgkmcnt(9)
    ds_read_b64_tr_b16 a[182:183], v26 offset:28672
    v_mfma_f32_16x16x32_bf16 v[224:227], a[160:163], a[16:19], v[224:227]
    s_waitcnt lgkmcnt(8)
    ds_read_b64_tr_b16 a[184:185], v27 offset:16384
    v_mfma_f32_16x16x32_bf16 v[224:227], a[164:167], a[24:27], v[224:227]
    ds_read_b64_tr_b16 a[186:187], v27 offset:20480
    v_mfma_f32_16x16x32_bf16 v[228:231], a[160:163], a[20:23], v[228:231]
    ds_read_b64_tr_b16 a[188:189], v27 offset:24576
    v_mfma_f32_16x16x32_bf16 v[228:231], a[164:167], a[28:31], v[228:231]
    s_waitcnt lgkmcnt(9)
    ds_read_b64_tr_b16 a[190:191], v27 offset:28672
    s_barrier
    v_mfma_f32_16x16x32_bf16 v[232:235], a[168:171], a[16:19], v[232:235]
    s_waitcnt lgkmcnt(8)
    ds_read_b64_tr_b16 a[160:161], v20 offset:32768
    v_mfma_f32_16x16x32_bf16 v[232:235], a[172:175], a[24:27], v[232:235]
    ds_read_b64_tr_b16 a[162:163], v20 offset:36864
    v_mfma_f32_16x16x32_bf16 v[236:239], a[168:171], a[20:23], v[236:239]
    ds_read_b64_tr_b16 a[164:165], v20 offset:40960
    v_mfma_f32_16x16x32_bf16 v[236:239], a[172:175], a[28:31], v[236:239]
    s_waitcnt lgkmcnt(9)
    buffer_load_dwordx4 a[112:115], v51, s[24:27], s46 offen offset:1792 sc1
    v_mfma_f32_16x16x32_bf16 v[240:243], a[176:179], a[16:19], v[240:243]
    s_waitcnt lgkmcnt(7)
    ds_read_b64_tr_b16 a[166:167], v20 offset:45056
    ds_read_b64_tr_b16 a[168:169], v21 offset:32768
    v_mfma_f32_16x16x32_bf16 v[240:243], a[180:183], a[24:27], v[240:243]
    ds_read_b64_tr_b16 a[170:171], v21 offset:36864
    v_mfma_f32_16x16x32_bf16 v[244:247], a[176:179], a[20:23], v[244:247]
    ds_read_b64_tr_b16 a[172:173], v21 offset:40960
    v_mfma_f32_16x16x32_bf16 v[244:247], a[180:183], a[28:31], v[244:247]
    s_waitcnt lgkmcnt(9)
    buffer_load_dwordx4 a[120:123], v51, s[24:27], s46 offen offset:1920 sc1
    v_mfma_f32_16x16x32_bf16 v[248:251], a[184:187], a[16:19], v[248:251]
    s_waitcnt lgkmcnt(7)
    ds_read_b64_tr_b16 a[174:175], v21 offset:45056
    ds_read_b64_tr_b16 a[176:177], v22 offset:32768
    v_mfma_f32_16x16x32_bf16 v[248:251], a[188:191], a[24:27], v[248:251]
    ds_read_b64_tr_b16 a[178:179], v22 offset:36864
    v_mfma_f32_16x16x32_bf16 v[252:255], a[184:187], a[20:23], v[252:255]
    ds_read_b64_tr_b16 a[180:181], v22 offset:40960
    v_mfma_f32_16x16x32_bf16 v[252:255], a[188:191], a[28:31], v[252:255]
    s_waitcnt vmcnt(44)
    s_waitcnt lgkmcnt(9)
    buffer_load_dwordx4 a[116:119], v51, s[24:27], s43 offen offset:1792 sc1
    v_mfma_f32_16x16x32_bf16 v[128:131], a[160:163], a[32:35], v[128:131]
    s_waitcnt vmcnt(44)
    s_waitcnt lgkmcnt(7)
    ds_read_b64_tr_b16 a[182:183], v22 offset:45056
    ds_read_b64_tr_b16 a[184:185], v23 offset:32768
    v_mfma_f32_16x16x32_bf16 v[128:131], a[164:167], a[40:43], v[128:131]
    s_waitcnt vmcnt(43)
    ds_read_b64_tr_b16 a[186:187], v23 offset:36864
    v_mfma_f32_16x16x32_bf16 v[132:135], a[160:163], a[36:39], v[132:135]
    s_waitcnt vmcnt(42)
    ds_read_b64_tr_b16 a[188:189], v23 offset:40960
    v_mfma_f32_16x16x32_bf16 v[132:135], a[164:167], a[44:47], v[132:135]
    s_waitcnt lgkmcnt(9)
    buffer_load_dwordx4 a[124:127], v51, s[24:27], s43 offen offset:1920 sc1
    v_mfma_f32_16x16x32_bf16 v[136:139], a[168:171], a[32:35], v[136:139]
    s_waitcnt lgkmcnt(7)
    ds_read_b64_tr_b16 a[190:191], v23 offset:45056
    ds_read_b64_tr_b16 a[160:161], v24 offset:32768
    v_mfma_f32_16x16x32_bf16 v[136:139], a[172:175], a[40:43], v[136:139]
    s_add_u32 s49, s44, 2621440
    ds_read_b64_tr_b16 a[162:163], v24 offset:36864
    v_mfma_f32_16x16x32_bf16 v[140:143], a[168:171], a[36:39], v[140:143]
    s_add_u32 m0, s42, 32768
    ds_read_b64_tr_b16 a[164:165], v24 offset:40960
    v_mfma_f32_16x16x32_bf16 v[140:143], a[172:175], a[44:47], v[140:143]
    s_waitcnt lgkmcnt(9)
    buffer_load_dwordx4 v42, s[16:19], s49 offen lds
    v_mfma_f32_16x16x32_bf16 v[144:147], a[176:179], a[32:35], v[144:147]
    s_waitcnt lgkmcnt(7)
    ds_read_b64_tr_b16 a[166:167], v24 offset:45056
    ds_read_b64_tr_b16 a[168:169], v25 offset:32768
    v_mfma_f32_16x16x32_bf16 v[144:147], a[180:183], a[40:43], v[144:147]
    ds_read_b64_tr_b16 a[170:171], v25 offset:36864
    v_mfma_f32_16x16x32_bf16 v[148:151], a[176:179], a[36:39], v[148:151]
    ds_read_b64_tr_b16 a[172:173], v25 offset:40960
    v_mfma_f32_16x16x32_bf16 v[148:151], a[180:183], a[44:47], v[148:151]
    s_waitcnt lgkmcnt(9)
    buffer_load_dwordx4 v43, s[16:19], s49 offen offset:1024 lds
    v_mfma_f32_16x16x32_bf16 v[152:155], a[184:187], a[32:35], v[152:155]
    s_waitcnt lgkmcnt(7)
    ds_read_b64_tr_b16 a[174:175], v25 offset:45056
    ds_read_b64_tr_b16 a[176:177], v26 offset:32768
    v_mfma_f32_16x16x32_bf16 v[152:155], a[188:191], a[40:43], v[152:155]
    ds_read_b64_tr_b16 a[178:179], v26 offset:36864
    v_mfma_f32_16x16x32_bf16 v[156:159], a[184:187], a[36:39], v[156:159]
    ds_read_b64_tr_b16 a[180:181], v26 offset:40960
    v_mfma_f32_16x16x32_bf16 v[156:159], a[188:191], a[44:47], v[156:159]
    s_waitcnt lgkmcnt(9)
    buffer_load_dwordx4 v44, s[16:19], s49 offen offset:2048 lds
    v_mfma_f32_16x16x32_bf16 v[160:163], a[160:163], a[32:35], v[160:163]
    s_waitcnt lgkmcnt(7)
    ds_read_b64_tr_b16 a[182:183], v26 offset:45056
    ds_read_b64_tr_b16 a[184:185], v27 offset:32768
    v_mfma_f32_16x16x32_bf16 v[160:163], a[164:167], a[40:43], v[160:163]
    ds_read_b64_tr_b16 a[186:187], v27 offset:36864
    v_mfma_f32_16x16x32_bf16 v[164:167], a[160:163], a[36:39], v[164:167]
    ds_read_b64_tr_b16 a[188:189], v27 offset:40960
    v_mfma_f32_16x16x32_bf16 v[164:167], a[164:167], a[44:47], v[164:167]
    s_waitcnt lgkmcnt(9)
    buffer_load_dwordx4 v45, s[16:19], s49 offen offset:3072 lds
    v_mfma_f32_16x16x32_bf16 v[168:171], a[168:171], a[32:35], v[168:171]
    s_waitcnt lgkmcnt(7)
    ds_read_b64_tr_b16 a[190:191], v27 offset:45056
    ds_read_b64_tr_b16 a[160:161], v20 offset:49152
    v_mfma_f32_16x16x32_bf16 v[168:171], a[172:175], a[40:43], v[168:171]
    s_add_u32 s49, s44, 2621696
    ds_read_b64_tr_b16 a[162:163], v20 offset:53248
    v_mfma_f32_16x16x32_bf16 v[172:175], a[168:171], a[36:39], v[172:175]
    s_add_u32 m0, s42, 49152
    ds_read_b64_tr_b16 a[164:165], v20 offset:57344
    v_mfma_f32_16x16x32_bf16 v[172:175], a[172:175], a[44:47], v[172:175]
    s_waitcnt lgkmcnt(9)
    buffer_load_dwordx4 v42, s[16:19], s49 offen lds
    v_mfma_f32_16x16x32_bf16 v[176:179], a[176:179], a[32:35], v[176:179]
    s_waitcnt lgkmcnt(7)
    ds_read_b64_tr_b16 a[166:167], v20 offset:61440
    ds_read_b64_tr_b16 a[168:169], v21 offset:49152
    v_mfma_f32_16x16x32_bf16 v[176:179], a[180:183], a[40:43], v[176:179]
    ds_read_b64_tr_b16 a[170:171], v21 offset:53248
    v_mfma_f32_16x16x32_bf16 v[180:183], a[176:179], a[36:39], v[180:183]
    ds_read_b64_tr_b16 a[172:173], v21 offset:57344
    v_mfma_f32_16x16x32_bf16 v[180:183], a[180:183], a[44:47], v[180:183]
    s_waitcnt lgkmcnt(9)
    buffer_load_dwordx4 v43, s[16:19], s49 offen offset:1024 lds
    v_mfma_f32_16x16x32_bf16 v[184:187], a[184:187], a[32:35], v[184:187]
    s_waitcnt lgkmcnt(7)
    ds_read_b64_tr_b16 a[174:175], v21 offset:61440
    ds_read_b64_tr_b16 a[176:177], v22 offset:49152
    v_mfma_f32_16x16x32_bf16 v[184:187], a[188:191], a[40:43], v[184:187]
    ds_read_b64_tr_b16 a[178:179], v22 offset:53248
    v_mfma_f32_16x16x32_bf16 v[188:191], a[184:187], a[36:39], v[188:191]
    ds_read_b64_tr_b16 a[180:181], v22 offset:57344
    v_mfma_f32_16x16x32_bf16 v[188:191], a[188:191], a[44:47], v[188:191]
    s_waitcnt lgkmcnt(9)
    buffer_load_dwordx4 v44, s[16:19], s49 offen offset:2048 lds
    v_mfma_f32_16x16x32_bf16 v[192:195], a[160:163], a[32:35], v[192:195]
    s_waitcnt lgkmcnt(7)
    ds_read_b64_tr_b16 a[182:183], v22 offset:61440
    ds_read_b64_tr_b16 a[184:185], v23 offset:49152
    v_mfma_f32_16x16x32_bf16 v[192:195], a[164:167], a[40:43], v[192:195]
    ds_read_b64_tr_b16 a[186:187], v23 offset:53248
    v_mfma_f32_16x16x32_bf16 v[196:199], a[160:163], a[36:39], v[196:199]
    ds_read_b64_tr_b16 a[188:189], v23 offset:57344
    v_mfma_f32_16x16x32_bf16 v[196:199], a[164:167], a[44:47], v[196:199]
    s_waitcnt lgkmcnt(9)
    buffer_load_dwordx4 v45, s[16:19], s49 offen offset:3072 lds
    v_mfma_f32_16x16x32_bf16 v[200:203], a[168:171], a[32:35], v[200:203]
    s_waitcnt lgkmcnt(7)
    ds_read_b64_tr_b16 a[190:191], v23 offset:61440
    ds_read_b64_tr_b16 a[160:161], v24 offset:49152
    v_mfma_f32_16x16x32_bf16 v[200:203], a[172:175], a[40:43], v[200:203]
    ds_read_b64_tr_b16 a[162:163], v24 offset:53248
    v_mfma_f32_16x16x32_bf16 v[204:207], a[168:171], a[36:39], v[204:207]
    ds_read_b64_tr_b16 a[164:165], v24 offset:57344
    v_mfma_f32_16x16x32_bf16 v[204:207], a[172:175], a[44:47], v[204:207]
    s_waitcnt lgkmcnt(9)
    ds_read_b64_tr_b16 a[166:167], v24 offset:61440
    v_mfma_f32_16x16x32_bf16 v[208:211], a[176:179], a[32:35], v[208:211]
    s_waitcnt lgkmcnt(8)
    ds_read_b64_tr_b16 a[168:169], v25 offset:49152
    v_mfma_f32_16x16x32_bf16 v[208:211], a[180:183], a[40:43], v[208:211]
    ds_read_b64_tr_b16 a[170:171], v25 offset:53248
    v_mfma_f32_16x16x32_bf16 v[212:215], a[176:179], a[36:39], v[212:215]
    ds_read_b64_tr_b16 a[172:173], v25 offset:57344
    v_mfma_f32_16x16x32_bf16 v[212:215], a[180:183], a[44:47], v[212:215]
    s_waitcnt lgkmcnt(9)
    ds_read_b64_tr_b16 a[174:175], v25 offset:61440
    v_mfma_f32_16x16x32_bf16 v[216:219], a[184:187], a[32:35], v[216:219]
    s_waitcnt lgkmcnt(8)
    ds_read_b64_tr_b16 a[176:177], v26 offset:49152
    v_mfma_f32_16x16x32_bf16 v[216:219], a[188:191], a[40:43], v[216:219]
    ds_read_b64_tr_b16 a[178:179], v26 offset:53248
    v_mfma_f32_16x16x32_bf16 v[220:223], a[184:187], a[36:39], v[220:223]
    ds_read_b64_tr_b16 a[180:181], v26 offset:57344
    v_mfma_f32_16x16x32_bf16 v[220:223], a[188:191], a[44:47], v[220:223]
    s_waitcnt lgkmcnt(9)
    ds_read_b64_tr_b16 a[182:183], v26 offset:61440
    v_mfma_f32_16x16x32_bf16 v[224:227], a[160:163], a[32:35], v[224:227]
    s_waitcnt lgkmcnt(8)
    ds_read_b64_tr_b16 a[184:185], v27 offset:49152
    v_mfma_f32_16x16x32_bf16 v[224:227], a[164:167], a[40:43], v[224:227]
    ds_read_b64_tr_b16 a[186:187], v27 offset:53248
    v_mfma_f32_16x16x32_bf16 v[228:231], a[160:163], a[36:39], v[228:231]
    ds_read_b64_tr_b16 a[188:189], v27 offset:57344
    v_mfma_f32_16x16x32_bf16 v[228:231], a[164:167], a[44:47], v[228:231]
    s_waitcnt lgkmcnt(9)
    ds_read_b64_tr_b16 a[190:191], v27 offset:61440
    s_waitcnt vmcnt(43)
    s_barrier
    v_mfma_f32_16x16x32_bf16 v[232:235], a[168:171], a[32:35], v[232:235]
    s_waitcnt lgkmcnt(8)
    ds_read_b64_tr_b16 a[160:161], v28 offset:0
    v_mfma_f32_16x16x32_bf16 v[232:235], a[172:175], a[40:43], v[232:235]
    ds_read_b64_tr_b16 a[162:163], v28 offset:4096
    v_mfma_f32_16x16x32_bf16 v[236:239], a[168:171], a[36:39], v[236:239]
    ds_read_b64_tr_b16 a[164:165], v28 offset:8192
    v_mfma_f32_16x16x32_bf16 v[236:239], a[172:175], a[44:47], v[236:239]
    s_waitcnt lgkmcnt(9)
    buffer_load_dwordx4 a[128:131], v51, s[24:27], s46 offen offset:2048 sc1
    v_mfma_f32_16x16x32_bf16 v[240:243], a[176:179], a[32:35], v[240:243]
    s_waitcnt lgkmcnt(7)
    ds_read_b64_tr_b16 a[166:167], v28 offset:12288
    ds_read_b64_tr_b16 a[168:169], v29 offset:0
    v_mfma_f32_16x16x32_bf16 v[240:243], a[180:183], a[40:43], v[240:243]
    ds_read_b64_tr_b16 a[170:171], v29 offset:4096
    v_mfma_f32_16x16x32_bf16 v[244:247], a[176:179], a[36:39], v[244:247]
    ds_read_b64_tr_b16 a[172:173], v29 offset:8192
    v_mfma_f32_16x16x32_bf16 v[244:247], a[180:183], a[44:47], v[244:247]
    s_waitcnt lgkmcnt(9)
    buffer_load_dwordx4 a[136:139], v51, s[24:27], s46 offen offset:2176 sc1
    v_mfma_f32_16x16x32_bf16 v[248:251], a[184:187], a[32:35], v[248:251]
    s_waitcnt lgkmcnt(7)
    ds_read_b64_tr_b16 a[174:175], v29 offset:12288
    ds_read_b64_tr_b16 a[176:177], v30 offset:0
    v_mfma_f32_16x16x32_bf16 v[248:251], a[188:191], a[40:43], v[248:251]
    ds_read_b64_tr_b16 a[178:179], v30 offset:4096
    v_mfma_f32_16x16x32_bf16 v[252:255], a[184:187], a[36:39], v[252:255]
    ds_read_b64_tr_b16 a[180:181], v30 offset:8192
    v_mfma_f32_16x16x32_bf16 v[252:255], a[188:191], a[44:47], v[252:255]
    s_waitcnt vmcnt(37)
    s_waitcnt lgkmcnt(9)
    buffer_load_dwordx4 a[132:135], v51, s[24:27], s43 offen offset:2048 sc1
    v_mfma_f32_16x16x32_bf16 v[128:131], a[160:163], a[48:51], v[128:131]
    s_waitcnt vmcnt(37)
    s_waitcnt lgkmcnt(7)
    ds_read_b64_tr_b16 a[182:183], v30 offset:12288
    ds_read_b64_tr_b16 a[184:185], v31 offset:0
    v_mfma_f32_16x16x32_bf16 v[128:131], a[164:167], a[56:59], v[128:131]
    s_waitcnt vmcnt(36)
    ds_read_b64_tr_b16 a[186:187], v31 offset:4096
    v_mfma_f32_16x16x32_bf16 v[132:135], a[160:163], a[52:55], v[132:135]
    s_waitcnt vmcnt(35)
    ds_read_b64_tr_b16 a[188:189], v31 offset:8192
    v_mfma_f32_16x16x32_bf16 v[132:135], a[164:167], a[60:63], v[132:135]
    s_waitcnt lgkmcnt(9)
    buffer_load_dwordx4 a[140:143], v51, s[24:27], s43 offen offset:2176 sc1
    v_mfma_f32_16x16x32_bf16 v[136:139], a[168:171], a[48:51], v[136:139]
    s_waitcnt lgkmcnt(7)
    ds_read_b64_tr_b16 a[190:191], v31 offset:12288
    ds_read_b64_tr_b16 a[160:161], v32 offset:0
    v_mfma_f32_16x16x32_bf16 v[136:139], a[172:175], a[56:59], v[136:139]
    s_add_u32 s49, s44, 3145728
    ds_read_b64_tr_b16 a[162:163], v32 offset:4096
    v_mfma_f32_16x16x32_bf16 v[140:143], a[168:171], a[52:55], v[140:143]
    s_add_u32 m0, s42, 65536
    ds_read_b64_tr_b16 a[164:165], v32 offset:8192
    v_mfma_f32_16x16x32_bf16 v[140:143], a[172:175], a[60:63], v[140:143]
    s_waitcnt lgkmcnt(9)
    buffer_load_dwordx4 v42, s[16:19], s49 offen lds
    v_mfma_f32_16x16x32_bf16 v[144:147], a[176:179], a[48:51], v[144:147]
    s_waitcnt lgkmcnt(7)
    ds_read_b64_tr_b16 a[166:167], v32 offset:12288
    ds_read_b64_tr_b16 a[168:169], v33 offset:0
    v_mfma_f32_16x16x32_bf16 v[144:147], a[180:183], a[56:59], v[144:147]
    ds_read_b64_tr_b16 a[170:171], v33 offset:4096
    v_mfma_f32_16x16x32_bf16 v[148:151], a[176:179], a[52:55], v[148:151]
    ds_read_b64_tr_b16 a[172:173], v33 offset:8192
    v_mfma_f32_16x16x32_bf16 v[148:151], a[180:183], a[60:63], v[148:151]
    s_waitcnt lgkmcnt(9)
    buffer_load_dwordx4 v43, s[16:19], s49 offen offset:1024 lds
    v_mfma_f32_16x16x32_bf16 v[152:155], a[184:187], a[48:51], v[152:155]
    s_waitcnt lgkmcnt(7)
    ds_read_b64_tr_b16 a[174:175], v33 offset:12288
    ds_read_b64_tr_b16 a[176:177], v34 offset:0
    v_mfma_f32_16x16x32_bf16 v[152:155], a[188:191], a[56:59], v[152:155]
    ds_read_b64_tr_b16 a[178:179], v34 offset:4096
    v_mfma_f32_16x16x32_bf16 v[156:159], a[184:187], a[52:55], v[156:159]
    ds_read_b64_tr_b16 a[180:181], v34 offset:8192
    v_mfma_f32_16x16x32_bf16 v[156:159], a[188:191], a[60:63], v[156:159]
    s_waitcnt lgkmcnt(9)
    buffer_load_dwordx4 v44, s[16:19], s49 offen offset:2048 lds
    v_mfma_f32_16x16x32_bf16 v[160:163], a[160:163], a[48:51], v[160:163]
    s_waitcnt lgkmcnt(7)
    ds_read_b64_tr_b16 a[182:183], v34 offset:12288
    ds_read_b64_tr_b16 a[184:185], v35 offset:0
    v_mfma_f32_16x16x32_bf16 v[160:163], a[164:167], a[56:59], v[160:163]
    ds_read_b64_tr_b16 a[186:187], v35 offset:4096
    v_mfma_f32_16x16x32_bf16 v[164:167], a[160:163], a[52:55], v[164:167]
    ds_read_b64_tr_b16 a[188:189], v35 offset:8192
    v_mfma_f32_16x16x32_bf16 v[164:167], a[164:167], a[60:63], v[164:167]
    s_waitcnt lgkmcnt(9)
    buffer_load_dwordx4 v45, s[16:19], s49 offen offset:3072 lds
    v_mfma_f32_16x16x32_bf16 v[168:171], a[168:171], a[48:51], v[168:171]
    s_waitcnt lgkmcnt(7)
    ds_read_b64_tr_b16 a[190:191], v35 offset:12288
    ds_read_b64_tr_b16 a[160:161], v28 offset:16384
    v_mfma_f32_16x16x32_bf16 v[168:171], a[172:175], a[56:59], v[168:171]
    s_add_u32 s49, s44, 3145984
    ds_read_b64_tr_b16 a[162:163], v28 offset:20480
    v_mfma_f32_16x16x32_bf16 v[172:175], a[168:171], a[52:55], v[172:175]
    s_add_u32 m0, s42, 81920
    ds_read_b64_tr_b16 a[164:165], v28 offset:24576
    v_mfma_f32_16x16x32_bf16 v[172:175], a[172:175], a[60:63], v[172:175]
    s_waitcnt lgkmcnt(9)
    buffer_load_dwordx4 v42, s[16:19], s49 offen lds
    v_mfma_f32_16x16x32_bf16 v[176:179], a[176:179], a[48:51], v[176:179]
    s_waitcnt lgkmcnt(7)
    ds_read_b64_tr_b16 a[166:167], v28 offset:28672
    ds_read_b64_tr_b16 a[168:169], v29 offset:16384
    v_mfma_f32_16x16x32_bf16 v[176:179], a[180:183], a[56:59], v[176:179]
    ds_read_b64_tr_b16 a[170:171], v29 offset:20480
    v_mfma_f32_16x16x32_bf16 v[180:183], a[176:179], a[52:55], v[180:183]
    ds_read_b64_tr_b16 a[172:173], v29 offset:24576
    v_mfma_f32_16x16x32_bf16 v[180:183], a[180:183], a[60:63], v[180:183]
    s_waitcnt lgkmcnt(9)
    buffer_load_dwordx4 v43, s[16:19], s49 offen offset:1024 lds
    v_mfma_f32_16x16x32_bf16 v[184:187], a[184:187], a[48:51], v[184:187]
    s_waitcnt lgkmcnt(7)
    ds_read_b64_tr_b16 a[174:175], v29 offset:28672
    ds_read_b64_tr_b16 a[176:177], v30 offset:16384
    v_mfma_f32_16x16x32_bf16 v[184:187], a[188:191], a[56:59], v[184:187]
    ds_read_b64_tr_b16 a[178:179], v30 offset:20480
    v_mfma_f32_16x16x32_bf16 v[188:191], a[184:187], a[52:55], v[188:191]
    ds_read_b64_tr_b16 a[180:181], v30 offset:24576
    v_mfma_f32_16x16x32_bf16 v[188:191], a[188:191], a[60:63], v[188:191]
    s_waitcnt lgkmcnt(9)
    buffer_load_dwordx4 v44, s[16:19], s49 offen offset:2048 lds
    v_mfma_f32_16x16x32_bf16 v[192:195], a[160:163], a[48:51], v[192:195]
    s_waitcnt lgkmcnt(7)
    ds_read_b64_tr_b16 a[182:183], v30 offset:28672
    ds_read_b64_tr_b16 a[184:185], v31 offset:16384
    v_mfma_f32_16x16x32_bf16 v[192:195], a[164:167], a[56:59], v[192:195]
    ds_read_b64_tr_b16 a[186:187], v31 offset:20480
    v_mfma_f32_16x16x32_bf16 v[196:199], a[160:163], a[52:55], v[196:199]
    ds_read_b64_tr_b16 a[188:189], v31 offset:24576
    v_mfma_f32_16x16x32_bf16 v[196:199], a[164:167], a[60:63], v[196:199]
    s_waitcnt lgkmcnt(9)
    buffer_load_dwordx4 v45, s[16:19], s49 offen offset:3072 lds
    v_mfma_f32_16x16x32_bf16 v[200:203], a[168:171], a[48:51], v[200:203]
    s_waitcnt lgkmcnt(7)
    ds_read_b64_tr_b16 a[190:191], v31 offset:28672
    ds_read_b64_tr_b16 a[160:161], v32 offset:16384
    v_mfma_f32_16x16x32_bf16 v[200:203], a[172:175], a[56:59], v[200:203]
    ds_read_b64_tr_b16 a[162:163], v32 offset:20480
    v_mfma_f32_16x16x32_bf16 v[204:207], a[168:171], a[52:55], v[204:207]
    ds_read_b64_tr_b16 a[164:165], v32 offset:24576
    v_mfma_f32_16x16x32_bf16 v[204:207], a[172:175], a[60:63], v[204:207]
    s_waitcnt lgkmcnt(9)
    ds_read_b64_tr_b16 a[166:167], v32 offset:28672
    v_mfma_f32_16x16x32_bf16 v[208:211], a[176:179], a[48:51], v[208:211]
    s_waitcnt lgkmcnt(8)
    ds_read_b64_tr_b16 a[168:169], v33 offset:16384
    v_mfma_f32_16x16x32_bf16 v[208:211], a[180:183], a[56:59], v[208:211]
    ds_read_b64_tr_b16 a[170:171], v33 offset:20480
    v_mfma_f32_16x16x32_bf16 v[212:215], a[176:179], a[52:55], v[212:215]
    ds_read_b64_tr_b16 a[172:173], v33 offset:24576
    v_mfma_f32_16x16x32_bf16 v[212:215], a[180:183], a[60:63], v[212:215]
    s_waitcnt lgkmcnt(9)
    ds_read_b64_tr_b16 a[174:175], v33 offset:28672
    v_mfma_f32_16x16x32_bf16 v[216:219], a[184:187], a[48:51], v[216:219]
    s_waitcnt lgkmcnt(8)
    ds_read_b64_tr_b16 a[176:177], v34 offset:16384
    v_mfma_f32_16x16x32_bf16 v[216:219], a[188:191], a[56:59], v[216:219]
    ds_read_b64_tr_b16 a[178:179], v34 offset:20480
    v_mfma_f32_16x16x32_bf16 v[220:223], a[184:187], a[52:55], v[220:223]
    ds_read_b64_tr_b16 a[180:181], v34 offset:24576
    v_mfma_f32_16x16x32_bf16 v[220:223], a[188:191], a[60:63], v[220:223]
    s_waitcnt lgkmcnt(9)
    ds_read_b64_tr_b16 a[182:183], v34 offset:28672
    v_mfma_f32_16x16x32_bf16 v[224:227], a[160:163], a[48:51], v[224:227]
    s_waitcnt lgkmcnt(8)
    ds_read_b64_tr_b16 a[184:185], v35 offset:16384
    v_mfma_f32_16x16x32_bf16 v[224:227], a[164:167], a[56:59], v[224:227]
    ds_read_b64_tr_b16 a[186:187], v35 offset:20480
    v_mfma_f32_16x16x32_bf16 v[228:231], a[160:163], a[52:55], v[228:231]
    ds_read_b64_tr_b16 a[188:189], v35 offset:24576
    v_mfma_f32_16x16x32_bf16 v[228:231], a[164:167], a[60:63], v[228:231]
    s_waitcnt lgkmcnt(9)
    ds_read_b64_tr_b16 a[190:191], v35 offset:28672
    s_waitcnt vmcnt(36)
    s_barrier
    v_mfma_f32_16x16x32_bf16 v[232:235], a[168:171], a[48:51], v[232:235]
    s_waitcnt lgkmcnt(8)
    ds_read_b64_tr_b16 a[160:161], v12 offset:0
    v_mfma_f32_16x16x32_bf16 v[232:235], a[172:175], a[56:59], v[232:235]
    s_add_u32 s49, s44, 3670016
    ds_read_b64_tr_b16 a[162:163], v12 offset:4096
    v_mfma_f32_16x16x32_bf16 v[236:239], a[168:171], a[52:55], v[236:239]
    s_add_u32 m0, s42, 98304
    ds_read_b64_tr_b16 a[164:165], v12 offset:8192
    v_mfma_f32_16x16x32_bf16 v[236:239], a[172:175], a[60:63], v[236:239]
    s_waitcnt lgkmcnt(9)
    buffer_load_dwordx4 v42, s[16:19], s49 offen lds
    v_mfma_f32_16x16x32_bf16 v[240:243], a[176:179], a[48:51], v[240:243]
    s_waitcnt lgkmcnt(7)
    ds_read_b64_tr_b16 a[166:167], v12 offset:12288
    ds_read_b64_tr_b16 a[168:169], v13 offset:0
    v_mfma_f32_16x16x32_bf16 v[240:243], a[180:183], a[56:59], v[240:243]
    ds_read_b64_tr_b16 a[170:171], v13 offset:4096
    v_mfma_f32_16x16x32_bf16 v[244:247], a[176:179], a[52:55], v[244:247]
    ds_read_b64_tr_b16 a[172:173], v13 offset:8192
    v_mfma_f32_16x16x32_bf16 v[244:247], a[180:183], a[60:63], v[244:247]
    s_waitcnt lgkmcnt(9)
    buffer_load_dwordx4 v43, s[16:19], s49 offen offset:1024 lds
    v_mfma_f32_16x16x32_bf16 v[248:251], a[184:187], a[48:51], v[248:251]
    s_waitcnt lgkmcnt(7)
    ds_read_b64_tr_b16 a[174:175], v13 offset:12288
    ds_read_b64_tr_b16 a[176:177], v14 offset:0
    v_mfma_f32_16x16x32_bf16 v[248:251], a[188:191], a[56:59], v[248:251]
    ds_read_b64_tr_b16 a[178:179], v14 offset:4096
    v_mfma_f32_16x16x32_bf16 v[252:255], a[184:187], a[52:55], v[252:255]
    ds_read_b64_tr_b16 a[180:181], v14 offset:8192
    v_mfma_f32_16x16x32_bf16 v[252:255], a[188:191], a[60:63], v[252:255]
    s_waitcnt vmcnt(37)
    s_waitcnt lgkmcnt(9)
    buffer_load_dwordx4 v44, s[16:19], s49 offen offset:2048 lds
    v_mfma_f32_16x16x32_bf16 v[128:131], a[160:163], a[64:67], v[128:131]
    s_waitcnt vmcnt(37)
    s_waitcnt lgkmcnt(7)
    ds_read_b64_tr_b16 a[182:183], v14 offset:12288
    ds_read_b64_tr_b16 a[184:185], v15 offset:0
    v_mfma_f32_16x16x32_bf16 v[128:131], a[164:167], a[72:75], v[128:131]
    s_waitcnt vmcnt(36)
    ds_read_b64_tr_b16 a[186:187], v15 offset:4096
    v_mfma_f32_16x16x32_bf16 v[132:135], a[160:163], a[68:71], v[132:135]
    s_waitcnt vmcnt(35)
    ds_read_b64_tr_b16 a[188:189], v15 offset:8192
    v_mfma_f32_16x16x32_bf16 v[132:135], a[164:167], a[76:79], v[132:135]
    s_waitcnt lgkmcnt(9)
    buffer_load_dwordx4 v45, s[16:19], s49 offen offset:3072 lds
    v_mfma_f32_16x16x32_bf16 v[136:139], a[168:171], a[64:67], v[136:139]
    s_waitcnt lgkmcnt(7)
    ds_read_b64_tr_b16 a[190:191], v15 offset:12288
    ds_read_b64_tr_b16 a[160:161], v16 offset:0
    v_mfma_f32_16x16x32_bf16 v[136:139], a[172:175], a[72:75], v[136:139]
    s_add_u32 s49, s44, 3670272
    ds_read_b64_tr_b16 a[162:163], v16 offset:4096
    v_mfma_f32_16x16x32_bf16 v[140:143], a[168:171], a[68:71], v[140:143]
    s_add_u32 m0, s42, 114688
    ds_read_b64_tr_b16 a[164:165], v16 offset:8192
    v_mfma_f32_16x16x32_bf16 v[140:143], a[172:175], a[76:79], v[140:143]
    s_waitcnt lgkmcnt(9)
    buffer_load_dwordx4 v42, s[16:19], s49 offen lds
    v_mfma_f32_16x16x32_bf16 v[144:147], a[176:179], a[64:67], v[144:147]
    s_waitcnt lgkmcnt(7)
    ds_read_b64_tr_b16 a[166:167], v16 offset:12288
    ds_read_b64_tr_b16 a[168:169], v17 offset:0
    v_mfma_f32_16x16x32_bf16 v[144:147], a[180:183], a[72:75], v[144:147]
    ds_read_b64_tr_b16 a[170:171], v17 offset:4096
    v_mfma_f32_16x16x32_bf16 v[148:151], a[176:179], a[68:71], v[148:151]
    ds_read_b64_tr_b16 a[172:173], v17 offset:8192
    v_mfma_f32_16x16x32_bf16 v[148:151], a[180:183], a[76:79], v[148:151]
    s_waitcnt lgkmcnt(9)
    buffer_load_dwordx4 v43, s[16:19], s49 offen offset:1024 lds
    v_mfma_f32_16x16x32_bf16 v[152:155], a[184:187], a[64:67], v[152:155]
    s_waitcnt lgkmcnt(7)
    ds_read_b64_tr_b16 a[174:175], v17 offset:12288
    ds_read_b64_tr_b16 a[176:177], v18 offset:0
    v_mfma_f32_16x16x32_bf16 v[152:155], a[188:191], a[72:75], v[152:155]
    ds_read_b64_tr_b16 a[178:179], v18 offset:4096
    v_mfma_f32_16x16x32_bf16 v[156:159], a[184:187], a[68:71], v[156:159]
    ds_read_b64_tr_b16 a[180:181], v18 offset:8192
    v_mfma_f32_16x16x32_bf16 v[156:159], a[188:191], a[76:79], v[156:159]
    s_waitcnt lgkmcnt(9)
    buffer_load_dwordx4 v44, s[16:19], s49 offen offset:2048 lds
    v_mfma_f32_16x16x32_bf16 v[160:163], a[160:163], a[64:67], v[160:163]
    s_waitcnt lgkmcnt(7)
    ds_read_b64_tr_b16 a[182:183], v18 offset:12288
    ds_read_b64_tr_b16 a[184:185], v19 offset:0
    v_mfma_f32_16x16x32_bf16 v[160:163], a[164:167], a[72:75], v[160:163]
    ds_read_b64_tr_b16 a[186:187], v19 offset:4096
    v_mfma_f32_16x16x32_bf16 v[164:167], a[160:163], a[68:71], v[164:167]
    ds_read_b64_tr_b16 a[188:189], v19 offset:8192
    v_mfma_f32_16x16x32_bf16 v[164:167], a[164:167], a[76:79], v[164:167]
    s_waitcnt lgkmcnt(9)
    buffer_load_dwordx4 v45, s[16:19], s49 offen offset:3072 lds
    v_mfma_f32_16x16x32_bf16 v[168:171], a[168:171], a[64:67], v[168:171]
    s_waitcnt lgkmcnt(7)
    ds_read_b64_tr_b16 a[190:191], v19 offset:12288
    ds_read_b64_tr_b16 a[160:161], v12 offset:16384
    v_mfma_f32_16x16x32_bf16 v[168:171], a[172:175], a[72:75], v[168:171]
    ds_read_b64_tr_b16 a[162:163], v12 offset:20480
    v_mfma_f32_16x16x32_bf16 v[172:175], a[168:171], a[68:71], v[172:175]
    ds_read_b64_tr_b16 a[164:165], v12 offset:24576
    v_mfma_f32_16x16x32_bf16 v[172:175], a[172:175], a[76:79], v[172:175]
    s_waitcnt lgkmcnt(9)
    buffer_atomic_add v65, v64, s[88:91], 0 offen sc1
    v_mfma_f32_16x16x32_bf16 v[176:179], a[176:179], a[64:67], v[176:179]
    s_waitcnt lgkmcnt(7)
    ds_read_b64_tr_b16 a[166:167], v12 offset:28672
    ds_read_b64_tr_b16 a[168:169], v13 offset:16384
    v_mfma_f32_16x16x32_bf16 v[176:179], a[180:183], a[72:75], v[176:179]
    ds_read_b64_tr_b16 a[170:171], v13 offset:20480
    v_mfma_f32_16x16x32_bf16 v[180:183], a[176:179], a[68:71], v[180:183]
    ds_read_b64_tr_b16 a[172:173], v13 offset:24576
    v_mfma_f32_16x16x32_bf16 v[180:183], a[180:183], a[76:79], v[180:183]
    s_waitcnt lgkmcnt(9)
    ds_read_b64_tr_b16 a[174:175], v13 offset:28672
    v_mfma_f32_16x16x32_bf16 v[184:187], a[184:187], a[64:67], v[184:187]
    s_waitcnt lgkmcnt(8)
    ds_read_b64_tr_b16 a[176:177], v14 offset:16384
    v_mfma_f32_16x16x32_bf16 v[184:187], a[188:191], a[72:75], v[184:187]
    ds_read_b64_tr_b16 a[178:179], v14 offset:20480
    v_mfma_f32_16x16x32_bf16 v[188:191], a[184:187], a[68:71], v[188:191]
    ds_read_b64_tr_b16 a[180:181], v14 offset:24576
    v_mfma_f32_16x16x32_bf16 v[188:191], a[188:191], a[76:79], v[188:191]
    s_waitcnt lgkmcnt(9)
    ds_read_b64_tr_b16 a[182:183], v14 offset:28672
    v_mfma_f32_16x16x32_bf16 v[192:195], a[160:163], a[64:67], v[192:195]
    s_waitcnt lgkmcnt(8)
    ds_read_b64_tr_b16 a[184:185], v15 offset:16384
    v_mfma_f32_16x16x32_bf16 v[192:195], a[164:167], a[72:75], v[192:195]
    ds_read_b64_tr_b16 a[186:187], v15 offset:20480
    v_mfma_f32_16x16x32_bf16 v[196:199], a[160:163], a[68:71], v[196:199]
    ds_read_b64_tr_b16 a[188:189], v15 offset:24576
    v_mfma_f32_16x16x32_bf16 v[196:199], a[164:167], a[76:79], v[196:199]
    s_waitcnt lgkmcnt(9)
    ds_read_b64_tr_b16 a[190:191], v15 offset:28672
    v_mfma_f32_16x16x32_bf16 v[200:203], a[168:171], a[64:67], v[200:203]
    s_waitcnt lgkmcnt(8)
    ds_read_b64_tr_b16 a[160:161], v16 offset:16384
    v_mfma_f32_16x16x32_bf16 v[200:203], a[172:175], a[72:75], v[200:203]
    ds_read_b64_tr_b16 a[162:163], v16 offset:20480
    v_mfma_f32_16x16x32_bf16 v[204:207], a[168:171], a[68:71], v[204:207]
    ds_read_b64_tr_b16 a[164:165], v16 offset:24576
    v_mfma_f32_16x16x32_bf16 v[204:207], a[172:175], a[76:79], v[204:207]
    s_waitcnt lgkmcnt(9)
    ds_read_b64_tr_b16 a[166:167], v16 offset:28672
    v_mfma_f32_16x16x32_bf16 v[208:211], a[176:179], a[64:67], v[208:211]
    s_waitcnt lgkmcnt(8)
    ds_read_b64_tr_b16 a[168:169], v17 offset:16384
    v_mfma_f32_16x16x32_bf16 v[208:211], a[180:183], a[72:75], v[208:211]
    ds_read_b64_tr_b16 a[170:171], v17 offset:20480
    v_mfma_f32_16x16x32_bf16 v[212:215], a[176:179], a[68:71], v[212:215]
    ds_read_b64_tr_b16 a[172:173], v17 offset:24576
    v_mfma_f32_16x16x32_bf16 v[212:215], a[180:183], a[76:79], v[212:215]
    s_waitcnt lgkmcnt(9)
    ds_read_b64_tr_b16 a[174:175], v17 offset:28672
    v_mfma_f32_16x16x32_bf16 v[216:219], a[184:187], a[64:67], v[216:219]
    s_waitcnt lgkmcnt(8)
    ds_read_b64_tr_b16 a[176:177], v18 offset:16384
    v_mfma_f32_16x16x32_bf16 v[216:219], a[188:191], a[72:75], v[216:219]
    ds_read_b64_tr_b16 a[178:179], v18 offset:20480
    v_mfma_f32_16x16x32_bf16 v[220:223], a[184:187], a[68:71], v[220:223]
    ds_read_b64_tr_b16 a[180:181], v18 offset:24576
    v_mfma_f32_16x16x32_bf16 v[220:223], a[188:191], a[76:79], v[220:223]
    s_waitcnt lgkmcnt(9)
    ds_read_b64_tr_b16 a[182:183], v18 offset:28672
    v_mfma_f32_16x16x32_bf16 v[224:227], a[160:163], a[64:67], v[224:227]
    s_waitcnt lgkmcnt(8)
    ds_read_b64_tr_b16 a[184:185], v19 offset:16384
    v_mfma_f32_16x16x32_bf16 v[224:227], a[164:167], a[72:75], v[224:227]
    ds_read_b64_tr_b16 a[186:187], v19 offset:20480
    v_mfma_f32_16x16x32_bf16 v[228:231], a[160:163], a[68:71], v[228:231]
    ds_read_b64_tr_b16 a[188:189], v19 offset:24576
    v_mfma_f32_16x16x32_bf16 v[228:231], a[164:167], a[76:79], v[228:231]
    s_waitcnt lgkmcnt(9)
    ds_read_b64_tr_b16 a[190:191], v19 offset:28672
    s_waitcnt vmcnt(21)
    s_barrier
    v_mfma_f32_16x16x32_bf16 v[232:235], a[168:171], a[64:67], v[232:235]
    s_waitcnt lgkmcnt(8)
    ds_read_b64_tr_b16 a[160:161], v12 offset:32768
    v_mfma_f32_16x16x32_bf16 v[232:235], a[172:175], a[72:75], v[232:235]
    s_add_u32 s49, s44, 4194304
    ds_read_b64_tr_b16 a[162:163], v12 offset:36864
    v_mfma_f32_16x16x32_bf16 v[236:239], a[168:171], a[68:71], v[236:239]
    s_add_u32 m0, s42, 131072
    ds_read_b64_tr_b16 a[164:165], v12 offset:40960
    v_mfma_f32_16x16x32_bf16 v[236:239], a[172:175], a[76:79], v[236:239]
    s_waitcnt lgkmcnt(9)
    buffer_load_dwordx4 v42, s[16:19], s49 offen lds
    v_mfma_f32_16x16x32_bf16 v[240:243], a[176:179], a[64:67], v[240:243]
    s_waitcnt lgkmcnt(7)
    ds_read_b64_tr_b16 a[166:167], v12 offset:45056
    ds_read_b64_tr_b16 a[168:169], v13 offset:32768
    v_mfma_f32_16x16x32_bf16 v[240:243], a[180:183], a[72:75], v[240:243]
    ds_read_b64_tr_b16 a[170:171], v13 offset:36864
    v_mfma_f32_16x16x32_bf16 v[244:247], a[176:179], a[68:71], v[244:247]
    ds_read_b64_tr_b16 a[172:173], v13 offset:40960
    v_mfma_f32_16x16x32_bf16 v[244:247], a[180:183], a[76:79], v[244:247]
    s_waitcnt lgkmcnt(9)
    buffer_load_dwordx4 v43, s[16:19], s49 offen offset:1024 lds
    v_mfma_f32_16x16x32_bf16 v[248:251], a[184:187], a[64:67], v[248:251]
    s_waitcnt lgkmcnt(7)
    ds_read_b64_tr_b16 a[174:175], v13 offset:45056
    ds_read_b64_tr_b16 a[176:177], v14 offset:32768
    v_mfma_f32_16x16x32_bf16 v[248:251], a[188:191], a[72:75], v[248:251]
    ds_read_b64_tr_b16 a[178:179], v14 offset:36864
    v_mfma_f32_16x16x32_bf16 v[252:255], a[184:187], a[68:71], v[252:255]
    ds_read_b64_tr_b16 a[180:181], v14 offset:40960
    v_mfma_f32_16x16x32_bf16 v[252:255], a[188:191], a[76:79], v[252:255]
    s_waitcnt lgkmcnt(9)
    buffer_load_dwordx4 v44, s[16:19], s49 offen offset:2048 lds
    v_mfma_f32_16x16x32_bf16 v[128:131], a[160:163], a[80:83], v[128:131]
    s_waitcnt lgkmcnt(7)
    ds_read_b64_tr_b16 a[182:183], v14 offset:45056
    ds_read_b64_tr_b16 a[184:185], v15 offset:32768
    v_mfma_f32_16x16x32_bf16 v[128:131], a[164:167], a[88:91], v[128:131]
    ds_read_b64_tr_b16 a[186:187], v15 offset:36864
    v_mfma_f32_16x16x32_bf16 v[132:135], a[160:163], a[84:87], v[132:135]
    ds_read_b64_tr_b16 a[188:189], v15 offset:40960
    v_mfma_f32_16x16x32_bf16 v[132:135], a[164:167], a[92:95], v[132:135]
    s_waitcnt lgkmcnt(9)
    buffer_load_dwordx4 v45, s[16:19], s49 offen offset:3072 lds
    v_mfma_f32_16x16x32_bf16 v[136:139], a[168:171], a[80:83], v[136:139]
    s_waitcnt lgkmcnt(7)
    ds_read_b64_tr_b16 a[190:191], v15 offset:45056
    ds_read_b64_tr_b16 a[160:161], v16 offset:32768
    v_mfma_f32_16x16x32_bf16 v[136:139], a[172:175], a[88:91], v[136:139]
    s_add_u32 s49, s44, 4194560
    ds_read_b64_tr_b16 a[162:163], v16 offset:36864
    v_mfma_f32_16x16x32_bf16 v[140:143], a[168:171], a[84:87], v[140:143]
    s_add_u32 m0, s42, 147456
    ds_read_b64_tr_b16 a[164:165], v16 offset:40960
    v_mfma_f32_16x16x32_bf16 v[140:143], a[172:175], a[92:95], v[140:143]
    s_waitcnt lgkmcnt(9)
    buffer_load_dwordx4 v42, s[16:19], s49 offen lds
    v_mfma_f32_16x16x32_bf16 v[144:147], a[176:179], a[80:83], v[144:147]
    s_waitcnt lgkmcnt(7)
    ds_read_b64_tr_b16 a[166:167], v16 offset:45056
    ds_read_b64_tr_b16 a[168:169], v17 offset:32768
    v_mfma_f32_16x16x32_bf16 v[144:147], a[180:183], a[88:91], v[144:147]
    ds_read_b64_tr_b16 a[170:171], v17 offset:36864
    v_mfma_f32_16x16x32_bf16 v[148:151], a[176:179], a[84:87], v[148:151]
    ds_read_b64_tr_b16 a[172:173], v17 offset:40960
    v_mfma_f32_16x16x32_bf16 v[148:151], a[180:183], a[92:95], v[148:151]
    s_waitcnt lgkmcnt(9)
    buffer_load_dwordx4 v43, s[16:19], s49 offen offset:1024 lds
    v_mfma_f32_16x16x32_bf16 v[152:155], a[184:187], a[80:83], v[152:155]
    s_waitcnt lgkmcnt(7)
    ds_read_b64_tr_b16 a[174:175], v17 offset:45056
    ds_read_b64_tr_b16 a[176:177], v18 offset:32768
    v_mfma_f32_16x16x32_bf16 v[152:155], a[188:191], a[88:91], v[152:155]
    ds_read_b64_tr_b16 a[178:179], v18 offset:36864
    v_mfma_f32_16x16x32_bf16 v[156:159], a[184:187], a[84:87], v[156:159]
    ds_read_b64_tr_b16 a[180:181], v18 offset:40960
    v_mfma_f32_16x16x32_bf16 v[156:159], a[188:191], a[92:95], v[156:159]
    s_waitcnt lgkmcnt(9)
    buffer_load_dwordx4 v44, s[16:19], s49 offen offset:2048 lds
    v_mfma_f32_16x16x32_bf16 v[160:163], a[160:163], a[80:83], v[160:163]
    s_waitcnt lgkmcnt(7)
    ds_read_b64_tr_b16 a[182:183], v18 offset:45056
    ds_read_b64_tr_b16 a[184:185], v19 offset:32768
    v_mfma_f32_16x16x32_bf16 v[160:163], a[164:167], a[88:91], v[160:163]
    ds_read_b64_tr_b16 a[186:187], v19 offset:36864
    v_mfma_f32_16x16x32_bf16 v[164:167], a[160:163], a[84:87], v[164:167]
    ds_read_b64_tr_b16 a[188:189], v19 offset:40960
    v_mfma_f32_16x16x32_bf16 v[164:167], a[164:167], a[92:95], v[164:167]
    s_waitcnt lgkmcnt(9)
    buffer_load_dwordx4 v45, s[16:19], s49 offen offset:3072 lds
    v_mfma_f32_16x16x32_bf16 v[168:171], a[168:171], a[80:83], v[168:171]
    s_waitcnt lgkmcnt(7)
    ds_read_b64_tr_b16 a[190:191], v19 offset:45056
    ds_read_b64_tr_b16 a[160:161], v12 offset:49152
    v_mfma_f32_16x16x32_bf16 v[168:171], a[172:175], a[88:91], v[168:171]
    ds_read_b64_tr_b16 a[162:163], v12 offset:53248
    v_mfma_f32_16x16x32_bf16 v[172:175], a[168:171], a[84:87], v[172:175]
    ds_read_b64_tr_b16 a[164:165], v12 offset:57344
    v_mfma_f32_16x16x32_bf16 v[172:175], a[172:175], a[92:95], v[172:175]
    s_waitcnt lgkmcnt(9)
    ds_read_b64_tr_b16 a[166:167], v12 offset:61440
    v_mfma_f32_16x16x32_bf16 v[176:179], a[176:179], a[80:83], v[176:179]
    s_waitcnt lgkmcnt(8)
    ds_read_b64_tr_b16 a[168:169], v13 offset:49152
    v_mfma_f32_16x16x32_bf16 v[176:179], a[180:183], a[88:91], v[176:179]
    ds_read_b64_tr_b16 a[170:171], v13 offset:53248
    v_mfma_f32_16x16x32_bf16 v[180:183], a[176:179], a[84:87], v[180:183]
    ds_read_b64_tr_b16 a[172:173], v13 offset:57344
    v_mfma_f32_16x16x32_bf16 v[180:183], a[180:183], a[92:95], v[180:183]
    s_waitcnt lgkmcnt(9)
    ds_read_b64_tr_b16 a[174:175], v13 offset:61440
    v_mfma_f32_16x16x32_bf16 v[184:187], a[184:187], a[80:83], v[184:187]
    s_waitcnt lgkmcnt(8)
    ds_read_b64_tr_b16 a[176:177], v14 offset:49152
    v_mfma_f32_16x16x32_bf16 v[184:187], a[188:191], a[88:91], v[184:187]
    ds_read_b64_tr_b16 a[178:179], v14 offset:53248
    v_mfma_f32_16x16x32_bf16 v[188:191], a[184:187], a[84:87], v[188:191]
    ds_read_b64_tr_b16 a[180:181], v14 offset:57344
    v_mfma_f32_16x16x32_bf16 v[188:191], a[188:191], a[92:95], v[188:191]
    s_waitcnt lgkmcnt(9)
    ds_read_b64_tr_b16 a[182:183], v14 offset:61440
    v_mfma_f32_16x16x32_bf16 v[192:195], a[160:163], a[80:83], v[192:195]
    s_waitcnt lgkmcnt(8)
    ds_read_b64_tr_b16 a[184:185], v15 offset:49152
    v_mfma_f32_16x16x32_bf16 v[192:195], a[164:167], a[88:91], v[192:195]
    ds_read_b64_tr_b16 a[186:187], v15 offset:53248
    v_mfma_f32_16x16x32_bf16 v[196:199], a[160:163], a[84:87], v[196:199]
    ds_read_b64_tr_b16 a[188:189], v15 offset:57344
    v_mfma_f32_16x16x32_bf16 v[196:199], a[164:167], a[92:95], v[196:199]
    s_waitcnt lgkmcnt(9)
    ds_read_b64_tr_b16 a[190:191], v15 offset:61440
    v_mfma_f32_16x16x32_bf16 v[200:203], a[168:171], a[80:83], v[200:203]
    s_waitcnt lgkmcnt(8)
    ds_read_b64_tr_b16 a[160:161], v16 offset:49152
    v_mfma_f32_16x16x32_bf16 v[200:203], a[172:175], a[88:91], v[200:203]
    ds_read_b64_tr_b16 a[162:163], v16 offset:53248
    v_mfma_f32_16x16x32_bf16 v[204:207], a[168:171], a[84:87], v[204:207]
    ds_read_b64_tr_b16 a[164:165], v16 offset:57344
    v_mfma_f32_16x16x32_bf16 v[204:207], a[172:175], a[92:95], v[204:207]
    s_waitcnt lgkmcnt(9)
    ds_read_b64_tr_b16 a[166:167], v16 offset:61440
    v_mfma_f32_16x16x32_bf16 v[208:211], a[176:179], a[80:83], v[208:211]
    s_waitcnt lgkmcnt(8)
    ds_read_b64_tr_b16 a[168:169], v17 offset:49152
    v_mfma_f32_16x16x32_bf16 v[208:211], a[180:183], a[88:91], v[208:211]
    ds_read_b64_tr_b16 a[170:171], v17 offset:53248
    v_mfma_f32_16x16x32_bf16 v[212:215], a[176:179], a[84:87], v[212:215]
    ds_read_b64_tr_b16 a[172:173], v17 offset:57344
    v_mfma_f32_16x16x32_bf16 v[212:215], a[180:183], a[92:95], v[212:215]
    s_waitcnt lgkmcnt(9)
    ds_read_b64_tr_b16 a[174:175], v17 offset:61440
    v_mfma_f32_16x16x32_bf16 v[216:219], a[184:187], a[80:83], v[216:219]
    s_waitcnt lgkmcnt(8)
    ds_read_b64_tr_b16 a[176:177], v18 offset:49152
    v_mfma_f32_16x16x32_bf16 v[216:219], a[188:191], a[88:91], v[216:219]
    ds_read_b64_tr_b16 a[178:179], v18 offset:53248
    v_mfma_f32_16x16x32_bf16 v[220:223], a[184:187], a[84:87], v[220:223]
    ds_read_b64_tr_b16 a[180:181], v18 offset:57344
    v_mfma_f32_16x16x32_bf16 v[220:223], a[188:191], a[92:95], v[220:223]
    s_waitcnt lgkmcnt(9)
    ds_read_b64_tr_b16 a[182:183], v18 offset:61440
    v_mfma_f32_16x16x32_bf16 v[224:227], a[160:163], a[80:83], v[224:227]
    s_waitcnt lgkmcnt(8)
    ds_read_b64_tr_b16 a[184:185], v19 offset:49152
    v_mfma_f32_16x16x32_bf16 v[224:227], a[164:167], a[88:91], v[224:227]
    ds_read_b64_tr_b16 a[186:187], v19 offset:53248
    v_mfma_f32_16x16x32_bf16 v[228:231], a[160:163], a[84:87], v[228:231]
    ds_read_b64_tr_b16 a[188:189], v19 offset:57344
    v_mfma_f32_16x16x32_bf16 v[228:231], a[164:167], a[92:95], v[228:231]
    s_waitcnt lgkmcnt(9)
    ds_read_b64_tr_b16 a[190:191], v19 offset:61440
    s_waitcnt vmcnt(17)
    s_barrier
    v_mfma_f32_16x16x32_bf16 v[232:235], a[168:171], a[80:83], v[232:235]
    s_waitcnt lgkmcnt(8)
    ds_read_b64_tr_b16 a[160:161], v20 offset:0
    v_mfma_f32_16x16x32_bf16 v[232:235], a[172:175], a[88:91], v[232:235]
    ds_read_b64_tr_b16 a[162:163], v20 offset:4096
    v_mfma_f32_16x16x32_bf16 v[236:239], a[168:171], a[84:87], v[236:239]
    s_add_u32 m0, s42, 0
    ds_read_b64_tr_b16 a[164:165], v20 offset:8192
    v_mfma_f32_16x16x32_bf16 v[236:239], a[172:175], a[92:95], v[236:239]
    s_waitcnt lgkmcnt(9)
    buffer_load_dwordx4 v36, s[8:11], s40 offen lds
    v_mfma_f32_16x16x32_bf16 v[240:243], a[176:179], a[80:83], v[240:243]
    s_waitcnt lgkmcnt(7)
    ds_read_b64_tr_b16 a[166:167], v20 offset:12288
    ds_read_b64_tr_b16 a[168:169], v21 offset:0
    v_mfma_f32_16x16x32_bf16 v[240:243], a[180:183], a[88:91], v[240:243]
    ds_read_b64_tr_b16 a[170:171], v21 offset:4096
    v_mfma_f32_16x16x32_bf16 v[244:247], a[176:179], a[84:87], v[244:247]
    ds_read_b64_tr_b16 a[172:173], v21 offset:8192
    v_mfma_f32_16x16x32_bf16 v[244:247], a[180:183], a[92:95], v[244:247]
    s_waitcnt lgkmcnt(9)
    buffer_load_dwordx4 v37, s[8:11], s40 offen offset:1024 lds
    v_mfma_f32_16x16x32_bf16 v[248:251], a[184:187], a[80:83], v[248:251]
    s_waitcnt lgkmcnt(7)
    ds_read_b64_tr_b16 a[174:175], v21 offset:12288
    ds_read_b64_tr_b16 a[176:177], v22 offset:0
    v_mfma_f32_16x16x32_bf16 v[248:251], a[188:191], a[88:91], v[248:251]
    ds_read_b64_tr_b16 a[178:179], v22 offset:4096
    v_mfma_f32_16x16x32_bf16 v[252:255], a[184:187], a[84:87], v[252:255]
    ds_read_b64_tr_b16 a[180:181], v22 offset:8192
    v_mfma_f32_16x16x32_bf16 v[252:255], a[188:191], a[92:95], v[252:255]
    s_waitcnt lgkmcnt(9)
    buffer_load_dwordx4 v38, s[8:11], s40 offen offset:2048 lds
    v_mfma_f32_16x16x32_bf16 v[128:131], a[160:163], a[96:99], v[128:131]
    s_waitcnt lgkmcnt(7)
    ds_read_b64_tr_b16 a[182:183], v22 offset:12288
    ds_read_b64_tr_b16 a[184:185], v23 offset:0
    v_mfma_f32_16x16x32_bf16 v[128:131], a[164:167], a[104:107], v[128:131]
    ds_read_b64_tr_b16 a[186:187], v23 offset:4096
    v_mfma_f32_16x16x32_bf16 v[132:135], a[160:163], a[100:103], v[132:135]
    ds_read_b64_tr_b16 a[188:189], v23 offset:8192
    v_mfma_f32_16x16x32_bf16 v[132:135], a[164:167], a[108:111], v[132:135]
    s_waitcnt lgkmcnt(9)
    buffer_load_dwordx4 v39, s[8:11], s40 offen offset:3072 lds
    v_mfma_f32_16x16x32_bf16 v[136:139], a[168:171], a[96:99], v[136:139]
    s_waitcnt lgkmcnt(7)
    s_add_u32 s40, s40, 16384
    ds_read_b64_tr_b16 a[190:191], v23 offset:12288
    ds_read_b64_tr_b16 a[160:161], v24 offset:0
    v_mfma_f32_16x16x32_bf16 v[136:139], a[172:175], a[104:107], v[136:139]
    ds_read_b64_tr_b16 a[162:163], v24 offset:4096
    v_mfma_f32_16x16x32_bf16 v[140:143], a[168:171], a[100:103], v[140:143]
    s_add_u32 m0, s42, 16384
    ds_read_b64_tr_b16 a[164:165], v24 offset:8192
    v_mfma_f32_16x16x32_bf16 v[140:143], a[172:175], a[108:111], v[140:143]
    s_waitcnt lgkmcnt(9)
    buffer_load_dwordx4 v36, s[8:11], s40 offen lds
    v_mfma_f32_16x16x32_bf16 v[144:147], a[176:179], a[96:99], v[144:147]
    s_waitcnt lgkmcnt(7)
    ds_read_b64_tr_b16 a[166:167], v24 offset:12288
    ds_read_b64_tr_b16 a[168:169], v25 offset:0
    v_mfma_f32_16x16x32_bf16 v[144:147], a[180:183], a[104:107], v[144:147]
    ds_read_b64_tr_b16 a[170:171], v25 offset:4096
    v_mfma_f32_16x16x32_bf16 v[148:151], a[176:179], a[100:103], v[148:151]
    ds_read_b64_tr_b16 a[172:173], v25 offset:8192
    v_mfma_f32_16x16x32_bf16 v[148:151], a[180:183], a[108:111], v[148:151]
    s_waitcnt lgkmcnt(9)
    buffer_load_dwordx4 v37, s[8:11], s40 offen offset:1024 lds
    v_mfma_f32_16x16x32_bf16 v[152:155], a[184:187], a[96:99], v[152:155]
    s_waitcnt lgkmcnt(7)
    ds_read_b64_tr_b16 a[174:175], v25 offset:12288
    ds_read_b64_tr_b16 a[176:177], v26 offset:0
    v_mfma_f32_16x16x32_bf16 v[152:155], a[188:191], a[104:107], v[152:155]
    ds_read_b64_tr_b16 a[178:179], v26 offset:4096
    v_mfma_f32_16x16x32_bf16 v[156:159], a[184:187], a[100:103], v[156:159]
    ds_read_b64_tr_b16 a[180:181], v26 offset:8192
    v_mfma_f32_16x16x32_bf16 v[156:159], a[188:191], a[108:111], v[156:159]
    s_waitcnt lgkmcnt(9)
    buffer_load_dwordx4 v38, s[8:11], s40 offen offset:2048 lds
    v_mfma_f32_16x16x32_bf16 v[160:163], a[160:163], a[96:99], v[160:163]
    s_waitcnt lgkmcnt(7)
    ds_read_b64_tr_b16 a[182:183], v26 offset:12288
    ds_read_b64_tr_b16 a[184:185], v27 offset:0
    v_mfma_f32_16x16x32_bf16 v[160:163], a[164:167], a[104:107], v[160:163]
    ds_read_b64_tr_b16 a[186:187], v27 offset:4096
    v_accvgpr_write_b32 a0, 0
    v_mfma_f32_16x16x32_bf16 v[164:167], a[160:163], a[100:103], v[164:167]
    ds_read_b64_tr_b16 a[188:189], v27 offset:8192
    v_accvgpr_write_b32 a1, 0
    v_mfma_f32_16x16x32_bf16 v[164:167], a[164:167], a[108:111], v[164:167]
    s_waitcnt lgkmcnt(9)
    buffer_load_dwordx4 v39, s[8:11], s40 offen offset:3072 lds
    v_mfma_f32_16x16x32_bf16 v[168:171], a[168:171], a[96:99], v[168:171]
    s_waitcnt lgkmcnt(7)
    s_add_u32 s40, s40, 16384
    ds_read_b64_tr_b16 a[190:191], v27 offset:12288
    ds_read_b64_tr_b16 a[160:161], v20 offset:16384
    v_mfma_f32_16x16x32_bf16 v[168:171], a[172:175], a[104:107], v[168:171]
    ds_read_b64_tr_b16 a[162:163], v20 offset:20480
    v_accvgpr_write_b32 a2, 0
    v_mfma_f32_16x16x32_bf16 v[172:175], a[168:171], a[100:103], v[172:175]
    ds_read_b64_tr_b16 a[164:165], v20 offset:24576
    v_accvgpr_write_b32 a3, 0
    v_mfma_f32_16x16x32_bf16 v[172:175], a[172:175], a[108:111], v[172:175]
    s_waitcnt lgkmcnt(9)
    ds_read_b64_tr_b16 a[166:167], v20 offset:28672
    v_accvgpr_write_b32 a4, 0
    v_mfma_f32_16x16x32_bf16 v[176:179], a[176:179], a[96:99], v[176:179]
    s_waitcnt lgkmcnt(8)
    ds_read_b64_tr_b16 a[168:169], v21 offset:16384
    v_accvgpr_write_b32 a5, 0
    v_mfma_f32_16x16x32_bf16 v[176:179], a[180:183], a[104:107], v[176:179]
    ds_read_b64_tr_b16 a[170:171], v21 offset:20480
    v_accvgpr_write_b32 a6, 0
    v_mfma_f32_16x16x32_bf16 v[180:183], a[176:179], a[100:103], v[180:183]
    ds_read_b64_tr_b16 a[172:173], v21 offset:24576
    v_accvgpr_write_b32 a7, 0
    v_mfma_f32_16x16x32_bf16 v[180:183], a[180:183], a[108:111], v[180:183]
    s_waitcnt lgkmcnt(9)
    ds_read_b64_tr_b16 a[174:175], v21 offset:28672
    v_accvgpr_write_b32 a8, 0
    v_mfma_f32_16x16x32_bf16 v[184:187], a[184:187], a[96:99], v[184:187]
    s_waitcnt lgkmcnt(8)
    ds_read_b64_tr_b16 a[176:177], v22 offset:16384
    v_accvgpr_write_b32 a9, 0
    v_mfma_f32_16x16x32_bf16 v[184:187], a[188:191], a[104:107], v[184:187]
    ds_read_b64_tr_b16 a[178:179], v22 offset:20480
    v_accvgpr_write_b32 a10, 0
    v_mfma_f32_16x16x32_bf16 v[188:191], a[184:187], a[100:103], v[188:191]
    ds_read_b64_tr_b16 a[180:181], v22 offset:24576
    v_accvgpr_write_b32 a11, 0
    v_mfma_f32_16x16x32_bf16 v[188:191], a[188:191], a[108:111], v[188:191]
    s_waitcnt lgkmcnt(9)
    ds_read_b64_tr_b16 a[182:183], v22 offset:28672
    v_accvgpr_write_b32 a12, 0
    v_mfma_f32_16x16x32_bf16 v[192:195], a[160:163], a[96:99], v[192:195]
    s_waitcnt lgkmcnt(8)
    ds_read_b64_tr_b16 a[184:185], v23 offset:16384
    v_accvgpr_write_b32 a13, 0
    v_mfma_f32_16x16x32_bf16 v[192:195], a[164:167], a[104:107], v[192:195]
    ds_read_b64_tr_b16 a[186:187], v23 offset:20480
    v_accvgpr_write_b32 a14, 0
    v_mfma_f32_16x16x32_bf16 v[196:199], a[160:163], a[100:103], v[196:199]
    ds_read_b64_tr_b16 a[188:189], v23 offset:24576
    v_accvgpr_write_b32 a15, 0
    v_mfma_f32_16x16x32_bf16 v[196:199], a[164:167], a[108:111], v[196:199]
    s_waitcnt lgkmcnt(9)
    ds_read_b64_tr_b16 a[190:191], v23 offset:28672
    v_accvgpr_write_b32 a16, 0
    v_mfma_f32_16x16x32_bf16 v[200:203], a[168:171], a[96:99], v[200:203]
    s_waitcnt lgkmcnt(8)
    ds_read_b64_tr_b16 a[160:161], v24 offset:16384
    v_accvgpr_write_b32 a17, 0
    v_mfma_f32_16x16x32_bf16 v[200:203], a[172:175], a[104:107], v[200:203]
    ds_read_b64_tr_b16 a[162:163], v24 offset:20480
    v_accvgpr_write_b32 a18, 0
    v_mfma_f32_16x16x32_bf16 v[204:207], a[168:171], a[100:103], v[204:207]
    ds_read_b64_tr_b16 a[164:165], v24 offset:24576
    v_accvgpr_write_b32 a19, 0
    v_mfma_f32_16x16x32_bf16 v[204:207], a[172:175], a[108:111], v[204:207]
    s_waitcnt lgkmcnt(9)
    ds_read_b64_tr_b16 a[166:167], v24 offset:28672
    v_accvgpr_write_b32 a20, 0
    v_mfma_f32_16x16x32_bf16 v[208:211], a[176:179], a[96:99], v[208:211]
    s_waitcnt lgkmcnt(8)
    ds_read_b64_tr_b16 a[168:169], v25 offset:16384
    v_accvgpr_write_b32 a21, 0
    v_mfma_f32_16x16x32_bf16 v[208:211], a[180:183], a[104:107], v[208:211]
    ds_read_b64_tr_b16 a[170:171], v25 offset:20480
    v_accvgpr_write_b32 a22, 0
    v_mfma_f32_16x16x32_bf16 v[212:215], a[176:179], a[100:103], v[212:215]
    ds_read_b64_tr_b16 a[172:173], v25 offset:24576
    v_accvgpr_write_b32 a23, 0
    v_mfma_f32_16x16x32_bf16 v[212:215], a[180:183], a[108:111], v[212:215]
    s_waitcnt lgkmcnt(9)
    ds_read_b64_tr_b16 a[174:175], v25 offset:28672
    v_accvgpr_write_b32 a24, 0
    v_mfma_f32_16x16x32_bf16 v[216:219], a[184:187], a[96:99], v[216:219]
    s_waitcnt lgkmcnt(8)
    ds_read_b64_tr_b16 a[176:177], v26 offset:16384
    v_accvgpr_write_b32 a25, 0
    v_mfma_f32_16x16x32_bf16 v[216:219], a[188:191], a[104:107], v[216:219]
    ds_read_b64_tr_b16 a[178:179], v26 offset:20480
    v_accvgpr_write_b32 a26, 0
    v_mfma_f32_16x16x32_bf16 v[220:223], a[184:187], a[100:103], v[220:223]
    ds_read_b64_tr_b16 a[180:181], v26 offset:24576
    v_accvgpr_write_b32 a27, 0
    v_mfma_f32_16x16x32_bf16 v[220:223], a[188:191], a[108:111], v[220:223]
    s_waitcnt lgkmcnt(9)
    ds_read_b64_tr_b16 a[182:183], v26 offset:28672
    v_accvgpr_write_b32 a28, 0
    v_mfma_f32_16x16x32_bf16 v[224:227], a[160:163], a[96:99], v[224:227]
    s_waitcnt lgkmcnt(8)
    ds_read_b64_tr_b16 a[184:185], v27 offset:16384
    v_accvgpr_write_b32 a29, 0
    v_mfma_f32_16x16x32_bf16 v[224:227], a[164:167], a[104:107], v[224:227]
    ds_read_b64_tr_b16 a[186:187], v27 offset:20480
    v_accvgpr_write_b32 a30, 0
    v_mfma_f32_16x16x32_bf16 v[228:231], a[160:163], a[100:103], v[228:231]
    ds_read_b64_tr_b16 a[188:189], v27 offset:24576
    v_accvgpr_write_b32 a31, 0
    v_mfma_f32_16x16x32_bf16 v[228:231], a[164:167], a[108:111], v[228:231]
    s_waitcnt lgkmcnt(9)
    ds_read_b64_tr_b16 a[190:191], v27 offset:28672
    v_accvgpr_write_b32 a32, 0
    s_waitcnt vmcnt(17)
    s_barrier
    v_mfma_f32_16x16x32_bf16 v[232:235], a[168:171], a[96:99], v[232:235]
    s_waitcnt lgkmcnt(8)
    ds_read_b64_tr_b16 a[160:161], v20 offset:32768
    v_accvgpr_write_b32 a33, 0
    v_mfma_f32_16x16x32_bf16 v[232:235], a[172:175], a[104:107], v[232:235]
    ds_read_b64_tr_b16 a[162:163], v20 offset:36864
    v_accvgpr_write_b32 a34, 0
    v_mfma_f32_16x16x32_bf16 v[236:239], a[168:171], a[100:103], v[236:239]
    s_add_u32 m0, s42, 32768
    ds_read_b64_tr_b16 a[164:165], v20 offset:40960
    v_accvgpr_write_b32 a35, 0
    v_mfma_f32_16x16x32_bf16 v[236:239], a[172:175], a[108:111], v[236:239]
    s_waitcnt lgkmcnt(9)
    buffer_load_dwordx4 v36, s[8:11], s40 offen lds
    v_mfma_f32_16x16x32_bf16 v[240:243], a[176:179], a[96:99], v[240:243]
    s_waitcnt lgkmcnt(7)
    ds_read_b64_tr_b16 a[166:167], v20 offset:45056
    ds_read_b64_tr_b16 a[168:169], v21 offset:32768
    v_mfma_f32_16x16x32_bf16 v[240:243], a[180:183], a[104:107], v[240:243]
    ds_read_b64_tr_b16 a[170:171], v21 offset:36864
    v_accvgpr_write_b32 a36, 0
    v_mfma_f32_16x16x32_bf16 v[244:247], a[176:179], a[100:103], v[244:247]
    ds_read_b64_tr_b16 a[172:173], v21 offset:40960
    v_accvgpr_write_b32 a37, 0
    v_mfma_f32_16x16x32_bf16 v[244:247], a[180:183], a[108:111], v[244:247]
    s_waitcnt lgkmcnt(9)
    buffer_load_dwordx4 v37, s[8:11], s40 offen offset:1024 lds
    v_mfma_f32_16x16x32_bf16 v[248:251], a[184:187], a[96:99], v[248:251]
    s_waitcnt lgkmcnt(7)
    ds_read_b64_tr_b16 a[174:175], v21 offset:45056
    ds_read_b64_tr_b16 a[176:177], v22 offset:32768
    v_mfma_f32_16x16x32_bf16 v[248:251], a[188:191], a[104:107], v[248:251]
    ds_read_b64_tr_b16 a[178:179], v22 offset:36864
    v_accvgpr_write_b32 a38, 0
    v_mfma_f32_16x16x32_bf16 v[252:255], a[184:187], a[100:103], v[252:255]
    ds_read_b64_tr_b16 a[180:181], v22 offset:40960
    v_accvgpr_write_b32 a39, 0
    v_mfma_f32_16x16x32_bf16 v[252:255], a[188:191], a[108:111], v[252:255]
    s_waitcnt lgkmcnt(9)
    buffer_load_dwordx4 v38, s[8:11], s40 offen offset:2048 lds
    v_mfma_f32_16x16x32_bf16 v[128:131], a[160:163], a[112:115], v[128:131]
    s_waitcnt lgkmcnt(7)
    ds_read_b64_tr_b16 a[182:183], v22 offset:45056
    ds_read_b64_tr_b16 a[184:185], v23 offset:32768
    v_mfma_f32_16x16x32_bf16 v[128:131], a[164:167], a[120:123], v[128:131]
    ds_read_b64_tr_b16 a[186:187], v23 offset:36864
    v_accvgpr_write_b32 a40, 0
    v_mfma_f32_16x16x32_bf16 v[132:135], a[160:163], a[116:119], v[132:135]
    ds_read_b64_tr_b16 a[188:189], v23 offset:40960
    v_accvgpr_write_b32 a41, 0
    v_mfma_f32_16x16x32_bf16 v[132:135], a[164:167], a[124:127], v[132:135]
    s_waitcnt lgkmcnt(9)
    buffer_load_dwordx4 v39, s[8:11], s40 offen offset:3072 lds
    v_mfma_f32_16x16x32_bf16 v[136:139], a[168:171], a[112:115], v[136:139]
    s_waitcnt lgkmcnt(7)
    s_add_u32 s40, s40, 16384
    ds_read_b64_tr_b16 a[190:191], v23 offset:45056
    ds_read_b64_tr_b16 a[160:161], v24 offset:32768
    v_mfma_f32_16x16x32_bf16 v[136:139], a[172:175], a[120:123], v[136:139]
    ds_read_b64_tr_b16 a[162:163], v24 offset:36864
    v_accvgpr_write_b32 a42, 0
    v_mfma_f32_16x16x32_bf16 v[140:143], a[168:171], a[116:119], v[140:143]
    ds_read_b64_tr_b16 a[164:165], v24 offset:40960
    v_accvgpr_write_b32 a43, 0
    v_mfma_f32_16x16x32_bf16 v[140:143], a[172:175], a[124:127], v[140:143]
    s_waitcnt lgkmcnt(9)
    ds_read_b64_tr_b16 a[166:167], v24 offset:45056
    v_accvgpr_write_b32 a44, 0
    v_mfma_f32_16x16x32_bf16 v[144:147], a[176:179], a[112:115], v[144:147]
    s_waitcnt lgkmcnt(8)
    ds_read_b64_tr_b16 a[168:169], v25 offset:32768
    v_accvgpr_write_b32 a45, 0
    v_mfma_f32_16x16x32_bf16 v[144:147], a[180:183], a[120:123], v[144:147]
    ds_read_b64_tr_b16 a[170:171], v25 offset:36864
    v_accvgpr_write_b32 a46, 0
    v_mfma_f32_16x16x32_bf16 v[148:151], a[176:179], a[116:119], v[148:151]
    ds_read_b64_tr_b16 a[172:173], v25 offset:40960
    v_accvgpr_write_b32 a47, 0
    v_mfma_f32_16x16x32_bf16 v[148:151], a[180:183], a[124:127], v[148:151]
    s_waitcnt lgkmcnt(9)
    ds_read_b64_tr_b16 a[174:175], v25 offset:45056
    v_accvgpr_write_b32 a48, 0
    v_mfma_f32_16x16x32_bf16 v[152:155], a[184:187], a[112:115], v[152:155]
    s_waitcnt lgkmcnt(8)
    ds_read_b64_tr_b16 a[176:177], v26 offset:32768
    v_accvgpr_write_b32 a49, 0
    v_mfma_f32_16x16x32_bf16 v[152:155], a[188:191], a[120:123], v[152:155]
    ds_read_b64_tr_b16 a[178:179], v26 offset:36864
    v_accvgpr_write_b32 a50, 0
    v_mfma_f32_16x16x32_bf16 v[156:159], a[184:187], a[116:119], v[156:159]
    ds_read_b64_tr_b16 a[180:181], v26 offset:40960
    v_accvgpr_write_b32 a51, 0
    v_mfma_f32_16x16x32_bf16 v[156:159], a[188:191], a[124:127], v[156:159]
    s_waitcnt lgkmcnt(9)
    ds_read_b64_tr_b16 a[182:183], v26 offset:45056
    v_accvgpr_write_b32 a52, 0
    v_mfma_f32_16x16x32_bf16 v[160:163], a[160:163], a[112:115], v[160:163]
    s_waitcnt lgkmcnt(8)
    ds_read_b64_tr_b16 a[184:185], v27 offset:32768
    v_accvgpr_write_b32 a53, 0
    v_mfma_f32_16x16x32_bf16 v[160:163], a[164:167], a[120:123], v[160:163]
    ds_read_b64_tr_b16 a[186:187], v27 offset:36864
    v_accvgpr_write_b32 a54, 0
    v_mfma_f32_16x16x32_bf16 v[164:167], a[160:163], a[116:119], v[164:167]
    ds_read_b64_tr_b16 a[188:189], v27 offset:40960
    v_accvgpr_write_b32 a55, 0
    v_mfma_f32_16x16x32_bf16 v[164:167], a[164:167], a[124:127], v[164:167]
    s_waitcnt lgkmcnt(9)
    ds_read_b64_tr_b16 a[190:191], v27 offset:45056
    v_accvgpr_write_b32 a56, 0
    v_mfma_f32_16x16x32_bf16 v[168:171], a[168:171], a[112:115], v[168:171]
    s_waitcnt lgkmcnt(8)
    ds_read_b64_tr_b16 a[160:161], v20 offset:49152
    v_accvgpr_write_b32 a57, 0
    v_mfma_f32_16x16x32_bf16 v[168:171], a[172:175], a[120:123], v[168:171]
    ds_read_b64_tr_b16 a[162:163], v20 offset:53248
    v_accvgpr_write_b32 a58, 0
    v_mfma_f32_16x16x32_bf16 v[172:175], a[168:171], a[116:119], v[172:175]
    ds_read_b64_tr_b16 a[164:165], v20 offset:57344
    v_accvgpr_write_b32 a59, 0
    v_mfma_f32_16x16x32_bf16 v[172:175], a[172:175], a[124:127], v[172:175]
    s_waitcnt lgkmcnt(9)
    ds_read_b64_tr_b16 a[166:167], v20 offset:61440
    v_accvgpr_write_b32 a60, 0
    v_mfma_f32_16x16x32_bf16 v[176:179], a[176:179], a[112:115], v[176:179]
    s_waitcnt lgkmcnt(8)
    ds_read_b64_tr_b16 a[168:169], v21 offset:49152
    v_accvgpr_write_b32 a61, 0
    v_mfma_f32_16x16x32_bf16 v[176:179], a[180:183], a[120:123], v[176:179]
    ds_read_b64_tr_b16 a[170:171], v21 offset:53248
    v_accvgpr_write_b32 a62, 0
    v_mfma_f32_16x16x32_bf16 v[180:183], a[176:179], a[116:119], v[180:183]
    ds_read_b64_tr_b16 a[172:173], v21 offset:57344
    v_accvgpr_write_b32 a63, 0
    v_mfma_f32_16x16x32_bf16 v[180:183], a[180:183], a[124:127], v[180:183]
    s_waitcnt lgkmcnt(9)
    ds_read_b64_tr_b16 a[174:175], v21 offset:61440
    v_accvgpr_write_b32 a64, 0
    v_mfma_f32_16x16x32_bf16 v[184:187], a[184:187], a[112:115], v[184:187]
    s_waitcnt lgkmcnt(8)
    ds_read_b64_tr_b16 a[176:177], v22 offset:49152
    v_accvgpr_write_b32 a65, 0
    v_mfma_f32_16x16x32_bf16 v[184:187], a[188:191], a[120:123], v[184:187]
    ds_read_b64_tr_b16 a[178:179], v22 offset:53248
    v_accvgpr_write_b32 a66, 0
    v_mfma_f32_16x16x32_bf16 v[188:191], a[184:187], a[116:119], v[188:191]
    ds_read_b64_tr_b16 a[180:181], v22 offset:57344
    v_accvgpr_write_b32 a67, 0
    v_mfma_f32_16x16x32_bf16 v[188:191], a[188:191], a[124:127], v[188:191]
    s_waitcnt lgkmcnt(9)
    ds_read_b64_tr_b16 a[182:183], v22 offset:61440
    v_accvgpr_write_b32 a68, 0
    v_mfma_f32_16x16x32_bf16 v[192:195], a[160:163], a[112:115], v[192:195]
    s_waitcnt lgkmcnt(8)
    ds_read_b64_tr_b16 a[184:185], v23 offset:49152
    v_accvgpr_write_b32 a69, 0
    v_mfma_f32_16x16x32_bf16 v[192:195], a[164:167], a[120:123], v[192:195]
    ds_read_b64_tr_b16 a[186:187], v23 offset:53248
    v_accvgpr_write_b32 a70, 0
    v_mfma_f32_16x16x32_bf16 v[196:199], a[160:163], a[116:119], v[196:199]
    ds_read_b64_tr_b16 a[188:189], v23 offset:57344
    v_accvgpr_write_b32 a71, 0
    v_mfma_f32_16x16x32_bf16 v[196:199], a[164:167], a[124:127], v[196:199]
    s_waitcnt lgkmcnt(9)
    ds_read_b64_tr_b16 a[190:191], v23 offset:61440
    v_accvgpr_write_b32 a72, 0
    v_mfma_f32_16x16x32_bf16 v[200:203], a[168:171], a[112:115], v[200:203]
    s_waitcnt lgkmcnt(8)
    ds_read_b64_tr_b16 a[160:161], v24 offset:49152
    v_accvgpr_write_b32 a73, 0
    v_mfma_f32_16x16x32_bf16 v[200:203], a[172:175], a[120:123], v[200:203]
    ds_read_b64_tr_b16 a[162:163], v24 offset:53248
    v_accvgpr_write_b32 a74, 0
    v_mfma_f32_16x16x32_bf16 v[204:207], a[168:171], a[116:119], v[204:207]
    ds_read_b64_tr_b16 a[164:165], v24 offset:57344
    v_accvgpr_write_b32 a75, 0
    v_mfma_f32_16x16x32_bf16 v[204:207], a[172:175], a[124:127], v[204:207]
    s_waitcnt lgkmcnt(9)
    ds_read_b64_tr_b16 a[166:167], v24 offset:61440
    v_accvgpr_write_b32 a76, 0
    v_mfma_f32_16x16x32_bf16 v[208:211], a[176:179], a[112:115], v[208:211]
    s_waitcnt lgkmcnt(8)
    ds_read_b64_tr_b16 a[168:169], v25 offset:49152
    v_accvgpr_write_b32 a77, 0
    v_mfma_f32_16x16x32_bf16 v[208:211], a[180:183], a[120:123], v[208:211]
    ds_read_b64_tr_b16 a[170:171], v25 offset:53248
    v_accvgpr_write_b32 a78, 0
    v_mfma_f32_16x16x32_bf16 v[212:215], a[176:179], a[116:119], v[212:215]
    ds_read_b64_tr_b16 a[172:173], v25 offset:57344
    v_accvgpr_write_b32 a79, 0
    v_mfma_f32_16x16x32_bf16 v[212:215], a[180:183], a[124:127], v[212:215]
    s_waitcnt lgkmcnt(9)
    ds_read_b64_tr_b16 a[174:175], v25 offset:61440
    v_accvgpr_write_b32 a80, 0
    v_mfma_f32_16x16x32_bf16 v[216:219], a[184:187], a[112:115], v[216:219]
    s_waitcnt lgkmcnt(8)
    ds_read_b64_tr_b16 a[176:177], v26 offset:49152
    v_accvgpr_write_b32 a81, 0
    v_mfma_f32_16x16x32_bf16 v[216:219], a[188:191], a[120:123], v[216:219]
    ds_read_b64_tr_b16 a[178:179], v26 offset:53248
    v_accvgpr_write_b32 a82, 0
    v_mfma_f32_16x16x32_bf16 v[220:223], a[184:187], a[116:119], v[220:223]
    ds_read_b64_tr_b16 a[180:181], v26 offset:57344
    v_accvgpr_write_b32 a83, 0
    v_mfma_f32_16x16x32_bf16 v[220:223], a[188:191], a[124:127], v[220:223]
    s_waitcnt lgkmcnt(9)
    ds_read_b64_tr_b16 a[182:183], v26 offset:61440
    v_accvgpr_write_b32 a84, 0
    v_mfma_f32_16x16x32_bf16 v[224:227], a[160:163], a[112:115], v[224:227]
    s_waitcnt lgkmcnt(8)
    ds_read_b64_tr_b16 a[184:185], v27 offset:49152
    v_accvgpr_write_b32 a85, 0
    v_mfma_f32_16x16x32_bf16 v[224:227], a[164:167], a[120:123], v[224:227]
    ds_read_b64_tr_b16 a[186:187], v27 offset:53248
    v_accvgpr_write_b32 a86, 0
    v_mfma_f32_16x16x32_bf16 v[228:231], a[160:163], a[116:119], v[228:231]
    ds_read_b64_tr_b16 a[188:189], v27 offset:57344
    v_accvgpr_write_b32 a87, 0
    v_mfma_f32_16x16x32_bf16 v[228:231], a[164:167], a[124:127], v[228:231]
    s_waitcnt lgkmcnt(9)
    ds_read_b64_tr_b16 a[190:191], v27 offset:61440
    v_accvgpr_write_b32 a88, 0
    s_waitcnt vmcnt(12)
    s_barrier
    v_mfma_f32_16x16x32_bf16 v[232:235], a[168:171], a[112:115], v[232:235]
    s_waitcnt lgkmcnt(8)
    ds_read_b64_tr_b16 a[160:161], v28 offset:0
    v_accvgpr_write_b32 a89, 0
    v_mfma_f32_16x16x32_bf16 v[232:235], a[172:175], a[120:123], v[232:235]
    ds_read_b64_tr_b16 a[162:163], v28 offset:4096
    v_accvgpr_write_b32 a90, 0
    v_mfma_f32_16x16x32_bf16 v[236:239], a[168:171], a[116:119], v[236:239]
    s_add_u32 m0, s42, 65536
    ds_read_b64_tr_b16 a[164:165], v28 offset:8192
    v_accvgpr_write_b32 a91, 0
    v_mfma_f32_16x16x32_bf16 v[236:239], a[172:175], a[124:127], v[236:239]
    s_waitcnt lgkmcnt(9)
    buffer_load_dwordx4 v40, s[12:15], s41 offen lds
    v_mfma_f32_16x16x32_bf16 v[240:243], a[176:179], a[112:115], v[240:243]
    s_waitcnt lgkmcnt(7)
    ds_read_b64_tr_b16 a[166:167], v28 offset:12288
    ds_read_b64_tr_b16 a[168:169], v29 offset:0
    v_mfma_f32_16x16x32_bf16 v[240:243], a[180:183], a[120:123], v[240:243]
    ds_read_b64_tr_b16 a[170:171], v29 offset:4096
    v_accvgpr_write_b32 a92, 0
    v_mfma_f32_16x16x32_bf16 v[244:247], a[176:179], a[116:119], v[244:247]
    ds_read_b64_tr_b16 a[172:173], v29 offset:8192
    v_accvgpr_write_b32 a93, 0
    v_mfma_f32_16x16x32_bf16 v[244:247], a[180:183], a[124:127], v[244:247]
    s_waitcnt lgkmcnt(9)
    buffer_load_dwordx4 v41, s[12:15], s41 offen offset:1024 lds
    v_mfma_f32_16x16x32_bf16 v[248:251], a[184:187], a[112:115], v[248:251]
    s_waitcnt lgkmcnt(7)
    ds_read_b64_tr_b16 a[174:175], v29 offset:12288
    ds_read_b64_tr_b16 a[176:177], v30 offset:0
    v_mfma_f32_16x16x32_bf16 v[248:251], a[188:191], a[120:123], v[248:251]
    ds_read_b64_tr_b16 a[178:179], v30 offset:4096
    v_accvgpr_write_b32 a94, 0
    v_mfma_f32_16x16x32_bf16 v[252:255], a[184:187], a[116:119], v[252:255]
    ds_read_b64_tr_b16 a[180:181], v30 offset:8192
    v_accvgpr_write_b32 a95, 0
    v_mfma_f32_16x16x32_bf16 v[252:255], a[188:191], a[124:127], v[252:255]
    s_waitcnt lgkmcnt(9)
    buffer_load_dwordx4 v40, s[12:15], s41 offen offset:2048 lds
    v_mfma_f32_16x16x32_bf16 v[128:131], a[160:163], a[128:131], v[128:131]
    s_waitcnt lgkmcnt(7)
    ds_read_b64_tr_b16 a[182:183], v30 offset:12288
    ds_read_b64_tr_b16 a[184:185], v31 offset:0
    v_mfma_f32_16x16x32_bf16 v[128:131], a[164:167], a[136:139], v[128:131]
    ds_read_b64_tr_b16 a[186:187], v31 offset:4096
    v_accvgpr_write_b32 a96, 0
    v_mfma_f32_16x16x32_bf16 v[132:135], a[160:163], a[132:135], v[132:135]
    ds_read_b64_tr_b16 a[188:189], v31 offset:8192
    v_accvgpr_write_b32 a97, 0
    v_mfma_f32_16x16x32_bf16 v[132:135], a[164:167], a[140:143], v[132:135]
    s_waitcnt lgkmcnt(9)
    buffer_load_dwordx4 v41, s[12:15], s41 offen offset:3072 lds
    v_mfma_f32_16x16x32_bf16 v[136:139], a[168:171], a[128:131], v[136:139]
    s_waitcnt lgkmcnt(7)
    s_add_u32 s41, s41, 16384
    ds_read_b64_tr_b16 a[190:191], v31 offset:12288
    ds_read_b64_tr_b16 a[160:161], v32 offset:0
    v_mfma_f32_16x16x32_bf16 v[136:139], a[172:175], a[136:139], v[136:139]
    ds_read_b64_tr_b16 a[162:163], v32 offset:4096
    v_accvgpr_write_b32 a98, 0
    v_mfma_f32_16x16x32_bf16 v[140:143], a[168:171], a[132:135], v[140:143]
    s_add_u32 m0, s42, 81920
    ds_read_b64_tr_b16 a[164:165], v32 offset:8192
    v_accvgpr_write_b32 a99, 0
    v_mfma_f32_16x16x32_bf16 v[140:143], a[172:175], a[140:143], v[140:143]
    s_waitcnt lgkmcnt(9)
    buffer_load_dwordx4 v40, s[12:15], s41 offen lds
    v_mfma_f32_16x16x32_bf16 v[144:147], a[176:179], a[128:131], v[144:147]
    s_waitcnt lgkmcnt(7)
    ds_read_b64_tr_b16 a[166:167], v32 offset:12288
    ds_read_b64_tr_b16 a[168:169], v33 offset:0
    v_mfma_f32_16x16x32_bf16 v[144:147], a[180:183], a[136:139], v[144:147]
    ds_read_b64_tr_b16 a[170:171], v33 offset:4096
    v_accvgpr_write_b32 a100, 0
    v_mfma_f32_16x16x32_bf16 v[148:151], a[176:179], a[132:135], v[148:151]
    ds_read_b64_tr_b16 a[172:173], v33 offset:8192
    v_accvgpr_write_b32 a101, 0
    v_mfma_f32_16x16x32_bf16 v[148:151], a[180:183], a[140:143], v[148:151]
    s_waitcnt lgkmcnt(9)
    buffer_load_dwordx4 v41, s[12:15], s41 offen offset:1024 lds
    v_mfma_f32_16x16x32_bf16 v[152:155], a[184:187], a[128:131], v[152:155]
    s_waitcnt lgkmcnt(7)
    ds_read_b64_tr_b16 a[174:175], v33 offset:12288
    ds_read_b64_tr_b16 a[176:177], v34 offset:0
    v_mfma_f32_16x16x32_bf16 v[152:155], a[188:191], a[136:139], v[152:155]
    ds_read_b64_tr_b16 a[178:179], v34 offset:4096
    v_accvgpr_write_b32 a102, 0
    v_mfma_f32_16x16x32_bf16 v[156:159], a[184:187], a[132:135], v[156:159]
    ds_read_b64_tr_b16 a[180:181], v34 offset:8192
    v_accvgpr_write_b32 a103, 0
    v_mfma_f32_16x16x32_bf16 v[156:159], a[188:191], a[140:143], v[156:159]
    s_waitcnt lgkmcnt(9)
    buffer_load_dwordx4 v40, s[12:15], s41 offen offset:2048 lds
    v_mfma_f32_16x16x32_bf16 v[160:163], a[160:163], a[128:131], v[160:163]
    s_waitcnt lgkmcnt(7)
    ds_read_b64_tr_b16 a[182:183], v34 offset:12288
    ds_read_b64_tr_b16 a[184:185], v35 offset:0
    v_mfma_f32_16x16x32_bf16 v[160:163], a[164:167], a[136:139], v[160:163]
    ds_read_b64_tr_b16 a[186:187], v35 offset:4096
    v_accvgpr_write_b32 a104, 0
    v_mfma_f32_16x16x32_bf16 v[164:167], a[160:163], a[132:135], v[164:167]
    ds_read_b64_tr_b16 a[188:189], v35 offset:8192
    v_accvgpr_write_b32 a105, 0
    v_mfma_f32_16x16x32_bf16 v[164:167], a[164:167], a[140:143], v[164:167]
    s_waitcnt lgkmcnt(9)
    buffer_load_dwordx4 v41, s[12:15], s41 offen offset:3072 lds
    v_mfma_f32_16x16x32_bf16 v[168:171], a[168:171], a[128:131], v[168:171]
    s_waitcnt lgkmcnt(7)
    s_add_u32 s41, s41, 16384
    ds_read_b64_tr_b16 a[190:191], v35 offset:12288
    ds_read_b64_tr_b16 a[160:161], v28 offset:16384
    v_mfma_f32_16x16x32_bf16 v[168:171], a[172:175], a[136:139], v[168:171]
    ds_read_b64_tr_b16 a[162:163], v28 offset:20480
    v_accvgpr_write_b32 a106, 0
    v_mfma_f32_16x16x32_bf16 v[172:175], a[168:171], a[132:135], v[172:175]
    ds_read_b64_tr_b16 a[164:165], v28 offset:24576
    v_accvgpr_write_b32 a107, 0
    v_mfma_f32_16x16x32_bf16 v[172:175], a[172:175], a[140:143], v[172:175]
    s_waitcnt lgkmcnt(9)
    ds_read_b64_tr_b16 a[166:167], v28 offset:28672
    v_accvgpr_write_b32 a108, 0
    v_mfma_f32_16x16x32_bf16 v[176:179], a[176:179], a[128:131], v[176:179]
    s_waitcnt lgkmcnt(8)
    ds_read_b64_tr_b16 a[168:169], v29 offset:16384
    v_accvgpr_write_b32 a109, 0
    v_mfma_f32_16x16x32_bf16 v[176:179], a[180:183], a[136:139], v[176:179]
    ds_read_b64_tr_b16 a[170:171], v29 offset:20480
    v_accvgpr_write_b32 a110, 0
    v_mfma_f32_16x16x32_bf16 v[180:183], a[176:179], a[132:135], v[180:183]
    ds_read_b64_tr_b16 a[172:173], v29 offset:24576
    v_accvgpr_write_b32 a111, 0
    v_mfma_f32_16x16x32_bf16 v[180:183], a[180:183], a[140:143], v[180:183]
    s_waitcnt lgkmcnt(9)
    ds_read_b64_tr_b16 a[174:175], v29 offset:28672
    v_accvgpr_write_b32 a192, 0
    v_mfma_f32_16x16x32_bf16 v[184:187], a[184:187], a[128:131], v[184:187]
    s_waitcnt lgkmcnt(8)
    ds_read_b64_tr_b16 a[176:177], v30 offset:16384
    v_accvgpr_write_b32 a193, 0
    v_mfma_f32_16x16x32_bf16 v[184:187], a[188:191], a[136:139], v[184:187]
    ds_read_b64_tr_b16 a[178:179], v30 offset:20480
    v_accvgpr_write_b32 a194, 0
    v_mfma_f32_16x16x32_bf16 v[188:191], a[184:187], a[132:135], v[188:191]
    ds_read_b64_tr_b16 a[180:181], v30 offset:24576
    v_accvgpr_write_b32 a195, 0
    v_mfma_f32_16x16x32_bf16 v[188:191], a[188:191], a[140:143], v[188:191]
    s_waitcnt lgkmcnt(9)
    ds_read_b64_tr_b16 a[182:183], v30 offset:28672
    v_accvgpr_write_b32 a196, 0
    v_mfma_f32_16x16x32_bf16 v[192:195], a[160:163], a[128:131], v[192:195]
    s_waitcnt lgkmcnt(8)
    ds_read_b64_tr_b16 a[184:185], v31 offset:16384
    v_accvgpr_write_b32 a197, 0
    v_mfma_f32_16x16x32_bf16 v[192:195], a[164:167], a[136:139], v[192:195]
    ds_read_b64_tr_b16 a[186:187], v31 offset:20480
    v_accvgpr_write_b32 a198, 0
    v_mfma_f32_16x16x32_bf16 v[196:199], a[160:163], a[132:135], v[196:199]
    ds_read_b64_tr_b16 a[188:189], v31 offset:24576
    v_accvgpr_write_b32 a199, 0
    v_mfma_f32_16x16x32_bf16 v[196:199], a[164:167], a[140:143], v[196:199]
    s_waitcnt lgkmcnt(9)
    ds_read_b64_tr_b16 a[190:191], v31 offset:28672
    v_accvgpr_write_b32 a200, 0
    v_mfma_f32_16x16x32_bf16 v[200:203], a[168:171], a[128:131], v[200:203]
    s_waitcnt lgkmcnt(8)
    ds_read_b64_tr_b16 a[160:161], v32 offset:16384
    v_accvgpr_write_b32 a201, 0
    v_mfma_f32_16x16x32_bf16 v[200:203], a[172:175], a[136:139], v[200:203]
    ds_read_b64_tr_b16 a[162:163], v32 offset:20480
    v_accvgpr_write_b32 a202, 0
    v_mfma_f32_16x16x32_bf16 v[204:207], a[168:171], a[132:135], v[204:207]
    ds_read_b64_tr_b16 a[164:165], v32 offset:24576
    v_accvgpr_write_b32 a203, 0
    v_mfma_f32_16x16x32_bf16 v[204:207], a[172:175], a[140:143], v[204:207]
    s_waitcnt lgkmcnt(9)
    ds_read_b64_tr_b16 a[166:167], v32 offset:28672
    v_accvgpr_write_b32 a204, 0
    v_mfma_f32_16x16x32_bf16 v[208:211], a[176:179], a[128:131], v[208:211]
    s_waitcnt lgkmcnt(8)
    ds_read_b64_tr_b16 a[168:169], v33 offset:16384
    v_accvgpr_write_b32 a205, 0
    v_mfma_f32_16x16x32_bf16 v[208:211], a[180:183], a[136:139], v[208:211]
    ds_read_b64_tr_b16 a[170:171], v33 offset:20480
    v_accvgpr_write_b32 a206, 0
    v_mfma_f32_16x16x32_bf16 v[212:215], a[176:179], a[132:135], v[212:215]
    ds_read_b64_tr_b16 a[172:173], v33 offset:24576
    v_accvgpr_write_b32 a207, 0
    v_mfma_f32_16x16x32_bf16 v[212:215], a[180:183], a[140:143], v[212:215]
    s_waitcnt lgkmcnt(9)
    ds_read_b64_tr_b16 a[174:175], v33 offset:28672
    v_accvgpr_write_b32 a112, 0
    v_mfma_f32_16x16x32_bf16 v[216:219], a[184:187], a[128:131], v[216:219]
    s_waitcnt lgkmcnt(8)
    ds_read_b64_tr_b16 a[176:177], v34 offset:16384
    v_accvgpr_write_b32 a113, 0
    v_mfma_f32_16x16x32_bf16 v[216:219], a[188:191], a[136:139], v[216:219]
    ds_read_b64_tr_b16 a[178:179], v34 offset:20480
    v_accvgpr_write_b32 a114, 0
    v_mfma_f32_16x16x32_bf16 v[220:223], a[184:187], a[132:135], v[220:223]
    ds_read_b64_tr_b16 a[180:181], v34 offset:24576
    v_accvgpr_write_b32 a115, 0
    v_mfma_f32_16x16x32_bf16 v[220:223], a[188:191], a[140:143], v[220:223]
    s_waitcnt lgkmcnt(9)
    ds_read_b64_tr_b16 a[182:183], v34 offset:28672
    v_accvgpr_write_b32 a116, 0
    v_mfma_f32_16x16x32_bf16 v[224:227], a[160:163], a[128:131], v[224:227]
    s_waitcnt lgkmcnt(8)
    ds_read_b64_tr_b16 a[184:185], v35 offset:16384
    v_accvgpr_write_b32 a117, 0
    v_mfma_f32_16x16x32_bf16 v[224:227], a[164:167], a[136:139], v[224:227]
    ds_read_b64_tr_b16 a[186:187], v35 offset:20480
    v_accvgpr_write_b32 a118, 0
    v_mfma_f32_16x16x32_bf16 v[228:231], a[160:163], a[132:135], v[228:231]
    ds_read_b64_tr_b16 a[188:189], v35 offset:24576
    v_accvgpr_write_b32 a119, 0
    v_mfma_f32_16x16x32_bf16 v[228:231], a[164:167], a[140:143], v[228:231]
    s_waitcnt lgkmcnt(9)
    ds_read_b64_tr_b16 a[190:191], v35 offset:28672
    v_accvgpr_write_b32 a120, 0
    v_mfma_f32_16x16x32_bf16 v[232:235], a[168:171], a[128:131], v[232:235]
    s_waitcnt lgkmcnt(8)
    v_accvgpr_write_b32 a121, 0
    v_mfma_f32_16x16x32_bf16 v[232:235], a[172:175], a[136:139], v[232:235]
    v_accvgpr_write_b32 a122, 0
    v_mfma_f32_16x16x32_bf16 v[236:239], a[168:171], a[132:135], v[236:239]
    v_accvgpr_write_b32 a123, 0
    v_mfma_f32_16x16x32_bf16 v[236:239], a[172:175], a[140:143], v[236:239]
    s_waitcnt lgkmcnt(6)
    v_accvgpr_write_b32 a124, 0
    s_waitcnt vmcnt(16)
    s_barrier
    v_mfma_f32_16x16x32_bf16 v[240:243], a[176:179], a[128:131], v[240:243]
    s_waitcnt lgkmcnt(4)
    ds_read_b128 a[208:211], v8 offset:0
    v_accvgpr_write_b32 a125, 0
    v_mfma_f32_16x16x32_bf16 v[240:243], a[180:183], a[136:139], v[240:243]
    ds_read_b128 a[212:215], v9 offset:0
    v_accvgpr_write_b32 a126, 0
    v_mfma_f32_16x16x32_bf16 v[244:247], a[176:179], a[132:135], v[244:247]
    ds_read_b128 a[216:219], v10 offset:0
    v_accvgpr_write_b32 a127, 0
    v_mfma_f32_16x16x32_bf16 v[244:247], a[180:183], a[140:143], v[244:247]
    s_waitcnt lgkmcnt(5)
    ds_read_b128 a[220:223], v11 offset:0
    v_mfma_f32_16x16x32_bf16 v[248:251], a[184:187], a[128:131], v[248:251]
    s_waitcnt lgkmcnt(4)
    ds_read_b128 a[224:227], v8 offset:4096
    v_mfma_f32_16x16x32_bf16 v[248:251], a[188:191], a[136:139], v[248:251]
    v_mfma_f32_16x16x32_bf16 v[252:255], a[184:187], a[132:135], v[252:255]
    v_mfma_f32_16x16x32_bf16 v[252:255], a[188:191], a[140:143], v[252:255]
    s_waitcnt lgkmcnt(4)
    s_mov_b32 s36, 1040356334
    s_mov_b32 s37, 1040356334
    v_pk_mul_f32 v[128:129], v[128:129], s[36:37]
    v_pk_mul_f32 v[130:131], v[130:131], s[36:37]
    v_pk_mul_f32 v[136:137], v[136:137], s[36:37]
    v_pk_mul_f32 v[138:139], v[138:139], s[36:37]
    v_cvt_pk_bf16_f32 v64, v128, v129
    v_cvt_pk_bf16_f32 v65, v130, v131
    v_cvt_pk_bf16_f32 v66, v136, v137
    v_cvt_pk_bf16_f32 v67, v138, v139
    v_pk_mul_f32 v[132:133], v[132:133], s[36:37]
    v_pk_mul_f32 v[134:135], v[134:135], s[36:37]
    v_pk_mul_f32 v[140:141], v[140:141], s[36:37]
    v_pk_mul_f32 v[142:143], v[142:143], s[36:37]
    v_cvt_pk_bf16_f32 v80, v132, v133
    v_cvt_pk_bf16_f32 v81, v134, v135
    v_cvt_pk_bf16_f32 v82, v140, v141
    v_cvt_pk_bf16_f32 v83, v142, v143
    v_permlane32_swap_b32 v64, v66
    v_permlane32_swap_b32 v65, v67
    v_permlane32_swap_b32 v80, v82
    v_permlane32_swap_b32 v81, v83
    v_permlane16_swap_b32 v64, v66
    v_permlane16_swap_b32 v65, v67
    v_permlane16_swap_b32 v80, v82
    v_permlane16_swap_b32 v81, v83
    v_pk_mul_f32 v[144:145], v[144:145], s[36:37]
    v_pk_mul_f32 v[146:147], v[146:147], s[36:37]
    v_pk_mul_f32 v[152:153], v[152:153], s[36:37]
    v_pk_mul_f32 v[154:155], v[154:155], s[36:37]
    v_cvt_pk_bf16_f32 v68, v144, v145
    v_cvt_pk_bf16_f32 v69, v146, v147
    v_cvt_pk_bf16_f32 v70, v152, v153
    v_cvt_pk_bf16_f32 v71, v154, v155
    v_pk_mul_f32 v[148:149], v[148:149], s[36:37]
    v_pk_mul_f32 v[150:151], v[150:151], s[36:37]
    v_pk_mul_f32 v[156:157], v[156:157], s[36:37]
    v_pk_mul_f32 v[158:159], v[158:159], s[36:37]
    v_cvt_pk_bf16_f32 v84, v148, v149
    v_cvt_pk_bf16_f32 v85, v150, v151
    v_cvt_pk_bf16_f32 v86, v156, v157
    v_cvt_pk_bf16_f32 v87, v158, v159
    v_permlane32_swap_b32 v68, v70
    v_permlane32_swap_b32 v69, v71
    v_permlane32_swap_b32 v84, v86
    v_permlane32_swap_b32 v85, v87
    v_permlane16_swap_b32 v68, v70
    v_permlane16_swap_b32 v69, v71
    v_permlane16_swap_b32 v84, v86
    v_permlane16_swap_b32 v85, v87
    v_pk_mul_f32 v[160:161], v[160:161], s[36:37]
    v_pk_mul_f32 v[162:163], v[162:163], s[36:37]
    v_pk_mul_f32 v[168:169], v[168:169], s[36:37]
    v_pk_mul_f32 v[170:171], v[170:171], s[36:37]
    v_cvt_pk_bf16_f32 v72, v160, v161
    v_cvt_pk_bf16_f32 v73, v162, v163
    v_cvt_pk_bf16_f32 v74, v168, v169
    v_cvt_pk_bf16_f32 v75, v170, v171
    v_pk_mul_f32 v[164:165], v[164:165], s[36:37]
    v_pk_mul_f32 v[166:167], v[166:167], s[36:37]
    v_pk_mul_f32 v[172:173], v[172:173], s[36:37]
    v_pk_mul_f32 v[174:175], v[174:175], s[36:37]
    v_cvt_pk_bf16_f32 v88, v164, v165
    v_cvt_pk_bf16_f32 v89, v166, v167
    v_cvt_pk_bf16_f32 v90, v172, v173
    v_cvt_pk_bf16_f32 v91, v174, v175
    v_permlane32_swap_b32 v72, v74
    v_permlane32_swap_b32 v73, v75
    v_permlane32_swap_b32 v88, v90
    v_permlane32_swap_b32 v89, v91
    v_permlane16_swap_b32 v72, v74
    v_permlane16_swap_b32 v73, v75
    v_permlane16_swap_b32 v88, v90
    v_permlane16_swap_b32 v89, v91
    v_pk_mul_f32 v[176:177], v[176:177], s[36:37]
    v_pk_mul_f32 v[178:179], v[178:179], s[36:37]
    v_pk_mul_f32 v[184:185], v[184:185], s[36:37]
    v_pk_mul_f32 v[186:187], v[186:187], s[36:37]
    v_cvt_pk_bf16_f32 v76, v176, v177
    v_cvt_pk_bf16_f32 v77, v178, v179
    v_cvt_pk_bf16_f32 v78, v184, v185
    v_cvt_pk_bf16_f32 v79, v186, v187
    v_pk_mul_f32 v[180:181], v[180:181], s[36:37]
    v_pk_mul_f32 v[182:183], v[182:183], s[36:37]
    v_pk_mul_f32 v[188:189], v[188:189], s[36:37]
    v_pk_mul_f32 v[190:191], v[190:191], s[36:37]
    v_cvt_pk_bf16_f32 v92, v180, v181
    v_cvt_pk_bf16_f32 v93, v182, v183
    v_cvt_pk_bf16_f32 v94, v188, v189
    v_cvt_pk_bf16_f32 v95, v190, v191
    v_permlane32_swap_b32 v76, v78
    v_permlane32_swap_b32 v77, v79
    v_permlane32_swap_b32 v92, v94
    v_permlane32_swap_b32 v93, v95
    v_permlane16_swap_b32 v76, v78
    v_permlane16_swap_b32 v77, v79
    v_permlane16_swap_b32 v92, v94
    v_permlane16_swap_b32 v93, v95
    v_pk_mul_f32 v[192:193], v[192:193], s[36:37]
    v_pk_mul_f32 v[194:195], v[194:195], s[36:37]
    v_pk_mul_f32 v[200:201], v[200:201], s[36:37]
    v_pk_mul_f32 v[202:203], v[202:203], s[36:37]
    v_cvt_pk_bf16_f32 v96, v192, v193
    v_cvt_pk_bf16_f32 v97, v194, v195
    v_cvt_pk_bf16_f32 v98, v200, v201
    v_cvt_pk_bf16_f32 v99, v202, v203
    v_pk_mul_f32 v[196:197], v[196:197], s[36:37]
    v_pk_mul_f32 v[198:199], v[198:199], s[36:37]
    v_pk_mul_f32 v[204:205], v[204:205], s[36:37]
    v_pk_mul_f32 v[206:207], v[206:207], s[36:37]
    v_cvt_pk_bf16_f32 v112, v196, v197
    v_cvt_pk_bf16_f32 v113, v198, v199
    v_cvt_pk_bf16_f32 v114, v204, v205
    v_cvt_pk_bf16_f32 v115, v206, v207
    v_permlane32_swap_b32 v96, v98
    v_permlane32_swap_b32 v97, v99
    v_permlane32_swap_b32 v112, v114
    v_permlane32_swap_b32 v113, v115
    v_permlane16_swap_b32 v96, v98
    v_permlane16_swap_b32 v97, v99
    v_permlane16_swap_b32 v112, v114
    v_permlane16_swap_b32 v113, v115
    v_pk_mul_f32 v[208:209], v[208:209], s[36:37]
    v_pk_mul_f32 v[210:211], v[210:211], s[36:37]
    v_pk_mul_f32 v[216:217], v[216:217], s[36:37]
    v_pk_mul_f32 v[218:219], v[218:219], s[36:37]
    v_cvt_pk_bf16_f32 v100, v208, v209
    v_cvt_pk_bf16_f32 v101, v210, v211
    v_cvt_pk_bf16_f32 v102, v216, v217
    v_cvt_pk_bf16_f32 v103, v218, v219
    v_pk_mul_f32 v[212:213], v[212:213], s[36:37]
    v_pk_mul_f32 v[214:215], v[214:215], s[36:37]
    v_pk_mul_f32 v[220:221], v[220:221], s[36:37]
    v_pk_mul_f32 v[222:223], v[222:223], s[36:37]
    v_cvt_pk_bf16_f32 v116, v212, v213
    v_cvt_pk_bf16_f32 v117, v214, v215
    v_cvt_pk_bf16_f32 v118, v220, v221
    v_cvt_pk_bf16_f32 v119, v222, v223
    v_permlane32_swap_b32 v100, v102
    v_permlane32_swap_b32 v101, v103
    v_permlane32_swap_b32 v116, v118
    v_permlane32_swap_b32 v117, v119
    v_permlane16_swap_b32 v100, v102
    v_permlane16_swap_b32 v101, v103
    v_permlane16_swap_b32 v116, v118
    v_permlane16_swap_b32 v117, v119
    v_pk_mul_f32 v[224:225], v[224:225], s[36:37]
    v_pk_mul_f32 v[226:227], v[226:227], s[36:37]
    v_pk_mul_f32 v[232:233], v[232:233], s[36:37]
    v_pk_mul_f32 v[234:235], v[234:235], s[36:37]
    v_cvt_pk_bf16_f32 v104, v224, v225
    v_cvt_pk_bf16_f32 v105, v226, v227
    v_cvt_pk_bf16_f32 v106, v232, v233
    v_cvt_pk_bf16_f32 v107, v234, v235
    v_pk_mul_f32 v[228:229], v[228:229], s[36:37]
    v_pk_mul_f32 v[230:231], v[230:231], s[36:37]
    v_pk_mul_f32 v[236:237], v[236:237], s[36:37]
    v_pk_mul_f32 v[238:239], v[238:239], s[36:37]
    v_cvt_pk_bf16_f32 v120, v228, v229
    v_cvt_pk_bf16_f32 v121, v230, v231
    v_cvt_pk_bf16_f32 v122, v236, v237
    v_cvt_pk_bf16_f32 v123, v238, v239
    v_permlane32_swap_b32 v104, v106
    v_permlane32_swap_b32 v105, v107
    v_permlane32_swap_b32 v120, v122
    v_permlane32_swap_b32 v121, v123
    v_permlane16_swap_b32 v104, v106
    v_permlane16_swap_b32 v105, v107
    v_permlane16_swap_b32 v120, v122
    v_permlane16_swap_b32 v121, v123
    v_pk_mul_f32 v[240:241], v[240:241], s[36:37]
    v_pk_mul_f32 v[242:243], v[242:243], s[36:37]
    v_pk_mul_f32 v[248:249], v[248:249], s[36:37]
    v_pk_mul_f32 v[250:251], v[250:251], s[36:37]
    v_cvt_pk_bf16_f32 v108, v240, v241
    v_cvt_pk_bf16_f32 v109, v242, v243
    v_cvt_pk_bf16_f32 v110, v248, v249
    v_cvt_pk_bf16_f32 v111, v250, v251
    v_pk_mul_f32 v[244:245], v[244:245], s[36:37]
    v_pk_mul_f32 v[246:247], v[246:247], s[36:37]
    v_pk_mul_f32 v[252:253], v[252:253], s[36:37]
    v_pk_mul_f32 v[254:255], v[254:255], s[36:37]
    v_cvt_pk_bf16_f32 v124, v244, v245
    v_cvt_pk_bf16_f32 v125, v246, v247
    v_cvt_pk_bf16_f32 v126, v252, v253
    v_cvt_pk_bf16_f32 v127, v254, v255
    v_permlane32_swap_b32 v108, v110
    v_permlane32_swap_b32 v109, v111
    v_permlane32_swap_b32 v124, v126
    v_permlane32_swap_b32 v125, v127
    v_permlane16_swap_b32 v108, v110
    v_permlane16_swap_b32 v109, v111
    v_permlane16_swap_b32 v124, v126
    v_permlane16_swap_b32 v125, v127
    v_mfma_f32_16x16x32_bf16 v[216:219], a[208:211], v[64:67], 0
    s_waitcnt lgkmcnt(3)
    v_mfma_f32_16x16x32_bf16 v[216:219], a[212:215], v[68:71], v[216:219]
    s_waitcnt lgkmcnt(2)
    v_mfma_f32_16x16x32_bf16 v[216:219], a[216:219], v[72:75], v[216:219]
    s_waitcnt lgkmcnt(1)
    v_mfma_f32_16x16x32_bf16 v[216:219], a[220:223], v[76:79], v[216:219]
    v_mfma_f32_16x16x32_bf16 v[220:223], a[208:211], v[80:83], 0
    v_mfma_f32_16x16x32_bf16 v[220:223], a[212:215], v[84:87], v[220:223]
    v_mfma_f32_16x16x32_bf16 v[220:223], a[216:219], v[88:91], v[220:223]
    v_mfma_f32_16x16x32_bf16 v[220:223], a[220:223], v[92:95], v[220:223]
    v_mfma_f32_16x16x32_bf16 v[224:227], a[208:211], v[96:99], 0
    v_mfma_f32_16x16x32_bf16 v[224:227], a[212:215], v[100:103], v[224:227]
    v_mfma_f32_16x16x32_bf16 v[224:227], a[216:219], v[104:107], v[224:227]
    v_mfma_f32_16x16x32_bf16 v[224:227], a[220:223], v[108:111], v[224:227]
    v_mfma_f32_16x16x32_bf16 v[228:231], a[208:211], v[112:115], 0
    v_mfma_f32_16x16x32_bf16 v[228:231], a[212:215], v[116:119], v[228:231]
    v_mfma_f32_16x16x32_bf16 v[228:231], a[216:219], v[120:123], v[228:231]
    v_mfma_f32_16x16x32_bf16 v[228:231], a[220:223], v[124:127], v[228:231]
    v_max3_f32 v232, v216, v217, v218
    v_max_f32 v232, v232, v219
    v_max3_f32 v233, v220, v221, v222
    v_max_f32 v233, v233, v223
    v_max3_f32 v234, v224, v225, v226
    v_max_f32 v234, v234, v227
    s_nop 1
    v_max3_f32 v235, v228, v229, v230
    v_max_f32 v235, v235, v231
    v_mov_b32 v236, v232
    v_mov_b32 v237, v233
    v_mov_b32 v238, v234
    v_mov_b32 v239, v235
    v_permlane16_swap_b32 v232, v236
    v_permlane16_swap_b32 v233, v237
    v_permlane16_swap_b32 v234, v238
    v_permlane16_swap_b32 v235, v239
    v_max_f32 v232, v232, v236
    v_max_f32 v233, v233, v237
    v_max_f32 v234, v234, v238
    v_max_f32 v235, v235, v239
    v_mov_b32 v236, v232
    v_mov_b32 v237, v233
    v_mov_b32 v238, v234
    v_mov_b32 v239, v235
    v_permlane32_swap_b32 v232, v236
    v_permlane32_swap_b32 v233, v237
    v_permlane32_swap_b32 v234, v238
    v_permlane32_swap_b32 v235, v239
    v_max_f32 v232, v232, v236
    v_max_f32 v233, v233, v237
    v_max_f32 v234, v234, v238
    v_max_f32 v235, v235, v239
    v_sub_f32 v192, 3250585600, v232
    v_sub_f32 v193, 3250585600, v232
    v_sub_f32 v194, 3250585600, v232
    v_sub_f32 v195, 3250585600, v232
    v_sub_f32 v196, 3250585600, v233
    v_sub_f32 v197, 3250585600, v233
    v_sub_f32 v198, 3250585600, v233
    v_sub_f32 v199, 3250585600, v233
    v_sub_f32 v200, 3250585600, v234
    v_sub_f32 v201, 3250585600, v234
    v_sub_f32 v202, 3250585600, v234
    v_sub_f32 v203, 3250585600, v234
    v_sub_f32 v204, 3250585600, v235
    v_sub_f32 v205, 3250585600, v235
    v_sub_f32 v206, 3250585600, v235
    v_sub_f32 v207, 3250585600, v235
Lattn_stage0:
    s_mov_b32 s43, 7
    v_mfma_f32_16x16x32_bf16 v[208:211], a[208:211], v[64:67], v[192:195]
    v_mfma_f32_16x16x32_bf16 v[208:211], a[212:215], v[68:71], v[208:211]
    v_mfma_f32_16x16x32_bf16 v[208:211], a[216:219], v[72:75], v[208:211]
    v_mfma_f32_16x16x32_bf16 v[208:211], a[220:223], v[76:79], v[208:211]
    s_lshr_b32 s6, s2, 3
    ds_read_b128 a[228:231], v9 offset:4096
    v_mfma_f32_16x16x32_bf16 v[212:215], a[208:211], v[80:83], v[196:199]
    s_nop 4
    v_exp_f32 v208, v208
    v_mfma_f32_16x16x32_bf16 v[212:215], a[212:215], v[84:87], v[212:215]
    v_exp_f32 v209, v209
    v_mfma_f32_16x16x32_bf16 v[212:215], a[216:219], v[88:91], v[212:215]
    v_exp_f32 v210, v210
    v_mfma_f32_16x16x32_bf16 v[212:215], a[220:223], v[92:95], v[212:215]
    v_exp_f32 v211, v211
    v_cvt_pk_bf16_f32 v128, v208, v209
    s_and_b32 s7, s2, 7
    ds_read_b128 a[232:235], v10 offset:4096
    v_cvt_pk_bf16_f32 v129, v210, v211
    v_mfma_f32_16x16x32_bf16 v[208:211], a[208:211], v[96:99], v[200:203]
    s_nop 1
    v_exp_f32 v212, v212
    v_mfma_f32_16x16x32_bf16 v[208:211], a[212:215], v[100:103], v[208:211]
    v_exp_f32 v213, v213
    v_mfma_f32_16x16x32_bf16 v[208:211], a[216:219], v[104:107], v[208:211]
    v_exp_f32 v214, v214
    v_mfma_f32_16x16x32_bf16 v[208:211], a[220:223], v[108:111], v[208:211]
    v_exp_f32 v215, v215
    v_cvt_pk_bf16_f32 v136, v212, v213
    s_mul_i32 s7, s7, 18
    ds_read_b128 a[236:239], v11 offset:4096
    v_cvt_pk_bf16_f32 v137, v214, v215
    s_mul_i32 s49, s5, 18432
    s_add_u32 s49, s49, s45
    v_lshlrev_b32 v220, 6, v0
    v_mfma_f32_16x16x32_bf16 v[212:215], a[208:211], v[112:115], v[204:207]
    v_exp_f32 v208, v208
    v_mfma_f32_16x16x32_bf16 v[212:215], a[212:215], v[116:119], v[212:215]
    v_exp_f32 v209, v209
    v_mfma_f32_16x16x32_bf16 v[212:215], a[216:219], v[120:123], v[212:215]
    v_exp_f32 v210, v210
    v_mfma_f32_16x16x32_bf16 v[212:215], a[220:223], v[124:127], v[212:215]
    s_waitcnt lgkmcnt(3)
    v_exp_f32 v211, v211
    v_cvt_pk_bf16_f32 v144, v208, v209
    s_add_u32 s7, s7, s6
    ds_read_b128 a[208:211], v8 offset:8192
    v_cvt_pk_bf16_f32 v145, v210, v211
    buffer_load_dword v221, v220, s[20:23], s49 offen
    v_mfma_f32_16x16x32_bf16 v[208:211], a[224:227], v[64:67], v[192:195]
    s_waitcnt lgkmcnt(3)
    v_exp_f32 v212, v212
    v_mfma_f32_16x16x32_bf16 v[208:211], a[228:231], v[68:71], v[208:211]
    s_waitcnt lgkmcnt(2)
    v_exp_f32 v213, v213
    v_mfma_f32_16x16x32_bf16 v[208:211], a[232:235], v[72:75], v[208:211]
    s_waitcnt lgkmcnt(1)
    v_exp_f32 v214, v214
    v_mfma_f32_16x16x32_bf16 v[208:211], a[236:239], v[76:79], v[208:211]
    v_exp_f32 v215, v215
    v_cvt_pk_bf16_f32 v152, v212, v213
    s_lshl_b32 s58, s7, 6
    ds_read_b128 a[212:215], v9 offset:8192
    v_cvt_pk_bf16_f32 v153, v214, v215
    s_add_u32 s49, s49, 16384
    v_mfma_f32_16x16x32_bf16 v[212:215], a[224:227], v[80:83], v[196:199]
    s_nop 0
    v_exp_f32 v208, v208
    v_mfma_f32_16x16x32_bf16 v[212:215], a[228:231], v[84:87], v[212:215]
    v_exp_f32 v209, v209
    v_mfma_f32_16x16x32_bf16 v[212:215], a[232:235], v[88:91], v[212:215]
    v_exp_f32 v210, v210
    v_mfma_f32_16x16x32_bf16 v[212:215], a[236:239], v[92:95], v[212:215]
    v_exp_f32 v211, v211
    v_cvt_pk_bf16_f32 v130, v208, v209
    s_mul_i32 s59, s7, 36864
    ds_read_b128 a[216:219], v10 offset:8192
    v_cvt_pk_bf16_f32 v131, v210, v211
    buffer_load_dword v222, v220, s[20:23], s49 offen
    v_mfma_f32_16x16x32_bf16 v[208:211], a[224:227], v[96:99], v[200:203]
    s_nop 0
    v_exp_f32 v212, v212
    v_mfma_f32_16x16x32_bf16 v[208:211], a[228:231], v[100:103], v[208:211]
    v_exp_f32 v213, v213
    v_mfma_f32_16x16x32_bf16 v[208:211], a[232:235], v[104:107], v[208:211]
    v_exp_f32 v214, v214
    v_mfma_f32_16x16x32_bf16 v[208:211], a[236:239], v[108:111], v[208:211]
    v_exp_f32 v215, v215
    v_cvt_pk_bf16_f32 v138, v212, v213
    s_cmp_lt_u32 s6, 18
    s_cselect_b32 s7, 0, 2147483648
    ds_read_b128 a[220:223], v11 offset:8192
    v_cvt_pk_bf16_f32 v139, v214, v215
    s_mov_b32 s39, 221184
    s_mov_b32 s38, 27648
    v_mfma_f32_16x16x32_bf16 v[212:215], a[224:227], v[112:115], v[204:207]
    v_exp_f32 v208, v208
    v_mfma_f32_16x16x32_bf16 v[212:215], a[228:231], v[116:119], v[212:215]
    v_exp_f32 v209, v209
    v_mfma_f32_16x16x32_bf16 v[212:215], a[232:235], v[120:123], v[212:215]
    v_exp_f32 v210, v210
    v_mfma_f32_16x16x32_bf16 v[212:215], a[236:239], v[124:127], v[212:215]
    s_waitcnt lgkmcnt(3)
    v_exp_f32 v211, v211
    v_cvt_pk_bf16_f32 v146, v208, v209
    s_or_b32 s58, s58, s7
    ds_read_b128 a[224:227], v8 offset:12288
    v_cvt_pk_bf16_f32 v147, v210, v211
    v_mfma_f32_16x16x32_bf16 v[208:211], a[208:211], v[64:67], v[192:195]
    s_waitcnt lgkmcnt(3)
    v_exp_f32 v212, v212
    v_mfma_f32_16x16x32_bf16 v[208:211], a[212:215], v[68:71], v[208:211]
    s_waitcnt lgkmcnt(2)
    v_exp_f32 v213, v213
    v_mfma_f32_16x16x32_bf16 v[208:211], a[216:219], v[72:75], v[208:211]
    s_waitcnt lgkmcnt(1)
    v_exp_f32 v214, v214
    v_mfma_f32_16x16x32_bf16 v[208:211], a[220:223], v[76:79], v[208:211]
    v_exp_f32 v215, v215
    v_cvt_pk_bf16_f32 v154, v212, v213
    s_or_b32 s59, s59, s7
    ds_read_b128 a[228:231], v9 offset:12288
    v_cvt_pk_bf16_f32 v155, v214, v215
    v_mfma_f32_16x16x32_bf16 v[212:215], a[208:211], v[80:83], v[196:199]
    s_nop 1
    v_exp_f32 v208, v208
    v_mfma_f32_16x16x32_bf16 v[212:215], a[212:215], v[84:87], v[212:215]
    v_exp_f32 v209, v209
    v_mfma_f32_16x16x32_bf16 v[212:215], a[216:219], v[88:91], v[212:215]
    v_exp_f32 v210, v210
    v_mfma_f32_16x16x32_bf16 v[212:215], a[220:223], v[92:95], v[212:215]
    v_exp_f32 v211, v211
    v_cvt_pk_bf16_f32 v132, v208, v209
    v_lshrrev_b32 v51, 2, v0
    ds_read_b128 a[232:235], v10 offset:12288
    v_cvt_pk_bf16_f32 v133, v210, v211
    v_mfma_f32_16x16x32_bf16 v[208:211], a[208:211], v[96:99], v[200:203]
    s_nop 1
    v_exp_f32 v212, v212
    v_mfma_f32_16x16x32_bf16 v[208:211], a[212:215], v[100:103], v[208:211]
    v_exp_f32 v213, v213
    v_mfma_f32_16x16x32_bf16 v[208:211], a[216:219], v[104:107], v[208:211]
    v_exp_f32 v214, v214
    v_mfma_f32_16x16x32_bf16 v[208:211], a[220:223], v[108:111], v[208:211]
    v_exp_f32 v215, v215
    v_cvt_pk_bf16_f32 v140, v212, v213
    v_mul_u32_u24 v51, 9216, v51
    ds_read_b128 a[236:239], v11 offset:12288
    v_cvt_pk_bf16_f32 v141, v214, v215
    s_waitcnt vmcnt(6)
    s_barrier
    v_mfma_f32_16x16x32_bf16 v[212:215], a[208:211], v[112:115], v[204:207]
    v_exp_f32 v208, v208
    v_mfma_f32_16x16x32_bf16 v[212:215], a[212:215], v[116:119], v[212:215]
    s_add_u32 m0, s42, 49152
    v_exp_f32 v209, v209
    v_mfma_f32_16x16x32_bf16 v[212:215], a[216:219], v[120:123], v[212:215]
    v_exp_f32 v210, v210
    v_mfma_f32_16x16x32_bf16 v[212:215], a[220:223], v[124:127], v[212:215]
    s_waitcnt lgkmcnt(3)
    v_exp_f32 v211, v211
    v_cvt_pk_bf16_f32 v148, v208, v209
    v_and_b32 v254, 3, v0
    ds_read_b128 a[208:211], v8 offset:16384
    v_cvt_pk_bf16_f32 v149, v210, v211
    buffer_load_dwordx4 v36, s[8:11], s40 offen lds
    v_mfma_f32_16x16x32_bf16 v[208:211], a[224:227], v[64:67], v[192:195]
    s_waitcnt lgkmcnt(3)
    v_exp_f32 v212, v212
    v_mfma_f32_16x16x32_bf16 v[208:211], a[228:231], v[68:71], v[208:211]
    s_waitcnt lgkmcnt(2)
    v_exp_f32 v213, v213
    v_mfma_f32_16x16x32_bf16 v[208:211], a[232:235], v[72:75], v[208:211]
    s_waitcnt lgkmcnt(1)
    v_exp_f32 v214, v214
    v_mfma_f32_16x16x32_bf16 v[208:211], a[236:239], v[76:79], v[208:211]
    v_exp_f32 v215, v215
    v_cvt_pk_bf16_f32 v156, v212, v213
    v_lshl_add_u32 v254, v254, 4, v51
    ds_read_b128 a[212:215], v9 offset:16384
    v_cvt_pk_bf16_f32 v157, v214, v215
    v_mfma_f32_16x16x32_bf16 v[212:215], a[224:227], v[80:83], v[196:199]
    s_nop 1
    v_exp_f32 v208, v208
    v_mfma_f32_16x16x32_bf16 v[212:215], a[228:231], v[84:87], v[212:215]
    v_exp_f32 v209, v209
    v_mfma_f32_16x16x32_bf16 v[212:215], a[232:235], v[88:91], v[212:215]
    v_exp_f32 v210, v210
    v_mfma_f32_16x16x32_bf16 v[212:215], a[236:239], v[92:95], v[212:215]
    v_exp_f32 v211, v211
    ds_read_b64_tr_b16 a[160:161], v20 offset:0
    v_cvt_pk_bf16_f32 v134, v208, v209
    ds_read_b64_tr_b16 a[162:163], v20 offset:4096
    v_lshlrev_b32 v255, 4, v0
    ds_read_b128 a[216:219], v10 offset:16384
    v_cvt_pk_bf16_f32 v135, v210, v211
    buffer_load_dwordx4 v37, s[8:11], s40 offen offset:1024 lds
    v_mfma_f32_16x16x32_bf16 v[208:211], a[224:227], v[96:99], v[200:203]
    v_exp_f32 v212, v212
    v_mfma_f32_16x16x32_bf16 v[208:211], a[228:231], v[100:103], v[208:211]
    v_exp_f32 v213, v213
    v_mfma_f32_16x16x32_bf16 v[208:211], a[232:235], v[104:107], v[208:211]
    v_exp_f32 v214, v214
    v_mfma_f32_16x16x32_bf16 v[208:211], a[236:239], v[108:111], v[208:211]
    v_exp_f32 v215, v215
    ds_read_b64_tr_b16 a[164:165], v20 offset:8192
    v_cvt_pk_bf16_f32 v142, v212, v213
    ds_read_b64_tr_b16 a[166:167], v20 offset:12288
    v_add_u32 v51, 98304, v255
    ds_read_b128 a[220:223], v11 offset:16384
    v_cvt_pk_bf16_f32 v143, v214, v215
    v_mfma_f32_16x16x32_bf16 v[212:215], a[224:227], v[112:115], v[204:207]
    v_exp_f32 v208, v208
    v_mfma_f32_16x16x32_bf16 v[212:215], a[228:231], v[116:119], v[212:215]
    v_exp_f32 v209, v209
    v_mfma_f32_16x16x32_bf16 v[212:215], a[232:235], v[120:123], v[212:215]
    v_exp_f32 v210, v210
    v_mfma_f32_16x16x32_bf16 v[212:215], a[236:239], v[124:127], v[212:215]
    v_exp_f32 v211, v211
    ds_read_b64_tr_b16 a[168:169], v21 offset:0
    v_cvt_pk_bf16_f32 v150, v208, v209
    ds_read_b64_tr_b16 a[170:171], v21 offset:4096
    ds_read_b128 a[224:227], v8 offset:20480
    v_cvt_pk_bf16_f32 v151, v210, v211
    s_waitcnt lgkmcnt(3)
    buffer_load_dwordx4 v38, s[8:11], s40 offen offset:2048 lds
Lattn_loop:
    v_mfma_f32_16x16x32_bf16 v[208:211], a[208:211], v[64:67], v[192:195]
    v_exp_f32 v212, v212
    v_mfma_f32_16x16x32_bf16 v[208:211], a[212:215], v[68:71], v[208:211]
    v_exp_f32 v213, v213
    v_mfma_f32_16x16x32_bf16 v[208:211], a[216:219], v[72:75], v[208:211]
    v_exp_f32 v214, v214
    v_mfma_f32_16x16x32_bf16 v[208:211], a[220:223], v[76:79], v[208:211]
    v_exp_f32 v215, v215
    v_mfma_f32_16x16x32_bf16 a[0:3], a[160:163], v[128:131], a[0:3]
    ds_read_b64_tr_b16 a[172:173], v21 offset:8192
    v_cvt_pk_bf16_f32 v158, v212, v213
    v_mfma_f32_16x16x32_bf16 a[0:3], a[164:167], v[132:135], a[0:3]
    ds_read_b64_tr_b16 a[174:175], v21 offset:12288
    v_mfma_f32_16x16x32_bf16 a[4:7], a[160:163], v[136:139], a[4:7]
    ds_read_b128 a[228:231], v9 offset:20480
    v_cvt_pk_bf16_f32 v159, v214, v215
    v_mfma_f32_16x16x32_bf16 a[4:7], a[164:167], v[140:143], a[4:7]
    v_mfma_f32_16x16x32_bf16 v[212:215], a[208:211], v[80:83], v[196:199]
    v_exp_f32 v208, v208
    v_mfma_f32_16x16x32_bf16 v[212:215], a[212:215], v[84:87], v[212:215]
    v_exp_f32 v209, v209
    v_mfma_f32_16x16x32_bf16 v[212:215], a[216:219], v[88:91], v[212:215]
    v_exp_f32 v210, v210
    v_mfma_f32_16x16x32_bf16 v[212:215], a[220:223], v[92:95], v[212:215]
    v_exp_f32 v211, v211
    v_mfma_f32_16x16x32_bf16 a[8:11], a[160:163], v[144:147], a[8:11]
    ds_read_b64_tr_b16 a[176:177], v22 offset:0
    v_cvt_pk_bf16_f32 v160, v208, v209
    v_mfma_f32_16x16x32_bf16 a[8:11], a[164:167], v[148:151], a[8:11]
    ds_read_b64_tr_b16 a[178:179], v22 offset:4096
    v_mfma_f32_16x16x32_bf16 a[12:15], a[160:163], v[152:155], a[12:15]
    ds_read_b128 a[232:235], v10 offset:20480
    v_cvt_pk_bf16_f32 v161, v210, v211
    v_mfma_f32_16x16x32_bf16 a[12:15], a[164:167], v[156:159], a[12:15]
    s_waitcnt lgkmcnt(3)
    buffer_load_dwordx4 v39, s[8:11], s40 offen offset:3072 lds
    v_mfma_f32_16x16x32_bf16 v[208:211], a[208:211], v[96:99], v[200:203]
    v_exp_f32 v212, v212
    v_mfma_f32_16x16x32_bf16 v[208:211], a[212:215], v[100:103], v[208:211]
    s_add_u32 s40, s40, 16384
    v_exp_f32 v213, v213
    v_mfma_f32_16x16x32_bf16 v[208:211], a[216:219], v[104:107], v[208:211]
    v_exp_f32 v214, v214
    v_mfma_f32_16x16x32_bf16 v[208:211], a[220:223], v[108:111], v[208:211]
    v_exp_f32 v215, v215
    v_mfma_f32_16x16x32_bf16 a[16:19], a[168:171], v[128:131], a[16:19]
    ds_read_b64_tr_b16 a[180:181], v22 offset:8192
    v_cvt_pk_bf16_f32 v168, v212, v213
    v_mfma_f32_16x16x32_bf16 a[16:19], a[172:175], v[132:135], a[16:19]
    ds_read_b64_tr_b16 a[182:183], v22 offset:12288
    v_mfma_f32_16x16x32_bf16 a[20:23], a[168:171], v[136:139], a[20:23]
    ds_read_b128 a[236:239], v11 offset:20480
    v_cvt_pk_bf16_f32 v169, v214, v215
    v_mfma_f32_16x16x32_bf16 a[20:23], a[172:175], v[140:143], a[20:23]
    v_smfmac_f32_16x16x64_bf16 a[192:195], v[52:55], v[128:135], v50
    v_mfma_f32_16x16x32_bf16 v[212:215], a[208:211], v[112:115], v[204:207]
    v_exp_f32 v208, v208
    v_mfma_f32_16x16x32_bf16 v[212:215], a[212:215], v[116:119], v[212:215]
    s_add_u32 m0, s42, 98304
    v_exp_f32 v209, v209
    v_mfma_f32_16x16x32_bf16 v[212:215], a[216:219], v[120:123], v[212:215]
    v_exp_f32 v210, v210
    v_mfma_f32_16x16x32_bf16 v[212:215], a[220:223], v[124:127], v[212:215]
    v_exp_f32 v211, v211
    v_mfma_f32_16x16x32_bf16 a[24:27], a[168:171], v[144:147], a[24:27]
    ds_read_b64_tr_b16 a[184:185], v23 offset:0
    v_cvt_pk_bf16_f32 v176, v208, v209
    v_mfma_f32_16x16x32_bf16 a[24:27], a[172:175], v[148:151], a[24:27]
    ds_read_b64_tr_b16 a[186:187], v23 offset:4096
    v_mfma_f32_16x16x32_bf16 a[28:31], a[168:171], v[152:155], a[28:31]
    ds_read_b128 a[208:211], v8 offset:24576
    v_cvt_pk_bf16_f32 v177, v210, v211
    v_mfma_f32_16x16x32_bf16 a[28:31], a[172:175], v[156:159], a[28:31]
    s_waitcnt lgkmcnt(3)
    buffer_load_dwordx4 v40, s[12:15], s41 offen lds
    v_mfma_f32_16x16x32_bf16 v[208:211], a[224:227], v[64:67], v[192:195]
    v_exp_f32 v212, v212
    v_mfma_f32_16x16x32_bf16 v[208:211], a[228:231], v[68:71], v[208:211]
    v_exp_f32 v213, v213
    v_mfma_f32_16x16x32_bf16 v[208:211], a[232:235], v[72:75], v[208:211]
    v_exp_f32 v214, v214
    v_mfma_f32_16x16x32_bf16 v[208:211], a[236:239], v[76:79], v[208:211]
    v_exp_f32 v215, v215
    v_mfma_f32_16x16x32_bf16 a[32:35], a[176:179], v[128:131], a[32:35]
    ds_read_b64_tr_b16 a[188:189], v23 offset:8192
    v_cvt_pk_bf16_f32 v184, v212, v213
    v_mfma_f32_16x16x32_bf16 a[32:35], a[180:183], v[132:135], a[32:35]
    ds_read_b64_tr_b16 a[190:191], v23 offset:12288
    v_mfma_f32_16x16x32_bf16 a[36:39], a[176:179], v[136:139], a[36:39]
    ds_read_b128 a[212:215], v9 offset:24576
    v_cvt_pk_bf16_f32 v185, v214, v215
    v_mfma_f32_16x16x32_bf16 a[36:39], a[180:183], v[140:143], a[36:39]
    v_smfmac_f32_16x16x64_bf16 a[196:199], v[52:55], v[136:143], v50
    v_mfma_f32_16x16x32_bf16 v[212:215], a[224:227], v[80:83], v[196:199]
    v_exp_f32 v208, v208
    v_mfma_f32_16x16x32_bf16 v[212:215], a[228:231], v[84:87], v[212:215]
    v_exp_f32 v209, v209
    v_mfma_f32_16x16x32_bf16 v[212:215], a[232:235], v[88:91], v[212:215]
    v_exp_f32 v210, v210
    v_mfma_f32_16x16x32_bf16 v[212:215], a[236:239], v[92:95], v[212:215]
    v_exp_f32 v211, v211
    v_mfma_f32_16x16x32_bf16 a[40:43], a[176:179], v[144:147], a[40:43]
    ds_read_b64_tr_b16 a[160:161], v24 offset:0
    v_cvt_pk_bf16_f32 v162, v208, v209
    v_mfma_f32_16x16x32_bf16 a[40:43], a[180:183], v[148:151], a[40:43]
    ds_read_b64_tr_b16 a[162:163], v24 offset:4096
    v_mfma_f32_16x16x32_bf16 a[44:47], a[176:179], v[152:155], a[44:47]
    ds_read_b128 a[216:219], v10 offset:24576
    v_cvt_pk_bf16_f32 v163, v210, v211
    v_mfma_f32_16x16x32_bf16 a[44:47], a[180:183], v[156:159], a[44:47]
    s_waitcnt lgkmcnt(3)
    buffer_load_dwordx4 v41, s[12:15], s41 offen offset:1024 lds
    v_mfma_f32_16x16x32_bf16 v[208:211], a[224:227], v[96:99], v[200:203]
    v_exp_f32 v212, v212
    v_mfma_f32_16x16x32_bf16 v[208:211], a[228:231], v[100:103], v[208:211]
    v_exp_f32 v213, v213
    v_mfma_f32_16x16x32_bf16 v[208:211], a[232:235], v[104:107], v[208:211]
    v_exp_f32 v214, v214
    v_mfma_f32_16x16x32_bf16 v[208:211], a[236:239], v[108:111], v[208:211]
    v_exp_f32 v215, v215
    v_mfma_f32_16x16x32_bf16 a[48:51], a[184:187], v[128:131], a[48:51]
    ds_read_b64_tr_b16 a[164:165], v24 offset:8192
    v_cvt_pk_bf16_f32 v170, v212, v213
    v_mfma_f32_16x16x32_bf16 a[48:51], a[188:191], v[132:135], a[48:51]
    ds_read_b64_tr_b16 a[166:167], v24 offset:12288
    v_mfma_f32_16x16x32_bf16 a[52:55], a[184:187], v[136:139], a[52:55]
    ds_read_b128 a[220:223], v11 offset:24576
    v_cvt_pk_bf16_f32 v171, v214, v215
    v_mfma_f32_16x16x32_bf16 a[52:55], a[188:191], v[140:143], a[52:55]
    v_smfmac_f32_16x16x64_bf16 a[200:203], v[52:55], v[144:151], v50
    v_mfma_f32_16x16x32_bf16 v[212:215], a[224:227], v[112:115], v[204:207]
    v_exp_f32 v208, v208
    v_mfma_f32_16x16x32_bf16 v[212:215], a[228:231], v[116:119], v[212:215]
    v_exp_f32 v209, v209
    v_mfma_f32_16x16x32_bf16 v[212:215], a[232:235], v[120:123], v[212:215]
    v_exp_f32 v210, v210
    v_mfma_f32_16x16x32_bf16 v[212:215], a[236:239], v[124:127], v[212:215]
    v_exp_f32 v211, v211
    v_mfma_f32_16x16x32_bf16 a[56:59], a[184:187], v[144:147], a[56:59]
    ds_read_b64_tr_b16 a[168:169], v25 offset:0
    v_cvt_pk_bf16_f32 v178, v208, v209
    v_mfma_f32_16x16x32_bf16 a[56:59], a[188:191], v[148:151], a[56:59]
    ds_read_b64_tr_b16 a[170:171], v25 offset:4096
    v_mfma_f32_16x16x32_bf16 a[60:63], a[184:187], v[152:155], a[60:63]
    ds_read_b128 a[224:227], v8 offset:28672
    v_cvt_pk_bf16_f32 v179, v210, v211
    v_mfma_f32_16x16x32_bf16 a[60:63], a[188:191], v[156:159], a[60:63]
    s_waitcnt lgkmcnt(3)
    buffer_load_dwordx4 v40, s[12:15], s41 offen offset:2048 lds
    v_mfma_f32_16x16x32_bf16 v[208:211], a[208:211], v[64:67], v[192:195]
    v_exp_f32 v212, v212
    v_mfma_f32_16x16x32_bf16 v[208:211], a[212:215], v[68:71], v[208:211]
    v_exp_f32 v213, v213
    v_mfma_f32_16x16x32_bf16 v[208:211], a[216:219], v[72:75], v[208:211]
    v_exp_f32 v214, v214
    v_mfma_f32_16x16x32_bf16 v[208:211], a[220:223], v[76:79], v[208:211]
    v_exp_f32 v215, v215
    v_mfma_f32_16x16x32_bf16 a[64:67], a[160:163], v[128:131], a[64:67]
    ds_read_b64_tr_b16 a[172:173], v25 offset:8192
    v_cvt_pk_bf16_f32 v186, v212, v213
    v_mfma_f32_16x16x32_bf16 a[64:67], a[164:167], v[132:135], a[64:67]
    ds_read_b64_tr_b16 a[174:175], v25 offset:12288
    v_mfma_f32_16x16x32_bf16 a[68:71], a[160:163], v[136:139], a[68:71]
    ds_read_b128 a[228:231], v9 offset:28672
    v_cvt_pk_bf16_f32 v187, v214, v215
    v_mfma_f32_16x16x32_bf16 a[68:71], a[164:167], v[140:143], a[68:71]
    v_smfmac_f32_16x16x64_bf16 a[204:207], v[52:55], v[152:159], v50
    v_mfma_f32_16x16x32_bf16 v[212:215], a[208:211], v[80:83], v[196:199]
    v_exp_f32 v208, v208
    v_mfma_f32_16x16x32_bf16 v[212:215], a[212:215], v[84:87], v[212:215]
    v_exp_f32 v209, v209
    v_mfma_f32_16x16x32_bf16 v[212:215], a[216:219], v[88:91], v[212:215]
    v_exp_f32 v210, v210
    v_mfma_f32_16x16x32_bf16 v[212:215], a[220:223], v[92:95], v[212:215]
    v_exp_f32 v211, v211
    v_mfma_f32_16x16x32_bf16 a[72:75], a[160:163], v[144:147], a[72:75]
    ds_read_b64_tr_b16 a[176:177], v26 offset:0
    v_cvt_pk_bf16_f32 v164, v208, v209
    v_mfma_f32_16x16x32_bf16 a[72:75], a[164:167], v[148:151], a[72:75]
    ds_read_b64_tr_b16 a[178:179], v26 offset:4096
    v_mfma_f32_16x16x32_bf16 a[76:79], a[160:163], v[152:155], a[76:79]
    ds_read_b128 a[232:235], v10 offset:28672
    v_cvt_pk_bf16_f32 v165, v210, v211
    v_mfma_f32_16x16x32_bf16 a[76:79], a[164:167], v[156:159], a[76:79]
    s_waitcnt lgkmcnt(3)
    buffer_load_dwordx4 v41, s[12:15], s41 offen offset:3072 lds
    v_mfma_f32_16x16x32_bf16 v[208:211], a[208:211], v[96:99], v[200:203]
    v_exp_f32 v212, v212
    v_mfma_f32_16x16x32_bf16 v[208:211], a[212:215], v[100:103], v[208:211]
    s_add_u32 s41, s41, 16384
    v_exp_f32 v213, v213
    v_mfma_f32_16x16x32_bf16 v[208:211], a[216:219], v[104:107], v[208:211]
    v_exp_f32 v214, v214
    v_mfma_f32_16x16x32_bf16 v[208:211], a[220:223], v[108:111], v[208:211]
    v_exp_f32 v215, v215
    v_mfma_f32_16x16x32_bf16 a[80:83], a[168:171], v[128:131], a[80:83]
    ds_read_b64_tr_b16 a[180:181], v26 offset:8192
    v_cvt_pk_bf16_f32 v172, v212, v213
    v_mfma_f32_16x16x32_bf16 a[80:83], a[172:175], v[132:135], a[80:83]
    ds_read_b64_tr_b16 a[182:183], v26 offset:12288
    v_mfma_f32_16x16x32_bf16 a[84:87], a[168:171], v[136:139], a[84:87]
    ds_read_b128 a[236:239], v11 offset:28672
    v_cvt_pk_bf16_f32 v173, v214, v215
    v_mfma_f32_16x16x32_bf16 a[84:87], a[172:175], v[140:143], a[84:87]
    s_waitcnt vmcnt(8)
    s_barrier
    v_mfma_f32_16x16x32_bf16 v[212:215], a[208:211], v[112:115], v[204:207]
    v_exp_f32 v208, v208
    v_mfma_f32_16x16x32_bf16 v[212:215], a[212:215], v[116:119], v[212:215]
    s_add_u32 m0, s42, 0
    v_exp_f32 v209, v209
    v_mfma_f32_16x16x32_bf16 v[212:215], a[216:219], v[120:123], v[212:215]
    v_exp_f32 v210, v210
    v_mfma_f32_16x16x32_bf16 v[212:215], a[220:223], v[124:127], v[212:215]
    v_exp_f32 v211, v211
    v_mfma_f32_16x16x32_bf16 a[88:91], a[168:171], v[144:147], a[88:91]
    ds_read_b64_tr_b16 a[184:185], v27 offset:0
    v_cvt_pk_bf16_f32 v180, v208, v209
    v_mfma_f32_16x16x32_bf16 a[88:91], a[172:175], v[148:151], a[88:91]
    ds_read_b64_tr_b16 a[186:187], v27 offset:4096
    v_mfma_f32_16x16x32_bf16 a[92:95], a[168:171], v[152:155], a[92:95]
    ds_read_b128 a[208:211], v8 offset:32768
    v_cvt_pk_bf16_f32 v181, v210, v211
    v_mfma_f32_16x16x32_bf16 a[92:95], a[172:175], v[156:159], a[92:95]
    s_waitcnt lgkmcnt(3)
    buffer_load_dwordx4 v36, s[8:11], s40 offen lds
    v_mfma_f32_16x16x32_bf16 v[208:211], a[224:227], v[64:67], v[192:195]
    v_exp_f32 v212, v212
    v_mfma_f32_16x16x32_bf16 v[208:211], a[228:231], v[68:71], v[208:211]
    v_exp_f32 v213, v213
    v_mfma_f32_16x16x32_bf16 v[208:211], a[232:235], v[72:75], v[208:211]
    v_exp_f32 v214, v214
    v_mfma_f32_16x16x32_bf16 v[208:211], a[236:239], v[76:79], v[208:211]
    v_exp_f32 v215, v215
    v_mfma_f32_16x16x32_bf16 a[96:99], a[176:179], v[128:131], a[96:99]
    ds_read_b64_tr_b16 a[188:189], v27 offset:8192
    v_cvt_pk_bf16_f32 v188, v212, v213
    v_mfma_f32_16x16x32_bf16 a[96:99], a[180:183], v[132:135], a[96:99]
    ds_read_b64_tr_b16 a[190:191], v27 offset:12288
    v_mfma_f32_16x16x32_bf16 a[100:103], a[176:179], v[136:139], a[100:103]
    ds_read_b128 a[212:215], v9 offset:32768
    v_cvt_pk_bf16_f32 v189, v214, v215
    v_mfma_f32_16x16x32_bf16 a[100:103], a[180:183], v[140:143], a[100:103]
    buffer_load_dword v217, v57, s[32:35], s39 offen
    v_mfma_f32_16x16x32_bf16 v[212:215], a[224:227], v[80:83], v[196:199]
    v_exp_f32 v208, v208
    v_mfma_f32_16x16x32_bf16 v[212:215], a[228:231], v[84:87], v[212:215]
    v_exp_f32 v209, v209
    v_mfma_f32_16x16x32_bf16 v[212:215], a[232:235], v[88:91], v[212:215]
    v_exp_f32 v210, v210
    v_mfma_f32_16x16x32_bf16 v[212:215], a[236:239], v[92:95], v[212:215]
    v_exp_f32 v211, v211
    v_mfma_f32_16x16x32_bf16 a[104:107], a[176:179], v[144:147], a[104:107]
    ds_read_b64_tr_b16 a[160:161], v20 offset:16384
    v_cvt_pk_bf16_f32 v166, v208, v209
    v_mfma_f32_16x16x32_bf16 a[104:107], a[180:183], v[148:151], a[104:107]
    ds_read_b64_tr_b16 a[162:163], v20 offset:20480
    v_mfma_f32_16x16x32_bf16 a[108:111], a[176:179], v[152:155], a[108:111]
    ds_read_b128 a[216:219], v10 offset:32768
    v_cvt_pk_bf16_f32 v167, v210, v211
    v_mfma_f32_16x16x32_bf16 a[108:111], a[180:183], v[156:159], a[108:111]
    s_waitcnt lgkmcnt(3)
    buffer_load_dwordx4 v37, s[8:11], s40 offen offset:1024 lds
    v_mfma_f32_16x16x32_bf16 v[208:211], a[224:227], v[96:99], v[200:203]
    v_exp_f32 v212, v212
    v_mfma_f32_16x16x32_bf16 v[208:211], a[228:231], v[100:103], v[208:211]
    v_exp_f32 v213, v213
    v_mfma_f32_16x16x32_bf16 v[208:211], a[232:235], v[104:107], v[208:211]
    v_exp_f32 v214, v214
    v_mfma_f32_16x16x32_bf16 v[208:211], a[236:239], v[108:111], v[208:211]
    v_exp_f32 v215, v215
    v_mfma_f32_16x16x32_bf16 a[112:115], a[184:187], v[128:131], a[112:115]
    ds_read_b64_tr_b16 a[164:165], v20 offset:24576
    v_cvt_pk_bf16_f32 v174, v212, v213
    v_mfma_f32_16x16x32_bf16 a[112:115], a[188:191], v[132:135], a[112:115]
    ds_read_b64_tr_b16 a[166:167], v20 offset:28672
    v_mfma_f32_16x16x32_bf16 a[116:119], a[184:187], v[136:139], a[116:119]
    ds_read_b128 a[220:223], v11 offset:32768
    v_cvt_pk_bf16_f32 v175, v214, v215
    v_mfma_f32_16x16x32_bf16 a[116:119], a[188:191], v[140:143], a[116:119]
    v_mfma_f32_16x16x32_bf16 v[212:215], a[224:227], v[112:115], v[204:207]
    v_exp_f32 v208, v208
    v_mfma_f32_16x16x32_bf16 v[212:215], a[228:231], v[116:119], v[212:215]
    v_exp_f32 v209, v209
    v_mfma_f32_16x16x32_bf16 v[212:215], a[232:235], v[120:123], v[212:215]
    v_exp_f32 v210, v210
    v_mfma_f32_16x16x32_bf16 v[212:215], a[236:239], v[124:127], v[212:215]
    v_exp_f32 v211, v211
    v_mfma_f32_16x16x32_bf16 a[120:123], a[184:187], v[144:147], a[120:123]
    ds_read_b64_tr_b16 a[168:169], v21 offset:16384
    v_cvt_pk_bf16_f32 v182, v208, v209
    v_mfma_f32_16x16x32_bf16 a[120:123], a[188:191], v[148:151], a[120:123]
    ds_read_b64_tr_b16 a[170:171], v21 offset:20480
    v_mfma_f32_16x16x32_bf16 a[124:127], a[184:187], v[152:155], a[124:127]
    ds_read_b128 a[224:227], v8 offset:36864
    v_cvt_pk_bf16_f32 v183, v210, v211
    v_mfma_f32_16x16x32_bf16 a[124:127], a[188:191], v[156:159], a[124:127]
    s_waitcnt lgkmcnt(3)
    buffer_load_dwordx4 v38, s[8:11], s40 offen offset:2048 lds
    v_mfma_f32_16x16x32_bf16 v[208:211], a[208:211], v[64:67], v[192:195]
    v_exp_f32 v212, v212
    v_mfma_f32_16x16x32_bf16 v[208:211], a[212:215], v[68:71], v[208:211]
    v_exp_f32 v213, v213
    v_mfma_f32_16x16x32_bf16 v[208:211], a[216:219], v[72:75], v[208:211]
    v_exp_f32 v214, v214
    v_mfma_f32_16x16x32_bf16 v[208:211], a[220:223], v[76:79], v[208:211]
    v_exp_f32 v215, v215
    v_mfma_f32_16x16x32_bf16 a[0:3], a[160:163], v[160:163], a[0:3]
    ds_read_b64_tr_b16 a[172:173], v21 offset:24576
    v_cvt_pk_bf16_f32 v190, v212, v213
    v_mfma_f32_16x16x32_bf16 a[0:3], a[164:167], v[164:167], a[0:3]
    ds_read_b64_tr_b16 a[174:175], v21 offset:28672
    v_mfma_f32_16x16x32_bf16 a[4:7], a[160:163], v[168:171], a[4:7]
    ds_read_b128 a[228:231], v9 offset:36864
    v_cvt_pk_bf16_f32 v191, v214, v215
    v_mfma_f32_16x16x32_bf16 a[4:7], a[164:167], v[172:175], a[4:7]
    v_mfma_f32_16x16x32_bf16 v[212:215], a[208:211], v[80:83], v[196:199]
    v_exp_f32 v208, v208
    v_mfma_f32_16x16x32_bf16 v[212:215], a[212:215], v[84:87], v[212:215]
    v_exp_f32 v209, v209
    v_mfma_f32_16x16x32_bf16 v[212:215], a[216:219], v[88:91], v[212:215]
    v_exp_f32 v210, v210
    v_mfma_f32_16x16x32_bf16 v[212:215], a[220:223], v[92:95], v[212:215]
    v_exp_f32 v211, v211
    v_mfma_f32_16x16x32_bf16 a[8:11], a[160:163], v[176:179], a[8:11]
    ds_read_b64_tr_b16 a[176:177], v22 offset:16384
    v_cvt_pk_bf16_f32 v128, v208, v209
    v_mfma_f32_16x16x32_bf16 a[8:11], a[164:167], v[180:183], a[8:11]
    ds_read_b64_tr_b16 a[178:179], v22 offset:20480
    v_mfma_f32_16x16x32_bf16 a[12:15], a[160:163], v[184:187], a[12:15]
    ds_read_b128 a[232:235], v10 offset:36864
    v_cvt_pk_bf16_f32 v129, v210, v211
    v_mfma_f32_16x16x32_bf16 a[12:15], a[164:167], v[188:191], a[12:15]
    s_waitcnt lgkmcnt(3)
    buffer_load_dwordx4 v39, s[8:11], s40 offen offset:3072 lds
    v_mfma_f32_16x16x32_bf16 v[208:211], a[208:211], v[96:99], v[200:203]
    v_exp_f32 v212, v212
    v_mfma_f32_16x16x32_bf16 v[208:211], a[212:215], v[100:103], v[208:211]
    s_add_u32 s40, s40, 16384
    v_exp_f32 v213, v213
    v_mfma_f32_16x16x32_bf16 v[208:211], a[216:219], v[104:107], v[208:211]
    v_exp_f32 v214, v214
    v_mfma_f32_16x16x32_bf16 v[208:211], a[220:223], v[108:111], v[208:211]
    v_exp_f32 v215, v215
    v_mfma_f32_16x16x32_bf16 a[16:19], a[168:171], v[160:163], a[16:19]
    ds_read_b64_tr_b16 a[180:181], v22 offset:24576
    v_cvt_pk_bf16_f32 v136, v212, v213
    v_mfma_f32_16x16x32_bf16 a[16:19], a[172:175], v[164:167], a[16:19]
    ds_read_b64_tr_b16 a[182:183], v22 offset:28672
    v_mfma_f32_16x16x32_bf16 a[20:23], a[168:171], v[168:171], a[20:23]
    ds_read_b128 a[236:239], v11 offset:36864
    v_cvt_pk_bf16_f32 v137, v214, v215
    v_mfma_f32_16x16x32_bf16 a[20:23], a[172:175], v[172:175], a[20:23]
    v_smfmac_f32_16x16x64_bf16 a[192:195], v[52:55], v[160:167], v50
    v_mfma_f32_16x16x32_bf16 v[212:215], a[208:211], v[112:115], v[204:207]
    v_exp_f32 v208, v208
    v_mfma_f32_16x16x32_bf16 v[212:215], a[212:215], v[116:119], v[212:215]
    s_add_u32 m0, s42, 114688
    v_exp_f32 v209, v209
    v_mfma_f32_16x16x32_bf16 v[212:215], a[216:219], v[120:123], v[212:215]
    v_exp_f32 v210, v210
    v_mfma_f32_16x16x32_bf16 v[212:215], a[220:223], v[124:127], v[212:215]
    v_exp_f32 v211, v211
    v_mfma_f32_16x16x32_bf16 a[24:27], a[168:171], v[176:179], a[24:27]
    ds_read_b64_tr_b16 a[184:185], v23 offset:16384
    v_cvt_pk_bf16_f32 v144, v208, v209
    v_mfma_f32_16x16x32_bf16 a[24:27], a[172:175], v[180:183], a[24:27]
    ds_read_b64_tr_b16 a[186:187], v23 offset:20480
    v_mfma_f32_16x16x32_bf16 a[28:31], a[168:171], v[184:187], a[28:31]
    ds_read_b128 a[208:211], v8 offset:40960
    v_cvt_pk_bf16_f32 v145, v210, v211
    v_mfma_f32_16x16x32_bf16 a[28:31], a[172:175], v[188:191], a[28:31]
    s_waitcnt lgkmcnt(3)
    buffer_load_dwordx4 v40, s[12:15], s41 offen lds
    v_mfma_f32_16x16x32_bf16 v[208:211], a[224:227], v[64:67], v[192:195]
    v_exp_f32 v212, v212
    v_mfma_f32_16x16x32_bf16 v[208:211], a[228:231], v[68:71], v[208:211]
    v_exp_f32 v213, v213
    v_mfma_f32_16x16x32_bf16 v[208:211], a[232:235], v[72:75], v[208:211]
    v_exp_f32 v214, v214
    v_mfma_f32_16x16x32_bf16 v[208:211], a[236:239], v[76:79], v[208:211]
    v_exp_f32 v215, v215
    v_mfma_f32_16x16x32_bf16 a[32:35], a[176:179], v[160:163], a[32:35]
    ds_read_b64_tr_b16 a[188:189], v23 offset:24576
    v_cvt_pk_bf16_f32 v152, v212, v213
    v_mfma_f32_16x16x32_bf16 a[32:35], a[180:183], v[164:167], a[32:35]
    ds_read_b64_tr_b16 a[190:191], v23 offset:28672
    v_mfma_f32_16x16x32_bf16 a[36:39], a[176:179], v[168:171], a[36:39]
    ds_read_b128 a[212:215], v9 offset:40960
    v_cvt_pk_bf16_f32 v153, v214, v215
    v_mfma_f32_16x16x32_bf16 a[36:39], a[180:183], v[172:175], a[36:39]
    v_smfmac_f32_16x16x64_bf16 a[196:199], v[52:55], v[168:175], v50
    v_mfma_f32_16x16x32_bf16 v[212:215], a[224:227], v[80:83], v[196:199]
    v_exp_f32 v208, v208
    v_mfma_f32_16x16x32_bf16 v[212:215], a[228:231], v[84:87], v[212:215]
    v_exp_f32 v209, v209
    v_mfma_f32_16x16x32_bf16 v[212:215], a[232:235], v[88:91], v[212:215]
    v_exp_f32 v210, v210
    v_mfma_f32_16x16x32_bf16 v[212:215], a[236:239], v[92:95], v[212:215]
    v_exp_f32 v211, v211
    v_mfma_f32_16x16x32_bf16 a[40:43], a[176:179], v[176:179], a[40:43]
    ds_read_b64_tr_b16 a[160:161], v24 offset:16384
    v_cvt_pk_bf16_f32 v130, v208, v209
    v_mfma_f32_16x16x32_bf16 a[40:43], a[180:183], v[180:183], a[40:43]
    ds_read_b64_tr_b16 a[162:163], v24 offset:20480
    v_mfma_f32_16x16x32_bf16 a[44:47], a[176:179], v[184:187], a[44:47]
    ds_read_b128 a[216:219], v10 offset:40960
    v_cvt_pk_bf16_f32 v131, v210, v211
    v_mfma_f32_16x16x32_bf16 a[44:47], a[180:183], v[188:191], a[44:47]
    s_waitcnt lgkmcnt(3)
    buffer_load_dwordx4 v41, s[12:15], s41 offen offset:1024 lds
    v_mfma_f32_16x16x32_bf16 v[208:211], a[224:227], v[96:99], v[200:203]
    v_exp_f32 v212, v212
    v_mfma_f32_16x16x32_bf16 v[208:211], a[228:231], v[100:103], v[208:211]
    v_exp_f32 v213, v213
    v_mfma_f32_16x16x32_bf16 v[208:211], a[232:235], v[104:107], v[208:211]
    v_exp_f32 v214, v214
    v_mfma_f32_16x16x32_bf16 v[208:211], a[236:239], v[108:111], v[208:211]
    v_exp_f32 v215, v215
    v_mfma_f32_16x16x32_bf16 a[48:51], a[184:187], v[160:163], a[48:51]
    ds_read_b64_tr_b16 a[164:165], v24 offset:24576
    v_cvt_pk_bf16_f32 v138, v212, v213
    v_mfma_f32_16x16x32_bf16 a[48:51], a[188:191], v[164:167], a[48:51]
    ds_read_b64_tr_b16 a[166:167], v24 offset:28672
    v_mfma_f32_16x16x32_bf16 a[52:55], a[184:187], v[168:171], a[52:55]
    ds_read_b128 a[220:223], v11 offset:40960
    v_cvt_pk_bf16_f32 v139, v214, v215
    v_mfma_f32_16x16x32_bf16 a[52:55], a[188:191], v[172:175], a[52:55]
    v_smfmac_f32_16x16x64_bf16 a[200:203], v[52:55], v[176:183], v50
    v_mfma_f32_16x16x32_bf16 v[212:215], a[224:227], v[112:115], v[204:207]
    v_exp_f32 v208, v208
    v_mfma_f32_16x16x32_bf16 v[212:215], a[228:231], v[116:119], v[212:215]
    v_exp_f32 v209, v209
    v_mfma_f32_16x16x32_bf16 v[212:215], a[232:235], v[120:123], v[212:215]
    v_exp_f32 v210, v210
    v_mfma_f32_16x16x32_bf16 v[212:215], a[236:239], v[124:127], v[212:215]
    v_exp_f32 v211, v211
    v_mfma_f32_16x16x32_bf16 a[56:59], a[184:187], v[176:179], a[56:59]
    ds_read_b64_tr_b16 a[168:169], v25 offset:16384
    v_cvt_pk_bf16_f32 v146, v208, v209
    v_mfma_f32_16x16x32_bf16 a[56:59], a[188:191], v[180:183], a[56:59]
    ds_read_b64_tr_b16 a[170:171], v25 offset:20480
    v_mfma_f32_16x16x32_bf16 a[60:63], a[184:187], v[184:187], a[60:63]
    ds_read_b128 a[224:227], v8 offset:45056
    v_cvt_pk_bf16_f32 v147, v210, v211
    v_mfma_f32_16x16x32_bf16 a[60:63], a[188:191], v[188:191], a[60:63]
    s_waitcnt lgkmcnt(3)
    buffer_load_dwordx4 v40, s[12:15], s41 offen offset:2048 lds
    v_mfma_f32_16x16x32_bf16 v[208:211], a[208:211], v[64:67], v[192:195]
    v_exp_f32 v212, v212
    v_mfma_f32_16x16x32_bf16 v[208:211], a[212:215], v[68:71], v[208:211]
    v_exp_f32 v213, v213
    v_mfma_f32_16x16x32_bf16 v[208:211], a[216:219], v[72:75], v[208:211]
    v_exp_f32 v214, v214
    v_mfma_f32_16x16x32_bf16 v[208:211], a[220:223], v[76:79], v[208:211]
    v_exp_f32 v215, v215
    v_mfma_f32_16x16x32_bf16 a[64:67], a[160:163], v[160:163], a[64:67]
    ds_read_b64_tr_b16 a[172:173], v25 offset:24576
    v_cvt_pk_bf16_f32 v154, v212, v213
    v_mfma_f32_16x16x32_bf16 a[64:67], a[164:167], v[164:167], a[64:67]
    ds_read_b64_tr_b16 a[174:175], v25 offset:28672
    v_mfma_f32_16x16x32_bf16 a[68:71], a[160:163], v[168:171], a[68:71]
    ds_read_b128 a[228:231], v9 offset:45056
    v_cvt_pk_bf16_f32 v155, v214, v215
    v_mfma_f32_16x16x32_bf16 a[68:71], a[164:167], v[172:175], a[68:71]
    v_smfmac_f32_16x16x64_bf16 a[204:207], v[52:55], v[184:191], v50
    v_mfma_f32_16x16x32_bf16 v[212:215], a[208:211], v[80:83], v[196:199]
    v_exp_f32 v208, v208
    v_mfma_f32_16x16x32_bf16 v[212:215], a[212:215], v[84:87], v[212:215]
    v_exp_f32 v209, v209
    v_mfma_f32_16x16x32_bf16 v[212:215], a[216:219], v[88:91], v[212:215]
    v_exp_f32 v210, v210
    v_mfma_f32_16x16x32_bf16 v[212:215], a[220:223], v[92:95], v[212:215]
    v_exp_f32 v211, v211
    v_mfma_f32_16x16x32_bf16 a[72:75], a[160:163], v[176:179], a[72:75]
    ds_read_b64_tr_b16 a[176:177], v26 offset:16384
    v_cvt_pk_bf16_f32 v132, v208, v209
    v_mfma_f32_16x16x32_bf16 a[72:75], a[164:167], v[180:183], a[72:75]
    ds_read_b64_tr_b16 a[178:179], v26 offset:20480
    v_mfma_f32_16x16x32_bf16 a[76:79], a[160:163], v[184:187], a[76:79]
    ds_read_b128 a[232:235], v10 offset:45056
    v_cvt_pk_bf16_f32 v133, v210, v211
    v_mfma_f32_16x16x32_bf16 a[76:79], a[164:167], v[188:191], a[76:79]
    s_waitcnt lgkmcnt(3)
    buffer_load_dwordx4 v41, s[12:15], s41 offen offset:3072 lds
    v_mfma_f32_16x16x32_bf16 v[208:211], a[208:211], v[96:99], v[200:203]
    v_exp_f32 v212, v212
    v_mfma_f32_16x16x32_bf16 v[208:211], a[212:215], v[100:103], v[208:211]
    s_add_u32 s41, s41, 16384
    v_exp_f32 v213, v213
    v_mfma_f32_16x16x32_bf16 v[208:211], a[216:219], v[104:107], v[208:211]
    v_exp_f32 v214, v214
    v_mfma_f32_16x16x32_bf16 v[208:211], a[220:223], v[108:111], v[208:211]
    v_exp_f32 v215, v215
    v_mfma_f32_16x16x32_bf16 a[80:83], a[168:171], v[160:163], a[80:83]
    ds_read_b64_tr_b16 a[180:181], v26 offset:24576
    v_cvt_pk_bf16_f32 v140, v212, v213
    v_mfma_f32_16x16x32_bf16 a[80:83], a[172:175], v[164:167], a[80:83]
    ds_read_b64_tr_b16 a[182:183], v26 offset:28672
    v_mfma_f32_16x16x32_bf16 a[84:87], a[168:171], v[168:171], a[84:87]
    ds_read_b128 a[236:239], v11 offset:45056
    v_cvt_pk_bf16_f32 v141, v214, v215
    v_mfma_f32_16x16x32_bf16 a[84:87], a[172:175], v[172:175], a[84:87]
    s_waitcnt vmcnt(9)
    s_barrier
    v_mfma_f32_16x16x32_bf16 v[212:215], a[208:211], v[112:115], v[204:207]
    v_exp_f32 v208, v208
    v_mfma_f32_16x16x32_bf16 v[212:215], a[212:215], v[116:119], v[212:215]
    s_add_u32 m0, s42, 16384
    v_exp_f32 v209, v209
    v_mfma_f32_16x16x32_bf16 v[212:215], a[216:219], v[120:123], v[212:215]
    v_exp_f32 v210, v210
    v_mfma_f32_16x16x32_bf16 v[212:215], a[220:223], v[124:127], v[212:215]
    v_exp_f32 v211, v211
    v_mfma_f32_16x16x32_bf16 a[88:91], a[168:171], v[176:179], a[88:91]
    ds_read_b64_tr_b16 a[184:185], v27 offset:16384
    v_cvt_pk_bf16_f32 v148, v208, v209
    v_mfma_f32_16x16x32_bf16 a[88:91], a[172:175], v[180:183], a[88:91]
    ds_read_b64_tr_b16 a[186:187], v27 offset:20480
    v_mfma_f32_16x16x32_bf16 a[92:95], a[168:171], v[184:187], a[92:95]
    ds_read_b128 a[208:211], v8 offset:49152
    v_cvt_pk_bf16_f32 v149, v210, v211
    v_mfma_f32_16x16x32_bf16 a[92:95], a[172:175], v[188:191], a[92:95]
    s_waitcnt lgkmcnt(3)
    buffer_load_dwordx4 v36, s[8:11], s40 offen lds
    v_mfma_f32_16x16x32_bf16 v[208:211], a[224:227], v[64:67], v[192:195]
    v_exp_f32 v212, v212
    v_mfma_f32_16x16x32_bf16 v[208:211], a[228:231], v[68:71], v[208:211]
    v_exp_f32 v213, v213
    v_mfma_f32_16x16x32_bf16 v[208:211], a[232:235], v[72:75], v[208:211]
    v_exp_f32 v214, v214
    v_mfma_f32_16x16x32_bf16 v[208:211], a[236:239], v[76:79], v[208:211]
    v_exp_f32 v215, v215
    v_mfma_f32_16x16x32_bf16 a[96:99], a[176:179], v[160:163], a[96:99]
    ds_read_b64_tr_b16 a[188:189], v27 offset:24576
    v_cvt_pk_bf16_f32 v156, v212, v213
    v_mfma_f32_16x16x32_bf16 a[96:99], a[180:183], v[164:167], a[96:99]
    ds_read_b64_tr_b16 a[190:191], v27 offset:28672
    v_mfma_f32_16x16x32_bf16 a[100:103], a[176:179], v[168:171], a[100:103]
    ds_read_b128 a[212:215], v9 offset:49152
    v_cvt_pk_bf16_f32 v157, v214, v215
    v_mfma_f32_16x16x32_bf16 a[100:103], a[180:183], v[172:175], a[100:103]
    buffer_load_dword v218, v57, s[80:83], s39 offen
    v_mfma_f32_16x16x32_bf16 v[212:215], a[224:227], v[80:83], v[196:199]
    v_exp_f32 v208, v208
    v_mfma_f32_16x16x32_bf16 v[212:215], a[228:231], v[84:87], v[212:215]
    v_exp_f32 v209, v209
    v_mfma_f32_16x16x32_bf16 v[212:215], a[232:235], v[88:91], v[212:215]
    v_exp_f32 v210, v210
    v_mfma_f32_16x16x32_bf16 v[212:215], a[236:239], v[92:95], v[212:215]
    v_exp_f32 v211, v211
    v_mfma_f32_16x16x32_bf16 a[104:107], a[176:179], v[176:179], a[104:107]
    ds_read_b64_tr_b16 a[160:161], v20 offset:32768
    v_cvt_pk_bf16_f32 v134, v208, v209
    v_mfma_f32_16x16x32_bf16 a[104:107], a[180:183], v[180:183], a[104:107]
    ds_read_b64_tr_b16 a[162:163], v20 offset:36864
    v_mfma_f32_16x16x32_bf16 a[108:111], a[176:179], v[184:187], a[108:111]
    ds_read_b128 a[216:219], v10 offset:49152
    v_cvt_pk_bf16_f32 v135, v210, v211
    v_mfma_f32_16x16x32_bf16 a[108:111], a[180:183], v[188:191], a[108:111]
    s_waitcnt lgkmcnt(3)
    buffer_load_dwordx4 v37, s[8:11], s40 offen offset:1024 lds
    v_mfma_f32_16x16x32_bf16 v[208:211], a[224:227], v[96:99], v[200:203]
    v_exp_f32 v212, v212
    v_mfma_f32_16x16x32_bf16 v[208:211], a[228:231], v[100:103], v[208:211]
    v_exp_f32 v213, v213
    v_mfma_f32_16x16x32_bf16 v[208:211], a[232:235], v[104:107], v[208:211]
    v_exp_f32 v214, v214
    v_mfma_f32_16x16x32_bf16 v[208:211], a[236:239], v[108:111], v[208:211]
    v_exp_f32 v215, v215
    v_mfma_f32_16x16x32_bf16 a[112:115], a[184:187], v[160:163], a[112:115]
    ds_read_b64_tr_b16 a[164:165], v20 offset:40960
    v_cvt_pk_bf16_f32 v142, v212, v213
    v_mfma_f32_16x16x32_bf16 a[112:115], a[188:191], v[164:167], a[112:115]
    ds_read_b64_tr_b16 a[166:167], v20 offset:45056
    v_mfma_f32_16x16x32_bf16 a[116:119], a[184:187], v[168:171], a[116:119]
    ds_read_b128 a[220:223], v11 offset:49152
    v_cvt_pk_bf16_f32 v143, v214, v215
    v_mfma_f32_16x16x32_bf16 a[116:119], a[188:191], v[172:175], a[116:119]
    v_mfma_f32_16x16x32_bf16 v[212:215], a[224:227], v[112:115], v[204:207]
    v_exp_f32 v208, v208
    v_mfma_f32_16x16x32_bf16 v[212:215], a[228:231], v[116:119], v[212:215]
    v_exp_f32 v209, v209
    v_mfma_f32_16x16x32_bf16 v[212:215], a[232:235], v[120:123], v[212:215]
    v_exp_f32 v210, v210
    v_mfma_f32_16x16x32_bf16 v[212:215], a[236:239], v[124:127], v[212:215]
    v_exp_f32 v211, v211
    v_mfma_f32_16x16x32_bf16 a[120:123], a[184:187], v[176:179], a[120:123]
    ds_read_b64_tr_b16 a[168:169], v21 offset:32768
    v_cvt_pk_bf16_f32 v150, v208, v209
    v_mfma_f32_16x16x32_bf16 a[120:123], a[188:191], v[180:183], a[120:123]
    ds_read_b64_tr_b16 a[170:171], v21 offset:36864
    v_mfma_f32_16x16x32_bf16 a[124:127], a[184:187], v[184:187], a[124:127]
    ds_read_b128 a[224:227], v8 offset:53248
    v_cvt_pk_bf16_f32 v151, v210, v211
    v_mfma_f32_16x16x32_bf16 a[124:127], a[188:191], v[188:191], a[124:127]
    s_waitcnt lgkmcnt(3)
    buffer_load_dwordx4 v38, s[8:11], s40 offen offset:2048 lds
    v_mfma_f32_16x16x32_bf16 v[208:211], a[208:211], v[64:67], v[192:195]
    v_exp_f32 v212, v212
    v_mfma_f32_16x16x32_bf16 v[208:211], a[212:215], v[68:71], v[208:211]
    v_exp_f32 v213, v213
    v_mfma_f32_16x16x32_bf16 v[208:211], a[216:219], v[72:75], v[208:211]
    v_exp_f32 v214, v214
    v_mfma_f32_16x16x32_bf16 v[208:211], a[220:223], v[76:79], v[208:211]
    v_exp_f32 v215, v215
    v_mfma_f32_16x16x32_bf16 a[0:3], a[160:163], v[128:131], a[0:3]
    ds_read_b64_tr_b16 a[172:173], v21 offset:40960
    v_cvt_pk_bf16_f32 v158, v212, v213
    v_mfma_f32_16x16x32_bf16 a[0:3], a[164:167], v[132:135], a[0:3]
    ds_read_b64_tr_b16 a[174:175], v21 offset:45056
    v_mfma_f32_16x16x32_bf16 a[4:7], a[160:163], v[136:139], a[4:7]
    ds_read_b128 a[228:231], v9 offset:53248
    v_cvt_pk_bf16_f32 v159, v214, v215
    v_mfma_f32_16x16x32_bf16 a[4:7], a[164:167], v[140:143], a[4:7]
    v_mfma_f32_16x16x32_bf16 v[212:215], a[208:211], v[80:83], v[196:199]
    v_exp_f32 v208, v208
    v_mfma_f32_16x16x32_bf16 v[212:215], a[212:215], v[84:87], v[212:215]
    v_exp_f32 v209, v209
    v_mfma_f32_16x16x32_bf16 v[212:215], a[216:219], v[88:91], v[212:215]
    v_exp_f32 v210, v210
    v_mfma_f32_16x16x32_bf16 v[212:215], a[220:223], v[92:95], v[212:215]
    v_exp_f32 v211, v211
    v_mfma_f32_16x16x32_bf16 a[8:11], a[160:163], v[144:147], a[8:11]
    ds_read_b64_tr_b16 a[176:177], v22 offset:32768
    v_cvt_pk_bf16_f32 v160, v208, v209
    v_mfma_f32_16x16x32_bf16 a[8:11], a[164:167], v[148:151], a[8:11]
    ds_read_b64_tr_b16 a[178:179], v22 offset:36864
    v_mfma_f32_16x16x32_bf16 a[12:15], a[160:163], v[152:155], a[12:15]
    ds_read_b128 a[232:235], v10 offset:53248
    v_cvt_pk_bf16_f32 v161, v210, v211
    v_mfma_f32_16x16x32_bf16 a[12:15], a[164:167], v[156:159], a[12:15]
    s_waitcnt lgkmcnt(3)
    buffer_load_dwordx4 v39, s[8:11], s40 offen offset:3072 lds
    v_mfma_f32_16x16x32_bf16 v[208:211], a[208:211], v[96:99], v[200:203]
    v_exp_f32 v212, v212
    v_mfma_f32_16x16x32_bf16 v[208:211], a[212:215], v[100:103], v[208:211]
    s_add_u32 s40, s40, 16384
    v_exp_f32 v213, v213
    v_mfma_f32_16x16x32_bf16 v[208:211], a[216:219], v[104:107], v[208:211]
    v_exp_f32 v214, v214
    v_mfma_f32_16x16x32_bf16 v[208:211], a[220:223], v[108:111], v[208:211]
    v_exp_f32 v215, v215
    v_mfma_f32_16x16x32_bf16 a[16:19], a[168:171], v[128:131], a[16:19]
    ds_read_b64_tr_b16 a[180:181], v22 offset:40960
    v_cvt_pk_bf16_f32 v168, v212, v213
    v_mfma_f32_16x16x32_bf16 a[16:19], a[172:175], v[132:135], a[16:19]
    ds_read_b64_tr_b16 a[182:183], v22 offset:45056
    v_mfma_f32_16x16x32_bf16 a[20:23], a[168:171], v[136:139], a[20:23]
    ds_read_b128 a[236:239], v11 offset:53248
    v_cvt_pk_bf16_f32 v169, v214, v215
    v_mfma_f32_16x16x32_bf16 a[20:23], a[172:175], v[140:143], a[20:23]
    v_smfmac_f32_16x16x64_bf16 a[192:195], v[52:55], v[128:135], v50
    v_mfma_f32_16x16x32_bf16 v[212:215], a[208:211], v[112:115], v[204:207]
    v_exp_f32 v208, v208
    v_mfma_f32_16x16x32_bf16 v[212:215], a[212:215], v[116:119], v[212:215]
    s_add_u32 m0, s42, 65536
    v_exp_f32 v209, v209
    v_mfma_f32_16x16x32_bf16 v[212:215], a[216:219], v[120:123], v[212:215]
    v_exp_f32 v210, v210
    v_mfma_f32_16x16x32_bf16 v[212:215], a[220:223], v[124:127], v[212:215]
    v_exp_f32 v211, v211
    v_mfma_f32_16x16x32_bf16 a[24:27], a[168:171], v[144:147], a[24:27]
    ds_read_b64_tr_b16 a[184:185], v23 offset:32768
    v_cvt_pk_bf16_f32 v176, v208, v209
    v_mfma_f32_16x16x32_bf16 a[24:27], a[172:175], v[148:151], a[24:27]
    ds_read_b64_tr_b16 a[186:187], v23 offset:36864
    v_mfma_f32_16x16x32_bf16 a[28:31], a[168:171], v[152:155], a[28:31]
    ds_read_b128 a[208:211], v8 offset:57344
    v_cvt_pk_bf16_f32 v177, v210, v211
    v_mfma_f32_16x16x32_bf16 a[28:31], a[172:175], v[156:159], a[28:31]
    s_waitcnt lgkmcnt(3)
    buffer_load_dwordx4 v40, s[12:15], s41 offen lds
    v_mfma_f32_16x16x32_bf16 v[208:211], a[224:227], v[64:67], v[192:195]
    v_exp_f32 v212, v212
    v_mfma_f32_16x16x32_bf16 v[208:211], a[228:231], v[68:71], v[208:211]
    v_exp_f32 v213, v213
    v_mfma_f32_16x16x32_bf16 v[208:211], a[232:235], v[72:75], v[208:211]
    v_exp_f32 v214, v214
    v_mfma_f32_16x16x32_bf16 v[208:211], a[236:239], v[76:79], v[208:211]
    v_exp_f32 v215, v215
    v_mfma_f32_16x16x32_bf16 a[32:35], a[176:179], v[128:131], a[32:35]
    ds_read_b64_tr_b16 a[188:189], v23 offset:40960
    v_cvt_pk_bf16_f32 v184, v212, v213
    v_mfma_f32_16x16x32_bf16 a[32:35], a[180:183], v[132:135], a[32:35]
    ds_read_b64_tr_b16 a[190:191], v23 offset:45056
    v_mfma_f32_16x16x32_bf16 a[36:39], a[176:179], v[136:139], a[36:39]
    ds_read_b128 a[212:215], v9 offset:57344
    v_cvt_pk_bf16_f32 v185, v214, v215
    v_mfma_f32_16x16x32_bf16 a[36:39], a[180:183], v[140:143], a[36:39]
    v_smfmac_f32_16x16x64_bf16 a[196:199], v[52:55], v[136:143], v50
    v_mfma_f32_16x16x32_bf16 v[212:215], a[224:227], v[80:83], v[196:199]
    v_exp_f32 v208, v208
    v_mfma_f32_16x16x32_bf16 v[212:215], a[228:231], v[84:87], v[212:215]
    v_exp_f32 v209, v209
    v_mfma_f32_16x16x32_bf16 v[212:215], a[232:235], v[88:91], v[212:215]
    v_exp_f32 v210, v210
    v_mfma_f32_16x16x32_bf16 v[212:215], a[236:239], v[92:95], v[212:215]
    v_exp_f32 v211, v211
    v_mfma_f32_16x16x32_bf16 a[40:43], a[176:179], v[144:147], a[40:43]
    ds_read_b64_tr_b16 a[160:161], v24 offset:32768
    v_cvt_pk_bf16_f32 v162, v208, v209
    v_mfma_f32_16x16x32_bf16 a[40:43], a[180:183], v[148:151], a[40:43]
    ds_read_b64_tr_b16 a[162:163], v24 offset:36864
    v_mfma_f32_16x16x32_bf16 a[44:47], a[176:179], v[152:155], a[44:47]
    ds_read_b128 a[216:219], v10 offset:57344
    v_cvt_pk_bf16_f32 v163, v210, v211
    v_mfma_f32_16x16x32_bf16 a[44:47], a[180:183], v[156:159], a[44:47]
    s_waitcnt lgkmcnt(3)
    buffer_load_dwordx4 v41, s[12:15], s41 offen offset:1024 lds
    v_mfma_f32_16x16x32_bf16 v[208:211], a[224:227], v[96:99], v[200:203]
    v_exp_f32 v212, v212
    v_mfma_f32_16x16x32_bf16 v[208:211], a[228:231], v[100:103], v[208:211]
    v_exp_f32 v213, v213
    v_mfma_f32_16x16x32_bf16 v[208:211], a[232:235], v[104:107], v[208:211]
    v_exp_f32 v214, v214
    v_mfma_f32_16x16x32_bf16 v[208:211], a[236:239], v[108:111], v[208:211]
    v_exp_f32 v215, v215
    v_mfma_f32_16x16x32_bf16 a[48:51], a[184:187], v[128:131], a[48:51]
    ds_read_b64_tr_b16 a[164:165], v24 offset:40960
    v_cvt_pk_bf16_f32 v170, v212, v213
    v_mfma_f32_16x16x32_bf16 a[48:51], a[188:191], v[132:135], a[48:51]
    ds_read_b64_tr_b16 a[166:167], v24 offset:45056
    v_mfma_f32_16x16x32_bf16 a[52:55], a[184:187], v[136:139], a[52:55]
    ds_read_b128 a[220:223], v11 offset:57344
    v_cvt_pk_bf16_f32 v171, v214, v215
    v_mfma_f32_16x16x32_bf16 a[52:55], a[188:191], v[140:143], a[52:55]
    v_smfmac_f32_16x16x64_bf16 a[200:203], v[52:55], v[144:151], v50
    v_mfma_f32_16x16x32_bf16 v[212:215], a[224:227], v[112:115], v[204:207]
    v_exp_f32 v208, v208
    v_mfma_f32_16x16x32_bf16 v[212:215], a[228:231], v[116:119], v[212:215]
    v_exp_f32 v209, v209
    v_mfma_f32_16x16x32_bf16 v[212:215], a[232:235], v[120:123], v[212:215]
    v_exp_f32 v210, v210
    v_mfma_f32_16x16x32_bf16 v[212:215], a[236:239], v[124:127], v[212:215]
    v_exp_f32 v211, v211
    v_mfma_f32_16x16x32_bf16 a[56:59], a[184:187], v[144:147], a[56:59]
    ds_read_b64_tr_b16 a[168:169], v25 offset:32768
    v_cvt_pk_bf16_f32 v178, v208, v209
    v_mfma_f32_16x16x32_bf16 a[56:59], a[188:191], v[148:151], a[56:59]
    ds_read_b64_tr_b16 a[170:171], v25 offset:36864
    v_mfma_f32_16x16x32_bf16 a[60:63], a[184:187], v[152:155], a[60:63]
    ds_read_b128 a[224:227], v8 offset:61440
    v_cvt_pk_bf16_f32 v179, v210, v211
    v_mfma_f32_16x16x32_bf16 a[60:63], a[188:191], v[156:159], a[60:63]
    s_waitcnt lgkmcnt(3)
    buffer_load_dwordx4 v40, s[12:15], s41 offen offset:2048 lds
    v_mfma_f32_16x16x32_bf16 v[208:211], a[208:211], v[64:67], v[192:195]
    v_exp_f32 v212, v212
    v_mfma_f32_16x16x32_bf16 v[208:211], a[212:215], v[68:71], v[208:211]
    v_exp_f32 v213, v213
    v_mfma_f32_16x16x32_bf16 v[208:211], a[216:219], v[72:75], v[208:211]
    v_exp_f32 v214, v214
    v_mfma_f32_16x16x32_bf16 v[208:211], a[220:223], v[76:79], v[208:211]
    v_exp_f32 v215, v215
    v_mfma_f32_16x16x32_bf16 a[64:67], a[160:163], v[128:131], a[64:67]
    ds_read_b64_tr_b16 a[172:173], v25 offset:40960
    v_cvt_pk_bf16_f32 v186, v212, v213
    v_mfma_f32_16x16x32_bf16 a[64:67], a[164:167], v[132:135], a[64:67]
    ds_read_b64_tr_b16 a[174:175], v25 offset:45056
    v_mfma_f32_16x16x32_bf16 a[68:71], a[160:163], v[136:139], a[68:71]
    ds_read_b128 a[228:231], v9 offset:61440
    v_cvt_pk_bf16_f32 v187, v214, v215
    v_mfma_f32_16x16x32_bf16 a[68:71], a[164:167], v[140:143], a[68:71]
    v_smfmac_f32_16x16x64_bf16 a[204:207], v[52:55], v[152:159], v50
    v_mfma_f32_16x16x32_bf16 v[212:215], a[208:211], v[80:83], v[196:199]
    v_exp_f32 v208, v208
    v_mfma_f32_16x16x32_bf16 v[212:215], a[212:215], v[84:87], v[212:215]
    v_exp_f32 v209, v209
    v_mfma_f32_16x16x32_bf16 v[212:215], a[216:219], v[88:91], v[212:215]
    v_exp_f32 v210, v210
    v_mfma_f32_16x16x32_bf16 v[212:215], a[220:223], v[92:95], v[212:215]
    v_exp_f32 v211, v211
    v_mfma_f32_16x16x32_bf16 a[72:75], a[160:163], v[144:147], a[72:75]
    ds_read_b64_tr_b16 a[176:177], v26 offset:32768
    v_cvt_pk_bf16_f32 v164, v208, v209
    v_mfma_f32_16x16x32_bf16 a[72:75], a[164:167], v[148:151], a[72:75]
    ds_read_b64_tr_b16 a[178:179], v26 offset:36864
    v_mfma_f32_16x16x32_bf16 a[76:79], a[160:163], v[152:155], a[76:79]
    ds_read_b128 a[232:235], v10 offset:61440
    v_cvt_pk_bf16_f32 v165, v210, v211
    v_mfma_f32_16x16x32_bf16 a[76:79], a[164:167], v[156:159], a[76:79]
    s_waitcnt lgkmcnt(3)
    buffer_load_dwordx4 v41, s[12:15], s41 offen offset:3072 lds
    v_mfma_f32_16x16x32_bf16 v[208:211], a[208:211], v[96:99], v[200:203]
    v_exp_f32 v212, v212
    v_mfma_f32_16x16x32_bf16 v[208:211], a[212:215], v[100:103], v[208:211]
    s_add_u32 s41, s41, 16384
    v_exp_f32 v213, v213
    v_mfma_f32_16x16x32_bf16 v[208:211], a[216:219], v[104:107], v[208:211]
    v_exp_f32 v214, v214
    v_mfma_f32_16x16x32_bf16 v[208:211], a[220:223], v[108:111], v[208:211]
    v_exp_f32 v215, v215
    v_mfma_f32_16x16x32_bf16 a[80:83], a[168:171], v[128:131], a[80:83]
    ds_read_b64_tr_b16 a[180:181], v26 offset:40960
    v_cvt_pk_bf16_f32 v172, v212, v213
    v_mfma_f32_16x16x32_bf16 a[80:83], a[172:175], v[132:135], a[80:83]
    ds_read_b64_tr_b16 a[182:183], v26 offset:45056
    v_mfma_f32_16x16x32_bf16 a[84:87], a[168:171], v[136:139], a[84:87]
    ds_read_b128 a[236:239], v11 offset:61440
    v_cvt_pk_bf16_f32 v173, v214, v215
    v_mfma_f32_16x16x32_bf16 a[84:87], a[172:175], v[140:143], a[84:87]
    s_waitcnt vmcnt(9)
    s_barrier
    v_mfma_f32_16x16x32_bf16 v[212:215], a[208:211], v[112:115], v[204:207]
    v_exp_f32 v208, v208
    v_mfma_f32_16x16x32_bf16 v[212:215], a[212:215], v[116:119], v[212:215]
    s_add_u32 m0, s42, 32768
    v_exp_f32 v209, v209
    v_mfma_f32_16x16x32_bf16 v[212:215], a[216:219], v[120:123], v[212:215]
    v_exp_f32 v210, v210
    v_mfma_f32_16x16x32_bf16 v[212:215], a[220:223], v[124:127], v[212:215]
    v_exp_f32 v211, v211
    v_mfma_f32_16x16x32_bf16 a[88:91], a[168:171], v[144:147], a[88:91]
    ds_read_b64_tr_b16 a[184:185], v27 offset:32768
    v_cvt_pk_bf16_f32 v180, v208, v209
    v_mfma_f32_16x16x32_bf16 a[88:91], a[172:175], v[148:151], a[88:91]
    ds_read_b64_tr_b16 a[186:187], v27 offset:36864
    v_mfma_f32_16x16x32_bf16 a[92:95], a[168:171], v[152:155], a[92:95]
    ds_read_b128 a[208:211], v8 offset:0
    v_cvt_pk_bf16_f32 v181, v210, v211
    v_mfma_f32_16x16x32_bf16 a[92:95], a[172:175], v[156:159], a[92:95]
    s_waitcnt lgkmcnt(3)
    buffer_load_dwordx4 v36, s[8:11], s40 offen lds
    v_mfma_f32_16x16x32_bf16 v[208:211], a[224:227], v[64:67], v[192:195]
    v_exp_f32 v212, v212
    v_mfma_f32_16x16x32_bf16 v[208:211], a[228:231], v[68:71], v[208:211]
    v_exp_f32 v213, v213
    v_mfma_f32_16x16x32_bf16 v[208:211], a[232:235], v[72:75], v[208:211]
    v_exp_f32 v214, v214
    v_mfma_f32_16x16x32_bf16 v[208:211], a[236:239], v[76:79], v[208:211]
    v_exp_f32 v215, v215
    v_mfma_f32_16x16x32_bf16 a[96:99], a[176:179], v[128:131], a[96:99]
    ds_read_b64_tr_b16 a[188:189], v27 offset:40960
    v_cvt_pk_bf16_f32 v188, v212, v213
    v_mfma_f32_16x16x32_bf16 a[96:99], a[180:183], v[132:135], a[96:99]
    ds_read_b64_tr_b16 a[190:191], v27 offset:45056
    v_mfma_f32_16x16x32_bf16 a[100:103], a[176:179], v[136:139], a[100:103]
    ds_read_b128 a[212:215], v9 offset:0
    v_cvt_pk_bf16_f32 v189, v214, v215
    v_mfma_f32_16x16x32_bf16 a[100:103], a[180:183], v[140:143], a[100:103]
    buffer_load_dword v219, v62, s[84:87], s38 offen
    v_mfma_f32_16x16x32_bf16 v[212:215], a[224:227], v[80:83], v[196:199]
    v_exp_f32 v208, v208
    v_mfma_f32_16x16x32_bf16 v[212:215], a[228:231], v[84:87], v[212:215]
    v_exp_f32 v209, v209
    v_mfma_f32_16x16x32_bf16 v[212:215], a[232:235], v[88:91], v[212:215]
    v_exp_f32 v210, v210
    v_mfma_f32_16x16x32_bf16 v[212:215], a[236:239], v[92:95], v[212:215]
    v_exp_f32 v211, v211
    v_mfma_f32_16x16x32_bf16 a[104:107], a[176:179], v[144:147], a[104:107]
    ds_read_b64_tr_b16 a[160:161], v20 offset:49152
    v_cvt_pk_bf16_f32 v166, v208, v209
    v_mfma_f32_16x16x32_bf16 a[104:107], a[180:183], v[148:151], a[104:107]
    ds_read_b64_tr_b16 a[162:163], v20 offset:53248
    v_mfma_f32_16x16x32_bf16 a[108:111], a[176:179], v[152:155], a[108:111]
    ds_read_b128 a[216:219], v10 offset:0
    v_cvt_pk_bf16_f32 v167, v210, v211
    v_mfma_f32_16x16x32_bf16 a[108:111], a[180:183], v[156:159], a[108:111]
    s_waitcnt lgkmcnt(3)
    buffer_load_dwordx4 v37, s[8:11], s40 offen offset:1024 lds
    v_mfma_f32_16x16x32_bf16 v[208:211], a[224:227], v[96:99], v[200:203]
    v_exp_f32 v212, v212
    v_mfma_f32_16x16x32_bf16 v[208:211], a[228:231], v[100:103], v[208:211]
    v_exp_f32 v213, v213
    v_mfma_f32_16x16x32_bf16 v[208:211], a[232:235], v[104:107], v[208:211]
    v_exp_f32 v214, v214
    v_mfma_f32_16x16x32_bf16 v[208:211], a[236:239], v[108:111], v[208:211]
    v_exp_f32 v215, v215
    v_mfma_f32_16x16x32_bf16 a[112:115], a[184:187], v[128:131], a[112:115]
    ds_read_b64_tr_b16 a[164:165], v20 offset:57344
    v_cvt_pk_bf16_f32 v174, v212, v213
    v_mfma_f32_16x16x32_bf16 a[112:115], a[188:191], v[132:135], a[112:115]
    ds_read_b64_tr_b16 a[166:167], v20 offset:61440
    v_mfma_f32_16x16x32_bf16 a[116:119], a[184:187], v[136:139], a[116:119]
    ds_read_b128 a[220:223], v11 offset:0
    v_cvt_pk_bf16_f32 v175, v214, v215
    v_mfma_f32_16x16x32_bf16 a[116:119], a[188:191], v[140:143], a[116:119]
    v_mfma_f32_16x16x32_bf16 v[212:215], a[224:227], v[112:115], v[204:207]
    v_exp_f32 v208, v208
    v_mfma_f32_16x16x32_bf16 v[212:215], a[228:231], v[116:119], v[212:215]
    v_exp_f32 v209, v209
    v_mfma_f32_16x16x32_bf16 v[212:215], a[232:235], v[120:123], v[212:215]
    v_exp_f32 v210, v210
    v_mfma_f32_16x16x32_bf16 v[212:215], a[236:239], v[124:127], v[212:215]
    v_exp_f32 v211, v211
    v_mfma_f32_16x16x32_bf16 a[120:123], a[184:187], v[144:147], a[120:123]
    ds_read_b64_tr_b16 a[168:169], v21 offset:49152
    v_cvt_pk_bf16_f32 v182, v208, v209
    v_mfma_f32_16x16x32_bf16 a[120:123], a[188:191], v[148:151], a[120:123]
    ds_read_b64_tr_b16 a[170:171], v21 offset:53248
    v_mfma_f32_16x16x32_bf16 a[124:127], a[184:187], v[152:155], a[124:127]
    ds_read_b128 a[224:227], v8 offset:4096
    v_cvt_pk_bf16_f32 v183, v210, v211
    v_mfma_f32_16x16x32_bf16 a[124:127], a[188:191], v[156:159], a[124:127]
    s_waitcnt lgkmcnt(3)
    buffer_load_dwordx4 v38, s[8:11], s40 offen offset:2048 lds
    v_mfma_f32_16x16x32_bf16 v[208:211], a[208:211], v[64:67], v[192:195]
    v_exp_f32 v212, v212
    v_mfma_f32_16x16x32_bf16 v[208:211], a[212:215], v[68:71], v[208:211]
    v_exp_f32 v213, v213
    v_mfma_f32_16x16x32_bf16 v[208:211], a[216:219], v[72:75], v[208:211]
    v_exp_f32 v214, v214
    v_mfma_f32_16x16x32_bf16 v[208:211], a[220:223], v[76:79], v[208:211]
    v_exp_f32 v215, v215
    v_mfma_f32_16x16x32_bf16 a[0:3], a[160:163], v[160:163], a[0:3]
    ds_read_b64_tr_b16 a[172:173], v21 offset:57344
    v_cvt_pk_bf16_f32 v190, v212, v213
    v_mfma_f32_16x16x32_bf16 a[0:3], a[164:167], v[164:167], a[0:3]
    ds_read_b64_tr_b16 a[174:175], v21 offset:61440
    v_mfma_f32_16x16x32_bf16 a[4:7], a[160:163], v[168:171], a[4:7]
    ds_read_b128 a[228:231], v9 offset:4096
    v_cvt_pk_bf16_f32 v191, v214, v215
    v_mfma_f32_16x16x32_bf16 a[4:7], a[164:167], v[172:175], a[4:7]
    v_mfma_f32_16x16x32_bf16 v[212:215], a[208:211], v[80:83], v[196:199]
    v_exp_f32 v208, v208
    v_mfma_f32_16x16x32_bf16 v[212:215], a[212:215], v[84:87], v[212:215]
    v_exp_f32 v209, v209
    v_mfma_f32_16x16x32_bf16 v[212:215], a[216:219], v[88:91], v[212:215]
    v_exp_f32 v210, v210
    v_mfma_f32_16x16x32_bf16 v[212:215], a[220:223], v[92:95], v[212:215]
    v_exp_f32 v211, v211
    v_mfma_f32_16x16x32_bf16 a[8:11], a[160:163], v[176:179], a[8:11]
    ds_read_b64_tr_b16 a[176:177], v22 offset:49152
    v_cvt_pk_bf16_f32 v128, v208, v209
    v_mfma_f32_16x16x32_bf16 a[8:11], a[164:167], v[180:183], a[8:11]
    ds_read_b64_tr_b16 a[178:179], v22 offset:53248
    v_mfma_f32_16x16x32_bf16 a[12:15], a[160:163], v[184:187], a[12:15]
    ds_read_b128 a[232:235], v10 offset:4096
    v_cvt_pk_bf16_f32 v129, v210, v211
    v_mfma_f32_16x16x32_bf16 a[12:15], a[164:167], v[188:191], a[12:15]
    s_waitcnt lgkmcnt(3)
    buffer_load_dwordx4 v39, s[8:11], s40 offen offset:3072 lds
    v_mfma_f32_16x16x32_bf16 v[208:211], a[208:211], v[96:99], v[200:203]
    v_exp_f32 v212, v212
    v_mfma_f32_16x16x32_bf16 v[208:211], a[212:215], v[100:103], v[208:211]
    s_add_u32 s40, s40, 16384
    v_exp_f32 v213, v213
    v_mfma_f32_16x16x32_bf16 v[208:211], a[216:219], v[104:107], v[208:211]
    v_exp_f32 v214, v214
    v_mfma_f32_16x16x32_bf16 v[208:211], a[220:223], v[108:111], v[208:211]
    v_exp_f32 v215, v215
    v_mfma_f32_16x16x32_bf16 a[16:19], a[168:171], v[160:163], a[16:19]
    ds_read_b64_tr_b16 a[180:181], v22 offset:57344
    v_cvt_pk_bf16_f32 v136, v212, v213
    v_mfma_f32_16x16x32_bf16 a[16:19], a[172:175], v[164:167], a[16:19]
    ds_read_b64_tr_b16 a[182:183], v22 offset:61440
    v_mfma_f32_16x16x32_bf16 a[20:23], a[168:171], v[168:171], a[20:23]
    ds_read_b128 a[236:239], v11 offset:4096
    v_cvt_pk_bf16_f32 v137, v214, v215
    v_mfma_f32_16x16x32_bf16 a[20:23], a[172:175], v[172:175], a[20:23]
    v_smfmac_f32_16x16x64_bf16 a[192:195], v[52:55], v[160:167], v50
    v_mfma_f32_16x16x32_bf16 v[212:215], a[208:211], v[112:115], v[204:207]
    v_exp_f32 v208, v208
    v_mfma_f32_16x16x32_bf16 v[212:215], a[212:215], v[116:119], v[212:215]
    s_add_u32 m0, s42, 81920
    v_exp_f32 v209, v209
    v_mfma_f32_16x16x32_bf16 v[212:215], a[216:219], v[120:123], v[212:215]
    v_exp_f32 v210, v210
    v_mfma_f32_16x16x32_bf16 v[212:215], a[220:223], v[124:127], v[212:215]
    v_exp_f32 v211, v211
    v_mfma_f32_16x16x32_bf16 a[24:27], a[168:171], v[176:179], a[24:27]
    ds_read_b64_tr_b16 a[184:185], v23 offset:49152
    v_cvt_pk_bf16_f32 v144, v208, v209
    v_mfma_f32_16x16x32_bf16 a[24:27], a[172:175], v[180:183], a[24:27]
    ds_read_b64_tr_b16 a[186:187], v23 offset:53248
    v_mfma_f32_16x16x32_bf16 a[28:31], a[168:171], v[184:187], a[28:31]
    ds_read_b128 a[208:211], v8 offset:8192
    v_cvt_pk_bf16_f32 v145, v210, v211
    v_mfma_f32_16x16x32_bf16 a[28:31], a[172:175], v[188:191], a[28:31]
    s_waitcnt lgkmcnt(3)
    buffer_load_dwordx4 v40, s[12:15], s41 offen lds
    v_mfma_f32_16x16x32_bf16 v[208:211], a[224:227], v[64:67], v[192:195]
    v_exp_f32 v212, v212
    v_mfma_f32_16x16x32_bf16 v[208:211], a[228:231], v[68:71], v[208:211]
    v_exp_f32 v213, v213
    v_mfma_f32_16x16x32_bf16 v[208:211], a[232:235], v[72:75], v[208:211]
    v_exp_f32 v214, v214
    v_mfma_f32_16x16x32_bf16 v[208:211], a[236:239], v[76:79], v[208:211]
    v_exp_f32 v215, v215
    v_mfma_f32_16x16x32_bf16 a[32:35], a[176:179], v[160:163], a[32:35]
    ds_read_b64_tr_b16 a[188:189], v23 offset:57344
    v_cvt_pk_bf16_f32 v152, v212, v213
    v_mfma_f32_16x16x32_bf16 a[32:35], a[180:183], v[164:167], a[32:35]
    ds_read_b64_tr_b16 a[190:191], v23 offset:61440
    v_mfma_f32_16x16x32_bf16 a[36:39], a[176:179], v[168:171], a[36:39]
    ds_read_b128 a[212:215], v9 offset:8192
    v_cvt_pk_bf16_f32 v153, v214, v215
    v_mfma_f32_16x16x32_bf16 a[36:39], a[180:183], v[172:175], a[36:39]
    v_smfmac_f32_16x16x64_bf16 a[196:199], v[52:55], v[168:175], v50
    v_mfma_f32_16x16x32_bf16 v[212:215], a[224:227], v[80:83], v[196:199]
    v_exp_f32 v208, v208
    v_mfma_f32_16x16x32_bf16 v[212:215], a[228:231], v[84:87], v[212:215]
    v_exp_f32 v209, v209
    v_mfma_f32_16x16x32_bf16 v[212:215], a[232:235], v[88:91], v[212:215]
    v_exp_f32 v210, v210
    v_mfma_f32_16x16x32_bf16 v[212:215], a[236:239], v[92:95], v[212:215]
    v_exp_f32 v211, v211
    v_mfma_f32_16x16x32_bf16 a[40:43], a[176:179], v[176:179], a[40:43]
    ds_read_b64_tr_b16 a[160:161], v24 offset:49152
    v_cvt_pk_bf16_f32 v130, v208, v209
    v_mfma_f32_16x16x32_bf16 a[40:43], a[180:183], v[180:183], a[40:43]
    ds_read_b64_tr_b16 a[162:163], v24 offset:53248
    v_mfma_f32_16x16x32_bf16 a[44:47], a[176:179], v[184:187], a[44:47]
    ds_read_b128 a[216:219], v10 offset:8192
    v_cvt_pk_bf16_f32 v131, v210, v211
    v_mfma_f32_16x16x32_bf16 a[44:47], a[180:183], v[188:191], a[44:47]
    s_waitcnt lgkmcnt(3)
    buffer_load_dwordx4 v41, s[12:15], s41 offen offset:1024 lds
    v_mfma_f32_16x16x32_bf16 v[208:211], a[224:227], v[96:99], v[200:203]
    v_exp_f32 v212, v212
    v_mfma_f32_16x16x32_bf16 v[208:211], a[228:231], v[100:103], v[208:211]
    v_exp_f32 v213, v213
    v_mfma_f32_16x16x32_bf16 v[208:211], a[232:235], v[104:107], v[208:211]
    v_exp_f32 v214, v214
    v_mfma_f32_16x16x32_bf16 v[208:211], a[236:239], v[108:111], v[208:211]
    v_exp_f32 v215, v215
    v_mfma_f32_16x16x32_bf16 a[48:51], a[184:187], v[160:163], a[48:51]
    ds_read_b64_tr_b16 a[164:165], v24 offset:57344
    v_cvt_pk_bf16_f32 v138, v212, v213
    v_mfma_f32_16x16x32_bf16 a[48:51], a[188:191], v[164:167], a[48:51]
    ds_read_b64_tr_b16 a[166:167], v24 offset:61440
    v_mfma_f32_16x16x32_bf16 a[52:55], a[184:187], v[168:171], a[52:55]
    ds_read_b128 a[220:223], v11 offset:8192
    v_cvt_pk_bf16_f32 v139, v214, v215
    v_mfma_f32_16x16x32_bf16 a[52:55], a[188:191], v[172:175], a[52:55]
    v_smfmac_f32_16x16x64_bf16 a[200:203], v[52:55], v[176:183], v50
    v_mfma_f32_16x16x32_bf16 v[212:215], a[224:227], v[112:115], v[204:207]
    v_exp_f32 v208, v208
    v_mfma_f32_16x16x32_bf16 v[212:215], a[228:231], v[116:119], v[212:215]
    v_exp_f32 v209, v209
    v_mfma_f32_16x16x32_bf16 v[212:215], a[232:235], v[120:123], v[212:215]
    v_exp_f32 v210, v210
    v_mfma_f32_16x16x32_bf16 v[212:215], a[236:239], v[124:127], v[212:215]
    v_exp_f32 v211, v211
    v_mfma_f32_16x16x32_bf16 a[56:59], a[184:187], v[176:179], a[56:59]
    ds_read_b64_tr_b16 a[168:169], v25 offset:49152
    v_cvt_pk_bf16_f32 v146, v208, v209
    v_mfma_f32_16x16x32_bf16 a[56:59], a[188:191], v[180:183], a[56:59]
    ds_read_b64_tr_b16 a[170:171], v25 offset:53248
    v_mfma_f32_16x16x32_bf16 a[60:63], a[184:187], v[184:187], a[60:63]
    ds_read_b128 a[224:227], v8 offset:12288
    v_cvt_pk_bf16_f32 v147, v210, v211
    v_mfma_f32_16x16x32_bf16 a[60:63], a[188:191], v[188:191], a[60:63]
    s_waitcnt lgkmcnt(3)
    buffer_load_dwordx4 v40, s[12:15], s41 offen offset:2048 lds
    v_mfma_f32_16x16x32_bf16 v[208:211], a[208:211], v[64:67], v[192:195]
    v_exp_f32 v212, v212
    v_mfma_f32_16x16x32_bf16 v[208:211], a[212:215], v[68:71], v[208:211]
    v_exp_f32 v213, v213
    v_mfma_f32_16x16x32_bf16 v[208:211], a[216:219], v[72:75], v[208:211]
    v_exp_f32 v214, v214
    v_mfma_f32_16x16x32_bf16 v[208:211], a[220:223], v[76:79], v[208:211]
    v_exp_f32 v215, v215
    v_mfma_f32_16x16x32_bf16 a[64:67], a[160:163], v[160:163], a[64:67]
    ds_read_b64_tr_b16 a[172:173], v25 offset:57344
    v_cvt_pk_bf16_f32 v154, v212, v213
    v_mfma_f32_16x16x32_bf16 a[64:67], a[164:167], v[164:167], a[64:67]
    ds_read_b64_tr_b16 a[174:175], v25 offset:61440
    v_mfma_f32_16x16x32_bf16 a[68:71], a[160:163], v[168:171], a[68:71]
    ds_read_b128 a[228:231], v9 offset:12288
    v_cvt_pk_bf16_f32 v155, v214, v215
    v_mfma_f32_16x16x32_bf16 a[68:71], a[164:167], v[172:175], a[68:71]
    v_smfmac_f32_16x16x64_bf16 a[204:207], v[52:55], v[184:191], v50
    v_mfma_f32_16x16x32_bf16 v[212:215], a[208:211], v[80:83], v[196:199]
    v_exp_f32 v208, v208
    v_mfma_f32_16x16x32_bf16 v[212:215], a[212:215], v[84:87], v[212:215]
    v_exp_f32 v209, v209
    v_mfma_f32_16x16x32_bf16 v[212:215], a[216:219], v[88:91], v[212:215]
    v_exp_f32 v210, v210
    v_mfma_f32_16x16x32_bf16 v[212:215], a[220:223], v[92:95], v[212:215]
    v_exp_f32 v211, v211
    v_mfma_f32_16x16x32_bf16 a[72:75], a[160:163], v[176:179], a[72:75]
    ds_read_b64_tr_b16 a[176:177], v26 offset:49152
    v_cvt_pk_bf16_f32 v132, v208, v209
    v_mfma_f32_16x16x32_bf16 a[72:75], a[164:167], v[180:183], a[72:75]
    ds_read_b64_tr_b16 a[178:179], v26 offset:53248
    v_mfma_f32_16x16x32_bf16 a[76:79], a[160:163], v[184:187], a[76:79]
    ds_read_b128 a[232:235], v10 offset:12288
    v_cvt_pk_bf16_f32 v133, v210, v211
    v_mfma_f32_16x16x32_bf16 a[76:79], a[164:167], v[188:191], a[76:79]
    s_waitcnt lgkmcnt(3)
    buffer_load_dwordx4 v41, s[12:15], s41 offen offset:3072 lds
    v_mfma_f32_16x16x32_bf16 v[208:211], a[208:211], v[96:99], v[200:203]
    v_exp_f32 v212, v212
    v_mfma_f32_16x16x32_bf16 v[208:211], a[212:215], v[100:103], v[208:211]
    s_add_u32 s41, s41, 16384
    v_exp_f32 v213, v213
    v_mfma_f32_16x16x32_bf16 v[208:211], a[216:219], v[104:107], v[208:211]
    v_exp_f32 v214, v214
    v_mfma_f32_16x16x32_bf16 v[208:211], a[220:223], v[108:111], v[208:211]
    v_exp_f32 v215, v215
    v_mfma_f32_16x16x32_bf16 a[80:83], a[168:171], v[160:163], a[80:83]
    ds_read_b64_tr_b16 a[180:181], v26 offset:57344
    v_cvt_pk_bf16_f32 v140, v212, v213
    v_mfma_f32_16x16x32_bf16 a[80:83], a[172:175], v[164:167], a[80:83]
    ds_read_b64_tr_b16 a[182:183], v26 offset:61440
    v_mfma_f32_16x16x32_bf16 a[84:87], a[168:171], v[168:171], a[84:87]
    ds_read_b128 a[236:239], v11 offset:12288
    v_cvt_pk_bf16_f32 v141, v214, v215
    v_mfma_f32_16x16x32_bf16 a[84:87], a[172:175], v[172:175], a[84:87]
    s_waitcnt vmcnt(9)
    s_barrier
    v_mfma_f32_16x16x32_bf16 v[212:215], a[208:211], v[112:115], v[204:207]
    v_exp_f32 v208, v208
    v_mfma_f32_16x16x32_bf16 v[212:215], a[212:215], v[116:119], v[212:215]
    s_add_u32 m0, s42, 49152
    v_exp_f32 v209, v209
    v_mfma_f32_16x16x32_bf16 v[212:215], a[216:219], v[120:123], v[212:215]
    v_exp_f32 v210, v210
    v_mfma_f32_16x16x32_bf16 v[212:215], a[220:223], v[124:127], v[212:215]
    v_exp_f32 v211, v211
    v_mfma_f32_16x16x32_bf16 a[88:91], a[168:171], v[176:179], a[88:91]
    ds_read_b64_tr_b16 a[184:185], v27 offset:49152
    v_cvt_pk_bf16_f32 v148, v208, v209
    v_mfma_f32_16x16x32_bf16 a[88:91], a[172:175], v[180:183], a[88:91]
    ds_read_b64_tr_b16 a[186:187], v27 offset:53248
    v_mfma_f32_16x16x32_bf16 a[92:95], a[168:171], v[184:187], a[92:95]
    ds_read_b128 a[208:211], v8 offset:16384
    v_cvt_pk_bf16_f32 v149, v210, v211
    v_mfma_f32_16x16x32_bf16 a[92:95], a[172:175], v[188:191], a[92:95]
    s_waitcnt lgkmcnt(3)
    buffer_load_dwordx4 v36, s[8:11], s40 offen lds
    v_mfma_f32_16x16x32_bf16 v[208:211], a[224:227], v[64:67], v[192:195]
    v_exp_f32 v212, v212
    v_mfma_f32_16x16x32_bf16 v[208:211], a[228:231], v[68:71], v[208:211]
    v_exp_f32 v213, v213
    v_mfma_f32_16x16x32_bf16 v[208:211], a[232:235], v[72:75], v[208:211]
    v_exp_f32 v214, v214
    v_mfma_f32_16x16x32_bf16 v[208:211], a[236:239], v[76:79], v[208:211]
    v_exp_f32 v215, v215
    v_mfma_f32_16x16x32_bf16 a[96:99], a[176:179], v[160:163], a[96:99]
    ds_read_b64_tr_b16 a[188:189], v27 offset:57344
    v_cvt_pk_bf16_f32 v156, v212, v213
    v_mfma_f32_16x16x32_bf16 a[96:99], a[180:183], v[164:167], a[96:99]
    ds_read_b64_tr_b16 a[190:191], v27 offset:61440
    v_mfma_f32_16x16x32_bf16 a[100:103], a[176:179], v[168:171], a[100:103]
    ds_read_b128 a[212:215], v9 offset:16384
    v_cvt_pk_bf16_f32 v157, v214, v215
    v_mfma_f32_16x16x32_bf16 a[100:103], a[180:183], v[172:175], a[100:103]
    v_mfma_f32_16x16x32_bf16 v[212:215], a[224:227], v[80:83], v[196:199]
    v_exp_f32 v208, v208
    v_mfma_f32_16x16x32_bf16 v[212:215], a[228:231], v[84:87], v[212:215]
    s_sub_u32 s39, s39, 36864
    v_exp_f32 v209, v209
    v_mfma_f32_16x16x32_bf16 v[212:215], a[232:235], v[88:91], v[212:215]
    s_sub_u32 s38, s38, 4608
    v_exp_f32 v210, v210
    v_mfma_f32_16x16x32_bf16 v[212:215], a[236:239], v[92:95], v[212:215]
    v_exp_f32 v211, v211
    v_mfma_f32_16x16x32_bf16 a[104:107], a[176:179], v[176:179], a[104:107]
    ds_read_b64_tr_b16 a[160:161], v20 offset:0
    v_cvt_pk_bf16_f32 v134, v208, v209
    v_mfma_f32_16x16x32_bf16 a[104:107], a[180:183], v[180:183], a[104:107]
    ds_read_b64_tr_b16 a[162:163], v20 offset:4096
    v_mfma_f32_16x16x32_bf16 a[108:111], a[176:179], v[184:187], a[108:111]
    ds_read_b128 a[216:219], v10 offset:16384
    v_cvt_pk_bf16_f32 v135, v210, v211
    v_mfma_f32_16x16x32_bf16 a[108:111], a[180:183], v[188:191], a[108:111]
    s_waitcnt lgkmcnt(3)
    buffer_load_dwordx4 v37, s[8:11], s40 offen offset:1024 lds
    v_mfma_f32_16x16x32_bf16 v[208:211], a[224:227], v[96:99], v[200:203]
    v_exp_f32 v212, v212
    v_mfma_f32_16x16x32_bf16 v[208:211], a[228:231], v[100:103], v[208:211]
    v_exp_f32 v213, v213
    v_mfma_f32_16x16x32_bf16 v[208:211], a[232:235], v[104:107], v[208:211]
    v_exp_f32 v214, v214
    v_mfma_f32_16x16x32_bf16 v[208:211], a[236:239], v[108:111], v[208:211]
    v_exp_f32 v215, v215
    v_mfma_f32_16x16x32_bf16 a[112:115], a[184:187], v[160:163], a[112:115]
    ds_read_b64_tr_b16 a[164:165], v20 offset:8192
    v_cvt_pk_bf16_f32 v142, v212, v213
    v_mfma_f32_16x16x32_bf16 a[112:115], a[188:191], v[164:167], a[112:115]
    ds_read_b64_tr_b16 a[166:167], v20 offset:12288
    v_mfma_f32_16x16x32_bf16 a[116:119], a[184:187], v[168:171], a[116:119]
    ds_read_b128 a[220:223], v11 offset:16384
    v_cvt_pk_bf16_f32 v143, v214, v215
    v_mfma_f32_16x16x32_bf16 a[116:119], a[188:191], v[172:175], a[116:119]
    v_mfma_f32_16x16x32_bf16 v[212:215], a[224:227], v[112:115], v[204:207]
    v_exp_f32 v208, v208
    v_mfma_f32_16x16x32_bf16 v[212:215], a[228:231], v[116:119], v[212:215]
    v_exp_f32 v209, v209
    v_mfma_f32_16x16x32_bf16 v[212:215], a[232:235], v[120:123], v[212:215]
    v_exp_f32 v210, v210
    v_mfma_f32_16x16x32_bf16 v[212:215], a[236:239], v[124:127], v[212:215]
    v_exp_f32 v211, v211
    v_mfma_f32_16x16x32_bf16 a[120:123], a[184:187], v[176:179], a[120:123]
    ds_read_b64_tr_b16 a[168:169], v21 offset:0
    v_cvt_pk_bf16_f32 v150, v208, v209
    v_mfma_f32_16x16x32_bf16 a[120:123], a[188:191], v[180:183], a[120:123]
    ds_read_b64_tr_b16 a[170:171], v21 offset:4096
    v_mfma_f32_16x16x32_bf16 a[124:127], a[184:187], v[184:187], a[124:127]
    ds_read_b128 a[224:227], v8 offset:20480
    v_cvt_pk_bf16_f32 v151, v210, v211
    v_mfma_f32_16x16x32_bf16 a[124:127], a[188:191], v[188:191], a[124:127]
    s_waitcnt lgkmcnt(3)
    buffer_load_dwordx4 v38, s[8:11], s40 offen offset:2048 lds
    s_sub_u32 s43, s43, 1
    s_cmp_lg_u32 s43, 0
    s_cbranch_scc1 Lattn_loop
    v_mfma_f32_16x16x32_bf16 v[208:211], a[208:211], v[64:67], v[192:195]
    v_exp_f32 v212, v212
    v_mfma_f32_16x16x32_bf16 v[208:211], a[212:215], v[68:71], v[208:211]
    v_exp_f32 v213, v213
    v_mfma_f32_16x16x32_bf16 v[208:211], a[216:219], v[72:75], v[208:211]
    v_exp_f32 v214, v214
    v_mfma_f32_16x16x32_bf16 v[208:211], a[220:223], v[76:79], v[208:211]
    s_add_u32 s57, s58, 0
    v_exp_f32 v215, v215
    v_mfma_f32_16x16x32_bf16 a[0:3], a[160:163], v[128:131], a[0:3]
    ds_read_b64_tr_b16 a[172:173], v21 offset:8192
    v_cvt_pk_bf16_f32 v158, v212, v213
    v_mfma_f32_16x16x32_bf16 a[0:3], a[164:167], v[132:135], a[0:3]
    ds_read_b64_tr_b16 a[174:175], v21 offset:12288
    v_mfma_f32_16x16x32_bf16 a[4:7], a[160:163], v[136:139], a[4:7]
    ds_read_b128 a[228:231], v9 offset:20480
    v_cvt_pk_bf16_f32 v159, v214, v215
    v_mfma_f32_16x16x32_bf16 a[4:7], a[164:167], v[140:143], a[4:7]
    buffer_load_dwordx4 a[128:131], v254, s[80:83], s57 offen
    v_mfma_f32_16x16x32_bf16 v[212:215], a[208:211], v[80:83], v[196:199]
    v_exp_f32 v208, v208
    v_mfma_f32_16x16x32_bf16 v[212:215], a[212:215], v[84:87], v[212:215]
    v_exp_f32 v209, v209
    v_mfma_f32_16x16x32_bf16 v[212:215], a[216:219], v[88:91], v[212:215]
    v_exp_f32 v210, v210
    v_mfma_f32_16x16x32_bf16 v[212:215], a[220:223], v[92:95], v[212:215]
    v_exp_f32 v211, v211
    v_mfma_f32_16x16x32_bf16 a[8:11], a[160:163], v[144:147], a[8:11]
    ds_read_b64_tr_b16 a[176:177], v22 offset:0
    v_cvt_pk_bf16_f32 v160, v208, v209
    v_mfma_f32_16x16x32_bf16 a[8:11], a[164:167], v[148:151], a[8:11]
    ds_read_b64_tr_b16 a[178:179], v22 offset:4096
    v_mfma_f32_16x16x32_bf16 a[12:15], a[160:163], v[152:155], a[12:15]
    ds_read_b128 a[232:235], v10 offset:20480
    v_cvt_pk_bf16_f32 v161, v210, v211
    v_mfma_f32_16x16x32_bf16 a[12:15], a[164:167], v[156:159], a[12:15]
    s_waitcnt lgkmcnt(3)
    buffer_load_dwordx4 v39, s[8:11], s40 offen offset:3072 lds
    v_mfma_f32_16x16x32_bf16 v[208:211], a[208:211], v[96:99], v[200:203]
    v_exp_f32 v212, v212
    v_mfma_f32_16x16x32_bf16 v[208:211], a[212:215], v[100:103], v[208:211]
    s_add_u32 s40, s40, 16384
    v_exp_f32 v213, v213
    v_mfma_f32_16x16x32_bf16 v[208:211], a[216:219], v[104:107], v[208:211]
    v_exp_f32 v214, v214
    v_mfma_f32_16x16x32_bf16 v[208:211], a[220:223], v[108:111], v[208:211]
    v_exp_f32 v215, v215
    v_mfma_f32_16x16x32_bf16 a[16:19], a[168:171], v[128:131], a[16:19]
    ds_read_b64_tr_b16 a[180:181], v22 offset:8192
    v_cvt_pk_bf16_f32 v168, v212, v213
    v_mfma_f32_16x16x32_bf16 a[16:19], a[172:175], v[132:135], a[16:19]
    ds_read_b64_tr_b16 a[182:183], v22 offset:12288
    v_mfma_f32_16x16x32_bf16 a[20:23], a[168:171], v[136:139], a[20:23]
    ds_read_b128 a[236:239], v11 offset:20480
    v_cvt_pk_bf16_f32 v169, v214, v215
    v_mfma_f32_16x16x32_bf16 a[20:23], a[172:175], v[140:143], a[20:23]
    v_smfmac_f32_16x16x64_bf16 a[192:195], v[52:55], v[128:135], v50
    v_mfma_f32_16x16x32_bf16 v[212:215], a[208:211], v[112:115], v[204:207]
    v_exp_f32 v208, v208
    v_mfma_f32_16x16x32_bf16 v[212:215], a[212:215], v[116:119], v[212:215]
    s_add_u32 m0, s42, 98304
    v_exp_f32 v209, v209
    v_mfma_f32_16x16x32_bf16 v[212:215], a[216:219], v[120:123], v[212:215]
    v_exp_f32 v210, v210
    v_mfma_f32_16x16x32_bf16 v[212:215], a[220:223], v[124:127], v[212:215]
    v_exp_f32 v211, v211
    v_mfma_f32_16x16x32_bf16 a[24:27], a[168:171], v[144:147], a[24:27]
    ds_read_b64_tr_b16 a[184:185], v23 offset:0
    v_cvt_pk_bf16_f32 v176, v208, v209
    v_mfma_f32_16x16x32_bf16 a[24:27], a[172:175], v[148:151], a[24:27]
    ds_read_b64_tr_b16 a[186:187], v23 offset:4096
    v_mfma_f32_16x16x32_bf16 a[28:31], a[168:171], v[152:155], a[28:31]
    ds_read_b128 a[208:211], v8 offset:24576
    v_cvt_pk_bf16_f32 v177, v210, v211
    v_mfma_f32_16x16x32_bf16 a[28:31], a[172:175], v[156:159], a[28:31]
    s_waitcnt lgkmcnt(3)
    buffer_load_dwordx4 v40, s[12:15], s41 offen lds
    v_mfma_f32_16x16x32_bf16 v[208:211], a[224:227], v[64:67], v[192:195]
    v_exp_f32 v212, v212
    v_mfma_f32_16x16x32_bf16 v[208:211], a[228:231], v[68:71], v[208:211]
    v_exp_f32 v213, v213
    v_mfma_f32_16x16x32_bf16 v[208:211], a[232:235], v[72:75], v[208:211]
    v_exp_f32 v214, v214
    v_mfma_f32_16x16x32_bf16 v[208:211], a[236:239], v[76:79], v[208:211]
    s_add_u32 s57, s58, 589824
    v_exp_f32 v215, v215
    v_mfma_f32_16x16x32_bf16 a[32:35], a[176:179], v[128:131], a[32:35]
    ds_read_b64_tr_b16 a[188:189], v23 offset:8192
    v_cvt_pk_bf16_f32 v184, v212, v213
    v_mfma_f32_16x16x32_bf16 a[32:35], a[180:183], v[132:135], a[32:35]
    ds_read_b64_tr_b16 a[190:191], v23 offset:12288
    v_mfma_f32_16x16x32_bf16 a[36:39], a[176:179], v[136:139], a[36:39]
    ds_read_b128 a[212:215], v9 offset:24576
    v_cvt_pk_bf16_f32 v185, v214, v215
    v_mfma_f32_16x16x32_bf16 a[36:39], a[180:183], v[140:143], a[36:39]
    buffer_load_dwordx4 a[132:135], v254, s[80:83], s57 offen
    v_smfmac_f32_16x16x64_bf16 a[196:199], v[52:55], v[136:143], v50
    v_mfma_f32_16x16x32_bf16 v[212:215], a[224:227], v[80:83], v[196:199]
    v_exp_f32 v208, v208
    v_mfma_f32_16x16x32_bf16 v[212:215], a[228:231], v[84:87], v[212:215]
    v_exp_f32 v209, v209
    v_mfma_f32_16x16x32_bf16 v[212:215], a[232:235], v[88:91], v[212:215]
    v_exp_f32 v210, v210
    v_mfma_f32_16x16x32_bf16 v[212:215], a[236:239], v[92:95], v[212:215]
    v_exp_f32 v211, v211
    v_mfma_f32_16x16x32_bf16 a[40:43], a[176:179], v[144:147], a[40:43]
    ds_read_b64_tr_b16 a[160:161], v24 offset:0
    v_cvt_pk_bf16_f32 v162, v208, v209
    v_mfma_f32_16x16x32_bf16 a[40:43], a[180:183], v[148:151], a[40:43]
    ds_read_b64_tr_b16 a[162:163], v24 offset:4096
    v_mfma_f32_16x16x32_bf16 a[44:47], a[176:179], v[152:155], a[44:47]
    ds_read_b128 a[216:219], v10 offset:24576
    v_cvt_pk_bf16_f32 v163, v210, v211
    v_mfma_f32_16x16x32_bf16 a[44:47], a[180:183], v[156:159], a[44:47]
    s_waitcnt lgkmcnt(3)
    buffer_load_dwordx4 v41, s[12:15], s41 offen offset:1024 lds
    v_mfma_f32_16x16x32_bf16 v[208:211], a[224:227], v[96:99], v[200:203]
    v_exp_f32 v212, v212
    v_mfma_f32_16x16x32_bf16 v[208:211], a[228:231], v[100:103], v[208:211]
    v_exp_f32 v213, v213
    v_mfma_f32_16x16x32_bf16 v[208:211], a[232:235], v[104:107], v[208:211]
    v_exp_f32 v214, v214
    v_mfma_f32_16x16x32_bf16 v[208:211], a[236:239], v[108:111], v[208:211]
    v_exp_f32 v215, v215
    v_mfma_f32_16x16x32_bf16 a[48:51], a[184:187], v[128:131], a[48:51]
    ds_read_b64_tr_b16 a[164:165], v24 offset:8192
    v_cvt_pk_bf16_f32 v170, v212, v213
    v_mfma_f32_16x16x32_bf16 a[48:51], a[188:191], v[132:135], a[48:51]
    ds_read_b64_tr_b16 a[166:167], v24 offset:12288
    v_mfma_f32_16x16x32_bf16 a[52:55], a[184:187], v[136:139], a[52:55]
    ds_read_b128 a[220:223], v11 offset:24576
    v_cvt_pk_bf16_f32 v171, v214, v215
    v_mfma_f32_16x16x32_bf16 a[52:55], a[188:191], v[140:143], a[52:55]
    v_smfmac_f32_16x16x64_bf16 a[200:203], v[52:55], v[144:151], v50
    v_mfma_f32_16x16x32_bf16 v[212:215], a[224:227], v[112:115], v[204:207]
    v_exp_f32 v208, v208
    v_mfma_f32_16x16x32_bf16 v[212:215], a[228:231], v[116:119], v[212:215]
    v_exp_f32 v209, v209
    v_mfma_f32_16x16x32_bf16 v[212:215], a[232:235], v[120:123], v[212:215]
    v_exp_f32 v210, v210
    v_mfma_f32_16x16x32_bf16 v[212:215], a[236:239], v[124:127], v[212:215]
    v_exp_f32 v211, v211
    v_mfma_f32_16x16x32_bf16 a[56:59], a[184:187], v[144:147], a[56:59]
    ds_read_b64_tr_b16 a[168:169], v25 offset:0
    v_cvt_pk_bf16_f32 v178, v208, v209
    v_mfma_f32_16x16x32_bf16 a[56:59], a[188:191], v[148:151], a[56:59]
    ds_read_b64_tr_b16 a[170:171], v25 offset:4096
    v_mfma_f32_16x16x32_bf16 a[60:63], a[184:187], v[152:155], a[60:63]
    ds_read_b128 a[224:227], v8 offset:28672
    v_cvt_pk_bf16_f32 v179, v210, v211
    v_mfma_f32_16x16x32_bf16 a[60:63], a[188:191], v[156:159], a[60:63]
    s_waitcnt lgkmcnt(3)
    buffer_load_dwordx4 v40, s[12:15], s41 offen offset:2048 lds
    v_mfma_f32_16x16x32_bf16 v[208:211], a[208:211], v[64:67], v[192:195]
    v_exp_f32 v212, v212
    v_mfma_f32_16x16x32_bf16 v[208:211], a[212:215], v[68:71], v[208:211]
    v_exp_f32 v213, v213
    v_mfma_f32_16x16x32_bf16 v[208:211], a[216:219], v[72:75], v[208:211]
    v_exp_f32 v214, v214
    v_mfma_f32_16x16x32_bf16 v[208:211], a[220:223], v[76:79], v[208:211]
    s_add_u32 s57, s58, 1179648
    v_exp_f32 v215, v215
    v_mfma_f32_16x16x32_bf16 a[64:67], a[160:163], v[128:131], a[64:67]
    ds_read_b64_tr_b16 a[172:173], v25 offset:8192
    v_cvt_pk_bf16_f32 v186, v212, v213
    v_mfma_f32_16x16x32_bf16 a[64:67], a[164:167], v[132:135], a[64:67]
    ds_read_b64_tr_b16 a[174:175], v25 offset:12288
    v_mfma_f32_16x16x32_bf16 a[68:71], a[160:163], v[136:139], a[68:71]
    ds_read_b128 a[228:231], v9 offset:28672
    v_cvt_pk_bf16_f32 v187, v214, v215
    v_mfma_f32_16x16x32_bf16 a[68:71], a[164:167], v[140:143], a[68:71]
    buffer_load_dwordx4 a[136:139], v254, s[80:83], s57 offen
    v_smfmac_f32_16x16x64_bf16 a[204:207], v[52:55], v[152:159], v50
    v_mfma_f32_16x16x32_bf16 v[212:215], a[208:211], v[80:83], v[196:199]
    v_exp_f32 v208, v208
    v_mfma_f32_16x16x32_bf16 v[212:215], a[212:215], v[84:87], v[212:215]
    v_exp_f32 v209, v209
    v_mfma_f32_16x16x32_bf16 v[212:215], a[216:219], v[88:91], v[212:215]
    v_exp_f32 v210, v210
    v_mfma_f32_16x16x32_bf16 v[212:215], a[220:223], v[92:95], v[212:215]
    v_exp_f32 v211, v211
    v_mfma_f32_16x16x32_bf16 a[72:75], a[160:163], v[144:147], a[72:75]
    ds_read_b64_tr_b16 a[176:177], v26 offset:0
    v_cvt_pk_bf16_f32 v164, v208, v209
    v_mfma_f32_16x16x32_bf16 a[72:75], a[164:167], v[148:151], a[72:75]
    ds_read_b64_tr_b16 a[178:179], v26 offset:4096
    v_mfma_f32_16x16x32_bf16 a[76:79], a[160:163], v[152:155], a[76:79]
    ds_read_b128 a[232:235], v10 offset:28672
    v_cvt_pk_bf16_f32 v165, v210, v211
    v_mfma_f32_16x16x32_bf16 a[76:79], a[164:167], v[156:159], a[76:79]
    s_waitcnt lgkmcnt(3)
    buffer_load_dwordx4 v41, s[12:15], s41 offen offset:3072 lds
    v_mfma_f32_16x16x32_bf16 v[208:211], a[208:211], v[96:99], v[200:203]
    v_exp_f32 v212, v212
    v_mfma_f32_16x16x32_bf16 v[208:211], a[212:215], v[100:103], v[208:211]
    s_add_u32 s41, s41, 16384
    v_exp_f32 v213, v213
    v_mfma_f32_16x16x32_bf16 v[208:211], a[216:219], v[104:107], v[208:211]
    v_exp_f32 v214, v214
    v_mfma_f32_16x16x32_bf16 v[208:211], a[220:223], v[108:111], v[208:211]
    v_exp_f32 v215, v215
    v_mfma_f32_16x16x32_bf16 a[80:83], a[168:171], v[128:131], a[80:83]
    ds_read_b64_tr_b16 a[180:181], v26 offset:8192
    v_cvt_pk_bf16_f32 v172, v212, v213
    v_mfma_f32_16x16x32_bf16 a[80:83], a[172:175], v[132:135], a[80:83]
    ds_read_b64_tr_b16 a[182:183], v26 offset:12288
    v_mfma_f32_16x16x32_bf16 a[84:87], a[168:171], v[136:139], a[84:87]
    ds_read_b128 a[236:239], v11 offset:28672
    v_cvt_pk_bf16_f32 v173, v214, v215
    v_mfma_f32_16x16x32_bf16 a[84:87], a[172:175], v[140:143], a[84:87]
    s_waitcnt vmcnt(11)
    s_barrier
    v_mfma_f32_16x16x32_bf16 v[212:215], a[208:211], v[112:115], v[204:207]
    v_exp_f32 v208, v208
    v_mfma_f32_16x16x32_bf16 v[212:215], a[212:215], v[116:119], v[212:215]
    s_add_u32 s49, s45, 0
    v_exp_f32 v209, v209
    v_mfma_f32_16x16x32_bf16 v[212:215], a[216:219], v[120:123], v[212:215]
    s_add_u32 m0, s42, 131072
    v_exp_f32 v210, v210
    v_mfma_f32_16x16x32_bf16 v[212:215], a[220:223], v[124:127], v[212:215]
    v_exp_f32 v211, v211
    v_mfma_f32_16x16x32_bf16 a[88:91], a[168:171], v[144:147], a[88:91]
    ds_read_b64_tr_b16 a[184:185], v27 offset:0
    v_cvt_pk_bf16_f32 v180, v208, v209
    v_mfma_f32_16x16x32_bf16 a[88:91], a[172:175], v[148:151], a[88:91]
    ds_read_b64_tr_b16 a[186:187], v27 offset:4096
    v_mfma_f32_16x16x32_bf16 a[92:95], a[168:171], v[152:155], a[92:95]
    ds_read_b128 a[208:211], v8 offset:32768
    v_cvt_pk_bf16_f32 v181, v210, v211
    v_mfma_f32_16x16x32_bf16 a[92:95], a[172:175], v[156:159], a[92:95]
    s_waitcnt lgkmcnt(3)
    buffer_load_dwordx4 v46, s[20:23], s49 offen lds
    v_mfma_f32_16x16x32_bf16 v[208:211], a[224:227], v[64:67], v[192:195]
    v_exp_f32 v212, v212
    v_mfma_f32_16x16x32_bf16 v[208:211], a[228:231], v[68:71], v[208:211]
    v_exp_f32 v213, v213
    v_mfma_f32_16x16x32_bf16 v[208:211], a[232:235], v[72:75], v[208:211]
    v_exp_f32 v214, v214
    v_mfma_f32_16x16x32_bf16 v[208:211], a[236:239], v[76:79], v[208:211]
    v_exp_f32 v215, v215
    v_mfma_f32_16x16x32_bf16 a[96:99], a[176:179], v[128:131], a[96:99]
    ds_read_b64_tr_b16 a[188:189], v27 offset:8192
    v_cvt_pk_bf16_f32 v188, v212, v213
    v_mfma_f32_16x16x32_bf16 a[96:99], a[180:183], v[132:135], a[96:99]
    ds_read_b64_tr_b16 a[190:191], v27 offset:12288
    v_mfma_f32_16x16x32_bf16 a[100:103], a[176:179], v[136:139], a[100:103]
    ds_read_b128 a[212:215], v9 offset:32768
    v_cvt_pk_bf16_f32 v189, v214, v215
    v_mfma_f32_16x16x32_bf16 a[100:103], a[180:183], v[140:143], a[100:103]
    v_mfma_f32_16x16x32_bf16 v[212:215], a[224:227], v[80:83], v[196:199]
    v_exp_f32 v208, v208
    v_mfma_f32_16x16x32_bf16 v[212:215], a[228:231], v[84:87], v[212:215]
    v_exp_f32 v209, v209
    v_mfma_f32_16x16x32_bf16 v[212:215], a[232:235], v[88:91], v[212:215]
    v_exp_f32 v210, v210
    v_mfma_f32_16x16x32_bf16 v[212:215], a[236:239], v[92:95], v[212:215]
    v_exp_f32 v211, v211
    v_mfma_f32_16x16x32_bf16 a[104:107], a[176:179], v[144:147], a[104:107]
    ds_read_b64_tr_b16 a[160:161], v20 offset:16384
    v_cvt_pk_bf16_f32 v166, v208, v209
    v_mfma_f32_16x16x32_bf16 a[104:107], a[180:183], v[148:151], a[104:107]
    ds_read_b64_tr_b16 a[162:163], v20 offset:20480
    v_mfma_f32_16x16x32_bf16 a[108:111], a[176:179], v[152:155], a[108:111]
    ds_read_b128 a[216:219], v10 offset:32768
    v_cvt_pk_bf16_f32 v167, v210, v211
    v_mfma_f32_16x16x32_bf16 a[108:111], a[180:183], v[156:159], a[108:111]
    s_waitcnt lgkmcnt(3)
    buffer_load_dwordx4 v47, s[20:23], s49 offen offset:1024 lds
    v_mfma_f32_16x16x32_bf16 v[208:211], a[224:227], v[96:99], v[200:203]
    v_exp_f32 v212, v212
    v_mfma_f32_16x16x32_bf16 v[208:211], a[228:231], v[100:103], v[208:211]
    v_exp_f32 v213, v213
    v_mfma_f32_16x16x32_bf16 v[208:211], a[232:235], v[104:107], v[208:211]
    v_exp_f32 v214, v214
    v_mfma_f32_16x16x32_bf16 v[208:211], a[236:239], v[108:111], v[208:211]
    s_add_u32 s57, s58, 1769472
    v_exp_f32 v215, v215
    v_mfma_f32_16x16x32_bf16 a[112:115], a[184:187], v[128:131], a[112:115]
    ds_read_b64_tr_b16 a[164:165], v20 offset:24576
    v_cvt_pk_bf16_f32 v174, v212, v213
    v_mfma_f32_16x16x32_bf16 a[112:115], a[188:191], v[132:135], a[112:115]
    ds_read_b64_tr_b16 a[166:167], v20 offset:28672
    v_mfma_f32_16x16x32_bf16 a[116:119], a[184:187], v[136:139], a[116:119]
    ds_read_b128 a[220:223], v11 offset:32768
    v_cvt_pk_bf16_f32 v175, v214, v215
    v_mfma_f32_16x16x32_bf16 a[116:119], a[188:191], v[140:143], a[116:119]
    buffer_load_dwordx4 a[140:143], v254, s[80:83], s57 offen
    v_mfma_f32_16x16x32_bf16 v[212:215], a[224:227], v[112:115], v[204:207]
    v_exp_f32 v208, v208
    v_mfma_f32_16x16x32_bf16 v[212:215], a[228:231], v[116:119], v[212:215]
    v_exp_f32 v209, v209
    v_mfma_f32_16x16x32_bf16 v[212:215], a[232:235], v[120:123], v[212:215]
    v_exp_f32 v210, v210
    v_mfma_f32_16x16x32_bf16 v[212:215], a[236:239], v[124:127], v[212:215]
    v_exp_f32 v211, v211
    v_mfma_f32_16x16x32_bf16 a[120:123], a[184:187], v[144:147], a[120:123]
    ds_read_b64_tr_b16 a[168:169], v21 offset:16384
    v_cvt_pk_bf16_f32 v182, v208, v209
    v_mfma_f32_16x16x32_bf16 a[120:123], a[188:191], v[148:151], a[120:123]
    ds_read_b64_tr_b16 a[170:171], v21 offset:20480
    v_mfma_f32_16x16x32_bf16 a[124:127], a[184:187], v[152:155], a[124:127]
    ds_read_b128 a[224:227], v8 offset:36864
    v_cvt_pk_bf16_f32 v183, v210, v211
    v_mfma_f32_16x16x32_bf16 a[124:127], a[188:191], v[156:159], a[124:127]
    s_waitcnt lgkmcnt(3)
    buffer_load_dwordx4 v48, s[20:23], s49 offen offset:2048 lds
    v_mfma_f32_16x16x32_bf16 v[208:211], a[208:211], v[64:67], v[192:195]
    v_exp_f32 v212, v212
    v_mfma_f32_16x16x32_bf16 v[208:211], a[212:215], v[68:71], v[208:211]
    v_exp_f32 v213, v213
    v_mfma_f32_16x16x32_bf16 v[208:211], a[216:219], v[72:75], v[208:211]
    v_exp_f32 v214, v214
    v_mfma_f32_16x16x32_bf16 v[208:211], a[220:223], v[76:79], v[208:211]
    s_add_u32 s57, s58, 2359296
    v_exp_f32 v215, v215
    v_mfma_f32_16x16x32_bf16 a[0:3], a[160:163], v[160:163], a[0:3]
    ds_read_b64_tr_b16 a[172:173], v21 offset:24576
    v_cvt_pk_bf16_f32 v190, v212, v213
    v_mfma_f32_16x16x32_bf16 a[0:3], a[164:167], v[164:167], a[0:3]
    ds_read_b64_tr_b16 a[174:175], v21 offset:28672
    v_mov_b32 v63, 0
    v_mfma_f32_16x16x32_bf16 a[4:7], a[160:163], v[168:171], a[4:7]
    ds_read_b128 a[228:231], v9 offset:36864
    v_cvt_pk_bf16_f32 v191, v214, v215
    v_mfma_f32_16x16x32_bf16 a[4:7], a[164:167], v[172:175], a[4:7]
    buffer_load_dwordx4 a[144:147], v254, s[80:83], s57 offen
    v_mfma_f32_16x16x32_bf16 v[212:215], a[208:211], v[80:83], v[196:199]
    v_exp_f32 v208, v208
    v_mfma_f32_16x16x32_bf16 v[212:215], a[212:215], v[84:87], v[212:215]
    v_exp_f32 v209, v209
    v_mfma_f32_16x16x32_bf16 v[212:215], a[216:219], v[88:91], v[212:215]
    v_exp_f32 v210, v210
    v_mfma_f32_16x16x32_bf16 v[212:215], a[220:223], v[92:95], v[212:215]
    v_exp_f32 v211, v211
    v_mfma_f32_16x16x32_bf16 a[8:11], a[160:163], v[176:179], a[8:11]
    ds_read_b64_tr_b16 a[176:177], v22 offset:16384
    v_cvt_pk_bf16_f32 v128, v208, v209
    v_mfma_f32_16x16x32_bf16 a[8:11], a[164:167], v[180:183], a[8:11]
    ds_read_b64_tr_b16 a[178:179], v22 offset:20480
    v_mfma_f32_16x16x32_bf16 a[12:15], a[160:163], v[184:187], a[12:15]
    ds_read_b128 a[232:235], v10 offset:36864
    v_cvt_pk_bf16_f32 v129, v210, v211
    v_mfma_f32_16x16x32_bf16 a[12:15], a[164:167], v[188:191], a[12:15]
    s_waitcnt lgkmcnt(3)
    buffer_load_dwordx4 v49, s[20:23], s49 offen offset:3072 lds
    v_mfma_f32_16x16x32_bf16 v[208:211], a[208:211], v[96:99], v[200:203]
    v_exp_f32 v212, v212
    v_mfma_f32_16x16x32_bf16 v[208:211], a[212:215], v[100:103], v[208:211]
    v_exp_f32 v213, v213
    v_mfma_f32_16x16x32_bf16 v[208:211], a[216:219], v[104:107], v[208:211]
    v_exp_f32 v214, v214
    v_mfma_f32_16x16x32_bf16 v[208:211], a[220:223], v[108:111], v[208:211]
    v_exp_f32 v215, v215
    v_mfma_f32_16x16x32_bf16 a[16:19], a[168:171], v[160:163], a[16:19]
    ds_read_b64_tr_b16 a[180:181], v22 offset:24576
    v_cvt_pk_bf16_f32 v136, v212, v213
    v_mfma_f32_16x16x32_bf16 a[16:19], a[172:175], v[164:167], a[16:19]
    ds_read_b64_tr_b16 a[182:183], v22 offset:28672
    v_mfma_f32_16x16x32_bf16 a[20:23], a[168:171], v[168:171], a[20:23]
    ds_read_b128 a[236:239], v11 offset:36864
    v_cvt_pk_bf16_f32 v137, v214, v215
    v_mfma_f32_16x16x32_bf16 a[20:23], a[172:175], v[172:175], a[20:23]
    v_smfmac_f32_16x16x64_bf16 a[192:195], v[52:55], v[160:167], v50
    v_mfma_f32_16x16x32_bf16 v[212:215], a[208:211], v[112:115], v[204:207]
    v_exp_f32 v208, v208
    v_mfma_f32_16x16x32_bf16 v[212:215], a[212:215], v[116:119], v[212:215]
    s_add_u32 m0, s42, 114688
    v_exp_f32 v209, v209
    v_mfma_f32_16x16x32_bf16 v[212:215], a[216:219], v[120:123], v[212:215]
    v_exp_f32 v210, v210
    v_mfma_f32_16x16x32_bf16 v[212:215], a[220:223], v[124:127], v[212:215]
    v_exp_f32 v211, v211
    v_mfma_f32_16x16x32_bf16 a[24:27], a[168:171], v[176:179], a[24:27]
    ds_read_b64_tr_b16 a[184:185], v23 offset:16384
    v_cvt_pk_bf16_f32 v144, v208, v209
    v_mfma_f32_16x16x32_bf16 a[24:27], a[172:175], v[180:183], a[24:27]
    ds_read_b64_tr_b16 a[186:187], v23 offset:20480
    v_mfma_f32_16x16x32_bf16 a[28:31], a[168:171], v[184:187], a[28:31]
    ds_read_b128 a[208:211], v8 offset:40960
    v_cvt_pk_bf16_f32 v145, v210, v211
    v_mfma_f32_16x16x32_bf16 a[28:31], a[172:175], v[188:191], a[28:31]
    s_waitcnt lgkmcnt(3)
    buffer_load_dwordx4 v40, s[12:15], s41 offen lds
    v_mfma_f32_16x16x32_bf16 v[208:211], a[224:227], v[64:67], v[192:195]
    v_exp_f32 v212, v212
    v_mfma_f32_16x16x32_bf16 v[208:211], a[228:231], v[68:71], v[208:211]
    v_exp_f32 v213, v213
    v_mfma_f32_16x16x32_bf16 v[208:211], a[232:235], v[72:75], v[208:211]
    v_exp_f32 v214, v214
    v_mfma_f32_16x16x32_bf16 v[208:211], a[236:239], v[76:79], v[208:211]
    s_add_u32 s57, s58, 2949120
    v_exp_f32 v215, v215
    v_mfma_f32_16x16x32_bf16 a[32:35], a[176:179], v[160:163], a[32:35]
    ds_read_b64_tr_b16 a[188:189], v23 offset:24576
    v_cvt_pk_bf16_f32 v152, v212, v213
    v_mfma_f32_16x16x32_bf16 a[32:35], a[180:183], v[164:167], a[32:35]
    ds_read_b64_tr_b16 a[190:191], v23 offset:28672
    v_mfma_f32_16x16x32_bf16 a[36:39], a[176:179], v[168:171], a[36:39]
    ds_read_b128 a[212:215], v9 offset:40960
    v_cvt_pk_bf16_f32 v153, v214, v215
    v_mfma_f32_16x16x32_bf16 a[36:39], a[180:183], v[172:175], a[36:39]
    buffer_load_dwordx4 a[148:151], v254, s[80:83], s57 offen
    v_smfmac_f32_16x16x64_bf16 a[196:199], v[52:55], v[168:175], v50
    v_mfma_f32_16x16x32_bf16 v[212:215], a[224:227], v[80:83], v[196:199]
    v_exp_f32 v208, v208
    v_mfma_f32_16x16x32_bf16 v[212:215], a[228:231], v[84:87], v[212:215]
    v_exp_f32 v209, v209
    v_mfma_f32_16x16x32_bf16 v[212:215], a[232:235], v[88:91], v[212:215]
    v_exp_f32 v210, v210
    v_mfma_f32_16x16x32_bf16 v[212:215], a[236:239], v[92:95], v[212:215]
    v_exp_f32 v211, v211
    v_mfma_f32_16x16x32_bf16 a[40:43], a[176:179], v[176:179], a[40:43]
    ds_read_b64_tr_b16 a[160:161], v24 offset:16384
    v_cvt_pk_bf16_f32 v130, v208, v209
    v_mfma_f32_16x16x32_bf16 a[40:43], a[180:183], v[180:183], a[40:43]
    ds_read_b64_tr_b16 a[162:163], v24 offset:20480
    v_mfma_f32_16x16x32_bf16 a[44:47], a[176:179], v[184:187], a[44:47]
    ds_read_b128 a[216:219], v10 offset:40960
    v_cvt_pk_bf16_f32 v131, v210, v211
    v_mfma_f32_16x16x32_bf16 a[44:47], a[180:183], v[188:191], a[44:47]
    s_waitcnt lgkmcnt(3)
    buffer_load_dwordx4 v41, s[12:15], s41 offen offset:1024 lds
    v_mfma_f32_16x16x32_bf16 v[208:211], a[224:227], v[96:99], v[200:203]
    v_exp_f32 v212, v212
    v_mfma_f32_16x16x32_bf16 v[208:211], a[228:231], v[100:103], v[208:211]
    v_exp_f32 v213, v213
    v_mfma_f32_16x16x32_bf16 v[208:211], a[232:235], v[104:107], v[208:211]
    v_exp_f32 v214, v214
    v_mfma_f32_16x16x32_bf16 v[208:211], a[236:239], v[108:111], v[208:211]
    v_exp_f32 v215, v215
    v_mfma_f32_16x16x32_bf16 a[48:51], a[184:187], v[160:163], a[48:51]
    ds_read_b64_tr_b16 a[164:165], v24 offset:24576
    v_cvt_pk_bf16_f32 v138, v212, v213
    v_mfma_f32_16x16x32_bf16 a[48:51], a[188:191], v[164:167], a[48:51]
    ds_read_b64_tr_b16 a[166:167], v24 offset:28672
    v_mfma_f32_16x16x32_bf16 a[52:55], a[184:187], v[168:171], a[52:55]
    ds_read_b128 a[220:223], v11 offset:40960
    v_cvt_pk_bf16_f32 v139, v214, v215
    v_mfma_f32_16x16x32_bf16 a[52:55], a[188:191], v[172:175], a[52:55]
    v_smfmac_f32_16x16x64_bf16 a[200:203], v[52:55], v[176:183], v50
    v_mfma_f32_16x16x32_bf16 v[212:215], a[224:227], v[112:115], v[204:207]
    v_exp_f32 v208, v208
    v_mfma_f32_16x16x32_bf16 v[212:215], a[228:231], v[116:119], v[212:215]
    v_exp_f32 v209, v209
    v_mfma_f32_16x16x32_bf16 v[212:215], a[232:235], v[120:123], v[212:215]
    v_exp_f32 v210, v210
    v_mfma_f32_16x16x32_bf16 v[212:215], a[236:239], v[124:127], v[212:215]
    v_exp_f32 v211, v211
    v_mfma_f32_16x16x32_bf16 a[56:59], a[184:187], v[176:179], a[56:59]
    ds_read_b64_tr_b16 a[168:169], v25 offset:16384
    v_cvt_pk_bf16_f32 v146, v208, v209
    v_mfma_f32_16x16x32_bf16 a[56:59], a[188:191], v[180:183], a[56:59]
    ds_read_b64_tr_b16 a[170:171], v25 offset:20480
    v_mfma_f32_16x16x32_bf16 a[60:63], a[184:187], v[184:187], a[60:63]
    ds_read_b128 a[224:227], v8 offset:45056
    v_cvt_pk_bf16_f32 v147, v210, v211
    v_mfma_f32_16x16x32_bf16 a[60:63], a[188:191], v[188:191], a[60:63]
    s_waitcnt lgkmcnt(3)
    buffer_load_dwordx4 v40, s[12:15], s41 offen offset:2048 lds
    v_mfma_f32_16x16x32_bf16 v[208:211], a[208:211], v[64:67], v[192:195]
    v_exp_f32 v212, v212
    v_mfma_f32_16x16x32_bf16 v[208:211], a[212:215], v[68:71], v[208:211]
    v_exp_f32 v213, v213
    v_mfma_f32_16x16x32_bf16 v[208:211], a[216:219], v[72:75], v[208:211]
    v_exp_f32 v214, v214
    v_mfma_f32_16x16x32_bf16 v[208:211], a[220:223], v[76:79], v[208:211]
    s_add_u32 s57, s58, 3538944
    v_exp_f32 v215, v215
    v_mfma_f32_16x16x32_bf16 a[64:67], a[160:163], v[160:163], a[64:67]
    ds_read_b64_tr_b16 a[172:173], v25 offset:24576
    v_cvt_pk_bf16_f32 v154, v212, v213
    v_mfma_f32_16x16x32_bf16 a[64:67], a[164:167], v[164:167], a[64:67]
    ds_read_b64_tr_b16 a[174:175], v25 offset:28672
    v_mfma_f32_16x16x32_bf16 a[68:71], a[160:163], v[168:171], a[68:71]
    ds_read_b128 a[228:231], v9 offset:45056
    v_cvt_pk_bf16_f32 v155, v214, v215
    v_mfma_f32_16x16x32_bf16 a[68:71], a[164:167], v[172:175], a[68:71]
    buffer_load_dwordx4 a[152:155], v254, s[80:83], s57 offen
    v_smfmac_f32_16x16x64_bf16 a[204:207], v[52:55], v[184:191], v50
    v_mfma_f32_16x16x32_bf16 v[212:215], a[208:211], v[80:83], v[196:199]
    v_exp_f32 v208, v208
    v_mfma_f32_16x16x32_bf16 v[212:215], a[212:215], v[84:87], v[212:215]
    v_exp_f32 v209, v209
    v_mfma_f32_16x16x32_bf16 v[212:215], a[216:219], v[88:91], v[212:215]
    v_exp_f32 v210, v210
    v_mfma_f32_16x16x32_bf16 v[212:215], a[220:223], v[92:95], v[212:215]
    v_exp_f32 v211, v211
    v_mfma_f32_16x16x32_bf16 a[72:75], a[160:163], v[176:179], a[72:75]
    ds_read_b64_tr_b16 a[176:177], v26 offset:16384
    v_cvt_pk_bf16_f32 v132, v208, v209
    v_mfma_f32_16x16x32_bf16 a[72:75], a[164:167], v[180:183], a[72:75]
    ds_read_b64_tr_b16 a[178:179], v26 offset:20480
    v_mfma_f32_16x16x32_bf16 a[76:79], a[160:163], v[184:187], a[76:79]
    ds_read_b128 a[232:235], v10 offset:45056
    v_cvt_pk_bf16_f32 v133, v210, v211
    v_mfma_f32_16x16x32_bf16 a[76:79], a[164:167], v[188:191], a[76:79]
    s_waitcnt lgkmcnt(3)
    buffer_load_dwordx4 v41, s[12:15], s41 offen offset:3072 lds
    v_mfma_f32_16x16x32_bf16 v[208:211], a[208:211], v[96:99], v[200:203]
    v_exp_f32 v212, v212
    v_mfma_f32_16x16x32_bf16 v[208:211], a[212:215], v[100:103], v[208:211]
    s_add_u32 s41, s41, 16384
    v_exp_f32 v213, v213
    v_mfma_f32_16x16x32_bf16 v[208:211], a[216:219], v[104:107], v[208:211]
    v_exp_f32 v214, v214
    v_mfma_f32_16x16x32_bf16 v[208:211], a[220:223], v[108:111], v[208:211]
    v_exp_f32 v215, v215
    v_mfma_f32_16x16x32_bf16 a[80:83], a[168:171], v[160:163], a[80:83]
    ds_read_b64_tr_b16 a[180:181], v26 offset:24576
    v_cvt_pk_bf16_f32 v140, v212, v213
    v_mfma_f32_16x16x32_bf16 a[80:83], a[172:175], v[164:167], a[80:83]
    ds_read_b64_tr_b16 a[182:183], v26 offset:28672
    v_mfma_f32_16x16x32_bf16 a[84:87], a[168:171], v[168:171], a[84:87]
    ds_read_b128 a[236:239], v11 offset:45056
    v_cvt_pk_bf16_f32 v141, v214, v215
    v_mfma_f32_16x16x32_bf16 a[84:87], a[172:175], v[172:175], a[84:87]
    s_waitcnt vmcnt(12)
    s_barrier
    v_mfma_f32_16x16x32_bf16 v[212:215], a[208:211], v[112:115], v[204:207]
    v_exp_f32 v208, v208
    v_mfma_f32_16x16x32_bf16 v[212:215], a[212:215], v[116:119], v[212:215]
    s_add_u32 s49, s45, 73728
    v_exp_f32 v209, v209
    v_mfma_f32_16x16x32_bf16 v[212:215], a[216:219], v[120:123], v[212:215]
    s_add_u32 m0, s42, 147456
    v_exp_f32 v210, v210
    v_mfma_f32_16x16x32_bf16 v[212:215], a[220:223], v[124:127], v[212:215]
    v_exp_f32 v211, v211
    v_mfma_f32_16x16x32_bf16 a[88:91], a[168:171], v[176:179], a[88:91]
    ds_read_b64_tr_b16 a[184:185], v27 offset:16384
    v_cvt_pk_bf16_f32 v148, v208, v209
    v_mfma_f32_16x16x32_bf16 a[88:91], a[172:175], v[180:183], a[88:91]
    ds_read_b64_tr_b16 a[186:187], v27 offset:20480
    v_mfma_f32_16x16x32_bf16 a[92:95], a[168:171], v[184:187], a[92:95]
    ds_read_b128 a[208:211], v8 offset:49152
    v_cvt_pk_bf16_f32 v149, v210, v211
    v_mfma_f32_16x16x32_bf16 a[92:95], a[172:175], v[188:191], a[92:95]
    s_waitcnt lgkmcnt(3)
    buffer_load_dwordx4 v46, s[20:23], s49 offen lds
    v_mfma_f32_16x16x32_bf16 v[208:211], a[224:227], v[64:67], v[192:195]
    v_exp_f32 v212, v212
    v_mfma_f32_16x16x32_bf16 v[208:211], a[228:231], v[68:71], v[208:211]
    v_exp_f32 v213, v213
    v_mfma_f32_16x16x32_bf16 v[208:211], a[232:235], v[72:75], v[208:211]
    v_exp_f32 v214, v214
    v_mfma_f32_16x16x32_bf16 v[208:211], a[236:239], v[76:79], v[208:211]
    v_exp_f32 v215, v215
    v_mfma_f32_16x16x32_bf16 a[96:99], a[176:179], v[160:163], a[96:99]
    ds_read_b64_tr_b16 a[188:189], v27 offset:24576
    v_cvt_pk_bf16_f32 v156, v212, v213
    v_mfma_f32_16x16x32_bf16 a[96:99], a[180:183], v[164:167], a[96:99]
    ds_read_b64_tr_b16 a[190:191], v27 offset:28672
    v_mfma_f32_16x16x32_bf16 a[100:103], a[176:179], v[168:171], a[100:103]
    ds_read_b128 a[212:215], v9 offset:49152
    v_cvt_pk_bf16_f32 v157, v214, v215
    v_mfma_f32_16x16x32_bf16 a[100:103], a[180:183], v[172:175], a[100:103]
    buffer_load_dword v63, v63, s[88:91], 0 offen sc1
    v_mfma_f32_16x16x32_bf16 v[212:215], a[224:227], v[80:83], v[196:199]
    v_exp_f32 v208, v208
    v_mfma_f32_16x16x32_bf16 v[212:215], a[228:231], v[84:87], v[212:215]
    v_exp_f32 v209, v209
    v_mfma_f32_16x16x32_bf16 v[212:215], a[232:235], v[88:91], v[212:215]
    v_exp_f32 v210, v210
    v_mfma_f32_16x16x32_bf16 v[212:215], a[236:239], v[92:95], v[212:215]
    v_exp_f32 v211, v211
    v_mfma_f32_16x16x32_bf16 a[104:107], a[176:179], v[176:179], a[104:107]
    ds_read_b64_tr_b16 a[160:161], v20 offset:32768
    v_cvt_pk_bf16_f32 v134, v208, v209
    v_mfma_f32_16x16x32_bf16 a[104:107], a[180:183], v[180:183], a[104:107]
    ds_read_b64_tr_b16 a[162:163], v20 offset:36864
    v_mfma_f32_16x16x32_bf16 a[108:111], a[176:179], v[184:187], a[108:111]
    ds_read_b128 a[216:219], v10 offset:49152
    v_cvt_pk_bf16_f32 v135, v210, v211
    v_mfma_f32_16x16x32_bf16 a[108:111], a[180:183], v[188:191], a[108:111]
    s_waitcnt lgkmcnt(3)
    buffer_load_dwordx4 v47, s[20:23], s49 offen offset:1024 lds
    v_mfma_f32_16x16x32_bf16 v[208:211], a[224:227], v[96:99], v[200:203]
    v_exp_f32 v212, v212
    v_mfma_f32_16x16x32_bf16 v[208:211], a[228:231], v[100:103], v[208:211]
    v_exp_f32 v213, v213
    v_mfma_f32_16x16x32_bf16 v[208:211], a[232:235], v[104:107], v[208:211]
    v_exp_f32 v214, v214
    v_mfma_f32_16x16x32_bf16 v[208:211], a[236:239], v[108:111], v[208:211]
    s_add_u32 s57, s58, 4128768
    v_exp_f32 v215, v215
    v_mfma_f32_16x16x32_bf16 a[112:115], a[184:187], v[160:163], a[112:115]
    ds_read_b64_tr_b16 a[164:165], v20 offset:40960
    v_cvt_pk_bf16_f32 v142, v212, v213
    v_mfma_f32_16x16x32_bf16 a[112:115], a[188:191], v[164:167], a[112:115]
    ds_read_b64_tr_b16 a[166:167], v20 offset:45056
    v_mfma_f32_16x16x32_bf16 a[116:119], a[184:187], v[168:171], a[116:119]
    ds_read_b128 a[220:223], v11 offset:49152
    v_cvt_pk_bf16_f32 v143, v214, v215
    v_mfma_f32_16x16x32_bf16 a[116:119], a[188:191], v[172:175], a[116:119]
    buffer_load_dwordx4 a[156:159], v254, s[80:83], s57 offen
    v_mfma_f32_16x16x32_bf16 v[212:215], a[224:227], v[112:115], v[204:207]
    v_exp_f32 v208, v208
    v_mfma_f32_16x16x32_bf16 v[212:215], a[228:231], v[116:119], v[212:215]
    v_exp_f32 v209, v209
    v_mfma_f32_16x16x32_bf16 v[212:215], a[232:235], v[120:123], v[212:215]
    v_exp_f32 v210, v210
    v_mfma_f32_16x16x32_bf16 v[212:215], a[236:239], v[124:127], v[212:215]
    v_exp_f32 v211, v211
    v_mfma_f32_16x16x32_bf16 a[120:123], a[184:187], v[176:179], a[120:123]
    ds_read_b64_tr_b16 a[168:169], v21 offset:32768
    v_cvt_pk_bf16_f32 v150, v208, v209
    v_mfma_f32_16x16x32_bf16 a[120:123], a[188:191], v[180:183], a[120:123]
    ds_read_b64_tr_b16 a[170:171], v21 offset:36864
    v_mfma_f32_16x16x32_bf16 a[124:127], a[184:187], v[184:187], a[124:127]
    ds_read_b128 a[224:227], v8 offset:53248
    v_cvt_pk_bf16_f32 v151, v210, v211
    v_mfma_f32_16x16x32_bf16 a[124:127], a[188:191], v[188:191], a[124:127]
    s_waitcnt lgkmcnt(3)
    buffer_load_dwordx4 v48, s[20:23], s49 offen offset:2048 lds
    v_mfma_f32_16x16x32_bf16 v[208:211], a[208:211], v[64:67], v[192:195]
    v_exp_f32 v212, v212
    v_mfma_f32_16x16x32_bf16 v[208:211], a[212:215], v[68:71], v[208:211]
    v_exp_f32 v213, v213
    v_mfma_f32_16x16x32_bf16 v[208:211], a[216:219], v[72:75], v[208:211]
    v_exp_f32 v214, v214
    v_mfma_f32_16x16x32_bf16 v[208:211], a[220:223], v[76:79], v[208:211]
    s_add_u32 s57, s58, 4718592
    v_exp_f32 v215, v215
    v_mfma_f32_16x16x32_bf16 a[0:3], a[160:163], v[128:131], a[0:3]
    ds_read_b64_tr_b16 a[172:173], v21 offset:40960
    v_cvt_pk_bf16_f32 v158, v212, v213
    v_mfma_f32_16x16x32_bf16 a[0:3], a[164:167], v[132:135], a[0:3]
    ds_read_b64_tr_b16 a[174:175], v21 offset:45056
    v_mfma_f32_16x16x32_bf16 a[4:7], a[160:163], v[136:139], a[4:7]
    ds_read_b128 a[228:231], v9 offset:53248
    v_cvt_pk_bf16_f32 v159, v214, v215
    v_mfma_f32_16x16x32_bf16 a[4:7], a[164:167], v[140:143], a[4:7]
    buffer_load_dwordx4 a[240:243], v254, s[80:83], s57 offen
    v_mfma_f32_16x16x32_bf16 v[212:215], a[208:211], v[80:83], v[196:199]
    v_exp_f32 v208, v208
    v_mfma_f32_16x16x32_bf16 v[212:215], a[212:215], v[84:87], v[212:215]
    v_exp_f32 v209, v209
    v_mfma_f32_16x16x32_bf16 v[212:215], a[216:219], v[88:91], v[212:215]
    v_exp_f32 v210, v210
    v_mfma_f32_16x16x32_bf16 v[212:215], a[220:223], v[92:95], v[212:215]
    v_exp_f32 v211, v211
    v_mfma_f32_16x16x32_bf16 a[8:11], a[160:163], v[144:147], a[8:11]
    ds_read_b64_tr_b16 a[176:177], v22 offset:32768
    v_cvt_pk_bf16_f32 v160, v208, v209
    v_mfma_f32_16x16x32_bf16 a[8:11], a[164:167], v[148:151], a[8:11]
    ds_read_b64_tr_b16 a[178:179], v22 offset:36864
    v_mfma_f32_16x16x32_bf16 a[12:15], a[160:163], v[152:155], a[12:15]
    ds_read_b128 a[232:235], v10 offset:53248
    v_cvt_pk_bf16_f32 v161, v210, v211
    v_mfma_f32_16x16x32_bf16 a[12:15], a[164:167], v[156:159], a[12:15]
    s_waitcnt lgkmcnt(3)
    buffer_load_dwordx4 v49, s[20:23], s49 offen offset:3072 lds
    v_mfma_f32_16x16x32_bf16 v[208:211], a[208:211], v[96:99], v[200:203]
    v_exp_f32 v212, v212
    v_mfma_f32_16x16x32_bf16 v[208:211], a[212:215], v[100:103], v[208:211]
    v_exp_f32 v213, v213
    v_mfma_f32_16x16x32_bf16 v[208:211], a[216:219], v[104:107], v[208:211]
    v_exp_f32 v214, v214
    v_mfma_f32_16x16x32_bf16 v[208:211], a[220:223], v[108:111], v[208:211]
    v_exp_f32 v215, v215
    v_mfma_f32_16x16x32_bf16 a[16:19], a[168:171], v[128:131], a[16:19]
    ds_read_b64_tr_b16 a[180:181], v22 offset:40960
    v_cvt_pk_bf16_f32 v168, v212, v213
    v_mfma_f32_16x16x32_bf16 a[16:19], a[172:175], v[132:135], a[16:19]
    ds_read_b64_tr_b16 a[182:183], v22 offset:45056
    v_mfma_f32_16x16x32_bf16 a[20:23], a[168:171], v[136:139], a[20:23]
    ds_read_b128 a[236:239], v11 offset:53248
    v_cvt_pk_bf16_f32 v169, v214, v215
    v_mfma_f32_16x16x32_bf16 a[20:23], a[172:175], v[140:143], a[20:23]
    v_smfmac_f32_16x16x64_bf16 a[192:195], v[52:55], v[128:135], v50
    v_mfma_f32_16x16x32_bf16 v[212:215], a[208:211], v[112:115], v[204:207]
    v_exp_f32 v208, v208
    v_mfma_f32_16x16x32_bf16 v[212:215], a[212:215], v[116:119], v[212:215]
    s_add_u32 s49, s45, 128
    v_exp_f32 v209, v209
    v_mfma_f32_16x16x32_bf16 v[212:215], a[216:219], v[120:123], v[212:215]
    s_add_u32 m0, s42, 0
    v_exp_f32 v210, v210
    v_mfma_f32_16x16x32_bf16 v[212:215], a[220:223], v[124:127], v[212:215]
    v_exp_f32 v211, v211
    v_mfma_f32_16x16x32_bf16 a[24:27], a[168:171], v[144:147], a[24:27]
    ds_read_b64_tr_b16 a[184:185], v23 offset:32768
    v_cvt_pk_bf16_f32 v176, v208, v209
    v_mfma_f32_16x16x32_bf16 a[24:27], a[172:175], v[148:151], a[24:27]
    ds_read_b64_tr_b16 a[186:187], v23 offset:36864
    v_mfma_f32_16x16x32_bf16 a[28:31], a[168:171], v[152:155], a[28:31]
    ds_read_b128 a[208:211], v8 offset:57344
    v_cvt_pk_bf16_f32 v177, v210, v211
    v_mfma_f32_16x16x32_bf16 a[28:31], a[172:175], v[156:159], a[28:31]
    s_waitcnt lgkmcnt(3)
    buffer_load_dwordx4 v46, s[20:23], s49 offen lds
    v_mfma_f32_16x16x32_bf16 v[208:211], a[224:227], v[64:67], v[192:195]
    v_exp_f32 v212, v212
    v_mfma_f32_16x16x32_bf16 v[208:211], a[228:231], v[68:71], v[208:211]
    v_exp_f32 v213, v213
    v_mfma_f32_16x16x32_bf16 v[208:211], a[232:235], v[72:75], v[208:211]
    v_exp_f32 v214, v214
    v_mfma_f32_16x16x32_bf16 v[208:211], a[236:239], v[76:79], v[208:211]
    s_add_u32 s57, s58, 0
    v_exp_f32 v215, v215
    v_mfma_f32_16x16x32_bf16 a[32:35], a[176:179], v[128:131], a[32:35]
    ds_read_b64_tr_b16 a[188:189], v23 offset:40960
    v_cvt_pk_bf16_f32 v184, v212, v213
    v_mfma_f32_16x16x32_bf16 a[32:35], a[180:183], v[132:135], a[32:35]
    ds_read_b64_tr_b16 a[190:191], v23 offset:45056
    v_mfma_f32_16x16x32_bf16 a[36:39], a[176:179], v[136:139], a[36:39]
    ds_read_b128 a[212:215], v9 offset:57344
    v_cvt_pk_bf16_f32 v185, v214, v215
    v_mfma_f32_16x16x32_bf16 a[36:39], a[180:183], v[140:143], a[36:39]
    buffer_load_dwordx4 a[244:247], v254, s[32:35], s57 offen
    v_smfmac_f32_16x16x64_bf16 a[196:199], v[52:55], v[136:143], v50
    v_mfma_f32_16x16x32_bf16 v[212:215], a[224:227], v[80:83], v[196:199]
    v_exp_f32 v208, v208
    v_mfma_f32_16x16x32_bf16 v[212:215], a[228:231], v[84:87], v[212:215]
    v_exp_f32 v209, v209
    v_mfma_f32_16x16x32_bf16 v[212:215], a[232:235], v[88:91], v[212:215]
    v_exp_f32 v210, v210
    v_mfma_f32_16x16x32_bf16 v[212:215], a[236:239], v[92:95], v[212:215]
    v_exp_f32 v211, v211
    v_mfma_f32_16x16x32_bf16 a[40:43], a[176:179], v[144:147], a[40:43]
    ds_read_b64_tr_b16 a[160:161], v24 offset:32768
    v_cvt_pk_bf16_f32 v162, v208, v209
    v_mfma_f32_16x16x32_bf16 a[40:43], a[180:183], v[148:151], a[40:43]
    ds_read_b64_tr_b16 a[162:163], v24 offset:36864
    v_mfma_f32_16x16x32_bf16 a[44:47], a[176:179], v[152:155], a[44:47]
    ds_read_b128 a[216:219], v10 offset:57344
    v_cvt_pk_bf16_f32 v163, v210, v211
    v_mfma_f32_16x16x32_bf16 a[44:47], a[180:183], v[156:159], a[44:47]
    s_waitcnt lgkmcnt(3)
    buffer_load_dwordx4 v47, s[20:23], s49 offen offset:1024 lds
    v_mfma_f32_16x16x32_bf16 v[208:211], a[224:227], v[96:99], v[200:203]
    v_exp_f32 v212, v212
    v_mfma_f32_16x16x32_bf16 v[208:211], a[228:231], v[100:103], v[208:211]
    v_exp_f32 v213, v213
    v_mfma_f32_16x16x32_bf16 v[208:211], a[232:235], v[104:107], v[208:211]
    v_exp_f32 v214, v214
    v_mfma_f32_16x16x32_bf16 v[208:211], a[236:239], v[108:111], v[208:211]
    v_exp_f32 v215, v215
    v_mfma_f32_16x16x32_bf16 a[48:51], a[184:187], v[128:131], a[48:51]
    ds_read_b64_tr_b16 a[164:165], v24 offset:40960
    v_cvt_pk_bf16_f32 v170, v212, v213
    v_mfma_f32_16x16x32_bf16 a[48:51], a[188:191], v[132:135], a[48:51]
    ds_read_b64_tr_b16 a[166:167], v24 offset:45056
    v_mfma_f32_16x16x32_bf16 a[52:55], a[184:187], v[136:139], a[52:55]
    ds_read_b128 a[220:223], v11 offset:57344
    v_cvt_pk_bf16_f32 v171, v214, v215
    v_mfma_f32_16x16x32_bf16 a[52:55], a[188:191], v[140:143], a[52:55]
    v_smfmac_f32_16x16x64_bf16 a[200:203], v[52:55], v[144:151], v50
    v_mfma_f32_16x16x32_bf16 v[212:215], a[224:227], v[112:115], v[204:207]
    v_exp_f32 v208, v208
    v_mfma_f32_16x16x32_bf16 v[212:215], a[228:231], v[116:119], v[212:215]
    v_exp_f32 v209, v209
    v_mfma_f32_16x16x32_bf16 v[212:215], a[232:235], v[120:123], v[212:215]
    v_exp_f32 v210, v210
    v_mfma_f32_16x16x32_bf16 v[212:215], a[236:239], v[124:127], v[212:215]
    v_exp_f32 v211, v211
    v_mfma_f32_16x16x32_bf16 a[56:59], a[184:187], v[144:147], a[56:59]
    ds_read_b64_tr_b16 a[168:169], v25 offset:32768
    v_cvt_pk_bf16_f32 v178, v208, v209
    v_mfma_f32_16x16x32_bf16 a[56:59], a[188:191], v[148:151], a[56:59]
    ds_read_b64_tr_b16 a[170:171], v25 offset:36864
    v_mfma_f32_16x16x32_bf16 a[60:63], a[184:187], v[152:155], a[60:63]
    ds_read_b128 a[224:227], v8 offset:61440
    v_cvt_pk_bf16_f32 v179, v210, v211
    v_mfma_f32_16x16x32_bf16 a[60:63], a[188:191], v[156:159], a[60:63]
    s_waitcnt lgkmcnt(3)
    buffer_load_dwordx4 v48, s[20:23], s49 offen offset:2048 lds
    v_mfma_f32_16x16x32_bf16 v[208:211], a[208:211], v[64:67], v[192:195]
    v_exp_f32 v212, v212
    v_mfma_f32_16x16x32_bf16 v[208:211], a[212:215], v[68:71], v[208:211]
    v_exp_f32 v213, v213
    v_mfma_f32_16x16x32_bf16 v[208:211], a[216:219], v[72:75], v[208:211]
    v_exp_f32 v214, v214
    v_mfma_f32_16x16x32_bf16 v[208:211], a[220:223], v[76:79], v[208:211]
    s_add_u32 s57, s58, 589824
    v_exp_f32 v215, v215
    v_mfma_f32_16x16x32_bf16 a[64:67], a[160:163], v[128:131], a[64:67]
    ds_read_b64_tr_b16 a[172:173], v25 offset:40960
    v_cvt_pk_bf16_f32 v186, v212, v213
    v_mfma_f32_16x16x32_bf16 a[64:67], a[164:167], v[132:135], a[64:67]
    ds_read_b64_tr_b16 a[174:175], v25 offset:45056
    v_mfma_f32_16x16x32_bf16 a[68:71], a[160:163], v[136:139], a[68:71]
    ds_read_b128 a[228:231], v9 offset:61440
    v_cvt_pk_bf16_f32 v187, v214, v215
    v_mfma_f32_16x16x32_bf16 a[68:71], a[164:167], v[140:143], a[68:71]
    buffer_load_dwordx4 a[248:251], v254, s[32:35], s57 offen
    v_smfmac_f32_16x16x64_bf16 a[204:207], v[52:55], v[152:159], v50
    v_mfma_f32_16x16x32_bf16 v[212:215], a[208:211], v[80:83], v[196:199]
    v_exp_f32 v208, v208
    v_mfma_f32_16x16x32_bf16 v[212:215], a[212:215], v[84:87], v[212:215]
    v_exp_f32 v209, v209
    v_mfma_f32_16x16x32_bf16 v[212:215], a[216:219], v[88:91], v[212:215]
    v_exp_f32 v210, v210
    v_mfma_f32_16x16x32_bf16 v[212:215], a[220:223], v[92:95], v[212:215]
    v_exp_f32 v211, v211
    v_mfma_f32_16x16x32_bf16 a[72:75], a[160:163], v[144:147], a[72:75]
    ds_read_b64_tr_b16 a[176:177], v26 offset:32768
    v_cvt_pk_bf16_f32 v164, v208, v209
    v_mfma_f32_16x16x32_bf16 a[72:75], a[164:167], v[148:151], a[72:75]
    ds_read_b64_tr_b16 a[178:179], v26 offset:36864
    v_mfma_f32_16x16x32_bf16 a[76:79], a[160:163], v[152:155], a[76:79]
    ds_read_b128 a[232:235], v10 offset:61440
    v_cvt_pk_bf16_f32 v165, v210, v211
    v_mfma_f32_16x16x32_bf16 a[76:79], a[164:167], v[156:159], a[76:79]
    s_waitcnt lgkmcnt(3)
    buffer_load_dwordx4 v49, s[20:23], s49 offen offset:3072 lds
    v_mfma_f32_16x16x32_bf16 v[208:211], a[208:211], v[96:99], v[200:203]
    v_exp_f32 v212, v212
    v_mfma_f32_16x16x32_bf16 v[208:211], a[212:215], v[100:103], v[208:211]
    v_exp_f32 v213, v213
    v_mfma_f32_16x16x32_bf16 v[208:211], a[216:219], v[104:107], v[208:211]
    v_exp_f32 v214, v214
    v_mfma_f32_16x16x32_bf16 v[208:211], a[220:223], v[108:111], v[208:211]
    v_exp_f32 v215, v215
    v_mfma_f32_16x16x32_bf16 a[80:83], a[168:171], v[128:131], a[80:83]
    ds_read_b64_tr_b16 a[180:181], v26 offset:40960
    v_cvt_pk_bf16_f32 v172, v212, v213
    v_mfma_f32_16x16x32_bf16 a[80:83], a[172:175], v[132:135], a[80:83]
    ds_read_b64_tr_b16 a[182:183], v26 offset:45056
    v_mfma_f32_16x16x32_bf16 a[84:87], a[168:171], v[136:139], a[84:87]
    ds_read_b128 a[236:239], v11 offset:61440
    v_cvt_pk_bf16_f32 v173, v214, v215
    v_mfma_f32_16x16x32_bf16 a[84:87], a[172:175], v[140:143], a[84:87]
    s_waitcnt vmcnt(13)
    s_barrier
    v_mfma_f32_16x16x32_bf16 v[212:215], a[208:211], v[112:115], v[204:207]
    v_exp_f32 v208, v208
    v_mfma_f32_16x16x32_bf16 v[212:215], a[212:215], v[116:119], v[212:215]
    s_add_u32 s49, s45, 73856
    v_exp_f32 v209, v209
    v_mfma_f32_16x16x32_bf16 v[212:215], a[216:219], v[120:123], v[212:215]
    s_add_u32 m0, s42, 16384
    v_exp_f32 v210, v210
    v_mfma_f32_16x16x32_bf16 v[212:215], a[220:223], v[124:127], v[212:215]
    v_exp_f32 v211, v211
    v_mfma_f32_16x16x32_bf16 a[88:91], a[168:171], v[144:147], a[88:91]
    ds_read_b64_tr_b16 a[184:185], v27 offset:32768
    v_cvt_pk_bf16_f32 v180, v208, v209
    v_mfma_f32_16x16x32_bf16 a[88:91], a[172:175], v[148:151], a[88:91]
    ds_read_b64_tr_b16 a[186:187], v27 offset:36864
    v_mfma_f32_16x16x32_bf16 a[92:95], a[168:171], v[152:155], a[92:95]
    v_cvt_pk_bf16_f32 v181, v210, v211
    v_mfma_f32_16x16x32_bf16 a[92:95], a[172:175], v[156:159], a[92:95]
    s_waitcnt lgkmcnt(3)
    buffer_load_dwordx4 v46, s[20:23], s49 offen lds
    v_mfma_f32_16x16x32_bf16 v[208:211], a[224:227], v[64:67], v[192:195]
    v_exp_f32 v212, v212
    v_mfma_f32_16x16x32_bf16 v[208:211], a[228:231], v[68:71], v[208:211]
    v_exp_f32 v213, v213
    v_mfma_f32_16x16x32_bf16 v[208:211], a[232:235], v[72:75], v[208:211]
    s_waitcnt lgkmcnt(2)
    v_exp_f32 v214, v214
    v_mfma_f32_16x16x32_bf16 v[208:211], a[236:239], v[76:79], v[208:211]
    v_exp_f32 v215, v215
    v_mfma_f32_16x16x32_bf16 a[96:99], a[176:179], v[128:131], a[96:99]
    ds_read_b64_tr_b16 a[188:189], v27 offset:40960
    v_cvt_pk_bf16_f32 v188, v212, v213
    v_mfma_f32_16x16x32_bf16 a[96:99], a[180:183], v[132:135], a[96:99]
    ds_read_b64_tr_b16 a[190:191], v27 offset:45056
    v_mfma_f32_16x16x32_bf16 a[100:103], a[176:179], v[136:139], a[100:103]
    v_cvt_pk_bf16_f32 v189, v214, v215
    v_mfma_f32_16x16x32_bf16 a[100:103], a[180:183], v[140:143], a[100:103]
    v_mfma_f32_16x16x32_bf16 v[212:215], a[224:227], v[80:83], v[196:199]
    v_exp_f32 v208, v208
    v_mfma_f32_16x16x32_bf16 v[212:215], a[228:231], v[84:87], v[212:215]
    v_exp_f32 v209, v209
    v_mfma_f32_16x16x32_bf16 v[212:215], a[232:235], v[88:91], v[212:215]
    v_exp_f32 v210, v210
    v_mfma_f32_16x16x32_bf16 v[212:215], a[236:239], v[92:95], v[212:215]
    v_exp_f32 v211, v211
    v_mfma_f32_16x16x32_bf16 a[104:107], a[176:179], v[144:147], a[104:107]
    ds_read_b64_tr_b16 a[160:161], v20 offset:49152
    v_cvt_pk_bf16_f32 v166, v208, v209
    v_mfma_f32_16x16x32_bf16 a[104:107], a[180:183], v[148:151], a[104:107]
    ds_read_b64_tr_b16 a[162:163], v20 offset:53248
    v_mfma_f32_16x16x32_bf16 a[108:111], a[176:179], v[152:155], a[108:111]
    v_cvt_pk_bf16_f32 v167, v210, v211
    v_mfma_f32_16x16x32_bf16 a[108:111], a[180:183], v[156:159], a[108:111]
    s_waitcnt lgkmcnt(3)
    buffer_load_dwordx4 v47, s[20:23], s49 offen offset:1024 lds
    v_mfma_f32_16x16x32_bf16 v[208:211], a[224:227], v[96:99], v[200:203]
    v_exp_f32 v212, v212
    v_mfma_f32_16x16x32_bf16 v[208:211], a[228:231], v[100:103], v[208:211]
    v_exp_f32 v213, v213
    v_mfma_f32_16x16x32_bf16 v[208:211], a[232:235], v[104:107], v[208:211]
    v_exp_f32 v214, v214
    v_mfma_f32_16x16x32_bf16 v[208:211], a[236:239], v[108:111], v[208:211]
    s_add_u32 s57, s58, 1179648
    v_exp_f32 v215, v215
    v_mfma_f32_16x16x32_bf16 a[112:115], a[184:187], v[128:131], a[112:115]
    s_waitcnt lgkmcnt(2)
    ds_read_b64_tr_b16 a[164:165], v20 offset:57344
    v_cvt_pk_bf16_f32 v174, v212, v213
    v_mfma_f32_16x16x32_bf16 a[112:115], a[188:191], v[132:135], a[112:115]
    ds_read_b64_tr_b16 a[166:167], v20 offset:61440
    v_mfma_f32_16x16x32_bf16 a[116:119], a[184:187], v[136:139], a[116:119]
    v_cvt_pk_bf16_f32 v175, v214, v215
    v_mfma_f32_16x16x32_bf16 a[116:119], a[188:191], v[140:143], a[116:119]
    buffer_load_dwordx4 a[252:255], v254, s[32:35], s57 offen
    v_mfma_f32_16x16x32_bf16 v[212:215], a[224:227], v[112:115], v[204:207]
    v_exp_f32 v208, v208
    v_mfma_f32_16x16x32_bf16 v[212:215], a[228:231], v[116:119], v[212:215]
    v_exp_f32 v209, v209
    v_mfma_f32_16x16x32_bf16 v[212:215], a[232:235], v[120:123], v[212:215]
    v_exp_f32 v210, v210
    v_mfma_f32_16x16x32_bf16 v[212:215], a[236:239], v[124:127], v[212:215]
    v_exp_f32 v211, v211
    v_mfma_f32_16x16x32_bf16 a[120:123], a[184:187], v[144:147], a[120:123]
    ds_read_b64_tr_b16 a[168:169], v21 offset:49152
    v_cvt_pk_bf16_f32 v182, v208, v209
    v_mfma_f32_16x16x32_bf16 a[120:123], a[188:191], v[148:151], a[120:123]
    ds_read_b64_tr_b16 a[170:171], v21 offset:53248
    v_mfma_f32_16x16x32_bf16 a[124:127], a[184:187], v[152:155], a[124:127]
    v_cvt_pk_bf16_f32 v183, v210, v211
    v_mfma_f32_16x16x32_bf16 a[124:127], a[188:191], v[156:159], a[124:127]
    s_waitcnt lgkmcnt(3)
    buffer_load_dwordx4 v48, s[20:23], s49 offen offset:2048 lds
    v_exp_f32 v212, v212
    v_exp_f32 v213, v213
    v_exp_f32 v214, v214
    v_exp_f32 v215, v215
    v_mfma_f32_16x16x32_bf16 a[0:3], a[160:163], v[160:163], a[0:3]
    s_waitcnt lgkmcnt(2)
    ds_read_b64_tr_b16 a[172:173], v21 offset:57344
    v_cvt_pk_bf16_f32 v190, v212, v213
    v_mfma_f32_16x16x32_bf16 a[0:3], a[164:167], v[164:167], a[0:3]
    ds_read_b64_tr_b16 a[174:175], v21 offset:61440
    v_mfma_f32_16x16x32_bf16 a[4:7], a[160:163], v[168:171], a[4:7]
    v_cvt_pk_bf16_f32 v191, v214, v215
    v_mfma_f32_16x16x32_bf16 a[4:7], a[164:167], v[172:175], a[4:7]
    v_mfma_f32_16x16x32_bf16 a[8:11], a[160:163], v[176:179], a[8:11]
    ds_read_b64_tr_b16 a[176:177], v22 offset:49152
    v_mfma_f32_16x16x32_bf16 a[8:11], a[164:167], v[180:183], a[8:11]
    ds_read_b64_tr_b16 a[178:179], v22 offset:53248
    v_mfma_f32_16x16x32_bf16 a[12:15], a[160:163], v[184:187], a[12:15]
    v_mfma_f32_16x16x32_bf16 a[12:15], a[164:167], v[188:191], a[12:15]
    buffer_load_dwordx4 v49, s[20:23], s49 offen offset:3072 lds
    v_smfmac_f32_16x16x64_bf16 a[192:195], v[52:55], v[160:167], v50
    s_waitcnt lgkmcnt(4)
    v_mfma_f32_16x16x32_bf16 a[16:19], a[168:171], v[160:163], a[16:19]
    s_waitcnt lgkmcnt(2)
    ds_read_b64_tr_b16 a[180:181], v22 offset:57344
    v_mfma_f32_16x16x32_bf16 a[16:19], a[172:175], v[164:167], a[16:19]
    ds_read_b64_tr_b16 a[182:183], v22 offset:61440
    v_mfma_f32_16x16x32_bf16 a[20:23], a[168:171], v[168:171], a[20:23]
    v_mfma_f32_16x16x32_bf16 a[20:23], a[172:175], v[172:175], a[20:23]
    v_smfmac_f32_16x16x64_bf16 a[196:199], v[52:55], v[168:175], v50
    s_add_u32 s49, s45, 256
    s_add_u32 m0, s42, 32768
    v_mfma_f32_16x16x32_bf16 a[24:27], a[168:171], v[176:179], a[24:27]
    ds_read_b64_tr_b16 a[184:185], v23 offset:49152
    v_mfma_f32_16x16x32_bf16 a[24:27], a[172:175], v[180:183], a[24:27]
    ds_read_b64_tr_b16 a[186:187], v23 offset:53248
    v_mfma_f32_16x16x32_bf16 a[28:31], a[168:171], v[184:187], a[28:31]
    v_mfma_f32_16x16x32_bf16 a[28:31], a[172:175], v[188:191], a[28:31]
    buffer_load_dwordx4 v46, s[20:23], s49 offen lds
    v_smfmac_f32_16x16x64_bf16 a[200:203], v[52:55], v[176:183], v50
    s_waitcnt lgkmcnt(4)
    v_mfma_f32_16x16x32_bf16 a[32:35], a[176:179], v[160:163], a[32:35]
    s_waitcnt lgkmcnt(2)
    ds_read_b64_tr_b16 a[188:189], v23 offset:57344
    v_mfma_f32_16x16x32_bf16 a[32:35], a[180:183], v[164:167], a[32:35]
    ds_read_b64_tr_b16 a[190:191], v23 offset:61440
    v_mfma_f32_16x16x32_bf16 a[36:39], a[176:179], v[168:171], a[36:39]
    v_mfma_f32_16x16x32_bf16 a[36:39], a[180:183], v[172:175], a[36:39]
    v_smfmac_f32_16x16x64_bf16 a[204:207], v[52:55], v[184:191], v50
    v_mfma_f32_16x16x32_bf16 a[40:43], a[176:179], v[176:179], a[40:43]
    ds_read_b64_tr_b16 a[160:161], v24 offset:49152
    v_mfma_f32_16x16x32_bf16 a[40:43], a[180:183], v[180:183], a[40:43]
    ds_read_b64_tr_b16 a[162:163], v24 offset:53248
    v_mfma_f32_16x16x32_bf16 a[44:47], a[176:179], v[184:187], a[44:47]
    v_mfma_f32_16x16x32_bf16 a[44:47], a[180:183], v[188:191], a[44:47]
    s_waitcnt lgkmcnt(4)
    buffer_load_dwordx4 v47, s[20:23], s49 offen offset:1024 lds
    v_mfma_f32_16x16x32_bf16 a[48:51], a[184:187], v[160:163], a[48:51]
    s_waitcnt lgkmcnt(2)
    ds_read_b64_tr_b16 a[164:165], v24 offset:57344
    v_accvgpr_read_b32 v216, a192
    v_mfma_f32_16x16x32_bf16 a[48:51], a[188:191], v[164:167], a[48:51]
    ds_read_b64_tr_b16 a[166:167], v24 offset:61440
    v_accvgpr_read_b32 v217, a193
    v_mfma_f32_16x16x32_bf16 a[52:55], a[184:187], v[168:171], a[52:55]
    v_accvgpr_read_b32 v218, a196
    v_accvgpr_read_b32 v219, a197
    v_mfma_f32_16x16x32_bf16 a[52:55], a[188:191], v[172:175], a[52:55]
    v_accvgpr_read_b32 v220, a200
    v_accvgpr_read_b32 v221, a201
    v_mfma_f32_16x16x32_bf16 a[56:59], a[184:187], v[176:179], a[56:59]
    ds_read_b64_tr_b16 a[168:169], v25 offset:49152
    v_accvgpr_read_b32 v222, a204
    v_mfma_f32_16x16x32_bf16 a[56:59], a[188:191], v[180:183], a[56:59]
    ds_read_b64_tr_b16 a[170:171], v25 offset:53248
    v_accvgpr_read_b32 v223, a205
    v_mfma_f32_16x16x32_bf16 a[60:63], a[184:187], v[184:187], a[60:63]
    v_add_f32 v58, v216, v217
    v_add_f32 v59, v218, v219
    v_mfma_f32_16x16x32_bf16 a[60:63], a[188:191], v[188:191], a[60:63]
    s_waitcnt lgkmcnt(4)
    buffer_load_dwordx4 v48, s[20:23], s49 offen offset:2048 lds
    v_add_f32 v60, v220, v221
    v_add_f32 v61, v222, v223
    v_mfma_f32_16x16x32_bf16 a[64:67], a[160:163], v[160:163], a[64:67]
    s_waitcnt lgkmcnt(2)
    ds_read_b64_tr_b16 a[172:173], v25 offset:57344
    v_add_f32 v216, v58, v59
    v_mfma_f32_16x16x32_bf16 a[64:67], a[164:167], v[164:167], a[64:67]
    ds_read_b64_tr_b16 a[174:175], v25 offset:61440
    v_add_f32 v217, v60, v61
    v_mfma_f32_16x16x32_bf16 a[68:71], a[160:163], v[168:171], a[68:71]
    v_add_f32 v216, v216, v217
    v_cmp_ngt_f32 vcc, 1669332992, v216
    v_mfma_f32_16x16x32_bf16 a[68:71], a[164:167], v[172:175], a[68:71]
    v_rcp_f32 v58, v58
    v_rcp_f32 v59, v59
    v_mfma_f32_16x16x32_bf16 a[72:75], a[160:163], v[176:179], a[72:75]
    ds_read_b64_tr_b16 a[176:177], v26 offset:49152
    v_rcp_f32 v60, v60
    v_mfma_f32_16x16x32_bf16 a[72:75], a[164:167], v[180:183], a[72:75]
    ds_read_b64_tr_b16 a[178:179], v26 offset:53248
    v_rcp_f32 v61, v61
    v_mfma_f32_16x16x32_bf16 a[76:79], a[160:163], v[184:187], a[76:79]
    v_mov_b32 v228, 81920
    s_or_b32 s36, vcc_lo, vcc_hi
    v_mfma_f32_16x16x32_bf16 a[76:79], a[164:167], v[188:191], a[76:79]
    s_waitcnt lgkmcnt(4)
    buffer_load_dwordx4 v49, s[20:23], s49 offen offset:3072 lds
    v_mov_b32 v218, s36
    s_lshl_b32 s37, s3, 2
    v_mfma_f32_16x16x32_bf16 a[80:83], a[168:171], v[160:163], a[80:83]
    s_waitcnt lgkmcnt(2)
    ds_read_b64_tr_b16 a[180:181], v26 offset:57344
    v_add_u32 v219, s37, v228
    ds_write_b32 v219, v218
    v_mfma_f32_16x16x32_bf16 a[80:83], a[172:175], v[164:167], a[80:83]
    ds_read_b64_tr_b16 a[182:183], v26 offset:61440
    v_mfma_f32_16x16x32_bf16 a[84:87], a[168:171], v[168:171], a[84:87]
    v_mfma_f32_16x16x32_bf16 a[84:87], a[172:175], v[172:175], a[84:87]
    s_waitcnt lgkmcnt(1)
    s_waitcnt vmcnt(15)
    s_barrier
    v_mfma_f32_16x16x32_bf16 a[88:91], a[168:171], v[176:179], a[88:91]
    ds_read_b64_tr_b16 a[184:185], v27 offset:49152
    v_mfma_f32_16x16x32_bf16 a[88:91], a[172:175], v[180:183], a[88:91]
    ds_read_b64_tr_b16 a[186:187], v27 offset:53248
    v_mfma_f32_16x16x32_bf16 a[92:95], a[168:171], v[184:187], a[92:95]
    ds_read_b128 v[224:227], v228
    v_mfma_f32_16x16x32_bf16 a[92:95], a[172:175], v[188:191], a[92:95]
    s_add_u32 s49, s45, 73984
    v_mfma_f32_16x16x32_bf16 a[96:99], a[176:179], v[160:163], a[96:99]
    s_waitcnt lgkmcnt(3)
    s_add_u32 m0, s42, 49152
    ds_read_b64_tr_b16 a[188:189], v27 offset:57344
    v_mfma_f32_16x16x32_bf16 a[96:99], a[180:183], v[164:167], a[96:99]
    buffer_load_dwordx4 v46, s[20:23], s49 offen lds
    v_mfma_f32_16x16x32_bf16 a[100:103], a[176:179], v[168:171], a[100:103]
    ds_read_b64_tr_b16 a[190:191], v27 offset:61440
    v_mfma_f32_16x16x32_bf16 a[100:103], a[180:183], v[172:175], a[100:103]
    buffer_load_dwordx4 v47, s[20:23], s49 offen offset:1024 lds
    v_mfma_f32_16x16x32_bf16 a[104:107], a[176:179], v[176:179], a[104:107]
    v_mfma_f32_16x16x32_bf16 a[104:107], a[180:183], v[180:183], a[104:107]
    buffer_load_dwordx4 v48, s[20:23], s49 offen offset:2048 lds
    v_mfma_f32_16x16x32_bf16 a[108:111], a[176:179], v[184:187], a[108:111]
    v_mfma_f32_16x16x32_bf16 a[108:111], a[180:183], v[188:191], a[108:111]
    s_waitcnt lgkmcnt(3)
    buffer_load_dwordx4 v49, s[20:23], s49 offen offset:3072 lds
    s_add_u32 s49, s45, 384
    v_mfma_f32_16x16x32_bf16 a[112:115], a[184:187], v[160:163], a[112:115]
    s_waitcnt lgkmcnt(0)
    s_add_u32 m0, s42, 65536
    v_mfma_f32_16x16x32_bf16 a[112:115], a[188:191], v[164:167], a[112:115]
    buffer_load_dwordx4 v46, s[20:23], s49 offen lds
    v_mfma_f32_16x16x32_bf16 a[116:119], a[184:187], v[168:171], a[116:119]
    v_mfma_f32_16x16x32_bf16 a[116:119], a[188:191], v[172:175], a[116:119]
    buffer_load_dwordx4 v47, s[20:23], s49 offen offset:1024 lds
    v_mfma_f32_16x16x32_bf16 a[120:123], a[184:187], v[176:179], a[120:123]
    v_mfma_f32_16x16x32_bf16 a[120:123], a[188:191], v[180:183], a[120:123]
    buffer_load_dwordx4 v48, s[20:23], s49 offen offset:2048 lds
    v_mfma_f32_16x16x32_bf16 a[124:127], a[184:187], v[184:187], a[124:127]
    v_mfma_f32_16x16x32_bf16 a[124:127], a[188:191], v[188:191], a[124:127]
    buffer_load_dwordx4 v49, s[20:23], s49 offen offset:3072 lds
    v_or3_b32 v224, v224, v225, v226
    v_or_b32 v224, v224, v227
    s_nop 0
    v_readfirstlane_b32 s36, v224
    v_readfirstlane_b32 s37, v63
    ds_read_b64_tr_b16 a[208:209], v28 offset:0
    ds_read_b64_tr_b16 a[210:211], v28 offset:4096
    ds_read_b64_tr_b16 a[212:213], v28 offset:8192
    ds_read_b64_tr_b16 a[214:215], v28 offset:12288
    ds_read_b64_tr_b16 a[216:217], v28 offset:16384
    ds_read_b64_tr_b16 a[218:219], v28 offset:20480
    ds_read_b64_tr_b16 a[220:221], v28 offset:24576
    ds_read_b64_tr_b16 a[222:223], v28 offset:28672
    ds_read_b64_tr_b16 a[224:225], v32 offset:0
    ds_read_b64_tr_b16 a[226:227], v32 offset:4096
    ds_read_b64_tr_b16 a[228:229], v32 offset:8192
    ds_read_b64_tr_b16 a[230:231], v32 offset:12288
    ds_read_b64_tr_b16 a[232:233], v32 offset:16384
    ds_read_b64_tr_b16 a[234:235], v32 offset:20480
    ds_read_b64_tr_b16 a[236:237], v32 offset:24576
    ds_read_b64_tr_b16 a[238:239], v32 offset:28672
    s_andn2_b32 s36, s36, s48
    s_cbranch_scc1 Lattn_redo
    s_cmp_lt_u32 s37, 256
    s_cbranch_scc1 Lattn_armwait
Lattn_armed:
    v_accvgpr_read_b32 v216, a0
    v_accvgpr_read_b32 v217, a1
    v_accvgpr_read_b32 v218, a2
    v_accvgpr_read_b32 v219, a3
    v_pk_mul_f32 v[216:217], v[216:217], v[58:59] op_sel:[0,0] op_sel_hi:[1,0]
    v_pk_mul_f32 v[218:219], v[218:219], v[58:59] op_sel:[0,0] op_sel_hi:[1,0]
    v_cvt_pk_bf16_f32 v128, v216, v217
    v_cvt_pk_bf16_f32 v129, v218, v219
    v_accvgpr_read_b32 v220, a4
    v_accvgpr_read_b32 v221, a5
    v_accvgpr_read_b32 v222, a6
    v_accvgpr_read_b32 v223, a7
    v_pk_mul_f32 v[220:221], v[220:221], v[58:59] op_sel:[0,1] op_sel_hi:[1,1]
    v_pk_mul_f32 v[222:223], v[222:223], v[58:59] op_sel:[0,1] op_sel_hi:[1,1]
    v_cvt_pk_bf16_f32 v160, v220, v221
    v_cvt_pk_bf16_f32 v161, v222, v223
    v_accvgpr_read_b32 v224, a8
    v_accvgpr_read_b32 v225, a9
    v_accvgpr_read_b32 v226, a10
    v_accvgpr_read_b32 v227, a11
    v_pk_mul_f32 v[224:225], v[224:225], v[60:61] op_sel:[0,0] op_sel_hi:[1,0]
    v_pk_mul_f32 v[226:227], v[226:227], v[60:61] op_sel:[0,0] op_sel_hi:[1,0]
    v_cvt_pk_bf16_f32 v144, v224, v225
    v_cvt_pk_bf16_f32 v145, v226, v227
    s_add_u32 s57, s58, 1769472
    buffer_load_dwordx4 a[0:3], v254, s[32:35], s57 offen
    v_accvgpr_read_b32 v228, a12
    v_accvgpr_read_b32 v229, a13
    v_accvgpr_read_b32 v230, a14
    v_accvgpr_read_b32 v231, a15
    v_pk_mul_f32 v[228:229], v[228:229], v[60:61] op_sel:[0,1] op_sel_hi:[1,1]
    v_pk_mul_f32 v[230:231], v[230:231], v[60:61] op_sel:[0,1] op_sel_hi:[1,1]
    v_cvt_pk_bf16_f32 v176, v228, v229
    v_cvt_pk_bf16_f32 v177, v230, v231
    v_accvgpr_read_b32 v216, a16
    v_accvgpr_read_b32 v217, a17
    v_accvgpr_read_b32 v218, a18
    v_accvgpr_read_b32 v219, a19
    v_pk_mul_f32 v[216:217], v[216:217], v[58:59] op_sel:[0,0] op_sel_hi:[1,0]
    v_pk_mul_f32 v[218:219], v[218:219], v[58:59] op_sel:[0,0] op_sel_hi:[1,0]
    v_cvt_pk_bf16_f32 v130, v216, v217
    v_cvt_pk_bf16_f32 v131, v218, v219
    s_add_u32 s57, s58, 2359296
    buffer_load_dwordx4 a[4:7], v254, s[32:35], s57 offen
    v_accvgpr_read_b32 v220, a20
    v_accvgpr_read_b32 v221, a21
    v_accvgpr_read_b32 v222, a22
    v_accvgpr_read_b32 v223, a23
    v_pk_mul_f32 v[220:221], v[220:221], v[58:59] op_sel:[0,1] op_sel_hi:[1,1]
    v_pk_mul_f32 v[222:223], v[222:223], v[58:59] op_sel:[0,1] op_sel_hi:[1,1]
    v_cvt_pk_bf16_f32 v162, v220, v221
    v_cvt_pk_bf16_f32 v163, v222, v223
    v_accvgpr_read_b32 v224, a24
    v_accvgpr_read_b32 v225, a25
    v_accvgpr_read_b32 v226, a26
    v_accvgpr_read_b32 v227, a27
    v_pk_mul_f32 v[224:225], v[224:225], v[60:61] op_sel:[0,0] op_sel_hi:[1,0]
    v_pk_mul_f32 v[226:227], v[226:227], v[60:61] op_sel:[0,0] op_sel_hi:[1,0]
    v_cvt_pk_bf16_f32 v146, v224, v225
    v_cvt_pk_bf16_f32 v147, v226, v227
    s_add_u32 s57, s58, 2949120
    buffer_load_dwordx4 a[8:11], v254, s[32:35], s57 offen
    v_accvgpr_read_b32 v228, a28
    v_accvgpr_read_b32 v229, a29
    v_accvgpr_read_b32 v230, a30
    v_accvgpr_read_b32 v231, a31
    v_pk_mul_f32 v[228:229], v[228:229], v[60:61] op_sel:[0,1] op_sel_hi:[1,1]
    v_pk_mul_f32 v[230:231], v[230:231], v[60:61] op_sel:[0,1] op_sel_hi:[1,1]
    v_cvt_pk_bf16_f32 v178, v228, v229
    v_cvt_pk_bf16_f32 v179, v230, v231
    v_accvgpr_read_b32 v216, a32
    v_accvgpr_read_b32 v217, a33
    v_accvgpr_read_b32 v218, a34
    v_accvgpr_read_b32 v219, a35
    v_pk_mul_f32 v[216:217], v[216:217], v[58:59] op_sel:[0,0] op_sel_hi:[1,0]
    v_pk_mul_f32 v[218:219], v[218:219], v[58:59] op_sel:[0,0] op_sel_hi:[1,0]
    v_cvt_pk_bf16_f32 v132, v216, v217
    v_cvt_pk_bf16_f32 v133, v218, v219
    s_add_u32 s57, s58, 3538944
    buffer_load_dwordx4 a[12:15], v254, s[32:35], s57 offen
    v_accvgpr_read_b32 v220, a36
    v_accvgpr_read_b32 v221, a37
    v_accvgpr_read_b32 v222, a38
    v_accvgpr_read_b32 v223, a39
    v_pk_mul_f32 v[220:221], v[220:221], v[58:59] op_sel:[0,1] op_sel_hi:[1,1]
    v_pk_mul_f32 v[222:223], v[222:223], v[58:59] op_sel:[0,1] op_sel_hi:[1,1]
    v_cvt_pk_bf16_f32 v164, v220, v221
    v_cvt_pk_bf16_f32 v165, v222, v223
    v_accvgpr_read_b32 v224, a40
    v_accvgpr_read_b32 v225, a41
    v_accvgpr_read_b32 v226, a42
    v_accvgpr_read_b32 v227, a43
    v_pk_mul_f32 v[224:225], v[224:225], v[60:61] op_sel:[0,0] op_sel_hi:[1,0]
    v_pk_mul_f32 v[226:227], v[226:227], v[60:61] op_sel:[0,0] op_sel_hi:[1,0]
    v_cvt_pk_bf16_f32 v148, v224, v225
    v_cvt_pk_bf16_f32 v149, v226, v227
    s_add_u32 s57, s58, 4128768
    buffer_load_dwordx4 a[16:19], v254, s[32:35], s57 offen
    v_accvgpr_read_b32 v228, a44
    v_accvgpr_read_b32 v229, a45
    v_accvgpr_read_b32 v230, a46
    v_accvgpr_read_b32 v231, a47
    v_pk_mul_f32 v[228:229], v[228:229], v[60:61] op_sel:[0,1] op_sel_hi:[1,1]
    v_pk_mul_f32 v[230:231], v[230:231], v[60:61] op_sel:[0,1] op_sel_hi:[1,1]
    v_cvt_pk_bf16_f32 v180, v228, v229
    v_cvt_pk_bf16_f32 v181, v230, v231
    v_accvgpr_read_b32 v216, a48
    v_accvgpr_read_b32 v217, a49
    v_accvgpr_read_b32 v218, a50
    v_accvgpr_read_b32 v219, a51
    v_pk_mul_f32 v[216:217], v[216:217], v[58:59] op_sel:[0,0] op_sel_hi:[1,0]
    v_pk_mul_f32 v[218:219], v[218:219], v[58:59] op_sel:[0,0] op_sel_hi:[1,0]
    v_cvt_pk_bf16_f32 v134, v216, v217
    v_cvt_pk_bf16_f32 v135, v218, v219
    s_add_u32 s57, s58, 4718592
    buffer_load_dwordx4 a[20:23], v254, s[32:35], s57 offen
    v_accvgpr_read_b32 v220, a52
    v_accvgpr_read_b32 v221, a53
    v_accvgpr_read_b32 v222, a54
    v_accvgpr_read_b32 v223, a55
    v_pk_mul_f32 v[220:221], v[220:221], v[58:59] op_sel:[0,1] op_sel_hi:[1,1]
    v_pk_mul_f32 v[222:223], v[222:223], v[58:59] op_sel:[0,1] op_sel_hi:[1,1]
    v_cvt_pk_bf16_f32 v166, v220, v221
    v_cvt_pk_bf16_f32 v167, v222, v223
    v_accvgpr_read_b32 v224, a56
    v_accvgpr_read_b32 v225, a57
    v_accvgpr_read_b32 v226, a58
    v_accvgpr_read_b32 v227, a59
    v_pk_mul_f32 v[224:225], v[224:225], v[60:61] op_sel:[0,0] op_sel_hi:[1,0]
    v_pk_mul_f32 v[226:227], v[226:227], v[60:61] op_sel:[0,0] op_sel_hi:[1,0]
    v_cvt_pk_bf16_f32 v150, v224, v225
    v_cvt_pk_bf16_f32 v151, v226, v227
    s_add_u32 s57, s59, 0
    buffer_load_dwordx4 a[24:27], v255, s[84:87], s57 offen
    v_accvgpr_read_b32 v228, a60
    v_accvgpr_read_b32 v229, a61
    v_accvgpr_read_b32 v230, a62
    v_accvgpr_read_b32 v231, a63
    v_pk_mul_f32 v[228:229], v[228:229], v[60:61] op_sel:[0,1] op_sel_hi:[1,1]
    v_pk_mul_f32 v[230:231], v[230:231], v[60:61] op_sel:[0,1] op_sel_hi:[1,1]
    v_cvt_pk_bf16_f32 v182, v228, v229
    v_cvt_pk_bf16_f32 v183, v230, v231
    v_accvgpr_read_b32 v216, a64
    v_accvgpr_read_b32 v217, a65
    v_accvgpr_read_b32 v218, a66
    v_accvgpr_read_b32 v219, a67
    v_pk_mul_f32 v[216:217], v[216:217], v[58:59] op_sel:[0,0] op_sel_hi:[1,0]
    v_pk_mul_f32 v[218:219], v[218:219], v[58:59] op_sel:[0,0] op_sel_hi:[1,0]
    v_cvt_pk_bf16_f32 v136, v216, v217
    v_cvt_pk_bf16_f32 v137, v218, v219
    v_accvgpr_read_b32 v220, a68
    v_accvgpr_read_b32 v221, a69
    v_accvgpr_read_b32 v222, a70
    v_accvgpr_read_b32 v223, a71
    v_pk_mul_f32 v[220:221], v[220:221], v[58:59] op_sel:[0,1] op_sel_hi:[1,1]
    v_pk_mul_f32 v[222:223], v[222:223], v[58:59] op_sel:[0,1] op_sel_hi:[1,1]
    v_cvt_pk_bf16_f32 v168, v220, v221
    v_cvt_pk_bf16_f32 v169, v222, v223
    s_add_u32 s57, s59, 4096
    buffer_load_dwordx4 a[28:31], v255, s[84:87], s57 offen
    v_accvgpr_read_b32 v224, a72
    v_accvgpr_read_b32 v225, a73
    v_accvgpr_read_b32 v226, a74
    v_accvgpr_read_b32 v227, a75
    v_pk_mul_f32 v[224:225], v[224:225], v[60:61] op_sel:[0,0] op_sel_hi:[1,0]
    v_pk_mul_f32 v[226:227], v[226:227], v[60:61] op_sel:[0,0] op_sel_hi:[1,0]
    v_cvt_pk_bf16_f32 v152, v224, v225
    v_cvt_pk_bf16_f32 v153, v226, v227
    v_accvgpr_read_b32 v228, a76
    v_accvgpr_read_b32 v229, a77
    v_accvgpr_read_b32 v230, a78
    v_accvgpr_read_b32 v231, a79
    v_pk_mul_f32 v[228:229], v[228:229], v[60:61] op_sel:[0,1] op_sel_hi:[1,1]
    v_pk_mul_f32 v[230:231], v[230:231], v[60:61] op_sel:[0,1] op_sel_hi:[1,1]
    v_cvt_pk_bf16_f32 v184, v228, v229
    v_cvt_pk_bf16_f32 v185, v230, v231
    s_add_u32 s57, s59, 8192
    buffer_load_dwordx4 a[32:35], v255, s[84:87], s57 offen
    v_accvgpr_read_b32 v216, a80
    v_accvgpr_read_b32 v217, a81
    v_accvgpr_read_b32 v218, a82
    v_accvgpr_read_b32 v219, a83
    v_pk_mul_f32 v[216:217], v[216:217], v[58:59] op_sel:[0,0] op_sel_hi:[1,0]
    v_pk_mul_f32 v[218:219], v[218:219], v[58:59] op_sel:[0,0] op_sel_hi:[1,0]
    v_cvt_pk_bf16_f32 v138, v216, v217
    v_cvt_pk_bf16_f32 v139, v218, v219
    v_accvgpr_read_b32 v220, a84
    v_accvgpr_read_b32 v221, a85
    v_accvgpr_read_b32 v222, a86
    v_accvgpr_read_b32 v223, a87
    v_pk_mul_f32 v[220:221], v[220:221], v[58:59] op_sel:[0,1] op_sel_hi:[1,1]
    v_pk_mul_f32 v[222:223], v[222:223], v[58:59] op_sel:[0,1] op_sel_hi:[1,1]
    v_cvt_pk_bf16_f32 v170, v220, v221
    v_cvt_pk_bf16_f32 v171, v222, v223
    s_add_u32 s57, s59, 12288
    buffer_load_dwordx4 a[36:39], v255, s[84:87], s57 offen
    v_accvgpr_read_b32 v224, a88
    v_accvgpr_read_b32 v225, a89
    v_accvgpr_read_b32 v226, a90
    v_accvgpr_read_b32 v227, a91
    v_pk_mul_f32 v[224:225], v[224:225], v[60:61] op_sel:[0,0] op_sel_hi:[1,0]
    v_pk_mul_f32 v[226:227], v[226:227], v[60:61] op_sel:[0,0] op_sel_hi:[1,0]
    v_cvt_pk_bf16_f32 v154, v224, v225
    v_cvt_pk_bf16_f32 v155, v226, v227
    v_accvgpr_read_b32 v228, a92
    v_accvgpr_read_b32 v229, a93
    v_accvgpr_read_b32 v230, a94
    v_accvgpr_read_b32 v231, a95
    v_pk_mul_f32 v[228:229], v[228:229], v[60:61] op_sel:[0,1] op_sel_hi:[1,1]
    v_pk_mul_f32 v[230:231], v[230:231], v[60:61] op_sel:[0,1] op_sel_hi:[1,1]
    v_cvt_pk_bf16_f32 v186, v228, v229
    v_cvt_pk_bf16_f32 v187, v230, v231
    s_add_u32 s57, s59, 16384
    buffer_load_dwordx4 a[40:43], v255, s[84:87], s57 offen
    v_accvgpr_read_b32 v216, a96
    v_accvgpr_read_b32 v217, a97
    v_accvgpr_read_b32 v218, a98
    v_accvgpr_read_b32 v219, a99
    v_pk_mul_f32 v[216:217], v[216:217], v[58:59] op_sel:[0,0] op_sel_hi:[1,0]
    v_pk_mul_f32 v[218:219], v[218:219], v[58:59] op_sel:[0,0] op_sel_hi:[1,0]
    v_cvt_pk_bf16_f32 v140, v216, v217
    v_cvt_pk_bf16_f32 v141, v218, v219
    v_accvgpr_read_b32 v220, a100
    v_accvgpr_read_b32 v221, a101
    v_accvgpr_read_b32 v222, a102
    v_accvgpr_read_b32 v223, a103
    v_pk_mul_f32 v[220:221], v[220:221], v[58:59] op_sel:[0,1] op_sel_hi:[1,1]
    v_pk_mul_f32 v[222:223], v[222:223], v[58:59] op_sel:[0,1] op_sel_hi:[1,1]
    v_cvt_pk_bf16_f32 v172, v220, v221
    v_cvt_pk_bf16_f32 v173, v222, v223
    s_add_u32 s57, s59, 20480
    buffer_load_dwordx4 a[44:47], v255, s[84:87], s57 offen
    v_accvgpr_read_b32 v224, a104
    v_accvgpr_read_b32 v225, a105
    v_accvgpr_read_b32 v226, a106
    v_accvgpr_read_b32 v227, a107
    v_pk_mul_f32 v[224:225], v[224:225], v[60:61] op_sel:[0,0] op_sel_hi:[1,0]
    v_pk_mul_f32 v[226:227], v[226:227], v[60:61] op_sel:[0,0] op_sel_hi:[1,0]
    v_cvt_pk_bf16_f32 v156, v224, v225
    v_cvt_pk_bf16_f32 v157, v226, v227
    v_accvgpr_read_b32 v228, a108
    v_accvgpr_read_b32 v229, a109
    v_accvgpr_read_b32 v230, a110
    v_accvgpr_read_b32 v231, a111
    v_pk_mul_f32 v[228:229], v[228:229], v[60:61] op_sel:[0,1] op_sel_hi:[1,1]
    v_pk_mul_f32 v[230:231], v[230:231], v[60:61] op_sel:[0,1] op_sel_hi:[1,1]
    v_cvt_pk_bf16_f32 v188, v228, v229
    v_cvt_pk_bf16_f32 v189, v230, v231
    s_add_u32 s57, s59, 24576
    buffer_load_dwordx4 a[48:51], v255, s[84:87], s57 offen
    v_accvgpr_read_b32 v216, a112
    v_accvgpr_read_b32 v217, a113
    v_accvgpr_read_b32 v218, a114
    v_accvgpr_read_b32 v219, a115
    v_pk_mul_f32 v[216:217], v[216:217], v[58:59] op_sel:[0,0] op_sel_hi:[1,0]
    v_pk_mul_f32 v[218:219], v[218:219], v[58:59] op_sel:[0,0] op_sel_hi:[1,0]
    v_cvt_pk_bf16_f32 v142, v216, v217
    v_cvt_pk_bf16_f32 v143, v218, v219
    v_accvgpr_read_b32 v220, a116
    v_accvgpr_read_b32 v221, a117
    v_accvgpr_read_b32 v222, a118
    v_accvgpr_read_b32 v223, a119
    v_pk_mul_f32 v[220:221], v[220:221], v[58:59] op_sel:[0,1] op_sel_hi:[1,1]
    v_pk_mul_f32 v[222:223], v[222:223], v[58:59] op_sel:[0,1] op_sel_hi:[1,1]
    v_cvt_pk_bf16_f32 v174, v220, v221
    v_cvt_pk_bf16_f32 v175, v222, v223
    s_add_u32 s57, s59, 28672
    buffer_load_dwordx4 a[52:55], v255, s[84:87], s57 offen
    v_accvgpr_read_b32 v224, a120
    v_accvgpr_read_b32 v225, a121
    v_accvgpr_read_b32 v226, a122
    v_accvgpr_read_b32 v227, a123
    v_pk_mul_f32 v[224:225], v[224:225], v[60:61] op_sel:[0,0] op_sel_hi:[1,0]
    v_pk_mul_f32 v[226:227], v[226:227], v[60:61] op_sel:[0,0] op_sel_hi:[1,0]
    v_cvt_pk_bf16_f32 v158, v224, v225
    v_cvt_pk_bf16_f32 v159, v226, v227
    v_accvgpr_read_b32 v228, a124
    v_accvgpr_read_b32 v229, a125
    v_accvgpr_read_b32 v230, a126
    v_accvgpr_read_b32 v231, a127
    v_pk_mul_f32 v[228:229], v[228:229], v[60:61] op_sel:[0,1] op_sel_hi:[1,1]
    v_pk_mul_f32 v[230:231], v[230:231], v[60:61] op_sel:[0,1] op_sel_hi:[1,1]
    v_cvt_pk_bf16_f32 v190, v228, v229
    v_cvt_pk_bf16_f32 v191, v230, v231
    s_add_u32 s57, s59, 32768
    buffer_load_dwordx4 a[56:59], v255, s[84:87], s57 offen
    s_waitcnt lgkmcnt(14)
    v_mfma_f32_16x16x32_bf16 v[192:195], a[208:211], v[128:131], 0
    s_waitcnt lgkmcnt(12)
    ds_read_b64_tr_b16 a[160:161], v29 offset:0
    v_mfma_f32_16x16x32_bf16 v[192:195], a[212:215], v[132:135], v[192:195]
    s_waitcnt lgkmcnt(11)
    ds_read_b64_tr_b16 a[162:163], v29 offset:4096
    v_mfma_f32_16x16x32_bf16 v[192:195], a[216:219], v[136:139], v[192:195]
    s_waitcnt lgkmcnt(10)
    s_load_dwordx2 s[12:13], s[0:1], 0
    ds_read_b64_tr_b16 a[164:165], v29 offset:8192
    v_mfma_f32_16x16x32_bf16 v[192:195], a[220:223], v[140:143], v[192:195]
    s_waitcnt lgkmcnt(9)
    s_load_dwordx2 s[16:17], s[0:1], 96
    ds_read_b64_tr_b16 a[166:167], v29 offset:12288
    v_mfma_f32_16x16x32_bf16 v[192:195], a[224:227], v[144:147], v[192:195]
    s_waitcnt lgkmcnt(8)
    s_load_dwordx2 s[52:53], s[0:1], 48
    ds_read_b64_tr_b16 a[168:169], v29 offset:16384
    v_mfma_f32_16x16x32_bf16 v[192:195], a[228:231], v[148:151], v[192:195]
    s_waitcnt lgkmcnt(7)
    ds_read_b64_tr_b16 a[170:171], v29 offset:20480
    v_mfma_f32_16x16x32_bf16 v[192:195], a[232:235], v[152:155], v[192:195]
    s_waitcnt lgkmcnt(6)
    ds_read_b64_tr_b16 a[172:173], v29 offset:24576
    v_mfma_f32_16x16x32_bf16 v[192:195], a[236:239], v[156:159], v[192:195]
    ds_read_b64_tr_b16 a[174:175], v29 offset:28672
    v_mfma_f32_16x16x32_bf16 v[196:199], a[208:211], v[160:163], 0
    ds_read_b64_tr_b16 a[176:177], v33 offset:0
    v_mfma_f32_16x16x32_bf16 v[196:199], a[212:215], v[164:167], v[196:199]
    ds_read_b64_tr_b16 a[178:179], v33 offset:4096
    v_mfma_f32_16x16x32_bf16 v[196:199], a[216:219], v[168:171], v[196:199]
    ds_read_b64_tr_b16 a[180:181], v33 offset:8192
    v_mfma_f32_16x16x32_bf16 v[196:199], a[220:223], v[172:175], v[196:199]
    ds_read_b64_tr_b16 a[182:183], v33 offset:12288
    v_mfma_f32_16x16x32_bf16 v[196:199], a[224:227], v[176:179], v[196:199]
    ds_read_b64_tr_b16 a[184:185], v33 offset:16384
    v_cvt_pk_bf16_f32 v224, v192, v193
    v_mfma_f32_16x16x32_bf16 v[196:199], a[228:231], v[180:183], v[196:199]
    ds_read_b64_tr_b16 a[186:187], v33 offset:20480
    v_cvt_pk_bf16_f32 v225, v194, v195
    v_mfma_f32_16x16x32_bf16 v[196:199], a[232:235], v[184:187], v[196:199]
    ds_read_b64_tr_b16 a[188:189], v33 offset:24576
    v_mfma_f32_16x16x32_bf16 v[196:199], a[236:239], v[188:191], v[196:199]
    s_waitcnt lgkmcnt(13)
    ds_read_b64_tr_b16 a[190:191], v33 offset:28672
    v_mfma_f32_16x16x32_bf16 v[200:203], a[160:163], v[128:131], 0
    s_waitcnt lgkmcnt(12)
    ds_read_b64_tr_b16 a[208:209], v30 offset:0
    v_mfma_f32_16x16x32_bf16 v[200:203], a[164:167], v[132:135], v[200:203]
    s_waitcnt lgkmcnt(11)
    ds_read_b64_tr_b16 a[210:211], v30 offset:4096
    v_mfma_f32_16x16x32_bf16 v[200:203], a[168:171], v[136:139], v[200:203]
    s_waitcnt lgkmcnt(10)
    ds_read_b64_tr_b16 a[212:213], v30 offset:8192
    v_mfma_f32_16x16x32_bf16 v[200:203], a[172:175], v[140:143], v[200:203]
    s_waitcnt lgkmcnt(9)
    ds_read_b64_tr_b16 a[214:215], v30 offset:12288
    v_mfma_f32_16x16x32_bf16 v[200:203], a[176:179], v[144:147], v[200:203]
    s_waitcnt lgkmcnt(8)
    ds_read_b64_tr_b16 a[216:217], v30 offset:16384
    v_cvt_pk_bf16_f32 v228, v196, v197
    v_mfma_f32_16x16x32_bf16 v[200:203], a[180:183], v[148:151], v[200:203]
    s_waitcnt lgkmcnt(7)
    ds_read_b64_tr_b16 a[218:219], v30 offset:20480
    v_cvt_pk_bf16_f32 v229, v198, v199
    v_mfma_f32_16x16x32_bf16 v[200:203], a[184:187], v[152:155], v[200:203]
    s_waitcnt lgkmcnt(6)
    ds_read_b64_tr_b16 a[220:221], v30 offset:24576
    v_mfma_f32_16x16x32_bf16 v[200:203], a[188:191], v[156:159], v[200:203]
    ds_read_b64_tr_b16 a[222:223], v30 offset:28672
    v_mfma_f32_16x16x32_bf16 v[204:207], a[160:163], v[160:163], 0
    ds_read_b64_tr_b16 a[224:225], v34 offset:0
    v_mfma_f32_16x16x32_bf16 v[204:207], a[164:167], v[164:167], v[204:207]
    ds_read_b64_tr_b16 a[226:227], v34 offset:4096
    v_mfma_f32_16x16x32_bf16 v[204:207], a[168:171], v[168:171], v[204:207]
    ds_read_b64_tr_b16 a[228:229], v34 offset:8192
    v_mfma_f32_16x16x32_bf16 v[204:207], a[172:175], v[172:175], v[204:207]
    ds_read_b64_tr_b16 a[230:231], v34 offset:12288
    v_mfma_f32_16x16x32_bf16 v[204:207], a[176:179], v[176:179], v[204:207]
    ds_read_b64_tr_b16 a[232:233], v34 offset:16384
    v_cvt_pk_bf16_f32 v226, v200, v201
    v_mfma_f32_16x16x32_bf16 v[204:207], a[180:183], v[180:183], v[204:207]
    s_add_u32 s38, s47, 0
    ds_read_b64_tr_b16 a[234:235], v34 offset:20480
    v_cvt_pk_bf16_f32 v227, v202, v203
    v_mfma_f32_16x16x32_bf16 v[204:207], a[184:187], v[184:187], v[204:207]
    buffer_store_dwordx4 v[224:227], v56, s[28:31], s38 offen sc1
    v_mfma_f32_16x16x32_bf16 v[204:207], a[188:191], v[188:191], v[204:207]
    s_waitcnt lgkmcnt(12)
    ds_read_b64_tr_b16 a[236:237], v34 offset:24576
    ds_read_b64_tr_b16 a[238:239], v34 offset:28672
    v_mfma_f32_16x16x32_bf16 v[192:195], a[208:211], v[128:131], 0
    s_waitcnt lgkmcnt(12)
    ds_read_b64_tr_b16 a[160:161], v31 offset:0
    v_mfma_f32_16x16x32_bf16 v[192:195], a[212:215], v[132:135], v[192:195]
    s_waitcnt lgkmcnt(11)
    ds_read_b64_tr_b16 a[162:163], v31 offset:4096
    v_mfma_f32_16x16x32_bf16 v[192:195], a[216:219], v[136:139], v[192:195]
    s_waitcnt lgkmcnt(10)
    ds_read_b64_tr_b16 a[164:165], v31 offset:8192
    v_mfma_f32_16x16x32_bf16 v[192:195], a[220:223], v[140:143], v[192:195]
    s_waitcnt lgkmcnt(9)
    ds_read_b64_tr_b16 a[166:167], v31 offset:12288
    v_mfma_f32_16x16x32_bf16 v[192:195], a[224:227], v[144:147], v[192:195]
    s_waitcnt lgkmcnt(8)
    ds_read_b64_tr_b16 a[168:169], v31 offset:16384
    v_cvt_pk_bf16_f32 v230, v204, v205
    v_mfma_f32_16x16x32_bf16 v[192:195], a[228:231], v[148:151], v[192:195]
    s_waitcnt lgkmcnt(7)
    s_add_u32 s38, s47, 294912
    ds_read_b64_tr_b16 a[170:171], v31 offset:20480
    v_cvt_pk_bf16_f32 v231, v206, v207
    v_mfma_f32_16x16x32_bf16 v[192:195], a[232:235], v[152:155], v[192:195]
    s_waitcnt lgkmcnt(6)
    buffer_store_dwordx4 v[228:231], v56, s[28:31], s38 offen sc1
    v_mfma_f32_16x16x32_bf16 v[192:195], a[236:239], v[156:159], v[192:195]
    ds_read_b64_tr_b16 a[172:173], v31 offset:24576
    ds_read_b64_tr_b16 a[174:175], v31 offset:28672
    v_mfma_f32_16x16x32_bf16 v[196:199], a[208:211], v[160:163], 0
    ds_read_b64_tr_b16 a[176:177], v35 offset:0
    v_mfma_f32_16x16x32_bf16 v[196:199], a[212:215], v[164:167], v[196:199]
    ds_read_b64_tr_b16 a[178:179], v35 offset:4096
    v_mfma_f32_16x16x32_bf16 v[196:199], a[216:219], v[168:171], v[196:199]
    ds_read_b64_tr_b16 a[180:181], v35 offset:8192
    v_mfma_f32_16x16x32_bf16 v[196:199], a[220:223], v[172:175], v[196:199]
    ds_read_b64_tr_b16 a[182:183], v35 offset:12288
    v_mfma_f32_16x16x32_bf16 v[196:199], a[224:227], v[176:179], v[196:199]
    ds_read_b64_tr_b16 a[184:185], v35 offset:16384
    v_cvt_pk_bf16_f32 v232, v192, v193
    v_mfma_f32_16x16x32_bf16 v[196:199], a[228:231], v[180:183], v[196:199]
    ds_read_b64_tr_b16 a[186:187], v35 offset:20480
    v_cvt_pk_bf16_f32 v233, v194, v195
    v_mfma_f32_16x16x32_bf16 v[196:199], a[232:235], v[184:187], v[196:199]
    ds_read_b64_tr_b16 a[188:189], v35 offset:24576
    v_mfma_f32_16x16x32_bf16 v[196:199], a[236:239], v[188:191], v[196:199]
    s_waitcnt lgkmcnt(13)
    ds_read_b64_tr_b16 a[190:191], v35 offset:28672
    s_waitcnt vmcnt(29)
    s_barrier
    v_mfma_f32_16x16x32_bf16 v[200:203], a[160:163], v[128:131], 0
    s_waitcnt lgkmcnt(12)
    ds_read_b64_tr_b16 a[208:209], v12 offset:0
    v_mfma_f32_16x16x32_bf16 v[200:203], a[164:167], v[132:135], v[200:203]
    s_waitcnt lgkmcnt(11)
    ds_read_b64_tr_b16 a[210:211], v12 offset:4096
    v_mfma_f32_16x16x32_bf16 v[200:203], a[168:171], v[136:139], v[200:203]
    s_waitcnt lgkmcnt(10)
    ds_read_b64_tr_b16 a[212:213], v12 offset:8192
    v_mfma_f32_16x16x32_bf16 v[200:203], a[172:175], v[140:143], v[200:203]
    s_waitcnt lgkmcnt(9)
    ds_read_b64_tr_b16 a[214:215], v12 offset:12288
    v_mfma_f32_16x16x32_bf16 v[200:203], a[176:179], v[144:147], v[200:203]
    s_waitcnt lgkmcnt(8)
    ds_read_b64_tr_b16 a[216:217], v12 offset:16384
    v_cvt_pk_bf16_f32 v236, v196, v197
    v_mfma_f32_16x16x32_bf16 v[200:203], a[180:183], v[148:151], v[200:203]
    s_waitcnt lgkmcnt(7)
    ds_read_b64_tr_b16 a[218:219], v12 offset:20480
    v_cvt_pk_bf16_f32 v237, v198, v199
    v_mfma_f32_16x16x32_bf16 v[200:203], a[184:187], v[152:155], v[200:203]
    s_waitcnt lgkmcnt(6)
    s_add_u32 s49, s45, 74112
    ds_read_b64_tr_b16 a[220:221], v12 offset:24576
    v_mfma_f32_16x16x32_bf16 v[200:203], a[188:191], v[156:159], v[200:203]
    s_add_u32 m0, s42, 81920
    ds_read_b64_tr_b16 a[222:223], v12 offset:28672
    v_mfma_f32_16x16x32_bf16 v[204:207], a[160:163], v[160:163], 0
    buffer_load_dwordx4 v46, s[20:23], s49 offen lds
    v_mfma_f32_16x16x32_bf16 v[204:207], a[164:167], v[164:167], v[204:207]
    ds_read_b64_tr_b16 a[224:225], v16 offset:0
    ds_read_b64_tr_b16 a[226:227], v16 offset:4096
    v_mfma_f32_16x16x32_bf16 v[204:207], a[168:171], v[168:171], v[204:207]
    buffer_load_dwordx4 v47, s[20:23], s49 offen offset:1024 lds
    v_mfma_f32_16x16x32_bf16 v[204:207], a[172:175], v[172:175], v[204:207]
    ds_read_b64_tr_b16 a[228:229], v16 offset:8192
    ds_read_b64_tr_b16 a[230:231], v16 offset:12288
    v_mfma_f32_16x16x32_bf16 v[204:207], a[176:179], v[176:179], v[204:207]
    ds_read_b64_tr_b16 a[232:233], v16 offset:16384
    v_cvt_pk_bf16_f32 v234, v200, v201
    v_mfma_f32_16x16x32_bf16 v[204:207], a[180:183], v[180:183], v[204:207]
    s_add_u32 s38, s47, 128
    ds_read_b64_tr_b16 a[234:235], v16 offset:20480
    v_cvt_pk_bf16_f32 v235, v202, v203
    v_mfma_f32_16x16x32_bf16 v[204:207], a[184:187], v[184:187], v[204:207]
    buffer_store_dwordx4 v[232:235], v56, s[28:31], s38 offen sc1
    v_mfma_f32_16x16x32_bf16 v[204:207], a[188:191], v[188:191], v[204:207]
    s_waitcnt lgkmcnt(12)
    ds_read_b64_tr_b16 a[236:237], v16 offset:24576
    ds_read_b64_tr_b16 a[238:239], v16 offset:28672
    v_mfma_f32_16x16x32_bf16 v[192:195], a[208:211], v[128:131], 0
    s_waitcnt lgkmcnt(12)
    buffer_load_dwordx4 v48, s[20:23], s49 offen offset:2048 lds
    v_mfma_f32_16x16x32_bf16 v[192:195], a[212:215], v[132:135], v[192:195]
    s_waitcnt lgkmcnt(10)
    ds_read_b64_tr_b16 a[160:161], v13 offset:0
    ds_read_b64_tr_b16 a[162:163], v13 offset:4096
    v_mfma_f32_16x16x32_bf16 v[192:195], a[216:219], v[136:139], v[192:195]
    s_waitcnt lgkmcnt(10)
    buffer_load_dwordx4 v49, s[20:23], s49 offen offset:3072 lds
    v_mfma_f32_16x16x32_bf16 v[192:195], a[220:223], v[140:143], v[192:195]
    s_waitcnt lgkmcnt(8)
    ds_read_b64_tr_b16 a[164:165], v13 offset:8192
    ds_read_b64_tr_b16 a[166:167], v13 offset:12288
    v_mfma_f32_16x16x32_bf16 v[192:195], a[224:227], v[144:147], v[192:195]
    s_waitcnt lgkmcnt(8)
    ds_read_b64_tr_b16 a[168:169], v13 offset:16384
    v_cvt_pk_bf16_f32 v238, v204, v205
    v_mfma_f32_16x16x32_bf16 v[192:195], a[228:231], v[148:151], v[192:195]
    s_waitcnt lgkmcnt(7)
    s_add_u32 s38, s47, 295040
    ds_read_b64_tr_b16 a[170:171], v13 offset:20480
    v_cvt_pk_bf16_f32 v239, v206, v207
    v_mfma_f32_16x16x32_bf16 v[192:195], a[232:235], v[152:155], v[192:195]
    s_waitcnt lgkmcnt(6)
    s_add_u32 s49, s45, 512
    buffer_store_dwordx4 v[236:239], v56, s[28:31], s38 offen sc1
    v_mfma_f32_16x16x32_bf16 v[192:195], a[236:239], v[156:159], v[192:195]
    s_add_u32 m0, s42, 98304
    ds_read_b64_tr_b16 a[172:173], v13 offset:24576
    ds_read_b64_tr_b16 a[174:175], v13 offset:28672
    v_mfma_f32_16x16x32_bf16 v[196:199], a[208:211], v[160:163], 0
    buffer_load_dwordx4 v46, s[20:23], s49 offen lds
    v_mfma_f32_16x16x32_bf16 v[196:199], a[212:215], v[164:167], v[196:199]
    ds_read_b64_tr_b16 a[176:177], v17 offset:0
    ds_read_b64_tr_b16 a[178:179], v17 offset:4096
    v_mfma_f32_16x16x32_bf16 v[196:199], a[216:219], v[168:171], v[196:199]
    buffer_load_dwordx4 v47, s[20:23], s49 offen offset:1024 lds
    v_mfma_f32_16x16x32_bf16 v[196:199], a[220:223], v[172:175], v[196:199]
    ds_read_b64_tr_b16 a[180:181], v17 offset:8192
    ds_read_b64_tr_b16 a[182:183], v17 offset:12288
    v_mfma_f32_16x16x32_bf16 v[196:199], a[224:227], v[176:179], v[196:199]
    ds_read_b64_tr_b16 a[184:185], v17 offset:16384
    v_cvt_pk_bf16_f32 v224, v192, v193
    v_mfma_f32_16x16x32_bf16 v[196:199], a[228:231], v[180:183], v[196:199]
    ds_read_b64_tr_b16 a[186:187], v17 offset:20480
    v_cvt_pk_bf16_f32 v225, v194, v195
    v_mfma_f32_16x16x32_bf16 v[196:199], a[232:235], v[184:187], v[196:199]
    ds_read_b64_tr_b16 a[188:189], v17 offset:24576
    v_mfma_f32_16x16x32_bf16 v[196:199], a[236:239], v[188:191], v[196:199]
    s_waitcnt lgkmcnt(13)
    ds_read_b64_tr_b16 a[190:191], v17 offset:28672
    v_mfma_f32_16x16x32_bf16 v[200:203], a[160:163], v[128:131], 0
    s_waitcnt lgkmcnt(12)
    buffer_load_dwordx4 v48, s[20:23], s49 offen offset:2048 lds
    v_mfma_f32_16x16x32_bf16 v[200:203], a[164:167], v[132:135], v[200:203]
    s_waitcnt lgkmcnt(10)
    ds_read_b64_tr_b16 a[208:209], v14 offset:0
    ds_read_b64_tr_b16 a[210:211], v14 offset:4096
    v_mfma_f32_16x16x32_bf16 v[200:203], a[168:171], v[136:139], v[200:203]
    s_waitcnt lgkmcnt(10)
    buffer_load_dwordx4 v49, s[20:23], s49 offen offset:3072 lds
    v_mfma_f32_16x16x32_bf16 v[200:203], a[172:175], v[140:143], v[200:203]
    s_waitcnt lgkmcnt(8)
    ds_read_b64_tr_b16 a[212:213], v14 offset:8192
    ds_read_b64_tr_b16 a[214:215], v14 offset:12288
    v_mfma_f32_16x16x32_bf16 v[200:203], a[176:179], v[144:147], v[200:203]
    s_waitcnt lgkmcnt(8)
    ds_read_b64_tr_b16 a[216:217], v14 offset:16384
    v_cvt_pk_bf16_f32 v228, v196, v197
    v_mfma_f32_16x16x32_bf16 v[200:203], a[180:183], v[148:151], v[200:203]
    s_waitcnt lgkmcnt(7)
    ds_read_b64_tr_b16 a[218:219], v14 offset:20480
    v_cvt_pk_bf16_f32 v229, v198, v199
    v_mfma_f32_16x16x32_bf16 v[200:203], a[184:187], v[152:155], v[200:203]
    s_waitcnt lgkmcnt(6)
    s_add_u32 s49, s45, 74240
    ds_read_b64_tr_b16 a[220:221], v14 offset:24576
    v_mfma_f32_16x16x32_bf16 v[200:203], a[188:191], v[156:159], v[200:203]
    s_add_u32 m0, s42, 114688
    ds_read_b64_tr_b16 a[222:223], v14 offset:28672
    v_mfma_f32_16x16x32_bf16 v[204:207], a[160:163], v[160:163], 0
    buffer_load_dwordx4 v46, s[20:23], s49 offen lds
    v_mfma_f32_16x16x32_bf16 v[204:207], a[164:167], v[164:167], v[204:207]
    ds_read_b64_tr_b16 a[224:225], v18 offset:0
    ds_read_b64_tr_b16 a[226:227], v18 offset:4096
    v_mfma_f32_16x16x32_bf16 v[204:207], a[168:171], v[168:171], v[204:207]
    buffer_load_dwordx4 v47, s[20:23], s49 offen offset:1024 lds
    v_mfma_f32_16x16x32_bf16 v[204:207], a[172:175], v[172:175], v[204:207]
    ds_read_b64_tr_b16 a[228:229], v18 offset:8192
    ds_read_b64_tr_b16 a[230:231], v18 offset:12288
    v_mfma_f32_16x16x32_bf16 v[204:207], a[176:179], v[176:179], v[204:207]
    ds_read_b64_tr_b16 a[232:233], v18 offset:16384
    v_cvt_pk_bf16_f32 v226, v200, v201
    v_mfma_f32_16x16x32_bf16 v[204:207], a[180:183], v[180:183], v[204:207]
    s_add_u32 s38, s47, 256
    ds_read_b64_tr_b16 a[234:235], v18 offset:20480
    v_cvt_pk_bf16_f32 v227, v202, v203
    v_mfma_f32_16x16x32_bf16 v[204:207], a[184:187], v[184:187], v[204:207]
    buffer_store_dwordx4 v[224:227], v56, s[28:31], s38 offen sc1
    v_mfma_f32_16x16x32_bf16 v[204:207], a[188:191], v[188:191], v[204:207]
    s_waitcnt lgkmcnt(12)
    ds_read_b64_tr_b16 a[236:237], v18 offset:24576
    ds_read_b64_tr_b16 a[238:239], v18 offset:28672
    v_mfma_f32_16x16x32_bf16 v[192:195], a[208:211], v[128:131], 0
    s_waitcnt lgkmcnt(12)
    buffer_load_dwordx4 v48, s[20:23], s49 offen offset:2048 lds
    v_mfma_f32_16x16x32_bf16 v[192:195], a[212:215], v[132:135], v[192:195]
    s_waitcnt lgkmcnt(10)
    ds_read_b64_tr_b16 a[160:161], v15 offset:0
    ds_read_b64_tr_b16 a[162:163], v15 offset:4096
    v_mfma_f32_16x16x32_bf16 v[192:195], a[216:219], v[136:139], v[192:195]
    s_waitcnt lgkmcnt(10)
    buffer_load_dwordx4 v49, s[20:23], s49 offen offset:3072 lds
    v_mfma_f32_16x16x32_bf16 v[192:195], a[220:223], v[140:143], v[192:195]
    s_waitcnt lgkmcnt(8)
    ds_read_b64_tr_b16 a[164:165], v15 offset:8192
    ds_read_b64_tr_b16 a[166:167], v15 offset:12288
    v_mfma_f32_16x16x32_bf16 v[192:195], a[224:227], v[144:147], v[192:195]
    s_waitcnt lgkmcnt(8)
    ds_read_b64_tr_b16 a[168:169], v15 offset:16384
    v_cvt_pk_bf16_f32 v230, v204, v205
    v_mfma_f32_16x16x32_bf16 v[192:195], a[228:231], v[148:151], v[192:195]
    s_waitcnt lgkmcnt(7)
    s_add_u32 s38, s47, 295168
    ds_read_b64_tr_b16 a[170:171], v15 offset:20480
    v_cvt_pk_bf16_f32 v231, v206, v207
    v_mfma_f32_16x16x32_bf16 v[192:195], a[232:235], v[152:155], v[192:195]
    s_waitcnt lgkmcnt(6)
    buffer_store_dwordx4 v[228:231], v56, s[28:31], s38 offen sc1
    v_mfma_f32_16x16x32_bf16 v[192:195], a[236:239], v[156:159], v[192:195]
    ds_read_b64_tr_b16 a[172:173], v15 offset:24576
    ds_read_b64_tr_b16 a[174:175], v15 offset:28672
    v_mfma_f32_16x16x32_bf16 v[196:199], a[208:211], v[160:163], 0
    ds_read_b64_tr_b16 a[176:177], v19 offset:0
    v_mfma_f32_16x16x32_bf16 v[196:199], a[212:215], v[164:167], v[196:199]
    ds_read_b64_tr_b16 a[178:179], v19 offset:4096
    v_mfma_f32_16x16x32_bf16 v[196:199], a[216:219], v[168:171], v[196:199]
    ds_read_b64_tr_b16 a[180:181], v19 offset:8192
    v_mfma_f32_16x16x32_bf16 v[196:199], a[220:223], v[172:175], v[196:199]
    ds_read_b64_tr_b16 a[182:183], v19 offset:12288
    v_mfma_f32_16x16x32_bf16 v[196:199], a[224:227], v[176:179], v[196:199]
    ds_read_b64_tr_b16 a[184:185], v19 offset:16384
    v_cvt_pk_bf16_f32 v232, v192, v193
    v_mfma_f32_16x16x32_bf16 v[196:199], a[228:231], v[180:183], v[196:199]
    ds_read_b64_tr_b16 a[186:187], v19 offset:20480
    v_cvt_pk_bf16_f32 v233, v194, v195
    v_mfma_f32_16x16x32_bf16 v[196:199], a[232:235], v[184:187], v[196:199]
    ds_read_b64_tr_b16 a[188:189], v19 offset:24576
    v_mfma_f32_16x16x32_bf16 v[196:199], a[236:239], v[188:191], v[196:199]
    s_waitcnt lgkmcnt(13)
    ds_read_b64_tr_b16 a[190:191], v19 offset:28672
    s_waitcnt vmcnt(37)
    s_barrier
    v_mfma_f32_16x16x32_bf16 v[200:203], a[160:163], v[128:131], 0
    s_waitcnt lgkmcnt(12)
    ds_read_b64_tr_b16 a[208:209], v12 offset:32768
    v_mfma_f32_16x16x32_bf16 v[200:203], a[164:167], v[132:135], v[200:203]
    s_waitcnt lgkmcnt(11)
    ds_read_b64_tr_b16 a[210:211], v12 offset:36864
    v_mfma_f32_16x16x32_bf16 v[200:203], a[168:171], v[136:139], v[200:203]
    s_waitcnt lgkmcnt(10)
    ds_read_b64_tr_b16 a[212:213], v12 offset:40960
    v_mfma_f32_16x16x32_bf16 v[200:203], a[172:175], v[140:143], v[200:203]
    s_waitcnt lgkmcnt(9)
    ds_read_b64_tr_b16 a[214:215], v12 offset:45056
    v_mfma_f32_16x16x32_bf16 v[200:203], a[176:179], v[144:147], v[200:203]
    s_waitcnt lgkmcnt(8)
    ds_read_b64_tr_b16 a[216:217], v12 offset:49152
    v_cvt_pk_bf16_f32 v236, v196, v197
    v_mfma_f32_16x16x32_bf16 v[200:203], a[180:183], v[148:151], v[200:203]
    s_waitcnt lgkmcnt(7)
    ds_read_b64_tr_b16 a[218:219], v12 offset:53248
    v_cvt_pk_bf16_f32 v237, v198, v199
    v_mfma_f32_16x16x32_bf16 v[200:203], a[184:187], v[152:155], v[200:203]
    s_waitcnt lgkmcnt(6)
    s_add_u32 s49, s45, 640
    ds_read_b64_tr_b16 a[220:221], v12 offset:57344
    v_mfma_f32_16x16x32_bf16 v[200:203], a[188:191], v[156:159], v[200:203]
    s_add_u32 m0, s42, 131072
    ds_read_b64_tr_b16 a[222:223], v12 offset:61440
    v_mfma_f32_16x16x32_bf16 v[204:207], a[160:163], v[160:163], 0
    buffer_load_dwordx4 v46, s[20:23], s49 offen lds
    v_mfma_f32_16x16x32_bf16 v[204:207], a[164:167], v[164:167], v[204:207]
    ds_read_b64_tr_b16 a[224:225], v16 offset:32768
    ds_read_b64_tr_b16 a[226:227], v16 offset:36864
    v_mfma_f32_16x16x32_bf16 v[204:207], a[168:171], v[168:171], v[204:207]
    buffer_load_dwordx4 v47, s[20:23], s49 offen offset:1024 lds
    v_mfma_f32_16x16x32_bf16 v[204:207], a[172:175], v[172:175], v[204:207]
    ds_read_b64_tr_b16 a[228:229], v16 offset:40960
    ds_read_b64_tr_b16 a[230:231], v16 offset:45056
    v_mfma_f32_16x16x32_bf16 v[204:207], a[176:179], v[176:179], v[204:207]
    ds_read_b64_tr_b16 a[232:233], v16 offset:49152
    v_cvt_pk_bf16_f32 v234, v200, v201
    v_mfma_f32_16x16x32_bf16 v[204:207], a[180:183], v[180:183], v[204:207]
    s_add_u32 s38, s47, 384
    ds_read_b64_tr_b16 a[234:235], v16 offset:53248
    v_cvt_pk_bf16_f32 v235, v202, v203
    v_mfma_f32_16x16x32_bf16 v[204:207], a[184:187], v[184:187], v[204:207]
    buffer_store_dwordx4 v[232:235], v56, s[28:31], s38 offen sc1
    v_mfma_f32_16x16x32_bf16 v[204:207], a[188:191], v[188:191], v[204:207]
    s_waitcnt lgkmcnt(12)
    ds_read_b64_tr_b16 a[236:237], v16 offset:57344
    ds_read_b64_tr_b16 a[238:239], v16 offset:61440
    v_mfma_f32_16x16x32_bf16 v[192:195], a[208:211], v[128:131], 0
    s_waitcnt lgkmcnt(12)
    buffer_load_dwordx4 v48, s[20:23], s49 offen offset:2048 lds
    v_mfma_f32_16x16x32_bf16 v[192:195], a[212:215], v[132:135], v[192:195]
    s_waitcnt lgkmcnt(10)
    ds_read_b64_tr_b16 a[160:161], v13 offset:32768
    ds_read_b64_tr_b16 a[162:163], v13 offset:36864
    v_mfma_f32_16x16x32_bf16 v[192:195], a[216:219], v[136:139], v[192:195]
    s_waitcnt lgkmcnt(10)
    buffer_load_dwordx4 v49, s[20:23], s49 offen offset:3072 lds
    v_mfma_f32_16x16x32_bf16 v[192:195], a[220:223], v[140:143], v[192:195]
    s_waitcnt lgkmcnt(8)
    ds_read_b64_tr_b16 a[164:165], v13 offset:40960
    ds_read_b64_tr_b16 a[166:167], v13 offset:45056
    v_mfma_f32_16x16x32_bf16 v[192:195], a[224:227], v[144:147], v[192:195]
    s_waitcnt lgkmcnt(8)
    ds_read_b64_tr_b16 a[168:169], v13 offset:49152
    v_cvt_pk_bf16_f32 v238, v204, v205
    v_mfma_f32_16x16x32_bf16 v[192:195], a[228:231], v[148:151], v[192:195]
    s_waitcnt lgkmcnt(7)
    s_add_u32 s38, s47, 295296
    ds_read_b64_tr_b16 a[170:171], v13 offset:53248
    v_cvt_pk_bf16_f32 v239, v206, v207
    v_mfma_f32_16x16x32_bf16 v[192:195], a[232:235], v[152:155], v[192:195]
    s_waitcnt lgkmcnt(6)
    s_add_u32 s49, s45, 74368
    buffer_store_dwordx4 v[236:239], v56, s[28:31], s38 offen sc1
    v_mfma_f32_16x16x32_bf16 v[192:195], a[236:239], v[156:159], v[192:195]
    s_add_u32 m0, s42, 147456
    ds_read_b64_tr_b16 a[172:173], v13 offset:57344
    ds_read_b64_tr_b16 a[174:175], v13 offset:61440
    v_mfma_f32_16x16x32_bf16 v[196:199], a[208:211], v[160:163], 0
    buffer_load_dwordx4 v46, s[20:23], s49 offen lds
    v_mfma_f32_16x16x32_bf16 v[196:199], a[212:215], v[164:167], v[196:199]
    ds_read_b64_tr_b16 a[176:177], v17 offset:32768
    ds_read_b64_tr_b16 a[178:179], v17 offset:36864
    v_mfma_f32_16x16x32_bf16 v[196:199], a[216:219], v[168:171], v[196:199]
    buffer_load_dwordx4 v47, s[20:23], s49 offen offset:1024 lds
    v_mfma_f32_16x16x32_bf16 v[196:199], a[220:223], v[172:175], v[196:199]
    ds_read_b64_tr_b16 a[180:181], v17 offset:40960
    ds_read_b64_tr_b16 a[182:183], v17 offset:45056
    v_mfma_f32_16x16x32_bf16 v[196:199], a[224:227], v[176:179], v[196:199]
    ds_read_b64_tr_b16 a[184:185], v17 offset:49152
    v_cvt_pk_bf16_f32 v224, v192, v193
    v_mfma_f32_16x16x32_bf16 v[196:199], a[228:231], v[180:183], v[196:199]
    ds_read_b64_tr_b16 a[186:187], v17 offset:53248
    v_cvt_pk_bf16_f32 v225, v194, v195
    v_mfma_f32_16x16x32_bf16 v[196:199], a[232:235], v[184:187], v[196:199]
    ds_read_b64_tr_b16 a[188:189], v17 offset:57344
    v_mfma_f32_16x16x32_bf16 v[196:199], a[236:239], v[188:191], v[196:199]
    s_waitcnt lgkmcnt(13)
    ds_read_b64_tr_b16 a[190:191], v17 offset:61440
    v_mfma_f32_16x16x32_bf16 v[200:203], a[160:163], v[128:131], 0
    s_waitcnt lgkmcnt(12)
    buffer_load_dwordx4 v48, s[20:23], s49 offen offset:2048 lds
    v_mfma_f32_16x16x32_bf16 v[200:203], a[164:167], v[132:135], v[200:203]
    s_waitcnt lgkmcnt(10)
    ds_read_b64_tr_b16 a[208:209], v14 offset:32768
    ds_read_b64_tr_b16 a[210:211], v14 offset:36864
    v_mfma_f32_16x16x32_bf16 v[200:203], a[168:171], v[136:139], v[200:203]
    s_waitcnt lgkmcnt(10)
    buffer_load_dwordx4 v49, s[20:23], s49 offen offset:3072 lds
    v_mfma_f32_16x16x32_bf16 v[200:203], a[172:175], v[140:143], v[200:203]
    s_waitcnt lgkmcnt(8)
    ds_read_b64_tr_b16 a[212:213], v14 offset:40960
    ds_read_b64_tr_b16 a[214:215], v14 offset:45056
    v_mfma_f32_16x16x32_bf16 v[200:203], a[176:179], v[144:147], v[200:203]
    s_waitcnt lgkmcnt(8)
    ds_read_b64_tr_b16 a[216:217], v14 offset:49152
    v_cvt_pk_bf16_f32 v228, v196, v197
    v_mfma_f32_16x16x32_bf16 v[200:203], a[180:183], v[148:151], v[200:203]
    s_waitcnt lgkmcnt(7)
    ds_read_b64_tr_b16 a[218:219], v14 offset:53248
    v_cvt_pk_bf16_f32 v229, v198, v199
    v_mfma_f32_16x16x32_bf16 v[200:203], a[184:187], v[152:155], v[200:203]
    s_waitcnt lgkmcnt(6)
    ds_read_b64_tr_b16 a[220:221], v14 offset:57344
    v_mfma_f32_16x16x32_bf16 v[200:203], a[188:191], v[156:159], v[200:203]
    ds_read_b64_tr_b16 a[222:223], v14 offset:61440
    v_mfma_f32_16x16x32_bf16 v[204:207], a[160:163], v[160:163], 0
    ds_read_b64_tr_b16 a[224:225], v18 offset:32768
    v_mfma_f32_16x16x32_bf16 v[204:207], a[164:167], v[164:167], v[204:207]
    ds_read_b64_tr_b16 a[226:227], v18 offset:36864
    v_mfma_f32_16x16x32_bf16 v[204:207], a[168:171], v[168:171], v[204:207]
    ds_read_b64_tr_b16 a[228:229], v18 offset:40960
    v_mfma_f32_16x16x32_bf16 v[204:207], a[172:175], v[172:175], v[204:207]
    ds_read_b64_tr_b16 a[230:231], v18 offset:45056
    v_mfma_f32_16x16x32_bf16 v[204:207], a[176:179], v[176:179], v[204:207]
    ds_read_b64_tr_b16 a[232:233], v18 offset:49152
    v_cvt_pk_bf16_f32 v226, v200, v201
    v_mfma_f32_16x16x32_bf16 v[204:207], a[180:183], v[180:183], v[204:207]
    s_add_u32 s38, s47, 512
    ds_read_b64_tr_b16 a[234:235], v18 offset:53248
    v_cvt_pk_bf16_f32 v227, v202, v203
    v_mfma_f32_16x16x32_bf16 v[204:207], a[184:187], v[184:187], v[204:207]
    buffer_store_dwordx4 v[224:227], v56, s[28:31], s38 offen sc1
    v_mfma_f32_16x16x32_bf16 v[204:207], a[188:191], v[188:191], v[204:207]
    s_waitcnt lgkmcnt(12)
    ds_read_b64_tr_b16 a[236:237], v18 offset:57344
    ds_read_b64_tr_b16 a[238:239], v18 offset:61440
    v_mfma_f32_16x16x32_bf16 v[192:195], a[208:211], v[128:131], 0
    s_waitcnt lgkmcnt(12)
    ds_read_b64_tr_b16 a[160:161], v15 offset:32768
    v_mfma_f32_16x16x32_bf16 v[192:195], a[212:215], v[132:135], v[192:195]
    s_waitcnt lgkmcnt(11)
    ds_read_b64_tr_b16 a[162:163], v15 offset:36864
    v_mfma_f32_16x16x32_bf16 v[192:195], a[216:219], v[136:139], v[192:195]
    s_waitcnt lgkmcnt(10)
    ds_read_b64_tr_b16 a[164:165], v15 offset:40960
    v_mfma_f32_16x16x32_bf16 v[192:195], a[220:223], v[140:143], v[192:195]
    s_waitcnt lgkmcnt(9)
    ds_read_b64_tr_b16 a[166:167], v15 offset:45056
    v_mfma_f32_16x16x32_bf16 v[192:195], a[224:227], v[144:147], v[192:195]
    s_waitcnt lgkmcnt(8)
    ds_read_b64_tr_b16 a[168:169], v15 offset:49152
    v_cvt_pk_bf16_f32 v230, v204, v205
    v_mfma_f32_16x16x32_bf16 v[192:195], a[228:231], v[148:151], v[192:195]
    s_waitcnt lgkmcnt(7)
    s_add_u32 s38, s47, 295424
    ds_read_b64_tr_b16 a[170:171], v15 offset:53248
    v_cvt_pk_bf16_f32 v231, v206, v207
    v_mfma_f32_16x16x32_bf16 v[192:195], a[232:235], v[152:155], v[192:195]
    s_waitcnt lgkmcnt(6)
    buffer_store_dwordx4 v[228:231], v56, s[28:31], s38 offen sc1
    v_mfma_f32_16x16x32_bf16 v[192:195], a[236:239], v[156:159], v[192:195]
    ds_read_b64_tr_b16 a[172:173], v15 offset:57344
    ds_read_b64_tr_b16 a[174:175], v15 offset:61440
    v_mfma_f32_16x16x32_bf16 v[196:199], a[208:211], v[160:163], 0
    ds_read_b64_tr_b16 a[176:177], v19 offset:32768
    v_mfma_f32_16x16x32_bf16 v[196:199], a[212:215], v[164:167], v[196:199]
    ds_read_b64_tr_b16 a[178:179], v19 offset:36864
    v_mfma_f32_16x16x32_bf16 v[196:199], a[216:219], v[168:171], v[196:199]
    ds_read_b64_tr_b16 a[180:181], v19 offset:40960
    v_mfma_f32_16x16x32_bf16 v[196:199], a[220:223], v[172:175], v[196:199]
    ds_read_b64_tr_b16 a[182:183], v19 offset:45056
    v_mfma_f32_16x16x32_bf16 v[196:199], a[224:227], v[176:179], v[196:199]
    ds_read_b64_tr_b16 a[184:185], v19 offset:49152
    v_cvt_pk_bf16_f32 v232, v192, v193
    v_mfma_f32_16x16x32_bf16 v[196:199], a[228:231], v[180:183], v[196:199]
    ds_read_b64_tr_b16 a[186:187], v19 offset:53248
    v_cvt_pk_bf16_f32 v233, v194, v195
    v_mfma_f32_16x16x32_bf16 v[196:199], a[232:235], v[184:187], v[196:199]
    ds_read_b64_tr_b16 a[188:189], v19 offset:57344
    v_mfma_f32_16x16x32_bf16 v[196:199], a[236:239], v[188:191], v[196:199]
    s_waitcnt lgkmcnt(13)
    ds_read_b64_tr_b16 a[190:191], v19 offset:61440
    s_waitcnt vmcnt(23)
    s_barrier
    v_mfma_f32_16x16x32_bf16 v[200:203], a[160:163], v[128:131], 0
    s_waitcnt lgkmcnt(12)
    ds_read_b64_tr_b16 a[208:209], v20 offset:0
    v_mfma_f32_16x16x32_bf16 v[200:203], a[164:167], v[132:135], v[200:203]
    s_waitcnt lgkmcnt(11)
    ds_read_b64_tr_b16 a[210:211], v20 offset:4096
    v_mfma_f32_16x16x32_bf16 v[200:203], a[168:171], v[136:139], v[200:203]
    s_waitcnt lgkmcnt(10)
    ds_read_b64_tr_b16 a[212:213], v20 offset:8192
    v_mfma_f32_16x16x32_bf16 v[200:203], a[172:175], v[140:143], v[200:203]
    s_waitcnt lgkmcnt(9)
    ds_read_b64_tr_b16 a[214:215], v20 offset:12288
    v_mfma_f32_16x16x32_bf16 v[200:203], a[176:179], v[144:147], v[200:203]
    s_waitcnt lgkmcnt(8)
    ds_read_b64_tr_b16 a[216:217], v20 offset:16384
    v_cvt_pk_bf16_f32 v236, v196, v197
    v_mfma_f32_16x16x32_bf16 v[200:203], a[180:183], v[148:151], v[200:203]
    s_waitcnt lgkmcnt(7)
    ds_read_b64_tr_b16 a[218:219], v20 offset:20480
    v_cvt_pk_bf16_f32 v237, v198, v199
    v_mfma_f32_16x16x32_bf16 v[200:203], a[184:187], v[152:155], v[200:203]
    s_waitcnt lgkmcnt(6)
    s_add_u32 s49, s45, 768
    ds_read_b64_tr_b16 a[220:221], v20 offset:24576
    v_mfma_f32_16x16x32_bf16 v[200:203], a[188:191], v[156:159], v[200:203]
    s_add_u32 m0, s42, 0
    ds_read_b64_tr_b16 a[222:223], v20 offset:28672
    v_mfma_f32_16x16x32_bf16 v[204:207], a[160:163], v[160:163], 0
    buffer_load_dwordx4 v46, s[20:23], s49 offen lds
    v_mfma_f32_16x16x32_bf16 v[204:207], a[164:167], v[164:167], v[204:207]
    ds_read_b64_tr_b16 a[224:225], v24 offset:0
    ds_read_b64_tr_b16 a[226:227], v24 offset:4096
    v_mfma_f32_16x16x32_bf16 v[204:207], a[168:171], v[168:171], v[204:207]
    buffer_load_dwordx4 v47, s[20:23], s49 offen offset:1024 lds
    v_mfma_f32_16x16x32_bf16 v[204:207], a[172:175], v[172:175], v[204:207]
    ds_read_b64_tr_b16 a[228:229], v24 offset:8192
    ds_read_b64_tr_b16 a[230:231], v24 offset:12288
    v_mfma_f32_16x16x32_bf16 v[204:207], a[176:179], v[176:179], v[204:207]
    ds_read_b64_tr_b16 a[232:233], v24 offset:16384
    v_cvt_pk_bf16_f32 v234, v200, v201
    v_mfma_f32_16x16x32_bf16 v[204:207], a[180:183], v[180:183], v[204:207]
    s_add_u32 s38, s47, 640
    ds_read_b64_tr_b16 a[234:235], v24 offset:20480
    v_cvt_pk_bf16_f32 v235, v202, v203
    v_mfma_f32_16x16x32_bf16 v[204:207], a[184:187], v[184:187], v[204:207]
    buffer_store_dwordx4 v[232:235], v56, s[28:31], s38 offen sc1
    v_mfma_f32_16x16x32_bf16 v[204:207], a[188:191], v[188:191], v[204:207]
    s_waitcnt lgkmcnt(12)
    ds_read_b64_tr_b16 a[236:237], v24 offset:24576
    ds_read_b64_tr_b16 a[238:239], v24 offset:28672
    v_mfma_f32_16x16x32_bf16 v[192:195], a[208:211], v[128:131], 0
    s_waitcnt lgkmcnt(12)
    buffer_load_dwordx4 v48, s[20:23], s49 offen offset:2048 lds
    v_mfma_f32_16x16x32_bf16 v[192:195], a[212:215], v[132:135], v[192:195]
    s_waitcnt lgkmcnt(10)
    ds_read_b64_tr_b16 a[160:161], v21 offset:0
    ds_read_b64_tr_b16 a[162:163], v21 offset:4096
    v_mfma_f32_16x16x32_bf16 v[192:195], a[216:219], v[136:139], v[192:195]
    s_waitcnt lgkmcnt(10)
    buffer_load_dwordx4 v49, s[20:23], s49 offen offset:3072 lds
    v_mfma_f32_16x16x32_bf16 v[192:195], a[220:223], v[140:143], v[192:195]
    s_waitcnt lgkmcnt(8)
    ds_read_b64_tr_b16 a[164:165], v21 offset:8192
    ds_read_b64_tr_b16 a[166:167], v21 offset:12288
    v_mfma_f32_16x16x32_bf16 v[192:195], a[224:227], v[144:147], v[192:195]
    s_waitcnt lgkmcnt(8)
    ds_read_b64_tr_b16 a[168:169], v21 offset:16384
    v_cvt_pk_bf16_f32 v238, v204, v205
    v_mfma_f32_16x16x32_bf16 v[192:195], a[228:231], v[148:151], v[192:195]
    s_waitcnt lgkmcnt(7)
    s_add_u32 s38, s47, 295552
    ds_read_b64_tr_b16 a[170:171], v21 offset:20480
    v_cvt_pk_bf16_f32 v239, v206, v207
    v_mfma_f32_16x16x32_bf16 v[192:195], a[232:235], v[152:155], v[192:195]
    s_waitcnt lgkmcnt(6)
    s_add_u32 s49, s45, 74496
    buffer_store_dwordx4 v[236:239], v56, s[28:31], s38 offen sc1
    v_mfma_f32_16x16x32_bf16 v[192:195], a[236:239], v[156:159], v[192:195]
    s_add_u32 m0, s42, 16384
    ds_read_b64_tr_b16 a[172:173], v21 offset:24576
    ds_read_b64_tr_b16 a[174:175], v21 offset:28672
    v_mfma_f32_16x16x32_bf16 v[196:199], a[208:211], v[160:163], 0
    buffer_load_dwordx4 v46, s[20:23], s49 offen lds
    v_mfma_f32_16x16x32_bf16 v[196:199], a[212:215], v[164:167], v[196:199]
    ds_read_b64_tr_b16 a[176:177], v25 offset:0
    ds_read_b64_tr_b16 a[178:179], v25 offset:4096
    v_mfma_f32_16x16x32_bf16 v[196:199], a[216:219], v[168:171], v[196:199]
    buffer_load_dwordx4 v47, s[20:23], s49 offen offset:1024 lds
    v_mfma_f32_16x16x32_bf16 v[196:199], a[220:223], v[172:175], v[196:199]
    ds_read_b64_tr_b16 a[180:181], v25 offset:8192
    ds_read_b64_tr_b16 a[182:183], v25 offset:12288
    v_mfma_f32_16x16x32_bf16 v[196:199], a[224:227], v[176:179], v[196:199]
    ds_read_b64_tr_b16 a[184:185], v25 offset:16384
    v_cvt_pk_bf16_f32 v224, v192, v193
    v_mfma_f32_16x16x32_bf16 v[196:199], a[228:231], v[180:183], v[196:199]
    ds_read_b64_tr_b16 a[186:187], v25 offset:20480
    v_cvt_pk_bf16_f32 v225, v194, v195
    v_mfma_f32_16x16x32_bf16 v[196:199], a[232:235], v[184:187], v[196:199]
    ds_read_b64_tr_b16 a[188:189], v25 offset:24576
    v_mfma_f32_16x16x32_bf16 v[196:199], a[236:239], v[188:191], v[196:199]
    s_waitcnt lgkmcnt(13)
    ds_read_b64_tr_b16 a[190:191], v25 offset:28672
    v_mfma_f32_16x16x32_bf16 v[200:203], a[160:163], v[128:131], 0
    s_waitcnt lgkmcnt(12)
    buffer_load_dwordx4 v48, s[20:23], s49 offen offset:2048 lds
    v_mfma_f32_16x16x32_bf16 v[200:203], a[164:167], v[132:135], v[200:203]
    s_waitcnt lgkmcnt(10)
    ds_read_b64_tr_b16 a[208:209], v22 offset:0
    ds_read_b64_tr_b16 a[210:211], v22 offset:4096
    v_mfma_f32_16x16x32_bf16 v[200:203], a[168:171], v[136:139], v[200:203]
    s_waitcnt lgkmcnt(10)
    buffer_load_dwordx4 v49, s[20:23], s49 offen offset:3072 lds
    v_mfma_f32_16x16x32_bf16 v[200:203], a[172:175], v[140:143], v[200:203]
    s_waitcnt lgkmcnt(8)
    ds_read_b64_tr_b16 a[212:213], v22 offset:8192
    ds_read_b64_tr_b16 a[214:215], v22 offset:12288
    v_mfma_f32_16x16x32_bf16 v[200:203], a[176:179], v[144:147], v[200:203]
    s_waitcnt lgkmcnt(8)
    ds_read_b64_tr_b16 a[216:217], v22 offset:16384
    v_cvt_pk_bf16_f32 v228, v196, v197
    v_mfma_f32_16x16x32_bf16 v[200:203], a[180:183], v[148:151], v[200:203]
    s_waitcnt lgkmcnt(7)
    ds_read_b64_tr_b16 a[218:219], v22 offset:20480
    v_cvt_pk_bf16_f32 v229, v198, v199
    v_mfma_f32_16x16x32_bf16 v[200:203], a[184:187], v[152:155], v[200:203]
    s_waitcnt lgkmcnt(6)
    ds_read_b64_tr_b16 a[220:221], v22 offset:24576
    v_mfma_f32_16x16x32_bf16 v[200:203], a[188:191], v[156:159], v[200:203]
    ds_read_b64_tr_b16 a[222:223], v22 offset:28672
    v_mfma_f32_16x16x32_bf16 v[204:207], a[160:163], v[160:163], 0
    ds_read_b64_tr_b16 a[224:225], v26 offset:0
    v_mfma_f32_16x16x32_bf16 v[204:207], a[164:167], v[164:167], v[204:207]
    ds_read_b64_tr_b16 a[226:227], v26 offset:4096
    v_mfma_f32_16x16x32_bf16 v[204:207], a[168:171], v[168:171], v[204:207]
    ds_read_b64_tr_b16 a[228:229], v26 offset:8192
    v_mfma_f32_16x16x32_bf16 v[204:207], a[172:175], v[172:175], v[204:207]
    ds_read_b64_tr_b16 a[230:231], v26 offset:12288
    v_mfma_f32_16x16x32_bf16 v[204:207], a[176:179], v[176:179], v[204:207]
    ds_read_b64_tr_b16 a[232:233], v26 offset:16384
    v_cvt_pk_bf16_f32 v226, v200, v201
    v_mfma_f32_16x16x32_bf16 v[204:207], a[180:183], v[180:183], v[204:207]
    s_add_u32 s38, s47, 768
    ds_read_b64_tr_b16 a[234:235], v26 offset:20480
    v_cvt_pk_bf16_f32 v227, v202, v203
    v_mfma_f32_16x16x32_bf16 v[204:207], a[184:187], v[184:187], v[204:207]
    buffer_store_dwordx4 v[224:227], v56, s[28:31], s38 offen sc1
    v_mfma_f32_16x16x32_bf16 v[204:207], a[188:191], v[188:191], v[204:207]
    s_waitcnt lgkmcnt(12)
    ds_read_b64_tr_b16 a[236:237], v26 offset:24576
    ds_read_b64_tr_b16 a[238:239], v26 offset:28672
    v_mfma_f32_16x16x32_bf16 v[192:195], a[208:211], v[128:131], 0
    s_waitcnt lgkmcnt(12)
    ds_read_b64_tr_b16 a[160:161], v23 offset:0
    v_mfma_f32_16x16x32_bf16 v[192:195], a[212:215], v[132:135], v[192:195]
    s_waitcnt lgkmcnt(11)
    ds_read_b64_tr_b16 a[162:163], v23 offset:4096
    v_mfma_f32_16x16x32_bf16 v[192:195], a[216:219], v[136:139], v[192:195]
    s_waitcnt lgkmcnt(10)
    ds_read_b64_tr_b16 a[164:165], v23 offset:8192
    v_mfma_f32_16x16x32_bf16 v[192:195], a[220:223], v[140:143], v[192:195]
    s_waitcnt lgkmcnt(9)
    ds_read_b64_tr_b16 a[166:167], v23 offset:12288
    v_mfma_f32_16x16x32_bf16 v[192:195], a[224:227], v[144:147], v[192:195]
    s_waitcnt lgkmcnt(8)
    ds_read_b64_tr_b16 a[168:169], v23 offset:16384
    v_cvt_pk_bf16_f32 v230, v204, v205
    v_mfma_f32_16x16x32_bf16 v[192:195], a[228:231], v[148:151], v[192:195]
    s_waitcnt lgkmcnt(7)
    s_add_u32 s38, s47, 295680
    ds_read_b64_tr_b16 a[170:171], v23 offset:20480
    v_cvt_pk_bf16_f32 v231, v206, v207
    v_mfma_f32_16x16x32_bf16 v[192:195], a[232:235], v[152:155], v[192:195]
    s_waitcnt lgkmcnt(6)
    buffer_store_dwordx4 v[228:231], v56, s[28:31], s38 offen sc1
    v_mfma_f32_16x16x32_bf16 v[192:195], a[236:239], v[156:159], v[192:195]
    ds_read_b64_tr_b16 a[172:173], v23 offset:24576
    ds_read_b64_tr_b16 a[174:175], v23 offset:28672
    v_mfma_f32_16x16x32_bf16 v[196:199], a[208:211], v[160:163], 0
    ds_read_b64_tr_b16 a[176:177], v27 offset:0
    v_mfma_f32_16x16x32_bf16 v[196:199], a[212:215], v[164:167], v[196:199]
    ds_read_b64_tr_b16 a[178:179], v27 offset:4096
    v_mfma_f32_16x16x32_bf16 v[196:199], a[216:219], v[168:171], v[196:199]
    ds_read_b64_tr_b16 a[180:181], v27 offset:8192
    v_mfma_f32_16x16x32_bf16 v[196:199], a[220:223], v[172:175], v[196:199]
    ds_read_b64_tr_b16 a[182:183], v27 offset:12288
    v_mfma_f32_16x16x32_bf16 v[196:199], a[224:227], v[176:179], v[196:199]
    ds_read_b64_tr_b16 a[184:185], v27 offset:16384
    v_cvt_pk_bf16_f32 v232, v192, v193
    v_mfma_f32_16x16x32_bf16 v[196:199], a[228:231], v[180:183], v[196:199]
    ds_read_b64_tr_b16 a[186:187], v27 offset:20480
    v_cvt_pk_bf16_f32 v233, v194, v195
    v_mfma_f32_16x16x32_bf16 v[196:199], a[232:235], v[184:187], v[196:199]
    ds_read_b64_tr_b16 a[188:189], v27 offset:24576
    v_mfma_f32_16x16x32_bf16 v[196:199], a[236:239], v[188:191], v[196:199]
    s_waitcnt lgkmcnt(13)
    ds_read_b64_tr_b16 a[190:191], v27 offset:28672
    s_waitcnt vmcnt(25)
    s_barrier
    v_mfma_f32_16x16x32_bf16 v[200:203], a[160:163], v[128:131], 0
    s_waitcnt lgkmcnt(12)
    ds_read_b64_tr_b16 a[208:209], v20 offset:32768
    v_mfma_f32_16x16x32_bf16 v[200:203], a[164:167], v[132:135], v[200:203]
    s_waitcnt lgkmcnt(11)
    ds_read_b64_tr_b16 a[210:211], v20 offset:36864
    v_mfma_f32_16x16x32_bf16 v[200:203], a[168:171], v[136:139], v[200:203]
    s_waitcnt lgkmcnt(10)
    ds_read_b64_tr_b16 a[212:213], v20 offset:40960
    v_mfma_f32_16x16x32_bf16 v[200:203], a[172:175], v[140:143], v[200:203]
    s_waitcnt lgkmcnt(9)
    ds_read_b64_tr_b16 a[214:215], v20 offset:45056
    v_mfma_f32_16x16x32_bf16 v[200:203], a[176:179], v[144:147], v[200:203]
    s_waitcnt lgkmcnt(8)
    ds_read_b64_tr_b16 a[216:217], v20 offset:49152
    v_cvt_pk_bf16_f32 v236, v196, v197
    v_mfma_f32_16x16x32_bf16 v[200:203], a[180:183], v[148:151], v[200:203]
    s_waitcnt lgkmcnt(7)
    ds_read_b64_tr_b16 a[218:219], v20 offset:53248
    v_cvt_pk_bf16_f32 v237, v198, v199
    v_mfma_f32_16x16x32_bf16 v[200:203], a[184:187], v[152:155], v[200:203]
    s_waitcnt lgkmcnt(6)
    s_add_u32 s49, s45, 896
    ds_read_b64_tr_b16 a[220:221], v20 offset:57344
    v_mfma_f32_16x16x32_bf16 v[200:203], a[188:191], v[156:159], v[200:203]
    s_add_u32 m0, s42, 32768
    ds_read_b64_tr_b16 a[222:223], v20 offset:61440
    v_mfma_f32_16x16x32_bf16 v[204:207], a[160:163], v[160:163], 0
    buffer_load_dwordx4 v46, s[20:23], s49 offen lds
    v_mfma_f32_16x16x32_bf16 v[204:207], a[164:167], v[164:167], v[204:207]
    ds_read_b64_tr_b16 a[224:225], v24 offset:32768
    ds_read_b64_tr_b16 a[226:227], v24 offset:36864
    v_mfma_f32_16x16x32_bf16 v[204:207], a[168:171], v[168:171], v[204:207]
    buffer_load_dwordx4 v47, s[20:23], s49 offen offset:1024 lds
    v_mfma_f32_16x16x32_bf16 v[204:207], a[172:175], v[172:175], v[204:207]
    ds_read_b64_tr_b16 a[228:229], v24 offset:40960
    ds_read_b64_tr_b16 a[230:231], v24 offset:45056
    v_mfma_f32_16x16x32_bf16 v[204:207], a[176:179], v[176:179], v[204:207]
    ds_read_b64_tr_b16 a[232:233], v24 offset:49152
    v_cvt_pk_bf16_f32 v234, v200, v201
    v_mfma_f32_16x16x32_bf16 v[204:207], a[180:183], v[180:183], v[204:207]
    s_add_u32 s38, s47, 896
    ds_read_b64_tr_b16 a[234:235], v24 offset:53248
    v_cvt_pk_bf16_f32 v235, v202, v203
    v_mfma_f32_16x16x32_bf16 v[204:207], a[184:187], v[184:187], v[204:207]
    buffer_store_dwordx4 v[232:235], v56, s[28:31], s38 offen sc1
    v_mfma_f32_16x16x32_bf16 v[204:207], a[188:191], v[188:191], v[204:207]
    s_waitcnt lgkmcnt(12)
    ds_read_b64_tr_b16 a[236:237], v24 offset:57344
    ds_read_b64_tr_b16 a[238:239], v24 offset:61440
    v_mfma_f32_16x16x32_bf16 v[192:195], a[208:211], v[128:131], 0
    s_waitcnt lgkmcnt(12)
    buffer_load_dwordx4 v48, s[20:23], s49 offen offset:2048 lds
    v_mfma_f32_16x16x32_bf16 v[192:195], a[212:215], v[132:135], v[192:195]
    s_waitcnt lgkmcnt(10)
    ds_read_b64_tr_b16 a[160:161], v21 offset:32768
    ds_read_b64_tr_b16 a[162:163], v21 offset:36864
    v_mfma_f32_16x16x32_bf16 v[192:195], a[216:219], v[136:139], v[192:195]
    s_waitcnt lgkmcnt(10)
    buffer_load_dwordx4 v49, s[20:23], s49 offen offset:3072 lds
    v_mfma_f32_16x16x32_bf16 v[192:195], a[220:223], v[140:143], v[192:195]
    s_waitcnt lgkmcnt(8)
    ds_read_b64_tr_b16 a[164:165], v21 offset:40960
    ds_read_b64_tr_b16 a[166:167], v21 offset:45056
    v_mfma_f32_16x16x32_bf16 v[192:195], a[224:227], v[144:147], v[192:195]
    s_waitcnt lgkmcnt(8)
    ds_read_b64_tr_b16 a[168:169], v21 offset:49152
    v_cvt_pk_bf16_f32 v238, v204, v205
    v_mfma_f32_16x16x32_bf16 v[192:195], a[228:231], v[148:151], v[192:195]
    s_waitcnt lgkmcnt(7)
    s_add_u32 s38, s47, 295808
    ds_read_b64_tr_b16 a[170:171], v21 offset:53248
    v_cvt_pk_bf16_f32 v239, v206, v207
    v_mfma_f32_16x16x32_bf16 v[192:195], a[232:235], v[152:155], v[192:195]
    s_waitcnt lgkmcnt(6)
    s_add_u32 s49, s45, 74624
    buffer_store_dwordx4 v[236:239], v56, s[28:31], s38 offen sc1
    v_mfma_f32_16x16x32_bf16 v[192:195], a[236:239], v[156:159], v[192:195]
    s_add_u32 m0, s42, 49152
    ds_read_b64_tr_b16 a[172:173], v21 offset:57344
    ds_read_b64_tr_b16 a[174:175], v21 offset:61440
    v_mfma_f32_16x16x32_bf16 v[196:199], a[208:211], v[160:163], 0
    buffer_load_dwordx4 v46, s[20:23], s49 offen lds
    v_mfma_f32_16x16x32_bf16 v[196:199], a[212:215], v[164:167], v[196:199]
    ds_read_b64_tr_b16 a[176:177], v25 offset:32768
    ds_read_b64_tr_b16 a[178:179], v25 offset:36864
    v_mfma_f32_16x16x32_bf16 v[196:199], a[216:219], v[168:171], v[196:199]
    buffer_load_dwordx4 v47, s[20:23], s49 offen offset:1024 lds
    v_mfma_f32_16x16x32_bf16 v[196:199], a[220:223], v[172:175], v[196:199]
    ds_read_b64_tr_b16 a[180:181], v25 offset:40960
    ds_read_b64_tr_b16 a[182:183], v25 offset:45056
    v_mfma_f32_16x16x32_bf16 v[196:199], a[224:227], v[176:179], v[196:199]
    ds_read_b64_tr_b16 a[184:185], v25 offset:49152
    v_cvt_pk_bf16_f32 v224, v192, v193
    v_mfma_f32_16x16x32_bf16 v[196:199], a[228:231], v[180:183], v[196:199]
    ds_read_b64_tr_b16 a[186:187], v25 offset:53248
    v_cvt_pk_bf16_f32 v225, v194, v195
    v_mfma_f32_16x16x32_bf16 v[196:199], a[232:235], v[184:187], v[196:199]
    ds_read_b64_tr_b16 a[188:189], v25 offset:57344
    v_mfma_f32_16x16x32_bf16 v[196:199], a[236:239], v[188:191], v[196:199]
    s_waitcnt lgkmcnt(13)
    ds_read_b64_tr_b16 a[190:191], v25 offset:61440
    v_mfma_f32_16x16x32_bf16 v[200:203], a[160:163], v[128:131], 0
    s_waitcnt lgkmcnt(12)
    buffer_load_dwordx4 v48, s[20:23], s49 offen offset:2048 lds
    v_mfma_f32_16x16x32_bf16 v[200:203], a[164:167], v[132:135], v[200:203]
    s_waitcnt lgkmcnt(10)
    ds_read_b64_tr_b16 a[208:209], v22 offset:32768
    ds_read_b64_tr_b16 a[210:211], v22 offset:36864
    v_mfma_f32_16x16x32_bf16 v[200:203], a[168:171], v[136:139], v[200:203]
    s_waitcnt lgkmcnt(10)
    buffer_load_dwordx4 v49, s[20:23], s49 offen offset:3072 lds
    v_mfma_f32_16x16x32_bf16 v[200:203], a[172:175], v[140:143], v[200:203]
    s_waitcnt lgkmcnt(8)
    ds_read_b64_tr_b16 a[212:213], v22 offset:40960
    ds_read_b64_tr_b16 a[214:215], v22 offset:45056
    v_mfma_f32_16x16x32_bf16 v[200:203], a[176:179], v[144:147], v[200:203]
    s_waitcnt lgkmcnt(8)
    ds_read_b64_tr_b16 a[216:217], v22 offset:49152
    v_cvt_pk_bf16_f32 v228, v196, v197
    v_mfma_f32_16x16x32_bf16 v[200:203], a[180:183], v[148:151], v[200:203]
    s_waitcnt lgkmcnt(7)
    ds_read_b64_tr_b16 a[218:219], v22 offset:53248
    v_cvt_pk_bf16_f32 v229, v198, v199
    v_mfma_f32_16x16x32_bf16 v[200:203], a[184:187], v[152:155], v[200:203]
    s_waitcnt lgkmcnt(6)
    ds_read_b64_tr_b16 a[220:221], v22 offset:57344
    v_mfma_f32_16x16x32_bf16 v[200:203], a[188:191], v[156:159], v[200:203]
    ds_read_b64_tr_b16 a[222:223], v22 offset:61440
    v_mfma_f32_16x16x32_bf16 v[204:207], a[160:163], v[160:163], 0
    ds_read_b64_tr_b16 a[224:225], v26 offset:32768
    v_mfma_f32_16x16x32_bf16 v[204:207], a[164:167], v[164:167], v[204:207]
    ds_read_b64_tr_b16 a[226:227], v26 offset:36864
    v_mfma_f32_16x16x32_bf16 v[204:207], a[168:171], v[168:171], v[204:207]
    ds_read_b64_tr_b16 a[228:229], v26 offset:40960
    v_mfma_f32_16x16x32_bf16 v[204:207], a[172:175], v[172:175], v[204:207]
    ds_read_b64_tr_b16 a[230:231], v26 offset:45056
    v_mfma_f32_16x16x32_bf16 v[204:207], a[176:179], v[176:179], v[204:207]
    ds_read_b64_tr_b16 a[232:233], v26 offset:49152
    v_cvt_pk_bf16_f32 v226, v200, v201
    v_mfma_f32_16x16x32_bf16 v[204:207], a[180:183], v[180:183], v[204:207]
    s_add_u32 s38, s47, 1024
    ds_read_b64_tr_b16 a[234:235], v26 offset:53248
    v_cvt_pk_bf16_f32 v227, v202, v203
    v_mfma_f32_16x16x32_bf16 v[204:207], a[184:187], v[184:187], v[204:207]
    buffer_store_dwordx4 v[224:227], v56, s[28:31], s38 offen sc1
    v_mfma_f32_16x16x32_bf16 v[204:207], a[188:191], v[188:191], v[204:207]
    s_waitcnt lgkmcnt(12)
    ds_read_b64_tr_b16 a[236:237], v26 offset:57344
    ds_read_b64_tr_b16 a[238:239], v26 offset:61440
    v_mfma_f32_16x16x32_bf16 v[192:195], a[208:211], v[128:131], 0
    s_waitcnt lgkmcnt(12)
    ds_read_b64_tr_b16 a[160:161], v23 offset:32768
    v_mfma_f32_16x16x32_bf16 v[192:195], a[212:215], v[132:135], v[192:195]
    s_waitcnt lgkmcnt(11)
    ds_read_b64_tr_b16 a[162:163], v23 offset:36864
    v_mfma_f32_16x16x32_bf16 v[192:195], a[216:219], v[136:139], v[192:195]
    s_waitcnt lgkmcnt(10)
    ds_read_b64_tr_b16 a[164:165], v23 offset:40960
    v_mfma_f32_16x16x32_bf16 v[192:195], a[220:223], v[140:143], v[192:195]
    s_waitcnt lgkmcnt(9)
    ds_read_b64_tr_b16 a[166:167], v23 offset:45056
    v_mfma_f32_16x16x32_bf16 v[192:195], a[224:227], v[144:147], v[192:195]
    s_waitcnt lgkmcnt(8)
    ds_read_b64_tr_b16 a[168:169], v23 offset:49152
    v_cvt_pk_bf16_f32 v230, v204, v205
    v_mfma_f32_16x16x32_bf16 v[192:195], a[228:231], v[148:151], v[192:195]
    s_waitcnt lgkmcnt(7)
    s_add_u32 s38, s47, 295936
    ds_read_b64_tr_b16 a[170:171], v23 offset:53248
    v_cvt_pk_bf16_f32 v231, v206, v207
    v_mfma_f32_16x16x32_bf16 v[192:195], a[232:235], v[152:155], v[192:195]
    s_waitcnt lgkmcnt(6)
    buffer_store_dwordx4 v[228:231], v56, s[28:31], s38 offen sc1
    v_mfma_f32_16x16x32_bf16 v[192:195], a[236:239], v[156:159], v[192:195]
    ds_read_b64_tr_b16 a[172:173], v23 offset:57344
    ds_read_b64_tr_b16 a[174:175], v23 offset:61440
    v_mfma_f32_16x16x32_bf16 v[196:199], a[208:211], v[160:163], 0
    ds_read_b64_tr_b16 a[176:177], v27 offset:32768
    v_mfma_f32_16x16x32_bf16 v[196:199], a[212:215], v[164:167], v[196:199]
    ds_read_b64_tr_b16 a[178:179], v27 offset:36864
    v_mfma_f32_16x16x32_bf16 v[196:199], a[216:219], v[168:171], v[196:199]
    ds_read_b64_tr_b16 a[180:181], v27 offset:40960
    v_mfma_f32_16x16x32_bf16 v[196:199], a[220:223], v[172:175], v[196:199]
    ds_read_b64_tr_b16 a[182:183], v27 offset:45056
    v_mfma_f32_16x16x32_bf16 v[196:199], a[224:227], v[176:179], v[196:199]
    ds_read_b64_tr_b16 a[184:185], v27 offset:49152
    v_cvt_pk_bf16_f32 v232, v192, v193
    v_mfma_f32_16x16x32_bf16 v[196:199], a[228:231], v[180:183], v[196:199]
    ds_read_b64_tr_b16 a[186:187], v27 offset:53248
    v_cvt_pk_bf16_f32 v233, v194, v195
    v_mfma_f32_16x16x32_bf16 v[196:199], a[232:235], v[184:187], v[196:199]
    ds_read_b64_tr_b16 a[188:189], v27 offset:57344
    v_mfma_f32_16x16x32_bf16 v[196:199], a[236:239], v[188:191], v[196:199]
    ds_read_b64_tr_b16 a[190:191], v27 offset:61440
    s_waitcnt vmcnt(26)
    s_waitcnt lgkmcnt(0)
    s_barrier
    v_mfma_f32_16x16x32_bf16 v[200:203], a[160:163], v[128:131], 0
    ds_read_b64_tr_b16 a[208:209], v28 offset:0
    v_mfma_f32_16x16x32_bf16 v[200:203], a[164:167], v[132:135], v[200:203]
    ds_read_b64_tr_b16 a[210:211], v28 offset:4096
    v_mfma_f32_16x16x32_bf16 v[200:203], a[168:171], v[136:139], v[200:203]
    ds_read_b64_tr_b16 a[212:213], v28 offset:8192
    v_mfma_f32_16x16x32_bf16 v[200:203], a[172:175], v[140:143], v[200:203]
    ds_read_b64_tr_b16 a[214:215], v28 offset:12288
    v_mfma_f32_16x16x32_bf16 v[200:203], a[176:179], v[144:147], v[200:203]
    ds_read_b64_tr_b16 a[216:217], v28 offset:16384
    v_cvt_pk_bf16_f32 v236, v196, v197
    v_mfma_f32_16x16x32_bf16 v[200:203], a[180:183], v[148:151], v[200:203]
    ds_read_b64_tr_b16 a[218:219], v28 offset:20480
    v_cvt_pk_bf16_f32 v237, v198, v199
    v_mfma_f32_16x16x32_bf16 v[200:203], a[184:187], v[152:155], v[200:203]
    s_add_u32 s49, s45, 1024
    ds_read_b64_tr_b16 a[220:221], v28 offset:24576
    v_mfma_f32_16x16x32_bf16 v[200:203], a[188:191], v[156:159], v[200:203]
    s_add_u32 m0, s42, 65536
    ds_read_b64_tr_b16 a[222:223], v28 offset:28672
    v_mfma_f32_16x16x32_bf16 v[204:207], a[160:163], v[160:163], 0
    buffer_load_dwordx4 v46, s[20:23], s49 offen lds
    v_mfma_f32_16x16x32_bf16 v[204:207], a[164:167], v[164:167], v[204:207]
    ds_read_b64_tr_b16 a[224:225], v32 offset:0
    ds_read_b64_tr_b16 a[226:227], v32 offset:4096
    v_mfma_f32_16x16x32_bf16 v[204:207], a[168:171], v[168:171], v[204:207]
    buffer_load_dwordx4 v47, s[20:23], s49 offen offset:1024 lds
    v_mfma_f32_16x16x32_bf16 v[204:207], a[172:175], v[172:175], v[204:207]
    ds_read_b64_tr_b16 a[228:229], v32 offset:8192
    ds_read_b64_tr_b16 a[230:231], v32 offset:12288
    v_mfma_f32_16x16x32_bf16 v[204:207], a[176:179], v[176:179], v[204:207]
    ds_read_b64_tr_b16 a[232:233], v32 offset:16384
    v_cvt_pk_bf16_f32 v234, v200, v201
    v_mfma_f32_16x16x32_bf16 v[204:207], a[180:183], v[180:183], v[204:207]
    s_add_u32 s38, s47, 1152
    ds_read_b64_tr_b16 a[234:235], v32 offset:20480
    v_cvt_pk_bf16_f32 v235, v202, v203
    v_mfma_f32_16x16x32_bf16 v[204:207], a[184:187], v[184:187], v[204:207]
    buffer_store_dwordx4 v[232:235], v56, s[28:31], s38 offen sc1
    v_mfma_f32_16x16x32_bf16 v[204:207], a[188:191], v[188:191], v[204:207]
    s_waitcnt lgkmcnt(12)
    ds_read_b64_tr_b16 a[236:237], v32 offset:24576
    ds_read_b64_tr_b16 a[238:239], v32 offset:28672
    v_mfma_f32_16x16x32_bf16 v[192:195], a[208:211], v[128:131], 0
    s_waitcnt lgkmcnt(12)
    buffer_load_dwordx4 v48, s[20:23], s49 offen offset:2048 lds
    v_mfma_f32_16x16x32_bf16 v[192:195], a[212:215], v[132:135], v[192:195]
    s_waitcnt lgkmcnt(10)
    ds_read_b64_tr_b16 a[160:161], v29 offset:0
    ds_read_b64_tr_b16 a[162:163], v29 offset:4096
    v_mfma_f32_16x16x32_bf16 v[192:195], a[216:219], v[136:139], v[192:195]
    s_waitcnt lgkmcnt(10)
    buffer_load_dwordx4 v49, s[20:23], s49 offen offset:3072 lds
    v_mfma_f32_16x16x32_bf16 v[192:195], a[220:223], v[140:143], v[192:195]
    s_waitcnt lgkmcnt(8)
    ds_read_b64_tr_b16 a[164:165], v29 offset:8192
    ds_read_b64_tr_b16 a[166:167], v29 offset:12288
    v_mfma_f32_16x16x32_bf16 v[192:195], a[224:227], v[144:147], v[192:195]
    s_waitcnt lgkmcnt(8)
    ds_read_b64_tr_b16 a[168:169], v29 offset:16384
    v_cvt_pk_bf16_f32 v238, v204, v205
    v_mfma_f32_16x16x32_bf16 v[192:195], a[228:231], v[148:151], v[192:195]
    s_waitcnt lgkmcnt(7)
    s_add_u32 s38, s47, 296064
    ds_read_b64_tr_b16 a[170:171], v29 offset:20480
    v_cvt_pk_bf16_f32 v239, v206, v207
    v_mfma_f32_16x16x32_bf16 v[192:195], a[232:235], v[152:155], v[192:195]
    s_waitcnt lgkmcnt(6)
    s_add_u32 s49, s45, 74752
    buffer_store_dwordx4 v[236:239], v56, s[28:31], s38 offen sc1
    v_mfma_f32_16x16x32_bf16 v[192:195], a[236:239], v[156:159], v[192:195]
    s_add_u32 m0, s42, 81920
    ds_read_b64_tr_b16 a[172:173], v29 offset:24576
    ds_read_b64_tr_b16 a[174:175], v29 offset:28672
    v_mfma_f32_16x16x32_bf16 v[196:199], a[208:211], v[160:163], 0
    buffer_load_dwordx4 v46, s[20:23], s49 offen lds
    v_mfma_f32_16x16x32_bf16 v[196:199], a[212:215], v[164:167], v[196:199]
    ds_read_b64_tr_b16 a[176:177], v33 offset:0
    ds_read_b64_tr_b16 a[178:179], v33 offset:4096
    v_mfma_f32_16x16x32_bf16 v[196:199], a[216:219], v[168:171], v[196:199]
    buffer_load_dwordx4 v47, s[20:23], s49 offen offset:1024 lds
    v_mfma_f32_16x16x32_bf16 v[196:199], a[220:223], v[172:175], v[196:199]
    ds_read_b64_tr_b16 a[180:181], v33 offset:8192
    ds_read_b64_tr_b16 a[182:183], v33 offset:12288
    v_mfma_f32_16x16x32_bf16 v[196:199], a[224:227], v[176:179], v[196:199]
    ds_read_b64_tr_b16 a[184:185], v33 offset:16384
    v_cvt_pk_bf16_f32 v224, v192, v193
    v_mfma_f32_16x16x32_bf16 v[196:199], a[228:231], v[180:183], v[196:199]
    ds_read_b64_tr_b16 a[186:187], v33 offset:20480
    v_cvt_pk_bf16_f32 v225, v194, v195
    v_mfma_f32_16x16x32_bf16 v[196:199], a[232:235], v[184:187], v[196:199]
    ds_read_b64_tr_b16 a[188:189], v33 offset:24576
    v_mfma_f32_16x16x32_bf16 v[196:199], a[236:239], v[188:191], v[196:199]
    s_waitcnt lgkmcnt(13)
    ds_read_b64_tr_b16 a[190:191], v33 offset:28672
    v_mfma_f32_16x16x32_bf16 v[200:203], a[160:163], v[128:131], 0
    s_waitcnt lgkmcnt(12)
    buffer_load_dwordx4 v48, s[20:23], s49 offen offset:2048 lds
    v_mfma_f32_16x16x32_bf16 v[200:203], a[164:167], v[132:135], v[200:203]
    s_waitcnt lgkmcnt(10)
    ds_read_b64_tr_b16 a[208:209], v30 offset:0
    ds_read_b64_tr_b16 a[210:211], v30 offset:4096
    v_mfma_f32_16x16x32_bf16 v[200:203], a[168:171], v[136:139], v[200:203]
    s_waitcnt lgkmcnt(10)
    buffer_load_dwordx4 v49, s[20:23], s49 offen offset:3072 lds
    v_mfma_f32_16x16x32_bf16 v[200:203], a[172:175], v[140:143], v[200:203]
    s_waitcnt lgkmcnt(8)
    ds_read_b64_tr_b16 a[212:213], v30 offset:8192
    ds_read_b64_tr_b16 a[214:215], v30 offset:12288
    v_mfma_f32_16x16x32_bf16 v[200:203], a[176:179], v[144:147], v[200:203]
    s_waitcnt lgkmcnt(8)
    ds_read_b64_tr_b16 a[216:217], v30 offset:16384
    v_cvt_pk_bf16_f32 v228, v196, v197
    v_mfma_f32_16x16x32_bf16 v[200:203], a[180:183], v[148:151], v[200:203]
    s_waitcnt lgkmcnt(7)
    ds_read_b64_tr_b16 a[218:219], v30 offset:20480
    v_cvt_pk_bf16_f32 v229, v198, v199
    v_mfma_f32_16x16x32_bf16 v[200:203], a[184:187], v[152:155], v[200:203]
    s_waitcnt lgkmcnt(6)
    s_lshl_b32 s40, s5, 4
    ds_read_b64_tr_b16 a[220:221], v30 offset:24576
    v_mfma_f32_16x16x32_bf16 v[200:203], a[188:191], v[156:159], v[200:203]
    s_add_u32 s40, s40, s4
    ds_read_b64_tr_b16 a[222:223], v30 offset:28672
    v_and_b32 v240, 31, v1
    v_mfma_f32_16x16x32_bf16 v[204:207], a[160:163], v[160:163], 0
    ds_read_b64_tr_b16 a[224:225], v34 offset:0
    v_lshrrev_b32 v241, 5, v1
    v_mfma_f32_16x16x32_bf16 v[204:207], a[164:167], v[164:167], v[204:207]
    ds_read_b64_tr_b16 a[226:227], v34 offset:4096
    v_cmp_gt_u32 vcc, 24, v240
    v_mfma_f32_16x16x32_bf16 v[204:207], a[168:171], v[168:171], v[204:207]
    ds_read_b64_tr_b16 a[228:229], v34 offset:8192
    v_mov_b32 v242, 2147483648
    v_mfma_f32_16x16x32_bf16 v[204:207], a[172:175], v[172:175], v[204:207]
    s_lshl_b32 s43, s40, 3
    ds_read_b64_tr_b16 a[230:231], v34 offset:12288
    v_mfma_f32_16x16x32_bf16 v[204:207], a[176:179], v[176:179], v[204:207]
    ds_read_b64_tr_b16 a[232:233], v34 offset:16384
    v_cvt_pk_bf16_f32 v226, v200, v201
    v_mfma_f32_16x16x32_bf16 v[204:207], a[180:183], v[180:183], v[204:207]
    s_add_u32 s38, s47, 1280
    ds_read_b64_tr_b16 a[234:235], v34 offset:20480
    v_cvt_pk_bf16_f32 v227, v202, v203
    v_mfma_f32_16x16x32_bf16 v[204:207], a[184:187], v[184:187], v[204:207]
    buffer_store_dwordx4 v[224:227], v56, s[28:31], s38 offen sc1
    v_mfma_f32_16x16x32_bf16 v[204:207], a[188:191], v[188:191], v[204:207]
    s_waitcnt lgkmcnt(12)
    s_lshl_b32 s44, s3, 1
    ds_read_b64_tr_b16 a[236:237], v34 offset:24576
    ds_read_b64_tr_b16 a[238:239], v34 offset:28672
    v_mfma_f32_16x16x32_bf16 v[192:195], a[208:211], v[128:131], 0
    s_waitcnt lgkmcnt(12)
    s_add_u32 s43, s43, s44
    ds_read_b64_tr_b16 a[160:161], v31 offset:0
    v_cndmask_b32 v242, v242, 0, vcc
    v_mfma_f32_16x16x32_bf16 v[192:195], a[212:215], v[132:135], v[192:195]
    s_waitcnt lgkmcnt(11)
    ds_read_b64_tr_b16 a[162:163], v31 offset:4096
    v_add_u32 v7, s43, v241
    v_mfma_f32_16x16x32_bf16 v[192:195], a[216:219], v[136:139], v[192:195]
    s_waitcnt lgkmcnt(10)
    ds_read_b64_tr_b16 a[164:165], v31 offset:8192
    v_lshl_add_u32 v5, v240, 4, v242
    v_mfma_f32_16x16x32_bf16 v[192:195], a[220:223], v[140:143], v[192:195]
    s_waitcnt lgkmcnt(9)
    ds_read_b64_tr_b16 a[166:167], v31 offset:12288
    v_lshl_add_u32 v243, v241, 4, v242
    v_mfma_f32_16x16x32_bf16 v[192:195], a[224:227], v[144:147], v[192:195]
    s_waitcnt lgkmcnt(8)
    ds_read_b64_tr_b16 a[168:169], v31 offset:16384
    v_cvt_pk_bf16_f32 v230, v204, v205
    v_mfma_f32_16x16x32_bf16 v[192:195], a[228:231], v[148:151], v[192:195]
    s_waitcnt lgkmcnt(7)
    s_add_u32 s38, s47, 296192
    ds_read_b64_tr_b16 a[170:171], v31 offset:20480
    v_cvt_pk_bf16_f32 v231, v206, v207
    v_mfma_f32_16x16x32_bf16 v[192:195], a[232:235], v[152:155], v[192:195]
    s_waitcnt lgkmcnt(6)
    buffer_store_dwordx4 v[228:231], v56, s[28:31], s38 offen sc1
    v_mfma_f32_16x16x32_bf16 v[192:195], a[236:239], v[156:159], v[192:195]
    ds_read_b64_tr_b16 a[172:173], v31 offset:24576
    ds_read_b64_tr_b16 a[174:175], v31 offset:28672
    v_mfma_f32_16x16x32_bf16 v[196:199], a[208:211], v[160:163], 0
    ds_read_b64_tr_b16 a[176:177], v35 offset:0
    v_lshl_add_u32 v2, v240, 5, v243
    v_mfma_f32_16x16x32_bf16 v[196:199], a[212:215], v[164:167], v[196:199]
    s_mul_i32 s44, s43, 18432
    ds_read_b64_tr_b16 a[178:179], v35 offset:4096
    v_lshrrev_b32 v243, 2, v240
    v_mfma_f32_16x16x32_bf16 v[196:199], a[216:219], v[168:171], v[196:199]
    ds_read_b64_tr_b16 a[180:181], v35 offset:8192
    v_lshl_add_u32 v243, v243, 6, v242
    v_mfma_f32_16x16x32_bf16 v[196:199], a[220:223], v[172:175], v[196:199]
    ds_read_b64_tr_b16 a[182:183], v35 offset:12288
    v_and_b32 v241, 3, v240
    v_mfma_f32_16x16x32_bf16 v[196:199], a[224:227], v[176:179], v[196:199]
    ds_read_b64_tr_b16 a[184:185], v35 offset:16384
    v_cvt_pk_bf16_f32 v232, v192, v193
    v_mfma_f32_16x16x32_bf16 v[196:199], a[228:231], v[180:183], v[196:199]
    ds_read_b64_tr_b16 a[186:187], v35 offset:20480
    v_cvt_pk_bf16_f32 v233, v194, v195
    v_mfma_f32_16x16x32_bf16 v[196:199], a[232:235], v[184:187], v[196:199]
    ds_read_b64_tr_b16 a[188:189], v35 offset:24576
    v_lshl_add_u32 v3, v241, 3, v243
    v_mfma_f32_16x16x32_bf16 v[196:199], a[236:239], v[188:191], v[196:199]
    s_waitcnt lgkmcnt(13)
    ds_read_b64_tr_b16 a[190:191], v35 offset:28672
    v_mul_u32_u24 v243, 1152, v7
    s_waitcnt vmcnt(26)
    s_barrier
    v_mfma_f32_16x16x32_bf16 v[200:203], a[160:163], v[128:131], 0
    s_waitcnt lgkmcnt(12)
    ds_read_b64_tr_b16 a[208:209], v12 offset:0
    v_add_u32 v4, v243, v3
    v_mfma_f32_16x16x32_bf16 v[200:203], a[164:167], v[132:135], v[200:203]
    s_waitcnt lgkmcnt(11)
    ds_read_b64_tr_b16 a[210:211], v12 offset:4096
    v_add_u32 v6, v243, v5
    v_mfma_f32_16x16x32_bf16 v[200:203], a[168:171], v[136:139], v[200:203]
    s_waitcnt lgkmcnt(10)
    s_lshr_b32 s41, s2, 3
    ds_read_b64_tr_b16 a[212:213], v12 offset:8192
    v_mfma_f32_16x16x32_bf16 v[200:203], a[172:175], v[140:143], v[200:203]
    s_waitcnt lgkmcnt(9)
    s_and_b32 s42, s2, 7
    ds_read_b64_tr_b16 a[214:215], v12 offset:12288
    v_mfma_f32_16x16x32_bf16 v[200:203], a[176:179], v[144:147], v[200:203]
    s_waitcnt lgkmcnt(8)
    ds_read_b64_tr_b16 a[216:217], v12 offset:16384
    v_cvt_pk_bf16_f32 v236, v196, v197
    v_mfma_f32_16x16x32_bf16 v[200:203], a[180:183], v[148:151], v[200:203]
    s_waitcnt lgkmcnt(7)
    ds_read_b64_tr_b16 a[218:219], v12 offset:20480
    v_cvt_pk_bf16_f32 v237, v198, v199
    v_mfma_f32_16x16x32_bf16 v[200:203], a[184:187], v[152:155], v[200:203]
    s_waitcnt lgkmcnt(6)
    s_mov_b32 s14, 2359296
    ds_read_b64_tr_b16 a[220:221], v12 offset:24576
    v_mfma_f32_16x16x32_bf16 v[200:203], a[188:191], v[156:159], v[200:203]
    s_mov_b32 s15, 0x20000
    ds_read_b64_tr_b16 a[222:223], v12 offset:28672
    v_mfma_f32_16x16x32_bf16 v[204:207], a[160:163], v[160:163], 0
    s_mov_b32 s18, 2359296
    ds_read_b64_tr_b16 a[224:225], v16 offset:0
    v_mfma_f32_16x16x32_bf16 v[204:207], a[164:167], v[164:167], v[204:207]
    s_mov_b32 s19, 0x20000
    ds_read_b64_tr_b16 a[226:227], v16 offset:4096
    v_mfma_f32_16x16x32_bf16 v[204:207], a[168:171], v[168:171], v[204:207]
    s_mov_b32 s22, 1152
    ds_read_b64_tr_b16 a[228:229], v16 offset:8192
    v_mfma_f32_16x16x32_bf16 v[204:207], a[172:175], v[172:175], v[204:207]
    s_mov_b32 s23, 0x20000
    ds_read_b64_tr_b16 a[230:231], v16 offset:12288
    v_mfma_f32_16x16x32_bf16 v[204:207], a[176:179], v[176:179], v[204:207]
    ds_read_b64_tr_b16 a[232:233], v16 offset:16384
    v_cvt_pk_bf16_f32 v234, v200, v201
    v_mfma_f32_16x16x32_bf16 v[204:207], a[180:183], v[180:183], v[204:207]
    s_add_u32 s38, s47, 1408
    ds_read_b64_tr_b16 a[234:235], v16 offset:20480
    v_cvt_pk_bf16_f32 v235, v202, v203
    v_mfma_f32_16x16x32_bf16 v[204:207], a[184:187], v[184:187], v[204:207]
    buffer_store_dwordx4 v[232:235], v56, s[28:31], s38 offen sc1
    v_mfma_f32_16x16x32_bf16 v[204:207], a[188:191], v[188:191], v[204:207]
    s_waitcnt lgkmcnt(12)
    s_mov_b64 s[20:21], s[52:53]
    ds_read_b64_tr_b16 a[236:237], v16 offset:24576
    ds_read_b64_tr_b16 a[238:239], v16 offset:28672
    v_mfma_f32_16x16x32_bf16 v[192:195], a[208:211], v[128:131], 0
    s_waitcnt lgkmcnt(12)
    s_add_u32 s8, s50, 7864320
    s_addc_u32 s9, s51, 0
    ds_read_b64_tr_b16 a[160:161], v13 offset:0
    v_mfma_f32_16x16x32_bf16 v[192:195], a[212:215], v[132:135], v[192:195]
    s_waitcnt lgkmcnt(11)
    s_mov_b32 s10, 663552
    ds_read_b64_tr_b16 a[162:163], v13 offset:4096
    v_mfma_f32_16x16x32_bf16 v[192:195], a[216:219], v[136:139], v[192:195]
    s_waitcnt lgkmcnt(10)
    s_mov_b32 s11, 0x20000
    ds_read_b64_tr_b16 a[164:165], v13 offset:8192
    v_mfma_f32_16x16x32_bf16 v[192:195], a[220:223], v[140:143], v[192:195]
    s_waitcnt lgkmcnt(9)
    s_lshl_b32 s93, s5, 13
    ds_read_b64_tr_b16 a[166:167], v13 offset:12288
    v_mfma_f32_16x16x32_bf16 v[192:195], a[224:227], v[144:147], v[192:195]
    s_waitcnt lgkmcnt(8)
    ds_read_b64_tr_b16 a[168:169], v13 offset:16384
    v_cvt_pk_bf16_f32 v238, v204, v205
    v_mfma_f32_16x16x32_bf16 v[192:195], a[228:231], v[148:151], v[192:195]
    s_waitcnt lgkmcnt(7)
    s_add_u32 s38, s47, 296320
    ds_read_b64_tr_b16 a[170:171], v13 offset:20480
    v_cvt_pk_bf16_f32 v239, v206, v207
    v_mfma_f32_16x16x32_bf16 v[192:195], a[232:235], v[152:155], v[192:195]
    s_waitcnt lgkmcnt(6)
    buffer_store_dwordx4 v[236:239], v56, s[28:31], s38 offen sc1
    v_mfma_f32_16x16x32_bf16 v[192:195], a[236:239], v[156:159], v[192:195]
    s_add_u32 s93, s93, 8781824
    ds_read_b64_tr_b16 a[172:173], v13 offset:24576
    ds_read_b64_tr_b16 a[174:175], v13 offset:28672
    v_mfma_f32_16x16x32_bf16 v[196:199], a[208:211], v[160:163], 0
    s_lshl_b32 s45, s3, 11
    ds_read_b64_tr_b16 a[176:177], v17 offset:0
    v_mfma_f32_16x16x32_bf16 v[196:199], a[212:215], v[164:167], v[196:199]
    s_add_u32 s92, s93, s45
    ds_read_b64_tr_b16 a[178:179], v17 offset:4096
    v_mfma_f32_16x16x32_bf16 v[196:199], a[216:219], v[168:171], v[196:199]
    s_lshl_b32 s45, s4, 7
    ds_read_b64_tr_b16 a[180:181], v17 offset:8192
    v_mfma_f32_16x16x32_bf16 v[196:199], a[220:223], v[172:175], v[196:199]
    s_add_u32 s92, s92, s45
    ds_read_b64_tr_b16 a[182:183], v17 offset:12288
    v_mfma_f32_16x16x32_bf16 v[196:199], a[224:227], v[176:179], v[196:199]
    ds_read_b64_tr_b16 a[184:185], v17 offset:16384
    v_cvt_pk_bf16_f32 v224, v192, v193
    v_mfma_f32_16x16x32_bf16 v[196:199], a[228:231], v[180:183], v[196:199]
    ds_read_b64_tr_b16 a[186:187], v17 offset:20480
    v_cvt_pk_bf16_f32 v225, v194, v195
    v_mfma_f32_16x16x32_bf16 v[196:199], a[232:235], v[184:187], v[196:199]
    s_lshr_b32 s45, s4, 2
    ds_read_b64_tr_b16 a[188:189], v17 offset:24576
    v_mfma_f32_16x16x32_bf16 v[196:199], a[236:239], v[188:191], v[196:199]
    s_waitcnt lgkmcnt(13)
    s_lshl_b32 s45, s45, 11
    ds_read_b64_tr_b16 a[190:191], v17 offset:28672
    v_mfma_f32_16x16x32_bf16 v[200:203], a[160:163], v[128:131], 0
    s_waitcnt lgkmcnt(12)
    s_add_u32 s93, s93, s45
    ds_read_b64_tr_b16 a[208:209], v14 offset:0
    v_min_u32 v8, 1, v1
    v_mfma_f32_16x16x32_bf16 v[200:203], a[164:167], v[132:135], v[200:203]
    s_waitcnt lgkmcnt(11)
    ds_read_b64_tr_b16 a[210:211], v14 offset:4096
    v_lshlrev_b32 v8, 31, v8
    v_mfma_f32_16x16x32_bf16 v[200:203], a[168:171], v[136:139], v[200:203]
    s_waitcnt lgkmcnt(10)
    ds_read_b64_tr_b16 a[212:213], v14 offset:8192
    v_and_b32 v9, 15, v1
    v_mfma_f32_16x16x32_bf16 v[200:203], a[172:175], v[140:143], v[200:203]
    s_waitcnt lgkmcnt(9)
    ds_read_b64_tr_b16 a[214:215], v14 offset:12288
    v_lshlrev_b32 v9, 7, v9
    v_mfma_f32_16x16x32_bf16 v[200:203], a[176:179], v[144:147], v[200:203]
    s_waitcnt lgkmcnt(8)
    ds_read_b64_tr_b16 a[216:217], v14 offset:16384
    v_cvt_pk_bf16_f32 v228, v196, v197
    v_mfma_f32_16x16x32_bf16 v[200:203], a[180:183], v[148:151], v[200:203]
    s_waitcnt lgkmcnt(7)
    ds_read_b64_tr_b16 a[218:219], v14 offset:20480
    v_cvt_pk_bf16_f32 v229, v198, v199
    v_mfma_f32_16x16x32_bf16 v[200:203], a[184:187], v[152:155], v[200:203]
    s_waitcnt lgkmcnt(6)
    ds_read_b64_tr_b16 a[220:221], v14 offset:24576
    v_mov_b32 v10, s95
    v_mfma_f32_16x16x32_bf16 v[200:203], a[188:191], v[156:159], v[200:203]
    ds_read_b64_tr_b16 a[222:223], v14 offset:28672
    v_lshrrev_b32 v240, 4, v1
    v_mfma_f32_16x16x32_bf16 v[204:207], a[160:163], v[160:163], 0
    ds_read_b64_tr_b16 a[224:225], v18 offset:0
    v_bfe_u32 v241, v1, 2, 2
    v_mfma_f32_16x16x32_bf16 v[204:207], a[164:167], v[164:167], v[204:207]
    ds_read_b64_tr_b16 a[226:227], v18 offset:4096
    v_cmp_eq_u32 s[54:55], v240, v241
    v_mfma_f32_16x16x32_bf16 v[204:207], a[168:171], v[168:171], v[204:207]
    ds_read_b64_tr_b16 a[228:229], v18 offset:8192
    v_and_b32 v240, 1, v1
    v_mfma_f32_16x16x32_bf16 v[204:207], a[172:175], v[172:175], v[204:207]
    ds_read_b64_tr_b16 a[230:231], v18 offset:12288
    v_lshlrev_b32 v240, 4, v240
    v_mfma_f32_16x16x32_bf16 v[204:207], a[176:179], v[176:179], v[204:207]
    ds_read_b64_tr_b16 a[232:233], v18 offset:16384
    v_cvt_pk_bf16_f32 v226, v200, v201
    v_mfma_f32_16x16x32_bf16 v[204:207], a[180:183], v[180:183], v[204:207]
    s_add_u32 s38, s47, 1536
    ds_read_b64_tr_b16 a[234:235], v18 offset:20480
    v_cvt_pk_bf16_f32 v227, v202, v203
    v_mfma_f32_16x16x32_bf16 v[204:207], a[184:187], v[184:187], v[204:207]
    buffer_store_dwordx4 v[224:227], v56, s[28:31], s38 offen sc1
    v_mfma_f32_16x16x32_bf16 v[204:207], a[188:191], v[188:191], v[204:207]
    s_waitcnt lgkmcnt(12)
    ds_read_b64_tr_b16 a[236:237], v18 offset:24576
    ds_read_b64_tr_b16 a[238:239], v18 offset:28672
    v_mfma_f32_16x16x32_bf16 v[192:195], a[208:211], v[128:131], 0
    s_waitcnt lgkmcnt(12)
    ds_read_b64_tr_b16 a[160:161], v15 offset:0
    v_mov_b32 v241, 0x3f80
    v_mfma_f32_16x16x32_bf16 v[192:195], a[212:215], v[132:135], v[192:195]
    s_waitcnt lgkmcnt(11)
    ds_read_b64_tr_b16 a[162:163], v15 offset:4096
    v_lshlrev_b32 v240, v240, v241
    v_mfma_f32_16x16x32_bf16 v[192:195], a[216:219], v[136:139], v[192:195]
    s_waitcnt lgkmcnt(10)
    ds_read_b64_tr_b16 a[164:165], v15 offset:8192
    v_cndmask_b32 v240, 0, v240, s[54:55]
    v_mfma_f32_16x16x32_bf16 v[192:195], a[220:223], v[140:143], v[192:195]
    s_waitcnt lgkmcnt(9)
    ds_read_b64_tr_b16 a[166:167], v15 offset:12288
    v_bfe_i32 v241, v1, 1, 1
    v_mfma_f32_16x16x32_bf16 v[192:195], a[224:227], v[144:147], v[192:195]
    s_waitcnt lgkmcnt(8)
    ds_read_b64_tr_b16 a[168:169], v15 offset:16384
    v_cvt_pk_bf16_f32 v230, v204, v205
    v_mfma_f32_16x16x32_bf16 v[192:195], a[228:231], v[148:151], v[192:195]
    s_waitcnt lgkmcnt(7)
    s_add_u32 s38, s47, 296448
    ds_read_b64_tr_b16 a[170:171], v15 offset:20480
    v_cvt_pk_bf16_f32 v231, v206, v207
    v_mfma_f32_16x16x32_bf16 v[192:195], a[232:235], v[152:155], v[192:195]
    s_waitcnt lgkmcnt(6)
    buffer_store_dwordx4 v[228:231], v56, s[28:31], s38 offen sc1
    v_mfma_f32_16x16x32_bf16 v[192:195], a[236:239], v[156:159], v[192:195]
    ds_read_b64_tr_b16 a[172:173], v15 offset:24576
    ds_read_b64_tr_b16 a[174:175], v15 offset:28672
    v_mfma_f32_16x16x32_bf16 v[196:199], a[208:211], v[160:163], 0
    ds_read_b64_tr_b16 a[176:177], v19 offset:0
    v_mov_b32 v248, 0
    v_mfma_f32_16x16x32_bf16 v[196:199], a[212:215], v[164:167], v[196:199]
    ds_read_b64_tr_b16 a[178:179], v19 offset:4096
    v_mov_b32 v249, 0
    v_mfma_f32_16x16x32_bf16 v[196:199], a[216:219], v[168:171], v[196:199]
    ds_read_b64_tr_b16 a[180:181], v19 offset:8192
    v_mov_b32 v252, 0
    v_mfma_f32_16x16x32_bf16 v[196:199], a[220:223], v[172:175], v[196:199]
    ds_read_b64_tr_b16 a[182:183], v19 offset:12288
    v_mov_b32 v253, 0
    v_mfma_f32_16x16x32_bf16 v[196:199], a[224:227], v[176:179], v[196:199]
    ds_read_b64_tr_b16 a[184:185], v19 offset:16384
    v_cvt_pk_bf16_f32 v232, v192, v193
    v_mfma_f32_16x16x32_bf16 v[196:199], a[228:231], v[180:183], v[196:199]
    ds_read_b64_tr_b16 a[186:187], v19 offset:20480
    v_cvt_pk_bf16_f32 v233, v194, v195
    v_mfma_f32_16x16x32_bf16 v[196:199], a[232:235], v[184:187], v[196:199]
    ds_read_b64_tr_b16 a[188:189], v19 offset:24576
    v_and_b32 v251, v240, v241
    v_mfma_f32_16x16x32_bf16 v[196:199], a[236:239], v[188:191], v[196:199]
    s_waitcnt lgkmcnt(13)
    ds_read_b64_tr_b16 a[190:191], v19 offset:28672
    v_xor_b32 v250, v240, v251
    s_waitcnt vmcnt(18)
    s_barrier
    v_mfma_f32_16x16x32_bf16 v[200:203], a[160:163], v[128:131], 0
    s_waitcnt lgkmcnt(12)
    ds_read_b64_tr_b16 a[208:209], v12 offset:32768
    v_mfma_f32_16x16x32_bf16 v[200:203], a[164:167], v[132:135], v[200:203]
    s_waitcnt lgkmcnt(11)
    s_mov_b32 s45, 18688
    ds_read_b64_tr_b16 a[210:211], v12 offset:36864
    v_mfma_f32_16x16x32_bf16 v[200:203], a[168:171], v[136:139], v[200:203]
    s_waitcnt lgkmcnt(10)
    buffer_load_dwordx4 v[64:67], v5, s[24:27], s45 offen offset:0 sc1
    v_mfma_f32_16x16x32_bf16 v[200:203], a[172:175], v[140:143], v[200:203]
    s_waitcnt lgkmcnt(8)
    ds_read_b64_tr_b16 a[212:213], v12 offset:40960
    ds_read_b64_tr_b16 a[214:215], v12 offset:45056
    v_mfma_f32_16x16x32_bf16 v[200:203], a[176:179], v[144:147], v[200:203]
    s_waitcnt lgkmcnt(8)
    ds_read_b64_tr_b16 a[216:217], v12 offset:49152
    v_cvt_pk_bf16_f32 v236, v196, v197
    v_mfma_f32_16x16x32_bf16 v[200:203], a[180:183], v[148:151], v[200:203]
    s_waitcnt lgkmcnt(7)
    ds_read_b64_tr_b16 a[218:219], v12 offset:53248
    v_cvt_pk_bf16_f32 v237, v198, v199
    v_mfma_f32_16x16x32_bf16 v[200:203], a[184:187], v[152:155], v[200:203]
    s_waitcnt lgkmcnt(6)
    ds_read_b64_tr_b16 a[220:221], v12 offset:57344
    v_mfma_f32_16x16x32_bf16 v[200:203], a[188:191], v[156:159], v[200:203]
    ds_read_b64_tr_b16 a[222:223], v12 offset:61440
    v_mfma_f32_16x16x32_bf16 v[204:207], a[160:163], v[160:163], 0
    buffer_load_dwordx4 v[68:71], v5, s[24:27], s45 offen offset:384 sc1
    v_mfma_f32_16x16x32_bf16 v[204:207], a[164:167], v[164:167], v[204:207]
    ds_read_b64_tr_b16 a[224:225], v16 offset:32768
    ds_read_b64_tr_b16 a[226:227], v16 offset:36864
    v_mfma_f32_16x16x32_bf16 v[204:207], a[168:171], v[168:171], v[204:207]
    buffer_load_dwordx4 v[72:75], v5, s[24:27], s45 offen offset:768 sc1
    v_mfma_f32_16x16x32_bf16 v[204:207], a[172:175], v[172:175], v[204:207]
    ds_read_b64_tr_b16 a[228:229], v16 offset:40960
    ds_read_b64_tr_b16 a[230:231], v16 offset:45056
    v_mfma_f32_16x16x32_bf16 v[204:207], a[176:179], v[176:179], v[204:207]
    ds_read_b64_tr_b16 a[232:233], v16 offset:49152
    v_cvt_pk_bf16_f32 v234, v200, v201
    v_mfma_f32_16x16x32_bf16 v[204:207], a[180:183], v[180:183], v[204:207]
    s_add_u32 s38, s47, 1664
    ds_read_b64_tr_b16 a[234:235], v16 offset:53248
    v_cvt_pk_bf16_f32 v235, v202, v203
    v_mfma_f32_16x16x32_bf16 v[204:207], a[184:187], v[184:187], v[204:207]
    buffer_store_dwordx4 v[232:235], v56, s[28:31], s38 offen sc1
    v_mfma_f32_16x16x32_bf16 v[204:207], a[188:191], v[188:191], v[204:207]
    s_waitcnt lgkmcnt(12)
    s_mov_b32 s45, 20992
    ds_read_b64_tr_b16 a[236:237], v16 offset:57344
    ds_read_b64_tr_b16 a[238:239], v16 offset:61440
    v_mfma_f32_16x16x32_bf16 v[192:195], a[208:211], v[128:131], 0
    s_waitcnt lgkmcnt(12)
    buffer_load_dwordx4 v[76:79], v5, s[24:27], s45 offen offset:0 sc1
    v_mfma_f32_16x16x32_bf16 v[192:195], a[212:215], v[132:135], v[192:195]
    s_waitcnt lgkmcnt(10)
    ds_read_b64_tr_b16 a[160:161], v13 offset:32768
    ds_read_b64_tr_b16 a[162:163], v13 offset:36864
    v_mfma_f32_16x16x32_bf16 v[192:195], a[216:219], v[136:139], v[192:195]
    s_waitcnt lgkmcnt(10)
    buffer_load_dwordx4 v[80:83], v5, s[24:27], s45 offen offset:384 sc1
    v_mfma_f32_16x16x32_bf16 v[192:195], a[220:223], v[140:143], v[192:195]
    s_waitcnt lgkmcnt(8)
    ds_read_b64_tr_b16 a[164:165], v13 offset:40960
    ds_read_b64_tr_b16 a[166:167], v13 offset:45056
    v_mfma_f32_16x16x32_bf16 v[192:195], a[224:227], v[144:147], v[192:195]
    s_waitcnt lgkmcnt(8)
    ds_read_b64_tr_b16 a[168:169], v13 offset:49152
    v_cvt_pk_bf16_f32 v238, v204, v205
    v_mfma_f32_16x16x32_bf16 v[192:195], a[228:231], v[148:151], v[192:195]
    s_waitcnt lgkmcnt(7)
    s_add_u32 s38, s47, 296576
    ds_read_b64_tr_b16 a[170:171], v13 offset:53248
    v_cvt_pk_bf16_f32 v239, v206, v207
    v_mfma_f32_16x16x32_bf16 v[192:195], a[232:235], v[152:155], v[192:195]
    s_waitcnt lgkmcnt(6)
    buffer_store_dwordx4 v[236:239], v56, s[28:31], s38 offen sc1
    v_mfma_f32_16x16x32_bf16 v[192:195], a[236:239], v[156:159], v[192:195]
    ds_read_b64_tr_b16 a[172:173], v13 offset:57344
    ds_read_b64_tr_b16 a[174:175], v13 offset:61440
    v_mfma_f32_16x16x32_bf16 v[196:199], a[208:211], v[160:163], 0
    buffer_load_dwordx4 v[84:87], v5, s[24:27], s45 offen offset:768 sc1
    v_mfma_f32_16x16x32_bf16 v[196:199], a[212:215], v[164:167], v[196:199]
    s_mov_b32 s45, 19840
    ds_read_b64_tr_b16 a[176:177], v17 offset:32768
    ds_read_b64_tr_b16 a[178:179], v17 offset:36864
    v_mfma_f32_16x16x32_bf16 v[196:199], a[216:219], v[168:171], v[196:199]
    buffer_load_dwordx4 v[88:91], v5, s[24:27], s45 offen offset:0 sc1
    v_mfma_f32_16x16x32_bf16 v[196:199], a[220:223], v[172:175], v[196:199]
    ds_read_b64_tr_b16 a[180:181], v17 offset:40960
    ds_read_b64_tr_b16 a[182:183], v17 offset:45056
    v_mfma_f32_16x16x32_bf16 v[196:199], a[224:227], v[176:179], v[196:199]
    ds_read_b64_tr_b16 a[184:185], v17 offset:49152
    v_cvt_pk_bf16_f32 v224, v192, v193
    v_mfma_f32_16x16x32_bf16 v[196:199], a[228:231], v[180:183], v[196:199]
    ds_read_b64_tr_b16 a[186:187], v17 offset:53248
    v_cvt_pk_bf16_f32 v225, v194, v195
    v_mfma_f32_16x16x32_bf16 v[196:199], a[232:235], v[184:187], v[196:199]
    ds_read_b64_tr_b16 a[188:189], v17 offset:57344
    v_mfma_f32_16x16x32_bf16 v[196:199], a[236:239], v[188:191], v[196:199]
    s_waitcnt lgkmcnt(13)
    ds_read_b64_tr_b16 a[190:191], v17 offset:61440
    v_mfma_f32_16x16x32_bf16 v[200:203], a[160:163], v[128:131], 0
    s_waitcnt lgkmcnt(12)
    buffer_load_dwordx4 v[92:95], v5, s[24:27], s45 offen offset:384 sc1
    v_mfma_f32_16x16x32_bf16 v[200:203], a[164:167], v[132:135], v[200:203]
    s_waitcnt lgkmcnt(10)
    ds_read_b64_tr_b16 a[208:209], v14 offset:32768
    ds_read_b64_tr_b16 a[210:211], v14 offset:36864
    v_mfma_f32_16x16x32_bf16 v[200:203], a[168:171], v[136:139], v[200:203]
    s_waitcnt lgkmcnt(10)
    buffer_load_dwordx4 v[96:99], v5, s[24:27], s45 offen offset:768 sc1
    v_mfma_f32_16x16x32_bf16 v[200:203], a[172:175], v[140:143], v[200:203]
    s_waitcnt lgkmcnt(8)
    ds_read_b64_tr_b16 a[212:213], v14 offset:40960
    ds_read_b64_tr_b16 a[214:215], v14 offset:45056
    v_mfma_f32_16x16x32_bf16 v[200:203], a[176:179], v[144:147], v[200:203]
    s_waitcnt lgkmcnt(8)
    ds_read_b64_tr_b16 a[216:217], v14 offset:49152
    v_cvt_pk_bf16_f32 v228, v196, v197
    v_mfma_f32_16x16x32_bf16 v[200:203], a[180:183], v[148:151], v[200:203]
    s_waitcnt lgkmcnt(7)
    ds_read_b64_tr_b16 a[218:219], v14 offset:53248
    v_cvt_pk_bf16_f32 v229, v198, v199
    v_mfma_f32_16x16x32_bf16 v[200:203], a[184:187], v[152:155], v[200:203]
    s_waitcnt lgkmcnt(6)
    ds_read_b64_tr_b16 a[220:221], v14 offset:57344
    v_mfma_f32_16x16x32_bf16 v[200:203], a[188:191], v[156:159], v[200:203]
    s_mov_b32 s45, 22144
    ds_read_b64_tr_b16 a[222:223], v14 offset:61440
    v_mfma_f32_16x16x32_bf16 v[204:207], a[160:163], v[160:163], 0
    buffer_load_dwordx4 v[112:115], v5, s[24:27], s45 offen offset:0 sc1
    v_mfma_f32_16x16x32_bf16 v[204:207], a[164:167], v[164:167], v[204:207]
    ds_read_b64_tr_b16 a[224:225], v18 offset:32768
    ds_read_b64_tr_b16 a[226:227], v18 offset:36864
    v_mfma_f32_16x16x32_bf16 v[204:207], a[168:171], v[168:171], v[204:207]
    buffer_load_dwordx4 v[116:119], v5, s[24:27], s45 offen offset:384 sc1
    v_mfma_f32_16x16x32_bf16 v[204:207], a[172:175], v[172:175], v[204:207]
    ds_read_b64_tr_b16 a[228:229], v18 offset:40960
    ds_read_b64_tr_b16 a[230:231], v18 offset:45056
    v_mfma_f32_16x16x32_bf16 v[204:207], a[176:179], v[176:179], v[204:207]
    ds_read_b64_tr_b16 a[232:233], v18 offset:49152
    v_cvt_pk_bf16_f32 v226, v200, v201
    v_mfma_f32_16x16x32_bf16 v[204:207], a[180:183], v[180:183], v[204:207]
    s_add_u32 s38, s47, 1792
    ds_read_b64_tr_b16 a[234:235], v18 offset:53248
    v_cvt_pk_bf16_f32 v227, v202, v203
    v_mfma_f32_16x16x32_bf16 v[204:207], a[184:187], v[184:187], v[204:207]
    buffer_store_dwordx4 v[224:227], v56, s[28:31], s38 offen sc1
    v_mfma_f32_16x16x32_bf16 v[204:207], a[188:191], v[188:191], v[204:207]
    s_waitcnt lgkmcnt(12)
    ds_read_b64_tr_b16 a[236:237], v18 offset:57344
    ds_read_b64_tr_b16 a[238:239], v18 offset:61440
    v_mfma_f32_16x16x32_bf16 v[192:195], a[208:211], v[128:131], 0
    s_waitcnt lgkmcnt(12)
    s_waitcnt vmcnt(16)
    buffer_store_dword v10, v8, s[24:27], s92 offen sc1
    v_mfma_f32_16x16x32_bf16 v[192:195], a[212:215], v[132:135], v[192:195]
    s_waitcnt lgkmcnt(10)
    s_add_u32 s92, s92, 4
    ds_read_b64_tr_b16 a[160:161], v15 offset:32768
    ds_read_b64_tr_b16 a[162:163], v15 offset:36864
    v_mfma_f32_16x16x32_bf16 v[192:195], a[216:219], v[136:139], v[192:195]
    s_waitcnt lgkmcnt(10)
    buffer_load_dwordx4 v[120:123], v5, s[24:27], s45 offen offset:768 sc1
    v_mfma_f32_16x16x32_bf16 v[192:195], a[220:223], v[140:143], v[192:195]
    s_waitcnt lgkmcnt(8)
    ds_read_b64_tr_b16 a[164:165], v15 offset:40960
    ds_read_b64_tr_b16 a[166:167], v15 offset:45056
    v_mfma_f32_16x16x32_bf16 v[192:195], a[224:227], v[144:147], v[192:195]
    s_waitcnt lgkmcnt(8)
    ds_read_b64_tr_b16 a[168:169], v15 offset:49152
    v_cvt_pk_bf16_f32 v230, v204, v205
    v_mfma_f32_16x16x32_bf16 v[192:195], a[228:231], v[148:151], v[192:195]
    s_waitcnt lgkmcnt(7)
    s_add_u32 s38, s47, 296704
    ds_read_b64_tr_b16 a[170:171], v15 offset:53248
    v_cvt_pk_bf16_f32 v231, v206, v207
    v_mfma_f32_16x16x32_bf16 v[192:195], a[232:235], v[152:155], v[192:195]
    s_waitcnt lgkmcnt(6)
    buffer_store_dwordx4 v[228:231], v56, s[28:31], s38 offen sc1
    v_mfma_f32_16x16x32_bf16 v[192:195], a[236:239], v[156:159], v[192:195]
    ds_read_b64_tr_b16 a[172:173], v15 offset:57344
    ds_read_b64_tr_b16 a[174:175], v15 offset:61440
    v_mfma_f32_16x16x32_bf16 v[196:199], a[208:211], v[160:163], 0
    buffer_load_dwordx2 v[36:37], v4, s[12:15], 0 offen offset:0
    v_mfma_f32_16x16x32_bf16 v[196:199], a[212:215], v[164:167], v[196:199]
    ds_read_b64_tr_b16 a[176:177], v19 offset:32768
    ds_read_b64_tr_b16 a[178:179], v19 offset:36864
    v_mfma_f32_16x16x32_bf16 v[196:199], a[216:219], v[168:171], v[196:199]
    buffer_load_dwordx2 v[38:39], v4, s[12:15], 0 offen offset:32
    v_mfma_f32_16x16x32_bf16 v[196:199], a[220:223], v[172:175], v[196:199]
    ds_read_b64_tr_b16 a[180:181], v19 offset:40960
    ds_read_b64_tr_b16 a[182:183], v19 offset:45056
    v_mfma_f32_16x16x32_bf16 v[196:199], a[224:227], v[176:179], v[196:199]
    ds_read_b64_tr_b16 a[184:185], v19 offset:49152
    v_cvt_pk_bf16_f32 v232, v192, v193
    v_mfma_f32_16x16x32_bf16 v[196:199], a[228:231], v[180:183], v[196:199]
    ds_read_b64_tr_b16 a[186:187], v19 offset:53248
    v_cvt_pk_bf16_f32 v233, v194, v195
    v_mfma_f32_16x16x32_bf16 v[196:199], a[232:235], v[184:187], v[196:199]
    ds_read_b64_tr_b16 a[188:189], v19 offset:57344
    v_mfma_f32_16x16x32_bf16 v[196:199], a[236:239], v[188:191], v[196:199]
    ds_read_b64_tr_b16 a[190:191], v19 offset:61440
    s_waitcnt lgkmcnt(0)
    s_barrier
    v_mfma_f32_16x16x32_bf16 v[200:203], a[160:163], v[128:131], 0
    buffer_load_dwordx2 v[40:41], v4, s[12:15], 0 offen offset:384
    v_mfma_f32_16x16x32_bf16 v[200:203], a[164:167], v[132:135], v[200:203]
    ds_read_b64_tr_b16 a[208:209], v20 offset:0
    ds_read_b64_tr_b16 a[210:211], v20 offset:4096
    v_mfma_f32_16x16x32_bf16 v[200:203], a[168:171], v[136:139], v[200:203]
    buffer_load_dwordx2 v[42:43], v4, s[12:15], 0 offen offset:416
    v_mfma_f32_16x16x32_bf16 v[200:203], a[172:175], v[140:143], v[200:203]
    ds_read_b64_tr_b16 a[212:213], v20 offset:8192
    ds_read_b64_tr_b16 a[214:215], v20 offset:12288
    v_mfma_f32_16x16x32_bf16 v[200:203], a[176:179], v[144:147], v[200:203]
    ds_read_b64_tr_b16 a[216:217], v20 offset:16384
    v_cvt_pk_bf16_f32 v236, v196, v197
    v_mfma_f32_16x16x32_bf16 v[200:203], a[180:183], v[148:151], v[200:203]
    ds_read_b64_tr_b16 a[218:219], v20 offset:20480
    v_cvt_pk_bf16_f32 v237, v198, v199
    v_mfma_f32_16x16x32_bf16 v[200:203], a[184:187], v[152:155], v[200:203]
    ds_read_b64_tr_b16 a[220:221], v20 offset:24576
    v_mfma_f32_16x16x32_bf16 v[200:203], a[188:191], v[156:159], v[200:203]
    ds_read_b64_tr_b16 a[222:223], v20 offset:28672
    v_mfma_f32_16x16x32_bf16 v[204:207], a[160:163], v[160:163], 0
    buffer_load_dwordx2 v[44:45], v4, s[12:15], 0 offen offset:768
    v_mfma_f32_16x16x32_bf16 v[204:207], a[164:167], v[164:167], v[204:207]
    ds_read_b64_tr_b16 a[224:225], v24 offset:0
    ds_read_b64_tr_b16 a[226:227], v24 offset:4096
    v_mfma_f32_16x16x32_bf16 v[204:207], a[168:171], v[168:171], v[204:207]
    buffer_load_dwordx2 v[46:47], v4, s[12:15], 0 offen offset:800
    v_mfma_f32_16x16x32_bf16 v[204:207], a[172:175], v[172:175], v[204:207]
    ds_read_b64_tr_b16 a[228:229], v24 offset:8192
    ds_read_b64_tr_b16 a[230:231], v24 offset:12288
    v_mfma_f32_16x16x32_bf16 v[204:207], a[176:179], v[176:179], v[204:207]
    ds_read_b64_tr_b16 a[232:233], v24 offset:16384
    v_cvt_pk_bf16_f32 v234, v200, v201
    v_mfma_f32_16x16x32_bf16 v[204:207], a[180:183], v[180:183], v[204:207]
    s_add_u32 s38, s47, 1920
    ds_read_b64_tr_b16 a[234:235], v24 offset:20480
    v_cvt_pk_bf16_f32 v235, v202, v203
    v_mfma_f32_16x16x32_bf16 v[204:207], a[184:187], v[184:187], v[204:207]
    buffer_store_dwordx4 v[232:235], v56, s[28:31], s38 offen sc1
    v_mfma_f32_16x16x32_bf16 v[204:207], a[188:191], v[188:191], v[204:207]
    s_waitcnt lgkmcnt(12)
    ds_read_b64_tr_b16 a[236:237], v24 offset:24576
    ds_read_b64_tr_b16 a[238:239], v24 offset:28672
    v_mfma_f32_16x16x32_bf16 v[192:195], a[208:211], v[128:131], 0
    s_waitcnt lgkmcnt(12)
    buffer_load_dwordx2 v[100:101], v3, s[20:23], 0 offen offset:0
    v_mfma_f32_16x16x32_bf16 v[192:195], a[212:215], v[132:135], v[192:195]
    s_waitcnt lgkmcnt(10)
    ds_read_b64_tr_b16 a[160:161], v21 offset:0
    ds_read_b64_tr_b16 a[162:163], v21 offset:4096
    v_mfma_f32_16x16x32_bf16 v[192:195], a[216:219], v[136:139], v[192:195]
    s_waitcnt lgkmcnt(10)
    buffer_load_dwordx2 v[102:103], v3, s[20:23], 0 offen offset:32
    v_mfma_f32_16x16x32_bf16 v[192:195], a[220:223], v[140:143], v[192:195]
    s_waitcnt lgkmcnt(8)
    ds_read_b64_tr_b16 a[164:165], v21 offset:8192
    ds_read_b64_tr_b16 a[166:167], v21 offset:12288
    v_mfma_f32_16x16x32_bf16 v[192:195], a[224:227], v[144:147], v[192:195]
    s_waitcnt lgkmcnt(8)
    ds_read_b64_tr_b16 a[168:169], v21 offset:16384
    v_cvt_pk_bf16_f32 v238, v204, v205
    v_mfma_f32_16x16x32_bf16 v[192:195], a[228:231], v[148:151], v[192:195]
    s_waitcnt lgkmcnt(7)
    s_add_u32 s38, s47, 296832
    ds_read_b64_tr_b16 a[170:171], v21 offset:20480
    v_cvt_pk_bf16_f32 v239, v206, v207
    v_mfma_f32_16x16x32_bf16 v[192:195], a[232:235], v[152:155], v[192:195]
    s_waitcnt lgkmcnt(6)
    buffer_store_dwordx4 v[236:239], v56, s[28:31], s38 offen sc1
    v_mfma_f32_16x16x32_bf16 v[192:195], a[236:239], v[156:159], v[192:195]
    ds_read_b64_tr_b16 a[172:173], v21 offset:24576
    ds_read_b64_tr_b16 a[174:175], v21 offset:28672
    v_mfma_f32_16x16x32_bf16 v[196:199], a[208:211], v[160:163], 0
    buffer_load_dwordx2 v[104:105], v3, s[20:23], 0 offen offset:384
    v_mfma_f32_16x16x32_bf16 v[196:199], a[212:215], v[164:167], v[196:199]
    ds_read_b64_tr_b16 a[176:177], v25 offset:0
    ds_read_b64_tr_b16 a[178:179], v25 offset:4096
    v_mfma_f32_16x16x32_bf16 v[196:199], a[216:219], v[168:171], v[196:199]
    buffer_load_dwordx2 v[106:107], v3, s[20:23], 0 offen offset:416
    v_mfma_f32_16x16x32_bf16 v[196:199], a[220:223], v[172:175], v[196:199]
    ds_read_b64_tr_b16 a[180:181], v25 offset:8192
    ds_read_b64_tr_b16 a[182:183], v25 offset:12288
    v_mfma_f32_16x16x32_bf16 v[196:199], a[224:227], v[176:179], v[196:199]
    ds_read_b64_tr_b16 a[184:185], v25 offset:16384
    v_cvt_pk_bf16_f32 v224, v192, v193
    v_mfma_f32_16x16x32_bf16 v[196:199], a[228:231], v[180:183], v[196:199]
    ds_read_b64_tr_b16 a[186:187], v25 offset:20480
    v_cvt_pk_bf16_f32 v225, v194, v195
    v_mfma_f32_16x16x32_bf16 v[196:199], a[232:235], v[184:187], v[196:199]
    ds_read_b64_tr_b16 a[188:189], v25 offset:24576
    v_mfma_f32_16x16x32_bf16 v[196:199], a[236:239], v[188:191], v[196:199]
    s_waitcnt lgkmcnt(13)
    ds_read_b64_tr_b16 a[190:191], v25 offset:28672
    v_mfma_f32_16x16x32_bf16 v[200:203], a[160:163], v[128:131], 0
    s_waitcnt lgkmcnt(12)
    buffer_load_dwordx2 v[108:109], v3, s[20:23], 0 offen offset:768
    v_mfma_f32_16x16x32_bf16 v[200:203], a[164:167], v[132:135], v[200:203]
    s_waitcnt lgkmcnt(10)
    ds_read_b64_tr_b16 a[208:209], v22 offset:0
    ds_read_b64_tr_b16 a[210:211], v22 offset:4096
    v_mfma_f32_16x16x32_bf16 v[200:203], a[168:171], v[136:139], v[200:203]
    s_waitcnt lgkmcnt(10)
    buffer_load_dwordx2 v[110:111], v3, s[20:23], 0 offen offset:800
    v_mfma_f32_16x16x32_bf16 v[200:203], a[172:175], v[140:143], v[200:203]
    s_waitcnt lgkmcnt(8)
    ds_read_b64_tr_b16 a[212:213], v22 offset:8192
    ds_read_b64_tr_b16 a[214:215], v22 offset:12288
    v_mfma_f32_16x16x32_bf16 v[200:203], a[176:179], v[144:147], v[200:203]
    s_waitcnt lgkmcnt(8)
    ds_read_b64_tr_b16 a[216:217], v22 offset:16384
    v_cvt_pk_bf16_f32 v228, v196, v197
    v_mfma_f32_16x16x32_bf16 v[200:203], a[180:183], v[148:151], v[200:203]
    s_waitcnt lgkmcnt(7)
    ds_read_b64_tr_b16 a[218:219], v22 offset:20480
    v_cvt_pk_bf16_f32 v229, v198, v199
    v_mfma_f32_16x16x32_bf16 v[200:203], a[184:187], v[152:155], v[200:203]
    s_waitcnt lgkmcnt(6)
    ds_read_b64_tr_b16 a[220:221], v22 offset:24576
    v_mfma_f32_16x16x32_bf16 v[200:203], a[188:191], v[156:159], v[200:203]
    ds_read_b64_tr_b16 a[222:223], v22 offset:28672
    v_mfma_f32_16x16x32_bf16 v[204:207], a[160:163], v[160:163], 0
    ds_read_b64_tr_b16 a[224:225], v26 offset:0
    v_mfma_f32_16x16x32_bf16 v[204:207], a[164:167], v[164:167], v[204:207]
    ds_read_b64_tr_b16 a[226:227], v26 offset:4096
    v_mfma_f32_16x16x32_bf16 v[204:207], a[168:171], v[168:171], v[204:207]
    ds_read_b64_tr_b16 a[228:229], v26 offset:8192
    v_mfma_f32_16x16x32_bf16 v[204:207], a[172:175], v[172:175], v[204:207]
    ds_read_b64_tr_b16 a[230:231], v26 offset:12288
    v_mfma_f32_16x16x32_bf16 v[204:207], a[176:179], v[176:179], v[204:207]
    ds_read_b64_tr_b16 a[232:233], v26 offset:16384
    v_cvt_pk_bf16_f32 v226, v200, v201
    v_mfma_f32_16x16x32_bf16 v[204:207], a[180:183], v[180:183], v[204:207]
    s_add_u32 s38, s47, 2048
    ds_read_b64_tr_b16 a[234:235], v26 offset:20480
    v_cvt_pk_bf16_f32 v227, v202, v203
    v_mfma_f32_16x16x32_bf16 v[204:207], a[184:187], v[184:187], v[204:207]
    buffer_store_dwordx4 v[224:227], v56, s[28:31], s38 offen sc1
    v_mfma_f32_16x16x32_bf16 v[204:207], a[188:191], v[188:191], v[204:207]
    s_waitcnt lgkmcnt(12)
    ds_read_b64_tr_b16 a[236:237], v26 offset:24576
    ds_read_b64_tr_b16 a[238:239], v26 offset:28672
    v_mfma_f32_16x16x32_bf16 v[192:195], a[208:211], v[128:131], 0
    s_waitcnt lgkmcnt(12)
    ds_read_b64_tr_b16 a[160:161], v23 offset:0
    v_mfma_f32_16x16x32_bf16 v[192:195], a[212:215], v[132:135], v[192:195]
    s_waitcnt lgkmcnt(11)
    ds_read_b64_tr_b16 a[162:163], v23 offset:4096
    v_mfma_f32_16x16x32_bf16 v[192:195], a[216:219], v[136:139], v[192:195]
    s_waitcnt lgkmcnt(10)
    ds_read_b64_tr_b16 a[164:165], v23 offset:8192
    v_mfma_f32_16x16x32_bf16 v[192:195], a[220:223], v[140:143], v[192:195]
    s_waitcnt lgkmcnt(9)
    ds_read_b64_tr_b16 a[166:167], v23 offset:12288
    v_mfma_f32_16x16x32_bf16 v[192:195], a[224:227], v[144:147], v[192:195]
    s_waitcnt lgkmcnt(8)
    ds_read_b64_tr_b16 a[168:169], v23 offset:16384
    v_cvt_pk_bf16_f32 v230, v204, v205
    v_mfma_f32_16x16x32_bf16 v[192:195], a[228:231], v[148:151], v[192:195]
    s_waitcnt lgkmcnt(7)
    s_add_u32 s38, s47, 296960
    ds_read_b64_tr_b16 a[170:171], v23 offset:20480
    v_cvt_pk_bf16_f32 v231, v206, v207
    v_mfma_f32_16x16x32_bf16 v[192:195], a[232:235], v[152:155], v[192:195]
    s_waitcnt lgkmcnt(6)
    buffer_store_dwordx4 v[228:231], v56, s[28:31], s38 offen sc1
    v_mfma_f32_16x16x32_bf16 v[192:195], a[236:239], v[156:159], v[192:195]
    ds_read_b64_tr_b16 a[172:173], v23 offset:24576
    ds_read_b64_tr_b16 a[174:175], v23 offset:28672
    v_mfma_f32_16x16x32_bf16 v[196:199], a[208:211], v[160:163], 0
    ds_read_b64_tr_b16 a[176:177], v27 offset:0
    v_mfma_f32_16x16x32_bf16 v[196:199], a[212:215], v[164:167], v[196:199]
    ds_read_b64_tr_b16 a[178:179], v27 offset:4096
    v_mfma_f32_16x16x32_bf16 v[196:199], a[216:219], v[168:171], v[196:199]
    ds_read_b64_tr_b16 a[180:181], v27 offset:8192
    v_mfma_f32_16x16x32_bf16 v[196:199], a[220:223], v[172:175], v[196:199]
    ds_read_b64_tr_b16 a[182:183], v27 offset:12288
    v_mfma_f32_16x16x32_bf16 v[196:199], a[224:227], v[176:179], v[196:199]
    ds_read_b64_tr_b16 a[184:185], v27 offset:16384
    v_cvt_pk_bf16_f32 v232, v192, v193
    v_mfma_f32_16x16x32_bf16 v[196:199], a[228:231], v[180:183], v[196:199]
    ds_read_b64_tr_b16 a[186:187], v27 offset:20480
    v_cvt_pk_bf16_f32 v233, v194, v195
    v_mfma_f32_16x16x32_bf16 v[196:199], a[232:235], v[184:187], v[196:199]
    ds_read_b64_tr_b16 a[188:189], v27 offset:24576
    v_mfma_f32_16x16x32_bf16 v[196:199], a[236:239], v[188:191], v[196:199]
    s_waitcnt lgkmcnt(13)
    ds_read_b64_tr_b16 a[190:191], v27 offset:28672
    v_mfma_f32_16x16x32_bf16 v[200:203], a[160:163], v[128:131], 0
    s_waitcnt lgkmcnt(12)
    buffer_load_dword v11, v9, s[24:27], s93 offen sc1
    v_mfma_f32_16x16x32_bf16 v[200:203], a[164:167], v[132:135], v[200:203]
    s_waitcnt lgkmcnt(10)
    v_mfma_f32_16x16x32_bf16 v[200:203], a[168:171], v[136:139], v[200:203]
    s_waitcnt lgkmcnt(8)
    v_mfma_f32_16x16x32_bf16 v[200:203], a[172:175], v[140:143], v[200:203]
    s_waitcnt lgkmcnt(6)
    v_mfma_f32_16x16x32_bf16 v[200:203], a[176:179], v[144:147], v[200:203]
    s_waitcnt lgkmcnt(4)
    v_cvt_pk_bf16_f32 v236, v196, v197
    v_mfma_f32_16x16x32_bf16 v[200:203], a[180:183], v[148:151], v[200:203]
    s_waitcnt lgkmcnt(2)
    v_cvt_pk_bf16_f32 v237, v198, v199
    v_mfma_f32_16x16x32_bf16 v[200:203], a[184:187], v[152:155], v[200:203]
    s_waitcnt lgkmcnt(0)
    v_mfma_f32_16x16x32_bf16 v[200:203], a[188:191], v[156:159], v[200:203]
    v_mfma_f32_16x16x32_bf16 v[204:207], a[160:163], v[160:163], 0
    v_mfma_f32_16x16x32_bf16 v[204:207], a[164:167], v[164:167], v[204:207]
    v_mfma_f32_16x16x32_bf16 v[204:207], a[168:171], v[168:171], v[204:207]
    v_mfma_f32_16x16x32_bf16 v[204:207], a[172:175], v[172:175], v[204:207]
    v_mfma_f32_16x16x32_bf16 v[204:207], a[176:179], v[176:179], v[204:207]
    s_nop 2
    v_cvt_pk_bf16_f32 v234, v200, v201
    v_mfma_f32_16x16x32_bf16 v[204:207], a[180:183], v[180:183], v[204:207]
    s_add_u32 s38, s47, 2176
    v_cvt_pk_bf16_f32 v235, v202, v203
    v_mfma_f32_16x16x32_bf16 v[204:207], a[184:187], v[184:187], v[204:207]
    buffer_store_dwordx4 v[232:235], v56, s[28:31], s38 offen sc1
    v_mfma_f32_16x16x32_bf16 v[204:207], a[188:191], v[188:191], v[204:207]
    s_nop 7
    v_cvt_pk_bf16_f32 v238, v204, v205
    s_add_u32 s38, s47, 297088
    v_cvt_pk_bf16_f32 v239, v206, v207
    buffer_store_dwordx4 v[236:239], v56, s[28:31], s38 offen sc1
    s_waitcnt vmcnt(2)
    v_cmp_ne_u32 s[54:55], s95, v11
    s_cmp_lg_u64 s[54:55], 0
    s_cbranch_scc1 Ltail_spin1
Ltail_got1:
    s_add_u32 s93, s93, 4
    s_add_u32 s45, s44, 0
    buffer_load_dwordx4 a[64:67], v2, s[28:31], s45 offen offset:0 sc1
    s_add_u32 s45, s44, 2304
    buffer_load_dwordx4 a[68:71], v2, s[28:31], s45 offen offset:0 sc1
    s_add_u32 s45, s44, 4608
    buffer_load_dwordx4 a[72:75], v2, s[28:31], s45 offen offset:0 sc1
    s_add_u32 s45, s44, 6912
    buffer_load_dwordx4 a[76:79], v2, s[28:31], s45 offen offset:0 sc1
    s_add_u32 s45, s44, 9216
    buffer_load_dwordx4 a[80:83], v2, s[28:31], s45 offen offset:0 sc1
    s_add_u32 s45, s44, 11520
    buffer_load_dwordx4 a[84:87], v2, s[28:31], s45 offen offset:0 sc1
    s_add_u32 s45, s44, 13824
    buffer_load_dwordx4 a[88:91], v2, s[28:31], s45 offen offset:0 sc1
    s_add_u32 s45, s44, 16128
    buffer_load_dwordx4 a[92:95], v2, s[28:31], s45 offen offset:0 sc1
    s_add_u32 s45, s44, 18432
    buffer_load_dwordx4 a[96:99], v2, s[28:31], s45 offen offset:0 sc1
    s_add_u32 s45, s44, 20736
    buffer_load_dwordx4 a[100:103], v2, s[28:31], s45 offen offset:0 sc1
    s_add_u32 s45, s44, 23040
    buffer_load_dwordx4 a[104:107], v2, s[28:31], s45 offen offset:0 sc1
    s_add_u32 s45, s44, 25344
    buffer_load_dwordx4 a[108:111], v2, s[28:31], s45 offen offset:0 sc1
    v_lshlrev_b32 v12, 16, v36
    v_and_b32 v13, 0xffff0000, v36
    v_lshlrev_b32 v14, 16, v37
    v_and_b32 v15, 0xffff0000, v37
    v_lshlrev_b32 v16, 16, v38
    v_and_b32 v17, 0xffff0000, v38
    v_lshlrev_b32 v18, 16, v39
    v_and_b32 v19, 0xffff0000, v39
    v_lshlrev_b32 v20, 16, v40
    v_and_b32 v21, 0xffff0000, v40
    v_lshlrev_b32 v22, 16, v41
    v_and_b32 v23, 0xffff0000, v41
    v_lshlrev_b32 v24, 16, v42
    v_and_b32 v25, 0xffff0000, v42
    v_lshlrev_b32 v26, 16, v43
    v_and_b32 v27, 0xffff0000, v43
    v_lshlrev_b32 v28, 16, v44
    v_and_b32 v29, 0xffff0000, v44
    v_lshlrev_b32 v30, 16, v45
    v_and_b32 v31, 0xffff0000, v45
    v_lshlrev_b32 v32, 16, v46
    v_and_b32 v33, 0xffff0000, v46
    v_lshlrev_b32 v34, 16, v47
    v_and_b32 v35, 0xffff0000, v47
    v_lshlrev_b32 v128, 16, v64
    v_and_b32 v129, 0xffff0000, v64
    v_lshlrev_b32 v130, 16, v65
    v_and_b32 v131, 0xffff0000, v65
    v_lshlrev_b32 v132, 16, v66
    v_and_b32 v133, 0xffff0000, v66
    v_lshlrev_b32 v134, 16, v67
    v_and_b32 v135, 0xffff0000, v67
    v_lshlrev_b32 v136, 16, v68
    v_and_b32 v137, 0xffff0000, v68
    v_lshlrev_b32 v138, 16, v69
    v_and_b32 v139, 0xffff0000, v69
    v_lshlrev_b32 v140, 16, v70
    v_and_b32 v141, 0xffff0000, v70
    v_lshlrev_b32 v142, 16, v71
    v_and_b32 v143, 0xffff0000, v71
    v_lshlrev_b32 v144, 16, v72
    v_and_b32 v145, 0xffff0000, v72
    v_lshlrev_b32 v146, 16, v73
    v_and_b32 v147, 0xffff0000, v73
    v_lshlrev_b32 v148, 16, v74
    v_and_b32 v149, 0xffff0000, v74
    v_lshlrev_b32 v150, 16, v75
    v_and_b32 v151, 0xffff0000, v75
    v_lshlrev_b32 v152, 16, v76
    v_and_b32 v153, 0xffff0000, v76
    v_lshlrev_b32 v154, 16, v77
    v_and_b32 v155, 0xffff0000, v77
    v_lshlrev_b32 v156, 16, v78
    v_and_b32 v157, 0xffff0000, v78
    v_lshlrev_b32 v158, 16, v79
    v_and_b32 v159, 0xffff0000, v79
    v_lshlrev_b32 v160, 16, v80
    v_and_b32 v161, 0xffff0000, v80
    v_lshlrev_b32 v162, 16, v81
    v_and_b32 v163, 0xffff0000, v81
    v_lshlrev_b32 v164, 16, v82
    v_and_b32 v165, 0xffff0000, v82
    v_lshlrev_b32 v166, 16, v83
    v_and_b32 v167, 0xffff0000, v83
    v_lshlrev_b32 v168, 16, v84
    v_and_b32 v169, 0xffff0000, v84
    v_lshlrev_b32 v170, 16, v85
    v_and_b32 v171, 0xffff0000, v85
    v_lshlrev_b32 v172, 16, v86
    v_and_b32 v173, 0xffff0000, v86
    v_lshlrev_b32 v174, 16, v87
    v_and_b32 v175, 0xffff0000, v87
    v_lshlrev_b32 v176, 16, v88
    v_and_b32 v177, 0xffff0000, v88
    v_lshlrev_b32 v178, 16, v89
    v_and_b32 v179, 0xffff0000, v89
    v_lshlrev_b32 v180, 16, v90
    v_and_b32 v181, 0xffff0000, v90
    v_lshlrev_b32 v182, 16, v91
    v_and_b32 v183, 0xffff0000, v91
    v_lshlrev_b32 v184, 16, v92
    v_and_b32 v185, 0xffff0000, v92
    v_lshlrev_b32 v186, 16, v93
    v_and_b32 v187, 0xffff0000, v93
    v_lshlrev_b32 v188, 16, v94
    v_and_b32 v189, 0xffff0000, v94
    v_lshlrev_b32 v190, 16, v95
    v_and_b32 v191, 0xffff0000, v95
    v_lshlrev_b32 v192, 16, v96
    v_and_b32 v193, 0xffff0000, v96
    v_lshlrev_b32 v194, 16, v97
    v_and_b32 v195, 0xffff0000, v97
    v_lshlrev_b32 v196, 16, v98
    v_and_b32 v197, 0xffff0000, v98
    v_lshlrev_b32 v198, 16, v99
    v_and_b32 v199, 0xffff0000, v99
    s_waitcnt vmcnt(12)
    buffer_store_dword v10, v8, s[24:27], s92 offen sc1
    s_add_u32 s92, s92, 4
    v_lshlrev_b32 v200, 16, v100
    v_and_b32 v201, 0xffff0000, v100
    v_lshlrev_b32 v202, 16, v101
    v_and_b32 v203, 0xffff0000, v101
    v_lshlrev_b32 v204, 16, v102
    v_and_b32 v205, 0xffff0000, v102
    v_lshlrev_b32 v206, 16, v103
    v_and_b32 v207, 0xffff0000, v103
    v_lshlrev_b32 v208, 16, v104
    v_and_b32 v209, 0xffff0000, v104
    v_lshlrev_b32 v210, 16, v105
    v_and_b32 v211, 0xffff0000, v105
    v_lshlrev_b32 v212, 16, v106
    v_and_b32 v213, 0xffff0000, v106
    v_lshlrev_b32 v214, 16, v107
    v_and_b32 v215, 0xffff0000, v107
    v_lshlrev_b32 v216, 16, v108
    v_and_b32 v217, 0xffff0000, v108
    v_lshlrev_b32 v218, 16, v109
    v_and_b32 v219, 0xffff0000, v109
    v_lshlrev_b32 v220, 16, v110
    v_and_b32 v221, 0xffff0000, v110
    v_lshlrev_b32 v222, 16, v111
    v_and_b32 v223, 0xffff0000, v111
    v_lshlrev_b32 v224, 16, v112
    v_and_b32 v225, 0xffff0000, v112
    v_lshlrev_b32 v226, 16, v113
    v_and_b32 v227, 0xffff0000, v113
    v_lshlrev_b32 v228, 16, v114
    v_and_b32 v229, 0xffff0000, v114
    v_lshlrev_b32 v230, 16, v115
    v_and_b32 v231, 0xffff0000, v115
    v_lshlrev_b32 v232, 16, v116
    v_and_b32 v233, 0xffff0000, v116
    v_lshlrev_b32 v234, 16, v117
    v_and_b32 v235, 0xffff0000, v117
    v_lshlrev_b32 v236, 16, v118
    v_and_b32 v237, 0xffff0000, v118
    v_lshlrev_b32 v238, 16, v119
    v_and_b32 v239, 0xffff0000, v119
    v_lshlrev_b32 v240, 16, v120
    v_and_b32 v241, 0xffff0000, v120
    v_lshlrev_b32 v242, 16, v121
    v_and_b32 v243, 0xffff0000, v121
    v_lshlrev_b32 v244, 16, v122
    v_and_b32 v245, 0xffff0000, v122
    v_lshlrev_b32 v246, 16, v123
    v_and_b32 v247, 0xffff0000, v123
    s_add_u32 s45, s44, 27648
    buffer_load_dwordx4 a[112:115], v2, s[28:31], s45 offen offset:0 sc1
    s_add_u32 s45, s44, 29952
    buffer_load_dwordx4 a[116:119], v2, s[28:31], s45 offen offset:0 sc1
    s_add_u32 s45, s44, 32256
    buffer_load_dwordx4 a[120:123], v2, s[28:31], s45 offen offset:0 sc1
    s_add_u32 s45, s44, 34560
    buffer_load_dwordx4 a[124:127], v2, s[28:31], s45 offen offset:0 sc1
    s_add_u32 s45, s44, 0
    buffer_load_dwordx4 a[160:163], v2, s[28:31], s45 offen offset:768 sc1
    s_add_u32 s45, s44, 2304
    buffer_load_dwordx4 a[164:167], v2, s[28:31], s45 offen offset:768 sc1
    s_add_u32 s45, s44, 4608
    buffer_load_dwordx4 a[168:171], v2, s[28:31], s45 offen offset:768 sc1
    s_add_u32 s45, s44, 6912
    buffer_load_dwordx4 a[172:175], v2, s[28:31], s45 offen offset:768 sc1
    s_add_u32 s45, s44, 9216
    buffer_load_dwordx4 a[176:179], v2, s[28:31], s45 offen offset:768 sc1
    s_add_u32 s45, s44, 11520
    buffer_load_dwordx4 a[180:183], v2, s[28:31], s45 offen offset:768 sc1
    s_add_u32 s45, s44, 13824
    buffer_load_dwordx4 a[184:187], v2, s[28:31], s45 offen offset:768 sc1
    s_add_u32 s45, s44, 16128
    buffer_load_dwordx4 a[188:191], v2, s[28:31], s45 offen offset:768 sc1
    s_add_u32 s45, s44, 18432
    buffer_load_dwordx4 a[192:195], v2, s[28:31], s45 offen offset:768 sc1
    s_add_u32 s45, s44, 20736
    buffer_load_dwordx4 a[196:199], v2, s[28:31], s45 offen offset:768 sc1
    buffer_load_dword v11, v9, s[24:27], s93 offen sc1
    s_add_u32 s45, s44, 23040
    buffer_load_dwordx4 a[200:203], v2, s[28:31], s45 offen offset:768 sc1
    s_add_u32 s45, s44, 25344
    buffer_load_dwordx4 a[204:207], v2, s[28:31], s45 offen offset:768 sc1
    s_add_u32 s45, s44, 27648
    buffer_load_dwordx4 a[208:211], v2, s[28:31], s45 offen offset:768 sc1
    s_add_u32 s45, s44, 29952
    buffer_load_dwordx4 a[212:215], v2, s[28:31], s45 offen offset:768 sc1
    s_add_u32 s45, s44, 32256
    buffer_load_dwordx4 a[216:219], v2, s[28:31], s45 offen offset:768 sc1
    s_add_u32 s45, s44, 34560
    buffer_load_dwordx4 a[220:223], v2, s[28:31], s45 offen offset:768 sc1
    ds_write_b128 v51, a[128:131] offset:0
    ds_write_b128 v51, a[132:135] offset:4096
    ds_write_b128 v51, a[136:139] offset:8192
    ds_write_b128 v51, a[140:143] offset:12288
    ds_write_b128 v51, a[144:147] offset:16384
    ds_write_b128 v51, a[148:151] offset:20480
    ds_write_b128 v51, a[152:155] offset:24576
    ds_write_b128 v51, a[156:159] offset:28672
    ds_write_b128 v51, a[240:243] offset:32768
    ds_write_b128 v51, a[244:247] offset:36864
    ds_write_b128 v51, a[248:251] offset:40960
    ds_write_b128 v51, a[252:255] offset:45056
    ds_write_b128 v51, a[0:3] offset:49152
    ds_write_b128 v51, a[4:7] offset:53248
    ds_write_b128 v51, a[8:11] offset:57344
    ds_write_b128 v51, a[12:15] offset:61440
    ds_write_b128 v255, a[16:19] offset:36864
    ds_write_b128 v255, a[20:23] offset:40960
    ds_write_b128 v255, a[24:27] offset:0
    ds_write_b128 v255, a[28:31] offset:4096
    ds_write_b128 v255, a[32:35] offset:8192
    ds_write_b128 v255, a[36:39] offset:12288
    ds_write_b128 v255, a[40:43] offset:16384
    ds_write_b128 v255, a[44:47] offset:20480
    ds_write_b128 v255, a[48:51] offset:24576
    ds_write_b128 v255, a[52:55] offset:28672
    ds_write_b128 v255, a[56:59] offset:32768
    s_waitcnt vmcnt(33)
    v_mfma_f32_16x16x32_bf16 v[64:67], v[250:253], a[64:67], 0
    v_mfma_f32_16x16x32_bf16 v[68:71], v[248:251], a[64:67], 0
    s_waitcnt vmcnt(32)
    v_mfma_f32_16x16x32_bf16 v[64:67], v[250:253], a[68:71], v[64:67]
    v_mfma_f32_16x16x32_bf16 v[68:71], v[248:251], a[68:71], v[68:71]
    s_waitcnt vmcnt(31)
    v_mfma_f32_16x16x32_bf16 v[64:67], v[250:253], a[72:75], v[64:67]
    v_mfma_f32_16x16x32_bf16 v[68:71], v[248:251], a[72:75], v[68:71]
    s_waitcnt vmcnt(30)
    v_mfma_f32_16x16x32_bf16 v[64:67], v[250:253], a[76:79], v[64:67]
    v_mfma_f32_16x16x32_bf16 v[68:71], v[248:251], a[76:79], v[68:71]
    s_waitcnt vmcnt(29)
    v_mfma_f32_16x16x32_bf16 v[64:67], v[250:253], a[80:83], v[64:67]
    v_mfma_f32_16x16x32_bf16 v[68:71], v[248:251], a[80:83], v[68:71]
    s_waitcnt vmcnt(28)
    v_mfma_f32_16x16x32_bf16 v[64:67], v[250:253], a[84:87], v[64:67]
    v_mfma_f32_16x16x32_bf16 v[68:71], v[248:251], a[84:87], v[68:71]
    s_waitcnt vmcnt(27)
    v_mfma_f32_16x16x32_bf16 v[64:67], v[250:253], a[88:91], v[64:67]
    v_mfma_f32_16x16x32_bf16 v[68:71], v[248:251], a[88:91], v[68:71]
    s_waitcnt vmcnt(26)
    v_mfma_f32_16x16x32_bf16 v[64:67], v[250:253], a[92:95], v[64:67]
    v_mfma_f32_16x16x32_bf16 v[68:71], v[248:251], a[92:95], v[68:71]
    s_waitcnt vmcnt(25)
    v_mfma_f32_16x16x32_bf16 v[64:67], v[250:253], a[96:99], v[64:67]
    v_mfma_f32_16x16x32_bf16 v[68:71], v[248:251], a[96:99], v[68:71]
    s_waitcnt vmcnt(24)
    v_mfma_f32_16x16x32_bf16 v[64:67], v[250:253], a[100:103], v[64:67]
    v_mfma_f32_16x16x32_bf16 v[68:71], v[248:251], a[100:103], v[68:71]
    s_waitcnt vmcnt(23)
    v_mfma_f32_16x16x32_bf16 v[64:67], v[250:253], a[104:107], v[64:67]
    v_mfma_f32_16x16x32_bf16 v[68:71], v[248:251], a[104:107], v[68:71]
    s_waitcnt vmcnt(22)
    v_mfma_f32_16x16x32_bf16 v[64:67], v[250:253], a[108:111], v[64:67]
    v_mfma_f32_16x16x32_bf16 v[68:71], v[248:251], a[108:111], v[68:71]
    s_waitcnt vmcnt(20)
    v_mfma_f32_16x16x32_bf16 v[64:67], v[250:253], a[112:115], v[64:67]
    v_mfma_f32_16x16x32_bf16 v[68:71], v[248:251], a[112:115], v[68:71]
    s_waitcnt vmcnt(19)
    v_mfma_f32_16x16x32_bf16 v[64:67], v[250:253], a[116:119], v[64:67]
    v_mfma_f32_16x16x32_bf16 v[68:71], v[248:251], a[116:119], v[68:71]
    s_waitcnt vmcnt(18)
    v_mfma_f32_16x16x32_bf16 v[64:67], v[250:253], a[120:123], v[64:67]
    v_mfma_f32_16x16x32_bf16 v[68:71], v[248:251], a[120:123], v[68:71]
    s_waitcnt vmcnt(17)
    v_mfma_f32_16x16x32_bf16 v[64:67], v[250:253], a[124:127], v[64:67]
    v_mfma_f32_16x16x32_bf16 v[68:71], v[248:251], a[124:127], v[68:71]
    s_nop 6
    v_pk_fma_f32 v[12:13], v[128:129], v[64:65], v[12:13]
    v_pk_fma_f32 v[14:15], v[130:131], v[66:67], v[14:15]
    v_pk_fma_f32 v[16:17], v[132:133], v[68:69], v[16:17]
    v_pk_fma_f32 v[18:19], v[134:135], v[70:71], v[18:19]
    v_cvt_pk_bf16_f32 v112, v12, v13
    v_cvt_pk_bf16_f32 v113, v14, v15
    v_cvt_pk_bf16_f32 v114, v16, v17
    v_cvt_pk_bf16_f32 v115, v18, v19
    v_lshlrev_b32 v12, 16, v112
    v_and_b32 v13, 0xffff0000, v112
    v_lshlrev_b32 v14, 16, v113
    v_and_b32 v15, 0xffff0000, v113
    v_lshlrev_b32 v16, 16, v114
    v_and_b32 v17, 0xffff0000, v114
    v_lshlrev_b32 v18, 16, v115
    v_and_b32 v19, 0xffff0000, v115
    s_mov_b32 s45, 5242880
    buffer_store_dwordx4 v[112:115], v6, s[24:27], s45 offen offset:0 sc1
    v_pk_add_f32 v[48:49], v[12:13], v[14:15]
    v_pk_add_f32 v[50:51], v[16:17], v[18:19]
    s_waitcnt vmcnt(7)
    v_cmp_ne_u32 s[54:55], s95, v11
    s_cmp_lg_u64 s[54:55], 0
    s_cbranch_scc1 Ltail_spin2
Ltail_got2:
    s_add_u32 s93, s93, 4
    s_add_u32 s45, s44, 0
    s_waitcnt lgkmcnt(14)
    buffer_load_dwordx4 a[0:3], v2, s[28:31], s45 offen offset:1536 sc1
    s_add_u32 s45, s44, 2304
    s_waitcnt lgkmcnt(13)
    buffer_load_dwordx4 a[4:7], v2, s[28:31], s45 offen offset:1536 sc1
    s_add_u32 s45, s44, 4608
    s_waitcnt lgkmcnt(12)
    buffer_load_dwordx4 a[8:11], v2, s[28:31], s45 offen offset:1536 sc1
    s_add_u32 s45, s44, 6912
    s_waitcnt lgkmcnt(11)
    buffer_load_dwordx4 a[12:15], v2, s[28:31], s45 offen offset:1536 sc1
    s_add_u32 s45, s44, 9216
    s_waitcnt lgkmcnt(10)
    buffer_load_dwordx4 a[16:19], v2, s[28:31], s45 offen offset:1536 sc1
    s_add_u32 s45, s44, 11520
    s_waitcnt lgkmcnt(9)
    buffer_load_dwordx4 a[20:23], v2, s[28:31], s45 offen offset:1536 sc1
    s_add_u32 s45, s44, 13824
    s_waitcnt lgkmcnt(8)
    buffer_load_dwordx4 a[24:27], v2, s[28:31], s45 offen offset:1536 sc1
    s_add_u32 s45, s44, 16128
    s_waitcnt lgkmcnt(7)
    buffer_load_dwordx4 a[28:31], v2, s[28:31], s45 offen offset:1536 sc1
    s_add_u32 s45, s44, 18432
    s_waitcnt lgkmcnt(6)
    buffer_load_dwordx4 a[32:35], v2, s[28:31], s45 offen offset:1536 sc1
    s_add_u32 s45, s44, 20736
    s_waitcnt lgkmcnt(5)
    buffer_load_dwordx4 a[36:39], v2, s[28:31], s45 offen offset:1536 sc1
    s_add_u32 s45, s44, 23040
    s_waitcnt lgkmcnt(4)
    buffer_load_dwordx4 a[40:43], v2, s[28:31], s45 offen offset:1536 sc1
    s_add_u32 s45, s44, 25344
    s_waitcnt lgkmcnt(3)
    buffer_load_dwordx4 a[44:47], v2, s[28:31], s45 offen offset:1536 sc1
    s_add_u32 s45, s44, 27648
    s_waitcnt lgkmcnt(2)
    buffer_load_dwordx4 a[48:51], v2, s[28:31], s45 offen offset:1536 sc1
    s_add_u32 s45, s44, 29952
    s_waitcnt lgkmcnt(1)
    buffer_load_dwordx4 a[52:55], v2, s[28:31], s45 offen offset:1536 sc1
    s_add_u32 s45, s44, 32256
    s_waitcnt lgkmcnt(0)
    buffer_load_dwordx4 a[56:59], v2, s[28:31], s45 offen offset:1536 sc1
    s_add_u32 s45, s44, 34560
    buffer_load_dwordx4 a[60:63], v2, s[28:31], s45 offen offset:1536 sc1
    v_mfma_f32_16x16x32_bf16 v[72:75], v[250:253], a[160:163], 0
    v_mfma_f32_16x16x32_bf16 v[76:79], v[248:251], a[160:163], 0
    v_mfma_f32_16x16x32_bf16 v[72:75], v[250:253], a[164:167], v[72:75]
    v_mfma_f32_16x16x32_bf16 v[76:79], v[248:251], a[164:167], v[76:79]
    v_mfma_f32_16x16x32_bf16 v[72:75], v[250:253], a[168:171], v[72:75]
    v_mfma_f32_16x16x32_bf16 v[76:79], v[248:251], a[168:171], v[76:79]
    v_mfma_f32_16x16x32_bf16 v[72:75], v[250:253], a[172:175], v[72:75]
    v_mfma_f32_16x16x32_bf16 v[76:79], v[248:251], a[172:175], v[76:79]
    v_mfma_f32_16x16x32_bf16 v[72:75], v[250:253], a[176:179], v[72:75]
    v_mfma_f32_16x16x32_bf16 v[76:79], v[248:251], a[176:179], v[76:79]
    v_mfma_f32_16x16x32_bf16 v[72:75], v[250:253], a[180:183], v[72:75]
    v_mfma_f32_16x16x32_bf16 v[76:79], v[248:251], a[180:183], v[76:79]
    v_mfma_f32_16x16x32_bf16 v[72:75], v[250:253], a[184:187], v[72:75]
    v_mfma_f32_16x16x32_bf16 v[76:79], v[248:251], a[184:187], v[76:79]
    v_mfma_f32_16x16x32_bf16 v[72:75], v[250:253], a[188:191], v[72:75]
    v_mfma_f32_16x16x32_bf16 v[76:79], v[248:251], a[188:191], v[76:79]
    v_mfma_f32_16x16x32_bf16 v[72:75], v[250:253], a[192:195], v[72:75]
    v_mfma_f32_16x16x32_bf16 v[76:79], v[248:251], a[192:195], v[76:79]
    v_mfma_f32_16x16x32_bf16 v[72:75], v[250:253], a[196:199], v[72:75]
    v_mfma_f32_16x16x32_bf16 v[76:79], v[248:251], a[196:199], v[76:79]
    s_waitcnt vmcnt(22)
    v_mfma_f32_16x16x32_bf16 v[72:75], v[250:253], a[200:203], v[72:75]
    v_mfma_f32_16x16x32_bf16 v[76:79], v[248:251], a[200:203], v[76:79]
    s_waitcnt vmcnt(21)
    v_mfma_f32_16x16x32_bf16 v[72:75], v[250:253], a[204:207], v[72:75]
    v_mfma_f32_16x16x32_bf16 v[76:79], v[248:251], a[204:207], v[76:79]
    s_waitcnt vmcnt(20)
    v_mfma_f32_16x16x32_bf16 v[72:75], v[250:253], a[208:211], v[72:75]
    v_mfma_f32_16x16x32_bf16 v[76:79], v[248:251], a[208:211], v[76:79]
    s_waitcnt vmcnt(19)
    v_mfma_f32_16x16x32_bf16 v[72:75], v[250:253], a[212:215], v[72:75]
    v_mfma_f32_16x16x32_bf16 v[76:79], v[248:251], a[212:215], v[76:79]
    s_waitcnt vmcnt(18)
    v_mfma_f32_16x16x32_bf16 v[72:75], v[250:253], a[216:219], v[72:75]
    v_mfma_f32_16x16x32_bf16 v[76:79], v[248:251], a[216:219], v[76:79]
    s_waitcnt vmcnt(17)
    v_mfma_f32_16x16x32_bf16 v[72:75], v[250:253], a[220:223], v[72:75]
    v_mfma_f32_16x16x32_bf16 v[76:79], v[248:251], a[220:223], v[76:79]
    s_waitcnt vmcnt(15)
    s_nop 5
    v_pk_fma_f32 v[20:21], v[136:137], v[72:73], v[20:21]
    v_pk_fma_f32 v[22:23], v[138:139], v[74:75], v[22:23]
    v_pk_fma_f32 v[24:25], v[140:141], v[76:77], v[24:25]
    v_pk_fma_f32 v[26:27], v[142:143], v[78:79], v[26:27]
    v_cvt_pk_bf16_f32 v116, v20, v21
    v_cvt_pk_bf16_f32 v117, v22, v23
    v_cvt_pk_bf16_f32 v118, v24, v25
    v_cvt_pk_bf16_f32 v119, v26, v27
    v_lshlrev_b32 v20, 16, v116
    v_and_b32 v21, 0xffff0000, v116
    v_lshlrev_b32 v22, 16, v117
    v_and_b32 v23, 0xffff0000, v117
    v_lshlrev_b32 v24, 16, v118
    v_and_b32 v25, 0xffff0000, v118
    v_lshlrev_b32 v26, 16, v119
    v_and_b32 v27, 0xffff0000, v119
    s_mov_b32 s45, 5242880
    buffer_store_dwordx4 v[116:119], v6, s[24:27], s45 offen offset:384 sc1
    v_pk_add_f32 v[48:49], v[48:49], v[20:21]
    v_pk_add_f32 v[50:51], v[50:51], v[22:23]
    v_pk_add_f32 v[48:49], v[48:49], v[24:25]
    v_pk_add_f32 v[50:51], v[50:51], v[26:27]
    v_mfma_f32_16x16x32_bf16 v[80:83], v[250:253], a[0:3], 0
    v_mfma_f32_16x16x32_bf16 v[84:87], v[248:251], a[0:3], 0
    s_waitcnt vmcnt(15)
    v_mfma_f32_16x16x32_bf16 v[80:83], v[250:253], a[4:7], v[80:83]
    v_mfma_f32_16x16x32_bf16 v[84:87], v[248:251], a[4:7], v[84:87]
    s_waitcnt vmcnt(14)
    v_mfma_f32_16x16x32_bf16 v[80:83], v[250:253], a[8:11], v[80:83]
    v_mfma_f32_16x16x32_bf16 v[84:87], v[248:251], a[8:11], v[84:87]
    s_waitcnt vmcnt(13)
    v_mfma_f32_16x16x32_bf16 v[80:83], v[250:253], a[12:15], v[80:83]
    v_mfma_f32_16x16x32_bf16 v[84:87], v[248:251], a[12:15], v[84:87]
    s_waitcnt vmcnt(12)
    v_mfma_f32_16x16x32_bf16 v[80:83], v[250:253], a[16:19], v[80:83]
    v_mfma_f32_16x16x32_bf16 v[84:87], v[248:251], a[16:19], v[84:87]
    s_waitcnt vmcnt(11)
    v_mfma_f32_16x16x32_bf16 v[80:83], v[250:253], a[20:23], v[80:83]
    v_mfma_f32_16x16x32_bf16 v[84:87], v[248:251], a[20:23], v[84:87]
    s_waitcnt vmcnt(10)
    v_mfma_f32_16x16x32_bf16 v[80:83], v[250:253], a[24:27], v[80:83]
    v_mfma_f32_16x16x32_bf16 v[84:87], v[248:251], a[24:27], v[84:87]
    s_waitcnt vmcnt(9)
    v_mfma_f32_16x16x32_bf16 v[80:83], v[250:253], a[28:31], v[80:83]
    v_mfma_f32_16x16x32_bf16 v[84:87], v[248:251], a[28:31], v[84:87]
    s_waitcnt vmcnt(8)
    v_mfma_f32_16x16x32_bf16 v[80:83], v[250:253], a[32:35], v[80:83]
    v_mfma_f32_16x16x32_bf16 v[84:87], v[248:251], a[32:35], v[84:87]
    s_waitcnt vmcnt(7)
    v_mfma_f32_16x16x32_bf16 v[80:83], v[250:253], a[36:39], v[80:83]
    v_mfma_f32_16x16x32_bf16 v[84:87], v[248:251], a[36:39], v[84:87]
    s_waitcnt vmcnt(6)
    v_mfma_f32_16x16x32_bf16 v[80:83], v[250:253], a[40:43], v[80:83]
    v_mfma_f32_16x16x32_bf16 v[84:87], v[248:251], a[40:43], v[84:87]
    s_waitcnt vmcnt(5)
    v_mfma_f32_16x16x32_bf16 v[80:83], v[250:253], a[44:47], v[80:83]
    v_mfma_f32_16x16x32_bf16 v[84:87], v[248:251], a[44:47], v[84:87]
    s_waitcnt vmcnt(4)
    v_mfma_f32_16x16x32_bf16 v[80:83], v[250:253], a[48:51], v[80:83]
    v_mfma_f32_16x16x32_bf16 v[84:87], v[248:251], a[48:51], v[84:87]
    s_waitcnt vmcnt(3)
    v_mfma_f32_16x16x32_bf16 v[80:83], v[250:253], a[52:55], v[80:83]
    v_mfma_f32_16x16x32_bf16 v[84:87], v[248:251], a[52:55], v[84:87]
    s_waitcnt vmcnt(2)
    v_mfma_f32_16x16x32_bf16 v[80:83], v[250:253], a[56:59], v[80:83]
    v_mfma_f32_16x16x32_bf16 v[84:87], v[248:251], a[56:59], v[84:87]
    s_waitcnt vmcnt(1)
    v_mfma_f32_16x16x32_bf16 v[80:83], v[250:253], a[60:63], v[80:83]
    v_mfma_f32_16x16x32_bf16 v[84:87], v[248:251], a[60:63], v[84:87]
    s_nop 6
    v_pk_fma_f32 v[28:29], v[144:145], v[80:81], v[28:29]
    v_pk_fma_f32 v[30:31], v[146:147], v[82:83], v[30:31]
    v_pk_fma_f32 v[32:33], v[148:149], v[84:85], v[32:33]
    v_pk_fma_f32 v[34:35], v[150:151], v[86:87], v[34:35]
    v_cvt_pk_bf16_f32 v120, v28, v29
    v_cvt_pk_bf16_f32 v121, v30, v31
    v_cvt_pk_bf16_f32 v122, v32, v33
    v_cvt_pk_bf16_f32 v123, v34, v35
    v_lshlrev_b32 v28, 16, v120
    v_and_b32 v29, 0xffff0000, v120
    v_lshlrev_b32 v30, 16, v121
    v_and_b32 v31, 0xffff0000, v121
    v_lshlrev_b32 v32, 16, v122
    v_and_b32 v33, 0xffff0000, v122
    v_lshlrev_b32 v34, 16, v123
    v_and_b32 v35, 0xffff0000, v123
    s_mov_b32 s45, 5242880
    buffer_store_dwordx4 v[120:123], v6, s[24:27], s45 offen offset:768 sc1
    v_pk_add_f32 v[48:49], v[48:49], v[28:29]
    v_pk_add_f32 v[50:51], v[50:51], v[30:31]
    v_pk_add_f32 v[48:49], v[48:49], v[32:33]
    v_pk_add_f32 v[50:51], v[50:51], v[34:35]
    v_pk_add_f32 v[48:49], v[48:49], v[50:51]
    v_add_f32 v48, v48, v49
    s_nop 1
    v_add_f32_dpp v48, v48, v48 row_ror:1 row_mask:0xf bank_mask:0xf
    s_nop 1
    v_add_f32_dpp v48, v48, v48 row_ror:2 row_mask:0xf bank_mask:0xf
    s_nop 1
    v_add_f32_dpp v48, v48, v48 row_ror:4 row_mask:0xf bank_mask:0xf
    s_nop 1
    v_add_f32_dpp v48, v48, v48 row_ror:8 row_mask:0xf bank_mask:0xf
    v_mov_b32 v52, v48
    s_nop 1
    v_permlane16_swap_b32 v48, v52
    s_nop 0
    v_add_f32 v48, v48, v52
    v_mul_f32 v48, 0x3ae38e39, v48
    v_pk_add_f32 v[88:89], v[12:13], v[48:49] op_sel_hi:[1,0] neg_lo:[0,1] neg_hi:[0,1]
    v_pk_add_f32 v[90:91], v[14:15], v[48:49] op_sel_hi:[1,0] neg_lo:[0,1] neg_hi:[0,1]
    v_pk_add_f32 v[92:93], v[16:17], v[48:49] op_sel_hi:[1,0] neg_lo:[0,1] neg_hi:[0,1]
    v_pk_add_f32 v[94:95], v[18:19], v[48:49] op_sel_hi:[1,0] neg_lo:[0,1] neg_hi:[0,1]
    v_pk_add_f32 v[96:97], v[20:21], v[48:49] op_sel_hi:[1,0] neg_lo:[0,1] neg_hi:[0,1]
    v_pk_add_f32 v[98:99], v[22:23], v[48:49] op_sel_hi:[1,0] neg_lo:[0,1] neg_hi:[0,1]
    v_pk_add_f32 v[100:101], v[24:25], v[48:49] op_sel_hi:[1,0] neg_lo:[0,1] neg_hi:[0,1]
    v_pk_add_f32 v[102:103], v[26:27], v[48:49] op_sel_hi:[1,0] neg_lo:[0,1] neg_hi:[0,1]
    v_pk_add_f32 v[104:105], v[28:29], v[48:49] op_sel_hi:[1,0] neg_lo:[0,1] neg_hi:[0,1]
    v_pk_add_f32 v[106:107], v[30:31], v[48:49] op_sel_hi:[1,0] neg_lo:[0,1] neg_hi:[0,1]
    v_pk_add_f32 v[108:109], v[32:33], v[48:49] op_sel_hi:[1,0] neg_lo:[0,1] neg_hi:[0,1]
    v_pk_add_f32 v[110:111], v[34:35], v[48:49] op_sel_hi:[1,0] neg_lo:[0,1] neg_hi:[0,1]
    v_pk_mul_f32 v[50:51], v[88:89], v[88:89]
    v_pk_mul_f32 v[52:53], v[90:91], v[90:91]
    v_pk_fma_f32 v[50:51], v[92:93], v[92:93], v[50:51]
    v_pk_fma_f32 v[52:53], v[94:95], v[94:95], v[52:53]
    v_pk_fma_f32 v[50:51], v[96:97], v[96:97], v[50:51]
    v_pk_fma_f32 v[52:53], v[98:99], v[98:99], v[52:53]
    v_pk_fma_f32 v[50:51], v[100:101], v[100:101], v[50:51]
    v_pk_fma_f32 v[52:53], v[102:103], v[102:103], v[52:53]
    v_pk_fma_f32 v[50:51], v[104:105], v[104:105], v[50:51]
    v_pk_fma_f32 v[52:53], v[106:107], v[106:107], v[52:53]
    v_pk_fma_f32 v[50:51], v[108:109], v[108:109], v[50:51]
    v_pk_fma_f32 v[52:53], v[110:111], v[110:111], v[52:53]
    v_pk_add_f32 v[50:51], v[50:51], v[52:53]
    v_add_f32 v50, v50, v51
    v_cndmask_b32 v50, 0, v50, vcc
    s_nop 1
    v_add_f32_dpp v50, v50, v50 row_ror:1 row_mask:0xf bank_mask:0xf
    s_nop 1
    v_add_f32_dpp v50, v50, v50 row_ror:2 row_mask:0xf bank_mask:0xf
    s_nop 1
    v_add_f32_dpp v50, v50, v50 row_ror:4 row_mask:0xf bank_mask:0xf
    s_nop 1
    v_add_f32_dpp v50, v50, v50 row_ror:8 row_mask:0xf bank_mask:0xf
    v_mov_b32 v52, v50
    s_nop 1
    v_permlane16_swap_b32 v50, v52
    s_nop 0
    v_add_f32 v50, v50, v52
    v_mul_f32 v50, 0x3ae38e39, v50
    v_cvt_pk_bf16_f32 v52, v48, v50
    v_and_b32 v50, 0xffff0000, v52
    v_lshlrev_b32 v52, 16, v52
    v_add_f32 v50, 0x3727c5ac, v50
    v_sub_f32 v48, v48, v52
    v_cvt_pk_bf16_f32 v50, v50, v50
    v_and_b32 v50, 0xffff0000, v50
    v_sqrt_f32 v50, v50
    s_nop 0
    v_cvt_pk_bf16_f32 v50, v50, v50
    v_and_b32 v50, 0xffff0000, v50
    v_rcp_f32 v50, v50
    s_mov_b32 s45, 2621440
    v_mul_f32 v48, v48, v50
    v_pk_fma_f32 v[88:89], v[88:89], v[50:51], v[48:49] op_sel_hi:[1,0,0]
    v_pk_fma_f32 v[90:91], v[90:91], v[50:51], v[48:49] op_sel_hi:[1,0,0]
    v_pk_fma_f32 v[92:93], v[92:93], v[50:51], v[48:49] op_sel_hi:[1,0,0]
    v_pk_fma_f32 v[94:95], v[94:95], v[50:51], v[48:49] op_sel_hi:[1,0,0]
    v_pk_fma_f32 v[96:97], v[96:97], v[50:51], v[48:49] op_sel_hi:[1,0,0]
    v_pk_fma_f32 v[98:99], v[98:99], v[50:51], v[48:49] op_sel_hi:[1,0,0]
    v_pk_fma_f32 v[100:101], v[100:101], v[50:51], v[48:49] op_sel_hi:[1,0,0]
    v_pk_fma_f32 v[102:103], v[102:103], v[50:51], v[48:49] op_sel_hi:[1,0,0]
    v_pk_fma_f32 v[104:105], v[104:105], v[50:51], v[48:49] op_sel_hi:[1,0,0]
    v_pk_fma_f32 v[106:107], v[106:107], v[50:51], v[48:49] op_sel_hi:[1,0,0]
    v_pk_fma_f32 v[108:109], v[108:109], v[50:51], v[48:49] op_sel_hi:[1,0,0]
    v_pk_fma_f32 v[110:111], v[110:111], v[50:51], v[48:49] op_sel_hi:[1,0,0]
    v_pk_fma_f32 v[88:89], v[88:89], v[152:153], v[176:177]
    v_pk_fma_f32 v[90:91], v[90:91], v[154:155], v[178:179]
    v_pk_fma_f32 v[92:93], v[92:93], v[156:157], v[180:181]
    v_pk_fma_f32 v[94:95], v[94:95], v[158:159], v[182:183]
    v_pk_fma_f32 v[96:97], v[96:97], v[160:161], v[184:185]
    v_pk_fma_f32 v[98:99], v[98:99], v[162:163], v[186:187]
    v_pk_fma_f32 v[100:101], v[100:101], v[164:165], v[188:189]
    v_pk_fma_f32 v[102:103], v[102:103], v[166:167], v[190:191]
    v_pk_fma_f32 v[104:105], v[104:105], v[168:169], v[192:193]
    v_pk_fma_f32 v[106:107], v[106:107], v[170:171], v[194:195]
    v_pk_fma_f32 v[108:109], v[108:109], v[172:173], v[196:197]
    v_pk_fma_f32 v[110:111], v[110:111], v[174:175], v[198:199]
    v_cvt_pk_bf16_f32 v36, v88, v89
    v_cvt_pk_bf16_f32 v37, v90, v91
    v_cvt_pk_bf16_f32 v38, v92, v93
    v_cvt_pk_bf16_f32 v39, v94, v95
    v_cvt_pk_bf16_f32 v40, v96, v97
    v_cvt_pk_bf16_f32 v41, v98, v99
    v_cvt_pk_bf16_f32 v42, v100, v101
    v_cvt_pk_bf16_f32 v43, v102, v103
    v_cvt_pk_bf16_f32 v44, v104, v105
    v_cvt_pk_bf16_f32 v45, v106, v107
    v_cvt_pk_bf16_f32 v46, v108, v109
    v_cvt_pk_bf16_f32 v47, v110, v111
    buffer_store_dwordx4 v[36:39], v6, s[24:27], s45 offen offset:0 sc1
    buffer_store_dwordx4 v[40:43], v6, s[24:27], s45 offen offset:384 sc1
    buffer_store_dwordx4 v[44:47], v6, s[24:27], s45 offen offset:768 sc1
    v_lshlrev_b32 v88, 16, v36
    v_and_b32 v89, 0xffff0000, v36
    v_lshlrev_b32 v90, 16, v37
    v_and_b32 v91, 0xffff0000, v37
    v_lshlrev_b32 v92, 16, v38
    v_and_b32 v93, 0xffff0000, v38
    v_lshlrev_b32 v94, 16, v39
    v_and_b32 v95, 0xffff0000, v39
    v_lshlrev_b32 v96, 16, v40
    v_and_b32 v97, 0xffff0000, v40
    v_lshlrev_b32 v98, 16, v41
    v_and_b32 v99, 0xffff0000, v41
    v_lshlrev_b32 v100, 16, v42
    v_and_b32 v101, 0xffff0000, v42
    v_lshlrev_b32 v102, 16, v43
    v_and_b32 v103, 0xffff0000, v43
    v_lshlrev_b32 v104, 16, v44
    v_and_b32 v105, 0xffff0000, v44
    v_lshlrev_b32 v106, 16, v45
    v_and_b32 v107, 0xffff0000, v45
    v_lshlrev_b32 v108, 16, v46
    v_and_b32 v109, 0xffff0000, v46
    v_lshlrev_b32 v110, 16, v47
    v_and_b32 v111, 0xffff0000, v47
    v_pk_mul_f32 v[50:51], v[88:89], v[200:201]
    v_pk_mul_f32 v[52:53], v[90:91], v[202:203]
    v_pk_fma_f32 v[50:51], v[92:93], v[204:205], v[50:51]
    v_pk_fma_f32 v[52:53], v[94:95], v[206:207], v[52:53]
    v_pk_fma_f32 v[50:51], v[96:97], v[208:209], v[50:51]
    v_pk_fma_f32 v[52:53], v[98:99], v[210:211], v[52:53]
    v_pk_fma_f32 v[50:51], v[100:101], v[212:213], v[50:51]
    v_pk_fma_f32 v[52:53], v[102:103], v[214:215], v[52:53]
    v_pk_fma_f32 v[50:51], v[104:105], v[216:217], v[50:51]
    v_pk_fma_f32 v[52:53], v[106:107], v[218:219], v[52:53]
    v_pk_fma_f32 v[50:51], v[108:109], v[220:221], v[50:51]
    v_pk_fma_f32 v[52:53], v[110:111], v[222:223], v[52:53]
    v_pk_add_f32 v[50:51], v[50:51], v[52:53]
    v_add_f32 v50, v50, v51
    v_lshlrev_b32 v48, 2, v7
    v_and_b32 v48, 28, v48
    v_sub_u32 v49, 2047, v7
    v_add_f32_dpp v50, v50, v50 row_ror:1 row_mask:0xf bank_mask:0xf
    s_nop 1
    v_add_f32_dpp v50, v50, v50 row_ror:2 row_mask:0xf bank_mask:0xf
    s_nop 1
    v_add_f32_dpp v50, v50, v50 row_ror:4 row_mask:0xf bank_mask:0xf
    s_nop 1
    v_add_f32_dpp v50, v50, v50 row_ror:8 row_mask:0xf bank_mask:0xf
    v_mov_b32 v52, v50
    s_nop 1
    v_permlane16_swap_b32 v50, v52
    s_nop 0
    v_add_f32 v50, v50, v52
    v_ashrrev_i32 v52, 31, v50
    v_or_b32 v52, 0x80000000, v52
    v_xor_b32 v52, v52, v50
    v_and_b32 v52, 0xfffff800, v52
    v_min_u32 v52, 0xfffff000, v52
    v_or_b32 v52, v52, v49
    s_mov_b32 exec_lo, 1
    s_mov_b32 exec_hi, 1
    ds_write_b32 v48, v52 offset:53248
    s_mov_b64 exec, -1
    s_waitcnt lgkmcnt(0)
    s_barrier
    s_cmp_lg_u32 s3, 0
    s_cbranch_scc1 Ltail_notw0
    v_mov_b32 v141, 53248
    ds_read_b128 v[128:131], v141
    ds_read_b128 v[132:135], v141 offset:16
    s_lshl_b32 s45, s2, 7
    s_add_u32 s45, s45, 8912896
    s_waitcnt lgkmcnt(1)
    v_max_u32 v136, v128, v129
    v_min_u32 v137, v128, v129
    v_med3_u32 v137, v136, v137, v130
    v_max_u32 v136, v136, v130
    v_med3_u32 v137, v136, v137, v131
    v_max_u32 v136, v136, v131
    s_waitcnt lgkmcnt(0)
    v_med3_u32 v137, v136, v137, v132
    v_max_u32 v136, v136, v132
    v_med3_u32 v137, v136, v137, v133
    v_max_u32 v136, v136, v133
    v_med3_u32 v137, v136, v137, v134
    v_max_u32 v136, v136, v134
    v_med3_u32 v137, v136, v137, v135
    v_max_u32 v136, v136, v135
    buffer_store_dwordx2 v[136:137], v8, s[24:27], s45 offen sc1
Ltail_notw0:
    v_pk_mul_f32 v[224:225], v[224:225], v[88:89]
    v_pk_mul_f32 v[226:227], v[226:227], v[90:91]
    v_pk_mul_f32 v[228:229], v[228:229], v[92:93]
    v_pk_mul_f32 v[230:231], v[230:231], v[94:95]
    v_pk_mul_f32 v[232:233], v[232:233], v[96:97]
    v_pk_mul_f32 v[234:235], v[234:235], v[98:99]
    v_pk_mul_f32 v[236:237], v[236:237], v[100:101]
    v_pk_mul_f32 v[238:239], v[238:239], v[102:103]
    v_pk_mul_f32 v[240:241], v[240:241], v[104:105]
    v_pk_mul_f32 v[242:243], v[242:243], v[106:107]
    v_pk_mul_f32 v[244:245], v[244:245], v[108:109]
    v_pk_mul_f32 v[246:247], v[246:247], v[110:111]
    v_cvt_pk_bf16_f32 v208, v224, v225
    v_cvt_pk_bf16_f32 v209, v226, v227
    v_cvt_pk_bf16_f32 v210, v228, v229
    v_cvt_pk_bf16_f32 v211, v230, v231
    v_cvt_pk_bf16_f32 v212, v232, v233
    v_cvt_pk_bf16_f32 v213, v234, v235
    v_cvt_pk_bf16_f32 v214, v236, v237
    v_cvt_pk_bf16_f32 v215, v238, v239
    v_cvt_pk_bf16_f32 v216, v240, v241
    v_cvt_pk_bf16_f32 v217, v242, v243
    v_cvt_pk_bf16_f32 v218, v244, v245
    v_cvt_pk_bf16_f32 v219, v246, v247
    v_lshlrev_b32 v224, 16, v208
    v_and_b32 v225, 0xffff0000, v208
    v_lshlrev_b32 v226, 16, v209
    v_and_b32 v227, 0xffff0000, v209
    v_lshlrev_b32 v228, 16, v210
    v_and_b32 v229, 0xffff0000, v210
    v_lshlrev_b32 v230, 16, v211
    v_and_b32 v231, 0xffff0000, v211
    v_lshlrev_b32 v232, 16, v212
    v_and_b32 v233, 0xffff0000, v212
    v_lshlrev_b32 v234, 16, v213
    v_and_b32 v235, 0xffff0000, v213
    v_lshlrev_b32 v236, 16, v214
    v_and_b32 v237, 0xffff0000, v214
    v_lshlrev_b32 v238, 16, v215
    v_and_b32 v239, 0xffff0000, v215
    v_lshlrev_b32 v240, 16, v216
    v_and_b32 v241, 0xffff0000, v216
    v_lshlrev_b32 v242, 16, v217
    v_and_b32 v243, 0xffff0000, v217
    v_lshlrev_b32 v244, 16, v218
    v_and_b32 v245, 0xffff0000, v218
    v_lshlrev_b32 v246, 16, v219
    v_and_b32 v247, 0xffff0000, v219
    v_pk_add_f32 v[224:225], v[224:225], v[12:13]
    v_pk_add_f32 v[226:227], v[226:227], v[14:15]
    v_pk_add_f32 v[228:229], v[228:229], v[16:17]
    v_pk_add_f32 v[230:231], v[230:231], v[18:19]
    v_pk_add_f32 v[232:233], v[232:233], v[20:21]
    v_pk_add_f32 v[234:235], v[234:235], v[22:23]
    v_pk_add_f32 v[236:237], v[236:237], v[24:25]
    v_pk_add_f32 v[238:239], v[238:239], v[26:27]
    v_pk_add_f32 v[240:241], v[240:241], v[28:29]
    v_pk_add_f32 v[242:243], v[242:243], v[30:31]
    v_pk_add_f32 v[244:245], v[244:245], v[32:33]
    v_pk_add_f32 v[246:247], v[246:247], v[34:35]
    v_cvt_pk_bf16_f32 v208, v224, v225
    v_cvt_pk_bf16_f32 v209, v226, v227
    v_cvt_pk_bf16_f32 v210, v228, v229
    v_cvt_pk_bf16_f32 v211, v230, v231
    v_cvt_pk_bf16_f32 v212, v232, v233
    v_cvt_pk_bf16_f32 v213, v234, v235
    v_cvt_pk_bf16_f32 v214, v236, v237
    v_cvt_pk_bf16_f32 v215, v238, v239
    v_cvt_pk_bf16_f32 v216, v240, v241
    v_cvt_pk_bf16_f32 v217, v242, v243
    v_cvt_pk_bf16_f32 v218, v244, v245
    v_cvt_pk_bf16_f32 v219, v246, v247
    s_mov_b32 s38, 135168
    s_mov_b32 s39, 8192
    v_lshrrev_b32 v9, 2, v1
    v_and_b32 v10, 3, v1
    v_lshlrev_b32 v10, 3, v10
    s_and_b32 s45, s3, 1
    s_lshl_b32 s45, s45, 5
    v_lshl_add_u32 v11, v9, 6, v10
    v_add_u32 v11, s45, v11
    s_cmp_lt_u32 s3, 2
    s_cselect_b32 s44, 98304, s38
    s_cselect_b32 s45, 98304, s39
    v_add_u32 v12, s45, v11
    v_add_u32 v11, s44, v11
    ds_read_b64_tr_b16 a[0:1], v11 offset:0
    ds_read_b64_tr_b16 a[2:3], v11 offset:1024
    ds_read_b64_tr_b16 a[4:5], v11 offset:2048
    ds_read_b64_tr_b16 a[6:7], v11 offset:3072
    ds_read_b64_tr_b16 a[8:9], v11 offset:4096
    ds_read_b64_tr_b16 a[10:11], v11 offset:5120
    ds_read_b64_tr_b16 a[12:13], v11 offset:6144
    ds_read_b64_tr_b16 a[14:15], v11 offset:7168
    ds_read_b64_tr_b16 a[16:17], v11 offset:8192
    ds_read_b64_tr_b16 a[18:19], v11 offset:9216
    ds_read_b64_tr_b16 a[20:21], v11 offset:10240
    ds_read_b64_tr_b16 a[22:23], v11 offset:11264
    ds_read_b64_tr_b16 a[24:25], v11 offset:12288
    ds_read_b64_tr_b16 a[26:27], v11 offset:13312
    ds_read_b64_tr_b16 a[28:29], v11 offset:14336
    ds_read_b64_tr_b16 a[30:31], v11 offset:15360
    ds_read_b64_tr_b16 a[32:33], v11 offset:16384
    ds_read_b64_tr_b16 a[34:35], v11 offset:17408
    ds_read_b64_tr_b16 a[36:37], v11 offset:18432
    ds_read_b64_tr_b16 a[38:39], v11 offset:19456
    ds_read_b64_tr_b16 a[40:41], v11 offset:20480
    ds_read_b64_tr_b16 a[42:43], v11 offset:21504
    ds_read_b64_tr_b16 a[44:45], v11 offset:22528
    ds_read_b64_tr_b16 a[46:47], v11 offset:23552
    ds_read_b64_tr_b16 a[48:49], v11 offset:24576
    ds_read_b64_tr_b16 a[50:51], v11 offset:25600
    ds_read_b64_tr_b16 a[52:53], v11 offset:26624
    ds_read_b64_tr_b16 a[54:55], v11 offset:27648
    ds_read_b64_tr_b16 a[56:57], v12 offset:28672
    ds_read_b64_tr_b16 a[58:59], v12 offset:29696
    ds_read_b64_tr_b16 a[60:61], v12 offset:30720
    ds_read_b64_tr_b16 a[62:63], v12 offset:31744
    ds_read_b64_tr_b16 a[64:65], v12 offset:32768
    ds_read_b64_tr_b16 a[66:67], v12 offset:33792
    ds_read_b64_tr_b16 a[68:69], v12 offset:34816
    ds_read_b64_tr_b16 a[70:71], v12 offset:35840
    v_mul_u32_u24 v12, 1152, v9
    s_lshl_b32 s44, s3, 7
    s_add_u32 s44, s44, 0
    v_add3_u32 v12, v12, v10, s44
    ds_read_b64_tr_b16 a[72:73], v12 offset:0
    ds_read_b64_tr_b16 a[74:75], v12 offset:18432
    ds_read_b64_tr_b16 a[76:77], v12 offset:32
    ds_read_b64_tr_b16 a[78:79], v12 offset:18464
    ds_read_b64_tr_b16 a[80:81], v12 offset:64
    ds_read_b64_tr_b16 a[82:83], v12 offset:18496
    ds_read_b64_tr_b16 a[84:85], v12 offset:96
    ds_read_b64_tr_b16 a[86:87], v12 offset:18528
    ds_read_b64_tr_b16 a[88:89], v12 offset:512
    ds_read_b64_tr_b16 a[90:91], v12 offset:18944
    ds_read_b64_tr_b16 a[92:93], v12 offset:544
    ds_read_b64_tr_b16 a[94:95], v12 offset:18976
    ds_read_b64_tr_b16 a[96:97], v12 offset:576
    ds_read_b64_tr_b16 a[98:99], v12 offset:19008
    ds_read_b64_tr_b16 a[100:101], v12 offset:608
    ds_read_b64_tr_b16 a[102:103], v12 offset:19040
    ds_read_b64_tr_b16 a[104:105], v12 offset:1024
    ds_read_b64_tr_b16 a[106:107], v12 offset:19456
    ds_read_b64_tr_b16 a[108:109], v12 offset:1056
    ds_read_b64_tr_b16 a[110:111], v12 offset:19488
    ds_read_b64_tr_b16 a[112:113], v12 offset:1088
    ds_read_b64_tr_b16 a[114:115], v12 offset:19520
    ds_read_b64_tr_b16 a[116:117], v12 offset:1120
    ds_read_b64_tr_b16 a[118:119], v12 offset:19552
    v_lshlrev_b32 v13, 4, v1
    v_add_u32 v13, 49152, v13
    s_lshl_b32 s44, s3, 10
    v_add_u32 v14, s44, v13
    v_bfe_u32 v15, v1, 2, 2
    v_cmp_eq_u32 s[52:53], 0, v15
    v_cmp_eq_u32 s[54:55], 1, v15
    v_cmp_eq_u32 s[56:57], 2, v15
    v_cmp_eq_u32 s[58:59], 3, v15
    s_mul_i32 s43, s42, 18
    s_add_u32 s43, s43, s41
    s_lshl_b32 s43, s43, 9
    s_mul_i32 s44, s3, 73728
    s_add_u32 s43, s43, s44
    v_lshlrev_b32 v15, 3, v1
    v_lshlrev_b32 v140, 7, v0
    s_mov_b32 s45, 8912896
    s_lshl_b32 s36, s3, 3
    v_mov_b32 v141, s36
    s_mov_b32 s48, 16384
Ltail_pollk:
    buffer_load_dwordx2 v[136:137], v140, s[24:27], s45 offen sc1
    s_sub_u32 s48, s48, 1
    s_cbranch_scc1 Ltail_gotk
    s_waitcnt vmcnt(0)
    v_max_u32 v138, v136, v137
    v_cmp_eq_u32 vcc, -1, v138
    s_cbranch_vccnz Ltail_pollk
Ltail_gotk:
    s_waitcnt vmcnt(0)
    v_mov_b32_dpp v138, v136 row_ror:1 row_mask:0xf bank_mask:0xf
    v_mov_b32_dpp v139, v137 row_ror:1 row_mask:0xf bank_mask:0xf
    v_min_u32 v142, v136, v138
    v_max_u32 v136, v136, v138
    v_max3_u32 v137, v142, v137, v139
    s_nop 0
    v_mov_b32_dpp v138, v136 row_ror:2 row_mask:0xf bank_mask:0xf
    v_mov_b32_dpp v139, v137 row_ror:2 row_mask:0xf bank_mask:0xf
    v_min_u32 v142, v136, v138
    v_max_u32 v136, v136, v138
    v_max3_u32 v137, v142, v137, v139
    s_nop 0
    v_mov_b32_dpp v138, v136 row_ror:4 row_mask:0xf bank_mask:0xf
    v_mov_b32_dpp v139, v137 row_ror:4 row_mask:0xf bank_mask:0xf
    v_min_u32 v142, v136, v138
    v_max_u32 v136, v136, v138
    v_max3_u32 v137, v142, v137, v139
    s_nop 0
    v_mov_b32_dpp v138, v136 row_ror:8 row_mask:0xf bank_mask:0xf
    v_mov_b32_dpp v139, v137 row_ror:8 row_mask:0xf bank_mask:0xf
    v_min_u32 v142, v136, v138
    v_max_u32 v136, v136, v138
    v_max3_u32 v137, v142, v137, v139
    v_mov_b32 v138, v136
    v_mov_b32 v139, v137
    s_nop 0
    v_permlane16_swap_b32 v136, v138
    v_permlane16_swap_b32 v137, v139
    v_min_u32 v142, v136, v138
    v_max_u32 v136, v136, v138
    v_max3_u32 v137, v142, v137, v139
    v_mov_b32 v138, v136
    v_mov_b32 v139, v137
    s_nop 0
    v_permlane32_swap_b32 v136, v138
    v_permlane32_swap_b32 v137, v139
    v_min_u32 v142, v136, v138
    v_max_u32 v136, v136, v138
    v_max3_u32 v137, v142, v137, v139
    ds_write_b64 v141, v[136:137] offset:53312
    v_mov_b32 v141, 53312
    s_waitcnt lgkmcnt(0)
    s_barrier
    ds_read_b128 v[128:131], v141
    ds_read_b128 v[132:135], v141 offset:16
    s_or_b32 s36, s2, s3
    s_cselect_b32 s45, -4, 24576
    s_add_u32 s36, s94, 1
    v_mov_b32 v138, s36
    buffer_store_dword v138, v8, s[24:27], s45 offen
    s_waitcnt lgkmcnt(1)
    v_max_u32 v136, v128, v129
    v_min_u32 v137, v128, v129
    v_med3_u32 v137, v136, v137, v130
    v_max_u32 v136, v136, v130
    v_med3_u32 v137, v136, v137, v131
    v_max_u32 v136, v136, v131
    s_waitcnt lgkmcnt(0)
    v_med3_u32 v137, v136, v137, v132
    v_max_u32 v136, v136, v132
    v_med3_u32 v137, v136, v137, v133
    v_max_u32 v136, v136, v133
    v_med3_u32 v137, v136, v137, v134
    v_max_u32 v136, v136, v134
    v_med3_u32 v137, v136, v137, v135
    v_max_u32 v136, v136, v135
    s_nop 0
    v_readfirstlane_b32 s92, v136
    v_readfirstlane_b32 s93, v137
    s_andn2_b32 s46, 0x7ff, s92
    s_andn2_b32 s47, 0x7ff, s93
    s_cmp_ge_u32 s41, 18
    s_cbranch_scc1 Ltail_noffn
    s_mul_i32 s44, s46, 1152
    s_mul_i32 s45, s47, 1152
    s_sub_u32 s45, s45, s44
    v_and_b32 v8, 1, v1
    v_mul_lo_u32 v8, v8, s45
    v_and_b32 v9, 48, v1
    v_add3_u32 v8, v8, v9, s44
    s_mov_b32 s45, 2621440
    s_mov_b32 s48, 16384
Ltail_pollh:
    buffer_load_dwordx4 a[120:123], v8, s[24:27], s45 offen offset:0 sc1
    buffer_load_dwordx4 a[124:127], v8, s[24:27], s45 offen offset:64 sc1
    buffer_load_dwordx4 a[128:131], v8, s[24:27], s45 offen offset:128 sc1
    buffer_load_dwordx4 a[132:135], v8, s[24:27], s45 offen offset:192 sc1
    buffer_load_dwordx4 a[136:139], v8, s[24:27], s45 offen offset:256 sc1
    buffer_load_dwordx4 a[140:143], v8, s[24:27], s45 offen offset:320 sc1
    buffer_load_dwordx4 a[144:147], v8, s[24:27], s45 offen offset:384 sc1
    buffer_load_dwordx4 a[148:151], v8, s[24:27], s45 offen offset:448 sc1
    buffer_load_dwordx4 a[152:155], v8, s[24:27], s45 offen offset:512 sc1
    buffer_load_dwordx4 a[156:159], v8, s[24:27], s45 offen offset:576 sc1
    buffer_load_dwordx4 a[160:163], v8, s[24:27], s45 offen offset:640 sc1
    buffer_load_dwordx4 a[164:167], v8, s[24:27], s45 offen offset:704 sc1
    buffer_load_dwordx4 a[168:171], v8, s[24:27], s45 offen offset:768 sc1
    buffer_load_dwordx4 a[172:175], v8, s[24:27], s45 offen offset:832 sc1
    buffer_load_dwordx4 a[176:179], v8, s[24:27], s45 offen offset:896 sc1
    buffer_load_dwordx4 a[180:183], v8, s[24:27], s45 offen offset:960 sc1
    buffer_load_dwordx4 a[184:187], v8, s[24:27], s45 offen offset:1024 sc1
    buffer_load_dwordx4 a[188:191], v8, s[24:27], s45 offen offset:1088 sc1
    s_waitcnt vmcnt(17)
    v_mfma_f32_16x16x32_bf16 v[16:19], a[0:3], a[120:123], 0
    s_waitcnt vmcnt(16)
    v_mfma_f32_16x16x32_bf16 v[20:23], a[4:7], a[124:127], 0
    s_waitcnt vmcnt(15)
    v_mfma_f32_16x16x32_bf16 v[16:19], a[8:11], a[128:131], v[16:19]
    s_waitcnt vmcnt(14)
    v_mfma_f32_16x16x32_bf16 v[20:23], a[12:15], a[132:135], v[20:23]
    s_waitcnt vmcnt(13)
    v_mfma_f32_16x16x32_bf16 v[16:19], a[16:19], a[136:139], v[16:19]
    s_waitcnt vmcnt(12)
    v_mfma_f32_16x16x32_bf16 v[20:23], a[20:23], a[140:143], v[20:23]
    s_waitcnt vmcnt(11)
    v_mfma_f32_16x16x32_bf16 v[16:19], a[24:27], a[144:147], v[16:19]
    s_waitcnt vmcnt(10)
    v_mfma_f32_16x16x32_bf16 v[20:23], a[28:31], a[148:151], v[20:23]
    s_waitcnt vmcnt(9)
    v_mfma_f32_16x16x32_bf16 v[16:19], a[32:35], a[152:155], v[16:19]
    s_waitcnt vmcnt(8)
    v_mfma_f32_16x16x32_bf16 v[20:23], a[36:39], a[156:159], v[20:23]
    s_waitcnt vmcnt(7)
    v_mfma_f32_16x16x32_bf16 v[16:19], a[40:43], a[160:163], v[16:19]
    s_waitcnt vmcnt(6)
    v_mfma_f32_16x16x32_bf16 v[20:23], a[44:47], a[164:167], v[20:23]
    s_waitcnt vmcnt(5)
    v_mfma_f32_16x16x32_bf16 v[16:19], a[48:51], a[168:171], v[16:19]
    s_waitcnt vmcnt(4)
    v_mfma_f32_16x16x32_bf16 v[20:23], a[52:55], a[172:175], v[20:23]
    s_waitcnt vmcnt(3)
    v_mfma_f32_16x16x32_bf16 v[16:19], a[56:59], a[176:179], v[16:19]
    s_waitcnt vmcnt(2)
    v_mfma_f32_16x16x32_bf16 v[20:23], a[60:63], a[180:183], v[20:23]
    s_waitcnt vmcnt(1)
    v_mfma_f32_16x16x32_bf16 v[16:19], a[64:67], a[184:187], v[16:19]
    s_waitcnt vmcnt(0)
    v_mfma_f32_16x16x32_bf16 v[20:23], a[68:71], a[188:191], v[20:23]
    s_sub_u32 s48, s48, 1
    s_nop 6
    v_pk_add_f32 v[16:17], v[16:17], v[20:21]
    v_pk_add_f32 v[18:19], v[18:19], v[22:23]
    s_cbranch_scc1 Ltail_goth
    v_cmp_u_f32 vcc, v16, v16
    s_cbranch_vccnz Ltail_pollh
Ltail_goth:
    ds_write_b128 v14, v[16:19]
    s_waitcnt lgkmcnt(0)
    s_barrier
    ds_read_b128 v[16:19], v13 offset:0
    ds_read_b128 v[20:23], v13 offset:1024
    ds_read_b128 v[24:27], v13 offset:2048
    ds_read_b128 v[28:31], v13 offset:3072
    s_mov_b32 s36, 0xbfb8aa3b
    s_mov_b32 s37, 0xbfb8aa3b
    s_waitcnt lgkmcnt(3)
    v_cvt_pk_bf16_f32 v32, v16, v17
    v_cvt_pk_bf16_f32 v33, v18, v19
    s_waitcnt lgkmcnt(2)
    v_cvt_pk_bf16_f32 v34, v20, v21
    v_cvt_pk_bf16_f32 v35, v22, v23
    v_lshlrev_b32 v16, 16, v32
    v_and_b32 v17, 0xffff0000, v32
    v_lshlrev_b32 v18, 16, v33
    v_and_b32 v19, 0xffff0000, v33
    v_lshlrev_b32 v20, 16, v34
    v_and_b32 v21, 0xffff0000, v34
    v_lshlrev_b32 v22, 16, v35
    v_and_b32 v23, 0xffff0000, v35
    v_pk_mul_f32 v[32:33], v[16:17], s[36:37]
    v_pk_mul_f32 v[34:35], v[18:19], s[36:37]
    v_pk_mul_f32 v[36:37], v[20:21], s[36:37]
    v_pk_mul_f32 v[38:39], v[22:23], s[36:37]
    v_exp_f32 v32, v32
    v_exp_f32 v33, v33
    v_exp_f32 v34, v34
    v_exp_f32 v35, v35
    v_exp_f32 v36, v36
    v_exp_f32 v37, v37
    v_exp_f32 v38, v38
    v_exp_f32 v39, v39
    s_waitcnt lgkmcnt(1)
    v_cvt_pk_bf16_f32 v60, v24, v25
    v_cvt_pk_bf16_f32 v61, v26, v27
    s_waitcnt lgkmcnt(0)
    v_cvt_pk_bf16_f32 v62, v28, v29
    v_cvt_pk_bf16_f32 v63, v30, v31
    v_pk_add_f32 v[32:33], v[32:33], 1.0 op_sel_hi:[1,0]
    v_pk_add_f32 v[34:35], v[34:35], 1.0 op_sel_hi:[1,0]
    v_pk_add_f32 v[36:37], v[36:37], 1.0 op_sel_hi:[1,0]
    v_pk_add_f32 v[38:39], v[38:39], 1.0 op_sel_hi:[1,0]
    v_rcp_f32 v32, v32
    v_rcp_f32 v33, v33
    v_rcp_f32 v34, v34
    v_rcp_f32 v35, v35
    v_rcp_f32 v36, v36
    v_rcp_f32 v37, v37
    v_rcp_f32 v38, v38
    v_rcp_f32 v39, v39
    v_lshlrev_b32 v24, 16, v60
    v_and_b32 v25, 0xffff0000, v60
    v_lshlrev_b32 v26, 16, v61
    v_and_b32 v27, 0xffff0000, v61
    v_lshlrev_b32 v28, 16, v62
    v_and_b32 v29, 0xffff0000, v62
    v_lshlrev_b32 v30, 16, v63
    v_and_b32 v31, 0xffff0000, v63
    v_pk_mul_f32 v[16:17], v[16:17], v[32:33]
    v_pk_mul_f32 v[18:19], v[18:19], v[34:35]
    v_pk_mul_f32 v[20:21], v[20:21], v[36:37]
    v_pk_mul_f32 v[22:23], v[22:23], v[38:39]
    v_cvt_pk_bf16_f32 v32, v16, v17
    v_cvt_pk_bf16_f32 v33, v18, v19
    v_cvt_pk_bf16_f32 v34, v20, v21
    v_cvt_pk_bf16_f32 v35, v22, v23
    v_lshlrev_b32 v16, 16, v32
    v_and_b32 v17, 0xffff0000, v32
    v_lshlrev_b32 v18, 16, v33
    v_and_b32 v19, 0xffff0000, v33
    v_lshlrev_b32 v20, 16, v34
    v_and_b32 v21, 0xffff0000, v34
    v_lshlrev_b32 v22, 16, v35
    v_and_b32 v23, 0xffff0000, v35
    v_pk_mul_f32 v[16:17], v[16:17], v[24:25]
    v_pk_mul_f32 v[18:19], v[18:19], v[26:27]
    v_pk_mul_f32 v[20:21], v[20:21], v[28:29]
    v_pk_mul_f32 v[22:23], v[22:23], v[30:31]
    v_cvt_pk_bf16_f32 v32, v16, v17
    v_cvt_pk_bf16_f32 v33, v18, v19
    v_cvt_pk_bf16_f32 v34, v20, v21
    v_cvt_pk_bf16_f32 v35, v22, v23
    v_cndmask_b32 v64, 0, v32, s[52:53]
    v_cndmask_b32 v65, 0, v33, s[52:53]
    v_cndmask_b32 v66, 0, v34, s[52:53]
    v_cndmask_b32 v67, 0, v35, s[52:53]
    v_cndmask_b32 v68, 0, v32, s[54:55]
    v_cndmask_b32 v69, 0, v33, s[54:55]
    v_cndmask_b32 v70, 0, v34, s[54:55]
    v_cndmask_b32 v71, 0, v35, s[54:55]
    v_cndmask_b32 v72, 0, v32, s[56:57]
    v_cndmask_b32 v73, 0, v33, s[56:57]
    v_cndmask_b32 v74, 0, v34, s[56:57]
    v_cndmask_b32 v75, 0, v35, s[56:57]
    v_cndmask_b32 v76, 0, v32, s[58:59]
    v_cndmask_b32 v77, 0, v33, s[58:59]
    v_cndmask_b32 v78, 0, v34, s[58:59]
    v_cndmask_b32 v79, 0, v35, s[58:59]
    v_mfma_f32_16x16x32_bf16 v[16:19], v[64:67], a[72:75], 0
    v_mfma_f32_16x16x32_bf16 v[16:19], v[68:71], a[76:79], v[16:19]
    v_mfma_f32_16x16x32_bf16 v[16:19], v[72:75], a[80:83], v[16:19]
    v_mfma_f32_16x16x32_bf16 v[16:19], v[76:79], a[84:87], v[16:19]
    v_mfma_f32_16x16x32_bf16 v[20:23], v[64:67], a[88:91], 0
    v_mfma_f32_16x16x32_bf16 v[20:23], v[68:71], a[92:95], v[20:23]
    v_mfma_f32_16x16x32_bf16 v[20:23], v[72:75], a[96:99], v[20:23]
    v_mfma_f32_16x16x32_bf16 v[20:23], v[76:79], a[100:103], v[20:23]
    v_mfma_f32_16x16x32_bf16 v[24:27], v[64:67], a[104:107], 0
    v_mfma_f32_16x16x32_bf16 v[24:27], v[68:71], a[108:111], v[24:27]
    v_mfma_f32_16x16x32_bf16 v[24:27], v[72:75], a[112:115], v[24:27]
    v_mfma_f32_16x16x32_bf16 v[24:27], v[76:79], a[116:119], v[24:27]
    v_min_u32 v16, -2, v16
    v_min_u32 v17, -2, v17
    buffer_store_dwordx2 v[16:17], v15, s[8:11], s43 offen sc1
    s_add_u32 s43, s43, 294912
    v_min_u32 v20, -2, v20
    v_min_u32 v21, -2, v21
    buffer_store_dwordx2 v[20:21], v15, s[8:11], s43 offen sc1
    s_add_u32 s43, s43, 294912
    v_min_u32 v24, -2, v24
    v_min_u32 v25, -2, v25
    buffer_store_dwordx2 v[24:25], v15, s[8:11], s43 offen sc1
    v_cmp_ne_u32 vcc, s46, v7
    v_cmp_ne_u32 s[36:37], s47, v7
    v_mov_b32 v31, 2147483648
    s_and_b64 vcc, vcc, s[36:37]
    s_nop 1
    v_cndmask_b32 v31, v31, v4, vcc
    buffer_store_dwordx2 v[208:209], v31, s[16:19], 0 offen offset:0
    buffer_store_dwordx2 v[210:211], v31, s[16:19], 0 offen offset:32
    buffer_store_dwordx2 v[212:213], v31, s[16:19], 0 offen offset:384
    buffer_store_dwordx2 v[214:215], v31, s[16:19], 0 offen offset:416
    buffer_store_dwordx2 v[216:217], v31, s[16:19], 0 offen offset:768
    buffer_store_dwordx2 v[218:219], v31, s[16:19], 0 offen offset:800
    s_branch Ltail_done
Ltail_noffn:
    s_cmp_lt_u32 s41, 27
    s_cselect_b32 s36, s3, 1
    s_cmp_eq_u32 s36, 0
    s_cbranch_scc1 Ltail_final
    v_cmp_ne_u32 vcc, s46, v7
    v_cmp_ne_u32 s[36:37], s47, v7
    v_mov_b32 v31, 2147483648
    s_and_b64 vcc, vcc, s[36:37]
    s_nop 1
    v_cndmask_b32 v31, v31, v4, vcc
    buffer_store_dwordx2 v[208:209], v31, s[16:19], 0 offen offset:0
    buffer_store_dwordx2 v[210:211], v31, s[16:19], 0 offen offset:32
    buffer_store_dwordx2 v[212:213], v31, s[16:19], 0 offen offset:384
    buffer_store_dwordx2 v[214:215], v31, s[16:19], 0 offen offset:416
    buffer_store_dwordx2 v[216:217], v31, s[16:19], 0 offen offset:768
    buffer_store_dwordx2 v[218:219], v31, s[16:19], 0 offen offset:800
    s_branch Ltail_done
Ltail_final:
    s_mul_i32 s43, s42, 9
    s_add_u32 s43, s43, s41
    s_sub_u32 s43, s43, 18
    v_bfe_u32 v8, v1, 2, 1
    v_cmp_eq_u32 vcc, 1, v8
    v_mov_b32 v9, s46
    v_mov_b32 v10, s47
    v_and_b32 v11, 3, v1
    v_cndmask_b32 v9, v9, v10, vcc
    s_lshr_b32 s44, s43, 2
    s_lshl_b32 s44, s44, 6
    s_and_b32 s45, s43, 1
    s_lshl_b32 s45, s45, 5
    s_add_u32 s44, s44, s45
    s_and_b32 s45, s43, 2
    s_lshl_b32 s45, s45, 2
    s_add_u32 s44, s44, s45
    v_lshrrev_b32 v12, 1, v11
    v_lshl_add_u32 v12, v12, 4, s44
    v_and_b32 v13, 1, v11
    v_lshl_add_u32 v12, v13, 2, v12
    v_mul_u32_u24 v13, 1152, v9
    v_add_u32 v14, v13, v12
    v_add_u32 v15, 2621440, v14
    s_mov_b32 s45, 22144
    buffer_load_dword v18, v12, s[24:27], s45 offen sc1
    v_mov_b32 v19, s92
    v_mov_b32 v10, s93
    v_cndmask_b32 v19, v19, v10, vcc
    v_and_b32 v19, 0xfffff800, v19
    v_or_b32 v19, 0x400, v19
    v_ashrrev_i32 v10, 31, v19
    v_not_b32 v10, v10
    v_or_b32 v10, 0x80000000, v10
    v_xor_b32 v19, v19, v10
    s_lshl_b32 s45, s43, 4
    v_lshl_add_u32 v13, v11, 2, v13
    v_add_u32 v13, s45, v13
    v_lshrrev_b32 v14, 2, v1
    v_lshlrev_b32 v14, 9, v14
    v_lshl_add_u32 v14, v11, 4, v14
    s_lshr_b32 s44, s43, 3
    s_mul_i32 s44, s44, 73728
    s_and_b32 s45, s43, 7
    s_lshl_b32 s45, s45, 6
    s_add_u32 s44, s44, s45
    v_cmp_ne_u32 vcc, s46, v7
    v_cmp_ne_u32 s[36:37], s47, v7
    v_mov_b32 v31, 2147483648
    s_and_b64 vcc, vcc, s[36:37]
    s_nop 1
    v_cndmask_b32 v31, v31, v4, vcc
    buffer_store_dwordx2 v[208:209], v31, s[16:19], 0 offen offset:0
    buffer_store_dwordx2 v[210:211], v31, s[16:19], 0 offen offset:32
    buffer_store_dwordx2 v[212:213], v31, s[16:19], 0 offen offset:384
    buffer_store_dwordx2 v[214:215], v31, s[16:19], 0 offen offset:416
    buffer_store_dwordx2 v[216:217], v31, s[16:19], 0 offen offset:768
    buffer_store_dwordx2 v[218:219], v31, s[16:19], 0 offen offset:800
    v_cmp_eq_u32 s[36:37], 1, v8
    v_cvt_pk_bf16_f32 v19, v19, v19
    v_and_b32 v19, 0xffff0000, v19
    v_mul_f32 v19, 0xbfb8aa3b, v19
    v_exp_f32 v19, v19
    s_waitcnt vmcnt(6)
    v_lshlrev_b32 v24, 16, v18
    v_and_b32 v25, 0xffff0000, v18
    v_add_f32 v19, 1.0, v19
    v_rcp_f32 v19, v19
    s_mov_b32 s48, 16384
    v_cvt_pk_bf16_f32 v19, v19, v19
    v_and_b32 v19, 0xffff0000, v19
Ltail_polly:
    s_add_u32 s45, s44, 0
    buffer_load_dwordx4 v[64:67], v14, s[8:11], s45 offen sc1
    s_add_u32 s45, s44, 8192
    buffer_load_dwordx4 v[68:71], v14, s[8:11], s45 offen sc1
    s_add_u32 s45, s44, 16384
    buffer_load_dwordx4 v[72:75], v14, s[8:11], s45 offen sc1
    s_add_u32 s45, s44, 24576
    buffer_load_dwordx4 v[76:79], v14, s[8:11], s45 offen sc1
    s_add_u32 s45, s44, 32768
    buffer_load_dwordx4 v[80:83], v14, s[8:11], s45 offen sc1
    s_add_u32 s45, s44, 40960
    buffer_load_dwordx4 v[84:87], v14, s[8:11], s45 offen sc1
    s_add_u32 s45, s44, 49152
    buffer_load_dwordx4 v[88:91], v14, s[8:11], s45 offen sc1
    s_add_u32 s45, s44, 57344
    buffer_load_dwordx4 v[92:95], v14, s[8:11], s45 offen sc1
    s_add_u32 s45, s44, 65536
    buffer_load_dwordx4 v[96:99], v14, s[8:11], s45 offen sc1
    s_mov_b32 s45, 2621440
    buffer_load_dword v16, v15, s[24:27], s45 offen sc1
    buffer_load_dword v17, v15, s[24:27], 0 offen sc1
    s_sub_u32 s48, s48, 1
    s_cbranch_scc1 Ltail_goty
    s_waitcnt vmcnt(10)
    v_max3_u32 v26, v64, v65, v66
    s_waitcnt vmcnt(9)
    v_max3_u32 v26, v26, v67, v68
    v_max3_u32 v26, v26, v69, v70
    s_waitcnt vmcnt(8)
    v_max3_u32 v26, v26, v71, v72
    v_max3_u32 v26, v26, v73, v74
    s_waitcnt vmcnt(7)
    v_max3_u32 v26, v26, v75, v76
    v_max3_u32 v26, v26, v77, v78
    s_waitcnt vmcnt(6)
    v_max3_u32 v26, v26, v79, v80
    v_max3_u32 v26, v26, v81, v82
    s_waitcnt vmcnt(5)
    v_max3_u32 v26, v26, v83, v84
    v_max3_u32 v26, v26, v85, v86
    s_waitcnt vmcnt(4)
    v_max3_u32 v26, v26, v87, v88
    v_max3_u32 v26, v26, v89, v90
    s_waitcnt vmcnt(3)
    v_max3_u32 v26, v26, v91, v92
    v_max3_u32 v26, v26, v93, v94
    s_waitcnt vmcnt(2)
    v_max3_u32 v26, v26, v95, v96
    v_max3_u32 v26, v26, v97, v98
    v_max_u32 v26, v26, v99
    s_waitcnt vmcnt(0)
    v_max3_u32 v26, v26, v16, v17
    v_cmp_eq_u32 vcc, -1, v26
    s_cbranch_vccnz Ltail_polly
Ltail_goty:
    s_waitcnt vmcnt(0) lgkmcnt(0)
    v_lshlrev_b32 v20, 16, v16
    v_and_b32 v21, 0xffff0000, v16
    v_lshlrev_b32 v22, 16, v17
    v_and_b32 v23, 0xffff0000, v17
    v_pk_add_f32 v[64:65], v[64:65], v[68:69]
    v_pk_add_f32 v[66:67], v[66:67], v[70:71]
    v_pk_add_f32 v[64:65], v[64:65], v[72:73]
    v_pk_add_f32 v[66:67], v[66:67], v[74:75]
    v_pk_add_f32 v[64:65], v[64:65], v[76:77]
    v_pk_add_f32 v[66:67], v[66:67], v[78:79]
    v_pk_add_f32 v[64:65], v[64:65], v[80:81]
    v_pk_add_f32 v[66:67], v[66:67], v[82:83]
    v_pk_add_f32 v[64:65], v[64:65], v[84:85]
    v_pk_add_f32 v[66:67], v[66:67], v[86:87]
    v_pk_add_f32 v[64:65], v[64:65], v[88:89]
    v_pk_add_f32 v[66:67], v[66:67], v[90:91]
    v_pk_add_f32 v[64:65], v[64:65], v[92:93]
    v_pk_add_f32 v[66:67], v[66:67], v[94:95]
    v_pk_add_f32 v[64:65], v[64:65], v[96:97]
    v_pk_add_f32 v[66:67], v[66:67], v[98:99]
    s_nop 0
    v_add_f32_dpp v64, v64, v64 row_ror:4 row_mask:0xf bank_mask:0xf
    v_add_f32_dpp v65, v65, v65 row_ror:4 row_mask:0xf bank_mask:0xf
    v_add_f32_dpp v66, v66, v66 row_ror:4 row_mask:0xf bank_mask:0xf
    v_add_f32_dpp v67, v67, v67 row_ror:4 row_mask:0xf bank_mask:0xf
    v_add_f32_dpp v64, v64, v64 row_ror:8 row_mask:0xf bank_mask:0xf
    v_add_f32_dpp v65, v65, v65 row_ror:8 row_mask:0xf bank_mask:0xf
    v_add_f32_dpp v66, v66, v66 row_ror:8 row_mask:0xf bank_mask:0xf
    v_add_f32_dpp v67, v67, v67 row_ror:8 row_mask:0xf bank_mask:0xf
    v_mov_b32 v68, v64
    v_mov_b32 v69, v65
    v_mov_b32 v70, v66
    v_mov_b32 v71, v67
    v_permlane16_swap_b32 v64, v68
    v_permlane16_swap_b32 v65, v69
    v_permlane16_swap_b32 v66, v70
    v_permlane16_swap_b32 v67, v71
    v_add_f32 v64, v64, v68
    v_add_f32 v65, v65, v69
    v_add_f32 v66, v66, v70
    v_add_f32 v67, v67, v71
    v_mov_b32 v68, v64
    v_mov_b32 v69, v65
    v_mov_b32 v70, v66
    v_mov_b32 v71, v67
    v_permlane32_swap_b32 v64, v68
    v_permlane32_swap_b32 v65, v69
    v_permlane32_swap_b32 v66, v70
    v_permlane32_swap_b32 v67, v71
    v_add_f32 v64, v64, v68
    v_add_f32 v65, v65, v69
    v_add_f32 v66, v66, v70
    v_add_f32 v67, v67, v71
    v_cndmask_b32 v26, v64, v65, s[36:37]
    v_cndmask_b32 v27, v66, v67, s[36:37]
    v_cvt_pk_bf16_f32 v28, v26, v27
    v_lshlrev_b32 v26, 16, v28
    v_and_b32 v27, 0xffff0000, v28
    v_mul_f32 v26, v26, v19
    v_mul_f32 v27, v27, v19
    v_cvt_pk_bf16_f32 v28, v26, v27
    v_lshlrev_b32 v26, 16, v28
    v_and_b32 v27, 0xffff0000, v28
    v_pk_add_f32 v[26:27], v[26:27], v[22:23]
    v_cvt_pk_bf16_f32 v28, v26, v27
    v_lshlrev_b32 v26, 16, v28
    v_and_b32 v27, 0xffff0000, v28
    v_pk_mul_f32 v[26:27], v[26:27], v[24:25]
    v_cvt_pk_bf16_f32 v28, v26, v27
    v_lshlrev_b32 v26, 16, v28
    v_and_b32 v27, 0xffff0000, v28
    v_pk_add_f32 v[26:27], v[26:27], v[20:21]
    v_cvt_pk_bf16_f32 v28, v26, v27
    s_mov_b64 exec, 0xff
    buffer_store_dword v28, v13, s[16:19], 0 offen
Ltail_done:
    s_endpgm
Ltail_spin1:
    s_mov_b32 s48, 16384
Ltail_spinl1:
    buffer_load_dword v11, v9, s[24:27], s93 offen sc1
    s_waitcnt vmcnt(0)
    v_cmp_ne_u32 s[54:55], s95, v11
    s_sub_u32 s48, s48, 1
    s_cbranch_scc1 Ltail_got1
    s_cmp_lg_u64 s[54:55], 0
    s_cbranch_scc1 Ltail_spinl1
    s_branch Ltail_got1
Ltail_spin2:
    s_mov_b32 s48, 16384
Ltail_spinl2:
    buffer_load_dword v11, v9, s[24:27], s93 offen sc1
    s_waitcnt vmcnt(0)
    v_cmp_ne_u32 s[54:55], s95, v11
    s_sub_u32 s48, s48, 1
    s_cbranch_scc1 Ltail_got2
    s_cmp_lg_u64 s[54:55], 0
    s_cbranch_scc1 Ltail_spinl2
    s_branch Ltail_got2
Lattn_redo:
    s_waitcnt vmcnt(0) lgkmcnt(0)
    s_barrier
    v_mov_b32 v232, 0xff800000
    v_mov_b32 v233, 0xff800000
    v_mov_b32 v234, 0xff800000
    v_mov_b32 v235, 0xff800000
    s_mov_b32 s40, 0
    s_mov_b32 s48, -1
Lattn_redo_loop:
    s_add_u32 m0, s42, 0
    s_nop 0
    buffer_load_dwordx4 v36, s[8:11], s40 offen lds
    buffer_load_dwordx4 v37, s[8:11], s40 offen offset:1024 lds
    buffer_load_dwordx4 v38, s[8:11], s40 offen offset:2048 lds
    buffer_load_dwordx4 v39, s[8:11], s40 offen offset:3072 lds
    s_add_u32 s40, s40, 16384
    s_waitcnt vmcnt(0) lgkmcnt(0)
    s_barrier
    ds_read_b128 a[208:211], v8 offset:0
    ds_read_b128 a[212:215], v9 offset:0
    ds_read_b128 a[216:219], v10 offset:0
    ds_read_b128 a[220:223], v11 offset:0
    s_waitcnt lgkmcnt(3)
    v_mfma_f32_16x16x32_bf16 v[216:219], a[208:211], v[64:67], 0
    s_waitcnt lgkmcnt(2)
    v_mfma_f32_16x16x32_bf16 v[216:219], a[212:215], v[68:71], v[216:219]
    s_waitcnt lgkmcnt(1)
    v_mfma_f32_16x16x32_bf16 v[216:219], a[216:219], v[72:75], v[216:219]
    s_waitcnt lgkmcnt(0)
    v_mfma_f32_16x16x32_bf16 v[216:219], a[220:223], v[76:79], v[216:219]
    v_mfma_f32_16x16x32_bf16 v[220:223], a[208:211], v[80:83], 0
    v_mfma_f32_16x16x32_bf16 v[220:223], a[212:215], v[84:87], v[220:223]
    v_mfma_f32_16x16x32_bf16 v[220:223], a[216:219], v[88:91], v[220:223]
    v_mfma_f32_16x16x32_bf16 v[220:223], a[220:223], v[92:95], v[220:223]
    v_mfma_f32_16x16x32_bf16 v[224:227], a[208:211], v[96:99], 0
    v_mfma_f32_16x16x32_bf16 v[224:227], a[212:215], v[100:103], v[224:227]
    v_mfma_f32_16x16x32_bf16 v[224:227], a[216:219], v[104:107], v[224:227]
    v_mfma_f32_16x16x32_bf16 v[224:227], a[220:223], v[108:111], v[224:227]
    v_mfma_f32_16x16x32_bf16 v[228:231], a[208:211], v[112:115], 0
    v_mfma_f32_16x16x32_bf16 v[228:231], a[212:215], v[116:119], v[228:231]
    v_mfma_f32_16x16x32_bf16 v[228:231], a[216:219], v[120:123], v[228:231]
    v_mfma_f32_16x16x32_bf16 v[228:231], a[220:223], v[124:127], v[228:231]
    v_max3_f32 v232, v232, v216, v217
    v_max3_f32 v232, v232, v218, v219
    v_max3_f32 v233, v233, v220, v221
    v_max3_f32 v233, v233, v222, v223
    v_max3_f32 v234, v234, v224, v225
    v_max3_f32 v234, v234, v226, v227
    s_nop 1
    v_max3_f32 v235, v235, v228, v229
    v_max3_f32 v235, v235, v230, v231
    ds_read_b128 a[224:227], v8 offset:4096
    ds_read_b128 a[228:231], v9 offset:4096
    ds_read_b128 a[232:235], v10 offset:4096
    ds_read_b128 a[236:239], v11 offset:4096
    s_waitcnt lgkmcnt(3)
    v_mfma_f32_16x16x32_bf16 v[216:219], a[224:227], v[64:67], 0
    s_waitcnt lgkmcnt(2)
    v_mfma_f32_16x16x32_bf16 v[216:219], a[228:231], v[68:71], v[216:219]
    s_waitcnt lgkmcnt(1)
    v_mfma_f32_16x16x32_bf16 v[216:219], a[232:235], v[72:75], v[216:219]
    s_waitcnt lgkmcnt(0)
    v_mfma_f32_16x16x32_bf16 v[216:219], a[236:239], v[76:79], v[216:219]
    v_mfma_f32_16x16x32_bf16 v[220:223], a[224:227], v[80:83], 0
    v_mfma_f32_16x16x32_bf16 v[220:223], a[228:231], v[84:87], v[220:223]
    v_mfma_f32_16x16x32_bf16 v[220:223], a[232:235], v[88:91], v[220:223]
    v_mfma_f32_16x16x32_bf16 v[220:223], a[236:239], v[92:95], v[220:223]
    v_mfma_f32_16x16x32_bf16 v[224:227], a[224:227], v[96:99], 0
    v_mfma_f32_16x16x32_bf16 v[224:227], a[228:231], v[100:103], v[224:227]
    v_mfma_f32_16x16x32_bf16 v[224:227], a[232:235], v[104:107], v[224:227]
    v_mfma_f32_16x16x32_bf16 v[224:227], a[236:239], v[108:111], v[224:227]
    v_mfma_f32_16x16x32_bf16 v[228:231], a[224:227], v[112:115], 0
    v_mfma_f32_16x16x32_bf16 v[228:231], a[228:231], v[116:119], v[228:231]
    v_mfma_f32_16x16x32_bf16 v[228:231], a[232:235], v[120:123], v[228:231]
    v_mfma_f32_16x16x32_bf16 v[228:231], a[236:239], v[124:127], v[228:231]
    v_max3_f32 v232, v232, v216, v217
    v_max3_f32 v232, v232, v218, v219
    v_max3_f32 v233, v233, v220, v221
    v_max3_f32 v233, v233, v222, v223
    v_max3_f32 v234, v234, v224, v225
    v_max3_f32 v234, v234, v226, v227
    s_nop 1
    v_max3_f32 v235, v235, v228, v229
    v_max3_f32 v235, v235, v230, v231
    ds_read_b128 a[208:211], v8 offset:8192
    ds_read_b128 a[212:215], v9 offset:8192
    ds_read_b128 a[216:219], v10 offset:8192
    ds_read_b128 a[220:223], v11 offset:8192
    s_waitcnt lgkmcnt(3)
    v_mfma_f32_16x16x32_bf16 v[216:219], a[208:211], v[64:67], 0
    s_waitcnt lgkmcnt(2)
    v_mfma_f32_16x16x32_bf16 v[216:219], a[212:215], v[68:71], v[216:219]
    s_waitcnt lgkmcnt(1)
    v_mfma_f32_16x16x32_bf16 v[216:219], a[216:219], v[72:75], v[216:219]
    s_waitcnt lgkmcnt(0)
    v_mfma_f32_16x16x32_bf16 v[216:219], a[220:223], v[76:79], v[216:219]
    v_mfma_f32_16x16x32_bf16 v[220:223], a[208:211], v[80:83], 0
    v_mfma_f32_16x16x32_bf16 v[220:223], a[212:215], v[84:87], v[220:223]
    v_mfma_f32_16x16x32_bf16 v[220:223], a[216:219], v[88:91], v[220:223]
    v_mfma_f32_16x16x32_bf16 v[220:223], a[220:223], v[92:95], v[220:223]
    v_mfma_f32_16x16x32_bf16 v[224:227], a[208:211], v[96:99], 0
    v_mfma_f32_16x16x32_bf16 v[224:227], a[212:215], v[100:103], v[224:227]
    v_mfma_f32_16x16x32_bf16 v[224:227], a[216:219], v[104:107], v[224:227]
    v_mfma_f32_16x16x32_bf16 v[224:227], a[220:223], v[108:111], v[224:227]
    v_mfma_f32_16x16x32_bf16 v[228:231], a[208:211], v[112:115], 0
    v_mfma_f32_16x16x32_bf16 v[228:231], a[212:215], v[116:119], v[228:231]
    v_mfma_f32_16x16x32_bf16 v[228:231], a[216:219], v[120:123], v[228:231]
    v_mfma_f32_16x16x32_bf16 v[228:231], a[220:223], v[124:127], v[228:231]
    v_max3_f32 v232, v232, v216, v217
    v_max3_f32 v232, v232, v218, v219
    v_max3_f32 v233, v233, v220, v221
    v_max3_f32 v233, v233, v222, v223
    v_max3_f32 v234, v234, v224, v225
    v_max3_f32 v234, v234, v226, v227
    s_nop 1
    v_max3_f32 v235, v235, v228, v229
    v_max3_f32 v235, v235, v230, v231
    ds_read_b128 a[224:227], v8 offset:12288
    ds_read_b128 a[228:231], v9 offset:12288
    ds_read_b128 a[232:235], v10 offset:12288
    ds_read_b128 a[236:239], v11 offset:12288
    s_waitcnt lgkmcnt(3)
    v_mfma_f32_16x16x32_bf16 v[216:219], a[224:227], v[64:67], 0
    s_waitcnt lgkmcnt(2)
    v_mfma_f32_16x16x32_bf16 v[216:219], a[228:231], v[68:71], v[216:219]
    s_waitcnt lgkmcnt(1)
    v_mfma_f32_16x16x32_bf16 v[216:219], a[232:235], v[72:75], v[216:219]
    s_waitcnt lgkmcnt(0)
    v_mfma_f32_16x16x32_bf16 v[216:219], a[236:239], v[76:79], v[216:219]
    v_mfma_f32_16x16x32_bf16 v[220:223], a[224:227], v[80:83], 0
    v_mfma_f32_16x16x32_bf16 v[220:223], a[228:231], v[84:87], v[220:223]
    v_mfma_f32_16x16x32_bf16 v[220:223], a[232:235], v[88:91], v[220:223]
    v_mfma_f32_16x16x32_bf16 v[220:223], a[236:239], v[92:95], v[220:223]
    v_mfma_f32_16x16x32_bf16 v[224:227], a[224:227], v[96:99], 0
    v_mfma_f32_16x16x32_bf16 v[224:227], a[228:231], v[100:103], v[224:227]
    v_mfma_f32_16x16x32_bf16 v[224:227], a[232:235], v[104:107], v[224:227]
    v_mfma_f32_16x16x32_bf16 v[224:227], a[236:239], v[108:111], v[224:227]
    v_mfma_f32_16x16x32_bf16 v[228:231], a[224:227], v[112:115], 0
    v_mfma_f32_16x16x32_bf16 v[228:231], a[228:231], v[116:119], v[228:231]
    v_mfma_f32_16x16x32_bf16 v[228:231], a[232:235], v[120:123], v[228:231]
    v_mfma_f32_16x16x32_bf16 v[228:231], a[236:239], v[124:127], v[228:231]
    v_max3_f32 v232, v232, v216, v217
    v_max3_f32 v232, v232, v218, v219
    v_max3_f32 v233, v233, v220, v221
    v_max3_f32 v233, v233, v222, v223
    v_max3_f32 v234, v234, v224, v225
    v_max3_f32 v234, v234, v226, v227
    s_nop 1
    v_max3_f32 v235, v235, v228, v229
    v_max3_f32 v235, v235, v230, v231
    s_barrier
    s_cmp_lt_u32 s40, 524288
    s_cbranch_scc1 Lattn_redo_loop
    v_mov_b32 v236, v232
    v_mov_b32 v237, v233
    v_mov_b32 v238, v234
    v_mov_b32 v239, v235
    v_permlane16_swap_b32 v232, v236
    v_permlane16_swap_b32 v233, v237
    v_permlane16_swap_b32 v234, v238
    v_permlane16_swap_b32 v235, v239
    v_max_f32 v232, v232, v236
    v_max_f32 v233, v233, v237
    v_max_f32 v234, v234, v238
    v_max_f32 v235, v235, v239
    v_mov_b32 v236, v232
    v_mov_b32 v237, v233
    v_mov_b32 v238, v234
    v_mov_b32 v239, v235
    v_permlane32_swap_b32 v232, v236
    v_permlane32_swap_b32 v233, v237
    v_permlane32_swap_b32 v234, v238
    v_permlane32_swap_b32 v235, v239
    v_max_f32 v232, v232, v236
    v_max_f32 v233, v233, v237
    v_max_f32 v234, v234, v238
    v_max_f32 v235, v235, v239
    v_sub_f32 v192, 0, v232
    v_sub_f32 v193, 0, v232
    v_sub_f32 v194, 0, v232
    v_sub_f32 v195, 0, v232
    v_sub_f32 v196, 0, v233
    v_sub_f32 v197, 0, v233
    v_sub_f32 v198, 0, v233
    v_sub_f32 v199, 0, v233
    v_sub_f32 v200, 0, v234
    v_sub_f32 v201, 0, v234
    v_sub_f32 v202, 0, v234
    v_sub_f32 v203, 0, v234
    v_sub_f32 v204, 0, v235
    v_sub_f32 v205, 0, v235
    v_sub_f32 v206, 0, v235
    v_sub_f32 v207, 0, v235
    s_mov_b32 s40, 0
    s_mov_b32 s41, 0
    s_add_u32 m0, s42, 0
    s_nop 0
    buffer_load_dwordx4 v36, s[8:11], s40 offen lds
    buffer_load_dwordx4 v37, s[8:11], s40 offen offset:1024 lds
    buffer_load_dwordx4 v38, s[8:11], s40 offen offset:2048 lds
    buffer_load_dwordx4 v39, s[8:11], s40 offen offset:3072 lds
    s_add_u32 s40, s40, 16384
    s_add_u32 m0, s42, 16384
    s_nop 0
    buffer_load_dwordx4 v36, s[8:11], s40 offen lds
    buffer_load_dwordx4 v37, s[8:11], s40 offen offset:1024 lds
    buffer_load_dwordx4 v38, s[8:11], s40 offen offset:2048 lds
    buffer_load_dwordx4 v39, s[8:11], s40 offen offset:3072 lds
    s_add_u32 s40, s40, 16384
    s_add_u32 m0, s42, 32768
    s_nop 0
    buffer_load_dwordx4 v36, s[8:11], s40 offen lds
    buffer_load_dwordx4 v37, s[8:11], s40 offen offset:1024 lds
    buffer_load_dwordx4 v38, s[8:11], s40 offen offset:2048 lds
    buffer_load_dwordx4 v39, s[8:11], s40 offen offset:3072 lds
    s_add_u32 s40, s40, 16384
    s_add_u32 m0, s42, 65536
    s_nop 0
    buffer_load_dwordx4 v40, s[12:15], s41 offen lds
    buffer_load_dwordx4 v41, s[12:15], s41 offen offset:1024 lds
    buffer_load_dwordx4 v40, s[12:15], s41 offen offset:2048 lds
    buffer_load_dwordx4 v41, s[12:15], s41 offen offset:3072 lds
    s_add_u32 s41, s41, 16384
    s_add_u32 m0, s42, 81920
    s_nop 0
    buffer_load_dwordx4 v40, s[12:15], s41 offen lds
    buffer_load_dwordx4 v41, s[12:15], s41 offen offset:1024 lds
    buffer_load_dwordx4 v40, s[12:15], s41 offen offset:2048 lds
    buffer_load_dwordx4 v41, s[12:15], s41 offen offset:3072 lds
    s_add_u32 s41, s41, 16384
    v_accvgpr_write_b32 a0, 0
    v_accvgpr_write_b32 a1, 0
    v_accvgpr_write_b32 a2, 0
    v_accvgpr_write_b32 a3, 0
    v_accvgpr_write_b32 a4, 0
    v_accvgpr_write_b32 a5, 0
    v_accvgpr_write_b32 a6, 0
    v_accvgpr_write_b32 a7, 0
    v_accvgpr_write_b32 a8, 0
    v_accvgpr_write_b32 a9, 0
    v_accvgpr_write_b32 a10, 0
    v_accvgpr_write_b32 a11, 0
    v_accvgpr_write_b32 a12, 0
    v_accvgpr_write_b32 a13, 0
    v_accvgpr_write_b32 a14, 0
    v_accvgpr_write_b32 a15, 0
    v_accvgpr_write_b32 a16, 0
    v_accvgpr_write_b32 a17, 0
    v_accvgpr_write_b32 a18, 0
    v_accvgpr_write_b32 a19, 0
    v_accvgpr_write_b32 a20, 0
    v_accvgpr_write_b32 a21, 0
    v_accvgpr_write_b32 a22, 0
    v_accvgpr_write_b32 a23, 0
    v_accvgpr_write_b32 a24, 0
    v_accvgpr_write_b32 a25, 0
    v_accvgpr_write_b32 a26, 0
    v_accvgpr_write_b32 a27, 0
    v_accvgpr_write_b32 a28, 0
    v_accvgpr_write_b32 a29, 0
    v_accvgpr_write_b32 a30, 0
    v_accvgpr_write_b32 a31, 0
    v_accvgpr_write_b32 a32, 0
    v_accvgpr_write_b32 a33, 0
    v_accvgpr_write_b32 a34, 0
    v_accvgpr_write_b32 a35, 0
    v_accvgpr_write_b32 a36, 0
    v_accvgpr_write_b32 a37, 0
    v_accvgpr_write_b32 a38, 0
    v_accvgpr_write_b32 a39, 0
    v_accvgpr_write_b32 a40, 0
    v_accvgpr_write_b32 a41, 0
    v_accvgpr_write_b32 a42, 0
    v_accvgpr_write_b32 a43, 0
    v_accvgpr_write_b32 a44, 0
    v_accvgpr_write_b32 a45, 0
    v_accvgpr_write_b32 a46, 0
    v_accvgpr_write_b32 a47, 0
    v_accvgpr_write_b32 a48, 0
    v_accvgpr_write_b32 a49, 0
    v_accvgpr_write_b32 a50, 0
    v_accvgpr_write_b32 a51, 0
    v_accvgpr_write_b32 a52, 0
    v_accvgpr_write_b32 a53, 0
    v_accvgpr_write_b32 a54, 0
    v_accvgpr_write_b32 a55, 0
    v_accvgpr_write_b32 a56, 0
    v_accvgpr_write_b32 a57, 0
    v_accvgpr_write_b32 a58, 0
    v_accvgpr_write_b32 a59, 0
    v_accvgpr_write_b32 a60, 0
    v_accvgpr_write_b32 a61, 0
    v_accvgpr_write_b32 a62, 0
    v_accvgpr_write_b32 a63, 0
    v_accvgpr_write_b32 a64, 0
    v_accvgpr_write_b32 a65, 0
    v_accvgpr_write_b32 a66, 0
    v_accvgpr_write_b32 a67, 0
    v_accvgpr_write_b32 a68, 0
    v_accvgpr_write_b32 a69, 0
    v_accvgpr_write_b32 a70, 0
    v_accvgpr_write_b32 a71, 0
    v_accvgpr_write_b32 a72, 0
    v_accvgpr_write_b32 a73, 0
    v_accvgpr_write_b32 a74, 0
    v_accvgpr_write_b32 a75, 0
    v_accvgpr_write_b32 a76, 0
    v_accvgpr_write_b32 a77, 0
    v_accvgpr_write_b32 a78, 0
    v_accvgpr_write_b32 a79, 0
    v_accvgpr_write_b32 a80, 0
    v_accvgpr_write_b32 a81, 0
    v_accvgpr_write_b32 a82, 0
    v_accvgpr_write_b32 a83, 0
    v_accvgpr_write_b32 a84, 0
    v_accvgpr_write_b32 a85, 0
    v_accvgpr_write_b32 a86, 0
    v_accvgpr_write_b32 a87, 0
    v_accvgpr_write_b32 a88, 0
    v_accvgpr_write_b32 a89, 0
    v_accvgpr_write_b32 a90, 0
    v_accvgpr_write_b32 a91, 0
    v_accvgpr_write_b32 a92, 0
    v_accvgpr_write_b32 a93, 0
    v_accvgpr_write_b32 a94, 0
    v_accvgpr_write_b32 a95, 0
    v_accvgpr_write_b32 a96, 0
    v_accvgpr_write_b32 a97, 0
    v_accvgpr_write_b32 a98, 0
    v_accvgpr_write_b32 a99, 0
    v_accvgpr_write_b32 a100, 0
    v_accvgpr_write_b32 a101, 0
    v_accvgpr_write_b32 a102, 0
    v_accvgpr_write_b32 a103, 0
    v_accvgpr_write_b32 a104, 0
    v_accvgpr_write_b32 a105, 0
    v_accvgpr_write_b32 a106, 0
    v_accvgpr_write_b32 a107, 0
    v_accvgpr_write_b32 a108, 0
    v_accvgpr_write_b32 a109, 0
    v_accvgpr_write_b32 a110, 0
    v_accvgpr_write_b32 a111, 0
    v_accvgpr_write_b32 a112, 0
    v_accvgpr_write_b32 a113, 0
    v_accvgpr_write_b32 a114, 0
    v_accvgpr_write_b32 a115, 0
    v_accvgpr_write_b32 a116, 0
    v_accvgpr_write_b32 a117, 0
    v_accvgpr_write_b32 a118, 0
    v_accvgpr_write_b32 a119, 0
    v_accvgpr_write_b32 a120, 0
    v_accvgpr_write_b32 a121, 0
    v_accvgpr_write_b32 a122, 0
    v_accvgpr_write_b32 a123, 0
    v_accvgpr_write_b32 a124, 0
    v_accvgpr_write_b32 a125, 0
    v_accvgpr_write_b32 a126, 0
    v_accvgpr_write_b32 a127, 0
    v_accvgpr_write_b32 a192, 0
    v_accvgpr_write_b32 a193, 0
    v_accvgpr_write_b32 a194, 0
    v_accvgpr_write_b32 a195, 0
    v_accvgpr_write_b32 a196, 0
    v_accvgpr_write_b32 a197, 0
    v_accvgpr_write_b32 a198, 0
    v_accvgpr_write_b32 a199, 0
    v_accvgpr_write_b32 a200, 0
    v_accvgpr_write_b32 a201, 0
    v_accvgpr_write_b32 a202, 0
    v_accvgpr_write_b32 a203, 0
    v_accvgpr_write_b32 a204, 0
    v_accvgpr_write_b32 a205, 0
    v_accvgpr_write_b32 a206, 0
    v_accvgpr_write_b32 a207, 0
    s_waitcnt vmcnt(0) lgkmcnt(0)
    s_barrier
    ds_read_b128 a[208:211], v8 offset:0
    ds_read_b128 a[212:215], v9 offset:0
    ds_read_b128 a[216:219], v10 offset:0
    ds_read_b128 a[220:223], v11 offset:0
    ds_read_b128 a[224:227], v8 offset:4096
    s_waitcnt vmcnt(0) lgkmcnt(0)
    s_branch Lattn_stage0
Lattn_armwait:
    s_mov_b32 s36, 16384
Lattn_armloop:
    v_mov_b32 v63, 0
    buffer_load_dword v63, v63, s[88:91], 0 offen sc1
    s_waitcnt vmcnt(0)
    v_readfirstlane_b32 s37, v63
    s_sub_u32 s36, s36, 1
    s_cbranch_scc1 Lattn_armed
    s_cmp_lt_u32 s37, 256
    s_cbranch_scc1 Lattn_armloop
    s_branch Lattn_armed
Lattn_end:
    s_endpgm
.section .rodata,"a"
.p2align 6
.amdhsa_kernel adaLN_cond__gqa_block_cached__moe_arch_mod__prompt_kernel
  .amdhsa_next_free_vgpr 512
  .amdhsa_next_free_sgpr 102
  .amdhsa_accum_offset 256
  .amdhsa_group_segment_fixed_size 0
  .amdhsa_kernarg_size 120
  .amdhsa_user_sgpr_count 2
  .amdhsa_user_sgpr_kernarg_segment_ptr 1
  .amdhsa_system_sgpr_workgroup_id_x 1
  .amdhsa_float_denorm_mode_32 3
.end_amdhsa_kernel
```

```asm
; @launch grid=(256,1,1) block=(256,1,1) lds=163840
.amdgcn_target "amdgcn-amd-amdhsa--gfx950"
.text
.globl adaLN_cond__gqa_block_cached__moe_arch_mod__prompt_kernel
.p2align 8
.type adaLN_cond__gqa_block_cached__moe_arch_mod__prompt_kernel,@function
adaLN_cond__gqa_block_cached__moe_arch_mod__prompt_kernel:
    s_cmp_ge_u32 s2, 256
    s_cbranch_scc1 Lattn_end
    s_load_dwordx2 s[8:9], s[0:1], 80
    s_load_dwordx2 s[12:13], s[0:1], 88
    s_load_dwordx2 s[20:21], s[0:1], 0
    s_load_dwordx2 s[50:51], s[0:1], 112
    s_load_dwordx8 s[52:59], s[0:1], 8
    s_load_dwordx4 s[80:83], s[0:1], 56
    s_load_dwordx2 s[84:85], s[0:1], 72
    s_load_dwordx2 s[88:89], s[0:1], 104
    s_getpc_b64 s[32:33]
Lattn_pc:
    s_mov_b32 s34, Lattn_end-Lattn_pc
    s_mov_b32 s35, 0x20000
    s_lshr_b32 s6, s2, 3
    s_lshl_b32 s7, s6, 6
    v_lshrrev_b32 v3, 6, v0
    v_and_b32 v1, 63, v0
    v_lshrrev_b32 v2, 2, v0
    v_lshlrev_b32 v2, 11, v2
    v_readfirstlane_b32 s3, v3
    buffer_load_dword v240, v2, s[32:35], s7 offen
    s_and_b32 s7, s2, 7
    s_lshl_b32 s4, s7, 1
    s_and_b32 s5, s6, 1
    s_add_u32 s4, s4, s5
    s_lshr_b32 s5, s2, 4
    s_lshr_b32 s38, s6, 2
    s_lshl_b32 s38, s38, 3
    s_add_u32 s38, s38, s7
    s_cmp_lt_u32 s38, 54
    s_cselect_b32 s39, 0, 2147483648
    s_lshl_b32 s38, s38, 2
    s_and_b32 s36, s6, 3
    s_add_u32 s38, s38, s36
    s_mov_b32 s14, 3981312
    s_mul_i32 s92, s6, 124416
    s_lshl_b32 s36, s7, 7
    s_add_u32 s92, s92, s36
    v_lshrrev_b32 v2, 2, v0
    v_min_u32 v2, 53, v2
    v_mul_u32_u24 v3, 86, v2
    v_lshrrev_b32 v3, 8, v3
    v_mul_u32_u24 v3, 3840, v3
    v_lshl_add_u32 v72, v2, 10, v3
    s_mov_b32 s15, 0x20000
    s_mov_b32 s10, 1152
    s_mov_b32 s11, 0x20000
    s_mov_b32 s22, 2359296
    s_mov_b32 s23, 0x20000
    v_and_b32 v64, 0xfe, v0
    v_mul_u32_u24 v65, 3456, v64
    v_and_b32 v2, 1, v0
    v_lshl_add_u32 v65, v2, 4, v65
    s_lshl_b32 s36, s38, 5
    s_or_b32 s36, s36, s39
    v_and_b32 v4, 31, v1
    v_lshrrev_b32 v5, 5, v1
    v_cmp_gt_u32 vcc, 24, v4
    v_mov_b32 v6, 2147483648
    s_lshl_b32 s7, s5, 4
    s_add_u32 s7, s7, s4
    s_lshl_b32 s7, s7, 2
    s_add_u32 s7, s7, s3
    v_cndmask_b32 v6, v6, 0, vcc
    s_mul_i32 s37, s7, 2304
    v_lshrrev_b32 v7, 2, v4
    v_lshl_add_u32 v7, v7, 6, v6
    v_and_b32 v2, 3, v4
    v_lshl_add_u32 v7, v2, 3, v7
    v_mul_u32_u24 v2, 1152, v5
    v_add_u32 v66, v7, v2
    s_waitcnt lgkmcnt(0)
    s_load_dword s94, s[50:51], 24576
    buffer_load_dword v241, v72, s[12:15], s92 offen
    buffer_load_ushort v80, v64, s[8:11], 0 offen offset:0
    buffer_load_ushort v81, v64, s[8:11], 0 offen offset:256
    buffer_load_ushort v82, v64, s[8:11], 0 offen offset:512
    buffer_load_ushort v83, v64, s[8:11], 0 offen offset:768
    buffer_load_ushort v84, v64, s[8:11], 0 offen offset:1024
    buffer_load_dwordx2 v[108:109], v66, s[20:23], s37 offen offset:0
    buffer_load_dwordx2 v[110:111], v66, s[20:23], s37 offen offset:32
    buffer_load_dwordx2 v[112:113], v66, s[20:23], s37 offen offset:384
    buffer_load_dwordx2 v[114:115], v66, s[20:23], s37 offen offset:416
    buffer_load_dwordx2 v[116:117], v66, s[20:23], s37 offen offset:768
    buffer_load_dwordx2 v[118:119], v66, s[20:23], s37 offen offset:800
    buffer_load_dwordx4 v[88:91], v65, s[12:15], s36 offen
    s_add_u32 s36, s36, 884736
    buffer_load_dwordx4 v[92:95], v65, s[12:15], s36 offen
    s_add_u32 s36, s36, 884736
    buffer_load_dwordx4 v[96:99], v65, s[12:15], s36 offen
    s_add_u32 s36, s36, 884736
    buffer_load_dwordx4 v[100:103], v65, s[12:15], s36 offen
    s_add_u32 s36, s36, 884736
    buffer_load_dwordx4 v[104:107], v65, s[12:15], s36 offen
    s_mov_b32 s16, s56
    s_mov_b32 s17, s57
    s_mov_b32 s18, 4718592
    s_mov_b32 s19, 0x20000
    s_lshl_b32 s44, s4, 9
    s_mul_i32 s36, s5, 294912
    v_min_u32 v2, 143, v0
    v_lshrrev_b32 v3, 2, v2
    v_and_b32 v2, 3, v2
    v_lshl_add_u32 v2, v2, 7, s36
    v_lshl_add_u32 v71, v3, 13, v2
    s_add_u32 s92, s37, 65536
    v_lshl_add_u32 v7, v5, 4, v6
    v_lshl_add_u32 v67, v4, 5, v7
    v_min_u32 v4, 23, v4
    v_lshlrev_b32 v68, 4, v4
    s_mov_b32 s24, s50
    s_mov_b32 s25, s51
    s_mov_b32 s26, 10485760
    s_mov_b32 s27, 0x20000
    s_mov_b32 s90, 256
    s_mov_b32 s91, 0x20000
    s_mul_i32 s36, s38, 1821
    s_lshr_b32 s36, s36, 16
    s_cmp_eq_u32 s36, 1
    s_cselect_b32 s93, 1.0, 0
    s_cmp_eq_u32 s36, 4
    s_cselect_b32 s93, 1.0, s93
    s_lshr_b32 s36, s38, 1
    s_lshl_b32 s36, s36, 6
    s_and_b32 s37, s38, 1
    s_lshl_b32 s37, s37, 3
    s_add_u32 s36, s36, s37
    v_lshrrev_b32 v2, 1, v0
    v_lshl_add_u32 v2, v2, 4, s36
    v_and_b32 v3, 1, v0
    v_lshl_add_u32 v70, v3, 2, v2
    v_lshlrev_b32 v69, 1, v70
    v_cmp_gt_u32 s[36:37], 8, v0
    v_mov_b32 v2, 2147483648
    v_mov_b32 v3, s39
    v_cndmask_b32 v2, v2, v3, s[36:37]
    v_or_b32 v69, v69, v2
    v_or_b32 v70, v70, v2
    s_lshl_b32 s42, s3, 12
    v_lshrrev_b32 v2, 4, v1
    v_and_b32 v3, 15, v1
    v_lshrrev_b32 v5, 1, v3
    v_mul_u32_u24 v5, 2304, v5
    v_lshl_add_u32 v5, v2, 5, v5
    v_and_b32 v6, 1, v3
    v_lshl_add_u32 v51, v6, 4, v5
    s_lshl_b32 s6, s5, 2
    s_add_u32 s6, s6, s3
    s_mul_i32 s46, s6, 36864
    s_add_u32 s46, s46, 65536
    s_add_u32 s43, s46, 18432
    s_mul_i32 s45, s4, 294912
    s_lshl_b32 s7, s3, 4
    v_add_u32 v4, s7, v2
    v_lshlrev_b32 v5, 1, v2
    v_xor_b32 v5, v5, v3
    v_xor_b32 v6, 8, v5
    v_lshlrev_b32 v7, 13, v4
    v_lshl_add_u32 v42, v5, 4, v7
    v_lshl_add_u32 v43, v6, 4, v7
    v_add_u32 v44, 63488, v42
    v_add_u32 v45, 95232, v43
    v_add_u32 v43, 31744, v43
    s_lshl_b32 s7, s4, 19
    s_add_u32 s8, s52, s7
    s_addc_u32 s9, s53, 0
    s_mov_b32 s10, 524288
    s_mov_b32 s11, 0x20000
    s_add_u32 s12, s54, s7
    s_addc_u32 s13, s55, 0
    s_mov_b32 s14, 524288
    s_mov_b32 s15, 0x20000
    s_mov_b32 s20, s58
    s_mov_b32 s21, s59
    s_mov_b32 s22, 4718592
    s_mov_b32 s23, 0x20000
    s_add_u32 s28, s50, 10485760
    s_addc_u32 s29, s51, 0
    s_mov_b32 s30, 37748736
    s_mov_b32 s31, 0x20000
    v_lshlrev_b32 v7, 8, v4
    v_lshl_add_u32 v40, v5, 4, v7
    v_lshl_add_u32 v41, v6, 4, v7
    v_xor_b32 v224, v3, v2
    v_lshl_add_u32 v36, v224, 4, v7
    v_xor_b32 v37, 64, v36
    v_xor_b32 v38, 128, v36
    v_xor_b32 v39, 192, v36
    v_lshrrev_b32 v7, 3, v5
    v_lshl_add_u32 v7, v7, 7, v4
    v_mul_u32_u24 v7, 1152, v7
    v_and_b32 v225, 7, v5
    v_lshl_add_u32 v46, v225, 4, v7
    v_lshrrev_b32 v7, 3, v6
    v_lshl_add_u32 v7, v7, 7, v4
    v_mul_u32_u24 v7, 1152, v7
    v_and_b32 v225, 7, v6
    v_lshl_add_u32 v47, v225, 4, v7
    v_add_u32 v48, 7168, v46
    v_add_u32 v49, 10752, v47
    v_add_u32 v47, 3584, v47
    v_lshlrev_b32 v7, 8, v3
    v_lshl_add_u32 v8, v224, 4, v7
    v_xor_b32 v9, 64, v8
    v_xor_b32 v10, 128, v8
    v_xor_b32 v11, 192, v8
    v_lshrrev_b32 v5, 2, v1
    v_and_b32 v6, 7, v5
    v_lshlrev_b32 v6, 5, v6
    v_lshl_add_u32 v6, v5, 8, v6
    v_and_b32 v7, 3, v1
    v_lshl_add_u32 v12, v7, 3, v6
    v_xor_b32 v13, 32, v12
    v_xor_b32 v14, 64, v12
    v_xor_b32 v15, 96, v12
    v_xor_b32 v16, 128, v12
    v_xor_b32 v17, 160, v12
    v_xor_b32 v18, 192, v12
    v_xor_b32 v19, 224, v12
    v_add_u32 v20, 65536, v12
    v_add_u32 v21, 65536, v13
    v_add_u32 v22, 65536, v14
    v_add_u32 v23, 65536, v15
    v_add_u32 v24, 65536, v16
    v_add_u32 v25, 65536, v17
    v_add_u32 v26, 65536, v18
    v_add_u32 v27, 65536, v19
    v_add_u32 v28, 131072, v12
    v_add_u32 v29, 131072, v13
    v_add_u32 v30, 131072, v14
    v_add_u32 v31, 131072, v15
    v_add_u32 v32, 131072, v16
    v_add_u32 v33, 131072, v17
    v_add_u32 v34, 131072, v18
    v_add_u32 v35, 131072, v19
    v_mov_b32 v52, 0x3f803f80
    v_mov_b32 v53, 0x3f803f80
    v_mov_b32 v54, 0x3f803f80
    v_mov_b32 v55, 0x3f803f80
    v_and_b32 v5, 1, v1
    v_mul_u32_u24 v5, 0xaaaa, v5
    v_add_u32 v5, 0x4444, v5
    v_lshl_add_u32 v50, v5, 16, v5
    v_lshrrev_b32 v5, 1, v3
    v_mul_u32_u24 v5, 20480, v5
    v_lshl_add_u32 v5, v2, 5, v5
    v_and_b32 v6, 1, v3
    v_lshl_add_u32 v56, v6, 4, v5
    s_mul_i32 s47, s6, 327680
    s_mov_b32 s32, s82
    s_mov_b32 s33, s83
    s_mov_b32 s34, 5308416
    s_mov_b32 s35, 0x20000
    s_mov_b32 s82, 5308416
    s_mov_b32 s83, 0x20000
    s_mov_b32 s86, 5308416
    s_mov_b32 s87, 0x20000
    s_lshr_b32 s7, s2, 3
    s_mul_i32 s7, s7, 18
    s_add_u32 s7, s7, s3
    s_and_b32 s36, s2, 7
    s_mul_i32 s37, s36, 576
    s_add_u32 s37, s37, s7
    s_mul_i32 s37, s37, 1152
    s_mul_i32 s7, s7, 9216
    s_mul_i32 s36, s36, 1152
    s_add_u32 s7, s7, s36
    v_min_u32 v5, 17, v1
    v_lshl_add_u32 v57, v5, 6, s7
    v_lshl_add_u32 v62, v5, 6, s37
    s_mov_b32 s40, 0
    s_mov_b32 s41, 0
    s_mov_b32 s48, 0
    s_waitcnt vmcnt(15)
    v_lshlrev_b32 v80, 16, v80
    s_waitcnt vmcnt(14)
    v_lshlrev_b32 v81, 16, v81
    s_waitcnt vmcnt(13)
    v_lshlrev_b32 v82, 16, v82
    s_waitcnt vmcnt(12)
    v_lshlrev_b32 v83, 16, v83
    s_waitcnt vmcnt(11)
    v_lshlrev_b32 v84, 16, v84
    v_mul_f32 v144, 0xbfb8aa3b, v80
    v_mul_f32 v148, 0xbfb8aa3b, v81
    v_mul_f32 v152, 0xbfb8aa3b, v82
    v_mul_f32 v156, 0xbfb8aa3b, v83
    v_mul_f32 v160, 0xbfb8aa3b, v84
    v_min_f32 v144, 0x42fc0000, v144
    v_min_f32 v148, 0x42fc0000, v148
    v_min_f32 v152, 0x42fc0000, v152
    v_min_f32 v156, 0x42fc0000, v156
    v_min_f32 v160, 0x42fc0000, v160
    v_exp_f32 v144, v144
    v_exp_f32 v148, v148
    v_exp_f32 v152, v152
    v_exp_f32 v156, v156
    v_exp_f32 v160, v160
    v_add_f32 v144, 1.0, v144
    v_add_f32 v148, 1.0, v148
    v_add_f32 v152, 1.0, v152
    v_add_f32 v156, 1.0, v156
    v_add_f32 v160, 1.0, v160
    v_rcp_f32 v145, v144
    v_rcp_f32 v149, v148
    v_rcp_f32 v153, v152
    v_rcp_f32 v157, v156
    v_rcp_f32 v161, v160
    v_mul_f32 v146, v80, v145
    v_mul_f32 v150, v81, v149
    v_mul_f32 v154, v82, v153
    v_mul_f32 v158, v83, v157
    v_mul_f32 v162, v84, v161
    v_fma_f32 v144, -v146, v144, v80
    v_fma_f32 v148, -v150, v148, v81
    v_fma_f32 v152, -v154, v152, v82
    v_fma_f32 v156, -v158, v156, v83
    v_fma_f32 v160, -v162, v160, v84
    v_fma_f32 v80, v144, v145, v146
    v_fma_f32 v81, v148, v149, v150
    v_fma_f32 v82, v152, v153, v154
    v_fma_f32 v83, v156, v157, v158
    v_fma_f32 v84, v160, v161, v162
    v_cvt_pk_bf16_f32 v80, v80, v80
    v_cvt_pk_bf16_f32 v81, v81, v81
    v_cvt_pk_bf16_f32 v82, v82, v82
    v_cvt_pk_bf16_f32 v83, v83, v83
    v_cvt_pk_bf16_f32 v84, v84, v84
    v_and_b32 v80, 0xffff0000, v80
    v_and_b32 v81, 0xffff0000, v81
    v_and_b32 v82, 0xffff0000, v82
    v_and_b32 v83, 0xffff0000, v83
    v_and_b32 v84, 0xffff0000, v84
    s_waitcnt vmcnt(4)
    v_lshlrev_b32 v136, 16, v88
    v_and_b32 v137, 0xffff0000, v88
    v_lshlrev_b32 v138, 16, v89
    v_and_b32 v139, 0xffff0000, v89
    v_lshlrev_b32 v140, 16, v90
    v_and_b32 v141, 0xffff0000, v90
    v_lshlrev_b32 v142, 16, v91
    v_and_b32 v143, 0xffff0000, v91
    v_pk_mul_f32 v[128:129], v[136:137], v[80:81] op_sel:[0,0] op_sel_hi:[1,0]
    v_pk_mul_f32 v[130:131], v[138:139], v[80:81] op_sel:[0,0] op_sel_hi:[1,0]
    v_pk_mul_f32 v[132:133], v[140:141], v[80:81] op_sel:[0,0] op_sel_hi:[1,0]
    v_pk_mul_f32 v[134:135], v[142:143], v[80:81] op_sel:[0,0] op_sel_hi:[1,0]
    s_waitcnt vmcnt(3)
    v_lshlrev_b32 v136, 16, v92
    v_and_b32 v137, 0xffff0000, v92
    v_lshlrev_b32 v138, 16, v93
    v_and_b32 v139, 0xffff0000, v93
    v_lshlrev_b32 v140, 16, v94
    v_and_b32 v141, 0xffff0000, v94
    v_lshlrev_b32 v142, 16, v95
    v_and_b32 v143, 0xffff0000, v95
    v_pk_fma_f32 v[128:129], v[136:137], v[80:81], v[128:129] op_sel:[0,1,0] op_sel_hi:[1,1,1]
    v_pk_fma_f32 v[130:131], v[138:139], v[80:81], v[130:131] op_sel:[0,1,0] op_sel_hi:[1,1,1]
    v_pk_fma_f32 v[132:133], v[140:141], v[80:81], v[132:133] op_sel:[0,1,0] op_sel_hi:[1,1,1]
    v_pk_fma_f32 v[134:135], v[142:143], v[80:81], v[134:135] op_sel:[0,1,0] op_sel_hi:[1,1,1]
    s_waitcnt vmcnt(2)
    v_lshlrev_b32 v136, 16, v96
    v_and_b32 v137, 0xffff0000, v96
    v_lshlrev_b32 v138, 16, v97
    v_and_b32 v139, 0xffff0000, v97
    v_lshlrev_b32 v140, 16, v98
    v_and_b32 v141, 0xffff0000, v98
    v_lshlrev_b32 v142, 16, v99
    v_and_b32 v143, 0xffff0000, v99
    v_pk_fma_f32 v[128:129], v[136:137], v[82:83], v[128:129] op_sel:[0,0,0] op_sel_hi:[1,0,1]
    v_pk_fma_f32 v[130:131], v[138:139], v[82:83], v[130:131] op_sel:[0,0,0] op_sel_hi:[1,0,1]
    v_pk_fma_f32 v[132:133], v[140:141], v[82:83], v[132:133] op_sel:[0,0,0] op_sel_hi:[1,0,1]
    v_pk_fma_f32 v[134:135], v[142:143], v[82:83], v[134:135] op_sel:[0,0,0] op_sel_hi:[1,0,1]
    s_waitcnt vmcnt(1)
    v_lshlrev_b32 v136, 16, v100
    v_and_b32 v137, 0xffff0000, v100
    v_lshlrev_b32 v138, 16, v101
    v_and_b32 v139, 0xffff0000, v101
    v_lshlrev_b32 v140, 16, v102
    v_and_b32 v141, 0xffff0000, v102
    v_lshlrev_b32 v142, 16, v103
    v_and_b32 v143, 0xffff0000, v103
    v_pk_fma_f32 v[128:129], v[136:137], v[82:83], v[128:129] op_sel:[0,1,0] op_sel_hi:[1,1,1]
    v_pk_fma_f32 v[130:131], v[138:139], v[82:83], v[130:131] op_sel:[0,1,0] op_sel_hi:[1,1,1]
    v_pk_fma_f32 v[132:133], v[140:141], v[82:83], v[132:133] op_sel:[0,1,0] op_sel_hi:[1,1,1]
    v_pk_fma_f32 v[134:135], v[142:143], v[82:83], v[134:135] op_sel:[0,1,0] op_sel_hi:[1,1,1]
    s_waitcnt vmcnt(0)
    v_lshlrev_b32 v136, 16, v104
    v_and_b32 v137, 0xffff0000, v104
    v_lshlrev_b32 v138, 16, v105
    v_and_b32 v139, 0xffff0000, v105
    v_lshlrev_b32 v140, 16, v106
    v_and_b32 v141, 0xffff0000, v106
    v_lshlrev_b32 v142, 16, v107
    v_and_b32 v143, 0xffff0000, v107
    v_pk_fma_f32 v[128:129], v[136:137], v[84:85], v[128:129] op_sel:[0,0,0] op_sel_hi:[1,0,1]
    v_pk_fma_f32 v[130:131], v[138:139], v[84:85], v[130:131] op_sel:[0,0,0] op_sel_hi:[1,0,1]
    v_pk_fma_f32 v[132:133], v[140:141], v[84:85], v[132:133] op_sel:[0,0,0] op_sel_hi:[1,0,1]
    v_pk_fma_f32 v[134:135], v[142:143], v[84:85], v[134:135] op_sel:[0,0,0] op_sel_hi:[1,0,1]
    buffer_load_dword v242, v71, s[16:19], s44 offen
    v_permlane32_swap_b32 v128, v132
    v_permlane32_swap_b32 v129, v133
    v_permlane32_swap_b32 v130, v134
    v_permlane32_swap_b32 v131, v135
    v_and_b32 v72, 1, v1
    v_pk_add_f32 v[128:129], v[128:129], v[132:133]
    v_pk_add_f32 v[130:131], v[130:131], v[134:135]
    v_lshlrev_b32 v72, 5, v72
    v_lshrrev_b32 v73, 4, v1
    v_permlane16_swap_b32 v128, v130
    v_permlane16_swap_b32 v129, v131
    v_lshl_add_u32 v72, v73, 3, v72
    v_pk_add_f32 v[128:129], v[128:129], v[130:131]
    s_lshl_b32 s36, s3, 6
    v_add_u32 v72, s36, v72
    v_add_f32_dpp v128, v128, v128 row_ror:2 row_mask:0xf bank_mask:0xf
    v_add_f32_dpp v129, v129, v129 row_ror:2 row_mask:0xf bank_mask:0xf
    s_nop 0
    v_add_f32_dpp v128, v128, v128 row_ror:4 row_mask:0xf bank_mask:0xf
    v_add_f32_dpp v129, v129, v129 row_ror:4 row_mask:0xf bank_mask:0xf
    s_nop 0
    v_add_f32_dpp v128, v128, v128 row_ror:8 row_mask:0xf bank_mask:0xf
    v_add_f32_dpp v129, v129, v129 row_ror:8 row_mask:0xf bank_mask:0xf
    ds_write_b64 v72, v[128:129] offset:0
    v_and_b32 v73, 7, v1
    v_lshlrev_b32 v73, 3, v73
    s_waitcnt lgkmcnt(0)
    s_barrier
    ds_read_b64 v[128:129], v73 offset:0
    ds_read_b64 v[130:131], v73 offset:64
    ds_read_b64 v[132:133], v73 offset:128
    ds_read_b64 v[134:135], v73 offset:192
    s_add_u32 s95, s94, 0x9e3779b9
    v_mov_b32 v137, s95
    s_mov_b32 s36, 16384
    s_waitcnt lgkmcnt(2)
    v_pk_add_f32 v[128:129], v[128:129], v[130:131]
    s_waitcnt lgkmcnt(0)
    v_pk_add_f32 v[132:133], v[132:133], v[134:135]
    v_pk_add_f32 v[128:129], v[128:129], v[132:133]
    v_cvt_pk_bf16_f32 v136, v128, v129
    v_lshlrev_b32 v128, 16, v136
    v_and_b32 v129, 0xffff0000, v136
    v_add_f32 v128, s93, v128
    v_add_f32 v129, s93, v129
    v_cvt_pk_bf16_f32 v136, v128, v129
    buffer_store_dwordx2 v[136:137], v69, s[24:27], 0 offen sc1
    buffer_store_dword v136, v70, s[24:27], s36 offen sc1
    v_lshlrev_b32 v144, 16, v108
    v_and_b32 v145, 0xffff0000, v108
    v_lshlrev_b32 v146, 16, v109
    v_and_b32 v147, 0xffff0000, v109
    v_lshlrev_b32 v148, 16, v110
    v_and_b32 v149, 0xffff0000, v110
    v_lshlrev_b32 v150, 16, v111
    v_and_b32 v151, 0xffff0000, v111
    v_lshlrev_b32 v152, 16, v112
    v_and_b32 v153, 0xffff0000, v112
    v_lshlrev_b32 v154, 16, v113
    v_and_b32 v155, 0xffff0000, v113
    v_lshlrev_b32 v156, 16, v114
    v_and_b32 v157, 0xffff0000, v114
    v_lshlrev_b32 v158, 16, v115
    v_and_b32 v159, 0xffff0000, v115
    v_lshlrev_b32 v160, 16, v116
    v_and_b32 v161, 0xffff0000, v116
    v_lshlrev_b32 v162, 16, v117
    v_and_b32 v163, 0xffff0000, v117
    v_lshlrev_b32 v164, 16, v118
    v_and_b32 v165, 0xffff0000, v118
    v_lshlrev_b32 v166, 16, v119
    v_and_b32 v167, 0xffff0000, v119
    v_pk_add_f32 v[72:73], v[144:145], v[148:149]
    v_pk_add_f32 v[76:77], v[146:147], v[150:151]
    v_pk_add_f32 v[72:73], v[72:73], v[152:153]
    v_pk_add_f32 v[76:77], v[76:77], v[154:155]
    v_pk_add_f32 v[72:73], v[72:73], v[156:157]
    v_pk_add_f32 v[76:77], v[76:77], v[158:159]
    v_pk_add_f32 v[72:73], v[72:73], v[160:161]
    v_pk_add_f32 v[76:77], v[76:77], v[162:163]
    v_pk_add_f32 v[72:73], v[72:73], v[164:165]
    v_pk_add_f32 v[76:77], v[76:77], v[166:167]
    v_pk_add_f32 v[72:73], v[72:73], v[76:77]
    v_add_f32 v72, v72, v73
    s_nop 1
    v_add_f32_dpp v72, v72, v72 row_ror:1 row_mask:0xf bank_mask:0xf
    s_nop 1
    v_add_f32_dpp v72, v72, v72 row_ror:2 row_mask:0xf bank_mask:0xf
    s_nop 1
    v_add_f32_dpp v72, v72, v72 row_ror:4 row_mask:0xf bank_mask:0xf
    s_nop 1
    v_add_f32_dpp v72, v72, v72 row_ror:8 row_mask:0xf bank_mask:0xf
    v_mov_b32 v76, v72
    s_nop 1
    v_permlane16_swap_b32 v72, v76
    s_nop 0
    v_add_f32 v72, v72, v76
    v_mul_f32 v72, 0x3ae38e39, v72
    v_pk_add_f32 v[168:169], v[144:145], v[72:73] op_sel_hi:[1,0] neg_lo:[0,1] neg_hi:[0,1]
    v_pk_add_f32 v[170:171], v[146:147], v[72:73] op_sel_hi:[1,0] neg_lo:[0,1] neg_hi:[0,1]
    v_pk_add_f32 v[172:173], v[148:149], v[72:73] op_sel_hi:[1,0] neg_lo:[0,1] neg_hi:[0,1]
    v_pk_add_f32 v[174:175], v[150:151], v[72:73] op_sel_hi:[1,0] neg_lo:[0,1] neg_hi:[0,1]
    v_pk_add_f32 v[176:177], v[152:153], v[72:73] op_sel_hi:[1,0] neg_lo:[0,1] neg_hi:[0,1]
    v_pk_add_f32 v[178:179], v[154:155], v[72:73] op_sel_hi:[1,0] neg_lo:[0,1] neg_hi:[0,1]
    v_pk_add_f32 v[180:181], v[156:157], v[72:73] op_sel_hi:[1,0] neg_lo:[0,1] neg_hi:[0,1]
    v_pk_add_f32 v[182:183], v[158:159], v[72:73] op_sel_hi:[1,0] neg_lo:[0,1] neg_hi:[0,1]
    v_pk_add_f32 v[184:185], v[160:161], v[72:73] op_sel_hi:[1,0] neg_lo:[0,1] neg_hi:[0,1]
    v_pk_add_f32 v[186:187], v[162:163], v[72:73] op_sel_hi:[1,0] neg_lo:[0,1] neg_hi:[0,1]
    v_pk_add_f32 v[188:189], v[164:165], v[72:73] op_sel_hi:[1,0] neg_lo:[0,1] neg_hi:[0,1]
    v_pk_add_f32 v[190:191], v[166:167], v[72:73] op_sel_hi:[1,0] neg_lo:[0,1] neg_hi:[0,1]
    v_pk_mul_f32 v[74:75], v[168:169], v[168:169]
    v_pk_mul_f32 v[76:77], v[170:171], v[170:171]
    v_pk_fma_f32 v[74:75], v[172:173], v[172:173], v[74:75]
    v_pk_fma_f32 v[76:77], v[174:175], v[174:175], v[76:77]
    v_pk_fma_f32 v[74:75], v[176:177], v[176:177], v[74:75]
    v_pk_fma_f32 v[76:77], v[178:179], v[178:179], v[76:77]
    v_pk_fma_f32 v[74:75], v[180:181], v[180:181], v[74:75]
    v_pk_fma_f32 v[76:77], v[182:183], v[182:183], v[76:77]
    v_pk_fma_f32 v[74:75], v[184:185], v[184:185], v[74:75]
    v_pk_fma_f32 v[76:77], v[186:187], v[186:187], v[76:77]
    v_pk_fma_f32 v[74:75], v[188:189], v[188:189], v[74:75]
    v_pk_fma_f32 v[76:77], v[190:191], v[190:191], v[76:77]
    v_pk_add_f32 v[74:75], v[74:75], v[76:77]
    v_add_f32 v74, v74, v75
    v_cndmask_b32 v74, 0, v74, vcc
    s_nop 1
    v_add_f32_dpp v74, v74, v74 row_ror:1 row_mask:0xf bank_mask:0xf
    s_nop 1
    v_add_f32_dpp v74, v74, v74 row_ror:2 row_mask:0xf bank_mask:0xf
    s_nop 1
    v_add_f32_dpp v74, v74, v74 row_ror:4 row_mask:0xf bank_mask:0xf
    s_nop 1
    v_add_f32_dpp v74, v74, v74 row_ror:8 row_mask:0xf bank_mask:0xf
    v_mov_b32 v76, v74
    s_nop 1
    v_permlane16_swap_b32 v74, v76
    s_nop 0
    v_add_f32 v74, v74, v76
    v_mul_f32 v74, 0x3ae38e39, v74
    v_cvt_pk_bf16_f32 v76, v72, v74
    v_and_b32 v74, 0xffff0000, v76
    v_lshlrev_b32 v72, 16, v76
    v_add_f32 v74, 0x3727c5ac, v74
    v_cvt_pk_bf16_f32 v74, v74, v74
    v_and_b32 v74, 0xffff0000, v74
    v_sqrt_f32 v74, v74
    v_pk_add_f32 v[168:169], v[144:145], v[72:73] op_sel_hi:[1,0] neg_lo:[0,1] neg_hi:[0,1]
    v_pk_add_f32 v[170:171], v[146:147], v[72:73] op_sel_hi:[1,0] neg_lo:[0,1] neg_hi:[0,1]
    v_pk_add_f32 v[172:173], v[148:149], v[72:73] op_sel_hi:[1,0] neg_lo:[0,1] neg_hi:[0,1]
    v_pk_add_f32 v[174:175], v[150:151], v[72:73] op_sel_hi:[1,0] neg_lo:[0,1] neg_hi:[0,1]
    v_pk_add_f32 v[176:177], v[152:153], v[72:73] op_sel_hi:[1,0] neg_lo:[0,1] neg_hi:[0,1]
    v_pk_add_f32 v[178:179], v[154:155], v[72:73] op_sel_hi:[1,0] neg_lo:[0,1] neg_hi:[0,1]
    v_pk_add_f32 v[180:181], v[156:157], v[72:73] op_sel_hi:[1,0] neg_lo:[0,1] neg_hi:[0,1]
    v_pk_add_f32 v[182:183], v[158:159], v[72:73] op_sel_hi:[1,0] neg_lo:[0,1] neg_hi:[0,1]
    v_pk_add_f32 v[184:185], v[160:161], v[72:73] op_sel_hi:[1,0] neg_lo:[0,1] neg_hi:[0,1]
    v_pk_add_f32 v[186:187], v[162:163], v[72:73] op_sel_hi:[1,0] neg_lo:[0,1] neg_hi:[0,1]
    v_pk_add_f32 v[188:189], v[164:165], v[72:73] op_sel_hi:[1,0] neg_lo:[0,1] neg_hi:[0,1]
    v_pk_add_f32 v[190:191], v[166:167], v[72:73] op_sel_hi:[1,0] neg_lo:[0,1] neg_hi:[0,1]
    v_cvt_pk_bf16_f32 v74, v74, v74
    v_and_b32 v74, 0xffff0000, v74
    v_rcp_f32 v74, v74
    v_cvt_pk_bf16_f32 v108, v168, v169
    v_cvt_pk_bf16_f32 v109, v170, v171
    v_cvt_pk_bf16_f32 v110, v172, v173
    v_cvt_pk_bf16_f32 v111, v174, v175
    v_cvt_pk_bf16_f32 v112, v176, v177
    v_cvt_pk_bf16_f32 v113, v178, v179
    v_cvt_pk_bf16_f32 v114, v180, v181
    v_cvt_pk_bf16_f32 v115, v182, v183
    v_cvt_pk_bf16_f32 v116, v184, v185
    v_cvt_pk_bf16_f32 v117, v186, v187
    v_cvt_pk_bf16_f32 v118, v188, v189
    v_cvt_pk_bf16_f32 v119, v190, v191
    v_lshlrev_b32 v168, 16, v108
    v_and_b32 v169, 0xffff0000, v108
    v_lshlrev_b32 v170, 16, v109
    v_and_b32 v171, 0xffff0000, v109
    v_lshlrev_b32 v172, 16, v110
    v_and_b32 v173, 0xffff0000, v110
    v_lshlrev_b32 v174, 16, v111
    v_and_b32 v175, 0xffff0000, v111
    v_lshlrev_b32 v176, 16, v112
    v_and_b32 v177, 0xffff0000, v112
    v_lshlrev_b32 v178, 16, v113
    v_and_b32 v179, 0xffff0000, v113
    v_lshlrev_b32 v180, 16, v114
    v_and_b32 v181, 0xffff0000, v114
    v_lshlrev_b32 v182, 16, v115
    v_and_b32 v183, 0xffff0000, v115
    v_lshlrev_b32 v184, 16, v116
    v_and_b32 v185, 0xffff0000, v116
    v_lshlrev_b32 v186, 16, v117
    v_and_b32 v187, 0xffff0000, v117
    v_lshlrev_b32 v188, 16, v118
    v_and_b32 v189, 0xffff0000, v118
    v_lshlrev_b32 v190, 16, v119
    v_and_b32 v191, 0xffff0000, v119
    v_pk_mul_f32 v[168:169], v[168:169], v[74:75] op_sel_hi:[1,0]
    v_pk_mul_f32 v[170:171], v[170:171], v[74:75] op_sel_hi:[1,0]
    v_pk_mul_f32 v[172:173], v[172:173], v[74:75] op_sel_hi:[1,0]
    v_pk_mul_f32 v[174:175], v[174:175], v[74:75] op_sel_hi:[1,0]
    v_pk_mul_f32 v[176:177], v[176:177], v[74:75] op_sel_hi:[1,0]
    v_pk_mul_f32 v[178:179], v[178:179], v[74:75] op_sel_hi:[1,0]
    v_pk_mul_f32 v[180:181], v[180:181], v[74:75] op_sel_hi:[1,0]
    v_pk_mul_f32 v[182:183], v[182:183], v[74:75] op_sel_hi:[1,0]
    v_pk_mul_f32 v[184:185], v[184:185], v[74:75] op_sel_hi:[1,0]
    v_pk_mul_f32 v[186:187], v[186:187], v[74:75] op_sel_hi:[1,0]
    v_pk_mul_f32 v[188:189], v[188:189], v[74:75] op_sel_hi:[1,0]
    v_pk_mul_f32 v[190:191], v[190:191], v[74:75] op_sel_hi:[1,0]
    v_cvt_pk_bf16_f32 v108, v168, v169
    v_cvt_pk_bf16_f32 v109, v170, v171
    v_cvt_pk_bf16_f32 v110, v172, v173
    v_cvt_pk_bf16_f32 v111, v174, v175
    v_cvt_pk_bf16_f32 v112, v176, v177
    v_cvt_pk_bf16_f32 v113, v178, v179
    v_cvt_pk_bf16_f32 v114, v180, v181
    v_cvt_pk_bf16_f32 v115, v182, v183
    v_cvt_pk_bf16_f32 v116, v184, v185
    v_cvt_pk_bf16_f32 v117, v186, v187
    v_cvt_pk_bf16_f32 v118, v188, v189
    v_cvt_pk_bf16_f32 v119, v190, v191
    v_lshlrev_b32 v168, 16, v108
    v_and_b32 v169, 0xffff0000, v108
    v_lshlrev_b32 v170, 16, v109
    v_and_b32 v171, 0xffff0000, v109
    v_lshlrev_b32 v172, 16, v110
    v_and_b32 v173, 0xffff0000, v110
    v_lshlrev_b32 v174, 16, v111
    v_and_b32 v175, 0xffff0000, v111
    v_lshlrev_b32 v176, 16, v112
    v_and_b32 v177, 0xffff0000, v112
    v_lshlrev_b32 v178, 16, v113
    v_and_b32 v179, 0xffff0000, v113
    v_lshlrev_b32 v180, 16, v114
    v_and_b32 v181, 0xffff0000, v114
    v_lshlrev_b32 v182, 16, v115
    v_and_b32 v183, 0xffff0000, v115
    v_lshlrev_b32 v184, 16, v116
    v_and_b32 v185, 0xffff0000, v116
    v_lshlrev_b32 v186, 16, v117
    v_and_b32 v187, 0xffff0000, v117
    v_lshlrev_b32 v188, 16, v118
    v_and_b32 v189, 0xffff0000, v118
    v_lshlrev_b32 v190, 16, v119
    v_and_b32 v191, 0xffff0000, v119
    s_mul_i32 s36, s3, 72
    v_add_u32 v72, s36, v1
    v_and_b32 v73, 7, v1
    s_add_u32 s36, s36, 64
    v_add_u32 v73, s36, v73
    v_lshlrev_b32 v74, 4, v72
    v_lshlrev_b32 v75, 4, v73
    s_movk_i32 s36, 1024
    v_lshl_add_u32 v72, v72, 3, s36
    v_lshl_add_u32 v73, v73, 3, s36
    s_add_u32 s49, s44, 0
    s_add_u32 m0, s42, 32768
    s_nop 0
    buffer_load_dwordx4 v42, s[16:19], s49 offen lds
    buffer_load_dwordx4 v43, s[16:19], s49 offen offset:1024 lds
    buffer_load_dwordx4 v44, s[16:19], s49 offen offset:2048 lds
    buffer_load_dwordx4 v45, s[16:19], s49 offen offset:3072 lds
    s_add_u32 s49, s44, 256
    s_add_u32 m0, s42, 49152
    s_nop 0
    buffer_load_dwordx4 v42, s[16:19], s49 offen lds
    buffer_load_dwordx4 v43, s[16:19], s49 offen offset:1024 lds
    buffer_load_dwordx4 v44, s[16:19], s49 offen offset:2048 lds
    buffer_load_dwordx4 v45, s[16:19], s49 offen offset:3072 lds
Lhead_tour:
    s_mov_b32 s38, 16384
Lhead_pollm:
    buffer_load_dwordx4 v[88:91], v74, s[24:27], 0 offen sc1
    buffer_load_dwordx4 v[92:95], v75, s[24:27], 0 offen sc1
    s_sub_u32 s38, s38, 1
    s_cbranch_scc1 Lhead_gotm
    s_waitcnt vmcnt(0) lgkmcnt(0)
    v_xor_b32 v89, s95, v89
    v_xor_b32 v91, s95, v91
    v_xor_b32 v93, s95, v93
    v_xor_b32 v95, s95, v95
    v_or3_b32 v89, v89, v91, v93
    v_or_b32 v89, v89, v95
    v_cmp_ne_u32 vcc, 0, v89
    s_cbranch_vccnz Lhead_pollm
Lhead_gotm:
    s_waitcnt vmcnt(0) lgkmcnt(0)
    ds_write2_b32 v72, v88, v90 offset0:0 offset1:1
    ds_write2_b32 v73, v92, v94 offset0:0 offset1:1
    s_waitcnt lgkmcnt(0)
    s_barrier
    ds_read_b128 v[144:147], v68 offset:2176
    ds_read_b128 v[148:151], v68 offset:2560
    ds_read_b128 v[152:155], v68 offset:2944
    ds_read_b128 v[156:159], v68 offset:1024
    ds_read_b128 v[160:163], v68 offset:1408
    ds_read_b128 v[164:167], v68 offset:1792
    s_waitcnt lgkmcnt(5)
    v_lshlrev_b32 v192, 16, v144
    v_and_b32 v193, 0xffff0000, v144
    v_lshlrev_b32 v194, 16, v145
    v_and_b32 v195, 0xffff0000, v145
    v_lshlrev_b32 v196, 16, v146
    v_and_b32 v197, 0xffff0000, v146
    v_lshlrev_b32 v198, 16, v147
    v_and_b32 v199, 0xffff0000, v147
    s_waitcnt lgkmcnt(4)
    v_lshlrev_b32 v200, 16, v148
    v_and_b32 v201, 0xffff0000, v148
    v_lshlrev_b32 v202, 16, v149
    v_and_b32 v203, 0xffff0000, v149
    v_lshlrev_b32 v204, 16, v150
    v_and_b32 v205, 0xffff0000, v150
    v_lshlrev_b32 v206, 16, v151
    v_and_b32 v207, 0xffff0000, v151
    s_waitcnt lgkmcnt(3)
    v_lshlrev_b32 v208, 16, v152
    v_and_b32 v209, 0xffff0000, v152
    v_lshlrev_b32 v210, 16, v153
    v_and_b32 v211, 0xffff0000, v153
    v_lshlrev_b32 v212, 16, v154
    v_and_b32 v213, 0xffff0000, v154
    v_lshlrev_b32 v214, 16, v155
    v_and_b32 v215, 0xffff0000, v155
    v_pk_mul_f32 v[168:169], v[168:169], v[192:193]
    v_pk_mul_f32 v[170:171], v[170:171], v[194:195]
    v_pk_mul_f32 v[172:173], v[172:173], v[196:197]
    v_pk_mul_f32 v[174:175], v[174:175], v[198:199]
    v_pk_mul_f32 v[176:177], v[176:177], v[200:201]
    v_pk_mul_f32 v[178:179], v[178:179], v[202:203]
    v_pk_mul_f32 v[180:181], v[180:181], v[204:205]
    v_pk_mul_f32 v[182:183], v[182:183], v[206:207]
    v_pk_mul_f32 v[184:185], v[184:185], v[208:209]
    v_pk_mul_f32 v[186:187], v[186:187], v[210:211]
    v_pk_mul_f32 v[188:189], v[188:189], v[212:213]
    v_pk_mul_f32 v[190:191], v[190:191], v[214:215]
    v_cvt_pk_bf16_f32 v108, v168, v169
    v_cvt_pk_bf16_f32 v109, v170, v171
    v_cvt_pk_bf16_f32 v110, v172, v173
    v_cvt_pk_bf16_f32 v111, v174, v175
    v_cvt_pk_bf16_f32 v112, v176, v177
    v_cvt_pk_bf16_f32 v113, v178, v179
    v_cvt_pk_bf16_f32 v114, v180, v181
    v_cvt_pk_bf16_f32 v115, v182, v183
    v_cvt_pk_bf16_f32 v116, v184, v185
    v_cvt_pk_bf16_f32 v117, v186, v187
    v_cvt_pk_bf16_f32 v118, v188, v189
    v_cvt_pk_bf16_f32 v119, v190, v191
    s_waitcnt lgkmcnt(2)
    v_lshlrev_b32 v216, 16, v156
    v_and_b32 v217, 0xffff0000, v156
    v_lshlrev_b32 v218, 16, v157
    v_and_b32 v219, 0xffff0000, v157
    v_lshlrev_b32 v220, 16, v158
    v_and_b32 v221, 0xffff0000, v158
    v_lshlrev_b32 v222, 16, v159
    v_and_b32 v223, 0xffff0000, v159
    s_waitcnt lgkmcnt(1)
    v_lshlrev_b32 v224, 16, v160
    v_and_b32 v225, 0xffff0000, v160
    v_lshlrev_b32 v226, 16, v161
    v_and_b32 v227, 0xffff0000, v161
    v_lshlrev_b32 v228, 16, v162
    v_and_b32 v229, 0xffff0000, v162
    v_lshlrev_b32 v230, 16, v163
    v_and_b32 v231, 0xffff0000, v163
    s_waitcnt lgkmcnt(0)
    v_lshlrev_b32 v232, 16, v164
    v_and_b32 v233, 0xffff0000, v164
    v_lshlrev_b32 v234, 16, v165
    v_and_b32 v235, 0xffff0000, v165
    v_lshlrev_b32 v236, 16, v166
    v_and_b32 v237, 0xffff0000, v166
    v_lshlrev_b32 v238, 16, v167
    v_and_b32 v239, 0xffff0000, v167
    v_lshlrev_b32 v168, 16, v108
    v_and_b32 v169, 0xffff0000, v108
    v_lshlrev_b32 v170, 16, v109
    v_and_b32 v171, 0xffff0000, v109
    v_lshlrev_b32 v172, 16, v110
    v_and_b32 v173, 0xffff0000, v110
    v_lshlrev_b32 v174, 16, v111
    v_and_b32 v175, 0xffff0000, v111
    v_lshlrev_b32 v176, 16, v112
    v_and_b32 v177, 0xffff0000, v112
    v_lshlrev_b32 v178, 16, v113
    v_and_b32 v179, 0xffff0000, v113
    v_lshlrev_b32 v180, 16, v114
    v_and_b32 v181, 0xffff0000, v114
    v_lshlrev_b32 v182, 16, v115
    v_and_b32 v183, 0xffff0000, v115
    v_lshlrev_b32 v184, 16, v116
    v_and_b32 v185, 0xffff0000, v116
    v_lshlrev_b32 v186, 16, v117
    v_and_b32 v187, 0xffff0000, v117
    v_lshlrev_b32 v188, 16, v118
    v_and_b32 v189, 0xffff0000, v118
    v_lshlrev_b32 v190, 16, v119
    v_and_b32 v191, 0xffff0000, v119
    v_pk_add_f32 v[168:169], v[168:169], v[216:217]
    v_pk_add_f32 v[170:171], v[170:171], v[218:219]
    v_pk_add_f32 v[172:173], v[172:173], v[220:221]
    v_pk_add_f32 v[174:175], v[174:175], v[222:223]
    v_cvt_pk_bf16_f32 v108, v168, v169
    v_cvt_pk_bf16_f32 v109, v170, v171
    v_cvt_pk_bf16_f32 v110, v172, v173
    v_cvt_pk_bf16_f32 v111, v174, v175
    buffer_store_dwordx4 v[108:111], v67, s[24:27], s92 offen offset:0 sc1
    v_pk_add_f32 v[176:177], v[176:177], v[224:225]
    v_pk_add_f32 v[178:179], v[178:179], v[226:227]
    v_pk_add_f32 v[180:181], v[180:181], v[228:229]
    v_pk_add_f32 v[182:183], v[182:183], v[230:231]
    v_cvt_pk_bf16_f32 v112, v176, v177
    v_cvt_pk_bf16_f32 v113, v178, v179
    v_cvt_pk_bf16_f32 v114, v180, v181
    v_cvt_pk_bf16_f32 v115, v182, v183
    buffer_store_dwordx4 v[112:115], v67, s[24:27], s92 offen offset:768 sc1
    v_pk_add_f32 v[184:185], v[184:185], v[232:233]
    v_pk_add_f32 v[186:187], v[186:187], v[234:235]
    v_pk_add_f32 v[188:189], v[188:189], v[236:237]
    v_pk_add_f32 v[190:191], v[190:191], v[238:239]
    v_cvt_pk_bf16_f32 v116, v184, v185
    v_cvt_pk_bf16_f32 v117, v186, v187
    v_cvt_pk_bf16_f32 v118, v188, v189
    v_cvt_pk_bf16_f32 v119, v190, v191
    buffer_store_dwordx4 v[116:119], v67, s[24:27], s92 offen offset:1536 sc1
    s_lshl_b32 s36, s5, 13
    s_add_u32 s36, s36, 8650752
    s_lshl_b32 s37, s4, 9
    s_add_u32 s37, s37, s36
    s_lshl_b32 s38, s3, 7
    s_add_u32 s37, s37, s38
    s_lshl_b32 s38, s3, 11
    s_add_u32 s36, s36, s38
    v_mov_b32 v72, 0
    v_and_b32 v73, 15, v1
    v_lshlrev_b32 v73, 7, v73
    v_cmp_gt_u32 vcc, 162, v0
    v_mov_b32 v88, -1
    v_mov_b32 v89, -1
    v_mov_b32 v90, -1
    v_mov_b32 v91, -1
    s_mul_i32 s39, s2, 2592
    s_add_u32 s39, s39, 7864320
    v_lshl_add_u32 v74, v0, 4, s39
    s_lshl_b32 s39, s2, 7
    s_add_u32 s39, s39, 8912896
    v_mov_b32 v75, s39
    v_cndmask_b32 v74, v75, v74, vcc
    v_cmp_eq_u32 vcc, 0, v0
    v_mov_b32 v64, 2147483648
    v_mov_b32 v65, 1
    s_waitcnt vmcnt(0)
    s_mov_b64 exec, 1
    buffer_store_dword v137, v72, s[24:27], s37 offen sc1
    s_mov_b64 exec, -1
    v_cndmask_b32 v64, v64, 0, vcc
    s_add_u32 s49, s44, 524288
    s_add_u32 m0, s42, 65536
    s_nop 0
    buffer_load_dwordx4 v42, s[16:19], s49 offen lds
    buffer_load_dwordx4 v43, s[16:19], s49 offen offset:1024 lds
    buffer_load_dwordx4 v44, s[16:19], s49 offen offset:2048 lds
    buffer_load_dwordx4 v45, s[16:19], s49 offen offset:3072 lds
    s_add_u32 s49, s44, 524544
    s_add_u32 m0, s42, 81920
    s_nop 0
    buffer_load_dwordx4 v42, s[16:19], s49 offen lds
    buffer_load_dwordx4 v43, s[16:19], s49 offen offset:1024 lds
    buffer_load_dwordx4 v44, s[16:19], s49 offen offset:2048 lds
    buffer_load_dwordx4 v45, s[16:19], s49 offen offset:3072 lds
    s_add_u32 s49, s44, 1048576
    s_add_u32 m0, s42, 98304
    s_nop 0
    buffer_load_dwordx4 v42, s[16:19], s49 offen lds
    buffer_load_dwordx4 v43, s[16:19], s49 offen offset:1024 lds
    buffer_load_dwordx4 v44, s[16:19], s49 offen offset:2048 lds
    buffer_load_dwordx4 v45, s[16:19], s49 offen offset:3072 lds
    s_add_u32 s49, s44, 1048832
    s_add_u32 m0, s42, 114688
    s_nop 0
    buffer_load_dwordx4 v42, s[16:19], s49 offen lds
    buffer_load_dwordx4 v43, s[16:19], s49 offen offset:1024 lds
    buffer_load_dwordx4 v44, s[16:19], s49 offen offset:2048 lds
    buffer_load_dwordx4 v45, s[16:19], s49 offen offset:3072 lds
    s_mov_b32 s38, 16384
Lhead_pollh:
    buffer_load_dword v75, v73, s[24:27], s36 offen sc1
    s_sub_u32 s38, s38, 1
    s_cbranch_scc1 Lhead_goth
    s_waitcnt vmcnt(0) lgkmcnt(0)
    v_cmp_ne_u32 vcc, s95, v75
    s_cbranch_vccnz Lhead_pollh
Lhead_goth:
    s_waitcnt vmcnt(0) lgkmcnt(0)
    buffer_load_dwordx4 a[0:3], v51, s[24:27], s46 offen offset:0 sc1
    buffer_load_dwordx4 a[8:11], v51, s[24:27], s46 offen offset:128 sc1
    buffer_load_dwordx4 a[4:7], v51, s[24:27], s43 offen offset:0 sc1
    buffer_load_dwordx4 a[12:15], v51, s[24:27], s43 offen offset:128 sc1
    buffer_load_dwordx4 a[16:19], v51, s[24:27], s46 offen offset:256 sc1
    buffer_load_dwordx4 a[24:27], v51, s[24:27], s46 offen offset:384 sc1
    buffer_load_dwordx4 a[20:23], v51, s[24:27], s43 offen offset:256 sc1
    buffer_load_dwordx4 a[28:31], v51, s[24:27], s43 offen offset:384 sc1
    buffer_load_dwordx4 a[32:35], v51, s[24:27], s46 offen offset:512 sc1
    buffer_load_dwordx4 a[40:43], v51, s[24:27], s46 offen offset:640 sc1
    buffer_load_dwordx4 a[36:39], v51, s[24:27], s43 offen offset:512 sc1
    buffer_load_dwordx4 a[44:47], v51, s[24:27], s43 offen offset:640 sc1
    s_add_u32 s49, s44, 1572864
    s_add_u32 m0, s42, 131072
    s_nop 0
    buffer_load_dwordx4 v42, s[16:19], s49 offen lds
    buffer_load_dwordx4 v43, s[16:19], s49 offen offset:1024 lds
    buffer_load_dwordx4 v44, s[16:19], s49 offen offset:2048 lds
    buffer_load_dwordx4 v45, s[16:19], s49 offen offset:3072 lds
    s_add_u32 s49, s44, 1573120
    s_add_u32 m0, s42, 147456
    s_nop 0
    buffer_load_dwordx4 v42, s[16:19], s49 offen lds
    buffer_load_dwordx4 v43, s[16:19], s49 offen offset:1024 lds
    buffer_load_dwordx4 v44, s[16:19], s49 offen offset:2048 lds
    buffer_load_dwordx4 v45, s[16:19], s49 offen offset:3072 lds
    buffer_store_dwordx4 v[88:91], v74, s[24:27], 0 offen sc1
    s_add_u32 s36, s92, 2555904
    buffer_store_dwordx4 v[88:91], v67, s[24:27], s36 offen offset:0 sc1
    buffer_store_dwordx4 v[88:91], v67, s[24:27], s36 offen offset:768 sc1
    buffer_store_dwordx4 v[88:91], v67, s[24:27], s36 offen offset:1536 sc1
    s_add_u32 s36, s92, 5177344
    buffer_store_dwordx4 v[88:91], v67, s[24:27], s36 offen offset:0 sc1
    buffer_store_dwordx4 v[88:91], v67, s[24:27], s36 offen offset:768 sc1
    buffer_store_dwordx4 v[88:91], v67, s[24:27], s36 offen offset:1536 sc1
    s_lshl_b32 s92, s5, 13
    s_add_u32 s92, s92, 8781824
    s_lshl_b32 s36, s3, 11
    s_add_u32 s92, s92, s36
    s_lshl_b32 s36, s4, 7
    s_add_u32 s92, s92, s36
    s_getreg_b32 s36, hwreg(HW_REG_XCC_ID, 0, 4)
    s_add_u32 s36, s36, s95
    v_mov_b32 v75, s36
    s_mov_b64 exec, 1
    buffer_store_dword v75, v72, s[24:27], s92 offen offset:12 sc1
    s_mov_b64 exec, -1
    s_barrier
    ds_read_b64_tr_b16 a[160:161], v12 offset:32768
    ds_read_b64_tr_b16 a[162:163], v12 offset:36864
    ds_read_b64_tr_b16 a[164:165], v12 offset:40960
    ds_read_b64_tr_b16 a[166:167], v12 offset:45056
    ds_read_b64_tr_b16 a[168:169], v13 offset:32768
    ds_read_b64_tr_b16 a[170:171], v13 offset:36864
    ds_read_b64_tr_b16 a[172:173], v13 offset:40960
    ds_read_b64_tr_b16 a[174:175], v13 offset:45056
    ds_read_b64_tr_b16 a[176:177], v14 offset:32768
    ds_read_b64_tr_b16 a[178:179], v14 offset:36864
    ds_read_b64_tr_b16 a[180:181], v14 offset:40960
    ds_read_b64_tr_b16 a[182:183], v14 offset:45056
    s_waitcnt lgkmcnt(10)
    s_waitcnt vmcnt(27)
    v_mfma_f32_16x16x32_bf16 v[128:131], a[160:163], a[0:3], 0
    s_waitcnt vmcnt(26)
    s_waitcnt lgkmcnt(8)
    ds_read_b64_tr_b16 a[184:185], v15 offset:32768
    v_mfma_f32_16x16x32_bf16 v[128:131], a[164:167], a[8:11], v[128:131]
    s_waitcnt vmcnt(25)
    ds_read_b64_tr_b16 a[186:187], v15 offset:36864
    v_mfma_f32_16x16x32_bf16 v[132:135], a[160:163], a[4:7], 0
    s_waitcnt vmcnt(24)
    ds_read_b64_tr_b16 a[188:189], v15 offset:40960
    v_mfma_f32_16x16x32_bf16 v[132:135], a[164:167], a[12:15], v[132:135]
    s_waitcnt lgkmcnt(9)
    buffer_load_dwordx4 a[48:51], v51, s[24:27], s46 offen offset:768 sc1
    v_mfma_f32_16x16x32_bf16 v[136:139], a[168:171], a[0:3], 0
    s_waitcnt lgkmcnt(7)
    ds_read_b64_tr_b16 a[190:191], v15 offset:45056
    ds_read_b64_tr_b16 a[160:161], v16 offset:32768
    v_mfma_f32_16x16x32_bf16 v[136:139], a[172:175], a[8:11], v[136:139]
    ds_read_b64_tr_b16 a[162:163], v16 offset:36864
    v_mfma_f32_16x16x32_bf16 v[140:143], a[168:171], a[4:7], 0
    ds_read_b64_tr_b16 a[164:165], v16 offset:40960
    v_mfma_f32_16x16x32_bf16 v[140:143], a[172:175], a[12:15], v[140:143]
    s_waitcnt lgkmcnt(9)
    buffer_load_dwordx4 a[56:59], v51, s[24:27], s46 offen offset:896 sc1
    v_mfma_f32_16x16x32_bf16 v[144:147], a[176:179], a[0:3], 0
    s_waitcnt lgkmcnt(7)
    ds_read_b64_tr_b16 a[166:167], v16 offset:45056
    ds_read_b64_tr_b16 a[168:169], v17 offset:32768
    v_mfma_f32_16x16x32_bf16 v[144:147], a[180:183], a[8:11], v[144:147]
    ds_read_b64_tr_b16 a[170:171], v17 offset:36864
    v_mfma_f32_16x16x32_bf16 v[148:151], a[176:179], a[4:7], 0
    ds_read_b64_tr_b16 a[172:173], v17 offset:40960
    v_mfma_f32_16x16x32_bf16 v[148:151], a[180:183], a[12:15], v[148:151]
    s_waitcnt lgkmcnt(9)
    buffer_load_dwordx4 a[52:55], v51, s[24:27], s43 offen offset:768 sc1
    v_mfma_f32_16x16x32_bf16 v[152:155], a[184:187], a[0:3], 0
    s_waitcnt lgkmcnt(7)
    ds_read_b64_tr_b16 a[174:175], v17 offset:45056
    ds_read_b64_tr_b16 a[176:177], v18 offset:32768
    v_mfma_f32_16x16x32_bf16 v[152:155], a[188:191], a[8:11], v[152:155]
    ds_read_b64_tr_b16 a[178:179], v18 offset:36864
    v_mfma_f32_16x16x32_bf16 v[156:159], a[184:187], a[4:7], 0
    ds_read_b64_tr_b16 a[180:181], v18 offset:40960
    v_mfma_f32_16x16x32_bf16 v[156:159], a[188:191], a[12:15], v[156:159]
    s_waitcnt lgkmcnt(9)
    buffer_load_dwordx4 a[60:63], v51, s[24:27], s43 offen offset:896 sc1
    v_mfma_f32_16x16x32_bf16 v[160:163], a[160:163], a[0:3], 0
    s_waitcnt lgkmcnt(7)
    ds_read_b64_tr_b16 a[182:183], v18 offset:45056
    ds_read_b64_tr_b16 a[184:185], v19 offset:32768
    v_mfma_f32_16x16x32_bf16 v[160:163], a[164:167], a[8:11], v[160:163]
    s_add_u32 s49, s44, 2097152
    ds_read_b64_tr_b16 a[186:187], v19 offset:36864
    v_mfma_f32_16x16x32_bf16 v[164:167], a[160:163], a[4:7], 0
    s_add_u32 m0, s42, 0
    ds_read_b64_tr_b16 a[188:189], v19 offset:40960
    v_mfma_f32_16x16x32_bf16 v[164:167], a[164:167], a[12:15], v[164:167]
    s_waitcnt lgkmcnt(9)
    buffer_load_dwordx4 v42, s[16:19], s49 offen lds
    v_mfma_f32_16x16x32_bf16 v[168:171], a[168:171], a[0:3], 0
    s_waitcnt lgkmcnt(7)
    ds_read_b64_tr_b16 a[190:191], v19 offset:45056
    ds_read_b64_tr_b16 a[160:161], v12 offset:49152
    v_mfma_f32_16x16x32_bf16 v[168:171], a[172:175], a[8:11], v[168:171]
    ds_read_b64_tr_b16 a[162:163], v12 offset:53248
    v_mfma_f32_16x16x32_bf16 v[172:175], a[168:171], a[4:7], 0
    ds_read_b64_tr_b16 a[164:165], v12 offset:57344
    v_mfma_f32_16x16x32_bf16 v[172:175], a[172:175], a[12:15], v[172:175]
    s_waitcnt lgkmcnt(9)
    buffer_load_dwordx4 v43, s[16:19], s49 offen offset:1024 lds
    v_mfma_f32_16x16x32_bf16 v[176:179], a[176:179], a[0:3], 0
    s_waitcnt lgkmcnt(7)
    ds_read_b64_tr_b16 a[166:167], v12 offset:61440
    ds_read_b64_tr_b16 a[168:169], v13 offset:49152
    v_mfma_f32_16x16x32_bf16 v[176:179], a[180:183], a[8:11], v[176:179]
    ds_read_b64_tr_b16 a[170:171], v13 offset:53248
    v_mfma_f32_16x16x32_bf16 v[180:183], a[176:179], a[4:7], 0
    ds_read_b64_tr_b16 a[172:173], v13 offset:57344
    v_mfma_f32_16x16x32_bf16 v[180:183], a[180:183], a[12:15], v[180:183]
    s_waitcnt lgkmcnt(9)
    buffer_load_dwordx4 v44, s[16:19], s49 offen offset:2048 lds
    v_mfma_f32_16x16x32_bf16 v[184:187], a[184:187], a[0:3], 0
    s_waitcnt lgkmcnt(7)
    ds_read_b64_tr_b16 a[174:175], v13 offset:61440
    ds_read_b64_tr_b16 a[176:177], v14 offset:49152
    v_mfma_f32_16x16x32_bf16 v[184:187], a[188:191], a[8:11], v[184:187]
    ds_read_b64_tr_b16 a[178:179], v14 offset:53248
    v_mfma_f32_16x16x32_bf16 v[188:191], a[184:187], a[4:7], 0
    ds_read_b64_tr_b16 a[180:181], v14 offset:57344
    v_mfma_f32_16x16x32_bf16 v[188:191], a[188:191], a[12:15], v[188:191]
    s_waitcnt lgkmcnt(9)
    buffer_load_dwordx4 v45, s[16:19], s49 offen offset:3072 lds
    v_mfma_f32_16x16x32_bf16 v[192:195], a[160:163], a[0:3], 0
    s_waitcnt lgkmcnt(7)
    ds_read_b64_tr_b16 a[182:183], v14 offset:61440
    ds_read_b64_tr_b16 a[184:185], v15 offset:49152
    v_mfma_f32_16x16x32_bf16 v[192:195], a[164:167], a[8:11], v[192:195]
    s_add_u32 s49, s44, 2097408
    ds_read_b64_tr_b16 a[186:187], v15 offset:53248
    v_mfma_f32_16x16x32_bf16 v[196:199], a[160:163], a[4:7], 0
    s_add_u32 m0, s42, 16384
    ds_read_b64_tr_b16 a[188:189], v15 offset:57344
    v_mfma_f32_16x16x32_bf16 v[196:199], a[164:167], a[12:15], v[196:199]
    s_waitcnt lgkmcnt(9)
    buffer_load_dwordx4 v42, s[16:19], s49 offen lds
    v_mfma_f32_16x16x32_bf16 v[200:203], a[168:171], a[0:3], 0
    s_waitcnt lgkmcnt(7)
    ds_read_b64_tr_b16 a[190:191], v15 offset:61440
    ds_read_b64_tr_b16 a[160:161], v16 offset:49152
    v_mfma_f32_16x16x32_bf16 v[200:203], a[172:175], a[8:11], v[200:203]
    ds_read_b64_tr_b16 a[162:163], v16 offset:53248
    v_mfma_f32_16x16x32_bf16 v[204:207], a[168:171], a[4:7], 0
    ds_read_b64_tr_b16 a[164:165], v16 offset:57344
    v_mfma_f32_16x16x32_bf16 v[204:207], a[172:175], a[12:15], v[204:207]
    s_waitcnt lgkmcnt(9)
    buffer_load_dwordx4 v43, s[16:19], s49 offen offset:1024 lds
    v_mfma_f32_16x16x32_bf16 v[208:211], a[176:179], a[0:3], 0
    s_waitcnt lgkmcnt(7)
    ds_read_b64_tr_b16 a[166:167], v16 offset:61440
    ds_read_b64_tr_b16 a[168:169], v17 offset:49152
    v_mfma_f32_16x16x32_bf16 v[208:211], a[180:183], a[8:11], v[208:211]
    ds_read_b64_tr_b16 a[170:171], v17 offset:53248
    v_mfma_f32_16x16x32_bf16 v[212:215], a[176:179], a[4:7], 0
    ds_read_b64_tr_b16 a[172:173], v17 offset:57344
    v_mfma_f32_16x16x32_bf16 v[212:215], a[180:183], a[12:15], v[212:215]
    s_waitcnt lgkmcnt(9)
    buffer_load_dwordx4 v44, s[16:19], s49 offen offset:2048 lds
    v_mfma_f32_16x16x32_bf16 v[216:219], a[184:187], a[0:3], 0
    s_waitcnt lgkmcnt(7)
    ds_read_b64_tr_b16 a[174:175], v17 offset:61440
    ds_read_b64_tr_b16 a[176:177], v18 offset:49152
    v_mfma_f32_16x16x32_bf16 v[216:219], a[188:191], a[8:11], v[216:219]
    ds_read_b64_tr_b16 a[178:179], v18 offset:53248
    v_mfma_f32_16x16x32_bf16 v[220:223], a[184:187], a[4:7], 0
    ds_read_b64_tr_b16 a[180:181], v18 offset:57344
    v_mfma_f32_16x16x32_bf16 v[220:223], a[188:191], a[12:15], v[220:223]
    s_waitcnt lgkmcnt(9)
    buffer_load_dwordx4 v45, s[16:19], s49 offen offset:3072 lds
    v_mfma_f32_16x16x32_bf16 v[224:227], a[160:163], a[0:3], 0
    s_waitcnt lgkmcnt(7)
    ds_read_b64_tr_b16 a[182:183], v18 offset:61440
    ds_read_b64_tr_b16 a[184:185], v19 offset:49152
    v_mfma_f32_16x16x32_bf16 v[224:227], a[164:167], a[8:11], v[224:227]
    ds_read_b64_tr_b16 a[186:187], v19 offset:53248
    v_mfma_f32_16x16x32_bf16 v[228:231], a[160:163], a[4:7], 0
    ds_read_b64_tr_b16 a[188:189], v19 offset:57344
    v_mfma_f32_16x16x32_bf16 v[228:231], a[164:167], a[12:15], v[228:231]
    s_waitcnt lgkmcnt(9)
    ds_read_b64_tr_b16 a[190:191], v19 offset:61440
    s_barrier
    v_mfma_f32_16x16x32_bf16 v[232:235], a[168:171], a[0:3], 0
    s_waitcnt lgkmcnt(8)
    ds_read_b64_tr_b16 a[160:161], v20 offset:0
    v_mfma_f32_16x16x32_bf16 v[232:235], a[172:175], a[8:11], v[232:235]
    ds_read_b64_tr_b16 a[162:163], v20 offset:4096
    v_mfma_f32_16x16x32_bf16 v[236:239], a[168:171], a[4:7], 0
    ds_read_b64_tr_b16 a[164:165], v20 offset:8192
    v_mfma_f32_16x16x32_bf16 v[236:239], a[172:175], a[12:15], v[236:239]
    s_waitcnt lgkmcnt(9)
    buffer_load_dwordx4 a[64:67], v51, s[24:27], s46 offen offset:1024 sc1
    v_mfma_f32_16x16x32_bf16 v[240:243], a[176:179], a[0:3], 0
    s_waitcnt lgkmcnt(7)
    ds_read_b64_tr_b16 a[166:167], v20 offset:12288
    ds_read_b64_tr_b16 a[168:169], v21 offset:0
    v_mfma_f32_16x16x32_bf16 v[240:243], a[180:183], a[8:11], v[240:243]
    ds_read_b64_tr_b16 a[170:171], v21 offset:4096
    v_mfma_f32_16x16x32_bf16 v[244:247], a[176:179], a[4:7], 0
    ds_read_b64_tr_b16 a[172:173], v21 offset:8192
    v_mfma_f32_16x16x32_bf16 v[244:247], a[180:183], a[12:15], v[244:247]
    s_waitcnt lgkmcnt(9)
    buffer_load_dwordx4 a[72:75], v51, s[24:27], s46 offen offset:1152 sc1
    v_mfma_f32_16x16x32_bf16 v[248:251], a[184:187], a[0:3], 0
    s_waitcnt lgkmcnt(7)
    ds_read_b64_tr_b16 a[174:175], v21 offset:12288
    ds_read_b64_tr_b16 a[176:177], v22 offset:0
    v_mfma_f32_16x16x32_bf16 v[248:251], a[188:191], a[8:11], v[248:251]
    ds_read_b64_tr_b16 a[178:179], v22 offset:4096
    v_mfma_f32_16x16x32_bf16 v[252:255], a[184:187], a[4:7], 0
    ds_read_b64_tr_b16 a[180:181], v22 offset:8192
    v_mfma_f32_16x16x32_bf16 v[252:255], a[188:191], a[12:15], v[252:255]
    s_waitcnt vmcnt(37)
    s_waitcnt lgkmcnt(9)
    buffer_load_dwordx4 a[68:71], v51, s[24:27], s43 offen offset:1024 sc1
    v_mfma_f32_16x16x32_bf16 v[128:131], a[160:163], a[16:19], v[128:131]
    s_waitcnt vmcnt(37)
    s_waitcnt lgkmcnt(7)
    ds_read_b64_tr_b16 a[182:183], v22 offset:12288
    ds_read_b64_tr_b16 a[184:185], v23 offset:0
    v_mfma_f32_16x16x32_bf16 v[128:131], a[164:167], a[24:27], v[128:131]
    s_waitcnt vmcnt(36)
    ds_read_b64_tr_b16 a[186:187], v23 offset:4096
    v_mfma_f32_16x16x32_bf16 v[132:135], a[160:163], a[20:23], v[132:135]
    s_waitcnt vmcnt(35)
    ds_read_b64_tr_b16 a[188:189], v23 offset:8192
    v_mfma_f32_16x16x32_bf16 v[132:135], a[164:167], a[28:31], v[132:135]
    s_waitcnt lgkmcnt(9)
    buffer_load_dwordx4 a[76:79], v51, s[24:27], s43 offen offset:1152 sc1
    v_mfma_f32_16x16x32_bf16 v[136:139], a[168:171], a[16:19], v[136:139]
    s_waitcnt lgkmcnt(7)
    ds_read_b64_tr_b16 a[190:191], v23 offset:12288
    ds_read_b64_tr_b16 a[160:161], v24 offset:0
    v_mfma_f32_16x16x32_bf16 v[136:139], a[172:175], a[24:27], v[136:139]
    ds_read_b64_tr_b16 a[162:163], v24 offset:4096
    v_mfma_f32_16x16x32_bf16 v[140:143], a[168:171], a[20:23], v[140:143]
    ds_read_b64_tr_b16 a[164:165], v24 offset:8192
    v_mfma_f32_16x16x32_bf16 v[140:143], a[172:175], a[28:31], v[140:143]
    s_waitcnt lgkmcnt(9)
    buffer_load_dwordx4 a[80:83], v51, s[24:27], s46 offen offset:1280 sc1
    v_mfma_f32_16x16x32_bf16 v[144:147], a[176:179], a[16:19], v[144:147]
    s_waitcnt lgkmcnt(7)
    ds_read_b64_tr_b16 a[166:167], v24 offset:12288
    ds_read_b64_tr_b16 a[168:169], v25 offset:0
    v_mfma_f32_16x16x32_bf16 v[144:147], a[180:183], a[24:27], v[144:147]
    ds_read_b64_tr_b16 a[170:171], v25 offset:4096
    v_mfma_f32_16x16x32_bf16 v[148:151], a[176:179], a[20:23], v[148:151]
    ds_read_b64_tr_b16 a[172:173], v25 offset:8192
    v_mfma_f32_16x16x32_bf16 v[148:151], a[180:183], a[28:31], v[148:151]
    s_waitcnt lgkmcnt(9)
    buffer_load_dwordx4 a[88:91], v51, s[24:27], s46 offen offset:1408 sc1
    v_mfma_f32_16x16x32_bf16 v[152:155], a[184:187], a[16:19], v[152:155]
    s_waitcnt lgkmcnt(7)
    ds_read_b64_tr_b16 a[174:175], v25 offset:12288
    ds_read_b64_tr_b16 a[176:177], v26 offset:0
    v_mfma_f32_16x16x32_bf16 v[152:155], a[188:191], a[24:27], v[152:155]
    ds_read_b64_tr_b16 a[178:179], v26 offset:4096
    v_mfma_f32_16x16x32_bf16 v[156:159], a[184:187], a[20:23], v[156:159]
    ds_read_b64_tr_b16 a[180:181], v26 offset:8192
    v_mfma_f32_16x16x32_bf16 v[156:159], a[188:191], a[28:31], v[156:159]
    s_waitcnt lgkmcnt(9)
    buffer_load_dwordx4 a[84:87], v51, s[24:27], s43 offen offset:1280 sc1
    v_mfma_f32_16x16x32_bf16 v[160:163], a[160:163], a[16:19], v[160:163]
    s_waitcnt lgkmcnt(7)
    ds_read_b64_tr_b16 a[182:183], v26 offset:12288
    ds_read_b64_tr_b16 a[184:185], v27 offset:0
    v_mfma_f32_16x16x32_bf16 v[160:163], a[164:167], a[24:27], v[160:163]
    ds_read_b64_tr_b16 a[186:187], v27 offset:4096
    v_mfma_f32_16x16x32_bf16 v[164:167], a[160:163], a[20:23], v[164:167]
    ds_read_b64_tr_b16 a[188:189], v27 offset:8192
    v_mfma_f32_16x16x32_bf16 v[164:167], a[164:167], a[28:31], v[164:167]
    s_waitcnt lgkmcnt(9)
    buffer_load_dwordx4 a[92:95], v51, s[24:27], s43 offen offset:1408 sc1
    v_mfma_f32_16x16x32_bf16 v[168:171], a[168:171], a[16:19], v[168:171]
    s_waitcnt lgkmcnt(7)
    ds_read_b64_tr_b16 a[190:191], v27 offset:12288
    ds_read_b64_tr_b16 a[160:161], v20 offset:16384
    v_mfma_f32_16x16x32_bf16 v[168:171], a[172:175], a[24:27], v[168:171]
    ds_read_b64_tr_b16 a[162:163], v20 offset:20480
    v_mfma_f32_16x16x32_bf16 v[172:175], a[168:171], a[20:23], v[172:175]
    ds_read_b64_tr_b16 a[164:165], v20 offset:24576
    v_mfma_f32_16x16x32_bf16 v[172:175], a[172:175], a[28:31], v[172:175]
    s_waitcnt lgkmcnt(9)
    buffer_load_dwordx4 a[96:99], v51, s[24:27], s46 offen offset:1536 sc1
    v_mfma_f32_16x16x32_bf16 v[176:179], a[176:179], a[16:19], v[176:179]
    s_waitcnt lgkmcnt(7)
    ds_read_b64_tr_b16 a[166:167], v20 offset:28672
    ds_read_b64_tr_b16 a[168:169], v21 offset:16384
    v_mfma_f32_16x16x32_bf16 v[176:179], a[180:183], a[24:27], v[176:179]
    ds_read_b64_tr_b16 a[170:171], v21 offset:20480
    v_mfma_f32_16x16x32_bf16 v[180:183], a[176:179], a[20:23], v[180:183]
    ds_read_b64_tr_b16 a[172:173], v21 offset:24576
    v_mfma_f32_16x16x32_bf16 v[180:183], a[180:183], a[28:31], v[180:183]
    s_waitcnt lgkmcnt(9)
    buffer_load_dwordx4 a[104:107], v51, s[24:27], s46 offen offset:1664 sc1
    v_mfma_f32_16x16x32_bf16 v[184:187], a[184:187], a[16:19], v[184:187]
    s_waitcnt lgkmcnt(7)
    ds_read_b64_tr_b16 a[174:175], v21 offset:28672
    ds_read_b64_tr_b16 a[176:177], v22 offset:16384
    v_mfma_f32_16x16x32_bf16 v[184:187], a[188:191], a[24:27], v[184:187]
    ds_read_b64_tr_b16 a[178:179], v22 offset:20480
    v_mfma_f32_16x16x32_bf16 v[188:191], a[184:187], a[20:23], v[188:191]
    ds_read_b64_tr_b16 a[180:181], v22 offset:24576
    v_mfma_f32_16x16x32_bf16 v[188:191], a[188:191], a[28:31], v[188:191]
    s_waitcnt lgkmcnt(9)
    buffer_load_dwordx4 a[100:103], v51, s[24:27], s43 offen offset:1536 sc1
    v_mfma_f32_16x16x32_bf16 v[192:195], a[160:163], a[16:19], v[192:195]
    s_waitcnt lgkmcnt(7)
    ds_read_b64_tr_b16 a[182:183], v22 offset:28672
    ds_read_b64_tr_b16 a[184:185], v23 offset:16384
    v_mfma_f32_16x16x32_bf16 v[192:195], a[164:167], a[24:27], v[192:195]
    ds_read_b64_tr_b16 a[186:187], v23 offset:20480
    v_mfma_f32_16x16x32_bf16 v[196:199], a[160:163], a[20:23], v[196:199]
    ds_read_b64_tr_b16 a[188:189], v23 offset:24576
    v_mfma_f32_16x16x32_bf16 v[196:199], a[164:167], a[28:31], v[196:199]
    s_waitcnt lgkmcnt(9)
    buffer_load_dwordx4 a[108:111], v51, s[24:27], s43 offen offset:1664 sc1
    v_mfma_f32_16x16x32_bf16 v[200:203], a[168:171], a[16:19], v[200:203]
    s_waitcnt lgkmcnt(7)
    ds_read_b64_tr_b16 a[190:191], v23 offset:28672
    ds_read_b64_tr_b16 a[160:161], v24 offset:16384
    v_mfma_f32_16x16x32_bf16 v[200:203], a[172:175], a[24:27], v[200:203]
    ds_read_b64_tr_b16 a[162:163], v24 offset:20480
    v_mfma_f32_16x16x32_bf16 v[204:207], a[168:171], a[20:23], v[204:207]
    ds_read_b64_tr_b16 a[164:165], v24 offset:24576
    v_mfma_f32_16x16x32_bf16 v[204:207], a[172:175], a[28:31], v[204:207]
    s_waitcnt lgkmcnt(9)
    ds_read_b64_tr_b16 a[166:167], v24 offset:28672
    v_mfma_f32_16x16x32_bf16 v[208:211], a[176:179], a[16:19], v[208:211]
    s_waitcnt lgkmcnt(8)
    ds_read_b64_tr_b16 a[168:169], v25 offset:16384
    v_mfma_f32_16x16x32_bf16 v[208:211], a[180:183], a[24:27], v[208:211]
    ds_read_b64_tr_b16 a[170:171], v25 offset:20480
    v_mfma_f32_16x16x32_bf16 v[212:215], a[176:179], a[20:23], v[212:215]
    ds_read_b64_tr_b16 a[172:173], v25 offset:24576
    v_mfma_f32_16x16x32_bf16 v[212:215], a[180:183], a[28:31], v[212:215]
    s_waitcnt lgkmcnt(9)
    ds_read_b64_tr_b16 a[174:175], v25 offset:28672
    v_mfma_f32_16x16x32_bf16 v[216:219], a[184:187], a[16:19], v[216:219]
    s_waitcnt lgkmcnt(8)
    ds_read_b64_tr_b16 a[176:177], v26 offset:16384
    v_mfma_f32_16x16x32_bf16 v[216:219], a[188:191], a[24:27], v[216:219]
    ds_read_b64_tr_b16 a[178:179], v26 offset:20480
    v_mfma_f32_16x16x32_bf16 v[220:223], a[184:187], a[20:23], v[220:223]
    ds_read_b64_tr_b16 a[180:181], v26 offset:24576
    v_mfma_f32_16x16x32_bf16 v[220:223], a[188:191], a[28:31], v[220:223]
    s_waitcnt lgkmcnt(9)
    ds_read_b64_tr_b16 a[182:183], v26 offset:28672
    v_mfma_f32_16x16x32_bf16 v[224:227], a[160:163], a[16:19], v[224:227]
    s_waitcnt lgkmcnt(8)
    ds_read_b64_tr_b16 a[184:185], v27 offset:16384
    v_mfma_f32_16x16x32_bf16 v[224:227], a[164:167], a[24:27], v[224:227]
    ds_read_b64_tr_b16 a[186:187], v27 offset:20480
    v_mfma_f32_16x16x32_bf16 v[228:231], a[160:163], a[20:23], v[228:231]
    ds_read_b64_tr_b16 a[188:189], v27 offset:24576
    v_mfma_f32_16x16x32_bf16 v[228:231], a[164:167], a[28:31], v[228:231]
    s_waitcnt lgkmcnt(9)
    ds_read_b64_tr_b16 a[190:191], v27 offset:28672
    s_barrier
    v_mfma_f32_16x16x32_bf16 v[232:235], a[168:171], a[16:19], v[232:235]
    s_waitcnt lgkmcnt(8)
    ds_read_b64_tr_b16 a[160:161], v20 offset:32768
    v_mfma_f32_16x16x32_bf16 v[232:235], a[172:175], a[24:27], v[232:235]
    ds_read_b64_tr_b16 a[162:163], v20 offset:36864
    v_mfma_f32_16x16x32_bf16 v[236:239], a[168:171], a[20:23], v[236:239]
    ds_read_b64_tr_b16 a[164:165], v20 offset:40960
    v_mfma_f32_16x16x32_bf16 v[236:239], a[172:175], a[28:31], v[236:239]
    s_waitcnt lgkmcnt(9)
    buffer_load_dwordx4 a[112:115], v51, s[24:27], s46 offen offset:1792 sc1
    v_mfma_f32_16x16x32_bf16 v[240:243], a[176:179], a[16:19], v[240:243]
    s_waitcnt lgkmcnt(7)
    ds_read_b64_tr_b16 a[166:167], v20 offset:45056
    ds_read_b64_tr_b16 a[168:169], v21 offset:32768
    v_mfma_f32_16x16x32_bf16 v[240:243], a[180:183], a[24:27], v[240:243]
    ds_read_b64_tr_b16 a[170:171], v21 offset:36864
    v_mfma_f32_16x16x32_bf16 v[244:247], a[176:179], a[20:23], v[244:247]
    ds_read_b64_tr_b16 a[172:173], v21 offset:40960
    v_mfma_f32_16x16x32_bf16 v[244:247], a[180:183], a[28:31], v[244:247]
    s_waitcnt lgkmcnt(9)
    buffer_load_dwordx4 a[120:123], v51, s[24:27], s46 offen offset:1920 sc1
    v_mfma_f32_16x16x32_bf16 v[248:251], a[184:187], a[16:19], v[248:251]
    s_waitcnt lgkmcnt(7)
    ds_read_b64_tr_b16 a[174:175], v21 offset:45056
    ds_read_b64_tr_b16 a[176:177], v22 offset:32768
    v_mfma_f32_16x16x32_bf16 v[248:251], a[188:191], a[24:27], v[248:251]
    ds_read_b64_tr_b16 a[178:179], v22 offset:36864
    v_mfma_f32_16x16x32_bf16 v[252:255], a[184:187], a[20:23], v[252:255]
    ds_read_b64_tr_b16 a[180:181], v22 offset:40960
    v_mfma_f32_16x16x32_bf16 v[252:255], a[188:191], a[28:31], v[252:255]
    s_waitcnt vmcnt(45)
    s_waitcnt lgkmcnt(9)
    buffer_load_dwordx4 a[116:119], v51, s[24:27], s43 offen offset:1792 sc1
    v_mfma_f32_16x16x32_bf16 v[128:131], a[160:163], a[32:35], v[128:131]
    s_waitcnt vmcnt(45)
    s_waitcnt lgkmcnt(7)
    ds_read_b64_tr_b16 a[182:183], v22 offset:45056
    ds_read_b64_tr_b16 a[184:185], v23 offset:32768
    v_mfma_f32_16x16x32_bf16 v[128:131], a[164:167], a[40:43], v[128:131]
    s_waitcnt vmcnt(44)
    ds_read_b64_tr_b16 a[186:187], v23 offset:36864
    v_mfma_f32_16x16x32_bf16 v[132:135], a[160:163], a[36:39], v[132:135]
    s_waitcnt vmcnt(43)
    ds_read_b64_tr_b16 a[188:189], v23 offset:40960
    v_mfma_f32_16x16x32_bf16 v[132:135], a[164:167], a[44:47], v[132:135]
    s_waitcnt lgkmcnt(9)
    buffer_load_dwordx4 a[124:127], v51, s[24:27], s43 offen offset:1920 sc1
    v_mfma_f32_16x16x32_bf16 v[136:139], a[168:171], a[32:35], v[136:139]
    s_waitcnt lgkmcnt(7)
    ds_read_b64_tr_b16 a[190:191], v23 offset:45056
    ds_read_b64_tr_b16 a[160:161], v24 offset:32768
    v_mfma_f32_16x16x32_bf16 v[136:139], a[172:175], a[40:43], v[136:139]
    s_add_u32 s49, s44, 2621440
    ds_read_b64_tr_b16 a[162:163], v24 offset:36864
    v_mfma_f32_16x16x32_bf16 v[140:143], a[168:171], a[36:39], v[140:143]
    s_add_u32 m0, s42, 32768
    ds_read_b64_tr_b16 a[164:165], v24 offset:40960
    v_mfma_f32_16x16x32_bf16 v[140:143], a[172:175], a[44:47], v[140:143]
    s_waitcnt lgkmcnt(9)
    buffer_load_dwordx4 v42, s[16:19], s49 offen lds
    v_mfma_f32_16x16x32_bf16 v[144:147], a[176:179], a[32:35], v[144:147]
    s_waitcnt lgkmcnt(7)
    ds_read_b64_tr_b16 a[166:167], v24 offset:45056
    ds_read_b64_tr_b16 a[168:169], v25 offset:32768
    v_mfma_f32_16x16x32_bf16 v[144:147], a[180:183], a[40:43], v[144:147]
    ds_read_b64_tr_b16 a[170:171], v25 offset:36864
    v_mfma_f32_16x16x32_bf16 v[148:151], a[176:179], a[36:39], v[148:151]
    ds_read_b64_tr_b16 a[172:173], v25 offset:40960
    v_mfma_f32_16x16x32_bf16 v[148:151], a[180:183], a[44:47], v[148:151]
    s_waitcnt lgkmcnt(9)
    buffer_load_dwordx4 v43, s[16:19], s49 offen offset:1024 lds
    v_mfma_f32_16x16x32_bf16 v[152:155], a[184:187], a[32:35], v[152:155]
    s_waitcnt lgkmcnt(7)
    ds_read_b64_tr_b16 a[174:175], v25 offset:45056
    ds_read_b64_tr_b16 a[176:177], v26 offset:32768
    v_mfma_f32_16x16x32_bf16 v[152:155], a[188:191], a[40:43], v[152:155]
    ds_read_b64_tr_b16 a[178:179], v26 offset:36864
    v_mfma_f32_16x16x32_bf16 v[156:159], a[184:187], a[36:39], v[156:159]
    ds_read_b64_tr_b16 a[180:181], v26 offset:40960
    v_mfma_f32_16x16x32_bf16 v[156:159], a[188:191], a[44:47], v[156:159]
    s_waitcnt lgkmcnt(9)
    buffer_load_dwordx4 v44, s[16:19], s49 offen offset:2048 lds
    v_mfma_f32_16x16x32_bf16 v[160:163], a[160:163], a[32:35], v[160:163]
    s_waitcnt lgkmcnt(7)
    ds_read_b64_tr_b16 a[182:183], v26 offset:45056
    ds_read_b64_tr_b16 a[184:185], v27 offset:32768
    v_mfma_f32_16x16x32_bf16 v[160:163], a[164:167], a[40:43], v[160:163]
    ds_read_b64_tr_b16 a[186:187], v27 offset:36864
    v_mfma_f32_16x16x32_bf16 v[164:167], a[160:163], a[36:39], v[164:167]
    ds_read_b64_tr_b16 a[188:189], v27 offset:40960
    v_mfma_f32_16x16x32_bf16 v[164:167], a[164:167], a[44:47], v[164:167]
    s_waitcnt lgkmcnt(9)
    buffer_load_dwordx4 v45, s[16:19], s49 offen offset:3072 lds
    v_mfma_f32_16x16x32_bf16 v[168:171], a[168:171], a[32:35], v[168:171]
    s_waitcnt lgkmcnt(7)
    ds_read_b64_tr_b16 a[190:191], v27 offset:45056
    ds_read_b64_tr_b16 a[160:161], v20 offset:49152
    v_mfma_f32_16x16x32_bf16 v[168:171], a[172:175], a[40:43], v[168:171]
    s_add_u32 s49, s44, 2621696
    ds_read_b64_tr_b16 a[162:163], v20 offset:53248
    v_mfma_f32_16x16x32_bf16 v[172:175], a[168:171], a[36:39], v[172:175]
    s_add_u32 m0, s42, 49152
    ds_read_b64_tr_b16 a[164:165], v20 offset:57344
    v_mfma_f32_16x16x32_bf16 v[172:175], a[172:175], a[44:47], v[172:175]
    s_waitcnt lgkmcnt(9)
    buffer_load_dwordx4 v42, s[16:19], s49 offen lds
    v_mfma_f32_16x16x32_bf16 v[176:179], a[176:179], a[32:35], v[176:179]
    s_waitcnt lgkmcnt(7)
    ds_read_b64_tr_b16 a[166:167], v20 offset:61440
    ds_read_b64_tr_b16 a[168:169], v21 offset:49152
    v_mfma_f32_16x16x32_bf16 v[176:179], a[180:183], a[40:43], v[176:179]
    ds_read_b64_tr_b16 a[170:171], v21 offset:53248
    v_mfma_f32_16x16x32_bf16 v[180:183], a[176:179], a[36:39], v[180:183]
    ds_read_b64_tr_b16 a[172:173], v21 offset:57344
    v_mfma_f32_16x16x32_bf16 v[180:183], a[180:183], a[44:47], v[180:183]
    s_waitcnt lgkmcnt(9)
    buffer_load_dwordx4 v43, s[16:19], s49 offen offset:1024 lds
    v_mfma_f32_16x16x32_bf16 v[184:187], a[184:187], a[32:35], v[184:187]
    s_waitcnt lgkmcnt(7)
    ds_read_b64_tr_b16 a[174:175], v21 offset:61440
    ds_read_b64_tr_b16 a[176:177], v22 offset:49152
    v_mfma_f32_16x16x32_bf16 v[184:187], a[188:191], a[40:43], v[184:187]
    ds_read_b64_tr_b16 a[178:179], v22 offset:53248
    v_mfma_f32_16x16x32_bf16 v[188:191], a[184:187], a[36:39], v[188:191]
    ds_read_b64_tr_b16 a[180:181], v22 offset:57344
    v_mfma_f32_16x16x32_bf16 v[188:191], a[188:191], a[44:47], v[188:191]
    s_waitcnt lgkmcnt(9)
    buffer_load_dwordx4 v44, s[16:19], s49 offen offset:2048 lds
    v_mfma_f32_16x16x32_bf16 v[192:195], a[160:163], a[32:35], v[192:195]
    s_waitcnt lgkmcnt(7)
    ds_read_b64_tr_b16 a[182:183], v22 offset:61440
    ds_read_b64_tr_b16 a[184:185], v23 offset:49152
    v_mfma_f32_16x16x32_bf16 v[192:195], a[164:167], a[40:43], v[192:195]
    ds_read_b64_tr_b16 a[186:187], v23 offset:53248
    v_mfma_f32_16x16x32_bf16 v[196:199], a[160:163], a[36:39], v[196:199]
    ds_read_b64_tr_b16 a[188:189], v23 offset:57344
    v_mfma_f32_16x16x32_bf16 v[196:199], a[164:167], a[44:47], v[196:199]
    s_waitcnt lgkmcnt(9)
    buffer_load_dwordx4 v45, s[16:19], s49 offen offset:3072 lds
    v_mfma_f32_16x16x32_bf16 v[200:203], a[168:171], a[32:35], v[200:203]
    s_waitcnt lgkmcnt(7)
    ds_read_b64_tr_b16 a[190:191], v23 offset:61440
    ds_read_b64_tr_b16 a[160:161], v24 offset:49152
    v_mfma_f32_16x16x32_bf16 v[200:203], a[172:175], a[40:43], v[200:203]
    ds_read_b64_tr_b16 a[162:163], v24 offset:53248
    v_mfma_f32_16x16x32_bf16 v[204:207], a[168:171], a[36:39], v[204:207]
    ds_read_b64_tr_b16 a[164:165], v24 offset:57344
    v_mfma_f32_16x16x32_bf16 v[204:207], a[172:175], a[44:47], v[204:207]
    s_waitcnt lgkmcnt(9)
    ds_read_b64_tr_b16 a[166:167], v24 offset:61440
    v_mfma_f32_16x16x32_bf16 v[208:211], a[176:179], a[32:35], v[208:211]
    s_waitcnt lgkmcnt(8)
    ds_read_b64_tr_b16 a[168:169], v25 offset:49152
    v_mfma_f32_16x16x32_bf16 v[208:211], a[180:183], a[40:43], v[208:211]
    ds_read_b64_tr_b16 a[170:171], v25 offset:53248
    v_mfma_f32_16x16x32_bf16 v[212:215], a[176:179], a[36:39], v[212:215]
    ds_read_b64_tr_b16 a[172:173], v25 offset:57344
    v_mfma_f32_16x16x32_bf16 v[212:215], a[180:183], a[44:47], v[212:215]
    s_waitcnt lgkmcnt(9)
    ds_read_b64_tr_b16 a[174:175], v25 offset:61440
    v_mfma_f32_16x16x32_bf16 v[216:219], a[184:187], a[32:35], v[216:219]
    s_waitcnt lgkmcnt(8)
    ds_read_b64_tr_b16 a[176:177], v26 offset:49152
    v_mfma_f32_16x16x32_bf16 v[216:219], a[188:191], a[40:43], v[216:219]
    ds_read_b64_tr_b16 a[178:179], v26 offset:53248
    v_mfma_f32_16x16x32_bf16 v[220:223], a[184:187], a[36:39], v[220:223]
    ds_read_b64_tr_b16 a[180:181], v26 offset:57344
    v_mfma_f32_16x16x32_bf16 v[220:223], a[188:191], a[44:47], v[220:223]
    s_waitcnt lgkmcnt(9)
    ds_read_b64_tr_b16 a[182:183], v26 offset:61440
    v_mfma_f32_16x16x32_bf16 v[224:227], a[160:163], a[32:35], v[224:227]
    s_waitcnt lgkmcnt(8)
    ds_read_b64_tr_b16 a[184:185], v27 offset:49152
    v_mfma_f32_16x16x32_bf16 v[224:227], a[164:167], a[40:43], v[224:227]
    ds_read_b64_tr_b16 a[186:187], v27 offset:53248
    v_mfma_f32_16x16x32_bf16 v[228:231], a[160:163], a[36:39], v[228:231]
    ds_read_b64_tr_b16 a[188:189], v27 offset:57344
    v_mfma_f32_16x16x32_bf16 v[228:231], a[164:167], a[44:47], v[228:231]
    s_waitcnt lgkmcnt(9)
    ds_read_b64_tr_b16 a[190:191], v27 offset:61440
    s_waitcnt vmcnt(44)
    s_barrier
    v_mfma_f32_16x16x32_bf16 v[232:235], a[168:171], a[32:35], v[232:235]
    s_waitcnt lgkmcnt(8)
    ds_read_b64_tr_b16 a[160:161], v28 offset:0
    v_mfma_f32_16x16x32_bf16 v[232:235], a[172:175], a[40:43], v[232:235]
    ds_read_b64_tr_b16 a[162:163], v28 offset:4096
    v_mfma_f32_16x16x32_bf16 v[236:239], a[168:171], a[36:39], v[236:239]
    ds_read_b64_tr_b16 a[164:165], v28 offset:8192
    v_mfma_f32_16x16x32_bf16 v[236:239], a[172:175], a[44:47], v[236:239]
    s_waitcnt lgkmcnt(9)
    buffer_load_dwordx4 a[128:131], v51, s[24:27], s46 offen offset:2048 sc1
    v_mfma_f32_16x16x32_bf16 v[240:243], a[176:179], a[32:35], v[240:243]
    s_waitcnt lgkmcnt(7)
    ds_read_b64_tr_b16 a[166:167], v28 offset:12288
    ds_read_b64_tr_b16 a[168:169], v29 offset:0
    v_mfma_f32_16x16x32_bf16 v[240:243], a[180:183], a[40:43], v[240:243]
    ds_read_b64_tr_b16 a[170:171], v29 offset:4096
    v_mfma_f32_16x16x32_bf16 v[244:247], a[176:179], a[36:39], v[244:247]
    ds_read_b64_tr_b16 a[172:173], v29 offset:8192
    v_mfma_f32_16x16x32_bf16 v[244:247], a[180:183], a[44:47], v[244:247]
    s_waitcnt lgkmcnt(9)
    buffer_load_dwordx4 a[136:139], v51, s[24:27], s46 offen offset:2176 sc1
    v_mfma_f32_16x16x32_bf16 v[248:251], a[184:187], a[32:35], v[248:251]
    s_waitcnt lgkmcnt(7)
    ds_read_b64_tr_b16 a[174:175], v29 offset:12288
    ds_read_b64_tr_b16 a[176:177], v30 offset:0
    v_mfma_f32_16x16x32_bf16 v[248:251], a[188:191], a[40:43], v[248:251]
    ds_read_b64_tr_b16 a[178:179], v30 offset:4096
    v_mfma_f32_16x16x32_bf16 v[252:255], a[184:187], a[36:39], v[252:255]
    ds_read_b64_tr_b16 a[180:181], v30 offset:8192
    v_mfma_f32_16x16x32_bf16 v[252:255], a[188:191], a[44:47], v[252:255]
    s_waitcnt vmcnt(37)
    s_waitcnt lgkmcnt(9)
    buffer_load_dwordx4 a[132:135], v51, s[24:27], s43 offen offset:2048 sc1
    v_mfma_f32_16x16x32_bf16 v[128:131], a[160:163], a[48:51], v[128:131]
    s_waitcnt vmcnt(37)
    s_waitcnt lgkmcnt(7)
    ds_read_b64_tr_b16 a[182:183], v30 offset:12288
    ds_read_b64_tr_b16 a[184:185], v31 offset:0
    v_mfma_f32_16x16x32_bf16 v[128:131], a[164:167], a[56:59], v[128:131]
    s_waitcnt vmcnt(36)
    ds_read_b64_tr_b16 a[186:187], v31 offset:4096
    v_mfma_f32_16x16x32_bf16 v[132:135], a[160:163], a[52:55], v[132:135]
    s_waitcnt vmcnt(35)
    ds_read_b64_tr_b16 a[188:189], v31 offset:8192
    v_mfma_f32_16x16x32_bf16 v[132:135], a[164:167], a[60:63], v[132:135]
    s_waitcnt lgkmcnt(9)
    buffer_load_dwordx4 a[140:143], v51, s[24:27], s43 offen offset:2176 sc1
    v_mfma_f32_16x16x32_bf16 v[136:139], a[168:171], a[48:51], v[136:139]
    s_waitcnt lgkmcnt(7)
    ds_read_b64_tr_b16 a[190:191], v31 offset:12288
    ds_read_b64_tr_b16 a[160:161], v32 offset:0
    v_mfma_f32_16x16x32_bf16 v[136:139], a[172:175], a[56:59], v[136:139]
    s_add_u32 s49, s44, 3145728
    ds_read_b64_tr_b16 a[162:163], v32 offset:4096
    v_mfma_f32_16x16x32_bf16 v[140:143], a[168:171], a[52:55], v[140:143]
    s_add_u32 m0, s42, 65536
    ds_read_b64_tr_b16 a[164:165], v32 offset:8192
    v_mfma_f32_16x16x32_bf16 v[140:143], a[172:175], a[60:63], v[140:143]
    s_waitcnt lgkmcnt(9)
    buffer_load_dwordx4 v42, s[16:19], s49 offen lds
    v_mfma_f32_16x16x32_bf16 v[144:147], a[176:179], a[48:51], v[144:147]
    s_waitcnt lgkmcnt(7)
    ds_read_b64_tr_b16 a[166:167], v32 offset:12288
    ds_read_b64_tr_b16 a[168:169], v33 offset:0
    v_mfma_f32_16x16x32_bf16 v[144:147], a[180:183], a[56:59], v[144:147]
    ds_read_b64_tr_b16 a[170:171], v33 offset:4096
    v_mfma_f32_16x16x32_bf16 v[148:151], a[176:179], a[52:55], v[148:151]
    ds_read_b64_tr_b16 a[172:173], v33 offset:8192
    v_mfma_f32_16x16x32_bf16 v[148:151], a[180:183], a[60:63], v[148:151]
    s_waitcnt lgkmcnt(9)
    buffer_load_dwordx4 v43, s[16:19], s49 offen offset:1024 lds
    v_mfma_f32_16x16x32_bf16 v[152:155], a[184:187], a[48:51], v[152:155]
    s_waitcnt lgkmcnt(7)
    ds_read_b64_tr_b16 a[174:175], v33 offset:12288
    ds_read_b64_tr_b16 a[176:177], v34 offset:0
    v_mfma_f32_16x16x32_bf16 v[152:155], a[188:191], a[56:59], v[152:155]
    ds_read_b64_tr_b16 a[178:179], v34 offset:4096
    v_mfma_f32_16x16x32_bf16 v[156:159], a[184:187], a[52:55], v[156:159]
    ds_read_b64_tr_b16 a[180:181], v34 offset:8192
    v_mfma_f32_16x16x32_bf16 v[156:159], a[188:191], a[60:63], v[156:159]
    s_waitcnt lgkmcnt(9)
    buffer_load_dwordx4 v44, s[16:19], s49 offen offset:2048 lds
    v_mfma_f32_16x16x32_bf16 v[160:163], a[160:163], a[48:51], v[160:163]
    s_waitcnt lgkmcnt(7)
    ds_read_b64_tr_b16 a[182:183], v34 offset:12288
    ds_read_b64_tr_b16 a[184:185], v35 offset:0
    v_mfma_f32_16x16x32_bf16 v[160:163], a[164:167], a[56:59], v[160:163]
    ds_read_b64_tr_b16 a[186:187], v35 offset:4096
    v_mfma_f32_16x16x32_bf16 v[164:167], a[160:163], a[52:55], v[164:167]
    ds_read_b64_tr_b16 a[188:189], v35 offset:8192
    v_mfma_f32_16x16x32_bf16 v[164:167], a[164:167], a[60:63], v[164:167]
    s_waitcnt lgkmcnt(9)
    buffer_load_dwordx4 v45, s[16:19], s49 offen offset:3072 lds
    v_mfma_f32_16x16x32_bf16 v[168:171], a[168:171], a[48:51], v[168:171]
    s_waitcnt lgkmcnt(7)
    ds_read_b64_tr_b16 a[190:191], v35 offset:12288
    ds_read_b64_tr_b16 a[160:161], v28 offset:16384
    v_mfma_f32_16x16x32_bf16 v[168:171], a[172:175], a[56:59], v[168:171]
    s_add_u32 s49, s44, 3145984
    ds_read_b64_tr_b16 a[162:163], v28 offset:20480
    v_mfma_f32_16x16x32_bf16 v[172:175], a[168:171], a[52:55], v[172:175]
    s_add_u32 m0, s42, 81920
    ds_read_b64_tr_b16 a[164:165], v28 offset:24576
    v_mfma_f32_16x16x32_bf16 v[172:175], a[172:175], a[60:63], v[172:175]
    s_waitcnt lgkmcnt(9)
    buffer_load_dwordx4 v42, s[16:19], s49 offen lds
    v_mfma_f32_16x16x32_bf16 v[176:179], a[176:179], a[48:51], v[176:179]
    s_waitcnt lgkmcnt(7)
    ds_read_b64_tr_b16 a[166:167], v28 offset:28672
    ds_read_b64_tr_b16 a[168:169], v29 offset:16384
    v_mfma_f32_16x16x32_bf16 v[176:179], a[180:183], a[56:59], v[176:179]
    ds_read_b64_tr_b16 a[170:171], v29 offset:20480
    v_mfma_f32_16x16x32_bf16 v[180:183], a[176:179], a[52:55], v[180:183]
    ds_read_b64_tr_b16 a[172:173], v29 offset:24576
    v_mfma_f32_16x16x32_bf16 v[180:183], a[180:183], a[60:63], v[180:183]
    s_waitcnt lgkmcnt(9)
    buffer_load_dwordx4 v43, s[16:19], s49 offen offset:1024 lds
    v_mfma_f32_16x16x32_bf16 v[184:187], a[184:187], a[48:51], v[184:187]
    s_waitcnt lgkmcnt(7)
    ds_read_b64_tr_b16 a[174:175], v29 offset:28672
    ds_read_b64_tr_b16 a[176:177], v30 offset:16384
    v_mfma_f32_16x16x32_bf16 v[184:187], a[188:191], a[56:59], v[184:187]
    ds_read_b64_tr_b16 a[178:179], v30 offset:20480
    v_mfma_f32_16x16x32_bf16 v[188:191], a[184:187], a[52:55], v[188:191]
    ds_read_b64_tr_b16 a[180:181], v30 offset:24576
    v_mfma_f32_16x16x32_bf16 v[188:191], a[188:191], a[60:63], v[188:191]
    s_waitcnt lgkmcnt(9)
    buffer_load_dwordx4 v44, s[16:19], s49 offen offset:2048 lds
    v_mfma_f32_16x16x32_bf16 v[192:195], a[160:163], a[48:51], v[192:195]
    s_waitcnt lgkmcnt(7)
    ds_read_b64_tr_b16 a[182:183], v30 offset:28672
    ds_read_b64_tr_b16 a[184:185], v31 offset:16384
    v_mfma_f32_16x16x32_bf16 v[192:195], a[164:167], a[56:59], v[192:195]
    ds_read_b64_tr_b16 a[186:187], v31 offset:20480
    v_mfma_f32_16x16x32_bf16 v[196:199], a[160:163], a[52:55], v[196:199]
    ds_read_b64_tr_b16 a[188:189], v31 offset:24576
    v_mfma_f32_16x16x32_bf16 v[196:199], a[164:167], a[60:63], v[196:199]
    s_waitcnt lgkmcnt(9)
    buffer_load_dwordx4 v45, s[16:19], s49 offen offset:3072 lds
    v_mfma_f32_16x16x32_bf16 v[200:203], a[168:171], a[48:51], v[200:203]
    s_waitcnt lgkmcnt(7)
    ds_read_b64_tr_b16 a[190:191], v31 offset:28672
    ds_read_b64_tr_b16 a[160:161], v32 offset:16384
    v_mfma_f32_16x16x32_bf16 v[200:203], a[172:175], a[56:59], v[200:203]
    ds_read_b64_tr_b16 a[162:163], v32 offset:20480
    v_mfma_f32_16x16x32_bf16 v[204:207], a[168:171], a[52:55], v[204:207]
    ds_read_b64_tr_b16 a[164:165], v32 offset:24576
    v_mfma_f32_16x16x32_bf16 v[204:207], a[172:175], a[60:63], v[204:207]
    s_waitcnt lgkmcnt(9)
    ds_read_b64_tr_b16 a[166:167], v32 offset:28672
    v_mfma_f32_16x16x32_bf16 v[208:211], a[176:179], a[48:51], v[208:211]
    s_waitcnt lgkmcnt(8)
    ds_read_b64_tr_b16 a[168:169], v33 offset:16384
    v_mfma_f32_16x16x32_bf16 v[208:211], a[180:183], a[56:59], v[208:211]
    ds_read_b64_tr_b16 a[170:171], v33 offset:20480
    v_mfma_f32_16x16x32_bf16 v[212:215], a[176:179], a[52:55], v[212:215]
    ds_read_b64_tr_b16 a[172:173], v33 offset:24576
    v_mfma_f32_16x16x32_bf16 v[212:215], a[180:183], a[60:63], v[212:215]
    s_waitcnt lgkmcnt(9)
    ds_read_b64_tr_b16 a[174:175], v33 offset:28672
    v_mfma_f32_16x16x32_bf16 v[216:219], a[184:187], a[48:51], v[216:219]
    s_waitcnt lgkmcnt(8)
    ds_read_b64_tr_b16 a[176:177], v34 offset:16384
    v_mfma_f32_16x16x32_bf16 v[216:219], a[188:191], a[56:59], v[216:219]
    ds_read_b64_tr_b16 a[178:179], v34 offset:20480
    v_mfma_f32_16x16x32_bf16 v[220:223], a[184:187], a[52:55], v[220:223]
    ds_read_b64_tr_b16 a[180:181], v34 offset:24576
    v_mfma_f32_16x16x32_bf16 v[220:223], a[188:191], a[60:63], v[220:223]
    s_waitcnt lgkmcnt(9)
    ds_read_b64_tr_b16 a[182:183], v34 offset:28672
    v_mfma_f32_16x16x32_bf16 v[224:227], a[160:163], a[48:51], v[224:227]
    s_waitcnt lgkmcnt(8)
    ds_read_b64_tr_b16 a[184:185], v35 offset:16384
    v_mfma_f32_16x16x32_bf16 v[224:227], a[164:167], a[56:59], v[224:227]
    ds_read_b64_tr_b16 a[186:187], v35 offset:20480
    v_mfma_f32_16x16x32_bf16 v[228:231], a[160:163], a[52:55], v[228:231]
    ds_read_b64_tr_b16 a[188:189], v35 offset:24576
    v_mfma_f32_16x16x32_bf16 v[228:231], a[164:167], a[60:63], v[228:231]
    s_waitcnt lgkmcnt(9)
    ds_read_b64_tr_b16 a[190:191], v35 offset:28672
    s_waitcnt vmcnt(36)
    s_barrier
    v_mfma_f32_16x16x32_bf16 v[232:235], a[168:171], a[48:51], v[232:235]
    s_waitcnt lgkmcnt(8)
    ds_read_b64_tr_b16 a[160:161], v12 offset:0
    v_mfma_f32_16x16x32_bf16 v[232:235], a[172:175], a[56:59], v[232:235]
    s_add_u32 s49, s44, 3670016
    ds_read_b64_tr_b16 a[162:163], v12 offset:4096
    v_mfma_f32_16x16x32_bf16 v[236:239], a[168:171], a[52:55], v[236:239]
    s_add_u32 m0, s42, 98304
    ds_read_b64_tr_b16 a[164:165], v12 offset:8192
    v_mfma_f32_16x16x32_bf16 v[236:239], a[172:175], a[60:63], v[236:239]
    s_waitcnt lgkmcnt(9)
    buffer_load_dwordx4 v42, s[16:19], s49 offen lds
    v_mfma_f32_16x16x32_bf16 v[240:243], a[176:179], a[48:51], v[240:243]
    s_waitcnt lgkmcnt(7)
    ds_read_b64_tr_b16 a[166:167], v12 offset:12288
    ds_read_b64_tr_b16 a[168:169], v13 offset:0
    v_mfma_f32_16x16x32_bf16 v[240:243], a[180:183], a[56:59], v[240:243]
    ds_read_b64_tr_b16 a[170:171], v13 offset:4096
    v_mfma_f32_16x16x32_bf16 v[244:247], a[176:179], a[52:55], v[244:247]
    ds_read_b64_tr_b16 a[172:173], v13 offset:8192
    v_mfma_f32_16x16x32_bf16 v[244:247], a[180:183], a[60:63], v[244:247]
    s_waitcnt lgkmcnt(9)
    buffer_load_dwordx4 v43, s[16:19], s49 offen offset:1024 lds
    v_mfma_f32_16x16x32_bf16 v[248:251], a[184:187], a[48:51], v[248:251]
    s_waitcnt lgkmcnt(7)
    ds_read_b64_tr_b16 a[174:175], v13 offset:12288
    ds_read_b64_tr_b16 a[176:177], v14 offset:0
    v_mfma_f32_16x16x32_bf16 v[248:251], a[188:191], a[56:59], v[248:251]
    ds_read_b64_tr_b16 a[178:179], v14 offset:4096
    v_mfma_f32_16x16x32_bf16 v[252:255], a[184:187], a[52:55], v[252:255]
    ds_read_b64_tr_b16 a[180:181], v14 offset:8192
    v_mfma_f32_16x16x32_bf16 v[252:255], a[188:191], a[60:63], v[252:255]
    s_waitcnt vmcnt(37)
    s_waitcnt lgkmcnt(9)
    buffer_load_dwordx4 v44, s[16:19], s49 offen offset:2048 lds
    v_mfma_f32_16x16x32_bf16 v[128:131], a[160:163], a[64:67], v[128:131]
    s_waitcnt vmcnt(37)
    s_waitcnt lgkmcnt(7)
    ds_read_b64_tr_b16 a[182:183], v14 offset:12288
    ds_read_b64_tr_b16 a[184:185], v15 offset:0
    v_mfma_f32_16x16x32_bf16 v[128:131], a[164:167], a[72:75], v[128:131]
    s_waitcnt vmcnt(36)
    ds_read_b64_tr_b16 a[186:187], v15 offset:4096
    v_mfma_f32_16x16x32_bf16 v[132:135], a[160:163], a[68:71], v[132:135]
    s_waitcnt vmcnt(35)
    ds_read_b64_tr_b16 a[188:189], v15 offset:8192
    v_mfma_f32_16x16x32_bf16 v[132:135], a[164:167], a[76:79], v[132:135]
    s_waitcnt lgkmcnt(9)
    buffer_load_dwordx4 v45, s[16:19], s49 offen offset:3072 lds
    v_mfma_f32_16x16x32_bf16 v[136:139], a[168:171], a[64:67], v[136:139]
    s_waitcnt lgkmcnt(7)
    ds_read_b64_tr_b16 a[190:191], v15 offset:12288
    ds_read_b64_tr_b16 a[160:161], v16 offset:0
    v_mfma_f32_16x16x32_bf16 v[136:139], a[172:175], a[72:75], v[136:139]
    s_add_u32 s49, s44, 3670272
    ds_read_b64_tr_b16 a[162:163], v16 offset:4096
    v_mfma_f32_16x16x32_bf16 v[140:143], a[168:171], a[68:71], v[140:143]
    s_add_u32 m0, s42, 114688
    ds_read_b64_tr_b16 a[164:165], v16 offset:8192
    v_mfma_f32_16x16x32_bf16 v[140:143], a[172:175], a[76:79], v[140:143]
    s_waitcnt lgkmcnt(9)
    buffer_load_dwordx4 v42, s[16:19], s49 offen lds
    v_mfma_f32_16x16x32_bf16 v[144:147], a[176:179], a[64:67], v[144:147]
    s_waitcnt lgkmcnt(7)
    ds_read_b64_tr_b16 a[166:167], v16 offset:12288
    ds_read_b64_tr_b16 a[168:169], v17 offset:0
    v_mfma_f32_16x16x32_bf16 v[144:147], a[180:183], a[72:75], v[144:147]
    ds_read_b64_tr_b16 a[170:171], v17 offset:4096
    v_mfma_f32_16x16x32_bf16 v[148:151], a[176:179], a[68:71], v[148:151]
    ds_read_b64_tr_b16 a[172:173], v17 offset:8192
    v_mfma_f32_16x16x32_bf16 v[148:151], a[180:183], a[76:79], v[148:151]
    s_waitcnt lgkmcnt(9)
    buffer_load_dwordx4 v43, s[16:19], s49 offen offset:1024 lds
    v_mfma_f32_16x16x32_bf16 v[152:155], a[184:187], a[64:67], v[152:155]
    s_waitcnt lgkmcnt(7)
    ds_read_b64_tr_b16 a[174:175], v17 offset:12288
    ds_read_b64_tr_b16 a[176:177], v18 offset:0
    v_mfma_f32_16x16x32_bf16 v[152:155], a[188:191], a[72:75], v[152:155]
    ds_read_b64_tr_b16 a[178:179], v18 offset:4096
    v_mfma_f32_16x16x32_bf16 v[156:159], a[184:187], a[68:71], v[156:159]
    ds_read_b64_tr_b16 a[180:181], v18 offset:8192
    v_mfma_f32_16x16x32_bf16 v[156:159], a[188:191], a[76:79], v[156:159]
    s_waitcnt lgkmcnt(9)
    buffer_load_dwordx4 v44, s[16:19], s49 offen offset:2048 lds
    v_mfma_f32_16x16x32_bf16 v[160:163], a[160:163], a[64:67], v[160:163]
    s_waitcnt lgkmcnt(7)
    ds_read_b64_tr_b16 a[182:183], v18 offset:12288
    ds_read_b64_tr_b16 a[184:185], v19 offset:0
    v_mfma_f32_16x16x32_bf16 v[160:163], a[164:167], a[72:75], v[160:163]
    ds_read_b64_tr_b16 a[186:187], v19 offset:4096
    v_mfma_f32_16x16x32_bf16 v[164:167], a[160:163], a[68:71], v[164:167]
    ds_read_b64_tr_b16 a[188:189], v19 offset:8192
    v_mfma_f32_16x16x32_bf16 v[164:167], a[164:167], a[76:79], v[164:167]
    s_waitcnt lgkmcnt(9)
    buffer_load_dwordx4 v45, s[16:19], s49 offen offset:3072 lds
    v_mfma_f32_16x16x32_bf16 v[168:171], a[168:171], a[64:67], v[168:171]
    s_waitcnt lgkmcnt(7)
    ds_read_b64_tr_b16 a[190:191], v19 offset:12288
    ds_read_b64_tr_b16 a[160:161], v12 offset:16384
    v_mfma_f32_16x16x32_bf16 v[168:171], a[172:175], a[72:75], v[168:171]
    ds_read_b64_tr_b16 a[162:163], v12 offset:20480
    v_mfma_f32_16x16x32_bf16 v[172:175], a[168:171], a[68:71], v[172:175]
    ds_read_b64_tr_b16 a[164:165], v12 offset:24576
    v_mfma_f32_16x16x32_bf16 v[172:175], a[172:175], a[76:79], v[172:175]
    s_waitcnt lgkmcnt(9)
    buffer_atomic_add v65, v64, s[88:91], 0 offen sc1
    v_mfma_f32_16x16x32_bf16 v[176:179], a[176:179], a[64:67], v[176:179]
    s_waitcnt lgkmcnt(7)
    ds_read_b64_tr_b16 a[166:167], v12 offset:28672
    ds_read_b64_tr_b16 a[168:169], v13 offset:16384
    v_mfma_f32_16x16x32_bf16 v[176:179], a[180:183], a[72:75], v[176:179]
    ds_read_b64_tr_b16 a[170:171], v13 offset:20480
    v_mfma_f32_16x16x32_bf16 v[180:183], a[176:179], a[68:71], v[180:183]
    ds_read_b64_tr_b16 a[172:173], v13 offset:24576
    v_mfma_f32_16x16x32_bf16 v[180:183], a[180:183], a[76:79], v[180:183]
    s_waitcnt lgkmcnt(9)
    ds_read_b64_tr_b16 a[174:175], v13 offset:28672
    v_mfma_f32_16x16x32_bf16 v[184:187], a[184:187], a[64:67], v[184:187]
    s_waitcnt lgkmcnt(8)
    ds_read_b64_tr_b16 a[176:177], v14 offset:16384
    v_mfma_f32_16x16x32_bf16 v[184:187], a[188:191], a[72:75], v[184:187]
    ds_read_b64_tr_b16 a[178:179], v14 offset:20480
    v_mfma_f32_16x16x32_bf16 v[188:191], a[184:187], a[68:71], v[188:191]
    ds_read_b64_tr_b16 a[180:181], v14 offset:24576
    v_mfma_f32_16x16x32_bf16 v[188:191], a[188:191], a[76:79], v[188:191]
    s_waitcnt lgkmcnt(9)
    ds_read_b64_tr_b16 a[182:183], v14 offset:28672
    v_mfma_f32_16x16x32_bf16 v[192:195], a[160:163], a[64:67], v[192:195]
    s_waitcnt lgkmcnt(8)
    ds_read_b64_tr_b16 a[184:185], v15 offset:16384
    v_mfma_f32_16x16x32_bf16 v[192:195], a[164:167], a[72:75], v[192:195]
    ds_read_b64_tr_b16 a[186:187], v15 offset:20480
    v_mfma_f32_16x16x32_bf16 v[196:199], a[160:163], a[68:71], v[196:199]
    ds_read_b64_tr_b16 a[188:189], v15 offset:24576
    v_mfma_f32_16x16x32_bf16 v[196:199], a[164:167], a[76:79], v[196:199]
    s_waitcnt lgkmcnt(9)
    ds_read_b64_tr_b16 a[190:191], v15 offset:28672
    v_mfma_f32_16x16x32_bf16 v[200:203], a[168:171], a[64:67], v[200:203]
    s_waitcnt lgkmcnt(8)
    ds_read_b64_tr_b16 a[160:161], v16 offset:16384
    v_mfma_f32_16x16x32_bf16 v[200:203], a[172:175], a[72:75], v[200:203]
    ds_read_b64_tr_b16 a[162:163], v16 offset:20480
    v_mfma_f32_16x16x32_bf16 v[204:207], a[168:171], a[68:71], v[204:207]
    ds_read_b64_tr_b16 a[164:165], v16 offset:24576
    v_mfma_f32_16x16x32_bf16 v[204:207], a[172:175], a[76:79], v[204:207]
    s_waitcnt lgkmcnt(9)
    ds_read_b64_tr_b16 a[166:167], v16 offset:28672
    v_mfma_f32_16x16x32_bf16 v[208:211], a[176:179], a[64:67], v[208:211]
    s_waitcnt lgkmcnt(8)
    ds_read_b64_tr_b16 a[168:169], v17 offset:16384
    v_mfma_f32_16x16x32_bf16 v[208:211], a[180:183], a[72:75], v[208:211]
    ds_read_b64_tr_b16 a[170:171], v17 offset:20480
    v_mfma_f32_16x16x32_bf16 v[212:215], a[176:179], a[68:71], v[212:215]
    ds_read_b64_tr_b16 a[172:173], v17 offset:24576
    v_mfma_f32_16x16x32_bf16 v[212:215], a[180:183], a[76:79], v[212:215]
    s_waitcnt lgkmcnt(9)
    ds_read_b64_tr_b16 a[174:175], v17 offset:28672
    v_mfma_f32_16x16x32_bf16 v[216:219], a[184:187], a[64:67], v[216:219]
    s_waitcnt lgkmcnt(8)
    ds_read_b64_tr_b16 a[176:177], v18 offset:16384
    v_mfma_f32_16x16x32_bf16 v[216:219], a[188:191], a[72:75], v[216:219]
    ds_read_b64_tr_b16 a[178:179], v18 offset:20480
    v_mfma_f32_16x16x32_bf16 v[220:223], a[184:187], a[68:71], v[220:223]
    ds_read_b64_tr_b16 a[180:181], v18 offset:24576
    v_mfma_f32_16x16x32_bf16 v[220:223], a[188:191], a[76:79], v[220:223]
    s_waitcnt lgkmcnt(9)
    ds_read_b64_tr_b16 a[182:183], v18 offset:28672
    v_mfma_f32_16x16x32_bf16 v[224:227], a[160:163], a[64:67], v[224:227]
    s_waitcnt lgkmcnt(8)
    ds_read_b64_tr_b16 a[184:185], v19 offset:16384
    v_mfma_f32_16x16x32_bf16 v[224:227], a[164:167], a[72:75], v[224:227]
    ds_read_b64_tr_b16 a[186:187], v19 offset:20480
    v_mfma_f32_16x16x32_bf16 v[228:231], a[160:163], a[68:71], v[228:231]
    ds_read_b64_tr_b16 a[188:189], v19 offset:24576
    v_mfma_f32_16x16x32_bf16 v[228:231], a[164:167], a[76:79], v[228:231]
    s_waitcnt lgkmcnt(9)
    ds_read_b64_tr_b16 a[190:191], v19 offset:28672
    s_waitcnt vmcnt(21)
    s_barrier
    v_mfma_f32_16x16x32_bf16 v[232:235], a[168:171], a[64:67], v[232:235]
    s_waitcnt lgkmcnt(8)
    ds_read_b64_tr_b16 a[160:161], v12 offset:32768
    v_mfma_f32_16x16x32_bf16 v[232:235], a[172:175], a[72:75], v[232:235]
    s_add_u32 s49, s44, 4194304
    ds_read_b64_tr_b16 a[162:163], v12 offset:36864
    v_mfma_f32_16x16x32_bf16 v[236:239], a[168:171], a[68:71], v[236:239]
    s_add_u32 m0, s42, 131072
    ds_read_b64_tr_b16 a[164:165], v12 offset:40960
    v_mfma_f32_16x16x32_bf16 v[236:239], a[172:175], a[76:79], v[236:239]
    s_waitcnt lgkmcnt(9)
    buffer_load_dwordx4 v42, s[16:19], s49 offen lds
    v_mfma_f32_16x16x32_bf16 v[240:243], a[176:179], a[64:67], v[240:243]
    s_waitcnt lgkmcnt(7)
    ds_read_b64_tr_b16 a[166:167], v12 offset:45056
    ds_read_b64_tr_b16 a[168:169], v13 offset:32768
    v_mfma_f32_16x16x32_bf16 v[240:243], a[180:183], a[72:75], v[240:243]
    ds_read_b64_tr_b16 a[170:171], v13 offset:36864
    v_mfma_f32_16x16x32_bf16 v[244:247], a[176:179], a[68:71], v[244:247]
    ds_read_b64_tr_b16 a[172:173], v13 offset:40960
    v_mfma_f32_16x16x32_bf16 v[244:247], a[180:183], a[76:79], v[244:247]
    s_waitcnt lgkmcnt(9)
    buffer_load_dwordx4 v43, s[16:19], s49 offen offset:1024 lds
    v_mfma_f32_16x16x32_bf16 v[248:251], a[184:187], a[64:67], v[248:251]
    s_waitcnt lgkmcnt(7)
    ds_read_b64_tr_b16 a[174:175], v13 offset:45056
    ds_read_b64_tr_b16 a[176:177], v14 offset:32768
    v_mfma_f32_16x16x32_bf16 v[248:251], a[188:191], a[72:75], v[248:251]
    ds_read_b64_tr_b16 a[178:179], v14 offset:36864
    v_mfma_f32_16x16x32_bf16 v[252:255], a[184:187], a[68:71], v[252:255]
    ds_read_b64_tr_b16 a[180:181], v14 offset:40960
    v_mfma_f32_16x16x32_bf16 v[252:255], a[188:191], a[76:79], v[252:255]
    s_waitcnt lgkmcnt(9)
    buffer_load_dwordx4 v44, s[16:19], s49 offen offset:2048 lds
    v_mfma_f32_16x16x32_bf16 v[128:131], a[160:163], a[80:83], v[128:131]
    s_waitcnt lgkmcnt(7)
    ds_read_b64_tr_b16 a[182:183], v14 offset:45056
    ds_read_b64_tr_b16 a[184:185], v15 offset:32768
    v_mfma_f32_16x16x32_bf16 v[128:131], a[164:167], a[88:91], v[128:131]
    ds_read_b64_tr_b16 a[186:187], v15 offset:36864
    v_mfma_f32_16x16x32_bf16 v[132:135], a[160:163], a[84:87], v[132:135]
    ds_read_b64_tr_b16 a[188:189], v15 offset:40960
    v_mfma_f32_16x16x32_bf16 v[132:135], a[164:167], a[92:95], v[132:135]
    s_waitcnt lgkmcnt(9)
    buffer_load_dwordx4 v45, s[16:19], s49 offen offset:3072 lds
    v_mfma_f32_16x16x32_bf16 v[136:139], a[168:171], a[80:83], v[136:139]
    s_waitcnt lgkmcnt(7)
    ds_read_b64_tr_b16 a[190:191], v15 offset:45056
    ds_read_b64_tr_b16 a[160:161], v16 offset:32768
    v_mfma_f32_16x16x32_bf16 v[136:139], a[172:175], a[88:91], v[136:139]
    s_add_u32 s49, s44, 4194560
    ds_read_b64_tr_b16 a[162:163], v16 offset:36864
    v_mfma_f32_16x16x32_bf16 v[140:143], a[168:171], a[84:87], v[140:143]
    s_add_u32 m0, s42, 147456
    ds_read_b64_tr_b16 a[164:165], v16 offset:40960
    v_mfma_f32_16x16x32_bf16 v[140:143], a[172:175], a[92:95], v[140:143]
    s_waitcnt lgkmcnt(9)
    buffer_load_dwordx4 v42, s[16:19], s49 offen lds
    v_mfma_f32_16x16x32_bf16 v[144:147], a[176:179], a[80:83], v[144:147]
    s_waitcnt lgkmcnt(7)
    ds_read_b64_tr_b16 a[166:167], v16 offset:45056
    ds_read_b64_tr_b16 a[168:169], v17 offset:32768
    v_mfma_f32_16x16x32_bf16 v[144:147], a[180:183], a[88:91], v[144:147]
    ds_read_b64_tr_b16 a[170:171], v17 offset:36864
    v_mfma_f32_16x16x32_bf16 v[148:151], a[176:179], a[84:87], v[148:151]
    ds_read_b64_tr_b16 a[172:173], v17 offset:40960
    v_mfma_f32_16x16x32_bf16 v[148:151], a[180:183], a[92:95], v[148:151]
    s_waitcnt lgkmcnt(9)
    buffer_load_dwordx4 v43, s[16:19], s49 offen offset:1024 lds
    v_mfma_f32_16x16x32_bf16 v[152:155], a[184:187], a[80:83], v[152:155]
    s_waitcnt lgkmcnt(7)
    ds_read_b64_tr_b16 a[174:175], v17 offset:45056
    ds_read_b64_tr_b16 a[176:177], v18 offset:32768
    v_mfma_f32_16x16x32_bf16 v[152:155], a[188:191], a[88:91], v[152:155]
    ds_read_b64_tr_b16 a[178:179], v18 offset:36864
    v_mfma_f32_16x16x32_bf16 v[156:159], a[184:187], a[84:87], v[156:159]
    ds_read_b64_tr_b16 a[180:181], v18 offset:40960
    v_mfma_f32_16x16x32_bf16 v[156:159], a[188:191], a[92:95], v[156:159]
    s_waitcnt lgkmcnt(9)
    buffer_load_dwordx4 v44, s[16:19], s49 offen offset:2048 lds
    v_mfma_f32_16x16x32_bf16 v[160:163], a[160:163], a[80:83], v[160:163]
    s_waitcnt lgkmcnt(7)
    ds_read_b64_tr_b16 a[182:183], v18 offset:45056
    ds_read_b64_tr_b16 a[184:185], v19 offset:32768
    v_mfma_f32_16x16x32_bf16 v[160:163], a[164:167], a[88:91], v[160:163]
    ds_read_b64_tr_b16 a[186:187], v19 offset:36864
    v_mfma_f32_16x16x32_bf16 v[164:167], a[160:163], a[84:87], v[164:167]
    ds_read_b64_tr_b16 a[188:189], v19 offset:40960
    v_mfma_f32_16x16x32_bf16 v[164:167], a[164:167], a[92:95], v[164:167]
    s_waitcnt lgkmcnt(9)
    buffer_load_dwordx4 v45, s[16:19], s49 offen offset:3072 lds
    v_mfma_f32_16x16x32_bf16 v[168:171], a[168:171], a[80:83], v[168:171]
    s_waitcnt lgkmcnt(7)
    ds_read_b64_tr_b16 a[190:191], v19 offset:45056
    ds_read_b64_tr_b16 a[160:161], v12 offset:49152
    v_mfma_f32_16x16x32_bf16 v[168:171], a[172:175], a[88:91], v[168:171]
    ds_read_b64_tr_b16 a[162:163], v12 offset:53248
    v_mfma_f32_16x16x32_bf16 v[172:175], a[168:171], a[84:87], v[172:175]
    ds_read_b64_tr_b16 a[164:165], v12 offset:57344
    v_mfma_f32_16x16x32_bf16 v[172:175], a[172:175], a[92:95], v[172:175]
    s_waitcnt lgkmcnt(9)
    ds_read_b64_tr_b16 a[166:167], v12 offset:61440
    v_mfma_f32_16x16x32_bf16 v[176:179], a[176:179], a[80:83], v[176:179]
    s_waitcnt lgkmcnt(8)
    ds_read_b64_tr_b16 a[168:169], v13 offset:49152
    v_mfma_f32_16x16x32_bf16 v[176:179], a[180:183], a[88:91], v[176:179]
    ds_read_b64_tr_b16 a[170:171], v13 offset:53248
    v_mfma_f32_16x16x32_bf16 v[180:183], a[176:179], a[84:87], v[180:183]
    ds_read_b64_tr_b16 a[172:173], v13 offset:57344
    v_mfma_f32_16x16x32_bf16 v[180:183], a[180:183], a[92:95], v[180:183]
    s_waitcnt lgkmcnt(9)
    ds_read_b64_tr_b16 a[174:175], v13 offset:61440
    v_mfma_f32_16x16x32_bf16 v[184:187], a[184:187], a[80:83], v[184:187]
    s_waitcnt lgkmcnt(8)
    ds_read_b64_tr_b16 a[176:177], v14 offset:49152
    v_mfma_f32_16x16x32_bf16 v[184:187], a[188:191], a[88:91], v[184:187]
    ds_read_b64_tr_b16 a[178:179], v14 offset:53248
    v_mfma_f32_16x16x32_bf16 v[188:191], a[184:187], a[84:87], v[188:191]
    ds_read_b64_tr_b16 a[180:181], v14 offset:57344
    v_mfma_f32_16x16x32_bf16 v[188:191], a[188:191], a[92:95], v[188:191]
    s_waitcnt lgkmcnt(9)
    ds_read_b64_tr_b16 a[182:183], v14 offset:61440
    v_mfma_f32_16x16x32_bf16 v[192:195], a[160:163], a[80:83], v[192:195]
    s_waitcnt lgkmcnt(8)
    ds_read_b64_tr_b16 a[184:185], v15 offset:49152
    v_mfma_f32_16x16x32_bf16 v[192:195], a[164:167], a[88:91], v[192:195]
    ds_read_b64_tr_b16 a[186:187], v15 offset:53248
    v_mfma_f32_16x16x32_bf16 v[196:199], a[160:163], a[84:87], v[196:199]
    ds_read_b64_tr_b16 a[188:189], v15 offset:57344
    v_mfma_f32_16x16x32_bf16 v[196:199], a[164:167], a[92:95], v[196:199]
    s_waitcnt lgkmcnt(9)
    ds_read_b64_tr_b16 a[190:191], v15 offset:61440
    v_mfma_f32_16x16x32_bf16 v[200:203], a[168:171], a[80:83], v[200:203]
    s_waitcnt lgkmcnt(8)
    ds_read_b64_tr_b16 a[160:161], v16 offset:49152
    v_mfma_f32_16x16x32_bf16 v[200:203], a[172:175], a[88:91], v[200:203]
    ds_read_b64_tr_b16 a[162:163], v16 offset:53248
    v_mfma_f32_16x16x32_bf16 v[204:207], a[168:171], a[84:87], v[204:207]
    ds_read_b64_tr_b16 a[164:165], v16 offset:57344
    v_mfma_f32_16x16x32_bf16 v[204:207], a[172:175], a[92:95], v[204:207]
    s_waitcnt lgkmcnt(9)
    ds_read_b64_tr_b16 a[166:167], v16 offset:61440
    v_mfma_f32_16x16x32_bf16 v[208:211], a[176:179], a[80:83], v[208:211]
    s_waitcnt lgkmcnt(8)
    ds_read_b64_tr_b16 a[168:169], v17 offset:49152
    v_mfma_f32_16x16x32_bf16 v[208:211], a[180:183], a[88:91], v[208:211]
    ds_read_b64_tr_b16 a[170:171], v17 offset:53248
    v_mfma_f32_16x16x32_bf16 v[212:215], a[176:179], a[84:87], v[212:215]
    ds_read_b64_tr_b16 a[172:173], v17 offset:57344
    v_mfma_f32_16x16x32_bf16 v[212:215], a[180:183], a[92:95], v[212:215]
    s_waitcnt lgkmcnt(9)
    ds_read_b64_tr_b16 a[174:175], v17 offset:61440
    v_mfma_f32_16x16x32_bf16 v[216:219], a[184:187], a[80:83], v[216:219]
    s_waitcnt lgkmcnt(8)
    ds_read_b64_tr_b16 a[176:177], v18 offset:49152
    v_mfma_f32_16x16x32_bf16 v[216:219], a[188:191], a[88:91], v[216:219]
    ds_read_b64_tr_b16 a[178:179], v18 offset:53248
    v_mfma_f32_16x16x32_bf16 v[220:223], a[184:187], a[84:87], v[220:223]
    ds_read_b64_tr_b16 a[180:181], v18 offset:57344
    v_mfma_f32_16x16x32_bf16 v[220:223], a[188:191], a[92:95], v[220:223]
    s_waitcnt lgkmcnt(9)
    ds_read_b64_tr_b16 a[182:183], v18 offset:61440
    v_mfma_f32_16x16x32_bf16 v[224:227], a[160:163], a[80:83], v[224:227]
    s_waitcnt lgkmcnt(8)
    ds_read_b64_tr_b16 a[184:185], v19 offset:49152
    v_mfma_f32_16x16x32_bf16 v[224:227], a[164:167], a[88:91], v[224:227]
    ds_read_b64_tr_b16 a[186:187], v19 offset:53248
    v_mfma_f32_16x16x32_bf16 v[228:231], a[160:163], a[84:87], v[228:231]
    ds_read_b64_tr_b16 a[188:189], v19 offset:57344
    v_mfma_f32_16x16x32_bf16 v[228:231], a[164:167], a[92:95], v[228:231]
    s_waitcnt lgkmcnt(9)
    ds_read_b64_tr_b16 a[190:191], v19 offset:61440
    s_waitcnt vmcnt(17)
    s_barrier
    v_mfma_f32_16x16x32_bf16 v[232:235], a[168:171], a[80:83], v[232:235]
    s_waitcnt lgkmcnt(8)
    ds_read_b64_tr_b16 a[160:161], v20 offset:0
    v_mfma_f32_16x16x32_bf16 v[232:235], a[172:175], a[88:91], v[232:235]
    ds_read_b64_tr_b16 a[162:163], v20 offset:4096
    v_mfma_f32_16x16x32_bf16 v[236:239], a[168:171], a[84:87], v[236:239]
    s_add_u32 m0, s42, 0
    ds_read_b64_tr_b16 a[164:165], v20 offset:8192
    v_mfma_f32_16x16x32_bf16 v[236:239], a[172:175], a[92:95], v[236:239]
    s_waitcnt lgkmcnt(9)
    buffer_load_dwordx4 v36, s[8:11], s40 offen lds
    v_mfma_f32_16x16x32_bf16 v[240:243], a[176:179], a[80:83], v[240:243]
    s_waitcnt lgkmcnt(7)
    ds_read_b64_tr_b16 a[166:167], v20 offset:12288
    ds_read_b64_tr_b16 a[168:169], v21 offset:0
    v_mfma_f32_16x16x32_bf16 v[240:243], a[180:183], a[88:91], v[240:243]
    ds_read_b64_tr_b16 a[170:171], v21 offset:4096
    v_mfma_f32_16x16x32_bf16 v[244:247], a[176:179], a[84:87], v[244:247]
    ds_read_b64_tr_b16 a[172:173], v21 offset:8192
    v_mfma_f32_16x16x32_bf16 v[244:247], a[180:183], a[92:95], v[244:247]
    s_waitcnt lgkmcnt(9)
    buffer_load_dwordx4 v37, s[8:11], s40 offen offset:1024 lds
    v_mfma_f32_16x16x32_bf16 v[248:251], a[184:187], a[80:83], v[248:251]
    s_waitcnt lgkmcnt(7)
    ds_read_b64_tr_b16 a[174:175], v21 offset:12288
    ds_read_b64_tr_b16 a[176:177], v22 offset:0
    v_mfma_f32_16x16x32_bf16 v[248:251], a[188:191], a[88:91], v[248:251]
    ds_read_b64_tr_b16 a[178:179], v22 offset:4096
    v_mfma_f32_16x16x32_bf16 v[252:255], a[184:187], a[84:87], v[252:255]
    ds_read_b64_tr_b16 a[180:181], v22 offset:8192
    v_mfma_f32_16x16x32_bf16 v[252:255], a[188:191], a[92:95], v[252:255]
    s_waitcnt lgkmcnt(9)
    buffer_load_dwordx4 v38, s[8:11], s40 offen offset:2048 lds
    v_mfma_f32_16x16x32_bf16 v[128:131], a[160:163], a[96:99], v[128:131]
    s_waitcnt lgkmcnt(7)
    ds_read_b64_tr_b16 a[182:183], v22 offset:12288
    ds_read_b64_tr_b16 a[184:185], v23 offset:0
    v_mfma_f32_16x16x32_bf16 v[128:131], a[164:167], a[104:107], v[128:131]
    ds_read_b64_tr_b16 a[186:187], v23 offset:4096
    v_mfma_f32_16x16x32_bf16 v[132:135], a[160:163], a[100:103], v[132:135]
    ds_read_b64_tr_b16 a[188:189], v23 offset:8192
    v_mfma_f32_16x16x32_bf16 v[132:135], a[164:167], a[108:111], v[132:135]
    s_waitcnt lgkmcnt(9)
    buffer_load_dwordx4 v39, s[8:11], s40 offen offset:3072 lds
    v_mfma_f32_16x16x32_bf16 v[136:139], a[168:171], a[96:99], v[136:139]
    s_waitcnt lgkmcnt(7)
    s_add_u32 s40, s40, 16384
    ds_read_b64_tr_b16 a[190:191], v23 offset:12288
    ds_read_b64_tr_b16 a[160:161], v24 offset:0
    v_mfma_f32_16x16x32_bf16 v[136:139], a[172:175], a[104:107], v[136:139]
    ds_read_b64_tr_b16 a[162:163], v24 offset:4096
    v_mfma_f32_16x16x32_bf16 v[140:143], a[168:171], a[100:103], v[140:143]
    s_add_u32 m0, s42, 16384
    ds_read_b64_tr_b16 a[164:165], v24 offset:8192
    v_mfma_f32_16x16x32_bf16 v[140:143], a[172:175], a[108:111], v[140:143]
    s_waitcnt lgkmcnt(9)
    buffer_load_dwordx4 v36, s[8:11], s40 offen lds
    v_mfma_f32_16x16x32_bf16 v[144:147], a[176:179], a[96:99], v[144:147]
    s_waitcnt lgkmcnt(7)
    ds_read_b64_tr_b16 a[166:167], v24 offset:12288
    ds_read_b64_tr_b16 a[168:169], v25 offset:0
    v_mfma_f32_16x16x32_bf16 v[144:147], a[180:183], a[104:107], v[144:147]
    ds_read_b64_tr_b16 a[170:171], v25 offset:4096
    v_mfma_f32_16x16x32_bf16 v[148:151], a[176:179], a[100:103], v[148:151]
    ds_read_b64_tr_b16 a[172:173], v25 offset:8192
    v_mfma_f32_16x16x32_bf16 v[148:151], a[180:183], a[108:111], v[148:151]
    s_waitcnt lgkmcnt(9)
    buffer_load_dwordx4 v37, s[8:11], s40 offen offset:1024 lds
    v_mfma_f32_16x16x32_bf16 v[152:155], a[184:187], a[96:99], v[152:155]
    s_waitcnt lgkmcnt(7)
    ds_read_b64_tr_b16 a[174:175], v25 offset:12288
    ds_read_b64_tr_b16 a[176:177], v26 offset:0
    v_mfma_f32_16x16x32_bf16 v[152:155], a[188:191], a[104:107], v[152:155]
    ds_read_b64_tr_b16 a[178:179], v26 offset:4096
    v_mfma_f32_16x16x32_bf16 v[156:159], a[184:187], a[100:103], v[156:159]
    ds_read_b64_tr_b16 a[180:181], v26 offset:8192
    v_mfma_f32_16x16x32_bf16 v[156:159], a[188:191], a[108:111], v[156:159]
    s_waitcnt lgkmcnt(9)
    buffer_load_dwordx4 v38, s[8:11], s40 offen offset:2048 lds
    v_mfma_f32_16x16x32_bf16 v[160:163], a[160:163], a[96:99], v[160:163]
    s_waitcnt lgkmcnt(7)
    ds_read_b64_tr_b16 a[182:183], v26 offset:12288
    ds_read_b64_tr_b16 a[184:185], v27 offset:0
    v_mfma_f32_16x16x32_bf16 v[160:163], a[164:167], a[104:107], v[160:163]
    ds_read_b64_tr_b16 a[186:187], v27 offset:4096
    v_accvgpr_write_b32 a0, 0
    v_mfma_f32_16x16x32_bf16 v[164:167], a[160:163], a[100:103], v[164:167]
    ds_read_b64_tr_b16 a[188:189], v27 offset:8192
    v_accvgpr_write_b32 a1, 0
    v_mfma_f32_16x16x32_bf16 v[164:167], a[164:167], a[108:111], v[164:167]
    s_waitcnt lgkmcnt(9)
    buffer_load_dwordx4 v39, s[8:11], s40 offen offset:3072 lds
    v_mfma_f32_16x16x32_bf16 v[168:171], a[168:171], a[96:99], v[168:171]
    s_waitcnt lgkmcnt(7)
    s_add_u32 s40, s40, 16384
    ds_read_b64_tr_b16 a[190:191], v27 offset:12288
    ds_read_b64_tr_b16 a[160:161], v20 offset:16384
    v_mfma_f32_16x16x32_bf16 v[168:171], a[172:175], a[104:107], v[168:171]
    ds_read_b64_tr_b16 a[162:163], v20 offset:20480
    v_accvgpr_write_b32 a2, 0
    v_mfma_f32_16x16x32_bf16 v[172:175], a[168:171], a[100:103], v[172:175]
    ds_read_b64_tr_b16 a[164:165], v20 offset:24576
    v_accvgpr_write_b32 a3, 0
    v_mfma_f32_16x16x32_bf16 v[172:175], a[172:175], a[108:111], v[172:175]
    s_waitcnt lgkmcnt(9)
    ds_read_b64_tr_b16 a[166:167], v20 offset:28672
    v_accvgpr_write_b32 a4, 0
    v_mfma_f32_16x16x32_bf16 v[176:179], a[176:179], a[96:99], v[176:179]
    s_waitcnt lgkmcnt(8)
    ds_read_b64_tr_b16 a[168:169], v21 offset:16384
    v_accvgpr_write_b32 a5, 0
    v_mfma_f32_16x16x32_bf16 v[176:179], a[180:183], a[104:107], v[176:179]
    ds_read_b64_tr_b16 a[170:171], v21 offset:20480
    v_accvgpr_write_b32 a6, 0
    v_mfma_f32_16x16x32_bf16 v[180:183], a[176:179], a[100:103], v[180:183]
    ds_read_b64_tr_b16 a[172:173], v21 offset:24576
    v_accvgpr_write_b32 a7, 0
    v_mfma_f32_16x16x32_bf16 v[180:183], a[180:183], a[108:111], v[180:183]
    s_waitcnt lgkmcnt(9)
    ds_read_b64_tr_b16 a[174:175], v21 offset:28672
    v_accvgpr_write_b32 a8, 0
    v_mfma_f32_16x16x32_bf16 v[184:187], a[184:187], a[96:99], v[184:187]
    s_waitcnt lgkmcnt(8)
    ds_read_b64_tr_b16 a[176:177], v22 offset:16384
    v_accvgpr_write_b32 a9, 0
    v_mfma_f32_16x16x32_bf16 v[184:187], a[188:191], a[104:107], v[184:187]
    ds_read_b64_tr_b16 a[178:179], v22 offset:20480
    v_accvgpr_write_b32 a10, 0
    v_mfma_f32_16x16x32_bf16 v[188:191], a[184:187], a[100:103], v[188:191]
    ds_read_b64_tr_b16 a[180:181], v22 offset:24576
    v_accvgpr_write_b32 a11, 0
    v_mfma_f32_16x16x32_bf16 v[188:191], a[188:191], a[108:111], v[188:191]
    s_waitcnt lgkmcnt(9)
    ds_read_b64_tr_b16 a[182:183], v22 offset:28672
    v_accvgpr_write_b32 a12, 0
    v_mfma_f32_16x16x32_bf16 v[192:195], a[160:163], a[96:99], v[192:195]
    s_waitcnt lgkmcnt(8)
    ds_read_b64_tr_b16 a[184:185], v23 offset:16384
    v_accvgpr_write_b32 a13, 0
    v_mfma_f32_16x16x32_bf16 v[192:195], a[164:167], a[104:107], v[192:195]
    ds_read_b64_tr_b16 a[186:187], v23 offset:20480
    v_accvgpr_write_b32 a14, 0
    v_mfma_f32_16x16x32_bf16 v[196:199], a[160:163], a[100:103], v[196:199]
    ds_read_b64_tr_b16 a[188:189], v23 offset:24576
    v_accvgpr_write_b32 a15, 0
    v_mfma_f32_16x16x32_bf16 v[196:199], a[164:167], a[108:111], v[196:199]
    s_waitcnt lgkmcnt(9)
    ds_read_b64_tr_b16 a[190:191], v23 offset:28672
    v_accvgpr_write_b32 a16, 0
    v_mfma_f32_16x16x32_bf16 v[200:203], a[168:171], a[96:99], v[200:203]
    s_waitcnt lgkmcnt(8)
    ds_read_b64_tr_b16 a[160:161], v24 offset:16384
    v_accvgpr_write_b32 a17, 0
    v_mfma_f32_16x16x32_bf16 v[200:203], a[172:175], a[104:107], v[200:203]
    ds_read_b64_tr_b16 a[162:163], v24 offset:20480
    v_accvgpr_write_b32 a18, 0
    v_mfma_f32_16x16x32_bf16 v[204:207], a[168:171], a[100:103], v[204:207]
    ds_read_b64_tr_b16 a[164:165], v24 offset:24576
    v_accvgpr_write_b32 a19, 0
    v_mfma_f32_16x16x32_bf16 v[204:207], a[172:175], a[108:111], v[204:207]
    s_waitcnt lgkmcnt(9)
    ds_read_b64_tr_b16 a[166:167], v24 offset:28672
    v_accvgpr_write_b32 a20, 0
    v_mfma_f32_16x16x32_bf16 v[208:211], a[176:179], a[96:99], v[208:211]
    s_waitcnt lgkmcnt(8)
    ds_read_b64_tr_b16 a[168:169], v25 offset:16384
    v_accvgpr_write_b32 a21, 0
    v_mfma_f32_16x16x32_bf16 v[208:211], a[180:183], a[104:107], v[208:211]
    ds_read_b64_tr_b16 a[170:171], v25 offset:20480
    v_accvgpr_write_b32 a22, 0
    v_mfma_f32_16x16x32_bf16 v[212:215], a[176:179], a[100:103], v[212:215]
    ds_read_b64_tr_b16 a[172:173], v25 offset:24576
    v_accvgpr_write_b32 a23, 0
    v_mfma_f32_16x16x32_bf16 v[212:215], a[180:183], a[108:111], v[212:215]
    s_waitcnt lgkmcnt(9)
    ds_read_b64_tr_b16 a[174:175], v25 offset:28672
    v_accvgpr_write_b32 a24, 0
    v_mfma_f32_16x16x32_bf16 v[216:219], a[184:187], a[96:99], v[216:219]
    s_waitcnt lgkmcnt(8)
    ds_read_b64_tr_b16 a[176:177], v26 offset:16384
    v_accvgpr_write_b32 a25, 0
    v_mfma_f32_16x16x32_bf16 v[216:219], a[188:191], a[104:107], v[216:219]
    ds_read_b64_tr_b16 a[178:179], v26 offset:20480
    v_accvgpr_write_b32 a26, 0
    v_mfma_f32_16x16x32_bf16 v[220:223], a[184:187], a[100:103], v[220:223]
    ds_read_b64_tr_b16 a[180:181], v26 offset:24576
    v_accvgpr_write_b32 a27, 0
    v_mfma_f32_16x16x32_bf16 v[220:223], a[188:191], a[108:111], v[220:223]
    s_waitcnt lgkmcnt(9)
    ds_read_b64_tr_b16 a[182:183], v26 offset:28672
    v_accvgpr_write_b32 a28, 0
    v_mfma_f32_16x16x32_bf16 v[224:227], a[160:163], a[96:99], v[224:227]
    s_waitcnt lgkmcnt(8)
    ds_read_b64_tr_b16 a[184:185], v27 offset:16384
    v_accvgpr_write_b32 a29, 0
    v_mfma_f32_16x16x32_bf16 v[224:227], a[164:167], a[104:107], v[224:227]
    ds_read_b64_tr_b16 a[186:187], v27 offset:20480
    v_accvgpr_write_b32 a30, 0
    v_mfma_f32_16x16x32_bf16 v[228:231], a[160:163], a[100:103], v[228:231]
    ds_read_b64_tr_b16 a[188:189], v27 offset:24576
    v_accvgpr_write_b32 a31, 0
    v_mfma_f32_16x16x32_bf16 v[228:231], a[164:167], a[108:111], v[228:231]
    s_waitcnt lgkmcnt(9)
    ds_read_b64_tr_b16 a[190:191], v27 offset:28672
    v_accvgpr_write_b32 a32, 0
    s_waitcnt vmcnt(17)
    s_barrier
    v_mfma_f32_16x16x32_bf16 v[232:235], a[168:171], a[96:99], v[232:235]
    s_waitcnt lgkmcnt(8)
    ds_read_b64_tr_b16 a[160:161], v20 offset:32768
    v_accvgpr_write_b32 a33, 0
    v_mfma_f32_16x16x32_bf16 v[232:235], a[172:175], a[104:107], v[232:235]
    ds_read_b64_tr_b16 a[162:163], v20 offset:36864
    v_accvgpr_write_b32 a34, 0
    v_mfma_f32_16x16x32_bf16 v[236:239], a[168:171], a[100:103], v[236:239]
    s_add_u32 m0, s42, 32768
    ds_read_b64_tr_b16 a[164:165], v20 offset:40960
    v_accvgpr_write_b32 a35, 0
    v_mfma_f32_16x16x32_bf16 v[236:239], a[172:175], a[108:111], v[236:239]
    s_waitcnt lgkmcnt(9)
    buffer_load_dwordx4 v36, s[8:11], s40 offen lds
    v_mfma_f32_16x16x32_bf16 v[240:243], a[176:179], a[96:99], v[240:243]
    s_waitcnt lgkmcnt(7)
    ds_read_b64_tr_b16 a[166:167], v20 offset:45056
    ds_read_b64_tr_b16 a[168:169], v21 offset:32768
    v_mfma_f32_16x16x32_bf16 v[240:243], a[180:183], a[104:107], v[240:243]
    ds_read_b64_tr_b16 a[170:171], v21 offset:36864
    v_accvgpr_write_b32 a36, 0
    v_mfma_f32_16x16x32_bf16 v[244:247], a[176:179], a[100:103], v[244:247]
    ds_read_b64_tr_b16 a[172:173], v21 offset:40960
    v_accvgpr_write_b32 a37, 0
    v_mfma_f32_16x16x32_bf16 v[244:247], a[180:183], a[108:111], v[244:247]
    s_waitcnt lgkmcnt(9)
    buffer_load_dwordx4 v37, s[8:11], s40 offen offset:1024 lds
    v_mfma_f32_16x16x32_bf16 v[248:251], a[184:187], a[96:99], v[248:251]
    s_waitcnt lgkmcnt(7)
    ds_read_b64_tr_b16 a[174:175], v21 offset:45056
    ds_read_b64_tr_b16 a[176:177], v22 offset:32768
    v_mfma_f32_16x16x32_bf16 v[248:251], a[188:191], a[104:107], v[248:251]
    ds_read_b64_tr_b16 a[178:179], v22 offset:36864
    v_accvgpr_write_b32 a38, 0
    v_mfma_f32_16x16x32_bf16 v[252:255], a[184:187], a[100:103], v[252:255]
    ds_read_b64_tr_b16 a[180:181], v22 offset:40960
    v_accvgpr_write_b32 a39, 0
    v_mfma_f32_16x16x32_bf16 v[252:255], a[188:191], a[108:111], v[252:255]
    s_waitcnt lgkmcnt(9)
    buffer_load_dwordx4 v38, s[8:11], s40 offen offset:2048 lds
    v_mfma_f32_16x16x32_bf16 v[128:131], a[160:163], a[112:115], v[128:131]
    s_waitcnt lgkmcnt(7)
    ds_read_b64_tr_b16 a[182:183], v22 offset:45056
    ds_read_b64_tr_b16 a[184:185], v23 offset:32768
    v_mfma_f32_16x16x32_bf16 v[128:131], a[164:167], a[120:123], v[128:131]
    ds_read_b64_tr_b16 a[186:187], v23 offset:36864
    v_accvgpr_write_b32 a40, 0
    v_mfma_f32_16x16x32_bf16 v[132:135], a[160:163], a[116:119], v[132:135]
    ds_read_b64_tr_b16 a[188:189], v23 offset:40960
    v_accvgpr_write_b32 a41, 0
    v_mfma_f32_16x16x32_bf16 v[132:135], a[164:167], a[124:127], v[132:135]
    s_waitcnt lgkmcnt(9)
    buffer_load_dwordx4 v39, s[8:11], s40 offen offset:3072 lds
    v_mfma_f32_16x16x32_bf16 v[136:139], a[168:171], a[112:115], v[136:139]
    s_waitcnt lgkmcnt(7)
    s_add_u32 s40, s40, 16384
    ds_read_b64_tr_b16 a[190:191], v23 offset:45056
    ds_read_b64_tr_b16 a[160:161], v24 offset:32768
    v_mfma_f32_16x16x32_bf16 v[136:139], a[172:175], a[120:123], v[136:139]
    ds_read_b64_tr_b16 a[162:163], v24 offset:36864
    v_accvgpr_write_b32 a42, 0
    v_mfma_f32_16x16x32_bf16 v[140:143], a[168:171], a[116:119], v[140:143]
    ds_read_b64_tr_b16 a[164:165], v24 offset:40960
    v_accvgpr_write_b32 a43, 0
    v_mfma_f32_16x16x32_bf16 v[140:143], a[172:175], a[124:127], v[140:143]
    s_waitcnt lgkmcnt(9)
    ds_read_b64_tr_b16 a[166:167], v24 offset:45056
    v_accvgpr_write_b32 a44, 0
    v_mfma_f32_16x16x32_bf16 v[144:147], a[176:179], a[112:115], v[144:147]
    s_waitcnt lgkmcnt(8)
    ds_read_b64_tr_b16 a[168:169], v25 offset:32768
    v_accvgpr_write_b32 a45, 0
    v_mfma_f32_16x16x32_bf16 v[144:147], a[180:183], a[120:123], v[144:147]
    ds_read_b64_tr_b16 a[170:171], v25 offset:36864
    v_accvgpr_write_b32 a46, 0
    v_mfma_f32_16x16x32_bf16 v[148:151], a[176:179], a[116:119], v[148:151]
    ds_read_b64_tr_b16 a[172:173], v25 offset:40960
    v_accvgpr_write_b32 a47, 0
    v_mfma_f32_16x16x32_bf16 v[148:151], a[180:183], a[124:127], v[148:151]
    s_waitcnt lgkmcnt(9)
    ds_read_b64_tr_b16 a[174:175], v25 offset:45056
    v_accvgpr_write_b32 a48, 0
    v_mfma_f32_16x16x32_bf16 v[152:155], a[184:187], a[112:115], v[152:155]
    s_waitcnt lgkmcnt(8)
    ds_read_b64_tr_b16 a[176:177], v26 offset:32768
    v_accvgpr_write_b32 a49, 0
    v_mfma_f32_16x16x32_bf16 v[152:155], a[188:191], a[120:123], v[152:155]
    ds_read_b64_tr_b16 a[178:179], v26 offset:36864
    v_accvgpr_write_b32 a50, 0
    v_mfma_f32_16x16x32_bf16 v[156:159], a[184:187], a[116:119], v[156:159]
    ds_read_b64_tr_b16 a[180:181], v26 offset:40960
    v_accvgpr_write_b32 a51, 0
    v_mfma_f32_16x16x32_bf16 v[156:159], a[188:191], a[124:127], v[156:159]
    s_waitcnt lgkmcnt(9)
    ds_read_b64_tr_b16 a[182:183], v26 offset:45056
    v_accvgpr_write_b32 a52, 0
    v_mfma_f32_16x16x32_bf16 v[160:163], a[160:163], a[112:115], v[160:163]
    s_waitcnt lgkmcnt(8)
    ds_read_b64_tr_b16 a[184:185], v27 offset:32768
    v_accvgpr_write_b32 a53, 0
    v_mfma_f32_16x16x32_bf16 v[160:163], a[164:167], a[120:123], v[160:163]
    ds_read_b64_tr_b16 a[186:187], v27 offset:36864
    v_accvgpr_write_b32 a54, 0
    v_mfma_f32_16x16x32_bf16 v[164:167], a[160:163], a[116:119], v[164:167]
    ds_read_b64_tr_b16 a[188:189], v27 offset:40960
    v_accvgpr_write_b32 a55, 0
    v_mfma_f32_16x16x32_bf16 v[164:167], a[164:167], a[124:127], v[164:167]
    s_waitcnt lgkmcnt(9)
    ds_read_b64_tr_b16 a[190:191], v27 offset:45056
    v_accvgpr_write_b32 a56, 0
    v_mfma_f32_16x16x32_bf16 v[168:171], a[168:171], a[112:115], v[168:171]
    s_waitcnt lgkmcnt(8)
    ds_read_b64_tr_b16 a[160:161], v20 offset:49152
    v_accvgpr_write_b32 a57, 0
    v_mfma_f32_16x16x32_bf16 v[168:171], a[172:175], a[120:123], v[168:171]
    ds_read_b64_tr_b16 a[162:163], v20 offset:53248
    v_accvgpr_write_b32 a58, 0
    v_mfma_f32_16x16x32_bf16 v[172:175], a[168:171], a[116:119], v[172:175]
    ds_read_b64_tr_b16 a[164:165], v20 offset:57344
    v_accvgpr_write_b32 a59, 0
    v_mfma_f32_16x16x32_bf16 v[172:175], a[172:175], a[124:127], v[172:175]
    s_waitcnt lgkmcnt(9)
    ds_read_b64_tr_b16 a[166:167], v20 offset:61440
    v_accvgpr_write_b32 a60, 0
    v_mfma_f32_16x16x32_bf16 v[176:179], a[176:179], a[112:115], v[176:179]
    s_waitcnt lgkmcnt(8)
    ds_read_b64_tr_b16 a[168:169], v21 offset:49152
    v_accvgpr_write_b32 a61, 0
    v_mfma_f32_16x16x32_bf16 v[176:179], a[180:183], a[120:123], v[176:179]
    ds_read_b64_tr_b16 a[170:171], v21 offset:53248
    v_accvgpr_write_b32 a62, 0
    v_mfma_f32_16x16x32_bf16 v[180:183], a[176:179], a[116:119], v[180:183]
    ds_read_b64_tr_b16 a[172:173], v21 offset:57344
    v_accvgpr_write_b32 a63, 0
    v_mfma_f32_16x16x32_bf16 v[180:183], a[180:183], a[124:127], v[180:183]
    s_waitcnt lgkmcnt(9)
    ds_read_b64_tr_b16 a[174:175], v21 offset:61440
    v_accvgpr_write_b32 a64, 0
    v_mfma_f32_16x16x32_bf16 v[184:187], a[184:187], a[112:115], v[184:187]
    s_waitcnt lgkmcnt(8)
    ds_read_b64_tr_b16 a[176:177], v22 offset:49152
    v_accvgpr_write_b32 a65, 0
    v_mfma_f32_16x16x32_bf16 v[184:187], a[188:191], a[120:123], v[184:187]
    ds_read_b64_tr_b16 a[178:179], v22 offset:53248
    v_accvgpr_write_b32 a66, 0
    v_mfma_f32_16x16x32_bf16 v[188:191], a[184:187], a[116:119], v[188:191]
    ds_read_b64_tr_b16 a[180:181], v22 offset:57344
    v_accvgpr_write_b32 a67, 0
    v_mfma_f32_16x16x32_bf16 v[188:191], a[188:191], a[124:127], v[188:191]
    s_waitcnt lgkmcnt(9)
    ds_read_b64_tr_b16 a[182:183], v22 offset:61440
    v_accvgpr_write_b32 a68, 0
    v_mfma_f32_16x16x32_bf16 v[192:195], a[160:163], a[112:115], v[192:195]
    s_waitcnt lgkmcnt(8)
    ds_read_b64_tr_b16 a[184:185], v23 offset:49152
    v_accvgpr_write_b32 a69, 0
    v_mfma_f32_16x16x32_bf16 v[192:195], a[164:167], a[120:123], v[192:195]
    ds_read_b64_tr_b16 a[186:187], v23 offset:53248
    v_accvgpr_write_b32 a70, 0
    v_mfma_f32_16x16x32_bf16 v[196:199], a[160:163], a[116:119], v[196:199]
    ds_read_b64_tr_b16 a[188:189], v23 offset:57344
    v_accvgpr_write_b32 a71, 0
    v_mfma_f32_16x16x32_bf16 v[196:199], a[164:167], a[124:127], v[196:199]
    s_waitcnt lgkmcnt(9)
    ds_read_b64_tr_b16 a[190:191], v23 offset:61440
    v_accvgpr_write_b32 a72, 0
    v_mfma_f32_16x16x32_bf16 v[200:203], a[168:171], a[112:115], v[200:203]
    s_waitcnt lgkmcnt(8)
    ds_read_b64_tr_b16 a[160:161], v24 offset:49152
    v_accvgpr_write_b32 a73, 0
    v_mfma_f32_16x16x32_bf16 v[200:203], a[172:175], a[120:123], v[200:203]
    ds_read_b64_tr_b16 a[162:163], v24 offset:53248
    v_accvgpr_write_b32 a74, 0
    v_mfma_f32_16x16x32_bf16 v[204:207], a[168:171], a[116:119], v[204:207]
    ds_read_b64_tr_b16 a[164:165], v24 offset:57344
    v_accvgpr_write_b32 a75, 0
    v_mfma_f32_16x16x32_bf16 v[204:207], a[172:175], a[124:127], v[204:207]
    s_waitcnt lgkmcnt(9)
    ds_read_b64_tr_b16 a[166:167], v24 offset:61440
    v_accvgpr_write_b32 a76, 0
    v_mfma_f32_16x16x32_bf16 v[208:211], a[176:179], a[112:115], v[208:211]
    s_waitcnt lgkmcnt(8)
    ds_read_b64_tr_b16 a[168:169], v25 offset:49152
    v_accvgpr_write_b32 a77, 0
    v_mfma_f32_16x16x32_bf16 v[208:211], a[180:183], a[120:123], v[208:211]
    ds_read_b64_tr_b16 a[170:171], v25 offset:53248
    v_accvgpr_write_b32 a78, 0
    v_mfma_f32_16x16x32_bf16 v[212:215], a[176:179], a[116:119], v[212:215]
    ds_read_b64_tr_b16 a[172:173], v25 offset:57344
    v_accvgpr_write_b32 a79, 0
    v_mfma_f32_16x16x32_bf16 v[212:215], a[180:183], a[124:127], v[212:215]
    s_waitcnt lgkmcnt(9)
    ds_read_b64_tr_b16 a[174:175], v25 offset:61440
    v_accvgpr_write_b32 a80, 0
    v_mfma_f32_16x16x32_bf16 v[216:219], a[184:187], a[112:115], v[216:219]
    s_waitcnt lgkmcnt(8)
    ds_read_b64_tr_b16 a[176:177], v26 offset:49152
    v_accvgpr_write_b32 a81, 0
    v_mfma_f32_16x16x32_bf16 v[216:219], a[188:191], a[120:123], v[216:219]
    ds_read_b64_tr_b16 a[178:179], v26 offset:53248
    v_accvgpr_write_b32 a82, 0
    v_mfma_f32_16x16x32_bf16 v[220:223], a[184:187], a[116:119], v[220:223]
    ds_read_b64_tr_b16 a[180:181], v26 offset:57344
    v_accvgpr_write_b32 a83, 0
    v_mfma_f32_16x16x32_bf16 v[220:223], a[188:191], a[124:127], v[220:223]
    s_waitcnt lgkmcnt(9)
    ds_read_b64_tr_b16 a[182:183], v26 offset:61440
    v_accvgpr_write_b32 a84, 0
    v_mfma_f32_16x16x32_bf16 v[224:227], a[160:163], a[112:115], v[224:227]
    s_waitcnt lgkmcnt(8)
    ds_read_b64_tr_b16 a[184:185], v27 offset:49152
    v_accvgpr_write_b32 a85, 0
    v_mfma_f32_16x16x32_bf16 v[224:227], a[164:167], a[120:123], v[224:227]
    ds_read_b64_tr_b16 a[186:187], v27 offset:53248
    v_accvgpr_write_b32 a86, 0
    v_mfma_f32_16x16x32_bf16 v[228:231], a[160:163], a[116:119], v[228:231]
    ds_read_b64_tr_b16 a[188:189], v27 offset:57344
    v_accvgpr_write_b32 a87, 0
    v_mfma_f32_16x16x32_bf16 v[228:231], a[164:167], a[124:127], v[228:231]
    s_waitcnt lgkmcnt(9)
    ds_read_b64_tr_b16 a[190:191], v27 offset:61440
    v_accvgpr_write_b32 a88, 0
    s_waitcnt vmcnt(12)
    s_barrier
    v_mfma_f32_16x16x32_bf16 v[232:235], a[168:171], a[112:115], v[232:235]
    s_waitcnt lgkmcnt(8)
    ds_read_b64_tr_b16 a[160:161], v28 offset:0
    v_accvgpr_write_b32 a89, 0
    v_mfma_f32_16x16x32_bf16 v[232:235], a[172:175], a[120:123], v[232:235]
    ds_read_b64_tr_b16 a[162:163], v28 offset:4096
    v_accvgpr_write_b32 a90, 0
    v_mfma_f32_16x16x32_bf16 v[236:239], a[168:171], a[116:119], v[236:239]
    s_add_u32 m0, s42, 65536
    ds_read_b64_tr_b16 a[164:165], v28 offset:8192
    v_accvgpr_write_b32 a91, 0
    v_mfma_f32_16x16x32_bf16 v[236:239], a[172:175], a[124:127], v[236:239]
    s_waitcnt lgkmcnt(9)
    buffer_load_dwordx4 v40, s[12:15], s41 offen lds
    v_mfma_f32_16x16x32_bf16 v[240:243], a[176:179], a[112:115], v[240:243]
    s_waitcnt lgkmcnt(7)
    ds_read_b64_tr_b16 a[166:167], v28 offset:12288
    ds_read_b64_tr_b16 a[168:169], v29 offset:0
    v_mfma_f32_16x16x32_bf16 v[240:243], a[180:183], a[120:123], v[240:243]
    ds_read_b64_tr_b16 a[170:171], v29 offset:4096
    v_accvgpr_write_b32 a92, 0
    v_mfma_f32_16x16x32_bf16 v[244:247], a[176:179], a[116:119], v[244:247]
    ds_read_b64_tr_b16 a[172:173], v29 offset:8192
    v_accvgpr_write_b32 a93, 0
    v_mfma_f32_16x16x32_bf16 v[244:247], a[180:183], a[124:127], v[244:247]
    s_waitcnt lgkmcnt(9)
    buffer_load_dwordx4 v41, s[12:15], s41 offen offset:1024 lds
    v_mfma_f32_16x16x32_bf16 v[248:251], a[184:187], a[112:115], v[248:251]
    s_waitcnt lgkmcnt(7)
    ds_read_b64_tr_b16 a[174:175], v29 offset:12288
    ds_read_b64_tr_b16 a[176:177], v30 offset:0
    v_mfma_f32_16x16x32_bf16 v[248:251], a[188:191], a[120:123], v[248:251]
    ds_read_b64_tr_b16 a[178:179], v30 offset:4096
    v_accvgpr_write_b32 a94, 0
    v_mfma_f32_16x16x32_bf16 v[252:255], a[184:187], a[116:119], v[252:255]
    ds_read_b64_tr_b16 a[180:181], v30 offset:8192
    v_accvgpr_write_b32 a95, 0
    v_mfma_f32_16x16x32_bf16 v[252:255], a[188:191], a[124:127], v[252:255]
    s_waitcnt lgkmcnt(9)
    buffer_load_dwordx4 v40, s[12:15], s41 offen offset:2048 lds
    v_mfma_f32_16x16x32_bf16 v[128:131], a[160:163], a[128:131], v[128:131]
    s_waitcnt lgkmcnt(7)
    ds_read_b64_tr_b16 a[182:183], v30 offset:12288
    ds_read_b64_tr_b16 a[184:185], v31 offset:0
    v_mfma_f32_16x16x32_bf16 v[128:131], a[164:167], a[136:139], v[128:131]
    ds_read_b64_tr_b16 a[186:187], v31 offset:4096
    v_accvgpr_write_b32 a96, 0
    v_mfma_f32_16x16x32_bf16 v[132:135], a[160:163], a[132:135], v[132:135]
    ds_read_b64_tr_b16 a[188:189], v31 offset:8192
    v_accvgpr_write_b32 a97, 0
    v_mfma_f32_16x16x32_bf16 v[132:135], a[164:167], a[140:143], v[132:135]
    s_waitcnt lgkmcnt(9)
    buffer_load_dwordx4 v41, s[12:15], s41 offen offset:3072 lds
    v_mfma_f32_16x16x32_bf16 v[136:139], a[168:171], a[128:131], v[136:139]
    s_waitcnt lgkmcnt(7)
    s_add_u32 s41, s41, 16384
    ds_read_b64_tr_b16 a[190:191], v31 offset:12288
    ds_read_b64_tr_b16 a[160:161], v32 offset:0
    v_mfma_f32_16x16x32_bf16 v[136:139], a[172:175], a[136:139], v[136:139]
    ds_read_b64_tr_b16 a[162:163], v32 offset:4096
    v_accvgpr_write_b32 a98, 0
    v_mfma_f32_16x16x32_bf16 v[140:143], a[168:171], a[132:135], v[140:143]
    s_add_u32 m0, s42, 81920
    ds_read_b64_tr_b16 a[164:165], v32 offset:8192
    v_accvgpr_write_b32 a99, 0
    v_mfma_f32_16x16x32_bf16 v[140:143], a[172:175], a[140:143], v[140:143]
    s_waitcnt lgkmcnt(9)
    buffer_load_dwordx4 v40, s[12:15], s41 offen lds
    v_mfma_f32_16x16x32_bf16 v[144:147], a[176:179], a[128:131], v[144:147]
    s_waitcnt lgkmcnt(7)
    ds_read_b64_tr_b16 a[166:167], v32 offset:12288
    ds_read_b64_tr_b16 a[168:169], v33 offset:0
    v_mfma_f32_16x16x32_bf16 v[144:147], a[180:183], a[136:139], v[144:147]
    ds_read_b64_tr_b16 a[170:171], v33 offset:4096
    v_accvgpr_write_b32 a100, 0
    v_mfma_f32_16x16x32_bf16 v[148:151], a[176:179], a[132:135], v[148:151]
    ds_read_b64_tr_b16 a[172:173], v33 offset:8192
    v_accvgpr_write_b32 a101, 0
    v_mfma_f32_16x16x32_bf16 v[148:151], a[180:183], a[140:143], v[148:151]
    s_waitcnt lgkmcnt(9)
    buffer_load_dwordx4 v41, s[12:15], s41 offen offset:1024 lds
    v_mfma_f32_16x16x32_bf16 v[152:155], a[184:187], a[128:131], v[152:155]
    s_waitcnt lgkmcnt(7)
    ds_read_b64_tr_b16 a[174:175], v33 offset:12288
    ds_read_b64_tr_b16 a[176:177], v34 offset:0
    v_mfma_f32_16x16x32_bf16 v[152:155], a[188:191], a[136:139], v[152:155]
    ds_read_b64_tr_b16 a[178:179], v34 offset:4096
    v_accvgpr_write_b32 a102, 0
    v_mfma_f32_16x16x32_bf16 v[156:159], a[184:187], a[132:135], v[156:159]
    ds_read_b64_tr_b16 a[180:181], v34 offset:8192
    v_accvgpr_write_b32 a103, 0
    v_mfma_f32_16x16x32_bf16 v[156:159], a[188:191], a[140:143], v[156:159]
    s_waitcnt lgkmcnt(9)
    buffer_load_dwordx4 v40, s[12:15], s41 offen offset:2048 lds
    v_mfma_f32_16x16x32_bf16 v[160:163], a[160:163], a[128:131], v[160:163]
    s_waitcnt lgkmcnt(7)
    ds_read_b64_tr_b16 a[182:183], v34 offset:12288
    ds_read_b64_tr_b16 a[184:185], v35 offset:0
    v_mfma_f32_16x16x32_bf16 v[160:163], a[164:167], a[136:139], v[160:163]
    ds_read_b64_tr_b16 a[186:187], v35 offset:4096
    v_accvgpr_write_b32 a104, 0
    v_mfma_f32_16x16x32_bf16 v[164:167], a[160:163], a[132:135], v[164:167]
    ds_read_b64_tr_b16 a[188:189], v35 offset:8192
    v_accvgpr_write_b32 a105, 0
    v_mfma_f32_16x16x32_bf16 v[164:167], a[164:167], a[140:143], v[164:167]
    s_waitcnt lgkmcnt(9)
    buffer_load_dwordx4 v41, s[12:15], s41 offen offset:3072 lds
    v_mfma_f32_16x16x32_bf16 v[168:171], a[168:171], a[128:131], v[168:171]
    s_waitcnt lgkmcnt(7)
    s_add_u32 s41, s41, 16384
    ds_read_b64_tr_b16 a[190:191], v35 offset:12288
    ds_read_b64_tr_b16 a[160:161], v28 offset:16384
    v_mfma_f32_16x16x32_bf16 v[168:171], a[172:175], a[136:139], v[168:171]
    ds_read_b64_tr_b16 a[162:163], v28 offset:20480
    v_accvgpr_write_b32 a106, 0
    v_mfma_f32_16x16x32_bf16 v[172:175], a[168:171], a[132:135], v[172:175]
    ds_read_b64_tr_b16 a[164:165], v28 offset:24576
    v_accvgpr_write_b32 a107, 0
    v_mfma_f32_16x16x32_bf16 v[172:175], a[172:175], a[140:143], v[172:175]
    s_waitcnt lgkmcnt(9)
    ds_read_b64_tr_b16 a[166:167], v28 offset:28672
    v_accvgpr_write_b32 a108, 0
    v_mfma_f32_16x16x32_bf16 v[176:179], a[176:179], a[128:131], v[176:179]
    s_waitcnt lgkmcnt(8)
    ds_read_b64_tr_b16 a[168:169], v29 offset:16384
    v_accvgpr_write_b32 a109, 0
    v_mfma_f32_16x16x32_bf16 v[176:179], a[180:183], a[136:139], v[176:179]
    ds_read_b64_tr_b16 a[170:171], v29 offset:20480
    v_accvgpr_write_b32 a110, 0
    v_mfma_f32_16x16x32_bf16 v[180:183], a[176:179], a[132:135], v[180:183]
    ds_read_b64_tr_b16 a[172:173], v29 offset:24576
    v_accvgpr_write_b32 a111, 0
    v_mfma_f32_16x16x32_bf16 v[180:183], a[180:183], a[140:143], v[180:183]
    s_waitcnt lgkmcnt(9)
    ds_read_b64_tr_b16 a[174:175], v29 offset:28672
    v_accvgpr_write_b32 a192, 0
    v_mfma_f32_16x16x32_bf16 v[184:187], a[184:187], a[128:131], v[184:187]
    s_waitcnt lgkmcnt(8)
    ds_read_b64_tr_b16 a[176:177], v30 offset:16384
    v_accvgpr_write_b32 a193, 0
    v_mfma_f32_16x16x32_bf16 v[184:187], a[188:191], a[136:139], v[184:187]
    ds_read_b64_tr_b16 a[178:179], v30 offset:20480
    v_accvgpr_write_b32 a194, 0
    v_mfma_f32_16x16x32_bf16 v[188:191], a[184:187], a[132:135], v[188:191]
    ds_read_b64_tr_b16 a[180:181], v30 offset:24576
    v_accvgpr_write_b32 a195, 0
    v_mfma_f32_16x16x32_bf16 v[188:191], a[188:191], a[140:143], v[188:191]
    s_waitcnt lgkmcnt(9)
    ds_read_b64_tr_b16 a[182:183], v30 offset:28672
    v_accvgpr_write_b32 a196, 0
    v_mfma_f32_16x16x32_bf16 v[192:195], a[160:163], a[128:131], v[192:195]
    s_waitcnt lgkmcnt(8)
    ds_read_b64_tr_b16 a[184:185], v31 offset:16384
    v_accvgpr_write_b32 a197, 0
    v_mfma_f32_16x16x32_bf16 v[192:195], a[164:167], a[136:139], v[192:195]
    ds_read_b64_tr_b16 a[186:187], v31 offset:20480
    v_accvgpr_write_b32 a198, 0
    v_mfma_f32_16x16x32_bf16 v[196:199], a[160:163], a[132:135], v[196:199]
    ds_read_b64_tr_b16 a[188:189], v31 offset:24576
    v_accvgpr_write_b32 a199, 0
    v_mfma_f32_16x16x32_bf16 v[196:199], a[164:167], a[140:143], v[196:199]
    s_waitcnt lgkmcnt(9)
    ds_read_b64_tr_b16 a[190:191], v31 offset:28672
    v_accvgpr_write_b32 a200, 0
    v_mfma_f32_16x16x32_bf16 v[200:203], a[168:171], a[128:131], v[200:203]
    s_waitcnt lgkmcnt(8)
    ds_read_b64_tr_b16 a[160:161], v32 offset:16384
    v_accvgpr_write_b32 a201, 0
    v_mfma_f32_16x16x32_bf16 v[200:203], a[172:175], a[136:139], v[200:203]
    ds_read_b64_tr_b16 a[162:163], v32 offset:20480
    v_accvgpr_write_b32 a202, 0
    v_mfma_f32_16x16x32_bf16 v[204:207], a[168:171], a[132:135], v[204:207]
    ds_read_b64_tr_b16 a[164:165], v32 offset:24576
    v_accvgpr_write_b32 a203, 0
    v_mfma_f32_16x16x32_bf16 v[204:207], a[172:175], a[140:143], v[204:207]
    s_waitcnt lgkmcnt(9)
    ds_read_b64_tr_b16 a[166:167], v32 offset:28672
    v_accvgpr_write_b32 a204, 0
    v_mfma_f32_16x16x32_bf16 v[208:211], a[176:179], a[128:131], v[208:211]
    s_waitcnt lgkmcnt(8)
    ds_read_b64_tr_b16 a[168:169], v33 offset:16384
    v_accvgpr_write_b32 a205, 0
    v_mfma_f32_16x16x32_bf16 v[208:211], a[180:183], a[136:139], v[208:211]
    ds_read_b64_tr_b16 a[170:171], v33 offset:20480
    v_accvgpr_write_b32 a206, 0
    v_mfma_f32_16x16x32_bf16 v[212:215], a[176:179], a[132:135], v[212:215]
    ds_read_b64_tr_b16 a[172:173], v33 offset:24576
    v_accvgpr_write_b32 a207, 0
    v_mfma_f32_16x16x32_bf16 v[212:215], a[180:183], a[140:143], v[212:215]
    s_waitcnt lgkmcnt(9)
    ds_read_b64_tr_b16 a[174:175], v33 offset:28672
    v_accvgpr_write_b32 a112, 0
    v_mfma_f32_16x16x32_bf16 v[216:219], a[184:187], a[128:131], v[216:219]
    s_waitcnt lgkmcnt(8)
    ds_read_b64_tr_b16 a[176:177], v34 offset:16384
    v_accvgpr_write_b32 a113, 0
    v_mfma_f32_16x16x32_bf16 v[216:219], a[188:191], a[136:139], v[216:219]
    ds_read_b64_tr_b16 a[178:179], v34 offset:20480
    v_accvgpr_write_b32 a114, 0
    v_mfma_f32_16x16x32_bf16 v[220:223], a[184:187], a[132:135], v[220:223]
    ds_read_b64_tr_b16 a[180:181], v34 offset:24576
    v_accvgpr_write_b32 a115, 0
    v_mfma_f32_16x16x32_bf16 v[220:223], a[188:191], a[140:143], v[220:223]
    s_waitcnt lgkmcnt(9)
    ds_read_b64_tr_b16 a[182:183], v34 offset:28672
    v_accvgpr_write_b32 a116, 0
    v_mfma_f32_16x16x32_bf16 v[224:227], a[160:163], a[128:131], v[224:227]
    s_waitcnt lgkmcnt(8)
    ds_read_b64_tr_b16 a[184:185], v35 offset:16384
    v_accvgpr_write_b32 a117, 0
    v_mfma_f32_16x16x32_bf16 v[224:227], a[164:167], a[136:139], v[224:227]
    ds_read_b64_tr_b16 a[186:187], v35 offset:20480
    v_accvgpr_write_b32 a118, 0
    v_mfma_f32_16x16x32_bf16 v[228:231], a[160:163], a[132:135], v[228:231]
    ds_read_b64_tr_b16 a[188:189], v35 offset:24576
    v_accvgpr_write_b32 a119, 0
    v_mfma_f32_16x16x32_bf16 v[228:231], a[164:167], a[140:143], v[228:231]
    s_waitcnt lgkmcnt(9)
    ds_read_b64_tr_b16 a[190:191], v35 offset:28672
    v_accvgpr_write_b32 a120, 0
    v_mfma_f32_16x16x32_bf16 v[232:235], a[168:171], a[128:131], v[232:235]
    s_waitcnt lgkmcnt(8)
    v_accvgpr_write_b32 a121, 0
    v_mfma_f32_16x16x32_bf16 v[232:235], a[172:175], a[136:139], v[232:235]
    v_accvgpr_write_b32 a122, 0
    v_mfma_f32_16x16x32_bf16 v[236:239], a[168:171], a[132:135], v[236:239]
    v_accvgpr_write_b32 a123, 0
    v_mfma_f32_16x16x32_bf16 v[236:239], a[172:175], a[140:143], v[236:239]
    s_waitcnt lgkmcnt(6)
    v_accvgpr_write_b32 a124, 0
    s_waitcnt vmcnt(16)
    s_barrier
    v_mfma_f32_16x16x32_bf16 v[240:243], a[176:179], a[128:131], v[240:243]
    s_waitcnt lgkmcnt(4)
    ds_read_b128 a[208:211], v8 offset:0
    v_accvgpr_write_b32 a125, 0
    v_mfma_f32_16x16x32_bf16 v[240:243], a[180:183], a[136:139], v[240:243]
    ds_read_b128 a[212:215], v9 offset:0
    v_accvgpr_write_b32 a126, 0
    v_mfma_f32_16x16x32_bf16 v[244:247], a[176:179], a[132:135], v[244:247]
    ds_read_b128 a[216:219], v10 offset:0
    v_accvgpr_write_b32 a127, 0
    v_mfma_f32_16x16x32_bf16 v[244:247], a[180:183], a[140:143], v[244:247]
    s_waitcnt lgkmcnt(5)
    ds_read_b128 a[220:223], v11 offset:0
    v_mfma_f32_16x16x32_bf16 v[248:251], a[184:187], a[128:131], v[248:251]
    s_waitcnt lgkmcnt(4)
    ds_read_b128 a[224:227], v8 offset:4096
    v_mfma_f32_16x16x32_bf16 v[248:251], a[188:191], a[136:139], v[248:251]
    v_mfma_f32_16x16x32_bf16 v[252:255], a[184:187], a[132:135], v[252:255]
    v_mfma_f32_16x16x32_bf16 v[252:255], a[188:191], a[140:143], v[252:255]
    s_waitcnt lgkmcnt(4)
    s_mov_b32 s36, 1040356334
    s_mov_b32 s37, 1040356334
    v_pk_mul_f32 v[128:129], v[128:129], s[36:37]
    v_pk_mul_f32 v[130:131], v[130:131], s[36:37]
    v_pk_mul_f32 v[136:137], v[136:137], s[36:37]
    v_pk_mul_f32 v[138:139], v[138:139], s[36:37]
    v_cvt_pk_bf16_f32 v64, v128, v129
    v_cvt_pk_bf16_f32 v65, v130, v131
    v_cvt_pk_bf16_f32 v66, v136, v137
    v_cvt_pk_bf16_f32 v67, v138, v139
    v_pk_mul_f32 v[132:133], v[132:133], s[36:37]
    v_pk_mul_f32 v[134:135], v[134:135], s[36:37]
    v_pk_mul_f32 v[140:141], v[140:141], s[36:37]
    v_pk_mul_f32 v[142:143], v[142:143], s[36:37]
    v_cvt_pk_bf16_f32 v80, v132, v133
    v_cvt_pk_bf16_f32 v81, v134, v135
    v_cvt_pk_bf16_f32 v82, v140, v141
    v_cvt_pk_bf16_f32 v83, v142, v143
    v_permlane32_swap_b32 v64, v66
    v_permlane32_swap_b32 v65, v67
    v_permlane32_swap_b32 v80, v82
    v_permlane32_swap_b32 v81, v83
    v_permlane16_swap_b32 v64, v66
    v_permlane16_swap_b32 v65, v67
    v_permlane16_swap_b32 v80, v82
    v_permlane16_swap_b32 v81, v83
    v_pk_mul_f32 v[144:145], v[144:145], s[36:37]
    v_pk_mul_f32 v[146:147], v[146:147], s[36:37]
    v_pk_mul_f32 v[152:153], v[152:153], s[36:37]
    v_pk_mul_f32 v[154:155], v[154:155], s[36:37]
    v_cvt_pk_bf16_f32 v68, v144, v145
    v_cvt_pk_bf16_f32 v69, v146, v147
    v_cvt_pk_bf16_f32 v70, v152, v153
    v_cvt_pk_bf16_f32 v71, v154, v155
    v_pk_mul_f32 v[148:149], v[148:149], s[36:37]
    v_pk_mul_f32 v[150:151], v[150:151], s[36:37]
    v_pk_mul_f32 v[156:157], v[156:157], s[36:37]
    v_pk_mul_f32 v[158:159], v[158:159], s[36:37]
    v_cvt_pk_bf16_f32 v84, v148, v149
    v_cvt_pk_bf16_f32 v85, v150, v151
    v_cvt_pk_bf16_f32 v86, v156, v157
    v_cvt_pk_bf16_f32 v87, v158, v159
    v_permlane32_swap_b32 v68, v70
    v_permlane32_swap_b32 v69, v71
    v_permlane32_swap_b32 v84, v86
    v_permlane32_swap_b32 v85, v87
    v_permlane16_swap_b32 v68, v70
    v_permlane16_swap_b32 v69, v71
    v_permlane16_swap_b32 v84, v86
    v_permlane16_swap_b32 v85, v87
    v_pk_mul_f32 v[160:161], v[160:161], s[36:37]
    v_pk_mul_f32 v[162:163], v[162:163], s[36:37]
    v_pk_mul_f32 v[168:169], v[168:169], s[36:37]
    v_pk_mul_f32 v[170:171], v[170:171], s[36:37]
    v_cvt_pk_bf16_f32 v72, v160, v161
    v_cvt_pk_bf16_f32 v73, v162, v163
    v_cvt_pk_bf16_f32 v74, v168, v169
    v_cvt_pk_bf16_f32 v75, v170, v171
    v_pk_mul_f32 v[164:165], v[164:165], s[36:37]
    v_pk_mul_f32 v[166:167], v[166:167], s[36:37]
    v_pk_mul_f32 v[172:173], v[172:173], s[36:37]
    v_pk_mul_f32 v[174:175], v[174:175], s[36:37]
    v_cvt_pk_bf16_f32 v88, v164, v165
    v_cvt_pk_bf16_f32 v89, v166, v167
    v_cvt_pk_bf16_f32 v90, v172, v173
    v_cvt_pk_bf16_f32 v91, v174, v175
    v_permlane32_swap_b32 v72, v74
    v_permlane32_swap_b32 v73, v75
    v_permlane32_swap_b32 v88, v90
    v_permlane32_swap_b32 v89, v91
    v_permlane16_swap_b32 v72, v74
    v_permlane16_swap_b32 v73, v75
    v_permlane16_swap_b32 v88, v90
    v_permlane16_swap_b32 v89, v91
    v_pk_mul_f32 v[176:177], v[176:177], s[36:37]
    v_pk_mul_f32 v[178:179], v[178:179], s[36:37]
    v_pk_mul_f32 v[184:185], v[184:185], s[36:37]
    v_pk_mul_f32 v[186:187], v[186:187], s[36:37]
    v_cvt_pk_bf16_f32 v76, v176, v177
    v_cvt_pk_bf16_f32 v77, v178, v179
    v_cvt_pk_bf16_f32 v78, v184, v185
    v_cvt_pk_bf16_f32 v79, v186, v187
    v_pk_mul_f32 v[180:181], v[180:181], s[36:37]
    v_pk_mul_f32 v[182:183], v[182:183], s[36:37]
    v_pk_mul_f32 v[188:189], v[188:189], s[36:37]
    v_pk_mul_f32 v[190:191], v[190:191], s[36:37]
    v_cvt_pk_bf16_f32 v92, v180, v181
    v_cvt_pk_bf16_f32 v93, v182, v183
    v_cvt_pk_bf16_f32 v94, v188, v189
    v_cvt_pk_bf16_f32 v95, v190, v191
    v_permlane32_swap_b32 v76, v78
    v_permlane32_swap_b32 v77, v79
    v_permlane32_swap_b32 v92, v94
    v_permlane32_swap_b32 v93, v95
    v_permlane16_swap_b32 v76, v78
    v_permlane16_swap_b32 v77, v79
    v_permlane16_swap_b32 v92, v94
    v_permlane16_swap_b32 v93, v95
    v_pk_mul_f32 v[192:193], v[192:193], s[36:37]
    v_pk_mul_f32 v[194:195], v[194:195], s[36:37]
    v_pk_mul_f32 v[200:201], v[200:201], s[36:37]
    v_pk_mul_f32 v[202:203], v[202:203], s[36:37]
    v_cvt_pk_bf16_f32 v96, v192, v193
    v_cvt_pk_bf16_f32 v97, v194, v195
    v_cvt_pk_bf16_f32 v98, v200, v201
    v_cvt_pk_bf16_f32 v99, v202, v203
    v_pk_mul_f32 v[196:197], v[196:197], s[36:37]
    v_pk_mul_f32 v[198:199], v[198:199], s[36:37]
    v_pk_mul_f32 v[204:205], v[204:205], s[36:37]
    v_pk_mul_f32 v[206:207], v[206:207], s[36:37]
    v_cvt_pk_bf16_f32 v112, v196, v197
    v_cvt_pk_bf16_f32 v113, v198, v199
    v_cvt_pk_bf16_f32 v114, v204, v205
    v_cvt_pk_bf16_f32 v115, v206, v207
    v_permlane32_swap_b32 v96, v98
    v_permlane32_swap_b32 v97, v99
    v_permlane32_swap_b32 v112, v114
    v_permlane32_swap_b32 v113, v115
    v_permlane16_swap_b32 v96, v98
    v_permlane16_swap_b32 v97, v99
    v_permlane16_swap_b32 v112, v114
    v_permlane16_swap_b32 v113, v115
    v_pk_mul_f32 v[208:209], v[208:209], s[36:37]
    v_pk_mul_f32 v[210:211], v[210:211], s[36:37]
    v_pk_mul_f32 v[216:217], v[216:217], s[36:37]
    v_pk_mul_f32 v[218:219], v[218:219], s[36:37]
    v_cvt_pk_bf16_f32 v100, v208, v209
    v_cvt_pk_bf16_f32 v101, v210, v211
    v_cvt_pk_bf16_f32 v102, v216, v217
    v_cvt_pk_bf16_f32 v103, v218, v219
    v_pk_mul_f32 v[212:213], v[212:213], s[36:37]
    v_pk_mul_f32 v[214:215], v[214:215], s[36:37]
    v_pk_mul_f32 v[220:221], v[220:221], s[36:37]
    v_pk_mul_f32 v[222:223], v[222:223], s[36:37]
    v_cvt_pk_bf16_f32 v116, v212, v213
    v_cvt_pk_bf16_f32 v117, v214, v215
    v_cvt_pk_bf16_f32 v118, v220, v221
    v_cvt_pk_bf16_f32 v119, v222, v223
    v_permlane32_swap_b32 v100, v102
    v_permlane32_swap_b32 v101, v103
    v_permlane32_swap_b32 v116, v118
    v_permlane32_swap_b32 v117, v119
    v_permlane16_swap_b32 v100, v102
    v_permlane16_swap_b32 v101, v103
    v_permlane16_swap_b32 v116, v118
    v_permlane16_swap_b32 v117, v119
    v_pk_mul_f32 v[224:225], v[224:225], s[36:37]
    v_pk_mul_f32 v[226:227], v[226:227], s[36:37]
    v_pk_mul_f32 v[232:233], v[232:233], s[36:37]
    v_pk_mul_f32 v[234:235], v[234:235], s[36:37]
    v_cvt_pk_bf16_f32 v104, v224, v225
    v_cvt_pk_bf16_f32 v105, v226, v227
    v_cvt_pk_bf16_f32 v106, v232, v233
    v_cvt_pk_bf16_f32 v107, v234, v235
    v_pk_mul_f32 v[228:229], v[228:229], s[36:37]
    v_pk_mul_f32 v[230:231], v[230:231], s[36:37]
    v_pk_mul_f32 v[236:237], v[236:237], s[36:37]
    v_pk_mul_f32 v[238:239], v[238:239], s[36:37]
    v_cvt_pk_bf16_f32 v120, v228, v229
    v_cvt_pk_bf16_f32 v121, v230, v231
    v_cvt_pk_bf16_f32 v122, v236, v237
    v_cvt_pk_bf16_f32 v123, v238, v239
    v_permlane32_swap_b32 v104, v106
    v_permlane32_swap_b32 v105, v107
    v_permlane32_swap_b32 v120, v122
    v_permlane32_swap_b32 v121, v123
    v_permlane16_swap_b32 v104, v106
    v_permlane16_swap_b32 v105, v107
    v_permlane16_swap_b32 v120, v122
    v_permlane16_swap_b32 v121, v123
    v_pk_mul_f32 v[240:241], v[240:241], s[36:37]
    v_pk_mul_f32 v[242:243], v[242:243], s[36:37]
    v_pk_mul_f32 v[248:249], v[248:249], s[36:37]
    v_pk_mul_f32 v[250:251], v[250:251], s[36:37]
    v_cvt_pk_bf16_f32 v108, v240, v241
    v_cvt_pk_bf16_f32 v109, v242, v243
    v_cvt_pk_bf16_f32 v110, v248, v249
    v_cvt_pk_bf16_f32 v111, v250, v251
    v_pk_mul_f32 v[244:245], v[244:245], s[36:37]
    v_pk_mul_f32 v[246:247], v[246:247], s[36:37]
    v_pk_mul_f32 v[252:253], v[252:253], s[36:37]
    v_pk_mul_f32 v[254:255], v[254:255], s[36:37]
    v_cvt_pk_bf16_f32 v124, v244, v245
    v_cvt_pk_bf16_f32 v125, v246, v247
    v_cvt_pk_bf16_f32 v126, v252, v253
    v_cvt_pk_bf16_f32 v127, v254, v255
    v_permlane32_swap_b32 v108, v110
    v_permlane32_swap_b32 v109, v111
    v_permlane32_swap_b32 v124, v126
    v_permlane32_swap_b32 v125, v127
    v_permlane16_swap_b32 v108, v110
    v_permlane16_swap_b32 v109, v111
    v_permlane16_swap_b32 v124, v126
    v_permlane16_swap_b32 v125, v127
    v_mfma_f32_16x16x32_bf16 v[216:219], a[208:211], v[64:67], 0
    s_waitcnt lgkmcnt(3)
    v_mfma_f32_16x16x32_bf16 v[216:219], a[212:215], v[68:71], v[216:219]
    s_waitcnt lgkmcnt(2)
    v_mfma_f32_16x16x32_bf16 v[216:219], a[216:219], v[72:75], v[216:219]
    s_waitcnt lgkmcnt(1)
    v_mfma_f32_16x16x32_bf16 v[216:219], a[220:223], v[76:79], v[216:219]
    v_mfma_f32_16x16x32_bf16 v[220:223], a[208:211], v[80:83], 0
    v_mfma_f32_16x16x32_bf16 v[220:223], a[212:215], v[84:87], v[220:223]
    v_mfma_f32_16x16x32_bf16 v[220:223], a[216:219], v[88:91], v[220:223]
    v_mfma_f32_16x16x32_bf16 v[220:223], a[220:223], v[92:95], v[220:223]
    v_mfma_f32_16x16x32_bf16 v[224:227], a[208:211], v[96:99], 0
    v_mfma_f32_16x16x32_bf16 v[224:227], a[212:215], v[100:103], v[224:227]
    v_mfma_f32_16x16x32_bf16 v[224:227], a[216:219], v[104:107], v[224:227]
    v_mfma_f32_16x16x32_bf16 v[224:227], a[220:223], v[108:111], v[224:227]
    v_mfma_f32_16x16x32_bf16 v[228:231], a[208:211], v[112:115], 0
    v_mfma_f32_16x16x32_bf16 v[228:231], a[212:215], v[116:119], v[228:231]
    v_mfma_f32_16x16x32_bf16 v[228:231], a[216:219], v[120:123], v[228:231]
    v_mfma_f32_16x16x32_bf16 v[228:231], a[220:223], v[124:127], v[228:231]
    v_max3_f32 v232, v216, v217, v218
    v_max_f32 v232, v232, v219
    v_max3_f32 v233, v220, v221, v222
    v_max_f32 v233, v233, v223
    v_max3_f32 v234, v224, v225, v226
    v_max_f32 v234, v234, v227
    s_nop 1
    v_max3_f32 v235, v228, v229, v230
    v_max_f32 v235, v235, v231
    v_mov_b32 v236, v232
    v_mov_b32 v237, v233
    v_mov_b32 v238, v234
    v_mov_b32 v239, v235
    v_permlane16_swap_b32 v232, v236
    v_permlane16_swap_b32 v233, v237
    v_permlane16_swap_b32 v234, v238
    v_permlane16_swap_b32 v235, v239
    v_max_f32 v232, v232, v236
    v_max_f32 v233, v233, v237
    v_max_f32 v234, v234, v238
    v_max_f32 v235, v235, v239
    v_mov_b32 v236, v232
    v_mov_b32 v237, v233
    v_mov_b32 v238, v234
    v_mov_b32 v239, v235
    v_permlane32_swap_b32 v232, v236
    v_permlane32_swap_b32 v233, v237
    v_permlane32_swap_b32 v234, v238
    v_permlane32_swap_b32 v235, v239
    v_max_f32 v232, v232, v236
    v_max_f32 v233, v233, v237
    v_max_f32 v234, v234, v238
    v_max_f32 v235, v235, v239
    v_sub_f32 v192, 3250585600, v232
    v_sub_f32 v193, 3250585600, v232
    v_sub_f32 v194, 3250585600, v232
    v_sub_f32 v195, 3250585600, v232
    v_sub_f32 v196, 3250585600, v233
    v_sub_f32 v197, 3250585600, v233
    v_sub_f32 v198, 3250585600, v233
    v_sub_f32 v199, 3250585600, v233
    v_sub_f32 v200, 3250585600, v234
    v_sub_f32 v201, 3250585600, v234
    v_sub_f32 v202, 3250585600, v234
    v_sub_f32 v203, 3250585600, v234
    v_sub_f32 v204, 3250585600, v235
    v_sub_f32 v205, 3250585600, v235
    v_sub_f32 v206, 3250585600, v235
    v_sub_f32 v207, 3250585600, v235
Lattn_stage0:
    s_mov_b32 s43, 7
    v_mfma_f32_16x16x32_bf16 v[208:211], a[208:211], v[64:67], v[192:195]
    s_lshr_b32 s6, s2, 3
    v_mfma_f32_16x16x32_bf16 v[208:211], a[212:215], v[68:71], v[208:211]
    s_and_b32 s7, s2, 7
    v_mfma_f32_16x16x32_bf16 v[208:211], a[216:219], v[72:75], v[208:211]
    s_mul_i32 s7, s7, 18
    v_mfma_f32_16x16x32_bf16 v[208:211], a[220:223], v[76:79], v[208:211]
    ds_read_b128 a[228:231], v9 offset:4096
    v_mfma_f32_16x16x32_bf16 v[212:215], a[208:211], v[80:83], v[196:199]
    s_add_u32 s7, s7, s6
    s_nop 4
    v_exp_f32 v208, v208
    v_mfma_f32_16x16x32_bf16 v[212:215], a[212:215], v[84:87], v[212:215]
    s_lshl_b32 s58, s7, 6
    v_exp_f32 v209, v209
    v_mfma_f32_16x16x32_bf16 v[212:215], a[216:219], v[88:91], v[212:215]
    s_mul_i32 s59, s7, 36864
    v_exp_f32 v210, v210
    v_mfma_f32_16x16x32_bf16 v[212:215], a[220:223], v[92:95], v[212:215]
    v_exp_f32 v211, v211
    v_cvt_pk_bf16_f32 v128, v208, v209
    ds_read_b128 a[232:235], v10 offset:4096
    v_cvt_pk_bf16_f32 v129, v210, v211
    v_mfma_f32_16x16x32_bf16 v[208:211], a[208:211], v[96:99], v[200:203]
    s_cmp_lt_u32 s6, 18
    s_cselect_b32 s7, 0, 2147483648
    s_nop 0
    v_exp_f32 v212, v212
    v_mfma_f32_16x16x32_bf16 v[208:211], a[212:215], v[100:103], v[208:211]
    s_or_b32 s58, s58, s7
    v_exp_f32 v213, v213
    v_mfma_f32_16x16x32_bf16 v[208:211], a[216:219], v[104:107], v[208:211]
    s_mul_i32 s37, s5, 18432
    s_or_b32 s59, s59, s7
    v_exp_f32 v214, v214
    v_mfma_f32_16x16x32_bf16 v[208:211], a[220:223], v[108:111], v[208:211]
    s_add_u32 s37, s37, s45
    v_exp_f32 v215, v215
    v_cvt_pk_bf16_f32 v136, v212, v213
    v_min_u32 v236, 143, v0
    v_lshlrev_b32 v236, 7, v236
    ds_read_b128 a[236:239], v11 offset:4096
    v_cvt_pk_bf16_f32 v137, v214, v215
    v_mfma_f32_16x16x32_bf16 v[212:215], a[208:211], v[112:115], v[204:207]
    s_and_b32 s7, s4, 1
    v_exp_f32 v208, v208
    v_mfma_f32_16x16x32_bf16 v[212:215], a[212:215], v[116:119], v[212:215]
    s_lshl_b32 s6, s7, 7
    v_exp_f32 v209, v209
    v_mfma_f32_16x16x32_bf16 v[212:215], a[216:219], v[120:123], v[212:215]
    s_xor_b32 s36, s4, 1
    v_exp_f32 v210, v210
    v_mfma_f32_16x16x32_bf16 v[212:215], a[220:223], v[124:127], v[212:215]
    s_waitcnt lgkmcnt(3)
    v_exp_f32 v211, v211
    v_cvt_pk_bf16_f32 v144, v208, v209
    ds_read_b128 a[208:211], v8 offset:8192
    v_cvt_pk_bf16_f32 v145, v210, v211
    buffer_load_dword v221, v236, s[20:23], s37 offen
    v_mfma_f32_16x16x32_bf16 v[208:211], a[224:227], v[64:67], v[192:195]
    s_waitcnt lgkmcnt(3)
    s_mul_i32 s36, s36, 294912
    v_exp_f32 v212, v212
    v_mfma_f32_16x16x32_bf16 v[208:211], a[228:231], v[68:71], v[208:211]
    s_waitcnt lgkmcnt(2)
    s_add_u32 s46, s36, s6
    v_exp_f32 v213, v213
    v_mfma_f32_16x16x32_bf16 v[208:211], a[232:235], v[72:75], v[208:211]
    s_waitcnt lgkmcnt(1)
    s_lshl_b32 s36, s4, 8
    v_exp_f32 v214, v214
    v_mfma_f32_16x16x32_bf16 v[208:211], a[236:239], v[76:79], v[208:211]
    v_exp_f32 v215, v215
    v_cvt_pk_bf16_f32 v152, v212, v213
    ds_read_b128 a[212:215], v9 offset:8192
    v_cvt_pk_bf16_f32 v153, v214, v215
    v_mfma_f32_16x16x32_bf16 v[212:215], a[224:227], v[80:83], v[196:199]
    s_add_u32 s56, s47, s36
    s_nop 1
    v_exp_f32 v208, v208
    v_mfma_f32_16x16x32_bf16 v[212:215], a[228:231], v[84:87], v[212:215]
    s_lshr_b32 s36, s4, 1
    v_exp_f32 v209, v209
    v_mfma_f32_16x16x32_bf16 v[212:215], a[232:235], v[88:91], v[212:215]
    s_lshl_b32 s36, s36, 11
    v_exp_f32 v210, v210
    v_mfma_f32_16x16x32_bf16 v[212:215], a[236:239], v[92:95], v[212:215]
    v_exp_f32 v211, v211
    v_cvt_pk_bf16_f32 v130, v208, v209
    ds_read_b128 a[216:219], v10 offset:8192
    v_cvt_pk_bf16_f32 v131, v210, v211
    v_mfma_f32_16x16x32_bf16 v[208:211], a[224:227], v[96:99], v[200:203]
    s_lshl_b32 s7, s7, 8
    s_nop 1
    v_exp_f32 v212, v212
    v_mfma_f32_16x16x32_bf16 v[208:211], a[228:231], v[100:103], v[208:211]
    s_add_u32 s36, s36, s7
    v_exp_f32 v213, v213
    v_mfma_f32_16x16x32_bf16 v[208:211], a[232:235], v[104:107], v[208:211]
    s_add_u32 s93, s47, s36
    v_exp_f32 v214, v214
    v_mfma_f32_16x16x32_bf16 v[208:211], a[236:239], v[108:111], v[208:211]
    v_exp_f32 v215, v215
    v_cvt_pk_bf16_f32 v138, v212, v213
    ds_read_b128 a[220:223], v11 offset:8192
    v_cvt_pk_bf16_f32 v139, v214, v215
    s_mov_b32 s39, 221184
    s_mov_b32 s38, 27648
    v_mfma_f32_16x16x32_bf16 v[212:215], a[224:227], v[112:115], v[204:207]
    s_lshr_b32 s36, s4, 1
    v_exp_f32 v208, v208
    v_mfma_f32_16x16x32_bf16 v[212:215], a[228:231], v[116:119], v[212:215]
    s_lshl_b32 s36, s36, 4
    v_exp_f32 v209, v209
    v_mfma_f32_16x16x32_bf16 v[212:215], a[232:235], v[120:123], v[212:215]
    s_add_u32 s36, s36, s5
    v_exp_f32 v210, v210
    v_mfma_f32_16x16x32_bf16 v[212:215], a[236:239], v[124:127], v[212:215]
    s_waitcnt lgkmcnt(3)
    v_exp_f32 v211, v211
    v_cvt_pk_bf16_f32 v146, v208, v209
    ds_read_b128 a[224:227], v8 offset:12288
    v_cvt_pk_bf16_f32 v147, v210, v211
    v_mfma_f32_16x16x32_bf16 v[208:211], a[208:211], v[64:67], v[192:195]
    s_waitcnt lgkmcnt(3)
    s_lshl_b32 s36, s36, 9
    v_exp_f32 v212, v212
    v_mfma_f32_16x16x32_bf16 v[208:211], a[212:215], v[68:71], v[208:211]
    s_waitcnt lgkmcnt(2)
    s_add_u32 s36, s36, s7
    v_exp_f32 v213, v213
    v_mfma_f32_16x16x32_bf16 v[208:211], a[216:219], v[72:75], v[208:211]
    s_waitcnt lgkmcnt(1)
    s_lshl_b32 s36, s36, 8
    v_exp_f32 v214, v214
    v_mfma_f32_16x16x32_bf16 v[208:211], a[220:223], v[76:79], v[208:211]
    v_exp_f32 v215, v215
    v_cvt_pk_bf16_f32 v154, v212, v213
    ds_read_b128 a[228:231], v9 offset:12288
    v_cvt_pk_bf16_f32 v155, v214, v215
    v_mfma_f32_16x16x32_bf16 v[212:215], a[208:211], v[80:83], v[196:199]
    s_add_u32 s55, s36, 20971520
    s_nop 1
    v_exp_f32 v208, v208
    v_mfma_f32_16x16x32_bf16 v[212:215], a[212:215], v[84:87], v[212:215]
    s_add_u32 s7, s45, s6
    v_exp_f32 v209, v209
    v_mfma_f32_16x16x32_bf16 v[212:215], a[216:219], v[88:91], v[212:215]
    s_xor_b32 s54, s92, 128
    v_exp_f32 v210, v210
    v_mfma_f32_16x16x32_bf16 v[212:215], a[220:223], v[92:95], v[212:215]
    v_exp_f32 v211, v211
    v_cvt_pk_bf16_f32 v132, v208, v209
    ds_read_b128 a[232:235], v10 offset:12288
    v_cvt_pk_bf16_f32 v133, v210, v211
    v_mfma_f32_16x16x32_bf16 v[208:211], a[208:211], v[96:99], v[200:203]
    s_lshl_b32 s36, s3, 14
    s_nop 1
    v_exp_f32 v212, v212
    v_mfma_f32_16x16x32_bf16 v[208:211], a[212:215], v[100:103], v[208:211]
    v_exp_f32 v213, v213
    v_lshrrev_b32 v51, 2, v0
    v_mfma_f32_16x16x32_bf16 v[208:211], a[216:219], v[104:107], v[208:211]
    v_exp_f32 v214, v214
    v_mul_u32_u24 v51, 9216, v51
    v_mfma_f32_16x16x32_bf16 v[208:211], a[220:223], v[108:111], v[208:211]
    v_exp_f32 v215, v215
    v_cvt_pk_bf16_f32 v140, v212, v213
    ds_read_b128 a[236:239], v11 offset:12288
    v_cvt_pk_bf16_f32 v141, v214, v215
    s_waitcnt vmcnt(5)
    s_barrier
    v_mfma_f32_16x16x32_bf16 v[212:215], a[208:211], v[112:115], v[204:207]
    s_nop 0
    v_exp_f32 v208, v208
    v_and_b32 v254, 3, v0
    v_mfma_f32_16x16x32_bf16 v[212:215], a[212:215], v[116:119], v[212:215]
    s_add_u32 m0, s42, 49152
    v_exp_f32 v209, v209
    v_lshl_add_u32 v254, v254, 4, v51
    v_mfma_f32_16x16x32_bf16 v[212:215], a[216:219], v[120:123], v[212:215]
    v_exp_f32 v210, v210
    v_lshlrev_b32 v255, 4, v0
    v_mfma_f32_16x16x32_bf16 v[212:215], a[220:223], v[124:127], v[212:215]
    s_waitcnt lgkmcnt(3)
    v_exp_f32 v211, v211
    v_cvt_pk_bf16_f32 v148, v208, v209
    ds_read_b128 a[208:211], v8 offset:16384
    v_cvt_pk_bf16_f32 v149, v210, v211
    buffer_load_dwordx4 v36, s[8:11], s40 offen lds
    v_mfma_f32_16x16x32_bf16 v[208:211], a[224:227], v[64:67], v[192:195]
    s_waitcnt lgkmcnt(3)
    v_exp_f32 v212, v212
    v_add_u32 v51, 98304, v255
    v_mfma_f32_16x16x32_bf16 v[208:211], a[228:231], v[68:71], v[208:211]
    s_waitcnt lgkmcnt(2)
    v_exp_f32 v213, v213
    v_lshl_add_u32 v252, v1, 4, s36
    v_mfma_f32_16x16x32_bf16 v[208:211], a[232:235], v[72:75], v[208:211]
    s_waitcnt lgkmcnt(1)
    v_exp_f32 v214, v214
    v_mfma_f32_16x16x32_bf16 v[208:211], a[236:239], v[76:79], v[208:211]
    v_exp_f32 v215, v215
    v_cvt_pk_bf16_f32 v156, v212, v213
    ds_read_b128 a[212:215], v9 offset:16384
    v_cvt_pk_bf16_f32 v157, v214, v215
    v_mfma_f32_16x16x32_bf16 v[212:215], a[224:227], v[80:83], v[196:199]
    s_nop 2
    v_exp_f32 v208, v208
    v_mfma_f32_16x16x32_bf16 v[212:215], a[228:231], v[84:87], v[212:215]
    v_exp_f32 v209, v209
    v_mfma_f32_16x16x32_bf16 v[212:215], a[232:235], v[88:91], v[212:215]
    v_exp_f32 v210, v210
    v_mfma_f32_16x16x32_bf16 v[212:215], a[236:239], v[92:95], v[212:215]
    v_exp_f32 v211, v211
    ds_read_b64_tr_b16 a[160:161], v20 offset:0
    v_cvt_pk_bf16_f32 v134, v208, v209
    s_mov_b32 s57, s58
    s_lshl_b32 s6, s3, 10
    s_add_u32 s6, s6, 135168
    s_lshr_b32 s37, s2, 3
    s_mul_i32 s37, s37, -129024
    s_add_u32 s37, s37, 4128768
    ds_read_b64_tr_b16 a[162:163], v20 offset:4096
    ds_read_b128 a[216:219], v10 offset:16384
    v_cvt_pk_bf16_f32 v135, v210, v211
    buffer_load_dwordx4 v37, s[8:11], s40 offen offset:1024 lds
    v_mfma_f32_16x16x32_bf16 v[208:211], a[224:227], v[96:99], v[200:203]
    v_exp_f32 v212, v212
    v_mfma_f32_16x16x32_bf16 v[208:211], a[228:231], v[100:103], v[208:211]
    v_exp_f32 v213, v213
    v_mfma_f32_16x16x32_bf16 v[208:211], a[232:235], v[104:107], v[208:211]
    v_exp_f32 v214, v214
    v_mfma_f32_16x16x32_bf16 v[208:211], a[236:239], v[108:111], v[208:211]
    s_mov_b32 s52, s55
    v_exp_f32 v215, v215
    ds_read_b64_tr_b16 a[164:165], v20 offset:8192
    v_cvt_pk_bf16_f32 v142, v212, v213
    ds_read_b64_tr_b16 a[166:167], v20 offset:12288
    v_min_u32 v237, 19, v1
    v_lshl_add_u32 v237, v237, 7, s36
    v_lshl_add_u32 v238, v1, 7, s36
    ds_read_b128 a[220:223], v11 offset:16384
    v_cvt_pk_bf16_f32 v143, v214, v215
    buffer_load_dword v217, v57, s[32:35], s37 offen
    v_mfma_f32_16x16x32_bf16 v[212:215], a[224:227], v[112:115], v[204:207]
    v_exp_f32 v208, v208
    v_mfma_f32_16x16x32_bf16 v[212:215], a[228:231], v[116:119], v[212:215]
    v_exp_f32 v209, v209
    v_mfma_f32_16x16x32_bf16 v[212:215], a[232:235], v[120:123], v[212:215]
    v_exp_f32 v210, v210
    v_mfma_f32_16x16x32_bf16 v[212:215], a[236:239], v[124:127], v[212:215]
    v_exp_f32 v211, v211
    ds_read_b64_tr_b16 a[168:169], v21 offset:0
    v_cvt_pk_bf16_f32 v150, v208, v209
    ds_read_b64_tr_b16 a[170:171], v21 offset:4096
    ds_read_b128 a[224:227], v8 offset:20480
    v_cvt_pk_bf16_f32 v151, v210, v211
    s_waitcnt lgkmcnt(3)
    buffer_load_dwordx4 v38, s[8:11], s40 offen offset:2048 lds
Lattn_loop:
    v_mfma_f32_16x16x32_bf16 v[208:211], a[208:211], v[64:67], v[192:195]
    v_exp_f32 v212, v212
    v_mfma_f32_16x16x32_bf16 v[208:211], a[212:215], v[68:71], v[208:211]
    v_exp_f32 v213, v213
    v_mfma_f32_16x16x32_bf16 v[208:211], a[216:219], v[72:75], v[208:211]
    v_exp_f32 v214, v214
    v_mfma_f32_16x16x32_bf16 v[208:211], a[220:223], v[76:79], v[208:211]
    v_exp_f32 v215, v215
    v_mfma_f32_16x16x32_bf16 a[0:3], a[160:163], v[128:131], a[0:3]
    ds_read_b64_tr_b16 a[172:173], v21 offset:8192
    v_cvt_pk_bf16_f32 v158, v212, v213
    v_mfma_f32_16x16x32_bf16 a[0:3], a[164:167], v[132:135], a[0:3]
    ds_read_b64_tr_b16 a[174:175], v21 offset:12288
    v_mfma_f32_16x16x32_bf16 a[4:7], a[160:163], v[136:139], a[4:7]
    ds_read_b128 a[228:231], v9 offset:20480
    v_cvt_pk_bf16_f32 v159, v214, v215
    v_mfma_f32_16x16x32_bf16 a[4:7], a[164:167], v[140:143], a[4:7]
    v_mfma_f32_16x16x32_bf16 v[212:215], a[208:211], v[80:83], v[196:199]
    v_exp_f32 v208, v208
    v_mfma_f32_16x16x32_bf16 v[212:215], a[212:215], v[84:87], v[212:215]
    v_exp_f32 v209, v209
    v_mfma_f32_16x16x32_bf16 v[212:215], a[216:219], v[88:91], v[212:215]
    v_exp_f32 v210, v210
    v_mfma_f32_16x16x32_bf16 v[212:215], a[220:223], v[92:95], v[212:215]
    v_exp_f32 v211, v211
    v_mfma_f32_16x16x32_bf16 a[8:11], a[160:163], v[144:147], a[8:11]
    ds_read_b64_tr_b16 a[176:177], v22 offset:0
    v_cvt_pk_bf16_f32 v160, v208, v209
    v_mfma_f32_16x16x32_bf16 a[8:11], a[164:167], v[148:151], a[8:11]
    ds_read_b64_tr_b16 a[178:179], v22 offset:4096
    v_mfma_f32_16x16x32_bf16 a[12:15], a[160:163], v[152:155], a[12:15]
    ds_read_b128 a[232:235], v10 offset:20480
    v_cvt_pk_bf16_f32 v161, v210, v211
    v_mfma_f32_16x16x32_bf16 a[12:15], a[164:167], v[156:159], a[12:15]
    s_waitcnt lgkmcnt(3)
    buffer_load_dwordx4 v39, s[8:11], s40 offen offset:3072 lds
    v_mfma_f32_16x16x32_bf16 v[208:211], a[208:211], v[96:99], v[200:203]
    v_exp_f32 v212, v212
    v_mfma_f32_16x16x32_bf16 v[208:211], a[212:215], v[100:103], v[208:211]
    s_add_u32 s40, s40, 16384
    v_exp_f32 v213, v213
    v_mfma_f32_16x16x32_bf16 v[208:211], a[216:219], v[104:107], v[208:211]
    s_mov_b32 m0, s6
    v_exp_f32 v214, v214
    v_mfma_f32_16x16x32_bf16 v[208:211], a[220:223], v[108:111], v[208:211]
    v_exp_f32 v215, v215
    v_mfma_f32_16x16x32_bf16 a[16:19], a[168:171], v[128:131], a[16:19]
    ds_read_b64_tr_b16 a[180:181], v22 offset:8192
    v_cvt_pk_bf16_f32 v168, v212, v213
    v_mfma_f32_16x16x32_bf16 a[16:19], a[172:175], v[132:135], a[16:19]
    ds_read_b64_tr_b16 a[182:183], v22 offset:12288
    v_mfma_f32_16x16x32_bf16 a[20:23], a[168:171], v[136:139], a[20:23]
    ds_read_b128 a[236:239], v11 offset:20480
    v_cvt_pk_bf16_f32 v169, v214, v215
    v_mfma_f32_16x16x32_bf16 a[20:23], a[172:175], v[140:143], a[20:23]
    buffer_load_dwordx4 v254, s[32:35], s57 offen  lds
    v_smfmac_f32_16x16x64_bf16 a[192:195], v[52:55], v[128:135], v50
    v_mfma_f32_16x16x32_bf16 v[212:215], a[208:211], v[112:115], v[204:207]
    v_exp_f32 v208, v208
    v_mfma_f32_16x16x32_bf16 v[212:215], a[212:215], v[116:119], v[212:215]
    s_add_u32 m0, s42, 98304
    v_exp_f32 v209, v209
    v_mfma_f32_16x16x32_bf16 v[212:215], a[216:219], v[120:123], v[212:215]
    v_exp_f32 v210, v210
    v_mfma_f32_16x16x32_bf16 v[212:215], a[220:223], v[124:127], v[212:215]
    v_exp_f32 v211, v211
    v_mfma_f32_16x16x32_bf16 a[24:27], a[168:171], v[144:147], a[24:27]
    ds_read_b64_tr_b16 a[184:185], v23 offset:0
    v_cvt_pk_bf16_f32 v176, v208, v209
    v_mfma_f32_16x16x32_bf16 a[24:27], a[172:175], v[148:151], a[24:27]
    ds_read_b64_tr_b16 a[186:187], v23 offset:4096
    v_mfma_f32_16x16x32_bf16 a[28:31], a[168:171], v[152:155], a[28:31]
    ds_read_b128 a[208:211], v8 offset:24576
    v_cvt_pk_bf16_f32 v177, v210, v211
    v_mfma_f32_16x16x32_bf16 a[28:31], a[172:175], v[156:159], a[28:31]
    s_waitcnt lgkmcnt(3)
    buffer_load_dwordx4 v40, s[12:15], s41 offen lds
    v_mfma_f32_16x16x32_bf16 v[208:211], a[224:227], v[64:67], v[192:195]
    v_exp_f32 v212, v212
    v_mfma_f32_16x16x32_bf16 v[208:211], a[228:231], v[68:71], v[208:211]
    s_add_u32 s6, s6, 4096
    v_exp_f32 v213, v213
    v_mfma_f32_16x16x32_bf16 v[208:211], a[232:235], v[72:75], v[208:211]
    s_add_u32 s57, s57, 589824
    v_exp_f32 v214, v214
    v_mfma_f32_16x16x32_bf16 v[208:211], a[236:239], v[76:79], v[208:211]
    v_exp_f32 v215, v215
    v_mfma_f32_16x16x32_bf16 a[32:35], a[176:179], v[128:131], a[32:35]
    ds_read_b64_tr_b16 a[188:189], v23 offset:8192
    v_cvt_pk_bf16_f32 v184, v212, v213
    v_mfma_f32_16x16x32_bf16 a[32:35], a[180:183], v[132:135], a[32:35]
    ds_read_b64_tr_b16 a[190:191], v23 offset:12288
    v_mfma_f32_16x16x32_bf16 a[36:39], a[176:179], v[136:139], a[36:39]
    ds_read_b128 a[212:215], v9 offset:24576
    v_cvt_pk_bf16_f32 v185, v214, v215
    v_mfma_f32_16x16x32_bf16 a[36:39], a[180:183], v[140:143], a[36:39]
    v_smfmac_f32_16x16x64_bf16 a[196:199], v[52:55], v[136:143], v50
    v_mfma_f32_16x16x32_bf16 v[212:215], a[224:227], v[80:83], v[196:199]
    v_exp_f32 v208, v208
    v_mfma_f32_16x16x32_bf16 v[212:215], a[228:231], v[84:87], v[212:215]
    v_exp_f32 v209, v209
    v_mfma_f32_16x16x32_bf16 v[212:215], a[232:235], v[88:91], v[212:215]
    v_exp_f32 v210, v210
    v_mfma_f32_16x16x32_bf16 v[212:215], a[236:239], v[92:95], v[212:215]
    v_exp_f32 v211, v211
    v_mfma_f32_16x16x32_bf16 a[40:43], a[176:179], v[144:147], a[40:43]
    ds_read_b64_tr_b16 a[160:161], v24 offset:0
    v_cvt_pk_bf16_f32 v162, v208, v209
    v_mfma_f32_16x16x32_bf16 a[40:43], a[180:183], v[148:151], a[40:43]
    ds_read_b64_tr_b16 a[162:163], v24 offset:4096
    v_mfma_f32_16x16x32_bf16 a[44:47], a[176:179], v[152:155], a[44:47]
    ds_read_b128 a[216:219], v10 offset:24576
    v_cvt_pk_bf16_f32 v163, v210, v211
    v_mfma_f32_16x16x32_bf16 a[44:47], a[180:183], v[156:159], a[44:47]
    s_waitcnt lgkmcnt(3)
    buffer_load_dwordx4 v41, s[12:15], s41 offen offset:1024 lds
    v_mfma_f32_16x16x32_bf16 v[208:211], a[224:227], v[96:99], v[200:203]
    v_exp_f32 v212, v212
    v_mfma_f32_16x16x32_bf16 v[208:211], a[228:231], v[100:103], v[208:211]
    v_exp_f32 v213, v213
    v_mfma_f32_16x16x32_bf16 v[208:211], a[232:235], v[104:107], v[208:211]
    v_exp_f32 v214, v214
    v_mfma_f32_16x16x32_bf16 v[208:211], a[236:239], v[108:111], v[208:211]
    v_exp_f32 v215, v215
    v_mfma_f32_16x16x32_bf16 a[48:51], a[184:187], v[128:131], a[48:51]
    ds_read_b64_tr_b16 a[164:165], v24 offset:8192
    v_cvt_pk_bf16_f32 v170, v212, v213
    v_mfma_f32_16x16x32_bf16 a[48:51], a[188:191], v[132:135], a[48:51]
    ds_read_b64_tr_b16 a[166:167], v24 offset:12288
    v_mfma_f32_16x16x32_bf16 a[52:55], a[184:187], v[136:139], a[52:55]
    ds_read_b128 a[220:223], v11 offset:24576
    v_cvt_pk_bf16_f32 v171, v214, v215
    v_mfma_f32_16x16x32_bf16 a[52:55], a[188:191], v[140:143], a[52:55]
    v_smfmac_f32_16x16x64_bf16 a[200:203], v[52:55], v[144:151], v50
    v_mfma_f32_16x16x32_bf16 v[212:215], a[224:227], v[112:115], v[204:207]
    v_exp_f32 v208, v208
    v_mfma_f32_16x16x32_bf16 v[212:215], a[228:231], v[116:119], v[212:215]
    v_exp_f32 v209, v209
    v_mfma_f32_16x16x32_bf16 v[212:215], a[232:235], v[120:123], v[212:215]
    v_exp_f32 v210, v210
    v_mfma_f32_16x16x32_bf16 v[212:215], a[236:239], v[124:127], v[212:215]
    v_exp_f32 v211, v211
    v_mfma_f32_16x16x32_bf16 a[56:59], a[184:187], v[144:147], a[56:59]
    ds_read_b64_tr_b16 a[168:169], v25 offset:0
    v_cvt_pk_bf16_f32 v178, v208, v209
    v_mfma_f32_16x16x32_bf16 a[56:59], a[188:191], v[148:151], a[56:59]
    ds_read_b64_tr_b16 a[170:171], v25 offset:4096
    v_mfma_f32_16x16x32_bf16 a[60:63], a[184:187], v[152:155], a[60:63]
    ds_read_b128 a[224:227], v8 offset:28672
    v_cvt_pk_bf16_f32 v179, v210, v211
    v_mfma_f32_16x16x32_bf16 a[60:63], a[188:191], v[156:159], a[60:63]
    s_waitcnt lgkmcnt(3)
    buffer_load_dwordx4 v40, s[12:15], s41 offen offset:2048 lds
    v_mfma_f32_16x16x32_bf16 v[208:211], a[208:211], v[64:67], v[192:195]
    v_exp_f32 v212, v212
    v_mfma_f32_16x16x32_bf16 v[208:211], a[212:215], v[68:71], v[208:211]
    v_exp_f32 v213, v213
    v_mfma_f32_16x16x32_bf16 v[208:211], a[216:219], v[72:75], v[208:211]
    v_exp_f32 v214, v214
    v_mfma_f32_16x16x32_bf16 v[208:211], a[220:223], v[76:79], v[208:211]
    v_exp_f32 v215, v215
    v_mfma_f32_16x16x32_bf16 a[64:67], a[160:163], v[128:131], a[64:67]
    ds_read_b64_tr_b16 a[172:173], v25 offset:8192
    v_cvt_pk_bf16_f32 v186, v212, v213
    v_mfma_f32_16x16x32_bf16 a[64:67], a[164:167], v[132:135], a[64:67]
    ds_read_b64_tr_b16 a[174:175], v25 offset:12288
    v_mfma_f32_16x16x32_bf16 a[68:71], a[160:163], v[136:139], a[68:71]
    ds_read_b128 a[228:231], v9 offset:28672
    v_cvt_pk_bf16_f32 v187, v214, v215
    v_mfma_f32_16x16x32_bf16 a[68:71], a[164:167], v[140:143], a[68:71]
    v_smfmac_f32_16x16x64_bf16 a[204:207], v[52:55], v[152:159], v50
    v_mfma_f32_16x16x32_bf16 v[212:215], a[208:211], v[80:83], v[196:199]
    v_exp_f32 v208, v208
    v_mfma_f32_16x16x32_bf16 v[212:215], a[212:215], v[84:87], v[212:215]
    v_exp_f32 v209, v209
    v_mfma_f32_16x16x32_bf16 v[212:215], a[216:219], v[88:91], v[212:215]
    v_exp_f32 v210, v210
    v_mfma_f32_16x16x32_bf16 v[212:215], a[220:223], v[92:95], v[212:215]
    v_exp_f32 v211, v211
    v_mfma_f32_16x16x32_bf16 a[72:75], a[160:163], v[144:147], a[72:75]
    ds_read_b64_tr_b16 a[176:177], v26 offset:0
    v_cvt_pk_bf16_f32 v164, v208, v209
    v_mfma_f32_16x16x32_bf16 a[72:75], a[164:167], v[148:151], a[72:75]
    ds_read_b64_tr_b16 a[178:179], v26 offset:4096
    v_mfma_f32_16x16x32_bf16 a[76:79], a[160:163], v[152:155], a[76:79]
    ds_read_b128 a[232:235], v10 offset:28672
    v_cvt_pk_bf16_f32 v165, v210, v211
    v_mfma_f32_16x16x32_bf16 a[76:79], a[164:167], v[156:159], a[76:79]
    s_waitcnt lgkmcnt(3)
    buffer_load_dwordx4 v41, s[12:15], s41 offen offset:3072 lds
    v_mfma_f32_16x16x32_bf16 v[208:211], a[208:211], v[96:99], v[200:203]
    v_exp_f32 v212, v212
    v_mfma_f32_16x16x32_bf16 v[208:211], a[212:215], v[100:103], v[208:211]
    s_add_u32 s41, s41, 16384
    v_exp_f32 v213, v213
    v_mfma_f32_16x16x32_bf16 v[208:211], a[216:219], v[104:107], v[208:211]
    v_exp_f32 v214, v214
    v_mfma_f32_16x16x32_bf16 v[208:211], a[220:223], v[108:111], v[208:211]
    v_exp_f32 v215, v215
    v_mfma_f32_16x16x32_bf16 a[80:83], a[168:171], v[128:131], a[80:83]
    ds_read_b64_tr_b16 a[180:181], v26 offset:8192
    v_cvt_pk_bf16_f32 v172, v212, v213
    v_mfma_f32_16x16x32_bf16 a[80:83], a[172:175], v[132:135], a[80:83]
    ds_read_b64_tr_b16 a[182:183], v26 offset:12288
    v_mfma_f32_16x16x32_bf16 a[84:87], a[168:171], v[136:139], a[84:87]
    ds_read_b128 a[236:239], v11 offset:28672
    v_cvt_pk_bf16_f32 v173, v214, v215
    v_mfma_f32_16x16x32_bf16 a[84:87], a[172:175], v[140:143], a[84:87]
    s_waitcnt vmcnt(10)
    s_barrier
    v_mfma_f32_16x16x32_bf16 v[212:215], a[208:211], v[112:115], v[204:207]
    v_exp_f32 v208, v208
    v_mfma_f32_16x16x32_bf16 v[212:215], a[212:215], v[116:119], v[212:215]
    s_add_u32 m0, s42, 0
    v_exp_f32 v209, v209
    v_mfma_f32_16x16x32_bf16 v[212:215], a[216:219], v[120:123], v[212:215]
    v_exp_f32 v210, v210
    v_mfma_f32_16x16x32_bf16 v[212:215], a[220:223], v[124:127], v[212:215]
    v_exp_f32 v211, v211
    v_mfma_f32_16x16x32_bf16 a[88:91], a[168:171], v[144:147], a[88:91]
    ds_read_b64_tr_b16 a[184:185], v27 offset:0
    v_cvt_pk_bf16_f32 v180, v208, v209
    v_mfma_f32_16x16x32_bf16 a[88:91], a[172:175], v[148:151], a[88:91]
    ds_read_b64_tr_b16 a[186:187], v27 offset:4096
    v_mfma_f32_16x16x32_bf16 a[92:95], a[168:171], v[152:155], a[92:95]
    ds_read_b128 a[208:211], v8 offset:32768
    v_cvt_pk_bf16_f32 v181, v210, v211
    v_mfma_f32_16x16x32_bf16 a[92:95], a[172:175], v[156:159], a[92:95]
    s_waitcnt lgkmcnt(3)
    buffer_load_dwordx4 v36, s[8:11], s40 offen lds
    v_mfma_f32_16x16x32_bf16 v[208:211], a[224:227], v[64:67], v[192:195]
    v_exp_f32 v212, v212
    v_mfma_f32_16x16x32_bf16 v[208:211], a[228:231], v[68:71], v[208:211]
    v_exp_f32 v213, v213
    v_mfma_f32_16x16x32_bf16 v[208:211], a[232:235], v[72:75], v[208:211]
    v_exp_f32 v214, v214
    v_mfma_f32_16x16x32_bf16 v[208:211], a[236:239], v[76:79], v[208:211]
    v_exp_f32 v215, v215
    v_mfma_f32_16x16x32_bf16 a[96:99], a[176:179], v[128:131], a[96:99]
    ds_read_b64_tr_b16 a[188:189], v27 offset:8192
    v_cvt_pk_bf16_f32 v188, v212, v213
    v_mfma_f32_16x16x32_bf16 a[96:99], a[180:183], v[132:135], a[96:99]
    ds_read_b64_tr_b16 a[190:191], v27 offset:12288
    v_mfma_f32_16x16x32_bf16 a[100:103], a[176:179], v[136:139], a[100:103]
    ds_read_b128 a[212:215], v9 offset:32768
    v_cvt_pk_bf16_f32 v189, v214, v215
    v_mfma_f32_16x16x32_bf16 a[100:103], a[180:183], v[140:143], a[100:103]
    v_mfma_f32_16x16x32_bf16 v[212:215], a[224:227], v[80:83], v[196:199]
    v_exp_f32 v208, v208
    v_mfma_f32_16x16x32_bf16 v[212:215], a[228:231], v[84:87], v[212:215]
    v_exp_f32 v209, v209
    v_mfma_f32_16x16x32_bf16 v[212:215], a[232:235], v[88:91], v[212:215]
    v_exp_f32 v210, v210
    v_mfma_f32_16x16x32_bf16 v[212:215], a[236:239], v[92:95], v[212:215]
    v_exp_f32 v211, v211
    v_mfma_f32_16x16x32_bf16 a[104:107], a[176:179], v[144:147], a[104:107]
    ds_read_b64_tr_b16 a[160:161], v20 offset:16384
    v_cvt_pk_bf16_f32 v166, v208, v209
    v_mfma_f32_16x16x32_bf16 a[104:107], a[180:183], v[148:151], a[104:107]
    ds_read_b64_tr_b16 a[162:163], v20 offset:20480
    v_mfma_f32_16x16x32_bf16 a[108:111], a[176:179], v[152:155], a[108:111]
    ds_read_b128 a[216:219], v10 offset:32768
    v_cvt_pk_bf16_f32 v167, v210, v211
    v_mfma_f32_16x16x32_bf16 a[108:111], a[180:183], v[156:159], a[108:111]
    s_waitcnt lgkmcnt(3)
    buffer_load_dwordx4 v37, s[8:11], s40 offen offset:1024 lds
    v_mfma_f32_16x16x32_bf16 v[208:211], a[224:227], v[96:99], v[200:203]
    v_exp_f32 v212, v212
    v_mfma_f32_16x16x32_bf16 v[208:211], a[228:231], v[100:103], v[208:211]
    v_exp_f32 v213, v213
    v_mfma_f32_16x16x32_bf16 v[208:211], a[232:235], v[104:107], v[208:211]
    v_exp_f32 v214, v214
    v_mfma_f32_16x16x32_bf16 v[208:211], a[236:239], v[108:111], v[208:211]
    v_exp_f32 v215, v215
    v_mfma_f32_16x16x32_bf16 a[112:115], a[184:187], v[128:131], a[112:115]
    ds_read_b64_tr_b16 a[164:165], v20 offset:24576
    v_cvt_pk_bf16_f32 v174, v212, v213
    v_mfma_f32_16x16x32_bf16 a[112:115], a[188:191], v[132:135], a[112:115]
    ds_read_b64_tr_b16 a[166:167], v20 offset:28672
    v_mfma_f32_16x16x32_bf16 a[116:119], a[184:187], v[136:139], a[116:119]
    ds_read_b128 a[220:223], v11 offset:32768
    v_cvt_pk_bf16_f32 v175, v214, v215
    v_mfma_f32_16x16x32_bf16 a[116:119], a[188:191], v[140:143], a[116:119]
    v_mfma_f32_16x16x32_bf16 v[212:215], a[224:227], v[112:115], v[204:207]
    v_exp_f32 v208, v208
    v_mfma_f32_16x16x32_bf16 v[212:215], a[228:231], v[116:119], v[212:215]
    v_exp_f32 v209, v209
    v_mfma_f32_16x16x32_bf16 v[212:215], a[232:235], v[120:123], v[212:215]
    v_exp_f32 v210, v210
    v_mfma_f32_16x16x32_bf16 v[212:215], a[236:239], v[124:127], v[212:215]
    v_exp_f32 v211, v211
    v_mfma_f32_16x16x32_bf16 a[120:123], a[184:187], v[144:147], a[120:123]
    ds_read_b64_tr_b16 a[168:169], v21 offset:16384
    v_cvt_pk_bf16_f32 v182, v208, v209
    v_mfma_f32_16x16x32_bf16 a[120:123], a[188:191], v[148:151], a[120:123]
    ds_read_b64_tr_b16 a[170:171], v21 offset:20480
    v_mfma_f32_16x16x32_bf16 a[124:127], a[184:187], v[152:155], a[124:127]
    ds_read_b128 a[224:227], v8 offset:36864
    v_cvt_pk_bf16_f32 v183, v210, v211
    v_mfma_f32_16x16x32_bf16 a[124:127], a[188:191], v[156:159], a[124:127]
    s_waitcnt lgkmcnt(3)
    buffer_load_dwordx4 v38, s[8:11], s40 offen offset:2048 lds
    v_mfma_f32_16x16x32_bf16 v[208:211], a[208:211], v[64:67], v[192:195]
    v_exp_f32 v212, v212
    v_mfma_f32_16x16x32_bf16 v[208:211], a[212:215], v[68:71], v[208:211]
    v_exp_f32 v213, v213
    v_mfma_f32_16x16x32_bf16 v[208:211], a[216:219], v[72:75], v[208:211]
    v_exp_f32 v214, v214
    v_mfma_f32_16x16x32_bf16 v[208:211], a[220:223], v[76:79], v[208:211]
    v_exp_f32 v215, v215
    v_mfma_f32_16x16x32_bf16 a[0:3], a[160:163], v[160:163], a[0:3]
    ds_read_b64_tr_b16 a[172:173], v21 offset:24576
    v_cvt_pk_bf16_f32 v190, v212, v213
    v_mfma_f32_16x16x32_bf16 a[0:3], a[164:167], v[164:167], a[0:3]
    ds_read_b64_tr_b16 a[174:175], v21 offset:28672
    v_mfma_f32_16x16x32_bf16 a[4:7], a[160:163], v[168:171], a[4:7]
    ds_read_b128 a[228:231], v9 offset:36864
    v_cvt_pk_bf16_f32 v191, v214, v215
    v_mfma_f32_16x16x32_bf16 a[4:7], a[164:167], v[172:175], a[4:7]
    v_mfma_f32_16x16x32_bf16 v[212:215], a[208:211], v[80:83], v[196:199]
    v_exp_f32 v208, v208
    v_mfma_f32_16x16x32_bf16 v[212:215], a[212:215], v[84:87], v[212:215]
    v_exp_f32 v209, v209
    v_mfma_f32_16x16x32_bf16 v[212:215], a[216:219], v[88:91], v[212:215]
    v_exp_f32 v210, v210
    v_mfma_f32_16x16x32_bf16 v[212:215], a[220:223], v[92:95], v[212:215]
    v_exp_f32 v211, v211
    v_mfma_f32_16x16x32_bf16 a[8:11], a[160:163], v[176:179], a[8:11]
    ds_read_b64_tr_b16 a[176:177], v22 offset:16384
    v_cvt_pk_bf16_f32 v128, v208, v209
    v_mfma_f32_16x16x32_bf16 a[8:11], a[164:167], v[180:183], a[8:11]
    ds_read_b64_tr_b16 a[178:179], v22 offset:20480
    v_mfma_f32_16x16x32_bf16 a[12:15], a[160:163], v[184:187], a[12:15]
    ds_read_b128 a[232:235], v10 offset:36864
    v_cvt_pk_bf16_f32 v129, v210, v211
    v_mfma_f32_16x16x32_bf16 a[12:15], a[164:167], v[188:191], a[12:15]
    s_waitcnt lgkmcnt(3)
    buffer_load_dwordx4 v39, s[8:11], s40 offen offset:3072 lds
    v_mfma_f32_16x16x32_bf16 v[208:211], a[208:211], v[96:99], v[200:203]
    v_exp_f32 v212, v212
    v_mfma_f32_16x16x32_bf16 v[208:211], a[212:215], v[100:103], v[208:211]
    s_add_u32 s40, s40, 16384
    v_exp_f32 v213, v213
    v_mfma_f32_16x16x32_bf16 v[208:211], a[216:219], v[104:107], v[208:211]
    v_exp_f32 v214, v214
    v_mfma_f32_16x16x32_bf16 v[208:211], a[220:223], v[108:111], v[208:211]
    v_exp_f32 v215, v215
    v_mfma_f32_16x16x32_bf16 a[16:19], a[168:171], v[160:163], a[16:19]
    ds_read_b64_tr_b16 a[180:181], v22 offset:24576
    v_cvt_pk_bf16_f32 v136, v212, v213
    v_mfma_f32_16x16x32_bf16 a[16:19], a[172:175], v[164:167], a[16:19]
    ds_read_b64_tr_b16 a[182:183], v22 offset:28672
    v_mfma_f32_16x16x32_bf16 a[20:23], a[168:171], v[168:171], a[20:23]
    ds_read_b128 a[236:239], v11 offset:36864
    v_cvt_pk_bf16_f32 v137, v214, v215
    v_mfma_f32_16x16x32_bf16 a[20:23], a[172:175], v[172:175], a[20:23]
    v_smfmac_f32_16x16x64_bf16 a[192:195], v[52:55], v[160:167], v50
    v_mfma_f32_16x16x32_bf16 v[212:215], a[208:211], v[112:115], v[204:207]
    v_exp_f32 v208, v208
    v_mfma_f32_16x16x32_bf16 v[212:215], a[212:215], v[116:119], v[212:215]
    s_add_u32 m0, s42, 114688
    v_exp_f32 v209, v209
    v_mfma_f32_16x16x32_bf16 v[212:215], a[216:219], v[120:123], v[212:215]
    v_exp_f32 v210, v210
    v_mfma_f32_16x16x32_bf16 v[212:215], a[220:223], v[124:127], v[212:215]
    v_exp_f32 v211, v211
    v_mfma_f32_16x16x32_bf16 a[24:27], a[168:171], v[176:179], a[24:27]
    ds_read_b64_tr_b16 a[184:185], v23 offset:16384
    v_cvt_pk_bf16_f32 v144, v208, v209
    v_mfma_f32_16x16x32_bf16 a[24:27], a[172:175], v[180:183], a[24:27]
    ds_read_b64_tr_b16 a[186:187], v23 offset:20480
    v_mfma_f32_16x16x32_bf16 a[28:31], a[168:171], v[184:187], a[28:31]
    ds_read_b128 a[208:211], v8 offset:40960
    v_cvt_pk_bf16_f32 v145, v210, v211
    v_mfma_f32_16x16x32_bf16 a[28:31], a[172:175], v[188:191], a[28:31]
    s_waitcnt lgkmcnt(3)
    buffer_load_dwordx4 v40, s[12:15], s41 offen lds
    v_mfma_f32_16x16x32_bf16 v[208:211], a[224:227], v[64:67], v[192:195]
    v_exp_f32 v212, v212
    v_mfma_f32_16x16x32_bf16 v[208:211], a[228:231], v[68:71], v[208:211]
    v_exp_f32 v213, v213
    v_mfma_f32_16x16x32_bf16 v[208:211], a[232:235], v[72:75], v[208:211]
    v_exp_f32 v214, v214
    v_mfma_f32_16x16x32_bf16 v[208:211], a[236:239], v[76:79], v[208:211]
    v_exp_f32 v215, v215
    v_mfma_f32_16x16x32_bf16 a[32:35], a[176:179], v[160:163], a[32:35]
    ds_read_b64_tr_b16 a[188:189], v23 offset:24576
    v_cvt_pk_bf16_f32 v152, v212, v213
    v_mfma_f32_16x16x32_bf16 a[32:35], a[180:183], v[164:167], a[32:35]
    ds_read_b64_tr_b16 a[190:191], v23 offset:28672
    v_mfma_f32_16x16x32_bf16 a[36:39], a[176:179], v[168:171], a[36:39]
    ds_read_b128 a[212:215], v9 offset:40960
    v_cvt_pk_bf16_f32 v153, v214, v215
    v_mfma_f32_16x16x32_bf16 a[36:39], a[180:183], v[172:175], a[36:39]
    v_smfmac_f32_16x16x64_bf16 a[196:199], v[52:55], v[168:175], v50
    v_mfma_f32_16x16x32_bf16 v[212:215], a[224:227], v[80:83], v[196:199]
    v_exp_f32 v208, v208
    v_mfma_f32_16x16x32_bf16 v[212:215], a[228:231], v[84:87], v[212:215]
    v_exp_f32 v209, v209
    v_mfma_f32_16x16x32_bf16 v[212:215], a[232:235], v[88:91], v[212:215]
    v_exp_f32 v210, v210
    v_mfma_f32_16x16x32_bf16 v[212:215], a[236:239], v[92:95], v[212:215]
    v_exp_f32 v211, v211
    v_mfma_f32_16x16x32_bf16 a[40:43], a[176:179], v[176:179], a[40:43]
    ds_read_b64_tr_b16 a[160:161], v24 offset:16384
    v_cvt_pk_bf16_f32 v130, v208, v209
    v_mfma_f32_16x16x32_bf16 a[40:43], a[180:183], v[180:183], a[40:43]
    ds_read_b64_tr_b16 a[162:163], v24 offset:20480
    v_mfma_f32_16x16x32_bf16 a[44:47], a[176:179], v[184:187], a[44:47]
    ds_read_b128 a[216:219], v10 offset:40960
    v_cvt_pk_bf16_f32 v131, v210, v211
    v_mfma_f32_16x16x32_bf16 a[44:47], a[180:183], v[188:191], a[44:47]
    s_waitcnt lgkmcnt(3)
    buffer_load_dwordx4 v41, s[12:15], s41 offen offset:1024 lds
    v_mfma_f32_16x16x32_bf16 v[208:211], a[224:227], v[96:99], v[200:203]
    v_exp_f32 v212, v212
    v_mfma_f32_16x16x32_bf16 v[208:211], a[228:231], v[100:103], v[208:211]
    v_exp_f32 v213, v213
    v_mfma_f32_16x16x32_bf16 v[208:211], a[232:235], v[104:107], v[208:211]
    v_exp_f32 v214, v214
    v_mfma_f32_16x16x32_bf16 v[208:211], a[236:239], v[108:111], v[208:211]
    v_exp_f32 v215, v215
    v_mfma_f32_16x16x32_bf16 a[48:51], a[184:187], v[160:163], a[48:51]
    ds_read_b64_tr_b16 a[164:165], v24 offset:24576
    v_cvt_pk_bf16_f32 v138, v212, v213
    v_mfma_f32_16x16x32_bf16 a[48:51], a[188:191], v[164:167], a[48:51]
    ds_read_b64_tr_b16 a[166:167], v24 offset:28672
    v_mfma_f32_16x16x32_bf16 a[52:55], a[184:187], v[168:171], a[52:55]
    ds_read_b128 a[220:223], v11 offset:40960
    v_cvt_pk_bf16_f32 v139, v214, v215
    v_mfma_f32_16x16x32_bf16 a[52:55], a[188:191], v[172:175], a[52:55]
    v_smfmac_f32_16x16x64_bf16 a[200:203], v[52:55], v[176:183], v50
    v_mfma_f32_16x16x32_bf16 v[212:215], a[224:227], v[112:115], v[204:207]
    v_exp_f32 v208, v208
    v_mfma_f32_16x16x32_bf16 v[212:215], a[228:231], v[116:119], v[212:215]
    v_exp_f32 v209, v209
    v_mfma_f32_16x16x32_bf16 v[212:215], a[232:235], v[120:123], v[212:215]
    v_exp_f32 v210, v210
    v_mfma_f32_16x16x32_bf16 v[212:215], a[236:239], v[124:127], v[212:215]
    v_exp_f32 v211, v211
    v_mfma_f32_16x16x32_bf16 a[56:59], a[184:187], v[176:179], a[56:59]
    ds_read_b64_tr_b16 a[168:169], v25 offset:16384
    v_cvt_pk_bf16_f32 v146, v208, v209
    v_mfma_f32_16x16x32_bf16 a[56:59], a[188:191], v[180:183], a[56:59]
    ds_read_b64_tr_b16 a[170:171], v25 offset:20480
    v_mfma_f32_16x16x32_bf16 a[60:63], a[184:187], v[184:187], a[60:63]
    ds_read_b128 a[224:227], v8 offset:45056
    v_cvt_pk_bf16_f32 v147, v210, v211
    v_mfma_f32_16x16x32_bf16 a[60:63], a[188:191], v[188:191], a[60:63]
    s_waitcnt lgkmcnt(3)
    buffer_load_dwordx4 v40, s[12:15], s41 offen offset:2048 lds
    v_mfma_f32_16x16x32_bf16 v[208:211], a[208:211], v[64:67], v[192:195]
    v_exp_f32 v212, v212
    v_mfma_f32_16x16x32_bf16 v[208:211], a[212:215], v[68:71], v[208:211]
    v_exp_f32 v213, v213
    v_mfma_f32_16x16x32_bf16 v[208:211], a[216:219], v[72:75], v[208:211]
    v_exp_f32 v214, v214
    v_mfma_f32_16x16x32_bf16 v[208:211], a[220:223], v[76:79], v[208:211]
    v_exp_f32 v215, v215
    v_mfma_f32_16x16x32_bf16 a[64:67], a[160:163], v[160:163], a[64:67]
    ds_read_b64_tr_b16 a[172:173], v25 offset:24576
    v_cvt_pk_bf16_f32 v154, v212, v213
    v_mfma_f32_16x16x32_bf16 a[64:67], a[164:167], v[164:167], a[64:67]
    ds_read_b64_tr_b16 a[174:175], v25 offset:28672
    v_mfma_f32_16x16x32_bf16 a[68:71], a[160:163], v[168:171], a[68:71]
    ds_read_b128 a[228:231], v9 offset:45056
    v_cvt_pk_bf16_f32 v155, v214, v215
    v_mfma_f32_16x16x32_bf16 a[68:71], a[164:167], v[172:175], a[68:71]
    v_smfmac_f32_16x16x64_bf16 a[204:207], v[52:55], v[184:191], v50
    v_mfma_f32_16x16x32_bf16 v[212:215], a[208:211], v[80:83], v[196:199]
    v_exp_f32 v208, v208
    v_mfma_f32_16x16x32_bf16 v[212:215], a[212:215], v[84:87], v[212:215]
    v_exp_f32 v209, v209
    v_mfma_f32_16x16x32_bf16 v[212:215], a[216:219], v[88:91], v[212:215]
    v_exp_f32 v210, v210
    v_mfma_f32_16x16x32_bf16 v[212:215], a[220:223], v[92:95], v[212:215]
    v_exp_f32 v211, v211
    v_mfma_f32_16x16x32_bf16 a[72:75], a[160:163], v[176:179], a[72:75]
    ds_read_b64_tr_b16 a[176:177], v26 offset:16384
    v_cvt_pk_bf16_f32 v132, v208, v209
    v_mfma_f32_16x16x32_bf16 a[72:75], a[164:167], v[180:183], a[72:75]
    ds_read_b64_tr_b16 a[178:179], v26 offset:20480
    v_mfma_f32_16x16x32_bf16 a[76:79], a[160:163], v[184:187], a[76:79]
    ds_read_b128 a[232:235], v10 offset:45056
    v_cvt_pk_bf16_f32 v133, v210, v211
    v_mfma_f32_16x16x32_bf16 a[76:79], a[164:167], v[188:191], a[76:79]
    s_waitcnt lgkmcnt(3)
    buffer_load_dwordx4 v41, s[12:15], s41 offen offset:3072 lds
    v_mfma_f32_16x16x32_bf16 v[208:211], a[208:211], v[96:99], v[200:203]
    v_exp_f32 v212, v212
    v_mfma_f32_16x16x32_bf16 v[208:211], a[212:215], v[100:103], v[208:211]
    s_add_u32 s41, s41, 16384
    v_exp_f32 v213, v213
    v_mfma_f32_16x16x32_bf16 v[208:211], a[216:219], v[104:107], v[208:211]
    v_exp_f32 v214, v214
    v_mfma_f32_16x16x32_bf16 v[208:211], a[220:223], v[108:111], v[208:211]
    v_exp_f32 v215, v215
    v_mfma_f32_16x16x32_bf16 a[80:83], a[168:171], v[160:163], a[80:83]
    ds_read_b64_tr_b16 a[180:181], v26 offset:24576
    v_cvt_pk_bf16_f32 v140, v212, v213
    v_mfma_f32_16x16x32_bf16 a[80:83], a[172:175], v[164:167], a[80:83]
    ds_read_b64_tr_b16 a[182:183], v26 offset:28672
    v_mfma_f32_16x16x32_bf16 a[84:87], a[168:171], v[168:171], a[84:87]
    ds_read_b128 a[236:239], v11 offset:45056
    v_cvt_pk_bf16_f32 v141, v214, v215
    v_mfma_f32_16x16x32_bf16 a[84:87], a[172:175], v[172:175], a[84:87]
    s_waitcnt vmcnt(8)
    s_barrier
    v_mfma_f32_16x16x32_bf16 v[212:215], a[208:211], v[112:115], v[204:207]
    v_exp_f32 v208, v208
    v_mfma_f32_16x16x32_bf16 v[212:215], a[212:215], v[116:119], v[212:215]
    s_add_u32 m0, s42, 16384
    v_exp_f32 v209, v209
    v_mfma_f32_16x16x32_bf16 v[212:215], a[216:219], v[120:123], v[212:215]
    v_exp_f32 v210, v210
    v_mfma_f32_16x16x32_bf16 v[212:215], a[220:223], v[124:127], v[212:215]
    v_exp_f32 v211, v211
    v_mfma_f32_16x16x32_bf16 a[88:91], a[168:171], v[176:179], a[88:91]
    ds_read_b64_tr_b16 a[184:185], v27 offset:16384
    v_cvt_pk_bf16_f32 v148, v208, v209
    v_mfma_f32_16x16x32_bf16 a[88:91], a[172:175], v[180:183], a[88:91]
    ds_read_b64_tr_b16 a[186:187], v27 offset:20480
    v_mfma_f32_16x16x32_bf16 a[92:95], a[168:171], v[184:187], a[92:95]
    ds_read_b128 a[208:211], v8 offset:49152
    v_cvt_pk_bf16_f32 v149, v210, v211
    v_mfma_f32_16x16x32_bf16 a[92:95], a[172:175], v[188:191], a[92:95]
    s_waitcnt lgkmcnt(3)
    buffer_load_dwordx4 v36, s[8:11], s40 offen lds
    v_mfma_f32_16x16x32_bf16 v[208:211], a[224:227], v[64:67], v[192:195]
    v_exp_f32 v212, v212
    v_mfma_f32_16x16x32_bf16 v[208:211], a[228:231], v[68:71], v[208:211]
    v_exp_f32 v213, v213
    v_mfma_f32_16x16x32_bf16 v[208:211], a[232:235], v[72:75], v[208:211]
    v_exp_f32 v214, v214
    v_mfma_f32_16x16x32_bf16 v[208:211], a[236:239], v[76:79], v[208:211]
    v_exp_f32 v215, v215
    v_mfma_f32_16x16x32_bf16 a[96:99], a[176:179], v[160:163], a[96:99]
    ds_read_b64_tr_b16 a[188:189], v27 offset:24576
    v_cvt_pk_bf16_f32 v156, v212, v213
    v_mfma_f32_16x16x32_bf16 a[96:99], a[180:183], v[164:167], a[96:99]
    ds_read_b64_tr_b16 a[190:191], v27 offset:28672
    v_mfma_f32_16x16x32_bf16 a[100:103], a[176:179], v[168:171], a[100:103]
    ds_read_b128 a[212:215], v9 offset:49152
    v_cvt_pk_bf16_f32 v157, v214, v215
    v_mfma_f32_16x16x32_bf16 a[100:103], a[180:183], v[172:175], a[100:103]
    buffer_load_dword v218, v57, s[80:83], s39 offen
    v_mfma_f32_16x16x32_bf16 v[212:215], a[224:227], v[80:83], v[196:199]
    v_exp_f32 v208, v208
    v_mfma_f32_16x16x32_bf16 v[212:215], a[228:231], v[84:87], v[212:215]
    v_exp_f32 v209, v209
    v_mfma_f32_16x16x32_bf16 v[212:215], a[232:235], v[88:91], v[212:215]
    v_exp_f32 v210, v210
    v_mfma_f32_16x16x32_bf16 v[212:215], a[236:239], v[92:95], v[212:215]
    v_exp_f32 v211, v211
    v_mfma_f32_16x16x32_bf16 a[104:107], a[176:179], v[176:179], a[104:107]
    ds_read_b64_tr_b16 a[160:161], v20 offset:32768
    v_cvt_pk_bf16_f32 v134, v208, v209
    v_mfma_f32_16x16x32_bf16 a[104:107], a[180:183], v[180:183], a[104:107]
    ds_read_b64_tr_b16 a[162:163], v20 offset:36864
    v_mfma_f32_16x16x32_bf16 a[108:111], a[176:179], v[184:187], a[108:111]
    ds_read_b128 a[216:219], v10 offset:49152
    v_cvt_pk_bf16_f32 v135, v210, v211
    v_mfma_f32_16x16x32_bf16 a[108:111], a[180:183], v[188:191], a[108:111]
    s_waitcnt lgkmcnt(3)
    buffer_load_dwordx4 v37, s[8:11], s40 offen offset:1024 lds
    v_mfma_f32_16x16x32_bf16 v[208:211], a[224:227], v[96:99], v[200:203]
    v_exp_f32 v212, v212
    v_mfma_f32_16x16x32_bf16 v[208:211], a[228:231], v[100:103], v[208:211]
    v_exp_f32 v213, v213
    v_mfma_f32_16x16x32_bf16 v[208:211], a[232:235], v[104:107], v[208:211]
    v_exp_f32 v214, v214
    v_mfma_f32_16x16x32_bf16 v[208:211], a[236:239], v[108:111], v[208:211]
    v_exp_f32 v215, v215
    v_mfma_f32_16x16x32_bf16 a[112:115], a[184:187], v[160:163], a[112:115]
    ds_read_b64_tr_b16 a[164:165], v20 offset:40960
    v_cvt_pk_bf16_f32 v142, v212, v213
    v_mfma_f32_16x16x32_bf16 a[112:115], a[188:191], v[164:167], a[112:115]
    ds_read_b64_tr_b16 a[166:167], v20 offset:45056
    v_mfma_f32_16x16x32_bf16 a[116:119], a[184:187], v[168:171], a[116:119]
    ds_read_b128 a[220:223], v11 offset:49152
    v_cvt_pk_bf16_f32 v143, v214, v215
    v_mfma_f32_16x16x32_bf16 a[116:119], a[188:191], v[172:175], a[116:119]
    v_mfma_f32_16x16x32_bf16 v[212:215], a[224:227], v[112:115], v[204:207]
    v_exp_f32 v208, v208
    v_mfma_f32_16x16x32_bf16 v[212:215], a[228:231], v[116:119], v[212:215]
    v_exp_f32 v209, v209
    v_mfma_f32_16x16x32_bf16 v[212:215], a[232:235], v[120:123], v[212:215]
    v_exp_f32 v210, v210
    v_mfma_f32_16x16x32_bf16 v[212:215], a[236:239], v[124:127], v[212:215]
    v_exp_f32 v211, v211
    v_mfma_f32_16x16x32_bf16 a[120:123], a[184:187], v[176:179], a[120:123]
    ds_read_b64_tr_b16 a[168:169], v21 offset:32768
    v_cvt_pk_bf16_f32 v150, v208, v209
    v_mfma_f32_16x16x32_bf16 a[120:123], a[188:191], v[180:183], a[120:123]
    ds_read_b64_tr_b16 a[170:171], v21 offset:36864
    v_mfma_f32_16x16x32_bf16 a[124:127], a[184:187], v[184:187], a[124:127]
    ds_read_b128 a[224:227], v8 offset:53248
    v_cvt_pk_bf16_f32 v151, v210, v211
    v_mfma_f32_16x16x32_bf16 a[124:127], a[188:191], v[188:191], a[124:127]
    s_waitcnt lgkmcnt(3)
    buffer_load_dwordx4 v38, s[8:11], s40 offen offset:2048 lds
    v_mfma_f32_16x16x32_bf16 v[208:211], a[208:211], v[64:67], v[192:195]
    v_exp_f32 v212, v212
    v_mfma_f32_16x16x32_bf16 v[208:211], a[212:215], v[68:71], v[208:211]
    v_exp_f32 v213, v213
    v_mfma_f32_16x16x32_bf16 v[208:211], a[216:219], v[72:75], v[208:211]
    v_exp_f32 v214, v214
    v_mfma_f32_16x16x32_bf16 v[208:211], a[220:223], v[76:79], v[208:211]
    v_exp_f32 v215, v215
    v_mfma_f32_16x16x32_bf16 a[0:3], a[160:163], v[128:131], a[0:3]
    ds_read_b64_tr_b16 a[172:173], v21 offset:40960
    v_cvt_pk_bf16_f32 v158, v212, v213
    v_mfma_f32_16x16x32_bf16 a[0:3], a[164:167], v[132:135], a[0:3]
    ds_read_b64_tr_b16 a[174:175], v21 offset:45056
    v_mfma_f32_16x16x32_bf16 a[4:7], a[160:163], v[136:139], a[4:7]
    ds_read_b128 a[228:231], v9 offset:53248
    v_cvt_pk_bf16_f32 v159, v214, v215
    v_mfma_f32_16x16x32_bf16 a[4:7], a[164:167], v[140:143], a[4:7]
    v_mfma_f32_16x16x32_bf16 v[212:215], a[208:211], v[80:83], v[196:199]
    v_exp_f32 v208, v208
    v_mfma_f32_16x16x32_bf16 v[212:215], a[212:215], v[84:87], v[212:215]
    v_exp_f32 v209, v209
    v_mfma_f32_16x16x32_bf16 v[212:215], a[216:219], v[88:91], v[212:215]
    v_exp_f32 v210, v210
    v_mfma_f32_16x16x32_bf16 v[212:215], a[220:223], v[92:95], v[212:215]
    v_exp_f32 v211, v211
    v_mfma_f32_16x16x32_bf16 a[8:11], a[160:163], v[144:147], a[8:11]
    ds_read_b64_tr_b16 a[176:177], v22 offset:32768
    v_cvt_pk_bf16_f32 v160, v208, v209
    v_mfma_f32_16x16x32_bf16 a[8:11], a[164:167], v[148:151], a[8:11]
    ds_read_b64_tr_b16 a[178:179], v22 offset:36864
    v_mfma_f32_16x16x32_bf16 a[12:15], a[160:163], v[152:155], a[12:15]
    ds_read_b128 a[232:235], v10 offset:53248
    v_cvt_pk_bf16_f32 v161, v210, v211
    v_mfma_f32_16x16x32_bf16 a[12:15], a[164:167], v[156:159], a[12:15]
    s_waitcnt lgkmcnt(3)
    buffer_load_dwordx4 v39, s[8:11], s40 offen offset:3072 lds
    v_mfma_f32_16x16x32_bf16 v[208:211], a[208:211], v[96:99], v[200:203]
    v_exp_f32 v212, v212
    v_mfma_f32_16x16x32_bf16 v[208:211], a[212:215], v[100:103], v[208:211]
    s_add_u32 s40, s40, 16384
    v_exp_f32 v213, v213
    v_mfma_f32_16x16x32_bf16 v[208:211], a[216:219], v[104:107], v[208:211]
    v_exp_f32 v214, v214
    v_mfma_f32_16x16x32_bf16 v[208:211], a[220:223], v[108:111], v[208:211]
    v_exp_f32 v215, v215
    v_mfma_f32_16x16x32_bf16 a[16:19], a[168:171], v[128:131], a[16:19]
    ds_read_b64_tr_b16 a[180:181], v22 offset:40960
    v_cvt_pk_bf16_f32 v168, v212, v213
    v_mfma_f32_16x16x32_bf16 a[16:19], a[172:175], v[132:135], a[16:19]
    ds_read_b64_tr_b16 a[182:183], v22 offset:45056
    v_mfma_f32_16x16x32_bf16 a[20:23], a[168:171], v[136:139], a[20:23]
    ds_read_b128 a[236:239], v11 offset:53248
    v_cvt_pk_bf16_f32 v169, v214, v215
    v_mfma_f32_16x16x32_bf16 a[20:23], a[172:175], v[140:143], a[20:23]
    v_smfmac_f32_16x16x64_bf16 a[192:195], v[52:55], v[128:135], v50
    v_mfma_f32_16x16x32_bf16 v[212:215], a[208:211], v[112:115], v[204:207]
    v_exp_f32 v208, v208
    v_mfma_f32_16x16x32_bf16 v[212:215], a[212:215], v[116:119], v[212:215]
    s_add_u32 m0, s42, 65536
    v_exp_f32 v209, v209
    v_mfma_f32_16x16x32_bf16 v[212:215], a[216:219], v[120:123], v[212:215]
    v_exp_f32 v210, v210
    v_mfma_f32_16x16x32_bf16 v[212:215], a[220:223], v[124:127], v[212:215]
    v_exp_f32 v211, v211
    v_mfma_f32_16x16x32_bf16 a[24:27], a[168:171], v[144:147], a[24:27]
    ds_read_b64_tr_b16 a[184:185], v23 offset:32768
    v_cvt_pk_bf16_f32 v176, v208, v209
    v_mfma_f32_16x16x32_bf16 a[24:27], a[172:175], v[148:151], a[24:27]
    ds_read_b64_tr_b16 a[186:187], v23 offset:36864
    v_mfma_f32_16x16x32_bf16 a[28:31], a[168:171], v[152:155], a[28:31]
    ds_read_b128 a[208:211], v8 offset:57344
    v_cvt_pk_bf16_f32 v177, v210, v211
    v_mfma_f32_16x16x32_bf16 a[28:31], a[172:175], v[156:159], a[28:31]
    s_waitcnt lgkmcnt(3)
    buffer_load_dwordx4 v40, s[12:15], s41 offen lds
    v_mfma_f32_16x16x32_bf16 v[208:211], a[224:227], v[64:67], v[192:195]
    v_exp_f32 v212, v212
    v_mfma_f32_16x16x32_bf16 v[208:211], a[228:231], v[68:71], v[208:211]
    v_exp_f32 v213, v213
    v_mfma_f32_16x16x32_bf16 v[208:211], a[232:235], v[72:75], v[208:211]
    v_exp_f32 v214, v214
    v_mfma_f32_16x16x32_bf16 v[208:211], a[236:239], v[76:79], v[208:211]
    v_exp_f32 v215, v215
    v_mfma_f32_16x16x32_bf16 a[32:35], a[176:179], v[128:131], a[32:35]
    ds_read_b64_tr_b16 a[188:189], v23 offset:40960
    v_cvt_pk_bf16_f32 v184, v212, v213
    v_mfma_f32_16x16x32_bf16 a[32:35], a[180:183], v[132:135], a[32:35]
    ds_read_b64_tr_b16 a[190:191], v23 offset:45056
    v_mfma_f32_16x16x32_bf16 a[36:39], a[176:179], v[136:139], a[36:39]
    ds_read_b128 a[212:215], v9 offset:57344
    v_cvt_pk_bf16_f32 v185, v214, v215
    v_mfma_f32_16x16x32_bf16 a[36:39], a[180:183], v[140:143], a[36:39]
    v_smfmac_f32_16x16x64_bf16 a[196:199], v[52:55], v[136:143], v50
    v_mfma_f32_16x16x32_bf16 v[212:215], a[224:227], v[80:83], v[196:199]
    v_exp_f32 v208, v208
    v_mfma_f32_16x16x32_bf16 v[212:215], a[228:231], v[84:87], v[212:215]
    v_exp_f32 v209, v209
    v_mfma_f32_16x16x32_bf16 v[212:215], a[232:235], v[88:91], v[212:215]
    v_exp_f32 v210, v210
    v_mfma_f32_16x16x32_bf16 v[212:215], a[236:239], v[92:95], v[212:215]
    v_exp_f32 v211, v211
    v_mfma_f32_16x16x32_bf16 a[40:43], a[176:179], v[144:147], a[40:43]
    ds_read_b64_tr_b16 a[160:161], v24 offset:32768
    v_cvt_pk_bf16_f32 v162, v208, v209
    v_mfma_f32_16x16x32_bf16 a[40:43], a[180:183], v[148:151], a[40:43]
    ds_read_b64_tr_b16 a[162:163], v24 offset:36864
    v_mfma_f32_16x16x32_bf16 a[44:47], a[176:179], v[152:155], a[44:47]
    ds_read_b128 a[216:219], v10 offset:57344
    v_cvt_pk_bf16_f32 v163, v210, v211
    v_mfma_f32_16x16x32_bf16 a[44:47], a[180:183], v[156:159], a[44:47]
    s_waitcnt lgkmcnt(3)
    buffer_load_dwordx4 v41, s[12:15], s41 offen offset:1024 lds
    v_mfma_f32_16x16x32_bf16 v[208:211], a[224:227], v[96:99], v[200:203]
    v_exp_f32 v212, v212
    v_mfma_f32_16x16x32_bf16 v[208:211], a[228:231], v[100:103], v[208:211]
    v_exp_f32 v213, v213
    v_mfma_f32_16x16x32_bf16 v[208:211], a[232:235], v[104:107], v[208:211]
    v_exp_f32 v214, v214
    v_mfma_f32_16x16x32_bf16 v[208:211], a[236:239], v[108:111], v[208:211]
    v_exp_f32 v215, v215
    v_mfma_f32_16x16x32_bf16 a[48:51], a[184:187], v[128:131], a[48:51]
    ds_read_b64_tr_b16 a[164:165], v24 offset:40960
    v_cvt_pk_bf16_f32 v170, v212, v213
    v_mfma_f32_16x16x32_bf16 a[48:51], a[188:191], v[132:135], a[48:51]
    ds_read_b64_tr_b16 a[166:167], v24 offset:45056
    v_mfma_f32_16x16x32_bf16 a[52:55], a[184:187], v[136:139], a[52:55]
    ds_read_b128 a[220:223], v11 offset:57344
    v_cvt_pk_bf16_f32 v171, v214, v215
    v_mfma_f32_16x16x32_bf16 a[52:55], a[188:191], v[140:143], a[52:55]
    v_smfmac_f32_16x16x64_bf16 a[200:203], v[52:55], v[144:151], v50
    v_mfma_f32_16x16x32_bf16 v[212:215], a[224:227], v[112:115], v[204:207]
    v_exp_f32 v208, v208
    v_mfma_f32_16x16x32_bf16 v[212:215], a[228:231], v[116:119], v[212:215]
    v_exp_f32 v209, v209
    v_mfma_f32_16x16x32_bf16 v[212:215], a[232:235], v[120:123], v[212:215]
    v_exp_f32 v210, v210
    v_mfma_f32_16x16x32_bf16 v[212:215], a[236:239], v[124:127], v[212:215]
    v_exp_f32 v211, v211
    v_mfma_f32_16x16x32_bf16 a[56:59], a[184:187], v[144:147], a[56:59]
    ds_read_b64_tr_b16 a[168:169], v25 offset:32768
    v_cvt_pk_bf16_f32 v178, v208, v209
    v_mfma_f32_16x16x32_bf16 a[56:59], a[188:191], v[148:151], a[56:59]
    ds_read_b64_tr_b16 a[170:171], v25 offset:36864
    v_mfma_f32_16x16x32_bf16 a[60:63], a[184:187], v[152:155], a[60:63]
    ds_read_b128 a[224:227], v8 offset:61440
    v_cvt_pk_bf16_f32 v179, v210, v211
    v_mfma_f32_16x16x32_bf16 a[60:63], a[188:191], v[156:159], a[60:63]
    s_waitcnt lgkmcnt(3)
    buffer_load_dwordx4 v40, s[12:15], s41 offen offset:2048 lds
    v_mfma_f32_16x16x32_bf16 v[208:211], a[208:211], v[64:67], v[192:195]
    v_exp_f32 v212, v212
    v_mfma_f32_16x16x32_bf16 v[208:211], a[212:215], v[68:71], v[208:211]
    v_exp_f32 v213, v213
    v_mfma_f32_16x16x32_bf16 v[208:211], a[216:219], v[72:75], v[208:211]
    v_exp_f32 v214, v214
    v_mfma_f32_16x16x32_bf16 v[208:211], a[220:223], v[76:79], v[208:211]
    v_exp_f32 v215, v215
    v_mfma_f32_16x16x32_bf16 a[64:67], a[160:163], v[128:131], a[64:67]
    ds_read_b64_tr_b16 a[172:173], v25 offset:40960
    v_cvt_pk_bf16_f32 v186, v212, v213
    v_mfma_f32_16x16x32_bf16 a[64:67], a[164:167], v[132:135], a[64:67]
    ds_read_b64_tr_b16 a[174:175], v25 offset:45056
    v_mfma_f32_16x16x32_bf16 a[68:71], a[160:163], v[136:139], a[68:71]
    ds_read_b128 a[228:231], v9 offset:61440
    v_cvt_pk_bf16_f32 v187, v214, v215
    v_mfma_f32_16x16x32_bf16 a[68:71], a[164:167], v[140:143], a[68:71]
    v_smfmac_f32_16x16x64_bf16 a[204:207], v[52:55], v[152:159], v50
    v_mfma_f32_16x16x32_bf16 v[212:215], a[208:211], v[80:83], v[196:199]
    v_exp_f32 v208, v208
    v_mfma_f32_16x16x32_bf16 v[212:215], a[212:215], v[84:87], v[212:215]
    v_exp_f32 v209, v209
    v_mfma_f32_16x16x32_bf16 v[212:215], a[216:219], v[88:91], v[212:215]
    v_exp_f32 v210, v210
    v_mfma_f32_16x16x32_bf16 v[212:215], a[220:223], v[92:95], v[212:215]
    v_exp_f32 v211, v211
    v_mfma_f32_16x16x32_bf16 a[72:75], a[160:163], v[144:147], a[72:75]
    ds_read_b64_tr_b16 a[176:177], v26 offset:32768
    v_cvt_pk_bf16_f32 v164, v208, v209
    v_mfma_f32_16x16x32_bf16 a[72:75], a[164:167], v[148:151], a[72:75]
    ds_read_b64_tr_b16 a[178:179], v26 offset:36864
    v_mfma_f32_16x16x32_bf16 a[76:79], a[160:163], v[152:155], a[76:79]
    ds_read_b128 a[232:235], v10 offset:61440
    v_cvt_pk_bf16_f32 v165, v210, v211
    v_mfma_f32_16x16x32_bf16 a[76:79], a[164:167], v[156:159], a[76:79]
    s_waitcnt lgkmcnt(3)
    buffer_load_dwordx4 v41, s[12:15], s41 offen offset:3072 lds
    v_mfma_f32_16x16x32_bf16 v[208:211], a[208:211], v[96:99], v[200:203]
    v_exp_f32 v212, v212
    v_mfma_f32_16x16x32_bf16 v[208:211], a[212:215], v[100:103], v[208:211]
    s_add_u32 s41, s41, 16384
    v_exp_f32 v213, v213
    v_mfma_f32_16x16x32_bf16 v[208:211], a[216:219], v[104:107], v[208:211]
    v_exp_f32 v214, v214
    v_mfma_f32_16x16x32_bf16 v[208:211], a[220:223], v[108:111], v[208:211]
    v_exp_f32 v215, v215
    v_mfma_f32_16x16x32_bf16 a[80:83], a[168:171], v[128:131], a[80:83]
    ds_read_b64_tr_b16 a[180:181], v26 offset:40960
    v_cvt_pk_bf16_f32 v172, v212, v213
    v_mfma_f32_16x16x32_bf16 a[80:83], a[172:175], v[132:135], a[80:83]
    ds_read_b64_tr_b16 a[182:183], v26 offset:45056
    v_mfma_f32_16x16x32_bf16 a[84:87], a[168:171], v[136:139], a[84:87]
    ds_read_b128 a[236:239], v11 offset:61440
    v_cvt_pk_bf16_f32 v173, v214, v215
    v_mfma_f32_16x16x32_bf16 a[84:87], a[172:175], v[140:143], a[84:87]
    s_waitcnt vmcnt(9)
    s_barrier
    v_mfma_f32_16x16x32_bf16 v[212:215], a[208:211], v[112:115], v[204:207]
    v_exp_f32 v208, v208
    v_mfma_f32_16x16x32_bf16 v[212:215], a[212:215], v[116:119], v[212:215]
    s_add_u32 m0, s42, 32768
    v_exp_f32 v209, v209
    v_mfma_f32_16x16x32_bf16 v[212:215], a[216:219], v[120:123], v[212:215]
    v_exp_f32 v210, v210
    v_mfma_f32_16x16x32_bf16 v[212:215], a[220:223], v[124:127], v[212:215]
    v_exp_f32 v211, v211
    v_mfma_f32_16x16x32_bf16 a[88:91], a[168:171], v[144:147], a[88:91]
    ds_read_b64_tr_b16 a[184:185], v27 offset:32768
    v_cvt_pk_bf16_f32 v180, v208, v209
    v_mfma_f32_16x16x32_bf16 a[88:91], a[172:175], v[148:151], a[88:91]
    ds_read_b64_tr_b16 a[186:187], v27 offset:36864
    v_mfma_f32_16x16x32_bf16 a[92:95], a[168:171], v[152:155], a[92:95]
    ds_read_b128 a[208:211], v8 offset:0
    v_cvt_pk_bf16_f32 v181, v210, v211
    v_mfma_f32_16x16x32_bf16 a[92:95], a[172:175], v[156:159], a[92:95]
    s_waitcnt lgkmcnt(3)
    buffer_load_dwordx4 v36, s[8:11], s40 offen lds
    v_mfma_f32_16x16x32_bf16 v[208:211], a[224:227], v[64:67], v[192:195]
    v_exp_f32 v212, v212
    v_mfma_f32_16x16x32_bf16 v[208:211], a[228:231], v[68:71], v[208:211]
    v_exp_f32 v213, v213
    v_mfma_f32_16x16x32_bf16 v[208:211], a[232:235], v[72:75], v[208:211]
    v_exp_f32 v214, v214
    v_mfma_f32_16x16x32_bf16 v[208:211], a[236:239], v[76:79], v[208:211]
    v_exp_f32 v215, v215
    v_mfma_f32_16x16x32_bf16 a[96:99], a[176:179], v[128:131], a[96:99]
    ds_read_b64_tr_b16 a[188:189], v27 offset:40960
    v_cvt_pk_bf16_f32 v188, v212, v213
    v_mfma_f32_16x16x32_bf16 a[96:99], a[180:183], v[132:135], a[96:99]
    ds_read_b64_tr_b16 a[190:191], v27 offset:45056
    v_mfma_f32_16x16x32_bf16 a[100:103], a[176:179], v[136:139], a[100:103]
    ds_read_b128 a[212:215], v9 offset:0
    v_cvt_pk_bf16_f32 v189, v214, v215
    v_mfma_f32_16x16x32_bf16 a[100:103], a[180:183], v[140:143], a[100:103]
    buffer_load_dword v219, v62, s[84:87], s38 offen
    v_mfma_f32_16x16x32_bf16 v[212:215], a[224:227], v[80:83], v[196:199]
    v_exp_f32 v208, v208
    v_mfma_f32_16x16x32_bf16 v[212:215], a[228:231], v[84:87], v[212:215]
    v_exp_f32 v209, v209
    v_mfma_f32_16x16x32_bf16 v[212:215], a[232:235], v[88:91], v[212:215]
    v_exp_f32 v210, v210
    v_mfma_f32_16x16x32_bf16 v[212:215], a[236:239], v[92:95], v[212:215]
    v_exp_f32 v211, v211
    v_mfma_f32_16x16x32_bf16 a[104:107], a[176:179], v[144:147], a[104:107]
    ds_read_b64_tr_b16 a[160:161], v20 offset:49152
    v_cvt_pk_bf16_f32 v166, v208, v209
    v_mfma_f32_16x16x32_bf16 a[104:107], a[180:183], v[148:151], a[104:107]
    ds_read_b64_tr_b16 a[162:163], v20 offset:53248
    v_mfma_f32_16x16x32_bf16 a[108:111], a[176:179], v[152:155], a[108:111]
    ds_read_b128 a[216:219], v10 offset:0
    v_cvt_pk_bf16_f32 v167, v210, v211
    v_mfma_f32_16x16x32_bf16 a[108:111], a[180:183], v[156:159], a[108:111]
    s_waitcnt lgkmcnt(3)
    buffer_load_dwordx4 v37, s[8:11], s40 offen offset:1024 lds
    v_mfma_f32_16x16x32_bf16 v[208:211], a[224:227], v[96:99], v[200:203]
    v_exp_f32 v212, v212
    v_mfma_f32_16x16x32_bf16 v[208:211], a[228:231], v[100:103], v[208:211]
    v_exp_f32 v213, v213
    v_mfma_f32_16x16x32_bf16 v[208:211], a[232:235], v[104:107], v[208:211]
    v_exp_f32 v214, v214
    v_mfma_f32_16x16x32_bf16 v[208:211], a[236:239], v[108:111], v[208:211]
    v_exp_f32 v215, v215
    v_mfma_f32_16x16x32_bf16 a[112:115], a[184:187], v[128:131], a[112:115]
    ds_read_b64_tr_b16 a[164:165], v20 offset:57344
    v_cvt_pk_bf16_f32 v174, v212, v213
    v_mfma_f32_16x16x32_bf16 a[112:115], a[188:191], v[132:135], a[112:115]
    ds_read_b64_tr_b16 a[166:167], v20 offset:61440
    v_mfma_f32_16x16x32_bf16 a[116:119], a[184:187], v[136:139], a[116:119]
    ds_read_b128 a[220:223], v11 offset:0
    v_cvt_pk_bf16_f32 v175, v214, v215
    v_mfma_f32_16x16x32_bf16 a[116:119], a[188:191], v[140:143], a[116:119]
    v_mfma_f32_16x16x32_bf16 v[212:215], a[224:227], v[112:115], v[204:207]
    v_exp_f32 v208, v208
    v_mfma_f32_16x16x32_bf16 v[212:215], a[228:231], v[116:119], v[212:215]
    v_exp_f32 v209, v209
    v_mfma_f32_16x16x32_bf16 v[212:215], a[232:235], v[120:123], v[212:215]
    v_exp_f32 v210, v210
    v_mfma_f32_16x16x32_bf16 v[212:215], a[236:239], v[124:127], v[212:215]
    v_exp_f32 v211, v211
    v_mfma_f32_16x16x32_bf16 a[120:123], a[184:187], v[144:147], a[120:123]
    ds_read_b64_tr_b16 a[168:169], v21 offset:49152
    v_cvt_pk_bf16_f32 v182, v208, v209
    v_mfma_f32_16x16x32_bf16 a[120:123], a[188:191], v[148:151], a[120:123]
    ds_read_b64_tr_b16 a[170:171], v21 offset:53248
    v_mfma_f32_16x16x32_bf16 a[124:127], a[184:187], v[152:155], a[124:127]
    ds_read_b128 a[224:227], v8 offset:4096
    v_cvt_pk_bf16_f32 v183, v210, v211
    v_mfma_f32_16x16x32_bf16 a[124:127], a[188:191], v[156:159], a[124:127]
    s_waitcnt lgkmcnt(3)
    buffer_load_dwordx4 v38, s[8:11], s40 offen offset:2048 lds
    v_mfma_f32_16x16x32_bf16 v[208:211], a[208:211], v[64:67], v[192:195]
    v_exp_f32 v212, v212
    v_mfma_f32_16x16x32_bf16 v[208:211], a[212:215], v[68:71], v[208:211]
    v_exp_f32 v213, v213
    v_mfma_f32_16x16x32_bf16 v[208:211], a[216:219], v[72:75], v[208:211]
    v_exp_f32 v214, v214
    v_mfma_f32_16x16x32_bf16 v[208:211], a[220:223], v[76:79], v[208:211]
    v_exp_f32 v215, v215
    v_mfma_f32_16x16x32_bf16 a[0:3], a[160:163], v[160:163], a[0:3]
    ds_read_b64_tr_b16 a[172:173], v21 offset:57344
    v_cvt_pk_bf16_f32 v190, v212, v213
    v_mfma_f32_16x16x32_bf16 a[0:3], a[164:167], v[164:167], a[0:3]
    ds_read_b64_tr_b16 a[174:175], v21 offset:61440
    v_mfma_f32_16x16x32_bf16 a[4:7], a[160:163], v[168:171], a[4:7]
    ds_read_b128 a[228:231], v9 offset:4096
    v_cvt_pk_bf16_f32 v191, v214, v215
    v_mfma_f32_16x16x32_bf16 a[4:7], a[164:167], v[172:175], a[4:7]
    v_mfma_f32_16x16x32_bf16 v[212:215], a[208:211], v[80:83], v[196:199]
    v_exp_f32 v208, v208
    v_mfma_f32_16x16x32_bf16 v[212:215], a[212:215], v[84:87], v[212:215]
    v_exp_f32 v209, v209
    v_mfma_f32_16x16x32_bf16 v[212:215], a[216:219], v[88:91], v[212:215]
    v_exp_f32 v210, v210
    v_mfma_f32_16x16x32_bf16 v[212:215], a[220:223], v[92:95], v[212:215]
    v_exp_f32 v211, v211
    v_mfma_f32_16x16x32_bf16 a[8:11], a[160:163], v[176:179], a[8:11]
    ds_read_b64_tr_b16 a[176:177], v22 offset:49152
    v_cvt_pk_bf16_f32 v128, v208, v209
    v_mfma_f32_16x16x32_bf16 a[8:11], a[164:167], v[180:183], a[8:11]
    ds_read_b64_tr_b16 a[178:179], v22 offset:53248
    v_mfma_f32_16x16x32_bf16 a[12:15], a[160:163], v[184:187], a[12:15]
    ds_read_b128 a[232:235], v10 offset:4096
    v_cvt_pk_bf16_f32 v129, v210, v211
    v_mfma_f32_16x16x32_bf16 a[12:15], a[164:167], v[188:191], a[12:15]
    s_waitcnt lgkmcnt(3)
    buffer_load_dwordx4 v39, s[8:11], s40 offen offset:3072 lds
    v_mfma_f32_16x16x32_bf16 v[208:211], a[208:211], v[96:99], v[200:203]
    v_exp_f32 v212, v212
    v_mfma_f32_16x16x32_bf16 v[208:211], a[212:215], v[100:103], v[208:211]
    s_add_u32 s40, s40, 16384
    v_exp_f32 v213, v213
    v_mfma_f32_16x16x32_bf16 v[208:211], a[216:219], v[104:107], v[208:211]
    v_exp_f32 v214, v214
    v_mfma_f32_16x16x32_bf16 v[208:211], a[220:223], v[108:111], v[208:211]
    v_exp_f32 v215, v215
    v_mfma_f32_16x16x32_bf16 a[16:19], a[168:171], v[160:163], a[16:19]
    ds_read_b64_tr_b16 a[180:181], v22 offset:57344
    v_cvt_pk_bf16_f32 v136, v212, v213
    v_mfma_f32_16x16x32_bf16 a[16:19], a[172:175], v[164:167], a[16:19]
    ds_read_b64_tr_b16 a[182:183], v22 offset:61440
    v_mfma_f32_16x16x32_bf16 a[20:23], a[168:171], v[168:171], a[20:23]
    ds_read_b128 a[236:239], v11 offset:4096
    v_cvt_pk_bf16_f32 v137, v214, v215
    v_mfma_f32_16x16x32_bf16 a[20:23], a[172:175], v[172:175], a[20:23]
    v_smfmac_f32_16x16x64_bf16 a[192:195], v[52:55], v[160:167], v50
    v_mfma_f32_16x16x32_bf16 v[212:215], a[208:211], v[112:115], v[204:207]
    v_exp_f32 v208, v208
    v_mfma_f32_16x16x32_bf16 v[212:215], a[212:215], v[116:119], v[212:215]
    s_add_u32 m0, s42, 81920
    v_exp_f32 v209, v209
    v_mfma_f32_16x16x32_bf16 v[212:215], a[216:219], v[120:123], v[212:215]
    v_exp_f32 v210, v210
    v_mfma_f32_16x16x32_bf16 v[212:215], a[220:223], v[124:127], v[212:215]
    v_exp_f32 v211, v211
    v_mfma_f32_16x16x32_bf16 a[24:27], a[168:171], v[176:179], a[24:27]
    ds_read_b64_tr_b16 a[184:185], v23 offset:49152
    v_cvt_pk_bf16_f32 v144, v208, v209
    v_mfma_f32_16x16x32_bf16 a[24:27], a[172:175], v[180:183], a[24:27]
    ds_read_b64_tr_b16 a[186:187], v23 offset:53248
    v_mfma_f32_16x16x32_bf16 a[28:31], a[168:171], v[184:187], a[28:31]
    ds_read_b128 a[208:211], v8 offset:8192
    v_cvt_pk_bf16_f32 v145, v210, v211
    v_mfma_f32_16x16x32_bf16 a[28:31], a[172:175], v[188:191], a[28:31]
    s_waitcnt lgkmcnt(3)
    buffer_load_dwordx4 v40, s[12:15], s41 offen lds
    v_mfma_f32_16x16x32_bf16 v[208:211], a[224:227], v[64:67], v[192:195]
    v_exp_f32 v212, v212
    v_mfma_f32_16x16x32_bf16 v[208:211], a[228:231], v[68:71], v[208:211]
    v_exp_f32 v213, v213
    v_mfma_f32_16x16x32_bf16 v[208:211], a[232:235], v[72:75], v[208:211]
    v_exp_f32 v214, v214
    v_mfma_f32_16x16x32_bf16 v[208:211], a[236:239], v[76:79], v[208:211]
    v_exp_f32 v215, v215
    v_mfma_f32_16x16x32_bf16 a[32:35], a[176:179], v[160:163], a[32:35]
    ds_read_b64_tr_b16 a[188:189], v23 offset:57344
    v_cvt_pk_bf16_f32 v152, v212, v213
    v_mfma_f32_16x16x32_bf16 a[32:35], a[180:183], v[164:167], a[32:35]
    ds_read_b64_tr_b16 a[190:191], v23 offset:61440
    v_mfma_f32_16x16x32_bf16 a[36:39], a[176:179], v[168:171], a[36:39]
    ds_read_b128 a[212:215], v9 offset:8192
    v_cvt_pk_bf16_f32 v153, v214, v215
    v_mfma_f32_16x16x32_bf16 a[36:39], a[180:183], v[172:175], a[36:39]
    v_smfmac_f32_16x16x64_bf16 a[196:199], v[52:55], v[168:175], v50
    v_mfma_f32_16x16x32_bf16 v[212:215], a[224:227], v[80:83], v[196:199]
    v_exp_f32 v208, v208
    v_mfma_f32_16x16x32_bf16 v[212:215], a[228:231], v[84:87], v[212:215]
    v_exp_f32 v209, v209
    v_mfma_f32_16x16x32_bf16 v[212:215], a[232:235], v[88:91], v[212:215]
    v_exp_f32 v210, v210
    v_mfma_f32_16x16x32_bf16 v[212:215], a[236:239], v[92:95], v[212:215]
    v_exp_f32 v211, v211
    v_mfma_f32_16x16x32_bf16 a[40:43], a[176:179], v[176:179], a[40:43]
    ds_read_b64_tr_b16 a[160:161], v24 offset:49152
    v_cvt_pk_bf16_f32 v130, v208, v209
    v_mfma_f32_16x16x32_bf16 a[40:43], a[180:183], v[180:183], a[40:43]
    ds_read_b64_tr_b16 a[162:163], v24 offset:53248
    v_mfma_f32_16x16x32_bf16 a[44:47], a[176:179], v[184:187], a[44:47]
    ds_read_b128 a[216:219], v10 offset:8192
    v_cvt_pk_bf16_f32 v131, v210, v211
    v_mfma_f32_16x16x32_bf16 a[44:47], a[180:183], v[188:191], a[44:47]
    s_waitcnt lgkmcnt(3)
    buffer_load_dwordx4 v41, s[12:15], s41 offen offset:1024 lds
    v_mfma_f32_16x16x32_bf16 v[208:211], a[224:227], v[96:99], v[200:203]
    v_exp_f32 v212, v212
    v_mfma_f32_16x16x32_bf16 v[208:211], a[228:231], v[100:103], v[208:211]
    v_exp_f32 v213, v213
    v_mfma_f32_16x16x32_bf16 v[208:211], a[232:235], v[104:107], v[208:211]
    v_exp_f32 v214, v214
    v_mfma_f32_16x16x32_bf16 v[208:211], a[236:239], v[108:111], v[208:211]
    v_exp_f32 v215, v215
    v_mfma_f32_16x16x32_bf16 a[48:51], a[184:187], v[160:163], a[48:51]
    ds_read_b64_tr_b16 a[164:165], v24 offset:57344
    v_cvt_pk_bf16_f32 v138, v212, v213
    v_mfma_f32_16x16x32_bf16 a[48:51], a[188:191], v[164:167], a[48:51]
    ds_read_b64_tr_b16 a[166:167], v24 offset:61440
    v_mfma_f32_16x16x32_bf16 a[52:55], a[184:187], v[168:171], a[52:55]
    ds_read_b128 a[220:223], v11 offset:8192
    v_cvt_pk_bf16_f32 v139, v214, v215
    v_mfma_f32_16x16x32_bf16 a[52:55], a[188:191], v[172:175], a[52:55]
    v_smfmac_f32_16x16x64_bf16 a[200:203], v[52:55], v[176:183], v50
    v_mfma_f32_16x16x32_bf16 v[212:215], a[224:227], v[112:115], v[204:207]
    v_exp_f32 v208, v208
    v_mfma_f32_16x16x32_bf16 v[212:215], a[228:231], v[116:119], v[212:215]
    v_exp_f32 v209, v209
    v_mfma_f32_16x16x32_bf16 v[212:215], a[232:235], v[120:123], v[212:215]
    v_exp_f32 v210, v210
    v_mfma_f32_16x16x32_bf16 v[212:215], a[236:239], v[124:127], v[212:215]
    v_exp_f32 v211, v211
    v_mfma_f32_16x16x32_bf16 a[56:59], a[184:187], v[176:179], a[56:59]
    ds_read_b64_tr_b16 a[168:169], v25 offset:49152
    v_cvt_pk_bf16_f32 v146, v208, v209
    v_mfma_f32_16x16x32_bf16 a[56:59], a[188:191], v[180:183], a[56:59]
    ds_read_b64_tr_b16 a[170:171], v25 offset:53248
    v_mfma_f32_16x16x32_bf16 a[60:63], a[184:187], v[184:187], a[60:63]
    ds_read_b128 a[224:227], v8 offset:12288
    v_cvt_pk_bf16_f32 v147, v210, v211
    v_mfma_f32_16x16x32_bf16 a[60:63], a[188:191], v[188:191], a[60:63]
    s_waitcnt lgkmcnt(3)
    buffer_load_dwordx4 v40, s[12:15], s41 offen offset:2048 lds
    v_mfma_f32_16x16x32_bf16 v[208:211], a[208:211], v[64:67], v[192:195]
    v_exp_f32 v212, v212
    v_mfma_f32_16x16x32_bf16 v[208:211], a[212:215], v[68:71], v[208:211]
    v_exp_f32 v213, v213
    v_mfma_f32_16x16x32_bf16 v[208:211], a[216:219], v[72:75], v[208:211]
    v_exp_f32 v214, v214
    v_mfma_f32_16x16x32_bf16 v[208:211], a[220:223], v[76:79], v[208:211]
    v_exp_f32 v215, v215
    v_mfma_f32_16x16x32_bf16 a[64:67], a[160:163], v[160:163], a[64:67]
    ds_read_b64_tr_b16 a[172:173], v25 offset:57344
    v_cvt_pk_bf16_f32 v154, v212, v213
    v_mfma_f32_16x16x32_bf16 a[64:67], a[164:167], v[164:167], a[64:67]
    ds_read_b64_tr_b16 a[174:175], v25 offset:61440
    v_mfma_f32_16x16x32_bf16 a[68:71], a[160:163], v[168:171], a[68:71]
    ds_read_b128 a[228:231], v9 offset:12288
    v_cvt_pk_bf16_f32 v155, v214, v215
    v_mfma_f32_16x16x32_bf16 a[68:71], a[164:167], v[172:175], a[68:71]
    v_smfmac_f32_16x16x64_bf16 a[204:207], v[52:55], v[184:191], v50
    v_mfma_f32_16x16x32_bf16 v[212:215], a[208:211], v[80:83], v[196:199]
    v_exp_f32 v208, v208
    v_mfma_f32_16x16x32_bf16 v[212:215], a[212:215], v[84:87], v[212:215]
    v_exp_f32 v209, v209
    v_mfma_f32_16x16x32_bf16 v[212:215], a[216:219], v[88:91], v[212:215]
    v_exp_f32 v210, v210
    v_mfma_f32_16x16x32_bf16 v[212:215], a[220:223], v[92:95], v[212:215]
    v_exp_f32 v211, v211
    v_mfma_f32_16x16x32_bf16 a[72:75], a[160:163], v[176:179], a[72:75]
    ds_read_b64_tr_b16 a[176:177], v26 offset:49152
    v_cvt_pk_bf16_f32 v132, v208, v209
    v_mfma_f32_16x16x32_bf16 a[72:75], a[164:167], v[180:183], a[72:75]
    ds_read_b64_tr_b16 a[178:179], v26 offset:53248
    v_mfma_f32_16x16x32_bf16 a[76:79], a[160:163], v[184:187], a[76:79]
    ds_read_b128 a[232:235], v10 offset:12288
    v_cvt_pk_bf16_f32 v133, v210, v211
    v_mfma_f32_16x16x32_bf16 a[76:79], a[164:167], v[188:191], a[76:79]
    s_waitcnt lgkmcnt(3)
    buffer_load_dwordx4 v41, s[12:15], s41 offen offset:3072 lds
    v_mfma_f32_16x16x32_bf16 v[208:211], a[208:211], v[96:99], v[200:203]
    v_exp_f32 v212, v212
    v_mfma_f32_16x16x32_bf16 v[208:211], a[212:215], v[100:103], v[208:211]
    s_add_u32 s41, s41, 16384
    v_exp_f32 v213, v213
    v_mfma_f32_16x16x32_bf16 v[208:211], a[216:219], v[104:107], v[208:211]
    v_exp_f32 v214, v214
    v_mfma_f32_16x16x32_bf16 v[208:211], a[220:223], v[108:111], v[208:211]
    v_exp_f32 v215, v215
    v_mfma_f32_16x16x32_bf16 a[80:83], a[168:171], v[160:163], a[80:83]
    ds_read_b64_tr_b16 a[180:181], v26 offset:57344
    v_cvt_pk_bf16_f32 v140, v212, v213
    v_mfma_f32_16x16x32_bf16 a[80:83], a[172:175], v[164:167], a[80:83]
    ds_read_b64_tr_b16 a[182:183], v26 offset:61440
    v_mfma_f32_16x16x32_bf16 a[84:87], a[168:171], v[168:171], a[84:87]
    ds_read_b128 a[236:239], v11 offset:12288
    v_cvt_pk_bf16_f32 v141, v214, v215
    v_mfma_f32_16x16x32_bf16 a[84:87], a[172:175], v[172:175], a[84:87]
    s_waitcnt vmcnt(9)
    s_barrier
    v_mfma_f32_16x16x32_bf16 v[212:215], a[208:211], v[112:115], v[204:207]
    v_exp_f32 v208, v208
    v_mfma_f32_16x16x32_bf16 v[212:215], a[212:215], v[116:119], v[212:215]
    s_add_u32 m0, s42, 49152
    v_exp_f32 v209, v209
    v_mfma_f32_16x16x32_bf16 v[212:215], a[216:219], v[120:123], v[212:215]
    v_exp_f32 v210, v210
    v_mfma_f32_16x16x32_bf16 v[212:215], a[220:223], v[124:127], v[212:215]
    v_exp_f32 v211, v211
    v_mfma_f32_16x16x32_bf16 a[88:91], a[168:171], v[176:179], a[88:91]
    ds_read_b64_tr_b16 a[184:185], v27 offset:49152
    v_cvt_pk_bf16_f32 v148, v208, v209
    v_mfma_f32_16x16x32_bf16 a[88:91], a[172:175], v[180:183], a[88:91]
    ds_read_b64_tr_b16 a[186:187], v27 offset:53248
    v_mfma_f32_16x16x32_bf16 a[92:95], a[168:171], v[184:187], a[92:95]
    ds_read_b128 a[208:211], v8 offset:16384
    v_cvt_pk_bf16_f32 v149, v210, v211
    v_mfma_f32_16x16x32_bf16 a[92:95], a[172:175], v[188:191], a[92:95]
    s_waitcnt lgkmcnt(3)
    buffer_load_dwordx4 v36, s[8:11], s40 offen lds
    v_mfma_f32_16x16x32_bf16 v[208:211], a[224:227], v[64:67], v[192:195]
    v_exp_f32 v212, v212
    v_mfma_f32_16x16x32_bf16 v[208:211], a[228:231], v[68:71], v[208:211]
    v_exp_f32 v213, v213
    v_mfma_f32_16x16x32_bf16 v[208:211], a[232:235], v[72:75], v[208:211]
    v_exp_f32 v214, v214
    v_mfma_f32_16x16x32_bf16 v[208:211], a[236:239], v[76:79], v[208:211]
    v_exp_f32 v215, v215
    v_mfma_f32_16x16x32_bf16 a[96:99], a[176:179], v[160:163], a[96:99]
    ds_read_b64_tr_b16 a[188:189], v27 offset:57344
    v_cvt_pk_bf16_f32 v156, v212, v213
    v_mfma_f32_16x16x32_bf16 a[96:99], a[180:183], v[164:167], a[96:99]
    ds_read_b64_tr_b16 a[190:191], v27 offset:61440
    v_mfma_f32_16x16x32_bf16 a[100:103], a[176:179], v[168:171], a[100:103]
    ds_read_b128 a[212:215], v9 offset:16384
    v_cvt_pk_bf16_f32 v157, v214, v215
    v_mfma_f32_16x16x32_bf16 a[100:103], a[180:183], v[172:175], a[100:103]
    buffer_load_dword v216, v237, s[28:31], s52 offen
    v_mfma_f32_16x16x32_bf16 v[212:215], a[224:227], v[80:83], v[196:199]
    v_exp_f32 v208, v208
    v_mfma_f32_16x16x32_bf16 v[212:215], a[228:231], v[84:87], v[212:215]
    s_sub_u32 s39, s39, 36864
    v_exp_f32 v209, v209
    v_mfma_f32_16x16x32_bf16 v[212:215], a[232:235], v[88:91], v[212:215]
    s_sub_u32 s38, s38, 4608
    v_exp_f32 v210, v210
    v_mfma_f32_16x16x32_bf16 v[212:215], a[236:239], v[92:95], v[212:215]
    s_add_u32 s52, s52, 2304
    v_exp_f32 v211, v211
    v_mfma_f32_16x16x32_bf16 a[104:107], a[176:179], v[176:179], a[104:107]
    ds_read_b64_tr_b16 a[160:161], v20 offset:0
    v_cvt_pk_bf16_f32 v134, v208, v209
    v_mfma_f32_16x16x32_bf16 a[104:107], a[180:183], v[180:183], a[104:107]
    ds_read_b64_tr_b16 a[162:163], v20 offset:4096
    v_mfma_f32_16x16x32_bf16 a[108:111], a[176:179], v[184:187], a[108:111]
    ds_read_b128 a[216:219], v10 offset:16384
    v_cvt_pk_bf16_f32 v135, v210, v211
    v_mfma_f32_16x16x32_bf16 a[108:111], a[180:183], v[188:191], a[108:111]
    s_waitcnt lgkmcnt(3)
    buffer_load_dwordx4 v37, s[8:11], s40 offen offset:1024 lds
    v_mfma_f32_16x16x32_bf16 v[208:211], a[224:227], v[96:99], v[200:203]
    v_exp_f32 v212, v212
    v_mfma_f32_16x16x32_bf16 v[208:211], a[228:231], v[100:103], v[208:211]
    v_exp_f32 v213, v213
    v_mfma_f32_16x16x32_bf16 v[208:211], a[232:235], v[104:107], v[208:211]
    v_exp_f32 v214, v214
    v_mfma_f32_16x16x32_bf16 v[208:211], a[236:239], v[108:111], v[208:211]
    v_exp_f32 v215, v215
    v_mfma_f32_16x16x32_bf16 a[112:115], a[184:187], v[160:163], a[112:115]
    ds_read_b64_tr_b16 a[164:165], v20 offset:8192
    v_cvt_pk_bf16_f32 v142, v212, v213
    v_mfma_f32_16x16x32_bf16 a[112:115], a[188:191], v[164:167], a[112:115]
    ds_read_b64_tr_b16 a[166:167], v20 offset:12288
    v_mfma_f32_16x16x32_bf16 a[116:119], a[184:187], v[168:171], a[116:119]
    ds_read_b128 a[220:223], v11 offset:16384
    v_cvt_pk_bf16_f32 v143, v214, v215
    v_mfma_f32_16x16x32_bf16 a[116:119], a[188:191], v[172:175], a[116:119]
    v_mfma_f32_16x16x32_bf16 v[212:215], a[224:227], v[112:115], v[204:207]
    v_exp_f32 v208, v208
    v_mfma_f32_16x16x32_bf16 v[212:215], a[228:231], v[116:119], v[212:215]
    v_exp_f32 v209, v209
    v_mfma_f32_16x16x32_bf16 v[212:215], a[232:235], v[120:123], v[212:215]
    v_exp_f32 v210, v210
    v_mfma_f32_16x16x32_bf16 v[212:215], a[236:239], v[124:127], v[212:215]
    v_exp_f32 v211, v211
    v_mfma_f32_16x16x32_bf16 a[120:123], a[184:187], v[176:179], a[120:123]
    ds_read_b64_tr_b16 a[168:169], v21 offset:0
    v_cvt_pk_bf16_f32 v150, v208, v209
    v_mfma_f32_16x16x32_bf16 a[120:123], a[188:191], v[180:183], a[120:123]
    ds_read_b64_tr_b16 a[170:171], v21 offset:4096
    v_mfma_f32_16x16x32_bf16 a[124:127], a[184:187], v[184:187], a[124:127]
    ds_read_b128 a[224:227], v8 offset:20480
    v_cvt_pk_bf16_f32 v151, v210, v211
    v_mfma_f32_16x16x32_bf16 a[124:127], a[188:191], v[188:191], a[124:127]
    s_waitcnt lgkmcnt(3)
    buffer_load_dwordx4 v38, s[8:11], s40 offen offset:2048 lds
    s_sub_u32 s43, s43, 1
    s_cmp_lg_u32 s43, 0
    s_cbranch_scc1 Lattn_loop
    v_mfma_f32_16x16x32_bf16 v[208:211], a[208:211], v[64:67], v[192:195]
    v_exp_f32 v212, v212
    v_mfma_f32_16x16x32_bf16 v[208:211], a[212:215], v[68:71], v[208:211]
    v_exp_f32 v213, v213
    v_mfma_f32_16x16x32_bf16 v[208:211], a[216:219], v[72:75], v[208:211]
    v_exp_f32 v214, v214
    v_mfma_f32_16x16x32_bf16 v[208:211], a[220:223], v[76:79], v[208:211]
    s_add_u32 s57, s58, 0
    v_exp_f32 v215, v215
    v_mfma_f32_16x16x32_bf16 a[0:3], a[160:163], v[128:131], a[0:3]
    ds_read_b64_tr_b16 a[172:173], v21 offset:8192
    v_cvt_pk_bf16_f32 v158, v212, v213
    v_mfma_f32_16x16x32_bf16 a[0:3], a[164:167], v[132:135], a[0:3]
    ds_read_b64_tr_b16 a[174:175], v21 offset:12288
    v_mfma_f32_16x16x32_bf16 a[4:7], a[160:163], v[136:139], a[4:7]
    ds_read_b128 a[228:231], v9 offset:20480
    v_cvt_pk_bf16_f32 v159, v214, v215
    v_mfma_f32_16x16x32_bf16 a[4:7], a[164:167], v[140:143], a[4:7]
    buffer_load_dwordx4 a[128:131], v254, s[80:83], s57 offen
    v_mfma_f32_16x16x32_bf16 v[212:215], a[208:211], v[80:83], v[196:199]
    v_exp_f32 v208, v208
    v_mfma_f32_16x16x32_bf16 v[212:215], a[212:215], v[84:87], v[212:215]
    v_exp_f32 v209, v209
    v_mfma_f32_16x16x32_bf16 v[212:215], a[216:219], v[88:91], v[212:215]
    v_exp_f32 v210, v210
    v_mfma_f32_16x16x32_bf16 v[212:215], a[220:223], v[92:95], v[212:215]
    v_exp_f32 v211, v211
    v_mfma_f32_16x16x32_bf16 a[8:11], a[160:163], v[144:147], a[8:11]
    ds_read_b64_tr_b16 a[176:177], v22 offset:0
    v_cvt_pk_bf16_f32 v160, v208, v209
    v_mfma_f32_16x16x32_bf16 a[8:11], a[164:167], v[148:151], a[8:11]
    ds_read_b64_tr_b16 a[178:179], v22 offset:4096
    v_mfma_f32_16x16x32_bf16 a[12:15], a[160:163], v[152:155], a[12:15]
    ds_read_b128 a[232:235], v10 offset:20480
    v_cvt_pk_bf16_f32 v161, v210, v211
    v_mfma_f32_16x16x32_bf16 a[12:15], a[164:167], v[156:159], a[12:15]
    s_waitcnt lgkmcnt(3)
    buffer_load_dwordx4 v39, s[8:11], s40 offen offset:3072 lds
    v_mfma_f32_16x16x32_bf16 v[208:211], a[208:211], v[96:99], v[200:203]
    v_exp_f32 v212, v212
    v_mfma_f32_16x16x32_bf16 v[208:211], a[212:215], v[100:103], v[208:211]
    s_add_u32 s40, s40, 16384
    v_exp_f32 v213, v213
    v_mfma_f32_16x16x32_bf16 v[208:211], a[216:219], v[104:107], v[208:211]
    v_exp_f32 v214, v214
    v_mfma_f32_16x16x32_bf16 v[208:211], a[220:223], v[108:111], v[208:211]
    v_exp_f32 v215, v215
    v_mfma_f32_16x16x32_bf16 a[16:19], a[168:171], v[128:131], a[16:19]
    ds_read_b64_tr_b16 a[180:181], v22 offset:8192
    v_cvt_pk_bf16_f32 v168, v212, v213
    v_mfma_f32_16x16x32_bf16 a[16:19], a[172:175], v[132:135], a[16:19]
    ds_read_b64_tr_b16 a[182:183], v22 offset:12288
    v_mfma_f32_16x16x32_bf16 a[20:23], a[168:171], v[136:139], a[20:23]
    ds_read_b128 a[236:239], v11 offset:20480
    v_cvt_pk_bf16_f32 v169, v214, v215
    v_mfma_f32_16x16x32_bf16 a[20:23], a[172:175], v[140:143], a[20:23]
    v_smfmac_f32_16x16x64_bf16 a[192:195], v[52:55], v[128:135], v50
    v_mfma_f32_16x16x32_bf16 v[212:215], a[208:211], v[112:115], v[204:207]
    v_exp_f32 v208, v208
    v_mfma_f32_16x16x32_bf16 v[212:215], a[212:215], v[116:119], v[212:215]
    s_add_u32 m0, s42, 98304
    v_exp_f32 v209, v209
    v_mfma_f32_16x16x32_bf16 v[212:215], a[216:219], v[120:123], v[212:215]
    v_exp_f32 v210, v210
    v_mfma_f32_16x16x32_bf16 v[212:215], a[220:223], v[124:127], v[212:215]
    v_exp_f32 v211, v211
    v_mfma_f32_16x16x32_bf16 a[24:27], a[168:171], v[144:147], a[24:27]
    ds_read_b64_tr_b16 a[184:185], v23 offset:0
    v_cvt_pk_bf16_f32 v176, v208, v209
    v_mfma_f32_16x16x32_bf16 a[24:27], a[172:175], v[148:151], a[24:27]
    ds_read_b64_tr_b16 a[186:187], v23 offset:4096
    v_mfma_f32_16x16x32_bf16 a[28:31], a[168:171], v[152:155], a[28:31]
    ds_read_b128 a[208:211], v8 offset:24576
    v_cvt_pk_bf16_f32 v177, v210, v211
    v_mfma_f32_16x16x32_bf16 a[28:31], a[172:175], v[156:159], a[28:31]
    s_waitcnt lgkmcnt(3)
    buffer_load_dwordx4 v40, s[12:15], s41 offen lds
    v_mfma_f32_16x16x32_bf16 v[208:211], a[224:227], v[64:67], v[192:195]
    v_exp_f32 v212, v212
    v_mfma_f32_16x16x32_bf16 v[208:211], a[228:231], v[68:71], v[208:211]
    v_exp_f32 v213, v213
    v_mfma_f32_16x16x32_bf16 v[208:211], a[232:235], v[72:75], v[208:211]
    v_exp_f32 v214, v214
    v_mfma_f32_16x16x32_bf16 v[208:211], a[236:239], v[76:79], v[208:211]
    s_add_u32 s57, s58, 589824
    v_exp_f32 v215, v215
    v_mfma_f32_16x16x32_bf16 a[32:35], a[176:179], v[128:131], a[32:35]
    ds_read_b64_tr_b16 a[188:189], v23 offset:8192
    v_cvt_pk_bf16_f32 v184, v212, v213
    v_mfma_f32_16x16x32_bf16 a[32:35], a[180:183], v[132:135], a[32:35]
    ds_read_b64_tr_b16 a[190:191], v23 offset:12288
    v_mfma_f32_16x16x32_bf16 a[36:39], a[176:179], v[136:139], a[36:39]
    ds_read_b128 a[212:215], v9 offset:24576
    v_cvt_pk_bf16_f32 v185, v214, v215
    v_mfma_f32_16x16x32_bf16 a[36:39], a[180:183], v[140:143], a[36:39]
    buffer_load_dwordx4 a[132:135], v254, s[80:83], s57 offen
    v_smfmac_f32_16x16x64_bf16 a[196:199], v[52:55], v[136:143], v50
    v_mfma_f32_16x16x32_bf16 v[212:215], a[224:227], v[80:83], v[196:199]
    v_exp_f32 v208, v208
    v_mfma_f32_16x16x32_bf16 v[212:215], a[228:231], v[84:87], v[212:215]
    v_exp_f32 v209, v209
    v_mfma_f32_16x16x32_bf16 v[212:215], a[232:235], v[88:91], v[212:215]
    s_mul_i32 s37, s5, 18432
    v_exp_f32 v210, v210
    v_mfma_f32_16x16x32_bf16 v[212:215], a[236:239], v[92:95], v[212:215]
    s_add_u32 s37, s37, s45
    v_exp_f32 v211, v211
    v_mfma_f32_16x16x32_bf16 a[40:43], a[176:179], v[144:147], a[40:43]
    ds_read_b64_tr_b16 a[160:161], v24 offset:0
    v_cvt_pk_bf16_f32 v162, v208, v209
    v_mfma_f32_16x16x32_bf16 a[40:43], a[180:183], v[148:151], a[40:43]
    ds_read_b64_tr_b16 a[162:163], v24 offset:4096
    v_mfma_f32_16x16x32_bf16 a[44:47], a[176:179], v[152:155], a[44:47]
    ds_read_b128 a[216:219], v10 offset:24576
    v_cvt_pk_bf16_f32 v163, v210, v211
    v_mfma_f32_16x16x32_bf16 a[44:47], a[180:183], v[156:159], a[44:47]
    s_waitcnt lgkmcnt(3)
    buffer_load_dwordx4 v41, s[12:15], s41 offen offset:1024 lds
    v_mfma_f32_16x16x32_bf16 v[208:211], a[224:227], v[96:99], v[200:203]
    v_exp_f32 v212, v212
    v_mfma_f32_16x16x32_bf16 v[208:211], a[228:231], v[100:103], v[208:211]
    v_exp_f32 v213, v213
    v_mfma_f32_16x16x32_bf16 v[208:211], a[232:235], v[104:107], v[208:211]
    v_exp_f32 v214, v214
    v_mfma_f32_16x16x32_bf16 v[208:211], a[236:239], v[108:111], v[208:211]
    v_exp_f32 v215, v215
    v_mfma_f32_16x16x32_bf16 a[48:51], a[184:187], v[128:131], a[48:51]
    ds_read_b64_tr_b16 a[164:165], v24 offset:8192
    v_cvt_pk_bf16_f32 v170, v212, v213
    v_mfma_f32_16x16x32_bf16 a[48:51], a[188:191], v[132:135], a[48:51]
    ds_read_b64_tr_b16 a[166:167], v24 offset:12288
    v_mfma_f32_16x16x32_bf16 a[52:55], a[184:187], v[136:139], a[52:55]
    ds_read_b128 a[220:223], v11 offset:24576
    v_cvt_pk_bf16_f32 v171, v214, v215
    v_mfma_f32_16x16x32_bf16 a[52:55], a[188:191], v[140:143], a[52:55]
    buffer_load_dword v221, v236, s[20:23], s37 offen
    v_smfmac_f32_16x16x64_bf16 a[200:203], v[52:55], v[144:151], v50
    v_mfma_f32_16x16x32_bf16 v[212:215], a[224:227], v[112:115], v[204:207]
    v_exp_f32 v208, v208
    v_mfma_f32_16x16x32_bf16 v[212:215], a[228:231], v[116:119], v[212:215]
    v_exp_f32 v209, v209
    v_mfma_f32_16x16x32_bf16 v[212:215], a[232:235], v[120:123], v[212:215]
    v_exp_f32 v210, v210
    v_mfma_f32_16x16x32_bf16 v[212:215], a[236:239], v[124:127], v[212:215]
    v_exp_f32 v211, v211
    v_mfma_f32_16x16x32_bf16 a[56:59], a[184:187], v[144:147], a[56:59]
    ds_read_b64_tr_b16 a[168:169], v25 offset:0
    v_cvt_pk_bf16_f32 v178, v208, v209
    v_mfma_f32_16x16x32_bf16 a[56:59], a[188:191], v[148:151], a[56:59]
    ds_read_b64_tr_b16 a[170:171], v25 offset:4096
    v_mfma_f32_16x16x32_bf16 a[60:63], a[184:187], v[152:155], a[60:63]
    ds_read_b128 a[224:227], v8 offset:28672
    v_cvt_pk_bf16_f32 v179, v210, v211
    v_mfma_f32_16x16x32_bf16 a[60:63], a[188:191], v[156:159], a[60:63]
    s_waitcnt lgkmcnt(3)
    buffer_load_dwordx4 v40, s[12:15], s41 offen offset:2048 lds
    v_mfma_f32_16x16x32_bf16 v[208:211], a[208:211], v[64:67], v[192:195]
    v_exp_f32 v212, v212
    v_mfma_f32_16x16x32_bf16 v[208:211], a[212:215], v[68:71], v[208:211]
    v_exp_f32 v213, v213
    v_mfma_f32_16x16x32_bf16 v[208:211], a[216:219], v[72:75], v[208:211]
    v_exp_f32 v214, v214
    v_mfma_f32_16x16x32_bf16 v[208:211], a[220:223], v[76:79], v[208:211]
    s_add_u32 s57, s58, 1179648
    v_exp_f32 v215, v215
    v_mfma_f32_16x16x32_bf16 a[64:67], a[160:163], v[128:131], a[64:67]
    ds_read_b64_tr_b16 a[172:173], v25 offset:8192
    v_cvt_pk_bf16_f32 v186, v212, v213
    v_mfma_f32_16x16x32_bf16 a[64:67], a[164:167], v[132:135], a[64:67]
    ds_read_b64_tr_b16 a[174:175], v25 offset:12288
    v_mfma_f32_16x16x32_bf16 a[68:71], a[160:163], v[136:139], a[68:71]
    ds_read_b128 a[228:231], v9 offset:28672
    v_cvt_pk_bf16_f32 v187, v214, v215
    v_mfma_f32_16x16x32_bf16 a[68:71], a[164:167], v[140:143], a[68:71]
    buffer_load_dwordx4 a[136:139], v254, s[80:83], s57 offen
    v_smfmac_f32_16x16x64_bf16 a[204:207], v[52:55], v[152:159], v50
    v_mfma_f32_16x16x32_bf16 v[212:215], a[208:211], v[80:83], v[196:199]
    v_exp_f32 v208, v208
    v_mfma_f32_16x16x32_bf16 v[212:215], a[212:215], v[84:87], v[212:215]
    v_exp_f32 v209, v209
    v_mfma_f32_16x16x32_bf16 v[212:215], a[216:219], v[88:91], v[212:215]
    v_exp_f32 v210, v210
    v_mfma_f32_16x16x32_bf16 v[212:215], a[220:223], v[92:95], v[212:215]
    v_exp_f32 v211, v211
    v_mfma_f32_16x16x32_bf16 a[72:75], a[160:163], v[144:147], a[72:75]
    ds_read_b64_tr_b16 a[176:177], v26 offset:0
    v_cvt_pk_bf16_f32 v164, v208, v209
    v_mfma_f32_16x16x32_bf16 a[72:75], a[164:167], v[148:151], a[72:75]
    ds_read_b64_tr_b16 a[178:179], v26 offset:4096
    v_mfma_f32_16x16x32_bf16 a[76:79], a[160:163], v[152:155], a[76:79]
    ds_read_b128 a[232:235], v10 offset:28672
    v_cvt_pk_bf16_f32 v165, v210, v211
    v_mfma_f32_16x16x32_bf16 a[76:79], a[164:167], v[156:159], a[76:79]
    s_waitcnt lgkmcnt(3)
    buffer_load_dwordx4 v41, s[12:15], s41 offen offset:3072 lds
    v_mfma_f32_16x16x32_bf16 v[208:211], a[208:211], v[96:99], v[200:203]
    v_exp_f32 v212, v212
    v_mfma_f32_16x16x32_bf16 v[208:211], a[212:215], v[100:103], v[208:211]
    s_add_u32 s41, s41, 16384
    v_exp_f32 v213, v213
    v_mfma_f32_16x16x32_bf16 v[208:211], a[216:219], v[104:107], v[208:211]
    v_exp_f32 v214, v214
    v_mfma_f32_16x16x32_bf16 v[208:211], a[220:223], v[108:111], v[208:211]
    v_exp_f32 v215, v215
    v_mfma_f32_16x16x32_bf16 a[80:83], a[168:171], v[128:131], a[80:83]
    ds_read_b64_tr_b16 a[180:181], v26 offset:8192
    v_cvt_pk_bf16_f32 v172, v212, v213
    v_mfma_f32_16x16x32_bf16 a[80:83], a[172:175], v[132:135], a[80:83]
    ds_read_b64_tr_b16 a[182:183], v26 offset:12288
    v_mfma_f32_16x16x32_bf16 a[84:87], a[168:171], v[136:139], a[84:87]
    ds_read_b128 a[236:239], v11 offset:28672
    v_cvt_pk_bf16_f32 v173, v214, v215
    v_mfma_f32_16x16x32_bf16 a[84:87], a[172:175], v[140:143], a[84:87]
    s_waitcnt vmcnt(13)
    s_barrier
    v_mfma_f32_16x16x32_bf16 v[212:215], a[208:211], v[112:115], v[204:207]
    v_exp_f32 v208, v208
    v_mfma_f32_16x16x32_bf16 v[212:215], a[212:215], v[116:119], v[212:215]
    s_add_u32 s49, s45, 1024
    v_exp_f32 v209, v209
    v_mfma_f32_16x16x32_bf16 v[212:215], a[216:219], v[120:123], v[212:215]
    s_add_u32 m0, s42, 0
    v_exp_f32 v210, v210
    v_mfma_f32_16x16x32_bf16 v[212:215], a[220:223], v[124:127], v[212:215]
    v_exp_f32 v211, v211
    v_mfma_f32_16x16x32_bf16 a[88:91], a[168:171], v[144:147], a[88:91]
    ds_read_b64_tr_b16 a[184:185], v27 offset:0
    v_cvt_pk_bf16_f32 v180, v208, v209
    v_mfma_f32_16x16x32_bf16 a[88:91], a[172:175], v[148:151], a[88:91]
    ds_read_b64_tr_b16 a[186:187], v27 offset:4096
    v_mfma_f32_16x16x32_bf16 a[92:95], a[168:171], v[152:155], a[92:95]
    ds_read_b128 a[208:211], v8 offset:32768
    v_cvt_pk_bf16_f32 v181, v210, v211
    v_mfma_f32_16x16x32_bf16 a[92:95], a[172:175], v[156:159], a[92:95]
    s_waitcnt lgkmcnt(3)
    buffer_load_dwordx4 v46, s[20:23], s49 offen lds
    v_mfma_f32_16x16x32_bf16 v[208:211], a[224:227], v[64:67], v[192:195]
    v_exp_f32 v212, v212
    v_mfma_f32_16x16x32_bf16 v[208:211], a[228:231], v[68:71], v[208:211]
    v_exp_f32 v213, v213
    v_mfma_f32_16x16x32_bf16 v[208:211], a[232:235], v[72:75], v[208:211]
    v_exp_f32 v214, v214
    v_mfma_f32_16x16x32_bf16 v[208:211], a[236:239], v[76:79], v[208:211]
    s_add_u32 s37, s55, 0
    v_exp_f32 v215, v215
    v_mfma_f32_16x16x32_bf16 a[96:99], a[176:179], v[128:131], a[96:99]
    ds_read_b64_tr_b16 a[188:189], v27 offset:8192
    v_cvt_pk_bf16_f32 v188, v212, v213
    v_mfma_f32_16x16x32_bf16 a[96:99], a[180:183], v[132:135], a[96:99]
    ds_read_b64_tr_b16 a[190:191], v27 offset:12288
    v_mfma_f32_16x16x32_bf16 a[100:103], a[176:179], v[136:139], a[100:103]
    ds_read_b128 a[212:215], v9 offset:32768
    v_cvt_pk_bf16_f32 v189, v214, v215
    v_mfma_f32_16x16x32_bf16 a[100:103], a[180:183], v[140:143], a[100:103]
    buffer_load_dword v239, v238, s[28:31], s37 offen
    v_mfma_f32_16x16x32_bf16 v[212:215], a[224:227], v[80:83], v[196:199]
    v_exp_f32 v208, v208
    v_mfma_f32_16x16x32_bf16 v[212:215], a[228:231], v[84:87], v[212:215]
    v_exp_f32 v209, v209
    v_mfma_f32_16x16x32_bf16 v[212:215], a[232:235], v[88:91], v[212:215]
    v_exp_f32 v210, v210
    v_mfma_f32_16x16x32_bf16 v[212:215], a[236:239], v[92:95], v[212:215]
    v_exp_f32 v211, v211
    v_mfma_f32_16x16x32_bf16 a[104:107], a[176:179], v[144:147], a[104:107]
    ds_read_b64_tr_b16 a[160:161], v20 offset:16384
    v_cvt_pk_bf16_f32 v166, v208, v209
    v_mfma_f32_16x16x32_bf16 a[104:107], a[180:183], v[148:151], a[104:107]
    ds_read_b64_tr_b16 a[162:163], v20 offset:20480
    v_mfma_f32_16x16x32_bf16 a[108:111], a[176:179], v[152:155], a[108:111]
    ds_read_b128 a[216:219], v10 offset:32768
    v_cvt_pk_bf16_f32 v167, v210, v211
    v_mfma_f32_16x16x32_bf16 a[108:111], a[180:183], v[156:159], a[108:111]
    s_waitcnt lgkmcnt(3)
    buffer_load_dwordx4 v47, s[20:23], s49 offen offset:1024 lds
    v_mfma_f32_16x16x32_bf16 v[208:211], a[224:227], v[96:99], v[200:203]
    v_exp_f32 v212, v212
    v_mfma_f32_16x16x32_bf16 v[208:211], a[228:231], v[100:103], v[208:211]
    v_exp_f32 v213, v213
    v_mfma_f32_16x16x32_bf16 v[208:211], a[232:235], v[104:107], v[208:211]
    v_exp_f32 v214, v214
    v_mfma_f32_16x16x32_bf16 v[208:211], a[236:239], v[108:111], v[208:211]
    s_add_u32 s57, s58, 1769472
    v_exp_f32 v215, v215
    v_mfma_f32_16x16x32_bf16 a[112:115], a[184:187], v[128:131], a[112:115]
    ds_read_b64_tr_b16 a[164:165], v20 offset:24576
    v_cvt_pk_bf16_f32 v174, v212, v213
    v_mfma_f32_16x16x32_bf16 a[112:115], a[188:191], v[132:135], a[112:115]
    ds_read_b64_tr_b16 a[166:167], v20 offset:28672
    v_mfma_f32_16x16x32_bf16 a[116:119], a[184:187], v[136:139], a[116:119]
    ds_read_b128 a[220:223], v11 offset:32768
    v_cvt_pk_bf16_f32 v175, v214, v215
    v_mfma_f32_16x16x32_bf16 a[116:119], a[188:191], v[140:143], a[116:119]
    buffer_load_dwordx4 a[140:143], v254, s[80:83], s57 offen
    v_mfma_f32_16x16x32_bf16 v[212:215], a[224:227], v[112:115], v[204:207]
    v_exp_f32 v208, v208
    v_mfma_f32_16x16x32_bf16 v[212:215], a[228:231], v[116:119], v[212:215]
    v_exp_f32 v209, v209
    v_mfma_f32_16x16x32_bf16 v[212:215], a[232:235], v[120:123], v[212:215]
    v_exp_f32 v210, v210
    v_mfma_f32_16x16x32_bf16 v[212:215], a[236:239], v[124:127], v[212:215]
    v_exp_f32 v211, v211
    v_mfma_f32_16x16x32_bf16 a[120:123], a[184:187], v[144:147], a[120:123]
    ds_read_b64_tr_b16 a[168:169], v21 offset:16384
    v_cvt_pk_bf16_f32 v182, v208, v209
    v_mfma_f32_16x16x32_bf16 a[120:123], a[188:191], v[148:151], a[120:123]
    ds_read_b64_tr_b16 a[170:171], v21 offset:20480
    v_mfma_f32_16x16x32_bf16 a[124:127], a[184:187], v[152:155], a[124:127]
    ds_read_b128 a[224:227], v8 offset:36864
    v_cvt_pk_bf16_f32 v183, v210, v211
    v_mfma_f32_16x16x32_bf16 a[124:127], a[188:191], v[156:159], a[124:127]
    s_waitcnt lgkmcnt(3)
    buffer_load_dwordx4 v48, s[20:23], s49 offen offset:2048 lds
    v_mfma_f32_16x16x32_bf16 v[208:211], a[208:211], v[64:67], v[192:195]
    v_exp_f32 v212, v212
    v_mfma_f32_16x16x32_bf16 v[208:211], a[212:215], v[68:71], v[208:211]
    v_exp_f32 v213, v213
    v_mfma_f32_16x16x32_bf16 v[208:211], a[216:219], v[72:75], v[208:211]
    v_exp_f32 v214, v214
    v_mfma_f32_16x16x32_bf16 v[208:211], a[220:223], v[76:79], v[208:211]
    s_add_u32 s57, s58, 2359296
    v_exp_f32 v215, v215
    v_mfma_f32_16x16x32_bf16 a[0:3], a[160:163], v[160:163], a[0:3]
    ds_read_b64_tr_b16 a[172:173], v21 offset:24576
    v_cvt_pk_bf16_f32 v190, v212, v213
    v_mfma_f32_16x16x32_bf16 a[0:3], a[164:167], v[164:167], a[0:3]
    ds_read_b64_tr_b16 a[174:175], v21 offset:28672
    v_mov_b32 v63, 0
    v_mfma_f32_16x16x32_bf16 a[4:7], a[160:163], v[168:171], a[4:7]
    ds_read_b128 a[228:231], v9 offset:36864
    v_cvt_pk_bf16_f32 v191, v214, v215
    v_mfma_f32_16x16x32_bf16 a[4:7], a[164:167], v[172:175], a[4:7]
    buffer_load_dwordx4 a[144:147], v254, s[80:83], s57 offen
    v_mfma_f32_16x16x32_bf16 v[212:215], a[208:211], v[80:83], v[196:199]
    v_exp_f32 v208, v208
    v_mfma_f32_16x16x32_bf16 v[212:215], a[212:215], v[84:87], v[212:215]
    v_exp_f32 v209, v209
    v_mfma_f32_16x16x32_bf16 v[212:215], a[216:219], v[88:91], v[212:215]
    v_exp_f32 v210, v210
    v_mfma_f32_16x16x32_bf16 v[212:215], a[220:223], v[92:95], v[212:215]
    v_exp_f32 v211, v211
    v_mfma_f32_16x16x32_bf16 a[8:11], a[160:163], v[176:179], a[8:11]
    ds_read_b64_tr_b16 a[176:177], v22 offset:16384
    v_cvt_pk_bf16_f32 v128, v208, v209
    v_mfma_f32_16x16x32_bf16 a[8:11], a[164:167], v[180:183], a[8:11]
    ds_read_b64_tr_b16 a[178:179], v22 offset:20480
    v_mfma_f32_16x16x32_bf16 a[12:15], a[160:163], v[184:187], a[12:15]
    ds_read_b128 a[232:235], v10 offset:36864
    v_cvt_pk_bf16_f32 v129, v210, v211
    v_mfma_f32_16x16x32_bf16 a[12:15], a[164:167], v[188:191], a[12:15]
    s_waitcnt lgkmcnt(3)
    buffer_load_dwordx4 v49, s[20:23], s49 offen offset:3072 lds
    v_mfma_f32_16x16x32_bf16 v[208:211], a[208:211], v[96:99], v[200:203]
    v_exp_f32 v212, v212
    v_mfma_f32_16x16x32_bf16 v[208:211], a[212:215], v[100:103], v[208:211]
    v_exp_f32 v213, v213
    v_mfma_f32_16x16x32_bf16 v[208:211], a[216:219], v[104:107], v[208:211]
    v_exp_f32 v214, v214
    v_mfma_f32_16x16x32_bf16 v[208:211], a[220:223], v[108:111], v[208:211]
    v_exp_f32 v215, v215
    v_mfma_f32_16x16x32_bf16 a[16:19], a[168:171], v[160:163], a[16:19]
    ds_read_b64_tr_b16 a[180:181], v22 offset:24576
    v_cvt_pk_bf16_f32 v136, v212, v213
    v_mfma_f32_16x16x32_bf16 a[16:19], a[172:175], v[164:167], a[16:19]
    ds_read_b64_tr_b16 a[182:183], v22 offset:28672
    v_mfma_f32_16x16x32_bf16 a[20:23], a[168:171], v[168:171], a[20:23]
    ds_read_b128 a[236:239], v11 offset:36864
    v_cvt_pk_bf16_f32 v137, v214, v215
    v_mfma_f32_16x16x32_bf16 a[20:23], a[172:175], v[172:175], a[20:23]
    buffer_load_dword v253, v63, s[24:27], s54 offen offset:12 sc1
    v_smfmac_f32_16x16x64_bf16 a[192:195], v[52:55], v[160:167], v50
    v_mfma_f32_16x16x32_bf16 v[212:215], a[208:211], v[112:115], v[204:207]
    v_exp_f32 v208, v208
    v_mfma_f32_16x16x32_bf16 v[212:215], a[212:215], v[116:119], v[212:215]
    s_add_u32 m0, s42, 114688
    v_exp_f32 v209, v209
    v_mfma_f32_16x16x32_bf16 v[212:215], a[216:219], v[120:123], v[212:215]
    v_exp_f32 v210, v210
    v_mfma_f32_16x16x32_bf16 v[212:215], a[220:223], v[124:127], v[212:215]
    v_exp_f32 v211, v211
    v_mfma_f32_16x16x32_bf16 a[24:27], a[168:171], v[176:179], a[24:27]
    ds_read_b64_tr_b16 a[184:185], v23 offset:16384
    v_cvt_pk_bf16_f32 v144, v208, v209
    v_mfma_f32_16x16x32_bf16 a[24:27], a[172:175], v[180:183], a[24:27]
    ds_read_b64_tr_b16 a[186:187], v23 offset:20480
    v_mfma_f32_16x16x32_bf16 a[28:31], a[168:171], v[184:187], a[28:31]
    ds_read_b128 a[208:211], v8 offset:40960
    v_cvt_pk_bf16_f32 v145, v210, v211
    v_mfma_f32_16x16x32_bf16 a[28:31], a[172:175], v[188:191], a[28:31]
    s_waitcnt lgkmcnt(3)
    buffer_load_dwordx4 v40, s[12:15], s41 offen lds
    v_mfma_f32_16x16x32_bf16 v[208:211], a[224:227], v[64:67], v[192:195]
    v_exp_f32 v212, v212
    v_mfma_f32_16x16x32_bf16 v[208:211], a[228:231], v[68:71], v[208:211]
    v_exp_f32 v213, v213
    v_mfma_f32_16x16x32_bf16 v[208:211], a[232:235], v[72:75], v[208:211]
    v_exp_f32 v214, v214
    v_mfma_f32_16x16x32_bf16 v[208:211], a[236:239], v[76:79], v[208:211]
    s_add_u32 s57, s58, 2949120
    v_exp_f32 v215, v215
    v_mfma_f32_16x16x32_bf16 a[32:35], a[176:179], v[160:163], a[32:35]
    ds_read_b64_tr_b16 a[188:189], v23 offset:24576
    v_cvt_pk_bf16_f32 v152, v212, v213
    v_mfma_f32_16x16x32_bf16 a[32:35], a[180:183], v[164:167], a[32:35]
    ds_read_b64_tr_b16 a[190:191], v23 offset:28672
    v_mfma_f32_16x16x32_bf16 a[36:39], a[176:179], v[168:171], a[36:39]
    ds_read_b128 a[212:215], v9 offset:40960
    v_cvt_pk_bf16_f32 v153, v214, v215
    v_mfma_f32_16x16x32_bf16 a[36:39], a[180:183], v[172:175], a[36:39]
    buffer_load_dwordx4 a[148:151], v254, s[80:83], s57 offen
    v_smfmac_f32_16x16x64_bf16 a[196:199], v[52:55], v[168:175], v50
    v_mfma_f32_16x16x32_bf16 v[212:215], a[224:227], v[80:83], v[196:199]
    v_exp_f32 v208, v208
    v_mfma_f32_16x16x32_bf16 v[212:215], a[228:231], v[84:87], v[212:215]
    v_exp_f32 v209, v209
    v_mfma_f32_16x16x32_bf16 v[212:215], a[232:235], v[88:91], v[212:215]
    v_exp_f32 v210, v210
    v_mfma_f32_16x16x32_bf16 v[212:215], a[236:239], v[92:95], v[212:215]
    v_exp_f32 v211, v211
    v_mfma_f32_16x16x32_bf16 a[40:43], a[176:179], v[176:179], a[40:43]
    ds_read_b64_tr_b16 a[160:161], v24 offset:16384
    v_cvt_pk_bf16_f32 v130, v208, v209
    v_mfma_f32_16x16x32_bf16 a[40:43], a[180:183], v[180:183], a[40:43]
    ds_read_b64_tr_b16 a[162:163], v24 offset:20480
    v_mfma_f32_16x16x32_bf16 a[44:47], a[176:179], v[184:187], a[44:47]
    ds_read_b128 a[216:219], v10 offset:40960
    v_cvt_pk_bf16_f32 v131, v210, v211
    v_mfma_f32_16x16x32_bf16 a[44:47], a[180:183], v[188:191], a[44:47]
    s_waitcnt lgkmcnt(3)
    buffer_load_dwordx4 v41, s[12:15], s41 offen offset:1024 lds
    v_mfma_f32_16x16x32_bf16 v[208:211], a[224:227], v[96:99], v[200:203]
    v_exp_f32 v212, v212
    v_mfma_f32_16x16x32_bf16 v[208:211], a[228:231], v[100:103], v[208:211]
    v_exp_f32 v213, v213
    v_mfma_f32_16x16x32_bf16 v[208:211], a[232:235], v[104:107], v[208:211]
    v_exp_f32 v214, v214
    v_mfma_f32_16x16x32_bf16 v[208:211], a[236:239], v[108:111], v[208:211]
    v_exp_f32 v215, v215
    v_mfma_f32_16x16x32_bf16 a[48:51], a[184:187], v[160:163], a[48:51]
    ds_read_b64_tr_b16 a[164:165], v24 offset:24576
    v_cvt_pk_bf16_f32 v138, v212, v213
    v_mfma_f32_16x16x32_bf16 a[48:51], a[188:191], v[164:167], a[48:51]
    ds_read_b64_tr_b16 a[166:167], v24 offset:28672
    v_mfma_f32_16x16x32_bf16 a[52:55], a[184:187], v[168:171], a[52:55]
    ds_read_b128 a[220:223], v11 offset:40960
    v_cvt_pk_bf16_f32 v139, v214, v215
    v_mfma_f32_16x16x32_bf16 a[52:55], a[188:191], v[172:175], a[52:55]
    v_smfmac_f32_16x16x64_bf16 a[200:203], v[52:55], v[176:183], v50
    v_mfma_f32_16x16x32_bf16 v[212:215], a[224:227], v[112:115], v[204:207]
    v_exp_f32 v208, v208
    v_mfma_f32_16x16x32_bf16 v[212:215], a[228:231], v[116:119], v[212:215]
    v_exp_f32 v209, v209
    v_mfma_f32_16x16x32_bf16 v[212:215], a[232:235], v[120:123], v[212:215]
    v_exp_f32 v210, v210
    v_mfma_f32_16x16x32_bf16 v[212:215], a[236:239], v[124:127], v[212:215]
    v_exp_f32 v211, v211
    v_mfma_f32_16x16x32_bf16 a[56:59], a[184:187], v[176:179], a[56:59]
    ds_read_b64_tr_b16 a[168:169], v25 offset:16384
    v_cvt_pk_bf16_f32 v146, v208, v209
    v_mfma_f32_16x16x32_bf16 a[56:59], a[188:191], v[180:183], a[56:59]
    ds_read_b64_tr_b16 a[170:171], v25 offset:20480
    v_mfma_f32_16x16x32_bf16 a[60:63], a[184:187], v[184:187], a[60:63]
    ds_read_b128 a[224:227], v8 offset:45056
    v_cvt_pk_bf16_f32 v147, v210, v211
    v_mfma_f32_16x16x32_bf16 a[60:63], a[188:191], v[188:191], a[60:63]
    s_waitcnt lgkmcnt(3)
    buffer_load_dwordx4 v40, s[12:15], s41 offen offset:2048 lds
    v_mfma_f32_16x16x32_bf16 v[208:211], a[208:211], v[64:67], v[192:195]
    v_exp_f32 v212, v212
    v_mfma_f32_16x16x32_bf16 v[208:211], a[212:215], v[68:71], v[208:211]
    v_exp_f32 v213, v213
    v_mfma_f32_16x16x32_bf16 v[208:211], a[216:219], v[72:75], v[208:211]
    v_exp_f32 v214, v214
    v_mfma_f32_16x16x32_bf16 v[208:211], a[220:223], v[76:79], v[208:211]
    s_add_u32 s57, s58, 3538944
    v_exp_f32 v215, v215
    v_mfma_f32_16x16x32_bf16 a[64:67], a[160:163], v[160:163], a[64:67]
    ds_read_b64_tr_b16 a[172:173], v25 offset:24576
    v_cvt_pk_bf16_f32 v154, v212, v213
    v_mfma_f32_16x16x32_bf16 a[64:67], a[164:167], v[164:167], a[64:67]
    ds_read_b64_tr_b16 a[174:175], v25 offset:28672
    v_mfma_f32_16x16x32_bf16 a[68:71], a[160:163], v[168:171], a[68:71]
    ds_read_b128 a[228:231], v9 offset:45056
    v_cvt_pk_bf16_f32 v155, v214, v215
    v_mfma_f32_16x16x32_bf16 a[68:71], a[164:167], v[172:175], a[68:71]
    buffer_load_dwordx4 a[152:155], v254, s[80:83], s57 offen
    v_smfmac_f32_16x16x64_bf16 a[204:207], v[52:55], v[184:191], v50
    v_mfma_f32_16x16x32_bf16 v[212:215], a[208:211], v[80:83], v[196:199]
    v_exp_f32 v208, v208
    v_mfma_f32_16x16x32_bf16 v[212:215], a[212:215], v[84:87], v[212:215]
    v_exp_f32 v209, v209
    v_mfma_f32_16x16x32_bf16 v[212:215], a[216:219], v[88:91], v[212:215]
    v_exp_f32 v210, v210
    v_mfma_f32_16x16x32_bf16 v[212:215], a[220:223], v[92:95], v[212:215]
    v_exp_f32 v211, v211
    v_mfma_f32_16x16x32_bf16 a[72:75], a[160:163], v[176:179], a[72:75]
    ds_read_b64_tr_b16 a[176:177], v26 offset:16384
    v_cvt_pk_bf16_f32 v132, v208, v209
    v_mfma_f32_16x16x32_bf16 a[72:75], a[164:167], v[180:183], a[72:75]
    ds_read_b64_tr_b16 a[178:179], v26 offset:20480
    v_mfma_f32_16x16x32_bf16 a[76:79], a[160:163], v[184:187], a[76:79]
    ds_read_b128 a[232:235], v10 offset:45056
    v_cvt_pk_bf16_f32 v133, v210, v211
    v_mfma_f32_16x16x32_bf16 a[76:79], a[164:167], v[188:191], a[76:79]
    s_waitcnt lgkmcnt(3)
    buffer_load_dwordx4 v41, s[12:15], s41 offen offset:3072 lds
    v_mfma_f32_16x16x32_bf16 v[208:211], a[208:211], v[96:99], v[200:203]
    v_exp_f32 v212, v212
    v_mfma_f32_16x16x32_bf16 v[208:211], a[212:215], v[100:103], v[208:211]
    s_add_u32 s41, s41, 16384
    v_exp_f32 v213, v213
    v_mfma_f32_16x16x32_bf16 v[208:211], a[216:219], v[104:107], v[208:211]
    v_exp_f32 v214, v214
    v_mfma_f32_16x16x32_bf16 v[208:211], a[220:223], v[108:111], v[208:211]
    v_exp_f32 v215, v215
    v_mfma_f32_16x16x32_bf16 a[80:83], a[168:171], v[160:163], a[80:83]
    ds_read_b64_tr_b16 a[180:181], v26 offset:24576
    v_cvt_pk_bf16_f32 v140, v212, v213
    v_mfma_f32_16x16x32_bf16 a[80:83], a[172:175], v[164:167], a[80:83]
    ds_read_b64_tr_b16 a[182:183], v26 offset:28672
    v_mfma_f32_16x16x32_bf16 a[84:87], a[168:171], v[168:171], a[84:87]
    ds_read_b128 a[236:239], v11 offset:45056
    v_cvt_pk_bf16_f32 v141, v214, v215
    v_mfma_f32_16x16x32_bf16 a[84:87], a[172:175], v[172:175], a[84:87]
    s_waitcnt vmcnt(14)
    s_barrier
    v_mfma_f32_16x16x32_bf16 v[212:215], a[208:211], v[112:115], v[204:207]
    v_exp_f32 v208, v208
    v_mfma_f32_16x16x32_bf16 v[212:215], a[212:215], v[116:119], v[212:215]
    s_add_u32 s49, s45, 74752
    v_exp_f32 v209, v209
    v_mfma_f32_16x16x32_bf16 v[212:215], a[216:219], v[120:123], v[212:215]
    s_add_u32 m0, s42, 16384
    v_exp_f32 v210, v210
    v_mfma_f32_16x16x32_bf16 v[212:215], a[220:223], v[124:127], v[212:215]
    v_exp_f32 v211, v211
    v_mfma_f32_16x16x32_bf16 a[88:91], a[168:171], v[176:179], a[88:91]
    ds_read_b64_tr_b16 a[184:185], v27 offset:16384
    v_cvt_pk_bf16_f32 v148, v208, v209
    v_mfma_f32_16x16x32_bf16 a[88:91], a[172:175], v[180:183], a[88:91]
    ds_read_b64_tr_b16 a[186:187], v27 offset:20480
    v_mfma_f32_16x16x32_bf16 a[92:95], a[168:171], v[184:187], a[92:95]
    ds_read_b128 a[208:211], v8 offset:49152
    v_cvt_pk_bf16_f32 v149, v210, v211
    v_mfma_f32_16x16x32_bf16 a[92:95], a[172:175], v[188:191], a[92:95]
    s_waitcnt lgkmcnt(3)
    buffer_load_dwordx4 v46, s[20:23], s49 offen lds
    v_mfma_f32_16x16x32_bf16 v[208:211], a[224:227], v[64:67], v[192:195]
    v_exp_f32 v212, v212
    v_mfma_f32_16x16x32_bf16 v[208:211], a[228:231], v[68:71], v[208:211]
    v_exp_f32 v213, v213
    v_mfma_f32_16x16x32_bf16 v[208:211], a[232:235], v[72:75], v[208:211]
    v_exp_f32 v214, v214
    v_mfma_f32_16x16x32_bf16 v[208:211], a[236:239], v[76:79], v[208:211]
    v_exp_f32 v215, v215
    v_mfma_f32_16x16x32_bf16 a[96:99], a[176:179], v[160:163], a[96:99]
    ds_read_b64_tr_b16 a[188:189], v27 offset:24576
    v_cvt_pk_bf16_f32 v156, v212, v213
    v_mfma_f32_16x16x32_bf16 a[96:99], a[180:183], v[164:167], a[96:99]
    ds_read_b64_tr_b16 a[190:191], v27 offset:28672
    v_mfma_f32_16x16x32_bf16 a[100:103], a[176:179], v[168:171], a[100:103]
    ds_read_b128 a[212:215], v9 offset:49152
    v_cvt_pk_bf16_f32 v157, v214, v215
    v_mfma_f32_16x16x32_bf16 a[100:103], a[180:183], v[172:175], a[100:103]
    buffer_load_dword v63, v63, s[88:91], 0 offen sc1
    v_mfma_f32_16x16x32_bf16 v[212:215], a[224:227], v[80:83], v[196:199]
    v_exp_f32 v208, v208
    v_mfma_f32_16x16x32_bf16 v[212:215], a[228:231], v[84:87], v[212:215]
    v_exp_f32 v209, v209
    v_mfma_f32_16x16x32_bf16 v[212:215], a[232:235], v[88:91], v[212:215]
    v_exp_f32 v210, v210
    v_mfma_f32_16x16x32_bf16 v[212:215], a[236:239], v[92:95], v[212:215]
    v_exp_f32 v211, v211
    v_mfma_f32_16x16x32_bf16 a[104:107], a[176:179], v[176:179], a[104:107]
    ds_read_b64_tr_b16 a[160:161], v20 offset:32768
    v_cvt_pk_bf16_f32 v134, v208, v209
    v_mfma_f32_16x16x32_bf16 a[104:107], a[180:183], v[180:183], a[104:107]
    ds_read_b64_tr_b16 a[162:163], v20 offset:36864
    v_mfma_f32_16x16x32_bf16 a[108:111], a[176:179], v[184:187], a[108:111]
    ds_read_b128 a[216:219], v10 offset:49152
    v_cvt_pk_bf16_f32 v135, v210, v211
    v_mfma_f32_16x16x32_bf16 a[108:111], a[180:183], v[188:191], a[108:111]
    s_waitcnt lgkmcnt(3)
    buffer_load_dwordx4 v47, s[20:23], s49 offen offset:1024 lds
    v_mfma_f32_16x16x32_bf16 v[208:211], a[224:227], v[96:99], v[200:203]
    v_exp_f32 v212, v212
    v_mfma_f32_16x16x32_bf16 v[208:211], a[228:231], v[100:103], v[208:211]
    v_exp_f32 v213, v213
    v_mfma_f32_16x16x32_bf16 v[208:211], a[232:235], v[104:107], v[208:211]
    v_exp_f32 v214, v214
    v_mfma_f32_16x16x32_bf16 v[208:211], a[236:239], v[108:111], v[208:211]
    s_add_u32 s57, s58, 4128768
    v_exp_f32 v215, v215
    v_mfma_f32_16x16x32_bf16 a[112:115], a[184:187], v[160:163], a[112:115]
    ds_read_b64_tr_b16 a[164:165], v20 offset:40960
    v_cvt_pk_bf16_f32 v142, v212, v213
    v_mfma_f32_16x16x32_bf16 a[112:115], a[188:191], v[164:167], a[112:115]
    ds_read_b64_tr_b16 a[166:167], v20 offset:45056
    v_mfma_f32_16x16x32_bf16 a[116:119], a[184:187], v[168:171], a[116:119]
    ds_read_b128 a[220:223], v11 offset:49152
    v_cvt_pk_bf16_f32 v143, v214, v215
    v_mfma_f32_16x16x32_bf16 a[116:119], a[188:191], v[172:175], a[116:119]
    buffer_load_dwordx4 a[156:159], v254, s[80:83], s57 offen
    v_mfma_f32_16x16x32_bf16 v[212:215], a[224:227], v[112:115], v[204:207]
    v_exp_f32 v208, v208
    v_mfma_f32_16x16x32_bf16 v[212:215], a[228:231], v[116:119], v[212:215]
    v_exp_f32 v209, v209
    v_mfma_f32_16x16x32_bf16 v[212:215], a[232:235], v[120:123], v[212:215]
    v_exp_f32 v210, v210
    v_mfma_f32_16x16x32_bf16 v[212:215], a[236:239], v[124:127], v[212:215]
    v_exp_f32 v211, v211
    v_mfma_f32_16x16x32_bf16 a[120:123], a[184:187], v[176:179], a[120:123]
    ds_read_b64_tr_b16 a[168:169], v21 offset:32768
    v_cvt_pk_bf16_f32 v150, v208, v209
    v_mfma_f32_16x16x32_bf16 a[120:123], a[188:191], v[180:183], a[120:123]
    ds_read_b64_tr_b16 a[170:171], v21 offset:36864
    v_mfma_f32_16x16x32_bf16 a[124:127], a[184:187], v[184:187], a[124:127]
    ds_read_b128 a[224:227], v8 offset:53248
    v_cvt_pk_bf16_f32 v151, v210, v211
    v_mfma_f32_16x16x32_bf16 a[124:127], a[188:191], v[188:191], a[124:127]
    s_waitcnt lgkmcnt(3)
    buffer_load_dwordx4 v48, s[20:23], s49 offen offset:2048 lds
    v_mfma_f32_16x16x32_bf16 v[208:211], a[208:211], v[64:67], v[192:195]
    v_exp_f32 v212, v212
    v_mfma_f32_16x16x32_bf16 v[208:211], a[212:215], v[68:71], v[208:211]
    v_exp_f32 v213, v213
    v_mfma_f32_16x16x32_bf16 v[208:211], a[216:219], v[72:75], v[208:211]
    v_exp_f32 v214, v214
    v_mfma_f32_16x16x32_bf16 v[208:211], a[220:223], v[76:79], v[208:211]
    s_add_u32 s57, s58, 4718592
    v_exp_f32 v215, v215
    v_mfma_f32_16x16x32_bf16 a[0:3], a[160:163], v[128:131], a[0:3]
    ds_read_b64_tr_b16 a[172:173], v21 offset:40960
    v_cvt_pk_bf16_f32 v158, v212, v213
    v_mfma_f32_16x16x32_bf16 a[0:3], a[164:167], v[132:135], a[0:3]
    ds_read_b64_tr_b16 a[174:175], v21 offset:45056
    v_mfma_f32_16x16x32_bf16 a[4:7], a[160:163], v[136:139], a[4:7]
    ds_read_b128 a[228:231], v9 offset:53248
    v_cvt_pk_bf16_f32 v159, v214, v215
    v_mfma_f32_16x16x32_bf16 a[4:7], a[164:167], v[140:143], a[4:7]
    buffer_load_dwordx4 a[240:243], v254, s[80:83], s57 offen
    v_mfma_f32_16x16x32_bf16 v[212:215], a[208:211], v[80:83], v[196:199]
    v_exp_f32 v208, v208
    v_mfma_f32_16x16x32_bf16 v[212:215], a[212:215], v[84:87], v[212:215]
    v_exp_f32 v209, v209
    v_mfma_f32_16x16x32_bf16 v[212:215], a[216:219], v[88:91], v[212:215]
    v_exp_f32 v210, v210
    v_mfma_f32_16x16x32_bf16 v[212:215], a[220:223], v[92:95], v[212:215]
    v_exp_f32 v211, v211
    v_mfma_f32_16x16x32_bf16 a[8:11], a[160:163], v[144:147], a[8:11]
    ds_read_b64_tr_b16 a[176:177], v22 offset:32768
    v_cvt_pk_bf16_f32 v160, v208, v209
    v_mfma_f32_16x16x32_bf16 a[8:11], a[164:167], v[148:151], a[8:11]
    ds_read_b64_tr_b16 a[178:179], v22 offset:36864
    v_mfma_f32_16x16x32_bf16 a[12:15], a[160:163], v[152:155], a[12:15]
    ds_read_b128 a[232:235], v10 offset:53248
    v_cvt_pk_bf16_f32 v161, v210, v211
    v_mfma_f32_16x16x32_bf16 a[12:15], a[164:167], v[156:159], a[12:15]
    s_waitcnt lgkmcnt(3)
    buffer_load_dwordx4 v49, s[20:23], s49 offen offset:3072 lds
    v_mfma_f32_16x16x32_bf16 v[208:211], a[208:211], v[96:99], v[200:203]
    v_exp_f32 v212, v212
    v_mfma_f32_16x16x32_bf16 v[208:211], a[212:215], v[100:103], v[208:211]
    v_exp_f32 v213, v213
    v_mfma_f32_16x16x32_bf16 v[208:211], a[216:219], v[104:107], v[208:211]
    v_exp_f32 v214, v214
    v_mfma_f32_16x16x32_bf16 v[208:211], a[220:223], v[108:111], v[208:211]
    v_exp_f32 v215, v215
    v_mfma_f32_16x16x32_bf16 a[16:19], a[168:171], v[128:131], a[16:19]
    ds_read_b64_tr_b16 a[180:181], v22 offset:40960
    v_cvt_pk_bf16_f32 v168, v212, v213
    v_mfma_f32_16x16x32_bf16 a[16:19], a[172:175], v[132:135], a[16:19]
    ds_read_b64_tr_b16 a[182:183], v22 offset:45056
    v_mfma_f32_16x16x32_bf16 a[20:23], a[168:171], v[136:139], a[20:23]
    ds_read_b128 a[236:239], v11 offset:53248
    v_cvt_pk_bf16_f32 v169, v214, v215
    v_mfma_f32_16x16x32_bf16 a[20:23], a[172:175], v[140:143], a[20:23]
    v_smfmac_f32_16x16x64_bf16 a[192:195], v[52:55], v[128:135], v50
    v_mfma_f32_16x16x32_bf16 v[212:215], a[208:211], v[112:115], v[204:207]
    v_exp_f32 v208, v208
    v_mfma_f32_16x16x32_bf16 v[212:215], a[212:215], v[116:119], v[212:215]
    s_add_u32 s49, s7, 0
    v_exp_f32 v209, v209
    v_mfma_f32_16x16x32_bf16 v[212:215], a[216:219], v[120:123], v[212:215]
    s_add_u32 m0, s42, 65536
    v_exp_f32 v210, v210
    v_mfma_f32_16x16x32_bf16 v[212:215], a[220:223], v[124:127], v[212:215]
    v_exp_f32 v211, v211
    v_mfma_f32_16x16x32_bf16 a[24:27], a[168:171], v[144:147], a[24:27]
    ds_read_b64_tr_b16 a[184:185], v23 offset:32768
    v_cvt_pk_bf16_f32 v176, v208, v209
    v_mfma_f32_16x16x32_bf16 a[24:27], a[172:175], v[148:151], a[24:27]
    ds_read_b64_tr_b16 a[186:187], v23 offset:36864
    v_mfma_f32_16x16x32_bf16 a[28:31], a[168:171], v[152:155], a[28:31]
    ds_read_b128 a[208:211], v8 offset:57344
    v_cvt_pk_bf16_f32 v177, v210, v211
    v_mfma_f32_16x16x32_bf16 a[28:31], a[172:175], v[156:159], a[28:31]
    s_waitcnt lgkmcnt(3)
    buffer_load_dwordx4 v46, s[20:23], s49 offen lds
    v_mfma_f32_16x16x32_bf16 v[208:211], a[224:227], v[64:67], v[192:195]
    v_exp_f32 v212, v212
    v_mfma_f32_16x16x32_bf16 v[208:211], a[228:231], v[68:71], v[208:211]
    v_exp_f32 v213, v213
    v_mfma_f32_16x16x32_bf16 v[208:211], a[232:235], v[72:75], v[208:211]
    v_exp_f32 v214, v214
    v_mfma_f32_16x16x32_bf16 v[208:211], a[236:239], v[76:79], v[208:211]
    s_add_u32 s57, s58, 4128768
    v_exp_f32 v215, v215
    v_mfma_f32_16x16x32_bf16 a[32:35], a[176:179], v[128:131], a[32:35]
    ds_read_b64_tr_b16 a[188:189], v23 offset:40960
    v_cvt_pk_bf16_f32 v184, v212, v213
    v_mfma_f32_16x16x32_bf16 a[32:35], a[180:183], v[132:135], a[32:35]
    ds_read_b64_tr_b16 a[190:191], v23 offset:45056
    v_mfma_f32_16x16x32_bf16 a[36:39], a[176:179], v[136:139], a[36:39]
    ds_read_b128 a[212:215], v9 offset:57344
    v_cvt_pk_bf16_f32 v185, v214, v215
    v_mfma_f32_16x16x32_bf16 a[36:39], a[180:183], v[140:143], a[36:39]
    buffer_load_dwordx4 a[244:247], v254, s[32:35], s57 offen
    v_smfmac_f32_16x16x64_bf16 a[196:199], v[52:55], v[136:143], v50
    v_mfma_f32_16x16x32_bf16 v[212:215], a[224:227], v[80:83], v[196:199]
    v_exp_f32 v208, v208
    v_mfma_f32_16x16x32_bf16 v[212:215], a[228:231], v[84:87], v[212:215]
    v_exp_f32 v209, v209
    v_mfma_f32_16x16x32_bf16 v[212:215], a[232:235], v[88:91], v[212:215]
    v_exp_f32 v210, v210
    v_mfma_f32_16x16x32_bf16 v[212:215], a[236:239], v[92:95], v[212:215]
    v_exp_f32 v211, v211
    v_mfma_f32_16x16x32_bf16 a[40:43], a[176:179], v[144:147], a[40:43]
    ds_read_b64_tr_b16 a[160:161], v24 offset:32768
    v_cvt_pk_bf16_f32 v162, v208, v209
    v_mfma_f32_16x16x32_bf16 a[40:43], a[180:183], v[148:151], a[40:43]
    ds_read_b64_tr_b16 a[162:163], v24 offset:36864
    v_mfma_f32_16x16x32_bf16 a[44:47], a[176:179], v[152:155], a[44:47]
    ds_read_b128 a[216:219], v10 offset:57344
    v_cvt_pk_bf16_f32 v163, v210, v211
    v_mfma_f32_16x16x32_bf16 a[44:47], a[180:183], v[156:159], a[44:47]
    s_waitcnt lgkmcnt(3)
    buffer_load_dwordx4 v47, s[20:23], s49 offen offset:1024 lds
    v_mfma_f32_16x16x32_bf16 v[208:211], a[224:227], v[96:99], v[200:203]
    v_exp_f32 v212, v212
    v_mfma_f32_16x16x32_bf16 v[208:211], a[228:231], v[100:103], v[208:211]
    v_exp_f32 v213, v213
    v_mfma_f32_16x16x32_bf16 v[208:211], a[232:235], v[104:107], v[208:211]
    v_exp_f32 v214, v214
    v_mfma_f32_16x16x32_bf16 v[208:211], a[236:239], v[108:111], v[208:211]
    v_exp_f32 v215, v215
    v_mfma_f32_16x16x32_bf16 a[48:51], a[184:187], v[128:131], a[48:51]
    ds_read_b64_tr_b16 a[164:165], v24 offset:40960
    v_cvt_pk_bf16_f32 v170, v212, v213
    v_mfma_f32_16x16x32_bf16 a[48:51], a[188:191], v[132:135], a[48:51]
    ds_read_b64_tr_b16 a[166:167], v24 offset:45056
    v_mfma_f32_16x16x32_bf16 a[52:55], a[184:187], v[136:139], a[52:55]
    ds_read_b128 a[220:223], v11 offset:57344
    v_cvt_pk_bf16_f32 v171, v214, v215
    v_mfma_f32_16x16x32_bf16 a[52:55], a[188:191], v[140:143], a[52:55]
    v_smfmac_f32_16x16x64_bf16 a[200:203], v[52:55], v[144:151], v50
    v_mfma_f32_16x16x32_bf16 v[212:215], a[224:227], v[112:115], v[204:207]
    v_exp_f32 v208, v208
    v_mfma_f32_16x16x32_bf16 v[212:215], a[228:231], v[116:119], v[212:215]
    v_exp_f32 v209, v209
    v_mfma_f32_16x16x32_bf16 v[212:215], a[232:235], v[120:123], v[212:215]
    v_exp_f32 v210, v210
    v_mfma_f32_16x16x32_bf16 v[212:215], a[236:239], v[124:127], v[212:215]
    v_exp_f32 v211, v211
    v_mfma_f32_16x16x32_bf16 a[56:59], a[184:187], v[144:147], a[56:59]
    ds_read_b64_tr_b16 a[168:169], v25 offset:32768
    v_cvt_pk_bf16_f32 v178, v208, v209
    v_mfma_f32_16x16x32_bf16 a[56:59], a[188:191], v[148:151], a[56:59]
    ds_read_b64_tr_b16 a[170:171], v25 offset:36864
    v_mfma_f32_16x16x32_bf16 a[60:63], a[184:187], v[152:155], a[60:63]
    ds_read_b128 a[224:227], v8 offset:61440
    v_cvt_pk_bf16_f32 v179, v210, v211
    v_mfma_f32_16x16x32_bf16 a[60:63], a[188:191], v[156:159], a[60:63]
    s_waitcnt lgkmcnt(3)
    buffer_load_dwordx4 v48, s[20:23], s49 offen offset:2048 lds
    v_mfma_f32_16x16x32_bf16 v[208:211], a[208:211], v[64:67], v[192:195]
    v_exp_f32 v212, v212
    v_mfma_f32_16x16x32_bf16 v[208:211], a[212:215], v[68:71], v[208:211]
    v_exp_f32 v213, v213
    v_mfma_f32_16x16x32_bf16 v[208:211], a[216:219], v[72:75], v[208:211]
    v_exp_f32 v214, v214
    v_mfma_f32_16x16x32_bf16 v[208:211], a[220:223], v[76:79], v[208:211]
    s_add_u32 s57, s58, 4718592
    v_exp_f32 v215, v215
    v_mfma_f32_16x16x32_bf16 a[64:67], a[160:163], v[128:131], a[64:67]
    ds_read_b64_tr_b16 a[172:173], v25 offset:40960
    v_cvt_pk_bf16_f32 v186, v212, v213
    v_mfma_f32_16x16x32_bf16 a[64:67], a[164:167], v[132:135], a[64:67]
    ds_read_b64_tr_b16 a[174:175], v25 offset:45056
    v_mfma_f32_16x16x32_bf16 a[68:71], a[160:163], v[136:139], a[68:71]
    ds_read_b128 a[228:231], v9 offset:61440
    v_cvt_pk_bf16_f32 v187, v214, v215
    v_mfma_f32_16x16x32_bf16 a[68:71], a[164:167], v[140:143], a[68:71]
    buffer_load_dwordx4 a[248:251], v254, s[32:35], s57 offen
    v_smfmac_f32_16x16x64_bf16 a[204:207], v[52:55], v[152:159], v50
    v_mfma_f32_16x16x32_bf16 v[212:215], a[208:211], v[80:83], v[196:199]
    v_exp_f32 v208, v208
    v_mfma_f32_16x16x32_bf16 v[212:215], a[212:215], v[84:87], v[212:215]
    v_exp_f32 v209, v209
    v_mfma_f32_16x16x32_bf16 v[212:215], a[216:219], v[88:91], v[212:215]
    v_exp_f32 v210, v210
    v_mfma_f32_16x16x32_bf16 v[212:215], a[220:223], v[92:95], v[212:215]
    v_exp_f32 v211, v211
    v_mfma_f32_16x16x32_bf16 a[72:75], a[160:163], v[144:147], a[72:75]
    ds_read_b64_tr_b16 a[176:177], v26 offset:32768
    v_cvt_pk_bf16_f32 v164, v208, v209
    v_mfma_f32_16x16x32_bf16 a[72:75], a[164:167], v[148:151], a[72:75]
    ds_read_b64_tr_b16 a[178:179], v26 offset:36864
    v_mfma_f32_16x16x32_bf16 a[76:79], a[160:163], v[152:155], a[76:79]
    ds_read_b128 a[232:235], v10 offset:61440
    v_cvt_pk_bf16_f32 v165, v210, v211
    v_mfma_f32_16x16x32_bf16 a[76:79], a[164:167], v[156:159], a[76:79]
    s_waitcnt lgkmcnt(3)
    buffer_load_dwordx4 v49, s[20:23], s49 offen offset:3072 lds
    v_mfma_f32_16x16x32_bf16 v[208:211], a[208:211], v[96:99], v[200:203]
    v_exp_f32 v212, v212
    v_mfma_f32_16x16x32_bf16 v[208:211], a[212:215], v[100:103], v[208:211]
    v_exp_f32 v213, v213
    v_mfma_f32_16x16x32_bf16 v[208:211], a[216:219], v[104:107], v[208:211]
    v_exp_f32 v214, v214
    v_mfma_f32_16x16x32_bf16 v[208:211], a[220:223], v[108:111], v[208:211]
    v_exp_f32 v215, v215
    v_mfma_f32_16x16x32_bf16 a[80:83], a[168:171], v[128:131], a[80:83]
    ds_read_b64_tr_b16 a[180:181], v26 offset:40960
    v_cvt_pk_bf16_f32 v172, v212, v213
    v_mfma_f32_16x16x32_bf16 a[80:83], a[172:175], v[132:135], a[80:83]
    ds_read_b64_tr_b16 a[182:183], v26 offset:45056
    v_mfma_f32_16x16x32_bf16 a[84:87], a[168:171], v[136:139], a[84:87]
    ds_read_b128 a[236:239], v11 offset:61440
    v_cvt_pk_bf16_f32 v173, v214, v215
    v_mfma_f32_16x16x32_bf16 a[84:87], a[172:175], v[140:143], a[84:87]
    s_waitcnt vmcnt(13)
    s_barrier
    v_mfma_f32_16x16x32_bf16 v[212:215], a[208:211], v[112:115], v[204:207]
    v_exp_f32 v208, v208
    v_mfma_f32_16x16x32_bf16 v[212:215], a[212:215], v[116:119], v[212:215]
    s_add_u32 s49, s7, 73728
    v_exp_f32 v209, v209
    v_mfma_f32_16x16x32_bf16 v[212:215], a[216:219], v[120:123], v[212:215]
    s_add_u32 m0, s42, 81920
    v_exp_f32 v210, v210
    v_mfma_f32_16x16x32_bf16 v[212:215], a[220:223], v[124:127], v[212:215]
    v_exp_f32 v211, v211
    v_mfma_f32_16x16x32_bf16 a[88:91], a[168:171], v[144:147], a[88:91]
    ds_read_b64_tr_b16 a[184:185], v27 offset:32768
    v_cvt_pk_bf16_f32 v180, v208, v209
    v_mfma_f32_16x16x32_bf16 a[88:91], a[172:175], v[148:151], a[88:91]
    ds_read_b64_tr_b16 a[186:187], v27 offset:36864
    v_mfma_f32_16x16x32_bf16 a[92:95], a[168:171], v[152:155], a[92:95]
    v_cvt_pk_bf16_f32 v181, v210, v211
    v_mfma_f32_16x16x32_bf16 a[92:95], a[172:175], v[156:159], a[92:95]
    s_waitcnt lgkmcnt(3)
    buffer_load_dwordx4 v46, s[20:23], s49 offen lds
    v_mfma_f32_16x16x32_bf16 v[208:211], a[224:227], v[64:67], v[192:195]
    v_exp_f32 v212, v212
    v_mfma_f32_16x16x32_bf16 v[208:211], a[228:231], v[68:71], v[208:211]
    v_exp_f32 v213, v213
    v_mfma_f32_16x16x32_bf16 v[208:211], a[232:235], v[72:75], v[208:211]
    s_waitcnt lgkmcnt(2)
    v_exp_f32 v214, v214
    v_mfma_f32_16x16x32_bf16 v[208:211], a[236:239], v[76:79], v[208:211]
    s_add_u32 s37, s55, 8192
    v_exp_f32 v215, v215
    v_mfma_f32_16x16x32_bf16 a[96:99], a[176:179], v[128:131], a[96:99]
    ds_read_b64_tr_b16 a[188:189], v27 offset:40960
    v_cvt_pk_bf16_f32 v188, v212, v213
    v_mfma_f32_16x16x32_bf16 a[96:99], a[180:183], v[132:135], a[96:99]
    ds_read_b64_tr_b16 a[190:191], v27 offset:45056
    v_mfma_f32_16x16x32_bf16 a[100:103], a[176:179], v[136:139], a[100:103]
    v_cvt_pk_bf16_f32 v189, v214, v215
    v_mfma_f32_16x16x32_bf16 a[100:103], a[180:183], v[140:143], a[100:103]
    buffer_load_dword v239, v238, s[28:31], s37 offen
    v_mfma_f32_16x16x32_bf16 v[212:215], a[224:227], v[80:83], v[196:199]
    v_exp_f32 v208, v208
    v_mfma_f32_16x16x32_bf16 v[212:215], a[228:231], v[84:87], v[212:215]
    v_exp_f32 v209, v209
    v_mfma_f32_16x16x32_bf16 v[212:215], a[232:235], v[88:91], v[212:215]
    v_exp_f32 v210, v210
    v_mfma_f32_16x16x32_bf16 v[212:215], a[236:239], v[92:95], v[212:215]
    v_exp_f32 v211, v211
    v_mfma_f32_16x16x32_bf16 a[104:107], a[176:179], v[144:147], a[104:107]
    ds_read_b64_tr_b16 a[160:161], v20 offset:49152
    v_cvt_pk_bf16_f32 v166, v208, v209
    v_mfma_f32_16x16x32_bf16 a[104:107], a[180:183], v[148:151], a[104:107]
    ds_read_b64_tr_b16 a[162:163], v20 offset:53248
    v_mfma_f32_16x16x32_bf16 a[108:111], a[176:179], v[152:155], a[108:111]
    v_cvt_pk_bf16_f32 v167, v210, v211
    v_mfma_f32_16x16x32_bf16 a[108:111], a[180:183], v[156:159], a[108:111]
    s_waitcnt lgkmcnt(3)
    buffer_load_dwordx4 v47, s[20:23], s49 offen offset:1024 lds
    v_mfma_f32_16x16x32_bf16 v[208:211], a[224:227], v[96:99], v[200:203]
    v_exp_f32 v212, v212
    v_mfma_f32_16x16x32_bf16 v[208:211], a[228:231], v[100:103], v[208:211]
    v_exp_f32 v213, v213
    v_mfma_f32_16x16x32_bf16 v[208:211], a[232:235], v[104:107], v[208:211]
    v_exp_f32 v214, v214
    v_mfma_f32_16x16x32_bf16 v[208:211], a[236:239], v[108:111], v[208:211]
    s_add_u32 s57, s59, 0
    v_exp_f32 v215, v215
    v_mfma_f32_16x16x32_bf16 a[112:115], a[184:187], v[128:131], a[112:115]
    s_waitcnt lgkmcnt(2)
    ds_read_b64_tr_b16 a[164:165], v20 offset:57344
    v_cvt_pk_bf16_f32 v174, v212, v213
    v_mfma_f32_16x16x32_bf16 a[112:115], a[188:191], v[132:135], a[112:115]
    ds_read_b64_tr_b16 a[166:167], v20 offset:61440
    v_mfma_f32_16x16x32_bf16 a[116:119], a[184:187], v[136:139], a[116:119]
    v_cvt_pk_bf16_f32 v175, v214, v215
    v_mfma_f32_16x16x32_bf16 a[116:119], a[188:191], v[140:143], a[116:119]
    buffer_load_dwordx4 a[252:255], v255, s[84:87], s57 offen
    v_mfma_f32_16x16x32_bf16 v[212:215], a[224:227], v[112:115], v[204:207]
    v_exp_f32 v208, v208
    v_mfma_f32_16x16x32_bf16 v[212:215], a[228:231], v[116:119], v[212:215]
    v_exp_f32 v209, v209
    v_mfma_f32_16x16x32_bf16 v[212:215], a[232:235], v[120:123], v[212:215]
    v_exp_f32 v210, v210
    v_mfma_f32_16x16x32_bf16 v[212:215], a[236:239], v[124:127], v[212:215]
    v_exp_f32 v211, v211
    v_mfma_f32_16x16x32_bf16 a[120:123], a[184:187], v[144:147], a[120:123]
    ds_read_b64_tr_b16 a[168:169], v21 offset:49152
    v_cvt_pk_bf16_f32 v182, v208, v209
    v_mfma_f32_16x16x32_bf16 a[120:123], a[188:191], v[148:151], a[120:123]
    ds_read_b64_tr_b16 a[170:171], v21 offset:53248
    v_mfma_f32_16x16x32_bf16 a[124:127], a[184:187], v[152:155], a[124:127]
    v_cvt_pk_bf16_f32 v183, v210, v211
    v_mfma_f32_16x16x32_bf16 a[124:127], a[188:191], v[156:159], a[124:127]
    s_waitcnt lgkmcnt(3)
    buffer_load_dwordx4 v48, s[20:23], s49 offen offset:2048 lds
    v_exp_f32 v212, v212
    v_exp_f32 v213, v213
    v_exp_f32 v214, v214
    v_exp_f32 v215, v215
    v_mfma_f32_16x16x32_bf16 a[0:3], a[160:163], v[160:163], a[0:3]
    s_waitcnt lgkmcnt(2)
    ds_read_b64_tr_b16 a[172:173], v21 offset:57344
    v_cvt_pk_bf16_f32 v190, v212, v213
    v_mfma_f32_16x16x32_bf16 a[0:3], a[164:167], v[164:167], a[0:3]
    ds_read_b64_tr_b16 a[174:175], v21 offset:61440
    v_mfma_f32_16x16x32_bf16 a[4:7], a[160:163], v[168:171], a[4:7]
    v_cvt_pk_bf16_f32 v191, v214, v215
    v_mfma_f32_16x16x32_bf16 a[4:7], a[164:167], v[172:175], a[4:7]
    v_mfma_f32_16x16x32_bf16 a[8:11], a[160:163], v[176:179], a[8:11]
    ds_read_b64_tr_b16 a[176:177], v22 offset:49152
    v_mfma_f32_16x16x32_bf16 a[8:11], a[164:167], v[180:183], a[8:11]
    ds_read_b64_tr_b16 a[178:179], v22 offset:53248
    v_mfma_f32_16x16x32_bf16 a[12:15], a[160:163], v[184:187], a[12:15]
    v_mfma_f32_16x16x32_bf16 a[12:15], a[164:167], v[188:191], a[12:15]
    buffer_load_dwordx4 v49, s[20:23], s49 offen offset:3072 lds
    v_smfmac_f32_16x16x64_bf16 a[192:195], v[52:55], v[160:167], v50
    s_waitcnt lgkmcnt(4)
    v_mfma_f32_16x16x32_bf16 a[16:19], a[168:171], v[160:163], a[16:19]
    s_waitcnt lgkmcnt(2)
    ds_read_b64_tr_b16 a[180:181], v22 offset:57344
    v_mfma_f32_16x16x32_bf16 a[16:19], a[172:175], v[164:167], a[16:19]
    ds_read_b64_tr_b16 a[182:183], v22 offset:61440
    v_mfma_f32_16x16x32_bf16 a[20:23], a[168:171], v[168:171], a[20:23]
    v_mfma_f32_16x16x32_bf16 a[20:23], a[172:175], v[172:175], a[20:23]
    v_smfmac_f32_16x16x64_bf16 a[196:199], v[52:55], v[168:175], v50
    s_add_u32 s49, s7, 256
    s_add_u32 m0, s42, 32768
    v_mfma_f32_16x16x32_bf16 a[24:27], a[168:171], v[176:179], a[24:27]
    ds_read_b64_tr_b16 a[184:185], v23 offset:49152
    v_mfma_f32_16x16x32_bf16 a[24:27], a[172:175], v[180:183], a[24:27]
    ds_read_b64_tr_b16 a[186:187], v23 offset:53248
    v_mfma_f32_16x16x32_bf16 a[28:31], a[168:171], v[184:187], a[28:31]
    v_mfma_f32_16x16x32_bf16 a[28:31], a[172:175], v[188:191], a[28:31]
    buffer_load_dwordx4 v46, s[20:23], s49 offen lds
    v_smfmac_f32_16x16x64_bf16 a[200:203], v[52:55], v[176:183], v50
    s_waitcnt lgkmcnt(4)
    v_mfma_f32_16x16x32_bf16 a[32:35], a[176:179], v[160:163], a[32:35]
    s_waitcnt lgkmcnt(2)
    ds_read_b64_tr_b16 a[188:189], v23 offset:57344
    v_mfma_f32_16x16x32_bf16 a[32:35], a[180:183], v[164:167], a[32:35]
    ds_read_b64_tr_b16 a[190:191], v23 offset:61440
    v_mfma_f32_16x16x32_bf16 a[36:39], a[176:179], v[168:171], a[36:39]
    v_mfma_f32_16x16x32_bf16 a[36:39], a[180:183], v[172:175], a[36:39]
    v_smfmac_f32_16x16x64_bf16 a[204:207], v[52:55], v[184:191], v50
    v_mfma_f32_16x16x32_bf16 a[40:43], a[176:179], v[176:179], a[40:43]
    ds_read_b64_tr_b16 a[160:161], v24 offset:49152
    v_mfma_f32_16x16x32_bf16 a[40:43], a[180:183], v[180:183], a[40:43]
    ds_read_b64_tr_b16 a[162:163], v24 offset:53248
    v_mfma_f32_16x16x32_bf16 a[44:47], a[176:179], v[184:187], a[44:47]
    v_mfma_f32_16x16x32_bf16 a[44:47], a[180:183], v[188:191], a[44:47]
    s_waitcnt lgkmcnt(4)
    buffer_load_dwordx4 v47, s[20:23], s49 offen offset:1024 lds
    v_mfma_f32_16x16x32_bf16 a[48:51], a[184:187], v[160:163], a[48:51]
    s_waitcnt lgkmcnt(2)
    ds_read_b64_tr_b16 a[164:165], v24 offset:57344
    v_accvgpr_read_b32 v216, a192
    v_mfma_f32_16x16x32_bf16 a[48:51], a[188:191], v[164:167], a[48:51]
    ds_read_b64_tr_b16 a[166:167], v24 offset:61440
    v_accvgpr_read_b32 v217, a193
    v_mfma_f32_16x16x32_bf16 a[52:55], a[184:187], v[168:171], a[52:55]
    v_accvgpr_read_b32 v218, a196
    v_accvgpr_read_b32 v219, a197
    v_mfma_f32_16x16x32_bf16 a[52:55], a[188:191], v[172:175], a[52:55]
    v_accvgpr_read_b32 v220, a200
    v_accvgpr_read_b32 v221, a201
    v_mfma_f32_16x16x32_bf16 a[56:59], a[184:187], v[176:179], a[56:59]
    ds_read_b64_tr_b16 a[168:169], v25 offset:49152
    v_accvgpr_read_b32 v222, a204
    v_mfma_f32_16x16x32_bf16 a[56:59], a[188:191], v[180:183], a[56:59]
    ds_read_b64_tr_b16 a[170:171], v25 offset:53248
    v_accvgpr_read_b32 v223, a205
    v_mfma_f32_16x16x32_bf16 a[60:63], a[184:187], v[184:187], a[60:63]
    v_add_f32 v58, v216, v217
    v_add_f32 v59, v218, v219
    v_mfma_f32_16x16x32_bf16 a[60:63], a[188:191], v[188:191], a[60:63]
    s_waitcnt lgkmcnt(4)
    buffer_load_dwordx4 v48, s[20:23], s49 offen offset:2048 lds
    v_add_f32 v60, v220, v221
    v_add_f32 v61, v222, v223
    v_mfma_f32_16x16x32_bf16 a[64:67], a[160:163], v[160:163], a[64:67]
    s_waitcnt lgkmcnt(2)
    ds_read_b64_tr_b16 a[172:173], v25 offset:57344
    v_add_f32 v216, v58, v59
    v_mfma_f32_16x16x32_bf16 a[64:67], a[164:167], v[164:167], a[64:67]
    ds_read_b64_tr_b16 a[174:175], v25 offset:61440
    v_add_f32 v217, v60, v61
    v_mfma_f32_16x16x32_bf16 a[68:71], a[160:163], v[168:171], a[68:71]
    v_add_f32 v216, v216, v217
    v_cmp_ngt_f32 vcc, 1669332992, v216
    v_mfma_f32_16x16x32_bf16 a[68:71], a[164:167], v[172:175], a[68:71]
    v_rcp_f32 v58, v58
    v_rcp_f32 v59, v59
    v_mfma_f32_16x16x32_bf16 a[72:75], a[160:163], v[176:179], a[72:75]
    ds_read_b64_tr_b16 a[176:177], v26 offset:49152
    v_rcp_f32 v60, v60
    v_mfma_f32_16x16x32_bf16 a[72:75], a[164:167], v[180:183], a[72:75]
    ds_read_b64_tr_b16 a[178:179], v26 offset:53248
    v_rcp_f32 v61, v61
    v_mfma_f32_16x16x32_bf16 a[76:79], a[160:163], v[184:187], a[76:79]
    v_mov_b32 v228, 131072
    s_or_b32 s36, vcc_lo, vcc_hi
    v_mfma_f32_16x16x32_bf16 a[76:79], a[164:167], v[188:191], a[76:79]
    s_waitcnt lgkmcnt(4)
    buffer_load_dwordx4 v49, s[20:23], s49 offen offset:3072 lds
    v_mov_b32 v218, s36
    s_lshl_b32 s37, s3, 2
    v_mfma_f32_16x16x32_bf16 a[80:83], a[168:171], v[160:163], a[80:83]
    s_waitcnt lgkmcnt(2)
    ds_read_b64_tr_b16 a[180:181], v26 offset:57344
    v_add_u32 v219, s37, v228
    ds_write_b32 v219, v218
    v_mfma_f32_16x16x32_bf16 a[80:83], a[172:175], v[164:167], a[80:83]
    ds_read_b64_tr_b16 a[182:183], v26 offset:61440
    v_mfma_f32_16x16x32_bf16 a[84:87], a[168:171], v[168:171], a[84:87]
    v_mfma_f32_16x16x32_bf16 a[84:87], a[172:175], v[172:175], a[84:87]
    s_waitcnt lgkmcnt(1)
    s_waitcnt vmcnt(16)
    s_barrier
    v_mfma_f32_16x16x32_bf16 a[88:91], a[168:171], v[176:179], a[88:91]
    ds_read_b64_tr_b16 a[184:185], v27 offset:49152
    v_mfma_f32_16x16x32_bf16 a[88:91], a[172:175], v[180:183], a[88:91]
    ds_read_b64_tr_b16 a[186:187], v27 offset:53248
    v_mfma_f32_16x16x32_bf16 a[92:95], a[168:171], v[184:187], a[92:95]
    ds_read_b128 v[224:227], v228
    v_mfma_f32_16x16x32_bf16 a[92:95], a[172:175], v[188:191], a[92:95]
    s_add_u32 s49, s7, 73984
    v_mfma_f32_16x16x32_bf16 a[96:99], a[176:179], v[160:163], a[96:99]
    s_waitcnt lgkmcnt(3)
    s_add_u32 m0, s42, 49152
    ds_read_b64_tr_b16 a[188:189], v27 offset:57344
    v_mfma_f32_16x16x32_bf16 a[96:99], a[180:183], v[164:167], a[96:99]
    buffer_load_dwordx4 v46, s[20:23], s49 offen lds
    v_mfma_f32_16x16x32_bf16 a[100:103], a[176:179], v[168:171], a[100:103]
    ds_read_b64_tr_b16 a[190:191], v27 offset:61440
    v_mfma_f32_16x16x32_bf16 a[100:103], a[180:183], v[172:175], a[100:103]
    buffer_load_dwordx4 v47, s[20:23], s49 offen offset:1024 lds
    v_mfma_f32_16x16x32_bf16 a[104:107], a[176:179], v[176:179], a[104:107]
    v_mfma_f32_16x16x32_bf16 a[104:107], a[180:183], v[180:183], a[104:107]
    buffer_load_dwordx4 v48, s[20:23], s49 offen offset:2048 lds
    v_mfma_f32_16x16x32_bf16 a[108:111], a[176:179], v[184:187], a[108:111]
    v_mfma_f32_16x16x32_bf16 a[108:111], a[180:183], v[188:191], a[108:111]
    s_waitcnt lgkmcnt(3)
    buffer_load_dwordx4 v49, s[20:23], s49 offen offset:3072 lds
    s_add_u32 s49, s46, 0
    v_mfma_f32_16x16x32_bf16 a[112:115], a[184:187], v[160:163], a[112:115]
    s_waitcnt lgkmcnt(0)
    s_add_u32 m0, s42, 98304
    v_mfma_f32_16x16x32_bf16 a[112:115], a[188:191], v[164:167], a[112:115]
    buffer_load_dwordx4 v46, s[20:23], s49 offen lds
    v_mfma_f32_16x16x32_bf16 a[116:119], a[184:187], v[168:171], a[116:119]
    v_mfma_f32_16x16x32_bf16 a[116:119], a[188:191], v[172:175], a[116:119]
    buffer_load_dwordx4 v47, s[20:23], s49 offen offset:1024 lds
    v_mfma_f32_16x16x32_bf16 a[120:123], a[184:187], v[176:179], a[120:123]
    v_mfma_f32_16x16x32_bf16 a[120:123], a[188:191], v[180:183], a[120:123]
    buffer_load_dwordx4 v48, s[20:23], s49 offen offset:2048 lds
    v_mfma_f32_16x16x32_bf16 a[124:127], a[184:187], v[184:187], a[124:127]
    v_mfma_f32_16x16x32_bf16 a[124:127], a[188:191], v[188:191], a[124:127]
    buffer_load_dwordx4 v49, s[20:23], s49 offen offset:3072 lds
    v_or3_b32 v224, v224, v225, v226
    v_or_b32 v224, v224, v227
    s_nop 0
    v_readfirstlane_b32 s36, v224
    v_readfirstlane_b32 s37, v63
    v_readfirstlane_b32 s38, v253
    v_min_u32 v8, 1, v1
    v_lshlrev_b32 v8, 31, v8
    v_mov_b32 v10, s95
    s_getreg_b32 s39, hwreg(HW_REG_XCC_ID, 0, 4)
    s_add_u32 s39, s39, s95
    s_cmp_eq_u32 s38, s39
    s_cselect_b32 s53, 1, 0
    ds_read_b64_tr_b16 a[208:209], v12 offset:0
    ds_read_b64_tr_b16 a[210:211], v12 offset:4096
    ds_read_b64_tr_b16 a[212:213], v12 offset:8192
    ds_read_b64_tr_b16 a[214:215], v12 offset:12288
    ds_read_b64_tr_b16 a[216:217], v12 offset:16384
    ds_read_b64_tr_b16 a[218:219], v12 offset:20480
    ds_read_b64_tr_b16 a[220:221], v12 offset:24576
    ds_read_b64_tr_b16 a[222:223], v12 offset:28672
    ds_read_b64_tr_b16 a[224:225], v16 offset:0
    ds_read_b64_tr_b16 a[226:227], v16 offset:4096
    ds_read_b64_tr_b16 a[228:229], v16 offset:8192
    ds_read_b64_tr_b16 a[230:231], v16 offset:12288
    ds_read_b64_tr_b16 a[232:233], v16 offset:16384
    ds_read_b64_tr_b16 a[234:235], v16 offset:20480
    ds_read_b64_tr_b16 a[236:237], v16 offset:24576
    ds_read_b64_tr_b16 a[238:239], v16 offset:28672
    s_andn2_b32 s36, s36, s48
    s_cbranch_scc1 Lattn_redo
    s_cmp_lt_u32 s37, 256
    s_cbranch_scc1 Lattn_armwait
Lattn_armed:
    v_accvgpr_read_b32 v216, a0
    v_accvgpr_read_b32 v217, a1
    v_accvgpr_read_b32 v218, a2
    v_accvgpr_read_b32 v219, a3
    v_pk_mul_f32 v[216:217], v[216:217], v[58:59] op_sel:[0,0] op_sel_hi:[1,0]
    v_pk_mul_f32 v[218:219], v[218:219], v[58:59] op_sel:[0,0] op_sel_hi:[1,0]
    v_cvt_pk_bf16_f32 v128, v216, v217
    v_cvt_pk_bf16_f32 v129, v218, v219
    v_accvgpr_read_b32 v220, a4
    v_accvgpr_read_b32 v221, a5
    v_accvgpr_read_b32 v222, a6
    v_accvgpr_read_b32 v223, a7
    v_pk_mul_f32 v[220:221], v[220:221], v[58:59] op_sel:[0,1] op_sel_hi:[1,1]
    v_pk_mul_f32 v[222:223], v[222:223], v[58:59] op_sel:[0,1] op_sel_hi:[1,1]
    v_cvt_pk_bf16_f32 v160, v220, v221
    v_cvt_pk_bf16_f32 v161, v222, v223
    v_accvgpr_read_b32 v224, a8
    v_accvgpr_read_b32 v225, a9
    v_accvgpr_read_b32 v226, a10
    v_accvgpr_read_b32 v227, a11
    v_pk_mul_f32 v[224:225], v[224:225], v[60:61] op_sel:[0,0] op_sel_hi:[1,0]
    v_pk_mul_f32 v[226:227], v[226:227], v[60:61] op_sel:[0,0] op_sel_hi:[1,0]
    v_cvt_pk_bf16_f32 v144, v224, v225
    v_cvt_pk_bf16_f32 v145, v226, v227
    v_accvgpr_read_b32 v228, a12
    v_accvgpr_read_b32 v229, a13
    v_accvgpr_read_b32 v230, a14
    v_accvgpr_read_b32 v231, a15
    v_pk_mul_f32 v[228:229], v[228:229], v[60:61] op_sel:[0,1] op_sel_hi:[1,1]
    v_pk_mul_f32 v[230:231], v[230:231], v[60:61] op_sel:[0,1] op_sel_hi:[1,1]
    v_cvt_pk_bf16_f32 v176, v228, v229
    v_cvt_pk_bf16_f32 v177, v230, v231
    v_accvgpr_read_b32 v216, a16
    v_accvgpr_read_b32 v217, a17
    v_accvgpr_read_b32 v218, a18
    v_accvgpr_read_b32 v219, a19
    v_pk_mul_f32 v[216:217], v[216:217], v[58:59] op_sel:[0,0] op_sel_hi:[1,0]
    v_pk_mul_f32 v[218:219], v[218:219], v[58:59] op_sel:[0,0] op_sel_hi:[1,0]
    v_cvt_pk_bf16_f32 v130, v216, v217
    v_cvt_pk_bf16_f32 v131, v218, v219
    s_add_u32 s37, s55, 0
    buffer_store_dwordx4 v[128:131], v252, s[28:31], s37 offen offset:0
    v_accvgpr_read_b32 v220, a20
    v_accvgpr_read_b32 v221, a21
    v_accvgpr_read_b32 v222, a22
    v_accvgpr_read_b32 v223, a23
    v_pk_mul_f32 v[220:221], v[220:221], v[58:59] op_sel:[0,1] op_sel_hi:[1,1]
    v_pk_mul_f32 v[222:223], v[222:223], v[58:59] op_sel:[0,1] op_sel_hi:[1,1]
    v_cvt_pk_bf16_f32 v162, v220, v221
    v_cvt_pk_bf16_f32 v163, v222, v223
    s_add_u32 s37, s55, 8192
    buffer_store_dwordx4 v[160:163], v252, s[28:31], s37 offen offset:0
    v_accvgpr_read_b32 v224, a24
    v_accvgpr_read_b32 v225, a25
    v_accvgpr_read_b32 v226, a26
    v_accvgpr_read_b32 v227, a27
    v_pk_mul_f32 v[224:225], v[224:225], v[60:61] op_sel:[0,0] op_sel_hi:[1,0]
    v_pk_mul_f32 v[226:227], v[226:227], v[60:61] op_sel:[0,0] op_sel_hi:[1,0]
    v_cvt_pk_bf16_f32 v146, v224, v225
    v_cvt_pk_bf16_f32 v147, v226, v227
    s_add_u32 s37, s55, 4096
    buffer_store_dwordx4 v[144:147], v252, s[28:31], s37 offen offset:0
    v_accvgpr_read_b32 v228, a28
    v_accvgpr_read_b32 v229, a29
    v_accvgpr_read_b32 v230, a30
    v_accvgpr_read_b32 v231, a31
    v_pk_mul_f32 v[228:229], v[228:229], v[60:61] op_sel:[0,1] op_sel_hi:[1,1]
    v_pk_mul_f32 v[230:231], v[230:231], v[60:61] op_sel:[0,1] op_sel_hi:[1,1]
    v_cvt_pk_bf16_f32 v178, v228, v229
    v_cvt_pk_bf16_f32 v179, v230, v231
    s_add_u32 s37, s55, 12288
    buffer_store_dwordx4 v[176:179], v252, s[28:31], s37 offen offset:0
    v_accvgpr_read_b32 v216, a32
    v_accvgpr_read_b32 v217, a33
    v_accvgpr_read_b32 v218, a34
    v_accvgpr_read_b32 v219, a35
    v_pk_mul_f32 v[216:217], v[216:217], v[58:59] op_sel:[0,0] op_sel_hi:[1,0]
    v_pk_mul_f32 v[218:219], v[218:219], v[58:59] op_sel:[0,0] op_sel_hi:[1,0]
    v_cvt_pk_bf16_f32 v132, v216, v217
    v_cvt_pk_bf16_f32 v133, v218, v219
    v_accvgpr_read_b32 v220, a36
    v_accvgpr_read_b32 v221, a37
    v_accvgpr_read_b32 v222, a38
    v_accvgpr_read_b32 v223, a39
    v_pk_mul_f32 v[220:221], v[220:221], v[58:59] op_sel:[0,1] op_sel_hi:[1,1]
    v_pk_mul_f32 v[222:223], v[222:223], v[58:59] op_sel:[0,1] op_sel_hi:[1,1]
    v_cvt_pk_bf16_f32 v164, v220, v221
    v_cvt_pk_bf16_f32 v165, v222, v223
    v_accvgpr_read_b32 v224, a40
    v_accvgpr_read_b32 v225, a41
    v_accvgpr_read_b32 v226, a42
    v_accvgpr_read_b32 v227, a43
    v_pk_mul_f32 v[224:225], v[224:225], v[60:61] op_sel:[0,0] op_sel_hi:[1,0]
    v_pk_mul_f32 v[226:227], v[226:227], v[60:61] op_sel:[0,0] op_sel_hi:[1,0]
    v_cvt_pk_bf16_f32 v148, v224, v225
    v_cvt_pk_bf16_f32 v149, v226, v227
    v_accvgpr_read_b32 v228, a44
    v_accvgpr_read_b32 v229, a45
    v_accvgpr_read_b32 v230, a46
    v_accvgpr_read_b32 v231, a47
    v_pk_mul_f32 v[228:229], v[228:229], v[60:61] op_sel:[0,1] op_sel_hi:[1,1]
    v_pk_mul_f32 v[230:231], v[230:231], v[60:61] op_sel:[0,1] op_sel_hi:[1,1]
    v_cvt_pk_bf16_f32 v180, v228, v229
    v_cvt_pk_bf16_f32 v181, v230, v231
    v_accvgpr_read_b32 v216, a48
    v_accvgpr_read_b32 v217, a49
    v_accvgpr_read_b32 v218, a50
    v_accvgpr_read_b32 v219, a51
    v_pk_mul_f32 v[216:217], v[216:217], v[58:59] op_sel:[0,0] op_sel_hi:[1,0]
    v_pk_mul_f32 v[218:219], v[218:219], v[58:59] op_sel:[0,0] op_sel_hi:[1,0]
    v_cvt_pk_bf16_f32 v134, v216, v217
    v_cvt_pk_bf16_f32 v135, v218, v219
    s_add_u32 s37, s55, 0
    buffer_store_dwordx4 v[132:135], v252, s[28:31], s37 offen offset:1024
    v_accvgpr_read_b32 v220, a52
    v_accvgpr_read_b32 v221, a53
    v_accvgpr_read_b32 v222, a54
    v_accvgpr_read_b32 v223, a55
    v_pk_mul_f32 v[220:221], v[220:221], v[58:59] op_sel:[0,1] op_sel_hi:[1,1]
    v_pk_mul_f32 v[222:223], v[222:223], v[58:59] op_sel:[0,1] op_sel_hi:[1,1]
    v_cvt_pk_bf16_f32 v166, v220, v221
    v_cvt_pk_bf16_f32 v167, v222, v223
    s_add_u32 s37, s55, 8192
    buffer_store_dwordx4 v[164:167], v252, s[28:31], s37 offen offset:1024
    v_accvgpr_read_b32 v224, a56
    v_accvgpr_read_b32 v225, a57
    v_accvgpr_read_b32 v226, a58
    v_accvgpr_read_b32 v227, a59
    v_pk_mul_f32 v[224:225], v[224:225], v[60:61] op_sel:[0,0] op_sel_hi:[1,0]
    v_pk_mul_f32 v[226:227], v[226:227], v[60:61] op_sel:[0,0] op_sel_hi:[1,0]
    v_cvt_pk_bf16_f32 v150, v224, v225
    v_cvt_pk_bf16_f32 v151, v226, v227
    s_add_u32 s37, s55, 4096
    buffer_store_dwordx4 v[148:151], v252, s[28:31], s37 offen offset:1024
    v_accvgpr_read_b32 v228, a60
    v_accvgpr_read_b32 v229, a61
    v_accvgpr_read_b32 v230, a62
    v_accvgpr_read_b32 v231, a63
    v_pk_mul_f32 v[228:229], v[228:229], v[60:61] op_sel:[0,1] op_sel_hi:[1,1]
    v_pk_mul_f32 v[230:231], v[230:231], v[60:61] op_sel:[0,1] op_sel_hi:[1,1]
    v_cvt_pk_bf16_f32 v182, v228, v229
    v_cvt_pk_bf16_f32 v183, v230, v231
    s_add_u32 s37, s55, 12288
    buffer_store_dwordx4 v[180:183], v252, s[28:31], s37 offen offset:1024
    v_accvgpr_read_b32 v216, a64
    v_accvgpr_read_b32 v217, a65
    v_accvgpr_read_b32 v218, a66
    v_accvgpr_read_b32 v219, a67
    v_pk_mul_f32 v[216:217], v[216:217], v[58:59] op_sel:[0,0] op_sel_hi:[1,0]
    v_pk_mul_f32 v[218:219], v[218:219], v[58:59] op_sel:[0,0] op_sel_hi:[1,0]
    v_cvt_pk_bf16_f32 v136, v216, v217
    v_cvt_pk_bf16_f32 v137, v218, v219
    v_accvgpr_read_b32 v220, a68
    v_accvgpr_read_b32 v221, a69
    v_accvgpr_read_b32 v222, a70
    v_accvgpr_read_b32 v223, a71
    v_pk_mul_f32 v[220:221], v[220:221], v[58:59] op_sel:[0,1] op_sel_hi:[1,1]
    v_pk_mul_f32 v[222:223], v[222:223], v[58:59] op_sel:[0,1] op_sel_hi:[1,1]
    v_cvt_pk_bf16_f32 v168, v220, v221
    v_cvt_pk_bf16_f32 v169, v222, v223
    v_accvgpr_read_b32 v224, a72
    v_accvgpr_read_b32 v225, a73
    v_accvgpr_read_b32 v226, a74
    v_accvgpr_read_b32 v227, a75
    v_pk_mul_f32 v[224:225], v[224:225], v[60:61] op_sel:[0,0] op_sel_hi:[1,0]
    v_pk_mul_f32 v[226:227], v[226:227], v[60:61] op_sel:[0,0] op_sel_hi:[1,0]
    v_cvt_pk_bf16_f32 v152, v224, v225
    v_cvt_pk_bf16_f32 v153, v226, v227
    v_accvgpr_read_b32 v228, a76
    v_accvgpr_read_b32 v229, a77
    v_accvgpr_read_b32 v230, a78
    v_accvgpr_read_b32 v231, a79
    v_pk_mul_f32 v[228:229], v[228:229], v[60:61] op_sel:[0,1] op_sel_hi:[1,1]
    v_pk_mul_f32 v[230:231], v[230:231], v[60:61] op_sel:[0,1] op_sel_hi:[1,1]
    v_cvt_pk_bf16_f32 v184, v228, v229
    v_cvt_pk_bf16_f32 v185, v230, v231
    v_accvgpr_read_b32 v216, a80
    v_accvgpr_read_b32 v217, a81
    v_accvgpr_read_b32 v218, a82
    v_accvgpr_read_b32 v219, a83
    v_pk_mul_f32 v[216:217], v[216:217], v[58:59] op_sel:[0,0] op_sel_hi:[1,0]
    v_pk_mul_f32 v[218:219], v[218:219], v[58:59] op_sel:[0,0] op_sel_hi:[1,0]
    v_cvt_pk_bf16_f32 v138, v216, v217
    v_cvt_pk_bf16_f32 v139, v218, v219
    s_add_u32 s37, s55, 0
    buffer_store_dwordx4 v[136:139], v252, s[28:31], s37 offen offset:2048
    v_accvgpr_read_b32 v220, a84
    v_accvgpr_read_b32 v221, a85
    v_accvgpr_read_b32 v222, a86
    v_accvgpr_read_b32 v223, a87
    v_pk_mul_f32 v[220:221], v[220:221], v[58:59] op_sel:[0,1] op_sel_hi:[1,1]
    v_pk_mul_f32 v[222:223], v[222:223], v[58:59] op_sel:[0,1] op_sel_hi:[1,1]
    v_cvt_pk_bf16_f32 v170, v220, v221
    v_cvt_pk_bf16_f32 v171, v222, v223
    s_add_u32 s37, s55, 8192
    buffer_store_dwordx4 v[168:171], v252, s[28:31], s37 offen offset:2048
    v_accvgpr_read_b32 v224, a88
    v_accvgpr_read_b32 v225, a89
    v_accvgpr_read_b32 v226, a90
    v_accvgpr_read_b32 v227, a91
    v_pk_mul_f32 v[224:225], v[224:225], v[60:61] op_sel:[0,0] op_sel_hi:[1,0]
    v_pk_mul_f32 v[226:227], v[226:227], v[60:61] op_sel:[0,0] op_sel_hi:[1,0]
    v_cvt_pk_bf16_f32 v154, v224, v225
    v_cvt_pk_bf16_f32 v155, v226, v227
    s_add_u32 s37, s55, 4096
    buffer_store_dwordx4 v[152:155], v252, s[28:31], s37 offen offset:2048
    v_accvgpr_read_b32 v228, a92
    v_accvgpr_read_b32 v229, a93
    v_accvgpr_read_b32 v230, a94
    v_accvgpr_read_b32 v231, a95
    v_pk_mul_f32 v[228:229], v[228:229], v[60:61] op_sel:[0,1] op_sel_hi:[1,1]
    v_pk_mul_f32 v[230:231], v[230:231], v[60:61] op_sel:[0,1] op_sel_hi:[1,1]
    v_cvt_pk_bf16_f32 v186, v228, v229
    v_cvt_pk_bf16_f32 v187, v230, v231
    s_add_u32 s37, s55, 12288
    buffer_store_dwordx4 v[184:187], v252, s[28:31], s37 offen offset:2048
    v_accvgpr_read_b32 v216, a96
    v_accvgpr_read_b32 v217, a97
    v_accvgpr_read_b32 v218, a98
    v_accvgpr_read_b32 v219, a99
    v_pk_mul_f32 v[216:217], v[216:217], v[58:59] op_sel:[0,0] op_sel_hi:[1,0]
    v_pk_mul_f32 v[218:219], v[218:219], v[58:59] op_sel:[0,0] op_sel_hi:[1,0]
    v_cvt_pk_bf16_f32 v140, v216, v217
    v_cvt_pk_bf16_f32 v141, v218, v219
    v_accvgpr_read_b32 v220, a100
    v_accvgpr_read_b32 v221, a101
    v_accvgpr_read_b32 v222, a102
    v_accvgpr_read_b32 v223, a103
    v_pk_mul_f32 v[220:221], v[220:221], v[58:59] op_sel:[0,1] op_sel_hi:[1,1]
    v_pk_mul_f32 v[222:223], v[222:223], v[58:59] op_sel:[0,1] op_sel_hi:[1,1]
    v_cvt_pk_bf16_f32 v172, v220, v221
    v_cvt_pk_bf16_f32 v173, v222, v223
    v_accvgpr_read_b32 v224, a104
    v_accvgpr_read_b32 v225, a105
    v_accvgpr_read_b32 v226, a106
    v_accvgpr_read_b32 v227, a107
    v_pk_mul_f32 v[224:225], v[224:225], v[60:61] op_sel:[0,0] op_sel_hi:[1,0]
    v_pk_mul_f32 v[226:227], v[226:227], v[60:61] op_sel:[0,0] op_sel_hi:[1,0]
    v_cvt_pk_bf16_f32 v156, v224, v225
    v_cvt_pk_bf16_f32 v157, v226, v227
    v_accvgpr_read_b32 v228, a108
    v_accvgpr_read_b32 v229, a109
    v_accvgpr_read_b32 v230, a110
    v_accvgpr_read_b32 v231, a111
    v_pk_mul_f32 v[228:229], v[228:229], v[60:61] op_sel:[0,1] op_sel_hi:[1,1]
    v_pk_mul_f32 v[230:231], v[230:231], v[60:61] op_sel:[0,1] op_sel_hi:[1,1]
    v_cvt_pk_bf16_f32 v188, v228, v229
    v_cvt_pk_bf16_f32 v189, v230, v231
    v_accvgpr_read_b32 v216, a112
    v_accvgpr_read_b32 v217, a113
    v_accvgpr_read_b32 v218, a114
    v_accvgpr_read_b32 v219, a115
    v_pk_mul_f32 v[216:217], v[216:217], v[58:59] op_sel:[0,0] op_sel_hi:[1,0]
    v_pk_mul_f32 v[218:219], v[218:219], v[58:59] op_sel:[0,0] op_sel_hi:[1,0]
    v_cvt_pk_bf16_f32 v142, v216, v217
    v_cvt_pk_bf16_f32 v143, v218, v219
    s_add_u32 s37, s55, 0
    buffer_store_dwordx4 v[140:143], v252, s[28:31], s37 offen offset:3072
    v_accvgpr_read_b32 v220, a116
    v_accvgpr_read_b32 v221, a117
    v_accvgpr_read_b32 v222, a118
    v_accvgpr_read_b32 v223, a119
    v_pk_mul_f32 v[220:221], v[220:221], v[58:59] op_sel:[0,1] op_sel_hi:[1,1]
    v_pk_mul_f32 v[222:223], v[222:223], v[58:59] op_sel:[0,1] op_sel_hi:[1,1]
    v_cvt_pk_bf16_f32 v174, v220, v221
    v_cvt_pk_bf16_f32 v175, v222, v223
    s_add_u32 s37, s55, 8192
    buffer_store_dwordx4 v[172:175], v252, s[28:31], s37 offen offset:3072
    v_accvgpr_read_b32 v224, a120
    v_accvgpr_read_b32 v225, a121
    v_accvgpr_read_b32 v226, a122
    v_accvgpr_read_b32 v227, a123
    v_pk_mul_f32 v[224:225], v[224:225], v[60:61] op_sel:[0,0] op_sel_hi:[1,0]
    v_pk_mul_f32 v[226:227], v[226:227], v[60:61] op_sel:[0,0] op_sel_hi:[1,0]
    v_cvt_pk_bf16_f32 v158, v224, v225
    v_cvt_pk_bf16_f32 v159, v226, v227
    s_add_u32 s37, s55, 4096
    buffer_store_dwordx4 v[156:159], v252, s[28:31], s37 offen offset:3072
    v_accvgpr_read_b32 v228, a124
    v_accvgpr_read_b32 v229, a125
    v_accvgpr_read_b32 v230, a126
    v_accvgpr_read_b32 v231, a127
    v_pk_mul_f32 v[228:229], v[228:229], v[60:61] op_sel:[0,1] op_sel_hi:[1,1]
    v_pk_mul_f32 v[230:231], v[230:231], v[60:61] op_sel:[0,1] op_sel_hi:[1,1]
    v_cvt_pk_bf16_f32 v190, v228, v229
    v_cvt_pk_bf16_f32 v191, v230, v231
    s_add_u32 s37, s55, 12288
    buffer_store_dwordx4 v[188:191], v252, s[28:31], s37 offen offset:3072
    s_waitcnt lgkmcnt(14)
    v_mfma_f32_16x16x32_bf16 v[96:99], a[208:211], v[128:131], 0
    s_waitcnt lgkmcnt(12)
    ds_read_b64_tr_b16 a[160:161], v13 offset:0
    v_mfma_f32_16x16x32_bf16 v[96:99], a[212:215], v[132:135], v[96:99]
    s_waitcnt lgkmcnt(11)
    ds_read_b64_tr_b16 a[162:163], v13 offset:4096
    v_mfma_f32_16x16x32_bf16 v[96:99], a[216:219], v[136:139], v[96:99]
    s_waitcnt lgkmcnt(10)
    ds_read_b64_tr_b16 a[164:165], v13 offset:8192
    v_mfma_f32_16x16x32_bf16 v[96:99], a[220:223], v[140:143], v[96:99]
    s_waitcnt lgkmcnt(9)
    ds_read_b64_tr_b16 a[166:167], v13 offset:12288
    v_mfma_f32_16x16x32_bf16 v[96:99], a[224:227], v[144:147], v[96:99]
    s_waitcnt lgkmcnt(8)
    ds_read_b64_tr_b16 a[168:169], v13 offset:16384
    v_mfma_f32_16x16x32_bf16 v[96:99], a[228:231], v[148:151], v[96:99]
    s_waitcnt lgkmcnt(7)
    ds_read_b64_tr_b16 a[170:171], v13 offset:20480
    v_mfma_f32_16x16x32_bf16 v[96:99], a[232:235], v[152:155], v[96:99]
    s_waitcnt lgkmcnt(6)
    ds_read_b64_tr_b16 a[172:173], v13 offset:24576
    v_mfma_f32_16x16x32_bf16 v[96:99], a[236:239], v[156:159], v[96:99]
    ds_read_b64_tr_b16 a[174:175], v13 offset:28672
    v_mfma_f32_16x16x32_bf16 v[100:103], a[208:211], v[160:163], 0
    ds_read_b64_tr_b16 a[176:177], v17 offset:0
    v_mfma_f32_16x16x32_bf16 v[100:103], a[212:215], v[164:167], v[100:103]
    ds_read_b64_tr_b16 a[178:179], v17 offset:4096
    v_mfma_f32_16x16x32_bf16 v[100:103], a[216:219], v[168:171], v[100:103]
    ds_read_b64_tr_b16 a[180:181], v17 offset:8192
    v_mfma_f32_16x16x32_bf16 v[100:103], a[220:223], v[172:175], v[100:103]
    ds_read_b64_tr_b16 a[182:183], v17 offset:12288
    v_mfma_f32_16x16x32_bf16 v[100:103], a[224:227], v[176:179], v[100:103]
    ds_read_b64_tr_b16 a[184:185], v17 offset:16384
    v_cvt_pk_bf16_f32 v224, v96, v97
    v_mfma_f32_16x16x32_bf16 v[100:103], a[228:231], v[180:183], v[100:103]
    ds_read_b64_tr_b16 a[186:187], v17 offset:20480
    v_cvt_pk_bf16_f32 v225, v98, v99
    v_mfma_f32_16x16x32_bf16 v[100:103], a[232:235], v[184:187], v[100:103]
    ds_read_b64_tr_b16 a[188:189], v17 offset:24576
    v_mfma_f32_16x16x32_bf16 v[100:103], a[236:239], v[188:191], v[100:103]
    s_waitcnt lgkmcnt(13)
    ds_read_b64_tr_b16 a[190:191], v17 offset:28672
    v_mfma_f32_16x16x32_bf16 v[104:107], a[160:163], v[128:131], 0
    s_waitcnt lgkmcnt(12)
    ds_read_b64_tr_b16 a[208:209], v14 offset:0
    v_mfma_f32_16x16x32_bf16 v[104:107], a[164:167], v[132:135], v[104:107]
    s_waitcnt lgkmcnt(11)
    ds_read_b64_tr_b16 a[210:211], v14 offset:4096
    v_mfma_f32_16x16x32_bf16 v[104:107], a[168:171], v[136:139], v[104:107]
    s_waitcnt lgkmcnt(10)
    ds_read_b64_tr_b16 a[212:213], v14 offset:8192
    v_mfma_f32_16x16x32_bf16 v[104:107], a[172:175], v[140:143], v[104:107]
    s_waitcnt lgkmcnt(9)
    ds_read_b64_tr_b16 a[214:215], v14 offset:12288
    v_mfma_f32_16x16x32_bf16 v[104:107], a[176:179], v[144:147], v[104:107]
    s_waitcnt lgkmcnt(8)
    ds_read_b64_tr_b16 a[216:217], v14 offset:16384
    v_cvt_pk_bf16_f32 v228, v100, v101
    v_mfma_f32_16x16x32_bf16 v[104:107], a[180:183], v[148:151], v[104:107]
    s_waitcnt lgkmcnt(7)
    ds_read_b64_tr_b16 a[218:219], v14 offset:20480
    v_cvt_pk_bf16_f32 v229, v102, v103
    v_mfma_f32_16x16x32_bf16 v[104:107], a[184:187], v[152:155], v[104:107]
    s_waitcnt lgkmcnt(6)
    ds_read_b64_tr_b16 a[220:221], v14 offset:24576
    v_mfma_f32_16x16x32_bf16 v[104:107], a[188:191], v[156:159], v[104:107]
    ds_read_b64_tr_b16 a[222:223], v14 offset:28672
    s_waitcnt vmcnt(0)
    s_cmp_eq_u32 s53, 0
    s_cbranch_scc1 Lattn_wb
Lattn_wbdone:
    v_mfma_f32_16x16x32_bf16 v[108:111], a[160:163], v[160:163], 0
    buffer_store_dword v10, v8, s[24:27], s92 offen offset:8 sc1
    v_mfma_f32_16x16x32_bf16 v[108:111], a[164:167], v[164:167], v[108:111]
    s_xor_b32 s55, s55, 65536
    ds_read_b64_tr_b16 a[224:225], v18 offset:0
    ds_read_b64_tr_b16 a[226:227], v18 offset:4096
    v_mfma_f32_16x16x32_bf16 v[108:111], a[168:171], v[168:171], v[108:111]
    ds_read_b64_tr_b16 a[228:229], v18 offset:8192
    v_mfma_f32_16x16x32_bf16 v[108:111], a[172:175], v[172:175], v[108:111]
    ds_read_b64_tr_b16 a[230:231], v18 offset:12288
    s_load_dwordx2 s[12:13], s[0:1], 0
    v_mfma_f32_16x16x32_bf16 v[108:111], a[176:179], v[176:179], v[108:111]
    ds_read_b64_tr_b16 a[232:233], v18 offset:16384
    v_cvt_pk_bf16_f32 v226, v104, v105
    v_mfma_f32_16x16x32_bf16 v[108:111], a[180:183], v[180:183], v[108:111]
    s_add_u32 s38, s56, 16384
    ds_read_b64_tr_b16 a[234:235], v18 offset:20480
    v_cvt_pk_bf16_f32 v227, v106, v107
    s_load_dwordx2 s[16:17], s[0:1], 96
    v_mfma_f32_16x16x32_bf16 v[108:111], a[184:187], v[184:187], v[108:111]
    buffer_store_dwordx4 v[224:227], v56, s[28:31], s38 offen sc1
    v_mfma_f32_16x16x32_bf16 v[108:111], a[188:191], v[188:191], v[108:111]
    s_waitcnt lgkmcnt(12)
    ds_read_b64_tr_b16 a[236:237], v18 offset:24576
    ds_read_b64_tr_b16 a[238:239], v18 offset:28672
    s_load_dwordx2 s[52:53], s[0:1], 48
    v_mfma_f32_16x16x32_bf16 v[112:115], a[208:211], v[128:131], 0
    s_waitcnt lgkmcnt(12)
    ds_read_b64_tr_b16 a[160:161], v15 offset:0
    v_mfma_f32_16x16x32_bf16 v[112:115], a[212:215], v[132:135], v[112:115]
    s_waitcnt lgkmcnt(11)
    ds_read_b64_tr_b16 a[162:163], v15 offset:4096
    v_mfma_f32_16x16x32_bf16 v[112:115], a[216:219], v[136:139], v[112:115]
    s_waitcnt lgkmcnt(10)
    ds_read_b64_tr_b16 a[164:165], v15 offset:8192
    v_mfma_f32_16x16x32_bf16 v[112:115], a[220:223], v[140:143], v[112:115]
    s_waitcnt lgkmcnt(9)
    ds_read_b64_tr_b16 a[166:167], v15 offset:12288
    v_mfma_f32_16x16x32_bf16 v[112:115], a[224:227], v[144:147], v[112:115]
    s_waitcnt lgkmcnt(8)
    ds_read_b64_tr_b16 a[168:169], v15 offset:16384
    v_cvt_pk_bf16_f32 v230, v108, v109
    v_mfma_f32_16x16x32_bf16 v[112:115], a[228:231], v[148:151], v[112:115]
    s_waitcnt lgkmcnt(7)
    s_add_u32 s38, s56, 180224
    ds_read_b64_tr_b16 a[170:171], v15 offset:20480
    v_cvt_pk_bf16_f32 v231, v110, v111
    v_mfma_f32_16x16x32_bf16 v[112:115], a[232:235], v[152:155], v[112:115]
    s_waitcnt lgkmcnt(6)
    buffer_store_dwordx4 v[228:231], v56, s[28:31], s38 offen sc1
    v_mfma_f32_16x16x32_bf16 v[112:115], a[236:239], v[156:159], v[112:115]
    ds_read_b64_tr_b16 a[172:173], v15 offset:24576
    ds_read_b64_tr_b16 a[174:175], v15 offset:28672
    v_mfma_f32_16x16x32_bf16 v[116:119], a[208:211], v[160:163], 0
    ds_read_b64_tr_b16 a[176:177], v19 offset:0
    v_mfma_f32_16x16x32_bf16 v[116:119], a[212:215], v[164:167], v[116:119]
    ds_read_b64_tr_b16 a[178:179], v19 offset:4096
    v_mfma_f32_16x16x32_bf16 v[116:119], a[216:219], v[168:171], v[116:119]
    ds_read_b64_tr_b16 a[180:181], v19 offset:8192
    v_mfma_f32_16x16x32_bf16 v[116:119], a[220:223], v[172:175], v[116:119]
    ds_read_b64_tr_b16 a[182:183], v19 offset:12288
    v_mfma_f32_16x16x32_bf16 v[116:119], a[224:227], v[176:179], v[116:119]
    ds_read_b64_tr_b16 a[184:185], v19 offset:16384
    v_cvt_pk_bf16_f32 v232, v112, v113
    v_mfma_f32_16x16x32_bf16 v[116:119], a[228:231], v[180:183], v[116:119]
    ds_read_b64_tr_b16 a[186:187], v19 offset:20480
    v_cvt_pk_bf16_f32 v233, v114, v115
    v_mfma_f32_16x16x32_bf16 v[116:119], a[232:235], v[184:187], v[116:119]
    ds_read_b64_tr_b16 a[188:189], v19 offset:24576
    v_mfma_f32_16x16x32_bf16 v[116:119], a[236:239], v[188:191], v[116:119]
    s_waitcnt lgkmcnt(13)
    ds_read_b64_tr_b16 a[190:191], v19 offset:28672
    s_barrier
    v_mfma_f32_16x16x32_bf16 v[120:123], a[160:163], v[128:131], 0
    s_waitcnt lgkmcnt(12)
    buffer_load_dword v11, v8, s[24:27], s54 offen offset:8 sc1
    v_mfma_f32_16x16x32_bf16 v[120:123], a[164:167], v[132:135], v[120:123]
    s_waitcnt lgkmcnt(10)
    ds_read_b64_tr_b16 a[208:209], v20 offset:0
    ds_read_b64_tr_b16 a[210:211], v20 offset:4096
    v_mfma_f32_16x16x32_bf16 v[120:123], a[168:171], v[136:139], v[120:123]
    s_waitcnt lgkmcnt(10)
    ds_read_b64_tr_b16 a[212:213], v20 offset:8192
    v_mfma_f32_16x16x32_bf16 v[120:123], a[172:175], v[140:143], v[120:123]
    s_waitcnt lgkmcnt(9)
    ds_read_b64_tr_b16 a[214:215], v20 offset:12288
    v_mfma_f32_16x16x32_bf16 v[120:123], a[176:179], v[144:147], v[120:123]
    s_waitcnt lgkmcnt(8)
    ds_read_b64_tr_b16 a[216:217], v20 offset:16384
    v_cvt_pk_bf16_f32 v236, v116, v117
    v_mfma_f32_16x16x32_bf16 v[120:123], a[180:183], v[148:151], v[120:123]
    s_waitcnt lgkmcnt(7)
    ds_read_b64_tr_b16 a[218:219], v20 offset:20480
    v_cvt_pk_bf16_f32 v237, v118, v119
    v_mfma_f32_16x16x32_bf16 v[120:123], a[184:187], v[152:155], v[120:123]
    s_waitcnt lgkmcnt(6)
    s_add_u32 s49, s46, 73728
    ds_read_b64_tr_b16 a[220:221], v20 offset:24576
    v_mfma_f32_16x16x32_bf16 v[120:123], a[188:191], v[156:159], v[120:123]
    s_add_u32 m0, s42, 114688
    ds_read_b64_tr_b16 a[222:223], v20 offset:28672
    v_mfma_f32_16x16x32_bf16 v[124:127], a[160:163], v[160:163], 0
    buffer_load_dwordx4 v46, s[20:23], s49 offen lds
    v_mfma_f32_16x16x32_bf16 v[124:127], a[164:167], v[164:167], v[124:127]
    ds_read_b64_tr_b16 a[224:225], v24 offset:0
    ds_read_b64_tr_b16 a[226:227], v24 offset:4096
    v_mfma_f32_16x16x32_bf16 v[124:127], a[168:171], v[168:171], v[124:127]
    buffer_load_dwordx4 v47, s[20:23], s49 offen offset:1024 lds
    v_mfma_f32_16x16x32_bf16 v[124:127], a[172:175], v[172:175], v[124:127]
    ds_read_b64_tr_b16 a[228:229], v24 offset:8192
    ds_read_b64_tr_b16 a[230:231], v24 offset:12288
    v_mfma_f32_16x16x32_bf16 v[124:127], a[176:179], v[176:179], v[124:127]
    ds_read_b64_tr_b16 a[232:233], v24 offset:16384
    v_cvt_pk_bf16_f32 v234, v120, v121
    v_mfma_f32_16x16x32_bf16 v[124:127], a[180:183], v[180:183], v[124:127]
    s_add_u32 s38, s56, 16512
    ds_read_b64_tr_b16 a[234:235], v24 offset:20480
    v_cvt_pk_bf16_f32 v235, v122, v123
    v_mfma_f32_16x16x32_bf16 v[124:127], a[184:187], v[184:187], v[124:127]
    buffer_store_dwordx4 v[232:235], v56, s[28:31], s38 offen sc1
    v_mfma_f32_16x16x32_bf16 v[124:127], a[188:191], v[188:191], v[124:127]
    s_waitcnt lgkmcnt(12)
    ds_read_b64_tr_b16 a[236:237], v24 offset:24576
    ds_read_b64_tr_b16 a[238:239], v24 offset:28672
    v_mfma_f32_16x16x32_bf16 v[64:67], a[208:211], v[128:131], 0
    s_waitcnt lgkmcnt(12)
    buffer_load_dwordx4 v48, s[20:23], s49 offen offset:2048 lds
    v_mfma_f32_16x16x32_bf16 v[64:67], a[212:215], v[132:135], v[64:67]
    s_waitcnt lgkmcnt(10)
    ds_read_b64_tr_b16 a[160:161], v21 offset:0
    ds_read_b64_tr_b16 a[162:163], v21 offset:4096
    v_mfma_f32_16x16x32_bf16 v[64:67], a[216:219], v[136:139], v[64:67]
    s_waitcnt lgkmcnt(10)
    buffer_load_dwordx4 v49, s[20:23], s49 offen offset:3072 lds
    v_mfma_f32_16x16x32_bf16 v[64:67], a[220:223], v[140:143], v[64:67]
    s_waitcnt lgkmcnt(8)
    ds_read_b64_tr_b16 a[164:165], v21 offset:8192
    ds_read_b64_tr_b16 a[166:167], v21 offset:12288
    v_mfma_f32_16x16x32_bf16 v[64:67], a[224:227], v[144:147], v[64:67]
    s_waitcnt lgkmcnt(8)
    ds_read_b64_tr_b16 a[168:169], v21 offset:16384
    v_cvt_pk_bf16_f32 v238, v124, v125
    v_mfma_f32_16x16x32_bf16 v[64:67], a[228:231], v[148:151], v[64:67]
    s_waitcnt lgkmcnt(7)
    s_add_u32 s38, s56, 180352
    ds_read_b64_tr_b16 a[170:171], v21 offset:20480
    v_cvt_pk_bf16_f32 v239, v126, v127
    v_mfma_f32_16x16x32_bf16 v[64:67], a[232:235], v[152:155], v[64:67]
    s_waitcnt lgkmcnt(6)
    buffer_store_dwordx4 v[236:239], v56, s[28:31], s38 offen sc1
    v_mfma_f32_16x16x32_bf16 v[64:67], a[236:239], v[156:159], v[64:67]
    ds_read_b64_tr_b16 a[172:173], v21 offset:24576
    ds_read_b64_tr_b16 a[174:175], v21 offset:28672
    v_mfma_f32_16x16x32_bf16 v[68:71], a[208:211], v[160:163], 0
    ds_read_b64_tr_b16 a[176:177], v25 offset:0
    v_mfma_f32_16x16x32_bf16 v[68:71], a[212:215], v[164:167], v[68:71]
    ds_read_b64_tr_b16 a[178:179], v25 offset:4096
    v_mfma_f32_16x16x32_bf16 v[68:71], a[216:219], v[168:171], v[68:71]
    ds_read_b64_tr_b16 a[180:181], v25 offset:8192
    v_mfma_f32_16x16x32_bf16 v[68:71], a[220:223], v[172:175], v[68:71]
    ds_read_b64_tr_b16 a[182:183], v25 offset:12288
    v_mfma_f32_16x16x32_bf16 v[68:71], a[224:227], v[176:179], v[68:71]
    ds_read_b64_tr_b16 a[184:185], v25 offset:16384
    v_mfma_f32_16x16x32_bf16 v[68:71], a[228:231], v[180:183], v[68:71]
    ds_read_b64_tr_b16 a[186:187], v25 offset:20480
    v_mfma_f32_16x16x32_bf16 v[68:71], a[232:235], v[184:187], v[68:71]
    ds_read_b64_tr_b16 a[188:189], v25 offset:24576
    v_mfma_f32_16x16x32_bf16 v[68:71], a[236:239], v[188:191], v[68:71]
    s_waitcnt lgkmcnt(13)
    ds_read_b64_tr_b16 a[190:191], v25 offset:28672
    v_mfma_f32_16x16x32_bf16 v[72:75], a[160:163], v[128:131], 0
    s_waitcnt lgkmcnt(12)
    ds_read_b64_tr_b16 a[208:209], v22 offset:0
    v_mfma_f32_16x16x32_bf16 v[72:75], a[164:167], v[132:135], v[72:75]
    s_waitcnt lgkmcnt(11)
    ds_read_b64_tr_b16 a[210:211], v22 offset:4096
    v_mfma_f32_16x16x32_bf16 v[72:75], a[168:171], v[136:139], v[72:75]
    s_waitcnt lgkmcnt(10)
    ds_read_b64_tr_b16 a[212:213], v22 offset:8192
    v_mfma_f32_16x16x32_bf16 v[72:75], a[172:175], v[140:143], v[72:75]
    s_waitcnt lgkmcnt(9)
    ds_read_b64_tr_b16 a[214:215], v22 offset:12288
    v_mfma_f32_16x16x32_bf16 v[72:75], a[176:179], v[144:147], v[72:75]
    s_waitcnt lgkmcnt(8)
    ds_read_b64_tr_b16 a[216:217], v22 offset:16384
    v_mfma_f32_16x16x32_bf16 v[72:75], a[180:183], v[148:151], v[72:75]
    s_waitcnt lgkmcnt(7)
    ds_read_b64_tr_b16 a[218:219], v22 offset:20480
    v_mfma_f32_16x16x32_bf16 v[72:75], a[184:187], v[152:155], v[72:75]
    s_waitcnt lgkmcnt(6)
    ds_read_b64_tr_b16 a[220:221], v22 offset:24576
    v_mfma_f32_16x16x32_bf16 v[72:75], a[188:191], v[156:159], v[72:75]
    ds_read_b64_tr_b16 a[222:223], v22 offset:28672
    v_mfma_f32_16x16x32_bf16 v[76:79], a[160:163], v[160:163], 0
    ds_read_b64_tr_b16 a[224:225], v26 offset:0
    v_mfma_f32_16x16x32_bf16 v[76:79], a[164:167], v[164:167], v[76:79]
    ds_read_b64_tr_b16 a[226:227], v26 offset:4096
    v_mfma_f32_16x16x32_bf16 v[76:79], a[168:171], v[168:171], v[76:79]
    ds_read_b64_tr_b16 a[228:229], v26 offset:8192
    v_mfma_f32_16x16x32_bf16 v[76:79], a[172:175], v[172:175], v[76:79]
    ds_read_b64_tr_b16 a[230:231], v26 offset:12288
    v_mfma_f32_16x16x32_bf16 v[76:79], a[176:179], v[176:179], v[76:79]
    ds_read_b64_tr_b16 a[232:233], v26 offset:16384
    v_mfma_f32_16x16x32_bf16 v[76:79], a[180:183], v[180:183], v[76:79]
    ds_read_b64_tr_b16 a[234:235], v26 offset:20480
    v_mfma_f32_16x16x32_bf16 v[76:79], a[184:187], v[184:187], v[76:79]
    ds_read_b64_tr_b16 a[236:237], v26 offset:24576
    v_mfma_f32_16x16x32_bf16 v[76:79], a[188:191], v[188:191], v[76:79]
    s_waitcnt lgkmcnt(13)
    ds_read_b64_tr_b16 a[238:239], v26 offset:28672
    v_mfma_f32_16x16x32_bf16 v[80:83], a[208:211], v[128:131], 0
    s_waitcnt lgkmcnt(12)
    ds_read_b64_tr_b16 a[160:161], v23 offset:0
    v_mfma_f32_16x16x32_bf16 v[80:83], a[212:215], v[132:135], v[80:83]
    s_waitcnt lgkmcnt(11)
    ds_read_b64_tr_b16 a[162:163], v23 offset:4096
    v_mfma_f32_16x16x32_bf16 v[80:83], a[216:219], v[136:139], v[80:83]
    s_waitcnt lgkmcnt(10)
    ds_read_b64_tr_b16 a[164:165], v23 offset:8192
    s_waitcnt vmcnt(6)
    v_readfirstlane_b32 s36, v11
    v_mfma_f32_16x16x32_bf16 v[80:83], a[220:223], v[140:143], v[80:83]
    s_waitcnt lgkmcnt(9)
    ds_read_b64_tr_b16 a[166:167], v23 offset:12288
    v_mfma_f32_16x16x32_bf16 v[80:83], a[224:227], v[144:147], v[80:83]
    ds_read_b64_tr_b16 a[168:169], v23 offset:16384
    s_cmp_lg_u32 s36, s95
    s_cbranch_scc1 Lattn_xspin
Lattn_xgot:
    s_waitcnt lgkmcnt(9)
    v_mfma_f32_16x16x32_bf16 v[80:83], a[228:231], v[148:151], v[80:83]
    s_waitcnt lgkmcnt(7)
    ds_read_b64_tr_b16 a[170:171], v23 offset:20480
    v_mfma_f32_16x16x32_bf16 v[80:83], a[232:235], v[152:155], v[80:83]
    s_waitcnt lgkmcnt(6)
    ds_read_b64_tr_b16 a[172:173], v23 offset:24576
    v_mfma_f32_16x16x32_bf16 v[80:83], a[236:239], v[156:159], v[80:83]
    s_add_u32 s37, s55, 0
    ds_read_b64_tr_b16 a[174:175], v23 offset:28672
    v_mfma_f32_16x16x32_bf16 v[84:87], a[208:211], v[160:163], 0
    buffer_load_dwordx4 a[64:67], v252, s[28:31], s37 offen offset:0 sc1
    v_mfma_f32_16x16x32_bf16 v[84:87], a[212:215], v[164:167], v[84:87]
    ds_read_b64_tr_b16 a[176:177], v27 offset:0
    ds_read_b64_tr_b16 a[178:179], v27 offset:4096
    v_mfma_f32_16x16x32_bf16 v[84:87], a[216:219], v[168:171], v[84:87]
    buffer_load_dwordx4 a[68:71], v252, s[28:31], s37 offen offset:1024 sc1
    v_mfma_f32_16x16x32_bf16 v[84:87], a[220:223], v[172:175], v[84:87]
    ds_read_b64_tr_b16 a[180:181], v27 offset:8192
    ds_read_b64_tr_b16 a[182:183], v27 offset:12288
    v_mfma_f32_16x16x32_bf16 v[84:87], a[224:227], v[176:179], v[84:87]
    ds_read_b64_tr_b16 a[184:185], v27 offset:16384
    v_mfma_f32_16x16x32_bf16 v[84:87], a[228:231], v[180:183], v[84:87]
    ds_read_b64_tr_b16 a[186:187], v27 offset:20480
    v_mfma_f32_16x16x32_bf16 v[84:87], a[232:235], v[184:187], v[84:87]
    buffer_load_dwordx4 a[72:75], v252, s[28:31], s37 offen offset:2048 sc1
    v_mfma_f32_16x16x32_bf16 v[84:87], a[236:239], v[188:191], v[84:87]
    s_waitcnt lgkmcnt(12)
    ds_read_b64_tr_b16 a[188:189], v27 offset:24576
    ds_read_b64_tr_b16 a[190:191], v27 offset:28672
    s_barrier
    v_mfma_f32_16x16x32_bf16 v[88:91], a[160:163], v[128:131], 0
    s_waitcnt lgkmcnt(12)
    ds_read_b64_tr_b16 a[208:209], v12 offset:32768
    v_mfma_f32_16x16x32_bf16 v[88:91], a[164:167], v[132:135], v[88:91]
    s_waitcnt lgkmcnt(11)
    ds_read_b64_tr_b16 a[210:211], v12 offset:36864
    v_mfma_f32_16x16x32_bf16 v[88:91], a[168:171], v[136:139], v[88:91]
    s_waitcnt lgkmcnt(10)
    buffer_load_dwordx4 a[76:79], v252, s[28:31], s37 offen offset:3072 sc1
    v_mfma_f32_16x16x32_bf16 v[88:91], a[172:175], v[140:143], v[88:91]
    s_waitcnt lgkmcnt(8)
    ds_read_b64_tr_b16 a[212:213], v12 offset:40960
    ds_read_b64_tr_b16 a[214:215], v12 offset:45056
    v_mfma_f32_16x16x32_bf16 v[88:91], a[176:179], v[144:147], v[88:91]
    s_waitcnt lgkmcnt(8)
    ds_read_b64_tr_b16 a[216:217], v12 offset:49152
    v_mfma_f32_16x16x32_bf16 v[88:91], a[180:183], v[148:151], v[88:91]
    s_waitcnt lgkmcnt(7)
    s_add_u32 s37, s55, 4096
    ds_read_b64_tr_b16 a[218:219], v12 offset:53248
    v_mfma_f32_16x16x32_bf16 v[88:91], a[184:187], v[152:155], v[88:91]
    s_waitcnt lgkmcnt(6)
    s_add_u32 s49, s46, 256
    buffer_load_dwordx4 a[80:83], v252, s[28:31], s37 offen offset:0 sc1
    v_mfma_f32_16x16x32_bf16 v[88:91], a[188:191], v[156:159], v[88:91]
    s_add_u32 m0, s42, 0
    ds_read_b64_tr_b16 a[220:221], v12 offset:57344
    ds_read_b64_tr_b16 a[222:223], v12 offset:61440
    v_mfma_f32_16x16x32_bf16 v[92:95], a[160:163], v[160:163], 0
    buffer_load_dwordx4 v46, s[20:23], s49 offen lds
    v_mfma_f32_16x16x32_bf16 v[92:95], a[164:167], v[164:167], v[92:95]
    ds_read_b64_tr_b16 a[224:225], v16 offset:32768
    ds_read_b64_tr_b16 a[226:227], v16 offset:36864
    v_mfma_f32_16x16x32_bf16 v[92:95], a[168:171], v[168:171], v[92:95]
    buffer_load_dwordx4 v47, s[20:23], s49 offen offset:1024 lds
    v_mfma_f32_16x16x32_bf16 v[92:95], a[172:175], v[172:175], v[92:95]
    ds_read_b64_tr_b16 a[228:229], v16 offset:40960
    ds_read_b64_tr_b16 a[230:231], v16 offset:45056
    v_mfma_f32_16x16x32_bf16 v[92:95], a[176:179], v[176:179], v[92:95]
    buffer_load_dwordx4 a[84:87], v252, s[28:31], s37 offen offset:1024 sc1
    v_mfma_f32_16x16x32_bf16 v[92:95], a[180:183], v[180:183], v[92:95]
    ds_read_b64_tr_b16 a[232:233], v16 offset:49152
    ds_read_b64_tr_b16 a[234:235], v16 offset:53248
    v_mfma_f32_16x16x32_bf16 v[92:95], a[184:187], v[184:187], v[92:95]
    ds_read_b64_tr_b16 a[236:237], v16 offset:57344
    v_mfma_f32_16x16x32_bf16 v[92:95], a[188:191], v[188:191], v[92:95]
    s_waitcnt lgkmcnt(13)
    ds_read_b64_tr_b16 a[238:239], v16 offset:61440
    v_mfma_f32_16x16x32_bf16 v[96:99], a[208:211], v[128:131], 0
    s_waitcnt lgkmcnt(12)
    buffer_load_dwordx4 v48, s[20:23], s49 offen offset:2048 lds
    v_mfma_f32_16x16x32_bf16 v[96:99], a[212:215], v[132:135], v[96:99]
    s_waitcnt lgkmcnt(10)
    ds_read_b64_tr_b16 a[160:161], v13 offset:32768
    ds_read_b64_tr_b16 a[162:163], v13 offset:36864
    v_mfma_f32_16x16x32_bf16 v[96:99], a[216:219], v[136:139], v[96:99]
    s_waitcnt lgkmcnt(10)
    buffer_load_dwordx4 v49, s[20:23], s49 offen offset:3072 lds
    v_mfma_f32_16x16x32_bf16 v[96:99], a[220:223], v[140:143], v[96:99]
    s_waitcnt lgkmcnt(8)
    ds_read_b64_tr_b16 a[164:165], v13 offset:40960
    ds_read_b64_tr_b16 a[166:167], v13 offset:45056
    v_mfma_f32_16x16x32_bf16 v[96:99], a[224:227], v[144:147], v[96:99]
    s_waitcnt lgkmcnt(8)
    buffer_load_dwordx4 a[88:91], v252, s[28:31], s37 offen offset:2048 sc1
    v_mfma_f32_16x16x32_bf16 v[96:99], a[228:231], v[148:151], v[96:99]
    s_waitcnt lgkmcnt(6)
    ds_read_b64_tr_b16 a[168:169], v13 offset:49152
    ds_read_b64_tr_b16 a[170:171], v13 offset:53248
    v_mfma_f32_16x16x32_bf16 v[96:99], a[232:235], v[152:155], v[96:99]
    s_waitcnt lgkmcnt(6)
    s_add_u32 s49, s46, 73984
    ds_read_b64_tr_b16 a[172:173], v13 offset:57344
    v_mfma_f32_16x16x32_bf16 v[96:99], a[236:239], v[156:159], v[96:99]
    s_add_u32 m0, s42, 16384
    ds_read_b64_tr_b16 a[174:175], v13 offset:61440
    v_mfma_f32_16x16x32_bf16 v[100:103], a[208:211], v[160:163], 0
    buffer_load_dwordx4 v46, s[20:23], s49 offen lds
    v_mfma_f32_16x16x32_bf16 v[100:103], a[212:215], v[164:167], v[100:103]
    ds_read_b64_tr_b16 a[176:177], v17 offset:32768
    ds_read_b64_tr_b16 a[178:179], v17 offset:36864
    v_mfma_f32_16x16x32_bf16 v[100:103], a[216:219], v[168:171], v[100:103]
    buffer_load_dwordx4 v47, s[20:23], s49 offen offset:1024 lds
    v_mfma_f32_16x16x32_bf16 v[100:103], a[220:223], v[172:175], v[100:103]
    ds_read_b64_tr_b16 a[180:181], v17 offset:40960
    ds_read_b64_tr_b16 a[182:183], v17 offset:45056
    v_mfma_f32_16x16x32_bf16 v[100:103], a[224:227], v[176:179], v[100:103]
    buffer_load_dwordx4 a[92:95], v252, s[28:31], s37 offen offset:3072 sc1
    v_mfma_f32_16x16x32_bf16 v[100:103], a[228:231], v[180:183], v[100:103]
    ds_read_b64_tr_b16 a[184:185], v17 offset:49152
    ds_read_b64_tr_b16 a[186:187], v17 offset:53248
    v_mfma_f32_16x16x32_bf16 v[100:103], a[232:235], v[184:187], v[100:103]
    ds_read_b64_tr_b16 a[188:189], v17 offset:57344
    v_mfma_f32_16x16x32_bf16 v[100:103], a[236:239], v[188:191], v[100:103]
    s_waitcnt lgkmcnt(13)
    ds_read_b64_tr_b16 a[190:191], v17 offset:61440
    v_mfma_f32_16x16x32_bf16 v[104:107], a[160:163], v[128:131], 0
    s_waitcnt lgkmcnt(12)
    buffer_load_dwordx4 v48, s[20:23], s49 offen offset:2048 lds
    v_mfma_f32_16x16x32_bf16 v[104:107], a[164:167], v[132:135], v[104:107]
    s_waitcnt lgkmcnt(10)
    ds_read_b64_tr_b16 a[208:209], v14 offset:32768
    ds_read_b64_tr_b16 a[210:211], v14 offset:36864
    v_mfma_f32_16x16x32_bf16 v[104:107], a[168:171], v[136:139], v[104:107]
    s_waitcnt lgkmcnt(10)
    buffer_load_dwordx4 v49, s[20:23], s49 offen offset:3072 lds
    v_mfma_f32_16x16x32_bf16 v[104:107], a[172:175], v[140:143], v[104:107]
    s_waitcnt lgkmcnt(8)
    s_add_u32 s37, s55, 8192
    ds_read_b64_tr_b16 a[212:213], v14 offset:40960
    ds_read_b64_tr_b16 a[214:215], v14 offset:45056
    v_mfma_f32_16x16x32_bf16 v[104:107], a[176:179], v[144:147], v[104:107]
    s_waitcnt lgkmcnt(8)
    buffer_load_dwordx4 a[96:99], v252, s[28:31], s37 offen offset:0 sc1
    v_mfma_f32_16x16x32_bf16 v[104:107], a[180:183], v[148:151], v[104:107]
    s_waitcnt lgkmcnt(6)
    ds_read_b64_tr_b16 a[216:217], v14 offset:49152
    ds_read_b64_tr_b16 a[218:219], v14 offset:53248
    v_mfma_f32_16x16x32_bf16 v[104:107], a[184:187], v[152:155], v[104:107]
    s_waitcnt lgkmcnt(6)
    buffer_load_dwordx4 a[100:103], v252, s[28:31], s37 offen offset:1024 sc1
    v_mfma_f32_16x16x32_bf16 v[104:107], a[188:191], v[156:159], v[104:107]
    ds_read_b64_tr_b16 a[220:221], v14 offset:57344
    ds_read_b64_tr_b16 a[222:223], v14 offset:61440
    v_mfma_f32_16x16x32_bf16 v[108:111], a[160:163], v[160:163], 0
    ds_read_b64_tr_b16 a[224:225], v18 offset:32768
    v_mfma_f32_16x16x32_bf16 v[108:111], a[164:167], v[164:167], v[108:111]
    ds_read_b64_tr_b16 a[226:227], v18 offset:36864
    v_mfma_f32_16x16x32_bf16 v[108:111], a[168:171], v[168:171], v[108:111]
    buffer_load_dwordx4 a[104:107], v252, s[28:31], s37 offen offset:2048 sc1
    v_mfma_f32_16x16x32_bf16 v[108:111], a[172:175], v[172:175], v[108:111]
    ds_read_b64_tr_b16 a[228:229], v18 offset:40960
    ds_read_b64_tr_b16 a[230:231], v18 offset:45056
    v_mfma_f32_16x16x32_bf16 v[108:111], a[176:179], v[176:179], v[108:111]
    ds_read_b64_tr_b16 a[232:233], v18 offset:49152
    v_mfma_f32_16x16x32_bf16 v[108:111], a[180:183], v[180:183], v[108:111]
    ds_read_b64_tr_b16 a[234:235], v18 offset:53248
    v_mfma_f32_16x16x32_bf16 v[108:111], a[184:187], v[184:187], v[108:111]
    buffer_load_dwordx4 a[108:111], v252, s[28:31], s37 offen offset:3072 sc1
    v_mfma_f32_16x16x32_bf16 v[108:111], a[188:191], v[188:191], v[108:111]
    s_waitcnt lgkmcnt(12)
    ds_read_b64_tr_b16 a[236:237], v18 offset:57344
    ds_read_b64_tr_b16 a[238:239], v18 offset:61440
    v_mfma_f32_16x16x32_bf16 v[112:115], a[208:211], v[128:131], 0
    s_waitcnt lgkmcnt(12)
    ds_read_b64_tr_b16 a[160:161], v15 offset:32768
    v_mfma_f32_16x16x32_bf16 v[112:115], a[212:215], v[132:135], v[112:115]
    s_waitcnt lgkmcnt(11)
    s_add_u32 s37, s55, 12288
    ds_read_b64_tr_b16 a[162:163], v15 offset:36864
    v_mfma_f32_16x16x32_bf16 v[112:115], a[216:219], v[136:139], v[112:115]
    s_waitcnt lgkmcnt(10)
    buffer_load_dwordx4 a[112:115], v252, s[28:31], s37 offen offset:0 sc1
    v_mfma_f32_16x16x32_bf16 v[112:115], a[220:223], v[140:143], v[112:115]
    s_waitcnt lgkmcnt(8)
    ds_read_b64_tr_b16 a[164:165], v15 offset:40960
    ds_read_b64_tr_b16 a[166:167], v15 offset:45056
    v_mfma_f32_16x16x32_bf16 v[112:115], a[224:227], v[144:147], v[112:115]
    s_waitcnt lgkmcnt(8)
    buffer_load_dwordx4 a[116:119], v252, s[28:31], s37 offen offset:1024 sc1
    v_mfma_f32_16x16x32_bf16 v[112:115], a[228:231], v[148:151], v[112:115]
    s_waitcnt lgkmcnt(6)
    ds_read_b64_tr_b16 a[168:169], v15 offset:49152
    ds_read_b64_tr_b16 a[170:171], v15 offset:53248
    v_mfma_f32_16x16x32_bf16 v[112:115], a[232:235], v[152:155], v[112:115]
    s_waitcnt lgkmcnt(6)
    ds_read_b64_tr_b16 a[172:173], v15 offset:57344
    v_mfma_f32_16x16x32_bf16 v[112:115], a[236:239], v[156:159], v[112:115]
    ds_read_b64_tr_b16 a[174:175], v15 offset:61440
    v_mfma_f32_16x16x32_bf16 v[116:119], a[208:211], v[160:163], 0
    buffer_load_dwordx4 a[120:123], v252, s[28:31], s37 offen offset:2048 sc1
    v_mfma_f32_16x16x32_bf16 v[116:119], a[212:215], v[164:167], v[116:119]
    ds_read_b64_tr_b16 a[176:177], v19 offset:32768
    ds_read_b64_tr_b16 a[178:179], v19 offset:36864
    v_mfma_f32_16x16x32_bf16 v[116:119], a[216:219], v[168:171], v[116:119]
    ds_read_b64_tr_b16 a[180:181], v19 offset:40960
    v_mfma_f32_16x16x32_bf16 v[116:119], a[220:223], v[172:175], v[116:119]
    ds_read_b64_tr_b16 a[182:183], v19 offset:45056
    v_mfma_f32_16x16x32_bf16 v[116:119], a[224:227], v[176:179], v[116:119]
    buffer_load_dwordx4 a[124:127], v252, s[28:31], s37 offen offset:3072 sc1
    v_mfma_f32_16x16x32_bf16 v[116:119], a[228:231], v[180:183], v[116:119]
    ds_read_b64_tr_b16 a[184:185], v19 offset:49152
    ds_read_b64_tr_b16 a[186:187], v19 offset:53248
    v_mfma_f32_16x16x32_bf16 v[116:119], a[232:235], v[184:187], v[116:119]
    ds_read_b64_tr_b16 a[188:189], v19 offset:57344
    v_mfma_f32_16x16x32_bf16 v[116:119], a[236:239], v[188:191], v[116:119]
    ds_read_b64_tr_b16 a[190:191], v19 offset:61440
    s_waitcnt vmcnt(25)
    s_waitcnt lgkmcnt(0)
    s_barrier
    v_mfma_f32_16x16x32_bf16 v[120:123], a[160:163], v[128:131], 0
    ds_read_b64_tr_b16 a[208:209], v20 offset:32768
    v_mfma_f32_16x16x32_bf16 v[120:123], a[164:167], v[132:135], v[120:123]
    ds_read_b64_tr_b16 a[210:211], v20 offset:36864
    v_mfma_f32_16x16x32_bf16 v[120:123], a[168:171], v[136:139], v[120:123]
    ds_read_b64_tr_b16 a[212:213], v20 offset:40960
    v_mfma_f32_16x16x32_bf16 v[120:123], a[172:175], v[140:143], v[120:123]
    ds_read_b64_tr_b16 a[214:215], v20 offset:45056
    v_mfma_f32_16x16x32_bf16 v[120:123], a[176:179], v[144:147], v[120:123]
    ds_read_b64_tr_b16 a[216:217], v20 offset:49152
    v_mfma_f32_16x16x32_bf16 v[120:123], a[180:183], v[148:151], v[120:123]
    ds_read_b64_tr_b16 a[218:219], v20 offset:53248
    v_mfma_f32_16x16x32_bf16 v[120:123], a[184:187], v[152:155], v[120:123]
    s_add_u32 s49, s7, 512
    ds_read_b64_tr_b16 a[220:221], v20 offset:57344
    v_mfma_f32_16x16x32_bf16 v[120:123], a[188:191], v[156:159], v[120:123]
    s_add_u32 m0, s42, 65536
    ds_read_b64_tr_b16 a[222:223], v20 offset:61440
    v_mfma_f32_16x16x32_bf16 v[124:127], a[160:163], v[160:163], 0
    buffer_load_dwordx4 v46, s[20:23], s49 offen lds
    v_mfma_f32_16x16x32_bf16 v[124:127], a[164:167], v[164:167], v[124:127]
    ds_read_b64_tr_b16 a[224:225], v24 offset:32768
    ds_read_b64_tr_b16 a[226:227], v24 offset:36864
    v_mfma_f32_16x16x32_bf16 v[124:127], a[168:171], v[168:171], v[124:127]
    buffer_load_dwordx4 v47, s[20:23], s49 offen offset:1024 lds
    v_mfma_f32_16x16x32_bf16 v[124:127], a[172:175], v[172:175], v[124:127]
    ds_read_b64_tr_b16 a[228:229], v24 offset:40960
    ds_read_b64_tr_b16 a[230:231], v24 offset:45056
    v_mfma_f32_16x16x32_bf16 v[124:127], a[176:179], v[176:179], v[124:127]
    ds_read_b64_tr_b16 a[232:233], v24 offset:49152
    v_mfma_f32_16x16x32_bf16 v[124:127], a[180:183], v[180:183], v[124:127]
    ds_read_b64_tr_b16 a[234:235], v24 offset:53248
    v_mfma_f32_16x16x32_bf16 v[124:127], a[184:187], v[184:187], v[124:127]
    ds_read_b64_tr_b16 a[236:237], v24 offset:57344
    v_mfma_f32_16x16x32_bf16 v[124:127], a[188:191], v[188:191], v[124:127]
    s_waitcnt vmcnt(25)
    s_waitcnt lgkmcnt(13)
    ds_read_b64_tr_b16 a[238:239], v24 offset:61440
    v_mfma_f32_16x16x32_bf16 v[64:67], a[208:211], a[64:67], v[64:67]
    s_waitcnt vmcnt(24)
    s_waitcnt lgkmcnt(12)
    buffer_load_dwordx4 v48, s[20:23], s49 offen offset:2048 lds
    v_mfma_f32_16x16x32_bf16 v[64:67], a[212:215], a[68:71], v[64:67]
    s_waitcnt vmcnt(24)
    s_waitcnt lgkmcnt(10)
    s_lshl_b32 s40, s5, 4
    ds_read_b64_tr_b16 a[160:161], v21 offset:32768
    ds_read_b64_tr_b16 a[162:163], v21 offset:36864
    v_mfma_f32_16x16x32_bf16 v[64:67], a[216:219], a[72:75], v[64:67]
    s_waitcnt vmcnt(23)
    s_waitcnt lgkmcnt(10)
    buffer_load_dwordx4 v49, s[20:23], s49 offen offset:3072 lds
    v_mfma_f32_16x16x32_bf16 v[64:67], a[220:223], a[76:79], v[64:67]
    s_waitcnt vmcnt(23)
    s_waitcnt lgkmcnt(8)
    s_add_u32 s40, s40, s4
    ds_read_b64_tr_b16 a[164:165], v21 offset:40960
    ds_read_b64_tr_b16 a[166:167], v21 offset:45056
    v_mfma_f32_16x16x32_bf16 v[64:67], a[224:227], a[80:83], v[64:67]
    s_waitcnt vmcnt(20)
    s_waitcnt lgkmcnt(8)
    ds_read_b64_tr_b16 a[168:169], v21 offset:49152
    v_and_b32 v240, 31, v1
    v_mfma_f32_16x16x32_bf16 v[64:67], a[228:231], a[84:87], v[64:67]
    s_waitcnt vmcnt(17)
    s_waitcnt lgkmcnt(7)
    ds_read_b64_tr_b16 a[170:171], v21 offset:53248
    v_lshrrev_b32 v241, 5, v1
    v_mfma_f32_16x16x32_bf16 v[64:67], a[232:235], a[88:91], v[64:67]
    s_waitcnt vmcnt(14)
    s_waitcnt lgkmcnt(6)
    s_add_u32 s49, s7, 74240
    ds_read_b64_tr_b16 a[172:173], v21 offset:57344
    v_cmp_gt_u32 vcc, 8, v240
    v_mfma_f32_16x16x32_bf16 v[64:67], a[236:239], a[92:95], v[64:67]
    s_waitcnt vmcnt(11)
    s_add_u32 m0, s42, 81920
    ds_read_b64_tr_b16 a[174:175], v21 offset:61440
    v_mov_b32 v242, 2147483648
    v_mfma_f32_16x16x32_bf16 v[68:71], a[208:211], a[96:99], v[68:71]
    s_waitcnt vmcnt(10)
    buffer_load_dwordx4 v46, s[20:23], s49 offen lds
    v_mfma_f32_16x16x32_bf16 v[68:71], a[212:215], a[100:103], v[68:71]
    s_waitcnt vmcnt(10)
    s_lshl_b32 s43, s40, 3
    ds_read_b64_tr_b16 a[176:177], v25 offset:32768
    ds_read_b64_tr_b16 a[178:179], v25 offset:36864
    v_mfma_f32_16x16x32_bf16 v[68:71], a[216:219], a[104:107], v[68:71]
    s_waitcnt vmcnt(9)
    buffer_load_dwordx4 v47, s[20:23], s49 offen offset:1024 lds
    v_mfma_f32_16x16x32_bf16 v[68:71], a[220:223], a[108:111], v[68:71]
    s_waitcnt vmcnt(9)
    s_lshl_b32 s44, s3, 1
    ds_read_b64_tr_b16 a[180:181], v25 offset:40960
    ds_read_b64_tr_b16 a[182:183], v25 offset:45056
    v_mfma_f32_16x16x32_bf16 v[68:71], a[224:227], a[112:115], v[68:71]
    s_waitcnt vmcnt(8)
    ds_read_b64_tr_b16 a[184:185], v25 offset:49152
    v_cvt_pk_bf16_f32 v224, v64, v65
    v_mfma_f32_16x16x32_bf16 v[68:71], a[228:231], a[116:119], v[68:71]
    s_waitcnt vmcnt(7)
    ds_read_b64_tr_b16 a[186:187], v25 offset:53248
    v_cvt_pk_bf16_f32 v225, v66, v67
    v_mfma_f32_16x16x32_bf16 v[68:71], a[232:235], a[120:123], v[68:71]
    s_waitcnt vmcnt(6)
    s_add_u32 s43, s43, s44
    ds_read_b64_tr_b16 a[188:189], v25 offset:57344
    v_cndmask_b32 v242, v242, 0, vcc
    v_mfma_f32_16x16x32_bf16 v[68:71], a[236:239], a[124:127], v[68:71]
    s_waitcnt lgkmcnt(13)
    ds_read_b64_tr_b16 a[190:191], v25 offset:61440
    v_add_u32 v7, s43, v241
    v_mfma_f32_16x16x32_bf16 v[72:75], a[160:163], a[64:67], v[72:75]
    s_waitcnt lgkmcnt(12)
    buffer_load_dwordx4 v48, s[20:23], s49 offen offset:2048 lds
    v_mfma_f32_16x16x32_bf16 v[72:75], a[164:167], a[68:71], v[72:75]
    s_waitcnt lgkmcnt(10)
    ds_read_b64_tr_b16 a[208:209], v22 offset:32768
    ds_read_b64_tr_b16 a[210:211], v22 offset:36864
    v_mfma_f32_16x16x32_bf16 v[72:75], a[168:171], a[72:75], v[72:75]
    s_waitcnt lgkmcnt(10)
    buffer_load_dwordx4 v49, s[20:23], s49 offen offset:3072 lds
    v_mfma_f32_16x16x32_bf16 v[72:75], a[172:175], a[76:79], v[72:75]
    s_waitcnt lgkmcnt(8)
    ds_read_b64_tr_b16 a[212:213], v22 offset:40960
    ds_read_b64_tr_b16 a[214:215], v22 offset:45056
    v_mfma_f32_16x16x32_bf16 v[72:75], a[176:179], a[80:83], v[72:75]
    s_waitcnt lgkmcnt(8)
    ds_read_b64_tr_b16 a[216:217], v22 offset:49152
    v_cvt_pk_bf16_f32 v228, v68, v69
    v_mfma_f32_16x16x32_bf16 v[72:75], a[180:183], a[84:87], v[72:75]
    s_waitcnt lgkmcnt(7)
    ds_read_b64_tr_b16 a[218:219], v22 offset:53248
    v_cvt_pk_bf16_f32 v229, v70, v71
    v_mfma_f32_16x16x32_bf16 v[72:75], a[184:187], a[88:91], v[72:75]
    s_waitcnt lgkmcnt(6)
    ds_read_b64_tr_b16 a[220:221], v22 offset:57344
    v_lshlrev_b32 v5, 4, v240
    v_mfma_f32_16x16x32_bf16 v[72:75], a[188:191], a[92:95], v[72:75]
    ds_read_b64_tr_b16 a[222:223], v22 offset:61440
    v_lshlrev_b32 v243, 4, v241
    v_mfma_f32_16x16x32_bf16 v[76:79], a[160:163], a[96:99], v[76:79]
    ds_read_b64_tr_b16 a[224:225], v26 offset:32768
    v_lshl_add_u32 v2, v240, 5, v243
    v_mfma_f32_16x16x32_bf16 v[76:79], a[164:167], a[100:103], v[76:79]
    s_mul_i32 s44, s43, 10240
    ds_read_b64_tr_b16 a[226:227], v26 offset:36864
    v_lshrrev_b32 v243, 2, v240
    v_mfma_f32_16x16x32_bf16 v[76:79], a[168:171], a[104:107], v[76:79]
    ds_read_b64_tr_b16 a[228:229], v26 offset:40960
    v_lshlrev_b32 v243, 6, v243
    v_mfma_f32_16x16x32_bf16 v[76:79], a[172:175], a[108:111], v[76:79]
    ds_read_b64_tr_b16 a[230:231], v26 offset:45056
    v_and_b32 v241, 3, v240
    v_mfma_f32_16x16x32_bf16 v[76:79], a[176:179], a[112:115], v[76:79]
    ds_read_b64_tr_b16 a[232:233], v26 offset:49152
    v_cvt_pk_bf16_f32 v226, v72, v73
    v_mfma_f32_16x16x32_bf16 v[76:79], a[180:183], a[116:119], v[76:79]
    s_add_u32 s38, s93, 0
    ds_read_b64_tr_b16 a[234:235], v26 offset:53248
    v_cvt_pk_bf16_f32 v227, v74, v75
    v_mfma_f32_16x16x32_bf16 v[76:79], a[184:187], a[120:123], v[76:79]
    buffer_store_dwordx4 v[224:227], v56, s[28:31], s38 offen sc1
    v_mfma_f32_16x16x32_bf16 v[76:79], a[188:191], a[124:127], v[76:79]
    s_waitcnt lgkmcnt(12)
    ds_read_b64_tr_b16 a[236:237], v26 offset:57344
    ds_read_b64_tr_b16 a[238:239], v26 offset:61440
    v_mfma_f32_16x16x32_bf16 v[80:83], a[208:211], a[64:67], v[80:83]
    s_waitcnt lgkmcnt(12)
    ds_read_b64_tr_b16 a[160:161], v23 offset:32768
    v_lshl_add_u32 v3, v241, 3, v243
    v_mfma_f32_16x16x32_bf16 v[80:83], a[212:215], a[68:71], v[80:83]
    s_waitcnt lgkmcnt(11)
    ds_read_b64_tr_b16 a[162:163], v23 offset:36864
    v_mul_u32_u24 v243, 1152, v7
    v_mfma_f32_16x16x32_bf16 v[80:83], a[216:219], a[72:75], v[80:83]
    s_waitcnt lgkmcnt(10)
    ds_read_b64_tr_b16 a[164:165], v23 offset:40960
    v_add_u32 v4, v243, v3
    v_mfma_f32_16x16x32_bf16 v[80:83], a[220:223], a[76:79], v[80:83]
    s_waitcnt lgkmcnt(9)
    ds_read_b64_tr_b16 a[166:167], v23 offset:45056
    v_add_u32 v6, v243, v5
    v_mfma_f32_16x16x32_bf16 v[80:83], a[224:227], a[80:83], v[80:83]
    s_waitcnt lgkmcnt(8)
    ds_read_b64_tr_b16 a[168:169], v23 offset:49152
    v_cvt_pk_bf16_f32 v230, v76, v77
    v_mfma_f32_16x16x32_bf16 v[80:83], a[228:231], a[84:87], v[80:83]
    s_waitcnt lgkmcnt(7)
    s_add_u32 s38, s93, 163840
    ds_read_b64_tr_b16 a[170:171], v23 offset:53248
    v_cvt_pk_bf16_f32 v231, v78, v79
    v_mfma_f32_16x16x32_bf16 v[80:83], a[232:235], a[88:91], v[80:83]
    s_waitcnt lgkmcnt(6)
    buffer_store_dwordx4 v[228:231], v56, s[28:31], s38 offen sc1
    v_mfma_f32_16x16x32_bf16 v[80:83], a[236:239], a[92:95], v[80:83]
    ds_read_b64_tr_b16 a[172:173], v23 offset:57344
    ds_read_b64_tr_b16 a[174:175], v23 offset:61440
    v_mfma_f32_16x16x32_bf16 v[84:87], a[208:211], a[96:99], v[84:87]
    ds_read_b64_tr_b16 a[176:177], v27 offset:32768
    v_or_b32 v55, v3, v242
    v_mfma_f32_16x16x32_bf16 v[84:87], a[212:215], a[100:103], v[84:87]
    ds_read_b64_tr_b16 a[178:179], v27 offset:36864
    v_or_b32 v58, v4, v242
    v_mfma_f32_16x16x32_bf16 v[84:87], a[216:219], a[104:107], v[84:87]
    ds_read_b64_tr_b16 a[180:181], v27 offset:40960
    v_or_b32 v59, v5, v242
    v_mfma_f32_16x16x32_bf16 v[84:87], a[220:223], a[108:111], v[84:87]
    ds_read_b64_tr_b16 a[182:183], v27 offset:45056
    v_or_b32 v60, v6, v242
    v_mfma_f32_16x16x32_bf16 v[84:87], a[224:227], a[112:115], v[84:87]
    ds_read_b64_tr_b16 a[184:185], v27 offset:49152
    v_cvt_pk_bf16_f32 v232, v80, v81
    v_mfma_f32_16x16x32_bf16 v[84:87], a[228:231], a[116:119], v[84:87]
    ds_read_b64_tr_b16 a[186:187], v27 offset:53248
    v_cvt_pk_bf16_f32 v233, v82, v83
    v_mfma_f32_16x16x32_bf16 v[84:87], a[232:235], a[120:123], v[84:87]
    ds_read_b64_tr_b16 a[188:189], v27 offset:57344
    v_lshrrev_b32 v243, 4, v1
    v_mfma_f32_16x16x32_bf16 v[84:87], a[236:239], a[124:127], v[84:87]
    s_waitcnt lgkmcnt(13)
    ds_read_b64_tr_b16 a[190:191], v27 offset:61440
    v_lshlrev_b32 v243, 8, v243
    s_barrier
    v_mfma_f32_16x16x32_bf16 v[88:91], a[160:163], a[64:67], v[88:91]
    s_waitcnt lgkmcnt(12)
    ds_read_b64_tr_b16 a[208:209], v12 offset:0
    v_and_b32 v241, 7, v1
    v_mfma_f32_16x16x32_bf16 v[88:91], a[164:167], a[68:71], v[88:91]
    s_waitcnt lgkmcnt(11)
    ds_read_b64_tr_b16 a[210:211], v12 offset:4096
    v_lshl_add_u32 v243, v241, 5, v243
    v_mfma_f32_16x16x32_bf16 v[88:91], a[168:171], a[72:75], v[88:91]
    s_waitcnt lgkmcnt(10)
    ds_read_b64_tr_b16 a[212:213], v12 offset:8192
    v_and_b32 v241, 8, v1
    v_mfma_f32_16x16x32_bf16 v[88:91], a[172:175], a[76:79], v[88:91]
    s_waitcnt lgkmcnt(9)
    ds_read_b64_tr_b16 a[214:215], v12 offset:12288
    v_lshl_add_u32 v54, v241, 1, v243
    v_mfma_f32_16x16x32_bf16 v[88:91], a[176:179], a[80:83], v[88:91]
    s_waitcnt lgkmcnt(8)
    ds_read_b64_tr_b16 a[216:217], v12 offset:16384
    v_cvt_pk_bf16_f32 v236, v84, v85
    v_mfma_f32_16x16x32_bf16 v[88:91], a[180:183], a[84:87], v[88:91]
    s_waitcnt lgkmcnt(7)
    ds_read_b64_tr_b16 a[218:219], v12 offset:20480
    v_cvt_pk_bf16_f32 v237, v86, v87
    v_mfma_f32_16x16x32_bf16 v[88:91], a[184:187], a[88:91], v[88:91]
    s_waitcnt lgkmcnt(6)
    s_add_u32 s49, s46, 512
    ds_read_b64_tr_b16 a[220:221], v12 offset:24576
    v_mfma_f32_16x16x32_bf16 v[88:91], a[188:191], a[92:95], v[88:91]
    s_add_u32 m0, s42, 32768
    ds_read_b64_tr_b16 a[222:223], v12 offset:28672
    v_mfma_f32_16x16x32_bf16 v[92:95], a[160:163], a[96:99], v[92:95]
    buffer_load_dwordx4 v46, s[20:23], s49 offen lds
    v_mfma_f32_16x16x32_bf16 v[92:95], a[164:167], a[100:103], v[92:95]
    s_lshr_b32 s41, s2, 3
    ds_read_b64_tr_b16 a[224:225], v16 offset:0
    ds_read_b64_tr_b16 a[226:227], v16 offset:4096
    v_mfma_f32_16x16x32_bf16 v[92:95], a[168:171], a[104:107], v[92:95]
    buffer_load_dwordx4 v47, s[20:23], s49 offen offset:1024 lds
    v_mfma_f32_16x16x32_bf16 v[92:95], a[172:175], a[108:111], v[92:95]
    s_mov_b32 s14, 2359296
    ds_read_b64_tr_b16 a[228:229], v16 offset:8192
    ds_read_b64_tr_b16 a[230:231], v16 offset:12288
    v_mfma_f32_16x16x32_bf16 v[92:95], a[176:179], a[112:115], v[92:95]
    ds_read_b64_tr_b16 a[232:233], v16 offset:16384
    v_cvt_pk_bf16_f32 v234, v88, v89
    v_mfma_f32_16x16x32_bf16 v[92:95], a[180:183], a[116:119], v[92:95]
    s_add_u32 s38, s93, 128
    ds_read_b64_tr_b16 a[234:235], v16 offset:20480
    v_cvt_pk_bf16_f32 v235, v90, v91
    v_mfma_f32_16x16x32_bf16 v[92:95], a[184:187], a[120:123], v[92:95]
    buffer_store_dwordx4 v[232:235], v56, s[28:31], s38 offen sc1
    v_mfma_f32_16x16x32_bf16 v[92:95], a[188:191], a[124:127], v[92:95]
    s_waitcnt lgkmcnt(12)
    s_mov_b32 s15, 0x20000
    ds_read_b64_tr_b16 a[236:237], v16 offset:24576
    ds_read_b64_tr_b16 a[238:239], v16 offset:28672
    v_mfma_f32_16x16x32_bf16 v[96:99], a[208:211], a[64:67], v[96:99]
    s_waitcnt lgkmcnt(12)
    buffer_load_dwordx4 v48, s[20:23], s49 offen offset:2048 lds
    v_mfma_f32_16x16x32_bf16 v[96:99], a[212:215], a[68:71], v[96:99]
    s_waitcnt lgkmcnt(10)
    s_mov_b32 s18, 2359296
    ds_read_b64_tr_b16 a[160:161], v13 offset:0
    ds_read_b64_tr_b16 a[162:163], v13 offset:4096
    v_mfma_f32_16x16x32_bf16 v[96:99], a[216:219], a[72:75], v[96:99]
    s_waitcnt lgkmcnt(10)
    buffer_load_dwordx4 v49, s[20:23], s49 offen offset:3072 lds
    v_mfma_f32_16x16x32_bf16 v[96:99], a[220:223], a[76:79], v[96:99]
    s_waitcnt lgkmcnt(8)
    s_mov_b32 s19, 0x20000
    ds_read_b64_tr_b16 a[164:165], v13 offset:8192
    ds_read_b64_tr_b16 a[166:167], v13 offset:12288
    v_mfma_f32_16x16x32_bf16 v[96:99], a[224:227], a[80:83], v[96:99]
    s_waitcnt lgkmcnt(8)
    ds_read_b64_tr_b16 a[168:169], v13 offset:16384
    v_cvt_pk_bf16_f32 v238, v92, v93
    v_mfma_f32_16x16x32_bf16 v[96:99], a[228:231], a[84:87], v[96:99]
    s_waitcnt lgkmcnt(7)
    s_add_u32 s38, s93, 163968
    ds_read_b64_tr_b16 a[170:171], v13 offset:20480
    v_cvt_pk_bf16_f32 v239, v94, v95
    v_mfma_f32_16x16x32_bf16 v[96:99], a[232:235], a[88:91], v[96:99]
    s_waitcnt lgkmcnt(6)
    s_add_u32 s49, s46, 74240
    buffer_store_dwordx4 v[236:239], v56, s[28:31], s38 offen sc1
    v_mfma_f32_16x16x32_bf16 v[96:99], a[236:239], a[92:95], v[96:99]
    s_add_u32 m0, s42, 49152
    ds_read_b64_tr_b16 a[172:173], v13 offset:24576
    ds_read_b64_tr_b16 a[174:175], v13 offset:28672
    v_mfma_f32_16x16x32_bf16 v[100:103], a[208:211], a[96:99], v[100:103]
    buffer_load_dwordx4 v46, s[20:23], s49 offen lds
    v_mfma_f32_16x16x32_bf16 v[100:103], a[212:215], a[100:103], v[100:103]
    s_add_u32 s8, s50, 7864320
    s_addc_u32 s9, s51, 0
    ds_read_b64_tr_b16 a[176:177], v17 offset:0
    ds_read_b64_tr_b16 a[178:179], v17 offset:4096
    v_mfma_f32_16x16x32_bf16 v[100:103], a[216:219], a[104:107], v[100:103]
    buffer_load_dwordx4 v47, s[20:23], s49 offen offset:1024 lds
    v_mfma_f32_16x16x32_bf16 v[100:103], a[220:223], a[108:111], v[100:103]
    s_mov_b32 s10, 663552
    ds_read_b64_tr_b16 a[180:181], v17 offset:8192
    ds_read_b64_tr_b16 a[182:183], v17 offset:12288
    v_mfma_f32_16x16x32_bf16 v[100:103], a[224:227], a[112:115], v[100:103]
    ds_read_b64_tr_b16 a[184:185], v17 offset:16384
    v_cvt_pk_bf16_f32 v224, v96, v97
    v_mfma_f32_16x16x32_bf16 v[100:103], a[228:231], a[116:119], v[100:103]
    ds_read_b64_tr_b16 a[186:187], v17 offset:20480
    v_cvt_pk_bf16_f32 v225, v98, v99
    v_mfma_f32_16x16x32_bf16 v[100:103], a[232:235], a[120:123], v[100:103]
    s_mov_b32 s11, 0x20000
    ds_read_b64_tr_b16 a[188:189], v17 offset:24576
    v_mfma_f32_16x16x32_bf16 v[100:103], a[236:239], a[124:127], v[100:103]
    s_waitcnt lgkmcnt(13)
    s_lshl_b32 s39, s5, 13
    ds_read_b64_tr_b16 a[190:191], v17 offset:28672
    v_mfma_f32_16x16x32_bf16 v[104:107], a[160:163], a[64:67], v[104:107]
    s_waitcnt lgkmcnt(12)
    buffer_load_dwordx4 v48, s[20:23], s49 offen offset:2048 lds
    v_mfma_f32_16x16x32_bf16 v[104:107], a[164:167], a[68:71], v[104:107]
    s_waitcnt lgkmcnt(10)
    s_add_u32 s39, s39, 8781824
    ds_read_b64_tr_b16 a[208:209], v14 offset:0
    ds_read_b64_tr_b16 a[210:211], v14 offset:4096
    v_mfma_f32_16x16x32_bf16 v[104:107], a[168:171], a[72:75], v[104:107]
    s_waitcnt lgkmcnt(10)
    buffer_load_dwordx4 v49, s[20:23], s49 offen offset:3072 lds
    v_mfma_f32_16x16x32_bf16 v[104:107], a[172:175], a[76:79], v[104:107]
    s_waitcnt lgkmcnt(8)
    s_lshr_b32 s45, s4, 2
    ds_read_b64_tr_b16 a[212:213], v14 offset:8192
    ds_read_b64_tr_b16 a[214:215], v14 offset:12288
    v_mfma_f32_16x16x32_bf16 v[104:107], a[176:179], a[80:83], v[104:107]
    s_waitcnt lgkmcnt(8)
    ds_read_b64_tr_b16 a[216:217], v14 offset:16384
    v_cvt_pk_bf16_f32 v228, v100, v101
    v_mfma_f32_16x16x32_bf16 v[104:107], a[180:183], a[84:87], v[104:107]
    s_waitcnt lgkmcnt(7)
    ds_read_b64_tr_b16 a[218:219], v14 offset:20480
    v_cvt_pk_bf16_f32 v229, v102, v103
    v_mfma_f32_16x16x32_bf16 v[104:107], a[184:187], a[88:91], v[104:107]
    s_waitcnt lgkmcnt(6)
    s_lshl_b32 s45, s45, 11
    ds_read_b64_tr_b16 a[220:221], v14 offset:24576
    v_mfma_f32_16x16x32_bf16 v[104:107], a[188:191], a[92:95], v[104:107]
    s_add_u32 s39, s39, s45
    ds_read_b64_tr_b16 a[222:223], v14 offset:28672
    v_and_b32 v9, 15, v1
    v_mfma_f32_16x16x32_bf16 v[108:111], a[160:163], a[96:99], v[108:111]
    ds_read_b64_tr_b16 a[224:225], v18 offset:0
    v_lshlrev_b32 v9, 7, v9
    v_mfma_f32_16x16x32_bf16 v[108:111], a[164:167], a[100:103], v[108:111]
    ds_read_b64_tr_b16 a[226:227], v18 offset:4096
    v_lshrrev_b32 v240, 4, v1
    v_mfma_f32_16x16x32_bf16 v[108:111], a[168:171], a[104:107], v[108:111]
    ds_read_b64_tr_b16 a[228:229], v18 offset:8192
    v_bfe_u32 v241, v1, 2, 2
    v_mfma_f32_16x16x32_bf16 v[108:111], a[172:175], a[108:111], v[108:111]
    ds_read_b64_tr_b16 a[230:231], v18 offset:12288
    v_cmp_eq_u32 s[54:55], v240, v241
    v_mfma_f32_16x16x32_bf16 v[108:111], a[176:179], a[112:115], v[108:111]
    ds_read_b64_tr_b16 a[232:233], v18 offset:16384
    v_cvt_pk_bf16_f32 v226, v104, v105
    v_mfma_f32_16x16x32_bf16 v[108:111], a[180:183], a[116:119], v[108:111]
    s_add_u32 s38, s93, 512
    ds_read_b64_tr_b16 a[234:235], v18 offset:20480
    v_cvt_pk_bf16_f32 v227, v106, v107
    v_mfma_f32_16x16x32_bf16 v[108:111], a[184:187], a[120:123], v[108:111]
    buffer_store_dwordx4 v[224:227], v56, s[28:31], s38 offen sc1
    v_mfma_f32_16x16x32_bf16 v[108:111], a[188:191], a[124:127], v[108:111]
    s_waitcnt lgkmcnt(12)
    ds_read_b64_tr_b16 a[236:237], v18 offset:24576
    ds_read_b64_tr_b16 a[238:239], v18 offset:28672
    v_mfma_f32_16x16x32_bf16 v[112:115], a[208:211], a[64:67], v[112:115]
    s_waitcnt lgkmcnt(12)
    ds_read_b64_tr_b16 a[160:161], v15 offset:0
    v_and_b32 v240, 1, v1
    v_mfma_f32_16x16x32_bf16 v[112:115], a[212:215], a[68:71], v[112:115]
    s_waitcnt lgkmcnt(11)
    ds_read_b64_tr_b16 a[162:163], v15 offset:4096
    v_lshlrev_b32 v240, 4, v240
    v_mfma_f32_16x16x32_bf16 v[112:115], a[216:219], a[72:75], v[112:115]
    s_waitcnt lgkmcnt(10)
    ds_read_b64_tr_b16 a[164:165], v15 offset:8192
    v_mov_b32 v241, 0x3f80
    v_mfma_f32_16x16x32_bf16 v[112:115], a[220:223], a[76:79], v[112:115]
    s_waitcnt lgkmcnt(9)
    ds_read_b64_tr_b16 a[166:167], v15 offset:12288
    v_lshlrev_b32 v240, v240, v241
    v_mfma_f32_16x16x32_bf16 v[112:115], a[224:227], a[80:83], v[112:115]
    s_waitcnt lgkmcnt(8)
    ds_read_b64_tr_b16 a[168:169], v15 offset:16384
    v_cvt_pk_bf16_f32 v230, v108, v109
    v_mfma_f32_16x16x32_bf16 v[112:115], a[228:231], a[84:87], v[112:115]
    s_waitcnt lgkmcnt(7)
    s_add_u32 s38, s93, 164352
    ds_read_b64_tr_b16 a[170:171], v15 offset:20480
    v_cvt_pk_bf16_f32 v231, v110, v111
    v_mfma_f32_16x16x32_bf16 v[112:115], a[232:235], a[88:91], v[112:115]
    s_waitcnt lgkmcnt(6)
    buffer_store_dwordx4 v[228:231], v56, s[28:31], s38 offen sc1
    v_mfma_f32_16x16x32_bf16 v[112:115], a[236:239], a[92:95], v[112:115]
    ds_read_b64_tr_b16 a[172:173], v15 offset:24576
    ds_read_b64_tr_b16 a[174:175], v15 offset:28672
    v_mfma_f32_16x16x32_bf16 v[116:119], a[208:211], a[96:99], v[116:119]
    ds_read_b64_tr_b16 a[176:177], v19 offset:0
    v_bfe_i32 v241, v1, 1, 1
    v_mfma_f32_16x16x32_bf16 v[116:119], a[212:215], a[100:103], v[116:119]
    ds_read_b64_tr_b16 a[178:179], v19 offset:4096
    v_and_b32 v243, v240, v241
    v_mfma_f32_16x16x32_bf16 v[116:119], a[216:219], a[104:107], v[116:119]
    ds_read_b64_tr_b16 a[180:181], v19 offset:8192
    v_xor_b32 v242, v240, v243
    v_mfma_f32_16x16x32_bf16 v[116:119], a[220:223], a[108:111], v[116:119]
    ds_read_b64_tr_b16 a[182:183], v19 offset:12288
    v_cndmask_b32 v250, 0, v242, s[54:55]
    v_mfma_f32_16x16x32_bf16 v[116:119], a[224:227], a[112:115], v[116:119]
    ds_read_b64_tr_b16 a[184:185], v19 offset:16384
    v_cvt_pk_bf16_f32 v232, v112, v113
    v_mfma_f32_16x16x32_bf16 v[116:119], a[228:231], a[116:119], v[116:119]
    ds_read_b64_tr_b16 a[186:187], v19 offset:20480
    v_cvt_pk_bf16_f32 v233, v114, v115
    v_mfma_f32_16x16x32_bf16 v[116:119], a[232:235], a[120:123], v[116:119]
    ds_read_b64_tr_b16 a[188:189], v19 offset:24576
    v_cndmask_b32 v251, 0, v243, s[54:55]
    v_mfma_f32_16x16x32_bf16 v[116:119], a[236:239], a[124:127], v[116:119]
    s_waitcnt lgkmcnt(13)
    ds_read_b64_tr_b16 a[190:191], v19 offset:28672
    v_mov_b32 v248, 0
    s_waitcnt vmcnt(14)
    s_barrier
    v_mfma_f32_16x16x32_bf16 v[120:123], a[160:163], a[64:67], v[120:123]
    s_waitcnt lgkmcnt(12)
    ds_read_b64_tr_b16 a[208:209], v20 offset:0
    v_mov_b32 v249, 0
    v_mfma_f32_16x16x32_bf16 v[120:123], a[164:167], a[68:71], v[120:123]
    s_waitcnt lgkmcnt(11)
    ds_read_b64_tr_b16 a[210:211], v20 offset:4096
    v_mov_b32 v252, 0
    v_mfma_f32_16x16x32_bf16 v[120:123], a[168:171], a[72:75], v[120:123]
    s_waitcnt lgkmcnt(10)
    ds_read_b64_tr_b16 a[212:213], v20 offset:8192
    v_mov_b32 v253, 0
    v_mfma_f32_16x16x32_bf16 v[120:123], a[172:175], a[76:79], v[120:123]
    s_waitcnt lgkmcnt(9)
    ds_read_b64_tr_b16 a[214:215], v20 offset:12288
    v_mov_b32 v240, 0
    v_mfma_f32_16x16x32_bf16 v[120:123], a[176:179], a[80:83], v[120:123]
    s_waitcnt lgkmcnt(8)
    ds_read_b64_tr_b16 a[216:217], v20 offset:16384
    v_cvt_pk_bf16_f32 v236, v116, v117
    v_mfma_f32_16x16x32_bf16 v[120:123], a[180:183], a[84:87], v[120:123]
    s_waitcnt lgkmcnt(7)
    ds_read_b64_tr_b16 a[218:219], v20 offset:20480
    v_cvt_pk_bf16_f32 v237, v118, v119
    v_mfma_f32_16x16x32_bf16 v[120:123], a[184:187], a[88:91], v[120:123]
    s_waitcnt lgkmcnt(6)
    s_add_u32 s49, s7, 768
    ds_read_b64_tr_b16 a[220:221], v20 offset:24576
    v_mov_b32 v241, 0
    v_mfma_f32_16x16x32_bf16 v[120:123], a[188:191], a[92:95], v[120:123]
    s_add_u32 m0, s42, 98304
    ds_read_b64_tr_b16 a[222:223], v20 offset:28672
    v_mfma_f32_16x16x32_bf16 v[124:127], a[160:163], a[96:99], v[124:127]
    buffer_load_dwordx4 v46, s[20:23], s49 offen lds
    v_mfma_f32_16x16x32_bf16 v[124:127], a[164:167], a[100:103], v[124:127]
    ds_read_b64_tr_b16 a[224:225], v24 offset:0
    ds_read_b64_tr_b16 a[226:227], v24 offset:4096
    v_mfma_f32_16x16x32_bf16 v[124:127], a[168:171], a[104:107], v[124:127]
    buffer_load_dwordx4 v47, s[20:23], s49 offen offset:1024 lds
    v_mfma_f32_16x16x32_bf16 v[124:127], a[172:175], a[108:111], v[124:127]
    ds_read_b64_tr_b16 a[228:229], v24 offset:8192
    ds_read_b64_tr_b16 a[230:231], v24 offset:12288
    v_mfma_f32_16x16x32_bf16 v[124:127], a[176:179], a[112:115], v[124:127]
    ds_read_b64_tr_b16 a[232:233], v24 offset:16384
    v_cvt_pk_bf16_f32 v234, v120, v121
    v_mfma_f32_16x16x32_bf16 v[124:127], a[180:183], a[116:119], v[124:127]
    s_add_u32 s38, s93, 640
    ds_read_b64_tr_b16 a[234:235], v24 offset:20480
    v_cvt_pk_bf16_f32 v235, v122, v123
    v_mfma_f32_16x16x32_bf16 v[124:127], a[184:187], a[120:123], v[124:127]
    buffer_store_dwordx4 v[232:235], v56, s[28:31], s38 offen sc1
    v_mfma_f32_16x16x32_bf16 v[124:127], a[188:191], a[124:127], v[124:127]
    s_waitcnt lgkmcnt(12)
    ds_read_b64_tr_b16 a[236:237], v24 offset:24576
    ds_read_b64_tr_b16 a[238:239], v24 offset:28672
    v_mfma_f32_16x16x32_bf16 v[64:67], a[208:211], v[128:131], 0
    s_waitcnt lgkmcnt(12)
    buffer_load_dwordx4 v48, s[20:23], s49 offen offset:2048 lds
    v_mfma_f32_16x16x32_bf16 v[64:67], a[212:215], v[132:135], v[64:67]
    s_waitcnt lgkmcnt(10)
    ds_read_b64_tr_b16 a[160:161], v21 offset:0
    ds_read_b64_tr_b16 a[162:163], v21 offset:4096
    v_mfma_f32_16x16x32_bf16 v[64:67], a[216:219], v[136:139], v[64:67]
    s_waitcnt lgkmcnt(10)
    buffer_load_dwordx4 v49, s[20:23], s49 offen offset:3072 lds
    v_mfma_f32_16x16x32_bf16 v[64:67], a[220:223], v[140:143], v[64:67]
    s_waitcnt lgkmcnt(8)
    ds_read_b64_tr_b16 a[164:165], v21 offset:8192
    ds_read_b64_tr_b16 a[166:167], v21 offset:12288
    v_mfma_f32_16x16x32_bf16 v[64:67], a[224:227], v[144:147], v[64:67]
    s_waitcnt lgkmcnt(8)
    ds_read_b64_tr_b16 a[168:169], v21 offset:16384
    v_cvt_pk_bf16_f32 v238, v124, v125
    v_mfma_f32_16x16x32_bf16 v[64:67], a[228:231], v[148:151], v[64:67]
    s_waitcnt lgkmcnt(7)
    s_add_u32 s38, s93, 164480
    ds_read_b64_tr_b16 a[170:171], v21 offset:20480
    v_cvt_pk_bf16_f32 v239, v126, v127
    v_mfma_f32_16x16x32_bf16 v[64:67], a[232:235], v[152:155], v[64:67]
    s_waitcnt lgkmcnt(6)
    s_add_u32 s49, s7, 74496
    buffer_store_dwordx4 v[236:239], v56, s[28:31], s38 offen sc1
    v_mfma_f32_16x16x32_bf16 v[64:67], a[236:239], v[156:159], v[64:67]
    s_add_u32 m0, s42, 114688
    ds_read_b64_tr_b16 a[172:173], v21 offset:24576
    ds_read_b64_tr_b16 a[174:175], v21 offset:28672
    v_mfma_f32_16x16x32_bf16 v[68:71], a[208:211], v[160:163], 0
    buffer_load_dwordx4 v46, s[20:23], s49 offen lds
    v_mfma_f32_16x16x32_bf16 v[68:71], a[212:215], v[164:167], v[68:71]
    ds_read_b64_tr_b16 a[176:177], v25 offset:0
    ds_read_b64_tr_b16 a[178:179], v25 offset:4096
    v_mfma_f32_16x16x32_bf16 v[68:71], a[216:219], v[168:171], v[68:71]
    buffer_load_dwordx4 v47, s[20:23], s49 offen offset:1024 lds
    v_mfma_f32_16x16x32_bf16 v[68:71], a[220:223], v[172:175], v[68:71]
    ds_read_b64_tr_b16 a[180:181], v25 offset:8192
    ds_read_b64_tr_b16 a[182:183], v25 offset:12288
    v_mfma_f32_16x16x32_bf16 v[68:71], a[224:227], v[176:179], v[68:71]
    buffer_load_dwordx2 v[36:37], v4, s[12:15], 0 offen offset:0
    v_mfma_f32_16x16x32_bf16 v[68:71], a[228:231], v[180:183], v[68:71]
    ds_read_b64_tr_b16 a[184:185], v25 offset:16384
    ds_read_b64_tr_b16 a[186:187], v25 offset:20480
    v_mfma_f32_16x16x32_bf16 v[68:71], a[232:235], v[184:187], v[68:71]
    ds_read_b64_tr_b16 a[188:189], v25 offset:24576
    v_mfma_f32_16x16x32_bf16 v[68:71], a[236:239], v[188:191], v[68:71]
    s_waitcnt lgkmcnt(13)
    ds_read_b64_tr_b16 a[190:191], v25 offset:28672
    v_mfma_f32_16x16x32_bf16 v[72:75], a[160:163], v[128:131], 0
    s_waitcnt lgkmcnt(12)
    buffer_load_dwordx4 v48, s[20:23], s49 offen offset:2048 lds
    v_mfma_f32_16x16x32_bf16 v[72:75], a[164:167], v[132:135], v[72:75]
    s_waitcnt lgkmcnt(10)
    ds_read_b64_tr_b16 a[208:209], v22 offset:0
    ds_read_b64_tr_b16 a[210:211], v22 offset:4096
    v_mfma_f32_16x16x32_bf16 v[72:75], a[168:171], v[136:139], v[72:75]
    s_waitcnt lgkmcnt(10)
    buffer_load_dwordx4 v49, s[20:23], s49 offen offset:3072 lds
    v_mfma_f32_16x16x32_bf16 v[72:75], a[172:175], v[140:143], v[72:75]
    s_waitcnt lgkmcnt(8)
    ds_read_b64_tr_b16 a[212:213], v22 offset:8192
    ds_read_b64_tr_b16 a[214:215], v22 offset:12288
    v_mfma_f32_16x16x32_bf16 v[72:75], a[176:179], v[144:147], v[72:75]
    s_waitcnt lgkmcnt(8)
    buffer_load_dwordx2 v[38:39], v4, s[12:15], 0 offen offset:32
    v_mfma_f32_16x16x32_bf16 v[72:75], a[180:183], v[148:151], v[72:75]
    s_waitcnt lgkmcnt(6)
    ds_read_b64_tr_b16 a[216:217], v22 offset:16384
    ds_read_b64_tr_b16 a[218:219], v22 offset:20480
    v_mfma_f32_16x16x32_bf16 v[72:75], a[184:187], v[152:155], v[72:75]
    s_waitcnt lgkmcnt(6)
    ds_read_b64_tr_b16 a[220:221], v22 offset:24576
    v_mfma_f32_16x16x32_bf16 v[72:75], a[188:191], v[156:159], v[72:75]
    ds_read_b64_tr_b16 a[222:223], v22 offset:28672
    v_mfma_f32_16x16x32_bf16 v[76:79], a[160:163], v[160:163], 0
    buffer_load_dwordx2 v[40:41], v4, s[12:15], 0 offen offset:512
    v_mfma_f32_16x16x32_bf16 v[76:79], a[164:167], v[164:167], v[76:79]
    ds_read_b64_tr_b16 a[224:225], v26 offset:0
    ds_read_b64_tr_b16 a[226:227], v26 offset:4096
    v_mfma_f32_16x16x32_bf16 v[76:79], a[168:171], v[168:171], v[76:79]
    ds_read_b64_tr_b16 a[228:229], v26 offset:8192
    v_mfma_f32_16x16x32_bf16 v[76:79], a[172:175], v[172:175], v[76:79]
    ds_read_b64_tr_b16 a[230:231], v26 offset:12288
    v_mfma_f32_16x16x32_bf16 v[76:79], a[176:179], v[176:179], v[76:79]
    buffer_load_dwordx2 v[42:43], v4, s[12:15], 0 offen offset:544
    v_mfma_f32_16x16x32_bf16 v[76:79], a[180:183], v[180:183], v[76:79]
    ds_read_b64_tr_b16 a[232:233], v26 offset:16384
    ds_read_b64_tr_b16 a[234:235], v26 offset:20480
    v_mfma_f32_16x16x32_bf16 v[76:79], a[184:187], v[184:187], v[76:79]
    ds_read_b64_tr_b16 a[236:237], v26 offset:24576
    v_mfma_f32_16x16x32_bf16 v[76:79], a[188:191], v[188:191], v[76:79]
    s_waitcnt lgkmcnt(13)
    ds_read_b64_tr_b16 a[238:239], v26 offset:28672
    v_mfma_f32_16x16x32_bf16 v[80:83], a[208:211], v[128:131], 0
    s_waitcnt lgkmcnt(12)
    buffer_load_dwordx2 v[244:245], v58, s[12:15], 0 offen offset:1024
    v_mfma_f32_16x16x32_bf16 v[80:83], a[212:215], v[132:135], v[80:83]
    s_waitcnt lgkmcnt(10)
    ds_read_b64_tr_b16 a[160:161], v23 offset:0
    ds_read_b64_tr_b16 a[162:163], v23 offset:4096
    v_mfma_f32_16x16x32_bf16 v[80:83], a[216:219], v[136:139], v[80:83]
    s_waitcnt lgkmcnt(10)
    ds_read_b64_tr_b16 a[164:165], v23 offset:8192
    v_mfma_f32_16x16x32_bf16 v[80:83], a[220:223], v[140:143], v[80:83]
    s_waitcnt lgkmcnt(9)
    ds_read_b64_tr_b16 a[166:167], v23 offset:12288
    v_mfma_f32_16x16x32_bf16 v[80:83], a[224:227], v[144:147], v[80:83]
    s_waitcnt lgkmcnt(8)
    buffer_load_dwordx2 v[246:247], v58, s[12:15], 0 offen offset:1056
    v_mfma_f32_16x16x32_bf16 v[80:83], a[228:231], v[148:151], v[80:83]
    s_waitcnt lgkmcnt(6)
    ds_read_b64_tr_b16 a[168:169], v23 offset:16384
    ds_read_b64_tr_b16 a[170:171], v23 offset:20480
    v_mfma_f32_16x16x32_bf16 v[80:83], a[232:235], v[152:155], v[80:83]
    s_waitcnt lgkmcnt(6)
    ds_read_b64_tr_b16 a[172:173], v23 offset:24576
    v_mfma_f32_16x16x32_bf16 v[80:83], a[236:239], v[156:159], v[80:83]
    s_mov_b32 s45, 18688
    ds_read_b64_tr_b16 a[174:175], v23 offset:28672
    v_mfma_f32_16x16x32_bf16 v[84:87], a[208:211], v[160:163], 0
    buffer_load_dwordx4 v[192:195], v5, s[24:27], s45 offen offset:0 sc1
    v_mfma_f32_16x16x32_bf16 v[84:87], a[212:215], v[164:167], v[84:87]
    ds_read_b64_tr_b16 a[176:177], v27 offset:0
    ds_read_b64_tr_b16 a[178:179], v27 offset:4096
    v_mfma_f32_16x16x32_bf16 v[84:87], a[216:219], v[168:171], v[84:87]
    ds_read_b64_tr_b16 a[180:181], v27 offset:8192
    v_mfma_f32_16x16x32_bf16 v[84:87], a[220:223], v[172:175], v[84:87]
    ds_read_b64_tr_b16 a[182:183], v27 offset:12288
    v_mfma_f32_16x16x32_bf16 v[84:87], a[224:227], v[176:179], v[84:87]
    buffer_load_dwordx4 v[196:199], v5, s[24:27], s45 offen offset:512 sc1
    v_mfma_f32_16x16x32_bf16 v[84:87], a[228:231], v[180:183], v[84:87]
    ds_read_b64_tr_b16 a[184:185], v27 offset:16384
    ds_read_b64_tr_b16 a[186:187], v27 offset:20480
    v_mfma_f32_16x16x32_bf16 v[84:87], a[232:235], v[184:187], v[84:87]
    ds_read_b64_tr_b16 a[188:189], v27 offset:24576
    v_mfma_f32_16x16x32_bf16 v[84:87], a[236:239], v[188:191], v[84:87]
    s_waitcnt lgkmcnt(13)
    ds_read_b64_tr_b16 a[190:191], v27 offset:28672
    s_waitcnt vmcnt(20)
    s_barrier
    v_mfma_f32_16x16x32_bf16 v[88:91], a[160:163], v[128:131], 0
    s_waitcnt lgkmcnt(12)
    buffer_load_dwordx4 v[200:203], v59, s[24:27], s45 offen offset:1024 sc1
    v_mfma_f32_16x16x32_bf16 v[88:91], a[164:167], v[132:135], v[88:91]
    s_waitcnt lgkmcnt(10)
    ds_read_b64_tr_b16 a[208:209], v12 offset:32768
    ds_read_b64_tr_b16 a[210:211], v12 offset:36864
    v_mfma_f32_16x16x32_bf16 v[88:91], a[168:171], v[136:139], v[88:91]
    s_waitcnt lgkmcnt(10)
    ds_read_b64_tr_b16 a[212:213], v12 offset:40960
    v_mfma_f32_16x16x32_bf16 v[88:91], a[172:175], v[140:143], v[88:91]
    s_waitcnt lgkmcnt(9)
    s_mov_b32 s45, 20992
    ds_read_b64_tr_b16 a[214:215], v12 offset:45056
    v_mfma_f32_16x16x32_bf16 v[88:91], a[176:179], v[144:147], v[88:91]
    s_waitcnt lgkmcnt(8)
    buffer_load_dwordx4 v[204:207], v5, s[24:27], s45 offen offset:0 sc1
    v_mfma_f32_16x16x32_bf16 v[88:91], a[180:183], v[148:151], v[88:91]
    s_waitcnt lgkmcnt(6)
    ds_read_b64_tr_b16 a[216:217], v12 offset:49152
    ds_read_b64_tr_b16 a[218:219], v12 offset:53248
    v_mfma_f32_16x16x32_bf16 v[88:91], a[184:187], v[152:155], v[88:91]
    s_waitcnt lgkmcnt(6)
    s_add_u32 s49, s46, 768
    ds_read_b64_tr_b16 a[220:221], v12 offset:57344
    v_mfma_f32_16x16x32_bf16 v[88:91], a[188:191], v[156:159], v[88:91]
    s_add_u32 m0, s42, 0
    ds_read_b64_tr_b16 a[222:223], v12 offset:61440
    v_mfma_f32_16x16x32_bf16 v[92:95], a[160:163], v[160:163], 0
    buffer_load_dwordx4 v46, s[20:23], s49 offen lds
    v_mfma_f32_16x16x32_bf16 v[92:95], a[164:167], v[164:167], v[92:95]
    ds_read_b64_tr_b16 a[224:225], v16 offset:32768
    ds_read_b64_tr_b16 a[226:227], v16 offset:36864
    v_mfma_f32_16x16x32_bf16 v[92:95], a[168:171], v[168:171], v[92:95]
    buffer_load_dwordx4 v47, s[20:23], s49 offen offset:1024 lds
    v_mfma_f32_16x16x32_bf16 v[92:95], a[172:175], v[172:175], v[92:95]
    ds_read_b64_tr_b16 a[228:229], v16 offset:40960
    ds_read_b64_tr_b16 a[230:231], v16 offset:45056
    v_mfma_f32_16x16x32_bf16 v[92:95], a[176:179], v[176:179], v[92:95]
    buffer_load_dwordx4 v[208:211], v5, s[24:27], s45 offen offset:512 sc1
    v_mfma_f32_16x16x32_bf16 v[92:95], a[180:183], v[180:183], v[92:95]
    ds_read_b64_tr_b16 a[232:233], v16 offset:49152
    ds_read_b64_tr_b16 a[234:235], v16 offset:53248
    v_mfma_f32_16x16x32_bf16 v[92:95], a[184:187], v[184:187], v[92:95]
    ds_read_b64_tr_b16 a[236:237], v16 offset:57344
    v_mfma_f32_16x16x32_bf16 v[92:95], a[188:191], v[188:191], v[92:95]
    s_waitcnt lgkmcnt(13)
    ds_read_b64_tr_b16 a[238:239], v16 offset:61440
    v_mfma_f32_16x16x32_bf16 v[64:67], a[208:211], a[64:67], v[64:67]
    s_waitcnt lgkmcnt(12)
    buffer_load_dwordx4 v48, s[20:23], s49 offen offset:2048 lds
    v_mfma_f32_16x16x32_bf16 v[64:67], a[212:215], a[68:71], v[64:67]
    s_waitcnt lgkmcnt(10)
    ds_read_b64_tr_b16 a[160:161], v13 offset:32768
    ds_read_b64_tr_b16 a[162:163], v13 offset:36864
    v_mfma_f32_16x16x32_bf16 v[64:67], a[216:219], a[72:75], v[64:67]
    s_waitcnt lgkmcnt(10)
    buffer_load_dwordx4 v49, s[20:23], s49 offen offset:3072 lds
    v_mfma_f32_16x16x32_bf16 v[64:67], a[220:223], a[76:79], v[64:67]
    s_waitcnt lgkmcnt(8)
    ds_read_b64_tr_b16 a[164:165], v13 offset:40960
    ds_read_b64_tr_b16 a[166:167], v13 offset:45056
    v_mfma_f32_16x16x32_bf16 v[64:67], a[224:227], a[80:83], v[64:67]
    s_waitcnt lgkmcnt(8)
    buffer_load_dwordx4 v[212:215], v59, s[24:27], s45 offen offset:1024 sc1
    v_mfma_f32_16x16x32_bf16 v[64:67], a[228:231], a[84:87], v[64:67]
    s_waitcnt lgkmcnt(6)
    ds_read_b64_tr_b16 a[168:169], v13 offset:49152
    ds_read_b64_tr_b16 a[170:171], v13 offset:53248
    v_mfma_f32_16x16x32_bf16 v[64:67], a[232:235], a[88:91], v[64:67]
    s_waitcnt lgkmcnt(6)
    s_add_u32 s49, s46, 74496
    ds_read_b64_tr_b16 a[172:173], v13 offset:57344
    v_mfma_f32_16x16x32_bf16 v[64:67], a[236:239], a[92:95], v[64:67]
    s_add_u32 m0, s42, 16384
    ds_read_b64_tr_b16 a[174:175], v13 offset:61440
    v_mfma_f32_16x16x32_bf16 v[68:71], a[208:211], a[96:99], v[68:71]
    buffer_load_dwordx4 v46, s[20:23], s49 offen lds
    v_mfma_f32_16x16x32_bf16 v[68:71], a[212:215], a[100:103], v[68:71]
    ds_read_b64_tr_b16 a[176:177], v17 offset:32768
    ds_read_b64_tr_b16 a[178:179], v17 offset:36864
    v_mfma_f32_16x16x32_bf16 v[68:71], a[216:219], a[104:107], v[68:71]
    buffer_load_dwordx4 v47, s[20:23], s49 offen offset:1024 lds
    v_mfma_f32_16x16x32_bf16 v[68:71], a[220:223], a[108:111], v[68:71]
    ds_read_b64_tr_b16 a[180:181], v17 offset:40960
    ds_read_b64_tr_b16 a[182:183], v17 offset:45056
    v_mfma_f32_16x16x32_bf16 v[68:71], a[224:227], a[112:115], v[68:71]
    ds_read_b64_tr_b16 a[184:185], v17 offset:49152
    v_cvt_pk_bf16_f32 v224, v64, v65
    v_mfma_f32_16x16x32_bf16 v[68:71], a[228:231], a[116:119], v[68:71]
    ds_read_b64_tr_b16 a[186:187], v17 offset:53248
    v_cvt_pk_bf16_f32 v225, v66, v67
    v_mfma_f32_16x16x32_bf16 v[68:71], a[232:235], a[120:123], v[68:71]
    ds_read_b64_tr_b16 a[188:189], v17 offset:57344
    v_mfma_f32_16x16x32_bf16 v[68:71], a[236:239], a[124:127], v[68:71]
    s_waitcnt lgkmcnt(13)
    ds_read_b64_tr_b16 a[190:191], v17 offset:61440
    v_mfma_f32_16x16x32_bf16 v[72:75], a[160:163], a[64:67], v[72:75]
    s_waitcnt lgkmcnt(12)
    buffer_load_dwordx4 v48, s[20:23], s49 offen offset:2048 lds
    v_mfma_f32_16x16x32_bf16 v[72:75], a[164:167], a[68:71], v[72:75]
    s_waitcnt lgkmcnt(10)
    ds_read_b64_tr_b16 a[208:209], v14 offset:32768
    ds_read_b64_tr_b16 a[210:211], v14 offset:36864
    v_mfma_f32_16x16x32_bf16 v[72:75], a[168:171], a[72:75], v[72:75]
    s_waitcnt lgkmcnt(10)
    buffer_load_dwordx4 v49, s[20:23], s49 offen offset:3072 lds
    v_mfma_f32_16x16x32_bf16 v[72:75], a[172:175], a[76:79], v[72:75]
    s_waitcnt lgkmcnt(8)
    ds_read_b64_tr_b16 a[212:213], v14 offset:40960
    ds_read_b64_tr_b16 a[214:215], v14 offset:45056
    v_mfma_f32_16x16x32_bf16 v[72:75], a[176:179], a[80:83], v[72:75]
    s_waitcnt lgkmcnt(8)
    ds_read_b64_tr_b16 a[216:217], v14 offset:49152
    v_cvt_pk_bf16_f32 v228, v68, v69
    v_mfma_f32_16x16x32_bf16 v[72:75], a[180:183], a[84:87], v[72:75]
    s_waitcnt lgkmcnt(7)
    s_waitcnt vmcnt(24)
    ds_read_b64_tr_b16 a[218:219], v14 offset:53248
    v_cvt_pk_bf16_f32 v229, v70, v71
    v_mfma_f32_16x16x32_bf16 v[72:75], a[184:187], a[88:91], v[72:75]
    s_waitcnt lgkmcnt(6)
    s_and_b32 s42, s2, 7
    buffer_store_dword v10, v8, s[24:27], s92 offen sc1
    v_mfma_f32_16x16x32_bf16 v[72:75], a[188:191], a[92:95], v[72:75]
    s_mov_b64 s[20:21], s[52:53]
    s_add_u32 s92, s92, 4
    ds_read_b64_tr_b16 a[220:221], v14 offset:57344
    ds_read_b64_tr_b16 a[222:223], v14 offset:61440
    v_mfma_f32_16x16x32_bf16 v[76:79], a[160:163], a[96:99], v[76:79]
    s_mov_b32 s22, 1152
    ds_read_b64_tr_b16 a[224:225], v18 offset:32768
    v_mfma_f32_16x16x32_bf16 v[76:79], a[164:167], a[100:103], v[76:79]
    s_mov_b32 s23, 0x20000
    ds_read_b64_tr_b16 a[226:227], v18 offset:36864
    v_mfma_f32_16x16x32_bf16 v[76:79], a[168:171], a[104:107], v[76:79]
    ds_read_b64_tr_b16 a[228:229], v18 offset:40960
    v_mfma_f32_16x16x32_bf16 v[76:79], a[172:175], a[108:111], v[76:79]
    ds_read_b64_tr_b16 a[230:231], v18 offset:45056
    v_mfma_f32_16x16x32_bf16 v[76:79], a[176:179], a[112:115], v[76:79]
    ds_read_b64_tr_b16 a[232:233], v18 offset:49152
    v_cvt_pk_bf16_f32 v226, v72, v73
    v_mfma_f32_16x16x32_bf16 v[76:79], a[180:183], a[116:119], v[76:79]
    s_add_u32 s38, s93, 1024
    ds_read_b64_tr_b16 a[234:235], v18 offset:53248
    v_cvt_pk_bf16_f32 v227, v74, v75
    v_mfma_f32_16x16x32_bf16 v[76:79], a[184:187], a[120:123], v[76:79]
    buffer_store_dwordx4 v[224:227], v56, s[28:31], s38 offen sc1
    v_mfma_f32_16x16x32_bf16 v[76:79], a[188:191], a[124:127], v[76:79]
    s_waitcnt lgkmcnt(12)
    ds_read_b64_tr_b16 a[236:237], v18 offset:57344
    ds_read_b64_tr_b16 a[238:239], v18 offset:61440
    v_mfma_f32_16x16x32_bf16 v[80:83], a[208:211], a[64:67], v[80:83]
    s_waitcnt lgkmcnt(12)
    ds_read_b64_tr_b16 a[160:161], v15 offset:32768
    v_mfma_f32_16x16x32_bf16 v[80:83], a[212:215], a[68:71], v[80:83]
    s_waitcnt lgkmcnt(11)
    ds_read_b64_tr_b16 a[162:163], v15 offset:36864
    v_mfma_f32_16x16x32_bf16 v[80:83], a[216:219], a[72:75], v[80:83]
    s_waitcnt lgkmcnt(10)
    ds_read_b64_tr_b16 a[164:165], v15 offset:40960
    v_mfma_f32_16x16x32_bf16 v[80:83], a[220:223], a[76:79], v[80:83]
    s_waitcnt lgkmcnt(9)
    ds_read_b64_tr_b16 a[166:167], v15 offset:45056
    v_mfma_f32_16x16x32_bf16 v[80:83], a[224:227], a[80:83], v[80:83]
    s_waitcnt lgkmcnt(8)
    ds_read_b64_tr_b16 a[168:169], v15 offset:49152
    v_cvt_pk_bf16_f32 v230, v76, v77
    v_mfma_f32_16x16x32_bf16 v[80:83], a[228:231], a[84:87], v[80:83]
    s_waitcnt lgkmcnt(7)
    s_add_u32 s38, s93, 164864
    ds_read_b64_tr_b16 a[170:171], v15 offset:53248
    v_cvt_pk_bf16_f32 v231, v78, v79
    v_mfma_f32_16x16x32_bf16 v[80:83], a[232:235], a[88:91], v[80:83]
    s_waitcnt lgkmcnt(6)
    buffer_store_dwordx4 v[228:231], v56, s[28:31], s38 offen sc1
    v_mfma_f32_16x16x32_bf16 v[80:83], a[236:239], a[92:95], v[80:83]
    ds_read_b64_tr_b16 a[172:173], v15 offset:57344
    ds_read_b64_tr_b16 a[174:175], v15 offset:61440
    v_mfma_f32_16x16x32_bf16 v[84:87], a[208:211], a[96:99], v[84:87]
    ds_read_b64_tr_b16 a[176:177], v19 offset:32768
    v_mfma_f32_16x16x32_bf16 v[84:87], a[212:215], a[100:103], v[84:87]
    ds_read_b64_tr_b16 a[178:179], v19 offset:36864
    v_mfma_f32_16x16x32_bf16 v[84:87], a[216:219], a[104:107], v[84:87]
    ds_read_b64_tr_b16 a[180:181], v19 offset:40960
    v_mfma_f32_16x16x32_bf16 v[84:87], a[220:223], a[108:111], v[84:87]
    ds_read_b64_tr_b16 a[182:183], v19 offset:45056
    v_mfma_f32_16x16x32_bf16 v[84:87], a[224:227], a[112:115], v[84:87]
    ds_read_b64_tr_b16 a[184:185], v19 offset:49152
    v_cvt_pk_bf16_f32 v232, v80, v81
    v_mfma_f32_16x16x32_bf16 v[84:87], a[228:231], a[116:119], v[84:87]
    ds_read_b64_tr_b16 a[186:187], v19 offset:53248
    v_cvt_pk_bf16_f32 v233, v82, v83
    v_mfma_f32_16x16x32_bf16 v[84:87], a[232:235], a[120:123], v[84:87]
    ds_read_b64_tr_b16 a[188:189], v19 offset:57344
    v_mfma_f32_16x16x32_bf16 v[84:87], a[236:239], a[124:127], v[84:87]
    s_waitcnt lgkmcnt(13)
    ds_read_b64_tr_b16 a[190:191], v19 offset:61440
    s_waitcnt vmcnt(22)
    s_barrier
    v_mfma_f32_16x16x32_bf16 v[88:91], a[160:163], a[64:67], v[88:91]
    s_waitcnt lgkmcnt(12)
    ds_read_b64_tr_b16 a[208:209], v20 offset:32768
    v_mfma_f32_16x16x32_bf16 v[88:91], a[164:167], a[68:71], v[88:91]
    s_waitcnt lgkmcnt(11)
    ds_read_b64_tr_b16 a[210:211], v20 offset:36864
    v_mfma_f32_16x16x32_bf16 v[88:91], a[168:171], a[72:75], v[88:91]
    s_waitcnt lgkmcnt(10)
    ds_read_b64_tr_b16 a[212:213], v20 offset:40960
    v_mfma_f32_16x16x32_bf16 v[88:91], a[172:175], a[76:79], v[88:91]
    s_waitcnt lgkmcnt(9)
    ds_read_b64_tr_b16 a[214:215], v20 offset:45056
    v_mfma_f32_16x16x32_bf16 v[88:91], a[176:179], a[80:83], v[88:91]
    s_waitcnt lgkmcnt(8)
    ds_read_b64_tr_b16 a[216:217], v20 offset:49152
    v_cvt_pk_bf16_f32 v236, v84, v85
    v_mfma_f32_16x16x32_bf16 v[88:91], a[180:183], a[84:87], v[88:91]
    s_waitcnt lgkmcnt(7)
    ds_read_b64_tr_b16 a[218:219], v20 offset:53248
    v_cvt_pk_bf16_f32 v237, v86, v87
    v_mfma_f32_16x16x32_bf16 v[88:91], a[184:187], a[88:91], v[88:91]
    s_waitcnt lgkmcnt(6)
    ds_read_b64_tr_b16 a[220:221], v20 offset:57344
    v_mfma_f32_16x16x32_bf16 v[88:91], a[188:191], a[92:95], v[88:91]
    ds_read_b64_tr_b16 a[222:223], v20 offset:61440
    v_mfma_f32_16x16x32_bf16 v[92:95], a[160:163], a[96:99], v[92:95]
    ds_read_b64_tr_b16 a[224:225], v24 offset:32768
    v_mfma_f32_16x16x32_bf16 v[92:95], a[164:167], a[100:103], v[92:95]
    ds_read_b64_tr_b16 a[226:227], v24 offset:36864
    v_mfma_f32_16x16x32_bf16 v[92:95], a[168:171], a[104:107], v[92:95]
    ds_read_b64_tr_b16 a[228:229], v24 offset:40960
    v_mfma_f32_16x16x32_bf16 v[92:95], a[172:175], a[108:111], v[92:95]
    ds_read_b64_tr_b16 a[230:231], v24 offset:45056
    v_mfma_f32_16x16x32_bf16 v[92:95], a[176:179], a[112:115], v[92:95]
    ds_read_b64_tr_b16 a[232:233], v24 offset:49152
    v_cvt_pk_bf16_f32 v234, v88, v89
    v_mfma_f32_16x16x32_bf16 v[92:95], a[180:183], a[116:119], v[92:95]
    s_add_u32 s38, s93, 1152
    ds_read_b64_tr_b16 a[234:235], v24 offset:53248
    v_cvt_pk_bf16_f32 v235, v90, v91
    v_mfma_f32_16x16x32_bf16 v[92:95], a[184:187], a[120:123], v[92:95]
    buffer_store_dwordx4 v[232:235], v56, s[28:31], s38 offen sc1
    v_mfma_f32_16x16x32_bf16 v[92:95], a[188:191], a[124:127], v[92:95]
    s_waitcnt lgkmcnt(12)
    ds_read_b64_tr_b16 a[236:237], v24 offset:57344
    ds_read_b64_tr_b16 a[238:239], v24 offset:61440
    v_mfma_f32_16x16x32_bf16 v[96:99], a[208:211], v[128:131], 0
    s_waitcnt lgkmcnt(12)
    ds_read_b64_tr_b16 a[160:161], v21 offset:32768
    v_mfma_f32_16x16x32_bf16 v[96:99], a[212:215], v[132:135], v[96:99]
    s_waitcnt lgkmcnt(11)
    ds_read_b64_tr_b16 a[162:163], v21 offset:36864
    v_mfma_f32_16x16x32_bf16 v[96:99], a[216:219], v[136:139], v[96:99]
    s_waitcnt lgkmcnt(10)
    ds_read_b64_tr_b16 a[164:165], v21 offset:40960
    v_mfma_f32_16x16x32_bf16 v[96:99], a[220:223], v[140:143], v[96:99]
    s_waitcnt lgkmcnt(9)
    ds_read_b64_tr_b16 a[166:167], v21 offset:45056
    v_mfma_f32_16x16x32_bf16 v[96:99], a[224:227], v[144:147], v[96:99]
    s_waitcnt lgkmcnt(8)
    ds_read_b64_tr_b16 a[168:169], v21 offset:49152
    v_cvt_pk_bf16_f32 v238, v92, v93
    v_mfma_f32_16x16x32_bf16 v[96:99], a[228:231], v[148:151], v[96:99]
    s_waitcnt lgkmcnt(7)
    s_add_u32 s38, s93, 164992
    ds_read_b64_tr_b16 a[170:171], v21 offset:53248
    v_cvt_pk_bf16_f32 v239, v94, v95
    v_mfma_f32_16x16x32_bf16 v[96:99], a[232:235], v[152:155], v[96:99]
    s_waitcnt lgkmcnt(6)
    buffer_store_dwordx4 v[236:239], v56, s[28:31], s38 offen sc1
    v_mfma_f32_16x16x32_bf16 v[96:99], a[236:239], v[156:159], v[96:99]
    s_mov_b32 s45, 19840
    ds_read_b64_tr_b16 a[172:173], v21 offset:57344
    ds_read_b64_tr_b16 a[174:175], v21 offset:61440
    v_mfma_f32_16x16x32_bf16 v[100:103], a[208:211], v[160:163], 0
    buffer_load_dwordx4 v[64:67], v5, s[24:27], s45 offen offset:0 sc1
    v_mfma_f32_16x16x32_bf16 v[100:103], a[212:215], v[164:167], v[100:103]
    ds_read_b64_tr_b16 a[176:177], v25 offset:32768
    ds_read_b64_tr_b16 a[178:179], v25 offset:36864
    v_mfma_f32_16x16x32_bf16 v[100:103], a[216:219], v[168:171], v[100:103]
    ds_read_b64_tr_b16 a[180:181], v25 offset:40960
    v_mfma_f32_16x16x32_bf16 v[100:103], a[220:223], v[172:175], v[100:103]
    ds_read_b64_tr_b16 a[182:183], v25 offset:45056
    v_mfma_f32_16x16x32_bf16 v[100:103], a[224:227], v[176:179], v[100:103]
    buffer_load_dwordx4 v[68:71], v5, s[24:27], s45 offen offset:512 sc1
    v_mfma_f32_16x16x32_bf16 v[100:103], a[228:231], v[180:183], v[100:103]
    ds_read_b64_tr_b16 a[184:185], v25 offset:49152
    ds_read_b64_tr_b16 a[186:187], v25 offset:53248
    v_mfma_f32_16x16x32_bf16 v[100:103], a[232:235], v[184:187], v[100:103]
    ds_read_b64_tr_b16 a[188:189], v25 offset:57344
    v_mfma_f32_16x16x32_bf16 v[100:103], a[236:239], v[188:191], v[100:103]
    s_waitcnt lgkmcnt(13)
    ds_read_b64_tr_b16 a[190:191], v25 offset:61440
    v_mfma_f32_16x16x32_bf16 v[104:107], a[160:163], v[128:131], 0
    s_waitcnt lgkmcnt(12)
    ds_read_b64_tr_b16 a[208:209], v22 offset:32768
    v_mfma_f32_16x16x32_bf16 v[104:107], a[164:167], v[132:135], v[104:107]
    s_waitcnt lgkmcnt(11)
    ds_read_b64_tr_b16 a[210:211], v22 offset:36864
    v_mfma_f32_16x16x32_bf16 v[104:107], a[168:171], v[136:139], v[104:107]
    s_waitcnt lgkmcnt(10)
    buffer_load_dwordx4 v[72:75], v59, s[24:27], s45 offen offset:1024 sc1
    v_mfma_f32_16x16x32_bf16 v[104:107], a[172:175], v[140:143], v[104:107]
    s_waitcnt lgkmcnt(8)
    ds_read_b64_tr_b16 a[212:213], v22 offset:40960
    ds_read_b64_tr_b16 a[214:215], v22 offset:45056
    v_mfma_f32_16x16x32_bf16 v[104:107], a[176:179], v[144:147], v[104:107]
    s_waitcnt lgkmcnt(8)
    ds_read_b64_tr_b16 a[216:217], v22 offset:49152
    v_mfma_f32_16x16x32_bf16 v[104:107], a[180:183], v[148:151], v[104:107]
    s_waitcnt lgkmcnt(7)
    ds_read_b64_tr_b16 a[218:219], v22 offset:53248
    v_mfma_f32_16x16x32_bf16 v[104:107], a[184:187], v[152:155], v[104:107]
    s_waitcnt lgkmcnt(6)
    ds_read_b64_tr_b16 a[220:221], v22 offset:57344
    v_mfma_f32_16x16x32_bf16 v[104:107], a[188:191], v[156:159], v[104:107]
    ds_read_b64_tr_b16 a[222:223], v22 offset:61440
    v_mfma_f32_16x16x32_bf16 v[108:111], a[160:163], v[160:163], 0
    buffer_load_dwordx2 v[76:77], v3, s[20:23], 0 offen offset:0
    v_mfma_f32_16x16x32_bf16 v[108:111], a[164:167], v[164:167], v[108:111]
    ds_read_b64_tr_b16 a[224:225], v26 offset:32768
    ds_read_b64_tr_b16 a[226:227], v26 offset:36864
    v_mfma_f32_16x16x32_bf16 v[108:111], a[168:171], v[168:171], v[108:111]
    ds_read_b64_tr_b16 a[228:229], v26 offset:40960
    v_mfma_f32_16x16x32_bf16 v[108:111], a[172:175], v[172:175], v[108:111]
    ds_read_b64_tr_b16 a[230:231], v26 offset:45056
    v_mfma_f32_16x16x32_bf16 v[108:111], a[176:179], v[176:179], v[108:111]
    ds_read_b64_tr_b16 a[232:233], v26 offset:49152
    v_mfma_f32_16x16x32_bf16 v[108:111], a[180:183], v[180:183], v[108:111]
    ds_read_b64_tr_b16 a[234:235], v26 offset:53248
    v_mfma_f32_16x16x32_bf16 v[108:111], a[184:187], v[184:187], v[108:111]
    buffer_load_dwordx2 v[78:79], v3, s[20:23], 0 offen offset:32
    v_mfma_f32_16x16x32_bf16 v[108:111], a[188:191], v[188:191], v[108:111]
    s_waitcnt lgkmcnt(12)
    ds_read_b64_tr_b16 a[236:237], v26 offset:57344
    ds_read_b64_tr_b16 a[238:239], v26 offset:61440
    v_mfma_f32_16x16x32_bf16 v[112:115], a[208:211], v[128:131], 0
    s_waitcnt lgkmcnt(12)
    ds_read_b64_tr_b16 a[160:161], v23 offset:32768
    v_mfma_f32_16x16x32_bf16 v[112:115], a[212:215], v[132:135], v[112:115]
    s_waitcnt lgkmcnt(11)
    ds_read_b64_tr_b16 a[162:163], v23 offset:36864
    v_mfma_f32_16x16x32_bf16 v[112:115], a[216:219], v[136:139], v[112:115]
    s_waitcnt lgkmcnt(10)
    ds_read_b64_tr_b16 a[164:165], v23 offset:40960
    v_mfma_f32_16x16x32_bf16 v[112:115], a[220:223], v[140:143], v[112:115]
    s_waitcnt lgkmcnt(9)
    ds_read_b64_tr_b16 a[166:167], v23 offset:45056
    v_mfma_f32_16x16x32_bf16 v[112:115], a[224:227], v[144:147], v[112:115]
    s_waitcnt lgkmcnt(8)
    buffer_load_dwordx2 v[80:81], v3, s[20:23], 0 offen offset:512
    v_mfma_f32_16x16x32_bf16 v[112:115], a[228:231], v[148:151], v[112:115]
    s_waitcnt lgkmcnt(6)
    ds_read_b64_tr_b16 a[168:169], v23 offset:49152
    ds_read_b64_tr_b16 a[170:171], v23 offset:53248
    v_mfma_f32_16x16x32_bf16 v[112:115], a[232:235], v[152:155], v[112:115]
    s_waitcnt lgkmcnt(6)
    ds_read_b64_tr_b16 a[172:173], v23 offset:57344
    v_mfma_f32_16x16x32_bf16 v[112:115], a[236:239], v[156:159], v[112:115]
    ds_read_b64_tr_b16 a[174:175], v23 offset:61440
    v_mfma_f32_16x16x32_bf16 v[116:119], a[208:211], v[160:163], 0
    ds_read_b64_tr_b16 a[176:177], v27 offset:32768
    v_mfma_f32_16x16x32_bf16 v[116:119], a[212:215], v[164:167], v[116:119]
    ds_read_b64_tr_b16 a[178:179], v27 offset:36864
    v_mfma_f32_16x16x32_bf16 v[116:119], a[216:219], v[168:171], v[116:119]
    buffer_load_dwordx2 v[82:83], v3, s[20:23], 0 offen offset:544
    v_mfma_f32_16x16x32_bf16 v[116:119], a[220:223], v[172:175], v[116:119]
    ds_read_b64_tr_b16 a[180:181], v27 offset:40960
    ds_read_b64_tr_b16 a[182:183], v27 offset:45056
    v_mfma_f32_16x16x32_bf16 v[116:119], a[224:227], v[176:179], v[116:119]
    ds_read_b64_tr_b16 a[184:185], v27 offset:49152
    v_mfma_f32_16x16x32_bf16 v[116:119], a[228:231], v[180:183], v[116:119]
    ds_read_b64_tr_b16 a[186:187], v27 offset:53248
    v_mfma_f32_16x16x32_bf16 v[116:119], a[232:235], v[184:187], v[116:119]
    buffer_load_dwordx2 v[84:85], v55, s[20:23], 0 offen offset:1024
    v_mfma_f32_16x16x32_bf16 v[116:119], a[236:239], v[188:191], v[116:119]
    ds_read_b64_tr_b16 a[188:189], v27 offset:57344
    ds_read_b64_tr_b16 a[190:191], v27 offset:61440
    s_waitcnt vmcnt(13)
    s_waitcnt lgkmcnt(0)
    s_barrier
    v_mfma_f32_16x16x32_bf16 v[120:123], a[160:163], v[128:131], 0
    ds_read_b64_tr_b16 a[208:209], v12 offset:0
    v_mfma_f32_16x16x32_bf16 v[120:123], a[164:167], v[132:135], v[120:123]
    ds_read_b64_tr_b16 a[210:211], v12 offset:4096
    v_mfma_f32_16x16x32_bf16 v[120:123], a[168:171], v[136:139], v[120:123]
    ds_read_b64_tr_b16 a[212:213], v12 offset:8192
    v_mfma_f32_16x16x32_bf16 v[120:123], a[172:175], v[140:143], v[120:123]
    ds_read_b64_tr_b16 a[214:215], v12 offset:12288
    v_mfma_f32_16x16x32_bf16 v[120:123], a[176:179], v[144:147], v[120:123]
    buffer_load_dwordx2 v[86:87], v55, s[20:23], 0 offen offset:1056
    v_mfma_f32_16x16x32_bf16 v[120:123], a[180:183], v[148:151], v[120:123]
    ds_read_b64_tr_b16 a[216:217], v12 offset:16384
    ds_read_b64_tr_b16 a[218:219], v12 offset:20480
    v_mfma_f32_16x16x32_bf16 v[120:123], a[184:187], v[152:155], v[120:123]
    ds_read_b64_tr_b16 a[220:221], v12 offset:24576
    v_mfma_f32_16x16x32_bf16 v[120:123], a[188:191], v[156:159], v[120:123]
    ds_read_b64_tr_b16 a[222:223], v12 offset:28672
    v_mfma_f32_16x16x32_bf16 v[124:127], a[160:163], v[160:163], 0
    ds_read_b64_tr_b16 a[224:225], v16 offset:0
    v_mfma_f32_16x16x32_bf16 v[124:127], a[164:167], v[164:167], v[124:127]
    s_mov_b32 s45, 22144
    ds_read_b64_tr_b16 a[226:227], v16 offset:4096
    v_mfma_f32_16x16x32_bf16 v[124:127], a[168:171], v[168:171], v[124:127]
    buffer_load_dwordx4 v[216:219], v5, s[24:27], s45 offen offset:0 sc1
    v_mfma_f32_16x16x32_bf16 v[124:127], a[172:175], v[172:175], v[124:127]
    ds_read_b64_tr_b16 a[228:229], v16 offset:8192
    ds_read_b64_tr_b16 a[230:231], v16 offset:12288
    v_mfma_f32_16x16x32_bf16 v[124:127], a[176:179], v[176:179], v[124:127]
    ds_read_b64_tr_b16 a[232:233], v16 offset:16384
    v_mfma_f32_16x16x32_bf16 v[124:127], a[180:183], v[180:183], v[124:127]
    ds_read_b64_tr_b16 a[234:235], v16 offset:20480
    v_mfma_f32_16x16x32_bf16 v[124:127], a[184:187], v[184:187], v[124:127]
    ds_read_b64_tr_b16 a[236:237], v16 offset:24576
    v_mfma_f32_16x16x32_bf16 v[124:127], a[188:191], v[188:191], v[124:127]
    s_waitcnt lgkmcnt(13)
    ds_read_b64_tr_b16 a[238:239], v16 offset:28672
    v_mfma_f32_16x16x32_bf16 v[96:99], a[208:211], a[64:67], v[96:99]
    s_waitcnt lgkmcnt(12)
    buffer_load_dwordx4 v[220:223], v5, s[24:27], s45 offen offset:512 sc1
    v_mfma_f32_16x16x32_bf16 v[96:99], a[212:215], a[68:71], v[96:99]
    s_waitcnt lgkmcnt(10)
    ds_read_b64_tr_b16 a[160:161], v13 offset:0
    ds_read_b64_tr_b16 a[162:163], v13 offset:4096
    v_mfma_f32_16x16x32_bf16 v[96:99], a[216:219], a[72:75], v[96:99]
    s_waitcnt lgkmcnt(10)
    ds_read_b64_tr_b16 a[164:165], v13 offset:8192
    v_mfma_f32_16x16x32_bf16 v[96:99], a[220:223], a[76:79], v[96:99]
    s_waitcnt lgkmcnt(9)
    ds_read_b64_tr_b16 a[166:167], v13 offset:12288
    v_mfma_f32_16x16x32_bf16 v[96:99], a[224:227], a[80:83], v[96:99]
    s_waitcnt lgkmcnt(8)
    ds_read_b64_tr_b16 a[168:169], v13 offset:16384
    v_mfma_f32_16x16x32_bf16 v[96:99], a[228:231], a[84:87], v[96:99]
    s_waitcnt lgkmcnt(7)
    ds_read_b64_tr_b16 a[170:171], v13 offset:20480
    v_mfma_f32_16x16x32_bf16 v[96:99], a[232:235], a[88:91], v[96:99]
    s_waitcnt lgkmcnt(6)
    buffer_load_dwordx4 v[88:91], v59, s[24:27], s45 offen offset:1024 sc1
    v_mfma_f32_16x16x32_bf16 v[96:99], a[236:239], a[92:95], v[96:99]
    ds_read_b64_tr_b16 a[172:173], v13 offset:24576
    ds_read_b64_tr_b16 a[174:175], v13 offset:28672
    v_mfma_f32_16x16x32_bf16 v[100:103], a[208:211], a[96:99], v[100:103]
    buffer_load_dword v11, v9, s[24:27], s39 offen sc1
    v_mfma_f32_16x16x32_bf16 v[100:103], a[212:215], a[100:103], v[100:103]
    ds_read_b64_tr_b16 a[176:177], v17 offset:0
    ds_read_b64_tr_b16 a[178:179], v17 offset:4096
    v_mfma_f32_16x16x32_bf16 v[100:103], a[216:219], a[104:107], v[100:103]
    ds_read_b64_tr_b16 a[180:181], v17 offset:8192
    v_mfma_f32_16x16x32_bf16 v[100:103], a[220:223], a[108:111], v[100:103]
    ds_read_b64_tr_b16 a[182:183], v17 offset:12288
    v_mfma_f32_16x16x32_bf16 v[100:103], a[224:227], a[112:115], v[100:103]
    ds_read_b64_tr_b16 a[184:185], v17 offset:16384
    v_cvt_pk_bf16_f32 v224, v96, v97
    v_mfma_f32_16x16x32_bf16 v[100:103], a[228:231], a[116:119], v[100:103]
    ds_read_b64_tr_b16 a[186:187], v17 offset:20480
    v_cvt_pk_bf16_f32 v225, v98, v99
    v_mfma_f32_16x16x32_bf16 v[100:103], a[232:235], a[120:123], v[100:103]
    ds_read_b64_tr_b16 a[188:189], v17 offset:24576
    v_mfma_f32_16x16x32_bf16 v[100:103], a[236:239], a[124:127], v[100:103]
    s_waitcnt lgkmcnt(13)
    ds_read_b64_tr_b16 a[190:191], v17 offset:28672
    v_mfma_f32_16x16x32_bf16 v[104:107], a[160:163], a[64:67], v[104:107]
    s_waitcnt lgkmcnt(12)
    ds_read_b64_tr_b16 a[208:209], v14 offset:0
    v_mfma_f32_16x16x32_bf16 v[104:107], a[164:167], a[68:71], v[104:107]
    s_waitcnt lgkmcnt(11)
    ds_read_b64_tr_b16 a[210:211], v14 offset:4096
    v_mfma_f32_16x16x32_bf16 v[104:107], a[168:171], a[72:75], v[104:107]
    s_waitcnt lgkmcnt(10)
    ds_read_b64_tr_b16 a[212:213], v14 offset:8192
    v_mfma_f32_16x16x32_bf16 v[104:107], a[172:175], a[76:79], v[104:107]
    s_waitcnt lgkmcnt(9)
    ds_read_b64_tr_b16 a[214:215], v14 offset:12288
    v_mfma_f32_16x16x32_bf16 v[104:107], a[176:179], a[80:83], v[104:107]
    s_waitcnt lgkmcnt(8)
    ds_read_b64_tr_b16 a[216:217], v14 offset:16384
    v_cvt_pk_bf16_f32 v228, v100, v101
    v_mfma_f32_16x16x32_bf16 v[104:107], a[180:183], a[84:87], v[104:107]
    s_waitcnt lgkmcnt(7)
    ds_read_b64_tr_b16 a[218:219], v14 offset:20480
    v_cvt_pk_bf16_f32 v229, v102, v103
    v_mfma_f32_16x16x32_bf16 v[104:107], a[184:187], a[88:91], v[104:107]
    s_waitcnt lgkmcnt(6)
    ds_read_b64_tr_b16 a[220:221], v14 offset:24576
    v_mfma_f32_16x16x32_bf16 v[104:107], a[188:191], a[92:95], v[104:107]
    ds_read_b64_tr_b16 a[222:223], v14 offset:28672
    v_mfma_f32_16x16x32_bf16 v[108:111], a[160:163], a[96:99], v[108:111]
    ds_read_b64_tr_b16 a[224:225], v18 offset:0
    v_mfma_f32_16x16x32_bf16 v[108:111], a[164:167], a[100:103], v[108:111]
    ds_read_b64_tr_b16 a[226:227], v18 offset:4096
    v_mfma_f32_16x16x32_bf16 v[108:111], a[168:171], a[104:107], v[108:111]
    ds_read_b64_tr_b16 a[228:229], v18 offset:8192
    v_mfma_f32_16x16x32_bf16 v[108:111], a[172:175], a[108:111], v[108:111]
    ds_read_b64_tr_b16 a[230:231], v18 offset:12288
    v_mfma_f32_16x16x32_bf16 v[108:111], a[176:179], a[112:115], v[108:111]
    ds_read_b64_tr_b16 a[232:233], v18 offset:16384
    v_cvt_pk_bf16_f32 v226, v104, v105
    v_mfma_f32_16x16x32_bf16 v[108:111], a[180:183], a[116:119], v[108:111]
    s_add_u32 s38, s93, 1536
    ds_read_b64_tr_b16 a[234:235], v18 offset:20480
    v_cvt_pk_bf16_f32 v227, v106, v107
    v_mfma_f32_16x16x32_bf16 v[108:111], a[184:187], a[120:123], v[108:111]
    buffer_store_dwordx4 v[224:227], v56, s[28:31], s38 offen sc1
    v_mfma_f32_16x16x32_bf16 v[108:111], a[188:191], a[124:127], v[108:111]
    s_waitcnt lgkmcnt(12)
    ds_read_b64_tr_b16 a[236:237], v18 offset:24576
    ds_read_b64_tr_b16 a[238:239], v18 offset:28672
    v_mfma_f32_16x16x32_bf16 v[112:115], a[208:211], a[64:67], v[112:115]
    s_waitcnt lgkmcnt(12)
    ds_read_b64_tr_b16 a[160:161], v15 offset:0
    v_mfma_f32_16x16x32_bf16 v[112:115], a[212:215], a[68:71], v[112:115]
    s_waitcnt lgkmcnt(11)
    ds_read_b64_tr_b16 a[162:163], v15 offset:4096
    v_mfma_f32_16x16x32_bf16 v[112:115], a[216:219], a[72:75], v[112:115]
    s_waitcnt lgkmcnt(10)
    ds_read_b64_tr_b16 a[164:165], v15 offset:8192
    v_mfma_f32_16x16x32_bf16 v[112:115], a[220:223], a[76:79], v[112:115]
    s_waitcnt lgkmcnt(9)
    ds_read_b64_tr_b16 a[166:167], v15 offset:12288
    v_mfma_f32_16x16x32_bf16 v[112:115], a[224:227], a[80:83], v[112:115]
    s_waitcnt lgkmcnt(8)
    ds_read_b64_tr_b16 a[168:169], v15 offset:16384
    v_cvt_pk_bf16_f32 v230, v108, v109
    v_mfma_f32_16x16x32_bf16 v[112:115], a[228:231], a[84:87], v[112:115]
    s_waitcnt lgkmcnt(7)
    s_add_u32 s38, s93, 165376
    ds_read_b64_tr_b16 a[170:171], v15 offset:20480
    v_cvt_pk_bf16_f32 v231, v110, v111
    v_mfma_f32_16x16x32_bf16 v[112:115], a[232:235], a[88:91], v[112:115]
    s_waitcnt lgkmcnt(6)
    buffer_store_dwordx4 v[228:231], v56, s[28:31], s38 offen sc1
    v_mfma_f32_16x16x32_bf16 v[112:115], a[236:239], a[92:95], v[112:115]
    ds_read_b64_tr_b16 a[172:173], v15 offset:24576
    ds_read_b64_tr_b16 a[174:175], v15 offset:28672
    v_mfma_f32_16x16x32_bf16 v[116:119], a[208:211], a[96:99], v[116:119]
    ds_read_b64_tr_b16 a[176:177], v19 offset:0
    v_mfma_f32_16x16x32_bf16 v[116:119], a[212:215], a[100:103], v[116:119]
    ds_read_b64_tr_b16 a[178:179], v19 offset:4096
    v_mfma_f32_16x16x32_bf16 v[116:119], a[216:219], a[104:107], v[116:119]
    ds_read_b64_tr_b16 a[180:181], v19 offset:8192
    v_mfma_f32_16x16x32_bf16 v[116:119], a[220:223], a[108:111], v[116:119]
    ds_read_b64_tr_b16 a[182:183], v19 offset:12288
    v_mfma_f32_16x16x32_bf16 v[116:119], a[224:227], a[112:115], v[116:119]
    ds_read_b64_tr_b16 a[184:185], v19 offset:16384
    v_cvt_pk_bf16_f32 v232, v112, v113
    v_mfma_f32_16x16x32_bf16 v[116:119], a[228:231], a[116:119], v[116:119]
    ds_read_b64_tr_b16 a[186:187], v19 offset:20480
    v_cvt_pk_bf16_f32 v233, v114, v115
    v_mfma_f32_16x16x32_bf16 v[116:119], a[232:235], a[120:123], v[116:119]
    ds_read_b64_tr_b16 a[188:189], v19 offset:24576
    v_mfma_f32_16x16x32_bf16 v[116:119], a[236:239], a[124:127], v[116:119]
    s_waitcnt lgkmcnt(13)
    ds_read_b64_tr_b16 a[190:191], v19 offset:28672
    v_mfma_f32_16x16x32_bf16 v[120:123], a[160:163], a[64:67], v[120:123]
    s_waitcnt lgkmcnt(12)
    v_mfma_f32_16x16x32_bf16 v[120:123], a[164:167], a[68:71], v[120:123]
    s_waitcnt lgkmcnt(10)
    v_mfma_f32_16x16x32_bf16 v[120:123], a[168:171], a[72:75], v[120:123]
    s_waitcnt lgkmcnt(8)
    v_mfma_f32_16x16x32_bf16 v[120:123], a[172:175], a[76:79], v[120:123]
    s_waitcnt lgkmcnt(6)
    v_mfma_f32_16x16x32_bf16 v[120:123], a[176:179], a[80:83], v[120:123]
    s_waitcnt lgkmcnt(4)
    v_cvt_pk_bf16_f32 v236, v116, v117
    v_mfma_f32_16x16x32_bf16 v[120:123], a[180:183], a[84:87], v[120:123]
    s_waitcnt lgkmcnt(2)
    v_cvt_pk_bf16_f32 v237, v118, v119
    v_mfma_f32_16x16x32_bf16 v[120:123], a[184:187], a[88:91], v[120:123]
    s_waitcnt lgkmcnt(0)
    v_mfma_f32_16x16x32_bf16 v[120:123], a[188:191], a[92:95], v[120:123]
    v_mfma_f32_16x16x32_bf16 v[124:127], a[160:163], a[96:99], v[124:127]
    v_mfma_f32_16x16x32_bf16 v[124:127], a[164:167], a[100:103], v[124:127]
    v_mfma_f32_16x16x32_bf16 v[124:127], a[168:171], a[104:107], v[124:127]
    v_mfma_f32_16x16x32_bf16 v[124:127], a[172:175], a[108:111], v[124:127]
    v_mfma_f32_16x16x32_bf16 v[124:127], a[176:179], a[112:115], v[124:127]
    s_nop 2
    v_cvt_pk_bf16_f32 v234, v120, v121
    v_mfma_f32_16x16x32_bf16 v[124:127], a[180:183], a[116:119], v[124:127]
    s_add_u32 s38, s93, 1664
    v_cvt_pk_bf16_f32 v235, v122, v123
    v_mfma_f32_16x16x32_bf16 v[124:127], a[184:187], a[120:123], v[124:127]
    buffer_store_dwordx4 v[232:235], v56, s[28:31], s38 offen sc1
    v_mfma_f32_16x16x32_bf16 v[124:127], a[188:191], a[124:127], v[124:127]
    s_nop 7
    v_cvt_pk_bf16_f32 v238, v124, v125
    s_add_u32 s38, s93, 165504
    v_cvt_pk_bf16_f32 v239, v126, v127
    buffer_store_dwordx4 v[236:239], v56, s[28:31], s38 offen sc1
    s_waitcnt vmcnt(16)
    v_lshlrev_b32 v144, 16, v64
    v_and_b32 v145, 0xffff0000, v64
    v_lshlrev_b32 v146, 16, v65
    v_and_b32 v147, 0xffff0000, v65
    v_lshlrev_b32 v148, 16, v66
    v_and_b32 v149, 0xffff0000, v66
    v_lshlrev_b32 v150, 16, v67
    v_and_b32 v151, 0xffff0000, v67
    s_waitcnt vmcnt(15)
    v_lshlrev_b32 v152, 16, v68
    v_and_b32 v153, 0xffff0000, v68
    v_lshlrev_b32 v154, 16, v69
    v_and_b32 v155, 0xffff0000, v69
    v_lshlrev_b32 v156, 16, v70
    v_and_b32 v157, 0xffff0000, v70
    v_lshlrev_b32 v158, 16, v71
    v_and_b32 v159, 0xffff0000, v71
    s_waitcnt vmcnt(14)
    v_lshlrev_b32 v160, 16, v72
    v_and_b32 v161, 0xffff0000, v72
    v_lshlrev_b32 v162, 16, v73
    v_and_b32 v163, 0xffff0000, v73
    v_lshlrev_b32 v164, 16, v74
    v_and_b32 v165, 0xffff0000, v74
    v_lshlrev_b32 v166, 16, v75
    v_and_b32 v167, 0xffff0000, v75
    s_waitcnt vmcnt(13)
    v_lshlrev_b32 v168, 16, v76
    v_and_b32 v169, 0xffff0000, v76
    v_lshlrev_b32 v170, 16, v77
    v_and_b32 v171, 0xffff0000, v77
    s_waitcnt vmcnt(12)
    v_lshlrev_b32 v172, 16, v78
    v_and_b32 v173, 0xffff0000, v78
    v_lshlrev_b32 v174, 16, v79
    v_and_b32 v175, 0xffff0000, v79
    s_waitcnt vmcnt(11)
    v_lshlrev_b32 v176, 16, v80
    v_and_b32 v177, 0xffff0000, v80
    v_lshlrev_b32 v178, 16, v81
    v_and_b32 v179, 0xffff0000, v81
    s_waitcnt vmcnt(10)
    v_lshlrev_b32 v180, 16, v82
    v_and_b32 v181, 0xffff0000, v82
    v_lshlrev_b32 v182, 16, v83
    v_and_b32 v183, 0xffff0000, v83
    s_waitcnt vmcnt(9)
    v_lshlrev_b32 v184, 16, v84
    v_and_b32 v185, 0xffff0000, v84
    v_lshlrev_b32 v186, 16, v85
    v_and_b32 v187, 0xffff0000, v85
    s_waitcnt vmcnt(8)
    v_lshlrev_b32 v188, 16, v86
    v_and_b32 v189, 0xffff0000, v86
    v_lshlrev_b32 v190, 16, v87
    v_and_b32 v191, 0xffff0000, v87
    v_lshlrev_b32 v12, 16, v36
    v_and_b32 v13, 0xffff0000, v36
    v_lshlrev_b32 v14, 16, v37
    v_and_b32 v15, 0xffff0000, v37
    v_lshlrev_b32 v16, 16, v38
    v_and_b32 v17, 0xffff0000, v38
    v_lshlrev_b32 v18, 16, v39
    v_and_b32 v19, 0xffff0000, v39
    v_lshlrev_b32 v20, 16, v40
    v_and_b32 v21, 0xffff0000, v40
    v_lshlrev_b32 v22, 16, v41
    v_and_b32 v23, 0xffff0000, v41
    v_lshlrev_b32 v24, 16, v42
    v_and_b32 v25, 0xffff0000, v42
    v_lshlrev_b32 v26, 16, v43
    v_and_b32 v27, 0xffff0000, v43
    v_lshlrev_b32 v28, 16, v244
    v_and_b32 v29, 0xffff0000, v244
    v_lshlrev_b32 v30, 16, v245
    v_and_b32 v31, 0xffff0000, v245
    v_lshlrev_b32 v32, 16, v246
    v_and_b32 v33, 0xffff0000, v246
    v_lshlrev_b32 v34, 16, v247
    v_and_b32 v35, 0xffff0000, v247
    v_lshlrev_b32 v96, 16, v192
    v_and_b32 v97, 0xffff0000, v192
    v_lshlrev_b32 v98, 16, v193
    v_and_b32 v99, 0xffff0000, v193
    v_lshlrev_b32 v100, 16, v194
    v_and_b32 v101, 0xffff0000, v194
    v_lshlrev_b32 v102, 16, v195
    v_and_b32 v103, 0xffff0000, v195
    v_lshlrev_b32 v104, 16, v196
    v_and_b32 v105, 0xffff0000, v196
    v_lshlrev_b32 v106, 16, v197
    v_and_b32 v107, 0xffff0000, v197
    v_lshlrev_b32 v108, 16, v198
    v_and_b32 v109, 0xffff0000, v198
    v_lshlrev_b32 v110, 16, v199
    v_and_b32 v111, 0xffff0000, v199
    v_lshlrev_b32 v112, 16, v200
    v_and_b32 v113, 0xffff0000, v200
    v_lshlrev_b32 v114, 16, v201
    v_and_b32 v115, 0xffff0000, v201
    v_lshlrev_b32 v116, 16, v202
    v_and_b32 v117, 0xffff0000, v202
    v_lshlrev_b32 v118, 16, v203
    v_and_b32 v119, 0xffff0000, v203
    v_mov_b32 v244, 0
    v_mov_b32 v245, 0
    s_waitcnt vmcnt(0)
    buffer_store_dword v10, v8, s[24:27], s92 offen sc1
    v_cmp_ne_u32 s[54:55], s95, v11
    s_cmp_lg_u64 s[54:55], 0
    s_cbranch_scc1 Ltail_spin1
Ltail_got1:
    s_add_u32 s39, s39, 4
    s_add_u32 s45, s44, 0
    buffer_load_dwordx4 a[0:3], v2, s[28:31], s45 offen offset:0 sc1
    buffer_load_dwordx4 a[4:7], v2, s[28:31], s45 offen offset:2048 sc1
    s_add_u32 s45, s44, 4096
    buffer_load_dwordx4 a[8:11], v2, s[28:31], s45 offen offset:0 sc1
    buffer_load_dwordx4 a[12:15], v2, s[28:31], s45 offen offset:2048 sc1
    s_add_u32 s45, s44, 8192
    buffer_load_dwordx4 a[16:19], v2, s[28:31], s45 offen offset:0 sc1
    buffer_load_dwordx4 a[20:23], v2, s[28:31], s45 offen offset:2048 sc1
    s_add_u32 s45, s44, 12288
    buffer_load_dwordx4 a[24:27], v2, s[28:31], s45 offen offset:0 sc1
    buffer_load_dwordx4 a[28:31], v2, s[28:31], s45 offen offset:2048 sc1
    ds_write_b128 v51, a[128:131] offset:0
    ds_write_b128 v51, a[132:135] offset:4096
    ds_write_b128 v51, a[136:139] offset:8192
    ds_write_b128 v51, a[140:143] offset:12288
    ds_write_b128 v51, a[144:147] offset:16384
    ds_write_b128 v51, a[148:151] offset:20480
    ds_write_b128 v51, a[152:155] offset:24576
    ds_write_b128 v51, a[156:159] offset:28672
    ds_write_b128 v51, a[240:243] offset:32768
    ds_write_b128 v255, a[244:247] offset:40960
    ds_write_b128 v255, a[248:251] offset:45056
    ds_write_b128 v255, a[252:255] offset:49152
    v_lshlrev_b32 v120, 16, v204
    v_and_b32 v121, 0xffff0000, v204
    v_lshlrev_b32 v122, 16, v205
    v_and_b32 v123, 0xffff0000, v205
    v_lshlrev_b32 v124, 16, v206
    v_and_b32 v125, 0xffff0000, v206
    v_lshlrev_b32 v126, 16, v207
    v_and_b32 v127, 0xffff0000, v207
    v_lshlrev_b32 v128, 16, v208
    v_and_b32 v129, 0xffff0000, v208
    v_lshlrev_b32 v130, 16, v209
    v_and_b32 v131, 0xffff0000, v209
    v_lshlrev_b32 v132, 16, v210
    v_and_b32 v133, 0xffff0000, v210
    v_lshlrev_b32 v134, 16, v211
    v_and_b32 v135, 0xffff0000, v211
    v_lshlrev_b32 v136, 16, v212
    v_and_b32 v137, 0xffff0000, v212
    v_lshlrev_b32 v138, 16, v213
    v_and_b32 v139, 0xffff0000, v213
    v_lshlrev_b32 v140, 16, v214
    v_and_b32 v141, 0xffff0000, v214
    v_lshlrev_b32 v142, 16, v215
    v_and_b32 v143, 0xffff0000, v215
    v_lshlrev_b32 v192, 16, v216
    v_and_b32 v193, 0xffff0000, v216
    v_lshlrev_b32 v194, 16, v217
    v_and_b32 v195, 0xffff0000, v217
    v_lshlrev_b32 v196, 16, v218
    v_and_b32 v197, 0xffff0000, v218
    v_lshlrev_b32 v198, 16, v219
    v_and_b32 v199, 0xffff0000, v219
    v_lshlrev_b32 v200, 16, v220
    v_and_b32 v201, 0xffff0000, v220
    v_lshlrev_b32 v202, 16, v221
    v_and_b32 v203, 0xffff0000, v221
    v_lshlrev_b32 v204, 16, v222
    v_and_b32 v205, 0xffff0000, v222
    v_lshlrev_b32 v206, 16, v223
    v_and_b32 v207, 0xffff0000, v223
    v_lshlrev_b32 v208, 16, v88
    v_and_b32 v209, 0xffff0000, v88
    v_lshlrev_b32 v210, 16, v89
    v_and_b32 v211, 0xffff0000, v89
    v_lshlrev_b32 v212, 16, v90
    v_and_b32 v213, 0xffff0000, v90
    v_lshlrev_b32 v214, 16, v91
    v_and_b32 v215, 0xffff0000, v91
    buffer_load_dword v11, v9, s[24:27], s39 offen sc1
    s_add_u32 s45, s44, 16384
    buffer_load_dwordx4 a[32:35], v54, s[28:31], s45 offen offset:0 sc1
    buffer_load_dwordx4 a[36:39], v54, s[28:31], s45 offen offset:1024 sc1
    buffer_load_dwordx4 a[40:43], v54, s[28:31], s45 offen offset:2048 sc1
    buffer_load_dwordx4 a[44:47], v54, s[28:31], s45 offen offset:3072 sc1
    s_waitcnt vmcnt(4)
    v_cmp_ne_u32 s[54:55], s95, v11
    s_cmp_lg_u64 s[54:55], 0
    s_cbranch_scc1 Ltail_spin2
Ltail_got2:
    s_add_u32 s39, s39, 4
    s_add_u32 s45, s44, 0
    buffer_load_dwordx4 a[64:67], v2, s[28:31], s45 offen offset:1024 sc1
    buffer_load_dwordx4 a[68:71], v2, s[28:31], s45 offen offset:3072 sc1
    s_add_u32 s45, s44, 4096
    buffer_load_dwordx4 a[72:75], v2, s[28:31], s45 offen offset:1024 sc1
    buffer_load_dwordx4 a[76:79], v2, s[28:31], s45 offen offset:3072 sc1
    s_add_u32 s45, s44, 8192
    buffer_load_dwordx4 a[80:83], v2, s[28:31], s45 offen offset:1024 sc1
    buffer_load_dwordx4 a[84:87], v2, s[28:31], s45 offen offset:3072 sc1
    s_add_u32 s45, s44, 12288
    buffer_load_dwordx4 a[88:91], v2, s[28:31], s45 offen offset:1024 sc1
    buffer_load_dwordx4 a[92:95], v2, s[28:31], s45 offen offset:3072 sc1
    v_mfma_f32_16x16x32_bf16 v[64:67], v[250:253], a[0:3], 0
    v_mfma_f32_16x16x32_bf16 v[68:71], v[248:251], a[0:3], 0
    v_mfma_f32_16x16x32_bf16 v[64:67], v[250:253], a[4:7], v[64:67]
    v_mfma_f32_16x16x32_bf16 v[68:71], v[248:251], a[4:7], v[68:71]
    v_mfma_f32_16x16x32_bf16 v[64:67], v[250:253], a[8:11], v[64:67]
    v_mfma_f32_16x16x32_bf16 v[68:71], v[248:251], a[8:11], v[68:71]
    v_mfma_f32_16x16x32_bf16 v[64:67], v[250:253], a[12:15], v[64:67]
    v_mfma_f32_16x16x32_bf16 v[68:71], v[248:251], a[12:15], v[68:71]
    v_mfma_f32_16x16x32_bf16 v[64:67], v[250:253], a[16:19], v[64:67]
    v_mfma_f32_16x16x32_bf16 v[68:71], v[248:251], a[16:19], v[68:71]
    v_mfma_f32_16x16x32_bf16 v[64:67], v[250:253], a[20:23], v[64:67]
    v_mfma_f32_16x16x32_bf16 v[68:71], v[248:251], a[20:23], v[68:71]
    v_mfma_f32_16x16x32_bf16 v[64:67], v[250:253], a[24:27], v[64:67]
    v_mfma_f32_16x16x32_bf16 v[68:71], v[248:251], a[24:27], v[68:71]
    v_mfma_f32_16x16x32_bf16 v[64:67], v[250:253], a[28:31], v[64:67]
    v_mfma_f32_16x16x32_bf16 v[68:71], v[248:251], a[28:31], v[68:71]
    s_waitcnt vmcnt(11)
    v_mfma_f32_16x16x32_bf16 v[80:83], v[242:245], a[32:35], 0
    v_mfma_f32_16x16x32_bf16 v[84:87], v[240:243], a[32:35], 0
    s_waitcnt vmcnt(10)
    v_mfma_f32_16x16x32_bf16 v[80:83], v[242:245], a[36:39], v[80:83]
    v_mfma_f32_16x16x32_bf16 v[84:87], v[240:243], a[36:39], v[84:87]
    s_waitcnt vmcnt(9)
    v_mfma_f32_16x16x32_bf16 v[80:83], v[242:245], a[40:43], v[80:83]
    v_mfma_f32_16x16x32_bf16 v[84:87], v[240:243], a[40:43], v[84:87]
    s_waitcnt vmcnt(8)
    v_mfma_f32_16x16x32_bf16 v[80:83], v[242:245], a[44:47], v[80:83]
    v_mfma_f32_16x16x32_bf16 v[84:87], v[240:243], a[44:47], v[84:87]
    s_waitcnt vmcnt(7)
    s_nop 5
    v_mov_b32_dpp v80, v80 row_ror:8 row_mask:0x4 bank_mask:0xf
    v_mov_b32_dpp v81, v81 row_ror:8 row_mask:0x4 bank_mask:0xf
    v_mov_b32_dpp v82, v82 row_ror:8 row_mask:0x4 bank_mask:0xf
    v_mov_b32_dpp v83, v83 row_ror:8 row_mask:0x4 bank_mask:0xf
    v_mov_b32_dpp v84, v84 row_ror:8 row_mask:0x4 bank_mask:0xf
    v_mov_b32_dpp v85, v85 row_ror:8 row_mask:0x4 bank_mask:0xf
    v_mov_b32_dpp v86, v86 row_ror:8 row_mask:0x4 bank_mask:0xf
    v_mov_b32_dpp v87, v87 row_ror:8 row_mask:0x4 bank_mask:0xf
    v_pk_fma_f32 v[12:13], v[96:97], v[64:65], v[12:13]
    v_pk_fma_f32 v[14:15], v[98:99], v[66:67], v[14:15]
    v_pk_fma_f32 v[16:17], v[100:101], v[68:69], v[16:17]
    v_pk_fma_f32 v[18:19], v[102:103], v[70:71], v[18:19]
    v_cvt_pk_bf16_f32 v36, v12, v13
    v_cvt_pk_bf16_f32 v37, v14, v15
    v_cvt_pk_bf16_f32 v38, v16, v17
    v_cvt_pk_bf16_f32 v39, v18, v19
    v_lshlrev_b32 v12, 16, v36
    v_and_b32 v13, 0xffff0000, v36
    v_lshlrev_b32 v14, 16, v37
    v_and_b32 v15, 0xffff0000, v37
    v_lshlrev_b32 v16, 16, v38
    v_and_b32 v17, 0xffff0000, v38
    v_lshlrev_b32 v18, 16, v39
    v_and_b32 v19, 0xffff0000, v39
    s_mov_b32 s45, 5242880
    buffer_store_dwordx4 v[36:39], v6, s[24:27], s45 offen offset:0 sc1
    v_pk_add_f32 v[48:49], v[12:13], v[14:15]
    v_pk_add_f32 v[50:51], v[16:17], v[18:19]
    v_pk_fma_f32 v[28:29], v[112:113], v[80:81], v[28:29]
    v_pk_fma_f32 v[30:31], v[114:115], v[82:83], v[30:31]
    v_pk_fma_f32 v[32:33], v[116:117], v[84:85], v[32:33]
    v_pk_fma_f32 v[34:35], v[118:119], v[86:87], v[34:35]
    v_cvt_pk_bf16_f32 v44, v28, v29
    v_cvt_pk_bf16_f32 v45, v30, v31
    v_cvt_pk_bf16_f32 v46, v32, v33
    v_cvt_pk_bf16_f32 v47, v34, v35
    v_lshlrev_b32 v28, 16, v44
    v_and_b32 v29, 0xffff0000, v44
    v_lshlrev_b32 v30, 16, v45
    v_and_b32 v31, 0xffff0000, v45
    v_lshlrev_b32 v32, 16, v46
    v_and_b32 v33, 0xffff0000, v46
    v_lshlrev_b32 v34, 16, v47
    v_and_b32 v35, 0xffff0000, v47
    s_mov_b32 s45, 5242880
    buffer_store_dwordx4 v[44:47], v60, s[24:27], s45 offen offset:1024 sc1
    v_pk_add_f32 v[48:49], v[48:49], v[28:29]
    v_pk_add_f32 v[50:51], v[50:51], v[30:31]
    v_pk_add_f32 v[48:49], v[48:49], v[32:33]
    v_pk_add_f32 v[50:51], v[50:51], v[34:35]
    v_mfma_f32_16x16x32_bf16 v[72:75], v[250:253], a[64:67], 0
    v_mfma_f32_16x16x32_bf16 v[76:79], v[248:251], a[64:67], 0
    s_waitcnt vmcnt(8)
    v_mfma_f32_16x16x32_bf16 v[72:75], v[250:253], a[68:71], v[72:75]
    v_mfma_f32_16x16x32_bf16 v[76:79], v[248:251], a[68:71], v[76:79]
    s_waitcnt vmcnt(7)
    v_mfma_f32_16x16x32_bf16 v[72:75], v[250:253], a[72:75], v[72:75]
    v_mfma_f32_16x16x32_bf16 v[76:79], v[248:251], a[72:75], v[76:79]
    s_waitcnt vmcnt(6)
    v_mfma_f32_16x16x32_bf16 v[72:75], v[250:253], a[76:79], v[72:75]
    v_mfma_f32_16x16x32_bf16 v[76:79], v[248:251], a[76:79], v[76:79]
    s_waitcnt vmcnt(5)
    v_mfma_f32_16x16x32_bf16 v[72:75], v[250:253], a[80:83], v[72:75]
    v_mfma_f32_16x16x32_bf16 v[76:79], v[248:251], a[80:83], v[76:79]
    s_waitcnt vmcnt(4)
    v_mfma_f32_16x16x32_bf16 v[72:75], v[250:253], a[84:87], v[72:75]
    v_mfma_f32_16x16x32_bf16 v[76:79], v[248:251], a[84:87], v[76:79]
    s_waitcnt vmcnt(3)
    v_mfma_f32_16x16x32_bf16 v[72:75], v[250:253], a[88:91], v[72:75]
    v_mfma_f32_16x16x32_bf16 v[76:79], v[248:251], a[88:91], v[76:79]
    s_waitcnt vmcnt(2)
    v_mfma_f32_16x16x32_bf16 v[72:75], v[250:253], a[92:95], v[72:75]
    v_mfma_f32_16x16x32_bf16 v[76:79], v[248:251], a[92:95], v[76:79]
    s_add_u32 s57, s59, 4096
    s_add_u32 m0, s6, -110592
    s_nop 0
    buffer_load_dwordx4 v255, s[84:87], s57 offen lds
    s_add_u32 s57, s59, 8192
    s_add_u32 m0, s6, -106496
    s_nop 0
    buffer_load_dwordx4 v255, s[84:87], s57 offen lds
    s_add_u32 s57, s59, 12288
    s_add_u32 m0, s6, -102400
    s_nop 0
    buffer_load_dwordx4 v255, s[84:87], s57 offen lds
    s_add_u32 s57, s59, 16384
    s_add_u32 m0, s6, -98304
    s_nop 0
    buffer_load_dwordx4 v255, s[84:87], s57 offen lds
    s_add_u32 s57, s59, 20480
    s_add_u32 m0, s6, -94208
    s_nop 0
    buffer_load_dwordx4 v255, s[84:87], s57 offen lds
    s_add_u32 s57, s59, 24576
    s_add_u32 m0, s6, -90112
    s_nop 0
    buffer_load_dwordx4 v255, s[84:87], s57 offen lds
    s_add_u32 s57, s59, 28672
    s_add_u32 m0, s6, -86016
    s_nop 0
    buffer_load_dwordx4 v255, s[84:87], s57 offen lds
    s_add_u32 s57, s59, 32768
    s_add_u32 m0, s6, -81920
    s_nop 0
    buffer_load_dwordx4 v255, s[84:87], s57 offen lds
    v_pk_fma_f32 v[20:21], v[104:105], v[72:73], v[20:21]
    v_pk_fma_f32 v[22:23], v[106:107], v[74:75], v[22:23]
    v_pk_fma_f32 v[24:25], v[108:109], v[76:77], v[24:25]
    v_pk_fma_f32 v[26:27], v[110:111], v[78:79], v[26:27]
    v_cvt_pk_bf16_f32 v40, v20, v21
    v_cvt_pk_bf16_f32 v41, v22, v23
    v_cvt_pk_bf16_f32 v42, v24, v25
    v_cvt_pk_bf16_f32 v43, v26, v27
    v_lshlrev_b32 v20, 16, v40
    v_and_b32 v21, 0xffff0000, v40
    v_lshlrev_b32 v22, 16, v41
    v_and_b32 v23, 0xffff0000, v41
    v_lshlrev_b32 v24, 16, v42
    v_and_b32 v25, 0xffff0000, v42
    v_lshlrev_b32 v26, 16, v43
    v_and_b32 v27, 0xffff0000, v43
    s_mov_b32 s45, 5242880
    buffer_store_dwordx4 v[40:43], v6, s[24:27], s45 offen offset:512 sc1
    v_pk_add_f32 v[48:49], v[48:49], v[20:21]
    v_pk_add_f32 v[50:51], v[50:51], v[22:23]
    v_pk_add_f32 v[48:49], v[48:49], v[24:25]
    v_pk_add_f32 v[50:51], v[50:51], v[26:27]
    v_pk_add_f32 v[48:49], v[48:49], v[50:51]
    v_add_f32 v48, v48, v49
    s_nop 1
    v_add_f32_dpp v48, v48, v48 row_ror:1 row_mask:0xf bank_mask:0xf
    s_nop 1
    v_add_f32_dpp v48, v48, v48 row_ror:2 row_mask:0xf bank_mask:0xf
    s_nop 1
    v_add_f32_dpp v48, v48, v48 row_ror:4 row_mask:0xf bank_mask:0xf
    s_nop 1
    v_add_f32_dpp v48, v48, v48 row_ror:8 row_mask:0xf bank_mask:0xf
    v_mov_b32 v52, v48
    s_nop 1
    v_permlane16_swap_b32 v48, v52
    s_nop 0
    v_add_f32 v48, v48, v52
    v_mul_f32 v48, 0x3ae38e39, v48
    v_pk_add_f32 v[216:217], v[12:13], v[48:49] op_sel_hi:[1,0] neg_lo:[0,1] neg_hi:[0,1]
    v_pk_add_f32 v[218:219], v[14:15], v[48:49] op_sel_hi:[1,0] neg_lo:[0,1] neg_hi:[0,1]
    v_pk_add_f32 v[220:221], v[16:17], v[48:49] op_sel_hi:[1,0] neg_lo:[0,1] neg_hi:[0,1]
    v_pk_add_f32 v[222:223], v[18:19], v[48:49] op_sel_hi:[1,0] neg_lo:[0,1] neg_hi:[0,1]
    v_pk_add_f32 v[224:225], v[20:21], v[48:49] op_sel_hi:[1,0] neg_lo:[0,1] neg_hi:[0,1]
    v_pk_add_f32 v[226:227], v[22:23], v[48:49] op_sel_hi:[1,0] neg_lo:[0,1] neg_hi:[0,1]
    v_pk_add_f32 v[228:229], v[24:25], v[48:49] op_sel_hi:[1,0] neg_lo:[0,1] neg_hi:[0,1]
    v_pk_add_f32 v[230:231], v[26:27], v[48:49] op_sel_hi:[1,0] neg_lo:[0,1] neg_hi:[0,1]
    v_pk_add_f32 v[232:233], v[28:29], v[48:49] op_sel_hi:[1,0] neg_lo:[0,1] neg_hi:[0,1]
    v_pk_add_f32 v[234:235], v[30:31], v[48:49] op_sel_hi:[1,0] neg_lo:[0,1] neg_hi:[0,1]
    v_pk_add_f32 v[236:237], v[32:33], v[48:49] op_sel_hi:[1,0] neg_lo:[0,1] neg_hi:[0,1]
    v_pk_add_f32 v[238:239], v[34:35], v[48:49] op_sel_hi:[1,0] neg_lo:[0,1] neg_hi:[0,1]
    v_pk_mul_f32 v[50:51], v[216:217], v[216:217]
    v_pk_mul_f32 v[52:53], v[224:225], v[224:225]
    v_pk_mul_f32 v[62:63], v[232:233], v[232:233]
    v_pk_fma_f32 v[50:51], v[218:219], v[218:219], v[50:51]
    v_pk_fma_f32 v[52:53], v[226:227], v[226:227], v[52:53]
    v_pk_fma_f32 v[62:63], v[234:235], v[234:235], v[62:63]
    v_pk_fma_f32 v[50:51], v[220:221], v[220:221], v[50:51]
    v_pk_fma_f32 v[52:53], v[228:229], v[228:229], v[52:53]
    v_pk_fma_f32 v[62:63], v[236:237], v[236:237], v[62:63]
    v_pk_fma_f32 v[50:51], v[222:223], v[222:223], v[50:51]
    v_pk_fma_f32 v[52:53], v[230:231], v[230:231], v[52:53]
    v_pk_fma_f32 v[62:63], v[238:239], v[238:239], v[62:63]
    v_pk_add_f32 v[50:51], v[50:51], v[52:53]
    v_add_f32 v62, v62, v63
    v_add_f32 v50, v50, v51
    v_cndmask_b32 v62, 0, v62, vcc
    v_add_f32 v50, v50, v62
    s_nop 1
    v_add_f32_dpp v50, v50, v50 row_ror:1 row_mask:0xf bank_mask:0xf
    s_nop 1
    v_add_f32_dpp v50, v50, v50 row_ror:2 row_mask:0xf bank_mask:0xf
    s_nop 1
    v_add_f32_dpp v50, v50, v50 row_ror:4 row_mask:0xf bank_mask:0xf
    s_nop 1
    v_add_f32_dpp v50, v50, v50 row_ror:8 row_mask:0xf bank_mask:0xf
    v_mov_b32 v52, v50
    s_nop 1
    v_permlane16_swap_b32 v50, v52
    s_nop 0
    v_add_f32 v50, v50, v52
    v_mul_f32 v50, 0x3ae38e39, v50
    v_cvt_pk_bf16_f32 v52, v48, v50
    v_and_b32 v50, 0xffff0000, v52
    v_lshlrev_b32 v52, 16, v52
    v_add_f32 v50, 0x3727c5ac, v50
    v_sub_f32 v48, v48, v52
    v_cvt_pk_bf16_f32 v50, v50, v50
    v_and_b32 v50, 0xffff0000, v50
    v_sqrt_f32 v50, v50
    s_nop 0
    v_cvt_pk_bf16_f32 v50, v50, v50
    v_and_b32 v50, 0xffff0000, v50
    v_rcp_f32 v50, v50
    s_mov_b32 s45, 2621440
    v_mul_f32 v48, v48, v50
    v_pk_fma_f32 v[216:217], v[216:217], v[50:51], v[48:49] op_sel_hi:[1,0,0]
    v_pk_fma_f32 v[218:219], v[218:219], v[50:51], v[48:49] op_sel_hi:[1,0,0]
    v_pk_fma_f32 v[220:221], v[220:221], v[50:51], v[48:49] op_sel_hi:[1,0,0]
    v_pk_fma_f32 v[222:223], v[222:223], v[50:51], v[48:49] op_sel_hi:[1,0,0]
    v_pk_fma_f32 v[224:225], v[224:225], v[50:51], v[48:49] op_sel_hi:[1,0,0]
    v_pk_fma_f32 v[226:227], v[226:227], v[50:51], v[48:49] op_sel_hi:[1,0,0]
    v_pk_fma_f32 v[228:229], v[228:229], v[50:51], v[48:49] op_sel_hi:[1,0,0]
    v_pk_fma_f32 v[230:231], v[230:231], v[50:51], v[48:49] op_sel_hi:[1,0,0]
    v_pk_fma_f32 v[232:233], v[232:233], v[50:51], v[48:49] op_sel_hi:[1,0,0]
    v_pk_fma_f32 v[234:235], v[234:235], v[50:51], v[48:49] op_sel_hi:[1,0,0]
    v_pk_fma_f32 v[236:237], v[236:237], v[50:51], v[48:49] op_sel_hi:[1,0,0]
    v_pk_fma_f32 v[238:239], v[238:239], v[50:51], v[48:49] op_sel_hi:[1,0,0]
    v_pk_fma_f32 v[216:217], v[216:217], v[120:121], v[144:145]
    v_pk_fma_f32 v[218:219], v[218:219], v[122:123], v[146:147]
    v_pk_fma_f32 v[220:221], v[220:221], v[124:125], v[148:149]
    v_pk_fma_f32 v[222:223], v[222:223], v[126:127], v[150:151]
    v_pk_fma_f32 v[224:225], v[224:225], v[128:129], v[152:153]
    v_pk_fma_f32 v[226:227], v[226:227], v[130:131], v[154:155]
    v_pk_fma_f32 v[228:229], v[228:229], v[132:133], v[156:157]
    v_pk_fma_f32 v[230:231], v[230:231], v[134:135], v[158:159]
    v_pk_fma_f32 v[232:233], v[232:233], v[136:137], v[160:161]
    v_pk_fma_f32 v[234:235], v[234:235], v[138:139], v[162:163]
    v_pk_fma_f32 v[236:237], v[236:237], v[140:141], v[164:165]
    v_pk_fma_f32 v[238:239], v[238:239], v[142:143], v[166:167]
    v_cvt_pk_bf16_f32 v64, v216, v217
    v_cvt_pk_bf16_f32 v65, v218, v219
    v_cvt_pk_bf16_f32 v66, v220, v221
    v_cvt_pk_bf16_f32 v67, v222, v223
    v_cvt_pk_bf16_f32 v68, v224, v225
    v_cvt_pk_bf16_f32 v69, v226, v227
    v_cvt_pk_bf16_f32 v70, v228, v229
    v_cvt_pk_bf16_f32 v71, v230, v231
    v_cvt_pk_bf16_f32 v72, v232, v233
    v_cvt_pk_bf16_f32 v73, v234, v235
    v_cvt_pk_bf16_f32 v74, v236, v237
    v_cvt_pk_bf16_f32 v75, v238, v239
    buffer_store_dwordx4 v[64:67], v6, s[24:27], s45 offen offset:0 sc1
    buffer_store_dwordx4 v[68:71], v6, s[24:27], s45 offen offset:512 sc1
    buffer_store_dwordx4 v[72:75], v60, s[24:27], s45 offen offset:1024 sc1
    v_lshlrev_b32 v216, 16, v64
    v_and_b32 v217, 0xffff0000, v64
    v_lshlrev_b32 v218, 16, v65
    v_and_b32 v219, 0xffff0000, v65
    v_lshlrev_b32 v220, 16, v66
    v_and_b32 v221, 0xffff0000, v66
    v_lshlrev_b32 v222, 16, v67
    v_and_b32 v223, 0xffff0000, v67
    v_lshlrev_b32 v224, 16, v68
    v_and_b32 v225, 0xffff0000, v68
    v_lshlrev_b32 v226, 16, v69
    v_and_b32 v227, 0xffff0000, v69
    v_lshlrev_b32 v228, 16, v70
    v_and_b32 v229, 0xffff0000, v70
    v_lshlrev_b32 v230, 16, v71
    v_and_b32 v231, 0xffff0000, v71
    v_lshlrev_b32 v232, 16, v72
    v_and_b32 v233, 0xffff0000, v72
    v_lshlrev_b32 v234, 16, v73
    v_and_b32 v235, 0xffff0000, v73
    v_lshlrev_b32 v236, 16, v74
    v_and_b32 v237, 0xffff0000, v74
    v_lshlrev_b32 v238, 16, v75
    v_and_b32 v239, 0xffff0000, v75
    v_pk_mul_f32 v[50:51], v[216:217], v[168:169]
    v_pk_mul_f32 v[52:53], v[224:225], v[176:177]
    v_pk_mul_f32 v[62:63], v[232:233], v[184:185]
    v_pk_fma_f32 v[50:51], v[218:219], v[170:171], v[50:51]
    v_pk_fma_f32 v[52:53], v[226:227], v[178:179], v[52:53]
    v_pk_fma_f32 v[62:63], v[234:235], v[186:187], v[62:63]
    v_pk_fma_f32 v[50:51], v[220:221], v[172:173], v[50:51]
    v_pk_fma_f32 v[52:53], v[228:229], v[180:181], v[52:53]
    v_pk_fma_f32 v[62:63], v[236:237], v[188:189], v[62:63]
    v_pk_fma_f32 v[50:51], v[222:223], v[174:175], v[50:51]
    v_pk_fma_f32 v[52:53], v[230:231], v[182:183], v[52:53]
    v_pk_fma_f32 v[62:63], v[238:239], v[190:191], v[62:63]
    v_pk_add_f32 v[50:51], v[50:51], v[52:53]
    v_add_f32 v62, v62, v63
    v_add_f32 v50, v50, v51
    v_add_f32 v50, v50, v62
    v_lshlrev_b32 v48, 2, v7
    v_and_b32 v48, 28, v48
    v_sub_u32 v49, 2047, v7
    v_add_f32_dpp v50, v50, v50 row_ror:1 row_mask:0xf bank_mask:0xf
    s_nop 1
    v_add_f32_dpp v50, v50, v50 row_ror:2 row_mask:0xf bank_mask:0xf
    s_nop 1
    v_add_f32_dpp v50, v50, v50 row_ror:4 row_mask:0xf bank_mask:0xf
    s_nop 1
    v_add_f32_dpp v50, v50, v50 row_ror:8 row_mask:0xf bank_mask:0xf
    v_mov_b32 v52, v50
    s_nop 1
    v_permlane16_swap_b32 v50, v52
    s_nop 0
    v_add_f32 v50, v50, v52
    v_ashrrev_i32 v52, 31, v50
    v_or_b32 v52, 0x80000000, v52
    v_xor_b32 v52, v52, v50
    v_and_b32 v52, 0xfffff800, v52
    v_min_u32 v52, 0xfffff000, v52
    v_or_b32 v52, v52, v49
    s_mov_b32 exec_lo, 1
    s_mov_b32 exec_hi, 1
    ds_write_b32 v48, v52 offset:36864
    s_mov_b64 exec, -1
    s_waitcnt lgkmcnt(0)
    s_barrier
    s_cmp_lg_u32 s3, 0
    s_cbranch_scc1 Ltail_notw0
    v_mov_b32 v141, 36864
    ds_read_b128 v[128:131], v141
    ds_read_b128 v[132:135], v141 offset:16
    s_lshl_b32 s45, s2, 7
    s_add_u32 s45, s45, 8912896
    s_waitcnt lgkmcnt(1)
    v_max_u32 v136, v128, v129
    v_min_u32 v137, v128, v129
    v_med3_u32 v137, v136, v137, v130
    v_max_u32 v136, v136, v130
    v_med3_u32 v137, v136, v137, v131
    v_max_u32 v136, v136, v131
    s_waitcnt lgkmcnt(0)
    v_med3_u32 v137, v136, v137, v132
    v_max_u32 v136, v136, v132
    v_med3_u32 v137, v136, v137, v133
    v_max_u32 v136, v136, v133
    v_med3_u32 v137, v136, v137, v134
    v_max_u32 v136, v136, v134
    v_med3_u32 v137, v136, v137, v135
    v_max_u32 v136, v136, v135
    buffer_store_dwordx2 v[136:137], v8, s[24:27], s45 offen sc1
Ltail_notw0:
    v_pk_mul_f32 v[192:193], v[192:193], v[216:217]
    v_pk_mul_f32 v[194:195], v[194:195], v[218:219]
    v_pk_mul_f32 v[196:197], v[196:197], v[220:221]
    v_pk_mul_f32 v[198:199], v[198:199], v[222:223]
    v_pk_mul_f32 v[200:201], v[200:201], v[224:225]
    v_pk_mul_f32 v[202:203], v[202:203], v[226:227]
    v_pk_mul_f32 v[204:205], v[204:205], v[228:229]
    v_pk_mul_f32 v[206:207], v[206:207], v[230:231]
    v_pk_mul_f32 v[208:209], v[208:209], v[232:233]
    v_pk_mul_f32 v[210:211], v[210:211], v[234:235]
    v_pk_mul_f32 v[212:213], v[212:213], v[236:237]
    v_pk_mul_f32 v[214:215], v[214:215], v[238:239]
    v_cvt_pk_bf16_f32 v144, v192, v193
    v_cvt_pk_bf16_f32 v145, v194, v195
    v_cvt_pk_bf16_f32 v146, v196, v197
    v_cvt_pk_bf16_f32 v147, v198, v199
    v_cvt_pk_bf16_f32 v148, v200, v201
    v_cvt_pk_bf16_f32 v149, v202, v203
    v_cvt_pk_bf16_f32 v150, v204, v205
    v_cvt_pk_bf16_f32 v151, v206, v207
    v_cvt_pk_bf16_f32 v152, v208, v209
    v_cvt_pk_bf16_f32 v153, v210, v211
    v_cvt_pk_bf16_f32 v154, v212, v213
    v_cvt_pk_bf16_f32 v155, v214, v215
    v_lshlrev_b32 v192, 16, v144
    v_and_b32 v193, 0xffff0000, v144
    v_lshlrev_b32 v194, 16, v145
    v_and_b32 v195, 0xffff0000, v145
    v_lshlrev_b32 v196, 16, v146
    v_and_b32 v197, 0xffff0000, v146
    v_lshlrev_b32 v198, 16, v147
    v_and_b32 v199, 0xffff0000, v147
    v_lshlrev_b32 v200, 16, v148
    v_and_b32 v201, 0xffff0000, v148
    v_lshlrev_b32 v202, 16, v149
    v_and_b32 v203, 0xffff0000, v149
    v_lshlrev_b32 v204, 16, v150
    v_and_b32 v205, 0xffff0000, v150
    v_lshlrev_b32 v206, 16, v151
    v_and_b32 v207, 0xffff0000, v151
    v_lshlrev_b32 v208, 16, v152
    v_and_b32 v209, 0xffff0000, v152
    v_lshlrev_b32 v210, 16, v153
    v_and_b32 v211, 0xffff0000, v153
    v_lshlrev_b32 v212, 16, v154
    v_and_b32 v213, 0xffff0000, v154
    v_lshlrev_b32 v214, 16, v155
    v_and_b32 v215, 0xffff0000, v155
    v_pk_add_f32 v[192:193], v[192:193], v[12:13]
    v_pk_add_f32 v[194:195], v[194:195], v[14:15]
    v_pk_add_f32 v[196:197], v[196:197], v[16:17]
    v_pk_add_f32 v[198:199], v[198:199], v[18:19]
    v_pk_add_f32 v[200:201], v[200:201], v[20:21]
    v_pk_add_f32 v[202:203], v[202:203], v[22:23]
    v_pk_add_f32 v[204:205], v[204:205], v[24:25]
    v_pk_add_f32 v[206:207], v[206:207], v[26:27]
    v_pk_add_f32 v[208:209], v[208:209], v[28:29]
    v_pk_add_f32 v[210:211], v[210:211], v[30:31]
    v_pk_add_f32 v[212:213], v[212:213], v[32:33]
    v_pk_add_f32 v[214:215], v[214:215], v[34:35]
    v_cvt_pk_bf16_f32 v144, v192, v193
    v_cvt_pk_bf16_f32 v145, v194, v195
    v_cvt_pk_bf16_f32 v146, v196, v197
    v_cvt_pk_bf16_f32 v147, v198, v199
    v_cvt_pk_bf16_f32 v148, v200, v201
    v_cvt_pk_bf16_f32 v149, v202, v203
    v_cvt_pk_bf16_f32 v150, v204, v205
    v_cvt_pk_bf16_f32 v151, v206, v207
    v_cvt_pk_bf16_f32 v152, v208, v209
    v_cvt_pk_bf16_f32 v153, v210, v211
    v_cvt_pk_bf16_f32 v154, v212, v213
    v_cvt_pk_bf16_f32 v155, v214, v215
    s_mov_b32 s38, 135168
    s_mov_b32 s39, 12288
    v_lshrrev_b32 v9, 2, v1
    v_and_b32 v10, 3, v1
    v_lshlrev_b32 v10, 3, v10
    s_and_b32 s45, s3, 1
    s_lshl_b32 s45, s45, 5
    v_lshl_add_u32 v11, v9, 6, v10
    v_add_u32 v11, s45, v11
    s_cmp_lt_u32 s3, 2
    s_cselect_b32 s44, 98304, s38
    s_cselect_b32 s45, 98304, s39
    v_add_u32 v12, s45, v11
    v_add_u32 v11, s44, v11
    ds_read_b64_tr_b16 a[0:1], v11 offset:0
    ds_read_b64_tr_b16 a[2:3], v11 offset:1024
    ds_read_b64_tr_b16 a[4:5], v11 offset:2048
    ds_read_b64_tr_b16 a[6:7], v11 offset:3072
    ds_read_b64_tr_b16 a[8:9], v11 offset:4096
    ds_read_b64_tr_b16 a[10:11], v11 offset:5120
    ds_read_b64_tr_b16 a[12:13], v11 offset:6144
    ds_read_b64_tr_b16 a[14:15], v11 offset:7168
    ds_read_b64_tr_b16 a[16:17], v11 offset:8192
    ds_read_b64_tr_b16 a[18:19], v11 offset:9216
    ds_read_b64_tr_b16 a[20:21], v11 offset:10240
    ds_read_b64_tr_b16 a[22:23], v11 offset:11264
    ds_read_b64_tr_b16 a[24:25], v11 offset:12288
    ds_read_b64_tr_b16 a[26:27], v11 offset:13312
    ds_read_b64_tr_b16 a[28:29], v11 offset:14336
    ds_read_b64_tr_b16 a[30:31], v11 offset:15360
    ds_read_b64_tr_b16 a[32:33], v11 offset:16384
    ds_read_b64_tr_b16 a[34:35], v11 offset:17408
    ds_read_b64_tr_b16 a[36:37], v11 offset:18432
    ds_read_b64_tr_b16 a[38:39], v11 offset:19456
    ds_read_b64_tr_b16 a[40:41], v11 offset:20480
    ds_read_b64_tr_b16 a[42:43], v11 offset:21504
    ds_read_b64_tr_b16 a[44:45], v11 offset:22528
    ds_read_b64_tr_b16 a[46:47], v11 offset:23552
    ds_read_b64_tr_b16 a[48:49], v11 offset:24576
    ds_read_b64_tr_b16 a[50:51], v11 offset:25600
    ds_read_b64_tr_b16 a[52:53], v11 offset:26624
    ds_read_b64_tr_b16 a[54:55], v11 offset:27648
    ds_read_b64_tr_b16 a[56:57], v12 offset:28672
    ds_read_b64_tr_b16 a[58:59], v12 offset:29696
    ds_read_b64_tr_b16 a[60:61], v12 offset:30720
    ds_read_b64_tr_b16 a[62:63], v12 offset:31744
    ds_read_b64_tr_b16 a[64:65], v12 offset:32768
    ds_read_b64_tr_b16 a[66:67], v12 offset:33792
    ds_read_b64_tr_b16 a[68:69], v12 offset:34816
    ds_read_b64_tr_b16 a[70:71], v12 offset:35840
    v_mul_u32_u24 v12, 1152, v9
    s_lshl_b32 s44, s3, 7
    s_add_u32 s44, s44, 49152
    v_add3_u32 v12, v12, v10, s44
    v_lshlrev_b32 v13, 4, v1
    v_add_u32 v13, 32768, v13
    s_lshl_b32 s44, s3, 10
    v_add_u32 v14, s44, v13
    v_bfe_u32 v15, v1, 2, 2
    v_cmp_eq_u32 s[52:53], 0, v15
    v_cmp_eq_u32 s[54:55], 1, v15
    v_cmp_eq_u32 s[56:57], 2, v15
    v_cmp_eq_u32 s[58:59], 3, v15
    s_mul_i32 s43, s42, 18
    s_add_u32 s43, s43, s41
    s_lshl_b32 s43, s43, 9
    s_mul_i32 s44, s3, 73728
    s_add_u32 s43, s43, s44
    v_lshlrev_b32 v15, 3, v1
    v_lshlrev_b32 v140, 7, v0
    s_mov_b32 s45, 8912896
    s_lshl_b32 s36, s3, 3
    v_mov_b32 v141, s36
    s_mov_b32 s48, 16384
Ltail_pollk:
    buffer_load_dwordx2 v[136:137], v140, s[24:27], s45 offen sc1
    s_sub_u32 s48, s48, 1
    s_cbranch_scc1 Ltail_gotk
    s_waitcnt vmcnt(0)
    v_max_u32 v138, v136, v137
    v_cmp_eq_u32 vcc, -1, v138
    s_cbranch_vccnz Ltail_pollk
Ltail_gotk:
    s_waitcnt vmcnt(0)
    v_mov_b32_dpp v138, v136 row_ror:1 row_mask:0xf bank_mask:0xf
    v_mov_b32_dpp v139, v137 row_ror:1 row_mask:0xf bank_mask:0xf
    v_min_u32 v142, v136, v138
    v_max_u32 v136, v136, v138
    v_max3_u32 v137, v142, v137, v139
    s_nop 0
    v_mov_b32_dpp v138, v136 row_ror:2 row_mask:0xf bank_mask:0xf
    v_mov_b32_dpp v139, v137 row_ror:2 row_mask:0xf bank_mask:0xf
    v_min_u32 v142, v136, v138
    v_max_u32 v136, v136, v138
    v_max3_u32 v137, v142, v137, v139
    s_nop 0
    v_mov_b32_dpp v138, v136 row_ror:4 row_mask:0xf bank_mask:0xf
    v_mov_b32_dpp v139, v137 row_ror:4 row_mask:0xf bank_mask:0xf
    v_min_u32 v142, v136, v138
    v_max_u32 v136, v136, v138
    v_max3_u32 v137, v142, v137, v139
    s_nop 0
    v_mov_b32_dpp v138, v136 row_ror:8 row_mask:0xf bank_mask:0xf
    v_mov_b32_dpp v139, v137 row_ror:8 row_mask:0xf bank_mask:0xf
    v_min_u32 v142, v136, v138
    v_max_u32 v136, v136, v138
    v_max3_u32 v137, v142, v137, v139
    v_mov_b32 v138, v136
    v_mov_b32 v139, v137
    s_nop 0
    v_permlane16_swap_b32 v136, v138
    v_permlane16_swap_b32 v137, v139
    v_min_u32 v142, v136, v138
    v_max_u32 v136, v136, v138
    v_max3_u32 v137, v142, v137, v139
    v_mov_b32 v138, v136
    v_mov_b32 v139, v137
    s_nop 0
    v_permlane32_swap_b32 v136, v138
    v_permlane32_swap_b32 v137, v139
    v_min_u32 v142, v136, v138
    v_max_u32 v136, v136, v138
    v_max3_u32 v137, v142, v137, v139
    ds_write_b64 v141, v[136:137] offset:36928
    v_mov_b32 v141, 36928
    s_waitcnt lgkmcnt(0)
    s_barrier
    ds_read_b128 v[128:131], v141
    ds_read_b128 v[132:135], v141 offset:16
    s_or_b32 s36, s2, s3
    s_cselect_b32 s45, -4, 24576
    s_add_u32 s36, s94, 1
    v_mov_b32 v138, s36
    buffer_store_dword v138, v8, s[24:27], s45 offen
    s_waitcnt lgkmcnt(1)
    v_max_u32 v136, v128, v129
    v_min_u32 v137, v128, v129
    v_med3_u32 v137, v136, v137, v130
    v_max_u32 v136, v136, v130
    v_med3_u32 v137, v136, v137, v131
    v_max_u32 v136, v136, v131
    s_waitcnt lgkmcnt(0)
    v_med3_u32 v137, v136, v137, v132
    v_max_u32 v136, v136, v132
    v_med3_u32 v137, v136, v137, v133
    v_max_u32 v136, v136, v133
    v_med3_u32 v137, v136, v137, v134
    v_max_u32 v136, v136, v134
    v_med3_u32 v137, v136, v137, v135
    v_max_u32 v136, v136, v135
    s_nop 0
    v_readfirstlane_b32 s92, v136
    v_readfirstlane_b32 s93, v137
    s_andn2_b32 s46, 0x7ff, s92
    s_andn2_b32 s47, 0x7ff, s93
    s_cmp_ge_u32 s41, 18
    s_cbranch_scc1 Ltail_noffn
    s_mul_i32 s44, s46, 1152
    s_mul_i32 s45, s47, 1152
    s_sub_u32 s45, s45, s44
    v_and_b32 v8, 1, v1
    v_mul_lo_u32 v8, v8, s45
    v_and_b32 v9, 48, v1
    v_add3_u32 v8, v8, v9, s44
    s_mov_b32 s45, 2621440
    s_mov_b32 s48, 16384
Ltail_pollh:
    buffer_load_dwordx4 a[120:123], v8, s[24:27], s45 offen offset:0 sc1
    buffer_load_dwordx4 a[124:127], v8, s[24:27], s45 offen offset:64 sc1
    buffer_load_dwordx4 a[128:131], v8, s[24:27], s45 offen offset:128 sc1
    buffer_load_dwordx4 a[132:135], v8, s[24:27], s45 offen offset:192 sc1
    buffer_load_dwordx4 a[136:139], v8, s[24:27], s45 offen offset:256 sc1
    buffer_load_dwordx4 a[140:143], v8, s[24:27], s45 offen offset:320 sc1
    buffer_load_dwordx4 a[144:147], v8, s[24:27], s45 offen offset:384 sc1
    buffer_load_dwordx4 a[148:151], v8, s[24:27], s45 offen offset:448 sc1
    buffer_load_dwordx4 a[152:155], v8, s[24:27], s45 offen offset:512 sc1
    buffer_load_dwordx4 a[156:159], v8, s[24:27], s45 offen offset:576 sc1
    buffer_load_dwordx4 a[160:163], v8, s[24:27], s45 offen offset:640 sc1
    buffer_load_dwordx4 a[164:167], v8, s[24:27], s45 offen offset:704 sc1
    buffer_load_dwordx4 a[168:171], v8, s[24:27], s45 offen offset:768 sc1
    buffer_load_dwordx4 a[172:175], v8, s[24:27], s45 offen offset:832 sc1
    buffer_load_dwordx4 a[176:179], v8, s[24:27], s45 offen offset:896 sc1
    buffer_load_dwordx4 a[180:183], v8, s[24:27], s45 offen offset:960 sc1
    buffer_load_dwordx4 a[184:187], v8, s[24:27], s45 offen offset:1024 sc1
    buffer_load_dwordx4 a[188:191], v8, s[24:27], s45 offen offset:1088 sc1
    ds_read_b64_tr_b16 a[72:73], v12 offset:0
    ds_read_b64_tr_b16 a[74:75], v12 offset:18432
    ds_read_b64_tr_b16 a[76:77], v12 offset:32
    ds_read_b64_tr_b16 a[78:79], v12 offset:18464
    ds_read_b64_tr_b16 a[80:81], v12 offset:64
    ds_read_b64_tr_b16 a[82:83], v12 offset:18496
    ds_read_b64_tr_b16 a[84:85], v12 offset:96
    ds_read_b64_tr_b16 a[86:87], v12 offset:18528
    ds_read_b64_tr_b16 a[88:89], v12 offset:512
    ds_read_b64_tr_b16 a[90:91], v12 offset:18944
    ds_read_b64_tr_b16 a[92:93], v12 offset:544
    ds_read_b64_tr_b16 a[94:95], v12 offset:18976
    ds_read_b64_tr_b16 a[96:97], v12 offset:576
    ds_read_b64_tr_b16 a[98:99], v12 offset:19008
    ds_read_b64_tr_b16 a[100:101], v12 offset:608
    ds_read_b64_tr_b16 a[102:103], v12 offset:19040
    ds_read_b64_tr_b16 a[104:105], v12 offset:1024
    ds_read_b64_tr_b16 a[106:107], v12 offset:19456
    ds_read_b64_tr_b16 a[108:109], v12 offset:1056
    ds_read_b64_tr_b16 a[110:111], v12 offset:19488
    ds_read_b64_tr_b16 a[112:113], v12 offset:1088
    ds_read_b64_tr_b16 a[114:115], v12 offset:19520
    ds_read_b64_tr_b16 a[116:117], v12 offset:1120
    ds_read_b64_tr_b16 a[118:119], v12 offset:19552
    s_waitcnt vmcnt(17)
    v_mfma_f32_16x16x32_bf16 v[16:19], a[0:3], a[120:123], 0
    s_waitcnt vmcnt(16)
    v_mfma_f32_16x16x32_bf16 v[20:23], a[4:7], a[124:127], 0
    s_waitcnt vmcnt(15)
    v_mfma_f32_16x16x32_bf16 v[16:19], a[8:11], a[128:131], v[16:19]
    s_waitcnt vmcnt(14)
    v_mfma_f32_16x16x32_bf16 v[20:23], a[12:15], a[132:135], v[20:23]
    s_waitcnt vmcnt(13)
    v_mfma_f32_16x16x32_bf16 v[16:19], a[16:19], a[136:139], v[16:19]
    s_waitcnt vmcnt(12)
    v_mfma_f32_16x16x32_bf16 v[20:23], a[20:23], a[140:143], v[20:23]
    s_waitcnt vmcnt(11)
    v_mfma_f32_16x16x32_bf16 v[16:19], a[24:27], a[144:147], v[16:19]
    s_waitcnt vmcnt(10)
    v_mfma_f32_16x16x32_bf16 v[20:23], a[28:31], a[148:151], v[20:23]
    s_waitcnt vmcnt(9)
    v_mfma_f32_16x16x32_bf16 v[16:19], a[32:35], a[152:155], v[16:19]
    s_waitcnt vmcnt(8)
    v_mfma_f32_16x16x32_bf16 v[20:23], a[36:39], a[156:159], v[20:23]
    s_waitcnt vmcnt(7)
    v_mfma_f32_16x16x32_bf16 v[16:19], a[40:43], a[160:163], v[16:19]
    s_waitcnt vmcnt(6)
    v_mfma_f32_16x16x32_bf16 v[20:23], a[44:47], a[164:167], v[20:23]
    s_waitcnt vmcnt(5)
    v_mfma_f32_16x16x32_bf16 v[16:19], a[48:51], a[168:171], v[16:19]
    s_waitcnt vmcnt(4)
    v_mfma_f32_16x16x32_bf16 v[20:23], a[52:55], a[172:175], v[20:23]
    s_waitcnt vmcnt(3)
    v_mfma_f32_16x16x32_bf16 v[16:19], a[56:59], a[176:179], v[16:19]
    s_waitcnt vmcnt(2)
    v_mfma_f32_16x16x32_bf16 v[20:23], a[60:63], a[180:183], v[20:23]
    s_waitcnt vmcnt(1)
    v_mfma_f32_16x16x32_bf16 v[16:19], a[64:67], a[184:187], v[16:19]
    s_waitcnt vmcnt(0)
    v_mfma_f32_16x16x32_bf16 v[20:23], a[68:71], a[188:191], v[20:23]
    s_sub_u32 s48, s48, 1
    s_nop 6
    v_pk_add_f32 v[16:17], v[16:17], v[20:21]
    v_pk_add_f32 v[18:19], v[18:19], v[22:23]
    s_cbranch_scc1 Ltail_goth
    v_cmp_u_f32 vcc, v16, v16
    s_cbranch_vccnz Ltail_pollh
Ltail_goth:
    ds_write_b128 v14, v[16:19]
    s_waitcnt lgkmcnt(0)
    s_barrier
    ds_read_b128 v[16:19], v13 offset:0
    ds_read_b128 v[20:23], v13 offset:1024
    ds_read_b128 v[24:27], v13 offset:2048
    ds_read_b128 v[28:31], v13 offset:3072
    s_mov_b32 s36, 0xbfb8aa3b
    s_mov_b32 s37, 0xbfb8aa3b
    s_waitcnt lgkmcnt(3)
    v_cvt_pk_bf16_f32 v32, v16, v17
    v_cvt_pk_bf16_f32 v33, v18, v19
    s_waitcnt lgkmcnt(2)
    v_cvt_pk_bf16_f32 v34, v20, v21
    v_cvt_pk_bf16_f32 v35, v22, v23
    v_lshlrev_b32 v16, 16, v32
    v_and_b32 v17, 0xffff0000, v32
    v_lshlrev_b32 v18, 16, v33
    v_and_b32 v19, 0xffff0000, v33
    v_lshlrev_b32 v20, 16, v34
    v_and_b32 v21, 0xffff0000, v34
    v_lshlrev_b32 v22, 16, v35
    v_and_b32 v23, 0xffff0000, v35
    v_pk_mul_f32 v[32:33], v[16:17], s[36:37]
    v_pk_mul_f32 v[34:35], v[18:19], s[36:37]
    v_pk_mul_f32 v[36:37], v[20:21], s[36:37]
    v_pk_mul_f32 v[38:39], v[22:23], s[36:37]
    v_exp_f32 v32, v32
    v_exp_f32 v33, v33
    v_exp_f32 v34, v34
    v_exp_f32 v35, v35
    v_exp_f32 v36, v36
    v_exp_f32 v37, v37
    v_exp_f32 v38, v38
    v_exp_f32 v39, v39
    s_waitcnt lgkmcnt(1)
    v_cvt_pk_bf16_f32 v60, v24, v25
    v_cvt_pk_bf16_f32 v61, v26, v27
    s_waitcnt lgkmcnt(0)
    v_cvt_pk_bf16_f32 v62, v28, v29
    v_cvt_pk_bf16_f32 v63, v30, v31
    v_pk_add_f32 v[32:33], v[32:33], 1.0 op_sel_hi:[1,0]
    v_pk_add_f32 v[34:35], v[34:35], 1.0 op_sel_hi:[1,0]
    v_pk_add_f32 v[36:37], v[36:37], 1.0 op_sel_hi:[1,0]
    v_pk_add_f32 v[38:39], v[38:39], 1.0 op_sel_hi:[1,0]
    v_rcp_f32 v32, v32
    v_rcp_f32 v33, v33
    v_rcp_f32 v34, v34
    v_rcp_f32 v35, v35
    v_rcp_f32 v36, v36
    v_rcp_f32 v37, v37
    v_rcp_f32 v38, v38
    v_rcp_f32 v39, v39
    v_lshlrev_b32 v24, 16, v60
    v_and_b32 v25, 0xffff0000, v60
    v_lshlrev_b32 v26, 16, v61
    v_and_b32 v27, 0xffff0000, v61
    v_lshlrev_b32 v28, 16, v62
    v_and_b32 v29, 0xffff0000, v62
    v_lshlrev_b32 v30, 16, v63
    v_and_b32 v31, 0xffff0000, v63
    v_pk_mul_f32 v[16:17], v[16:17], v[32:33]
    v_pk_mul_f32 v[18:19], v[18:19], v[34:35]
    v_pk_mul_f32 v[20:21], v[20:21], v[36:37]
    v_pk_mul_f32 v[22:23], v[22:23], v[38:39]
    v_cvt_pk_bf16_f32 v32, v16, v17
    v_cvt_pk_bf16_f32 v33, v18, v19
    v_cvt_pk_bf16_f32 v34, v20, v21
    v_cvt_pk_bf16_f32 v35, v22, v23
    v_lshlrev_b32 v16, 16, v32
    v_and_b32 v17, 0xffff0000, v32
    v_lshlrev_b32 v18, 16, v33
    v_and_b32 v19, 0xffff0000, v33
    v_lshlrev_b32 v20, 16, v34
    v_and_b32 v21, 0xffff0000, v34
    v_lshlrev_b32 v22, 16, v35
    v_and_b32 v23, 0xffff0000, v35
    v_pk_mul_f32 v[16:17], v[16:17], v[24:25]
    v_pk_mul_f32 v[18:19], v[18:19], v[26:27]
    v_pk_mul_f32 v[20:21], v[20:21], v[28:29]
    v_pk_mul_f32 v[22:23], v[22:23], v[30:31]
    v_cvt_pk_bf16_f32 v32, v16, v17
    v_cvt_pk_bf16_f32 v33, v18, v19
    v_cvt_pk_bf16_f32 v34, v20, v21
    v_cvt_pk_bf16_f32 v35, v22, v23
    v_cndmask_b32 v64, 0, v32, s[52:53]
    v_cndmask_b32 v65, 0, v33, s[52:53]
    v_cndmask_b32 v66, 0, v34, s[52:53]
    v_cndmask_b32 v67, 0, v35, s[52:53]
    v_cndmask_b32 v68, 0, v32, s[54:55]
    v_cndmask_b32 v69, 0, v33, s[54:55]
    v_cndmask_b32 v70, 0, v34, s[54:55]
    v_cndmask_b32 v71, 0, v35, s[54:55]
    v_cndmask_b32 v72, 0, v32, s[56:57]
    v_cndmask_b32 v73, 0, v33, s[56:57]
    v_cndmask_b32 v74, 0, v34, s[56:57]
    v_cndmask_b32 v75, 0, v35, s[56:57]
    v_cndmask_b32 v76, 0, v32, s[58:59]
    v_cndmask_b32 v77, 0, v33, s[58:59]
    v_cndmask_b32 v78, 0, v34, s[58:59]
    v_cndmask_b32 v79, 0, v35, s[58:59]
    v_mfma_f32_16x16x32_bf16 v[16:19], v[64:67], a[72:75], 0
    v_mfma_f32_16x16x32_bf16 v[16:19], v[68:71], a[76:79], v[16:19]
    v_mfma_f32_16x16x32_bf16 v[16:19], v[72:75], a[80:83], v[16:19]
    v_mfma_f32_16x16x32_bf16 v[16:19], v[76:79], a[84:87], v[16:19]
    v_mfma_f32_16x16x32_bf16 v[20:23], v[64:67], a[88:91], 0
    v_mfma_f32_16x16x32_bf16 v[20:23], v[68:71], a[92:95], v[20:23]
    v_mfma_f32_16x16x32_bf16 v[20:23], v[72:75], a[96:99], v[20:23]
    v_mfma_f32_16x16x32_bf16 v[20:23], v[76:79], a[100:103], v[20:23]
    v_mfma_f32_16x16x32_bf16 v[24:27], v[64:67], a[104:107], 0
    v_mfma_f32_16x16x32_bf16 v[24:27], v[68:71], a[108:111], v[24:27]
    v_mfma_f32_16x16x32_bf16 v[24:27], v[72:75], a[112:115], v[24:27]
    v_mfma_f32_16x16x32_bf16 v[24:27], v[76:79], a[116:119], v[24:27]
    v_min_u32 v16, -2, v16
    v_min_u32 v17, -2, v17
    buffer_store_dwordx2 v[16:17], v15, s[8:11], s43 offen sc1
    s_add_u32 s43, s43, 294912
    v_min_u32 v20, -2, v20
    v_min_u32 v21, -2, v21
    buffer_store_dwordx2 v[20:21], v15, s[8:11], s43 offen sc1
    s_add_u32 s43, s43, 294912
    v_min_u32 v24, -2, v24
    v_min_u32 v25, -2, v25
    buffer_store_dwordx2 v[24:25], v15, s[8:11], s43 offen sc1
    v_cmp_ne_u32 vcc, s46, v7
    v_cmp_ne_u32 s[36:37], s47, v7
    v_mov_b32 v31, 2147483648
    s_and_b64 vcc, vcc, s[36:37]
    s_nop 1
    v_cndmask_b32 v30, v31, v58, vcc
    v_cndmask_b32 v31, v31, v4, vcc
    buffer_store_dwordx2 v[144:145], v31, s[16:19], 0 offen offset:0
    buffer_store_dwordx2 v[146:147], v31, s[16:19], 0 offen offset:32
    buffer_store_dwordx2 v[148:149], v31, s[16:19], 0 offen offset:512
    buffer_store_dwordx2 v[150:151], v31, s[16:19], 0 offen offset:544
    buffer_store_dwordx2 v[152:153], v30, s[16:19], 0 offen offset:1024
    buffer_store_dwordx2 v[154:155], v30, s[16:19], 0 offen offset:1056
    s_branch Ltail_done
Ltail_noffn:
    s_cmp_lt_u32 s41, 27
    s_cselect_b32 s36, s3, 1
    s_cmp_eq_u32 s36, 0
    s_cbranch_scc1 Ltail_final
    v_cmp_ne_u32 vcc, s46, v7
    v_cmp_ne_u32 s[36:37], s47, v7
    v_mov_b32 v31, 2147483648
    s_and_b64 vcc, vcc, s[36:37]
    s_nop 1
    v_cndmask_b32 v30, v31, v58, vcc
    v_cndmask_b32 v31, v31, v4, vcc
    buffer_store_dwordx2 v[144:145], v31, s[16:19], 0 offen offset:0
    buffer_store_dwordx2 v[146:147], v31, s[16:19], 0 offen offset:32
    buffer_store_dwordx2 v[148:149], v31, s[16:19], 0 offen offset:512
    buffer_store_dwordx2 v[150:151], v31, s[16:19], 0 offen offset:544
    buffer_store_dwordx2 v[152:153], v30, s[16:19], 0 offen offset:1024
    buffer_store_dwordx2 v[154:155], v30, s[16:19], 0 offen offset:1056
    s_branch Ltail_done
Ltail_final:
    s_mul_i32 s43, s42, 9
    s_add_u32 s43, s43, s41
    s_sub_u32 s43, s43, 18
    v_bfe_u32 v8, v1, 2, 1
    v_cmp_eq_u32 vcc, 1, v8
    v_mov_b32 v9, s46
    v_mov_b32 v10, s47
    v_and_b32 v11, 3, v1
    v_cndmask_b32 v9, v9, v10, vcc
    s_lshr_b32 s44, s43, 2
    s_lshl_b32 s44, s44, 6
    s_and_b32 s45, s43, 1
    s_lshl_b32 s45, s45, 5
    s_add_u32 s44, s44, s45
    s_and_b32 s45, s43, 2
    s_lshl_b32 s45, s45, 2
    s_add_u32 s44, s44, s45
    v_lshrrev_b32 v12, 1, v11
    v_lshl_add_u32 v12, v12, 4, s44
    v_and_b32 v13, 1, v11
    v_lshl_add_u32 v12, v13, 2, v12
    v_mul_u32_u24 v13, 1152, v9
    v_add_u32 v14, v13, v12
    v_add_u32 v15, 2621440, v14
    s_mov_b32 s45, 22144
    buffer_load_dword v18, v12, s[24:27], s45 offen sc1
    v_mov_b32 v19, s92
    v_mov_b32 v10, s93
    v_cndmask_b32 v19, v19, v10, vcc
    v_and_b32 v19, 0xfffff800, v19
    v_or_b32 v19, 0x400, v19
    v_ashrrev_i32 v10, 31, v19
    v_not_b32 v10, v10
    v_or_b32 v10, 0x80000000, v10
    v_xor_b32 v19, v19, v10
    s_lshl_b32 s45, s43, 4
    v_lshl_add_u32 v13, v11, 2, v13
    v_add_u32 v13, s45, v13
    v_lshrrev_b32 v14, 2, v1
    v_lshlrev_b32 v14, 9, v14
    v_lshl_add_u32 v14, v11, 4, v14
    s_lshr_b32 s44, s43, 3
    s_mul_i32 s44, s44, 73728
    s_and_b32 s45, s43, 7
    s_lshl_b32 s45, s45, 6
    s_add_u32 s44, s44, s45
    v_cmp_ne_u32 vcc, s46, v7
    v_cmp_ne_u32 s[36:37], s47, v7
    v_mov_b32 v31, 2147483648
    s_and_b64 vcc, vcc, s[36:37]
    s_nop 1
    v_cndmask_b32 v30, v31, v58, vcc
    v_cndmask_b32 v31, v31, v4, vcc
    buffer_store_dwordx2 v[144:145], v31, s[16:19], 0 offen offset:0
    buffer_store_dwordx2 v[146:147], v31, s[16:19], 0 offen offset:32
    buffer_store_dwordx2 v[148:149], v31, s[16:19], 0 offen offset:512
    buffer_store_dwordx2 v[150:151], v31, s[16:19], 0 offen offset:544
    buffer_store_dwordx2 v[152:153], v30, s[16:19], 0 offen offset:1024
    buffer_store_dwordx2 v[154:155], v30, s[16:19], 0 offen offset:1056
    v_cmp_eq_u32 s[36:37], 1, v8
    v_cvt_pk_bf16_f32 v19, v19, v19
    v_and_b32 v19, 0xffff0000, v19
    v_mul_f32 v19, 0xbfb8aa3b, v19
    v_exp_f32 v19, v19
    s_waitcnt vmcnt(6)
    v_lshlrev_b32 v24, 16, v18
    v_and_b32 v25, 0xffff0000, v18
    v_add_f32 v19, 1.0, v19
    v_rcp_f32 v19, v19
    s_mov_b32 s48, 16384
    v_cvt_pk_bf16_f32 v19, v19, v19
    v_and_b32 v19, 0xffff0000, v19
Ltail_polly:
    s_add_u32 s45, s44, 0
    buffer_load_dwordx4 v[64:67], v14, s[8:11], s45 offen sc1
    s_add_u32 s45, s44, 8192
    buffer_load_dwordx4 v[68:71], v14, s[8:11], s45 offen sc1
    s_add_u32 s45, s44, 16384
    buffer_load_dwordx4 v[72:75], v14, s[8:11], s45 offen sc1
    s_add_u32 s45, s44, 24576
    buffer_load_dwordx4 v[76:79], v14, s[8:11], s45 offen sc1
    s_add_u32 s45, s44, 32768
    buffer_load_dwordx4 v[80:83], v14, s[8:11], s45 offen sc1
    s_add_u32 s45, s44, 40960
    buffer_load_dwordx4 v[84:87], v14, s[8:11], s45 offen sc1
    s_add_u32 s45, s44, 49152
    buffer_load_dwordx4 v[88:91], v14, s[8:11], s45 offen sc1
    s_add_u32 s45, s44, 57344
    buffer_load_dwordx4 v[92:95], v14, s[8:11], s45 offen sc1
    s_add_u32 s45, s44, 65536
    buffer_load_dwordx4 v[96:99], v14, s[8:11], s45 offen sc1
    s_mov_b32 s45, 2621440
    buffer_load_dword v16, v15, s[24:27], s45 offen sc1
    buffer_load_dword v17, v15, s[24:27], 0 offen sc1
    s_sub_u32 s48, s48, 1
    s_cbranch_scc1 Ltail_goty
    s_waitcnt vmcnt(10)
    v_max3_u32 v26, v64, v65, v66
    s_waitcnt vmcnt(9)
    v_max3_u32 v26, v26, v67, v68
    v_max3_u32 v26, v26, v69, v70
    s_waitcnt vmcnt(8)
    v_max3_u32 v26, v26, v71, v72
    v_max3_u32 v26, v26, v73, v74
    s_waitcnt vmcnt(7)
    v_max3_u32 v26, v26, v75, v76
    v_max3_u32 v26, v26, v77, v78
    s_waitcnt vmcnt(6)
    v_max3_u32 v26, v26, v79, v80
    v_max3_u32 v26, v26, v81, v82
    s_waitcnt vmcnt(5)
    v_max3_u32 v26, v26, v83, v84
    v_max3_u32 v26, v26, v85, v86
    s_waitcnt vmcnt(4)
    v_max3_u32 v26, v26, v87, v88
    v_max3_u32 v26, v26, v89, v90
    s_waitcnt vmcnt(3)
    v_max3_u32 v26, v26, v91, v92
    v_max3_u32 v26, v26, v93, v94
    s_waitcnt vmcnt(2)
    v_max3_u32 v26, v26, v95, v96
    v_max3_u32 v26, v26, v97, v98
    v_max_u32 v26, v26, v99
    s_waitcnt vmcnt(0)
    v_max3_u32 v26, v26, v16, v17
    v_cmp_eq_u32 vcc, -1, v26
    s_cbranch_vccnz Ltail_polly
Ltail_goty:
    s_waitcnt vmcnt(0) lgkmcnt(0)
    v_lshlrev_b32 v20, 16, v16
    v_and_b32 v21, 0xffff0000, v16
    v_lshlrev_b32 v22, 16, v17
    v_and_b32 v23, 0xffff0000, v17
    v_pk_add_f32 v[64:65], v[64:65], v[68:69]
    v_pk_add_f32 v[66:67], v[66:67], v[70:71]
    v_pk_add_f32 v[64:65], v[64:65], v[72:73]
    v_pk_add_f32 v[66:67], v[66:67], v[74:75]
    v_pk_add_f32 v[64:65], v[64:65], v[76:77]
    v_pk_add_f32 v[66:67], v[66:67], v[78:79]
    v_pk_add_f32 v[64:65], v[64:65], v[80:81]
    v_pk_add_f32 v[66:67], v[66:67], v[82:83]
    v_pk_add_f32 v[64:65], v[64:65], v[84:85]
    v_pk_add_f32 v[66:67], v[66:67], v[86:87]
    v_pk_add_f32 v[64:65], v[64:65], v[88:89]
    v_pk_add_f32 v[66:67], v[66:67], v[90:91]
    v_pk_add_f32 v[64:65], v[64:65], v[92:93]
    v_pk_add_f32 v[66:67], v[66:67], v[94:95]
    v_pk_add_f32 v[64:65], v[64:65], v[96:97]
    v_pk_add_f32 v[66:67], v[66:67], v[98:99]
    s_nop 0
    v_add_f32_dpp v64, v64, v64 row_ror:4 row_mask:0xf bank_mask:0xf
    v_add_f32_dpp v65, v65, v65 row_ror:4 row_mask:0xf bank_mask:0xf
    v_add_f32_dpp v66, v66, v66 row_ror:4 row_mask:0xf bank_mask:0xf
    v_add_f32_dpp v67, v67, v67 row_ror:4 row_mask:0xf bank_mask:0xf
    v_add_f32_dpp v64, v64, v64 row_ror:8 row_mask:0xf bank_mask:0xf
    v_add_f32_dpp v65, v65, v65 row_ror:8 row_mask:0xf bank_mask:0xf
    v_add_f32_dpp v66, v66, v66 row_ror:8 row_mask:0xf bank_mask:0xf
    v_add_f32_dpp v67, v67, v67 row_ror:8 row_mask:0xf bank_mask:0xf
    v_mov_b32 v68, v64
    v_mov_b32 v69, v65
    v_mov_b32 v70, v66
    v_mov_b32 v71, v67
    v_permlane16_swap_b32 v64, v68
    v_permlane16_swap_b32 v65, v69
    v_permlane16_swap_b32 v66, v70
    v_permlane16_swap_b32 v67, v71
    v_add_f32 v64, v64, v68
    v_add_f32 v65, v65, v69
    v_add_f32 v66, v66, v70
    v_add_f32 v67, v67, v71
    v_mov_b32 v68, v64
    v_mov_b32 v69, v65
    v_mov_b32 v70, v66
    v_mov_b32 v71, v67
    v_permlane32_swap_b32 v64, v68
    v_permlane32_swap_b32 v65, v69
    v_permlane32_swap_b32 v66, v70
    v_permlane32_swap_b32 v67, v71
    v_add_f32 v64, v64, v68
    v_add_f32 v65, v65, v69
    v_add_f32 v66, v66, v70
    v_add_f32 v67, v67, v71
    v_cndmask_b32 v26, v64, v65, s[36:37]
    v_cndmask_b32 v27, v66, v67, s[36:37]
    v_cvt_pk_bf16_f32 v28, v26, v27
    v_lshlrev_b32 v26, 16, v28
    v_and_b32 v27, 0xffff0000, v28
    v_mul_f32 v26, v26, v19
    v_mul_f32 v27, v27, v19
    v_cvt_pk_bf16_f32 v28, v26, v27
    v_lshlrev_b32 v26, 16, v28
    v_and_b32 v27, 0xffff0000, v28
    v_pk_add_f32 v[26:27], v[26:27], v[22:23]
    v_cvt_pk_bf16_f32 v28, v26, v27
    v_lshlrev_b32 v26, 16, v28
    v_and_b32 v27, 0xffff0000, v28
    v_pk_mul_f32 v[26:27], v[26:27], v[24:25]
    v_cvt_pk_bf16_f32 v28, v26, v27
    v_lshlrev_b32 v26, 16, v28
    v_and_b32 v27, 0xffff0000, v28
    v_pk_add_f32 v[26:27], v[26:27], v[20:21]
    v_cvt_pk_bf16_f32 v28, v26, v27
    s_mov_b64 exec, 0xff
    buffer_store_dword v28, v13, s[16:19], 0 offen
Ltail_done:
    s_endpgm
Lattn_wb:
    buffer_wbl2 sc1
    s_waitcnt vmcnt(0)
    s_branch Lattn_wbdone
Lattn_xspin:
    s_mov_b32 s37, 16384
Lattn_xloop:
    buffer_load_dword v11, v8, s[24:27], s54 offen offset:8 sc1
    s_waitcnt vmcnt(0)
    v_readfirstlane_b32 s36, v11
    s_sub_u32 s37, s37, 1
    s_cbranch_scc1 Lattn_xgot
    s_cmp_lg_u32 s36, s95
    s_cbranch_scc1 Lattn_xloop
    s_branch Lattn_xgot
Ltail_spin1:
    s_mov_b32 s48, 16384
Ltail_spinl1:
    buffer_load_dword v11, v9, s[24:27], s39 offen sc1
    s_waitcnt vmcnt(0)
    v_cmp_ne_u32 s[54:55], s95, v11
    s_sub_u32 s48, s48, 1
    s_cbranch_scc1 Ltail_got1
    s_cmp_lg_u64 s[54:55], 0
    s_cbranch_scc1 Ltail_spinl1
    s_branch Ltail_got1
Ltail_spin2:
    s_mov_b32 s48, 16384
Ltail_spinl2:
    buffer_load_dword v11, v9, s[24:27], s39 offen sc1
    s_waitcnt vmcnt(0)
    v_cmp_ne_u32 s[54:55], s95, v11
    s_sub_u32 s48, s48, 1
    s_cbranch_scc1 Ltail_got2
    s_cmp_lg_u64 s[54:55], 0
    s_cbranch_scc1 Ltail_spinl2
    s_branch Ltail_got2
Lattn_redo:
    v_xor_b32 v8, 64, v9
    v_xor_b32 v10, 64, v11
    s_waitcnt vmcnt(0) lgkmcnt(0)
    s_barrier
    v_mov_b32 v232, 0xff800000
    v_mov_b32 v233, 0xff800000
    v_mov_b32 v234, 0xff800000
    v_mov_b32 v235, 0xff800000
    s_mov_b32 s40, 0
    s_mov_b32 s48, -1
Lattn_redo_loop:
    s_add_u32 m0, s42, 0
    s_nop 0
    buffer_load_dwordx4 v36, s[8:11], s40 offen lds
    buffer_load_dwordx4 v37, s[8:11], s40 offen offset:1024 lds
    buffer_load_dwordx4 v38, s[8:11], s40 offen offset:2048 lds
    buffer_load_dwordx4 v39, s[8:11], s40 offen offset:3072 lds
    s_add_u32 s40, s40, 16384
    s_waitcnt vmcnt(0) lgkmcnt(0)
    s_barrier
    ds_read_b128 a[208:211], v8 offset:0
    ds_read_b128 a[212:215], v9 offset:0
    ds_read_b128 a[216:219], v10 offset:0
    ds_read_b128 a[220:223], v11 offset:0
    s_waitcnt lgkmcnt(3)
    v_mfma_f32_16x16x32_bf16 v[216:219], a[208:211], v[64:67], 0
    s_waitcnt lgkmcnt(2)
    v_mfma_f32_16x16x32_bf16 v[216:219], a[212:215], v[68:71], v[216:219]
    s_waitcnt lgkmcnt(1)
    v_mfma_f32_16x16x32_bf16 v[216:219], a[216:219], v[72:75], v[216:219]
    s_waitcnt lgkmcnt(0)
    v_mfma_f32_16x16x32_bf16 v[216:219], a[220:223], v[76:79], v[216:219]
    v_mfma_f32_16x16x32_bf16 v[220:223], a[208:211], v[80:83], 0
    v_mfma_f32_16x16x32_bf16 v[220:223], a[212:215], v[84:87], v[220:223]
    v_mfma_f32_16x16x32_bf16 v[220:223], a[216:219], v[88:91], v[220:223]
    v_mfma_f32_16x16x32_bf16 v[220:223], a[220:223], v[92:95], v[220:223]
    v_mfma_f32_16x16x32_bf16 v[224:227], a[208:211], v[96:99], 0
    v_mfma_f32_16x16x32_bf16 v[224:227], a[212:215], v[100:103], v[224:227]
    v_mfma_f32_16x16x32_bf16 v[224:227], a[216:219], v[104:107], v[224:227]
    v_mfma_f32_16x16x32_bf16 v[224:227], a[220:223], v[108:111], v[224:227]
    v_mfma_f32_16x16x32_bf16 v[228:231], a[208:211], v[112:115], 0
    v_mfma_f32_16x16x32_bf16 v[228:231], a[212:215], v[116:119], v[228:231]
    v_mfma_f32_16x16x32_bf16 v[228:231], a[216:219], v[120:123], v[228:231]
    v_mfma_f32_16x16x32_bf16 v[228:231], a[220:223], v[124:127], v[228:231]
    v_max3_f32 v232, v232, v216, v217
    v_max3_f32 v232, v232, v218, v219
    v_max3_f32 v233, v233, v220, v221
    v_max3_f32 v233, v233, v222, v223
    v_max3_f32 v234, v234, v224, v225
    v_max3_f32 v234, v234, v226, v227
    s_nop 1
    v_max3_f32 v235, v235, v228, v229
    v_max3_f32 v235, v235, v230, v231
    ds_read_b128 a[224:227], v8 offset:4096
    ds_read_b128 a[228:231], v9 offset:4096
    ds_read_b128 a[232:235], v10 offset:4096
    ds_read_b128 a[236:239], v11 offset:4096
    s_waitcnt lgkmcnt(3)
    v_mfma_f32_16x16x32_bf16 v[216:219], a[224:227], v[64:67], 0
    s_waitcnt lgkmcnt(2)
    v_mfma_f32_16x16x32_bf16 v[216:219], a[228:231], v[68:71], v[216:219]
    s_waitcnt lgkmcnt(1)
    v_mfma_f32_16x16x32_bf16 v[216:219], a[232:235], v[72:75], v[216:219]
    s_waitcnt lgkmcnt(0)
    v_mfma_f32_16x16x32_bf16 v[216:219], a[236:239], v[76:79], v[216:219]
    v_mfma_f32_16x16x32_bf16 v[220:223], a[224:227], v[80:83], 0
    v_mfma_f32_16x16x32_bf16 v[220:223], a[228:231], v[84:87], v[220:223]
    v_mfma_f32_16x16x32_bf16 v[220:223], a[232:235], v[88:91], v[220:223]
    v_mfma_f32_16x16x32_bf16 v[220:223], a[236:239], v[92:95], v[220:223]
    v_mfma_f32_16x16x32_bf16 v[224:227], a[224:227], v[96:99], 0
    v_mfma_f32_16x16x32_bf16 v[224:227], a[228:231], v[100:103], v[224:227]
    v_mfma_f32_16x16x32_bf16 v[224:227], a[232:235], v[104:107], v[224:227]
    v_mfma_f32_16x16x32_bf16 v[224:227], a[236:239], v[108:111], v[224:227]
    v_mfma_f32_16x16x32_bf16 v[228:231], a[224:227], v[112:115], 0
    v_mfma_f32_16x16x32_bf16 v[228:231], a[228:231], v[116:119], v[228:231]
    v_mfma_f32_16x16x32_bf16 v[228:231], a[232:235], v[120:123], v[228:231]
    v_mfma_f32_16x16x32_bf16 v[228:231], a[236:239], v[124:127], v[228:231]
    v_max3_f32 v232, v232, v216, v217
    v_max3_f32 v232, v232, v218, v219
    v_max3_f32 v233, v233, v220, v221
    v_max3_f32 v233, v233, v222, v223
    v_max3_f32 v234, v234, v224, v225
    v_max3_f32 v234, v234, v226, v227
    s_nop 1
    v_max3_f32 v235, v235, v228, v229
    v_max3_f32 v235, v235, v230, v231
    ds_read_b128 a[208:211], v8 offset:8192
    ds_read_b128 a[212:215], v9 offset:8192
    ds_read_b128 a[216:219], v10 offset:8192
    ds_read_b128 a[220:223], v11 offset:8192
    s_waitcnt lgkmcnt(3)
    v_mfma_f32_16x16x32_bf16 v[216:219], a[208:211], v[64:67], 0
    s_waitcnt lgkmcnt(2)
    v_mfma_f32_16x16x32_bf16 v[216:219], a[212:215], v[68:71], v[216:219]
    s_waitcnt lgkmcnt(1)
    v_mfma_f32_16x16x32_bf16 v[216:219], a[216:219], v[72:75], v[216:219]
    s_waitcnt lgkmcnt(0)
    v_mfma_f32_16x16x32_bf16 v[216:219], a[220:223], v[76:79], v[216:219]
    v_mfma_f32_16x16x32_bf16 v[220:223], a[208:211], v[80:83], 0
    v_mfma_f32_16x16x32_bf16 v[220:223], a[212:215], v[84:87], v[220:223]
    v_mfma_f32_16x16x32_bf16 v[220:223], a[216:219], v[88:91], v[220:223]
    v_mfma_f32_16x16x32_bf16 v[220:223], a[220:223], v[92:95], v[220:223]
    v_mfma_f32_16x16x32_bf16 v[224:227], a[208:211], v[96:99], 0
    v_mfma_f32_16x16x32_bf16 v[224:227], a[212:215], v[100:103], v[224:227]
    v_mfma_f32_16x16x32_bf16 v[224:227], a[216:219], v[104:107], v[224:227]
    v_mfma_f32_16x16x32_bf16 v[224:227], a[220:223], v[108:111], v[224:227]
    v_mfma_f32_16x16x32_bf16 v[228:231], a[208:211], v[112:115], 0
    v_mfma_f32_16x16x32_bf16 v[228:231], a[212:215], v[116:119], v[228:231]
    v_mfma_f32_16x16x32_bf16 v[228:231], a[216:219], v[120:123], v[228:231]
    v_mfma_f32_16x16x32_bf16 v[228:231], a[220:223], v[124:127], v[228:231]
    v_max3_f32 v232, v232, v216, v217
    v_max3_f32 v232, v232, v218, v219
    v_max3_f32 v233, v233, v220, v221
    v_max3_f32 v233, v233, v222, v223
    v_max3_f32 v234, v234, v224, v225
    v_max3_f32 v234, v234, v226, v227
    s_nop 1
    v_max3_f32 v235, v235, v228, v229
    v_max3_f32 v235, v235, v230, v231
    ds_read_b128 a[224:227], v8 offset:12288
    ds_read_b128 a[228:231], v9 offset:12288
    ds_read_b128 a[232:235], v10 offset:12288
    ds_read_b128 a[236:239], v11 offset:12288
    s_waitcnt lgkmcnt(3)
    v_mfma_f32_16x16x32_bf16 v[216:219], a[224:227], v[64:67], 0
    s_waitcnt lgkmcnt(2)
    v_mfma_f32_16x16x32_bf16 v[216:219], a[228:231], v[68:71], v[216:219]
    s_waitcnt lgkmcnt(1)
    v_mfma_f32_16x16x32_bf16 v[216:219], a[232:235], v[72:75], v[216:219]
    s_waitcnt lgkmcnt(0)
    v_mfma_f32_16x16x32_bf16 v[216:219], a[236:239], v[76:79], v[216:219]
    v_mfma_f32_16x16x32_bf16 v[220:223], a[224:227], v[80:83], 0
    v_mfma_f32_16x16x32_bf16 v[220:223], a[228:231], v[84:87], v[220:223]
    v_mfma_f32_16x16x32_bf16 v[220:223], a[232:235], v[88:91], v[220:223]
    v_mfma_f32_16x16x32_bf16 v[220:223], a[236:239], v[92:95], v[220:223]
    v_mfma_f32_16x16x32_bf16 v[224:227], a[224:227], v[96:99], 0
    v_mfma_f32_16x16x32_bf16 v[224:227], a[228:231], v[100:103], v[224:227]
    v_mfma_f32_16x16x32_bf16 v[224:227], a[232:235], v[104:107], v[224:227]
    v_mfma_f32_16x16x32_bf16 v[224:227], a[236:239], v[108:111], v[224:227]
    v_mfma_f32_16x16x32_bf16 v[228:231], a[224:227], v[112:115], 0
    v_mfma_f32_16x16x32_bf16 v[228:231], a[228:231], v[116:119], v[228:231]
    v_mfma_f32_16x16x32_bf16 v[228:231], a[232:235], v[120:123], v[228:231]
    v_mfma_f32_16x16x32_bf16 v[228:231], a[236:239], v[124:127], v[228:231]
    v_max3_f32 v232, v232, v216, v217
    v_max3_f32 v232, v232, v218, v219
    v_max3_f32 v233, v233, v220, v221
    v_max3_f32 v233, v233, v222, v223
    v_max3_f32 v234, v234, v224, v225
    v_max3_f32 v234, v234, v226, v227
    s_nop 1
    v_max3_f32 v235, v235, v228, v229
    v_max3_f32 v235, v235, v230, v231
    s_barrier
    s_cmp_lt_u32 s40, 524288
    s_cbranch_scc1 Lattn_redo_loop
    v_mov_b32 v236, v232
    v_mov_b32 v237, v233
    v_mov_b32 v238, v234
    v_mov_b32 v239, v235
    v_permlane16_swap_b32 v232, v236
    v_permlane16_swap_b32 v233, v237
    v_permlane16_swap_b32 v234, v238
    v_permlane16_swap_b32 v235, v239
    v_max_f32 v232, v232, v236
    v_max_f32 v233, v233, v237
    v_max_f32 v234, v234, v238
    v_max_f32 v235, v235, v239
    v_mov_b32 v236, v232
    v_mov_b32 v237, v233
    v_mov_b32 v238, v234
    v_mov_b32 v239, v235
    v_permlane32_swap_b32 v232, v236
    v_permlane32_swap_b32 v233, v237
    v_permlane32_swap_b32 v234, v238
    v_permlane32_swap_b32 v235, v239
    v_max_f32 v232, v232, v236
    v_max_f32 v233, v233, v237
    v_max_f32 v234, v234, v238
    v_max_f32 v235, v235, v239
    v_sub_f32 v192, 0, v232
    v_sub_f32 v193, 0, v232
    v_sub_f32 v194, 0, v232
    v_sub_f32 v195, 0, v232
    v_sub_f32 v196, 0, v233
    v_sub_f32 v197, 0, v233
    v_sub_f32 v198, 0, v233
    v_sub_f32 v199, 0, v233
    v_sub_f32 v200, 0, v234
    v_sub_f32 v201, 0, v234
    v_sub_f32 v202, 0, v234
    v_sub_f32 v203, 0, v234
    v_sub_f32 v204, 0, v235
    v_sub_f32 v205, 0, v235
    v_sub_f32 v206, 0, v235
    v_sub_f32 v207, 0, v235
    s_mov_b32 s40, 0
    s_mov_b32 s41, 0
    s_add_u32 m0, s42, 0
    s_nop 0
    buffer_load_dwordx4 v36, s[8:11], s40 offen lds
    buffer_load_dwordx4 v37, s[8:11], s40 offen offset:1024 lds
    buffer_load_dwordx4 v38, s[8:11], s40 offen offset:2048 lds
    buffer_load_dwordx4 v39, s[8:11], s40 offen offset:3072 lds
    s_add_u32 s40, s40, 16384
    s_add_u32 m0, s42, 16384
    s_nop 0
    buffer_load_dwordx4 v36, s[8:11], s40 offen lds
    buffer_load_dwordx4 v37, s[8:11], s40 offen offset:1024 lds
    buffer_load_dwordx4 v38, s[8:11], s40 offen offset:2048 lds
    buffer_load_dwordx4 v39, s[8:11], s40 offen offset:3072 lds
    s_add_u32 s40, s40, 16384
    s_add_u32 m0, s42, 32768
    s_nop 0
    buffer_load_dwordx4 v36, s[8:11], s40 offen lds
    buffer_load_dwordx4 v37, s[8:11], s40 offen offset:1024 lds
    buffer_load_dwordx4 v38, s[8:11], s40 offen offset:2048 lds
    buffer_load_dwordx4 v39, s[8:11], s40 offen offset:3072 lds
    s_add_u32 s40, s40, 16384
    s_add_u32 m0, s42, 65536
    s_nop 0
    buffer_load_dwordx4 v40, s[12:15], s41 offen lds
    buffer_load_dwordx4 v41, s[12:15], s41 offen offset:1024 lds
    buffer_load_dwordx4 v40, s[12:15], s41 offen offset:2048 lds
    buffer_load_dwordx4 v41, s[12:15], s41 offen offset:3072 lds
    s_add_u32 s41, s41, 16384
    s_add_u32 m0, s42, 81920
    s_nop 0
    buffer_load_dwordx4 v40, s[12:15], s41 offen lds
    buffer_load_dwordx4 v41, s[12:15], s41 offen offset:1024 lds
    buffer_load_dwordx4 v40, s[12:15], s41 offen offset:2048 lds
    buffer_load_dwordx4 v41, s[12:15], s41 offen offset:3072 lds
    s_add_u32 s41, s41, 16384
    v_accvgpr_write_b32 a0, 0
    v_accvgpr_write_b32 a1, 0
    v_accvgpr_write_b32 a2, 0
    v_accvgpr_write_b32 a3, 0
    v_accvgpr_write_b32 a4, 0
    v_accvgpr_write_b32 a5, 0
    v_accvgpr_write_b32 a6, 0
    v_accvgpr_write_b32 a7, 0
    v_accvgpr_write_b32 a8, 0
    v_accvgpr_write_b32 a9, 0
    v_accvgpr_write_b32 a10, 0
    v_accvgpr_write_b32 a11, 0
    v_accvgpr_write_b32 a12, 0
    v_accvgpr_write_b32 a13, 0
    v_accvgpr_write_b32 a14, 0
    v_accvgpr_write_b32 a15, 0
    v_accvgpr_write_b32 a16, 0
    v_accvgpr_write_b32 a17, 0
    v_accvgpr_write_b32 a18, 0
    v_accvgpr_write_b32 a19, 0
    v_accvgpr_write_b32 a20, 0
    v_accvgpr_write_b32 a21, 0
    v_accvgpr_write_b32 a22, 0
    v_accvgpr_write_b32 a23, 0
    v_accvgpr_write_b32 a24, 0
    v_accvgpr_write_b32 a25, 0
    v_accvgpr_write_b32 a26, 0
    v_accvgpr_write_b32 a27, 0
    v_accvgpr_write_b32 a28, 0
    v_accvgpr_write_b32 a29, 0
    v_accvgpr_write_b32 a30, 0
    v_accvgpr_write_b32 a31, 0
    v_accvgpr_write_b32 a32, 0
    v_accvgpr_write_b32 a33, 0
    v_accvgpr_write_b32 a34, 0
    v_accvgpr_write_b32 a35, 0
    v_accvgpr_write_b32 a36, 0
    v_accvgpr_write_b32 a37, 0
    v_accvgpr_write_b32 a38, 0
    v_accvgpr_write_b32 a39, 0
    v_accvgpr_write_b32 a40, 0
    v_accvgpr_write_b32 a41, 0
    v_accvgpr_write_b32 a42, 0
    v_accvgpr_write_b32 a43, 0
    v_accvgpr_write_b32 a44, 0
    v_accvgpr_write_b32 a45, 0
    v_accvgpr_write_b32 a46, 0
    v_accvgpr_write_b32 a47, 0
    v_accvgpr_write_b32 a48, 0
    v_accvgpr_write_b32 a49, 0
    v_accvgpr_write_b32 a50, 0
    v_accvgpr_write_b32 a51, 0
    v_accvgpr_write_b32 a52, 0
    v_accvgpr_write_b32 a53, 0
    v_accvgpr_write_b32 a54, 0
    v_accvgpr_write_b32 a55, 0
    v_accvgpr_write_b32 a56, 0
    v_accvgpr_write_b32 a57, 0
    v_accvgpr_write_b32 a58, 0
    v_accvgpr_write_b32 a59, 0
    v_accvgpr_write_b32 a60, 0
    v_accvgpr_write_b32 a61, 0
    v_accvgpr_write_b32 a62, 0
    v_accvgpr_write_b32 a63, 0
    v_accvgpr_write_b32 a64, 0
    v_accvgpr_write_b32 a65, 0
    v_accvgpr_write_b32 a66, 0
    v_accvgpr_write_b32 a67, 0
    v_accvgpr_write_b32 a68, 0
    v_accvgpr_write_b32 a69, 0
    v_accvgpr_write_b32 a70, 0
    v_accvgpr_write_b32 a71, 0
    v_accvgpr_write_b32 a72, 0
    v_accvgpr_write_b32 a73, 0
    v_accvgpr_write_b32 a74, 0
    v_accvgpr_write_b32 a75, 0
    v_accvgpr_write_b32 a76, 0
    v_accvgpr_write_b32 a77, 0
    v_accvgpr_write_b32 a78, 0
    v_accvgpr_write_b32 a79, 0
    v_accvgpr_write_b32 a80, 0
    v_accvgpr_write_b32 a81, 0
    v_accvgpr_write_b32 a82, 0
    v_accvgpr_write_b32 a83, 0
    v_accvgpr_write_b32 a84, 0
    v_accvgpr_write_b32 a85, 0
    v_accvgpr_write_b32 a86, 0
    v_accvgpr_write_b32 a87, 0
    v_accvgpr_write_b32 a88, 0
    v_accvgpr_write_b32 a89, 0
    v_accvgpr_write_b32 a90, 0
    v_accvgpr_write_b32 a91, 0
    v_accvgpr_write_b32 a92, 0
    v_accvgpr_write_b32 a93, 0
    v_accvgpr_write_b32 a94, 0
    v_accvgpr_write_b32 a95, 0
    v_accvgpr_write_b32 a96, 0
    v_accvgpr_write_b32 a97, 0
    v_accvgpr_write_b32 a98, 0
    v_accvgpr_write_b32 a99, 0
    v_accvgpr_write_b32 a100, 0
    v_accvgpr_write_b32 a101, 0
    v_accvgpr_write_b32 a102, 0
    v_accvgpr_write_b32 a103, 0
    v_accvgpr_write_b32 a104, 0
    v_accvgpr_write_b32 a105, 0
    v_accvgpr_write_b32 a106, 0
    v_accvgpr_write_b32 a107, 0
    v_accvgpr_write_b32 a108, 0
    v_accvgpr_write_b32 a109, 0
    v_accvgpr_write_b32 a110, 0
    v_accvgpr_write_b32 a111, 0
    v_accvgpr_write_b32 a112, 0
    v_accvgpr_write_b32 a113, 0
    v_accvgpr_write_b32 a114, 0
    v_accvgpr_write_b32 a115, 0
    v_accvgpr_write_b32 a116, 0
    v_accvgpr_write_b32 a117, 0
    v_accvgpr_write_b32 a118, 0
    v_accvgpr_write_b32 a119, 0
    v_accvgpr_write_b32 a120, 0
    v_accvgpr_write_b32 a121, 0
    v_accvgpr_write_b32 a122, 0
    v_accvgpr_write_b32 a123, 0
    v_accvgpr_write_b32 a124, 0
    v_accvgpr_write_b32 a125, 0
    v_accvgpr_write_b32 a126, 0
    v_accvgpr_write_b32 a127, 0
    v_accvgpr_write_b32 a192, 0
    v_accvgpr_write_b32 a193, 0
    v_accvgpr_write_b32 a194, 0
    v_accvgpr_write_b32 a195, 0
    v_accvgpr_write_b32 a196, 0
    v_accvgpr_write_b32 a197, 0
    v_accvgpr_write_b32 a198, 0
    v_accvgpr_write_b32 a199, 0
    v_accvgpr_write_b32 a200, 0
    v_accvgpr_write_b32 a201, 0
    v_accvgpr_write_b32 a202, 0
    v_accvgpr_write_b32 a203, 0
    v_accvgpr_write_b32 a204, 0
    v_accvgpr_write_b32 a205, 0
    v_accvgpr_write_b32 a206, 0
    v_accvgpr_write_b32 a207, 0
    s_waitcnt vmcnt(0) lgkmcnt(0)
    s_barrier
    ds_read_b128 a[208:211], v8 offset:0
    ds_read_b128 a[212:215], v9 offset:0
    ds_read_b128 a[216:219], v10 offset:0
    ds_read_b128 a[220:223], v11 offset:0
    ds_read_b128 a[224:227], v8 offset:4096
    s_waitcnt vmcnt(0) lgkmcnt(0)
    s_branch Lattn_stage0
Lattn_armwait:
    s_mov_b32 s36, 16384
Lattn_armloop:
    v_mov_b32 v63, 0
    buffer_load_dword v63, v63, s[88:91], 0 offen sc1
    s_waitcnt vmcnt(0)
    v_readfirstlane_b32 s37, v63
    s_sub_u32 s36, s36, 1
    s_cbranch_scc1 Lattn_armed
    s_cmp_lt_u32 s37, 256
    s_cbranch_scc1 Lattn_armloop
    s_branch Lattn_armed
Lattn_end:
    s_endpgm
.section .rodata,"a"
.p2align 6
.amdhsa_kernel adaLN_cond__gqa_block_cached__moe_arch_mod__prompt_kernel
  .amdhsa_next_free_vgpr 512
  .amdhsa_next_free_sgpr 102
  .amdhsa_accum_offset 256
  .amdhsa_group_segment_fixed_size 0
  .amdhsa_kernarg_size 120
  .amdhsa_user_sgpr_count 2
  .amdhsa_user_sgpr_kernarg_segment_ptr 1
  .amdhsa_system_sgpr_workgroup_id_x 1
  .amdhsa_float_denorm_mode_32 3
.end_amdhsa_kernel
```

```asm
; @launch grid=(256,1,1) block=(256,1,1) lds=163840
.amdgcn_target "amdgcn-amd-amdhsa--gfx950"
.text
.globl adaLN_cond__gqa_block_cached__moe_arch_mod__prompt_kernel
.p2align 8
.type adaLN_cond__gqa_block_cached__moe_arch_mod__prompt_kernel,@function
adaLN_cond__gqa_block_cached__moe_arch_mod__prompt_kernel:
    s_cmp_ge_u32 s2, 256
    s_cbranch_scc1 Lattn_end
    s_load_dwordx2 s[8:9], s[0:1], 80
    s_load_dwordx2 s[12:13], s[0:1], 88
    s_load_dwordx2 s[20:21], s[0:1], 0
    s_load_dwordx2 s[50:51], s[0:1], 112
    s_load_dwordx8 s[52:59], s[0:1], 8
    s_load_dwordx4 s[80:83], s[0:1], 56
    s_load_dwordx2 s[84:85], s[0:1], 72
    s_load_dwordx2 s[88:89], s[0:1], 104
    s_getpc_b64 s[32:33]
Lattn_pc:
    s_mov_b32 s34, Lattn_end-Lattn_pc
    s_mov_b32 s35, 0x20000
    s_lshr_b32 s6, s2, 3
    s_lshl_b32 s7, s6, 6
    v_lshrrev_b32 v3, 6, v0
    v_and_b32 v1, 63, v0
    v_lshrrev_b32 v2, 2, v0
    v_lshlrev_b32 v2, 11, v2
    v_readfirstlane_b32 s3, v3
    buffer_load_dword v240, v2, s[32:35], s7 offen
    s_and_b32 s7, s2, 7
    s_lshl_b32 s4, s7, 1
    s_and_b32 s5, s6, 1
    s_add_u32 s4, s4, s5
    s_lshr_b32 s5, s2, 4
    s_lshr_b32 s38, s6, 2
    s_lshl_b32 s38, s38, 3
    s_add_u32 s38, s38, s7
    s_cmp_lt_u32 s38, 18
    s_cselect_b32 s39, 0, 2147483648
    s_lshl_b32 s38, s38, 2
    s_and_b32 s36, s6, 3
    s_add_u32 s38, s38, s36
    s_mov_b32 s14, 3981312
    s_mul_i32 s92, s6, 124416
    s_lshl_b32 s36, s7, 7
    s_add_u32 s92, s92, s36
    s_cmp_lt_u32 s7, 2
    s_cselect_b32 s36, 53, 35
    v_lshrrev_b32 v2, 2, v0
    v_min_u32 v2, s36, v2
    v_mul_u32_u24 v3, 57, v2
    v_lshrrev_b32 v3, 10, v3
    v_mul_i32_i24 v3, -123392, v3
    v_mul_u32_u24 v2, 6912, v2
    v_add_u32 v72, v2, v3
    s_mov_b32 s15, 0x20000
    s_mov_b32 s10, 1152
    s_mov_b32 s11, 0x20000
    s_mov_b32 s22, 2359296
    s_mov_b32 s23, 0x20000
    v_and_b32 v64, 0xfe, v0
    v_mul_u32_u24 v65, 3456, v64
    v_and_b32 v2, 1, v0
    v_lshl_add_u32 v65, v2, 4, v65
    s_lshl_b32 s36, s38, 5
    s_or_b32 s36, s36, s39
    v_and_b32 v4, 31, v1
    v_lshrrev_b32 v5, 5, v1
    v_cmp_gt_u32 vcc, 24, v4
    v_mov_b32 v6, 2147483648
    s_lshl_b32 s7, s5, 4
    s_add_u32 s7, s7, s4
    s_lshl_b32 s7, s7, 2
    s_add_u32 s7, s7, s3
    v_cndmask_b32 v6, v6, 0, vcc
    s_mul_i32 s49, s7, 2304
    v_lshrrev_b32 v7, 2, v4
    v_lshl_add_u32 v7, v7, 6, v6
    v_and_b32 v2, 3, v4
    v_lshl_add_u32 v7, v2, 3, v7
    v_mul_u32_u24 v2, 1152, v5
    v_add_u32 v66, v7, v2
    s_waitcnt lgkmcnt(0)
    s_load_dword s94, s[50:51], 24576
    buffer_load_dword v241, v72, s[12:15], s92 offen
    buffer_load_ushort v80, v64, s[8:11], 0 offen offset:0
    buffer_load_ushort v81, v64, s[8:11], 0 offen offset:256
    buffer_load_ushort v82, v64, s[8:11], 0 offen offset:512
    buffer_load_ushort v83, v64, s[8:11], 0 offen offset:768
    buffer_load_ushort v84, v64, s[8:11], 0 offen offset:1024
    buffer_load_dwordx4 v[88:91], v65, s[12:15], s36 offen
    s_add_u32 s36, s36, 884736
    buffer_load_dwordx4 v[92:95], v65, s[12:15], s36 offen
    s_add_u32 s36, s36, 884736
    buffer_load_dwordx4 v[96:99], v65, s[12:15], s36 offen
    s_add_u32 s36, s36, 884736
    buffer_load_dwordx4 v[100:103], v65, s[12:15], s36 offen
    s_add_u32 s36, s36, 884736
    buffer_load_dwordx4 v[104:107], v65, s[12:15], s36 offen
    s_mov_b32 s16, s56
    s_mov_b32 s17, s57
    s_mov_b32 s18, 4718592
    s_mov_b32 s19, 0x20000
    s_lshl_b32 s44, s4, 9
    s_mul_i32 s36, s5, 98304
    s_add_u32 s36, s36, 0
    v_lshrrev_b32 v2, 2, v0
    v_min_u32 v2, 47, v2
    v_lshrrev_b32 v3, 2, v2
    v_and_b32 v2, 3, v2
    v_lshl_add_u32 v2, v2, 7, s36
    v_lshl_add_u32 v71, v3, 13, v2
    s_mul_i32 s36, s5, 196608
    s_add_u32 s36, s36, 1572864
    v_lshrrev_b32 v2, 1, v0
    v_min_u32 v2, 95, v2
    v_lshrrev_b32 v3, 2, v2
    v_and_b32 v2, 3, v2
    v_lshl_add_u32 v2, v2, 7, s36
    v_lshl_add_u32 v70, v3, 13, v2
    s_add_u32 s92, s49, 65536
    v_lshl_add_u32 v7, v5, 4, v6
    v_lshl_add_u32 v67, v4, 5, v7
    v_min_u32 v4, 23, v4
    v_lshlrev_b32 v68, 4, v4
    s_mov_b32 s24, s50
    s_mov_b32 s25, s51
    s_mov_b32 s26, 10485760
    s_mov_b32 s27, 0x20000
    s_mov_b32 s90, 256
    s_mov_b32 s91, 0x20000
    s_cmp_ge_u32 s38, 36
    s_cselect_b32 s93, 1.0, 0
    s_lshl_b32 s36, s38, 7
    v_lshl_add_u32 v69, v0, 3, s36
    v_cmp_gt_u32 s[36:37], 8, v0
    v_mov_b32 v2, 2147483648
    v_mov_b32 v3, s39
    v_cndmask_b32 v2, v2, v3, s[36:37]
    v_or_b32 v69, v69, v2
    s_lshl_b32 s42, s3, 12
    v_lshrrev_b32 v2, 4, v1
    v_and_b32 v3, 15, v1
    v_lshrrev_b32 v5, 1, v3
    v_mul_u32_u24 v5, 2304, v5
    v_lshl_add_u32 v5, v2, 5, v5
    v_and_b32 v6, 1, v3
    v_lshl_add_u32 v51, v6, 4, v5
    s_lshl_b32 s6, s5, 2
    s_add_u32 s6, s6, s3
    s_mul_i32 s46, s6, 36864
    s_add_u32 s46, s46, 65536
    s_add_u32 s43, s46, 18432
    s_mul_i32 s45, s4, 294912
    s_lshl_b32 s7, s3, 4
    v_add_u32 v4, s7, v2
    v_lshlrev_b32 v5, 1, v2
    v_xor_b32 v5, v5, v3
    v_xor_b32 v6, 8, v5
    v_lshlrev_b32 v7, 13, v4
    v_lshl_add_u32 v42, v5, 4, v7
    v_lshl_add_u32 v43, v6, 4, v7
    v_add_u32 v44, 63488, v42
    v_add_u32 v45, 95232, v43
    v_add_u32 v43, 31744, v43
    s_lshl_b32 s7, s4, 19
    s_add_u32 s8, s52, s7
    s_addc_u32 s9, s53, 0
    s_mov_b32 s10, 524288
    s_mov_b32 s11, 0x20000
    s_add_u32 s12, s54, s7
    s_addc_u32 s13, s55, 0
    s_mov_b32 s14, 524288
    s_mov_b32 s15, 0x20000
    s_add_u32 s28, s50, 10485760
    s_addc_u32 s29, s51, 0
    s_mov_b32 s30, 37748736
    s_mov_b32 s31, 0x20000
    v_lshlrev_b32 v7, 8, v4
    v_lshl_add_u32 v40, v5, 4, v7
    v_lshl_add_u32 v41, v6, 4, v7
    v_xor_b32 v224, v3, v2
    v_lshl_add_u32 v36, v224, 4, v7
    v_xor_b32 v37, 64, v36
    v_xor_b32 v38, 128, v36
    v_xor_b32 v39, 192, v36
    v_lshrrev_b32 v7, 3, v5
    v_lshl_add_u32 v7, v7, 7, v4
    v_mul_u32_u24 v7, 1152, v7
    v_and_b32 v225, 7, v5
    v_lshl_add_u32 v46, v225, 4, v7
    v_lshrrev_b32 v7, 3, v6
    v_lshl_add_u32 v7, v7, 7, v4
    v_mul_u32_u24 v7, 1152, v7
    v_and_b32 v225, 7, v6
    v_lshl_add_u32 v47, v225, 4, v7
    v_add_u32 v48, 7168, v46
    v_add_u32 v49, 10752, v47
    v_add_u32 v47, 3584, v47
    v_lshlrev_b32 v7, 8, v3
    v_lshl_add_u32 v8, v224, 4, v7
    v_xor_b32 v9, 64, v8
    v_xor_b32 v10, 128, v8
    v_xor_b32 v11, 192, v8
    v_lshrrev_b32 v5, 2, v1
    v_and_b32 v6, 7, v5
    v_lshlrev_b32 v6, 5, v6
    v_lshl_add_u32 v6, v5, 8, v6
    v_and_b32 v7, 3, v1
    v_lshl_add_u32 v12, v7, 3, v6
    v_xor_b32 v13, 32, v12
    v_xor_b32 v14, 64, v12
    v_xor_b32 v15, 96, v12
    v_xor_b32 v16, 128, v12
    v_xor_b32 v17, 160, v12
    v_xor_b32 v18, 192, v12
    v_xor_b32 v19, 224, v12
    v_add_u32 v20, 65536, v12
    v_add_u32 v21, 65536, v13
    v_add_u32 v22, 65536, v14
    v_add_u32 v23, 65536, v15
    v_add_u32 v24, 65536, v16
    v_add_u32 v25, 65536, v17
    v_add_u32 v26, 65536, v18
    v_add_u32 v27, 65536, v19
    v_add_u32 v28, 131072, v12
    v_add_u32 v29, 131072, v13
    v_add_u32 v30, 131072, v14
    v_add_u32 v31, 131072, v15
    v_add_u32 v32, 131072, v16
    v_add_u32 v33, 131072, v17
    v_add_u32 v34, 131072, v18
    v_add_u32 v35, 131072, v19
    v_mov_b32 v52, 0x3f803f80
    v_mov_b32 v53, 0x3f803f80
    v_mov_b32 v54, 0x3f803f80
    v_mov_b32 v55, 0x3f803f80
    v_and_b32 v5, 1, v1
    v_mul_u32_u24 v5, 0xaaaa, v5
    v_add_u32 v5, 0x4444, v5
    v_lshl_add_u32 v50, v5, 16, v5
    v_lshrrev_b32 v5, 1, v3
    v_mul_u32_u24 v5, 20480, v5
    v_lshl_add_u32 v5, v2, 5, v5
    v_and_b32 v6, 1, v3
    v_lshl_add_u32 v56, v6, 4, v5
    s_mul_i32 s47, s6, 327680
    s_mov_b32 s32, s82
    s_mov_b32 s33, s83
    s_mov_b32 s34, 5308416
    s_mov_b32 s35, 0x20000
    s_mov_b32 s82, 5308416
    s_mov_b32 s83, 0x20000
    s_mov_b32 s86, 5308416
    s_mov_b32 s87, 0x20000
    s_lshr_b32 s7, s2, 3
    s_mul_i32 s7, s7, 18
    s_add_u32 s7, s7, s3
    s_and_b32 s36, s2, 7
    s_mul_i32 s37, s36, 576
    s_add_u32 s37, s37, s7
    s_mul_i32 s37, s37, 1152
    s_mul_i32 s7, s7, 9216
    s_mul_i32 s36, s36, 1152
    s_add_u32 s7, s7, s36
    v_min_u32 v5, 17, v1
    v_lshl_add_u32 v57, v5, 6, s7
    v_lshl_add_u32 v62, v5, 6, s37
    s_mov_b32 s40, 0
    s_mov_b32 s41, 0
    s_mov_b32 s48, 0
    s_waitcnt vmcnt(9)
    v_lshlrev_b32 v80, 16, v80
    s_waitcnt vmcnt(8)
    v_lshlrev_b32 v81, 16, v81
    s_waitcnt vmcnt(7)
    v_lshlrev_b32 v82, 16, v82
    s_waitcnt vmcnt(6)
    v_lshlrev_b32 v83, 16, v83
    s_waitcnt vmcnt(5)
    v_lshlrev_b32 v84, 16, v84
    v_mul_f32 v144, 0xbfb8aa3b, v80
    v_mul_f32 v148, 0xbfb8aa3b, v81
    v_mul_f32 v152, 0xbfb8aa3b, v82
    v_mul_f32 v156, 0xbfb8aa3b, v83
    v_mul_f32 v160, 0xbfb8aa3b, v84
    v_min_f32 v144, 0x42fc0000, v144
    v_min_f32 v148, 0x42fc0000, v148
    v_min_f32 v152, 0x42fc0000, v152
    v_min_f32 v156, 0x42fc0000, v156
    v_min_f32 v160, 0x42fc0000, v160
    v_exp_f32 v144, v144
    v_exp_f32 v148, v148
    v_exp_f32 v152, v152
    v_exp_f32 v156, v156
    v_exp_f32 v160, v160
    v_add_f32 v144, 1.0, v144
    v_add_f32 v148, 1.0, v148
    v_add_f32 v152, 1.0, v152
    v_add_f32 v156, 1.0, v156
    v_add_f32 v160, 1.0, v160
    v_rcp_f32 v145, v144
    v_rcp_f32 v149, v148
    v_rcp_f32 v153, v152
    v_rcp_f32 v157, v156
    v_rcp_f32 v161, v160
    v_mul_f32 v146, v80, v145
    v_mul_f32 v150, v81, v149
    v_mul_f32 v154, v82, v153
    v_mul_f32 v158, v83, v157
    v_mul_f32 v162, v84, v161
    v_fma_f32 v144, -v146, v144, v80
    v_fma_f32 v148, -v150, v148, v81
    v_fma_f32 v152, -v154, v152, v82
    v_fma_f32 v156, -v158, v156, v83
    v_fma_f32 v160, -v162, v160, v84
    v_fma_f32 v80, v144, v145, v146
    v_fma_f32 v81, v148, v149, v150
    v_fma_f32 v82, v152, v153, v154
    v_fma_f32 v83, v156, v157, v158
    v_fma_f32 v84, v160, v161, v162
    v_cvt_pk_bf16_f32 v80, v80, v80
    v_cvt_pk_bf16_f32 v81, v81, v81
    v_cvt_pk_bf16_f32 v82, v82, v82
    v_cvt_pk_bf16_f32 v83, v83, v83
    v_cvt_pk_bf16_f32 v84, v84, v84
    v_and_b32 v80, 0xffff0000, v80
    v_and_b32 v81, 0xffff0000, v81
    v_and_b32 v82, 0xffff0000, v82
    v_and_b32 v83, 0xffff0000, v83
    v_and_b32 v84, 0xffff0000, v84
    buffer_load_dwordx2 v[108:109], v66, s[20:23], s49 offen offset:0
    buffer_load_dwordx2 v[110:111], v66, s[20:23], s49 offen offset:32
    buffer_load_dwordx2 v[112:113], v66, s[20:23], s49 offen offset:384
    buffer_load_dwordx2 v[114:115], v66, s[20:23], s49 offen offset:416
    buffer_load_dwordx2 v[116:117], v66, s[20:23], s49 offen offset:768
    buffer_load_dwordx2 v[118:119], v66, s[20:23], s49 offen offset:800
    s_mov_b32 s20, s58
    s_mov_b32 s21, s59
    s_mov_b32 s22, 4718592
    s_mov_b32 s23, 0x20000
    buffer_load_dword v242, v71, s[16:19], s44 offen
    s_waitcnt vmcnt(11)
    v_lshlrev_b32 v136, 16, v88
    v_and_b32 v137, 0xffff0000, v88
    v_lshlrev_b32 v138, 16, v89
    v_and_b32 v139, 0xffff0000, v89
    v_lshlrev_b32 v140, 16, v90
    v_and_b32 v141, 0xffff0000, v90
    v_lshlrev_b32 v142, 16, v91
    v_and_b32 v143, 0xffff0000, v91
    v_pk_mul_f32 v[128:129], v[136:137], v[80:81] op_sel:[0,0] op_sel_hi:[1,0]
    v_pk_mul_f32 v[130:131], v[138:139], v[80:81] op_sel:[0,0] op_sel_hi:[1,0]
    v_pk_mul_f32 v[132:133], v[140:141], v[80:81] op_sel:[0,0] op_sel_hi:[1,0]
    v_pk_mul_f32 v[134:135], v[142:143], v[80:81] op_sel:[0,0] op_sel_hi:[1,0]
    s_waitcnt vmcnt(10)
    v_lshlrev_b32 v136, 16, v92
    v_and_b32 v137, 0xffff0000, v92
    v_lshlrev_b32 v138, 16, v93
    v_and_b32 v139, 0xffff0000, v93
    v_lshlrev_b32 v140, 16, v94
    v_and_b32 v141, 0xffff0000, v94
    v_lshlrev_b32 v142, 16, v95
    v_and_b32 v143, 0xffff0000, v95
    v_pk_fma_f32 v[128:129], v[136:137], v[80:81], v[128:129] op_sel:[0,1,0] op_sel_hi:[1,1,1]
    v_pk_fma_f32 v[130:131], v[138:139], v[80:81], v[130:131] op_sel:[0,1,0] op_sel_hi:[1,1,1]
    v_pk_fma_f32 v[132:133], v[140:141], v[80:81], v[132:133] op_sel:[0,1,0] op_sel_hi:[1,1,1]
    v_pk_fma_f32 v[134:135], v[142:143], v[80:81], v[134:135] op_sel:[0,1,0] op_sel_hi:[1,1,1]
    s_waitcnt vmcnt(9)
    v_lshlrev_b32 v136, 16, v96
    v_and_b32 v137, 0xffff0000, v96
    v_lshlrev_b32 v138, 16, v97
    v_and_b32 v139, 0xffff0000, v97
    v_lshlrev_b32 v140, 16, v98
    v_and_b32 v141, 0xffff0000, v98
    v_lshlrev_b32 v142, 16, v99
    v_and_b32 v143, 0xffff0000, v99
    v_pk_fma_f32 v[128:129], v[136:137], v[82:83], v[128:129] op_sel:[0,0,0] op_sel_hi:[1,0,1]
    v_pk_fma_f32 v[130:131], v[138:139], v[82:83], v[130:131] op_sel:[0,0,0] op_sel_hi:[1,0,1]
    v_pk_fma_f32 v[132:133], v[140:141], v[82:83], v[132:133] op_sel:[0,0,0] op_sel_hi:[1,0,1]
    v_pk_fma_f32 v[134:135], v[142:143], v[82:83], v[134:135] op_sel:[0,0,0] op_sel_hi:[1,0,1]
    s_waitcnt vmcnt(8)
    v_lshlrev_b32 v136, 16, v100
    v_and_b32 v137, 0xffff0000, v100
    v_lshlrev_b32 v138, 16, v101
    v_and_b32 v139, 0xffff0000, v101
    v_lshlrev_b32 v140, 16, v102
    v_and_b32 v141, 0xffff0000, v102
    v_lshlrev_b32 v142, 16, v103
    v_and_b32 v143, 0xffff0000, v103
    v_pk_fma_f32 v[128:129], v[136:137], v[82:83], v[128:129] op_sel:[0,1,0] op_sel_hi:[1,1,1]
    v_pk_fma_f32 v[130:131], v[138:139], v[82:83], v[130:131] op_sel:[0,1,0] op_sel_hi:[1,1,1]
    v_pk_fma_f32 v[132:133], v[140:141], v[82:83], v[132:133] op_sel:[0,1,0] op_sel_hi:[1,1,1]
    v_pk_fma_f32 v[134:135], v[142:143], v[82:83], v[134:135] op_sel:[0,1,0] op_sel_hi:[1,1,1]
    s_waitcnt vmcnt(7)
    v_lshlrev_b32 v136, 16, v104
    v_and_b32 v137, 0xffff0000, v104
    v_lshlrev_b32 v138, 16, v105
    v_and_b32 v139, 0xffff0000, v105
    v_lshlrev_b32 v140, 16, v106
    v_and_b32 v141, 0xffff0000, v106
    v_lshlrev_b32 v142, 16, v107
    v_and_b32 v143, 0xffff0000, v107
    v_pk_fma_f32 v[128:129], v[136:137], v[84:85], v[128:129] op_sel:[0,0,0] op_sel_hi:[1,0,1]
    v_pk_fma_f32 v[130:131], v[138:139], v[84:85], v[130:131] op_sel:[0,0,0] op_sel_hi:[1,0,1]
    v_pk_fma_f32 v[132:133], v[140:141], v[84:85], v[132:133] op_sel:[0,0,0] op_sel_hi:[1,0,1]
    v_pk_fma_f32 v[134:135], v[142:143], v[84:85], v[134:135] op_sel:[0,0,0] op_sel_hi:[1,0,1]
    s_nop 0
    v_permlane32_swap_b32 v128, v132
    v_permlane32_swap_b32 v129, v133
    v_permlane32_swap_b32 v130, v134
    v_permlane32_swap_b32 v131, v135
    v_and_b32 v72, 1, v1
    v_pk_add_f32 v[128:129], v[128:129], v[132:133]
    v_pk_add_f32 v[130:131], v[130:131], v[134:135]
    v_lshlrev_b32 v72, 5, v72
    v_lshrrev_b32 v73, 4, v1
    v_permlane16_swap_b32 v128, v130
    v_permlane16_swap_b32 v129, v131
    v_lshl_add_u32 v72, v73, 3, v72
    v_pk_add_f32 v[128:129], v[128:129], v[130:131]
    s_lshl_b32 s36, s3, 6
    v_add_u32 v72, s36, v72
    v_add_f32_dpp v128, v128, v128 row_ror:2 row_mask:0xf bank_mask:0xf
    v_add_f32_dpp v129, v129, v129 row_ror:2 row_mask:0xf bank_mask:0xf
    s_nop 0
    v_add_f32_dpp v128, v128, v128 row_ror:4 row_mask:0xf bank_mask:0xf
    v_add_f32_dpp v129, v129, v129 row_ror:4 row_mask:0xf bank_mask:0xf
    s_nop 0
    v_add_f32_dpp v128, v128, v128 row_ror:8 row_mask:0xf bank_mask:0xf
    v_add_f32_dpp v129, v129, v129 row_ror:8 row_mask:0xf bank_mask:0xf
    ds_write_b64 v72, v[128:129] offset:0
    v_and_b32 v73, 7, v1
    v_lshlrev_b32 v73, 3, v73
    s_waitcnt lgkmcnt(0)
    s_barrier
    ds_read_b64 v[128:129], v73 offset:0
    ds_read_b64 v[130:131], v73 offset:64
    ds_read_b64 v[132:133], v73 offset:128
    ds_read_b64 v[134:135], v73 offset:192
    s_add_u32 s95, s94, 0x9e3779b9
    v_mov_b32 v137, s95
    s_mov_b32 s37, 32768
    s_waitcnt lgkmcnt(2)
    v_pk_add_f32 v[128:129], v[128:129], v[130:131]
    s_waitcnt lgkmcnt(0)
    v_pk_add_f32 v[132:133], v[132:133], v[134:135]
    v_pk_add_f32 v[128:129], v[128:129], v[132:133]
    v_cvt_pk_bf16_f32 v136, v128, v129
    v_lshlrev_b32 v128, 16, v136
    v_and_b32 v129, 0xffff0000, v136
    v_add_f32 v128, s93, v128
    v_add_f32 v129, s93, v129
    v_cvt_pk_bf16_f32 v136, v128, v129
    buffer_store_dwordx2 v[136:137], v69, s[24:27], s37 offen sc1
    s_waitcnt vmcnt(7)
    v_lshlrev_b32 v144, 16, v108
    v_and_b32 v145, 0xffff0000, v108
    v_lshlrev_b32 v146, 16, v109
    v_and_b32 v147, 0xffff0000, v109
    s_waitcnt vmcnt(6)
    v_lshlrev_b32 v148, 16, v110
    v_and_b32 v149, 0xffff0000, v110
    v_lshlrev_b32 v150, 16, v111
    v_and_b32 v151, 0xffff0000, v111
    s_waitcnt vmcnt(5)
    v_lshlrev_b32 v152, 16, v112
    v_and_b32 v153, 0xffff0000, v112
    v_lshlrev_b32 v154, 16, v113
    v_and_b32 v155, 0xffff0000, v113
    s_waitcnt vmcnt(4)
    v_lshlrev_b32 v156, 16, v114
    v_and_b32 v157, 0xffff0000, v114
    v_lshlrev_b32 v158, 16, v115
    v_and_b32 v159, 0xffff0000, v115
    s_waitcnt vmcnt(3)
    v_lshlrev_b32 v160, 16, v116
    v_and_b32 v161, 0xffff0000, v116
    v_lshlrev_b32 v162, 16, v117
    v_and_b32 v163, 0xffff0000, v117
    s_waitcnt vmcnt(2)
    v_lshlrev_b32 v164, 16, v118
    v_and_b32 v165, 0xffff0000, v118
    v_lshlrev_b32 v166, 16, v119
    v_and_b32 v167, 0xffff0000, v119
    v_pk_add_f32 v[72:73], v[144:145], v[148:149]
    v_pk_add_f32 v[76:77], v[146:147], v[150:151]
    v_pk_add_f32 v[72:73], v[72:73], v[152:153]
    v_pk_add_f32 v[76:77], v[76:77], v[154:155]
    v_pk_add_f32 v[72:73], v[72:73], v[156:157]
    v_pk_add_f32 v[76:77], v[76:77], v[158:159]
    v_pk_add_f32 v[72:73], v[72:73], v[160:161]
    v_pk_add_f32 v[76:77], v[76:77], v[162:163]
    v_pk_add_f32 v[72:73], v[72:73], v[164:165]
    v_pk_add_f32 v[76:77], v[76:77], v[166:167]
    v_pk_add_f32 v[72:73], v[72:73], v[76:77]
    v_add_f32 v72, v72, v73
    s_nop 1
    v_add_f32_dpp v72, v72, v72 row_ror:1 row_mask:0xf bank_mask:0xf
    s_nop 1
    v_add_f32_dpp v72, v72, v72 row_ror:2 row_mask:0xf bank_mask:0xf
    s_nop 1
    v_add_f32_dpp v72, v72, v72 row_ror:4 row_mask:0xf bank_mask:0xf
    s_nop 1
    v_add_f32_dpp v72, v72, v72 row_ror:8 row_mask:0xf bank_mask:0xf
    v_mov_b32 v76, v72
    s_nop 1
    v_permlane16_swap_b32 v72, v76
    s_nop 0
    v_add_f32 v72, v72, v76
    v_mul_f32 v72, 0x3ae38e39, v72
    v_pk_add_f32 v[168:169], v[144:145], v[72:73] op_sel_hi:[1,0] neg_lo:[0,1] neg_hi:[0,1]
    v_pk_add_f32 v[170:171], v[146:147], v[72:73] op_sel_hi:[1,0] neg_lo:[0,1] neg_hi:[0,1]
    v_pk_add_f32 v[172:173], v[148:149], v[72:73] op_sel_hi:[1,0] neg_lo:[0,1] neg_hi:[0,1]
    v_pk_add_f32 v[174:175], v[150:151], v[72:73] op_sel_hi:[1,0] neg_lo:[0,1] neg_hi:[0,1]
    v_pk_add_f32 v[176:177], v[152:153], v[72:73] op_sel_hi:[1,0] neg_lo:[0,1] neg_hi:[0,1]
    v_pk_add_f32 v[178:179], v[154:155], v[72:73] op_sel_hi:[1,0] neg_lo:[0,1] neg_hi:[0,1]
    v_pk_add_f32 v[180:181], v[156:157], v[72:73] op_sel_hi:[1,0] neg_lo:[0,1] neg_hi:[0,1]
    v_pk_add_f32 v[182:183], v[158:159], v[72:73] op_sel_hi:[1,0] neg_lo:[0,1] neg_hi:[0,1]
    v_pk_add_f32 v[184:185], v[160:161], v[72:73] op_sel_hi:[1,0] neg_lo:[0,1] neg_hi:[0,1]
    v_pk_add_f32 v[186:187], v[162:163], v[72:73] op_sel_hi:[1,0] neg_lo:[0,1] neg_hi:[0,1]
    v_pk_add_f32 v[188:189], v[164:165], v[72:73] op_sel_hi:[1,0] neg_lo:[0,1] neg_hi:[0,1]
    v_pk_add_f32 v[190:191], v[166:167], v[72:73] op_sel_hi:[1,0] neg_lo:[0,1] neg_hi:[0,1]
    v_pk_mul_f32 v[74:75], v[168:169], v[168:169]
    v_pk_mul_f32 v[76:77], v[170:171], v[170:171]
    v_pk_fma_f32 v[74:75], v[172:173], v[172:173], v[74:75]
    v_pk_fma_f32 v[76:77], v[174:175], v[174:175], v[76:77]
    v_pk_fma_f32 v[74:75], v[176:177], v[176:177], v[74:75]
    v_pk_fma_f32 v[76:77], v[178:179], v[178:179], v[76:77]
    v_pk_fma_f32 v[74:75], v[180:181], v[180:181], v[74:75]
    v_pk_fma_f32 v[76:77], v[182:183], v[182:183], v[76:77]
    v_pk_fma_f32 v[74:75], v[184:185], v[184:185], v[74:75]
    v_pk_fma_f32 v[76:77], v[186:187], v[186:187], v[76:77]
    v_pk_fma_f32 v[74:75], v[188:189], v[188:189], v[74:75]
    v_pk_fma_f32 v[76:77], v[190:191], v[190:191], v[76:77]
    v_pk_add_f32 v[74:75], v[74:75], v[76:77]
    v_add_f32 v74, v74, v75
    v_cndmask_b32 v74, 0, v74, vcc
    s_nop 1
    v_add_f32_dpp v74, v74, v74 row_ror:1 row_mask:0xf bank_mask:0xf
    s_nop 1
    v_add_f32_dpp v74, v74, v74 row_ror:2 row_mask:0xf bank_mask:0xf
    s_nop 1
    v_add_f32_dpp v74, v74, v74 row_ror:4 row_mask:0xf bank_mask:0xf
    s_nop 1
    v_add_f32_dpp v74, v74, v74 row_ror:8 row_mask:0xf bank_mask:0xf
    v_mov_b32 v76, v74
    s_nop 1
    v_permlane16_swap_b32 v74, v76
    s_nop 0
    v_add_f32 v74, v74, v76
    v_mul_f32 v74, 0x3ae38e39, v74
    v_cvt_pk_bf16_f32 v76, v72, v74
    v_and_b32 v74, 0xffff0000, v76
    v_lshlrev_b32 v72, 16, v76
    v_add_f32 v74, 0x3727c5ac, v74
    v_cvt_pk_bf16_f32 v74, v74, v74
    v_and_b32 v74, 0xffff0000, v74
    v_sqrt_f32 v74, v74
    v_pk_add_f32 v[168:169], v[144:145], v[72:73] op_sel_hi:[1,0] neg_lo:[0,1] neg_hi:[0,1]
    v_pk_add_f32 v[170:171], v[146:147], v[72:73] op_sel_hi:[1,0] neg_lo:[0,1] neg_hi:[0,1]
    v_pk_add_f32 v[172:173], v[148:149], v[72:73] op_sel_hi:[1,0] neg_lo:[0,1] neg_hi:[0,1]
    v_pk_add_f32 v[174:175], v[150:151], v[72:73] op_sel_hi:[1,0] neg_lo:[0,1] neg_hi:[0,1]
    v_pk_add_f32 v[176:177], v[152:153], v[72:73] op_sel_hi:[1,0] neg_lo:[0,1] neg_hi:[0,1]
    v_pk_add_f32 v[178:179], v[154:155], v[72:73] op_sel_hi:[1,0] neg_lo:[0,1] neg_hi:[0,1]
    v_pk_add_f32 v[180:181], v[156:157], v[72:73] op_sel_hi:[1,0] neg_lo:[0,1] neg_hi:[0,1]
    v_pk_add_f32 v[182:183], v[158:159], v[72:73] op_sel_hi:[1,0] neg_lo:[0,1] neg_hi:[0,1]
    v_pk_add_f32 v[184:185], v[160:161], v[72:73] op_sel_hi:[1,0] neg_lo:[0,1] neg_hi:[0,1]
    v_pk_add_f32 v[186:187], v[162:163], v[72:73] op_sel_hi:[1,0] neg_lo:[0,1] neg_hi:[0,1]
    v_pk_add_f32 v[188:189], v[164:165], v[72:73] op_sel_hi:[1,0] neg_lo:[0,1] neg_hi:[0,1]
    v_pk_add_f32 v[190:191], v[166:167], v[72:73] op_sel_hi:[1,0] neg_lo:[0,1] neg_hi:[0,1]
    v_cvt_pk_bf16_f32 v74, v74, v74
    v_and_b32 v74, 0xffff0000, v74
    v_rcp_f32 v74, v74
    v_cvt_pk_bf16_f32 v108, v168, v169
    v_cvt_pk_bf16_f32 v109, v170, v171
    v_cvt_pk_bf16_f32 v110, v172, v173
    v_cvt_pk_bf16_f32 v111, v174, v175
    v_cvt_pk_bf16_f32 v112, v176, v177
    v_cvt_pk_bf16_f32 v113, v178, v179
    v_cvt_pk_bf16_f32 v114, v180, v181
    v_cvt_pk_bf16_f32 v115, v182, v183
    v_cvt_pk_bf16_f32 v116, v184, v185
    v_cvt_pk_bf16_f32 v117, v186, v187
    v_cvt_pk_bf16_f32 v118, v188, v189
    v_cvt_pk_bf16_f32 v119, v190, v191
    v_lshlrev_b32 v168, 16, v108
    v_and_b32 v169, 0xffff0000, v108
    v_lshlrev_b32 v170, 16, v109
    v_and_b32 v171, 0xffff0000, v109
    v_lshlrev_b32 v172, 16, v110
    v_and_b32 v173, 0xffff0000, v110
    v_lshlrev_b32 v174, 16, v111
    v_and_b32 v175, 0xffff0000, v111
    v_lshlrev_b32 v176, 16, v112
    v_and_b32 v177, 0xffff0000, v112
    v_lshlrev_b32 v178, 16, v113
    v_and_b32 v179, 0xffff0000, v113
    v_lshlrev_b32 v180, 16, v114
    v_and_b32 v181, 0xffff0000, v114
    v_lshlrev_b32 v182, 16, v115
    v_and_b32 v183, 0xffff0000, v115
    v_lshlrev_b32 v184, 16, v116
    v_and_b32 v185, 0xffff0000, v116
    v_lshlrev_b32 v186, 16, v117
    v_and_b32 v187, 0xffff0000, v117
    v_lshlrev_b32 v188, 16, v118
    v_and_b32 v189, 0xffff0000, v118
    v_lshlrev_b32 v190, 16, v119
    v_and_b32 v191, 0xffff0000, v119
    v_pk_mul_f32 v[168:169], v[168:169], v[74:75] op_sel_hi:[1,0]
    v_pk_mul_f32 v[170:171], v[170:171], v[74:75] op_sel_hi:[1,0]
    v_pk_mul_f32 v[172:173], v[172:173], v[74:75] op_sel_hi:[1,0]
    v_pk_mul_f32 v[174:175], v[174:175], v[74:75] op_sel_hi:[1,0]
    v_pk_mul_f32 v[176:177], v[176:177], v[74:75] op_sel_hi:[1,0]
    v_pk_mul_f32 v[178:179], v[178:179], v[74:75] op_sel_hi:[1,0]
    v_pk_mul_f32 v[180:181], v[180:181], v[74:75] op_sel_hi:[1,0]
    v_pk_mul_f32 v[182:183], v[182:183], v[74:75] op_sel_hi:[1,0]
    v_pk_mul_f32 v[184:185], v[184:185], v[74:75] op_sel_hi:[1,0]
    v_pk_mul_f32 v[186:187], v[186:187], v[74:75] op_sel_hi:[1,0]
    v_pk_mul_f32 v[188:189], v[188:189], v[74:75] op_sel_hi:[1,0]
    v_pk_mul_f32 v[190:191], v[190:191], v[74:75] op_sel_hi:[1,0]
    v_cvt_pk_bf16_f32 v108, v168, v169
    v_cvt_pk_bf16_f32 v109, v170, v171
    v_cvt_pk_bf16_f32 v110, v172, v173
    v_cvt_pk_bf16_f32 v111, v174, v175
    v_cvt_pk_bf16_f32 v112, v176, v177
    v_cvt_pk_bf16_f32 v113, v178, v179
    v_cvt_pk_bf16_f32 v114, v180, v181
    v_cvt_pk_bf16_f32 v115, v182, v183
    v_cvt_pk_bf16_f32 v116, v184, v185
    v_cvt_pk_bf16_f32 v117, v186, v187
    v_cvt_pk_bf16_f32 v118, v188, v189
    v_cvt_pk_bf16_f32 v119, v190, v191
    v_lshlrev_b32 v168, 16, v108
    v_and_b32 v169, 0xffff0000, v108
    v_lshlrev_b32 v170, 16, v109
    v_and_b32 v171, 0xffff0000, v109
    v_lshlrev_b32 v172, 16, v110
    v_and_b32 v173, 0xffff0000, v110
    v_lshlrev_b32 v174, 16, v111
    v_and_b32 v175, 0xffff0000, v111
    v_lshlrev_b32 v176, 16, v112
    v_and_b32 v177, 0xffff0000, v112
    v_lshlrev_b32 v178, 16, v113
    v_and_b32 v179, 0xffff0000, v113
    v_lshlrev_b32 v180, 16, v114
    v_and_b32 v181, 0xffff0000, v114
    v_lshlrev_b32 v182, 16, v115
    v_and_b32 v183, 0xffff0000, v115
    v_lshlrev_b32 v184, 16, v116
    v_and_b32 v185, 0xffff0000, v116
    v_lshlrev_b32 v186, 16, v117
    v_and_b32 v187, 0xffff0000, v117
    v_lshlrev_b32 v188, 16, v118
    v_and_b32 v189, 0xffff0000, v118
    v_lshlrev_b32 v190, 16, v119
    v_and_b32 v191, 0xffff0000, v119
    s_mul_i32 s36, s3, 72
    v_add_u32 v72, s36, v1
    v_and_b32 v73, 7, v1
    s_add_u32 s36, s36, 64
    v_add_u32 v73, s36, v73
    s_movk_i32 s36, 1024
    v_and_b32 v76, 3, v72
    v_lshlrev_b32 v76, 4, v76
    v_lshrrev_b32 v72, 2, v72
    v_lshl_add_u32 v74, v72, 7, v76
    v_and_b32 v77, 1, v72
    v_lshl_add_u32 v76, v77, 3, v76
    v_lshrrev_b32 v72, 1, v72
    v_lshl_add_u32 v72, v72, 6, v76
    v_add_u32 v72, s36, v72
    v_and_b32 v76, 3, v73
    v_lshlrev_b32 v76, 4, v76
    v_lshrrev_b32 v73, 2, v73
    v_lshl_add_u32 v75, v73, 7, v76
    v_and_b32 v77, 1, v73
    v_lshl_add_u32 v76, v77, 3, v76
    v_lshrrev_b32 v73, 1, v73
    v_lshl_add_u32 v73, v73, 6, v76
    v_add_u32 v73, s36, v73
    s_mov_b64 exec, 0
    s_cmp_eq_u32 s3, 0
    s_cbranch_scc1 Ltour0
    s_cmp_eq_u32 s3, 1
    s_cbranch_scc1 Ltour1
    s_cmp_eq_u32 s3, 2
    s_cbranch_scc1 Ltour2
    s_branch Ltour3
.p2align 12
Lmain:
    s_mov_b64 exec, -1
    s_mov_b32 s38, 16384
Lhead_pollm:
    buffer_load_dwordx4 v[88:91], v74, s[24:27], s37 offen sc1
    buffer_load_dwordx4 v[92:95], v75, s[24:27], s37 offen sc1
    s_sub_u32 s38, s38, 1
    s_cbranch_scc1 Lhead_gotm
    s_waitcnt vmcnt(0) lgkmcnt(0)
    v_xor_b32 v89, s95, v89
    v_xor_b32 v91, s95, v91
    v_xor_b32 v93, s95, v93
    v_xor_b32 v95, s95, v95
    v_or3_b32 v89, v89, v91, v93
    v_or_b32 v89, v89, v95
    v_cmp_ne_u32 vcc, 0, v89
    s_cbranch_vccnz Lhead_pollm
Lhead_gotm:
    s_waitcnt vmcnt(0) lgkmcnt(0)
    ds_write2_b32 v72, v88, v90 offset0:0 offset1:1
    ds_write2_b32 v73, v92, v94 offset0:0 offset1:1
    s_waitcnt lgkmcnt(0)
    s_barrier
    ds_read_b128 v[144:147], v68 offset:2176
    ds_read_b128 v[148:151], v68 offset:2560
    ds_read_b128 v[152:155], v68 offset:2944
    ds_read_b128 v[156:159], v68 offset:1024
    ds_read_b128 v[160:163], v68 offset:1408
    ds_read_b128 v[164:167], v68 offset:1792
    s_waitcnt lgkmcnt(5)
    v_lshlrev_b32 v192, 16, v144
    v_and_b32 v193, 0xffff0000, v144
    v_lshlrev_b32 v194, 16, v145
    v_and_b32 v195, 0xffff0000, v145
    v_lshlrev_b32 v196, 16, v146
    v_and_b32 v197, 0xffff0000, v146
    v_lshlrev_b32 v198, 16, v147
    v_and_b32 v199, 0xffff0000, v147
    s_waitcnt lgkmcnt(4)
    v_lshlrev_b32 v200, 16, v148
    v_and_b32 v201, 0xffff0000, v148
    v_lshlrev_b32 v202, 16, v149
    v_and_b32 v203, 0xffff0000, v149
    v_lshlrev_b32 v204, 16, v150
    v_and_b32 v205, 0xffff0000, v150
    v_lshlrev_b32 v206, 16, v151
    v_and_b32 v207, 0xffff0000, v151
    s_waitcnt lgkmcnt(3)
    v_lshlrev_b32 v208, 16, v152
    v_and_b32 v209, 0xffff0000, v152
    v_lshlrev_b32 v210, 16, v153
    v_and_b32 v211, 0xffff0000, v153
    v_lshlrev_b32 v212, 16, v154
    v_and_b32 v213, 0xffff0000, v154
    v_lshlrev_b32 v214, 16, v155
    v_and_b32 v215, 0xffff0000, v155
    v_pk_mul_f32 v[168:169], v[168:169], v[192:193]
    v_pk_mul_f32 v[170:171], v[170:171], v[194:195]
    v_pk_mul_f32 v[172:173], v[172:173], v[196:197]
    v_pk_mul_f32 v[174:175], v[174:175], v[198:199]
    v_pk_mul_f32 v[176:177], v[176:177], v[200:201]
    v_pk_mul_f32 v[178:179], v[178:179], v[202:203]
    v_pk_mul_f32 v[180:181], v[180:181], v[204:205]
    v_pk_mul_f32 v[182:183], v[182:183], v[206:207]
    v_pk_mul_f32 v[184:185], v[184:185], v[208:209]
    v_pk_mul_f32 v[186:187], v[186:187], v[210:211]
    v_pk_mul_f32 v[188:189], v[188:189], v[212:213]
    v_pk_mul_f32 v[190:191], v[190:191], v[214:215]
    v_cvt_pk_bf16_f32 v108, v168, v169
    v_cvt_pk_bf16_f32 v109, v170, v171
    v_cvt_pk_bf16_f32 v110, v172, v173
    v_cvt_pk_bf16_f32 v111, v174, v175
    v_cvt_pk_bf16_f32 v112, v176, v177
    v_cvt_pk_bf16_f32 v113, v178, v179
    v_cvt_pk_bf16_f32 v114, v180, v181
    v_cvt_pk_bf16_f32 v115, v182, v183
    v_cvt_pk_bf16_f32 v116, v184, v185
    v_cvt_pk_bf16_f32 v117, v186, v187
    v_cvt_pk_bf16_f32 v118, v188, v189
    v_cvt_pk_bf16_f32 v119, v190, v191
    s_waitcnt lgkmcnt(2)
    v_lshlrev_b32 v216, 16, v156
    v_and_b32 v217, 0xffff0000, v156
    v_lshlrev_b32 v218, 16, v157
    v_and_b32 v219, 0xffff0000, v157
    v_lshlrev_b32 v220, 16, v158
    v_and_b32 v221, 0xffff0000, v158
    v_lshlrev_b32 v222, 16, v159
    v_and_b32 v223, 0xffff0000, v159
    s_waitcnt lgkmcnt(1)
    v_lshlrev_b32 v224, 16, v160
    v_and_b32 v225, 0xffff0000, v160
    v_lshlrev_b32 v226, 16, v161
    v_and_b32 v227, 0xffff0000, v161
    v_lshlrev_b32 v228, 16, v162
    v_and_b32 v229, 0xffff0000, v162
    v_lshlrev_b32 v230, 16, v163
    v_and_b32 v231, 0xffff0000, v163
    s_waitcnt lgkmcnt(0)
    v_lshlrev_b32 v232, 16, v164
    v_and_b32 v233, 0xffff0000, v164
    v_lshlrev_b32 v234, 16, v165
    v_and_b32 v235, 0xffff0000, v165
    v_lshlrev_b32 v236, 16, v166
    v_and_b32 v237, 0xffff0000, v166
    v_lshlrev_b32 v238, 16, v167
    v_and_b32 v239, 0xffff0000, v167
    v_lshlrev_b32 v168, 16, v108
    v_and_b32 v169, 0xffff0000, v108
    v_lshlrev_b32 v170, 16, v109
    v_and_b32 v171, 0xffff0000, v109
    v_lshlrev_b32 v172, 16, v110
    v_and_b32 v173, 0xffff0000, v110
    v_lshlrev_b32 v174, 16, v111
    v_and_b32 v175, 0xffff0000, v111
    v_lshlrev_b32 v176, 16, v112
    v_and_b32 v177, 0xffff0000, v112
    v_lshlrev_b32 v178, 16, v113
    v_and_b32 v179, 0xffff0000, v113
    v_lshlrev_b32 v180, 16, v114
    v_and_b32 v181, 0xffff0000, v114
    v_lshlrev_b32 v182, 16, v115
    v_and_b32 v183, 0xffff0000, v115
    v_lshlrev_b32 v184, 16, v116
    v_and_b32 v185, 0xffff0000, v116
    v_lshlrev_b32 v186, 16, v117
    v_and_b32 v187, 0xffff0000, v117
    v_lshlrev_b32 v188, 16, v118
    v_and_b32 v189, 0xffff0000, v118
    v_lshlrev_b32 v190, 16, v119
    v_and_b32 v191, 0xffff0000, v119
    v_pk_add_f32 v[168:169], v[168:169], v[216:217]
    v_pk_add_f32 v[170:171], v[170:171], v[218:219]
    v_pk_add_f32 v[172:173], v[172:173], v[220:221]
    v_pk_add_f32 v[174:175], v[174:175], v[222:223]
    v_cvt_pk_bf16_f32 v108, v168, v169
    v_cvt_pk_bf16_f32 v109, v170, v171
    v_cvt_pk_bf16_f32 v110, v172, v173
    v_cvt_pk_bf16_f32 v111, v174, v175
    buffer_store_dwordx4 v[108:111], v67, s[24:27], s92 offen offset:0 sc1
    v_pk_add_f32 v[176:177], v[176:177], v[224:225]
    v_pk_add_f32 v[178:179], v[178:179], v[226:227]
    v_pk_add_f32 v[180:181], v[180:181], v[228:229]
    v_pk_add_f32 v[182:183], v[182:183], v[230:231]
    v_cvt_pk_bf16_f32 v112, v176, v177
    v_cvt_pk_bf16_f32 v113, v178, v179
    v_cvt_pk_bf16_f32 v114, v180, v181
    v_cvt_pk_bf16_f32 v115, v182, v183
    buffer_store_dwordx4 v[112:115], v67, s[24:27], s92 offen offset:768 sc1
    v_pk_add_f32 v[184:185], v[184:185], v[232:233]
    v_pk_add_f32 v[186:187], v[186:187], v[234:235]
    v_pk_add_f32 v[188:189], v[188:189], v[236:237]
    v_pk_add_f32 v[190:191], v[190:191], v[238:239]
    v_cvt_pk_bf16_f32 v116, v184, v185
    v_cvt_pk_bf16_f32 v117, v186, v187
    v_cvt_pk_bf16_f32 v118, v188, v189
    v_cvt_pk_bf16_f32 v119, v190, v191
    buffer_store_dwordx4 v[116:119], v67, s[24:27], s92 offen offset:1536 sc1
    s_lshl_b32 s36, s5, 13
    s_add_u32 s36, s36, 8650752
    s_lshl_b32 s37, s4, 9
    s_add_u32 s37, s37, s36
    s_lshl_b32 s38, s3, 7
    s_add_u32 s37, s37, s38
    s_lshl_b32 s38, s3, 11
    s_add_u32 s36, s36, s38
    v_min_u32 v72, 1, v1
    v_lshlrev_b32 v72, 31, v72
    v_and_b32 v73, 15, v1
    v_lshlrev_b32 v73, 7, v73
    v_cmp_gt_u32 vcc, 162, v0
    v_mov_b32 v88, -1
    v_mov_b32 v89, -1
    v_mov_b32 v90, -1
    v_mov_b32 v91, -1
    s_mul_i32 s39, s2, 2592
    s_add_u32 s39, s39, 7864320
    v_lshl_add_u32 v74, v0, 4, s39
    s_lshl_b32 s39, s2, 7
    s_add_u32 s39, s39, 8912896
    v_mov_b32 v75, s39
    v_cndmask_b32 v74, v75, v74, vcc
    s_mul_i32 s39, s5, 3072
    s_lshl_b32 s93, s5, 11
    v_lshrrev_b32 v69, 3, v0
    v_min_u32 v69, 23, v69
    v_lshlrev_b32 v69, 7, v69
    v_lshrrev_b32 v66, 4, v0
    v_lshlrev_b32 v66, 7, v66
    s_lshl_b32 s92, s5, 13
    s_add_u32 s92, s92, 8781824
    s_add_u32 s92, s92, s38
    s_lshl_b32 s38, s4, 7
    s_add_u32 s92, s92, s38
    s_getreg_b32 s38, hwreg(HW_REG_XCC_ID, 0, 4)
    s_add_u32 s38, s38, s95
    v_mov_b32 v76, s38
    v_mov_b32 v2, v80
    v_mov_b32 v3, v81
    v_mov_b32 v4, v82
    v_mov_b32 v5, v83
    v_mov_b32 v6, v84
    v_mov_b32 v7, v65
    s_waitcnt vmcnt(0)
    buffer_store_dword v137, v72, s[24:27], s37 offen sc1
    s_add_u32 s49, s44, 0
    s_add_u32 m0, s42, 32768
    s_nop 0
    buffer_load_dwordx4 v42, s[16:19], s49 offen lds
    buffer_load_dwordx4 v43, s[16:19], s49 offen offset:1024 lds
    buffer_load_dwordx4 v44, s[16:19], s49 offen offset:2048 lds
    buffer_load_dwordx4 v45, s[16:19], s49 offen offset:3072 lds
    s_add_u32 s49, s44, 256
    s_add_u32 m0, s42, 49152
    s_nop 0
    buffer_load_dwordx4 v42, s[16:19], s49 offen lds
    buffer_load_dwordx4 v43, s[16:19], s49 offen offset:1024 lds
    buffer_load_dwordx4 v44, s[16:19], s49 offen offset:2048 lds
    buffer_load_dwordx4 v45, s[16:19], s49 offen offset:3072 lds
    s_add_u32 s49, s44, 524288
    s_add_u32 m0, s42, 65536
    s_nop 0
    buffer_load_dwordx4 v42, s[16:19], s49 offen lds
    buffer_load_dwordx4 v43, s[16:19], s49 offen offset:1024 lds
    buffer_load_dwordx4 v44, s[16:19], s49 offen offset:2048 lds
    buffer_load_dwordx4 v45, s[16:19], s49 offen offset:3072 lds
    s_add_u32 s49, s44, 524544
    s_add_u32 m0, s42, 81920
    s_nop 0
    buffer_load_dwordx4 v42, s[16:19], s49 offen lds
    buffer_load_dwordx4 v43, s[16:19], s49 offen offset:1024 lds
    buffer_load_dwordx4 v44, s[16:19], s49 offen offset:2048 lds
    buffer_load_dwordx4 v45, s[16:19], s49 offen offset:3072 lds
    s_add_u32 s49, s44, 1048576
    s_add_u32 m0, s42, 98304
    s_nop 0
    buffer_load_dwordx4 v42, s[16:19], s49 offen lds
    buffer_load_dwordx4 v43, s[16:19], s49 offen offset:1024 lds
    buffer_load_dwordx4 v44, s[16:19], s49 offen offset:2048 lds
    buffer_load_dwordx4 v45, s[16:19], s49 offen offset:3072 lds
    s_add_u32 s49, s44, 1048832
    s_add_u32 m0, s42, 114688
    s_nop 0
    buffer_load_dwordx4 v42, s[16:19], s49 offen lds
    buffer_load_dwordx4 v43, s[16:19], s49 offen offset:1024 lds
    buffer_load_dwordx4 v44, s[16:19], s49 offen offset:2048 lds
    buffer_load_dwordx4 v45, s[16:19], s49 offen offset:3072 lds
    s_mov_b32 s38, 16384
Lhead_pollh:
    buffer_load_dword v75, v73, s[24:27], s36 offen sc1
    s_sub_u32 s38, s38, 1
    s_cbranch_scc1 Lhead_goth
    s_waitcnt vmcnt(0) lgkmcnt(0)
    v_cmp_ne_u32 vcc, s95, v75
    s_cbranch_vccnz Lhead_pollh
Lhead_goth:
    s_waitcnt vmcnt(0) lgkmcnt(0)
    buffer_load_dwordx4 a[0:3], v51, s[24:27], s46 offen offset:0 sc1
    buffer_load_dwordx4 a[8:11], v51, s[24:27], s46 offen offset:128 sc1
    buffer_load_dwordx4 a[4:7], v51, s[24:27], s43 offen offset:0 sc1
    buffer_load_dwordx4 a[12:15], v51, s[24:27], s43 offen offset:128 sc1
    s_barrier
    ds_read_b64_tr_b16 a[160:161], v12 offset:32768
    ds_read_b64_tr_b16 a[162:163], v12 offset:36864
    ds_read_b64_tr_b16 a[164:165], v12 offset:40960
    ds_read_b64_tr_b16 a[166:167], v12 offset:45056
    ds_read_b64_tr_b16 a[168:169], v13 offset:32768
    ds_read_b64_tr_b16 a[170:171], v13 offset:36864
    ds_read_b64_tr_b16 a[172:173], v13 offset:40960
    ds_read_b64_tr_b16 a[174:175], v13 offset:45056
    ds_read_b64_tr_b16 a[176:177], v14 offset:32768
    ds_read_b64_tr_b16 a[178:179], v14 offset:36864
    ds_read_b64_tr_b16 a[180:181], v14 offset:40960
    ds_read_b64_tr_b16 a[182:183], v14 offset:45056
    buffer_load_dwordx4 a[16:19], v51, s[24:27], s46 offen offset:256 sc1
    buffer_load_dwordx4 a[24:27], v51, s[24:27], s46 offen offset:384 sc1
    buffer_load_dwordx4 a[20:23], v51, s[24:27], s43 offen offset:256 sc1
    buffer_load_dwordx4 a[28:31], v51, s[24:27], s43 offen offset:384 sc1
    s_waitcnt lgkmcnt(10)
    s_waitcnt vmcnt(7)
    v_mfma_f32_16x16x32_bf16 v[128:131], a[160:163], a[0:3], 0
    s_waitcnt vmcnt(6)
    s_waitcnt lgkmcnt(8)
    ds_read_b64_tr_b16 a[184:185], v15 offset:32768
    v_mfma_f32_16x16x32_bf16 v[128:131], a[164:167], a[8:11], v[128:131]
    s_waitcnt vmcnt(5)
    ds_read_b64_tr_b16 a[186:187], v15 offset:36864
    v_mfma_f32_16x16x32_bf16 v[132:135], a[160:163], a[4:7], 0
    s_waitcnt vmcnt(4)
    ds_read_b64_tr_b16 a[188:189], v15 offset:40960
    v_mfma_f32_16x16x32_bf16 v[132:135], a[164:167], a[12:15], v[132:135]
    s_waitcnt lgkmcnt(9)
    buffer_load_dwordx4 a[32:35], v51, s[24:27], s46 offen offset:512 sc1
    v_mfma_f32_16x16x32_bf16 v[136:139], a[168:171], a[0:3], 0
    s_waitcnt lgkmcnt(7)
    ds_read_b64_tr_b16 a[190:191], v15 offset:45056
    ds_read_b64_tr_b16 a[160:161], v16 offset:32768
    v_mfma_f32_16x16x32_bf16 v[136:139], a[172:175], a[8:11], v[136:139]
    ds_read_b64_tr_b16 a[162:163], v16 offset:36864
    v_mfma_f32_16x16x32_bf16 v[140:143], a[168:171], a[4:7], 0
    ds_read_b64_tr_b16 a[164:165], v16 offset:40960
    v_mfma_f32_16x16x32_bf16 v[140:143], a[172:175], a[12:15], v[140:143]
    s_waitcnt lgkmcnt(9)
    buffer_load_dwordx4 a[40:43], v51, s[24:27], s46 offen offset:640 sc1
    v_mfma_f32_16x16x32_bf16 v[144:147], a[176:179], a[0:3], 0
    s_waitcnt lgkmcnt(7)
    ds_read_b64_tr_b16 a[166:167], v16 offset:45056
    ds_read_b64_tr_b16 a[168:169], v17 offset:32768
    v_mfma_f32_16x16x32_bf16 v[144:147], a[180:183], a[8:11], v[144:147]
    ds_read_b64_tr_b16 a[170:171], v17 offset:36864
    v_mfma_f32_16x16x32_bf16 v[148:151], a[176:179], a[4:7], 0
    ds_read_b64_tr_b16 a[172:173], v17 offset:40960
    v_mfma_f32_16x16x32_bf16 v[148:151], a[180:183], a[12:15], v[148:151]
    s_waitcnt lgkmcnt(9)
    buffer_load_dwordx4 a[36:39], v51, s[24:27], s43 offen offset:512 sc1
    v_mfma_f32_16x16x32_bf16 v[152:155], a[184:187], a[0:3], 0
    s_waitcnt lgkmcnt(7)
    ds_read_b64_tr_b16 a[174:175], v17 offset:45056
    ds_read_b64_tr_b16 a[176:177], v18 offset:32768
    v_mfma_f32_16x16x32_bf16 v[152:155], a[188:191], a[8:11], v[152:155]
    ds_read_b64_tr_b16 a[178:179], v18 offset:36864
    v_mfma_f32_16x16x32_bf16 v[156:159], a[184:187], a[4:7], 0
    ds_read_b64_tr_b16 a[180:181], v18 offset:40960
    v_mfma_f32_16x16x32_bf16 v[156:159], a[188:191], a[12:15], v[156:159]
    s_waitcnt lgkmcnt(9)
    buffer_load_dwordx4 a[44:47], v51, s[24:27], s43 offen offset:640 sc1
    v_mfma_f32_16x16x32_bf16 v[160:163], a[160:163], a[0:3], 0
    s_waitcnt lgkmcnt(7)
    ds_read_b64_tr_b16 a[182:183], v18 offset:45056
    ds_read_b64_tr_b16 a[184:185], v19 offset:32768
    v_mfma_f32_16x16x32_bf16 v[160:163], a[164:167], a[8:11], v[160:163]
    ds_read_b64_tr_b16 a[186:187], v19 offset:36864
    v_mfma_f32_16x16x32_bf16 v[164:167], a[160:163], a[4:7], 0
    ds_read_b64_tr_b16 a[188:189], v19 offset:40960
    v_mfma_f32_16x16x32_bf16 v[164:167], a[164:167], a[12:15], v[164:167]
    s_waitcnt lgkmcnt(9)
    buffer_load_dword v77, v70, s[16:19], s44 offen
    v_mfma_f32_16x16x32_bf16 v[168:171], a[168:171], a[0:3], 0
    s_waitcnt lgkmcnt(7)
    ds_read_b64_tr_b16 a[190:191], v19 offset:45056
    ds_read_b64_tr_b16 a[160:161], v12 offset:49152
    v_mfma_f32_16x16x32_bf16 v[168:171], a[172:175], a[8:11], v[168:171]
    ds_read_b64_tr_b16 a[162:163], v12 offset:53248
    v_mfma_f32_16x16x32_bf16 v[172:175], a[168:171], a[4:7], 0
    ds_read_b64_tr_b16 a[164:165], v12 offset:57344
    v_mfma_f32_16x16x32_bf16 v[172:175], a[172:175], a[12:15], v[172:175]
    s_waitcnt lgkmcnt(9)
    buffer_load_dword v78, v69, s[8:11], s39 offen
    v_mfma_f32_16x16x32_bf16 v[176:179], a[176:179], a[0:3], 0
    s_waitcnt lgkmcnt(7)
    ds_read_b64_tr_b16 a[166:167], v12 offset:61440
    ds_read_b64_tr_b16 a[168:169], v13 offset:49152
    v_mfma_f32_16x16x32_bf16 v[176:179], a[180:183], a[8:11], v[176:179]
    ds_read_b64_tr_b16 a[170:171], v13 offset:53248
    v_mfma_f32_16x16x32_bf16 v[180:183], a[176:179], a[4:7], 0
    ds_read_b64_tr_b16 a[172:173], v13 offset:57344
    v_mfma_f32_16x16x32_bf16 v[180:183], a[180:183], a[12:15], v[180:183]
    s_waitcnt lgkmcnt(9)
    buffer_load_dword v79, v66, s[12:15], s93 offen
    v_mfma_f32_16x16x32_bf16 v[184:187], a[184:187], a[0:3], 0
    s_waitcnt lgkmcnt(7)
    ds_read_b64_tr_b16 a[174:175], v13 offset:61440
    ds_read_b64_tr_b16 a[176:177], v14 offset:49152
    v_mfma_f32_16x16x32_bf16 v[184:187], a[188:191], a[8:11], v[184:187]
    ds_read_b64_tr_b16 a[178:179], v14 offset:53248
    v_mfma_f32_16x16x32_bf16 v[188:191], a[184:187], a[4:7], 0
    ds_read_b64_tr_b16 a[180:181], v14 offset:57344
    v_mfma_f32_16x16x32_bf16 v[188:191], a[188:191], a[12:15], v[188:191]
    s_waitcnt lgkmcnt(9)
    ds_read_b64_tr_b16 a[182:183], v14 offset:61440
    v_mfma_f32_16x16x32_bf16 v[192:195], a[160:163], a[0:3], 0
    s_waitcnt lgkmcnt(8)
    ds_read_b64_tr_b16 a[184:185], v15 offset:49152
    v_mfma_f32_16x16x32_bf16 v[192:195], a[164:167], a[8:11], v[192:195]
    ds_read_b64_tr_b16 a[186:187], v15 offset:53248
    v_mfma_f32_16x16x32_bf16 v[196:199], a[160:163], a[4:7], 0
    ds_read_b64_tr_b16 a[188:189], v15 offset:57344
    v_mfma_f32_16x16x32_bf16 v[196:199], a[164:167], a[12:15], v[196:199]
    s_waitcnt lgkmcnt(9)
    ds_read_b64_tr_b16 a[190:191], v15 offset:61440
    v_mfma_f32_16x16x32_bf16 v[200:203], a[168:171], a[0:3], 0
    s_waitcnt lgkmcnt(8)
    ds_read_b64_tr_b16 a[160:161], v16 offset:49152
    v_mfma_f32_16x16x32_bf16 v[200:203], a[172:175], a[8:11], v[200:203]
    ds_read_b64_tr_b16 a[162:163], v16 offset:53248
    v_mfma_f32_16x16x32_bf16 v[204:207], a[168:171], a[4:7], 0
    ds_read_b64_tr_b16 a[164:165], v16 offset:57344
    v_mfma_f32_16x16x32_bf16 v[204:207], a[172:175], a[12:15], v[204:207]
    s_waitcnt lgkmcnt(9)
    ds_read_b64_tr_b16 a[166:167], v16 offset:61440
    v_mfma_f32_16x16x32_bf16 v[208:211], a[176:179], a[0:3], 0
    s_waitcnt lgkmcnt(8)
    ds_read_b64_tr_b16 a[168:169], v17 offset:49152
    v_mfma_f32_16x16x32_bf16 v[208:211], a[180:183], a[8:11], v[208:211]
    ds_read_b64_tr_b16 a[170:171], v17 offset:53248
    v_mfma_f32_16x16x32_bf16 v[212:215], a[176:179], a[4:7], 0
    ds_read_b64_tr_b16 a[172:173], v17 offset:57344
    v_mfma_f32_16x16x32_bf16 v[212:215], a[180:183], a[12:15], v[212:215]
    s_waitcnt lgkmcnt(9)
    ds_read_b64_tr_b16 a[174:175], v17 offset:61440
    v_mfma_f32_16x16x32_bf16 v[216:219], a[184:187], a[0:3], 0
    s_waitcnt lgkmcnt(8)
    ds_read_b64_tr_b16 a[176:177], v18 offset:49152
    v_mfma_f32_16x16x32_bf16 v[216:219], a[188:191], a[8:11], v[216:219]
    ds_read_b64_tr_b16 a[178:179], v18 offset:53248
    v_mfma_f32_16x16x32_bf16 v[220:223], a[184:187], a[4:7], 0
    ds_read_b64_tr_b16 a[180:181], v18 offset:57344
    v_mfma_f32_16x16x32_bf16 v[220:223], a[188:191], a[12:15], v[220:223]
    s_waitcnt lgkmcnt(9)
    ds_read_b64_tr_b16 a[182:183], v18 offset:61440
    v_mfma_f32_16x16x32_bf16 v[224:227], a[160:163], a[0:3], 0
    s_waitcnt lgkmcnt(8)
    ds_read_b64_tr_b16 a[184:185], v19 offset:49152
    v_mfma_f32_16x16x32_bf16 v[224:227], a[164:167], a[8:11], v[224:227]
    ds_read_b64_tr_b16 a[186:187], v19 offset:53248
    v_mfma_f32_16x16x32_bf16 v[228:231], a[160:163], a[4:7], 0
    ds_read_b64_tr_b16 a[188:189], v19 offset:57344
    v_mfma_f32_16x16x32_bf16 v[228:231], a[164:167], a[12:15], v[228:231]
    s_waitcnt lgkmcnt(9)
    ds_read_b64_tr_b16 a[190:191], v19 offset:61440
    s_barrier
    v_mfma_f32_16x16x32_bf16 v[232:235], a[168:171], a[0:3], 0
    s_waitcnt lgkmcnt(8)
    ds_read_b64_tr_b16 a[160:161], v20 offset:0
    v_mfma_f32_16x16x32_bf16 v[232:235], a[172:175], a[8:11], v[232:235]
    ds_read_b64_tr_b16 a[162:163], v20 offset:4096
    v_mfma_f32_16x16x32_bf16 v[236:239], a[168:171], a[4:7], 0
    ds_read_b64_tr_b16 a[164:165], v20 offset:8192
    v_mfma_f32_16x16x32_bf16 v[236:239], a[172:175], a[12:15], v[236:239]
    s_waitcnt lgkmcnt(9)
    buffer_load_dwordx4 a[48:51], v51, s[24:27], s46 offen offset:768 sc1
    v_mfma_f32_16x16x32_bf16 v[240:243], a[176:179], a[0:3], 0
    s_waitcnt lgkmcnt(7)
    ds_read_b64_tr_b16 a[166:167], v20 offset:12288
    ds_read_b64_tr_b16 a[168:169], v21 offset:0
    v_mfma_f32_16x16x32_bf16 v[240:243], a[180:183], a[8:11], v[240:243]
    ds_read_b64_tr_b16 a[170:171], v21 offset:4096
    v_mfma_f32_16x16x32_bf16 v[244:247], a[176:179], a[4:7], 0
    ds_read_b64_tr_b16 a[172:173], v21 offset:8192
    v_mfma_f32_16x16x32_bf16 v[244:247], a[180:183], a[12:15], v[244:247]
    s_waitcnt lgkmcnt(9)
    buffer_load_dwordx4 a[56:59], v51, s[24:27], s46 offen offset:896 sc1
    v_mfma_f32_16x16x32_bf16 v[248:251], a[184:187], a[0:3], 0
    s_waitcnt lgkmcnt(7)
    ds_read_b64_tr_b16 a[174:175], v21 offset:12288
    ds_read_b64_tr_b16 a[176:177], v22 offset:0
    v_mfma_f32_16x16x32_bf16 v[248:251], a[188:191], a[8:11], v[248:251]
    ds_read_b64_tr_b16 a[178:179], v22 offset:4096
    v_mfma_f32_16x16x32_bf16 v[252:255], a[184:187], a[4:7], 0
    ds_read_b64_tr_b16 a[180:181], v22 offset:8192
    v_mfma_f32_16x16x32_bf16 v[252:255], a[188:191], a[12:15], v[252:255]
    s_waitcnt vmcnt(12)
    s_waitcnt lgkmcnt(9)
    buffer_load_dwordx4 a[52:55], v51, s[24:27], s43 offen offset:768 sc1
    v_mfma_f32_16x16x32_bf16 v[128:131], a[160:163], a[16:19], v[128:131]
    s_waitcnt vmcnt(12)
    s_waitcnt lgkmcnt(7)
    ds_read_b64_tr_b16 a[182:183], v22 offset:12288
    ds_read_b64_tr_b16 a[184:185], v23 offset:0
    v_mfma_f32_16x16x32_bf16 v[128:131], a[164:167], a[24:27], v[128:131]
    s_waitcnt vmcnt(11)
    ds_read_b64_tr_b16 a[186:187], v23 offset:4096
    v_mfma_f32_16x16x32_bf16 v[132:135], a[160:163], a[20:23], v[132:135]
    s_waitcnt vmcnt(10)
    ds_read_b64_tr_b16 a[188:189], v23 offset:8192
    v_mfma_f32_16x16x32_bf16 v[132:135], a[164:167], a[28:31], v[132:135]
    s_waitcnt lgkmcnt(9)
    buffer_load_dwordx4 a[60:63], v51, s[24:27], s43 offen offset:896 sc1
    v_mfma_f32_16x16x32_bf16 v[136:139], a[168:171], a[16:19], v[136:139]
    s_waitcnt lgkmcnt(7)
    ds_read_b64_tr_b16 a[190:191], v23 offset:12288
    ds_read_b64_tr_b16 a[160:161], v24 offset:0
    v_mfma_f32_16x16x32_bf16 v[136:139], a[172:175], a[24:27], v[136:139]
    s_add_u32 s49, s44, 1572864
    ds_read_b64_tr_b16 a[162:163], v24 offset:4096
    v_mfma_f32_16x16x32_bf16 v[140:143], a[168:171], a[20:23], v[140:143]
    s_add_u32 m0, s42, 131072
    ds_read_b64_tr_b16 a[164:165], v24 offset:8192
    v_mfma_f32_16x16x32_bf16 v[140:143], a[172:175], a[28:31], v[140:143]
    s_waitcnt lgkmcnt(9)
    buffer_load_dwordx4 v42, s[16:19], s49 offen lds
    v_mfma_f32_16x16x32_bf16 v[144:147], a[176:179], a[16:19], v[144:147]
    s_waitcnt lgkmcnt(7)
    ds_read_b64_tr_b16 a[166:167], v24 offset:12288
    ds_read_b64_tr_b16 a[168:169], v25 offset:0
    v_mfma_f32_16x16x32_bf16 v[144:147], a[180:183], a[24:27], v[144:147]
    ds_read_b64_tr_b16 a[170:171], v25 offset:4096
    v_mfma_f32_16x16x32_bf16 v[148:151], a[176:179], a[20:23], v[148:151]
    ds_read_b64_tr_b16 a[172:173], v25 offset:8192
    v_mfma_f32_16x16x32_bf16 v[148:151], a[180:183], a[28:31], v[148:151]
    s_waitcnt lgkmcnt(9)
    buffer_load_dwordx4 v43, s[16:19], s49 offen offset:1024 lds
    v_mfma_f32_16x16x32_bf16 v[152:155], a[184:187], a[16:19], v[152:155]
    s_waitcnt lgkmcnt(7)
    ds_read_b64_tr_b16 a[174:175], v25 offset:12288
    ds_read_b64_tr_b16 a[176:177], v26 offset:0
    v_mfma_f32_16x16x32_bf16 v[152:155], a[188:191], a[24:27], v[152:155]
    ds_read_b64_tr_b16 a[178:179], v26 offset:4096
    v_mfma_f32_16x16x32_bf16 v[156:159], a[184:187], a[20:23], v[156:159]
    ds_read_b64_tr_b16 a[180:181], v26 offset:8192
    v_mfma_f32_16x16x32_bf16 v[156:159], a[188:191], a[28:31], v[156:159]
    s_waitcnt lgkmcnt(9)
    buffer_load_dwordx4 v44, s[16:19], s49 offen offset:2048 lds
    v_mfma_f32_16x16x32_bf16 v[160:163], a[160:163], a[16:19], v[160:163]
    s_waitcnt lgkmcnt(7)
    ds_read_b64_tr_b16 a[182:183], v26 offset:12288
    ds_read_b64_tr_b16 a[184:185], v27 offset:0
    v_mfma_f32_16x16x32_bf16 v[160:163], a[164:167], a[24:27], v[160:163]
    ds_read_b64_tr_b16 a[186:187], v27 offset:4096
    v_mfma_f32_16x16x32_bf16 v[164:167], a[160:163], a[20:23], v[164:167]
    ds_read_b64_tr_b16 a[188:189], v27 offset:8192
    v_mfma_f32_16x16x32_bf16 v[164:167], a[164:167], a[28:31], v[164:167]
    s_waitcnt lgkmcnt(9)
    buffer_load_dwordx4 v45, s[16:19], s49 offen offset:3072 lds
    v_mfma_f32_16x16x32_bf16 v[168:171], a[168:171], a[16:19], v[168:171]
    s_waitcnt lgkmcnt(7)
    ds_read_b64_tr_b16 a[190:191], v27 offset:12288
    ds_read_b64_tr_b16 a[160:161], v20 offset:16384
    v_mfma_f32_16x16x32_bf16 v[168:171], a[172:175], a[24:27], v[168:171]
    s_add_u32 s49, s44, 1573120
    ds_read_b64_tr_b16 a[162:163], v20 offset:20480
    v_mfma_f32_16x16x32_bf16 v[172:175], a[168:171], a[20:23], v[172:175]
    s_add_u32 m0, s42, 147456
    ds_read_b64_tr_b16 a[164:165], v20 offset:24576
    v_mfma_f32_16x16x32_bf16 v[172:175], a[172:175], a[28:31], v[172:175]
    s_waitcnt lgkmcnt(9)
    buffer_load_dwordx4 v42, s[16:19], s49 offen lds
    v_mfma_f32_16x16x32_bf16 v[176:179], a[176:179], a[16:19], v[176:179]
    s_waitcnt lgkmcnt(7)
    ds_read_b64_tr_b16 a[166:167], v20 offset:28672
    ds_read_b64_tr_b16 a[168:169], v21 offset:16384
    v_mfma_f32_16x16x32_bf16 v[176:179], a[180:183], a[24:27], v[176:179]
    ds_read_b64_tr_b16 a[170:171], v21 offset:20480
    v_mfma_f32_16x16x32_bf16 v[180:183], a[176:179], a[20:23], v[180:183]
    ds_read_b64_tr_b16 a[172:173], v21 offset:24576
    v_mfma_f32_16x16x32_bf16 v[180:183], a[180:183], a[28:31], v[180:183]
    s_waitcnt lgkmcnt(9)
    buffer_load_dwordx4 v43, s[16:19], s49 offen offset:1024 lds
    v_mfma_f32_16x16x32_bf16 v[184:187], a[184:187], a[16:19], v[184:187]
    s_waitcnt lgkmcnt(7)
    ds_read_b64_tr_b16 a[174:175], v21 offset:28672
    ds_read_b64_tr_b16 a[176:177], v22 offset:16384
    v_mfma_f32_16x16x32_bf16 v[184:187], a[188:191], a[24:27], v[184:187]
    ds_read_b64_tr_b16 a[178:179], v22 offset:20480
    v_mfma_f32_16x16x32_bf16 v[188:191], a[184:187], a[20:23], v[188:191]
    ds_read_b64_tr_b16 a[180:181], v22 offset:24576
    v_mfma_f32_16x16x32_bf16 v[188:191], a[188:191], a[28:31], v[188:191]
    s_waitcnt lgkmcnt(9)
    buffer_load_dwordx4 v44, s[16:19], s49 offen offset:2048 lds
    v_mfma_f32_16x16x32_bf16 v[192:195], a[160:163], a[16:19], v[192:195]
    s_waitcnt lgkmcnt(7)
    ds_read_b64_tr_b16 a[182:183], v22 offset:28672
    ds_read_b64_tr_b16 a[184:185], v23 offset:16384
    v_mfma_f32_16x16x32_bf16 v[192:195], a[164:167], a[24:27], v[192:195]
    ds_read_b64_tr_b16 a[186:187], v23 offset:20480
    v_mfma_f32_16x16x32_bf16 v[196:199], a[160:163], a[20:23], v[196:199]
    ds_read_b64_tr_b16 a[188:189], v23 offset:24576
    v_mfma_f32_16x16x32_bf16 v[196:199], a[164:167], a[28:31], v[196:199]
    s_waitcnt lgkmcnt(9)
    buffer_load_dwordx4 v45, s[16:19], s49 offen offset:3072 lds
    v_mfma_f32_16x16x32_bf16 v[200:203], a[168:171], a[16:19], v[200:203]
    s_waitcnt lgkmcnt(7)
    ds_read_b64_tr_b16 a[190:191], v23 offset:28672
    ds_read_b64_tr_b16 a[160:161], v24 offset:16384
    v_mfma_f32_16x16x32_bf16 v[200:203], a[172:175], a[24:27], v[200:203]
    ds_read_b64_tr_b16 a[162:163], v24 offset:20480
    v_mfma_f32_16x16x32_bf16 v[204:207], a[168:171], a[20:23], v[204:207]
    ds_read_b64_tr_b16 a[164:165], v24 offset:24576
    v_mfma_f32_16x16x32_bf16 v[204:207], a[172:175], a[28:31], v[204:207]
    s_waitcnt lgkmcnt(9)
    ds_read_b64_tr_b16 a[166:167], v24 offset:28672
    v_mfma_f32_16x16x32_bf16 v[208:211], a[176:179], a[16:19], v[208:211]
    s_waitcnt lgkmcnt(8)
    ds_read_b64_tr_b16 a[168:169], v25 offset:16384
    v_mfma_f32_16x16x32_bf16 v[208:211], a[180:183], a[24:27], v[208:211]
    ds_read_b64_tr_b16 a[170:171], v25 offset:20480
    v_mfma_f32_16x16x32_bf16 v[212:215], a[176:179], a[20:23], v[212:215]
    ds_read_b64_tr_b16 a[172:173], v25 offset:24576
    v_mfma_f32_16x16x32_bf16 v[212:215], a[180:183], a[28:31], v[212:215]
    s_waitcnt lgkmcnt(9)
    ds_read_b64_tr_b16 a[174:175], v25 offset:28672
    v_mfma_f32_16x16x32_bf16 v[216:219], a[184:187], a[16:19], v[216:219]
    s_waitcnt lgkmcnt(8)
    ds_read_b64_tr_b16 a[176:177], v26 offset:16384
    v_mfma_f32_16x16x32_bf16 v[216:219], a[188:191], a[24:27], v[216:219]
    ds_read_b64_tr_b16 a[178:179], v26 offset:20480
    v_mfma_f32_16x16x32_bf16 v[220:223], a[184:187], a[20:23], v[220:223]
    ds_read_b64_tr_b16 a[180:181], v26 offset:24576
    v_mfma_f32_16x16x32_bf16 v[220:223], a[188:191], a[28:31], v[220:223]
    s_waitcnt lgkmcnt(9)
    ds_read_b64_tr_b16 a[182:183], v26 offset:28672
    v_mfma_f32_16x16x32_bf16 v[224:227], a[160:163], a[16:19], v[224:227]
    s_waitcnt lgkmcnt(8)
    ds_read_b64_tr_b16 a[184:185], v27 offset:16384
    v_mfma_f32_16x16x32_bf16 v[224:227], a[164:167], a[24:27], v[224:227]
    ds_read_b64_tr_b16 a[186:187], v27 offset:20480
    v_mfma_f32_16x16x32_bf16 v[228:231], a[160:163], a[20:23], v[228:231]
    ds_read_b64_tr_b16 a[188:189], v27 offset:24576
    v_mfma_f32_16x16x32_bf16 v[228:231], a[164:167], a[28:31], v[228:231]
    s_waitcnt lgkmcnt(9)
    ds_read_b64_tr_b16 a[190:191], v27 offset:28672
    s_barrier
    v_mfma_f32_16x16x32_bf16 v[232:235], a[168:171], a[16:19], v[232:235]
    s_waitcnt lgkmcnt(8)
    ds_read_b64_tr_b16 a[160:161], v20 offset:32768
    v_mfma_f32_16x16x32_bf16 v[232:235], a[172:175], a[24:27], v[232:235]
Ltour0:
    s_cbranch_execz Ltour4
    ds_read_b64_tr_b16 a[162:163], v20 offset:36864
    v_mfma_f32_16x16x32_bf16 v[236:239], a[168:171], a[20:23], v[236:239]
    ds_read_b64_tr_b16 a[164:165], v20 offset:40960
    v_mfma_f32_16x16x32_bf16 v[236:239], a[172:175], a[28:31], v[236:239]
    s_waitcnt lgkmcnt(9)
    buffer_load_dwordx4 a[64:67], v51, s[24:27], s46 offen offset:1024 sc1
    v_mfma_f32_16x16x32_bf16 v[240:243], a[176:179], a[16:19], v[240:243]
    s_waitcnt lgkmcnt(7)
    ds_read_b64_tr_b16 a[166:167], v20 offset:45056
    ds_read_b64_tr_b16 a[168:169], v21 offset:32768
    v_mfma_f32_16x16x32_bf16 v[240:243], a[180:183], a[24:27], v[240:243]
    ds_read_b64_tr_b16 a[170:171], v21 offset:36864
    v_mfma_f32_16x16x32_bf16 v[244:247], a[176:179], a[20:23], v[244:247]
    ds_read_b64_tr_b16 a[172:173], v21 offset:40960
    v_mfma_f32_16x16x32_bf16 v[244:247], a[180:183], a[28:31], v[244:247]
    s_waitcnt lgkmcnt(9)
    buffer_load_dwordx4 a[72:75], v51, s[24:27], s46 offen offset:1152 sc1
    v_mfma_f32_16x16x32_bf16 v[248:251], a[184:187], a[16:19], v[248:251]
    s_waitcnt lgkmcnt(7)
    ds_read_b64_tr_b16 a[174:175], v21 offset:45056
    ds_read_b64_tr_b16 a[176:177], v22 offset:32768
    v_mfma_f32_16x16x32_bf16 v[248:251], a[188:191], a[24:27], v[248:251]
    ds_read_b64_tr_b16 a[178:179], v22 offset:36864
    v_mfma_f32_16x16x32_bf16 v[252:255], a[184:187], a[20:23], v[252:255]
    ds_read_b64_tr_b16 a[180:181], v22 offset:40960
    v_mfma_f32_16x16x32_bf16 v[252:255], a[188:191], a[28:31], v[252:255]
    s_waitcnt vmcnt(20)
    s_waitcnt lgkmcnt(9)
    buffer_load_dwordx4 a[68:71], v51, s[24:27], s43 offen offset:1024 sc1
    v_mfma_f32_16x16x32_bf16 v[128:131], a[160:163], a[32:35], v[128:131]
    s_waitcnt vmcnt(20)
    s_waitcnt lgkmcnt(7)
    ds_read_b64_tr_b16 a[182:183], v22 offset:45056
    ds_read_b64_tr_b16 a[184:185], v23 offset:32768
    v_mfma_f32_16x16x32_bf16 v[128:131], a[164:167], a[40:43], v[128:131]
    s_waitcnt vmcnt(19)
    ds_read_b64_tr_b16 a[186:187], v23 offset:36864
    v_mfma_f32_16x16x32_bf16 v[132:135], a[160:163], a[36:39], v[132:135]
    s_waitcnt vmcnt(18)
    ds_read_b64_tr_b16 a[188:189], v23 offset:40960
    v_mfma_f32_16x16x32_bf16 v[132:135], a[164:167], a[44:47], v[132:135]
    s_waitcnt lgkmcnt(9)
    buffer_load_dwordx4 a[76:79], v51, s[24:27], s43 offen offset:1152 sc1
    v_mfma_f32_16x16x32_bf16 v[136:139], a[168:171], a[32:35], v[136:139]
    s_waitcnt lgkmcnt(7)
    ds_read_b64_tr_b16 a[190:191], v23 offset:45056
    ds_read_b64_tr_b16 a[160:161], v24 offset:32768
    v_mfma_f32_16x16x32_bf16 v[136:139], a[172:175], a[40:43], v[136:139]
    s_add_u32 s49, s44, 2097152
    ds_read_b64_tr_b16 a[162:163], v24 offset:36864
    v_mfma_f32_16x16x32_bf16 v[140:143], a[168:171], a[36:39], v[140:143]
    s_add_u32 m0, s42, 0
    ds_read_b64_tr_b16 a[164:165], v24 offset:40960
    v_mfma_f32_16x16x32_bf16 v[140:143], a[172:175], a[44:47], v[140:143]
    s_waitcnt lgkmcnt(9)
    buffer_load_dwordx4 v42, s[16:19], s49 offen lds
    v_mfma_f32_16x16x32_bf16 v[144:147], a[176:179], a[32:35], v[144:147]
    s_waitcnt lgkmcnt(7)
    ds_read_b64_tr_b16 a[166:167], v24 offset:45056
    ds_read_b64_tr_b16 a[168:169], v25 offset:32768
    v_mfma_f32_16x16x32_bf16 v[144:147], a[180:183], a[40:43], v[144:147]
    ds_read_b64_tr_b16 a[170:171], v25 offset:36864
    v_mfma_f32_16x16x32_bf16 v[148:151], a[176:179], a[36:39], v[148:151]
    ds_read_b64_tr_b16 a[172:173], v25 offset:40960
    v_mfma_f32_16x16x32_bf16 v[148:151], a[180:183], a[44:47], v[148:151]
    s_waitcnt lgkmcnt(9)
    buffer_load_dwordx4 v43, s[16:19], s49 offen offset:1024 lds
    v_mfma_f32_16x16x32_bf16 v[152:155], a[184:187], a[32:35], v[152:155]
    s_waitcnt lgkmcnt(7)
    ds_read_b64_tr_b16 a[174:175], v25 offset:45056
    ds_read_b64_tr_b16 a[176:177], v26 offset:32768
    v_mfma_f32_16x16x32_bf16 v[152:155], a[188:191], a[40:43], v[152:155]
    ds_read_b64_tr_b16 a[178:179], v26 offset:36864
    v_mfma_f32_16x16x32_bf16 v[156:159], a[184:187], a[36:39], v[156:159]
    ds_read_b64_tr_b16 a[180:181], v26 offset:40960
    v_mfma_f32_16x16x32_bf16 v[156:159], a[188:191], a[44:47], v[156:159]
    s_waitcnt lgkmcnt(9)
    buffer_load_dwordx4 v44, s[16:19], s49 offen offset:2048 lds
    v_mfma_f32_16x16x32_bf16 v[160:163], a[160:163], a[32:35], v[160:163]
    s_waitcnt lgkmcnt(7)
    ds_read_b64_tr_b16 a[182:183], v26 offset:45056
    ds_read_b64_tr_b16 a[184:185], v27 offset:32768
    v_mfma_f32_16x16x32_bf16 v[160:163], a[164:167], a[40:43], v[160:163]
    ds_read_b64_tr_b16 a[186:187], v27 offset:36864
    v_mfma_f32_16x16x32_bf16 v[164:167], a[160:163], a[36:39], v[164:167]
    ds_read_b64_tr_b16 a[188:189], v27 offset:40960
    v_mfma_f32_16x16x32_bf16 v[164:167], a[164:167], a[44:47], v[164:167]
    s_waitcnt lgkmcnt(9)
    buffer_load_dwordx4 v45, s[16:19], s49 offen offset:3072 lds
    v_mfma_f32_16x16x32_bf16 v[168:171], a[168:171], a[32:35], v[168:171]
    s_waitcnt lgkmcnt(7)
    ds_read_b64_tr_b16 a[190:191], v27 offset:45056
    ds_read_b64_tr_b16 a[160:161], v20 offset:49152
    v_mfma_f32_16x16x32_bf16 v[168:171], a[172:175], a[40:43], v[168:171]
    s_add_u32 s49, s44, 2097408
    ds_read_b64_tr_b16 a[162:163], v20 offset:53248
    v_mfma_f32_16x16x32_bf16 v[172:175], a[168:171], a[36:39], v[172:175]
    s_add_u32 m0, s42, 16384
    ds_read_b64_tr_b16 a[164:165], v20 offset:57344
    v_mfma_f32_16x16x32_bf16 v[172:175], a[172:175], a[44:47], v[172:175]
    s_waitcnt lgkmcnt(9)
    buffer_load_dwordx4 v42, s[16:19], s49 offen lds
    v_mfma_f32_16x16x32_bf16 v[176:179], a[176:179], a[32:35], v[176:179]
    s_waitcnt lgkmcnt(7)
    ds_read_b64_tr_b16 a[166:167], v20 offset:61440
    ds_read_b64_tr_b16 a[168:169], v21 offset:49152
    v_mfma_f32_16x16x32_bf16 v[176:179], a[180:183], a[40:43], v[176:179]
    ds_read_b64_tr_b16 a[170:171], v21 offset:53248
    v_mfma_f32_16x16x32_bf16 v[180:183], a[176:179], a[36:39], v[180:183]
    ds_read_b64_tr_b16 a[172:173], v21 offset:57344
    v_mfma_f32_16x16x32_bf16 v[180:183], a[180:183], a[44:47], v[180:183]
    s_waitcnt lgkmcnt(9)
    buffer_load_dwordx4 v43, s[16:19], s49 offen offset:1024 lds
    v_mfma_f32_16x16x32_bf16 v[184:187], a[184:187], a[32:35], v[184:187]
    s_waitcnt lgkmcnt(7)
    ds_read_b64_tr_b16 a[174:175], v21 offset:61440
    ds_read_b64_tr_b16 a[176:177], v22 offset:49152
    v_mfma_f32_16x16x32_bf16 v[184:187], a[188:191], a[40:43], v[184:187]
    ds_read_b64_tr_b16 a[178:179], v22 offset:53248
    v_mfma_f32_16x16x32_bf16 v[188:191], a[184:187], a[36:39], v[188:191]
    ds_read_b64_tr_b16 a[180:181], v22 offset:57344
    v_mfma_f32_16x16x32_bf16 v[188:191], a[188:191], a[44:47], v[188:191]
    s_waitcnt lgkmcnt(9)
    buffer_load_dwordx4 v44, s[16:19], s49 offen offset:2048 lds
    v_mfma_f32_16x16x32_bf16 v[192:195], a[160:163], a[32:35], v[192:195]
    s_waitcnt lgkmcnt(7)
    ds_read_b64_tr_b16 a[182:183], v22 offset:61440
    ds_read_b64_tr_b16 a[184:185], v23 offset:49152
    v_mfma_f32_16x16x32_bf16 v[192:195], a[164:167], a[40:43], v[192:195]
    ds_read_b64_tr_b16 a[186:187], v23 offset:53248
    v_mfma_f32_16x16x32_bf16 v[196:199], a[160:163], a[36:39], v[196:199]
    ds_read_b64_tr_b16 a[188:189], v23 offset:57344
    v_mfma_f32_16x16x32_bf16 v[196:199], a[164:167], a[44:47], v[196:199]
    s_waitcnt lgkmcnt(9)
    buffer_load_dwordx4 v45, s[16:19], s49 offen offset:3072 lds
    v_mfma_f32_16x16x32_bf16 v[200:203], a[168:171], a[32:35], v[200:203]
    s_waitcnt lgkmcnt(7)
    ds_read_b64_tr_b16 a[190:191], v23 offset:61440
    ds_read_b64_tr_b16 a[160:161], v24 offset:49152
    v_mfma_f32_16x16x32_bf16 v[200:203], a[172:175], a[40:43], v[200:203]
    ds_read_b64_tr_b16 a[162:163], v24 offset:53248
    v_mfma_f32_16x16x32_bf16 v[204:207], a[168:171], a[36:39], v[204:207]
    ds_read_b64_tr_b16 a[164:165], v24 offset:57344
    v_mfma_f32_16x16x32_bf16 v[204:207], a[172:175], a[44:47], v[204:207]
    s_waitcnt lgkmcnt(9)
    ds_read_b64_tr_b16 a[166:167], v24 offset:61440
    v_mfma_f32_16x16x32_bf16 v[208:211], a[176:179], a[32:35], v[208:211]
    s_waitcnt lgkmcnt(8)
    ds_read_b64_tr_b16 a[168:169], v25 offset:49152
    v_mfma_f32_16x16x32_bf16 v[208:211], a[180:183], a[40:43], v[208:211]
    ds_read_b64_tr_b16 a[170:171], v25 offset:53248
    v_mfma_f32_16x16x32_bf16 v[212:215], a[176:179], a[36:39], v[212:215]
    ds_read_b64_tr_b16 a[172:173], v25 offset:57344
    v_mfma_f32_16x16x32_bf16 v[212:215], a[180:183], a[44:47], v[212:215]
    s_waitcnt lgkmcnt(9)
    ds_read_b64_tr_b16 a[174:175], v25 offset:61440
    v_mfma_f32_16x16x32_bf16 v[216:219], a[184:187], a[32:35], v[216:219]
    s_waitcnt lgkmcnt(8)
    ds_read_b64_tr_b16 a[176:177], v26 offset:49152
    v_mfma_f32_16x16x32_bf16 v[216:219], a[188:191], a[40:43], v[216:219]
    ds_read_b64_tr_b16 a[178:179], v26 offset:53248
    v_mfma_f32_16x16x32_bf16 v[220:223], a[184:187], a[36:39], v[220:223]
    ds_read_b64_tr_b16 a[180:181], v26 offset:57344
    v_mfma_f32_16x16x32_bf16 v[220:223], a[188:191], a[44:47], v[220:223]
    s_waitcnt lgkmcnt(9)
    ds_read_b64_tr_b16 a[182:183], v26 offset:61440
    v_mfma_f32_16x16x32_bf16 v[224:227], a[160:163], a[32:35], v[224:227]
    s_waitcnt lgkmcnt(8)
    ds_read_b64_tr_b16 a[184:185], v27 offset:49152
    v_mfma_f32_16x16x32_bf16 v[224:227], a[164:167], a[40:43], v[224:227]
    ds_read_b64_tr_b16 a[186:187], v27 offset:53248
    v_mfma_f32_16x16x32_bf16 v[228:231], a[160:163], a[36:39], v[228:231]
    ds_read_b64_tr_b16 a[188:189], v27 offset:57344
    v_mfma_f32_16x16x32_bf16 v[228:231], a[164:167], a[44:47], v[228:231]
    s_waitcnt lgkmcnt(9)
    ds_read_b64_tr_b16 a[190:191], v27 offset:61440
    s_waitcnt vmcnt(12)
    s_barrier
    v_mfma_f32_16x16x32_bf16 v[232:235], a[168:171], a[32:35], v[232:235]
    s_waitcnt lgkmcnt(8)
    ds_read_b64_tr_b16 a[160:161], v28 offset:0
    v_mfma_f32_16x16x32_bf16 v[232:235], a[172:175], a[40:43], v[232:235]
    ds_read_b64_tr_b16 a[162:163], v28 offset:4096
    v_mfma_f32_16x16x32_bf16 v[236:239], a[168:171], a[36:39], v[236:239]
    ds_read_b64_tr_b16 a[164:165], v28 offset:8192
    v_mfma_f32_16x16x32_bf16 v[236:239], a[172:175], a[44:47], v[236:239]
    s_waitcnt lgkmcnt(9)
    buffer_load_dwordx4 a[80:83], v51, s[24:27], s46 offen offset:1280 sc1
    v_mfma_f32_16x16x32_bf16 v[240:243], a[176:179], a[32:35], v[240:243]
    s_waitcnt lgkmcnt(7)
    ds_read_b64_tr_b16 a[166:167], v28 offset:12288
    ds_read_b64_tr_b16 a[168:169], v29 offset:0
    v_mfma_f32_16x16x32_bf16 v[240:243], a[180:183], a[40:43], v[240:243]
    ds_read_b64_tr_b16 a[170:171], v29 offset:4096
    v_mfma_f32_16x16x32_bf16 v[244:247], a[176:179], a[36:39], v[244:247]
    ds_read_b64_tr_b16 a[172:173], v29 offset:8192
    v_mfma_f32_16x16x32_bf16 v[244:247], a[180:183], a[44:47], v[244:247]
    s_waitcnt lgkmcnt(9)
    buffer_load_dwordx4 a[88:91], v51, s[24:27], s46 offen offset:1408 sc1
    v_mfma_f32_16x16x32_bf16 v[248:251], a[184:187], a[32:35], v[248:251]
    s_waitcnt lgkmcnt(7)
    ds_read_b64_tr_b16 a[174:175], v29 offset:12288
    ds_read_b64_tr_b16 a[176:177], v30 offset:0
    v_mfma_f32_16x16x32_bf16 v[248:251], a[188:191], a[40:43], v[248:251]
    ds_read_b64_tr_b16 a[178:179], v30 offset:4096
    v_mfma_f32_16x16x32_bf16 v[252:255], a[184:187], a[36:39], v[252:255]
    ds_read_b64_tr_b16 a[180:181], v30 offset:8192
    v_mfma_f32_16x16x32_bf16 v[252:255], a[188:191], a[44:47], v[252:255]
    s_waitcnt lgkmcnt(9)
    buffer_load_dwordx4 a[84:87], v51, s[24:27], s43 offen offset:1280 sc1
    v_mfma_f32_16x16x32_bf16 v[128:131], a[160:163], a[48:51], v[128:131]
    s_waitcnt lgkmcnt(7)
    ds_read_b64_tr_b16 a[182:183], v30 offset:12288
    ds_read_b64_tr_b16 a[184:185], v31 offset:0
    v_mfma_f32_16x16x32_bf16 v[128:131], a[164:167], a[56:59], v[128:131]
    ds_read_b64_tr_b16 a[186:187], v31 offset:4096
    v_mfma_f32_16x16x32_bf16 v[132:135], a[160:163], a[52:55], v[132:135]
    ds_read_b64_tr_b16 a[188:189], v31 offset:8192
    v_mfma_f32_16x16x32_bf16 v[132:135], a[164:167], a[60:63], v[132:135]
    s_waitcnt lgkmcnt(9)
    buffer_load_dwordx4 a[92:95], v51, s[24:27], s43 offen offset:1408 sc1
    v_mfma_f32_16x16x32_bf16 v[136:139], a[168:171], a[48:51], v[136:139]
    s_waitcnt lgkmcnt(7)
    ds_read_b64_tr_b16 a[190:191], v31 offset:12288
    ds_read_b64_tr_b16 a[160:161], v32 offset:0
    v_mfma_f32_16x16x32_bf16 v[136:139], a[172:175], a[56:59], v[136:139]
    s_add_u32 s49, s44, 2621440
    ds_read_b64_tr_b16 a[162:163], v32 offset:4096
    v_mfma_f32_16x16x32_bf16 v[140:143], a[168:171], a[52:55], v[140:143]
    s_add_u32 m0, s42, 32768
    ds_read_b64_tr_b16 a[164:165], v32 offset:8192
    v_mfma_f32_16x16x32_bf16 v[140:143], a[172:175], a[60:63], v[140:143]
    s_waitcnt lgkmcnt(9)
    buffer_load_dwordx4 v42, s[16:19], s49 offen lds
    v_mfma_f32_16x16x32_bf16 v[144:147], a[176:179], a[48:51], v[144:147]
    s_waitcnt lgkmcnt(7)
    ds_read_b64_tr_b16 a[166:167], v32 offset:12288
    ds_read_b64_tr_b16 a[168:169], v33 offset:0
    v_mfma_f32_16x16x32_bf16 v[144:147], a[180:183], a[56:59], v[144:147]
    ds_read_b64_tr_b16 a[170:171], v33 offset:4096
    v_mfma_f32_16x16x32_bf16 v[148:151], a[176:179], a[52:55], v[148:151]
    ds_read_b64_tr_b16 a[172:173], v33 offset:8192
    v_mfma_f32_16x16x32_bf16 v[148:151], a[180:183], a[60:63], v[148:151]
    s_waitcnt lgkmcnt(9)
    buffer_load_dwordx4 v43, s[16:19], s49 offen offset:1024 lds
    v_mfma_f32_16x16x32_bf16 v[152:155], a[184:187], a[48:51], v[152:155]
    s_waitcnt lgkmcnt(7)
    ds_read_b64_tr_b16 a[174:175], v33 offset:12288
    ds_read_b64_tr_b16 a[176:177], v34 offset:0
    v_mfma_f32_16x16x32_bf16 v[152:155], a[188:191], a[56:59], v[152:155]
    ds_read_b64_tr_b16 a[178:179], v34 offset:4096
    v_mfma_f32_16x16x32_bf16 v[156:159], a[184:187], a[52:55], v[156:159]
    ds_read_b64_tr_b16 a[180:181], v34 offset:8192
    v_mfma_f32_16x16x32_bf16 v[156:159], a[188:191], a[60:63], v[156:159]
    s_waitcnt lgkmcnt(9)
    buffer_load_dwordx4 v44, s[16:19], s49 offen offset:2048 lds
    v_mfma_f32_16x16x32_bf16 v[160:163], a[160:163], a[48:51], v[160:163]
    s_waitcnt lgkmcnt(7)
    ds_read_b64_tr_b16 a[182:183], v34 offset:12288
    ds_read_b64_tr_b16 a[184:185], v35 offset:0
    v_mfma_f32_16x16x32_bf16 v[160:163], a[164:167], a[56:59], v[160:163]
    ds_read_b64_tr_b16 a[186:187], v35 offset:4096
    v_mfma_f32_16x16x32_bf16 v[164:167], a[160:163], a[52:55], v[164:167]
    ds_read_b64_tr_b16 a[188:189], v35 offset:8192
    v_mfma_f32_16x16x32_bf16 v[164:167], a[164:167], a[60:63], v[164:167]
    s_waitcnt lgkmcnt(9)
    buffer_load_dwordx4 v45, s[16:19], s49 offen offset:3072 lds
    v_mfma_f32_16x16x32_bf16 v[168:171], a[168:171], a[48:51], v[168:171]
    s_waitcnt lgkmcnt(7)
    ds_read_b64_tr_b16 a[190:191], v35 offset:12288
    ds_read_b64_tr_b16 a[160:161], v28 offset:16384
    v_mfma_f32_16x16x32_bf16 v[168:171], a[172:175], a[56:59], v[168:171]
    s_add_u32 s49, s44, 2621696
    ds_read_b64_tr_b16 a[162:163], v28 offset:20480
    v_mfma_f32_16x16x32_bf16 v[172:175], a[168:171], a[52:55], v[172:175]
    s_add_u32 m0, s42, 49152
    ds_read_b64_tr_b16 a[164:165], v28 offset:24576
    v_mfma_f32_16x16x32_bf16 v[172:175], a[172:175], a[60:63], v[172:175]
    s_waitcnt lgkmcnt(9)
    buffer_load_dwordx4 v42, s[16:19], s49 offen lds
    v_mfma_f32_16x16x32_bf16 v[176:179], a[176:179], a[48:51], v[176:179]
    s_waitcnt lgkmcnt(7)
    ds_read_b64_tr_b16 a[166:167], v28 offset:28672
    ds_read_b64_tr_b16 a[168:169], v29 offset:16384
    v_mfma_f32_16x16x32_bf16 v[176:179], a[180:183], a[56:59], v[176:179]
    ds_read_b64_tr_b16 a[170:171], v29 offset:20480
    v_mfma_f32_16x16x32_bf16 v[180:183], a[176:179], a[52:55], v[180:183]
    ds_read_b64_tr_b16 a[172:173], v29 offset:24576
    v_mfma_f32_16x16x32_bf16 v[180:183], a[180:183], a[60:63], v[180:183]
    s_waitcnt lgkmcnt(9)
    buffer_load_dwordx4 v43, s[16:19], s49 offen offset:1024 lds
    v_mfma_f32_16x16x32_bf16 v[184:187], a[184:187], a[48:51], v[184:187]
    s_waitcnt lgkmcnt(7)
    ds_read_b64_tr_b16 a[174:175], v29 offset:28672
    ds_read_b64_tr_b16 a[176:177], v30 offset:16384
    v_mfma_f32_16x16x32_bf16 v[184:187], a[188:191], a[56:59], v[184:187]
    ds_read_b64_tr_b16 a[178:179], v30 offset:20480
    v_mfma_f32_16x16x32_bf16 v[188:191], a[184:187], a[52:55], v[188:191]
    ds_read_b64_tr_b16 a[180:181], v30 offset:24576
    v_mfma_f32_16x16x32_bf16 v[188:191], a[188:191], a[60:63], v[188:191]
    s_waitcnt lgkmcnt(9)
    buffer_load_dwordx4 v44, s[16:19], s49 offen offset:2048 lds
    v_mfma_f32_16x16x32_bf16 v[192:195], a[160:163], a[48:51], v[192:195]
    s_waitcnt lgkmcnt(7)
    ds_read_b64_tr_b16 a[182:183], v30 offset:28672
    ds_read_b64_tr_b16 a[184:185], v31 offset:16384
    v_mfma_f32_16x16x32_bf16 v[192:195], a[164:167], a[56:59], v[192:195]
    ds_read_b64_tr_b16 a[186:187], v31 offset:20480
    v_mfma_f32_16x16x32_bf16 v[196:199], a[160:163], a[52:55], v[196:199]
    ds_read_b64_tr_b16 a[188:189], v31 offset:24576
    v_mfma_f32_16x16x32_bf16 v[196:199], a[164:167], a[60:63], v[196:199]
    s_waitcnt lgkmcnt(9)
    buffer_load_dwordx4 v45, s[16:19], s49 offen offset:3072 lds
    v_mfma_f32_16x16x32_bf16 v[200:203], a[168:171], a[48:51], v[200:203]
    s_waitcnt lgkmcnt(7)
    ds_read_b64_tr_b16 a[190:191], v31 offset:28672
    ds_read_b64_tr_b16 a[160:161], v32 offset:16384
    v_mfma_f32_16x16x32_bf16 v[200:203], a[172:175], a[56:59], v[200:203]
    ds_read_b64_tr_b16 a[162:163], v32 offset:20480
    v_mfma_f32_16x16x32_bf16 v[204:207], a[168:171], a[52:55], v[204:207]
    ds_read_b64_tr_b16 a[164:165], v32 offset:24576
    v_mfma_f32_16x16x32_bf16 v[204:207], a[172:175], a[60:63], v[204:207]
    s_waitcnt lgkmcnt(9)
    ds_read_b64_tr_b16 a[166:167], v32 offset:28672
    v_mfma_f32_16x16x32_bf16 v[208:211], a[176:179], a[48:51], v[208:211]
    s_waitcnt lgkmcnt(8)
    ds_read_b64_tr_b16 a[168:169], v33 offset:16384
    v_mfma_f32_16x16x32_bf16 v[208:211], a[180:183], a[56:59], v[208:211]
    ds_read_b64_tr_b16 a[170:171], v33 offset:20480
    v_mfma_f32_16x16x32_bf16 v[212:215], a[176:179], a[52:55], v[212:215]
    ds_read_b64_tr_b16 a[172:173], v33 offset:24576
    v_mfma_f32_16x16x32_bf16 v[212:215], a[180:183], a[60:63], v[212:215]
    s_waitcnt lgkmcnt(9)
    ds_read_b64_tr_b16 a[174:175], v33 offset:28672
    v_mfma_f32_16x16x32_bf16 v[216:219], a[184:187], a[48:51], v[216:219]
    s_waitcnt lgkmcnt(8)
    ds_read_b64_tr_b16 a[176:177], v34 offset:16384
    v_mfma_f32_16x16x32_bf16 v[216:219], a[188:191], a[56:59], v[216:219]
    ds_read_b64_tr_b16 a[178:179], v34 offset:20480
    v_mfma_f32_16x16x32_bf16 v[220:223], a[184:187], a[52:55], v[220:223]
    ds_read_b64_tr_b16 a[180:181], v34 offset:24576
    v_mfma_f32_16x16x32_bf16 v[220:223], a[188:191], a[60:63], v[220:223]
    s_waitcnt lgkmcnt(9)
    ds_read_b64_tr_b16 a[182:183], v34 offset:28672
    v_mfma_f32_16x16x32_bf16 v[224:227], a[160:163], a[48:51], v[224:227]
    s_waitcnt lgkmcnt(8)
    ds_read_b64_tr_b16 a[184:185], v35 offset:16384
    v_mfma_f32_16x16x32_bf16 v[224:227], a[164:167], a[56:59], v[224:227]
    ds_read_b64_tr_b16 a[186:187], v35 offset:20480
    v_mfma_f32_16x16x32_bf16 v[228:231], a[160:163], a[52:55], v[228:231]
    ds_read_b64_tr_b16 a[188:189], v35 offset:24576
    v_mfma_f32_16x16x32_bf16 v[228:231], a[164:167], a[60:63], v[228:231]
    s_waitcnt lgkmcnt(9)
    ds_read_b64_tr_b16 a[190:191], v35 offset:28672
    s_waitcnt vmcnt(12)
    s_barrier
    v_mfma_f32_16x16x32_bf16 v[232:235], a[168:171], a[48:51], v[232:235]
    s_waitcnt lgkmcnt(8)
    ds_read_b64_tr_b16 a[160:161], v12 offset:0
    v_mfma_f32_16x16x32_bf16 v[232:235], a[172:175], a[56:59], v[232:235]
    ds_read_b64_tr_b16 a[162:163], v12 offset:4096
    v_mfma_f32_16x16x32_bf16 v[236:239], a[168:171], a[52:55], v[236:239]
    ds_read_b64_tr_b16 a[164:165], v12 offset:8192
    v_mfma_f32_16x16x32_bf16 v[236:239], a[172:175], a[60:63], v[236:239]
    s_waitcnt lgkmcnt(9)
    buffer_load_dwordx4 a[96:99], v51, s[24:27], s46 offen offset:1536 sc1
    v_mfma_f32_16x16x32_bf16 v[240:243], a[176:179], a[48:51], v[240:243]
    s_waitcnt lgkmcnt(7)
    ds_read_b64_tr_b16 a[166:167], v12 offset:12288
    ds_read_b64_tr_b16 a[168:169], v13 offset:0
    v_mfma_f32_16x16x32_bf16 v[240:243], a[180:183], a[56:59], v[240:243]
    ds_read_b64_tr_b16 a[170:171], v13 offset:4096
    v_mfma_f32_16x16x32_bf16 v[244:247], a[176:179], a[52:55], v[244:247]
    ds_read_b64_tr_b16 a[172:173], v13 offset:8192
    v_mfma_f32_16x16x32_bf16 v[244:247], a[180:183], a[60:63], v[244:247]
    s_waitcnt lgkmcnt(9)
    buffer_load_dwordx4 a[104:107], v51, s[24:27], s46 offen offset:1664 sc1
    v_mfma_f32_16x16x32_bf16 v[248:251], a[184:187], a[48:51], v[248:251]
    s_waitcnt lgkmcnt(7)
    ds_read_b64_tr_b16 a[174:175], v13 offset:12288
    ds_read_b64_tr_b16 a[176:177], v14 offset:0
    v_mfma_f32_16x16x32_bf16 v[248:251], a[188:191], a[56:59], v[248:251]
    ds_read_b64_tr_b16 a[178:179], v14 offset:4096
    v_mfma_f32_16x16x32_bf16 v[252:255], a[184:187], a[52:55], v[252:255]
    ds_read_b64_tr_b16 a[180:181], v14 offset:8192
    v_mfma_f32_16x16x32_bf16 v[252:255], a[188:191], a[60:63], v[252:255]
    s_waitcnt lgkmcnt(9)
    buffer_load_dwordx4 a[100:103], v51, s[24:27], s43 offen offset:1536 sc1
    v_mfma_f32_16x16x32_bf16 v[128:131], a[160:163], a[64:67], v[128:131]
    s_waitcnt lgkmcnt(7)
    ds_read_b64_tr_b16 a[182:183], v14 offset:12288
    ds_read_b64_tr_b16 a[184:185], v15 offset:0
    v_mfma_f32_16x16x32_bf16 v[128:131], a[164:167], a[72:75], v[128:131]
    ds_read_b64_tr_b16 a[186:187], v15 offset:4096
    v_mfma_f32_16x16x32_bf16 v[132:135], a[160:163], a[68:71], v[132:135]
    ds_read_b64_tr_b16 a[188:189], v15 offset:8192
    v_mfma_f32_16x16x32_bf16 v[132:135], a[164:167], a[76:79], v[132:135]
    s_waitcnt lgkmcnt(9)
    buffer_load_dwordx4 a[108:111], v51, s[24:27], s43 offen offset:1664 sc1
    v_mfma_f32_16x16x32_bf16 v[136:139], a[168:171], a[64:67], v[136:139]
    s_waitcnt lgkmcnt(7)
    ds_read_b64_tr_b16 a[190:191], v15 offset:12288
    ds_read_b64_tr_b16 a[160:161], v16 offset:0
    v_mfma_f32_16x16x32_bf16 v[136:139], a[172:175], a[72:75], v[136:139]
    s_add_u32 s49, s44, 3145728
    ds_read_b64_tr_b16 a[162:163], v16 offset:4096
    v_mfma_f32_16x16x32_bf16 v[140:143], a[168:171], a[68:71], v[140:143]
    s_add_u32 m0, s42, 65536
    ds_read_b64_tr_b16 a[164:165], v16 offset:8192
    v_mfma_f32_16x16x32_bf16 v[140:143], a[172:175], a[76:79], v[140:143]
    s_waitcnt lgkmcnt(9)
    buffer_load_dwordx4 v42, s[16:19], s49 offen lds
    v_mfma_f32_16x16x32_bf16 v[144:147], a[176:179], a[64:67], v[144:147]
    s_waitcnt lgkmcnt(7)
    ds_read_b64_tr_b16 a[166:167], v16 offset:12288
    ds_read_b64_tr_b16 a[168:169], v17 offset:0
    v_mfma_f32_16x16x32_bf16 v[144:147], a[180:183], a[72:75], v[144:147]
    ds_read_b64_tr_b16 a[170:171], v17 offset:4096
    v_mfma_f32_16x16x32_bf16 v[148:151], a[176:179], a[68:71], v[148:151]
    ds_read_b64_tr_b16 a[172:173], v17 offset:8192
    v_mfma_f32_16x16x32_bf16 v[148:151], a[180:183], a[76:79], v[148:151]
    s_waitcnt lgkmcnt(9)
    buffer_load_dwordx4 v43, s[16:19], s49 offen offset:1024 lds
    v_mfma_f32_16x16x32_bf16 v[152:155], a[184:187], a[64:67], v[152:155]
    s_waitcnt lgkmcnt(7)
    ds_read_b64_tr_b16 a[174:175], v17 offset:12288
    ds_read_b64_tr_b16 a[176:177], v18 offset:0
    v_mfma_f32_16x16x32_bf16 v[152:155], a[188:191], a[72:75], v[152:155]
    ds_read_b64_tr_b16 a[178:179], v18 offset:4096
    v_mfma_f32_16x16x32_bf16 v[156:159], a[184:187], a[68:71], v[156:159]
    ds_read_b64_tr_b16 a[180:181], v18 offset:8192
    v_mfma_f32_16x16x32_bf16 v[156:159], a[188:191], a[76:79], v[156:159]
    s_waitcnt lgkmcnt(9)
    buffer_load_dwordx4 v44, s[16:19], s49 offen offset:2048 lds
    v_mfma_f32_16x16x32_bf16 v[160:163], a[160:163], a[64:67], v[160:163]
    s_waitcnt lgkmcnt(7)
    ds_read_b64_tr_b16 a[182:183], v18 offset:12288
    ds_read_b64_tr_b16 a[184:185], v19 offset:0
    v_mfma_f32_16x16x32_bf16 v[160:163], a[164:167], a[72:75], v[160:163]
    ds_read_b64_tr_b16 a[186:187], v19 offset:4096
    v_mfma_f32_16x16x32_bf16 v[164:167], a[160:163], a[68:71], v[164:167]
    ds_read_b64_tr_b16 a[188:189], v19 offset:8192
    v_mfma_f32_16x16x32_bf16 v[164:167], a[164:167], a[76:79], v[164:167]
    s_waitcnt lgkmcnt(9)
    buffer_load_dwordx4 v45, s[16:19], s49 offen offset:3072 lds
    v_mfma_f32_16x16x32_bf16 v[168:171], a[168:171], a[64:67], v[168:171]
    s_waitcnt lgkmcnt(7)
    ds_read_b64_tr_b16 a[190:191], v19 offset:12288
    ds_read_b64_tr_b16 a[160:161], v12 offset:16384
    v_mfma_f32_16x16x32_bf16 v[168:171], a[172:175], a[72:75], v[168:171]
    s_add_u32 s49, s44, 3145984
    ds_read_b64_tr_b16 a[162:163], v12 offset:20480
    v_mfma_f32_16x16x32_bf16 v[172:175], a[168:171], a[68:71], v[172:175]
    s_add_u32 m0, s42, 81920
    ds_read_b64_tr_b16 a[164:165], v12 offset:24576
    v_mfma_f32_16x16x32_bf16 v[172:175], a[172:175], a[76:79], v[172:175]
    s_waitcnt lgkmcnt(9)
    buffer_load_dwordx4 v42, s[16:19], s49 offen lds
    v_mfma_f32_16x16x32_bf16 v[176:179], a[176:179], a[64:67], v[176:179]
    s_waitcnt lgkmcnt(7)
    ds_read_b64_tr_b16 a[166:167], v12 offset:28672
    ds_read_b64_tr_b16 a[168:169], v13 offset:16384
    v_mfma_f32_16x16x32_bf16 v[176:179], a[180:183], a[72:75], v[176:179]
    ds_read_b64_tr_b16 a[170:171], v13 offset:20480
    v_mfma_f32_16x16x32_bf16 v[180:183], a[176:179], a[68:71], v[180:183]
    ds_read_b64_tr_b16 a[172:173], v13 offset:24576
    v_mfma_f32_16x16x32_bf16 v[180:183], a[180:183], a[76:79], v[180:183]
    s_waitcnt lgkmcnt(9)
    buffer_load_dwordx4 v43, s[16:19], s49 offen offset:1024 lds
    v_mfma_f32_16x16x32_bf16 v[184:187], a[184:187], a[64:67], v[184:187]
    s_waitcnt lgkmcnt(7)
    ds_read_b64_tr_b16 a[174:175], v13 offset:28672
    ds_read_b64_tr_b16 a[176:177], v14 offset:16384
    v_mfma_f32_16x16x32_bf16 v[184:187], a[188:191], a[72:75], v[184:187]
    ds_read_b64_tr_b16 a[178:179], v14 offset:20480
    v_mfma_f32_16x16x32_bf16 v[188:191], a[184:187], a[68:71], v[188:191]
    ds_read_b64_tr_b16 a[180:181], v14 offset:24576
    v_mfma_f32_16x16x32_bf16 v[188:191], a[188:191], a[76:79], v[188:191]
    s_waitcnt lgkmcnt(9)
    buffer_load_dwordx4 v44, s[16:19], s49 offen offset:2048 lds
    v_mfma_f32_16x16x32_bf16 v[192:195], a[160:163], a[64:67], v[192:195]
    s_waitcnt lgkmcnt(7)
    ds_read_b64_tr_b16 a[182:183], v14 offset:28672
    ds_read_b64_tr_b16 a[184:185], v15 offset:16384
    v_mfma_f32_16x16x32_bf16 v[192:195], a[164:167], a[72:75], v[192:195]
    ds_read_b64_tr_b16 a[186:187], v15 offset:20480
    v_mfma_f32_16x16x32_bf16 v[196:199], a[160:163], a[68:71], v[196:199]
    ds_read_b64_tr_b16 a[188:189], v15 offset:24576
    v_mfma_f32_16x16x32_bf16 v[196:199], a[164:167], a[76:79], v[196:199]
    s_waitcnt lgkmcnt(9)
    buffer_load_dwordx4 v45, s[16:19], s49 offen offset:3072 lds
    v_mfma_f32_16x16x32_bf16 v[200:203], a[168:171], a[64:67], v[200:203]
    s_waitcnt lgkmcnt(7)
    ds_read_b64_tr_b16 a[190:191], v15 offset:28672
    ds_read_b64_tr_b16 a[160:161], v16 offset:16384
    v_mfma_f32_16x16x32_bf16 v[200:203], a[172:175], a[72:75], v[200:203]
    ds_read_b64_tr_b16 a[162:163], v16 offset:20480
    v_mfma_f32_16x16x32_bf16 v[204:207], a[168:171], a[68:71], v[204:207]
    ds_read_b64_tr_b16 a[164:165], v16 offset:24576
    v_mfma_f32_16x16x32_bf16 v[204:207], a[172:175], a[76:79], v[204:207]
    s_waitcnt lgkmcnt(9)
    ds_read_b64_tr_b16 a[166:167], v16 offset:28672
    v_mfma_f32_16x16x32_bf16 v[208:211], a[176:179], a[64:67], v[208:211]
    s_waitcnt lgkmcnt(8)
    ds_read_b64_tr_b16 a[168:169], v17 offset:16384
    v_mfma_f32_16x16x32_bf16 v[208:211], a[180:183], a[72:75], v[208:211]
    ds_read_b64_tr_b16 a[170:171], v17 offset:20480
    v_mfma_f32_16x16x32_bf16 v[212:215], a[176:179], a[68:71], v[212:215]
    ds_read_b64_tr_b16 a[172:173], v17 offset:24576
    v_mfma_f32_16x16x32_bf16 v[212:215], a[180:183], a[76:79], v[212:215]
    s_waitcnt lgkmcnt(9)
    ds_read_b64_tr_b16 a[174:175], v17 offset:28672
    v_mfma_f32_16x16x32_bf16 v[216:219], a[184:187], a[64:67], v[216:219]
    s_waitcnt lgkmcnt(8)
    ds_read_b64_tr_b16 a[176:177], v18 offset:16384
    v_mfma_f32_16x16x32_bf16 v[216:219], a[188:191], a[72:75], v[216:219]
    ds_read_b64_tr_b16 a[178:179], v18 offset:20480
    v_mfma_f32_16x16x32_bf16 v[220:223], a[184:187], a[68:71], v[220:223]
    ds_read_b64_tr_b16 a[180:181], v18 offset:24576
    v_mfma_f32_16x16x32_bf16 v[220:223], a[188:191], a[76:79], v[220:223]
    s_waitcnt lgkmcnt(9)
    ds_read_b64_tr_b16 a[182:183], v18 offset:28672
    v_mfma_f32_16x16x32_bf16 v[224:227], a[160:163], a[64:67], v[224:227]
    s_waitcnt lgkmcnt(8)
    ds_read_b64_tr_b16 a[184:185], v19 offset:16384
    v_mfma_f32_16x16x32_bf16 v[224:227], a[164:167], a[72:75], v[224:227]
    ds_read_b64_tr_b16 a[186:187], v19 offset:20480
    v_mfma_f32_16x16x32_bf16 v[228:231], a[160:163], a[68:71], v[228:231]
    ds_read_b64_tr_b16 a[188:189], v19 offset:24576
    v_mfma_f32_16x16x32_bf16 v[228:231], a[164:167], a[76:79], v[228:231]
    s_waitcnt lgkmcnt(9)
    ds_read_b64_tr_b16 a[190:191], v19 offset:28672
    s_waitcnt vmcnt(12)
    s_barrier
    v_mfma_f32_16x16x32_bf16 v[232:235], a[168:171], a[64:67], v[232:235]
    s_waitcnt lgkmcnt(8)
    ds_read_b64_tr_b16 a[160:161], v12 offset:32768
    v_mfma_f32_16x16x32_bf16 v[232:235], a[172:175], a[72:75], v[232:235]
    ds_read_b64_tr_b16 a[162:163], v12 offset:36864
    v_mfma_f32_16x16x32_bf16 v[236:239], a[168:171], a[68:71], v[236:239]
    ds_read_b64_tr_b16 a[164:165], v12 offset:40960
    v_mfma_f32_16x16x32_bf16 v[236:239], a[172:175], a[76:79], v[236:239]
    s_waitcnt lgkmcnt(9)
    buffer_load_dwordx4 a[112:115], v51, s[24:27], s46 offen offset:1792 sc1
    v_mfma_f32_16x16x32_bf16 v[240:243], a[176:179], a[64:67], v[240:243]
    s_waitcnt lgkmcnt(7)
    ds_read_b64_tr_b16 a[166:167], v12 offset:45056
    ds_read_b64_tr_b16 a[168:169], v13 offset:32768
    v_mfma_f32_16x16x32_bf16 v[240:243], a[180:183], a[72:75], v[240:243]
    ds_read_b64_tr_b16 a[170:171], v13 offset:36864
    v_mfma_f32_16x16x32_bf16 v[244:247], a[176:179], a[68:71], v[244:247]
    ds_read_b64_tr_b16 a[172:173], v13 offset:40960
    v_mfma_f32_16x16x32_bf16 v[244:247], a[180:183], a[76:79], v[244:247]
    s_waitcnt lgkmcnt(9)
    buffer_load_dwordx4 a[120:123], v51, s[24:27], s46 offen offset:1920 sc1
    v_mfma_f32_16x16x32_bf16 v[248:251], a[184:187], a[64:67], v[248:251]
    s_waitcnt lgkmcnt(7)
    ds_read_b64_tr_b16 a[174:175], v13 offset:45056
    ds_read_b64_tr_b16 a[176:177], v14 offset:32768
    v_mfma_f32_16x16x32_bf16 v[248:251], a[188:191], a[72:75], v[248:251]
    ds_read_b64_tr_b16 a[178:179], v14 offset:36864
    v_mfma_f32_16x16x32_bf16 v[252:255], a[184:187], a[68:71], v[252:255]
    ds_read_b64_tr_b16 a[180:181], v14 offset:40960
    v_mfma_f32_16x16x32_bf16 v[252:255], a[188:191], a[76:79], v[252:255]
    s_waitcnt lgkmcnt(9)
    buffer_load_dwordx4 a[116:119], v51, s[24:27], s43 offen offset:1792 sc1
    v_mfma_f32_16x16x32_bf16 v[128:131], a[160:163], a[80:83], v[128:131]
    s_waitcnt lgkmcnt(7)
    ds_read_b64_tr_b16 a[182:183], v14 offset:45056
    ds_read_b64_tr_b16 a[184:185], v15 offset:32768
    v_mfma_f32_16x16x32_bf16 v[128:131], a[164:167], a[88:91], v[128:131]
Ltour1:
    s_cbranch_execz Ltour5
    ds_read_b64_tr_b16 a[186:187], v15 offset:36864
    v_accvgpr_write_b32 a0, 0
    v_mfma_f32_16x16x32_bf16 v[132:135], a[160:163], a[84:87], v[132:135]
    ds_read_b64_tr_b16 a[188:189], v15 offset:40960
    v_accvgpr_write_b32 a1, 0
    v_mfma_f32_16x16x32_bf16 v[132:135], a[164:167], a[92:95], v[132:135]
    s_waitcnt lgkmcnt(9)
    buffer_load_dwordx4 a[124:127], v51, s[24:27], s43 offen offset:1920 sc1
    v_mfma_f32_16x16x32_bf16 v[136:139], a[168:171], a[80:83], v[136:139]
    s_waitcnt lgkmcnt(7)
    ds_read_b64_tr_b16 a[190:191], v15 offset:45056
    ds_read_b64_tr_b16 a[160:161], v16 offset:32768
    v_mfma_f32_16x16x32_bf16 v[136:139], a[172:175], a[88:91], v[136:139]
    s_add_u32 s49, s44, 3670016
    ds_read_b64_tr_b16 a[162:163], v16 offset:36864
    v_accvgpr_write_b32 a2, 0
    v_mfma_f32_16x16x32_bf16 v[140:143], a[168:171], a[84:87], v[140:143]
    s_add_u32 m0, s42, 98304
    ds_read_b64_tr_b16 a[164:165], v16 offset:40960
    v_accvgpr_write_b32 a3, 0
    v_mfma_f32_16x16x32_bf16 v[140:143], a[172:175], a[92:95], v[140:143]
    s_waitcnt lgkmcnt(9)
    buffer_load_dwordx4 v42, s[16:19], s49 offen lds
    v_mfma_f32_16x16x32_bf16 v[144:147], a[176:179], a[80:83], v[144:147]
    s_waitcnt lgkmcnt(7)
    ds_read_b64_tr_b16 a[166:167], v16 offset:45056
    ds_read_b64_tr_b16 a[168:169], v17 offset:32768
    v_mfma_f32_16x16x32_bf16 v[144:147], a[180:183], a[88:91], v[144:147]
    ds_read_b64_tr_b16 a[170:171], v17 offset:36864
    v_accvgpr_write_b32 a4, 0
    v_mfma_f32_16x16x32_bf16 v[148:151], a[176:179], a[84:87], v[148:151]
    ds_read_b64_tr_b16 a[172:173], v17 offset:40960
    v_accvgpr_write_b32 a5, 0
    v_mfma_f32_16x16x32_bf16 v[148:151], a[180:183], a[92:95], v[148:151]
    s_waitcnt lgkmcnt(9)
    buffer_load_dwordx4 v43, s[16:19], s49 offen offset:1024 lds
    v_mfma_f32_16x16x32_bf16 v[152:155], a[184:187], a[80:83], v[152:155]
    s_waitcnt lgkmcnt(7)
    ds_read_b64_tr_b16 a[174:175], v17 offset:45056
    ds_read_b64_tr_b16 a[176:177], v18 offset:32768
    v_mfma_f32_16x16x32_bf16 v[152:155], a[188:191], a[88:91], v[152:155]
    ds_read_b64_tr_b16 a[178:179], v18 offset:36864
    v_accvgpr_write_b32 a6, 0
    v_mfma_f32_16x16x32_bf16 v[156:159], a[184:187], a[84:87], v[156:159]
    ds_read_b64_tr_b16 a[180:181], v18 offset:40960
    v_accvgpr_write_b32 a7, 0
    v_mfma_f32_16x16x32_bf16 v[156:159], a[188:191], a[92:95], v[156:159]
    s_waitcnt lgkmcnt(9)
    buffer_load_dwordx4 v44, s[16:19], s49 offen offset:2048 lds
    v_mfma_f32_16x16x32_bf16 v[160:163], a[160:163], a[80:83], v[160:163]
    s_waitcnt lgkmcnt(7)
    ds_read_b64_tr_b16 a[182:183], v18 offset:45056
    ds_read_b64_tr_b16 a[184:185], v19 offset:32768
    v_mfma_f32_16x16x32_bf16 v[160:163], a[164:167], a[88:91], v[160:163]
    ds_read_b64_tr_b16 a[186:187], v19 offset:36864
    v_accvgpr_write_b32 a8, 0
    v_mfma_f32_16x16x32_bf16 v[164:167], a[160:163], a[84:87], v[164:167]
    ds_read_b64_tr_b16 a[188:189], v19 offset:40960
    v_accvgpr_write_b32 a9, 0
    v_mfma_f32_16x16x32_bf16 v[164:167], a[164:167], a[92:95], v[164:167]
    s_waitcnt lgkmcnt(9)
    buffer_load_dwordx4 v45, s[16:19], s49 offen offset:3072 lds
    v_mfma_f32_16x16x32_bf16 v[168:171], a[168:171], a[80:83], v[168:171]
    s_waitcnt lgkmcnt(7)
    ds_read_b64_tr_b16 a[190:191], v19 offset:45056
    ds_read_b64_tr_b16 a[160:161], v12 offset:49152
    v_mfma_f32_16x16x32_bf16 v[168:171], a[172:175], a[88:91], v[168:171]
    s_add_u32 s49, s44, 3670272
    ds_read_b64_tr_b16 a[162:163], v12 offset:53248
    v_accvgpr_write_b32 a10, 0
    v_mfma_f32_16x16x32_bf16 v[172:175], a[168:171], a[84:87], v[172:175]
    s_add_u32 m0, s42, 114688
    ds_read_b64_tr_b16 a[164:165], v12 offset:57344
    v_accvgpr_write_b32 a11, 0
    v_mfma_f32_16x16x32_bf16 v[172:175], a[172:175], a[92:95], v[172:175]
    s_waitcnt lgkmcnt(9)
    buffer_load_dwordx4 v42, s[16:19], s49 offen lds
    v_mfma_f32_16x16x32_bf16 v[176:179], a[176:179], a[80:83], v[176:179]
    s_waitcnt lgkmcnt(7)
    ds_read_b64_tr_b16 a[166:167], v12 offset:61440
    ds_read_b64_tr_b16 a[168:169], v13 offset:49152
    v_mfma_f32_16x16x32_bf16 v[176:179], a[180:183], a[88:91], v[176:179]
    ds_read_b64_tr_b16 a[170:171], v13 offset:53248
    v_accvgpr_write_b32 a12, 0
    v_mfma_f32_16x16x32_bf16 v[180:183], a[176:179], a[84:87], v[180:183]
    ds_read_b64_tr_b16 a[172:173], v13 offset:57344
    v_accvgpr_write_b32 a13, 0
    v_mfma_f32_16x16x32_bf16 v[180:183], a[180:183], a[92:95], v[180:183]
    s_waitcnt lgkmcnt(9)
    buffer_load_dwordx4 v43, s[16:19], s49 offen offset:1024 lds
    v_mfma_f32_16x16x32_bf16 v[184:187], a[184:187], a[80:83], v[184:187]
    s_waitcnt lgkmcnt(7)
    ds_read_b64_tr_b16 a[174:175], v13 offset:61440
    ds_read_b64_tr_b16 a[176:177], v14 offset:49152
    v_mfma_f32_16x16x32_bf16 v[184:187], a[188:191], a[88:91], v[184:187]
    ds_read_b64_tr_b16 a[178:179], v14 offset:53248
    v_accvgpr_write_b32 a14, 0
    v_mfma_f32_16x16x32_bf16 v[188:191], a[184:187], a[84:87], v[188:191]
    ds_read_b64_tr_b16 a[180:181], v14 offset:57344
    v_accvgpr_write_b32 a15, 0
    v_mfma_f32_16x16x32_bf16 v[188:191], a[188:191], a[92:95], v[188:191]
    s_waitcnt lgkmcnt(9)
    buffer_load_dwordx4 v44, s[16:19], s49 offen offset:2048 lds
    v_mfma_f32_16x16x32_bf16 v[192:195], a[160:163], a[80:83], v[192:195]
    s_waitcnt lgkmcnt(7)
    ds_read_b64_tr_b16 a[182:183], v14 offset:61440
    ds_read_b64_tr_b16 a[184:185], v15 offset:49152
    v_mfma_f32_16x16x32_bf16 v[192:195], a[164:167], a[88:91], v[192:195]
    ds_read_b64_tr_b16 a[186:187], v15 offset:53248
    v_accvgpr_write_b32 a16, 0
    v_mfma_f32_16x16x32_bf16 v[196:199], a[160:163], a[84:87], v[196:199]
    ds_read_b64_tr_b16 a[188:189], v15 offset:57344
    v_accvgpr_write_b32 a17, 0
    v_mfma_f32_16x16x32_bf16 v[196:199], a[164:167], a[92:95], v[196:199]
    s_waitcnt lgkmcnt(9)
    buffer_load_dwordx4 v45, s[16:19], s49 offen offset:3072 lds
    v_mfma_f32_16x16x32_bf16 v[200:203], a[168:171], a[80:83], v[200:203]
    s_waitcnt lgkmcnt(7)
    ds_read_b64_tr_b16 a[190:191], v15 offset:61440
    ds_read_b64_tr_b16 a[160:161], v16 offset:49152
    v_mfma_f32_16x16x32_bf16 v[200:203], a[172:175], a[88:91], v[200:203]
    ds_read_b64_tr_b16 a[162:163], v16 offset:53248
    v_accvgpr_write_b32 a18, 0
    v_mfma_f32_16x16x32_bf16 v[204:207], a[168:171], a[84:87], v[204:207]
    ds_read_b64_tr_b16 a[164:165], v16 offset:57344
    v_accvgpr_write_b32 a19, 0
    v_mfma_f32_16x16x32_bf16 v[204:207], a[172:175], a[92:95], v[204:207]
    s_waitcnt lgkmcnt(9)
    ds_read_b64_tr_b16 a[166:167], v16 offset:61440
    v_accvgpr_write_b32 a20, 0
    v_mfma_f32_16x16x32_bf16 v[208:211], a[176:179], a[80:83], v[208:211]
    s_waitcnt lgkmcnt(8)
    ds_read_b64_tr_b16 a[168:169], v17 offset:49152
    v_accvgpr_write_b32 a21, 0
    v_mfma_f32_16x16x32_bf16 v[208:211], a[180:183], a[88:91], v[208:211]
    ds_read_b64_tr_b16 a[170:171], v17 offset:53248
    v_accvgpr_write_b32 a22, 0
    v_mfma_f32_16x16x32_bf16 v[212:215], a[176:179], a[84:87], v[212:215]
    ds_read_b64_tr_b16 a[172:173], v17 offset:57344
    v_accvgpr_write_b32 a23, 0
    v_mfma_f32_16x16x32_bf16 v[212:215], a[180:183], a[92:95], v[212:215]
    s_waitcnt lgkmcnt(9)
    ds_read_b64_tr_b16 a[174:175], v17 offset:61440
    v_accvgpr_write_b32 a24, 0
    v_mfma_f32_16x16x32_bf16 v[216:219], a[184:187], a[80:83], v[216:219]
    s_waitcnt lgkmcnt(8)
    ds_read_b64_tr_b16 a[176:177], v18 offset:49152
    v_accvgpr_write_b32 a25, 0
    v_mfma_f32_16x16x32_bf16 v[216:219], a[188:191], a[88:91], v[216:219]
    ds_read_b64_tr_b16 a[178:179], v18 offset:53248
    v_accvgpr_write_b32 a26, 0
    v_mfma_f32_16x16x32_bf16 v[220:223], a[184:187], a[84:87], v[220:223]
    ds_read_b64_tr_b16 a[180:181], v18 offset:57344
    v_accvgpr_write_b32 a27, 0
    v_mfma_f32_16x16x32_bf16 v[220:223], a[188:191], a[92:95], v[220:223]
    s_waitcnt lgkmcnt(9)
    ds_read_b64_tr_b16 a[182:183], v18 offset:61440
    v_accvgpr_write_b32 a28, 0
    v_mfma_f32_16x16x32_bf16 v[224:227], a[160:163], a[80:83], v[224:227]
    s_waitcnt lgkmcnt(8)
    ds_read_b64_tr_b16 a[184:185], v19 offset:49152
    v_accvgpr_write_b32 a29, 0
    v_mfma_f32_16x16x32_bf16 v[224:227], a[164:167], a[88:91], v[224:227]
    ds_read_b64_tr_b16 a[186:187], v19 offset:53248
    v_accvgpr_write_b32 a30, 0
    v_mfma_f32_16x16x32_bf16 v[228:231], a[160:163], a[84:87], v[228:231]
    ds_read_b64_tr_b16 a[188:189], v19 offset:57344
    v_accvgpr_write_b32 a31, 0
    v_mfma_f32_16x16x32_bf16 v[228:231], a[164:167], a[92:95], v[228:231]
    s_waitcnt lgkmcnt(9)
    ds_read_b64_tr_b16 a[190:191], v19 offset:61440
    v_accvgpr_write_b32 a32, 0
    s_waitcnt vmcnt(12)
    s_barrier
    v_mfma_f32_16x16x32_bf16 v[232:235], a[168:171], a[80:83], v[232:235]
    s_waitcnt lgkmcnt(8)
    ds_read_b64_tr_b16 a[160:161], v20 offset:0
    v_accvgpr_write_b32 a33, 0
    v_mfma_f32_16x16x32_bf16 v[232:235], a[172:175], a[88:91], v[232:235]
    ds_read_b64_tr_b16 a[162:163], v20 offset:4096
    v_accvgpr_write_b32 a34, 0
    v_mfma_f32_16x16x32_bf16 v[236:239], a[168:171], a[84:87], v[236:239]
    ds_read_b64_tr_b16 a[164:165], v20 offset:8192
    v_accvgpr_write_b32 a35, 0
    v_mfma_f32_16x16x32_bf16 v[236:239], a[172:175], a[92:95], v[236:239]
    s_waitcnt lgkmcnt(9)
    buffer_load_dwordx4 a[128:131], v51, s[24:27], s46 offen offset:2048 sc1
    v_mfma_f32_16x16x32_bf16 v[240:243], a[176:179], a[80:83], v[240:243]
    s_waitcnt lgkmcnt(7)
    ds_read_b64_tr_b16 a[166:167], v20 offset:12288
    ds_read_b64_tr_b16 a[168:169], v21 offset:0
    v_mfma_f32_16x16x32_bf16 v[240:243], a[180:183], a[88:91], v[240:243]
    ds_read_b64_tr_b16 a[170:171], v21 offset:4096
    v_accvgpr_write_b32 a36, 0
    v_mfma_f32_16x16x32_bf16 v[244:247], a[176:179], a[84:87], v[244:247]
    ds_read_b64_tr_b16 a[172:173], v21 offset:8192
    v_accvgpr_write_b32 a37, 0
    v_mfma_f32_16x16x32_bf16 v[244:247], a[180:183], a[92:95], v[244:247]
    s_waitcnt lgkmcnt(9)
    buffer_load_dwordx4 a[136:139], v51, s[24:27], s46 offen offset:2176 sc1
    v_mfma_f32_16x16x32_bf16 v[248:251], a[184:187], a[80:83], v[248:251]
    s_waitcnt lgkmcnt(7)
    ds_read_b64_tr_b16 a[174:175], v21 offset:12288
    ds_read_b64_tr_b16 a[176:177], v22 offset:0
    v_mfma_f32_16x16x32_bf16 v[248:251], a[188:191], a[88:91], v[248:251]
    ds_read_b64_tr_b16 a[178:179], v22 offset:4096
    v_accvgpr_write_b32 a38, 0
    v_mfma_f32_16x16x32_bf16 v[252:255], a[184:187], a[84:87], v[252:255]
    ds_read_b64_tr_b16 a[180:181], v22 offset:8192
    v_accvgpr_write_b32 a39, 0
    v_mfma_f32_16x16x32_bf16 v[252:255], a[188:191], a[92:95], v[252:255]
    s_waitcnt lgkmcnt(9)
    buffer_load_dwordx4 a[132:135], v51, s[24:27], s43 offen offset:2048 sc1
    v_mfma_f32_16x16x32_bf16 v[128:131], a[160:163], a[96:99], v[128:131]
    s_waitcnt lgkmcnt(7)
    ds_read_b64_tr_b16 a[182:183], v22 offset:12288
    ds_read_b64_tr_b16 a[184:185], v23 offset:0
    v_mfma_f32_16x16x32_bf16 v[128:131], a[164:167], a[104:107], v[128:131]
    ds_read_b64_tr_b16 a[186:187], v23 offset:4096
    v_accvgpr_write_b32 a40, 0
    v_mfma_f32_16x16x32_bf16 v[132:135], a[160:163], a[100:103], v[132:135]
    ds_read_b64_tr_b16 a[188:189], v23 offset:8192
    v_accvgpr_write_b32 a41, 0
    v_mfma_f32_16x16x32_bf16 v[132:135], a[164:167], a[108:111], v[132:135]
    s_waitcnt lgkmcnt(9)
    buffer_load_dwordx4 a[140:143], v51, s[24:27], s43 offen offset:2176 sc1
    v_mfma_f32_16x16x32_bf16 v[136:139], a[168:171], a[96:99], v[136:139]
    s_waitcnt lgkmcnt(7)
    ds_read_b64_tr_b16 a[190:191], v23 offset:12288
    ds_read_b64_tr_b16 a[160:161], v24 offset:0
    v_mfma_f32_16x16x32_bf16 v[136:139], a[172:175], a[104:107], v[136:139]
    s_add_u32 s49, s44, 4194304
    ds_read_b64_tr_b16 a[162:163], v24 offset:4096
    v_accvgpr_write_b32 a42, 0
    v_mfma_f32_16x16x32_bf16 v[140:143], a[168:171], a[100:103], v[140:143]
    s_add_u32 m0, s42, 131072
    ds_read_b64_tr_b16 a[164:165], v24 offset:8192
    v_accvgpr_write_b32 a43, 0
    v_mfma_f32_16x16x32_bf16 v[140:143], a[172:175], a[108:111], v[140:143]
    s_waitcnt lgkmcnt(9)
    buffer_load_dwordx4 v42, s[16:19], s49 offen lds
    v_mfma_f32_16x16x32_bf16 v[144:147], a[176:179], a[96:99], v[144:147]
    s_waitcnt lgkmcnt(7)
    ds_read_b64_tr_b16 a[166:167], v24 offset:12288
    ds_read_b64_tr_b16 a[168:169], v25 offset:0
    v_mfma_f32_16x16x32_bf16 v[144:147], a[180:183], a[104:107], v[144:147]
    ds_read_b64_tr_b16 a[170:171], v25 offset:4096
    v_accvgpr_write_b32 a44, 0
    v_mfma_f32_16x16x32_bf16 v[148:151], a[176:179], a[100:103], v[148:151]
    ds_read_b64_tr_b16 a[172:173], v25 offset:8192
    v_accvgpr_write_b32 a45, 0
    v_mfma_f32_16x16x32_bf16 v[148:151], a[180:183], a[108:111], v[148:151]
    s_waitcnt lgkmcnt(9)
    buffer_load_dwordx4 v43, s[16:19], s49 offen offset:1024 lds
    v_mfma_f32_16x16x32_bf16 v[152:155], a[184:187], a[96:99], v[152:155]
    s_waitcnt lgkmcnt(7)
    ds_read_b64_tr_b16 a[174:175], v25 offset:12288
    ds_read_b64_tr_b16 a[176:177], v26 offset:0
    v_mfma_f32_16x16x32_bf16 v[152:155], a[188:191], a[104:107], v[152:155]
    ds_read_b64_tr_b16 a[178:179], v26 offset:4096
    v_accvgpr_write_b32 a46, 0
    v_mfma_f32_16x16x32_bf16 v[156:159], a[184:187], a[100:103], v[156:159]
    ds_read_b64_tr_b16 a[180:181], v26 offset:8192
    v_accvgpr_write_b32 a47, 0
    v_mfma_f32_16x16x32_bf16 v[156:159], a[188:191], a[108:111], v[156:159]
    s_waitcnt lgkmcnt(9)
    buffer_load_dwordx4 v44, s[16:19], s49 offen offset:2048 lds
    v_mfma_f32_16x16x32_bf16 v[160:163], a[160:163], a[96:99], v[160:163]
    s_waitcnt lgkmcnt(7)
    ds_read_b64_tr_b16 a[182:183], v26 offset:12288
    ds_read_b64_tr_b16 a[184:185], v27 offset:0
    v_mfma_f32_16x16x32_bf16 v[160:163], a[164:167], a[104:107], v[160:163]
    ds_read_b64_tr_b16 a[186:187], v27 offset:4096
    v_accvgpr_write_b32 a48, 0
    v_mfma_f32_16x16x32_bf16 v[164:167], a[160:163], a[100:103], v[164:167]
    ds_read_b64_tr_b16 a[188:189], v27 offset:8192
    v_accvgpr_write_b32 a49, 0
    v_mfma_f32_16x16x32_bf16 v[164:167], a[164:167], a[108:111], v[164:167]
    s_waitcnt lgkmcnt(9)
    buffer_load_dwordx4 v45, s[16:19], s49 offen offset:3072 lds
    v_mfma_f32_16x16x32_bf16 v[168:171], a[168:171], a[96:99], v[168:171]
    s_waitcnt lgkmcnt(7)
    ds_read_b64_tr_b16 a[190:191], v27 offset:12288
    ds_read_b64_tr_b16 a[160:161], v20 offset:16384
    v_mfma_f32_16x16x32_bf16 v[168:171], a[172:175], a[104:107], v[168:171]
    s_add_u32 s49, s44, 4194560
    ds_read_b64_tr_b16 a[162:163], v20 offset:20480
    v_accvgpr_write_b32 a50, 0
    v_mfma_f32_16x16x32_bf16 v[172:175], a[168:171], a[100:103], v[172:175]
    s_add_u32 m0, s42, 147456
    ds_read_b64_tr_b16 a[164:165], v20 offset:24576
    v_accvgpr_write_b32 a51, 0
    v_mfma_f32_16x16x32_bf16 v[172:175], a[172:175], a[108:111], v[172:175]
    s_waitcnt lgkmcnt(9)
    buffer_load_dwordx4 v42, s[16:19], s49 offen lds
    v_mfma_f32_16x16x32_bf16 v[176:179], a[176:179], a[96:99], v[176:179]
    s_waitcnt lgkmcnt(7)
    ds_read_b64_tr_b16 a[166:167], v20 offset:28672
    ds_read_b64_tr_b16 a[168:169], v21 offset:16384
    v_mfma_f32_16x16x32_bf16 v[176:179], a[180:183], a[104:107], v[176:179]
    ds_read_b64_tr_b16 a[170:171], v21 offset:20480
    v_accvgpr_write_b32 a52, 0
    v_mfma_f32_16x16x32_bf16 v[180:183], a[176:179], a[100:103], v[180:183]
    ds_read_b64_tr_b16 a[172:173], v21 offset:24576
    v_accvgpr_write_b32 a53, 0
    v_mfma_f32_16x16x32_bf16 v[180:183], a[180:183], a[108:111], v[180:183]
    s_waitcnt lgkmcnt(9)
    buffer_load_dwordx4 v43, s[16:19], s49 offen offset:1024 lds
    v_mfma_f32_16x16x32_bf16 v[184:187], a[184:187], a[96:99], v[184:187]
    s_waitcnt lgkmcnt(7)
    ds_read_b64_tr_b16 a[174:175], v21 offset:28672
    ds_read_b64_tr_b16 a[176:177], v22 offset:16384
    v_mfma_f32_16x16x32_bf16 v[184:187], a[188:191], a[104:107], v[184:187]
    ds_read_b64_tr_b16 a[178:179], v22 offset:20480
    v_accvgpr_write_b32 a54, 0
    v_mfma_f32_16x16x32_bf16 v[188:191], a[184:187], a[100:103], v[188:191]
    ds_read_b64_tr_b16 a[180:181], v22 offset:24576
    v_accvgpr_write_b32 a55, 0
    v_mfma_f32_16x16x32_bf16 v[188:191], a[188:191], a[108:111], v[188:191]
    s_waitcnt lgkmcnt(9)
    buffer_load_dwordx4 v44, s[16:19], s49 offen offset:2048 lds
    v_mfma_f32_16x16x32_bf16 v[192:195], a[160:163], a[96:99], v[192:195]
    s_waitcnt lgkmcnt(7)
    ds_read_b64_tr_b16 a[182:183], v22 offset:28672
    ds_read_b64_tr_b16 a[184:185], v23 offset:16384
    v_mfma_f32_16x16x32_bf16 v[192:195], a[164:167], a[104:107], v[192:195]
    ds_read_b64_tr_b16 a[186:187], v23 offset:20480
    v_accvgpr_write_b32 a56, 0
    v_mfma_f32_16x16x32_bf16 v[196:199], a[160:163], a[100:103], v[196:199]
    ds_read_b64_tr_b16 a[188:189], v23 offset:24576
    v_accvgpr_write_b32 a57, 0
    v_mfma_f32_16x16x32_bf16 v[196:199], a[164:167], a[108:111], v[196:199]
    s_waitcnt lgkmcnt(9)
    buffer_load_dwordx4 v45, s[16:19], s49 offen offset:3072 lds
    v_mfma_f32_16x16x32_bf16 v[200:203], a[168:171], a[96:99], v[200:203]
    s_waitcnt lgkmcnt(7)
    ds_read_b64_tr_b16 a[190:191], v23 offset:28672
    ds_read_b64_tr_b16 a[160:161], v24 offset:16384
    v_mfma_f32_16x16x32_bf16 v[200:203], a[172:175], a[104:107], v[200:203]
    ds_read_b64_tr_b16 a[162:163], v24 offset:20480
    v_accvgpr_write_b32 a58, 0
    v_mfma_f32_16x16x32_bf16 v[204:207], a[168:171], a[100:103], v[204:207]
    ds_read_b64_tr_b16 a[164:165], v24 offset:24576
    v_accvgpr_write_b32 a59, 0
    v_mfma_f32_16x16x32_bf16 v[204:207], a[172:175], a[108:111], v[204:207]
    s_waitcnt lgkmcnt(9)
    ds_read_b64_tr_b16 a[166:167], v24 offset:28672
    v_accvgpr_write_b32 a60, 0
    v_mfma_f32_16x16x32_bf16 v[208:211], a[176:179], a[96:99], v[208:211]
    s_waitcnt lgkmcnt(8)
    ds_read_b64_tr_b16 a[168:169], v25 offset:16384
    v_accvgpr_write_b32 a61, 0
    v_mfma_f32_16x16x32_bf16 v[208:211], a[180:183], a[104:107], v[208:211]
    ds_read_b64_tr_b16 a[170:171], v25 offset:20480
    v_accvgpr_write_b32 a62, 0
    v_mfma_f32_16x16x32_bf16 v[212:215], a[176:179], a[100:103], v[212:215]
    ds_read_b64_tr_b16 a[172:173], v25 offset:24576
    v_accvgpr_write_b32 a63, 0
    v_mfma_f32_16x16x32_bf16 v[212:215], a[180:183], a[108:111], v[212:215]
    s_waitcnt lgkmcnt(9)
    ds_read_b64_tr_b16 a[174:175], v25 offset:28672
    v_accvgpr_write_b32 a64, 0
    v_mfma_f32_16x16x32_bf16 v[216:219], a[184:187], a[96:99], v[216:219]
    s_waitcnt lgkmcnt(8)
    ds_read_b64_tr_b16 a[176:177], v26 offset:16384
    v_accvgpr_write_b32 a65, 0
    v_mfma_f32_16x16x32_bf16 v[216:219], a[188:191], a[104:107], v[216:219]
    ds_read_b64_tr_b16 a[178:179], v26 offset:20480
    v_accvgpr_write_b32 a66, 0
    v_mfma_f32_16x16x32_bf16 v[220:223], a[184:187], a[100:103], v[220:223]
    ds_read_b64_tr_b16 a[180:181], v26 offset:24576
    v_accvgpr_write_b32 a67, 0
    v_mfma_f32_16x16x32_bf16 v[220:223], a[188:191], a[108:111], v[220:223]
    s_waitcnt lgkmcnt(9)
    ds_read_b64_tr_b16 a[182:183], v26 offset:28672
    v_accvgpr_write_b32 a68, 0
    v_mfma_f32_16x16x32_bf16 v[224:227], a[160:163], a[96:99], v[224:227]
    s_waitcnt lgkmcnt(8)
    ds_read_b64_tr_b16 a[184:185], v27 offset:16384
    v_accvgpr_write_b32 a69, 0
    v_mfma_f32_16x16x32_bf16 v[224:227], a[164:167], a[104:107], v[224:227]
    ds_read_b64_tr_b16 a[186:187], v27 offset:20480
    v_accvgpr_write_b32 a70, 0
    v_mfma_f32_16x16x32_bf16 v[228:231], a[160:163], a[100:103], v[228:231]
    ds_read_b64_tr_b16 a[188:189], v27 offset:24576
    v_accvgpr_write_b32 a71, 0
    v_mfma_f32_16x16x32_bf16 v[228:231], a[164:167], a[108:111], v[228:231]
    s_waitcnt lgkmcnt(9)
    ds_read_b64_tr_b16 a[190:191], v27 offset:28672
    v_accvgpr_write_b32 a72, 0
    s_waitcnt vmcnt(12)
    s_barrier
    v_mfma_f32_16x16x32_bf16 v[232:235], a[168:171], a[96:99], v[232:235]
    s_waitcnt lgkmcnt(8)
    ds_read_b64_tr_b16 a[160:161], v20 offset:32768
    v_accvgpr_write_b32 a73, 0
    v_mfma_f32_16x16x32_bf16 v[232:235], a[172:175], a[104:107], v[232:235]
    ds_read_b64_tr_b16 a[162:163], v20 offset:36864
    v_accvgpr_write_b32 a74, 0
    v_mfma_f32_16x16x32_bf16 v[236:239], a[168:171], a[100:103], v[236:239]
    s_add_u32 m0, s42, 0
    ds_read_b64_tr_b16 a[164:165], v20 offset:40960
    v_accvgpr_write_b32 a75, 0
    v_mfma_f32_16x16x32_bf16 v[236:239], a[172:175], a[108:111], v[236:239]
    s_waitcnt lgkmcnt(9)
    buffer_load_dwordx4 v36, s[8:11], s40 offen lds
    v_mfma_f32_16x16x32_bf16 v[240:243], a[176:179], a[96:99], v[240:243]
    s_waitcnt lgkmcnt(7)
    ds_read_b64_tr_b16 a[166:167], v20 offset:45056
    ds_read_b64_tr_b16 a[168:169], v21 offset:32768
    v_mfma_f32_16x16x32_bf16 v[240:243], a[180:183], a[104:107], v[240:243]
    ds_read_b64_tr_b16 a[170:171], v21 offset:36864
    v_accvgpr_write_b32 a76, 0
    v_mfma_f32_16x16x32_bf16 v[244:247], a[176:179], a[100:103], v[244:247]
    ds_read_b64_tr_b16 a[172:173], v21 offset:40960
    v_accvgpr_write_b32 a77, 0
    v_mfma_f32_16x16x32_bf16 v[244:247], a[180:183], a[108:111], v[244:247]
    s_waitcnt lgkmcnt(9)
    buffer_load_dwordx4 v37, s[8:11], s40 offen offset:1024 lds
    v_mfma_f32_16x16x32_bf16 v[248:251], a[184:187], a[96:99], v[248:251]
    s_waitcnt lgkmcnt(7)
    ds_read_b64_tr_b16 a[174:175], v21 offset:45056
    ds_read_b64_tr_b16 a[176:177], v22 offset:32768
    v_mfma_f32_16x16x32_bf16 v[248:251], a[188:191], a[104:107], v[248:251]
    ds_read_b64_tr_b16 a[178:179], v22 offset:36864
    v_accvgpr_write_b32 a78, 0
    v_mfma_f32_16x16x32_bf16 v[252:255], a[184:187], a[100:103], v[252:255]
    ds_read_b64_tr_b16 a[180:181], v22 offset:40960
    v_accvgpr_write_b32 a79, 0
    v_mfma_f32_16x16x32_bf16 v[252:255], a[188:191], a[108:111], v[252:255]
    s_waitcnt lgkmcnt(9)
    buffer_load_dwordx4 v38, s[8:11], s40 offen offset:2048 lds
    v_mfma_f32_16x16x32_bf16 v[128:131], a[160:163], a[112:115], v[128:131]
    s_waitcnt lgkmcnt(7)
    ds_read_b64_tr_b16 a[182:183], v22 offset:45056
    ds_read_b64_tr_b16 a[184:185], v23 offset:32768
    v_mfma_f32_16x16x32_bf16 v[128:131], a[164:167], a[120:123], v[128:131]
    ds_read_b64_tr_b16 a[186:187], v23 offset:36864
    v_accvgpr_write_b32 a80, 0
    v_mfma_f32_16x16x32_bf16 v[132:135], a[160:163], a[116:119], v[132:135]
    ds_read_b64_tr_b16 a[188:189], v23 offset:40960
    v_accvgpr_write_b32 a81, 0
    v_mfma_f32_16x16x32_bf16 v[132:135], a[164:167], a[124:127], v[132:135]
    s_waitcnt lgkmcnt(9)
    buffer_load_dwordx4 v39, s[8:11], s40 offen offset:3072 lds
    v_mfma_f32_16x16x32_bf16 v[136:139], a[168:171], a[112:115], v[136:139]
    s_waitcnt lgkmcnt(7)
    s_add_u32 s40, s40, 16384
    ds_read_b64_tr_b16 a[190:191], v23 offset:45056
    ds_read_b64_tr_b16 a[160:161], v24 offset:32768
    v_mfma_f32_16x16x32_bf16 v[136:139], a[172:175], a[120:123], v[136:139]
    ds_read_b64_tr_b16 a[162:163], v24 offset:36864
    v_accvgpr_write_b32 a82, 0
    v_mfma_f32_16x16x32_bf16 v[140:143], a[168:171], a[116:119], v[140:143]
    s_add_u32 m0, s42, 16384
    ds_read_b64_tr_b16 a[164:165], v24 offset:40960
    v_accvgpr_write_b32 a83, 0
    v_mfma_f32_16x16x32_bf16 v[140:143], a[172:175], a[124:127], v[140:143]
    s_waitcnt lgkmcnt(9)
    buffer_load_dwordx4 v36, s[8:11], s40 offen lds
    v_mfma_f32_16x16x32_bf16 v[144:147], a[176:179], a[112:115], v[144:147]
    s_waitcnt lgkmcnt(7)
    ds_read_b64_tr_b16 a[166:167], v24 offset:45056
    ds_read_b64_tr_b16 a[168:169], v25 offset:32768
    v_mfma_f32_16x16x32_bf16 v[144:147], a[180:183], a[120:123], v[144:147]
    ds_read_b64_tr_b16 a[170:171], v25 offset:36864
    v_accvgpr_write_b32 a84, 0
    v_mfma_f32_16x16x32_bf16 v[148:151], a[176:179], a[116:119], v[148:151]
    ds_read_b64_tr_b16 a[172:173], v25 offset:40960
    v_accvgpr_write_b32 a85, 0
    v_mfma_f32_16x16x32_bf16 v[148:151], a[180:183], a[124:127], v[148:151]
    s_waitcnt lgkmcnt(9)
    buffer_load_dwordx4 v37, s[8:11], s40 offen offset:1024 lds
    v_mfma_f32_16x16x32_bf16 v[152:155], a[184:187], a[112:115], v[152:155]
    s_waitcnt lgkmcnt(7)
    ds_read_b64_tr_b16 a[174:175], v25 offset:45056
    ds_read_b64_tr_b16 a[176:177], v26 offset:32768
    v_mfma_f32_16x16x32_bf16 v[152:155], a[188:191], a[120:123], v[152:155]
    ds_read_b64_tr_b16 a[178:179], v26 offset:36864
    v_accvgpr_write_b32 a86, 0
    v_mfma_f32_16x16x32_bf16 v[156:159], a[184:187], a[116:119], v[156:159]
    ds_read_b64_tr_b16 a[180:181], v26 offset:40960
    v_accvgpr_write_b32 a87, 0
    v_mfma_f32_16x16x32_bf16 v[156:159], a[188:191], a[124:127], v[156:159]
    s_waitcnt lgkmcnt(9)
    buffer_load_dwordx4 v38, s[8:11], s40 offen offset:2048 lds
    v_mfma_f32_16x16x32_bf16 v[160:163], a[160:163], a[112:115], v[160:163]
    s_waitcnt lgkmcnt(7)
    ds_read_b64_tr_b16 a[182:183], v26 offset:45056
    ds_read_b64_tr_b16 a[184:185], v27 offset:32768
    v_mfma_f32_16x16x32_bf16 v[160:163], a[164:167], a[120:123], v[160:163]
    ds_read_b64_tr_b16 a[186:187], v27 offset:36864
    v_accvgpr_write_b32 a88, 0
    v_mfma_f32_16x16x32_bf16 v[164:167], a[160:163], a[116:119], v[164:167]
    ds_read_b64_tr_b16 a[188:189], v27 offset:40960
    v_accvgpr_write_b32 a89, 0
    v_mfma_f32_16x16x32_bf16 v[164:167], a[164:167], a[124:127], v[164:167]
    s_waitcnt lgkmcnt(9)
    buffer_load_dwordx4 v39, s[8:11], s40 offen offset:3072 lds
    v_mfma_f32_16x16x32_bf16 v[168:171], a[168:171], a[112:115], v[168:171]
    s_waitcnt lgkmcnt(7)
    s_add_u32 s40, s40, 16384
    ds_read_b64_tr_b16 a[190:191], v27 offset:45056
    ds_read_b64_tr_b16 a[160:161], v20 offset:49152
    v_mfma_f32_16x16x32_bf16 v[168:171], a[172:175], a[120:123], v[168:171]
    ds_read_b64_tr_b16 a[162:163], v20 offset:53248
    v_accvgpr_write_b32 a90, 0
    v_mfma_f32_16x16x32_bf16 v[172:175], a[168:171], a[116:119], v[172:175]
    ds_read_b64_tr_b16 a[164:165], v20 offset:57344
    v_accvgpr_write_b32 a91, 0
    v_mfma_f32_16x16x32_bf16 v[172:175], a[172:175], a[124:127], v[172:175]
    s_waitcnt lgkmcnt(9)
    buffer_store_dword v76, v72, s[24:27], s92 offen offset:12 sc1
    v_mfma_f32_16x16x32_bf16 v[176:179], a[176:179], a[112:115], v[176:179]
    s_waitcnt lgkmcnt(7)
    ds_read_b64_tr_b16 a[166:167], v20 offset:61440
    ds_read_b64_tr_b16 a[168:169], v21 offset:49152
    v_mfma_f32_16x16x32_bf16 v[176:179], a[180:183], a[120:123], v[176:179]
    ds_read_b64_tr_b16 a[170:171], v21 offset:53248
    v_accvgpr_write_b32 a92, 0
    v_mfma_f32_16x16x32_bf16 v[180:183], a[176:179], a[116:119], v[180:183]
    ds_read_b64_tr_b16 a[172:173], v21 offset:57344
    v_accvgpr_write_b32 a93, 0
    v_mfma_f32_16x16x32_bf16 v[180:183], a[180:183], a[124:127], v[180:183]
    s_waitcnt lgkmcnt(9)
    buffer_store_dwordx4 v[88:91], v74, s[24:27], 0 offen sc1
    v_mfma_f32_16x16x32_bf16 v[184:187], a[184:187], a[112:115], v[184:187]
    s_waitcnt lgkmcnt(7)
    ds_read_b64_tr_b16 a[174:175], v21 offset:61440
    ds_read_b64_tr_b16 a[176:177], v22 offset:49152
    v_mfma_f32_16x16x32_bf16 v[184:187], a[188:191], a[120:123], v[184:187]
    ds_read_b64_tr_b16 a[178:179], v22 offset:53248
    v_accvgpr_write_b32 a94, 0
    v_mfma_f32_16x16x32_bf16 v[188:191], a[184:187], a[116:119], v[188:191]
    ds_read_b64_tr_b16 a[180:181], v22 offset:57344
    v_accvgpr_write_b32 a95, 0
    v_mfma_f32_16x16x32_bf16 v[188:191], a[188:191], a[124:127], v[188:191]
    s_waitcnt lgkmcnt(9)
    ds_read_b64_tr_b16 a[182:183], v22 offset:61440
    v_accvgpr_write_b32 a96, 0
    v_mfma_f32_16x16x32_bf16 v[192:195], a[160:163], a[112:115], v[192:195]
    s_waitcnt lgkmcnt(8)
    ds_read_b64_tr_b16 a[184:185], v23 offset:49152
    v_accvgpr_write_b32 a97, 0
    v_mfma_f32_16x16x32_bf16 v[192:195], a[164:167], a[120:123], v[192:195]
    ds_read_b64_tr_b16 a[186:187], v23 offset:53248
    v_accvgpr_write_b32 a98, 0
    v_mfma_f32_16x16x32_bf16 v[196:199], a[160:163], a[116:119], v[196:199]
    ds_read_b64_tr_b16 a[188:189], v23 offset:57344
    v_accvgpr_write_b32 a99, 0
    v_mfma_f32_16x16x32_bf16 v[196:199], a[164:167], a[124:127], v[196:199]
    s_waitcnt lgkmcnt(9)
    ds_read_b64_tr_b16 a[190:191], v23 offset:61440
    v_accvgpr_write_b32 a100, 0
    v_mfma_f32_16x16x32_bf16 v[200:203], a[168:171], a[112:115], v[200:203]
    s_waitcnt lgkmcnt(8)
    ds_read_b64_tr_b16 a[160:161], v24 offset:49152
Ltour2:
    s_cbranch_execz Ltour6
    v_accvgpr_write_b32 a101, 0
    v_mfma_f32_16x16x32_bf16 v[200:203], a[172:175], a[120:123], v[200:203]
    ds_read_b64_tr_b16 a[162:163], v24 offset:53248
    v_accvgpr_write_b32 a102, 0
    v_mfma_f32_16x16x32_bf16 v[204:207], a[168:171], a[116:119], v[204:207]
    ds_read_b64_tr_b16 a[164:165], v24 offset:57344
    v_accvgpr_write_b32 a103, 0
    v_mfma_f32_16x16x32_bf16 v[204:207], a[172:175], a[124:127], v[204:207]
    s_waitcnt lgkmcnt(9)
    ds_read_b64_tr_b16 a[166:167], v24 offset:61440
    v_accvgpr_write_b32 a104, 0
    v_mfma_f32_16x16x32_bf16 v[208:211], a[176:179], a[112:115], v[208:211]
    s_waitcnt lgkmcnt(8)
    ds_read_b64_tr_b16 a[168:169], v25 offset:49152
    v_accvgpr_write_b32 a105, 0
    v_mfma_f32_16x16x32_bf16 v[208:211], a[180:183], a[120:123], v[208:211]
    ds_read_b64_tr_b16 a[170:171], v25 offset:53248
    v_accvgpr_write_b32 a106, 0
    v_mfma_f32_16x16x32_bf16 v[212:215], a[176:179], a[116:119], v[212:215]
    ds_read_b64_tr_b16 a[172:173], v25 offset:57344
    v_accvgpr_write_b32 a107, 0
    v_mfma_f32_16x16x32_bf16 v[212:215], a[180:183], a[124:127], v[212:215]
    s_waitcnt lgkmcnt(9)
    ds_read_b64_tr_b16 a[174:175], v25 offset:61440
    v_accvgpr_write_b32 a108, 0
    v_mfma_f32_16x16x32_bf16 v[216:219], a[184:187], a[112:115], v[216:219]
    s_waitcnt lgkmcnt(8)
    ds_read_b64_tr_b16 a[176:177], v26 offset:49152
    v_accvgpr_write_b32 a109, 0
    v_mfma_f32_16x16x32_bf16 v[216:219], a[188:191], a[120:123], v[216:219]
    ds_read_b64_tr_b16 a[178:179], v26 offset:53248
    v_accvgpr_write_b32 a110, 0
    v_mfma_f32_16x16x32_bf16 v[220:223], a[184:187], a[116:119], v[220:223]
    ds_read_b64_tr_b16 a[180:181], v26 offset:57344
    v_accvgpr_write_b32 a111, 0
    v_mfma_f32_16x16x32_bf16 v[220:223], a[188:191], a[124:127], v[220:223]
    s_waitcnt lgkmcnt(9)
    ds_read_b64_tr_b16 a[182:183], v26 offset:61440
    v_accvgpr_write_b32 a192, 0
    v_mfma_f32_16x16x32_bf16 v[224:227], a[160:163], a[112:115], v[224:227]
    s_waitcnt lgkmcnt(8)
    ds_read_b64_tr_b16 a[184:185], v27 offset:49152
    v_accvgpr_write_b32 a193, 0
    v_mfma_f32_16x16x32_bf16 v[224:227], a[164:167], a[120:123], v[224:227]
    ds_read_b64_tr_b16 a[186:187], v27 offset:53248
    v_accvgpr_write_b32 a194, 0
    v_mfma_f32_16x16x32_bf16 v[228:231], a[160:163], a[116:119], v[228:231]
    ds_read_b64_tr_b16 a[188:189], v27 offset:57344
    v_accvgpr_write_b32 a195, 0
    v_mfma_f32_16x16x32_bf16 v[228:231], a[164:167], a[124:127], v[228:231]
    s_waitcnt lgkmcnt(9)
    ds_read_b64_tr_b16 a[190:191], v27 offset:61440
    v_accvgpr_write_b32 a196, 0
    s_waitcnt vmcnt(10)
    s_barrier
    v_mfma_f32_16x16x32_bf16 v[232:235], a[168:171], a[112:115], v[232:235]
    s_waitcnt lgkmcnt(8)
    ds_read_b64_tr_b16 a[160:161], v28 offset:0
    v_accvgpr_write_b32 a197, 0
    v_mfma_f32_16x16x32_bf16 v[232:235], a[172:175], a[120:123], v[232:235]
    ds_read_b64_tr_b16 a[162:163], v28 offset:4096
    v_accvgpr_write_b32 a198, 0
    v_mfma_f32_16x16x32_bf16 v[236:239], a[168:171], a[116:119], v[236:239]
    s_add_u32 m0, s42, 32768
    ds_read_b64_tr_b16 a[164:165], v28 offset:8192
    v_accvgpr_write_b32 a199, 0
    v_mfma_f32_16x16x32_bf16 v[236:239], a[172:175], a[124:127], v[236:239]
    s_waitcnt lgkmcnt(9)
    buffer_load_dwordx4 v36, s[8:11], s40 offen lds
    v_mfma_f32_16x16x32_bf16 v[240:243], a[176:179], a[112:115], v[240:243]
    s_waitcnt lgkmcnt(7)
    ds_read_b64_tr_b16 a[166:167], v28 offset:12288
    ds_read_b64_tr_b16 a[168:169], v29 offset:0
    v_mfma_f32_16x16x32_bf16 v[240:243], a[180:183], a[120:123], v[240:243]
    ds_read_b64_tr_b16 a[170:171], v29 offset:4096
    v_accvgpr_write_b32 a200, 0
    v_mfma_f32_16x16x32_bf16 v[244:247], a[176:179], a[116:119], v[244:247]
    ds_read_b64_tr_b16 a[172:173], v29 offset:8192
    v_accvgpr_write_b32 a201, 0
    v_mfma_f32_16x16x32_bf16 v[244:247], a[180:183], a[124:127], v[244:247]
    s_waitcnt lgkmcnt(9)
    buffer_load_dwordx4 v37, s[8:11], s40 offen offset:1024 lds
    v_mfma_f32_16x16x32_bf16 v[248:251], a[184:187], a[112:115], v[248:251]
    s_waitcnt lgkmcnt(7)
    ds_read_b64_tr_b16 a[174:175], v29 offset:12288
    ds_read_b64_tr_b16 a[176:177], v30 offset:0
    v_mfma_f32_16x16x32_bf16 v[248:251], a[188:191], a[120:123], v[248:251]
    ds_read_b64_tr_b16 a[178:179], v30 offset:4096
    v_accvgpr_write_b32 a202, 0
    v_mfma_f32_16x16x32_bf16 v[252:255], a[184:187], a[116:119], v[252:255]
    ds_read_b64_tr_b16 a[180:181], v30 offset:8192
    v_accvgpr_write_b32 a203, 0
    v_mfma_f32_16x16x32_bf16 v[252:255], a[188:191], a[124:127], v[252:255]
    s_waitcnt lgkmcnt(9)
    buffer_load_dwordx4 v38, s[8:11], s40 offen offset:2048 lds
    v_mfma_f32_16x16x32_bf16 v[128:131], a[160:163], a[128:131], v[128:131]
    s_waitcnt lgkmcnt(7)
    ds_read_b64_tr_b16 a[182:183], v30 offset:12288
    ds_read_b64_tr_b16 a[184:185], v31 offset:0
    v_mfma_f32_16x16x32_bf16 v[128:131], a[164:167], a[136:139], v[128:131]
    ds_read_b64_tr_b16 a[186:187], v31 offset:4096
    v_accvgpr_write_b32 a204, 0
    v_mfma_f32_16x16x32_bf16 v[132:135], a[160:163], a[132:135], v[132:135]
    ds_read_b64_tr_b16 a[188:189], v31 offset:8192
    v_accvgpr_write_b32 a205, 0
    v_mfma_f32_16x16x32_bf16 v[132:135], a[164:167], a[140:143], v[132:135]
    s_waitcnt lgkmcnt(9)
    buffer_load_dwordx4 v39, s[8:11], s40 offen offset:3072 lds
    v_mfma_f32_16x16x32_bf16 v[136:139], a[168:171], a[128:131], v[136:139]
    s_waitcnt lgkmcnt(7)
    s_add_u32 s40, s40, 16384
    ds_read_b64_tr_b16 a[190:191], v31 offset:12288
    ds_read_b64_tr_b16 a[160:161], v32 offset:0
    v_mfma_f32_16x16x32_bf16 v[136:139], a[172:175], a[136:139], v[136:139]
    ds_read_b64_tr_b16 a[162:163], v32 offset:4096
    v_accvgpr_write_b32 a206, 0
    v_mfma_f32_16x16x32_bf16 v[140:143], a[168:171], a[132:135], v[140:143]
    s_add_u32 m0, s42, 65536
    ds_read_b64_tr_b16 a[164:165], v32 offset:8192
    v_accvgpr_write_b32 a207, 0
    v_mfma_f32_16x16x32_bf16 v[140:143], a[172:175], a[140:143], v[140:143]
    s_waitcnt lgkmcnt(9)
    buffer_load_dwordx4 v40, s[12:15], s41 offen lds
    v_mfma_f32_16x16x32_bf16 v[144:147], a[176:179], a[128:131], v[144:147]
    s_waitcnt lgkmcnt(7)
    ds_read_b64_tr_b16 a[166:167], v32 offset:12288
    ds_read_b64_tr_b16 a[168:169], v33 offset:0
    v_mfma_f32_16x16x32_bf16 v[144:147], a[180:183], a[136:139], v[144:147]
    ds_read_b64_tr_b16 a[170:171], v33 offset:4096
    v_accvgpr_write_b32 a112, 0
    v_mfma_f32_16x16x32_bf16 v[148:151], a[176:179], a[132:135], v[148:151]
    ds_read_b64_tr_b16 a[172:173], v33 offset:8192
    v_accvgpr_write_b32 a113, 0
    v_mfma_f32_16x16x32_bf16 v[148:151], a[180:183], a[140:143], v[148:151]
    s_waitcnt lgkmcnt(9)
    buffer_load_dwordx4 v41, s[12:15], s41 offen offset:1024 lds
    v_mfma_f32_16x16x32_bf16 v[152:155], a[184:187], a[128:131], v[152:155]
    s_waitcnt lgkmcnt(7)
    ds_read_b64_tr_b16 a[174:175], v33 offset:12288
    ds_read_b64_tr_b16 a[176:177], v34 offset:0
    v_mfma_f32_16x16x32_bf16 v[152:155], a[188:191], a[136:139], v[152:155]
    ds_read_b64_tr_b16 a[178:179], v34 offset:4096
    v_accvgpr_write_b32 a114, 0
    v_mfma_f32_16x16x32_bf16 v[156:159], a[184:187], a[132:135], v[156:159]
    ds_read_b64_tr_b16 a[180:181], v34 offset:8192
    v_accvgpr_write_b32 a115, 0
    v_mfma_f32_16x16x32_bf16 v[156:159], a[188:191], a[140:143], v[156:159]
    s_waitcnt lgkmcnt(9)
    buffer_load_dwordx4 v40, s[12:15], s41 offen offset:2048 lds
    v_mfma_f32_16x16x32_bf16 v[160:163], a[160:163], a[128:131], v[160:163]
    s_waitcnt lgkmcnt(7)
    ds_read_b64_tr_b16 a[182:183], v34 offset:12288
    ds_read_b64_tr_b16 a[184:185], v35 offset:0
    v_mfma_f32_16x16x32_bf16 v[160:163], a[164:167], a[136:139], v[160:163]
    ds_read_b64_tr_b16 a[186:187], v35 offset:4096
    v_accvgpr_write_b32 a116, 0
    v_mfma_f32_16x16x32_bf16 v[164:167], a[160:163], a[132:135], v[164:167]
    ds_read_b64_tr_b16 a[188:189], v35 offset:8192
    v_accvgpr_write_b32 a117, 0
    v_mfma_f32_16x16x32_bf16 v[164:167], a[164:167], a[140:143], v[164:167]
    s_waitcnt lgkmcnt(9)
    buffer_load_dwordx4 v41, s[12:15], s41 offen offset:3072 lds
    v_mfma_f32_16x16x32_bf16 v[168:171], a[168:171], a[128:131], v[168:171]
    s_waitcnt lgkmcnt(7)
    s_add_u32 s41, s41, 16384
    ds_read_b64_tr_b16 a[190:191], v35 offset:12288
    ds_read_b64_tr_b16 a[160:161], v28 offset:16384
    v_mfma_f32_16x16x32_bf16 v[168:171], a[172:175], a[136:139], v[168:171]
    ds_read_b64_tr_b16 a[162:163], v28 offset:20480
    v_accvgpr_write_b32 a118, 0
    v_mfma_f32_16x16x32_bf16 v[172:175], a[168:171], a[132:135], v[172:175]
    s_add_u32 m0, s42, 81920
    ds_read_b64_tr_b16 a[164:165], v28 offset:24576
    v_accvgpr_write_b32 a119, 0
    v_mfma_f32_16x16x32_bf16 v[172:175], a[172:175], a[140:143], v[172:175]
    s_waitcnt lgkmcnt(9)
    buffer_load_dwordx4 v40, s[12:15], s41 offen lds
    v_mfma_f32_16x16x32_bf16 v[176:179], a[176:179], a[128:131], v[176:179]
    s_waitcnt lgkmcnt(7)
    ds_read_b64_tr_b16 a[166:167], v28 offset:28672
    ds_read_b64_tr_b16 a[168:169], v29 offset:16384
    v_mfma_f32_16x16x32_bf16 v[176:179], a[180:183], a[136:139], v[176:179]
    ds_read_b64_tr_b16 a[170:171], v29 offset:20480
    v_accvgpr_write_b32 a120, 0
    v_mfma_f32_16x16x32_bf16 v[180:183], a[176:179], a[132:135], v[180:183]
    ds_read_b64_tr_b16 a[172:173], v29 offset:24576
    v_accvgpr_write_b32 a121, 0
    v_mfma_f32_16x16x32_bf16 v[180:183], a[180:183], a[140:143], v[180:183]
    s_waitcnt lgkmcnt(9)
    buffer_load_dwordx4 v41, s[12:15], s41 offen offset:1024 lds
    v_mfma_f32_16x16x32_bf16 v[184:187], a[184:187], a[128:131], v[184:187]
    s_waitcnt lgkmcnt(7)
    ds_read_b64_tr_b16 a[174:175], v29 offset:28672
    ds_read_b64_tr_b16 a[176:177], v30 offset:16384
    v_mfma_f32_16x16x32_bf16 v[184:187], a[188:191], a[136:139], v[184:187]
    ds_read_b64_tr_b16 a[178:179], v30 offset:20480
    v_accvgpr_write_b32 a122, 0
    v_mfma_f32_16x16x32_bf16 v[188:191], a[184:187], a[132:135], v[188:191]
    ds_read_b64_tr_b16 a[180:181], v30 offset:24576
    v_accvgpr_write_b32 a123, 0
    v_mfma_f32_16x16x32_bf16 v[188:191], a[188:191], a[140:143], v[188:191]
    s_waitcnt lgkmcnt(9)
    buffer_load_dwordx4 v40, s[12:15], s41 offen offset:2048 lds
    v_mfma_f32_16x16x32_bf16 v[192:195], a[160:163], a[128:131], v[192:195]
    s_waitcnt lgkmcnt(7)
    ds_read_b64_tr_b16 a[182:183], v30 offset:28672
    ds_read_b64_tr_b16 a[184:185], v31 offset:16384
    v_mfma_f32_16x16x32_bf16 v[192:195], a[164:167], a[136:139], v[192:195]
    ds_read_b64_tr_b16 a[186:187], v31 offset:20480
    v_accvgpr_write_b32 a124, 0
    v_mfma_f32_16x16x32_bf16 v[196:199], a[160:163], a[132:135], v[196:199]
    ds_read_b64_tr_b16 a[188:189], v31 offset:24576
    v_accvgpr_write_b32 a125, 0
    v_mfma_f32_16x16x32_bf16 v[196:199], a[164:167], a[140:143], v[196:199]
    s_waitcnt lgkmcnt(9)
    buffer_load_dwordx4 v41, s[12:15], s41 offen offset:3072 lds
    v_mfma_f32_16x16x32_bf16 v[200:203], a[168:171], a[128:131], v[200:203]
    s_waitcnt lgkmcnt(7)
    s_add_u32 s41, s41, 16384
    ds_read_b64_tr_b16 a[190:191], v31 offset:28672
    ds_read_b64_tr_b16 a[160:161], v32 offset:16384
    v_mfma_f32_16x16x32_bf16 v[200:203], a[172:175], a[136:139], v[200:203]
    ds_read_b64_tr_b16 a[162:163], v32 offset:20480
    v_accvgpr_write_b32 a126, 0
    v_mfma_f32_16x16x32_bf16 v[204:207], a[168:171], a[132:135], v[204:207]
    ds_read_b64_tr_b16 a[164:165], v32 offset:24576
    v_accvgpr_write_b32 a127, 0
    v_mfma_f32_16x16x32_bf16 v[204:207], a[172:175], a[140:143], v[204:207]
    s_waitcnt lgkmcnt(9)
    ds_read_b64_tr_b16 a[166:167], v32 offset:28672
    v_mfma_f32_16x16x32_bf16 v[208:211], a[176:179], a[128:131], v[208:211]
    s_waitcnt lgkmcnt(8)
    ds_read_b64_tr_b16 a[168:169], v33 offset:16384
    v_mfma_f32_16x16x32_bf16 v[208:211], a[180:183], a[136:139], v[208:211]
    ds_read_b64_tr_b16 a[170:171], v33 offset:20480
    v_mfma_f32_16x16x32_bf16 v[212:215], a[176:179], a[132:135], v[212:215]
    ds_read_b64_tr_b16 a[172:173], v33 offset:24576
    v_mfma_f32_16x16x32_bf16 v[212:215], a[180:183], a[140:143], v[212:215]
    s_waitcnt lgkmcnt(9)
    ds_read_b64_tr_b16 a[174:175], v33 offset:28672
    v_mfma_f32_16x16x32_bf16 v[216:219], a[184:187], a[128:131], v[216:219]
    s_waitcnt lgkmcnt(8)
    ds_read_b64_tr_b16 a[176:177], v34 offset:16384
    v_mfma_f32_16x16x32_bf16 v[216:219], a[188:191], a[136:139], v[216:219]
    ds_read_b64_tr_b16 a[178:179], v34 offset:20480
    v_mfma_f32_16x16x32_bf16 v[220:223], a[184:187], a[132:135], v[220:223]
    ds_read_b64_tr_b16 a[180:181], v34 offset:24576
    v_mfma_f32_16x16x32_bf16 v[220:223], a[188:191], a[140:143], v[220:223]
    s_waitcnt lgkmcnt(9)
    ds_read_b64_tr_b16 a[182:183], v34 offset:28672
    v_mfma_f32_16x16x32_bf16 v[224:227], a[160:163], a[128:131], v[224:227]
    s_waitcnt lgkmcnt(8)
    ds_read_b64_tr_b16 a[184:185], v35 offset:16384
    v_mfma_f32_16x16x32_bf16 v[224:227], a[164:167], a[136:139], v[224:227]
    ds_read_b64_tr_b16 a[186:187], v35 offset:20480
    v_mfma_f32_16x16x32_bf16 v[228:231], a[160:163], a[132:135], v[228:231]
    ds_read_b64_tr_b16 a[188:189], v35 offset:24576
    v_mfma_f32_16x16x32_bf16 v[228:231], a[164:167], a[140:143], v[228:231]
    s_waitcnt lgkmcnt(9)
    ds_read_b64_tr_b16 a[190:191], v35 offset:28672
    v_mfma_f32_16x16x32_bf16 v[232:235], a[168:171], a[128:131], v[232:235]
    s_waitcnt lgkmcnt(8)
    v_mfma_f32_16x16x32_bf16 v[232:235], a[172:175], a[136:139], v[232:235]
    v_mfma_f32_16x16x32_bf16 v[236:239], a[168:171], a[132:135], v[236:239]
    v_mfma_f32_16x16x32_bf16 v[236:239], a[172:175], a[140:143], v[236:239]
    s_waitcnt lgkmcnt(6)
    s_waitcnt vmcnt(18)
    s_barrier
    v_mfma_f32_16x16x32_bf16 v[240:243], a[176:179], a[128:131], v[240:243]
    s_waitcnt lgkmcnt(4)
    ds_read_b128 a[208:211], v8 offset:0
    v_mfma_f32_16x16x32_bf16 v[240:243], a[180:183], a[136:139], v[240:243]
    ds_read_b128 a[212:215], v9 offset:0
    v_mfma_f32_16x16x32_bf16 v[244:247], a[176:179], a[132:135], v[244:247]
    ds_read_b128 a[216:219], v10 offset:0
    v_mfma_f32_16x16x32_bf16 v[244:247], a[180:183], a[140:143], v[244:247]
    s_waitcnt lgkmcnt(5)
    ds_read_b128 a[220:223], v11 offset:0
    v_mfma_f32_16x16x32_bf16 v[248:251], a[184:187], a[128:131], v[248:251]
    s_waitcnt lgkmcnt(4)
    ds_read_b128 a[224:227], v8 offset:4096
    v_mfma_f32_16x16x32_bf16 v[248:251], a[188:191], a[136:139], v[248:251]
    v_mfma_f32_16x16x32_bf16 v[252:255], a[184:187], a[132:135], v[252:255]
    s_load_dwordx2 s[16:17], s[0:1], 88
    v_mfma_f32_16x16x32_bf16 v[252:255], a[188:191], a[140:143], v[252:255]
    s_mov_b32 s36, 1040356334
    s_mov_b32 s37, 1040356334
    v_pk_mul_f32 v[128:129], v[128:129], s[36:37]
    v_pk_mul_f32 v[130:131], v[130:131], s[36:37]
    v_pk_mul_f32 v[136:137], v[136:137], s[36:37]
    v_pk_mul_f32 v[138:139], v[138:139], s[36:37]
    v_cvt_pk_bf16_f32 v64, v128, v129
    v_cvt_pk_bf16_f32 v65, v130, v131
    v_cvt_pk_bf16_f32 v66, v136, v137
    v_cvt_pk_bf16_f32 v67, v138, v139
    v_pk_mul_f32 v[132:133], v[132:133], s[36:37]
    v_pk_mul_f32 v[134:135], v[134:135], s[36:37]
    v_pk_mul_f32 v[140:141], v[140:141], s[36:37]
    v_pk_mul_f32 v[142:143], v[142:143], s[36:37]
    v_cvt_pk_bf16_f32 v80, v132, v133
    v_cvt_pk_bf16_f32 v81, v134, v135
    v_cvt_pk_bf16_f32 v82, v140, v141
    v_cvt_pk_bf16_f32 v83, v142, v143
    v_permlane32_swap_b32 v64, v66
    v_permlane32_swap_b32 v65, v67
    v_permlane32_swap_b32 v80, v82
    v_permlane32_swap_b32 v81, v83
    v_permlane16_swap_b32 v64, v66
    v_permlane16_swap_b32 v65, v67
    v_permlane16_swap_b32 v80, v82
    v_permlane16_swap_b32 v81, v83
    v_pk_mul_f32 v[144:145], v[144:145], s[36:37]
    v_pk_mul_f32 v[146:147], v[146:147], s[36:37]
    v_pk_mul_f32 v[152:153], v[152:153], s[36:37]
    v_pk_mul_f32 v[154:155], v[154:155], s[36:37]
    v_cvt_pk_bf16_f32 v68, v144, v145
    v_cvt_pk_bf16_f32 v69, v146, v147
    v_cvt_pk_bf16_f32 v70, v152, v153
    v_cvt_pk_bf16_f32 v71, v154, v155
    v_pk_mul_f32 v[148:149], v[148:149], s[36:37]
    v_pk_mul_f32 v[150:151], v[150:151], s[36:37]
    v_pk_mul_f32 v[156:157], v[156:157], s[36:37]
    v_pk_mul_f32 v[158:159], v[158:159], s[36:37]
    v_cvt_pk_bf16_f32 v84, v148, v149
    v_cvt_pk_bf16_f32 v85, v150, v151
    v_cvt_pk_bf16_f32 v86, v156, v157
    v_cvt_pk_bf16_f32 v87, v158, v159
    v_permlane32_swap_b32 v68, v70
    v_permlane32_swap_b32 v69, v71
    v_permlane32_swap_b32 v84, v86
    v_permlane32_swap_b32 v85, v87
    v_permlane16_swap_b32 v68, v70
    v_permlane16_swap_b32 v69, v71
    v_permlane16_swap_b32 v84, v86
    v_permlane16_swap_b32 v85, v87
    v_pk_mul_f32 v[160:161], v[160:161], s[36:37]
    v_pk_mul_f32 v[162:163], v[162:163], s[36:37]
    v_pk_mul_f32 v[168:169], v[168:169], s[36:37]
    v_pk_mul_f32 v[170:171], v[170:171], s[36:37]
    v_cvt_pk_bf16_f32 v72, v160, v161
    v_cvt_pk_bf16_f32 v73, v162, v163
    v_cvt_pk_bf16_f32 v74, v168, v169
    v_cvt_pk_bf16_f32 v75, v170, v171
    v_pk_mul_f32 v[164:165], v[164:165], s[36:37]
    v_pk_mul_f32 v[166:167], v[166:167], s[36:37]
    v_pk_mul_f32 v[172:173], v[172:173], s[36:37]
    v_pk_mul_f32 v[174:175], v[174:175], s[36:37]
    v_cvt_pk_bf16_f32 v88, v164, v165
    v_cvt_pk_bf16_f32 v89, v166, v167
    v_cvt_pk_bf16_f32 v90, v172, v173
    v_cvt_pk_bf16_f32 v91, v174, v175
    v_permlane32_swap_b32 v72, v74
    v_permlane32_swap_b32 v73, v75
    v_permlane32_swap_b32 v88, v90
    v_permlane32_swap_b32 v89, v91
    v_permlane16_swap_b32 v72, v74
    v_permlane16_swap_b32 v73, v75
    v_permlane16_swap_b32 v88, v90
    v_permlane16_swap_b32 v89, v91
    v_pk_mul_f32 v[176:177], v[176:177], s[36:37]
    v_pk_mul_f32 v[178:179], v[178:179], s[36:37]
    v_pk_mul_f32 v[184:185], v[184:185], s[36:37]
    v_pk_mul_f32 v[186:187], v[186:187], s[36:37]
    v_cvt_pk_bf16_f32 v76, v176, v177
    v_cvt_pk_bf16_f32 v77, v178, v179
    v_cvt_pk_bf16_f32 v78, v184, v185
    v_cvt_pk_bf16_f32 v79, v186, v187
    v_pk_mul_f32 v[180:181], v[180:181], s[36:37]
    v_pk_mul_f32 v[182:183], v[182:183], s[36:37]
    v_pk_mul_f32 v[188:189], v[188:189], s[36:37]
    v_pk_mul_f32 v[190:191], v[190:191], s[36:37]
    v_cvt_pk_bf16_f32 v92, v180, v181
    v_cvt_pk_bf16_f32 v93, v182, v183
    v_cvt_pk_bf16_f32 v94, v188, v189
    v_cvt_pk_bf16_f32 v95, v190, v191
    v_permlane32_swap_b32 v76, v78
    v_permlane32_swap_b32 v77, v79
    v_permlane32_swap_b32 v92, v94
    v_permlane32_swap_b32 v93, v95
    v_permlane16_swap_b32 v76, v78
    v_permlane16_swap_b32 v77, v79
    v_permlane16_swap_b32 v92, v94
    v_permlane16_swap_b32 v93, v95
    v_pk_mul_f32 v[192:193], v[192:193], s[36:37]
    v_pk_mul_f32 v[194:195], v[194:195], s[36:37]
    v_pk_mul_f32 v[200:201], v[200:201], s[36:37]
    v_pk_mul_f32 v[202:203], v[202:203], s[36:37]
    v_cvt_pk_bf16_f32 v96, v192, v193
    v_cvt_pk_bf16_f32 v97, v194, v195
    v_cvt_pk_bf16_f32 v98, v200, v201
    v_cvt_pk_bf16_f32 v99, v202, v203
    v_pk_mul_f32 v[196:197], v[196:197], s[36:37]
    v_pk_mul_f32 v[198:199], v[198:199], s[36:37]
    v_pk_mul_f32 v[204:205], v[204:205], s[36:37]
    v_pk_mul_f32 v[206:207], v[206:207], s[36:37]
    v_cvt_pk_bf16_f32 v112, v196, v197
    v_cvt_pk_bf16_f32 v113, v198, v199
    v_cvt_pk_bf16_f32 v114, v204, v205
    v_cvt_pk_bf16_f32 v115, v206, v207
    v_permlane32_swap_b32 v96, v98
    v_permlane32_swap_b32 v97, v99
    v_permlane32_swap_b32 v112, v114
    v_permlane32_swap_b32 v113, v115
    v_permlane16_swap_b32 v96, v98
    v_permlane16_swap_b32 v97, v99
    v_permlane16_swap_b32 v112, v114
    v_permlane16_swap_b32 v113, v115
    v_pk_mul_f32 v[208:209], v[208:209], s[36:37]
    v_pk_mul_f32 v[210:211], v[210:211], s[36:37]
    v_pk_mul_f32 v[216:217], v[216:217], s[36:37]
    v_pk_mul_f32 v[218:219], v[218:219], s[36:37]
    v_cvt_pk_bf16_f32 v100, v208, v209
    v_cvt_pk_bf16_f32 v101, v210, v211
    v_cvt_pk_bf16_f32 v102, v216, v217
    v_cvt_pk_bf16_f32 v103, v218, v219
    v_pk_mul_f32 v[212:213], v[212:213], s[36:37]
    v_pk_mul_f32 v[214:215], v[214:215], s[36:37]
    v_pk_mul_f32 v[220:221], v[220:221], s[36:37]
    v_pk_mul_f32 v[222:223], v[222:223], s[36:37]
    v_cvt_pk_bf16_f32 v116, v212, v213
    v_cvt_pk_bf16_f32 v117, v214, v215
    v_cvt_pk_bf16_f32 v118, v220, v221
    v_cvt_pk_bf16_f32 v119, v222, v223
    v_permlane32_swap_b32 v100, v102
    v_permlane32_swap_b32 v101, v103
    v_permlane32_swap_b32 v116, v118
    v_permlane32_swap_b32 v117, v119
    v_permlane16_swap_b32 v100, v102
    v_permlane16_swap_b32 v101, v103
    v_permlane16_swap_b32 v116, v118
    v_permlane16_swap_b32 v117, v119
    v_pk_mul_f32 v[224:225], v[224:225], s[36:37]
    v_pk_mul_f32 v[226:227], v[226:227], s[36:37]
    v_pk_mul_f32 v[232:233], v[232:233], s[36:37]
    v_pk_mul_f32 v[234:235], v[234:235], s[36:37]
    v_cvt_pk_bf16_f32 v104, v224, v225
    v_cvt_pk_bf16_f32 v105, v226, v227
    v_cvt_pk_bf16_f32 v106, v232, v233
    v_cvt_pk_bf16_f32 v107, v234, v235
    v_pk_mul_f32 v[228:229], v[228:229], s[36:37]
    v_pk_mul_f32 v[230:231], v[230:231], s[36:37]
    v_pk_mul_f32 v[236:237], v[236:237], s[36:37]
    v_pk_mul_f32 v[238:239], v[238:239], s[36:37]
    v_cvt_pk_bf16_f32 v120, v228, v229
    v_cvt_pk_bf16_f32 v121, v230, v231
    v_cvt_pk_bf16_f32 v122, v236, v237
    v_cvt_pk_bf16_f32 v123, v238, v239
    v_permlane32_swap_b32 v104, v106
    v_permlane32_swap_b32 v105, v107
    v_permlane32_swap_b32 v120, v122
    v_permlane32_swap_b32 v121, v123
    v_permlane16_swap_b32 v104, v106
    v_permlane16_swap_b32 v105, v107
    v_permlane16_swap_b32 v120, v122
    v_permlane16_swap_b32 v121, v123
    v_pk_mul_f32 v[240:241], v[240:241], s[36:37]
    v_pk_mul_f32 v[242:243], v[242:243], s[36:37]
    v_pk_mul_f32 v[248:249], v[248:249], s[36:37]
    v_pk_mul_f32 v[250:251], v[250:251], s[36:37]
    v_cvt_pk_bf16_f32 v108, v240, v241
    v_cvt_pk_bf16_f32 v109, v242, v243
    v_cvt_pk_bf16_f32 v110, v248, v249
    v_cvt_pk_bf16_f32 v111, v250, v251
    v_pk_mul_f32 v[244:245], v[244:245], s[36:37]
    v_pk_mul_f32 v[246:247], v[246:247], s[36:37]
    v_pk_mul_f32 v[252:253], v[252:253], s[36:37]
    v_pk_mul_f32 v[254:255], v[254:255], s[36:37]
    v_cvt_pk_bf16_f32 v124, v244, v245
    v_cvt_pk_bf16_f32 v125, v246, v247
    v_cvt_pk_bf16_f32 v126, v252, v253
    v_cvt_pk_bf16_f32 v127, v254, v255
    v_permlane32_swap_b32 v108, v110
    v_permlane32_swap_b32 v109, v111
    v_permlane32_swap_b32 v124, v126
    v_permlane32_swap_b32 v125, v127
    v_permlane16_swap_b32 v108, v110
    v_permlane16_swap_b32 v109, v111
    v_permlane16_swap_b32 v124, v126
    v_permlane16_swap_b32 v125, v127
    s_waitcnt lgkmcnt(0)
    v_mfma_f32_16x16x32_bf16 v[216:219], a[208:211], v[64:67], 0
    v_mfma_f32_16x16x32_bf16 v[216:219], a[212:215], v[68:71], v[216:219]
    v_mfma_f32_16x16x32_bf16 v[216:219], a[216:219], v[72:75], v[216:219]
    v_mfma_f32_16x16x32_bf16 v[216:219], a[220:223], v[76:79], v[216:219]
    v_mfma_f32_16x16x32_bf16 v[220:223], a[208:211], v[80:83], 0
    v_mfma_f32_16x16x32_bf16 v[220:223], a[212:215], v[84:87], v[220:223]
    v_mfma_f32_16x16x32_bf16 v[220:223], a[216:219], v[88:91], v[220:223]
    v_mfma_f32_16x16x32_bf16 v[220:223], a[220:223], v[92:95], v[220:223]
    v_mfma_f32_16x16x32_bf16 v[224:227], a[208:211], v[96:99], 0
    v_mfma_f32_16x16x32_bf16 v[224:227], a[212:215], v[100:103], v[224:227]
    v_mfma_f32_16x16x32_bf16 v[224:227], a[216:219], v[104:107], v[224:227]
    v_mfma_f32_16x16x32_bf16 v[224:227], a[220:223], v[108:111], v[224:227]
    v_mfma_f32_16x16x32_bf16 v[228:231], a[208:211], v[112:115], 0
    v_mfma_f32_16x16x32_bf16 v[228:231], a[212:215], v[116:119], v[228:231]
    v_mfma_f32_16x16x32_bf16 v[228:231], a[216:219], v[120:123], v[228:231]
    v_mfma_f32_16x16x32_bf16 v[228:231], a[220:223], v[124:127], v[228:231]
    v_max3_f32 v232, v216, v217, v218
    v_max_f32 v232, v232, v219
    v_max3_f32 v233, v220, v221, v222
    v_max_f32 v233, v233, v223
    v_max3_f32 v234, v224, v225, v226
    v_max_f32 v234, v234, v227
    s_nop 1
    v_max3_f32 v235, v228, v229, v230
    v_max_f32 v235, v235, v231
    v_mov_b32 v236, v232
    v_mov_b32 v237, v233
    v_mov_b32 v238, v234
    v_mov_b32 v239, v235
    v_permlane16_swap_b32 v232, v236
    v_permlane16_swap_b32 v233, v237
    v_permlane16_swap_b32 v234, v238
    v_permlane16_swap_b32 v235, v239
    v_max_f32 v232, v232, v236
    v_max_f32 v233, v233, v237
    v_max_f32 v234, v234, v238
    v_max_f32 v235, v235, v239
    v_mov_b32 v236, v232
    v_mov_b32 v237, v233
    v_mov_b32 v238, v234
    v_mov_b32 v239, v235
    v_permlane32_swap_b32 v232, v236
    v_permlane32_swap_b32 v233, v237
    v_permlane32_swap_b32 v234, v238
    v_permlane32_swap_b32 v235, v239
    v_max_f32 v232, v232, v236
    v_max_f32 v233, v233, v237
    v_max_f32 v234, v234, v238
    v_max_f32 v235, v235, v239
    v_sub_f32 v192, 3250585600, v232
    v_sub_f32 v193, 3250585600, v232
    v_sub_f32 v194, 3250585600, v232
    v_sub_f32 v195, 3250585600, v232
    v_sub_f32 v196, 3250585600, v233
    v_sub_f32 v197, 3250585600, v233
    v_sub_f32 v198, 3250585600, v233
    v_sub_f32 v199, 3250585600, v233
    v_sub_f32 v200, 3250585600, v234
    v_sub_f32 v201, 3250585600, v234
    v_sub_f32 v202, 3250585600, v234
    v_sub_f32 v203, 3250585600, v234
    v_sub_f32 v204, 3250585600, v235
    v_sub_f32 v205, 3250585600, v235
    v_sub_f32 v206, 3250585600, v235
    v_sub_f32 v207, 3250585600, v235
Lattn_stage0:
    s_mov_b32 s43, 7
    v_mfma_f32_16x16x32_bf16 v[208:211], a[208:211], v[64:67], v[192:195]
    s_lshl_b32 s53, s5, 4
    v_mfma_f32_16x16x32_bf16 v[208:211], a[212:215], v[68:71], v[208:211]
    s_add_u32 s53, s53, s4
    v_mfma_f32_16x16x32_bf16 v[208:211], a[216:219], v[72:75], v[208:211]
    s_lshl_b32 s53, s53, 2
    v_mfma_f32_16x16x32_bf16 v[208:211], a[220:223], v[76:79], v[208:211]
    s_add_u32 s53, s53, s3
    ds_read_b128 a[228:231], v9 offset:4096
    v_mfma_f32_16x16x32_bf16 v[212:215], a[208:211], v[80:83], v[196:199]
    s_mul_i32 s53, s53, 4608
    s_nop 3
    v_exp_f32 v208, v208
    v_mfma_f32_16x16x32_bf16 v[212:215], a[212:215], v[84:87], v[212:215]
    s_add_u32 s53, s53, 2621440
    v_exp_f32 v209, v209
    v_mfma_f32_16x16x32_bf16 v[212:215], a[216:219], v[88:91], v[212:215]
    s_lshr_b32 s44, s2, 5
    v_exp_f32 v210, v210
    v_mfma_f32_16x16x32_bf16 v[212:215], a[220:223], v[92:95], v[212:215]
    s_lshl_b32 s44, s44, 3
    v_exp_f32 v211, v211
    v_cvt_pk_bf16_f32 v128, v208, v209
    ds_read_b128 a[232:235], v10 offset:4096
    v_cvt_pk_bf16_f32 v129, v210, v211
    v_mfma_f32_16x16x32_bf16 v[208:211], a[208:211], v[96:99], v[200:203]
    s_and_b32 s37, s2, 7
    s_nop 0
    v_exp_f32 v212, v212
    v_mfma_f32_16x16x32_bf16 v[208:211], a[212:215], v[100:103], v[208:211]
    s_add_u32 s44, s44, s37
    v_exp_f32 v213, v213
    v_mfma_f32_16x16x32_bf16 v[208:211], a[216:219], v[104:107], v[208:211]
    s_lshl_b32 s44, s44, 2
    v_exp_f32 v214, v214
    v_mfma_f32_16x16x32_bf16 v[208:211], a[220:223], v[108:111], v[208:211]
    s_bfe_u32 s37, s2, 0x20003
    v_exp_f32 v215, v215
    v_cvt_pk_bf16_f32 v136, v212, v213
    ds_read_b128 a[236:239], v11 offset:4096
    v_cvt_pk_bf16_f32 v137, v214, v215
    v_mfma_f32_16x16x32_bf16 v[212:215], a[208:211], v[112:115], v[204:207]
    s_add_u32 s44, s44, s37
    s_nop 0
    v_exp_f32 v208, v208
    v_mfma_f32_16x16x32_bf16 v[212:215], a[212:215], v[116:119], v[212:215]
    s_add_u32 s44, s44, 72
    v_exp_f32 v209, v209
    v_mfma_f32_16x16x32_bf16 v[212:215], a[216:219], v[120:123], v[212:215]
Ltour3:
    s_cbranch_execz Ltour7
    s_cmp_lt_u32 s44, 216
    s_cselect_b32 s37, 0, 2147483648
    v_exp_f32 v210, v210
    v_mfma_f32_16x16x32_bf16 v[212:215], a[220:223], v[124:127], v[212:215]
    s_lshl_b32 s44, s44, 5
    v_exp_f32 v211, v211
    v_cvt_pk_bf16_f32 v144, v208, v209
    ds_read_b128 a[208:211], v8 offset:8192
    v_cvt_pk_bf16_f32 v145, v210, v211
    v_mfma_f32_16x16x32_bf16 v[208:211], a[224:227], v[64:67], v[192:195]
    s_waitcnt lgkmcnt(3)
    s_or_b32 s44, s44, s37
    v_exp_f32 v212, v212
    v_mfma_f32_16x16x32_bf16 v[208:211], a[228:231], v[68:71], v[208:211]
    s_waitcnt lgkmcnt(2)
    s_mov_b32 s18, 3981312
    v_exp_f32 v213, v213
    v_mfma_f32_16x16x32_bf16 v[208:211], a[232:235], v[72:75], v[208:211]
    s_waitcnt lgkmcnt(1)
    s_lshr_b32 s6, s2, 3
    v_exp_f32 v214, v214
    v_mfma_f32_16x16x32_bf16 v[208:211], a[236:239], v[76:79], v[208:211]
    s_and_b32 s7, s2, 7
    v_exp_f32 v215, v215
    v_cvt_pk_bf16_f32 v152, v212, v213
    ds_read_b128 a[212:215], v9 offset:8192
    v_cvt_pk_bf16_f32 v153, v214, v215
    v_mfma_f32_16x16x32_bf16 v[212:215], a[224:227], v[80:83], v[196:199]
    s_mul_i32 s7, s7, 18
    s_nop 0
    v_exp_f32 v208, v208
    v_mfma_f32_16x16x32_bf16 v[212:215], a[228:231], v[84:87], v[212:215]
    s_add_u32 s7, s7, s6
    v_exp_f32 v209, v209
    v_mfma_f32_16x16x32_bf16 v[212:215], a[232:235], v[88:91], v[212:215]
    s_lshl_b32 s58, s7, 6
    v_exp_f32 v210, v210
    v_mfma_f32_16x16x32_bf16 v[212:215], a[236:239], v[92:95], v[212:215]
    s_mul_i32 s59, s7, 36864
    v_exp_f32 v211, v211
    v_cvt_pk_bf16_f32 v130, v208, v209
    ds_read_b128 a[216:219], v10 offset:8192
    v_cvt_pk_bf16_f32 v131, v210, v211
    v_mfma_f32_16x16x32_bf16 v[208:211], a[224:227], v[96:99], v[200:203]
    s_cmp_lt_u32 s6, 18
    s_cselect_b32 s7, 0, 2147483648
    v_exp_f32 v212, v212
    v_mfma_f32_16x16x32_bf16 v[208:211], a[228:231], v[100:103], v[208:211]
    s_or_b32 s58, s58, s7
    v_exp_f32 v213, v213
    v_mfma_f32_16x16x32_bf16 v[208:211], a[232:235], v[104:107], v[208:211]
    s_or_b32 s59, s59, s7
    v_exp_f32 v214, v214
    v_mfma_f32_16x16x32_bf16 v[208:211], a[236:239], v[108:111], v[208:211]
    s_and_b32 s7, s4, 1
    v_exp_f32 v215, v215
    v_cvt_pk_bf16_f32 v138, v212, v213
    ds_read_b128 a[220:223], v11 offset:8192
    v_cvt_pk_bf16_f32 v139, v214, v215
    s_mov_b32 s39, 221184
    s_mov_b32 s38, 27648
    v_mfma_f32_16x16x32_bf16 v[212:215], a[224:227], v[112:115], v[204:207]
    s_lshl_b32 s6, s7, 7
    v_exp_f32 v208, v208
    v_mfma_f32_16x16x32_bf16 v[212:215], a[228:231], v[116:119], v[212:215]
    s_xor_b32 s36, s4, 1
    v_exp_f32 v209, v209
    v_mfma_f32_16x16x32_bf16 v[212:215], a[232:235], v[120:123], v[212:215]
    s_mul_i32 s37, s5, 18432
    s_mul_i32 s36, s36, 294912
    v_exp_f32 v210, v210
    v_mfma_f32_16x16x32_bf16 v[212:215], a[236:239], v[124:127], v[212:215]
    s_waitcnt lgkmcnt(3)
    s_add_u32 s37, s37, s45
    s_add_u32 s46, s36, s6
    v_exp_f32 v211, v211
    v_cvt_pk_bf16_f32 v146, v208, v209
    v_min_u32 v236, 143, v0
    v_lshlrev_b32 v236, 7, v236
    ds_read_b128 a[224:227], v8 offset:12288
    v_cvt_pk_bf16_f32 v147, v210, v211
    v_mfma_f32_16x16x32_bf16 v[208:211], a[208:211], v[64:67], v[192:195]
    s_waitcnt lgkmcnt(3)
    s_lshl_b32 s36, s4, 8
    v_exp_f32 v212, v212
    v_mfma_f32_16x16x32_bf16 v[208:211], a[212:215], v[68:71], v[208:211]
    s_waitcnt lgkmcnt(2)
    s_add_u32 s56, s47, s36
    v_exp_f32 v213, v213
    v_mfma_f32_16x16x32_bf16 v[208:211], a[216:219], v[72:75], v[208:211]
    s_waitcnt lgkmcnt(1)
    s_lshr_b32 s36, s4, 1
    v_exp_f32 v214, v214
    v_mfma_f32_16x16x32_bf16 v[208:211], a[220:223], v[76:79], v[208:211]
    s_lshl_b32 s36, s36, 11
    v_exp_f32 v215, v215
    v_cvt_pk_bf16_f32 v154, v212, v213
    ds_read_b128 a[228:231], v9 offset:12288
    v_cvt_pk_bf16_f32 v155, v214, v215
    buffer_load_dword v221, v236, s[20:23], s37 offen
    v_mfma_f32_16x16x32_bf16 v[212:215], a[208:211], v[80:83], v[196:199]
    s_lshl_b32 s7, s7, 8
    v_exp_f32 v208, v208
    v_mfma_f32_16x16x32_bf16 v[212:215], a[212:215], v[84:87], v[212:215]
    s_add_u32 s36, s36, s7
    v_exp_f32 v209, v209
    v_mfma_f32_16x16x32_bf16 v[212:215], a[216:219], v[88:91], v[212:215]
    s_add_u32 s93, s47, s36
    v_exp_f32 v210, v210
    v_mfma_f32_16x16x32_bf16 v[212:215], a[220:223], v[92:95], v[212:215]
    s_lshr_b32 s36, s4, 1
    v_exp_f32 v211, v211
    v_cvt_pk_bf16_f32 v132, v208, v209
    ds_read_b128 a[232:235], v10 offset:12288
    v_cvt_pk_bf16_f32 v133, v210, v211
    v_mfma_f32_16x16x32_bf16 v[208:211], a[208:211], v[96:99], v[200:203]
    s_lshl_b32 s36, s36, 4
    s_nop 0
    v_exp_f32 v212, v212
    v_mfma_f32_16x16x32_bf16 v[208:211], a[212:215], v[100:103], v[208:211]
    s_add_u32 s36, s36, s5
    v_exp_f32 v213, v213
    v_mfma_f32_16x16x32_bf16 v[208:211], a[216:219], v[104:107], v[208:211]
    s_lshl_b32 s36, s36, 9
    v_exp_f32 v214, v214
    v_mfma_f32_16x16x32_bf16 v[208:211], a[220:223], v[108:111], v[208:211]
    s_add_u32 s36, s36, s7
    v_exp_f32 v215, v215
    v_cvt_pk_bf16_f32 v140, v212, v213
    ds_read_b128 a[236:239], v11 offset:12288
    v_cvt_pk_bf16_f32 v141, v214, v215
    s_waitcnt vmcnt(5)
    s_barrier
    v_mfma_f32_16x16x32_bf16 v[212:215], a[208:211], v[112:115], v[204:207]
    s_lshl_b32 s36, s36, 8
    v_exp_f32 v208, v208
    v_mfma_f32_16x16x32_bf16 v[212:215], a[212:215], v[116:119], v[212:215]
    s_add_u32 m0, s42, 49152
    s_add_u32 s55, s36, 20971520
    v_exp_f32 v209, v209
    v_mfma_f32_16x16x32_bf16 v[212:215], a[216:219], v[120:123], v[212:215]
    s_add_u32 s7, s45, s6
    v_exp_f32 v210, v210
    v_mfma_f32_16x16x32_bf16 v[212:215], a[220:223], v[124:127], v[212:215]
    s_waitcnt lgkmcnt(3)
    s_xor_b32 s54, s92, 128
    v_exp_f32 v211, v211
    v_cvt_pk_bf16_f32 v148, v208, v209
    ds_read_b128 a[208:211], v8 offset:16384
    v_cvt_pk_bf16_f32 v149, v210, v211
    buffer_load_dwordx4 v36, s[8:11], s40 offen lds
    v_mfma_f32_16x16x32_bf16 v[208:211], a[224:227], v[64:67], v[192:195]
    s_waitcnt lgkmcnt(3)
    s_lshl_b32 s36, s3, 14
    v_exp_f32 v212, v212
    v_mfma_f32_16x16x32_bf16 v[208:211], a[228:231], v[68:71], v[208:211]
    s_waitcnt lgkmcnt(2)
    v_exp_f32 v213, v213
    v_mfma_f32_16x16x32_bf16 v[208:211], a[232:235], v[72:75], v[208:211]
    s_waitcnt lgkmcnt(1)
    v_exp_f32 v214, v214
    v_mfma_f32_16x16x32_bf16 v[208:211], a[236:239], v[76:79], v[208:211]
    v_exp_f32 v215, v215
    v_cvt_pk_bf16_f32 v156, v212, v213
    ds_read_b128 a[212:215], v9 offset:16384
    v_cvt_pk_bf16_f32 v157, v214, v215
    v_mfma_f32_16x16x32_bf16 v[212:215], a[224:227], v[80:83], v[196:199]
    s_nop 2
    v_exp_f32 v208, v208
    v_mfma_f32_16x16x32_bf16 v[212:215], a[228:231], v[84:87], v[212:215]
    v_exp_f32 v209, v209
    v_mfma_f32_16x16x32_bf16 v[212:215], a[232:235], v[88:91], v[212:215]
    v_exp_f32 v210, v210
    v_mfma_f32_16x16x32_bf16 v[212:215], a[236:239], v[92:95], v[212:215]
    v_exp_f32 v211, v211
    ds_read_b64_tr_b16 a[160:161], v20 offset:0
    v_cvt_pk_bf16_f32 v134, v208, v209
    v_lshrrev_b32 v51, 2, v0
    v_mul_u32_u24 v51, 9216, v51
    v_and_b32 v254, 3, v0
    v_lshl_add_u32 v254, v254, 4, v51
    v_lshlrev_b32 v255, 4, v0
    v_add_u32 v51, 98304, v255
    v_lshl_add_u32 v252, v1, 4, s36
    v_mov_b32 v224, 0
    v_mov_b32 v225, 0
    v_mov_b32 v226, 0
    v_mov_b32 v227, 0
    v_mov_b32 v228, 0
    v_mov_b32 v229, 0
    v_mov_b32 v230, 0
    v_mov_b32 v231, 0
    v_mov_b32 v248, -1
    v_mov_b32 v249, -1
    v_mov_b32 v250, -1
    v_mov_b32 v251, -1
    v_min_u32 v232, 41, v1
    v_lshlrev_b32 v232, 4, v232
    s_mov_b32 s57, s58
    s_lshl_b32 s6, s3, 10
    s_add_u32 s6, s6, 135168
    s_lshr_b32 s37, s2, 3
    s_mul_i32 s37, s37, -129024
    s_add_u32 s37, s37, 4128768
    ds_read_b64_tr_b16 a[162:163], v20 offset:4096
    ds_read_b128 a[216:219], v10 offset:16384
    v_cvt_pk_bf16_f32 v135, v210, v211
    buffer_load_dwordx4 v37, s[8:11], s40 offen offset:1024 lds
    v_mfma_f32_16x16x32_bf16 v[208:211], a[224:227], v[96:99], v[200:203]
    v_exp_f32 v212, v212
    v_mfma_f32_16x16x32_bf16 v[208:211], a[228:231], v[100:103], v[208:211]
    v_exp_f32 v213, v213
    v_mfma_f32_16x16x32_bf16 v[208:211], a[232:235], v[104:107], v[208:211]
    v_exp_f32 v214, v214
    v_mfma_f32_16x16x32_bf16 v[208:211], a[236:239], v[108:111], v[208:211]
    s_mov_b32 s52, s55
    v_exp_f32 v215, v215
    ds_read_b64_tr_b16 a[164:165], v20 offset:8192
    v_cvt_pk_bf16_f32 v142, v212, v213
    ds_read_b64_tr_b16 a[166:167], v20 offset:12288
    v_min_u32 v237, 19, v1
    v_lshl_add_u32 v237, v237, 7, s36
    v_lshl_add_u32 v238, v1, 7, s36
    ds_read_b128 a[220:223], v11 offset:16384
    v_cvt_pk_bf16_f32 v143, v214, v215
    buffer_load_dword v217, v57, s[32:35], s37 offen
    v_mfma_f32_16x16x32_bf16 v[212:215], a[224:227], v[112:115], v[204:207]
    v_exp_f32 v208, v208
    v_mfma_f32_16x16x32_bf16 v[212:215], a[228:231], v[116:119], v[212:215]
    v_exp_f32 v209, v209
    v_mfma_f32_16x16x32_bf16 v[212:215], a[232:235], v[120:123], v[212:215]
    v_exp_f32 v210, v210
    v_mfma_f32_16x16x32_bf16 v[212:215], a[236:239], v[124:127], v[212:215]
    v_exp_f32 v211, v211
    ds_read_b64_tr_b16 a[168:169], v21 offset:0
    v_cvt_pk_bf16_f32 v150, v208, v209
    ds_read_b64_tr_b16 a[170:171], v21 offset:4096
    ds_read_b128 a[224:227], v8 offset:20480
    v_cvt_pk_bf16_f32 v151, v210, v211
    s_waitcnt lgkmcnt(3)
    buffer_load_dwordx4 v38, s[8:11], s40 offen offset:2048 lds
Lattn_loop:
    v_mfma_f32_16x16x32_bf16 v[208:211], a[208:211], v[64:67], v[192:195]
    v_exp_f32 v212, v212
    v_mfma_f32_16x16x32_bf16 v[208:211], a[212:215], v[68:71], v[208:211]
    v_exp_f32 v213, v213
    v_mfma_f32_16x16x32_bf16 v[208:211], a[216:219], v[72:75], v[208:211]
    v_exp_f32 v214, v214
    v_mfma_f32_16x16x32_bf16 v[208:211], a[220:223], v[76:79], v[208:211]
    v_exp_f32 v215, v215
    v_mfma_f32_16x16x32_bf16 a[0:3], a[160:163], v[128:131], a[0:3]
    ds_read_b64_tr_b16 a[172:173], v21 offset:8192
    v_cvt_pk_bf16_f32 v158, v212, v213
    v_mfma_f32_16x16x32_bf16 a[0:3], a[164:167], v[132:135], a[0:3]
    ds_read_b64_tr_b16 a[174:175], v21 offset:12288
    v_mfma_f32_16x16x32_bf16 a[4:7], a[160:163], v[136:139], a[4:7]
    ds_read_b128 a[228:231], v9 offset:20480
    v_cvt_pk_bf16_f32 v159, v214, v215
    v_mfma_f32_16x16x32_bf16 a[4:7], a[164:167], v[140:143], a[4:7]
    v_mfma_f32_16x16x32_bf16 v[212:215], a[208:211], v[80:83], v[196:199]
    v_exp_f32 v208, v208
    v_mfma_f32_16x16x32_bf16 v[212:215], a[212:215], v[84:87], v[212:215]
    v_exp_f32 v209, v209
    v_mfma_f32_16x16x32_bf16 v[212:215], a[216:219], v[88:91], v[212:215]
    v_exp_f32 v210, v210
    v_mfma_f32_16x16x32_bf16 v[212:215], a[220:223], v[92:95], v[212:215]
    v_exp_f32 v211, v211
    v_mfma_f32_16x16x32_bf16 a[8:11], a[160:163], v[144:147], a[8:11]
    ds_read_b64_tr_b16 a[176:177], v22 offset:0
    v_cvt_pk_bf16_f32 v160, v208, v209
    v_mfma_f32_16x16x32_bf16 a[8:11], a[164:167], v[148:151], a[8:11]
    ds_read_b64_tr_b16 a[178:179], v22 offset:4096
    v_mfma_f32_16x16x32_bf16 a[12:15], a[160:163], v[152:155], a[12:15]
    ds_read_b128 a[232:235], v10 offset:20480
    v_cvt_pk_bf16_f32 v161, v210, v211
    v_mfma_f32_16x16x32_bf16 a[12:15], a[164:167], v[156:159], a[12:15]
    s_waitcnt lgkmcnt(3)
    buffer_load_dwordx4 v39, s[8:11], s40 offen offset:3072 lds
    v_mfma_f32_16x16x32_bf16 v[208:211], a[208:211], v[96:99], v[200:203]
    v_exp_f32 v212, v212
    v_mfma_f32_16x16x32_bf16 v[208:211], a[212:215], v[100:103], v[208:211]
    s_add_u32 s40, s40, 16384
    v_exp_f32 v213, v213
    v_mfma_f32_16x16x32_bf16 v[208:211], a[216:219], v[104:107], v[208:211]
    s_mov_b32 m0, s6
    v_exp_f32 v214, v214
    v_mfma_f32_16x16x32_bf16 v[208:211], a[220:223], v[108:111], v[208:211]
    v_exp_f32 v215, v215
    v_mfma_f32_16x16x32_bf16 a[16:19], a[168:171], v[128:131], a[16:19]
    ds_read_b64_tr_b16 a[180:181], v22 offset:8192
    v_cvt_pk_bf16_f32 v168, v212, v213
    v_mfma_f32_16x16x32_bf16 a[16:19], a[172:175], v[132:135], a[16:19]
    ds_read_b64_tr_b16 a[182:183], v22 offset:12288
    v_mfma_f32_16x16x32_bf16 a[20:23], a[168:171], v[136:139], a[20:23]
    ds_read_b128 a[236:239], v11 offset:20480
    v_cvt_pk_bf16_f32 v169, v214, v215
    v_mfma_f32_16x16x32_bf16 a[20:23], a[172:175], v[140:143], a[20:23]
    buffer_load_dwordx4 v254, s[32:35], s57 offen  lds
    v_smfmac_f32_16x16x64_bf16 a[192:195], v[52:55], v[128:135], v50
    v_mfma_f32_16x16x32_bf16 v[212:215], a[208:211], v[112:115], v[204:207]
    v_exp_f32 v208, v208
    v_mfma_f32_16x16x32_bf16 v[212:215], a[212:215], v[116:119], v[212:215]
    s_add_u32 m0, s42, 98304
    v_exp_f32 v209, v209
    v_mfma_f32_16x16x32_bf16 v[212:215], a[216:219], v[120:123], v[212:215]
    v_exp_f32 v210, v210
    v_mfma_f32_16x16x32_bf16 v[212:215], a[220:223], v[124:127], v[212:215]
    v_exp_f32 v211, v211
    v_mfma_f32_16x16x32_bf16 a[24:27], a[168:171], v[144:147], a[24:27]
    ds_read_b64_tr_b16 a[184:185], v23 offset:0
    v_cvt_pk_bf16_f32 v176, v208, v209
    v_mfma_f32_16x16x32_bf16 a[24:27], a[172:175], v[148:151], a[24:27]
    ds_read_b64_tr_b16 a[186:187], v23 offset:4096
    v_mfma_f32_16x16x32_bf16 a[28:31], a[168:171], v[152:155], a[28:31]
    ds_read_b128 a[208:211], v8 offset:24576
    v_cvt_pk_bf16_f32 v177, v210, v211
    v_mfma_f32_16x16x32_bf16 a[28:31], a[172:175], v[156:159], a[28:31]
    s_waitcnt lgkmcnt(3)
    buffer_load_dwordx4 v40, s[12:15], s41 offen lds
    v_mfma_f32_16x16x32_bf16 v[208:211], a[224:227], v[64:67], v[192:195]
    v_exp_f32 v212, v212
    v_mfma_f32_16x16x32_bf16 v[208:211], a[228:231], v[68:71], v[208:211]
    s_add_u32 s6, s6, 4096
    v_exp_f32 v213, v213
    v_mfma_f32_16x16x32_bf16 v[208:211], a[232:235], v[72:75], v[208:211]
    s_add_u32 s57, s57, 589824
    v_exp_f32 v214, v214
    v_mfma_f32_16x16x32_bf16 v[208:211], a[236:239], v[76:79], v[208:211]
    v_exp_f32 v215, v215
    v_mfma_f32_16x16x32_bf16 a[32:35], a[176:179], v[128:131], a[32:35]
    ds_read_b64_tr_b16 a[188:189], v23 offset:8192
    v_cvt_pk_bf16_f32 v184, v212, v213
    v_mfma_f32_16x16x32_bf16 a[32:35], a[180:183], v[132:135], a[32:35]
    ds_read_b64_tr_b16 a[190:191], v23 offset:12288
    v_mfma_f32_16x16x32_bf16 a[36:39], a[176:179], v[136:139], a[36:39]
    ds_read_b128 a[212:215], v9 offset:24576
    v_cvt_pk_bf16_f32 v185, v214, v215
    v_mfma_f32_16x16x32_bf16 a[36:39], a[180:183], v[140:143], a[36:39]
    v_smfmac_f32_16x16x64_bf16 a[196:199], v[52:55], v[136:143], v50
    v_mfma_f32_16x16x32_bf16 v[212:215], a[224:227], v[80:83], v[196:199]
    v_exp_f32 v208, v208
    v_mfma_f32_16x16x32_bf16 v[212:215], a[228:231], v[84:87], v[212:215]
    v_exp_f32 v209, v209
    v_mfma_f32_16x16x32_bf16 v[212:215], a[232:235], v[88:91], v[212:215]
    v_exp_f32 v210, v210
    v_mfma_f32_16x16x32_bf16 v[212:215], a[236:239], v[92:95], v[212:215]
    v_exp_f32 v211, v211
    v_mfma_f32_16x16x32_bf16 a[40:43], a[176:179], v[144:147], a[40:43]
    ds_read_b64_tr_b16 a[160:161], v24 offset:0
    v_cvt_pk_bf16_f32 v162, v208, v209
    v_mfma_f32_16x16x32_bf16 a[40:43], a[180:183], v[148:151], a[40:43]
    ds_read_b64_tr_b16 a[162:163], v24 offset:4096
    v_mfma_f32_16x16x32_bf16 a[44:47], a[176:179], v[152:155], a[44:47]
    ds_read_b128 a[216:219], v10 offset:24576
    v_cvt_pk_bf16_f32 v163, v210, v211
    v_mfma_f32_16x16x32_bf16 a[44:47], a[180:183], v[156:159], a[44:47]
    s_waitcnt lgkmcnt(3)
    buffer_load_dwordx4 v41, s[12:15], s41 offen offset:1024 lds
    v_mfma_f32_16x16x32_bf16 v[208:211], a[224:227], v[96:99], v[200:203]
    v_exp_f32 v212, v212
    v_mfma_f32_16x16x32_bf16 v[208:211], a[228:231], v[100:103], v[208:211]
    v_exp_f32 v213, v213
    v_mfma_f32_16x16x32_bf16 v[208:211], a[232:235], v[104:107], v[208:211]
    v_exp_f32 v214, v214
    v_mfma_f32_16x16x32_bf16 v[208:211], a[236:239], v[108:111], v[208:211]
    v_exp_f32 v215, v215
    v_mfma_f32_16x16x32_bf16 a[48:51], a[184:187], v[128:131], a[48:51]
    ds_read_b64_tr_b16 a[164:165], v24 offset:8192
    v_cvt_pk_bf16_f32 v170, v212, v213
    v_mfma_f32_16x16x32_bf16 a[48:51], a[188:191], v[132:135], a[48:51]
    ds_read_b64_tr_b16 a[166:167], v24 offset:12288
    v_mfma_f32_16x16x32_bf16 a[52:55], a[184:187], v[136:139], a[52:55]
    ds_read_b128 a[220:223], v11 offset:24576
    v_cvt_pk_bf16_f32 v171, v214, v215
    v_mfma_f32_16x16x32_bf16 a[52:55], a[188:191], v[140:143], a[52:55]
    v_smfmac_f32_16x16x64_bf16 a[200:203], v[52:55], v[144:151], v50
    v_mfma_f32_16x16x32_bf16 v[212:215], a[224:227], v[112:115], v[204:207]
    v_exp_f32 v208, v208
    v_mfma_f32_16x16x32_bf16 v[212:215], a[228:231], v[116:119], v[212:215]
    v_exp_f32 v209, v209
    v_mfma_f32_16x16x32_bf16 v[212:215], a[232:235], v[120:123], v[212:215]
    v_exp_f32 v210, v210
    v_mfma_f32_16x16x32_bf16 v[212:215], a[236:239], v[124:127], v[212:215]
    v_exp_f32 v211, v211
    v_mfma_f32_16x16x32_bf16 a[56:59], a[184:187], v[144:147], a[56:59]
    ds_read_b64_tr_b16 a[168:169], v25 offset:0
    v_cvt_pk_bf16_f32 v178, v208, v209
    v_mfma_f32_16x16x32_bf16 a[56:59], a[188:191], v[148:151], a[56:59]
    ds_read_b64_tr_b16 a[170:171], v25 offset:4096
    v_mfma_f32_16x16x32_bf16 a[60:63], a[184:187], v[152:155], a[60:63]
    ds_read_b128 a[224:227], v8 offset:28672
    v_cvt_pk_bf16_f32 v179, v210, v211
    v_mfma_f32_16x16x32_bf16 a[60:63], a[188:191], v[156:159], a[60:63]
    s_waitcnt lgkmcnt(3)
    buffer_load_dwordx4 v40, s[12:15], s41 offen offset:2048 lds
    v_mfma_f32_16x16x32_bf16 v[208:211], a[208:211], v[64:67], v[192:195]
    v_exp_f32 v212, v212
    v_mfma_f32_16x16x32_bf16 v[208:211], a[212:215], v[68:71], v[208:211]
    v_exp_f32 v213, v213
    v_mfma_f32_16x16x32_bf16 v[208:211], a[216:219], v[72:75], v[208:211]
    v_exp_f32 v214, v214
    v_mfma_f32_16x16x32_bf16 v[208:211], a[220:223], v[76:79], v[208:211]
    v_exp_f32 v215, v215
    v_mfma_f32_16x16x32_bf16 a[64:67], a[160:163], v[128:131], a[64:67]
    ds_read_b64_tr_b16 a[172:173], v25 offset:8192
    v_cvt_pk_bf16_f32 v186, v212, v213
    v_mfma_f32_16x16x32_bf16 a[64:67], a[164:167], v[132:135], a[64:67]
    ds_read_b64_tr_b16 a[174:175], v25 offset:12288
    v_mfma_f32_16x16x32_bf16 a[68:71], a[160:163], v[136:139], a[68:71]
    ds_read_b128 a[228:231], v9 offset:28672
    v_cvt_pk_bf16_f32 v187, v214, v215
    v_mfma_f32_16x16x32_bf16 a[68:71], a[164:167], v[140:143], a[68:71]
    v_smfmac_f32_16x16x64_bf16 a[204:207], v[52:55], v[152:159], v50
    v_mfma_f32_16x16x32_bf16 v[212:215], a[208:211], v[80:83], v[196:199]
    v_exp_f32 v208, v208
    v_mfma_f32_16x16x32_bf16 v[212:215], a[212:215], v[84:87], v[212:215]
    v_exp_f32 v209, v209
    v_mfma_f32_16x16x32_bf16 v[212:215], a[216:219], v[88:91], v[212:215]
    v_exp_f32 v210, v210
    v_mfma_f32_16x16x32_bf16 v[212:215], a[220:223], v[92:95], v[212:215]
    v_exp_f32 v211, v211
    v_mfma_f32_16x16x32_bf16 a[72:75], a[160:163], v[144:147], a[72:75]
    ds_read_b64_tr_b16 a[176:177], v26 offset:0
    v_cvt_pk_bf16_f32 v164, v208, v209
    v_mfma_f32_16x16x32_bf16 a[72:75], a[164:167], v[148:151], a[72:75]
    ds_read_b64_tr_b16 a[178:179], v26 offset:4096
    v_mfma_f32_16x16x32_bf16 a[76:79], a[160:163], v[152:155], a[76:79]
    ds_read_b128 a[232:235], v10 offset:28672
    v_cvt_pk_bf16_f32 v165, v210, v211
    v_mfma_f32_16x16x32_bf16 a[76:79], a[164:167], v[156:159], a[76:79]
    s_waitcnt lgkmcnt(3)
    buffer_load_dwordx4 v41, s[12:15], s41 offen offset:3072 lds
    v_mfma_f32_16x16x32_bf16 v[208:211], a[208:211], v[96:99], v[200:203]
    v_exp_f32 v212, v212
    v_mfma_f32_16x16x32_bf16 v[208:211], a[212:215], v[100:103], v[208:211]
    s_add_u32 s41, s41, 16384
    v_exp_f32 v213, v213
    v_mfma_f32_16x16x32_bf16 v[208:211], a[216:219], v[104:107], v[208:211]
    v_exp_f32 v214, v214
    v_mfma_f32_16x16x32_bf16 v[208:211], a[220:223], v[108:111], v[208:211]
    v_exp_f32 v215, v215
    v_mfma_f32_16x16x32_bf16 a[80:83], a[168:171], v[128:131], a[80:83]
    ds_read_b64_tr_b16 a[180:181], v26 offset:8192
    v_cvt_pk_bf16_f32 v172, v212, v213
    v_mfma_f32_16x16x32_bf16 a[80:83], a[172:175], v[132:135], a[80:83]
    ds_read_b64_tr_b16 a[182:183], v26 offset:12288
    v_mfma_f32_16x16x32_bf16 a[84:87], a[168:171], v[136:139], a[84:87]
    ds_read_b128 a[236:239], v11 offset:28672
    v_cvt_pk_bf16_f32 v173, v214, v215
    v_mfma_f32_16x16x32_bf16 a[84:87], a[172:175], v[140:143], a[84:87]
    s_waitcnt vmcnt(10)
    s_barrier
    v_mfma_f32_16x16x32_bf16 v[212:215], a[208:211], v[112:115], v[204:207]
    v_exp_f32 v208, v208
    v_mfma_f32_16x16x32_bf16 v[212:215], a[212:215], v[116:119], v[212:215]
    s_add_u32 m0, s42, 0
    v_exp_f32 v209, v209
    v_mfma_f32_16x16x32_bf16 v[212:215], a[216:219], v[120:123], v[212:215]
    v_exp_f32 v210, v210
    v_mfma_f32_16x16x32_bf16 v[212:215], a[220:223], v[124:127], v[212:215]
    v_exp_f32 v211, v211
    v_mfma_f32_16x16x32_bf16 a[88:91], a[168:171], v[144:147], a[88:91]
    ds_read_b64_tr_b16 a[184:185], v27 offset:0
    v_cvt_pk_bf16_f32 v180, v208, v209
    v_mfma_f32_16x16x32_bf16 a[88:91], a[172:175], v[148:151], a[88:91]
    ds_read_b64_tr_b16 a[186:187], v27 offset:4096
    v_mfma_f32_16x16x32_bf16 a[92:95], a[168:171], v[152:155], a[92:95]
    ds_read_b128 a[208:211], v8 offset:32768
    v_cvt_pk_bf16_f32 v181, v210, v211
    v_mfma_f32_16x16x32_bf16 a[92:95], a[172:175], v[156:159], a[92:95]
    s_waitcnt lgkmcnt(3)
    buffer_load_dwordx4 v36, s[8:11], s40 offen lds
    v_mfma_f32_16x16x32_bf16 v[208:211], a[224:227], v[64:67], v[192:195]
    v_exp_f32 v212, v212
    v_mfma_f32_16x16x32_bf16 v[208:211], a[228:231], v[68:71], v[208:211]
    v_exp_f32 v213, v213
    v_mfma_f32_16x16x32_bf16 v[208:211], a[232:235], v[72:75], v[208:211]
    v_exp_f32 v214, v214
    v_mfma_f32_16x16x32_bf16 v[208:211], a[236:239], v[76:79], v[208:211]
    v_exp_f32 v215, v215
    v_mfma_f32_16x16x32_bf16 a[96:99], a[176:179], v[128:131], a[96:99]
    ds_read_b64_tr_b16 a[188:189], v27 offset:8192
    v_cvt_pk_bf16_f32 v188, v212, v213
    v_mfma_f32_16x16x32_bf16 a[96:99], a[180:183], v[132:135], a[96:99]
    ds_read_b64_tr_b16 a[190:191], v27 offset:12288
    v_mfma_f32_16x16x32_bf16 a[100:103], a[176:179], v[136:139], a[100:103]
    ds_read_b128 a[212:215], v9 offset:32768
    v_cvt_pk_bf16_f32 v189, v214, v215
    v_mfma_f32_16x16x32_bf16 a[100:103], a[180:183], v[140:143], a[100:103]
    v_mfma_f32_16x16x32_bf16 v[212:215], a[224:227], v[80:83], v[196:199]
    v_exp_f32 v208, v208
    v_mfma_f32_16x16x32_bf16 v[212:215], a[228:231], v[84:87], v[212:215]
    v_exp_f32 v209, v209
    v_mfma_f32_16x16x32_bf16 v[212:215], a[232:235], v[88:91], v[212:215]
    v_exp_f32 v210, v210
    v_mfma_f32_16x16x32_bf16 v[212:215], a[236:239], v[92:95], v[212:215]
    v_exp_f32 v211, v211
    v_mfma_f32_16x16x32_bf16 a[104:107], a[176:179], v[144:147], a[104:107]
    ds_read_b64_tr_b16 a[160:161], v20 offset:16384
    v_cvt_pk_bf16_f32 v166, v208, v209
    v_mfma_f32_16x16x32_bf16 a[104:107], a[180:183], v[148:151], a[104:107]
    ds_read_b64_tr_b16 a[162:163], v20 offset:20480
    v_mfma_f32_16x16x32_bf16 a[108:111], a[176:179], v[152:155], a[108:111]
    ds_read_b128 a[216:219], v10 offset:32768
    v_cvt_pk_bf16_f32 v167, v210, v211
    v_mfma_f32_16x16x32_bf16 a[108:111], a[180:183], v[156:159], a[108:111]
    s_waitcnt lgkmcnt(3)
    buffer_load_dwordx4 v37, s[8:11], s40 offen offset:1024 lds
    v_mfma_f32_16x16x32_bf16 v[208:211], a[224:227], v[96:99], v[200:203]
    v_exp_f32 v212, v212
    v_mfma_f32_16x16x32_bf16 v[208:211], a[228:231], v[100:103], v[208:211]
    v_exp_f32 v213, v213
    v_mfma_f32_16x16x32_bf16 v[208:211], a[232:235], v[104:107], v[208:211]
    v_exp_f32 v214, v214
    v_mfma_f32_16x16x32_bf16 v[208:211], a[236:239], v[108:111], v[208:211]
    v_exp_f32 v215, v215
    v_mfma_f32_16x16x32_bf16 a[112:115], a[184:187], v[128:131], a[112:115]
    ds_read_b64_tr_b16 a[164:165], v20 offset:24576
    v_cvt_pk_bf16_f32 v174, v212, v213
    v_mfma_f32_16x16x32_bf16 a[112:115], a[188:191], v[132:135], a[112:115]
    ds_read_b64_tr_b16 a[166:167], v20 offset:28672
    v_mfma_f32_16x16x32_bf16 a[116:119], a[184:187], v[136:139], a[116:119]
    ds_read_b128 a[220:223], v11 offset:32768
    v_cvt_pk_bf16_f32 v175, v214, v215
    v_mfma_f32_16x16x32_bf16 a[116:119], a[188:191], v[140:143], a[116:119]
    buffer_load_dwordx4 v[240:243], v7, s[16:19], s44 offen
    v_mfma_f32_16x16x32_bf16 v[212:215], a[224:227], v[112:115], v[204:207]
    v_exp_f32 v208, v208
    v_mfma_f32_16x16x32_bf16 v[212:215], a[228:231], v[116:119], v[212:215]
    v_exp_f32 v209, v209
    v_mfma_f32_16x16x32_bf16 v[212:215], a[232:235], v[120:123], v[212:215]
    v_exp_f32 v210, v210
    v_mfma_f32_16x16x32_bf16 v[212:215], a[236:239], v[124:127], v[212:215]
    s_add_u32 s44, s44, 884736
    v_exp_f32 v211, v211
    v_mfma_f32_16x16x32_bf16 a[120:123], a[184:187], v[144:147], a[120:123]
    ds_read_b64_tr_b16 a[168:169], v21 offset:16384
    v_cvt_pk_bf16_f32 v182, v208, v209
    v_mfma_f32_16x16x32_bf16 a[120:123], a[188:191], v[148:151], a[120:123]
    ds_read_b64_tr_b16 a[170:171], v21 offset:20480
    v_mfma_f32_16x16x32_bf16 a[124:127], a[184:187], v[152:155], a[124:127]
    ds_read_b128 a[224:227], v8 offset:36864
    v_cvt_pk_bf16_f32 v183, v210, v211
    v_mfma_f32_16x16x32_bf16 a[124:127], a[188:191], v[156:159], a[124:127]
    s_waitcnt lgkmcnt(3)
    buffer_load_dwordx4 v38, s[8:11], s40 offen offset:2048 lds
    v_mfma_f32_16x16x32_bf16 v[208:211], a[208:211], v[64:67], v[192:195]
    v_exp_f32 v212, v212
    v_mfma_f32_16x16x32_bf16 v[208:211], a[212:215], v[68:71], v[208:211]
    v_exp_f32 v213, v213
    v_mfma_f32_16x16x32_bf16 v[208:211], a[216:219], v[72:75], v[208:211]
    v_exp_f32 v214, v214
    v_mfma_f32_16x16x32_bf16 v[208:211], a[220:223], v[76:79], v[208:211]
    v_exp_f32 v215, v215
    v_mfma_f32_16x16x32_bf16 a[0:3], a[160:163], v[160:163], a[0:3]
    ds_read_b64_tr_b16 a[172:173], v21 offset:24576
    v_cvt_pk_bf16_f32 v190, v212, v213
    v_mfma_f32_16x16x32_bf16 a[0:3], a[164:167], v[164:167], a[0:3]
    ds_read_b64_tr_b16 a[174:175], v21 offset:28672
    v_mfma_f32_16x16x32_bf16 a[4:7], a[160:163], v[168:171], a[4:7]
    ds_read_b128 a[228:231], v9 offset:36864
    v_cvt_pk_bf16_f32 v191, v214, v215
    v_mfma_f32_16x16x32_bf16 a[4:7], a[164:167], v[172:175], a[4:7]
    v_mfma_f32_16x16x32_bf16 v[212:215], a[208:211], v[80:83], v[196:199]
    v_exp_f32 v208, v208
    v_mfma_f32_16x16x32_bf16 v[212:215], a[212:215], v[84:87], v[212:215]
    v_exp_f32 v209, v209
    v_mfma_f32_16x16x32_bf16 v[212:215], a[216:219], v[88:91], v[212:215]
    v_exp_f32 v210, v210
    v_mfma_f32_16x16x32_bf16 v[212:215], a[220:223], v[92:95], v[212:215]
    v_exp_f32 v211, v211
    v_mfma_f32_16x16x32_bf16 a[8:11], a[160:163], v[176:179], a[8:11]
    ds_read_b64_tr_b16 a[176:177], v22 offset:16384
    v_cvt_pk_bf16_f32 v128, v208, v209
    v_mfma_f32_16x16x32_bf16 a[8:11], a[164:167], v[180:183], a[8:11]
    ds_read_b64_tr_b16 a[178:179], v22 offset:20480
    v_mfma_f32_16x16x32_bf16 a[12:15], a[160:163], v[184:187], a[12:15]
    ds_read_b128 a[232:235], v10 offset:36864
    v_cvt_pk_bf16_f32 v129, v210, v211
    v_mfma_f32_16x16x32_bf16 a[12:15], a[164:167], v[188:191], a[12:15]
    s_waitcnt lgkmcnt(3)
    buffer_load_dwordx4 v39, s[8:11], s40 offen offset:3072 lds
    v_mfma_f32_16x16x32_bf16 v[208:211], a[208:211], v[96:99], v[200:203]
    v_exp_f32 v212, v212
    v_mfma_f32_16x16x32_bf16 v[208:211], a[212:215], v[100:103], v[208:211]
    s_add_u32 s40, s40, 16384
    v_exp_f32 v213, v213
    v_mfma_f32_16x16x32_bf16 v[208:211], a[216:219], v[104:107], v[208:211]
    v_exp_f32 v214, v214
    v_mfma_f32_16x16x32_bf16 v[208:211], a[220:223], v[108:111], v[208:211]
    v_exp_f32 v215, v215
    v_mfma_f32_16x16x32_bf16 a[16:19], a[168:171], v[160:163], a[16:19]
    ds_read_b64_tr_b16 a[180:181], v22 offset:24576
    v_cvt_pk_bf16_f32 v136, v212, v213
    v_mfma_f32_16x16x32_bf16 a[16:19], a[172:175], v[164:167], a[16:19]
    ds_read_b64_tr_b16 a[182:183], v22 offset:28672
    v_mfma_f32_16x16x32_bf16 a[20:23], a[168:171], v[168:171], a[20:23]
    ds_read_b128 a[236:239], v11 offset:36864
    v_cvt_pk_bf16_f32 v137, v214, v215
    v_mfma_f32_16x16x32_bf16 a[20:23], a[172:175], v[172:175], a[20:23]
    v_smfmac_f32_16x16x64_bf16 a[192:195], v[52:55], v[160:167], v50
    v_mfma_f32_16x16x32_bf16 v[212:215], a[208:211], v[112:115], v[204:207]
    v_exp_f32 v208, v208
    v_mfma_f32_16x16x32_bf16 v[212:215], a[212:215], v[116:119], v[212:215]
    s_add_u32 m0, s42, 114688
    v_exp_f32 v209, v209
    v_mfma_f32_16x16x32_bf16 v[212:215], a[216:219], v[120:123], v[212:215]
    v_exp_f32 v210, v210
    v_mfma_f32_16x16x32_bf16 v[212:215], a[220:223], v[124:127], v[212:215]
    v_exp_f32 v211, v211
    v_mfma_f32_16x16x32_bf16 a[24:27], a[168:171], v[176:179], a[24:27]
    ds_read_b64_tr_b16 a[184:185], v23 offset:16384
    v_cvt_pk_bf16_f32 v144, v208, v209
    v_mfma_f32_16x16x32_bf16 a[24:27], a[172:175], v[180:183], a[24:27]
Ltour4:
    s_cbranch_execz Ltour8
    ds_read_b64_tr_b16 a[186:187], v23 offset:20480
    v_mfma_f32_16x16x32_bf16 a[28:31], a[168:171], v[184:187], a[28:31]
    ds_read_b128 a[208:211], v8 offset:40960
    v_cvt_pk_bf16_f32 v145, v210, v211
    v_mfma_f32_16x16x32_bf16 a[28:31], a[172:175], v[188:191], a[28:31]
    s_waitcnt lgkmcnt(3)
    buffer_load_dwordx4 v40, s[12:15], s41 offen lds
    v_mfma_f32_16x16x32_bf16 v[208:211], a[224:227], v[64:67], v[192:195]
    v_exp_f32 v212, v212
    v_mfma_f32_16x16x32_bf16 v[208:211], a[228:231], v[68:71], v[208:211]
    v_exp_f32 v213, v213
    v_mfma_f32_16x16x32_bf16 v[208:211], a[232:235], v[72:75], v[208:211]
    v_exp_f32 v214, v214
    v_mfma_f32_16x16x32_bf16 v[208:211], a[236:239], v[76:79], v[208:211]
    v_exp_f32 v215, v215
    v_mfma_f32_16x16x32_bf16 a[32:35], a[176:179], v[160:163], a[32:35]
    ds_read_b64_tr_b16 a[188:189], v23 offset:24576
    v_cvt_pk_bf16_f32 v152, v212, v213
    v_mfma_f32_16x16x32_bf16 a[32:35], a[180:183], v[164:167], a[32:35]
    ds_read_b64_tr_b16 a[190:191], v23 offset:28672
    v_mfma_f32_16x16x32_bf16 a[36:39], a[176:179], v[168:171], a[36:39]
    ds_read_b128 a[212:215], v9 offset:40960
    v_cvt_pk_bf16_f32 v153, v214, v215
    v_mfma_f32_16x16x32_bf16 a[36:39], a[180:183], v[172:175], a[36:39]
    v_smfmac_f32_16x16x64_bf16 a[196:199], v[52:55], v[168:175], v50
    v_mfma_f32_16x16x32_bf16 v[212:215], a[224:227], v[80:83], v[196:199]
    v_exp_f32 v208, v208
    v_mfma_f32_16x16x32_bf16 v[212:215], a[228:231], v[84:87], v[212:215]
    v_exp_f32 v209, v209
    v_mfma_f32_16x16x32_bf16 v[212:215], a[232:235], v[88:91], v[212:215]
    v_exp_f32 v210, v210
    v_mfma_f32_16x16x32_bf16 v[212:215], a[236:239], v[92:95], v[212:215]
    v_exp_f32 v211, v211
    v_mfma_f32_16x16x32_bf16 a[40:43], a[176:179], v[176:179], a[40:43]
    ds_read_b64_tr_b16 a[160:161], v24 offset:16384
    v_cvt_pk_bf16_f32 v130, v208, v209
    v_mfma_f32_16x16x32_bf16 a[40:43], a[180:183], v[180:183], a[40:43]
    ds_read_b64_tr_b16 a[162:163], v24 offset:20480
    v_mfma_f32_16x16x32_bf16 a[44:47], a[176:179], v[184:187], a[44:47]
    ds_read_b128 a[216:219], v10 offset:40960
    v_cvt_pk_bf16_f32 v131, v210, v211
    v_mfma_f32_16x16x32_bf16 a[44:47], a[180:183], v[188:191], a[44:47]
    s_waitcnt lgkmcnt(3)
    buffer_load_dwordx4 v41, s[12:15], s41 offen offset:1024 lds
    v_mfma_f32_16x16x32_bf16 v[208:211], a[224:227], v[96:99], v[200:203]
    v_exp_f32 v212, v212
    v_mfma_f32_16x16x32_bf16 v[208:211], a[228:231], v[100:103], v[208:211]
    v_exp_f32 v213, v213
    v_mfma_f32_16x16x32_bf16 v[208:211], a[232:235], v[104:107], v[208:211]
    v_exp_f32 v214, v214
    v_mfma_f32_16x16x32_bf16 v[208:211], a[236:239], v[108:111], v[208:211]
    v_exp_f32 v215, v215
    v_mfma_f32_16x16x32_bf16 a[48:51], a[184:187], v[160:163], a[48:51]
    ds_read_b64_tr_b16 a[164:165], v24 offset:24576
    v_cvt_pk_bf16_f32 v138, v212, v213
    v_mfma_f32_16x16x32_bf16 a[48:51], a[188:191], v[164:167], a[48:51]
    ds_read_b64_tr_b16 a[166:167], v24 offset:28672
    v_mfma_f32_16x16x32_bf16 a[52:55], a[184:187], v[168:171], a[52:55]
    ds_read_b128 a[220:223], v11 offset:40960
    v_cvt_pk_bf16_f32 v139, v214, v215
    v_mfma_f32_16x16x32_bf16 a[52:55], a[188:191], v[172:175], a[52:55]
    v_smfmac_f32_16x16x64_bf16 a[200:203], v[52:55], v[176:183], v50
    v_mfma_f32_16x16x32_bf16 v[212:215], a[224:227], v[112:115], v[204:207]
    v_exp_f32 v208, v208
    v_mfma_f32_16x16x32_bf16 v[212:215], a[228:231], v[116:119], v[212:215]
    v_exp_f32 v209, v209
    v_mfma_f32_16x16x32_bf16 v[212:215], a[232:235], v[120:123], v[212:215]
    v_exp_f32 v210, v210
    v_mfma_f32_16x16x32_bf16 v[212:215], a[236:239], v[124:127], v[212:215]
    v_exp_f32 v211, v211
    v_mfma_f32_16x16x32_bf16 a[56:59], a[184:187], v[176:179], a[56:59]
    ds_read_b64_tr_b16 a[168:169], v25 offset:16384
    v_cvt_pk_bf16_f32 v146, v208, v209
    v_mfma_f32_16x16x32_bf16 a[56:59], a[188:191], v[180:183], a[56:59]
    ds_read_b64_tr_b16 a[170:171], v25 offset:20480
    v_mfma_f32_16x16x32_bf16 a[60:63], a[184:187], v[184:187], a[60:63]
    ds_read_b128 a[224:227], v8 offset:45056
    v_cvt_pk_bf16_f32 v147, v210, v211
    v_mfma_f32_16x16x32_bf16 a[60:63], a[188:191], v[188:191], a[60:63]
    s_waitcnt lgkmcnt(3)
    buffer_load_dwordx4 v40, s[12:15], s41 offen offset:2048 lds
    v_mfma_f32_16x16x32_bf16 v[208:211], a[208:211], v[64:67], v[192:195]
    v_exp_f32 v212, v212
    v_mfma_f32_16x16x32_bf16 v[208:211], a[212:215], v[68:71], v[208:211]
    v_exp_f32 v213, v213
    v_mfma_f32_16x16x32_bf16 v[208:211], a[216:219], v[72:75], v[208:211]
    v_exp_f32 v214, v214
    v_mfma_f32_16x16x32_bf16 v[208:211], a[220:223], v[76:79], v[208:211]
    v_exp_f32 v215, v215
    v_mfma_f32_16x16x32_bf16 a[64:67], a[160:163], v[160:163], a[64:67]
    ds_read_b64_tr_b16 a[172:173], v25 offset:24576
    v_cvt_pk_bf16_f32 v154, v212, v213
    v_mfma_f32_16x16x32_bf16 a[64:67], a[164:167], v[164:167], a[64:67]
    ds_read_b64_tr_b16 a[174:175], v25 offset:28672
    v_mfma_f32_16x16x32_bf16 a[68:71], a[160:163], v[168:171], a[68:71]
    ds_read_b128 a[228:231], v9 offset:45056
    v_cvt_pk_bf16_f32 v155, v214, v215
    v_mfma_f32_16x16x32_bf16 a[68:71], a[164:167], v[172:175], a[68:71]
    v_smfmac_f32_16x16x64_bf16 a[204:207], v[52:55], v[184:191], v50
    v_mfma_f32_16x16x32_bf16 v[212:215], a[208:211], v[80:83], v[196:199]
    v_exp_f32 v208, v208
    v_mfma_f32_16x16x32_bf16 v[212:215], a[212:215], v[84:87], v[212:215]
    v_exp_f32 v209, v209
    v_mfma_f32_16x16x32_bf16 v[212:215], a[216:219], v[88:91], v[212:215]
    v_exp_f32 v210, v210
    v_mfma_f32_16x16x32_bf16 v[212:215], a[220:223], v[92:95], v[212:215]
    v_exp_f32 v211, v211
    v_mfma_f32_16x16x32_bf16 a[72:75], a[160:163], v[176:179], a[72:75]
    ds_read_b64_tr_b16 a[176:177], v26 offset:16384
    v_cvt_pk_bf16_f32 v132, v208, v209
    v_mfma_f32_16x16x32_bf16 a[72:75], a[164:167], v[180:183], a[72:75]
    ds_read_b64_tr_b16 a[178:179], v26 offset:20480
    v_mfma_f32_16x16x32_bf16 a[76:79], a[160:163], v[184:187], a[76:79]
    ds_read_b128 a[232:235], v10 offset:45056
    v_cvt_pk_bf16_f32 v133, v210, v211
    v_mfma_f32_16x16x32_bf16 a[76:79], a[164:167], v[188:191], a[76:79]
    s_waitcnt lgkmcnt(3)
    buffer_load_dwordx4 v41, s[12:15], s41 offen offset:3072 lds
    v_mfma_f32_16x16x32_bf16 v[208:211], a[208:211], v[96:99], v[200:203]
    v_exp_f32 v212, v212
    v_mfma_f32_16x16x32_bf16 v[208:211], a[212:215], v[100:103], v[208:211]
    s_add_u32 s41, s41, 16384
    v_exp_f32 v213, v213
    v_mfma_f32_16x16x32_bf16 v[208:211], a[216:219], v[104:107], v[208:211]
    v_exp_f32 v214, v214
    v_mfma_f32_16x16x32_bf16 v[208:211], a[220:223], v[108:111], v[208:211]
    v_exp_f32 v215, v215
    v_mfma_f32_16x16x32_bf16 a[80:83], a[168:171], v[160:163], a[80:83]
    ds_read_b64_tr_b16 a[180:181], v26 offset:24576
    v_cvt_pk_bf16_f32 v140, v212, v213
    v_mfma_f32_16x16x32_bf16 a[80:83], a[172:175], v[164:167], a[80:83]
    ds_read_b64_tr_b16 a[182:183], v26 offset:28672
    v_mfma_f32_16x16x32_bf16 a[84:87], a[168:171], v[168:171], a[84:87]
    ds_read_b128 a[236:239], v11 offset:45056
    v_cvt_pk_bf16_f32 v141, v214, v215
    v_mfma_f32_16x16x32_bf16 a[84:87], a[172:175], v[172:175], a[84:87]
    s_waitcnt vmcnt(9)
    s_barrier
    v_mfma_f32_16x16x32_bf16 v[212:215], a[208:211], v[112:115], v[204:207]
    v_exp_f32 v208, v208
    v_mfma_f32_16x16x32_bf16 v[212:215], a[212:215], v[116:119], v[212:215]
    s_add_u32 m0, s42, 16384
    v_exp_f32 v209, v209
    v_mfma_f32_16x16x32_bf16 v[212:215], a[216:219], v[120:123], v[212:215]
    v_exp_f32 v210, v210
    v_mfma_f32_16x16x32_bf16 v[212:215], a[220:223], v[124:127], v[212:215]
    v_exp_f32 v211, v211
    v_mfma_f32_16x16x32_bf16 a[88:91], a[168:171], v[176:179], a[88:91]
    ds_read_b64_tr_b16 a[184:185], v27 offset:16384
    v_cvt_pk_bf16_f32 v148, v208, v209
    v_mfma_f32_16x16x32_bf16 a[88:91], a[172:175], v[180:183], a[88:91]
    ds_read_b64_tr_b16 a[186:187], v27 offset:20480
    v_mfma_f32_16x16x32_bf16 a[92:95], a[168:171], v[184:187], a[92:95]
    ds_read_b128 a[208:211], v8 offset:49152
    v_cvt_pk_bf16_f32 v149, v210, v211
    v_mfma_f32_16x16x32_bf16 a[92:95], a[172:175], v[188:191], a[92:95]
    s_waitcnt lgkmcnt(3)
    buffer_load_dwordx4 v36, s[8:11], s40 offen lds
    v_mfma_f32_16x16x32_bf16 v[208:211], a[224:227], v[64:67], v[192:195]
    v_exp_f32 v212, v212
    v_mfma_f32_16x16x32_bf16 v[208:211], a[228:231], v[68:71], v[208:211]
    v_exp_f32 v213, v213
    v_mfma_f32_16x16x32_bf16 v[208:211], a[232:235], v[72:75], v[208:211]
    v_exp_f32 v214, v214
    v_mfma_f32_16x16x32_bf16 v[208:211], a[236:239], v[76:79], v[208:211]
    v_exp_f32 v215, v215
    v_mfma_f32_16x16x32_bf16 a[96:99], a[176:179], v[160:163], a[96:99]
    ds_read_b64_tr_b16 a[188:189], v27 offset:24576
    v_cvt_pk_bf16_f32 v156, v212, v213
    v_mfma_f32_16x16x32_bf16 a[96:99], a[180:183], v[164:167], a[96:99]
    ds_read_b64_tr_b16 a[190:191], v27 offset:28672
    v_mfma_f32_16x16x32_bf16 a[100:103], a[176:179], v[168:171], a[100:103]
    ds_read_b128 a[212:215], v9 offset:49152
    v_cvt_pk_bf16_f32 v157, v214, v215
    v_mfma_f32_16x16x32_bf16 a[100:103], a[180:183], v[172:175], a[100:103]
    buffer_load_dword v218, v57, s[80:83], s39 offen
    v_mfma_f32_16x16x32_bf16 v[212:215], a[224:227], v[80:83], v[196:199]
    v_exp_f32 v208, v208
    v_mfma_f32_16x16x32_bf16 v[212:215], a[228:231], v[84:87], v[212:215]
    v_exp_f32 v209, v209
    v_mfma_f32_16x16x32_bf16 v[212:215], a[232:235], v[88:91], v[212:215]
    v_exp_f32 v210, v210
    v_mfma_f32_16x16x32_bf16 v[212:215], a[236:239], v[92:95], v[212:215]
    v_exp_f32 v211, v211
    v_mfma_f32_16x16x32_bf16 a[104:107], a[176:179], v[176:179], a[104:107]
    ds_read_b64_tr_b16 a[160:161], v20 offset:32768
    v_cvt_pk_bf16_f32 v134, v208, v209
    v_mfma_f32_16x16x32_bf16 a[104:107], a[180:183], v[180:183], a[104:107]
    ds_read_b64_tr_b16 a[162:163], v20 offset:36864
    v_mfma_f32_16x16x32_bf16 a[108:111], a[176:179], v[184:187], a[108:111]
    ds_read_b128 a[216:219], v10 offset:49152
    v_cvt_pk_bf16_f32 v135, v210, v211
    v_mfma_f32_16x16x32_bf16 a[108:111], a[180:183], v[188:191], a[108:111]
    s_waitcnt lgkmcnt(3)
    buffer_load_dwordx4 v37, s[8:11], s40 offen offset:1024 lds
    v_mfma_f32_16x16x32_bf16 v[208:211], a[224:227], v[96:99], v[200:203]
    v_exp_f32 v212, v212
    v_mfma_f32_16x16x32_bf16 v[208:211], a[228:231], v[100:103], v[208:211]
    v_exp_f32 v213, v213
    v_mfma_f32_16x16x32_bf16 v[208:211], a[232:235], v[104:107], v[208:211]
    v_exp_f32 v214, v214
    v_mfma_f32_16x16x32_bf16 v[208:211], a[236:239], v[108:111], v[208:211]
    v_exp_f32 v215, v215
    v_mfma_f32_16x16x32_bf16 a[112:115], a[184:187], v[160:163], a[112:115]
    ds_read_b64_tr_b16 a[164:165], v20 offset:40960
    v_cvt_pk_bf16_f32 v142, v212, v213
    v_mfma_f32_16x16x32_bf16 a[112:115], a[188:191], v[164:167], a[112:115]
    ds_read_b64_tr_b16 a[166:167], v20 offset:45056
    v_mfma_f32_16x16x32_bf16 a[116:119], a[184:187], v[168:171], a[116:119]
    ds_read_b128 a[220:223], v11 offset:49152
    v_cvt_pk_bf16_f32 v143, v214, v215
    v_mfma_f32_16x16x32_bf16 a[116:119], a[188:191], v[172:175], a[116:119]
    buffer_store_dwordx4 v[248:251], v232, s[24:27], s53 offen sc1
    v_mfma_f32_16x16x32_bf16 v[212:215], a[224:227], v[112:115], v[204:207]
    v_exp_f32 v208, v208
    v_mfma_f32_16x16x32_bf16 v[212:215], a[228:231], v[116:119], v[212:215]
    v_exp_f32 v209, v209
    v_mfma_f32_16x16x32_bf16 v[212:215], a[232:235], v[120:123], v[212:215]
    v_exp_f32 v210, v210
    v_mfma_f32_16x16x32_bf16 v[212:215], a[236:239], v[124:127], v[212:215]
    s_add_u32 s53, s53, 656
    v_exp_f32 v211, v211
    v_mfma_f32_16x16x32_bf16 a[120:123], a[184:187], v[176:179], a[120:123]
    ds_read_b64_tr_b16 a[168:169], v21 offset:32768
    v_cvt_pk_bf16_f32 v150, v208, v209
    v_mfma_f32_16x16x32_bf16 a[120:123], a[188:191], v[180:183], a[120:123]
    ds_read_b64_tr_b16 a[170:171], v21 offset:36864
    v_mfma_f32_16x16x32_bf16 a[124:127], a[184:187], v[184:187], a[124:127]
    ds_read_b128 a[224:227], v8 offset:53248
    v_cvt_pk_bf16_f32 v151, v210, v211
    v_mfma_f32_16x16x32_bf16 a[124:127], a[188:191], v[188:191], a[124:127]
    s_waitcnt lgkmcnt(3)
    buffer_load_dwordx4 v38, s[8:11], s40 offen offset:2048 lds
    v_mfma_f32_16x16x32_bf16 v[208:211], a[208:211], v[64:67], v[192:195]
    v_exp_f32 v212, v212
    v_mfma_f32_16x16x32_bf16 v[208:211], a[212:215], v[68:71], v[208:211]
    v_exp_f32 v213, v213
    v_mfma_f32_16x16x32_bf16 v[208:211], a[216:219], v[72:75], v[208:211]
    v_exp_f32 v214, v214
    v_mfma_f32_16x16x32_bf16 v[208:211], a[220:223], v[76:79], v[208:211]
    v_exp_f32 v215, v215
    v_mfma_f32_16x16x32_bf16 a[0:3], a[160:163], v[128:131], a[0:3]
    ds_read_b64_tr_b16 a[172:173], v21 offset:40960
    v_cvt_pk_bf16_f32 v158, v212, v213
    v_mfma_f32_16x16x32_bf16 a[0:3], a[164:167], v[132:135], a[0:3]
    ds_read_b64_tr_b16 a[174:175], v21 offset:45056
    v_mfma_f32_16x16x32_bf16 a[4:7], a[160:163], v[136:139], a[4:7]
    ds_read_b128 a[228:231], v9 offset:53248
    v_cvt_pk_bf16_f32 v159, v214, v215
    v_mfma_f32_16x16x32_bf16 a[4:7], a[164:167], v[140:143], a[4:7]
    v_mfma_f32_16x16x32_bf16 v[212:215], a[208:211], v[80:83], v[196:199]
    v_exp_f32 v208, v208
    v_mfma_f32_16x16x32_bf16 v[212:215], a[212:215], v[84:87], v[212:215]
    v_exp_f32 v209, v209
    v_mfma_f32_16x16x32_bf16 v[212:215], a[216:219], v[88:91], v[212:215]
    v_exp_f32 v210, v210
    v_mfma_f32_16x16x32_bf16 v[212:215], a[220:223], v[92:95], v[212:215]
    v_exp_f32 v211, v211
    v_mfma_f32_16x16x32_bf16 a[8:11], a[160:163], v[144:147], a[8:11]
    ds_read_b64_tr_b16 a[176:177], v22 offset:32768
    v_cvt_pk_bf16_f32 v160, v208, v209
    v_mfma_f32_16x16x32_bf16 a[8:11], a[164:167], v[148:151], a[8:11]
    ds_read_b64_tr_b16 a[178:179], v22 offset:36864
    v_mfma_f32_16x16x32_bf16 a[12:15], a[160:163], v[152:155], a[12:15]
    ds_read_b128 a[232:235], v10 offset:53248
    v_cvt_pk_bf16_f32 v161, v210, v211
    v_mfma_f32_16x16x32_bf16 a[12:15], a[164:167], v[156:159], a[12:15]
    s_waitcnt lgkmcnt(3)
    buffer_load_dwordx4 v39, s[8:11], s40 offen offset:3072 lds
    v_mfma_f32_16x16x32_bf16 v[208:211], a[208:211], v[96:99], v[200:203]
    v_exp_f32 v212, v212
    v_mfma_f32_16x16x32_bf16 v[208:211], a[212:215], v[100:103], v[208:211]
    s_add_u32 s40, s40, 16384
    v_exp_f32 v213, v213
    v_mfma_f32_16x16x32_bf16 v[208:211], a[216:219], v[104:107], v[208:211]
    v_exp_f32 v214, v214
    v_mfma_f32_16x16x32_bf16 v[208:211], a[220:223], v[108:111], v[208:211]
    v_exp_f32 v215, v215
    v_mfma_f32_16x16x32_bf16 a[16:19], a[168:171], v[128:131], a[16:19]
    ds_read_b64_tr_b16 a[180:181], v22 offset:40960
    v_cvt_pk_bf16_f32 v168, v212, v213
    v_mfma_f32_16x16x32_bf16 a[16:19], a[172:175], v[132:135], a[16:19]
    ds_read_b64_tr_b16 a[182:183], v22 offset:45056
    v_mfma_f32_16x16x32_bf16 a[20:23], a[168:171], v[136:139], a[20:23]
    ds_read_b128 a[236:239], v11 offset:53248
    v_cvt_pk_bf16_f32 v169, v214, v215
    v_mfma_f32_16x16x32_bf16 a[20:23], a[172:175], v[140:143], a[20:23]
    v_smfmac_f32_16x16x64_bf16 a[192:195], v[52:55], v[128:135], v50
    v_mfma_f32_16x16x32_bf16 v[212:215], a[208:211], v[112:115], v[204:207]
    v_exp_f32 v208, v208
    v_mfma_f32_16x16x32_bf16 v[212:215], a[212:215], v[116:119], v[212:215]
    s_add_u32 m0, s42, 65536
    v_exp_f32 v209, v209
    v_mfma_f32_16x16x32_bf16 v[212:215], a[216:219], v[120:123], v[212:215]
    v_exp_f32 v210, v210
    v_mfma_f32_16x16x32_bf16 v[212:215], a[220:223], v[124:127], v[212:215]
    v_exp_f32 v211, v211
    v_mfma_f32_16x16x32_bf16 a[24:27], a[168:171], v[144:147], a[24:27]
    ds_read_b64_tr_b16 a[184:185], v23 offset:32768
    v_cvt_pk_bf16_f32 v176, v208, v209
    v_mfma_f32_16x16x32_bf16 a[24:27], a[172:175], v[148:151], a[24:27]
    ds_read_b64_tr_b16 a[186:187], v23 offset:36864
    v_mfma_f32_16x16x32_bf16 a[28:31], a[168:171], v[152:155], a[28:31]
    ds_read_b128 a[208:211], v8 offset:57344
    v_cvt_pk_bf16_f32 v177, v210, v211
    v_mfma_f32_16x16x32_bf16 a[28:31], a[172:175], v[156:159], a[28:31]
    s_waitcnt lgkmcnt(3)
    buffer_load_dwordx4 v40, s[12:15], s41 offen lds
    v_mfma_f32_16x16x32_bf16 v[208:211], a[224:227], v[64:67], v[192:195]
    v_exp_f32 v212, v212
    v_mfma_f32_16x16x32_bf16 v[208:211], a[228:231], v[68:71], v[208:211]
    v_exp_f32 v213, v213
    v_mfma_f32_16x16x32_bf16 v[208:211], a[232:235], v[72:75], v[208:211]
    v_exp_f32 v214, v214
    v_mfma_f32_16x16x32_bf16 v[208:211], a[236:239], v[76:79], v[208:211]
    v_exp_f32 v215, v215
    v_mfma_f32_16x16x32_bf16 a[32:35], a[176:179], v[128:131], a[32:35]
    ds_read_b64_tr_b16 a[188:189], v23 offset:40960
    v_cvt_pk_bf16_f32 v184, v212, v213
    v_mfma_f32_16x16x32_bf16 a[32:35], a[180:183], v[132:135], a[32:35]
    ds_read_b64_tr_b16 a[190:191], v23 offset:45056
    v_mfma_f32_16x16x32_bf16 a[36:39], a[176:179], v[136:139], a[36:39]
    ds_read_b128 a[212:215], v9 offset:57344
    v_cvt_pk_bf16_f32 v185, v214, v215
    v_mfma_f32_16x16x32_bf16 a[36:39], a[180:183], v[140:143], a[36:39]
    v_smfmac_f32_16x16x64_bf16 a[196:199], v[52:55], v[136:143], v50
    v_mfma_f32_16x16x32_bf16 v[212:215], a[224:227], v[80:83], v[196:199]
    v_exp_f32 v208, v208
    v_mfma_f32_16x16x32_bf16 v[212:215], a[228:231], v[84:87], v[212:215]
    v_exp_f32 v209, v209
    v_mfma_f32_16x16x32_bf16 v[212:215], a[232:235], v[88:91], v[212:215]
    v_exp_f32 v210, v210
    v_mfma_f32_16x16x32_bf16 v[212:215], a[236:239], v[92:95], v[212:215]
    v_exp_f32 v211, v211
    v_mfma_f32_16x16x32_bf16 a[40:43], a[176:179], v[144:147], a[40:43]
    ds_read_b64_tr_b16 a[160:161], v24 offset:32768
    v_cvt_pk_bf16_f32 v162, v208, v209
    v_mfma_f32_16x16x32_bf16 a[40:43], a[180:183], v[148:151], a[40:43]
    ds_read_b64_tr_b16 a[162:163], v24 offset:36864
    v_mfma_f32_16x16x32_bf16 a[44:47], a[176:179], v[152:155], a[44:47]
    ds_read_b128 a[216:219], v10 offset:57344
    v_cvt_pk_bf16_f32 v163, v210, v211
    v_mfma_f32_16x16x32_bf16 a[44:47], a[180:183], v[156:159], a[44:47]
    s_waitcnt lgkmcnt(3)
    buffer_load_dwordx4 v41, s[12:15], s41 offen offset:1024 lds
    v_mfma_f32_16x16x32_bf16 v[208:211], a[224:227], v[96:99], v[200:203]
    v_exp_f32 v212, v212
    v_mfma_f32_16x16x32_bf16 v[208:211], a[228:231], v[100:103], v[208:211]
    v_exp_f32 v213, v213
    v_mfma_f32_16x16x32_bf16 v[208:211], a[232:235], v[104:107], v[208:211]
    v_exp_f32 v214, v214
    v_mfma_f32_16x16x32_bf16 v[208:211], a[236:239], v[108:111], v[208:211]
    v_exp_f32 v215, v215
    v_mfma_f32_16x16x32_bf16 a[48:51], a[184:187], v[128:131], a[48:51]
    ds_read_b64_tr_b16 a[164:165], v24 offset:40960
    v_cvt_pk_bf16_f32 v170, v212, v213
    v_mfma_f32_16x16x32_bf16 a[48:51], a[188:191], v[132:135], a[48:51]
    ds_read_b64_tr_b16 a[166:167], v24 offset:45056
    v_mfma_f32_16x16x32_bf16 a[52:55], a[184:187], v[136:139], a[52:55]
    ds_read_b128 a[220:223], v11 offset:57344
    v_cvt_pk_bf16_f32 v171, v214, v215
    v_mfma_f32_16x16x32_bf16 a[52:55], a[188:191], v[140:143], a[52:55]
    v_smfmac_f32_16x16x64_bf16 a[200:203], v[52:55], v[144:151], v50
    v_mfma_f32_16x16x32_bf16 v[212:215], a[224:227], v[112:115], v[204:207]
    v_exp_f32 v208, v208
    v_mfma_f32_16x16x32_bf16 v[212:215], a[228:231], v[116:119], v[212:215]
    v_exp_f32 v209, v209
    v_mfma_f32_16x16x32_bf16 v[212:215], a[232:235], v[120:123], v[212:215]
    v_exp_f32 v210, v210
    v_mfma_f32_16x16x32_bf16 v[212:215], a[236:239], v[124:127], v[212:215]
    v_exp_f32 v211, v211
    v_mfma_f32_16x16x32_bf16 a[56:59], a[184:187], v[144:147], a[56:59]
    ds_read_b64_tr_b16 a[168:169], v25 offset:32768
    v_cvt_pk_bf16_f32 v178, v208, v209
    v_mfma_f32_16x16x32_bf16 a[56:59], a[188:191], v[148:151], a[56:59]
    ds_read_b64_tr_b16 a[170:171], v25 offset:36864
    v_mfma_f32_16x16x32_bf16 a[60:63], a[184:187], v[152:155], a[60:63]
    ds_read_b128 a[224:227], v8 offset:61440
    v_cvt_pk_bf16_f32 v179, v210, v211
    v_mfma_f32_16x16x32_bf16 a[60:63], a[188:191], v[156:159], a[60:63]
    s_waitcnt lgkmcnt(3)
    buffer_load_dwordx4 v40, s[12:15], s41 offen offset:2048 lds
    v_mfma_f32_16x16x32_bf16 v[208:211], a[208:211], v[64:67], v[192:195]
    v_exp_f32 v212, v212
    v_mfma_f32_16x16x32_bf16 v[208:211], a[212:215], v[68:71], v[208:211]
    v_exp_f32 v213, v213
    v_mfma_f32_16x16x32_bf16 v[208:211], a[216:219], v[72:75], v[208:211]
    v_exp_f32 v214, v214
    v_mfma_f32_16x16x32_bf16 v[208:211], a[220:223], v[76:79], v[208:211]
    v_exp_f32 v215, v215
    v_mfma_f32_16x16x32_bf16 a[64:67], a[160:163], v[128:131], a[64:67]
    ds_read_b64_tr_b16 a[172:173], v25 offset:40960
    v_cvt_pk_bf16_f32 v186, v212, v213
    v_mfma_f32_16x16x32_bf16 a[64:67], a[164:167], v[132:135], a[64:67]
    ds_read_b64_tr_b16 a[174:175], v25 offset:45056
    v_mfma_f32_16x16x32_bf16 a[68:71], a[160:163], v[136:139], a[68:71]
    ds_read_b128 a[228:231], v9 offset:61440
    v_cvt_pk_bf16_f32 v187, v214, v215
    v_mfma_f32_16x16x32_bf16 a[68:71], a[164:167], v[140:143], a[68:71]
    v_smfmac_f32_16x16x64_bf16 a[204:207], v[52:55], v[152:159], v50
    v_mfma_f32_16x16x32_bf16 v[212:215], a[208:211], v[80:83], v[196:199]
    v_exp_f32 v208, v208
    v_mfma_f32_16x16x32_bf16 v[212:215], a[212:215], v[84:87], v[212:215]
    v_exp_f32 v209, v209
    v_mfma_f32_16x16x32_bf16 v[212:215], a[216:219], v[88:91], v[212:215]
    v_exp_f32 v210, v210
    v_mfma_f32_16x16x32_bf16 v[212:215], a[220:223], v[92:95], v[212:215]
    v_exp_f32 v211, v211
    v_mfma_f32_16x16x32_bf16 a[72:75], a[160:163], v[144:147], a[72:75]
    ds_read_b64_tr_b16 a[176:177], v26 offset:32768
    v_cvt_pk_bf16_f32 v164, v208, v209
    v_mfma_f32_16x16x32_bf16 a[72:75], a[164:167], v[148:151], a[72:75]
    ds_read_b64_tr_b16 a[178:179], v26 offset:36864
    v_mfma_f32_16x16x32_bf16 a[76:79], a[160:163], v[152:155], a[76:79]
    ds_read_b128 a[232:235], v10 offset:61440
    v_cvt_pk_bf16_f32 v165, v210, v211
    v_mfma_f32_16x16x32_bf16 a[76:79], a[164:167], v[156:159], a[76:79]
    s_waitcnt lgkmcnt(3)
    buffer_load_dwordx4 v41, s[12:15], s41 offen offset:3072 lds
    v_mfma_f32_16x16x32_bf16 v[208:211], a[208:211], v[96:99], v[200:203]
    v_exp_f32 v212, v212
    v_mfma_f32_16x16x32_bf16 v[208:211], a[212:215], v[100:103], v[208:211]
    s_add_u32 s41, s41, 16384
    v_exp_f32 v213, v213
    v_mfma_f32_16x16x32_bf16 v[208:211], a[216:219], v[104:107], v[208:211]
    v_exp_f32 v214, v214
    v_mfma_f32_16x16x32_bf16 v[208:211], a[220:223], v[108:111], v[208:211]
    v_exp_f32 v215, v215
    v_mfma_f32_16x16x32_bf16 a[80:83], a[168:171], v[128:131], a[80:83]
    ds_read_b64_tr_b16 a[180:181], v26 offset:40960
    v_cvt_pk_bf16_f32 v172, v212, v213
    v_mfma_f32_16x16x32_bf16 a[80:83], a[172:175], v[132:135], a[80:83]
    ds_read_b64_tr_b16 a[182:183], v26 offset:45056
    v_mfma_f32_16x16x32_bf16 a[84:87], a[168:171], v[136:139], a[84:87]
    ds_read_b128 a[236:239], v11 offset:61440
    v_cvt_pk_bf16_f32 v173, v214, v215
    v_mfma_f32_16x16x32_bf16 a[84:87], a[172:175], v[140:143], a[84:87]
    s_waitcnt vmcnt(10)
    s_barrier
    v_mfma_f32_16x16x32_bf16 v[212:215], a[208:211], v[112:115], v[204:207]
    v_exp_f32 v208, v208
    v_mfma_f32_16x16x32_bf16 v[212:215], a[212:215], v[116:119], v[212:215]
    s_add_u32 m0, s42, 32768
    v_exp_f32 v209, v209
    v_mfma_f32_16x16x32_bf16 v[212:215], a[216:219], v[120:123], v[212:215]
    v_exp_f32 v210, v210
    v_mfma_f32_16x16x32_bf16 v[212:215], a[220:223], v[124:127], v[212:215]
    v_exp_f32 v211, v211
    v_mfma_f32_16x16x32_bf16 a[88:91], a[168:171], v[144:147], a[88:91]
    ds_read_b64_tr_b16 a[184:185], v27 offset:32768
    v_cvt_pk_bf16_f32 v180, v208, v209
    v_mfma_f32_16x16x32_bf16 a[88:91], a[172:175], v[148:151], a[88:91]
    ds_read_b64_tr_b16 a[186:187], v27 offset:36864
    v_mfma_f32_16x16x32_bf16 a[92:95], a[168:171], v[152:155], a[92:95]
    ds_read_b128 a[208:211], v8 offset:0
    v_cvt_pk_bf16_f32 v181, v210, v211
    v_mfma_f32_16x16x32_bf16 a[92:95], a[172:175], v[156:159], a[92:95]
    s_waitcnt lgkmcnt(3)
    buffer_load_dwordx4 v36, s[8:11], s40 offen lds
    v_mfma_f32_16x16x32_bf16 v[208:211], a[224:227], v[64:67], v[192:195]
    v_exp_f32 v212, v212
    v_mfma_f32_16x16x32_bf16 v[208:211], a[228:231], v[68:71], v[208:211]
    v_exp_f32 v213, v213
    v_mfma_f32_16x16x32_bf16 v[208:211], a[232:235], v[72:75], v[208:211]
    v_exp_f32 v214, v214
    v_mfma_f32_16x16x32_bf16 v[208:211], a[236:239], v[76:79], v[208:211]
    v_exp_f32 v215, v215
    v_mfma_f32_16x16x32_bf16 a[96:99], a[176:179], v[128:131], a[96:99]
    ds_read_b64_tr_b16 a[188:189], v27 offset:40960
    v_cvt_pk_bf16_f32 v188, v212, v213
    v_mfma_f32_16x16x32_bf16 a[96:99], a[180:183], v[132:135], a[96:99]
    ds_read_b64_tr_b16 a[190:191], v27 offset:45056
    v_mfma_f32_16x16x32_bf16 a[100:103], a[176:179], v[136:139], a[100:103]
    ds_read_b128 a[212:215], v9 offset:0
    v_cvt_pk_bf16_f32 v189, v214, v215
    v_mfma_f32_16x16x32_bf16 a[100:103], a[180:183], v[140:143], a[100:103]
    buffer_load_dword v219, v62, s[84:87], s38 offen
    v_mfma_f32_16x16x32_bf16 v[212:215], a[224:227], v[80:83], v[196:199]
    v_exp_f32 v208, v208
    v_mfma_f32_16x16x32_bf16 v[212:215], a[228:231], v[84:87], v[212:215]
    v_exp_f32 v209, v209
    v_mfma_f32_16x16x32_bf16 v[212:215], a[232:235], v[88:91], v[212:215]
    v_exp_f32 v210, v210
    v_mfma_f32_16x16x32_bf16 v[212:215], a[236:239], v[92:95], v[212:215]
    v_exp_f32 v211, v211
    v_mfma_f32_16x16x32_bf16 a[104:107], a[176:179], v[144:147], a[104:107]
    ds_read_b64_tr_b16 a[160:161], v20 offset:49152
    v_cvt_pk_bf16_f32 v166, v208, v209
    v_mfma_f32_16x16x32_bf16 a[104:107], a[180:183], v[148:151], a[104:107]
    ds_read_b64_tr_b16 a[162:163], v20 offset:53248
    v_mfma_f32_16x16x32_bf16 a[108:111], a[176:179], v[152:155], a[108:111]
    ds_read_b128 a[216:219], v10 offset:0
    v_cvt_pk_bf16_f32 v167, v210, v211
    v_mfma_f32_16x16x32_bf16 a[108:111], a[180:183], v[156:159], a[108:111]
    s_waitcnt lgkmcnt(3)
    buffer_load_dwordx4 v37, s[8:11], s40 offen offset:1024 lds
    v_mfma_f32_16x16x32_bf16 v[208:211], a[224:227], v[96:99], v[200:203]
    v_exp_f32 v212, v212
    v_mfma_f32_16x16x32_bf16 v[208:211], a[228:231], v[100:103], v[208:211]
    v_exp_f32 v213, v213
    v_mfma_f32_16x16x32_bf16 v[208:211], a[232:235], v[104:107], v[208:211]
    v_exp_f32 v214, v214
    v_mfma_f32_16x16x32_bf16 v[208:211], a[236:239], v[108:111], v[208:211]
    v_exp_f32 v215, v215
    v_mfma_f32_16x16x32_bf16 a[112:115], a[184:187], v[128:131], a[112:115]
    ds_read_b64_tr_b16 a[164:165], v20 offset:57344
    v_cvt_pk_bf16_f32 v174, v212, v213
    v_mfma_f32_16x16x32_bf16 a[112:115], a[188:191], v[132:135], a[112:115]
    ds_read_b64_tr_b16 a[166:167], v20 offset:61440
    v_mfma_f32_16x16x32_bf16 a[116:119], a[184:187], v[136:139], a[116:119]
    ds_read_b128 a[220:223], v11 offset:0
    v_cvt_pk_bf16_f32 v175, v214, v215
    v_mfma_f32_16x16x32_bf16 a[116:119], a[188:191], v[140:143], a[116:119]
    v_mfma_f32_16x16x32_bf16 v[212:215], a[224:227], v[112:115], v[204:207]
    v_exp_f32 v208, v208
    v_mfma_f32_16x16x32_bf16 v[212:215], a[228:231], v[116:119], v[212:215]
    v_exp_f32 v209, v209
    v_mfma_f32_16x16x32_bf16 v[212:215], a[232:235], v[120:123], v[212:215]
    v_exp_f32 v210, v210
    v_mfma_f32_16x16x32_bf16 v[212:215], a[236:239], v[124:127], v[212:215]
    v_exp_f32 v211, v211
    v_mfma_f32_16x16x32_bf16 a[120:123], a[184:187], v[144:147], a[120:123]
    ds_read_b64_tr_b16 a[168:169], v21 offset:49152
    v_cvt_pk_bf16_f32 v182, v208, v209
    v_mfma_f32_16x16x32_bf16 a[120:123], a[188:191], v[148:151], a[120:123]
    ds_read_b64_tr_b16 a[170:171], v21 offset:53248
    v_mfma_f32_16x16x32_bf16 a[124:127], a[184:187], v[152:155], a[124:127]
    ds_read_b128 a[224:227], v8 offset:4096
    v_cvt_pk_bf16_f32 v183, v210, v211
    v_mfma_f32_16x16x32_bf16 a[124:127], a[188:191], v[156:159], a[124:127]
    s_waitcnt lgkmcnt(3)
    buffer_load_dwordx4 v38, s[8:11], s40 offen offset:2048 lds
    v_mfma_f32_16x16x32_bf16 v[208:211], a[208:211], v[64:67], v[192:195]
    v_exp_f32 v212, v212
    v_mfma_f32_16x16x32_bf16 v[208:211], a[212:215], v[68:71], v[208:211]
    v_exp_f32 v213, v213
    v_mfma_f32_16x16x32_bf16 v[208:211], a[216:219], v[72:75], v[208:211]
    v_exp_f32 v214, v214
    v_mfma_f32_16x16x32_bf16 v[208:211], a[220:223], v[76:79], v[208:211]
    v_exp_f32 v215, v215
    v_mfma_f32_16x16x32_bf16 a[0:3], a[160:163], v[160:163], a[0:3]
    ds_read_b64_tr_b16 a[172:173], v21 offset:57344
    v_cvt_pk_bf16_f32 v190, v212, v213
    v_mfma_f32_16x16x32_bf16 a[0:3], a[164:167], v[164:167], a[0:3]
    ds_read_b64_tr_b16 a[174:175], v21 offset:61440
    v_lshlrev_b32 v244, 16, v240
    v_mfma_f32_16x16x32_bf16 a[4:7], a[160:163], v[168:171], a[4:7]
    ds_read_b128 a[228:231], v9 offset:4096
    v_cvt_pk_bf16_f32 v191, v214, v215
    v_mfma_f32_16x16x32_bf16 a[4:7], a[164:167], v[172:175], a[4:7]
    v_and_b32 v245, 0xffff0000, v240
    v_fmac_f32 v224, v2, v244
    v_mfma_f32_16x16x32_bf16 v[212:215], a[208:211], v[80:83], v[196:199]
    v_exp_f32 v208, v208
    v_mfma_f32_16x16x32_bf16 v[212:215], a[212:215], v[84:87], v[212:215]
    v_exp_f32 v209, v209
    v_mfma_f32_16x16x32_bf16 v[212:215], a[216:219], v[88:91], v[212:215]
    v_exp_f32 v210, v210
    v_mfma_f32_16x16x32_bf16 v[212:215], a[220:223], v[92:95], v[212:215]
    v_exp_f32 v211, v211
    v_mfma_f32_16x16x32_bf16 a[8:11], a[160:163], v[176:179], a[8:11]
    ds_read_b64_tr_b16 a[176:177], v22 offset:49152
    v_cvt_pk_bf16_f32 v128, v208, v209
    v_mfma_f32_16x16x32_bf16 a[8:11], a[164:167], v[180:183], a[8:11]
    ds_read_b64_tr_b16 a[178:179], v22 offset:53248
    v_fmac_f32 v225, v2, v245
    v_mfma_f32_16x16x32_bf16 a[12:15], a[160:163], v[184:187], a[12:15]
    ds_read_b128 a[232:235], v10 offset:4096
    v_cvt_pk_bf16_f32 v129, v210, v211
    v_mfma_f32_16x16x32_bf16 a[12:15], a[164:167], v[188:191], a[12:15]
    s_waitcnt lgkmcnt(3)
    buffer_load_dwordx4 v39, s[8:11], s40 offen offset:3072 lds
    v_mfma_f32_16x16x32_bf16 v[208:211], a[208:211], v[96:99], v[200:203]
    v_exp_f32 v212, v212
    v_mfma_f32_16x16x32_bf16 v[208:211], a[212:215], v[100:103], v[208:211]
    s_add_u32 s40, s40, 16384
    v_exp_f32 v213, v213
    v_mfma_f32_16x16x32_bf16 v[208:211], a[216:219], v[104:107], v[208:211]
    v_exp_f32 v214, v214
    v_mfma_f32_16x16x32_bf16 v[208:211], a[220:223], v[108:111], v[208:211]
    v_exp_f32 v215, v215
    v_mfma_f32_16x16x32_bf16 a[16:19], a[168:171], v[160:163], a[16:19]
    ds_read_b64_tr_b16 a[180:181], v22 offset:57344
    v_cvt_pk_bf16_f32 v136, v212, v213
    v_mfma_f32_16x16x32_bf16 a[16:19], a[172:175], v[164:167], a[16:19]
Ltour5:
    s_cbranch_execz Ltour9
    ds_read_b64_tr_b16 a[182:183], v22 offset:61440
    v_lshlrev_b32 v246, 16, v241
    v_mfma_f32_16x16x32_bf16 a[20:23], a[168:171], v[168:171], a[20:23]
    ds_read_b128 a[236:239], v11 offset:4096
    v_cvt_pk_bf16_f32 v137, v214, v215
    v_mfma_f32_16x16x32_bf16 a[20:23], a[172:175], v[172:175], a[20:23]
    v_and_b32 v247, 0xffff0000, v241
    v_fmac_f32 v226, v2, v246
    v_smfmac_f32_16x16x64_bf16 a[192:195], v[52:55], v[160:167], v50
    v_mfma_f32_16x16x32_bf16 v[212:215], a[208:211], v[112:115], v[204:207]
    v_exp_f32 v208, v208
    v_mfma_f32_16x16x32_bf16 v[212:215], a[212:215], v[116:119], v[212:215]
    s_add_u32 m0, s42, 81920
    v_exp_f32 v209, v209
    v_mfma_f32_16x16x32_bf16 v[212:215], a[216:219], v[120:123], v[212:215]
    v_exp_f32 v210, v210
    v_mfma_f32_16x16x32_bf16 v[212:215], a[220:223], v[124:127], v[212:215]
    v_exp_f32 v211, v211
    v_mfma_f32_16x16x32_bf16 a[24:27], a[168:171], v[176:179], a[24:27]
    ds_read_b64_tr_b16 a[184:185], v23 offset:49152
    v_cvt_pk_bf16_f32 v144, v208, v209
    v_mfma_f32_16x16x32_bf16 a[24:27], a[172:175], v[180:183], a[24:27]
    ds_read_b64_tr_b16 a[186:187], v23 offset:53248
    v_fmac_f32 v227, v2, v247
    v_mfma_f32_16x16x32_bf16 a[28:31], a[168:171], v[184:187], a[28:31]
    ds_read_b128 a[208:211], v8 offset:8192
    v_cvt_pk_bf16_f32 v145, v210, v211
    v_mfma_f32_16x16x32_bf16 a[28:31], a[172:175], v[188:191], a[28:31]
    s_waitcnt lgkmcnt(3)
    buffer_load_dwordx4 v40, s[12:15], s41 offen lds
    v_mfma_f32_16x16x32_bf16 v[208:211], a[224:227], v[64:67], v[192:195]
    v_exp_f32 v212, v212
    v_mfma_f32_16x16x32_bf16 v[208:211], a[228:231], v[68:71], v[208:211]
    v_exp_f32 v213, v213
    v_mfma_f32_16x16x32_bf16 v[208:211], a[232:235], v[72:75], v[208:211]
    v_exp_f32 v214, v214
    v_mfma_f32_16x16x32_bf16 v[208:211], a[236:239], v[76:79], v[208:211]
    v_exp_f32 v215, v215
    v_mfma_f32_16x16x32_bf16 a[32:35], a[176:179], v[160:163], a[32:35]
    ds_read_b64_tr_b16 a[188:189], v23 offset:57344
    v_cvt_pk_bf16_f32 v152, v212, v213
    v_mfma_f32_16x16x32_bf16 a[32:35], a[180:183], v[164:167], a[32:35]
    ds_read_b64_tr_b16 a[190:191], v23 offset:61440
    v_lshlrev_b32 v244, 16, v242
    v_mfma_f32_16x16x32_bf16 a[36:39], a[176:179], v[168:171], a[36:39]
    ds_read_b128 a[212:215], v9 offset:8192
    v_cvt_pk_bf16_f32 v153, v214, v215
    v_mfma_f32_16x16x32_bf16 a[36:39], a[180:183], v[172:175], a[36:39]
    v_and_b32 v245, 0xffff0000, v242
    v_fmac_f32 v228, v2, v244
    v_smfmac_f32_16x16x64_bf16 a[196:199], v[52:55], v[168:175], v50
    v_mfma_f32_16x16x32_bf16 v[212:215], a[224:227], v[80:83], v[196:199]
    v_exp_f32 v208, v208
    v_mfma_f32_16x16x32_bf16 v[212:215], a[228:231], v[84:87], v[212:215]
    v_exp_f32 v209, v209
    v_mfma_f32_16x16x32_bf16 v[212:215], a[232:235], v[88:91], v[212:215]
    v_exp_f32 v210, v210
    v_mfma_f32_16x16x32_bf16 v[212:215], a[236:239], v[92:95], v[212:215]
    v_exp_f32 v211, v211
    v_mfma_f32_16x16x32_bf16 a[40:43], a[176:179], v[176:179], a[40:43]
    ds_read_b64_tr_b16 a[160:161], v24 offset:49152
    v_cvt_pk_bf16_f32 v130, v208, v209
    v_mfma_f32_16x16x32_bf16 a[40:43], a[180:183], v[180:183], a[40:43]
    ds_read_b64_tr_b16 a[162:163], v24 offset:53248
    v_fmac_f32 v229, v2, v245
    v_mfma_f32_16x16x32_bf16 a[44:47], a[176:179], v[184:187], a[44:47]
    ds_read_b128 a[216:219], v10 offset:8192
    v_cvt_pk_bf16_f32 v131, v210, v211
    v_mfma_f32_16x16x32_bf16 a[44:47], a[180:183], v[188:191], a[44:47]
    s_waitcnt lgkmcnt(3)
    buffer_load_dwordx4 v41, s[12:15], s41 offen offset:1024 lds
    v_mfma_f32_16x16x32_bf16 v[208:211], a[224:227], v[96:99], v[200:203]
    v_exp_f32 v212, v212
    v_mfma_f32_16x16x32_bf16 v[208:211], a[228:231], v[100:103], v[208:211]
    v_exp_f32 v213, v213
    v_mfma_f32_16x16x32_bf16 v[208:211], a[232:235], v[104:107], v[208:211]
    v_exp_f32 v214, v214
    v_mfma_f32_16x16x32_bf16 v[208:211], a[236:239], v[108:111], v[208:211]
    v_exp_f32 v215, v215
    v_mfma_f32_16x16x32_bf16 a[48:51], a[184:187], v[160:163], a[48:51]
    ds_read_b64_tr_b16 a[164:165], v24 offset:57344
    v_cvt_pk_bf16_f32 v138, v212, v213
    v_mfma_f32_16x16x32_bf16 a[48:51], a[188:191], v[164:167], a[48:51]
    ds_read_b64_tr_b16 a[166:167], v24 offset:61440
    v_lshlrev_b32 v246, 16, v243
    v_mfma_f32_16x16x32_bf16 a[52:55], a[184:187], v[168:171], a[52:55]
    ds_read_b128 a[220:223], v11 offset:8192
    v_cvt_pk_bf16_f32 v139, v214, v215
    v_mfma_f32_16x16x32_bf16 a[52:55], a[188:191], v[172:175], a[52:55]
    v_and_b32 v247, 0xffff0000, v243
    v_fmac_f32 v230, v2, v246
    v_smfmac_f32_16x16x64_bf16 a[200:203], v[52:55], v[176:183], v50
    v_mfma_f32_16x16x32_bf16 v[212:215], a[224:227], v[112:115], v[204:207]
    v_exp_f32 v208, v208
    v_mfma_f32_16x16x32_bf16 v[212:215], a[228:231], v[116:119], v[212:215]
    v_exp_f32 v209, v209
    v_mfma_f32_16x16x32_bf16 v[212:215], a[232:235], v[120:123], v[212:215]
    v_exp_f32 v210, v210
    v_mfma_f32_16x16x32_bf16 v[212:215], a[236:239], v[124:127], v[212:215]
    v_exp_f32 v211, v211
    v_mfma_f32_16x16x32_bf16 a[56:59], a[184:187], v[176:179], a[56:59]
    ds_read_b64_tr_b16 a[168:169], v25 offset:49152
    v_cvt_pk_bf16_f32 v146, v208, v209
    v_mfma_f32_16x16x32_bf16 a[56:59], a[188:191], v[180:183], a[56:59]
    ds_read_b64_tr_b16 a[170:171], v25 offset:53248
    v_fmac_f32 v231, v2, v247
    v_mfma_f32_16x16x32_bf16 a[60:63], a[184:187], v[184:187], a[60:63]
    ds_read_b128 a[224:227], v8 offset:12288
    v_cvt_pk_bf16_f32 v147, v210, v211
    v_mfma_f32_16x16x32_bf16 a[60:63], a[188:191], v[188:191], a[60:63]
    s_waitcnt lgkmcnt(3)
    buffer_load_dwordx4 v40, s[12:15], s41 offen offset:2048 lds
    v_mfma_f32_16x16x32_bf16 v[208:211], a[208:211], v[64:67], v[192:195]
    v_exp_f32 v212, v212
    v_mfma_f32_16x16x32_bf16 v[208:211], a[212:215], v[68:71], v[208:211]
    v_exp_f32 v213, v213
    v_mfma_f32_16x16x32_bf16 v[208:211], a[216:219], v[72:75], v[208:211]
    v_exp_f32 v214, v214
    v_mfma_f32_16x16x32_bf16 v[208:211], a[220:223], v[76:79], v[208:211]
    v_exp_f32 v215, v215
    v_mfma_f32_16x16x32_bf16 a[64:67], a[160:163], v[160:163], a[64:67]
    ds_read_b64_tr_b16 a[172:173], v25 offset:57344
    v_cvt_pk_bf16_f32 v154, v212, v213
    v_mfma_f32_16x16x32_bf16 a[64:67], a[164:167], v[164:167], a[64:67]
    ds_read_b64_tr_b16 a[174:175], v25 offset:61440
    v_mov_b32 v2, v3
    v_mfma_f32_16x16x32_bf16 a[68:71], a[160:163], v[168:171], a[68:71]
    ds_read_b128 a[228:231], v9 offset:12288
    v_cvt_pk_bf16_f32 v155, v214, v215
    v_mfma_f32_16x16x32_bf16 a[68:71], a[164:167], v[172:175], a[68:71]
    v_mov_b32 v3, v4
    v_mov_b32 v4, v5
    v_smfmac_f32_16x16x64_bf16 a[204:207], v[52:55], v[184:191], v50
    v_mfma_f32_16x16x32_bf16 v[212:215], a[208:211], v[80:83], v[196:199]
    v_exp_f32 v208, v208
    v_mfma_f32_16x16x32_bf16 v[212:215], a[212:215], v[84:87], v[212:215]
    v_exp_f32 v209, v209
    v_mfma_f32_16x16x32_bf16 v[212:215], a[216:219], v[88:91], v[212:215]
    v_exp_f32 v210, v210
    v_mfma_f32_16x16x32_bf16 v[212:215], a[220:223], v[92:95], v[212:215]
    v_exp_f32 v211, v211
    v_mfma_f32_16x16x32_bf16 a[72:75], a[160:163], v[176:179], a[72:75]
    ds_read_b64_tr_b16 a[176:177], v26 offset:49152
    v_cvt_pk_bf16_f32 v132, v208, v209
    v_mfma_f32_16x16x32_bf16 a[72:75], a[164:167], v[180:183], a[72:75]
    ds_read_b64_tr_b16 a[178:179], v26 offset:53248
    v_mov_b32 v5, v6
    v_mfma_f32_16x16x32_bf16 a[76:79], a[160:163], v[184:187], a[76:79]
    ds_read_b128 a[232:235], v10 offset:12288
    v_cvt_pk_bf16_f32 v133, v210, v211
    v_mfma_f32_16x16x32_bf16 a[76:79], a[164:167], v[188:191], a[76:79]
    s_waitcnt lgkmcnt(3)
    buffer_load_dwordx4 v41, s[12:15], s41 offen offset:3072 lds
    v_mfma_f32_16x16x32_bf16 v[208:211], a[208:211], v[96:99], v[200:203]
    v_exp_f32 v212, v212
    v_mfma_f32_16x16x32_bf16 v[208:211], a[212:215], v[100:103], v[208:211]
    s_add_u32 s41, s41, 16384
    v_exp_f32 v213, v213
    v_mfma_f32_16x16x32_bf16 v[208:211], a[216:219], v[104:107], v[208:211]
    v_exp_f32 v214, v214
    v_mfma_f32_16x16x32_bf16 v[208:211], a[220:223], v[108:111], v[208:211]
    v_exp_f32 v215, v215
    v_mfma_f32_16x16x32_bf16 a[80:83], a[168:171], v[160:163], a[80:83]
    ds_read_b64_tr_b16 a[180:181], v26 offset:57344
    v_cvt_pk_bf16_f32 v140, v212, v213
    v_mfma_f32_16x16x32_bf16 a[80:83], a[172:175], v[164:167], a[80:83]
    ds_read_b64_tr_b16 a[182:183], v26 offset:61440
    v_mfma_f32_16x16x32_bf16 a[84:87], a[168:171], v[168:171], a[84:87]
    ds_read_b128 a[236:239], v11 offset:12288
    v_cvt_pk_bf16_f32 v141, v214, v215
    v_mfma_f32_16x16x32_bf16 a[84:87], a[172:175], v[172:175], a[84:87]
    s_waitcnt vmcnt(9)
    s_barrier
    v_mfma_f32_16x16x32_bf16 v[212:215], a[208:211], v[112:115], v[204:207]
    v_exp_f32 v208, v208
    v_mfma_f32_16x16x32_bf16 v[212:215], a[212:215], v[116:119], v[212:215]
    s_add_u32 m0, s42, 49152
    v_exp_f32 v209, v209
    v_mfma_f32_16x16x32_bf16 v[212:215], a[216:219], v[120:123], v[212:215]
    v_exp_f32 v210, v210
    v_mfma_f32_16x16x32_bf16 v[212:215], a[220:223], v[124:127], v[212:215]
    v_exp_f32 v211, v211
    v_mfma_f32_16x16x32_bf16 a[88:91], a[168:171], v[176:179], a[88:91]
    ds_read_b64_tr_b16 a[184:185], v27 offset:49152
    v_cvt_pk_bf16_f32 v148, v208, v209
    v_mfma_f32_16x16x32_bf16 a[88:91], a[172:175], v[180:183], a[88:91]
    ds_read_b64_tr_b16 a[186:187], v27 offset:53248
    v_mfma_f32_16x16x32_bf16 a[92:95], a[168:171], v[184:187], a[92:95]
    ds_read_b128 a[208:211], v8 offset:16384
    v_cvt_pk_bf16_f32 v149, v210, v211
    v_mfma_f32_16x16x32_bf16 a[92:95], a[172:175], v[188:191], a[92:95]
    s_waitcnt lgkmcnt(3)
    buffer_load_dwordx4 v36, s[8:11], s40 offen lds
    v_mfma_f32_16x16x32_bf16 v[208:211], a[224:227], v[64:67], v[192:195]
    v_exp_f32 v212, v212
    v_mfma_f32_16x16x32_bf16 v[208:211], a[228:231], v[68:71], v[208:211]
    v_exp_f32 v213, v213
    v_mfma_f32_16x16x32_bf16 v[208:211], a[232:235], v[72:75], v[208:211]
    v_exp_f32 v214, v214
    v_mfma_f32_16x16x32_bf16 v[208:211], a[236:239], v[76:79], v[208:211]
    v_exp_f32 v215, v215
    v_mfma_f32_16x16x32_bf16 a[96:99], a[176:179], v[160:163], a[96:99]
    ds_read_b64_tr_b16 a[188:189], v27 offset:57344
    v_cvt_pk_bf16_f32 v156, v212, v213
    v_mfma_f32_16x16x32_bf16 a[96:99], a[180:183], v[164:167], a[96:99]
    ds_read_b64_tr_b16 a[190:191], v27 offset:61440
    v_mfma_f32_16x16x32_bf16 a[100:103], a[176:179], v[168:171], a[100:103]
    ds_read_b128 a[212:215], v9 offset:16384
    v_cvt_pk_bf16_f32 v157, v214, v215
    v_mfma_f32_16x16x32_bf16 a[100:103], a[180:183], v[172:175], a[100:103]
    buffer_load_dword v216, v237, s[28:31], s52 offen
    v_mfma_f32_16x16x32_bf16 v[212:215], a[224:227], v[80:83], v[196:199]
    v_exp_f32 v208, v208
    v_mfma_f32_16x16x32_bf16 v[212:215], a[228:231], v[84:87], v[212:215]
    s_sub_u32 s39, s39, 36864
    v_exp_f32 v209, v209
    v_mfma_f32_16x16x32_bf16 v[212:215], a[232:235], v[88:91], v[212:215]
    s_sub_u32 s38, s38, 4608
    v_exp_f32 v210, v210
    v_mfma_f32_16x16x32_bf16 v[212:215], a[236:239], v[92:95], v[212:215]
    s_add_u32 s52, s52, 2304
    v_exp_f32 v211, v211
    v_mfma_f32_16x16x32_bf16 a[104:107], a[176:179], v[176:179], a[104:107]
    ds_read_b64_tr_b16 a[160:161], v20 offset:0
    v_cvt_pk_bf16_f32 v134, v208, v209
    v_mfma_f32_16x16x32_bf16 a[104:107], a[180:183], v[180:183], a[104:107]
    ds_read_b64_tr_b16 a[162:163], v20 offset:4096
    v_mfma_f32_16x16x32_bf16 a[108:111], a[176:179], v[184:187], a[108:111]
    ds_read_b128 a[216:219], v10 offset:16384
    v_cvt_pk_bf16_f32 v135, v210, v211
    v_mfma_f32_16x16x32_bf16 a[108:111], a[180:183], v[188:191], a[108:111]
    s_waitcnt lgkmcnt(3)
    buffer_load_dwordx4 v37, s[8:11], s40 offen offset:1024 lds
    v_mfma_f32_16x16x32_bf16 v[208:211], a[224:227], v[96:99], v[200:203]
    v_exp_f32 v212, v212
    v_mfma_f32_16x16x32_bf16 v[208:211], a[228:231], v[100:103], v[208:211]
    v_exp_f32 v213, v213
    v_mfma_f32_16x16x32_bf16 v[208:211], a[232:235], v[104:107], v[208:211]
    v_exp_f32 v214, v214
    v_mfma_f32_16x16x32_bf16 v[208:211], a[236:239], v[108:111], v[208:211]
    v_exp_f32 v215, v215
    v_mfma_f32_16x16x32_bf16 a[112:115], a[184:187], v[160:163], a[112:115]
    ds_read_b64_tr_b16 a[164:165], v20 offset:8192
    v_cvt_pk_bf16_f32 v142, v212, v213
    v_mfma_f32_16x16x32_bf16 a[112:115], a[188:191], v[164:167], a[112:115]
    ds_read_b64_tr_b16 a[166:167], v20 offset:12288
    v_mfma_f32_16x16x32_bf16 a[116:119], a[184:187], v[168:171], a[116:119]
    ds_read_b128 a[220:223], v11 offset:16384
    v_cvt_pk_bf16_f32 v143, v214, v215
    v_mfma_f32_16x16x32_bf16 a[116:119], a[188:191], v[172:175], a[116:119]
    v_mfma_f32_16x16x32_bf16 v[212:215], a[224:227], v[112:115], v[204:207]
    v_exp_f32 v208, v208
    v_mfma_f32_16x16x32_bf16 v[212:215], a[228:231], v[116:119], v[212:215]
    v_exp_f32 v209, v209
    v_mfma_f32_16x16x32_bf16 v[212:215], a[232:235], v[120:123], v[212:215]
    v_exp_f32 v210, v210
    v_mfma_f32_16x16x32_bf16 v[212:215], a[236:239], v[124:127], v[212:215]
    v_exp_f32 v211, v211
    v_mfma_f32_16x16x32_bf16 a[120:123], a[184:187], v[176:179], a[120:123]
    ds_read_b64_tr_b16 a[168:169], v21 offset:0
    v_cvt_pk_bf16_f32 v150, v208, v209
    v_mfma_f32_16x16x32_bf16 a[120:123], a[188:191], v[180:183], a[120:123]
    ds_read_b64_tr_b16 a[170:171], v21 offset:4096
    v_mfma_f32_16x16x32_bf16 a[124:127], a[184:187], v[184:187], a[124:127]
    ds_read_b128 a[224:227], v8 offset:20480
    v_cvt_pk_bf16_f32 v151, v210, v211
    v_mfma_f32_16x16x32_bf16 a[124:127], a[188:191], v[188:191], a[124:127]
    s_waitcnt lgkmcnt(3)
    buffer_load_dwordx4 v38, s[8:11], s40 offen offset:2048 lds
    s_sub_u32 s43, s43, 1
    s_cmp_lg_u32 s43, 0
    s_cbranch_scc1 Lattn_loop
    v_mfma_f32_16x16x32_bf16 v[208:211], a[208:211], v[64:67], v[192:195]
    s_lshl_b32 s38, s3, 6
    v_exp_f32 v212, v212
    v_mfma_f32_16x16x32_bf16 v[208:211], a[212:215], v[68:71], v[208:211]
    s_add_u32 s38, s38, 131136
    v_exp_f32 v213, v213
    v_mfma_f32_16x16x32_bf16 v[208:211], a[216:219], v[72:75], v[208:211]
    v_exp_f32 v214, v214
    v_mfma_f32_16x16x32_bf16 v[208:211], a[220:223], v[76:79], v[208:211]
    s_add_u32 s57, s58, 0
    v_exp_f32 v215, v215
    v_mfma_f32_16x16x32_bf16 a[0:3], a[160:163], v[128:131], a[0:3]
    ds_read_b64_tr_b16 a[172:173], v21 offset:8192
    v_cvt_pk_bf16_f32 v158, v212, v213
    v_mfma_f32_16x16x32_bf16 a[0:3], a[164:167], v[132:135], a[0:3]
    ds_read_b64_tr_b16 a[174:175], v21 offset:12288
    v_permlane32_swap_b32 v224, v228
    v_mfma_f32_16x16x32_bf16 a[4:7], a[160:163], v[136:139], a[4:7]
    ds_read_b128 a[228:231], v9 offset:20480
    v_cvt_pk_bf16_f32 v159, v214, v215
    v_mfma_f32_16x16x32_bf16 a[4:7], a[164:167], v[140:143], a[4:7]
    buffer_load_dwordx4 a[128:131], v254, s[80:83], s57 offen
    v_mfma_f32_16x16x32_bf16 v[212:215], a[208:211], v[80:83], v[196:199]
    v_exp_f32 v208, v208
    v_mfma_f32_16x16x32_bf16 v[212:215], a[212:215], v[84:87], v[212:215]
    v_exp_f32 v209, v209
    v_mfma_f32_16x16x32_bf16 v[212:215], a[216:219], v[88:91], v[212:215]
    v_exp_f32 v210, v210
    v_mfma_f32_16x16x32_bf16 v[212:215], a[220:223], v[92:95], v[212:215]
    v_exp_f32 v211, v211
    v_mfma_f32_16x16x32_bf16 a[8:11], a[160:163], v[144:147], a[8:11]
    ds_read_b64_tr_b16 a[176:177], v22 offset:0
    v_cvt_pk_bf16_f32 v160, v208, v209
    v_mfma_f32_16x16x32_bf16 a[8:11], a[164:167], v[148:151], a[8:11]
    ds_read_b64_tr_b16 a[178:179], v22 offset:4096
    v_permlane32_swap_b32 v225, v229
    v_mfma_f32_16x16x32_bf16 a[12:15], a[160:163], v[152:155], a[12:15]
    ds_read_b128 a[232:235], v10 offset:20480
    v_cvt_pk_bf16_f32 v161, v210, v211
    v_mfma_f32_16x16x32_bf16 a[12:15], a[164:167], v[156:159], a[12:15]
    s_waitcnt lgkmcnt(3)
    buffer_load_dwordx4 v39, s[8:11], s40 offen offset:3072 lds
    v_mfma_f32_16x16x32_bf16 v[208:211], a[208:211], v[96:99], v[200:203]
    v_exp_f32 v212, v212
    v_mfma_f32_16x16x32_bf16 v[208:211], a[212:215], v[100:103], v[208:211]
    s_add_u32 s40, s40, 16384
    v_exp_f32 v213, v213
    v_mfma_f32_16x16x32_bf16 v[208:211], a[216:219], v[104:107], v[208:211]
    v_exp_f32 v214, v214
    v_mfma_f32_16x16x32_bf16 v[208:211], a[220:223], v[108:111], v[208:211]
    v_exp_f32 v215, v215
    v_mfma_f32_16x16x32_bf16 a[16:19], a[168:171], v[128:131], a[16:19]
    ds_read_b64_tr_b16 a[180:181], v22 offset:8192
    v_cvt_pk_bf16_f32 v168, v212, v213
    v_mfma_f32_16x16x32_bf16 a[16:19], a[172:175], v[132:135], a[16:19]
    ds_read_b64_tr_b16 a[182:183], v22 offset:12288
    v_permlane32_swap_b32 v226, v230
    v_mfma_f32_16x16x32_bf16 a[20:23], a[168:171], v[136:139], a[20:23]
    ds_read_b128 a[236:239], v11 offset:20480
    v_cvt_pk_bf16_f32 v169, v214, v215
    v_mfma_f32_16x16x32_bf16 a[20:23], a[172:175], v[140:143], a[20:23]
    v_permlane32_swap_b32 v227, v231
    v_add_f32 v224, v224, v228
    v_smfmac_f32_16x16x64_bf16 a[192:195], v[52:55], v[128:135], v50
    v_mfma_f32_16x16x32_bf16 v[212:215], a[208:211], v[112:115], v[204:207]
    v_exp_f32 v208, v208
    v_mfma_f32_16x16x32_bf16 v[212:215], a[212:215], v[116:119], v[212:215]
    s_add_u32 m0, s42, 98304
    v_exp_f32 v209, v209
    v_mfma_f32_16x16x32_bf16 v[212:215], a[216:219], v[120:123], v[212:215]
    v_exp_f32 v210, v210
    v_mfma_f32_16x16x32_bf16 v[212:215], a[220:223], v[124:127], v[212:215]
    v_exp_f32 v211, v211
    v_mfma_f32_16x16x32_bf16 a[24:27], a[168:171], v[144:147], a[24:27]
    ds_read_b64_tr_b16 a[184:185], v23 offset:0
    v_cvt_pk_bf16_f32 v176, v208, v209
    v_mfma_f32_16x16x32_bf16 a[24:27], a[172:175], v[148:151], a[24:27]
    ds_read_b64_tr_b16 a[186:187], v23 offset:4096
    v_add_f32 v225, v225, v229
    v_mfma_f32_16x16x32_bf16 a[28:31], a[168:171], v[152:155], a[28:31]
    ds_read_b128 a[208:211], v8 offset:24576
    v_cvt_pk_bf16_f32 v177, v210, v211
    v_mfma_f32_16x16x32_bf16 a[28:31], a[172:175], v[156:159], a[28:31]
    s_waitcnt lgkmcnt(3)
    buffer_load_dwordx4 v40, s[12:15], s41 offen lds
    v_mfma_f32_16x16x32_bf16 v[208:211], a[224:227], v[64:67], v[192:195]
    v_exp_f32 v212, v212
    v_mfma_f32_16x16x32_bf16 v[208:211], a[228:231], v[68:71], v[208:211]
    v_exp_f32 v213, v213
    v_mfma_f32_16x16x32_bf16 v[208:211], a[232:235], v[72:75], v[208:211]
    v_exp_f32 v214, v214
    v_mfma_f32_16x16x32_bf16 v[208:211], a[236:239], v[76:79], v[208:211]
    s_add_u32 s57, s58, 589824
    v_exp_f32 v215, v215
    v_mfma_f32_16x16x32_bf16 a[32:35], a[176:179], v[128:131], a[32:35]
    ds_read_b64_tr_b16 a[188:189], v23 offset:8192
    v_cvt_pk_bf16_f32 v184, v212, v213
    v_mfma_f32_16x16x32_bf16 a[32:35], a[180:183], v[132:135], a[32:35]
    ds_read_b64_tr_b16 a[190:191], v23 offset:12288
    v_add_f32 v226, v226, v230
    v_mfma_f32_16x16x32_bf16 a[36:39], a[176:179], v[136:139], a[36:39]
    ds_read_b128 a[212:215], v9 offset:24576
    v_cvt_pk_bf16_f32 v185, v214, v215
    v_mfma_f32_16x16x32_bf16 a[36:39], a[180:183], v[140:143], a[36:39]
    buffer_load_dwordx4 a[132:135], v254, s[80:83], s57 offen
    v_smfmac_f32_16x16x64_bf16 a[196:199], v[52:55], v[136:143], v50
    v_mfma_f32_16x16x32_bf16 v[212:215], a[224:227], v[80:83], v[196:199]
    v_exp_f32 v208, v208
    v_mfma_f32_16x16x32_bf16 v[212:215], a[228:231], v[84:87], v[212:215]
    v_exp_f32 v209, v209
    v_mfma_f32_16x16x32_bf16 v[212:215], a[232:235], v[88:91], v[212:215]
    s_mul_i32 s37, s5, 18432
    v_exp_f32 v210, v210
    v_mfma_f32_16x16x32_bf16 v[212:215], a[236:239], v[92:95], v[212:215]
    s_add_u32 s37, s37, s45
    v_exp_f32 v211, v211
    v_mfma_f32_16x16x32_bf16 a[40:43], a[176:179], v[144:147], a[40:43]
    ds_read_b64_tr_b16 a[160:161], v24 offset:0
    v_cvt_pk_bf16_f32 v162, v208, v209
    v_mfma_f32_16x16x32_bf16 a[40:43], a[180:183], v[148:151], a[40:43]
    ds_read_b64_tr_b16 a[162:163], v24 offset:4096
    v_add_f32 v227, v227, v231
    v_mfma_f32_16x16x32_bf16 a[44:47], a[176:179], v[152:155], a[44:47]
    ds_read_b128 a[216:219], v10 offset:24576
    v_cvt_pk_bf16_f32 v163, v210, v211
    v_mfma_f32_16x16x32_bf16 a[44:47], a[180:183], v[156:159], a[44:47]
    s_waitcnt lgkmcnt(3)
    buffer_load_dwordx4 v41, s[12:15], s41 offen offset:1024 lds
    v_mfma_f32_16x16x32_bf16 v[208:211], a[224:227], v[96:99], v[200:203]
    v_exp_f32 v212, v212
    v_mfma_f32_16x16x32_bf16 v[208:211], a[228:231], v[100:103], v[208:211]
    v_exp_f32 v213, v213
    v_mfma_f32_16x16x32_bf16 v[208:211], a[232:235], v[104:107], v[208:211]
    v_exp_f32 v214, v214
    v_mfma_f32_16x16x32_bf16 v[208:211], a[236:239], v[108:111], v[208:211]
    v_exp_f32 v215, v215
    v_mfma_f32_16x16x32_bf16 a[48:51], a[184:187], v[128:131], a[48:51]
    ds_read_b64_tr_b16 a[164:165], v24 offset:8192
    v_cvt_pk_bf16_f32 v170, v212, v213
    v_mfma_f32_16x16x32_bf16 a[48:51], a[188:191], v[132:135], a[48:51]
    ds_read_b64_tr_b16 a[166:167], v24 offset:12288
    v_and_b32 v244, 1, v1
    v_mfma_f32_16x16x32_bf16 a[52:55], a[184:187], v[136:139], a[52:55]
    ds_read_b128 a[220:223], v11 offset:24576
    v_cvt_pk_bf16_f32 v171, v214, v215
    v_mfma_f32_16x16x32_bf16 a[52:55], a[188:191], v[140:143], a[52:55]
    buffer_load_dword v221, v236, s[20:23], s37 offen
    v_smfmac_f32_16x16x64_bf16 a[200:203], v[52:55], v[144:151], v50
    v_mfma_f32_16x16x32_bf16 v[212:215], a[224:227], v[112:115], v[204:207]
    v_exp_f32 v208, v208
    v_mfma_f32_16x16x32_bf16 v[212:215], a[228:231], v[116:119], v[212:215]
    v_exp_f32 v209, v209
    v_mfma_f32_16x16x32_bf16 v[212:215], a[232:235], v[120:123], v[212:215]
    v_exp_f32 v210, v210
    v_mfma_f32_16x16x32_bf16 v[212:215], a[236:239], v[124:127], v[212:215]
    v_exp_f32 v211, v211
    v_mfma_f32_16x16x32_bf16 a[56:59], a[184:187], v[144:147], a[56:59]
    ds_read_b64_tr_b16 a[168:169], v25 offset:0
    v_cvt_pk_bf16_f32 v178, v208, v209
    v_mfma_f32_16x16x32_bf16 a[56:59], a[188:191], v[148:151], a[56:59]
    ds_read_b64_tr_b16 a[170:171], v25 offset:4096
    v_permlane16_swap_b32 v224, v226
    v_mfma_f32_16x16x32_bf16 a[60:63], a[184:187], v[152:155], a[60:63]
    ds_read_b128 a[224:227], v8 offset:28672
    v_cvt_pk_bf16_f32 v179, v210, v211
    v_mfma_f32_16x16x32_bf16 a[60:63], a[188:191], v[156:159], a[60:63]
    s_waitcnt lgkmcnt(3)
    buffer_load_dwordx4 v40, s[12:15], s41 offen offset:2048 lds
    v_mfma_f32_16x16x32_bf16 v[208:211], a[208:211], v[64:67], v[192:195]
    v_exp_f32 v212, v212
    v_mfma_f32_16x16x32_bf16 v[208:211], a[212:215], v[68:71], v[208:211]
    v_exp_f32 v213, v213
    v_mfma_f32_16x16x32_bf16 v[208:211], a[216:219], v[72:75], v[208:211]
    v_exp_f32 v214, v214
    v_mfma_f32_16x16x32_bf16 v[208:211], a[220:223], v[76:79], v[208:211]
    s_add_u32 s57, s58, 1179648
    v_exp_f32 v215, v215
    v_mfma_f32_16x16x32_bf16 a[64:67], a[160:163], v[128:131], a[64:67]
    ds_read_b64_tr_b16 a[172:173], v25 offset:8192
    v_cvt_pk_bf16_f32 v186, v212, v213
    v_mfma_f32_16x16x32_bf16 a[64:67], a[164:167], v[132:135], a[64:67]
    ds_read_b64_tr_b16 a[174:175], v25 offset:12288
    v_permlane16_swap_b32 v225, v227
    v_mfma_f32_16x16x32_bf16 a[68:71], a[160:163], v[136:139], a[68:71]
    ds_read_b128 a[228:231], v9 offset:28672
    v_cvt_pk_bf16_f32 v187, v214, v215
    v_mfma_f32_16x16x32_bf16 a[68:71], a[164:167], v[140:143], a[68:71]
    buffer_load_dwordx4 a[136:139], v254, s[80:83], s57 offen
    v_smfmac_f32_16x16x64_bf16 a[204:207], v[52:55], v[152:159], v50
    v_mfma_f32_16x16x32_bf16 v[212:215], a[208:211], v[80:83], v[196:199]
    v_exp_f32 v208, v208
    v_mfma_f32_16x16x32_bf16 v[212:215], a[212:215], v[84:87], v[212:215]
    v_exp_f32 v209, v209
    v_mfma_f32_16x16x32_bf16 v[212:215], a[216:219], v[88:91], v[212:215]
    v_exp_f32 v210, v210
    v_mfma_f32_16x16x32_bf16 v[212:215], a[220:223], v[92:95], v[212:215]
    v_exp_f32 v211, v211
    v_mfma_f32_16x16x32_bf16 a[72:75], a[160:163], v[144:147], a[72:75]
    ds_read_b64_tr_b16 a[176:177], v26 offset:0
    v_cvt_pk_bf16_f32 v164, v208, v209
    v_mfma_f32_16x16x32_bf16 a[72:75], a[164:167], v[148:151], a[72:75]
    ds_read_b64_tr_b16 a[178:179], v26 offset:4096
    v_lshlrev_b32 v244, 5, v244
    v_mfma_f32_16x16x32_bf16 a[76:79], a[160:163], v[152:155], a[76:79]
    ds_read_b128 a[232:235], v10 offset:28672
    v_cvt_pk_bf16_f32 v165, v210, v211
    v_mfma_f32_16x16x32_bf16 a[76:79], a[164:167], v[156:159], a[76:79]
    s_waitcnt lgkmcnt(3)
    buffer_load_dwordx4 v41, s[12:15], s41 offen offset:3072 lds
    v_mfma_f32_16x16x32_bf16 v[208:211], a[208:211], v[96:99], v[200:203]
    v_exp_f32 v212, v212
    v_mfma_f32_16x16x32_bf16 v[208:211], a[212:215], v[100:103], v[208:211]
    s_add_u32 s41, s41, 16384
    v_exp_f32 v213, v213
    v_mfma_f32_16x16x32_bf16 v[208:211], a[216:219], v[104:107], v[208:211]
    v_exp_f32 v214, v214
    v_mfma_f32_16x16x32_bf16 v[208:211], a[220:223], v[108:111], v[208:211]
    v_exp_f32 v215, v215
    v_mfma_f32_16x16x32_bf16 a[80:83], a[168:171], v[128:131], a[80:83]
    ds_read_b64_tr_b16 a[180:181], v26 offset:8192
    v_cvt_pk_bf16_f32 v172, v212, v213
    v_mfma_f32_16x16x32_bf16 a[80:83], a[172:175], v[132:135], a[80:83]
    ds_read_b64_tr_b16 a[182:183], v26 offset:12288
    v_add_f32 v224, v224, v226
    v_mfma_f32_16x16x32_bf16 a[84:87], a[168:171], v[136:139], a[84:87]
    ds_read_b128 a[236:239], v11 offset:28672
    v_cvt_pk_bf16_f32 v173, v214, v215
    v_mfma_f32_16x16x32_bf16 a[84:87], a[172:175], v[140:143], a[84:87]
    s_waitcnt vmcnt(13)
    s_barrier
    v_mfma_f32_16x16x32_bf16 v[212:215], a[208:211], v[112:115], v[204:207]
    v_exp_f32 v208, v208
    v_mfma_f32_16x16x32_bf16 v[212:215], a[212:215], v[116:119], v[212:215]
    s_add_u32 s49, s45, 1024
    v_exp_f32 v209, v209
    v_mfma_f32_16x16x32_bf16 v[212:215], a[216:219], v[120:123], v[212:215]
    s_add_u32 m0, s42, 0
    v_exp_f32 v210, v210
    v_mfma_f32_16x16x32_bf16 v[212:215], a[220:223], v[124:127], v[212:215]
    v_exp_f32 v211, v211
    v_mfma_f32_16x16x32_bf16 a[88:91], a[168:171], v[144:147], a[88:91]
    ds_read_b64_tr_b16 a[184:185], v27 offset:0
    v_cvt_pk_bf16_f32 v180, v208, v209
    v_mfma_f32_16x16x32_bf16 a[88:91], a[172:175], v[148:151], a[88:91]
    ds_read_b64_tr_b16 a[186:187], v27 offset:4096
    v_add_f32 v225, v225, v227
    v_mfma_f32_16x16x32_bf16 a[92:95], a[168:171], v[152:155], a[92:95]
    ds_read_b128 a[208:211], v8 offset:32768
    v_cvt_pk_bf16_f32 v181, v210, v211
    v_mfma_f32_16x16x32_bf16 a[92:95], a[172:175], v[156:159], a[92:95]
    s_waitcnt lgkmcnt(3)
    buffer_load_dwordx4 v46, s[20:23], s49 offen lds
    v_mfma_f32_16x16x32_bf16 v[208:211], a[224:227], v[64:67], v[192:195]
    v_exp_f32 v212, v212
    v_mfma_f32_16x16x32_bf16 v[208:211], a[228:231], v[68:71], v[208:211]
    v_exp_f32 v213, v213
    v_mfma_f32_16x16x32_bf16 v[208:211], a[232:235], v[72:75], v[208:211]
    v_exp_f32 v214, v214
    v_mfma_f32_16x16x32_bf16 v[208:211], a[236:239], v[76:79], v[208:211]
    s_add_u32 s37, s55, 0
    v_exp_f32 v215, v215
    v_mfma_f32_16x16x32_bf16 a[96:99], a[176:179], v[128:131], a[96:99]
    ds_read_b64_tr_b16 a[188:189], v27 offset:8192
    v_cvt_pk_bf16_f32 v188, v212, v213
    v_mfma_f32_16x16x32_bf16 a[96:99], a[180:183], v[132:135], a[96:99]
    ds_read_b64_tr_b16 a[190:191], v27 offset:12288
    v_lshrrev_b32 v245, 4, v1
    v_mfma_f32_16x16x32_bf16 a[100:103], a[176:179], v[136:139], a[100:103]
    ds_read_b128 a[212:215], v9 offset:32768
    v_cvt_pk_bf16_f32 v189, v214, v215
    v_mfma_f32_16x16x32_bf16 a[100:103], a[180:183], v[140:143], a[100:103]
    buffer_load_dword v239, v238, s[28:31], s37 offen
    v_mfma_f32_16x16x32_bf16 v[212:215], a[224:227], v[80:83], v[196:199]
    v_exp_f32 v208, v208
    v_mfma_f32_16x16x32_bf16 v[212:215], a[228:231], v[84:87], v[212:215]
    v_exp_f32 v209, v209
    v_mfma_f32_16x16x32_bf16 v[212:215], a[232:235], v[88:91], v[212:215]
    v_exp_f32 v210, v210
    v_mfma_f32_16x16x32_bf16 v[212:215], a[236:239], v[92:95], v[212:215]
    v_exp_f32 v211, v211
    v_mfma_f32_16x16x32_bf16 a[104:107], a[176:179], v[144:147], a[104:107]
    ds_read_b64_tr_b16 a[160:161], v20 offset:16384
    v_cvt_pk_bf16_f32 v166, v208, v209
    v_mfma_f32_16x16x32_bf16 a[104:107], a[180:183], v[148:151], a[104:107]
    ds_read_b64_tr_b16 a[162:163], v20 offset:20480
    v_lshl_add_u32 v244, v245, 3, v244
    v_mfma_f32_16x16x32_bf16 a[108:111], a[176:179], v[152:155], a[108:111]
    ds_read_b128 a[216:219], v10 offset:32768
    v_cvt_pk_bf16_f32 v167, v210, v211
    v_mfma_f32_16x16x32_bf16 a[108:111], a[180:183], v[156:159], a[108:111]
    s_waitcnt lgkmcnt(3)
    buffer_load_dwordx4 v47, s[20:23], s49 offen offset:1024 lds
    v_mfma_f32_16x16x32_bf16 v[208:211], a[224:227], v[96:99], v[200:203]
    v_exp_f32 v212, v212
    v_mfma_f32_16x16x32_bf16 v[208:211], a[228:231], v[100:103], v[208:211]
    v_exp_f32 v213, v213
    v_mfma_f32_16x16x32_bf16 v[208:211], a[232:235], v[104:107], v[208:211]
    v_exp_f32 v214, v214
    v_mfma_f32_16x16x32_bf16 v[208:211], a[236:239], v[108:111], v[208:211]
    s_add_u32 s57, s58, 1769472
    v_exp_f32 v215, v215
    v_mfma_f32_16x16x32_bf16 a[112:115], a[184:187], v[128:131], a[112:115]
    ds_read_b64_tr_b16 a[164:165], v20 offset:24576
    v_cvt_pk_bf16_f32 v174, v212, v213
    v_mfma_f32_16x16x32_bf16 a[112:115], a[188:191], v[132:135], a[112:115]
    ds_read_b64_tr_b16 a[166:167], v20 offset:28672
    v_mfma_f32_16x16x32_bf16 a[116:119], a[184:187], v[136:139], a[116:119]
    ds_read_b128 a[220:223], v11 offset:32768
    v_cvt_pk_bf16_f32 v175, v214, v215
    v_mfma_f32_16x16x32_bf16 a[116:119], a[188:191], v[140:143], a[116:119]
    buffer_load_dwordx4 a[140:143], v254, s[80:83], s57 offen
    v_mfma_f32_16x16x32_bf16 v[212:215], a[224:227], v[112:115], v[204:207]
    v_exp_f32 v208, v208
    v_mfma_f32_16x16x32_bf16 v[212:215], a[228:231], v[116:119], v[212:215]
    v_exp_f32 v209, v209
    v_mfma_f32_16x16x32_bf16 v[212:215], a[232:235], v[120:123], v[212:215]
    v_exp_f32 v210, v210
    v_mfma_f32_16x16x32_bf16 v[212:215], a[236:239], v[124:127], v[212:215]
    v_exp_f32 v211, v211
    v_mfma_f32_16x16x32_bf16 a[120:123], a[184:187], v[144:147], a[120:123]
    ds_read_b64_tr_b16 a[168:169], v21 offset:16384
    v_cvt_pk_bf16_f32 v182, v208, v209
    v_mfma_f32_16x16x32_bf16 a[120:123], a[188:191], v[148:151], a[120:123]
    ds_read_b64_tr_b16 a[170:171], v21 offset:20480
    v_mfma_f32_16x16x32_bf16 a[124:127], a[184:187], v[152:155], a[124:127]
Ltour6:
    s_cbranch_execz Ltour10
    ds_read_b128 a[224:227], v8 offset:36864
    v_cvt_pk_bf16_f32 v183, v210, v211
    v_mfma_f32_16x16x32_bf16 a[124:127], a[188:191], v[156:159], a[124:127]
    s_waitcnt lgkmcnt(3)
    buffer_load_dwordx4 v48, s[20:23], s49 offen offset:2048 lds
    v_mfma_f32_16x16x32_bf16 v[208:211], a[208:211], v[64:67], v[192:195]
    v_exp_f32 v212, v212
    v_mfma_f32_16x16x32_bf16 v[208:211], a[212:215], v[68:71], v[208:211]
    v_exp_f32 v213, v213
    v_mfma_f32_16x16x32_bf16 v[208:211], a[216:219], v[72:75], v[208:211]
    v_exp_f32 v214, v214
    v_mfma_f32_16x16x32_bf16 v[208:211], a[220:223], v[76:79], v[208:211]
    s_add_u32 s57, s58, 2359296
    v_exp_f32 v215, v215
    v_mfma_f32_16x16x32_bf16 a[0:3], a[160:163], v[160:163], a[0:3]
    ds_read_b64_tr_b16 a[172:173], v21 offset:24576
    v_cvt_pk_bf16_f32 v190, v212, v213
    v_mfma_f32_16x16x32_bf16 a[0:3], a[164:167], v[164:167], a[0:3]
    ds_read_b64_tr_b16 a[174:175], v21 offset:28672
    v_mov_b32 v63, 0
    v_mfma_f32_16x16x32_bf16 a[4:7], a[160:163], v[168:171], a[4:7]
    ds_read_b128 a[228:231], v9 offset:36864
    v_cvt_pk_bf16_f32 v191, v214, v215
    v_mfma_f32_16x16x32_bf16 a[4:7], a[164:167], v[172:175], a[4:7]
    buffer_load_dwordx4 a[144:147], v254, s[80:83], s57 offen
    v_mfma_f32_16x16x32_bf16 v[212:215], a[208:211], v[80:83], v[196:199]
    v_exp_f32 v208, v208
    v_mfma_f32_16x16x32_bf16 v[212:215], a[212:215], v[84:87], v[212:215]
    v_exp_f32 v209, v209
    v_mfma_f32_16x16x32_bf16 v[212:215], a[216:219], v[88:91], v[212:215]
    v_exp_f32 v210, v210
    v_mfma_f32_16x16x32_bf16 v[212:215], a[220:223], v[92:95], v[212:215]
    v_exp_f32 v211, v211
    v_mfma_f32_16x16x32_bf16 a[8:11], a[160:163], v[176:179], a[8:11]
    ds_read_b64_tr_b16 a[176:177], v22 offset:16384
    v_cvt_pk_bf16_f32 v128, v208, v209
    v_mfma_f32_16x16x32_bf16 a[8:11], a[164:167], v[180:183], a[8:11]
    ds_read_b64_tr_b16 a[178:179], v22 offset:20480
    v_add_f32_dpp v224, v224, v224 row_ror:2 row_mask:0xf bank_mask:0xf
    v_mfma_f32_16x16x32_bf16 a[12:15], a[160:163], v[184:187], a[12:15]
    ds_read_b128 a[232:235], v10 offset:36864
    v_cvt_pk_bf16_f32 v129, v210, v211
    v_mfma_f32_16x16x32_bf16 a[12:15], a[164:167], v[188:191], a[12:15]
    s_waitcnt lgkmcnt(3)
    buffer_load_dwordx4 v49, s[20:23], s49 offen offset:3072 lds
    v_mfma_f32_16x16x32_bf16 v[208:211], a[208:211], v[96:99], v[200:203]
    s_lshr_b32 s39, s2, 5
    v_exp_f32 v212, v212
    v_mfma_f32_16x16x32_bf16 v[208:211], a[212:215], v[100:103], v[208:211]
    s_lshl_b32 s39, s39, 3
    v_exp_f32 v213, v213
    v_mfma_f32_16x16x32_bf16 v[208:211], a[216:219], v[104:107], v[208:211]
    s_and_b32 s43, s2, 7
    v_exp_f32 v214, v214
    v_mfma_f32_16x16x32_bf16 v[208:211], a[220:223], v[108:111], v[208:211]
    s_add_u32 s39, s39, s43
    v_exp_f32 v215, v215
    v_mfma_f32_16x16x32_bf16 a[16:19], a[168:171], v[160:163], a[16:19]
    ds_read_b64_tr_b16 a[180:181], v22 offset:24576
    v_cvt_pk_bf16_f32 v136, v212, v213
    v_mfma_f32_16x16x32_bf16 a[16:19], a[172:175], v[164:167], a[16:19]
    ds_read_b64_tr_b16 a[182:183], v22 offset:28672
    v_add_f32_dpp v225, v225, v225 row_ror:2 row_mask:0xf bank_mask:0xf
    v_mfma_f32_16x16x32_bf16 a[20:23], a[168:171], v[168:171], a[20:23]
    ds_read_b128 a[236:239], v11 offset:36864
    v_cvt_pk_bf16_f32 v137, v214, v215
    v_mfma_f32_16x16x32_bf16 a[20:23], a[172:175], v[172:175], a[20:23]
    buffer_load_dword v253, v63, s[24:27], s54 offen offset:12 sc1
    v_smfmac_f32_16x16x64_bf16 a[192:195], v[52:55], v[160:167], v50
    v_mfma_f32_16x16x32_bf16 v[212:215], a[208:211], v[112:115], v[204:207]
    s_lshl_b32 s39, s39, 2
    v_exp_f32 v208, v208
    v_mfma_f32_16x16x32_bf16 v[212:215], a[212:215], v[116:119], v[212:215]
    s_add_u32 m0, s42, 114688
    v_exp_f32 v209, v209
    v_mfma_f32_16x16x32_bf16 v[212:215], a[216:219], v[120:123], v[212:215]
    s_bfe_u32 s43, s2, 0x20003
    v_exp_f32 v210, v210
    v_mfma_f32_16x16x32_bf16 v[212:215], a[220:223], v[124:127], v[212:215]
    s_add_u32 s39, s39, s43
    v_exp_f32 v211, v211
    v_mfma_f32_16x16x32_bf16 a[24:27], a[168:171], v[176:179], a[24:27]
    ds_read_b64_tr_b16 a[184:185], v23 offset:16384
    v_cvt_pk_bf16_f32 v144, v208, v209
    v_mfma_f32_16x16x32_bf16 a[24:27], a[172:175], v[180:183], a[24:27]
    ds_read_b64_tr_b16 a[186:187], v23 offset:20480
    v_add_f32_dpp v224, v224, v224 row_ror:4 row_mask:0xf bank_mask:0xf
    v_mfma_f32_16x16x32_bf16 a[28:31], a[168:171], v[184:187], a[28:31]
    ds_read_b128 a[208:211], v8 offset:40960
    v_cvt_pk_bf16_f32 v145, v210, v211
    v_mfma_f32_16x16x32_bf16 a[28:31], a[172:175], v[188:191], a[28:31]
    s_waitcnt lgkmcnt(3)
    buffer_load_dwordx4 v40, s[12:15], s41 offen lds
    v_mfma_f32_16x16x32_bf16 v[208:211], a[224:227], v[64:67], v[192:195]
    s_add_u32 s39, s39, 72
    v_exp_f32 v212, v212
    v_mfma_f32_16x16x32_bf16 v[208:211], a[228:231], v[68:71], v[208:211]
    s_cmp_lt_u32 s39, 216
    s_cselect_b32 s43, 0, 2147483648
    v_exp_f32 v213, v213
    v_mfma_f32_16x16x32_bf16 v[208:211], a[232:235], v[72:75], v[208:211]
    s_or_b32 s43, s43, s48
    v_exp_f32 v214, v214
    v_mfma_f32_16x16x32_bf16 v[208:211], a[236:239], v[76:79], v[208:211]
    s_add_u32 s57, s58, 2949120
    v_exp_f32 v215, v215
    v_mfma_f32_16x16x32_bf16 a[32:35], a[176:179], v[160:163], a[32:35]
    ds_read_b64_tr_b16 a[188:189], v23 offset:24576
    v_cvt_pk_bf16_f32 v152, v212, v213
    v_mfma_f32_16x16x32_bf16 a[32:35], a[180:183], v[164:167], a[32:35]
    ds_read_b64_tr_b16 a[190:191], v23 offset:28672
    v_add_f32_dpp v225, v225, v225 row_ror:4 row_mask:0xf bank_mask:0xf
    v_mfma_f32_16x16x32_bf16 a[36:39], a[176:179], v[168:171], a[36:39]
    ds_read_b128 a[212:215], v9 offset:40960
    v_cvt_pk_bf16_f32 v153, v214, v215
    v_mfma_f32_16x16x32_bf16 a[36:39], a[180:183], v[172:175], a[36:39]
    buffer_load_dwordx4 a[148:151], v254, s[80:83], s57 offen
    v_smfmac_f32_16x16x64_bf16 a[196:199], v[52:55], v[168:175], v50
    v_mfma_f32_16x16x32_bf16 v[212:215], a[224:227], v[80:83], v[196:199]
    s_and_b32 s43, s43, 2147483648
    v_exp_f32 v208, v208
    v_mfma_f32_16x16x32_bf16 v[212:215], a[228:231], v[84:87], v[212:215]
    s_sub_u32 s36, s39, 144
    v_exp_f32 v209, v209
    v_mfma_f32_16x16x32_bf16 v[212:215], a[232:235], v[88:91], v[212:215]
    s_cmp_lt_u32 s36, 36
    s_cselect_b32 s36, 1.0, 0
    v_exp_f32 v210, v210
    v_mfma_f32_16x16x32_bf16 v[212:215], a[236:239], v[92:95], v[212:215]
    s_lshr_b32 s44, s39, 1
    v_exp_f32 v211, v211
    v_mfma_f32_16x16x32_bf16 a[40:43], a[176:179], v[176:179], a[40:43]
    ds_read_b64_tr_b16 a[160:161], v24 offset:16384
    v_cvt_pk_bf16_f32 v130, v208, v209
    v_mfma_f32_16x16x32_bf16 a[40:43], a[180:183], v[180:183], a[40:43]
    ds_read_b64_tr_b16 a[162:163], v24 offset:20480
    v_add_f32_dpp v224, v224, v224 row_ror:8 row_mask:0xf bank_mask:0xf
    v_mfma_f32_16x16x32_bf16 a[44:47], a[176:179], v[184:187], a[44:47]
    ds_read_b128 a[216:219], v10 offset:40960
    v_cvt_pk_bf16_f32 v131, v210, v211
    v_mfma_f32_16x16x32_bf16 a[44:47], a[180:183], v[188:191], a[44:47]
    s_waitcnt lgkmcnt(3)
    buffer_load_dwordx4 v41, s[12:15], s41 offen offset:1024 lds
    v_mfma_f32_16x16x32_bf16 v[208:211], a[224:227], v[96:99], v[200:203]
    s_lshl_b32 s44, s44, 6
    v_exp_f32 v212, v212
    v_mfma_f32_16x16x32_bf16 v[208:211], a[228:231], v[100:103], v[208:211]
    s_and_b32 s39, s39, 1
    v_exp_f32 v213, v213
    v_mfma_f32_16x16x32_bf16 v[208:211], a[232:235], v[104:107], v[208:211]
    s_lshl_b32 s39, s39, 3
    v_exp_f32 v214, v214
    v_mfma_f32_16x16x32_bf16 v[208:211], a[236:239], v[108:111], v[208:211]
    s_add_u32 s39, s39, s44
    v_exp_f32 v215, v215
    v_mfma_f32_16x16x32_bf16 a[48:51], a[184:187], v[160:163], a[48:51]
    ds_read_b64_tr_b16 a[164:165], v24 offset:24576
    v_cvt_pk_bf16_f32 v138, v212, v213
    v_mfma_f32_16x16x32_bf16 a[48:51], a[188:191], v[164:167], a[48:51]
    ds_read_b64_tr_b16 a[166:167], v24 offset:28672
    v_add_f32_dpp v225, v225, v225 row_ror:8 row_mask:0xf bank_mask:0xf
    v_mfma_f32_16x16x32_bf16 a[52:55], a[184:187], v[168:171], a[52:55]
    ds_read_b128 a[220:223], v11 offset:40960
    v_cvt_pk_bf16_f32 v139, v214, v215
    v_mfma_f32_16x16x32_bf16 a[52:55], a[188:191], v[172:175], a[52:55]
    v_add_u32 v244, s38, v244
    v_and_b32 v245, 7, v1
    v_smfmac_f32_16x16x64_bf16 a[200:203], v[52:55], v[176:183], v50
    v_mfma_f32_16x16x32_bf16 v[212:215], a[224:227], v[112:115], v[204:207]
    s_add_u32 s39, s39, 16384
    v_exp_f32 v208, v208
    v_mfma_f32_16x16x32_bf16 v[212:215], a[228:231], v[116:119], v[212:215]
    s_or_b32 s39, s39, s43
    v_exp_f32 v209, v209
    v_mfma_f32_16x16x32_bf16 v[212:215], a[232:235], v[120:123], v[212:215]
    s_and_b32 s43, s48, 2147483648
    v_exp_f32 v210, v210
    v_mfma_f32_16x16x32_bf16 v[212:215], a[236:239], v[124:127], v[212:215]
    v_exp_f32 v211, v211
    v_mfma_f32_16x16x32_bf16 a[56:59], a[184:187], v[176:179], a[56:59]
    ds_read_b64_tr_b16 a[168:169], v25 offset:16384
    v_cvt_pk_bf16_f32 v146, v208, v209
    v_mfma_f32_16x16x32_bf16 a[56:59], a[188:191], v[180:183], a[56:59]
    ds_read_b64_tr_b16 a[170:171], v25 offset:20480
    v_mfma_f32_16x16x32_bf16 a[60:63], a[184:187], v[184:187], a[60:63]
    ds_read_b128 a[224:227], v8 offset:45056
    v_cvt_pk_bf16_f32 v147, v210, v211
    v_mfma_f32_16x16x32_bf16 a[60:63], a[188:191], v[188:191], a[60:63]
    s_waitcnt lgkmcnt(3)
    buffer_load_dwordx4 v40, s[12:15], s41 offen offset:2048 lds
    v_mfma_f32_16x16x32_bf16 v[208:211], a[208:211], v[64:67], v[192:195]
    v_exp_f32 v212, v212
    v_mfma_f32_16x16x32_bf16 v[208:211], a[212:215], v[68:71], v[208:211]
    v_exp_f32 v213, v213
    v_mfma_f32_16x16x32_bf16 v[208:211], a[216:219], v[72:75], v[208:211]
    v_exp_f32 v214, v214
    v_mfma_f32_16x16x32_bf16 v[208:211], a[220:223], v[76:79], v[208:211]
    s_add_u32 s57, s58, 3538944
    v_exp_f32 v215, v215
    v_mfma_f32_16x16x32_bf16 a[64:67], a[160:163], v[160:163], a[64:67]
    ds_read_b64_tr_b16 a[172:173], v25 offset:24576
    v_cvt_pk_bf16_f32 v154, v212, v213
    v_mfma_f32_16x16x32_bf16 a[64:67], a[164:167], v[164:167], a[64:67]
    ds_read_b64_tr_b16 a[174:175], v25 offset:28672
    v_lshlrev_b32 v245, 3, v245
    v_mfma_f32_16x16x32_bf16 a[68:71], a[160:163], v[168:171], a[68:71]
    ds_read_b128 a[228:231], v9 offset:45056
    v_cvt_pk_bf16_f32 v155, v214, v215
    v_mfma_f32_16x16x32_bf16 a[68:71], a[164:167], v[172:175], a[68:71]
    buffer_load_dwordx4 a[152:155], v254, s[80:83], s57 offen
    v_smfmac_f32_16x16x64_bf16 a[204:207], v[52:55], v[184:191], v50
    ds_write_b64 v244, v[224:225]
    v_mfma_f32_16x16x32_bf16 v[212:215], a[208:211], v[80:83], v[196:199]
    v_exp_f32 v208, v208
    v_mfma_f32_16x16x32_bf16 v[212:215], a[212:215], v[84:87], v[212:215]
    v_exp_f32 v209, v209
    v_mfma_f32_16x16x32_bf16 v[212:215], a[216:219], v[88:91], v[212:215]
    v_exp_f32 v210, v210
    v_mfma_f32_16x16x32_bf16 v[212:215], a[220:223], v[92:95], v[212:215]
    v_exp_f32 v211, v211
    v_mfma_f32_16x16x32_bf16 a[72:75], a[160:163], v[176:179], a[72:75]
    ds_read_b64_tr_b16 a[176:177], v26 offset:16384
    v_cvt_pk_bf16_f32 v132, v208, v209
    v_mfma_f32_16x16x32_bf16 a[72:75], a[164:167], v[180:183], a[72:75]
    ds_read_b64_tr_b16 a[178:179], v26 offset:20480
    v_add_u32 v245, 131136, v245
    v_mfma_f32_16x16x32_bf16 a[76:79], a[160:163], v[184:187], a[76:79]
    ds_read_b128 a[232:235], v10 offset:45056
    v_cvt_pk_bf16_f32 v133, v210, v211
    v_mfma_f32_16x16x32_bf16 a[76:79], a[164:167], v[188:191], a[76:79]
    s_waitcnt lgkmcnt(3)
    buffer_load_dwordx4 v41, s[12:15], s41 offen offset:3072 lds
    v_mfma_f32_16x16x32_bf16 v[208:211], a[208:211], v[96:99], v[200:203]
    v_exp_f32 v212, v212
    v_mfma_f32_16x16x32_bf16 v[208:211], a[212:215], v[100:103], v[208:211]
    s_add_u32 s41, s41, 16384
    v_exp_f32 v213, v213
    v_mfma_f32_16x16x32_bf16 v[208:211], a[216:219], v[104:107], v[208:211]
    v_exp_f32 v214, v214
    v_mfma_f32_16x16x32_bf16 v[208:211], a[220:223], v[108:111], v[208:211]
    v_exp_f32 v215, v215
    v_mfma_f32_16x16x32_bf16 a[80:83], a[168:171], v[160:163], a[80:83]
    ds_read_b64_tr_b16 a[180:181], v26 offset:24576
    v_cvt_pk_bf16_f32 v140, v212, v213
    v_mfma_f32_16x16x32_bf16 a[80:83], a[172:175], v[164:167], a[80:83]
    ds_read_b64_tr_b16 a[182:183], v26 offset:28672
    v_mfma_f32_16x16x32_bf16 a[84:87], a[168:171], v[168:171], a[84:87]
    ds_read_b128 a[236:239], v11 offset:45056
    v_cvt_pk_bf16_f32 v141, v214, v215
    v_mfma_f32_16x16x32_bf16 a[84:87], a[172:175], v[172:175], a[84:87]
    s_waitcnt vmcnt(14)
    s_barrier
    v_mfma_f32_16x16x32_bf16 v[212:215], a[208:211], v[112:115], v[204:207]
    v_exp_f32 v208, v208
    v_mfma_f32_16x16x32_bf16 v[212:215], a[212:215], v[116:119], v[212:215]
    s_add_u32 s49, s45, 74752
    v_exp_f32 v209, v209
    v_mfma_f32_16x16x32_bf16 v[212:215], a[216:219], v[120:123], v[212:215]
    s_add_u32 m0, s42, 16384
    v_exp_f32 v210, v210
    v_mfma_f32_16x16x32_bf16 v[212:215], a[220:223], v[124:127], v[212:215]
    v_exp_f32 v211, v211
    v_mfma_f32_16x16x32_bf16 a[88:91], a[168:171], v[176:179], a[88:91]
    ds_read_b64_tr_b16 a[184:185], v27 offset:16384
    v_cvt_pk_bf16_f32 v148, v208, v209
    v_mfma_f32_16x16x32_bf16 a[88:91], a[172:175], v[180:183], a[88:91]
    ds_read_b64_tr_b16 a[186:187], v27 offset:20480
    ds_read_b64 v[224:225], v245 offset:0
    v_mfma_f32_16x16x32_bf16 a[92:95], a[168:171], v[184:187], a[92:95]
    ds_read_b128 a[208:211], v8 offset:49152
    v_cvt_pk_bf16_f32 v149, v210, v211
    v_mfma_f32_16x16x32_bf16 a[92:95], a[172:175], v[188:191], a[92:95]
    s_waitcnt lgkmcnt(3)
    buffer_load_dwordx4 v46, s[20:23], s49 offen lds
    v_mfma_f32_16x16x32_bf16 v[208:211], a[224:227], v[64:67], v[192:195]
    v_exp_f32 v212, v212
    v_mfma_f32_16x16x32_bf16 v[208:211], a[228:231], v[68:71], v[208:211]
    v_exp_f32 v213, v213
    v_mfma_f32_16x16x32_bf16 v[208:211], a[232:235], v[72:75], v[208:211]
    v_exp_f32 v214, v214
    v_mfma_f32_16x16x32_bf16 v[208:211], a[236:239], v[76:79], v[208:211]
    v_exp_f32 v215, v215
    v_mfma_f32_16x16x32_bf16 a[96:99], a[176:179], v[160:163], a[96:99]
    ds_read_b64_tr_b16 a[188:189], v27 offset:24576
    v_cvt_pk_bf16_f32 v156, v212, v213
    v_mfma_f32_16x16x32_bf16 a[96:99], a[180:183], v[164:167], a[96:99]
    ds_read_b64_tr_b16 a[190:191], v27 offset:28672
    ds_read_b64 v[226:227], v245 offset:64
    v_mfma_f32_16x16x32_bf16 a[100:103], a[176:179], v[168:171], a[100:103]
    ds_read_b128 a[212:215], v9 offset:49152
    v_cvt_pk_bf16_f32 v157, v214, v215
    v_mfma_f32_16x16x32_bf16 a[100:103], a[180:183], v[172:175], a[100:103]
    v_mfma_f32_16x16x32_bf16 v[212:215], a[224:227], v[80:83], v[196:199]
    v_exp_f32 v208, v208
    v_mfma_f32_16x16x32_bf16 v[212:215], a[228:231], v[84:87], v[212:215]
    v_exp_f32 v209, v209
    v_mfma_f32_16x16x32_bf16 v[212:215], a[232:235], v[88:91], v[212:215]
    v_exp_f32 v210, v210
    v_mfma_f32_16x16x32_bf16 v[212:215], a[236:239], v[92:95], v[212:215]
    v_exp_f32 v211, v211
    v_mfma_f32_16x16x32_bf16 a[104:107], a[176:179], v[176:179], a[104:107]
    ds_read_b64_tr_b16 a[160:161], v20 offset:32768
    v_cvt_pk_bf16_f32 v134, v208, v209
    v_mfma_f32_16x16x32_bf16 a[104:107], a[180:183], v[180:183], a[104:107]
    ds_read_b64_tr_b16 a[162:163], v20 offset:36864
    ds_read_b64 v[228:229], v245 offset:128
    v_mfma_f32_16x16x32_bf16 a[108:111], a[176:179], v[184:187], a[108:111]
    ds_read_b128 a[216:219], v10 offset:49152
    v_cvt_pk_bf16_f32 v135, v210, v211
    v_mfma_f32_16x16x32_bf16 a[108:111], a[180:183], v[188:191], a[108:111]
    s_waitcnt lgkmcnt(3)
    buffer_load_dwordx4 v47, s[20:23], s49 offen offset:1024 lds
    v_mfma_f32_16x16x32_bf16 v[208:211], a[224:227], v[96:99], v[200:203]
    v_exp_f32 v212, v212
    v_mfma_f32_16x16x32_bf16 v[208:211], a[228:231], v[100:103], v[208:211]
    v_exp_f32 v213, v213
    v_mfma_f32_16x16x32_bf16 v[208:211], a[232:235], v[104:107], v[208:211]
    v_exp_f32 v214, v214
    v_mfma_f32_16x16x32_bf16 v[208:211], a[236:239], v[108:111], v[208:211]
    s_add_u32 s57, s58, 4128768
    v_exp_f32 v215, v215
    v_mfma_f32_16x16x32_bf16 a[112:115], a[184:187], v[160:163], a[112:115]
    ds_read_b64_tr_b16 a[164:165], v20 offset:40960
    v_cvt_pk_bf16_f32 v142, v212, v213
    v_mfma_f32_16x16x32_bf16 a[112:115], a[188:191], v[164:167], a[112:115]
    ds_read_b64_tr_b16 a[166:167], v20 offset:45056
    ds_read_b64 v[230:231], v245 offset:192
    v_mfma_f32_16x16x32_bf16 a[116:119], a[184:187], v[168:171], a[116:119]
    ds_read_b128 a[220:223], v11 offset:49152
    v_cvt_pk_bf16_f32 v143, v214, v215
    v_mfma_f32_16x16x32_bf16 a[116:119], a[188:191], v[172:175], a[116:119]
    buffer_load_dwordx4 a[156:159], v254, s[80:83], s57 offen
    v_mfma_f32_16x16x32_bf16 v[212:215], a[224:227], v[112:115], v[204:207]
    v_exp_f32 v208, v208
    v_mfma_f32_16x16x32_bf16 v[212:215], a[228:231], v[116:119], v[212:215]
    v_exp_f32 v209, v209
    v_mfma_f32_16x16x32_bf16 v[212:215], a[232:235], v[120:123], v[212:215]
    v_exp_f32 v210, v210
    v_mfma_f32_16x16x32_bf16 v[212:215], a[236:239], v[124:127], v[212:215]
    v_exp_f32 v211, v211
    v_mfma_f32_16x16x32_bf16 a[120:123], a[184:187], v[176:179], a[120:123]
    ds_read_b64_tr_b16 a[168:169], v21 offset:32768
    v_cvt_pk_bf16_f32 v150, v208, v209
    v_mfma_f32_16x16x32_bf16 a[120:123], a[188:191], v[180:183], a[120:123]
    ds_read_b64_tr_b16 a[170:171], v21 offset:36864
    v_mfma_f32_16x16x32_bf16 a[124:127], a[184:187], v[184:187], a[124:127]
    ds_read_b128 a[224:227], v8 offset:53248
    v_cvt_pk_bf16_f32 v151, v210, v211
    v_mfma_f32_16x16x32_bf16 a[124:127], a[188:191], v[188:191], a[124:127]
    s_waitcnt lgkmcnt(3)
    buffer_load_dwordx4 v48, s[20:23], s49 offen offset:2048 lds
    v_mfma_f32_16x16x32_bf16 v[208:211], a[208:211], v[64:67], v[192:195]
    v_exp_f32 v212, v212
    v_mfma_f32_16x16x32_bf16 v[208:211], a[212:215], v[68:71], v[208:211]
    v_exp_f32 v213, v213
    v_mfma_f32_16x16x32_bf16 v[208:211], a[216:219], v[72:75], v[208:211]
    v_exp_f32 v214, v214
    v_mfma_f32_16x16x32_bf16 v[208:211], a[220:223], v[76:79], v[208:211]
    s_add_u32 s57, s58, 4718592
    v_exp_f32 v215, v215
    v_mfma_f32_16x16x32_bf16 a[0:3], a[160:163], v[128:131], a[0:3]
    ds_read_b64_tr_b16 a[172:173], v21 offset:40960
    v_cvt_pk_bf16_f32 v158, v212, v213
    v_mfma_f32_16x16x32_bf16 a[0:3], a[164:167], v[132:135], a[0:3]
    ds_read_b64_tr_b16 a[174:175], v21 offset:45056
    v_add_f32 v224, v224, v228
    v_mfma_f32_16x16x32_bf16 a[4:7], a[160:163], v[136:139], a[4:7]
    ds_read_b128 a[228:231], v9 offset:53248
    v_cvt_pk_bf16_f32 v159, v214, v215
    v_mfma_f32_16x16x32_bf16 a[4:7], a[164:167], v[140:143], a[4:7]
    buffer_load_dwordx4 a[240:243], v254, s[80:83], s57 offen
    v_mfma_f32_16x16x32_bf16 v[212:215], a[208:211], v[80:83], v[196:199]
    v_exp_f32 v208, v208
    v_mfma_f32_16x16x32_bf16 v[212:215], a[212:215], v[84:87], v[212:215]
    v_exp_f32 v209, v209
    v_mfma_f32_16x16x32_bf16 v[212:215], a[216:219], v[88:91], v[212:215]
    v_exp_f32 v210, v210
    v_mfma_f32_16x16x32_bf16 v[212:215], a[220:223], v[92:95], v[212:215]
    v_exp_f32 v211, v211
    v_mfma_f32_16x16x32_bf16 a[8:11], a[160:163], v[144:147], a[8:11]
    ds_read_b64_tr_b16 a[176:177], v22 offset:32768
    v_cvt_pk_bf16_f32 v160, v208, v209
    v_mfma_f32_16x16x32_bf16 a[8:11], a[164:167], v[148:151], a[8:11]
    ds_read_b64_tr_b16 a[178:179], v22 offset:36864
    v_add_f32 v225, v225, v229
    v_mfma_f32_16x16x32_bf16 a[12:15], a[160:163], v[152:155], a[12:15]
    ds_read_b128 a[232:235], v10 offset:53248
    v_cvt_pk_bf16_f32 v161, v210, v211
    v_mfma_f32_16x16x32_bf16 a[12:15], a[164:167], v[156:159], a[12:15]
    s_waitcnt lgkmcnt(3)
    buffer_load_dwordx4 v49, s[20:23], s49 offen offset:3072 lds
    v_mfma_f32_16x16x32_bf16 v[208:211], a[208:211], v[96:99], v[200:203]
    v_exp_f32 v212, v212
    v_mfma_f32_16x16x32_bf16 v[208:211], a[212:215], v[100:103], v[208:211]
    v_exp_f32 v213, v213
    v_mfma_f32_16x16x32_bf16 v[208:211], a[216:219], v[104:107], v[208:211]
    v_exp_f32 v214, v214
    v_mfma_f32_16x16x32_bf16 v[208:211], a[220:223], v[108:111], v[208:211]
    v_exp_f32 v215, v215
    v_mfma_f32_16x16x32_bf16 a[16:19], a[168:171], v[128:131], a[16:19]
    ds_read_b64_tr_b16 a[180:181], v22 offset:40960
    v_cvt_pk_bf16_f32 v168, v212, v213
    v_mfma_f32_16x16x32_bf16 a[16:19], a[172:175], v[132:135], a[16:19]
    ds_read_b64_tr_b16 a[182:183], v22 offset:45056
    v_add_f32 v226, v226, v230
    v_mfma_f32_16x16x32_bf16 a[20:23], a[168:171], v[136:139], a[20:23]
    ds_read_b128 a[236:239], v11 offset:53248
    v_cvt_pk_bf16_f32 v169, v214, v215
    v_mfma_f32_16x16x32_bf16 a[20:23], a[172:175], v[140:143], a[20:23]
    v_add_f32 v227, v227, v231
    v_add_f32 v224, v224, v226
    v_smfmac_f32_16x16x64_bf16 a[192:195], v[52:55], v[128:135], v50
    v_mfma_f32_16x16x32_bf16 v[212:215], a[208:211], v[112:115], v[204:207]
    v_exp_f32 v208, v208
    v_mfma_f32_16x16x32_bf16 v[212:215], a[212:215], v[116:119], v[212:215]
    s_add_u32 s49, s7, 0
    v_exp_f32 v209, v209
    v_mfma_f32_16x16x32_bf16 v[212:215], a[216:219], v[120:123], v[212:215]
    s_add_u32 m0, s42, 65536
    v_exp_f32 v210, v210
    v_mfma_f32_16x16x32_bf16 v[212:215], a[220:223], v[124:127], v[212:215]
    v_exp_f32 v211, v211
    v_mfma_f32_16x16x32_bf16 a[24:27], a[168:171], v[144:147], a[24:27]
    ds_read_b64_tr_b16 a[184:185], v23 offset:32768
    v_cvt_pk_bf16_f32 v176, v208, v209
    v_mfma_f32_16x16x32_bf16 a[24:27], a[172:175], v[148:151], a[24:27]
    ds_read_b64_tr_b16 a[186:187], v23 offset:36864
    v_add_f32 v225, v225, v227
    v_mfma_f32_16x16x32_bf16 a[28:31], a[168:171], v[152:155], a[28:31]
    ds_read_b128 a[208:211], v8 offset:57344
    v_cvt_pk_bf16_f32 v177, v210, v211
    v_mfma_f32_16x16x32_bf16 a[28:31], a[172:175], v[156:159], a[28:31]
    s_waitcnt lgkmcnt(3)
    buffer_load_dwordx4 v46, s[20:23], s49 offen lds
    v_mfma_f32_16x16x32_bf16 v[208:211], a[224:227], v[64:67], v[192:195]
    v_exp_f32 v212, v212
    v_mfma_f32_16x16x32_bf16 v[208:211], a[228:231], v[68:71], v[208:211]
    v_exp_f32 v213, v213
    v_mfma_f32_16x16x32_bf16 v[208:211], a[232:235], v[72:75], v[208:211]
    v_exp_f32 v214, v214
    v_mfma_f32_16x16x32_bf16 v[208:211], a[236:239], v[76:79], v[208:211]
    s_add_u32 s57, s58, 4128768
    v_exp_f32 v215, v215
    v_mfma_f32_16x16x32_bf16 a[32:35], a[176:179], v[128:131], a[32:35]
    ds_read_b64_tr_b16 a[188:189], v23 offset:40960
    v_cvt_pk_bf16_f32 v184, v212, v213
    v_mfma_f32_16x16x32_bf16 a[32:35], a[180:183], v[132:135], a[32:35]
    ds_read_b64_tr_b16 a[190:191], v23 offset:45056
    v_cvt_pk_bf16_f32 v246, v224, v225
    v_mfma_f32_16x16x32_bf16 a[36:39], a[176:179], v[136:139], a[36:39]
    ds_read_b128 a[212:215], v9 offset:57344
    v_cvt_pk_bf16_f32 v185, v214, v215
    v_mfma_f32_16x16x32_bf16 a[36:39], a[180:183], v[140:143], a[36:39]
    buffer_load_dwordx4 a[244:247], v254, s[32:35], s57 offen
    v_smfmac_f32_16x16x64_bf16 a[196:199], v[52:55], v[136:143], v50
    v_mfma_f32_16x16x32_bf16 v[212:215], a[224:227], v[80:83], v[196:199]
    v_exp_f32 v208, v208
    v_mfma_f32_16x16x32_bf16 v[212:215], a[228:231], v[84:87], v[212:215]
    v_exp_f32 v209, v209
    v_mfma_f32_16x16x32_bf16 v[212:215], a[232:235], v[88:91], v[212:215]
    v_exp_f32 v210, v210
    v_mfma_f32_16x16x32_bf16 v[212:215], a[236:239], v[92:95], v[212:215]
    v_exp_f32 v211, v211
    v_mfma_f32_16x16x32_bf16 a[40:43], a[176:179], v[144:147], a[40:43]
    ds_read_b64_tr_b16 a[160:161], v24 offset:32768
    v_cvt_pk_bf16_f32 v162, v208, v209
    v_mfma_f32_16x16x32_bf16 a[40:43], a[180:183], v[148:151], a[40:43]
    ds_read_b64_tr_b16 a[162:163], v24 offset:36864
    v_lshlrev_b32 v224, 16, v246
    v_mfma_f32_16x16x32_bf16 a[44:47], a[176:179], v[152:155], a[44:47]
    ds_read_b128 a[216:219], v10 offset:57344
    v_cvt_pk_bf16_f32 v163, v210, v211
    v_mfma_f32_16x16x32_bf16 a[44:47], a[180:183], v[156:159], a[44:47]
    s_waitcnt lgkmcnt(3)
    buffer_load_dwordx4 v47, s[20:23], s49 offen offset:1024 lds
    v_mfma_f32_16x16x32_bf16 v[208:211], a[224:227], v[96:99], v[200:203]
    v_exp_f32 v212, v212
    v_mfma_f32_16x16x32_bf16 v[208:211], a[228:231], v[100:103], v[208:211]
    v_exp_f32 v213, v213
    v_mfma_f32_16x16x32_bf16 v[208:211], a[232:235], v[104:107], v[208:211]
    v_exp_f32 v214, v214
    v_mfma_f32_16x16x32_bf16 v[208:211], a[236:239], v[108:111], v[208:211]
    v_exp_f32 v215, v215
    v_mfma_f32_16x16x32_bf16 a[48:51], a[184:187], v[128:131], a[48:51]
    ds_read_b64_tr_b16 a[164:165], v24 offset:40960
    v_cvt_pk_bf16_f32 v170, v212, v213
    v_mfma_f32_16x16x32_bf16 a[48:51], a[188:191], v[132:135], a[48:51]
    ds_read_b64_tr_b16 a[166:167], v24 offset:45056
    v_and_b32 v225, 0xffff0000, v246
    v_mfma_f32_16x16x32_bf16 a[52:55], a[184:187], v[136:139], a[52:55]
    ds_read_b128 a[220:223], v11 offset:57344
    v_cvt_pk_bf16_f32 v171, v214, v215
    v_mfma_f32_16x16x32_bf16 a[52:55], a[188:191], v[140:143], a[52:55]
    v_add_f32 v224, s36, v224
    v_add_f32 v225, s36, v225
    v_smfmac_f32_16x16x64_bf16 a[200:203], v[52:55], v[144:151], v50
    v_mfma_f32_16x16x32_bf16 v[212:215], a[224:227], v[112:115], v[204:207]
    v_exp_f32 v208, v208
    v_mfma_f32_16x16x32_bf16 v[212:215], a[228:231], v[116:119], v[212:215]
    v_exp_f32 v209, v209
    v_mfma_f32_16x16x32_bf16 v[212:215], a[232:235], v[120:123], v[212:215]
    v_exp_f32 v210, v210
    v_mfma_f32_16x16x32_bf16 v[212:215], a[236:239], v[124:127], v[212:215]
    v_exp_f32 v211, v211
    v_mfma_f32_16x16x32_bf16 a[56:59], a[184:187], v[144:147], a[56:59]
    ds_read_b64_tr_b16 a[168:169], v25 offset:32768
    v_cvt_pk_bf16_f32 v178, v208, v209
    v_mfma_f32_16x16x32_bf16 a[56:59], a[188:191], v[148:151], a[56:59]
    ds_read_b64_tr_b16 a[170:171], v25 offset:36864
    v_cvt_pk_bf16_f32 v246, v224, v225
    v_mfma_f32_16x16x32_bf16 a[60:63], a[184:187], v[152:155], a[60:63]
    ds_read_b128 a[224:227], v8 offset:61440
    v_cvt_pk_bf16_f32 v179, v210, v211
    v_mfma_f32_16x16x32_bf16 a[60:63], a[188:191], v[156:159], a[60:63]
    s_waitcnt lgkmcnt(3)
    buffer_load_dwordx4 v48, s[20:23], s49 offen offset:2048 lds
    v_mfma_f32_16x16x32_bf16 v[208:211], a[208:211], v[64:67], v[192:195]
    v_exp_f32 v212, v212
    v_mfma_f32_16x16x32_bf16 v[208:211], a[212:215], v[68:71], v[208:211]
    v_exp_f32 v213, v213
    v_mfma_f32_16x16x32_bf16 v[208:211], a[216:219], v[72:75], v[208:211]
    v_exp_f32 v214, v214
    v_mfma_f32_16x16x32_bf16 v[208:211], a[220:223], v[76:79], v[208:211]
    s_add_u32 s57, s58, 4718592
    v_exp_f32 v215, v215
    v_mfma_f32_16x16x32_bf16 a[64:67], a[160:163], v[128:131], a[64:67]
    ds_read_b64_tr_b16 a[172:173], v25 offset:40960
    v_cvt_pk_bf16_f32 v186, v212, v213
    v_mfma_f32_16x16x32_bf16 a[64:67], a[164:167], v[132:135], a[64:67]
    ds_read_b64_tr_b16 a[174:175], v25 offset:45056
    v_lshrrev_b32 v244, 1, v0
    v_mfma_f32_16x16x32_bf16 a[68:71], a[160:163], v[136:139], a[68:71]
    ds_read_b128 a[228:231], v9 offset:61440
    v_cvt_pk_bf16_f32 v187, v214, v215
    v_mfma_f32_16x16x32_bf16 a[68:71], a[164:167], v[140:143], a[68:71]
    buffer_load_dwordx4 a[248:251], v254, s[32:35], s57 offen
    v_smfmac_f32_16x16x64_bf16 a[204:207], v[52:55], v[152:159], v50
    v_mfma_f32_16x16x32_bf16 v[212:215], a[208:211], v[80:83], v[196:199]
    v_exp_f32 v208, v208
    v_mfma_f32_16x16x32_bf16 v[212:215], a[212:215], v[84:87], v[212:215]
    v_exp_f32 v209, v209
    v_mfma_f32_16x16x32_bf16 v[212:215], a[216:219], v[88:91], v[212:215]
    v_exp_f32 v210, v210
    v_mfma_f32_16x16x32_bf16 v[212:215], a[220:223], v[92:95], v[212:215]
    v_exp_f32 v211, v211
    v_mfma_f32_16x16x32_bf16 a[72:75], a[160:163], v[144:147], a[72:75]
    ds_read_b64_tr_b16 a[176:177], v26 offset:32768
    v_cvt_pk_bf16_f32 v164, v208, v209
    v_mfma_f32_16x16x32_bf16 a[72:75], a[164:167], v[148:151], a[72:75]
    ds_read_b64_tr_b16 a[178:179], v26 offset:36864
    v_lshlrev_b32 v244, 4, v244
    v_mfma_f32_16x16x32_bf16 a[76:79], a[160:163], v[152:155], a[76:79]
    ds_read_b128 a[232:235], v10 offset:61440
    v_cvt_pk_bf16_f32 v165, v210, v211
    v_mfma_f32_16x16x32_bf16 a[76:79], a[164:167], v[156:159], a[76:79]
    s_waitcnt lgkmcnt(3)
    buffer_load_dwordx4 v49, s[20:23], s49 offen offset:3072 lds
    v_mfma_f32_16x16x32_bf16 v[208:211], a[208:211], v[96:99], v[200:203]
    v_exp_f32 v212, v212
    v_mfma_f32_16x16x32_bf16 v[208:211], a[212:215], v[100:103], v[208:211]
    v_exp_f32 v213, v213
    v_mfma_f32_16x16x32_bf16 v[208:211], a[216:219], v[104:107], v[208:211]
    v_exp_f32 v214, v214
    v_mfma_f32_16x16x32_bf16 v[208:211], a[220:223], v[108:111], v[208:211]
    v_exp_f32 v215, v215
    v_mfma_f32_16x16x32_bf16 a[80:83], a[168:171], v[128:131], a[80:83]
    ds_read_b64_tr_b16 a[180:181], v26 offset:40960
    v_cvt_pk_bf16_f32 v172, v212, v213
    v_mfma_f32_16x16x32_bf16 a[80:83], a[172:175], v[132:135], a[80:83]
    ds_read_b64_tr_b16 a[182:183], v26 offset:45056
    v_and_b32 v245, 1, v0
    v_mfma_f32_16x16x32_bf16 a[84:87], a[168:171], v[136:139], a[84:87]
    ds_read_b128 a[236:239], v11 offset:61440
    v_cvt_pk_bf16_f32 v173, v214, v215
    v_mfma_f32_16x16x32_bf16 a[84:87], a[172:175], v[140:143], a[84:87]
    s_waitcnt vmcnt(12)
    s_barrier
    v_mfma_f32_16x16x32_bf16 v[212:215], a[208:211], v[112:115], v[204:207]
    v_exp_f32 v208, v208
    v_mfma_f32_16x16x32_bf16 v[212:215], a[212:215], v[116:119], v[212:215]
    s_add_u32 s49, s7, 73728
    v_exp_f32 v209, v209
    v_mfma_f32_16x16x32_bf16 v[212:215], a[216:219], v[120:123], v[212:215]
    s_add_u32 m0, s42, 81920
    v_exp_f32 v210, v210
    v_mfma_f32_16x16x32_bf16 v[212:215], a[220:223], v[124:127], v[212:215]
    v_exp_f32 v211, v211
    v_mfma_f32_16x16x32_bf16 a[88:91], a[168:171], v[144:147], a[88:91]
    ds_read_b64_tr_b16 a[184:185], v27 offset:32768
    v_cvt_pk_bf16_f32 v180, v208, v209
    v_mfma_f32_16x16x32_bf16 a[88:91], a[172:175], v[148:151], a[88:91]
    ds_read_b64_tr_b16 a[186:187], v27 offset:36864
    v_lshl_add_u32 v244, v245, 2, v244
    v_mfma_f32_16x16x32_bf16 a[92:95], a[168:171], v[152:155], a[92:95]
Ltour7:
    s_cbranch_execz Ltour11
    v_cvt_pk_bf16_f32 v181, v210, v211
    v_mfma_f32_16x16x32_bf16 a[92:95], a[172:175], v[156:159], a[92:95]
    s_waitcnt lgkmcnt(3)
    buffer_load_dwordx4 v46, s[20:23], s49 offen lds
    v_mfma_f32_16x16x32_bf16 v[208:211], a[224:227], v[64:67], v[192:195]
    v_exp_f32 v212, v212
    v_mfma_f32_16x16x32_bf16 v[208:211], a[228:231], v[68:71], v[208:211]
    v_exp_f32 v213, v213
    v_mfma_f32_16x16x32_bf16 v[208:211], a[232:235], v[72:75], v[208:211]
    s_waitcnt lgkmcnt(2)
    v_exp_f32 v214, v214
    v_mfma_f32_16x16x32_bf16 v[208:211], a[236:239], v[76:79], v[208:211]
    s_add_u32 s37, s55, 8192
    v_exp_f32 v215, v215
    v_mfma_f32_16x16x32_bf16 a[96:99], a[176:179], v[128:131], a[96:99]
    ds_read_b64_tr_b16 a[188:189], v27 offset:40960
    v_cvt_pk_bf16_f32 v188, v212, v213
    v_mfma_f32_16x16x32_bf16 a[96:99], a[180:183], v[132:135], a[96:99]
    ds_read_b64_tr_b16 a[190:191], v27 offset:45056
    v_lshrrev_b32 v245, 3, v0
    v_mfma_f32_16x16x32_bf16 a[100:103], a[176:179], v[136:139], a[100:103]
    v_cvt_pk_bf16_f32 v189, v214, v215
    v_mfma_f32_16x16x32_bf16 a[100:103], a[180:183], v[140:143], a[100:103]
    buffer_load_dword v239, v238, s[28:31], s37 offen
    v_mfma_f32_16x16x32_bf16 v[212:215], a[224:227], v[80:83], v[196:199]
    v_exp_f32 v208, v208
    v_mfma_f32_16x16x32_bf16 v[212:215], a[228:231], v[84:87], v[212:215]
    v_exp_f32 v209, v209
    v_mfma_f32_16x16x32_bf16 v[212:215], a[232:235], v[88:91], v[212:215]
    v_exp_f32 v210, v210
    v_mfma_f32_16x16x32_bf16 v[212:215], a[236:239], v[92:95], v[212:215]
    v_exp_f32 v211, v211
    v_mfma_f32_16x16x32_bf16 a[104:107], a[176:179], v[144:147], a[104:107]
    ds_read_b64_tr_b16 a[160:161], v20 offset:49152
    v_cvt_pk_bf16_f32 v166, v208, v209
    v_mfma_f32_16x16x32_bf16 a[104:107], a[180:183], v[148:151], a[104:107]
    ds_read_b64_tr_b16 a[162:163], v20 offset:53248
    v_min_u32 v245, 1, v245
    v_mfma_f32_16x16x32_bf16 a[108:111], a[176:179], v[152:155], a[108:111]
    v_cvt_pk_bf16_f32 v167, v210, v211
    v_mfma_f32_16x16x32_bf16 a[108:111], a[180:183], v[156:159], a[108:111]
    s_waitcnt lgkmcnt(3)
    buffer_load_dwordx4 v47, s[20:23], s49 offen offset:1024 lds
    v_mfma_f32_16x16x32_bf16 v[208:211], a[224:227], v[96:99], v[200:203]
    v_exp_f32 v212, v212
    v_mfma_f32_16x16x32_bf16 v[208:211], a[228:231], v[100:103], v[208:211]
    v_exp_f32 v213, v213
    v_mfma_f32_16x16x32_bf16 v[208:211], a[232:235], v[104:107], v[208:211]
    v_exp_f32 v214, v214
    v_mfma_f32_16x16x32_bf16 v[208:211], a[236:239], v[108:111], v[208:211]
    s_add_u32 s57, s59, 0
    v_exp_f32 v215, v215
    v_mfma_f32_16x16x32_bf16 a[112:115], a[184:187], v[128:131], a[112:115]
    s_waitcnt lgkmcnt(2)
    ds_read_b64_tr_b16 a[164:165], v20 offset:57344
    v_cvt_pk_bf16_f32 v174, v212, v213
    v_mfma_f32_16x16x32_bf16 a[112:115], a[188:191], v[132:135], a[112:115]
    ds_read_b64_tr_b16 a[166:167], v20 offset:61440
    v_lshl_or_b32 v244, v245, 31, v244
    v_mfma_f32_16x16x32_bf16 a[116:119], a[184:187], v[136:139], a[116:119]
    v_cvt_pk_bf16_f32 v175, v214, v215
    v_mfma_f32_16x16x32_bf16 a[116:119], a[188:191], v[140:143], a[116:119]
    buffer_load_dwordx4 a[252:255], v255, s[84:87], s57 offen
    v_mfma_f32_16x16x32_bf16 v[212:215], a[224:227], v[112:115], v[204:207]
    v_exp_f32 v208, v208
    v_mfma_f32_16x16x32_bf16 v[212:215], a[228:231], v[116:119], v[212:215]
    v_exp_f32 v209, v209
    v_mfma_f32_16x16x32_bf16 v[212:215], a[232:235], v[120:123], v[212:215]
    v_exp_f32 v210, v210
    v_mfma_f32_16x16x32_bf16 v[212:215], a[236:239], v[124:127], v[212:215]
    v_exp_f32 v211, v211
    v_mfma_f32_16x16x32_bf16 a[120:123], a[184:187], v[144:147], a[120:123]
    ds_read_b64_tr_b16 a[168:169], v21 offset:49152
    v_cvt_pk_bf16_f32 v182, v208, v209
    v_mfma_f32_16x16x32_bf16 a[120:123], a[188:191], v[148:151], a[120:123]
    ds_read_b64_tr_b16 a[170:171], v21 offset:53248
    v_mfma_f32_16x16x32_bf16 a[124:127], a[184:187], v[152:155], a[124:127]
    v_cvt_pk_bf16_f32 v183, v210, v211
    v_mfma_f32_16x16x32_bf16 a[124:127], a[188:191], v[156:159], a[124:127]
    s_waitcnt lgkmcnt(3)
    buffer_load_dwordx4 v48, s[20:23], s49 offen offset:2048 lds
    v_exp_f32 v212, v212
    v_exp_f32 v213, v213
    v_exp_f32 v214, v214
    v_exp_f32 v215, v215
    v_mfma_f32_16x16x32_bf16 a[0:3], a[160:163], v[160:163], a[0:3]
    s_waitcnt lgkmcnt(2)
    ds_read_b64_tr_b16 a[172:173], v21 offset:57344
    v_cvt_pk_bf16_f32 v190, v212, v213
    v_mfma_f32_16x16x32_bf16 a[0:3], a[164:167], v[164:167], a[0:3]
    ds_read_b64_tr_b16 a[174:175], v21 offset:61440
    v_mfma_f32_16x16x32_bf16 a[4:7], a[160:163], v[168:171], a[4:7]
    v_cvt_pk_bf16_f32 v191, v214, v215
    v_mfma_f32_16x16x32_bf16 a[4:7], a[164:167], v[172:175], a[4:7]
    buffer_store_dword v246, v244, s[24:27], s39 offen sc1
    v_mfma_f32_16x16x32_bf16 a[8:11], a[160:163], v[176:179], a[8:11]
    ds_read_b64_tr_b16 a[176:177], v22 offset:49152
    v_mfma_f32_16x16x32_bf16 a[8:11], a[164:167], v[180:183], a[8:11]
    ds_read_b64_tr_b16 a[178:179], v22 offset:53248
    v_mfma_f32_16x16x32_bf16 a[12:15], a[160:163], v[184:187], a[12:15]
    v_mfma_f32_16x16x32_bf16 a[12:15], a[164:167], v[188:191], a[12:15]
    buffer_load_dwordx4 v49, s[20:23], s49 offen offset:3072 lds
    v_smfmac_f32_16x16x64_bf16 a[192:195], v[52:55], v[160:167], v50
    s_waitcnt lgkmcnt(4)
    v_mfma_f32_16x16x32_bf16 a[16:19], a[168:171], v[160:163], a[16:19]
    s_waitcnt lgkmcnt(2)
    ds_read_b64_tr_b16 a[180:181], v22 offset:57344
    v_mfma_f32_16x16x32_bf16 a[16:19], a[172:175], v[164:167], a[16:19]
    ds_read_b64_tr_b16 a[182:183], v22 offset:61440
    v_mfma_f32_16x16x32_bf16 a[20:23], a[168:171], v[168:171], a[20:23]
    v_min_u32 v240, 1, v0
    v_mfma_f32_16x16x32_bf16 a[20:23], a[172:175], v[172:175], a[20:23]
    v_smfmac_f32_16x16x64_bf16 a[196:199], v[52:55], v[168:175], v50
    s_add_u32 s49, s7, 256
    s_add_u32 m0, s42, 32768
    v_mfma_f32_16x16x32_bf16 a[24:27], a[168:171], v[176:179], a[24:27]
    ds_read_b64_tr_b16 a[184:185], v23 offset:49152
    v_mfma_f32_16x16x32_bf16 a[24:27], a[172:175], v[180:183], a[24:27]
    ds_read_b64_tr_b16 a[186:187], v23 offset:53248
    v_mfma_f32_16x16x32_bf16 a[28:31], a[168:171], v[184:187], a[28:31]
    v_lshlrev_b32 v240, 31, v240
    v_mfma_f32_16x16x32_bf16 a[28:31], a[172:175], v[188:191], a[28:31]
    buffer_load_dwordx4 v46, s[20:23], s49 offen lds
    v_smfmac_f32_16x16x64_bf16 a[200:203], v[52:55], v[176:183], v50
    s_waitcnt lgkmcnt(4)
    v_mfma_f32_16x16x32_bf16 a[32:35], a[176:179], v[160:163], a[32:35]
    s_waitcnt lgkmcnt(2)
    ds_read_b64_tr_b16 a[188:189], v23 offset:57344
    v_mfma_f32_16x16x32_bf16 a[32:35], a[180:183], v[164:167], a[32:35]
    ds_read_b64_tr_b16 a[190:191], v23 offset:61440
    v_mfma_f32_16x16x32_bf16 a[36:39], a[176:179], v[168:171], a[36:39]
    v_mov_b32 v241, 1
    v_mfma_f32_16x16x32_bf16 a[36:39], a[180:183], v[172:175], a[36:39]
    v_smfmac_f32_16x16x64_bf16 a[204:207], v[52:55], v[184:191], v50
    v_mfma_f32_16x16x32_bf16 a[40:43], a[176:179], v[176:179], a[40:43]
    ds_read_b64_tr_b16 a[160:161], v24 offset:49152
    v_mfma_f32_16x16x32_bf16 a[40:43], a[180:183], v[180:183], a[40:43]
    ds_read_b64_tr_b16 a[162:163], v24 offset:53248
    v_mfma_f32_16x16x32_bf16 a[44:47], a[176:179], v[184:187], a[44:47]
    v_mfma_f32_16x16x32_bf16 a[44:47], a[180:183], v[188:191], a[44:47]
    s_waitcnt lgkmcnt(4)
    buffer_load_dwordx4 v47, s[20:23], s49 offen offset:1024 lds
    v_mfma_f32_16x16x32_bf16 a[48:51], a[184:187], v[160:163], a[48:51]
    s_waitcnt lgkmcnt(2)
    ds_read_b64_tr_b16 a[164:165], v24 offset:57344
    v_accvgpr_read_b32 v216, a192
    v_mfma_f32_16x16x32_bf16 a[48:51], a[188:191], v[164:167], a[48:51]
    ds_read_b64_tr_b16 a[166:167], v24 offset:61440
    v_accvgpr_read_b32 v217, a193
    v_mfma_f32_16x16x32_bf16 a[52:55], a[184:187], v[168:171], a[52:55]
    v_accvgpr_read_b32 v218, a196
    v_accvgpr_read_b32 v219, a197
    v_mfma_f32_16x16x32_bf16 a[52:55], a[188:191], v[172:175], a[52:55]
    v_accvgpr_read_b32 v220, a200
    v_accvgpr_read_b32 v221, a201
    v_mfma_f32_16x16x32_bf16 a[56:59], a[184:187], v[176:179], a[56:59]
    ds_read_b64_tr_b16 a[168:169], v25 offset:49152
    v_accvgpr_read_b32 v222, a204
    v_mfma_f32_16x16x32_bf16 a[56:59], a[188:191], v[180:183], a[56:59]
    ds_read_b64_tr_b16 a[170:171], v25 offset:53248
    v_accvgpr_read_b32 v223, a205
    v_mfma_f32_16x16x32_bf16 a[60:63], a[184:187], v[184:187], a[60:63]
    v_add_f32 v58, v216, v217
    v_add_f32 v59, v218, v219
    v_mfma_f32_16x16x32_bf16 a[60:63], a[188:191], v[188:191], a[60:63]
    s_waitcnt lgkmcnt(4)
    buffer_load_dwordx4 v48, s[20:23], s49 offen offset:2048 lds
    v_add_f32 v60, v220, v221
    v_add_f32 v61, v222, v223
    v_mfma_f32_16x16x32_bf16 a[64:67], a[160:163], v[160:163], a[64:67]
    s_waitcnt lgkmcnt(2)
    ds_read_b64_tr_b16 a[172:173], v25 offset:57344
    v_add_f32 v216, v58, v59
    v_mfma_f32_16x16x32_bf16 a[64:67], a[164:167], v[164:167], a[64:67]
    ds_read_b64_tr_b16 a[174:175], v25 offset:61440
    v_add_f32 v217, v60, v61
    v_mfma_f32_16x16x32_bf16 a[68:71], a[160:163], v[168:171], a[68:71]
    v_add_f32 v216, v216, v217
    v_cmp_ngt_f32 vcc, 1669332992, v216
    v_mfma_f32_16x16x32_bf16 a[68:71], a[164:167], v[172:175], a[68:71]
    v_rcp_f32 v58, v58
    v_rcp_f32 v59, v59
    v_mfma_f32_16x16x32_bf16 a[72:75], a[160:163], v[176:179], a[72:75]
    ds_read_b64_tr_b16 a[176:177], v26 offset:49152
    v_rcp_f32 v60, v60
    v_mfma_f32_16x16x32_bf16 a[72:75], a[164:167], v[180:183], a[72:75]
    ds_read_b64_tr_b16 a[178:179], v26 offset:53248
    v_rcp_f32 v61, v61
    v_mfma_f32_16x16x32_bf16 a[76:79], a[160:163], v[184:187], a[76:79]
    v_mov_b32 v228, 131072
    s_or_b32 s36, vcc_lo, vcc_hi
    v_mfma_f32_16x16x32_bf16 a[76:79], a[164:167], v[188:191], a[76:79]
    s_waitcnt lgkmcnt(4)
    buffer_load_dwordx4 v49, s[20:23], s49 offen offset:3072 lds
    v_mov_b32 v218, s36
    s_lshl_b32 s37, s3, 2
    v_mfma_f32_16x16x32_bf16 a[80:83], a[168:171], v[160:163], a[80:83]
    s_waitcnt lgkmcnt(2)
    ds_read_b64_tr_b16 a[180:181], v26 offset:57344
    v_add_u32 v219, s37, v228
    ds_write_b32 v219, v218
    v_mfma_f32_16x16x32_bf16 a[80:83], a[172:175], v[164:167], a[80:83]
    ds_read_b64_tr_b16 a[182:183], v26 offset:61440
    v_mfma_f32_16x16x32_bf16 a[84:87], a[168:171], v[168:171], a[84:87]
    v_mfma_f32_16x16x32_bf16 a[84:87], a[172:175], v[172:175], a[84:87]
    s_waitcnt lgkmcnt(1)
    s_waitcnt vmcnt(17)
    s_barrier
    v_mfma_f32_16x16x32_bf16 a[88:91], a[168:171], v[176:179], a[88:91]
    ds_read_b64_tr_b16 a[184:185], v27 offset:49152
    v_mfma_f32_16x16x32_bf16 a[88:91], a[172:175], v[180:183], a[88:91]
    ds_read_b64_tr_b16 a[186:187], v27 offset:53248
    v_mfma_f32_16x16x32_bf16 a[92:95], a[168:171], v[184:187], a[92:95]
    ds_read_b128 v[224:227], v228
    v_mfma_f32_16x16x32_bf16 a[92:95], a[172:175], v[188:191], a[92:95]
    s_add_u32 s49, s7, 73984
    v_mfma_f32_16x16x32_bf16 a[96:99], a[176:179], v[160:163], a[96:99]
    s_waitcnt lgkmcnt(3)
    s_add_u32 m0, s42, 49152
    ds_read_b64_tr_b16 a[188:189], v27 offset:57344
    v_mfma_f32_16x16x32_bf16 a[96:99], a[180:183], v[164:167], a[96:99]
    buffer_load_dwordx4 v46, s[20:23], s49 offen lds
    v_mfma_f32_16x16x32_bf16 a[100:103], a[176:179], v[168:171], a[100:103]
    ds_read_b64_tr_b16 a[190:191], v27 offset:61440
    v_mfma_f32_16x16x32_bf16 a[100:103], a[180:183], v[172:175], a[100:103]
    buffer_load_dwordx4 v47, s[20:23], s49 offen offset:1024 lds
    v_mfma_f32_16x16x32_bf16 a[104:107], a[176:179], v[176:179], a[104:107]
    v_mfma_f32_16x16x32_bf16 a[104:107], a[180:183], v[180:183], a[104:107]
    buffer_load_dwordx4 v48, s[20:23], s49 offen offset:2048 lds
    v_mfma_f32_16x16x32_bf16 a[108:111], a[176:179], v[184:187], a[108:111]
    v_mfma_f32_16x16x32_bf16 a[108:111], a[180:183], v[188:191], a[108:111]
    s_waitcnt lgkmcnt(3)
    buffer_load_dwordx4 v49, s[20:23], s49 offen offset:3072 lds
    s_add_u32 s49, s46, 0
    v_mfma_f32_16x16x32_bf16 a[112:115], a[184:187], v[160:163], a[112:115]
    s_waitcnt lgkmcnt(0)
    s_add_u32 m0, s42, 98304
    v_mfma_f32_16x16x32_bf16 a[112:115], a[188:191], v[164:167], a[112:115]
    buffer_load_dwordx4 v46, s[20:23], s49 offen lds
    v_mfma_f32_16x16x32_bf16 a[116:119], a[184:187], v[168:171], a[116:119]
    v_mfma_f32_16x16x32_bf16 a[116:119], a[188:191], v[172:175], a[116:119]
    buffer_load_dwordx4 v47, s[20:23], s49 offen offset:1024 lds
    v_mfma_f32_16x16x32_bf16 a[120:123], a[184:187], v[176:179], a[120:123]
    v_mfma_f32_16x16x32_bf16 a[120:123], a[188:191], v[180:183], a[120:123]
    buffer_load_dwordx4 v48, s[20:23], s49 offen offset:2048 lds
    v_mfma_f32_16x16x32_bf16 a[124:127], a[184:187], v[184:187], a[124:127]
    v_mfma_f32_16x16x32_bf16 a[124:127], a[188:191], v[188:191], a[124:127]
    buffer_load_dwordx4 v49, s[20:23], s49 offen offset:3072 lds
    v_or3_b32 v224, v224, v225, v226
    v_or_b32 v224, v224, v227
    s_nop 0
    v_readfirstlane_b32 s36, v224
    v_readfirstlane_b32 s38, v253
    v_min_u32 v8, 1, v1
    v_lshlrev_b32 v8, 31, v8
    v_mov_b32 v10, s95
    s_getreg_b32 s39, hwreg(HW_REG_XCC_ID, 0, 4)
    s_add_u32 s39, s39, s95
    s_cmp_eq_u32 s38, s39
    s_cselect_b32 s53, 1, 0
    ds_read_b64_tr_b16 a[208:209], v12 offset:0
    ds_read_b64_tr_b16 a[210:211], v12 offset:4096
    ds_read_b64_tr_b16 a[212:213], v12 offset:8192
    ds_read_b64_tr_b16 a[214:215], v12 offset:12288
    ds_read_b64_tr_b16 a[216:217], v12 offset:16384
    ds_read_b64_tr_b16 a[218:219], v12 offset:20480
    ds_read_b64_tr_b16 a[220:221], v12 offset:24576
    ds_read_b64_tr_b16 a[222:223], v12 offset:28672
    ds_read_b64_tr_b16 a[224:225], v16 offset:0
    ds_read_b64_tr_b16 a[226:227], v16 offset:4096
    ds_read_b64_tr_b16 a[228:229], v16 offset:8192
    ds_read_b64_tr_b16 a[230:231], v16 offset:12288
    ds_read_b64_tr_b16 a[232:233], v16 offset:16384
    ds_read_b64_tr_b16 a[234:235], v16 offset:20480
    ds_read_b64_tr_b16 a[236:237], v16 offset:24576
    ds_read_b64_tr_b16 a[238:239], v16 offset:28672
    s_waitcnt vmcnt(13)
    buffer_atomic_add v241, v240, s[88:91], s43 offen sc1
    s_andn2_b32 s36, s36, s48
    s_cbranch_scc1 Lattn_redo
    v_accvgpr_read_b32 v216, a0
    v_accvgpr_read_b32 v217, a1
    v_accvgpr_read_b32 v218, a2
    v_accvgpr_read_b32 v219, a3
    v_pk_mul_f32 v[216:217], v[216:217], v[58:59] op_sel:[0,0] op_sel_hi:[1,0]
    v_pk_mul_f32 v[218:219], v[218:219], v[58:59] op_sel:[0,0] op_sel_hi:[1,0]
    v_cvt_pk_bf16_f32 v128, v216, v217
    v_cvt_pk_bf16_f32 v129, v218, v219
    v_accvgpr_read_b32 v220, a4
    v_accvgpr_read_b32 v221, a5
    v_accvgpr_read_b32 v222, a6
    v_accvgpr_read_b32 v223, a7
    v_pk_mul_f32 v[220:221], v[220:221], v[58:59] op_sel:[0,1] op_sel_hi:[1,1]
    v_pk_mul_f32 v[222:223], v[222:223], v[58:59] op_sel:[0,1] op_sel_hi:[1,1]
    v_cvt_pk_bf16_f32 v160, v220, v221
    v_cvt_pk_bf16_f32 v161, v222, v223
    v_accvgpr_read_b32 v224, a8
    v_accvgpr_read_b32 v225, a9
    v_accvgpr_read_b32 v226, a10
    v_accvgpr_read_b32 v227, a11
    v_pk_mul_f32 v[224:225], v[224:225], v[60:61] op_sel:[0,0] op_sel_hi:[1,0]
    v_pk_mul_f32 v[226:227], v[226:227], v[60:61] op_sel:[0,0] op_sel_hi:[1,0]
    v_cvt_pk_bf16_f32 v144, v224, v225
    v_cvt_pk_bf16_f32 v145, v226, v227
    v_accvgpr_read_b32 v228, a12
    v_accvgpr_read_b32 v229, a13
    v_accvgpr_read_b32 v230, a14
    v_accvgpr_read_b32 v231, a15
    v_pk_mul_f32 v[228:229], v[228:229], v[60:61] op_sel:[0,1] op_sel_hi:[1,1]
    v_pk_mul_f32 v[230:231], v[230:231], v[60:61] op_sel:[0,1] op_sel_hi:[1,1]
    v_cvt_pk_bf16_f32 v176, v228, v229
    v_cvt_pk_bf16_f32 v177, v230, v231
    v_accvgpr_read_b32 v216, a16
    v_accvgpr_read_b32 v217, a17
    v_accvgpr_read_b32 v218, a18
    v_accvgpr_read_b32 v219, a19
    v_pk_mul_f32 v[216:217], v[216:217], v[58:59] op_sel:[0,0] op_sel_hi:[1,0]
    v_pk_mul_f32 v[218:219], v[218:219], v[58:59] op_sel:[0,0] op_sel_hi:[1,0]
    v_cvt_pk_bf16_f32 v130, v216, v217
    v_cvt_pk_bf16_f32 v131, v218, v219
    s_add_u32 s37, s55, 0
    buffer_store_dwordx4 v[128:131], v252, s[28:31], s37 offen offset:0
    v_accvgpr_read_b32 v220, a20
    v_accvgpr_read_b32 v221, a21
    v_accvgpr_read_b32 v222, a22
    v_accvgpr_read_b32 v223, a23
    v_pk_mul_f32 v[220:221], v[220:221], v[58:59] op_sel:[0,1] op_sel_hi:[1,1]
    v_pk_mul_f32 v[222:223], v[222:223], v[58:59] op_sel:[0,1] op_sel_hi:[1,1]
    v_cvt_pk_bf16_f32 v162, v220, v221
    v_cvt_pk_bf16_f32 v163, v222, v223
    s_add_u32 s37, s55, 8192
    buffer_store_dwordx4 v[160:163], v252, s[28:31], s37 offen offset:0
    v_accvgpr_read_b32 v224, a24
    v_accvgpr_read_b32 v225, a25
    v_accvgpr_read_b32 v226, a26
    v_accvgpr_read_b32 v227, a27
    v_pk_mul_f32 v[224:225], v[224:225], v[60:61] op_sel:[0,0] op_sel_hi:[1,0]
    v_pk_mul_f32 v[226:227], v[226:227], v[60:61] op_sel:[0,0] op_sel_hi:[1,0]
    v_cvt_pk_bf16_f32 v146, v224, v225
    v_cvt_pk_bf16_f32 v147, v226, v227
    s_add_u32 s37, s55, 4096
    buffer_store_dwordx4 v[144:147], v252, s[28:31], s37 offen offset:0
    v_accvgpr_read_b32 v228, a28
    v_accvgpr_read_b32 v229, a29
    v_accvgpr_read_b32 v230, a30
    v_accvgpr_read_b32 v231, a31
    v_pk_mul_f32 v[228:229], v[228:229], v[60:61] op_sel:[0,1] op_sel_hi:[1,1]
    v_pk_mul_f32 v[230:231], v[230:231], v[60:61] op_sel:[0,1] op_sel_hi:[1,1]
    v_cvt_pk_bf16_f32 v178, v228, v229
    v_cvt_pk_bf16_f32 v179, v230, v231
    s_add_u32 s37, s55, 12288
    buffer_store_dwordx4 v[176:179], v252, s[28:31], s37 offen offset:0
    v_accvgpr_read_b32 v216, a32
    v_accvgpr_read_b32 v217, a33
    v_accvgpr_read_b32 v218, a34
    v_accvgpr_read_b32 v219, a35
    v_pk_mul_f32 v[216:217], v[216:217], v[58:59] op_sel:[0,0] op_sel_hi:[1,0]
    v_pk_mul_f32 v[218:219], v[218:219], v[58:59] op_sel:[0,0] op_sel_hi:[1,0]
    v_cvt_pk_bf16_f32 v132, v216, v217
    v_cvt_pk_bf16_f32 v133, v218, v219
    v_accvgpr_read_b32 v220, a36
    v_accvgpr_read_b32 v221, a37
    v_accvgpr_read_b32 v222, a38
    v_accvgpr_read_b32 v223, a39
    v_pk_mul_f32 v[220:221], v[220:221], v[58:59] op_sel:[0,1] op_sel_hi:[1,1]
    v_pk_mul_f32 v[222:223], v[222:223], v[58:59] op_sel:[0,1] op_sel_hi:[1,1]
    v_cvt_pk_bf16_f32 v164, v220, v221
    v_cvt_pk_bf16_f32 v165, v222, v223
    v_accvgpr_read_b32 v224, a40
    v_accvgpr_read_b32 v225, a41
    v_accvgpr_read_b32 v226, a42
    v_accvgpr_read_b32 v227, a43
    v_pk_mul_f32 v[224:225], v[224:225], v[60:61] op_sel:[0,0] op_sel_hi:[1,0]
    v_pk_mul_f32 v[226:227], v[226:227], v[60:61] op_sel:[0,0] op_sel_hi:[1,0]
    v_cvt_pk_bf16_f32 v148, v224, v225
    v_cvt_pk_bf16_f32 v149, v226, v227
    v_accvgpr_read_b32 v228, a44
    v_accvgpr_read_b32 v229, a45
    v_accvgpr_read_b32 v230, a46
    v_accvgpr_read_b32 v231, a47
    v_pk_mul_f32 v[228:229], v[228:229], v[60:61] op_sel:[0,1] op_sel_hi:[1,1]
    v_pk_mul_f32 v[230:231], v[230:231], v[60:61] op_sel:[0,1] op_sel_hi:[1,1]
    v_cvt_pk_bf16_f32 v180, v228, v229
    v_cvt_pk_bf16_f32 v181, v230, v231
    v_accvgpr_read_b32 v216, a48
    v_accvgpr_read_b32 v217, a49
    v_accvgpr_read_b32 v218, a50
    v_accvgpr_read_b32 v219, a51
    v_pk_mul_f32 v[216:217], v[216:217], v[58:59] op_sel:[0,0] op_sel_hi:[1,0]
    v_pk_mul_f32 v[218:219], v[218:219], v[58:59] op_sel:[0,0] op_sel_hi:[1,0]
    v_cvt_pk_bf16_f32 v134, v216, v217
    v_cvt_pk_bf16_f32 v135, v218, v219
    s_add_u32 s37, s55, 0
    buffer_store_dwordx4 v[132:135], v252, s[28:31], s37 offen offset:1024
    v_accvgpr_read_b32 v220, a52
    v_accvgpr_read_b32 v221, a53
    v_accvgpr_read_b32 v222, a54
    v_accvgpr_read_b32 v223, a55
    v_pk_mul_f32 v[220:221], v[220:221], v[58:59] op_sel:[0,1] op_sel_hi:[1,1]
    v_pk_mul_f32 v[222:223], v[222:223], v[58:59] op_sel:[0,1] op_sel_hi:[1,1]
    v_cvt_pk_bf16_f32 v166, v220, v221
    v_cvt_pk_bf16_f32 v167, v222, v223
    s_add_u32 s37, s55, 8192
    buffer_store_dwordx4 v[164:167], v252, s[28:31], s37 offen offset:1024
    v_accvgpr_read_b32 v224, a56
    v_accvgpr_read_b32 v225, a57
    v_accvgpr_read_b32 v226, a58
    v_accvgpr_read_b32 v227, a59
    v_pk_mul_f32 v[224:225], v[224:225], v[60:61] op_sel:[0,0] op_sel_hi:[1,0]
    v_pk_mul_f32 v[226:227], v[226:227], v[60:61] op_sel:[0,0] op_sel_hi:[1,0]
    v_cvt_pk_bf16_f32 v150, v224, v225
    v_cvt_pk_bf16_f32 v151, v226, v227
    s_add_u32 s37, s55, 4096
    buffer_store_dwordx4 v[148:151], v252, s[28:31], s37 offen offset:1024
    v_accvgpr_read_b32 v228, a60
    v_accvgpr_read_b32 v229, a61
    v_accvgpr_read_b32 v230, a62
    v_accvgpr_read_b32 v231, a63
    v_pk_mul_f32 v[228:229], v[228:229], v[60:61] op_sel:[0,1] op_sel_hi:[1,1]
    v_pk_mul_f32 v[230:231], v[230:231], v[60:61] op_sel:[0,1] op_sel_hi:[1,1]
    v_cvt_pk_bf16_f32 v182, v228, v229
    v_cvt_pk_bf16_f32 v183, v230, v231
    s_add_u32 s37, s55, 12288
    buffer_store_dwordx4 v[180:183], v252, s[28:31], s37 offen offset:1024
    v_accvgpr_read_b32 v216, a64
    v_accvgpr_read_b32 v217, a65
    v_accvgpr_read_b32 v218, a66
    v_accvgpr_read_b32 v219, a67
    v_pk_mul_f32 v[216:217], v[216:217], v[58:59] op_sel:[0,0] op_sel_hi:[1,0]
    v_pk_mul_f32 v[218:219], v[218:219], v[58:59] op_sel:[0,0] op_sel_hi:[1,0]
    v_cvt_pk_bf16_f32 v136, v216, v217
    v_cvt_pk_bf16_f32 v137, v218, v219
    v_accvgpr_read_b32 v220, a68
    v_accvgpr_read_b32 v221, a69
    v_accvgpr_read_b32 v222, a70
    v_accvgpr_read_b32 v223, a71
    v_pk_mul_f32 v[220:221], v[220:221], v[58:59] op_sel:[0,1] op_sel_hi:[1,1]
    v_pk_mul_f32 v[222:223], v[222:223], v[58:59] op_sel:[0,1] op_sel_hi:[1,1]
    v_cvt_pk_bf16_f32 v168, v220, v221
    v_cvt_pk_bf16_f32 v169, v222, v223
    v_accvgpr_read_b32 v224, a72
    v_accvgpr_read_b32 v225, a73
    v_accvgpr_read_b32 v226, a74
    v_accvgpr_read_b32 v227, a75
    v_pk_mul_f32 v[224:225], v[224:225], v[60:61] op_sel:[0,0] op_sel_hi:[1,0]
    v_pk_mul_f32 v[226:227], v[226:227], v[60:61] op_sel:[0,0] op_sel_hi:[1,0]
    v_cvt_pk_bf16_f32 v152, v224, v225
    v_cvt_pk_bf16_f32 v153, v226, v227
    v_accvgpr_read_b32 v228, a76
    v_accvgpr_read_b32 v229, a77
    v_accvgpr_read_b32 v230, a78
    v_accvgpr_read_b32 v231, a79
    v_pk_mul_f32 v[228:229], v[228:229], v[60:61] op_sel:[0,1] op_sel_hi:[1,1]
    v_pk_mul_f32 v[230:231], v[230:231], v[60:61] op_sel:[0,1] op_sel_hi:[1,1]
    v_cvt_pk_bf16_f32 v184, v228, v229
    v_cvt_pk_bf16_f32 v185, v230, v231
    v_accvgpr_read_b32 v216, a80
    v_accvgpr_read_b32 v217, a81
    v_accvgpr_read_b32 v218, a82
    v_accvgpr_read_b32 v219, a83
    v_pk_mul_f32 v[216:217], v[216:217], v[58:59] op_sel:[0,0] op_sel_hi:[1,0]
    v_pk_mul_f32 v[218:219], v[218:219], v[58:59] op_sel:[0,0] op_sel_hi:[1,0]
    v_cvt_pk_bf16_f32 v138, v216, v217
    v_cvt_pk_bf16_f32 v139, v218, v219
    s_add_u32 s37, s55, 0
    buffer_store_dwordx4 v[136:139], v252, s[28:31], s37 offen offset:2048
    v_accvgpr_read_b32 v220, a84
    v_accvgpr_read_b32 v221, a85
    v_accvgpr_read_b32 v222, a86
    v_accvgpr_read_b32 v223, a87
    v_pk_mul_f32 v[220:221], v[220:221], v[58:59] op_sel:[0,1] op_sel_hi:[1,1]
    v_pk_mul_f32 v[222:223], v[222:223], v[58:59] op_sel:[0,1] op_sel_hi:[1,1]
    v_cvt_pk_bf16_f32 v170, v220, v221
    v_cvt_pk_bf16_f32 v171, v222, v223
    s_add_u32 s37, s55, 8192
    buffer_store_dwordx4 v[168:171], v252, s[28:31], s37 offen offset:2048
    v_accvgpr_read_b32 v224, a88
    v_accvgpr_read_b32 v225, a89
    v_accvgpr_read_b32 v226, a90
    v_accvgpr_read_b32 v227, a91
    v_pk_mul_f32 v[224:225], v[224:225], v[60:61] op_sel:[0,0] op_sel_hi:[1,0]
    v_pk_mul_f32 v[226:227], v[226:227], v[60:61] op_sel:[0,0] op_sel_hi:[1,0]
    v_cvt_pk_bf16_f32 v154, v224, v225
    v_cvt_pk_bf16_f32 v155, v226, v227
    s_add_u32 s37, s55, 4096
    buffer_store_dwordx4 v[152:155], v252, s[28:31], s37 offen offset:2048
    v_accvgpr_read_b32 v228, a92
    v_accvgpr_read_b32 v229, a93
    v_accvgpr_read_b32 v230, a94
    v_accvgpr_read_b32 v231, a95
    v_pk_mul_f32 v[228:229], v[228:229], v[60:61] op_sel:[0,1] op_sel_hi:[1,1]
    v_pk_mul_f32 v[230:231], v[230:231], v[60:61] op_sel:[0,1] op_sel_hi:[1,1]
    v_cvt_pk_bf16_f32 v186, v228, v229
    v_cvt_pk_bf16_f32 v187, v230, v231
    s_add_u32 s37, s55, 12288
    buffer_store_dwordx4 v[184:187], v252, s[28:31], s37 offen offset:2048
    v_accvgpr_read_b32 v216, a96
    v_accvgpr_read_b32 v217, a97
    v_accvgpr_read_b32 v218, a98
    v_accvgpr_read_b32 v219, a99
    v_pk_mul_f32 v[216:217], v[216:217], v[58:59] op_sel:[0,0] op_sel_hi:[1,0]
    v_pk_mul_f32 v[218:219], v[218:219], v[58:59] op_sel:[0,0] op_sel_hi:[1,0]
    v_cvt_pk_bf16_f32 v140, v216, v217
    v_cvt_pk_bf16_f32 v141, v218, v219
    v_accvgpr_read_b32 v220, a100
    v_accvgpr_read_b32 v221, a101
    v_accvgpr_read_b32 v222, a102
    v_accvgpr_read_b32 v223, a103
    v_pk_mul_f32 v[220:221], v[220:221], v[58:59] op_sel:[0,1] op_sel_hi:[1,1]
    v_pk_mul_f32 v[222:223], v[222:223], v[58:59] op_sel:[0,1] op_sel_hi:[1,1]
    v_cvt_pk_bf16_f32 v172, v220, v221
    v_cvt_pk_bf16_f32 v173, v222, v223
    v_accvgpr_read_b32 v224, a104
    v_accvgpr_read_b32 v225, a105
    v_accvgpr_read_b32 v226, a106
    v_accvgpr_read_b32 v227, a107
    v_pk_mul_f32 v[224:225], v[224:225], v[60:61] op_sel:[0,0] op_sel_hi:[1,0]
    v_pk_mul_f32 v[226:227], v[226:227], v[60:61] op_sel:[0,0] op_sel_hi:[1,0]
    v_cvt_pk_bf16_f32 v156, v224, v225
    v_cvt_pk_bf16_f32 v157, v226, v227
    v_accvgpr_read_b32 v228, a108
    v_accvgpr_read_b32 v229, a109
    v_accvgpr_read_b32 v230, a110
    v_accvgpr_read_b32 v231, a111
    v_pk_mul_f32 v[228:229], v[228:229], v[60:61] op_sel:[0,1] op_sel_hi:[1,1]
    v_pk_mul_f32 v[230:231], v[230:231], v[60:61] op_sel:[0,1] op_sel_hi:[1,1]
    v_cvt_pk_bf16_f32 v188, v228, v229
    v_cvt_pk_bf16_f32 v189, v230, v231
    v_accvgpr_read_b32 v216, a112
    v_accvgpr_read_b32 v217, a113
    v_accvgpr_read_b32 v218, a114
    v_accvgpr_read_b32 v219, a115
    v_pk_mul_f32 v[216:217], v[216:217], v[58:59] op_sel:[0,0] op_sel_hi:[1,0]
    v_pk_mul_f32 v[218:219], v[218:219], v[58:59] op_sel:[0,0] op_sel_hi:[1,0]
    v_cvt_pk_bf16_f32 v142, v216, v217
    v_cvt_pk_bf16_f32 v143, v218, v219
    s_add_u32 s37, s55, 0
    buffer_store_dwordx4 v[140:143], v252, s[28:31], s37 offen offset:3072
    v_accvgpr_read_b32 v220, a116
    v_accvgpr_read_b32 v221, a117
    v_accvgpr_read_b32 v222, a118
    v_accvgpr_read_b32 v223, a119
    v_pk_mul_f32 v[220:221], v[220:221], v[58:59] op_sel:[0,1] op_sel_hi:[1,1]
    v_pk_mul_f32 v[222:223], v[222:223], v[58:59] op_sel:[0,1] op_sel_hi:[1,1]
    v_cvt_pk_bf16_f32 v174, v220, v221
    v_cvt_pk_bf16_f32 v175, v222, v223
    s_add_u32 s37, s55, 8192
    buffer_store_dwordx4 v[172:175], v252, s[28:31], s37 offen offset:3072
    v_accvgpr_read_b32 v224, a120
    v_accvgpr_read_b32 v225, a121
    v_accvgpr_read_b32 v226, a122
    v_accvgpr_read_b32 v227, a123
    v_pk_mul_f32 v[224:225], v[224:225], v[60:61] op_sel:[0,0] op_sel_hi:[1,0]
    v_pk_mul_f32 v[226:227], v[226:227], v[60:61] op_sel:[0,0] op_sel_hi:[1,0]
    v_cvt_pk_bf16_f32 v158, v224, v225
Ltour8:
    s_cbranch_execz Ltour12
    v_cvt_pk_bf16_f32 v159, v226, v227
    s_add_u32 s37, s55, 4096
    buffer_store_dwordx4 v[156:159], v252, s[28:31], s37 offen offset:3072
    v_accvgpr_read_b32 v228, a124
    v_accvgpr_read_b32 v229, a125
    v_accvgpr_read_b32 v230, a126
    v_accvgpr_read_b32 v231, a127
    v_pk_mul_f32 v[228:229], v[228:229], v[60:61] op_sel:[0,1] op_sel_hi:[1,1]
    v_pk_mul_f32 v[230:231], v[230:231], v[60:61] op_sel:[0,1] op_sel_hi:[1,1]
    v_cvt_pk_bf16_f32 v190, v228, v229
    v_cvt_pk_bf16_f32 v191, v230, v231
    s_add_u32 s37, s55, 12288
    buffer_store_dwordx4 v[188:191], v252, s[28:31], s37 offen offset:3072
    s_waitcnt lgkmcnt(14)
    v_mfma_f32_16x16x32_bf16 v[96:99], a[208:211], v[128:131], 0
    s_waitcnt lgkmcnt(12)
    ds_read_b64_tr_b16 a[160:161], v13 offset:0
    v_mfma_f32_16x16x32_bf16 v[96:99], a[212:215], v[132:135], v[96:99]
    s_waitcnt lgkmcnt(11)
    ds_read_b64_tr_b16 a[162:163], v13 offset:4096
    v_mfma_f32_16x16x32_bf16 v[96:99], a[216:219], v[136:139], v[96:99]
    s_waitcnt lgkmcnt(10)
    ds_read_b64_tr_b16 a[164:165], v13 offset:8192
    v_mfma_f32_16x16x32_bf16 v[96:99], a[220:223], v[140:143], v[96:99]
    s_waitcnt lgkmcnt(9)
    ds_read_b64_tr_b16 a[166:167], v13 offset:12288
    v_mfma_f32_16x16x32_bf16 v[96:99], a[224:227], v[144:147], v[96:99]
    s_waitcnt lgkmcnt(8)
    ds_read_b64_tr_b16 a[168:169], v13 offset:16384
    v_mfma_f32_16x16x32_bf16 v[96:99], a[228:231], v[148:151], v[96:99]
    s_waitcnt lgkmcnt(7)
    ds_read_b64_tr_b16 a[170:171], v13 offset:20480
    v_mfma_f32_16x16x32_bf16 v[96:99], a[232:235], v[152:155], v[96:99]
    s_waitcnt lgkmcnt(6)
    ds_read_b64_tr_b16 a[172:173], v13 offset:24576
    v_mfma_f32_16x16x32_bf16 v[96:99], a[236:239], v[156:159], v[96:99]
    ds_read_b64_tr_b16 a[174:175], v13 offset:28672
    v_mfma_f32_16x16x32_bf16 v[100:103], a[208:211], v[160:163], 0
    ds_read_b64_tr_b16 a[176:177], v17 offset:0
    v_mfma_f32_16x16x32_bf16 v[100:103], a[212:215], v[164:167], v[100:103]
    ds_read_b64_tr_b16 a[178:179], v17 offset:4096
    v_mfma_f32_16x16x32_bf16 v[100:103], a[216:219], v[168:171], v[100:103]
    ds_read_b64_tr_b16 a[180:181], v17 offset:8192
    v_mfma_f32_16x16x32_bf16 v[100:103], a[220:223], v[172:175], v[100:103]
    ds_read_b64_tr_b16 a[182:183], v17 offset:12288
    v_mfma_f32_16x16x32_bf16 v[100:103], a[224:227], v[176:179], v[100:103]
    ds_read_b64_tr_b16 a[184:185], v17 offset:16384
    v_cvt_pk_bf16_f32 v224, v96, v97
    v_mfma_f32_16x16x32_bf16 v[100:103], a[228:231], v[180:183], v[100:103]
    ds_read_b64_tr_b16 a[186:187], v17 offset:20480
    v_cvt_pk_bf16_f32 v225, v98, v99
    v_mfma_f32_16x16x32_bf16 v[100:103], a[232:235], v[184:187], v[100:103]
    ds_read_b64_tr_b16 a[188:189], v17 offset:24576
    v_mfma_f32_16x16x32_bf16 v[100:103], a[236:239], v[188:191], v[100:103]
    s_waitcnt lgkmcnt(13)
    ds_read_b64_tr_b16 a[190:191], v17 offset:28672
    v_mfma_f32_16x16x32_bf16 v[104:107], a[160:163], v[128:131], 0
    s_waitcnt lgkmcnt(12)
    ds_read_b64_tr_b16 a[208:209], v14 offset:0
    v_mfma_f32_16x16x32_bf16 v[104:107], a[164:167], v[132:135], v[104:107]
    s_waitcnt lgkmcnt(11)
    ds_read_b64_tr_b16 a[210:211], v14 offset:4096
    v_mfma_f32_16x16x32_bf16 v[104:107], a[168:171], v[136:139], v[104:107]
    s_waitcnt lgkmcnt(10)
    ds_read_b64_tr_b16 a[212:213], v14 offset:8192
    v_mfma_f32_16x16x32_bf16 v[104:107], a[172:175], v[140:143], v[104:107]
    s_waitcnt lgkmcnt(9)
    ds_read_b64_tr_b16 a[214:215], v14 offset:12288
    v_mfma_f32_16x16x32_bf16 v[104:107], a[176:179], v[144:147], v[104:107]
    s_waitcnt lgkmcnt(8)
    ds_read_b64_tr_b16 a[216:217], v14 offset:16384
    v_cvt_pk_bf16_f32 v228, v100, v101
    v_mfma_f32_16x16x32_bf16 v[104:107], a[180:183], v[148:151], v[104:107]
    s_waitcnt lgkmcnt(7)
    ds_read_b64_tr_b16 a[218:219], v14 offset:20480
    v_cvt_pk_bf16_f32 v229, v102, v103
    v_mfma_f32_16x16x32_bf16 v[104:107], a[184:187], v[152:155], v[104:107]
    s_waitcnt lgkmcnt(6)
    ds_read_b64_tr_b16 a[220:221], v14 offset:24576
    v_mfma_f32_16x16x32_bf16 v[104:107], a[188:191], v[156:159], v[104:107]
    ds_read_b64_tr_b16 a[222:223], v14 offset:28672
    s_waitcnt vmcnt(0)
    s_cmp_eq_u32 s53, 0
    s_cbranch_scc1 Lattn_wb
Lattn_wbdone:
    v_mfma_f32_16x16x32_bf16 v[108:111], a[160:163], v[160:163], 0
    buffer_store_dword v10, v8, s[24:27], s92 offen offset:8 sc1
    v_mfma_f32_16x16x32_bf16 v[108:111], a[164:167], v[164:167], v[108:111]
    s_xor_b32 s55, s55, 65536
    ds_read_b64_tr_b16 a[224:225], v18 offset:0
    ds_read_b64_tr_b16 a[226:227], v18 offset:4096
    v_mfma_f32_16x16x32_bf16 v[108:111], a[168:171], v[168:171], v[108:111]
    ds_read_b64_tr_b16 a[228:229], v18 offset:8192
    v_mfma_f32_16x16x32_bf16 v[108:111], a[172:175], v[172:175], v[108:111]
    ds_read_b64_tr_b16 a[230:231], v18 offset:12288
    s_load_dwordx2 s[12:13], s[0:1], 0
    v_mfma_f32_16x16x32_bf16 v[108:111], a[176:179], v[176:179], v[108:111]
    ds_read_b64_tr_b16 a[232:233], v18 offset:16384
    v_cvt_pk_bf16_f32 v226, v104, v105
    v_mfma_f32_16x16x32_bf16 v[108:111], a[180:183], v[180:183], v[108:111]
    s_add_u32 s38, s56, 16384
    ds_read_b64_tr_b16 a[234:235], v18 offset:20480
    v_cvt_pk_bf16_f32 v227, v106, v107
    s_load_dwordx2 s[16:17], s[0:1], 96
    v_mfma_f32_16x16x32_bf16 v[108:111], a[184:187], v[184:187], v[108:111]
    buffer_store_dwordx4 v[224:227], v56, s[28:31], s38 offen sc1
    v_mfma_f32_16x16x32_bf16 v[108:111], a[188:191], v[188:191], v[108:111]
    s_waitcnt lgkmcnt(12)
    ds_read_b64_tr_b16 a[236:237], v18 offset:24576
    ds_read_b64_tr_b16 a[238:239], v18 offset:28672
    s_load_dwordx2 s[52:53], s[0:1], 48
    v_mfma_f32_16x16x32_bf16 v[112:115], a[208:211], v[128:131], 0
    s_waitcnt lgkmcnt(12)
    ds_read_b64_tr_b16 a[160:161], v15 offset:0
    v_mfma_f32_16x16x32_bf16 v[112:115], a[212:215], v[132:135], v[112:115]
    s_waitcnt lgkmcnt(11)
    ds_read_b64_tr_b16 a[162:163], v15 offset:4096
    v_mfma_f32_16x16x32_bf16 v[112:115], a[216:219], v[136:139], v[112:115]
    s_waitcnt lgkmcnt(10)
    ds_read_b64_tr_b16 a[164:165], v15 offset:8192
    v_mfma_f32_16x16x32_bf16 v[112:115], a[220:223], v[140:143], v[112:115]
    s_waitcnt lgkmcnt(9)
    ds_read_b64_tr_b16 a[166:167], v15 offset:12288
    v_mfma_f32_16x16x32_bf16 v[112:115], a[224:227], v[144:147], v[112:115]
    s_waitcnt lgkmcnt(8)
    ds_read_b64_tr_b16 a[168:169], v15 offset:16384
    v_cvt_pk_bf16_f32 v230, v108, v109
    v_mfma_f32_16x16x32_bf16 v[112:115], a[228:231], v[148:151], v[112:115]
    s_waitcnt lgkmcnt(7)
    s_add_u32 s38, s56, 180224
    ds_read_b64_tr_b16 a[170:171], v15 offset:20480
    v_cvt_pk_bf16_f32 v231, v110, v111
    v_mfma_f32_16x16x32_bf16 v[112:115], a[232:235], v[152:155], v[112:115]
    s_waitcnt lgkmcnt(6)
    buffer_store_dwordx4 v[228:231], v56, s[28:31], s38 offen sc1
    v_mfma_f32_16x16x32_bf16 v[112:115], a[236:239], v[156:159], v[112:115]
    ds_read_b64_tr_b16 a[172:173], v15 offset:24576
    ds_read_b64_tr_b16 a[174:175], v15 offset:28672
    v_mfma_f32_16x16x32_bf16 v[116:119], a[208:211], v[160:163], 0
    ds_read_b64_tr_b16 a[176:177], v19 offset:0
    v_mfma_f32_16x16x32_bf16 v[116:119], a[212:215], v[164:167], v[116:119]
    ds_read_b64_tr_b16 a[178:179], v19 offset:4096
    v_mfma_f32_16x16x32_bf16 v[116:119], a[216:219], v[168:171], v[116:119]
    ds_read_b64_tr_b16 a[180:181], v19 offset:8192
    v_mfma_f32_16x16x32_bf16 v[116:119], a[220:223], v[172:175], v[116:119]
    ds_read_b64_tr_b16 a[182:183], v19 offset:12288
    v_mfma_f32_16x16x32_bf16 v[116:119], a[224:227], v[176:179], v[116:119]
    ds_read_b64_tr_b16 a[184:185], v19 offset:16384
    v_cvt_pk_bf16_f32 v232, v112, v113
    v_mfma_f32_16x16x32_bf16 v[116:119], a[228:231], v[180:183], v[116:119]
    ds_read_b64_tr_b16 a[186:187], v19 offset:20480
    v_cvt_pk_bf16_f32 v233, v114, v115
    v_mfma_f32_16x16x32_bf16 v[116:119], a[232:235], v[184:187], v[116:119]
    ds_read_b64_tr_b16 a[188:189], v19 offset:24576
    v_mfma_f32_16x16x32_bf16 v[116:119], a[236:239], v[188:191], v[116:119]
    s_waitcnt lgkmcnt(13)
    ds_read_b64_tr_b16 a[190:191], v19 offset:28672
    s_barrier
    v_mfma_f32_16x16x32_bf16 v[120:123], a[160:163], v[128:131], 0
    s_waitcnt lgkmcnt(12)
    buffer_load_dword v11, v8, s[24:27], s54 offen offset:8 sc1
    v_mfma_f32_16x16x32_bf16 v[120:123], a[164:167], v[132:135], v[120:123]
    s_waitcnt lgkmcnt(10)
    ds_read_b64_tr_b16 a[208:209], v20 offset:0
    ds_read_b64_tr_b16 a[210:211], v20 offset:4096
    v_mfma_f32_16x16x32_bf16 v[120:123], a[168:171], v[136:139], v[120:123]
    s_waitcnt lgkmcnt(10)
    ds_read_b64_tr_b16 a[212:213], v20 offset:8192
    v_mfma_f32_16x16x32_bf16 v[120:123], a[172:175], v[140:143], v[120:123]
    s_waitcnt lgkmcnt(9)
    ds_read_b64_tr_b16 a[214:215], v20 offset:12288
    v_mfma_f32_16x16x32_bf16 v[120:123], a[176:179], v[144:147], v[120:123]
    s_waitcnt lgkmcnt(8)
    ds_read_b64_tr_b16 a[216:217], v20 offset:16384
    v_cvt_pk_bf16_f32 v236, v116, v117
    v_mfma_f32_16x16x32_bf16 v[120:123], a[180:183], v[148:151], v[120:123]
    s_waitcnt lgkmcnt(7)
    ds_read_b64_tr_b16 a[218:219], v20 offset:20480
    v_cvt_pk_bf16_f32 v237, v118, v119
    v_mfma_f32_16x16x32_bf16 v[120:123], a[184:187], v[152:155], v[120:123]
    s_waitcnt lgkmcnt(6)
    s_add_u32 s49, s46, 73728
    ds_read_b64_tr_b16 a[220:221], v20 offset:24576
    v_mfma_f32_16x16x32_bf16 v[120:123], a[188:191], v[156:159], v[120:123]
    s_add_u32 m0, s42, 114688
    ds_read_b64_tr_b16 a[222:223], v20 offset:28672
    v_mfma_f32_16x16x32_bf16 v[124:127], a[160:163], v[160:163], 0
    buffer_load_dwordx4 v46, s[20:23], s49 offen lds
    v_mfma_f32_16x16x32_bf16 v[124:127], a[164:167], v[164:167], v[124:127]
    ds_read_b64_tr_b16 a[224:225], v24 offset:0
    ds_read_b64_tr_b16 a[226:227], v24 offset:4096
    v_mfma_f32_16x16x32_bf16 v[124:127], a[168:171], v[168:171], v[124:127]
    buffer_load_dwordx4 v47, s[20:23], s49 offen offset:1024 lds
    v_mfma_f32_16x16x32_bf16 v[124:127], a[172:175], v[172:175], v[124:127]
    ds_read_b64_tr_b16 a[228:229], v24 offset:8192
    ds_read_b64_tr_b16 a[230:231], v24 offset:12288
    v_mfma_f32_16x16x32_bf16 v[124:127], a[176:179], v[176:179], v[124:127]
    ds_read_b64_tr_b16 a[232:233], v24 offset:16384
    v_cvt_pk_bf16_f32 v234, v120, v121
    v_mfma_f32_16x16x32_bf16 v[124:127], a[180:183], v[180:183], v[124:127]
    s_add_u32 s38, s56, 16512
    ds_read_b64_tr_b16 a[234:235], v24 offset:20480
    v_cvt_pk_bf16_f32 v235, v122, v123
    v_mfma_f32_16x16x32_bf16 v[124:127], a[184:187], v[184:187], v[124:127]
    buffer_store_dwordx4 v[232:235], v56, s[28:31], s38 offen sc1
    v_mfma_f32_16x16x32_bf16 v[124:127], a[188:191], v[188:191], v[124:127]
    s_waitcnt lgkmcnt(12)
    ds_read_b64_tr_b16 a[236:237], v24 offset:24576
    ds_read_b64_tr_b16 a[238:239], v24 offset:28672
    v_mfma_f32_16x16x32_bf16 v[64:67], a[208:211], v[128:131], 0
    s_waitcnt lgkmcnt(12)
    buffer_load_dwordx4 v48, s[20:23], s49 offen offset:2048 lds
    v_mfma_f32_16x16x32_bf16 v[64:67], a[212:215], v[132:135], v[64:67]
    s_waitcnt lgkmcnt(10)
    ds_read_b64_tr_b16 a[160:161], v21 offset:0
    ds_read_b64_tr_b16 a[162:163], v21 offset:4096
    v_mfma_f32_16x16x32_bf16 v[64:67], a[216:219], v[136:139], v[64:67]
    s_waitcnt lgkmcnt(10)
    buffer_load_dwordx4 v49, s[20:23], s49 offen offset:3072 lds
    v_mfma_f32_16x16x32_bf16 v[64:67], a[220:223], v[140:143], v[64:67]
    s_waitcnt lgkmcnt(8)
    ds_read_b64_tr_b16 a[164:165], v21 offset:8192
    ds_read_b64_tr_b16 a[166:167], v21 offset:12288
    v_mfma_f32_16x16x32_bf16 v[64:67], a[224:227], v[144:147], v[64:67]
    s_waitcnt lgkmcnt(8)
    ds_read_b64_tr_b16 a[168:169], v21 offset:16384
    v_cvt_pk_bf16_f32 v238, v124, v125
    v_mfma_f32_16x16x32_bf16 v[64:67], a[228:231], v[148:151], v[64:67]
    s_waitcnt lgkmcnt(7)
    s_add_u32 s38, s56, 180352
    ds_read_b64_tr_b16 a[170:171], v21 offset:20480
    v_cvt_pk_bf16_f32 v239, v126, v127
    v_mfma_f32_16x16x32_bf16 v[64:67], a[232:235], v[152:155], v[64:67]
    s_waitcnt lgkmcnt(6)
    buffer_store_dwordx4 v[236:239], v56, s[28:31], s38 offen sc1
    v_mfma_f32_16x16x32_bf16 v[64:67], a[236:239], v[156:159], v[64:67]
    ds_read_b64_tr_b16 a[172:173], v21 offset:24576
    ds_read_b64_tr_b16 a[174:175], v21 offset:28672
    v_mfma_f32_16x16x32_bf16 v[68:71], a[208:211], v[160:163], 0
    ds_read_b64_tr_b16 a[176:177], v25 offset:0
    v_mfma_f32_16x16x32_bf16 v[68:71], a[212:215], v[164:167], v[68:71]
    ds_read_b64_tr_b16 a[178:179], v25 offset:4096
    v_mfma_f32_16x16x32_bf16 v[68:71], a[216:219], v[168:171], v[68:71]
    ds_read_b64_tr_b16 a[180:181], v25 offset:8192
    v_mfma_f32_16x16x32_bf16 v[68:71], a[220:223], v[172:175], v[68:71]
    ds_read_b64_tr_b16 a[182:183], v25 offset:12288
    v_mfma_f32_16x16x32_bf16 v[68:71], a[224:227], v[176:179], v[68:71]
    ds_read_b64_tr_b16 a[184:185], v25 offset:16384
    v_mfma_f32_16x16x32_bf16 v[68:71], a[228:231], v[180:183], v[68:71]
    ds_read_b64_tr_b16 a[186:187], v25 offset:20480
    v_mfma_f32_16x16x32_bf16 v[68:71], a[232:235], v[184:187], v[68:71]
    ds_read_b64_tr_b16 a[188:189], v25 offset:24576
    v_mfma_f32_16x16x32_bf16 v[68:71], a[236:239], v[188:191], v[68:71]
    s_waitcnt lgkmcnt(13)
    ds_read_b64_tr_b16 a[190:191], v25 offset:28672
    v_mfma_f32_16x16x32_bf16 v[72:75], a[160:163], v[128:131], 0
    s_waitcnt lgkmcnt(12)
    ds_read_b64_tr_b16 a[208:209], v22 offset:0
    v_mfma_f32_16x16x32_bf16 v[72:75], a[164:167], v[132:135], v[72:75]
    s_waitcnt lgkmcnt(11)
    ds_read_b64_tr_b16 a[210:211], v22 offset:4096
    v_mfma_f32_16x16x32_bf16 v[72:75], a[168:171], v[136:139], v[72:75]
    s_waitcnt lgkmcnt(10)
    ds_read_b64_tr_b16 a[212:213], v22 offset:8192
    v_mfma_f32_16x16x32_bf16 v[72:75], a[172:175], v[140:143], v[72:75]
    s_waitcnt lgkmcnt(9)
    ds_read_b64_tr_b16 a[214:215], v22 offset:12288
    v_mfma_f32_16x16x32_bf16 v[72:75], a[176:179], v[144:147], v[72:75]
    s_waitcnt lgkmcnt(8)
    ds_read_b64_tr_b16 a[216:217], v22 offset:16384
    v_mfma_f32_16x16x32_bf16 v[72:75], a[180:183], v[148:151], v[72:75]
    s_waitcnt lgkmcnt(7)
    ds_read_b64_tr_b16 a[218:219], v22 offset:20480
    v_mfma_f32_16x16x32_bf16 v[72:75], a[184:187], v[152:155], v[72:75]
    s_waitcnt lgkmcnt(6)
    ds_read_b64_tr_b16 a[220:221], v22 offset:24576
    v_mfma_f32_16x16x32_bf16 v[72:75], a[188:191], v[156:159], v[72:75]
    ds_read_b64_tr_b16 a[222:223], v22 offset:28672
    v_mfma_f32_16x16x32_bf16 v[76:79], a[160:163], v[160:163], 0
    ds_read_b64_tr_b16 a[224:225], v26 offset:0
    v_mfma_f32_16x16x32_bf16 v[76:79], a[164:167], v[164:167], v[76:79]
    ds_read_b64_tr_b16 a[226:227], v26 offset:4096
    v_mfma_f32_16x16x32_bf16 v[76:79], a[168:171], v[168:171], v[76:79]
    ds_read_b64_tr_b16 a[228:229], v26 offset:8192
    v_mfma_f32_16x16x32_bf16 v[76:79], a[172:175], v[172:175], v[76:79]
    ds_read_b64_tr_b16 a[230:231], v26 offset:12288
    v_mfma_f32_16x16x32_bf16 v[76:79], a[176:179], v[176:179], v[76:79]
    ds_read_b64_tr_b16 a[232:233], v26 offset:16384
    v_mfma_f32_16x16x32_bf16 v[76:79], a[180:183], v[180:183], v[76:79]
    ds_read_b64_tr_b16 a[234:235], v26 offset:20480
    v_mfma_f32_16x16x32_bf16 v[76:79], a[184:187], v[184:187], v[76:79]
    ds_read_b64_tr_b16 a[236:237], v26 offset:24576
    v_mfma_f32_16x16x32_bf16 v[76:79], a[188:191], v[188:191], v[76:79]
    s_waitcnt lgkmcnt(13)
    ds_read_b64_tr_b16 a[238:239], v26 offset:28672
    v_mfma_f32_16x16x32_bf16 v[80:83], a[208:211], v[128:131], 0
    s_waitcnt lgkmcnt(12)
    ds_read_b64_tr_b16 a[160:161], v23 offset:0
    v_mfma_f32_16x16x32_bf16 v[80:83], a[212:215], v[132:135], v[80:83]
    s_waitcnt lgkmcnt(11)
    ds_read_b64_tr_b16 a[162:163], v23 offset:4096
    v_mfma_f32_16x16x32_bf16 v[80:83], a[216:219], v[136:139], v[80:83]
    s_waitcnt lgkmcnt(10)
    ds_read_b64_tr_b16 a[164:165], v23 offset:8192
    s_waitcnt vmcnt(6)
    v_readfirstlane_b32 s36, v11
    v_mfma_f32_16x16x32_bf16 v[80:83], a[220:223], v[140:143], v[80:83]
    s_waitcnt lgkmcnt(9)
    ds_read_b64_tr_b16 a[166:167], v23 offset:12288
    v_mfma_f32_16x16x32_bf16 v[80:83], a[224:227], v[144:147], v[80:83]
    ds_read_b64_tr_b16 a[168:169], v23 offset:16384
    s_cmp_lg_u32 s36, s95
    s_cbranch_scc1 Lattn_xspin
Lattn_xgot:
    s_waitcnt lgkmcnt(9)
    v_mfma_f32_16x16x32_bf16 v[80:83], a[228:231], v[148:151], v[80:83]
    s_waitcnt lgkmcnt(7)
    ds_read_b64_tr_b16 a[170:171], v23 offset:20480
    v_mfma_f32_16x16x32_bf16 v[80:83], a[232:235], v[152:155], v[80:83]
    s_waitcnt lgkmcnt(6)
    ds_read_b64_tr_b16 a[172:173], v23 offset:24576
    v_mfma_f32_16x16x32_bf16 v[80:83], a[236:239], v[156:159], v[80:83]
    s_add_u32 s37, s55, 0
    ds_read_b64_tr_b16 a[174:175], v23 offset:28672
    v_mfma_f32_16x16x32_bf16 v[84:87], a[208:211], v[160:163], 0
    buffer_load_dwordx4 a[64:67], v252, s[28:31], s37 offen offset:0 sc1
    v_mfma_f32_16x16x32_bf16 v[84:87], a[212:215], v[164:167], v[84:87]
    ds_read_b64_tr_b16 a[176:177], v27 offset:0
    ds_read_b64_tr_b16 a[178:179], v27 offset:4096
    v_mfma_f32_16x16x32_bf16 v[84:87], a[216:219], v[168:171], v[84:87]
    buffer_load_dwordx4 a[68:71], v252, s[28:31], s37 offen offset:1024 sc1
    v_mfma_f32_16x16x32_bf16 v[84:87], a[220:223], v[172:175], v[84:87]
    ds_read_b64_tr_b16 a[180:181], v27 offset:8192
    ds_read_b64_tr_b16 a[182:183], v27 offset:12288
    v_mfma_f32_16x16x32_bf16 v[84:87], a[224:227], v[176:179], v[84:87]
    ds_read_b64_tr_b16 a[184:185], v27 offset:16384
    v_mfma_f32_16x16x32_bf16 v[84:87], a[228:231], v[180:183], v[84:87]
    ds_read_b64_tr_b16 a[186:187], v27 offset:20480
    v_mfma_f32_16x16x32_bf16 v[84:87], a[232:235], v[184:187], v[84:87]
    buffer_load_dwordx4 a[72:75], v252, s[28:31], s37 offen offset:2048 sc1
    v_mfma_f32_16x16x32_bf16 v[84:87], a[236:239], v[188:191], v[84:87]
    s_waitcnt lgkmcnt(12)
    ds_read_b64_tr_b16 a[188:189], v27 offset:24576
    ds_read_b64_tr_b16 a[190:191], v27 offset:28672
    s_barrier
    v_mfma_f32_16x16x32_bf16 v[88:91], a[160:163], v[128:131], 0
    s_waitcnt lgkmcnt(12)
    ds_read_b64_tr_b16 a[208:209], v12 offset:32768
    v_mfma_f32_16x16x32_bf16 v[88:91], a[164:167], v[132:135], v[88:91]
    s_waitcnt lgkmcnt(11)
    ds_read_b64_tr_b16 a[210:211], v12 offset:36864
    v_mfma_f32_16x16x32_bf16 v[88:91], a[168:171], v[136:139], v[88:91]
    s_waitcnt lgkmcnt(10)
    buffer_load_dwordx4 a[76:79], v252, s[28:31], s37 offen offset:3072 sc1
    v_mfma_f32_16x16x32_bf16 v[88:91], a[172:175], v[140:143], v[88:91]
    s_waitcnt lgkmcnt(8)
    ds_read_b64_tr_b16 a[212:213], v12 offset:40960
    ds_read_b64_tr_b16 a[214:215], v12 offset:45056
    v_mfma_f32_16x16x32_bf16 v[88:91], a[176:179], v[144:147], v[88:91]
    s_waitcnt lgkmcnt(8)
    ds_read_b64_tr_b16 a[216:217], v12 offset:49152
    v_mfma_f32_16x16x32_bf16 v[88:91], a[180:183], v[148:151], v[88:91]
    s_waitcnt lgkmcnt(7)
    s_add_u32 s37, s55, 4096
    ds_read_b64_tr_b16 a[218:219], v12 offset:53248
    v_mfma_f32_16x16x32_bf16 v[88:91], a[184:187], v[152:155], v[88:91]
    s_waitcnt lgkmcnt(6)
    s_add_u32 s49, s46, 256
    buffer_load_dwordx4 a[80:83], v252, s[28:31], s37 offen offset:0 sc1
    v_mfma_f32_16x16x32_bf16 v[88:91], a[188:191], v[156:159], v[88:91]
    s_add_u32 m0, s42, 0
    ds_read_b64_tr_b16 a[220:221], v12 offset:57344
    ds_read_b64_tr_b16 a[222:223], v12 offset:61440
    v_mfma_f32_16x16x32_bf16 v[92:95], a[160:163], v[160:163], 0
    buffer_load_dwordx4 v46, s[20:23], s49 offen lds
    v_mfma_f32_16x16x32_bf16 v[92:95], a[164:167], v[164:167], v[92:95]
    ds_read_b64_tr_b16 a[224:225], v16 offset:32768
    ds_read_b64_tr_b16 a[226:227], v16 offset:36864
    v_mfma_f32_16x16x32_bf16 v[92:95], a[168:171], v[168:171], v[92:95]
    buffer_load_dwordx4 v47, s[20:23], s49 offen offset:1024 lds
    v_mfma_f32_16x16x32_bf16 v[92:95], a[172:175], v[172:175], v[92:95]
    ds_read_b64_tr_b16 a[228:229], v16 offset:40960
    ds_read_b64_tr_b16 a[230:231], v16 offset:45056
    v_mfma_f32_16x16x32_bf16 v[92:95], a[176:179], v[176:179], v[92:95]
    buffer_load_dwordx4 a[84:87], v252, s[28:31], s37 offen offset:1024 sc1
    v_mfma_f32_16x16x32_bf16 v[92:95], a[180:183], v[180:183], v[92:95]
    ds_read_b64_tr_b16 a[232:233], v16 offset:49152
    ds_read_b64_tr_b16 a[234:235], v16 offset:53248
    v_mfma_f32_16x16x32_bf16 v[92:95], a[184:187], v[184:187], v[92:95]
    ds_read_b64_tr_b16 a[236:237], v16 offset:57344
    v_mfma_f32_16x16x32_bf16 v[92:95], a[188:191], v[188:191], v[92:95]
    s_waitcnt lgkmcnt(13)
    ds_read_b64_tr_b16 a[238:239], v16 offset:61440
    v_mfma_f32_16x16x32_bf16 v[96:99], a[208:211], v[128:131], 0
    s_waitcnt lgkmcnt(12)
    buffer_load_dwordx4 v48, s[20:23], s49 offen offset:2048 lds
    v_mfma_f32_16x16x32_bf16 v[96:99], a[212:215], v[132:135], v[96:99]
    s_waitcnt lgkmcnt(10)
    ds_read_b64_tr_b16 a[160:161], v13 offset:32768
    ds_read_b64_tr_b16 a[162:163], v13 offset:36864
    v_mfma_f32_16x16x32_bf16 v[96:99], a[216:219], v[136:139], v[96:99]
    s_waitcnt lgkmcnt(10)
    buffer_load_dwordx4 v49, s[20:23], s49 offen offset:3072 lds
    v_mfma_f32_16x16x32_bf16 v[96:99], a[220:223], v[140:143], v[96:99]
    s_waitcnt lgkmcnt(8)
    ds_read_b64_tr_b16 a[164:165], v13 offset:40960
    ds_read_b64_tr_b16 a[166:167], v13 offset:45056
    v_mfma_f32_16x16x32_bf16 v[96:99], a[224:227], v[144:147], v[96:99]
    s_waitcnt lgkmcnt(8)
    buffer_load_dwordx4 a[88:91], v252, s[28:31], s37 offen offset:2048 sc1
    v_mfma_f32_16x16x32_bf16 v[96:99], a[228:231], v[148:151], v[96:99]
    s_waitcnt lgkmcnt(6)
    ds_read_b64_tr_b16 a[168:169], v13 offset:49152
    ds_read_b64_tr_b16 a[170:171], v13 offset:53248
    v_mfma_f32_16x16x32_bf16 v[96:99], a[232:235], v[152:155], v[96:99]
    s_waitcnt lgkmcnt(6)
    s_add_u32 s49, s46, 73984
    ds_read_b64_tr_b16 a[172:173], v13 offset:57344
    v_mfma_f32_16x16x32_bf16 v[96:99], a[236:239], v[156:159], v[96:99]
    s_add_u32 m0, s42, 16384
    ds_read_b64_tr_b16 a[174:175], v13 offset:61440
    v_mfma_f32_16x16x32_bf16 v[100:103], a[208:211], v[160:163], 0
    buffer_load_dwordx4 v46, s[20:23], s49 offen lds
    v_mfma_f32_16x16x32_bf16 v[100:103], a[212:215], v[164:167], v[100:103]
    ds_read_b64_tr_b16 a[176:177], v17 offset:32768
    ds_read_b64_tr_b16 a[178:179], v17 offset:36864
    v_mfma_f32_16x16x32_bf16 v[100:103], a[216:219], v[168:171], v[100:103]
    buffer_load_dwordx4 v47, s[20:23], s49 offen offset:1024 lds
    v_mfma_f32_16x16x32_bf16 v[100:103], a[220:223], v[172:175], v[100:103]
    ds_read_b64_tr_b16 a[180:181], v17 offset:40960
    ds_read_b64_tr_b16 a[182:183], v17 offset:45056
    v_mfma_f32_16x16x32_bf16 v[100:103], a[224:227], v[176:179], v[100:103]
    buffer_load_dwordx4 a[92:95], v252, s[28:31], s37 offen offset:3072 sc1
    v_mfma_f32_16x16x32_bf16 v[100:103], a[228:231], v[180:183], v[100:103]
    ds_read_b64_tr_b16 a[184:185], v17 offset:49152
    ds_read_b64_tr_b16 a[186:187], v17 offset:53248
    v_mfma_f32_16x16x32_bf16 v[100:103], a[232:235], v[184:187], v[100:103]
    ds_read_b64_tr_b16 a[188:189], v17 offset:57344
    v_mfma_f32_16x16x32_bf16 v[100:103], a[236:239], v[188:191], v[100:103]
    s_waitcnt lgkmcnt(13)
    ds_read_b64_tr_b16 a[190:191], v17 offset:61440
    v_mfma_f32_16x16x32_bf16 v[104:107], a[160:163], v[128:131], 0
    s_waitcnt lgkmcnt(12)
    buffer_load_dwordx4 v48, s[20:23], s49 offen offset:2048 lds
    v_mfma_f32_16x16x32_bf16 v[104:107], a[164:167], v[132:135], v[104:107]
    s_waitcnt lgkmcnt(10)
    ds_read_b64_tr_b16 a[208:209], v14 offset:32768
    ds_read_b64_tr_b16 a[210:211], v14 offset:36864
    v_mfma_f32_16x16x32_bf16 v[104:107], a[168:171], v[136:139], v[104:107]
    s_waitcnt lgkmcnt(10)
    buffer_load_dwordx4 v49, s[20:23], s49 offen offset:3072 lds
    v_mfma_f32_16x16x32_bf16 v[104:107], a[172:175], v[140:143], v[104:107]
    s_waitcnt lgkmcnt(8)
    s_add_u32 s37, s55, 8192
    ds_read_b64_tr_b16 a[212:213], v14 offset:40960
    ds_read_b64_tr_b16 a[214:215], v14 offset:45056
    v_mfma_f32_16x16x32_bf16 v[104:107], a[176:179], v[144:147], v[104:107]
    s_waitcnt lgkmcnt(8)
    buffer_load_dwordx4 a[96:99], v252, s[28:31], s37 offen offset:0 sc1
    v_mfma_f32_16x16x32_bf16 v[104:107], a[180:183], v[148:151], v[104:107]
    s_waitcnt lgkmcnt(6)
    ds_read_b64_tr_b16 a[216:217], v14 offset:49152
    ds_read_b64_tr_b16 a[218:219], v14 offset:53248
    v_mfma_f32_16x16x32_bf16 v[104:107], a[184:187], v[152:155], v[104:107]
    s_waitcnt lgkmcnt(6)
    buffer_load_dwordx4 a[100:103], v252, s[28:31], s37 offen offset:1024 sc1
    v_mfma_f32_16x16x32_bf16 v[104:107], a[188:191], v[156:159], v[104:107]
    ds_read_b64_tr_b16 a[220:221], v14 offset:57344
    ds_read_b64_tr_b16 a[222:223], v14 offset:61440
    v_mfma_f32_16x16x32_bf16 v[108:111], a[160:163], v[160:163], 0
    ds_read_b64_tr_b16 a[224:225], v18 offset:32768
    v_mfma_f32_16x16x32_bf16 v[108:111], a[164:167], v[164:167], v[108:111]
    ds_read_b64_tr_b16 a[226:227], v18 offset:36864
    v_mfma_f32_16x16x32_bf16 v[108:111], a[168:171], v[168:171], v[108:111]
    buffer_load_dwordx4 a[104:107], v252, s[28:31], s37 offen offset:2048 sc1
    v_mfma_f32_16x16x32_bf16 v[108:111], a[172:175], v[172:175], v[108:111]
    ds_read_b64_tr_b16 a[228:229], v18 offset:40960
    ds_read_b64_tr_b16 a[230:231], v18 offset:45056
    v_mfma_f32_16x16x32_bf16 v[108:111], a[176:179], v[176:179], v[108:111]
    ds_read_b64_tr_b16 a[232:233], v18 offset:49152
    v_mfma_f32_16x16x32_bf16 v[108:111], a[180:183], v[180:183], v[108:111]
    ds_read_b64_tr_b16 a[234:235], v18 offset:53248
    v_mfma_f32_16x16x32_bf16 v[108:111], a[184:187], v[184:187], v[108:111]
    buffer_load_dwordx4 a[108:111], v252, s[28:31], s37 offen offset:3072 sc1
    v_mfma_f32_16x16x32_bf16 v[108:111], a[188:191], v[188:191], v[108:111]
    s_waitcnt lgkmcnt(12)
    ds_read_b64_tr_b16 a[236:237], v18 offset:57344
    ds_read_b64_tr_b16 a[238:239], v18 offset:61440
    v_mfma_f32_16x16x32_bf16 v[112:115], a[208:211], v[128:131], 0
    s_waitcnt lgkmcnt(12)
    ds_read_b64_tr_b16 a[160:161], v15 offset:32768
    v_mfma_f32_16x16x32_bf16 v[112:115], a[212:215], v[132:135], v[112:115]
    s_waitcnt lgkmcnt(11)
    s_add_u32 s37, s55, 12288
    ds_read_b64_tr_b16 a[162:163], v15 offset:36864
    v_mfma_f32_16x16x32_bf16 v[112:115], a[216:219], v[136:139], v[112:115]
    s_waitcnt lgkmcnt(10)
    buffer_load_dwordx4 a[112:115], v252, s[28:31], s37 offen offset:0 sc1
    v_mfma_f32_16x16x32_bf16 v[112:115], a[220:223], v[140:143], v[112:115]
    s_waitcnt lgkmcnt(8)
    ds_read_b64_tr_b16 a[164:165], v15 offset:40960
    ds_read_b64_tr_b16 a[166:167], v15 offset:45056
    v_mfma_f32_16x16x32_bf16 v[112:115], a[224:227], v[144:147], v[112:115]
    s_waitcnt lgkmcnt(8)
    buffer_load_dwordx4 a[116:119], v252, s[28:31], s37 offen offset:1024 sc1
    v_mfma_f32_16x16x32_bf16 v[112:115], a[228:231], v[148:151], v[112:115]
    s_waitcnt lgkmcnt(6)
    ds_read_b64_tr_b16 a[168:169], v15 offset:49152
    ds_read_b64_tr_b16 a[170:171], v15 offset:53248
    v_mfma_f32_16x16x32_bf16 v[112:115], a[232:235], v[152:155], v[112:115]
    s_waitcnt lgkmcnt(6)
    ds_read_b64_tr_b16 a[172:173], v15 offset:57344
    v_mfma_f32_16x16x32_bf16 v[112:115], a[236:239], v[156:159], v[112:115]
    ds_read_b64_tr_b16 a[174:175], v15 offset:61440
    v_mfma_f32_16x16x32_bf16 v[116:119], a[208:211], v[160:163], 0
    buffer_load_dwordx4 a[120:123], v252, s[28:31], s37 offen offset:2048 sc1
    v_mfma_f32_16x16x32_bf16 v[116:119], a[212:215], v[164:167], v[116:119]
    ds_read_b64_tr_b16 a[176:177], v19 offset:32768
    ds_read_b64_tr_b16 a[178:179], v19 offset:36864
    v_mfma_f32_16x16x32_bf16 v[116:119], a[216:219], v[168:171], v[116:119]
    ds_read_b64_tr_b16 a[180:181], v19 offset:40960
    v_mfma_f32_16x16x32_bf16 v[116:119], a[220:223], v[172:175], v[116:119]
    ds_read_b64_tr_b16 a[182:183], v19 offset:45056
    v_mfma_f32_16x16x32_bf16 v[116:119], a[224:227], v[176:179], v[116:119]
    buffer_load_dwordx4 a[124:127], v252, s[28:31], s37 offen offset:3072 sc1
    v_mfma_f32_16x16x32_bf16 v[116:119], a[228:231], v[180:183], v[116:119]
    ds_read_b64_tr_b16 a[184:185], v19 offset:49152
    ds_read_b64_tr_b16 a[186:187], v19 offset:53248
    v_mfma_f32_16x16x32_bf16 v[116:119], a[232:235], v[184:187], v[116:119]
    ds_read_b64_tr_b16 a[188:189], v19 offset:57344
    v_mfma_f32_16x16x32_bf16 v[116:119], a[236:239], v[188:191], v[116:119]
    ds_read_b64_tr_b16 a[190:191], v19 offset:61440
    s_waitcnt vmcnt(25)
    s_waitcnt lgkmcnt(0)
    s_barrier
    v_mfma_f32_16x16x32_bf16 v[120:123], a[160:163], v[128:131], 0
    ds_read_b64_tr_b16 a[208:209], v20 offset:32768
    v_mfma_f32_16x16x32_bf16 v[120:123], a[164:167], v[132:135], v[120:123]
    ds_read_b64_tr_b16 a[210:211], v20 offset:36864
    v_mfma_f32_16x16x32_bf16 v[120:123], a[168:171], v[136:139], v[120:123]
    ds_read_b64_tr_b16 a[212:213], v20 offset:40960
    v_mfma_f32_16x16x32_bf16 v[120:123], a[172:175], v[140:143], v[120:123]
    ds_read_b64_tr_b16 a[214:215], v20 offset:45056
    v_mfma_f32_16x16x32_bf16 v[120:123], a[176:179], v[144:147], v[120:123]
    ds_read_b64_tr_b16 a[216:217], v20 offset:49152
    v_mfma_f32_16x16x32_bf16 v[120:123], a[180:183], v[148:151], v[120:123]
    ds_read_b64_tr_b16 a[218:219], v20 offset:53248
    v_mfma_f32_16x16x32_bf16 v[120:123], a[184:187], v[152:155], v[120:123]
    s_add_u32 s49, s7, 512
    ds_read_b64_tr_b16 a[220:221], v20 offset:57344
    v_mfma_f32_16x16x32_bf16 v[120:123], a[188:191], v[156:159], v[120:123]
    s_add_u32 m0, s42, 65536
    ds_read_b64_tr_b16 a[222:223], v20 offset:61440
    v_mfma_f32_16x16x32_bf16 v[124:127], a[160:163], v[160:163], 0
    buffer_load_dwordx4 v46, s[20:23], s49 offen lds
    v_mfma_f32_16x16x32_bf16 v[124:127], a[164:167], v[164:167], v[124:127]
    ds_read_b64_tr_b16 a[224:225], v24 offset:32768
    ds_read_b64_tr_b16 a[226:227], v24 offset:36864
    v_mfma_f32_16x16x32_bf16 v[124:127], a[168:171], v[168:171], v[124:127]
    buffer_load_dwordx4 v47, s[20:23], s49 offen offset:1024 lds
    v_mfma_f32_16x16x32_bf16 v[124:127], a[172:175], v[172:175], v[124:127]
Ltour9:
    s_cbranch_execz Ltour13
    ds_read_b64_tr_b16 a[228:229], v24 offset:40960
    ds_read_b64_tr_b16 a[230:231], v24 offset:45056
    v_mfma_f32_16x16x32_bf16 v[124:127], a[176:179], v[176:179], v[124:127]
    ds_read_b64_tr_b16 a[232:233], v24 offset:49152
    v_mfma_f32_16x16x32_bf16 v[124:127], a[180:183], v[180:183], v[124:127]
    ds_read_b64_tr_b16 a[234:235], v24 offset:53248
    v_mfma_f32_16x16x32_bf16 v[124:127], a[184:187], v[184:187], v[124:127]
    ds_read_b64_tr_b16 a[236:237], v24 offset:57344
    v_mfma_f32_16x16x32_bf16 v[124:127], a[188:191], v[188:191], v[124:127]
    s_waitcnt vmcnt(25)
    s_waitcnt lgkmcnt(13)
    ds_read_b64_tr_b16 a[238:239], v24 offset:61440
    v_mfma_f32_16x16x32_bf16 v[64:67], a[208:211], a[64:67], v[64:67]
    s_waitcnt vmcnt(24)
    s_waitcnt lgkmcnt(12)
    buffer_load_dwordx4 v48, s[20:23], s49 offen offset:2048 lds
    v_mfma_f32_16x16x32_bf16 v[64:67], a[212:215], a[68:71], v[64:67]
    s_waitcnt vmcnt(24)
    s_waitcnt lgkmcnt(10)
    s_lshl_b32 s40, s5, 4
    ds_read_b64_tr_b16 a[160:161], v21 offset:32768
    ds_read_b64_tr_b16 a[162:163], v21 offset:36864
    v_mfma_f32_16x16x32_bf16 v[64:67], a[216:219], a[72:75], v[64:67]
    s_waitcnt vmcnt(23)
    s_waitcnt lgkmcnt(10)
    buffer_load_dwordx4 v49, s[20:23], s49 offen offset:3072 lds
    v_mfma_f32_16x16x32_bf16 v[64:67], a[220:223], a[76:79], v[64:67]
    s_waitcnt vmcnt(23)
    s_waitcnt lgkmcnt(8)
    s_add_u32 s40, s40, s4
    ds_read_b64_tr_b16 a[164:165], v21 offset:40960
    ds_read_b64_tr_b16 a[166:167], v21 offset:45056
    v_mfma_f32_16x16x32_bf16 v[64:67], a[224:227], a[80:83], v[64:67]
    s_waitcnt vmcnt(20)
    s_waitcnt lgkmcnt(8)
    ds_read_b64_tr_b16 a[168:169], v21 offset:49152
    v_and_b32 v240, 31, v1
    v_mfma_f32_16x16x32_bf16 v[64:67], a[228:231], a[84:87], v[64:67]
    s_waitcnt vmcnt(17)
    s_waitcnt lgkmcnt(7)
    ds_read_b64_tr_b16 a[170:171], v21 offset:53248
    v_lshrrev_b32 v241, 5, v1
    v_mfma_f32_16x16x32_bf16 v[64:67], a[232:235], a[88:91], v[64:67]
    s_waitcnt vmcnt(14)
    s_waitcnt lgkmcnt(6)
    s_add_u32 s49, s7, 74240
    ds_read_b64_tr_b16 a[172:173], v21 offset:57344
    v_cmp_gt_u32 vcc, 8, v240
    v_mfma_f32_16x16x32_bf16 v[64:67], a[236:239], a[92:95], v[64:67]
    s_waitcnt vmcnt(11)
    s_add_u32 m0, s42, 81920
    ds_read_b64_tr_b16 a[174:175], v21 offset:61440
    v_mov_b32 v242, 2147483648
    v_mfma_f32_16x16x32_bf16 v[68:71], a[208:211], a[96:99], v[68:71]
    s_waitcnt vmcnt(10)
    buffer_load_dwordx4 v46, s[20:23], s49 offen lds
    v_mfma_f32_16x16x32_bf16 v[68:71], a[212:215], a[100:103], v[68:71]
    s_waitcnt vmcnt(10)
    s_lshl_b32 s43, s40, 3
    ds_read_b64_tr_b16 a[176:177], v25 offset:32768
    ds_read_b64_tr_b16 a[178:179], v25 offset:36864
    v_mfma_f32_16x16x32_bf16 v[68:71], a[216:219], a[104:107], v[68:71]
    s_waitcnt vmcnt(9)
    buffer_load_dwordx4 v47, s[20:23], s49 offen offset:1024 lds
    v_mfma_f32_16x16x32_bf16 v[68:71], a[220:223], a[108:111], v[68:71]
    s_waitcnt vmcnt(9)
    s_lshl_b32 s44, s3, 1
    ds_read_b64_tr_b16 a[180:181], v25 offset:40960
    ds_read_b64_tr_b16 a[182:183], v25 offset:45056
    v_mfma_f32_16x16x32_bf16 v[68:71], a[224:227], a[112:115], v[68:71]
    s_waitcnt vmcnt(8)
    ds_read_b64_tr_b16 a[184:185], v25 offset:49152
    v_cvt_pk_bf16_f32 v224, v64, v65
    v_mfma_f32_16x16x32_bf16 v[68:71], a[228:231], a[116:119], v[68:71]
    s_waitcnt vmcnt(7)
    ds_read_b64_tr_b16 a[186:187], v25 offset:53248
    v_cvt_pk_bf16_f32 v225, v66, v67
    v_mfma_f32_16x16x32_bf16 v[68:71], a[232:235], a[120:123], v[68:71]
    s_waitcnt vmcnt(6)
    s_add_u32 s43, s43, s44
    ds_read_b64_tr_b16 a[188:189], v25 offset:57344
    v_cndmask_b32 v242, v242, 0, vcc
    v_mfma_f32_16x16x32_bf16 v[68:71], a[236:239], a[124:127], v[68:71]
    s_waitcnt lgkmcnt(13)
    ds_read_b64_tr_b16 a[190:191], v25 offset:61440
    v_add_u32 v7, s43, v241
    v_mfma_f32_16x16x32_bf16 v[72:75], a[160:163], a[64:67], v[72:75]
    s_waitcnt lgkmcnt(12)
    buffer_load_dwordx4 v48, s[20:23], s49 offen offset:2048 lds
    v_mfma_f32_16x16x32_bf16 v[72:75], a[164:167], a[68:71], v[72:75]
    s_waitcnt lgkmcnt(10)
    ds_read_b64_tr_b16 a[208:209], v22 offset:32768
    ds_read_b64_tr_b16 a[210:211], v22 offset:36864
    v_mfma_f32_16x16x32_bf16 v[72:75], a[168:171], a[72:75], v[72:75]
    s_waitcnt lgkmcnt(10)
    buffer_load_dwordx4 v49, s[20:23], s49 offen offset:3072 lds
    v_mfma_f32_16x16x32_bf16 v[72:75], a[172:175], a[76:79], v[72:75]
    s_waitcnt lgkmcnt(8)
    ds_read_b64_tr_b16 a[212:213], v22 offset:40960
    ds_read_b64_tr_b16 a[214:215], v22 offset:45056
    v_mfma_f32_16x16x32_bf16 v[72:75], a[176:179], a[80:83], v[72:75]
    s_waitcnt lgkmcnt(8)
    ds_read_b64_tr_b16 a[216:217], v22 offset:49152
    v_cvt_pk_bf16_f32 v228, v68, v69
    v_mfma_f32_16x16x32_bf16 v[72:75], a[180:183], a[84:87], v[72:75]
    s_waitcnt lgkmcnt(7)
    ds_read_b64_tr_b16 a[218:219], v22 offset:53248
    v_cvt_pk_bf16_f32 v229, v70, v71
    v_mfma_f32_16x16x32_bf16 v[72:75], a[184:187], a[88:91], v[72:75]
    s_waitcnt lgkmcnt(6)
    ds_read_b64_tr_b16 a[220:221], v22 offset:57344
    v_lshlrev_b32 v5, 4, v240
    v_mfma_f32_16x16x32_bf16 v[72:75], a[188:191], a[92:95], v[72:75]
    ds_read_b64_tr_b16 a[222:223], v22 offset:61440
    v_lshlrev_b32 v243, 4, v241
    v_mfma_f32_16x16x32_bf16 v[76:79], a[160:163], a[96:99], v[76:79]
    ds_read_b64_tr_b16 a[224:225], v26 offset:32768
    v_lshl_add_u32 v2, v240, 5, v243
    v_mfma_f32_16x16x32_bf16 v[76:79], a[164:167], a[100:103], v[76:79]
    s_mul_i32 s44, s43, 10240
    ds_read_b64_tr_b16 a[226:227], v26 offset:36864
    v_lshrrev_b32 v243, 2, v240
    v_mfma_f32_16x16x32_bf16 v[76:79], a[168:171], a[104:107], v[76:79]
    ds_read_b64_tr_b16 a[228:229], v26 offset:40960
    v_lshlrev_b32 v243, 6, v243
    v_mfma_f32_16x16x32_bf16 v[76:79], a[172:175], a[108:111], v[76:79]
    ds_read_b64_tr_b16 a[230:231], v26 offset:45056
    v_and_b32 v241, 3, v240
    v_mfma_f32_16x16x32_bf16 v[76:79], a[176:179], a[112:115], v[76:79]
    ds_read_b64_tr_b16 a[232:233], v26 offset:49152
    v_cvt_pk_bf16_f32 v226, v72, v73
    v_mfma_f32_16x16x32_bf16 v[76:79], a[180:183], a[116:119], v[76:79]
    s_add_u32 s38, s93, 0
    ds_read_b64_tr_b16 a[234:235], v26 offset:53248
    v_cvt_pk_bf16_f32 v227, v74, v75
    v_mfma_f32_16x16x32_bf16 v[76:79], a[184:187], a[120:123], v[76:79]
    buffer_store_dwordx4 v[224:227], v56, s[28:31], s38 offen sc1
    v_mfma_f32_16x16x32_bf16 v[76:79], a[188:191], a[124:127], v[76:79]
    s_waitcnt lgkmcnt(12)
    ds_read_b64_tr_b16 a[236:237], v26 offset:57344
    ds_read_b64_tr_b16 a[238:239], v26 offset:61440
    v_mfma_f32_16x16x32_bf16 v[80:83], a[208:211], a[64:67], v[80:83]
    s_waitcnt lgkmcnt(12)
    ds_read_b64_tr_b16 a[160:161], v23 offset:32768
    v_lshl_add_u32 v3, v241, 3, v243
    v_mfma_f32_16x16x32_bf16 v[80:83], a[212:215], a[68:71], v[80:83]
    s_waitcnt lgkmcnt(11)
    ds_read_b64_tr_b16 a[162:163], v23 offset:36864
    v_mul_u32_u24 v243, 1152, v7
    v_mfma_f32_16x16x32_bf16 v[80:83], a[216:219], a[72:75], v[80:83]
    s_waitcnt lgkmcnt(10)
    ds_read_b64_tr_b16 a[164:165], v23 offset:40960
    v_add_u32 v4, v243, v3
    v_mfma_f32_16x16x32_bf16 v[80:83], a[220:223], a[76:79], v[80:83]
    s_waitcnt lgkmcnt(9)
    ds_read_b64_tr_b16 a[166:167], v23 offset:45056
    v_lshl_add_u32 v6, v243, 1, v5
    v_mfma_f32_16x16x32_bf16 v[80:83], a[224:227], a[80:83], v[80:83]
    s_waitcnt lgkmcnt(8)
    ds_read_b64_tr_b16 a[168:169], v23 offset:49152
    v_cvt_pk_bf16_f32 v230, v76, v77
    v_mfma_f32_16x16x32_bf16 v[80:83], a[228:231], a[84:87], v[80:83]
    s_waitcnt lgkmcnt(7)
    s_add_u32 s38, s93, 163840
    ds_read_b64_tr_b16 a[170:171], v23 offset:53248
    v_cvt_pk_bf16_f32 v231, v78, v79
    v_mfma_f32_16x16x32_bf16 v[80:83], a[232:235], a[88:91], v[80:83]
    s_waitcnt lgkmcnt(6)
    buffer_store_dwordx4 v[228:231], v56, s[28:31], s38 offen sc1
    v_mfma_f32_16x16x32_bf16 v[80:83], a[236:239], a[92:95], v[80:83]
    ds_read_b64_tr_b16 a[172:173], v23 offset:57344
    ds_read_b64_tr_b16 a[174:175], v23 offset:61440
    v_mfma_f32_16x16x32_bf16 v[84:87], a[208:211], a[96:99], v[84:87]
    ds_read_b64_tr_b16 a[176:177], v27 offset:32768
    v_or_b32 v55, v3, v242
    v_mfma_f32_16x16x32_bf16 v[84:87], a[212:215], a[100:103], v[84:87]
    ds_read_b64_tr_b16 a[178:179], v27 offset:36864
    v_or_b32 v58, v4, v242
    v_mfma_f32_16x16x32_bf16 v[84:87], a[216:219], a[104:107], v[84:87]
    ds_read_b64_tr_b16 a[180:181], v27 offset:40960
    v_or_b32 v59, v5, v242
    v_mfma_f32_16x16x32_bf16 v[84:87], a[220:223], a[108:111], v[84:87]
    ds_read_b64_tr_b16 a[182:183], v27 offset:45056
    v_or_b32 v60, v6, v242
    v_mfma_f32_16x16x32_bf16 v[84:87], a[224:227], a[112:115], v[84:87]
    ds_read_b64_tr_b16 a[184:185], v27 offset:49152
    v_cvt_pk_bf16_f32 v232, v80, v81
    v_mfma_f32_16x16x32_bf16 v[84:87], a[228:231], a[116:119], v[84:87]
    ds_read_b64_tr_b16 a[186:187], v27 offset:53248
    v_cvt_pk_bf16_f32 v233, v82, v83
    v_mfma_f32_16x16x32_bf16 v[84:87], a[232:235], a[120:123], v[84:87]
    ds_read_b64_tr_b16 a[188:189], v27 offset:57344
    v_lshrrev_b32 v243, 4, v1
    v_mfma_f32_16x16x32_bf16 v[84:87], a[236:239], a[124:127], v[84:87]
    s_waitcnt lgkmcnt(13)
    ds_read_b64_tr_b16 a[190:191], v27 offset:61440
    v_lshlrev_b32 v243, 8, v243
    s_barrier
    v_mfma_f32_16x16x32_bf16 v[88:91], a[160:163], a[64:67], v[88:91]
    s_waitcnt lgkmcnt(12)
    ds_read_b64_tr_b16 a[208:209], v12 offset:0
    v_and_b32 v241, 7, v1
    v_mfma_f32_16x16x32_bf16 v[88:91], a[164:167], a[68:71], v[88:91]
    s_waitcnt lgkmcnt(11)
    ds_read_b64_tr_b16 a[210:211], v12 offset:4096
    v_lshl_add_u32 v243, v241, 5, v243
    v_mfma_f32_16x16x32_bf16 v[88:91], a[168:171], a[72:75], v[88:91]
    s_waitcnt lgkmcnt(10)
    ds_read_b64_tr_b16 a[212:213], v12 offset:8192
    v_and_b32 v241, 8, v1
    v_mfma_f32_16x16x32_bf16 v[88:91], a[172:175], a[76:79], v[88:91]
    s_waitcnt lgkmcnt(9)
    ds_read_b64_tr_b16 a[214:215], v12 offset:12288
    v_lshl_add_u32 v54, v241, 1, v243
    v_mfma_f32_16x16x32_bf16 v[88:91], a[176:179], a[80:83], v[88:91]
    s_waitcnt lgkmcnt(8)
    ds_read_b64_tr_b16 a[216:217], v12 offset:16384
    v_cvt_pk_bf16_f32 v236, v84, v85
    v_mfma_f32_16x16x32_bf16 v[88:91], a[180:183], a[84:87], v[88:91]
    s_waitcnt lgkmcnt(7)
    ds_read_b64_tr_b16 a[218:219], v12 offset:20480
    v_cvt_pk_bf16_f32 v237, v86, v87
    v_mfma_f32_16x16x32_bf16 v[88:91], a[184:187], a[88:91], v[88:91]
    s_waitcnt lgkmcnt(6)
    s_add_u32 s49, s46, 512
    ds_read_b64_tr_b16 a[220:221], v12 offset:24576
    v_mfma_f32_16x16x32_bf16 v[88:91], a[188:191], a[92:95], v[88:91]
    s_add_u32 m0, s42, 32768
    ds_read_b64_tr_b16 a[222:223], v12 offset:28672
    v_mfma_f32_16x16x32_bf16 v[92:95], a[160:163], a[96:99], v[92:95]
    buffer_load_dwordx4 v46, s[20:23], s49 offen lds
    v_mfma_f32_16x16x32_bf16 v[92:95], a[164:167], a[100:103], v[92:95]
    s_lshr_b32 s41, s2, 3
    ds_read_b64_tr_b16 a[224:225], v16 offset:0
    ds_read_b64_tr_b16 a[226:227], v16 offset:4096
    v_mfma_f32_16x16x32_bf16 v[92:95], a[168:171], a[104:107], v[92:95]
    buffer_load_dwordx4 v47, s[20:23], s49 offen offset:1024 lds
    v_mfma_f32_16x16x32_bf16 v[92:95], a[172:175], a[108:111], v[92:95]
    s_mov_b32 s14, 2359296
    ds_read_b64_tr_b16 a[228:229], v16 offset:8192
    ds_read_b64_tr_b16 a[230:231], v16 offset:12288
    v_mfma_f32_16x16x32_bf16 v[92:95], a[176:179], a[112:115], v[92:95]
    ds_read_b64_tr_b16 a[232:233], v16 offset:16384
    v_cvt_pk_bf16_f32 v234, v88, v89
    v_mfma_f32_16x16x32_bf16 v[92:95], a[180:183], a[116:119], v[92:95]
    s_add_u32 s38, s93, 128
    ds_read_b64_tr_b16 a[234:235], v16 offset:20480
    v_cvt_pk_bf16_f32 v235, v90, v91
    v_mfma_f32_16x16x32_bf16 v[92:95], a[184:187], a[120:123], v[92:95]
    buffer_store_dwordx4 v[232:235], v56, s[28:31], s38 offen sc1
    v_mfma_f32_16x16x32_bf16 v[92:95], a[188:191], a[124:127], v[92:95]
    s_waitcnt lgkmcnt(12)
    s_mov_b32 s15, 0x20000
    ds_read_b64_tr_b16 a[236:237], v16 offset:24576
    ds_read_b64_tr_b16 a[238:239], v16 offset:28672
    v_mfma_f32_16x16x32_bf16 v[96:99], a[208:211], a[64:67], v[96:99]
    s_waitcnt lgkmcnt(12)
    buffer_load_dwordx4 v48, s[20:23], s49 offen offset:2048 lds
    v_mfma_f32_16x16x32_bf16 v[96:99], a[212:215], a[68:71], v[96:99]
    s_waitcnt lgkmcnt(10)
    s_mov_b32 s18, 2359296
    ds_read_b64_tr_b16 a[160:161], v13 offset:0
    ds_read_b64_tr_b16 a[162:163], v13 offset:4096
    v_mfma_f32_16x16x32_bf16 v[96:99], a[216:219], a[72:75], v[96:99]
    s_waitcnt lgkmcnt(10)
    buffer_load_dwordx4 v49, s[20:23], s49 offen offset:3072 lds
    v_mfma_f32_16x16x32_bf16 v[96:99], a[220:223], a[76:79], v[96:99]
    s_waitcnt lgkmcnt(8)
    s_mov_b32 s19, 0x20000
    ds_read_b64_tr_b16 a[164:165], v13 offset:8192
    ds_read_b64_tr_b16 a[166:167], v13 offset:12288
    v_mfma_f32_16x16x32_bf16 v[96:99], a[224:227], a[80:83], v[96:99]
    s_waitcnt lgkmcnt(8)
    ds_read_b64_tr_b16 a[168:169], v13 offset:16384
    v_cvt_pk_bf16_f32 v238, v92, v93
    v_mfma_f32_16x16x32_bf16 v[96:99], a[228:231], a[84:87], v[96:99]
    s_waitcnt lgkmcnt(7)
    s_add_u32 s38, s93, 163968
    ds_read_b64_tr_b16 a[170:171], v13 offset:20480
    v_cvt_pk_bf16_f32 v239, v94, v95
    v_mfma_f32_16x16x32_bf16 v[96:99], a[232:235], a[88:91], v[96:99]
    s_waitcnt lgkmcnt(6)
    s_add_u32 s49, s46, 74240
    buffer_store_dwordx4 v[236:239], v56, s[28:31], s38 offen sc1
    v_mfma_f32_16x16x32_bf16 v[96:99], a[236:239], a[92:95], v[96:99]
    s_add_u32 m0, s42, 49152
    ds_read_b64_tr_b16 a[172:173], v13 offset:24576
    ds_read_b64_tr_b16 a[174:175], v13 offset:28672
    v_mfma_f32_16x16x32_bf16 v[100:103], a[208:211], a[96:99], v[100:103]
    buffer_load_dwordx4 v46, s[20:23], s49 offen lds
    v_mfma_f32_16x16x32_bf16 v[100:103], a[212:215], a[100:103], v[100:103]
    s_add_u32 s8, s50, 7864320
    s_addc_u32 s9, s51, 0
    ds_read_b64_tr_b16 a[176:177], v17 offset:0
    ds_read_b64_tr_b16 a[178:179], v17 offset:4096
    v_mfma_f32_16x16x32_bf16 v[100:103], a[216:219], a[104:107], v[100:103]
    buffer_load_dwordx4 v47, s[20:23], s49 offen offset:1024 lds
    v_mfma_f32_16x16x32_bf16 v[100:103], a[220:223], a[108:111], v[100:103]
    s_mov_b32 s10, 663552
    ds_read_b64_tr_b16 a[180:181], v17 offset:8192
    ds_read_b64_tr_b16 a[182:183], v17 offset:12288
    v_mfma_f32_16x16x32_bf16 v[100:103], a[224:227], a[112:115], v[100:103]
    ds_read_b64_tr_b16 a[184:185], v17 offset:16384
    v_cvt_pk_bf16_f32 v224, v96, v97
    v_mfma_f32_16x16x32_bf16 v[100:103], a[228:231], a[116:119], v[100:103]
    ds_read_b64_tr_b16 a[186:187], v17 offset:20480
    v_cvt_pk_bf16_f32 v225, v98, v99
    v_mfma_f32_16x16x32_bf16 v[100:103], a[232:235], a[120:123], v[100:103]
    s_mov_b32 s11, 0x20000
    ds_read_b64_tr_b16 a[188:189], v17 offset:24576
    v_mfma_f32_16x16x32_bf16 v[100:103], a[236:239], a[124:127], v[100:103]
    s_waitcnt lgkmcnt(13)
    s_lshl_b32 s39, s5, 13
    ds_read_b64_tr_b16 a[190:191], v17 offset:28672
    v_mfma_f32_16x16x32_bf16 v[104:107], a[160:163], a[64:67], v[104:107]
    s_waitcnt lgkmcnt(12)
    buffer_load_dwordx4 v48, s[20:23], s49 offen offset:2048 lds
    v_mfma_f32_16x16x32_bf16 v[104:107], a[164:167], a[68:71], v[104:107]
    s_waitcnt lgkmcnt(10)
    s_add_u32 s39, s39, 8781824
    ds_read_b64_tr_b16 a[208:209], v14 offset:0
    ds_read_b64_tr_b16 a[210:211], v14 offset:4096
    v_mfma_f32_16x16x32_bf16 v[104:107], a[168:171], a[72:75], v[104:107]
    s_waitcnt lgkmcnt(10)
    buffer_load_dwordx4 v49, s[20:23], s49 offen offset:3072 lds
    v_mfma_f32_16x16x32_bf16 v[104:107], a[172:175], a[76:79], v[104:107]
    s_waitcnt lgkmcnt(8)
    s_lshr_b32 s45, s4, 2
    ds_read_b64_tr_b16 a[212:213], v14 offset:8192
    ds_read_b64_tr_b16 a[214:215], v14 offset:12288
    v_mfma_f32_16x16x32_bf16 v[104:107], a[176:179], a[80:83], v[104:107]
    s_waitcnt lgkmcnt(8)
    ds_read_b64_tr_b16 a[216:217], v14 offset:16384
    v_cvt_pk_bf16_f32 v228, v100, v101
    v_mfma_f32_16x16x32_bf16 v[104:107], a[180:183], a[84:87], v[104:107]
    s_waitcnt lgkmcnt(7)
    ds_read_b64_tr_b16 a[218:219], v14 offset:20480
    v_cvt_pk_bf16_f32 v229, v102, v103
    v_mfma_f32_16x16x32_bf16 v[104:107], a[184:187], a[88:91], v[104:107]
    s_waitcnt lgkmcnt(6)
    s_lshl_b32 s45, s45, 11
    ds_read_b64_tr_b16 a[220:221], v14 offset:24576
    v_mfma_f32_16x16x32_bf16 v[104:107], a[188:191], a[92:95], v[104:107]
    s_add_u32 s39, s39, s45
    ds_read_b64_tr_b16 a[222:223], v14 offset:28672
    v_and_b32 v9, 15, v1
    v_mfma_f32_16x16x32_bf16 v[108:111], a[160:163], a[96:99], v[108:111]
    ds_read_b64_tr_b16 a[224:225], v18 offset:0
    v_lshlrev_b32 v9, 7, v9
    v_mfma_f32_16x16x32_bf16 v[108:111], a[164:167], a[100:103], v[108:111]
    ds_read_b64_tr_b16 a[226:227], v18 offset:4096
    v_lshrrev_b32 v240, 4, v1
    v_mfma_f32_16x16x32_bf16 v[108:111], a[168:171], a[104:107], v[108:111]
    ds_read_b64_tr_b16 a[228:229], v18 offset:8192
    v_bfe_u32 v241, v1, 2, 2
    v_mfma_f32_16x16x32_bf16 v[108:111], a[172:175], a[108:111], v[108:111]
    ds_read_b64_tr_b16 a[230:231], v18 offset:12288
    v_cmp_eq_u32 s[54:55], v240, v241
    v_mfma_f32_16x16x32_bf16 v[108:111], a[176:179], a[112:115], v[108:111]
    ds_read_b64_tr_b16 a[232:233], v18 offset:16384
    v_cvt_pk_bf16_f32 v226, v104, v105
    v_mfma_f32_16x16x32_bf16 v[108:111], a[180:183], a[116:119], v[108:111]
    s_add_u32 s38, s93, 512
    ds_read_b64_tr_b16 a[234:235], v18 offset:20480
    v_cvt_pk_bf16_f32 v227, v106, v107
    v_mfma_f32_16x16x32_bf16 v[108:111], a[184:187], a[120:123], v[108:111]
    buffer_store_dwordx4 v[224:227], v56, s[28:31], s38 offen sc1
    v_mfma_f32_16x16x32_bf16 v[108:111], a[188:191], a[124:127], v[108:111]
    s_waitcnt lgkmcnt(12)
    ds_read_b64_tr_b16 a[236:237], v18 offset:24576
    ds_read_b64_tr_b16 a[238:239], v18 offset:28672
    v_mfma_f32_16x16x32_bf16 v[112:115], a[208:211], a[64:67], v[112:115]
    s_waitcnt lgkmcnt(12)
    ds_read_b64_tr_b16 a[160:161], v15 offset:0
    v_and_b32 v240, 1, v1
    v_mfma_f32_16x16x32_bf16 v[112:115], a[212:215], a[68:71], v[112:115]
    s_waitcnt lgkmcnt(11)
    ds_read_b64_tr_b16 a[162:163], v15 offset:4096
    v_lshlrev_b32 v240, 4, v240
    v_mfma_f32_16x16x32_bf16 v[112:115], a[216:219], a[72:75], v[112:115]
    s_waitcnt lgkmcnt(10)
    ds_read_b64_tr_b16 a[164:165], v15 offset:8192
    v_mov_b32 v241, 0x3f80
    v_mfma_f32_16x16x32_bf16 v[112:115], a[220:223], a[76:79], v[112:115]
    s_waitcnt lgkmcnt(9)
    ds_read_b64_tr_b16 a[166:167], v15 offset:12288
    v_lshlrev_b32 v240, v240, v241
    v_mfma_f32_16x16x32_bf16 v[112:115], a[224:227], a[80:83], v[112:115]
    s_waitcnt lgkmcnt(8)
    ds_read_b64_tr_b16 a[168:169], v15 offset:16384
    v_cvt_pk_bf16_f32 v230, v108, v109
    v_mfma_f32_16x16x32_bf16 v[112:115], a[228:231], a[84:87], v[112:115]
    s_waitcnt lgkmcnt(7)
    s_add_u32 s38, s93, 164352
    ds_read_b64_tr_b16 a[170:171], v15 offset:20480
    v_cvt_pk_bf16_f32 v231, v110, v111
    v_mfma_f32_16x16x32_bf16 v[112:115], a[232:235], a[88:91], v[112:115]
    s_waitcnt lgkmcnt(6)
    buffer_store_dwordx4 v[228:231], v56, s[28:31], s38 offen sc1
    v_mfma_f32_16x16x32_bf16 v[112:115], a[236:239], a[92:95], v[112:115]
    ds_read_b64_tr_b16 a[172:173], v15 offset:24576
    ds_read_b64_tr_b16 a[174:175], v15 offset:28672
    v_mfma_f32_16x16x32_bf16 v[116:119], a[208:211], a[96:99], v[116:119]
    ds_read_b64_tr_b16 a[176:177], v19 offset:0
    v_bfe_i32 v241, v1, 1, 1
    v_mfma_f32_16x16x32_bf16 v[116:119], a[212:215], a[100:103], v[116:119]
    ds_read_b64_tr_b16 a[178:179], v19 offset:4096
    v_and_b32 v243, v240, v241
    v_mfma_f32_16x16x32_bf16 v[116:119], a[216:219], a[104:107], v[116:119]
    ds_read_b64_tr_b16 a[180:181], v19 offset:8192
    v_xor_b32 v242, v240, v243
    v_mfma_f32_16x16x32_bf16 v[116:119], a[220:223], a[108:111], v[116:119]
    ds_read_b64_tr_b16 a[182:183], v19 offset:12288
    v_cndmask_b32 v250, 0, v242, s[54:55]
    v_mfma_f32_16x16x32_bf16 v[116:119], a[224:227], a[112:115], v[116:119]
    ds_read_b64_tr_b16 a[184:185], v19 offset:16384
    v_cvt_pk_bf16_f32 v232, v112, v113
    v_mfma_f32_16x16x32_bf16 v[116:119], a[228:231], a[116:119], v[116:119]
    ds_read_b64_tr_b16 a[186:187], v19 offset:20480
    v_cvt_pk_bf16_f32 v233, v114, v115
    v_mfma_f32_16x16x32_bf16 v[116:119], a[232:235], a[120:123], v[116:119]
    ds_read_b64_tr_b16 a[188:189], v19 offset:24576
    v_cndmask_b32 v251, 0, v243, s[54:55]
    v_mfma_f32_16x16x32_bf16 v[116:119], a[236:239], a[124:127], v[116:119]
    s_waitcnt lgkmcnt(13)
    ds_read_b64_tr_b16 a[190:191], v19 offset:28672
    v_mov_b32 v248, 0
    s_waitcnt vmcnt(14)
    s_barrier
    v_mfma_f32_16x16x32_bf16 v[120:123], a[160:163], a[64:67], v[120:123]
    s_waitcnt lgkmcnt(12)
    ds_read_b64_tr_b16 a[208:209], v20 offset:0
    v_mov_b32 v249, 0
    v_mfma_f32_16x16x32_bf16 v[120:123], a[164:167], a[68:71], v[120:123]
    s_waitcnt lgkmcnt(11)
    ds_read_b64_tr_b16 a[210:211], v20 offset:4096
    v_mov_b32 v252, 0
    v_mfma_f32_16x16x32_bf16 v[120:123], a[168:171], a[72:75], v[120:123]
    s_waitcnt lgkmcnt(10)
    ds_read_b64_tr_b16 a[212:213], v20 offset:8192
    v_mov_b32 v253, 0
    v_mfma_f32_16x16x32_bf16 v[120:123], a[172:175], a[76:79], v[120:123]
    s_waitcnt lgkmcnt(9)
    ds_read_b64_tr_b16 a[214:215], v20 offset:12288
    v_mov_b32 v240, 0
    v_mfma_f32_16x16x32_bf16 v[120:123], a[176:179], a[80:83], v[120:123]
    s_waitcnt lgkmcnt(8)
    ds_read_b64_tr_b16 a[216:217], v20 offset:16384
    v_cvt_pk_bf16_f32 v236, v116, v117
    v_mfma_f32_16x16x32_bf16 v[120:123], a[180:183], a[84:87], v[120:123]
    s_waitcnt lgkmcnt(7)
    ds_read_b64_tr_b16 a[218:219], v20 offset:20480
    v_cvt_pk_bf16_f32 v237, v118, v119
    v_mfma_f32_16x16x32_bf16 v[120:123], a[184:187], a[88:91], v[120:123]
    s_waitcnt lgkmcnt(6)
    s_add_u32 s49, s7, 768
    ds_read_b64_tr_b16 a[220:221], v20 offset:24576
    v_mov_b32 v241, 0
    v_mfma_f32_16x16x32_bf16 v[120:123], a[188:191], a[92:95], v[120:123]
    s_add_u32 m0, s42, 98304
    ds_read_b64_tr_b16 a[222:223], v20 offset:28672
    v_mfma_f32_16x16x32_bf16 v[124:127], a[160:163], a[96:99], v[124:127]
    buffer_load_dwordx4 v46, s[20:23], s49 offen lds
    v_mfma_f32_16x16x32_bf16 v[124:127], a[164:167], a[100:103], v[124:127]
    ds_read_b64_tr_b16 a[224:225], v24 offset:0
    ds_read_b64_tr_b16 a[226:227], v24 offset:4096
    v_mfma_f32_16x16x32_bf16 v[124:127], a[168:171], a[104:107], v[124:127]
    buffer_load_dwordx4 v47, s[20:23], s49 offen offset:1024 lds
    v_mfma_f32_16x16x32_bf16 v[124:127], a[172:175], a[108:111], v[124:127]
    ds_read_b64_tr_b16 a[228:229], v24 offset:8192
    ds_read_b64_tr_b16 a[230:231], v24 offset:12288
    v_mfma_f32_16x16x32_bf16 v[124:127], a[176:179], a[112:115], v[124:127]
    ds_read_b64_tr_b16 a[232:233], v24 offset:16384
    v_cvt_pk_bf16_f32 v234, v120, v121
    v_mfma_f32_16x16x32_bf16 v[124:127], a[180:183], a[116:119], v[124:127]
    s_add_u32 s38, s93, 640
    ds_read_b64_tr_b16 a[234:235], v24 offset:20480
    v_cvt_pk_bf16_f32 v235, v122, v123
    v_mfma_f32_16x16x32_bf16 v[124:127], a[184:187], a[120:123], v[124:127]
    buffer_store_dwordx4 v[232:235], v56, s[28:31], s38 offen sc1
    v_mfma_f32_16x16x32_bf16 v[124:127], a[188:191], a[124:127], v[124:127]
    s_waitcnt lgkmcnt(12)
    ds_read_b64_tr_b16 a[236:237], v24 offset:24576
    ds_read_b64_tr_b16 a[238:239], v24 offset:28672
    v_mfma_f32_16x16x32_bf16 v[64:67], a[208:211], v[128:131], 0
    s_waitcnt lgkmcnt(12)
    buffer_load_dwordx4 v48, s[20:23], s49 offen offset:2048 lds
    v_mfma_f32_16x16x32_bf16 v[64:67], a[212:215], v[132:135], v[64:67]
    s_waitcnt lgkmcnt(10)
    ds_read_b64_tr_b16 a[160:161], v21 offset:0
    ds_read_b64_tr_b16 a[162:163], v21 offset:4096
    v_mfma_f32_16x16x32_bf16 v[64:67], a[216:219], v[136:139], v[64:67]
    s_waitcnt lgkmcnt(10)
    buffer_load_dwordx4 v49, s[20:23], s49 offen offset:3072 lds
    v_mfma_f32_16x16x32_bf16 v[64:67], a[220:223], v[140:143], v[64:67]
    s_waitcnt lgkmcnt(8)
    ds_read_b64_tr_b16 a[164:165], v21 offset:8192
    ds_read_b64_tr_b16 a[166:167], v21 offset:12288
    v_mfma_f32_16x16x32_bf16 v[64:67], a[224:227], v[144:147], v[64:67]
    s_waitcnt lgkmcnt(8)
    ds_read_b64_tr_b16 a[168:169], v21 offset:16384
    v_cvt_pk_bf16_f32 v238, v124, v125
    v_mfma_f32_16x16x32_bf16 v[64:67], a[228:231], v[148:151], v[64:67]
    s_waitcnt lgkmcnt(7)
    s_add_u32 s38, s93, 164480
    ds_read_b64_tr_b16 a[170:171], v21 offset:20480
    v_cvt_pk_bf16_f32 v239, v126, v127
    v_mfma_f32_16x16x32_bf16 v[64:67], a[232:235], v[152:155], v[64:67]
    s_waitcnt lgkmcnt(6)
    s_add_u32 s49, s7, 74496
    buffer_store_dwordx4 v[236:239], v56, s[28:31], s38 offen sc1
    v_mfma_f32_16x16x32_bf16 v[64:67], a[236:239], v[156:159], v[64:67]
    s_add_u32 m0, s42, 114688
    ds_read_b64_tr_b16 a[172:173], v21 offset:24576
    ds_read_b64_tr_b16 a[174:175], v21 offset:28672
    v_mfma_f32_16x16x32_bf16 v[68:71], a[208:211], v[160:163], 0
    buffer_load_dwordx4 v46, s[20:23], s49 offen lds
    v_mfma_f32_16x16x32_bf16 v[68:71], a[212:215], v[164:167], v[68:71]
    ds_read_b64_tr_b16 a[176:177], v25 offset:0
    ds_read_b64_tr_b16 a[178:179], v25 offset:4096
    v_mfma_f32_16x16x32_bf16 v[68:71], a[216:219], v[168:171], v[68:71]
    buffer_load_dwordx4 v47, s[20:23], s49 offen offset:1024 lds
    v_mfma_f32_16x16x32_bf16 v[68:71], a[220:223], v[172:175], v[68:71]
    ds_read_b64_tr_b16 a[180:181], v25 offset:8192
    ds_read_b64_tr_b16 a[182:183], v25 offset:12288
    v_mfma_f32_16x16x32_bf16 v[68:71], a[224:227], v[176:179], v[68:71]
    buffer_load_dwordx2 v[36:37], v4, s[12:15], 0 offen offset:0
    v_mfma_f32_16x16x32_bf16 v[68:71], a[228:231], v[180:183], v[68:71]
    ds_read_b64_tr_b16 a[184:185], v25 offset:16384
    ds_read_b64_tr_b16 a[186:187], v25 offset:20480
    v_mfma_f32_16x16x32_bf16 v[68:71], a[232:235], v[184:187], v[68:71]
    ds_read_b64_tr_b16 a[188:189], v25 offset:24576
    v_mfma_f32_16x16x32_bf16 v[68:71], a[236:239], v[188:191], v[68:71]
    s_waitcnt lgkmcnt(13)
    ds_read_b64_tr_b16 a[190:191], v25 offset:28672
    v_mfma_f32_16x16x32_bf16 v[72:75], a[160:163], v[128:131], 0
    s_waitcnt lgkmcnt(12)
    buffer_load_dwordx4 v48, s[20:23], s49 offen offset:2048 lds
    v_mfma_f32_16x16x32_bf16 v[72:75], a[164:167], v[132:135], v[72:75]
    s_waitcnt lgkmcnt(10)
    ds_read_b64_tr_b16 a[208:209], v22 offset:0
    ds_read_b64_tr_b16 a[210:211], v22 offset:4096
    v_mfma_f32_16x16x32_bf16 v[72:75], a[168:171], v[136:139], v[72:75]
    s_waitcnt lgkmcnt(10)
    buffer_load_dwordx4 v49, s[20:23], s49 offen offset:3072 lds
    v_mfma_f32_16x16x32_bf16 v[72:75], a[172:175], v[140:143], v[72:75]
    s_waitcnt lgkmcnt(8)
    ds_read_b64_tr_b16 a[212:213], v22 offset:8192
    ds_read_b64_tr_b16 a[214:215], v22 offset:12288
    v_mfma_f32_16x16x32_bf16 v[72:75], a[176:179], v[144:147], v[72:75]
    s_waitcnt lgkmcnt(8)
    ds_read_b64_tr_b16 a[216:217], v22 offset:16384
    v_mfma_f32_16x16x32_bf16 v[72:75], a[180:183], v[148:151], v[72:75]
    s_waitcnt lgkmcnt(7)
    ds_read_b64_tr_b16 a[218:219], v22 offset:20480
    v_mfma_f32_16x16x32_bf16 v[72:75], a[184:187], v[152:155], v[72:75]
    s_waitcnt lgkmcnt(6)
    ds_read_b64_tr_b16 a[220:221], v22 offset:24576
    v_mfma_f32_16x16x32_bf16 v[72:75], a[188:191], v[156:159], v[72:75]
    ds_read_b64_tr_b16 a[222:223], v22 offset:28672
    v_mfma_f32_16x16x32_bf16 v[76:79], a[160:163], v[160:163], 0
    buffer_load_dwordx2 v[38:39], v4, s[12:15], 0 offen offset:32
    v_mfma_f32_16x16x32_bf16 v[76:79], a[164:167], v[164:167], v[76:79]
    ds_read_b64_tr_b16 a[224:225], v26 offset:0
    ds_read_b64_tr_b16 a[226:227], v26 offset:4096
    v_mfma_f32_16x16x32_bf16 v[76:79], a[168:171], v[168:171], v[76:79]
    ds_read_b64_tr_b16 a[228:229], v26 offset:8192
    v_mfma_f32_16x16x32_bf16 v[76:79], a[172:175], v[172:175], v[76:79]
    ds_read_b64_tr_b16 a[230:231], v26 offset:12288
    v_mfma_f32_16x16x32_bf16 v[76:79], a[176:179], v[176:179], v[76:79]
    ds_read_b64_tr_b16 a[232:233], v26 offset:16384
    v_mfma_f32_16x16x32_bf16 v[76:79], a[180:183], v[180:183], v[76:79]
    ds_read_b64_tr_b16 a[234:235], v26 offset:20480
    v_mfma_f32_16x16x32_bf16 v[76:79], a[184:187], v[184:187], v[76:79]
    buffer_load_dword v63, v63, s[88:91], 0 offen sc1
    v_mfma_f32_16x16x32_bf16 v[76:79], a[188:191], v[188:191], v[76:79]
    s_waitcnt lgkmcnt(12)
    ds_read_b64_tr_b16 a[236:237], v26 offset:24576
    ds_read_b64_tr_b16 a[238:239], v26 offset:28672
    v_mfma_f32_16x16x32_bf16 v[80:83], a[208:211], v[128:131], 0
    s_waitcnt lgkmcnt(12)
    ds_read_b64_tr_b16 a[160:161], v23 offset:0
    v_mfma_f32_16x16x32_bf16 v[80:83], a[212:215], v[132:135], v[80:83]
    s_waitcnt lgkmcnt(11)
    ds_read_b64_tr_b16 a[162:163], v23 offset:4096
    v_mfma_f32_16x16x32_bf16 v[80:83], a[216:219], v[136:139], v[80:83]
    s_waitcnt lgkmcnt(10)
    buffer_load_dwordx2 v[40:41], v4, s[12:15], 0 offen offset:512
    v_mfma_f32_16x16x32_bf16 v[80:83], a[220:223], v[140:143], v[80:83]
Ltour10:
    s_cbranch_execz Ltour14
    s_waitcnt lgkmcnt(8)
    ds_read_b64_tr_b16 a[164:165], v23 offset:8192
    ds_read_b64_tr_b16 a[166:167], v23 offset:12288
    v_mfma_f32_16x16x32_bf16 v[80:83], a[224:227], v[144:147], v[80:83]
    s_waitcnt lgkmcnt(8)
    ds_read_b64_tr_b16 a[168:169], v23 offset:16384
    v_mfma_f32_16x16x32_bf16 v[80:83], a[228:231], v[148:151], v[80:83]
    s_waitcnt lgkmcnt(7)
    ds_read_b64_tr_b16 a[170:171], v23 offset:20480
    v_mfma_f32_16x16x32_bf16 v[80:83], a[232:235], v[152:155], v[80:83]
    s_waitcnt lgkmcnt(6)
    ds_read_b64_tr_b16 a[172:173], v23 offset:24576
    v_mfma_f32_16x16x32_bf16 v[80:83], a[236:239], v[156:159], v[80:83]
    ds_read_b64_tr_b16 a[174:175], v23 offset:28672
    v_mfma_f32_16x16x32_bf16 v[84:87], a[208:211], v[160:163], 0
    ds_read_b64_tr_b16 a[176:177], v27 offset:0
    v_mfma_f32_16x16x32_bf16 v[84:87], a[212:215], v[164:167], v[84:87]
    ds_read_b64_tr_b16 a[178:179], v27 offset:4096
    v_mfma_f32_16x16x32_bf16 v[84:87], a[216:219], v[168:171], v[84:87]
    buffer_load_dwordx2 v[42:43], v4, s[12:15], 0 offen offset:544
    v_mfma_f32_16x16x32_bf16 v[84:87], a[220:223], v[172:175], v[84:87]
    ds_read_b64_tr_b16 a[180:181], v27 offset:8192
    ds_read_b64_tr_b16 a[182:183], v27 offset:12288
    v_mfma_f32_16x16x32_bf16 v[84:87], a[224:227], v[176:179], v[84:87]
    ds_read_b64_tr_b16 a[184:185], v27 offset:16384
    v_mfma_f32_16x16x32_bf16 v[84:87], a[228:231], v[180:183], v[84:87]
    ds_read_b64_tr_b16 a[186:187], v27 offset:20480
    v_mfma_f32_16x16x32_bf16 v[84:87], a[232:235], v[184:187], v[84:87]
    ds_read_b64_tr_b16 a[188:189], v27 offset:24576
    v_mfma_f32_16x16x32_bf16 v[84:87], a[236:239], v[188:191], v[84:87]
    s_waitcnt lgkmcnt(13)
    ds_read_b64_tr_b16 a[190:191], v27 offset:28672
    s_waitcnt vmcnt(17)
    s_barrier
    v_mfma_f32_16x16x32_bf16 v[88:91], a[160:163], v[128:131], 0
    s_waitcnt lgkmcnt(12)
    ds_read_b64_tr_b16 a[208:209], v12 offset:32768
    v_mfma_f32_16x16x32_bf16 v[88:91], a[164:167], v[132:135], v[88:91]
    s_waitcnt lgkmcnt(11)
    ds_read_b64_tr_b16 a[210:211], v12 offset:36864
    v_mfma_f32_16x16x32_bf16 v[88:91], a[168:171], v[136:139], v[88:91]
    s_waitcnt lgkmcnt(10)
    buffer_load_dwordx2 v[244:245], v58, s[12:15], 0 offen offset:1024
    v_mfma_f32_16x16x32_bf16 v[88:91], a[172:175], v[140:143], v[88:91]
    s_waitcnt lgkmcnt(8)
    ds_read_b64_tr_b16 a[212:213], v12 offset:40960
    ds_read_b64_tr_b16 a[214:215], v12 offset:45056
    v_mfma_f32_16x16x32_bf16 v[88:91], a[176:179], v[144:147], v[88:91]
    s_waitcnt lgkmcnt(8)
    ds_read_b64_tr_b16 a[216:217], v12 offset:49152
    v_mfma_f32_16x16x32_bf16 v[88:91], a[180:183], v[148:151], v[88:91]
    s_waitcnt lgkmcnt(7)
    ds_read_b64_tr_b16 a[218:219], v12 offset:53248
    v_mfma_f32_16x16x32_bf16 v[88:91], a[184:187], v[152:155], v[88:91]
    s_waitcnt lgkmcnt(6)
    s_add_u32 s49, s46, 768
    ds_read_b64_tr_b16 a[220:221], v12 offset:57344
    v_mfma_f32_16x16x32_bf16 v[88:91], a[188:191], v[156:159], v[88:91]
    s_add_u32 m0, s42, 0
    ds_read_b64_tr_b16 a[222:223], v12 offset:61440
    v_mfma_f32_16x16x32_bf16 v[92:95], a[160:163], v[160:163], 0
    buffer_load_dwordx4 v46, s[20:23], s49 offen lds
    v_mfma_f32_16x16x32_bf16 v[92:95], a[164:167], v[164:167], v[92:95]
    ds_read_b64_tr_b16 a[224:225], v16 offset:32768
    ds_read_b64_tr_b16 a[226:227], v16 offset:36864
    v_mfma_f32_16x16x32_bf16 v[92:95], a[168:171], v[168:171], v[92:95]
    buffer_load_dwordx4 v47, s[20:23], s49 offen offset:1024 lds
    v_mfma_f32_16x16x32_bf16 v[92:95], a[172:175], v[172:175], v[92:95]
    ds_read_b64_tr_b16 a[228:229], v16 offset:40960
    ds_read_b64_tr_b16 a[230:231], v16 offset:45056
    v_mfma_f32_16x16x32_bf16 v[92:95], a[176:179], v[176:179], v[92:95]
    ds_read_b64_tr_b16 a[232:233], v16 offset:49152
    v_mfma_f32_16x16x32_bf16 v[92:95], a[180:183], v[180:183], v[92:95]
    ds_read_b64_tr_b16 a[234:235], v16 offset:53248
    v_mfma_f32_16x16x32_bf16 v[92:95], a[184:187], v[184:187], v[92:95]
    buffer_load_dwordx2 v[246:247], v58, s[12:15], 0 offen offset:1056
    v_mfma_f32_16x16x32_bf16 v[92:95], a[188:191], v[188:191], v[92:95]
    s_waitcnt lgkmcnt(12)
    ds_read_b64_tr_b16 a[236:237], v16 offset:57344
    ds_read_b64_tr_b16 a[238:239], v16 offset:61440
    v_mfma_f32_16x16x32_bf16 v[64:67], a[208:211], a[64:67], v[64:67]
    s_waitcnt lgkmcnt(12)
    buffer_load_dwordx4 v48, s[20:23], s49 offen offset:2048 lds
    v_mfma_f32_16x16x32_bf16 v[64:67], a[212:215], a[68:71], v[64:67]
    s_waitcnt lgkmcnt(10)
    ds_read_b64_tr_b16 a[160:161], v13 offset:32768
    ds_read_b64_tr_b16 a[162:163], v13 offset:36864
    v_mfma_f32_16x16x32_bf16 v[64:67], a[216:219], a[72:75], v[64:67]
    s_waitcnt lgkmcnt(10)
    buffer_load_dwordx4 v49, s[20:23], s49 offen offset:3072 lds
    v_mfma_f32_16x16x32_bf16 v[64:67], a[220:223], a[76:79], v[64:67]
    s_waitcnt lgkmcnt(8)
    ds_read_b64_tr_b16 a[164:165], v13 offset:40960
    ds_read_b64_tr_b16 a[166:167], v13 offset:45056
    v_mfma_f32_16x16x32_bf16 v[64:67], a[224:227], a[80:83], v[64:67]
    s_waitcnt lgkmcnt(8)
    ds_read_b64_tr_b16 a[168:169], v13 offset:49152
    v_mfma_f32_16x16x32_bf16 v[64:67], a[228:231], a[84:87], v[64:67]
    s_waitcnt lgkmcnt(7)
    ds_read_b64_tr_b16 a[170:171], v13 offset:53248
    v_mfma_f32_16x16x32_bf16 v[64:67], a[232:235], a[88:91], v[64:67]
    s_waitcnt lgkmcnt(6)
    s_add_u32 s49, s46, 74496
    ds_read_b64_tr_b16 a[172:173], v13 offset:57344
    v_mfma_f32_16x16x32_bf16 v[64:67], a[236:239], a[92:95], v[64:67]
    s_add_u32 m0, s42, 16384
    ds_read_b64_tr_b16 a[174:175], v13 offset:61440
    v_mfma_f32_16x16x32_bf16 v[68:71], a[208:211], a[96:99], v[68:71]
    buffer_load_dwordx4 v46, s[20:23], s49 offen lds
    v_mfma_f32_16x16x32_bf16 v[68:71], a[212:215], a[100:103], v[68:71]
    ds_read_b64_tr_b16 a[176:177], v17 offset:32768
    ds_read_b64_tr_b16 a[178:179], v17 offset:36864
    v_mfma_f32_16x16x32_bf16 v[68:71], a[216:219], a[104:107], v[68:71]
    buffer_load_dwordx4 v47, s[20:23], s49 offen offset:1024 lds
    v_mfma_f32_16x16x32_bf16 v[68:71], a[220:223], a[108:111], v[68:71]
    ds_read_b64_tr_b16 a[180:181], v17 offset:40960
    ds_read_b64_tr_b16 a[182:183], v17 offset:45056
    v_mfma_f32_16x16x32_bf16 v[68:71], a[224:227], a[112:115], v[68:71]
    ds_read_b64_tr_b16 a[184:185], v17 offset:49152
    v_cvt_pk_bf16_f32 v224, v64, v65
    v_mfma_f32_16x16x32_bf16 v[68:71], a[228:231], a[116:119], v[68:71]
    ds_read_b64_tr_b16 a[186:187], v17 offset:53248
    v_cvt_pk_bf16_f32 v225, v66, v67
    v_mfma_f32_16x16x32_bf16 v[68:71], a[232:235], a[120:123], v[68:71]
    ds_read_b64_tr_b16 a[188:189], v17 offset:57344
    v_mfma_f32_16x16x32_bf16 v[68:71], a[236:239], a[124:127], v[68:71]
    s_waitcnt lgkmcnt(13)
    ds_read_b64_tr_b16 a[190:191], v17 offset:61440
    v_mfma_f32_16x16x32_bf16 v[72:75], a[160:163], a[64:67], v[72:75]
    s_waitcnt lgkmcnt(12)
    buffer_load_dwordx4 v48, s[20:23], s49 offen offset:2048 lds
    v_mfma_f32_16x16x32_bf16 v[72:75], a[164:167], a[68:71], v[72:75]
    s_waitcnt lgkmcnt(10)
    ds_read_b64_tr_b16 a[208:209], v14 offset:32768
    ds_read_b64_tr_b16 a[210:211], v14 offset:36864
    v_mfma_f32_16x16x32_bf16 v[72:75], a[168:171], a[72:75], v[72:75]
    s_waitcnt lgkmcnt(10)
    buffer_load_dwordx4 v49, s[20:23], s49 offen offset:3072 lds
    v_mfma_f32_16x16x32_bf16 v[72:75], a[172:175], a[76:79], v[72:75]
    s_waitcnt lgkmcnt(8)
    ds_read_b64_tr_b16 a[212:213], v14 offset:40960
    ds_read_b64_tr_b16 a[214:215], v14 offset:45056
    v_mfma_f32_16x16x32_bf16 v[72:75], a[176:179], a[80:83], v[72:75]
    s_waitcnt lgkmcnt(8)
    ds_read_b64_tr_b16 a[216:217], v14 offset:49152
    v_cvt_pk_bf16_f32 v228, v68, v69
    v_mfma_f32_16x16x32_bf16 v[72:75], a[180:183], a[84:87], v[72:75]
    s_waitcnt lgkmcnt(7)
    s_waitcnt vmcnt(19)
    ds_read_b64_tr_b16 a[218:219], v14 offset:53248
    v_cvt_pk_bf16_f32 v229, v70, v71
    v_mfma_f32_16x16x32_bf16 v[72:75], a[184:187], a[88:91], v[72:75]
    s_waitcnt lgkmcnt(6)
    s_and_b32 s42, s2, 7
    buffer_store_dword v10, v8, s[24:27], s92 offen sc1
    v_mfma_f32_16x16x32_bf16 v[72:75], a[188:191], a[92:95], v[72:75]
    s_mov_b64 s[20:21], s[52:53]
    s_add_u32 s92, s92, 4
    ds_read_b64_tr_b16 a[220:221], v14 offset:57344
    ds_read_b64_tr_b16 a[222:223], v14 offset:61440
    v_mfma_f32_16x16x32_bf16 v[76:79], a[160:163], a[96:99], v[76:79]
    s_mov_b32 s22, 1152
    ds_read_b64_tr_b16 a[224:225], v18 offset:32768
    s_waitcnt vmcnt(13)
    v_readfirstlane_b32 s37, v63
    v_mfma_f32_16x16x32_bf16 v[76:79], a[164:167], a[100:103], v[76:79]
    s_mov_b32 s23, 0x20000
    ds_read_b64_tr_b16 a[226:227], v18 offset:36864
    v_mfma_f32_16x16x32_bf16 v[76:79], a[168:171], a[104:107], v[76:79]
    ds_read_b64_tr_b16 a[228:229], v18 offset:40960
    s_cmp_lt_u32 s37, 256
    s_cbranch_scc1 Lattn_armwait
Lattn_armed:
    v_mfma_f32_16x16x32_bf16 v[76:79], a[172:175], a[108:111], v[76:79]
    ds_read_b64_tr_b16 a[230:231], v18 offset:45056
    v_mfma_f32_16x16x32_bf16 v[76:79], a[176:179], a[112:115], v[76:79]
    ds_read_b64_tr_b16 a[232:233], v18 offset:49152
    v_cvt_pk_bf16_f32 v226, v72, v73
    v_mfma_f32_16x16x32_bf16 v[76:79], a[180:183], a[116:119], v[76:79]
    s_add_u32 s38, s93, 1024
    ds_read_b64_tr_b16 a[234:235], v18 offset:53248
    v_cvt_pk_bf16_f32 v227, v74, v75
    v_mfma_f32_16x16x32_bf16 v[76:79], a[184:187], a[120:123], v[76:79]
    buffer_store_dwordx4 v[224:227], v56, s[28:31], s38 offen sc1
    v_mfma_f32_16x16x32_bf16 v[76:79], a[188:191], a[124:127], v[76:79]
    s_waitcnt lgkmcnt(12)
    s_mov_b32 s45, 18688
    ds_read_b64_tr_b16 a[236:237], v18 offset:57344
    ds_read_b64_tr_b16 a[238:239], v18 offset:61440
    v_mfma_f32_16x16x32_bf16 v[80:83], a[208:211], a[64:67], v[80:83]
    s_waitcnt lgkmcnt(12)
    buffer_load_dwordx4 v[192:195], v5, s[24:27], s45 offen offset:0 sc1
    v_mfma_f32_16x16x32_bf16 v[80:83], a[212:215], a[68:71], v[80:83]
    s_waitcnt lgkmcnt(10)
    ds_read_b64_tr_b16 a[160:161], v15 offset:32768
    ds_read_b64_tr_b16 a[162:163], v15 offset:36864
    v_mfma_f32_16x16x32_bf16 v[80:83], a[216:219], a[72:75], v[80:83]
    s_waitcnt lgkmcnt(10)
    ds_read_b64_tr_b16 a[164:165], v15 offset:40960
    v_mfma_f32_16x16x32_bf16 v[80:83], a[220:223], a[76:79], v[80:83]
    s_waitcnt lgkmcnt(9)
    ds_read_b64_tr_b16 a[166:167], v15 offset:45056
    v_mfma_f32_16x16x32_bf16 v[80:83], a[224:227], a[80:83], v[80:83]
    s_waitcnt lgkmcnt(8)
    ds_read_b64_tr_b16 a[168:169], v15 offset:49152
    v_cvt_pk_bf16_f32 v230, v76, v77
    v_mfma_f32_16x16x32_bf16 v[80:83], a[228:231], a[84:87], v[80:83]
    s_waitcnt lgkmcnt(7)
    s_add_u32 s38, s93, 164864
    ds_read_b64_tr_b16 a[170:171], v15 offset:53248
    v_cvt_pk_bf16_f32 v231, v78, v79
    v_mfma_f32_16x16x32_bf16 v[80:83], a[232:235], a[88:91], v[80:83]
    s_waitcnt lgkmcnt(6)
    buffer_store_dwordx4 v[228:231], v56, s[28:31], s38 offen sc1
    v_mfma_f32_16x16x32_bf16 v[80:83], a[236:239], a[92:95], v[80:83]
    ds_read_b64_tr_b16 a[172:173], v15 offset:57344
    ds_read_b64_tr_b16 a[174:175], v15 offset:61440
    v_mfma_f32_16x16x32_bf16 v[84:87], a[208:211], a[96:99], v[84:87]
    buffer_load_dwordx4 v[196:199], v5, s[24:27], s45 offen offset:512 sc1
    v_mfma_f32_16x16x32_bf16 v[84:87], a[212:215], a[100:103], v[84:87]
    ds_read_b64_tr_b16 a[176:177], v19 offset:32768
    ds_read_b64_tr_b16 a[178:179], v19 offset:36864
    v_mfma_f32_16x16x32_bf16 v[84:87], a[216:219], a[104:107], v[84:87]
    ds_read_b64_tr_b16 a[180:181], v19 offset:40960
    v_mfma_f32_16x16x32_bf16 v[84:87], a[220:223], a[108:111], v[84:87]
    ds_read_b64_tr_b16 a[182:183], v19 offset:45056
    v_mfma_f32_16x16x32_bf16 v[84:87], a[224:227], a[112:115], v[84:87]
    ds_read_b64_tr_b16 a[184:185], v19 offset:49152
    v_cvt_pk_bf16_f32 v232, v80, v81
    v_mfma_f32_16x16x32_bf16 v[84:87], a[228:231], a[116:119], v[84:87]
    ds_read_b64_tr_b16 a[186:187], v19 offset:53248
    v_cvt_pk_bf16_f32 v233, v82, v83
    v_mfma_f32_16x16x32_bf16 v[84:87], a[232:235], a[120:123], v[84:87]
    buffer_load_dwordx4 v[200:203], v59, s[24:27], s45 offen offset:1024 sc1
    v_mfma_f32_16x16x32_bf16 v[84:87], a[236:239], a[124:127], v[84:87]
    s_waitcnt lgkmcnt(12)
    ds_read_b64_tr_b16 a[188:189], v19 offset:57344
    ds_read_b64_tr_b16 a[190:191], v19 offset:61440
    s_barrier
    v_mfma_f32_16x16x32_bf16 v[88:91], a[160:163], a[64:67], v[88:91]
    s_waitcnt lgkmcnt(12)
    ds_read_b64_tr_b16 a[208:209], v20 offset:32768
    v_mfma_f32_16x16x32_bf16 v[88:91], a[164:167], a[68:71], v[88:91]
    s_waitcnt lgkmcnt(11)
    s_mov_b32 s45, 20992
    ds_read_b64_tr_b16 a[210:211], v20 offset:36864
    v_mfma_f32_16x16x32_bf16 v[88:91], a[168:171], a[72:75], v[88:91]
    s_waitcnt lgkmcnt(10)
    buffer_load_dwordx4 v[204:207], v5, s[24:27], s45 offen offset:0 sc1
    v_mfma_f32_16x16x32_bf16 v[88:91], a[172:175], a[76:79], v[88:91]
    s_waitcnt lgkmcnt(8)
    ds_read_b64_tr_b16 a[212:213], v20 offset:40960
    ds_read_b64_tr_b16 a[214:215], v20 offset:45056
    v_mfma_f32_16x16x32_bf16 v[88:91], a[176:179], a[80:83], v[88:91]
    s_waitcnt lgkmcnt(8)
    ds_read_b64_tr_b16 a[216:217], v20 offset:49152
    v_cvt_pk_bf16_f32 v236, v84, v85
    v_mfma_f32_16x16x32_bf16 v[88:91], a[180:183], a[84:87], v[88:91]
    s_waitcnt lgkmcnt(7)
    ds_read_b64_tr_b16 a[218:219], v20 offset:53248
    v_cvt_pk_bf16_f32 v237, v86, v87
    v_mfma_f32_16x16x32_bf16 v[88:91], a[184:187], a[88:91], v[88:91]
    s_waitcnt lgkmcnt(6)
    ds_read_b64_tr_b16 a[220:221], v20 offset:57344
    v_mfma_f32_16x16x32_bf16 v[88:91], a[188:191], a[92:95], v[88:91]
    ds_read_b64_tr_b16 a[222:223], v20 offset:61440
    v_mfma_f32_16x16x32_bf16 v[92:95], a[160:163], a[96:99], v[92:95]
    buffer_load_dwordx4 v[208:211], v5, s[24:27], s45 offen offset:512 sc1
    v_mfma_f32_16x16x32_bf16 v[92:95], a[164:167], a[100:103], v[92:95]
    ds_read_b64_tr_b16 a[224:225], v24 offset:32768
    ds_read_b64_tr_b16 a[226:227], v24 offset:36864
    v_mfma_f32_16x16x32_bf16 v[92:95], a[168:171], a[104:107], v[92:95]
    ds_read_b64_tr_b16 a[228:229], v24 offset:40960
    v_mfma_f32_16x16x32_bf16 v[92:95], a[172:175], a[108:111], v[92:95]
    ds_read_b64_tr_b16 a[230:231], v24 offset:45056
    v_mfma_f32_16x16x32_bf16 v[92:95], a[176:179], a[112:115], v[92:95]
    ds_read_b64_tr_b16 a[232:233], v24 offset:49152
    v_cvt_pk_bf16_f32 v234, v88, v89
    v_mfma_f32_16x16x32_bf16 v[92:95], a[180:183], a[116:119], v[92:95]
    s_add_u32 s38, s93, 1152
    ds_read_b64_tr_b16 a[234:235], v24 offset:53248
    v_cvt_pk_bf16_f32 v235, v90, v91
    v_mfma_f32_16x16x32_bf16 v[92:95], a[184:187], a[120:123], v[92:95]
    buffer_store_dwordx4 v[232:235], v56, s[28:31], s38 offen sc1
    v_mfma_f32_16x16x32_bf16 v[92:95], a[188:191], a[124:127], v[92:95]
    s_waitcnt lgkmcnt(12)
    ds_read_b64_tr_b16 a[236:237], v24 offset:57344
    ds_read_b64_tr_b16 a[238:239], v24 offset:61440
    v_mfma_f32_16x16x32_bf16 v[96:99], a[208:211], v[128:131], 0
    s_waitcnt lgkmcnt(12)
    buffer_load_dwordx4 v[212:215], v59, s[24:27], s45 offen offset:1024 sc1
    v_mfma_f32_16x16x32_bf16 v[96:99], a[212:215], v[132:135], v[96:99]
    s_waitcnt lgkmcnt(10)
    ds_read_b64_tr_b16 a[160:161], v21 offset:32768
    ds_read_b64_tr_b16 a[162:163], v21 offset:36864
    v_mfma_f32_16x16x32_bf16 v[96:99], a[216:219], v[136:139], v[96:99]
    s_waitcnt lgkmcnt(10)
    ds_read_b64_tr_b16 a[164:165], v21 offset:40960
    v_mfma_f32_16x16x32_bf16 v[96:99], a[220:223], v[140:143], v[96:99]
    s_waitcnt lgkmcnt(9)
    ds_read_b64_tr_b16 a[166:167], v21 offset:45056
    v_mfma_f32_16x16x32_bf16 v[96:99], a[224:227], v[144:147], v[96:99]
    s_waitcnt lgkmcnt(8)
    ds_read_b64_tr_b16 a[168:169], v21 offset:49152
    v_cvt_pk_bf16_f32 v238, v92, v93
    v_mfma_f32_16x16x32_bf16 v[96:99], a[228:231], v[148:151], v[96:99]
    s_waitcnt lgkmcnt(7)
    s_add_u32 s38, s93, 164992
    ds_read_b64_tr_b16 a[170:171], v21 offset:53248
    v_cvt_pk_bf16_f32 v239, v94, v95
    v_mfma_f32_16x16x32_bf16 v[96:99], a[232:235], v[152:155], v[96:99]
    s_waitcnt lgkmcnt(6)
    buffer_store_dwordx4 v[236:239], v56, s[28:31], s38 offen sc1
    v_mfma_f32_16x16x32_bf16 v[96:99], a[236:239], v[156:159], v[96:99]
    s_mov_b32 s45, 19840
    ds_read_b64_tr_b16 a[172:173], v21 offset:57344
    ds_read_b64_tr_b16 a[174:175], v21 offset:61440
    v_mfma_f32_16x16x32_bf16 v[100:103], a[208:211], v[160:163], 0
    buffer_load_dwordx4 v[64:67], v5, s[24:27], s45 offen offset:0 sc1
    v_mfma_f32_16x16x32_bf16 v[100:103], a[212:215], v[164:167], v[100:103]
    ds_read_b64_tr_b16 a[176:177], v25 offset:32768
    ds_read_b64_tr_b16 a[178:179], v25 offset:36864
    v_mfma_f32_16x16x32_bf16 v[100:103], a[216:219], v[168:171], v[100:103]
    ds_read_b64_tr_b16 a[180:181], v25 offset:40960
    v_mfma_f32_16x16x32_bf16 v[100:103], a[220:223], v[172:175], v[100:103]
    ds_read_b64_tr_b16 a[182:183], v25 offset:45056
    v_mfma_f32_16x16x32_bf16 v[100:103], a[224:227], v[176:179], v[100:103]
    buffer_load_dwordx4 v[68:71], v5, s[24:27], s45 offen offset:512 sc1
    v_mfma_f32_16x16x32_bf16 v[100:103], a[228:231], v[180:183], v[100:103]
    ds_read_b64_tr_b16 a[184:185], v25 offset:49152
    ds_read_b64_tr_b16 a[186:187], v25 offset:53248
    v_mfma_f32_16x16x32_bf16 v[100:103], a[232:235], v[184:187], v[100:103]
    ds_read_b64_tr_b16 a[188:189], v25 offset:57344
    v_mfma_f32_16x16x32_bf16 v[100:103], a[236:239], v[188:191], v[100:103]
    s_waitcnt lgkmcnt(13)
    ds_read_b64_tr_b16 a[190:191], v25 offset:61440
    v_mfma_f32_16x16x32_bf16 v[104:107], a[160:163], v[128:131], 0
    s_waitcnt lgkmcnt(12)
    ds_read_b64_tr_b16 a[208:209], v22 offset:32768
    v_mfma_f32_16x16x32_bf16 v[104:107], a[164:167], v[132:135], v[104:107]
    s_waitcnt lgkmcnt(11)
    ds_read_b64_tr_b16 a[210:211], v22 offset:36864
    v_mfma_f32_16x16x32_bf16 v[104:107], a[168:171], v[136:139], v[104:107]
    s_waitcnt lgkmcnt(10)
    buffer_load_dwordx4 v[72:75], v59, s[24:27], s45 offen offset:1024 sc1
    v_mfma_f32_16x16x32_bf16 v[104:107], a[172:175], v[140:143], v[104:107]
    s_waitcnt lgkmcnt(8)
    ds_read_b64_tr_b16 a[212:213], v22 offset:40960
    ds_read_b64_tr_b16 a[214:215], v22 offset:45056
    v_mfma_f32_16x16x32_bf16 v[104:107], a[176:179], v[144:147], v[104:107]
    s_waitcnt lgkmcnt(8)
    ds_read_b64_tr_b16 a[216:217], v22 offset:49152
    v_mfma_f32_16x16x32_bf16 v[104:107], a[180:183], v[148:151], v[104:107]
    s_waitcnt lgkmcnt(7)
    ds_read_b64_tr_b16 a[218:219], v22 offset:53248
    v_mfma_f32_16x16x32_bf16 v[104:107], a[184:187], v[152:155], v[104:107]
    s_waitcnt lgkmcnt(6)
    ds_read_b64_tr_b16 a[220:221], v22 offset:57344
    v_mfma_f32_16x16x32_bf16 v[104:107], a[188:191], v[156:159], v[104:107]
    ds_read_b64_tr_b16 a[222:223], v22 offset:61440
    v_mfma_f32_16x16x32_bf16 v[108:111], a[160:163], v[160:163], 0
    buffer_load_dwordx2 v[76:77], v3, s[20:23], 0 offen offset:0
    v_mfma_f32_16x16x32_bf16 v[108:111], a[164:167], v[164:167], v[108:111]
    ds_read_b64_tr_b16 a[224:225], v26 offset:32768
    ds_read_b64_tr_b16 a[226:227], v26 offset:36864
    v_mfma_f32_16x16x32_bf16 v[108:111], a[168:171], v[168:171], v[108:111]
    ds_read_b64_tr_b16 a[228:229], v26 offset:40960
    v_mfma_f32_16x16x32_bf16 v[108:111], a[172:175], v[172:175], v[108:111]
    ds_read_b64_tr_b16 a[230:231], v26 offset:45056
    v_mfma_f32_16x16x32_bf16 v[108:111], a[176:179], v[176:179], v[108:111]
    ds_read_b64_tr_b16 a[232:233], v26 offset:49152
    v_mfma_f32_16x16x32_bf16 v[108:111], a[180:183], v[180:183], v[108:111]
    ds_read_b64_tr_b16 a[234:235], v26 offset:53248
    v_mfma_f32_16x16x32_bf16 v[108:111], a[184:187], v[184:187], v[108:111]
    buffer_load_dwordx2 v[78:79], v3, s[20:23], 0 offen offset:32
    v_mfma_f32_16x16x32_bf16 v[108:111], a[188:191], v[188:191], v[108:111]
    s_waitcnt lgkmcnt(12)
    ds_read_b64_tr_b16 a[236:237], v26 offset:57344
    ds_read_b64_tr_b16 a[238:239], v26 offset:61440
    v_mfma_f32_16x16x32_bf16 v[112:115], a[208:211], v[128:131], 0
    s_waitcnt lgkmcnt(12)
    ds_read_b64_tr_b16 a[160:161], v23 offset:32768
    v_mfma_f32_16x16x32_bf16 v[112:115], a[212:215], v[132:135], v[112:115]
    s_waitcnt lgkmcnt(11)
    ds_read_b64_tr_b16 a[162:163], v23 offset:36864
    v_mfma_f32_16x16x32_bf16 v[112:115], a[216:219], v[136:139], v[112:115]
    s_waitcnt lgkmcnt(10)
    ds_read_b64_tr_b16 a[164:165], v23 offset:40960
    v_mfma_f32_16x16x32_bf16 v[112:115], a[220:223], v[140:143], v[112:115]
    s_waitcnt lgkmcnt(9)
    ds_read_b64_tr_b16 a[166:167], v23 offset:45056
    v_mfma_f32_16x16x32_bf16 v[112:115], a[224:227], v[144:147], v[112:115]
    s_waitcnt lgkmcnt(8)
    buffer_load_dwordx2 v[80:81], v3, s[20:23], 0 offen offset:512
    v_mfma_f32_16x16x32_bf16 v[112:115], a[228:231], v[148:151], v[112:115]
    s_waitcnt lgkmcnt(6)
    ds_read_b64_tr_b16 a[168:169], v23 offset:49152
    ds_read_b64_tr_b16 a[170:171], v23 offset:53248
    v_mfma_f32_16x16x32_bf16 v[112:115], a[232:235], v[152:155], v[112:115]
    s_waitcnt lgkmcnt(6)
    ds_read_b64_tr_b16 a[172:173], v23 offset:57344
    v_mfma_f32_16x16x32_bf16 v[112:115], a[236:239], v[156:159], v[112:115]
    ds_read_b64_tr_b16 a[174:175], v23 offset:61440
    v_mfma_f32_16x16x32_bf16 v[116:119], a[208:211], v[160:163], 0
    ds_read_b64_tr_b16 a[176:177], v27 offset:32768
    v_mfma_f32_16x16x32_bf16 v[116:119], a[212:215], v[164:167], v[116:119]
    ds_read_b64_tr_b16 a[178:179], v27 offset:36864
    v_mfma_f32_16x16x32_bf16 v[116:119], a[216:219], v[168:171], v[116:119]
    buffer_load_dwordx2 v[82:83], v3, s[20:23], 0 offen offset:544
    v_mfma_f32_16x16x32_bf16 v[116:119], a[220:223], v[172:175], v[116:119]
    ds_read_b64_tr_b16 a[180:181], v27 offset:40960
    ds_read_b64_tr_b16 a[182:183], v27 offset:45056
    v_mfma_f32_16x16x32_bf16 v[116:119], a[224:227], v[176:179], v[116:119]
    ds_read_b64_tr_b16 a[184:185], v27 offset:49152
    v_mfma_f32_16x16x32_bf16 v[116:119], a[228:231], v[180:183], v[116:119]
    ds_read_b64_tr_b16 a[186:187], v27 offset:53248
    v_mfma_f32_16x16x32_bf16 v[116:119], a[232:235], v[184:187], v[116:119]
    buffer_load_dwordx2 v[84:85], v55, s[20:23], 0 offen offset:1024
    v_mfma_f32_16x16x32_bf16 v[116:119], a[236:239], v[188:191], v[116:119]
    ds_read_b64_tr_b16 a[188:189], v27 offset:57344
    ds_read_b64_tr_b16 a[190:191], v27 offset:61440
    s_waitcnt vmcnt(19)
    s_waitcnt lgkmcnt(0)
    s_barrier
    v_mfma_f32_16x16x32_bf16 v[120:123], a[160:163], v[128:131], 0
    ds_read_b64_tr_b16 a[208:209], v12 offset:0
    v_mfma_f32_16x16x32_bf16 v[120:123], a[164:167], v[132:135], v[120:123]
    ds_read_b64_tr_b16 a[210:211], v12 offset:4096
    v_mfma_f32_16x16x32_bf16 v[120:123], a[168:171], v[136:139], v[120:123]
    ds_read_b64_tr_b16 a[212:213], v12 offset:8192
    v_mfma_f32_16x16x32_bf16 v[120:123], a[172:175], v[140:143], v[120:123]
    ds_read_b64_tr_b16 a[214:215], v12 offset:12288
    v_mfma_f32_16x16x32_bf16 v[120:123], a[176:179], v[144:147], v[120:123]
    buffer_load_dwordx2 v[86:87], v55, s[20:23], 0 offen offset:1056
    v_mfma_f32_16x16x32_bf16 v[120:123], a[180:183], v[148:151], v[120:123]
    ds_read_b64_tr_b16 a[216:217], v12 offset:16384
    ds_read_b64_tr_b16 a[218:219], v12 offset:20480
    v_mfma_f32_16x16x32_bf16 v[120:123], a[184:187], v[152:155], v[120:123]
    ds_read_b64_tr_b16 a[220:221], v12 offset:24576
    v_mfma_f32_16x16x32_bf16 v[120:123], a[188:191], v[156:159], v[120:123]
    ds_read_b64_tr_b16 a[222:223], v12 offset:28672
    v_mfma_f32_16x16x32_bf16 v[124:127], a[160:163], v[160:163], 0
    ds_read_b64_tr_b16 a[224:225], v16 offset:0
    v_mfma_f32_16x16x32_bf16 v[124:127], a[164:167], v[164:167], v[124:127]
    s_mov_b32 s45, 22144
    ds_read_b64_tr_b16 a[226:227], v16 offset:4096
    v_mfma_f32_16x16x32_bf16 v[124:127], a[168:171], v[168:171], v[124:127]
    buffer_load_dwordx4 v[216:219], v5, s[24:27], s45 offen offset:0 sc1
    v_mfma_f32_16x16x32_bf16 v[124:127], a[172:175], v[172:175], v[124:127]
    ds_read_b64_tr_b16 a[228:229], v16 offset:8192
    ds_read_b64_tr_b16 a[230:231], v16 offset:12288
    v_mfma_f32_16x16x32_bf16 v[124:127], a[176:179], v[176:179], v[124:127]
    ds_read_b64_tr_b16 a[232:233], v16 offset:16384
    v_mfma_f32_16x16x32_bf16 v[124:127], a[180:183], v[180:183], v[124:127]
    ds_read_b64_tr_b16 a[234:235], v16 offset:20480
    v_mfma_f32_16x16x32_bf16 v[124:127], a[184:187], v[184:187], v[124:127]
    ds_read_b64_tr_b16 a[236:237], v16 offset:24576
    v_mfma_f32_16x16x32_bf16 v[124:127], a[188:191], v[188:191], v[124:127]
    s_waitcnt lgkmcnt(13)
    ds_read_b64_tr_b16 a[238:239], v16 offset:28672
    v_mfma_f32_16x16x32_bf16 v[96:99], a[208:211], a[64:67], v[96:99]
    s_waitcnt lgkmcnt(12)
    buffer_load_dwordx4 v[220:223], v5, s[24:27], s45 offen offset:512 sc1
    v_mfma_f32_16x16x32_bf16 v[96:99], a[212:215], a[68:71], v[96:99]
    s_waitcnt lgkmcnt(10)
    ds_read_b64_tr_b16 a[160:161], v13 offset:0
    ds_read_b64_tr_b16 a[162:163], v13 offset:4096
    v_mfma_f32_16x16x32_bf16 v[96:99], a[216:219], a[72:75], v[96:99]
    s_waitcnt lgkmcnt(10)
    ds_read_b64_tr_b16 a[164:165], v13 offset:8192
    v_mfma_f32_16x16x32_bf16 v[96:99], a[220:223], a[76:79], v[96:99]
    s_waitcnt lgkmcnt(9)
    ds_read_b64_tr_b16 a[166:167], v13 offset:12288
    v_mfma_f32_16x16x32_bf16 v[96:99], a[224:227], a[80:83], v[96:99]
    s_waitcnt lgkmcnt(8)
    ds_read_b64_tr_b16 a[168:169], v13 offset:16384
    v_mfma_f32_16x16x32_bf16 v[96:99], a[228:231], a[84:87], v[96:99]
    s_waitcnt lgkmcnt(7)
    ds_read_b64_tr_b16 a[170:171], v13 offset:20480
    v_mfma_f32_16x16x32_bf16 v[96:99], a[232:235], a[88:91], v[96:99]
    s_waitcnt lgkmcnt(6)
    buffer_load_dwordx4 v[88:91], v59, s[24:27], s45 offen offset:1024 sc1
    v_mfma_f32_16x16x32_bf16 v[96:99], a[236:239], a[92:95], v[96:99]
    ds_read_b64_tr_b16 a[172:173], v13 offset:24576
    ds_read_b64_tr_b16 a[174:175], v13 offset:28672
    v_mfma_f32_16x16x32_bf16 v[100:103], a[208:211], a[96:99], v[100:103]
    buffer_load_dword v11, v9, s[24:27], s39 offen sc1
    v_mfma_f32_16x16x32_bf16 v[100:103], a[212:215], a[100:103], v[100:103]
    ds_read_b64_tr_b16 a[176:177], v17 offset:0
    ds_read_b64_tr_b16 a[178:179], v17 offset:4096
    v_mfma_f32_16x16x32_bf16 v[100:103], a[216:219], a[104:107], v[100:103]
    ds_read_b64_tr_b16 a[180:181], v17 offset:8192
    v_mfma_f32_16x16x32_bf16 v[100:103], a[220:223], a[108:111], v[100:103]
    ds_read_b64_tr_b16 a[182:183], v17 offset:12288
    v_mfma_f32_16x16x32_bf16 v[100:103], a[224:227], a[112:115], v[100:103]
    ds_read_b64_tr_b16 a[184:185], v17 offset:16384
    v_cvt_pk_bf16_f32 v224, v96, v97
    v_mfma_f32_16x16x32_bf16 v[100:103], a[228:231], a[116:119], v[100:103]
    ds_read_b64_tr_b16 a[186:187], v17 offset:20480
    v_cvt_pk_bf16_f32 v225, v98, v99
    v_mfma_f32_16x16x32_bf16 v[100:103], a[232:235], a[120:123], v[100:103]
    ds_read_b64_tr_b16 a[188:189], v17 offset:24576
    v_mfma_f32_16x16x32_bf16 v[100:103], a[236:239], a[124:127], v[100:103]
    s_waitcnt lgkmcnt(13)
    ds_read_b64_tr_b16 a[190:191], v17 offset:28672
    v_mfma_f32_16x16x32_bf16 v[104:107], a[160:163], a[64:67], v[104:107]
    s_waitcnt lgkmcnt(12)
    ds_read_b64_tr_b16 a[208:209], v14 offset:0
    v_mfma_f32_16x16x32_bf16 v[104:107], a[164:167], a[68:71], v[104:107]
    s_waitcnt lgkmcnt(11)
    ds_read_b64_tr_b16 a[210:211], v14 offset:4096
    v_mfma_f32_16x16x32_bf16 v[104:107], a[168:171], a[72:75], v[104:107]
    s_waitcnt lgkmcnt(10)
    ds_read_b64_tr_b16 a[212:213], v14 offset:8192
    v_mfma_f32_16x16x32_bf16 v[104:107], a[172:175], a[76:79], v[104:107]
    s_waitcnt lgkmcnt(9)
    ds_read_b64_tr_b16 a[214:215], v14 offset:12288
    v_mfma_f32_16x16x32_bf16 v[104:107], a[176:179], a[80:83], v[104:107]
    s_waitcnt lgkmcnt(8)
    ds_read_b64_tr_b16 a[216:217], v14 offset:16384
    v_cvt_pk_bf16_f32 v228, v100, v101
    v_mfma_f32_16x16x32_bf16 v[104:107], a[180:183], a[84:87], v[104:107]
    s_waitcnt lgkmcnt(7)
    ds_read_b64_tr_b16 a[218:219], v14 offset:20480
    v_cvt_pk_bf16_f32 v229, v102, v103
    v_mfma_f32_16x16x32_bf16 v[104:107], a[184:187], a[88:91], v[104:107]
    s_waitcnt lgkmcnt(6)
    ds_read_b64_tr_b16 a[220:221], v14 offset:24576
    v_mfma_f32_16x16x32_bf16 v[104:107], a[188:191], a[92:95], v[104:107]
    ds_read_b64_tr_b16 a[222:223], v14 offset:28672
    v_mfma_f32_16x16x32_bf16 v[108:111], a[160:163], a[96:99], v[108:111]
    ds_read_b64_tr_b16 a[224:225], v18 offset:0
    v_mfma_f32_16x16x32_bf16 v[108:111], a[164:167], a[100:103], v[108:111]
    ds_read_b64_tr_b16 a[226:227], v18 offset:4096
    v_mfma_f32_16x16x32_bf16 v[108:111], a[168:171], a[104:107], v[108:111]
    ds_read_b64_tr_b16 a[228:229], v18 offset:8192
    v_mfma_f32_16x16x32_bf16 v[108:111], a[172:175], a[108:111], v[108:111]
    ds_read_b64_tr_b16 a[230:231], v18 offset:12288
    v_mfma_f32_16x16x32_bf16 v[108:111], a[176:179], a[112:115], v[108:111]
    ds_read_b64_tr_b16 a[232:233], v18 offset:16384
    v_cvt_pk_bf16_f32 v226, v104, v105
    v_mfma_f32_16x16x32_bf16 v[108:111], a[180:183], a[116:119], v[108:111]
    s_add_u32 s38, s93, 1536
    ds_read_b64_tr_b16 a[234:235], v18 offset:20480
    v_cvt_pk_bf16_f32 v227, v106, v107
    v_mfma_f32_16x16x32_bf16 v[108:111], a[184:187], a[120:123], v[108:111]
    buffer_store_dwordx4 v[224:227], v56, s[28:31], s38 offen sc1
    v_mfma_f32_16x16x32_bf16 v[108:111], a[188:191], a[124:127], v[108:111]
    s_waitcnt lgkmcnt(12)
    ds_read_b64_tr_b16 a[236:237], v18 offset:24576
    ds_read_b64_tr_b16 a[238:239], v18 offset:28672
    v_mfma_f32_16x16x32_bf16 v[112:115], a[208:211], a[64:67], v[112:115]
    s_waitcnt lgkmcnt(12)
    ds_read_b64_tr_b16 a[160:161], v15 offset:0
    v_mfma_f32_16x16x32_bf16 v[112:115], a[212:215], a[68:71], v[112:115]
    s_waitcnt lgkmcnt(11)
    ds_read_b64_tr_b16 a[162:163], v15 offset:4096
    v_mfma_f32_16x16x32_bf16 v[112:115], a[216:219], a[72:75], v[112:115]
    s_waitcnt lgkmcnt(10)
    ds_read_b64_tr_b16 a[164:165], v15 offset:8192
    v_mfma_f32_16x16x32_bf16 v[112:115], a[220:223], a[76:79], v[112:115]
    s_waitcnt lgkmcnt(9)
    ds_read_b64_tr_b16 a[166:167], v15 offset:12288
    v_mfma_f32_16x16x32_bf16 v[112:115], a[224:227], a[80:83], v[112:115]
Ltour11:
    s_cbranch_execz Ltour15
    s_waitcnt lgkmcnt(8)
    ds_read_b64_tr_b16 a[168:169], v15 offset:16384
    v_cvt_pk_bf16_f32 v230, v108, v109
    v_mfma_f32_16x16x32_bf16 v[112:115], a[228:231], a[84:87], v[112:115]
    s_waitcnt lgkmcnt(7)
    s_add_u32 s38, s93, 165376
    ds_read_b64_tr_b16 a[170:171], v15 offset:20480
    v_cvt_pk_bf16_f32 v231, v110, v111
    v_mfma_f32_16x16x32_bf16 v[112:115], a[232:235], a[88:91], v[112:115]
    s_waitcnt lgkmcnt(6)
    buffer_store_dwordx4 v[228:231], v56, s[28:31], s38 offen sc1
    v_mfma_f32_16x16x32_bf16 v[112:115], a[236:239], a[92:95], v[112:115]
    ds_read_b64_tr_b16 a[172:173], v15 offset:24576
    ds_read_b64_tr_b16 a[174:175], v15 offset:28672
    v_mfma_f32_16x16x32_bf16 v[116:119], a[208:211], a[96:99], v[116:119]
    ds_read_b64_tr_b16 a[176:177], v19 offset:0
    v_mfma_f32_16x16x32_bf16 v[116:119], a[212:215], a[100:103], v[116:119]
    ds_read_b64_tr_b16 a[178:179], v19 offset:4096
    v_mfma_f32_16x16x32_bf16 v[116:119], a[216:219], a[104:107], v[116:119]
    ds_read_b64_tr_b16 a[180:181], v19 offset:8192
    v_mfma_f32_16x16x32_bf16 v[116:119], a[220:223], a[108:111], v[116:119]
    ds_read_b64_tr_b16 a[182:183], v19 offset:12288
    v_mfma_f32_16x16x32_bf16 v[116:119], a[224:227], a[112:115], v[116:119]
    ds_read_b64_tr_b16 a[184:185], v19 offset:16384
    v_cvt_pk_bf16_f32 v232, v112, v113
    v_mfma_f32_16x16x32_bf16 v[116:119], a[228:231], a[116:119], v[116:119]
    ds_read_b64_tr_b16 a[186:187], v19 offset:20480
    v_cvt_pk_bf16_f32 v233, v114, v115
    v_mfma_f32_16x16x32_bf16 v[116:119], a[232:235], a[120:123], v[116:119]
    ds_read_b64_tr_b16 a[188:189], v19 offset:24576
    v_mfma_f32_16x16x32_bf16 v[116:119], a[236:239], a[124:127], v[116:119]
    s_waitcnt lgkmcnt(13)
    ds_read_b64_tr_b16 a[190:191], v19 offset:28672
    v_mfma_f32_16x16x32_bf16 v[120:123], a[160:163], a[64:67], v[120:123]
    s_waitcnt lgkmcnt(12)
    v_mfma_f32_16x16x32_bf16 v[120:123], a[164:167], a[68:71], v[120:123]
    s_waitcnt lgkmcnt(10)
    v_mfma_f32_16x16x32_bf16 v[120:123], a[168:171], a[72:75], v[120:123]
    s_waitcnt lgkmcnt(8)
    v_mfma_f32_16x16x32_bf16 v[120:123], a[172:175], a[76:79], v[120:123]
    s_waitcnt lgkmcnt(6)
    v_mfma_f32_16x16x32_bf16 v[120:123], a[176:179], a[80:83], v[120:123]
    s_waitcnt lgkmcnt(4)
    v_cvt_pk_bf16_f32 v236, v116, v117
    v_mfma_f32_16x16x32_bf16 v[120:123], a[180:183], a[84:87], v[120:123]
    s_waitcnt lgkmcnt(2)
    v_cvt_pk_bf16_f32 v237, v118, v119
    v_mfma_f32_16x16x32_bf16 v[120:123], a[184:187], a[88:91], v[120:123]
    s_waitcnt lgkmcnt(0)
    v_mfma_f32_16x16x32_bf16 v[120:123], a[188:191], a[92:95], v[120:123]
    v_mfma_f32_16x16x32_bf16 v[124:127], a[160:163], a[96:99], v[124:127]
    v_mfma_f32_16x16x32_bf16 v[124:127], a[164:167], a[100:103], v[124:127]
    v_mfma_f32_16x16x32_bf16 v[124:127], a[168:171], a[104:107], v[124:127]
    v_mfma_f32_16x16x32_bf16 v[124:127], a[172:175], a[108:111], v[124:127]
    v_mfma_f32_16x16x32_bf16 v[124:127], a[176:179], a[112:115], v[124:127]
    s_nop 2
    v_cvt_pk_bf16_f32 v234, v120, v121
    v_mfma_f32_16x16x32_bf16 v[124:127], a[180:183], a[116:119], v[124:127]
    s_add_u32 s38, s93, 1664
    v_cvt_pk_bf16_f32 v235, v122, v123
    v_mfma_f32_16x16x32_bf16 v[124:127], a[184:187], a[120:123], v[124:127]
    buffer_store_dwordx4 v[232:235], v56, s[28:31], s38 offen sc1
    v_mfma_f32_16x16x32_bf16 v[124:127], a[188:191], a[124:127], v[124:127]
    s_nop 7
    v_cvt_pk_bf16_f32 v238, v124, v125
    s_add_u32 s38, s93, 165504
    v_cvt_pk_bf16_f32 v239, v126, v127
    buffer_store_dwordx4 v[236:239], v56, s[28:31], s38 offen sc1
    s_waitcnt vmcnt(16)
    v_lshlrev_b32 v144, 16, v64
    v_and_b32 v145, 0xffff0000, v64
    v_lshlrev_b32 v146, 16, v65
    v_and_b32 v147, 0xffff0000, v65
    v_lshlrev_b32 v148, 16, v66
    v_and_b32 v149, 0xffff0000, v66
    v_lshlrev_b32 v150, 16, v67
    v_and_b32 v151, 0xffff0000, v67
    s_waitcnt vmcnt(15)
    v_lshlrev_b32 v152, 16, v68
    v_and_b32 v153, 0xffff0000, v68
    v_lshlrev_b32 v154, 16, v69
    v_and_b32 v155, 0xffff0000, v69
    v_lshlrev_b32 v156, 16, v70
    v_and_b32 v157, 0xffff0000, v70
    v_lshlrev_b32 v158, 16, v71
    v_and_b32 v159, 0xffff0000, v71
    s_waitcnt vmcnt(14)
    v_lshlrev_b32 v160, 16, v72
    v_and_b32 v161, 0xffff0000, v72
    v_lshlrev_b32 v162, 16, v73
    v_and_b32 v163, 0xffff0000, v73
    v_lshlrev_b32 v164, 16, v74
    v_and_b32 v165, 0xffff0000, v74
    v_lshlrev_b32 v166, 16, v75
    v_and_b32 v167, 0xffff0000, v75
    s_waitcnt vmcnt(13)
    v_lshlrev_b32 v168, 16, v76
    v_and_b32 v169, 0xffff0000, v76
    v_lshlrev_b32 v170, 16, v77
    v_and_b32 v171, 0xffff0000, v77
    s_waitcnt vmcnt(12)
    v_lshlrev_b32 v172, 16, v78
    v_and_b32 v173, 0xffff0000, v78
    v_lshlrev_b32 v174, 16, v79
    v_and_b32 v175, 0xffff0000, v79
    s_waitcnt vmcnt(11)
    v_lshlrev_b32 v176, 16, v80
    v_and_b32 v177, 0xffff0000, v80
    v_lshlrev_b32 v178, 16, v81
    v_and_b32 v179, 0xffff0000, v81
    s_waitcnt vmcnt(10)
    v_lshlrev_b32 v180, 16, v82
    v_and_b32 v181, 0xffff0000, v82
    v_lshlrev_b32 v182, 16, v83
    v_and_b32 v183, 0xffff0000, v83
    s_waitcnt vmcnt(9)
    v_lshlrev_b32 v184, 16, v84
    v_and_b32 v185, 0xffff0000, v84
    v_lshlrev_b32 v186, 16, v85
    v_and_b32 v187, 0xffff0000, v85
    s_waitcnt vmcnt(8)
    v_lshlrev_b32 v188, 16, v86
    v_and_b32 v189, 0xffff0000, v86
    v_lshlrev_b32 v190, 16, v87
    v_and_b32 v191, 0xffff0000, v87
    v_lshlrev_b32 v12, 16, v36
    v_and_b32 v13, 0xffff0000, v36
    v_lshlrev_b32 v14, 16, v37
    v_and_b32 v15, 0xffff0000, v37
    v_lshlrev_b32 v16, 16, v38
    v_and_b32 v17, 0xffff0000, v38
    v_lshlrev_b32 v18, 16, v39
    v_and_b32 v19, 0xffff0000, v39
    v_lshlrev_b32 v20, 16, v40
    v_and_b32 v21, 0xffff0000, v40
    v_lshlrev_b32 v22, 16, v41
    v_and_b32 v23, 0xffff0000, v41
    v_lshlrev_b32 v24, 16, v42
    v_and_b32 v25, 0xffff0000, v42
    v_lshlrev_b32 v26, 16, v43
    v_and_b32 v27, 0xffff0000, v43
    v_lshlrev_b32 v28, 16, v244
    v_and_b32 v29, 0xffff0000, v244
    v_lshlrev_b32 v30, 16, v245
    v_and_b32 v31, 0xffff0000, v245
    v_lshlrev_b32 v32, 16, v246
    v_and_b32 v33, 0xffff0000, v246
    v_lshlrev_b32 v34, 16, v247
    v_and_b32 v35, 0xffff0000, v247
    v_lshlrev_b32 v96, 16, v192
    v_and_b32 v97, 0xffff0000, v192
    v_lshlrev_b32 v98, 16, v193
    v_and_b32 v99, 0xffff0000, v193
    v_lshlrev_b32 v100, 16, v194
    v_and_b32 v101, 0xffff0000, v194
    v_lshlrev_b32 v102, 16, v195
    v_and_b32 v103, 0xffff0000, v195
    v_lshlrev_b32 v104, 16, v196
    v_and_b32 v105, 0xffff0000, v196
    v_lshlrev_b32 v106, 16, v197
    v_and_b32 v107, 0xffff0000, v197
    v_lshlrev_b32 v108, 16, v198
    v_and_b32 v109, 0xffff0000, v198
    v_lshlrev_b32 v110, 16, v199
    v_and_b32 v111, 0xffff0000, v199
    v_lshlrev_b32 v112, 16, v200
    v_and_b32 v113, 0xffff0000, v200
    v_lshlrev_b32 v114, 16, v201
    v_and_b32 v115, 0xffff0000, v201
    v_lshlrev_b32 v116, 16, v202
    v_and_b32 v117, 0xffff0000, v202
    v_lshlrev_b32 v118, 16, v203
    v_and_b32 v119, 0xffff0000, v203
    v_mov_b32 v244, 0
    v_mov_b32 v245, 0
    s_waitcnt vmcnt(0)
    buffer_store_dword v10, v8, s[24:27], s92 offen sc1
    v_cmp_ne_u32 s[54:55], s95, v11
    s_cmp_lg_u64 s[54:55], 0
    s_cbranch_scc1 Ltail_spin1
Ltail_got1:
    s_add_u32 s39, s39, 4
    s_add_u32 s45, s44, 0
    buffer_load_dwordx4 a[0:3], v2, s[28:31], s45 offen offset:0 sc1
    buffer_load_dwordx4 a[4:7], v2, s[28:31], s45 offen offset:2048 sc1
    s_add_u32 s45, s44, 4096
    buffer_load_dwordx4 a[8:11], v2, s[28:31], s45 offen offset:0 sc1
    buffer_load_dwordx4 a[12:15], v2, s[28:31], s45 offen offset:2048 sc1
    s_add_u32 s45, s44, 8192
    buffer_load_dwordx4 a[16:19], v2, s[28:31], s45 offen offset:0 sc1
    buffer_load_dwordx4 a[20:23], v2, s[28:31], s45 offen offset:2048 sc1
    s_add_u32 s45, s44, 12288
    buffer_load_dwordx4 a[24:27], v2, s[28:31], s45 offen offset:0 sc1
    buffer_load_dwordx4 a[28:31], v2, s[28:31], s45 offen offset:2048 sc1
    ds_write_b128 v51, a[128:131] offset:0
    ds_write_b128 v51, a[132:135] offset:4096
    ds_write_b128 v51, a[136:139] offset:8192
    ds_write_b128 v51, a[140:143] offset:12288
    ds_write_b128 v51, a[144:147] offset:16384
    ds_write_b128 v51, a[148:151] offset:20480
    ds_write_b128 v51, a[152:155] offset:24576
    ds_write_b128 v51, a[156:159] offset:28672
    ds_write_b128 v51, a[240:243] offset:32768
    ds_write_b128 v255, a[244:247] offset:40960
    ds_write_b128 v255, a[248:251] offset:45056
    ds_write_b128 v255, a[252:255] offset:49152
    v_lshlrev_b32 v120, 16, v204
    v_and_b32 v121, 0xffff0000, v204
    v_lshlrev_b32 v122, 16, v205
    v_and_b32 v123, 0xffff0000, v205
    v_lshlrev_b32 v124, 16, v206
    v_and_b32 v125, 0xffff0000, v206
    v_lshlrev_b32 v126, 16, v207
    v_and_b32 v127, 0xffff0000, v207
    v_lshlrev_b32 v128, 16, v208
    v_and_b32 v129, 0xffff0000, v208
    v_lshlrev_b32 v130, 16, v209
    v_and_b32 v131, 0xffff0000, v209
    v_lshlrev_b32 v132, 16, v210
    v_and_b32 v133, 0xffff0000, v210
    v_lshlrev_b32 v134, 16, v211
    v_and_b32 v135, 0xffff0000, v211
    v_lshlrev_b32 v136, 16, v212
    v_and_b32 v137, 0xffff0000, v212
    v_lshlrev_b32 v138, 16, v213
    v_and_b32 v139, 0xffff0000, v213
    v_lshlrev_b32 v140, 16, v214
    v_and_b32 v141, 0xffff0000, v214
    v_lshlrev_b32 v142, 16, v215
    v_and_b32 v143, 0xffff0000, v215
    v_lshlrev_b32 v192, 16, v216
    v_and_b32 v193, 0xffff0000, v216
    v_lshlrev_b32 v194, 16, v217
    v_and_b32 v195, 0xffff0000, v217
    v_lshlrev_b32 v196, 16, v218
    v_and_b32 v197, 0xffff0000, v218
    v_lshlrev_b32 v198, 16, v219
    v_and_b32 v199, 0xffff0000, v219
    v_lshlrev_b32 v200, 16, v220
    v_and_b32 v201, 0xffff0000, v220
    v_lshlrev_b32 v202, 16, v221
    v_and_b32 v203, 0xffff0000, v221
    v_lshlrev_b32 v204, 16, v222
    v_and_b32 v205, 0xffff0000, v222
    v_lshlrev_b32 v206, 16, v223
    v_and_b32 v207, 0xffff0000, v223
    v_lshlrev_b32 v208, 16, v88
    v_and_b32 v209, 0xffff0000, v88
    v_lshlrev_b32 v210, 16, v89
    v_and_b32 v211, 0xffff0000, v89
    v_lshlrev_b32 v212, 16, v90
    v_and_b32 v213, 0xffff0000, v90
    v_lshlrev_b32 v214, 16, v91
    v_and_b32 v215, 0xffff0000, v91
    buffer_load_dword v11, v9, s[24:27], s39 offen sc1
    s_add_u32 s45, s44, 16384
    buffer_load_dwordx4 a[32:35], v54, s[28:31], s45 offen offset:0 sc1
    buffer_load_dwordx4 a[36:39], v54, s[28:31], s45 offen offset:1024 sc1
    buffer_load_dwordx4 a[40:43], v54, s[28:31], s45 offen offset:2048 sc1
    buffer_load_dwordx4 a[44:47], v54, s[28:31], s45 offen offset:3072 sc1
    s_waitcnt vmcnt(4)
    v_cmp_ne_u32 s[54:55], s95, v11
    s_cmp_lg_u64 s[54:55], 0
    s_cbranch_scc1 Ltail_spin2
Ltail_got2:
    s_add_u32 s39, s39, 4
    s_add_u32 s45, s44, 0
    buffer_load_dwordx4 a[64:67], v2, s[28:31], s45 offen offset:1024 sc1
    buffer_load_dwordx4 a[68:71], v2, s[28:31], s45 offen offset:3072 sc1
    s_add_u32 s45, s44, 4096
    buffer_load_dwordx4 a[72:75], v2, s[28:31], s45 offen offset:1024 sc1
    buffer_load_dwordx4 a[76:79], v2, s[28:31], s45 offen offset:3072 sc1
    s_add_u32 s45, s44, 8192
    buffer_load_dwordx4 a[80:83], v2, s[28:31], s45 offen offset:1024 sc1
    buffer_load_dwordx4 a[84:87], v2, s[28:31], s45 offen offset:3072 sc1
    s_add_u32 s45, s44, 12288
    buffer_load_dwordx4 a[88:91], v2, s[28:31], s45 offen offset:1024 sc1
    buffer_load_dwordx4 a[92:95], v2, s[28:31], s45 offen offset:3072 sc1
    v_mfma_f32_16x16x32_bf16 v[64:67], v[250:253], a[0:3], 0
    v_mfma_f32_16x16x32_bf16 v[68:71], v[248:251], a[0:3], 0
    v_mfma_f32_16x16x32_bf16 v[64:67], v[250:253], a[4:7], v[64:67]
    v_mfma_f32_16x16x32_bf16 v[68:71], v[248:251], a[4:7], v[68:71]
    v_mfma_f32_16x16x32_bf16 v[64:67], v[250:253], a[8:11], v[64:67]
    v_mfma_f32_16x16x32_bf16 v[68:71], v[248:251], a[8:11], v[68:71]
    v_mfma_f32_16x16x32_bf16 v[64:67], v[250:253], a[12:15], v[64:67]
    v_mfma_f32_16x16x32_bf16 v[68:71], v[248:251], a[12:15], v[68:71]
    v_mfma_f32_16x16x32_bf16 v[64:67], v[250:253], a[16:19], v[64:67]
    v_mfma_f32_16x16x32_bf16 v[68:71], v[248:251], a[16:19], v[68:71]
    v_mfma_f32_16x16x32_bf16 v[64:67], v[250:253], a[20:23], v[64:67]
    v_mfma_f32_16x16x32_bf16 v[68:71], v[248:251], a[20:23], v[68:71]
    v_mfma_f32_16x16x32_bf16 v[64:67], v[250:253], a[24:27], v[64:67]
    v_mfma_f32_16x16x32_bf16 v[68:71], v[248:251], a[24:27], v[68:71]
    v_mfma_f32_16x16x32_bf16 v[64:67], v[250:253], a[28:31], v[64:67]
    v_mfma_f32_16x16x32_bf16 v[68:71], v[248:251], a[28:31], v[68:71]
    s_waitcnt vmcnt(11)
    v_mfma_f32_16x16x32_bf16 v[80:83], v[242:245], a[32:35], 0
    v_mfma_f32_16x16x32_bf16 v[84:87], v[240:243], a[32:35], 0
    s_waitcnt vmcnt(10)
    v_mfma_f32_16x16x32_bf16 v[80:83], v[242:245], a[36:39], v[80:83]
    v_mfma_f32_16x16x32_bf16 v[84:87], v[240:243], a[36:39], v[84:87]
    s_waitcnt vmcnt(9)
    v_mfma_f32_16x16x32_bf16 v[80:83], v[242:245], a[40:43], v[80:83]
    v_mfma_f32_16x16x32_bf16 v[84:87], v[240:243], a[40:43], v[84:87]
    s_waitcnt vmcnt(8)
    v_mfma_f32_16x16x32_bf16 v[80:83], v[242:245], a[44:47], v[80:83]
    v_mfma_f32_16x16x32_bf16 v[84:87], v[240:243], a[44:47], v[84:87]
    s_waitcnt vmcnt(7)
    s_nop 5
    v_mov_b32_dpp v80, v80 row_ror:8 row_mask:0x4 bank_mask:0xf
    v_mov_b32_dpp v81, v81 row_ror:8 row_mask:0x4 bank_mask:0xf
    v_mov_b32_dpp v82, v82 row_ror:8 row_mask:0x4 bank_mask:0xf
    v_mov_b32_dpp v83, v83 row_ror:8 row_mask:0x4 bank_mask:0xf
    v_mov_b32_dpp v84, v84 row_ror:8 row_mask:0x4 bank_mask:0xf
    v_mov_b32_dpp v85, v85 row_ror:8 row_mask:0x4 bank_mask:0xf
    v_mov_b32_dpp v86, v86 row_ror:8 row_mask:0x4 bank_mask:0xf
    v_mov_b32_dpp v87, v87 row_ror:8 row_mask:0x4 bank_mask:0xf
    v_pk_fma_f32 v[12:13], v[96:97], v[64:65], v[12:13]
    v_pk_fma_f32 v[14:15], v[98:99], v[66:67], v[14:15]
    v_pk_fma_f32 v[16:17], v[100:101], v[68:69], v[16:17]
    v_pk_fma_f32 v[18:19], v[102:103], v[70:71], v[18:19]
    v_cvt_pk_bf16_f32 v36, v12, v13
    v_cvt_pk_bf16_f32 v37, v14, v15
    v_cvt_pk_bf16_f32 v38, v16, v17
    v_cvt_pk_bf16_f32 v39, v18, v19
    v_lshlrev_b32 v12, 16, v36
    v_and_b32 v13, 0xffff0000, v36
    v_lshlrev_b32 v14, 16, v37
    v_and_b32 v15, 0xffff0000, v37
    v_lshlrev_b32 v16, 16, v38
    v_and_b32 v17, 0xffff0000, v38
    v_lshlrev_b32 v18, 16, v39
    v_and_b32 v19, 0xffff0000, v39
    s_mov_b32 s45, 2622592
    buffer_store_dwordx4 v[36:39], v6, s[24:27], s45 offen offset:0 sc1
    v_pk_add_f32 v[48:49], v[12:13], v[14:15]
    v_pk_add_f32 v[50:51], v[16:17], v[18:19]
    v_pk_fma_f32 v[28:29], v[112:113], v[80:81], v[28:29]
    v_pk_fma_f32 v[30:31], v[114:115], v[82:83], v[30:31]
    v_pk_fma_f32 v[32:33], v[116:117], v[84:85], v[32:33]
    v_pk_fma_f32 v[34:35], v[118:119], v[86:87], v[34:35]
    v_cvt_pk_bf16_f32 v44, v28, v29
    v_cvt_pk_bf16_f32 v45, v30, v31
    v_cvt_pk_bf16_f32 v46, v32, v33
    v_cvt_pk_bf16_f32 v47, v34, v35
    v_lshlrev_b32 v28, 16, v44
    v_and_b32 v29, 0xffff0000, v44
    v_lshlrev_b32 v30, 16, v45
    v_and_b32 v31, 0xffff0000, v45
    v_lshlrev_b32 v32, 16, v46
    v_and_b32 v33, 0xffff0000, v46
    v_lshlrev_b32 v34, 16, v47
    v_and_b32 v35, 0xffff0000, v47
    s_mov_b32 s45, 2622592
    buffer_store_dwordx4 v[44:47], v60, s[24:27], s45 offen offset:1024 sc1
    v_pk_add_f32 v[48:49], v[48:49], v[28:29]
    v_pk_add_f32 v[50:51], v[50:51], v[30:31]
    v_pk_add_f32 v[48:49], v[48:49], v[32:33]
    v_pk_add_f32 v[50:51], v[50:51], v[34:35]
    v_mfma_f32_16x16x32_bf16 v[72:75], v[250:253], a[64:67], 0
    v_mfma_f32_16x16x32_bf16 v[76:79], v[248:251], a[64:67], 0
    s_waitcnt vmcnt(8)
    v_mfma_f32_16x16x32_bf16 v[72:75], v[250:253], a[68:71], v[72:75]
    v_mfma_f32_16x16x32_bf16 v[76:79], v[248:251], a[68:71], v[76:79]
    s_waitcnt vmcnt(7)
    v_mfma_f32_16x16x32_bf16 v[72:75], v[250:253], a[72:75], v[72:75]
    v_mfma_f32_16x16x32_bf16 v[76:79], v[248:251], a[72:75], v[76:79]
    s_waitcnt vmcnt(6)
    v_mfma_f32_16x16x32_bf16 v[72:75], v[250:253], a[76:79], v[72:75]
    v_mfma_f32_16x16x32_bf16 v[76:79], v[248:251], a[76:79], v[76:79]
    s_waitcnt vmcnt(5)
    v_mfma_f32_16x16x32_bf16 v[72:75], v[250:253], a[80:83], v[72:75]
    v_mfma_f32_16x16x32_bf16 v[76:79], v[248:251], a[80:83], v[76:79]
    s_waitcnt vmcnt(4)
    v_mfma_f32_16x16x32_bf16 v[72:75], v[250:253], a[84:87], v[72:75]
    v_mfma_f32_16x16x32_bf16 v[76:79], v[248:251], a[84:87], v[76:79]
    s_waitcnt vmcnt(3)
    v_mfma_f32_16x16x32_bf16 v[72:75], v[250:253], a[88:91], v[72:75]
    v_mfma_f32_16x16x32_bf16 v[76:79], v[248:251], a[88:91], v[76:79]
    s_waitcnt vmcnt(2)
    v_mfma_f32_16x16x32_bf16 v[72:75], v[250:253], a[92:95], v[72:75]
    v_mfma_f32_16x16x32_bf16 v[76:79], v[248:251], a[92:95], v[76:79]
    s_add_u32 s57, s59, 4096
    s_add_u32 m0, s6, -110592
    s_nop 0
    buffer_load_dwordx4 v255, s[84:87], s57 offen lds
    s_add_u32 s57, s59, 8192
    s_add_u32 m0, s6, -106496
    s_nop 0
    buffer_load_dwordx4 v255, s[84:87], s57 offen lds
    s_add_u32 s57, s59, 12288
    s_add_u32 m0, s6, -102400
    s_nop 0
    buffer_load_dwordx4 v255, s[84:87], s57 offen lds
    s_add_u32 s57, s59, 16384
    s_add_u32 m0, s6, -98304
    s_nop 0
    buffer_load_dwordx4 v255, s[84:87], s57 offen lds
    s_add_u32 s57, s59, 20480
    s_add_u32 m0, s6, -94208
    s_nop 0
    buffer_load_dwordx4 v255, s[84:87], s57 offen lds
    s_add_u32 s57, s59, 24576
    s_add_u32 m0, s6, -90112
    s_nop 0
    buffer_load_dwordx4 v255, s[84:87], s57 offen lds
    s_add_u32 s57, s59, 28672
    s_add_u32 m0, s6, -86016
    s_nop 0
    buffer_load_dwordx4 v255, s[84:87], s57 offen lds
    s_add_u32 s57, s59, 32768
    s_add_u32 m0, s6, -81920
    s_nop 0
    buffer_load_dwordx4 v255, s[84:87], s57 offen lds
    v_pk_fma_f32 v[20:21], v[104:105], v[72:73], v[20:21]
    v_pk_fma_f32 v[22:23], v[106:107], v[74:75], v[22:23]
    v_pk_fma_f32 v[24:25], v[108:109], v[76:77], v[24:25]
    v_pk_fma_f32 v[26:27], v[110:111], v[78:79], v[26:27]
    v_cvt_pk_bf16_f32 v40, v20, v21
    v_cvt_pk_bf16_f32 v41, v22, v23
    v_cvt_pk_bf16_f32 v42, v24, v25
    v_cvt_pk_bf16_f32 v43, v26, v27
    v_lshlrev_b32 v20, 16, v40
    v_and_b32 v21, 0xffff0000, v40
    v_lshlrev_b32 v22, 16, v41
    v_and_b32 v23, 0xffff0000, v41
    v_lshlrev_b32 v24, 16, v42
    v_and_b32 v25, 0xffff0000, v42
    v_lshlrev_b32 v26, 16, v43
    v_and_b32 v27, 0xffff0000, v43
    s_mov_b32 s45, 2622592
    buffer_store_dwordx4 v[40:43], v6, s[24:27], s45 offen offset:512 sc1
    v_pk_add_f32 v[48:49], v[48:49], v[20:21]
    v_pk_add_f32 v[50:51], v[50:51], v[22:23]
    v_pk_add_f32 v[48:49], v[48:49], v[24:25]
    v_pk_add_f32 v[50:51], v[50:51], v[26:27]
    v_pk_add_f32 v[48:49], v[48:49], v[50:51]
    v_add_f32 v48, v48, v49
    s_nop 1
    v_add_f32_dpp v48, v48, v48 row_ror:1 row_mask:0xf bank_mask:0xf
    s_nop 1
    v_add_f32_dpp v48, v48, v48 row_ror:2 row_mask:0xf bank_mask:0xf
    s_nop 1
    v_add_f32_dpp v48, v48, v48 row_ror:4 row_mask:0xf bank_mask:0xf
    s_nop 1
    v_add_f32_dpp v48, v48, v48 row_ror:8 row_mask:0xf bank_mask:0xf
    v_mov_b32 v52, v48
    s_nop 1
    v_permlane16_swap_b32 v48, v52
    s_nop 0
    v_add_f32 v48, v48, v52
    v_mul_f32 v48, 0x3ae38e39, v48
    v_pk_add_f32 v[216:217], v[12:13], v[48:49] op_sel_hi:[1,0] neg_lo:[0,1] neg_hi:[0,1]
    v_pk_add_f32 v[218:219], v[14:15], v[48:49] op_sel_hi:[1,0] neg_lo:[0,1] neg_hi:[0,1]
    v_pk_add_f32 v[220:221], v[16:17], v[48:49] op_sel_hi:[1,0] neg_lo:[0,1] neg_hi:[0,1]
    v_pk_add_f32 v[222:223], v[18:19], v[48:49] op_sel_hi:[1,0] neg_lo:[0,1] neg_hi:[0,1]
    v_pk_add_f32 v[224:225], v[20:21], v[48:49] op_sel_hi:[1,0] neg_lo:[0,1] neg_hi:[0,1]
    v_pk_add_f32 v[226:227], v[22:23], v[48:49] op_sel_hi:[1,0] neg_lo:[0,1] neg_hi:[0,1]
    v_pk_add_f32 v[228:229], v[24:25], v[48:49] op_sel_hi:[1,0] neg_lo:[0,1] neg_hi:[0,1]
    v_pk_add_f32 v[230:231], v[26:27], v[48:49] op_sel_hi:[1,0] neg_lo:[0,1] neg_hi:[0,1]
    v_pk_add_f32 v[232:233], v[28:29], v[48:49] op_sel_hi:[1,0] neg_lo:[0,1] neg_hi:[0,1]
    v_pk_add_f32 v[234:235], v[30:31], v[48:49] op_sel_hi:[1,0] neg_lo:[0,1] neg_hi:[0,1]
    v_pk_add_f32 v[236:237], v[32:33], v[48:49] op_sel_hi:[1,0] neg_lo:[0,1] neg_hi:[0,1]
    v_pk_add_f32 v[238:239], v[34:35], v[48:49] op_sel_hi:[1,0] neg_lo:[0,1] neg_hi:[0,1]
    v_pk_mul_f32 v[50:51], v[216:217], v[216:217]
    v_pk_mul_f32 v[52:53], v[224:225], v[224:225]
    v_pk_mul_f32 v[62:63], v[232:233], v[232:233]
    v_pk_fma_f32 v[50:51], v[218:219], v[218:219], v[50:51]
    v_pk_fma_f32 v[52:53], v[226:227], v[226:227], v[52:53]
    v_pk_fma_f32 v[62:63], v[234:235], v[234:235], v[62:63]
    v_pk_fma_f32 v[50:51], v[220:221], v[220:221], v[50:51]
    v_pk_fma_f32 v[52:53], v[228:229], v[228:229], v[52:53]
    v_pk_fma_f32 v[62:63], v[236:237], v[236:237], v[62:63]
    v_pk_fma_f32 v[50:51], v[222:223], v[222:223], v[50:51]
    v_pk_fma_f32 v[52:53], v[230:231], v[230:231], v[52:53]
    v_pk_fma_f32 v[62:63], v[238:239], v[238:239], v[62:63]
    v_pk_add_f32 v[50:51], v[50:51], v[52:53]
    v_add_f32 v62, v62, v63
    v_add_f32 v50, v50, v51
    v_cndmask_b32 v62, 0, v62, vcc
    v_add_f32 v50, v50, v62
    s_nop 1
    v_add_f32_dpp v50, v50, v50 row_ror:1 row_mask:0xf bank_mask:0xf
    s_nop 1
    v_add_f32_dpp v50, v50, v50 row_ror:2 row_mask:0xf bank_mask:0xf
    s_nop 1
    v_add_f32_dpp v50, v50, v50 row_ror:4 row_mask:0xf bank_mask:0xf
    s_nop 1
    v_add_f32_dpp v50, v50, v50 row_ror:8 row_mask:0xf bank_mask:0xf
    v_mov_b32 v52, v50
    s_nop 1
    v_permlane16_swap_b32 v50, v52
    s_nop 0
    v_add_f32 v50, v50, v52
    v_mul_f32 v50, 0x3ae38e39, v50
    v_cvt_pk_bf16_f32 v52, v48, v50
    v_and_b32 v50, 0xffff0000, v52
    v_lshlrev_b32 v52, 16, v52
    v_add_f32 v50, 0x3727c5ac, v50
    v_sub_f32 v48, v48, v52
    v_cvt_pk_bf16_f32 v50, v50, v50
    v_and_b32 v50, 0xffff0000, v50
    v_sqrt_f32 v50, v50
    s_nop 0
    v_cvt_pk_bf16_f32 v50, v50, v50
    v_and_b32 v50, 0xffff0000, v50
    v_rcp_f32 v50, v50
    s_mov_b32 s45, 2621440
    v_mul_f32 v48, v48, v50
    v_pk_fma_f32 v[216:217], v[216:217], v[50:51], v[48:49] op_sel_hi:[1,0,0]
    v_pk_fma_f32 v[218:219], v[218:219], v[50:51], v[48:49] op_sel_hi:[1,0,0]
    v_pk_fma_f32 v[220:221], v[220:221], v[50:51], v[48:49] op_sel_hi:[1,0,0]
    v_pk_fma_f32 v[222:223], v[222:223], v[50:51], v[48:49] op_sel_hi:[1,0,0]
    v_pk_fma_f32 v[224:225], v[224:225], v[50:51], v[48:49] op_sel_hi:[1,0,0]
    v_pk_fma_f32 v[226:227], v[226:227], v[50:51], v[48:49] op_sel_hi:[1,0,0]
    v_pk_fma_f32 v[228:229], v[228:229], v[50:51], v[48:49] op_sel_hi:[1,0,0]
    v_pk_fma_f32 v[230:231], v[230:231], v[50:51], v[48:49] op_sel_hi:[1,0,0]
    v_pk_fma_f32 v[232:233], v[232:233], v[50:51], v[48:49] op_sel_hi:[1,0,0]
    v_pk_fma_f32 v[234:235], v[234:235], v[50:51], v[48:49] op_sel_hi:[1,0,0]
    v_pk_fma_f32 v[236:237], v[236:237], v[50:51], v[48:49] op_sel_hi:[1,0,0]
    v_pk_fma_f32 v[238:239], v[238:239], v[50:51], v[48:49] op_sel_hi:[1,0,0]
    v_pk_fma_f32 v[216:217], v[216:217], v[120:121], v[144:145]
    v_pk_fma_f32 v[218:219], v[218:219], v[122:123], v[146:147]
    v_pk_fma_f32 v[220:221], v[220:221], v[124:125], v[148:149]
    v_pk_fma_f32 v[222:223], v[222:223], v[126:127], v[150:151]
    v_pk_fma_f32 v[224:225], v[224:225], v[128:129], v[152:153]
    v_pk_fma_f32 v[226:227], v[226:227], v[130:131], v[154:155]
    v_pk_fma_f32 v[228:229], v[228:229], v[132:133], v[156:157]
    v_pk_fma_f32 v[230:231], v[230:231], v[134:135], v[158:159]
    v_pk_fma_f32 v[232:233], v[232:233], v[136:137], v[160:161]
    v_pk_fma_f32 v[234:235], v[234:235], v[138:139], v[162:163]
    v_pk_fma_f32 v[236:237], v[236:237], v[140:141], v[164:165]
    v_pk_fma_f32 v[238:239], v[238:239], v[142:143], v[166:167]
    v_cvt_pk_bf16_f32 v64, v216, v217
    v_cvt_pk_bf16_f32 v65, v218, v219
    v_cvt_pk_bf16_f32 v66, v220, v221
    v_cvt_pk_bf16_f32 v67, v222, v223
    v_cvt_pk_bf16_f32 v68, v224, v225
    v_cvt_pk_bf16_f32 v69, v226, v227
    v_cvt_pk_bf16_f32 v70, v228, v229
    v_cvt_pk_bf16_f32 v71, v230, v231
    v_cvt_pk_bf16_f32 v72, v232, v233
    v_cvt_pk_bf16_f32 v73, v234, v235
    v_cvt_pk_bf16_f32 v74, v236, v237
    v_cvt_pk_bf16_f32 v75, v238, v239
    buffer_store_dwordx4 v[64:67], v6, s[24:27], s45 offen offset:0 sc1
    buffer_store_dwordx4 v[68:71], v6, s[24:27], s45 offen offset:512 sc1
    buffer_store_dwordx4 v[72:75], v60, s[24:27], s45 offen offset:1024 sc1
    v_lshlrev_b32 v216, 16, v64
    v_and_b32 v217, 0xffff0000, v64
    v_lshlrev_b32 v218, 16, v65
    v_and_b32 v219, 0xffff0000, v65
    v_lshlrev_b32 v220, 16, v66
    v_and_b32 v221, 0xffff0000, v66
    v_lshlrev_b32 v222, 16, v67
    v_and_b32 v223, 0xffff0000, v67
    v_lshlrev_b32 v224, 16, v68
    v_and_b32 v225, 0xffff0000, v68
    v_lshlrev_b32 v226, 16, v69
    v_and_b32 v227, 0xffff0000, v69
    v_lshlrev_b32 v228, 16, v70
    v_and_b32 v229, 0xffff0000, v70
    v_lshlrev_b32 v230, 16, v71
    v_and_b32 v231, 0xffff0000, v71
    v_lshlrev_b32 v232, 16, v72
    v_and_b32 v233, 0xffff0000, v72
    v_lshlrev_b32 v234, 16, v73
    v_and_b32 v235, 0xffff0000, v73
    v_lshlrev_b32 v236, 16, v74
    v_and_b32 v237, 0xffff0000, v74
    v_lshlrev_b32 v238, 16, v75
    v_and_b32 v239, 0xffff0000, v75
    v_pk_mul_f32 v[50:51], v[216:217], v[168:169]
    v_pk_mul_f32 v[52:53], v[224:225], v[176:177]
    v_pk_mul_f32 v[62:63], v[232:233], v[184:185]
    v_pk_fma_f32 v[50:51], v[218:219], v[170:171], v[50:51]
    v_pk_fma_f32 v[52:53], v[226:227], v[178:179], v[52:53]
    v_pk_fma_f32 v[62:63], v[234:235], v[186:187], v[62:63]
    v_pk_fma_f32 v[50:51], v[220:221], v[172:173], v[50:51]
    v_pk_fma_f32 v[52:53], v[228:229], v[180:181], v[52:53]
    v_pk_fma_f32 v[62:63], v[236:237], v[188:189], v[62:63]
    v_pk_fma_f32 v[50:51], v[222:223], v[174:175], v[50:51]
    v_pk_fma_f32 v[52:53], v[230:231], v[182:183], v[52:53]
    v_pk_fma_f32 v[62:63], v[238:239], v[190:191], v[62:63]
    v_pk_add_f32 v[50:51], v[50:51], v[52:53]
    v_add_f32 v62, v62, v63
    v_add_f32 v50, v50, v51
    v_add_f32 v50, v50, v62
    v_lshlrev_b32 v48, 2, v7
    v_and_b32 v48, 28, v48
    v_sub_u32 v49, 2047, v7
    v_add_f32_dpp v50, v50, v50 row_ror:1 row_mask:0xf bank_mask:0xf
    s_nop 1
    v_add_f32_dpp v50, v50, v50 row_ror:2 row_mask:0xf bank_mask:0xf
    s_nop 1
    v_add_f32_dpp v50, v50, v50 row_ror:4 row_mask:0xf bank_mask:0xf
    s_nop 1
    v_add_f32_dpp v50, v50, v50 row_ror:8 row_mask:0xf bank_mask:0xf
    v_mov_b32 v52, v50
    s_nop 1
    v_permlane16_swap_b32 v50, v52
    s_nop 0
    v_add_f32 v50, v50, v52
    v_ashrrev_i32 v52, 31, v50
    v_or_b32 v52, 0x80000000, v52
    v_xor_b32 v52, v52, v50
    v_and_b32 v52, 0xfffff800, v52
    v_min_u32 v52, 0xfffff000, v52
    v_or_b32 v52, v52, v49
    s_mov_b32 exec_lo, 1
    s_mov_b32 exec_hi, 1
    ds_write_b32 v48, v52 offset:36864
    s_mov_b64 exec, -1
    s_waitcnt lgkmcnt(0)
Ltour12:
    s_cbranch_execz Ltour16
    s_barrier
    s_cmp_lg_u32 s3, 0
    s_cbranch_scc1 Ltail_notw0
    v_mov_b32 v141, 36864
    ds_read_b128 v[128:131], v141
    ds_read_b128 v[132:135], v141 offset:16
    s_lshl_b32 s45, s2, 7
    s_add_u32 s45, s45, 8912896
    s_waitcnt lgkmcnt(1)
    v_max_u32 v136, v128, v129
    v_min_u32 v137, v128, v129
    v_med3_u32 v137, v136, v137, v130
    v_max_u32 v136, v136, v130
    v_med3_u32 v137, v136, v137, v131
    v_max_u32 v136, v136, v131
    s_waitcnt lgkmcnt(0)
    v_med3_u32 v137, v136, v137, v132
    v_max_u32 v136, v136, v132
    v_med3_u32 v137, v136, v137, v133
    v_max_u32 v136, v136, v133
    v_med3_u32 v137, v136, v137, v134
    v_max_u32 v136, v136, v134
    v_med3_u32 v137, v136, v137, v135
    v_max_u32 v136, v136, v135
    buffer_store_dwordx2 v[136:137], v8, s[24:27], s45 offen sc1
Ltail_notw0:
    v_pk_mul_f32 v[192:193], v[192:193], v[216:217]
    v_pk_mul_f32 v[194:195], v[194:195], v[218:219]
    v_pk_mul_f32 v[196:197], v[196:197], v[220:221]
    v_pk_mul_f32 v[198:199], v[198:199], v[222:223]
    v_pk_mul_f32 v[200:201], v[200:201], v[224:225]
    v_pk_mul_f32 v[202:203], v[202:203], v[226:227]
    v_pk_mul_f32 v[204:205], v[204:205], v[228:229]
    v_pk_mul_f32 v[206:207], v[206:207], v[230:231]
    v_pk_mul_f32 v[208:209], v[208:209], v[232:233]
    v_pk_mul_f32 v[210:211], v[210:211], v[234:235]
    v_pk_mul_f32 v[212:213], v[212:213], v[236:237]
    v_pk_mul_f32 v[214:215], v[214:215], v[238:239]
    v_cvt_pk_bf16_f32 v144, v192, v193
    v_cvt_pk_bf16_f32 v145, v194, v195
    v_cvt_pk_bf16_f32 v146, v196, v197
    v_cvt_pk_bf16_f32 v147, v198, v199
    v_cvt_pk_bf16_f32 v148, v200, v201
    v_cvt_pk_bf16_f32 v149, v202, v203
    v_cvt_pk_bf16_f32 v150, v204, v205
    v_cvt_pk_bf16_f32 v151, v206, v207
    v_cvt_pk_bf16_f32 v152, v208, v209
    v_cvt_pk_bf16_f32 v153, v210, v211
    v_cvt_pk_bf16_f32 v154, v212, v213
    v_cvt_pk_bf16_f32 v155, v214, v215
    v_lshlrev_b32 v192, 16, v144
    v_and_b32 v193, 0xffff0000, v144
    v_lshlrev_b32 v194, 16, v145
    v_and_b32 v195, 0xffff0000, v145
    v_lshlrev_b32 v196, 16, v146
    v_and_b32 v197, 0xffff0000, v146
    v_lshlrev_b32 v198, 16, v147
    v_and_b32 v199, 0xffff0000, v147
    v_lshlrev_b32 v200, 16, v148
    v_and_b32 v201, 0xffff0000, v148
    v_lshlrev_b32 v202, 16, v149
    v_and_b32 v203, 0xffff0000, v149
    v_lshlrev_b32 v204, 16, v150
    v_and_b32 v205, 0xffff0000, v150
    v_lshlrev_b32 v206, 16, v151
    v_and_b32 v207, 0xffff0000, v151
    v_lshlrev_b32 v208, 16, v152
    v_and_b32 v209, 0xffff0000, v152
    v_lshlrev_b32 v210, 16, v153
    v_and_b32 v211, 0xffff0000, v153
    v_lshlrev_b32 v212, 16, v154
    v_and_b32 v213, 0xffff0000, v154
    v_lshlrev_b32 v214, 16, v155
    v_and_b32 v215, 0xffff0000, v155
    v_pk_add_f32 v[192:193], v[192:193], v[12:13]
    v_pk_add_f32 v[194:195], v[194:195], v[14:15]
    v_pk_add_f32 v[196:197], v[196:197], v[16:17]
    v_pk_add_f32 v[198:199], v[198:199], v[18:19]
    v_pk_add_f32 v[200:201], v[200:201], v[20:21]
    v_pk_add_f32 v[202:203], v[202:203], v[22:23]
    v_pk_add_f32 v[204:205], v[204:205], v[24:25]
    v_pk_add_f32 v[206:207], v[206:207], v[26:27]
    v_pk_add_f32 v[208:209], v[208:209], v[28:29]
    v_pk_add_f32 v[210:211], v[210:211], v[30:31]
    v_pk_add_f32 v[212:213], v[212:213], v[32:33]
    v_pk_add_f32 v[214:215], v[214:215], v[34:35]
    v_cvt_pk_bf16_f32 v144, v192, v193
    v_cvt_pk_bf16_f32 v145, v194, v195
    v_cvt_pk_bf16_f32 v146, v196, v197
    v_cvt_pk_bf16_f32 v147, v198, v199
    v_cvt_pk_bf16_f32 v148, v200, v201
    v_cvt_pk_bf16_f32 v149, v202, v203
    v_cvt_pk_bf16_f32 v150, v204, v205
    v_cvt_pk_bf16_f32 v151, v206, v207
    v_cvt_pk_bf16_f32 v152, v208, v209
    v_cvt_pk_bf16_f32 v153, v210, v211
    v_cvt_pk_bf16_f32 v154, v212, v213
    v_cvt_pk_bf16_f32 v155, v214, v215
    s_mov_b32 s38, 135168
    s_mov_b32 s39, 12288
    v_lshrrev_b32 v9, 2, v1
    v_and_b32 v10, 3, v1
    v_lshlrev_b32 v10, 3, v10
    s_and_b32 s45, s3, 1
    s_lshl_b32 s45, s45, 5
    v_lshl_add_u32 v11, v9, 6, v10
    v_add_u32 v11, s45, v11
    s_cmp_lt_u32 s3, 2
    s_cselect_b32 s44, 98304, s38
    s_cselect_b32 s45, 98304, s39
    v_add_u32 v12, s45, v11
    v_add_u32 v11, s44, v11
    ds_read_b64_tr_b16 a[0:1], v11 offset:0
    ds_read_b64_tr_b16 a[2:3], v11 offset:1024
    ds_read_b64_tr_b16 a[4:5], v11 offset:2048
    ds_read_b64_tr_b16 a[6:7], v11 offset:3072
    ds_read_b64_tr_b16 a[8:9], v11 offset:4096
    ds_read_b64_tr_b16 a[10:11], v11 offset:5120
    ds_read_b64_tr_b16 a[12:13], v11 offset:6144
    ds_read_b64_tr_b16 a[14:15], v11 offset:7168
    ds_read_b64_tr_b16 a[16:17], v11 offset:8192
    ds_read_b64_tr_b16 a[18:19], v11 offset:9216
    ds_read_b64_tr_b16 a[20:21], v11 offset:10240
    ds_read_b64_tr_b16 a[22:23], v11 offset:11264
    ds_read_b64_tr_b16 a[24:25], v11 offset:12288
    ds_read_b64_tr_b16 a[26:27], v11 offset:13312
    ds_read_b64_tr_b16 a[28:29], v11 offset:14336
    ds_read_b64_tr_b16 a[30:31], v11 offset:15360
    ds_read_b64_tr_b16 a[32:33], v11 offset:16384
    ds_read_b64_tr_b16 a[34:35], v11 offset:17408
    ds_read_b64_tr_b16 a[36:37], v11 offset:18432
    ds_read_b64_tr_b16 a[38:39], v11 offset:19456
    ds_read_b64_tr_b16 a[40:41], v11 offset:20480
    ds_read_b64_tr_b16 a[42:43], v11 offset:21504
    ds_read_b64_tr_b16 a[44:45], v11 offset:22528
    ds_read_b64_tr_b16 a[46:47], v11 offset:23552
    ds_read_b64_tr_b16 a[48:49], v11 offset:24576
    ds_read_b64_tr_b16 a[50:51], v11 offset:25600
    ds_read_b64_tr_b16 a[52:53], v11 offset:26624
    ds_read_b64_tr_b16 a[54:55], v11 offset:27648
    ds_read_b64_tr_b16 a[56:57], v12 offset:28672
    ds_read_b64_tr_b16 a[58:59], v12 offset:29696
    ds_read_b64_tr_b16 a[60:61], v12 offset:30720
    ds_read_b64_tr_b16 a[62:63], v12 offset:31744
    ds_read_b64_tr_b16 a[64:65], v12 offset:32768
    ds_read_b64_tr_b16 a[66:67], v12 offset:33792
    ds_read_b64_tr_b16 a[68:69], v12 offset:34816
    ds_read_b64_tr_b16 a[70:71], v12 offset:35840
    v_mul_u32_u24 v12, 1152, v9
    s_lshl_b32 s44, s3, 7
    s_add_u32 s44, s44, 49152
    v_add3_u32 v12, v12, v10, s44
    v_lshlrev_b32 v13, 4, v1
    v_add_u32 v13, 32768, v13
    s_lshl_b32 s44, s3, 10
    v_add_u32 v14, s44, v13
    v_bfe_u32 v15, v1, 2, 2
    v_cmp_eq_u32 s[52:53], 0, v15
    v_cmp_eq_u32 s[54:55], 1, v15
    v_cmp_eq_u32 s[56:57], 2, v15
    v_cmp_eq_u32 s[58:59], 3, v15
    s_mul_i32 s43, s42, 18
    s_add_u32 s43, s43, s41
    s_lshl_b32 s43, s43, 9
    s_mul_i32 s44, s3, 73728
    s_add_u32 s43, s43, s44
    v_lshlrev_b32 v15, 3, v1
    v_lshlrev_b32 v140, 7, v0
    s_mov_b32 s45, 8912896
    s_lshl_b32 s36, s3, 3
    v_mov_b32 v141, s36
    s_mov_b32 s48, 16384
Ltail_pollk:
    buffer_load_dwordx2 v[136:137], v140, s[24:27], s45 offen sc1
    s_sub_u32 s48, s48, 1
    s_cbranch_scc1 Ltail_gotk
    s_waitcnt vmcnt(0)
    v_max_u32 v138, v136, v137
    v_cmp_eq_u32 vcc, -1, v138
    s_cbranch_vccnz Ltail_pollk
Ltail_gotk:
    s_waitcnt vmcnt(0)
    v_mov_b32_dpp v138, v136 row_ror:1 row_mask:0xf bank_mask:0xf
    v_mov_b32_dpp v139, v137 row_ror:1 row_mask:0xf bank_mask:0xf
    v_min_u32 v142, v136, v138
    v_max_u32 v136, v136, v138
    v_max3_u32 v137, v142, v137, v139
    s_nop 0
    v_mov_b32_dpp v138, v136 row_ror:2 row_mask:0xf bank_mask:0xf
    v_mov_b32_dpp v139, v137 row_ror:2 row_mask:0xf bank_mask:0xf
    v_min_u32 v142, v136, v138
    v_max_u32 v136, v136, v138
    v_max3_u32 v137, v142, v137, v139
    s_nop 0
    v_mov_b32_dpp v138, v136 row_ror:4 row_mask:0xf bank_mask:0xf
    v_mov_b32_dpp v139, v137 row_ror:4 row_mask:0xf bank_mask:0xf
    v_min_u32 v142, v136, v138
    v_max_u32 v136, v136, v138
    v_max3_u32 v137, v142, v137, v139
    s_nop 0
    v_mov_b32_dpp v138, v136 row_ror:8 row_mask:0xf bank_mask:0xf
    v_mov_b32_dpp v139, v137 row_ror:8 row_mask:0xf bank_mask:0xf
    v_min_u32 v142, v136, v138
    v_max_u32 v136, v136, v138
    v_max3_u32 v137, v142, v137, v139
    v_mov_b32 v138, v136
    v_mov_b32 v139, v137
    s_nop 0
    v_permlane16_swap_b32 v136, v138
    v_permlane16_swap_b32 v137, v139
    v_min_u32 v142, v136, v138
    v_max_u32 v136, v136, v138
    v_max3_u32 v137, v142, v137, v139
    v_mov_b32 v138, v136
    v_mov_b32 v139, v137
    s_nop 0
    v_permlane32_swap_b32 v136, v138
    v_permlane32_swap_b32 v137, v139
    v_min_u32 v142, v136, v138
    v_max_u32 v136, v136, v138
    v_max3_u32 v137, v142, v137, v139
    ds_write_b64 v141, v[136:137] offset:36928
    v_mov_b32 v141, 36928
    s_waitcnt lgkmcnt(0)
    s_barrier
    ds_read_b128 v[128:131], v141
    ds_read_b128 v[132:135], v141 offset:16
    s_or_b32 s36, s2, s3
    s_cselect_b32 s45, -4, 24576
    s_add_u32 s36, s94, 1
    v_mov_b32 v138, s36
    buffer_store_dword v138, v8, s[24:27], s45 offen
    s_waitcnt lgkmcnt(1)
    v_max_u32 v136, v128, v129
    v_min_u32 v137, v128, v129
    v_med3_u32 v137, v136, v137, v130
    v_max_u32 v136, v136, v130
    v_med3_u32 v137, v136, v137, v131
    v_max_u32 v136, v136, v131
    s_waitcnt lgkmcnt(0)
    v_med3_u32 v137, v136, v137, v132
    v_max_u32 v136, v136, v132
    v_med3_u32 v137, v136, v137, v133
    v_max_u32 v136, v136, v133
    v_med3_u32 v137, v136, v137, v134
    v_max_u32 v136, v136, v134
    v_med3_u32 v137, v136, v137, v135
    v_max_u32 v136, v136, v135
    s_nop 0
    v_readfirstlane_b32 s92, v136
    v_readfirstlane_b32 s93, v137
    s_andn2_b32 s46, 0x7ff, s92
    s_andn2_b32 s47, 0x7ff, s93
    s_cmp_ge_u32 s41, 18
    s_cbranch_scc1 Ltail_noffn
    s_mul_i32 s44, s46, 2304
    s_mul_i32 s45, s47, 2304
    s_sub_u32 s45, s45, s44
    v_and_b32 v8, 1, v1
    v_mul_lo_u32 v8, v8, s45
    v_and_b32 v9, 48, v1
    v_add3_u32 v8, v8, v9, s44
    s_mov_b32 s45, 2621440
    s_mov_b32 s48, 16384
Ltail_pollh:
    buffer_load_dwordx4 a[120:123], v8, s[24:27], s45 offen offset:0 sc1
    buffer_load_dwordx4 a[124:127], v8, s[24:27], s45 offen offset:64 sc1
    buffer_load_dwordx4 a[128:131], v8, s[24:27], s45 offen offset:128 sc1
    buffer_load_dwordx4 a[132:135], v8, s[24:27], s45 offen offset:192 sc1
    buffer_load_dwordx4 a[136:139], v8, s[24:27], s45 offen offset:256 sc1
    buffer_load_dwordx4 a[140:143], v8, s[24:27], s45 offen offset:320 sc1
    buffer_load_dwordx4 a[144:147], v8, s[24:27], s45 offen offset:384 sc1
    buffer_load_dwordx4 a[148:151], v8, s[24:27], s45 offen offset:448 sc1
    buffer_load_dwordx4 a[152:155], v8, s[24:27], s45 offen offset:512 sc1
    buffer_load_dwordx4 a[156:159], v8, s[24:27], s45 offen offset:576 sc1
    buffer_load_dwordx4 a[160:163], v8, s[24:27], s45 offen offset:640 sc1
    buffer_load_dwordx4 a[164:167], v8, s[24:27], s45 offen offset:704 sc1
    buffer_load_dwordx4 a[168:171], v8, s[24:27], s45 offen offset:768 sc1
    buffer_load_dwordx4 a[172:175], v8, s[24:27], s45 offen offset:832 sc1
    buffer_load_dwordx4 a[176:179], v8, s[24:27], s45 offen offset:896 sc1
    buffer_load_dwordx4 a[180:183], v8, s[24:27], s45 offen offset:960 sc1
    buffer_load_dwordx4 a[184:187], v8, s[24:27], s45 offen offset:1024 sc1
    buffer_load_dwordx4 a[188:191], v8, s[24:27], s45 offen offset:1088 sc1
    ds_read_b64_tr_b16 a[72:73], v12 offset:0
    ds_read_b64_tr_b16 a[74:75], v12 offset:18432
    ds_read_b64_tr_b16 a[76:77], v12 offset:32
    ds_read_b64_tr_b16 a[78:79], v12 offset:18464
    ds_read_b64_tr_b16 a[80:81], v12 offset:64
    ds_read_b64_tr_b16 a[82:83], v12 offset:18496
    ds_read_b64_tr_b16 a[84:85], v12 offset:96
    ds_read_b64_tr_b16 a[86:87], v12 offset:18528
    ds_read_b64_tr_b16 a[88:89], v12 offset:512
    ds_read_b64_tr_b16 a[90:91], v12 offset:18944
    ds_read_b64_tr_b16 a[92:93], v12 offset:544
    ds_read_b64_tr_b16 a[94:95], v12 offset:18976
    ds_read_b64_tr_b16 a[96:97], v12 offset:576
    ds_read_b64_tr_b16 a[98:99], v12 offset:19008
    ds_read_b64_tr_b16 a[100:101], v12 offset:608
    ds_read_b64_tr_b16 a[102:103], v12 offset:19040
    ds_read_b64_tr_b16 a[104:105], v12 offset:1024
    ds_read_b64_tr_b16 a[106:107], v12 offset:19456
    ds_read_b64_tr_b16 a[108:109], v12 offset:1056
    ds_read_b64_tr_b16 a[110:111], v12 offset:19488
    ds_read_b64_tr_b16 a[112:113], v12 offset:1088
    ds_read_b64_tr_b16 a[114:115], v12 offset:19520
    ds_read_b64_tr_b16 a[116:117], v12 offset:1120
    ds_read_b64_tr_b16 a[118:119], v12 offset:19552
    s_waitcnt vmcnt(17)
    v_mfma_f32_16x16x32_bf16 v[16:19], a[0:3], a[120:123], 0
    s_waitcnt vmcnt(16)
    v_mfma_f32_16x16x32_bf16 v[20:23], a[4:7], a[124:127], 0
    s_waitcnt vmcnt(15)
    v_mfma_f32_16x16x32_bf16 v[16:19], a[8:11], a[128:131], v[16:19]
    s_waitcnt vmcnt(14)
    v_mfma_f32_16x16x32_bf16 v[20:23], a[12:15], a[132:135], v[20:23]
    s_waitcnt vmcnt(13)
    v_mfma_f32_16x16x32_bf16 v[16:19], a[16:19], a[136:139], v[16:19]
    s_waitcnt vmcnt(12)
    v_mfma_f32_16x16x32_bf16 v[20:23], a[20:23], a[140:143], v[20:23]
    s_waitcnt vmcnt(11)
    v_mfma_f32_16x16x32_bf16 v[16:19], a[24:27], a[144:147], v[16:19]
    s_waitcnt vmcnt(10)
    v_mfma_f32_16x16x32_bf16 v[20:23], a[28:31], a[148:151], v[20:23]
    s_waitcnt vmcnt(9)
    v_mfma_f32_16x16x32_bf16 v[16:19], a[32:35], a[152:155], v[16:19]
    s_waitcnt vmcnt(8)
    v_mfma_f32_16x16x32_bf16 v[20:23], a[36:39], a[156:159], v[20:23]
    s_waitcnt vmcnt(7)
    v_mfma_f32_16x16x32_bf16 v[16:19], a[40:43], a[160:163], v[16:19]
    s_waitcnt vmcnt(6)
    v_mfma_f32_16x16x32_bf16 v[20:23], a[44:47], a[164:167], v[20:23]
    s_waitcnt vmcnt(5)
    v_mfma_f32_16x16x32_bf16 v[16:19], a[48:51], a[168:171], v[16:19]
    s_waitcnt vmcnt(4)
    v_mfma_f32_16x16x32_bf16 v[20:23], a[52:55], a[172:175], v[20:23]
    s_waitcnt vmcnt(3)
    v_mfma_f32_16x16x32_bf16 v[16:19], a[56:59], a[176:179], v[16:19]
    s_waitcnt vmcnt(2)
    v_mfma_f32_16x16x32_bf16 v[20:23], a[60:63], a[180:183], v[20:23]
    s_waitcnt vmcnt(1)
    v_mfma_f32_16x16x32_bf16 v[16:19], a[64:67], a[184:187], v[16:19]
    s_waitcnt vmcnt(0)
    v_mfma_f32_16x16x32_bf16 v[20:23], a[68:71], a[188:191], v[20:23]
    s_sub_u32 s48, s48, 1
    s_nop 6
    v_pk_add_f32 v[16:17], v[16:17], v[20:21]
    v_pk_add_f32 v[18:19], v[18:19], v[22:23]
    s_cbranch_scc1 Ltail_goth
    v_cmp_u_f32 vcc, v16, v16
    s_cbranch_vccnz Ltail_pollh
Ltail_goth:
    ds_write_b128 v14, v[16:19]
    s_waitcnt lgkmcnt(0)
    s_barrier
    ds_read_b128 v[16:19], v13 offset:0
    ds_read_b128 v[20:23], v13 offset:1024
    ds_read_b128 v[24:27], v13 offset:2048
    ds_read_b128 v[28:31], v13 offset:3072
    s_mov_b32 s36, 0xbfb8aa3b
    s_mov_b32 s37, 0xbfb8aa3b
    s_waitcnt lgkmcnt(3)
    v_cvt_pk_bf16_f32 v32, v16, v17
    v_cvt_pk_bf16_f32 v33, v18, v19
    s_waitcnt lgkmcnt(2)
    v_cvt_pk_bf16_f32 v34, v20, v21
    v_cvt_pk_bf16_f32 v35, v22, v23
    v_lshlrev_b32 v16, 16, v32
    v_and_b32 v17, 0xffff0000, v32
    v_lshlrev_b32 v18, 16, v33
    v_and_b32 v19, 0xffff0000, v33
    v_lshlrev_b32 v20, 16, v34
    v_and_b32 v21, 0xffff0000, v34
    v_lshlrev_b32 v22, 16, v35
    v_and_b32 v23, 0xffff0000, v35
    v_pk_mul_f32 v[32:33], v[16:17], s[36:37]
    v_pk_mul_f32 v[34:35], v[18:19], s[36:37]
    v_pk_mul_f32 v[36:37], v[20:21], s[36:37]
    v_pk_mul_f32 v[38:39], v[22:23], s[36:37]
    v_exp_f32 v32, v32
    v_exp_f32 v33, v33
    v_exp_f32 v34, v34
    v_exp_f32 v35, v35
    v_exp_f32 v36, v36
    v_exp_f32 v37, v37
    v_exp_f32 v38, v38
    v_exp_f32 v39, v39
    s_waitcnt lgkmcnt(1)
    v_cvt_pk_bf16_f32 v60, v24, v25
    v_cvt_pk_bf16_f32 v61, v26, v27
    s_waitcnt lgkmcnt(0)
    v_cvt_pk_bf16_f32 v62, v28, v29
    v_cvt_pk_bf16_f32 v63, v30, v31
    v_pk_add_f32 v[32:33], v[32:33], 1.0 op_sel_hi:[1,0]
    v_pk_add_f32 v[34:35], v[34:35], 1.0 op_sel_hi:[1,0]
    v_pk_add_f32 v[36:37], v[36:37], 1.0 op_sel_hi:[1,0]
    v_pk_add_f32 v[38:39], v[38:39], 1.0 op_sel_hi:[1,0]
    v_rcp_f32 v32, v32
    v_rcp_f32 v33, v33
    v_rcp_f32 v34, v34
    v_rcp_f32 v35, v35
    v_rcp_f32 v36, v36
    v_rcp_f32 v37, v37
    v_rcp_f32 v38, v38
    v_rcp_f32 v39, v39
    v_lshlrev_b32 v24, 16, v60
    v_and_b32 v25, 0xffff0000, v60
    v_lshlrev_b32 v26, 16, v61
    v_and_b32 v27, 0xffff0000, v61
    v_lshlrev_b32 v28, 16, v62
    v_and_b32 v29, 0xffff0000, v62
    v_lshlrev_b32 v30, 16, v63
    v_and_b32 v31, 0xffff0000, v63
    v_pk_mul_f32 v[16:17], v[16:17], v[32:33]
    v_pk_mul_f32 v[18:19], v[18:19], v[34:35]
    v_pk_mul_f32 v[20:21], v[20:21], v[36:37]
    v_pk_mul_f32 v[22:23], v[22:23], v[38:39]
    v_cvt_pk_bf16_f32 v32, v16, v17
    v_cvt_pk_bf16_f32 v33, v18, v19
    v_cvt_pk_bf16_f32 v34, v20, v21
    v_cvt_pk_bf16_f32 v35, v22, v23
    v_lshlrev_b32 v16, 16, v32
    v_and_b32 v17, 0xffff0000, v32
    v_lshlrev_b32 v18, 16, v33
    v_and_b32 v19, 0xffff0000, v33
    v_lshlrev_b32 v20, 16, v34
    v_and_b32 v21, 0xffff0000, v34
    v_lshlrev_b32 v22, 16, v35
    v_and_b32 v23, 0xffff0000, v35
    v_pk_mul_f32 v[16:17], v[16:17], v[24:25]
    v_pk_mul_f32 v[18:19], v[18:19], v[26:27]
    v_pk_mul_f32 v[20:21], v[20:21], v[28:29]
    v_pk_mul_f32 v[22:23], v[22:23], v[30:31]
    v_cvt_pk_bf16_f32 v32, v16, v17
    v_cvt_pk_bf16_f32 v33, v18, v19
    v_cvt_pk_bf16_f32 v34, v20, v21
    v_cvt_pk_bf16_f32 v35, v22, v23
    v_cndmask_b32 v64, 0, v32, s[52:53]
    v_cndmask_b32 v65, 0, v33, s[52:53]
    v_cndmask_b32 v66, 0, v34, s[52:53]
    v_cndmask_b32 v67, 0, v35, s[52:53]
    v_cndmask_b32 v68, 0, v32, s[54:55]
    v_cndmask_b32 v69, 0, v33, s[54:55]
    v_cndmask_b32 v70, 0, v34, s[54:55]
    v_cndmask_b32 v71, 0, v35, s[54:55]
    v_cndmask_b32 v72, 0, v32, s[56:57]
    v_cndmask_b32 v73, 0, v33, s[56:57]
    v_cndmask_b32 v74, 0, v34, s[56:57]
    v_cndmask_b32 v75, 0, v35, s[56:57]
    v_cndmask_b32 v76, 0, v32, s[58:59]
    v_cndmask_b32 v77, 0, v33, s[58:59]
    v_cndmask_b32 v78, 0, v34, s[58:59]
    v_cndmask_b32 v79, 0, v35, s[58:59]
    v_mfma_f32_16x16x32_bf16 v[16:19], v[64:67], a[72:75], 0
    v_mfma_f32_16x16x32_bf16 v[16:19], v[68:71], a[76:79], v[16:19]
    v_mfma_f32_16x16x32_bf16 v[16:19], v[72:75], a[80:83], v[16:19]
    v_mfma_f32_16x16x32_bf16 v[16:19], v[76:79], a[84:87], v[16:19]
    v_mfma_f32_16x16x32_bf16 v[20:23], v[64:67], a[88:91], 0
    v_mfma_f32_16x16x32_bf16 v[20:23], v[68:71], a[92:95], v[20:23]
    v_mfma_f32_16x16x32_bf16 v[20:23], v[72:75], a[96:99], v[20:23]
    v_mfma_f32_16x16x32_bf16 v[20:23], v[76:79], a[100:103], v[20:23]
    v_mfma_f32_16x16x32_bf16 v[24:27], v[64:67], a[104:107], 0
    v_mfma_f32_16x16x32_bf16 v[24:27], v[68:71], a[108:111], v[24:27]
    v_mfma_f32_16x16x32_bf16 v[24:27], v[72:75], a[112:115], v[24:27]
    v_mfma_f32_16x16x32_bf16 v[24:27], v[76:79], a[116:119], v[24:27]
    v_min_u32 v16, -2, v16
    v_min_u32 v17, -2, v17
    buffer_store_dwordx2 v[16:17], v15, s[8:11], s43 offen sc1
    s_add_u32 s43, s43, 294912
    v_min_u32 v20, -2, v20
    v_min_u32 v21, -2, v21
    buffer_store_dwordx2 v[20:21], v15, s[8:11], s43 offen sc1
    s_add_u32 s43, s43, 294912
    v_min_u32 v24, -2, v24
    v_min_u32 v25, -2, v25
    buffer_store_dwordx2 v[24:25], v15, s[8:11], s43 offen sc1
    v_cmp_ne_u32 vcc, s46, v7
    v_cmp_ne_u32 s[36:37], s47, v7
    v_mov_b32 v31, 2147483648
    s_and_b64 vcc, vcc, s[36:37]
    s_nop 1
    v_cndmask_b32 v30, v31, v58, vcc
    v_cndmask_b32 v31, v31, v4, vcc
    buffer_store_dwordx2 v[144:145], v31, s[16:19], 0 offen offset:0
    buffer_store_dwordx2 v[146:147], v31, s[16:19], 0 offen offset:32
    buffer_store_dwordx2 v[148:149], v31, s[16:19], 0 offen offset:512
    buffer_store_dwordx2 v[150:151], v31, s[16:19], 0 offen offset:544
    buffer_store_dwordx2 v[152:153], v30, s[16:19], 0 offen offset:1024
    buffer_store_dwordx2 v[154:155], v30, s[16:19], 0 offen offset:1056
    s_branch Ltail_done
Ltail_noffn:
Ltour13:
    s_cbranch_execz Ltour17
    s_cmp_lt_u32 s41, 27
    s_cselect_b32 s36, s3, 1
    s_cmp_eq_u32 s36, 0
    s_cbranch_scc1 Ltail_final
    v_cmp_ne_u32 vcc, s46, v7
    v_cmp_ne_u32 s[36:37], s47, v7
    v_mov_b32 v31, 2147483648
    s_and_b64 vcc, vcc, s[36:37]
    s_nop 1
    v_cndmask_b32 v30, v31, v58, vcc
    v_cndmask_b32 v31, v31, v4, vcc
    buffer_store_dwordx2 v[144:145], v31, s[16:19], 0 offen offset:0
    buffer_store_dwordx2 v[146:147], v31, s[16:19], 0 offen offset:32
    buffer_store_dwordx2 v[148:149], v31, s[16:19], 0 offen offset:512
    buffer_store_dwordx2 v[150:151], v31, s[16:19], 0 offen offset:544
    buffer_store_dwordx2 v[152:153], v30, s[16:19], 0 offen offset:1024
    buffer_store_dwordx2 v[154:155], v30, s[16:19], 0 offen offset:1056
    s_branch Ltail_done
Ltail_final:
Ltour14:
    s_cbranch_execz Lmain
    s_mul_i32 s43, s42, 9
    s_add_u32 s43, s43, s41
    s_sub_u32 s43, s43, 18
    v_bfe_u32 v8, v1, 2, 1
    v_cmp_eq_u32 vcc, 1, v8
    v_mov_b32 v9, s46
    v_mov_b32 v10, s47
    v_and_b32 v11, 3, v1
    v_cndmask_b32 v9, v9, v10, vcc
    s_lshr_b32 s44, s43, 2
    s_lshl_b32 s44, s44, 6
    s_and_b32 s45, s43, 1
    s_lshl_b32 s45, s45, 5
    s_add_u32 s44, s44, s45
    s_and_b32 s45, s43, 2
    s_lshl_b32 s45, s45, 2
    s_add_u32 s44, s44, s45
    v_lshrrev_b32 v12, 1, v11
    v_lshl_add_u32 v12, v12, 4, s44
    v_and_b32 v13, 1, v11
    v_lshl_add_u32 v12, v13, 2, v12
    v_mul_u32_u24 v13, 1152, v9
    v_lshl_add_u32 v14, v13, 1, v12
    v_add_u32 v15, 2621440, v14
    s_mov_b32 s45, 22144
    buffer_load_dword v18, v12, s[24:27], s45 offen sc1
    v_mov_b32 v19, s92
    v_mov_b32 v10, s93
    v_cndmask_b32 v19, v19, v10, vcc
    v_and_b32 v19, 0xfffff800, v19
    v_or_b32 v19, 0x400, v19
    v_ashrrev_i32 v10, 31, v19
    v_not_b32 v10, v10
    v_or_b32 v10, 0x80000000, v10
    v_xor_b32 v19, v19, v10
    s_lshl_b32 s45, s43, 4
    v_lshl_add_u32 v13, v11, 2, v13
    v_add_u32 v13, s45, v13
    v_lshrrev_b32 v14, 2, v1
    v_lshlrev_b32 v14, 9, v14
    v_lshl_add_u32 v14, v11, 4, v14
    s_lshr_b32 s44, s43, 3
    s_mul_i32 s44, s44, 73728
    s_and_b32 s45, s43, 7
    s_lshl_b32 s45, s45, 6
    s_add_u32 s44, s44, s45
    v_cmp_ne_u32 vcc, s46, v7
    v_cmp_ne_u32 s[36:37], s47, v7
    v_mov_b32 v31, 2147483648
    s_and_b64 vcc, vcc, s[36:37]
    s_nop 1
    v_cndmask_b32 v30, v31, v58, vcc
    v_cndmask_b32 v31, v31, v4, vcc
    buffer_store_dwordx2 v[144:145], v31, s[16:19], 0 offen offset:0
    buffer_store_dwordx2 v[146:147], v31, s[16:19], 0 offen offset:32
    buffer_store_dwordx2 v[148:149], v31, s[16:19], 0 offen offset:512
    buffer_store_dwordx2 v[150:151], v31, s[16:19], 0 offen offset:544
    buffer_store_dwordx2 v[152:153], v30, s[16:19], 0 offen offset:1024
    buffer_store_dwordx2 v[154:155], v30, s[16:19], 0 offen offset:1056
    v_cmp_eq_u32 s[36:37], 1, v8
    v_cvt_pk_bf16_f32 v19, v19, v19
    v_and_b32 v19, 0xffff0000, v19
    v_mul_f32 v19, 0xbfb8aa3b, v19
    v_exp_f32 v19, v19
    s_waitcnt vmcnt(6)
    v_lshlrev_b32 v24, 16, v18
    v_and_b32 v25, 0xffff0000, v18
    v_add_f32 v19, 1.0, v19
    v_rcp_f32 v19, v19
    s_mov_b32 s48, 16384
    v_cvt_pk_bf16_f32 v19, v19, v19
    v_and_b32 v19, 0xffff0000, v19
Ltail_polly:
    s_add_u32 s45, s44, 0
    buffer_load_dwordx4 v[64:67], v14, s[8:11], s45 offen sc1
    s_add_u32 s45, s44, 8192
    buffer_load_dwordx4 v[68:71], v14, s[8:11], s45 offen sc1
    s_add_u32 s45, s44, 16384
    buffer_load_dwordx4 v[72:75], v14, s[8:11], s45 offen sc1
    s_add_u32 s45, s44, 24576
    buffer_load_dwordx4 v[76:79], v14, s[8:11], s45 offen sc1
    s_add_u32 s45, s44, 32768
    buffer_load_dwordx4 v[80:83], v14, s[8:11], s45 offen sc1
    s_add_u32 s45, s44, 40960
    buffer_load_dwordx4 v[84:87], v14, s[8:11], s45 offen sc1
    s_add_u32 s45, s44, 49152
    buffer_load_dwordx4 v[88:91], v14, s[8:11], s45 offen sc1
    s_add_u32 s45, s44, 57344
    buffer_load_dwordx4 v[92:95], v14, s[8:11], s45 offen sc1
    s_add_u32 s45, s44, 65536
    buffer_load_dwordx4 v[96:99], v14, s[8:11], s45 offen sc1
    s_mov_b32 s45, 1152
    buffer_load_dword v16, v15, s[24:27], s45 offen sc1
    buffer_load_dword v17, v15, s[24:27], 0 offen sc1
    s_sub_u32 s48, s48, 1
    s_cbranch_scc1 Ltail_goty
    s_waitcnt vmcnt(10)
    v_max3_u32 v26, v64, v65, v66
    s_waitcnt vmcnt(9)
    v_max3_u32 v26, v26, v67, v68
    v_max3_u32 v26, v26, v69, v70
    s_waitcnt vmcnt(8)
    v_max3_u32 v26, v26, v71, v72
    v_max3_u32 v26, v26, v73, v74
    s_waitcnt vmcnt(7)
    v_max3_u32 v26, v26, v75, v76
    v_max3_u32 v26, v26, v77, v78
    s_waitcnt vmcnt(6)
    v_max3_u32 v26, v26, v79, v80
    v_max3_u32 v26, v26, v81, v82
    s_waitcnt vmcnt(5)
    v_max3_u32 v26, v26, v83, v84
    v_max3_u32 v26, v26, v85, v86
    s_waitcnt vmcnt(4)
    v_max3_u32 v26, v26, v87, v88
    v_max3_u32 v26, v26, v89, v90
    s_waitcnt vmcnt(3)
    v_max3_u32 v26, v26, v91, v92
    v_max3_u32 v26, v26, v93, v94
    s_waitcnt vmcnt(2)
    v_max3_u32 v26, v26, v95, v96
    v_max3_u32 v26, v26, v97, v98
    v_max_u32 v26, v26, v99
    s_waitcnt vmcnt(0)
    v_max3_u32 v26, v26, v16, v17
    v_cmp_eq_u32 vcc, -1, v26
    s_cbranch_vccnz Ltail_polly
Ltail_goty:
    s_waitcnt vmcnt(0) lgkmcnt(0)
    v_lshlrev_b32 v20, 16, v16
    v_and_b32 v21, 0xffff0000, v16
Ltour15:
    s_cbranch_execz Lmain
    v_lshlrev_b32 v22, 16, v17
    v_and_b32 v23, 0xffff0000, v17
    v_pk_add_f32 v[64:65], v[64:65], v[68:69]
    v_pk_add_f32 v[66:67], v[66:67], v[70:71]
    v_pk_add_f32 v[64:65], v[64:65], v[72:73]
    v_pk_add_f32 v[66:67], v[66:67], v[74:75]
    v_pk_add_f32 v[64:65], v[64:65], v[76:77]
    v_pk_add_f32 v[66:67], v[66:67], v[78:79]
    v_pk_add_f32 v[64:65], v[64:65], v[80:81]
    v_pk_add_f32 v[66:67], v[66:67], v[82:83]
    v_pk_add_f32 v[64:65], v[64:65], v[84:85]
    v_pk_add_f32 v[66:67], v[66:67], v[86:87]
    v_pk_add_f32 v[64:65], v[64:65], v[88:89]
    v_pk_add_f32 v[66:67], v[66:67], v[90:91]
    v_pk_add_f32 v[64:65], v[64:65], v[92:93]
    v_pk_add_f32 v[66:67], v[66:67], v[94:95]
    v_pk_add_f32 v[64:65], v[64:65], v[96:97]
    v_pk_add_f32 v[66:67], v[66:67], v[98:99]
    s_nop 0
    v_add_f32_dpp v64, v64, v64 row_ror:4 row_mask:0xf bank_mask:0xf
    v_add_f32_dpp v65, v65, v65 row_ror:4 row_mask:0xf bank_mask:0xf
    v_add_f32_dpp v66, v66, v66 row_ror:4 row_mask:0xf bank_mask:0xf
    v_add_f32_dpp v67, v67, v67 row_ror:4 row_mask:0xf bank_mask:0xf
    v_add_f32_dpp v64, v64, v64 row_ror:8 row_mask:0xf bank_mask:0xf
    v_add_f32_dpp v65, v65, v65 row_ror:8 row_mask:0xf bank_mask:0xf
    v_add_f32_dpp v66, v66, v66 row_ror:8 row_mask:0xf bank_mask:0xf
    v_add_f32_dpp v67, v67, v67 row_ror:8 row_mask:0xf bank_mask:0xf
    v_mov_b32 v68, v64
    v_mov_b32 v69, v65
    v_mov_b32 v70, v66
    v_mov_b32 v71, v67
    v_permlane16_swap_b32 v64, v68
    v_permlane16_swap_b32 v65, v69
    v_permlane16_swap_b32 v66, v70
    v_permlane16_swap_b32 v67, v71
    v_add_f32 v64, v64, v68
    v_add_f32 v65, v65, v69
    v_add_f32 v66, v66, v70
    v_add_f32 v67, v67, v71
    v_mov_b32 v68, v64
    v_mov_b32 v69, v65
    v_mov_b32 v70, v66
    v_mov_b32 v71, v67
    v_permlane32_swap_b32 v64, v68
    v_permlane32_swap_b32 v65, v69
    v_permlane32_swap_b32 v66, v70
    v_permlane32_swap_b32 v67, v71
    v_add_f32 v64, v64, v68
    v_add_f32 v65, v65, v69
    v_add_f32 v66, v66, v70
    v_add_f32 v67, v67, v71
    v_cndmask_b32 v26, v64, v65, s[36:37]
    v_cndmask_b32 v27, v66, v67, s[36:37]
    v_cvt_pk_bf16_f32 v28, v26, v27
    v_lshlrev_b32 v26, 16, v28
    v_and_b32 v27, 0xffff0000, v28
    v_mul_f32 v26, v26, v19
    v_mul_f32 v27, v27, v19
    v_cvt_pk_bf16_f32 v28, v26, v27
    v_lshlrev_b32 v26, 16, v28
    v_and_b32 v27, 0xffff0000, v28
    v_pk_add_f32 v[26:27], v[26:27], v[22:23]
    v_cvt_pk_bf16_f32 v28, v26, v27
    v_lshlrev_b32 v26, 16, v28
    v_and_b32 v27, 0xffff0000, v28
    v_pk_mul_f32 v[26:27], v[26:27], v[24:25]
    v_cvt_pk_bf16_f32 v28, v26, v27
    v_lshlrev_b32 v26, 16, v28
    v_and_b32 v27, 0xffff0000, v28
    v_pk_add_f32 v[26:27], v[26:27], v[20:21]
    v_cvt_pk_bf16_f32 v28, v26, v27
    s_mov_b64 exec, 0xff
    buffer_store_dword v28, v13, s[16:19], 0 offen
Ltail_done:
    s_endpgm
Lattn_wb:
    buffer_wbl2 sc1
    s_waitcnt vmcnt(0)
    s_branch Lattn_wbdone
Lattn_xspin:
    s_mov_b32 s37, 16384
Lattn_xloop:
    buffer_load_dword v11, v8, s[24:27], s54 offen offset:8 sc1
    s_waitcnt vmcnt(0)
    v_readfirstlane_b32 s36, v11
    s_sub_u32 s37, s37, 1
    s_cbranch_scc1 Lattn_xgot
    s_cmp_lg_u32 s36, s95
    s_cbranch_scc1 Lattn_xloop
    s_branch Lattn_xgot
Ltail_spin1:
Ltour16:
    s_cbranch_execz Lmain
    s_mov_b32 s48, 16384
Ltail_spinl1:
    buffer_load_dword v11, v9, s[24:27], s39 offen sc1
    s_waitcnt vmcnt(0)
    v_cmp_ne_u32 s[54:55], s95, v11
    s_sub_u32 s48, s48, 1
    s_cbranch_scc1 Ltail_got1
    s_cmp_lg_u64 s[54:55], 0
    s_cbranch_scc1 Ltail_spinl1
    s_branch Ltail_got1
Ltail_spin2:
Ltour17:
    s_cbranch_execz Lmain
    s_mov_b32 s48, 16384
Ltail_spinl2:
    buffer_load_dword v11, v9, s[24:27], s39 offen sc1
    s_waitcnt vmcnt(0)
    v_cmp_ne_u32 s[54:55], s95, v11
    s_sub_u32 s48, s48, 1
    s_cbranch_scc1 Ltail_got2
    s_cmp_lg_u64 s[54:55], 0
    s_cbranch_scc1 Ltail_spinl2
    s_branch Ltail_got2
Lattn_redo:
    v_xor_b32 v8, 64, v9
    v_xor_b32 v10, 64, v11
    s_waitcnt vmcnt(0) lgkmcnt(0)
    s_barrier
    v_mov_b32 v232, 0xff800000
    v_mov_b32 v233, 0xff800000
    v_mov_b32 v234, 0xff800000
    v_mov_b32 v235, 0xff800000
    s_mov_b32 s40, 0
    s_mov_b32 s48, -1
Lattn_redo_loop:
    s_add_u32 m0, s42, 0
    s_nop 0
    buffer_load_dwordx4 v36, s[8:11], s40 offen lds
    buffer_load_dwordx4 v37, s[8:11], s40 offen offset:1024 lds
    buffer_load_dwordx4 v38, s[8:11], s40 offen offset:2048 lds
    buffer_load_dwordx4 v39, s[8:11], s40 offen offset:3072 lds
    s_add_u32 s40, s40, 16384
    s_waitcnt vmcnt(0) lgkmcnt(0)
    s_barrier
    ds_read_b128 a[208:211], v8 offset:0
    ds_read_b128 a[212:215], v9 offset:0
    ds_read_b128 a[216:219], v10 offset:0
    ds_read_b128 a[220:223], v11 offset:0
    s_waitcnt lgkmcnt(3)
    v_mfma_f32_16x16x32_bf16 v[216:219], a[208:211], v[64:67], 0
    s_waitcnt lgkmcnt(2)
    v_mfma_f32_16x16x32_bf16 v[216:219], a[212:215], v[68:71], v[216:219]
    s_waitcnt lgkmcnt(1)
    v_mfma_f32_16x16x32_bf16 v[216:219], a[216:219], v[72:75], v[216:219]
    s_waitcnt lgkmcnt(0)
    v_mfma_f32_16x16x32_bf16 v[216:219], a[220:223], v[76:79], v[216:219]
    v_mfma_f32_16x16x32_bf16 v[220:223], a[208:211], v[80:83], 0
    v_mfma_f32_16x16x32_bf16 v[220:223], a[212:215], v[84:87], v[220:223]
    v_mfma_f32_16x16x32_bf16 v[220:223], a[216:219], v[88:91], v[220:223]
    v_mfma_f32_16x16x32_bf16 v[220:223], a[220:223], v[92:95], v[220:223]
    v_mfma_f32_16x16x32_bf16 v[224:227], a[208:211], v[96:99], 0
    v_mfma_f32_16x16x32_bf16 v[224:227], a[212:215], v[100:103], v[224:227]
    v_mfma_f32_16x16x32_bf16 v[224:227], a[216:219], v[104:107], v[224:227]
    v_mfma_f32_16x16x32_bf16 v[224:227], a[220:223], v[108:111], v[224:227]
    v_mfma_f32_16x16x32_bf16 v[228:231], a[208:211], v[112:115], 0
    v_mfma_f32_16x16x32_bf16 v[228:231], a[212:215], v[116:119], v[228:231]
    v_mfma_f32_16x16x32_bf16 v[228:231], a[216:219], v[120:123], v[228:231]
    v_mfma_f32_16x16x32_bf16 v[228:231], a[220:223], v[124:127], v[228:231]
    v_max3_f32 v232, v232, v216, v217
    v_max3_f32 v232, v232, v218, v219
    v_max3_f32 v233, v233, v220, v221
    v_max3_f32 v233, v233, v222, v223
    v_max3_f32 v234, v234, v224, v225
    v_max3_f32 v234, v234, v226, v227
    s_nop 1
    v_max3_f32 v235, v235, v228, v229
    v_max3_f32 v235, v235, v230, v231
    ds_read_b128 a[224:227], v8 offset:4096
    ds_read_b128 a[228:231], v9 offset:4096
    ds_read_b128 a[232:235], v10 offset:4096
    ds_read_b128 a[236:239], v11 offset:4096
    s_waitcnt lgkmcnt(3)
    v_mfma_f32_16x16x32_bf16 v[216:219], a[224:227], v[64:67], 0
    s_waitcnt lgkmcnt(2)
    v_mfma_f32_16x16x32_bf16 v[216:219], a[228:231], v[68:71], v[216:219]
    s_waitcnt lgkmcnt(1)
    v_mfma_f32_16x16x32_bf16 v[216:219], a[232:235], v[72:75], v[216:219]
    s_waitcnt lgkmcnt(0)
    v_mfma_f32_16x16x32_bf16 v[216:219], a[236:239], v[76:79], v[216:219]
    v_mfma_f32_16x16x32_bf16 v[220:223], a[224:227], v[80:83], 0
    v_mfma_f32_16x16x32_bf16 v[220:223], a[228:231], v[84:87], v[220:223]
    v_mfma_f32_16x16x32_bf16 v[220:223], a[232:235], v[88:91], v[220:223]
    v_mfma_f32_16x16x32_bf16 v[220:223], a[236:239], v[92:95], v[220:223]
    v_mfma_f32_16x16x32_bf16 v[224:227], a[224:227], v[96:99], 0
    v_mfma_f32_16x16x32_bf16 v[224:227], a[228:231], v[100:103], v[224:227]
    v_mfma_f32_16x16x32_bf16 v[224:227], a[232:235], v[104:107], v[224:227]
    v_mfma_f32_16x16x32_bf16 v[224:227], a[236:239], v[108:111], v[224:227]
    v_mfma_f32_16x16x32_bf16 v[228:231], a[224:227], v[112:115], 0
    v_mfma_f32_16x16x32_bf16 v[228:231], a[228:231], v[116:119], v[228:231]
    v_mfma_f32_16x16x32_bf16 v[228:231], a[232:235], v[120:123], v[228:231]
    v_mfma_f32_16x16x32_bf16 v[228:231], a[236:239], v[124:127], v[228:231]
    v_max3_f32 v232, v232, v216, v217
    v_max3_f32 v232, v232, v218, v219
    v_max3_f32 v233, v233, v220, v221
    v_max3_f32 v233, v233, v222, v223
    v_max3_f32 v234, v234, v224, v225
    v_max3_f32 v234, v234, v226, v227
    s_nop 1
    v_max3_f32 v235, v235, v228, v229
    v_max3_f32 v235, v235, v230, v231
    ds_read_b128 a[208:211], v8 offset:8192
    ds_read_b128 a[212:215], v9 offset:8192
    ds_read_b128 a[216:219], v10 offset:8192
    ds_read_b128 a[220:223], v11 offset:8192
    s_waitcnt lgkmcnt(3)
    v_mfma_f32_16x16x32_bf16 v[216:219], a[208:211], v[64:67], 0
    s_waitcnt lgkmcnt(2)
    v_mfma_f32_16x16x32_bf16 v[216:219], a[212:215], v[68:71], v[216:219]
    s_waitcnt lgkmcnt(1)
    v_mfma_f32_16x16x32_bf16 v[216:219], a[216:219], v[72:75], v[216:219]
    s_waitcnt lgkmcnt(0)
    v_mfma_f32_16x16x32_bf16 v[216:219], a[220:223], v[76:79], v[216:219]
    v_mfma_f32_16x16x32_bf16 v[220:223], a[208:211], v[80:83], 0
    v_mfma_f32_16x16x32_bf16 v[220:223], a[212:215], v[84:87], v[220:223]
    v_mfma_f32_16x16x32_bf16 v[220:223], a[216:219], v[88:91], v[220:223]
    v_mfma_f32_16x16x32_bf16 v[220:223], a[220:223], v[92:95], v[220:223]
    v_mfma_f32_16x16x32_bf16 v[224:227], a[208:211], v[96:99], 0
    v_mfma_f32_16x16x32_bf16 v[224:227], a[212:215], v[100:103], v[224:227]
    v_mfma_f32_16x16x32_bf16 v[224:227], a[216:219], v[104:107], v[224:227]
    v_mfma_f32_16x16x32_bf16 v[224:227], a[220:223], v[108:111], v[224:227]
    v_mfma_f32_16x16x32_bf16 v[228:231], a[208:211], v[112:115], 0
    v_mfma_f32_16x16x32_bf16 v[228:231], a[212:215], v[116:119], v[228:231]
    v_mfma_f32_16x16x32_bf16 v[228:231], a[216:219], v[120:123], v[228:231]
    v_mfma_f32_16x16x32_bf16 v[228:231], a[220:223], v[124:127], v[228:231]
    v_max3_f32 v232, v232, v216, v217
    v_max3_f32 v232, v232, v218, v219
    v_max3_f32 v233, v233, v220, v221
    v_max3_f32 v233, v233, v222, v223
    v_max3_f32 v234, v234, v224, v225
    v_max3_f32 v234, v234, v226, v227
    s_nop 1
    v_max3_f32 v235, v235, v228, v229
    v_max3_f32 v235, v235, v230, v231
    ds_read_b128 a[224:227], v8 offset:12288
    ds_read_b128 a[228:231], v9 offset:12288
    ds_read_b128 a[232:235], v10 offset:12288
    ds_read_b128 a[236:239], v11 offset:12288
    s_waitcnt lgkmcnt(3)
    v_mfma_f32_16x16x32_bf16 v[216:219], a[224:227], v[64:67], 0
    s_waitcnt lgkmcnt(2)
    v_mfma_f32_16x16x32_bf16 v[216:219], a[228:231], v[68:71], v[216:219]
    s_waitcnt lgkmcnt(1)
    v_mfma_f32_16x16x32_bf16 v[216:219], a[232:235], v[72:75], v[216:219]
    s_waitcnt lgkmcnt(0)
    v_mfma_f32_16x16x32_bf16 v[216:219], a[236:239], v[76:79], v[216:219]
    v_mfma_f32_16x16x32_bf16 v[220:223], a[224:227], v[80:83], 0
    v_mfma_f32_16x16x32_bf16 v[220:223], a[228:231], v[84:87], v[220:223]
    v_mfma_f32_16x16x32_bf16 v[220:223], a[232:235], v[88:91], v[220:223]
    v_mfma_f32_16x16x32_bf16 v[220:223], a[236:239], v[92:95], v[220:223]
    v_mfma_f32_16x16x32_bf16 v[224:227], a[224:227], v[96:99], 0
    v_mfma_f32_16x16x32_bf16 v[224:227], a[228:231], v[100:103], v[224:227]
    v_mfma_f32_16x16x32_bf16 v[224:227], a[232:235], v[104:107], v[224:227]
    v_mfma_f32_16x16x32_bf16 v[224:227], a[236:239], v[108:111], v[224:227]
    v_mfma_f32_16x16x32_bf16 v[228:231], a[224:227], v[112:115], 0
    v_mfma_f32_16x16x32_bf16 v[228:231], a[228:231], v[116:119], v[228:231]
    v_mfma_f32_16x16x32_bf16 v[228:231], a[232:235], v[120:123], v[228:231]
    v_mfma_f32_16x16x32_bf16 v[228:231], a[236:239], v[124:127], v[228:231]
    v_max3_f32 v232, v232, v216, v217
    v_max3_f32 v232, v232, v218, v219
    v_max3_f32 v233, v233, v220, v221
    v_max3_f32 v233, v233, v222, v223
    v_max3_f32 v234, v234, v224, v225
    v_max3_f32 v234, v234, v226, v227
    s_nop 1
    v_max3_f32 v235, v235, v228, v229
    v_max3_f32 v235, v235, v230, v231
    s_barrier
    s_cmp_lt_u32 s40, 524288
    s_cbranch_scc1 Lattn_redo_loop
    v_mov_b32 v236, v232
    v_mov_b32 v237, v233
    v_mov_b32 v238, v234
    v_mov_b32 v239, v235
    v_permlane16_swap_b32 v232, v236
    v_permlane16_swap_b32 v233, v237
    v_permlane16_swap_b32 v234, v238
    v_permlane16_swap_b32 v235, v239
    v_max_f32 v232, v232, v236
    v_max_f32 v233, v233, v237
    v_max_f32 v234, v234, v238
    v_max_f32 v235, v235, v239
    v_mov_b32 v236, v232
    v_mov_b32 v237, v233
    v_mov_b32 v238, v234
    v_mov_b32 v239, v235
    v_permlane32_swap_b32 v232, v236
    v_permlane32_swap_b32 v233, v237
    v_permlane32_swap_b32 v234, v238
    v_permlane32_swap_b32 v235, v239
    v_max_f32 v232, v232, v236
    v_max_f32 v233, v233, v237
    v_max_f32 v234, v234, v238
    v_max_f32 v235, v235, v239
    v_sub_f32 v192, 0, v232
    v_sub_f32 v193, 0, v232
    v_sub_f32 v194, 0, v232
    v_sub_f32 v195, 0, v232
    v_sub_f32 v196, 0, v233
    v_sub_f32 v197, 0, v233
    v_sub_f32 v198, 0, v233
    v_sub_f32 v199, 0, v233
    v_sub_f32 v200, 0, v234
    v_sub_f32 v201, 0, v234
    v_sub_f32 v202, 0, v234
    v_sub_f32 v203, 0, v234
    v_sub_f32 v204, 0, v235
    v_sub_f32 v205, 0, v235
    v_sub_f32 v206, 0, v235
    v_sub_f32 v207, 0, v235
    s_mov_b32 s40, 0
    s_mov_b32 s41, 0
    s_add_u32 m0, s42, 0
    s_nop 0
    buffer_load_dwordx4 v36, s[8:11], s40 offen lds
    buffer_load_dwordx4 v37, s[8:11], s40 offen offset:1024 lds
    buffer_load_dwordx4 v38, s[8:11], s40 offen offset:2048 lds
    buffer_load_dwordx4 v39, s[8:11], s40 offen offset:3072 lds
    s_add_u32 s40, s40, 16384
    s_add_u32 m0, s42, 16384
    s_nop 0
    buffer_load_dwordx4 v36, s[8:11], s40 offen lds
    buffer_load_dwordx4 v37, s[8:11], s40 offen offset:1024 lds
    buffer_load_dwordx4 v38, s[8:11], s40 offen offset:2048 lds
    buffer_load_dwordx4 v39, s[8:11], s40 offen offset:3072 lds
    s_add_u32 s40, s40, 16384
    s_add_u32 m0, s42, 32768
    s_nop 0
    buffer_load_dwordx4 v36, s[8:11], s40 offen lds
    buffer_load_dwordx4 v37, s[8:11], s40 offen offset:1024 lds
    buffer_load_dwordx4 v38, s[8:11], s40 offen offset:2048 lds
    buffer_load_dwordx4 v39, s[8:11], s40 offen offset:3072 lds
    s_add_u32 s40, s40, 16384
    s_add_u32 m0, s42, 65536
    s_nop 0
    buffer_load_dwordx4 v40, s[12:15], s41 offen lds
    buffer_load_dwordx4 v41, s[12:15], s41 offen offset:1024 lds
    buffer_load_dwordx4 v40, s[12:15], s41 offen offset:2048 lds
    buffer_load_dwordx4 v41, s[12:15], s41 offen offset:3072 lds
    s_add_u32 s41, s41, 16384
    s_add_u32 m0, s42, 81920
    s_nop 0
    buffer_load_dwordx4 v40, s[12:15], s41 offen lds
    buffer_load_dwordx4 v41, s[12:15], s41 offen offset:1024 lds
    buffer_load_dwordx4 v40, s[12:15], s41 offen offset:2048 lds
    buffer_load_dwordx4 v41, s[12:15], s41 offen offset:3072 lds
    s_add_u32 s41, s41, 16384
    v_accvgpr_write_b32 a0, 0
    v_accvgpr_write_b32 a1, 0
    v_accvgpr_write_b32 a2, 0
    v_accvgpr_write_b32 a3, 0
    v_accvgpr_write_b32 a4, 0
    v_accvgpr_write_b32 a5, 0
    v_accvgpr_write_b32 a6, 0
    v_accvgpr_write_b32 a7, 0
    v_accvgpr_write_b32 a8, 0
    v_accvgpr_write_b32 a9, 0
    v_accvgpr_write_b32 a10, 0
    v_accvgpr_write_b32 a11, 0
    v_accvgpr_write_b32 a12, 0
    v_accvgpr_write_b32 a13, 0
    v_accvgpr_write_b32 a14, 0
    v_accvgpr_write_b32 a15, 0
    v_accvgpr_write_b32 a16, 0
    v_accvgpr_write_b32 a17, 0
    v_accvgpr_write_b32 a18, 0
    v_accvgpr_write_b32 a19, 0
    v_accvgpr_write_b32 a20, 0
    v_accvgpr_write_b32 a21, 0
    v_accvgpr_write_b32 a22, 0
    v_accvgpr_write_b32 a23, 0
    v_accvgpr_write_b32 a24, 0
    v_accvgpr_write_b32 a25, 0
    v_accvgpr_write_b32 a26, 0
    v_accvgpr_write_b32 a27, 0
    v_accvgpr_write_b32 a28, 0
    v_accvgpr_write_b32 a29, 0
    v_accvgpr_write_b32 a30, 0
    v_accvgpr_write_b32 a31, 0
    v_accvgpr_write_b32 a32, 0
    v_accvgpr_write_b32 a33, 0
    v_accvgpr_write_b32 a34, 0
    v_accvgpr_write_b32 a35, 0
    v_accvgpr_write_b32 a36, 0
    v_accvgpr_write_b32 a37, 0
    v_accvgpr_write_b32 a38, 0
    v_accvgpr_write_b32 a39, 0
    v_accvgpr_write_b32 a40, 0
    v_accvgpr_write_b32 a41, 0
    v_accvgpr_write_b32 a42, 0
    v_accvgpr_write_b32 a43, 0
    v_accvgpr_write_b32 a44, 0
    v_accvgpr_write_b32 a45, 0
    v_accvgpr_write_b32 a46, 0
    v_accvgpr_write_b32 a47, 0
    v_accvgpr_write_b32 a48, 0
    v_accvgpr_write_b32 a49, 0
    v_accvgpr_write_b32 a50, 0
    v_accvgpr_write_b32 a51, 0
    v_accvgpr_write_b32 a52, 0
    v_accvgpr_write_b32 a53, 0
    v_accvgpr_write_b32 a54, 0
    v_accvgpr_write_b32 a55, 0
    v_accvgpr_write_b32 a56, 0
    v_accvgpr_write_b32 a57, 0
    v_accvgpr_write_b32 a58, 0
    v_accvgpr_write_b32 a59, 0
    v_accvgpr_write_b32 a60, 0
    v_accvgpr_write_b32 a61, 0
    v_accvgpr_write_b32 a62, 0
    v_accvgpr_write_b32 a63, 0
    v_accvgpr_write_b32 a64, 0
    v_accvgpr_write_b32 a65, 0
    v_accvgpr_write_b32 a66, 0
    v_accvgpr_write_b32 a67, 0
    v_accvgpr_write_b32 a68, 0
    v_accvgpr_write_b32 a69, 0
    v_accvgpr_write_b32 a70, 0
    v_accvgpr_write_b32 a71, 0
    v_accvgpr_write_b32 a72, 0
    v_accvgpr_write_b32 a73, 0
    v_accvgpr_write_b32 a74, 0
    v_accvgpr_write_b32 a75, 0
    v_accvgpr_write_b32 a76, 0
    v_accvgpr_write_b32 a77, 0
    v_accvgpr_write_b32 a78, 0
    v_accvgpr_write_b32 a79, 0
    v_accvgpr_write_b32 a80, 0
    v_accvgpr_write_b32 a81, 0
    v_accvgpr_write_b32 a82, 0
    v_accvgpr_write_b32 a83, 0
    v_accvgpr_write_b32 a84, 0
    v_accvgpr_write_b32 a85, 0
    v_accvgpr_write_b32 a86, 0
    v_accvgpr_write_b32 a87, 0
    v_accvgpr_write_b32 a88, 0
    v_accvgpr_write_b32 a89, 0
    v_accvgpr_write_b32 a90, 0
    v_accvgpr_write_b32 a91, 0
    v_accvgpr_write_b32 a92, 0
    v_accvgpr_write_b32 a93, 0
    v_accvgpr_write_b32 a94, 0
    v_accvgpr_write_b32 a95, 0
    v_accvgpr_write_b32 a96, 0
    v_accvgpr_write_b32 a97, 0
    v_accvgpr_write_b32 a98, 0
    v_accvgpr_write_b32 a99, 0
    v_accvgpr_write_b32 a100, 0
    v_accvgpr_write_b32 a101, 0
    v_accvgpr_write_b32 a102, 0
    v_accvgpr_write_b32 a103, 0
    v_accvgpr_write_b32 a104, 0
    v_accvgpr_write_b32 a105, 0
    v_accvgpr_write_b32 a106, 0
    v_accvgpr_write_b32 a107, 0
    v_accvgpr_write_b32 a108, 0
    v_accvgpr_write_b32 a109, 0
    v_accvgpr_write_b32 a110, 0
    v_accvgpr_write_b32 a111, 0
    v_accvgpr_write_b32 a112, 0
    v_accvgpr_write_b32 a113, 0
    v_accvgpr_write_b32 a114, 0
    v_accvgpr_write_b32 a115, 0
    v_accvgpr_write_b32 a116, 0
    v_accvgpr_write_b32 a117, 0
    v_accvgpr_write_b32 a118, 0
    v_accvgpr_write_b32 a119, 0
    v_accvgpr_write_b32 a120, 0
    v_accvgpr_write_b32 a121, 0
    v_accvgpr_write_b32 a122, 0
    v_accvgpr_write_b32 a123, 0
    v_accvgpr_write_b32 a124, 0
    v_accvgpr_write_b32 a125, 0
    v_accvgpr_write_b32 a126, 0
    v_accvgpr_write_b32 a127, 0
    v_accvgpr_write_b32 a192, 0
    v_accvgpr_write_b32 a193, 0
    v_accvgpr_write_b32 a194, 0
    v_accvgpr_write_b32 a195, 0
    v_accvgpr_write_b32 a196, 0
    v_accvgpr_write_b32 a197, 0
    v_accvgpr_write_b32 a198, 0
    v_accvgpr_write_b32 a199, 0
    v_accvgpr_write_b32 a200, 0
    v_accvgpr_write_b32 a201, 0
    v_accvgpr_write_b32 a202, 0
    v_accvgpr_write_b32 a203, 0
    v_accvgpr_write_b32 a204, 0
    v_accvgpr_write_b32 a205, 0
    v_accvgpr_write_b32 a206, 0
    v_accvgpr_write_b32 a207, 0
    s_waitcnt vmcnt(0) lgkmcnt(0)
    s_barrier
    ds_read_b128 a[208:211], v8 offset:0
    ds_read_b128 a[212:215], v9 offset:0
    ds_read_b128 a[216:219], v10 offset:0
    ds_read_b128 a[220:223], v11 offset:0
    ds_read_b128 a[224:227], v8 offset:4096
    s_waitcnt vmcnt(0) lgkmcnt(0)
    s_branch Lattn_stage0
Lattn_armwait:
    s_mov_b32 s36, 16384
Lattn_armloop:
    v_mov_b32 v63, 0
    buffer_load_dword v63, v63, s[88:91], 0 offen sc1
    s_waitcnt vmcnt(0)
    v_readfirstlane_b32 s37, v63
    s_sub_u32 s36, s36, 1
    s_cbranch_scc1 Lattn_armed
    s_cmp_lt_u32 s37, 256
    s_cbranch_scc1 Lattn_armloop
    s_branch Lattn_armed
Lattn_end:
    s_endpgm
.section .rodata,"a"
.p2align 6
.amdhsa_kernel adaLN_cond__gqa_block_cached__moe_arch_mod__prompt_kernel
  .amdhsa_next_free_vgpr 512
  .amdhsa_next_free_sgpr 102
  .amdhsa_accum_offset 256
  .amdhsa_group_segment_fixed_size 0
  .amdhsa_kernarg_size 120
  .amdhsa_user_sgpr_count 2
  .amdhsa_user_sgpr_kernarg_segment_ptr 1
  .amdhsa_system_sgpr_workgroup_id_x 1
  .amdhsa_float_denorm_mode_32 3
.end_amdhsa_kernel
```

```asm
; @launch grid=(256,1,1) block=(256,1,1) lds=163840
.amdgcn_target "amdgcn-amd-amdhsa--gfx950"
.text
.globl adaLN_cond__gqa_block_cached__moe_arch_mod__prompt_kernel
.p2align 8
.type adaLN_cond__gqa_block_cached__moe_arch_mod__prompt_kernel,@function
adaLN_cond__gqa_block_cached__moe_arch_mod__prompt_kernel:
    s_cmp_ge_u32 s2, 256
    s_cbranch_scc1 Lattn_end
    s_load_dwordx2 s[8:9], s[0:1], 80
    s_load_dwordx2 s[12:13], s[0:1], 88
    s_load_dwordx2 s[20:21], s[0:1], 0
    s_load_dwordx2 s[50:51], s[0:1], 112
    s_load_dwordx8 s[52:59], s[0:1], 8
    s_load_dwordx4 s[80:83], s[0:1], 56
    s_load_dwordx2 s[84:85], s[0:1], 72
    s_load_dwordx2 s[88:89], s[0:1], 104
    s_getpc_b64 s[32:33]
Lattn_pc:
    s_mov_b32 s34, Lattn_end-Lattn_pc
    s_mov_b32 s35, 0x20000
    s_lshr_b32 s6, s2, 3
    s_lshl_b32 s7, s6, 6
    v_lshrrev_b32 v3, 6, v0
    v_and_b32 v1, 63, v0
    v_lshrrev_b32 v2, 2, v0
    v_lshlrev_b32 v2, 11, v2
    v_readfirstlane_b32 s3, v3
    buffer_load_dword v240, v2, s[32:35], s7 offen
    s_and_b32 s7, s2, 7
    s_lshl_b32 s4, s7, 1
    s_and_b32 s5, s6, 1
    s_add_u32 s4, s4, s5
    s_lshr_b32 s5, s2, 4
    s_lshr_b32 s38, s6, 2
    s_lshl_b32 s38, s38, 3
    s_add_u32 s38, s38, s7
    s_cmp_lt_u32 s38, 18
    s_cselect_b32 s39, 0, 2147483648
    s_lshl_b32 s38, s38, 2
    s_and_b32 s36, s6, 3
    s_add_u32 s38, s38, s36
    s_mov_b32 s14, 3981312
    s_mul_i32 s92, s6, 124416
    s_lshl_b32 s36, s7, 7
    s_add_u32 s92, s92, s36
    s_cmp_lt_u32 s7, 2
    s_cselect_b32 s36, 53, 35
    v_lshrrev_b32 v2, 2, v0
    v_min_u32 v2, s36, v2
    v_mul_u32_u24 v3, 57, v2
    v_lshrrev_b32 v3, 10, v3
    v_mul_i32_i24 v3, -123392, v3
    v_mul_u32_u24 v2, 6912, v2
    v_add_u32 v72, v2, v3
    s_mov_b32 s15, 0x20000
    s_mov_b32 s10, 1152
    s_mov_b32 s11, 0x20000
    s_mov_b32 s22, 2359296
    s_mov_b32 s23, 0x20000
    v_and_b32 v64, 0xfe, v0
    v_mul_u32_u24 v65, 3456, v64
    v_and_b32 v2, 1, v0
    v_lshl_add_u32 v65, v2, 4, v65
    s_lshl_b32 s36, s38, 5
    s_or_b32 s36, s36, s39
    v_and_b32 v4, 31, v1
    v_lshrrev_b32 v5, 5, v1
    v_cmp_gt_u32 vcc, 24, v4
    v_mov_b32 v6, 2147483648
    s_lshl_b32 s7, s5, 4
    s_add_u32 s7, s7, s4
    s_lshl_b32 s7, s7, 2
    s_add_u32 s7, s7, s3
    v_cndmask_b32 v6, v6, 0, vcc
    s_mul_i32 s49, s7, 2304
    v_lshrrev_b32 v7, 2, v4
    v_lshl_add_u32 v7, v7, 6, v6
    v_and_b32 v2, 3, v4
    v_lshl_add_u32 v7, v2, 3, v7
    v_mul_u32_u24 v2, 1152, v5
    v_add_u32 v66, v7, v2
    s_waitcnt lgkmcnt(0)
    s_load_dword s94, s[50:51], 24576
    buffer_load_dword v241, v72, s[12:15], s92 offen
    buffer_load_ushort v80, v64, s[8:11], 0 offen offset:0
    buffer_load_ushort v81, v64, s[8:11], 0 offen offset:256
    buffer_load_ushort v82, v64, s[8:11], 0 offen offset:512
    buffer_load_ushort v83, v64, s[8:11], 0 offen offset:768
    buffer_load_ushort v84, v64, s[8:11], 0 offen offset:1024
    buffer_load_dwordx4 v[88:91], v65, s[12:15], s36 offen
    s_add_u32 s36, s36, 884736
    buffer_load_dwordx4 v[92:95], v65, s[12:15], s36 offen
    s_add_u32 s36, s36, 884736
    buffer_load_dwordx4 v[96:99], v65, s[12:15], s36 offen
    s_add_u32 s36, s36, 884736
    buffer_load_dwordx4 v[100:103], v65, s[12:15], s36 offen
    s_add_u32 s36, s36, 884736
    buffer_load_dwordx4 v[104:107], v65, s[12:15], s36 offen
    s_mov_b32 s16, s56
    s_mov_b32 s17, s57
    s_mov_b32 s18, 4718592
    s_mov_b32 s19, 0x20000
    s_lshl_b32 s44, s4, 9
    s_mul_i32 s36, s5, 98304
    s_add_u32 s36, s36, 0
    v_lshrrev_b32 v2, 2, v0
    v_min_u32 v2, 47, v2
    v_lshrrev_b32 v3, 2, v2
    v_and_b32 v2, 3, v2
    v_lshl_add_u32 v2, v2, 7, s36
    v_lshl_add_u32 v71, v3, 13, v2
    s_mul_i32 s36, s5, 196608
    s_add_u32 s36, s36, 1572864
    v_lshrrev_b32 v2, 1, v0
    v_min_u32 v2, 95, v2
    v_lshrrev_b32 v3, 2, v2
    v_and_b32 v2, 3, v2
    v_lshl_add_u32 v2, v2, 7, s36
    v_lshl_add_u32 v70, v3, 13, v2
    s_add_u32 s92, s49, 65536
    v_lshl_add_u32 v7, v5, 4, v6
    v_lshl_add_u32 v67, v4, 5, v7
    v_min_u32 v4, 23, v4
    v_lshlrev_b32 v68, 4, v4
    s_mov_b32 s24, s50
    s_mov_b32 s25, s51
    s_mov_b32 s26, 10485760
    s_mov_b32 s27, 0x20000
    s_mov_b32 s90, 256
    s_mov_b32 s91, 0x20000
    s_cmp_ge_u32 s38, 36
    s_cselect_b32 s93, 1.0, 0
    s_lshl_b32 s36, s38, 7
    v_lshl_add_u32 v69, v0, 3, s36
    v_cmp_gt_u32 s[36:37], 8, v0
    v_mov_b32 v2, 2147483648
    v_mov_b32 v3, s39
    v_cndmask_b32 v2, v2, v3, s[36:37]
    v_or_b32 v69, v69, v2
    s_mul_i32 s36, s5, 3072
    s_lshl_b32 s37, s5, 11
    v_lshrrev_b32 v120, 3, v0
    v_min_u32 v120, 23, v120
    v_lshl_add_u32 v120, v120, 7, s36
    v_lshrrev_b32 v121, 4, v0
    v_lshl_add_u32 v121, v121, 7, s37
    s_lshl_b32 s42, s3, 12
    v_lshrrev_b32 v2, 4, v1
    v_and_b32 v3, 15, v1
    v_lshrrev_b32 v5, 1, v3
    v_mul_u32_u24 v5, 2304, v5
    v_lshl_add_u32 v5, v2, 5, v5
    v_and_b32 v6, 1, v3
    v_lshl_add_u32 v51, v6, 4, v5
    s_lshl_b32 s6, s5, 2
    s_add_u32 s6, s6, s3
    s_mul_i32 s46, s6, 36864
    s_add_u32 s46, s46, 65536
    s_add_u32 s43, s46, 18432
    s_mul_i32 s45, s4, 294912
    s_lshl_b32 s7, s3, 4
    v_add_u32 v4, s7, v2
    v_lshlrev_b32 v5, 1, v2
    v_xor_b32 v5, v5, v3
    v_xor_b32 v6, 8, v5
    v_lshlrev_b32 v7, 13, v4
    v_lshl_add_u32 v42, v5, 4, v7
    v_lshl_add_u32 v43, v6, 4, v7
    v_add_u32 v44, 63488, v42
    v_add_u32 v45, 95232, v43
    v_add_u32 v43, 31744, v43
    s_lshl_b32 s7, s4, 19
    s_add_u32 s8, s52, s7
    s_addc_u32 s9, s53, 0
    s_mov_b32 s10, 524288
    s_mov_b32 s11, 0x20000
    s_add_u32 s12, s54, s7
    s_addc_u32 s13, s55, 0
    s_mov_b32 s14, 524288
    s_mov_b32 s15, 0x20000
    s_add_u32 s28, s50, 10485760
    s_addc_u32 s29, s51, 0
    s_mov_b32 s30, 37748736
    s_mov_b32 s31, 0x20000
    v_lshlrev_b32 v7, 8, v4
    v_lshl_add_u32 v40, v5, 4, v7
    v_lshl_add_u32 v41, v6, 4, v7
    v_xor_b32 v224, v3, v2
    v_lshl_add_u32 v36, v224, 4, v7
    v_xor_b32 v37, 64, v36
    v_xor_b32 v38, 128, v36
    v_xor_b32 v39, 192, v36
    v_lshrrev_b32 v7, 3, v5
    v_lshl_add_u32 v7, v7, 7, v4
    v_mul_u32_u24 v7, 1152, v7
    v_and_b32 v225, 7, v5
    v_lshl_add_u32 v46, v225, 4, v7
    v_lshrrev_b32 v7, 3, v6
    v_lshl_add_u32 v7, v7, 7, v4
    v_mul_u32_u24 v7, 1152, v7
    v_and_b32 v225, 7, v6
    v_lshl_add_u32 v47, v225, 4, v7
    v_add_u32 v48, 7168, v46
    v_add_u32 v49, 10752, v47
    v_add_u32 v47, 3584, v47
    v_lshlrev_b32 v7, 8, v3
    v_lshl_add_u32 v8, v224, 4, v7
    v_xor_b32 v9, 64, v8
    v_xor_b32 v10, 128, v8
    v_xor_b32 v11, 192, v8
    v_lshrrev_b32 v5, 2, v1
    v_and_b32 v6, 7, v5
    v_lshlrev_b32 v6, 5, v6
    v_lshl_add_u32 v6, v5, 8, v6
    v_and_b32 v7, 3, v1
    v_lshl_add_u32 v12, v7, 3, v6
    v_xor_b32 v13, 32, v12
    v_xor_b32 v14, 64, v12
    v_xor_b32 v15, 96, v12
    v_xor_b32 v16, 128, v12
    v_xor_b32 v17, 160, v12
    v_xor_b32 v18, 192, v12
    v_xor_b32 v19, 224, v12
    v_add_u32 v20, 65536, v12
    v_add_u32 v21, 65536, v13
    v_add_u32 v22, 65536, v14
    v_add_u32 v23, 65536, v15
    v_add_u32 v24, 65536, v16
    v_add_u32 v25, 65536, v17
    v_add_u32 v26, 65536, v18
    v_add_u32 v27, 65536, v19
    v_add_u32 v28, 131072, v12
    v_add_u32 v29, 131072, v13
    v_add_u32 v30, 131072, v14
    v_add_u32 v31, 131072, v15
    v_add_u32 v32, 131072, v16
    v_add_u32 v33, 131072, v17
    v_add_u32 v34, 131072, v18
    v_add_u32 v35, 131072, v19
    v_mov_b32 v52, 0x3f803f80
    v_mov_b32 v53, 0x3f803f80
    v_mov_b32 v54, 0x3f803f80
    v_mov_b32 v55, 0x3f803f80
    v_and_b32 v5, 1, v1
    v_mul_u32_u24 v5, 0xaaaa, v5
    v_add_u32 v5, 0x4444, v5
    v_lshl_add_u32 v50, v5, 16, v5
    v_lshrrev_b32 v5, 1, v3
    v_mul_u32_u24 v5, 20480, v5
    v_lshl_add_u32 v5, v2, 5, v5
    v_and_b32 v6, 1, v3
    v_lshl_add_u32 v56, v6, 4, v5
    s_mul_i32 s47, s6, 327680
    s_mov_b32 s32, s82
    s_mov_b32 s33, s83
    s_mov_b32 s34, 5308416
    s_mov_b32 s35, 0x20000
    s_mov_b32 s82, 5308416
    s_mov_b32 s83, 0x20000
    s_mov_b32 s86, 5308416
    s_mov_b32 s87, 0x20000
    s_lshr_b32 s7, s2, 3
    s_mul_i32 s7, s7, 18
    s_add_u32 s7, s7, s3
    s_and_b32 s36, s2, 7
    s_mul_i32 s37, s36, 576
    s_add_u32 s37, s37, s7
    s_mul_i32 s37, s37, 1152
    s_mul_i32 s7, s7, 9216
    s_mul_i32 s36, s36, 1152
    s_add_u32 s7, s7, s36
    v_min_u32 v5, 17, v1
    v_lshl_add_u32 v57, v5, 6, s7
    v_lshl_add_u32 v62, v5, 6, s37
    s_mov_b32 s40, 0
    s_mov_b32 s41, 0
    s_mov_b32 s48, 0
    s_waitcnt vmcnt(9)
    v_lshlrev_b32 v80, 16, v80
    s_waitcnt vmcnt(8)
    v_lshlrev_b32 v81, 16, v81
    s_waitcnt vmcnt(7)
    v_lshlrev_b32 v82, 16, v82
    s_waitcnt vmcnt(6)
    v_lshlrev_b32 v83, 16, v83
    s_waitcnt vmcnt(5)
    v_lshlrev_b32 v84, 16, v84
    v_mul_f32 v144, 0xbfb8aa3b, v80
    v_mul_f32 v148, 0xbfb8aa3b, v81
    v_mul_f32 v152, 0xbfb8aa3b, v82
    v_mul_f32 v156, 0xbfb8aa3b, v83
    v_mul_f32 v160, 0xbfb8aa3b, v84
    v_min_f32 v144, 0x42fc0000, v144
    v_min_f32 v148, 0x42fc0000, v148
    v_min_f32 v152, 0x42fc0000, v152
    v_min_f32 v156, 0x42fc0000, v156
    v_min_f32 v160, 0x42fc0000, v160
    v_exp_f32 v144, v144
    v_exp_f32 v148, v148
    v_exp_f32 v152, v152
    v_exp_f32 v156, v156
    v_exp_f32 v160, v160
    v_add_f32 v144, 1.0, v144
    v_add_f32 v148, 1.0, v148
    v_add_f32 v152, 1.0, v152
    v_add_f32 v156, 1.0, v156
    v_add_f32 v160, 1.0, v160
    v_rcp_f32 v145, v144
    v_rcp_f32 v149, v148
    v_rcp_f32 v153, v152
    v_rcp_f32 v157, v156
    v_rcp_f32 v161, v160
    v_mul_f32 v146, v80, v145
    v_mul_f32 v150, v81, v149
    v_mul_f32 v154, v82, v153
    v_mul_f32 v158, v83, v157
    v_mul_f32 v162, v84, v161
    v_fma_f32 v144, -v146, v144, v80
    v_fma_f32 v148, -v150, v148, v81
    v_fma_f32 v152, -v154, v152, v82
    v_fma_f32 v156, -v158, v156, v83
    v_fma_f32 v160, -v162, v160, v84
    v_fma_f32 v80, v144, v145, v146
    v_fma_f32 v81, v148, v149, v150
    v_fma_f32 v82, v152, v153, v154
    v_fma_f32 v83, v156, v157, v158
    v_fma_f32 v84, v160, v161, v162
    v_cvt_pk_bf16_f32 v80, v80, v80
    v_cvt_pk_bf16_f32 v81, v81, v81
    v_cvt_pk_bf16_f32 v82, v82, v82
    v_cvt_pk_bf16_f32 v83, v83, v83
    v_cvt_pk_bf16_f32 v84, v84, v84
    v_and_b32 v80, 0xffff0000, v80
    v_and_b32 v81, 0xffff0000, v81
    v_and_b32 v82, 0xffff0000, v82
    v_and_b32 v83, 0xffff0000, v83
    v_and_b32 v84, 0xffff0000, v84
    buffer_load_dwordx2 v[108:109], v66, s[20:23], s49 offen offset:0
    buffer_load_dwordx2 v[110:111], v66, s[20:23], s49 offen offset:32
    buffer_load_dwordx2 v[112:113], v66, s[20:23], s49 offen offset:384
    buffer_load_dwordx2 v[114:115], v66, s[20:23], s49 offen offset:416
    buffer_load_dwordx2 v[116:117], v66, s[20:23], s49 offen offset:768
    buffer_load_dwordx2 v[118:119], v66, s[20:23], s49 offen offset:800
    s_mov_b32 s20, s58
    s_mov_b32 s21, s59
    s_mov_b32 s22, 4718592
    s_mov_b32 s23, 0x20000
    buffer_load_dword v242, v71, s[16:19], s44 offen
    s_waitcnt vmcnt(11)
    v_lshlrev_b32 v136, 16, v88
    v_and_b32 v137, 0xffff0000, v88
    v_lshlrev_b32 v138, 16, v89
    v_and_b32 v139, 0xffff0000, v89
    v_lshlrev_b32 v140, 16, v90
    v_and_b32 v141, 0xffff0000, v90
    v_lshlrev_b32 v142, 16, v91
    v_and_b32 v143, 0xffff0000, v91
    v_pk_mul_f32 v[128:129], v[136:137], v[80:81] op_sel:[0,0] op_sel_hi:[1,0]
    v_pk_mul_f32 v[130:131], v[138:139], v[80:81] op_sel:[0,0] op_sel_hi:[1,0]
    v_pk_mul_f32 v[132:133], v[140:141], v[80:81] op_sel:[0,0] op_sel_hi:[1,0]
    v_pk_mul_f32 v[134:135], v[142:143], v[80:81] op_sel:[0,0] op_sel_hi:[1,0]
    s_waitcnt vmcnt(10)
    v_lshlrev_b32 v136, 16, v92
    v_and_b32 v137, 0xffff0000, v92
    v_lshlrev_b32 v138, 16, v93
    v_and_b32 v139, 0xffff0000, v93
    v_lshlrev_b32 v140, 16, v94
    v_and_b32 v141, 0xffff0000, v94
    v_lshlrev_b32 v142, 16, v95
    v_and_b32 v143, 0xffff0000, v95
    v_pk_fma_f32 v[128:129], v[136:137], v[80:81], v[128:129] op_sel:[0,1,0] op_sel_hi:[1,1,1]
    v_pk_fma_f32 v[130:131], v[138:139], v[80:81], v[130:131] op_sel:[0,1,0] op_sel_hi:[1,1,1]
    v_pk_fma_f32 v[132:133], v[140:141], v[80:81], v[132:133] op_sel:[0,1,0] op_sel_hi:[1,1,1]
    v_pk_fma_f32 v[134:135], v[142:143], v[80:81], v[134:135] op_sel:[0,1,0] op_sel_hi:[1,1,1]
    s_waitcnt vmcnt(9)
    v_lshlrev_b32 v136, 16, v96
    v_and_b32 v137, 0xffff0000, v96
    v_lshlrev_b32 v138, 16, v97
    v_and_b32 v139, 0xffff0000, v97
    v_lshlrev_b32 v140, 16, v98
    v_and_b32 v141, 0xffff0000, v98
    v_lshlrev_b32 v142, 16, v99
    v_and_b32 v143, 0xffff0000, v99
    v_pk_fma_f32 v[128:129], v[136:137], v[82:83], v[128:129] op_sel:[0,0,0] op_sel_hi:[1,0,1]
    v_pk_fma_f32 v[130:131], v[138:139], v[82:83], v[130:131] op_sel:[0,0,0] op_sel_hi:[1,0,1]
    v_pk_fma_f32 v[132:133], v[140:141], v[82:83], v[132:133] op_sel:[0,0,0] op_sel_hi:[1,0,1]
    v_pk_fma_f32 v[134:135], v[142:143], v[82:83], v[134:135] op_sel:[0,0,0] op_sel_hi:[1,0,1]
    s_waitcnt vmcnt(8)
    v_lshlrev_b32 v136, 16, v100
    v_and_b32 v137, 0xffff0000, v100
    v_lshlrev_b32 v138, 16, v101
    v_and_b32 v139, 0xffff0000, v101
    v_lshlrev_b32 v140, 16, v102
    v_and_b32 v141, 0xffff0000, v102
    v_lshlrev_b32 v142, 16, v103
    v_and_b32 v143, 0xffff0000, v103
    v_pk_fma_f32 v[128:129], v[136:137], v[82:83], v[128:129] op_sel:[0,1,0] op_sel_hi:[1,1,1]
    v_pk_fma_f32 v[130:131], v[138:139], v[82:83], v[130:131] op_sel:[0,1,0] op_sel_hi:[1,1,1]
    v_pk_fma_f32 v[132:133], v[140:141], v[82:83], v[132:133] op_sel:[0,1,0] op_sel_hi:[1,1,1]
    v_pk_fma_f32 v[134:135], v[142:143], v[82:83], v[134:135] op_sel:[0,1,0] op_sel_hi:[1,1,1]
    s_waitcnt vmcnt(7)
    v_lshlrev_b32 v136, 16, v104
    v_and_b32 v137, 0xffff0000, v104
    v_lshlrev_b32 v138, 16, v105
    v_and_b32 v139, 0xffff0000, v105
    v_lshlrev_b32 v140, 16, v106
    v_and_b32 v141, 0xffff0000, v106
    v_lshlrev_b32 v142, 16, v107
    v_and_b32 v143, 0xffff0000, v107
    v_pk_fma_f32 v[128:129], v[136:137], v[84:85], v[128:129] op_sel:[0,0,0] op_sel_hi:[1,0,1]
    v_pk_fma_f32 v[130:131], v[138:139], v[84:85], v[130:131] op_sel:[0,0,0] op_sel_hi:[1,0,1]
    v_pk_fma_f32 v[132:133], v[140:141], v[84:85], v[132:133] op_sel:[0,0,0] op_sel_hi:[1,0,1]
    v_pk_fma_f32 v[134:135], v[142:143], v[84:85], v[134:135] op_sel:[0,0,0] op_sel_hi:[1,0,1]
    s_nop 0
    v_permlane32_swap_b32 v128, v132
    v_permlane32_swap_b32 v129, v133
    v_permlane32_swap_b32 v130, v134
    v_permlane32_swap_b32 v131, v135
    v_and_b32 v72, 1, v1
    v_pk_add_f32 v[128:129], v[128:129], v[132:133]
    v_pk_add_f32 v[130:131], v[130:131], v[134:135]
    v_lshlrev_b32 v72, 5, v72
    v_lshrrev_b32 v73, 4, v1
    v_permlane16_swap_b32 v128, v130
    v_permlane16_swap_b32 v129, v131
    v_lshl_add_u32 v72, v73, 3, v72
    v_pk_add_f32 v[128:129], v[128:129], v[130:131]
    s_lshl_b32 s36, s3, 6
    v_add_u32 v72, s36, v72
    v_add_f32_dpp v128, v128, v128 row_ror:2 row_mask:0xf bank_mask:0xf
    v_add_f32_dpp v129, v129, v129 row_ror:2 row_mask:0xf bank_mask:0xf
    s_nop 0
    v_add_f32_dpp v128, v128, v128 row_ror:4 row_mask:0xf bank_mask:0xf
    v_add_f32_dpp v129, v129, v129 row_ror:4 row_mask:0xf bank_mask:0xf
    s_nop 0
    v_add_f32_dpp v128, v128, v128 row_ror:8 row_mask:0xf bank_mask:0xf
    v_add_f32_dpp v129, v129, v129 row_ror:8 row_mask:0xf bank_mask:0xf
    ds_write_b64 v72, v[128:129] offset:0
    v_and_b32 v73, 7, v1
    v_lshlrev_b32 v73, 3, v73
    s_waitcnt lgkmcnt(0)
    s_barrier
    ds_read_b64 v[128:129], v73 offset:0
    ds_read_b64 v[130:131], v73 offset:64
    ds_read_b64 v[132:133], v73 offset:128
    ds_read_b64 v[134:135], v73 offset:192
    s_add_u32 s95, s94, 0x9e3779b9
    v_mov_b32 v137, s95
    s_mov_b32 s37, 32768
    s_waitcnt lgkmcnt(2)
    v_pk_add_f32 v[128:129], v[128:129], v[130:131]
    s_waitcnt lgkmcnt(0)
    v_pk_add_f32 v[132:133], v[132:133], v[134:135]
    v_pk_add_f32 v[128:129], v[128:129], v[132:133]
    v_cvt_pk_bf16_f32 v136, v128, v129
    v_lshlrev_b32 v128, 16, v136
    v_and_b32 v129, 0xffff0000, v136
    v_add_f32 v128, s93, v128
    v_add_f32 v129, s93, v129
    v_cvt_pk_bf16_f32 v136, v128, v129
    buffer_store_dwordx2 v[136:137], v69, s[24:27], s37 offen sc1
    s_waitcnt vmcnt(7)
    v_lshlrev_b32 v144, 16, v108
    v_and_b32 v145, 0xffff0000, v108
    v_lshlrev_b32 v146, 16, v109
    v_and_b32 v147, 0xffff0000, v109
    s_waitcnt vmcnt(6)
    v_lshlrev_b32 v148, 16, v110
    v_and_b32 v149, 0xffff0000, v110
    v_lshlrev_b32 v150, 16, v111
    v_and_b32 v151, 0xffff0000, v111
    s_waitcnt vmcnt(5)
    v_lshlrev_b32 v152, 16, v112
    v_and_b32 v153, 0xffff0000, v112
    v_lshlrev_b32 v154, 16, v113
    v_and_b32 v155, 0xffff0000, v113
    s_waitcnt vmcnt(4)
    v_lshlrev_b32 v156, 16, v114
    v_and_b32 v157, 0xffff0000, v114
    v_lshlrev_b32 v158, 16, v115
    v_and_b32 v159, 0xffff0000, v115
    s_waitcnt vmcnt(3)
    v_lshlrev_b32 v160, 16, v116
    v_and_b32 v161, 0xffff0000, v116
    v_lshlrev_b32 v162, 16, v117
    v_and_b32 v163, 0xffff0000, v117
    s_waitcnt vmcnt(2)
    v_lshlrev_b32 v164, 16, v118
    v_and_b32 v165, 0xffff0000, v118
    v_lshlrev_b32 v166, 16, v119
    v_and_b32 v167, 0xffff0000, v119
    v_pk_add_f32 v[72:73], v[144:145], v[148:149]
    v_pk_add_f32 v[76:77], v[146:147], v[150:151]
    v_pk_add_f32 v[72:73], v[72:73], v[152:153]
    v_pk_add_f32 v[76:77], v[76:77], v[154:155]
    v_pk_add_f32 v[72:73], v[72:73], v[156:157]
    v_pk_add_f32 v[76:77], v[76:77], v[158:159]
    v_pk_add_f32 v[72:73], v[72:73], v[160:161]
    v_pk_add_f32 v[76:77], v[76:77], v[162:163]
    v_pk_add_f32 v[72:73], v[72:73], v[164:165]
    v_pk_add_f32 v[76:77], v[76:77], v[166:167]
    v_pk_add_f32 v[72:73], v[72:73], v[76:77]
    v_add_f32 v72, v72, v73
    s_nop 1
    v_add_f32_dpp v72, v72, v72 row_ror:1 row_mask:0xf bank_mask:0xf
    s_nop 1
    v_add_f32_dpp v72, v72, v72 row_ror:2 row_mask:0xf bank_mask:0xf
    s_nop 1
    v_add_f32_dpp v72, v72, v72 row_ror:4 row_mask:0xf bank_mask:0xf
    s_nop 1
    v_add_f32_dpp v72, v72, v72 row_ror:8 row_mask:0xf bank_mask:0xf
    v_mov_b32 v76, v72
    s_nop 1
    v_permlane16_swap_b32 v72, v76
    s_nop 0
    v_add_f32 v72, v72, v76
    v_mul_f32 v72, 0x3ae38e39, v72
    v_pk_add_f32 v[168:169], v[144:145], v[72:73] op_sel_hi:[1,0] neg_lo:[0,1] neg_hi:[0,1]
    v_pk_add_f32 v[170:171], v[146:147], v[72:73] op_sel_hi:[1,0] neg_lo:[0,1] neg_hi:[0,1]
    v_pk_add_f32 v[172:173], v[148:149], v[72:73] op_sel_hi:[1,0] neg_lo:[0,1] neg_hi:[0,1]
    v_pk_add_f32 v[174:175], v[150:151], v[72:73] op_sel_hi:[1,0] neg_lo:[0,1] neg_hi:[0,1]
    v_pk_add_f32 v[176:177], v[152:153], v[72:73] op_sel_hi:[1,0] neg_lo:[0,1] neg_hi:[0,1]
    v_pk_add_f32 v[178:179], v[154:155], v[72:73] op_sel_hi:[1,0] neg_lo:[0,1] neg_hi:[0,1]
    v_pk_add_f32 v[180:181], v[156:157], v[72:73] op_sel_hi:[1,0] neg_lo:[0,1] neg_hi:[0,1]
    v_pk_add_f32 v[182:183], v[158:159], v[72:73] op_sel_hi:[1,0] neg_lo:[0,1] neg_hi:[0,1]
    v_pk_add_f32 v[184:185], v[160:161], v[72:73] op_sel_hi:[1,0] neg_lo:[0,1] neg_hi:[0,1]
    v_pk_add_f32 v[186:187], v[162:163], v[72:73] op_sel_hi:[1,0] neg_lo:[0,1] neg_hi:[0,1]
    v_pk_add_f32 v[188:189], v[164:165], v[72:73] op_sel_hi:[1,0] neg_lo:[0,1] neg_hi:[0,1]
    v_pk_add_f32 v[190:191], v[166:167], v[72:73] op_sel_hi:[1,0] neg_lo:[0,1] neg_hi:[0,1]
    v_pk_mul_f32 v[74:75], v[168:169], v[168:169]
    v_pk_mul_f32 v[76:77], v[170:171], v[170:171]
    v_pk_fma_f32 v[74:75], v[172:173], v[172:173], v[74:75]
    v_pk_fma_f32 v[76:77], v[174:175], v[174:175], v[76:77]
    v_pk_fma_f32 v[74:75], v[176:177], v[176:177], v[74:75]
    v_pk_fma_f32 v[76:77], v[178:179], v[178:179], v[76:77]
    v_pk_fma_f32 v[74:75], v[180:181], v[180:181], v[74:75]
    v_pk_fma_f32 v[76:77], v[182:183], v[182:183], v[76:77]
    v_pk_fma_f32 v[74:75], v[184:185], v[184:185], v[74:75]
    v_pk_fma_f32 v[76:77], v[186:187], v[186:187], v[76:77]
    v_pk_fma_f32 v[74:75], v[188:189], v[188:189], v[74:75]
    v_pk_fma_f32 v[76:77], v[190:191], v[190:191], v[76:77]
    v_pk_add_f32 v[74:75], v[74:75], v[76:77]
    v_add_f32 v74, v74, v75
    v_cndmask_b32 v74, 0, v74, vcc
    s_nop 1
    v_add_f32_dpp v74, v74, v74 row_ror:1 row_mask:0xf bank_mask:0xf
    s_nop 1
    v_add_f32_dpp v74, v74, v74 row_ror:2 row_mask:0xf bank_mask:0xf
    s_nop 1
    v_add_f32_dpp v74, v74, v74 row_ror:4 row_mask:0xf bank_mask:0xf
    s_nop 1
    v_add_f32_dpp v74, v74, v74 row_ror:8 row_mask:0xf bank_mask:0xf
    v_mov_b32 v76, v74
    s_nop 1
    v_permlane16_swap_b32 v74, v76
    s_nop 0
    v_add_f32 v74, v74, v76
    v_mul_f32 v74, 0x3ae38e39, v74
    v_cvt_pk_bf16_f32 v76, v72, v74
    v_and_b32 v74, 0xffff0000, v76
    v_lshlrev_b32 v72, 16, v76
    v_add_f32 v74, 0x3727c5ac, v74
    v_cvt_pk_bf16_f32 v74, v74, v74
    v_and_b32 v74, 0xffff0000, v74
    v_sqrt_f32 v74, v74
    v_pk_add_f32 v[168:169], v[144:145], v[72:73] op_sel_hi:[1,0] neg_lo:[0,1] neg_hi:[0,1]
    v_pk_add_f32 v[170:171], v[146:147], v[72:73] op_sel_hi:[1,0] neg_lo:[0,1] neg_hi:[0,1]
    v_pk_add_f32 v[172:173], v[148:149], v[72:73] op_sel_hi:[1,0] neg_lo:[0,1] neg_hi:[0,1]
    v_pk_add_f32 v[174:175], v[150:151], v[72:73] op_sel_hi:[1,0] neg_lo:[0,1] neg_hi:[0,1]
    v_pk_add_f32 v[176:177], v[152:153], v[72:73] op_sel_hi:[1,0] neg_lo:[0,1] neg_hi:[0,1]
    v_pk_add_f32 v[178:179], v[154:155], v[72:73] op_sel_hi:[1,0] neg_lo:[0,1] neg_hi:[0,1]
    v_pk_add_f32 v[180:181], v[156:157], v[72:73] op_sel_hi:[1,0] neg_lo:[0,1] neg_hi:[0,1]
    v_pk_add_f32 v[182:183], v[158:159], v[72:73] op_sel_hi:[1,0] neg_lo:[0,1] neg_hi:[0,1]
    v_pk_add_f32 v[184:185], v[160:161], v[72:73] op_sel_hi:[1,0] neg_lo:[0,1] neg_hi:[0,1]
    v_pk_add_f32 v[186:187], v[162:163], v[72:73] op_sel_hi:[1,0] neg_lo:[0,1] neg_hi:[0,1]
    v_pk_add_f32 v[188:189], v[164:165], v[72:73] op_sel_hi:[1,0] neg_lo:[0,1] neg_hi:[0,1]
    v_pk_add_f32 v[190:191], v[166:167], v[72:73] op_sel_hi:[1,0] neg_lo:[0,1] neg_hi:[0,1]
    v_cvt_pk_bf16_f32 v74, v74, v74
    v_and_b32 v74, 0xffff0000, v74
    v_rcp_f32 v74, v74
    v_cvt_pk_bf16_f32 v108, v168, v169
    v_cvt_pk_bf16_f32 v109, v170, v171
    v_cvt_pk_bf16_f32 v110, v172, v173
    v_cvt_pk_bf16_f32 v111, v174, v175
    v_cvt_pk_bf16_f32 v112, v176, v177
    v_cvt_pk_bf16_f32 v113, v178, v179
    v_cvt_pk_bf16_f32 v114, v180, v181
    v_cvt_pk_bf16_f32 v115, v182, v183
    v_cvt_pk_bf16_f32 v116, v184, v185
    v_cvt_pk_bf16_f32 v117, v186, v187
    v_cvt_pk_bf16_f32 v118, v188, v189
    v_cvt_pk_bf16_f32 v119, v190, v191
    v_lshlrev_b32 v168, 16, v108
    v_and_b32 v169, 0xffff0000, v108
    v_lshlrev_b32 v170, 16, v109
    v_and_b32 v171, 0xffff0000, v109
    v_lshlrev_b32 v172, 16, v110
    v_and_b32 v173, 0xffff0000, v110
    v_lshlrev_b32 v174, 16, v111
    v_and_b32 v175, 0xffff0000, v111
    v_lshlrev_b32 v176, 16, v112
    v_and_b32 v177, 0xffff0000, v112
    v_lshlrev_b32 v178, 16, v113
    v_and_b32 v179, 0xffff0000, v113
    v_lshlrev_b32 v180, 16, v114
    v_and_b32 v181, 0xffff0000, v114
    v_lshlrev_b32 v182, 16, v115
    v_and_b32 v183, 0xffff0000, v115
    v_lshlrev_b32 v184, 16, v116
    v_and_b32 v185, 0xffff0000, v116
    v_lshlrev_b32 v186, 16, v117
    v_and_b32 v187, 0xffff0000, v117
    v_lshlrev_b32 v188, 16, v118
    v_and_b32 v189, 0xffff0000, v118
    v_lshlrev_b32 v190, 16, v119
    v_and_b32 v191, 0xffff0000, v119
    v_pk_mul_f32 v[168:169], v[168:169], v[74:75] op_sel_hi:[1,0]
    v_pk_mul_f32 v[170:171], v[170:171], v[74:75] op_sel_hi:[1,0]
    v_pk_mul_f32 v[172:173], v[172:173], v[74:75] op_sel_hi:[1,0]
    v_pk_mul_f32 v[174:175], v[174:175], v[74:75] op_sel_hi:[1,0]
    v_pk_mul_f32 v[176:177], v[176:177], v[74:75] op_sel_hi:[1,0]
    v_pk_mul_f32 v[178:179], v[178:179], v[74:75] op_sel_hi:[1,0]
    v_pk_mul_f32 v[180:181], v[180:181], v[74:75] op_sel_hi:[1,0]
    v_pk_mul_f32 v[182:183], v[182:183], v[74:75] op_sel_hi:[1,0]
    v_pk_mul_f32 v[184:185], v[184:185], v[74:75] op_sel_hi:[1,0]
    v_pk_mul_f32 v[186:187], v[186:187], v[74:75] op_sel_hi:[1,0]
    v_pk_mul_f32 v[188:189], v[188:189], v[74:75] op_sel_hi:[1,0]
    v_pk_mul_f32 v[190:191], v[190:191], v[74:75] op_sel_hi:[1,0]
    v_cvt_pk_bf16_f32 v108, v168, v169
    v_cvt_pk_bf16_f32 v109, v170, v171
    v_cvt_pk_bf16_f32 v110, v172, v173
    v_cvt_pk_bf16_f32 v111, v174, v175
    v_cvt_pk_bf16_f32 v112, v176, v177
    v_cvt_pk_bf16_f32 v113, v178, v179
    v_cvt_pk_bf16_f32 v114, v180, v181
    v_cvt_pk_bf16_f32 v115, v182, v183
    v_cvt_pk_bf16_f32 v116, v184, v185
    v_cvt_pk_bf16_f32 v117, v186, v187
    v_cvt_pk_bf16_f32 v118, v188, v189
    v_cvt_pk_bf16_f32 v119, v190, v191
    v_lshlrev_b32 v168, 16, v108
    v_and_b32 v169, 0xffff0000, v108
    v_lshlrev_b32 v170, 16, v109
    v_and_b32 v171, 0xffff0000, v109
    v_lshlrev_b32 v172, 16, v110
    v_and_b32 v173, 0xffff0000, v110
    v_lshlrev_b32 v174, 16, v111
    v_and_b32 v175, 0xffff0000, v111
    v_lshlrev_b32 v176, 16, v112
    v_and_b32 v177, 0xffff0000, v112
    v_lshlrev_b32 v178, 16, v113
    v_and_b32 v179, 0xffff0000, v113
    v_lshlrev_b32 v180, 16, v114
    v_and_b32 v181, 0xffff0000, v114
    v_lshlrev_b32 v182, 16, v115
    v_and_b32 v183, 0xffff0000, v115
    v_lshlrev_b32 v184, 16, v116
    v_and_b32 v185, 0xffff0000, v116
    v_lshlrev_b32 v186, 16, v117
    v_and_b32 v187, 0xffff0000, v117
    v_lshlrev_b32 v188, 16, v118
    v_and_b32 v189, 0xffff0000, v118
    v_lshlrev_b32 v190, 16, v119
    v_and_b32 v191, 0xffff0000, v119
    s_mul_i32 s36, s3, 72
    v_add_u32 v72, s36, v1
    v_and_b32 v73, 7, v1
    s_add_u32 s36, s36, 64
    v_add_u32 v73, s36, v73
    s_movk_i32 s36, 1024
    v_and_b32 v76, 3, v72
    v_lshlrev_b32 v76, 4, v76
    v_lshrrev_b32 v72, 2, v72
    v_lshl_add_u32 v74, v72, 7, v76
    v_and_b32 v77, 1, v72
    v_lshl_add_u32 v76, v77, 3, v76
    v_lshrrev_b32 v72, 1, v72
    v_lshl_add_u32 v72, v72, 6, v76
    v_add_u32 v72, s36, v72
    v_and_b32 v76, 3, v73
    v_lshlrev_b32 v76, 4, v76
    v_lshrrev_b32 v73, 2, v73
    v_lshl_add_u32 v75, v73, 7, v76
    v_and_b32 v77, 1, v73
    v_lshl_add_u32 v76, v77, 3, v76
    v_lshrrev_b32 v73, 1, v73
    v_lshl_add_u32 v73, v73, 6, v76
    v_add_u32 v73, s36, v73
    s_mov_b64 exec, 0
    s_cmp_eq_u32 s3, 0
    s_cbranch_scc1 Ltour0
    s_cmp_eq_u32 s3, 1
    s_cbranch_scc1 Ltour1
    s_cmp_eq_u32 s3, 2
    s_cbranch_scc1 Ltour2
    s_branch Ltour3
.p2align 12
Lmain:
    s_mov_b64 exec, -1
    s_mov_b32 s38, 16384
Lhead_pollm:
    buffer_load_dwordx4 v[88:91], v74, s[24:27], s37 offen sc1
    buffer_load_dwordx4 v[92:95], v75, s[24:27], s37 offen sc1
    s_sub_u32 s38, s38, 1
    s_cbranch_scc1 Lhead_gotm
    s_waitcnt vmcnt(0) lgkmcnt(0)
    v_xor_b32 v89, s95, v89
    v_xor_b32 v91, s95, v91
    v_xor_b32 v93, s95, v93
    v_xor_b32 v95, s95, v95
    v_or3_b32 v89, v89, v91, v93
    v_or_b32 v89, v89, v95
    v_cmp_ne_u32 vcc, 0, v89
    s_cbranch_vccnz Lhead_pollm
Lhead_gotm:
    s_waitcnt vmcnt(0) lgkmcnt(0)
    ds_write2_b32 v72, v88, v90 offset0:0 offset1:1
    ds_write2_b32 v73, v92, v94 offset0:0 offset1:1
    s_waitcnt lgkmcnt(0)
    s_barrier
    ds_read_b128 v[144:147], v68 offset:2176
    ds_read_b128 v[148:151], v68 offset:2560
    ds_read_b128 v[152:155], v68 offset:2944
    ds_read_b128 v[156:159], v68 offset:1024
    ds_read_b128 v[160:163], v68 offset:1408
    ds_read_b128 v[164:167], v68 offset:1792
    s_waitcnt lgkmcnt(5)
    v_lshlrev_b32 v192, 16, v144
    v_and_b32 v193, 0xffff0000, v144
    v_lshlrev_b32 v194, 16, v145
    v_and_b32 v195, 0xffff0000, v145
    v_lshlrev_b32 v196, 16, v146
    v_and_b32 v197, 0xffff0000, v146
    v_lshlrev_b32 v198, 16, v147
    v_and_b32 v199, 0xffff0000, v147
    s_waitcnt lgkmcnt(4)
    v_lshlrev_b32 v200, 16, v148
    v_and_b32 v201, 0xffff0000, v148
    v_lshlrev_b32 v202, 16, v149
    v_and_b32 v203, 0xffff0000, v149
    v_lshlrev_b32 v204, 16, v150
    v_and_b32 v205, 0xffff0000, v150
    v_lshlrev_b32 v206, 16, v151
    v_and_b32 v207, 0xffff0000, v151
    s_waitcnt lgkmcnt(3)
    v_lshlrev_b32 v208, 16, v152
    v_and_b32 v209, 0xffff0000, v152
    v_lshlrev_b32 v210, 16, v153
    v_and_b32 v211, 0xffff0000, v153
    v_lshlrev_b32 v212, 16, v154
    v_and_b32 v213, 0xffff0000, v154
    v_lshlrev_b32 v214, 16, v155
    v_and_b32 v215, 0xffff0000, v155
    v_pk_mul_f32 v[168:169], v[168:169], v[192:193]
    v_pk_mul_f32 v[170:171], v[170:171], v[194:195]
    v_pk_mul_f32 v[172:173], v[172:173], v[196:197]
    v_pk_mul_f32 v[174:175], v[174:175], v[198:199]
    v_pk_mul_f32 v[176:177], v[176:177], v[200:201]
    v_pk_mul_f32 v[178:179], v[178:179], v[202:203]
    v_pk_mul_f32 v[180:181], v[180:181], v[204:205]
    v_pk_mul_f32 v[182:183], v[182:183], v[206:207]
    v_pk_mul_f32 v[184:185], v[184:185], v[208:209]
    v_pk_mul_f32 v[186:187], v[186:187], v[210:211]
    v_pk_mul_f32 v[188:189], v[188:189], v[212:213]
    v_pk_mul_f32 v[190:191], v[190:191], v[214:215]
    v_cvt_pk_bf16_f32 v108, v168, v169
    v_cvt_pk_bf16_f32 v109, v170, v171
    v_cvt_pk_bf16_f32 v110, v172, v173
    v_cvt_pk_bf16_f32 v111, v174, v175
    v_cvt_pk_bf16_f32 v112, v176, v177
    v_cvt_pk_bf16_f32 v113, v178, v179
    v_cvt_pk_bf16_f32 v114, v180, v181
    v_cvt_pk_bf16_f32 v115, v182, v183
    v_cvt_pk_bf16_f32 v116, v184, v185
    v_cvt_pk_bf16_f32 v117, v186, v187
    v_cvt_pk_bf16_f32 v118, v188, v189
    v_cvt_pk_bf16_f32 v119, v190, v191
    s_waitcnt lgkmcnt(2)
    v_lshlrev_b32 v216, 16, v156
    v_and_b32 v217, 0xffff0000, v156
    v_lshlrev_b32 v218, 16, v157
    v_and_b32 v219, 0xffff0000, v157
    v_lshlrev_b32 v220, 16, v158
    v_and_b32 v221, 0xffff0000, v158
    v_lshlrev_b32 v222, 16, v159
    v_and_b32 v223, 0xffff0000, v159
    s_waitcnt lgkmcnt(1)
    v_lshlrev_b32 v224, 16, v160
    v_and_b32 v225, 0xffff0000, v160
    v_lshlrev_b32 v226, 16, v161
    v_and_b32 v227, 0xffff0000, v161
    v_lshlrev_b32 v228, 16, v162
    v_and_b32 v229, 0xffff0000, v162
    v_lshlrev_b32 v230, 16, v163
    v_and_b32 v231, 0xffff0000, v163
    s_waitcnt lgkmcnt(0)
    v_lshlrev_b32 v232, 16, v164
    v_and_b32 v233, 0xffff0000, v164
    v_lshlrev_b32 v234, 16, v165
    v_and_b32 v235, 0xffff0000, v165
    v_lshlrev_b32 v236, 16, v166
    v_and_b32 v237, 0xffff0000, v166
    v_lshlrev_b32 v238, 16, v167
    v_and_b32 v239, 0xffff0000, v167
    v_lshlrev_b32 v168, 16, v108
    v_and_b32 v169, 0xffff0000, v108
    v_lshlrev_b32 v170, 16, v109
    v_and_b32 v171, 0xffff0000, v109
    v_lshlrev_b32 v172, 16, v110
    v_and_b32 v173, 0xffff0000, v110
    v_lshlrev_b32 v174, 16, v111
    v_and_b32 v175, 0xffff0000, v111
    v_lshlrev_b32 v176, 16, v112
    v_and_b32 v177, 0xffff0000, v112
    v_lshlrev_b32 v178, 16, v113
    v_and_b32 v179, 0xffff0000, v113
    v_lshlrev_b32 v180, 16, v114
    v_and_b32 v181, 0xffff0000, v114
    v_lshlrev_b32 v182, 16, v115
    v_and_b32 v183, 0xffff0000, v115
    v_lshlrev_b32 v184, 16, v116
    v_and_b32 v185, 0xffff0000, v116
    v_lshlrev_b32 v186, 16, v117
    v_and_b32 v187, 0xffff0000, v117
    v_lshlrev_b32 v188, 16, v118
    v_and_b32 v189, 0xffff0000, v118
    v_lshlrev_b32 v190, 16, v119
    v_and_b32 v191, 0xffff0000, v119
    v_pk_add_f32 v[168:169], v[168:169], v[216:217]
    v_pk_add_f32 v[170:171], v[170:171], v[218:219]
    v_pk_add_f32 v[172:173], v[172:173], v[220:221]
    v_pk_add_f32 v[174:175], v[174:175], v[222:223]
    v_cvt_pk_bf16_f32 v108, v168, v169
    v_cvt_pk_bf16_f32 v109, v170, v171
    v_cvt_pk_bf16_f32 v110, v172, v173
    v_cvt_pk_bf16_f32 v111, v174, v175
    buffer_store_dwordx4 v[108:111], v67, s[24:27], s92 offen offset:0 sc1
    v_pk_add_f32 v[176:177], v[176:177], v[224:225]
    v_pk_add_f32 v[178:179], v[178:179], v[226:227]
    v_pk_add_f32 v[180:181], v[180:181], v[228:229]
    v_pk_add_f32 v[182:183], v[182:183], v[230:231]
    v_cvt_pk_bf16_f32 v112, v176, v177
    v_cvt_pk_bf16_f32 v113, v178, v179
    v_cvt_pk_bf16_f32 v114, v180, v181
    v_cvt_pk_bf16_f32 v115, v182, v183
    buffer_store_dwordx4 v[112:115], v67, s[24:27], s92 offen offset:768 sc1
    v_pk_add_f32 v[184:185], v[184:185], v[232:233]
    v_pk_add_f32 v[186:187], v[186:187], v[234:235]
    v_pk_add_f32 v[188:189], v[188:189], v[236:237]
    v_pk_add_f32 v[190:191], v[190:191], v[238:239]
    v_cvt_pk_bf16_f32 v116, v184, v185
    v_cvt_pk_bf16_f32 v117, v186, v187
    v_cvt_pk_bf16_f32 v118, v188, v189
    v_cvt_pk_bf16_f32 v119, v190, v191
    buffer_store_dwordx4 v[116:119], v67, s[24:27], s92 offen offset:1536 sc1
    s_lshl_b32 s36, s5, 13
    s_add_u32 s36, s36, 8650752
    s_lshl_b32 s37, s4, 9
    s_add_u32 s37, s37, s36
    s_lshl_b32 s38, s3, 7
    s_add_u32 s37, s37, s38
    s_lshl_b32 s38, s3, 11
    s_add_u32 s36, s36, s38
    v_min_u32 v72, 1, v1
    v_lshlrev_b32 v72, 31, v72
    v_and_b32 v73, 15, v1
    v_lshlrev_b32 v73, 7, v73
    v_cmp_gt_u32 vcc, 162, v0
    v_mov_b32 v88, -1
    v_mov_b32 v89, -1
    v_mov_b32 v90, -1
    v_mov_b32 v91, -1
    s_mul_i32 s39, s2, 2592
    s_add_u32 s39, s39, 7864320
    v_lshl_add_u32 v74, v0, 4, s39
    s_lshl_b32 s39, s2, 7
    s_add_u32 s39, s39, 8912896
    v_mov_b32 v75, s39
    v_cndmask_b32 v74, v75, v74, vcc
    s_lshl_b32 s92, s5, 13
    s_add_u32 s92, s92, 8781824
    s_add_u32 s92, s92, s38
    s_lshl_b32 s38, s4, 7
    s_add_u32 s92, s92, s38
    s_getreg_b32 s38, hwreg(HW_REG_XCC_ID, 0, 4)
    s_add_u32 s38, s38, s95
    v_mov_b32 v76, s38
    v_mov_b32 v2, v80
    v_mov_b32 v3, v81
    v_mov_b32 v4, v82
    v_mov_b32 v5, v83
    v_mov_b32 v6, v84
    v_mov_b32 v7, v65
    s_waitcnt vmcnt(0)
    buffer_store_dword v137, v72, s[24:27], s37 offen sc1
    s_add_u32 s49, s44, 0
    s_add_u32 m0, s42, 32768
    s_nop 0
    buffer_load_dwordx4 v42, s[16:19], s49 offen lds
    buffer_load_dwordx4 v43, s[16:19], s49 offen offset:1024 lds
    buffer_load_dwordx4 v44, s[16:19], s49 offen offset:2048 lds
    buffer_load_dwordx4 v45, s[16:19], s49 offen offset:3072 lds
    s_add_u32 s49, s44, 256
    s_add_u32 m0, s42, 49152
    s_nop 0
    buffer_load_dwordx4 v42, s[16:19], s49 offen lds
    buffer_load_dwordx4 v43, s[16:19], s49 offen offset:1024 lds
    buffer_load_dwordx4 v44, s[16:19], s49 offen offset:2048 lds
    buffer_load_dwordx4 v45, s[16:19], s49 offen offset:3072 lds
    s_add_u32 s49, s44, 524288
    s_add_u32 m0, s42, 65536
    s_nop 0
    buffer_load_dwordx4 v42, s[16:19], s49 offen lds
    buffer_load_dwordx4 v43, s[16:19], s49 offen offset:1024 lds
    buffer_load_dwordx4 v44, s[16:19], s49 offen offset:2048 lds
    buffer_load_dwordx4 v45, s[16:19], s49 offen offset:3072 lds
    s_add_u32 s49, s44, 524544
    s_add_u32 m0, s42, 81920
    s_nop 0
    buffer_load_dwordx4 v42, s[16:19], s49 offen lds
    buffer_load_dwordx4 v43, s[16:19], s49 offen offset:1024 lds
    buffer_load_dwordx4 v44, s[16:19], s49 offen offset:2048 lds
    buffer_load_dwordx4 v45, s[16:19], s49 offen offset:3072 lds
    s_add_u32 s49, s44, 1048576
    s_add_u32 m0, s42, 98304
    s_nop 0
    buffer_load_dwordx4 v42, s[16:19], s49 offen lds
    buffer_load_dwordx4 v43, s[16:19], s49 offen offset:1024 lds
    buffer_load_dwordx4 v44, s[16:19], s49 offen offset:2048 lds
    buffer_load_dwordx4 v45, s[16:19], s49 offen offset:3072 lds
    s_add_u32 s49, s44, 1048832
    s_add_u32 m0, s42, 114688
    s_nop 0
    buffer_load_dwordx4 v42, s[16:19], s49 offen lds
    buffer_load_dwordx4 v43, s[16:19], s49 offen offset:1024 lds
    buffer_load_dwordx4 v44, s[16:19], s49 offen offset:2048 lds
    buffer_load_dwordx4 v45, s[16:19], s49 offen offset:3072 lds
    s_mov_b32 s38, 16384
Lhead_pollh:
    buffer_load_dword v75, v73, s[24:27], s36 offen sc1
    s_sub_u32 s38, s38, 1
    s_cbranch_scc1 Lhead_goth
    s_waitcnt vmcnt(0) lgkmcnt(0)
    v_cmp_ne_u32 vcc, s95, v75
    s_cbranch_vccnz Lhead_pollh
Lhead_goth:
    s_waitcnt vmcnt(0) lgkmcnt(0)
    buffer_load_dwordx4 a[0:3], v51, s[24:27], s46 offen offset:0 sc1
    buffer_load_dwordx4 a[8:11], v51, s[24:27], s46 offen offset:128 sc1
    buffer_load_dwordx4 a[4:7], v51, s[24:27], s43 offen offset:0 sc1
    buffer_load_dwordx4 a[12:15], v51, s[24:27], s43 offen offset:128 sc1
    s_barrier
    ds_read_b64_tr_b16 a[160:161], v12 offset:32768
    ds_read_b64_tr_b16 a[162:163], v12 offset:36864
    ds_read_b64_tr_b16 a[164:165], v12 offset:40960
    ds_read_b64_tr_b16 a[166:167], v12 offset:45056
    ds_read_b64_tr_b16 a[168:169], v13 offset:32768
    ds_read_b64_tr_b16 a[170:171], v13 offset:36864
    ds_read_b64_tr_b16 a[172:173], v13 offset:40960
    ds_read_b64_tr_b16 a[174:175], v13 offset:45056
    ds_read_b64_tr_b16 a[176:177], v14 offset:32768
    ds_read_b64_tr_b16 a[178:179], v14 offset:36864
    ds_read_b64_tr_b16 a[180:181], v14 offset:40960
    ds_read_b64_tr_b16 a[182:183], v14 offset:45056
    buffer_load_dwordx4 a[16:19], v51, s[24:27], s46 offen offset:256 sc1
    buffer_load_dwordx4 a[24:27], v51, s[24:27], s46 offen offset:384 sc1
    buffer_load_dwordx4 a[20:23], v51, s[24:27], s43 offen offset:256 sc1
    buffer_load_dwordx4 a[28:31], v51, s[24:27], s43 offen offset:384 sc1
    s_waitcnt lgkmcnt(10)
    s_waitcnt vmcnt(7)
    v_mfma_f32_16x16x32_bf16 v[128:131], a[160:163], a[0:3], 0
    s_waitcnt vmcnt(6)
    s_waitcnt lgkmcnt(8)
    ds_read_b64_tr_b16 a[184:185], v15 offset:32768
    v_mfma_f32_16x16x32_bf16 v[128:131], a[164:167], a[8:11], v[128:131]
    s_waitcnt vmcnt(5)
    ds_read_b64_tr_b16 a[186:187], v15 offset:36864
    v_mfma_f32_16x16x32_bf16 v[132:135], a[160:163], a[4:7], 0
    s_waitcnt vmcnt(4)
    ds_read_b64_tr_b16 a[188:189], v15 offset:40960
    v_mfma_f32_16x16x32_bf16 v[132:135], a[164:167], a[12:15], v[132:135]
    s_waitcnt lgkmcnt(9)
    buffer_load_dwordx4 a[32:35], v51, s[24:27], s46 offen offset:512 sc1
    v_mfma_f32_16x16x32_bf16 v[136:139], a[168:171], a[0:3], 0
    s_waitcnt lgkmcnt(7)
    ds_read_b64_tr_b16 a[190:191], v15 offset:45056
    ds_read_b64_tr_b16 a[160:161], v16 offset:32768
    v_mfma_f32_16x16x32_bf16 v[136:139], a[172:175], a[8:11], v[136:139]
    ds_read_b64_tr_b16 a[162:163], v16 offset:36864
    v_mfma_f32_16x16x32_bf16 v[140:143], a[168:171], a[4:7], 0
    ds_read_b64_tr_b16 a[164:165], v16 offset:40960
    v_mfma_f32_16x16x32_bf16 v[140:143], a[172:175], a[12:15], v[140:143]
    s_waitcnt lgkmcnt(9)
    buffer_load_dwordx4 a[40:43], v51, s[24:27], s46 offen offset:640 sc1
    v_mfma_f32_16x16x32_bf16 v[144:147], a[176:179], a[0:3], 0
    s_waitcnt lgkmcnt(7)
    ds_read_b64_tr_b16 a[166:167], v16 offset:45056
    ds_read_b64_tr_b16 a[168:169], v17 offset:32768
    v_mfma_f32_16x16x32_bf16 v[144:147], a[180:183], a[8:11], v[144:147]
    ds_read_b64_tr_b16 a[170:171], v17 offset:36864
    v_mfma_f32_16x16x32_bf16 v[148:151], a[176:179], a[4:7], 0
    ds_read_b64_tr_b16 a[172:173], v17 offset:40960
    v_mfma_f32_16x16x32_bf16 v[148:151], a[180:183], a[12:15], v[148:151]
    s_waitcnt lgkmcnt(9)
    buffer_load_dwordx4 a[36:39], v51, s[24:27], s43 offen offset:512 sc1
    v_mfma_f32_16x16x32_bf16 v[152:155], a[184:187], a[0:3], 0
    s_waitcnt lgkmcnt(7)
    ds_read_b64_tr_b16 a[174:175], v17 offset:45056
    ds_read_b64_tr_b16 a[176:177], v18 offset:32768
    v_mfma_f32_16x16x32_bf16 v[152:155], a[188:191], a[8:11], v[152:155]
    ds_read_b64_tr_b16 a[178:179], v18 offset:36864
    v_mfma_f32_16x16x32_bf16 v[156:159], a[184:187], a[4:7], 0
    ds_read_b64_tr_b16 a[180:181], v18 offset:40960
    v_mfma_f32_16x16x32_bf16 v[156:159], a[188:191], a[12:15], v[156:159]
    s_waitcnt lgkmcnt(9)
    buffer_load_dwordx4 a[44:47], v51, s[24:27], s43 offen offset:640 sc1
    v_mfma_f32_16x16x32_bf16 v[160:163], a[160:163], a[0:3], 0
    s_waitcnt lgkmcnt(7)
    ds_read_b64_tr_b16 a[182:183], v18 offset:45056
    ds_read_b64_tr_b16 a[184:185], v19 offset:32768
    v_mfma_f32_16x16x32_bf16 v[160:163], a[164:167], a[8:11], v[160:163]
    ds_read_b64_tr_b16 a[186:187], v19 offset:36864
    v_mfma_f32_16x16x32_bf16 v[164:167], a[160:163], a[4:7], 0
    ds_read_b64_tr_b16 a[188:189], v19 offset:40960
    v_mfma_f32_16x16x32_bf16 v[164:167], a[164:167], a[12:15], v[164:167]
    s_waitcnt lgkmcnt(9)
    buffer_load_dword v77, v70, s[16:19], s44 offen
    v_mfma_f32_16x16x32_bf16 v[168:171], a[168:171], a[0:3], 0
    s_waitcnt lgkmcnt(7)
    ds_read_b64_tr_b16 a[190:191], v19 offset:45056
    ds_read_b64_tr_b16 a[160:161], v12 offset:49152
    v_mfma_f32_16x16x32_bf16 v[168:171], a[172:175], a[8:11], v[168:171]
    ds_read_b64_tr_b16 a[162:163], v12 offset:53248
    v_mfma_f32_16x16x32_bf16 v[172:175], a[168:171], a[4:7], 0
    ds_read_b64_tr_b16 a[164:165], v12 offset:57344
    v_mfma_f32_16x16x32_bf16 v[172:175], a[172:175], a[12:15], v[172:175]
    s_waitcnt lgkmcnt(9)
    ds_read_b64_tr_b16 a[166:167], v12 offset:61440
    v_mfma_f32_16x16x32_bf16 v[176:179], a[176:179], a[0:3], 0
    s_waitcnt lgkmcnt(8)
    ds_read_b64_tr_b16 a[168:169], v13 offset:49152
    v_mfma_f32_16x16x32_bf16 v[176:179], a[180:183], a[8:11], v[176:179]
    ds_read_b64_tr_b16 a[170:171], v13 offset:53248
    v_mfma_f32_16x16x32_bf16 v[180:183], a[176:179], a[4:7], 0
    ds_read_b64_tr_b16 a[172:173], v13 offset:57344
    v_mfma_f32_16x16x32_bf16 v[180:183], a[180:183], a[12:15], v[180:183]
    s_waitcnt lgkmcnt(9)
    ds_read_b64_tr_b16 a[174:175], v13 offset:61440
    v_mfma_f32_16x16x32_bf16 v[184:187], a[184:187], a[0:3], 0
    s_waitcnt lgkmcnt(8)
    ds_read_b64_tr_b16 a[176:177], v14 offset:49152
    v_mfma_f32_16x16x32_bf16 v[184:187], a[188:191], a[8:11], v[184:187]
    ds_read_b64_tr_b16 a[178:179], v14 offset:53248
    v_mfma_f32_16x16x32_bf16 v[188:191], a[184:187], a[4:7], 0
    ds_read_b64_tr_b16 a[180:181], v14 offset:57344
    v_mfma_f32_16x16x32_bf16 v[188:191], a[188:191], a[12:15], v[188:191]
    s_waitcnt lgkmcnt(9)
    ds_read_b64_tr_b16 a[182:183], v14 offset:61440
    v_mfma_f32_16x16x32_bf16 v[192:195], a[160:163], a[0:3], 0
    s_waitcnt lgkmcnt(8)
    ds_read_b64_tr_b16 a[184:185], v15 offset:49152
    v_mfma_f32_16x16x32_bf16 v[192:195], a[164:167], a[8:11], v[192:195]
    ds_read_b64_tr_b16 a[186:187], v15 offset:53248
    v_mfma_f32_16x16x32_bf16 v[196:199], a[160:163], a[4:7], 0
    ds_read_b64_tr_b16 a[188:189], v15 offset:57344
    v_mfma_f32_16x16x32_bf16 v[196:199], a[164:167], a[12:15], v[196:199]
    s_waitcnt lgkmcnt(9)
    ds_read_b64_tr_b16 a[190:191], v15 offset:61440
    v_mfma_f32_16x16x32_bf16 v[200:203], a[168:171], a[0:3], 0
    s_waitcnt lgkmcnt(8)
    ds_read_b64_tr_b16 a[160:161], v16 offset:49152
    v_mfma_f32_16x16x32_bf16 v[200:203], a[172:175], a[8:11], v[200:203]
    ds_read_b64_tr_b16 a[162:163], v16 offset:53248
    v_mfma_f32_16x16x32_bf16 v[204:207], a[168:171], a[4:7], 0
    ds_read_b64_tr_b16 a[164:165], v16 offset:57344
    v_mfma_f32_16x16x32_bf16 v[204:207], a[172:175], a[12:15], v[204:207]
    s_waitcnt lgkmcnt(9)
    ds_read_b64_tr_b16 a[166:167], v16 offset:61440
    v_mfma_f32_16x16x32_bf16 v[208:211], a[176:179], a[0:3], 0
    s_waitcnt lgkmcnt(8)
    ds_read_b64_tr_b16 a[168:169], v17 offset:49152
    v_mfma_f32_16x16x32_bf16 v[208:211], a[180:183], a[8:11], v[208:211]
    ds_read_b64_tr_b16 a[170:171], v17 offset:53248
    v_mfma_f32_16x16x32_bf16 v[212:215], a[176:179], a[4:7], 0
    ds_read_b64_tr_b16 a[172:173], v17 offset:57344
    v_mfma_f32_16x16x32_bf16 v[212:215], a[180:183], a[12:15], v[212:215]
    s_waitcnt lgkmcnt(9)
    ds_read_b64_tr_b16 a[174:175], v17 offset:61440
    v_mfma_f32_16x16x32_bf16 v[216:219], a[184:187], a[0:3], 0
    s_waitcnt lgkmcnt(8)
    ds_read_b64_tr_b16 a[176:177], v18 offset:49152
    v_mfma_f32_16x16x32_bf16 v[216:219], a[188:191], a[8:11], v[216:219]
    ds_read_b64_tr_b16 a[178:179], v18 offset:53248
    v_mfma_f32_16x16x32_bf16 v[220:223], a[184:187], a[4:7], 0
    ds_read_b64_tr_b16 a[180:181], v18 offset:57344
    v_mfma_f32_16x16x32_bf16 v[220:223], a[188:191], a[12:15], v[220:223]
    s_waitcnt lgkmcnt(9)
    ds_read_b64_tr_b16 a[182:183], v18 offset:61440
    v_mfma_f32_16x16x32_bf16 v[224:227], a[160:163], a[0:3], 0
    s_waitcnt lgkmcnt(8)
    ds_read_b64_tr_b16 a[184:185], v19 offset:49152
    v_mfma_f32_16x16x32_bf16 v[224:227], a[164:167], a[8:11], v[224:227]
    ds_read_b64_tr_b16 a[186:187], v19 offset:53248
    v_mfma_f32_16x16x32_bf16 v[228:231], a[160:163], a[4:7], 0
    ds_read_b64_tr_b16 a[188:189], v19 offset:57344
    v_mfma_f32_16x16x32_bf16 v[228:231], a[164:167], a[12:15], v[228:231]
    s_waitcnt lgkmcnt(9)
    ds_read_b64_tr_b16 a[190:191], v19 offset:61440
    s_barrier
    v_mfma_f32_16x16x32_bf16 v[232:235], a[168:171], a[0:3], 0
    s_waitcnt lgkmcnt(8)
    ds_read_b64_tr_b16 a[160:161], v20 offset:0
    v_mfma_f32_16x16x32_bf16 v[232:235], a[172:175], a[8:11], v[232:235]
    s_add_u32 s49, s44, 1572864
    ds_read_b64_tr_b16 a[162:163], v20 offset:4096
    v_mfma_f32_16x16x32_bf16 v[236:239], a[168:171], a[4:7], 0
    s_add_u32 m0, s42, 131072
    ds_read_b64_tr_b16 a[164:165], v20 offset:8192
    v_mfma_f32_16x16x32_bf16 v[236:239], a[172:175], a[12:15], v[236:239]
    s_waitcnt lgkmcnt(9)
    buffer_load_dwordx4 v42, s[16:19], s49 offen lds
    v_mfma_f32_16x16x32_bf16 v[240:243], a[176:179], a[0:3], 0
    s_waitcnt lgkmcnt(7)
    ds_read_b64_tr_b16 a[166:167], v20 offset:12288
    ds_read_b64_tr_b16 a[168:169], v21 offset:0
    v_mfma_f32_16x16x32_bf16 v[240:243], a[180:183], a[8:11], v[240:243]
    ds_read_b64_tr_b16 a[170:171], v21 offset:4096
    v_mfma_f32_16x16x32_bf16 v[244:247], a[176:179], a[4:7], 0
    ds_read_b64_tr_b16 a[172:173], v21 offset:8192
    v_mfma_f32_16x16x32_bf16 v[244:247], a[180:183], a[12:15], v[244:247]
    s_waitcnt lgkmcnt(9)
    buffer_load_dwordx4 v43, s[16:19], s49 offen offset:1024 lds
    v_mfma_f32_16x16x32_bf16 v[248:251], a[184:187], a[0:3], 0
    s_waitcnt lgkmcnt(7)
    ds_read_b64_tr_b16 a[174:175], v21 offset:12288
    ds_read_b64_tr_b16 a[176:177], v22 offset:0
    v_mfma_f32_16x16x32_bf16 v[248:251], a[188:191], a[8:11], v[248:251]
    ds_read_b64_tr_b16 a[178:179], v22 offset:4096
    v_mfma_f32_16x16x32_bf16 v[252:255], a[184:187], a[4:7], 0
    ds_read_b64_tr_b16 a[180:181], v22 offset:8192
    v_mfma_f32_16x16x32_bf16 v[252:255], a[188:191], a[12:15], v[252:255]
    s_waitcnt vmcnt(10)
    s_waitcnt lgkmcnt(9)
    buffer_load_dwordx4 v44, s[16:19], s49 offen offset:2048 lds
    v_mfma_f32_16x16x32_bf16 v[128:131], a[160:163], a[16:19], v[128:131]
    s_waitcnt vmcnt(10)
    s_waitcnt lgkmcnt(7)
    ds_read_b64_tr_b16 a[182:183], v22 offset:12288
    ds_read_b64_tr_b16 a[184:185], v23 offset:0
    v_mfma_f32_16x16x32_bf16 v[128:131], a[164:167], a[24:27], v[128:131]
    s_waitcnt vmcnt(9)
    ds_read_b64_tr_b16 a[186:187], v23 offset:4096
    v_mfma_f32_16x16x32_bf16 v[132:135], a[160:163], a[20:23], v[132:135]
    s_waitcnt vmcnt(8)
    ds_read_b64_tr_b16 a[188:189], v23 offset:8192
    v_mfma_f32_16x16x32_bf16 v[132:135], a[164:167], a[28:31], v[132:135]
    s_waitcnt lgkmcnt(9)
    buffer_load_dwordx4 v45, s[16:19], s49 offen offset:3072 lds
    v_mfma_f32_16x16x32_bf16 v[136:139], a[168:171], a[16:19], v[136:139]
    s_waitcnt lgkmcnt(7)
    ds_read_b64_tr_b16 a[190:191], v23 offset:12288
    ds_read_b64_tr_b16 a[160:161], v24 offset:0
    v_mfma_f32_16x16x32_bf16 v[136:139], a[172:175], a[24:27], v[136:139]
    s_add_u32 s49, s44, 1573120
    ds_read_b64_tr_b16 a[162:163], v24 offset:4096
    v_mfma_f32_16x16x32_bf16 v[140:143], a[168:171], a[20:23], v[140:143]
    s_add_u32 m0, s42, 147456
    ds_read_b64_tr_b16 a[164:165], v24 offset:8192
    v_mfma_f32_16x16x32_bf16 v[140:143], a[172:175], a[28:31], v[140:143]
    s_waitcnt lgkmcnt(9)
    buffer_load_dwordx4 v42, s[16:19], s49 offen lds
    v_mfma_f32_16x16x32_bf16 v[144:147], a[176:179], a[16:19], v[144:147]
    s_waitcnt lgkmcnt(7)
    ds_read_b64_tr_b16 a[166:167], v24 offset:12288
    ds_read_b64_tr_b16 a[168:169], v25 offset:0
    v_mfma_f32_16x16x32_bf16 v[144:147], a[180:183], a[24:27], v[144:147]
    ds_read_b64_tr_b16 a[170:171], v25 offset:4096
    v_mfma_f32_16x16x32_bf16 v[148:151], a[176:179], a[20:23], v[148:151]
    ds_read_b64_tr_b16 a[172:173], v25 offset:8192
    v_mfma_f32_16x16x32_bf16 v[148:151], a[180:183], a[28:31], v[148:151]
    s_waitcnt lgkmcnt(9)
    buffer_load_dwordx4 v43, s[16:19], s49 offen offset:1024 lds
    v_mfma_f32_16x16x32_bf16 v[152:155], a[184:187], a[16:19], v[152:155]
    s_waitcnt lgkmcnt(7)
    ds_read_b64_tr_b16 a[174:175], v25 offset:12288
    ds_read_b64_tr_b16 a[176:177], v26 offset:0
    v_mfma_f32_16x16x32_bf16 v[152:155], a[188:191], a[24:27], v[152:155]
    ds_read_b64_tr_b16 a[178:179], v26 offset:4096
    v_mfma_f32_16x16x32_bf16 v[156:159], a[184:187], a[20:23], v[156:159]
    ds_read_b64_tr_b16 a[180:181], v26 offset:8192
    v_mfma_f32_16x16x32_bf16 v[156:159], a[188:191], a[28:31], v[156:159]
    s_waitcnt lgkmcnt(9)
    buffer_load_dwordx4 v44, s[16:19], s49 offen offset:2048 lds
    v_mfma_f32_16x16x32_bf16 v[160:163], a[160:163], a[16:19], v[160:163]
    s_waitcnt lgkmcnt(7)
    ds_read_b64_tr_b16 a[182:183], v26 offset:12288
    ds_read_b64_tr_b16 a[184:185], v27 offset:0
    v_mfma_f32_16x16x32_bf16 v[160:163], a[164:167], a[24:27], v[160:163]
    ds_read_b64_tr_b16 a[186:187], v27 offset:4096
    v_mfma_f32_16x16x32_bf16 v[164:167], a[160:163], a[20:23], v[164:167]
    ds_read_b64_tr_b16 a[188:189], v27 offset:8192
    v_mfma_f32_16x16x32_bf16 v[164:167], a[164:167], a[28:31], v[164:167]
    s_waitcnt lgkmcnt(9)
    buffer_load_dwordx4 v45, s[16:19], s49 offen offset:3072 lds
    v_mfma_f32_16x16x32_bf16 v[168:171], a[168:171], a[16:19], v[168:171]
    s_waitcnt lgkmcnt(7)
    ds_read_b64_tr_b16 a[190:191], v27 offset:12288
    ds_read_b64_tr_b16 a[160:161], v20 offset:16384
    v_mfma_f32_16x16x32_bf16 v[168:171], a[172:175], a[24:27], v[168:171]
    ds_read_b64_tr_b16 a[162:163], v20 offset:20480
    v_mfma_f32_16x16x32_bf16 v[172:175], a[168:171], a[20:23], v[172:175]
    ds_read_b64_tr_b16 a[164:165], v20 offset:24576
    v_mfma_f32_16x16x32_bf16 v[172:175], a[172:175], a[28:31], v[172:175]
    s_waitcnt lgkmcnt(9)
    buffer_load_dwordx4 a[48:51], v51, s[24:27], s46 offen offset:768 sc1
    v_mfma_f32_16x16x32_bf16 v[176:179], a[176:179], a[16:19], v[176:179]
    s_waitcnt lgkmcnt(7)
    ds_read_b64_tr_b16 a[166:167], v20 offset:28672
    ds_read_b64_tr_b16 a[168:169], v21 offset:16384
    v_mfma_f32_16x16x32_bf16 v[176:179], a[180:183], a[24:27], v[176:179]
    ds_read_b64_tr_b16 a[170:171], v21 offset:20480
    v_mfma_f32_16x16x32_bf16 v[180:183], a[176:179], a[20:23], v[180:183]
    ds_read_b64_tr_b16 a[172:173], v21 offset:24576
    v_mfma_f32_16x16x32_bf16 v[180:183], a[180:183], a[28:31], v[180:183]
    s_waitcnt lgkmcnt(9)
    buffer_load_dwordx4 a[56:59], v51, s[24:27], s46 offen offset:896 sc1
    v_mfma_f32_16x16x32_bf16 v[184:187], a[184:187], a[16:19], v[184:187]
    s_waitcnt lgkmcnt(7)
    ds_read_b64_tr_b16 a[174:175], v21 offset:28672
    ds_read_b64_tr_b16 a[176:177], v22 offset:16384
    v_mfma_f32_16x16x32_bf16 v[184:187], a[188:191], a[24:27], v[184:187]
    ds_read_b64_tr_b16 a[178:179], v22 offset:20480
    v_mfma_f32_16x16x32_bf16 v[188:191], a[184:187], a[20:23], v[188:191]
    ds_read_b64_tr_b16 a[180:181], v22 offset:24576
    v_mfma_f32_16x16x32_bf16 v[188:191], a[188:191], a[28:31], v[188:191]
    s_waitcnt lgkmcnt(9)
    buffer_load_dwordx4 a[52:55], v51, s[24:27], s43 offen offset:768 sc1
    v_mfma_f32_16x16x32_bf16 v[192:195], a[160:163], a[16:19], v[192:195]
    s_waitcnt lgkmcnt(7)
    ds_read_b64_tr_b16 a[182:183], v22 offset:28672
    ds_read_b64_tr_b16 a[184:185], v23 offset:16384
    v_mfma_f32_16x16x32_bf16 v[192:195], a[164:167], a[24:27], v[192:195]
    ds_read_b64_tr_b16 a[186:187], v23 offset:20480
    v_mfma_f32_16x16x32_bf16 v[196:199], a[160:163], a[20:23], v[196:199]
    ds_read_b64_tr_b16 a[188:189], v23 offset:24576
    v_mfma_f32_16x16x32_bf16 v[196:199], a[164:167], a[28:31], v[196:199]
    s_waitcnt lgkmcnt(9)
    buffer_load_dwordx4 a[60:63], v51, s[24:27], s43 offen offset:896 sc1
    v_mfma_f32_16x16x32_bf16 v[200:203], a[168:171], a[16:19], v[200:203]
    s_waitcnt lgkmcnt(7)
    ds_read_b64_tr_b16 a[190:191], v23 offset:28672
    ds_read_b64_tr_b16 a[160:161], v24 offset:16384
    v_mfma_f32_16x16x32_bf16 v[200:203], a[172:175], a[24:27], v[200:203]
    ds_read_b64_tr_b16 a[162:163], v24 offset:20480
    v_mfma_f32_16x16x32_bf16 v[204:207], a[168:171], a[20:23], v[204:207]
    ds_read_b64_tr_b16 a[164:165], v24 offset:24576
    v_mfma_f32_16x16x32_bf16 v[204:207], a[172:175], a[28:31], v[204:207]
    s_waitcnt lgkmcnt(9)
    ds_read_b64_tr_b16 a[166:167], v24 offset:28672
    v_mfma_f32_16x16x32_bf16 v[208:211], a[176:179], a[16:19], v[208:211]
    s_waitcnt lgkmcnt(8)
    ds_read_b64_tr_b16 a[168:169], v25 offset:16384
    v_mfma_f32_16x16x32_bf16 v[208:211], a[180:183], a[24:27], v[208:211]
    ds_read_b64_tr_b16 a[170:171], v25 offset:20480
    v_mfma_f32_16x16x32_bf16 v[212:215], a[176:179], a[20:23], v[212:215]
    ds_read_b64_tr_b16 a[172:173], v25 offset:24576
    v_mfma_f32_16x16x32_bf16 v[212:215], a[180:183], a[28:31], v[212:215]
    s_waitcnt lgkmcnt(9)
    ds_read_b64_tr_b16 a[174:175], v25 offset:28672
    v_mfma_f32_16x16x32_bf16 v[216:219], a[184:187], a[16:19], v[216:219]
    s_waitcnt lgkmcnt(8)
    ds_read_b64_tr_b16 a[176:177], v26 offset:16384
    v_mfma_f32_16x16x32_bf16 v[216:219], a[188:191], a[24:27], v[216:219]
    ds_read_b64_tr_b16 a[178:179], v26 offset:20480
    v_mfma_f32_16x16x32_bf16 v[220:223], a[184:187], a[20:23], v[220:223]
    ds_read_b64_tr_b16 a[180:181], v26 offset:24576
    v_mfma_f32_16x16x32_bf16 v[220:223], a[188:191], a[28:31], v[220:223]
    s_waitcnt lgkmcnt(9)
    ds_read_b64_tr_b16 a[182:183], v26 offset:28672
    v_mfma_f32_16x16x32_bf16 v[224:227], a[160:163], a[16:19], v[224:227]
    s_waitcnt lgkmcnt(8)
    ds_read_b64_tr_b16 a[184:185], v27 offset:16384
    v_mfma_f32_16x16x32_bf16 v[224:227], a[164:167], a[24:27], v[224:227]
    ds_read_b64_tr_b16 a[186:187], v27 offset:20480
    v_mfma_f32_16x16x32_bf16 v[228:231], a[160:163], a[20:23], v[228:231]
    ds_read_b64_tr_b16 a[188:189], v27 offset:24576
    v_mfma_f32_16x16x32_bf16 v[228:231], a[164:167], a[28:31], v[228:231]
    s_waitcnt lgkmcnt(9)
    ds_read_b64_tr_b16 a[190:191], v27 offset:28672
    s_barrier
    v_mfma_f32_16x16x32_bf16 v[232:235], a[168:171], a[16:19], v[232:235]
    s_waitcnt lgkmcnt(8)
    ds_read_b64_tr_b16 a[160:161], v20 offset:32768
    v_mfma_f32_16x16x32_bf16 v[232:235], a[172:175], a[24:27], v[232:235]
    s_add_u32 s49, s44, 2097152
    ds_read_b64_tr_b16 a[162:163], v20 offset:36864
    v_mfma_f32_16x16x32_bf16 v[236:239], a[168:171], a[20:23], v[236:239]
    s_add_u32 m0, s42, 0
    ds_read_b64_tr_b16 a[164:165], v20 offset:40960
    v_mfma_f32_16x16x32_bf16 v[236:239], a[172:175], a[28:31], v[236:239]
    s_waitcnt lgkmcnt(9)
    buffer_load_dwordx4 v42, s[16:19], s49 offen lds
    v_mfma_f32_16x16x32_bf16 v[240:243], a[176:179], a[16:19], v[240:243]
    s_waitcnt lgkmcnt(7)
    ds_read_b64_tr_b16 a[166:167], v20 offset:45056
    ds_read_b64_tr_b16 a[168:169], v21 offset:32768
    v_mfma_f32_16x16x32_bf16 v[240:243], a[180:183], a[24:27], v[240:243]
Ltour0:
    s_cbranch_execz Ltour4
    ds_read_b64_tr_b16 a[170:171], v21 offset:36864
    v_mfma_f32_16x16x32_bf16 v[244:247], a[176:179], a[20:23], v[244:247]
    ds_read_b64_tr_b16 a[172:173], v21 offset:40960
    v_mfma_f32_16x16x32_bf16 v[244:247], a[180:183], a[28:31], v[244:247]
    s_waitcnt lgkmcnt(9)
    buffer_load_dwordx4 v43, s[16:19], s49 offen offset:1024 lds
    v_mfma_f32_16x16x32_bf16 v[248:251], a[184:187], a[16:19], v[248:251]
    s_waitcnt lgkmcnt(7)
    ds_read_b64_tr_b16 a[174:175], v21 offset:45056
    ds_read_b64_tr_b16 a[176:177], v22 offset:32768
    v_mfma_f32_16x16x32_bf16 v[248:251], a[188:191], a[24:27], v[248:251]
    ds_read_b64_tr_b16 a[178:179], v22 offset:36864
    v_mfma_f32_16x16x32_bf16 v[252:255], a[184:187], a[20:23], v[252:255]
    ds_read_b64_tr_b16 a[180:181], v22 offset:40960
    v_mfma_f32_16x16x32_bf16 v[252:255], a[188:191], a[28:31], v[252:255]
    s_waitcnt vmcnt(18)
    s_waitcnt lgkmcnt(9)
    buffer_load_dwordx4 v44, s[16:19], s49 offen offset:2048 lds
    v_mfma_f32_16x16x32_bf16 v[128:131], a[160:163], a[32:35], v[128:131]
    s_waitcnt vmcnt(18)
    s_waitcnt lgkmcnt(7)
    ds_read_b64_tr_b16 a[182:183], v22 offset:45056
    ds_read_b64_tr_b16 a[184:185], v23 offset:32768
    v_mfma_f32_16x16x32_bf16 v[128:131], a[164:167], a[40:43], v[128:131]
    s_waitcnt vmcnt(17)
    ds_read_b64_tr_b16 a[186:187], v23 offset:36864
    v_mfma_f32_16x16x32_bf16 v[132:135], a[160:163], a[36:39], v[132:135]
    s_waitcnt vmcnt(16)
    ds_read_b64_tr_b16 a[188:189], v23 offset:40960
    v_mfma_f32_16x16x32_bf16 v[132:135], a[164:167], a[44:47], v[132:135]
    s_waitcnt lgkmcnt(9)
    buffer_load_dwordx4 v45, s[16:19], s49 offen offset:3072 lds
    v_mfma_f32_16x16x32_bf16 v[136:139], a[168:171], a[32:35], v[136:139]
    s_waitcnt lgkmcnt(7)
    ds_read_b64_tr_b16 a[190:191], v23 offset:45056
    ds_read_b64_tr_b16 a[160:161], v24 offset:32768
    v_mfma_f32_16x16x32_bf16 v[136:139], a[172:175], a[40:43], v[136:139]
    s_add_u32 s49, s44, 2097408
    ds_read_b64_tr_b16 a[162:163], v24 offset:36864
    v_mfma_f32_16x16x32_bf16 v[140:143], a[168:171], a[36:39], v[140:143]
    s_add_u32 m0, s42, 16384
    ds_read_b64_tr_b16 a[164:165], v24 offset:40960
    v_mfma_f32_16x16x32_bf16 v[140:143], a[172:175], a[44:47], v[140:143]
    s_waitcnt lgkmcnt(9)
    buffer_load_dwordx4 v42, s[16:19], s49 offen lds
    v_mfma_f32_16x16x32_bf16 v[144:147], a[176:179], a[32:35], v[144:147]
    s_waitcnt lgkmcnt(7)
    ds_read_b64_tr_b16 a[166:167], v24 offset:45056
    ds_read_b64_tr_b16 a[168:169], v25 offset:32768
    v_mfma_f32_16x16x32_bf16 v[144:147], a[180:183], a[40:43], v[144:147]
    ds_read_b64_tr_b16 a[170:171], v25 offset:36864
    v_mfma_f32_16x16x32_bf16 v[148:151], a[176:179], a[36:39], v[148:151]
    ds_read_b64_tr_b16 a[172:173], v25 offset:40960
    v_mfma_f32_16x16x32_bf16 v[148:151], a[180:183], a[44:47], v[148:151]
    s_waitcnt lgkmcnt(9)
    buffer_load_dwordx4 v43, s[16:19], s49 offen offset:1024 lds
    v_mfma_f32_16x16x32_bf16 v[152:155], a[184:187], a[32:35], v[152:155]
    s_waitcnt lgkmcnt(7)
    ds_read_b64_tr_b16 a[174:175], v25 offset:45056
    ds_read_b64_tr_b16 a[176:177], v26 offset:32768
    v_mfma_f32_16x16x32_bf16 v[152:155], a[188:191], a[40:43], v[152:155]
    ds_read_b64_tr_b16 a[178:179], v26 offset:36864
    v_mfma_f32_16x16x32_bf16 v[156:159], a[184:187], a[36:39], v[156:159]
    ds_read_b64_tr_b16 a[180:181], v26 offset:40960
    v_mfma_f32_16x16x32_bf16 v[156:159], a[188:191], a[44:47], v[156:159]
    s_waitcnt lgkmcnt(9)
    buffer_load_dwordx4 v44, s[16:19], s49 offen offset:2048 lds
    v_mfma_f32_16x16x32_bf16 v[160:163], a[160:163], a[32:35], v[160:163]
    s_waitcnt lgkmcnt(7)
    ds_read_b64_tr_b16 a[182:183], v26 offset:45056
    ds_read_b64_tr_b16 a[184:185], v27 offset:32768
    v_mfma_f32_16x16x32_bf16 v[160:163], a[164:167], a[40:43], v[160:163]
    ds_read_b64_tr_b16 a[186:187], v27 offset:36864
    v_mfma_f32_16x16x32_bf16 v[164:167], a[160:163], a[36:39], v[164:167]
    ds_read_b64_tr_b16 a[188:189], v27 offset:40960
    v_mfma_f32_16x16x32_bf16 v[164:167], a[164:167], a[44:47], v[164:167]
    s_waitcnt lgkmcnt(9)
    buffer_load_dwordx4 v45, s[16:19], s49 offen offset:3072 lds
    v_mfma_f32_16x16x32_bf16 v[168:171], a[168:171], a[32:35], v[168:171]
    s_waitcnt lgkmcnt(7)
    ds_read_b64_tr_b16 a[190:191], v27 offset:45056
    ds_read_b64_tr_b16 a[160:161], v20 offset:49152
    v_mfma_f32_16x16x32_bf16 v[168:171], a[172:175], a[40:43], v[168:171]
    ds_read_b64_tr_b16 a[162:163], v20 offset:53248
    v_mfma_f32_16x16x32_bf16 v[172:175], a[168:171], a[36:39], v[172:175]
    ds_read_b64_tr_b16 a[164:165], v20 offset:57344
    v_mfma_f32_16x16x32_bf16 v[172:175], a[172:175], a[44:47], v[172:175]
    s_waitcnt lgkmcnt(9)
    buffer_load_dwordx4 a[64:67], v51, s[24:27], s46 offen offset:1024 sc1
    v_mfma_f32_16x16x32_bf16 v[176:179], a[176:179], a[32:35], v[176:179]
    s_waitcnt lgkmcnt(7)
    ds_read_b64_tr_b16 a[166:167], v20 offset:61440
    ds_read_b64_tr_b16 a[168:169], v21 offset:49152
    v_mfma_f32_16x16x32_bf16 v[176:179], a[180:183], a[40:43], v[176:179]
    ds_read_b64_tr_b16 a[170:171], v21 offset:53248
    v_mfma_f32_16x16x32_bf16 v[180:183], a[176:179], a[36:39], v[180:183]
    ds_read_b64_tr_b16 a[172:173], v21 offset:57344
    v_mfma_f32_16x16x32_bf16 v[180:183], a[180:183], a[44:47], v[180:183]
    s_waitcnt lgkmcnt(9)
    buffer_load_dwordx4 a[72:75], v51, s[24:27], s46 offen offset:1152 sc1
    v_mfma_f32_16x16x32_bf16 v[184:187], a[184:187], a[32:35], v[184:187]
    s_waitcnt lgkmcnt(7)
    ds_read_b64_tr_b16 a[174:175], v21 offset:61440
    ds_read_b64_tr_b16 a[176:177], v22 offset:49152
    v_mfma_f32_16x16x32_bf16 v[184:187], a[188:191], a[40:43], v[184:187]
    ds_read_b64_tr_b16 a[178:179], v22 offset:53248
    v_mfma_f32_16x16x32_bf16 v[188:191], a[184:187], a[36:39], v[188:191]
    ds_read_b64_tr_b16 a[180:181], v22 offset:57344
    v_mfma_f32_16x16x32_bf16 v[188:191], a[188:191], a[44:47], v[188:191]
    s_waitcnt lgkmcnt(9)
    buffer_load_dwordx4 a[68:71], v51, s[24:27], s43 offen offset:1024 sc1
    v_mfma_f32_16x16x32_bf16 v[192:195], a[160:163], a[32:35], v[192:195]
    s_waitcnt lgkmcnt(7)
    ds_read_b64_tr_b16 a[182:183], v22 offset:61440
    ds_read_b64_tr_b16 a[184:185], v23 offset:49152
    v_mfma_f32_16x16x32_bf16 v[192:195], a[164:167], a[40:43], v[192:195]
    ds_read_b64_tr_b16 a[186:187], v23 offset:53248
    v_mfma_f32_16x16x32_bf16 v[196:199], a[160:163], a[36:39], v[196:199]
    ds_read_b64_tr_b16 a[188:189], v23 offset:57344
    v_mfma_f32_16x16x32_bf16 v[196:199], a[164:167], a[44:47], v[196:199]
    s_waitcnt lgkmcnt(9)
    buffer_load_dwordx4 a[76:79], v51, s[24:27], s43 offen offset:1152 sc1
    v_mfma_f32_16x16x32_bf16 v[200:203], a[168:171], a[32:35], v[200:203]
    s_waitcnt lgkmcnt(7)
    ds_read_b64_tr_b16 a[190:191], v23 offset:61440
    ds_read_b64_tr_b16 a[160:161], v24 offset:49152
    v_mfma_f32_16x16x32_bf16 v[200:203], a[172:175], a[40:43], v[200:203]
    ds_read_b64_tr_b16 a[162:163], v24 offset:53248
    v_mfma_f32_16x16x32_bf16 v[204:207], a[168:171], a[36:39], v[204:207]
    ds_read_b64_tr_b16 a[164:165], v24 offset:57344
    v_mfma_f32_16x16x32_bf16 v[204:207], a[172:175], a[44:47], v[204:207]
    s_waitcnt lgkmcnt(9)
    ds_read_b64_tr_b16 a[166:167], v24 offset:61440
    v_mfma_f32_16x16x32_bf16 v[208:211], a[176:179], a[32:35], v[208:211]
    s_waitcnt lgkmcnt(8)
    ds_read_b64_tr_b16 a[168:169], v25 offset:49152
    v_mfma_f32_16x16x32_bf16 v[208:211], a[180:183], a[40:43], v[208:211]
    ds_read_b64_tr_b16 a[170:171], v25 offset:53248
    v_mfma_f32_16x16x32_bf16 v[212:215], a[176:179], a[36:39], v[212:215]
    ds_read_b64_tr_b16 a[172:173], v25 offset:57344
    v_mfma_f32_16x16x32_bf16 v[212:215], a[180:183], a[44:47], v[212:215]
    s_waitcnt lgkmcnt(9)
    ds_read_b64_tr_b16 a[174:175], v25 offset:61440
    v_mfma_f32_16x16x32_bf16 v[216:219], a[184:187], a[32:35], v[216:219]
    s_waitcnt lgkmcnt(8)
    ds_read_b64_tr_b16 a[176:177], v26 offset:49152
    v_mfma_f32_16x16x32_bf16 v[216:219], a[188:191], a[40:43], v[216:219]
    ds_read_b64_tr_b16 a[178:179], v26 offset:53248
    v_mfma_f32_16x16x32_bf16 v[220:223], a[184:187], a[36:39], v[220:223]
    ds_read_b64_tr_b16 a[180:181], v26 offset:57344
    v_mfma_f32_16x16x32_bf16 v[220:223], a[188:191], a[44:47], v[220:223]
    s_waitcnt lgkmcnt(9)
    ds_read_b64_tr_b16 a[182:183], v26 offset:61440
    v_mfma_f32_16x16x32_bf16 v[224:227], a[160:163], a[32:35], v[224:227]
    s_waitcnt lgkmcnt(8)
    ds_read_b64_tr_b16 a[184:185], v27 offset:49152
    v_mfma_f32_16x16x32_bf16 v[224:227], a[164:167], a[40:43], v[224:227]
    ds_read_b64_tr_b16 a[186:187], v27 offset:53248
    v_mfma_f32_16x16x32_bf16 v[228:231], a[160:163], a[36:39], v[228:231]
    ds_read_b64_tr_b16 a[188:189], v27 offset:57344
    v_mfma_f32_16x16x32_bf16 v[228:231], a[164:167], a[44:47], v[228:231]
    s_waitcnt lgkmcnt(9)
    ds_read_b64_tr_b16 a[190:191], v27 offset:61440
    s_waitcnt vmcnt(16)
    s_barrier
    v_mfma_f32_16x16x32_bf16 v[232:235], a[168:171], a[32:35], v[232:235]
    s_waitcnt lgkmcnt(8)
    ds_read_b64_tr_b16 a[160:161], v28 offset:0
    v_mfma_f32_16x16x32_bf16 v[232:235], a[172:175], a[40:43], v[232:235]
    s_add_u32 s49, s44, 2621440
    ds_read_b64_tr_b16 a[162:163], v28 offset:4096
    v_mfma_f32_16x16x32_bf16 v[236:239], a[168:171], a[36:39], v[236:239]
    s_add_u32 m0, s42, 32768
    ds_read_b64_tr_b16 a[164:165], v28 offset:8192
    v_mfma_f32_16x16x32_bf16 v[236:239], a[172:175], a[44:47], v[236:239]
    s_waitcnt lgkmcnt(9)
    buffer_load_dwordx4 v42, s[16:19], s49 offen lds
    v_mfma_f32_16x16x32_bf16 v[240:243], a[176:179], a[32:35], v[240:243]
    s_waitcnt lgkmcnt(7)
    ds_read_b64_tr_b16 a[166:167], v28 offset:12288
    ds_read_b64_tr_b16 a[168:169], v29 offset:0
    v_mfma_f32_16x16x32_bf16 v[240:243], a[180:183], a[40:43], v[240:243]
    ds_read_b64_tr_b16 a[170:171], v29 offset:4096
    v_mfma_f32_16x16x32_bf16 v[244:247], a[176:179], a[36:39], v[244:247]
    ds_read_b64_tr_b16 a[172:173], v29 offset:8192
    v_mfma_f32_16x16x32_bf16 v[244:247], a[180:183], a[44:47], v[244:247]
    s_waitcnt lgkmcnt(9)
    buffer_load_dwordx4 v43, s[16:19], s49 offen offset:1024 lds
    v_mfma_f32_16x16x32_bf16 v[248:251], a[184:187], a[32:35], v[248:251]
    s_waitcnt lgkmcnt(7)
    ds_read_b64_tr_b16 a[174:175], v29 offset:12288
    ds_read_b64_tr_b16 a[176:177], v30 offset:0
    v_mfma_f32_16x16x32_bf16 v[248:251], a[188:191], a[40:43], v[248:251]
    ds_read_b64_tr_b16 a[178:179], v30 offset:4096
    v_mfma_f32_16x16x32_bf16 v[252:255], a[184:187], a[36:39], v[252:255]
    ds_read_b64_tr_b16 a[180:181], v30 offset:8192
    v_mfma_f32_16x16x32_bf16 v[252:255], a[188:191], a[44:47], v[252:255]
    s_waitcnt vmcnt(17)
    s_waitcnt lgkmcnt(9)
    buffer_load_dwordx4 v44, s[16:19], s49 offen offset:2048 lds
    v_mfma_f32_16x16x32_bf16 v[128:131], a[160:163], a[48:51], v[128:131]
    s_waitcnt vmcnt(17)
    s_waitcnt lgkmcnt(7)
    ds_read_b64_tr_b16 a[182:183], v30 offset:12288
    ds_read_b64_tr_b16 a[184:185], v31 offset:0
    v_mfma_f32_16x16x32_bf16 v[128:131], a[164:167], a[56:59], v[128:131]
    s_waitcnt vmcnt(16)
    ds_read_b64_tr_b16 a[186:187], v31 offset:4096
    v_mfma_f32_16x16x32_bf16 v[132:135], a[160:163], a[52:55], v[132:135]
    s_waitcnt vmcnt(15)
    ds_read_b64_tr_b16 a[188:189], v31 offset:8192
    v_mfma_f32_16x16x32_bf16 v[132:135], a[164:167], a[60:63], v[132:135]
    s_waitcnt lgkmcnt(9)
    buffer_load_dwordx4 v45, s[16:19], s49 offen offset:3072 lds
    v_mfma_f32_16x16x32_bf16 v[136:139], a[168:171], a[48:51], v[136:139]
    s_waitcnt lgkmcnt(7)
    ds_read_b64_tr_b16 a[190:191], v31 offset:12288
    ds_read_b64_tr_b16 a[160:161], v32 offset:0
    v_mfma_f32_16x16x32_bf16 v[136:139], a[172:175], a[56:59], v[136:139]
    s_add_u32 s49, s44, 2621696
    ds_read_b64_tr_b16 a[162:163], v32 offset:4096
    v_mfma_f32_16x16x32_bf16 v[140:143], a[168:171], a[52:55], v[140:143]
    s_add_u32 m0, s42, 49152
    ds_read_b64_tr_b16 a[164:165], v32 offset:8192
    v_mfma_f32_16x16x32_bf16 v[140:143], a[172:175], a[60:63], v[140:143]
    s_waitcnt lgkmcnt(9)
    buffer_load_dwordx4 v42, s[16:19], s49 offen lds
    v_mfma_f32_16x16x32_bf16 v[144:147], a[176:179], a[48:51], v[144:147]
    s_waitcnt lgkmcnt(7)
    ds_read_b64_tr_b16 a[166:167], v32 offset:12288
    ds_read_b64_tr_b16 a[168:169], v33 offset:0
    v_mfma_f32_16x16x32_bf16 v[144:147], a[180:183], a[56:59], v[144:147]
    ds_read_b64_tr_b16 a[170:171], v33 offset:4096
    v_mfma_f32_16x16x32_bf16 v[148:151], a[176:179], a[52:55], v[148:151]
    ds_read_b64_tr_b16 a[172:173], v33 offset:8192
    v_mfma_f32_16x16x32_bf16 v[148:151], a[180:183], a[60:63], v[148:151]
    s_waitcnt lgkmcnt(9)
    buffer_load_dwordx4 v43, s[16:19], s49 offen offset:1024 lds
    v_mfma_f32_16x16x32_bf16 v[152:155], a[184:187], a[48:51], v[152:155]
    s_waitcnt lgkmcnt(7)
    ds_read_b64_tr_b16 a[174:175], v33 offset:12288
    ds_read_b64_tr_b16 a[176:177], v34 offset:0
    v_mfma_f32_16x16x32_bf16 v[152:155], a[188:191], a[56:59], v[152:155]
    ds_read_b64_tr_b16 a[178:179], v34 offset:4096
    v_mfma_f32_16x16x32_bf16 v[156:159], a[184:187], a[52:55], v[156:159]
    ds_read_b64_tr_b16 a[180:181], v34 offset:8192
    v_mfma_f32_16x16x32_bf16 v[156:159], a[188:191], a[60:63], v[156:159]
    s_waitcnt lgkmcnt(9)
    buffer_load_dwordx4 v44, s[16:19], s49 offen offset:2048 lds
    v_mfma_f32_16x16x32_bf16 v[160:163], a[160:163], a[48:51], v[160:163]
    s_waitcnt lgkmcnt(7)
    ds_read_b64_tr_b16 a[182:183], v34 offset:12288
    ds_read_b64_tr_b16 a[184:185], v35 offset:0
    v_mfma_f32_16x16x32_bf16 v[160:163], a[164:167], a[56:59], v[160:163]
    ds_read_b64_tr_b16 a[186:187], v35 offset:4096
    v_mfma_f32_16x16x32_bf16 v[164:167], a[160:163], a[52:55], v[164:167]
    ds_read_b64_tr_b16 a[188:189], v35 offset:8192
    v_mfma_f32_16x16x32_bf16 v[164:167], a[164:167], a[60:63], v[164:167]
    s_waitcnt lgkmcnt(9)
    buffer_load_dwordx4 v45, s[16:19], s49 offen offset:3072 lds
    v_mfma_f32_16x16x32_bf16 v[168:171], a[168:171], a[48:51], v[168:171]
    s_waitcnt lgkmcnt(7)
    ds_read_b64_tr_b16 a[190:191], v35 offset:12288
    ds_read_b64_tr_b16 a[160:161], v28 offset:16384
    v_mfma_f32_16x16x32_bf16 v[168:171], a[172:175], a[56:59], v[168:171]
    ds_read_b64_tr_b16 a[162:163], v28 offset:20480
    v_mfma_f32_16x16x32_bf16 v[172:175], a[168:171], a[52:55], v[172:175]
    ds_read_b64_tr_b16 a[164:165], v28 offset:24576
    v_mfma_f32_16x16x32_bf16 v[172:175], a[172:175], a[60:63], v[172:175]
    s_waitcnt lgkmcnt(9)
    buffer_load_dwordx4 a[80:83], v51, s[24:27], s46 offen offset:1280 sc1
    v_mfma_f32_16x16x32_bf16 v[176:179], a[176:179], a[48:51], v[176:179]
    s_waitcnt lgkmcnt(7)
    ds_read_b64_tr_b16 a[166:167], v28 offset:28672
    ds_read_b64_tr_b16 a[168:169], v29 offset:16384
    v_mfma_f32_16x16x32_bf16 v[176:179], a[180:183], a[56:59], v[176:179]
    ds_read_b64_tr_b16 a[170:171], v29 offset:20480
    v_mfma_f32_16x16x32_bf16 v[180:183], a[176:179], a[52:55], v[180:183]
    ds_read_b64_tr_b16 a[172:173], v29 offset:24576
    v_mfma_f32_16x16x32_bf16 v[180:183], a[180:183], a[60:63], v[180:183]
    s_waitcnt lgkmcnt(9)
    buffer_load_dwordx4 a[88:91], v51, s[24:27], s46 offen offset:1408 sc1
    v_mfma_f32_16x16x32_bf16 v[184:187], a[184:187], a[48:51], v[184:187]
    s_waitcnt lgkmcnt(7)
    ds_read_b64_tr_b16 a[174:175], v29 offset:28672
    ds_read_b64_tr_b16 a[176:177], v30 offset:16384
    v_mfma_f32_16x16x32_bf16 v[184:187], a[188:191], a[56:59], v[184:187]
    ds_read_b64_tr_b16 a[178:179], v30 offset:20480
    v_mfma_f32_16x16x32_bf16 v[188:191], a[184:187], a[52:55], v[188:191]
    ds_read_b64_tr_b16 a[180:181], v30 offset:24576
    v_mfma_f32_16x16x32_bf16 v[188:191], a[188:191], a[60:63], v[188:191]
    s_waitcnt lgkmcnt(9)
    buffer_load_dwordx4 a[84:87], v51, s[24:27], s43 offen offset:1280 sc1
    v_mfma_f32_16x16x32_bf16 v[192:195], a[160:163], a[48:51], v[192:195]
    s_waitcnt lgkmcnt(7)
    ds_read_b64_tr_b16 a[182:183], v30 offset:28672
    ds_read_b64_tr_b16 a[184:185], v31 offset:16384
    v_mfma_f32_16x16x32_bf16 v[192:195], a[164:167], a[56:59], v[192:195]
    ds_read_b64_tr_b16 a[186:187], v31 offset:20480
    v_mfma_f32_16x16x32_bf16 v[196:199], a[160:163], a[52:55], v[196:199]
    ds_read_b64_tr_b16 a[188:189], v31 offset:24576
    v_mfma_f32_16x16x32_bf16 v[196:199], a[164:167], a[60:63], v[196:199]
    s_waitcnt lgkmcnt(9)
    buffer_load_dwordx4 a[92:95], v51, s[24:27], s43 offen offset:1408 sc1
    v_mfma_f32_16x16x32_bf16 v[200:203], a[168:171], a[48:51], v[200:203]
    s_waitcnt lgkmcnt(7)
    ds_read_b64_tr_b16 a[190:191], v31 offset:28672
    ds_read_b64_tr_b16 a[160:161], v32 offset:16384
    v_mfma_f32_16x16x32_bf16 v[200:203], a[172:175], a[56:59], v[200:203]
    ds_read_b64_tr_b16 a[162:163], v32 offset:20480
    v_mfma_f32_16x16x32_bf16 v[204:207], a[168:171], a[52:55], v[204:207]
    ds_read_b64_tr_b16 a[164:165], v32 offset:24576
    v_mfma_f32_16x16x32_bf16 v[204:207], a[172:175], a[60:63], v[204:207]
    s_waitcnt lgkmcnt(9)
    buffer_load_dword v78, v120, s[8:11], 0 offen
    v_mfma_f32_16x16x32_bf16 v[208:211], a[176:179], a[48:51], v[208:211]
    s_waitcnt lgkmcnt(7)
    ds_read_b64_tr_b16 a[166:167], v32 offset:28672
    ds_read_b64_tr_b16 a[168:169], v33 offset:16384
    v_mfma_f32_16x16x32_bf16 v[208:211], a[180:183], a[56:59], v[208:211]
    ds_read_b64_tr_b16 a[170:171], v33 offset:20480
    v_mfma_f32_16x16x32_bf16 v[212:215], a[176:179], a[52:55], v[212:215]
    ds_read_b64_tr_b16 a[172:173], v33 offset:24576
    v_mfma_f32_16x16x32_bf16 v[212:215], a[180:183], a[60:63], v[212:215]
    s_waitcnt lgkmcnt(9)
    buffer_load_dword v79, v121, s[12:15], 0 offen
    v_mfma_f32_16x16x32_bf16 v[216:219], a[184:187], a[48:51], v[216:219]
    s_waitcnt lgkmcnt(7)
    ds_read_b64_tr_b16 a[174:175], v33 offset:28672
    ds_read_b64_tr_b16 a[176:177], v34 offset:16384
    v_mfma_f32_16x16x32_bf16 v[216:219], a[188:191], a[56:59], v[216:219]
    ds_read_b64_tr_b16 a[178:179], v34 offset:20480
    v_mfma_f32_16x16x32_bf16 v[220:223], a[184:187], a[52:55], v[220:223]
    ds_read_b64_tr_b16 a[180:181], v34 offset:24576
    v_mfma_f32_16x16x32_bf16 v[220:223], a[188:191], a[60:63], v[220:223]
    s_waitcnt lgkmcnt(9)
    ds_read_b64_tr_b16 a[182:183], v34 offset:28672
    v_mfma_f32_16x16x32_bf16 v[224:227], a[160:163], a[48:51], v[224:227]
    s_waitcnt lgkmcnt(8)
    ds_read_b64_tr_b16 a[184:185], v35 offset:16384
    v_mfma_f32_16x16x32_bf16 v[224:227], a[164:167], a[56:59], v[224:227]
    ds_read_b64_tr_b16 a[186:187], v35 offset:20480
    v_mfma_f32_16x16x32_bf16 v[228:231], a[160:163], a[52:55], v[228:231]
    ds_read_b64_tr_b16 a[188:189], v35 offset:24576
    v_mfma_f32_16x16x32_bf16 v[228:231], a[164:167], a[60:63], v[228:231]
    s_waitcnt lgkmcnt(9)
    ds_read_b64_tr_b16 a[190:191], v35 offset:28672
    s_waitcnt vmcnt(18)
    s_barrier
    v_mfma_f32_16x16x32_bf16 v[232:235], a[168:171], a[48:51], v[232:235]
    s_waitcnt lgkmcnt(8)
    ds_read_b64_tr_b16 a[160:161], v12 offset:0
    v_mfma_f32_16x16x32_bf16 v[232:235], a[172:175], a[56:59], v[232:235]
    s_add_u32 s49, s44, 3145728
    ds_read_b64_tr_b16 a[162:163], v12 offset:4096
    v_mfma_f32_16x16x32_bf16 v[236:239], a[168:171], a[52:55], v[236:239]
    s_add_u32 m0, s42, 65536
    ds_read_b64_tr_b16 a[164:165], v12 offset:8192
    v_mfma_f32_16x16x32_bf16 v[236:239], a[172:175], a[60:63], v[236:239]
    s_waitcnt lgkmcnt(9)
    buffer_load_dwordx4 v42, s[16:19], s49 offen lds
    v_mfma_f32_16x16x32_bf16 v[240:243], a[176:179], a[48:51], v[240:243]
    s_waitcnt lgkmcnt(7)
    ds_read_b64_tr_b16 a[166:167], v12 offset:12288
    ds_read_b64_tr_b16 a[168:169], v13 offset:0
    v_mfma_f32_16x16x32_bf16 v[240:243], a[180:183], a[56:59], v[240:243]
    ds_read_b64_tr_b16 a[170:171], v13 offset:4096
    v_mfma_f32_16x16x32_bf16 v[244:247], a[176:179], a[52:55], v[244:247]
    ds_read_b64_tr_b16 a[172:173], v13 offset:8192
    v_mfma_f32_16x16x32_bf16 v[244:247], a[180:183], a[60:63], v[244:247]
    s_waitcnt lgkmcnt(9)
    buffer_load_dwordx4 v43, s[16:19], s49 offen offset:1024 lds
    v_mfma_f32_16x16x32_bf16 v[248:251], a[184:187], a[48:51], v[248:251]
    s_waitcnt lgkmcnt(7)
    ds_read_b64_tr_b16 a[174:175], v13 offset:12288
    ds_read_b64_tr_b16 a[176:177], v14 offset:0
    v_mfma_f32_16x16x32_bf16 v[248:251], a[188:191], a[56:59], v[248:251]
    ds_read_b64_tr_b16 a[178:179], v14 offset:4096
    v_mfma_f32_16x16x32_bf16 v[252:255], a[184:187], a[52:55], v[252:255]
    ds_read_b64_tr_b16 a[180:181], v14 offset:8192
    v_mfma_f32_16x16x32_bf16 v[252:255], a[188:191], a[60:63], v[252:255]
    s_waitcnt vmcnt(19)
    s_waitcnt lgkmcnt(9)
    buffer_load_dwordx4 v44, s[16:19], s49 offen offset:2048 lds
    v_mfma_f32_16x16x32_bf16 v[128:131], a[160:163], a[64:67], v[128:131]
    s_waitcnt vmcnt(19)
    s_waitcnt lgkmcnt(7)
    ds_read_b64_tr_b16 a[182:183], v14 offset:12288
    ds_read_b64_tr_b16 a[184:185], v15 offset:0
    v_mfma_f32_16x16x32_bf16 v[128:131], a[164:167], a[72:75], v[128:131]
    s_waitcnt vmcnt(18)
    ds_read_b64_tr_b16 a[186:187], v15 offset:4096
    v_mfma_f32_16x16x32_bf16 v[132:135], a[160:163], a[68:71], v[132:135]
    s_waitcnt vmcnt(17)
    ds_read_b64_tr_b16 a[188:189], v15 offset:8192
    v_mfma_f32_16x16x32_bf16 v[132:135], a[164:167], a[76:79], v[132:135]
    s_waitcnt lgkmcnt(9)
    buffer_load_dwordx4 v45, s[16:19], s49 offen offset:3072 lds
    v_mfma_f32_16x16x32_bf16 v[136:139], a[168:171], a[64:67], v[136:139]
    s_waitcnt lgkmcnt(7)
    ds_read_b64_tr_b16 a[190:191], v15 offset:12288
    ds_read_b64_tr_b16 a[160:161], v16 offset:0
    v_mfma_f32_16x16x32_bf16 v[136:139], a[172:175], a[72:75], v[136:139]
    s_add_u32 s49, s44, 3145984
    ds_read_b64_tr_b16 a[162:163], v16 offset:4096
    v_mfma_f32_16x16x32_bf16 v[140:143], a[168:171], a[68:71], v[140:143]
    s_add_u32 m0, s42, 81920
    ds_read_b64_tr_b16 a[164:165], v16 offset:8192
    v_mfma_f32_16x16x32_bf16 v[140:143], a[172:175], a[76:79], v[140:143]
    s_waitcnt lgkmcnt(9)
    buffer_load_dwordx4 v42, s[16:19], s49 offen lds
    v_mfma_f32_16x16x32_bf16 v[144:147], a[176:179], a[64:67], v[144:147]
    s_waitcnt lgkmcnt(7)
    ds_read_b64_tr_b16 a[166:167], v16 offset:12288
    ds_read_b64_tr_b16 a[168:169], v17 offset:0
    v_mfma_f32_16x16x32_bf16 v[144:147], a[180:183], a[72:75], v[144:147]
    ds_read_b64_tr_b16 a[170:171], v17 offset:4096
    v_mfma_f32_16x16x32_bf16 v[148:151], a[176:179], a[68:71], v[148:151]
    ds_read_b64_tr_b16 a[172:173], v17 offset:8192
    v_mfma_f32_16x16x32_bf16 v[148:151], a[180:183], a[76:79], v[148:151]
    s_waitcnt lgkmcnt(9)
    buffer_load_dwordx4 v43, s[16:19], s49 offen offset:1024 lds
    v_mfma_f32_16x16x32_bf16 v[152:155], a[184:187], a[64:67], v[152:155]
    s_waitcnt lgkmcnt(7)
    ds_read_b64_tr_b16 a[174:175], v17 offset:12288
    ds_read_b64_tr_b16 a[176:177], v18 offset:0
    v_mfma_f32_16x16x32_bf16 v[152:155], a[188:191], a[72:75], v[152:155]
    ds_read_b64_tr_b16 a[178:179], v18 offset:4096
    v_mfma_f32_16x16x32_bf16 v[156:159], a[184:187], a[68:71], v[156:159]
    ds_read_b64_tr_b16 a[180:181], v18 offset:8192
    v_mfma_f32_16x16x32_bf16 v[156:159], a[188:191], a[76:79], v[156:159]
    s_waitcnt lgkmcnt(9)
    buffer_load_dwordx4 v44, s[16:19], s49 offen offset:2048 lds
    v_mfma_f32_16x16x32_bf16 v[160:163], a[160:163], a[64:67], v[160:163]
    s_waitcnt lgkmcnt(7)
    ds_read_b64_tr_b16 a[182:183], v18 offset:12288
    ds_read_b64_tr_b16 a[184:185], v19 offset:0
    v_mfma_f32_16x16x32_bf16 v[160:163], a[164:167], a[72:75], v[160:163]
    ds_read_b64_tr_b16 a[186:187], v19 offset:4096
    v_mfma_f32_16x16x32_bf16 v[164:167], a[160:163], a[68:71], v[164:167]
    ds_read_b64_tr_b16 a[188:189], v19 offset:8192
    v_mfma_f32_16x16x32_bf16 v[164:167], a[164:167], a[76:79], v[164:167]
    s_waitcnt lgkmcnt(9)
    buffer_load_dwordx4 v45, s[16:19], s49 offen offset:3072 lds
    v_mfma_f32_16x16x32_bf16 v[168:171], a[168:171], a[64:67], v[168:171]
    s_waitcnt lgkmcnt(7)
    ds_read_b64_tr_b16 a[190:191], v19 offset:12288
    ds_read_b64_tr_b16 a[160:161], v12 offset:16384
    v_mfma_f32_16x16x32_bf16 v[168:171], a[172:175], a[72:75], v[168:171]
    ds_read_b64_tr_b16 a[162:163], v12 offset:20480
    v_mfma_f32_16x16x32_bf16 v[172:175], a[168:171], a[68:71], v[172:175]
    ds_read_b64_tr_b16 a[164:165], v12 offset:24576
    v_mfma_f32_16x16x32_bf16 v[172:175], a[172:175], a[76:79], v[172:175]
    s_waitcnt lgkmcnt(9)
    buffer_load_dwordx4 a[96:99], v51, s[24:27], s46 offen offset:1536 sc1
    v_mfma_f32_16x16x32_bf16 v[176:179], a[176:179], a[64:67], v[176:179]
    s_waitcnt lgkmcnt(7)
    ds_read_b64_tr_b16 a[166:167], v12 offset:28672
    ds_read_b64_tr_b16 a[168:169], v13 offset:16384
    v_mfma_f32_16x16x32_bf16 v[176:179], a[180:183], a[72:75], v[176:179]
    ds_read_b64_tr_b16 a[170:171], v13 offset:20480
    v_mfma_f32_16x16x32_bf16 v[180:183], a[176:179], a[68:71], v[180:183]
    ds_read_b64_tr_b16 a[172:173], v13 offset:24576
    v_mfma_f32_16x16x32_bf16 v[180:183], a[180:183], a[76:79], v[180:183]
    s_waitcnt lgkmcnt(9)
    buffer_load_dwordx4 a[104:107], v51, s[24:27], s46 offen offset:1664 sc1
    v_mfma_f32_16x16x32_bf16 v[184:187], a[184:187], a[64:67], v[184:187]
    s_waitcnt lgkmcnt(7)
    ds_read_b64_tr_b16 a[174:175], v13 offset:28672
    ds_read_b64_tr_b16 a[176:177], v14 offset:16384
    v_mfma_f32_16x16x32_bf16 v[184:187], a[188:191], a[72:75], v[184:187]
    ds_read_b64_tr_b16 a[178:179], v14 offset:20480
    v_mfma_f32_16x16x32_bf16 v[188:191], a[184:187], a[68:71], v[188:191]
    ds_read_b64_tr_b16 a[180:181], v14 offset:24576
    v_mfma_f32_16x16x32_bf16 v[188:191], a[188:191], a[76:79], v[188:191]
    s_waitcnt lgkmcnt(9)
    buffer_load_dwordx4 a[100:103], v51, s[24:27], s43 offen offset:1536 sc1
    v_mfma_f32_16x16x32_bf16 v[192:195], a[160:163], a[64:67], v[192:195]
    s_waitcnt lgkmcnt(7)
    ds_read_b64_tr_b16 a[182:183], v14 offset:28672
    ds_read_b64_tr_b16 a[184:185], v15 offset:16384
    v_mfma_f32_16x16x32_bf16 v[192:195], a[164:167], a[72:75], v[192:195]
    ds_read_b64_tr_b16 a[186:187], v15 offset:20480
    v_mfma_f32_16x16x32_bf16 v[196:199], a[160:163], a[68:71], v[196:199]
    ds_read_b64_tr_b16 a[188:189], v15 offset:24576
    v_mfma_f32_16x16x32_bf16 v[196:199], a[164:167], a[76:79], v[196:199]
    s_waitcnt lgkmcnt(9)
    buffer_load_dwordx4 a[108:111], v51, s[24:27], s43 offen offset:1664 sc1
    v_mfma_f32_16x16x32_bf16 v[200:203], a[168:171], a[64:67], v[200:203]
    s_waitcnt lgkmcnt(7)
    ds_read_b64_tr_b16 a[190:191], v15 offset:28672
    ds_read_b64_tr_b16 a[160:161], v16 offset:16384
    v_mfma_f32_16x16x32_bf16 v[200:203], a[172:175], a[72:75], v[200:203]
    ds_read_b64_tr_b16 a[162:163], v16 offset:20480
    v_mfma_f32_16x16x32_bf16 v[204:207], a[168:171], a[68:71], v[204:207]
    ds_read_b64_tr_b16 a[164:165], v16 offset:24576
    v_mfma_f32_16x16x32_bf16 v[204:207], a[172:175], a[76:79], v[204:207]
    s_waitcnt lgkmcnt(9)
    ds_read_b64_tr_b16 a[166:167], v16 offset:28672
    v_mfma_f32_16x16x32_bf16 v[208:211], a[176:179], a[64:67], v[208:211]
    s_waitcnt lgkmcnt(8)
    ds_read_b64_tr_b16 a[168:169], v17 offset:16384
    v_mfma_f32_16x16x32_bf16 v[208:211], a[180:183], a[72:75], v[208:211]
    ds_read_b64_tr_b16 a[170:171], v17 offset:20480
    v_mfma_f32_16x16x32_bf16 v[212:215], a[176:179], a[68:71], v[212:215]
    ds_read_b64_tr_b16 a[172:173], v17 offset:24576
    v_mfma_f32_16x16x32_bf16 v[212:215], a[180:183], a[76:79], v[212:215]
    s_waitcnt lgkmcnt(9)
    ds_read_b64_tr_b16 a[174:175], v17 offset:28672
    v_mfma_f32_16x16x32_bf16 v[216:219], a[184:187], a[64:67], v[216:219]
    s_waitcnt lgkmcnt(8)
    ds_read_b64_tr_b16 a[176:177], v18 offset:16384
    v_mfma_f32_16x16x32_bf16 v[216:219], a[188:191], a[72:75], v[216:219]
    ds_read_b64_tr_b16 a[178:179], v18 offset:20480
    v_mfma_f32_16x16x32_bf16 v[220:223], a[184:187], a[68:71], v[220:223]
    ds_read_b64_tr_b16 a[180:181], v18 offset:24576
    v_mfma_f32_16x16x32_bf16 v[220:223], a[188:191], a[76:79], v[220:223]
    s_waitcnt lgkmcnt(9)
    ds_read_b64_tr_b16 a[182:183], v18 offset:28672
    v_mfma_f32_16x16x32_bf16 v[224:227], a[160:163], a[64:67], v[224:227]
    s_waitcnt lgkmcnt(8)
    ds_read_b64_tr_b16 a[184:185], v19 offset:16384
    v_mfma_f32_16x16x32_bf16 v[224:227], a[164:167], a[72:75], v[224:227]
    ds_read_b64_tr_b16 a[186:187], v19 offset:20480
    v_mfma_f32_16x16x32_bf16 v[228:231], a[160:163], a[68:71], v[228:231]
    ds_read_b64_tr_b16 a[188:189], v19 offset:24576
    v_mfma_f32_16x16x32_bf16 v[228:231], a[164:167], a[76:79], v[228:231]
    s_waitcnt lgkmcnt(9)
    ds_read_b64_tr_b16 a[190:191], v19 offset:28672
    s_waitcnt vmcnt(18)
    s_barrier
    v_mfma_f32_16x16x32_bf16 v[232:235], a[168:171], a[64:67], v[232:235]
    s_waitcnt lgkmcnt(8)
    ds_read_b64_tr_b16 a[160:161], v12 offset:32768
    v_mfma_f32_16x16x32_bf16 v[232:235], a[172:175], a[72:75], v[232:235]
    s_add_u32 s49, s44, 3670016
    ds_read_b64_tr_b16 a[162:163], v12 offset:36864
    v_mfma_f32_16x16x32_bf16 v[236:239], a[168:171], a[68:71], v[236:239]
    s_add_u32 m0, s42, 98304
    ds_read_b64_tr_b16 a[164:165], v12 offset:40960
    v_mfma_f32_16x16x32_bf16 v[236:239], a[172:175], a[76:79], v[236:239]
    s_waitcnt lgkmcnt(9)
    buffer_load_dwordx4 v42, s[16:19], s49 offen lds
    v_mfma_f32_16x16x32_bf16 v[240:243], a[176:179], a[64:67], v[240:243]
    s_waitcnt lgkmcnt(7)
    ds_read_b64_tr_b16 a[166:167], v12 offset:45056
    ds_read_b64_tr_b16 a[168:169], v13 offset:32768
    v_mfma_f32_16x16x32_bf16 v[240:243], a[180:183], a[72:75], v[240:243]
    ds_read_b64_tr_b16 a[170:171], v13 offset:36864
    v_mfma_f32_16x16x32_bf16 v[244:247], a[176:179], a[68:71], v[244:247]
    ds_read_b64_tr_b16 a[172:173], v13 offset:40960
    v_mfma_f32_16x16x32_bf16 v[244:247], a[180:183], a[76:79], v[244:247]
    s_waitcnt lgkmcnt(9)
    buffer_load_dwordx4 v43, s[16:19], s49 offen offset:1024 lds
    v_mfma_f32_16x16x32_bf16 v[248:251], a[184:187], a[64:67], v[248:251]
    s_waitcnt lgkmcnt(7)
    ds_read_b64_tr_b16 a[174:175], v13 offset:45056
    ds_read_b64_tr_b16 a[176:177], v14 offset:32768
    v_mfma_f32_16x16x32_bf16 v[248:251], a[188:191], a[72:75], v[248:251]
    ds_read_b64_tr_b16 a[178:179], v14 offset:36864
    v_mfma_f32_16x16x32_bf16 v[252:255], a[184:187], a[68:71], v[252:255]
    ds_read_b64_tr_b16 a[180:181], v14 offset:40960
    v_mfma_f32_16x16x32_bf16 v[252:255], a[188:191], a[76:79], v[252:255]
    s_waitcnt vmcnt(19)
    s_waitcnt lgkmcnt(9)
    buffer_load_dwordx4 v44, s[16:19], s49 offen offset:2048 lds
    v_mfma_f32_16x16x32_bf16 v[128:131], a[160:163], a[80:83], v[128:131]
    s_waitcnt vmcnt(19)
    s_waitcnt lgkmcnt(7)
    ds_read_b64_tr_b16 a[182:183], v14 offset:45056
    ds_read_b64_tr_b16 a[184:185], v15 offset:32768
Ltour1:
    s_cbranch_execz Ltour5
    v_mfma_f32_16x16x32_bf16 v[128:131], a[164:167], a[88:91], v[128:131]
    s_waitcnt vmcnt(18)
    ds_read_b64_tr_b16 a[186:187], v15 offset:36864
    v_accvgpr_write_b32 a0, 0
    v_mfma_f32_16x16x32_bf16 v[132:135], a[160:163], a[84:87], v[132:135]
    s_waitcnt vmcnt(17)
    ds_read_b64_tr_b16 a[188:189], v15 offset:40960
    v_accvgpr_write_b32 a1, 0
    v_mfma_f32_16x16x32_bf16 v[132:135], a[164:167], a[92:95], v[132:135]
    s_waitcnt lgkmcnt(9)
    buffer_load_dwordx4 v45, s[16:19], s49 offen offset:3072 lds
    v_mfma_f32_16x16x32_bf16 v[136:139], a[168:171], a[80:83], v[136:139]
    s_waitcnt lgkmcnt(7)
    ds_read_b64_tr_b16 a[190:191], v15 offset:45056
    ds_read_b64_tr_b16 a[160:161], v16 offset:32768
    v_mfma_f32_16x16x32_bf16 v[136:139], a[172:175], a[88:91], v[136:139]
    s_add_u32 s49, s44, 3670272
    ds_read_b64_tr_b16 a[162:163], v16 offset:36864
    v_accvgpr_write_b32 a2, 0
    v_mfma_f32_16x16x32_bf16 v[140:143], a[168:171], a[84:87], v[140:143]
    s_add_u32 m0, s42, 114688
    ds_read_b64_tr_b16 a[164:165], v16 offset:40960
    v_accvgpr_write_b32 a3, 0
    v_mfma_f32_16x16x32_bf16 v[140:143], a[172:175], a[92:95], v[140:143]
    s_waitcnt lgkmcnt(9)
    buffer_load_dwordx4 v42, s[16:19], s49 offen lds
    v_mfma_f32_16x16x32_bf16 v[144:147], a[176:179], a[80:83], v[144:147]
    s_waitcnt lgkmcnt(7)
    ds_read_b64_tr_b16 a[166:167], v16 offset:45056
    ds_read_b64_tr_b16 a[168:169], v17 offset:32768
    v_mfma_f32_16x16x32_bf16 v[144:147], a[180:183], a[88:91], v[144:147]
    ds_read_b64_tr_b16 a[170:171], v17 offset:36864
    v_accvgpr_write_b32 a4, 0
    v_mfma_f32_16x16x32_bf16 v[148:151], a[176:179], a[84:87], v[148:151]
    ds_read_b64_tr_b16 a[172:173], v17 offset:40960
    v_accvgpr_write_b32 a5, 0
    v_mfma_f32_16x16x32_bf16 v[148:151], a[180:183], a[92:95], v[148:151]
    s_waitcnt lgkmcnt(9)
    buffer_load_dwordx4 v43, s[16:19], s49 offen offset:1024 lds
    v_mfma_f32_16x16x32_bf16 v[152:155], a[184:187], a[80:83], v[152:155]
    s_waitcnt lgkmcnt(7)
    ds_read_b64_tr_b16 a[174:175], v17 offset:45056
    ds_read_b64_tr_b16 a[176:177], v18 offset:32768
    v_mfma_f32_16x16x32_bf16 v[152:155], a[188:191], a[88:91], v[152:155]
    ds_read_b64_tr_b16 a[178:179], v18 offset:36864
    v_accvgpr_write_b32 a6, 0
    v_mfma_f32_16x16x32_bf16 v[156:159], a[184:187], a[84:87], v[156:159]
    ds_read_b64_tr_b16 a[180:181], v18 offset:40960
    v_accvgpr_write_b32 a7, 0
    v_mfma_f32_16x16x32_bf16 v[156:159], a[188:191], a[92:95], v[156:159]
    s_waitcnt lgkmcnt(9)
    buffer_load_dwordx4 v44, s[16:19], s49 offen offset:2048 lds
    v_mfma_f32_16x16x32_bf16 v[160:163], a[160:163], a[80:83], v[160:163]
    s_waitcnt lgkmcnt(7)
    ds_read_b64_tr_b16 a[182:183], v18 offset:45056
    ds_read_b64_tr_b16 a[184:185], v19 offset:32768
    v_mfma_f32_16x16x32_bf16 v[160:163], a[164:167], a[88:91], v[160:163]
    ds_read_b64_tr_b16 a[186:187], v19 offset:36864
    v_accvgpr_write_b32 a8, 0
    v_mfma_f32_16x16x32_bf16 v[164:167], a[160:163], a[84:87], v[164:167]
    ds_read_b64_tr_b16 a[188:189], v19 offset:40960
    v_accvgpr_write_b32 a9, 0
    v_mfma_f32_16x16x32_bf16 v[164:167], a[164:167], a[92:95], v[164:167]
    s_waitcnt lgkmcnt(9)
    buffer_load_dwordx4 v45, s[16:19], s49 offen offset:3072 lds
    v_mfma_f32_16x16x32_bf16 v[168:171], a[168:171], a[80:83], v[168:171]
    s_waitcnt lgkmcnt(7)
    ds_read_b64_tr_b16 a[190:191], v19 offset:45056
    ds_read_b64_tr_b16 a[160:161], v12 offset:49152
    v_mfma_f32_16x16x32_bf16 v[168:171], a[172:175], a[88:91], v[168:171]
    ds_read_b64_tr_b16 a[162:163], v12 offset:53248
    v_accvgpr_write_b32 a10, 0
    v_mfma_f32_16x16x32_bf16 v[172:175], a[168:171], a[84:87], v[172:175]
    ds_read_b64_tr_b16 a[164:165], v12 offset:57344
    v_accvgpr_write_b32 a11, 0
    v_mfma_f32_16x16x32_bf16 v[172:175], a[172:175], a[92:95], v[172:175]
    s_waitcnt lgkmcnt(9)
    buffer_load_dwordx4 a[112:115], v51, s[24:27], s46 offen offset:1792 sc1
    v_mfma_f32_16x16x32_bf16 v[176:179], a[176:179], a[80:83], v[176:179]
    s_waitcnt lgkmcnt(7)
    ds_read_b64_tr_b16 a[166:167], v12 offset:61440
    ds_read_b64_tr_b16 a[168:169], v13 offset:49152
    v_mfma_f32_16x16x32_bf16 v[176:179], a[180:183], a[88:91], v[176:179]
    ds_read_b64_tr_b16 a[170:171], v13 offset:53248
    v_accvgpr_write_b32 a12, 0
    v_mfma_f32_16x16x32_bf16 v[180:183], a[176:179], a[84:87], v[180:183]
    ds_read_b64_tr_b16 a[172:173], v13 offset:57344
    v_accvgpr_write_b32 a13, 0
    v_mfma_f32_16x16x32_bf16 v[180:183], a[180:183], a[92:95], v[180:183]
    s_waitcnt lgkmcnt(9)
    buffer_load_dwordx4 a[120:123], v51, s[24:27], s46 offen offset:1920 sc1
    v_mfma_f32_16x16x32_bf16 v[184:187], a[184:187], a[80:83], v[184:187]
    s_waitcnt lgkmcnt(7)
    ds_read_b64_tr_b16 a[174:175], v13 offset:61440
    ds_read_b64_tr_b16 a[176:177], v14 offset:49152
    v_mfma_f32_16x16x32_bf16 v[184:187], a[188:191], a[88:91], v[184:187]
    ds_read_b64_tr_b16 a[178:179], v14 offset:53248
    v_accvgpr_write_b32 a14, 0
    v_mfma_f32_16x16x32_bf16 v[188:191], a[184:187], a[84:87], v[188:191]
    ds_read_b64_tr_b16 a[180:181], v14 offset:57344
    v_accvgpr_write_b32 a15, 0
    v_mfma_f32_16x16x32_bf16 v[188:191], a[188:191], a[92:95], v[188:191]
    s_waitcnt lgkmcnt(9)
    buffer_load_dwordx4 a[116:119], v51, s[24:27], s43 offen offset:1792 sc1
    v_mfma_f32_16x16x32_bf16 v[192:195], a[160:163], a[80:83], v[192:195]
    s_waitcnt lgkmcnt(7)
    ds_read_b64_tr_b16 a[182:183], v14 offset:61440
    ds_read_b64_tr_b16 a[184:185], v15 offset:49152
    v_mfma_f32_16x16x32_bf16 v[192:195], a[164:167], a[88:91], v[192:195]
    ds_read_b64_tr_b16 a[186:187], v15 offset:53248
    v_accvgpr_write_b32 a16, 0
    v_mfma_f32_16x16x32_bf16 v[196:199], a[160:163], a[84:87], v[196:199]
    ds_read_b64_tr_b16 a[188:189], v15 offset:57344
    v_accvgpr_write_b32 a17, 0
    v_mfma_f32_16x16x32_bf16 v[196:199], a[164:167], a[92:95], v[196:199]
    s_waitcnt lgkmcnt(9)
    buffer_load_dwordx4 a[124:127], v51, s[24:27], s43 offen offset:1920 sc1
    v_mfma_f32_16x16x32_bf16 v[200:203], a[168:171], a[80:83], v[200:203]
    s_waitcnt lgkmcnt(7)
    ds_read_b64_tr_b16 a[190:191], v15 offset:61440
    ds_read_b64_tr_b16 a[160:161], v16 offset:49152
    v_mfma_f32_16x16x32_bf16 v[200:203], a[172:175], a[88:91], v[200:203]
    ds_read_b64_tr_b16 a[162:163], v16 offset:53248
    v_accvgpr_write_b32 a18, 0
    v_mfma_f32_16x16x32_bf16 v[204:207], a[168:171], a[84:87], v[204:207]
    ds_read_b64_tr_b16 a[164:165], v16 offset:57344
    v_accvgpr_write_b32 a19, 0
    v_mfma_f32_16x16x32_bf16 v[204:207], a[172:175], a[92:95], v[204:207]
    s_waitcnt lgkmcnt(9)
    ds_read_b64_tr_b16 a[166:167], v16 offset:61440
    v_accvgpr_write_b32 a20, 0
    v_mfma_f32_16x16x32_bf16 v[208:211], a[176:179], a[80:83], v[208:211]
    s_waitcnt lgkmcnt(8)
    ds_read_b64_tr_b16 a[168:169], v17 offset:49152
    v_accvgpr_write_b32 a21, 0
    v_mfma_f32_16x16x32_bf16 v[208:211], a[180:183], a[88:91], v[208:211]
    ds_read_b64_tr_b16 a[170:171], v17 offset:53248
    v_accvgpr_write_b32 a22, 0
    v_mfma_f32_16x16x32_bf16 v[212:215], a[176:179], a[84:87], v[212:215]
    ds_read_b64_tr_b16 a[172:173], v17 offset:57344
    v_accvgpr_write_b32 a23, 0
    v_mfma_f32_16x16x32_bf16 v[212:215], a[180:183], a[92:95], v[212:215]
    s_waitcnt lgkmcnt(9)
    ds_read_b64_tr_b16 a[174:175], v17 offset:61440
    v_accvgpr_write_b32 a24, 0
    v_mfma_f32_16x16x32_bf16 v[216:219], a[184:187], a[80:83], v[216:219]
    s_waitcnt lgkmcnt(8)
    ds_read_b64_tr_b16 a[176:177], v18 offset:49152
    v_accvgpr_write_b32 a25, 0
    v_mfma_f32_16x16x32_bf16 v[216:219], a[188:191], a[88:91], v[216:219]
    ds_read_b64_tr_b16 a[178:179], v18 offset:53248
    v_accvgpr_write_b32 a26, 0
    v_mfma_f32_16x16x32_bf16 v[220:223], a[184:187], a[84:87], v[220:223]
    ds_read_b64_tr_b16 a[180:181], v18 offset:57344
    v_accvgpr_write_b32 a27, 0
    v_mfma_f32_16x16x32_bf16 v[220:223], a[188:191], a[92:95], v[220:223]
    s_waitcnt lgkmcnt(9)
    ds_read_b64_tr_b16 a[182:183], v18 offset:61440
    v_accvgpr_write_b32 a28, 0
    v_mfma_f32_16x16x32_bf16 v[224:227], a[160:163], a[80:83], v[224:227]
    s_waitcnt lgkmcnt(8)
    ds_read_b64_tr_b16 a[184:185], v19 offset:49152
    v_accvgpr_write_b32 a29, 0
    v_mfma_f32_16x16x32_bf16 v[224:227], a[164:167], a[88:91], v[224:227]
    ds_read_b64_tr_b16 a[186:187], v19 offset:53248
    v_accvgpr_write_b32 a30, 0
    v_mfma_f32_16x16x32_bf16 v[228:231], a[160:163], a[84:87], v[228:231]
    ds_read_b64_tr_b16 a[188:189], v19 offset:57344
    v_accvgpr_write_b32 a31, 0
    v_mfma_f32_16x16x32_bf16 v[228:231], a[164:167], a[92:95], v[228:231]
    s_waitcnt lgkmcnt(9)
    ds_read_b64_tr_b16 a[190:191], v19 offset:61440
    v_accvgpr_write_b32 a32, 0
    s_waitcnt vmcnt(16)
    s_barrier
    v_mfma_f32_16x16x32_bf16 v[232:235], a[168:171], a[80:83], v[232:235]
    s_waitcnt lgkmcnt(8)
    ds_read_b64_tr_b16 a[160:161], v20 offset:0
    v_accvgpr_write_b32 a33, 0
    v_mfma_f32_16x16x32_bf16 v[232:235], a[172:175], a[88:91], v[232:235]
    s_add_u32 s49, s44, 4194304
    ds_read_b64_tr_b16 a[162:163], v20 offset:4096
    v_accvgpr_write_b32 a34, 0
    v_mfma_f32_16x16x32_bf16 v[236:239], a[168:171], a[84:87], v[236:239]
    s_add_u32 m0, s42, 131072
    ds_read_b64_tr_b16 a[164:165], v20 offset:8192
    v_accvgpr_write_b32 a35, 0
    v_mfma_f32_16x16x32_bf16 v[236:239], a[172:175], a[92:95], v[236:239]
    s_waitcnt lgkmcnt(9)
    buffer_load_dwordx4 v42, s[16:19], s49 offen lds
    v_mfma_f32_16x16x32_bf16 v[240:243], a[176:179], a[80:83], v[240:243]
    s_waitcnt lgkmcnt(7)
    ds_read_b64_tr_b16 a[166:167], v20 offset:12288
    ds_read_b64_tr_b16 a[168:169], v21 offset:0
    v_mfma_f32_16x16x32_bf16 v[240:243], a[180:183], a[88:91], v[240:243]
    ds_read_b64_tr_b16 a[170:171], v21 offset:4096
    v_accvgpr_write_b32 a36, 0
    v_mfma_f32_16x16x32_bf16 v[244:247], a[176:179], a[84:87], v[244:247]
    ds_read_b64_tr_b16 a[172:173], v21 offset:8192
    v_accvgpr_write_b32 a37, 0
    v_mfma_f32_16x16x32_bf16 v[244:247], a[180:183], a[92:95], v[244:247]
    s_waitcnt lgkmcnt(9)
    buffer_load_dwordx4 v43, s[16:19], s49 offen offset:1024 lds
    v_mfma_f32_16x16x32_bf16 v[248:251], a[184:187], a[80:83], v[248:251]
    s_waitcnt lgkmcnt(7)
    ds_read_b64_tr_b16 a[174:175], v21 offset:12288
    ds_read_b64_tr_b16 a[176:177], v22 offset:0
    v_mfma_f32_16x16x32_bf16 v[248:251], a[188:191], a[88:91], v[248:251]
    ds_read_b64_tr_b16 a[178:179], v22 offset:4096
    v_accvgpr_write_b32 a38, 0
    v_mfma_f32_16x16x32_bf16 v[252:255], a[184:187], a[84:87], v[252:255]
    ds_read_b64_tr_b16 a[180:181], v22 offset:8192
    v_accvgpr_write_b32 a39, 0
    v_mfma_f32_16x16x32_bf16 v[252:255], a[188:191], a[92:95], v[252:255]
    s_waitcnt vmcnt(17)
    s_waitcnt lgkmcnt(9)
    buffer_load_dwordx4 v44, s[16:19], s49 offen offset:2048 lds
    v_mfma_f32_16x16x32_bf16 v[128:131], a[160:163], a[96:99], v[128:131]
    s_waitcnt vmcnt(17)
    s_waitcnt lgkmcnt(7)
    ds_read_b64_tr_b16 a[182:183], v22 offset:12288
    ds_read_b64_tr_b16 a[184:185], v23 offset:0
    v_mfma_f32_16x16x32_bf16 v[128:131], a[164:167], a[104:107], v[128:131]
    s_waitcnt vmcnt(16)
    ds_read_b64_tr_b16 a[186:187], v23 offset:4096
    v_accvgpr_write_b32 a40, 0
    v_mfma_f32_16x16x32_bf16 v[132:135], a[160:163], a[100:103], v[132:135]
    s_waitcnt vmcnt(15)
    ds_read_b64_tr_b16 a[188:189], v23 offset:8192
    v_accvgpr_write_b32 a41, 0
    v_mfma_f32_16x16x32_bf16 v[132:135], a[164:167], a[108:111], v[132:135]
    s_waitcnt lgkmcnt(9)
    buffer_load_dwordx4 v45, s[16:19], s49 offen offset:3072 lds
    v_mfma_f32_16x16x32_bf16 v[136:139], a[168:171], a[96:99], v[136:139]
    s_waitcnt lgkmcnt(7)
    ds_read_b64_tr_b16 a[190:191], v23 offset:12288
    ds_read_b64_tr_b16 a[160:161], v24 offset:0
    v_mfma_f32_16x16x32_bf16 v[136:139], a[172:175], a[104:107], v[136:139]
    s_add_u32 s49, s44, 4194560
    ds_read_b64_tr_b16 a[162:163], v24 offset:4096
    v_accvgpr_write_b32 a42, 0
    v_mfma_f32_16x16x32_bf16 v[140:143], a[168:171], a[100:103], v[140:143]
    s_add_u32 m0, s42, 147456
    ds_read_b64_tr_b16 a[164:165], v24 offset:8192
    v_accvgpr_write_b32 a43, 0
    v_mfma_f32_16x16x32_bf16 v[140:143], a[172:175], a[108:111], v[140:143]
    s_waitcnt lgkmcnt(9)
    buffer_load_dwordx4 v42, s[16:19], s49 offen lds
    v_mfma_f32_16x16x32_bf16 v[144:147], a[176:179], a[96:99], v[144:147]
    s_waitcnt lgkmcnt(7)
    ds_read_b64_tr_b16 a[166:167], v24 offset:12288
    ds_read_b64_tr_b16 a[168:169], v25 offset:0
    v_mfma_f32_16x16x32_bf16 v[144:147], a[180:183], a[104:107], v[144:147]
    ds_read_b64_tr_b16 a[170:171], v25 offset:4096
    v_accvgpr_write_b32 a44, 0
    v_mfma_f32_16x16x32_bf16 v[148:151], a[176:179], a[100:103], v[148:151]
    ds_read_b64_tr_b16 a[172:173], v25 offset:8192
    v_accvgpr_write_b32 a45, 0
    v_mfma_f32_16x16x32_bf16 v[148:151], a[180:183], a[108:111], v[148:151]
    s_waitcnt lgkmcnt(9)
    buffer_load_dwordx4 v43, s[16:19], s49 offen offset:1024 lds
    v_mfma_f32_16x16x32_bf16 v[152:155], a[184:187], a[96:99], v[152:155]
    s_waitcnt lgkmcnt(7)
    ds_read_b64_tr_b16 a[174:175], v25 offset:12288
    ds_read_b64_tr_b16 a[176:177], v26 offset:0
    v_mfma_f32_16x16x32_bf16 v[152:155], a[188:191], a[104:107], v[152:155]
    ds_read_b64_tr_b16 a[178:179], v26 offset:4096
    v_accvgpr_write_b32 a46, 0
    v_mfma_f32_16x16x32_bf16 v[156:159], a[184:187], a[100:103], v[156:159]
    ds_read_b64_tr_b16 a[180:181], v26 offset:8192
    v_accvgpr_write_b32 a47, 0
    v_mfma_f32_16x16x32_bf16 v[156:159], a[188:191], a[108:111], v[156:159]
    s_waitcnt lgkmcnt(9)
    buffer_load_dwordx4 v44, s[16:19], s49 offen offset:2048 lds
    v_mfma_f32_16x16x32_bf16 v[160:163], a[160:163], a[96:99], v[160:163]
    s_waitcnt lgkmcnt(7)
    ds_read_b64_tr_b16 a[182:183], v26 offset:12288
    ds_read_b64_tr_b16 a[184:185], v27 offset:0
    v_mfma_f32_16x16x32_bf16 v[160:163], a[164:167], a[104:107], v[160:163]
    ds_read_b64_tr_b16 a[186:187], v27 offset:4096
    v_accvgpr_write_b32 a48, 0
    v_mfma_f32_16x16x32_bf16 v[164:167], a[160:163], a[100:103], v[164:167]
    ds_read_b64_tr_b16 a[188:189], v27 offset:8192
    v_accvgpr_write_b32 a49, 0
    v_mfma_f32_16x16x32_bf16 v[164:167], a[164:167], a[108:111], v[164:167]
    s_waitcnt lgkmcnt(9)
    buffer_load_dwordx4 v45, s[16:19], s49 offen offset:3072 lds
    v_mfma_f32_16x16x32_bf16 v[168:171], a[168:171], a[96:99], v[168:171]
    s_waitcnt lgkmcnt(7)
    ds_read_b64_tr_b16 a[190:191], v27 offset:12288
    ds_read_b64_tr_b16 a[160:161], v20 offset:16384
    v_mfma_f32_16x16x32_bf16 v[168:171], a[172:175], a[104:107], v[168:171]
    ds_read_b64_tr_b16 a[162:163], v20 offset:20480
    v_accvgpr_write_b32 a50, 0
    v_mfma_f32_16x16x32_bf16 v[172:175], a[168:171], a[100:103], v[172:175]
    ds_read_b64_tr_b16 a[164:165], v20 offset:24576
    v_accvgpr_write_b32 a51, 0
    v_mfma_f32_16x16x32_bf16 v[172:175], a[172:175], a[108:111], v[172:175]
    s_waitcnt lgkmcnt(9)
    buffer_load_dwordx4 a[128:131], v51, s[24:27], s46 offen offset:2048 sc1
    v_mfma_f32_16x16x32_bf16 v[176:179], a[176:179], a[96:99], v[176:179]
    s_waitcnt lgkmcnt(7)
    ds_read_b64_tr_b16 a[166:167], v20 offset:28672
    ds_read_b64_tr_b16 a[168:169], v21 offset:16384
    v_mfma_f32_16x16x32_bf16 v[176:179], a[180:183], a[104:107], v[176:179]
    ds_read_b64_tr_b16 a[170:171], v21 offset:20480
    v_accvgpr_write_b32 a52, 0
    v_mfma_f32_16x16x32_bf16 v[180:183], a[176:179], a[100:103], v[180:183]
    ds_read_b64_tr_b16 a[172:173], v21 offset:24576
    v_accvgpr_write_b32 a53, 0
    v_mfma_f32_16x16x32_bf16 v[180:183], a[180:183], a[108:111], v[180:183]
    s_waitcnt lgkmcnt(9)
    buffer_load_dwordx4 a[136:139], v51, s[24:27], s46 offen offset:2176 sc1
    v_mfma_f32_16x16x32_bf16 v[184:187], a[184:187], a[96:99], v[184:187]
    s_waitcnt lgkmcnt(7)
    ds_read_b64_tr_b16 a[174:175], v21 offset:28672
    ds_read_b64_tr_b16 a[176:177], v22 offset:16384
    v_mfma_f32_16x16x32_bf16 v[184:187], a[188:191], a[104:107], v[184:187]
    ds_read_b64_tr_b16 a[178:179], v22 offset:20480
    v_accvgpr_write_b32 a54, 0
    v_mfma_f32_16x16x32_bf16 v[188:191], a[184:187], a[100:103], v[188:191]
    ds_read_b64_tr_b16 a[180:181], v22 offset:24576
    v_accvgpr_write_b32 a55, 0
    v_mfma_f32_16x16x32_bf16 v[188:191], a[188:191], a[108:111], v[188:191]
    s_waitcnt lgkmcnt(9)
    buffer_load_dwordx4 a[132:135], v51, s[24:27], s43 offen offset:2048 sc1
    v_mfma_f32_16x16x32_bf16 v[192:195], a[160:163], a[96:99], v[192:195]
    s_waitcnt lgkmcnt(7)
    ds_read_b64_tr_b16 a[182:183], v22 offset:28672
    ds_read_b64_tr_b16 a[184:185], v23 offset:16384
    v_mfma_f32_16x16x32_bf16 v[192:195], a[164:167], a[104:107], v[192:195]
    ds_read_b64_tr_b16 a[186:187], v23 offset:20480
    v_accvgpr_write_b32 a56, 0
    v_mfma_f32_16x16x32_bf16 v[196:199], a[160:163], a[100:103], v[196:199]
    ds_read_b64_tr_b16 a[188:189], v23 offset:24576
    v_accvgpr_write_b32 a57, 0
    v_mfma_f32_16x16x32_bf16 v[196:199], a[164:167], a[108:111], v[196:199]
    s_waitcnt lgkmcnt(9)
    buffer_load_dwordx4 a[140:143], v51, s[24:27], s43 offen offset:2176 sc1
    v_mfma_f32_16x16x32_bf16 v[200:203], a[168:171], a[96:99], v[200:203]
    s_waitcnt lgkmcnt(7)
    ds_read_b64_tr_b16 a[190:191], v23 offset:28672
    ds_read_b64_tr_b16 a[160:161], v24 offset:16384
    v_mfma_f32_16x16x32_bf16 v[200:203], a[172:175], a[104:107], v[200:203]
    ds_read_b64_tr_b16 a[162:163], v24 offset:20480
    v_accvgpr_write_b32 a58, 0
    v_mfma_f32_16x16x32_bf16 v[204:207], a[168:171], a[100:103], v[204:207]
    ds_read_b64_tr_b16 a[164:165], v24 offset:24576
    v_accvgpr_write_b32 a59, 0
    v_mfma_f32_16x16x32_bf16 v[204:207], a[172:175], a[108:111], v[204:207]
    s_waitcnt lgkmcnt(9)
    ds_read_b64_tr_b16 a[166:167], v24 offset:28672
    v_accvgpr_write_b32 a60, 0
    v_mfma_f32_16x16x32_bf16 v[208:211], a[176:179], a[96:99], v[208:211]
    s_waitcnt lgkmcnt(8)
    ds_read_b64_tr_b16 a[168:169], v25 offset:16384
    v_accvgpr_write_b32 a61, 0
    v_mfma_f32_16x16x32_bf16 v[208:211], a[180:183], a[104:107], v[208:211]
    ds_read_b64_tr_b16 a[170:171], v25 offset:20480
    v_accvgpr_write_b32 a62, 0
    v_mfma_f32_16x16x32_bf16 v[212:215], a[176:179], a[100:103], v[212:215]
    ds_read_b64_tr_b16 a[172:173], v25 offset:24576
    v_accvgpr_write_b32 a63, 0
    v_mfma_f32_16x16x32_bf16 v[212:215], a[180:183], a[108:111], v[212:215]
    s_waitcnt lgkmcnt(9)
    ds_read_b64_tr_b16 a[174:175], v25 offset:28672
    v_accvgpr_write_b32 a64, 0
    v_mfma_f32_16x16x32_bf16 v[216:219], a[184:187], a[96:99], v[216:219]
    s_waitcnt lgkmcnt(8)
    ds_read_b64_tr_b16 a[176:177], v26 offset:16384
    v_accvgpr_write_b32 a65, 0
    v_mfma_f32_16x16x32_bf16 v[216:219], a[188:191], a[104:107], v[216:219]
    ds_read_b64_tr_b16 a[178:179], v26 offset:20480
    v_accvgpr_write_b32 a66, 0
    v_mfma_f32_16x16x32_bf16 v[220:223], a[184:187], a[100:103], v[220:223]
    ds_read_b64_tr_b16 a[180:181], v26 offset:24576
    v_accvgpr_write_b32 a67, 0
    v_mfma_f32_16x16x32_bf16 v[220:223], a[188:191], a[108:111], v[220:223]
    s_waitcnt lgkmcnt(9)
    ds_read_b64_tr_b16 a[182:183], v26 offset:28672
    v_accvgpr_write_b32 a68, 0
    v_mfma_f32_16x16x32_bf16 v[224:227], a[160:163], a[96:99], v[224:227]
    s_waitcnt lgkmcnt(8)
    ds_read_b64_tr_b16 a[184:185], v27 offset:16384
    v_accvgpr_write_b32 a69, 0
    v_mfma_f32_16x16x32_bf16 v[224:227], a[164:167], a[104:107], v[224:227]
    ds_read_b64_tr_b16 a[186:187], v27 offset:20480
    v_accvgpr_write_b32 a70, 0
    v_mfma_f32_16x16x32_bf16 v[228:231], a[160:163], a[100:103], v[228:231]
    ds_read_b64_tr_b16 a[188:189], v27 offset:24576
    v_accvgpr_write_b32 a71, 0
    v_mfma_f32_16x16x32_bf16 v[228:231], a[164:167], a[108:111], v[228:231]
    s_waitcnt lgkmcnt(9)
    ds_read_b64_tr_b16 a[190:191], v27 offset:28672
    v_accvgpr_write_b32 a72, 0
    s_waitcnt vmcnt(16)
    s_barrier
    v_mfma_f32_16x16x32_bf16 v[232:235], a[168:171], a[96:99], v[232:235]
    s_waitcnt lgkmcnt(8)
    ds_read_b64_tr_b16 a[160:161], v20 offset:32768
    v_accvgpr_write_b32 a73, 0
    v_mfma_f32_16x16x32_bf16 v[232:235], a[172:175], a[104:107], v[232:235]
    ds_read_b64_tr_b16 a[162:163], v20 offset:36864
    v_accvgpr_write_b32 a74, 0
    v_mfma_f32_16x16x32_bf16 v[236:239], a[168:171], a[100:103], v[236:239]
    s_add_u32 m0, s42, 0
    ds_read_b64_tr_b16 a[164:165], v20 offset:40960
    v_accvgpr_write_b32 a75, 0
    v_mfma_f32_16x16x32_bf16 v[236:239], a[172:175], a[108:111], v[236:239]
    s_waitcnt lgkmcnt(9)
    buffer_load_dwordx4 v36, s[8:11], s40 offen lds
    v_mfma_f32_16x16x32_bf16 v[240:243], a[176:179], a[96:99], v[240:243]
    s_waitcnt lgkmcnt(7)
    ds_read_b64_tr_b16 a[166:167], v20 offset:45056
    ds_read_b64_tr_b16 a[168:169], v21 offset:32768
    v_mfma_f32_16x16x32_bf16 v[240:243], a[180:183], a[104:107], v[240:243]
    ds_read_b64_tr_b16 a[170:171], v21 offset:36864
    v_accvgpr_write_b32 a76, 0
    v_mfma_f32_16x16x32_bf16 v[244:247], a[176:179], a[100:103], v[244:247]
    ds_read_b64_tr_b16 a[172:173], v21 offset:40960
    v_accvgpr_write_b32 a77, 0
    v_mfma_f32_16x16x32_bf16 v[244:247], a[180:183], a[108:111], v[244:247]
    s_waitcnt lgkmcnt(9)
    buffer_load_dwordx4 v37, s[8:11], s40 offen offset:1024 lds
    v_mfma_f32_16x16x32_bf16 v[248:251], a[184:187], a[96:99], v[248:251]
    s_waitcnt lgkmcnt(7)
    ds_read_b64_tr_b16 a[174:175], v21 offset:45056
    ds_read_b64_tr_b16 a[176:177], v22 offset:32768
    v_mfma_f32_16x16x32_bf16 v[248:251], a[188:191], a[104:107], v[248:251]
    ds_read_b64_tr_b16 a[178:179], v22 offset:36864
    v_accvgpr_write_b32 a78, 0
    v_mfma_f32_16x16x32_bf16 v[252:255], a[184:187], a[100:103], v[252:255]
    ds_read_b64_tr_b16 a[180:181], v22 offset:40960
    v_accvgpr_write_b32 a79, 0
    v_mfma_f32_16x16x32_bf16 v[252:255], a[188:191], a[108:111], v[252:255]
    s_waitcnt vmcnt(17)
    s_waitcnt lgkmcnt(9)
    buffer_load_dwordx4 v38, s[8:11], s40 offen offset:2048 lds
    v_mfma_f32_16x16x32_bf16 v[128:131], a[160:163], a[112:115], v[128:131]
    s_waitcnt vmcnt(17)
    s_waitcnt lgkmcnt(7)
    ds_read_b64_tr_b16 a[182:183], v22 offset:45056
    ds_read_b64_tr_b16 a[184:185], v23 offset:32768
    v_mfma_f32_16x16x32_bf16 v[128:131], a[164:167], a[120:123], v[128:131]
    s_waitcnt vmcnt(16)
    ds_read_b64_tr_b16 a[186:187], v23 offset:36864
    v_accvgpr_write_b32 a80, 0
    v_mfma_f32_16x16x32_bf16 v[132:135], a[160:163], a[116:119], v[132:135]
    s_waitcnt vmcnt(15)
    ds_read_b64_tr_b16 a[188:189], v23 offset:40960
    v_accvgpr_write_b32 a81, 0
    v_mfma_f32_16x16x32_bf16 v[132:135], a[164:167], a[124:127], v[132:135]
    s_waitcnt lgkmcnt(9)
    buffer_load_dwordx4 v39, s[8:11], s40 offen offset:3072 lds
    v_mfma_f32_16x16x32_bf16 v[136:139], a[168:171], a[112:115], v[136:139]
    s_waitcnt lgkmcnt(7)
    s_add_u32 s40, s40, 16384
    ds_read_b64_tr_b16 a[190:191], v23 offset:45056
    ds_read_b64_tr_b16 a[160:161], v24 offset:32768
    v_mfma_f32_16x16x32_bf16 v[136:139], a[172:175], a[120:123], v[136:139]
    ds_read_b64_tr_b16 a[162:163], v24 offset:36864
    v_accvgpr_write_b32 a82, 0
    v_mfma_f32_16x16x32_bf16 v[140:143], a[168:171], a[116:119], v[140:143]
    s_add_u32 m0, s42, 16384
    ds_read_b64_tr_b16 a[164:165], v24 offset:40960
    v_accvgpr_write_b32 a83, 0
    v_mfma_f32_16x16x32_bf16 v[140:143], a[172:175], a[124:127], v[140:143]
    s_waitcnt lgkmcnt(9)
    buffer_load_dwordx4 v36, s[8:11], s40 offen lds
    v_mfma_f32_16x16x32_bf16 v[144:147], a[176:179], a[112:115], v[144:147]
    s_waitcnt lgkmcnt(7)
    ds_read_b64_tr_b16 a[166:167], v24 offset:45056
    ds_read_b64_tr_b16 a[168:169], v25 offset:32768
    v_mfma_f32_16x16x32_bf16 v[144:147], a[180:183], a[120:123], v[144:147]
    ds_read_b64_tr_b16 a[170:171], v25 offset:36864
    v_accvgpr_write_b32 a84, 0
    v_mfma_f32_16x16x32_bf16 v[148:151], a[176:179], a[116:119], v[148:151]
    ds_read_b64_tr_b16 a[172:173], v25 offset:40960
    v_accvgpr_write_b32 a85, 0
    v_mfma_f32_16x16x32_bf16 v[148:151], a[180:183], a[124:127], v[148:151]
    s_waitcnt lgkmcnt(9)
    buffer_load_dwordx4 v37, s[8:11], s40 offen offset:1024 lds
    v_mfma_f32_16x16x32_bf16 v[152:155], a[184:187], a[112:115], v[152:155]
    s_waitcnt lgkmcnt(7)
    ds_read_b64_tr_b16 a[174:175], v25 offset:45056
    ds_read_b64_tr_b16 a[176:177], v26 offset:32768
    v_mfma_f32_16x16x32_bf16 v[152:155], a[188:191], a[120:123], v[152:155]
    ds_read_b64_tr_b16 a[178:179], v26 offset:36864
    v_accvgpr_write_b32 a86, 0
    v_mfma_f32_16x16x32_bf16 v[156:159], a[184:187], a[116:119], v[156:159]
    ds_read_b64_tr_b16 a[180:181], v26 offset:40960
    v_accvgpr_write_b32 a87, 0
    v_mfma_f32_16x16x32_bf16 v[156:159], a[188:191], a[124:127], v[156:159]
    s_waitcnt lgkmcnt(9)
    buffer_load_dwordx4 v38, s[8:11], s40 offen offset:2048 lds
    v_mfma_f32_16x16x32_bf16 v[160:163], a[160:163], a[112:115], v[160:163]
    s_waitcnt lgkmcnt(7)
    ds_read_b64_tr_b16 a[182:183], v26 offset:45056
    ds_read_b64_tr_b16 a[184:185], v27 offset:32768
    v_mfma_f32_16x16x32_bf16 v[160:163], a[164:167], a[120:123], v[160:163]
    ds_read_b64_tr_b16 a[186:187], v27 offset:36864
    v_accvgpr_write_b32 a88, 0
    v_mfma_f32_16x16x32_bf16 v[164:167], a[160:163], a[116:119], v[164:167]
    ds_read_b64_tr_b16 a[188:189], v27 offset:40960
    v_accvgpr_write_b32 a89, 0
    v_mfma_f32_16x16x32_bf16 v[164:167], a[164:167], a[124:127], v[164:167]
    s_waitcnt lgkmcnt(9)
    buffer_load_dwordx4 v39, s[8:11], s40 offen offset:3072 lds
    v_mfma_f32_16x16x32_bf16 v[168:171], a[168:171], a[112:115], v[168:171]
    s_waitcnt lgkmcnt(7)
    s_add_u32 s40, s40, 16384
    ds_read_b64_tr_b16 a[190:191], v27 offset:45056
    ds_read_b64_tr_b16 a[160:161], v20 offset:49152
    v_mfma_f32_16x16x32_bf16 v[168:171], a[172:175], a[120:123], v[168:171]
    ds_read_b64_tr_b16 a[162:163], v20 offset:53248
    v_accvgpr_write_b32 a90, 0
    v_mfma_f32_16x16x32_bf16 v[172:175], a[168:171], a[116:119], v[172:175]
    ds_read_b64_tr_b16 a[164:165], v20 offset:57344
    v_accvgpr_write_b32 a91, 0
    v_mfma_f32_16x16x32_bf16 v[172:175], a[172:175], a[124:127], v[172:175]
    s_waitcnt lgkmcnt(9)
    buffer_store_dword v76, v72, s[24:27], s92 offen offset:12 sc1
    v_mfma_f32_16x16x32_bf16 v[176:179], a[176:179], a[112:115], v[176:179]
    s_waitcnt lgkmcnt(7)
    ds_read_b64_tr_b16 a[166:167], v20 offset:61440
    ds_read_b64_tr_b16 a[168:169], v21 offset:49152
    v_mfma_f32_16x16x32_bf16 v[176:179], a[180:183], a[120:123], v[176:179]
    ds_read_b64_tr_b16 a[170:171], v21 offset:53248
    v_accvgpr_write_b32 a92, 0
    v_mfma_f32_16x16x32_bf16 v[180:183], a[176:179], a[116:119], v[180:183]
    ds_read_b64_tr_b16 a[172:173], v21 offset:57344
    v_accvgpr_write_b32 a93, 0
    v_mfma_f32_16x16x32_bf16 v[180:183], a[180:183], a[124:127], v[180:183]
    s_waitcnt lgkmcnt(9)
    buffer_store_dwordx4 v[88:91], v74, s[24:27], 0 offen sc1
    v_mfma_f32_16x16x32_bf16 v[184:187], a[184:187], a[112:115], v[184:187]
    s_waitcnt lgkmcnt(7)
    ds_read_b64_tr_b16 a[174:175], v21 offset:61440
    ds_read_b64_tr_b16 a[176:177], v22 offset:49152
    v_mfma_f32_16x16x32_bf16 v[184:187], a[188:191], a[120:123], v[184:187]
    ds_read_b64_tr_b16 a[178:179], v22 offset:53248
    v_accvgpr_write_b32 a94, 0
    v_mfma_f32_16x16x32_bf16 v[188:191], a[184:187], a[116:119], v[188:191]
    ds_read_b64_tr_b16 a[180:181], v22 offset:57344
    v_accvgpr_write_b32 a95, 0
    v_mfma_f32_16x16x32_bf16 v[188:191], a[188:191], a[124:127], v[188:191]
    s_waitcnt lgkmcnt(9)
    ds_read_b64_tr_b16 a[182:183], v22 offset:61440
    v_accvgpr_write_b32 a96, 0
    v_mfma_f32_16x16x32_bf16 v[192:195], a[160:163], a[112:115], v[192:195]
    s_waitcnt lgkmcnt(8)
    ds_read_b64_tr_b16 a[184:185], v23 offset:49152
    v_accvgpr_write_b32 a97, 0
    v_mfma_f32_16x16x32_bf16 v[192:195], a[164:167], a[120:123], v[192:195]
Ltour2:
    s_cbranch_execz Ltour6
    ds_read_b64_tr_b16 a[186:187], v23 offset:53248
    v_accvgpr_write_b32 a98, 0
    v_mfma_f32_16x16x32_bf16 v[196:199], a[160:163], a[116:119], v[196:199]
    ds_read_b64_tr_b16 a[188:189], v23 offset:57344
    v_accvgpr_write_b32 a99, 0
    v_mfma_f32_16x16x32_bf16 v[196:199], a[164:167], a[124:127], v[196:199]
    s_waitcnt lgkmcnt(9)
    ds_read_b64_tr_b16 a[190:191], v23 offset:61440
    v_accvgpr_write_b32 a100, 0
    v_mfma_f32_16x16x32_bf16 v[200:203], a[168:171], a[112:115], v[200:203]
    s_waitcnt lgkmcnt(8)
    ds_read_b64_tr_b16 a[160:161], v24 offset:49152
    v_accvgpr_write_b32 a101, 0
    v_mfma_f32_16x16x32_bf16 v[200:203], a[172:175], a[120:123], v[200:203]
    ds_read_b64_tr_b16 a[162:163], v24 offset:53248
    v_accvgpr_write_b32 a102, 0
    v_mfma_f32_16x16x32_bf16 v[204:207], a[168:171], a[116:119], v[204:207]
    ds_read_b64_tr_b16 a[164:165], v24 offset:57344
    v_accvgpr_write_b32 a103, 0
    v_mfma_f32_16x16x32_bf16 v[204:207], a[172:175], a[124:127], v[204:207]
    s_waitcnt lgkmcnt(9)
    ds_read_b64_tr_b16 a[166:167], v24 offset:61440
    v_accvgpr_write_b32 a104, 0
    v_mfma_f32_16x16x32_bf16 v[208:211], a[176:179], a[112:115], v[208:211]
    s_waitcnt lgkmcnt(8)
    ds_read_b64_tr_b16 a[168:169], v25 offset:49152
    v_accvgpr_write_b32 a105, 0
    v_mfma_f32_16x16x32_bf16 v[208:211], a[180:183], a[120:123], v[208:211]
    ds_read_b64_tr_b16 a[170:171], v25 offset:53248
    v_accvgpr_write_b32 a106, 0
    v_mfma_f32_16x16x32_bf16 v[212:215], a[176:179], a[116:119], v[212:215]
    ds_read_b64_tr_b16 a[172:173], v25 offset:57344
    v_accvgpr_write_b32 a107, 0
    v_mfma_f32_16x16x32_bf16 v[212:215], a[180:183], a[124:127], v[212:215]
    s_waitcnt lgkmcnt(9)
    ds_read_b64_tr_b16 a[174:175], v25 offset:61440
    v_accvgpr_write_b32 a108, 0
    v_mfma_f32_16x16x32_bf16 v[216:219], a[184:187], a[112:115], v[216:219]
    s_waitcnt lgkmcnt(8)
    ds_read_b64_tr_b16 a[176:177], v26 offset:49152
    v_accvgpr_write_b32 a109, 0
    v_mfma_f32_16x16x32_bf16 v[216:219], a[188:191], a[120:123], v[216:219]
    ds_read_b64_tr_b16 a[178:179], v26 offset:53248
    v_accvgpr_write_b32 a110, 0
    v_mfma_f32_16x16x32_bf16 v[220:223], a[184:187], a[116:119], v[220:223]
    ds_read_b64_tr_b16 a[180:181], v26 offset:57344
    v_accvgpr_write_b32 a111, 0
    v_mfma_f32_16x16x32_bf16 v[220:223], a[188:191], a[124:127], v[220:223]
    s_waitcnt lgkmcnt(9)
    ds_read_b64_tr_b16 a[182:183], v26 offset:61440
    v_accvgpr_write_b32 a192, 0
    v_mfma_f32_16x16x32_bf16 v[224:227], a[160:163], a[112:115], v[224:227]
    s_waitcnt lgkmcnt(8)
    ds_read_b64_tr_b16 a[184:185], v27 offset:49152
    v_accvgpr_write_b32 a193, 0
    v_mfma_f32_16x16x32_bf16 v[224:227], a[164:167], a[120:123], v[224:227]
    ds_read_b64_tr_b16 a[186:187], v27 offset:53248
    v_accvgpr_write_b32 a194, 0
    v_mfma_f32_16x16x32_bf16 v[228:231], a[160:163], a[116:119], v[228:231]
    ds_read_b64_tr_b16 a[188:189], v27 offset:57344
    v_accvgpr_write_b32 a195, 0
    v_mfma_f32_16x16x32_bf16 v[228:231], a[164:167], a[124:127], v[228:231]
    s_waitcnt lgkmcnt(9)
    ds_read_b64_tr_b16 a[190:191], v27 offset:61440
    v_accvgpr_write_b32 a196, 0
    s_waitcnt vmcnt(14)
    s_barrier
    v_mfma_f32_16x16x32_bf16 v[232:235], a[168:171], a[112:115], v[232:235]
    s_waitcnt lgkmcnt(8)
    ds_read_b64_tr_b16 a[160:161], v28 offset:0
    v_accvgpr_write_b32 a197, 0
    v_mfma_f32_16x16x32_bf16 v[232:235], a[172:175], a[120:123], v[232:235]
    ds_read_b64_tr_b16 a[162:163], v28 offset:4096
    v_accvgpr_write_b32 a198, 0
    v_mfma_f32_16x16x32_bf16 v[236:239], a[168:171], a[116:119], v[236:239]
    s_add_u32 m0, s42, 32768
    ds_read_b64_tr_b16 a[164:165], v28 offset:8192
    v_accvgpr_write_b32 a199, 0
    v_mfma_f32_16x16x32_bf16 v[236:239], a[172:175], a[124:127], v[236:239]
    s_waitcnt lgkmcnt(9)
    buffer_load_dwordx4 v36, s[8:11], s40 offen lds
    v_mfma_f32_16x16x32_bf16 v[240:243], a[176:179], a[112:115], v[240:243]
    s_waitcnt lgkmcnt(7)
    ds_read_b64_tr_b16 a[166:167], v28 offset:12288
    ds_read_b64_tr_b16 a[168:169], v29 offset:0
    v_mfma_f32_16x16x32_bf16 v[240:243], a[180:183], a[120:123], v[240:243]
    ds_read_b64_tr_b16 a[170:171], v29 offset:4096
    v_accvgpr_write_b32 a200, 0
    v_mfma_f32_16x16x32_bf16 v[244:247], a[176:179], a[116:119], v[244:247]
    ds_read_b64_tr_b16 a[172:173], v29 offset:8192
    v_accvgpr_write_b32 a201, 0
    v_mfma_f32_16x16x32_bf16 v[244:247], a[180:183], a[124:127], v[244:247]
    s_waitcnt lgkmcnt(9)
    buffer_load_dwordx4 v37, s[8:11], s40 offen offset:1024 lds
    v_mfma_f32_16x16x32_bf16 v[248:251], a[184:187], a[112:115], v[248:251]
    s_waitcnt lgkmcnt(7)
    ds_read_b64_tr_b16 a[174:175], v29 offset:12288
    ds_read_b64_tr_b16 a[176:177], v30 offset:0
    v_mfma_f32_16x16x32_bf16 v[248:251], a[188:191], a[120:123], v[248:251]
    ds_read_b64_tr_b16 a[178:179], v30 offset:4096
    v_accvgpr_write_b32 a202, 0
    v_mfma_f32_16x16x32_bf16 v[252:255], a[184:187], a[116:119], v[252:255]
    ds_read_b64_tr_b16 a[180:181], v30 offset:8192
    v_accvgpr_write_b32 a203, 0
    v_mfma_f32_16x16x32_bf16 v[252:255], a[188:191], a[124:127], v[252:255]
    s_waitcnt vmcnt(15)
    s_waitcnt lgkmcnt(9)
    buffer_load_dwordx4 v38, s[8:11], s40 offen offset:2048 lds
    v_mfma_f32_16x16x32_bf16 v[128:131], a[160:163], a[128:131], v[128:131]
    s_waitcnt vmcnt(15)
    s_waitcnt lgkmcnt(7)
    ds_read_b64_tr_b16 a[182:183], v30 offset:12288
    ds_read_b64_tr_b16 a[184:185], v31 offset:0
    v_mfma_f32_16x16x32_bf16 v[128:131], a[164:167], a[136:139], v[128:131]
    s_waitcnt vmcnt(14)
    ds_read_b64_tr_b16 a[186:187], v31 offset:4096
    v_accvgpr_write_b32 a204, 0
    v_mfma_f32_16x16x32_bf16 v[132:135], a[160:163], a[132:135], v[132:135]
    s_waitcnt vmcnt(13)
    ds_read_b64_tr_b16 a[188:189], v31 offset:8192
    v_accvgpr_write_b32 a205, 0
    v_mfma_f32_16x16x32_bf16 v[132:135], a[164:167], a[140:143], v[132:135]
    s_waitcnt lgkmcnt(9)
    buffer_load_dwordx4 v39, s[8:11], s40 offen offset:3072 lds
    v_mfma_f32_16x16x32_bf16 v[136:139], a[168:171], a[128:131], v[136:139]
    s_waitcnt lgkmcnt(7)
    s_add_u32 s40, s40, 16384
    ds_read_b64_tr_b16 a[190:191], v31 offset:12288
    ds_read_b64_tr_b16 a[160:161], v32 offset:0
    v_mfma_f32_16x16x32_bf16 v[136:139], a[172:175], a[136:139], v[136:139]
    ds_read_b64_tr_b16 a[162:163], v32 offset:4096
    v_accvgpr_write_b32 a206, 0
    v_mfma_f32_16x16x32_bf16 v[140:143], a[168:171], a[132:135], v[140:143]
    s_add_u32 m0, s42, 65536
    ds_read_b64_tr_b16 a[164:165], v32 offset:8192
    v_accvgpr_write_b32 a207, 0
    v_mfma_f32_16x16x32_bf16 v[140:143], a[172:175], a[140:143], v[140:143]
    s_waitcnt lgkmcnt(9)
    buffer_load_dwordx4 v40, s[12:15], s41 offen lds
    v_mfma_f32_16x16x32_bf16 v[144:147], a[176:179], a[128:131], v[144:147]
    s_waitcnt lgkmcnt(7)
    ds_read_b64_tr_b16 a[166:167], v32 offset:12288
    ds_read_b64_tr_b16 a[168:169], v33 offset:0
    v_mfma_f32_16x16x32_bf16 v[144:147], a[180:183], a[136:139], v[144:147]
    ds_read_b64_tr_b16 a[170:171], v33 offset:4096
    v_accvgpr_write_b32 a112, 0
    v_mfma_f32_16x16x32_bf16 v[148:151], a[176:179], a[132:135], v[148:151]
    ds_read_b64_tr_b16 a[172:173], v33 offset:8192
    v_accvgpr_write_b32 a113, 0
    v_mfma_f32_16x16x32_bf16 v[148:151], a[180:183], a[140:143], v[148:151]
    s_waitcnt lgkmcnt(9)
    buffer_load_dwordx4 v41, s[12:15], s41 offen offset:1024 lds
    v_mfma_f32_16x16x32_bf16 v[152:155], a[184:187], a[128:131], v[152:155]
    s_waitcnt lgkmcnt(7)
    ds_read_b64_tr_b16 a[174:175], v33 offset:12288
    ds_read_b64_tr_b16 a[176:177], v34 offset:0
    v_mfma_f32_16x16x32_bf16 v[152:155], a[188:191], a[136:139], v[152:155]
    ds_read_b64_tr_b16 a[178:179], v34 offset:4096
    v_accvgpr_write_b32 a114, 0
    v_mfma_f32_16x16x32_bf16 v[156:159], a[184:187], a[132:135], v[156:159]
    ds_read_b64_tr_b16 a[180:181], v34 offset:8192
    v_accvgpr_write_b32 a115, 0
    v_mfma_f32_16x16x32_bf16 v[156:159], a[188:191], a[140:143], v[156:159]
    s_waitcnt lgkmcnt(9)
    buffer_load_dwordx4 v40, s[12:15], s41 offen offset:2048 lds
    v_mfma_f32_16x16x32_bf16 v[160:163], a[160:163], a[128:131], v[160:163]
    s_waitcnt lgkmcnt(7)
    ds_read_b64_tr_b16 a[182:183], v34 offset:12288
    ds_read_b64_tr_b16 a[184:185], v35 offset:0
    v_mfma_f32_16x16x32_bf16 v[160:163], a[164:167], a[136:139], v[160:163]
    ds_read_b64_tr_b16 a[186:187], v35 offset:4096
    v_accvgpr_write_b32 a116, 0
    v_mfma_f32_16x16x32_bf16 v[164:167], a[160:163], a[132:135], v[164:167]
    ds_read_b64_tr_b16 a[188:189], v35 offset:8192
    v_accvgpr_write_b32 a117, 0
    v_mfma_f32_16x16x32_bf16 v[164:167], a[164:167], a[140:143], v[164:167]
    s_waitcnt lgkmcnt(9)
    buffer_load_dwordx4 v41, s[12:15], s41 offen offset:3072 lds
    v_mfma_f32_16x16x32_bf16 v[168:171], a[168:171], a[128:131], v[168:171]
    s_waitcnt lgkmcnt(7)
    s_add_u32 s41, s41, 16384
    ds_read_b64_tr_b16 a[190:191], v35 offset:12288
    ds_read_b64_tr_b16 a[160:161], v28 offset:16384
    v_mfma_f32_16x16x32_bf16 v[168:171], a[172:175], a[136:139], v[168:171]
    ds_read_b64_tr_b16 a[162:163], v28 offset:20480
    v_accvgpr_write_b32 a118, 0
    v_mfma_f32_16x16x32_bf16 v[172:175], a[168:171], a[132:135], v[172:175]
    s_add_u32 m0, s42, 81920
    ds_read_b64_tr_b16 a[164:165], v28 offset:24576
    v_accvgpr_write_b32 a119, 0
    v_mfma_f32_16x16x32_bf16 v[172:175], a[172:175], a[140:143], v[172:175]
    s_waitcnt lgkmcnt(9)
    buffer_load_dwordx4 v40, s[12:15], s41 offen lds
    v_mfma_f32_16x16x32_bf16 v[176:179], a[176:179], a[128:131], v[176:179]
    s_waitcnt lgkmcnt(7)
    ds_read_b64_tr_b16 a[166:167], v28 offset:28672
    ds_read_b64_tr_b16 a[168:169], v29 offset:16384
    v_mfma_f32_16x16x32_bf16 v[176:179], a[180:183], a[136:139], v[176:179]
    ds_read_b64_tr_b16 a[170:171], v29 offset:20480
    v_accvgpr_write_b32 a120, 0
    v_mfma_f32_16x16x32_bf16 v[180:183], a[176:179], a[132:135], v[180:183]
    ds_read_b64_tr_b16 a[172:173], v29 offset:24576
    v_accvgpr_write_b32 a121, 0
    v_mfma_f32_16x16x32_bf16 v[180:183], a[180:183], a[140:143], v[180:183]
    s_waitcnt lgkmcnt(9)
    buffer_load_dwordx4 v41, s[12:15], s41 offen offset:1024 lds
    v_mfma_f32_16x16x32_bf16 v[184:187], a[184:187], a[128:131], v[184:187]
    s_waitcnt lgkmcnt(7)
    ds_read_b64_tr_b16 a[174:175], v29 offset:28672
    ds_read_b64_tr_b16 a[176:177], v30 offset:16384
    v_mfma_f32_16x16x32_bf16 v[184:187], a[188:191], a[136:139], v[184:187]
    ds_read_b64_tr_b16 a[178:179], v30 offset:20480
    v_accvgpr_write_b32 a122, 0
    v_mfma_f32_16x16x32_bf16 v[188:191], a[184:187], a[132:135], v[188:191]
    ds_read_b64_tr_b16 a[180:181], v30 offset:24576
    v_accvgpr_write_b32 a123, 0
    v_mfma_f32_16x16x32_bf16 v[188:191], a[188:191], a[140:143], v[188:191]
    s_waitcnt lgkmcnt(9)
    buffer_load_dwordx4 v40, s[12:15], s41 offen offset:2048 lds
    v_mfma_f32_16x16x32_bf16 v[192:195], a[160:163], a[128:131], v[192:195]
    s_waitcnt lgkmcnt(7)
    ds_read_b64_tr_b16 a[182:183], v30 offset:28672
    ds_read_b64_tr_b16 a[184:185], v31 offset:16384
    v_mfma_f32_16x16x32_bf16 v[192:195], a[164:167], a[136:139], v[192:195]
    ds_read_b64_tr_b16 a[186:187], v31 offset:20480
    v_accvgpr_write_b32 a124, 0
    v_mfma_f32_16x16x32_bf16 v[196:199], a[160:163], a[132:135], v[196:199]
    ds_read_b64_tr_b16 a[188:189], v31 offset:24576
    v_accvgpr_write_b32 a125, 0
    v_mfma_f32_16x16x32_bf16 v[196:199], a[164:167], a[140:143], v[196:199]
    s_waitcnt lgkmcnt(9)
    buffer_load_dwordx4 v41, s[12:15], s41 offen offset:3072 lds
    v_mfma_f32_16x16x32_bf16 v[200:203], a[168:171], a[128:131], v[200:203]
    s_waitcnt lgkmcnt(7)
    s_add_u32 s41, s41, 16384
    ds_read_b64_tr_b16 a[190:191], v31 offset:28672
    ds_read_b64_tr_b16 a[160:161], v32 offset:16384
    v_mfma_f32_16x16x32_bf16 v[200:203], a[172:175], a[136:139], v[200:203]
    ds_read_b64_tr_b16 a[162:163], v32 offset:20480
    v_accvgpr_write_b32 a126, 0
    v_mfma_f32_16x16x32_bf16 v[204:207], a[168:171], a[132:135], v[204:207]
    ds_read_b64_tr_b16 a[164:165], v32 offset:24576
    v_accvgpr_write_b32 a127, 0
    v_mfma_f32_16x16x32_bf16 v[204:207], a[172:175], a[140:143], v[204:207]
    s_waitcnt lgkmcnt(9)
    ds_read_b64_tr_b16 a[166:167], v32 offset:28672
    v_mfma_f32_16x16x32_bf16 v[208:211], a[176:179], a[128:131], v[208:211]
    s_waitcnt lgkmcnt(8)
    ds_read_b64_tr_b16 a[168:169], v33 offset:16384
    v_mfma_f32_16x16x32_bf16 v[208:211], a[180:183], a[136:139], v[208:211]
    ds_read_b64_tr_b16 a[170:171], v33 offset:20480
    v_mfma_f32_16x16x32_bf16 v[212:215], a[176:179], a[132:135], v[212:215]
    ds_read_b64_tr_b16 a[172:173], v33 offset:24576
    v_mfma_f32_16x16x32_bf16 v[212:215], a[180:183], a[140:143], v[212:215]
    s_waitcnt lgkmcnt(9)
    ds_read_b64_tr_b16 a[174:175], v33 offset:28672
    v_mfma_f32_16x16x32_bf16 v[216:219], a[184:187], a[128:131], v[216:219]
    s_waitcnt lgkmcnt(8)
    ds_read_b64_tr_b16 a[176:177], v34 offset:16384
    v_mfma_f32_16x16x32_bf16 v[216:219], a[188:191], a[136:139], v[216:219]
    ds_read_b64_tr_b16 a[178:179], v34 offset:20480
    v_mfma_f32_16x16x32_bf16 v[220:223], a[184:187], a[132:135], v[220:223]
    ds_read_b64_tr_b16 a[180:181], v34 offset:24576
    v_mfma_f32_16x16x32_bf16 v[220:223], a[188:191], a[140:143], v[220:223]
    s_waitcnt lgkmcnt(9)
    ds_read_b64_tr_b16 a[182:183], v34 offset:28672
    v_mfma_f32_16x16x32_bf16 v[224:227], a[160:163], a[128:131], v[224:227]
    s_waitcnt lgkmcnt(8)
    ds_read_b64_tr_b16 a[184:185], v35 offset:16384
    v_mfma_f32_16x16x32_bf16 v[224:227], a[164:167], a[136:139], v[224:227]
    ds_read_b64_tr_b16 a[186:187], v35 offset:20480
    v_mfma_f32_16x16x32_bf16 v[228:231], a[160:163], a[132:135], v[228:231]
    ds_read_b64_tr_b16 a[188:189], v35 offset:24576
    v_mfma_f32_16x16x32_bf16 v[228:231], a[164:167], a[140:143], v[228:231]
    s_waitcnt lgkmcnt(9)
    ds_read_b64_tr_b16 a[190:191], v35 offset:28672
    v_mfma_f32_16x16x32_bf16 v[232:235], a[168:171], a[128:131], v[232:235]
    s_waitcnt lgkmcnt(8)
    v_mfma_f32_16x16x32_bf16 v[232:235], a[172:175], a[136:139], v[232:235]
    v_mfma_f32_16x16x32_bf16 v[236:239], a[168:171], a[132:135], v[236:239]
    v_mfma_f32_16x16x32_bf16 v[236:239], a[172:175], a[140:143], v[236:239]
    s_waitcnt lgkmcnt(6)
    s_waitcnt vmcnt(18)
    s_barrier
    v_mfma_f32_16x16x32_bf16 v[240:243], a[176:179], a[128:131], v[240:243]
    s_waitcnt lgkmcnt(4)
    ds_read_b128 a[208:211], v8 offset:0
    v_mfma_f32_16x16x32_bf16 v[240:243], a[180:183], a[136:139], v[240:243]
    ds_read_b128 a[212:215], v9 offset:0
    v_mfma_f32_16x16x32_bf16 v[244:247], a[176:179], a[132:135], v[244:247]
    ds_read_b128 a[216:219], v10 offset:0
    v_mfma_f32_16x16x32_bf16 v[244:247], a[180:183], a[140:143], v[244:247]
    s_waitcnt lgkmcnt(5)
    ds_read_b128 a[220:223], v11 offset:0
    v_mfma_f32_16x16x32_bf16 v[248:251], a[184:187], a[128:131], v[248:251]
    s_waitcnt lgkmcnt(4)
    ds_read_b128 a[224:227], v8 offset:4096
    v_mfma_f32_16x16x32_bf16 v[248:251], a[188:191], a[136:139], v[248:251]
    v_mfma_f32_16x16x32_bf16 v[252:255], a[184:187], a[132:135], v[252:255]
    s_load_dwordx2 s[16:17], s[0:1], 88
    v_mfma_f32_16x16x32_bf16 v[252:255], a[188:191], a[140:143], v[252:255]
    s_mov_b32 s36, 1040356334
    s_mov_b32 s37, 1040356334
    v_pk_mul_f32 v[128:129], v[128:129], s[36:37]
    v_pk_mul_f32 v[130:131], v[130:131], s[36:37]
    v_pk_mul_f32 v[136:137], v[136:137], s[36:37]
    v_pk_mul_f32 v[138:139], v[138:139], s[36:37]
    v_cvt_pk_bf16_f32 v64, v128, v129
    v_cvt_pk_bf16_f32 v65, v130, v131
    v_cvt_pk_bf16_f32 v66, v136, v137
    v_cvt_pk_bf16_f32 v67, v138, v139
    v_pk_mul_f32 v[132:133], v[132:133], s[36:37]
    v_pk_mul_f32 v[134:135], v[134:135], s[36:37]
    v_pk_mul_f32 v[140:141], v[140:141], s[36:37]
    v_pk_mul_f32 v[142:143], v[142:143], s[36:37]
    v_cvt_pk_bf16_f32 v80, v132, v133
    v_cvt_pk_bf16_f32 v81, v134, v135
    v_cvt_pk_bf16_f32 v82, v140, v141
    v_cvt_pk_bf16_f32 v83, v142, v143
    v_permlane32_swap_b32 v64, v66
    v_permlane32_swap_b32 v65, v67
    v_permlane32_swap_b32 v80, v82
    v_permlane32_swap_b32 v81, v83
    v_permlane16_swap_b32 v64, v66
    v_permlane16_swap_b32 v65, v67
    v_permlane16_swap_b32 v80, v82
    v_permlane16_swap_b32 v81, v83
    v_pk_mul_f32 v[144:145], v[144:145], s[36:37]
    v_pk_mul_f32 v[146:147], v[146:147], s[36:37]
    v_pk_mul_f32 v[152:153], v[152:153], s[36:37]
    v_pk_mul_f32 v[154:155], v[154:155], s[36:37]
    v_cvt_pk_bf16_f32 v68, v144, v145
    v_cvt_pk_bf16_f32 v69, v146, v147
    v_cvt_pk_bf16_f32 v70, v152, v153
    v_cvt_pk_bf16_f32 v71, v154, v155
    v_pk_mul_f32 v[148:149], v[148:149], s[36:37]
    v_pk_mul_f32 v[150:151], v[150:151], s[36:37]
    v_pk_mul_f32 v[156:157], v[156:157], s[36:37]
    v_pk_mul_f32 v[158:159], v[158:159], s[36:37]
    v_cvt_pk_bf16_f32 v84, v148, v149
    v_cvt_pk_bf16_f32 v85, v150, v151
    v_cvt_pk_bf16_f32 v86, v156, v157
    v_cvt_pk_bf16_f32 v87, v158, v159
    v_permlane32_swap_b32 v68, v70
    v_permlane32_swap_b32 v69, v71
    v_permlane32_swap_b32 v84, v86
    v_permlane32_swap_b32 v85, v87
    v_permlane16_swap_b32 v68, v70
    v_permlane16_swap_b32 v69, v71
    v_permlane16_swap_b32 v84, v86
    v_permlane16_swap_b32 v85, v87
    v_pk_mul_f32 v[160:161], v[160:161], s[36:37]
    v_pk_mul_f32 v[162:163], v[162:163], s[36:37]
    v_pk_mul_f32 v[168:169], v[168:169], s[36:37]
    v_pk_mul_f32 v[170:171], v[170:171], s[36:37]
    v_cvt_pk_bf16_f32 v72, v160, v161
    v_cvt_pk_bf16_f32 v73, v162, v163
    v_cvt_pk_bf16_f32 v74, v168, v169
    v_cvt_pk_bf16_f32 v75, v170, v171
    v_pk_mul_f32 v[164:165], v[164:165], s[36:37]
    v_pk_mul_f32 v[166:167], v[166:167], s[36:37]
    v_pk_mul_f32 v[172:173], v[172:173], s[36:37]
    v_pk_mul_f32 v[174:175], v[174:175], s[36:37]
    v_cvt_pk_bf16_f32 v88, v164, v165
    v_cvt_pk_bf16_f32 v89, v166, v167
    v_cvt_pk_bf16_f32 v90, v172, v173
    v_cvt_pk_bf16_f32 v91, v174, v175
    v_permlane32_swap_b32 v72, v74
    v_permlane32_swap_b32 v73, v75
    v_permlane32_swap_b32 v88, v90
    v_permlane32_swap_b32 v89, v91
    v_permlane16_swap_b32 v72, v74
    v_permlane16_swap_b32 v73, v75
    v_permlane16_swap_b32 v88, v90
    v_permlane16_swap_b32 v89, v91
    v_pk_mul_f32 v[176:177], v[176:177], s[36:37]
    v_pk_mul_f32 v[178:179], v[178:179], s[36:37]
    v_pk_mul_f32 v[184:185], v[184:185], s[36:37]
    v_pk_mul_f32 v[186:187], v[186:187], s[36:37]
    v_cvt_pk_bf16_f32 v76, v176, v177
    v_cvt_pk_bf16_f32 v77, v178, v179
    v_cvt_pk_bf16_f32 v78, v184, v185
    v_cvt_pk_bf16_f32 v79, v186, v187
    v_pk_mul_f32 v[180:181], v[180:181], s[36:37]
    v_pk_mul_f32 v[182:183], v[182:183], s[36:37]
    v_pk_mul_f32 v[188:189], v[188:189], s[36:37]
    v_pk_mul_f32 v[190:191], v[190:191], s[36:37]
    v_cvt_pk_bf16_f32 v92, v180, v181
    v_cvt_pk_bf16_f32 v93, v182, v183
    v_cvt_pk_bf16_f32 v94, v188, v189
    v_cvt_pk_bf16_f32 v95, v190, v191
    v_permlane32_swap_b32 v76, v78
    v_permlane32_swap_b32 v77, v79
    v_permlane32_swap_b32 v92, v94
    v_permlane32_swap_b32 v93, v95
    v_permlane16_swap_b32 v76, v78
    v_permlane16_swap_b32 v77, v79
    v_permlane16_swap_b32 v92, v94
    v_permlane16_swap_b32 v93, v95
    v_pk_mul_f32 v[192:193], v[192:193], s[36:37]
    v_pk_mul_f32 v[194:195], v[194:195], s[36:37]
    v_pk_mul_f32 v[200:201], v[200:201], s[36:37]
    v_pk_mul_f32 v[202:203], v[202:203], s[36:37]
    v_cvt_pk_bf16_f32 v96, v192, v193
    v_cvt_pk_bf16_f32 v97, v194, v195
    v_cvt_pk_bf16_f32 v98, v200, v201
    v_cvt_pk_bf16_f32 v99, v202, v203
    v_pk_mul_f32 v[196:197], v[196:197], s[36:37]
    v_pk_mul_f32 v[198:199], v[198:199], s[36:37]
    v_pk_mul_f32 v[204:205], v[204:205], s[36:37]
    v_pk_mul_f32 v[206:207], v[206:207], s[36:37]
    v_cvt_pk_bf16_f32 v112, v196, v197
    v_cvt_pk_bf16_f32 v113, v198, v199
    v_cvt_pk_bf16_f32 v114, v204, v205
    v_cvt_pk_bf16_f32 v115, v206, v207
    v_permlane32_swap_b32 v96, v98
    v_permlane32_swap_b32 v97, v99
    v_permlane32_swap_b32 v112, v114
    v_permlane32_swap_b32 v113, v115
    v_permlane16_swap_b32 v96, v98
    v_permlane16_swap_b32 v97, v99
    v_permlane16_swap_b32 v112, v114
    v_permlane16_swap_b32 v113, v115
    v_pk_mul_f32 v[208:209], v[208:209], s[36:37]
    v_pk_mul_f32 v[210:211], v[210:211], s[36:37]
    v_pk_mul_f32 v[216:217], v[216:217], s[36:37]
    v_pk_mul_f32 v[218:219], v[218:219], s[36:37]
    v_cvt_pk_bf16_f32 v100, v208, v209
    v_cvt_pk_bf16_f32 v101, v210, v211
    v_cvt_pk_bf16_f32 v102, v216, v217
    v_cvt_pk_bf16_f32 v103, v218, v219
    v_pk_mul_f32 v[212:213], v[212:213], s[36:37]
    v_pk_mul_f32 v[214:215], v[214:215], s[36:37]
    v_pk_mul_f32 v[220:221], v[220:221], s[36:37]
    v_pk_mul_f32 v[222:223], v[222:223], s[36:37]
    v_cvt_pk_bf16_f32 v116, v212, v213
    v_cvt_pk_bf16_f32 v117, v214, v215
    v_cvt_pk_bf16_f32 v118, v220, v221
    v_cvt_pk_bf16_f32 v119, v222, v223
    v_permlane32_swap_b32 v100, v102
    v_permlane32_swap_b32 v101, v103
    v_permlane32_swap_b32 v116, v118
    v_permlane32_swap_b32 v117, v119
    v_permlane16_swap_b32 v100, v102
    v_permlane16_swap_b32 v101, v103
    v_permlane16_swap_b32 v116, v118
    v_permlane16_swap_b32 v117, v119
    v_pk_mul_f32 v[224:225], v[224:225], s[36:37]
    v_pk_mul_f32 v[226:227], v[226:227], s[36:37]
    v_pk_mul_f32 v[232:233], v[232:233], s[36:37]
    v_pk_mul_f32 v[234:235], v[234:235], s[36:37]
    v_cvt_pk_bf16_f32 v104, v224, v225
    v_cvt_pk_bf16_f32 v105, v226, v227
    v_cvt_pk_bf16_f32 v106, v232, v233
    v_cvt_pk_bf16_f32 v107, v234, v235
    v_pk_mul_f32 v[228:229], v[228:229], s[36:37]
    v_pk_mul_f32 v[230:231], v[230:231], s[36:37]
    v_pk_mul_f32 v[236:237], v[236:237], s[36:37]
    v_pk_mul_f32 v[238:239], v[238:239], s[36:37]
    v_cvt_pk_bf16_f32 v120, v228, v229
    v_cvt_pk_bf16_f32 v121, v230, v231
    v_cvt_pk_bf16_f32 v122, v236, v237
    v_cvt_pk_bf16_f32 v123, v238, v239
    v_permlane32_swap_b32 v104, v106
    v_permlane32_swap_b32 v105, v107
    v_permlane32_swap_b32 v120, v122
    v_permlane32_swap_b32 v121, v123
    v_permlane16_swap_b32 v104, v106
    v_permlane16_swap_b32 v105, v107
    v_permlane16_swap_b32 v120, v122
    v_permlane16_swap_b32 v121, v123
    v_pk_mul_f32 v[240:241], v[240:241], s[36:37]
    v_pk_mul_f32 v[242:243], v[242:243], s[36:37]
    v_pk_mul_f32 v[248:249], v[248:249], s[36:37]
    v_pk_mul_f32 v[250:251], v[250:251], s[36:37]
    v_cvt_pk_bf16_f32 v108, v240, v241
    v_cvt_pk_bf16_f32 v109, v242, v243
    v_cvt_pk_bf16_f32 v110, v248, v249
    v_cvt_pk_bf16_f32 v111, v250, v251
    v_pk_mul_f32 v[244:245], v[244:245], s[36:37]
    v_pk_mul_f32 v[246:247], v[246:247], s[36:37]
    v_pk_mul_f32 v[252:253], v[252:253], s[36:37]
    v_pk_mul_f32 v[254:255], v[254:255], s[36:37]
    v_cvt_pk_bf16_f32 v124, v244, v245
    v_cvt_pk_bf16_f32 v125, v246, v247
    v_cvt_pk_bf16_f32 v126, v252, v253
    v_cvt_pk_bf16_f32 v127, v254, v255
    v_permlane32_swap_b32 v108, v110
    v_permlane32_swap_b32 v109, v111
    v_permlane32_swap_b32 v124, v126
    v_permlane32_swap_b32 v125, v127
    v_permlane16_swap_b32 v108, v110
    v_permlane16_swap_b32 v109, v111
    v_permlane16_swap_b32 v124, v126
    v_permlane16_swap_b32 v125, v127
    s_waitcnt lgkmcnt(0)
    v_mfma_f32_16x16x32_bf16 v[216:219], a[208:211], v[64:67], 0
    v_mfma_f32_16x16x32_bf16 v[216:219], a[212:215], v[68:71], v[216:219]
    v_mfma_f32_16x16x32_bf16 v[216:219], a[216:219], v[72:75], v[216:219]
    v_mfma_f32_16x16x32_bf16 v[216:219], a[220:223], v[76:79], v[216:219]
    v_mfma_f32_16x16x32_bf16 v[220:223], a[208:211], v[80:83], 0
    v_mfma_f32_16x16x32_bf16 v[220:223], a[212:215], v[84:87], v[220:223]
    v_mfma_f32_16x16x32_bf16 v[220:223], a[216:219], v[88:91], v[220:223]
    v_mfma_f32_16x16x32_bf16 v[220:223], a[220:223], v[92:95], v[220:223]
    v_mfma_f32_16x16x32_bf16 v[224:227], a[208:211], v[96:99], 0
    v_mfma_f32_16x16x32_bf16 v[224:227], a[212:215], v[100:103], v[224:227]
    v_mfma_f32_16x16x32_bf16 v[224:227], a[216:219], v[104:107], v[224:227]
    v_mfma_f32_16x16x32_bf16 v[224:227], a[220:223], v[108:111], v[224:227]
    v_mfma_f32_16x16x32_bf16 v[228:231], a[208:211], v[112:115], 0
    v_mfma_f32_16x16x32_bf16 v[228:231], a[212:215], v[116:119], v[228:231]
    v_mfma_f32_16x16x32_bf16 v[228:231], a[216:219], v[120:123], v[228:231]
    v_mfma_f32_16x16x32_bf16 v[228:231], a[220:223], v[124:127], v[228:231]
    v_max3_f32 v232, v216, v217, v218
    v_max_f32 v232, v232, v219
    v_max3_f32 v233, v220, v221, v222
    v_max_f32 v233, v233, v223
    v_max3_f32 v234, v224, v225, v226
    v_max_f32 v234, v234, v227
    s_nop 1
    v_max3_f32 v235, v228, v229, v230
    v_max_f32 v235, v235, v231
    v_mov_b32 v236, v232
    v_mov_b32 v237, v233
    v_mov_b32 v238, v234
    v_mov_b32 v239, v235
    v_permlane16_swap_b32 v232, v236
    v_permlane16_swap_b32 v233, v237
    v_permlane16_swap_b32 v234, v238
    v_permlane16_swap_b32 v235, v239
    v_max_f32 v232, v232, v236
    v_max_f32 v233, v233, v237
    v_max_f32 v234, v234, v238
    v_max_f32 v235, v235, v239
    v_mov_b32 v236, v232
    v_mov_b32 v237, v233
    v_mov_b32 v238, v234
    v_mov_b32 v239, v235
    v_permlane32_swap_b32 v232, v236
    v_permlane32_swap_b32 v233, v237
    v_permlane32_swap_b32 v234, v238
    v_permlane32_swap_b32 v235, v239
    v_max_f32 v232, v232, v236
    v_max_f32 v233, v233, v237
    v_max_f32 v234, v234, v238
    v_max_f32 v235, v235, v239
    v_sub_f32 v192, 3250585600, v232
    v_sub_f32 v193, 3250585600, v232
    v_sub_f32 v194, 3250585600, v232
    v_sub_f32 v195, 3250585600, v232
    v_sub_f32 v196, 3250585600, v233
    v_sub_f32 v197, 3250585600, v233
    v_sub_f32 v198, 3250585600, v233
    v_sub_f32 v199, 3250585600, v233
    v_sub_f32 v200, 3250585600, v234
    v_sub_f32 v201, 3250585600, v234
    v_sub_f32 v202, 3250585600, v234
    v_sub_f32 v203, 3250585600, v234
    v_sub_f32 v204, 3250585600, v235
    v_sub_f32 v205, 3250585600, v235
    v_sub_f32 v206, 3250585600, v235
    v_sub_f32 v207, 3250585600, v235
Lattn_stage0:
    s_mov_b32 s43, 7
    v_mfma_f32_16x16x32_bf16 v[208:211], a[208:211], v[64:67], v[192:195]
    s_lshl_b32 s53, s5, 4
    v_mfma_f32_16x16x32_bf16 v[208:211], a[212:215], v[68:71], v[208:211]
    s_add_u32 s53, s53, s4
    v_mfma_f32_16x16x32_bf16 v[208:211], a[216:219], v[72:75], v[208:211]
    s_lshl_b32 s53, s53, 2
    v_mfma_f32_16x16x32_bf16 v[208:211], a[220:223], v[76:79], v[208:211]
    s_add_u32 s53, s53, s3
    ds_read_b128 a[228:231], v9 offset:4096
    v_mfma_f32_16x16x32_bf16 v[212:215], a[208:211], v[80:83], v[196:199]
    s_mul_i32 s53, s53, 4608
    s_nop 3
    v_exp_f32 v208, v208
    v_mfma_f32_16x16x32_bf16 v[212:215], a[212:215], v[84:87], v[212:215]
    s_add_u32 s53, s53, 2621440
    v_exp_f32 v209, v209
    v_mfma_f32_16x16x32_bf16 v[212:215], a[216:219], v[88:91], v[212:215]
    s_lshr_b32 s44, s2, 5
    v_exp_f32 v210, v210
    v_mfma_f32_16x16x32_bf16 v[212:215], a[220:223], v[92:95], v[212:215]
    s_lshl_b32 s44, s44, 3
    v_exp_f32 v211, v211
    v_cvt_pk_bf16_f32 v128, v208, v209
    ds_read_b128 a[232:235], v10 offset:4096
    v_cvt_pk_bf16_f32 v129, v210, v211
    v_mfma_f32_16x16x32_bf16 v[208:211], a[208:211], v[96:99], v[200:203]
    s_and_b32 s37, s2, 7
    s_nop 0
    v_exp_f32 v212, v212
    v_mfma_f32_16x16x32_bf16 v[208:211], a[212:215], v[100:103], v[208:211]
    s_add_u32 s44, s44, s37
    v_exp_f32 v213, v213
    v_mfma_f32_16x16x32_bf16 v[208:211], a[216:219], v[104:107], v[208:211]
    s_lshl_b32 s44, s44, 2
    v_exp_f32 v214, v214
    v_mfma_f32_16x16x32_bf16 v[208:211], a[220:223], v[108:111], v[208:211]
    s_bfe_u32 s37, s2, 0x20003
    v_exp_f32 v215, v215
    v_cvt_pk_bf16_f32 v136, v212, v213
Ltour3:
    s_cbranch_execz Ltour7
    ds_read_b128 a[236:239], v11 offset:4096
    v_cvt_pk_bf16_f32 v137, v214, v215
    v_mfma_f32_16x16x32_bf16 v[212:215], a[208:211], v[112:115], v[204:207]
    s_add_u32 s44, s44, s37
    s_nop 0
    v_exp_f32 v208, v208
    v_mfma_f32_16x16x32_bf16 v[212:215], a[212:215], v[116:119], v[212:215]
    s_add_u32 s44, s44, 72
    v_exp_f32 v209, v209
    v_mfma_f32_16x16x32_bf16 v[212:215], a[216:219], v[120:123], v[212:215]
    s_cmp_lt_u32 s44, 216
    s_cselect_b32 s37, 0, 2147483648
    v_exp_f32 v210, v210
    v_mfma_f32_16x16x32_bf16 v[212:215], a[220:223], v[124:127], v[212:215]
    s_lshl_b32 s44, s44, 5
    v_exp_f32 v211, v211
    v_cvt_pk_bf16_f32 v144, v208, v209
    ds_read_b128 a[208:211], v8 offset:8192
    v_cvt_pk_bf16_f32 v145, v210, v211
    v_mfma_f32_16x16x32_bf16 v[208:211], a[224:227], v[64:67], v[192:195]
    s_waitcnt lgkmcnt(3)
    s_or_b32 s44, s44, s37
    v_exp_f32 v212, v212
    v_mfma_f32_16x16x32_bf16 v[208:211], a[228:231], v[68:71], v[208:211]
    s_waitcnt lgkmcnt(2)
    s_mov_b32 s18, 3981312
    v_exp_f32 v213, v213
    v_mfma_f32_16x16x32_bf16 v[208:211], a[232:235], v[72:75], v[208:211]
    s_waitcnt lgkmcnt(1)
    s_lshr_b32 s6, s2, 3
    v_exp_f32 v214, v214
    v_mfma_f32_16x16x32_bf16 v[208:211], a[236:239], v[76:79], v[208:211]
    s_and_b32 s7, s2, 7
    v_exp_f32 v215, v215
    v_cvt_pk_bf16_f32 v152, v212, v213
    ds_read_b128 a[212:215], v9 offset:8192
    v_cvt_pk_bf16_f32 v153, v214, v215
    v_mfma_f32_16x16x32_bf16 v[212:215], a[224:227], v[80:83], v[196:199]
    s_mul_i32 s7, s7, 18
    s_nop 0
    v_exp_f32 v208, v208
    v_mfma_f32_16x16x32_bf16 v[212:215], a[228:231], v[84:87], v[212:215]
    s_add_u32 s7, s7, s6
    v_exp_f32 v209, v209
    v_mfma_f32_16x16x32_bf16 v[212:215], a[232:235], v[88:91], v[212:215]
    s_lshl_b32 s58, s7, 6
    v_exp_f32 v210, v210
    v_mfma_f32_16x16x32_bf16 v[212:215], a[236:239], v[92:95], v[212:215]
    s_mul_i32 s59, s7, 36864
    v_exp_f32 v211, v211
    v_cvt_pk_bf16_f32 v130, v208, v209
    ds_read_b128 a[216:219], v10 offset:8192
    v_cvt_pk_bf16_f32 v131, v210, v211
    v_mfma_f32_16x16x32_bf16 v[208:211], a[224:227], v[96:99], v[200:203]
    s_cmp_lt_u32 s6, 18
    s_cselect_b32 s7, 0, 2147483648
    v_exp_f32 v212, v212
    v_mfma_f32_16x16x32_bf16 v[208:211], a[228:231], v[100:103], v[208:211]
    s_or_b32 s58, s58, s7
    v_exp_f32 v213, v213
    v_mfma_f32_16x16x32_bf16 v[208:211], a[232:235], v[104:107], v[208:211]
    s_or_b32 s59, s59, s7
    v_exp_f32 v214, v214
    v_mfma_f32_16x16x32_bf16 v[208:211], a[236:239], v[108:111], v[208:211]
    s_and_b32 s7, s4, 1
    v_exp_f32 v215, v215
    v_cvt_pk_bf16_f32 v138, v212, v213
    ds_read_b128 a[220:223], v11 offset:8192
    v_cvt_pk_bf16_f32 v139, v214, v215
    s_mov_b32 s39, 221184
    s_mov_b32 s38, 27648
    v_mfma_f32_16x16x32_bf16 v[212:215], a[224:227], v[112:115], v[204:207]
    s_lshl_b32 s6, s7, 7
    v_exp_f32 v208, v208
    v_mfma_f32_16x16x32_bf16 v[212:215], a[228:231], v[116:119], v[212:215]
    s_xor_b32 s36, s4, 1
    v_exp_f32 v209, v209
    v_mfma_f32_16x16x32_bf16 v[212:215], a[232:235], v[120:123], v[212:215]
    s_mul_i32 s36, s36, 294912
    v_exp_f32 v210, v210
    v_mfma_f32_16x16x32_bf16 v[212:215], a[236:239], v[124:127], v[212:215]
    s_waitcnt lgkmcnt(3)
    s_add_u32 s46, s36, s6
    v_exp_f32 v211, v211
    v_cvt_pk_bf16_f32 v146, v208, v209
    ds_read_b128 a[224:227], v8 offset:12288
    v_cvt_pk_bf16_f32 v147, v210, v211
    v_mfma_f32_16x16x32_bf16 v[208:211], a[208:211], v[64:67], v[192:195]
    s_waitcnt lgkmcnt(3)
    s_lshl_b32 s36, s4, 8
    v_exp_f32 v212, v212
    v_mfma_f32_16x16x32_bf16 v[208:211], a[212:215], v[68:71], v[208:211]
    s_waitcnt lgkmcnt(2)
    s_add_u32 s56, s47, s36
    v_exp_f32 v213, v213
    v_mfma_f32_16x16x32_bf16 v[208:211], a[216:219], v[72:75], v[208:211]
    s_waitcnt lgkmcnt(1)
    s_lshr_b32 s36, s4, 1
    v_exp_f32 v214, v214
    v_mfma_f32_16x16x32_bf16 v[208:211], a[220:223], v[76:79], v[208:211]
    s_lshl_b32 s36, s36, 11
    v_exp_f32 v215, v215
    v_cvt_pk_bf16_f32 v154, v212, v213
    ds_read_b128 a[228:231], v9 offset:12288
    v_cvt_pk_bf16_f32 v155, v214, v215
    v_mfma_f32_16x16x32_bf16 v[212:215], a[208:211], v[80:83], v[196:199]
    s_lshl_b32 s7, s7, 8
    s_nop 0
    v_exp_f32 v208, v208
    v_mfma_f32_16x16x32_bf16 v[212:215], a[212:215], v[84:87], v[212:215]
    s_add_u32 s36, s36, s7
    v_exp_f32 v209, v209
    v_mfma_f32_16x16x32_bf16 v[212:215], a[216:219], v[88:91], v[212:215]
    s_add_u32 s93, s47, s36
    v_exp_f32 v210, v210
    v_mfma_f32_16x16x32_bf16 v[212:215], a[220:223], v[92:95], v[212:215]
    s_lshr_b32 s36, s4, 1
    v_exp_f32 v211, v211
    v_cvt_pk_bf16_f32 v132, v208, v209
    ds_read_b128 a[232:235], v10 offset:12288
    v_cvt_pk_bf16_f32 v133, v210, v211
    v_mfma_f32_16x16x32_bf16 v[208:211], a[208:211], v[96:99], v[200:203]
    s_lshl_b32 s36, s36, 4
    s_nop 0
    v_exp_f32 v212, v212
    v_mfma_f32_16x16x32_bf16 v[208:211], a[212:215], v[100:103], v[208:211]
    s_add_u32 s36, s36, s5
    v_exp_f32 v213, v213
    v_mfma_f32_16x16x32_bf16 v[208:211], a[216:219], v[104:107], v[208:211]
    s_lshl_b32 s36, s36, 9
    v_exp_f32 v214, v214
    v_mfma_f32_16x16x32_bf16 v[208:211], a[220:223], v[108:111], v[208:211]
    s_add_u32 s36, s36, s7
    v_exp_f32 v215, v215
    v_cvt_pk_bf16_f32 v140, v212, v213
    ds_read_b128 a[236:239], v11 offset:12288
    v_cvt_pk_bf16_f32 v141, v214, v215
    s_waitcnt vmcnt(4)
    s_barrier
    v_mfma_f32_16x16x32_bf16 v[212:215], a[208:211], v[112:115], v[204:207]
    s_lshl_b32 s36, s36, 8
    v_exp_f32 v208, v208
    v_mfma_f32_16x16x32_bf16 v[212:215], a[212:215], v[116:119], v[212:215]
    s_add_u32 m0, s42, 49152
    s_add_u32 s55, s36, 20971520
    v_exp_f32 v209, v209
    v_mfma_f32_16x16x32_bf16 v[212:215], a[216:219], v[120:123], v[212:215]
    s_add_u32 s7, s45, s6
    v_exp_f32 v210, v210
    v_mfma_f32_16x16x32_bf16 v[212:215], a[220:223], v[124:127], v[212:215]
    s_waitcnt lgkmcnt(3)
    s_xor_b32 s54, s92, 128
    v_exp_f32 v211, v211
    v_cvt_pk_bf16_f32 v148, v208, v209
    ds_read_b128 a[208:211], v8 offset:16384
    v_cvt_pk_bf16_f32 v149, v210, v211
    buffer_load_dwordx4 v36, s[8:11], s40 offen lds
    v_mfma_f32_16x16x32_bf16 v[208:211], a[224:227], v[64:67], v[192:195]
    s_waitcnt lgkmcnt(3)
    s_lshl_b32 s36, s3, 14
    v_exp_f32 v212, v212
    v_mfma_f32_16x16x32_bf16 v[208:211], a[228:231], v[68:71], v[208:211]
    s_waitcnt lgkmcnt(2)
    v_exp_f32 v213, v213
    v_mfma_f32_16x16x32_bf16 v[208:211], a[232:235], v[72:75], v[208:211]
    s_waitcnt lgkmcnt(1)
    v_exp_f32 v214, v214
    v_mfma_f32_16x16x32_bf16 v[208:211], a[236:239], v[76:79], v[208:211]
    v_exp_f32 v215, v215
    v_cvt_pk_bf16_f32 v156, v212, v213
    ds_read_b128 a[212:215], v9 offset:16384
    v_cvt_pk_bf16_f32 v157, v214, v215
    v_mfma_f32_16x16x32_bf16 v[212:215], a[224:227], v[80:83], v[196:199]
    s_nop 2
    v_exp_f32 v208, v208
    v_mfma_f32_16x16x32_bf16 v[212:215], a[228:231], v[84:87], v[212:215]
    v_exp_f32 v209, v209
    v_mfma_f32_16x16x32_bf16 v[212:215], a[232:235], v[88:91], v[212:215]
    v_exp_f32 v210, v210
    v_mfma_f32_16x16x32_bf16 v[212:215], a[236:239], v[92:95], v[212:215]
    v_exp_f32 v211, v211
    ds_read_b64_tr_b16 a[160:161], v20 offset:0
    v_cvt_pk_bf16_f32 v134, v208, v209
    v_lshrrev_b32 v51, 2, v0
    v_mul_u32_u24 v51, 9216, v51
    v_and_b32 v254, 3, v0
    v_lshl_add_u32 v254, v254, 4, v51
    v_lshlrev_b32 v255, 4, v0
    v_add_u32 v51, 98304, v255
    v_lshl_add_u32 v252, v1, 4, s36
    v_mov_b32 v224, 0
    v_mov_b32 v225, 0
    v_mov_b32 v226, 0
    v_mov_b32 v227, 0
    v_mov_b32 v228, 0
    v_mov_b32 v229, 0
    v_mov_b32 v230, 0
    v_mov_b32 v231, 0
    v_mov_b32 v248, -1
    v_mov_b32 v249, -1
    v_mov_b32 v250, -1
    v_mov_b32 v251, -1
    v_min_u32 v232, 41, v1
    v_lshlrev_b32 v232, 4, v232
    s_mov_b32 s57, s58
    s_lshl_b32 s6, s3, 10
    s_add_u32 s6, s6, 135168
    s_lshr_b32 s37, s2, 3
    s_mul_i32 s37, s37, -129024
    s_add_u32 s37, s37, 4128768
    ds_read_b64_tr_b16 a[162:163], v20 offset:4096
    ds_read_b128 a[216:219], v10 offset:16384
    v_cvt_pk_bf16_f32 v135, v210, v211
    buffer_load_dwordx4 v37, s[8:11], s40 offen offset:1024 lds
    v_mfma_f32_16x16x32_bf16 v[208:211], a[224:227], v[96:99], v[200:203]
    v_exp_f32 v212, v212
    v_mfma_f32_16x16x32_bf16 v[208:211], a[228:231], v[100:103], v[208:211]
    v_exp_f32 v213, v213
    v_mfma_f32_16x16x32_bf16 v[208:211], a[232:235], v[104:107], v[208:211]
    v_exp_f32 v214, v214
    v_mfma_f32_16x16x32_bf16 v[208:211], a[236:239], v[108:111], v[208:211]
    s_mov_b32 s52, s55
    v_exp_f32 v215, v215
    ds_read_b64_tr_b16 a[164:165], v20 offset:8192
    v_cvt_pk_bf16_f32 v142, v212, v213
    ds_read_b64_tr_b16 a[166:167], v20 offset:12288
    v_min_u32 v237, 19, v1
    v_lshl_add_u32 v237, v237, 7, s36
    v_lshl_add_u32 v238, v1, 7, s36
    ds_read_b128 a[220:223], v11 offset:16384
    v_cvt_pk_bf16_f32 v143, v214, v215
    buffer_load_dword v217, v57, s[32:35], s37 offen
    v_mfma_f32_16x16x32_bf16 v[212:215], a[224:227], v[112:115], v[204:207]
    v_exp_f32 v208, v208
    v_mfma_f32_16x16x32_bf16 v[212:215], a[228:231], v[116:119], v[212:215]
    v_exp_f32 v209, v209
    v_mfma_f32_16x16x32_bf16 v[212:215], a[232:235], v[120:123], v[212:215]
    s_mul_i32 s37, s5, 18432
    v_exp_f32 v210, v210
    v_mfma_f32_16x16x32_bf16 v[212:215], a[236:239], v[124:127], v[212:215]
    s_add_u32 s37, s37, s45
    v_exp_f32 v211, v211
    ds_read_b64_tr_b16 a[168:169], v21 offset:0
    v_cvt_pk_bf16_f32 v150, v208, v209
    ds_read_b64_tr_b16 a[170:171], v21 offset:4096
    v_min_u32 v236, 143, v0
    v_lshl_add_u32 v236, v236, 7, s37
    v_mul_u32_u24 v235, 24, v0
    v_lshrrev_b32 v235, 8, v235
    v_lshl_add_u32 v235, v235, 7, s37
    ds_read_b128 a[224:227], v8 offset:20480
    v_cvt_pk_bf16_f32 v151, v210, v211
    s_waitcnt lgkmcnt(3)
    buffer_load_dwordx4 v38, s[8:11], s40 offen offset:2048 lds
Lattn_loop:
    v_mfma_f32_16x16x32_bf16 v[208:211], a[208:211], v[64:67], v[192:195]
    v_exp_f32 v212, v212
    v_mfma_f32_16x16x32_bf16 v[208:211], a[212:215], v[68:71], v[208:211]
    v_exp_f32 v213, v213
    v_mfma_f32_16x16x32_bf16 v[208:211], a[216:219], v[72:75], v[208:211]
    v_exp_f32 v214, v214
    v_mfma_f32_16x16x32_bf16 v[208:211], a[220:223], v[76:79], v[208:211]
    v_exp_f32 v215, v215
    v_mfma_f32_16x16x32_bf16 a[0:3], a[160:163], v[128:131], a[0:3]
    ds_read_b64_tr_b16 a[172:173], v21 offset:8192
    v_cvt_pk_bf16_f32 v158, v212, v213
    v_mfma_f32_16x16x32_bf16 a[0:3], a[164:167], v[132:135], a[0:3]
    ds_read_b64_tr_b16 a[174:175], v21 offset:12288
    v_mfma_f32_16x16x32_bf16 a[4:7], a[160:163], v[136:139], a[4:7]
    ds_read_b128 a[228:231], v9 offset:20480
    v_cvt_pk_bf16_f32 v159, v214, v215
    v_mfma_f32_16x16x32_bf16 a[4:7], a[164:167], v[140:143], a[4:7]
    v_mfma_f32_16x16x32_bf16 v[212:215], a[208:211], v[80:83], v[196:199]
    v_exp_f32 v208, v208
    v_mfma_f32_16x16x32_bf16 v[212:215], a[212:215], v[84:87], v[212:215]
    v_exp_f32 v209, v209
    v_mfma_f32_16x16x32_bf16 v[212:215], a[216:219], v[88:91], v[212:215]
    v_exp_f32 v210, v210
    v_mfma_f32_16x16x32_bf16 v[212:215], a[220:223], v[92:95], v[212:215]
    v_exp_f32 v211, v211
    v_mfma_f32_16x16x32_bf16 a[8:11], a[160:163], v[144:147], a[8:11]
    ds_read_b64_tr_b16 a[176:177], v22 offset:0
    v_cvt_pk_bf16_f32 v160, v208, v209
    v_mfma_f32_16x16x32_bf16 a[8:11], a[164:167], v[148:151], a[8:11]
    ds_read_b64_tr_b16 a[178:179], v22 offset:4096
    v_mfma_f32_16x16x32_bf16 a[12:15], a[160:163], v[152:155], a[12:15]
    ds_read_b128 a[232:235], v10 offset:20480
    v_cvt_pk_bf16_f32 v161, v210, v211
    v_mfma_f32_16x16x32_bf16 a[12:15], a[164:167], v[156:159], a[12:15]
    s_waitcnt lgkmcnt(3)
    buffer_load_dwordx4 v39, s[8:11], s40 offen offset:3072 lds
    v_mfma_f32_16x16x32_bf16 v[208:211], a[208:211], v[96:99], v[200:203]
    v_exp_f32 v212, v212
    v_mfma_f32_16x16x32_bf16 v[208:211], a[212:215], v[100:103], v[208:211]
    s_add_u32 s40, s40, 16384
    v_exp_f32 v213, v213
    v_mfma_f32_16x16x32_bf16 v[208:211], a[216:219], v[104:107], v[208:211]
    s_mov_b32 m0, s6
    v_exp_f32 v214, v214
    v_mfma_f32_16x16x32_bf16 v[208:211], a[220:223], v[108:111], v[208:211]
    v_exp_f32 v215, v215
    v_mfma_f32_16x16x32_bf16 a[16:19], a[168:171], v[128:131], a[16:19]
    ds_read_b64_tr_b16 a[180:181], v22 offset:8192
    v_cvt_pk_bf16_f32 v168, v212, v213
    v_mfma_f32_16x16x32_bf16 a[16:19], a[172:175], v[132:135], a[16:19]
    ds_read_b64_tr_b16 a[182:183], v22 offset:12288
    v_mfma_f32_16x16x32_bf16 a[20:23], a[168:171], v[136:139], a[20:23]
    ds_read_b128 a[236:239], v11 offset:20480
    v_cvt_pk_bf16_f32 v169, v214, v215
    v_mfma_f32_16x16x32_bf16 a[20:23], a[172:175], v[140:143], a[20:23]
    buffer_load_dwordx4 v254, s[32:35], s57 offen  lds
    v_smfmac_f32_16x16x64_bf16 a[192:195], v[52:55], v[128:135], v50
    v_mfma_f32_16x16x32_bf16 v[212:215], a[208:211], v[112:115], v[204:207]
    v_exp_f32 v208, v208
    v_mfma_f32_16x16x32_bf16 v[212:215], a[212:215], v[116:119], v[212:215]
    s_add_u32 m0, s42, 98304
    v_exp_f32 v209, v209
    v_mfma_f32_16x16x32_bf16 v[212:215], a[216:219], v[120:123], v[212:215]
    v_exp_f32 v210, v210
    v_mfma_f32_16x16x32_bf16 v[212:215], a[220:223], v[124:127], v[212:215]
    v_exp_f32 v211, v211
    v_mfma_f32_16x16x32_bf16 a[24:27], a[168:171], v[144:147], a[24:27]
    ds_read_b64_tr_b16 a[184:185], v23 offset:0
    v_cvt_pk_bf16_f32 v176, v208, v209
    v_mfma_f32_16x16x32_bf16 a[24:27], a[172:175], v[148:151], a[24:27]
    ds_read_b64_tr_b16 a[186:187], v23 offset:4096
    v_mfma_f32_16x16x32_bf16 a[28:31], a[168:171], v[152:155], a[28:31]
    ds_read_b128 a[208:211], v8 offset:24576
    v_cvt_pk_bf16_f32 v177, v210, v211
    v_mfma_f32_16x16x32_bf16 a[28:31], a[172:175], v[156:159], a[28:31]
    s_waitcnt lgkmcnt(3)
    buffer_load_dwordx4 v40, s[12:15], s41 offen lds
    v_mfma_f32_16x16x32_bf16 v[208:211], a[224:227], v[64:67], v[192:195]
    v_exp_f32 v212, v212
    v_mfma_f32_16x16x32_bf16 v[208:211], a[228:231], v[68:71], v[208:211]
    s_add_u32 s6, s6, 4096
    v_exp_f32 v213, v213
    v_mfma_f32_16x16x32_bf16 v[208:211], a[232:235], v[72:75], v[208:211]
    s_add_u32 s57, s57, 589824
    v_exp_f32 v214, v214
    v_mfma_f32_16x16x32_bf16 v[208:211], a[236:239], v[76:79], v[208:211]
    v_exp_f32 v215, v215
    v_mfma_f32_16x16x32_bf16 a[32:35], a[176:179], v[128:131], a[32:35]
    ds_read_b64_tr_b16 a[188:189], v23 offset:8192
    v_cvt_pk_bf16_f32 v184, v212, v213
    v_mfma_f32_16x16x32_bf16 a[32:35], a[180:183], v[132:135], a[32:35]
    ds_read_b64_tr_b16 a[190:191], v23 offset:12288
    v_mfma_f32_16x16x32_bf16 a[36:39], a[176:179], v[136:139], a[36:39]
    ds_read_b128 a[212:215], v9 offset:24576
    v_cvt_pk_bf16_f32 v185, v214, v215
    v_mfma_f32_16x16x32_bf16 a[36:39], a[180:183], v[140:143], a[36:39]
    v_smfmac_f32_16x16x64_bf16 a[196:199], v[52:55], v[136:143], v50
    v_mfma_f32_16x16x32_bf16 v[212:215], a[224:227], v[80:83], v[196:199]
    v_exp_f32 v208, v208
    v_mfma_f32_16x16x32_bf16 v[212:215], a[228:231], v[84:87], v[212:215]
    v_exp_f32 v209, v209
    v_mfma_f32_16x16x32_bf16 v[212:215], a[232:235], v[88:91], v[212:215]
    v_exp_f32 v210, v210
    v_mfma_f32_16x16x32_bf16 v[212:215], a[236:239], v[92:95], v[212:215]
    v_exp_f32 v211, v211
    v_mfma_f32_16x16x32_bf16 a[40:43], a[176:179], v[144:147], a[40:43]
    ds_read_b64_tr_b16 a[160:161], v24 offset:0
    v_cvt_pk_bf16_f32 v162, v208, v209
    v_mfma_f32_16x16x32_bf16 a[40:43], a[180:183], v[148:151], a[40:43]
    ds_read_b64_tr_b16 a[162:163], v24 offset:4096
    v_mfma_f32_16x16x32_bf16 a[44:47], a[176:179], v[152:155], a[44:47]
    ds_read_b128 a[216:219], v10 offset:24576
    v_cvt_pk_bf16_f32 v163, v210, v211
    v_mfma_f32_16x16x32_bf16 a[44:47], a[180:183], v[156:159], a[44:47]
    s_waitcnt lgkmcnt(3)
    buffer_load_dwordx4 v41, s[12:15], s41 offen offset:1024 lds
    v_mfma_f32_16x16x32_bf16 v[208:211], a[224:227], v[96:99], v[200:203]
    v_exp_f32 v212, v212
    v_mfma_f32_16x16x32_bf16 v[208:211], a[228:231], v[100:103], v[208:211]
    v_exp_f32 v213, v213
    v_mfma_f32_16x16x32_bf16 v[208:211], a[232:235], v[104:107], v[208:211]
    v_exp_f32 v214, v214
    v_mfma_f32_16x16x32_bf16 v[208:211], a[236:239], v[108:111], v[208:211]
    v_exp_f32 v215, v215
    v_mfma_f32_16x16x32_bf16 a[48:51], a[184:187], v[128:131], a[48:51]
    ds_read_b64_tr_b16 a[164:165], v24 offset:8192
    v_cvt_pk_bf16_f32 v170, v212, v213
    v_mfma_f32_16x16x32_bf16 a[48:51], a[188:191], v[132:135], a[48:51]
    ds_read_b64_tr_b16 a[166:167], v24 offset:12288
    v_mfma_f32_16x16x32_bf16 a[52:55], a[184:187], v[136:139], a[52:55]
    ds_read_b128 a[220:223], v11 offset:24576
    v_cvt_pk_bf16_f32 v171, v214, v215
    v_mfma_f32_16x16x32_bf16 a[52:55], a[188:191], v[140:143], a[52:55]
    v_smfmac_f32_16x16x64_bf16 a[200:203], v[52:55], v[144:151], v50
    v_mfma_f32_16x16x32_bf16 v[212:215], a[224:227], v[112:115], v[204:207]
    v_exp_f32 v208, v208
    v_mfma_f32_16x16x32_bf16 v[212:215], a[228:231], v[116:119], v[212:215]
    v_exp_f32 v209, v209
    v_mfma_f32_16x16x32_bf16 v[212:215], a[232:235], v[120:123], v[212:215]
    v_exp_f32 v210, v210
    v_mfma_f32_16x16x32_bf16 v[212:215], a[236:239], v[124:127], v[212:215]
    v_exp_f32 v211, v211
    v_mfma_f32_16x16x32_bf16 a[56:59], a[184:187], v[144:147], a[56:59]
    ds_read_b64_tr_b16 a[168:169], v25 offset:0
    v_cvt_pk_bf16_f32 v178, v208, v209
    v_mfma_f32_16x16x32_bf16 a[56:59], a[188:191], v[148:151], a[56:59]
    ds_read_b64_tr_b16 a[170:171], v25 offset:4096
    v_mfma_f32_16x16x32_bf16 a[60:63], a[184:187], v[152:155], a[60:63]
    ds_read_b128 a[224:227], v8 offset:28672
    v_cvt_pk_bf16_f32 v179, v210, v211
    v_mfma_f32_16x16x32_bf16 a[60:63], a[188:191], v[156:159], a[60:63]
    s_waitcnt lgkmcnt(3)
    buffer_load_dwordx4 v40, s[12:15], s41 offen offset:2048 lds
    v_mfma_f32_16x16x32_bf16 v[208:211], a[208:211], v[64:67], v[192:195]
    v_exp_f32 v212, v212
    v_mfma_f32_16x16x32_bf16 v[208:211], a[212:215], v[68:71], v[208:211]
    v_exp_f32 v213, v213
    v_mfma_f32_16x16x32_bf16 v[208:211], a[216:219], v[72:75], v[208:211]
    v_exp_f32 v214, v214
    v_mfma_f32_16x16x32_bf16 v[208:211], a[220:223], v[76:79], v[208:211]
    v_exp_f32 v215, v215
    v_mfma_f32_16x16x32_bf16 a[64:67], a[160:163], v[128:131], a[64:67]
    ds_read_b64_tr_b16 a[172:173], v25 offset:8192
    v_cvt_pk_bf16_f32 v186, v212, v213
    v_mfma_f32_16x16x32_bf16 a[64:67], a[164:167], v[132:135], a[64:67]
    ds_read_b64_tr_b16 a[174:175], v25 offset:12288
    v_mfma_f32_16x16x32_bf16 a[68:71], a[160:163], v[136:139], a[68:71]
    ds_read_b128 a[228:231], v9 offset:28672
    v_cvt_pk_bf16_f32 v187, v214, v215
    v_mfma_f32_16x16x32_bf16 a[68:71], a[164:167], v[140:143], a[68:71]
    v_smfmac_f32_16x16x64_bf16 a[204:207], v[52:55], v[152:159], v50
    v_mfma_f32_16x16x32_bf16 v[212:215], a[208:211], v[80:83], v[196:199]
    v_exp_f32 v208, v208
    v_mfma_f32_16x16x32_bf16 v[212:215], a[212:215], v[84:87], v[212:215]
    v_exp_f32 v209, v209
    v_mfma_f32_16x16x32_bf16 v[212:215], a[216:219], v[88:91], v[212:215]
    v_exp_f32 v210, v210
    v_mfma_f32_16x16x32_bf16 v[212:215], a[220:223], v[92:95], v[212:215]
    v_exp_f32 v211, v211
    v_mfma_f32_16x16x32_bf16 a[72:75], a[160:163], v[144:147], a[72:75]
    ds_read_b64_tr_b16 a[176:177], v26 offset:0
    v_cvt_pk_bf16_f32 v164, v208, v209
    v_mfma_f32_16x16x32_bf16 a[72:75], a[164:167], v[148:151], a[72:75]
    ds_read_b64_tr_b16 a[178:179], v26 offset:4096
    v_mfma_f32_16x16x32_bf16 a[76:79], a[160:163], v[152:155], a[76:79]
    ds_read_b128 a[232:235], v10 offset:28672
    v_cvt_pk_bf16_f32 v165, v210, v211
    v_mfma_f32_16x16x32_bf16 a[76:79], a[164:167], v[156:159], a[76:79]
    s_waitcnt lgkmcnt(3)
    buffer_load_dwordx4 v41, s[12:15], s41 offen offset:3072 lds
    v_mfma_f32_16x16x32_bf16 v[208:211], a[208:211], v[96:99], v[200:203]
    v_exp_f32 v212, v212
    v_mfma_f32_16x16x32_bf16 v[208:211], a[212:215], v[100:103], v[208:211]
    s_add_u32 s41, s41, 16384
    v_exp_f32 v213, v213
    v_mfma_f32_16x16x32_bf16 v[208:211], a[216:219], v[104:107], v[208:211]
    v_exp_f32 v214, v214
    v_mfma_f32_16x16x32_bf16 v[208:211], a[220:223], v[108:111], v[208:211]
    v_exp_f32 v215, v215
    v_mfma_f32_16x16x32_bf16 a[80:83], a[168:171], v[128:131], a[80:83]
    ds_read_b64_tr_b16 a[180:181], v26 offset:8192
    v_cvt_pk_bf16_f32 v172, v212, v213
    v_mfma_f32_16x16x32_bf16 a[80:83], a[172:175], v[132:135], a[80:83]
    ds_read_b64_tr_b16 a[182:183], v26 offset:12288
    v_mfma_f32_16x16x32_bf16 a[84:87], a[168:171], v[136:139], a[84:87]
    ds_read_b128 a[236:239], v11 offset:28672
    v_cvt_pk_bf16_f32 v173, v214, v215
    v_mfma_f32_16x16x32_bf16 a[84:87], a[172:175], v[140:143], a[84:87]
    s_waitcnt vmcnt(10)
    s_barrier
    v_mfma_f32_16x16x32_bf16 v[212:215], a[208:211], v[112:115], v[204:207]
    v_exp_f32 v208, v208
    v_mfma_f32_16x16x32_bf16 v[212:215], a[212:215], v[116:119], v[212:215]
    s_add_u32 m0, s42, 0
    v_exp_f32 v209, v209
    v_mfma_f32_16x16x32_bf16 v[212:215], a[216:219], v[120:123], v[212:215]
    v_exp_f32 v210, v210
    v_mfma_f32_16x16x32_bf16 v[212:215], a[220:223], v[124:127], v[212:215]
    v_exp_f32 v211, v211
    v_mfma_f32_16x16x32_bf16 a[88:91], a[168:171], v[144:147], a[88:91]
    ds_read_b64_tr_b16 a[184:185], v27 offset:0
    v_cvt_pk_bf16_f32 v180, v208, v209
    v_mfma_f32_16x16x32_bf16 a[88:91], a[172:175], v[148:151], a[88:91]
    ds_read_b64_tr_b16 a[186:187], v27 offset:4096
    v_mfma_f32_16x16x32_bf16 a[92:95], a[168:171], v[152:155], a[92:95]
    ds_read_b128 a[208:211], v8 offset:32768
    v_cvt_pk_bf16_f32 v181, v210, v211
    v_mfma_f32_16x16x32_bf16 a[92:95], a[172:175], v[156:159], a[92:95]
    s_waitcnt lgkmcnt(3)
    buffer_load_dwordx4 v36, s[8:11], s40 offen lds
    v_mfma_f32_16x16x32_bf16 v[208:211], a[224:227], v[64:67], v[192:195]
    v_exp_f32 v212, v212
    v_mfma_f32_16x16x32_bf16 v[208:211], a[228:231], v[68:71], v[208:211]
    v_exp_f32 v213, v213
    v_mfma_f32_16x16x32_bf16 v[208:211], a[232:235], v[72:75], v[208:211]
    v_exp_f32 v214, v214
    v_mfma_f32_16x16x32_bf16 v[208:211], a[236:239], v[76:79], v[208:211]
    v_exp_f32 v215, v215
    v_mfma_f32_16x16x32_bf16 a[96:99], a[176:179], v[128:131], a[96:99]
    ds_read_b64_tr_b16 a[188:189], v27 offset:8192
    v_cvt_pk_bf16_f32 v188, v212, v213
    v_mfma_f32_16x16x32_bf16 a[96:99], a[180:183], v[132:135], a[96:99]
    ds_read_b64_tr_b16 a[190:191], v27 offset:12288
    v_mfma_f32_16x16x32_bf16 a[100:103], a[176:179], v[136:139], a[100:103]
    ds_read_b128 a[212:215], v9 offset:32768
    v_cvt_pk_bf16_f32 v189, v214, v215
    v_mfma_f32_16x16x32_bf16 a[100:103], a[180:183], v[140:143], a[100:103]
    v_mfma_f32_16x16x32_bf16 v[212:215], a[224:227], v[80:83], v[196:199]
    v_exp_f32 v208, v208
    v_mfma_f32_16x16x32_bf16 v[212:215], a[228:231], v[84:87], v[212:215]
    v_exp_f32 v209, v209
    v_mfma_f32_16x16x32_bf16 v[212:215], a[232:235], v[88:91], v[212:215]
    v_exp_f32 v210, v210
    v_mfma_f32_16x16x32_bf16 v[212:215], a[236:239], v[92:95], v[212:215]
    v_exp_f32 v211, v211
    v_mfma_f32_16x16x32_bf16 a[104:107], a[176:179], v[144:147], a[104:107]
    ds_read_b64_tr_b16 a[160:161], v20 offset:16384
    v_cvt_pk_bf16_f32 v166, v208, v209
    v_mfma_f32_16x16x32_bf16 a[104:107], a[180:183], v[148:151], a[104:107]
    ds_read_b64_tr_b16 a[162:163], v20 offset:20480
    v_mfma_f32_16x16x32_bf16 a[108:111], a[176:179], v[152:155], a[108:111]
    ds_read_b128 a[216:219], v10 offset:32768
    v_cvt_pk_bf16_f32 v167, v210, v211
    v_mfma_f32_16x16x32_bf16 a[108:111], a[180:183], v[156:159], a[108:111]
    s_waitcnt lgkmcnt(3)
    buffer_load_dwordx4 v37, s[8:11], s40 offen offset:1024 lds
    v_mfma_f32_16x16x32_bf16 v[208:211], a[224:227], v[96:99], v[200:203]
    v_exp_f32 v212, v212
    v_mfma_f32_16x16x32_bf16 v[208:211], a[228:231], v[100:103], v[208:211]
    v_exp_f32 v213, v213
    v_mfma_f32_16x16x32_bf16 v[208:211], a[232:235], v[104:107], v[208:211]
    v_exp_f32 v214, v214
    v_mfma_f32_16x16x32_bf16 v[208:211], a[236:239], v[108:111], v[208:211]
    v_exp_f32 v215, v215
    v_mfma_f32_16x16x32_bf16 a[112:115], a[184:187], v[128:131], a[112:115]
    ds_read_b64_tr_b16 a[164:165], v20 offset:24576
    v_cvt_pk_bf16_f32 v174, v212, v213
    v_mfma_f32_16x16x32_bf16 a[112:115], a[188:191], v[132:135], a[112:115]
    ds_read_b64_tr_b16 a[166:167], v20 offset:28672
    v_mfma_f32_16x16x32_bf16 a[116:119], a[184:187], v[136:139], a[116:119]
    ds_read_b128 a[220:223], v11 offset:32768
    v_cvt_pk_bf16_f32 v175, v214, v215
    v_mfma_f32_16x16x32_bf16 a[116:119], a[188:191], v[140:143], a[116:119]
    buffer_load_dwordx4 v[240:243], v7, s[16:19], s44 offen
    v_mfma_f32_16x16x32_bf16 v[212:215], a[224:227], v[112:115], v[204:207]
    v_exp_f32 v208, v208
    v_mfma_f32_16x16x32_bf16 v[212:215], a[228:231], v[116:119], v[212:215]
    v_exp_f32 v209, v209
    v_mfma_f32_16x16x32_bf16 v[212:215], a[232:235], v[120:123], v[212:215]
    v_exp_f32 v210, v210
    v_mfma_f32_16x16x32_bf16 v[212:215], a[236:239], v[124:127], v[212:215]
    s_add_u32 s44, s44, 884736
    v_exp_f32 v211, v211
    v_mfma_f32_16x16x32_bf16 a[120:123], a[184:187], v[144:147], a[120:123]
    ds_read_b64_tr_b16 a[168:169], v21 offset:16384
    v_cvt_pk_bf16_f32 v182, v208, v209
    v_mfma_f32_16x16x32_bf16 a[120:123], a[188:191], v[148:151], a[120:123]
    ds_read_b64_tr_b16 a[170:171], v21 offset:20480
    v_mfma_f32_16x16x32_bf16 a[124:127], a[184:187], v[152:155], a[124:127]
    ds_read_b128 a[224:227], v8 offset:36864
    v_cvt_pk_bf16_f32 v183, v210, v211
    v_mfma_f32_16x16x32_bf16 a[124:127], a[188:191], v[156:159], a[124:127]
    s_waitcnt lgkmcnt(3)
    buffer_load_dwordx4 v38, s[8:11], s40 offen offset:2048 lds
    v_mfma_f32_16x16x32_bf16 v[208:211], a[208:211], v[64:67], v[192:195]
    v_exp_f32 v212, v212
    v_mfma_f32_16x16x32_bf16 v[208:211], a[212:215], v[68:71], v[208:211]
    v_exp_f32 v213, v213
    v_mfma_f32_16x16x32_bf16 v[208:211], a[216:219], v[72:75], v[208:211]
    v_exp_f32 v214, v214
    v_mfma_f32_16x16x32_bf16 v[208:211], a[220:223], v[76:79], v[208:211]
    v_exp_f32 v215, v215
    v_mfma_f32_16x16x32_bf16 a[0:3], a[160:163], v[160:163], a[0:3]
    ds_read_b64_tr_b16 a[172:173], v21 offset:24576
    v_cvt_pk_bf16_f32 v190, v212, v213
    v_mfma_f32_16x16x32_bf16 a[0:3], a[164:167], v[164:167], a[0:3]
    ds_read_b64_tr_b16 a[174:175], v21 offset:28672
    v_mfma_f32_16x16x32_bf16 a[4:7], a[160:163], v[168:171], a[4:7]
    ds_read_b128 a[228:231], v9 offset:36864
    v_cvt_pk_bf16_f32 v191, v214, v215
    v_mfma_f32_16x16x32_bf16 a[4:7], a[164:167], v[172:175], a[4:7]
    v_mfma_f32_16x16x32_bf16 v[212:215], a[208:211], v[80:83], v[196:199]
    v_exp_f32 v208, v208
    v_mfma_f32_16x16x32_bf16 v[212:215], a[212:215], v[84:87], v[212:215]
    v_exp_f32 v209, v209
    v_mfma_f32_16x16x32_bf16 v[212:215], a[216:219], v[88:91], v[212:215]
    v_exp_f32 v210, v210
    v_mfma_f32_16x16x32_bf16 v[212:215], a[220:223], v[92:95], v[212:215]
    v_exp_f32 v211, v211
    v_mfma_f32_16x16x32_bf16 a[8:11], a[160:163], v[176:179], a[8:11]
    ds_read_b64_tr_b16 a[176:177], v22 offset:16384
    v_cvt_pk_bf16_f32 v128, v208, v209
    v_mfma_f32_16x16x32_bf16 a[8:11], a[164:167], v[180:183], a[8:11]
    ds_read_b64_tr_b16 a[178:179], v22 offset:20480
    v_mfma_f32_16x16x32_bf16 a[12:15], a[160:163], v[184:187], a[12:15]
    ds_read_b128 a[232:235], v10 offset:36864
    v_cvt_pk_bf16_f32 v129, v210, v211
    v_mfma_f32_16x16x32_bf16 a[12:15], a[164:167], v[188:191], a[12:15]
    s_waitcnt lgkmcnt(3)
    buffer_load_dwordx4 v39, s[8:11], s40 offen offset:3072 lds
    v_mfma_f32_16x16x32_bf16 v[208:211], a[208:211], v[96:99], v[200:203]
    v_exp_f32 v212, v212
    v_mfma_f32_16x16x32_bf16 v[208:211], a[212:215], v[100:103], v[208:211]
    s_add_u32 s40, s40, 16384
    v_exp_f32 v213, v213
    v_mfma_f32_16x16x32_bf16 v[208:211], a[216:219], v[104:107], v[208:211]
    v_exp_f32 v214, v214
    v_mfma_f32_16x16x32_bf16 v[208:211], a[220:223], v[108:111], v[208:211]
    v_exp_f32 v215, v215
    v_mfma_f32_16x16x32_bf16 a[16:19], a[168:171], v[160:163], a[16:19]
    ds_read_b64_tr_b16 a[180:181], v22 offset:24576
    v_cvt_pk_bf16_f32 v136, v212, v213
    v_mfma_f32_16x16x32_bf16 a[16:19], a[172:175], v[164:167], a[16:19]
    ds_read_b64_tr_b16 a[182:183], v22 offset:28672
    v_mfma_f32_16x16x32_bf16 a[20:23], a[168:171], v[168:171], a[20:23]
    ds_read_b128 a[236:239], v11 offset:36864
    v_cvt_pk_bf16_f32 v137, v214, v215
    v_mfma_f32_16x16x32_bf16 a[20:23], a[172:175], v[172:175], a[20:23]
    v_smfmac_f32_16x16x64_bf16 a[192:195], v[52:55], v[160:167], v50
    v_mfma_f32_16x16x32_bf16 v[212:215], a[208:211], v[112:115], v[204:207]
Ltour4:
    s_cbranch_execz Ltour8
    v_exp_f32 v208, v208
    v_mfma_f32_16x16x32_bf16 v[212:215], a[212:215], v[116:119], v[212:215]
    s_add_u32 m0, s42, 114688
    v_exp_f32 v209, v209
    v_mfma_f32_16x16x32_bf16 v[212:215], a[216:219], v[120:123], v[212:215]
    v_exp_f32 v210, v210
    v_mfma_f32_16x16x32_bf16 v[212:215], a[220:223], v[124:127], v[212:215]
    v_exp_f32 v211, v211
    v_mfma_f32_16x16x32_bf16 a[24:27], a[168:171], v[176:179], a[24:27]
    ds_read_b64_tr_b16 a[184:185], v23 offset:16384
    v_cvt_pk_bf16_f32 v144, v208, v209
    v_mfma_f32_16x16x32_bf16 a[24:27], a[172:175], v[180:183], a[24:27]
    ds_read_b64_tr_b16 a[186:187], v23 offset:20480
    v_mfma_f32_16x16x32_bf16 a[28:31], a[168:171], v[184:187], a[28:31]
    ds_read_b128 a[208:211], v8 offset:40960
    v_cvt_pk_bf16_f32 v145, v210, v211
    v_mfma_f32_16x16x32_bf16 a[28:31], a[172:175], v[188:191], a[28:31]
    s_waitcnt lgkmcnt(3)
    buffer_load_dwordx4 v40, s[12:15], s41 offen lds
    v_mfma_f32_16x16x32_bf16 v[208:211], a[224:227], v[64:67], v[192:195]
    v_exp_f32 v212, v212
    v_mfma_f32_16x16x32_bf16 v[208:211], a[228:231], v[68:71], v[208:211]
    v_exp_f32 v213, v213
    v_mfma_f32_16x16x32_bf16 v[208:211], a[232:235], v[72:75], v[208:211]
    v_exp_f32 v214, v214
    v_mfma_f32_16x16x32_bf16 v[208:211], a[236:239], v[76:79], v[208:211]
    v_exp_f32 v215, v215
    v_mfma_f32_16x16x32_bf16 a[32:35], a[176:179], v[160:163], a[32:35]
    ds_read_b64_tr_b16 a[188:189], v23 offset:24576
    v_cvt_pk_bf16_f32 v152, v212, v213
    v_mfma_f32_16x16x32_bf16 a[32:35], a[180:183], v[164:167], a[32:35]
    ds_read_b64_tr_b16 a[190:191], v23 offset:28672
    v_mfma_f32_16x16x32_bf16 a[36:39], a[176:179], v[168:171], a[36:39]
    ds_read_b128 a[212:215], v9 offset:40960
    v_cvt_pk_bf16_f32 v153, v214, v215
    v_mfma_f32_16x16x32_bf16 a[36:39], a[180:183], v[172:175], a[36:39]
    v_smfmac_f32_16x16x64_bf16 a[196:199], v[52:55], v[168:175], v50
    v_mfma_f32_16x16x32_bf16 v[212:215], a[224:227], v[80:83], v[196:199]
    v_exp_f32 v208, v208
    v_mfma_f32_16x16x32_bf16 v[212:215], a[228:231], v[84:87], v[212:215]
    v_exp_f32 v209, v209
    v_mfma_f32_16x16x32_bf16 v[212:215], a[232:235], v[88:91], v[212:215]
    v_exp_f32 v210, v210
    v_mfma_f32_16x16x32_bf16 v[212:215], a[236:239], v[92:95], v[212:215]
    v_exp_f32 v211, v211
    v_mfma_f32_16x16x32_bf16 a[40:43], a[176:179], v[176:179], a[40:43]
    ds_read_b64_tr_b16 a[160:161], v24 offset:16384
    v_cvt_pk_bf16_f32 v130, v208, v209
    v_mfma_f32_16x16x32_bf16 a[40:43], a[180:183], v[180:183], a[40:43]
    ds_read_b64_tr_b16 a[162:163], v24 offset:20480
    v_mfma_f32_16x16x32_bf16 a[44:47], a[176:179], v[184:187], a[44:47]
    ds_read_b128 a[216:219], v10 offset:40960
    v_cvt_pk_bf16_f32 v131, v210, v211
    v_mfma_f32_16x16x32_bf16 a[44:47], a[180:183], v[188:191], a[44:47]
    s_waitcnt lgkmcnt(3)
    buffer_load_dwordx4 v41, s[12:15], s41 offen offset:1024 lds
    v_mfma_f32_16x16x32_bf16 v[208:211], a[224:227], v[96:99], v[200:203]
    v_exp_f32 v212, v212
    v_mfma_f32_16x16x32_bf16 v[208:211], a[228:231], v[100:103], v[208:211]
    v_exp_f32 v213, v213
    v_mfma_f32_16x16x32_bf16 v[208:211], a[232:235], v[104:107], v[208:211]
    v_exp_f32 v214, v214
    v_mfma_f32_16x16x32_bf16 v[208:211], a[236:239], v[108:111], v[208:211]
    v_exp_f32 v215, v215
    v_mfma_f32_16x16x32_bf16 a[48:51], a[184:187], v[160:163], a[48:51]
    ds_read_b64_tr_b16 a[164:165], v24 offset:24576
    v_cvt_pk_bf16_f32 v138, v212, v213
    v_mfma_f32_16x16x32_bf16 a[48:51], a[188:191], v[164:167], a[48:51]
    ds_read_b64_tr_b16 a[166:167], v24 offset:28672
    v_mfma_f32_16x16x32_bf16 a[52:55], a[184:187], v[168:171], a[52:55]
    ds_read_b128 a[220:223], v11 offset:40960
    v_cvt_pk_bf16_f32 v139, v214, v215
    v_mfma_f32_16x16x32_bf16 a[52:55], a[188:191], v[172:175], a[52:55]
    v_smfmac_f32_16x16x64_bf16 a[200:203], v[52:55], v[176:183], v50
    v_mfma_f32_16x16x32_bf16 v[212:215], a[224:227], v[112:115], v[204:207]
    v_exp_f32 v208, v208
    v_mfma_f32_16x16x32_bf16 v[212:215], a[228:231], v[116:119], v[212:215]
    v_exp_f32 v209, v209
    v_mfma_f32_16x16x32_bf16 v[212:215], a[232:235], v[120:123], v[212:215]
    v_exp_f32 v210, v210
    v_mfma_f32_16x16x32_bf16 v[212:215], a[236:239], v[124:127], v[212:215]
    v_exp_f32 v211, v211
    v_mfma_f32_16x16x32_bf16 a[56:59], a[184:187], v[176:179], a[56:59]
    ds_read_b64_tr_b16 a[168:169], v25 offset:16384
    v_cvt_pk_bf16_f32 v146, v208, v209
    v_mfma_f32_16x16x32_bf16 a[56:59], a[188:191], v[180:183], a[56:59]
    ds_read_b64_tr_b16 a[170:171], v25 offset:20480
    v_mfma_f32_16x16x32_bf16 a[60:63], a[184:187], v[184:187], a[60:63]
    ds_read_b128 a[224:227], v8 offset:45056
    v_cvt_pk_bf16_f32 v147, v210, v211
    v_mfma_f32_16x16x32_bf16 a[60:63], a[188:191], v[188:191], a[60:63]
    s_waitcnt lgkmcnt(3)
    buffer_load_dwordx4 v40, s[12:15], s41 offen offset:2048 lds
    v_mfma_f32_16x16x32_bf16 v[208:211], a[208:211], v[64:67], v[192:195]
    v_exp_f32 v212, v212
    v_mfma_f32_16x16x32_bf16 v[208:211], a[212:215], v[68:71], v[208:211]
    v_exp_f32 v213, v213
    v_mfma_f32_16x16x32_bf16 v[208:211], a[216:219], v[72:75], v[208:211]
    v_exp_f32 v214, v214
    v_mfma_f32_16x16x32_bf16 v[208:211], a[220:223], v[76:79], v[208:211]
    v_exp_f32 v215, v215
    v_mfma_f32_16x16x32_bf16 a[64:67], a[160:163], v[160:163], a[64:67]
    ds_read_b64_tr_b16 a[172:173], v25 offset:24576
    v_cvt_pk_bf16_f32 v154, v212, v213
    v_mfma_f32_16x16x32_bf16 a[64:67], a[164:167], v[164:167], a[64:67]
    ds_read_b64_tr_b16 a[174:175], v25 offset:28672
    v_mfma_f32_16x16x32_bf16 a[68:71], a[160:163], v[168:171], a[68:71]
    ds_read_b128 a[228:231], v9 offset:45056
    v_cvt_pk_bf16_f32 v155, v214, v215
    v_mfma_f32_16x16x32_bf16 a[68:71], a[164:167], v[172:175], a[68:71]
    v_smfmac_f32_16x16x64_bf16 a[204:207], v[52:55], v[184:191], v50
    v_mfma_f32_16x16x32_bf16 v[212:215], a[208:211], v[80:83], v[196:199]
    v_exp_f32 v208, v208
    v_mfma_f32_16x16x32_bf16 v[212:215], a[212:215], v[84:87], v[212:215]
    v_exp_f32 v209, v209
    v_mfma_f32_16x16x32_bf16 v[212:215], a[216:219], v[88:91], v[212:215]
    v_exp_f32 v210, v210
    v_mfma_f32_16x16x32_bf16 v[212:215], a[220:223], v[92:95], v[212:215]
    v_exp_f32 v211, v211
    v_mfma_f32_16x16x32_bf16 a[72:75], a[160:163], v[176:179], a[72:75]
    ds_read_b64_tr_b16 a[176:177], v26 offset:16384
    v_cvt_pk_bf16_f32 v132, v208, v209
    v_mfma_f32_16x16x32_bf16 a[72:75], a[164:167], v[180:183], a[72:75]
    ds_read_b64_tr_b16 a[178:179], v26 offset:20480
    v_mfma_f32_16x16x32_bf16 a[76:79], a[160:163], v[184:187], a[76:79]
    ds_read_b128 a[232:235], v10 offset:45056
    v_cvt_pk_bf16_f32 v133, v210, v211
    v_mfma_f32_16x16x32_bf16 a[76:79], a[164:167], v[188:191], a[76:79]
    s_waitcnt lgkmcnt(3)
    buffer_load_dwordx4 v41, s[12:15], s41 offen offset:3072 lds
    v_mfma_f32_16x16x32_bf16 v[208:211], a[208:211], v[96:99], v[200:203]
    v_exp_f32 v212, v212
    v_mfma_f32_16x16x32_bf16 v[208:211], a[212:215], v[100:103], v[208:211]
    s_add_u32 s41, s41, 16384
    v_exp_f32 v213, v213
    v_mfma_f32_16x16x32_bf16 v[208:211], a[216:219], v[104:107], v[208:211]
    v_exp_f32 v214, v214
    v_mfma_f32_16x16x32_bf16 v[208:211], a[220:223], v[108:111], v[208:211]
    v_exp_f32 v215, v215
    v_mfma_f32_16x16x32_bf16 a[80:83], a[168:171], v[160:163], a[80:83]
    ds_read_b64_tr_b16 a[180:181], v26 offset:24576
    v_cvt_pk_bf16_f32 v140, v212, v213
    v_mfma_f32_16x16x32_bf16 a[80:83], a[172:175], v[164:167], a[80:83]
    ds_read_b64_tr_b16 a[182:183], v26 offset:28672
    v_mfma_f32_16x16x32_bf16 a[84:87], a[168:171], v[168:171], a[84:87]
    ds_read_b128 a[236:239], v11 offset:45056
    v_cvt_pk_bf16_f32 v141, v214, v215
    v_mfma_f32_16x16x32_bf16 a[84:87], a[172:175], v[172:175], a[84:87]
    s_waitcnt vmcnt(9)
    s_barrier
    v_mfma_f32_16x16x32_bf16 v[212:215], a[208:211], v[112:115], v[204:207]
    v_exp_f32 v208, v208
    v_mfma_f32_16x16x32_bf16 v[212:215], a[212:215], v[116:119], v[212:215]
    s_add_u32 m0, s42, 16384
    v_exp_f32 v209, v209
    v_mfma_f32_16x16x32_bf16 v[212:215], a[216:219], v[120:123], v[212:215]
    v_exp_f32 v210, v210
    v_mfma_f32_16x16x32_bf16 v[212:215], a[220:223], v[124:127], v[212:215]
    v_exp_f32 v211, v211
    v_mfma_f32_16x16x32_bf16 a[88:91], a[168:171], v[176:179], a[88:91]
    ds_read_b64_tr_b16 a[184:185], v27 offset:16384
    v_cvt_pk_bf16_f32 v148, v208, v209
    v_mfma_f32_16x16x32_bf16 a[88:91], a[172:175], v[180:183], a[88:91]
    ds_read_b64_tr_b16 a[186:187], v27 offset:20480
    v_mfma_f32_16x16x32_bf16 a[92:95], a[168:171], v[184:187], a[92:95]
    ds_read_b128 a[208:211], v8 offset:49152
    v_cvt_pk_bf16_f32 v149, v210, v211
    v_mfma_f32_16x16x32_bf16 a[92:95], a[172:175], v[188:191], a[92:95]
    s_waitcnt lgkmcnt(3)
    buffer_load_dwordx4 v36, s[8:11], s40 offen lds
    v_mfma_f32_16x16x32_bf16 v[208:211], a[224:227], v[64:67], v[192:195]
    v_exp_f32 v212, v212
    v_mfma_f32_16x16x32_bf16 v[208:211], a[228:231], v[68:71], v[208:211]
    v_exp_f32 v213, v213
    v_mfma_f32_16x16x32_bf16 v[208:211], a[232:235], v[72:75], v[208:211]
    v_exp_f32 v214, v214
    v_mfma_f32_16x16x32_bf16 v[208:211], a[236:239], v[76:79], v[208:211]
    v_exp_f32 v215, v215
    v_mfma_f32_16x16x32_bf16 a[96:99], a[176:179], v[160:163], a[96:99]
    ds_read_b64_tr_b16 a[188:189], v27 offset:24576
    v_cvt_pk_bf16_f32 v156, v212, v213
    v_mfma_f32_16x16x32_bf16 a[96:99], a[180:183], v[164:167], a[96:99]
    ds_read_b64_tr_b16 a[190:191], v27 offset:28672
    v_mfma_f32_16x16x32_bf16 a[100:103], a[176:179], v[168:171], a[100:103]
    ds_read_b128 a[212:215], v9 offset:49152
    v_cvt_pk_bf16_f32 v157, v214, v215
    v_mfma_f32_16x16x32_bf16 a[100:103], a[180:183], v[172:175], a[100:103]
    buffer_load_dword v218, v57, s[80:83], s39 offen
    v_mfma_f32_16x16x32_bf16 v[212:215], a[224:227], v[80:83], v[196:199]
    v_exp_f32 v208, v208
    v_mfma_f32_16x16x32_bf16 v[212:215], a[228:231], v[84:87], v[212:215]
    v_exp_f32 v209, v209
    v_mfma_f32_16x16x32_bf16 v[212:215], a[232:235], v[88:91], v[212:215]
    v_exp_f32 v210, v210
    v_mfma_f32_16x16x32_bf16 v[212:215], a[236:239], v[92:95], v[212:215]
    v_exp_f32 v211, v211
    v_mfma_f32_16x16x32_bf16 a[104:107], a[176:179], v[176:179], a[104:107]
    ds_read_b64_tr_b16 a[160:161], v20 offset:32768
    v_cvt_pk_bf16_f32 v134, v208, v209
    v_mfma_f32_16x16x32_bf16 a[104:107], a[180:183], v[180:183], a[104:107]
    ds_read_b64_tr_b16 a[162:163], v20 offset:36864
    v_mfma_f32_16x16x32_bf16 a[108:111], a[176:179], v[184:187], a[108:111]
    ds_read_b128 a[216:219], v10 offset:49152
    v_cvt_pk_bf16_f32 v135, v210, v211
    v_mfma_f32_16x16x32_bf16 a[108:111], a[180:183], v[188:191], a[108:111]
    s_waitcnt lgkmcnt(3)
    buffer_load_dwordx4 v37, s[8:11], s40 offen offset:1024 lds
    v_mfma_f32_16x16x32_bf16 v[208:211], a[224:227], v[96:99], v[200:203]
    v_exp_f32 v212, v212
    v_mfma_f32_16x16x32_bf16 v[208:211], a[228:231], v[100:103], v[208:211]
    v_exp_f32 v213, v213
    v_mfma_f32_16x16x32_bf16 v[208:211], a[232:235], v[104:107], v[208:211]
    v_exp_f32 v214, v214
    v_mfma_f32_16x16x32_bf16 v[208:211], a[236:239], v[108:111], v[208:211]
    v_exp_f32 v215, v215
    v_mfma_f32_16x16x32_bf16 a[112:115], a[184:187], v[160:163], a[112:115]
    ds_read_b64_tr_b16 a[164:165], v20 offset:40960
    v_cvt_pk_bf16_f32 v142, v212, v213
    v_mfma_f32_16x16x32_bf16 a[112:115], a[188:191], v[164:167], a[112:115]
    ds_read_b64_tr_b16 a[166:167], v20 offset:45056
    v_mfma_f32_16x16x32_bf16 a[116:119], a[184:187], v[168:171], a[116:119]
    ds_read_b128 a[220:223], v11 offset:49152
    v_cvt_pk_bf16_f32 v143, v214, v215
    v_mfma_f32_16x16x32_bf16 a[116:119], a[188:191], v[172:175], a[116:119]
    buffer_store_dwordx4 v[248:251], v232, s[24:27], s53 offen sc1
    v_mfma_f32_16x16x32_bf16 v[212:215], a[224:227], v[112:115], v[204:207]
    v_exp_f32 v208, v208
    v_mfma_f32_16x16x32_bf16 v[212:215], a[228:231], v[116:119], v[212:215]
    v_exp_f32 v209, v209
    v_mfma_f32_16x16x32_bf16 v[212:215], a[232:235], v[120:123], v[212:215]
    v_exp_f32 v210, v210
    v_mfma_f32_16x16x32_bf16 v[212:215], a[236:239], v[124:127], v[212:215]
    s_add_u32 s53, s53, 656
    v_exp_f32 v211, v211
    v_mfma_f32_16x16x32_bf16 a[120:123], a[184:187], v[176:179], a[120:123]
    ds_read_b64_tr_b16 a[168:169], v21 offset:32768
    v_cvt_pk_bf16_f32 v150, v208, v209
    v_mfma_f32_16x16x32_bf16 a[120:123], a[188:191], v[180:183], a[120:123]
    ds_read_b64_tr_b16 a[170:171], v21 offset:36864
    v_mfma_f32_16x16x32_bf16 a[124:127], a[184:187], v[184:187], a[124:127]
    ds_read_b128 a[224:227], v8 offset:53248
    v_cvt_pk_bf16_f32 v151, v210, v211
    v_mfma_f32_16x16x32_bf16 a[124:127], a[188:191], v[188:191], a[124:127]
    s_waitcnt lgkmcnt(3)
    buffer_load_dwordx4 v38, s[8:11], s40 offen offset:2048 lds
    v_mfma_f32_16x16x32_bf16 v[208:211], a[208:211], v[64:67], v[192:195]
    v_exp_f32 v212, v212
    v_mfma_f32_16x16x32_bf16 v[208:211], a[212:215], v[68:71], v[208:211]
    v_exp_f32 v213, v213
    v_mfma_f32_16x16x32_bf16 v[208:211], a[216:219], v[72:75], v[208:211]
    v_exp_f32 v214, v214
    v_mfma_f32_16x16x32_bf16 v[208:211], a[220:223], v[76:79], v[208:211]
    v_exp_f32 v215, v215
    v_mfma_f32_16x16x32_bf16 a[0:3], a[160:163], v[128:131], a[0:3]
    ds_read_b64_tr_b16 a[172:173], v21 offset:40960
    v_cvt_pk_bf16_f32 v158, v212, v213
    v_mfma_f32_16x16x32_bf16 a[0:3], a[164:167], v[132:135], a[0:3]
    ds_read_b64_tr_b16 a[174:175], v21 offset:45056
    v_mfma_f32_16x16x32_bf16 a[4:7], a[160:163], v[136:139], a[4:7]
    ds_read_b128 a[228:231], v9 offset:53248
    v_cvt_pk_bf16_f32 v159, v214, v215
    v_mfma_f32_16x16x32_bf16 a[4:7], a[164:167], v[140:143], a[4:7]
    v_mfma_f32_16x16x32_bf16 v[212:215], a[208:211], v[80:83], v[196:199]
    v_exp_f32 v208, v208
    v_mfma_f32_16x16x32_bf16 v[212:215], a[212:215], v[84:87], v[212:215]
    v_exp_f32 v209, v209
    v_mfma_f32_16x16x32_bf16 v[212:215], a[216:219], v[88:91], v[212:215]
    v_exp_f32 v210, v210
    v_mfma_f32_16x16x32_bf16 v[212:215], a[220:223], v[92:95], v[212:215]
    v_exp_f32 v211, v211
    v_mfma_f32_16x16x32_bf16 a[8:11], a[160:163], v[144:147], a[8:11]
    ds_read_b64_tr_b16 a[176:177], v22 offset:32768
    v_cvt_pk_bf16_f32 v160, v208, v209
    v_mfma_f32_16x16x32_bf16 a[8:11], a[164:167], v[148:151], a[8:11]
    ds_read_b64_tr_b16 a[178:179], v22 offset:36864
    v_mfma_f32_16x16x32_bf16 a[12:15], a[160:163], v[152:155], a[12:15]
    ds_read_b128 a[232:235], v10 offset:53248
    v_cvt_pk_bf16_f32 v161, v210, v211
    v_mfma_f32_16x16x32_bf16 a[12:15], a[164:167], v[156:159], a[12:15]
    s_waitcnt lgkmcnt(3)
    buffer_load_dwordx4 v39, s[8:11], s40 offen offset:3072 lds
    v_mfma_f32_16x16x32_bf16 v[208:211], a[208:211], v[96:99], v[200:203]
    v_exp_f32 v212, v212
    v_mfma_f32_16x16x32_bf16 v[208:211], a[212:215], v[100:103], v[208:211]
    s_add_u32 s40, s40, 16384
    v_exp_f32 v213, v213
    v_mfma_f32_16x16x32_bf16 v[208:211], a[216:219], v[104:107], v[208:211]
    v_exp_f32 v214, v214
    v_mfma_f32_16x16x32_bf16 v[208:211], a[220:223], v[108:111], v[208:211]
    v_exp_f32 v215, v215
    v_mfma_f32_16x16x32_bf16 a[16:19], a[168:171], v[128:131], a[16:19]
    ds_read_b64_tr_b16 a[180:181], v22 offset:40960
    v_cvt_pk_bf16_f32 v168, v212, v213
    v_mfma_f32_16x16x32_bf16 a[16:19], a[172:175], v[132:135], a[16:19]
    ds_read_b64_tr_b16 a[182:183], v22 offset:45056
    v_mfma_f32_16x16x32_bf16 a[20:23], a[168:171], v[136:139], a[20:23]
    ds_read_b128 a[236:239], v11 offset:53248
    v_cvt_pk_bf16_f32 v169, v214, v215
    v_mfma_f32_16x16x32_bf16 a[20:23], a[172:175], v[140:143], a[20:23]
    v_smfmac_f32_16x16x64_bf16 a[192:195], v[52:55], v[128:135], v50
    v_mfma_f32_16x16x32_bf16 v[212:215], a[208:211], v[112:115], v[204:207]
    v_exp_f32 v208, v208
    v_mfma_f32_16x16x32_bf16 v[212:215], a[212:215], v[116:119], v[212:215]
    s_add_u32 m0, s42, 65536
    v_exp_f32 v209, v209
    v_mfma_f32_16x16x32_bf16 v[212:215], a[216:219], v[120:123], v[212:215]
    v_exp_f32 v210, v210
    v_mfma_f32_16x16x32_bf16 v[212:215], a[220:223], v[124:127], v[212:215]
    v_exp_f32 v211, v211
    v_mfma_f32_16x16x32_bf16 a[24:27], a[168:171], v[144:147], a[24:27]
    ds_read_b64_tr_b16 a[184:185], v23 offset:32768
    v_cvt_pk_bf16_f32 v176, v208, v209
    v_mfma_f32_16x16x32_bf16 a[24:27], a[172:175], v[148:151], a[24:27]
    ds_read_b64_tr_b16 a[186:187], v23 offset:36864
    v_mfma_f32_16x16x32_bf16 a[28:31], a[168:171], v[152:155], a[28:31]
    ds_read_b128 a[208:211], v8 offset:57344
    v_cvt_pk_bf16_f32 v177, v210, v211
    v_mfma_f32_16x16x32_bf16 a[28:31], a[172:175], v[156:159], a[28:31]
    s_waitcnt lgkmcnt(3)
    buffer_load_dwordx4 v40, s[12:15], s41 offen lds
    v_mfma_f32_16x16x32_bf16 v[208:211], a[224:227], v[64:67], v[192:195]
    v_exp_f32 v212, v212
    v_mfma_f32_16x16x32_bf16 v[208:211], a[228:231], v[68:71], v[208:211]
    v_exp_f32 v213, v213
    v_mfma_f32_16x16x32_bf16 v[208:211], a[232:235], v[72:75], v[208:211]
    v_exp_f32 v214, v214
    v_mfma_f32_16x16x32_bf16 v[208:211], a[236:239], v[76:79], v[208:211]
    v_exp_f32 v215, v215
    v_mfma_f32_16x16x32_bf16 a[32:35], a[176:179], v[128:131], a[32:35]
    ds_read_b64_tr_b16 a[188:189], v23 offset:40960
    v_cvt_pk_bf16_f32 v184, v212, v213
    v_mfma_f32_16x16x32_bf16 a[32:35], a[180:183], v[132:135], a[32:35]
    ds_read_b64_tr_b16 a[190:191], v23 offset:45056
    v_mfma_f32_16x16x32_bf16 a[36:39], a[176:179], v[136:139], a[36:39]
    ds_read_b128 a[212:215], v9 offset:57344
    v_cvt_pk_bf16_f32 v185, v214, v215
    v_mfma_f32_16x16x32_bf16 a[36:39], a[180:183], v[140:143], a[36:39]
    v_smfmac_f32_16x16x64_bf16 a[196:199], v[52:55], v[136:143], v50
    v_mfma_f32_16x16x32_bf16 v[212:215], a[224:227], v[80:83], v[196:199]
    v_exp_f32 v208, v208
    v_mfma_f32_16x16x32_bf16 v[212:215], a[228:231], v[84:87], v[212:215]
    v_exp_f32 v209, v209
    v_mfma_f32_16x16x32_bf16 v[212:215], a[232:235], v[88:91], v[212:215]
    v_exp_f32 v210, v210
    v_mfma_f32_16x16x32_bf16 v[212:215], a[236:239], v[92:95], v[212:215]
    v_exp_f32 v211, v211
    v_mfma_f32_16x16x32_bf16 a[40:43], a[176:179], v[144:147], a[40:43]
    ds_read_b64_tr_b16 a[160:161], v24 offset:32768
    v_cvt_pk_bf16_f32 v162, v208, v209
    v_mfma_f32_16x16x32_bf16 a[40:43], a[180:183], v[148:151], a[40:43]
    ds_read_b64_tr_b16 a[162:163], v24 offset:36864
    v_mfma_f32_16x16x32_bf16 a[44:47], a[176:179], v[152:155], a[44:47]
    ds_read_b128 a[216:219], v10 offset:57344
    v_cvt_pk_bf16_f32 v163, v210, v211
    v_mfma_f32_16x16x32_bf16 a[44:47], a[180:183], v[156:159], a[44:47]
    s_waitcnt lgkmcnt(3)
    buffer_load_dwordx4 v41, s[12:15], s41 offen offset:1024 lds
    v_mfma_f32_16x16x32_bf16 v[208:211], a[224:227], v[96:99], v[200:203]
    v_exp_f32 v212, v212
    v_mfma_f32_16x16x32_bf16 v[208:211], a[228:231], v[100:103], v[208:211]
    v_exp_f32 v213, v213
    v_mfma_f32_16x16x32_bf16 v[208:211], a[232:235], v[104:107], v[208:211]
    v_exp_f32 v214, v214
    v_mfma_f32_16x16x32_bf16 v[208:211], a[236:239], v[108:111], v[208:211]
    v_exp_f32 v215, v215
    v_mfma_f32_16x16x32_bf16 a[48:51], a[184:187], v[128:131], a[48:51]
    ds_read_b64_tr_b16 a[164:165], v24 offset:40960
    v_cvt_pk_bf16_f32 v170, v212, v213
    v_mfma_f32_16x16x32_bf16 a[48:51], a[188:191], v[132:135], a[48:51]
    ds_read_b64_tr_b16 a[166:167], v24 offset:45056
    v_mfma_f32_16x16x32_bf16 a[52:55], a[184:187], v[136:139], a[52:55]
    ds_read_b128 a[220:223], v11 offset:57344
    v_cvt_pk_bf16_f32 v171, v214, v215
    v_mfma_f32_16x16x32_bf16 a[52:55], a[188:191], v[140:143], a[52:55]
    v_smfmac_f32_16x16x64_bf16 a[200:203], v[52:55], v[144:151], v50
    v_mfma_f32_16x16x32_bf16 v[212:215], a[224:227], v[112:115], v[204:207]
    v_exp_f32 v208, v208
    v_mfma_f32_16x16x32_bf16 v[212:215], a[228:231], v[116:119], v[212:215]
    v_exp_f32 v209, v209
    v_mfma_f32_16x16x32_bf16 v[212:215], a[232:235], v[120:123], v[212:215]
    v_exp_f32 v210, v210
    v_mfma_f32_16x16x32_bf16 v[212:215], a[236:239], v[124:127], v[212:215]
    v_exp_f32 v211, v211
    v_mfma_f32_16x16x32_bf16 a[56:59], a[184:187], v[144:147], a[56:59]
    ds_read_b64_tr_b16 a[168:169], v25 offset:32768
    v_cvt_pk_bf16_f32 v178, v208, v209
    v_mfma_f32_16x16x32_bf16 a[56:59], a[188:191], v[148:151], a[56:59]
    ds_read_b64_tr_b16 a[170:171], v25 offset:36864
    v_mfma_f32_16x16x32_bf16 a[60:63], a[184:187], v[152:155], a[60:63]
    ds_read_b128 a[224:227], v8 offset:61440
    v_cvt_pk_bf16_f32 v179, v210, v211
    v_mfma_f32_16x16x32_bf16 a[60:63], a[188:191], v[156:159], a[60:63]
    s_waitcnt lgkmcnt(3)
    buffer_load_dwordx4 v40, s[12:15], s41 offen offset:2048 lds
    v_mfma_f32_16x16x32_bf16 v[208:211], a[208:211], v[64:67], v[192:195]
    v_exp_f32 v212, v212
    v_mfma_f32_16x16x32_bf16 v[208:211], a[212:215], v[68:71], v[208:211]
    v_exp_f32 v213, v213
    v_mfma_f32_16x16x32_bf16 v[208:211], a[216:219], v[72:75], v[208:211]
    v_exp_f32 v214, v214
    v_mfma_f32_16x16x32_bf16 v[208:211], a[220:223], v[76:79], v[208:211]
    v_exp_f32 v215, v215
    v_mfma_f32_16x16x32_bf16 a[64:67], a[160:163], v[128:131], a[64:67]
    ds_read_b64_tr_b16 a[172:173], v25 offset:40960
    v_cvt_pk_bf16_f32 v186, v212, v213
    v_mfma_f32_16x16x32_bf16 a[64:67], a[164:167], v[132:135], a[64:67]
    ds_read_b64_tr_b16 a[174:175], v25 offset:45056
    v_mfma_f32_16x16x32_bf16 a[68:71], a[160:163], v[136:139], a[68:71]
    ds_read_b128 a[228:231], v9 offset:61440
    v_cvt_pk_bf16_f32 v187, v214, v215
    v_mfma_f32_16x16x32_bf16 a[68:71], a[164:167], v[140:143], a[68:71]
    v_smfmac_f32_16x16x64_bf16 a[204:207], v[52:55], v[152:159], v50
    v_mfma_f32_16x16x32_bf16 v[212:215], a[208:211], v[80:83], v[196:199]
    v_exp_f32 v208, v208
    v_mfma_f32_16x16x32_bf16 v[212:215], a[212:215], v[84:87], v[212:215]
    v_exp_f32 v209, v209
    v_mfma_f32_16x16x32_bf16 v[212:215], a[216:219], v[88:91], v[212:215]
    v_exp_f32 v210, v210
    v_mfma_f32_16x16x32_bf16 v[212:215], a[220:223], v[92:95], v[212:215]
    v_exp_f32 v211, v211
    v_mfma_f32_16x16x32_bf16 a[72:75], a[160:163], v[144:147], a[72:75]
    ds_read_b64_tr_b16 a[176:177], v26 offset:32768
    v_cvt_pk_bf16_f32 v164, v208, v209
    v_mfma_f32_16x16x32_bf16 a[72:75], a[164:167], v[148:151], a[72:75]
    ds_read_b64_tr_b16 a[178:179], v26 offset:36864
    v_mfma_f32_16x16x32_bf16 a[76:79], a[160:163], v[152:155], a[76:79]
    ds_read_b128 a[232:235], v10 offset:61440
    v_cvt_pk_bf16_f32 v165, v210, v211
    v_mfma_f32_16x16x32_bf16 a[76:79], a[164:167], v[156:159], a[76:79]
    s_waitcnt lgkmcnt(3)
    buffer_load_dwordx4 v41, s[12:15], s41 offen offset:3072 lds
    v_mfma_f32_16x16x32_bf16 v[208:211], a[208:211], v[96:99], v[200:203]
    v_exp_f32 v212, v212
    v_mfma_f32_16x16x32_bf16 v[208:211], a[212:215], v[100:103], v[208:211]
    s_add_u32 s41, s41, 16384
    v_exp_f32 v213, v213
    v_mfma_f32_16x16x32_bf16 v[208:211], a[216:219], v[104:107], v[208:211]
    v_exp_f32 v214, v214
    v_mfma_f32_16x16x32_bf16 v[208:211], a[220:223], v[108:111], v[208:211]
    v_exp_f32 v215, v215
    v_mfma_f32_16x16x32_bf16 a[80:83], a[168:171], v[128:131], a[80:83]
    ds_read_b64_tr_b16 a[180:181], v26 offset:40960
    v_cvt_pk_bf16_f32 v172, v212, v213
    v_mfma_f32_16x16x32_bf16 a[80:83], a[172:175], v[132:135], a[80:83]
    ds_read_b64_tr_b16 a[182:183], v26 offset:45056
    v_mfma_f32_16x16x32_bf16 a[84:87], a[168:171], v[136:139], a[84:87]
    ds_read_b128 a[236:239], v11 offset:61440
    v_cvt_pk_bf16_f32 v173, v214, v215
    v_mfma_f32_16x16x32_bf16 a[84:87], a[172:175], v[140:143], a[84:87]
    s_waitcnt vmcnt(10)
    s_barrier
    v_mfma_f32_16x16x32_bf16 v[212:215], a[208:211], v[112:115], v[204:207]
    v_exp_f32 v208, v208
    v_mfma_f32_16x16x32_bf16 v[212:215], a[212:215], v[116:119], v[212:215]
    s_add_u32 m0, s42, 32768
    v_exp_f32 v209, v209
    v_mfma_f32_16x16x32_bf16 v[212:215], a[216:219], v[120:123], v[212:215]
    v_exp_f32 v210, v210
    v_mfma_f32_16x16x32_bf16 v[212:215], a[220:223], v[124:127], v[212:215]
    v_exp_f32 v211, v211
    v_mfma_f32_16x16x32_bf16 a[88:91], a[168:171], v[144:147], a[88:91]
    ds_read_b64_tr_b16 a[184:185], v27 offset:32768
    v_cvt_pk_bf16_f32 v180, v208, v209
    v_mfma_f32_16x16x32_bf16 a[88:91], a[172:175], v[148:151], a[88:91]
    ds_read_b64_tr_b16 a[186:187], v27 offset:36864
    v_mfma_f32_16x16x32_bf16 a[92:95], a[168:171], v[152:155], a[92:95]
    ds_read_b128 a[208:211], v8 offset:0
    v_cvt_pk_bf16_f32 v181, v210, v211
    v_mfma_f32_16x16x32_bf16 a[92:95], a[172:175], v[156:159], a[92:95]
    s_waitcnt lgkmcnt(3)
    buffer_load_dwordx4 v36, s[8:11], s40 offen lds
    v_mfma_f32_16x16x32_bf16 v[208:211], a[224:227], v[64:67], v[192:195]
    v_exp_f32 v212, v212
    v_mfma_f32_16x16x32_bf16 v[208:211], a[228:231], v[68:71], v[208:211]
    v_exp_f32 v213, v213
    v_mfma_f32_16x16x32_bf16 v[208:211], a[232:235], v[72:75], v[208:211]
    v_exp_f32 v214, v214
    v_mfma_f32_16x16x32_bf16 v[208:211], a[236:239], v[76:79], v[208:211]
    v_exp_f32 v215, v215
    v_mfma_f32_16x16x32_bf16 a[96:99], a[176:179], v[128:131], a[96:99]
    ds_read_b64_tr_b16 a[188:189], v27 offset:40960
    v_cvt_pk_bf16_f32 v188, v212, v213
    v_mfma_f32_16x16x32_bf16 a[96:99], a[180:183], v[132:135], a[96:99]
    ds_read_b64_tr_b16 a[190:191], v27 offset:45056
    v_mfma_f32_16x16x32_bf16 a[100:103], a[176:179], v[136:139], a[100:103]
    ds_read_b128 a[212:215], v9 offset:0
    v_cvt_pk_bf16_f32 v189, v214, v215
    v_mfma_f32_16x16x32_bf16 a[100:103], a[180:183], v[140:143], a[100:103]
    buffer_load_dword v219, v62, s[84:87], s38 offen
    v_mfma_f32_16x16x32_bf16 v[212:215], a[224:227], v[80:83], v[196:199]
    v_exp_f32 v208, v208
    v_mfma_f32_16x16x32_bf16 v[212:215], a[228:231], v[84:87], v[212:215]
    v_exp_f32 v209, v209
    v_mfma_f32_16x16x32_bf16 v[212:215], a[232:235], v[88:91], v[212:215]
    v_exp_f32 v210, v210
    v_mfma_f32_16x16x32_bf16 v[212:215], a[236:239], v[92:95], v[212:215]
    v_exp_f32 v211, v211
    v_mfma_f32_16x16x32_bf16 a[104:107], a[176:179], v[144:147], a[104:107]
    ds_read_b64_tr_b16 a[160:161], v20 offset:49152
    v_cvt_pk_bf16_f32 v166, v208, v209
    v_mfma_f32_16x16x32_bf16 a[104:107], a[180:183], v[148:151], a[104:107]
    ds_read_b64_tr_b16 a[162:163], v20 offset:53248
    v_mfma_f32_16x16x32_bf16 a[108:111], a[176:179], v[152:155], a[108:111]
    ds_read_b128 a[216:219], v10 offset:0
    v_cvt_pk_bf16_f32 v167, v210, v211
    v_mfma_f32_16x16x32_bf16 a[108:111], a[180:183], v[156:159], a[108:111]
    s_waitcnt lgkmcnt(3)
    buffer_load_dwordx4 v37, s[8:11], s40 offen offset:1024 lds
    v_mfma_f32_16x16x32_bf16 v[208:211], a[224:227], v[96:99], v[200:203]
    v_exp_f32 v212, v212
    v_mfma_f32_16x16x32_bf16 v[208:211], a[228:231], v[100:103], v[208:211]
    v_exp_f32 v213, v213
    v_mfma_f32_16x16x32_bf16 v[208:211], a[232:235], v[104:107], v[208:211]
    v_exp_f32 v214, v214
    v_mfma_f32_16x16x32_bf16 v[208:211], a[236:239], v[108:111], v[208:211]
    v_exp_f32 v215, v215
    v_mfma_f32_16x16x32_bf16 a[112:115], a[184:187], v[128:131], a[112:115]
    ds_read_b64_tr_b16 a[164:165], v20 offset:57344
    v_cvt_pk_bf16_f32 v174, v212, v213
    v_mfma_f32_16x16x32_bf16 a[112:115], a[188:191], v[132:135], a[112:115]
    ds_read_b64_tr_b16 a[166:167], v20 offset:61440
    v_mfma_f32_16x16x32_bf16 a[116:119], a[184:187], v[136:139], a[116:119]
    ds_read_b128 a[220:223], v11 offset:0
    v_cvt_pk_bf16_f32 v175, v214, v215
    v_mfma_f32_16x16x32_bf16 a[116:119], a[188:191], v[140:143], a[116:119]
    buffer_load_dword v221, v235, s[20:23], 0 offen
    v_mfma_f32_16x16x32_bf16 v[212:215], a[224:227], v[112:115], v[204:207]
    v_exp_f32 v208, v208
    v_mfma_f32_16x16x32_bf16 v[212:215], a[228:231], v[116:119], v[212:215]
    v_exp_f32 v209, v209
    v_mfma_f32_16x16x32_bf16 v[212:215], a[232:235], v[120:123], v[212:215]
    v_exp_f32 v210, v210
    v_mfma_f32_16x16x32_bf16 v[212:215], a[236:239], v[124:127], v[212:215]
    v_exp_f32 v211, v211
    v_mfma_f32_16x16x32_bf16 a[120:123], a[184:187], v[144:147], a[120:123]
    ds_read_b64_tr_b16 a[168:169], v21 offset:49152
    v_cvt_pk_bf16_f32 v182, v208, v209
    v_mfma_f32_16x16x32_bf16 a[120:123], a[188:191], v[148:151], a[120:123]
    ds_read_b64_tr_b16 a[170:171], v21 offset:53248
    v_add_u32 v235, 2560, v235
    v_mfma_f32_16x16x32_bf16 a[124:127], a[184:187], v[152:155], a[124:127]
    ds_read_b128 a[224:227], v8 offset:4096
    v_cvt_pk_bf16_f32 v183, v210, v211
    v_mfma_f32_16x16x32_bf16 a[124:127], a[188:191], v[156:159], a[124:127]
    s_waitcnt lgkmcnt(3)
    buffer_load_dwordx4 v38, s[8:11], s40 offen offset:2048 lds
    v_mfma_f32_16x16x32_bf16 v[208:211], a[208:211], v[64:67], v[192:195]
    v_exp_f32 v212, v212
    v_mfma_f32_16x16x32_bf16 v[208:211], a[212:215], v[68:71], v[208:211]
    v_exp_f32 v213, v213
    v_mfma_f32_16x16x32_bf16 v[208:211], a[216:219], v[72:75], v[208:211]
    v_exp_f32 v214, v214
    v_mfma_f32_16x16x32_bf16 v[208:211], a[220:223], v[76:79], v[208:211]
    v_exp_f32 v215, v215
    v_mfma_f32_16x16x32_bf16 a[0:3], a[160:163], v[160:163], a[0:3]
    ds_read_b64_tr_b16 a[172:173], v21 offset:57344
    v_cvt_pk_bf16_f32 v190, v212, v213
    v_mfma_f32_16x16x32_bf16 a[0:3], a[164:167], v[164:167], a[0:3]
    ds_read_b64_tr_b16 a[174:175], v21 offset:61440
    v_lshlrev_b32 v244, 16, v240
    v_mfma_f32_16x16x32_bf16 a[4:7], a[160:163], v[168:171], a[4:7]
    ds_read_b128 a[228:231], v9 offset:4096
    v_cvt_pk_bf16_f32 v191, v214, v215
    v_mfma_f32_16x16x32_bf16 a[4:7], a[164:167], v[172:175], a[4:7]
    v_and_b32 v245, 0xffff0000, v240
    v_fmac_f32 v224, v2, v244
    v_mfma_f32_16x16x32_bf16 v[212:215], a[208:211], v[80:83], v[196:199]
    v_exp_f32 v208, v208
    v_mfma_f32_16x16x32_bf16 v[212:215], a[212:215], v[84:87], v[212:215]
    v_exp_f32 v209, v209
    v_mfma_f32_16x16x32_bf16 v[212:215], a[216:219], v[88:91], v[212:215]
    v_exp_f32 v210, v210
    v_mfma_f32_16x16x32_bf16 v[212:215], a[220:223], v[92:95], v[212:215]
    v_exp_f32 v211, v211
    v_mfma_f32_16x16x32_bf16 a[8:11], a[160:163], v[176:179], a[8:11]
    ds_read_b64_tr_b16 a[176:177], v22 offset:49152
    v_cvt_pk_bf16_f32 v128, v208, v209
    v_mfma_f32_16x16x32_bf16 a[8:11], a[164:167], v[180:183], a[8:11]
    ds_read_b64_tr_b16 a[178:179], v22 offset:53248
    v_fmac_f32 v225, v2, v245
    v_mfma_f32_16x16x32_bf16 a[12:15], a[160:163], v[184:187], a[12:15]
    ds_read_b128 a[232:235], v10 offset:4096
    v_cvt_pk_bf16_f32 v129, v210, v211
    v_mfma_f32_16x16x32_bf16 a[12:15], a[164:167], v[188:191], a[12:15]
    s_waitcnt lgkmcnt(3)
    buffer_load_dwordx4 v39, s[8:11], s40 offen offset:3072 lds
    v_mfma_f32_16x16x32_bf16 v[208:211], a[208:211], v[96:99], v[200:203]
Ltour5:
    s_cbranch_execz Ltour9
    v_exp_f32 v212, v212
    v_mfma_f32_16x16x32_bf16 v[208:211], a[212:215], v[100:103], v[208:211]
    s_add_u32 s40, s40, 16384
    v_exp_f32 v213, v213
    v_mfma_f32_16x16x32_bf16 v[208:211], a[216:219], v[104:107], v[208:211]
    v_exp_f32 v214, v214
    v_mfma_f32_16x16x32_bf16 v[208:211], a[220:223], v[108:111], v[208:211]
    v_exp_f32 v215, v215
    v_mfma_f32_16x16x32_bf16 a[16:19], a[168:171], v[160:163], a[16:19]
    ds_read_b64_tr_b16 a[180:181], v22 offset:57344
    v_cvt_pk_bf16_f32 v136, v212, v213
    v_mfma_f32_16x16x32_bf16 a[16:19], a[172:175], v[164:167], a[16:19]
    ds_read_b64_tr_b16 a[182:183], v22 offset:61440
    v_lshlrev_b32 v246, 16, v241
    v_mfma_f32_16x16x32_bf16 a[20:23], a[168:171], v[168:171], a[20:23]
    ds_read_b128 a[236:239], v11 offset:4096
    v_cvt_pk_bf16_f32 v137, v214, v215
    v_mfma_f32_16x16x32_bf16 a[20:23], a[172:175], v[172:175], a[20:23]
    v_and_b32 v247, 0xffff0000, v241
    v_fmac_f32 v226, v2, v246
    v_smfmac_f32_16x16x64_bf16 a[192:195], v[52:55], v[160:167], v50
    v_mfma_f32_16x16x32_bf16 v[212:215], a[208:211], v[112:115], v[204:207]
    v_exp_f32 v208, v208
    v_mfma_f32_16x16x32_bf16 v[212:215], a[212:215], v[116:119], v[212:215]
    s_add_u32 m0, s42, 81920
    v_exp_f32 v209, v209
    v_mfma_f32_16x16x32_bf16 v[212:215], a[216:219], v[120:123], v[212:215]
    v_exp_f32 v210, v210
    v_mfma_f32_16x16x32_bf16 v[212:215], a[220:223], v[124:127], v[212:215]
    v_exp_f32 v211, v211
    v_mfma_f32_16x16x32_bf16 a[24:27], a[168:171], v[176:179], a[24:27]
    ds_read_b64_tr_b16 a[184:185], v23 offset:49152
    v_cvt_pk_bf16_f32 v144, v208, v209
    v_mfma_f32_16x16x32_bf16 a[24:27], a[172:175], v[180:183], a[24:27]
    ds_read_b64_tr_b16 a[186:187], v23 offset:53248
    v_fmac_f32 v227, v2, v247
    v_mfma_f32_16x16x32_bf16 a[28:31], a[168:171], v[184:187], a[28:31]
    ds_read_b128 a[208:211], v8 offset:8192
    v_cvt_pk_bf16_f32 v145, v210, v211
    v_mfma_f32_16x16x32_bf16 a[28:31], a[172:175], v[188:191], a[28:31]
    s_waitcnt lgkmcnt(3)
    buffer_load_dwordx4 v40, s[12:15], s41 offen lds
    v_mfma_f32_16x16x32_bf16 v[208:211], a[224:227], v[64:67], v[192:195]
    v_exp_f32 v212, v212
    v_mfma_f32_16x16x32_bf16 v[208:211], a[228:231], v[68:71], v[208:211]
    v_exp_f32 v213, v213
    v_mfma_f32_16x16x32_bf16 v[208:211], a[232:235], v[72:75], v[208:211]
    v_exp_f32 v214, v214
    v_mfma_f32_16x16x32_bf16 v[208:211], a[236:239], v[76:79], v[208:211]
    v_exp_f32 v215, v215
    v_mfma_f32_16x16x32_bf16 a[32:35], a[176:179], v[160:163], a[32:35]
    ds_read_b64_tr_b16 a[188:189], v23 offset:57344
    v_cvt_pk_bf16_f32 v152, v212, v213
    v_mfma_f32_16x16x32_bf16 a[32:35], a[180:183], v[164:167], a[32:35]
    ds_read_b64_tr_b16 a[190:191], v23 offset:61440
    v_lshlrev_b32 v244, 16, v242
    v_mfma_f32_16x16x32_bf16 a[36:39], a[176:179], v[168:171], a[36:39]
    ds_read_b128 a[212:215], v9 offset:8192
    v_cvt_pk_bf16_f32 v153, v214, v215
    v_mfma_f32_16x16x32_bf16 a[36:39], a[180:183], v[172:175], a[36:39]
    v_and_b32 v245, 0xffff0000, v242
    v_fmac_f32 v228, v2, v244
    v_smfmac_f32_16x16x64_bf16 a[196:199], v[52:55], v[168:175], v50
    v_mfma_f32_16x16x32_bf16 v[212:215], a[224:227], v[80:83], v[196:199]
    v_exp_f32 v208, v208
    v_mfma_f32_16x16x32_bf16 v[212:215], a[228:231], v[84:87], v[212:215]
    v_exp_f32 v209, v209
    v_mfma_f32_16x16x32_bf16 v[212:215], a[232:235], v[88:91], v[212:215]
    v_exp_f32 v210, v210
    v_mfma_f32_16x16x32_bf16 v[212:215], a[236:239], v[92:95], v[212:215]
    v_exp_f32 v211, v211
    v_mfma_f32_16x16x32_bf16 a[40:43], a[176:179], v[176:179], a[40:43]
    ds_read_b64_tr_b16 a[160:161], v24 offset:49152
    v_cvt_pk_bf16_f32 v130, v208, v209
    v_mfma_f32_16x16x32_bf16 a[40:43], a[180:183], v[180:183], a[40:43]
    ds_read_b64_tr_b16 a[162:163], v24 offset:53248
    v_fmac_f32 v229, v2, v245
    v_mfma_f32_16x16x32_bf16 a[44:47], a[176:179], v[184:187], a[44:47]
    ds_read_b128 a[216:219], v10 offset:8192
    v_cvt_pk_bf16_f32 v131, v210, v211
    v_mfma_f32_16x16x32_bf16 a[44:47], a[180:183], v[188:191], a[44:47]
    s_waitcnt lgkmcnt(3)
    buffer_load_dwordx4 v41, s[12:15], s41 offen offset:1024 lds
    v_mfma_f32_16x16x32_bf16 v[208:211], a[224:227], v[96:99], v[200:203]
    v_exp_f32 v212, v212
    v_mfma_f32_16x16x32_bf16 v[208:211], a[228:231], v[100:103], v[208:211]
    v_exp_f32 v213, v213
    v_mfma_f32_16x16x32_bf16 v[208:211], a[232:235], v[104:107], v[208:211]
    v_exp_f32 v214, v214
    v_mfma_f32_16x16x32_bf16 v[208:211], a[236:239], v[108:111], v[208:211]
    v_exp_f32 v215, v215
    v_mfma_f32_16x16x32_bf16 a[48:51], a[184:187], v[160:163], a[48:51]
    ds_read_b64_tr_b16 a[164:165], v24 offset:57344
    v_cvt_pk_bf16_f32 v138, v212, v213
    v_mfma_f32_16x16x32_bf16 a[48:51], a[188:191], v[164:167], a[48:51]
    ds_read_b64_tr_b16 a[166:167], v24 offset:61440
    v_lshlrev_b32 v246, 16, v243
    v_mfma_f32_16x16x32_bf16 a[52:55], a[184:187], v[168:171], a[52:55]
    ds_read_b128 a[220:223], v11 offset:8192
    v_cvt_pk_bf16_f32 v139, v214, v215
    v_mfma_f32_16x16x32_bf16 a[52:55], a[188:191], v[172:175], a[52:55]
    v_and_b32 v247, 0xffff0000, v243
    v_fmac_f32 v230, v2, v246
    v_smfmac_f32_16x16x64_bf16 a[200:203], v[52:55], v[176:183], v50
    v_mfma_f32_16x16x32_bf16 v[212:215], a[224:227], v[112:115], v[204:207]
    v_exp_f32 v208, v208
    v_mfma_f32_16x16x32_bf16 v[212:215], a[228:231], v[116:119], v[212:215]
    v_exp_f32 v209, v209
    v_mfma_f32_16x16x32_bf16 v[212:215], a[232:235], v[120:123], v[212:215]
    v_exp_f32 v210, v210
    v_mfma_f32_16x16x32_bf16 v[212:215], a[236:239], v[124:127], v[212:215]
    v_exp_f32 v211, v211
    v_mfma_f32_16x16x32_bf16 a[56:59], a[184:187], v[176:179], a[56:59]
    ds_read_b64_tr_b16 a[168:169], v25 offset:49152
    v_cvt_pk_bf16_f32 v146, v208, v209
    v_mfma_f32_16x16x32_bf16 a[56:59], a[188:191], v[180:183], a[56:59]
    ds_read_b64_tr_b16 a[170:171], v25 offset:53248
    v_fmac_f32 v231, v2, v247
    v_mfma_f32_16x16x32_bf16 a[60:63], a[184:187], v[184:187], a[60:63]
    ds_read_b128 a[224:227], v8 offset:12288
    v_cvt_pk_bf16_f32 v147, v210, v211
    v_mfma_f32_16x16x32_bf16 a[60:63], a[188:191], v[188:191], a[60:63]
    s_waitcnt lgkmcnt(3)
    buffer_load_dwordx4 v40, s[12:15], s41 offen offset:2048 lds
    v_mfma_f32_16x16x32_bf16 v[208:211], a[208:211], v[64:67], v[192:195]
    v_exp_f32 v212, v212
    v_mfma_f32_16x16x32_bf16 v[208:211], a[212:215], v[68:71], v[208:211]
    v_exp_f32 v213, v213
    v_mfma_f32_16x16x32_bf16 v[208:211], a[216:219], v[72:75], v[208:211]
    v_exp_f32 v214, v214
    v_mfma_f32_16x16x32_bf16 v[208:211], a[220:223], v[76:79], v[208:211]
    v_exp_f32 v215, v215
    v_mfma_f32_16x16x32_bf16 a[64:67], a[160:163], v[160:163], a[64:67]
    ds_read_b64_tr_b16 a[172:173], v25 offset:57344
    v_cvt_pk_bf16_f32 v154, v212, v213
    v_mfma_f32_16x16x32_bf16 a[64:67], a[164:167], v[164:167], a[64:67]
    ds_read_b64_tr_b16 a[174:175], v25 offset:61440
    v_mov_b32 v2, v3
    v_mfma_f32_16x16x32_bf16 a[68:71], a[160:163], v[168:171], a[68:71]
    ds_read_b128 a[228:231], v9 offset:12288
    v_cvt_pk_bf16_f32 v155, v214, v215
    v_mfma_f32_16x16x32_bf16 a[68:71], a[164:167], v[172:175], a[68:71]
    v_mov_b32 v3, v4
    v_mov_b32 v4, v5
    v_smfmac_f32_16x16x64_bf16 a[204:207], v[52:55], v[184:191], v50
    v_mfma_f32_16x16x32_bf16 v[212:215], a[208:211], v[80:83], v[196:199]
    v_exp_f32 v208, v208
    v_mfma_f32_16x16x32_bf16 v[212:215], a[212:215], v[84:87], v[212:215]
    v_exp_f32 v209, v209
    v_mfma_f32_16x16x32_bf16 v[212:215], a[216:219], v[88:91], v[212:215]
    v_exp_f32 v210, v210
    v_mfma_f32_16x16x32_bf16 v[212:215], a[220:223], v[92:95], v[212:215]
    v_exp_f32 v211, v211
    v_mfma_f32_16x16x32_bf16 a[72:75], a[160:163], v[176:179], a[72:75]
    ds_read_b64_tr_b16 a[176:177], v26 offset:49152
    v_cvt_pk_bf16_f32 v132, v208, v209
    v_mfma_f32_16x16x32_bf16 a[72:75], a[164:167], v[180:183], a[72:75]
    ds_read_b64_tr_b16 a[178:179], v26 offset:53248
    v_mov_b32 v5, v6
    v_mfma_f32_16x16x32_bf16 a[76:79], a[160:163], v[184:187], a[76:79]
    ds_read_b128 a[232:235], v10 offset:12288
    v_cvt_pk_bf16_f32 v133, v210, v211
    v_mfma_f32_16x16x32_bf16 a[76:79], a[164:167], v[188:191], a[76:79]
    s_waitcnt lgkmcnt(3)
    buffer_load_dwordx4 v41, s[12:15], s41 offen offset:3072 lds
    v_mfma_f32_16x16x32_bf16 v[208:211], a[208:211], v[96:99], v[200:203]
    v_exp_f32 v212, v212
    v_mfma_f32_16x16x32_bf16 v[208:211], a[212:215], v[100:103], v[208:211]
    s_add_u32 s41, s41, 16384
    v_exp_f32 v213, v213
    v_mfma_f32_16x16x32_bf16 v[208:211], a[216:219], v[104:107], v[208:211]
    v_exp_f32 v214, v214
    v_mfma_f32_16x16x32_bf16 v[208:211], a[220:223], v[108:111], v[208:211]
    v_exp_f32 v215, v215
    v_mfma_f32_16x16x32_bf16 a[80:83], a[168:171], v[160:163], a[80:83]
    ds_read_b64_tr_b16 a[180:181], v26 offset:57344
    v_cvt_pk_bf16_f32 v140, v212, v213
    v_mfma_f32_16x16x32_bf16 a[80:83], a[172:175], v[164:167], a[80:83]
    ds_read_b64_tr_b16 a[182:183], v26 offset:61440
    v_mfma_f32_16x16x32_bf16 a[84:87], a[168:171], v[168:171], a[84:87]
    ds_read_b128 a[236:239], v11 offset:12288
    v_cvt_pk_bf16_f32 v141, v214, v215
    v_mfma_f32_16x16x32_bf16 a[84:87], a[172:175], v[172:175], a[84:87]
    s_waitcnt vmcnt(10)
    s_barrier
    v_mfma_f32_16x16x32_bf16 v[212:215], a[208:211], v[112:115], v[204:207]
    v_exp_f32 v208, v208
    v_mfma_f32_16x16x32_bf16 v[212:215], a[212:215], v[116:119], v[212:215]
    s_add_u32 m0, s42, 49152
    v_exp_f32 v209, v209
    v_mfma_f32_16x16x32_bf16 v[212:215], a[216:219], v[120:123], v[212:215]
    v_exp_f32 v210, v210
    v_mfma_f32_16x16x32_bf16 v[212:215], a[220:223], v[124:127], v[212:215]
    v_exp_f32 v211, v211
    v_mfma_f32_16x16x32_bf16 a[88:91], a[168:171], v[176:179], a[88:91]
    ds_read_b64_tr_b16 a[184:185], v27 offset:49152
    v_cvt_pk_bf16_f32 v148, v208, v209
    v_mfma_f32_16x16x32_bf16 a[88:91], a[172:175], v[180:183], a[88:91]
    ds_read_b64_tr_b16 a[186:187], v27 offset:53248
    v_mfma_f32_16x16x32_bf16 a[92:95], a[168:171], v[184:187], a[92:95]
    ds_read_b128 a[208:211], v8 offset:16384
    v_cvt_pk_bf16_f32 v149, v210, v211
    v_mfma_f32_16x16x32_bf16 a[92:95], a[172:175], v[188:191], a[92:95]
    s_waitcnt lgkmcnt(3)
    buffer_load_dwordx4 v36, s[8:11], s40 offen lds
    v_mfma_f32_16x16x32_bf16 v[208:211], a[224:227], v[64:67], v[192:195]
    v_exp_f32 v212, v212
    v_mfma_f32_16x16x32_bf16 v[208:211], a[228:231], v[68:71], v[208:211]
    v_exp_f32 v213, v213
    v_mfma_f32_16x16x32_bf16 v[208:211], a[232:235], v[72:75], v[208:211]
    v_exp_f32 v214, v214
    v_mfma_f32_16x16x32_bf16 v[208:211], a[236:239], v[76:79], v[208:211]
    v_exp_f32 v215, v215
    v_mfma_f32_16x16x32_bf16 a[96:99], a[176:179], v[160:163], a[96:99]
    ds_read_b64_tr_b16 a[188:189], v27 offset:57344
    v_cvt_pk_bf16_f32 v156, v212, v213
    v_mfma_f32_16x16x32_bf16 a[96:99], a[180:183], v[164:167], a[96:99]
    ds_read_b64_tr_b16 a[190:191], v27 offset:61440
    v_mfma_f32_16x16x32_bf16 a[100:103], a[176:179], v[168:171], a[100:103]
    ds_read_b128 a[212:215], v9 offset:16384
    v_cvt_pk_bf16_f32 v157, v214, v215
    v_mfma_f32_16x16x32_bf16 a[100:103], a[180:183], v[172:175], a[100:103]
    buffer_load_dword v216, v237, s[28:31], s52 offen
    v_mfma_f32_16x16x32_bf16 v[212:215], a[224:227], v[80:83], v[196:199]
    v_exp_f32 v208, v208
    v_mfma_f32_16x16x32_bf16 v[212:215], a[228:231], v[84:87], v[212:215]
    s_sub_u32 s39, s39, 36864
    v_exp_f32 v209, v209
    v_mfma_f32_16x16x32_bf16 v[212:215], a[232:235], v[88:91], v[212:215]
    s_sub_u32 s38, s38, 4608
    v_exp_f32 v210, v210
    v_mfma_f32_16x16x32_bf16 v[212:215], a[236:239], v[92:95], v[212:215]
    s_add_u32 s52, s52, 2304
    v_exp_f32 v211, v211
    v_mfma_f32_16x16x32_bf16 a[104:107], a[176:179], v[176:179], a[104:107]
    ds_read_b64_tr_b16 a[160:161], v20 offset:0
    v_cvt_pk_bf16_f32 v134, v208, v209
    v_mfma_f32_16x16x32_bf16 a[104:107], a[180:183], v[180:183], a[104:107]
    ds_read_b64_tr_b16 a[162:163], v20 offset:4096
    v_mfma_f32_16x16x32_bf16 a[108:111], a[176:179], v[184:187], a[108:111]
    ds_read_b128 a[216:219], v10 offset:16384
    v_cvt_pk_bf16_f32 v135, v210, v211
    v_mfma_f32_16x16x32_bf16 a[108:111], a[180:183], v[188:191], a[108:111]
    s_waitcnt lgkmcnt(3)
    buffer_load_dwordx4 v37, s[8:11], s40 offen offset:1024 lds
    v_mfma_f32_16x16x32_bf16 v[208:211], a[224:227], v[96:99], v[200:203]
    v_exp_f32 v212, v212
    v_mfma_f32_16x16x32_bf16 v[208:211], a[228:231], v[100:103], v[208:211]
    v_exp_f32 v213, v213
    v_mfma_f32_16x16x32_bf16 v[208:211], a[232:235], v[104:107], v[208:211]
    v_exp_f32 v214, v214
    v_mfma_f32_16x16x32_bf16 v[208:211], a[236:239], v[108:111], v[208:211]
    v_exp_f32 v215, v215
    v_mfma_f32_16x16x32_bf16 a[112:115], a[184:187], v[160:163], a[112:115]
    ds_read_b64_tr_b16 a[164:165], v20 offset:8192
    v_cvt_pk_bf16_f32 v142, v212, v213
    v_mfma_f32_16x16x32_bf16 a[112:115], a[188:191], v[164:167], a[112:115]
    ds_read_b64_tr_b16 a[166:167], v20 offset:12288
    v_mfma_f32_16x16x32_bf16 a[116:119], a[184:187], v[168:171], a[116:119]
    ds_read_b128 a[220:223], v11 offset:16384
    v_cvt_pk_bf16_f32 v143, v214, v215
    v_mfma_f32_16x16x32_bf16 a[116:119], a[188:191], v[172:175], a[116:119]
    v_mfma_f32_16x16x32_bf16 v[212:215], a[224:227], v[112:115], v[204:207]
    v_exp_f32 v208, v208
    v_mfma_f32_16x16x32_bf16 v[212:215], a[228:231], v[116:119], v[212:215]
    v_exp_f32 v209, v209
    v_mfma_f32_16x16x32_bf16 v[212:215], a[232:235], v[120:123], v[212:215]
    v_exp_f32 v210, v210
    v_mfma_f32_16x16x32_bf16 v[212:215], a[236:239], v[124:127], v[212:215]
    v_exp_f32 v211, v211
    v_mfma_f32_16x16x32_bf16 a[120:123], a[184:187], v[176:179], a[120:123]
    ds_read_b64_tr_b16 a[168:169], v21 offset:0
    v_cvt_pk_bf16_f32 v150, v208, v209
    v_mfma_f32_16x16x32_bf16 a[120:123], a[188:191], v[180:183], a[120:123]
    ds_read_b64_tr_b16 a[170:171], v21 offset:4096
    v_mfma_f32_16x16x32_bf16 a[124:127], a[184:187], v[184:187], a[124:127]
    ds_read_b128 a[224:227], v8 offset:20480
    v_cvt_pk_bf16_f32 v151, v210, v211
    v_mfma_f32_16x16x32_bf16 a[124:127], a[188:191], v[188:191], a[124:127]
    s_waitcnt lgkmcnt(3)
    buffer_load_dwordx4 v38, s[8:11], s40 offen offset:2048 lds
    s_sub_u32 s43, s43, 1
    s_cmp_lg_u32 s43, 0
    s_cbranch_scc1 Lattn_loop
    v_mfma_f32_16x16x32_bf16 v[208:211], a[208:211], v[64:67], v[192:195]
    s_lshl_b32 s38, s3, 6
    v_exp_f32 v212, v212
    v_mfma_f32_16x16x32_bf16 v[208:211], a[212:215], v[68:71], v[208:211]
    s_add_u32 s38, s38, 131136
    v_exp_f32 v213, v213
    v_mfma_f32_16x16x32_bf16 v[208:211], a[216:219], v[72:75], v[208:211]
    v_exp_f32 v214, v214
    v_mfma_f32_16x16x32_bf16 v[208:211], a[220:223], v[76:79], v[208:211]
    s_add_u32 s57, s58, 0
    v_exp_f32 v215, v215
    v_mfma_f32_16x16x32_bf16 a[0:3], a[160:163], v[128:131], a[0:3]
    ds_read_b64_tr_b16 a[172:173], v21 offset:8192
    v_cvt_pk_bf16_f32 v158, v212, v213
    v_mfma_f32_16x16x32_bf16 a[0:3], a[164:167], v[132:135], a[0:3]
    ds_read_b64_tr_b16 a[174:175], v21 offset:12288
    v_permlane32_swap_b32 v224, v228
    v_mfma_f32_16x16x32_bf16 a[4:7], a[160:163], v[136:139], a[4:7]
    ds_read_b128 a[228:231], v9 offset:20480
    v_cvt_pk_bf16_f32 v159, v214, v215
    v_mfma_f32_16x16x32_bf16 a[4:7], a[164:167], v[140:143], a[4:7]
    buffer_load_dwordx4 a[128:131], v254, s[80:83], s57 offen
    v_mfma_f32_16x16x32_bf16 v[212:215], a[208:211], v[80:83], v[196:199]
    v_exp_f32 v208, v208
    v_mfma_f32_16x16x32_bf16 v[212:215], a[212:215], v[84:87], v[212:215]
    v_exp_f32 v209, v209
    v_mfma_f32_16x16x32_bf16 v[212:215], a[216:219], v[88:91], v[212:215]
    v_exp_f32 v210, v210
    v_mfma_f32_16x16x32_bf16 v[212:215], a[220:223], v[92:95], v[212:215]
    v_exp_f32 v211, v211
    v_mfma_f32_16x16x32_bf16 a[8:11], a[160:163], v[144:147], a[8:11]
    ds_read_b64_tr_b16 a[176:177], v22 offset:0
    v_cvt_pk_bf16_f32 v160, v208, v209
    v_mfma_f32_16x16x32_bf16 a[8:11], a[164:167], v[148:151], a[8:11]
    ds_read_b64_tr_b16 a[178:179], v22 offset:4096
    v_permlane32_swap_b32 v225, v229
    v_mfma_f32_16x16x32_bf16 a[12:15], a[160:163], v[152:155], a[12:15]
    ds_read_b128 a[232:235], v10 offset:20480
    v_cvt_pk_bf16_f32 v161, v210, v211
    v_mfma_f32_16x16x32_bf16 a[12:15], a[164:167], v[156:159], a[12:15]
    s_waitcnt lgkmcnt(3)
    buffer_load_dwordx4 v39, s[8:11], s40 offen offset:3072 lds
    v_mfma_f32_16x16x32_bf16 v[208:211], a[208:211], v[96:99], v[200:203]
    v_exp_f32 v212, v212
    v_mfma_f32_16x16x32_bf16 v[208:211], a[212:215], v[100:103], v[208:211]
    s_add_u32 s40, s40, 16384
    v_exp_f32 v213, v213
    v_mfma_f32_16x16x32_bf16 v[208:211], a[216:219], v[104:107], v[208:211]
    v_exp_f32 v214, v214
    v_mfma_f32_16x16x32_bf16 v[208:211], a[220:223], v[108:111], v[208:211]
    v_exp_f32 v215, v215
    v_mfma_f32_16x16x32_bf16 a[16:19], a[168:171], v[128:131], a[16:19]
    ds_read_b64_tr_b16 a[180:181], v22 offset:8192
    v_cvt_pk_bf16_f32 v168, v212, v213
    v_mfma_f32_16x16x32_bf16 a[16:19], a[172:175], v[132:135], a[16:19]
    ds_read_b64_tr_b16 a[182:183], v22 offset:12288
    v_permlane32_swap_b32 v226, v230
    v_mfma_f32_16x16x32_bf16 a[20:23], a[168:171], v[136:139], a[20:23]
    ds_read_b128 a[236:239], v11 offset:20480
    v_cvt_pk_bf16_f32 v169, v214, v215
    v_mfma_f32_16x16x32_bf16 a[20:23], a[172:175], v[140:143], a[20:23]
    v_permlane32_swap_b32 v227, v231
    v_add_f32 v224, v224, v228
    v_smfmac_f32_16x16x64_bf16 a[192:195], v[52:55], v[128:135], v50
    v_mfma_f32_16x16x32_bf16 v[212:215], a[208:211], v[112:115], v[204:207]
    v_exp_f32 v208, v208
    v_mfma_f32_16x16x32_bf16 v[212:215], a[212:215], v[116:119], v[212:215]
    s_add_u32 m0, s42, 98304
    v_exp_f32 v209, v209
    v_mfma_f32_16x16x32_bf16 v[212:215], a[216:219], v[120:123], v[212:215]
    v_exp_f32 v210, v210
    v_mfma_f32_16x16x32_bf16 v[212:215], a[220:223], v[124:127], v[212:215]
    v_exp_f32 v211, v211
    v_mfma_f32_16x16x32_bf16 a[24:27], a[168:171], v[144:147], a[24:27]
    ds_read_b64_tr_b16 a[184:185], v23 offset:0
    v_cvt_pk_bf16_f32 v176, v208, v209
    v_mfma_f32_16x16x32_bf16 a[24:27], a[172:175], v[148:151], a[24:27]
    ds_read_b64_tr_b16 a[186:187], v23 offset:4096
    v_add_f32 v225, v225, v229
    v_mfma_f32_16x16x32_bf16 a[28:31], a[168:171], v[152:155], a[28:31]
    ds_read_b128 a[208:211], v8 offset:24576
    v_cvt_pk_bf16_f32 v177, v210, v211
    v_mfma_f32_16x16x32_bf16 a[28:31], a[172:175], v[156:159], a[28:31]
    s_waitcnt lgkmcnt(3)
    buffer_load_dwordx4 v40, s[12:15], s41 offen lds
    v_mfma_f32_16x16x32_bf16 v[208:211], a[224:227], v[64:67], v[192:195]
    v_exp_f32 v212, v212
    v_mfma_f32_16x16x32_bf16 v[208:211], a[228:231], v[68:71], v[208:211]
    v_exp_f32 v213, v213
    v_mfma_f32_16x16x32_bf16 v[208:211], a[232:235], v[72:75], v[208:211]
    v_exp_f32 v214, v214
    v_mfma_f32_16x16x32_bf16 v[208:211], a[236:239], v[76:79], v[208:211]
    s_add_u32 s57, s58, 589824
    v_exp_f32 v215, v215
    v_mfma_f32_16x16x32_bf16 a[32:35], a[176:179], v[128:131], a[32:35]
    ds_read_b64_tr_b16 a[188:189], v23 offset:8192
    v_cvt_pk_bf16_f32 v184, v212, v213
    v_mfma_f32_16x16x32_bf16 a[32:35], a[180:183], v[132:135], a[32:35]
    ds_read_b64_tr_b16 a[190:191], v23 offset:12288
    v_add_f32 v226, v226, v230
    v_mfma_f32_16x16x32_bf16 a[36:39], a[176:179], v[136:139], a[36:39]
    ds_read_b128 a[212:215], v9 offset:24576
    v_cvt_pk_bf16_f32 v185, v214, v215
    v_mfma_f32_16x16x32_bf16 a[36:39], a[180:183], v[140:143], a[36:39]
    buffer_load_dwordx4 a[132:135], v254, s[80:83], s57 offen
    v_smfmac_f32_16x16x64_bf16 a[196:199], v[52:55], v[136:143], v50
    v_mfma_f32_16x16x32_bf16 v[212:215], a[224:227], v[80:83], v[196:199]
    v_exp_f32 v208, v208
    v_mfma_f32_16x16x32_bf16 v[212:215], a[228:231], v[84:87], v[212:215]
    v_exp_f32 v209, v209
    v_mfma_f32_16x16x32_bf16 v[212:215], a[232:235], v[88:91], v[212:215]
    v_exp_f32 v210, v210
    v_mfma_f32_16x16x32_bf16 v[212:215], a[236:239], v[92:95], v[212:215]
    v_exp_f32 v211, v211
    v_mfma_f32_16x16x32_bf16 a[40:43], a[176:179], v[144:147], a[40:43]
    ds_read_b64_tr_b16 a[160:161], v24 offset:0
    v_cvt_pk_bf16_f32 v162, v208, v209
    v_mfma_f32_16x16x32_bf16 a[40:43], a[180:183], v[148:151], a[40:43]
    ds_read_b64_tr_b16 a[162:163], v24 offset:4096
    v_add_f32 v227, v227, v231
    v_mfma_f32_16x16x32_bf16 a[44:47], a[176:179], v[152:155], a[44:47]
    ds_read_b128 a[216:219], v10 offset:24576
    v_cvt_pk_bf16_f32 v163, v210, v211
    v_mfma_f32_16x16x32_bf16 a[44:47], a[180:183], v[156:159], a[44:47]
    s_waitcnt lgkmcnt(3)
    buffer_load_dwordx4 v41, s[12:15], s41 offen offset:1024 lds
    v_mfma_f32_16x16x32_bf16 v[208:211], a[224:227], v[96:99], v[200:203]
    v_exp_f32 v212, v212
    v_mfma_f32_16x16x32_bf16 v[208:211], a[228:231], v[100:103], v[208:211]
    v_exp_f32 v213, v213
    v_mfma_f32_16x16x32_bf16 v[208:211], a[232:235], v[104:107], v[208:211]
    v_exp_f32 v214, v214
    v_mfma_f32_16x16x32_bf16 v[208:211], a[236:239], v[108:111], v[208:211]
    v_exp_f32 v215, v215
    v_mfma_f32_16x16x32_bf16 a[48:51], a[184:187], v[128:131], a[48:51]
    ds_read_b64_tr_b16 a[164:165], v24 offset:8192
    v_cvt_pk_bf16_f32 v170, v212, v213
    v_mfma_f32_16x16x32_bf16 a[48:51], a[188:191], v[132:135], a[48:51]
    ds_read_b64_tr_b16 a[166:167], v24 offset:12288
    v_and_b32 v244, 1, v1
    v_mfma_f32_16x16x32_bf16 a[52:55], a[184:187], v[136:139], a[52:55]
    ds_read_b128 a[220:223], v11 offset:24576
    v_cvt_pk_bf16_f32 v171, v214, v215
    v_mfma_f32_16x16x32_bf16 a[52:55], a[188:191], v[140:143], a[52:55]
    s_waitcnt vmcnt(15)
    buffer_load_dword v221, v236, s[20:23], 0 offen
    v_smfmac_f32_16x16x64_bf16 a[200:203], v[52:55], v[144:151], v50
    v_mfma_f32_16x16x32_bf16 v[212:215], a[224:227], v[112:115], v[204:207]
    v_exp_f32 v208, v208
    v_mfma_f32_16x16x32_bf16 v[212:215], a[228:231], v[116:119], v[212:215]
    v_exp_f32 v209, v209
    v_mfma_f32_16x16x32_bf16 v[212:215], a[232:235], v[120:123], v[212:215]
    v_exp_f32 v210, v210
    v_mfma_f32_16x16x32_bf16 v[212:215], a[236:239], v[124:127], v[212:215]
    v_exp_f32 v211, v211
    v_mfma_f32_16x16x32_bf16 a[56:59], a[184:187], v[144:147], a[56:59]
    ds_read_b64_tr_b16 a[168:169], v25 offset:0
    v_cvt_pk_bf16_f32 v178, v208, v209
    v_mfma_f32_16x16x32_bf16 a[56:59], a[188:191], v[148:151], a[56:59]
    ds_read_b64_tr_b16 a[170:171], v25 offset:4096
    v_permlane16_swap_b32 v224, v226
    v_mfma_f32_16x16x32_bf16 a[60:63], a[184:187], v[152:155], a[60:63]
    ds_read_b128 a[224:227], v8 offset:28672
    v_cvt_pk_bf16_f32 v179, v210, v211
    v_mfma_f32_16x16x32_bf16 a[60:63], a[188:191], v[156:159], a[60:63]
    s_waitcnt lgkmcnt(3)
    buffer_load_dwordx4 v40, s[12:15], s41 offen offset:2048 lds
    v_mfma_f32_16x16x32_bf16 v[208:211], a[208:211], v[64:67], v[192:195]
    v_exp_f32 v212, v212
    v_mfma_f32_16x16x32_bf16 v[208:211], a[212:215], v[68:71], v[208:211]
    v_exp_f32 v213, v213
    v_mfma_f32_16x16x32_bf16 v[208:211], a[216:219], v[72:75], v[208:211]
    v_exp_f32 v214, v214
    v_mfma_f32_16x16x32_bf16 v[208:211], a[220:223], v[76:79], v[208:211]
    s_add_u32 s57, s58, 1179648
    v_exp_f32 v215, v215
    v_mfma_f32_16x16x32_bf16 a[64:67], a[160:163], v[128:131], a[64:67]
    ds_read_b64_tr_b16 a[172:173], v25 offset:8192
    v_cvt_pk_bf16_f32 v186, v212, v213
    v_mfma_f32_16x16x32_bf16 a[64:67], a[164:167], v[132:135], a[64:67]
    ds_read_b64_tr_b16 a[174:175], v25 offset:12288
    v_permlane16_swap_b32 v225, v227
    v_mfma_f32_16x16x32_bf16 a[68:71], a[160:163], v[136:139], a[68:71]
    ds_read_b128 a[228:231], v9 offset:28672
    v_cvt_pk_bf16_f32 v187, v214, v215
    v_mfma_f32_16x16x32_bf16 a[68:71], a[164:167], v[140:143], a[68:71]
    buffer_load_dwordx4 a[136:139], v254, s[80:83], s57 offen
    v_smfmac_f32_16x16x64_bf16 a[204:207], v[52:55], v[152:159], v50
    v_mfma_f32_16x16x32_bf16 v[212:215], a[208:211], v[80:83], v[196:199]
    v_exp_f32 v208, v208
    v_mfma_f32_16x16x32_bf16 v[212:215], a[212:215], v[84:87], v[212:215]
    v_exp_f32 v209, v209
    v_mfma_f32_16x16x32_bf16 v[212:215], a[216:219], v[88:91], v[212:215]
    v_exp_f32 v210, v210
    v_mfma_f32_16x16x32_bf16 v[212:215], a[220:223], v[92:95], v[212:215]
    v_exp_f32 v211, v211
    v_mfma_f32_16x16x32_bf16 a[72:75], a[160:163], v[144:147], a[72:75]
    ds_read_b64_tr_b16 a[176:177], v26 offset:0
    v_cvt_pk_bf16_f32 v164, v208, v209
    v_mfma_f32_16x16x32_bf16 a[72:75], a[164:167], v[148:151], a[72:75]
    ds_read_b64_tr_b16 a[178:179], v26 offset:4096
    v_lshlrev_b32 v244, 5, v244
    v_mfma_f32_16x16x32_bf16 a[76:79], a[160:163], v[152:155], a[76:79]
    ds_read_b128 a[232:235], v10 offset:28672
    v_cvt_pk_bf16_f32 v165, v210, v211
    v_mfma_f32_16x16x32_bf16 a[76:79], a[164:167], v[156:159], a[76:79]
    s_waitcnt lgkmcnt(3)
    buffer_load_dwordx4 v41, s[12:15], s41 offen offset:3072 lds
    v_mfma_f32_16x16x32_bf16 v[208:211], a[208:211], v[96:99], v[200:203]
    v_exp_f32 v212, v212
    v_mfma_f32_16x16x32_bf16 v[208:211], a[212:215], v[100:103], v[208:211]
    s_add_u32 s41, s41, 16384
    v_exp_f32 v213, v213
    v_mfma_f32_16x16x32_bf16 v[208:211], a[216:219], v[104:107], v[208:211]
    v_exp_f32 v214, v214
    v_mfma_f32_16x16x32_bf16 v[208:211], a[220:223], v[108:111], v[208:211]
    v_exp_f32 v215, v215
    v_mfma_f32_16x16x32_bf16 a[80:83], a[168:171], v[128:131], a[80:83]
    ds_read_b64_tr_b16 a[180:181], v26 offset:8192
    v_cvt_pk_bf16_f32 v172, v212, v213
    v_mfma_f32_16x16x32_bf16 a[80:83], a[172:175], v[132:135], a[80:83]
    ds_read_b64_tr_b16 a[182:183], v26 offset:12288
    v_add_f32 v224, v224, v226
    v_mfma_f32_16x16x32_bf16 a[84:87], a[168:171], v[136:139], a[84:87]
    ds_read_b128 a[236:239], v11 offset:28672
    v_cvt_pk_bf16_f32 v173, v214, v215
    v_mfma_f32_16x16x32_bf16 a[84:87], a[172:175], v[140:143], a[84:87]
    s_waitcnt vmcnt(13)
    s_barrier
    v_mfma_f32_16x16x32_bf16 v[212:215], a[208:211], v[112:115], v[204:207]
    v_exp_f32 v208, v208
    v_mfma_f32_16x16x32_bf16 v[212:215], a[212:215], v[116:119], v[212:215]
    s_add_u32 s49, s45, 1024
    v_exp_f32 v209, v209
    v_mfma_f32_16x16x32_bf16 v[212:215], a[216:219], v[120:123], v[212:215]
    s_add_u32 m0, s42, 0
    v_exp_f32 v210, v210
    v_mfma_f32_16x16x32_bf16 v[212:215], a[220:223], v[124:127], v[212:215]
    v_exp_f32 v211, v211
    v_mfma_f32_16x16x32_bf16 a[88:91], a[168:171], v[144:147], a[88:91]
    ds_read_b64_tr_b16 a[184:185], v27 offset:0
    v_cvt_pk_bf16_f32 v180, v208, v209
    v_mfma_f32_16x16x32_bf16 a[88:91], a[172:175], v[148:151], a[88:91]
    ds_read_b64_tr_b16 a[186:187], v27 offset:4096
    v_add_f32 v225, v225, v227
    v_mfma_f32_16x16x32_bf16 a[92:95], a[168:171], v[152:155], a[92:95]
    ds_read_b128 a[208:211], v8 offset:32768
    v_cvt_pk_bf16_f32 v181, v210, v211
    v_mfma_f32_16x16x32_bf16 a[92:95], a[172:175], v[156:159], a[92:95]
    s_waitcnt lgkmcnt(3)
    buffer_load_dwordx4 v46, s[20:23], s49 offen lds
    v_mfma_f32_16x16x32_bf16 v[208:211], a[224:227], v[64:67], v[192:195]
    v_exp_f32 v212, v212
    v_mfma_f32_16x16x32_bf16 v[208:211], a[228:231], v[68:71], v[208:211]
    v_exp_f32 v213, v213
    v_mfma_f32_16x16x32_bf16 v[208:211], a[232:235], v[72:75], v[208:211]
    v_exp_f32 v214, v214
    v_mfma_f32_16x16x32_bf16 v[208:211], a[236:239], v[76:79], v[208:211]
    s_add_u32 s37, s55, 0
    v_exp_f32 v215, v215
    v_mfma_f32_16x16x32_bf16 a[96:99], a[176:179], v[128:131], a[96:99]
    ds_read_b64_tr_b16 a[188:189], v27 offset:8192
    v_cvt_pk_bf16_f32 v188, v212, v213
    v_mfma_f32_16x16x32_bf16 a[96:99], a[180:183], v[132:135], a[96:99]
    ds_read_b64_tr_b16 a[190:191], v27 offset:12288
    v_lshrrev_b32 v245, 4, v1
    v_mfma_f32_16x16x32_bf16 a[100:103], a[176:179], v[136:139], a[100:103]
    ds_read_b128 a[212:215], v9 offset:32768
    v_cvt_pk_bf16_f32 v189, v214, v215
    v_mfma_f32_16x16x32_bf16 a[100:103], a[180:183], v[140:143], a[100:103]
    buffer_load_dword v239, v238, s[28:31], s37 offen
    v_mfma_f32_16x16x32_bf16 v[212:215], a[224:227], v[80:83], v[196:199]
    v_exp_f32 v208, v208
    v_mfma_f32_16x16x32_bf16 v[212:215], a[228:231], v[84:87], v[212:215]
    v_exp_f32 v209, v209
    v_mfma_f32_16x16x32_bf16 v[212:215], a[232:235], v[88:91], v[212:215]
    v_exp_f32 v210, v210
    v_mfma_f32_16x16x32_bf16 v[212:215], a[236:239], v[92:95], v[212:215]
    v_exp_f32 v211, v211
    v_mfma_f32_16x16x32_bf16 a[104:107], a[176:179], v[144:147], a[104:107]
    ds_read_b64_tr_b16 a[160:161], v20 offset:16384
    v_cvt_pk_bf16_f32 v166, v208, v209
    v_mfma_f32_16x16x32_bf16 a[104:107], a[180:183], v[148:151], a[104:107]
    ds_read_b64_tr_b16 a[162:163], v20 offset:20480
    v_lshl_add_u32 v244, v245, 3, v244
    v_mfma_f32_16x16x32_bf16 a[108:111], a[176:179], v[152:155], a[108:111]
    ds_read_b128 a[216:219], v10 offset:32768
    v_cvt_pk_bf16_f32 v167, v210, v211
    v_mfma_f32_16x16x32_bf16 a[108:111], a[180:183], v[156:159], a[108:111]
    s_waitcnt lgkmcnt(3)
    buffer_load_dwordx4 v47, s[20:23], s49 offen offset:1024 lds
    v_mfma_f32_16x16x32_bf16 v[208:211], a[224:227], v[96:99], v[200:203]
    v_exp_f32 v212, v212
    v_mfma_f32_16x16x32_bf16 v[208:211], a[228:231], v[100:103], v[208:211]
    v_exp_f32 v213, v213
    v_mfma_f32_16x16x32_bf16 v[208:211], a[232:235], v[104:107], v[208:211]
    v_exp_f32 v214, v214
    v_mfma_f32_16x16x32_bf16 v[208:211], a[236:239], v[108:111], v[208:211]
    s_add_u32 s57, s58, 1769472
    v_exp_f32 v215, v215
    v_mfma_f32_16x16x32_bf16 a[112:115], a[184:187], v[128:131], a[112:115]
    ds_read_b64_tr_b16 a[164:165], v20 offset:24576
    v_cvt_pk_bf16_f32 v174, v212, v213
    v_mfma_f32_16x16x32_bf16 a[112:115], a[188:191], v[132:135], a[112:115]
    ds_read_b64_tr_b16 a[166:167], v20 offset:28672
    v_mfma_f32_16x16x32_bf16 a[116:119], a[184:187], v[136:139], a[116:119]
    ds_read_b128 a[220:223], v11 offset:32768
    v_cvt_pk_bf16_f32 v175, v214, v215
    v_mfma_f32_16x16x32_bf16 a[116:119], a[188:191], v[140:143], a[116:119]
    buffer_load_dwordx4 a[140:143], v254, s[80:83], s57 offen
    v_mfma_f32_16x16x32_bf16 v[212:215], a[224:227], v[112:115], v[204:207]
Ltour6:
    s_cbranch_execz Ltour10
    v_exp_f32 v208, v208
    v_mfma_f32_16x16x32_bf16 v[212:215], a[228:231], v[116:119], v[212:215]
    v_exp_f32 v209, v209
    v_mfma_f32_16x16x32_bf16 v[212:215], a[232:235], v[120:123], v[212:215]
    v_exp_f32 v210, v210
    v_mfma_f32_16x16x32_bf16 v[212:215], a[236:239], v[124:127], v[212:215]
    v_exp_f32 v211, v211
    v_mfma_f32_16x16x32_bf16 a[120:123], a[184:187], v[144:147], a[120:123]
    ds_read_b64_tr_b16 a[168:169], v21 offset:16384
    v_cvt_pk_bf16_f32 v182, v208, v209
    v_mfma_f32_16x16x32_bf16 a[120:123], a[188:191], v[148:151], a[120:123]
    ds_read_b64_tr_b16 a[170:171], v21 offset:20480
    v_mfma_f32_16x16x32_bf16 a[124:127], a[184:187], v[152:155], a[124:127]
    ds_read_b128 a[224:227], v8 offset:36864
    v_cvt_pk_bf16_f32 v183, v210, v211
    v_mfma_f32_16x16x32_bf16 a[124:127], a[188:191], v[156:159], a[124:127]
    s_waitcnt lgkmcnt(3)
    buffer_load_dwordx4 v48, s[20:23], s49 offen offset:2048 lds
    v_mfma_f32_16x16x32_bf16 v[208:211], a[208:211], v[64:67], v[192:195]
    v_exp_f32 v212, v212
    v_mfma_f32_16x16x32_bf16 v[208:211], a[212:215], v[68:71], v[208:211]
    v_exp_f32 v213, v213
    v_mfma_f32_16x16x32_bf16 v[208:211], a[216:219], v[72:75], v[208:211]
    v_exp_f32 v214, v214
    v_mfma_f32_16x16x32_bf16 v[208:211], a[220:223], v[76:79], v[208:211]
    s_add_u32 s57, s58, 2359296
    v_exp_f32 v215, v215
    v_mfma_f32_16x16x32_bf16 a[0:3], a[160:163], v[160:163], a[0:3]
    ds_read_b64_tr_b16 a[172:173], v21 offset:24576
    v_cvt_pk_bf16_f32 v190, v212, v213
    v_mfma_f32_16x16x32_bf16 a[0:3], a[164:167], v[164:167], a[0:3]
    ds_read_b64_tr_b16 a[174:175], v21 offset:28672
    v_mov_b32 v63, 0
    v_mfma_f32_16x16x32_bf16 a[4:7], a[160:163], v[168:171], a[4:7]
    ds_read_b128 a[228:231], v9 offset:36864
    v_cvt_pk_bf16_f32 v191, v214, v215
    v_mfma_f32_16x16x32_bf16 a[4:7], a[164:167], v[172:175], a[4:7]
    buffer_load_dwordx4 a[144:147], v254, s[80:83], s57 offen
    v_mfma_f32_16x16x32_bf16 v[212:215], a[208:211], v[80:83], v[196:199]
    v_exp_f32 v208, v208
    v_mfma_f32_16x16x32_bf16 v[212:215], a[212:215], v[84:87], v[212:215]
    v_exp_f32 v209, v209
    v_mfma_f32_16x16x32_bf16 v[212:215], a[216:219], v[88:91], v[212:215]
    v_exp_f32 v210, v210
    v_mfma_f32_16x16x32_bf16 v[212:215], a[220:223], v[92:95], v[212:215]
    v_exp_f32 v211, v211
    v_mfma_f32_16x16x32_bf16 a[8:11], a[160:163], v[176:179], a[8:11]
    ds_read_b64_tr_b16 a[176:177], v22 offset:16384
    v_cvt_pk_bf16_f32 v128, v208, v209
    v_mfma_f32_16x16x32_bf16 a[8:11], a[164:167], v[180:183], a[8:11]
    ds_read_b64_tr_b16 a[178:179], v22 offset:20480
    v_add_f32_dpp v224, v224, v224 row_ror:2 row_mask:0xf bank_mask:0xf
    v_mfma_f32_16x16x32_bf16 a[12:15], a[160:163], v[184:187], a[12:15]
    ds_read_b128 a[232:235], v10 offset:36864
    v_cvt_pk_bf16_f32 v129, v210, v211
    v_mfma_f32_16x16x32_bf16 a[12:15], a[164:167], v[188:191], a[12:15]
    s_waitcnt lgkmcnt(3)
    buffer_load_dwordx4 v49, s[20:23], s49 offen offset:3072 lds
    v_mfma_f32_16x16x32_bf16 v[208:211], a[208:211], v[96:99], v[200:203]
    s_lshr_b32 s39, s2, 5
    v_exp_f32 v212, v212
    v_mfma_f32_16x16x32_bf16 v[208:211], a[212:215], v[100:103], v[208:211]
    s_lshl_b32 s39, s39, 3
    v_exp_f32 v213, v213
    v_mfma_f32_16x16x32_bf16 v[208:211], a[216:219], v[104:107], v[208:211]
    s_and_b32 s43, s2, 7
    v_exp_f32 v214, v214
    v_mfma_f32_16x16x32_bf16 v[208:211], a[220:223], v[108:111], v[208:211]
    s_add_u32 s39, s39, s43
    v_exp_f32 v215, v215
    v_mfma_f32_16x16x32_bf16 a[16:19], a[168:171], v[160:163], a[16:19]
    ds_read_b64_tr_b16 a[180:181], v22 offset:24576
    v_cvt_pk_bf16_f32 v136, v212, v213
    v_mfma_f32_16x16x32_bf16 a[16:19], a[172:175], v[164:167], a[16:19]
    ds_read_b64_tr_b16 a[182:183], v22 offset:28672
    v_add_f32_dpp v225, v225, v225 row_ror:2 row_mask:0xf bank_mask:0xf
    v_mfma_f32_16x16x32_bf16 a[20:23], a[168:171], v[168:171], a[20:23]
    ds_read_b128 a[236:239], v11 offset:36864
    v_cvt_pk_bf16_f32 v137, v214, v215
    v_mfma_f32_16x16x32_bf16 a[20:23], a[172:175], v[172:175], a[20:23]
    buffer_load_dword v253, v63, s[24:27], s54 offen offset:12 sc1
    v_smfmac_f32_16x16x64_bf16 a[192:195], v[52:55], v[160:167], v50
    v_mfma_f32_16x16x32_bf16 v[212:215], a[208:211], v[112:115], v[204:207]
    s_lshl_b32 s39, s39, 2
    v_exp_f32 v208, v208
    v_mfma_f32_16x16x32_bf16 v[212:215], a[212:215], v[116:119], v[212:215]
    s_add_u32 m0, s42, 114688
    v_exp_f32 v209, v209
    v_mfma_f32_16x16x32_bf16 v[212:215], a[216:219], v[120:123], v[212:215]
    s_bfe_u32 s43, s2, 0x20003
    v_exp_f32 v210, v210
    v_mfma_f32_16x16x32_bf16 v[212:215], a[220:223], v[124:127], v[212:215]
    s_add_u32 s39, s39, s43
    v_exp_f32 v211, v211
    v_mfma_f32_16x16x32_bf16 a[24:27], a[168:171], v[176:179], a[24:27]
    ds_read_b64_tr_b16 a[184:185], v23 offset:16384
    v_cvt_pk_bf16_f32 v144, v208, v209
    v_mfma_f32_16x16x32_bf16 a[24:27], a[172:175], v[180:183], a[24:27]
    ds_read_b64_tr_b16 a[186:187], v23 offset:20480
    v_add_f32_dpp v224, v224, v224 row_ror:4 row_mask:0xf bank_mask:0xf
    v_mfma_f32_16x16x32_bf16 a[28:31], a[168:171], v[184:187], a[28:31]
    ds_read_b128 a[208:211], v8 offset:40960
    v_cvt_pk_bf16_f32 v145, v210, v211
    v_mfma_f32_16x16x32_bf16 a[28:31], a[172:175], v[188:191], a[28:31]
    s_waitcnt lgkmcnt(3)
    buffer_load_dwordx4 v40, s[12:15], s41 offen lds
    v_mfma_f32_16x16x32_bf16 v[208:211], a[224:227], v[64:67], v[192:195]
    s_add_u32 s39, s39, 72
    v_exp_f32 v212, v212
    v_mfma_f32_16x16x32_bf16 v[208:211], a[228:231], v[68:71], v[208:211]
    s_cmp_lt_u32 s39, 216
    s_cselect_b32 s43, 0, 2147483648
    v_exp_f32 v213, v213
    v_mfma_f32_16x16x32_bf16 v[208:211], a[232:235], v[72:75], v[208:211]
    s_or_b32 s43, s43, s48
    v_exp_f32 v214, v214
    v_mfma_f32_16x16x32_bf16 v[208:211], a[236:239], v[76:79], v[208:211]
    s_add_u32 s57, s58, 2949120
    v_exp_f32 v215, v215
    v_mfma_f32_16x16x32_bf16 a[32:35], a[176:179], v[160:163], a[32:35]
    ds_read_b64_tr_b16 a[188:189], v23 offset:24576
    v_cvt_pk_bf16_f32 v152, v212, v213
    v_mfma_f32_16x16x32_bf16 a[32:35], a[180:183], v[164:167], a[32:35]
    ds_read_b64_tr_b16 a[190:191], v23 offset:28672
    v_add_f32_dpp v225, v225, v225 row_ror:4 row_mask:0xf bank_mask:0xf
    v_mfma_f32_16x16x32_bf16 a[36:39], a[176:179], v[168:171], a[36:39]
    ds_read_b128 a[212:215], v9 offset:40960
    v_cvt_pk_bf16_f32 v153, v214, v215
    v_mfma_f32_16x16x32_bf16 a[36:39], a[180:183], v[172:175], a[36:39]
    buffer_load_dwordx4 a[148:151], v254, s[80:83], s57 offen
    v_smfmac_f32_16x16x64_bf16 a[196:199], v[52:55], v[168:175], v50
    v_mfma_f32_16x16x32_bf16 v[212:215], a[224:227], v[80:83], v[196:199]
    s_and_b32 s43, s43, 2147483648
    v_exp_f32 v208, v208
    v_mfma_f32_16x16x32_bf16 v[212:215], a[228:231], v[84:87], v[212:215]
    s_sub_u32 s36, s39, 144
    v_exp_f32 v209, v209
    v_mfma_f32_16x16x32_bf16 v[212:215], a[232:235], v[88:91], v[212:215]
    s_cmp_lt_u32 s36, 36
    s_cselect_b32 s36, 1.0, 0
    v_exp_f32 v210, v210
    v_mfma_f32_16x16x32_bf16 v[212:215], a[236:239], v[92:95], v[212:215]
    s_lshr_b32 s44, s39, 1
    v_exp_f32 v211, v211
    v_mfma_f32_16x16x32_bf16 a[40:43], a[176:179], v[176:179], a[40:43]
    ds_read_b64_tr_b16 a[160:161], v24 offset:16384
    v_cvt_pk_bf16_f32 v130, v208, v209
    v_mfma_f32_16x16x32_bf16 a[40:43], a[180:183], v[180:183], a[40:43]
    ds_read_b64_tr_b16 a[162:163], v24 offset:20480
    v_add_f32_dpp v224, v224, v224 row_ror:8 row_mask:0xf bank_mask:0xf
    v_mfma_f32_16x16x32_bf16 a[44:47], a[176:179], v[184:187], a[44:47]
    ds_read_b128 a[216:219], v10 offset:40960
    v_cvt_pk_bf16_f32 v131, v210, v211
    v_mfma_f32_16x16x32_bf16 a[44:47], a[180:183], v[188:191], a[44:47]
    s_waitcnt lgkmcnt(3)
    buffer_load_dwordx4 v41, s[12:15], s41 offen offset:1024 lds
    v_mfma_f32_16x16x32_bf16 v[208:211], a[224:227], v[96:99], v[200:203]
    s_lshl_b32 s44, s44, 6
    v_exp_f32 v212, v212
    v_mfma_f32_16x16x32_bf16 v[208:211], a[228:231], v[100:103], v[208:211]
    s_and_b32 s39, s39, 1
    v_exp_f32 v213, v213
    v_mfma_f32_16x16x32_bf16 v[208:211], a[232:235], v[104:107], v[208:211]
    s_lshl_b32 s39, s39, 3
    v_exp_f32 v214, v214
    v_mfma_f32_16x16x32_bf16 v[208:211], a[236:239], v[108:111], v[208:211]
    s_add_u32 s39, s39, s44
    v_exp_f32 v215, v215
    v_mfma_f32_16x16x32_bf16 a[48:51], a[184:187], v[160:163], a[48:51]
    ds_read_b64_tr_b16 a[164:165], v24 offset:24576
    v_cvt_pk_bf16_f32 v138, v212, v213
    v_mfma_f32_16x16x32_bf16 a[48:51], a[188:191], v[164:167], a[48:51]
    ds_read_b64_tr_b16 a[166:167], v24 offset:28672
    v_add_f32_dpp v225, v225, v225 row_ror:8 row_mask:0xf bank_mask:0xf
    v_mfma_f32_16x16x32_bf16 a[52:55], a[184:187], v[168:171], a[52:55]
    ds_read_b128 a[220:223], v11 offset:40960
    v_cvt_pk_bf16_f32 v139, v214, v215
    v_mfma_f32_16x16x32_bf16 a[52:55], a[188:191], v[172:175], a[52:55]
    v_add_u32 v244, s38, v244
    v_and_b32 v245, 7, v1
    v_smfmac_f32_16x16x64_bf16 a[200:203], v[52:55], v[176:183], v50
    v_mfma_f32_16x16x32_bf16 v[212:215], a[224:227], v[112:115], v[204:207]
    s_add_u32 s39, s39, 16384
    v_exp_f32 v208, v208
    v_mfma_f32_16x16x32_bf16 v[212:215], a[228:231], v[116:119], v[212:215]
    s_or_b32 s39, s39, s43
    v_exp_f32 v209, v209
    v_mfma_f32_16x16x32_bf16 v[212:215], a[232:235], v[120:123], v[212:215]
    s_and_b32 s43, s48, 2147483648
    v_exp_f32 v210, v210
    v_mfma_f32_16x16x32_bf16 v[212:215], a[236:239], v[124:127], v[212:215]
    v_exp_f32 v211, v211
    v_mfma_f32_16x16x32_bf16 a[56:59], a[184:187], v[176:179], a[56:59]
    ds_read_b64_tr_b16 a[168:169], v25 offset:16384
    v_cvt_pk_bf16_f32 v146, v208, v209
    v_mfma_f32_16x16x32_bf16 a[56:59], a[188:191], v[180:183], a[56:59]
    ds_read_b64_tr_b16 a[170:171], v25 offset:20480
    v_mfma_f32_16x16x32_bf16 a[60:63], a[184:187], v[184:187], a[60:63]
    ds_read_b128 a[224:227], v8 offset:45056
    v_cvt_pk_bf16_f32 v147, v210, v211
    v_mfma_f32_16x16x32_bf16 a[60:63], a[188:191], v[188:191], a[60:63]
    s_waitcnt lgkmcnt(3)
    buffer_load_dwordx4 v40, s[12:15], s41 offen offset:2048 lds
    v_mfma_f32_16x16x32_bf16 v[208:211], a[208:211], v[64:67], v[192:195]
    v_exp_f32 v212, v212
    v_mfma_f32_16x16x32_bf16 v[208:211], a[212:215], v[68:71], v[208:211]
    v_exp_f32 v213, v213
    v_mfma_f32_16x16x32_bf16 v[208:211], a[216:219], v[72:75], v[208:211]
    v_exp_f32 v214, v214
    v_mfma_f32_16x16x32_bf16 v[208:211], a[220:223], v[76:79], v[208:211]
    s_add_u32 s57, s58, 3538944
    v_exp_f32 v215, v215
    v_mfma_f32_16x16x32_bf16 a[64:67], a[160:163], v[160:163], a[64:67]
    ds_read_b64_tr_b16 a[172:173], v25 offset:24576
    v_cvt_pk_bf16_f32 v154, v212, v213
    v_mfma_f32_16x16x32_bf16 a[64:67], a[164:167], v[164:167], a[64:67]
    ds_read_b64_tr_b16 a[174:175], v25 offset:28672
    v_lshlrev_b32 v245, 3, v245
    v_mfma_f32_16x16x32_bf16 a[68:71], a[160:163], v[168:171], a[68:71]
    ds_read_b128 a[228:231], v9 offset:45056
    v_cvt_pk_bf16_f32 v155, v214, v215
    v_mfma_f32_16x16x32_bf16 a[68:71], a[164:167], v[172:175], a[68:71]
    buffer_load_dwordx4 a[152:155], v254, s[80:83], s57 offen
    v_smfmac_f32_16x16x64_bf16 a[204:207], v[52:55], v[184:191], v50
    ds_write_b64 v244, v[224:225]
    v_mfma_f32_16x16x32_bf16 v[212:215], a[208:211], v[80:83], v[196:199]
    v_exp_f32 v208, v208
    v_mfma_f32_16x16x32_bf16 v[212:215], a[212:215], v[84:87], v[212:215]
    v_exp_f32 v209, v209
    v_mfma_f32_16x16x32_bf16 v[212:215], a[216:219], v[88:91], v[212:215]
    v_exp_f32 v210, v210
    v_mfma_f32_16x16x32_bf16 v[212:215], a[220:223], v[92:95], v[212:215]
    v_exp_f32 v211, v211
    v_mfma_f32_16x16x32_bf16 a[72:75], a[160:163], v[176:179], a[72:75]
    ds_read_b64_tr_b16 a[176:177], v26 offset:16384
    v_cvt_pk_bf16_f32 v132, v208, v209
    v_mfma_f32_16x16x32_bf16 a[72:75], a[164:167], v[180:183], a[72:75]
    ds_read_b64_tr_b16 a[178:179], v26 offset:20480
    v_add_u32 v245, 131136, v245
    v_mfma_f32_16x16x32_bf16 a[76:79], a[160:163], v[184:187], a[76:79]
    ds_read_b128 a[232:235], v10 offset:45056
    v_cvt_pk_bf16_f32 v133, v210, v211
    v_mfma_f32_16x16x32_bf16 a[76:79], a[164:167], v[188:191], a[76:79]
    s_waitcnt lgkmcnt(3)
    buffer_load_dwordx4 v41, s[12:15], s41 offen offset:3072 lds
    v_mfma_f32_16x16x32_bf16 v[208:211], a[208:211], v[96:99], v[200:203]
    v_exp_f32 v212, v212
    v_mfma_f32_16x16x32_bf16 v[208:211], a[212:215], v[100:103], v[208:211]
    s_add_u32 s41, s41, 16384
    v_exp_f32 v213, v213
    v_mfma_f32_16x16x32_bf16 v[208:211], a[216:219], v[104:107], v[208:211]
    v_exp_f32 v214, v214
    v_mfma_f32_16x16x32_bf16 v[208:211], a[220:223], v[108:111], v[208:211]
    v_exp_f32 v215, v215
    v_mfma_f32_16x16x32_bf16 a[80:83], a[168:171], v[160:163], a[80:83]
    ds_read_b64_tr_b16 a[180:181], v26 offset:24576
    v_cvt_pk_bf16_f32 v140, v212, v213
    v_mfma_f32_16x16x32_bf16 a[80:83], a[172:175], v[164:167], a[80:83]
    ds_read_b64_tr_b16 a[182:183], v26 offset:28672
    v_mfma_f32_16x16x32_bf16 a[84:87], a[168:171], v[168:171], a[84:87]
    ds_read_b128 a[236:239], v11 offset:45056
    v_cvt_pk_bf16_f32 v141, v214, v215
    v_mfma_f32_16x16x32_bf16 a[84:87], a[172:175], v[172:175], a[84:87]
    s_waitcnt vmcnt(14)
    s_barrier
    v_mfma_f32_16x16x32_bf16 v[212:215], a[208:211], v[112:115], v[204:207]
    v_exp_f32 v208, v208
    v_mfma_f32_16x16x32_bf16 v[212:215], a[212:215], v[116:119], v[212:215]
    s_add_u32 s49, s45, 74752
    v_exp_f32 v209, v209
    v_mfma_f32_16x16x32_bf16 v[212:215], a[216:219], v[120:123], v[212:215]
    s_add_u32 m0, s42, 16384
    v_exp_f32 v210, v210
    v_mfma_f32_16x16x32_bf16 v[212:215], a[220:223], v[124:127], v[212:215]
    v_exp_f32 v211, v211
    v_mfma_f32_16x16x32_bf16 a[88:91], a[168:171], v[176:179], a[88:91]
    ds_read_b64_tr_b16 a[184:185], v27 offset:16384
    v_cvt_pk_bf16_f32 v148, v208, v209
    v_mfma_f32_16x16x32_bf16 a[88:91], a[172:175], v[180:183], a[88:91]
    ds_read_b64_tr_b16 a[186:187], v27 offset:20480
    ds_read_b64 v[224:225], v245 offset:0
    v_mfma_f32_16x16x32_bf16 a[92:95], a[168:171], v[184:187], a[92:95]
    ds_read_b128 a[208:211], v8 offset:49152
    v_cvt_pk_bf16_f32 v149, v210, v211
    v_mfma_f32_16x16x32_bf16 a[92:95], a[172:175], v[188:191], a[92:95]
    s_waitcnt lgkmcnt(3)
    buffer_load_dwordx4 v46, s[20:23], s49 offen lds
    v_mfma_f32_16x16x32_bf16 v[208:211], a[224:227], v[64:67], v[192:195]
    v_exp_f32 v212, v212
    v_mfma_f32_16x16x32_bf16 v[208:211], a[228:231], v[68:71], v[208:211]
    v_exp_f32 v213, v213
    v_mfma_f32_16x16x32_bf16 v[208:211], a[232:235], v[72:75], v[208:211]
    v_exp_f32 v214, v214
    v_mfma_f32_16x16x32_bf16 v[208:211], a[236:239], v[76:79], v[208:211]
    v_exp_f32 v215, v215
    v_mfma_f32_16x16x32_bf16 a[96:99], a[176:179], v[160:163], a[96:99]
    ds_read_b64_tr_b16 a[188:189], v27 offset:24576
    v_cvt_pk_bf16_f32 v156, v212, v213
    v_mfma_f32_16x16x32_bf16 a[96:99], a[180:183], v[164:167], a[96:99]
    ds_read_b64_tr_b16 a[190:191], v27 offset:28672
    ds_read_b64 v[226:227], v245 offset:64
    v_mfma_f32_16x16x32_bf16 a[100:103], a[176:179], v[168:171], a[100:103]
    ds_read_b128 a[212:215], v9 offset:49152
    v_cvt_pk_bf16_f32 v157, v214, v215
    v_mfma_f32_16x16x32_bf16 a[100:103], a[180:183], v[172:175], a[100:103]
    v_mfma_f32_16x16x32_bf16 v[212:215], a[224:227], v[80:83], v[196:199]
    v_exp_f32 v208, v208
    v_mfma_f32_16x16x32_bf16 v[212:215], a[228:231], v[84:87], v[212:215]
    v_exp_f32 v209, v209
    v_mfma_f32_16x16x32_bf16 v[212:215], a[232:235], v[88:91], v[212:215]
    v_exp_f32 v210, v210
    v_mfma_f32_16x16x32_bf16 v[212:215], a[236:239], v[92:95], v[212:215]
    v_exp_f32 v211, v211
    v_mfma_f32_16x16x32_bf16 a[104:107], a[176:179], v[176:179], a[104:107]
    ds_read_b64_tr_b16 a[160:161], v20 offset:32768
    v_cvt_pk_bf16_f32 v134, v208, v209
    v_mfma_f32_16x16x32_bf16 a[104:107], a[180:183], v[180:183], a[104:107]
    ds_read_b64_tr_b16 a[162:163], v20 offset:36864
    ds_read_b64 v[228:229], v245 offset:128
    v_mfma_f32_16x16x32_bf16 a[108:111], a[176:179], v[184:187], a[108:111]
    ds_read_b128 a[216:219], v10 offset:49152
    v_cvt_pk_bf16_f32 v135, v210, v211
    v_mfma_f32_16x16x32_bf16 a[108:111], a[180:183], v[188:191], a[108:111]
    s_waitcnt lgkmcnt(3)
    buffer_load_dwordx4 v47, s[20:23], s49 offen offset:1024 lds
    v_mfma_f32_16x16x32_bf16 v[208:211], a[224:227], v[96:99], v[200:203]
    v_exp_f32 v212, v212
    v_mfma_f32_16x16x32_bf16 v[208:211], a[228:231], v[100:103], v[208:211]
    v_exp_f32 v213, v213
    v_mfma_f32_16x16x32_bf16 v[208:211], a[232:235], v[104:107], v[208:211]
    v_exp_f32 v214, v214
    v_mfma_f32_16x16x32_bf16 v[208:211], a[236:239], v[108:111], v[208:211]
    s_add_u32 s57, s58, 4128768
    v_exp_f32 v215, v215
    v_mfma_f32_16x16x32_bf16 a[112:115], a[184:187], v[160:163], a[112:115]
    ds_read_b64_tr_b16 a[164:165], v20 offset:40960
    v_cvt_pk_bf16_f32 v142, v212, v213
    v_mfma_f32_16x16x32_bf16 a[112:115], a[188:191], v[164:167], a[112:115]
    ds_read_b64_tr_b16 a[166:167], v20 offset:45056
    ds_read_b64 v[230:231], v245 offset:192
    v_mfma_f32_16x16x32_bf16 a[116:119], a[184:187], v[168:171], a[116:119]
    ds_read_b128 a[220:223], v11 offset:49152
    v_cvt_pk_bf16_f32 v143, v214, v215
    v_mfma_f32_16x16x32_bf16 a[116:119], a[188:191], v[172:175], a[116:119]
    buffer_load_dwordx4 a[156:159], v254, s[80:83], s57 offen
    v_mfma_f32_16x16x32_bf16 v[212:215], a[224:227], v[112:115], v[204:207]
    v_exp_f32 v208, v208
    v_mfma_f32_16x16x32_bf16 v[212:215], a[228:231], v[116:119], v[212:215]
    v_exp_f32 v209, v209
    v_mfma_f32_16x16x32_bf16 v[212:215], a[232:235], v[120:123], v[212:215]
    v_exp_f32 v210, v210
    v_mfma_f32_16x16x32_bf16 v[212:215], a[236:239], v[124:127], v[212:215]
    v_exp_f32 v211, v211
    v_mfma_f32_16x16x32_bf16 a[120:123], a[184:187], v[176:179], a[120:123]
    ds_read_b64_tr_b16 a[168:169], v21 offset:32768
    v_cvt_pk_bf16_f32 v150, v208, v209
    v_mfma_f32_16x16x32_bf16 a[120:123], a[188:191], v[180:183], a[120:123]
    ds_read_b64_tr_b16 a[170:171], v21 offset:36864
    v_mfma_f32_16x16x32_bf16 a[124:127], a[184:187], v[184:187], a[124:127]
    ds_read_b128 a[224:227], v8 offset:53248
    v_cvt_pk_bf16_f32 v151, v210, v211
    v_mfma_f32_16x16x32_bf16 a[124:127], a[188:191], v[188:191], a[124:127]
    s_waitcnt lgkmcnt(3)
    buffer_load_dwordx4 v48, s[20:23], s49 offen offset:2048 lds
    v_mfma_f32_16x16x32_bf16 v[208:211], a[208:211], v[64:67], v[192:195]
    v_exp_f32 v212, v212
    v_mfma_f32_16x16x32_bf16 v[208:211], a[212:215], v[68:71], v[208:211]
    v_exp_f32 v213, v213
    v_mfma_f32_16x16x32_bf16 v[208:211], a[216:219], v[72:75], v[208:211]
    v_exp_f32 v214, v214
    v_mfma_f32_16x16x32_bf16 v[208:211], a[220:223], v[76:79], v[208:211]
    s_add_u32 s57, s58, 4718592
    v_exp_f32 v215, v215
    v_mfma_f32_16x16x32_bf16 a[0:3], a[160:163], v[128:131], a[0:3]
    ds_read_b64_tr_b16 a[172:173], v21 offset:40960
    v_cvt_pk_bf16_f32 v158, v212, v213
    v_mfma_f32_16x16x32_bf16 a[0:3], a[164:167], v[132:135], a[0:3]
    ds_read_b64_tr_b16 a[174:175], v21 offset:45056
    v_add_f32 v224, v224, v228
    v_mfma_f32_16x16x32_bf16 a[4:7], a[160:163], v[136:139], a[4:7]
    ds_read_b128 a[228:231], v9 offset:53248
    v_cvt_pk_bf16_f32 v159, v214, v215
    v_mfma_f32_16x16x32_bf16 a[4:7], a[164:167], v[140:143], a[4:7]
    buffer_load_dwordx4 a[240:243], v254, s[80:83], s57 offen
    v_mfma_f32_16x16x32_bf16 v[212:215], a[208:211], v[80:83], v[196:199]
    v_exp_f32 v208, v208
    v_mfma_f32_16x16x32_bf16 v[212:215], a[212:215], v[84:87], v[212:215]
    v_exp_f32 v209, v209
    v_mfma_f32_16x16x32_bf16 v[212:215], a[216:219], v[88:91], v[212:215]
    v_exp_f32 v210, v210
    v_mfma_f32_16x16x32_bf16 v[212:215], a[220:223], v[92:95], v[212:215]
    v_exp_f32 v211, v211
    v_mfma_f32_16x16x32_bf16 a[8:11], a[160:163], v[144:147], a[8:11]
    ds_read_b64_tr_b16 a[176:177], v22 offset:32768
    v_cvt_pk_bf16_f32 v160, v208, v209
    v_mfma_f32_16x16x32_bf16 a[8:11], a[164:167], v[148:151], a[8:11]
    ds_read_b64_tr_b16 a[178:179], v22 offset:36864
    v_add_f32 v225, v225, v229
    v_mfma_f32_16x16x32_bf16 a[12:15], a[160:163], v[152:155], a[12:15]
    ds_read_b128 a[232:235], v10 offset:53248
    v_cvt_pk_bf16_f32 v161, v210, v211
    v_mfma_f32_16x16x32_bf16 a[12:15], a[164:167], v[156:159], a[12:15]
    s_waitcnt lgkmcnt(3)
    buffer_load_dwordx4 v49, s[20:23], s49 offen offset:3072 lds
    v_mfma_f32_16x16x32_bf16 v[208:211], a[208:211], v[96:99], v[200:203]
    v_exp_f32 v212, v212
    v_mfma_f32_16x16x32_bf16 v[208:211], a[212:215], v[100:103], v[208:211]
    v_exp_f32 v213, v213
    v_mfma_f32_16x16x32_bf16 v[208:211], a[216:219], v[104:107], v[208:211]
    v_exp_f32 v214, v214
    v_mfma_f32_16x16x32_bf16 v[208:211], a[220:223], v[108:111], v[208:211]
    v_exp_f32 v215, v215
    v_mfma_f32_16x16x32_bf16 a[16:19], a[168:171], v[128:131], a[16:19]
    ds_read_b64_tr_b16 a[180:181], v22 offset:40960
    v_cvt_pk_bf16_f32 v168, v212, v213
    v_mfma_f32_16x16x32_bf16 a[16:19], a[172:175], v[132:135], a[16:19]
    ds_read_b64_tr_b16 a[182:183], v22 offset:45056
    v_add_f32 v226, v226, v230
    v_mfma_f32_16x16x32_bf16 a[20:23], a[168:171], v[136:139], a[20:23]
    ds_read_b128 a[236:239], v11 offset:53248
    v_cvt_pk_bf16_f32 v169, v214, v215
    v_mfma_f32_16x16x32_bf16 a[20:23], a[172:175], v[140:143], a[20:23]
    v_add_f32 v227, v227, v231
    v_add_f32 v224, v224, v226
    v_smfmac_f32_16x16x64_bf16 a[192:195], v[52:55], v[128:135], v50
    v_mfma_f32_16x16x32_bf16 v[212:215], a[208:211], v[112:115], v[204:207]
    v_exp_f32 v208, v208
    v_mfma_f32_16x16x32_bf16 v[212:215], a[212:215], v[116:119], v[212:215]
    s_add_u32 s49, s7, 0
    v_exp_f32 v209, v209
    v_mfma_f32_16x16x32_bf16 v[212:215], a[216:219], v[120:123], v[212:215]
    s_add_u32 m0, s42, 65536
    v_exp_f32 v210, v210
    v_mfma_f32_16x16x32_bf16 v[212:215], a[220:223], v[124:127], v[212:215]
    v_exp_f32 v211, v211
    v_mfma_f32_16x16x32_bf16 a[24:27], a[168:171], v[144:147], a[24:27]
    ds_read_b64_tr_b16 a[184:185], v23 offset:32768
    v_cvt_pk_bf16_f32 v176, v208, v209
    v_mfma_f32_16x16x32_bf16 a[24:27], a[172:175], v[148:151], a[24:27]
    ds_read_b64_tr_b16 a[186:187], v23 offset:36864
    v_add_f32 v225, v225, v227
    v_mfma_f32_16x16x32_bf16 a[28:31], a[168:171], v[152:155], a[28:31]
    ds_read_b128 a[208:211], v8 offset:57344
    v_cvt_pk_bf16_f32 v177, v210, v211
    v_mfma_f32_16x16x32_bf16 a[28:31], a[172:175], v[156:159], a[28:31]
    s_waitcnt lgkmcnt(3)
    buffer_load_dwordx4 v46, s[20:23], s49 offen lds
    v_mfma_f32_16x16x32_bf16 v[208:211], a[224:227], v[64:67], v[192:195]
    v_exp_f32 v212, v212
    v_mfma_f32_16x16x32_bf16 v[208:211], a[228:231], v[68:71], v[208:211]
    v_exp_f32 v213, v213
    v_mfma_f32_16x16x32_bf16 v[208:211], a[232:235], v[72:75], v[208:211]
    v_exp_f32 v214, v214
    v_mfma_f32_16x16x32_bf16 v[208:211], a[236:239], v[76:79], v[208:211]
    s_add_u32 s57, s58, 4128768
    v_exp_f32 v215, v215
    v_mfma_f32_16x16x32_bf16 a[32:35], a[176:179], v[128:131], a[32:35]
    ds_read_b64_tr_b16 a[188:189], v23 offset:40960
    v_cvt_pk_bf16_f32 v184, v212, v213
    v_mfma_f32_16x16x32_bf16 a[32:35], a[180:183], v[132:135], a[32:35]
    ds_read_b64_tr_b16 a[190:191], v23 offset:45056
    v_cvt_pk_bf16_f32 v246, v224, v225
    v_mfma_f32_16x16x32_bf16 a[36:39], a[176:179], v[136:139], a[36:39]
    ds_read_b128 a[212:215], v9 offset:57344
    v_cvt_pk_bf16_f32 v185, v214, v215
    v_mfma_f32_16x16x32_bf16 a[36:39], a[180:183], v[140:143], a[36:39]
    buffer_load_dwordx4 a[244:247], v254, s[32:35], s57 offen
    v_smfmac_f32_16x16x64_bf16 a[196:199], v[52:55], v[136:143], v50
    v_mfma_f32_16x16x32_bf16 v[212:215], a[224:227], v[80:83], v[196:199]
    v_exp_f32 v208, v208
    v_mfma_f32_16x16x32_bf16 v[212:215], a[228:231], v[84:87], v[212:215]
    v_exp_f32 v209, v209
    v_mfma_f32_16x16x32_bf16 v[212:215], a[232:235], v[88:91], v[212:215]
    v_exp_f32 v210, v210
    v_mfma_f32_16x16x32_bf16 v[212:215], a[236:239], v[92:95], v[212:215]
    v_exp_f32 v211, v211
    v_mfma_f32_16x16x32_bf16 a[40:43], a[176:179], v[144:147], a[40:43]
    ds_read_b64_tr_b16 a[160:161], v24 offset:32768
    v_cvt_pk_bf16_f32 v162, v208, v209
    v_mfma_f32_16x16x32_bf16 a[40:43], a[180:183], v[148:151], a[40:43]
    ds_read_b64_tr_b16 a[162:163], v24 offset:36864
    v_lshlrev_b32 v224, 16, v246
    v_mfma_f32_16x16x32_bf16 a[44:47], a[176:179], v[152:155], a[44:47]
    ds_read_b128 a[216:219], v10 offset:57344
    v_cvt_pk_bf16_f32 v163, v210, v211
    v_mfma_f32_16x16x32_bf16 a[44:47], a[180:183], v[156:159], a[44:47]
    s_waitcnt lgkmcnt(3)
    buffer_load_dwordx4 v47, s[20:23], s49 offen offset:1024 lds
    v_mfma_f32_16x16x32_bf16 v[208:211], a[224:227], v[96:99], v[200:203]
    v_exp_f32 v212, v212
    v_mfma_f32_16x16x32_bf16 v[208:211], a[228:231], v[100:103], v[208:211]
    v_exp_f32 v213, v213
    v_mfma_f32_16x16x32_bf16 v[208:211], a[232:235], v[104:107], v[208:211]
    v_exp_f32 v214, v214
    v_mfma_f32_16x16x32_bf16 v[208:211], a[236:239], v[108:111], v[208:211]
    v_exp_f32 v215, v215
    v_mfma_f32_16x16x32_bf16 a[48:51], a[184:187], v[128:131], a[48:51]
    ds_read_b64_tr_b16 a[164:165], v24 offset:40960
    v_cvt_pk_bf16_f32 v170, v212, v213
    v_mfma_f32_16x16x32_bf16 a[48:51], a[188:191], v[132:135], a[48:51]
    ds_read_b64_tr_b16 a[166:167], v24 offset:45056
    v_and_b32 v225, 0xffff0000, v246
    v_mfma_f32_16x16x32_bf16 a[52:55], a[184:187], v[136:139], a[52:55]
    ds_read_b128 a[220:223], v11 offset:57344
    v_cvt_pk_bf16_f32 v171, v214, v215
    v_mfma_f32_16x16x32_bf16 a[52:55], a[188:191], v[140:143], a[52:55]
    v_add_f32 v224, s36, v224
    v_add_f32 v225, s36, v225
    v_smfmac_f32_16x16x64_bf16 a[200:203], v[52:55], v[144:151], v50
    v_mfma_f32_16x16x32_bf16 v[212:215], a[224:227], v[112:115], v[204:207]
    v_exp_f32 v208, v208
    v_mfma_f32_16x16x32_bf16 v[212:215], a[228:231], v[116:119], v[212:215]
    v_exp_f32 v209, v209
    v_mfma_f32_16x16x32_bf16 v[212:215], a[232:235], v[120:123], v[212:215]
    v_exp_f32 v210, v210
    v_mfma_f32_16x16x32_bf16 v[212:215], a[236:239], v[124:127], v[212:215]
    v_exp_f32 v211, v211
    v_mfma_f32_16x16x32_bf16 a[56:59], a[184:187], v[144:147], a[56:59]
    ds_read_b64_tr_b16 a[168:169], v25 offset:32768
    v_cvt_pk_bf16_f32 v178, v208, v209
    v_mfma_f32_16x16x32_bf16 a[56:59], a[188:191], v[148:151], a[56:59]
    ds_read_b64_tr_b16 a[170:171], v25 offset:36864
    v_cvt_pk_bf16_f32 v246, v224, v225
    v_mfma_f32_16x16x32_bf16 a[60:63], a[184:187], v[152:155], a[60:63]
    ds_read_b128 a[224:227], v8 offset:61440
    v_cvt_pk_bf16_f32 v179, v210, v211
    v_mfma_f32_16x16x32_bf16 a[60:63], a[188:191], v[156:159], a[60:63]
    s_waitcnt lgkmcnt(3)
    buffer_load_dwordx4 v48, s[20:23], s49 offen offset:2048 lds
    v_mfma_f32_16x16x32_bf16 v[208:211], a[208:211], v[64:67], v[192:195]
    v_exp_f32 v212, v212
    v_mfma_f32_16x16x32_bf16 v[208:211], a[212:215], v[68:71], v[208:211]
    v_exp_f32 v213, v213
    v_mfma_f32_16x16x32_bf16 v[208:211], a[216:219], v[72:75], v[208:211]
    v_exp_f32 v214, v214
    v_mfma_f32_16x16x32_bf16 v[208:211], a[220:223], v[76:79], v[208:211]
    s_add_u32 s57, s58, 4718592
    v_exp_f32 v215, v215
    v_mfma_f32_16x16x32_bf16 a[64:67], a[160:163], v[128:131], a[64:67]
    ds_read_b64_tr_b16 a[172:173], v25 offset:40960
    v_cvt_pk_bf16_f32 v186, v212, v213
    v_mfma_f32_16x16x32_bf16 a[64:67], a[164:167], v[132:135], a[64:67]
    ds_read_b64_tr_b16 a[174:175], v25 offset:45056
    v_lshrrev_b32 v244, 1, v0
    v_mfma_f32_16x16x32_bf16 a[68:71], a[160:163], v[136:139], a[68:71]
    ds_read_b128 a[228:231], v9 offset:61440
    v_cvt_pk_bf16_f32 v187, v214, v215
    v_mfma_f32_16x16x32_bf16 a[68:71], a[164:167], v[140:143], a[68:71]
    buffer_load_dwordx4 a[248:251], v254, s[32:35], s57 offen
    v_smfmac_f32_16x16x64_bf16 a[204:207], v[52:55], v[152:159], v50
    v_mfma_f32_16x16x32_bf16 v[212:215], a[208:211], v[80:83], v[196:199]
    v_exp_f32 v208, v208
    v_mfma_f32_16x16x32_bf16 v[212:215], a[212:215], v[84:87], v[212:215]
    v_exp_f32 v209, v209
    v_mfma_f32_16x16x32_bf16 v[212:215], a[216:219], v[88:91], v[212:215]
    v_exp_f32 v210, v210
    v_mfma_f32_16x16x32_bf16 v[212:215], a[220:223], v[92:95], v[212:215]
    v_exp_f32 v211, v211
    v_mfma_f32_16x16x32_bf16 a[72:75], a[160:163], v[144:147], a[72:75]
    ds_read_b64_tr_b16 a[176:177], v26 offset:32768
    v_cvt_pk_bf16_f32 v164, v208, v209
    v_mfma_f32_16x16x32_bf16 a[72:75], a[164:167], v[148:151], a[72:75]
    ds_read_b64_tr_b16 a[178:179], v26 offset:36864
    v_lshlrev_b32 v244, 4, v244
    v_mfma_f32_16x16x32_bf16 a[76:79], a[160:163], v[152:155], a[76:79]
    ds_read_b128 a[232:235], v10 offset:61440
    v_cvt_pk_bf16_f32 v165, v210, v211
    v_mfma_f32_16x16x32_bf16 a[76:79], a[164:167], v[156:159], a[76:79]
    s_waitcnt lgkmcnt(3)
    buffer_load_dwordx4 v49, s[20:23], s49 offen offset:3072 lds
    v_mfma_f32_16x16x32_bf16 v[208:211], a[208:211], v[96:99], v[200:203]
    v_exp_f32 v212, v212
    v_mfma_f32_16x16x32_bf16 v[208:211], a[212:215], v[100:103], v[208:211]
    v_exp_f32 v213, v213
    v_mfma_f32_16x16x32_bf16 v[208:211], a[216:219], v[104:107], v[208:211]
    v_exp_f32 v214, v214
    v_mfma_f32_16x16x32_bf16 v[208:211], a[220:223], v[108:111], v[208:211]
    v_exp_f32 v215, v215
    v_mfma_f32_16x16x32_bf16 a[80:83], a[168:171], v[128:131], a[80:83]
    ds_read_b64_tr_b16 a[180:181], v26 offset:40960
    v_cvt_pk_bf16_f32 v172, v212, v213
    v_mfma_f32_16x16x32_bf16 a[80:83], a[172:175], v[132:135], a[80:83]
    ds_read_b64_tr_b16 a[182:183], v26 offset:45056
    v_and_b32 v245, 1, v0
    v_mfma_f32_16x16x32_bf16 a[84:87], a[168:171], v[136:139], a[84:87]
    ds_read_b128 a[236:239], v11 offset:61440
    v_cvt_pk_bf16_f32 v173, v214, v215
    v_mfma_f32_16x16x32_bf16 a[84:87], a[172:175], v[140:143], a[84:87]
    s_waitcnt vmcnt(12)
    s_barrier
    v_mfma_f32_16x16x32_bf16 v[212:215], a[208:211], v[112:115], v[204:207]
    v_exp_f32 v208, v208
    v_mfma_f32_16x16x32_bf16 v[212:215], a[212:215], v[116:119], v[212:215]
    s_add_u32 s49, s7, 73728
    v_exp_f32 v209, v209
    v_mfma_f32_16x16x32_bf16 v[212:215], a[216:219], v[120:123], v[212:215]
    s_add_u32 m0, s42, 81920
    v_exp_f32 v210, v210
Ltour7:
    s_cbranch_execz Ltour11
    v_mfma_f32_16x16x32_bf16 v[212:215], a[220:223], v[124:127], v[212:215]
    v_exp_f32 v211, v211
    v_mfma_f32_16x16x32_bf16 a[88:91], a[168:171], v[144:147], a[88:91]
    ds_read_b64_tr_b16 a[184:185], v27 offset:32768
    v_cvt_pk_bf16_f32 v180, v208, v209
    v_mfma_f32_16x16x32_bf16 a[88:91], a[172:175], v[148:151], a[88:91]
    ds_read_b64_tr_b16 a[186:187], v27 offset:36864
    v_lshl_add_u32 v244, v245, 2, v244
    v_mfma_f32_16x16x32_bf16 a[92:95], a[168:171], v[152:155], a[92:95]
    v_cvt_pk_bf16_f32 v181, v210, v211
    v_mfma_f32_16x16x32_bf16 a[92:95], a[172:175], v[156:159], a[92:95]
    s_waitcnt lgkmcnt(3)
    buffer_load_dwordx4 v46, s[20:23], s49 offen lds
    v_mfma_f32_16x16x32_bf16 v[208:211], a[224:227], v[64:67], v[192:195]
    v_exp_f32 v212, v212
    v_mfma_f32_16x16x32_bf16 v[208:211], a[228:231], v[68:71], v[208:211]
    v_exp_f32 v213, v213
    v_mfma_f32_16x16x32_bf16 v[208:211], a[232:235], v[72:75], v[208:211]
    s_waitcnt lgkmcnt(2)
    v_exp_f32 v214, v214
    v_mfma_f32_16x16x32_bf16 v[208:211], a[236:239], v[76:79], v[208:211]
    s_add_u32 s37, s55, 8192
    v_exp_f32 v215, v215
    v_mfma_f32_16x16x32_bf16 a[96:99], a[176:179], v[128:131], a[96:99]
    ds_read_b64_tr_b16 a[188:189], v27 offset:40960
    v_cvt_pk_bf16_f32 v188, v212, v213
    v_mfma_f32_16x16x32_bf16 a[96:99], a[180:183], v[132:135], a[96:99]
    ds_read_b64_tr_b16 a[190:191], v27 offset:45056
    v_lshrrev_b32 v245, 3, v0
    v_mfma_f32_16x16x32_bf16 a[100:103], a[176:179], v[136:139], a[100:103]
    v_cvt_pk_bf16_f32 v189, v214, v215
    v_mfma_f32_16x16x32_bf16 a[100:103], a[180:183], v[140:143], a[100:103]
    buffer_load_dword v239, v238, s[28:31], s37 offen
    v_mfma_f32_16x16x32_bf16 v[212:215], a[224:227], v[80:83], v[196:199]
    v_exp_f32 v208, v208
    v_mfma_f32_16x16x32_bf16 v[212:215], a[228:231], v[84:87], v[212:215]
    v_exp_f32 v209, v209
    v_mfma_f32_16x16x32_bf16 v[212:215], a[232:235], v[88:91], v[212:215]
    v_exp_f32 v210, v210
    v_mfma_f32_16x16x32_bf16 v[212:215], a[236:239], v[92:95], v[212:215]
    v_exp_f32 v211, v211
    v_mfma_f32_16x16x32_bf16 a[104:107], a[176:179], v[144:147], a[104:107]
    ds_read_b64_tr_b16 a[160:161], v20 offset:49152
    v_cvt_pk_bf16_f32 v166, v208, v209
    v_mfma_f32_16x16x32_bf16 a[104:107], a[180:183], v[148:151], a[104:107]
    ds_read_b64_tr_b16 a[162:163], v20 offset:53248
    v_min_u32 v245, 1, v245
    v_mfma_f32_16x16x32_bf16 a[108:111], a[176:179], v[152:155], a[108:111]
    v_cvt_pk_bf16_f32 v167, v210, v211
    v_mfma_f32_16x16x32_bf16 a[108:111], a[180:183], v[156:159], a[108:111]
    s_waitcnt lgkmcnt(3)
    buffer_load_dwordx4 v47, s[20:23], s49 offen offset:1024 lds
    v_mfma_f32_16x16x32_bf16 v[208:211], a[224:227], v[96:99], v[200:203]
    v_exp_f32 v212, v212
    v_mfma_f32_16x16x32_bf16 v[208:211], a[228:231], v[100:103], v[208:211]
    v_exp_f32 v213, v213
    v_mfma_f32_16x16x32_bf16 v[208:211], a[232:235], v[104:107], v[208:211]
    v_exp_f32 v214, v214
    v_mfma_f32_16x16x32_bf16 v[208:211], a[236:239], v[108:111], v[208:211]
    s_add_u32 s57, s59, 0
    v_exp_f32 v215, v215
    v_mfma_f32_16x16x32_bf16 a[112:115], a[184:187], v[128:131], a[112:115]
    s_waitcnt lgkmcnt(2)
    ds_read_b64_tr_b16 a[164:165], v20 offset:57344
    v_cvt_pk_bf16_f32 v174, v212, v213
    v_mfma_f32_16x16x32_bf16 a[112:115], a[188:191], v[132:135], a[112:115]
    ds_read_b64_tr_b16 a[166:167], v20 offset:61440
    v_lshl_or_b32 v244, v245, 31, v244
    v_mfma_f32_16x16x32_bf16 a[116:119], a[184:187], v[136:139], a[116:119]
    v_cvt_pk_bf16_f32 v175, v214, v215
    v_mfma_f32_16x16x32_bf16 a[116:119], a[188:191], v[140:143], a[116:119]
    buffer_load_dwordx4 a[252:255], v255, s[84:87], s57 offen
    v_mfma_f32_16x16x32_bf16 v[212:215], a[224:227], v[112:115], v[204:207]
    v_exp_f32 v208, v208
    v_mfma_f32_16x16x32_bf16 v[212:215], a[228:231], v[116:119], v[212:215]
    v_exp_f32 v209, v209
    v_mfma_f32_16x16x32_bf16 v[212:215], a[232:235], v[120:123], v[212:215]
    v_exp_f32 v210, v210
    v_mfma_f32_16x16x32_bf16 v[212:215], a[236:239], v[124:127], v[212:215]
    v_exp_f32 v211, v211
    v_mfma_f32_16x16x32_bf16 a[120:123], a[184:187], v[144:147], a[120:123]
    ds_read_b64_tr_b16 a[168:169], v21 offset:49152
    v_cvt_pk_bf16_f32 v182, v208, v209
    v_mfma_f32_16x16x32_bf16 a[120:123], a[188:191], v[148:151], a[120:123]
    ds_read_b64_tr_b16 a[170:171], v21 offset:53248
    v_mfma_f32_16x16x32_bf16 a[124:127], a[184:187], v[152:155], a[124:127]
    v_cvt_pk_bf16_f32 v183, v210, v211
    v_mfma_f32_16x16x32_bf16 a[124:127], a[188:191], v[156:159], a[124:127]
    s_waitcnt lgkmcnt(3)
    buffer_load_dwordx4 v48, s[20:23], s49 offen offset:2048 lds
    v_exp_f32 v212, v212
    v_exp_f32 v213, v213
    v_exp_f32 v214, v214
    v_exp_f32 v215, v215
    v_mfma_f32_16x16x32_bf16 a[0:3], a[160:163], v[160:163], a[0:3]
    s_waitcnt lgkmcnt(2)
    ds_read_b64_tr_b16 a[172:173], v21 offset:57344
    v_cvt_pk_bf16_f32 v190, v212, v213
    v_mfma_f32_16x16x32_bf16 a[0:3], a[164:167], v[164:167], a[0:3]
    ds_read_b64_tr_b16 a[174:175], v21 offset:61440
    v_mfma_f32_16x16x32_bf16 a[4:7], a[160:163], v[168:171], a[4:7]
    v_cvt_pk_bf16_f32 v191, v214, v215
    v_mfma_f32_16x16x32_bf16 a[4:7], a[164:167], v[172:175], a[4:7]
    buffer_store_dword v246, v244, s[24:27], s39 offen sc1
    v_mfma_f32_16x16x32_bf16 a[8:11], a[160:163], v[176:179], a[8:11]
    ds_read_b64_tr_b16 a[176:177], v22 offset:49152
    v_mfma_f32_16x16x32_bf16 a[8:11], a[164:167], v[180:183], a[8:11]
    ds_read_b64_tr_b16 a[178:179], v22 offset:53248
    v_mfma_f32_16x16x32_bf16 a[12:15], a[160:163], v[184:187], a[12:15]
    v_mfma_f32_16x16x32_bf16 a[12:15], a[164:167], v[188:191], a[12:15]
    buffer_load_dwordx4 v49, s[20:23], s49 offen offset:3072 lds
    v_smfmac_f32_16x16x64_bf16 a[192:195], v[52:55], v[160:167], v50
    s_waitcnt lgkmcnt(4)
    v_mfma_f32_16x16x32_bf16 a[16:19], a[168:171], v[160:163], a[16:19]
    s_waitcnt lgkmcnt(2)
    ds_read_b64_tr_b16 a[180:181], v22 offset:57344
    v_mfma_f32_16x16x32_bf16 a[16:19], a[172:175], v[164:167], a[16:19]
    ds_read_b64_tr_b16 a[182:183], v22 offset:61440
    v_mfma_f32_16x16x32_bf16 a[20:23], a[168:171], v[168:171], a[20:23]
    v_min_u32 v240, 1, v0
    v_mfma_f32_16x16x32_bf16 a[20:23], a[172:175], v[172:175], a[20:23]
    v_smfmac_f32_16x16x64_bf16 a[196:199], v[52:55], v[168:175], v50
    s_add_u32 s49, s7, 256
    s_add_u32 m0, s42, 32768
    v_mfma_f32_16x16x32_bf16 a[24:27], a[168:171], v[176:179], a[24:27]
    ds_read_b64_tr_b16 a[184:185], v23 offset:49152
    v_mfma_f32_16x16x32_bf16 a[24:27], a[172:175], v[180:183], a[24:27]
    ds_read_b64_tr_b16 a[186:187], v23 offset:53248
    v_mfma_f32_16x16x32_bf16 a[28:31], a[168:171], v[184:187], a[28:31]
    v_lshlrev_b32 v240, 31, v240
    v_mfma_f32_16x16x32_bf16 a[28:31], a[172:175], v[188:191], a[28:31]
    buffer_load_dwordx4 v46, s[20:23], s49 offen lds
    v_smfmac_f32_16x16x64_bf16 a[200:203], v[52:55], v[176:183], v50
    s_waitcnt lgkmcnt(4)
    v_mfma_f32_16x16x32_bf16 a[32:35], a[176:179], v[160:163], a[32:35]
    s_waitcnt lgkmcnt(2)
    ds_read_b64_tr_b16 a[188:189], v23 offset:57344
    v_mfma_f32_16x16x32_bf16 a[32:35], a[180:183], v[164:167], a[32:35]
    ds_read_b64_tr_b16 a[190:191], v23 offset:61440
    v_mfma_f32_16x16x32_bf16 a[36:39], a[176:179], v[168:171], a[36:39]
    v_mov_b32 v241, 1
    v_mfma_f32_16x16x32_bf16 a[36:39], a[180:183], v[172:175], a[36:39]
    v_smfmac_f32_16x16x64_bf16 a[204:207], v[52:55], v[184:191], v50
    v_mfma_f32_16x16x32_bf16 a[40:43], a[176:179], v[176:179], a[40:43]
    ds_read_b64_tr_b16 a[160:161], v24 offset:49152
    v_mfma_f32_16x16x32_bf16 a[40:43], a[180:183], v[180:183], a[40:43]
    ds_read_b64_tr_b16 a[162:163], v24 offset:53248
    v_mfma_f32_16x16x32_bf16 a[44:47], a[176:179], v[184:187], a[44:47]
    v_mfma_f32_16x16x32_bf16 a[44:47], a[180:183], v[188:191], a[44:47]
    s_waitcnt lgkmcnt(4)
    buffer_load_dwordx4 v47, s[20:23], s49 offen offset:1024 lds
    v_mfma_f32_16x16x32_bf16 a[48:51], a[184:187], v[160:163], a[48:51]
    s_waitcnt lgkmcnt(2)
    ds_read_b64_tr_b16 a[164:165], v24 offset:57344
    v_accvgpr_read_b32 v216, a192
    v_mfma_f32_16x16x32_bf16 a[48:51], a[188:191], v[164:167], a[48:51]
    ds_read_b64_tr_b16 a[166:167], v24 offset:61440
    v_accvgpr_read_b32 v217, a193
    v_mfma_f32_16x16x32_bf16 a[52:55], a[184:187], v[168:171], a[52:55]
    v_accvgpr_read_b32 v218, a196
    v_accvgpr_read_b32 v219, a197
    v_mfma_f32_16x16x32_bf16 a[52:55], a[188:191], v[172:175], a[52:55]
    v_accvgpr_read_b32 v220, a200
    v_accvgpr_read_b32 v221, a201
    v_mfma_f32_16x16x32_bf16 a[56:59], a[184:187], v[176:179], a[56:59]
    ds_read_b64_tr_b16 a[168:169], v25 offset:49152
    v_accvgpr_read_b32 v222, a204
    v_mfma_f32_16x16x32_bf16 a[56:59], a[188:191], v[180:183], a[56:59]
    ds_read_b64_tr_b16 a[170:171], v25 offset:53248
    v_accvgpr_read_b32 v223, a205
    v_mfma_f32_16x16x32_bf16 a[60:63], a[184:187], v[184:187], a[60:63]
    v_add_f32 v58, v216, v217
    v_add_f32 v59, v218, v219
    v_mfma_f32_16x16x32_bf16 a[60:63], a[188:191], v[188:191], a[60:63]
    s_waitcnt lgkmcnt(4)
    buffer_load_dwordx4 v48, s[20:23], s49 offen offset:2048 lds
    v_add_f32 v60, v220, v221
    v_add_f32 v61, v222, v223
    v_mfma_f32_16x16x32_bf16 a[64:67], a[160:163], v[160:163], a[64:67]
    s_waitcnt lgkmcnt(2)
    ds_read_b64_tr_b16 a[172:173], v25 offset:57344
    v_add_f32 v216, v58, v59
    v_mfma_f32_16x16x32_bf16 a[64:67], a[164:167], v[164:167], a[64:67]
    ds_read_b64_tr_b16 a[174:175], v25 offset:61440
    v_add_f32 v217, v60, v61
    v_mfma_f32_16x16x32_bf16 a[68:71], a[160:163], v[168:171], a[68:71]
    v_add_f32 v216, v216, v217
    v_cmp_ngt_f32 vcc, 1669332992, v216
    v_mfma_f32_16x16x32_bf16 a[68:71], a[164:167], v[172:175], a[68:71]
    v_rcp_f32 v58, v58
    v_rcp_f32 v59, v59
    v_mfma_f32_16x16x32_bf16 a[72:75], a[160:163], v[176:179], a[72:75]
    ds_read_b64_tr_b16 a[176:177], v26 offset:49152
    v_rcp_f32 v60, v60
    v_mfma_f32_16x16x32_bf16 a[72:75], a[164:167], v[180:183], a[72:75]
    ds_read_b64_tr_b16 a[178:179], v26 offset:53248
    v_rcp_f32 v61, v61
    v_mfma_f32_16x16x32_bf16 a[76:79], a[160:163], v[184:187], a[76:79]
    v_mov_b32 v228, 131072
    s_or_b32 s36, vcc_lo, vcc_hi
    v_mfma_f32_16x16x32_bf16 a[76:79], a[164:167], v[188:191], a[76:79]
    s_waitcnt lgkmcnt(4)
    buffer_load_dwordx4 v49, s[20:23], s49 offen offset:3072 lds
    v_mov_b32 v218, s36
    s_lshl_b32 s37, s3, 2
    v_mfma_f32_16x16x32_bf16 a[80:83], a[168:171], v[160:163], a[80:83]
    s_waitcnt lgkmcnt(2)
    ds_read_b64_tr_b16 a[180:181], v26 offset:57344
    v_add_u32 v219, s37, v228
    ds_write_b32 v219, v218
    v_mfma_f32_16x16x32_bf16 a[80:83], a[172:175], v[164:167], a[80:83]
    ds_read_b64_tr_b16 a[182:183], v26 offset:61440
    v_mfma_f32_16x16x32_bf16 a[84:87], a[168:171], v[168:171], a[84:87]
    v_mfma_f32_16x16x32_bf16 a[84:87], a[172:175], v[172:175], a[84:87]
    s_waitcnt lgkmcnt(1)
    s_waitcnt vmcnt(17)
    s_barrier
    v_mfma_f32_16x16x32_bf16 a[88:91], a[168:171], v[176:179], a[88:91]
    ds_read_b64_tr_b16 a[184:185], v27 offset:49152
    v_mfma_f32_16x16x32_bf16 a[88:91], a[172:175], v[180:183], a[88:91]
    ds_read_b64_tr_b16 a[186:187], v27 offset:53248
    v_mfma_f32_16x16x32_bf16 a[92:95], a[168:171], v[184:187], a[92:95]
    ds_read_b128 v[224:227], v228
    v_mfma_f32_16x16x32_bf16 a[92:95], a[172:175], v[188:191], a[92:95]
    s_add_u32 s49, s7, 73984
    v_mfma_f32_16x16x32_bf16 a[96:99], a[176:179], v[160:163], a[96:99]
    s_waitcnt lgkmcnt(3)
    s_add_u32 m0, s42, 49152
    ds_read_b64_tr_b16 a[188:189], v27 offset:57344
    v_mfma_f32_16x16x32_bf16 a[96:99], a[180:183], v[164:167], a[96:99]
    buffer_load_dwordx4 v46, s[20:23], s49 offen lds
    v_mfma_f32_16x16x32_bf16 a[100:103], a[176:179], v[168:171], a[100:103]
    ds_read_b64_tr_b16 a[190:191], v27 offset:61440
    v_mfma_f32_16x16x32_bf16 a[100:103], a[180:183], v[172:175], a[100:103]
    buffer_load_dwordx4 v47, s[20:23], s49 offen offset:1024 lds
    v_mfma_f32_16x16x32_bf16 a[104:107], a[176:179], v[176:179], a[104:107]
    v_mfma_f32_16x16x32_bf16 a[104:107], a[180:183], v[180:183], a[104:107]
    buffer_load_dwordx4 v48, s[20:23], s49 offen offset:2048 lds
    v_mfma_f32_16x16x32_bf16 a[108:111], a[176:179], v[184:187], a[108:111]
    v_mfma_f32_16x16x32_bf16 a[108:111], a[180:183], v[188:191], a[108:111]
    s_waitcnt lgkmcnt(3)
    buffer_load_dwordx4 v49, s[20:23], s49 offen offset:3072 lds
    s_add_u32 s49, s46, 0
    v_mfma_f32_16x16x32_bf16 a[112:115], a[184:187], v[160:163], a[112:115]
    s_waitcnt lgkmcnt(0)
    s_add_u32 m0, s42, 98304
    v_mfma_f32_16x16x32_bf16 a[112:115], a[188:191], v[164:167], a[112:115]
    buffer_load_dwordx4 v46, s[20:23], s49 offen lds
    v_mfma_f32_16x16x32_bf16 a[116:119], a[184:187], v[168:171], a[116:119]
    v_mfma_f32_16x16x32_bf16 a[116:119], a[188:191], v[172:175], a[116:119]
    buffer_load_dwordx4 v47, s[20:23], s49 offen offset:1024 lds
    v_mfma_f32_16x16x32_bf16 a[120:123], a[184:187], v[176:179], a[120:123]
    v_mfma_f32_16x16x32_bf16 a[120:123], a[188:191], v[180:183], a[120:123]
    buffer_load_dwordx4 v48, s[20:23], s49 offen offset:2048 lds
    v_mfma_f32_16x16x32_bf16 a[124:127], a[184:187], v[184:187], a[124:127]
    v_mfma_f32_16x16x32_bf16 a[124:127], a[188:191], v[188:191], a[124:127]
    buffer_load_dwordx4 v49, s[20:23], s49 offen offset:3072 lds
    v_or3_b32 v224, v224, v225, v226
    v_or_b32 v224, v224, v227
    s_nop 0
    v_readfirstlane_b32 s36, v224
    v_readfirstlane_b32 s38, v253
    v_min_u32 v8, 1, v1
    v_lshlrev_b32 v8, 31, v8
    v_mov_b32 v10, s95
    s_getreg_b32 s39, hwreg(HW_REG_XCC_ID, 0, 4)
    s_add_u32 s39, s39, s95
    s_cmp_eq_u32 s38, s39
    s_cselect_b32 s53, 1, 0
    ds_read_b64_tr_b16 a[208:209], v12 offset:0
    ds_read_b64_tr_b16 a[210:211], v12 offset:4096
    ds_read_b64_tr_b16 a[212:213], v12 offset:8192
    ds_read_b64_tr_b16 a[214:215], v12 offset:12288
    ds_read_b64_tr_b16 a[216:217], v12 offset:16384
    ds_read_b64_tr_b16 a[218:219], v12 offset:20480
    ds_read_b64_tr_b16 a[220:221], v12 offset:24576
    ds_read_b64_tr_b16 a[222:223], v12 offset:28672
    ds_read_b64_tr_b16 a[224:225], v16 offset:0
    ds_read_b64_tr_b16 a[226:227], v16 offset:4096
    ds_read_b64_tr_b16 a[228:229], v16 offset:8192
    ds_read_b64_tr_b16 a[230:231], v16 offset:12288
    ds_read_b64_tr_b16 a[232:233], v16 offset:16384
    ds_read_b64_tr_b16 a[234:235], v16 offset:20480
    ds_read_b64_tr_b16 a[236:237], v16 offset:24576
    ds_read_b64_tr_b16 a[238:239], v16 offset:28672
    s_waitcnt vmcnt(13)
    buffer_atomic_add v241, v240, s[88:91], s43 offen sc1
    s_andn2_b32 s36, s36, s48
    s_cbranch_scc1 Lattn_redo
    v_accvgpr_read_b32 v216, a0
    v_accvgpr_read_b32 v217, a1
    v_accvgpr_read_b32 v218, a2
    v_accvgpr_read_b32 v219, a3
    v_pk_mul_f32 v[216:217], v[216:217], v[58:59] op_sel:[0,0] op_sel_hi:[1,0]
    v_pk_mul_f32 v[218:219], v[218:219], v[58:59] op_sel:[0,0] op_sel_hi:[1,0]
    v_cvt_pk_bf16_f32 v128, v216, v217
    v_cvt_pk_bf16_f32 v129, v218, v219
    v_accvgpr_read_b32 v220, a4
    v_accvgpr_read_b32 v221, a5
    v_accvgpr_read_b32 v222, a6
    v_accvgpr_read_b32 v223, a7
    v_pk_mul_f32 v[220:221], v[220:221], v[58:59] op_sel:[0,1] op_sel_hi:[1,1]
    v_pk_mul_f32 v[222:223], v[222:223], v[58:59] op_sel:[0,1] op_sel_hi:[1,1]
    v_cvt_pk_bf16_f32 v160, v220, v221
    v_cvt_pk_bf16_f32 v161, v222, v223
    v_accvgpr_read_b32 v224, a8
    v_accvgpr_read_b32 v225, a9
    v_accvgpr_read_b32 v226, a10
    v_accvgpr_read_b32 v227, a11
    v_pk_mul_f32 v[224:225], v[224:225], v[60:61] op_sel:[0,0] op_sel_hi:[1,0]
    v_pk_mul_f32 v[226:227], v[226:227], v[60:61] op_sel:[0,0] op_sel_hi:[1,0]
    v_cvt_pk_bf16_f32 v144, v224, v225
    v_cvt_pk_bf16_f32 v145, v226, v227
    v_accvgpr_read_b32 v228, a12
    v_accvgpr_read_b32 v229, a13
    v_accvgpr_read_b32 v230, a14
    v_accvgpr_read_b32 v231, a15
    v_pk_mul_f32 v[228:229], v[228:229], v[60:61] op_sel:[0,1] op_sel_hi:[1,1]
    v_pk_mul_f32 v[230:231], v[230:231], v[60:61] op_sel:[0,1] op_sel_hi:[1,1]
    v_cvt_pk_bf16_f32 v176, v228, v229
    v_cvt_pk_bf16_f32 v177, v230, v231
    v_accvgpr_read_b32 v216, a16
    v_accvgpr_read_b32 v217, a17
    v_accvgpr_read_b32 v218, a18
    v_accvgpr_read_b32 v219, a19
    v_pk_mul_f32 v[216:217], v[216:217], v[58:59] op_sel:[0,0] op_sel_hi:[1,0]
    v_pk_mul_f32 v[218:219], v[218:219], v[58:59] op_sel:[0,0] op_sel_hi:[1,0]
    v_cvt_pk_bf16_f32 v130, v216, v217
    v_cvt_pk_bf16_f32 v131, v218, v219
    s_add_u32 s37, s55, 0
    buffer_store_dwordx4 v[128:131], v252, s[28:31], s37 offen offset:0
    v_accvgpr_read_b32 v220, a20
    v_accvgpr_read_b32 v221, a21
    v_accvgpr_read_b32 v222, a22
    v_accvgpr_read_b32 v223, a23
    v_pk_mul_f32 v[220:221], v[220:221], v[58:59] op_sel:[0,1] op_sel_hi:[1,1]
    v_pk_mul_f32 v[222:223], v[222:223], v[58:59] op_sel:[0,1] op_sel_hi:[1,1]
    v_cvt_pk_bf16_f32 v162, v220, v221
    v_cvt_pk_bf16_f32 v163, v222, v223
    s_add_u32 s37, s55, 8192
    buffer_store_dwordx4 v[160:163], v252, s[28:31], s37 offen offset:0
    v_accvgpr_read_b32 v224, a24
    v_accvgpr_read_b32 v225, a25
    v_accvgpr_read_b32 v226, a26
    v_accvgpr_read_b32 v227, a27
    v_pk_mul_f32 v[224:225], v[224:225], v[60:61] op_sel:[0,0] op_sel_hi:[1,0]
    v_pk_mul_f32 v[226:227], v[226:227], v[60:61] op_sel:[0,0] op_sel_hi:[1,0]
    v_cvt_pk_bf16_f32 v146, v224, v225
    v_cvt_pk_bf16_f32 v147, v226, v227
    s_add_u32 s37, s55, 4096
    buffer_store_dwordx4 v[144:147], v252, s[28:31], s37 offen offset:0
    v_accvgpr_read_b32 v228, a28
    v_accvgpr_read_b32 v229, a29
    v_accvgpr_read_b32 v230, a30
    v_accvgpr_read_b32 v231, a31
    v_pk_mul_f32 v[228:229], v[228:229], v[60:61] op_sel:[0,1] op_sel_hi:[1,1]
    v_pk_mul_f32 v[230:231], v[230:231], v[60:61] op_sel:[0,1] op_sel_hi:[1,1]
    v_cvt_pk_bf16_f32 v178, v228, v229
    v_cvt_pk_bf16_f32 v179, v230, v231
    s_add_u32 s37, s55, 12288
    buffer_store_dwordx4 v[176:179], v252, s[28:31], s37 offen offset:0
    v_accvgpr_read_b32 v216, a32
    v_accvgpr_read_b32 v217, a33
    v_accvgpr_read_b32 v218, a34
    v_accvgpr_read_b32 v219, a35
    v_pk_mul_f32 v[216:217], v[216:217], v[58:59] op_sel:[0,0] op_sel_hi:[1,0]
    v_pk_mul_f32 v[218:219], v[218:219], v[58:59] op_sel:[0,0] op_sel_hi:[1,0]
    v_cvt_pk_bf16_f32 v132, v216, v217
    v_cvt_pk_bf16_f32 v133, v218, v219
    v_accvgpr_read_b32 v220, a36
    v_accvgpr_read_b32 v221, a37
    v_accvgpr_read_b32 v222, a38
    v_accvgpr_read_b32 v223, a39
    v_pk_mul_f32 v[220:221], v[220:221], v[58:59] op_sel:[0,1] op_sel_hi:[1,1]
    v_pk_mul_f32 v[222:223], v[222:223], v[58:59] op_sel:[0,1] op_sel_hi:[1,1]
    v_cvt_pk_bf16_f32 v164, v220, v221
    v_cvt_pk_bf16_f32 v165, v222, v223
    v_accvgpr_read_b32 v224, a40
    v_accvgpr_read_b32 v225, a41
    v_accvgpr_read_b32 v226, a42
    v_accvgpr_read_b32 v227, a43
    v_pk_mul_f32 v[224:225], v[224:225], v[60:61] op_sel:[0,0] op_sel_hi:[1,0]
    v_pk_mul_f32 v[226:227], v[226:227], v[60:61] op_sel:[0,0] op_sel_hi:[1,0]
    v_cvt_pk_bf16_f32 v148, v224, v225
    v_cvt_pk_bf16_f32 v149, v226, v227
    v_accvgpr_read_b32 v228, a44
    v_accvgpr_read_b32 v229, a45
    v_accvgpr_read_b32 v230, a46
    v_accvgpr_read_b32 v231, a47
    v_pk_mul_f32 v[228:229], v[228:229], v[60:61] op_sel:[0,1] op_sel_hi:[1,1]
    v_pk_mul_f32 v[230:231], v[230:231], v[60:61] op_sel:[0,1] op_sel_hi:[1,1]
    v_cvt_pk_bf16_f32 v180, v228, v229
    v_cvt_pk_bf16_f32 v181, v230, v231
    v_accvgpr_read_b32 v216, a48
    v_accvgpr_read_b32 v217, a49
    v_accvgpr_read_b32 v218, a50
    v_accvgpr_read_b32 v219, a51
    v_pk_mul_f32 v[216:217], v[216:217], v[58:59] op_sel:[0,0] op_sel_hi:[1,0]
    v_pk_mul_f32 v[218:219], v[218:219], v[58:59] op_sel:[0,0] op_sel_hi:[1,0]
    v_cvt_pk_bf16_f32 v134, v216, v217
    v_cvt_pk_bf16_f32 v135, v218, v219
    s_add_u32 s37, s55, 0
    buffer_store_dwordx4 v[132:135], v252, s[28:31], s37 offen offset:1024
    v_accvgpr_read_b32 v220, a52
    v_accvgpr_read_b32 v221, a53
    v_accvgpr_read_b32 v222, a54
    v_accvgpr_read_b32 v223, a55
    v_pk_mul_f32 v[220:221], v[220:221], v[58:59] op_sel:[0,1] op_sel_hi:[1,1]
    v_pk_mul_f32 v[222:223], v[222:223], v[58:59] op_sel:[0,1] op_sel_hi:[1,1]
    v_cvt_pk_bf16_f32 v166, v220, v221
    v_cvt_pk_bf16_f32 v167, v222, v223
    s_add_u32 s37, s55, 8192
    buffer_store_dwordx4 v[164:167], v252, s[28:31], s37 offen offset:1024
    v_accvgpr_read_b32 v224, a56
    v_accvgpr_read_b32 v225, a57
    v_accvgpr_read_b32 v226, a58
    v_accvgpr_read_b32 v227, a59
    v_pk_mul_f32 v[224:225], v[224:225], v[60:61] op_sel:[0,0] op_sel_hi:[1,0]
    v_pk_mul_f32 v[226:227], v[226:227], v[60:61] op_sel:[0,0] op_sel_hi:[1,0]
    v_cvt_pk_bf16_f32 v150, v224, v225
    v_cvt_pk_bf16_f32 v151, v226, v227
    s_add_u32 s37, s55, 4096
    buffer_store_dwordx4 v[148:151], v252, s[28:31], s37 offen offset:1024
    v_accvgpr_read_b32 v228, a60
    v_accvgpr_read_b32 v229, a61
    v_accvgpr_read_b32 v230, a62
    v_accvgpr_read_b32 v231, a63
    v_pk_mul_f32 v[228:229], v[228:229], v[60:61] op_sel:[0,1] op_sel_hi:[1,1]
    v_pk_mul_f32 v[230:231], v[230:231], v[60:61] op_sel:[0,1] op_sel_hi:[1,1]
    v_cvt_pk_bf16_f32 v182, v228, v229
    v_cvt_pk_bf16_f32 v183, v230, v231
    s_add_u32 s37, s55, 12288
    buffer_store_dwordx4 v[180:183], v252, s[28:31], s37 offen offset:1024
    v_accvgpr_read_b32 v216, a64
    v_accvgpr_read_b32 v217, a65
    v_accvgpr_read_b32 v218, a66
    v_accvgpr_read_b32 v219, a67
    v_pk_mul_f32 v[216:217], v[216:217], v[58:59] op_sel:[0,0] op_sel_hi:[1,0]
    v_pk_mul_f32 v[218:219], v[218:219], v[58:59] op_sel:[0,0] op_sel_hi:[1,0]
    v_cvt_pk_bf16_f32 v136, v216, v217
    v_cvt_pk_bf16_f32 v137, v218, v219
    v_accvgpr_read_b32 v220, a68
    v_accvgpr_read_b32 v221, a69
    v_accvgpr_read_b32 v222, a70
    v_accvgpr_read_b32 v223, a71
    v_pk_mul_f32 v[220:221], v[220:221], v[58:59] op_sel:[0,1] op_sel_hi:[1,1]
    v_pk_mul_f32 v[222:223], v[222:223], v[58:59] op_sel:[0,1] op_sel_hi:[1,1]
    v_cvt_pk_bf16_f32 v168, v220, v221
    v_cvt_pk_bf16_f32 v169, v222, v223
    v_accvgpr_read_b32 v224, a72
    v_accvgpr_read_b32 v225, a73
    v_accvgpr_read_b32 v226, a74
    v_accvgpr_read_b32 v227, a75
    v_pk_mul_f32 v[224:225], v[224:225], v[60:61] op_sel:[0,0] op_sel_hi:[1,0]
    v_pk_mul_f32 v[226:227], v[226:227], v[60:61] op_sel:[0,0] op_sel_hi:[1,0]
    v_cvt_pk_bf16_f32 v152, v224, v225
    v_cvt_pk_bf16_f32 v153, v226, v227
    v_accvgpr_read_b32 v228, a76
    v_accvgpr_read_b32 v229, a77
    v_accvgpr_read_b32 v230, a78
    v_accvgpr_read_b32 v231, a79
    v_pk_mul_f32 v[228:229], v[228:229], v[60:61] op_sel:[0,1] op_sel_hi:[1,1]
    v_pk_mul_f32 v[230:231], v[230:231], v[60:61] op_sel:[0,1] op_sel_hi:[1,1]
    v_cvt_pk_bf16_f32 v184, v228, v229
    v_cvt_pk_bf16_f32 v185, v230, v231
    v_accvgpr_read_b32 v216, a80
    v_accvgpr_read_b32 v217, a81
    v_accvgpr_read_b32 v218, a82
    v_accvgpr_read_b32 v219, a83
    v_pk_mul_f32 v[216:217], v[216:217], v[58:59] op_sel:[0,0] op_sel_hi:[1,0]
    v_pk_mul_f32 v[218:219], v[218:219], v[58:59] op_sel:[0,0] op_sel_hi:[1,0]
    v_cvt_pk_bf16_f32 v138, v216, v217
    v_cvt_pk_bf16_f32 v139, v218, v219
    s_add_u32 s37, s55, 0
    buffer_store_dwordx4 v[136:139], v252, s[28:31], s37 offen offset:2048
    v_accvgpr_read_b32 v220, a84
    v_accvgpr_read_b32 v221, a85
    v_accvgpr_read_b32 v222, a86
    v_accvgpr_read_b32 v223, a87
    v_pk_mul_f32 v[220:221], v[220:221], v[58:59] op_sel:[0,1] op_sel_hi:[1,1]
    v_pk_mul_f32 v[222:223], v[222:223], v[58:59] op_sel:[0,1] op_sel_hi:[1,1]
    v_cvt_pk_bf16_f32 v170, v220, v221
    v_cvt_pk_bf16_f32 v171, v222, v223
    s_add_u32 s37, s55, 8192
    buffer_store_dwordx4 v[168:171], v252, s[28:31], s37 offen offset:2048
    v_accvgpr_read_b32 v224, a88
    v_accvgpr_read_b32 v225, a89
    v_accvgpr_read_b32 v226, a90
    v_accvgpr_read_b32 v227, a91
    v_pk_mul_f32 v[224:225], v[224:225], v[60:61] op_sel:[0,0] op_sel_hi:[1,0]
    v_pk_mul_f32 v[226:227], v[226:227], v[60:61] op_sel:[0,0] op_sel_hi:[1,0]
    v_cvt_pk_bf16_f32 v154, v224, v225
    v_cvt_pk_bf16_f32 v155, v226, v227
    s_add_u32 s37, s55, 4096
    buffer_store_dwordx4 v[152:155], v252, s[28:31], s37 offen offset:2048
    v_accvgpr_read_b32 v228, a92
    v_accvgpr_read_b32 v229, a93
    v_accvgpr_read_b32 v230, a94
    v_accvgpr_read_b32 v231, a95
    v_pk_mul_f32 v[228:229], v[228:229], v[60:61] op_sel:[0,1] op_sel_hi:[1,1]
    v_pk_mul_f32 v[230:231], v[230:231], v[60:61] op_sel:[0,1] op_sel_hi:[1,1]
    v_cvt_pk_bf16_f32 v186, v228, v229
    v_cvt_pk_bf16_f32 v187, v230, v231
    s_add_u32 s37, s55, 12288
    buffer_store_dwordx4 v[184:187], v252, s[28:31], s37 offen offset:2048
    v_accvgpr_read_b32 v216, a96
    v_accvgpr_read_b32 v217, a97
    v_accvgpr_read_b32 v218, a98
    v_accvgpr_read_b32 v219, a99
    v_pk_mul_f32 v[216:217], v[216:217], v[58:59] op_sel:[0,0] op_sel_hi:[1,0]
    v_pk_mul_f32 v[218:219], v[218:219], v[58:59] op_sel:[0,0] op_sel_hi:[1,0]
    v_cvt_pk_bf16_f32 v140, v216, v217
    v_cvt_pk_bf16_f32 v141, v218, v219
    v_accvgpr_read_b32 v220, a100
    v_accvgpr_read_b32 v221, a101
    v_accvgpr_read_b32 v222, a102
    v_accvgpr_read_b32 v223, a103
    v_pk_mul_f32 v[220:221], v[220:221], v[58:59] op_sel:[0,1] op_sel_hi:[1,1]
    v_pk_mul_f32 v[222:223], v[222:223], v[58:59] op_sel:[0,1] op_sel_hi:[1,1]
    v_cvt_pk_bf16_f32 v172, v220, v221
    v_cvt_pk_bf16_f32 v173, v222, v223
    v_accvgpr_read_b32 v224, a104
    v_accvgpr_read_b32 v225, a105
    v_accvgpr_read_b32 v226, a106
    v_accvgpr_read_b32 v227, a107
    v_pk_mul_f32 v[224:225], v[224:225], v[60:61] op_sel:[0,0] op_sel_hi:[1,0]
    v_pk_mul_f32 v[226:227], v[226:227], v[60:61] op_sel:[0,0] op_sel_hi:[1,0]
    v_cvt_pk_bf16_f32 v156, v224, v225
    v_cvt_pk_bf16_f32 v157, v226, v227
    v_accvgpr_read_b32 v228, a108
    v_accvgpr_read_b32 v229, a109
    v_accvgpr_read_b32 v230, a110
    v_accvgpr_read_b32 v231, a111
    v_pk_mul_f32 v[228:229], v[228:229], v[60:61] op_sel:[0,1] op_sel_hi:[1,1]
    v_pk_mul_f32 v[230:231], v[230:231], v[60:61] op_sel:[0,1] op_sel_hi:[1,1]
    v_cvt_pk_bf16_f32 v188, v228, v229
    v_cvt_pk_bf16_f32 v189, v230, v231
    v_accvgpr_read_b32 v216, a112
    v_accvgpr_read_b32 v217, a113
    v_accvgpr_read_b32 v218, a114
    v_accvgpr_read_b32 v219, a115
    v_pk_mul_f32 v[216:217], v[216:217], v[58:59] op_sel:[0,0] op_sel_hi:[1,0]
    v_pk_mul_f32 v[218:219], v[218:219], v[58:59] op_sel:[0,0] op_sel_hi:[1,0]
    v_cvt_pk_bf16_f32 v142, v216, v217
    v_cvt_pk_bf16_f32 v143, v218, v219
    s_add_u32 s37, s55, 0
    buffer_store_dwordx4 v[140:143], v252, s[28:31], s37 offen offset:3072
    v_accvgpr_read_b32 v220, a116
    v_accvgpr_read_b32 v221, a117
    v_accvgpr_read_b32 v222, a118
    v_accvgpr_read_b32 v223, a119
    v_pk_mul_f32 v[220:221], v[220:221], v[58:59] op_sel:[0,1] op_sel_hi:[1,1]
    v_pk_mul_f32 v[222:223], v[222:223], v[58:59] op_sel:[0,1] op_sel_hi:[1,1]
Ltour8:
    s_cbranch_execz Ltour12
    v_cvt_pk_bf16_f32 v174, v220, v221
    v_cvt_pk_bf16_f32 v175, v222, v223
    s_add_u32 s37, s55, 8192
    buffer_store_dwordx4 v[172:175], v252, s[28:31], s37 offen offset:3072
    v_accvgpr_read_b32 v224, a120
    v_accvgpr_read_b32 v225, a121
    v_accvgpr_read_b32 v226, a122
    v_accvgpr_read_b32 v227, a123
    v_pk_mul_f32 v[224:225], v[224:225], v[60:61] op_sel:[0,0] op_sel_hi:[1,0]
    v_pk_mul_f32 v[226:227], v[226:227], v[60:61] op_sel:[0,0] op_sel_hi:[1,0]
    v_cvt_pk_bf16_f32 v158, v224, v225
    v_cvt_pk_bf16_f32 v159, v226, v227
    s_add_u32 s37, s55, 4096
    buffer_store_dwordx4 v[156:159], v252, s[28:31], s37 offen offset:3072
    v_accvgpr_read_b32 v228, a124
    v_accvgpr_read_b32 v229, a125
    v_accvgpr_read_b32 v230, a126
    v_accvgpr_read_b32 v231, a127
    v_pk_mul_f32 v[228:229], v[228:229], v[60:61] op_sel:[0,1] op_sel_hi:[1,1]
    v_pk_mul_f32 v[230:231], v[230:231], v[60:61] op_sel:[0,1] op_sel_hi:[1,1]
    v_cvt_pk_bf16_f32 v190, v228, v229
    v_cvt_pk_bf16_f32 v191, v230, v231
    s_add_u32 s37, s55, 12288
    buffer_store_dwordx4 v[188:191], v252, s[28:31], s37 offen offset:3072
    s_waitcnt lgkmcnt(14)
    v_mfma_f32_16x16x32_bf16 v[96:99], a[208:211], v[128:131], 0
    s_waitcnt lgkmcnt(12)
    ds_read_b64_tr_b16 a[160:161], v13 offset:0
    v_mfma_f32_16x16x32_bf16 v[96:99], a[212:215], v[132:135], v[96:99]
    s_waitcnt lgkmcnt(11)
    ds_read_b64_tr_b16 a[162:163], v13 offset:4096
    v_mfma_f32_16x16x32_bf16 v[96:99], a[216:219], v[136:139], v[96:99]
    s_waitcnt lgkmcnt(10)
    ds_read_b64_tr_b16 a[164:165], v13 offset:8192
    v_mfma_f32_16x16x32_bf16 v[96:99], a[220:223], v[140:143], v[96:99]
    s_waitcnt lgkmcnt(9)
    ds_read_b64_tr_b16 a[166:167], v13 offset:12288
    v_mfma_f32_16x16x32_bf16 v[96:99], a[224:227], v[144:147], v[96:99]
    s_waitcnt lgkmcnt(8)
    ds_read_b64_tr_b16 a[168:169], v13 offset:16384
    v_mfma_f32_16x16x32_bf16 v[96:99], a[228:231], v[148:151], v[96:99]
    s_waitcnt lgkmcnt(7)
    ds_read_b64_tr_b16 a[170:171], v13 offset:20480
    v_mfma_f32_16x16x32_bf16 v[96:99], a[232:235], v[152:155], v[96:99]
    s_waitcnt lgkmcnt(6)
    ds_read_b64_tr_b16 a[172:173], v13 offset:24576
    v_mfma_f32_16x16x32_bf16 v[96:99], a[236:239], v[156:159], v[96:99]
    ds_read_b64_tr_b16 a[174:175], v13 offset:28672
    v_mfma_f32_16x16x32_bf16 v[100:103], a[208:211], v[160:163], 0
    ds_read_b64_tr_b16 a[176:177], v17 offset:0
    v_mfma_f32_16x16x32_bf16 v[100:103], a[212:215], v[164:167], v[100:103]
    ds_read_b64_tr_b16 a[178:179], v17 offset:4096
    v_mfma_f32_16x16x32_bf16 v[100:103], a[216:219], v[168:171], v[100:103]
    ds_read_b64_tr_b16 a[180:181], v17 offset:8192
    v_mfma_f32_16x16x32_bf16 v[100:103], a[220:223], v[172:175], v[100:103]
    ds_read_b64_tr_b16 a[182:183], v17 offset:12288
    v_mfma_f32_16x16x32_bf16 v[100:103], a[224:227], v[176:179], v[100:103]
    ds_read_b64_tr_b16 a[184:185], v17 offset:16384
    v_cvt_pk_bf16_f32 v224, v96, v97
    v_mfma_f32_16x16x32_bf16 v[100:103], a[228:231], v[180:183], v[100:103]
    ds_read_b64_tr_b16 a[186:187], v17 offset:20480
    v_cvt_pk_bf16_f32 v225, v98, v99
    v_mfma_f32_16x16x32_bf16 v[100:103], a[232:235], v[184:187], v[100:103]
    ds_read_b64_tr_b16 a[188:189], v17 offset:24576
    v_mfma_f32_16x16x32_bf16 v[100:103], a[236:239], v[188:191], v[100:103]
    s_waitcnt lgkmcnt(13)
    ds_read_b64_tr_b16 a[190:191], v17 offset:28672
    v_mfma_f32_16x16x32_bf16 v[104:107], a[160:163], v[128:131], 0
    s_waitcnt lgkmcnt(12)
    ds_read_b64_tr_b16 a[208:209], v14 offset:0
    v_mfma_f32_16x16x32_bf16 v[104:107], a[164:167], v[132:135], v[104:107]
    s_waitcnt lgkmcnt(11)
    ds_read_b64_tr_b16 a[210:211], v14 offset:4096
    v_mfma_f32_16x16x32_bf16 v[104:107], a[168:171], v[136:139], v[104:107]
    s_waitcnt lgkmcnt(10)
    ds_read_b64_tr_b16 a[212:213], v14 offset:8192
    v_mfma_f32_16x16x32_bf16 v[104:107], a[172:175], v[140:143], v[104:107]
    s_waitcnt lgkmcnt(9)
    ds_read_b64_tr_b16 a[214:215], v14 offset:12288
    v_mfma_f32_16x16x32_bf16 v[104:107], a[176:179], v[144:147], v[104:107]
    s_waitcnt lgkmcnt(8)
    ds_read_b64_tr_b16 a[216:217], v14 offset:16384
    v_cvt_pk_bf16_f32 v228, v100, v101
    v_mfma_f32_16x16x32_bf16 v[104:107], a[180:183], v[148:151], v[104:107]
    s_waitcnt lgkmcnt(7)
    ds_read_b64_tr_b16 a[218:219], v14 offset:20480
    v_cvt_pk_bf16_f32 v229, v102, v103
    v_mfma_f32_16x16x32_bf16 v[104:107], a[184:187], v[152:155], v[104:107]
    s_waitcnt lgkmcnt(6)
    ds_read_b64_tr_b16 a[220:221], v14 offset:24576
    v_mfma_f32_16x16x32_bf16 v[104:107], a[188:191], v[156:159], v[104:107]
    ds_read_b64_tr_b16 a[222:223], v14 offset:28672
    s_waitcnt vmcnt(0)
    s_cmp_eq_u32 s53, 0
    s_cbranch_scc1 Lattn_wb
Lattn_wbdone:
    v_mfma_f32_16x16x32_bf16 v[108:111], a[160:163], v[160:163], 0
    buffer_store_dword v10, v8, s[24:27], s92 offen offset:8 sc1
    v_mfma_f32_16x16x32_bf16 v[108:111], a[164:167], v[164:167], v[108:111]
    s_xor_b32 s55, s55, 65536
    ds_read_b64_tr_b16 a[224:225], v18 offset:0
    ds_read_b64_tr_b16 a[226:227], v18 offset:4096
    v_mfma_f32_16x16x32_bf16 v[108:111], a[168:171], v[168:171], v[108:111]
    ds_read_b64_tr_b16 a[228:229], v18 offset:8192
    v_mfma_f32_16x16x32_bf16 v[108:111], a[172:175], v[172:175], v[108:111]
    ds_read_b64_tr_b16 a[230:231], v18 offset:12288
    s_load_dwordx2 s[12:13], s[0:1], 0
    v_mfma_f32_16x16x32_bf16 v[108:111], a[176:179], v[176:179], v[108:111]
    ds_read_b64_tr_b16 a[232:233], v18 offset:16384
    v_cvt_pk_bf16_f32 v226, v104, v105
    v_mfma_f32_16x16x32_bf16 v[108:111], a[180:183], v[180:183], v[108:111]
    s_add_u32 s38, s56, 16384
    ds_read_b64_tr_b16 a[234:235], v18 offset:20480
    v_cvt_pk_bf16_f32 v227, v106, v107
    s_load_dwordx2 s[16:17], s[0:1], 96
    v_mfma_f32_16x16x32_bf16 v[108:111], a[184:187], v[184:187], v[108:111]
    buffer_store_dwordx4 v[224:227], v56, s[28:31], s38 offen sc1
    v_mfma_f32_16x16x32_bf16 v[108:111], a[188:191], v[188:191], v[108:111]
    s_waitcnt lgkmcnt(12)
    ds_read_b64_tr_b16 a[236:237], v18 offset:24576
    ds_read_b64_tr_b16 a[238:239], v18 offset:28672
    s_load_dwordx2 s[52:53], s[0:1], 48
    v_mfma_f32_16x16x32_bf16 v[112:115], a[208:211], v[128:131], 0
    s_waitcnt lgkmcnt(12)
    ds_read_b64_tr_b16 a[160:161], v15 offset:0
    v_mfma_f32_16x16x32_bf16 v[112:115], a[212:215], v[132:135], v[112:115]
    s_waitcnt lgkmcnt(11)
    ds_read_b64_tr_b16 a[162:163], v15 offset:4096
    v_mfma_f32_16x16x32_bf16 v[112:115], a[216:219], v[136:139], v[112:115]
    s_waitcnt lgkmcnt(10)
    ds_read_b64_tr_b16 a[164:165], v15 offset:8192
    v_mfma_f32_16x16x32_bf16 v[112:115], a[220:223], v[140:143], v[112:115]
    s_waitcnt lgkmcnt(9)
    ds_read_b64_tr_b16 a[166:167], v15 offset:12288
    v_mfma_f32_16x16x32_bf16 v[112:115], a[224:227], v[144:147], v[112:115]
    s_waitcnt lgkmcnt(8)
    ds_read_b64_tr_b16 a[168:169], v15 offset:16384
    v_cvt_pk_bf16_f32 v230, v108, v109
    v_mfma_f32_16x16x32_bf16 v[112:115], a[228:231], v[148:151], v[112:115]
    s_waitcnt lgkmcnt(7)
    s_add_u32 s38, s56, 180224
    ds_read_b64_tr_b16 a[170:171], v15 offset:20480
    v_cvt_pk_bf16_f32 v231, v110, v111
    v_mfma_f32_16x16x32_bf16 v[112:115], a[232:235], v[152:155], v[112:115]
    s_waitcnt lgkmcnt(6)
    buffer_store_dwordx4 v[228:231], v56, s[28:31], s38 offen sc1
    v_mfma_f32_16x16x32_bf16 v[112:115], a[236:239], v[156:159], v[112:115]
    ds_read_b64_tr_b16 a[172:173], v15 offset:24576
    ds_read_b64_tr_b16 a[174:175], v15 offset:28672
    v_mfma_f32_16x16x32_bf16 v[116:119], a[208:211], v[160:163], 0
    ds_read_b64_tr_b16 a[176:177], v19 offset:0
    v_mfma_f32_16x16x32_bf16 v[116:119], a[212:215], v[164:167], v[116:119]
    ds_read_b64_tr_b16 a[178:179], v19 offset:4096
    v_mfma_f32_16x16x32_bf16 v[116:119], a[216:219], v[168:171], v[116:119]
    ds_read_b64_tr_b16 a[180:181], v19 offset:8192
    v_mfma_f32_16x16x32_bf16 v[116:119], a[220:223], v[172:175], v[116:119]
    ds_read_b64_tr_b16 a[182:183], v19 offset:12288
    v_mfma_f32_16x16x32_bf16 v[116:119], a[224:227], v[176:179], v[116:119]
    ds_read_b64_tr_b16 a[184:185], v19 offset:16384
    v_cvt_pk_bf16_f32 v232, v112, v113
    v_mfma_f32_16x16x32_bf16 v[116:119], a[228:231], v[180:183], v[116:119]
    ds_read_b64_tr_b16 a[186:187], v19 offset:20480
    v_cvt_pk_bf16_f32 v233, v114, v115
    v_mfma_f32_16x16x32_bf16 v[116:119], a[232:235], v[184:187], v[116:119]
    ds_read_b64_tr_b16 a[188:189], v19 offset:24576
    v_mfma_f32_16x16x32_bf16 v[116:119], a[236:239], v[188:191], v[116:119]
    s_waitcnt lgkmcnt(13)
    ds_read_b64_tr_b16 a[190:191], v19 offset:28672
    s_barrier
    v_mfma_f32_16x16x32_bf16 v[120:123], a[160:163], v[128:131], 0
    s_waitcnt lgkmcnt(12)
    buffer_load_dword v11, v8, s[24:27], s54 offen offset:8 sc1
    v_mfma_f32_16x16x32_bf16 v[120:123], a[164:167], v[132:135], v[120:123]
    s_waitcnt lgkmcnt(10)
    ds_read_b64_tr_b16 a[208:209], v20 offset:0
    ds_read_b64_tr_b16 a[210:211], v20 offset:4096
    v_mfma_f32_16x16x32_bf16 v[120:123], a[168:171], v[136:139], v[120:123]
    s_waitcnt lgkmcnt(10)
    ds_read_b64_tr_b16 a[212:213], v20 offset:8192
    v_mfma_f32_16x16x32_bf16 v[120:123], a[172:175], v[140:143], v[120:123]
    s_waitcnt lgkmcnt(9)
    ds_read_b64_tr_b16 a[214:215], v20 offset:12288
    v_mfma_f32_16x16x32_bf16 v[120:123], a[176:179], v[144:147], v[120:123]
    s_waitcnt lgkmcnt(8)
    ds_read_b64_tr_b16 a[216:217], v20 offset:16384
    v_cvt_pk_bf16_f32 v236, v116, v117
    v_mfma_f32_16x16x32_bf16 v[120:123], a[180:183], v[148:151], v[120:123]
    s_waitcnt lgkmcnt(7)
    ds_read_b64_tr_b16 a[218:219], v20 offset:20480
    v_cvt_pk_bf16_f32 v237, v118, v119
    v_mfma_f32_16x16x32_bf16 v[120:123], a[184:187], v[152:155], v[120:123]
    s_waitcnt lgkmcnt(6)
    s_add_u32 s49, s46, 73728
    ds_read_b64_tr_b16 a[220:221], v20 offset:24576
    v_mfma_f32_16x16x32_bf16 v[120:123], a[188:191], v[156:159], v[120:123]
    s_add_u32 m0, s42, 114688
    ds_read_b64_tr_b16 a[222:223], v20 offset:28672
    v_mfma_f32_16x16x32_bf16 v[124:127], a[160:163], v[160:163], 0
    buffer_load_dwordx4 v46, s[20:23], s49 offen lds
    v_mfma_f32_16x16x32_bf16 v[124:127], a[164:167], v[164:167], v[124:127]
    ds_read_b64_tr_b16 a[224:225], v24 offset:0
    ds_read_b64_tr_b16 a[226:227], v24 offset:4096
    v_mfma_f32_16x16x32_bf16 v[124:127], a[168:171], v[168:171], v[124:127]
    buffer_load_dwordx4 v47, s[20:23], s49 offen offset:1024 lds
    v_mfma_f32_16x16x32_bf16 v[124:127], a[172:175], v[172:175], v[124:127]
    ds_read_b64_tr_b16 a[228:229], v24 offset:8192
    ds_read_b64_tr_b16 a[230:231], v24 offset:12288
    v_mfma_f32_16x16x32_bf16 v[124:127], a[176:179], v[176:179], v[124:127]
    ds_read_b64_tr_b16 a[232:233], v24 offset:16384
    v_cvt_pk_bf16_f32 v234, v120, v121
    v_mfma_f32_16x16x32_bf16 v[124:127], a[180:183], v[180:183], v[124:127]
    s_add_u32 s38, s56, 16512
    ds_read_b64_tr_b16 a[234:235], v24 offset:20480
    v_cvt_pk_bf16_f32 v235, v122, v123
    v_mfma_f32_16x16x32_bf16 v[124:127], a[184:187], v[184:187], v[124:127]
    buffer_store_dwordx4 v[232:235], v56, s[28:31], s38 offen sc1
    v_mfma_f32_16x16x32_bf16 v[124:127], a[188:191], v[188:191], v[124:127]
    s_waitcnt lgkmcnt(12)
    ds_read_b64_tr_b16 a[236:237], v24 offset:24576
    ds_read_b64_tr_b16 a[238:239], v24 offset:28672
    v_mfma_f32_16x16x32_bf16 v[64:67], a[208:211], v[128:131], 0
    s_waitcnt lgkmcnt(12)
    buffer_load_dwordx4 v48, s[20:23], s49 offen offset:2048 lds
    v_mfma_f32_16x16x32_bf16 v[64:67], a[212:215], v[132:135], v[64:67]
    s_waitcnt lgkmcnt(10)
    ds_read_b64_tr_b16 a[160:161], v21 offset:0
    ds_read_b64_tr_b16 a[162:163], v21 offset:4096
    v_mfma_f32_16x16x32_bf16 v[64:67], a[216:219], v[136:139], v[64:67]
    s_waitcnt lgkmcnt(10)
    buffer_load_dwordx4 v49, s[20:23], s49 offen offset:3072 lds
    v_mfma_f32_16x16x32_bf16 v[64:67], a[220:223], v[140:143], v[64:67]
    s_waitcnt lgkmcnt(8)
    ds_read_b64_tr_b16 a[164:165], v21 offset:8192
    ds_read_b64_tr_b16 a[166:167], v21 offset:12288
    v_mfma_f32_16x16x32_bf16 v[64:67], a[224:227], v[144:147], v[64:67]
    s_waitcnt lgkmcnt(8)
    ds_read_b64_tr_b16 a[168:169], v21 offset:16384
    v_cvt_pk_bf16_f32 v238, v124, v125
    v_mfma_f32_16x16x32_bf16 v[64:67], a[228:231], v[148:151], v[64:67]
    s_waitcnt lgkmcnt(7)
    s_add_u32 s38, s56, 180352
    ds_read_b64_tr_b16 a[170:171], v21 offset:20480
    v_cvt_pk_bf16_f32 v239, v126, v127
    v_mfma_f32_16x16x32_bf16 v[64:67], a[232:235], v[152:155], v[64:67]
    s_waitcnt lgkmcnt(6)
    buffer_store_dwordx4 v[236:239], v56, s[28:31], s38 offen sc1
    v_mfma_f32_16x16x32_bf16 v[64:67], a[236:239], v[156:159], v[64:67]
    ds_read_b64_tr_b16 a[172:173], v21 offset:24576
    ds_read_b64_tr_b16 a[174:175], v21 offset:28672
    v_mfma_f32_16x16x32_bf16 v[68:71], a[208:211], v[160:163], 0
    ds_read_b64_tr_b16 a[176:177], v25 offset:0
    v_mfma_f32_16x16x32_bf16 v[68:71], a[212:215], v[164:167], v[68:71]
    ds_read_b64_tr_b16 a[178:179], v25 offset:4096
    v_mfma_f32_16x16x32_bf16 v[68:71], a[216:219], v[168:171], v[68:71]
    ds_read_b64_tr_b16 a[180:181], v25 offset:8192
    v_mfma_f32_16x16x32_bf16 v[68:71], a[220:223], v[172:175], v[68:71]
    ds_read_b64_tr_b16 a[182:183], v25 offset:12288
    v_mfma_f32_16x16x32_bf16 v[68:71], a[224:227], v[176:179], v[68:71]
    ds_read_b64_tr_b16 a[184:185], v25 offset:16384
    v_mfma_f32_16x16x32_bf16 v[68:71], a[228:231], v[180:183], v[68:71]
    ds_read_b64_tr_b16 a[186:187], v25 offset:20480
    v_mfma_f32_16x16x32_bf16 v[68:71], a[232:235], v[184:187], v[68:71]
    ds_read_b64_tr_b16 a[188:189], v25 offset:24576
    v_mfma_f32_16x16x32_bf16 v[68:71], a[236:239], v[188:191], v[68:71]
    s_waitcnt lgkmcnt(13)
    ds_read_b64_tr_b16 a[190:191], v25 offset:28672
    v_mfma_f32_16x16x32_bf16 v[72:75], a[160:163], v[128:131], 0
    s_waitcnt lgkmcnt(12)
    ds_read_b64_tr_b16 a[208:209], v22 offset:0
    v_mfma_f32_16x16x32_bf16 v[72:75], a[164:167], v[132:135], v[72:75]
    s_waitcnt lgkmcnt(11)
    ds_read_b64_tr_b16 a[210:211], v22 offset:4096
    v_mfma_f32_16x16x32_bf16 v[72:75], a[168:171], v[136:139], v[72:75]
    s_waitcnt lgkmcnt(10)
    ds_read_b64_tr_b16 a[212:213], v22 offset:8192
    v_mfma_f32_16x16x32_bf16 v[72:75], a[172:175], v[140:143], v[72:75]
    s_waitcnt lgkmcnt(9)
    ds_read_b64_tr_b16 a[214:215], v22 offset:12288
    v_mfma_f32_16x16x32_bf16 v[72:75], a[176:179], v[144:147], v[72:75]
    s_waitcnt lgkmcnt(8)
    ds_read_b64_tr_b16 a[216:217], v22 offset:16384
    v_mfma_f32_16x16x32_bf16 v[72:75], a[180:183], v[148:151], v[72:75]
    s_waitcnt lgkmcnt(7)
    ds_read_b64_tr_b16 a[218:219], v22 offset:20480
    v_mfma_f32_16x16x32_bf16 v[72:75], a[184:187], v[152:155], v[72:75]
    s_waitcnt lgkmcnt(6)
    ds_read_b64_tr_b16 a[220:221], v22 offset:24576
    v_mfma_f32_16x16x32_bf16 v[72:75], a[188:191], v[156:159], v[72:75]
    ds_read_b64_tr_b16 a[222:223], v22 offset:28672
    v_mfma_f32_16x16x32_bf16 v[76:79], a[160:163], v[160:163], 0
    ds_read_b64_tr_b16 a[224:225], v26 offset:0
    v_mfma_f32_16x16x32_bf16 v[76:79], a[164:167], v[164:167], v[76:79]
    ds_read_b64_tr_b16 a[226:227], v26 offset:4096
    v_mfma_f32_16x16x32_bf16 v[76:79], a[168:171], v[168:171], v[76:79]
    ds_read_b64_tr_b16 a[228:229], v26 offset:8192
    v_mfma_f32_16x16x32_bf16 v[76:79], a[172:175], v[172:175], v[76:79]
    ds_read_b64_tr_b16 a[230:231], v26 offset:12288
    v_mfma_f32_16x16x32_bf16 v[76:79], a[176:179], v[176:179], v[76:79]
    ds_read_b64_tr_b16 a[232:233], v26 offset:16384
    v_mfma_f32_16x16x32_bf16 v[76:79], a[180:183], v[180:183], v[76:79]
    ds_read_b64_tr_b16 a[234:235], v26 offset:20480
    v_mfma_f32_16x16x32_bf16 v[76:79], a[184:187], v[184:187], v[76:79]
    ds_read_b64_tr_b16 a[236:237], v26 offset:24576
    v_mfma_f32_16x16x32_bf16 v[76:79], a[188:191], v[188:191], v[76:79]
    s_waitcnt lgkmcnt(13)
    ds_read_b64_tr_b16 a[238:239], v26 offset:28672
    v_mfma_f32_16x16x32_bf16 v[80:83], a[208:211], v[128:131], 0
    s_waitcnt lgkmcnt(12)
    ds_read_b64_tr_b16 a[160:161], v23 offset:0
    v_mfma_f32_16x16x32_bf16 v[80:83], a[212:215], v[132:135], v[80:83]
    s_waitcnt lgkmcnt(11)
    ds_read_b64_tr_b16 a[162:163], v23 offset:4096
    v_mfma_f32_16x16x32_bf16 v[80:83], a[216:219], v[136:139], v[80:83]
    s_waitcnt lgkmcnt(10)
    ds_read_b64_tr_b16 a[164:165], v23 offset:8192
    s_waitcnt vmcnt(6)
    v_readfirstlane_b32 s36, v11
    v_mfma_f32_16x16x32_bf16 v[80:83], a[220:223], v[140:143], v[80:83]
    s_waitcnt lgkmcnt(9)
    ds_read_b64_tr_b16 a[166:167], v23 offset:12288
    v_mfma_f32_16x16x32_bf16 v[80:83], a[224:227], v[144:147], v[80:83]
    ds_read_b64_tr_b16 a[168:169], v23 offset:16384
    s_cmp_lg_u32 s36, s95
    s_cbranch_scc1 Lattn_xspin
Lattn_xgot:
    s_waitcnt lgkmcnt(9)
    v_mfma_f32_16x16x32_bf16 v[80:83], a[228:231], v[148:151], v[80:83]
    s_waitcnt lgkmcnt(7)
    ds_read_b64_tr_b16 a[170:171], v23 offset:20480
    v_mfma_f32_16x16x32_bf16 v[80:83], a[232:235], v[152:155], v[80:83]
    s_waitcnt lgkmcnt(6)
    ds_read_b64_tr_b16 a[172:173], v23 offset:24576
    v_mfma_f32_16x16x32_bf16 v[80:83], a[236:239], v[156:159], v[80:83]
    s_add_u32 s37, s55, 0
    ds_read_b64_tr_b16 a[174:175], v23 offset:28672
    v_mfma_f32_16x16x32_bf16 v[84:87], a[208:211], v[160:163], 0
    buffer_load_dwordx4 a[64:67], v252, s[28:31], s37 offen offset:0 sc1
    v_mfma_f32_16x16x32_bf16 v[84:87], a[212:215], v[164:167], v[84:87]
    ds_read_b64_tr_b16 a[176:177], v27 offset:0
    ds_read_b64_tr_b16 a[178:179], v27 offset:4096
    v_mfma_f32_16x16x32_bf16 v[84:87], a[216:219], v[168:171], v[84:87]
    buffer_load_dwordx4 a[68:71], v252, s[28:31], s37 offen offset:1024 sc1
    v_mfma_f32_16x16x32_bf16 v[84:87], a[220:223], v[172:175], v[84:87]
    ds_read_b64_tr_b16 a[180:181], v27 offset:8192
    ds_read_b64_tr_b16 a[182:183], v27 offset:12288
    v_mfma_f32_16x16x32_bf16 v[84:87], a[224:227], v[176:179], v[84:87]
    ds_read_b64_tr_b16 a[184:185], v27 offset:16384
    v_mfma_f32_16x16x32_bf16 v[84:87], a[228:231], v[180:183], v[84:87]
    ds_read_b64_tr_b16 a[186:187], v27 offset:20480
    v_mfma_f32_16x16x32_bf16 v[84:87], a[232:235], v[184:187], v[84:87]
    buffer_load_dwordx4 a[72:75], v252, s[28:31], s37 offen offset:2048 sc1
    v_mfma_f32_16x16x32_bf16 v[84:87], a[236:239], v[188:191], v[84:87]
    s_waitcnt lgkmcnt(12)
    ds_read_b64_tr_b16 a[188:189], v27 offset:24576
    ds_read_b64_tr_b16 a[190:191], v27 offset:28672
    s_barrier
    v_mfma_f32_16x16x32_bf16 v[88:91], a[160:163], v[128:131], 0
    s_waitcnt lgkmcnt(12)
    ds_read_b64_tr_b16 a[208:209], v12 offset:32768
    v_mfma_f32_16x16x32_bf16 v[88:91], a[164:167], v[132:135], v[88:91]
    s_waitcnt lgkmcnt(11)
    ds_read_b64_tr_b16 a[210:211], v12 offset:36864
    v_mfma_f32_16x16x32_bf16 v[88:91], a[168:171], v[136:139], v[88:91]
    s_waitcnt lgkmcnt(10)
    buffer_load_dwordx4 a[76:79], v252, s[28:31], s37 offen offset:3072 sc1
    v_mfma_f32_16x16x32_bf16 v[88:91], a[172:175], v[140:143], v[88:91]
    s_waitcnt lgkmcnt(8)
    ds_read_b64_tr_b16 a[212:213], v12 offset:40960
    ds_read_b64_tr_b16 a[214:215], v12 offset:45056
    v_mfma_f32_16x16x32_bf16 v[88:91], a[176:179], v[144:147], v[88:91]
    s_waitcnt lgkmcnt(8)
    ds_read_b64_tr_b16 a[216:217], v12 offset:49152
    v_mfma_f32_16x16x32_bf16 v[88:91], a[180:183], v[148:151], v[88:91]
    s_waitcnt lgkmcnt(7)
    s_add_u32 s37, s55, 4096
    ds_read_b64_tr_b16 a[218:219], v12 offset:53248
    v_mfma_f32_16x16x32_bf16 v[88:91], a[184:187], v[152:155], v[88:91]
    s_waitcnt lgkmcnt(6)
    s_add_u32 s49, s46, 256
    buffer_load_dwordx4 a[80:83], v252, s[28:31], s37 offen offset:0 sc1
    v_mfma_f32_16x16x32_bf16 v[88:91], a[188:191], v[156:159], v[88:91]
    s_add_u32 m0, s42, 0
    ds_read_b64_tr_b16 a[220:221], v12 offset:57344
    ds_read_b64_tr_b16 a[222:223], v12 offset:61440
    v_mfma_f32_16x16x32_bf16 v[92:95], a[160:163], v[160:163], 0
    buffer_load_dwordx4 v46, s[20:23], s49 offen lds
    v_mfma_f32_16x16x32_bf16 v[92:95], a[164:167], v[164:167], v[92:95]
    ds_read_b64_tr_b16 a[224:225], v16 offset:32768
    ds_read_b64_tr_b16 a[226:227], v16 offset:36864
    v_mfma_f32_16x16x32_bf16 v[92:95], a[168:171], v[168:171], v[92:95]
    buffer_load_dwordx4 v47, s[20:23], s49 offen offset:1024 lds
    v_mfma_f32_16x16x32_bf16 v[92:95], a[172:175], v[172:175], v[92:95]
    ds_read_b64_tr_b16 a[228:229], v16 offset:40960
    ds_read_b64_tr_b16 a[230:231], v16 offset:45056
    v_mfma_f32_16x16x32_bf16 v[92:95], a[176:179], v[176:179], v[92:95]
    buffer_load_dwordx4 a[84:87], v252, s[28:31], s37 offen offset:1024 sc1
    v_mfma_f32_16x16x32_bf16 v[92:95], a[180:183], v[180:183], v[92:95]
    ds_read_b64_tr_b16 a[232:233], v16 offset:49152
    ds_read_b64_tr_b16 a[234:235], v16 offset:53248
    v_mfma_f32_16x16x32_bf16 v[92:95], a[184:187], v[184:187], v[92:95]
    ds_read_b64_tr_b16 a[236:237], v16 offset:57344
    v_mfma_f32_16x16x32_bf16 v[92:95], a[188:191], v[188:191], v[92:95]
    s_waitcnt lgkmcnt(13)
    ds_read_b64_tr_b16 a[238:239], v16 offset:61440
    v_mfma_f32_16x16x32_bf16 v[96:99], a[208:211], v[128:131], 0
    s_waitcnt lgkmcnt(12)
    buffer_load_dwordx4 v48, s[20:23], s49 offen offset:2048 lds
    v_mfma_f32_16x16x32_bf16 v[96:99], a[212:215], v[132:135], v[96:99]
    s_waitcnt lgkmcnt(10)
    ds_read_b64_tr_b16 a[160:161], v13 offset:32768
    ds_read_b64_tr_b16 a[162:163], v13 offset:36864
    v_mfma_f32_16x16x32_bf16 v[96:99], a[216:219], v[136:139], v[96:99]
    s_waitcnt lgkmcnt(10)
    buffer_load_dwordx4 v49, s[20:23], s49 offen offset:3072 lds
    v_mfma_f32_16x16x32_bf16 v[96:99], a[220:223], v[140:143], v[96:99]
    s_waitcnt lgkmcnt(8)
    ds_read_b64_tr_b16 a[164:165], v13 offset:40960
    ds_read_b64_tr_b16 a[166:167], v13 offset:45056
    v_mfma_f32_16x16x32_bf16 v[96:99], a[224:227], v[144:147], v[96:99]
    s_waitcnt lgkmcnt(8)
    buffer_load_dwordx4 a[88:91], v252, s[28:31], s37 offen offset:2048 sc1
    v_mfma_f32_16x16x32_bf16 v[96:99], a[228:231], v[148:151], v[96:99]
    s_waitcnt lgkmcnt(6)
    ds_read_b64_tr_b16 a[168:169], v13 offset:49152
    ds_read_b64_tr_b16 a[170:171], v13 offset:53248
    v_mfma_f32_16x16x32_bf16 v[96:99], a[232:235], v[152:155], v[96:99]
    s_waitcnt lgkmcnt(6)
    s_add_u32 s49, s46, 73984
    ds_read_b64_tr_b16 a[172:173], v13 offset:57344
    v_mfma_f32_16x16x32_bf16 v[96:99], a[236:239], v[156:159], v[96:99]
    s_add_u32 m0, s42, 16384
    ds_read_b64_tr_b16 a[174:175], v13 offset:61440
    v_mfma_f32_16x16x32_bf16 v[100:103], a[208:211], v[160:163], 0
    buffer_load_dwordx4 v46, s[20:23], s49 offen lds
    v_mfma_f32_16x16x32_bf16 v[100:103], a[212:215], v[164:167], v[100:103]
    ds_read_b64_tr_b16 a[176:177], v17 offset:32768
    ds_read_b64_tr_b16 a[178:179], v17 offset:36864
    v_mfma_f32_16x16x32_bf16 v[100:103], a[216:219], v[168:171], v[100:103]
    buffer_load_dwordx4 v47, s[20:23], s49 offen offset:1024 lds
    v_mfma_f32_16x16x32_bf16 v[100:103], a[220:223], v[172:175], v[100:103]
    ds_read_b64_tr_b16 a[180:181], v17 offset:40960
    ds_read_b64_tr_b16 a[182:183], v17 offset:45056
    v_mfma_f32_16x16x32_bf16 v[100:103], a[224:227], v[176:179], v[100:103]
    buffer_load_dwordx4 a[92:95], v252, s[28:31], s37 offen offset:3072 sc1
    v_mfma_f32_16x16x32_bf16 v[100:103], a[228:231], v[180:183], v[100:103]
    ds_read_b64_tr_b16 a[184:185], v17 offset:49152
    ds_read_b64_tr_b16 a[186:187], v17 offset:53248
    v_mfma_f32_16x16x32_bf16 v[100:103], a[232:235], v[184:187], v[100:103]
    ds_read_b64_tr_b16 a[188:189], v17 offset:57344
    v_mfma_f32_16x16x32_bf16 v[100:103], a[236:239], v[188:191], v[100:103]
    s_waitcnt lgkmcnt(13)
    ds_read_b64_tr_b16 a[190:191], v17 offset:61440
    v_mfma_f32_16x16x32_bf16 v[104:107], a[160:163], v[128:131], 0
    s_waitcnt lgkmcnt(12)
    buffer_load_dwordx4 v48, s[20:23], s49 offen offset:2048 lds
    v_mfma_f32_16x16x32_bf16 v[104:107], a[164:167], v[132:135], v[104:107]
    s_waitcnt lgkmcnt(10)
    ds_read_b64_tr_b16 a[208:209], v14 offset:32768
    ds_read_b64_tr_b16 a[210:211], v14 offset:36864
    v_mfma_f32_16x16x32_bf16 v[104:107], a[168:171], v[136:139], v[104:107]
    s_waitcnt lgkmcnt(10)
    buffer_load_dwordx4 v49, s[20:23], s49 offen offset:3072 lds
    v_mfma_f32_16x16x32_bf16 v[104:107], a[172:175], v[140:143], v[104:107]
    s_waitcnt lgkmcnt(8)
    s_add_u32 s37, s55, 8192
    ds_read_b64_tr_b16 a[212:213], v14 offset:40960
    ds_read_b64_tr_b16 a[214:215], v14 offset:45056
    v_mfma_f32_16x16x32_bf16 v[104:107], a[176:179], v[144:147], v[104:107]
    s_waitcnt lgkmcnt(8)
    buffer_load_dwordx4 a[96:99], v252, s[28:31], s37 offen offset:0 sc1
    v_mfma_f32_16x16x32_bf16 v[104:107], a[180:183], v[148:151], v[104:107]
    s_waitcnt lgkmcnt(6)
    ds_read_b64_tr_b16 a[216:217], v14 offset:49152
    ds_read_b64_tr_b16 a[218:219], v14 offset:53248
    v_mfma_f32_16x16x32_bf16 v[104:107], a[184:187], v[152:155], v[104:107]
    s_waitcnt lgkmcnt(6)
    buffer_load_dwordx4 a[100:103], v252, s[28:31], s37 offen offset:1024 sc1
    v_mfma_f32_16x16x32_bf16 v[104:107], a[188:191], v[156:159], v[104:107]
    ds_read_b64_tr_b16 a[220:221], v14 offset:57344
    ds_read_b64_tr_b16 a[222:223], v14 offset:61440
    v_mfma_f32_16x16x32_bf16 v[108:111], a[160:163], v[160:163], 0
    ds_read_b64_tr_b16 a[224:225], v18 offset:32768
    v_mfma_f32_16x16x32_bf16 v[108:111], a[164:167], v[164:167], v[108:111]
    ds_read_b64_tr_b16 a[226:227], v18 offset:36864
    v_mfma_f32_16x16x32_bf16 v[108:111], a[168:171], v[168:171], v[108:111]
    buffer_load_dwordx4 a[104:107], v252, s[28:31], s37 offen offset:2048 sc1
    v_mfma_f32_16x16x32_bf16 v[108:111], a[172:175], v[172:175], v[108:111]
    ds_read_b64_tr_b16 a[228:229], v18 offset:40960
    ds_read_b64_tr_b16 a[230:231], v18 offset:45056
    v_mfma_f32_16x16x32_bf16 v[108:111], a[176:179], v[176:179], v[108:111]
    ds_read_b64_tr_b16 a[232:233], v18 offset:49152
    v_mfma_f32_16x16x32_bf16 v[108:111], a[180:183], v[180:183], v[108:111]
    ds_read_b64_tr_b16 a[234:235], v18 offset:53248
    v_mfma_f32_16x16x32_bf16 v[108:111], a[184:187], v[184:187], v[108:111]
    buffer_load_dwordx4 a[108:111], v252, s[28:31], s37 offen offset:3072 sc1
    v_mfma_f32_16x16x32_bf16 v[108:111], a[188:191], v[188:191], v[108:111]
    s_waitcnt lgkmcnt(12)
    ds_read_b64_tr_b16 a[236:237], v18 offset:57344
    ds_read_b64_tr_b16 a[238:239], v18 offset:61440
    v_mfma_f32_16x16x32_bf16 v[112:115], a[208:211], v[128:131], 0
    s_waitcnt lgkmcnt(12)
    ds_read_b64_tr_b16 a[160:161], v15 offset:32768
    v_mfma_f32_16x16x32_bf16 v[112:115], a[212:215], v[132:135], v[112:115]
    s_waitcnt lgkmcnt(11)
    s_add_u32 s37, s55, 12288
    ds_read_b64_tr_b16 a[162:163], v15 offset:36864
    v_mfma_f32_16x16x32_bf16 v[112:115], a[216:219], v[136:139], v[112:115]
    s_waitcnt lgkmcnt(10)
    buffer_load_dwordx4 a[112:115], v252, s[28:31], s37 offen offset:0 sc1
    v_mfma_f32_16x16x32_bf16 v[112:115], a[220:223], v[140:143], v[112:115]
    s_waitcnt lgkmcnt(8)
    ds_read_b64_tr_b16 a[164:165], v15 offset:40960
    ds_read_b64_tr_b16 a[166:167], v15 offset:45056
    v_mfma_f32_16x16x32_bf16 v[112:115], a[224:227], v[144:147], v[112:115]
    s_waitcnt lgkmcnt(8)
    buffer_load_dwordx4 a[116:119], v252, s[28:31], s37 offen offset:1024 sc1
    v_mfma_f32_16x16x32_bf16 v[112:115], a[228:231], v[148:151], v[112:115]
    s_waitcnt lgkmcnt(6)
    ds_read_b64_tr_b16 a[168:169], v15 offset:49152
    ds_read_b64_tr_b16 a[170:171], v15 offset:53248
    v_mfma_f32_16x16x32_bf16 v[112:115], a[232:235], v[152:155], v[112:115]
    s_waitcnt lgkmcnt(6)
    ds_read_b64_tr_b16 a[172:173], v15 offset:57344
    v_mfma_f32_16x16x32_bf16 v[112:115], a[236:239], v[156:159], v[112:115]
    ds_read_b64_tr_b16 a[174:175], v15 offset:61440
    v_mfma_f32_16x16x32_bf16 v[116:119], a[208:211], v[160:163], 0
    buffer_load_dwordx4 a[120:123], v252, s[28:31], s37 offen offset:2048 sc1
    v_mfma_f32_16x16x32_bf16 v[116:119], a[212:215], v[164:167], v[116:119]
    ds_read_b64_tr_b16 a[176:177], v19 offset:32768
    ds_read_b64_tr_b16 a[178:179], v19 offset:36864
    v_mfma_f32_16x16x32_bf16 v[116:119], a[216:219], v[168:171], v[116:119]
    ds_read_b64_tr_b16 a[180:181], v19 offset:40960
    v_mfma_f32_16x16x32_bf16 v[116:119], a[220:223], v[172:175], v[116:119]
    ds_read_b64_tr_b16 a[182:183], v19 offset:45056
    v_mfma_f32_16x16x32_bf16 v[116:119], a[224:227], v[176:179], v[116:119]
    buffer_load_dwordx4 a[124:127], v252, s[28:31], s37 offen offset:3072 sc1
    v_mfma_f32_16x16x32_bf16 v[116:119], a[228:231], v[180:183], v[116:119]
    ds_read_b64_tr_b16 a[184:185], v19 offset:49152
    ds_read_b64_tr_b16 a[186:187], v19 offset:53248
    v_mfma_f32_16x16x32_bf16 v[116:119], a[232:235], v[184:187], v[116:119]
    ds_read_b64_tr_b16 a[188:189], v19 offset:57344
    v_mfma_f32_16x16x32_bf16 v[116:119], a[236:239], v[188:191], v[116:119]
    ds_read_b64_tr_b16 a[190:191], v19 offset:61440
    s_waitcnt vmcnt(25)
    s_waitcnt lgkmcnt(0)
    s_barrier
    v_mfma_f32_16x16x32_bf16 v[120:123], a[160:163], v[128:131], 0
    ds_read_b64_tr_b16 a[208:209], v20 offset:32768
    v_mfma_f32_16x16x32_bf16 v[120:123], a[164:167], v[132:135], v[120:123]
    ds_read_b64_tr_b16 a[210:211], v20 offset:36864
    v_mfma_f32_16x16x32_bf16 v[120:123], a[168:171], v[136:139], v[120:123]
    ds_read_b64_tr_b16 a[212:213], v20 offset:40960
    v_mfma_f32_16x16x32_bf16 v[120:123], a[172:175], v[140:143], v[120:123]
    ds_read_b64_tr_b16 a[214:215], v20 offset:45056
    v_mfma_f32_16x16x32_bf16 v[120:123], a[176:179], v[144:147], v[120:123]
    ds_read_b64_tr_b16 a[216:217], v20 offset:49152
    v_mfma_f32_16x16x32_bf16 v[120:123], a[180:183], v[148:151], v[120:123]
    ds_read_b64_tr_b16 a[218:219], v20 offset:53248
    v_mfma_f32_16x16x32_bf16 v[120:123], a[184:187], v[152:155], v[120:123]
    s_add_u32 s49, s7, 512
    ds_read_b64_tr_b16 a[220:221], v20 offset:57344
    v_mfma_f32_16x16x32_bf16 v[120:123], a[188:191], v[156:159], v[120:123]
    s_add_u32 m0, s42, 65536
    ds_read_b64_tr_b16 a[222:223], v20 offset:61440
    v_mfma_f32_16x16x32_bf16 v[124:127], a[160:163], v[160:163], 0
Ltour9:
    s_cbranch_execz Ltour13
    buffer_load_dwordx4 v46, s[20:23], s49 offen lds
    v_mfma_f32_16x16x32_bf16 v[124:127], a[164:167], v[164:167], v[124:127]
    ds_read_b64_tr_b16 a[224:225], v24 offset:32768
    ds_read_b64_tr_b16 a[226:227], v24 offset:36864
    v_mfma_f32_16x16x32_bf16 v[124:127], a[168:171], v[168:171], v[124:127]
    buffer_load_dwordx4 v47, s[20:23], s49 offen offset:1024 lds
    v_mfma_f32_16x16x32_bf16 v[124:127], a[172:175], v[172:175], v[124:127]
    ds_read_b64_tr_b16 a[228:229], v24 offset:40960
    ds_read_b64_tr_b16 a[230:231], v24 offset:45056
    v_mfma_f32_16x16x32_bf16 v[124:127], a[176:179], v[176:179], v[124:127]
    ds_read_b64_tr_b16 a[232:233], v24 offset:49152
    v_mfma_f32_16x16x32_bf16 v[124:127], a[180:183], v[180:183], v[124:127]
    ds_read_b64_tr_b16 a[234:235], v24 offset:53248
    v_mfma_f32_16x16x32_bf16 v[124:127], a[184:187], v[184:187], v[124:127]
    ds_read_b64_tr_b16 a[236:237], v24 offset:57344
    v_mfma_f32_16x16x32_bf16 v[124:127], a[188:191], v[188:191], v[124:127]
    s_waitcnt vmcnt(25)
    s_waitcnt lgkmcnt(13)
    ds_read_b64_tr_b16 a[238:239], v24 offset:61440
    v_mfma_f32_16x16x32_bf16 v[64:67], a[208:211], a[64:67], v[64:67]
    s_waitcnt vmcnt(24)
    s_waitcnt lgkmcnt(12)
    buffer_load_dwordx4 v48, s[20:23], s49 offen offset:2048 lds
    v_mfma_f32_16x16x32_bf16 v[64:67], a[212:215], a[68:71], v[64:67]
    s_waitcnt vmcnt(24)
    s_waitcnt lgkmcnt(10)
    s_lshl_b32 s40, s5, 4
    ds_read_b64_tr_b16 a[160:161], v21 offset:32768
    ds_read_b64_tr_b16 a[162:163], v21 offset:36864
    v_mfma_f32_16x16x32_bf16 v[64:67], a[216:219], a[72:75], v[64:67]
    s_waitcnt vmcnt(23)
    s_waitcnt lgkmcnt(10)
    buffer_load_dwordx4 v49, s[20:23], s49 offen offset:3072 lds
    v_mfma_f32_16x16x32_bf16 v[64:67], a[220:223], a[76:79], v[64:67]
    s_waitcnt vmcnt(23)
    s_waitcnt lgkmcnt(8)
    s_add_u32 s40, s40, s4
    ds_read_b64_tr_b16 a[164:165], v21 offset:40960
    ds_read_b64_tr_b16 a[166:167], v21 offset:45056
    v_mfma_f32_16x16x32_bf16 v[64:67], a[224:227], a[80:83], v[64:67]
    s_waitcnt vmcnt(20)
    s_waitcnt lgkmcnt(8)
    ds_read_b64_tr_b16 a[168:169], v21 offset:49152
    v_and_b32 v240, 31, v1
    v_mfma_f32_16x16x32_bf16 v[64:67], a[228:231], a[84:87], v[64:67]
    s_waitcnt vmcnt(17)
    s_waitcnt lgkmcnt(7)
    ds_read_b64_tr_b16 a[170:171], v21 offset:53248
    v_lshrrev_b32 v241, 5, v1
    v_mfma_f32_16x16x32_bf16 v[64:67], a[232:235], a[88:91], v[64:67]
    s_waitcnt vmcnt(14)
    s_waitcnt lgkmcnt(6)
    s_add_u32 s49, s7, 74240
    ds_read_b64_tr_b16 a[172:173], v21 offset:57344
    v_cmp_gt_u32 vcc, 8, v240
    v_mfma_f32_16x16x32_bf16 v[64:67], a[236:239], a[92:95], v[64:67]
    s_waitcnt vmcnt(11)
    s_add_u32 m0, s42, 81920
    ds_read_b64_tr_b16 a[174:175], v21 offset:61440
    v_mov_b32 v242, 2147483648
    v_mfma_f32_16x16x32_bf16 v[68:71], a[208:211], a[96:99], v[68:71]
    s_waitcnt vmcnt(10)
    buffer_load_dwordx4 v46, s[20:23], s49 offen lds
    v_mfma_f32_16x16x32_bf16 v[68:71], a[212:215], a[100:103], v[68:71]
    s_waitcnt vmcnt(10)
    s_lshl_b32 s43, s40, 3
    ds_read_b64_tr_b16 a[176:177], v25 offset:32768
    ds_read_b64_tr_b16 a[178:179], v25 offset:36864
    v_mfma_f32_16x16x32_bf16 v[68:71], a[216:219], a[104:107], v[68:71]
    s_waitcnt vmcnt(9)
    buffer_load_dwordx4 v47, s[20:23], s49 offen offset:1024 lds
    v_mfma_f32_16x16x32_bf16 v[68:71], a[220:223], a[108:111], v[68:71]
    s_waitcnt vmcnt(9)
    s_lshl_b32 s44, s3, 1
    ds_read_b64_tr_b16 a[180:181], v25 offset:40960
    ds_read_b64_tr_b16 a[182:183], v25 offset:45056
    v_mfma_f32_16x16x32_bf16 v[68:71], a[224:227], a[112:115], v[68:71]
    s_waitcnt vmcnt(8)
    ds_read_b64_tr_b16 a[184:185], v25 offset:49152
    v_cvt_pk_bf16_f32 v224, v64, v65
    v_mfma_f32_16x16x32_bf16 v[68:71], a[228:231], a[116:119], v[68:71]
    s_waitcnt vmcnt(7)
    ds_read_b64_tr_b16 a[186:187], v25 offset:53248
    v_cvt_pk_bf16_f32 v225, v66, v67
    v_mfma_f32_16x16x32_bf16 v[68:71], a[232:235], a[120:123], v[68:71]
    s_waitcnt vmcnt(6)
    s_add_u32 s43, s43, s44
    ds_read_b64_tr_b16 a[188:189], v25 offset:57344
    v_cndmask_b32 v242, v242, 0, vcc
    v_mfma_f32_16x16x32_bf16 v[68:71], a[236:239], a[124:127], v[68:71]
    s_waitcnt lgkmcnt(13)
    ds_read_b64_tr_b16 a[190:191], v25 offset:61440
    v_add_u32 v7, s43, v241
    v_mfma_f32_16x16x32_bf16 v[72:75], a[160:163], a[64:67], v[72:75]
    s_waitcnt lgkmcnt(12)
    buffer_load_dwordx4 v48, s[20:23], s49 offen offset:2048 lds
    v_mfma_f32_16x16x32_bf16 v[72:75], a[164:167], a[68:71], v[72:75]
    s_waitcnt lgkmcnt(10)
    ds_read_b64_tr_b16 a[208:209], v22 offset:32768
    ds_read_b64_tr_b16 a[210:211], v22 offset:36864
    v_mfma_f32_16x16x32_bf16 v[72:75], a[168:171], a[72:75], v[72:75]
    s_waitcnt lgkmcnt(10)
    buffer_load_dwordx4 v49, s[20:23], s49 offen offset:3072 lds
    v_mfma_f32_16x16x32_bf16 v[72:75], a[172:175], a[76:79], v[72:75]
    s_waitcnt lgkmcnt(8)
    ds_read_b64_tr_b16 a[212:213], v22 offset:40960
    ds_read_b64_tr_b16 a[214:215], v22 offset:45056
    v_mfma_f32_16x16x32_bf16 v[72:75], a[176:179], a[80:83], v[72:75]
    s_waitcnt lgkmcnt(8)
    ds_read_b64_tr_b16 a[216:217], v22 offset:49152
    v_cvt_pk_bf16_f32 v228, v68, v69
    v_mfma_f32_16x16x32_bf16 v[72:75], a[180:183], a[84:87], v[72:75]
    s_waitcnt lgkmcnt(7)
    ds_read_b64_tr_b16 a[218:219], v22 offset:53248
    v_cvt_pk_bf16_f32 v229, v70, v71
    v_mfma_f32_16x16x32_bf16 v[72:75], a[184:187], a[88:91], v[72:75]
    s_waitcnt lgkmcnt(6)
    ds_read_b64_tr_b16 a[220:221], v22 offset:57344
    v_lshlrev_b32 v5, 4, v240
    v_mfma_f32_16x16x32_bf16 v[72:75], a[188:191], a[92:95], v[72:75]
    ds_read_b64_tr_b16 a[222:223], v22 offset:61440
    v_lshlrev_b32 v243, 4, v241
    v_mfma_f32_16x16x32_bf16 v[76:79], a[160:163], a[96:99], v[76:79]
    ds_read_b64_tr_b16 a[224:225], v26 offset:32768
    v_lshl_add_u32 v2, v240, 5, v243
    v_mfma_f32_16x16x32_bf16 v[76:79], a[164:167], a[100:103], v[76:79]
    s_mul_i32 s44, s43, 10240
    ds_read_b64_tr_b16 a[226:227], v26 offset:36864
    v_lshrrev_b32 v243, 2, v240
    v_mfma_f32_16x16x32_bf16 v[76:79], a[168:171], a[104:107], v[76:79]
    ds_read_b64_tr_b16 a[228:229], v26 offset:40960
    v_lshlrev_b32 v243, 6, v243
    v_mfma_f32_16x16x32_bf16 v[76:79], a[172:175], a[108:111], v[76:79]
    ds_read_b64_tr_b16 a[230:231], v26 offset:45056
    v_and_b32 v241, 3, v240
    v_mfma_f32_16x16x32_bf16 v[76:79], a[176:179], a[112:115], v[76:79]
    ds_read_b64_tr_b16 a[232:233], v26 offset:49152
    v_cvt_pk_bf16_f32 v226, v72, v73
    v_mfma_f32_16x16x32_bf16 v[76:79], a[180:183], a[116:119], v[76:79]
    s_add_u32 s38, s93, 0
    ds_read_b64_tr_b16 a[234:235], v26 offset:53248
    v_cvt_pk_bf16_f32 v227, v74, v75
    v_mfma_f32_16x16x32_bf16 v[76:79], a[184:187], a[120:123], v[76:79]
    buffer_store_dwordx4 v[224:227], v56, s[28:31], s38 offen sc1
    v_mfma_f32_16x16x32_bf16 v[76:79], a[188:191], a[124:127], v[76:79]
    s_waitcnt lgkmcnt(12)
    ds_read_b64_tr_b16 a[236:237], v26 offset:57344
    ds_read_b64_tr_b16 a[238:239], v26 offset:61440
    v_mfma_f32_16x16x32_bf16 v[80:83], a[208:211], a[64:67], v[80:83]
    s_waitcnt lgkmcnt(12)
    ds_read_b64_tr_b16 a[160:161], v23 offset:32768
    v_lshl_add_u32 v3, v241, 3, v243
    v_mfma_f32_16x16x32_bf16 v[80:83], a[212:215], a[68:71], v[80:83]
    s_waitcnt lgkmcnt(11)
    ds_read_b64_tr_b16 a[162:163], v23 offset:36864
    v_mul_u32_u24 v243, 1152, v7
    v_mfma_f32_16x16x32_bf16 v[80:83], a[216:219], a[72:75], v[80:83]
    s_waitcnt lgkmcnt(10)
    ds_read_b64_tr_b16 a[164:165], v23 offset:40960
    v_add_u32 v4, v243, v3
    v_mfma_f32_16x16x32_bf16 v[80:83], a[220:223], a[76:79], v[80:83]
    s_waitcnt lgkmcnt(9)
    ds_read_b64_tr_b16 a[166:167], v23 offset:45056
    v_lshl_add_u32 v6, v243, 1, v5
    v_mfma_f32_16x16x32_bf16 v[80:83], a[224:227], a[80:83], v[80:83]
    s_waitcnt lgkmcnt(8)
    ds_read_b64_tr_b16 a[168:169], v23 offset:49152
    v_cvt_pk_bf16_f32 v230, v76, v77
    v_mfma_f32_16x16x32_bf16 v[80:83], a[228:231], a[84:87], v[80:83]
    s_waitcnt lgkmcnt(7)
    s_add_u32 s38, s93, 163840
    ds_read_b64_tr_b16 a[170:171], v23 offset:53248
    v_cvt_pk_bf16_f32 v231, v78, v79
    v_mfma_f32_16x16x32_bf16 v[80:83], a[232:235], a[88:91], v[80:83]
    s_waitcnt lgkmcnt(6)
    buffer_store_dwordx4 v[228:231], v56, s[28:31], s38 offen sc1
    v_mfma_f32_16x16x32_bf16 v[80:83], a[236:239], a[92:95], v[80:83]
    ds_read_b64_tr_b16 a[172:173], v23 offset:57344
    ds_read_b64_tr_b16 a[174:175], v23 offset:61440
    v_mfma_f32_16x16x32_bf16 v[84:87], a[208:211], a[96:99], v[84:87]
    ds_read_b64_tr_b16 a[176:177], v27 offset:32768
    v_or_b32 v55, v3, v242
    v_mfma_f32_16x16x32_bf16 v[84:87], a[212:215], a[100:103], v[84:87]
    ds_read_b64_tr_b16 a[178:179], v27 offset:36864
    v_or_b32 v58, v4, v242
    v_mfma_f32_16x16x32_bf16 v[84:87], a[216:219], a[104:107], v[84:87]
    ds_read_b64_tr_b16 a[180:181], v27 offset:40960
    v_or_b32 v59, v5, v242
    v_mfma_f32_16x16x32_bf16 v[84:87], a[220:223], a[108:111], v[84:87]
    ds_read_b64_tr_b16 a[182:183], v27 offset:45056
    v_or_b32 v60, v6, v242
    v_mfma_f32_16x16x32_bf16 v[84:87], a[224:227], a[112:115], v[84:87]
    ds_read_b64_tr_b16 a[184:185], v27 offset:49152
    v_cvt_pk_bf16_f32 v232, v80, v81
    v_mfma_f32_16x16x32_bf16 v[84:87], a[228:231], a[116:119], v[84:87]
    ds_read_b64_tr_b16 a[186:187], v27 offset:53248
    v_cvt_pk_bf16_f32 v233, v82, v83
    v_mfma_f32_16x16x32_bf16 v[84:87], a[232:235], a[120:123], v[84:87]
    ds_read_b64_tr_b16 a[188:189], v27 offset:57344
    v_lshrrev_b32 v243, 4, v1
    v_mfma_f32_16x16x32_bf16 v[84:87], a[236:239], a[124:127], v[84:87]
    s_waitcnt lgkmcnt(13)
    ds_read_b64_tr_b16 a[190:191], v27 offset:61440
    v_lshlrev_b32 v243, 8, v243
    s_barrier
    v_mfma_f32_16x16x32_bf16 v[88:91], a[160:163], a[64:67], v[88:91]
    s_waitcnt lgkmcnt(12)
    ds_read_b64_tr_b16 a[208:209], v12 offset:0
    v_and_b32 v241, 7, v1
    v_mfma_f32_16x16x32_bf16 v[88:91], a[164:167], a[68:71], v[88:91]
    s_waitcnt lgkmcnt(11)
    ds_read_b64_tr_b16 a[210:211], v12 offset:4096
    v_lshl_add_u32 v243, v241, 5, v243
    v_mfma_f32_16x16x32_bf16 v[88:91], a[168:171], a[72:75], v[88:91]
    s_waitcnt lgkmcnt(10)
    ds_read_b64_tr_b16 a[212:213], v12 offset:8192
    v_and_b32 v241, 8, v1
    v_mfma_f32_16x16x32_bf16 v[88:91], a[172:175], a[76:79], v[88:91]
    s_waitcnt lgkmcnt(9)
    ds_read_b64_tr_b16 a[214:215], v12 offset:12288
    v_lshl_add_u32 v54, v241, 1, v243
    v_mfma_f32_16x16x32_bf16 v[88:91], a[176:179], a[80:83], v[88:91]
    s_waitcnt lgkmcnt(8)
    ds_read_b64_tr_b16 a[216:217], v12 offset:16384
    v_cvt_pk_bf16_f32 v236, v84, v85
    v_mfma_f32_16x16x32_bf16 v[88:91], a[180:183], a[84:87], v[88:91]
    s_waitcnt lgkmcnt(7)
    ds_read_b64_tr_b16 a[218:219], v12 offset:20480
    v_cvt_pk_bf16_f32 v237, v86, v87
    v_mfma_f32_16x16x32_bf16 v[88:91], a[184:187], a[88:91], v[88:91]
    s_waitcnt lgkmcnt(6)
    s_add_u32 s49, s46, 512
    ds_read_b64_tr_b16 a[220:221], v12 offset:24576
    v_mfma_f32_16x16x32_bf16 v[88:91], a[188:191], a[92:95], v[88:91]
    s_add_u32 m0, s42, 32768
    ds_read_b64_tr_b16 a[222:223], v12 offset:28672
    v_mfma_f32_16x16x32_bf16 v[92:95], a[160:163], a[96:99], v[92:95]
    buffer_load_dwordx4 v46, s[20:23], s49 offen lds
    v_mfma_f32_16x16x32_bf16 v[92:95], a[164:167], a[100:103], v[92:95]
    s_lshr_b32 s41, s2, 3
    ds_read_b64_tr_b16 a[224:225], v16 offset:0
    ds_read_b64_tr_b16 a[226:227], v16 offset:4096
    v_mfma_f32_16x16x32_bf16 v[92:95], a[168:171], a[104:107], v[92:95]
    buffer_load_dwordx4 v47, s[20:23], s49 offen offset:1024 lds
    v_mfma_f32_16x16x32_bf16 v[92:95], a[172:175], a[108:111], v[92:95]
    s_mov_b32 s14, 2359296
    ds_read_b64_tr_b16 a[228:229], v16 offset:8192
    ds_read_b64_tr_b16 a[230:231], v16 offset:12288
    v_mfma_f32_16x16x32_bf16 v[92:95], a[176:179], a[112:115], v[92:95]
    ds_read_b64_tr_b16 a[232:233], v16 offset:16384
    v_cvt_pk_bf16_f32 v234, v88, v89
    v_mfma_f32_16x16x32_bf16 v[92:95], a[180:183], a[116:119], v[92:95]
    s_add_u32 s38, s93, 128
    ds_read_b64_tr_b16 a[234:235], v16 offset:20480
    v_cvt_pk_bf16_f32 v235, v90, v91
    v_mfma_f32_16x16x32_bf16 v[92:95], a[184:187], a[120:123], v[92:95]
    buffer_store_dwordx4 v[232:235], v56, s[28:31], s38 offen sc1
    v_mfma_f32_16x16x32_bf16 v[92:95], a[188:191], a[124:127], v[92:95]
    s_waitcnt lgkmcnt(12)
    s_mov_b32 s15, 0x20000
    ds_read_b64_tr_b16 a[236:237], v16 offset:24576
    ds_read_b64_tr_b16 a[238:239], v16 offset:28672
    v_mfma_f32_16x16x32_bf16 v[96:99], a[208:211], a[64:67], v[96:99]
    s_waitcnt lgkmcnt(12)
    buffer_load_dwordx4 v48, s[20:23], s49 offen offset:2048 lds
    v_mfma_f32_16x16x32_bf16 v[96:99], a[212:215], a[68:71], v[96:99]
    s_waitcnt lgkmcnt(10)
    s_mov_b32 s18, 2359296
    ds_read_b64_tr_b16 a[160:161], v13 offset:0
    ds_read_b64_tr_b16 a[162:163], v13 offset:4096
    v_mfma_f32_16x16x32_bf16 v[96:99], a[216:219], a[72:75], v[96:99]
    s_waitcnt lgkmcnt(10)
    buffer_load_dwordx4 v49, s[20:23], s49 offen offset:3072 lds
    v_mfma_f32_16x16x32_bf16 v[96:99], a[220:223], a[76:79], v[96:99]
    s_waitcnt lgkmcnt(8)
    s_mov_b32 s19, 0x20000
    ds_read_b64_tr_b16 a[164:165], v13 offset:8192
    ds_read_b64_tr_b16 a[166:167], v13 offset:12288
    v_mfma_f32_16x16x32_bf16 v[96:99], a[224:227], a[80:83], v[96:99]
    s_waitcnt lgkmcnt(8)
    ds_read_b64_tr_b16 a[168:169], v13 offset:16384
    v_cvt_pk_bf16_f32 v238, v92, v93
    v_mfma_f32_16x16x32_bf16 v[96:99], a[228:231], a[84:87], v[96:99]
    s_waitcnt lgkmcnt(7)
    s_add_u32 s38, s93, 163968
    ds_read_b64_tr_b16 a[170:171], v13 offset:20480
    v_cvt_pk_bf16_f32 v239, v94, v95
    v_mfma_f32_16x16x32_bf16 v[96:99], a[232:235], a[88:91], v[96:99]
    s_waitcnt lgkmcnt(6)
    s_add_u32 s49, s46, 74240
    buffer_store_dwordx4 v[236:239], v56, s[28:31], s38 offen sc1
    v_mfma_f32_16x16x32_bf16 v[96:99], a[236:239], a[92:95], v[96:99]
    s_add_u32 m0, s42, 49152
    ds_read_b64_tr_b16 a[172:173], v13 offset:24576
    ds_read_b64_tr_b16 a[174:175], v13 offset:28672
    v_mfma_f32_16x16x32_bf16 v[100:103], a[208:211], a[96:99], v[100:103]
    buffer_load_dwordx4 v46, s[20:23], s49 offen lds
    v_mfma_f32_16x16x32_bf16 v[100:103], a[212:215], a[100:103], v[100:103]
    s_add_u32 s8, s50, 7864320
    s_addc_u32 s9, s51, 0
    ds_read_b64_tr_b16 a[176:177], v17 offset:0
    ds_read_b64_tr_b16 a[178:179], v17 offset:4096
    v_mfma_f32_16x16x32_bf16 v[100:103], a[216:219], a[104:107], v[100:103]
    buffer_load_dwordx4 v47, s[20:23], s49 offen offset:1024 lds
    v_mfma_f32_16x16x32_bf16 v[100:103], a[220:223], a[108:111], v[100:103]
    s_mov_b32 s10, 663552
    ds_read_b64_tr_b16 a[180:181], v17 offset:8192
    ds_read_b64_tr_b16 a[182:183], v17 offset:12288
    v_mfma_f32_16x16x32_bf16 v[100:103], a[224:227], a[112:115], v[100:103]
    ds_read_b64_tr_b16 a[184:185], v17 offset:16384
    v_cvt_pk_bf16_f32 v224, v96, v97
    v_mfma_f32_16x16x32_bf16 v[100:103], a[228:231], a[116:119], v[100:103]
    ds_read_b64_tr_b16 a[186:187], v17 offset:20480
    v_cvt_pk_bf16_f32 v225, v98, v99
    v_mfma_f32_16x16x32_bf16 v[100:103], a[232:235], a[120:123], v[100:103]
    s_mov_b32 s11, 0x20000
    ds_read_b64_tr_b16 a[188:189], v17 offset:24576
    v_mfma_f32_16x16x32_bf16 v[100:103], a[236:239], a[124:127], v[100:103]
    s_waitcnt lgkmcnt(13)
    s_lshl_b32 s39, s5, 13
    ds_read_b64_tr_b16 a[190:191], v17 offset:28672
    v_mfma_f32_16x16x32_bf16 v[104:107], a[160:163], a[64:67], v[104:107]
    s_waitcnt lgkmcnt(12)
    buffer_load_dwordx4 v48, s[20:23], s49 offen offset:2048 lds
    v_mfma_f32_16x16x32_bf16 v[104:107], a[164:167], a[68:71], v[104:107]
    s_waitcnt lgkmcnt(10)
    s_add_u32 s39, s39, 8781824
    ds_read_b64_tr_b16 a[208:209], v14 offset:0
    ds_read_b64_tr_b16 a[210:211], v14 offset:4096
    v_mfma_f32_16x16x32_bf16 v[104:107], a[168:171], a[72:75], v[104:107]
    s_waitcnt lgkmcnt(10)
    buffer_load_dwordx4 v49, s[20:23], s49 offen offset:3072 lds
    v_mfma_f32_16x16x32_bf16 v[104:107], a[172:175], a[76:79], v[104:107]
    s_waitcnt lgkmcnt(8)
    s_lshr_b32 s45, s4, 2
    ds_read_b64_tr_b16 a[212:213], v14 offset:8192
    ds_read_b64_tr_b16 a[214:215], v14 offset:12288
    v_mfma_f32_16x16x32_bf16 v[104:107], a[176:179], a[80:83], v[104:107]
    s_waitcnt lgkmcnt(8)
    ds_read_b64_tr_b16 a[216:217], v14 offset:16384
    v_cvt_pk_bf16_f32 v228, v100, v101
    v_mfma_f32_16x16x32_bf16 v[104:107], a[180:183], a[84:87], v[104:107]
    s_waitcnt lgkmcnt(7)
    ds_read_b64_tr_b16 a[218:219], v14 offset:20480
    v_cvt_pk_bf16_f32 v229, v102, v103
    v_mfma_f32_16x16x32_bf16 v[104:107], a[184:187], a[88:91], v[104:107]
    s_waitcnt lgkmcnt(6)
    s_lshl_b32 s45, s45, 11
    ds_read_b64_tr_b16 a[220:221], v14 offset:24576
    v_mfma_f32_16x16x32_bf16 v[104:107], a[188:191], a[92:95], v[104:107]
    s_add_u32 s39, s39, s45
    ds_read_b64_tr_b16 a[222:223], v14 offset:28672
    v_and_b32 v9, 15, v1
    v_mfma_f32_16x16x32_bf16 v[108:111], a[160:163], a[96:99], v[108:111]
    ds_read_b64_tr_b16 a[224:225], v18 offset:0
    v_lshlrev_b32 v9, 7, v9
    v_mfma_f32_16x16x32_bf16 v[108:111], a[164:167], a[100:103], v[108:111]
    ds_read_b64_tr_b16 a[226:227], v18 offset:4096
    v_lshrrev_b32 v240, 4, v1
    v_mfma_f32_16x16x32_bf16 v[108:111], a[168:171], a[104:107], v[108:111]
    ds_read_b64_tr_b16 a[228:229], v18 offset:8192
    v_bfe_u32 v241, v1, 2, 2
    v_mfma_f32_16x16x32_bf16 v[108:111], a[172:175], a[108:111], v[108:111]
    ds_read_b64_tr_b16 a[230:231], v18 offset:12288
    v_cmp_eq_u32 s[54:55], v240, v241
    v_mfma_f32_16x16x32_bf16 v[108:111], a[176:179], a[112:115], v[108:111]
    ds_read_b64_tr_b16 a[232:233], v18 offset:16384
    v_cvt_pk_bf16_f32 v226, v104, v105
    v_mfma_f32_16x16x32_bf16 v[108:111], a[180:183], a[116:119], v[108:111]
    s_add_u32 s38, s93, 512
    ds_read_b64_tr_b16 a[234:235], v18 offset:20480
    v_cvt_pk_bf16_f32 v227, v106, v107
    v_mfma_f32_16x16x32_bf16 v[108:111], a[184:187], a[120:123], v[108:111]
    buffer_store_dwordx4 v[224:227], v56, s[28:31], s38 offen sc1
    v_mfma_f32_16x16x32_bf16 v[108:111], a[188:191], a[124:127], v[108:111]
    s_waitcnt lgkmcnt(12)
    ds_read_b64_tr_b16 a[236:237], v18 offset:24576
    ds_read_b64_tr_b16 a[238:239], v18 offset:28672
    v_mfma_f32_16x16x32_bf16 v[112:115], a[208:211], a[64:67], v[112:115]
    s_waitcnt lgkmcnt(12)
    ds_read_b64_tr_b16 a[160:161], v15 offset:0
    v_and_b32 v240, 1, v1
    v_mfma_f32_16x16x32_bf16 v[112:115], a[212:215], a[68:71], v[112:115]
    s_waitcnt lgkmcnt(11)
    ds_read_b64_tr_b16 a[162:163], v15 offset:4096
    v_lshlrev_b32 v240, 4, v240
    v_mfma_f32_16x16x32_bf16 v[112:115], a[216:219], a[72:75], v[112:115]
    s_waitcnt lgkmcnt(10)
    ds_read_b64_tr_b16 a[164:165], v15 offset:8192
    v_mov_b32 v241, 0x3f80
    v_mfma_f32_16x16x32_bf16 v[112:115], a[220:223], a[76:79], v[112:115]
    s_waitcnt lgkmcnt(9)
    ds_read_b64_tr_b16 a[166:167], v15 offset:12288
    v_lshlrev_b32 v240, v240, v241
    v_mfma_f32_16x16x32_bf16 v[112:115], a[224:227], a[80:83], v[112:115]
    s_waitcnt lgkmcnt(8)
    ds_read_b64_tr_b16 a[168:169], v15 offset:16384
    v_cvt_pk_bf16_f32 v230, v108, v109
    v_mfma_f32_16x16x32_bf16 v[112:115], a[228:231], a[84:87], v[112:115]
    s_waitcnt lgkmcnt(7)
    s_add_u32 s38, s93, 164352
    ds_read_b64_tr_b16 a[170:171], v15 offset:20480
    v_cvt_pk_bf16_f32 v231, v110, v111
    v_mfma_f32_16x16x32_bf16 v[112:115], a[232:235], a[88:91], v[112:115]
    s_waitcnt lgkmcnt(6)
    buffer_store_dwordx4 v[228:231], v56, s[28:31], s38 offen sc1
    v_mfma_f32_16x16x32_bf16 v[112:115], a[236:239], a[92:95], v[112:115]
    ds_read_b64_tr_b16 a[172:173], v15 offset:24576
    ds_read_b64_tr_b16 a[174:175], v15 offset:28672
    v_mfma_f32_16x16x32_bf16 v[116:119], a[208:211], a[96:99], v[116:119]
    ds_read_b64_tr_b16 a[176:177], v19 offset:0
    v_bfe_i32 v241, v1, 1, 1
    v_mfma_f32_16x16x32_bf16 v[116:119], a[212:215], a[100:103], v[116:119]
    ds_read_b64_tr_b16 a[178:179], v19 offset:4096
    v_and_b32 v243, v240, v241
    v_mfma_f32_16x16x32_bf16 v[116:119], a[216:219], a[104:107], v[116:119]
    ds_read_b64_tr_b16 a[180:181], v19 offset:8192
    v_xor_b32 v242, v240, v243
    v_mfma_f32_16x16x32_bf16 v[116:119], a[220:223], a[108:111], v[116:119]
    ds_read_b64_tr_b16 a[182:183], v19 offset:12288
    v_cndmask_b32 v250, 0, v242, s[54:55]
    v_mfma_f32_16x16x32_bf16 v[116:119], a[224:227], a[112:115], v[116:119]
    ds_read_b64_tr_b16 a[184:185], v19 offset:16384
    v_cvt_pk_bf16_f32 v232, v112, v113
    v_mfma_f32_16x16x32_bf16 v[116:119], a[228:231], a[116:119], v[116:119]
    ds_read_b64_tr_b16 a[186:187], v19 offset:20480
    v_cvt_pk_bf16_f32 v233, v114, v115
    v_mfma_f32_16x16x32_bf16 v[116:119], a[232:235], a[120:123], v[116:119]
    ds_read_b64_tr_b16 a[188:189], v19 offset:24576
    v_cndmask_b32 v251, 0, v243, s[54:55]
    v_mfma_f32_16x16x32_bf16 v[116:119], a[236:239], a[124:127], v[116:119]
    s_waitcnt lgkmcnt(13)
    ds_read_b64_tr_b16 a[190:191], v19 offset:28672
    v_mov_b32 v248, 0
    s_waitcnt vmcnt(14)
    s_barrier
    v_mfma_f32_16x16x32_bf16 v[120:123], a[160:163], a[64:67], v[120:123]
    s_waitcnt lgkmcnt(12)
    ds_read_b64_tr_b16 a[208:209], v20 offset:0
    v_mov_b32 v249, 0
    v_mfma_f32_16x16x32_bf16 v[120:123], a[164:167], a[68:71], v[120:123]
    s_waitcnt lgkmcnt(11)
    ds_read_b64_tr_b16 a[210:211], v20 offset:4096
    v_mov_b32 v252, 0
    v_mfma_f32_16x16x32_bf16 v[120:123], a[168:171], a[72:75], v[120:123]
    s_waitcnt lgkmcnt(10)
    ds_read_b64_tr_b16 a[212:213], v20 offset:8192
    v_mov_b32 v253, 0
    v_mfma_f32_16x16x32_bf16 v[120:123], a[172:175], a[76:79], v[120:123]
    s_waitcnt lgkmcnt(9)
    ds_read_b64_tr_b16 a[214:215], v20 offset:12288
    v_mov_b32 v240, 0
    v_mfma_f32_16x16x32_bf16 v[120:123], a[176:179], a[80:83], v[120:123]
    s_waitcnt lgkmcnt(8)
    ds_read_b64_tr_b16 a[216:217], v20 offset:16384
    v_cvt_pk_bf16_f32 v236, v116, v117
    v_mfma_f32_16x16x32_bf16 v[120:123], a[180:183], a[84:87], v[120:123]
    s_waitcnt lgkmcnt(7)
    ds_read_b64_tr_b16 a[218:219], v20 offset:20480
    v_cvt_pk_bf16_f32 v237, v118, v119
    v_mfma_f32_16x16x32_bf16 v[120:123], a[184:187], a[88:91], v[120:123]
    s_waitcnt lgkmcnt(6)
    s_add_u32 s49, s7, 768
    ds_read_b64_tr_b16 a[220:221], v20 offset:24576
    v_mov_b32 v241, 0
    v_mfma_f32_16x16x32_bf16 v[120:123], a[188:191], a[92:95], v[120:123]
    s_add_u32 m0, s42, 98304
    ds_read_b64_tr_b16 a[222:223], v20 offset:28672
    v_mfma_f32_16x16x32_bf16 v[124:127], a[160:163], a[96:99], v[124:127]
    buffer_load_dwordx4 v46, s[20:23], s49 offen lds
    v_mfma_f32_16x16x32_bf16 v[124:127], a[164:167], a[100:103], v[124:127]
    ds_read_b64_tr_b16 a[224:225], v24 offset:0
    ds_read_b64_tr_b16 a[226:227], v24 offset:4096
    v_mfma_f32_16x16x32_bf16 v[124:127], a[168:171], a[104:107], v[124:127]
    buffer_load_dwordx4 v47, s[20:23], s49 offen offset:1024 lds
    v_mfma_f32_16x16x32_bf16 v[124:127], a[172:175], a[108:111], v[124:127]
    ds_read_b64_tr_b16 a[228:229], v24 offset:8192
    ds_read_b64_tr_b16 a[230:231], v24 offset:12288
    v_mfma_f32_16x16x32_bf16 v[124:127], a[176:179], a[112:115], v[124:127]
    ds_read_b64_tr_b16 a[232:233], v24 offset:16384
    v_cvt_pk_bf16_f32 v234, v120, v121
    v_mfma_f32_16x16x32_bf16 v[124:127], a[180:183], a[116:119], v[124:127]
    s_add_u32 s38, s93, 640
    ds_read_b64_tr_b16 a[234:235], v24 offset:20480
    v_cvt_pk_bf16_f32 v235, v122, v123
    v_mfma_f32_16x16x32_bf16 v[124:127], a[184:187], a[120:123], v[124:127]
    buffer_store_dwordx4 v[232:235], v56, s[28:31], s38 offen sc1
    v_mfma_f32_16x16x32_bf16 v[124:127], a[188:191], a[124:127], v[124:127]
    s_waitcnt lgkmcnt(12)
    ds_read_b64_tr_b16 a[236:237], v24 offset:24576
    ds_read_b64_tr_b16 a[238:239], v24 offset:28672
    v_mfma_f32_16x16x32_bf16 v[64:67], a[208:211], v[128:131], 0
    s_waitcnt lgkmcnt(12)
    buffer_load_dwordx4 v48, s[20:23], s49 offen offset:2048 lds
    v_mfma_f32_16x16x32_bf16 v[64:67], a[212:215], v[132:135], v[64:67]
    s_waitcnt lgkmcnt(10)
    ds_read_b64_tr_b16 a[160:161], v21 offset:0
    ds_read_b64_tr_b16 a[162:163], v21 offset:4096
    v_mfma_f32_16x16x32_bf16 v[64:67], a[216:219], v[136:139], v[64:67]
    s_waitcnt lgkmcnt(10)
    buffer_load_dwordx4 v49, s[20:23], s49 offen offset:3072 lds
    v_mfma_f32_16x16x32_bf16 v[64:67], a[220:223], v[140:143], v[64:67]
    s_waitcnt lgkmcnt(8)
    ds_read_b64_tr_b16 a[164:165], v21 offset:8192
    ds_read_b64_tr_b16 a[166:167], v21 offset:12288
    v_mfma_f32_16x16x32_bf16 v[64:67], a[224:227], v[144:147], v[64:67]
    s_waitcnt lgkmcnt(8)
    ds_read_b64_tr_b16 a[168:169], v21 offset:16384
    v_cvt_pk_bf16_f32 v238, v124, v125
    v_mfma_f32_16x16x32_bf16 v[64:67], a[228:231], v[148:151], v[64:67]
    s_waitcnt lgkmcnt(7)
    s_add_u32 s38, s93, 164480
    ds_read_b64_tr_b16 a[170:171], v21 offset:20480
    v_cvt_pk_bf16_f32 v239, v126, v127
    v_mfma_f32_16x16x32_bf16 v[64:67], a[232:235], v[152:155], v[64:67]
    s_waitcnt lgkmcnt(6)
    s_add_u32 s49, s7, 74496
    buffer_store_dwordx4 v[236:239], v56, s[28:31], s38 offen sc1
    v_mfma_f32_16x16x32_bf16 v[64:67], a[236:239], v[156:159], v[64:67]
    s_add_u32 m0, s42, 114688
    ds_read_b64_tr_b16 a[172:173], v21 offset:24576
    ds_read_b64_tr_b16 a[174:175], v21 offset:28672
    v_mfma_f32_16x16x32_bf16 v[68:71], a[208:211], v[160:163], 0
    buffer_load_dwordx4 v46, s[20:23], s49 offen lds
    v_mfma_f32_16x16x32_bf16 v[68:71], a[212:215], v[164:167], v[68:71]
    ds_read_b64_tr_b16 a[176:177], v25 offset:0
    ds_read_b64_tr_b16 a[178:179], v25 offset:4096
    v_mfma_f32_16x16x32_bf16 v[68:71], a[216:219], v[168:171], v[68:71]
    buffer_load_dwordx4 v47, s[20:23], s49 offen offset:1024 lds
    v_mfma_f32_16x16x32_bf16 v[68:71], a[220:223], v[172:175], v[68:71]
    ds_read_b64_tr_b16 a[180:181], v25 offset:8192
    ds_read_b64_tr_b16 a[182:183], v25 offset:12288
    v_mfma_f32_16x16x32_bf16 v[68:71], a[224:227], v[176:179], v[68:71]
    buffer_load_dwordx2 v[36:37], v4, s[12:15], 0 offen offset:0
    v_mfma_f32_16x16x32_bf16 v[68:71], a[228:231], v[180:183], v[68:71]
    ds_read_b64_tr_b16 a[184:185], v25 offset:16384
    ds_read_b64_tr_b16 a[186:187], v25 offset:20480
    v_mfma_f32_16x16x32_bf16 v[68:71], a[232:235], v[184:187], v[68:71]
    ds_read_b64_tr_b16 a[188:189], v25 offset:24576
    v_mfma_f32_16x16x32_bf16 v[68:71], a[236:239], v[188:191], v[68:71]
    s_waitcnt lgkmcnt(13)
    ds_read_b64_tr_b16 a[190:191], v25 offset:28672
    v_mfma_f32_16x16x32_bf16 v[72:75], a[160:163], v[128:131], 0
    s_waitcnt lgkmcnt(12)
    buffer_load_dwordx4 v48, s[20:23], s49 offen offset:2048 lds
    v_mfma_f32_16x16x32_bf16 v[72:75], a[164:167], v[132:135], v[72:75]
    s_waitcnt lgkmcnt(10)
    ds_read_b64_tr_b16 a[208:209], v22 offset:0
    ds_read_b64_tr_b16 a[210:211], v22 offset:4096
    v_mfma_f32_16x16x32_bf16 v[72:75], a[168:171], v[136:139], v[72:75]
    s_waitcnt lgkmcnt(10)
    buffer_load_dwordx4 v49, s[20:23], s49 offen offset:3072 lds
    v_mfma_f32_16x16x32_bf16 v[72:75], a[172:175], v[140:143], v[72:75]
    s_waitcnt lgkmcnt(8)
    ds_read_b64_tr_b16 a[212:213], v22 offset:8192
    ds_read_b64_tr_b16 a[214:215], v22 offset:12288
    v_mfma_f32_16x16x32_bf16 v[72:75], a[176:179], v[144:147], v[72:75]
    s_waitcnt lgkmcnt(8)
    ds_read_b64_tr_b16 a[216:217], v22 offset:16384
    v_mfma_f32_16x16x32_bf16 v[72:75], a[180:183], v[148:151], v[72:75]
    s_waitcnt lgkmcnt(7)
    ds_read_b64_tr_b16 a[218:219], v22 offset:20480
    v_mfma_f32_16x16x32_bf16 v[72:75], a[184:187], v[152:155], v[72:75]
    s_waitcnt lgkmcnt(6)
    ds_read_b64_tr_b16 a[220:221], v22 offset:24576
    v_mfma_f32_16x16x32_bf16 v[72:75], a[188:191], v[156:159], v[72:75]
    ds_read_b64_tr_b16 a[222:223], v22 offset:28672
    v_mfma_f32_16x16x32_bf16 v[76:79], a[160:163], v[160:163], 0
    buffer_load_dwordx2 v[38:39], v4, s[12:15], 0 offen offset:32
    v_mfma_f32_16x16x32_bf16 v[76:79], a[164:167], v[164:167], v[76:79]
    ds_read_b64_tr_b16 a[224:225], v26 offset:0
    ds_read_b64_tr_b16 a[226:227], v26 offset:4096
    v_mfma_f32_16x16x32_bf16 v[76:79], a[168:171], v[168:171], v[76:79]
    ds_read_b64_tr_b16 a[228:229], v26 offset:8192
    v_mfma_f32_16x16x32_bf16 v[76:79], a[172:175], v[172:175], v[76:79]
    ds_read_b64_tr_b16 a[230:231], v26 offset:12288
    v_mfma_f32_16x16x32_bf16 v[76:79], a[176:179], v[176:179], v[76:79]
    ds_read_b64_tr_b16 a[232:233], v26 offset:16384
    v_mfma_f32_16x16x32_bf16 v[76:79], a[180:183], v[180:183], v[76:79]
Ltour10:
    s_cbranch_execz Ltour14
    ds_read_b64_tr_b16 a[234:235], v26 offset:20480
    v_mfma_f32_16x16x32_bf16 v[76:79], a[184:187], v[184:187], v[76:79]
    buffer_load_dword v63, v63, s[88:91], 0 offen sc1
    v_mfma_f32_16x16x32_bf16 v[76:79], a[188:191], v[188:191], v[76:79]
    s_waitcnt lgkmcnt(12)
    ds_read_b64_tr_b16 a[236:237], v26 offset:24576
    ds_read_b64_tr_b16 a[238:239], v26 offset:28672
    v_mfma_f32_16x16x32_bf16 v[80:83], a[208:211], v[128:131], 0
    s_waitcnt lgkmcnt(12)
    ds_read_b64_tr_b16 a[160:161], v23 offset:0
    v_mfma_f32_16x16x32_bf16 v[80:83], a[212:215], v[132:135], v[80:83]
    s_waitcnt lgkmcnt(11)
    ds_read_b64_tr_b16 a[162:163], v23 offset:4096
    v_mfma_f32_16x16x32_bf16 v[80:83], a[216:219], v[136:139], v[80:83]
    s_waitcnt lgkmcnt(10)
    buffer_load_dwordx2 v[40:41], v4, s[12:15], 0 offen offset:512
    v_mfma_f32_16x16x32_bf16 v[80:83], a[220:223], v[140:143], v[80:83]
    s_waitcnt lgkmcnt(8)
    ds_read_b64_tr_b16 a[164:165], v23 offset:8192
    ds_read_b64_tr_b16 a[166:167], v23 offset:12288
    v_mfma_f32_16x16x32_bf16 v[80:83], a[224:227], v[144:147], v[80:83]
    s_waitcnt lgkmcnt(8)
    ds_read_b64_tr_b16 a[168:169], v23 offset:16384
    v_mfma_f32_16x16x32_bf16 v[80:83], a[228:231], v[148:151], v[80:83]
    s_waitcnt lgkmcnt(7)
    ds_read_b64_tr_b16 a[170:171], v23 offset:20480
    v_mfma_f32_16x16x32_bf16 v[80:83], a[232:235], v[152:155], v[80:83]
    s_waitcnt lgkmcnt(6)
    ds_read_b64_tr_b16 a[172:173], v23 offset:24576
    v_mfma_f32_16x16x32_bf16 v[80:83], a[236:239], v[156:159], v[80:83]
    ds_read_b64_tr_b16 a[174:175], v23 offset:28672
    v_mfma_f32_16x16x32_bf16 v[84:87], a[208:211], v[160:163], 0
    ds_read_b64_tr_b16 a[176:177], v27 offset:0
    v_mfma_f32_16x16x32_bf16 v[84:87], a[212:215], v[164:167], v[84:87]
    ds_read_b64_tr_b16 a[178:179], v27 offset:4096
    v_mfma_f32_16x16x32_bf16 v[84:87], a[216:219], v[168:171], v[84:87]
    buffer_load_dwordx2 v[42:43], v4, s[12:15], 0 offen offset:544
    v_mfma_f32_16x16x32_bf16 v[84:87], a[220:223], v[172:175], v[84:87]
    ds_read_b64_tr_b16 a[180:181], v27 offset:8192
    ds_read_b64_tr_b16 a[182:183], v27 offset:12288
    v_mfma_f32_16x16x32_bf16 v[84:87], a[224:227], v[176:179], v[84:87]
    ds_read_b64_tr_b16 a[184:185], v27 offset:16384
    v_mfma_f32_16x16x32_bf16 v[84:87], a[228:231], v[180:183], v[84:87]
    ds_read_b64_tr_b16 a[186:187], v27 offset:20480
    v_mfma_f32_16x16x32_bf16 v[84:87], a[232:235], v[184:187], v[84:87]
    ds_read_b64_tr_b16 a[188:189], v27 offset:24576
    v_mfma_f32_16x16x32_bf16 v[84:87], a[236:239], v[188:191], v[84:87]
    s_waitcnt lgkmcnt(13)
    ds_read_b64_tr_b16 a[190:191], v27 offset:28672
    s_waitcnt vmcnt(17)
    s_barrier
    v_mfma_f32_16x16x32_bf16 v[88:91], a[160:163], v[128:131], 0
    s_waitcnt lgkmcnt(12)
    ds_read_b64_tr_b16 a[208:209], v12 offset:32768
    v_mfma_f32_16x16x32_bf16 v[88:91], a[164:167], v[132:135], v[88:91]
    s_waitcnt lgkmcnt(11)
    ds_read_b64_tr_b16 a[210:211], v12 offset:36864
    v_mfma_f32_16x16x32_bf16 v[88:91], a[168:171], v[136:139], v[88:91]
    s_waitcnt lgkmcnt(10)
    buffer_load_dwordx2 v[244:245], v58, s[12:15], 0 offen offset:1024
    v_mfma_f32_16x16x32_bf16 v[88:91], a[172:175], v[140:143], v[88:91]
    s_waitcnt lgkmcnt(8)
    ds_read_b64_tr_b16 a[212:213], v12 offset:40960
    ds_read_b64_tr_b16 a[214:215], v12 offset:45056
    v_mfma_f32_16x16x32_bf16 v[88:91], a[176:179], v[144:147], v[88:91]
    s_waitcnt lgkmcnt(8)
    ds_read_b64_tr_b16 a[216:217], v12 offset:49152
    v_mfma_f32_16x16x32_bf16 v[88:91], a[180:183], v[148:151], v[88:91]
    s_waitcnt lgkmcnt(7)
    ds_read_b64_tr_b16 a[218:219], v12 offset:53248
    v_mfma_f32_16x16x32_bf16 v[88:91], a[184:187], v[152:155], v[88:91]
    s_waitcnt lgkmcnt(6)
    s_add_u32 s49, s46, 768
    ds_read_b64_tr_b16 a[220:221], v12 offset:57344
    v_mfma_f32_16x16x32_bf16 v[88:91], a[188:191], v[156:159], v[88:91]
    s_add_u32 m0, s42, 0
    ds_read_b64_tr_b16 a[222:223], v12 offset:61440
    v_mfma_f32_16x16x32_bf16 v[92:95], a[160:163], v[160:163], 0
    buffer_load_dwordx4 v46, s[20:23], s49 offen lds
    v_mfma_f32_16x16x32_bf16 v[92:95], a[164:167], v[164:167], v[92:95]
    ds_read_b64_tr_b16 a[224:225], v16 offset:32768
    ds_read_b64_tr_b16 a[226:227], v16 offset:36864
    v_mfma_f32_16x16x32_bf16 v[92:95], a[168:171], v[168:171], v[92:95]
    buffer_load_dwordx4 v47, s[20:23], s49 offen offset:1024 lds
    v_mfma_f32_16x16x32_bf16 v[92:95], a[172:175], v[172:175], v[92:95]
    ds_read_b64_tr_b16 a[228:229], v16 offset:40960
    ds_read_b64_tr_b16 a[230:231], v16 offset:45056
    v_mfma_f32_16x16x32_bf16 v[92:95], a[176:179], v[176:179], v[92:95]
    ds_read_b64_tr_b16 a[232:233], v16 offset:49152
    v_mfma_f32_16x16x32_bf16 v[92:95], a[180:183], v[180:183], v[92:95]
    ds_read_b64_tr_b16 a[234:235], v16 offset:53248
    v_mfma_f32_16x16x32_bf16 v[92:95], a[184:187], v[184:187], v[92:95]
    buffer_load_dwordx2 v[246:247], v58, s[12:15], 0 offen offset:1056
    v_mfma_f32_16x16x32_bf16 v[92:95], a[188:191], v[188:191], v[92:95]
    s_waitcnt lgkmcnt(12)
    ds_read_b64_tr_b16 a[236:237], v16 offset:57344
    ds_read_b64_tr_b16 a[238:239], v16 offset:61440
    v_mfma_f32_16x16x32_bf16 v[64:67], a[208:211], a[64:67], v[64:67]
    s_waitcnt lgkmcnt(12)
    buffer_load_dwordx4 v48, s[20:23], s49 offen offset:2048 lds
    v_mfma_f32_16x16x32_bf16 v[64:67], a[212:215], a[68:71], v[64:67]
    s_waitcnt lgkmcnt(10)
    ds_read_b64_tr_b16 a[160:161], v13 offset:32768
    ds_read_b64_tr_b16 a[162:163], v13 offset:36864
    v_mfma_f32_16x16x32_bf16 v[64:67], a[216:219], a[72:75], v[64:67]
    s_waitcnt lgkmcnt(10)
    buffer_load_dwordx4 v49, s[20:23], s49 offen offset:3072 lds
    v_mfma_f32_16x16x32_bf16 v[64:67], a[220:223], a[76:79], v[64:67]
    s_waitcnt lgkmcnt(8)
    ds_read_b64_tr_b16 a[164:165], v13 offset:40960
    ds_read_b64_tr_b16 a[166:167], v13 offset:45056
    v_mfma_f32_16x16x32_bf16 v[64:67], a[224:227], a[80:83], v[64:67]
    s_waitcnt lgkmcnt(8)
    ds_read_b64_tr_b16 a[168:169], v13 offset:49152
    v_mfma_f32_16x16x32_bf16 v[64:67], a[228:231], a[84:87], v[64:67]
    s_waitcnt lgkmcnt(7)
    ds_read_b64_tr_b16 a[170:171], v13 offset:53248
    v_mfma_f32_16x16x32_bf16 v[64:67], a[232:235], a[88:91], v[64:67]
    s_waitcnt lgkmcnt(6)
    s_add_u32 s49, s46, 74496
    ds_read_b64_tr_b16 a[172:173], v13 offset:57344
    v_mfma_f32_16x16x32_bf16 v[64:67], a[236:239], a[92:95], v[64:67]
    s_add_u32 m0, s42, 16384
    ds_read_b64_tr_b16 a[174:175], v13 offset:61440
    v_mfma_f32_16x16x32_bf16 v[68:71], a[208:211], a[96:99], v[68:71]
    buffer_load_dwordx4 v46, s[20:23], s49 offen lds
    v_mfma_f32_16x16x32_bf16 v[68:71], a[212:215], a[100:103], v[68:71]
    ds_read_b64_tr_b16 a[176:177], v17 offset:32768
    ds_read_b64_tr_b16 a[178:179], v17 offset:36864
    v_mfma_f32_16x16x32_bf16 v[68:71], a[216:219], a[104:107], v[68:71]
    buffer_load_dwordx4 v47, s[20:23], s49 offen offset:1024 lds
    v_mfma_f32_16x16x32_bf16 v[68:71], a[220:223], a[108:111], v[68:71]
    ds_read_b64_tr_b16 a[180:181], v17 offset:40960
    ds_read_b64_tr_b16 a[182:183], v17 offset:45056
    v_mfma_f32_16x16x32_bf16 v[68:71], a[224:227], a[112:115], v[68:71]
    ds_read_b64_tr_b16 a[184:185], v17 offset:49152
    v_cvt_pk_bf16_f32 v224, v64, v65
    v_mfma_f32_16x16x32_bf16 v[68:71], a[228:231], a[116:119], v[68:71]
    ds_read_b64_tr_b16 a[186:187], v17 offset:53248
    v_cvt_pk_bf16_f32 v225, v66, v67
    v_mfma_f32_16x16x32_bf16 v[68:71], a[232:235], a[120:123], v[68:71]
    ds_read_b64_tr_b16 a[188:189], v17 offset:57344
    v_mfma_f32_16x16x32_bf16 v[68:71], a[236:239], a[124:127], v[68:71]
    s_waitcnt lgkmcnt(13)
    ds_read_b64_tr_b16 a[190:191], v17 offset:61440
    v_mfma_f32_16x16x32_bf16 v[72:75], a[160:163], a[64:67], v[72:75]
    s_waitcnt lgkmcnt(12)
    buffer_load_dwordx4 v48, s[20:23], s49 offen offset:2048 lds
    v_mfma_f32_16x16x32_bf16 v[72:75], a[164:167], a[68:71], v[72:75]
    s_waitcnt lgkmcnt(10)
    ds_read_b64_tr_b16 a[208:209], v14 offset:32768
    ds_read_b64_tr_b16 a[210:211], v14 offset:36864
    v_mfma_f32_16x16x32_bf16 v[72:75], a[168:171], a[72:75], v[72:75]
    s_waitcnt lgkmcnt(10)
    buffer_load_dwordx4 v49, s[20:23], s49 offen offset:3072 lds
    v_mfma_f32_16x16x32_bf16 v[72:75], a[172:175], a[76:79], v[72:75]
    s_waitcnt lgkmcnt(8)
    ds_read_b64_tr_b16 a[212:213], v14 offset:40960
    ds_read_b64_tr_b16 a[214:215], v14 offset:45056
    v_mfma_f32_16x16x32_bf16 v[72:75], a[176:179], a[80:83], v[72:75]
    s_waitcnt lgkmcnt(8)
    ds_read_b64_tr_b16 a[216:217], v14 offset:49152
    v_cvt_pk_bf16_f32 v228, v68, v69
    v_mfma_f32_16x16x32_bf16 v[72:75], a[180:183], a[84:87], v[72:75]
    s_waitcnt lgkmcnt(7)
    s_waitcnt vmcnt(19)
    ds_read_b64_tr_b16 a[218:219], v14 offset:53248
    v_cvt_pk_bf16_f32 v229, v70, v71
    v_mfma_f32_16x16x32_bf16 v[72:75], a[184:187], a[88:91], v[72:75]
    s_waitcnt lgkmcnt(6)
    s_and_b32 s42, s2, 7
    buffer_store_dword v10, v8, s[24:27], s92 offen sc1
    v_mfma_f32_16x16x32_bf16 v[72:75], a[188:191], a[92:95], v[72:75]
    s_mov_b64 s[20:21], s[52:53]
    s_add_u32 s92, s92, 4
    ds_read_b64_tr_b16 a[220:221], v14 offset:57344
    ds_read_b64_tr_b16 a[222:223], v14 offset:61440
    v_mfma_f32_16x16x32_bf16 v[76:79], a[160:163], a[96:99], v[76:79]
    s_mov_b32 s22, 1152
    ds_read_b64_tr_b16 a[224:225], v18 offset:32768
    s_waitcnt vmcnt(13)
    v_readfirstlane_b32 s37, v63
    v_mfma_f32_16x16x32_bf16 v[76:79], a[164:167], a[100:103], v[76:79]
    s_mov_b32 s23, 0x20000
    ds_read_b64_tr_b16 a[226:227], v18 offset:36864
    v_mfma_f32_16x16x32_bf16 v[76:79], a[168:171], a[104:107], v[76:79]
    ds_read_b64_tr_b16 a[228:229], v18 offset:40960
    s_cmp_lt_u32 s37, 256
    s_cbranch_scc1 Lattn_armwait
Lattn_armed:
    v_mfma_f32_16x16x32_bf16 v[76:79], a[172:175], a[108:111], v[76:79]
    ds_read_b64_tr_b16 a[230:231], v18 offset:45056
    v_mfma_f32_16x16x32_bf16 v[76:79], a[176:179], a[112:115], v[76:79]
    ds_read_b64_tr_b16 a[232:233], v18 offset:49152
    v_cvt_pk_bf16_f32 v226, v72, v73
    v_mfma_f32_16x16x32_bf16 v[76:79], a[180:183], a[116:119], v[76:79]
    s_add_u32 s38, s93, 1024
    ds_read_b64_tr_b16 a[234:235], v18 offset:53248
    v_cvt_pk_bf16_f32 v227, v74, v75
    v_mfma_f32_16x16x32_bf16 v[76:79], a[184:187], a[120:123], v[76:79]
    buffer_store_dwordx4 v[224:227], v56, s[28:31], s38 offen sc1
    v_mfma_f32_16x16x32_bf16 v[76:79], a[188:191], a[124:127], v[76:79]
    s_waitcnt lgkmcnt(12)
    s_mov_b32 s45, 18688
    ds_read_b64_tr_b16 a[236:237], v18 offset:57344
    ds_read_b64_tr_b16 a[238:239], v18 offset:61440
    v_mfma_f32_16x16x32_bf16 v[80:83], a[208:211], a[64:67], v[80:83]
    s_waitcnt lgkmcnt(12)
    buffer_load_dwordx4 v[192:195], v5, s[24:27], s45 offen offset:0 sc1
    v_mfma_f32_16x16x32_bf16 v[80:83], a[212:215], a[68:71], v[80:83]
    s_waitcnt lgkmcnt(10)
    ds_read_b64_tr_b16 a[160:161], v15 offset:32768
    ds_read_b64_tr_b16 a[162:163], v15 offset:36864
    v_mfma_f32_16x16x32_bf16 v[80:83], a[216:219], a[72:75], v[80:83]
    s_waitcnt lgkmcnt(10)
    ds_read_b64_tr_b16 a[164:165], v15 offset:40960
    v_mfma_f32_16x16x32_bf16 v[80:83], a[220:223], a[76:79], v[80:83]
    s_waitcnt lgkmcnt(9)
    ds_read_b64_tr_b16 a[166:167], v15 offset:45056
    v_mfma_f32_16x16x32_bf16 v[80:83], a[224:227], a[80:83], v[80:83]
    s_waitcnt lgkmcnt(8)
    ds_read_b64_tr_b16 a[168:169], v15 offset:49152
    v_cvt_pk_bf16_f32 v230, v76, v77
    v_mfma_f32_16x16x32_bf16 v[80:83], a[228:231], a[84:87], v[80:83]
    s_waitcnt lgkmcnt(7)
    s_add_u32 s38, s93, 164864
    ds_read_b64_tr_b16 a[170:171], v15 offset:53248
    v_cvt_pk_bf16_f32 v231, v78, v79
    v_mfma_f32_16x16x32_bf16 v[80:83], a[232:235], a[88:91], v[80:83]
    s_waitcnt lgkmcnt(6)
    buffer_store_dwordx4 v[228:231], v56, s[28:31], s38 offen sc1
    v_mfma_f32_16x16x32_bf16 v[80:83], a[236:239], a[92:95], v[80:83]
    ds_read_b64_tr_b16 a[172:173], v15 offset:57344
    ds_read_b64_tr_b16 a[174:175], v15 offset:61440
    v_mfma_f32_16x16x32_bf16 v[84:87], a[208:211], a[96:99], v[84:87]
    buffer_load_dwordx4 v[196:199], v5, s[24:27], s45 offen offset:512 sc1
    v_mfma_f32_16x16x32_bf16 v[84:87], a[212:215], a[100:103], v[84:87]
    ds_read_b64_tr_b16 a[176:177], v19 offset:32768
    ds_read_b64_tr_b16 a[178:179], v19 offset:36864
    v_mfma_f32_16x16x32_bf16 v[84:87], a[216:219], a[104:107], v[84:87]
    ds_read_b64_tr_b16 a[180:181], v19 offset:40960
    v_mfma_f32_16x16x32_bf16 v[84:87], a[220:223], a[108:111], v[84:87]
    ds_read_b64_tr_b16 a[182:183], v19 offset:45056
    v_mfma_f32_16x16x32_bf16 v[84:87], a[224:227], a[112:115], v[84:87]
    ds_read_b64_tr_b16 a[184:185], v19 offset:49152
    v_cvt_pk_bf16_f32 v232, v80, v81
    v_mfma_f32_16x16x32_bf16 v[84:87], a[228:231], a[116:119], v[84:87]
    ds_read_b64_tr_b16 a[186:187], v19 offset:53248
    v_cvt_pk_bf16_f32 v233, v82, v83
    v_mfma_f32_16x16x32_bf16 v[84:87], a[232:235], a[120:123], v[84:87]
    buffer_load_dwordx4 v[200:203], v59, s[24:27], s45 offen offset:1024 sc1
    v_mfma_f32_16x16x32_bf16 v[84:87], a[236:239], a[124:127], v[84:87]
    s_waitcnt lgkmcnt(12)
    ds_read_b64_tr_b16 a[188:189], v19 offset:57344
    ds_read_b64_tr_b16 a[190:191], v19 offset:61440
    s_barrier
    v_mfma_f32_16x16x32_bf16 v[88:91], a[160:163], a[64:67], v[88:91]
    s_waitcnt lgkmcnt(12)
    ds_read_b64_tr_b16 a[208:209], v20 offset:32768
    v_mfma_f32_16x16x32_bf16 v[88:91], a[164:167], a[68:71], v[88:91]
    s_waitcnt lgkmcnt(11)
    s_mov_b32 s45, 20992
    ds_read_b64_tr_b16 a[210:211], v20 offset:36864
    v_mfma_f32_16x16x32_bf16 v[88:91], a[168:171], a[72:75], v[88:91]
    s_waitcnt lgkmcnt(10)
    buffer_load_dwordx4 v[204:207], v5, s[24:27], s45 offen offset:0 sc1
    v_mfma_f32_16x16x32_bf16 v[88:91], a[172:175], a[76:79], v[88:91]
    s_waitcnt lgkmcnt(8)
    ds_read_b64_tr_b16 a[212:213], v20 offset:40960
    ds_read_b64_tr_b16 a[214:215], v20 offset:45056
    v_mfma_f32_16x16x32_bf16 v[88:91], a[176:179], a[80:83], v[88:91]
    s_waitcnt lgkmcnt(8)
    ds_read_b64_tr_b16 a[216:217], v20 offset:49152
    v_cvt_pk_bf16_f32 v236, v84, v85
    v_mfma_f32_16x16x32_bf16 v[88:91], a[180:183], a[84:87], v[88:91]
    s_waitcnt lgkmcnt(7)
    ds_read_b64_tr_b16 a[218:219], v20 offset:53248
    v_cvt_pk_bf16_f32 v237, v86, v87
    v_mfma_f32_16x16x32_bf16 v[88:91], a[184:187], a[88:91], v[88:91]
    s_waitcnt lgkmcnt(6)
    ds_read_b64_tr_b16 a[220:221], v20 offset:57344
    v_mfma_f32_16x16x32_bf16 v[88:91], a[188:191], a[92:95], v[88:91]
    ds_read_b64_tr_b16 a[222:223], v20 offset:61440
    v_mfma_f32_16x16x32_bf16 v[92:95], a[160:163], a[96:99], v[92:95]
    buffer_load_dwordx4 v[208:211], v5, s[24:27], s45 offen offset:512 sc1
    v_mfma_f32_16x16x32_bf16 v[92:95], a[164:167], a[100:103], v[92:95]
    ds_read_b64_tr_b16 a[224:225], v24 offset:32768
    ds_read_b64_tr_b16 a[226:227], v24 offset:36864
    v_mfma_f32_16x16x32_bf16 v[92:95], a[168:171], a[104:107], v[92:95]
    ds_read_b64_tr_b16 a[228:229], v24 offset:40960
    v_mfma_f32_16x16x32_bf16 v[92:95], a[172:175], a[108:111], v[92:95]
    ds_read_b64_tr_b16 a[230:231], v24 offset:45056
    v_mfma_f32_16x16x32_bf16 v[92:95], a[176:179], a[112:115], v[92:95]
    ds_read_b64_tr_b16 a[232:233], v24 offset:49152
    v_cvt_pk_bf16_f32 v234, v88, v89
    v_mfma_f32_16x16x32_bf16 v[92:95], a[180:183], a[116:119], v[92:95]
    s_add_u32 s38, s93, 1152
    ds_read_b64_tr_b16 a[234:235], v24 offset:53248
    v_cvt_pk_bf16_f32 v235, v90, v91
    v_mfma_f32_16x16x32_bf16 v[92:95], a[184:187], a[120:123], v[92:95]
    buffer_store_dwordx4 v[232:235], v56, s[28:31], s38 offen sc1
    v_mfma_f32_16x16x32_bf16 v[92:95], a[188:191], a[124:127], v[92:95]
    s_waitcnt lgkmcnt(12)
    ds_read_b64_tr_b16 a[236:237], v24 offset:57344
    ds_read_b64_tr_b16 a[238:239], v24 offset:61440
    v_mfma_f32_16x16x32_bf16 v[96:99], a[208:211], v[128:131], 0
    s_waitcnt lgkmcnt(12)
    buffer_load_dwordx4 v[212:215], v59, s[24:27], s45 offen offset:1024 sc1
    v_mfma_f32_16x16x32_bf16 v[96:99], a[212:215], v[132:135], v[96:99]
    s_waitcnt lgkmcnt(10)
    ds_read_b64_tr_b16 a[160:161], v21 offset:32768
    ds_read_b64_tr_b16 a[162:163], v21 offset:36864
    v_mfma_f32_16x16x32_bf16 v[96:99], a[216:219], v[136:139], v[96:99]
    s_waitcnt lgkmcnt(10)
    ds_read_b64_tr_b16 a[164:165], v21 offset:40960
    v_mfma_f32_16x16x32_bf16 v[96:99], a[220:223], v[140:143], v[96:99]
    s_waitcnt lgkmcnt(9)
    ds_read_b64_tr_b16 a[166:167], v21 offset:45056
    v_mfma_f32_16x16x32_bf16 v[96:99], a[224:227], v[144:147], v[96:99]
    s_waitcnt lgkmcnt(8)
    ds_read_b64_tr_b16 a[168:169], v21 offset:49152
    v_cvt_pk_bf16_f32 v238, v92, v93
    v_mfma_f32_16x16x32_bf16 v[96:99], a[228:231], v[148:151], v[96:99]
    s_waitcnt lgkmcnt(7)
    s_add_u32 s38, s93, 164992
    ds_read_b64_tr_b16 a[170:171], v21 offset:53248
    v_cvt_pk_bf16_f32 v239, v94, v95
    v_mfma_f32_16x16x32_bf16 v[96:99], a[232:235], v[152:155], v[96:99]
    s_waitcnt lgkmcnt(6)
    buffer_store_dwordx4 v[236:239], v56, s[28:31], s38 offen sc1
    v_mfma_f32_16x16x32_bf16 v[96:99], a[236:239], v[156:159], v[96:99]
    s_mov_b32 s45, 19840
    ds_read_b64_tr_b16 a[172:173], v21 offset:57344
    ds_read_b64_tr_b16 a[174:175], v21 offset:61440
    v_mfma_f32_16x16x32_bf16 v[100:103], a[208:211], v[160:163], 0
    buffer_load_dwordx4 v[64:67], v5, s[24:27], s45 offen offset:0 sc1
    v_mfma_f32_16x16x32_bf16 v[100:103], a[212:215], v[164:167], v[100:103]
    ds_read_b64_tr_b16 a[176:177], v25 offset:32768
    ds_read_b64_tr_b16 a[178:179], v25 offset:36864
    v_mfma_f32_16x16x32_bf16 v[100:103], a[216:219], v[168:171], v[100:103]
    ds_read_b64_tr_b16 a[180:181], v25 offset:40960
    v_mfma_f32_16x16x32_bf16 v[100:103], a[220:223], v[172:175], v[100:103]
    ds_read_b64_tr_b16 a[182:183], v25 offset:45056
    v_mfma_f32_16x16x32_bf16 v[100:103], a[224:227], v[176:179], v[100:103]
    buffer_load_dwordx4 v[68:71], v5, s[24:27], s45 offen offset:512 sc1
    v_mfma_f32_16x16x32_bf16 v[100:103], a[228:231], v[180:183], v[100:103]
    ds_read_b64_tr_b16 a[184:185], v25 offset:49152
    ds_read_b64_tr_b16 a[186:187], v25 offset:53248
    v_mfma_f32_16x16x32_bf16 v[100:103], a[232:235], v[184:187], v[100:103]
    ds_read_b64_tr_b16 a[188:189], v25 offset:57344
    v_mfma_f32_16x16x32_bf16 v[100:103], a[236:239], v[188:191], v[100:103]
    s_waitcnt lgkmcnt(13)
    ds_read_b64_tr_b16 a[190:191], v25 offset:61440
    v_mfma_f32_16x16x32_bf16 v[104:107], a[160:163], v[128:131], 0
    s_waitcnt lgkmcnt(12)
    ds_read_b64_tr_b16 a[208:209], v22 offset:32768
    v_mfma_f32_16x16x32_bf16 v[104:107], a[164:167], v[132:135], v[104:107]
    s_waitcnt lgkmcnt(11)
    ds_read_b64_tr_b16 a[210:211], v22 offset:36864
    v_mfma_f32_16x16x32_bf16 v[104:107], a[168:171], v[136:139], v[104:107]
    s_waitcnt lgkmcnt(10)
    buffer_load_dwordx4 v[72:75], v59, s[24:27], s45 offen offset:1024 sc1
    v_mfma_f32_16x16x32_bf16 v[104:107], a[172:175], v[140:143], v[104:107]
    s_waitcnt lgkmcnt(8)
    ds_read_b64_tr_b16 a[212:213], v22 offset:40960
    ds_read_b64_tr_b16 a[214:215], v22 offset:45056
    v_mfma_f32_16x16x32_bf16 v[104:107], a[176:179], v[144:147], v[104:107]
    s_waitcnt lgkmcnt(8)
    ds_read_b64_tr_b16 a[216:217], v22 offset:49152
    v_mfma_f32_16x16x32_bf16 v[104:107], a[180:183], v[148:151], v[104:107]
    s_waitcnt lgkmcnt(7)
    ds_read_b64_tr_b16 a[218:219], v22 offset:53248
    v_mfma_f32_16x16x32_bf16 v[104:107], a[184:187], v[152:155], v[104:107]
    s_waitcnt lgkmcnt(6)
    ds_read_b64_tr_b16 a[220:221], v22 offset:57344
    v_mfma_f32_16x16x32_bf16 v[104:107], a[188:191], v[156:159], v[104:107]
    ds_read_b64_tr_b16 a[222:223], v22 offset:61440
    v_mfma_f32_16x16x32_bf16 v[108:111], a[160:163], v[160:163], 0
    buffer_load_dwordx2 v[76:77], v3, s[20:23], 0 offen offset:0
    v_mfma_f32_16x16x32_bf16 v[108:111], a[164:167], v[164:167], v[108:111]
    ds_read_b64_tr_b16 a[224:225], v26 offset:32768
    ds_read_b64_tr_b16 a[226:227], v26 offset:36864
    v_mfma_f32_16x16x32_bf16 v[108:111], a[168:171], v[168:171], v[108:111]
    ds_read_b64_tr_b16 a[228:229], v26 offset:40960
    v_mfma_f32_16x16x32_bf16 v[108:111], a[172:175], v[172:175], v[108:111]
    ds_read_b64_tr_b16 a[230:231], v26 offset:45056
    v_mfma_f32_16x16x32_bf16 v[108:111], a[176:179], v[176:179], v[108:111]
    ds_read_b64_tr_b16 a[232:233], v26 offset:49152
    v_mfma_f32_16x16x32_bf16 v[108:111], a[180:183], v[180:183], v[108:111]
    ds_read_b64_tr_b16 a[234:235], v26 offset:53248
    v_mfma_f32_16x16x32_bf16 v[108:111], a[184:187], v[184:187], v[108:111]
    buffer_load_dwordx2 v[78:79], v3, s[20:23], 0 offen offset:32
    v_mfma_f32_16x16x32_bf16 v[108:111], a[188:191], v[188:191], v[108:111]
    s_waitcnt lgkmcnt(12)
    ds_read_b64_tr_b16 a[236:237], v26 offset:57344
    ds_read_b64_tr_b16 a[238:239], v26 offset:61440
    v_mfma_f32_16x16x32_bf16 v[112:115], a[208:211], v[128:131], 0
    s_waitcnt lgkmcnt(12)
    ds_read_b64_tr_b16 a[160:161], v23 offset:32768
    v_mfma_f32_16x16x32_bf16 v[112:115], a[212:215], v[132:135], v[112:115]
    s_waitcnt lgkmcnt(11)
    ds_read_b64_tr_b16 a[162:163], v23 offset:36864
    v_mfma_f32_16x16x32_bf16 v[112:115], a[216:219], v[136:139], v[112:115]
    s_waitcnt lgkmcnt(10)
    ds_read_b64_tr_b16 a[164:165], v23 offset:40960
    v_mfma_f32_16x16x32_bf16 v[112:115], a[220:223], v[140:143], v[112:115]
    s_waitcnt lgkmcnt(9)
    ds_read_b64_tr_b16 a[166:167], v23 offset:45056
    v_mfma_f32_16x16x32_bf16 v[112:115], a[224:227], v[144:147], v[112:115]
    s_waitcnt lgkmcnt(8)
    buffer_load_dwordx2 v[80:81], v3, s[20:23], 0 offen offset:512
    v_mfma_f32_16x16x32_bf16 v[112:115], a[228:231], v[148:151], v[112:115]
    s_waitcnt lgkmcnt(6)
    ds_read_b64_tr_b16 a[168:169], v23 offset:49152
    ds_read_b64_tr_b16 a[170:171], v23 offset:53248
    v_mfma_f32_16x16x32_bf16 v[112:115], a[232:235], v[152:155], v[112:115]
    s_waitcnt lgkmcnt(6)
    ds_read_b64_tr_b16 a[172:173], v23 offset:57344
    v_mfma_f32_16x16x32_bf16 v[112:115], a[236:239], v[156:159], v[112:115]
    ds_read_b64_tr_b16 a[174:175], v23 offset:61440
    v_mfma_f32_16x16x32_bf16 v[116:119], a[208:211], v[160:163], 0
    ds_read_b64_tr_b16 a[176:177], v27 offset:32768
    v_mfma_f32_16x16x32_bf16 v[116:119], a[212:215], v[164:167], v[116:119]
    ds_read_b64_tr_b16 a[178:179], v27 offset:36864
    v_mfma_f32_16x16x32_bf16 v[116:119], a[216:219], v[168:171], v[116:119]
    buffer_load_dwordx2 v[82:83], v3, s[20:23], 0 offen offset:544
    v_mfma_f32_16x16x32_bf16 v[116:119], a[220:223], v[172:175], v[116:119]
    ds_read_b64_tr_b16 a[180:181], v27 offset:40960
    ds_read_b64_tr_b16 a[182:183], v27 offset:45056
    v_mfma_f32_16x16x32_bf16 v[116:119], a[224:227], v[176:179], v[116:119]
    ds_read_b64_tr_b16 a[184:185], v27 offset:49152
    v_mfma_f32_16x16x32_bf16 v[116:119], a[228:231], v[180:183], v[116:119]
    ds_read_b64_tr_b16 a[186:187], v27 offset:53248
    v_mfma_f32_16x16x32_bf16 v[116:119], a[232:235], v[184:187], v[116:119]
    buffer_load_dwordx2 v[84:85], v55, s[20:23], 0 offen offset:1024
    v_mfma_f32_16x16x32_bf16 v[116:119], a[236:239], v[188:191], v[116:119]
    ds_read_b64_tr_b16 a[188:189], v27 offset:57344
    ds_read_b64_tr_b16 a[190:191], v27 offset:61440
    s_waitcnt vmcnt(19)
    s_waitcnt lgkmcnt(0)
    s_barrier
    v_mfma_f32_16x16x32_bf16 v[120:123], a[160:163], v[128:131], 0
    ds_read_b64_tr_b16 a[208:209], v12 offset:0
    v_mfma_f32_16x16x32_bf16 v[120:123], a[164:167], v[132:135], v[120:123]
    ds_read_b64_tr_b16 a[210:211], v12 offset:4096
    v_mfma_f32_16x16x32_bf16 v[120:123], a[168:171], v[136:139], v[120:123]
    ds_read_b64_tr_b16 a[212:213], v12 offset:8192
    v_mfma_f32_16x16x32_bf16 v[120:123], a[172:175], v[140:143], v[120:123]
    ds_read_b64_tr_b16 a[214:215], v12 offset:12288
    v_mfma_f32_16x16x32_bf16 v[120:123], a[176:179], v[144:147], v[120:123]
    buffer_load_dwordx2 v[86:87], v55, s[20:23], 0 offen offset:1056
    v_mfma_f32_16x16x32_bf16 v[120:123], a[180:183], v[148:151], v[120:123]
    ds_read_b64_tr_b16 a[216:217], v12 offset:16384
    ds_read_b64_tr_b16 a[218:219], v12 offset:20480
    v_mfma_f32_16x16x32_bf16 v[120:123], a[184:187], v[152:155], v[120:123]
    ds_read_b64_tr_b16 a[220:221], v12 offset:24576
    v_mfma_f32_16x16x32_bf16 v[120:123], a[188:191], v[156:159], v[120:123]
    ds_read_b64_tr_b16 a[222:223], v12 offset:28672
    v_mfma_f32_16x16x32_bf16 v[124:127], a[160:163], v[160:163], 0
    ds_read_b64_tr_b16 a[224:225], v16 offset:0
    v_mfma_f32_16x16x32_bf16 v[124:127], a[164:167], v[164:167], v[124:127]
    s_mov_b32 s45, 22144
    ds_read_b64_tr_b16 a[226:227], v16 offset:4096
    v_mfma_f32_16x16x32_bf16 v[124:127], a[168:171], v[168:171], v[124:127]
    buffer_load_dwordx4 v[216:219], v5, s[24:27], s45 offen offset:0 sc1
    v_mfma_f32_16x16x32_bf16 v[124:127], a[172:175], v[172:175], v[124:127]
    ds_read_b64_tr_b16 a[228:229], v16 offset:8192
    ds_read_b64_tr_b16 a[230:231], v16 offset:12288
    v_mfma_f32_16x16x32_bf16 v[124:127], a[176:179], v[176:179], v[124:127]
    ds_read_b64_tr_b16 a[232:233], v16 offset:16384
    v_mfma_f32_16x16x32_bf16 v[124:127], a[180:183], v[180:183], v[124:127]
    ds_read_b64_tr_b16 a[234:235], v16 offset:20480
    v_mfma_f32_16x16x32_bf16 v[124:127], a[184:187], v[184:187], v[124:127]
    ds_read_b64_tr_b16 a[236:237], v16 offset:24576
    v_mfma_f32_16x16x32_bf16 v[124:127], a[188:191], v[188:191], v[124:127]
    s_waitcnt lgkmcnt(13)
    ds_read_b64_tr_b16 a[238:239], v16 offset:28672
    v_mfma_f32_16x16x32_bf16 v[96:99], a[208:211], a[64:67], v[96:99]
    s_waitcnt lgkmcnt(12)
    buffer_load_dwordx4 v[220:223], v5, s[24:27], s45 offen offset:512 sc1
    v_mfma_f32_16x16x32_bf16 v[96:99], a[212:215], a[68:71], v[96:99]
    s_waitcnt lgkmcnt(10)
    ds_read_b64_tr_b16 a[160:161], v13 offset:0
    ds_read_b64_tr_b16 a[162:163], v13 offset:4096
    v_mfma_f32_16x16x32_bf16 v[96:99], a[216:219], a[72:75], v[96:99]
    s_waitcnt lgkmcnt(10)
    ds_read_b64_tr_b16 a[164:165], v13 offset:8192
    v_mfma_f32_16x16x32_bf16 v[96:99], a[220:223], a[76:79], v[96:99]
    s_waitcnt lgkmcnt(9)
    ds_read_b64_tr_b16 a[166:167], v13 offset:12288
    v_mfma_f32_16x16x32_bf16 v[96:99], a[224:227], a[80:83], v[96:99]
    s_waitcnt lgkmcnt(8)
    ds_read_b64_tr_b16 a[168:169], v13 offset:16384
    v_mfma_f32_16x16x32_bf16 v[96:99], a[228:231], a[84:87], v[96:99]
    s_waitcnt lgkmcnt(7)
    ds_read_b64_tr_b16 a[170:171], v13 offset:20480
    v_mfma_f32_16x16x32_bf16 v[96:99], a[232:235], a[88:91], v[96:99]
    s_waitcnt lgkmcnt(6)
    buffer_load_dwordx4 v[88:91], v59, s[24:27], s45 offen offset:1024 sc1
    v_mfma_f32_16x16x32_bf16 v[96:99], a[236:239], a[92:95], v[96:99]
    ds_read_b64_tr_b16 a[172:173], v13 offset:24576
    ds_read_b64_tr_b16 a[174:175], v13 offset:28672
    v_mfma_f32_16x16x32_bf16 v[100:103], a[208:211], a[96:99], v[100:103]
    buffer_load_dword v11, v9, s[24:27], s39 offen sc1
    v_mfma_f32_16x16x32_bf16 v[100:103], a[212:215], a[100:103], v[100:103]
    ds_read_b64_tr_b16 a[176:177], v17 offset:0
    ds_read_b64_tr_b16 a[178:179], v17 offset:4096
    v_mfma_f32_16x16x32_bf16 v[100:103], a[216:219], a[104:107], v[100:103]
    ds_read_b64_tr_b16 a[180:181], v17 offset:8192
    v_mfma_f32_16x16x32_bf16 v[100:103], a[220:223], a[108:111], v[100:103]
    ds_read_b64_tr_b16 a[182:183], v17 offset:12288
    v_mfma_f32_16x16x32_bf16 v[100:103], a[224:227], a[112:115], v[100:103]
    ds_read_b64_tr_b16 a[184:185], v17 offset:16384
    v_cvt_pk_bf16_f32 v224, v96, v97
    v_mfma_f32_16x16x32_bf16 v[100:103], a[228:231], a[116:119], v[100:103]
    ds_read_b64_tr_b16 a[186:187], v17 offset:20480
    v_cvt_pk_bf16_f32 v225, v98, v99
    v_mfma_f32_16x16x32_bf16 v[100:103], a[232:235], a[120:123], v[100:103]
    ds_read_b64_tr_b16 a[188:189], v17 offset:24576
    v_mfma_f32_16x16x32_bf16 v[100:103], a[236:239], a[124:127], v[100:103]
    s_waitcnt lgkmcnt(13)
    ds_read_b64_tr_b16 a[190:191], v17 offset:28672
    v_mfma_f32_16x16x32_bf16 v[104:107], a[160:163], a[64:67], v[104:107]
    s_waitcnt lgkmcnt(12)
    ds_read_b64_tr_b16 a[208:209], v14 offset:0
    v_mfma_f32_16x16x32_bf16 v[104:107], a[164:167], a[68:71], v[104:107]
    s_waitcnt lgkmcnt(11)
    ds_read_b64_tr_b16 a[210:211], v14 offset:4096
    v_mfma_f32_16x16x32_bf16 v[104:107], a[168:171], a[72:75], v[104:107]
    s_waitcnt lgkmcnt(10)
    ds_read_b64_tr_b16 a[212:213], v14 offset:8192
    v_mfma_f32_16x16x32_bf16 v[104:107], a[172:175], a[76:79], v[104:107]
    s_waitcnt lgkmcnt(9)
    ds_read_b64_tr_b16 a[214:215], v14 offset:12288
    v_mfma_f32_16x16x32_bf16 v[104:107], a[176:179], a[80:83], v[104:107]
    s_waitcnt lgkmcnt(8)
    ds_read_b64_tr_b16 a[216:217], v14 offset:16384
    v_cvt_pk_bf16_f32 v228, v100, v101
    v_mfma_f32_16x16x32_bf16 v[104:107], a[180:183], a[84:87], v[104:107]
    s_waitcnt lgkmcnt(7)
    ds_read_b64_tr_b16 a[218:219], v14 offset:20480
    v_cvt_pk_bf16_f32 v229, v102, v103
    v_mfma_f32_16x16x32_bf16 v[104:107], a[184:187], a[88:91], v[104:107]
    s_waitcnt lgkmcnt(6)
    ds_read_b64_tr_b16 a[220:221], v14 offset:24576
    v_mfma_f32_16x16x32_bf16 v[104:107], a[188:191], a[92:95], v[104:107]
    ds_read_b64_tr_b16 a[222:223], v14 offset:28672
    v_mfma_f32_16x16x32_bf16 v[108:111], a[160:163], a[96:99], v[108:111]
    ds_read_b64_tr_b16 a[224:225], v18 offset:0
    v_mfma_f32_16x16x32_bf16 v[108:111], a[164:167], a[100:103], v[108:111]
    ds_read_b64_tr_b16 a[226:227], v18 offset:4096
    v_mfma_f32_16x16x32_bf16 v[108:111], a[168:171], a[104:107], v[108:111]
    ds_read_b64_tr_b16 a[228:229], v18 offset:8192
    v_mfma_f32_16x16x32_bf16 v[108:111], a[172:175], a[108:111], v[108:111]
    ds_read_b64_tr_b16 a[230:231], v18 offset:12288
    v_mfma_f32_16x16x32_bf16 v[108:111], a[176:179], a[112:115], v[108:111]
    ds_read_b64_tr_b16 a[232:233], v18 offset:16384
    v_cvt_pk_bf16_f32 v226, v104, v105
    v_mfma_f32_16x16x32_bf16 v[108:111], a[180:183], a[116:119], v[108:111]
    s_add_u32 s38, s93, 1536
    ds_read_b64_tr_b16 a[234:235], v18 offset:20480
    v_cvt_pk_bf16_f32 v227, v106, v107
    v_mfma_f32_16x16x32_bf16 v[108:111], a[184:187], a[120:123], v[108:111]
Ltour11:
    s_cbranch_execz Ltour15
    buffer_store_dwordx4 v[224:227], v56, s[28:31], s38 offen sc1
    v_mfma_f32_16x16x32_bf16 v[108:111], a[188:191], a[124:127], v[108:111]
    s_waitcnt lgkmcnt(12)
    ds_read_b64_tr_b16 a[236:237], v18 offset:24576
    ds_read_b64_tr_b16 a[238:239], v18 offset:28672
    v_mfma_f32_16x16x32_bf16 v[112:115], a[208:211], a[64:67], v[112:115]
    s_waitcnt lgkmcnt(12)
    ds_read_b64_tr_b16 a[160:161], v15 offset:0
    v_mfma_f32_16x16x32_bf16 v[112:115], a[212:215], a[68:71], v[112:115]
    s_waitcnt lgkmcnt(11)
    ds_read_b64_tr_b16 a[162:163], v15 offset:4096
    v_mfma_f32_16x16x32_bf16 v[112:115], a[216:219], a[72:75], v[112:115]
    s_waitcnt lgkmcnt(10)
    ds_read_b64_tr_b16 a[164:165], v15 offset:8192
    v_mfma_f32_16x16x32_bf16 v[112:115], a[220:223], a[76:79], v[112:115]
    s_waitcnt lgkmcnt(9)
    ds_read_b64_tr_b16 a[166:167], v15 offset:12288
    v_mfma_f32_16x16x32_bf16 v[112:115], a[224:227], a[80:83], v[112:115]
    s_waitcnt lgkmcnt(8)
    ds_read_b64_tr_b16 a[168:169], v15 offset:16384
    v_cvt_pk_bf16_f32 v230, v108, v109
    v_mfma_f32_16x16x32_bf16 v[112:115], a[228:231], a[84:87], v[112:115]
    s_waitcnt lgkmcnt(7)
    s_add_u32 s38, s93, 165376
    ds_read_b64_tr_b16 a[170:171], v15 offset:20480
    v_cvt_pk_bf16_f32 v231, v110, v111
    v_mfma_f32_16x16x32_bf16 v[112:115], a[232:235], a[88:91], v[112:115]
    s_waitcnt lgkmcnt(6)
    buffer_store_dwordx4 v[228:231], v56, s[28:31], s38 offen sc1
    v_mfma_f32_16x16x32_bf16 v[112:115], a[236:239], a[92:95], v[112:115]
    ds_read_b64_tr_b16 a[172:173], v15 offset:24576
    ds_read_b64_tr_b16 a[174:175], v15 offset:28672
    v_mfma_f32_16x16x32_bf16 v[116:119], a[208:211], a[96:99], v[116:119]
    ds_read_b64_tr_b16 a[176:177], v19 offset:0
    v_mfma_f32_16x16x32_bf16 v[116:119], a[212:215], a[100:103], v[116:119]
    ds_read_b64_tr_b16 a[178:179], v19 offset:4096
    v_mfma_f32_16x16x32_bf16 v[116:119], a[216:219], a[104:107], v[116:119]
    ds_read_b64_tr_b16 a[180:181], v19 offset:8192
    v_mfma_f32_16x16x32_bf16 v[116:119], a[220:223], a[108:111], v[116:119]
    ds_read_b64_tr_b16 a[182:183], v19 offset:12288
    v_mfma_f32_16x16x32_bf16 v[116:119], a[224:227], a[112:115], v[116:119]
    ds_read_b64_tr_b16 a[184:185], v19 offset:16384
    v_cvt_pk_bf16_f32 v232, v112, v113
    v_mfma_f32_16x16x32_bf16 v[116:119], a[228:231], a[116:119], v[116:119]
    ds_read_b64_tr_b16 a[186:187], v19 offset:20480
    v_cvt_pk_bf16_f32 v233, v114, v115
    v_mfma_f32_16x16x32_bf16 v[116:119], a[232:235], a[120:123], v[116:119]
    ds_read_b64_tr_b16 a[188:189], v19 offset:24576
    v_mfma_f32_16x16x32_bf16 v[116:119], a[236:239], a[124:127], v[116:119]
    s_waitcnt lgkmcnt(13)
    ds_read_b64_tr_b16 a[190:191], v19 offset:28672
    v_mfma_f32_16x16x32_bf16 v[120:123], a[160:163], a[64:67], v[120:123]
    s_waitcnt lgkmcnt(12)
    v_mfma_f32_16x16x32_bf16 v[120:123], a[164:167], a[68:71], v[120:123]
    s_waitcnt lgkmcnt(10)
    v_mfma_f32_16x16x32_bf16 v[120:123], a[168:171], a[72:75], v[120:123]
    s_waitcnt lgkmcnt(8)
    v_mfma_f32_16x16x32_bf16 v[120:123], a[172:175], a[76:79], v[120:123]
    s_waitcnt lgkmcnt(6)
    v_mfma_f32_16x16x32_bf16 v[120:123], a[176:179], a[80:83], v[120:123]
    s_waitcnt lgkmcnt(4)
    v_cvt_pk_bf16_f32 v236, v116, v117
    v_mfma_f32_16x16x32_bf16 v[120:123], a[180:183], a[84:87], v[120:123]
    s_waitcnt lgkmcnt(2)
    v_cvt_pk_bf16_f32 v237, v118, v119
    v_mfma_f32_16x16x32_bf16 v[120:123], a[184:187], a[88:91], v[120:123]
    s_waitcnt lgkmcnt(0)
    v_mfma_f32_16x16x32_bf16 v[120:123], a[188:191], a[92:95], v[120:123]
    v_mfma_f32_16x16x32_bf16 v[124:127], a[160:163], a[96:99], v[124:127]
    v_mfma_f32_16x16x32_bf16 v[124:127], a[164:167], a[100:103], v[124:127]
    v_mfma_f32_16x16x32_bf16 v[124:127], a[168:171], a[104:107], v[124:127]
    v_mfma_f32_16x16x32_bf16 v[124:127], a[172:175], a[108:111], v[124:127]
    v_mfma_f32_16x16x32_bf16 v[124:127], a[176:179], a[112:115], v[124:127]
    s_nop 2
    v_cvt_pk_bf16_f32 v234, v120, v121
    v_mfma_f32_16x16x32_bf16 v[124:127], a[180:183], a[116:119], v[124:127]
    s_add_u32 s38, s93, 1664
    v_cvt_pk_bf16_f32 v235, v122, v123
    v_mfma_f32_16x16x32_bf16 v[124:127], a[184:187], a[120:123], v[124:127]
    buffer_store_dwordx4 v[232:235], v56, s[28:31], s38 offen sc1
    v_mfma_f32_16x16x32_bf16 v[124:127], a[188:191], a[124:127], v[124:127]
    s_nop 7
    v_cvt_pk_bf16_f32 v238, v124, v125
    s_add_u32 s38, s93, 165504
    v_cvt_pk_bf16_f32 v239, v126, v127
    buffer_store_dwordx4 v[236:239], v56, s[28:31], s38 offen sc1
    s_waitcnt vmcnt(16)
    v_lshlrev_b32 v144, 16, v64
    v_and_b32 v145, 0xffff0000, v64
    v_lshlrev_b32 v146, 16, v65
    v_and_b32 v147, 0xffff0000, v65
    v_lshlrev_b32 v148, 16, v66
    v_and_b32 v149, 0xffff0000, v66
    v_lshlrev_b32 v150, 16, v67
    v_and_b32 v151, 0xffff0000, v67
    s_waitcnt vmcnt(15)
    v_lshlrev_b32 v152, 16, v68
    v_and_b32 v153, 0xffff0000, v68
    v_lshlrev_b32 v154, 16, v69
    v_and_b32 v155, 0xffff0000, v69
    v_lshlrev_b32 v156, 16, v70
    v_and_b32 v157, 0xffff0000, v70
    v_lshlrev_b32 v158, 16, v71
    v_and_b32 v159, 0xffff0000, v71
    s_waitcnt vmcnt(14)
    v_lshlrev_b32 v160, 16, v72
    v_and_b32 v161, 0xffff0000, v72
    v_lshlrev_b32 v162, 16, v73
    v_and_b32 v163, 0xffff0000, v73
    v_lshlrev_b32 v164, 16, v74
    v_and_b32 v165, 0xffff0000, v74
    v_lshlrev_b32 v166, 16, v75
    v_and_b32 v167, 0xffff0000, v75
    s_waitcnt vmcnt(13)
    v_lshlrev_b32 v168, 16, v76
    v_and_b32 v169, 0xffff0000, v76
    v_lshlrev_b32 v170, 16, v77
    v_and_b32 v171, 0xffff0000, v77
    s_waitcnt vmcnt(12)
    v_lshlrev_b32 v172, 16, v78
    v_and_b32 v173, 0xffff0000, v78
    v_lshlrev_b32 v174, 16, v79
    v_and_b32 v175, 0xffff0000, v79
    s_waitcnt vmcnt(11)
    v_lshlrev_b32 v176, 16, v80
    v_and_b32 v177, 0xffff0000, v80
    v_lshlrev_b32 v178, 16, v81
    v_and_b32 v179, 0xffff0000, v81
    s_waitcnt vmcnt(10)
    v_lshlrev_b32 v180, 16, v82
    v_and_b32 v181, 0xffff0000, v82
    v_lshlrev_b32 v182, 16, v83
    v_and_b32 v183, 0xffff0000, v83
    s_waitcnt vmcnt(9)
    v_lshlrev_b32 v184, 16, v84
    v_and_b32 v185, 0xffff0000, v84
    v_lshlrev_b32 v186, 16, v85
    v_and_b32 v187, 0xffff0000, v85
    s_waitcnt vmcnt(8)
    v_lshlrev_b32 v188, 16, v86
    v_and_b32 v189, 0xffff0000, v86
    v_lshlrev_b32 v190, 16, v87
    v_and_b32 v191, 0xffff0000, v87
    v_lshlrev_b32 v12, 16, v36
    v_and_b32 v13, 0xffff0000, v36
    v_lshlrev_b32 v14, 16, v37
    v_and_b32 v15, 0xffff0000, v37
    v_lshlrev_b32 v16, 16, v38
    v_and_b32 v17, 0xffff0000, v38
    v_lshlrev_b32 v18, 16, v39
    v_and_b32 v19, 0xffff0000, v39
    v_lshlrev_b32 v20, 16, v40
    v_and_b32 v21, 0xffff0000, v40
    v_lshlrev_b32 v22, 16, v41
    v_and_b32 v23, 0xffff0000, v41
    v_lshlrev_b32 v24, 16, v42
    v_and_b32 v25, 0xffff0000, v42
    v_lshlrev_b32 v26, 16, v43
    v_and_b32 v27, 0xffff0000, v43
    v_lshlrev_b32 v28, 16, v244
    v_and_b32 v29, 0xffff0000, v244
    v_lshlrev_b32 v30, 16, v245
    v_and_b32 v31, 0xffff0000, v245
    v_lshlrev_b32 v32, 16, v246
    v_and_b32 v33, 0xffff0000, v246
    v_lshlrev_b32 v34, 16, v247
    v_and_b32 v35, 0xffff0000, v247
    v_lshlrev_b32 v96, 16, v192
    v_and_b32 v97, 0xffff0000, v192
    v_lshlrev_b32 v98, 16, v193
    v_and_b32 v99, 0xffff0000, v193
    v_lshlrev_b32 v100, 16, v194
    v_and_b32 v101, 0xffff0000, v194
    v_lshlrev_b32 v102, 16, v195
    v_and_b32 v103, 0xffff0000, v195
    v_lshlrev_b32 v104, 16, v196
    v_and_b32 v105, 0xffff0000, v196
    v_lshlrev_b32 v106, 16, v197
    v_and_b32 v107, 0xffff0000, v197
    v_lshlrev_b32 v108, 16, v198
    v_and_b32 v109, 0xffff0000, v198
    v_lshlrev_b32 v110, 16, v199
    v_and_b32 v111, 0xffff0000, v199
    v_lshlrev_b32 v112, 16, v200
    v_and_b32 v113, 0xffff0000, v200
    v_lshlrev_b32 v114, 16, v201
    v_and_b32 v115, 0xffff0000, v201
    v_lshlrev_b32 v116, 16, v202
    v_and_b32 v117, 0xffff0000, v202
    v_lshlrev_b32 v118, 16, v203
    v_and_b32 v119, 0xffff0000, v203
    v_mov_b32 v244, 0
    v_mov_b32 v245, 0
    s_waitcnt vmcnt(0)
    buffer_store_dword v10, v8, s[24:27], s92 offen sc1
    v_cmp_ne_u32 s[54:55], s95, v11
    s_cmp_lg_u64 s[54:55], 0
    s_cbranch_scc1 Ltail_spin1
Ltail_got1:
    s_add_u32 s39, s39, 4
    s_add_u32 s45, s44, 0
    buffer_load_dwordx4 a[0:3], v2, s[28:31], s45 offen offset:0 sc1
    buffer_load_dwordx4 a[4:7], v2, s[28:31], s45 offen offset:2048 sc1
    s_add_u32 s45, s44, 4096
    buffer_load_dwordx4 a[8:11], v2, s[28:31], s45 offen offset:0 sc1
    buffer_load_dwordx4 a[12:15], v2, s[28:31], s45 offen offset:2048 sc1
    s_add_u32 s45, s44, 8192
    buffer_load_dwordx4 a[16:19], v2, s[28:31], s45 offen offset:0 sc1
    buffer_load_dwordx4 a[20:23], v2, s[28:31], s45 offen offset:2048 sc1
    s_add_u32 s45, s44, 12288
    buffer_load_dwordx4 a[24:27], v2, s[28:31], s45 offen offset:0 sc1
    buffer_load_dwordx4 a[28:31], v2, s[28:31], s45 offen offset:2048 sc1
    ds_write_b128 v51, a[128:131] offset:0
    ds_write_b128 v51, a[132:135] offset:4096
    ds_write_b128 v51, a[136:139] offset:8192
    ds_write_b128 v51, a[140:143] offset:12288
    ds_write_b128 v51, a[144:147] offset:16384
    ds_write_b128 v51, a[148:151] offset:20480
    ds_write_b128 v51, a[152:155] offset:24576
    ds_write_b128 v51, a[156:159] offset:28672
    ds_write_b128 v51, a[240:243] offset:32768
    ds_write_b128 v255, a[244:247] offset:40960
    ds_write_b128 v255, a[248:251] offset:45056
    ds_write_b128 v255, a[252:255] offset:49152
    v_lshlrev_b32 v120, 16, v204
    v_and_b32 v121, 0xffff0000, v204
    v_lshlrev_b32 v122, 16, v205
    v_and_b32 v123, 0xffff0000, v205
    v_lshlrev_b32 v124, 16, v206
    v_and_b32 v125, 0xffff0000, v206
    v_lshlrev_b32 v126, 16, v207
    v_and_b32 v127, 0xffff0000, v207
    v_lshlrev_b32 v128, 16, v208
    v_and_b32 v129, 0xffff0000, v208
    v_lshlrev_b32 v130, 16, v209
    v_and_b32 v131, 0xffff0000, v209
    v_lshlrev_b32 v132, 16, v210
    v_and_b32 v133, 0xffff0000, v210
    v_lshlrev_b32 v134, 16, v211
    v_and_b32 v135, 0xffff0000, v211
    v_lshlrev_b32 v136, 16, v212
    v_and_b32 v137, 0xffff0000, v212
    v_lshlrev_b32 v138, 16, v213
    v_and_b32 v139, 0xffff0000, v213
    v_lshlrev_b32 v140, 16, v214
    v_and_b32 v141, 0xffff0000, v214
    v_lshlrev_b32 v142, 16, v215
    v_and_b32 v143, 0xffff0000, v215
    v_lshlrev_b32 v192, 16, v216
    v_and_b32 v193, 0xffff0000, v216
    v_lshlrev_b32 v194, 16, v217
    v_and_b32 v195, 0xffff0000, v217
    v_lshlrev_b32 v196, 16, v218
    v_and_b32 v197, 0xffff0000, v218
    v_lshlrev_b32 v198, 16, v219
    v_and_b32 v199, 0xffff0000, v219
    v_lshlrev_b32 v200, 16, v220
    v_and_b32 v201, 0xffff0000, v220
    v_lshlrev_b32 v202, 16, v221
    v_and_b32 v203, 0xffff0000, v221
    v_lshlrev_b32 v204, 16, v222
    v_and_b32 v205, 0xffff0000, v222
    v_lshlrev_b32 v206, 16, v223
    v_and_b32 v207, 0xffff0000, v223
    v_lshlrev_b32 v208, 16, v88
    v_and_b32 v209, 0xffff0000, v88
    v_lshlrev_b32 v210, 16, v89
    v_and_b32 v211, 0xffff0000, v89
    v_lshlrev_b32 v212, 16, v90
    v_and_b32 v213, 0xffff0000, v90
    v_lshlrev_b32 v214, 16, v91
    v_and_b32 v215, 0xffff0000, v91
    buffer_load_dword v11, v9, s[24:27], s39 offen sc1
    s_add_u32 s45, s44, 16384
    buffer_load_dwordx4 a[32:35], v54, s[28:31], s45 offen offset:0 sc1
    buffer_load_dwordx4 a[36:39], v54, s[28:31], s45 offen offset:1024 sc1
    buffer_load_dwordx4 a[40:43], v54, s[28:31], s45 offen offset:2048 sc1
    buffer_load_dwordx4 a[44:47], v54, s[28:31], s45 offen offset:3072 sc1
    s_waitcnt vmcnt(4)
    v_cmp_ne_u32 s[54:55], s95, v11
    s_cmp_lg_u64 s[54:55], 0
    s_cbranch_scc1 Ltail_spin2
Ltail_got2:
    s_add_u32 s39, s39, 4
    s_add_u32 s45, s44, 0
    buffer_load_dwordx4 a[64:67], v2, s[28:31], s45 offen offset:1024 sc1
    buffer_load_dwordx4 a[68:71], v2, s[28:31], s45 offen offset:3072 sc1
    s_add_u32 s45, s44, 4096
    buffer_load_dwordx4 a[72:75], v2, s[28:31], s45 offen offset:1024 sc1
    buffer_load_dwordx4 a[76:79], v2, s[28:31], s45 offen offset:3072 sc1
    s_add_u32 s45, s44, 8192
    buffer_load_dwordx4 a[80:83], v2, s[28:31], s45 offen offset:1024 sc1
    buffer_load_dwordx4 a[84:87], v2, s[28:31], s45 offen offset:3072 sc1
    s_add_u32 s45, s44, 12288
    buffer_load_dwordx4 a[88:91], v2, s[28:31], s45 offen offset:1024 sc1
    buffer_load_dwordx4 a[92:95], v2, s[28:31], s45 offen offset:3072 sc1
    v_mfma_f32_16x16x32_bf16 v[64:67], v[250:253], a[0:3], 0
    v_mfma_f32_16x16x32_bf16 v[68:71], v[248:251], a[0:3], 0
    v_mfma_f32_16x16x32_bf16 v[64:67], v[250:253], a[4:7], v[64:67]
    v_mfma_f32_16x16x32_bf16 v[68:71], v[248:251], a[4:7], v[68:71]
    v_mfma_f32_16x16x32_bf16 v[64:67], v[250:253], a[8:11], v[64:67]
    v_mfma_f32_16x16x32_bf16 v[68:71], v[248:251], a[8:11], v[68:71]
    v_mfma_f32_16x16x32_bf16 v[64:67], v[250:253], a[12:15], v[64:67]
    v_mfma_f32_16x16x32_bf16 v[68:71], v[248:251], a[12:15], v[68:71]
    v_mfma_f32_16x16x32_bf16 v[64:67], v[250:253], a[16:19], v[64:67]
    v_mfma_f32_16x16x32_bf16 v[68:71], v[248:251], a[16:19], v[68:71]
    v_mfma_f32_16x16x32_bf16 v[64:67], v[250:253], a[20:23], v[64:67]
    v_mfma_f32_16x16x32_bf16 v[68:71], v[248:251], a[20:23], v[68:71]
    v_mfma_f32_16x16x32_bf16 v[64:67], v[250:253], a[24:27], v[64:67]
    v_mfma_f32_16x16x32_bf16 v[68:71], v[248:251], a[24:27], v[68:71]
    v_mfma_f32_16x16x32_bf16 v[64:67], v[250:253], a[28:31], v[64:67]
    v_mfma_f32_16x16x32_bf16 v[68:71], v[248:251], a[28:31], v[68:71]
    s_waitcnt vmcnt(11)
    v_mfma_f32_16x16x32_bf16 v[80:83], v[242:245], a[32:35], 0
    v_mfma_f32_16x16x32_bf16 v[84:87], v[240:243], a[32:35], 0
    s_waitcnt vmcnt(10)
    v_mfma_f32_16x16x32_bf16 v[80:83], v[242:245], a[36:39], v[80:83]
    v_mfma_f32_16x16x32_bf16 v[84:87], v[240:243], a[36:39], v[84:87]
    s_waitcnt vmcnt(9)
    v_mfma_f32_16x16x32_bf16 v[80:83], v[242:245], a[40:43], v[80:83]
    v_mfma_f32_16x16x32_bf16 v[84:87], v[240:243], a[40:43], v[84:87]
    s_waitcnt vmcnt(8)
    v_mfma_f32_16x16x32_bf16 v[80:83], v[242:245], a[44:47], v[80:83]
    v_mfma_f32_16x16x32_bf16 v[84:87], v[240:243], a[44:47], v[84:87]
    s_waitcnt vmcnt(7)
    s_nop 5
    v_mov_b32_dpp v80, v80 row_ror:8 row_mask:0x4 bank_mask:0xf
    v_mov_b32_dpp v81, v81 row_ror:8 row_mask:0x4 bank_mask:0xf
    v_mov_b32_dpp v82, v82 row_ror:8 row_mask:0x4 bank_mask:0xf
    v_mov_b32_dpp v83, v83 row_ror:8 row_mask:0x4 bank_mask:0xf
    v_mov_b32_dpp v84, v84 row_ror:8 row_mask:0x4 bank_mask:0xf
    v_mov_b32_dpp v85, v85 row_ror:8 row_mask:0x4 bank_mask:0xf
    v_mov_b32_dpp v86, v86 row_ror:8 row_mask:0x4 bank_mask:0xf
    v_mov_b32_dpp v87, v87 row_ror:8 row_mask:0x4 bank_mask:0xf
    v_pk_fma_f32 v[12:13], v[96:97], v[64:65], v[12:13]
    v_pk_fma_f32 v[14:15], v[98:99], v[66:67], v[14:15]
    v_pk_fma_f32 v[16:17], v[100:101], v[68:69], v[16:17]
    v_pk_fma_f32 v[18:19], v[102:103], v[70:71], v[18:19]
    v_cvt_pk_bf16_f32 v36, v12, v13
    v_cvt_pk_bf16_f32 v37, v14, v15
    v_cvt_pk_bf16_f32 v38, v16, v17
    v_cvt_pk_bf16_f32 v39, v18, v19
    v_lshlrev_b32 v12, 16, v36
    v_and_b32 v13, 0xffff0000, v36
    v_lshlrev_b32 v14, 16, v37
    v_and_b32 v15, 0xffff0000, v37
    v_lshlrev_b32 v16, 16, v38
    v_and_b32 v17, 0xffff0000, v38
    v_lshlrev_b32 v18, 16, v39
    v_and_b32 v19, 0xffff0000, v39
    s_mov_b32 s45, 2622592
    buffer_store_dwordx4 v[36:39], v6, s[24:27], s45 offen offset:0 sc1
    v_pk_add_f32 v[48:49], v[12:13], v[14:15]
    v_pk_add_f32 v[50:51], v[16:17], v[18:19]
    v_pk_fma_f32 v[28:29], v[112:113], v[80:81], v[28:29]
    v_pk_fma_f32 v[30:31], v[114:115], v[82:83], v[30:31]
    v_pk_fma_f32 v[32:33], v[116:117], v[84:85], v[32:33]
    v_pk_fma_f32 v[34:35], v[118:119], v[86:87], v[34:35]
    v_cvt_pk_bf16_f32 v44, v28, v29
    v_cvt_pk_bf16_f32 v45, v30, v31
    v_cvt_pk_bf16_f32 v46, v32, v33
    v_cvt_pk_bf16_f32 v47, v34, v35
    v_lshlrev_b32 v28, 16, v44
    v_and_b32 v29, 0xffff0000, v44
    v_lshlrev_b32 v30, 16, v45
    v_and_b32 v31, 0xffff0000, v45
    v_lshlrev_b32 v32, 16, v46
    v_and_b32 v33, 0xffff0000, v46
    v_lshlrev_b32 v34, 16, v47
    v_and_b32 v35, 0xffff0000, v47
    s_mov_b32 s45, 2622592
    buffer_store_dwordx4 v[44:47], v60, s[24:27], s45 offen offset:1024 sc1
    v_pk_add_f32 v[48:49], v[48:49], v[28:29]
    v_pk_add_f32 v[50:51], v[50:51], v[30:31]
    v_pk_add_f32 v[48:49], v[48:49], v[32:33]
    v_pk_add_f32 v[50:51], v[50:51], v[34:35]
    v_mfma_f32_16x16x32_bf16 v[72:75], v[250:253], a[64:67], 0
    v_mfma_f32_16x16x32_bf16 v[76:79], v[248:251], a[64:67], 0
    s_waitcnt vmcnt(8)
    v_mfma_f32_16x16x32_bf16 v[72:75], v[250:253], a[68:71], v[72:75]
    v_mfma_f32_16x16x32_bf16 v[76:79], v[248:251], a[68:71], v[76:79]
    s_waitcnt vmcnt(7)
    v_mfma_f32_16x16x32_bf16 v[72:75], v[250:253], a[72:75], v[72:75]
    v_mfma_f32_16x16x32_bf16 v[76:79], v[248:251], a[72:75], v[76:79]
    s_waitcnt vmcnt(6)
    v_mfma_f32_16x16x32_bf16 v[72:75], v[250:253], a[76:79], v[72:75]
    v_mfma_f32_16x16x32_bf16 v[76:79], v[248:251], a[76:79], v[76:79]
    s_waitcnt vmcnt(5)
    v_mfma_f32_16x16x32_bf16 v[72:75], v[250:253], a[80:83], v[72:75]
    v_mfma_f32_16x16x32_bf16 v[76:79], v[248:251], a[80:83], v[76:79]
    s_waitcnt vmcnt(4)
    v_mfma_f32_16x16x32_bf16 v[72:75], v[250:253], a[84:87], v[72:75]
    v_mfma_f32_16x16x32_bf16 v[76:79], v[248:251], a[84:87], v[76:79]
    s_waitcnt vmcnt(3)
    v_mfma_f32_16x16x32_bf16 v[72:75], v[250:253], a[88:91], v[72:75]
    v_mfma_f32_16x16x32_bf16 v[76:79], v[248:251], a[88:91], v[76:79]
    s_waitcnt vmcnt(2)
    v_mfma_f32_16x16x32_bf16 v[72:75], v[250:253], a[92:95], v[72:75]
    v_mfma_f32_16x16x32_bf16 v[76:79], v[248:251], a[92:95], v[76:79]
    s_add_u32 s57, s59, 4096
    s_add_u32 m0, s6, -110592
    s_nop 0
    buffer_load_dwordx4 v255, s[84:87], s57 offen lds
    s_add_u32 s57, s59, 8192
    s_add_u32 m0, s6, -106496
    s_nop 0
    buffer_load_dwordx4 v255, s[84:87], s57 offen lds
    s_add_u32 s57, s59, 12288
    s_add_u32 m0, s6, -102400
    s_nop 0
    buffer_load_dwordx4 v255, s[84:87], s57 offen lds
    s_add_u32 s57, s59, 16384
    s_add_u32 m0, s6, -98304
    s_nop 0
    buffer_load_dwordx4 v255, s[84:87], s57 offen lds
    s_add_u32 s57, s59, 20480
    s_add_u32 m0, s6, -94208
    s_nop 0
    buffer_load_dwordx4 v255, s[84:87], s57 offen lds
    s_add_u32 s57, s59, 24576
    s_add_u32 m0, s6, -90112
    s_nop 0
    buffer_load_dwordx4 v255, s[84:87], s57 offen lds
    s_add_u32 s57, s59, 28672
    s_add_u32 m0, s6, -86016
    s_nop 0
    buffer_load_dwordx4 v255, s[84:87], s57 offen lds
    s_add_u32 s57, s59, 32768
    s_add_u32 m0, s6, -81920
    s_nop 0
    buffer_load_dwordx4 v255, s[84:87], s57 offen lds
    v_pk_fma_f32 v[20:21], v[104:105], v[72:73], v[20:21]
    v_pk_fma_f32 v[22:23], v[106:107], v[74:75], v[22:23]
    v_pk_fma_f32 v[24:25], v[108:109], v[76:77], v[24:25]
    v_pk_fma_f32 v[26:27], v[110:111], v[78:79], v[26:27]
    v_cvt_pk_bf16_f32 v40, v20, v21
    v_cvt_pk_bf16_f32 v41, v22, v23
    v_cvt_pk_bf16_f32 v42, v24, v25
    v_cvt_pk_bf16_f32 v43, v26, v27
    v_lshlrev_b32 v20, 16, v40
    v_and_b32 v21, 0xffff0000, v40
    v_lshlrev_b32 v22, 16, v41
    v_and_b32 v23, 0xffff0000, v41
    v_lshlrev_b32 v24, 16, v42
    v_and_b32 v25, 0xffff0000, v42
    v_lshlrev_b32 v26, 16, v43
    v_and_b32 v27, 0xffff0000, v43
    s_mov_b32 s45, 2622592
    buffer_store_dwordx4 v[40:43], v6, s[24:27], s45 offen offset:512 sc1
    v_pk_add_f32 v[48:49], v[48:49], v[20:21]
    v_pk_add_f32 v[50:51], v[50:51], v[22:23]
    v_pk_add_f32 v[48:49], v[48:49], v[24:25]
    v_pk_add_f32 v[50:51], v[50:51], v[26:27]
    v_pk_add_f32 v[48:49], v[48:49], v[50:51]
    v_add_f32 v48, v48, v49
    s_nop 1
    v_add_f32_dpp v48, v48, v48 row_ror:1 row_mask:0xf bank_mask:0xf
    s_nop 1
    v_add_f32_dpp v48, v48, v48 row_ror:2 row_mask:0xf bank_mask:0xf
    s_nop 1
    v_add_f32_dpp v48, v48, v48 row_ror:4 row_mask:0xf bank_mask:0xf
    s_nop 1
    v_add_f32_dpp v48, v48, v48 row_ror:8 row_mask:0xf bank_mask:0xf
    v_mov_b32 v52, v48
    s_nop 1
    v_permlane16_swap_b32 v48, v52
    s_nop 0
    v_add_f32 v48, v48, v52
    v_mul_f32 v48, 0x3ae38e39, v48
    v_pk_add_f32 v[216:217], v[12:13], v[48:49] op_sel_hi:[1,0] neg_lo:[0,1] neg_hi:[0,1]
    v_pk_add_f32 v[218:219], v[14:15], v[48:49] op_sel_hi:[1,0] neg_lo:[0,1] neg_hi:[0,1]
    v_pk_add_f32 v[220:221], v[16:17], v[48:49] op_sel_hi:[1,0] neg_lo:[0,1] neg_hi:[0,1]
    v_pk_add_f32 v[222:223], v[18:19], v[48:49] op_sel_hi:[1,0] neg_lo:[0,1] neg_hi:[0,1]
    v_pk_add_f32 v[224:225], v[20:21], v[48:49] op_sel_hi:[1,0] neg_lo:[0,1] neg_hi:[0,1]
    v_pk_add_f32 v[226:227], v[22:23], v[48:49] op_sel_hi:[1,0] neg_lo:[0,1] neg_hi:[0,1]
    v_pk_add_f32 v[228:229], v[24:25], v[48:49] op_sel_hi:[1,0] neg_lo:[0,1] neg_hi:[0,1]
    v_pk_add_f32 v[230:231], v[26:27], v[48:49] op_sel_hi:[1,0] neg_lo:[0,1] neg_hi:[0,1]
    v_pk_add_f32 v[232:233], v[28:29], v[48:49] op_sel_hi:[1,0] neg_lo:[0,1] neg_hi:[0,1]
    v_pk_add_f32 v[234:235], v[30:31], v[48:49] op_sel_hi:[1,0] neg_lo:[0,1] neg_hi:[0,1]
    v_pk_add_f32 v[236:237], v[32:33], v[48:49] op_sel_hi:[1,0] neg_lo:[0,1] neg_hi:[0,1]
    v_pk_add_f32 v[238:239], v[34:35], v[48:49] op_sel_hi:[1,0] neg_lo:[0,1] neg_hi:[0,1]
    v_pk_mul_f32 v[50:51], v[216:217], v[216:217]
    v_pk_mul_f32 v[52:53], v[224:225], v[224:225]
    v_pk_mul_f32 v[62:63], v[232:233], v[232:233]
    v_pk_fma_f32 v[50:51], v[218:219], v[218:219], v[50:51]
    v_pk_fma_f32 v[52:53], v[226:227], v[226:227], v[52:53]
    v_pk_fma_f32 v[62:63], v[234:235], v[234:235], v[62:63]
    v_pk_fma_f32 v[50:51], v[220:221], v[220:221], v[50:51]
    v_pk_fma_f32 v[52:53], v[228:229], v[228:229], v[52:53]
    v_pk_fma_f32 v[62:63], v[236:237], v[236:237], v[62:63]
    v_pk_fma_f32 v[50:51], v[222:223], v[222:223], v[50:51]
    v_pk_fma_f32 v[52:53], v[230:231], v[230:231], v[52:53]
    v_pk_fma_f32 v[62:63], v[238:239], v[238:239], v[62:63]
    v_pk_add_f32 v[50:51], v[50:51], v[52:53]
    v_add_f32 v62, v62, v63
    v_add_f32 v50, v50, v51
    v_cndmask_b32 v62, 0, v62, vcc
    v_add_f32 v50, v50, v62
    s_nop 1
    v_add_f32_dpp v50, v50, v50 row_ror:1 row_mask:0xf bank_mask:0xf
    s_nop 1
    v_add_f32_dpp v50, v50, v50 row_ror:2 row_mask:0xf bank_mask:0xf
    s_nop 1
    v_add_f32_dpp v50, v50, v50 row_ror:4 row_mask:0xf bank_mask:0xf
    s_nop 1
    v_add_f32_dpp v50, v50, v50 row_ror:8 row_mask:0xf bank_mask:0xf
    v_mov_b32 v52, v50
    s_nop 1
    v_permlane16_swap_b32 v50, v52
    s_nop 0
    v_add_f32 v50, v50, v52
    v_mul_f32 v50, 0x3ae38e39, v50
    v_cvt_pk_bf16_f32 v52, v48, v50
    v_and_b32 v50, 0xffff0000, v52
    v_lshlrev_b32 v52, 16, v52
    v_add_f32 v50, 0x3727c5ac, v50
    v_sub_f32 v48, v48, v52
    v_cvt_pk_bf16_f32 v50, v50, v50
    v_and_b32 v50, 0xffff0000, v50
    v_sqrt_f32 v50, v50
    s_nop 0
    v_cvt_pk_bf16_f32 v50, v50, v50
    v_and_b32 v50, 0xffff0000, v50
    v_rcp_f32 v50, v50
    s_mov_b32 s45, 2621440
    v_mul_f32 v48, v48, v50
    v_pk_fma_f32 v[216:217], v[216:217], v[50:51], v[48:49] op_sel_hi:[1,0,0]
    v_pk_fma_f32 v[218:219], v[218:219], v[50:51], v[48:49] op_sel_hi:[1,0,0]
    v_pk_fma_f32 v[220:221], v[220:221], v[50:51], v[48:49] op_sel_hi:[1,0,0]
    v_pk_fma_f32 v[222:223], v[222:223], v[50:51], v[48:49] op_sel_hi:[1,0,0]
    v_pk_fma_f32 v[224:225], v[224:225], v[50:51], v[48:49] op_sel_hi:[1,0,0]
    v_pk_fma_f32 v[226:227], v[226:227], v[50:51], v[48:49] op_sel_hi:[1,0,0]
    v_pk_fma_f32 v[228:229], v[228:229], v[50:51], v[48:49] op_sel_hi:[1,0,0]
    v_pk_fma_f32 v[230:231], v[230:231], v[50:51], v[48:49] op_sel_hi:[1,0,0]
    v_pk_fma_f32 v[232:233], v[232:233], v[50:51], v[48:49] op_sel_hi:[1,0,0]
    v_pk_fma_f32 v[234:235], v[234:235], v[50:51], v[48:49] op_sel_hi:[1,0,0]
    v_pk_fma_f32 v[236:237], v[236:237], v[50:51], v[48:49] op_sel_hi:[1,0,0]
    v_pk_fma_f32 v[238:239], v[238:239], v[50:51], v[48:49] op_sel_hi:[1,0,0]
    v_pk_fma_f32 v[216:217], v[216:217], v[120:121], v[144:145]
    v_pk_fma_f32 v[218:219], v[218:219], v[122:123], v[146:147]
    v_pk_fma_f32 v[220:221], v[220:221], v[124:125], v[148:149]
    v_pk_fma_f32 v[222:223], v[222:223], v[126:127], v[150:151]
    v_pk_fma_f32 v[224:225], v[224:225], v[128:129], v[152:153]
    v_pk_fma_f32 v[226:227], v[226:227], v[130:131], v[154:155]
    v_pk_fma_f32 v[228:229], v[228:229], v[132:133], v[156:157]
    v_pk_fma_f32 v[230:231], v[230:231], v[134:135], v[158:159]
    v_pk_fma_f32 v[232:233], v[232:233], v[136:137], v[160:161]
    v_pk_fma_f32 v[234:235], v[234:235], v[138:139], v[162:163]
    v_pk_fma_f32 v[236:237], v[236:237], v[140:141], v[164:165]
    v_pk_fma_f32 v[238:239], v[238:239], v[142:143], v[166:167]
    v_cvt_pk_bf16_f32 v64, v216, v217
    v_cvt_pk_bf16_f32 v65, v218, v219
    v_cvt_pk_bf16_f32 v66, v220, v221
    v_cvt_pk_bf16_f32 v67, v222, v223
    v_cvt_pk_bf16_f32 v68, v224, v225
    v_cvt_pk_bf16_f32 v69, v226, v227
    v_cvt_pk_bf16_f32 v70, v228, v229
    v_cvt_pk_bf16_f32 v71, v230, v231
    v_cvt_pk_bf16_f32 v72, v232, v233
    v_cvt_pk_bf16_f32 v73, v234, v235
    v_cvt_pk_bf16_f32 v74, v236, v237
    v_cvt_pk_bf16_f32 v75, v238, v239
    buffer_store_dwordx4 v[64:67], v6, s[24:27], s45 offen offset:0 sc1
    buffer_store_dwordx4 v[68:71], v6, s[24:27], s45 offen offset:512 sc1
    buffer_store_dwordx4 v[72:75], v60, s[24:27], s45 offen offset:1024 sc1
    v_lshlrev_b32 v216, 16, v64
    v_and_b32 v217, 0xffff0000, v64
    v_lshlrev_b32 v218, 16, v65
    v_and_b32 v219, 0xffff0000, v65
    v_lshlrev_b32 v220, 16, v66
    v_and_b32 v221, 0xffff0000, v66
    v_lshlrev_b32 v222, 16, v67
    v_and_b32 v223, 0xffff0000, v67
    v_lshlrev_b32 v224, 16, v68
    v_and_b32 v225, 0xffff0000, v68
    v_lshlrev_b32 v226, 16, v69
    v_and_b32 v227, 0xffff0000, v69
    v_lshlrev_b32 v228, 16, v70
    v_and_b32 v229, 0xffff0000, v70
    v_lshlrev_b32 v230, 16, v71
    v_and_b32 v231, 0xffff0000, v71
    v_lshlrev_b32 v232, 16, v72
    v_and_b32 v233, 0xffff0000, v72
    v_lshlrev_b32 v234, 16, v73
    v_and_b32 v235, 0xffff0000, v73
    v_lshlrev_b32 v236, 16, v74
    v_and_b32 v237, 0xffff0000, v74
    v_lshlrev_b32 v238, 16, v75
    v_and_b32 v239, 0xffff0000, v75
    v_pk_mul_f32 v[50:51], v[216:217], v[168:169]
    v_pk_mul_f32 v[52:53], v[224:225], v[176:177]
    v_pk_mul_f32 v[62:63], v[232:233], v[184:185]
    v_pk_fma_f32 v[50:51], v[218:219], v[170:171], v[50:51]
    v_pk_fma_f32 v[52:53], v[226:227], v[178:179], v[52:53]
    v_pk_fma_f32 v[62:63], v[234:235], v[186:187], v[62:63]
    v_pk_fma_f32 v[50:51], v[220:221], v[172:173], v[50:51]
    v_pk_fma_f32 v[52:53], v[228:229], v[180:181], v[52:53]
    v_pk_fma_f32 v[62:63], v[236:237], v[188:189], v[62:63]
    v_pk_fma_f32 v[50:51], v[222:223], v[174:175], v[50:51]
    v_pk_fma_f32 v[52:53], v[230:231], v[182:183], v[52:53]
    v_pk_fma_f32 v[62:63], v[238:239], v[190:191], v[62:63]
    v_pk_add_f32 v[50:51], v[50:51], v[52:53]
    v_add_f32 v62, v62, v63
    v_add_f32 v50, v50, v51
    v_add_f32 v50, v50, v62
    v_lshlrev_b32 v48, 2, v7
    v_and_b32 v48, 28, v48
    v_sub_u32 v49, 2047, v7
    v_add_f32_dpp v50, v50, v50 row_ror:1 row_mask:0xf bank_mask:0xf
    s_nop 1
    v_add_f32_dpp v50, v50, v50 row_ror:2 row_mask:0xf bank_mask:0xf
    s_nop 1
    v_add_f32_dpp v50, v50, v50 row_ror:4 row_mask:0xf bank_mask:0xf
    s_nop 1
Ltour12:
    s_cbranch_execz Ltour16
    v_add_f32_dpp v50, v50, v50 row_ror:8 row_mask:0xf bank_mask:0xf
    v_mov_b32 v52, v50
    s_nop 1
    v_permlane16_swap_b32 v50, v52
    s_nop 0
    v_add_f32 v50, v50, v52
    v_ashrrev_i32 v52, 31, v50
    v_or_b32 v52, 0x80000000, v52
    v_xor_b32 v52, v52, v50
    v_and_b32 v52, 0xfffff800, v52
    v_min_u32 v52, 0xfffff000, v52
    v_or_b32 v52, v52, v49
    s_mov_b32 exec_lo, 1
    s_mov_b32 exec_hi, 1
    ds_write_b32 v48, v52 offset:36864
    s_mov_b64 exec, -1
    s_waitcnt lgkmcnt(0)
    s_barrier
    s_cmp_lg_u32 s3, 0
    s_cbranch_scc1 Ltail_notw0
    v_mov_b32 v141, 36864
    ds_read_b128 v[128:131], v141
    ds_read_b128 v[132:135], v141 offset:16
    s_lshl_b32 s45, s2, 7
    s_add_u32 s45, s45, 8912896
    s_waitcnt lgkmcnt(1)
    v_max_u32 v136, v128, v129
    v_min_u32 v137, v128, v129
    v_med3_u32 v137, v136, v137, v130
    v_max_u32 v136, v136, v130
    v_med3_u32 v137, v136, v137, v131
    v_max_u32 v136, v136, v131
    s_waitcnt lgkmcnt(0)
    v_med3_u32 v137, v136, v137, v132
    v_max_u32 v136, v136, v132
    v_med3_u32 v137, v136, v137, v133
    v_max_u32 v136, v136, v133
    v_med3_u32 v137, v136, v137, v134
    v_max_u32 v136, v136, v134
    v_med3_u32 v137, v136, v137, v135
    v_max_u32 v136, v136, v135
    buffer_store_dwordx2 v[136:137], v8, s[24:27], s45 offen sc1
Ltail_notw0:
    v_pk_mul_f32 v[192:193], v[192:193], v[216:217]
    v_pk_mul_f32 v[194:195], v[194:195], v[218:219]
    v_pk_mul_f32 v[196:197], v[196:197], v[220:221]
    v_pk_mul_f32 v[198:199], v[198:199], v[222:223]
    v_pk_mul_f32 v[200:201], v[200:201], v[224:225]
    v_pk_mul_f32 v[202:203], v[202:203], v[226:227]
    v_pk_mul_f32 v[204:205], v[204:205], v[228:229]
    v_pk_mul_f32 v[206:207], v[206:207], v[230:231]
    v_pk_mul_f32 v[208:209], v[208:209], v[232:233]
    v_pk_mul_f32 v[210:211], v[210:211], v[234:235]
    v_pk_mul_f32 v[212:213], v[212:213], v[236:237]
    v_pk_mul_f32 v[214:215], v[214:215], v[238:239]
    v_cvt_pk_bf16_f32 v144, v192, v193
    v_cvt_pk_bf16_f32 v145, v194, v195
    v_cvt_pk_bf16_f32 v146, v196, v197
    v_cvt_pk_bf16_f32 v147, v198, v199
    v_cvt_pk_bf16_f32 v148, v200, v201
    v_cvt_pk_bf16_f32 v149, v202, v203
    v_cvt_pk_bf16_f32 v150, v204, v205
    v_cvt_pk_bf16_f32 v151, v206, v207
    v_cvt_pk_bf16_f32 v152, v208, v209
    v_cvt_pk_bf16_f32 v153, v210, v211
    v_cvt_pk_bf16_f32 v154, v212, v213
    v_cvt_pk_bf16_f32 v155, v214, v215
    v_lshlrev_b32 v192, 16, v144
    v_and_b32 v193, 0xffff0000, v144
    v_lshlrev_b32 v194, 16, v145
    v_and_b32 v195, 0xffff0000, v145
    v_lshlrev_b32 v196, 16, v146
    v_and_b32 v197, 0xffff0000, v146
    v_lshlrev_b32 v198, 16, v147
    v_and_b32 v199, 0xffff0000, v147
    v_lshlrev_b32 v200, 16, v148
    v_and_b32 v201, 0xffff0000, v148
    v_lshlrev_b32 v202, 16, v149
    v_and_b32 v203, 0xffff0000, v149
    v_lshlrev_b32 v204, 16, v150
    v_and_b32 v205, 0xffff0000, v150
    v_lshlrev_b32 v206, 16, v151
    v_and_b32 v207, 0xffff0000, v151
    v_lshlrev_b32 v208, 16, v152
    v_and_b32 v209, 0xffff0000, v152
    v_lshlrev_b32 v210, 16, v153
    v_and_b32 v211, 0xffff0000, v153
    v_lshlrev_b32 v212, 16, v154
    v_and_b32 v213, 0xffff0000, v154
    v_lshlrev_b32 v214, 16, v155
    v_and_b32 v215, 0xffff0000, v155
    v_pk_add_f32 v[192:193], v[192:193], v[12:13]
    v_pk_add_f32 v[194:195], v[194:195], v[14:15]
    v_pk_add_f32 v[196:197], v[196:197], v[16:17]
    v_pk_add_f32 v[198:199], v[198:199], v[18:19]
    v_pk_add_f32 v[200:201], v[200:201], v[20:21]
    v_pk_add_f32 v[202:203], v[202:203], v[22:23]
    v_pk_add_f32 v[204:205], v[204:205], v[24:25]
    v_pk_add_f32 v[206:207], v[206:207], v[26:27]
    v_pk_add_f32 v[208:209], v[208:209], v[28:29]
    v_pk_add_f32 v[210:211], v[210:211], v[30:31]
    v_pk_add_f32 v[212:213], v[212:213], v[32:33]
    v_pk_add_f32 v[214:215], v[214:215], v[34:35]
    v_cvt_pk_bf16_f32 v144, v192, v193
    v_cvt_pk_bf16_f32 v145, v194, v195
    v_cvt_pk_bf16_f32 v146, v196, v197
    v_cvt_pk_bf16_f32 v147, v198, v199
    v_cvt_pk_bf16_f32 v148, v200, v201
    v_cvt_pk_bf16_f32 v149, v202, v203
    v_cvt_pk_bf16_f32 v150, v204, v205
    v_cvt_pk_bf16_f32 v151, v206, v207
    v_cvt_pk_bf16_f32 v152, v208, v209
    v_cvt_pk_bf16_f32 v153, v210, v211
    v_cvt_pk_bf16_f32 v154, v212, v213
    v_cvt_pk_bf16_f32 v155, v214, v215
    s_mov_b32 s38, 135168
    s_mov_b32 s39, 12288
    v_lshrrev_b32 v9, 2, v1
    v_and_b32 v10, 3, v1
    v_lshlrev_b32 v10, 3, v10
    s_and_b32 s45, s3, 1
    s_lshl_b32 s45, s45, 5
    v_lshl_add_u32 v11, v9, 6, v10
    v_add_u32 v11, s45, v11
    s_cmp_lt_u32 s3, 2
    s_cselect_b32 s44, 98304, s38
    s_cselect_b32 s45, 98304, s39
    v_add_u32 v12, s45, v11
    v_add_u32 v11, s44, v11
    ds_read_b64_tr_b16 a[0:1], v11 offset:0
    ds_read_b64_tr_b16 a[2:3], v11 offset:1024
    ds_read_b64_tr_b16 a[4:5], v11 offset:2048
    ds_read_b64_tr_b16 a[6:7], v11 offset:3072
    ds_read_b64_tr_b16 a[8:9], v11 offset:4096
    ds_read_b64_tr_b16 a[10:11], v11 offset:5120
    ds_read_b64_tr_b16 a[12:13], v11 offset:6144
    ds_read_b64_tr_b16 a[14:15], v11 offset:7168
    ds_read_b64_tr_b16 a[16:17], v11 offset:8192
    ds_read_b64_tr_b16 a[18:19], v11 offset:9216
    ds_read_b64_tr_b16 a[20:21], v11 offset:10240
    ds_read_b64_tr_b16 a[22:23], v11 offset:11264
    ds_read_b64_tr_b16 a[24:25], v11 offset:12288
    ds_read_b64_tr_b16 a[26:27], v11 offset:13312
    ds_read_b64_tr_b16 a[28:29], v11 offset:14336
    ds_read_b64_tr_b16 a[30:31], v11 offset:15360
    ds_read_b64_tr_b16 a[32:33], v11 offset:16384
    ds_read_b64_tr_b16 a[34:35], v11 offset:17408
    ds_read_b64_tr_b16 a[36:37], v11 offset:18432
    ds_read_b64_tr_b16 a[38:39], v11 offset:19456
    ds_read_b64_tr_b16 a[40:41], v11 offset:20480
    ds_read_b64_tr_b16 a[42:43], v11 offset:21504
    ds_read_b64_tr_b16 a[44:45], v11 offset:22528
    ds_read_b64_tr_b16 a[46:47], v11 offset:23552
    ds_read_b64_tr_b16 a[48:49], v11 offset:24576
    ds_read_b64_tr_b16 a[50:51], v11 offset:25600
    ds_read_b64_tr_b16 a[52:53], v11 offset:26624
    ds_read_b64_tr_b16 a[54:55], v11 offset:27648
    ds_read_b64_tr_b16 a[56:57], v12 offset:28672
    ds_read_b64_tr_b16 a[58:59], v12 offset:29696
    ds_read_b64_tr_b16 a[60:61], v12 offset:30720
    ds_read_b64_tr_b16 a[62:63], v12 offset:31744
    ds_read_b64_tr_b16 a[64:65], v12 offset:32768
    ds_read_b64_tr_b16 a[66:67], v12 offset:33792
    ds_read_b64_tr_b16 a[68:69], v12 offset:34816
    ds_read_b64_tr_b16 a[70:71], v12 offset:35840
    v_mul_u32_u24 v12, 1152, v9
    s_lshl_b32 s44, s3, 7
    s_add_u32 s44, s44, 49152
    v_add3_u32 v12, v12, v10, s44
    v_lshlrev_b32 v13, 4, v1
    v_add_u32 v13, 32768, v13
    s_lshl_b32 s44, s3, 10
    v_add_u32 v14, s44, v13
    v_bfe_u32 v15, v1, 2, 2
    v_cmp_eq_u32 s[52:53], 0, v15
    v_cmp_eq_u32 s[54:55], 1, v15
    v_cmp_eq_u32 s[56:57], 2, v15
    v_cmp_eq_u32 s[58:59], 3, v15
    s_mul_i32 s43, s42, 18
    s_add_u32 s43, s43, s41
    s_lshl_b32 s43, s43, 9
    s_mul_i32 s44, s3, 73728
    s_add_u32 s43, s43, s44
    v_lshlrev_b32 v15, 3, v1
    v_lshlrev_b32 v140, 7, v0
    s_mov_b32 s45, 8912896
    s_lshl_b32 s36, s3, 3
    v_mov_b32 v141, s36
    s_mov_b32 s48, 16384
Ltail_pollk:
    buffer_load_dwordx2 v[136:137], v140, s[24:27], s45 offen sc1
    s_sub_u32 s48, s48, 1
    s_cbranch_scc1 Ltail_gotk
    s_waitcnt vmcnt(0)
    v_max_u32 v138, v136, v137
    v_cmp_eq_u32 vcc, -1, v138
    s_cbranch_vccnz Ltail_pollk
Ltail_gotk:
    s_waitcnt vmcnt(0)
    v_mov_b32_dpp v138, v136 row_ror:1 row_mask:0xf bank_mask:0xf
    v_mov_b32_dpp v139, v137 row_ror:1 row_mask:0xf bank_mask:0xf
    v_min_u32 v142, v136, v138
    v_max_u32 v136, v136, v138
    v_max3_u32 v137, v142, v137, v139
    s_nop 0
    v_mov_b32_dpp v138, v136 row_ror:2 row_mask:0xf bank_mask:0xf
    v_mov_b32_dpp v139, v137 row_ror:2 row_mask:0xf bank_mask:0xf
    v_min_u32 v142, v136, v138
    v_max_u32 v136, v136, v138
    v_max3_u32 v137, v142, v137, v139
    s_nop 0
    v_mov_b32_dpp v138, v136 row_ror:4 row_mask:0xf bank_mask:0xf
    v_mov_b32_dpp v139, v137 row_ror:4 row_mask:0xf bank_mask:0xf
    v_min_u32 v142, v136, v138
    v_max_u32 v136, v136, v138
    v_max3_u32 v137, v142, v137, v139
    s_nop 0
    v_mov_b32_dpp v138, v136 row_ror:8 row_mask:0xf bank_mask:0xf
    v_mov_b32_dpp v139, v137 row_ror:8 row_mask:0xf bank_mask:0xf
    v_min_u32 v142, v136, v138
    v_max_u32 v136, v136, v138
    v_max3_u32 v137, v142, v137, v139
    v_mov_b32 v138, v136
    v_mov_b32 v139, v137
    s_nop 0
    v_permlane16_swap_b32 v136, v138
    v_permlane16_swap_b32 v137, v139
    v_min_u32 v142, v136, v138
    v_max_u32 v136, v136, v138
    v_max3_u32 v137, v142, v137, v139
    v_mov_b32 v138, v136
    v_mov_b32 v139, v137
    s_nop 0
    v_permlane32_swap_b32 v136, v138
    v_permlane32_swap_b32 v137, v139
    v_min_u32 v142, v136, v138
    v_max_u32 v136, v136, v138
    v_max3_u32 v137, v142, v137, v139
    ds_write_b64 v141, v[136:137] offset:36928
    v_mov_b32 v141, 36928
    s_waitcnt lgkmcnt(0)
    s_barrier
    ds_read_b128 v[128:131], v141
    ds_read_b128 v[132:135], v141 offset:16
    s_or_b32 s36, s2, s3
    s_cselect_b32 s45, -4, 24576
    s_add_u32 s36, s94, 1
    v_mov_b32 v138, s36
    buffer_store_dword v138, v8, s[24:27], s45 offen
    s_waitcnt lgkmcnt(1)
    v_max_u32 v136, v128, v129
    v_min_u32 v137, v128, v129
    v_med3_u32 v137, v136, v137, v130
    v_max_u32 v136, v136, v130
    v_med3_u32 v137, v136, v137, v131
    v_max_u32 v136, v136, v131
    s_waitcnt lgkmcnt(0)
    v_med3_u32 v137, v136, v137, v132
    v_max_u32 v136, v136, v132
    v_med3_u32 v137, v136, v137, v133
    v_max_u32 v136, v136, v133
    v_med3_u32 v137, v136, v137, v134
    v_max_u32 v136, v136, v134
    v_med3_u32 v137, v136, v137, v135
    v_max_u32 v136, v136, v135
    s_nop 0
    v_readfirstlane_b32 s92, v136
    v_readfirstlane_b32 s93, v137
    s_andn2_b32 s46, 0x7ff, s92
    s_andn2_b32 s47, 0x7ff, s93
    s_cmp_ge_u32 s41, 18
    s_cbranch_scc1 Ltail_noffn
    s_mul_i32 s44, s46, 2304
    s_mul_i32 s45, s47, 2304
    s_sub_u32 s45, s45, s44
    v_and_b32 v8, 1, v1
    v_mul_lo_u32 v8, v8, s45
    v_and_b32 v9, 48, v1
    v_add3_u32 v8, v8, v9, s44
    s_mov_b32 s45, 2621440
    s_mov_b32 s48, 16384
Ltail_pollh:
    buffer_load_dwordx4 a[120:123], v8, s[24:27], s45 offen offset:0 sc1
    buffer_load_dwordx4 a[124:127], v8, s[24:27], s45 offen offset:64 sc1
    buffer_load_dwordx4 a[128:131], v8, s[24:27], s45 offen offset:128 sc1
    buffer_load_dwordx4 a[132:135], v8, s[24:27], s45 offen offset:192 sc1
    buffer_load_dwordx4 a[136:139], v8, s[24:27], s45 offen offset:256 sc1
    buffer_load_dwordx4 a[140:143], v8, s[24:27], s45 offen offset:320 sc1
    buffer_load_dwordx4 a[144:147], v8, s[24:27], s45 offen offset:384 sc1
    buffer_load_dwordx4 a[148:151], v8, s[24:27], s45 offen offset:448 sc1
    buffer_load_dwordx4 a[152:155], v8, s[24:27], s45 offen offset:512 sc1
    buffer_load_dwordx4 a[156:159], v8, s[24:27], s45 offen offset:576 sc1
    buffer_load_dwordx4 a[160:163], v8, s[24:27], s45 offen offset:640 sc1
    buffer_load_dwordx4 a[164:167], v8, s[24:27], s45 offen offset:704 sc1
    buffer_load_dwordx4 a[168:171], v8, s[24:27], s45 offen offset:768 sc1
    buffer_load_dwordx4 a[172:175], v8, s[24:27], s45 offen offset:832 sc1
    buffer_load_dwordx4 a[176:179], v8, s[24:27], s45 offen offset:896 sc1
    buffer_load_dwordx4 a[180:183], v8, s[24:27], s45 offen offset:960 sc1
    buffer_load_dwordx4 a[184:187], v8, s[24:27], s45 offen offset:1024 sc1
    buffer_load_dwordx4 a[188:191], v8, s[24:27], s45 offen offset:1088 sc1
    ds_read_b64_tr_b16 a[72:73], v12 offset:0
    ds_read_b64_tr_b16 a[74:75], v12 offset:18432
    ds_read_b64_tr_b16 a[76:77], v12 offset:32
    ds_read_b64_tr_b16 a[78:79], v12 offset:18464
    ds_read_b64_tr_b16 a[80:81], v12 offset:64
    ds_read_b64_tr_b16 a[82:83], v12 offset:18496
    ds_read_b64_tr_b16 a[84:85], v12 offset:96
    ds_read_b64_tr_b16 a[86:87], v12 offset:18528
    ds_read_b64_tr_b16 a[88:89], v12 offset:512
    ds_read_b64_tr_b16 a[90:91], v12 offset:18944
    ds_read_b64_tr_b16 a[92:93], v12 offset:544
    ds_read_b64_tr_b16 a[94:95], v12 offset:18976
    ds_read_b64_tr_b16 a[96:97], v12 offset:576
    ds_read_b64_tr_b16 a[98:99], v12 offset:19008
    ds_read_b64_tr_b16 a[100:101], v12 offset:608
    ds_read_b64_tr_b16 a[102:103], v12 offset:19040
    ds_read_b64_tr_b16 a[104:105], v12 offset:1024
    ds_read_b64_tr_b16 a[106:107], v12 offset:19456
    ds_read_b64_tr_b16 a[108:109], v12 offset:1056
    ds_read_b64_tr_b16 a[110:111], v12 offset:19488
    ds_read_b64_tr_b16 a[112:113], v12 offset:1088
    ds_read_b64_tr_b16 a[114:115], v12 offset:19520
    ds_read_b64_tr_b16 a[116:117], v12 offset:1120
    ds_read_b64_tr_b16 a[118:119], v12 offset:19552
    s_waitcnt vmcnt(17)
    v_mfma_f32_16x16x32_bf16 v[16:19], a[0:3], a[120:123], 0
    s_waitcnt vmcnt(16)
    v_mfma_f32_16x16x32_bf16 v[20:23], a[4:7], a[124:127], 0
    s_waitcnt vmcnt(15)
    v_mfma_f32_16x16x32_bf16 v[16:19], a[8:11], a[128:131], v[16:19]
    s_waitcnt vmcnt(14)
    v_mfma_f32_16x16x32_bf16 v[20:23], a[12:15], a[132:135], v[20:23]
    s_waitcnt vmcnt(13)
    v_mfma_f32_16x16x32_bf16 v[16:19], a[16:19], a[136:139], v[16:19]
    s_waitcnt vmcnt(12)
    v_mfma_f32_16x16x32_bf16 v[20:23], a[20:23], a[140:143], v[20:23]
    s_waitcnt vmcnt(11)
    v_mfma_f32_16x16x32_bf16 v[16:19], a[24:27], a[144:147], v[16:19]
    s_waitcnt vmcnt(10)
    v_mfma_f32_16x16x32_bf16 v[20:23], a[28:31], a[148:151], v[20:23]
    s_waitcnt vmcnt(9)
    v_mfma_f32_16x16x32_bf16 v[16:19], a[32:35], a[152:155], v[16:19]
    s_waitcnt vmcnt(8)
    v_mfma_f32_16x16x32_bf16 v[20:23], a[36:39], a[156:159], v[20:23]
    s_waitcnt vmcnt(7)
    v_mfma_f32_16x16x32_bf16 v[16:19], a[40:43], a[160:163], v[16:19]
    s_waitcnt vmcnt(6)
    v_mfma_f32_16x16x32_bf16 v[20:23], a[44:47], a[164:167], v[20:23]
    s_waitcnt vmcnt(5)
    v_mfma_f32_16x16x32_bf16 v[16:19], a[48:51], a[168:171], v[16:19]
    s_waitcnt vmcnt(4)
    v_mfma_f32_16x16x32_bf16 v[20:23], a[52:55], a[172:175], v[20:23]
    s_waitcnt vmcnt(3)
    v_mfma_f32_16x16x32_bf16 v[16:19], a[56:59], a[176:179], v[16:19]
    s_waitcnt vmcnt(2)
    v_mfma_f32_16x16x32_bf16 v[20:23], a[60:63], a[180:183], v[20:23]
    s_waitcnt vmcnt(1)
    v_mfma_f32_16x16x32_bf16 v[16:19], a[64:67], a[184:187], v[16:19]
    s_waitcnt vmcnt(0)
    v_mfma_f32_16x16x32_bf16 v[20:23], a[68:71], a[188:191], v[20:23]
    s_sub_u32 s48, s48, 1
    s_nop 6
    v_pk_add_f32 v[16:17], v[16:17], v[20:21]
    v_pk_add_f32 v[18:19], v[18:19], v[22:23]
    s_cbranch_scc1 Ltail_goth
    v_cmp_u_f32 vcc, v16, v16
    s_cbranch_vccnz Ltail_pollh
Ltail_goth:
    ds_write_b128 v14, v[16:19]
    s_waitcnt lgkmcnt(0)
    s_barrier
    ds_read_b128 v[16:19], v13 offset:0
    ds_read_b128 v[20:23], v13 offset:1024
    ds_read_b128 v[24:27], v13 offset:2048
    ds_read_b128 v[28:31], v13 offset:3072
    s_mov_b32 s36, 0xbfb8aa3b
    s_mov_b32 s37, 0xbfb8aa3b
    s_waitcnt lgkmcnt(3)
    v_cvt_pk_bf16_f32 v32, v16, v17
    v_cvt_pk_bf16_f32 v33, v18, v19
    s_waitcnt lgkmcnt(2)
    v_cvt_pk_bf16_f32 v34, v20, v21
    v_cvt_pk_bf16_f32 v35, v22, v23
    v_lshlrev_b32 v16, 16, v32
    v_and_b32 v17, 0xffff0000, v32
    v_lshlrev_b32 v18, 16, v33
    v_and_b32 v19, 0xffff0000, v33
    v_lshlrev_b32 v20, 16, v34
    v_and_b32 v21, 0xffff0000, v34
    v_lshlrev_b32 v22, 16, v35
    v_and_b32 v23, 0xffff0000, v35
    v_pk_mul_f32 v[32:33], v[16:17], s[36:37]
    v_pk_mul_f32 v[34:35], v[18:19], s[36:37]
    v_pk_mul_f32 v[36:37], v[20:21], s[36:37]
    v_pk_mul_f32 v[38:39], v[22:23], s[36:37]
    v_exp_f32 v32, v32
    v_exp_f32 v33, v33
    v_exp_f32 v34, v34
    v_exp_f32 v35, v35
    v_exp_f32 v36, v36
    v_exp_f32 v37, v37
    v_exp_f32 v38, v38
    v_exp_f32 v39, v39
    s_waitcnt lgkmcnt(1)
    v_cvt_pk_bf16_f32 v60, v24, v25
    v_cvt_pk_bf16_f32 v61, v26, v27
    s_waitcnt lgkmcnt(0)
    v_cvt_pk_bf16_f32 v62, v28, v29
    v_cvt_pk_bf16_f32 v63, v30, v31
    v_pk_add_f32 v[32:33], v[32:33], 1.0 op_sel_hi:[1,0]
    v_pk_add_f32 v[34:35], v[34:35], 1.0 op_sel_hi:[1,0]
    v_pk_add_f32 v[36:37], v[36:37], 1.0 op_sel_hi:[1,0]
    v_pk_add_f32 v[38:39], v[38:39], 1.0 op_sel_hi:[1,0]
    v_rcp_f32 v32, v32
    v_rcp_f32 v33, v33
    v_rcp_f32 v34, v34
    v_rcp_f32 v35, v35
    v_rcp_f32 v36, v36
    v_rcp_f32 v37, v37
    v_rcp_f32 v38, v38
    v_rcp_f32 v39, v39
    v_lshlrev_b32 v24, 16, v60
    v_and_b32 v25, 0xffff0000, v60
    v_lshlrev_b32 v26, 16, v61
    v_and_b32 v27, 0xffff0000, v61
    v_lshlrev_b32 v28, 16, v62
    v_and_b32 v29, 0xffff0000, v62
    v_lshlrev_b32 v30, 16, v63
    v_and_b32 v31, 0xffff0000, v63
    v_pk_mul_f32 v[16:17], v[16:17], v[32:33]
    v_pk_mul_f32 v[18:19], v[18:19], v[34:35]
    v_pk_mul_f32 v[20:21], v[20:21], v[36:37]
    v_pk_mul_f32 v[22:23], v[22:23], v[38:39]
    v_cvt_pk_bf16_f32 v32, v16, v17
    v_cvt_pk_bf16_f32 v33, v18, v19
    v_cvt_pk_bf16_f32 v34, v20, v21
    v_cvt_pk_bf16_f32 v35, v22, v23
    v_lshlrev_b32 v16, 16, v32
    v_and_b32 v17, 0xffff0000, v32
    v_lshlrev_b32 v18, 16, v33
    v_and_b32 v19, 0xffff0000, v33
    v_lshlrev_b32 v20, 16, v34
    v_and_b32 v21, 0xffff0000, v34
    v_lshlrev_b32 v22, 16, v35
    v_and_b32 v23, 0xffff0000, v35
    v_pk_mul_f32 v[16:17], v[16:17], v[24:25]
    v_pk_mul_f32 v[18:19], v[18:19], v[26:27]
    v_pk_mul_f32 v[20:21], v[20:21], v[28:29]
    v_pk_mul_f32 v[22:23], v[22:23], v[30:31]
    v_cvt_pk_bf16_f32 v32, v16, v17
    v_cvt_pk_bf16_f32 v33, v18, v19
    v_cvt_pk_bf16_f32 v34, v20, v21
    v_cvt_pk_bf16_f32 v35, v22, v23
    v_cndmask_b32 v64, 0, v32, s[52:53]
    v_cndmask_b32 v65, 0, v33, s[52:53]
    v_cndmask_b32 v66, 0, v34, s[52:53]
    v_cndmask_b32 v67, 0, v35, s[52:53]
    v_cndmask_b32 v68, 0, v32, s[54:55]
    v_cndmask_b32 v69, 0, v33, s[54:55]
    v_cndmask_b32 v70, 0, v34, s[54:55]
    v_cndmask_b32 v71, 0, v35, s[54:55]
    v_cndmask_b32 v72, 0, v32, s[56:57]
    v_cndmask_b32 v73, 0, v33, s[56:57]
    v_cndmask_b32 v74, 0, v34, s[56:57]
    v_cndmask_b32 v75, 0, v35, s[56:57]
    v_cndmask_b32 v76, 0, v32, s[58:59]
    v_cndmask_b32 v77, 0, v33, s[58:59]
    v_cndmask_b32 v78, 0, v34, s[58:59]
    v_cndmask_b32 v79, 0, v35, s[58:59]
    v_mfma_f32_16x16x32_bf16 v[16:19], v[64:67], a[72:75], 0
    v_mfma_f32_16x16x32_bf16 v[16:19], v[68:71], a[76:79], v[16:19]
    v_mfma_f32_16x16x32_bf16 v[16:19], v[72:75], a[80:83], v[16:19]
    v_mfma_f32_16x16x32_bf16 v[16:19], v[76:79], a[84:87], v[16:19]
    v_mfma_f32_16x16x32_bf16 v[20:23], v[64:67], a[88:91], 0
    v_mfma_f32_16x16x32_bf16 v[20:23], v[68:71], a[92:95], v[20:23]
    v_mfma_f32_16x16x32_bf16 v[20:23], v[72:75], a[96:99], v[20:23]
    v_mfma_f32_16x16x32_bf16 v[20:23], v[76:79], a[100:103], v[20:23]
    v_mfma_f32_16x16x32_bf16 v[24:27], v[64:67], a[104:107], 0
    v_mfma_f32_16x16x32_bf16 v[24:27], v[68:71], a[108:111], v[24:27]
    v_mfma_f32_16x16x32_bf16 v[24:27], v[72:75], a[112:115], v[24:27]
    v_mfma_f32_16x16x32_bf16 v[24:27], v[76:79], a[116:119], v[24:27]
    v_min_u32 v16, -2, v16
    v_min_u32 v17, -2, v17
    buffer_store_dwordx2 v[16:17], v15, s[8:11], s43 offen sc1
    s_add_u32 s43, s43, 294912
    v_min_u32 v20, -2, v20
    v_min_u32 v21, -2, v21
    buffer_store_dwordx2 v[20:21], v15, s[8:11], s43 offen sc1
    s_add_u32 s43, s43, 294912
    v_min_u32 v24, -2, v24
    v_min_u32 v25, -2, v25
    buffer_store_dwordx2 v[24:25], v15, s[8:11], s43 offen sc1
    v_cmp_ne_u32 vcc, s46, v7
    v_cmp_ne_u32 s[36:37], s47, v7
    v_mov_b32 v31, 2147483648
    s_and_b64 vcc, vcc, s[36:37]
    s_nop 1
    v_cndmask_b32 v30, v31, v58, vcc
    v_cndmask_b32 v31, v31, v4, vcc
    buffer_store_dwordx2 v[144:145], v31, s[16:19], 0 offen offset:0
    buffer_store_dwordx2 v[146:147], v31, s[16:19], 0 offen offset:32
    buffer_store_dwordx2 v[148:149], v31, s[16:19], 0 offen offset:512
    buffer_store_dwordx2 v[150:151], v31, s[16:19], 0 offen offset:544
    buffer_store_dwordx2 v[152:153], v30, s[16:19], 0 offen offset:1024
    buffer_store_dwordx2 v[154:155], v30, s[16:19], 0 offen offset:1056
    s_branch Ltail_done
Ltail_noffn:
Ltour13:
    s_cbranch_execz Ltour17
    s_cmp_lt_u32 s41, 27
    s_cselect_b32 s36, s3, 1
    s_cmp_eq_u32 s36, 0
    s_cbranch_scc1 Ltail_final
    v_cmp_ne_u32 vcc, s46, v7
    v_cmp_ne_u32 s[36:37], s47, v7
    v_mov_b32 v31, 2147483648
    s_and_b64 vcc, vcc, s[36:37]
    s_nop 1
    v_cndmask_b32 v30, v31, v58, vcc
    v_cndmask_b32 v31, v31, v4, vcc
    buffer_store_dwordx2 v[144:145], v31, s[16:19], 0 offen offset:0
    buffer_store_dwordx2 v[146:147], v31, s[16:19], 0 offen offset:32
    buffer_store_dwordx2 v[148:149], v31, s[16:19], 0 offen offset:512
    buffer_store_dwordx2 v[150:151], v31, s[16:19], 0 offen offset:544
    buffer_store_dwordx2 v[152:153], v30, s[16:19], 0 offen offset:1024
    buffer_store_dwordx2 v[154:155], v30, s[16:19], 0 offen offset:1056
    s_branch Ltail_done
Ltail_final:
Ltour14:
    s_cbranch_execz Lmain
    s_mul_i32 s43, s42, 9
    s_add_u32 s43, s43, s41
    s_sub_u32 s43, s43, 18
    v_bfe_u32 v8, v1, 2, 1
    v_cmp_eq_u32 vcc, 1, v8
    v_mov_b32 v9, s46
    v_mov_b32 v10, s47
    v_and_b32 v11, 3, v1
    v_cndmask_b32 v9, v9, v10, vcc
    s_lshr_b32 s44, s43, 2
    s_lshl_b32 s44, s44, 6
    s_and_b32 s45, s43, 1
    s_lshl_b32 s45, s45, 5
    s_add_u32 s44, s44, s45
    s_and_b32 s45, s43, 2
    s_lshl_b32 s45, s45, 2
    s_add_u32 s44, s44, s45
    v_lshrrev_b32 v12, 1, v11
    v_lshl_add_u32 v12, v12, 4, s44
    v_and_b32 v13, 1, v11
    v_lshl_add_u32 v12, v13, 2, v12
    v_mul_u32_u24 v13, 1152, v9
    v_lshl_add_u32 v14, v13, 1, v12
    v_add_u32 v15, 2621440, v14
    s_mov_b32 s45, 22144
    buffer_load_dword v18, v12, s[24:27], s45 offen sc1
    v_mov_b32 v19, s92
    v_mov_b32 v10, s93
    v_cndmask_b32 v19, v19, v10, vcc
    v_and_b32 v19, 0xfffff800, v19
    v_or_b32 v19, 0x400, v19
    v_ashrrev_i32 v10, 31, v19
    v_not_b32 v10, v10
    v_or_b32 v10, 0x80000000, v10
    v_xor_b32 v19, v19, v10
    s_lshl_b32 s45, s43, 4
    v_lshl_add_u32 v13, v11, 2, v13
    v_add_u32 v13, s45, v13
    v_lshrrev_b32 v14, 2, v1
    v_lshlrev_b32 v14, 9, v14
    v_lshl_add_u32 v14, v11, 4, v14
    s_lshr_b32 s44, s43, 3
    s_mul_i32 s44, s44, 73728
    s_and_b32 s45, s43, 7
    s_lshl_b32 s45, s45, 6
    s_add_u32 s44, s44, s45
    v_cmp_ne_u32 vcc, s46, v7
    v_cmp_ne_u32 s[36:37], s47, v7
    v_mov_b32 v31, 2147483648
    s_and_b64 vcc, vcc, s[36:37]
    s_nop 1
    v_cndmask_b32 v30, v31, v58, vcc
    v_cndmask_b32 v31, v31, v4, vcc
    buffer_store_dwordx2 v[144:145], v31, s[16:19], 0 offen offset:0
    buffer_store_dwordx2 v[146:147], v31, s[16:19], 0 offen offset:32
    buffer_store_dwordx2 v[148:149], v31, s[16:19], 0 offen offset:512
    buffer_store_dwordx2 v[150:151], v31, s[16:19], 0 offen offset:544
    buffer_store_dwordx2 v[152:153], v30, s[16:19], 0 offen offset:1024
    buffer_store_dwordx2 v[154:155], v30, s[16:19], 0 offen offset:1056
    v_cmp_eq_u32 s[36:37], 1, v8
    v_cvt_pk_bf16_f32 v19, v19, v19
    v_and_b32 v19, 0xffff0000, v19
    v_mul_f32 v19, 0xbfb8aa3b, v19
    v_exp_f32 v19, v19
    s_waitcnt vmcnt(6)
    v_lshlrev_b32 v24, 16, v18
    v_and_b32 v25, 0xffff0000, v18
    v_add_f32 v19, 1.0, v19
    v_rcp_f32 v19, v19
    s_mov_b32 s48, 16384
    v_cvt_pk_bf16_f32 v19, v19, v19
    v_and_b32 v19, 0xffff0000, v19
Ltail_polly:
    s_add_u32 s45, s44, 0
    buffer_load_dwordx4 v[64:67], v14, s[8:11], s45 offen sc1
    s_add_u32 s45, s44, 8192
    buffer_load_dwordx4 v[68:71], v14, s[8:11], s45 offen sc1
    s_add_u32 s45, s44, 16384
    buffer_load_dwordx4 v[72:75], v14, s[8:11], s45 offen sc1
    s_add_u32 s45, s44, 24576
    buffer_load_dwordx4 v[76:79], v14, s[8:11], s45 offen sc1
    s_add_u32 s45, s44, 32768
    buffer_load_dwordx4 v[80:83], v14, s[8:11], s45 offen sc1
    s_add_u32 s45, s44, 40960
    buffer_load_dwordx4 v[84:87], v14, s[8:11], s45 offen sc1
    s_add_u32 s45, s44, 49152
    buffer_load_dwordx4 v[88:91], v14, s[8:11], s45 offen sc1
    s_add_u32 s45, s44, 57344
    buffer_load_dwordx4 v[92:95], v14, s[8:11], s45 offen sc1
    s_add_u32 s45, s44, 65536
    buffer_load_dwordx4 v[96:99], v14, s[8:11], s45 offen sc1
    s_mov_b32 s45, 1152
    buffer_load_dword v16, v15, s[24:27], s45 offen sc1
    buffer_load_dword v17, v15, s[24:27], 0 offen sc1
    s_sub_u32 s48, s48, 1
    s_cbranch_scc1 Ltail_goty
    s_waitcnt vmcnt(10)
    v_max3_u32 v26, v64, v65, v66
    s_waitcnt vmcnt(9)
    v_max3_u32 v26, v26, v67, v68
    v_max3_u32 v26, v26, v69, v70
    s_waitcnt vmcnt(8)
    v_max3_u32 v26, v26, v71, v72
    v_max3_u32 v26, v26, v73, v74
    s_waitcnt vmcnt(7)
    v_max3_u32 v26, v26, v75, v76
    v_max3_u32 v26, v26, v77, v78
    s_waitcnt vmcnt(6)
    v_max3_u32 v26, v26, v79, v80
    v_max3_u32 v26, v26, v81, v82
    s_waitcnt vmcnt(5)
    v_max3_u32 v26, v26, v83, v84
    v_max3_u32 v26, v26, v85, v86
    s_waitcnt vmcnt(4)
    v_max3_u32 v26, v26, v87, v88
Ltour15:
    s_cbranch_execz Lmain
    v_max3_u32 v26, v26, v89, v90
    s_waitcnt vmcnt(3)
    v_max3_u32 v26, v26, v91, v92
    v_max3_u32 v26, v26, v93, v94
    s_waitcnt vmcnt(2)
    v_max3_u32 v26, v26, v95, v96
    v_max3_u32 v26, v26, v97, v98
    v_max_u32 v26, v26, v99
    s_waitcnt vmcnt(0)
    v_max3_u32 v26, v26, v16, v17
    v_cmp_eq_u32 vcc, -1, v26
    s_cbranch_vccnz Ltail_polly
Ltail_goty:
    s_waitcnt vmcnt(0) lgkmcnt(0)
    v_lshlrev_b32 v20, 16, v16
    v_and_b32 v21, 0xffff0000, v16
    v_lshlrev_b32 v22, 16, v17
    v_and_b32 v23, 0xffff0000, v17
    v_pk_add_f32 v[64:65], v[64:65], v[68:69]
    v_pk_add_f32 v[66:67], v[66:67], v[70:71]
    v_pk_add_f32 v[64:65], v[64:65], v[72:73]
    v_pk_add_f32 v[66:67], v[66:67], v[74:75]
    v_pk_add_f32 v[64:65], v[64:65], v[76:77]
    v_pk_add_f32 v[66:67], v[66:67], v[78:79]
    v_pk_add_f32 v[64:65], v[64:65], v[80:81]
    v_pk_add_f32 v[66:67], v[66:67], v[82:83]
    v_pk_add_f32 v[64:65], v[64:65], v[84:85]
    v_pk_add_f32 v[66:67], v[66:67], v[86:87]
    v_pk_add_f32 v[64:65], v[64:65], v[88:89]
    v_pk_add_f32 v[66:67], v[66:67], v[90:91]
    v_pk_add_f32 v[64:65], v[64:65], v[92:93]
    v_pk_add_f32 v[66:67], v[66:67], v[94:95]
    v_pk_add_f32 v[64:65], v[64:65], v[96:97]
    v_pk_add_f32 v[66:67], v[66:67], v[98:99]
    s_nop 0
    v_add_f32_dpp v64, v64, v64 row_ror:4 row_mask:0xf bank_mask:0xf
    v_add_f32_dpp v65, v65, v65 row_ror:4 row_mask:0xf bank_mask:0xf
    v_add_f32_dpp v66, v66, v66 row_ror:4 row_mask:0xf bank_mask:0xf
    v_add_f32_dpp v67, v67, v67 row_ror:4 row_mask:0xf bank_mask:0xf
    v_add_f32_dpp v64, v64, v64 row_ror:8 row_mask:0xf bank_mask:0xf
    v_add_f32_dpp v65, v65, v65 row_ror:8 row_mask:0xf bank_mask:0xf
    v_add_f32_dpp v66, v66, v66 row_ror:8 row_mask:0xf bank_mask:0xf
    v_add_f32_dpp v67, v67, v67 row_ror:8 row_mask:0xf bank_mask:0xf
    v_mov_b32 v68, v64
    v_mov_b32 v69, v65
    v_mov_b32 v70, v66
    v_mov_b32 v71, v67
    v_permlane16_swap_b32 v64, v68
    v_permlane16_swap_b32 v65, v69
    v_permlane16_swap_b32 v66, v70
    v_permlane16_swap_b32 v67, v71
    v_add_f32 v64, v64, v68
    v_add_f32 v65, v65, v69
    v_add_f32 v66, v66, v70
    v_add_f32 v67, v67, v71
    v_mov_b32 v68, v64
    v_mov_b32 v69, v65
    v_mov_b32 v70, v66
    v_mov_b32 v71, v67
    v_permlane32_swap_b32 v64, v68
    v_permlane32_swap_b32 v65, v69
    v_permlane32_swap_b32 v66, v70
    v_permlane32_swap_b32 v67, v71
    v_add_f32 v64, v64, v68
    v_add_f32 v65, v65, v69
    v_add_f32 v66, v66, v70
    v_add_f32 v67, v67, v71
    v_cndmask_b32 v26, v64, v65, s[36:37]
    v_cndmask_b32 v27, v66, v67, s[36:37]
    v_cvt_pk_bf16_f32 v28, v26, v27
    v_lshlrev_b32 v26, 16, v28
    v_and_b32 v27, 0xffff0000, v28
    v_mul_f32 v26, v26, v19
    v_mul_f32 v27, v27, v19
    v_cvt_pk_bf16_f32 v28, v26, v27
    v_lshlrev_b32 v26, 16, v28
    v_and_b32 v27, 0xffff0000, v28
    v_pk_add_f32 v[26:27], v[26:27], v[22:23]
    v_cvt_pk_bf16_f32 v28, v26, v27
    v_lshlrev_b32 v26, 16, v28
    v_and_b32 v27, 0xffff0000, v28
    v_pk_mul_f32 v[26:27], v[26:27], v[24:25]
    v_cvt_pk_bf16_f32 v28, v26, v27
    v_lshlrev_b32 v26, 16, v28
    v_and_b32 v27, 0xffff0000, v28
    v_pk_add_f32 v[26:27], v[26:27], v[20:21]
    v_cvt_pk_bf16_f32 v28, v26, v27
    s_mov_b64 exec, 0xff
    buffer_store_dword v28, v13, s[16:19], 0 offen
Ltail_done:
    s_endpgm
Lattn_wb:
    buffer_wbl2 sc1
    s_waitcnt vmcnt(0)
    s_branch Lattn_wbdone
Lattn_xspin:
    s_mov_b32 s37, 16384
Lattn_xloop:
    buffer_load_dword v11, v8, s[24:27], s54 offen offset:8 sc1
    s_waitcnt vmcnt(0)
    v_readfirstlane_b32 s36, v11
    s_sub_u32 s37, s37, 1
    s_cbranch_scc1 Lattn_xgot
    s_cmp_lg_u32 s36, s95
    s_cbranch_scc1 Lattn_xloop
    s_branch Lattn_xgot
Ltail_spin1:
Ltour16:
    s_cbranch_execz Lmain
    s_mov_b32 s48, 16384
Ltail_spinl1:
    buffer_load_dword v11, v9, s[24:27], s39 offen sc1
    s_waitcnt vmcnt(0)
    v_cmp_ne_u32 s[54:55], s95, v11
    s_sub_u32 s48, s48, 1
    s_cbranch_scc1 Ltail_got1
    s_cmp_lg_u64 s[54:55], 0
    s_cbranch_scc1 Ltail_spinl1
    s_branch Ltail_got1
Ltail_spin2:
Ltour17:
    s_cbranch_execz Lmain
    s_mov_b32 s48, 16384
Ltail_spinl2:
    buffer_load_dword v11, v9, s[24:27], s39 offen sc1
    s_waitcnt vmcnt(0)
    v_cmp_ne_u32 s[54:55], s95, v11
    s_sub_u32 s48, s48, 1
    s_cbranch_scc1 Ltail_got2
    s_cmp_lg_u64 s[54:55], 0
    s_cbranch_scc1 Ltail_spinl2
    s_branch Ltail_got2
Lattn_redo:
    v_xor_b32 v8, 64, v9
    v_xor_b32 v10, 64, v11
    s_waitcnt vmcnt(0) lgkmcnt(0)
    s_barrier
    v_mov_b32 v232, 0xff800000
    v_mov_b32 v233, 0xff800000
    v_mov_b32 v234, 0xff800000
    v_mov_b32 v235, 0xff800000
    s_mov_b32 s40, 0
    s_mov_b32 s48, -1
Lattn_redo_loop:
    s_add_u32 m0, s42, 0
    s_nop 0
    buffer_load_dwordx4 v36, s[8:11], s40 offen lds
    buffer_load_dwordx4 v37, s[8:11], s40 offen offset:1024 lds
    buffer_load_dwordx4 v38, s[8:11], s40 offen offset:2048 lds
    buffer_load_dwordx4 v39, s[8:11], s40 offen offset:3072 lds
    s_add_u32 s40, s40, 16384
    s_waitcnt vmcnt(0) lgkmcnt(0)
    s_barrier
    ds_read_b128 a[208:211], v8 offset:0
    ds_read_b128 a[212:215], v9 offset:0
    ds_read_b128 a[216:219], v10 offset:0
    ds_read_b128 a[220:223], v11 offset:0
    s_waitcnt lgkmcnt(3)
    v_mfma_f32_16x16x32_bf16 v[216:219], a[208:211], v[64:67], 0
    s_waitcnt lgkmcnt(2)
    v_mfma_f32_16x16x32_bf16 v[216:219], a[212:215], v[68:71], v[216:219]
    s_waitcnt lgkmcnt(1)
    v_mfma_f32_16x16x32_bf16 v[216:219], a[216:219], v[72:75], v[216:219]
    s_waitcnt lgkmcnt(0)
    v_mfma_f32_16x16x32_bf16 v[216:219], a[220:223], v[76:79], v[216:219]
    v_mfma_f32_16x16x32_bf16 v[220:223], a[208:211], v[80:83], 0
    v_mfma_f32_16x16x32_bf16 v[220:223], a[212:215], v[84:87], v[220:223]
    v_mfma_f32_16x16x32_bf16 v[220:223], a[216:219], v[88:91], v[220:223]
    v_mfma_f32_16x16x32_bf16 v[220:223], a[220:223], v[92:95], v[220:223]
    v_mfma_f32_16x16x32_bf16 v[224:227], a[208:211], v[96:99], 0
    v_mfma_f32_16x16x32_bf16 v[224:227], a[212:215], v[100:103], v[224:227]
    v_mfma_f32_16x16x32_bf16 v[224:227], a[216:219], v[104:107], v[224:227]
    v_mfma_f32_16x16x32_bf16 v[224:227], a[220:223], v[108:111], v[224:227]
    v_mfma_f32_16x16x32_bf16 v[228:231], a[208:211], v[112:115], 0
    v_mfma_f32_16x16x32_bf16 v[228:231], a[212:215], v[116:119], v[228:231]
    v_mfma_f32_16x16x32_bf16 v[228:231], a[216:219], v[120:123], v[228:231]
    v_mfma_f32_16x16x32_bf16 v[228:231], a[220:223], v[124:127], v[228:231]
    v_max3_f32 v232, v232, v216, v217
    v_max3_f32 v232, v232, v218, v219
    v_max3_f32 v233, v233, v220, v221
    v_max3_f32 v233, v233, v222, v223
    v_max3_f32 v234, v234, v224, v225
    v_max3_f32 v234, v234, v226, v227
    s_nop 1
    v_max3_f32 v235, v235, v228, v229
    v_max3_f32 v235, v235, v230, v231
    ds_read_b128 a[224:227], v8 offset:4096
    ds_read_b128 a[228:231], v9 offset:4096
    ds_read_b128 a[232:235], v10 offset:4096
    ds_read_b128 a[236:239], v11 offset:4096
    s_waitcnt lgkmcnt(3)
    v_mfma_f32_16x16x32_bf16 v[216:219], a[224:227], v[64:67], 0
    s_waitcnt lgkmcnt(2)
    v_mfma_f32_16x16x32_bf16 v[216:219], a[228:231], v[68:71], v[216:219]
    s_waitcnt lgkmcnt(1)
    v_mfma_f32_16x16x32_bf16 v[216:219], a[232:235], v[72:75], v[216:219]
    s_waitcnt lgkmcnt(0)
    v_mfma_f32_16x16x32_bf16 v[216:219], a[236:239], v[76:79], v[216:219]
    v_mfma_f32_16x16x32_bf16 v[220:223], a[224:227], v[80:83], 0
    v_mfma_f32_16x16x32_bf16 v[220:223], a[228:231], v[84:87], v[220:223]
    v_mfma_f32_16x16x32_bf16 v[220:223], a[232:235], v[88:91], v[220:223]
    v_mfma_f32_16x16x32_bf16 v[220:223], a[236:239], v[92:95], v[220:223]
    v_mfma_f32_16x16x32_bf16 v[224:227], a[224:227], v[96:99], 0
    v_mfma_f32_16x16x32_bf16 v[224:227], a[228:231], v[100:103], v[224:227]
    v_mfma_f32_16x16x32_bf16 v[224:227], a[232:235], v[104:107], v[224:227]
    v_mfma_f32_16x16x32_bf16 v[224:227], a[236:239], v[108:111], v[224:227]
    v_mfma_f32_16x16x32_bf16 v[228:231], a[224:227], v[112:115], 0
    v_mfma_f32_16x16x32_bf16 v[228:231], a[228:231], v[116:119], v[228:231]
    v_mfma_f32_16x16x32_bf16 v[228:231], a[232:235], v[120:123], v[228:231]
    v_mfma_f32_16x16x32_bf16 v[228:231], a[236:239], v[124:127], v[228:231]
    v_max3_f32 v232, v232, v216, v217
    v_max3_f32 v232, v232, v218, v219
    v_max3_f32 v233, v233, v220, v221
    v_max3_f32 v233, v233, v222, v223
    v_max3_f32 v234, v234, v224, v225
    v_max3_f32 v234, v234, v226, v227
    s_nop 1
    v_max3_f32 v235, v235, v228, v229
    v_max3_f32 v235, v235, v230, v231
    ds_read_b128 a[208:211], v8 offset:8192
    ds_read_b128 a[212:215], v9 offset:8192
    ds_read_b128 a[216:219], v10 offset:8192
    ds_read_b128 a[220:223], v11 offset:8192
    s_waitcnt lgkmcnt(3)
    v_mfma_f32_16x16x32_bf16 v[216:219], a[208:211], v[64:67], 0
    s_waitcnt lgkmcnt(2)
    v_mfma_f32_16x16x32_bf16 v[216:219], a[212:215], v[68:71], v[216:219]
    s_waitcnt lgkmcnt(1)
    v_mfma_f32_16x16x32_bf16 v[216:219], a[216:219], v[72:75], v[216:219]
    s_waitcnt lgkmcnt(0)
    v_mfma_f32_16x16x32_bf16 v[216:219], a[220:223], v[76:79], v[216:219]
    v_mfma_f32_16x16x32_bf16 v[220:223], a[208:211], v[80:83], 0
    v_mfma_f32_16x16x32_bf16 v[220:223], a[212:215], v[84:87], v[220:223]
    v_mfma_f32_16x16x32_bf16 v[220:223], a[216:219], v[88:91], v[220:223]
    v_mfma_f32_16x16x32_bf16 v[220:223], a[220:223], v[92:95], v[220:223]
    v_mfma_f32_16x16x32_bf16 v[224:227], a[208:211], v[96:99], 0
    v_mfma_f32_16x16x32_bf16 v[224:227], a[212:215], v[100:103], v[224:227]
    v_mfma_f32_16x16x32_bf16 v[224:227], a[216:219], v[104:107], v[224:227]
    v_mfma_f32_16x16x32_bf16 v[224:227], a[220:223], v[108:111], v[224:227]
    v_mfma_f32_16x16x32_bf16 v[228:231], a[208:211], v[112:115], 0
    v_mfma_f32_16x16x32_bf16 v[228:231], a[212:215], v[116:119], v[228:231]
    v_mfma_f32_16x16x32_bf16 v[228:231], a[216:219], v[120:123], v[228:231]
    v_mfma_f32_16x16x32_bf16 v[228:231], a[220:223], v[124:127], v[228:231]
    v_max3_f32 v232, v232, v216, v217
    v_max3_f32 v232, v232, v218, v219
    v_max3_f32 v233, v233, v220, v221
    v_max3_f32 v233, v233, v222, v223
    v_max3_f32 v234, v234, v224, v225
    v_max3_f32 v234, v234, v226, v227
    s_nop 1
    v_max3_f32 v235, v235, v228, v229
    v_max3_f32 v235, v235, v230, v231
    ds_read_b128 a[224:227], v8 offset:12288
    ds_read_b128 a[228:231], v9 offset:12288
    ds_read_b128 a[232:235], v10 offset:12288
    ds_read_b128 a[236:239], v11 offset:12288
    s_waitcnt lgkmcnt(3)
    v_mfma_f32_16x16x32_bf16 v[216:219], a[224:227], v[64:67], 0
    s_waitcnt lgkmcnt(2)
    v_mfma_f32_16x16x32_bf16 v[216:219], a[228:231], v[68:71], v[216:219]
    s_waitcnt lgkmcnt(1)
    v_mfma_f32_16x16x32_bf16 v[216:219], a[232:235], v[72:75], v[216:219]
    s_waitcnt lgkmcnt(0)
    v_mfma_f32_16x16x32_bf16 v[216:219], a[236:239], v[76:79], v[216:219]
    v_mfma_f32_16x16x32_bf16 v[220:223], a[224:227], v[80:83], 0
    v_mfma_f32_16x16x32_bf16 v[220:223], a[228:231], v[84:87], v[220:223]
    v_mfma_f32_16x16x32_bf16 v[220:223], a[232:235], v[88:91], v[220:223]
    v_mfma_f32_16x16x32_bf16 v[220:223], a[236:239], v[92:95], v[220:223]
    v_mfma_f32_16x16x32_bf16 v[224:227], a[224:227], v[96:99], 0
    v_mfma_f32_16x16x32_bf16 v[224:227], a[228:231], v[100:103], v[224:227]
    v_mfma_f32_16x16x32_bf16 v[224:227], a[232:235], v[104:107], v[224:227]
    v_mfma_f32_16x16x32_bf16 v[224:227], a[236:239], v[108:111], v[224:227]
    v_mfma_f32_16x16x32_bf16 v[228:231], a[224:227], v[112:115], 0
    v_mfma_f32_16x16x32_bf16 v[228:231], a[228:231], v[116:119], v[228:231]
    v_mfma_f32_16x16x32_bf16 v[228:231], a[232:235], v[120:123], v[228:231]
    v_mfma_f32_16x16x32_bf16 v[228:231], a[236:239], v[124:127], v[228:231]
    v_max3_f32 v232, v232, v216, v217
    v_max3_f32 v232, v232, v218, v219
    v_max3_f32 v233, v233, v220, v221
    v_max3_f32 v233, v233, v222, v223
    v_max3_f32 v234, v234, v224, v225
    v_max3_f32 v234, v234, v226, v227
    s_nop 1
    v_max3_f32 v235, v235, v228, v229
    v_max3_f32 v235, v235, v230, v231
    s_barrier
    s_cmp_lt_u32 s40, 524288
    s_cbranch_scc1 Lattn_redo_loop
    v_mov_b32 v236, v232
    v_mov_b32 v237, v233
    v_mov_b32 v238, v234
    v_mov_b32 v239, v235
    v_permlane16_swap_b32 v232, v236
    v_permlane16_swap_b32 v233, v237
    v_permlane16_swap_b32 v234, v238
    v_permlane16_swap_b32 v235, v239
    v_max_f32 v232, v232, v236
    v_max_f32 v233, v233, v237
    v_max_f32 v234, v234, v238
    v_max_f32 v235, v235, v239
    v_mov_b32 v236, v232
    v_mov_b32 v237, v233
    v_mov_b32 v238, v234
    v_mov_b32 v239, v235
    v_permlane32_swap_b32 v232, v236
    v_permlane32_swap_b32 v233, v237
    v_permlane32_swap_b32 v234, v238
    v_permlane32_swap_b32 v235, v239
    v_max_f32 v232, v232, v236
    v_max_f32 v233, v233, v237
    v_max_f32 v234, v234, v238
    v_max_f32 v235, v235, v239
    v_sub_f32 v192, 0, v232
    v_sub_f32 v193, 0, v232
    v_sub_f32 v194, 0, v232
    v_sub_f32 v195, 0, v232
    v_sub_f32 v196, 0, v233
    v_sub_f32 v197, 0, v233
    v_sub_f32 v198, 0, v233
    v_sub_f32 v199, 0, v233
    v_sub_f32 v200, 0, v234
    v_sub_f32 v201, 0, v234
    v_sub_f32 v202, 0, v234
    v_sub_f32 v203, 0, v234
    v_sub_f32 v204, 0, v235
    v_sub_f32 v205, 0, v235
    v_sub_f32 v206, 0, v235
    v_sub_f32 v207, 0, v235
    s_mov_b32 s40, 0
    s_mov_b32 s41, 0
    s_add_u32 m0, s42, 0
    s_nop 0
    buffer_load_dwordx4 v36, s[8:11], s40 offen lds
    buffer_load_dwordx4 v37, s[8:11], s40 offen offset:1024 lds
    buffer_load_dwordx4 v38, s[8:11], s40 offen offset:2048 lds
    buffer_load_dwordx4 v39, s[8:11], s40 offen offset:3072 lds
    s_add_u32 s40, s40, 16384
    s_add_u32 m0, s42, 16384
    s_nop 0
    buffer_load_dwordx4 v36, s[8:11], s40 offen lds
    buffer_load_dwordx4 v37, s[8:11], s40 offen offset:1024 lds
    buffer_load_dwordx4 v38, s[8:11], s40 offen offset:2048 lds
    buffer_load_dwordx4 v39, s[8:11], s40 offen offset:3072 lds
    s_add_u32 s40, s40, 16384
    s_add_u32 m0, s42, 32768
    s_nop 0
    buffer_load_dwordx4 v36, s[8:11], s40 offen lds
    buffer_load_dwordx4 v37, s[8:11], s40 offen offset:1024 lds
    buffer_load_dwordx4 v38, s[8:11], s40 offen offset:2048 lds
    buffer_load_dwordx4 v39, s[8:11], s40 offen offset:3072 lds
    s_add_u32 s40, s40, 16384
    s_add_u32 m0, s42, 65536
    s_nop 0
    buffer_load_dwordx4 v40, s[12:15], s41 offen lds
    buffer_load_dwordx4 v41, s[12:15], s41 offen offset:1024 lds
    buffer_load_dwordx4 v40, s[12:15], s41 offen offset:2048 lds
    buffer_load_dwordx4 v41, s[12:15], s41 offen offset:3072 lds
    s_add_u32 s41, s41, 16384
    s_add_u32 m0, s42, 81920
    s_nop 0
    buffer_load_dwordx4 v40, s[12:15], s41 offen lds
    buffer_load_dwordx4 v41, s[12:15], s41 offen offset:1024 lds
    buffer_load_dwordx4 v40, s[12:15], s41 offen offset:2048 lds
    buffer_load_dwordx4 v41, s[12:15], s41 offen offset:3072 lds
    s_add_u32 s41, s41, 16384
    v_accvgpr_write_b32 a0, 0
    v_accvgpr_write_b32 a1, 0
    v_accvgpr_write_b32 a2, 0
    v_accvgpr_write_b32 a3, 0
    v_accvgpr_write_b32 a4, 0
    v_accvgpr_write_b32 a5, 0
    v_accvgpr_write_b32 a6, 0
    v_accvgpr_write_b32 a7, 0
    v_accvgpr_write_b32 a8, 0
    v_accvgpr_write_b32 a9, 0
    v_accvgpr_write_b32 a10, 0
    v_accvgpr_write_b32 a11, 0
    v_accvgpr_write_b32 a12, 0
    v_accvgpr_write_b32 a13, 0
    v_accvgpr_write_b32 a14, 0
    v_accvgpr_write_b32 a15, 0
    v_accvgpr_write_b32 a16, 0
    v_accvgpr_write_b32 a17, 0
    v_accvgpr_write_b32 a18, 0
    v_accvgpr_write_b32 a19, 0
    v_accvgpr_write_b32 a20, 0
    v_accvgpr_write_b32 a21, 0
    v_accvgpr_write_b32 a22, 0
    v_accvgpr_write_b32 a23, 0
    v_accvgpr_write_b32 a24, 0
    v_accvgpr_write_b32 a25, 0
    v_accvgpr_write_b32 a26, 0
    v_accvgpr_write_b32 a27, 0
    v_accvgpr_write_b32 a28, 0
    v_accvgpr_write_b32 a29, 0
    v_accvgpr_write_b32 a30, 0
    v_accvgpr_write_b32 a31, 0
    v_accvgpr_write_b32 a32, 0
    v_accvgpr_write_b32 a33, 0
    v_accvgpr_write_b32 a34, 0
    v_accvgpr_write_b32 a35, 0
    v_accvgpr_write_b32 a36, 0
    v_accvgpr_write_b32 a37, 0
    v_accvgpr_write_b32 a38, 0
    v_accvgpr_write_b32 a39, 0
    v_accvgpr_write_b32 a40, 0
    v_accvgpr_write_b32 a41, 0
    v_accvgpr_write_b32 a42, 0
    v_accvgpr_write_b32 a43, 0
    v_accvgpr_write_b32 a44, 0
    v_accvgpr_write_b32 a45, 0
    v_accvgpr_write_b32 a46, 0
    v_accvgpr_write_b32 a47, 0
    v_accvgpr_write_b32 a48, 0
    v_accvgpr_write_b32 a49, 0
    v_accvgpr_write_b32 a50, 0
    v_accvgpr_write_b32 a51, 0
    v_accvgpr_write_b32 a52, 0
    v_accvgpr_write_b32 a53, 0
    v_accvgpr_write_b32 a54, 0
    v_accvgpr_write_b32 a55, 0
    v_accvgpr_write_b32 a56, 0
    v_accvgpr_write_b32 a57, 0
    v_accvgpr_write_b32 a58, 0
    v_accvgpr_write_b32 a59, 0
    v_accvgpr_write_b32 a60, 0
    v_accvgpr_write_b32 a61, 0
    v_accvgpr_write_b32 a62, 0
    v_accvgpr_write_b32 a63, 0
    v_accvgpr_write_b32 a64, 0
    v_accvgpr_write_b32 a65, 0
    v_accvgpr_write_b32 a66, 0
    v_accvgpr_write_b32 a67, 0
    v_accvgpr_write_b32 a68, 0
    v_accvgpr_write_b32 a69, 0
    v_accvgpr_write_b32 a70, 0
    v_accvgpr_write_b32 a71, 0
    v_accvgpr_write_b32 a72, 0
    v_accvgpr_write_b32 a73, 0
    v_accvgpr_write_b32 a74, 0
    v_accvgpr_write_b32 a75, 0
    v_accvgpr_write_b32 a76, 0
    v_accvgpr_write_b32 a77, 0
    v_accvgpr_write_b32 a78, 0
    v_accvgpr_write_b32 a79, 0
    v_accvgpr_write_b32 a80, 0
    v_accvgpr_write_b32 a81, 0
    v_accvgpr_write_b32 a82, 0
    v_accvgpr_write_b32 a83, 0
    v_accvgpr_write_b32 a84, 0
    v_accvgpr_write_b32 a85, 0
    v_accvgpr_write_b32 a86, 0
    v_accvgpr_write_b32 a87, 0
    v_accvgpr_write_b32 a88, 0
    v_accvgpr_write_b32 a89, 0
    v_accvgpr_write_b32 a90, 0
    v_accvgpr_write_b32 a91, 0
    v_accvgpr_write_b32 a92, 0
    v_accvgpr_write_b32 a93, 0
    v_accvgpr_write_b32 a94, 0
    v_accvgpr_write_b32 a95, 0
    v_accvgpr_write_b32 a96, 0
    v_accvgpr_write_b32 a97, 0
    v_accvgpr_write_b32 a98, 0
    v_accvgpr_write_b32 a99, 0
    v_accvgpr_write_b32 a100, 0
    v_accvgpr_write_b32 a101, 0
    v_accvgpr_write_b32 a102, 0
    v_accvgpr_write_b32 a103, 0
    v_accvgpr_write_b32 a104, 0
    v_accvgpr_write_b32 a105, 0
    v_accvgpr_write_b32 a106, 0
    v_accvgpr_write_b32 a107, 0
    v_accvgpr_write_b32 a108, 0
    v_accvgpr_write_b32 a109, 0
    v_accvgpr_write_b32 a110, 0
    v_accvgpr_write_b32 a111, 0
    v_accvgpr_write_b32 a112, 0
    v_accvgpr_write_b32 a113, 0
    v_accvgpr_write_b32 a114, 0
    v_accvgpr_write_b32 a115, 0
    v_accvgpr_write_b32 a116, 0
    v_accvgpr_write_b32 a117, 0
    v_accvgpr_write_b32 a118, 0
    v_accvgpr_write_b32 a119, 0
    v_accvgpr_write_b32 a120, 0
    v_accvgpr_write_b32 a121, 0
    v_accvgpr_write_b32 a122, 0
    v_accvgpr_write_b32 a123, 0
    v_accvgpr_write_b32 a124, 0
    v_accvgpr_write_b32 a125, 0
    v_accvgpr_write_b32 a126, 0
    v_accvgpr_write_b32 a127, 0
    v_accvgpr_write_b32 a192, 0
    v_accvgpr_write_b32 a193, 0
    v_accvgpr_write_b32 a194, 0
    v_accvgpr_write_b32 a195, 0
    v_accvgpr_write_b32 a196, 0
    v_accvgpr_write_b32 a197, 0
    v_accvgpr_write_b32 a198, 0
    v_accvgpr_write_b32 a199, 0
    v_accvgpr_write_b32 a200, 0
    v_accvgpr_write_b32 a201, 0
    v_accvgpr_write_b32 a202, 0
    v_accvgpr_write_b32 a203, 0
    v_accvgpr_write_b32 a204, 0
    v_accvgpr_write_b32 a205, 0
    v_accvgpr_write_b32 a206, 0
    v_accvgpr_write_b32 a207, 0
    s_waitcnt vmcnt(0) lgkmcnt(0)
    s_barrier
    ds_read_b128 a[208:211], v8 offset:0
    ds_read_b128 a[212:215], v9 offset:0
    ds_read_b128 a[216:219], v10 offset:0
    ds_read_b128 a[220:223], v11 offset:0
    ds_read_b128 a[224:227], v8 offset:4096
    s_waitcnt vmcnt(0) lgkmcnt(0)
    s_branch Lattn_stage0
Lattn_armwait:
    s_mov_b32 s36, 16384
Lattn_armloop:
    v_mov_b32 v63, 0
    buffer_load_dword v63, v63, s[88:91], 0 offen sc1
    s_waitcnt vmcnt(0)
    v_readfirstlane_b32 s37, v63
    s_sub_u32 s36, s36, 1
    s_cbranch_scc1 Lattn_armed
    s_cmp_lt_u32 s37, 256
    s_cbranch_scc1 Lattn_armloop
    s_branch Lattn_armed
Lattn_end:
    s_endpgm
.section .rodata,"a"
.p2align 6
.amdhsa_kernel adaLN_cond__gqa_block_cached__moe_arch_mod__prompt_kernel
  .amdhsa_next_free_vgpr 512
  .amdhsa_next_free_sgpr 102
  .amdhsa_accum_offset 256
  .amdhsa_group_segment_fixed_size 0
  .amdhsa_kernarg_size 120
  .amdhsa_user_sgpr_count 2
  .amdhsa_user_sgpr_kernarg_segment_ptr 1
  .amdhsa_system_sgpr_workgroup_id_x 1
  .amdhsa_float_denorm_mode_32 3
.end_amdhsa_kernel
```

```asm
; @launch grid=(256,1,1) block=(256,1,1) lds=163840
.amdgcn_target "amdgcn-amd-amdhsa--gfx950"
.text
.globl adaLN_cond__gqa_block_cached__moe_arch_mod__prompt_kernel
.p2align 8
.type adaLN_cond__gqa_block_cached__moe_arch_mod__prompt_kernel,@function
adaLN_cond__gqa_block_cached__moe_arch_mod__prompt_kernel:
    s_cmp_ge_u32 s2, 256
    s_cbranch_scc1 Lattn_end
    s_load_dwordx2 s[8:9], s[0:1], 80
    s_load_dwordx2 s[12:13], s[0:1], 88
    s_load_dwordx2 s[20:21], s[0:1], 0
    s_load_dwordx2 s[50:51], s[0:1], 112
    s_load_dwordx8 s[52:59], s[0:1], 8
    s_load_dwordx4 s[80:83], s[0:1], 56
    s_load_dwordx2 s[84:85], s[0:1], 72
    s_load_dwordx2 s[88:89], s[0:1], 104
    s_getpc_b64 s[32:33]
Lattn_pc:
    s_mov_b32 s34, Lattn_end-Lattn_pc
    s_mov_b32 s35, 0x20000
    s_lshr_b32 s6, s2, 3
    s_lshl_b32 s7, s6, 6
    v_lshrrev_b32 v3, 6, v0
    v_and_b32 v1, 63, v0
    v_lshrrev_b32 v2, 2, v0
    v_lshlrev_b32 v2, 11, v2
    v_readfirstlane_b32 s3, v3
    buffer_load_dword v240, v2, s[32:35], s7 offen
    s_and_b32 s7, s2, 7
    s_lshl_b32 s4, s7, 1
    s_and_b32 s5, s6, 1
    s_add_u32 s4, s4, s5
    s_lshr_b32 s5, s2, 4
    s_lshr_b32 s38, s6, 2
    s_lshl_b32 s38, s38, 3
    s_add_u32 s38, s38, s7
    s_cmp_lt_u32 s38, 18
    s_cselect_b32 s39, 0, 2147483648
    s_lshl_b32 s38, s38, 2
    s_and_b32 s36, s6, 3
    s_add_u32 s38, s38, s36
    s_mov_b32 s14, 3981312
    s_mul_i32 s92, s6, 124416
    s_lshl_b32 s36, s7, 7
    s_add_u32 s92, s92, s36
    s_cmp_lt_u32 s7, 2
    s_cselect_b32 s36, 53, 35
    v_lshrrev_b32 v2, 2, v0
    v_min_u32 v2, s36, v2
    v_mul_u32_u24 v3, 57, v2
    v_lshrrev_b32 v3, 10, v3
    v_mul_i32_i24 v3, -123392, v3
    v_mul_u32_u24 v2, 6912, v2
    v_add_u32 v72, v2, v3
    s_mov_b32 s15, 0x20000
    s_mov_b32 s10, 1152
    s_mov_b32 s11, 0x20000
    s_mov_b32 s22, 2359296
    s_mov_b32 s23, 0x20000
    v_and_b32 v64, 0xfe, v0
    v_mul_u32_u24 v65, 3456, v64
    v_and_b32 v2, 1, v0
    v_lshl_add_u32 v65, v2, 4, v65
    s_lshl_b32 s36, s38, 5
    s_or_b32 s36, s36, s39
    v_and_b32 v4, 31, v1
    v_lshrrev_b32 v5, 5, v1
    v_cmp_gt_u32 vcc, 24, v4
    v_mov_b32 v6, 2147483648
    s_lshl_b32 s7, s5, 4
    s_add_u32 s7, s7, s4
    s_lshl_b32 s7, s7, 2
    s_add_u32 s7, s7, s3
    v_cndmask_b32 v6, v6, 0, vcc
    s_mul_i32 s49, s7, 2304
    v_lshrrev_b32 v7, 2, v4
    v_lshl_add_u32 v7, v7, 6, v6
    v_and_b32 v2, 3, v4
    v_lshl_add_u32 v7, v2, 3, v7
    v_mul_u32_u24 v2, 1152, v5
    v_add_u32 v66, v7, v2
    s_waitcnt lgkmcnt(0)
    s_load_dword s94, s[50:51], 24576
    buffer_load_dword v241, v72, s[12:15], s92 offen
    buffer_load_ushort v80, v64, s[8:11], 0 offen offset:0
    buffer_load_ushort v81, v64, s[8:11], 0 offen offset:256
    buffer_load_ushort v82, v64, s[8:11], 0 offen offset:512
    buffer_load_ushort v83, v64, s[8:11], 0 offen offset:768
    buffer_load_ushort v84, v64, s[8:11], 0 offen offset:1024
    buffer_load_dwordx4 v[88:91], v65, s[12:15], s36 offen
    s_add_u32 s36, s36, 884736
    buffer_load_dwordx4 v[92:95], v65, s[12:15], s36 offen
    s_add_u32 s36, s36, 884736
    buffer_load_dwordx4 v[96:99], v65, s[12:15], s36 offen
    s_add_u32 s36, s36, 884736
    buffer_load_dwordx4 v[100:103], v65, s[12:15], s36 offen
    s_add_u32 s36, s36, 884736
    buffer_load_dwordx4 v[104:107], v65, s[12:15], s36 offen
    s_mov_b32 s16, s56
    s_mov_b32 s17, s57
    s_mov_b32 s18, 4718592
    s_mov_b32 s19, 0x20000
    s_lshl_b32 s44, s4, 9
    s_mul_i32 s36, s5, 98304
    s_add_u32 s36, s36, 0
    v_lshrrev_b32 v2, 2, v0
    v_min_u32 v2, 47, v2
    v_lshrrev_b32 v3, 2, v2
    v_and_b32 v2, 3, v2
    v_lshl_add_u32 v2, v2, 7, s36
    v_lshl_add_u32 v71, v3, 13, v2
    s_mul_i32 s36, s5, 196608
    s_add_u32 s36, s36, 1572864
    v_lshrrev_b32 v2, 1, v0
    v_min_u32 v2, 95, v2
    v_lshrrev_b32 v3, 2, v2
    v_and_b32 v2, 3, v2
    v_lshl_add_u32 v2, v2, 7, s36
    v_lshl_add_u32 v70, v3, 13, v2
    s_add_u32 s92, s49, 65536
    v_lshl_add_u32 v7, v5, 4, v6
    v_lshl_add_u32 v67, v4, 5, v7
    v_min_u32 v4, 23, v4
    v_lshlrev_b32 v68, 4, v4
    s_mov_b32 s24, s50
    s_mov_b32 s25, s51
    s_mov_b32 s26, 10485760
    s_mov_b32 s27, 0x20000
    s_mov_b32 s90, 256
    s_mov_b32 s91, 0x20000
    s_cmp_ge_u32 s38, 36
    s_cselect_b32 s93, 1.0, 0
    s_lshl_b32 s36, s38, 7
    v_lshl_add_u32 v69, v0, 3, s36
    v_cmp_gt_u32 s[36:37], 8, v0
    v_mov_b32 v2, 2147483648
    v_mov_b32 v3, s39
    v_cndmask_b32 v2, v2, v3, s[36:37]
    v_or_b32 v69, v69, v2
    s_mul_i32 s36, s5, 3072
    s_lshl_b32 s37, s5, 11
    v_lshrrev_b32 v120, 3, v0
    v_min_u32 v120, 23, v120
    v_lshl_add_u32 v120, v120, 7, s36
    v_lshrrev_b32 v121, 4, v0
    v_lshl_add_u32 v121, v121, 7, s37
    s_lshl_b32 s42, s3, 12
    v_lshrrev_b32 v2, 4, v1
    v_and_b32 v3, 15, v1
    v_lshrrev_b32 v5, 1, v3
    v_mul_u32_u24 v5, 2304, v5
    v_lshl_add_u32 v5, v2, 5, v5
    v_and_b32 v6, 1, v3
    v_lshl_add_u32 v51, v6, 4, v5
    s_lshl_b32 s6, s5, 2
    s_add_u32 s6, s6, s3
    s_mul_i32 s46, s6, 36864
    s_add_u32 s46, s46, 65536
    s_add_u32 s43, s46, 18432
    s_mul_i32 s45, s4, 294912
    s_lshl_b32 s7, s3, 4
    v_add_u32 v4, s7, v2
    v_lshlrev_b32 v5, 1, v2
    v_xor_b32 v5, v5, v3
    v_xor_b32 v6, 8, v5
    v_lshlrev_b32 v7, 13, v4
    v_lshl_add_u32 v42, v5, 4, v7
    v_lshl_add_u32 v43, v6, 4, v7
    v_add_u32 v44, 63488, v42
    v_add_u32 v45, 95232, v43
    v_add_u32 v43, 31744, v43
    s_lshl_b32 s7, s4, 19
    s_add_u32 s8, s52, s7
    s_addc_u32 s9, s53, 0
    s_mov_b32 s10, 524288
    s_mov_b32 s11, 0x20000
    s_add_u32 s12, s54, s7
    s_addc_u32 s13, s55, 0
    s_mov_b32 s14, 524288
    s_mov_b32 s15, 0x20000
    s_add_u32 s28, s50, 10485760
    s_addc_u32 s29, s51, 0
    s_mov_b32 s30, 37748736
    s_mov_b32 s31, 0x20000
    v_lshlrev_b32 v7, 8, v4
    v_lshl_add_u32 v40, v5, 4, v7
    v_lshl_add_u32 v41, v6, 4, v7
    v_xor_b32 v224, v3, v2
    v_lshl_add_u32 v36, v224, 4, v7
    v_xor_b32 v37, 64, v36
    v_xor_b32 v38, 128, v36
    v_xor_b32 v39, 192, v36
    v_lshrrev_b32 v7, 3, v5
    v_lshl_add_u32 v7, v7, 7, v4
    v_mul_u32_u24 v7, 1152, v7
    v_and_b32 v225, 7, v5
    v_lshl_add_u32 v46, v225, 4, v7
    v_lshrrev_b32 v7, 3, v6
    v_lshl_add_u32 v7, v7, 7, v4
    v_mul_u32_u24 v7, 1152, v7
    v_and_b32 v225, 7, v6
    v_lshl_add_u32 v47, v225, 4, v7
    v_add_u32 v48, 7168, v46
    v_add_u32 v49, 10752, v47
    v_add_u32 v47, 3584, v47
    v_lshlrev_b32 v7, 8, v3
    v_lshl_add_u32 v8, v224, 4, v7
    v_xor_b32 v9, 64, v8
    v_xor_b32 v10, 128, v8
    v_xor_b32 v11, 192, v8
    v_lshrrev_b32 v5, 2, v1
    v_and_b32 v6, 7, v5
    v_lshlrev_b32 v6, 5, v6
    v_lshl_add_u32 v6, v5, 8, v6
    v_and_b32 v7, 3, v1
    v_lshl_add_u32 v12, v7, 3, v6
    v_xor_b32 v13, 32, v12
    v_xor_b32 v14, 64, v12
    v_xor_b32 v15, 96, v12
    v_xor_b32 v16, 128, v12
    v_xor_b32 v17, 160, v12
    v_xor_b32 v18, 192, v12
    v_xor_b32 v19, 224, v12
    v_add_u32 v20, 65536, v12
    v_add_u32 v21, 65536, v13
    v_add_u32 v22, 65536, v14
    v_add_u32 v23, 65536, v15
    v_add_u32 v24, 65536, v16
    v_add_u32 v25, 65536, v17
    v_add_u32 v26, 65536, v18
    v_add_u32 v27, 65536, v19
    v_add_u32 v28, 131072, v12
    v_add_u32 v29, 131072, v13
    v_add_u32 v30, 131072, v14
    v_add_u32 v31, 131072, v15
    v_add_u32 v32, 131072, v16
    v_add_u32 v33, 131072, v17
    v_add_u32 v34, 131072, v18
    v_add_u32 v35, 131072, v19
    v_mov_b32 v52, 0x3f803f80
    v_mov_b32 v53, 0x3f803f80
    v_mov_b32 v54, 0x3f803f80
    v_mov_b32 v55, 0x3f803f80
    v_and_b32 v5, 1, v1
    v_mul_u32_u24 v5, 0xaaaa, v5
    v_add_u32 v5, 0x4444, v5
    v_lshl_add_u32 v50, v5, 16, v5
    v_lshrrev_b32 v5, 1, v3
    v_mul_u32_u24 v5, 20480, v5
    v_lshl_add_u32 v5, v2, 5, v5
    v_and_b32 v6, 1, v3
    v_lshl_add_u32 v56, v6, 4, v5
    s_mul_i32 s47, s6, 327680
    s_mov_b32 s32, s82
    s_mov_b32 s33, s83
    s_mov_b32 s34, 5308416
    s_mov_b32 s35, 0x20000
    s_mov_b32 s82, 5308416
    s_mov_b32 s83, 0x20000
    s_mov_b32 s86, 5308416
    s_mov_b32 s87, 0x20000
    s_lshr_b32 s7, s2, 3
    s_mul_i32 s7, s7, 18
    s_add_u32 s7, s7, s3
    s_and_b32 s36, s2, 7
    s_mul_i32 s37, s36, 576
    s_add_u32 s37, s37, s7
    s_mul_i32 s37, s37, 1152
    s_mul_i32 s7, s7, 9216
    s_mul_i32 s36, s36, 1152
    s_add_u32 s7, s7, s36
    v_min_u32 v5, 17, v1
    v_lshl_add_u32 v57, v5, 6, s7
    v_lshl_add_u32 v62, v5, 6, s37
    s_mov_b32 s40, 0
    s_mov_b32 s41, 0
    s_mov_b32 s48, 0
    s_waitcnt vmcnt(9)
    v_lshlrev_b32 v80, 16, v80
    s_waitcnt vmcnt(8)
    v_lshlrev_b32 v81, 16, v81
    s_waitcnt vmcnt(7)
    v_lshlrev_b32 v82, 16, v82
    s_waitcnt vmcnt(6)
    v_lshlrev_b32 v83, 16, v83
    s_waitcnt vmcnt(5)
    v_lshlrev_b32 v84, 16, v84
    v_mul_f32 v144, 0xbfb8aa3b, v80
    v_mul_f32 v148, 0xbfb8aa3b, v81
    v_mul_f32 v152, 0xbfb8aa3b, v82
    v_mul_f32 v156, 0xbfb8aa3b, v83
    v_mul_f32 v160, 0xbfb8aa3b, v84
    v_min_f32 v144, 0x42fc0000, v144
    v_min_f32 v148, 0x42fc0000, v148
    v_min_f32 v152, 0x42fc0000, v152
    v_min_f32 v156, 0x42fc0000, v156
    v_min_f32 v160, 0x42fc0000, v160
    v_exp_f32 v144, v144
    v_exp_f32 v148, v148
    v_exp_f32 v152, v152
    v_exp_f32 v156, v156
    v_exp_f32 v160, v160
    v_add_f32 v144, 1.0, v144
    v_add_f32 v148, 1.0, v148
    v_add_f32 v152, 1.0, v152
    v_add_f32 v156, 1.0, v156
    v_add_f32 v160, 1.0, v160
    v_rcp_f32 v145, v144
    v_rcp_f32 v149, v148
    v_rcp_f32 v153, v152
    v_rcp_f32 v157, v156
    v_rcp_f32 v161, v160
    v_mul_f32 v146, v80, v145
    v_mul_f32 v150, v81, v149
    v_mul_f32 v154, v82, v153
    v_mul_f32 v158, v83, v157
    v_mul_f32 v162, v84, v161
    v_fma_f32 v144, -v146, v144, v80
    v_fma_f32 v148, -v150, v148, v81
    v_fma_f32 v152, -v154, v152, v82
    v_fma_f32 v156, -v158, v156, v83
    v_fma_f32 v160, -v162, v160, v84
    v_fma_f32 v80, v144, v145, v146
    v_fma_f32 v81, v148, v149, v150
    v_fma_f32 v82, v152, v153, v154
    v_fma_f32 v83, v156, v157, v158
    v_fma_f32 v84, v160, v161, v162
    v_cvt_pk_bf16_f32 v80, v80, v80
    v_cvt_pk_bf16_f32 v81, v81, v81
    v_cvt_pk_bf16_f32 v82, v82, v82
    v_cvt_pk_bf16_f32 v83, v83, v83
    v_cvt_pk_bf16_f32 v84, v84, v84
    v_and_b32 v80, 0xffff0000, v80
    v_and_b32 v81, 0xffff0000, v81
    v_and_b32 v82, 0xffff0000, v82
    v_and_b32 v83, 0xffff0000, v83
    v_and_b32 v84, 0xffff0000, v84
    buffer_load_dwordx2 v[108:109], v66, s[20:23], s49 offen offset:0
    buffer_load_dwordx2 v[110:111], v66, s[20:23], s49 offen offset:32
    buffer_load_dwordx2 v[112:113], v66, s[20:23], s49 offen offset:384
    buffer_load_dwordx2 v[114:115], v66, s[20:23], s49 offen offset:416
    buffer_load_dwordx2 v[116:117], v66, s[20:23], s49 offen offset:768
    buffer_load_dwordx2 v[118:119], v66, s[20:23], s49 offen offset:800
    s_mov_b32 s20, s58
    s_mov_b32 s21, s59
    s_mov_b32 s22, 4718592
    s_mov_b32 s23, 0x20000
    buffer_load_dword v242, v71, s[16:19], s44 offen
    s_waitcnt vmcnt(11)
    v_lshlrev_b32 v136, 16, v88
    v_and_b32 v137, 0xffff0000, v88
    v_lshlrev_b32 v138, 16, v89
    v_and_b32 v139, 0xffff0000, v89
    v_lshlrev_b32 v140, 16, v90
    v_and_b32 v141, 0xffff0000, v90
    v_lshlrev_b32 v142, 16, v91
    v_and_b32 v143, 0xffff0000, v91
    v_pk_mul_f32 v[128:129], v[136:137], v[80:81] op_sel:[0,0] op_sel_hi:[1,0]
    v_pk_mul_f32 v[130:131], v[138:139], v[80:81] op_sel:[0,0] op_sel_hi:[1,0]
    v_pk_mul_f32 v[132:133], v[140:141], v[80:81] op_sel:[0,0] op_sel_hi:[1,0]
    v_pk_mul_f32 v[134:135], v[142:143], v[80:81] op_sel:[0,0] op_sel_hi:[1,0]
    s_waitcnt vmcnt(10)
    v_lshlrev_b32 v136, 16, v92
    v_and_b32 v137, 0xffff0000, v92
    v_lshlrev_b32 v138, 16, v93
    v_and_b32 v139, 0xffff0000, v93
    v_lshlrev_b32 v140, 16, v94
    v_and_b32 v141, 0xffff0000, v94
    v_lshlrev_b32 v142, 16, v95
    v_and_b32 v143, 0xffff0000, v95
    v_pk_fma_f32 v[128:129], v[136:137], v[80:81], v[128:129] op_sel:[0,1,0] op_sel_hi:[1,1,1]
    v_pk_fma_f32 v[130:131], v[138:139], v[80:81], v[130:131] op_sel:[0,1,0] op_sel_hi:[1,1,1]
    v_pk_fma_f32 v[132:133], v[140:141], v[80:81], v[132:133] op_sel:[0,1,0] op_sel_hi:[1,1,1]
    v_pk_fma_f32 v[134:135], v[142:143], v[80:81], v[134:135] op_sel:[0,1,0] op_sel_hi:[1,1,1]
    s_waitcnt vmcnt(9)
    v_lshlrev_b32 v136, 16, v96
    v_and_b32 v137, 0xffff0000, v96
    v_lshlrev_b32 v138, 16, v97
    v_and_b32 v139, 0xffff0000, v97
    v_lshlrev_b32 v140, 16, v98
    v_and_b32 v141, 0xffff0000, v98
    v_lshlrev_b32 v142, 16, v99
    v_and_b32 v143, 0xffff0000, v99
    v_pk_fma_f32 v[128:129], v[136:137], v[82:83], v[128:129] op_sel:[0,0,0] op_sel_hi:[1,0,1]
    v_pk_fma_f32 v[130:131], v[138:139], v[82:83], v[130:131] op_sel:[0,0,0] op_sel_hi:[1,0,1]
    v_pk_fma_f32 v[132:133], v[140:141], v[82:83], v[132:133] op_sel:[0,0,0] op_sel_hi:[1,0,1]
    v_pk_fma_f32 v[134:135], v[142:143], v[82:83], v[134:135] op_sel:[0,0,0] op_sel_hi:[1,0,1]
    s_waitcnt vmcnt(8)
    v_lshlrev_b32 v136, 16, v100
    v_and_b32 v137, 0xffff0000, v100
    v_lshlrev_b32 v138, 16, v101
    v_and_b32 v139, 0xffff0000, v101
    v_lshlrev_b32 v140, 16, v102
    v_and_b32 v141, 0xffff0000, v102
    v_lshlrev_b32 v142, 16, v103
    v_and_b32 v143, 0xffff0000, v103
    v_pk_fma_f32 v[128:129], v[136:137], v[82:83], v[128:129] op_sel:[0,1,0] op_sel_hi:[1,1,1]
    v_pk_fma_f32 v[130:131], v[138:139], v[82:83], v[130:131] op_sel:[0,1,0] op_sel_hi:[1,1,1]
    v_pk_fma_f32 v[132:133], v[140:141], v[82:83], v[132:133] op_sel:[0,1,0] op_sel_hi:[1,1,1]
    v_pk_fma_f32 v[134:135], v[142:143], v[82:83], v[134:135] op_sel:[0,1,0] op_sel_hi:[1,1,1]
    s_waitcnt vmcnt(7)
    v_lshlrev_b32 v136, 16, v104
    v_and_b32 v137, 0xffff0000, v104
    v_lshlrev_b32 v138, 16, v105
    v_and_b32 v139, 0xffff0000, v105
    v_lshlrev_b32 v140, 16, v106
    v_and_b32 v141, 0xffff0000, v106
    v_lshlrev_b32 v142, 16, v107
    v_and_b32 v143, 0xffff0000, v107
    v_pk_fma_f32 v[128:129], v[136:137], v[84:85], v[128:129] op_sel:[0,0,0] op_sel_hi:[1,0,1]
    v_pk_fma_f32 v[130:131], v[138:139], v[84:85], v[130:131] op_sel:[0,0,0] op_sel_hi:[1,0,1]
    v_pk_fma_f32 v[132:133], v[140:141], v[84:85], v[132:133] op_sel:[0,0,0] op_sel_hi:[1,0,1]
    v_pk_fma_f32 v[134:135], v[142:143], v[84:85], v[134:135] op_sel:[0,0,0] op_sel_hi:[1,0,1]
    s_nop 0
    v_permlane32_swap_b32 v128, v132
    v_permlane32_swap_b32 v129, v133
    v_permlane32_swap_b32 v130, v134
    v_permlane32_swap_b32 v131, v135
    v_and_b32 v72, 1, v1
    v_pk_add_f32 v[128:129], v[128:129], v[132:133]
    v_pk_add_f32 v[130:131], v[130:131], v[134:135]
    v_lshlrev_b32 v72, 5, v72
    v_lshrrev_b32 v73, 4, v1
    v_permlane16_swap_b32 v128, v130
    v_permlane16_swap_b32 v129, v131
    v_lshl_add_u32 v72, v73, 3, v72
    v_pk_add_f32 v[128:129], v[128:129], v[130:131]
    s_lshl_b32 s36, s3, 6
    v_add_u32 v72, s36, v72
    v_add_f32_dpp v128, v128, v128 row_ror:2 row_mask:0xf bank_mask:0xf
    v_add_f32_dpp v129, v129, v129 row_ror:2 row_mask:0xf bank_mask:0xf
    s_nop 0
    v_add_f32_dpp v128, v128, v128 row_ror:4 row_mask:0xf bank_mask:0xf
    v_add_f32_dpp v129, v129, v129 row_ror:4 row_mask:0xf bank_mask:0xf
    s_nop 0
    v_add_f32_dpp v128, v128, v128 row_ror:8 row_mask:0xf bank_mask:0xf
    v_add_f32_dpp v129, v129, v129 row_ror:8 row_mask:0xf bank_mask:0xf
    ds_write_b64 v72, v[128:129] offset:0
    v_and_b32 v73, 7, v1
    v_lshlrev_b32 v73, 3, v73
    s_waitcnt lgkmcnt(0)
    s_barrier
    ds_read_b64 v[128:129], v73 offset:0
    ds_read_b64 v[130:131], v73 offset:64
    ds_read_b64 v[132:133], v73 offset:128
    ds_read_b64 v[134:135], v73 offset:192
    s_add_u32 s95, s94, 0x9e3779b9
    v_mov_b32 v137, s95
    s_mov_b32 s37, 32768
    s_waitcnt lgkmcnt(2)
    v_pk_add_f32 v[128:129], v[128:129], v[130:131]
    s_waitcnt lgkmcnt(0)
    v_pk_add_f32 v[132:133], v[132:133], v[134:135]
    v_pk_add_f32 v[128:129], v[128:129], v[132:133]
    v_cvt_pk_bf16_f32 v136, v128, v129
    v_lshlrev_b32 v128, 16, v136
    v_and_b32 v129, 0xffff0000, v136
    v_add_f32 v128, s93, v128
    v_add_f32 v129, s93, v129
    v_cvt_pk_bf16_f32 v136, v128, v129
    buffer_store_dwordx2 v[136:137], v69, s[24:27], s37 offen sc1
    s_waitcnt vmcnt(7)
    v_lshlrev_b32 v144, 16, v108
    v_and_b32 v145, 0xffff0000, v108
    v_lshlrev_b32 v146, 16, v109
    v_and_b32 v147, 0xffff0000, v109
    s_waitcnt vmcnt(6)
    v_lshlrev_b32 v148, 16, v110
    v_and_b32 v149, 0xffff0000, v110
    v_lshlrev_b32 v150, 16, v111
    v_and_b32 v151, 0xffff0000, v111
    s_waitcnt vmcnt(5)
    v_lshlrev_b32 v152, 16, v112
    v_and_b32 v153, 0xffff0000, v112
    v_lshlrev_b32 v154, 16, v113
    v_and_b32 v155, 0xffff0000, v113
    s_waitcnt vmcnt(4)
    v_lshlrev_b32 v156, 16, v114
    v_and_b32 v157, 0xffff0000, v114
    v_lshlrev_b32 v158, 16, v115
    v_and_b32 v159, 0xffff0000, v115
    s_waitcnt vmcnt(3)
    v_lshlrev_b32 v160, 16, v116
    v_and_b32 v161, 0xffff0000, v116
    v_lshlrev_b32 v162, 16, v117
    v_and_b32 v163, 0xffff0000, v117
    s_waitcnt vmcnt(2)
    v_lshlrev_b32 v164, 16, v118
    v_and_b32 v165, 0xffff0000, v118
    v_lshlrev_b32 v166, 16, v119
    v_and_b32 v167, 0xffff0000, v119
    v_pk_add_f32 v[72:73], v[144:145], v[148:149]
    v_pk_add_f32 v[76:77], v[146:147], v[150:151]
    v_pk_add_f32 v[72:73], v[72:73], v[152:153]
    v_pk_add_f32 v[76:77], v[76:77], v[154:155]
    v_pk_add_f32 v[72:73], v[72:73], v[156:157]
    v_pk_add_f32 v[76:77], v[76:77], v[158:159]
    v_pk_add_f32 v[72:73], v[72:73], v[160:161]
    v_pk_add_f32 v[76:77], v[76:77], v[162:163]
    v_pk_add_f32 v[72:73], v[72:73], v[164:165]
    v_pk_add_f32 v[76:77], v[76:77], v[166:167]
    v_pk_add_f32 v[72:73], v[72:73], v[76:77]
    v_add_f32 v72, v72, v73
    s_nop 1
    v_add_f32_dpp v72, v72, v72 row_ror:1 row_mask:0xf bank_mask:0xf
    s_nop 1
    v_add_f32_dpp v72, v72, v72 row_ror:2 row_mask:0xf bank_mask:0xf
    s_nop 1
    v_add_f32_dpp v72, v72, v72 row_ror:4 row_mask:0xf bank_mask:0xf
    s_nop 1
    v_add_f32_dpp v72, v72, v72 row_ror:8 row_mask:0xf bank_mask:0xf
    v_mov_b32 v76, v72
    s_nop 1
    v_permlane16_swap_b32 v72, v76
    s_nop 0
    v_add_f32 v72, v72, v76
    v_mul_f32 v72, 0x3ae38e39, v72
    v_pk_add_f32 v[168:169], v[144:145], v[72:73] op_sel_hi:[1,0] neg_lo:[0,1] neg_hi:[0,1]
    v_pk_add_f32 v[170:171], v[146:147], v[72:73] op_sel_hi:[1,0] neg_lo:[0,1] neg_hi:[0,1]
    v_pk_add_f32 v[172:173], v[148:149], v[72:73] op_sel_hi:[1,0] neg_lo:[0,1] neg_hi:[0,1]
    v_pk_add_f32 v[174:175], v[150:151], v[72:73] op_sel_hi:[1,0] neg_lo:[0,1] neg_hi:[0,1]
    v_pk_add_f32 v[176:177], v[152:153], v[72:73] op_sel_hi:[1,0] neg_lo:[0,1] neg_hi:[0,1]
    v_pk_add_f32 v[178:179], v[154:155], v[72:73] op_sel_hi:[1,0] neg_lo:[0,1] neg_hi:[0,1]
    v_pk_add_f32 v[180:181], v[156:157], v[72:73] op_sel_hi:[1,0] neg_lo:[0,1] neg_hi:[0,1]
    v_pk_add_f32 v[182:183], v[158:159], v[72:73] op_sel_hi:[1,0] neg_lo:[0,1] neg_hi:[0,1]
    v_pk_add_f32 v[184:185], v[160:161], v[72:73] op_sel_hi:[1,0] neg_lo:[0,1] neg_hi:[0,1]
    v_pk_add_f32 v[186:187], v[162:163], v[72:73] op_sel_hi:[1,0] neg_lo:[0,1] neg_hi:[0,1]
    v_pk_add_f32 v[188:189], v[164:165], v[72:73] op_sel_hi:[1,0] neg_lo:[0,1] neg_hi:[0,1]
    v_pk_add_f32 v[190:191], v[166:167], v[72:73] op_sel_hi:[1,0] neg_lo:[0,1] neg_hi:[0,1]
    v_pk_mul_f32 v[74:75], v[168:169], v[168:169]
    v_pk_mul_f32 v[76:77], v[170:171], v[170:171]
    v_pk_fma_f32 v[74:75], v[172:173], v[172:173], v[74:75]
    v_pk_fma_f32 v[76:77], v[174:175], v[174:175], v[76:77]
    v_pk_fma_f32 v[74:75], v[176:177], v[176:177], v[74:75]
    v_pk_fma_f32 v[76:77], v[178:179], v[178:179], v[76:77]
    v_pk_fma_f32 v[74:75], v[180:181], v[180:181], v[74:75]
    v_pk_fma_f32 v[76:77], v[182:183], v[182:183], v[76:77]
    v_pk_fma_f32 v[74:75], v[184:185], v[184:185], v[74:75]
    v_pk_fma_f32 v[76:77], v[186:187], v[186:187], v[76:77]
    v_pk_fma_f32 v[74:75], v[188:189], v[188:189], v[74:75]
    v_pk_fma_f32 v[76:77], v[190:191], v[190:191], v[76:77]
    v_pk_add_f32 v[74:75], v[74:75], v[76:77]
    v_add_f32 v74, v74, v75
    v_cndmask_b32 v74, 0, v74, vcc
    s_nop 1
    v_add_f32_dpp v74, v74, v74 row_ror:1 row_mask:0xf bank_mask:0xf
    s_nop 1
    v_add_f32_dpp v74, v74, v74 row_ror:2 row_mask:0xf bank_mask:0xf
    s_nop 1
    v_add_f32_dpp v74, v74, v74 row_ror:4 row_mask:0xf bank_mask:0xf
    s_nop 1
    v_add_f32_dpp v74, v74, v74 row_ror:8 row_mask:0xf bank_mask:0xf
    v_mov_b32 v76, v74
    s_nop 1
    v_permlane16_swap_b32 v74, v76
    s_nop 0
    v_add_f32 v74, v74, v76
    v_mul_f32 v74, 0x3ae38e39, v74
    v_cvt_pk_bf16_f32 v76, v72, v74
    v_and_b32 v74, 0xffff0000, v76
    v_lshlrev_b32 v72, 16, v76
    v_add_f32 v74, 0x3727c5ac, v74
    v_cvt_pk_bf16_f32 v74, v74, v74
    v_and_b32 v74, 0xffff0000, v74
    v_sqrt_f32 v74, v74
    v_pk_add_f32 v[168:169], v[144:145], v[72:73] op_sel_hi:[1,0] neg_lo:[0,1] neg_hi:[0,1]
    v_pk_add_f32 v[170:171], v[146:147], v[72:73] op_sel_hi:[1,0] neg_lo:[0,1] neg_hi:[0,1]
    v_pk_add_f32 v[172:173], v[148:149], v[72:73] op_sel_hi:[1,0] neg_lo:[0,1] neg_hi:[0,1]
    v_pk_add_f32 v[174:175], v[150:151], v[72:73] op_sel_hi:[1,0] neg_lo:[0,1] neg_hi:[0,1]
    v_pk_add_f32 v[176:177], v[152:153], v[72:73] op_sel_hi:[1,0] neg_lo:[0,1] neg_hi:[0,1]
    v_pk_add_f32 v[178:179], v[154:155], v[72:73] op_sel_hi:[1,0] neg_lo:[0,1] neg_hi:[0,1]
    v_pk_add_f32 v[180:181], v[156:157], v[72:73] op_sel_hi:[1,0] neg_lo:[0,1] neg_hi:[0,1]
    v_pk_add_f32 v[182:183], v[158:159], v[72:73] op_sel_hi:[1,0] neg_lo:[0,1] neg_hi:[0,1]
    v_pk_add_f32 v[184:185], v[160:161], v[72:73] op_sel_hi:[1,0] neg_lo:[0,1] neg_hi:[0,1]
    v_pk_add_f32 v[186:187], v[162:163], v[72:73] op_sel_hi:[1,0] neg_lo:[0,1] neg_hi:[0,1]
    v_pk_add_f32 v[188:189], v[164:165], v[72:73] op_sel_hi:[1,0] neg_lo:[0,1] neg_hi:[0,1]
    v_pk_add_f32 v[190:191], v[166:167], v[72:73] op_sel_hi:[1,0] neg_lo:[0,1] neg_hi:[0,1]
    v_cvt_pk_bf16_f32 v74, v74, v74
    v_and_b32 v74, 0xffff0000, v74
    v_rcp_f32 v74, v74
    v_cvt_pk_bf16_f32 v108, v168, v169
    v_cvt_pk_bf16_f32 v109, v170, v171
    v_cvt_pk_bf16_f32 v110, v172, v173
    v_cvt_pk_bf16_f32 v111, v174, v175
    v_cvt_pk_bf16_f32 v112, v176, v177
    v_cvt_pk_bf16_f32 v113, v178, v179
    v_cvt_pk_bf16_f32 v114, v180, v181
    v_cvt_pk_bf16_f32 v115, v182, v183
    v_cvt_pk_bf16_f32 v116, v184, v185
    v_cvt_pk_bf16_f32 v117, v186, v187
    v_cvt_pk_bf16_f32 v118, v188, v189
    v_cvt_pk_bf16_f32 v119, v190, v191
    v_lshlrev_b32 v168, 16, v108
    v_and_b32 v169, 0xffff0000, v108
    v_lshlrev_b32 v170, 16, v109
    v_and_b32 v171, 0xffff0000, v109
    v_lshlrev_b32 v172, 16, v110
    v_and_b32 v173, 0xffff0000, v110
    v_lshlrev_b32 v174, 16, v111
    v_and_b32 v175, 0xffff0000, v111
    v_lshlrev_b32 v176, 16, v112
    v_and_b32 v177, 0xffff0000, v112
    v_lshlrev_b32 v178, 16, v113
    v_and_b32 v179, 0xffff0000, v113
    v_lshlrev_b32 v180, 16, v114
    v_and_b32 v181, 0xffff0000, v114
    v_lshlrev_b32 v182, 16, v115
    v_and_b32 v183, 0xffff0000, v115
    v_lshlrev_b32 v184, 16, v116
    v_and_b32 v185, 0xffff0000, v116
    v_lshlrev_b32 v186, 16, v117
    v_and_b32 v187, 0xffff0000, v117
    v_lshlrev_b32 v188, 16, v118
    v_and_b32 v189, 0xffff0000, v118
    v_lshlrev_b32 v190, 16, v119
    v_and_b32 v191, 0xffff0000, v119
    v_pk_mul_f32 v[168:169], v[168:169], v[74:75] op_sel_hi:[1,0]
    v_pk_mul_f32 v[170:171], v[170:171], v[74:75] op_sel_hi:[1,0]
    v_pk_mul_f32 v[172:173], v[172:173], v[74:75] op_sel_hi:[1,0]
    v_pk_mul_f32 v[174:175], v[174:175], v[74:75] op_sel_hi:[1,0]
    v_pk_mul_f32 v[176:177], v[176:177], v[74:75] op_sel_hi:[1,0]
    v_pk_mul_f32 v[178:179], v[178:179], v[74:75] op_sel_hi:[1,0]
    v_pk_mul_f32 v[180:181], v[180:181], v[74:75] op_sel_hi:[1,0]
    v_pk_mul_f32 v[182:183], v[182:183], v[74:75] op_sel_hi:[1,0]
    v_pk_mul_f32 v[184:185], v[184:185], v[74:75] op_sel_hi:[1,0]
    v_pk_mul_f32 v[186:187], v[186:187], v[74:75] op_sel_hi:[1,0]
    v_pk_mul_f32 v[188:189], v[188:189], v[74:75] op_sel_hi:[1,0]
    v_pk_mul_f32 v[190:191], v[190:191], v[74:75] op_sel_hi:[1,0]
    v_cvt_pk_bf16_f32 v108, v168, v169
    v_cvt_pk_bf16_f32 v109, v170, v171
    v_cvt_pk_bf16_f32 v110, v172, v173
    v_cvt_pk_bf16_f32 v111, v174, v175
    v_cvt_pk_bf16_f32 v112, v176, v177
    v_cvt_pk_bf16_f32 v113, v178, v179
    v_cvt_pk_bf16_f32 v114, v180, v181
    v_cvt_pk_bf16_f32 v115, v182, v183
    v_cvt_pk_bf16_f32 v116, v184, v185
    v_cvt_pk_bf16_f32 v117, v186, v187
    v_cvt_pk_bf16_f32 v118, v188, v189
    v_cvt_pk_bf16_f32 v119, v190, v191
    v_lshlrev_b32 v168, 16, v108
    v_and_b32 v169, 0xffff0000, v108
    v_lshlrev_b32 v170, 16, v109
    v_and_b32 v171, 0xffff0000, v109
    v_lshlrev_b32 v172, 16, v110
    v_and_b32 v173, 0xffff0000, v110
    v_lshlrev_b32 v174, 16, v111
    v_and_b32 v175, 0xffff0000, v111
    v_lshlrev_b32 v176, 16, v112
    v_and_b32 v177, 0xffff0000, v112
    v_lshlrev_b32 v178, 16, v113
    v_and_b32 v179, 0xffff0000, v113
    v_lshlrev_b32 v180, 16, v114
    v_and_b32 v181, 0xffff0000, v114
    v_lshlrev_b32 v182, 16, v115
    v_and_b32 v183, 0xffff0000, v115
    v_lshlrev_b32 v184, 16, v116
    v_and_b32 v185, 0xffff0000, v116
    v_lshlrev_b32 v186, 16, v117
    v_and_b32 v187, 0xffff0000, v117
    v_lshlrev_b32 v188, 16, v118
    v_and_b32 v189, 0xffff0000, v118
    v_lshlrev_b32 v190, 16, v119
    v_and_b32 v191, 0xffff0000, v119
    s_mul_i32 s36, s3, 72
    v_add_u32 v72, s36, v1
    v_and_b32 v73, 7, v1
    s_add_u32 s36, s36, 64
    v_add_u32 v73, s36, v73
    s_movk_i32 s36, 1024
    v_and_b32 v76, 3, v72
    v_lshlrev_b32 v76, 4, v76
    v_lshrrev_b32 v72, 2, v72
    v_lshl_add_u32 v74, v72, 7, v76
    v_and_b32 v77, 1, v72
    v_lshl_add_u32 v76, v77, 3, v76
    v_lshrrev_b32 v72, 1, v72
    v_lshl_add_u32 v72, v72, 6, v76
    v_add_u32 v72, s36, v72
    v_and_b32 v76, 3, v73
    v_lshlrev_b32 v76, 4, v76
    v_lshrrev_b32 v73, 2, v73
    v_lshl_add_u32 v75, v73, 7, v76
    v_and_b32 v77, 1, v73
    v_lshl_add_u32 v76, v77, 3, v76
    v_lshrrev_b32 v73, 1, v73
    v_lshl_add_u32 v73, v73, 6, v76
    v_add_u32 v73, s36, v73
    s_mov_b64 exec, 0
    s_cmp_eq_u32 s3, 0
    s_cbranch_scc1 Ltour0
    s_cmp_eq_u32 s3, 1
    s_cbranch_scc1 Ltour1
    s_cmp_eq_u32 s3, 2
    s_cbranch_scc1 Ltour2
    s_branch Ltour3
.p2align 12
Lmain:
    s_mov_b64 exec, -1
    s_mov_b32 s38, 16384
Lhead_pollm:
    buffer_load_dwordx4 v[88:91], v74, s[24:27], s37 offen sc1
    buffer_load_dwordx4 v[92:95], v75, s[24:27], s37 offen sc1
    s_sub_u32 s38, s38, 1
    s_cbranch_scc1 Lhead_gotm
    s_waitcnt vmcnt(0) lgkmcnt(0)
    v_xor_b32 v89, s95, v89
    v_xor_b32 v91, s95, v91
    v_xor_b32 v93, s95, v93
    v_xor_b32 v95, s95, v95
    v_or3_b32 v89, v89, v91, v93
    v_or_b32 v89, v89, v95
    v_cmp_ne_u32 vcc, 0, v89
    s_cbranch_vccnz Lhead_pollm
Lhead_gotm:
    s_waitcnt vmcnt(0) lgkmcnt(0)
    ds_write2_b32 v72, v88, v90 offset0:0 offset1:1
    ds_write2_b32 v73, v92, v94 offset0:0 offset1:1
    s_waitcnt lgkmcnt(0)
    s_barrier
    ds_read_b128 v[144:147], v68 offset:2176
    ds_read_b128 v[148:151], v68 offset:2560
    ds_read_b128 v[152:155], v68 offset:2944
    ds_read_b128 v[156:159], v68 offset:1024
    ds_read_b128 v[160:163], v68 offset:1408
    ds_read_b128 v[164:167], v68 offset:1792
    s_waitcnt lgkmcnt(5)
    v_lshlrev_b32 v192, 16, v144
    v_and_b32 v193, 0xffff0000, v144
    v_lshlrev_b32 v194, 16, v145
    v_and_b32 v195, 0xffff0000, v145
    v_lshlrev_b32 v196, 16, v146
    v_and_b32 v197, 0xffff0000, v146
    v_lshlrev_b32 v198, 16, v147
    v_and_b32 v199, 0xffff0000, v147
    s_waitcnt lgkmcnt(4)
    v_lshlrev_b32 v200, 16, v148
    v_and_b32 v201, 0xffff0000, v148
    v_lshlrev_b32 v202, 16, v149
    v_and_b32 v203, 0xffff0000, v149
    v_lshlrev_b32 v204, 16, v150
    v_and_b32 v205, 0xffff0000, v150
    v_lshlrev_b32 v206, 16, v151
    v_and_b32 v207, 0xffff0000, v151
    s_waitcnt lgkmcnt(3)
    v_lshlrev_b32 v208, 16, v152
    v_and_b32 v209, 0xffff0000, v152
    v_lshlrev_b32 v210, 16, v153
    v_and_b32 v211, 0xffff0000, v153
    v_lshlrev_b32 v212, 16, v154
    v_and_b32 v213, 0xffff0000, v154
    v_lshlrev_b32 v214, 16, v155
    v_and_b32 v215, 0xffff0000, v155
    v_pk_mul_f32 v[168:169], v[168:169], v[192:193]
    v_pk_mul_f32 v[170:171], v[170:171], v[194:195]
    v_pk_mul_f32 v[172:173], v[172:173], v[196:197]
    v_pk_mul_f32 v[174:175], v[174:175], v[198:199]
    v_pk_mul_f32 v[176:177], v[176:177], v[200:201]
    v_pk_mul_f32 v[178:179], v[178:179], v[202:203]
    v_pk_mul_f32 v[180:181], v[180:181], v[204:205]
    v_pk_mul_f32 v[182:183], v[182:183], v[206:207]
    v_pk_mul_f32 v[184:185], v[184:185], v[208:209]
    v_pk_mul_f32 v[186:187], v[186:187], v[210:211]
    v_pk_mul_f32 v[188:189], v[188:189], v[212:213]
    v_pk_mul_f32 v[190:191], v[190:191], v[214:215]
    v_cvt_pk_bf16_f32 v108, v168, v169
    v_cvt_pk_bf16_f32 v109, v170, v171
    v_cvt_pk_bf16_f32 v110, v172, v173
    v_cvt_pk_bf16_f32 v111, v174, v175
    v_cvt_pk_bf16_f32 v112, v176, v177
    v_cvt_pk_bf16_f32 v113, v178, v179
    v_cvt_pk_bf16_f32 v114, v180, v181
    v_cvt_pk_bf16_f32 v115, v182, v183
    v_cvt_pk_bf16_f32 v116, v184, v185
    v_cvt_pk_bf16_f32 v117, v186, v187
    v_cvt_pk_bf16_f32 v118, v188, v189
    v_cvt_pk_bf16_f32 v119, v190, v191
    s_waitcnt lgkmcnt(2)
    v_lshlrev_b32 v216, 16, v156
    v_and_b32 v217, 0xffff0000, v156
    v_lshlrev_b32 v218, 16, v157
    v_and_b32 v219, 0xffff0000, v157
    v_lshlrev_b32 v220, 16, v158
    v_and_b32 v221, 0xffff0000, v158
    v_lshlrev_b32 v222, 16, v159
    v_and_b32 v223, 0xffff0000, v159
    s_waitcnt lgkmcnt(1)
    v_lshlrev_b32 v224, 16, v160
    v_and_b32 v225, 0xffff0000, v160
    v_lshlrev_b32 v226, 16, v161
    v_and_b32 v227, 0xffff0000, v161
    v_lshlrev_b32 v228, 16, v162
    v_and_b32 v229, 0xffff0000, v162
    v_lshlrev_b32 v230, 16, v163
    v_and_b32 v231, 0xffff0000, v163
    s_waitcnt lgkmcnt(0)
    v_lshlrev_b32 v232, 16, v164
    v_and_b32 v233, 0xffff0000, v164
    v_lshlrev_b32 v234, 16, v165
    v_and_b32 v235, 0xffff0000, v165
    v_lshlrev_b32 v236, 16, v166
    v_and_b32 v237, 0xffff0000, v166
    v_lshlrev_b32 v238, 16, v167
    v_and_b32 v239, 0xffff0000, v167
    v_lshlrev_b32 v168, 16, v108
    v_and_b32 v169, 0xffff0000, v108
    v_lshlrev_b32 v170, 16, v109
    v_and_b32 v171, 0xffff0000, v109
    v_lshlrev_b32 v172, 16, v110
    v_and_b32 v173, 0xffff0000, v110
    v_lshlrev_b32 v174, 16, v111
    v_and_b32 v175, 0xffff0000, v111
    v_lshlrev_b32 v176, 16, v112
    v_and_b32 v177, 0xffff0000, v112
    v_lshlrev_b32 v178, 16, v113
    v_and_b32 v179, 0xffff0000, v113
    v_lshlrev_b32 v180, 16, v114
    v_and_b32 v181, 0xffff0000, v114
    v_lshlrev_b32 v182, 16, v115
    v_and_b32 v183, 0xffff0000, v115
    v_lshlrev_b32 v184, 16, v116
    v_and_b32 v185, 0xffff0000, v116
    v_lshlrev_b32 v186, 16, v117
    v_and_b32 v187, 0xffff0000, v117
    v_lshlrev_b32 v188, 16, v118
    v_and_b32 v189, 0xffff0000, v118
    v_lshlrev_b32 v190, 16, v119
    v_and_b32 v191, 0xffff0000, v119
    v_pk_add_f32 v[168:169], v[168:169], v[216:217]
    v_pk_add_f32 v[170:171], v[170:171], v[218:219]
    v_pk_add_f32 v[172:173], v[172:173], v[220:221]
    v_pk_add_f32 v[174:175], v[174:175], v[222:223]
    v_cvt_pk_bf16_f32 v108, v168, v169
    v_cvt_pk_bf16_f32 v109, v170, v171
    v_cvt_pk_bf16_f32 v110, v172, v173
    v_cvt_pk_bf16_f32 v111, v174, v175
    buffer_store_dwordx4 v[108:111], v67, s[24:27], s92 offen offset:0 sc1
    v_pk_add_f32 v[176:177], v[176:177], v[224:225]
    v_pk_add_f32 v[178:179], v[178:179], v[226:227]
    v_pk_add_f32 v[180:181], v[180:181], v[228:229]
    v_pk_add_f32 v[182:183], v[182:183], v[230:231]
    v_cvt_pk_bf16_f32 v112, v176, v177
    v_cvt_pk_bf16_f32 v113, v178, v179
    v_cvt_pk_bf16_f32 v114, v180, v181
    v_cvt_pk_bf16_f32 v115, v182, v183
    buffer_store_dwordx4 v[112:115], v67, s[24:27], s92 offen offset:768 sc1
    v_pk_add_f32 v[184:185], v[184:185], v[232:233]
    v_pk_add_f32 v[186:187], v[186:187], v[234:235]
    v_pk_add_f32 v[188:189], v[188:189], v[236:237]
    v_pk_add_f32 v[190:191], v[190:191], v[238:239]
    v_cvt_pk_bf16_f32 v116, v184, v185
    v_cvt_pk_bf16_f32 v117, v186, v187
    v_cvt_pk_bf16_f32 v118, v188, v189
    v_cvt_pk_bf16_f32 v119, v190, v191
    buffer_store_dwordx4 v[116:119], v67, s[24:27], s92 offen offset:1536 sc1
    s_lshl_b32 s36, s5, 13
    s_add_u32 s36, s36, 8650752
    s_lshl_b32 s37, s4, 9
    s_add_u32 s37, s37, s36
    s_lshl_b32 s38, s3, 7
    s_add_u32 s37, s37, s38
    s_lshl_b32 s38, s3, 11
    s_add_u32 s36, s36, s38
    v_min_u32 v72, 1, v1
    v_lshlrev_b32 v72, 31, v72
    v_and_b32 v73, 15, v1
    v_lshlrev_b32 v73, 7, v73
    v_cmp_gt_u32 vcc, 162, v0
    v_mov_b32 v88, -1
    v_mov_b32 v89, -1
    v_mov_b32 v90, -1
    v_mov_b32 v91, -1
    s_mul_i32 s39, s2, 2592
    s_add_u32 s39, s39, 7864320
    v_lshl_add_u32 v74, v0, 4, s39
    s_lshl_b32 s39, s2, 7
    s_add_u32 s39, s39, 8912896
    v_mov_b32 v75, s39
    v_cndmask_b32 v74, v75, v74, vcc
    s_lshl_b32 s92, s5, 13
    s_add_u32 s92, s92, 8781824
    s_add_u32 s92, s92, s38
    s_lshl_b32 s38, s4, 7
    s_add_u32 s92, s92, s38
    s_getreg_b32 s38, hwreg(HW_REG_XCC_ID, 0, 4)
    s_add_u32 s38, s38, s95
    v_mov_b32 v76, s38
    v_mov_b32 v2, v80
    v_mov_b32 v3, v81
    v_mov_b32 v4, v82
    v_mov_b32 v5, v83
    v_mov_b32 v6, v84
    v_mov_b32 v7, v65
    s_waitcnt vmcnt(0)
    buffer_store_dword v137, v72, s[24:27], s37 offen sc1
    s_add_u32 s49, s44, 0
    s_add_u32 m0, s42, 32768
    s_nop 0
    buffer_load_dwordx4 v42, s[16:19], s49 offen lds
    buffer_load_dwordx4 v43, s[16:19], s49 offen offset:1024 lds
    buffer_load_dwordx4 v44, s[16:19], s49 offen offset:2048 lds
    buffer_load_dwordx4 v45, s[16:19], s49 offen offset:3072 lds
    s_add_u32 s49, s44, 256
    s_add_u32 m0, s42, 49152
    s_nop 0
    buffer_load_dwordx4 v42, s[16:19], s49 offen lds
    buffer_load_dwordx4 v43, s[16:19], s49 offen offset:1024 lds
    buffer_load_dwordx4 v44, s[16:19], s49 offen offset:2048 lds
    buffer_load_dwordx4 v45, s[16:19], s49 offen offset:3072 lds
    s_add_u32 s49, s44, 524288
    s_add_u32 m0, s42, 65536
    s_nop 0
    buffer_load_dwordx4 v42, s[16:19], s49 offen lds
    buffer_load_dwordx4 v43, s[16:19], s49 offen offset:1024 lds
    buffer_load_dwordx4 v44, s[16:19], s49 offen offset:2048 lds
    buffer_load_dwordx4 v45, s[16:19], s49 offen offset:3072 lds
    s_add_u32 s49, s44, 524544
    s_add_u32 m0, s42, 81920
    s_nop 0
    buffer_load_dwordx4 v42, s[16:19], s49 offen lds
    buffer_load_dwordx4 v43, s[16:19], s49 offen offset:1024 lds
    buffer_load_dwordx4 v44, s[16:19], s49 offen offset:2048 lds
    buffer_load_dwordx4 v45, s[16:19], s49 offen offset:3072 lds
    s_add_u32 s49, s44, 1048576
    s_add_u32 m0, s42, 98304
    s_nop 0
    buffer_load_dwordx4 v42, s[16:19], s49 offen lds
    buffer_load_dwordx4 v43, s[16:19], s49 offen offset:1024 lds
    buffer_load_dwordx4 v44, s[16:19], s49 offen offset:2048 lds
    buffer_load_dwordx4 v45, s[16:19], s49 offen offset:3072 lds
    s_add_u32 s49, s44, 1048832
    s_add_u32 m0, s42, 114688
    s_nop 0
    buffer_load_dwordx4 v42, s[16:19], s49 offen lds
    buffer_load_dwordx4 v43, s[16:19], s49 offen offset:1024 lds
    buffer_load_dwordx4 v44, s[16:19], s49 offen offset:2048 lds
    buffer_load_dwordx4 v45, s[16:19], s49 offen offset:3072 lds
    s_mov_b32 s38, 16384
Lhead_pollh:
    buffer_load_dword v75, v73, s[24:27], s36 offen sc1
    s_sub_u32 s38, s38, 1
    s_cbranch_scc1 Lhead_goth
    s_waitcnt vmcnt(0) lgkmcnt(0)
    v_cmp_ne_u32 vcc, s95, v75
    s_cbranch_vccnz Lhead_pollh
Lhead_goth:
    s_waitcnt vmcnt(0) lgkmcnt(0)
    buffer_load_dwordx4 a[0:3], v51, s[24:27], s46 offen offset:0 sc1
    buffer_load_dwordx4 a[8:11], v51, s[24:27], s46 offen offset:128 sc1
    buffer_load_dwordx4 a[4:7], v51, s[24:27], s43 offen offset:0 sc1
    buffer_load_dwordx4 a[12:15], v51, s[24:27], s43 offen offset:128 sc1
    s_barrier
    ds_read_b64_tr_b16 a[160:161], v12 offset:32768
    ds_read_b64_tr_b16 a[162:163], v12 offset:36864
    ds_read_b64_tr_b16 a[164:165], v12 offset:40960
    ds_read_b64_tr_b16 a[166:167], v12 offset:45056
    ds_read_b64_tr_b16 a[168:169], v13 offset:32768
    ds_read_b64_tr_b16 a[170:171], v13 offset:36864
    ds_read_b64_tr_b16 a[172:173], v13 offset:40960
    ds_read_b64_tr_b16 a[174:175], v13 offset:45056
    ds_read_b64_tr_b16 a[176:177], v14 offset:32768
    ds_read_b64_tr_b16 a[178:179], v14 offset:36864
    ds_read_b64_tr_b16 a[180:181], v14 offset:40960
    ds_read_b64_tr_b16 a[182:183], v14 offset:45056
    buffer_load_dwordx4 a[16:19], v51, s[24:27], s46 offen offset:256 sc1
    buffer_load_dwordx4 a[24:27], v51, s[24:27], s46 offen offset:384 sc1
    buffer_load_dwordx4 a[20:23], v51, s[24:27], s43 offen offset:256 sc1
    buffer_load_dwordx4 a[28:31], v51, s[24:27], s43 offen offset:384 sc1
    s_waitcnt lgkmcnt(10)
    s_waitcnt vmcnt(7)
    v_mfma_f32_16x16x32_bf16 v[128:131], a[160:163], a[0:3], 0
    s_waitcnt vmcnt(6)
    s_waitcnt lgkmcnt(8)
    ds_read_b64_tr_b16 a[184:185], v15 offset:32768
    v_mfma_f32_16x16x32_bf16 v[128:131], a[164:167], a[8:11], v[128:131]
    s_waitcnt vmcnt(5)
    ds_read_b64_tr_b16 a[186:187], v15 offset:36864
    v_mfma_f32_16x16x32_bf16 v[132:135], a[160:163], a[4:7], 0
    s_waitcnt vmcnt(4)
    ds_read_b64_tr_b16 a[188:189], v15 offset:40960
    v_mfma_f32_16x16x32_bf16 v[132:135], a[164:167], a[12:15], v[132:135]
    s_waitcnt lgkmcnt(9)
    buffer_load_dwordx4 a[32:35], v51, s[24:27], s46 offen offset:512 sc1
    v_mfma_f32_16x16x32_bf16 v[136:139], a[168:171], a[0:3], 0
    s_waitcnt lgkmcnt(7)
    ds_read_b64_tr_b16 a[190:191], v15 offset:45056
    ds_read_b64_tr_b16 a[160:161], v16 offset:32768
    v_mfma_f32_16x16x32_bf16 v[136:139], a[172:175], a[8:11], v[136:139]
    ds_read_b64_tr_b16 a[162:163], v16 offset:36864
    v_mfma_f32_16x16x32_bf16 v[140:143], a[168:171], a[4:7], 0
    ds_read_b64_tr_b16 a[164:165], v16 offset:40960
    v_mfma_f32_16x16x32_bf16 v[140:143], a[172:175], a[12:15], v[140:143]
    s_waitcnt lgkmcnt(9)
    buffer_load_dwordx4 a[40:43], v51, s[24:27], s46 offen offset:640 sc1
    v_mfma_f32_16x16x32_bf16 v[144:147], a[176:179], a[0:3], 0
    s_waitcnt lgkmcnt(7)
    ds_read_b64_tr_b16 a[166:167], v16 offset:45056
    ds_read_b64_tr_b16 a[168:169], v17 offset:32768
    v_mfma_f32_16x16x32_bf16 v[144:147], a[180:183], a[8:11], v[144:147]
    ds_read_b64_tr_b16 a[170:171], v17 offset:36864
    v_mfma_f32_16x16x32_bf16 v[148:151], a[176:179], a[4:7], 0
    ds_read_b64_tr_b16 a[172:173], v17 offset:40960
    v_mfma_f32_16x16x32_bf16 v[148:151], a[180:183], a[12:15], v[148:151]
    s_waitcnt lgkmcnt(9)
    buffer_load_dwordx4 a[36:39], v51, s[24:27], s43 offen offset:512 sc1
    v_mfma_f32_16x16x32_bf16 v[152:155], a[184:187], a[0:3], 0
    s_waitcnt lgkmcnt(7)
    ds_read_b64_tr_b16 a[174:175], v17 offset:45056
    ds_read_b64_tr_b16 a[176:177], v18 offset:32768
    v_mfma_f32_16x16x32_bf16 v[152:155], a[188:191], a[8:11], v[152:155]
    ds_read_b64_tr_b16 a[178:179], v18 offset:36864
    v_mfma_f32_16x16x32_bf16 v[156:159], a[184:187], a[4:7], 0
    ds_read_b64_tr_b16 a[180:181], v18 offset:40960
    v_mfma_f32_16x16x32_bf16 v[156:159], a[188:191], a[12:15], v[156:159]
    s_waitcnt lgkmcnt(9)
    buffer_load_dwordx4 a[44:47], v51, s[24:27], s43 offen offset:640 sc1
    v_mfma_f32_16x16x32_bf16 v[160:163], a[160:163], a[0:3], 0
    s_waitcnt lgkmcnt(7)
    ds_read_b64_tr_b16 a[182:183], v18 offset:45056
    ds_read_b64_tr_b16 a[184:185], v19 offset:32768
    v_mfma_f32_16x16x32_bf16 v[160:163], a[164:167], a[8:11], v[160:163]
    ds_read_b64_tr_b16 a[186:187], v19 offset:36864
    v_mfma_f32_16x16x32_bf16 v[164:167], a[160:163], a[4:7], 0
    ds_read_b64_tr_b16 a[188:189], v19 offset:40960
    v_mfma_f32_16x16x32_bf16 v[164:167], a[164:167], a[12:15], v[164:167]
    s_waitcnt lgkmcnt(9)
    buffer_load_dword v77, v70, s[16:19], s44 offen
    v_mfma_f32_16x16x32_bf16 v[168:171], a[168:171], a[0:3], 0
    s_waitcnt lgkmcnt(7)
    ds_read_b64_tr_b16 a[190:191], v19 offset:45056
    ds_read_b64_tr_b16 a[160:161], v12 offset:49152
    v_mfma_f32_16x16x32_bf16 v[168:171], a[172:175], a[8:11], v[168:171]
    ds_read_b64_tr_b16 a[162:163], v12 offset:53248
    v_mfma_f32_16x16x32_bf16 v[172:175], a[168:171], a[4:7], 0
    ds_read_b64_tr_b16 a[164:165], v12 offset:57344
    v_mfma_f32_16x16x32_bf16 v[172:175], a[172:175], a[12:15], v[172:175]
    s_waitcnt lgkmcnt(9)
    ds_read_b64_tr_b16 a[166:167], v12 offset:61440
    v_mfma_f32_16x16x32_bf16 v[176:179], a[176:179], a[0:3], 0
    s_waitcnt lgkmcnt(8)
    ds_read_b64_tr_b16 a[168:169], v13 offset:49152
    v_mfma_f32_16x16x32_bf16 v[176:179], a[180:183], a[8:11], v[176:179]
    ds_read_b64_tr_b16 a[170:171], v13 offset:53248
    v_mfma_f32_16x16x32_bf16 v[180:183], a[176:179], a[4:7], 0
    ds_read_b64_tr_b16 a[172:173], v13 offset:57344
    v_mfma_f32_16x16x32_bf16 v[180:183], a[180:183], a[12:15], v[180:183]
    s_waitcnt lgkmcnt(9)
    ds_read_b64_tr_b16 a[174:175], v13 offset:61440
    v_mfma_f32_16x16x32_bf16 v[184:187], a[184:187], a[0:3], 0
    s_waitcnt lgkmcnt(8)
    ds_read_b64_tr_b16 a[176:177], v14 offset:49152
    v_mfma_f32_16x16x32_bf16 v[184:187], a[188:191], a[8:11], v[184:187]
    ds_read_b64_tr_b16 a[178:179], v14 offset:53248
    v_mfma_f32_16x16x32_bf16 v[188:191], a[184:187], a[4:7], 0
    ds_read_b64_tr_b16 a[180:181], v14 offset:57344
    v_mfma_f32_16x16x32_bf16 v[188:191], a[188:191], a[12:15], v[188:191]
    s_waitcnt lgkmcnt(9)
    ds_read_b64_tr_b16 a[182:183], v14 offset:61440
    v_mfma_f32_16x16x32_bf16 v[192:195], a[160:163], a[0:3], 0
    s_waitcnt lgkmcnt(8)
    ds_read_b64_tr_b16 a[184:185], v15 offset:49152
    v_mfma_f32_16x16x32_bf16 v[192:195], a[164:167], a[8:11], v[192:195]
    ds_read_b64_tr_b16 a[186:187], v15 offset:53248
    v_mfma_f32_16x16x32_bf16 v[196:199], a[160:163], a[4:7], 0
    ds_read_b64_tr_b16 a[188:189], v15 offset:57344
    v_mfma_f32_16x16x32_bf16 v[196:199], a[164:167], a[12:15], v[196:199]
    s_waitcnt lgkmcnt(9)
    ds_read_b64_tr_b16 a[190:191], v15 offset:61440
    v_mfma_f32_16x16x32_bf16 v[200:203], a[168:171], a[0:3], 0
    s_waitcnt lgkmcnt(8)
    ds_read_b64_tr_b16 a[160:161], v16 offset:49152
    v_mfma_f32_16x16x32_bf16 v[200:203], a[172:175], a[8:11], v[200:203]
    ds_read_b64_tr_b16 a[162:163], v16 offset:53248
    v_mfma_f32_16x16x32_bf16 v[204:207], a[168:171], a[4:7], 0
    ds_read_b64_tr_b16 a[164:165], v16 offset:57344
    v_mfma_f32_16x16x32_bf16 v[204:207], a[172:175], a[12:15], v[204:207]
    s_waitcnt lgkmcnt(9)
    ds_read_b64_tr_b16 a[166:167], v16 offset:61440
    v_mfma_f32_16x16x32_bf16 v[208:211], a[176:179], a[0:3], 0
    s_waitcnt lgkmcnt(8)
    ds_read_b64_tr_b16 a[168:169], v17 offset:49152
    v_mfma_f32_16x16x32_bf16 v[208:211], a[180:183], a[8:11], v[208:211]
    ds_read_b64_tr_b16 a[170:171], v17 offset:53248
    v_mfma_f32_16x16x32_bf16 v[212:215], a[176:179], a[4:7], 0
    ds_read_b64_tr_b16 a[172:173], v17 offset:57344
    v_mfma_f32_16x16x32_bf16 v[212:215], a[180:183], a[12:15], v[212:215]
    s_waitcnt lgkmcnt(9)
    ds_read_b64_tr_b16 a[174:175], v17 offset:61440
    v_mfma_f32_16x16x32_bf16 v[216:219], a[184:187], a[0:3], 0
    s_waitcnt lgkmcnt(8)
    ds_read_b64_tr_b16 a[176:177], v18 offset:49152
    v_mfma_f32_16x16x32_bf16 v[216:219], a[188:191], a[8:11], v[216:219]
    ds_read_b64_tr_b16 a[178:179], v18 offset:53248
    v_mfma_f32_16x16x32_bf16 v[220:223], a[184:187], a[4:7], 0
    ds_read_b64_tr_b16 a[180:181], v18 offset:57344
    v_mfma_f32_16x16x32_bf16 v[220:223], a[188:191], a[12:15], v[220:223]
    s_waitcnt lgkmcnt(9)
    ds_read_b64_tr_b16 a[182:183], v18 offset:61440
    v_mfma_f32_16x16x32_bf16 v[224:227], a[160:163], a[0:3], 0
    s_waitcnt lgkmcnt(8)
    ds_read_b64_tr_b16 a[184:185], v19 offset:49152
    v_mfma_f32_16x16x32_bf16 v[224:227], a[164:167], a[8:11], v[224:227]
    ds_read_b64_tr_b16 a[186:187], v19 offset:53248
    v_mfma_f32_16x16x32_bf16 v[228:231], a[160:163], a[4:7], 0
    ds_read_b64_tr_b16 a[188:189], v19 offset:57344
    v_mfma_f32_16x16x32_bf16 v[228:231], a[164:167], a[12:15], v[228:231]
    s_waitcnt lgkmcnt(9)
    ds_read_b64_tr_b16 a[190:191], v19 offset:61440
    s_barrier
    v_mfma_f32_16x16x32_bf16 v[232:235], a[168:171], a[0:3], 0
    s_waitcnt lgkmcnt(8)
    ds_read_b64_tr_b16 a[160:161], v20 offset:0
    v_mfma_f32_16x16x32_bf16 v[232:235], a[172:175], a[8:11], v[232:235]
    s_add_u32 s49, s44, 1572864
    ds_read_b64_tr_b16 a[162:163], v20 offset:4096
    v_mfma_f32_16x16x32_bf16 v[236:239], a[168:171], a[4:7], 0
    s_add_u32 m0, s42, 131072
    ds_read_b64_tr_b16 a[164:165], v20 offset:8192
    v_mfma_f32_16x16x32_bf16 v[236:239], a[172:175], a[12:15], v[236:239]
    s_waitcnt lgkmcnt(9)
    buffer_load_dwordx4 v42, s[16:19], s49 offen lds
    v_mfma_f32_16x16x32_bf16 v[240:243], a[176:179], a[0:3], 0
    s_waitcnt lgkmcnt(7)
    ds_read_b64_tr_b16 a[166:167], v20 offset:12288
    ds_read_b64_tr_b16 a[168:169], v21 offset:0
    v_mfma_f32_16x16x32_bf16 v[240:243], a[180:183], a[8:11], v[240:243]
    ds_read_b64_tr_b16 a[170:171], v21 offset:4096
    v_mfma_f32_16x16x32_bf16 v[244:247], a[176:179], a[4:7], 0
    ds_read_b64_tr_b16 a[172:173], v21 offset:8192
    v_mfma_f32_16x16x32_bf16 v[244:247], a[180:183], a[12:15], v[244:247]
    s_waitcnt lgkmcnt(9)
    buffer_load_dwordx4 v43, s[16:19], s49 offen offset:1024 lds
    v_mfma_f32_16x16x32_bf16 v[248:251], a[184:187], a[0:3], 0
    s_waitcnt lgkmcnt(7)
    ds_read_b64_tr_b16 a[174:175], v21 offset:12288
    ds_read_b64_tr_b16 a[176:177], v22 offset:0
    v_mfma_f32_16x16x32_bf16 v[248:251], a[188:191], a[8:11], v[248:251]
    ds_read_b64_tr_b16 a[178:179], v22 offset:4096
    v_mfma_f32_16x16x32_bf16 v[252:255], a[184:187], a[4:7], 0
    ds_read_b64_tr_b16 a[180:181], v22 offset:8192
    v_mfma_f32_16x16x32_bf16 v[252:255], a[188:191], a[12:15], v[252:255]
    s_waitcnt vmcnt(10)
    s_waitcnt lgkmcnt(9)
    buffer_load_dwordx4 v44, s[16:19], s49 offen offset:2048 lds
    v_mfma_f32_16x16x32_bf16 v[128:131], a[160:163], a[16:19], v[128:131]
    s_waitcnt vmcnt(10)
    s_waitcnt lgkmcnt(7)
    ds_read_b64_tr_b16 a[182:183], v22 offset:12288
    ds_read_b64_tr_b16 a[184:185], v23 offset:0
    v_mfma_f32_16x16x32_bf16 v[128:131], a[164:167], a[24:27], v[128:131]
    s_waitcnt vmcnt(9)
    ds_read_b64_tr_b16 a[186:187], v23 offset:4096
    v_mfma_f32_16x16x32_bf16 v[132:135], a[160:163], a[20:23], v[132:135]
    s_waitcnt vmcnt(8)
    ds_read_b64_tr_b16 a[188:189], v23 offset:8192
    v_mfma_f32_16x16x32_bf16 v[132:135], a[164:167], a[28:31], v[132:135]
    s_waitcnt lgkmcnt(9)
    buffer_load_dwordx4 v45, s[16:19], s49 offen offset:3072 lds
    v_mfma_f32_16x16x32_bf16 v[136:139], a[168:171], a[16:19], v[136:139]
    s_waitcnt lgkmcnt(7)
    ds_read_b64_tr_b16 a[190:191], v23 offset:12288
    ds_read_b64_tr_b16 a[160:161], v24 offset:0
    v_mfma_f32_16x16x32_bf16 v[136:139], a[172:175], a[24:27], v[136:139]
    s_add_u32 s49, s44, 1573120
    ds_read_b64_tr_b16 a[162:163], v24 offset:4096
    v_mfma_f32_16x16x32_bf16 v[140:143], a[168:171], a[20:23], v[140:143]
    s_add_u32 m0, s42, 147456
    ds_read_b64_tr_b16 a[164:165], v24 offset:8192
    v_mfma_f32_16x16x32_bf16 v[140:143], a[172:175], a[28:31], v[140:143]
    s_waitcnt lgkmcnt(9)
    buffer_load_dwordx4 v42, s[16:19], s49 offen lds
    v_mfma_f32_16x16x32_bf16 v[144:147], a[176:179], a[16:19], v[144:147]
    s_waitcnt lgkmcnt(7)
    ds_read_b64_tr_b16 a[166:167], v24 offset:12288
    ds_read_b64_tr_b16 a[168:169], v25 offset:0
    v_mfma_f32_16x16x32_bf16 v[144:147], a[180:183], a[24:27], v[144:147]
    ds_read_b64_tr_b16 a[170:171], v25 offset:4096
    v_mfma_f32_16x16x32_bf16 v[148:151], a[176:179], a[20:23], v[148:151]
    ds_read_b64_tr_b16 a[172:173], v25 offset:8192
    v_mfma_f32_16x16x32_bf16 v[148:151], a[180:183], a[28:31], v[148:151]
    s_waitcnt lgkmcnt(9)
    buffer_load_dwordx4 v43, s[16:19], s49 offen offset:1024 lds
    v_mfma_f32_16x16x32_bf16 v[152:155], a[184:187], a[16:19], v[152:155]
    s_waitcnt lgkmcnt(7)
    ds_read_b64_tr_b16 a[174:175], v25 offset:12288
    ds_read_b64_tr_b16 a[176:177], v26 offset:0
    v_mfma_f32_16x16x32_bf16 v[152:155], a[188:191], a[24:27], v[152:155]
    ds_read_b64_tr_b16 a[178:179], v26 offset:4096
    v_mfma_f32_16x16x32_bf16 v[156:159], a[184:187], a[20:23], v[156:159]
    ds_read_b64_tr_b16 a[180:181], v26 offset:8192
    v_mfma_f32_16x16x32_bf16 v[156:159], a[188:191], a[28:31], v[156:159]
    s_waitcnt lgkmcnt(9)
    buffer_load_dwordx4 v44, s[16:19], s49 offen offset:2048 lds
    v_mfma_f32_16x16x32_bf16 v[160:163], a[160:163], a[16:19], v[160:163]
    s_waitcnt lgkmcnt(7)
    ds_read_b64_tr_b16 a[182:183], v26 offset:12288
    ds_read_b64_tr_b16 a[184:185], v27 offset:0
    v_mfma_f32_16x16x32_bf16 v[160:163], a[164:167], a[24:27], v[160:163]
    ds_read_b64_tr_b16 a[186:187], v27 offset:4096
    v_mfma_f32_16x16x32_bf16 v[164:167], a[160:163], a[20:23], v[164:167]
    ds_read_b64_tr_b16 a[188:189], v27 offset:8192
    v_mfma_f32_16x16x32_bf16 v[164:167], a[164:167], a[28:31], v[164:167]
    s_waitcnt lgkmcnt(9)
    buffer_load_dwordx4 v45, s[16:19], s49 offen offset:3072 lds
    v_mfma_f32_16x16x32_bf16 v[168:171], a[168:171], a[16:19], v[168:171]
    s_waitcnt lgkmcnt(7)
    ds_read_b64_tr_b16 a[190:191], v27 offset:12288
    ds_read_b64_tr_b16 a[160:161], v20 offset:16384
    v_mfma_f32_16x16x32_bf16 v[168:171], a[172:175], a[24:27], v[168:171]
    ds_read_b64_tr_b16 a[162:163], v20 offset:20480
    v_mfma_f32_16x16x32_bf16 v[172:175], a[168:171], a[20:23], v[172:175]
    ds_read_b64_tr_b16 a[164:165], v20 offset:24576
    v_mfma_f32_16x16x32_bf16 v[172:175], a[172:175], a[28:31], v[172:175]
    s_waitcnt lgkmcnt(9)
    buffer_load_dwordx4 a[48:51], v51, s[24:27], s46 offen offset:768 sc1
    v_mfma_f32_16x16x32_bf16 v[176:179], a[176:179], a[16:19], v[176:179]
    s_waitcnt lgkmcnt(7)
    ds_read_b64_tr_b16 a[166:167], v20 offset:28672
    ds_read_b64_tr_b16 a[168:169], v21 offset:16384
    v_mfma_f32_16x16x32_bf16 v[176:179], a[180:183], a[24:27], v[176:179]
    ds_read_b64_tr_b16 a[170:171], v21 offset:20480
    v_mfma_f32_16x16x32_bf16 v[180:183], a[176:179], a[20:23], v[180:183]
    ds_read_b64_tr_b16 a[172:173], v21 offset:24576
    v_mfma_f32_16x16x32_bf16 v[180:183], a[180:183], a[28:31], v[180:183]
    s_waitcnt lgkmcnt(9)
    buffer_load_dwordx4 a[56:59], v51, s[24:27], s46 offen offset:896 sc1
    v_mfma_f32_16x16x32_bf16 v[184:187], a[184:187], a[16:19], v[184:187]
    s_waitcnt lgkmcnt(7)
    ds_read_b64_tr_b16 a[174:175], v21 offset:28672
    ds_read_b64_tr_b16 a[176:177], v22 offset:16384
    v_mfma_f32_16x16x32_bf16 v[184:187], a[188:191], a[24:27], v[184:187]
    ds_read_b64_tr_b16 a[178:179], v22 offset:20480
    v_mfma_f32_16x16x32_bf16 v[188:191], a[184:187], a[20:23], v[188:191]
    ds_read_b64_tr_b16 a[180:181], v22 offset:24576
    v_mfma_f32_16x16x32_bf16 v[188:191], a[188:191], a[28:31], v[188:191]
    s_waitcnt lgkmcnt(9)
    buffer_load_dwordx4 a[52:55], v51, s[24:27], s43 offen offset:768 sc1
    v_mfma_f32_16x16x32_bf16 v[192:195], a[160:163], a[16:19], v[192:195]
    s_waitcnt lgkmcnt(7)
    ds_read_b64_tr_b16 a[182:183], v22 offset:28672
    ds_read_b64_tr_b16 a[184:185], v23 offset:16384
    v_mfma_f32_16x16x32_bf16 v[192:195], a[164:167], a[24:27], v[192:195]
    ds_read_b64_tr_b16 a[186:187], v23 offset:20480
    v_mfma_f32_16x16x32_bf16 v[196:199], a[160:163], a[20:23], v[196:199]
    ds_read_b64_tr_b16 a[188:189], v23 offset:24576
    v_mfma_f32_16x16x32_bf16 v[196:199], a[164:167], a[28:31], v[196:199]
    s_waitcnt lgkmcnt(9)
    buffer_load_dwordx4 a[60:63], v51, s[24:27], s43 offen offset:896 sc1
    v_mfma_f32_16x16x32_bf16 v[200:203], a[168:171], a[16:19], v[200:203]
    s_waitcnt lgkmcnt(7)
    ds_read_b64_tr_b16 a[190:191], v23 offset:28672
    ds_read_b64_tr_b16 a[160:161], v24 offset:16384
    v_mfma_f32_16x16x32_bf16 v[200:203], a[172:175], a[24:27], v[200:203]
    ds_read_b64_tr_b16 a[162:163], v24 offset:20480
    v_mfma_f32_16x16x32_bf16 v[204:207], a[168:171], a[20:23], v[204:207]
    ds_read_b64_tr_b16 a[164:165], v24 offset:24576
    v_mfma_f32_16x16x32_bf16 v[204:207], a[172:175], a[28:31], v[204:207]
    s_waitcnt lgkmcnt(9)
    ds_read_b64_tr_b16 a[166:167], v24 offset:28672
    v_mfma_f32_16x16x32_bf16 v[208:211], a[176:179], a[16:19], v[208:211]
    s_waitcnt lgkmcnt(8)
    ds_read_b64_tr_b16 a[168:169], v25 offset:16384
    v_mfma_f32_16x16x32_bf16 v[208:211], a[180:183], a[24:27], v[208:211]
    ds_read_b64_tr_b16 a[170:171], v25 offset:20480
    v_mfma_f32_16x16x32_bf16 v[212:215], a[176:179], a[20:23], v[212:215]
    ds_read_b64_tr_b16 a[172:173], v25 offset:24576
    v_mfma_f32_16x16x32_bf16 v[212:215], a[180:183], a[28:31], v[212:215]
    s_waitcnt lgkmcnt(9)
    ds_read_b64_tr_b16 a[174:175], v25 offset:28672
    v_mfma_f32_16x16x32_bf16 v[216:219], a[184:187], a[16:19], v[216:219]
    s_waitcnt lgkmcnt(8)
    ds_read_b64_tr_b16 a[176:177], v26 offset:16384
    v_mfma_f32_16x16x32_bf16 v[216:219], a[188:191], a[24:27], v[216:219]
    ds_read_b64_tr_b16 a[178:179], v26 offset:20480
    v_mfma_f32_16x16x32_bf16 v[220:223], a[184:187], a[20:23], v[220:223]
    ds_read_b64_tr_b16 a[180:181], v26 offset:24576
    v_mfma_f32_16x16x32_bf16 v[220:223], a[188:191], a[28:31], v[220:223]
    s_waitcnt lgkmcnt(9)
    ds_read_b64_tr_b16 a[182:183], v26 offset:28672
    v_mfma_f32_16x16x32_bf16 v[224:227], a[160:163], a[16:19], v[224:227]
    s_waitcnt lgkmcnt(8)
    ds_read_b64_tr_b16 a[184:185], v27 offset:16384
    v_mfma_f32_16x16x32_bf16 v[224:227], a[164:167], a[24:27], v[224:227]
    ds_read_b64_tr_b16 a[186:187], v27 offset:20480
    v_mfma_f32_16x16x32_bf16 v[228:231], a[160:163], a[20:23], v[228:231]
    ds_read_b64_tr_b16 a[188:189], v27 offset:24576
    v_mfma_f32_16x16x32_bf16 v[228:231], a[164:167], a[28:31], v[228:231]
    s_waitcnt lgkmcnt(9)
    ds_read_b64_tr_b16 a[190:191], v27 offset:28672
    s_barrier
    v_mfma_f32_16x16x32_bf16 v[232:235], a[168:171], a[16:19], v[232:235]
    s_waitcnt lgkmcnt(8)
    ds_read_b64_tr_b16 a[160:161], v20 offset:32768
    v_mfma_f32_16x16x32_bf16 v[232:235], a[172:175], a[24:27], v[232:235]
    s_add_u32 s49, s44, 2097152
    ds_read_b64_tr_b16 a[162:163], v20 offset:36864
    v_mfma_f32_16x16x32_bf16 v[236:239], a[168:171], a[20:23], v[236:239]
    s_add_u32 m0, s42, 0
    ds_read_b64_tr_b16 a[164:165], v20 offset:40960
    v_mfma_f32_16x16x32_bf16 v[236:239], a[172:175], a[28:31], v[236:239]
    s_waitcnt lgkmcnt(9)
    buffer_load_dwordx4 v42, s[16:19], s49 offen lds
    v_mfma_f32_16x16x32_bf16 v[240:243], a[176:179], a[16:19], v[240:243]
    s_waitcnt lgkmcnt(7)
    ds_read_b64_tr_b16 a[166:167], v20 offset:45056
    ds_read_b64_tr_b16 a[168:169], v21 offset:32768
    v_mfma_f32_16x16x32_bf16 v[240:243], a[180:183], a[24:27], v[240:243]
Ltour0:
    s_cbranch_execz Ltour4
    ds_read_b64_tr_b16 a[170:171], v21 offset:36864
    v_mfma_f32_16x16x32_bf16 v[244:247], a[176:179], a[20:23], v[244:247]
    ds_read_b64_tr_b16 a[172:173], v21 offset:40960
    v_mfma_f32_16x16x32_bf16 v[244:247], a[180:183], a[28:31], v[244:247]
    s_waitcnt lgkmcnt(9)
    buffer_load_dwordx4 v43, s[16:19], s49 offen offset:1024 lds
    v_mfma_f32_16x16x32_bf16 v[248:251], a[184:187], a[16:19], v[248:251]
    s_waitcnt lgkmcnt(7)
    ds_read_b64_tr_b16 a[174:175], v21 offset:45056
    ds_read_b64_tr_b16 a[176:177], v22 offset:32768
    v_mfma_f32_16x16x32_bf16 v[248:251], a[188:191], a[24:27], v[248:251]
    ds_read_b64_tr_b16 a[178:179], v22 offset:36864
    v_mfma_f32_16x16x32_bf16 v[252:255], a[184:187], a[20:23], v[252:255]
    ds_read_b64_tr_b16 a[180:181], v22 offset:40960
    v_mfma_f32_16x16x32_bf16 v[252:255], a[188:191], a[28:31], v[252:255]
    s_waitcnt vmcnt(18)
    s_waitcnt lgkmcnt(9)
    buffer_load_dwordx4 v44, s[16:19], s49 offen offset:2048 lds
    v_mfma_f32_16x16x32_bf16 v[128:131], a[160:163], a[32:35], v[128:131]
    s_waitcnt vmcnt(18)
    s_waitcnt lgkmcnt(7)
    ds_read_b64_tr_b16 a[182:183], v22 offset:45056
    ds_read_b64_tr_b16 a[184:185], v23 offset:32768
    v_mfma_f32_16x16x32_bf16 v[128:131], a[164:167], a[40:43], v[128:131]
    s_waitcnt vmcnt(17)
    ds_read_b64_tr_b16 a[186:187], v23 offset:36864
    v_mfma_f32_16x16x32_bf16 v[132:135], a[160:163], a[36:39], v[132:135]
    s_waitcnt vmcnt(16)
    ds_read_b64_tr_b16 a[188:189], v23 offset:40960
    v_mfma_f32_16x16x32_bf16 v[132:135], a[164:167], a[44:47], v[132:135]
    s_waitcnt lgkmcnt(9)
    buffer_load_dwordx4 v45, s[16:19], s49 offen offset:3072 lds
    v_mfma_f32_16x16x32_bf16 v[136:139], a[168:171], a[32:35], v[136:139]
    s_waitcnt lgkmcnt(7)
    ds_read_b64_tr_b16 a[190:191], v23 offset:45056
    ds_read_b64_tr_b16 a[160:161], v24 offset:32768
    v_mfma_f32_16x16x32_bf16 v[136:139], a[172:175], a[40:43], v[136:139]
    s_add_u32 s49, s44, 2097408
    ds_read_b64_tr_b16 a[162:163], v24 offset:36864
    v_mfma_f32_16x16x32_bf16 v[140:143], a[168:171], a[36:39], v[140:143]
    s_add_u32 m0, s42, 16384
    ds_read_b64_tr_b16 a[164:165], v24 offset:40960
    v_mfma_f32_16x16x32_bf16 v[140:143], a[172:175], a[44:47], v[140:143]
    s_waitcnt lgkmcnt(9)
    buffer_load_dwordx4 v42, s[16:19], s49 offen lds
    v_mfma_f32_16x16x32_bf16 v[144:147], a[176:179], a[32:35], v[144:147]
    s_waitcnt lgkmcnt(7)
    ds_read_b64_tr_b16 a[166:167], v24 offset:45056
    ds_read_b64_tr_b16 a[168:169], v25 offset:32768
    v_mfma_f32_16x16x32_bf16 v[144:147], a[180:183], a[40:43], v[144:147]
    ds_read_b64_tr_b16 a[170:171], v25 offset:36864
    v_mfma_f32_16x16x32_bf16 v[148:151], a[176:179], a[36:39], v[148:151]
    ds_read_b64_tr_b16 a[172:173], v25 offset:40960
    v_mfma_f32_16x16x32_bf16 v[148:151], a[180:183], a[44:47], v[148:151]
    s_waitcnt lgkmcnt(9)
    buffer_load_dwordx4 v43, s[16:19], s49 offen offset:1024 lds
    v_mfma_f32_16x16x32_bf16 v[152:155], a[184:187], a[32:35], v[152:155]
    s_waitcnt lgkmcnt(7)
    ds_read_b64_tr_b16 a[174:175], v25 offset:45056
    ds_read_b64_tr_b16 a[176:177], v26 offset:32768
    v_mfma_f32_16x16x32_bf16 v[152:155], a[188:191], a[40:43], v[152:155]
    ds_read_b64_tr_b16 a[178:179], v26 offset:36864
    v_mfma_f32_16x16x32_bf16 v[156:159], a[184:187], a[36:39], v[156:159]
    ds_read_b64_tr_b16 a[180:181], v26 offset:40960
    v_mfma_f32_16x16x32_bf16 v[156:159], a[188:191], a[44:47], v[156:159]
    s_waitcnt lgkmcnt(9)
    buffer_load_dwordx4 v44, s[16:19], s49 offen offset:2048 lds
    v_mfma_f32_16x16x32_bf16 v[160:163], a[160:163], a[32:35], v[160:163]
    s_waitcnt lgkmcnt(7)
    ds_read_b64_tr_b16 a[182:183], v26 offset:45056
    ds_read_b64_tr_b16 a[184:185], v27 offset:32768
    v_mfma_f32_16x16x32_bf16 v[160:163], a[164:167], a[40:43], v[160:163]
    ds_read_b64_tr_b16 a[186:187], v27 offset:36864
    v_mfma_f32_16x16x32_bf16 v[164:167], a[160:163], a[36:39], v[164:167]
    ds_read_b64_tr_b16 a[188:189], v27 offset:40960
    v_mfma_f32_16x16x32_bf16 v[164:167], a[164:167], a[44:47], v[164:167]
    s_waitcnt lgkmcnt(9)
    buffer_load_dwordx4 v45, s[16:19], s49 offen offset:3072 lds
    v_mfma_f32_16x16x32_bf16 v[168:171], a[168:171], a[32:35], v[168:171]
    s_waitcnt lgkmcnt(7)
    ds_read_b64_tr_b16 a[190:191], v27 offset:45056
    ds_read_b64_tr_b16 a[160:161], v20 offset:49152
    v_mfma_f32_16x16x32_bf16 v[168:171], a[172:175], a[40:43], v[168:171]
    ds_read_b64_tr_b16 a[162:163], v20 offset:53248
    v_mfma_f32_16x16x32_bf16 v[172:175], a[168:171], a[36:39], v[172:175]
    ds_read_b64_tr_b16 a[164:165], v20 offset:57344
    v_mfma_f32_16x16x32_bf16 v[172:175], a[172:175], a[44:47], v[172:175]
    s_waitcnt lgkmcnt(9)
    buffer_load_dwordx4 a[64:67], v51, s[24:27], s46 offen offset:1024 sc1
    v_mfma_f32_16x16x32_bf16 v[176:179], a[176:179], a[32:35], v[176:179]
    s_waitcnt lgkmcnt(7)
    ds_read_b64_tr_b16 a[166:167], v20 offset:61440
    ds_read_b64_tr_b16 a[168:169], v21 offset:49152
    v_mfma_f32_16x16x32_bf16 v[176:179], a[180:183], a[40:43], v[176:179]
    ds_read_b64_tr_b16 a[170:171], v21 offset:53248
    v_mfma_f32_16x16x32_bf16 v[180:183], a[176:179], a[36:39], v[180:183]
    ds_read_b64_tr_b16 a[172:173], v21 offset:57344
    v_mfma_f32_16x16x32_bf16 v[180:183], a[180:183], a[44:47], v[180:183]
    s_waitcnt lgkmcnt(9)
    buffer_load_dwordx4 a[72:75], v51, s[24:27], s46 offen offset:1152 sc1
    v_mfma_f32_16x16x32_bf16 v[184:187], a[184:187], a[32:35], v[184:187]
    s_waitcnt lgkmcnt(7)
    ds_read_b64_tr_b16 a[174:175], v21 offset:61440
    ds_read_b64_tr_b16 a[176:177], v22 offset:49152
    v_mfma_f32_16x16x32_bf16 v[184:187], a[188:191], a[40:43], v[184:187]
    ds_read_b64_tr_b16 a[178:179], v22 offset:53248
    v_mfma_f32_16x16x32_bf16 v[188:191], a[184:187], a[36:39], v[188:191]
    ds_read_b64_tr_b16 a[180:181], v22 offset:57344
    v_mfma_f32_16x16x32_bf16 v[188:191], a[188:191], a[44:47], v[188:191]
    s_waitcnt lgkmcnt(9)
    buffer_load_dwordx4 a[68:71], v51, s[24:27], s43 offen offset:1024 sc1
    v_mfma_f32_16x16x32_bf16 v[192:195], a[160:163], a[32:35], v[192:195]
    s_waitcnt lgkmcnt(7)
    ds_read_b64_tr_b16 a[182:183], v22 offset:61440
    ds_read_b64_tr_b16 a[184:185], v23 offset:49152
    v_mfma_f32_16x16x32_bf16 v[192:195], a[164:167], a[40:43], v[192:195]
    ds_read_b64_tr_b16 a[186:187], v23 offset:53248
    v_mfma_f32_16x16x32_bf16 v[196:199], a[160:163], a[36:39], v[196:199]
    ds_read_b64_tr_b16 a[188:189], v23 offset:57344
    v_mfma_f32_16x16x32_bf16 v[196:199], a[164:167], a[44:47], v[196:199]
    s_waitcnt lgkmcnt(9)
    buffer_load_dwordx4 a[76:79], v51, s[24:27], s43 offen offset:1152 sc1
    v_mfma_f32_16x16x32_bf16 v[200:203], a[168:171], a[32:35], v[200:203]
    s_waitcnt lgkmcnt(7)
    ds_read_b64_tr_b16 a[190:191], v23 offset:61440
    ds_read_b64_tr_b16 a[160:161], v24 offset:49152
    v_mfma_f32_16x16x32_bf16 v[200:203], a[172:175], a[40:43], v[200:203]
    ds_read_b64_tr_b16 a[162:163], v24 offset:53248
    v_mfma_f32_16x16x32_bf16 v[204:207], a[168:171], a[36:39], v[204:207]
    ds_read_b64_tr_b16 a[164:165], v24 offset:57344
    v_mfma_f32_16x16x32_bf16 v[204:207], a[172:175], a[44:47], v[204:207]
    s_waitcnt lgkmcnt(9)
    ds_read_b64_tr_b16 a[166:167], v24 offset:61440
    v_mfma_f32_16x16x32_bf16 v[208:211], a[176:179], a[32:35], v[208:211]
    s_waitcnt lgkmcnt(8)
    ds_read_b64_tr_b16 a[168:169], v25 offset:49152
    v_mfma_f32_16x16x32_bf16 v[208:211], a[180:183], a[40:43], v[208:211]
    ds_read_b64_tr_b16 a[170:171], v25 offset:53248
    v_mfma_f32_16x16x32_bf16 v[212:215], a[176:179], a[36:39], v[212:215]
    ds_read_b64_tr_b16 a[172:173], v25 offset:57344
    v_mfma_f32_16x16x32_bf16 v[212:215], a[180:183], a[44:47], v[212:215]
    s_waitcnt lgkmcnt(9)
    ds_read_b64_tr_b16 a[174:175], v25 offset:61440
    v_mfma_f32_16x16x32_bf16 v[216:219], a[184:187], a[32:35], v[216:219]
    s_waitcnt lgkmcnt(8)
    ds_read_b64_tr_b16 a[176:177], v26 offset:49152
    v_mfma_f32_16x16x32_bf16 v[216:219], a[188:191], a[40:43], v[216:219]
    ds_read_b64_tr_b16 a[178:179], v26 offset:53248
    v_mfma_f32_16x16x32_bf16 v[220:223], a[184:187], a[36:39], v[220:223]
    ds_read_b64_tr_b16 a[180:181], v26 offset:57344
    v_mfma_f32_16x16x32_bf16 v[220:223], a[188:191], a[44:47], v[220:223]
    s_waitcnt lgkmcnt(9)
    ds_read_b64_tr_b16 a[182:183], v26 offset:61440
    v_mfma_f32_16x16x32_bf16 v[224:227], a[160:163], a[32:35], v[224:227]
    s_waitcnt lgkmcnt(8)
    ds_read_b64_tr_b16 a[184:185], v27 offset:49152
    v_mfma_f32_16x16x32_bf16 v[224:227], a[164:167], a[40:43], v[224:227]
    ds_read_b64_tr_b16 a[186:187], v27 offset:53248
    v_mfma_f32_16x16x32_bf16 v[228:231], a[160:163], a[36:39], v[228:231]
    ds_read_b64_tr_b16 a[188:189], v27 offset:57344
    v_mfma_f32_16x16x32_bf16 v[228:231], a[164:167], a[44:47], v[228:231]
    s_waitcnt lgkmcnt(9)
    ds_read_b64_tr_b16 a[190:191], v27 offset:61440
    s_waitcnt vmcnt(16)
    s_barrier
    v_mfma_f32_16x16x32_bf16 v[232:235], a[168:171], a[32:35], v[232:235]
    s_waitcnt lgkmcnt(8)
    ds_read_b64_tr_b16 a[160:161], v28 offset:0
    v_mfma_f32_16x16x32_bf16 v[232:235], a[172:175], a[40:43], v[232:235]
    s_add_u32 s49, s44, 2621440
    ds_read_b64_tr_b16 a[162:163], v28 offset:4096
    v_mfma_f32_16x16x32_bf16 v[236:239], a[168:171], a[36:39], v[236:239]
    s_add_u32 m0, s42, 32768
    ds_read_b64_tr_b16 a[164:165], v28 offset:8192
    v_mfma_f32_16x16x32_bf16 v[236:239], a[172:175], a[44:47], v[236:239]
    s_waitcnt lgkmcnt(9)
    buffer_load_dwordx4 v42, s[16:19], s49 offen lds
    v_mfma_f32_16x16x32_bf16 v[240:243], a[176:179], a[32:35], v[240:243]
    s_waitcnt lgkmcnt(7)
    ds_read_b64_tr_b16 a[166:167], v28 offset:12288
    ds_read_b64_tr_b16 a[168:169], v29 offset:0
    v_mfma_f32_16x16x32_bf16 v[240:243], a[180:183], a[40:43], v[240:243]
    ds_read_b64_tr_b16 a[170:171], v29 offset:4096
    v_mfma_f32_16x16x32_bf16 v[244:247], a[176:179], a[36:39], v[244:247]
    ds_read_b64_tr_b16 a[172:173], v29 offset:8192
    v_mfma_f32_16x16x32_bf16 v[244:247], a[180:183], a[44:47], v[244:247]
    s_waitcnt lgkmcnt(9)
    buffer_load_dwordx4 v43, s[16:19], s49 offen offset:1024 lds
    v_mfma_f32_16x16x32_bf16 v[248:251], a[184:187], a[32:35], v[248:251]
    s_waitcnt lgkmcnt(7)
    ds_read_b64_tr_b16 a[174:175], v29 offset:12288
    ds_read_b64_tr_b16 a[176:177], v30 offset:0
    v_mfma_f32_16x16x32_bf16 v[248:251], a[188:191], a[40:43], v[248:251]
    ds_read_b64_tr_b16 a[178:179], v30 offset:4096
    v_mfma_f32_16x16x32_bf16 v[252:255], a[184:187], a[36:39], v[252:255]
    ds_read_b64_tr_b16 a[180:181], v30 offset:8192
    v_mfma_f32_16x16x32_bf16 v[252:255], a[188:191], a[44:47], v[252:255]
    s_waitcnt vmcnt(17)
    s_waitcnt lgkmcnt(9)
    buffer_load_dwordx4 v44, s[16:19], s49 offen offset:2048 lds
    v_mfma_f32_16x16x32_bf16 v[128:131], a[160:163], a[48:51], v[128:131]
    s_waitcnt vmcnt(17)
    s_waitcnt lgkmcnt(7)
    ds_read_b64_tr_b16 a[182:183], v30 offset:12288
    ds_read_b64_tr_b16 a[184:185], v31 offset:0
    v_mfma_f32_16x16x32_bf16 v[128:131], a[164:167], a[56:59], v[128:131]
    s_waitcnt vmcnt(16)
    ds_read_b64_tr_b16 a[186:187], v31 offset:4096
    v_mfma_f32_16x16x32_bf16 v[132:135], a[160:163], a[52:55], v[132:135]
    s_waitcnt vmcnt(15)
    ds_read_b64_tr_b16 a[188:189], v31 offset:8192
    v_mfma_f32_16x16x32_bf16 v[132:135], a[164:167], a[60:63], v[132:135]
    s_waitcnt lgkmcnt(9)
    buffer_load_dwordx4 v45, s[16:19], s49 offen offset:3072 lds
    v_mfma_f32_16x16x32_bf16 v[136:139], a[168:171], a[48:51], v[136:139]
    s_waitcnt lgkmcnt(7)
    ds_read_b64_tr_b16 a[190:191], v31 offset:12288
    ds_read_b64_tr_b16 a[160:161], v32 offset:0
    v_mfma_f32_16x16x32_bf16 v[136:139], a[172:175], a[56:59], v[136:139]
    s_add_u32 s49, s44, 2621696
    ds_read_b64_tr_b16 a[162:163], v32 offset:4096
    v_mfma_f32_16x16x32_bf16 v[140:143], a[168:171], a[52:55], v[140:143]
    s_add_u32 m0, s42, 49152
    ds_read_b64_tr_b16 a[164:165], v32 offset:8192
    v_mfma_f32_16x16x32_bf16 v[140:143], a[172:175], a[60:63], v[140:143]
    s_waitcnt lgkmcnt(9)
    buffer_load_dwordx4 v42, s[16:19], s49 offen lds
    v_mfma_f32_16x16x32_bf16 v[144:147], a[176:179], a[48:51], v[144:147]
    s_waitcnt lgkmcnt(7)
    ds_read_b64_tr_b16 a[166:167], v32 offset:12288
    ds_read_b64_tr_b16 a[168:169], v33 offset:0
    v_mfma_f32_16x16x32_bf16 v[144:147], a[180:183], a[56:59], v[144:147]
    ds_read_b64_tr_b16 a[170:171], v33 offset:4096
    v_mfma_f32_16x16x32_bf16 v[148:151], a[176:179], a[52:55], v[148:151]
    ds_read_b64_tr_b16 a[172:173], v33 offset:8192
    v_mfma_f32_16x16x32_bf16 v[148:151], a[180:183], a[60:63], v[148:151]
    s_waitcnt lgkmcnt(9)
    buffer_load_dwordx4 v43, s[16:19], s49 offen offset:1024 lds
    v_mfma_f32_16x16x32_bf16 v[152:155], a[184:187], a[48:51], v[152:155]
    s_waitcnt lgkmcnt(7)
    ds_read_b64_tr_b16 a[174:175], v33 offset:12288
    ds_read_b64_tr_b16 a[176:177], v34 offset:0
    v_mfma_f32_16x16x32_bf16 v[152:155], a[188:191], a[56:59], v[152:155]
    ds_read_b64_tr_b16 a[178:179], v34 offset:4096
    v_mfma_f32_16x16x32_bf16 v[156:159], a[184:187], a[52:55], v[156:159]
    ds_read_b64_tr_b16 a[180:181], v34 offset:8192
    v_mfma_f32_16x16x32_bf16 v[156:159], a[188:191], a[60:63], v[156:159]
    s_waitcnt lgkmcnt(9)
    buffer_load_dwordx4 v44, s[16:19], s49 offen offset:2048 lds
    v_mfma_f32_16x16x32_bf16 v[160:163], a[160:163], a[48:51], v[160:163]
    s_waitcnt lgkmcnt(7)
    ds_read_b64_tr_b16 a[182:183], v34 offset:12288
    ds_read_b64_tr_b16 a[184:185], v35 offset:0
    v_mfma_f32_16x16x32_bf16 v[160:163], a[164:167], a[56:59], v[160:163]
    ds_read_b64_tr_b16 a[186:187], v35 offset:4096
    v_mfma_f32_16x16x32_bf16 v[164:167], a[160:163], a[52:55], v[164:167]
    ds_read_b64_tr_b16 a[188:189], v35 offset:8192
    v_mfma_f32_16x16x32_bf16 v[164:167], a[164:167], a[60:63], v[164:167]
    s_waitcnt lgkmcnt(9)
    buffer_load_dwordx4 v45, s[16:19], s49 offen offset:3072 lds
    v_mfma_f32_16x16x32_bf16 v[168:171], a[168:171], a[48:51], v[168:171]
    s_waitcnt lgkmcnt(7)
    ds_read_b64_tr_b16 a[190:191], v35 offset:12288
    ds_read_b64_tr_b16 a[160:161], v28 offset:16384
    v_mfma_f32_16x16x32_bf16 v[168:171], a[172:175], a[56:59], v[168:171]
    ds_read_b64_tr_b16 a[162:163], v28 offset:20480
    v_mfma_f32_16x16x32_bf16 v[172:175], a[168:171], a[52:55], v[172:175]
    ds_read_b64_tr_b16 a[164:165], v28 offset:24576
    v_mfma_f32_16x16x32_bf16 v[172:175], a[172:175], a[60:63], v[172:175]
    s_waitcnt lgkmcnt(9)
    buffer_load_dwordx4 a[80:83], v51, s[24:27], s46 offen offset:1280 sc1
    v_mfma_f32_16x16x32_bf16 v[176:179], a[176:179], a[48:51], v[176:179]
    s_waitcnt lgkmcnt(7)
    ds_read_b64_tr_b16 a[166:167], v28 offset:28672
    ds_read_b64_tr_b16 a[168:169], v29 offset:16384
    v_mfma_f32_16x16x32_bf16 v[176:179], a[180:183], a[56:59], v[176:179]
    ds_read_b64_tr_b16 a[170:171], v29 offset:20480
    v_mfma_f32_16x16x32_bf16 v[180:183], a[176:179], a[52:55], v[180:183]
    ds_read_b64_tr_b16 a[172:173], v29 offset:24576
    v_mfma_f32_16x16x32_bf16 v[180:183], a[180:183], a[60:63], v[180:183]
    s_waitcnt lgkmcnt(9)
    buffer_load_dwordx4 a[88:91], v51, s[24:27], s46 offen offset:1408 sc1
    v_mfma_f32_16x16x32_bf16 v[184:187], a[184:187], a[48:51], v[184:187]
    s_waitcnt lgkmcnt(7)
    ds_read_b64_tr_b16 a[174:175], v29 offset:28672
    ds_read_b64_tr_b16 a[176:177], v30 offset:16384
    v_mfma_f32_16x16x32_bf16 v[184:187], a[188:191], a[56:59], v[184:187]
    ds_read_b64_tr_b16 a[178:179], v30 offset:20480
    v_mfma_f32_16x16x32_bf16 v[188:191], a[184:187], a[52:55], v[188:191]
    ds_read_b64_tr_b16 a[180:181], v30 offset:24576
    v_mfma_f32_16x16x32_bf16 v[188:191], a[188:191], a[60:63], v[188:191]
    s_waitcnt lgkmcnt(9)
    buffer_load_dwordx4 a[84:87], v51, s[24:27], s43 offen offset:1280 sc1
    v_mfma_f32_16x16x32_bf16 v[192:195], a[160:163], a[48:51], v[192:195]
    s_waitcnt lgkmcnt(7)
    ds_read_b64_tr_b16 a[182:183], v30 offset:28672
    ds_read_b64_tr_b16 a[184:185], v31 offset:16384
    v_mfma_f32_16x16x32_bf16 v[192:195], a[164:167], a[56:59], v[192:195]
    ds_read_b64_tr_b16 a[186:187], v31 offset:20480
    v_mfma_f32_16x16x32_bf16 v[196:199], a[160:163], a[52:55], v[196:199]
    ds_read_b64_tr_b16 a[188:189], v31 offset:24576
    v_mfma_f32_16x16x32_bf16 v[196:199], a[164:167], a[60:63], v[196:199]
    s_waitcnt lgkmcnt(9)
    buffer_load_dwordx4 a[92:95], v51, s[24:27], s43 offen offset:1408 sc1
    v_mfma_f32_16x16x32_bf16 v[200:203], a[168:171], a[48:51], v[200:203]
    s_waitcnt lgkmcnt(7)
    ds_read_b64_tr_b16 a[190:191], v31 offset:28672
    ds_read_b64_tr_b16 a[160:161], v32 offset:16384
    v_mfma_f32_16x16x32_bf16 v[200:203], a[172:175], a[56:59], v[200:203]
    ds_read_b64_tr_b16 a[162:163], v32 offset:20480
    v_mfma_f32_16x16x32_bf16 v[204:207], a[168:171], a[52:55], v[204:207]
    ds_read_b64_tr_b16 a[164:165], v32 offset:24576
    v_mfma_f32_16x16x32_bf16 v[204:207], a[172:175], a[60:63], v[204:207]
    s_waitcnt lgkmcnt(9)
    buffer_load_dword v78, v120, s[8:11], 0 offen
    v_mfma_f32_16x16x32_bf16 v[208:211], a[176:179], a[48:51], v[208:211]
    s_waitcnt lgkmcnt(7)
    ds_read_b64_tr_b16 a[166:167], v32 offset:28672
    ds_read_b64_tr_b16 a[168:169], v33 offset:16384
    v_mfma_f32_16x16x32_bf16 v[208:211], a[180:183], a[56:59], v[208:211]
    ds_read_b64_tr_b16 a[170:171], v33 offset:20480
    v_mfma_f32_16x16x32_bf16 v[212:215], a[176:179], a[52:55], v[212:215]
    ds_read_b64_tr_b16 a[172:173], v33 offset:24576
    v_mfma_f32_16x16x32_bf16 v[212:215], a[180:183], a[60:63], v[212:215]
    s_waitcnt lgkmcnt(9)
    buffer_load_dword v79, v121, s[12:15], 0 offen
    v_mfma_f32_16x16x32_bf16 v[216:219], a[184:187], a[48:51], v[216:219]
    s_waitcnt lgkmcnt(7)
    ds_read_b64_tr_b16 a[174:175], v33 offset:28672
    ds_read_b64_tr_b16 a[176:177], v34 offset:16384
    v_mfma_f32_16x16x32_bf16 v[216:219], a[188:191], a[56:59], v[216:219]
    ds_read_b64_tr_b16 a[178:179], v34 offset:20480
    v_mfma_f32_16x16x32_bf16 v[220:223], a[184:187], a[52:55], v[220:223]
    ds_read_b64_tr_b16 a[180:181], v34 offset:24576
    v_mfma_f32_16x16x32_bf16 v[220:223], a[188:191], a[60:63], v[220:223]
    s_waitcnt lgkmcnt(9)
    ds_read_b64_tr_b16 a[182:183], v34 offset:28672
    v_mfma_f32_16x16x32_bf16 v[224:227], a[160:163], a[48:51], v[224:227]
    s_waitcnt lgkmcnt(8)
    ds_read_b64_tr_b16 a[184:185], v35 offset:16384
    v_mfma_f32_16x16x32_bf16 v[224:227], a[164:167], a[56:59], v[224:227]
    ds_read_b64_tr_b16 a[186:187], v35 offset:20480
    v_mfma_f32_16x16x32_bf16 v[228:231], a[160:163], a[52:55], v[228:231]
    ds_read_b64_tr_b16 a[188:189], v35 offset:24576
    v_mfma_f32_16x16x32_bf16 v[228:231], a[164:167], a[60:63], v[228:231]
    s_waitcnt lgkmcnt(9)
    ds_read_b64_tr_b16 a[190:191], v35 offset:28672
    s_waitcnt vmcnt(18)
    s_barrier
    v_mfma_f32_16x16x32_bf16 v[232:235], a[168:171], a[48:51], v[232:235]
    s_waitcnt lgkmcnt(8)
    ds_read_b64_tr_b16 a[160:161], v12 offset:0
    v_mfma_f32_16x16x32_bf16 v[232:235], a[172:175], a[56:59], v[232:235]
    s_add_u32 s49, s44, 3145728
    ds_read_b64_tr_b16 a[162:163], v12 offset:4096
    v_mfma_f32_16x16x32_bf16 v[236:239], a[168:171], a[52:55], v[236:239]
    s_add_u32 m0, s42, 65536
    ds_read_b64_tr_b16 a[164:165], v12 offset:8192
    v_mfma_f32_16x16x32_bf16 v[236:239], a[172:175], a[60:63], v[236:239]
    s_waitcnt lgkmcnt(9)
    buffer_load_dwordx4 v42, s[16:19], s49 offen lds
    v_mfma_f32_16x16x32_bf16 v[240:243], a[176:179], a[48:51], v[240:243]
    s_waitcnt lgkmcnt(7)
    ds_read_b64_tr_b16 a[166:167], v12 offset:12288
    ds_read_b64_tr_b16 a[168:169], v13 offset:0
    v_mfma_f32_16x16x32_bf16 v[240:243], a[180:183], a[56:59], v[240:243]
    ds_read_b64_tr_b16 a[170:171], v13 offset:4096
    v_mfma_f32_16x16x32_bf16 v[244:247], a[176:179], a[52:55], v[244:247]
    ds_read_b64_tr_b16 a[172:173], v13 offset:8192
    v_mfma_f32_16x16x32_bf16 v[244:247], a[180:183], a[60:63], v[244:247]
    s_waitcnt lgkmcnt(9)
    buffer_load_dwordx4 v43, s[16:19], s49 offen offset:1024 lds
    v_mfma_f32_16x16x32_bf16 v[248:251], a[184:187], a[48:51], v[248:251]
    s_waitcnt lgkmcnt(7)
    ds_read_b64_tr_b16 a[174:175], v13 offset:12288
    ds_read_b64_tr_b16 a[176:177], v14 offset:0
    v_mfma_f32_16x16x32_bf16 v[248:251], a[188:191], a[56:59], v[248:251]
    ds_read_b64_tr_b16 a[178:179], v14 offset:4096
    v_mfma_f32_16x16x32_bf16 v[252:255], a[184:187], a[52:55], v[252:255]
    ds_read_b64_tr_b16 a[180:181], v14 offset:8192
    v_mfma_f32_16x16x32_bf16 v[252:255], a[188:191], a[60:63], v[252:255]
    s_waitcnt vmcnt(19)
    s_waitcnt lgkmcnt(9)
    buffer_load_dwordx4 v44, s[16:19], s49 offen offset:2048 lds
    v_mfma_f32_16x16x32_bf16 v[128:131], a[160:163], a[64:67], v[128:131]
    s_waitcnt vmcnt(19)
    s_waitcnt lgkmcnt(7)
    ds_read_b64_tr_b16 a[182:183], v14 offset:12288
    ds_read_b64_tr_b16 a[184:185], v15 offset:0
    v_mfma_f32_16x16x32_bf16 v[128:131], a[164:167], a[72:75], v[128:131]
    s_waitcnt vmcnt(18)
    ds_read_b64_tr_b16 a[186:187], v15 offset:4096
    v_mfma_f32_16x16x32_bf16 v[132:135], a[160:163], a[68:71], v[132:135]
    s_waitcnt vmcnt(17)
    ds_read_b64_tr_b16 a[188:189], v15 offset:8192
    v_mfma_f32_16x16x32_bf16 v[132:135], a[164:167], a[76:79], v[132:135]
    s_waitcnt lgkmcnt(9)
    buffer_load_dwordx4 v45, s[16:19], s49 offen offset:3072 lds
    v_mfma_f32_16x16x32_bf16 v[136:139], a[168:171], a[64:67], v[136:139]
    s_waitcnt lgkmcnt(7)
    ds_read_b64_tr_b16 a[190:191], v15 offset:12288
    ds_read_b64_tr_b16 a[160:161], v16 offset:0
    v_mfma_f32_16x16x32_bf16 v[136:139], a[172:175], a[72:75], v[136:139]
    s_add_u32 s49, s44, 3145984
    ds_read_b64_tr_b16 a[162:163], v16 offset:4096
    v_mfma_f32_16x16x32_bf16 v[140:143], a[168:171], a[68:71], v[140:143]
    s_add_u32 m0, s42, 81920
    ds_read_b64_tr_b16 a[164:165], v16 offset:8192
    v_mfma_f32_16x16x32_bf16 v[140:143], a[172:175], a[76:79], v[140:143]
    s_waitcnt lgkmcnt(9)
    buffer_load_dwordx4 v42, s[16:19], s49 offen lds
    v_mfma_f32_16x16x32_bf16 v[144:147], a[176:179], a[64:67], v[144:147]
    s_waitcnt lgkmcnt(7)
    ds_read_b64_tr_b16 a[166:167], v16 offset:12288
    ds_read_b64_tr_b16 a[168:169], v17 offset:0
    v_mfma_f32_16x16x32_bf16 v[144:147], a[180:183], a[72:75], v[144:147]
    ds_read_b64_tr_b16 a[170:171], v17 offset:4096
    v_mfma_f32_16x16x32_bf16 v[148:151], a[176:179], a[68:71], v[148:151]
    ds_read_b64_tr_b16 a[172:173], v17 offset:8192
    v_mfma_f32_16x16x32_bf16 v[148:151], a[180:183], a[76:79], v[148:151]
    s_waitcnt lgkmcnt(9)
    buffer_load_dwordx4 v43, s[16:19], s49 offen offset:1024 lds
    v_mfma_f32_16x16x32_bf16 v[152:155], a[184:187], a[64:67], v[152:155]
    s_waitcnt lgkmcnt(7)
    ds_read_b64_tr_b16 a[174:175], v17 offset:12288
    ds_read_b64_tr_b16 a[176:177], v18 offset:0
    v_mfma_f32_16x16x32_bf16 v[152:155], a[188:191], a[72:75], v[152:155]
    ds_read_b64_tr_b16 a[178:179], v18 offset:4096
    v_mfma_f32_16x16x32_bf16 v[156:159], a[184:187], a[68:71], v[156:159]
    ds_read_b64_tr_b16 a[180:181], v18 offset:8192
    v_mfma_f32_16x16x32_bf16 v[156:159], a[188:191], a[76:79], v[156:159]
    s_waitcnt lgkmcnt(9)
    buffer_load_dwordx4 v44, s[16:19], s49 offen offset:2048 lds
    v_mfma_f32_16x16x32_bf16 v[160:163], a[160:163], a[64:67], v[160:163]
    s_waitcnt lgkmcnt(7)
    ds_read_b64_tr_b16 a[182:183], v18 offset:12288
    ds_read_b64_tr_b16 a[184:185], v19 offset:0
    v_mfma_f32_16x16x32_bf16 v[160:163], a[164:167], a[72:75], v[160:163]
    ds_read_b64_tr_b16 a[186:187], v19 offset:4096
    v_mfma_f32_16x16x32_bf16 v[164:167], a[160:163], a[68:71], v[164:167]
    ds_read_b64_tr_b16 a[188:189], v19 offset:8192
    v_mfma_f32_16x16x32_bf16 v[164:167], a[164:167], a[76:79], v[164:167]
    s_waitcnt lgkmcnt(9)
    buffer_load_dwordx4 v45, s[16:19], s49 offen offset:3072 lds
    v_mfma_f32_16x16x32_bf16 v[168:171], a[168:171], a[64:67], v[168:171]
    s_waitcnt lgkmcnt(7)
    ds_read_b64_tr_b16 a[190:191], v19 offset:12288
    ds_read_b64_tr_b16 a[160:161], v12 offset:16384
    v_mfma_f32_16x16x32_bf16 v[168:171], a[172:175], a[72:75], v[168:171]
    ds_read_b64_tr_b16 a[162:163], v12 offset:20480
    v_mfma_f32_16x16x32_bf16 v[172:175], a[168:171], a[68:71], v[172:175]
    ds_read_b64_tr_b16 a[164:165], v12 offset:24576
    v_mfma_f32_16x16x32_bf16 v[172:175], a[172:175], a[76:79], v[172:175]
    s_waitcnt lgkmcnt(9)
    buffer_load_dwordx4 a[96:99], v51, s[24:27], s46 offen offset:1536 sc1
    v_mfma_f32_16x16x32_bf16 v[176:179], a[176:179], a[64:67], v[176:179]
    s_waitcnt lgkmcnt(7)
    ds_read_b64_tr_b16 a[166:167], v12 offset:28672
    ds_read_b64_tr_b16 a[168:169], v13 offset:16384
    v_mfma_f32_16x16x32_bf16 v[176:179], a[180:183], a[72:75], v[176:179]
    ds_read_b64_tr_b16 a[170:171], v13 offset:20480
    v_mfma_f32_16x16x32_bf16 v[180:183], a[176:179], a[68:71], v[180:183]
    ds_read_b64_tr_b16 a[172:173], v13 offset:24576
    v_mfma_f32_16x16x32_bf16 v[180:183], a[180:183], a[76:79], v[180:183]
    s_waitcnt lgkmcnt(9)
    buffer_load_dwordx4 a[104:107], v51, s[24:27], s46 offen offset:1664 sc1
    v_mfma_f32_16x16x32_bf16 v[184:187], a[184:187], a[64:67], v[184:187]
    s_waitcnt lgkmcnt(7)
    ds_read_b64_tr_b16 a[174:175], v13 offset:28672
    ds_read_b64_tr_b16 a[176:177], v14 offset:16384
    v_mfma_f32_16x16x32_bf16 v[184:187], a[188:191], a[72:75], v[184:187]
    ds_read_b64_tr_b16 a[178:179], v14 offset:20480
    v_mfma_f32_16x16x32_bf16 v[188:191], a[184:187], a[68:71], v[188:191]
    ds_read_b64_tr_b16 a[180:181], v14 offset:24576
    v_mfma_f32_16x16x32_bf16 v[188:191], a[188:191], a[76:79], v[188:191]
    s_waitcnt lgkmcnt(9)
    buffer_load_dwordx4 a[100:103], v51, s[24:27], s43 offen offset:1536 sc1
    v_mfma_f32_16x16x32_bf16 v[192:195], a[160:163], a[64:67], v[192:195]
    s_waitcnt lgkmcnt(7)
    ds_read_b64_tr_b16 a[182:183], v14 offset:28672
    ds_read_b64_tr_b16 a[184:185], v15 offset:16384
    v_mfma_f32_16x16x32_bf16 v[192:195], a[164:167], a[72:75], v[192:195]
    ds_read_b64_tr_b16 a[186:187], v15 offset:20480
    v_mfma_f32_16x16x32_bf16 v[196:199], a[160:163], a[68:71], v[196:199]
    ds_read_b64_tr_b16 a[188:189], v15 offset:24576
    v_mfma_f32_16x16x32_bf16 v[196:199], a[164:167], a[76:79], v[196:199]
    s_waitcnt lgkmcnt(9)
    buffer_load_dwordx4 a[108:111], v51, s[24:27], s43 offen offset:1664 sc1
    v_mfma_f32_16x16x32_bf16 v[200:203], a[168:171], a[64:67], v[200:203]
    s_waitcnt lgkmcnt(7)
    ds_read_b64_tr_b16 a[190:191], v15 offset:28672
    ds_read_b64_tr_b16 a[160:161], v16 offset:16384
    v_mfma_f32_16x16x32_bf16 v[200:203], a[172:175], a[72:75], v[200:203]
    ds_read_b64_tr_b16 a[162:163], v16 offset:20480
    v_mfma_f32_16x16x32_bf16 v[204:207], a[168:171], a[68:71], v[204:207]
    ds_read_b64_tr_b16 a[164:165], v16 offset:24576
    v_mfma_f32_16x16x32_bf16 v[204:207], a[172:175], a[76:79], v[204:207]
    s_waitcnt lgkmcnt(9)
    ds_read_b64_tr_b16 a[166:167], v16 offset:28672
    v_mfma_f32_16x16x32_bf16 v[208:211], a[176:179], a[64:67], v[208:211]
    s_waitcnt lgkmcnt(8)
    ds_read_b64_tr_b16 a[168:169], v17 offset:16384
    v_mfma_f32_16x16x32_bf16 v[208:211], a[180:183], a[72:75], v[208:211]
    ds_read_b64_tr_b16 a[170:171], v17 offset:20480
    v_mfma_f32_16x16x32_bf16 v[212:215], a[176:179], a[68:71], v[212:215]
    ds_read_b64_tr_b16 a[172:173], v17 offset:24576
    v_mfma_f32_16x16x32_bf16 v[212:215], a[180:183], a[76:79], v[212:215]
    s_waitcnt lgkmcnt(9)
    ds_read_b64_tr_b16 a[174:175], v17 offset:28672
    v_mfma_f32_16x16x32_bf16 v[216:219], a[184:187], a[64:67], v[216:219]
    s_waitcnt lgkmcnt(8)
    ds_read_b64_tr_b16 a[176:177], v18 offset:16384
    v_mfma_f32_16x16x32_bf16 v[216:219], a[188:191], a[72:75], v[216:219]
    ds_read_b64_tr_b16 a[178:179], v18 offset:20480
    v_mfma_f32_16x16x32_bf16 v[220:223], a[184:187], a[68:71], v[220:223]
    ds_read_b64_tr_b16 a[180:181], v18 offset:24576
    v_mfma_f32_16x16x32_bf16 v[220:223], a[188:191], a[76:79], v[220:223]
    s_waitcnt lgkmcnt(9)
    ds_read_b64_tr_b16 a[182:183], v18 offset:28672
    v_mfma_f32_16x16x32_bf16 v[224:227], a[160:163], a[64:67], v[224:227]
    s_waitcnt lgkmcnt(8)
    ds_read_b64_tr_b16 a[184:185], v19 offset:16384
    v_mfma_f32_16x16x32_bf16 v[224:227], a[164:167], a[72:75], v[224:227]
    ds_read_b64_tr_b16 a[186:187], v19 offset:20480
    v_mfma_f32_16x16x32_bf16 v[228:231], a[160:163], a[68:71], v[228:231]
    ds_read_b64_tr_b16 a[188:189], v19 offset:24576
    v_mfma_f32_16x16x32_bf16 v[228:231], a[164:167], a[76:79], v[228:231]
    s_waitcnt lgkmcnt(9)
    ds_read_b64_tr_b16 a[190:191], v19 offset:28672
    s_waitcnt vmcnt(18)
    s_barrier
    v_mfma_f32_16x16x32_bf16 v[232:235], a[168:171], a[64:67], v[232:235]
    s_waitcnt lgkmcnt(8)
    ds_read_b64_tr_b16 a[160:161], v12 offset:32768
    v_mfma_f32_16x16x32_bf16 v[232:235], a[172:175], a[72:75], v[232:235]
    s_add_u32 s49, s44, 3670016
    ds_read_b64_tr_b16 a[162:163], v12 offset:36864
    v_mfma_f32_16x16x32_bf16 v[236:239], a[168:171], a[68:71], v[236:239]
    s_add_u32 m0, s42, 98304
    ds_read_b64_tr_b16 a[164:165], v12 offset:40960
    v_mfma_f32_16x16x32_bf16 v[236:239], a[172:175], a[76:79], v[236:239]
    s_waitcnt lgkmcnt(9)
    buffer_load_dwordx4 v42, s[16:19], s49 offen lds
    v_mfma_f32_16x16x32_bf16 v[240:243], a[176:179], a[64:67], v[240:243]
    s_waitcnt lgkmcnt(7)
    ds_read_b64_tr_b16 a[166:167], v12 offset:45056
    ds_read_b64_tr_b16 a[168:169], v13 offset:32768
    v_mfma_f32_16x16x32_bf16 v[240:243], a[180:183], a[72:75], v[240:243]
    ds_read_b64_tr_b16 a[170:171], v13 offset:36864
    v_mfma_f32_16x16x32_bf16 v[244:247], a[176:179], a[68:71], v[244:247]
    ds_read_b64_tr_b16 a[172:173], v13 offset:40960
    v_mfma_f32_16x16x32_bf16 v[244:247], a[180:183], a[76:79], v[244:247]
    s_waitcnt lgkmcnt(9)
    buffer_load_dwordx4 v43, s[16:19], s49 offen offset:1024 lds
    v_mfma_f32_16x16x32_bf16 v[248:251], a[184:187], a[64:67], v[248:251]
    s_waitcnt lgkmcnt(7)
    ds_read_b64_tr_b16 a[174:175], v13 offset:45056
    ds_read_b64_tr_b16 a[176:177], v14 offset:32768
    v_mfma_f32_16x16x32_bf16 v[248:251], a[188:191], a[72:75], v[248:251]
    ds_read_b64_tr_b16 a[178:179], v14 offset:36864
    v_mfma_f32_16x16x32_bf16 v[252:255], a[184:187], a[68:71], v[252:255]
    ds_read_b64_tr_b16 a[180:181], v14 offset:40960
    v_mfma_f32_16x16x32_bf16 v[252:255], a[188:191], a[76:79], v[252:255]
    s_waitcnt vmcnt(19)
    s_waitcnt lgkmcnt(9)
    buffer_load_dwordx4 v44, s[16:19], s49 offen offset:2048 lds
    v_mfma_f32_16x16x32_bf16 v[128:131], a[160:163], a[80:83], v[128:131]
    s_waitcnt vmcnt(19)
    s_waitcnt lgkmcnt(7)
    ds_read_b64_tr_b16 a[182:183], v14 offset:45056
    ds_read_b64_tr_b16 a[184:185], v15 offset:32768
Ltour1:
    s_cbranch_execz Ltour5
    v_mfma_f32_16x16x32_bf16 v[128:131], a[164:167], a[88:91], v[128:131]
    s_waitcnt vmcnt(18)
    ds_read_b64_tr_b16 a[186:187], v15 offset:36864
    v_accvgpr_write_b32 a0, 0
    v_mfma_f32_16x16x32_bf16 v[132:135], a[160:163], a[84:87], v[132:135]
    s_waitcnt vmcnt(17)
    ds_read_b64_tr_b16 a[188:189], v15 offset:40960
    v_accvgpr_write_b32 a1, 0
    v_mfma_f32_16x16x32_bf16 v[132:135], a[164:167], a[92:95], v[132:135]
    s_waitcnt lgkmcnt(9)
    buffer_load_dwordx4 v45, s[16:19], s49 offen offset:3072 lds
    v_mfma_f32_16x16x32_bf16 v[136:139], a[168:171], a[80:83], v[136:139]
    s_waitcnt lgkmcnt(7)
    ds_read_b64_tr_b16 a[190:191], v15 offset:45056
    ds_read_b64_tr_b16 a[160:161], v16 offset:32768
    v_mfma_f32_16x16x32_bf16 v[136:139], a[172:175], a[88:91], v[136:139]
    s_add_u32 s49, s44, 3670272
    ds_read_b64_tr_b16 a[162:163], v16 offset:36864
    v_accvgpr_write_b32 a2, 0
    v_mfma_f32_16x16x32_bf16 v[140:143], a[168:171], a[84:87], v[140:143]
    s_add_u32 m0, s42, 114688
    ds_read_b64_tr_b16 a[164:165], v16 offset:40960
    v_accvgpr_write_b32 a3, 0
    v_mfma_f32_16x16x32_bf16 v[140:143], a[172:175], a[92:95], v[140:143]
    s_waitcnt lgkmcnt(9)
    buffer_load_dwordx4 v42, s[16:19], s49 offen lds
    v_mfma_f32_16x16x32_bf16 v[144:147], a[176:179], a[80:83], v[144:147]
    s_waitcnt lgkmcnt(7)
    ds_read_b64_tr_b16 a[166:167], v16 offset:45056
    ds_read_b64_tr_b16 a[168:169], v17 offset:32768
    v_mfma_f32_16x16x32_bf16 v[144:147], a[180:183], a[88:91], v[144:147]
    ds_read_b64_tr_b16 a[170:171], v17 offset:36864
    v_accvgpr_write_b32 a4, 0
    v_mfma_f32_16x16x32_bf16 v[148:151], a[176:179], a[84:87], v[148:151]
    ds_read_b64_tr_b16 a[172:173], v17 offset:40960
    v_accvgpr_write_b32 a5, 0
    v_mfma_f32_16x16x32_bf16 v[148:151], a[180:183], a[92:95], v[148:151]
    s_waitcnt lgkmcnt(9)
    buffer_load_dwordx4 v43, s[16:19], s49 offen offset:1024 lds
    v_mfma_f32_16x16x32_bf16 v[152:155], a[184:187], a[80:83], v[152:155]
    s_waitcnt lgkmcnt(7)
    ds_read_b64_tr_b16 a[174:175], v17 offset:45056
    ds_read_b64_tr_b16 a[176:177], v18 offset:32768
    v_mfma_f32_16x16x32_bf16 v[152:155], a[188:191], a[88:91], v[152:155]
    ds_read_b64_tr_b16 a[178:179], v18 offset:36864
    v_accvgpr_write_b32 a6, 0
    v_mfma_f32_16x16x32_bf16 v[156:159], a[184:187], a[84:87], v[156:159]
    ds_read_b64_tr_b16 a[180:181], v18 offset:40960
    v_accvgpr_write_b32 a7, 0
    v_mfma_f32_16x16x32_bf16 v[156:159], a[188:191], a[92:95], v[156:159]
    s_waitcnt lgkmcnt(9)
    buffer_load_dwordx4 v44, s[16:19], s49 offen offset:2048 lds
    v_mfma_f32_16x16x32_bf16 v[160:163], a[160:163], a[80:83], v[160:163]
    s_waitcnt lgkmcnt(7)
    ds_read_b64_tr_b16 a[182:183], v18 offset:45056
    ds_read_b64_tr_b16 a[184:185], v19 offset:32768
    v_mfma_f32_16x16x32_bf16 v[160:163], a[164:167], a[88:91], v[160:163]
    ds_read_b64_tr_b16 a[186:187], v19 offset:36864
    v_accvgpr_write_b32 a8, 0
    v_mfma_f32_16x16x32_bf16 v[164:167], a[160:163], a[84:87], v[164:167]
    ds_read_b64_tr_b16 a[188:189], v19 offset:40960
    v_accvgpr_write_b32 a9, 0
    v_mfma_f32_16x16x32_bf16 v[164:167], a[164:167], a[92:95], v[164:167]
    s_waitcnt lgkmcnt(9)
    buffer_load_dwordx4 v45, s[16:19], s49 offen offset:3072 lds
    v_mfma_f32_16x16x32_bf16 v[168:171], a[168:171], a[80:83], v[168:171]
    s_waitcnt lgkmcnt(7)
    ds_read_b64_tr_b16 a[190:191], v19 offset:45056
    ds_read_b64_tr_b16 a[160:161], v12 offset:49152
    v_mfma_f32_16x16x32_bf16 v[168:171], a[172:175], a[88:91], v[168:171]
    ds_read_b64_tr_b16 a[162:163], v12 offset:53248
    v_accvgpr_write_b32 a10, 0
    v_mfma_f32_16x16x32_bf16 v[172:175], a[168:171], a[84:87], v[172:175]
    ds_read_b64_tr_b16 a[164:165], v12 offset:57344
    v_accvgpr_write_b32 a11, 0
    v_mfma_f32_16x16x32_bf16 v[172:175], a[172:175], a[92:95], v[172:175]
    s_waitcnt lgkmcnt(9)
    buffer_load_dwordx4 a[112:115], v51, s[24:27], s46 offen offset:1792 sc1
    v_mfma_f32_16x16x32_bf16 v[176:179], a[176:179], a[80:83], v[176:179]
    s_waitcnt lgkmcnt(7)
    ds_read_b64_tr_b16 a[166:167], v12 offset:61440
    ds_read_b64_tr_b16 a[168:169], v13 offset:49152
    v_mfma_f32_16x16x32_bf16 v[176:179], a[180:183], a[88:91], v[176:179]
    ds_read_b64_tr_b16 a[170:171], v13 offset:53248
    v_accvgpr_write_b32 a12, 0
    v_mfma_f32_16x16x32_bf16 v[180:183], a[176:179], a[84:87], v[180:183]
    ds_read_b64_tr_b16 a[172:173], v13 offset:57344
    v_accvgpr_write_b32 a13, 0
    v_mfma_f32_16x16x32_bf16 v[180:183], a[180:183], a[92:95], v[180:183]
    s_waitcnt lgkmcnt(9)
    buffer_load_dwordx4 a[120:123], v51, s[24:27], s46 offen offset:1920 sc1
    v_mfma_f32_16x16x32_bf16 v[184:187], a[184:187], a[80:83], v[184:187]
    s_waitcnt lgkmcnt(7)
    ds_read_b64_tr_b16 a[174:175], v13 offset:61440
    ds_read_b64_tr_b16 a[176:177], v14 offset:49152
    v_mfma_f32_16x16x32_bf16 v[184:187], a[188:191], a[88:91], v[184:187]
    ds_read_b64_tr_b16 a[178:179], v14 offset:53248
    v_accvgpr_write_b32 a14, 0
    v_mfma_f32_16x16x32_bf16 v[188:191], a[184:187], a[84:87], v[188:191]
    ds_read_b64_tr_b16 a[180:181], v14 offset:57344
    v_accvgpr_write_b32 a15, 0
    v_mfma_f32_16x16x32_bf16 v[188:191], a[188:191], a[92:95], v[188:191]
    s_waitcnt lgkmcnt(9)
    buffer_load_dwordx4 a[116:119], v51, s[24:27], s43 offen offset:1792 sc1
    v_mfma_f32_16x16x32_bf16 v[192:195], a[160:163], a[80:83], v[192:195]
    s_waitcnt lgkmcnt(7)
    ds_read_b64_tr_b16 a[182:183], v14 offset:61440
    ds_read_b64_tr_b16 a[184:185], v15 offset:49152
    v_mfma_f32_16x16x32_bf16 v[192:195], a[164:167], a[88:91], v[192:195]
    ds_read_b64_tr_b16 a[186:187], v15 offset:53248
    v_accvgpr_write_b32 a16, 0
    v_mfma_f32_16x16x32_bf16 v[196:199], a[160:163], a[84:87], v[196:199]
    ds_read_b64_tr_b16 a[188:189], v15 offset:57344
    v_accvgpr_write_b32 a17, 0
    v_mfma_f32_16x16x32_bf16 v[196:199], a[164:167], a[92:95], v[196:199]
    s_waitcnt lgkmcnt(9)
    buffer_load_dwordx4 a[124:127], v51, s[24:27], s43 offen offset:1920 sc1
    v_mfma_f32_16x16x32_bf16 v[200:203], a[168:171], a[80:83], v[200:203]
    s_waitcnt lgkmcnt(7)
    ds_read_b64_tr_b16 a[190:191], v15 offset:61440
    ds_read_b64_tr_b16 a[160:161], v16 offset:49152
    v_mfma_f32_16x16x32_bf16 v[200:203], a[172:175], a[88:91], v[200:203]
    ds_read_b64_tr_b16 a[162:163], v16 offset:53248
    v_accvgpr_write_b32 a18, 0
    v_mfma_f32_16x16x32_bf16 v[204:207], a[168:171], a[84:87], v[204:207]
    ds_read_b64_tr_b16 a[164:165], v16 offset:57344
    v_accvgpr_write_b32 a19, 0
    v_mfma_f32_16x16x32_bf16 v[204:207], a[172:175], a[92:95], v[204:207]
    s_waitcnt lgkmcnt(9)
    ds_read_b64_tr_b16 a[166:167], v16 offset:61440
    v_accvgpr_write_b32 a20, 0
    v_mfma_f32_16x16x32_bf16 v[208:211], a[176:179], a[80:83], v[208:211]
    s_waitcnt lgkmcnt(8)
    ds_read_b64_tr_b16 a[168:169], v17 offset:49152
    v_accvgpr_write_b32 a21, 0
    v_mfma_f32_16x16x32_bf16 v[208:211], a[180:183], a[88:91], v[208:211]
    ds_read_b64_tr_b16 a[170:171], v17 offset:53248
    v_accvgpr_write_b32 a22, 0
    v_mfma_f32_16x16x32_bf16 v[212:215], a[176:179], a[84:87], v[212:215]
    ds_read_b64_tr_b16 a[172:173], v17 offset:57344
    v_accvgpr_write_b32 a23, 0
    v_mfma_f32_16x16x32_bf16 v[212:215], a[180:183], a[92:95], v[212:215]
    s_waitcnt lgkmcnt(9)
    ds_read_b64_tr_b16 a[174:175], v17 offset:61440
    v_accvgpr_write_b32 a24, 0
    v_mfma_f32_16x16x32_bf16 v[216:219], a[184:187], a[80:83], v[216:219]
    s_waitcnt lgkmcnt(8)
    ds_read_b64_tr_b16 a[176:177], v18 offset:49152
    v_accvgpr_write_b32 a25, 0
    v_mfma_f32_16x16x32_bf16 v[216:219], a[188:191], a[88:91], v[216:219]
    ds_read_b64_tr_b16 a[178:179], v18 offset:53248
    v_accvgpr_write_b32 a26, 0
    v_mfma_f32_16x16x32_bf16 v[220:223], a[184:187], a[84:87], v[220:223]
    ds_read_b64_tr_b16 a[180:181], v18 offset:57344
    v_accvgpr_write_b32 a27, 0
    v_mfma_f32_16x16x32_bf16 v[220:223], a[188:191], a[92:95], v[220:223]
    s_waitcnt lgkmcnt(9)
    ds_read_b64_tr_b16 a[182:183], v18 offset:61440
    v_accvgpr_write_b32 a28, 0
    v_mfma_f32_16x16x32_bf16 v[224:227], a[160:163], a[80:83], v[224:227]
    s_waitcnt lgkmcnt(8)
    ds_read_b64_tr_b16 a[184:185], v19 offset:49152
    v_accvgpr_write_b32 a29, 0
    v_mfma_f32_16x16x32_bf16 v[224:227], a[164:167], a[88:91], v[224:227]
    ds_read_b64_tr_b16 a[186:187], v19 offset:53248
    v_accvgpr_write_b32 a30, 0
    v_mfma_f32_16x16x32_bf16 v[228:231], a[160:163], a[84:87], v[228:231]
    ds_read_b64_tr_b16 a[188:189], v19 offset:57344
    v_accvgpr_write_b32 a31, 0
    v_mfma_f32_16x16x32_bf16 v[228:231], a[164:167], a[92:95], v[228:231]
    s_waitcnt lgkmcnt(9)
    ds_read_b64_tr_b16 a[190:191], v19 offset:61440
    v_accvgpr_write_b32 a32, 0
    s_waitcnt vmcnt(16)
    s_barrier
    v_mfma_f32_16x16x32_bf16 v[232:235], a[168:171], a[80:83], v[232:235]
    s_waitcnt lgkmcnt(8)
    ds_read_b64_tr_b16 a[160:161], v20 offset:0
    v_accvgpr_write_b32 a33, 0
    v_mfma_f32_16x16x32_bf16 v[232:235], a[172:175], a[88:91], v[232:235]
    s_add_u32 s49, s44, 4194304
    ds_read_b64_tr_b16 a[162:163], v20 offset:4096
    v_accvgpr_write_b32 a34, 0
    v_mfma_f32_16x16x32_bf16 v[236:239], a[168:171], a[84:87], v[236:239]
    s_add_u32 m0, s42, 131072
    ds_read_b64_tr_b16 a[164:165], v20 offset:8192
    v_accvgpr_write_b32 a35, 0
    v_mfma_f32_16x16x32_bf16 v[236:239], a[172:175], a[92:95], v[236:239]
    s_waitcnt lgkmcnt(9)
    buffer_load_dwordx4 v42, s[16:19], s49 offen lds
    v_mfma_f32_16x16x32_bf16 v[240:243], a[176:179], a[80:83], v[240:243]
    s_waitcnt lgkmcnt(7)
    ds_read_b64_tr_b16 a[166:167], v20 offset:12288
    ds_read_b64_tr_b16 a[168:169], v21 offset:0
    v_mfma_f32_16x16x32_bf16 v[240:243], a[180:183], a[88:91], v[240:243]
    ds_read_b64_tr_b16 a[170:171], v21 offset:4096
    v_accvgpr_write_b32 a36, 0
    v_mfma_f32_16x16x32_bf16 v[244:247], a[176:179], a[84:87], v[244:247]
    ds_read_b64_tr_b16 a[172:173], v21 offset:8192
    v_accvgpr_write_b32 a37, 0
    v_mfma_f32_16x16x32_bf16 v[244:247], a[180:183], a[92:95], v[244:247]
    s_waitcnt lgkmcnt(9)
    buffer_load_dwordx4 v43, s[16:19], s49 offen offset:1024 lds
    v_mfma_f32_16x16x32_bf16 v[248:251], a[184:187], a[80:83], v[248:251]
    s_waitcnt lgkmcnt(7)
    ds_read_b64_tr_b16 a[174:175], v21 offset:12288
    ds_read_b64_tr_b16 a[176:177], v22 offset:0
    v_mfma_f32_16x16x32_bf16 v[248:251], a[188:191], a[88:91], v[248:251]
    ds_read_b64_tr_b16 a[178:179], v22 offset:4096
    v_accvgpr_write_b32 a38, 0
    v_mfma_f32_16x16x32_bf16 v[252:255], a[184:187], a[84:87], v[252:255]
    ds_read_b64_tr_b16 a[180:181], v22 offset:8192
    v_accvgpr_write_b32 a39, 0
    v_mfma_f32_16x16x32_bf16 v[252:255], a[188:191], a[92:95], v[252:255]
    s_waitcnt vmcnt(17)
    s_waitcnt lgkmcnt(9)
    buffer_load_dwordx4 v44, s[16:19], s49 offen offset:2048 lds
    v_mfma_f32_16x16x32_bf16 v[128:131], a[160:163], a[96:99], v[128:131]
    s_waitcnt vmcnt(17)
    s_waitcnt lgkmcnt(7)
    ds_read_b64_tr_b16 a[182:183], v22 offset:12288
    ds_read_b64_tr_b16 a[184:185], v23 offset:0
    v_mfma_f32_16x16x32_bf16 v[128:131], a[164:167], a[104:107], v[128:131]
    s_waitcnt vmcnt(16)
    ds_read_b64_tr_b16 a[186:187], v23 offset:4096
    v_accvgpr_write_b32 a40, 0
    v_mfma_f32_16x16x32_bf16 v[132:135], a[160:163], a[100:103], v[132:135]
    s_waitcnt vmcnt(15)
    ds_read_b64_tr_b16 a[188:189], v23 offset:8192
    v_accvgpr_write_b32 a41, 0
    v_mfma_f32_16x16x32_bf16 v[132:135], a[164:167], a[108:111], v[132:135]
    s_waitcnt lgkmcnt(9)
    buffer_load_dwordx4 v45, s[16:19], s49 offen offset:3072 lds
    v_mfma_f32_16x16x32_bf16 v[136:139], a[168:171], a[96:99], v[136:139]
    s_waitcnt lgkmcnt(7)
    ds_read_b64_tr_b16 a[190:191], v23 offset:12288
    ds_read_b64_tr_b16 a[160:161], v24 offset:0
    v_mfma_f32_16x16x32_bf16 v[136:139], a[172:175], a[104:107], v[136:139]
    s_add_u32 s49, s44, 4194560
    ds_read_b64_tr_b16 a[162:163], v24 offset:4096
    v_accvgpr_write_b32 a42, 0
    v_mfma_f32_16x16x32_bf16 v[140:143], a[168:171], a[100:103], v[140:143]
    s_add_u32 m0, s42, 147456
    ds_read_b64_tr_b16 a[164:165], v24 offset:8192
    v_accvgpr_write_b32 a43, 0
    v_mfma_f32_16x16x32_bf16 v[140:143], a[172:175], a[108:111], v[140:143]
    s_waitcnt lgkmcnt(9)
    buffer_load_dwordx4 v42, s[16:19], s49 offen lds
    v_mfma_f32_16x16x32_bf16 v[144:147], a[176:179], a[96:99], v[144:147]
    s_waitcnt lgkmcnt(7)
    ds_read_b64_tr_b16 a[166:167], v24 offset:12288
    ds_read_b64_tr_b16 a[168:169], v25 offset:0
    v_mfma_f32_16x16x32_bf16 v[144:147], a[180:183], a[104:107], v[144:147]
    ds_read_b64_tr_b16 a[170:171], v25 offset:4096
    v_accvgpr_write_b32 a44, 0
    v_mfma_f32_16x16x32_bf16 v[148:151], a[176:179], a[100:103], v[148:151]
    ds_read_b64_tr_b16 a[172:173], v25 offset:8192
    v_accvgpr_write_b32 a45, 0
    v_mfma_f32_16x16x32_bf16 v[148:151], a[180:183], a[108:111], v[148:151]
    s_waitcnt lgkmcnt(9)
    buffer_load_dwordx4 v43, s[16:19], s49 offen offset:1024 lds
    v_mfma_f32_16x16x32_bf16 v[152:155], a[184:187], a[96:99], v[152:155]
    s_waitcnt lgkmcnt(7)
    ds_read_b64_tr_b16 a[174:175], v25 offset:12288
    ds_read_b64_tr_b16 a[176:177], v26 offset:0
    v_mfma_f32_16x16x32_bf16 v[152:155], a[188:191], a[104:107], v[152:155]
    ds_read_b64_tr_b16 a[178:179], v26 offset:4096
    v_accvgpr_write_b32 a46, 0
    v_mfma_f32_16x16x32_bf16 v[156:159], a[184:187], a[100:103], v[156:159]
    ds_read_b64_tr_b16 a[180:181], v26 offset:8192
    v_accvgpr_write_b32 a47, 0
    v_mfma_f32_16x16x32_bf16 v[156:159], a[188:191], a[108:111], v[156:159]
    s_waitcnt lgkmcnt(9)
    buffer_load_dwordx4 v44, s[16:19], s49 offen offset:2048 lds
    v_mfma_f32_16x16x32_bf16 v[160:163], a[160:163], a[96:99], v[160:163]
    s_waitcnt lgkmcnt(7)
    ds_read_b64_tr_b16 a[182:183], v26 offset:12288
    ds_read_b64_tr_b16 a[184:185], v27 offset:0
    v_mfma_f32_16x16x32_bf16 v[160:163], a[164:167], a[104:107], v[160:163]
    ds_read_b64_tr_b16 a[186:187], v27 offset:4096
    v_accvgpr_write_b32 a48, 0
    v_mfma_f32_16x16x32_bf16 v[164:167], a[160:163], a[100:103], v[164:167]
    ds_read_b64_tr_b16 a[188:189], v27 offset:8192
    v_accvgpr_write_b32 a49, 0
    v_mfma_f32_16x16x32_bf16 v[164:167], a[164:167], a[108:111], v[164:167]
    s_waitcnt lgkmcnt(9)
    buffer_load_dwordx4 v45, s[16:19], s49 offen offset:3072 lds
    v_mfma_f32_16x16x32_bf16 v[168:171], a[168:171], a[96:99], v[168:171]
    s_waitcnt lgkmcnt(7)
    ds_read_b64_tr_b16 a[190:191], v27 offset:12288
    ds_read_b64_tr_b16 a[160:161], v20 offset:16384
    v_mfma_f32_16x16x32_bf16 v[168:171], a[172:175], a[104:107], v[168:171]
    ds_read_b64_tr_b16 a[162:163], v20 offset:20480
    v_accvgpr_write_b32 a50, 0
    v_mfma_f32_16x16x32_bf16 v[172:175], a[168:171], a[100:103], v[172:175]
    ds_read_b64_tr_b16 a[164:165], v20 offset:24576
    v_accvgpr_write_b32 a51, 0
    v_mfma_f32_16x16x32_bf16 v[172:175], a[172:175], a[108:111], v[172:175]
    s_waitcnt lgkmcnt(9)
    buffer_load_dwordx4 a[128:131], v51, s[24:27], s46 offen offset:2048 sc1
    v_mfma_f32_16x16x32_bf16 v[176:179], a[176:179], a[96:99], v[176:179]
    s_waitcnt lgkmcnt(7)
    ds_read_b64_tr_b16 a[166:167], v20 offset:28672
    ds_read_b64_tr_b16 a[168:169], v21 offset:16384
    v_mfma_f32_16x16x32_bf16 v[176:179], a[180:183], a[104:107], v[176:179]
    ds_read_b64_tr_b16 a[170:171], v21 offset:20480
    v_accvgpr_write_b32 a52, 0
    v_mfma_f32_16x16x32_bf16 v[180:183], a[176:179], a[100:103], v[180:183]
    ds_read_b64_tr_b16 a[172:173], v21 offset:24576
    v_accvgpr_write_b32 a53, 0
    v_mfma_f32_16x16x32_bf16 v[180:183], a[180:183], a[108:111], v[180:183]
    s_waitcnt lgkmcnt(9)
    buffer_load_dwordx4 a[136:139], v51, s[24:27], s46 offen offset:2176 sc1
    v_mfma_f32_16x16x32_bf16 v[184:187], a[184:187], a[96:99], v[184:187]
    s_waitcnt lgkmcnt(7)
    ds_read_b64_tr_b16 a[174:175], v21 offset:28672
    ds_read_b64_tr_b16 a[176:177], v22 offset:16384
    v_mfma_f32_16x16x32_bf16 v[184:187], a[188:191], a[104:107], v[184:187]
    ds_read_b64_tr_b16 a[178:179], v22 offset:20480
    v_accvgpr_write_b32 a54, 0
    v_mfma_f32_16x16x32_bf16 v[188:191], a[184:187], a[100:103], v[188:191]
    ds_read_b64_tr_b16 a[180:181], v22 offset:24576
    v_accvgpr_write_b32 a55, 0
    v_mfma_f32_16x16x32_bf16 v[188:191], a[188:191], a[108:111], v[188:191]
    s_waitcnt lgkmcnt(9)
    buffer_load_dwordx4 a[132:135], v51, s[24:27], s43 offen offset:2048 sc1
    v_mfma_f32_16x16x32_bf16 v[192:195], a[160:163], a[96:99], v[192:195]
    s_waitcnt lgkmcnt(7)
    ds_read_b64_tr_b16 a[182:183], v22 offset:28672
    ds_read_b64_tr_b16 a[184:185], v23 offset:16384
    v_mfma_f32_16x16x32_bf16 v[192:195], a[164:167], a[104:107], v[192:195]
    ds_read_b64_tr_b16 a[186:187], v23 offset:20480
    v_accvgpr_write_b32 a56, 0
    v_mfma_f32_16x16x32_bf16 v[196:199], a[160:163], a[100:103], v[196:199]
    ds_read_b64_tr_b16 a[188:189], v23 offset:24576
    v_accvgpr_write_b32 a57, 0
    v_mfma_f32_16x16x32_bf16 v[196:199], a[164:167], a[108:111], v[196:199]
    s_waitcnt lgkmcnt(9)
    buffer_load_dwordx4 a[140:143], v51, s[24:27], s43 offen offset:2176 sc1
    v_mfma_f32_16x16x32_bf16 v[200:203], a[168:171], a[96:99], v[200:203]
    s_waitcnt lgkmcnt(7)
    ds_read_b64_tr_b16 a[190:191], v23 offset:28672
    ds_read_b64_tr_b16 a[160:161], v24 offset:16384
    v_mfma_f32_16x16x32_bf16 v[200:203], a[172:175], a[104:107], v[200:203]
    ds_read_b64_tr_b16 a[162:163], v24 offset:20480
    v_accvgpr_write_b32 a58, 0
    v_mfma_f32_16x16x32_bf16 v[204:207], a[168:171], a[100:103], v[204:207]
    ds_read_b64_tr_b16 a[164:165], v24 offset:24576
    v_accvgpr_write_b32 a59, 0
    v_mfma_f32_16x16x32_bf16 v[204:207], a[172:175], a[108:111], v[204:207]
    s_waitcnt lgkmcnt(9)
    ds_read_b64_tr_b16 a[166:167], v24 offset:28672
    v_accvgpr_write_b32 a60, 0
    v_mfma_f32_16x16x32_bf16 v[208:211], a[176:179], a[96:99], v[208:211]
    s_waitcnt lgkmcnt(8)
    ds_read_b64_tr_b16 a[168:169], v25 offset:16384
    v_accvgpr_write_b32 a61, 0
    v_mfma_f32_16x16x32_bf16 v[208:211], a[180:183], a[104:107], v[208:211]
    ds_read_b64_tr_b16 a[170:171], v25 offset:20480
    v_accvgpr_write_b32 a62, 0
    v_mfma_f32_16x16x32_bf16 v[212:215], a[176:179], a[100:103], v[212:215]
    ds_read_b64_tr_b16 a[172:173], v25 offset:24576
    v_accvgpr_write_b32 a63, 0
    v_mfma_f32_16x16x32_bf16 v[212:215], a[180:183], a[108:111], v[212:215]
    s_waitcnt lgkmcnt(9)
    ds_read_b64_tr_b16 a[174:175], v25 offset:28672
    v_accvgpr_write_b32 a64, 0
    v_mfma_f32_16x16x32_bf16 v[216:219], a[184:187], a[96:99], v[216:219]
    s_waitcnt lgkmcnt(8)
    ds_read_b64_tr_b16 a[176:177], v26 offset:16384
    v_accvgpr_write_b32 a65, 0
    v_mfma_f32_16x16x32_bf16 v[216:219], a[188:191], a[104:107], v[216:219]
    ds_read_b64_tr_b16 a[178:179], v26 offset:20480
    v_accvgpr_write_b32 a66, 0
    v_mfma_f32_16x16x32_bf16 v[220:223], a[184:187], a[100:103], v[220:223]
    ds_read_b64_tr_b16 a[180:181], v26 offset:24576
    v_accvgpr_write_b32 a67, 0
    v_mfma_f32_16x16x32_bf16 v[220:223], a[188:191], a[108:111], v[220:223]
    s_waitcnt lgkmcnt(9)
    ds_read_b64_tr_b16 a[182:183], v26 offset:28672
    v_accvgpr_write_b32 a68, 0
    v_mfma_f32_16x16x32_bf16 v[224:227], a[160:163], a[96:99], v[224:227]
    s_waitcnt lgkmcnt(8)
    ds_read_b64_tr_b16 a[184:185], v27 offset:16384
    v_accvgpr_write_b32 a69, 0
    v_mfma_f32_16x16x32_bf16 v[224:227], a[164:167], a[104:107], v[224:227]
    ds_read_b64_tr_b16 a[186:187], v27 offset:20480
    v_accvgpr_write_b32 a70, 0
    v_mfma_f32_16x16x32_bf16 v[228:231], a[160:163], a[100:103], v[228:231]
    ds_read_b64_tr_b16 a[188:189], v27 offset:24576
    v_accvgpr_write_b32 a71, 0
    v_mfma_f32_16x16x32_bf16 v[228:231], a[164:167], a[108:111], v[228:231]
    s_waitcnt lgkmcnt(9)
    ds_read_b64_tr_b16 a[190:191], v27 offset:28672
    v_accvgpr_write_b32 a72, 0
    s_waitcnt vmcnt(16)
    s_barrier
    v_mfma_f32_16x16x32_bf16 v[232:235], a[168:171], a[96:99], v[232:235]
    s_waitcnt lgkmcnt(8)
    ds_read_b64_tr_b16 a[160:161], v20 offset:32768
    v_accvgpr_write_b32 a73, 0
    v_mfma_f32_16x16x32_bf16 v[232:235], a[172:175], a[104:107], v[232:235]
    ds_read_b64_tr_b16 a[162:163], v20 offset:36864
    v_accvgpr_write_b32 a74, 0
    v_mfma_f32_16x16x32_bf16 v[236:239], a[168:171], a[100:103], v[236:239]
    s_add_u32 m0, s42, 0
    ds_read_b64_tr_b16 a[164:165], v20 offset:40960
    v_accvgpr_write_b32 a75, 0
    v_mfma_f32_16x16x32_bf16 v[236:239], a[172:175], a[108:111], v[236:239]
    s_waitcnt lgkmcnt(9)
    buffer_load_dwordx4 v36, s[8:11], s40 offen lds
    v_mfma_f32_16x16x32_bf16 v[240:243], a[176:179], a[96:99], v[240:243]
    s_waitcnt lgkmcnt(7)
    ds_read_b64_tr_b16 a[166:167], v20 offset:45056
    ds_read_b64_tr_b16 a[168:169], v21 offset:32768
    v_mfma_f32_16x16x32_bf16 v[240:243], a[180:183], a[104:107], v[240:243]
    ds_read_b64_tr_b16 a[170:171], v21 offset:36864
    v_accvgpr_write_b32 a76, 0
    v_mfma_f32_16x16x32_bf16 v[244:247], a[176:179], a[100:103], v[244:247]
    ds_read_b64_tr_b16 a[172:173], v21 offset:40960
    v_accvgpr_write_b32 a77, 0
    v_mfma_f32_16x16x32_bf16 v[244:247], a[180:183], a[108:111], v[244:247]
    s_waitcnt lgkmcnt(9)
    buffer_load_dwordx4 v37, s[8:11], s40 offen offset:1024 lds
    v_mfma_f32_16x16x32_bf16 v[248:251], a[184:187], a[96:99], v[248:251]
    s_waitcnt lgkmcnt(7)
    ds_read_b64_tr_b16 a[174:175], v21 offset:45056
    ds_read_b64_tr_b16 a[176:177], v22 offset:32768
    v_mfma_f32_16x16x32_bf16 v[248:251], a[188:191], a[104:107], v[248:251]
    ds_read_b64_tr_b16 a[178:179], v22 offset:36864
    v_accvgpr_write_b32 a78, 0
    v_mfma_f32_16x16x32_bf16 v[252:255], a[184:187], a[100:103], v[252:255]
    ds_read_b64_tr_b16 a[180:181], v22 offset:40960
    v_accvgpr_write_b32 a79, 0
    v_mfma_f32_16x16x32_bf16 v[252:255], a[188:191], a[108:111], v[252:255]
    s_waitcnt vmcnt(17)
    s_waitcnt lgkmcnt(9)
    buffer_load_dwordx4 v38, s[8:11], s40 offen offset:2048 lds
    v_mfma_f32_16x16x32_bf16 v[128:131], a[160:163], a[112:115], v[128:131]
    s_waitcnt vmcnt(17)
    s_waitcnt lgkmcnt(7)
    ds_read_b64_tr_b16 a[182:183], v22 offset:45056
    ds_read_b64_tr_b16 a[184:185], v23 offset:32768
    v_mfma_f32_16x16x32_bf16 v[128:131], a[164:167], a[120:123], v[128:131]
    s_waitcnt vmcnt(16)
    ds_read_b64_tr_b16 a[186:187], v23 offset:36864
    v_accvgpr_write_b32 a80, 0
    v_mfma_f32_16x16x32_bf16 v[132:135], a[160:163], a[116:119], v[132:135]
    s_waitcnt vmcnt(15)
    ds_read_b64_tr_b16 a[188:189], v23 offset:40960
    v_accvgpr_write_b32 a81, 0
    v_mfma_f32_16x16x32_bf16 v[132:135], a[164:167], a[124:127], v[132:135]
    s_waitcnt lgkmcnt(9)
    buffer_load_dwordx4 v39, s[8:11], s40 offen offset:3072 lds
    v_mfma_f32_16x16x32_bf16 v[136:139], a[168:171], a[112:115], v[136:139]
    s_waitcnt lgkmcnt(7)
    s_add_u32 s40, s40, 16384
    ds_read_b64_tr_b16 a[190:191], v23 offset:45056
    ds_read_b64_tr_b16 a[160:161], v24 offset:32768
    v_mfma_f32_16x16x32_bf16 v[136:139], a[172:175], a[120:123], v[136:139]
    ds_read_b64_tr_b16 a[162:163], v24 offset:36864
    v_accvgpr_write_b32 a82, 0
    v_mfma_f32_16x16x32_bf16 v[140:143], a[168:171], a[116:119], v[140:143]
    s_add_u32 m0, s42, 16384
    ds_read_b64_tr_b16 a[164:165], v24 offset:40960
    v_accvgpr_write_b32 a83, 0
    v_mfma_f32_16x16x32_bf16 v[140:143], a[172:175], a[124:127], v[140:143]
    s_waitcnt lgkmcnt(9)
    buffer_load_dwordx4 v36, s[8:11], s40 offen lds
    v_mfma_f32_16x16x32_bf16 v[144:147], a[176:179], a[112:115], v[144:147]
    s_waitcnt lgkmcnt(7)
    ds_read_b64_tr_b16 a[166:167], v24 offset:45056
    ds_read_b64_tr_b16 a[168:169], v25 offset:32768
    v_mfma_f32_16x16x32_bf16 v[144:147], a[180:183], a[120:123], v[144:147]
    ds_read_b64_tr_b16 a[170:171], v25 offset:36864
    v_accvgpr_write_b32 a84, 0
    v_mfma_f32_16x16x32_bf16 v[148:151], a[176:179], a[116:119], v[148:151]
    ds_read_b64_tr_b16 a[172:173], v25 offset:40960
    v_accvgpr_write_b32 a85, 0
    v_mfma_f32_16x16x32_bf16 v[148:151], a[180:183], a[124:127], v[148:151]
    s_waitcnt lgkmcnt(9)
    buffer_load_dwordx4 v37, s[8:11], s40 offen offset:1024 lds
    v_mfma_f32_16x16x32_bf16 v[152:155], a[184:187], a[112:115], v[152:155]
    s_waitcnt lgkmcnt(7)
    ds_read_b64_tr_b16 a[174:175], v25 offset:45056
    ds_read_b64_tr_b16 a[176:177], v26 offset:32768
    v_mfma_f32_16x16x32_bf16 v[152:155], a[188:191], a[120:123], v[152:155]
    ds_read_b64_tr_b16 a[178:179], v26 offset:36864
    v_accvgpr_write_b32 a86, 0
    v_mfma_f32_16x16x32_bf16 v[156:159], a[184:187], a[116:119], v[156:159]
    ds_read_b64_tr_b16 a[180:181], v26 offset:40960
    v_accvgpr_write_b32 a87, 0
    v_mfma_f32_16x16x32_bf16 v[156:159], a[188:191], a[124:127], v[156:159]
    s_waitcnt lgkmcnt(9)
    buffer_load_dwordx4 v38, s[8:11], s40 offen offset:2048 lds
    v_mfma_f32_16x16x32_bf16 v[160:163], a[160:163], a[112:115], v[160:163]
    s_waitcnt lgkmcnt(7)
    ds_read_b64_tr_b16 a[182:183], v26 offset:45056
    ds_read_b64_tr_b16 a[184:185], v27 offset:32768
    v_mfma_f32_16x16x32_bf16 v[160:163], a[164:167], a[120:123], v[160:163]
    ds_read_b64_tr_b16 a[186:187], v27 offset:36864
    v_accvgpr_write_b32 a88, 0
    v_mfma_f32_16x16x32_bf16 v[164:167], a[160:163], a[116:119], v[164:167]
    ds_read_b64_tr_b16 a[188:189], v27 offset:40960
    v_accvgpr_write_b32 a89, 0
    v_mfma_f32_16x16x32_bf16 v[164:167], a[164:167], a[124:127], v[164:167]
    s_waitcnt lgkmcnt(9)
    buffer_load_dwordx4 v39, s[8:11], s40 offen offset:3072 lds
    v_mfma_f32_16x16x32_bf16 v[168:171], a[168:171], a[112:115], v[168:171]
    s_waitcnt lgkmcnt(7)
    s_add_u32 s40, s40, 16384
    ds_read_b64_tr_b16 a[190:191], v27 offset:45056
    ds_read_b64_tr_b16 a[160:161], v20 offset:49152
    v_mfma_f32_16x16x32_bf16 v[168:171], a[172:175], a[120:123], v[168:171]
    ds_read_b64_tr_b16 a[162:163], v20 offset:53248
    v_accvgpr_write_b32 a90, 0
    v_mfma_f32_16x16x32_bf16 v[172:175], a[168:171], a[116:119], v[172:175]
    ds_read_b64_tr_b16 a[164:165], v20 offset:57344
    v_accvgpr_write_b32 a91, 0
    v_mfma_f32_16x16x32_bf16 v[172:175], a[172:175], a[124:127], v[172:175]
    s_waitcnt lgkmcnt(9)
    buffer_store_dword v76, v72, s[24:27], s92 offen offset:12 sc1
    v_mfma_f32_16x16x32_bf16 v[176:179], a[176:179], a[112:115], v[176:179]
    s_waitcnt lgkmcnt(7)
    ds_read_b64_tr_b16 a[166:167], v20 offset:61440
    ds_read_b64_tr_b16 a[168:169], v21 offset:49152
    v_mfma_f32_16x16x32_bf16 v[176:179], a[180:183], a[120:123], v[176:179]
    ds_read_b64_tr_b16 a[170:171], v21 offset:53248
    v_accvgpr_write_b32 a92, 0
    v_mfma_f32_16x16x32_bf16 v[180:183], a[176:179], a[116:119], v[180:183]
    ds_read_b64_tr_b16 a[172:173], v21 offset:57344
    v_accvgpr_write_b32 a93, 0
    v_mfma_f32_16x16x32_bf16 v[180:183], a[180:183], a[124:127], v[180:183]
    s_waitcnt lgkmcnt(9)
    buffer_store_dwordx4 v[88:91], v74, s[24:27], 0 offen sc1
    v_mfma_f32_16x16x32_bf16 v[184:187], a[184:187], a[112:115], v[184:187]
    s_waitcnt lgkmcnt(7)
    ds_read_b64_tr_b16 a[174:175], v21 offset:61440
    ds_read_b64_tr_b16 a[176:177], v22 offset:49152
    v_mfma_f32_16x16x32_bf16 v[184:187], a[188:191], a[120:123], v[184:187]
    ds_read_b64_tr_b16 a[178:179], v22 offset:53248
    v_accvgpr_write_b32 a94, 0
    v_mfma_f32_16x16x32_bf16 v[188:191], a[184:187], a[116:119], v[188:191]
    ds_read_b64_tr_b16 a[180:181], v22 offset:57344
    v_accvgpr_write_b32 a95, 0
    v_mfma_f32_16x16x32_bf16 v[188:191], a[188:191], a[124:127], v[188:191]
    s_waitcnt lgkmcnt(9)
    ds_read_b64_tr_b16 a[182:183], v22 offset:61440
    v_accvgpr_write_b32 a96, 0
    v_mfma_f32_16x16x32_bf16 v[192:195], a[160:163], a[112:115], v[192:195]
    s_waitcnt lgkmcnt(8)
    ds_read_b64_tr_b16 a[184:185], v23 offset:49152
    v_accvgpr_write_b32 a97, 0
    v_mfma_f32_16x16x32_bf16 v[192:195], a[164:167], a[120:123], v[192:195]
Ltour2:
    s_cbranch_execz Ltour6
    ds_read_b64_tr_b16 a[186:187], v23 offset:53248
    v_accvgpr_write_b32 a98, 0
    v_mfma_f32_16x16x32_bf16 v[196:199], a[160:163], a[116:119], v[196:199]
    ds_read_b64_tr_b16 a[188:189], v23 offset:57344
    v_accvgpr_write_b32 a99, 0
    v_mfma_f32_16x16x32_bf16 v[196:199], a[164:167], a[124:127], v[196:199]
    s_waitcnt lgkmcnt(9)
    ds_read_b64_tr_b16 a[190:191], v23 offset:61440
    v_accvgpr_write_b32 a100, 0
    v_mfma_f32_16x16x32_bf16 v[200:203], a[168:171], a[112:115], v[200:203]
    s_waitcnt lgkmcnt(8)
    ds_read_b64_tr_b16 a[160:161], v24 offset:49152
    v_accvgpr_write_b32 a101, 0
    v_mfma_f32_16x16x32_bf16 v[200:203], a[172:175], a[120:123], v[200:203]
    ds_read_b64_tr_b16 a[162:163], v24 offset:53248
    v_accvgpr_write_b32 a102, 0
    v_mfma_f32_16x16x32_bf16 v[204:207], a[168:171], a[116:119], v[204:207]
    ds_read_b64_tr_b16 a[164:165], v24 offset:57344
    v_accvgpr_write_b32 a103, 0
    v_mfma_f32_16x16x32_bf16 v[204:207], a[172:175], a[124:127], v[204:207]
    s_waitcnt lgkmcnt(9)
    ds_read_b64_tr_b16 a[166:167], v24 offset:61440
    v_accvgpr_write_b32 a104, 0
    v_mfma_f32_16x16x32_bf16 v[208:211], a[176:179], a[112:115], v[208:211]
    s_waitcnt lgkmcnt(8)
    ds_read_b64_tr_b16 a[168:169], v25 offset:49152
    v_accvgpr_write_b32 a105, 0
    v_mfma_f32_16x16x32_bf16 v[208:211], a[180:183], a[120:123], v[208:211]
    ds_read_b64_tr_b16 a[170:171], v25 offset:53248
    v_accvgpr_write_b32 a106, 0
    v_mfma_f32_16x16x32_bf16 v[212:215], a[176:179], a[116:119], v[212:215]
    ds_read_b64_tr_b16 a[172:173], v25 offset:57344
    v_accvgpr_write_b32 a107, 0
    v_mfma_f32_16x16x32_bf16 v[212:215], a[180:183], a[124:127], v[212:215]
    s_waitcnt lgkmcnt(9)
    ds_read_b64_tr_b16 a[174:175], v25 offset:61440
    v_accvgpr_write_b32 a108, 0
    v_mfma_f32_16x16x32_bf16 v[216:219], a[184:187], a[112:115], v[216:219]
    s_waitcnt lgkmcnt(8)
    ds_read_b64_tr_b16 a[176:177], v26 offset:49152
    v_accvgpr_write_b32 a109, 0
    v_mfma_f32_16x16x32_bf16 v[216:219], a[188:191], a[120:123], v[216:219]
    ds_read_b64_tr_b16 a[178:179], v26 offset:53248
    v_accvgpr_write_b32 a110, 0
    v_mfma_f32_16x16x32_bf16 v[220:223], a[184:187], a[116:119], v[220:223]
    ds_read_b64_tr_b16 a[180:181], v26 offset:57344
    v_accvgpr_write_b32 a111, 0
    v_mfma_f32_16x16x32_bf16 v[220:223], a[188:191], a[124:127], v[220:223]
    s_waitcnt lgkmcnt(9)
    ds_read_b64_tr_b16 a[182:183], v26 offset:61440
    v_accvgpr_write_b32 a192, 0
    v_mfma_f32_16x16x32_bf16 v[224:227], a[160:163], a[112:115], v[224:227]
    s_waitcnt lgkmcnt(8)
    ds_read_b64_tr_b16 a[184:185], v27 offset:49152
    v_accvgpr_write_b32 a193, 0
    v_mfma_f32_16x16x32_bf16 v[224:227], a[164:167], a[120:123], v[224:227]
    ds_read_b64_tr_b16 a[186:187], v27 offset:53248
    v_accvgpr_write_b32 a194, 0
    v_mfma_f32_16x16x32_bf16 v[228:231], a[160:163], a[116:119], v[228:231]
    ds_read_b64_tr_b16 a[188:189], v27 offset:57344
    v_accvgpr_write_b32 a195, 0
    v_mfma_f32_16x16x32_bf16 v[228:231], a[164:167], a[124:127], v[228:231]
    s_waitcnt lgkmcnt(9)
    ds_read_b64_tr_b16 a[190:191], v27 offset:61440
    v_accvgpr_write_b32 a196, 0
    s_waitcnt vmcnt(14)
    s_barrier
    v_mfma_f32_16x16x32_bf16 v[232:235], a[168:171], a[112:115], v[232:235]
    s_waitcnt lgkmcnt(8)
    ds_read_b64_tr_b16 a[160:161], v28 offset:0
    v_accvgpr_write_b32 a197, 0
    v_mfma_f32_16x16x32_bf16 v[232:235], a[172:175], a[120:123], v[232:235]
    ds_read_b64_tr_b16 a[162:163], v28 offset:4096
    v_accvgpr_write_b32 a198, 0
    v_mfma_f32_16x16x32_bf16 v[236:239], a[168:171], a[116:119], v[236:239]
    s_add_u32 m0, s42, 32768
    ds_read_b64_tr_b16 a[164:165], v28 offset:8192
    v_accvgpr_write_b32 a199, 0
    v_mfma_f32_16x16x32_bf16 v[236:239], a[172:175], a[124:127], v[236:239]
    s_waitcnt lgkmcnt(9)
    buffer_load_dwordx4 v36, s[8:11], s40 offen lds
    v_mfma_f32_16x16x32_bf16 v[240:243], a[176:179], a[112:115], v[240:243]
    s_waitcnt lgkmcnt(7)
    ds_read_b64_tr_b16 a[166:167], v28 offset:12288
    ds_read_b64_tr_b16 a[168:169], v29 offset:0
    v_mfma_f32_16x16x32_bf16 v[240:243], a[180:183], a[120:123], v[240:243]
    ds_read_b64_tr_b16 a[170:171], v29 offset:4096
    v_accvgpr_write_b32 a200, 0
    v_mfma_f32_16x16x32_bf16 v[244:247], a[176:179], a[116:119], v[244:247]
    ds_read_b64_tr_b16 a[172:173], v29 offset:8192
    v_accvgpr_write_b32 a201, 0
    v_mfma_f32_16x16x32_bf16 v[244:247], a[180:183], a[124:127], v[244:247]
    s_waitcnt lgkmcnt(9)
    buffer_load_dwordx4 v37, s[8:11], s40 offen offset:1024 lds
    v_mfma_f32_16x16x32_bf16 v[248:251], a[184:187], a[112:115], v[248:251]
    s_waitcnt lgkmcnt(7)
    ds_read_b64_tr_b16 a[174:175], v29 offset:12288
    ds_read_b64_tr_b16 a[176:177], v30 offset:0
    v_mfma_f32_16x16x32_bf16 v[248:251], a[188:191], a[120:123], v[248:251]
    ds_read_b64_tr_b16 a[178:179], v30 offset:4096
    v_accvgpr_write_b32 a202, 0
    v_mfma_f32_16x16x32_bf16 v[252:255], a[184:187], a[116:119], v[252:255]
    ds_read_b64_tr_b16 a[180:181], v30 offset:8192
    v_accvgpr_write_b32 a203, 0
    v_mfma_f32_16x16x32_bf16 v[252:255], a[188:191], a[124:127], v[252:255]
    s_waitcnt vmcnt(15)
    s_waitcnt lgkmcnt(9)
    buffer_load_dwordx4 v38, s[8:11], s40 offen offset:2048 lds
    v_mfma_f32_16x16x32_bf16 v[128:131], a[160:163], a[128:131], v[128:131]
    s_waitcnt vmcnt(15)
    s_waitcnt lgkmcnt(7)
    ds_read_b64_tr_b16 a[182:183], v30 offset:12288
    ds_read_b64_tr_b16 a[184:185], v31 offset:0
    v_mfma_f32_16x16x32_bf16 v[128:131], a[164:167], a[136:139], v[128:131]
    s_waitcnt vmcnt(14)
    ds_read_b64_tr_b16 a[186:187], v31 offset:4096
    v_accvgpr_write_b32 a204, 0
    v_mfma_f32_16x16x32_bf16 v[132:135], a[160:163], a[132:135], v[132:135]
    s_waitcnt vmcnt(13)
    ds_read_b64_tr_b16 a[188:189], v31 offset:8192
    v_accvgpr_write_b32 a205, 0
    v_mfma_f32_16x16x32_bf16 v[132:135], a[164:167], a[140:143], v[132:135]
    s_waitcnt lgkmcnt(9)
    buffer_load_dwordx4 v39, s[8:11], s40 offen offset:3072 lds
    v_mfma_f32_16x16x32_bf16 v[136:139], a[168:171], a[128:131], v[136:139]
    s_waitcnt lgkmcnt(7)
    s_add_u32 s40, s40, 16384
    ds_read_b64_tr_b16 a[190:191], v31 offset:12288
    ds_read_b64_tr_b16 a[160:161], v32 offset:0
    v_mfma_f32_16x16x32_bf16 v[136:139], a[172:175], a[136:139], v[136:139]
    ds_read_b64_tr_b16 a[162:163], v32 offset:4096
    v_accvgpr_write_b32 a206, 0
    v_mfma_f32_16x16x32_bf16 v[140:143], a[168:171], a[132:135], v[140:143]
    s_add_u32 m0, s42, 65536
    ds_read_b64_tr_b16 a[164:165], v32 offset:8192
    v_accvgpr_write_b32 a207, 0
    v_mfma_f32_16x16x32_bf16 v[140:143], a[172:175], a[140:143], v[140:143]
    s_waitcnt lgkmcnt(9)
    buffer_load_dwordx4 v40, s[12:15], s41 offen lds
    v_mfma_f32_16x16x32_bf16 v[144:147], a[176:179], a[128:131], v[144:147]
    s_waitcnt lgkmcnt(7)
    ds_read_b64_tr_b16 a[166:167], v32 offset:12288
    ds_read_b64_tr_b16 a[168:169], v33 offset:0
    v_mfma_f32_16x16x32_bf16 v[144:147], a[180:183], a[136:139], v[144:147]
    ds_read_b64_tr_b16 a[170:171], v33 offset:4096
    v_accvgpr_write_b32 a112, 0
    v_mfma_f32_16x16x32_bf16 v[148:151], a[176:179], a[132:135], v[148:151]
    ds_read_b64_tr_b16 a[172:173], v33 offset:8192
    v_accvgpr_write_b32 a113, 0
    v_mfma_f32_16x16x32_bf16 v[148:151], a[180:183], a[140:143], v[148:151]
    s_waitcnt lgkmcnt(9)
    buffer_load_dwordx4 v41, s[12:15], s41 offen offset:1024 lds
    v_mfma_f32_16x16x32_bf16 v[152:155], a[184:187], a[128:131], v[152:155]
    s_waitcnt lgkmcnt(7)
    ds_read_b64_tr_b16 a[174:175], v33 offset:12288
    ds_read_b64_tr_b16 a[176:177], v34 offset:0
    v_mfma_f32_16x16x32_bf16 v[152:155], a[188:191], a[136:139], v[152:155]
    ds_read_b64_tr_b16 a[178:179], v34 offset:4096
    v_accvgpr_write_b32 a114, 0
    v_mfma_f32_16x16x32_bf16 v[156:159], a[184:187], a[132:135], v[156:159]
    ds_read_b64_tr_b16 a[180:181], v34 offset:8192
    v_accvgpr_write_b32 a115, 0
    v_mfma_f32_16x16x32_bf16 v[156:159], a[188:191], a[140:143], v[156:159]
    s_waitcnt lgkmcnt(9)
    buffer_load_dwordx4 v40, s[12:15], s41 offen offset:2048 lds
    v_mfma_f32_16x16x32_bf16 v[160:163], a[160:163], a[128:131], v[160:163]
    s_waitcnt lgkmcnt(7)
    ds_read_b64_tr_b16 a[182:183], v34 offset:12288
    ds_read_b64_tr_b16 a[184:185], v35 offset:0
    v_mfma_f32_16x16x32_bf16 v[160:163], a[164:167], a[136:139], v[160:163]
    ds_read_b64_tr_b16 a[186:187], v35 offset:4096
    v_accvgpr_write_b32 a116, 0
    v_mfma_f32_16x16x32_bf16 v[164:167], a[160:163], a[132:135], v[164:167]
    ds_read_b64_tr_b16 a[188:189], v35 offset:8192
    v_accvgpr_write_b32 a117, 0
    v_mfma_f32_16x16x32_bf16 v[164:167], a[164:167], a[140:143], v[164:167]
    s_waitcnt lgkmcnt(9)
    buffer_load_dwordx4 v41, s[12:15], s41 offen offset:3072 lds
    v_mfma_f32_16x16x32_bf16 v[168:171], a[168:171], a[128:131], v[168:171]
    s_waitcnt lgkmcnt(7)
    s_add_u32 s41, s41, 16384
    ds_read_b64_tr_b16 a[190:191], v35 offset:12288
    ds_read_b64_tr_b16 a[160:161], v28 offset:16384
    v_mfma_f32_16x16x32_bf16 v[168:171], a[172:175], a[136:139], v[168:171]
    ds_read_b64_tr_b16 a[162:163], v28 offset:20480
    v_accvgpr_write_b32 a118, 0
    v_mfma_f32_16x16x32_bf16 v[172:175], a[168:171], a[132:135], v[172:175]
    s_add_u32 m0, s42, 81920
    ds_read_b64_tr_b16 a[164:165], v28 offset:24576
    v_accvgpr_write_b32 a119, 0
    v_mfma_f32_16x16x32_bf16 v[172:175], a[172:175], a[140:143], v[172:175]
    s_waitcnt lgkmcnt(9)
    buffer_load_dwordx4 v40, s[12:15], s41 offen lds
    v_mfma_f32_16x16x32_bf16 v[176:179], a[176:179], a[128:131], v[176:179]
    s_waitcnt lgkmcnt(7)
    ds_read_b64_tr_b16 a[166:167], v28 offset:28672
    ds_read_b64_tr_b16 a[168:169], v29 offset:16384
    v_mfma_f32_16x16x32_bf16 v[176:179], a[180:183], a[136:139], v[176:179]
    ds_read_b64_tr_b16 a[170:171], v29 offset:20480
    v_accvgpr_write_b32 a120, 0
    v_mfma_f32_16x16x32_bf16 v[180:183], a[176:179], a[132:135], v[180:183]
    ds_read_b64_tr_b16 a[172:173], v29 offset:24576
    v_accvgpr_write_b32 a121, 0
    v_mfma_f32_16x16x32_bf16 v[180:183], a[180:183], a[140:143], v[180:183]
    s_waitcnt lgkmcnt(9)
    buffer_load_dwordx4 v41, s[12:15], s41 offen offset:1024 lds
    v_mfma_f32_16x16x32_bf16 v[184:187], a[184:187], a[128:131], v[184:187]
    s_waitcnt lgkmcnt(7)
    ds_read_b64_tr_b16 a[174:175], v29 offset:28672
    ds_read_b64_tr_b16 a[176:177], v30 offset:16384
    v_mfma_f32_16x16x32_bf16 v[184:187], a[188:191], a[136:139], v[184:187]
    ds_read_b64_tr_b16 a[178:179], v30 offset:20480
    v_accvgpr_write_b32 a122, 0
    v_mfma_f32_16x16x32_bf16 v[188:191], a[184:187], a[132:135], v[188:191]
    ds_read_b64_tr_b16 a[180:181], v30 offset:24576
    v_accvgpr_write_b32 a123, 0
    v_mfma_f32_16x16x32_bf16 v[188:191], a[188:191], a[140:143], v[188:191]
    s_waitcnt lgkmcnt(9)
    buffer_load_dwordx4 v40, s[12:15], s41 offen offset:2048 lds
    v_mfma_f32_16x16x32_bf16 v[192:195], a[160:163], a[128:131], v[192:195]
    s_waitcnt lgkmcnt(7)
    ds_read_b64_tr_b16 a[182:183], v30 offset:28672
    ds_read_b64_tr_b16 a[184:185], v31 offset:16384
    v_mfma_f32_16x16x32_bf16 v[192:195], a[164:167], a[136:139], v[192:195]
    ds_read_b64_tr_b16 a[186:187], v31 offset:20480
    v_accvgpr_write_b32 a124, 0
    v_mfma_f32_16x16x32_bf16 v[196:199], a[160:163], a[132:135], v[196:199]
    ds_read_b64_tr_b16 a[188:189], v31 offset:24576
    v_accvgpr_write_b32 a125, 0
    v_mfma_f32_16x16x32_bf16 v[196:199], a[164:167], a[140:143], v[196:199]
    s_waitcnt lgkmcnt(9)
    buffer_load_dwordx4 v41, s[12:15], s41 offen offset:3072 lds
    v_mfma_f32_16x16x32_bf16 v[200:203], a[168:171], a[128:131], v[200:203]
    s_waitcnt lgkmcnt(7)
    s_add_u32 s41, s41, 16384
    ds_read_b64_tr_b16 a[190:191], v31 offset:28672
    ds_read_b64_tr_b16 a[160:161], v32 offset:16384
    v_mfma_f32_16x16x32_bf16 v[200:203], a[172:175], a[136:139], v[200:203]
    ds_read_b64_tr_b16 a[162:163], v32 offset:20480
    v_accvgpr_write_b32 a126, 0
    v_mfma_f32_16x16x32_bf16 v[204:207], a[168:171], a[132:135], v[204:207]
    ds_read_b64_tr_b16 a[164:165], v32 offset:24576
    v_accvgpr_write_b32 a127, 0
    v_mfma_f32_16x16x32_bf16 v[204:207], a[172:175], a[140:143], v[204:207]
    s_waitcnt lgkmcnt(9)
    ds_read_b64_tr_b16 a[166:167], v32 offset:28672
    v_mfma_f32_16x16x32_bf16 v[208:211], a[176:179], a[128:131], v[208:211]
    s_waitcnt lgkmcnt(8)
    ds_read_b64_tr_b16 a[168:169], v33 offset:16384
    v_mfma_f32_16x16x32_bf16 v[208:211], a[180:183], a[136:139], v[208:211]
    ds_read_b64_tr_b16 a[170:171], v33 offset:20480
    v_mfma_f32_16x16x32_bf16 v[212:215], a[176:179], a[132:135], v[212:215]
    ds_read_b64_tr_b16 a[172:173], v33 offset:24576
    v_mfma_f32_16x16x32_bf16 v[212:215], a[180:183], a[140:143], v[212:215]
    s_waitcnt lgkmcnt(9)
    ds_read_b64_tr_b16 a[174:175], v33 offset:28672
    v_mfma_f32_16x16x32_bf16 v[216:219], a[184:187], a[128:131], v[216:219]
    s_waitcnt lgkmcnt(8)
    ds_read_b64_tr_b16 a[176:177], v34 offset:16384
    v_mfma_f32_16x16x32_bf16 v[216:219], a[188:191], a[136:139], v[216:219]
    ds_read_b64_tr_b16 a[178:179], v34 offset:20480
    v_mfma_f32_16x16x32_bf16 v[220:223], a[184:187], a[132:135], v[220:223]
    ds_read_b64_tr_b16 a[180:181], v34 offset:24576
    v_mfma_f32_16x16x32_bf16 v[220:223], a[188:191], a[140:143], v[220:223]
    s_waitcnt lgkmcnt(9)
    ds_read_b64_tr_b16 a[182:183], v34 offset:28672
    v_mfma_f32_16x16x32_bf16 v[224:227], a[160:163], a[128:131], v[224:227]
    s_waitcnt lgkmcnt(8)
    ds_read_b64_tr_b16 a[184:185], v35 offset:16384
    v_mfma_f32_16x16x32_bf16 v[224:227], a[164:167], a[136:139], v[224:227]
    ds_read_b64_tr_b16 a[186:187], v35 offset:20480
    v_mfma_f32_16x16x32_bf16 v[228:231], a[160:163], a[132:135], v[228:231]
    ds_read_b64_tr_b16 a[188:189], v35 offset:24576
    v_mfma_f32_16x16x32_bf16 v[228:231], a[164:167], a[140:143], v[228:231]
    s_waitcnt lgkmcnt(9)
    ds_read_b64_tr_b16 a[190:191], v35 offset:28672
    v_mfma_f32_16x16x32_bf16 v[232:235], a[168:171], a[128:131], v[232:235]
    s_waitcnt lgkmcnt(8)
    v_mfma_f32_16x16x32_bf16 v[232:235], a[172:175], a[136:139], v[232:235]
    v_mfma_f32_16x16x32_bf16 v[236:239], a[168:171], a[132:135], v[236:239]
    v_mfma_f32_16x16x32_bf16 v[236:239], a[172:175], a[140:143], v[236:239]
    s_waitcnt lgkmcnt(6)
    s_waitcnt vmcnt(18)
    s_barrier
    v_mfma_f32_16x16x32_bf16 v[240:243], a[176:179], a[128:131], v[240:243]
    s_waitcnt lgkmcnt(4)
    ds_read_b128 a[208:211], v8 offset:0
    v_mfma_f32_16x16x32_bf16 v[240:243], a[180:183], a[136:139], v[240:243]
    ds_read_b128 a[212:215], v9 offset:0
    v_mfma_f32_16x16x32_bf16 v[244:247], a[176:179], a[132:135], v[244:247]
    ds_read_b128 a[216:219], v10 offset:0
    v_mfma_f32_16x16x32_bf16 v[244:247], a[180:183], a[140:143], v[244:247]
    s_waitcnt lgkmcnt(5)
    ds_read_b128 a[220:223], v11 offset:0
    v_mfma_f32_16x16x32_bf16 v[248:251], a[184:187], a[128:131], v[248:251]
    s_waitcnt lgkmcnt(4)
    ds_read_b128 a[224:227], v8 offset:4096
    v_mfma_f32_16x16x32_bf16 v[248:251], a[188:191], a[136:139], v[248:251]
    v_mfma_f32_16x16x32_bf16 v[252:255], a[184:187], a[132:135], v[252:255]
    s_load_dwordx2 s[16:17], s[0:1], 88
    v_mfma_f32_16x16x32_bf16 v[252:255], a[188:191], a[140:143], v[252:255]
    s_mov_b32 s36, 1040356334
    s_mov_b32 s37, 1040356334
    v_pk_mul_f32 v[128:129], v[128:129], s[36:37]
    v_pk_mul_f32 v[130:131], v[130:131], s[36:37]
    v_pk_mul_f32 v[136:137], v[136:137], s[36:37]
    v_pk_mul_f32 v[138:139], v[138:139], s[36:37]
    v_cvt_pk_bf16_f32 v64, v128, v129
    v_cvt_pk_bf16_f32 v65, v130, v131
    v_cvt_pk_bf16_f32 v66, v136, v137
    v_cvt_pk_bf16_f32 v67, v138, v139
    v_pk_mul_f32 v[132:133], v[132:133], s[36:37]
    v_pk_mul_f32 v[134:135], v[134:135], s[36:37]
    v_pk_mul_f32 v[140:141], v[140:141], s[36:37]
    v_pk_mul_f32 v[142:143], v[142:143], s[36:37]
    v_cvt_pk_bf16_f32 v80, v132, v133
    v_cvt_pk_bf16_f32 v81, v134, v135
    v_cvt_pk_bf16_f32 v82, v140, v141
    v_cvt_pk_bf16_f32 v83, v142, v143
    v_permlane32_swap_b32 v64, v66
    v_permlane32_swap_b32 v65, v67
    v_permlane32_swap_b32 v80, v82
    v_permlane32_swap_b32 v81, v83
    v_permlane16_swap_b32 v64, v66
    v_permlane16_swap_b32 v65, v67
    v_permlane16_swap_b32 v80, v82
    v_permlane16_swap_b32 v81, v83
    v_pk_mul_f32 v[144:145], v[144:145], s[36:37]
    v_pk_mul_f32 v[146:147], v[146:147], s[36:37]
    v_pk_mul_f32 v[152:153], v[152:153], s[36:37]
    v_pk_mul_f32 v[154:155], v[154:155], s[36:37]
    v_cvt_pk_bf16_f32 v68, v144, v145
    v_cvt_pk_bf16_f32 v69, v146, v147
    v_cvt_pk_bf16_f32 v70, v152, v153
    v_cvt_pk_bf16_f32 v71, v154, v155
    v_pk_mul_f32 v[148:149], v[148:149], s[36:37]
    v_pk_mul_f32 v[150:151], v[150:151], s[36:37]
    v_pk_mul_f32 v[156:157], v[156:157], s[36:37]
    v_pk_mul_f32 v[158:159], v[158:159], s[36:37]
    v_cvt_pk_bf16_f32 v84, v148, v149
    v_cvt_pk_bf16_f32 v85, v150, v151
    v_cvt_pk_bf16_f32 v86, v156, v157
    v_cvt_pk_bf16_f32 v87, v158, v159
    v_permlane32_swap_b32 v68, v70
    v_permlane32_swap_b32 v69, v71
    v_permlane32_swap_b32 v84, v86
    v_permlane32_swap_b32 v85, v87
    v_permlane16_swap_b32 v68, v70
    v_permlane16_swap_b32 v69, v71
    v_permlane16_swap_b32 v84, v86
    v_permlane16_swap_b32 v85, v87
    v_pk_mul_f32 v[160:161], v[160:161], s[36:37]
    v_pk_mul_f32 v[162:163], v[162:163], s[36:37]
    v_pk_mul_f32 v[168:169], v[168:169], s[36:37]
    v_pk_mul_f32 v[170:171], v[170:171], s[36:37]
    v_cvt_pk_bf16_f32 v72, v160, v161
    v_cvt_pk_bf16_f32 v73, v162, v163
    v_cvt_pk_bf16_f32 v74, v168, v169
    v_cvt_pk_bf16_f32 v75, v170, v171
    v_pk_mul_f32 v[164:165], v[164:165], s[36:37]
    v_pk_mul_f32 v[166:167], v[166:167], s[36:37]
    v_pk_mul_f32 v[172:173], v[172:173], s[36:37]
    v_pk_mul_f32 v[174:175], v[174:175], s[36:37]
    v_cvt_pk_bf16_f32 v88, v164, v165
    v_cvt_pk_bf16_f32 v89, v166, v167
    v_cvt_pk_bf16_f32 v90, v172, v173
    v_cvt_pk_bf16_f32 v91, v174, v175
    v_permlane32_swap_b32 v72, v74
    v_permlane32_swap_b32 v73, v75
    v_permlane32_swap_b32 v88, v90
    v_permlane32_swap_b32 v89, v91
    v_permlane16_swap_b32 v72, v74
    v_permlane16_swap_b32 v73, v75
    v_permlane16_swap_b32 v88, v90
    v_permlane16_swap_b32 v89, v91
    v_pk_mul_f32 v[176:177], v[176:177], s[36:37]
    v_pk_mul_f32 v[178:179], v[178:179], s[36:37]
    v_pk_mul_f32 v[184:185], v[184:185], s[36:37]
    v_pk_mul_f32 v[186:187], v[186:187], s[36:37]
    v_cvt_pk_bf16_f32 v76, v176, v177
    v_cvt_pk_bf16_f32 v77, v178, v179
    v_cvt_pk_bf16_f32 v78, v184, v185
    v_cvt_pk_bf16_f32 v79, v186, v187
    v_pk_mul_f32 v[180:181], v[180:181], s[36:37]
    v_pk_mul_f32 v[182:183], v[182:183], s[36:37]
    v_pk_mul_f32 v[188:189], v[188:189], s[36:37]
    v_pk_mul_f32 v[190:191], v[190:191], s[36:37]
    v_cvt_pk_bf16_f32 v92, v180, v181
    v_cvt_pk_bf16_f32 v93, v182, v183
    v_cvt_pk_bf16_f32 v94, v188, v189
    v_cvt_pk_bf16_f32 v95, v190, v191
    v_permlane32_swap_b32 v76, v78
    v_permlane32_swap_b32 v77, v79
    v_permlane32_swap_b32 v92, v94
    v_permlane32_swap_b32 v93, v95
    v_permlane16_swap_b32 v76, v78
    v_permlane16_swap_b32 v77, v79
    v_permlane16_swap_b32 v92, v94
    v_permlane16_swap_b32 v93, v95
    v_pk_mul_f32 v[192:193], v[192:193], s[36:37]
    v_pk_mul_f32 v[194:195], v[194:195], s[36:37]
    v_pk_mul_f32 v[200:201], v[200:201], s[36:37]
    v_pk_mul_f32 v[202:203], v[202:203], s[36:37]
    v_cvt_pk_bf16_f32 v96, v192, v193
    v_cvt_pk_bf16_f32 v97, v194, v195
    v_cvt_pk_bf16_f32 v98, v200, v201
    v_cvt_pk_bf16_f32 v99, v202, v203
    v_pk_mul_f32 v[196:197], v[196:197], s[36:37]
    v_pk_mul_f32 v[198:199], v[198:199], s[36:37]
    v_pk_mul_f32 v[204:205], v[204:205], s[36:37]
    v_pk_mul_f32 v[206:207], v[206:207], s[36:37]
    v_cvt_pk_bf16_f32 v112, v196, v197
    v_cvt_pk_bf16_f32 v113, v198, v199
    v_cvt_pk_bf16_f32 v114, v204, v205
    v_cvt_pk_bf16_f32 v115, v206, v207
    v_permlane32_swap_b32 v96, v98
    v_permlane32_swap_b32 v97, v99
    v_permlane32_swap_b32 v112, v114
    v_permlane32_swap_b32 v113, v115
    v_permlane16_swap_b32 v96, v98
    v_permlane16_swap_b32 v97, v99
    v_permlane16_swap_b32 v112, v114
    v_permlane16_swap_b32 v113, v115
    v_pk_mul_f32 v[208:209], v[208:209], s[36:37]
    v_pk_mul_f32 v[210:211], v[210:211], s[36:37]
    v_pk_mul_f32 v[216:217], v[216:217], s[36:37]
    v_pk_mul_f32 v[218:219], v[218:219], s[36:37]
    v_cvt_pk_bf16_f32 v100, v208, v209
    v_cvt_pk_bf16_f32 v101, v210, v211
    v_cvt_pk_bf16_f32 v102, v216, v217
    v_cvt_pk_bf16_f32 v103, v218, v219
    v_pk_mul_f32 v[212:213], v[212:213], s[36:37]
    v_pk_mul_f32 v[214:215], v[214:215], s[36:37]
    v_pk_mul_f32 v[220:221], v[220:221], s[36:37]
    v_pk_mul_f32 v[222:223], v[222:223], s[36:37]
    v_cvt_pk_bf16_f32 v116, v212, v213
    v_cvt_pk_bf16_f32 v117, v214, v215
    v_cvt_pk_bf16_f32 v118, v220, v221
    v_cvt_pk_bf16_f32 v119, v222, v223
    v_permlane32_swap_b32 v100, v102
    v_permlane32_swap_b32 v101, v103
    v_permlane32_swap_b32 v116, v118
    v_permlane32_swap_b32 v117, v119
    v_permlane16_swap_b32 v100, v102
    v_permlane16_swap_b32 v101, v103
    v_permlane16_swap_b32 v116, v118
    v_permlane16_swap_b32 v117, v119
    v_pk_mul_f32 v[224:225], v[224:225], s[36:37]
    v_pk_mul_f32 v[226:227], v[226:227], s[36:37]
    v_pk_mul_f32 v[232:233], v[232:233], s[36:37]
    v_pk_mul_f32 v[234:235], v[234:235], s[36:37]
    v_cvt_pk_bf16_f32 v104, v224, v225
    v_cvt_pk_bf16_f32 v105, v226, v227
    v_cvt_pk_bf16_f32 v106, v232, v233
    v_cvt_pk_bf16_f32 v107, v234, v235
    v_pk_mul_f32 v[228:229], v[228:229], s[36:37]
    v_pk_mul_f32 v[230:231], v[230:231], s[36:37]
    v_pk_mul_f32 v[236:237], v[236:237], s[36:37]
    v_pk_mul_f32 v[238:239], v[238:239], s[36:37]
    v_cvt_pk_bf16_f32 v120, v228, v229
    v_cvt_pk_bf16_f32 v121, v230, v231
    v_cvt_pk_bf16_f32 v122, v236, v237
    v_cvt_pk_bf16_f32 v123, v238, v239
    v_permlane32_swap_b32 v104, v106
    v_permlane32_swap_b32 v105, v107
    v_permlane32_swap_b32 v120, v122
    v_permlane32_swap_b32 v121, v123
    v_permlane16_swap_b32 v104, v106
    v_permlane16_swap_b32 v105, v107
    v_permlane16_swap_b32 v120, v122
    v_permlane16_swap_b32 v121, v123
    v_pk_mul_f32 v[240:241], v[240:241], s[36:37]
    v_pk_mul_f32 v[242:243], v[242:243], s[36:37]
    v_pk_mul_f32 v[248:249], v[248:249], s[36:37]
    v_pk_mul_f32 v[250:251], v[250:251], s[36:37]
    v_cvt_pk_bf16_f32 v108, v240, v241
    v_cvt_pk_bf16_f32 v109, v242, v243
    v_cvt_pk_bf16_f32 v110, v248, v249
    v_cvt_pk_bf16_f32 v111, v250, v251
    v_pk_mul_f32 v[244:245], v[244:245], s[36:37]
    v_pk_mul_f32 v[246:247], v[246:247], s[36:37]
    v_pk_mul_f32 v[252:253], v[252:253], s[36:37]
    v_pk_mul_f32 v[254:255], v[254:255], s[36:37]
    v_cvt_pk_bf16_f32 v124, v244, v245
    v_cvt_pk_bf16_f32 v125, v246, v247
    v_cvt_pk_bf16_f32 v126, v252, v253
    v_cvt_pk_bf16_f32 v127, v254, v255
    v_permlane32_swap_b32 v108, v110
    v_permlane32_swap_b32 v109, v111
    v_permlane32_swap_b32 v124, v126
    v_permlane32_swap_b32 v125, v127
    v_permlane16_swap_b32 v108, v110
    v_permlane16_swap_b32 v109, v111
    v_permlane16_swap_b32 v124, v126
    v_permlane16_swap_b32 v125, v127
    s_waitcnt lgkmcnt(0)
    v_mfma_f32_16x16x32_bf16 v[216:219], a[208:211], v[64:67], 0
    v_mfma_f32_16x16x32_bf16 v[216:219], a[212:215], v[68:71], v[216:219]
    v_mfma_f32_16x16x32_bf16 v[216:219], a[216:219], v[72:75], v[216:219]
    v_mfma_f32_16x16x32_bf16 v[216:219], a[220:223], v[76:79], v[216:219]
    v_mfma_f32_16x16x32_bf16 v[220:223], a[208:211], v[80:83], 0
    v_mfma_f32_16x16x32_bf16 v[220:223], a[212:215], v[84:87], v[220:223]
    v_mfma_f32_16x16x32_bf16 v[220:223], a[216:219], v[88:91], v[220:223]
    v_mfma_f32_16x16x32_bf16 v[220:223], a[220:223], v[92:95], v[220:223]
    v_mfma_f32_16x16x32_bf16 v[224:227], a[208:211], v[96:99], 0
    v_mfma_f32_16x16x32_bf16 v[224:227], a[212:215], v[100:103], v[224:227]
    v_mfma_f32_16x16x32_bf16 v[224:227], a[216:219], v[104:107], v[224:227]
    v_mfma_f32_16x16x32_bf16 v[224:227], a[220:223], v[108:111], v[224:227]
    v_mfma_f32_16x16x32_bf16 v[228:231], a[208:211], v[112:115], 0
    v_mfma_f32_16x16x32_bf16 v[228:231], a[212:215], v[116:119], v[228:231]
    v_mfma_f32_16x16x32_bf16 v[228:231], a[216:219], v[120:123], v[228:231]
    v_mfma_f32_16x16x32_bf16 v[228:231], a[220:223], v[124:127], v[228:231]
    v_max3_f32 v232, v216, v217, v218
    v_max_f32 v232, v232, v219
    v_max3_f32 v233, v220, v221, v222
    v_max_f32 v233, v233, v223
    v_max3_f32 v234, v224, v225, v226
    v_max_f32 v234, v234, v227
    s_nop 1
    v_max3_f32 v235, v228, v229, v230
    v_max_f32 v235, v235, v231
    v_mov_b32 v236, v232
    v_mov_b32 v237, v233
    v_mov_b32 v238, v234
    v_mov_b32 v239, v235
    v_permlane16_swap_b32 v232, v236
    v_permlane16_swap_b32 v233, v237
    v_permlane16_swap_b32 v234, v238
    v_permlane16_swap_b32 v235, v239
    v_max_f32 v232, v232, v236
    v_max_f32 v233, v233, v237
    v_max_f32 v234, v234, v238
    v_max_f32 v235, v235, v239
    v_mov_b32 v236, v232
    v_mov_b32 v237, v233
    v_mov_b32 v238, v234
    v_mov_b32 v239, v235
    v_permlane32_swap_b32 v232, v236
    v_permlane32_swap_b32 v233, v237
    v_permlane32_swap_b32 v234, v238
    v_permlane32_swap_b32 v235, v239
    v_max_f32 v232, v232, v236
    v_max_f32 v233, v233, v237
    v_max_f32 v234, v234, v238
    v_max_f32 v235, v235, v239
    v_sub_f32 v192, 3250585600, v232
    v_sub_f32 v193, 3250585600, v232
    v_sub_f32 v194, 3250585600, v232
    v_sub_f32 v195, 3250585600, v232
    v_sub_f32 v196, 3250585600, v233
    v_sub_f32 v197, 3250585600, v233
    v_sub_f32 v198, 3250585600, v233
    v_sub_f32 v199, 3250585600, v233
    v_sub_f32 v200, 3250585600, v234
    v_sub_f32 v201, 3250585600, v234
    v_sub_f32 v202, 3250585600, v234
    v_sub_f32 v203, 3250585600, v234
    v_sub_f32 v204, 3250585600, v235
    v_sub_f32 v205, 3250585600, v235
    v_sub_f32 v206, 3250585600, v235
    v_sub_f32 v207, 3250585600, v235
Lattn_stage0:
    s_mov_b32 s43, 7
    v_mfma_f32_16x16x32_bf16 v[208:211], a[208:211], v[64:67], v[192:195]
    s_lshl_b32 s53, s5, 4
    v_mfma_f32_16x16x32_bf16 v[208:211], a[212:215], v[68:71], v[208:211]
    s_add_u32 s53, s53, s4
    v_mfma_f32_16x16x32_bf16 v[208:211], a[216:219], v[72:75], v[208:211]
    s_lshl_b32 s53, s53, 2
    v_mfma_f32_16x16x32_bf16 v[208:211], a[220:223], v[76:79], v[208:211]
    s_add_u32 s53, s53, s3
    ds_read_b128 a[228:231], v9 offset:4096
    v_mfma_f32_16x16x32_bf16 v[212:215], a[208:211], v[80:83], v[196:199]
    s_mul_i32 s53, s53, 4608
    s_nop 3
    v_exp_f32 v208, v208
    v_mfma_f32_16x16x32_bf16 v[212:215], a[212:215], v[84:87], v[212:215]
    s_add_u32 s53, s53, 2621440
    v_exp_f32 v209, v209
    v_mfma_f32_16x16x32_bf16 v[212:215], a[216:219], v[88:91], v[212:215]
    s_lshr_b32 s44, s2, 5
    v_exp_f32 v210, v210
    v_mfma_f32_16x16x32_bf16 v[212:215], a[220:223], v[92:95], v[212:215]
    s_lshl_b32 s44, s44, 3
    v_exp_f32 v211, v211
    v_cvt_pk_bf16_f32 v128, v208, v209
    ds_read_b128 a[232:235], v10 offset:4096
    v_cvt_pk_bf16_f32 v129, v210, v211
    v_mfma_f32_16x16x32_bf16 v[208:211], a[208:211], v[96:99], v[200:203]
    s_and_b32 s37, s2, 7
    s_nop 0
    v_exp_f32 v212, v212
    v_mfma_f32_16x16x32_bf16 v[208:211], a[212:215], v[100:103], v[208:211]
    s_add_u32 s44, s44, s37
    v_exp_f32 v213, v213
    v_mfma_f32_16x16x32_bf16 v[208:211], a[216:219], v[104:107], v[208:211]
    s_lshl_b32 s44, s44, 2
    v_exp_f32 v214, v214
    v_mfma_f32_16x16x32_bf16 v[208:211], a[220:223], v[108:111], v[208:211]
    s_bfe_u32 s37, s2, 0x20003
    v_exp_f32 v215, v215
    v_cvt_pk_bf16_f32 v136, v212, v213
Ltour3:
    s_cbranch_execz Ltour7
    ds_read_b128 a[236:239], v11 offset:4096
    v_cvt_pk_bf16_f32 v137, v214, v215
    v_mfma_f32_16x16x32_bf16 v[212:215], a[208:211], v[112:115], v[204:207]
    s_add_u32 s44, s44, s37
    s_nop 0
    v_exp_f32 v208, v208
    v_mfma_f32_16x16x32_bf16 v[212:215], a[212:215], v[116:119], v[212:215]
    s_add_u32 s44, s44, 72
    v_exp_f32 v209, v209
    v_mfma_f32_16x16x32_bf16 v[212:215], a[216:219], v[120:123], v[212:215]
    s_cmp_lt_u32 s44, 216
    s_cselect_b32 s37, 0, 2147483648
    v_exp_f32 v210, v210
    v_mfma_f32_16x16x32_bf16 v[212:215], a[220:223], v[124:127], v[212:215]
    s_lshl_b32 s44, s44, 5
    v_exp_f32 v211, v211
    v_cvt_pk_bf16_f32 v144, v208, v209
    ds_read_b128 a[208:211], v8 offset:8192
    v_cvt_pk_bf16_f32 v145, v210, v211
    v_mfma_f32_16x16x32_bf16 v[208:211], a[224:227], v[64:67], v[192:195]
    s_waitcnt lgkmcnt(3)
    s_or_b32 s44, s44, s37
    v_exp_f32 v212, v212
    v_mfma_f32_16x16x32_bf16 v[208:211], a[228:231], v[68:71], v[208:211]
    s_waitcnt lgkmcnt(2)
    s_mov_b32 s18, 3981312
    v_exp_f32 v213, v213
    v_mfma_f32_16x16x32_bf16 v[208:211], a[232:235], v[72:75], v[208:211]
    s_waitcnt lgkmcnt(1)
    s_lshr_b32 s6, s2, 3
    v_exp_f32 v214, v214
    v_mfma_f32_16x16x32_bf16 v[208:211], a[236:239], v[76:79], v[208:211]
    s_and_b32 s7, s2, 7
    v_exp_f32 v215, v215
    v_cvt_pk_bf16_f32 v152, v212, v213
    ds_read_b128 a[212:215], v9 offset:8192
    v_cvt_pk_bf16_f32 v153, v214, v215
    v_mfma_f32_16x16x32_bf16 v[212:215], a[224:227], v[80:83], v[196:199]
    s_mul_i32 s7, s7, 18
    s_nop 0
    v_exp_f32 v208, v208
    v_mfma_f32_16x16x32_bf16 v[212:215], a[228:231], v[84:87], v[212:215]
    s_add_u32 s7, s7, s6
    v_exp_f32 v209, v209
    v_mfma_f32_16x16x32_bf16 v[212:215], a[232:235], v[88:91], v[212:215]
    s_lshl_b32 s58, s7, 6
    v_exp_f32 v210, v210
    v_mfma_f32_16x16x32_bf16 v[212:215], a[236:239], v[92:95], v[212:215]
    s_mul_i32 s59, s7, 36864
    v_exp_f32 v211, v211
    v_cvt_pk_bf16_f32 v130, v208, v209
    ds_read_b128 a[216:219], v10 offset:8192
    v_cvt_pk_bf16_f32 v131, v210, v211
    v_mfma_f32_16x16x32_bf16 v[208:211], a[224:227], v[96:99], v[200:203]
    s_cmp_lt_u32 s6, 18
    s_cselect_b32 s7, 0, 2147483648
    v_exp_f32 v212, v212
    v_mfma_f32_16x16x32_bf16 v[208:211], a[228:231], v[100:103], v[208:211]
    s_or_b32 s58, s58, s7
    v_exp_f32 v213, v213
    v_mfma_f32_16x16x32_bf16 v[208:211], a[232:235], v[104:107], v[208:211]
    s_or_b32 s59, s59, s7
    v_exp_f32 v214, v214
    v_mfma_f32_16x16x32_bf16 v[208:211], a[236:239], v[108:111], v[208:211]
    s_and_b32 s7, s4, 1
    v_exp_f32 v215, v215
    v_cvt_pk_bf16_f32 v138, v212, v213
    ds_read_b128 a[220:223], v11 offset:8192
    v_cvt_pk_bf16_f32 v139, v214, v215
    s_mov_b32 s39, 221184
    s_mov_b32 s38, 27648
    v_mfma_f32_16x16x32_bf16 v[212:215], a[224:227], v[112:115], v[204:207]
    s_lshl_b32 s6, s7, 7
    v_exp_f32 v208, v208
    v_mfma_f32_16x16x32_bf16 v[212:215], a[228:231], v[116:119], v[212:215]
    s_xor_b32 s36, s4, 1
    v_exp_f32 v209, v209
    v_mfma_f32_16x16x32_bf16 v[212:215], a[232:235], v[120:123], v[212:215]
    s_mul_i32 s36, s36, 294912
    v_exp_f32 v210, v210
    v_mfma_f32_16x16x32_bf16 v[212:215], a[236:239], v[124:127], v[212:215]
    s_waitcnt lgkmcnt(3)
    s_add_u32 s46, s36, s6
    v_exp_f32 v211, v211
    v_cvt_pk_bf16_f32 v146, v208, v209
    ds_read_b128 a[224:227], v8 offset:12288
    v_cvt_pk_bf16_f32 v147, v210, v211
    v_mfma_f32_16x16x32_bf16 v[208:211], a[208:211], v[64:67], v[192:195]
    s_waitcnt lgkmcnt(3)
    s_lshl_b32 s36, s4, 8
    v_exp_f32 v212, v212
    v_mfma_f32_16x16x32_bf16 v[208:211], a[212:215], v[68:71], v[208:211]
    s_waitcnt lgkmcnt(2)
    s_add_u32 s56, s47, s36
    v_exp_f32 v213, v213
    v_mfma_f32_16x16x32_bf16 v[208:211], a[216:219], v[72:75], v[208:211]
    s_waitcnt lgkmcnt(1)
    s_lshr_b32 s36, s4, 1
    v_exp_f32 v214, v214
    v_mfma_f32_16x16x32_bf16 v[208:211], a[220:223], v[76:79], v[208:211]
    s_lshl_b32 s36, s36, 11
    v_exp_f32 v215, v215
    v_cvt_pk_bf16_f32 v154, v212, v213
    ds_read_b128 a[228:231], v9 offset:12288
    v_cvt_pk_bf16_f32 v155, v214, v215
    v_mfma_f32_16x16x32_bf16 v[212:215], a[208:211], v[80:83], v[196:199]
    s_lshl_b32 s7, s7, 8
    s_nop 0
    v_exp_f32 v208, v208
    v_mfma_f32_16x16x32_bf16 v[212:215], a[212:215], v[84:87], v[212:215]
    s_add_u32 s36, s36, s7
    v_exp_f32 v209, v209
    v_mfma_f32_16x16x32_bf16 v[212:215], a[216:219], v[88:91], v[212:215]
    s_add_u32 s93, s47, s36
    v_exp_f32 v210, v210
    v_mfma_f32_16x16x32_bf16 v[212:215], a[220:223], v[92:95], v[212:215]
    s_lshr_b32 s36, s4, 1
    v_exp_f32 v211, v211
    v_cvt_pk_bf16_f32 v132, v208, v209
    ds_read_b128 a[232:235], v10 offset:12288
    v_cvt_pk_bf16_f32 v133, v210, v211
    v_mfma_f32_16x16x32_bf16 v[208:211], a[208:211], v[96:99], v[200:203]
    s_lshl_b32 s36, s36, 4
    s_nop 0
    v_exp_f32 v212, v212
    v_mfma_f32_16x16x32_bf16 v[208:211], a[212:215], v[100:103], v[208:211]
    s_add_u32 s36, s36, s5
    v_exp_f32 v213, v213
    v_mfma_f32_16x16x32_bf16 v[208:211], a[216:219], v[104:107], v[208:211]
    s_lshl_b32 s36, s36, 9
    v_exp_f32 v214, v214
    v_mfma_f32_16x16x32_bf16 v[208:211], a[220:223], v[108:111], v[208:211]
    s_add_u32 s36, s36, s7
    v_exp_f32 v215, v215
    v_cvt_pk_bf16_f32 v140, v212, v213
    ds_read_b128 a[236:239], v11 offset:12288
    v_cvt_pk_bf16_f32 v141, v214, v215
    s_waitcnt vmcnt(4)
    s_barrier
    v_mfma_f32_16x16x32_bf16 v[212:215], a[208:211], v[112:115], v[204:207]
    s_lshl_b32 s36, s36, 8
    v_exp_f32 v208, v208
    v_mfma_f32_16x16x32_bf16 v[212:215], a[212:215], v[116:119], v[212:215]
    s_add_u32 m0, s42, 49152
    s_add_u32 s55, s36, 20971520
    v_exp_f32 v209, v209
    v_mfma_f32_16x16x32_bf16 v[212:215], a[216:219], v[120:123], v[212:215]
    s_add_u32 s7, s45, s6
    v_exp_f32 v210, v210
    v_mfma_f32_16x16x32_bf16 v[212:215], a[220:223], v[124:127], v[212:215]
    s_waitcnt lgkmcnt(3)
    s_xor_b32 s54, s92, 128
    v_exp_f32 v211, v211
    v_cvt_pk_bf16_f32 v148, v208, v209
    ds_read_b128 a[208:211], v8 offset:16384
    v_cvt_pk_bf16_f32 v149, v210, v211
    buffer_load_dwordx4 v36, s[8:11], s40 offen lds
    v_mfma_f32_16x16x32_bf16 v[208:211], a[224:227], v[64:67], v[192:195]
    s_waitcnt lgkmcnt(3)
    s_lshl_b32 s36, s3, 14
    v_exp_f32 v212, v212
    v_mfma_f32_16x16x32_bf16 v[208:211], a[228:231], v[68:71], v[208:211]
    s_waitcnt lgkmcnt(2)
    v_exp_f32 v213, v213
    v_mfma_f32_16x16x32_bf16 v[208:211], a[232:235], v[72:75], v[208:211]
    s_waitcnt lgkmcnt(1)
    v_exp_f32 v214, v214
    v_mfma_f32_16x16x32_bf16 v[208:211], a[236:239], v[76:79], v[208:211]
    v_exp_f32 v215, v215
    v_cvt_pk_bf16_f32 v156, v212, v213
    ds_read_b128 a[212:215], v9 offset:16384
    v_cvt_pk_bf16_f32 v157, v214, v215
    v_mfma_f32_16x16x32_bf16 v[212:215], a[224:227], v[80:83], v[196:199]
    s_nop 2
    v_exp_f32 v208, v208
    v_mfma_f32_16x16x32_bf16 v[212:215], a[228:231], v[84:87], v[212:215]
    v_exp_f32 v209, v209
    v_mfma_f32_16x16x32_bf16 v[212:215], a[232:235], v[88:91], v[212:215]
    v_exp_f32 v210, v210
    v_mfma_f32_16x16x32_bf16 v[212:215], a[236:239], v[92:95], v[212:215]
    v_exp_f32 v211, v211
    ds_read_b64_tr_b16 a[160:161], v20 offset:0
    v_cvt_pk_bf16_f32 v134, v208, v209
    v_lshrrev_b32 v51, 2, v0
    v_mul_u32_u24 v51, 9216, v51
    v_and_b32 v254, 3, v0
    v_lshl_add_u32 v254, v254, 4, v51
    v_lshlrev_b32 v255, 4, v0
    v_add_u32 v51, 98304, v255
    v_lshl_add_u32 v252, v1, 4, s36
    v_mov_b32 v224, 0
    v_mov_b32 v225, 0
    v_mov_b32 v226, 0
    v_mov_b32 v227, 0
    v_mov_b32 v228, 0
    v_mov_b32 v229, 0
    v_mov_b32 v230, 0
    v_mov_b32 v231, 0
    v_mov_b32 v248, -1
    v_mov_b32 v249, -1
    v_mov_b32 v250, -1
    v_mov_b32 v251, -1
    v_min_u32 v232, 41, v1
    v_lshlrev_b32 v232, 4, v232
    s_mov_b32 s57, s58
    s_lshl_b32 s6, s3, 10
    s_add_u32 s6, s6, 135168
    s_lshr_b32 s37, s2, 3
    s_mul_i32 s37, s37, -129024
    s_add_u32 s37, s37, 4128768
    ds_read_b64_tr_b16 a[162:163], v20 offset:4096
    ds_read_b128 a[216:219], v10 offset:16384
    v_cvt_pk_bf16_f32 v135, v210, v211
    buffer_load_dwordx4 v37, s[8:11], s40 offen offset:1024 lds
    v_mfma_f32_16x16x32_bf16 v[208:211], a[224:227], v[96:99], v[200:203]
    v_exp_f32 v212, v212
    v_mfma_f32_16x16x32_bf16 v[208:211], a[228:231], v[100:103], v[208:211]
    v_exp_f32 v213, v213
    v_mfma_f32_16x16x32_bf16 v[208:211], a[232:235], v[104:107], v[208:211]
    v_exp_f32 v214, v214
    v_mfma_f32_16x16x32_bf16 v[208:211], a[236:239], v[108:111], v[208:211]
    s_mov_b32 s52, s55
    v_exp_f32 v215, v215
    ds_read_b64_tr_b16 a[164:165], v20 offset:8192
    v_cvt_pk_bf16_f32 v142, v212, v213
    ds_read_b64_tr_b16 a[166:167], v20 offset:12288
    v_min_u32 v237, 19, v1
    v_lshl_add_u32 v237, v237, 7, s36
    v_lshl_add_u32 v238, v1, 7, s36
    ds_read_b128 a[220:223], v11 offset:16384
    v_cvt_pk_bf16_f32 v143, v214, v215
    buffer_load_dword v217, v57, s[32:35], s37 offen
    v_mfma_f32_16x16x32_bf16 v[212:215], a[224:227], v[112:115], v[204:207]
    v_exp_f32 v208, v208
    v_mfma_f32_16x16x32_bf16 v[212:215], a[228:231], v[116:119], v[212:215]
    v_exp_f32 v209, v209
    v_mfma_f32_16x16x32_bf16 v[212:215], a[232:235], v[120:123], v[212:215]
    s_mul_i32 s37, s5, 18432
    v_exp_f32 v210, v210
    v_mfma_f32_16x16x32_bf16 v[212:215], a[236:239], v[124:127], v[212:215]
    s_add_u32 s37, s37, s45
    v_exp_f32 v211, v211
    ds_read_b64_tr_b16 a[168:169], v21 offset:0
    v_cvt_pk_bf16_f32 v150, v208, v209
    ds_read_b64_tr_b16 a[170:171], v21 offset:4096
    v_min_u32 v236, 143, v0
    v_lshl_add_u32 v236, v236, 7, s37
    v_mul_u32_u24 v235, 24, v0
    v_lshrrev_b32 v235, 8, v235
    v_lshl_add_u32 v235, v235, 7, s37
    ds_read_b128 a[224:227], v8 offset:20480
    v_cvt_pk_bf16_f32 v151, v210, v211
    s_waitcnt lgkmcnt(3)
    buffer_load_dwordx4 v38, s[8:11], s40 offen offset:2048 lds
Lattn_loop:
    v_mfma_f32_16x16x32_bf16 v[208:211], a[208:211], v[64:67], v[192:195]
    v_exp_f32 v212, v212
    v_mfma_f32_16x16x32_bf16 v[208:211], a[212:215], v[68:71], v[208:211]
    v_exp_f32 v213, v213
    v_mfma_f32_16x16x32_bf16 v[208:211], a[216:219], v[72:75], v[208:211]
    v_exp_f32 v214, v214
    v_mfma_f32_16x16x32_bf16 v[208:211], a[220:223], v[76:79], v[208:211]
    v_exp_f32 v215, v215
    v_mfma_f32_16x16x32_bf16 a[0:3], a[160:163], v[128:131], a[0:3]
    ds_read_b64_tr_b16 a[172:173], v21 offset:8192
    v_cvt_pk_bf16_f32 v158, v212, v213
    v_mfma_f32_16x16x32_bf16 a[0:3], a[164:167], v[132:135], a[0:3]
    ds_read_b64_tr_b16 a[174:175], v21 offset:12288
    v_mfma_f32_16x16x32_bf16 a[4:7], a[160:163], v[136:139], a[4:7]
    ds_read_b128 a[228:231], v9 offset:20480
    v_cvt_pk_bf16_f32 v159, v214, v215
    v_mfma_f32_16x16x32_bf16 a[4:7], a[164:167], v[140:143], a[4:7]
    v_mfma_f32_16x16x32_bf16 v[212:215], a[208:211], v[80:83], v[196:199]
    v_exp_f32 v208, v208
    v_mfma_f32_16x16x32_bf16 v[212:215], a[212:215], v[84:87], v[212:215]
    v_exp_f32 v209, v209
    v_mfma_f32_16x16x32_bf16 v[212:215], a[216:219], v[88:91], v[212:215]
    v_exp_f32 v210, v210
    v_mfma_f32_16x16x32_bf16 v[212:215], a[220:223], v[92:95], v[212:215]
    v_exp_f32 v211, v211
    v_mfma_f32_16x16x32_bf16 a[8:11], a[160:163], v[144:147], a[8:11]
    ds_read_b64_tr_b16 a[176:177], v22 offset:0
    v_cvt_pk_bf16_f32 v160, v208, v209
    v_mfma_f32_16x16x32_bf16 a[8:11], a[164:167], v[148:151], a[8:11]
    ds_read_b64_tr_b16 a[178:179], v22 offset:4096
    v_mfma_f32_16x16x32_bf16 a[12:15], a[160:163], v[152:155], a[12:15]
    ds_read_b128 a[232:235], v10 offset:20480
    v_cvt_pk_bf16_f32 v161, v210, v211
    v_mfma_f32_16x16x32_bf16 a[12:15], a[164:167], v[156:159], a[12:15]
    s_waitcnt lgkmcnt(3)
    buffer_load_dwordx4 v39, s[8:11], s40 offen offset:3072 lds
    v_mfma_f32_16x16x32_bf16 v[208:211], a[208:211], v[96:99], v[200:203]
    v_exp_f32 v212, v212
    v_mfma_f32_16x16x32_bf16 v[208:211], a[212:215], v[100:103], v[208:211]
    s_add_u32 s40, s40, 16384
    v_exp_f32 v213, v213
    v_mfma_f32_16x16x32_bf16 v[208:211], a[216:219], v[104:107], v[208:211]
    s_mov_b32 m0, s6
    v_exp_f32 v214, v214
    v_mfma_f32_16x16x32_bf16 v[208:211], a[220:223], v[108:111], v[208:211]
    v_exp_f32 v215, v215
    v_mfma_f32_16x16x32_bf16 a[16:19], a[168:171], v[128:131], a[16:19]
    ds_read_b64_tr_b16 a[180:181], v22 offset:8192
    v_cvt_pk_bf16_f32 v168, v212, v213
    v_mfma_f32_16x16x32_bf16 a[16:19], a[172:175], v[132:135], a[16:19]
    ds_read_b64_tr_b16 a[182:183], v22 offset:12288
    v_mfma_f32_16x16x32_bf16 a[20:23], a[168:171], v[136:139], a[20:23]
    ds_read_b128 a[236:239], v11 offset:20480
    v_cvt_pk_bf16_f32 v169, v214, v215
    v_mfma_f32_16x16x32_bf16 a[20:23], a[172:175], v[140:143], a[20:23]
    buffer_load_dwordx4 v254, s[32:35], s57 offen  lds
    v_smfmac_f32_16x16x64_bf16 a[192:195], v[52:55], v[128:135], v50
    v_mfma_f32_16x16x32_bf16 v[212:215], a[208:211], v[112:115], v[204:207]
    v_exp_f32 v208, v208
    v_mfma_f32_16x16x32_bf16 v[212:215], a[212:215], v[116:119], v[212:215]
    s_add_u32 m0, s42, 98304
    v_exp_f32 v209, v209
    v_mfma_f32_16x16x32_bf16 v[212:215], a[216:219], v[120:123], v[212:215]
    v_exp_f32 v210, v210
    v_mfma_f32_16x16x32_bf16 v[212:215], a[220:223], v[124:127], v[212:215]
    v_exp_f32 v211, v211
    v_mfma_f32_16x16x32_bf16 a[24:27], a[168:171], v[144:147], a[24:27]
    ds_read_b64_tr_b16 a[184:185], v23 offset:0
    v_cvt_pk_bf16_f32 v176, v208, v209
    v_mfma_f32_16x16x32_bf16 a[24:27], a[172:175], v[148:151], a[24:27]
    ds_read_b64_tr_b16 a[186:187], v23 offset:4096
    v_mfma_f32_16x16x32_bf16 a[28:31], a[168:171], v[152:155], a[28:31]
    ds_read_b128 a[208:211], v8 offset:24576
    v_cvt_pk_bf16_f32 v177, v210, v211
    v_mfma_f32_16x16x32_bf16 a[28:31], a[172:175], v[156:159], a[28:31]
    s_waitcnt lgkmcnt(3)
    buffer_load_dwordx4 v40, s[12:15], s41 offen lds
    v_mfma_f32_16x16x32_bf16 v[208:211], a[224:227], v[64:67], v[192:195]
    v_exp_f32 v212, v212
    v_mfma_f32_16x16x32_bf16 v[208:211], a[228:231], v[68:71], v[208:211]
    s_add_u32 s6, s6, 4096
    v_exp_f32 v213, v213
    v_mfma_f32_16x16x32_bf16 v[208:211], a[232:235], v[72:75], v[208:211]
    s_add_u32 s57, s57, 589824
    v_exp_f32 v214, v214
    v_mfma_f32_16x16x32_bf16 v[208:211], a[236:239], v[76:79], v[208:211]
    v_exp_f32 v215, v215
    v_mfma_f32_16x16x32_bf16 a[32:35], a[176:179], v[128:131], a[32:35]
    ds_read_b64_tr_b16 a[188:189], v23 offset:8192
    v_cvt_pk_bf16_f32 v184, v212, v213
    v_mfma_f32_16x16x32_bf16 a[32:35], a[180:183], v[132:135], a[32:35]
    ds_read_b64_tr_b16 a[190:191], v23 offset:12288
    v_mfma_f32_16x16x32_bf16 a[36:39], a[176:179], v[136:139], a[36:39]
    ds_read_b128 a[212:215], v9 offset:24576
    v_cvt_pk_bf16_f32 v185, v214, v215
    v_mfma_f32_16x16x32_bf16 a[36:39], a[180:183], v[140:143], a[36:39]
    v_smfmac_f32_16x16x64_bf16 a[196:199], v[52:55], v[136:143], v50
    v_mfma_f32_16x16x32_bf16 v[212:215], a[224:227], v[80:83], v[196:199]
    v_exp_f32 v208, v208
    v_mfma_f32_16x16x32_bf16 v[212:215], a[228:231], v[84:87], v[212:215]
    v_exp_f32 v209, v209
    v_mfma_f32_16x16x32_bf16 v[212:215], a[232:235], v[88:91], v[212:215]
    v_exp_f32 v210, v210
    v_mfma_f32_16x16x32_bf16 v[212:215], a[236:239], v[92:95], v[212:215]
    v_exp_f32 v211, v211
    v_mfma_f32_16x16x32_bf16 a[40:43], a[176:179], v[144:147], a[40:43]
    ds_read_b64_tr_b16 a[160:161], v24 offset:0
    v_cvt_pk_bf16_f32 v162, v208, v209
    v_mfma_f32_16x16x32_bf16 a[40:43], a[180:183], v[148:151], a[40:43]
    ds_read_b64_tr_b16 a[162:163], v24 offset:4096
    v_mfma_f32_16x16x32_bf16 a[44:47], a[176:179], v[152:155], a[44:47]
    ds_read_b128 a[216:219], v10 offset:24576
    v_cvt_pk_bf16_f32 v163, v210, v211
    v_mfma_f32_16x16x32_bf16 a[44:47], a[180:183], v[156:159], a[44:47]
    s_waitcnt lgkmcnt(3)
    buffer_load_dwordx4 v41, s[12:15], s41 offen offset:1024 lds
    v_mfma_f32_16x16x32_bf16 v[208:211], a[224:227], v[96:99], v[200:203]
    v_exp_f32 v212, v212
    v_mfma_f32_16x16x32_bf16 v[208:211], a[228:231], v[100:103], v[208:211]
    v_exp_f32 v213, v213
    v_mfma_f32_16x16x32_bf16 v[208:211], a[232:235], v[104:107], v[208:211]
    v_exp_f32 v214, v214
    v_mfma_f32_16x16x32_bf16 v[208:211], a[236:239], v[108:111], v[208:211]
    v_exp_f32 v215, v215
    v_mfma_f32_16x16x32_bf16 a[48:51], a[184:187], v[128:131], a[48:51]
    ds_read_b64_tr_b16 a[164:165], v24 offset:8192
    v_cvt_pk_bf16_f32 v170, v212, v213
    v_mfma_f32_16x16x32_bf16 a[48:51], a[188:191], v[132:135], a[48:51]
    ds_read_b64_tr_b16 a[166:167], v24 offset:12288
    v_mfma_f32_16x16x32_bf16 a[52:55], a[184:187], v[136:139], a[52:55]
    ds_read_b128 a[220:223], v11 offset:24576
    v_cvt_pk_bf16_f32 v171, v214, v215
    v_mfma_f32_16x16x32_bf16 a[52:55], a[188:191], v[140:143], a[52:55]
    v_smfmac_f32_16x16x64_bf16 a[200:203], v[52:55], v[144:151], v50
    v_mfma_f32_16x16x32_bf16 v[212:215], a[224:227], v[112:115], v[204:207]
    v_exp_f32 v208, v208
    v_mfma_f32_16x16x32_bf16 v[212:215], a[228:231], v[116:119], v[212:215]
    v_exp_f32 v209, v209
    v_mfma_f32_16x16x32_bf16 v[212:215], a[232:235], v[120:123], v[212:215]
    v_exp_f32 v210, v210
    v_mfma_f32_16x16x32_bf16 v[212:215], a[236:239], v[124:127], v[212:215]
    v_exp_f32 v211, v211
    v_mfma_f32_16x16x32_bf16 a[56:59], a[184:187], v[144:147], a[56:59]
    ds_read_b64_tr_b16 a[168:169], v25 offset:0
    v_cvt_pk_bf16_f32 v178, v208, v209
    v_mfma_f32_16x16x32_bf16 a[56:59], a[188:191], v[148:151], a[56:59]
    ds_read_b64_tr_b16 a[170:171], v25 offset:4096
    v_mfma_f32_16x16x32_bf16 a[60:63], a[184:187], v[152:155], a[60:63]
    ds_read_b128 a[224:227], v8 offset:28672
    v_cvt_pk_bf16_f32 v179, v210, v211
    v_mfma_f32_16x16x32_bf16 a[60:63], a[188:191], v[156:159], a[60:63]
    s_waitcnt lgkmcnt(3)
    buffer_load_dwordx4 v40, s[12:15], s41 offen offset:2048 lds
    v_mfma_f32_16x16x32_bf16 v[208:211], a[208:211], v[64:67], v[192:195]
    v_exp_f32 v212, v212
    v_mfma_f32_16x16x32_bf16 v[208:211], a[212:215], v[68:71], v[208:211]
    v_exp_f32 v213, v213
    v_mfma_f32_16x16x32_bf16 v[208:211], a[216:219], v[72:75], v[208:211]
    v_exp_f32 v214, v214
    v_mfma_f32_16x16x32_bf16 v[208:211], a[220:223], v[76:79], v[208:211]
    v_exp_f32 v215, v215
    v_mfma_f32_16x16x32_bf16 a[64:67], a[160:163], v[128:131], a[64:67]
    ds_read_b64_tr_b16 a[172:173], v25 offset:8192
    v_cvt_pk_bf16_f32 v186, v212, v213
    v_mfma_f32_16x16x32_bf16 a[64:67], a[164:167], v[132:135], a[64:67]
    ds_read_b64_tr_b16 a[174:175], v25 offset:12288
    v_mfma_f32_16x16x32_bf16 a[68:71], a[160:163], v[136:139], a[68:71]
    ds_read_b128 a[228:231], v9 offset:28672
    v_cvt_pk_bf16_f32 v187, v214, v215
    v_mfma_f32_16x16x32_bf16 a[68:71], a[164:167], v[140:143], a[68:71]
    v_smfmac_f32_16x16x64_bf16 a[204:207], v[52:55], v[152:159], v50
    v_mfma_f32_16x16x32_bf16 v[212:215], a[208:211], v[80:83], v[196:199]
    v_exp_f32 v208, v208
    v_mfma_f32_16x16x32_bf16 v[212:215], a[212:215], v[84:87], v[212:215]
    v_exp_f32 v209, v209
    v_mfma_f32_16x16x32_bf16 v[212:215], a[216:219], v[88:91], v[212:215]
    v_exp_f32 v210, v210
    v_mfma_f32_16x16x32_bf16 v[212:215], a[220:223], v[92:95], v[212:215]
    v_exp_f32 v211, v211
    v_mfma_f32_16x16x32_bf16 a[72:75], a[160:163], v[144:147], a[72:75]
    ds_read_b64_tr_b16 a[176:177], v26 offset:0
    v_cvt_pk_bf16_f32 v164, v208, v209
    v_mfma_f32_16x16x32_bf16 a[72:75], a[164:167], v[148:151], a[72:75]
    ds_read_b64_tr_b16 a[178:179], v26 offset:4096
    v_mfma_f32_16x16x32_bf16 a[76:79], a[160:163], v[152:155], a[76:79]
    ds_read_b128 a[232:235], v10 offset:28672
    v_cvt_pk_bf16_f32 v165, v210, v211
    v_mfma_f32_16x16x32_bf16 a[76:79], a[164:167], v[156:159], a[76:79]
    s_waitcnt lgkmcnt(3)
    buffer_load_dwordx4 v41, s[12:15], s41 offen offset:3072 lds
    v_mfma_f32_16x16x32_bf16 v[208:211], a[208:211], v[96:99], v[200:203]
    v_exp_f32 v212, v212
    v_mfma_f32_16x16x32_bf16 v[208:211], a[212:215], v[100:103], v[208:211]
    s_add_u32 s41, s41, 16384
    v_exp_f32 v213, v213
    v_mfma_f32_16x16x32_bf16 v[208:211], a[216:219], v[104:107], v[208:211]
    v_exp_f32 v214, v214
    v_mfma_f32_16x16x32_bf16 v[208:211], a[220:223], v[108:111], v[208:211]
    v_exp_f32 v215, v215
    v_mfma_f32_16x16x32_bf16 a[80:83], a[168:171], v[128:131], a[80:83]
    ds_read_b64_tr_b16 a[180:181], v26 offset:8192
    v_cvt_pk_bf16_f32 v172, v212, v213
    v_mfma_f32_16x16x32_bf16 a[80:83], a[172:175], v[132:135], a[80:83]
    ds_read_b64_tr_b16 a[182:183], v26 offset:12288
    v_mfma_f32_16x16x32_bf16 a[84:87], a[168:171], v[136:139], a[84:87]
    ds_read_b128 a[236:239], v11 offset:28672
    v_cvt_pk_bf16_f32 v173, v214, v215
    v_mfma_f32_16x16x32_bf16 a[84:87], a[172:175], v[140:143], a[84:87]
    s_waitcnt vmcnt(10)
    s_barrier
    v_mfma_f32_16x16x32_bf16 v[212:215], a[208:211], v[112:115], v[204:207]
    v_exp_f32 v208, v208
    v_mfma_f32_16x16x32_bf16 v[212:215], a[212:215], v[116:119], v[212:215]
    s_add_u32 m0, s42, 0
    v_exp_f32 v209, v209
    v_mfma_f32_16x16x32_bf16 v[212:215], a[216:219], v[120:123], v[212:215]
    v_exp_f32 v210, v210
    v_mfma_f32_16x16x32_bf16 v[212:215], a[220:223], v[124:127], v[212:215]
    v_exp_f32 v211, v211
    v_mfma_f32_16x16x32_bf16 a[88:91], a[168:171], v[144:147], a[88:91]
    ds_read_b64_tr_b16 a[184:185], v27 offset:0
    v_cvt_pk_bf16_f32 v180, v208, v209
    v_mfma_f32_16x16x32_bf16 a[88:91], a[172:175], v[148:151], a[88:91]
    ds_read_b64_tr_b16 a[186:187], v27 offset:4096
    v_mfma_f32_16x16x32_bf16 a[92:95], a[168:171], v[152:155], a[92:95]
    ds_read_b128 a[208:211], v8 offset:32768
    v_cvt_pk_bf16_f32 v181, v210, v211
    v_mfma_f32_16x16x32_bf16 a[92:95], a[172:175], v[156:159], a[92:95]
    s_waitcnt lgkmcnt(3)
    buffer_load_dwordx4 v36, s[8:11], s40 offen lds
    v_mfma_f32_16x16x32_bf16 v[208:211], a[224:227], v[64:67], v[192:195]
    v_exp_f32 v212, v212
    v_mfma_f32_16x16x32_bf16 v[208:211], a[228:231], v[68:71], v[208:211]
    v_exp_f32 v213, v213
    v_mfma_f32_16x16x32_bf16 v[208:211], a[232:235], v[72:75], v[208:211]
    v_exp_f32 v214, v214
    v_mfma_f32_16x16x32_bf16 v[208:211], a[236:239], v[76:79], v[208:211]
    v_exp_f32 v215, v215
    v_mfma_f32_16x16x32_bf16 a[96:99], a[176:179], v[128:131], a[96:99]
    ds_read_b64_tr_b16 a[188:189], v27 offset:8192
    v_cvt_pk_bf16_f32 v188, v212, v213
    v_mfma_f32_16x16x32_bf16 a[96:99], a[180:183], v[132:135], a[96:99]
    ds_read_b64_tr_b16 a[190:191], v27 offset:12288
    v_mfma_f32_16x16x32_bf16 a[100:103], a[176:179], v[136:139], a[100:103]
    ds_read_b128 a[212:215], v9 offset:32768
    v_cvt_pk_bf16_f32 v189, v214, v215
    v_mfma_f32_16x16x32_bf16 a[100:103], a[180:183], v[140:143], a[100:103]
    v_mfma_f32_16x16x32_bf16 v[212:215], a[224:227], v[80:83], v[196:199]
    v_exp_f32 v208, v208
    v_mfma_f32_16x16x32_bf16 v[212:215], a[228:231], v[84:87], v[212:215]
    v_exp_f32 v209, v209
    v_mfma_f32_16x16x32_bf16 v[212:215], a[232:235], v[88:91], v[212:215]
    v_exp_f32 v210, v210
    v_mfma_f32_16x16x32_bf16 v[212:215], a[236:239], v[92:95], v[212:215]
    v_exp_f32 v211, v211
    v_mfma_f32_16x16x32_bf16 a[104:107], a[176:179], v[144:147], a[104:107]
    ds_read_b64_tr_b16 a[160:161], v20 offset:16384
    v_cvt_pk_bf16_f32 v166, v208, v209
    v_mfma_f32_16x16x32_bf16 a[104:107], a[180:183], v[148:151], a[104:107]
    ds_read_b64_tr_b16 a[162:163], v20 offset:20480
    v_mfma_f32_16x16x32_bf16 a[108:111], a[176:179], v[152:155], a[108:111]
    ds_read_b128 a[216:219], v10 offset:32768
    v_cvt_pk_bf16_f32 v167, v210, v211
    v_mfma_f32_16x16x32_bf16 a[108:111], a[180:183], v[156:159], a[108:111]
    s_waitcnt lgkmcnt(3)
    buffer_load_dwordx4 v37, s[8:11], s40 offen offset:1024 lds
    v_mfma_f32_16x16x32_bf16 v[208:211], a[224:227], v[96:99], v[200:203]
    v_exp_f32 v212, v212
    v_mfma_f32_16x16x32_bf16 v[208:211], a[228:231], v[100:103], v[208:211]
    v_exp_f32 v213, v213
    v_mfma_f32_16x16x32_bf16 v[208:211], a[232:235], v[104:107], v[208:211]
    v_exp_f32 v214, v214
    v_mfma_f32_16x16x32_bf16 v[208:211], a[236:239], v[108:111], v[208:211]
    v_exp_f32 v215, v215
    v_mfma_f32_16x16x32_bf16 a[112:115], a[184:187], v[128:131], a[112:115]
    ds_read_b64_tr_b16 a[164:165], v20 offset:24576
    v_cvt_pk_bf16_f32 v174, v212, v213
    v_mfma_f32_16x16x32_bf16 a[112:115], a[188:191], v[132:135], a[112:115]
    ds_read_b64_tr_b16 a[166:167], v20 offset:28672
    v_mfma_f32_16x16x32_bf16 a[116:119], a[184:187], v[136:139], a[116:119]
    ds_read_b128 a[220:223], v11 offset:32768
    v_cvt_pk_bf16_f32 v175, v214, v215
    v_mfma_f32_16x16x32_bf16 a[116:119], a[188:191], v[140:143], a[116:119]
    buffer_load_dwordx4 v[240:243], v7, s[16:19], s44 offen
    v_mfma_f32_16x16x32_bf16 v[212:215], a[224:227], v[112:115], v[204:207]
    v_exp_f32 v208, v208
    v_mfma_f32_16x16x32_bf16 v[212:215], a[228:231], v[116:119], v[212:215]
    v_exp_f32 v209, v209
    v_mfma_f32_16x16x32_bf16 v[212:215], a[232:235], v[120:123], v[212:215]
    v_exp_f32 v210, v210
    v_mfma_f32_16x16x32_bf16 v[212:215], a[236:239], v[124:127], v[212:215]
    s_add_u32 s44, s44, 884736
    v_exp_f32 v211, v211
    v_mfma_f32_16x16x32_bf16 a[120:123], a[184:187], v[144:147], a[120:123]
    ds_read_b64_tr_b16 a[168:169], v21 offset:16384
    v_cvt_pk_bf16_f32 v182, v208, v209
    v_mfma_f32_16x16x32_bf16 a[120:123], a[188:191], v[148:151], a[120:123]
    ds_read_b64_tr_b16 a[170:171], v21 offset:20480
    v_mfma_f32_16x16x32_bf16 a[124:127], a[184:187], v[152:155], a[124:127]
    ds_read_b128 a[224:227], v8 offset:36864
    v_cvt_pk_bf16_f32 v183, v210, v211
    v_mfma_f32_16x16x32_bf16 a[124:127], a[188:191], v[156:159], a[124:127]
    s_waitcnt lgkmcnt(3)
    buffer_load_dwordx4 v38, s[8:11], s40 offen offset:2048 lds
    v_mfma_f32_16x16x32_bf16 v[208:211], a[208:211], v[64:67], v[192:195]
    v_exp_f32 v212, v212
    v_mfma_f32_16x16x32_bf16 v[208:211], a[212:215], v[68:71], v[208:211]
    v_exp_f32 v213, v213
    v_mfma_f32_16x16x32_bf16 v[208:211], a[216:219], v[72:75], v[208:211]
    v_exp_f32 v214, v214
    v_mfma_f32_16x16x32_bf16 v[208:211], a[220:223], v[76:79], v[208:211]
    v_exp_f32 v215, v215
    v_mfma_f32_16x16x32_bf16 a[0:3], a[160:163], v[160:163], a[0:3]
    ds_read_b64_tr_b16 a[172:173], v21 offset:24576
    v_cvt_pk_bf16_f32 v190, v212, v213
    v_mfma_f32_16x16x32_bf16 a[0:3], a[164:167], v[164:167], a[0:3]
    ds_read_b64_tr_b16 a[174:175], v21 offset:28672
    v_mfma_f32_16x16x32_bf16 a[4:7], a[160:163], v[168:171], a[4:7]
    ds_read_b128 a[228:231], v9 offset:36864
    v_cvt_pk_bf16_f32 v191, v214, v215
    v_mfma_f32_16x16x32_bf16 a[4:7], a[164:167], v[172:175], a[4:7]
    v_mfma_f32_16x16x32_bf16 v[212:215], a[208:211], v[80:83], v[196:199]
    v_exp_f32 v208, v208
    v_mfma_f32_16x16x32_bf16 v[212:215], a[212:215], v[84:87], v[212:215]
    v_exp_f32 v209, v209
    v_mfma_f32_16x16x32_bf16 v[212:215], a[216:219], v[88:91], v[212:215]
    v_exp_f32 v210, v210
    v_mfma_f32_16x16x32_bf16 v[212:215], a[220:223], v[92:95], v[212:215]
    v_exp_f32 v211, v211
    v_mfma_f32_16x16x32_bf16 a[8:11], a[160:163], v[176:179], a[8:11]
    ds_read_b64_tr_b16 a[176:177], v22 offset:16384
    v_cvt_pk_bf16_f32 v128, v208, v209
    v_mfma_f32_16x16x32_bf16 a[8:11], a[164:167], v[180:183], a[8:11]
    ds_read_b64_tr_b16 a[178:179], v22 offset:20480
    v_mfma_f32_16x16x32_bf16 a[12:15], a[160:163], v[184:187], a[12:15]
    ds_read_b128 a[232:235], v10 offset:36864
    v_cvt_pk_bf16_f32 v129, v210, v211
    v_mfma_f32_16x16x32_bf16 a[12:15], a[164:167], v[188:191], a[12:15]
    s_waitcnt lgkmcnt(3)
    buffer_load_dwordx4 v39, s[8:11], s40 offen offset:3072 lds
    v_mfma_f32_16x16x32_bf16 v[208:211], a[208:211], v[96:99], v[200:203]
    v_exp_f32 v212, v212
    v_mfma_f32_16x16x32_bf16 v[208:211], a[212:215], v[100:103], v[208:211]
    s_add_u32 s40, s40, 16384
    v_exp_f32 v213, v213
    v_mfma_f32_16x16x32_bf16 v[208:211], a[216:219], v[104:107], v[208:211]
    v_exp_f32 v214, v214
    v_mfma_f32_16x16x32_bf16 v[208:211], a[220:223], v[108:111], v[208:211]
    v_exp_f32 v215, v215
    v_mfma_f32_16x16x32_bf16 a[16:19], a[168:171], v[160:163], a[16:19]
    ds_read_b64_tr_b16 a[180:181], v22 offset:24576
    v_cvt_pk_bf16_f32 v136, v212, v213
    v_mfma_f32_16x16x32_bf16 a[16:19], a[172:175], v[164:167], a[16:19]
    ds_read_b64_tr_b16 a[182:183], v22 offset:28672
    v_mfma_f32_16x16x32_bf16 a[20:23], a[168:171], v[168:171], a[20:23]
    ds_read_b128 a[236:239], v11 offset:36864
    v_cvt_pk_bf16_f32 v137, v214, v215
    v_mfma_f32_16x16x32_bf16 a[20:23], a[172:175], v[172:175], a[20:23]
    v_smfmac_f32_16x16x64_bf16 a[192:195], v[52:55], v[160:167], v50
    v_mfma_f32_16x16x32_bf16 v[212:215], a[208:211], v[112:115], v[204:207]
Ltour4:
    s_cbranch_execz Ltour8
    v_exp_f32 v208, v208
    v_mfma_f32_16x16x32_bf16 v[212:215], a[212:215], v[116:119], v[212:215]
    s_add_u32 m0, s42, 114688
    v_exp_f32 v209, v209
    v_mfma_f32_16x16x32_bf16 v[212:215], a[216:219], v[120:123], v[212:215]
    v_exp_f32 v210, v210
    v_mfma_f32_16x16x32_bf16 v[212:215], a[220:223], v[124:127], v[212:215]
    v_exp_f32 v211, v211
    v_mfma_f32_16x16x32_bf16 a[24:27], a[168:171], v[176:179], a[24:27]
    ds_read_b64_tr_b16 a[184:185], v23 offset:16384
    v_cvt_pk_bf16_f32 v144, v208, v209
    v_mfma_f32_16x16x32_bf16 a[24:27], a[172:175], v[180:183], a[24:27]
    ds_read_b64_tr_b16 a[186:187], v23 offset:20480
    v_mfma_f32_16x16x32_bf16 a[28:31], a[168:171], v[184:187], a[28:31]
    ds_read_b128 a[208:211], v8 offset:40960
    v_cvt_pk_bf16_f32 v145, v210, v211
    v_mfma_f32_16x16x32_bf16 a[28:31], a[172:175], v[188:191], a[28:31]
    s_waitcnt lgkmcnt(3)
    buffer_load_dwordx4 v40, s[12:15], s41 offen lds
    v_mfma_f32_16x16x32_bf16 v[208:211], a[224:227], v[64:67], v[192:195]
    v_exp_f32 v212, v212
    v_mfma_f32_16x16x32_bf16 v[208:211], a[228:231], v[68:71], v[208:211]
    v_exp_f32 v213, v213
    v_mfma_f32_16x16x32_bf16 v[208:211], a[232:235], v[72:75], v[208:211]
    v_exp_f32 v214, v214
    v_mfma_f32_16x16x32_bf16 v[208:211], a[236:239], v[76:79], v[208:211]
    v_exp_f32 v215, v215
    v_mfma_f32_16x16x32_bf16 a[32:35], a[176:179], v[160:163], a[32:35]
    ds_read_b64_tr_b16 a[188:189], v23 offset:24576
    v_cvt_pk_bf16_f32 v152, v212, v213
    v_mfma_f32_16x16x32_bf16 a[32:35], a[180:183], v[164:167], a[32:35]
    ds_read_b64_tr_b16 a[190:191], v23 offset:28672
    v_mfma_f32_16x16x32_bf16 a[36:39], a[176:179], v[168:171], a[36:39]
    ds_read_b128 a[212:215], v9 offset:40960
    v_cvt_pk_bf16_f32 v153, v214, v215
    v_mfma_f32_16x16x32_bf16 a[36:39], a[180:183], v[172:175], a[36:39]
    v_smfmac_f32_16x16x64_bf16 a[196:199], v[52:55], v[168:175], v50
    v_mfma_f32_16x16x32_bf16 v[212:215], a[224:227], v[80:83], v[196:199]
    v_exp_f32 v208, v208
    v_mfma_f32_16x16x32_bf16 v[212:215], a[228:231], v[84:87], v[212:215]
    v_exp_f32 v209, v209
    v_mfma_f32_16x16x32_bf16 v[212:215], a[232:235], v[88:91], v[212:215]
    v_exp_f32 v210, v210
    v_mfma_f32_16x16x32_bf16 v[212:215], a[236:239], v[92:95], v[212:215]
    v_exp_f32 v211, v211
    v_mfma_f32_16x16x32_bf16 a[40:43], a[176:179], v[176:179], a[40:43]
    ds_read_b64_tr_b16 a[160:161], v24 offset:16384
    v_cvt_pk_bf16_f32 v130, v208, v209
    v_mfma_f32_16x16x32_bf16 a[40:43], a[180:183], v[180:183], a[40:43]
    ds_read_b64_tr_b16 a[162:163], v24 offset:20480
    v_mfma_f32_16x16x32_bf16 a[44:47], a[176:179], v[184:187], a[44:47]
    ds_read_b128 a[216:219], v10 offset:40960
    v_cvt_pk_bf16_f32 v131, v210, v211
    v_mfma_f32_16x16x32_bf16 a[44:47], a[180:183], v[188:191], a[44:47]
    s_waitcnt lgkmcnt(3)
    buffer_load_dwordx4 v41, s[12:15], s41 offen offset:1024 lds
    v_mfma_f32_16x16x32_bf16 v[208:211], a[224:227], v[96:99], v[200:203]
    v_exp_f32 v212, v212
    v_mfma_f32_16x16x32_bf16 v[208:211], a[228:231], v[100:103], v[208:211]
    v_exp_f32 v213, v213
    v_mfma_f32_16x16x32_bf16 v[208:211], a[232:235], v[104:107], v[208:211]
    v_exp_f32 v214, v214
    v_mfma_f32_16x16x32_bf16 v[208:211], a[236:239], v[108:111], v[208:211]
    v_exp_f32 v215, v215
    v_mfma_f32_16x16x32_bf16 a[48:51], a[184:187], v[160:163], a[48:51]
    ds_read_b64_tr_b16 a[164:165], v24 offset:24576
    v_cvt_pk_bf16_f32 v138, v212, v213
    v_mfma_f32_16x16x32_bf16 a[48:51], a[188:191], v[164:167], a[48:51]
    ds_read_b64_tr_b16 a[166:167], v24 offset:28672
    v_mfma_f32_16x16x32_bf16 a[52:55], a[184:187], v[168:171], a[52:55]
    ds_read_b128 a[220:223], v11 offset:40960
    v_cvt_pk_bf16_f32 v139, v214, v215
    v_mfma_f32_16x16x32_bf16 a[52:55], a[188:191], v[172:175], a[52:55]
    v_smfmac_f32_16x16x64_bf16 a[200:203], v[52:55], v[176:183], v50
    v_mfma_f32_16x16x32_bf16 v[212:215], a[224:227], v[112:115], v[204:207]
    v_exp_f32 v208, v208
    v_mfma_f32_16x16x32_bf16 v[212:215], a[228:231], v[116:119], v[212:215]
    v_exp_f32 v209, v209
    v_mfma_f32_16x16x32_bf16 v[212:215], a[232:235], v[120:123], v[212:215]
    v_exp_f32 v210, v210
    v_mfma_f32_16x16x32_bf16 v[212:215], a[236:239], v[124:127], v[212:215]
    v_exp_f32 v211, v211
    v_mfma_f32_16x16x32_bf16 a[56:59], a[184:187], v[176:179], a[56:59]
    ds_read_b64_tr_b16 a[168:169], v25 offset:16384
    v_cvt_pk_bf16_f32 v146, v208, v209
    v_mfma_f32_16x16x32_bf16 a[56:59], a[188:191], v[180:183], a[56:59]
    ds_read_b64_tr_b16 a[170:171], v25 offset:20480
    v_mfma_f32_16x16x32_bf16 a[60:63], a[184:187], v[184:187], a[60:63]
    ds_read_b128 a[224:227], v8 offset:45056
    v_cvt_pk_bf16_f32 v147, v210, v211
    v_mfma_f32_16x16x32_bf16 a[60:63], a[188:191], v[188:191], a[60:63]
    s_waitcnt lgkmcnt(3)
    buffer_load_dwordx4 v40, s[12:15], s41 offen offset:2048 lds
    v_mfma_f32_16x16x32_bf16 v[208:211], a[208:211], v[64:67], v[192:195]
    v_exp_f32 v212, v212
    v_mfma_f32_16x16x32_bf16 v[208:211], a[212:215], v[68:71], v[208:211]
    v_exp_f32 v213, v213
    v_mfma_f32_16x16x32_bf16 v[208:211], a[216:219], v[72:75], v[208:211]
    v_exp_f32 v214, v214
    v_mfma_f32_16x16x32_bf16 v[208:211], a[220:223], v[76:79], v[208:211]
    v_exp_f32 v215, v215
    v_mfma_f32_16x16x32_bf16 a[64:67], a[160:163], v[160:163], a[64:67]
    ds_read_b64_tr_b16 a[172:173], v25 offset:24576
    v_cvt_pk_bf16_f32 v154, v212, v213
    v_mfma_f32_16x16x32_bf16 a[64:67], a[164:167], v[164:167], a[64:67]
    ds_read_b64_tr_b16 a[174:175], v25 offset:28672
    v_mfma_f32_16x16x32_bf16 a[68:71], a[160:163], v[168:171], a[68:71]
    ds_read_b128 a[228:231], v9 offset:45056
    v_cvt_pk_bf16_f32 v155, v214, v215
    v_mfma_f32_16x16x32_bf16 a[68:71], a[164:167], v[172:175], a[68:71]
    v_smfmac_f32_16x16x64_bf16 a[204:207], v[52:55], v[184:191], v50
    v_mfma_f32_16x16x32_bf16 v[212:215], a[208:211], v[80:83], v[196:199]
    v_exp_f32 v208, v208
    v_mfma_f32_16x16x32_bf16 v[212:215], a[212:215], v[84:87], v[212:215]
    v_exp_f32 v209, v209
    v_mfma_f32_16x16x32_bf16 v[212:215], a[216:219], v[88:91], v[212:215]
    v_exp_f32 v210, v210
    v_mfma_f32_16x16x32_bf16 v[212:215], a[220:223], v[92:95], v[212:215]
    v_exp_f32 v211, v211
    v_mfma_f32_16x16x32_bf16 a[72:75], a[160:163], v[176:179], a[72:75]
    ds_read_b64_tr_b16 a[176:177], v26 offset:16384
    v_cvt_pk_bf16_f32 v132, v208, v209
    v_mfma_f32_16x16x32_bf16 a[72:75], a[164:167], v[180:183], a[72:75]
    ds_read_b64_tr_b16 a[178:179], v26 offset:20480
    v_mfma_f32_16x16x32_bf16 a[76:79], a[160:163], v[184:187], a[76:79]
    ds_read_b128 a[232:235], v10 offset:45056
    v_cvt_pk_bf16_f32 v133, v210, v211
    v_mfma_f32_16x16x32_bf16 a[76:79], a[164:167], v[188:191], a[76:79]
    s_waitcnt lgkmcnt(3)
    buffer_load_dwordx4 v41, s[12:15], s41 offen offset:3072 lds
    v_mfma_f32_16x16x32_bf16 v[208:211], a[208:211], v[96:99], v[200:203]
    v_exp_f32 v212, v212
    v_mfma_f32_16x16x32_bf16 v[208:211], a[212:215], v[100:103], v[208:211]
    s_add_u32 s41, s41, 16384
    v_exp_f32 v213, v213
    v_mfma_f32_16x16x32_bf16 v[208:211], a[216:219], v[104:107], v[208:211]
    v_exp_f32 v214, v214
    v_mfma_f32_16x16x32_bf16 v[208:211], a[220:223], v[108:111], v[208:211]
    v_exp_f32 v215, v215
    v_mfma_f32_16x16x32_bf16 a[80:83], a[168:171], v[160:163], a[80:83]
    ds_read_b64_tr_b16 a[180:181], v26 offset:24576
    v_cvt_pk_bf16_f32 v140, v212, v213
    v_mfma_f32_16x16x32_bf16 a[80:83], a[172:175], v[164:167], a[80:83]
    ds_read_b64_tr_b16 a[182:183], v26 offset:28672
    v_mfma_f32_16x16x32_bf16 a[84:87], a[168:171], v[168:171], a[84:87]
    ds_read_b128 a[236:239], v11 offset:45056
    v_cvt_pk_bf16_f32 v141, v214, v215
    v_mfma_f32_16x16x32_bf16 a[84:87], a[172:175], v[172:175], a[84:87]
    s_waitcnt vmcnt(9)
    s_barrier
    v_mfma_f32_16x16x32_bf16 v[212:215], a[208:211], v[112:115], v[204:207]
    v_exp_f32 v208, v208
    v_mfma_f32_16x16x32_bf16 v[212:215], a[212:215], v[116:119], v[212:215]
    s_add_u32 m0, s42, 16384
    v_exp_f32 v209, v209
    v_mfma_f32_16x16x32_bf16 v[212:215], a[216:219], v[120:123], v[212:215]
    v_exp_f32 v210, v210
    v_mfma_f32_16x16x32_bf16 v[212:215], a[220:223], v[124:127], v[212:215]
    v_exp_f32 v211, v211
    v_mfma_f32_16x16x32_bf16 a[88:91], a[168:171], v[176:179], a[88:91]
    ds_read_b64_tr_b16 a[184:185], v27 offset:16384
    v_cvt_pk_bf16_f32 v148, v208, v209
    v_mfma_f32_16x16x32_bf16 a[88:91], a[172:175], v[180:183], a[88:91]
    ds_read_b64_tr_b16 a[186:187], v27 offset:20480
    v_mfma_f32_16x16x32_bf16 a[92:95], a[168:171], v[184:187], a[92:95]
    ds_read_b128 a[208:211], v8 offset:49152
    v_cvt_pk_bf16_f32 v149, v210, v211
    v_mfma_f32_16x16x32_bf16 a[92:95], a[172:175], v[188:191], a[92:95]
    s_waitcnt lgkmcnt(3)
    buffer_load_dwordx4 v36, s[8:11], s40 offen lds
    v_mfma_f32_16x16x32_bf16 v[208:211], a[224:227], v[64:67], v[192:195]
    v_exp_f32 v212, v212
    v_mfma_f32_16x16x32_bf16 v[208:211], a[228:231], v[68:71], v[208:211]
    v_exp_f32 v213, v213
    v_mfma_f32_16x16x32_bf16 v[208:211], a[232:235], v[72:75], v[208:211]
    v_exp_f32 v214, v214
    v_mfma_f32_16x16x32_bf16 v[208:211], a[236:239], v[76:79], v[208:211]
    v_exp_f32 v215, v215
    v_mfma_f32_16x16x32_bf16 a[96:99], a[176:179], v[160:163], a[96:99]
    ds_read_b64_tr_b16 a[188:189], v27 offset:24576
    v_cvt_pk_bf16_f32 v156, v212, v213
    v_mfma_f32_16x16x32_bf16 a[96:99], a[180:183], v[164:167], a[96:99]
    ds_read_b64_tr_b16 a[190:191], v27 offset:28672
    v_mfma_f32_16x16x32_bf16 a[100:103], a[176:179], v[168:171], a[100:103]
    ds_read_b128 a[212:215], v9 offset:49152
    v_cvt_pk_bf16_f32 v157, v214, v215
    v_mfma_f32_16x16x32_bf16 a[100:103], a[180:183], v[172:175], a[100:103]
    buffer_load_dword v218, v57, s[80:83], s39 offen
    v_mfma_f32_16x16x32_bf16 v[212:215], a[224:227], v[80:83], v[196:199]
    v_exp_f32 v208, v208
    v_mfma_f32_16x16x32_bf16 v[212:215], a[228:231], v[84:87], v[212:215]
    v_exp_f32 v209, v209
    v_mfma_f32_16x16x32_bf16 v[212:215], a[232:235], v[88:91], v[212:215]
    v_exp_f32 v210, v210
    v_mfma_f32_16x16x32_bf16 v[212:215], a[236:239], v[92:95], v[212:215]
    v_exp_f32 v211, v211
    v_mfma_f32_16x16x32_bf16 a[104:107], a[176:179], v[176:179], a[104:107]
    ds_read_b64_tr_b16 a[160:161], v20 offset:32768
    v_cvt_pk_bf16_f32 v134, v208, v209
    v_mfma_f32_16x16x32_bf16 a[104:107], a[180:183], v[180:183], a[104:107]
    ds_read_b64_tr_b16 a[162:163], v20 offset:36864
    v_mfma_f32_16x16x32_bf16 a[108:111], a[176:179], v[184:187], a[108:111]
    ds_read_b128 a[216:219], v10 offset:49152
    v_cvt_pk_bf16_f32 v135, v210, v211
    v_mfma_f32_16x16x32_bf16 a[108:111], a[180:183], v[188:191], a[108:111]
    s_waitcnt lgkmcnt(3)
    buffer_load_dwordx4 v37, s[8:11], s40 offen offset:1024 lds
    v_mfma_f32_16x16x32_bf16 v[208:211], a[224:227], v[96:99], v[200:203]
    v_exp_f32 v212, v212
    v_mfma_f32_16x16x32_bf16 v[208:211], a[228:231], v[100:103], v[208:211]
    v_exp_f32 v213, v213
    v_mfma_f32_16x16x32_bf16 v[208:211], a[232:235], v[104:107], v[208:211]
    v_exp_f32 v214, v214
    v_mfma_f32_16x16x32_bf16 v[208:211], a[236:239], v[108:111], v[208:211]
    v_exp_f32 v215, v215
    v_mfma_f32_16x16x32_bf16 a[112:115], a[184:187], v[160:163], a[112:115]
    ds_read_b64_tr_b16 a[164:165], v20 offset:40960
    v_cvt_pk_bf16_f32 v142, v212, v213
    v_mfma_f32_16x16x32_bf16 a[112:115], a[188:191], v[164:167], a[112:115]
    ds_read_b64_tr_b16 a[166:167], v20 offset:45056
    v_mfma_f32_16x16x32_bf16 a[116:119], a[184:187], v[168:171], a[116:119]
    ds_read_b128 a[220:223], v11 offset:49152
    v_cvt_pk_bf16_f32 v143, v214, v215
    v_mfma_f32_16x16x32_bf16 a[116:119], a[188:191], v[172:175], a[116:119]
    buffer_store_dwordx4 v[248:251], v232, s[24:27], s53 offen sc1
    v_mfma_f32_16x16x32_bf16 v[212:215], a[224:227], v[112:115], v[204:207]
    v_exp_f32 v208, v208
    v_mfma_f32_16x16x32_bf16 v[212:215], a[228:231], v[116:119], v[212:215]
    v_exp_f32 v209, v209
    v_mfma_f32_16x16x32_bf16 v[212:215], a[232:235], v[120:123], v[212:215]
    v_exp_f32 v210, v210
    v_mfma_f32_16x16x32_bf16 v[212:215], a[236:239], v[124:127], v[212:215]
    s_add_u32 s53, s53, 656
    v_exp_f32 v211, v211
    v_mfma_f32_16x16x32_bf16 a[120:123], a[184:187], v[176:179], a[120:123]
    ds_read_b64_tr_b16 a[168:169], v21 offset:32768
    v_cvt_pk_bf16_f32 v150, v208, v209
    v_mfma_f32_16x16x32_bf16 a[120:123], a[188:191], v[180:183], a[120:123]
    ds_read_b64_tr_b16 a[170:171], v21 offset:36864
    v_mfma_f32_16x16x32_bf16 a[124:127], a[184:187], v[184:187], a[124:127]
    ds_read_b128 a[224:227], v8 offset:53248
    v_cvt_pk_bf16_f32 v151, v210, v211
    v_mfma_f32_16x16x32_bf16 a[124:127], a[188:191], v[188:191], a[124:127]
    s_waitcnt lgkmcnt(3)
    buffer_load_dwordx4 v38, s[8:11], s40 offen offset:2048 lds
    v_mfma_f32_16x16x32_bf16 v[208:211], a[208:211], v[64:67], v[192:195]
    v_exp_f32 v212, v212
    v_mfma_f32_16x16x32_bf16 v[208:211], a[212:215], v[68:71], v[208:211]
    v_exp_f32 v213, v213
    v_mfma_f32_16x16x32_bf16 v[208:211], a[216:219], v[72:75], v[208:211]
    v_exp_f32 v214, v214
    v_mfma_f32_16x16x32_bf16 v[208:211], a[220:223], v[76:79], v[208:211]
    v_exp_f32 v215, v215
    v_mfma_f32_16x16x32_bf16 a[0:3], a[160:163], v[128:131], a[0:3]
    ds_read_b64_tr_b16 a[172:173], v21 offset:40960
    v_cvt_pk_bf16_f32 v158, v212, v213
    v_mfma_f32_16x16x32_bf16 a[0:3], a[164:167], v[132:135], a[0:3]
    ds_read_b64_tr_b16 a[174:175], v21 offset:45056
    v_mfma_f32_16x16x32_bf16 a[4:7], a[160:163], v[136:139], a[4:7]
    ds_read_b128 a[228:231], v9 offset:53248
    v_cvt_pk_bf16_f32 v159, v214, v215
    v_mfma_f32_16x16x32_bf16 a[4:7], a[164:167], v[140:143], a[4:7]
    v_mfma_f32_16x16x32_bf16 v[212:215], a[208:211], v[80:83], v[196:199]
    v_exp_f32 v208, v208
    v_mfma_f32_16x16x32_bf16 v[212:215], a[212:215], v[84:87], v[212:215]
    v_exp_f32 v209, v209
    v_mfma_f32_16x16x32_bf16 v[212:215], a[216:219], v[88:91], v[212:215]
    v_exp_f32 v210, v210
    v_mfma_f32_16x16x32_bf16 v[212:215], a[220:223], v[92:95], v[212:215]
    v_exp_f32 v211, v211
    v_mfma_f32_16x16x32_bf16 a[8:11], a[160:163], v[144:147], a[8:11]
    ds_read_b64_tr_b16 a[176:177], v22 offset:32768
    v_cvt_pk_bf16_f32 v160, v208, v209
    v_mfma_f32_16x16x32_bf16 a[8:11], a[164:167], v[148:151], a[8:11]
    ds_read_b64_tr_b16 a[178:179], v22 offset:36864
    v_mfma_f32_16x16x32_bf16 a[12:15], a[160:163], v[152:155], a[12:15]
    ds_read_b128 a[232:235], v10 offset:53248
    v_cvt_pk_bf16_f32 v161, v210, v211
    v_mfma_f32_16x16x32_bf16 a[12:15], a[164:167], v[156:159], a[12:15]
    s_waitcnt lgkmcnt(3)
    buffer_load_dwordx4 v39, s[8:11], s40 offen offset:3072 lds
    v_mfma_f32_16x16x32_bf16 v[208:211], a[208:211], v[96:99], v[200:203]
    v_exp_f32 v212, v212
    v_mfma_f32_16x16x32_bf16 v[208:211], a[212:215], v[100:103], v[208:211]
    s_add_u32 s40, s40, 16384
    v_exp_f32 v213, v213
    v_mfma_f32_16x16x32_bf16 v[208:211], a[216:219], v[104:107], v[208:211]
    v_exp_f32 v214, v214
    v_mfma_f32_16x16x32_bf16 v[208:211], a[220:223], v[108:111], v[208:211]
    v_exp_f32 v215, v215
    v_mfma_f32_16x16x32_bf16 a[16:19], a[168:171], v[128:131], a[16:19]
    ds_read_b64_tr_b16 a[180:181], v22 offset:40960
    v_cvt_pk_bf16_f32 v168, v212, v213
    v_mfma_f32_16x16x32_bf16 a[16:19], a[172:175], v[132:135], a[16:19]
    ds_read_b64_tr_b16 a[182:183], v22 offset:45056
    v_mfma_f32_16x16x32_bf16 a[20:23], a[168:171], v[136:139], a[20:23]
    ds_read_b128 a[236:239], v11 offset:53248
    v_cvt_pk_bf16_f32 v169, v214, v215
    v_mfma_f32_16x16x32_bf16 a[20:23], a[172:175], v[140:143], a[20:23]
    v_smfmac_f32_16x16x64_bf16 a[192:195], v[52:55], v[128:135], v50
    v_mfma_f32_16x16x32_bf16 v[212:215], a[208:211], v[112:115], v[204:207]
    v_exp_f32 v208, v208
    v_mfma_f32_16x16x32_bf16 v[212:215], a[212:215], v[116:119], v[212:215]
    s_add_u32 m0, s42, 65536
    v_exp_f32 v209, v209
    v_mfma_f32_16x16x32_bf16 v[212:215], a[216:219], v[120:123], v[212:215]
    v_exp_f32 v210, v210
    v_mfma_f32_16x16x32_bf16 v[212:215], a[220:223], v[124:127], v[212:215]
    v_exp_f32 v211, v211
    v_mfma_f32_16x16x32_bf16 a[24:27], a[168:171], v[144:147], a[24:27]
    ds_read_b64_tr_b16 a[184:185], v23 offset:32768
    v_cvt_pk_bf16_f32 v176, v208, v209
    v_mfma_f32_16x16x32_bf16 a[24:27], a[172:175], v[148:151], a[24:27]
    ds_read_b64_tr_b16 a[186:187], v23 offset:36864
    v_mfma_f32_16x16x32_bf16 a[28:31], a[168:171], v[152:155], a[28:31]
    ds_read_b128 a[208:211], v8 offset:57344
    v_cvt_pk_bf16_f32 v177, v210, v211
    v_mfma_f32_16x16x32_bf16 a[28:31], a[172:175], v[156:159], a[28:31]
    s_waitcnt lgkmcnt(3)
    buffer_load_dwordx4 v40, s[12:15], s41 offen lds
    v_mfma_f32_16x16x32_bf16 v[208:211], a[224:227], v[64:67], v[192:195]
    v_exp_f32 v212, v212
    v_mfma_f32_16x16x32_bf16 v[208:211], a[228:231], v[68:71], v[208:211]
    v_exp_f32 v213, v213
    v_mfma_f32_16x16x32_bf16 v[208:211], a[232:235], v[72:75], v[208:211]
    v_exp_f32 v214, v214
    v_mfma_f32_16x16x32_bf16 v[208:211], a[236:239], v[76:79], v[208:211]
    v_exp_f32 v215, v215
    v_mfma_f32_16x16x32_bf16 a[32:35], a[176:179], v[128:131], a[32:35]
    ds_read_b64_tr_b16 a[188:189], v23 offset:40960
    v_cvt_pk_bf16_f32 v184, v212, v213
    v_mfma_f32_16x16x32_bf16 a[32:35], a[180:183], v[132:135], a[32:35]
    ds_read_b64_tr_b16 a[190:191], v23 offset:45056
    v_mfma_f32_16x16x32_bf16 a[36:39], a[176:179], v[136:139], a[36:39]
    ds_read_b128 a[212:215], v9 offset:57344
    v_cvt_pk_bf16_f32 v185, v214, v215
    v_mfma_f32_16x16x32_bf16 a[36:39], a[180:183], v[140:143], a[36:39]
    v_smfmac_f32_16x16x64_bf16 a[196:199], v[52:55], v[136:143], v50
    v_mfma_f32_16x16x32_bf16 v[212:215], a[224:227], v[80:83], v[196:199]
    v_exp_f32 v208, v208
    v_mfma_f32_16x16x32_bf16 v[212:215], a[228:231], v[84:87], v[212:215]
    v_exp_f32 v209, v209
    v_mfma_f32_16x16x32_bf16 v[212:215], a[232:235], v[88:91], v[212:215]
    v_exp_f32 v210, v210
    v_mfma_f32_16x16x32_bf16 v[212:215], a[236:239], v[92:95], v[212:215]
    v_exp_f32 v211, v211
    v_mfma_f32_16x16x32_bf16 a[40:43], a[176:179], v[144:147], a[40:43]
    ds_read_b64_tr_b16 a[160:161], v24 offset:32768
    v_cvt_pk_bf16_f32 v162, v208, v209
    v_mfma_f32_16x16x32_bf16 a[40:43], a[180:183], v[148:151], a[40:43]
    ds_read_b64_tr_b16 a[162:163], v24 offset:36864
    v_mfma_f32_16x16x32_bf16 a[44:47], a[176:179], v[152:155], a[44:47]
    ds_read_b128 a[216:219], v10 offset:57344
    v_cvt_pk_bf16_f32 v163, v210, v211
    v_mfma_f32_16x16x32_bf16 a[44:47], a[180:183], v[156:159], a[44:47]
    s_waitcnt lgkmcnt(3)
    buffer_load_dwordx4 v41, s[12:15], s41 offen offset:1024 lds
    v_mfma_f32_16x16x32_bf16 v[208:211], a[224:227], v[96:99], v[200:203]
    v_exp_f32 v212, v212
    v_mfma_f32_16x16x32_bf16 v[208:211], a[228:231], v[100:103], v[208:211]
    v_exp_f32 v213, v213
    v_mfma_f32_16x16x32_bf16 v[208:211], a[232:235], v[104:107], v[208:211]
    v_exp_f32 v214, v214
    v_mfma_f32_16x16x32_bf16 v[208:211], a[236:239], v[108:111], v[208:211]
    v_exp_f32 v215, v215
    v_mfma_f32_16x16x32_bf16 a[48:51], a[184:187], v[128:131], a[48:51]
    ds_read_b64_tr_b16 a[164:165], v24 offset:40960
    v_cvt_pk_bf16_f32 v170, v212, v213
    v_mfma_f32_16x16x32_bf16 a[48:51], a[188:191], v[132:135], a[48:51]
    ds_read_b64_tr_b16 a[166:167], v24 offset:45056
    v_mfma_f32_16x16x32_bf16 a[52:55], a[184:187], v[136:139], a[52:55]
    ds_read_b128 a[220:223], v11 offset:57344
    v_cvt_pk_bf16_f32 v171, v214, v215
    v_mfma_f32_16x16x32_bf16 a[52:55], a[188:191], v[140:143], a[52:55]
    v_smfmac_f32_16x16x64_bf16 a[200:203], v[52:55], v[144:151], v50
    v_mfma_f32_16x16x32_bf16 v[212:215], a[224:227], v[112:115], v[204:207]
    v_exp_f32 v208, v208
    v_mfma_f32_16x16x32_bf16 v[212:215], a[228:231], v[116:119], v[212:215]
    v_exp_f32 v209, v209
    v_mfma_f32_16x16x32_bf16 v[212:215], a[232:235], v[120:123], v[212:215]
    v_exp_f32 v210, v210
    v_mfma_f32_16x16x32_bf16 v[212:215], a[236:239], v[124:127], v[212:215]
    v_exp_f32 v211, v211
    v_mfma_f32_16x16x32_bf16 a[56:59], a[184:187], v[144:147], a[56:59]
    ds_read_b64_tr_b16 a[168:169], v25 offset:32768
    v_cvt_pk_bf16_f32 v178, v208, v209
    v_mfma_f32_16x16x32_bf16 a[56:59], a[188:191], v[148:151], a[56:59]
    ds_read_b64_tr_b16 a[170:171], v25 offset:36864
    v_mfma_f32_16x16x32_bf16 a[60:63], a[184:187], v[152:155], a[60:63]
    ds_read_b128 a[224:227], v8 offset:61440
    v_cvt_pk_bf16_f32 v179, v210, v211
    v_mfma_f32_16x16x32_bf16 a[60:63], a[188:191], v[156:159], a[60:63]
    s_waitcnt lgkmcnt(3)
    buffer_load_dwordx4 v40, s[12:15], s41 offen offset:2048 lds
    v_mfma_f32_16x16x32_bf16 v[208:211], a[208:211], v[64:67], v[192:195]
    v_exp_f32 v212, v212
    v_mfma_f32_16x16x32_bf16 v[208:211], a[212:215], v[68:71], v[208:211]
    v_exp_f32 v213, v213
    v_mfma_f32_16x16x32_bf16 v[208:211], a[216:219], v[72:75], v[208:211]
    v_exp_f32 v214, v214
    v_mfma_f32_16x16x32_bf16 v[208:211], a[220:223], v[76:79], v[208:211]
    v_exp_f32 v215, v215
    v_mfma_f32_16x16x32_bf16 a[64:67], a[160:163], v[128:131], a[64:67]
    ds_read_b64_tr_b16 a[172:173], v25 offset:40960
    v_cvt_pk_bf16_f32 v186, v212, v213
    v_mfma_f32_16x16x32_bf16 a[64:67], a[164:167], v[132:135], a[64:67]
    ds_read_b64_tr_b16 a[174:175], v25 offset:45056
    v_mfma_f32_16x16x32_bf16 a[68:71], a[160:163], v[136:139], a[68:71]
    ds_read_b128 a[228:231], v9 offset:61440
    v_cvt_pk_bf16_f32 v187, v214, v215
    v_mfma_f32_16x16x32_bf16 a[68:71], a[164:167], v[140:143], a[68:71]
    v_smfmac_f32_16x16x64_bf16 a[204:207], v[52:55], v[152:159], v50
    v_mfma_f32_16x16x32_bf16 v[212:215], a[208:211], v[80:83], v[196:199]
    v_exp_f32 v208, v208
    v_mfma_f32_16x16x32_bf16 v[212:215], a[212:215], v[84:87], v[212:215]
    v_exp_f32 v209, v209
    v_mfma_f32_16x16x32_bf16 v[212:215], a[216:219], v[88:91], v[212:215]
    v_exp_f32 v210, v210
    v_mfma_f32_16x16x32_bf16 v[212:215], a[220:223], v[92:95], v[212:215]
    v_exp_f32 v211, v211
    v_mfma_f32_16x16x32_bf16 a[72:75], a[160:163], v[144:147], a[72:75]
    ds_read_b64_tr_b16 a[176:177], v26 offset:32768
    v_cvt_pk_bf16_f32 v164, v208, v209
    v_mfma_f32_16x16x32_bf16 a[72:75], a[164:167], v[148:151], a[72:75]
    ds_read_b64_tr_b16 a[178:179], v26 offset:36864
    v_mfma_f32_16x16x32_bf16 a[76:79], a[160:163], v[152:155], a[76:79]
    ds_read_b128 a[232:235], v10 offset:61440
    v_cvt_pk_bf16_f32 v165, v210, v211
    v_mfma_f32_16x16x32_bf16 a[76:79], a[164:167], v[156:159], a[76:79]
    s_waitcnt lgkmcnt(3)
    buffer_load_dwordx4 v41, s[12:15], s41 offen offset:3072 lds
    v_mfma_f32_16x16x32_bf16 v[208:211], a[208:211], v[96:99], v[200:203]
    v_exp_f32 v212, v212
    v_mfma_f32_16x16x32_bf16 v[208:211], a[212:215], v[100:103], v[208:211]
    s_add_u32 s41, s41, 16384
    v_exp_f32 v213, v213
    v_mfma_f32_16x16x32_bf16 v[208:211], a[216:219], v[104:107], v[208:211]
    v_exp_f32 v214, v214
    v_mfma_f32_16x16x32_bf16 v[208:211], a[220:223], v[108:111], v[208:211]
    v_exp_f32 v215, v215
    v_mfma_f32_16x16x32_bf16 a[80:83], a[168:171], v[128:131], a[80:83]
    ds_read_b64_tr_b16 a[180:181], v26 offset:40960
    v_cvt_pk_bf16_f32 v172, v212, v213
    v_mfma_f32_16x16x32_bf16 a[80:83], a[172:175], v[132:135], a[80:83]
    ds_read_b64_tr_b16 a[182:183], v26 offset:45056
    v_mfma_f32_16x16x32_bf16 a[84:87], a[168:171], v[136:139], a[84:87]
    ds_read_b128 a[236:239], v11 offset:61440
    v_cvt_pk_bf16_f32 v173, v214, v215
    v_mfma_f32_16x16x32_bf16 a[84:87], a[172:175], v[140:143], a[84:87]
    s_waitcnt vmcnt(10)
    s_barrier
    v_mfma_f32_16x16x32_bf16 v[212:215], a[208:211], v[112:115], v[204:207]
    v_exp_f32 v208, v208
    v_mfma_f32_16x16x32_bf16 v[212:215], a[212:215], v[116:119], v[212:215]
    s_add_u32 m0, s42, 32768
    v_exp_f32 v209, v209
    v_mfma_f32_16x16x32_bf16 v[212:215], a[216:219], v[120:123], v[212:215]
    v_exp_f32 v210, v210
    v_mfma_f32_16x16x32_bf16 v[212:215], a[220:223], v[124:127], v[212:215]
    v_exp_f32 v211, v211
    v_mfma_f32_16x16x32_bf16 a[88:91], a[168:171], v[144:147], a[88:91]
    ds_read_b64_tr_b16 a[184:185], v27 offset:32768
    v_cvt_pk_bf16_f32 v180, v208, v209
    v_mfma_f32_16x16x32_bf16 a[88:91], a[172:175], v[148:151], a[88:91]
    ds_read_b64_tr_b16 a[186:187], v27 offset:36864
    v_mfma_f32_16x16x32_bf16 a[92:95], a[168:171], v[152:155], a[92:95]
    ds_read_b128 a[208:211], v8 offset:0
    v_cvt_pk_bf16_f32 v181, v210, v211
    v_mfma_f32_16x16x32_bf16 a[92:95], a[172:175], v[156:159], a[92:95]
    s_waitcnt lgkmcnt(3)
    buffer_load_dwordx4 v36, s[8:11], s40 offen lds
    v_mfma_f32_16x16x32_bf16 v[208:211], a[224:227], v[64:67], v[192:195]
    v_exp_f32 v212, v212
    v_mfma_f32_16x16x32_bf16 v[208:211], a[228:231], v[68:71], v[208:211]
    v_exp_f32 v213, v213
    v_mfma_f32_16x16x32_bf16 v[208:211], a[232:235], v[72:75], v[208:211]
    v_exp_f32 v214, v214
    v_mfma_f32_16x16x32_bf16 v[208:211], a[236:239], v[76:79], v[208:211]
    v_exp_f32 v215, v215
    v_mfma_f32_16x16x32_bf16 a[96:99], a[176:179], v[128:131], a[96:99]
    ds_read_b64_tr_b16 a[188:189], v27 offset:40960
    v_cvt_pk_bf16_f32 v188, v212, v213
    v_mfma_f32_16x16x32_bf16 a[96:99], a[180:183], v[132:135], a[96:99]
    ds_read_b64_tr_b16 a[190:191], v27 offset:45056
    v_mfma_f32_16x16x32_bf16 a[100:103], a[176:179], v[136:139], a[100:103]
    ds_read_b128 a[212:215], v9 offset:0
    v_cvt_pk_bf16_f32 v189, v214, v215
    v_mfma_f32_16x16x32_bf16 a[100:103], a[180:183], v[140:143], a[100:103]
    buffer_load_dword v219, v62, s[84:87], s38 offen
    v_mfma_f32_16x16x32_bf16 v[212:215], a[224:227], v[80:83], v[196:199]
    v_exp_f32 v208, v208
    v_mfma_f32_16x16x32_bf16 v[212:215], a[228:231], v[84:87], v[212:215]
    v_exp_f32 v209, v209
    v_mfma_f32_16x16x32_bf16 v[212:215], a[232:235], v[88:91], v[212:215]
    v_exp_f32 v210, v210
    v_mfma_f32_16x16x32_bf16 v[212:215], a[236:239], v[92:95], v[212:215]
    v_exp_f32 v211, v211
    v_mfma_f32_16x16x32_bf16 a[104:107], a[176:179], v[144:147], a[104:107]
    ds_read_b64_tr_b16 a[160:161], v20 offset:49152
    v_cvt_pk_bf16_f32 v166, v208, v209
    v_mfma_f32_16x16x32_bf16 a[104:107], a[180:183], v[148:151], a[104:107]
    ds_read_b64_tr_b16 a[162:163], v20 offset:53248
    v_mfma_f32_16x16x32_bf16 a[108:111], a[176:179], v[152:155], a[108:111]
    ds_read_b128 a[216:219], v10 offset:0
    v_cvt_pk_bf16_f32 v167, v210, v211
    v_mfma_f32_16x16x32_bf16 a[108:111], a[180:183], v[156:159], a[108:111]
    s_waitcnt lgkmcnt(3)
    buffer_load_dwordx4 v37, s[8:11], s40 offen offset:1024 lds
    v_mfma_f32_16x16x32_bf16 v[208:211], a[224:227], v[96:99], v[200:203]
    v_exp_f32 v212, v212
    v_mfma_f32_16x16x32_bf16 v[208:211], a[228:231], v[100:103], v[208:211]
    v_exp_f32 v213, v213
    v_mfma_f32_16x16x32_bf16 v[208:211], a[232:235], v[104:107], v[208:211]
    v_exp_f32 v214, v214
    v_mfma_f32_16x16x32_bf16 v[208:211], a[236:239], v[108:111], v[208:211]
    v_exp_f32 v215, v215
    v_mfma_f32_16x16x32_bf16 a[112:115], a[184:187], v[128:131], a[112:115]
    ds_read_b64_tr_b16 a[164:165], v20 offset:57344
    v_cvt_pk_bf16_f32 v174, v212, v213
    v_mfma_f32_16x16x32_bf16 a[112:115], a[188:191], v[132:135], a[112:115]
    ds_read_b64_tr_b16 a[166:167], v20 offset:61440
    v_mfma_f32_16x16x32_bf16 a[116:119], a[184:187], v[136:139], a[116:119]
    ds_read_b128 a[220:223], v11 offset:0
    v_cvt_pk_bf16_f32 v175, v214, v215
    v_mfma_f32_16x16x32_bf16 a[116:119], a[188:191], v[140:143], a[116:119]
    buffer_load_dword v221, v235, s[20:23], 0 offen
    v_mfma_f32_16x16x32_bf16 v[212:215], a[224:227], v[112:115], v[204:207]
    v_exp_f32 v208, v208
    v_mfma_f32_16x16x32_bf16 v[212:215], a[228:231], v[116:119], v[212:215]
    v_exp_f32 v209, v209
    v_mfma_f32_16x16x32_bf16 v[212:215], a[232:235], v[120:123], v[212:215]
    v_exp_f32 v210, v210
    v_mfma_f32_16x16x32_bf16 v[212:215], a[236:239], v[124:127], v[212:215]
    v_exp_f32 v211, v211
    v_mfma_f32_16x16x32_bf16 a[120:123], a[184:187], v[144:147], a[120:123]
    ds_read_b64_tr_b16 a[168:169], v21 offset:49152
    v_cvt_pk_bf16_f32 v182, v208, v209
    v_mfma_f32_16x16x32_bf16 a[120:123], a[188:191], v[148:151], a[120:123]
    ds_read_b64_tr_b16 a[170:171], v21 offset:53248
    v_add_u32 v235, 2560, v235
    v_mfma_f32_16x16x32_bf16 a[124:127], a[184:187], v[152:155], a[124:127]
    ds_read_b128 a[224:227], v8 offset:4096
    v_cvt_pk_bf16_f32 v183, v210, v211
    v_mfma_f32_16x16x32_bf16 a[124:127], a[188:191], v[156:159], a[124:127]
    s_waitcnt lgkmcnt(3)
    buffer_load_dwordx4 v38, s[8:11], s40 offen offset:2048 lds
    v_mfma_f32_16x16x32_bf16 v[208:211], a[208:211], v[64:67], v[192:195]
    v_exp_f32 v212, v212
    v_mfma_f32_16x16x32_bf16 v[208:211], a[212:215], v[68:71], v[208:211]
    v_exp_f32 v213, v213
    v_mfma_f32_16x16x32_bf16 v[208:211], a[216:219], v[72:75], v[208:211]
    v_exp_f32 v214, v214
    v_mfma_f32_16x16x32_bf16 v[208:211], a[220:223], v[76:79], v[208:211]
    v_exp_f32 v215, v215
    v_mfma_f32_16x16x32_bf16 a[0:3], a[160:163], v[160:163], a[0:3]
    ds_read_b64_tr_b16 a[172:173], v21 offset:57344
    v_cvt_pk_bf16_f32 v190, v212, v213
    v_mfma_f32_16x16x32_bf16 a[0:3], a[164:167], v[164:167], a[0:3]
    ds_read_b64_tr_b16 a[174:175], v21 offset:61440
    v_lshlrev_b32 v244, 16, v240
    v_mfma_f32_16x16x32_bf16 a[4:7], a[160:163], v[168:171], a[4:7]
    ds_read_b128 a[228:231], v9 offset:4096
    v_cvt_pk_bf16_f32 v191, v214, v215
    v_mfma_f32_16x16x32_bf16 a[4:7], a[164:167], v[172:175], a[4:7]
    v_and_b32 v245, 0xffff0000, v240
    v_fmac_f32 v224, v2, v244
    v_mfma_f32_16x16x32_bf16 v[212:215], a[208:211], v[80:83], v[196:199]
    v_exp_f32 v208, v208
    v_mfma_f32_16x16x32_bf16 v[212:215], a[212:215], v[84:87], v[212:215]
    v_exp_f32 v209, v209
    v_mfma_f32_16x16x32_bf16 v[212:215], a[216:219], v[88:91], v[212:215]
    v_exp_f32 v210, v210
    v_mfma_f32_16x16x32_bf16 v[212:215], a[220:223], v[92:95], v[212:215]
    v_exp_f32 v211, v211
    v_mfma_f32_16x16x32_bf16 a[8:11], a[160:163], v[176:179], a[8:11]
    ds_read_b64_tr_b16 a[176:177], v22 offset:49152
    v_cvt_pk_bf16_f32 v128, v208, v209
    v_mfma_f32_16x16x32_bf16 a[8:11], a[164:167], v[180:183], a[8:11]
    ds_read_b64_tr_b16 a[178:179], v22 offset:53248
    v_fmac_f32 v225, v2, v245
    v_mfma_f32_16x16x32_bf16 a[12:15], a[160:163], v[184:187], a[12:15]
    ds_read_b128 a[232:235], v10 offset:4096
    v_cvt_pk_bf16_f32 v129, v210, v211
    v_mfma_f32_16x16x32_bf16 a[12:15], a[164:167], v[188:191], a[12:15]
    s_waitcnt lgkmcnt(3)
    buffer_load_dwordx4 v39, s[8:11], s40 offen offset:3072 lds
    v_mfma_f32_16x16x32_bf16 v[208:211], a[208:211], v[96:99], v[200:203]
Ltour5:
    s_cbranch_execz Ltour9
    v_exp_f32 v212, v212
    v_mfma_f32_16x16x32_bf16 v[208:211], a[212:215], v[100:103], v[208:211]
    s_add_u32 s40, s40, 16384
    v_exp_f32 v213, v213
    v_mfma_f32_16x16x32_bf16 v[208:211], a[216:219], v[104:107], v[208:211]
    v_exp_f32 v214, v214
    v_mfma_f32_16x16x32_bf16 v[208:211], a[220:223], v[108:111], v[208:211]
    v_exp_f32 v215, v215
    v_mfma_f32_16x16x32_bf16 a[16:19], a[168:171], v[160:163], a[16:19]
    ds_read_b64_tr_b16 a[180:181], v22 offset:57344
    v_cvt_pk_bf16_f32 v136, v212, v213
    v_mfma_f32_16x16x32_bf16 a[16:19], a[172:175], v[164:167], a[16:19]
    ds_read_b64_tr_b16 a[182:183], v22 offset:61440
    v_lshlrev_b32 v246, 16, v241
    v_mfma_f32_16x16x32_bf16 a[20:23], a[168:171], v[168:171], a[20:23]
    ds_read_b128 a[236:239], v11 offset:4096
    v_cvt_pk_bf16_f32 v137, v214, v215
    v_mfma_f32_16x16x32_bf16 a[20:23], a[172:175], v[172:175], a[20:23]
    v_and_b32 v247, 0xffff0000, v241
    v_fmac_f32 v226, v2, v246
    v_smfmac_f32_16x16x64_bf16 a[192:195], v[52:55], v[160:167], v50
    v_mfma_f32_16x16x32_bf16 v[212:215], a[208:211], v[112:115], v[204:207]
    v_exp_f32 v208, v208
    v_mfma_f32_16x16x32_bf16 v[212:215], a[212:215], v[116:119], v[212:215]
    s_add_u32 m0, s42, 81920
    v_exp_f32 v209, v209
    v_mfma_f32_16x16x32_bf16 v[212:215], a[216:219], v[120:123], v[212:215]
    v_exp_f32 v210, v210
    v_mfma_f32_16x16x32_bf16 v[212:215], a[220:223], v[124:127], v[212:215]
    v_exp_f32 v211, v211
    v_mfma_f32_16x16x32_bf16 a[24:27], a[168:171], v[176:179], a[24:27]
    ds_read_b64_tr_b16 a[184:185], v23 offset:49152
    v_cvt_pk_bf16_f32 v144, v208, v209
    v_mfma_f32_16x16x32_bf16 a[24:27], a[172:175], v[180:183], a[24:27]
    ds_read_b64_tr_b16 a[186:187], v23 offset:53248
    v_fmac_f32 v227, v2, v247
    v_mfma_f32_16x16x32_bf16 a[28:31], a[168:171], v[184:187], a[28:31]
    ds_read_b128 a[208:211], v8 offset:8192
    v_cvt_pk_bf16_f32 v145, v210, v211
    v_mfma_f32_16x16x32_bf16 a[28:31], a[172:175], v[188:191], a[28:31]
    s_waitcnt lgkmcnt(3)
    buffer_load_dwordx4 v40, s[12:15], s41 offen lds
    v_mfma_f32_16x16x32_bf16 v[208:211], a[224:227], v[64:67], v[192:195]
    v_exp_f32 v212, v212
    v_mfma_f32_16x16x32_bf16 v[208:211], a[228:231], v[68:71], v[208:211]
    v_exp_f32 v213, v213
    v_mfma_f32_16x16x32_bf16 v[208:211], a[232:235], v[72:75], v[208:211]
    v_exp_f32 v214, v214
    v_mfma_f32_16x16x32_bf16 v[208:211], a[236:239], v[76:79], v[208:211]
    v_exp_f32 v215, v215
    v_mfma_f32_16x16x32_bf16 a[32:35], a[176:179], v[160:163], a[32:35]
    ds_read_b64_tr_b16 a[188:189], v23 offset:57344
    v_cvt_pk_bf16_f32 v152, v212, v213
    v_mfma_f32_16x16x32_bf16 a[32:35], a[180:183], v[164:167], a[32:35]
    ds_read_b64_tr_b16 a[190:191], v23 offset:61440
    v_lshlrev_b32 v244, 16, v242
    v_mfma_f32_16x16x32_bf16 a[36:39], a[176:179], v[168:171], a[36:39]
    ds_read_b128 a[212:215], v9 offset:8192
    v_cvt_pk_bf16_f32 v153, v214, v215
    v_mfma_f32_16x16x32_bf16 a[36:39], a[180:183], v[172:175], a[36:39]
    v_and_b32 v245, 0xffff0000, v242
    v_fmac_f32 v228, v2, v244
    v_smfmac_f32_16x16x64_bf16 a[196:199], v[52:55], v[168:175], v50
    v_mfma_f32_16x16x32_bf16 v[212:215], a[224:227], v[80:83], v[196:199]
    v_exp_f32 v208, v208
    v_mfma_f32_16x16x32_bf16 v[212:215], a[228:231], v[84:87], v[212:215]
    v_exp_f32 v209, v209
    v_mfma_f32_16x16x32_bf16 v[212:215], a[232:235], v[88:91], v[212:215]
    v_exp_f32 v210, v210
    v_mfma_f32_16x16x32_bf16 v[212:215], a[236:239], v[92:95], v[212:215]
    v_exp_f32 v211, v211
    v_mfma_f32_16x16x32_bf16 a[40:43], a[176:179], v[176:179], a[40:43]
    ds_read_b64_tr_b16 a[160:161], v24 offset:49152
    v_cvt_pk_bf16_f32 v130, v208, v209
    v_mfma_f32_16x16x32_bf16 a[40:43], a[180:183], v[180:183], a[40:43]
    ds_read_b64_tr_b16 a[162:163], v24 offset:53248
    v_fmac_f32 v229, v2, v245
    v_mfma_f32_16x16x32_bf16 a[44:47], a[176:179], v[184:187], a[44:47]
    ds_read_b128 a[216:219], v10 offset:8192
    v_cvt_pk_bf16_f32 v131, v210, v211
    v_mfma_f32_16x16x32_bf16 a[44:47], a[180:183], v[188:191], a[44:47]
    s_waitcnt lgkmcnt(3)
    buffer_load_dwordx4 v41, s[12:15], s41 offen offset:1024 lds
    v_mfma_f32_16x16x32_bf16 v[208:211], a[224:227], v[96:99], v[200:203]
    v_exp_f32 v212, v212
    v_mfma_f32_16x16x32_bf16 v[208:211], a[228:231], v[100:103], v[208:211]
    v_exp_f32 v213, v213
    v_mfma_f32_16x16x32_bf16 v[208:211], a[232:235], v[104:107], v[208:211]
    v_exp_f32 v214, v214
    v_mfma_f32_16x16x32_bf16 v[208:211], a[236:239], v[108:111], v[208:211]
    v_exp_f32 v215, v215
    v_mfma_f32_16x16x32_bf16 a[48:51], a[184:187], v[160:163], a[48:51]
    ds_read_b64_tr_b16 a[164:165], v24 offset:57344
    v_cvt_pk_bf16_f32 v138, v212, v213
    v_mfma_f32_16x16x32_bf16 a[48:51], a[188:191], v[164:167], a[48:51]
    ds_read_b64_tr_b16 a[166:167], v24 offset:61440
    v_lshlrev_b32 v246, 16, v243
    v_mfma_f32_16x16x32_bf16 a[52:55], a[184:187], v[168:171], a[52:55]
    ds_read_b128 a[220:223], v11 offset:8192
    v_cvt_pk_bf16_f32 v139, v214, v215
    v_mfma_f32_16x16x32_bf16 a[52:55], a[188:191], v[172:175], a[52:55]
    v_and_b32 v247, 0xffff0000, v243
    v_fmac_f32 v230, v2, v246
    v_smfmac_f32_16x16x64_bf16 a[200:203], v[52:55], v[176:183], v50
    v_mfma_f32_16x16x32_bf16 v[212:215], a[224:227], v[112:115], v[204:207]
    v_exp_f32 v208, v208
    v_mfma_f32_16x16x32_bf16 v[212:215], a[228:231], v[116:119], v[212:215]
    v_exp_f32 v209, v209
    v_mfma_f32_16x16x32_bf16 v[212:215], a[232:235], v[120:123], v[212:215]
    v_exp_f32 v210, v210
    v_mfma_f32_16x16x32_bf16 v[212:215], a[236:239], v[124:127], v[212:215]
    v_exp_f32 v211, v211
    v_mfma_f32_16x16x32_bf16 a[56:59], a[184:187], v[176:179], a[56:59]
    ds_read_b64_tr_b16 a[168:169], v25 offset:49152
    v_cvt_pk_bf16_f32 v146, v208, v209
    v_mfma_f32_16x16x32_bf16 a[56:59], a[188:191], v[180:183], a[56:59]
    ds_read_b64_tr_b16 a[170:171], v25 offset:53248
    v_fmac_f32 v231, v2, v247
    v_mfma_f32_16x16x32_bf16 a[60:63], a[184:187], v[184:187], a[60:63]
    ds_read_b128 a[224:227], v8 offset:12288
    v_cvt_pk_bf16_f32 v147, v210, v211
    v_mfma_f32_16x16x32_bf16 a[60:63], a[188:191], v[188:191], a[60:63]
    s_waitcnt lgkmcnt(3)
    buffer_load_dwordx4 v40, s[12:15], s41 offen offset:2048 lds
    v_mfma_f32_16x16x32_bf16 v[208:211], a[208:211], v[64:67], v[192:195]
    v_exp_f32 v212, v212
    v_mfma_f32_16x16x32_bf16 v[208:211], a[212:215], v[68:71], v[208:211]
    v_exp_f32 v213, v213
    v_mfma_f32_16x16x32_bf16 v[208:211], a[216:219], v[72:75], v[208:211]
    v_exp_f32 v214, v214
    v_mfma_f32_16x16x32_bf16 v[208:211], a[220:223], v[76:79], v[208:211]
    v_exp_f32 v215, v215
    v_mfma_f32_16x16x32_bf16 a[64:67], a[160:163], v[160:163], a[64:67]
    ds_read_b64_tr_b16 a[172:173], v25 offset:57344
    v_cvt_pk_bf16_f32 v154, v212, v213
    v_mfma_f32_16x16x32_bf16 a[64:67], a[164:167], v[164:167], a[64:67]
    ds_read_b64_tr_b16 a[174:175], v25 offset:61440
    v_mov_b32 v2, v3
    v_mfma_f32_16x16x32_bf16 a[68:71], a[160:163], v[168:171], a[68:71]
    ds_read_b128 a[228:231], v9 offset:12288
    v_cvt_pk_bf16_f32 v155, v214, v215
    v_mfma_f32_16x16x32_bf16 a[68:71], a[164:167], v[172:175], a[68:71]
    v_mov_b32 v3, v4
    v_mov_b32 v4, v5
    v_smfmac_f32_16x16x64_bf16 a[204:207], v[52:55], v[184:191], v50
    v_mfma_f32_16x16x32_bf16 v[212:215], a[208:211], v[80:83], v[196:199]
    v_exp_f32 v208, v208
    v_mfma_f32_16x16x32_bf16 v[212:215], a[212:215], v[84:87], v[212:215]
    v_exp_f32 v209, v209
    v_mfma_f32_16x16x32_bf16 v[212:215], a[216:219], v[88:91], v[212:215]
    v_exp_f32 v210, v210
    v_mfma_f32_16x16x32_bf16 v[212:215], a[220:223], v[92:95], v[212:215]
    v_exp_f32 v211, v211
    v_mfma_f32_16x16x32_bf16 a[72:75], a[160:163], v[176:179], a[72:75]
    ds_read_b64_tr_b16 a[176:177], v26 offset:49152
    v_cvt_pk_bf16_f32 v132, v208, v209
    v_mfma_f32_16x16x32_bf16 a[72:75], a[164:167], v[180:183], a[72:75]
    ds_read_b64_tr_b16 a[178:179], v26 offset:53248
    v_mov_b32 v5, v6
    v_mfma_f32_16x16x32_bf16 a[76:79], a[160:163], v[184:187], a[76:79]
    ds_read_b128 a[232:235], v10 offset:12288
    v_cvt_pk_bf16_f32 v133, v210, v211
    v_mfma_f32_16x16x32_bf16 a[76:79], a[164:167], v[188:191], a[76:79]
    s_waitcnt lgkmcnt(3)
    buffer_load_dwordx4 v41, s[12:15], s41 offen offset:3072 lds
    v_mfma_f32_16x16x32_bf16 v[208:211], a[208:211], v[96:99], v[200:203]
    v_exp_f32 v212, v212
    v_mfma_f32_16x16x32_bf16 v[208:211], a[212:215], v[100:103], v[208:211]
    s_add_u32 s41, s41, 16384
    v_exp_f32 v213, v213
    v_mfma_f32_16x16x32_bf16 v[208:211], a[216:219], v[104:107], v[208:211]
    v_exp_f32 v214, v214
    v_mfma_f32_16x16x32_bf16 v[208:211], a[220:223], v[108:111], v[208:211]
    v_exp_f32 v215, v215
    v_mfma_f32_16x16x32_bf16 a[80:83], a[168:171], v[160:163], a[80:83]
    ds_read_b64_tr_b16 a[180:181], v26 offset:57344
    v_cvt_pk_bf16_f32 v140, v212, v213
    v_mfma_f32_16x16x32_bf16 a[80:83], a[172:175], v[164:167], a[80:83]
    ds_read_b64_tr_b16 a[182:183], v26 offset:61440
    v_mfma_f32_16x16x32_bf16 a[84:87], a[168:171], v[168:171], a[84:87]
    ds_read_b128 a[236:239], v11 offset:12288
    v_cvt_pk_bf16_f32 v141, v214, v215
    v_mfma_f32_16x16x32_bf16 a[84:87], a[172:175], v[172:175], a[84:87]
    s_waitcnt vmcnt(10)
    s_barrier
    v_mfma_f32_16x16x32_bf16 v[212:215], a[208:211], v[112:115], v[204:207]
    v_exp_f32 v208, v208
    v_mfma_f32_16x16x32_bf16 v[212:215], a[212:215], v[116:119], v[212:215]
    s_add_u32 m0, s42, 49152
    v_exp_f32 v209, v209
    v_mfma_f32_16x16x32_bf16 v[212:215], a[216:219], v[120:123], v[212:215]
    v_exp_f32 v210, v210
    v_mfma_f32_16x16x32_bf16 v[212:215], a[220:223], v[124:127], v[212:215]
    v_exp_f32 v211, v211
    v_mfma_f32_16x16x32_bf16 a[88:91], a[168:171], v[176:179], a[88:91]
    ds_read_b64_tr_b16 a[184:185], v27 offset:49152
    v_cvt_pk_bf16_f32 v148, v208, v209
    v_mfma_f32_16x16x32_bf16 a[88:91], a[172:175], v[180:183], a[88:91]
    ds_read_b64_tr_b16 a[186:187], v27 offset:53248
    v_mfma_f32_16x16x32_bf16 a[92:95], a[168:171], v[184:187], a[92:95]
    ds_read_b128 a[208:211], v8 offset:16384
    v_cvt_pk_bf16_f32 v149, v210, v211
    v_mfma_f32_16x16x32_bf16 a[92:95], a[172:175], v[188:191], a[92:95]
    s_waitcnt lgkmcnt(3)
    buffer_load_dwordx4 v36, s[8:11], s40 offen lds
    v_mfma_f32_16x16x32_bf16 v[208:211], a[224:227], v[64:67], v[192:195]
    v_exp_f32 v212, v212
    v_mfma_f32_16x16x32_bf16 v[208:211], a[228:231], v[68:71], v[208:211]
    v_exp_f32 v213, v213
    v_mfma_f32_16x16x32_bf16 v[208:211], a[232:235], v[72:75], v[208:211]
    v_exp_f32 v214, v214
    v_mfma_f32_16x16x32_bf16 v[208:211], a[236:239], v[76:79], v[208:211]
    v_exp_f32 v215, v215
    v_mfma_f32_16x16x32_bf16 a[96:99], a[176:179], v[160:163], a[96:99]
    ds_read_b64_tr_b16 a[188:189], v27 offset:57344
    v_cvt_pk_bf16_f32 v156, v212, v213
    v_mfma_f32_16x16x32_bf16 a[96:99], a[180:183], v[164:167], a[96:99]
    ds_read_b64_tr_b16 a[190:191], v27 offset:61440
    v_mfma_f32_16x16x32_bf16 a[100:103], a[176:179], v[168:171], a[100:103]
    ds_read_b128 a[212:215], v9 offset:16384
    v_cvt_pk_bf16_f32 v157, v214, v215
    v_mfma_f32_16x16x32_bf16 a[100:103], a[180:183], v[172:175], a[100:103]
    buffer_load_dword v216, v237, s[28:31], s52 offen
    v_mfma_f32_16x16x32_bf16 v[212:215], a[224:227], v[80:83], v[196:199]
    v_exp_f32 v208, v208
    v_mfma_f32_16x16x32_bf16 v[212:215], a[228:231], v[84:87], v[212:215]
    s_sub_u32 s39, s39, 36864
    v_exp_f32 v209, v209
    v_mfma_f32_16x16x32_bf16 v[212:215], a[232:235], v[88:91], v[212:215]
    s_sub_u32 s38, s38, 4608
    v_exp_f32 v210, v210
    v_mfma_f32_16x16x32_bf16 v[212:215], a[236:239], v[92:95], v[212:215]
    s_add_u32 s52, s52, 2304
    v_exp_f32 v211, v211
    v_mfma_f32_16x16x32_bf16 a[104:107], a[176:179], v[176:179], a[104:107]
    ds_read_b64_tr_b16 a[160:161], v20 offset:0
    v_cvt_pk_bf16_f32 v134, v208, v209
    v_mfma_f32_16x16x32_bf16 a[104:107], a[180:183], v[180:183], a[104:107]
    ds_read_b64_tr_b16 a[162:163], v20 offset:4096
    v_mfma_f32_16x16x32_bf16 a[108:111], a[176:179], v[184:187], a[108:111]
    ds_read_b128 a[216:219], v10 offset:16384
    v_cvt_pk_bf16_f32 v135, v210, v211
    v_mfma_f32_16x16x32_bf16 a[108:111], a[180:183], v[188:191], a[108:111]
    s_waitcnt lgkmcnt(3)
    buffer_load_dwordx4 v37, s[8:11], s40 offen offset:1024 lds
    v_mfma_f32_16x16x32_bf16 v[208:211], a[224:227], v[96:99], v[200:203]
    v_exp_f32 v212, v212
    v_mfma_f32_16x16x32_bf16 v[208:211], a[228:231], v[100:103], v[208:211]
    v_exp_f32 v213, v213
    v_mfma_f32_16x16x32_bf16 v[208:211], a[232:235], v[104:107], v[208:211]
    v_exp_f32 v214, v214
    v_mfma_f32_16x16x32_bf16 v[208:211], a[236:239], v[108:111], v[208:211]
    v_exp_f32 v215, v215
    v_mfma_f32_16x16x32_bf16 a[112:115], a[184:187], v[160:163], a[112:115]
    ds_read_b64_tr_b16 a[164:165], v20 offset:8192
    v_cvt_pk_bf16_f32 v142, v212, v213
    v_mfma_f32_16x16x32_bf16 a[112:115], a[188:191], v[164:167], a[112:115]
    ds_read_b64_tr_b16 a[166:167], v20 offset:12288
    v_mfma_f32_16x16x32_bf16 a[116:119], a[184:187], v[168:171], a[116:119]
    ds_read_b128 a[220:223], v11 offset:16384
    v_cvt_pk_bf16_f32 v143, v214, v215
    v_mfma_f32_16x16x32_bf16 a[116:119], a[188:191], v[172:175], a[116:119]
    v_mfma_f32_16x16x32_bf16 v[212:215], a[224:227], v[112:115], v[204:207]
    v_exp_f32 v208, v208
    v_mfma_f32_16x16x32_bf16 v[212:215], a[228:231], v[116:119], v[212:215]
    v_exp_f32 v209, v209
    v_mfma_f32_16x16x32_bf16 v[212:215], a[232:235], v[120:123], v[212:215]
    v_exp_f32 v210, v210
    v_mfma_f32_16x16x32_bf16 v[212:215], a[236:239], v[124:127], v[212:215]
    v_exp_f32 v211, v211
    v_mfma_f32_16x16x32_bf16 a[120:123], a[184:187], v[176:179], a[120:123]
    ds_read_b64_tr_b16 a[168:169], v21 offset:0
    v_cvt_pk_bf16_f32 v150, v208, v209
    v_mfma_f32_16x16x32_bf16 a[120:123], a[188:191], v[180:183], a[120:123]
    ds_read_b64_tr_b16 a[170:171], v21 offset:4096
    v_mfma_f32_16x16x32_bf16 a[124:127], a[184:187], v[184:187], a[124:127]
    ds_read_b128 a[224:227], v8 offset:20480
    v_cvt_pk_bf16_f32 v151, v210, v211
    v_mfma_f32_16x16x32_bf16 a[124:127], a[188:191], v[188:191], a[124:127]
    s_waitcnt lgkmcnt(3)
    buffer_load_dwordx4 v38, s[8:11], s40 offen offset:2048 lds
    s_sub_u32 s43, s43, 1
    s_cmp_lg_u32 s43, 0
    s_cbranch_scc1 Lattn_loop
    v_mfma_f32_16x16x32_bf16 v[208:211], a[208:211], v[64:67], v[192:195]
    s_lshl_b32 s38, s3, 6
    v_exp_f32 v212, v212
    v_mfma_f32_16x16x32_bf16 v[208:211], a[212:215], v[68:71], v[208:211]
    s_add_u32 s38, s38, 131136
    v_exp_f32 v213, v213
    v_mfma_f32_16x16x32_bf16 v[208:211], a[216:219], v[72:75], v[208:211]
    v_exp_f32 v214, v214
    v_mfma_f32_16x16x32_bf16 v[208:211], a[220:223], v[76:79], v[208:211]
    s_add_u32 s57, s58, 0
    v_exp_f32 v215, v215
    v_mfma_f32_16x16x32_bf16 a[0:3], a[160:163], v[128:131], a[0:3]
    ds_read_b64_tr_b16 a[172:173], v21 offset:8192
    v_cvt_pk_bf16_f32 v158, v212, v213
    v_mfma_f32_16x16x32_bf16 a[0:3], a[164:167], v[132:135], a[0:3]
    ds_read_b64_tr_b16 a[174:175], v21 offset:12288
    v_permlane32_swap_b32 v224, v228
    v_mfma_f32_16x16x32_bf16 a[4:7], a[160:163], v[136:139], a[4:7]
    ds_read_b128 a[228:231], v9 offset:20480
    v_cvt_pk_bf16_f32 v159, v214, v215
    v_mfma_f32_16x16x32_bf16 a[4:7], a[164:167], v[140:143], a[4:7]
    buffer_load_dwordx4 a[128:131], v254, s[80:83], s57 offen
    v_mfma_f32_16x16x32_bf16 v[212:215], a[208:211], v[80:83], v[196:199]
    v_exp_f32 v208, v208
    v_mfma_f32_16x16x32_bf16 v[212:215], a[212:215], v[84:87], v[212:215]
    v_exp_f32 v209, v209
    v_mfma_f32_16x16x32_bf16 v[212:215], a[216:219], v[88:91], v[212:215]
    v_exp_f32 v210, v210
    v_mfma_f32_16x16x32_bf16 v[212:215], a[220:223], v[92:95], v[212:215]
    v_exp_f32 v211, v211
    v_mfma_f32_16x16x32_bf16 a[8:11], a[160:163], v[144:147], a[8:11]
    ds_read_b64_tr_b16 a[176:177], v22 offset:0
    v_cvt_pk_bf16_f32 v160, v208, v209
    v_mfma_f32_16x16x32_bf16 a[8:11], a[164:167], v[148:151], a[8:11]
    ds_read_b64_tr_b16 a[178:179], v22 offset:4096
    v_permlane32_swap_b32 v225, v229
    v_mfma_f32_16x16x32_bf16 a[12:15], a[160:163], v[152:155], a[12:15]
    ds_read_b128 a[232:235], v10 offset:20480
    v_cvt_pk_bf16_f32 v161, v210, v211
    v_mfma_f32_16x16x32_bf16 a[12:15], a[164:167], v[156:159], a[12:15]
    s_waitcnt lgkmcnt(3)
    buffer_load_dwordx4 v39, s[8:11], s40 offen offset:3072 lds
    v_mfma_f32_16x16x32_bf16 v[208:211], a[208:211], v[96:99], v[200:203]
    v_exp_f32 v212, v212
    v_mfma_f32_16x16x32_bf16 v[208:211], a[212:215], v[100:103], v[208:211]
    s_add_u32 s40, s40, 16384
    v_exp_f32 v213, v213
    v_mfma_f32_16x16x32_bf16 v[208:211], a[216:219], v[104:107], v[208:211]
    v_exp_f32 v214, v214
    v_mfma_f32_16x16x32_bf16 v[208:211], a[220:223], v[108:111], v[208:211]
    v_exp_f32 v215, v215
    v_mfma_f32_16x16x32_bf16 a[16:19], a[168:171], v[128:131], a[16:19]
    ds_read_b64_tr_b16 a[180:181], v22 offset:8192
    v_cvt_pk_bf16_f32 v168, v212, v213
    v_mfma_f32_16x16x32_bf16 a[16:19], a[172:175], v[132:135], a[16:19]
    ds_read_b64_tr_b16 a[182:183], v22 offset:12288
    v_permlane32_swap_b32 v226, v230
    v_mfma_f32_16x16x32_bf16 a[20:23], a[168:171], v[136:139], a[20:23]
    ds_read_b128 a[236:239], v11 offset:20480
    v_cvt_pk_bf16_f32 v169, v214, v215
    v_mfma_f32_16x16x32_bf16 a[20:23], a[172:175], v[140:143], a[20:23]
    v_permlane32_swap_b32 v227, v231
    v_add_f32 v224, v224, v228
    v_smfmac_f32_16x16x64_bf16 a[192:195], v[52:55], v[128:135], v50
    v_mfma_f32_16x16x32_bf16 v[212:215], a[208:211], v[112:115], v[204:207]
    v_exp_f32 v208, v208
    v_mfma_f32_16x16x32_bf16 v[212:215], a[212:215], v[116:119], v[212:215]
    s_add_u32 m0, s42, 98304
    v_exp_f32 v209, v209
    v_mfma_f32_16x16x32_bf16 v[212:215], a[216:219], v[120:123], v[212:215]
    v_exp_f32 v210, v210
    v_mfma_f32_16x16x32_bf16 v[212:215], a[220:223], v[124:127], v[212:215]
    v_exp_f32 v211, v211
    v_mfma_f32_16x16x32_bf16 a[24:27], a[168:171], v[144:147], a[24:27]
    ds_read_b64_tr_b16 a[184:185], v23 offset:0
    v_cvt_pk_bf16_f32 v176, v208, v209
    v_mfma_f32_16x16x32_bf16 a[24:27], a[172:175], v[148:151], a[24:27]
    ds_read_b64_tr_b16 a[186:187], v23 offset:4096
    v_add_f32 v225, v225, v229
    v_mfma_f32_16x16x32_bf16 a[28:31], a[168:171], v[152:155], a[28:31]
    ds_read_b128 a[208:211], v8 offset:24576
    v_cvt_pk_bf16_f32 v177, v210, v211
    v_mfma_f32_16x16x32_bf16 a[28:31], a[172:175], v[156:159], a[28:31]
    s_waitcnt lgkmcnt(3)
    buffer_load_dwordx4 v40, s[12:15], s41 offen lds
    v_mfma_f32_16x16x32_bf16 v[208:211], a[224:227], v[64:67], v[192:195]
    v_exp_f32 v212, v212
    v_mfma_f32_16x16x32_bf16 v[208:211], a[228:231], v[68:71], v[208:211]
    v_exp_f32 v213, v213
    v_mfma_f32_16x16x32_bf16 v[208:211], a[232:235], v[72:75], v[208:211]
    v_exp_f32 v214, v214
    v_mfma_f32_16x16x32_bf16 v[208:211], a[236:239], v[76:79], v[208:211]
    s_add_u32 s57, s58, 589824
    v_exp_f32 v215, v215
    v_mfma_f32_16x16x32_bf16 a[32:35], a[176:179], v[128:131], a[32:35]
    ds_read_b64_tr_b16 a[188:189], v23 offset:8192
    v_cvt_pk_bf16_f32 v184, v212, v213
    v_mfma_f32_16x16x32_bf16 a[32:35], a[180:183], v[132:135], a[32:35]
    ds_read_b64_tr_b16 a[190:191], v23 offset:12288
    v_add_f32 v226, v226, v230
    v_mfma_f32_16x16x32_bf16 a[36:39], a[176:179], v[136:139], a[36:39]
    ds_read_b128 a[212:215], v9 offset:24576
    v_cvt_pk_bf16_f32 v185, v214, v215
    v_mfma_f32_16x16x32_bf16 a[36:39], a[180:183], v[140:143], a[36:39]
    buffer_load_dwordx4 a[132:135], v254, s[80:83], s57 offen
    v_smfmac_f32_16x16x64_bf16 a[196:199], v[52:55], v[136:143], v50
    v_mfma_f32_16x16x32_bf16 v[212:215], a[224:227], v[80:83], v[196:199]
    v_exp_f32 v208, v208
    v_mfma_f32_16x16x32_bf16 v[212:215], a[228:231], v[84:87], v[212:215]
    v_exp_f32 v209, v209
    v_mfma_f32_16x16x32_bf16 v[212:215], a[232:235], v[88:91], v[212:215]
    v_exp_f32 v210, v210
    v_mfma_f32_16x16x32_bf16 v[212:215], a[236:239], v[92:95], v[212:215]
    v_exp_f32 v211, v211
    v_mfma_f32_16x16x32_bf16 a[40:43], a[176:179], v[144:147], a[40:43]
    ds_read_b64_tr_b16 a[160:161], v24 offset:0
    v_cvt_pk_bf16_f32 v162, v208, v209
    v_mfma_f32_16x16x32_bf16 a[40:43], a[180:183], v[148:151], a[40:43]
    ds_read_b64_tr_b16 a[162:163], v24 offset:4096
    v_add_f32 v227, v227, v231
    v_mfma_f32_16x16x32_bf16 a[44:47], a[176:179], v[152:155], a[44:47]
    ds_read_b128 a[216:219], v10 offset:24576
    v_cvt_pk_bf16_f32 v163, v210, v211
    v_mfma_f32_16x16x32_bf16 a[44:47], a[180:183], v[156:159], a[44:47]
    s_waitcnt lgkmcnt(3)
    buffer_load_dwordx4 v41, s[12:15], s41 offen offset:1024 lds
    v_mfma_f32_16x16x32_bf16 v[208:211], a[224:227], v[96:99], v[200:203]
    v_exp_f32 v212, v212
    v_mfma_f32_16x16x32_bf16 v[208:211], a[228:231], v[100:103], v[208:211]
    v_exp_f32 v213, v213
    v_mfma_f32_16x16x32_bf16 v[208:211], a[232:235], v[104:107], v[208:211]
    v_exp_f32 v214, v214
    v_mfma_f32_16x16x32_bf16 v[208:211], a[236:239], v[108:111], v[208:211]
    v_exp_f32 v215, v215
    v_mfma_f32_16x16x32_bf16 a[48:51], a[184:187], v[128:131], a[48:51]
    ds_read_b64_tr_b16 a[164:165], v24 offset:8192
    v_cvt_pk_bf16_f32 v170, v212, v213
    v_mfma_f32_16x16x32_bf16 a[48:51], a[188:191], v[132:135], a[48:51]
    ds_read_b64_tr_b16 a[166:167], v24 offset:12288
    v_and_b32 v244, 1, v1
    v_mfma_f32_16x16x32_bf16 a[52:55], a[184:187], v[136:139], a[52:55]
    ds_read_b128 a[220:223], v11 offset:24576
    v_cvt_pk_bf16_f32 v171, v214, v215
    v_mfma_f32_16x16x32_bf16 a[52:55], a[188:191], v[140:143], a[52:55]
    s_waitcnt vmcnt(15)
    buffer_load_dword v221, v236, s[20:23], 0 offen
    v_smfmac_f32_16x16x64_bf16 a[200:203], v[52:55], v[144:151], v50
    v_mfma_f32_16x16x32_bf16 v[212:215], a[224:227], v[112:115], v[204:207]
    v_exp_f32 v208, v208
    v_mfma_f32_16x16x32_bf16 v[212:215], a[228:231], v[116:119], v[212:215]
    v_exp_f32 v209, v209
    v_mfma_f32_16x16x32_bf16 v[212:215], a[232:235], v[120:123], v[212:215]
    v_exp_f32 v210, v210
    v_mfma_f32_16x16x32_bf16 v[212:215], a[236:239], v[124:127], v[212:215]
    v_exp_f32 v211, v211
    v_mfma_f32_16x16x32_bf16 a[56:59], a[184:187], v[144:147], a[56:59]
    ds_read_b64_tr_b16 a[168:169], v25 offset:0
    v_cvt_pk_bf16_f32 v178, v208, v209
    v_mfma_f32_16x16x32_bf16 a[56:59], a[188:191], v[148:151], a[56:59]
    ds_read_b64_tr_b16 a[170:171], v25 offset:4096
    v_permlane16_swap_b32 v224, v226
    v_mfma_f32_16x16x32_bf16 a[60:63], a[184:187], v[152:155], a[60:63]
    ds_read_b128 a[224:227], v8 offset:28672
    v_cvt_pk_bf16_f32 v179, v210, v211
    v_mfma_f32_16x16x32_bf16 a[60:63], a[188:191], v[156:159], a[60:63]
    s_waitcnt lgkmcnt(3)
    buffer_load_dwordx4 v40, s[12:15], s41 offen offset:2048 lds
    v_mfma_f32_16x16x32_bf16 v[208:211], a[208:211], v[64:67], v[192:195]
    v_exp_f32 v212, v212
    v_mfma_f32_16x16x32_bf16 v[208:211], a[212:215], v[68:71], v[208:211]
    v_exp_f32 v213, v213
    v_mfma_f32_16x16x32_bf16 v[208:211], a[216:219], v[72:75], v[208:211]
    v_exp_f32 v214, v214
    v_mfma_f32_16x16x32_bf16 v[208:211], a[220:223], v[76:79], v[208:211]
    s_add_u32 s57, s58, 1179648
    v_exp_f32 v215, v215
    v_mfma_f32_16x16x32_bf16 a[64:67], a[160:163], v[128:131], a[64:67]
    ds_read_b64_tr_b16 a[172:173], v25 offset:8192
    v_cvt_pk_bf16_f32 v186, v212, v213
    v_mfma_f32_16x16x32_bf16 a[64:67], a[164:167], v[132:135], a[64:67]
    ds_read_b64_tr_b16 a[174:175], v25 offset:12288
    v_permlane16_swap_b32 v225, v227
    v_mfma_f32_16x16x32_bf16 a[68:71], a[160:163], v[136:139], a[68:71]
    ds_read_b128 a[228:231], v9 offset:28672
    v_cvt_pk_bf16_f32 v187, v214, v215
    v_mfma_f32_16x16x32_bf16 a[68:71], a[164:167], v[140:143], a[68:71]
    buffer_load_dwordx4 a[136:139], v254, s[80:83], s57 offen
    v_smfmac_f32_16x16x64_bf16 a[204:207], v[52:55], v[152:159], v50
    v_mfma_f32_16x16x32_bf16 v[212:215], a[208:211], v[80:83], v[196:199]
    v_exp_f32 v208, v208
    v_mfma_f32_16x16x32_bf16 v[212:215], a[212:215], v[84:87], v[212:215]
    v_exp_f32 v209, v209
    v_mfma_f32_16x16x32_bf16 v[212:215], a[216:219], v[88:91], v[212:215]
    v_exp_f32 v210, v210
    v_mfma_f32_16x16x32_bf16 v[212:215], a[220:223], v[92:95], v[212:215]
    v_exp_f32 v211, v211
    v_mfma_f32_16x16x32_bf16 a[72:75], a[160:163], v[144:147], a[72:75]
    ds_read_b64_tr_b16 a[176:177], v26 offset:0
    v_cvt_pk_bf16_f32 v164, v208, v209
    v_mfma_f32_16x16x32_bf16 a[72:75], a[164:167], v[148:151], a[72:75]
    ds_read_b64_tr_b16 a[178:179], v26 offset:4096
    v_lshlrev_b32 v244, 5, v244
    v_mfma_f32_16x16x32_bf16 a[76:79], a[160:163], v[152:155], a[76:79]
    ds_read_b128 a[232:235], v10 offset:28672
    v_cvt_pk_bf16_f32 v165, v210, v211
    v_mfma_f32_16x16x32_bf16 a[76:79], a[164:167], v[156:159], a[76:79]
    s_waitcnt lgkmcnt(3)
    buffer_load_dwordx4 v41, s[12:15], s41 offen offset:3072 lds
    v_mfma_f32_16x16x32_bf16 v[208:211], a[208:211], v[96:99], v[200:203]
    v_exp_f32 v212, v212
    v_mfma_f32_16x16x32_bf16 v[208:211], a[212:215], v[100:103], v[208:211]
    s_add_u32 s41, s41, 16384
    v_exp_f32 v213, v213
    v_mfma_f32_16x16x32_bf16 v[208:211], a[216:219], v[104:107], v[208:211]
    v_exp_f32 v214, v214
    v_mfma_f32_16x16x32_bf16 v[208:211], a[220:223], v[108:111], v[208:211]
    v_exp_f32 v215, v215
    v_mfma_f32_16x16x32_bf16 a[80:83], a[168:171], v[128:131], a[80:83]
    ds_read_b64_tr_b16 a[180:181], v26 offset:8192
    v_cvt_pk_bf16_f32 v172, v212, v213
    v_mfma_f32_16x16x32_bf16 a[80:83], a[172:175], v[132:135], a[80:83]
    ds_read_b64_tr_b16 a[182:183], v26 offset:12288
    v_add_f32 v224, v224, v226
    v_mfma_f32_16x16x32_bf16 a[84:87], a[168:171], v[136:139], a[84:87]
    ds_read_b128 a[236:239], v11 offset:28672
    v_cvt_pk_bf16_f32 v173, v214, v215
    v_mfma_f32_16x16x32_bf16 a[84:87], a[172:175], v[140:143], a[84:87]
    s_waitcnt vmcnt(13)
    s_barrier
    v_mfma_f32_16x16x32_bf16 v[212:215], a[208:211], v[112:115], v[204:207]
    v_exp_f32 v208, v208
    v_mfma_f32_16x16x32_bf16 v[212:215], a[212:215], v[116:119], v[212:215]
    s_add_u32 s49, s45, 1024
    v_exp_f32 v209, v209
    v_mfma_f32_16x16x32_bf16 v[212:215], a[216:219], v[120:123], v[212:215]
    s_add_u32 m0, s42, 0
    v_exp_f32 v210, v210
    v_mfma_f32_16x16x32_bf16 v[212:215], a[220:223], v[124:127], v[212:215]
    v_exp_f32 v211, v211
    v_mfma_f32_16x16x32_bf16 a[88:91], a[168:171], v[144:147], a[88:91]
    ds_read_b64_tr_b16 a[184:185], v27 offset:0
    v_cvt_pk_bf16_f32 v180, v208, v209
    v_mfma_f32_16x16x32_bf16 a[88:91], a[172:175], v[148:151], a[88:91]
    ds_read_b64_tr_b16 a[186:187], v27 offset:4096
    v_add_f32 v225, v225, v227
    v_mfma_f32_16x16x32_bf16 a[92:95], a[168:171], v[152:155], a[92:95]
    ds_read_b128 a[208:211], v8 offset:32768
    v_cvt_pk_bf16_f32 v181, v210, v211
    v_mfma_f32_16x16x32_bf16 a[92:95], a[172:175], v[156:159], a[92:95]
    s_waitcnt lgkmcnt(3)
    buffer_load_dwordx4 v46, s[20:23], s49 offen lds
    v_mfma_f32_16x16x32_bf16 v[208:211], a[224:227], v[64:67], v[192:195]
    v_exp_f32 v212, v212
    v_mfma_f32_16x16x32_bf16 v[208:211], a[228:231], v[68:71], v[208:211]
    v_exp_f32 v213, v213
    v_mfma_f32_16x16x32_bf16 v[208:211], a[232:235], v[72:75], v[208:211]
    v_exp_f32 v214, v214
    v_mfma_f32_16x16x32_bf16 v[208:211], a[236:239], v[76:79], v[208:211]
    s_add_u32 s37, s55, 0
    v_exp_f32 v215, v215
    v_mfma_f32_16x16x32_bf16 a[96:99], a[176:179], v[128:131], a[96:99]
    ds_read_b64_tr_b16 a[188:189], v27 offset:8192
    v_cvt_pk_bf16_f32 v188, v212, v213
    v_mfma_f32_16x16x32_bf16 a[96:99], a[180:183], v[132:135], a[96:99]
    ds_read_b64_tr_b16 a[190:191], v27 offset:12288
    v_lshrrev_b32 v245, 4, v1
    v_mfma_f32_16x16x32_bf16 a[100:103], a[176:179], v[136:139], a[100:103]
    ds_read_b128 a[212:215], v9 offset:32768
    v_cvt_pk_bf16_f32 v189, v214, v215
    v_mfma_f32_16x16x32_bf16 a[100:103], a[180:183], v[140:143], a[100:103]
    buffer_load_dword v239, v238, s[28:31], s37 offen
    v_mfma_f32_16x16x32_bf16 v[212:215], a[224:227], v[80:83], v[196:199]
    v_exp_f32 v208, v208
    v_mfma_f32_16x16x32_bf16 v[212:215], a[228:231], v[84:87], v[212:215]
    v_exp_f32 v209, v209
    v_mfma_f32_16x16x32_bf16 v[212:215], a[232:235], v[88:91], v[212:215]
    v_exp_f32 v210, v210
    v_mfma_f32_16x16x32_bf16 v[212:215], a[236:239], v[92:95], v[212:215]
    v_exp_f32 v211, v211
    v_mfma_f32_16x16x32_bf16 a[104:107], a[176:179], v[144:147], a[104:107]
    ds_read_b64_tr_b16 a[160:161], v20 offset:16384
    v_cvt_pk_bf16_f32 v166, v208, v209
    v_mfma_f32_16x16x32_bf16 a[104:107], a[180:183], v[148:151], a[104:107]
    ds_read_b64_tr_b16 a[162:163], v20 offset:20480
    v_lshl_add_u32 v244, v245, 3, v244
    v_mfma_f32_16x16x32_bf16 a[108:111], a[176:179], v[152:155], a[108:111]
    ds_read_b128 a[216:219], v10 offset:32768
    v_cvt_pk_bf16_f32 v167, v210, v211
    v_mfma_f32_16x16x32_bf16 a[108:111], a[180:183], v[156:159], a[108:111]
    s_waitcnt lgkmcnt(3)
    buffer_load_dwordx4 v47, s[20:23], s49 offen offset:1024 lds
    v_mfma_f32_16x16x32_bf16 v[208:211], a[224:227], v[96:99], v[200:203]
    v_exp_f32 v212, v212
    v_mfma_f32_16x16x32_bf16 v[208:211], a[228:231], v[100:103], v[208:211]
    v_exp_f32 v213, v213
    v_mfma_f32_16x16x32_bf16 v[208:211], a[232:235], v[104:107], v[208:211]
    v_exp_f32 v214, v214
    v_mfma_f32_16x16x32_bf16 v[208:211], a[236:239], v[108:111], v[208:211]
    s_add_u32 s57, s58, 1769472
    v_exp_f32 v215, v215
    v_mfma_f32_16x16x32_bf16 a[112:115], a[184:187], v[128:131], a[112:115]
    ds_read_b64_tr_b16 a[164:165], v20 offset:24576
    v_cvt_pk_bf16_f32 v174, v212, v213
    v_mfma_f32_16x16x32_bf16 a[112:115], a[188:191], v[132:135], a[112:115]
    ds_read_b64_tr_b16 a[166:167], v20 offset:28672
    v_mfma_f32_16x16x32_bf16 a[116:119], a[184:187], v[136:139], a[116:119]
    ds_read_b128 a[220:223], v11 offset:32768
    v_cvt_pk_bf16_f32 v175, v214, v215
    v_mfma_f32_16x16x32_bf16 a[116:119], a[188:191], v[140:143], a[116:119]
    buffer_load_dwordx4 a[140:143], v254, s[80:83], s57 offen
    v_mfma_f32_16x16x32_bf16 v[212:215], a[224:227], v[112:115], v[204:207]
Ltour6:
    s_cbranch_execz Ltour10
    v_exp_f32 v208, v208
    v_mfma_f32_16x16x32_bf16 v[212:215], a[228:231], v[116:119], v[212:215]
    v_exp_f32 v209, v209
    v_mfma_f32_16x16x32_bf16 v[212:215], a[232:235], v[120:123], v[212:215]
    v_exp_f32 v210, v210
    v_mfma_f32_16x16x32_bf16 v[212:215], a[236:239], v[124:127], v[212:215]
    v_exp_f32 v211, v211
    v_mfma_f32_16x16x32_bf16 a[120:123], a[184:187], v[144:147], a[120:123]
    ds_read_b64_tr_b16 a[168:169], v21 offset:16384
    v_cvt_pk_bf16_f32 v182, v208, v209
    v_mfma_f32_16x16x32_bf16 a[120:123], a[188:191], v[148:151], a[120:123]
    ds_read_b64_tr_b16 a[170:171], v21 offset:20480
    v_mfma_f32_16x16x32_bf16 a[124:127], a[184:187], v[152:155], a[124:127]
    ds_read_b128 a[224:227], v8 offset:36864
    v_cvt_pk_bf16_f32 v183, v210, v211
    v_mfma_f32_16x16x32_bf16 a[124:127], a[188:191], v[156:159], a[124:127]
    s_waitcnt lgkmcnt(3)
    buffer_load_dwordx4 v48, s[20:23], s49 offen offset:2048 lds
    v_mfma_f32_16x16x32_bf16 v[208:211], a[208:211], v[64:67], v[192:195]
    v_exp_f32 v212, v212
    v_mfma_f32_16x16x32_bf16 v[208:211], a[212:215], v[68:71], v[208:211]
    v_exp_f32 v213, v213
    v_mfma_f32_16x16x32_bf16 v[208:211], a[216:219], v[72:75], v[208:211]
    v_exp_f32 v214, v214
    v_mfma_f32_16x16x32_bf16 v[208:211], a[220:223], v[76:79], v[208:211]
    s_add_u32 s57, s58, 2359296
    v_exp_f32 v215, v215
    v_mfma_f32_16x16x32_bf16 a[0:3], a[160:163], v[160:163], a[0:3]
    ds_read_b64_tr_b16 a[172:173], v21 offset:24576
    v_cvt_pk_bf16_f32 v190, v212, v213
    v_mfma_f32_16x16x32_bf16 a[0:3], a[164:167], v[164:167], a[0:3]
    ds_read_b64_tr_b16 a[174:175], v21 offset:28672
    v_mov_b32 v63, 0
    v_mfma_f32_16x16x32_bf16 a[4:7], a[160:163], v[168:171], a[4:7]
    ds_read_b128 a[228:231], v9 offset:36864
    v_cvt_pk_bf16_f32 v191, v214, v215
    v_mfma_f32_16x16x32_bf16 a[4:7], a[164:167], v[172:175], a[4:7]
    buffer_load_dwordx4 a[144:147], v254, s[80:83], s57 offen
    v_mfma_f32_16x16x32_bf16 v[212:215], a[208:211], v[80:83], v[196:199]
    v_exp_f32 v208, v208
    v_mfma_f32_16x16x32_bf16 v[212:215], a[212:215], v[84:87], v[212:215]
    v_exp_f32 v209, v209
    v_mfma_f32_16x16x32_bf16 v[212:215], a[216:219], v[88:91], v[212:215]
    v_exp_f32 v210, v210
    v_mfma_f32_16x16x32_bf16 v[212:215], a[220:223], v[92:95], v[212:215]
    v_exp_f32 v211, v211
    v_mfma_f32_16x16x32_bf16 a[8:11], a[160:163], v[176:179], a[8:11]
    ds_read_b64_tr_b16 a[176:177], v22 offset:16384
    v_cvt_pk_bf16_f32 v128, v208, v209
    v_mfma_f32_16x16x32_bf16 a[8:11], a[164:167], v[180:183], a[8:11]
    ds_read_b64_tr_b16 a[178:179], v22 offset:20480
    v_add_f32_dpp v224, v224, v224 row_ror:2 row_mask:0xf bank_mask:0xf
    v_mfma_f32_16x16x32_bf16 a[12:15], a[160:163], v[184:187], a[12:15]
    ds_read_b128 a[232:235], v10 offset:36864
    v_cvt_pk_bf16_f32 v129, v210, v211
    v_mfma_f32_16x16x32_bf16 a[12:15], a[164:167], v[188:191], a[12:15]
    s_waitcnt lgkmcnt(3)
    buffer_load_dwordx4 v49, s[20:23], s49 offen offset:3072 lds
    v_mfma_f32_16x16x32_bf16 v[208:211], a[208:211], v[96:99], v[200:203]
    s_lshr_b32 s39, s2, 5
    v_exp_f32 v212, v212
    v_mfma_f32_16x16x32_bf16 v[208:211], a[212:215], v[100:103], v[208:211]
    s_lshl_b32 s39, s39, 3
    v_exp_f32 v213, v213
    v_mfma_f32_16x16x32_bf16 v[208:211], a[216:219], v[104:107], v[208:211]
    s_and_b32 s43, s2, 7
    v_exp_f32 v214, v214
    v_mfma_f32_16x16x32_bf16 v[208:211], a[220:223], v[108:111], v[208:211]
    s_add_u32 s39, s39, s43
    v_exp_f32 v215, v215
    v_mfma_f32_16x16x32_bf16 a[16:19], a[168:171], v[160:163], a[16:19]
    ds_read_b64_tr_b16 a[180:181], v22 offset:24576
    v_cvt_pk_bf16_f32 v136, v212, v213
    v_mfma_f32_16x16x32_bf16 a[16:19], a[172:175], v[164:167], a[16:19]
    ds_read_b64_tr_b16 a[182:183], v22 offset:28672
    v_add_f32_dpp v225, v225, v225 row_ror:2 row_mask:0xf bank_mask:0xf
    v_mfma_f32_16x16x32_bf16 a[20:23], a[168:171], v[168:171], a[20:23]
    ds_read_b128 a[236:239], v11 offset:36864
    v_cvt_pk_bf16_f32 v137, v214, v215
    v_mfma_f32_16x16x32_bf16 a[20:23], a[172:175], v[172:175], a[20:23]
    buffer_load_dword v253, v63, s[24:27], s54 offen offset:12 sc1
    v_smfmac_f32_16x16x64_bf16 a[192:195], v[52:55], v[160:167], v50
    v_mfma_f32_16x16x32_bf16 v[212:215], a[208:211], v[112:115], v[204:207]
    s_lshl_b32 s39, s39, 2
    v_exp_f32 v208, v208
    v_mfma_f32_16x16x32_bf16 v[212:215], a[212:215], v[116:119], v[212:215]
    s_add_u32 m0, s42, 114688
    v_exp_f32 v209, v209
    v_mfma_f32_16x16x32_bf16 v[212:215], a[216:219], v[120:123], v[212:215]
    s_bfe_u32 s43, s2, 0x20003
    v_exp_f32 v210, v210
    v_mfma_f32_16x16x32_bf16 v[212:215], a[220:223], v[124:127], v[212:215]
    s_add_u32 s39, s39, s43
    v_exp_f32 v211, v211
    v_mfma_f32_16x16x32_bf16 a[24:27], a[168:171], v[176:179], a[24:27]
    ds_read_b64_tr_b16 a[184:185], v23 offset:16384
    v_cvt_pk_bf16_f32 v144, v208, v209
    v_mfma_f32_16x16x32_bf16 a[24:27], a[172:175], v[180:183], a[24:27]
    ds_read_b64_tr_b16 a[186:187], v23 offset:20480
    v_add_f32_dpp v224, v224, v224 row_ror:4 row_mask:0xf bank_mask:0xf
    v_mfma_f32_16x16x32_bf16 a[28:31], a[168:171], v[184:187], a[28:31]
    ds_read_b128 a[208:211], v8 offset:40960
    v_cvt_pk_bf16_f32 v145, v210, v211
    v_mfma_f32_16x16x32_bf16 a[28:31], a[172:175], v[188:191], a[28:31]
    s_waitcnt lgkmcnt(3)
    buffer_load_dwordx4 v40, s[12:15], s41 offen lds
    v_mfma_f32_16x16x32_bf16 v[208:211], a[224:227], v[64:67], v[192:195]
    s_add_u32 s39, s39, 72
    v_exp_f32 v212, v212
    v_mfma_f32_16x16x32_bf16 v[208:211], a[228:231], v[68:71], v[208:211]
    s_cmp_lt_u32 s39, 216
    s_cselect_b32 s43, 0, 2147483648
    v_exp_f32 v213, v213
    v_mfma_f32_16x16x32_bf16 v[208:211], a[232:235], v[72:75], v[208:211]
    s_or_b32 s43, s43, s48
    v_exp_f32 v214, v214
    v_mfma_f32_16x16x32_bf16 v[208:211], a[236:239], v[76:79], v[208:211]
    s_add_u32 s57, s58, 2949120
    v_exp_f32 v215, v215
    v_mfma_f32_16x16x32_bf16 a[32:35], a[176:179], v[160:163], a[32:35]
    ds_read_b64_tr_b16 a[188:189], v23 offset:24576
    v_cvt_pk_bf16_f32 v152, v212, v213
    v_mfma_f32_16x16x32_bf16 a[32:35], a[180:183], v[164:167], a[32:35]
    ds_read_b64_tr_b16 a[190:191], v23 offset:28672
    v_add_f32_dpp v225, v225, v225 row_ror:4 row_mask:0xf bank_mask:0xf
    v_mfma_f32_16x16x32_bf16 a[36:39], a[176:179], v[168:171], a[36:39]
    ds_read_b128 a[212:215], v9 offset:40960
    v_cvt_pk_bf16_f32 v153, v214, v215
    v_mfma_f32_16x16x32_bf16 a[36:39], a[180:183], v[172:175], a[36:39]
    buffer_load_dwordx4 a[148:151], v254, s[80:83], s57 offen
    v_smfmac_f32_16x16x64_bf16 a[196:199], v[52:55], v[168:175], v50
    v_mfma_f32_16x16x32_bf16 v[212:215], a[224:227], v[80:83], v[196:199]
    s_and_b32 s43, s43, 2147483648
    v_exp_f32 v208, v208
    v_mfma_f32_16x16x32_bf16 v[212:215], a[228:231], v[84:87], v[212:215]
    s_sub_u32 s36, s39, 144
    v_exp_f32 v209, v209
    v_mfma_f32_16x16x32_bf16 v[212:215], a[232:235], v[88:91], v[212:215]
    s_cmp_lt_u32 s36, 36
    s_cselect_b32 s36, 1.0, 0
    v_exp_f32 v210, v210
    v_mfma_f32_16x16x32_bf16 v[212:215], a[236:239], v[92:95], v[212:215]
    s_lshr_b32 s44, s39, 1
    v_exp_f32 v211, v211
    v_mfma_f32_16x16x32_bf16 a[40:43], a[176:179], v[176:179], a[40:43]
    ds_read_b64_tr_b16 a[160:161], v24 offset:16384
    v_cvt_pk_bf16_f32 v130, v208, v209
    v_mfma_f32_16x16x32_bf16 a[40:43], a[180:183], v[180:183], a[40:43]
    ds_read_b64_tr_b16 a[162:163], v24 offset:20480
    v_add_f32_dpp v224, v224, v224 row_ror:8 row_mask:0xf bank_mask:0xf
    v_mfma_f32_16x16x32_bf16 a[44:47], a[176:179], v[184:187], a[44:47]
    ds_read_b128 a[216:219], v10 offset:40960
    v_cvt_pk_bf16_f32 v131, v210, v211
    v_mfma_f32_16x16x32_bf16 a[44:47], a[180:183], v[188:191], a[44:47]
    s_waitcnt lgkmcnt(3)
    buffer_load_dwordx4 v41, s[12:15], s41 offen offset:1024 lds
    v_mfma_f32_16x16x32_bf16 v[208:211], a[224:227], v[96:99], v[200:203]
    s_lshl_b32 s44, s44, 6
    v_exp_f32 v212, v212
    v_mfma_f32_16x16x32_bf16 v[208:211], a[228:231], v[100:103], v[208:211]
    s_and_b32 s39, s39, 1
    v_exp_f32 v213, v213
    v_mfma_f32_16x16x32_bf16 v[208:211], a[232:235], v[104:107], v[208:211]
    s_lshl_b32 s39, s39, 3
    v_exp_f32 v214, v214
    v_mfma_f32_16x16x32_bf16 v[208:211], a[236:239], v[108:111], v[208:211]
    s_add_u32 s39, s39, s44
    v_exp_f32 v215, v215
    v_mfma_f32_16x16x32_bf16 a[48:51], a[184:187], v[160:163], a[48:51]
    ds_read_b64_tr_b16 a[164:165], v24 offset:24576
    v_cvt_pk_bf16_f32 v138, v212, v213
    v_mfma_f32_16x16x32_bf16 a[48:51], a[188:191], v[164:167], a[48:51]
    ds_read_b64_tr_b16 a[166:167], v24 offset:28672
    v_add_f32_dpp v225, v225, v225 row_ror:8 row_mask:0xf bank_mask:0xf
    v_mfma_f32_16x16x32_bf16 a[52:55], a[184:187], v[168:171], a[52:55]
    ds_read_b128 a[220:223], v11 offset:40960
    v_cvt_pk_bf16_f32 v139, v214, v215
    v_mfma_f32_16x16x32_bf16 a[52:55], a[188:191], v[172:175], a[52:55]
    v_add_u32 v244, s38, v244
    v_and_b32 v245, 7, v1
    v_smfmac_f32_16x16x64_bf16 a[200:203], v[52:55], v[176:183], v50
    v_mfma_f32_16x16x32_bf16 v[212:215], a[224:227], v[112:115], v[204:207]
    s_add_u32 s39, s39, 16384
    v_exp_f32 v208, v208
    v_mfma_f32_16x16x32_bf16 v[212:215], a[228:231], v[116:119], v[212:215]
    s_or_b32 s39, s39, s43
    v_exp_f32 v209, v209
    v_mfma_f32_16x16x32_bf16 v[212:215], a[232:235], v[120:123], v[212:215]
    s_and_b32 s43, s48, 2147483648
    v_exp_f32 v210, v210
    v_mfma_f32_16x16x32_bf16 v[212:215], a[236:239], v[124:127], v[212:215]
    v_exp_f32 v211, v211
    v_mfma_f32_16x16x32_bf16 a[56:59], a[184:187], v[176:179], a[56:59]
    ds_read_b64_tr_b16 a[168:169], v25 offset:16384
    v_cvt_pk_bf16_f32 v146, v208, v209
    v_mfma_f32_16x16x32_bf16 a[56:59], a[188:191], v[180:183], a[56:59]
    ds_read_b64_tr_b16 a[170:171], v25 offset:20480
    v_mfma_f32_16x16x32_bf16 a[60:63], a[184:187], v[184:187], a[60:63]
    ds_read_b128 a[224:227], v8 offset:45056
    v_cvt_pk_bf16_f32 v147, v210, v211
    v_mfma_f32_16x16x32_bf16 a[60:63], a[188:191], v[188:191], a[60:63]
    s_waitcnt lgkmcnt(3)
    buffer_load_dwordx4 v40, s[12:15], s41 offen offset:2048 lds
    v_mfma_f32_16x16x32_bf16 v[208:211], a[208:211], v[64:67], v[192:195]
    v_exp_f32 v212, v212
    v_mfma_f32_16x16x32_bf16 v[208:211], a[212:215], v[68:71], v[208:211]
    v_exp_f32 v213, v213
    v_mfma_f32_16x16x32_bf16 v[208:211], a[216:219], v[72:75], v[208:211]
    v_exp_f32 v214, v214
    v_mfma_f32_16x16x32_bf16 v[208:211], a[220:223], v[76:79], v[208:211]
    s_add_u32 s57, s58, 3538944
    v_exp_f32 v215, v215
    v_mfma_f32_16x16x32_bf16 a[64:67], a[160:163], v[160:163], a[64:67]
    ds_read_b64_tr_b16 a[172:173], v25 offset:24576
    v_cvt_pk_bf16_f32 v154, v212, v213
    v_mfma_f32_16x16x32_bf16 a[64:67], a[164:167], v[164:167], a[64:67]
    ds_read_b64_tr_b16 a[174:175], v25 offset:28672
    v_lshlrev_b32 v245, 3, v245
    v_mfma_f32_16x16x32_bf16 a[68:71], a[160:163], v[168:171], a[68:71]
    ds_read_b128 a[228:231], v9 offset:45056
    v_cvt_pk_bf16_f32 v155, v214, v215
    v_mfma_f32_16x16x32_bf16 a[68:71], a[164:167], v[172:175], a[68:71]
    buffer_load_dwordx4 a[152:155], v254, s[80:83], s57 offen
    v_smfmac_f32_16x16x64_bf16 a[204:207], v[52:55], v[184:191], v50
    ds_write_b64 v244, v[224:225]
    v_mfma_f32_16x16x32_bf16 v[212:215], a[208:211], v[80:83], v[196:199]
    v_exp_f32 v208, v208
    v_mfma_f32_16x16x32_bf16 v[212:215], a[212:215], v[84:87], v[212:215]
    v_exp_f32 v209, v209
    v_mfma_f32_16x16x32_bf16 v[212:215], a[216:219], v[88:91], v[212:215]
    v_exp_f32 v210, v210
    v_mfma_f32_16x16x32_bf16 v[212:215], a[220:223], v[92:95], v[212:215]
    v_exp_f32 v211, v211
    v_mfma_f32_16x16x32_bf16 a[72:75], a[160:163], v[176:179], a[72:75]
    ds_read_b64_tr_b16 a[176:177], v26 offset:16384
    v_cvt_pk_bf16_f32 v132, v208, v209
    v_mfma_f32_16x16x32_bf16 a[72:75], a[164:167], v[180:183], a[72:75]
    ds_read_b64_tr_b16 a[178:179], v26 offset:20480
    v_add_u32 v245, 131136, v245
    v_mfma_f32_16x16x32_bf16 a[76:79], a[160:163], v[184:187], a[76:79]
    ds_read_b128 a[232:235], v10 offset:45056
    v_cvt_pk_bf16_f32 v133, v210, v211
    v_mfma_f32_16x16x32_bf16 a[76:79], a[164:167], v[188:191], a[76:79]
    s_waitcnt lgkmcnt(3)
    buffer_load_dwordx4 v41, s[12:15], s41 offen offset:3072 lds
    v_mfma_f32_16x16x32_bf16 v[208:211], a[208:211], v[96:99], v[200:203]
    v_exp_f32 v212, v212
    v_mfma_f32_16x16x32_bf16 v[208:211], a[212:215], v[100:103], v[208:211]
    s_add_u32 s41, s41, 16384
    v_exp_f32 v213, v213
    v_mfma_f32_16x16x32_bf16 v[208:211], a[216:219], v[104:107], v[208:211]
    v_exp_f32 v214, v214
    v_mfma_f32_16x16x32_bf16 v[208:211], a[220:223], v[108:111], v[208:211]
    v_exp_f32 v215, v215
    v_mfma_f32_16x16x32_bf16 a[80:83], a[168:171], v[160:163], a[80:83]
    ds_read_b64_tr_b16 a[180:181], v26 offset:24576
    v_cvt_pk_bf16_f32 v140, v212, v213
    v_mfma_f32_16x16x32_bf16 a[80:83], a[172:175], v[164:167], a[80:83]
    ds_read_b64_tr_b16 a[182:183], v26 offset:28672
    v_mfma_f32_16x16x32_bf16 a[84:87], a[168:171], v[168:171], a[84:87]
    ds_read_b128 a[236:239], v11 offset:45056
    v_cvt_pk_bf16_f32 v141, v214, v215
    v_mfma_f32_16x16x32_bf16 a[84:87], a[172:175], v[172:175], a[84:87]
    s_waitcnt vmcnt(14)
    s_barrier
    v_mfma_f32_16x16x32_bf16 v[212:215], a[208:211], v[112:115], v[204:207]
    v_exp_f32 v208, v208
    v_mfma_f32_16x16x32_bf16 v[212:215], a[212:215], v[116:119], v[212:215]
    s_add_u32 s49, s45, 74752
    v_exp_f32 v209, v209
    v_mfma_f32_16x16x32_bf16 v[212:215], a[216:219], v[120:123], v[212:215]
    s_add_u32 m0, s42, 16384
    v_exp_f32 v210, v210
    v_mfma_f32_16x16x32_bf16 v[212:215], a[220:223], v[124:127], v[212:215]
    v_exp_f32 v211, v211
    v_mfma_f32_16x16x32_bf16 a[88:91], a[168:171], v[176:179], a[88:91]
    ds_read_b64_tr_b16 a[184:185], v27 offset:16384
    v_cvt_pk_bf16_f32 v148, v208, v209
    v_mfma_f32_16x16x32_bf16 a[88:91], a[172:175], v[180:183], a[88:91]
    ds_read_b64_tr_b16 a[186:187], v27 offset:20480
    ds_read_b64 v[224:225], v245 offset:0
    v_mfma_f32_16x16x32_bf16 a[92:95], a[168:171], v[184:187], a[92:95]
    ds_read_b128 a[208:211], v8 offset:49152
    v_cvt_pk_bf16_f32 v149, v210, v211
    v_mfma_f32_16x16x32_bf16 a[92:95], a[172:175], v[188:191], a[92:95]
    s_waitcnt lgkmcnt(3)
    buffer_load_dwordx4 v46, s[20:23], s49 offen lds
    v_mfma_f32_16x16x32_bf16 v[208:211], a[224:227], v[64:67], v[192:195]
    v_exp_f32 v212, v212
    v_mfma_f32_16x16x32_bf16 v[208:211], a[228:231], v[68:71], v[208:211]
    v_exp_f32 v213, v213
    v_mfma_f32_16x16x32_bf16 v[208:211], a[232:235], v[72:75], v[208:211]
    v_exp_f32 v214, v214
    v_mfma_f32_16x16x32_bf16 v[208:211], a[236:239], v[76:79], v[208:211]
    v_exp_f32 v215, v215
    v_mfma_f32_16x16x32_bf16 a[96:99], a[176:179], v[160:163], a[96:99]
    ds_read_b64_tr_b16 a[188:189], v27 offset:24576
    v_cvt_pk_bf16_f32 v156, v212, v213
    v_mfma_f32_16x16x32_bf16 a[96:99], a[180:183], v[164:167], a[96:99]
    ds_read_b64_tr_b16 a[190:191], v27 offset:28672
    ds_read_b64 v[226:227], v245 offset:64
    v_mfma_f32_16x16x32_bf16 a[100:103], a[176:179], v[168:171], a[100:103]
    ds_read_b128 a[212:215], v9 offset:49152
    v_cvt_pk_bf16_f32 v157, v214, v215
    v_mfma_f32_16x16x32_bf16 a[100:103], a[180:183], v[172:175], a[100:103]
    v_mfma_f32_16x16x32_bf16 v[212:215], a[224:227], v[80:83], v[196:199]
    v_exp_f32 v208, v208
    v_mfma_f32_16x16x32_bf16 v[212:215], a[228:231], v[84:87], v[212:215]
    v_exp_f32 v209, v209
    v_mfma_f32_16x16x32_bf16 v[212:215], a[232:235], v[88:91], v[212:215]
    v_exp_f32 v210, v210
    v_mfma_f32_16x16x32_bf16 v[212:215], a[236:239], v[92:95], v[212:215]
    v_exp_f32 v211, v211
    v_mfma_f32_16x16x32_bf16 a[104:107], a[176:179], v[176:179], a[104:107]
    ds_read_b64_tr_b16 a[160:161], v20 offset:32768
    v_cvt_pk_bf16_f32 v134, v208, v209
    v_mfma_f32_16x16x32_bf16 a[104:107], a[180:183], v[180:183], a[104:107]
    ds_read_b64_tr_b16 a[162:163], v20 offset:36864
    ds_read_b64 v[228:229], v245 offset:128
    v_mfma_f32_16x16x32_bf16 a[108:111], a[176:179], v[184:187], a[108:111]
    ds_read_b128 a[216:219], v10 offset:49152
    v_cvt_pk_bf16_f32 v135, v210, v211
    v_mfma_f32_16x16x32_bf16 a[108:111], a[180:183], v[188:191], a[108:111]
    s_waitcnt lgkmcnt(3)
    buffer_load_dwordx4 v47, s[20:23], s49 offen offset:1024 lds
    v_mfma_f32_16x16x32_bf16 v[208:211], a[224:227], v[96:99], v[200:203]
    v_exp_f32 v212, v212
    v_mfma_f32_16x16x32_bf16 v[208:211], a[228:231], v[100:103], v[208:211]
    v_exp_f32 v213, v213
    v_mfma_f32_16x16x32_bf16 v[208:211], a[232:235], v[104:107], v[208:211]
    v_exp_f32 v214, v214
    v_mfma_f32_16x16x32_bf16 v[208:211], a[236:239], v[108:111], v[208:211]
    s_add_u32 s57, s58, 4128768
    v_exp_f32 v215, v215
    v_mfma_f32_16x16x32_bf16 a[112:115], a[184:187], v[160:163], a[112:115]
    ds_read_b64_tr_b16 a[164:165], v20 offset:40960
    v_cvt_pk_bf16_f32 v142, v212, v213
    v_mfma_f32_16x16x32_bf16 a[112:115], a[188:191], v[164:167], a[112:115]
    ds_read_b64_tr_b16 a[166:167], v20 offset:45056
    ds_read_b64 v[230:231], v245 offset:192
    v_mfma_f32_16x16x32_bf16 a[116:119], a[184:187], v[168:171], a[116:119]
    ds_read_b128 a[220:223], v11 offset:49152
    v_cvt_pk_bf16_f32 v143, v214, v215
    v_mfma_f32_16x16x32_bf16 a[116:119], a[188:191], v[172:175], a[116:119]
    buffer_load_dwordx4 a[156:159], v254, s[80:83], s57 offen
    v_mfma_f32_16x16x32_bf16 v[212:215], a[224:227], v[112:115], v[204:207]
    v_exp_f32 v208, v208
    v_mfma_f32_16x16x32_bf16 v[212:215], a[228:231], v[116:119], v[212:215]
    v_exp_f32 v209, v209
    v_mfma_f32_16x16x32_bf16 v[212:215], a[232:235], v[120:123], v[212:215]
    v_exp_f32 v210, v210
    v_mfma_f32_16x16x32_bf16 v[212:215], a[236:239], v[124:127], v[212:215]
    v_exp_f32 v211, v211
    v_mfma_f32_16x16x32_bf16 a[120:123], a[184:187], v[176:179], a[120:123]
    ds_read_b64_tr_b16 a[168:169], v21 offset:32768
    v_cvt_pk_bf16_f32 v150, v208, v209
    v_mfma_f32_16x16x32_bf16 a[120:123], a[188:191], v[180:183], a[120:123]
    ds_read_b64_tr_b16 a[170:171], v21 offset:36864
    v_mfma_f32_16x16x32_bf16 a[124:127], a[184:187], v[184:187], a[124:127]
    ds_read_b128 a[224:227], v8 offset:53248
    v_cvt_pk_bf16_f32 v151, v210, v211
    v_mfma_f32_16x16x32_bf16 a[124:127], a[188:191], v[188:191], a[124:127]
    s_waitcnt lgkmcnt(3)
    buffer_load_dwordx4 v48, s[20:23], s49 offen offset:2048 lds
    v_mfma_f32_16x16x32_bf16 v[208:211], a[208:211], v[64:67], v[192:195]
    v_exp_f32 v212, v212
    v_mfma_f32_16x16x32_bf16 v[208:211], a[212:215], v[68:71], v[208:211]
    v_exp_f32 v213, v213
    v_mfma_f32_16x16x32_bf16 v[208:211], a[216:219], v[72:75], v[208:211]
    v_exp_f32 v214, v214
    v_mfma_f32_16x16x32_bf16 v[208:211], a[220:223], v[76:79], v[208:211]
    s_add_u32 s57, s58, 4718592
    v_exp_f32 v215, v215
    v_mfma_f32_16x16x32_bf16 a[0:3], a[160:163], v[128:131], a[0:3]
    ds_read_b64_tr_b16 a[172:173], v21 offset:40960
    v_cvt_pk_bf16_f32 v158, v212, v213
    v_mfma_f32_16x16x32_bf16 a[0:3], a[164:167], v[132:135], a[0:3]
    ds_read_b64_tr_b16 a[174:175], v21 offset:45056
    v_add_f32 v224, v224, v228
    v_mfma_f32_16x16x32_bf16 a[4:7], a[160:163], v[136:139], a[4:7]
    ds_read_b128 a[228:231], v9 offset:53248
    v_cvt_pk_bf16_f32 v159, v214, v215
    v_mfma_f32_16x16x32_bf16 a[4:7], a[164:167], v[140:143], a[4:7]
    buffer_load_dwordx4 a[240:243], v254, s[80:83], s57 offen
    v_mfma_f32_16x16x32_bf16 v[212:215], a[208:211], v[80:83], v[196:199]
    v_exp_f32 v208, v208
    v_mfma_f32_16x16x32_bf16 v[212:215], a[212:215], v[84:87], v[212:215]
    v_exp_f32 v209, v209
    v_mfma_f32_16x16x32_bf16 v[212:215], a[216:219], v[88:91], v[212:215]
    v_exp_f32 v210, v210
    v_mfma_f32_16x16x32_bf16 v[212:215], a[220:223], v[92:95], v[212:215]
    v_exp_f32 v211, v211
    v_mfma_f32_16x16x32_bf16 a[8:11], a[160:163], v[144:147], a[8:11]
    ds_read_b64_tr_b16 a[176:177], v22 offset:32768
    v_cvt_pk_bf16_f32 v160, v208, v209
    v_mfma_f32_16x16x32_bf16 a[8:11], a[164:167], v[148:151], a[8:11]
    ds_read_b64_tr_b16 a[178:179], v22 offset:36864
    v_add_f32 v225, v225, v229
    v_mfma_f32_16x16x32_bf16 a[12:15], a[160:163], v[152:155], a[12:15]
    ds_read_b128 a[232:235], v10 offset:53248
    v_cvt_pk_bf16_f32 v161, v210, v211
    v_mfma_f32_16x16x32_bf16 a[12:15], a[164:167], v[156:159], a[12:15]
    s_waitcnt lgkmcnt(3)
    buffer_load_dwordx4 v49, s[20:23], s49 offen offset:3072 lds
    v_mfma_f32_16x16x32_bf16 v[208:211], a[208:211], v[96:99], v[200:203]
    v_exp_f32 v212, v212
    v_mfma_f32_16x16x32_bf16 v[208:211], a[212:215], v[100:103], v[208:211]
    v_exp_f32 v213, v213
    v_mfma_f32_16x16x32_bf16 v[208:211], a[216:219], v[104:107], v[208:211]
    v_exp_f32 v214, v214
    v_mfma_f32_16x16x32_bf16 v[208:211], a[220:223], v[108:111], v[208:211]
    v_exp_f32 v215, v215
    v_mfma_f32_16x16x32_bf16 a[16:19], a[168:171], v[128:131], a[16:19]
    ds_read_b64_tr_b16 a[180:181], v22 offset:40960
    v_cvt_pk_bf16_f32 v168, v212, v213
    v_mfma_f32_16x16x32_bf16 a[16:19], a[172:175], v[132:135], a[16:19]
    ds_read_b64_tr_b16 a[182:183], v22 offset:45056
    v_add_f32 v226, v226, v230
    v_mfma_f32_16x16x32_bf16 a[20:23], a[168:171], v[136:139], a[20:23]
    ds_read_b128 a[236:239], v11 offset:53248
    v_cvt_pk_bf16_f32 v169, v214, v215
    v_mfma_f32_16x16x32_bf16 a[20:23], a[172:175], v[140:143], a[20:23]
    v_add_f32 v227, v227, v231
    v_add_f32 v224, v224, v226
    v_smfmac_f32_16x16x64_bf16 a[192:195], v[52:55], v[128:135], v50
    v_mfma_f32_16x16x32_bf16 v[212:215], a[208:211], v[112:115], v[204:207]
    v_exp_f32 v208, v208
    v_mfma_f32_16x16x32_bf16 v[212:215], a[212:215], v[116:119], v[212:215]
    s_add_u32 s49, s7, 0
    v_exp_f32 v209, v209
    v_mfma_f32_16x16x32_bf16 v[212:215], a[216:219], v[120:123], v[212:215]
    s_add_u32 m0, s42, 65536
    v_exp_f32 v210, v210
    v_mfma_f32_16x16x32_bf16 v[212:215], a[220:223], v[124:127], v[212:215]
    v_exp_f32 v211, v211
    v_mfma_f32_16x16x32_bf16 a[24:27], a[168:171], v[144:147], a[24:27]
    ds_read_b64_tr_b16 a[184:185], v23 offset:32768
    v_cvt_pk_bf16_f32 v176, v208, v209
    v_mfma_f32_16x16x32_bf16 a[24:27], a[172:175], v[148:151], a[24:27]
    ds_read_b64_tr_b16 a[186:187], v23 offset:36864
    v_add_f32 v225, v225, v227
    v_mfma_f32_16x16x32_bf16 a[28:31], a[168:171], v[152:155], a[28:31]
    ds_read_b128 a[208:211], v8 offset:57344
    v_cvt_pk_bf16_f32 v177, v210, v211
    v_mfma_f32_16x16x32_bf16 a[28:31], a[172:175], v[156:159], a[28:31]
    s_waitcnt lgkmcnt(3)
    buffer_load_dwordx4 v46, s[20:23], s49 offen lds
    v_mfma_f32_16x16x32_bf16 v[208:211], a[224:227], v[64:67], v[192:195]
    v_exp_f32 v212, v212
    v_mfma_f32_16x16x32_bf16 v[208:211], a[228:231], v[68:71], v[208:211]
    v_exp_f32 v213, v213
    v_mfma_f32_16x16x32_bf16 v[208:211], a[232:235], v[72:75], v[208:211]
    v_exp_f32 v214, v214
    v_mfma_f32_16x16x32_bf16 v[208:211], a[236:239], v[76:79], v[208:211]
    s_add_u32 s57, s58, 4128768
    v_exp_f32 v215, v215
    v_mfma_f32_16x16x32_bf16 a[32:35], a[176:179], v[128:131], a[32:35]
    ds_read_b64_tr_b16 a[188:189], v23 offset:40960
    v_cvt_pk_bf16_f32 v184, v212, v213
    v_mfma_f32_16x16x32_bf16 a[32:35], a[180:183], v[132:135], a[32:35]
    ds_read_b64_tr_b16 a[190:191], v23 offset:45056
    v_cvt_pk_bf16_f32 v246, v224, v225
    v_mfma_f32_16x16x32_bf16 a[36:39], a[176:179], v[136:139], a[36:39]
    ds_read_b128 a[212:215], v9 offset:57344
    v_cvt_pk_bf16_f32 v185, v214, v215
    v_mfma_f32_16x16x32_bf16 a[36:39], a[180:183], v[140:143], a[36:39]
    buffer_load_dwordx4 a[244:247], v254, s[32:35], s57 offen
    v_smfmac_f32_16x16x64_bf16 a[196:199], v[52:55], v[136:143], v50
    v_mfma_f32_16x16x32_bf16 v[212:215], a[224:227], v[80:83], v[196:199]
    v_exp_f32 v208, v208
    v_mfma_f32_16x16x32_bf16 v[212:215], a[228:231], v[84:87], v[212:215]
    v_exp_f32 v209, v209
    v_mfma_f32_16x16x32_bf16 v[212:215], a[232:235], v[88:91], v[212:215]
    v_exp_f32 v210, v210
    v_mfma_f32_16x16x32_bf16 v[212:215], a[236:239], v[92:95], v[212:215]
    v_exp_f32 v211, v211
    v_mfma_f32_16x16x32_bf16 a[40:43], a[176:179], v[144:147], a[40:43]
    ds_read_b64_tr_b16 a[160:161], v24 offset:32768
    v_cvt_pk_bf16_f32 v162, v208, v209
    v_mfma_f32_16x16x32_bf16 a[40:43], a[180:183], v[148:151], a[40:43]
    ds_read_b64_tr_b16 a[162:163], v24 offset:36864
    v_lshlrev_b32 v224, 16, v246
    v_mfma_f32_16x16x32_bf16 a[44:47], a[176:179], v[152:155], a[44:47]
    ds_read_b128 a[216:219], v10 offset:57344
    v_cvt_pk_bf16_f32 v163, v210, v211
    v_mfma_f32_16x16x32_bf16 a[44:47], a[180:183], v[156:159], a[44:47]
    s_waitcnt lgkmcnt(3)
    buffer_load_dwordx4 v47, s[20:23], s49 offen offset:1024 lds
    v_mfma_f32_16x16x32_bf16 v[208:211], a[224:227], v[96:99], v[200:203]
    v_exp_f32 v212, v212
    v_mfma_f32_16x16x32_bf16 v[208:211], a[228:231], v[100:103], v[208:211]
    v_exp_f32 v213, v213
    v_mfma_f32_16x16x32_bf16 v[208:211], a[232:235], v[104:107], v[208:211]
    v_exp_f32 v214, v214
    v_mfma_f32_16x16x32_bf16 v[208:211], a[236:239], v[108:111], v[208:211]
    v_exp_f32 v215, v215
    v_mfma_f32_16x16x32_bf16 a[48:51], a[184:187], v[128:131], a[48:51]
    ds_read_b64_tr_b16 a[164:165], v24 offset:40960
    v_cvt_pk_bf16_f32 v170, v212, v213
    v_mfma_f32_16x16x32_bf16 a[48:51], a[188:191], v[132:135], a[48:51]
    ds_read_b64_tr_b16 a[166:167], v24 offset:45056
    v_and_b32 v225, 0xffff0000, v246
    v_mfma_f32_16x16x32_bf16 a[52:55], a[184:187], v[136:139], a[52:55]
    ds_read_b128 a[220:223], v11 offset:57344
    v_cvt_pk_bf16_f32 v171, v214, v215
    v_mfma_f32_16x16x32_bf16 a[52:55], a[188:191], v[140:143], a[52:55]
    v_add_f32 v224, s36, v224
    v_add_f32 v225, s36, v225
    v_smfmac_f32_16x16x64_bf16 a[200:203], v[52:55], v[144:151], v50
    v_mfma_f32_16x16x32_bf16 v[212:215], a[224:227], v[112:115], v[204:207]
    v_exp_f32 v208, v208
    v_mfma_f32_16x16x32_bf16 v[212:215], a[228:231], v[116:119], v[212:215]
    v_exp_f32 v209, v209
    v_mfma_f32_16x16x32_bf16 v[212:215], a[232:235], v[120:123], v[212:215]
    v_exp_f32 v210, v210
    v_mfma_f32_16x16x32_bf16 v[212:215], a[236:239], v[124:127], v[212:215]
    v_exp_f32 v211, v211
    v_mfma_f32_16x16x32_bf16 a[56:59], a[184:187], v[144:147], a[56:59]
    ds_read_b64_tr_b16 a[168:169], v25 offset:32768
    v_cvt_pk_bf16_f32 v178, v208, v209
    v_mfma_f32_16x16x32_bf16 a[56:59], a[188:191], v[148:151], a[56:59]
    ds_read_b64_tr_b16 a[170:171], v25 offset:36864
    v_cvt_pk_bf16_f32 v246, v224, v225
    v_mfma_f32_16x16x32_bf16 a[60:63], a[184:187], v[152:155], a[60:63]
    ds_read_b128 a[224:227], v8 offset:61440
    v_cvt_pk_bf16_f32 v179, v210, v211
    v_mfma_f32_16x16x32_bf16 a[60:63], a[188:191], v[156:159], a[60:63]
    s_waitcnt lgkmcnt(3)
    buffer_load_dwordx4 v48, s[20:23], s49 offen offset:2048 lds
    v_mfma_f32_16x16x32_bf16 v[208:211], a[208:211], v[64:67], v[192:195]
    v_exp_f32 v212, v212
    v_mfma_f32_16x16x32_bf16 v[208:211], a[212:215], v[68:71], v[208:211]
    v_exp_f32 v213, v213
    v_mfma_f32_16x16x32_bf16 v[208:211], a[216:219], v[72:75], v[208:211]
    v_exp_f32 v214, v214
    v_mfma_f32_16x16x32_bf16 v[208:211], a[220:223], v[76:79], v[208:211]
    s_add_u32 s57, s58, 4718592
    v_exp_f32 v215, v215
    v_mfma_f32_16x16x32_bf16 a[64:67], a[160:163], v[128:131], a[64:67]
    ds_read_b64_tr_b16 a[172:173], v25 offset:40960
    v_cvt_pk_bf16_f32 v186, v212, v213
    v_mfma_f32_16x16x32_bf16 a[64:67], a[164:167], v[132:135], a[64:67]
    ds_read_b64_tr_b16 a[174:175], v25 offset:45056
    v_lshrrev_b32 v244, 1, v0
    v_mfma_f32_16x16x32_bf16 a[68:71], a[160:163], v[136:139], a[68:71]
    ds_read_b128 a[228:231], v9 offset:61440
    v_cvt_pk_bf16_f32 v187, v214, v215
    v_mfma_f32_16x16x32_bf16 a[68:71], a[164:167], v[140:143], a[68:71]
    buffer_load_dwordx4 a[248:251], v254, s[32:35], s57 offen
    v_smfmac_f32_16x16x64_bf16 a[204:207], v[52:55], v[152:159], v50
    v_mfma_f32_16x16x32_bf16 v[212:215], a[208:211], v[80:83], v[196:199]
    v_exp_f32 v208, v208
    v_mfma_f32_16x16x32_bf16 v[212:215], a[212:215], v[84:87], v[212:215]
    v_exp_f32 v209, v209
    v_mfma_f32_16x16x32_bf16 v[212:215], a[216:219], v[88:91], v[212:215]
    v_exp_f32 v210, v210
    v_mfma_f32_16x16x32_bf16 v[212:215], a[220:223], v[92:95], v[212:215]
    v_exp_f32 v211, v211
    v_mfma_f32_16x16x32_bf16 a[72:75], a[160:163], v[144:147], a[72:75]
    ds_read_b64_tr_b16 a[176:177], v26 offset:32768
    v_cvt_pk_bf16_f32 v164, v208, v209
    v_mfma_f32_16x16x32_bf16 a[72:75], a[164:167], v[148:151], a[72:75]
    ds_read_b64_tr_b16 a[178:179], v26 offset:36864
    v_lshlrev_b32 v244, 4, v244
    v_mfma_f32_16x16x32_bf16 a[76:79], a[160:163], v[152:155], a[76:79]
    ds_read_b128 a[232:235], v10 offset:61440
    v_cvt_pk_bf16_f32 v165, v210, v211
    v_mfma_f32_16x16x32_bf16 a[76:79], a[164:167], v[156:159], a[76:79]
    s_waitcnt lgkmcnt(3)
    buffer_load_dwordx4 v49, s[20:23], s49 offen offset:3072 lds
    v_mfma_f32_16x16x32_bf16 v[208:211], a[208:211], v[96:99], v[200:203]
    v_exp_f32 v212, v212
    v_mfma_f32_16x16x32_bf16 v[208:211], a[212:215], v[100:103], v[208:211]
    v_exp_f32 v213, v213
    v_mfma_f32_16x16x32_bf16 v[208:211], a[216:219], v[104:107], v[208:211]
    v_exp_f32 v214, v214
    v_mfma_f32_16x16x32_bf16 v[208:211], a[220:223], v[108:111], v[208:211]
    v_exp_f32 v215, v215
    v_mfma_f32_16x16x32_bf16 a[80:83], a[168:171], v[128:131], a[80:83]
    ds_read_b64_tr_b16 a[180:181], v26 offset:40960
    v_cvt_pk_bf16_f32 v172, v212, v213
    v_mfma_f32_16x16x32_bf16 a[80:83], a[172:175], v[132:135], a[80:83]
    ds_read_b64_tr_b16 a[182:183], v26 offset:45056
    v_and_b32 v245, 1, v0
    v_mfma_f32_16x16x32_bf16 a[84:87], a[168:171], v[136:139], a[84:87]
    ds_read_b128 a[236:239], v11 offset:61440
    v_cvt_pk_bf16_f32 v173, v214, v215
    v_mfma_f32_16x16x32_bf16 a[84:87], a[172:175], v[140:143], a[84:87]
    s_waitcnt vmcnt(12)
    s_barrier
    v_mfma_f32_16x16x32_bf16 v[212:215], a[208:211], v[112:115], v[204:207]
    v_exp_f32 v208, v208
    v_mfma_f32_16x16x32_bf16 v[212:215], a[212:215], v[116:119], v[212:215]
    s_add_u32 s49, s7, 73728
    v_exp_f32 v209, v209
    v_mfma_f32_16x16x32_bf16 v[212:215], a[216:219], v[120:123], v[212:215]
    s_add_u32 m0, s42, 81920
    v_exp_f32 v210, v210
Ltour7:
    s_cbranch_execz Ltour11
    v_mfma_f32_16x16x32_bf16 v[212:215], a[220:223], v[124:127], v[212:215]
    v_exp_f32 v211, v211
    v_mfma_f32_16x16x32_bf16 a[88:91], a[168:171], v[144:147], a[88:91]
    ds_read_b64_tr_b16 a[184:185], v27 offset:32768
    v_cvt_pk_bf16_f32 v180, v208, v209
    v_mfma_f32_16x16x32_bf16 a[88:91], a[172:175], v[148:151], a[88:91]
    ds_read_b64_tr_b16 a[186:187], v27 offset:36864
    v_lshl_add_u32 v244, v245, 2, v244
    v_mfma_f32_16x16x32_bf16 a[92:95], a[168:171], v[152:155], a[92:95]
    v_cvt_pk_bf16_f32 v181, v210, v211
    v_mfma_f32_16x16x32_bf16 a[92:95], a[172:175], v[156:159], a[92:95]
    s_waitcnt lgkmcnt(3)
    buffer_load_dwordx4 v46, s[20:23], s49 offen lds
    v_mfma_f32_16x16x32_bf16 v[208:211], a[224:227], v[64:67], v[192:195]
    v_exp_f32 v212, v212
    v_mfma_f32_16x16x32_bf16 v[208:211], a[228:231], v[68:71], v[208:211]
    v_exp_f32 v213, v213
    v_mfma_f32_16x16x32_bf16 v[208:211], a[232:235], v[72:75], v[208:211]
    s_waitcnt lgkmcnt(2)
    v_exp_f32 v214, v214
    v_mfma_f32_16x16x32_bf16 v[208:211], a[236:239], v[76:79], v[208:211]
    s_add_u32 s37, s55, 8192
    v_exp_f32 v215, v215
    v_mfma_f32_16x16x32_bf16 a[96:99], a[176:179], v[128:131], a[96:99]
    ds_read_b64_tr_b16 a[188:189], v27 offset:40960
    v_cvt_pk_bf16_f32 v188, v212, v213
    v_mfma_f32_16x16x32_bf16 a[96:99], a[180:183], v[132:135], a[96:99]
    ds_read_b64_tr_b16 a[190:191], v27 offset:45056
    v_lshrrev_b32 v245, 3, v0
    v_mfma_f32_16x16x32_bf16 a[100:103], a[176:179], v[136:139], a[100:103]
    v_cvt_pk_bf16_f32 v189, v214, v215
    v_mfma_f32_16x16x32_bf16 a[100:103], a[180:183], v[140:143], a[100:103]
    buffer_load_dword v239, v238, s[28:31], s37 offen
    v_mfma_f32_16x16x32_bf16 v[212:215], a[224:227], v[80:83], v[196:199]
    v_exp_f32 v208, v208
    v_mfma_f32_16x16x32_bf16 v[212:215], a[228:231], v[84:87], v[212:215]
    v_exp_f32 v209, v209
    v_mfma_f32_16x16x32_bf16 v[212:215], a[232:235], v[88:91], v[212:215]
    v_exp_f32 v210, v210
    v_mfma_f32_16x16x32_bf16 v[212:215], a[236:239], v[92:95], v[212:215]
    v_exp_f32 v211, v211
    v_mfma_f32_16x16x32_bf16 a[104:107], a[176:179], v[144:147], a[104:107]
    ds_read_b64_tr_b16 a[160:161], v20 offset:49152
    v_cvt_pk_bf16_f32 v166, v208, v209
    v_mfma_f32_16x16x32_bf16 a[104:107], a[180:183], v[148:151], a[104:107]
    ds_read_b64_tr_b16 a[162:163], v20 offset:53248
    v_min_u32 v245, 1, v245
    v_mfma_f32_16x16x32_bf16 a[108:111], a[176:179], v[152:155], a[108:111]
    v_cvt_pk_bf16_f32 v167, v210, v211
    v_mfma_f32_16x16x32_bf16 a[108:111], a[180:183], v[156:159], a[108:111]
    s_waitcnt lgkmcnt(3)
    buffer_load_dwordx4 v47, s[20:23], s49 offen offset:1024 lds
    v_mfma_f32_16x16x32_bf16 v[208:211], a[224:227], v[96:99], v[200:203]
    v_exp_f32 v212, v212
    v_mfma_f32_16x16x32_bf16 v[208:211], a[228:231], v[100:103], v[208:211]
    v_exp_f32 v213, v213
    v_mfma_f32_16x16x32_bf16 v[208:211], a[232:235], v[104:107], v[208:211]
    v_exp_f32 v214, v214
    v_mfma_f32_16x16x32_bf16 v[208:211], a[236:239], v[108:111], v[208:211]
    s_add_u32 s57, s59, 0
    v_exp_f32 v215, v215
    v_mfma_f32_16x16x32_bf16 a[112:115], a[184:187], v[128:131], a[112:115]
    s_waitcnt lgkmcnt(2)
    ds_read_b64_tr_b16 a[164:165], v20 offset:57344
    v_cvt_pk_bf16_f32 v174, v212, v213
    v_mfma_f32_16x16x32_bf16 a[112:115], a[188:191], v[132:135], a[112:115]
    ds_read_b64_tr_b16 a[166:167], v20 offset:61440
    v_lshl_or_b32 v244, v245, 31, v244
    v_mfma_f32_16x16x32_bf16 a[116:119], a[184:187], v[136:139], a[116:119]
    v_cvt_pk_bf16_f32 v175, v214, v215
    v_mfma_f32_16x16x32_bf16 a[116:119], a[188:191], v[140:143], a[116:119]
    buffer_load_dwordx4 a[252:255], v255, s[84:87], s57 offen
    v_mfma_f32_16x16x32_bf16 v[212:215], a[224:227], v[112:115], v[204:207]
    v_exp_f32 v208, v208
    v_mfma_f32_16x16x32_bf16 v[212:215], a[228:231], v[116:119], v[212:215]
    v_exp_f32 v209, v209
    v_mfma_f32_16x16x32_bf16 v[212:215], a[232:235], v[120:123], v[212:215]
    v_exp_f32 v210, v210
    v_mfma_f32_16x16x32_bf16 v[212:215], a[236:239], v[124:127], v[212:215]
    v_exp_f32 v211, v211
    v_mfma_f32_16x16x32_bf16 a[120:123], a[184:187], v[144:147], a[120:123]
    ds_read_b64_tr_b16 a[168:169], v21 offset:49152
    v_cvt_pk_bf16_f32 v182, v208, v209
    v_mfma_f32_16x16x32_bf16 a[120:123], a[188:191], v[148:151], a[120:123]
    ds_read_b64_tr_b16 a[170:171], v21 offset:53248
    v_mfma_f32_16x16x32_bf16 a[124:127], a[184:187], v[152:155], a[124:127]
    v_cvt_pk_bf16_f32 v183, v210, v211
    v_mfma_f32_16x16x32_bf16 a[124:127], a[188:191], v[156:159], a[124:127]
    s_waitcnt lgkmcnt(3)
    buffer_load_dwordx4 v48, s[20:23], s49 offen offset:2048 lds
    v_exp_f32 v212, v212
    v_exp_f32 v213, v213
    v_exp_f32 v214, v214
    v_exp_f32 v215, v215
    v_mfma_f32_16x16x32_bf16 a[0:3], a[160:163], v[160:163], a[0:3]
    s_waitcnt lgkmcnt(2)
    ds_read_b64_tr_b16 a[172:173], v21 offset:57344
    v_cvt_pk_bf16_f32 v190, v212, v213
    v_mfma_f32_16x16x32_bf16 a[0:3], a[164:167], v[164:167], a[0:3]
    ds_read_b64_tr_b16 a[174:175], v21 offset:61440
    v_mfma_f32_16x16x32_bf16 a[4:7], a[160:163], v[168:171], a[4:7]
    v_cvt_pk_bf16_f32 v191, v214, v215
    v_mfma_f32_16x16x32_bf16 a[4:7], a[164:167], v[172:175], a[4:7]
    buffer_store_dword v246, v244, s[24:27], s39 offen sc1
    v_mfma_f32_16x16x32_bf16 a[8:11], a[160:163], v[176:179], a[8:11]
    ds_read_b64_tr_b16 a[176:177], v22 offset:49152
    v_mfma_f32_16x16x32_bf16 a[8:11], a[164:167], v[180:183], a[8:11]
    ds_read_b64_tr_b16 a[178:179], v22 offset:53248
    v_mfma_f32_16x16x32_bf16 a[12:15], a[160:163], v[184:187], a[12:15]
    v_mfma_f32_16x16x32_bf16 a[12:15], a[164:167], v[188:191], a[12:15]
    buffer_load_dwordx4 v49, s[20:23], s49 offen offset:3072 lds
    v_smfmac_f32_16x16x64_bf16 a[192:195], v[52:55], v[160:167], v50
    s_waitcnt lgkmcnt(4)
    v_mfma_f32_16x16x32_bf16 a[16:19], a[168:171], v[160:163], a[16:19]
    s_waitcnt lgkmcnt(2)
    ds_read_b64_tr_b16 a[180:181], v22 offset:57344
    v_mfma_f32_16x16x32_bf16 a[16:19], a[172:175], v[164:167], a[16:19]
    ds_read_b64_tr_b16 a[182:183], v22 offset:61440
    v_mfma_f32_16x16x32_bf16 a[20:23], a[168:171], v[168:171], a[20:23]
    v_min_u32 v240, 1, v0
    v_mfma_f32_16x16x32_bf16 a[20:23], a[172:175], v[172:175], a[20:23]
    v_smfmac_f32_16x16x64_bf16 a[196:199], v[52:55], v[168:175], v50
    s_add_u32 s49, s7, 256
    s_add_u32 m0, s42, 32768
    v_mfma_f32_16x16x32_bf16 a[24:27], a[168:171], v[176:179], a[24:27]
    ds_read_b64_tr_b16 a[184:185], v23 offset:49152
    v_mfma_f32_16x16x32_bf16 a[24:27], a[172:175], v[180:183], a[24:27]
    ds_read_b64_tr_b16 a[186:187], v23 offset:53248
    v_mfma_f32_16x16x32_bf16 a[28:31], a[168:171], v[184:187], a[28:31]
    v_lshlrev_b32 v240, 31, v240
    v_mfma_f32_16x16x32_bf16 a[28:31], a[172:175], v[188:191], a[28:31]
    buffer_load_dwordx4 v46, s[20:23], s49 offen lds
    v_smfmac_f32_16x16x64_bf16 a[200:203], v[52:55], v[176:183], v50
    s_waitcnt lgkmcnt(4)
    v_mfma_f32_16x16x32_bf16 a[32:35], a[176:179], v[160:163], a[32:35]
    s_waitcnt lgkmcnt(2)
    ds_read_b64_tr_b16 a[188:189], v23 offset:57344
    v_mfma_f32_16x16x32_bf16 a[32:35], a[180:183], v[164:167], a[32:35]
    ds_read_b64_tr_b16 a[190:191], v23 offset:61440
    v_mfma_f32_16x16x32_bf16 a[36:39], a[176:179], v[168:171], a[36:39]
    v_mov_b32 v241, 1
    v_mfma_f32_16x16x32_bf16 a[36:39], a[180:183], v[172:175], a[36:39]
    v_smfmac_f32_16x16x64_bf16 a[204:207], v[52:55], v[184:191], v50
    v_mfma_f32_16x16x32_bf16 a[40:43], a[176:179], v[176:179], a[40:43]
    ds_read_b64_tr_b16 a[160:161], v24 offset:49152
    v_mfma_f32_16x16x32_bf16 a[40:43], a[180:183], v[180:183], a[40:43]
    ds_read_b64_tr_b16 a[162:163], v24 offset:53248
    v_mfma_f32_16x16x32_bf16 a[44:47], a[176:179], v[184:187], a[44:47]
    v_mfma_f32_16x16x32_bf16 a[44:47], a[180:183], v[188:191], a[44:47]
    s_waitcnt lgkmcnt(4)
    buffer_load_dwordx4 v47, s[20:23], s49 offen offset:1024 lds
    v_mfma_f32_16x16x32_bf16 a[48:51], a[184:187], v[160:163], a[48:51]
    s_waitcnt lgkmcnt(2)
    ds_read_b64_tr_b16 a[164:165], v24 offset:57344
    v_accvgpr_read_b32 v216, a192
    v_mfma_f32_16x16x32_bf16 a[48:51], a[188:191], v[164:167], a[48:51]
    ds_read_b64_tr_b16 a[166:167], v24 offset:61440
    v_accvgpr_read_b32 v217, a193
    v_mfma_f32_16x16x32_bf16 a[52:55], a[184:187], v[168:171], a[52:55]
    v_accvgpr_read_b32 v218, a196
    v_accvgpr_read_b32 v219, a197
    v_mfma_f32_16x16x32_bf16 a[52:55], a[188:191], v[172:175], a[52:55]
    v_accvgpr_read_b32 v220, a200
    v_accvgpr_read_b32 v221, a201
    v_mfma_f32_16x16x32_bf16 a[56:59], a[184:187], v[176:179], a[56:59]
    ds_read_b64_tr_b16 a[168:169], v25 offset:49152
    v_accvgpr_read_b32 v222, a204
    v_mfma_f32_16x16x32_bf16 a[56:59], a[188:191], v[180:183], a[56:59]
    ds_read_b64_tr_b16 a[170:171], v25 offset:53248
    v_accvgpr_read_b32 v223, a205
    v_mfma_f32_16x16x32_bf16 a[60:63], a[184:187], v[184:187], a[60:63]
    v_add_f32 v58, v216, v217
    v_add_f32 v59, v218, v219
    v_mfma_f32_16x16x32_bf16 a[60:63], a[188:191], v[188:191], a[60:63]
    s_waitcnt lgkmcnt(4)
    buffer_load_dwordx4 v48, s[20:23], s49 offen offset:2048 lds
    v_add_f32 v60, v220, v221
    v_add_f32 v61, v222, v223
    v_mfma_f32_16x16x32_bf16 a[64:67], a[160:163], v[160:163], a[64:67]
    s_waitcnt lgkmcnt(2)
    ds_read_b64_tr_b16 a[172:173], v25 offset:57344
    v_add_f32 v216, v58, v59
    v_mfma_f32_16x16x32_bf16 a[64:67], a[164:167], v[164:167], a[64:67]
    ds_read_b64_tr_b16 a[174:175], v25 offset:61440
    v_add_f32 v217, v60, v61
    v_mfma_f32_16x16x32_bf16 a[68:71], a[160:163], v[168:171], a[68:71]
    v_add_f32 v216, v216, v217
    v_cmp_ngt_f32 vcc, 1669332992, v216
    v_mfma_f32_16x16x32_bf16 a[68:71], a[164:167], v[172:175], a[68:71]
    v_rcp_f32 v58, v58
    v_rcp_f32 v59, v59
    v_mfma_f32_16x16x32_bf16 a[72:75], a[160:163], v[176:179], a[72:75]
    ds_read_b64_tr_b16 a[176:177], v26 offset:49152
    v_rcp_f32 v60, v60
    v_mfma_f32_16x16x32_bf16 a[72:75], a[164:167], v[180:183], a[72:75]
    ds_read_b64_tr_b16 a[178:179], v26 offset:53248
    v_rcp_f32 v61, v61
    v_mfma_f32_16x16x32_bf16 a[76:79], a[160:163], v[184:187], a[76:79]
    v_mov_b32 v228, 131072
    s_or_b32 s36, vcc_lo, vcc_hi
    v_mfma_f32_16x16x32_bf16 a[76:79], a[164:167], v[188:191], a[76:79]
    s_waitcnt lgkmcnt(4)
    buffer_load_dwordx4 v49, s[20:23], s49 offen offset:3072 lds
    v_mov_b32 v218, s36
    s_lshl_b32 s37, s3, 2
    v_mfma_f32_16x16x32_bf16 a[80:83], a[168:171], v[160:163], a[80:83]
    s_waitcnt lgkmcnt(2)
    ds_read_b64_tr_b16 a[180:181], v26 offset:57344
    v_add_u32 v219, s37, v228
    ds_write_b32 v219, v218
    v_mfma_f32_16x16x32_bf16 a[80:83], a[172:175], v[164:167], a[80:83]
    ds_read_b64_tr_b16 a[182:183], v26 offset:61440
    v_mfma_f32_16x16x32_bf16 a[84:87], a[168:171], v[168:171], a[84:87]
    v_mfma_f32_16x16x32_bf16 a[84:87], a[172:175], v[172:175], a[84:87]
    s_waitcnt lgkmcnt(1)
    s_waitcnt vmcnt(17)
    s_barrier
    v_mfma_f32_16x16x32_bf16 a[88:91], a[168:171], v[176:179], a[88:91]
    ds_read_b64_tr_b16 a[184:185], v27 offset:49152
    v_mfma_f32_16x16x32_bf16 a[88:91], a[172:175], v[180:183], a[88:91]
    ds_read_b64_tr_b16 a[186:187], v27 offset:53248
    v_mfma_f32_16x16x32_bf16 a[92:95], a[168:171], v[184:187], a[92:95]
    ds_read_b128 v[224:227], v228
    v_mfma_f32_16x16x32_bf16 a[92:95], a[172:175], v[188:191], a[92:95]
    s_add_u32 s49, s7, 73984
    v_mfma_f32_16x16x32_bf16 a[96:99], a[176:179], v[160:163], a[96:99]
    s_waitcnt lgkmcnt(3)
    s_add_u32 m0, s42, 49152
    ds_read_b64_tr_b16 a[188:189], v27 offset:57344
    v_mfma_f32_16x16x32_bf16 a[96:99], a[180:183], v[164:167], a[96:99]
    buffer_load_dwordx4 v46, s[20:23], s49 offen lds
    v_mfma_f32_16x16x32_bf16 a[100:103], a[176:179], v[168:171], a[100:103]
    ds_read_b64_tr_b16 a[190:191], v27 offset:61440
    v_mfma_f32_16x16x32_bf16 a[100:103], a[180:183], v[172:175], a[100:103]
    buffer_load_dwordx4 v47, s[20:23], s49 offen offset:1024 lds
    v_mfma_f32_16x16x32_bf16 a[104:107], a[176:179], v[176:179], a[104:107]
    v_mfma_f32_16x16x32_bf16 a[104:107], a[180:183], v[180:183], a[104:107]
    buffer_load_dwordx4 v48, s[20:23], s49 offen offset:2048 lds
    v_mfma_f32_16x16x32_bf16 a[108:111], a[176:179], v[184:187], a[108:111]
    v_mfma_f32_16x16x32_bf16 a[108:111], a[180:183], v[188:191], a[108:111]
    s_waitcnt lgkmcnt(3)
    buffer_load_dwordx4 v49, s[20:23], s49 offen offset:3072 lds
    s_add_u32 s49, s46, 0
    v_mfma_f32_16x16x32_bf16 a[112:115], a[184:187], v[160:163], a[112:115]
    s_waitcnt lgkmcnt(0)
    s_add_u32 m0, s42, 98304
    v_mfma_f32_16x16x32_bf16 a[112:115], a[188:191], v[164:167], a[112:115]
    buffer_load_dwordx4 v46, s[20:23], s49 offen lds
    v_mfma_f32_16x16x32_bf16 a[116:119], a[184:187], v[168:171], a[116:119]
    v_mfma_f32_16x16x32_bf16 a[116:119], a[188:191], v[172:175], a[116:119]
    buffer_load_dwordx4 v47, s[20:23], s49 offen offset:1024 lds
    v_mfma_f32_16x16x32_bf16 a[120:123], a[184:187], v[176:179], a[120:123]
    v_mfma_f32_16x16x32_bf16 a[120:123], a[188:191], v[180:183], a[120:123]
    buffer_load_dwordx4 v48, s[20:23], s49 offen offset:2048 lds
    v_mfma_f32_16x16x32_bf16 a[124:127], a[184:187], v[184:187], a[124:127]
    v_mfma_f32_16x16x32_bf16 a[124:127], a[188:191], v[188:191], a[124:127]
    buffer_load_dwordx4 v49, s[20:23], s49 offen offset:3072 lds
    v_or3_b32 v224, v224, v225, v226
    v_or_b32 v224, v224, v227
    s_nop 0
    v_readfirstlane_b32 s36, v224
    v_readfirstlane_b32 s38, v253
    v_min_u32 v8, 1, v1
    v_lshlrev_b32 v8, 31, v8
    v_mov_b32 v10, s95
    s_getreg_b32 s39, hwreg(HW_REG_XCC_ID, 0, 4)
    s_add_u32 s39, s39, s95
    s_cmp_eq_u32 s38, s39
    s_cselect_b32 s53, 1, 0
    ds_read_b64_tr_b16 a[208:209], v12 offset:0
    ds_read_b64_tr_b16 a[210:211], v12 offset:4096
    ds_read_b64_tr_b16 a[212:213], v12 offset:8192
    ds_read_b64_tr_b16 a[214:215], v12 offset:12288
    ds_read_b64_tr_b16 a[216:217], v12 offset:16384
    ds_read_b64_tr_b16 a[218:219], v12 offset:20480
    ds_read_b64_tr_b16 a[220:221], v12 offset:24576
    ds_read_b64_tr_b16 a[222:223], v12 offset:28672
    ds_read_b64_tr_b16 a[224:225], v16 offset:0
    ds_read_b64_tr_b16 a[226:227], v16 offset:4096
    ds_read_b64_tr_b16 a[228:229], v16 offset:8192
    ds_read_b64_tr_b16 a[230:231], v16 offset:12288
    ds_read_b64_tr_b16 a[232:233], v16 offset:16384
    ds_read_b64_tr_b16 a[234:235], v16 offset:20480
    ds_read_b64_tr_b16 a[236:237], v16 offset:24576
    ds_read_b64_tr_b16 a[238:239], v16 offset:28672
    s_waitcnt vmcnt(13)
    buffer_atomic_add v241, v240, s[88:91], s43 offen sc1
    s_andn2_b32 s36, s36, s48
    s_cbranch_scc1 Lattn_redo
    v_accvgpr_read_b32 v216, a0
    v_accvgpr_read_b32 v217, a1
    v_accvgpr_read_b32 v218, a2
    v_accvgpr_read_b32 v219, a3
    v_pk_mul_f32 v[216:217], v[216:217], v[58:59] op_sel:[0,0] op_sel_hi:[1,0]
    v_pk_mul_f32 v[218:219], v[218:219], v[58:59] op_sel:[0,0] op_sel_hi:[1,0]
    v_cvt_pk_bf16_f32 v128, v216, v217
    v_cvt_pk_bf16_f32 v129, v218, v219
    v_accvgpr_read_b32 v220, a4
    v_accvgpr_read_b32 v221, a5
    v_accvgpr_read_b32 v222, a6
    v_accvgpr_read_b32 v223, a7
    v_pk_mul_f32 v[220:221], v[220:221], v[58:59] op_sel:[0,1] op_sel_hi:[1,1]
    v_pk_mul_f32 v[222:223], v[222:223], v[58:59] op_sel:[0,1] op_sel_hi:[1,1]
    v_cvt_pk_bf16_f32 v160, v220, v221
    v_cvt_pk_bf16_f32 v161, v222, v223
    v_accvgpr_read_b32 v224, a8
    v_accvgpr_read_b32 v225, a9
    v_accvgpr_read_b32 v226, a10
    v_accvgpr_read_b32 v227, a11
    v_pk_mul_f32 v[224:225], v[224:225], v[60:61] op_sel:[0,0] op_sel_hi:[1,0]
    v_pk_mul_f32 v[226:227], v[226:227], v[60:61] op_sel:[0,0] op_sel_hi:[1,0]
    v_cvt_pk_bf16_f32 v144, v224, v225
    v_cvt_pk_bf16_f32 v145, v226, v227
    v_accvgpr_read_b32 v228, a12
    v_accvgpr_read_b32 v229, a13
    v_accvgpr_read_b32 v230, a14
    v_accvgpr_read_b32 v231, a15
    v_pk_mul_f32 v[228:229], v[228:229], v[60:61] op_sel:[0,1] op_sel_hi:[1,1]
    v_pk_mul_f32 v[230:231], v[230:231], v[60:61] op_sel:[0,1] op_sel_hi:[1,1]
    v_cvt_pk_bf16_f32 v176, v228, v229
    v_cvt_pk_bf16_f32 v177, v230, v231
    v_accvgpr_read_b32 v216, a16
    v_accvgpr_read_b32 v217, a17
    v_accvgpr_read_b32 v218, a18
    v_accvgpr_read_b32 v219, a19
    v_pk_mul_f32 v[216:217], v[216:217], v[58:59] op_sel:[0,0] op_sel_hi:[1,0]
    v_pk_mul_f32 v[218:219], v[218:219], v[58:59] op_sel:[0,0] op_sel_hi:[1,0]
    v_cvt_pk_bf16_f32 v130, v216, v217
    v_cvt_pk_bf16_f32 v131, v218, v219
    s_add_u32 s37, s55, 0
    buffer_store_dwordx4 v[128:131], v252, s[28:31], s37 offen offset:0
    v_accvgpr_read_b32 v220, a20
    v_accvgpr_read_b32 v221, a21
    v_accvgpr_read_b32 v222, a22
    v_accvgpr_read_b32 v223, a23
    v_pk_mul_f32 v[220:221], v[220:221], v[58:59] op_sel:[0,1] op_sel_hi:[1,1]
    v_pk_mul_f32 v[222:223], v[222:223], v[58:59] op_sel:[0,1] op_sel_hi:[1,1]
    v_cvt_pk_bf16_f32 v162, v220, v221
    v_cvt_pk_bf16_f32 v163, v222, v223
    s_add_u32 s37, s55, 8192
    buffer_store_dwordx4 v[160:163], v252, s[28:31], s37 offen offset:0
    v_accvgpr_read_b32 v224, a24
    v_accvgpr_read_b32 v225, a25
    v_accvgpr_read_b32 v226, a26
    v_accvgpr_read_b32 v227, a27
    v_pk_mul_f32 v[224:225], v[224:225], v[60:61] op_sel:[0,0] op_sel_hi:[1,0]
    v_pk_mul_f32 v[226:227], v[226:227], v[60:61] op_sel:[0,0] op_sel_hi:[1,0]
    v_cvt_pk_bf16_f32 v146, v224, v225
    v_cvt_pk_bf16_f32 v147, v226, v227
    s_add_u32 s37, s55, 4096
    buffer_store_dwordx4 v[144:147], v252, s[28:31], s37 offen offset:0
    v_accvgpr_read_b32 v228, a28
    v_accvgpr_read_b32 v229, a29
    v_accvgpr_read_b32 v230, a30
    v_accvgpr_read_b32 v231, a31
    v_pk_mul_f32 v[228:229], v[228:229], v[60:61] op_sel:[0,1] op_sel_hi:[1,1]
    v_pk_mul_f32 v[230:231], v[230:231], v[60:61] op_sel:[0,1] op_sel_hi:[1,1]
    v_cvt_pk_bf16_f32 v178, v228, v229
    v_cvt_pk_bf16_f32 v179, v230, v231
    s_add_u32 s37, s55, 12288
    buffer_store_dwordx4 v[176:179], v252, s[28:31], s37 offen offset:0
    v_accvgpr_read_b32 v216, a32
    v_accvgpr_read_b32 v217, a33
    v_accvgpr_read_b32 v218, a34
    v_accvgpr_read_b32 v219, a35
    v_pk_mul_f32 v[216:217], v[216:217], v[58:59] op_sel:[0,0] op_sel_hi:[1,0]
    v_pk_mul_f32 v[218:219], v[218:219], v[58:59] op_sel:[0,0] op_sel_hi:[1,0]
    v_cvt_pk_bf16_f32 v132, v216, v217
    v_cvt_pk_bf16_f32 v133, v218, v219
    v_accvgpr_read_b32 v220, a36
    v_accvgpr_read_b32 v221, a37
    v_accvgpr_read_b32 v222, a38
    v_accvgpr_read_b32 v223, a39
    v_pk_mul_f32 v[220:221], v[220:221], v[58:59] op_sel:[0,1] op_sel_hi:[1,1]
    v_pk_mul_f32 v[222:223], v[222:223], v[58:59] op_sel:[0,1] op_sel_hi:[1,1]
    v_cvt_pk_bf16_f32 v164, v220, v221
    v_cvt_pk_bf16_f32 v165, v222, v223
    v_accvgpr_read_b32 v224, a40
    v_accvgpr_read_b32 v225, a41
    v_accvgpr_read_b32 v226, a42
    v_accvgpr_read_b32 v227, a43
    v_pk_mul_f32 v[224:225], v[224:225], v[60:61] op_sel:[0,0] op_sel_hi:[1,0]
    v_pk_mul_f32 v[226:227], v[226:227], v[60:61] op_sel:[0,0] op_sel_hi:[1,0]
    v_cvt_pk_bf16_f32 v148, v224, v225
    v_cvt_pk_bf16_f32 v149, v226, v227
    v_accvgpr_read_b32 v228, a44
    v_accvgpr_read_b32 v229, a45
    v_accvgpr_read_b32 v230, a46
    v_accvgpr_read_b32 v231, a47
    v_pk_mul_f32 v[228:229], v[228:229], v[60:61] op_sel:[0,1] op_sel_hi:[1,1]
    v_pk_mul_f32 v[230:231], v[230:231], v[60:61] op_sel:[0,1] op_sel_hi:[1,1]
    v_cvt_pk_bf16_f32 v180, v228, v229
    v_cvt_pk_bf16_f32 v181, v230, v231
    v_accvgpr_read_b32 v216, a48
    v_accvgpr_read_b32 v217, a49
    v_accvgpr_read_b32 v218, a50
    v_accvgpr_read_b32 v219, a51
    v_pk_mul_f32 v[216:217], v[216:217], v[58:59] op_sel:[0,0] op_sel_hi:[1,0]
    v_pk_mul_f32 v[218:219], v[218:219], v[58:59] op_sel:[0,0] op_sel_hi:[1,0]
    v_cvt_pk_bf16_f32 v134, v216, v217
    v_cvt_pk_bf16_f32 v135, v218, v219
    s_add_u32 s37, s55, 0
    buffer_store_dwordx4 v[132:135], v252, s[28:31], s37 offen offset:1024
    v_accvgpr_read_b32 v220, a52
    v_accvgpr_read_b32 v221, a53
    v_accvgpr_read_b32 v222, a54
    v_accvgpr_read_b32 v223, a55
    v_pk_mul_f32 v[220:221], v[220:221], v[58:59] op_sel:[0,1] op_sel_hi:[1,1]
    v_pk_mul_f32 v[222:223], v[222:223], v[58:59] op_sel:[0,1] op_sel_hi:[1,1]
    v_cvt_pk_bf16_f32 v166, v220, v221
    v_cvt_pk_bf16_f32 v167, v222, v223
    s_add_u32 s37, s55, 8192
    buffer_store_dwordx4 v[164:167], v252, s[28:31], s37 offen offset:1024
    v_accvgpr_read_b32 v224, a56
    v_accvgpr_read_b32 v225, a57
    v_accvgpr_read_b32 v226, a58
    v_accvgpr_read_b32 v227, a59
    v_pk_mul_f32 v[224:225], v[224:225], v[60:61] op_sel:[0,0] op_sel_hi:[1,0]
    v_pk_mul_f32 v[226:227], v[226:227], v[60:61] op_sel:[0,0] op_sel_hi:[1,0]
    v_cvt_pk_bf16_f32 v150, v224, v225
    v_cvt_pk_bf16_f32 v151, v226, v227
    s_add_u32 s37, s55, 4096
    buffer_store_dwordx4 v[148:151], v252, s[28:31], s37 offen offset:1024
    v_accvgpr_read_b32 v228, a60
    v_accvgpr_read_b32 v229, a61
    v_accvgpr_read_b32 v230, a62
    v_accvgpr_read_b32 v231, a63
    v_pk_mul_f32 v[228:229], v[228:229], v[60:61] op_sel:[0,1] op_sel_hi:[1,1]
    v_pk_mul_f32 v[230:231], v[230:231], v[60:61] op_sel:[0,1] op_sel_hi:[1,1]
    v_cvt_pk_bf16_f32 v182, v228, v229
    v_cvt_pk_bf16_f32 v183, v230, v231
    s_add_u32 s37, s55, 12288
    buffer_store_dwordx4 v[180:183], v252, s[28:31], s37 offen offset:1024
    v_accvgpr_read_b32 v216, a64
    v_accvgpr_read_b32 v217, a65
    v_accvgpr_read_b32 v218, a66
    v_accvgpr_read_b32 v219, a67
    v_pk_mul_f32 v[216:217], v[216:217], v[58:59] op_sel:[0,0] op_sel_hi:[1,0]
    v_pk_mul_f32 v[218:219], v[218:219], v[58:59] op_sel:[0,0] op_sel_hi:[1,0]
    v_cvt_pk_bf16_f32 v136, v216, v217
    v_cvt_pk_bf16_f32 v137, v218, v219
    v_accvgpr_read_b32 v220, a68
    v_accvgpr_read_b32 v221, a69
    v_accvgpr_read_b32 v222, a70
    v_accvgpr_read_b32 v223, a71
    v_pk_mul_f32 v[220:221], v[220:221], v[58:59] op_sel:[0,1] op_sel_hi:[1,1]
    v_pk_mul_f32 v[222:223], v[222:223], v[58:59] op_sel:[0,1] op_sel_hi:[1,1]
    v_cvt_pk_bf16_f32 v168, v220, v221
    v_cvt_pk_bf16_f32 v169, v222, v223
    v_accvgpr_read_b32 v224, a72
    v_accvgpr_read_b32 v225, a73
    v_accvgpr_read_b32 v226, a74
    v_accvgpr_read_b32 v227, a75
    v_pk_mul_f32 v[224:225], v[224:225], v[60:61] op_sel:[0,0] op_sel_hi:[1,0]
    v_pk_mul_f32 v[226:227], v[226:227], v[60:61] op_sel:[0,0] op_sel_hi:[1,0]
    v_cvt_pk_bf16_f32 v152, v224, v225
    v_cvt_pk_bf16_f32 v153, v226, v227
    v_accvgpr_read_b32 v228, a76
    v_accvgpr_read_b32 v229, a77
    v_accvgpr_read_b32 v230, a78
    v_accvgpr_read_b32 v231, a79
    v_pk_mul_f32 v[228:229], v[228:229], v[60:61] op_sel:[0,1] op_sel_hi:[1,1]
    v_pk_mul_f32 v[230:231], v[230:231], v[60:61] op_sel:[0,1] op_sel_hi:[1,1]
    v_cvt_pk_bf16_f32 v184, v228, v229
    v_cvt_pk_bf16_f32 v185, v230, v231
    v_accvgpr_read_b32 v216, a80
    v_accvgpr_read_b32 v217, a81
    v_accvgpr_read_b32 v218, a82
    v_accvgpr_read_b32 v219, a83
    v_pk_mul_f32 v[216:217], v[216:217], v[58:59] op_sel:[0,0] op_sel_hi:[1,0]
    v_pk_mul_f32 v[218:219], v[218:219], v[58:59] op_sel:[0,0] op_sel_hi:[1,0]
    v_cvt_pk_bf16_f32 v138, v216, v217
    v_cvt_pk_bf16_f32 v139, v218, v219
    s_add_u32 s37, s55, 0
    buffer_store_dwordx4 v[136:139], v252, s[28:31], s37 offen offset:2048
    v_accvgpr_read_b32 v220, a84
    v_accvgpr_read_b32 v221, a85
    v_accvgpr_read_b32 v222, a86
    v_accvgpr_read_b32 v223, a87
    v_pk_mul_f32 v[220:221], v[220:221], v[58:59] op_sel:[0,1] op_sel_hi:[1,1]
    v_pk_mul_f32 v[222:223], v[222:223], v[58:59] op_sel:[0,1] op_sel_hi:[1,1]
    v_cvt_pk_bf16_f32 v170, v220, v221
    v_cvt_pk_bf16_f32 v171, v222, v223
    s_add_u32 s37, s55, 8192
    buffer_store_dwordx4 v[168:171], v252, s[28:31], s37 offen offset:2048
    v_accvgpr_read_b32 v224, a88
    v_accvgpr_read_b32 v225, a89
    v_accvgpr_read_b32 v226, a90
    v_accvgpr_read_b32 v227, a91
    v_pk_mul_f32 v[224:225], v[224:225], v[60:61] op_sel:[0,0] op_sel_hi:[1,0]
    v_pk_mul_f32 v[226:227], v[226:227], v[60:61] op_sel:[0,0] op_sel_hi:[1,0]
    v_cvt_pk_bf16_f32 v154, v224, v225
    v_cvt_pk_bf16_f32 v155, v226, v227
    s_add_u32 s37, s55, 4096
    buffer_store_dwordx4 v[152:155], v252, s[28:31], s37 offen offset:2048
    v_accvgpr_read_b32 v228, a92
    v_accvgpr_read_b32 v229, a93
    v_accvgpr_read_b32 v230, a94
    v_accvgpr_read_b32 v231, a95
    v_pk_mul_f32 v[228:229], v[228:229], v[60:61] op_sel:[0,1] op_sel_hi:[1,1]
    v_pk_mul_f32 v[230:231], v[230:231], v[60:61] op_sel:[0,1] op_sel_hi:[1,1]
    v_cvt_pk_bf16_f32 v186, v228, v229
    v_cvt_pk_bf16_f32 v187, v230, v231
    s_add_u32 s37, s55, 12288
    buffer_store_dwordx4 v[184:187], v252, s[28:31], s37 offen offset:2048
    v_accvgpr_read_b32 v216, a96
    v_accvgpr_read_b32 v217, a97
    v_accvgpr_read_b32 v218, a98
    v_accvgpr_read_b32 v219, a99
    v_pk_mul_f32 v[216:217], v[216:217], v[58:59] op_sel:[0,0] op_sel_hi:[1,0]
    v_pk_mul_f32 v[218:219], v[218:219], v[58:59] op_sel:[0,0] op_sel_hi:[1,0]
    v_cvt_pk_bf16_f32 v140, v216, v217
    v_cvt_pk_bf16_f32 v141, v218, v219
    v_accvgpr_read_b32 v220, a100
    v_accvgpr_read_b32 v221, a101
    v_accvgpr_read_b32 v222, a102
    v_accvgpr_read_b32 v223, a103
    v_pk_mul_f32 v[220:221], v[220:221], v[58:59] op_sel:[0,1] op_sel_hi:[1,1]
    v_pk_mul_f32 v[222:223], v[222:223], v[58:59] op_sel:[0,1] op_sel_hi:[1,1]
    v_cvt_pk_bf16_f32 v172, v220, v221
    v_cvt_pk_bf16_f32 v173, v222, v223
    v_accvgpr_read_b32 v224, a104
    v_accvgpr_read_b32 v225, a105
    v_accvgpr_read_b32 v226, a106
    v_accvgpr_read_b32 v227, a107
    v_pk_mul_f32 v[224:225], v[224:225], v[60:61] op_sel:[0,0] op_sel_hi:[1,0]
    v_pk_mul_f32 v[226:227], v[226:227], v[60:61] op_sel:[0,0] op_sel_hi:[1,0]
    v_cvt_pk_bf16_f32 v156, v224, v225
    v_cvt_pk_bf16_f32 v157, v226, v227
    v_accvgpr_read_b32 v228, a108
    v_accvgpr_read_b32 v229, a109
    v_accvgpr_read_b32 v230, a110
    v_accvgpr_read_b32 v231, a111
    v_pk_mul_f32 v[228:229], v[228:229], v[60:61] op_sel:[0,1] op_sel_hi:[1,1]
    v_pk_mul_f32 v[230:231], v[230:231], v[60:61] op_sel:[0,1] op_sel_hi:[1,1]
    v_cvt_pk_bf16_f32 v188, v228, v229
    v_cvt_pk_bf16_f32 v189, v230, v231
    v_accvgpr_read_b32 v216, a112
    v_accvgpr_read_b32 v217, a113
    v_accvgpr_read_b32 v218, a114
    v_accvgpr_read_b32 v219, a115
    v_pk_mul_f32 v[216:217], v[216:217], v[58:59] op_sel:[0,0] op_sel_hi:[1,0]
    v_pk_mul_f32 v[218:219], v[218:219], v[58:59] op_sel:[0,0] op_sel_hi:[1,0]
    v_cvt_pk_bf16_f32 v142, v216, v217
    v_cvt_pk_bf16_f32 v143, v218, v219
    s_add_u32 s37, s55, 0
    buffer_store_dwordx4 v[140:143], v252, s[28:31], s37 offen offset:3072
    v_accvgpr_read_b32 v220, a116
    v_accvgpr_read_b32 v221, a117
    v_accvgpr_read_b32 v222, a118
    v_accvgpr_read_b32 v223, a119
    v_pk_mul_f32 v[220:221], v[220:221], v[58:59] op_sel:[0,1] op_sel_hi:[1,1]
    v_pk_mul_f32 v[222:223], v[222:223], v[58:59] op_sel:[0,1] op_sel_hi:[1,1]
Ltour8:
    s_cbranch_execz Ltour12
    v_cvt_pk_bf16_f32 v174, v220, v221
    v_cvt_pk_bf16_f32 v175, v222, v223
    s_add_u32 s37, s55, 8192
    buffer_store_dwordx4 v[172:175], v252, s[28:31], s37 offen offset:3072
    v_accvgpr_read_b32 v224, a120
    v_accvgpr_read_b32 v225, a121
    v_accvgpr_read_b32 v226, a122
    v_accvgpr_read_b32 v227, a123
    v_pk_mul_f32 v[224:225], v[224:225], v[60:61] op_sel:[0,0] op_sel_hi:[1,0]
    v_pk_mul_f32 v[226:227], v[226:227], v[60:61] op_sel:[0,0] op_sel_hi:[1,0]
    v_cvt_pk_bf16_f32 v158, v224, v225
    v_cvt_pk_bf16_f32 v159, v226, v227
    s_add_u32 s37, s55, 4096
    buffer_store_dwordx4 v[156:159], v252, s[28:31], s37 offen offset:3072
    v_accvgpr_read_b32 v228, a124
    v_accvgpr_read_b32 v229, a125
    v_accvgpr_read_b32 v230, a126
    v_accvgpr_read_b32 v231, a127
    v_pk_mul_f32 v[228:229], v[228:229], v[60:61] op_sel:[0,1] op_sel_hi:[1,1]
    v_pk_mul_f32 v[230:231], v[230:231], v[60:61] op_sel:[0,1] op_sel_hi:[1,1]
    v_cvt_pk_bf16_f32 v190, v228, v229
    v_cvt_pk_bf16_f32 v191, v230, v231
    s_add_u32 s37, s55, 12288
    buffer_store_dwordx4 v[188:191], v252, s[28:31], s37 offen offset:3072
    s_waitcnt lgkmcnt(14)
    v_mfma_f32_16x16x32_bf16 v[96:99], a[208:211], v[128:131], 0
    s_waitcnt lgkmcnt(12)
    ds_read_b64_tr_b16 a[160:161], v13 offset:0
    v_mfma_f32_16x16x32_bf16 v[96:99], a[212:215], v[132:135], v[96:99]
    s_waitcnt lgkmcnt(11)
    ds_read_b64_tr_b16 a[162:163], v13 offset:4096
    v_mfma_f32_16x16x32_bf16 v[96:99], a[216:219], v[136:139], v[96:99]
    s_waitcnt lgkmcnt(10)
    ds_read_b64_tr_b16 a[164:165], v13 offset:8192
    v_mfma_f32_16x16x32_bf16 v[96:99], a[220:223], v[140:143], v[96:99]
    s_waitcnt lgkmcnt(9)
    ds_read_b64_tr_b16 a[166:167], v13 offset:12288
    v_mfma_f32_16x16x32_bf16 v[96:99], a[224:227], v[144:147], v[96:99]
    s_waitcnt lgkmcnt(8)
    ds_read_b64_tr_b16 a[168:169], v13 offset:16384
    v_mfma_f32_16x16x32_bf16 v[96:99], a[228:231], v[148:151], v[96:99]
    s_waitcnt lgkmcnt(7)
    ds_read_b64_tr_b16 a[170:171], v13 offset:20480
    v_mfma_f32_16x16x32_bf16 v[96:99], a[232:235], v[152:155], v[96:99]
    s_waitcnt lgkmcnt(6)
    ds_read_b64_tr_b16 a[172:173], v13 offset:24576
    v_mfma_f32_16x16x32_bf16 v[96:99], a[236:239], v[156:159], v[96:99]
    ds_read_b64_tr_b16 a[174:175], v13 offset:28672
    v_mfma_f32_16x16x32_bf16 v[100:103], a[208:211], v[160:163], 0
    ds_read_b64_tr_b16 a[176:177], v17 offset:0
    v_mfma_f32_16x16x32_bf16 v[100:103], a[212:215], v[164:167], v[100:103]
    ds_read_b64_tr_b16 a[178:179], v17 offset:4096
    v_mfma_f32_16x16x32_bf16 v[100:103], a[216:219], v[168:171], v[100:103]
    ds_read_b64_tr_b16 a[180:181], v17 offset:8192
    v_mfma_f32_16x16x32_bf16 v[100:103], a[220:223], v[172:175], v[100:103]
    ds_read_b64_tr_b16 a[182:183], v17 offset:12288
    v_mfma_f32_16x16x32_bf16 v[100:103], a[224:227], v[176:179], v[100:103]
    ds_read_b64_tr_b16 a[184:185], v17 offset:16384
    v_cvt_pk_bf16_f32 v224, v96, v97
    v_mfma_f32_16x16x32_bf16 v[100:103], a[228:231], v[180:183], v[100:103]
    ds_read_b64_tr_b16 a[186:187], v17 offset:20480
    v_cvt_pk_bf16_f32 v225, v98, v99
    v_mfma_f32_16x16x32_bf16 v[100:103], a[232:235], v[184:187], v[100:103]
    ds_read_b64_tr_b16 a[188:189], v17 offset:24576
    v_mfma_f32_16x16x32_bf16 v[100:103], a[236:239], v[188:191], v[100:103]
    s_waitcnt lgkmcnt(13)
    ds_read_b64_tr_b16 a[190:191], v17 offset:28672
    v_mfma_f32_16x16x32_bf16 v[104:107], a[160:163], v[128:131], 0
    s_waitcnt lgkmcnt(12)
    ds_read_b64_tr_b16 a[208:209], v14 offset:0
    v_mfma_f32_16x16x32_bf16 v[104:107], a[164:167], v[132:135], v[104:107]
    s_waitcnt lgkmcnt(11)
    ds_read_b64_tr_b16 a[210:211], v14 offset:4096
    v_mfma_f32_16x16x32_bf16 v[104:107], a[168:171], v[136:139], v[104:107]
    s_waitcnt lgkmcnt(10)
    ds_read_b64_tr_b16 a[212:213], v14 offset:8192
    v_mfma_f32_16x16x32_bf16 v[104:107], a[172:175], v[140:143], v[104:107]
    s_waitcnt lgkmcnt(9)
    ds_read_b64_tr_b16 a[214:215], v14 offset:12288
    v_mfma_f32_16x16x32_bf16 v[104:107], a[176:179], v[144:147], v[104:107]
    s_waitcnt lgkmcnt(8)
    ds_read_b64_tr_b16 a[216:217], v14 offset:16384
    v_cvt_pk_bf16_f32 v228, v100, v101
    v_mfma_f32_16x16x32_bf16 v[104:107], a[180:183], v[148:151], v[104:107]
    s_waitcnt lgkmcnt(7)
    ds_read_b64_tr_b16 a[218:219], v14 offset:20480
    v_cvt_pk_bf16_f32 v229, v102, v103
    v_mfma_f32_16x16x32_bf16 v[104:107], a[184:187], v[152:155], v[104:107]
    s_waitcnt lgkmcnt(6)
    ds_read_b64_tr_b16 a[220:221], v14 offset:24576
    v_mfma_f32_16x16x32_bf16 v[104:107], a[188:191], v[156:159], v[104:107]
    ds_read_b64_tr_b16 a[222:223], v14 offset:28672
    s_waitcnt vmcnt(0)
    s_cmp_eq_u32 s53, 0
    s_cbranch_scc1 Lattn_wb
Lattn_wbdone:
    v_mfma_f32_16x16x32_bf16 v[108:111], a[160:163], v[160:163], 0
    buffer_store_dword v10, v8, s[24:27], s92 offen offset:8 sc1
    v_mfma_f32_16x16x32_bf16 v[108:111], a[164:167], v[164:167], v[108:111]
    s_xor_b32 s55, s55, 65536
    ds_read_b64_tr_b16 a[224:225], v18 offset:0
    ds_read_b64_tr_b16 a[226:227], v18 offset:4096
    v_mfma_f32_16x16x32_bf16 v[108:111], a[168:171], v[168:171], v[108:111]
    ds_read_b64_tr_b16 a[228:229], v18 offset:8192
    v_mfma_f32_16x16x32_bf16 v[108:111], a[172:175], v[172:175], v[108:111]
    ds_read_b64_tr_b16 a[230:231], v18 offset:12288
    s_load_dwordx2 s[12:13], s[0:1], 0
    v_mfma_f32_16x16x32_bf16 v[108:111], a[176:179], v[176:179], v[108:111]
    ds_read_b64_tr_b16 a[232:233], v18 offset:16384
    v_cvt_pk_bf16_f32 v226, v104, v105
    v_mfma_f32_16x16x32_bf16 v[108:111], a[180:183], v[180:183], v[108:111]
    s_add_u32 s38, s56, 16384
    ds_read_b64_tr_b16 a[234:235], v18 offset:20480
    v_cvt_pk_bf16_f32 v227, v106, v107
    s_load_dwordx2 s[16:17], s[0:1], 96
    v_mfma_f32_16x16x32_bf16 v[108:111], a[184:187], v[184:187], v[108:111]
    buffer_store_dwordx4 v[224:227], v56, s[28:31], s38 offen sc1
    v_mfma_f32_16x16x32_bf16 v[108:111], a[188:191], v[188:191], v[108:111]
    s_waitcnt lgkmcnt(12)
    ds_read_b64_tr_b16 a[236:237], v18 offset:24576
    ds_read_b64_tr_b16 a[238:239], v18 offset:28672
    s_load_dwordx2 s[52:53], s[0:1], 48
    v_mfma_f32_16x16x32_bf16 v[112:115], a[208:211], v[128:131], 0
    s_waitcnt lgkmcnt(12)
    ds_read_b64_tr_b16 a[160:161], v15 offset:0
    v_mfma_f32_16x16x32_bf16 v[112:115], a[212:215], v[132:135], v[112:115]
    s_waitcnt lgkmcnt(11)
    ds_read_b64_tr_b16 a[162:163], v15 offset:4096
    v_mfma_f32_16x16x32_bf16 v[112:115], a[216:219], v[136:139], v[112:115]
    s_waitcnt lgkmcnt(10)
    ds_read_b64_tr_b16 a[164:165], v15 offset:8192
    v_mfma_f32_16x16x32_bf16 v[112:115], a[220:223], v[140:143], v[112:115]
    s_waitcnt lgkmcnt(9)
    ds_read_b64_tr_b16 a[166:167], v15 offset:12288
    v_mfma_f32_16x16x32_bf16 v[112:115], a[224:227], v[144:147], v[112:115]
    s_waitcnt lgkmcnt(8)
    ds_read_b64_tr_b16 a[168:169], v15 offset:16384
    v_cvt_pk_bf16_f32 v230, v108, v109
    v_mfma_f32_16x16x32_bf16 v[112:115], a[228:231], v[148:151], v[112:115]
    s_waitcnt lgkmcnt(7)
    s_add_u32 s38, s56, 180224
    ds_read_b64_tr_b16 a[170:171], v15 offset:20480
    v_cvt_pk_bf16_f32 v231, v110, v111
    v_mfma_f32_16x16x32_bf16 v[112:115], a[232:235], v[152:155], v[112:115]
    s_waitcnt lgkmcnt(6)
    buffer_store_dwordx4 v[228:231], v56, s[28:31], s38 offen sc1
    v_mfma_f32_16x16x32_bf16 v[112:115], a[236:239], v[156:159], v[112:115]
    ds_read_b64_tr_b16 a[172:173], v15 offset:24576
    ds_read_b64_tr_b16 a[174:175], v15 offset:28672
    v_mfma_f32_16x16x32_bf16 v[116:119], a[208:211], v[160:163], 0
    ds_read_b64_tr_b16 a[176:177], v19 offset:0
    v_mfma_f32_16x16x32_bf16 v[116:119], a[212:215], v[164:167], v[116:119]
    ds_read_b64_tr_b16 a[178:179], v19 offset:4096
    v_mfma_f32_16x16x32_bf16 v[116:119], a[216:219], v[168:171], v[116:119]
    ds_read_b64_tr_b16 a[180:181], v19 offset:8192
    v_mfma_f32_16x16x32_bf16 v[116:119], a[220:223], v[172:175], v[116:119]
    ds_read_b64_tr_b16 a[182:183], v19 offset:12288
    v_mfma_f32_16x16x32_bf16 v[116:119], a[224:227], v[176:179], v[116:119]
    ds_read_b64_tr_b16 a[184:185], v19 offset:16384
    v_cvt_pk_bf16_f32 v232, v112, v113
    v_mfma_f32_16x16x32_bf16 v[116:119], a[228:231], v[180:183], v[116:119]
    ds_read_b64_tr_b16 a[186:187], v19 offset:20480
    v_cvt_pk_bf16_f32 v233, v114, v115
    v_mfma_f32_16x16x32_bf16 v[116:119], a[232:235], v[184:187], v[116:119]
    ds_read_b64_tr_b16 a[188:189], v19 offset:24576
    v_mfma_f32_16x16x32_bf16 v[116:119], a[236:239], v[188:191], v[116:119]
    s_waitcnt lgkmcnt(13)
    ds_read_b64_tr_b16 a[190:191], v19 offset:28672
    s_barrier
    v_mfma_f32_16x16x32_bf16 v[120:123], a[160:163], v[128:131], 0
    s_waitcnt lgkmcnt(12)
    buffer_load_dword v11, v8, s[24:27], s54 offen offset:8 sc1
    v_mfma_f32_16x16x32_bf16 v[120:123], a[164:167], v[132:135], v[120:123]
    s_waitcnt lgkmcnt(10)
    ds_read_b64_tr_b16 a[208:209], v20 offset:0
    ds_read_b64_tr_b16 a[210:211], v20 offset:4096
    v_mfma_f32_16x16x32_bf16 v[120:123], a[168:171], v[136:139], v[120:123]
    s_waitcnt lgkmcnt(10)
    ds_read_b64_tr_b16 a[212:213], v20 offset:8192
    v_mfma_f32_16x16x32_bf16 v[120:123], a[172:175], v[140:143], v[120:123]
    s_waitcnt lgkmcnt(9)
    ds_read_b64_tr_b16 a[214:215], v20 offset:12288
    v_mfma_f32_16x16x32_bf16 v[120:123], a[176:179], v[144:147], v[120:123]
    s_waitcnt lgkmcnt(8)
    ds_read_b64_tr_b16 a[216:217], v20 offset:16384
    v_cvt_pk_bf16_f32 v236, v116, v117
    v_mfma_f32_16x16x32_bf16 v[120:123], a[180:183], v[148:151], v[120:123]
    s_waitcnt lgkmcnt(7)
    ds_read_b64_tr_b16 a[218:219], v20 offset:20480
    v_cvt_pk_bf16_f32 v237, v118, v119
    v_mfma_f32_16x16x32_bf16 v[120:123], a[184:187], v[152:155], v[120:123]
    s_waitcnt lgkmcnt(6)
    s_add_u32 s49, s46, 73728
    ds_read_b64_tr_b16 a[220:221], v20 offset:24576
    v_mfma_f32_16x16x32_bf16 v[120:123], a[188:191], v[156:159], v[120:123]
    s_add_u32 m0, s42, 114688
    ds_read_b64_tr_b16 a[222:223], v20 offset:28672
    v_mfma_f32_16x16x32_bf16 v[124:127], a[160:163], v[160:163], 0
    buffer_load_dwordx4 v46, s[20:23], s49 offen lds
    v_mfma_f32_16x16x32_bf16 v[124:127], a[164:167], v[164:167], v[124:127]
    ds_read_b64_tr_b16 a[224:225], v24 offset:0
    ds_read_b64_tr_b16 a[226:227], v24 offset:4096
    v_mfma_f32_16x16x32_bf16 v[124:127], a[168:171], v[168:171], v[124:127]
    buffer_load_dwordx4 v47, s[20:23], s49 offen offset:1024 lds
    v_mfma_f32_16x16x32_bf16 v[124:127], a[172:175], v[172:175], v[124:127]
    ds_read_b64_tr_b16 a[228:229], v24 offset:8192
    ds_read_b64_tr_b16 a[230:231], v24 offset:12288
    v_mfma_f32_16x16x32_bf16 v[124:127], a[176:179], v[176:179], v[124:127]
    ds_read_b64_tr_b16 a[232:233], v24 offset:16384
    v_cvt_pk_bf16_f32 v234, v120, v121
    v_mfma_f32_16x16x32_bf16 v[124:127], a[180:183], v[180:183], v[124:127]
    s_add_u32 s38, s56, 16512
    ds_read_b64_tr_b16 a[234:235], v24 offset:20480
    v_cvt_pk_bf16_f32 v235, v122, v123
    v_mfma_f32_16x16x32_bf16 v[124:127], a[184:187], v[184:187], v[124:127]
    buffer_store_dwordx4 v[232:235], v56, s[28:31], s38 offen sc1
    v_mfma_f32_16x16x32_bf16 v[124:127], a[188:191], v[188:191], v[124:127]
    s_waitcnt lgkmcnt(12)
    ds_read_b64_tr_b16 a[236:237], v24 offset:24576
    ds_read_b64_tr_b16 a[238:239], v24 offset:28672
    v_mfma_f32_16x16x32_bf16 v[64:67], a[208:211], v[128:131], 0
    s_waitcnt lgkmcnt(12)
    buffer_load_dwordx4 v48, s[20:23], s49 offen offset:2048 lds
    v_mfma_f32_16x16x32_bf16 v[64:67], a[212:215], v[132:135], v[64:67]
    s_waitcnt lgkmcnt(10)
    ds_read_b64_tr_b16 a[160:161], v21 offset:0
    ds_read_b64_tr_b16 a[162:163], v21 offset:4096
    v_mfma_f32_16x16x32_bf16 v[64:67], a[216:219], v[136:139], v[64:67]
    s_waitcnt lgkmcnt(10)
    buffer_load_dwordx4 v49, s[20:23], s49 offen offset:3072 lds
    v_mfma_f32_16x16x32_bf16 v[64:67], a[220:223], v[140:143], v[64:67]
    s_waitcnt lgkmcnt(8)
    ds_read_b64_tr_b16 a[164:165], v21 offset:8192
    ds_read_b64_tr_b16 a[166:167], v21 offset:12288
    v_mfma_f32_16x16x32_bf16 v[64:67], a[224:227], v[144:147], v[64:67]
    s_waitcnt lgkmcnt(8)
    ds_read_b64_tr_b16 a[168:169], v21 offset:16384
    v_cvt_pk_bf16_f32 v238, v124, v125
    v_mfma_f32_16x16x32_bf16 v[64:67], a[228:231], v[148:151], v[64:67]
    s_waitcnt lgkmcnt(7)
    s_add_u32 s38, s56, 180352
    ds_read_b64_tr_b16 a[170:171], v21 offset:20480
    v_cvt_pk_bf16_f32 v239, v126, v127
    v_mfma_f32_16x16x32_bf16 v[64:67], a[232:235], v[152:155], v[64:67]
    s_waitcnt lgkmcnt(6)
    buffer_store_dwordx4 v[236:239], v56, s[28:31], s38 offen sc1
    v_mfma_f32_16x16x32_bf16 v[64:67], a[236:239], v[156:159], v[64:67]
    ds_read_b64_tr_b16 a[172:173], v21 offset:24576
    ds_read_b64_tr_b16 a[174:175], v21 offset:28672
    v_mfma_f32_16x16x32_bf16 v[68:71], a[208:211], v[160:163], 0
    ds_read_b64_tr_b16 a[176:177], v25 offset:0
    v_mfma_f32_16x16x32_bf16 v[68:71], a[212:215], v[164:167], v[68:71]
    ds_read_b64_tr_b16 a[178:179], v25 offset:4096
    v_mfma_f32_16x16x32_bf16 v[68:71], a[216:219], v[168:171], v[68:71]
    ds_read_b64_tr_b16 a[180:181], v25 offset:8192
    v_mfma_f32_16x16x32_bf16 v[68:71], a[220:223], v[172:175], v[68:71]
    ds_read_b64_tr_b16 a[182:183], v25 offset:12288
    v_mfma_f32_16x16x32_bf16 v[68:71], a[224:227], v[176:179], v[68:71]
    ds_read_b64_tr_b16 a[184:185], v25 offset:16384
    v_mfma_f32_16x16x32_bf16 v[68:71], a[228:231], v[180:183], v[68:71]
    ds_read_b64_tr_b16 a[186:187], v25 offset:20480
    v_mfma_f32_16x16x32_bf16 v[68:71], a[232:235], v[184:187], v[68:71]
    ds_read_b64_tr_b16 a[188:189], v25 offset:24576
    v_mfma_f32_16x16x32_bf16 v[68:71], a[236:239], v[188:191], v[68:71]
    s_waitcnt lgkmcnt(13)
    ds_read_b64_tr_b16 a[190:191], v25 offset:28672
    v_mfma_f32_16x16x32_bf16 v[72:75], a[160:163], v[128:131], 0
    s_waitcnt lgkmcnt(12)
    ds_read_b64_tr_b16 a[208:209], v22 offset:0
    v_mfma_f32_16x16x32_bf16 v[72:75], a[164:167], v[132:135], v[72:75]
    s_waitcnt lgkmcnt(11)
    ds_read_b64_tr_b16 a[210:211], v22 offset:4096
    v_mfma_f32_16x16x32_bf16 v[72:75], a[168:171], v[136:139], v[72:75]
    s_waitcnt lgkmcnt(10)
    ds_read_b64_tr_b16 a[212:213], v22 offset:8192
    v_mfma_f32_16x16x32_bf16 v[72:75], a[172:175], v[140:143], v[72:75]
    s_waitcnt lgkmcnt(9)
    ds_read_b64_tr_b16 a[214:215], v22 offset:12288
    v_mfma_f32_16x16x32_bf16 v[72:75], a[176:179], v[144:147], v[72:75]
    s_waitcnt lgkmcnt(8)
    ds_read_b64_tr_b16 a[216:217], v22 offset:16384
    v_mfma_f32_16x16x32_bf16 v[72:75], a[180:183], v[148:151], v[72:75]
    s_waitcnt lgkmcnt(7)
    ds_read_b64_tr_b16 a[218:219], v22 offset:20480
    v_mfma_f32_16x16x32_bf16 v[72:75], a[184:187], v[152:155], v[72:75]
    s_waitcnt lgkmcnt(6)
    ds_read_b64_tr_b16 a[220:221], v22 offset:24576
    v_mfma_f32_16x16x32_bf16 v[72:75], a[188:191], v[156:159], v[72:75]
    ds_read_b64_tr_b16 a[222:223], v22 offset:28672
    v_mfma_f32_16x16x32_bf16 v[76:79], a[160:163], v[160:163], 0
    ds_read_b64_tr_b16 a[224:225], v26 offset:0
    v_mfma_f32_16x16x32_bf16 v[76:79], a[164:167], v[164:167], v[76:79]
    ds_read_b64_tr_b16 a[226:227], v26 offset:4096
    v_mfma_f32_16x16x32_bf16 v[76:79], a[168:171], v[168:171], v[76:79]
    ds_read_b64_tr_b16 a[228:229], v26 offset:8192
    v_mfma_f32_16x16x32_bf16 v[76:79], a[172:175], v[172:175], v[76:79]
    ds_read_b64_tr_b16 a[230:231], v26 offset:12288
    v_mfma_f32_16x16x32_bf16 v[76:79], a[176:179], v[176:179], v[76:79]
    ds_read_b64_tr_b16 a[232:233], v26 offset:16384
    v_mfma_f32_16x16x32_bf16 v[76:79], a[180:183], v[180:183], v[76:79]
    ds_read_b64_tr_b16 a[234:235], v26 offset:20480
    v_mfma_f32_16x16x32_bf16 v[76:79], a[184:187], v[184:187], v[76:79]
    ds_read_b64_tr_b16 a[236:237], v26 offset:24576
    v_mfma_f32_16x16x32_bf16 v[76:79], a[188:191], v[188:191], v[76:79]
    s_waitcnt lgkmcnt(13)
    ds_read_b64_tr_b16 a[238:239], v26 offset:28672
    v_mfma_f32_16x16x32_bf16 v[80:83], a[208:211], v[128:131], 0
    s_waitcnt lgkmcnt(12)
    ds_read_b64_tr_b16 a[160:161], v23 offset:0
    v_mfma_f32_16x16x32_bf16 v[80:83], a[212:215], v[132:135], v[80:83]
    s_waitcnt lgkmcnt(11)
    ds_read_b64_tr_b16 a[162:163], v23 offset:4096
    v_mfma_f32_16x16x32_bf16 v[80:83], a[216:219], v[136:139], v[80:83]
    s_waitcnt lgkmcnt(10)
    ds_read_b64_tr_b16 a[164:165], v23 offset:8192
    s_waitcnt vmcnt(6)
    v_readfirstlane_b32 s36, v11
    v_mfma_f32_16x16x32_bf16 v[80:83], a[220:223], v[140:143], v[80:83]
    s_waitcnt lgkmcnt(9)
    ds_read_b64_tr_b16 a[166:167], v23 offset:12288
    v_mfma_f32_16x16x32_bf16 v[80:83], a[224:227], v[144:147], v[80:83]
    ds_read_b64_tr_b16 a[168:169], v23 offset:16384
    s_cmp_lg_u32 s36, s95
    s_cbranch_scc1 Lattn_xspin
Lattn_xgot:
    s_waitcnt lgkmcnt(9)
    v_mfma_f32_16x16x32_bf16 v[80:83], a[228:231], v[148:151], v[80:83]
    s_waitcnt lgkmcnt(7)
    ds_read_b64_tr_b16 a[170:171], v23 offset:20480
    v_mfma_f32_16x16x32_bf16 v[80:83], a[232:235], v[152:155], v[80:83]
    s_waitcnt lgkmcnt(6)
    ds_read_b64_tr_b16 a[172:173], v23 offset:24576
    v_mfma_f32_16x16x32_bf16 v[80:83], a[236:239], v[156:159], v[80:83]
    s_add_u32 s37, s55, 0
    ds_read_b64_tr_b16 a[174:175], v23 offset:28672
    v_mfma_f32_16x16x32_bf16 v[84:87], a[208:211], v[160:163], 0
    buffer_load_dwordx4 a[64:67], v252, s[28:31], s37 offen offset:0 sc1
    v_mfma_f32_16x16x32_bf16 v[84:87], a[212:215], v[164:167], v[84:87]
    ds_read_b64_tr_b16 a[176:177], v27 offset:0
    ds_read_b64_tr_b16 a[178:179], v27 offset:4096
    v_mfma_f32_16x16x32_bf16 v[84:87], a[216:219], v[168:171], v[84:87]
    buffer_load_dwordx4 a[68:71], v252, s[28:31], s37 offen offset:1024 sc1
    v_mfma_f32_16x16x32_bf16 v[84:87], a[220:223], v[172:175], v[84:87]
    ds_read_b64_tr_b16 a[180:181], v27 offset:8192
    ds_read_b64_tr_b16 a[182:183], v27 offset:12288
    v_mfma_f32_16x16x32_bf16 v[84:87], a[224:227], v[176:179], v[84:87]
    ds_read_b64_tr_b16 a[184:185], v27 offset:16384
    v_mfma_f32_16x16x32_bf16 v[84:87], a[228:231], v[180:183], v[84:87]
    ds_read_b64_tr_b16 a[186:187], v27 offset:20480
    v_mfma_f32_16x16x32_bf16 v[84:87], a[232:235], v[184:187], v[84:87]
    buffer_load_dwordx4 a[72:75], v252, s[28:31], s37 offen offset:2048 sc1
    v_mfma_f32_16x16x32_bf16 v[84:87], a[236:239], v[188:191], v[84:87]
    s_waitcnt lgkmcnt(12)
    ds_read_b64_tr_b16 a[188:189], v27 offset:24576
    ds_read_b64_tr_b16 a[190:191], v27 offset:28672
    s_barrier
    v_mfma_f32_16x16x32_bf16 v[88:91], a[160:163], v[128:131], 0
    s_waitcnt lgkmcnt(12)
    ds_read_b64_tr_b16 a[208:209], v12 offset:32768
    v_mfma_f32_16x16x32_bf16 v[88:91], a[164:167], v[132:135], v[88:91]
    s_waitcnt lgkmcnt(11)
    ds_read_b64_tr_b16 a[210:211], v12 offset:36864
    v_mfma_f32_16x16x32_bf16 v[88:91], a[168:171], v[136:139], v[88:91]
    s_waitcnt lgkmcnt(10)
    buffer_load_dwordx4 a[76:79], v252, s[28:31], s37 offen offset:3072 sc1
    v_mfma_f32_16x16x32_bf16 v[88:91], a[172:175], v[140:143], v[88:91]
    s_waitcnt lgkmcnt(8)
    ds_read_b64_tr_b16 a[212:213], v12 offset:40960
    ds_read_b64_tr_b16 a[214:215], v12 offset:45056
    v_mfma_f32_16x16x32_bf16 v[88:91], a[176:179], v[144:147], v[88:91]
    s_waitcnt lgkmcnt(8)
    ds_read_b64_tr_b16 a[216:217], v12 offset:49152
    v_mfma_f32_16x16x32_bf16 v[88:91], a[180:183], v[148:151], v[88:91]
    s_waitcnt lgkmcnt(7)
    s_add_u32 s37, s55, 4096
    ds_read_b64_tr_b16 a[218:219], v12 offset:53248
    v_mfma_f32_16x16x32_bf16 v[88:91], a[184:187], v[152:155], v[88:91]
    s_waitcnt lgkmcnt(6)
    s_add_u32 s49, s46, 256
    buffer_load_dwordx4 a[80:83], v252, s[28:31], s37 offen offset:0 sc1
    v_mfma_f32_16x16x32_bf16 v[88:91], a[188:191], v[156:159], v[88:91]
    s_add_u32 m0, s42, 0
    ds_read_b64_tr_b16 a[220:221], v12 offset:57344
    ds_read_b64_tr_b16 a[222:223], v12 offset:61440
    v_mfma_f32_16x16x32_bf16 v[92:95], a[160:163], v[160:163], 0
    buffer_load_dwordx4 v46, s[20:23], s49 offen lds
    v_mfma_f32_16x16x32_bf16 v[92:95], a[164:167], v[164:167], v[92:95]
    ds_read_b64_tr_b16 a[224:225], v16 offset:32768
    ds_read_b64_tr_b16 a[226:227], v16 offset:36864
    v_mfma_f32_16x16x32_bf16 v[92:95], a[168:171], v[168:171], v[92:95]
    buffer_load_dwordx4 v47, s[20:23], s49 offen offset:1024 lds
    v_mfma_f32_16x16x32_bf16 v[92:95], a[172:175], v[172:175], v[92:95]
    ds_read_b64_tr_b16 a[228:229], v16 offset:40960
    ds_read_b64_tr_b16 a[230:231], v16 offset:45056
    v_mfma_f32_16x16x32_bf16 v[92:95], a[176:179], v[176:179], v[92:95]
    buffer_load_dwordx4 a[84:87], v252, s[28:31], s37 offen offset:1024 sc1
    v_mfma_f32_16x16x32_bf16 v[92:95], a[180:183], v[180:183], v[92:95]
    ds_read_b64_tr_b16 a[232:233], v16 offset:49152
    ds_read_b64_tr_b16 a[234:235], v16 offset:53248
    v_mfma_f32_16x16x32_bf16 v[92:95], a[184:187], v[184:187], v[92:95]
    ds_read_b64_tr_b16 a[236:237], v16 offset:57344
    v_mfma_f32_16x16x32_bf16 v[92:95], a[188:191], v[188:191], v[92:95]
    s_waitcnt lgkmcnt(13)
    ds_read_b64_tr_b16 a[238:239], v16 offset:61440
    v_mfma_f32_16x16x32_bf16 v[96:99], a[208:211], v[128:131], 0
    s_waitcnt lgkmcnt(12)
    buffer_load_dwordx4 v48, s[20:23], s49 offen offset:2048 lds
    v_mfma_f32_16x16x32_bf16 v[96:99], a[212:215], v[132:135], v[96:99]
    s_waitcnt lgkmcnt(10)
    ds_read_b64_tr_b16 a[160:161], v13 offset:32768
    ds_read_b64_tr_b16 a[162:163], v13 offset:36864
    v_mfma_f32_16x16x32_bf16 v[96:99], a[216:219], v[136:139], v[96:99]
    s_waitcnt lgkmcnt(10)
    buffer_load_dwordx4 v49, s[20:23], s49 offen offset:3072 lds
    v_mfma_f32_16x16x32_bf16 v[96:99], a[220:223], v[140:143], v[96:99]
    s_waitcnt lgkmcnt(8)
    ds_read_b64_tr_b16 a[164:165], v13 offset:40960
    ds_read_b64_tr_b16 a[166:167], v13 offset:45056
    v_mfma_f32_16x16x32_bf16 v[96:99], a[224:227], v[144:147], v[96:99]
    s_waitcnt lgkmcnt(8)
    buffer_load_dwordx4 a[88:91], v252, s[28:31], s37 offen offset:2048 sc1
    v_mfma_f32_16x16x32_bf16 v[96:99], a[228:231], v[148:151], v[96:99]
    s_waitcnt lgkmcnt(6)
    ds_read_b64_tr_b16 a[168:169], v13 offset:49152
    ds_read_b64_tr_b16 a[170:171], v13 offset:53248
    v_mfma_f32_16x16x32_bf16 v[96:99], a[232:235], v[152:155], v[96:99]
    s_waitcnt lgkmcnt(6)
    s_add_u32 s49, s46, 73984
    ds_read_b64_tr_b16 a[172:173], v13 offset:57344
    v_mfma_f32_16x16x32_bf16 v[96:99], a[236:239], v[156:159], v[96:99]
    s_add_u32 m0, s42, 16384
    ds_read_b64_tr_b16 a[174:175], v13 offset:61440
    v_mfma_f32_16x16x32_bf16 v[100:103], a[208:211], v[160:163], 0
    buffer_load_dwordx4 v46, s[20:23], s49 offen lds
    v_mfma_f32_16x16x32_bf16 v[100:103], a[212:215], v[164:167], v[100:103]
    ds_read_b64_tr_b16 a[176:177], v17 offset:32768
    ds_read_b64_tr_b16 a[178:179], v17 offset:36864
    v_mfma_f32_16x16x32_bf16 v[100:103], a[216:219], v[168:171], v[100:103]
    buffer_load_dwordx4 v47, s[20:23], s49 offen offset:1024 lds
    v_mfma_f32_16x16x32_bf16 v[100:103], a[220:223], v[172:175], v[100:103]
    ds_read_b64_tr_b16 a[180:181], v17 offset:40960
    ds_read_b64_tr_b16 a[182:183], v17 offset:45056
    v_mfma_f32_16x16x32_bf16 v[100:103], a[224:227], v[176:179], v[100:103]
    buffer_load_dwordx4 a[92:95], v252, s[28:31], s37 offen offset:3072 sc1
    v_mfma_f32_16x16x32_bf16 v[100:103], a[228:231], v[180:183], v[100:103]
    ds_read_b64_tr_b16 a[184:185], v17 offset:49152
    ds_read_b64_tr_b16 a[186:187], v17 offset:53248
    v_mfma_f32_16x16x32_bf16 v[100:103], a[232:235], v[184:187], v[100:103]
    ds_read_b64_tr_b16 a[188:189], v17 offset:57344
    v_mfma_f32_16x16x32_bf16 v[100:103], a[236:239], v[188:191], v[100:103]
    s_waitcnt lgkmcnt(13)
    ds_read_b64_tr_b16 a[190:191], v17 offset:61440
    v_mfma_f32_16x16x32_bf16 v[104:107], a[160:163], v[128:131], 0
    s_waitcnt lgkmcnt(12)
    buffer_load_dwordx4 v48, s[20:23], s49 offen offset:2048 lds
    v_mfma_f32_16x16x32_bf16 v[104:107], a[164:167], v[132:135], v[104:107]
    s_waitcnt lgkmcnt(10)
    ds_read_b64_tr_b16 a[208:209], v14 offset:32768
    ds_read_b64_tr_b16 a[210:211], v14 offset:36864
    v_mfma_f32_16x16x32_bf16 v[104:107], a[168:171], v[136:139], v[104:107]
    s_waitcnt lgkmcnt(10)
    buffer_load_dwordx4 v49, s[20:23], s49 offen offset:3072 lds
    v_mfma_f32_16x16x32_bf16 v[104:107], a[172:175], v[140:143], v[104:107]
    s_waitcnt lgkmcnt(8)
    s_add_u32 s37, s55, 8192
    ds_read_b64_tr_b16 a[212:213], v14 offset:40960
    ds_read_b64_tr_b16 a[214:215], v14 offset:45056
    v_mfma_f32_16x16x32_bf16 v[104:107], a[176:179], v[144:147], v[104:107]
    s_waitcnt lgkmcnt(8)
    buffer_load_dwordx4 a[96:99], v252, s[28:31], s37 offen offset:0 sc1
    v_mfma_f32_16x16x32_bf16 v[104:107], a[180:183], v[148:151], v[104:107]
    s_waitcnt lgkmcnt(6)
    ds_read_b64_tr_b16 a[216:217], v14 offset:49152
    ds_read_b64_tr_b16 a[218:219], v14 offset:53248
    v_mfma_f32_16x16x32_bf16 v[104:107], a[184:187], v[152:155], v[104:107]
    s_waitcnt lgkmcnt(6)
    buffer_load_dwordx4 a[100:103], v252, s[28:31], s37 offen offset:1024 sc1
    v_mfma_f32_16x16x32_bf16 v[104:107], a[188:191], v[156:159], v[104:107]
    ds_read_b64_tr_b16 a[220:221], v14 offset:57344
    ds_read_b64_tr_b16 a[222:223], v14 offset:61440
    v_mfma_f32_16x16x32_bf16 v[108:111], a[160:163], v[160:163], 0
    ds_read_b64_tr_b16 a[224:225], v18 offset:32768
    v_mfma_f32_16x16x32_bf16 v[108:111], a[164:167], v[164:167], v[108:111]
    ds_read_b64_tr_b16 a[226:227], v18 offset:36864
    v_mfma_f32_16x16x32_bf16 v[108:111], a[168:171], v[168:171], v[108:111]
    buffer_load_dwordx4 a[104:107], v252, s[28:31], s37 offen offset:2048 sc1
    v_mfma_f32_16x16x32_bf16 v[108:111], a[172:175], v[172:175], v[108:111]
    ds_read_b64_tr_b16 a[228:229], v18 offset:40960
    ds_read_b64_tr_b16 a[230:231], v18 offset:45056
    v_mfma_f32_16x16x32_bf16 v[108:111], a[176:179], v[176:179], v[108:111]
    ds_read_b64_tr_b16 a[232:233], v18 offset:49152
    v_mfma_f32_16x16x32_bf16 v[108:111], a[180:183], v[180:183], v[108:111]
    ds_read_b64_tr_b16 a[234:235], v18 offset:53248
    v_mfma_f32_16x16x32_bf16 v[108:111], a[184:187], v[184:187], v[108:111]
    buffer_load_dwordx4 a[108:111], v252, s[28:31], s37 offen offset:3072 sc1
    v_mfma_f32_16x16x32_bf16 v[108:111], a[188:191], v[188:191], v[108:111]
    s_waitcnt lgkmcnt(12)
    ds_read_b64_tr_b16 a[236:237], v18 offset:57344
    ds_read_b64_tr_b16 a[238:239], v18 offset:61440
    v_mfma_f32_16x16x32_bf16 v[112:115], a[208:211], v[128:131], 0
    s_waitcnt lgkmcnt(12)
    ds_read_b64_tr_b16 a[160:161], v15 offset:32768
    v_mfma_f32_16x16x32_bf16 v[112:115], a[212:215], v[132:135], v[112:115]
    s_waitcnt lgkmcnt(11)
    s_add_u32 s37, s55, 12288
    ds_read_b64_tr_b16 a[162:163], v15 offset:36864
    v_mfma_f32_16x16x32_bf16 v[112:115], a[216:219], v[136:139], v[112:115]
    s_waitcnt lgkmcnt(10)
    buffer_load_dwordx4 a[112:115], v252, s[28:31], s37 offen offset:0 sc1
    v_mfma_f32_16x16x32_bf16 v[112:115], a[220:223], v[140:143], v[112:115]
    s_waitcnt lgkmcnt(8)
    ds_read_b64_tr_b16 a[164:165], v15 offset:40960
    ds_read_b64_tr_b16 a[166:167], v15 offset:45056
    v_mfma_f32_16x16x32_bf16 v[112:115], a[224:227], v[144:147], v[112:115]
    s_waitcnt lgkmcnt(8)
    buffer_load_dwordx4 a[116:119], v252, s[28:31], s37 offen offset:1024 sc1
    v_mfma_f32_16x16x32_bf16 v[112:115], a[228:231], v[148:151], v[112:115]
    s_waitcnt lgkmcnt(6)
    ds_read_b64_tr_b16 a[168:169], v15 offset:49152
    ds_read_b64_tr_b16 a[170:171], v15 offset:53248
    v_mfma_f32_16x16x32_bf16 v[112:115], a[232:235], v[152:155], v[112:115]
    s_waitcnt lgkmcnt(6)
    ds_read_b64_tr_b16 a[172:173], v15 offset:57344
    v_mfma_f32_16x16x32_bf16 v[112:115], a[236:239], v[156:159], v[112:115]
    ds_read_b64_tr_b16 a[174:175], v15 offset:61440
    v_mfma_f32_16x16x32_bf16 v[116:119], a[208:211], v[160:163], 0
    buffer_load_dwordx4 a[120:123], v252, s[28:31], s37 offen offset:2048 sc1
    v_mfma_f32_16x16x32_bf16 v[116:119], a[212:215], v[164:167], v[116:119]
    ds_read_b64_tr_b16 a[176:177], v19 offset:32768
    ds_read_b64_tr_b16 a[178:179], v19 offset:36864
    v_mfma_f32_16x16x32_bf16 v[116:119], a[216:219], v[168:171], v[116:119]
    ds_read_b64_tr_b16 a[180:181], v19 offset:40960
    v_mfma_f32_16x16x32_bf16 v[116:119], a[220:223], v[172:175], v[116:119]
    ds_read_b64_tr_b16 a[182:183], v19 offset:45056
    v_mfma_f32_16x16x32_bf16 v[116:119], a[224:227], v[176:179], v[116:119]
    buffer_load_dwordx4 a[124:127], v252, s[28:31], s37 offen offset:3072 sc1
    v_mfma_f32_16x16x32_bf16 v[116:119], a[228:231], v[180:183], v[116:119]
    ds_read_b64_tr_b16 a[184:185], v19 offset:49152
    ds_read_b64_tr_b16 a[186:187], v19 offset:53248
    v_mfma_f32_16x16x32_bf16 v[116:119], a[232:235], v[184:187], v[116:119]
    ds_read_b64_tr_b16 a[188:189], v19 offset:57344
    v_mfma_f32_16x16x32_bf16 v[116:119], a[236:239], v[188:191], v[116:119]
    ds_read_b64_tr_b16 a[190:191], v19 offset:61440
    s_waitcnt vmcnt(25)
    s_waitcnt lgkmcnt(0)
    s_barrier
    v_mfma_f32_16x16x32_bf16 v[120:123], a[160:163], v[128:131], 0
    ds_read_b64_tr_b16 a[208:209], v20 offset:32768
    v_mfma_f32_16x16x32_bf16 v[120:123], a[164:167], v[132:135], v[120:123]
    ds_read_b64_tr_b16 a[210:211], v20 offset:36864
    v_mfma_f32_16x16x32_bf16 v[120:123], a[168:171], v[136:139], v[120:123]
    ds_read_b64_tr_b16 a[212:213], v20 offset:40960
    v_mfma_f32_16x16x32_bf16 v[120:123], a[172:175], v[140:143], v[120:123]
    ds_read_b64_tr_b16 a[214:215], v20 offset:45056
    v_mfma_f32_16x16x32_bf16 v[120:123], a[176:179], v[144:147], v[120:123]
    ds_read_b64_tr_b16 a[216:217], v20 offset:49152
    v_mfma_f32_16x16x32_bf16 v[120:123], a[180:183], v[148:151], v[120:123]
    ds_read_b64_tr_b16 a[218:219], v20 offset:53248
    v_mfma_f32_16x16x32_bf16 v[120:123], a[184:187], v[152:155], v[120:123]
    s_add_u32 s49, s7, 512
    ds_read_b64_tr_b16 a[220:221], v20 offset:57344
    v_mfma_f32_16x16x32_bf16 v[120:123], a[188:191], v[156:159], v[120:123]
    s_add_u32 m0, s42, 65536
    ds_read_b64_tr_b16 a[222:223], v20 offset:61440
    v_mfma_f32_16x16x32_bf16 v[124:127], a[160:163], v[160:163], 0
Ltour9:
    s_cbranch_execz Ltour13
    buffer_load_dwordx4 v46, s[20:23], s49 offen lds
    v_mfma_f32_16x16x32_bf16 v[124:127], a[164:167], v[164:167], v[124:127]
    ds_read_b64_tr_b16 a[224:225], v24 offset:32768
    ds_read_b64_tr_b16 a[226:227], v24 offset:36864
    v_mfma_f32_16x16x32_bf16 v[124:127], a[168:171], v[168:171], v[124:127]
    buffer_load_dwordx4 v47, s[20:23], s49 offen offset:1024 lds
    v_mfma_f32_16x16x32_bf16 v[124:127], a[172:175], v[172:175], v[124:127]
    ds_read_b64_tr_b16 a[228:229], v24 offset:40960
    ds_read_b64_tr_b16 a[230:231], v24 offset:45056
    v_mfma_f32_16x16x32_bf16 v[124:127], a[176:179], v[176:179], v[124:127]
    ds_read_b64_tr_b16 a[232:233], v24 offset:49152
    v_mfma_f32_16x16x32_bf16 v[124:127], a[180:183], v[180:183], v[124:127]
    ds_read_b64_tr_b16 a[234:235], v24 offset:53248
    v_mfma_f32_16x16x32_bf16 v[124:127], a[184:187], v[184:187], v[124:127]
    ds_read_b64_tr_b16 a[236:237], v24 offset:57344
    v_mfma_f32_16x16x32_bf16 v[124:127], a[188:191], v[188:191], v[124:127]
    s_waitcnt vmcnt(25)
    s_waitcnt lgkmcnt(13)
    ds_read_b64_tr_b16 a[238:239], v24 offset:61440
    v_mfma_f32_16x16x32_bf16 v[64:67], a[208:211], a[64:67], v[64:67]
    s_waitcnt vmcnt(24)
    s_waitcnt lgkmcnt(12)
    buffer_load_dwordx4 v48, s[20:23], s49 offen offset:2048 lds
    v_mfma_f32_16x16x32_bf16 v[64:67], a[212:215], a[68:71], v[64:67]
    s_waitcnt vmcnt(24)
    s_waitcnt lgkmcnt(10)
    s_lshl_b32 s40, s5, 4
    ds_read_b64_tr_b16 a[160:161], v21 offset:32768
    ds_read_b64_tr_b16 a[162:163], v21 offset:36864
    v_mfma_f32_16x16x32_bf16 v[64:67], a[216:219], a[72:75], v[64:67]
    s_waitcnt vmcnt(23)
    s_waitcnt lgkmcnt(10)
    buffer_load_dwordx4 v49, s[20:23], s49 offen offset:3072 lds
    v_mfma_f32_16x16x32_bf16 v[64:67], a[220:223], a[76:79], v[64:67]
    s_waitcnt vmcnt(23)
    s_waitcnt lgkmcnt(8)
    s_add_u32 s40, s40, s4
    ds_read_b64_tr_b16 a[164:165], v21 offset:40960
    ds_read_b64_tr_b16 a[166:167], v21 offset:45056
    v_mfma_f32_16x16x32_bf16 v[64:67], a[224:227], a[80:83], v[64:67]
    s_waitcnt vmcnt(20)
    s_waitcnt lgkmcnt(8)
    ds_read_b64_tr_b16 a[168:169], v21 offset:49152
    v_and_b32 v240, 31, v1
    v_mfma_f32_16x16x32_bf16 v[64:67], a[228:231], a[84:87], v[64:67]
    s_waitcnt vmcnt(17)
    s_waitcnt lgkmcnt(7)
    ds_read_b64_tr_b16 a[170:171], v21 offset:53248
    v_lshrrev_b32 v241, 5, v1
    v_mfma_f32_16x16x32_bf16 v[64:67], a[232:235], a[88:91], v[64:67]
    s_waitcnt vmcnt(14)
    s_waitcnt lgkmcnt(6)
    s_add_u32 s49, s7, 74240
    ds_read_b64_tr_b16 a[172:173], v21 offset:57344
    v_cmp_gt_u32 vcc, 8, v240
    v_mfma_f32_16x16x32_bf16 v[64:67], a[236:239], a[92:95], v[64:67]
    s_waitcnt vmcnt(11)
    s_add_u32 m0, s42, 81920
    ds_read_b64_tr_b16 a[174:175], v21 offset:61440
    v_mov_b32 v242, 2147483648
    v_mfma_f32_16x16x32_bf16 v[68:71], a[208:211], a[96:99], v[68:71]
    s_waitcnt vmcnt(10)
    buffer_load_dwordx4 v46, s[20:23], s49 offen lds
    v_mfma_f32_16x16x32_bf16 v[68:71], a[212:215], a[100:103], v[68:71]
    s_waitcnt vmcnt(10)
    s_lshl_b32 s43, s40, 3
    ds_read_b64_tr_b16 a[176:177], v25 offset:32768
    ds_read_b64_tr_b16 a[178:179], v25 offset:36864
    v_mfma_f32_16x16x32_bf16 v[68:71], a[216:219], a[104:107], v[68:71]
    s_waitcnt vmcnt(9)
    buffer_load_dwordx4 v47, s[20:23], s49 offen offset:1024 lds
    v_mfma_f32_16x16x32_bf16 v[68:71], a[220:223], a[108:111], v[68:71]
    s_waitcnt vmcnt(9)
    s_lshl_b32 s44, s3, 1
    ds_read_b64_tr_b16 a[180:181], v25 offset:40960
    ds_read_b64_tr_b16 a[182:183], v25 offset:45056
    v_mfma_f32_16x16x32_bf16 v[68:71], a[224:227], a[112:115], v[68:71]
    s_waitcnt vmcnt(8)
    ds_read_b64_tr_b16 a[184:185], v25 offset:49152
    v_cvt_pk_bf16_f32 v224, v64, v65
    v_mfma_f32_16x16x32_bf16 v[68:71], a[228:231], a[116:119], v[68:71]
    s_waitcnt vmcnt(7)
    ds_read_b64_tr_b16 a[186:187], v25 offset:53248
    v_cvt_pk_bf16_f32 v225, v66, v67
    v_mfma_f32_16x16x32_bf16 v[68:71], a[232:235], a[120:123], v[68:71]
    s_waitcnt vmcnt(6)
    s_add_u32 s43, s43, s44
    ds_read_b64_tr_b16 a[188:189], v25 offset:57344
    v_cndmask_b32 v242, v242, 0, vcc
    v_mfma_f32_16x16x32_bf16 v[68:71], a[236:239], a[124:127], v[68:71]
    s_waitcnt lgkmcnt(13)
    ds_read_b64_tr_b16 a[190:191], v25 offset:61440
    v_add_u32 v7, s43, v241
    v_mfma_f32_16x16x32_bf16 v[72:75], a[160:163], a[64:67], v[72:75]
    s_waitcnt lgkmcnt(12)
    buffer_load_dwordx4 v48, s[20:23], s49 offen offset:2048 lds
    v_mfma_f32_16x16x32_bf16 v[72:75], a[164:167], a[68:71], v[72:75]
    s_waitcnt lgkmcnt(10)
    ds_read_b64_tr_b16 a[208:209], v22 offset:32768
    ds_read_b64_tr_b16 a[210:211], v22 offset:36864
    v_mfma_f32_16x16x32_bf16 v[72:75], a[168:171], a[72:75], v[72:75]
    s_waitcnt lgkmcnt(10)
    buffer_load_dwordx4 v49, s[20:23], s49 offen offset:3072 lds
    v_mfma_f32_16x16x32_bf16 v[72:75], a[172:175], a[76:79], v[72:75]
    s_waitcnt lgkmcnt(8)
    ds_read_b64_tr_b16 a[212:213], v22 offset:40960
    ds_read_b64_tr_b16 a[214:215], v22 offset:45056
    v_mfma_f32_16x16x32_bf16 v[72:75], a[176:179], a[80:83], v[72:75]
    s_waitcnt lgkmcnt(8)
    ds_read_b64_tr_b16 a[216:217], v22 offset:49152
    v_cvt_pk_bf16_f32 v228, v68, v69
    v_mfma_f32_16x16x32_bf16 v[72:75], a[180:183], a[84:87], v[72:75]
    s_waitcnt lgkmcnt(7)
    ds_read_b64_tr_b16 a[218:219], v22 offset:53248
    v_cvt_pk_bf16_f32 v229, v70, v71
    v_mfma_f32_16x16x32_bf16 v[72:75], a[184:187], a[88:91], v[72:75]
    s_waitcnt lgkmcnt(6)
    ds_read_b64_tr_b16 a[220:221], v22 offset:57344
    v_lshlrev_b32 v5, 4, v240
    v_mfma_f32_16x16x32_bf16 v[72:75], a[188:191], a[92:95], v[72:75]
    ds_read_b64_tr_b16 a[222:223], v22 offset:61440
    v_lshlrev_b32 v243, 4, v241
    v_mfma_f32_16x16x32_bf16 v[76:79], a[160:163], a[96:99], v[76:79]
    ds_read_b64_tr_b16 a[224:225], v26 offset:32768
    v_lshl_add_u32 v2, v240, 5, v243
    v_mfma_f32_16x16x32_bf16 v[76:79], a[164:167], a[100:103], v[76:79]
    s_mul_i32 s44, s43, 10240
    ds_read_b64_tr_b16 a[226:227], v26 offset:36864
    v_lshrrev_b32 v243, 2, v240
    v_mfma_f32_16x16x32_bf16 v[76:79], a[168:171], a[104:107], v[76:79]
    ds_read_b64_tr_b16 a[228:229], v26 offset:40960
    v_lshlrev_b32 v243, 6, v243
    v_mfma_f32_16x16x32_bf16 v[76:79], a[172:175], a[108:111], v[76:79]
    ds_read_b64_tr_b16 a[230:231], v26 offset:45056
    v_and_b32 v241, 3, v240
    v_mfma_f32_16x16x32_bf16 v[76:79], a[176:179], a[112:115], v[76:79]
    ds_read_b64_tr_b16 a[232:233], v26 offset:49152
    v_cvt_pk_bf16_f32 v226, v72, v73
    v_mfma_f32_16x16x32_bf16 v[76:79], a[180:183], a[116:119], v[76:79]
    s_add_u32 s38, s93, 0
    ds_read_b64_tr_b16 a[234:235], v26 offset:53248
    v_cvt_pk_bf16_f32 v227, v74, v75
    v_mfma_f32_16x16x32_bf16 v[76:79], a[184:187], a[120:123], v[76:79]
    buffer_store_dwordx4 v[224:227], v56, s[28:31], s38 offen sc1
    v_mfma_f32_16x16x32_bf16 v[76:79], a[188:191], a[124:127], v[76:79]
    s_waitcnt lgkmcnt(12)
    ds_read_b64_tr_b16 a[236:237], v26 offset:57344
    ds_read_b64_tr_b16 a[238:239], v26 offset:61440
    v_mfma_f32_16x16x32_bf16 v[80:83], a[208:211], a[64:67], v[80:83]
    s_waitcnt lgkmcnt(12)
    ds_read_b64_tr_b16 a[160:161], v23 offset:32768
    v_lshl_add_u32 v3, v241, 3, v243
    v_mfma_f32_16x16x32_bf16 v[80:83], a[212:215], a[68:71], v[80:83]
    s_waitcnt lgkmcnt(11)
    ds_read_b64_tr_b16 a[162:163], v23 offset:36864
    v_mul_u32_u24 v243, 1152, v7
    v_mfma_f32_16x16x32_bf16 v[80:83], a[216:219], a[72:75], v[80:83]
    s_waitcnt lgkmcnt(10)
    ds_read_b64_tr_b16 a[164:165], v23 offset:40960
    v_add_u32 v4, v243, v3
    v_mfma_f32_16x16x32_bf16 v[80:83], a[220:223], a[76:79], v[80:83]
    s_waitcnt lgkmcnt(9)
    ds_read_b64_tr_b16 a[166:167], v23 offset:45056
    v_lshl_add_u32 v6, v243, 1, v5
    v_mfma_f32_16x16x32_bf16 v[80:83], a[224:227], a[80:83], v[80:83]
    s_waitcnt lgkmcnt(8)
    ds_read_b64_tr_b16 a[168:169], v23 offset:49152
    v_cvt_pk_bf16_f32 v230, v76, v77
    v_mfma_f32_16x16x32_bf16 v[80:83], a[228:231], a[84:87], v[80:83]
    s_waitcnt lgkmcnt(7)
    s_add_u32 s38, s93, 163840
    ds_read_b64_tr_b16 a[170:171], v23 offset:53248
    v_cvt_pk_bf16_f32 v231, v78, v79
    v_mfma_f32_16x16x32_bf16 v[80:83], a[232:235], a[88:91], v[80:83]
    s_waitcnt lgkmcnt(6)
    buffer_store_dwordx4 v[228:231], v56, s[28:31], s38 offen sc1
    v_mfma_f32_16x16x32_bf16 v[80:83], a[236:239], a[92:95], v[80:83]
    ds_read_b64_tr_b16 a[172:173], v23 offset:57344
    ds_read_b64_tr_b16 a[174:175], v23 offset:61440
    v_mfma_f32_16x16x32_bf16 v[84:87], a[208:211], a[96:99], v[84:87]
    ds_read_b64_tr_b16 a[176:177], v27 offset:32768
    v_or_b32 v55, v3, v242
    v_mfma_f32_16x16x32_bf16 v[84:87], a[212:215], a[100:103], v[84:87]
    ds_read_b64_tr_b16 a[178:179], v27 offset:36864
    v_or_b32 v58, v4, v242
    v_mfma_f32_16x16x32_bf16 v[84:87], a[216:219], a[104:107], v[84:87]
    ds_read_b64_tr_b16 a[180:181], v27 offset:40960
    v_or_b32 v59, v5, v242
    v_mfma_f32_16x16x32_bf16 v[84:87], a[220:223], a[108:111], v[84:87]
    ds_read_b64_tr_b16 a[182:183], v27 offset:45056
    v_or_b32 v60, v6, v242
    v_mfma_f32_16x16x32_bf16 v[84:87], a[224:227], a[112:115], v[84:87]
    ds_read_b64_tr_b16 a[184:185], v27 offset:49152
    v_cvt_pk_bf16_f32 v232, v80, v81
    v_mfma_f32_16x16x32_bf16 v[84:87], a[228:231], a[116:119], v[84:87]
    ds_read_b64_tr_b16 a[186:187], v27 offset:53248
    v_cvt_pk_bf16_f32 v233, v82, v83
    v_mfma_f32_16x16x32_bf16 v[84:87], a[232:235], a[120:123], v[84:87]
    ds_read_b64_tr_b16 a[188:189], v27 offset:57344
    v_lshrrev_b32 v243, 4, v1
    v_mfma_f32_16x16x32_bf16 v[84:87], a[236:239], a[124:127], v[84:87]
    s_waitcnt lgkmcnt(13)
    ds_read_b64_tr_b16 a[190:191], v27 offset:61440
    v_lshlrev_b32 v243, 8, v243
    s_barrier
    v_mfma_f32_16x16x32_bf16 v[88:91], a[160:163], a[64:67], v[88:91]
    s_waitcnt lgkmcnt(12)
    ds_read_b64_tr_b16 a[208:209], v12 offset:0
    v_and_b32 v241, 7, v1
    v_mfma_f32_16x16x32_bf16 v[88:91], a[164:167], a[68:71], v[88:91]
    s_waitcnt lgkmcnt(11)
    ds_read_b64_tr_b16 a[210:211], v12 offset:4096
    v_lshl_add_u32 v243, v241, 5, v243
    v_mfma_f32_16x16x32_bf16 v[88:91], a[168:171], a[72:75], v[88:91]
    s_waitcnt lgkmcnt(10)
    ds_read_b64_tr_b16 a[212:213], v12 offset:8192
    v_and_b32 v241, 8, v1
    v_mfma_f32_16x16x32_bf16 v[88:91], a[172:175], a[76:79], v[88:91]
    s_waitcnt lgkmcnt(9)
    ds_read_b64_tr_b16 a[214:215], v12 offset:12288
    v_lshl_add_u32 v54, v241, 1, v243
    v_mfma_f32_16x16x32_bf16 v[88:91], a[176:179], a[80:83], v[88:91]
    s_waitcnt lgkmcnt(8)
    ds_read_b64_tr_b16 a[216:217], v12 offset:16384
    v_cvt_pk_bf16_f32 v236, v84, v85
    v_mfma_f32_16x16x32_bf16 v[88:91], a[180:183], a[84:87], v[88:91]
    s_waitcnt lgkmcnt(7)
    ds_read_b64_tr_b16 a[218:219], v12 offset:20480
    v_cvt_pk_bf16_f32 v237, v86, v87
    v_mfma_f32_16x16x32_bf16 v[88:91], a[184:187], a[88:91], v[88:91]
    s_waitcnt lgkmcnt(6)
    s_add_u32 s49, s46, 512
    ds_read_b64_tr_b16 a[220:221], v12 offset:24576
    v_mfma_f32_16x16x32_bf16 v[88:91], a[188:191], a[92:95], v[88:91]
    s_add_u32 m0, s42, 32768
    ds_read_b64_tr_b16 a[222:223], v12 offset:28672
    v_mfma_f32_16x16x32_bf16 v[92:95], a[160:163], a[96:99], v[92:95]
    buffer_load_dwordx4 v46, s[20:23], s49 offen lds
    v_mfma_f32_16x16x32_bf16 v[92:95], a[164:167], a[100:103], v[92:95]
    s_lshr_b32 s41, s2, 3
    ds_read_b64_tr_b16 a[224:225], v16 offset:0
    ds_read_b64_tr_b16 a[226:227], v16 offset:4096
    v_mfma_f32_16x16x32_bf16 v[92:95], a[168:171], a[104:107], v[92:95]
    buffer_load_dwordx4 v47, s[20:23], s49 offen offset:1024 lds
    v_mfma_f32_16x16x32_bf16 v[92:95], a[172:175], a[108:111], v[92:95]
    s_mov_b32 s14, 2359296
    ds_read_b64_tr_b16 a[228:229], v16 offset:8192
    ds_read_b64_tr_b16 a[230:231], v16 offset:12288
    v_mfma_f32_16x16x32_bf16 v[92:95], a[176:179], a[112:115], v[92:95]
    ds_read_b64_tr_b16 a[232:233], v16 offset:16384
    v_cvt_pk_bf16_f32 v234, v88, v89
    v_mfma_f32_16x16x32_bf16 v[92:95], a[180:183], a[116:119], v[92:95]
    s_add_u32 s38, s93, 128
    ds_read_b64_tr_b16 a[234:235], v16 offset:20480
    v_cvt_pk_bf16_f32 v235, v90, v91
    v_mfma_f32_16x16x32_bf16 v[92:95], a[184:187], a[120:123], v[92:95]
    buffer_store_dwordx4 v[232:235], v56, s[28:31], s38 offen sc1
    v_mfma_f32_16x16x32_bf16 v[92:95], a[188:191], a[124:127], v[92:95]
    s_waitcnt lgkmcnt(12)
    s_mov_b32 s15, 0x20000
    ds_read_b64_tr_b16 a[236:237], v16 offset:24576
    ds_read_b64_tr_b16 a[238:239], v16 offset:28672
    v_mfma_f32_16x16x32_bf16 v[96:99], a[208:211], a[64:67], v[96:99]
    s_waitcnt lgkmcnt(12)
    buffer_load_dwordx4 v48, s[20:23], s49 offen offset:2048 lds
    v_mfma_f32_16x16x32_bf16 v[96:99], a[212:215], a[68:71], v[96:99]
    s_waitcnt lgkmcnt(10)
    s_mov_b32 s18, 2359296
    ds_read_b64_tr_b16 a[160:161], v13 offset:0
    ds_read_b64_tr_b16 a[162:163], v13 offset:4096
    v_mfma_f32_16x16x32_bf16 v[96:99], a[216:219], a[72:75], v[96:99]
    s_waitcnt lgkmcnt(10)
    buffer_load_dwordx4 v49, s[20:23], s49 offen offset:3072 lds
    v_mfma_f32_16x16x32_bf16 v[96:99], a[220:223], a[76:79], v[96:99]
    s_waitcnt lgkmcnt(8)
    s_mov_b32 s19, 0x20000
    ds_read_b64_tr_b16 a[164:165], v13 offset:8192
    ds_read_b64_tr_b16 a[166:167], v13 offset:12288
    v_mfma_f32_16x16x32_bf16 v[96:99], a[224:227], a[80:83], v[96:99]
    s_waitcnt lgkmcnt(8)
    ds_read_b64_tr_b16 a[168:169], v13 offset:16384
    v_cvt_pk_bf16_f32 v238, v92, v93
    v_mfma_f32_16x16x32_bf16 v[96:99], a[228:231], a[84:87], v[96:99]
    s_waitcnt lgkmcnt(7)
    s_add_u32 s38, s93, 163968
    ds_read_b64_tr_b16 a[170:171], v13 offset:20480
    v_cvt_pk_bf16_f32 v239, v94, v95
    v_mfma_f32_16x16x32_bf16 v[96:99], a[232:235], a[88:91], v[96:99]
    s_waitcnt lgkmcnt(6)
    s_add_u32 s49, s46, 74240
    buffer_store_dwordx4 v[236:239], v56, s[28:31], s38 offen sc1
    v_mfma_f32_16x16x32_bf16 v[96:99], a[236:239], a[92:95], v[96:99]
    s_add_u32 m0, s42, 49152
    ds_read_b64_tr_b16 a[172:173], v13 offset:24576
    ds_read_b64_tr_b16 a[174:175], v13 offset:28672
    v_mfma_f32_16x16x32_bf16 v[100:103], a[208:211], a[96:99], v[100:103]
    buffer_load_dwordx4 v46, s[20:23], s49 offen lds
    v_mfma_f32_16x16x32_bf16 v[100:103], a[212:215], a[100:103], v[100:103]
    s_add_u32 s8, s50, 7864320
    s_addc_u32 s9, s51, 0
    ds_read_b64_tr_b16 a[176:177], v17 offset:0
    ds_read_b64_tr_b16 a[178:179], v17 offset:4096
    v_mfma_f32_16x16x32_bf16 v[100:103], a[216:219], a[104:107], v[100:103]
    buffer_load_dwordx4 v47, s[20:23], s49 offen offset:1024 lds
    v_mfma_f32_16x16x32_bf16 v[100:103], a[220:223], a[108:111], v[100:103]
    s_mov_b32 s10, 663552
    ds_read_b64_tr_b16 a[180:181], v17 offset:8192
    ds_read_b64_tr_b16 a[182:183], v17 offset:12288
    v_mfma_f32_16x16x32_bf16 v[100:103], a[224:227], a[112:115], v[100:103]
    ds_read_b64_tr_b16 a[184:185], v17 offset:16384
    v_cvt_pk_bf16_f32 v224, v96, v97
    v_mfma_f32_16x16x32_bf16 v[100:103], a[228:231], a[116:119], v[100:103]
    ds_read_b64_tr_b16 a[186:187], v17 offset:20480
    v_cvt_pk_bf16_f32 v225, v98, v99
    v_mfma_f32_16x16x32_bf16 v[100:103], a[232:235], a[120:123], v[100:103]
    s_mov_b32 s11, 0x20000
    ds_read_b64_tr_b16 a[188:189], v17 offset:24576
    v_mfma_f32_16x16x32_bf16 v[100:103], a[236:239], a[124:127], v[100:103]
    s_waitcnt lgkmcnt(13)
    s_lshl_b32 s39, s5, 13
    ds_read_b64_tr_b16 a[190:191], v17 offset:28672
    v_mfma_f32_16x16x32_bf16 v[104:107], a[160:163], a[64:67], v[104:107]
    s_waitcnt lgkmcnt(12)
    buffer_load_dwordx4 v48, s[20:23], s49 offen offset:2048 lds
    v_mfma_f32_16x16x32_bf16 v[104:107], a[164:167], a[68:71], v[104:107]
    s_waitcnt lgkmcnt(10)
    s_add_u32 s39, s39, 8781824
    ds_read_b64_tr_b16 a[208:209], v14 offset:0
    ds_read_b64_tr_b16 a[210:211], v14 offset:4096
    v_mfma_f32_16x16x32_bf16 v[104:107], a[168:171], a[72:75], v[104:107]
    s_waitcnt lgkmcnt(10)
    buffer_load_dwordx4 v49, s[20:23], s49 offen offset:3072 lds
    v_mfma_f32_16x16x32_bf16 v[104:107], a[172:175], a[76:79], v[104:107]
    s_waitcnt lgkmcnt(8)
    s_lshr_b32 s45, s4, 2
    ds_read_b64_tr_b16 a[212:213], v14 offset:8192
    ds_read_b64_tr_b16 a[214:215], v14 offset:12288
    v_mfma_f32_16x16x32_bf16 v[104:107], a[176:179], a[80:83], v[104:107]
    s_waitcnt lgkmcnt(8)
    ds_read_b64_tr_b16 a[216:217], v14 offset:16384
    v_cvt_pk_bf16_f32 v228, v100, v101
    v_mfma_f32_16x16x32_bf16 v[104:107], a[180:183], a[84:87], v[104:107]
    s_waitcnt lgkmcnt(7)
    ds_read_b64_tr_b16 a[218:219], v14 offset:20480
    v_cvt_pk_bf16_f32 v229, v102, v103
    v_mfma_f32_16x16x32_bf16 v[104:107], a[184:187], a[88:91], v[104:107]
    s_waitcnt lgkmcnt(6)
    s_lshl_b32 s45, s45, 11
    ds_read_b64_tr_b16 a[220:221], v14 offset:24576
    v_mfma_f32_16x16x32_bf16 v[104:107], a[188:191], a[92:95], v[104:107]
    s_add_u32 s39, s39, s45
    ds_read_b64_tr_b16 a[222:223], v14 offset:28672
    v_and_b32 v9, 15, v1
    v_mfma_f32_16x16x32_bf16 v[108:111], a[160:163], a[96:99], v[108:111]
    ds_read_b64_tr_b16 a[224:225], v18 offset:0
    v_lshlrev_b32 v9, 7, v9
    v_mfma_f32_16x16x32_bf16 v[108:111], a[164:167], a[100:103], v[108:111]
    ds_read_b64_tr_b16 a[226:227], v18 offset:4096
    v_lshrrev_b32 v240, 4, v1
    v_mfma_f32_16x16x32_bf16 v[108:111], a[168:171], a[104:107], v[108:111]
    ds_read_b64_tr_b16 a[228:229], v18 offset:8192
    v_bfe_u32 v241, v1, 2, 2
    v_mfma_f32_16x16x32_bf16 v[108:111], a[172:175], a[108:111], v[108:111]
    ds_read_b64_tr_b16 a[230:231], v18 offset:12288
    v_cmp_eq_u32 s[54:55], v240, v241
    v_mfma_f32_16x16x32_bf16 v[108:111], a[176:179], a[112:115], v[108:111]
    ds_read_b64_tr_b16 a[232:233], v18 offset:16384
    v_cvt_pk_bf16_f32 v226, v104, v105
    v_mfma_f32_16x16x32_bf16 v[108:111], a[180:183], a[116:119], v[108:111]
    s_add_u32 s38, s93, 512
    ds_read_b64_tr_b16 a[234:235], v18 offset:20480
    v_cvt_pk_bf16_f32 v227, v106, v107
    v_mfma_f32_16x16x32_bf16 v[108:111], a[184:187], a[120:123], v[108:111]
    buffer_store_dwordx4 v[224:227], v56, s[28:31], s38 offen sc1
    v_mfma_f32_16x16x32_bf16 v[108:111], a[188:191], a[124:127], v[108:111]
    s_waitcnt lgkmcnt(12)
    ds_read_b64_tr_b16 a[236:237], v18 offset:24576
    ds_read_b64_tr_b16 a[238:239], v18 offset:28672
    v_mfma_f32_16x16x32_bf16 v[112:115], a[208:211], a[64:67], v[112:115]
    s_waitcnt lgkmcnt(12)
    ds_read_b64_tr_b16 a[160:161], v15 offset:0
    v_and_b32 v240, 1, v1
    v_mfma_f32_16x16x32_bf16 v[112:115], a[212:215], a[68:71], v[112:115]
    s_waitcnt lgkmcnt(11)
    ds_read_b64_tr_b16 a[162:163], v15 offset:4096
    v_lshlrev_b32 v240, 4, v240
    v_mfma_f32_16x16x32_bf16 v[112:115], a[216:219], a[72:75], v[112:115]
    s_waitcnt lgkmcnt(10)
    ds_read_b64_tr_b16 a[164:165], v15 offset:8192
    v_mov_b32 v241, 0x3f80
    v_mfma_f32_16x16x32_bf16 v[112:115], a[220:223], a[76:79], v[112:115]
    s_waitcnt lgkmcnt(9)
    ds_read_b64_tr_b16 a[166:167], v15 offset:12288
    v_lshlrev_b32 v240, v240, v241
    v_mfma_f32_16x16x32_bf16 v[112:115], a[224:227], a[80:83], v[112:115]
    s_waitcnt lgkmcnt(8)
    ds_read_b64_tr_b16 a[168:169], v15 offset:16384
    v_cvt_pk_bf16_f32 v230, v108, v109
    v_mfma_f32_16x16x32_bf16 v[112:115], a[228:231], a[84:87], v[112:115]
    s_waitcnt lgkmcnt(7)
    s_add_u32 s38, s93, 164352
    ds_read_b64_tr_b16 a[170:171], v15 offset:20480
    v_cvt_pk_bf16_f32 v231, v110, v111
    v_mfma_f32_16x16x32_bf16 v[112:115], a[232:235], a[88:91], v[112:115]
    s_waitcnt lgkmcnt(6)
    buffer_store_dwordx4 v[228:231], v56, s[28:31], s38 offen sc1
    v_mfma_f32_16x16x32_bf16 v[112:115], a[236:239], a[92:95], v[112:115]
    ds_read_b64_tr_b16 a[172:173], v15 offset:24576
    ds_read_b64_tr_b16 a[174:175], v15 offset:28672
    v_mfma_f32_16x16x32_bf16 v[116:119], a[208:211], a[96:99], v[116:119]
    ds_read_b64_tr_b16 a[176:177], v19 offset:0
    v_bfe_i32 v241, v1, 1, 1
    v_mfma_f32_16x16x32_bf16 v[116:119], a[212:215], a[100:103], v[116:119]
    ds_read_b64_tr_b16 a[178:179], v19 offset:4096
    v_and_b32 v243, v240, v241
    v_mfma_f32_16x16x32_bf16 v[116:119], a[216:219], a[104:107], v[116:119]
    ds_read_b64_tr_b16 a[180:181], v19 offset:8192
    v_xor_b32 v242, v240, v243
    v_mfma_f32_16x16x32_bf16 v[116:119], a[220:223], a[108:111], v[116:119]
    ds_read_b64_tr_b16 a[182:183], v19 offset:12288
    v_cndmask_b32 v250, 0, v242, s[54:55]
    v_mfma_f32_16x16x32_bf16 v[116:119], a[224:227], a[112:115], v[116:119]
    ds_read_b64_tr_b16 a[184:185], v19 offset:16384
    v_cvt_pk_bf16_f32 v232, v112, v113
    v_mfma_f32_16x16x32_bf16 v[116:119], a[228:231], a[116:119], v[116:119]
    ds_read_b64_tr_b16 a[186:187], v19 offset:20480
    v_cvt_pk_bf16_f32 v233, v114, v115
    v_mfma_f32_16x16x32_bf16 v[116:119], a[232:235], a[120:123], v[116:119]
    ds_read_b64_tr_b16 a[188:189], v19 offset:24576
    v_cndmask_b32 v251, 0, v243, s[54:55]
    v_mfma_f32_16x16x32_bf16 v[116:119], a[236:239], a[124:127], v[116:119]
    s_waitcnt lgkmcnt(13)
    ds_read_b64_tr_b16 a[190:191], v19 offset:28672
    v_mov_b32 v248, 0
    s_waitcnt vmcnt(14)
    s_barrier
    v_mfma_f32_16x16x32_bf16 v[120:123], a[160:163], a[64:67], v[120:123]
    s_waitcnt lgkmcnt(12)
    ds_read_b64_tr_b16 a[208:209], v20 offset:0
    v_mov_b32 v249, 0
    v_mfma_f32_16x16x32_bf16 v[120:123], a[164:167], a[68:71], v[120:123]
    s_waitcnt lgkmcnt(11)
    ds_read_b64_tr_b16 a[210:211], v20 offset:4096
    v_mov_b32 v252, 0
    v_mfma_f32_16x16x32_bf16 v[120:123], a[168:171], a[72:75], v[120:123]
    s_waitcnt lgkmcnt(10)
    ds_read_b64_tr_b16 a[212:213], v20 offset:8192
    v_mov_b32 v253, 0
    v_mfma_f32_16x16x32_bf16 v[120:123], a[172:175], a[76:79], v[120:123]
    s_waitcnt lgkmcnt(9)
    ds_read_b64_tr_b16 a[214:215], v20 offset:12288
    v_mov_b32 v240, 0
    v_mfma_f32_16x16x32_bf16 v[120:123], a[176:179], a[80:83], v[120:123]
    s_waitcnt lgkmcnt(8)
    ds_read_b64_tr_b16 a[216:217], v20 offset:16384
    v_cvt_pk_bf16_f32 v236, v116, v117
    v_mfma_f32_16x16x32_bf16 v[120:123], a[180:183], a[84:87], v[120:123]
    s_waitcnt lgkmcnt(7)
    ds_read_b64_tr_b16 a[218:219], v20 offset:20480
    v_cvt_pk_bf16_f32 v237, v118, v119
    v_mfma_f32_16x16x32_bf16 v[120:123], a[184:187], a[88:91], v[120:123]
    s_waitcnt lgkmcnt(6)
    s_add_u32 s49, s7, 768
    ds_read_b64_tr_b16 a[220:221], v20 offset:24576
    v_mov_b32 v241, 0
    v_mfma_f32_16x16x32_bf16 v[120:123], a[188:191], a[92:95], v[120:123]
    s_add_u32 m0, s42, 98304
    ds_read_b64_tr_b16 a[222:223], v20 offset:28672
    v_mfma_f32_16x16x32_bf16 v[124:127], a[160:163], a[96:99], v[124:127]
    buffer_load_dwordx4 v46, s[20:23], s49 offen lds
    v_mfma_f32_16x16x32_bf16 v[124:127], a[164:167], a[100:103], v[124:127]
    ds_read_b64_tr_b16 a[224:225], v24 offset:0
    ds_read_b64_tr_b16 a[226:227], v24 offset:4096
    v_mfma_f32_16x16x32_bf16 v[124:127], a[168:171], a[104:107], v[124:127]
    buffer_load_dwordx4 v47, s[20:23], s49 offen offset:1024 lds
    v_mfma_f32_16x16x32_bf16 v[124:127], a[172:175], a[108:111], v[124:127]
    ds_read_b64_tr_b16 a[228:229], v24 offset:8192
    ds_read_b64_tr_b16 a[230:231], v24 offset:12288
    v_mfma_f32_16x16x32_bf16 v[124:127], a[176:179], a[112:115], v[124:127]
    ds_read_b64_tr_b16 a[232:233], v24 offset:16384
    v_cvt_pk_bf16_f32 v234, v120, v121
    v_mfma_f32_16x16x32_bf16 v[124:127], a[180:183], a[116:119], v[124:127]
    s_add_u32 s38, s93, 640
    ds_read_b64_tr_b16 a[234:235], v24 offset:20480
    v_cvt_pk_bf16_f32 v235, v122, v123
    v_mfma_f32_16x16x32_bf16 v[124:127], a[184:187], a[120:123], v[124:127]
    buffer_store_dwordx4 v[232:235], v56, s[28:31], s38 offen sc1
    v_mfma_f32_16x16x32_bf16 v[124:127], a[188:191], a[124:127], v[124:127]
    s_waitcnt lgkmcnt(12)
    ds_read_b64_tr_b16 a[236:237], v24 offset:24576
    ds_read_b64_tr_b16 a[238:239], v24 offset:28672
    v_mfma_f32_16x16x32_bf16 v[64:67], a[208:211], v[128:131], 0
    s_waitcnt lgkmcnt(12)
    buffer_load_dwordx4 v48, s[20:23], s49 offen offset:2048 lds
    v_mfma_f32_16x16x32_bf16 v[64:67], a[212:215], v[132:135], v[64:67]
    s_waitcnt lgkmcnt(10)
    ds_read_b64_tr_b16 a[160:161], v21 offset:0
    ds_read_b64_tr_b16 a[162:163], v21 offset:4096
    v_mfma_f32_16x16x32_bf16 v[64:67], a[216:219], v[136:139], v[64:67]
    s_waitcnt lgkmcnt(10)
    buffer_load_dwordx4 v49, s[20:23], s49 offen offset:3072 lds
    v_mfma_f32_16x16x32_bf16 v[64:67], a[220:223], v[140:143], v[64:67]
    s_waitcnt lgkmcnt(8)
    ds_read_b64_tr_b16 a[164:165], v21 offset:8192
    ds_read_b64_tr_b16 a[166:167], v21 offset:12288
    v_mfma_f32_16x16x32_bf16 v[64:67], a[224:227], v[144:147], v[64:67]
    s_waitcnt lgkmcnt(8)
    ds_read_b64_tr_b16 a[168:169], v21 offset:16384
    v_cvt_pk_bf16_f32 v238, v124, v125
    v_mfma_f32_16x16x32_bf16 v[64:67], a[228:231], v[148:151], v[64:67]
    s_waitcnt lgkmcnt(7)
    s_add_u32 s38, s93, 164480
    ds_read_b64_tr_b16 a[170:171], v21 offset:20480
    v_cvt_pk_bf16_f32 v239, v126, v127
    v_mfma_f32_16x16x32_bf16 v[64:67], a[232:235], v[152:155], v[64:67]
    s_waitcnt lgkmcnt(6)
    s_add_u32 s49, s7, 74496
    buffer_store_dwordx4 v[236:239], v56, s[28:31], s38 offen sc1
    v_mfma_f32_16x16x32_bf16 v[64:67], a[236:239], v[156:159], v[64:67]
    s_add_u32 m0, s42, 114688
    ds_read_b64_tr_b16 a[172:173], v21 offset:24576
    ds_read_b64_tr_b16 a[174:175], v21 offset:28672
    v_mfma_f32_16x16x32_bf16 v[68:71], a[208:211], v[160:163], 0
    buffer_load_dwordx4 v46, s[20:23], s49 offen lds
    v_mfma_f32_16x16x32_bf16 v[68:71], a[212:215], v[164:167], v[68:71]
    ds_read_b64_tr_b16 a[176:177], v25 offset:0
    ds_read_b64_tr_b16 a[178:179], v25 offset:4096
    v_mfma_f32_16x16x32_bf16 v[68:71], a[216:219], v[168:171], v[68:71]
    buffer_load_dwordx4 v47, s[20:23], s49 offen offset:1024 lds
    v_mfma_f32_16x16x32_bf16 v[68:71], a[220:223], v[172:175], v[68:71]
    ds_read_b64_tr_b16 a[180:181], v25 offset:8192
    ds_read_b64_tr_b16 a[182:183], v25 offset:12288
    v_mfma_f32_16x16x32_bf16 v[68:71], a[224:227], v[176:179], v[68:71]
    buffer_load_dwordx2 v[36:37], v4, s[12:15], 0 offen offset:0
    v_mfma_f32_16x16x32_bf16 v[68:71], a[228:231], v[180:183], v[68:71]
    ds_read_b64_tr_b16 a[184:185], v25 offset:16384
    ds_read_b64_tr_b16 a[186:187], v25 offset:20480
    v_mfma_f32_16x16x32_bf16 v[68:71], a[232:235], v[184:187], v[68:71]
    ds_read_b64_tr_b16 a[188:189], v25 offset:24576
    v_mfma_f32_16x16x32_bf16 v[68:71], a[236:239], v[188:191], v[68:71]
    s_waitcnt lgkmcnt(13)
    ds_read_b64_tr_b16 a[190:191], v25 offset:28672
    v_mfma_f32_16x16x32_bf16 v[72:75], a[160:163], v[128:131], 0
    s_waitcnt lgkmcnt(12)
    buffer_load_dwordx4 v48, s[20:23], s49 offen offset:2048 lds
    v_mfma_f32_16x16x32_bf16 v[72:75], a[164:167], v[132:135], v[72:75]
    s_waitcnt lgkmcnt(10)
    ds_read_b64_tr_b16 a[208:209], v22 offset:0
    ds_read_b64_tr_b16 a[210:211], v22 offset:4096
    v_mfma_f32_16x16x32_bf16 v[72:75], a[168:171], v[136:139], v[72:75]
    s_waitcnt lgkmcnt(10)
    buffer_load_dwordx4 v49, s[20:23], s49 offen offset:3072 lds
    v_mfma_f32_16x16x32_bf16 v[72:75], a[172:175], v[140:143], v[72:75]
    s_waitcnt lgkmcnt(8)
    ds_read_b64_tr_b16 a[212:213], v22 offset:8192
    ds_read_b64_tr_b16 a[214:215], v22 offset:12288
    v_mfma_f32_16x16x32_bf16 v[72:75], a[176:179], v[144:147], v[72:75]
    s_waitcnt lgkmcnt(8)
    ds_read_b64_tr_b16 a[216:217], v22 offset:16384
    v_mfma_f32_16x16x32_bf16 v[72:75], a[180:183], v[148:151], v[72:75]
    s_waitcnt lgkmcnt(7)
    ds_read_b64_tr_b16 a[218:219], v22 offset:20480
    v_mfma_f32_16x16x32_bf16 v[72:75], a[184:187], v[152:155], v[72:75]
    s_waitcnt lgkmcnt(6)
    ds_read_b64_tr_b16 a[220:221], v22 offset:24576
    v_mfma_f32_16x16x32_bf16 v[72:75], a[188:191], v[156:159], v[72:75]
    ds_read_b64_tr_b16 a[222:223], v22 offset:28672
    v_mfma_f32_16x16x32_bf16 v[76:79], a[160:163], v[160:163], 0
    buffer_load_dwordx2 v[38:39], v4, s[12:15], 0 offen offset:32
    v_mfma_f32_16x16x32_bf16 v[76:79], a[164:167], v[164:167], v[76:79]
    ds_read_b64_tr_b16 a[224:225], v26 offset:0
    ds_read_b64_tr_b16 a[226:227], v26 offset:4096
    v_mfma_f32_16x16x32_bf16 v[76:79], a[168:171], v[168:171], v[76:79]
    ds_read_b64_tr_b16 a[228:229], v26 offset:8192
    v_mfma_f32_16x16x32_bf16 v[76:79], a[172:175], v[172:175], v[76:79]
    ds_read_b64_tr_b16 a[230:231], v26 offset:12288
    v_mfma_f32_16x16x32_bf16 v[76:79], a[176:179], v[176:179], v[76:79]
    ds_read_b64_tr_b16 a[232:233], v26 offset:16384
    v_mfma_f32_16x16x32_bf16 v[76:79], a[180:183], v[180:183], v[76:79]
Ltour10:
    s_cbranch_execz Ltour14
    ds_read_b64_tr_b16 a[234:235], v26 offset:20480
    v_mfma_f32_16x16x32_bf16 v[76:79], a[184:187], v[184:187], v[76:79]
    buffer_load_dword v63, v63, s[88:91], 0 offen sc1
    v_mfma_f32_16x16x32_bf16 v[76:79], a[188:191], v[188:191], v[76:79]
    s_waitcnt lgkmcnt(12)
    ds_read_b64_tr_b16 a[236:237], v26 offset:24576
    ds_read_b64_tr_b16 a[238:239], v26 offset:28672
    v_mfma_f32_16x16x32_bf16 v[80:83], a[208:211], v[128:131], 0
    s_waitcnt lgkmcnt(12)
    ds_read_b64_tr_b16 a[160:161], v23 offset:0
    v_mfma_f32_16x16x32_bf16 v[80:83], a[212:215], v[132:135], v[80:83]
    s_waitcnt lgkmcnt(11)
    ds_read_b64_tr_b16 a[162:163], v23 offset:4096
    v_mfma_f32_16x16x32_bf16 v[80:83], a[216:219], v[136:139], v[80:83]
    s_waitcnt lgkmcnt(10)
    buffer_load_dwordx2 v[40:41], v4, s[12:15], 0 offen offset:512
    v_mfma_f32_16x16x32_bf16 v[80:83], a[220:223], v[140:143], v[80:83]
    s_waitcnt lgkmcnt(8)
    ds_read_b64_tr_b16 a[164:165], v23 offset:8192
    ds_read_b64_tr_b16 a[166:167], v23 offset:12288
    v_mfma_f32_16x16x32_bf16 v[80:83], a[224:227], v[144:147], v[80:83]
    s_waitcnt lgkmcnt(8)
    ds_read_b64_tr_b16 a[168:169], v23 offset:16384
    v_mfma_f32_16x16x32_bf16 v[80:83], a[228:231], v[148:151], v[80:83]
    s_waitcnt lgkmcnt(7)
    ds_read_b64_tr_b16 a[170:171], v23 offset:20480
    v_mfma_f32_16x16x32_bf16 v[80:83], a[232:235], v[152:155], v[80:83]
    s_waitcnt lgkmcnt(6)
    ds_read_b64_tr_b16 a[172:173], v23 offset:24576
    v_mfma_f32_16x16x32_bf16 v[80:83], a[236:239], v[156:159], v[80:83]
    ds_read_b64_tr_b16 a[174:175], v23 offset:28672
    v_mfma_f32_16x16x32_bf16 v[84:87], a[208:211], v[160:163], 0
    ds_read_b64_tr_b16 a[176:177], v27 offset:0
    v_mfma_f32_16x16x32_bf16 v[84:87], a[212:215], v[164:167], v[84:87]
    ds_read_b64_tr_b16 a[178:179], v27 offset:4096
    v_mfma_f32_16x16x32_bf16 v[84:87], a[216:219], v[168:171], v[84:87]
    buffer_load_dwordx2 v[42:43], v4, s[12:15], 0 offen offset:544
    v_mfma_f32_16x16x32_bf16 v[84:87], a[220:223], v[172:175], v[84:87]
    ds_read_b64_tr_b16 a[180:181], v27 offset:8192
    ds_read_b64_tr_b16 a[182:183], v27 offset:12288
    v_mfma_f32_16x16x32_bf16 v[84:87], a[224:227], v[176:179], v[84:87]
    ds_read_b64_tr_b16 a[184:185], v27 offset:16384
    v_mfma_f32_16x16x32_bf16 v[84:87], a[228:231], v[180:183], v[84:87]
    ds_read_b64_tr_b16 a[186:187], v27 offset:20480
    v_mfma_f32_16x16x32_bf16 v[84:87], a[232:235], v[184:187], v[84:87]
    ds_read_b64_tr_b16 a[188:189], v27 offset:24576
    v_mfma_f32_16x16x32_bf16 v[84:87], a[236:239], v[188:191], v[84:87]
    s_waitcnt lgkmcnt(13)
    ds_read_b64_tr_b16 a[190:191], v27 offset:28672
    s_waitcnt vmcnt(17)
    s_barrier
    v_mfma_f32_16x16x32_bf16 v[88:91], a[160:163], v[128:131], 0
    s_waitcnt lgkmcnt(12)
    ds_read_b64_tr_b16 a[208:209], v12 offset:32768
    v_mfma_f32_16x16x32_bf16 v[88:91], a[164:167], v[132:135], v[88:91]
    s_waitcnt lgkmcnt(11)
    ds_read_b64_tr_b16 a[210:211], v12 offset:36864
    v_mfma_f32_16x16x32_bf16 v[88:91], a[168:171], v[136:139], v[88:91]
    s_waitcnt lgkmcnt(10)
    buffer_load_dwordx2 v[244:245], v58, s[12:15], 0 offen offset:1024
    v_mfma_f32_16x16x32_bf16 v[88:91], a[172:175], v[140:143], v[88:91]
    s_waitcnt lgkmcnt(8)
    ds_read_b64_tr_b16 a[212:213], v12 offset:40960
    ds_read_b64_tr_b16 a[214:215], v12 offset:45056
    v_mfma_f32_16x16x32_bf16 v[88:91], a[176:179], v[144:147], v[88:91]
    s_waitcnt lgkmcnt(8)
    ds_read_b64_tr_b16 a[216:217], v12 offset:49152
    v_mfma_f32_16x16x32_bf16 v[88:91], a[180:183], v[148:151], v[88:91]
    s_waitcnt lgkmcnt(7)
    ds_read_b64_tr_b16 a[218:219], v12 offset:53248
    v_mfma_f32_16x16x32_bf16 v[88:91], a[184:187], v[152:155], v[88:91]
    s_waitcnt lgkmcnt(6)
    s_add_u32 s49, s46, 768
    ds_read_b64_tr_b16 a[220:221], v12 offset:57344
    v_mfma_f32_16x16x32_bf16 v[88:91], a[188:191], v[156:159], v[88:91]
    s_add_u32 m0, s42, 0
    ds_read_b64_tr_b16 a[222:223], v12 offset:61440
    v_mfma_f32_16x16x32_bf16 v[92:95], a[160:163], v[160:163], 0
    buffer_load_dwordx4 v46, s[20:23], s49 offen lds
    v_mfma_f32_16x16x32_bf16 v[92:95], a[164:167], v[164:167], v[92:95]
    ds_read_b64_tr_b16 a[224:225], v16 offset:32768
    ds_read_b64_tr_b16 a[226:227], v16 offset:36864
    v_mfma_f32_16x16x32_bf16 v[92:95], a[168:171], v[168:171], v[92:95]
    buffer_load_dwordx4 v47, s[20:23], s49 offen offset:1024 lds
    v_mfma_f32_16x16x32_bf16 v[92:95], a[172:175], v[172:175], v[92:95]
    ds_read_b64_tr_b16 a[228:229], v16 offset:40960
    ds_read_b64_tr_b16 a[230:231], v16 offset:45056
    v_mfma_f32_16x16x32_bf16 v[92:95], a[176:179], v[176:179], v[92:95]
    ds_read_b64_tr_b16 a[232:233], v16 offset:49152
    v_mfma_f32_16x16x32_bf16 v[92:95], a[180:183], v[180:183], v[92:95]
    ds_read_b64_tr_b16 a[234:235], v16 offset:53248
    v_mfma_f32_16x16x32_bf16 v[92:95], a[184:187], v[184:187], v[92:95]
    buffer_load_dwordx2 v[246:247], v58, s[12:15], 0 offen offset:1056
    v_mfma_f32_16x16x32_bf16 v[92:95], a[188:191], v[188:191], v[92:95]
    s_waitcnt lgkmcnt(12)
    ds_read_b64_tr_b16 a[236:237], v16 offset:57344
    ds_read_b64_tr_b16 a[238:239], v16 offset:61440
    v_mfma_f32_16x16x32_bf16 v[64:67], a[208:211], a[64:67], v[64:67]
    s_waitcnt lgkmcnt(12)
    buffer_load_dwordx4 v48, s[20:23], s49 offen offset:2048 lds
    v_mfma_f32_16x16x32_bf16 v[64:67], a[212:215], a[68:71], v[64:67]
    s_waitcnt lgkmcnt(10)
    ds_read_b64_tr_b16 a[160:161], v13 offset:32768
    ds_read_b64_tr_b16 a[162:163], v13 offset:36864
    v_mfma_f32_16x16x32_bf16 v[64:67], a[216:219], a[72:75], v[64:67]
    s_waitcnt lgkmcnt(10)
    buffer_load_dwordx4 v49, s[20:23], s49 offen offset:3072 lds
    v_mfma_f32_16x16x32_bf16 v[64:67], a[220:223], a[76:79], v[64:67]
    s_waitcnt lgkmcnt(8)
    ds_read_b64_tr_b16 a[164:165], v13 offset:40960
    ds_read_b64_tr_b16 a[166:167], v13 offset:45056
    v_mfma_f32_16x16x32_bf16 v[64:67], a[224:227], a[80:83], v[64:67]
    s_waitcnt lgkmcnt(8)
    ds_read_b64_tr_b16 a[168:169], v13 offset:49152
    v_mfma_f32_16x16x32_bf16 v[64:67], a[228:231], a[84:87], v[64:67]
    s_waitcnt lgkmcnt(7)
    ds_read_b64_tr_b16 a[170:171], v13 offset:53248
    v_mfma_f32_16x16x32_bf16 v[64:67], a[232:235], a[88:91], v[64:67]
    s_waitcnt lgkmcnt(6)
    s_add_u32 s49, s46, 74496
    ds_read_b64_tr_b16 a[172:173], v13 offset:57344
    v_mfma_f32_16x16x32_bf16 v[64:67], a[236:239], a[92:95], v[64:67]
    s_add_u32 m0, s42, 16384
    ds_read_b64_tr_b16 a[174:175], v13 offset:61440
    v_mfma_f32_16x16x32_bf16 v[68:71], a[208:211], a[96:99], v[68:71]
    buffer_load_dwordx4 v46, s[20:23], s49 offen lds
    v_mfma_f32_16x16x32_bf16 v[68:71], a[212:215], a[100:103], v[68:71]
    ds_read_b64_tr_b16 a[176:177], v17 offset:32768
    ds_read_b64_tr_b16 a[178:179], v17 offset:36864
    v_mfma_f32_16x16x32_bf16 v[68:71], a[216:219], a[104:107], v[68:71]
    buffer_load_dwordx4 v47, s[20:23], s49 offen offset:1024 lds
    v_mfma_f32_16x16x32_bf16 v[68:71], a[220:223], a[108:111], v[68:71]
    ds_read_b64_tr_b16 a[180:181], v17 offset:40960
    ds_read_b64_tr_b16 a[182:183], v17 offset:45056
    v_mfma_f32_16x16x32_bf16 v[68:71], a[224:227], a[112:115], v[68:71]
    ds_read_b64_tr_b16 a[184:185], v17 offset:49152
    v_cvt_pk_bf16_f32 v224, v64, v65
    v_mfma_f32_16x16x32_bf16 v[68:71], a[228:231], a[116:119], v[68:71]
    ds_read_b64_tr_b16 a[186:187], v17 offset:53248
    v_cvt_pk_bf16_f32 v225, v66, v67
    v_mfma_f32_16x16x32_bf16 v[68:71], a[232:235], a[120:123], v[68:71]
    ds_read_b64_tr_b16 a[188:189], v17 offset:57344
    v_mfma_f32_16x16x32_bf16 v[68:71], a[236:239], a[124:127], v[68:71]
    s_waitcnt lgkmcnt(13)
    ds_read_b64_tr_b16 a[190:191], v17 offset:61440
    v_mfma_f32_16x16x32_bf16 v[72:75], a[160:163], a[64:67], v[72:75]
    s_waitcnt lgkmcnt(12)
    buffer_load_dwordx4 v48, s[20:23], s49 offen offset:2048 lds
    v_mfma_f32_16x16x32_bf16 v[72:75], a[164:167], a[68:71], v[72:75]
    s_waitcnt lgkmcnt(10)
    ds_read_b64_tr_b16 a[208:209], v14 offset:32768
    ds_read_b64_tr_b16 a[210:211], v14 offset:36864
    v_mfma_f32_16x16x32_bf16 v[72:75], a[168:171], a[72:75], v[72:75]
    s_waitcnt lgkmcnt(10)
    buffer_load_dwordx4 v49, s[20:23], s49 offen offset:3072 lds
    v_mfma_f32_16x16x32_bf16 v[72:75], a[172:175], a[76:79], v[72:75]
    s_waitcnt lgkmcnt(8)
    ds_read_b64_tr_b16 a[212:213], v14 offset:40960
    ds_read_b64_tr_b16 a[214:215], v14 offset:45056
    v_mfma_f32_16x16x32_bf16 v[72:75], a[176:179], a[80:83], v[72:75]
    s_waitcnt lgkmcnt(8)
    ds_read_b64_tr_b16 a[216:217], v14 offset:49152
    v_cvt_pk_bf16_f32 v228, v68, v69
    v_mfma_f32_16x16x32_bf16 v[72:75], a[180:183], a[84:87], v[72:75]
    s_waitcnt lgkmcnt(7)
    s_waitcnt vmcnt(19)
    ds_read_b64_tr_b16 a[218:219], v14 offset:53248
    v_cvt_pk_bf16_f32 v229, v70, v71
    v_mfma_f32_16x16x32_bf16 v[72:75], a[184:187], a[88:91], v[72:75]
    s_waitcnt lgkmcnt(6)
    s_and_b32 s42, s2, 7
    buffer_store_dword v10, v8, s[24:27], s92 offen sc1
    v_mfma_f32_16x16x32_bf16 v[72:75], a[188:191], a[92:95], v[72:75]
    s_mov_b64 s[20:21], s[52:53]
    s_add_u32 s92, s92, 4
    ds_read_b64_tr_b16 a[220:221], v14 offset:57344
    ds_read_b64_tr_b16 a[222:223], v14 offset:61440
    v_mfma_f32_16x16x32_bf16 v[76:79], a[160:163], a[96:99], v[76:79]
    s_mov_b32 s22, 1152
    ds_read_b64_tr_b16 a[224:225], v18 offset:32768
    s_waitcnt vmcnt(13)
    v_readfirstlane_b32 s37, v63
    v_mfma_f32_16x16x32_bf16 v[76:79], a[164:167], a[100:103], v[76:79]
    s_mov_b32 s23, 0x20000
    ds_read_b64_tr_b16 a[226:227], v18 offset:36864
    v_mfma_f32_16x16x32_bf16 v[76:79], a[168:171], a[104:107], v[76:79]
    ds_read_b64_tr_b16 a[228:229], v18 offset:40960
    s_cmp_lt_u32 s37, 256
    s_cbranch_scc1 Lattn_armwait
Lattn_armed:
    v_mfma_f32_16x16x32_bf16 v[76:79], a[172:175], a[108:111], v[76:79]
    ds_read_b64_tr_b16 a[230:231], v18 offset:45056
    v_mfma_f32_16x16x32_bf16 v[76:79], a[176:179], a[112:115], v[76:79]
    ds_read_b64_tr_b16 a[232:233], v18 offset:49152
    v_cvt_pk_bf16_f32 v226, v72, v73
    v_mfma_f32_16x16x32_bf16 v[76:79], a[180:183], a[116:119], v[76:79]
    s_add_u32 s38, s93, 1024
    ds_read_b64_tr_b16 a[234:235], v18 offset:53248
    v_cvt_pk_bf16_f32 v227, v74, v75
    v_mfma_f32_16x16x32_bf16 v[76:79], a[184:187], a[120:123], v[76:79]
    buffer_store_dwordx4 v[224:227], v56, s[28:31], s38 offen sc1
    v_mfma_f32_16x16x32_bf16 v[76:79], a[188:191], a[124:127], v[76:79]
    s_waitcnt lgkmcnt(12)
    s_mov_b32 s45, 18688
    ds_read_b64_tr_b16 a[236:237], v18 offset:57344
    ds_read_b64_tr_b16 a[238:239], v18 offset:61440
    v_mfma_f32_16x16x32_bf16 v[80:83], a[208:211], a[64:67], v[80:83]
    s_waitcnt lgkmcnt(12)
    buffer_load_dwordx4 v[192:195], v5, s[24:27], s45 offen offset:0 sc1
    v_mfma_f32_16x16x32_bf16 v[80:83], a[212:215], a[68:71], v[80:83]
    s_waitcnt lgkmcnt(10)
    ds_read_b64_tr_b16 a[160:161], v15 offset:32768
    ds_read_b64_tr_b16 a[162:163], v15 offset:36864
    v_mfma_f32_16x16x32_bf16 v[80:83], a[216:219], a[72:75], v[80:83]
    s_waitcnt lgkmcnt(10)
    ds_read_b64_tr_b16 a[164:165], v15 offset:40960
    v_mfma_f32_16x16x32_bf16 v[80:83], a[220:223], a[76:79], v[80:83]
    s_waitcnt lgkmcnt(9)
    ds_read_b64_tr_b16 a[166:167], v15 offset:45056
    v_mfma_f32_16x16x32_bf16 v[80:83], a[224:227], a[80:83], v[80:83]
    s_waitcnt lgkmcnt(8)
    ds_read_b64_tr_b16 a[168:169], v15 offset:49152
    v_cvt_pk_bf16_f32 v230, v76, v77
    v_mfma_f32_16x16x32_bf16 v[80:83], a[228:231], a[84:87], v[80:83]
    s_waitcnt lgkmcnt(7)
    s_add_u32 s38, s93, 164864
    ds_read_b64_tr_b16 a[170:171], v15 offset:53248
    v_cvt_pk_bf16_f32 v231, v78, v79
    v_mfma_f32_16x16x32_bf16 v[80:83], a[232:235], a[88:91], v[80:83]
    s_waitcnt lgkmcnt(6)
    buffer_store_dwordx4 v[228:231], v56, s[28:31], s38 offen sc1
    v_mfma_f32_16x16x32_bf16 v[80:83], a[236:239], a[92:95], v[80:83]
    ds_read_b64_tr_b16 a[172:173], v15 offset:57344
    ds_read_b64_tr_b16 a[174:175], v15 offset:61440
    v_mfma_f32_16x16x32_bf16 v[84:87], a[208:211], a[96:99], v[84:87]
    buffer_load_dwordx4 v[196:199], v5, s[24:27], s45 offen offset:512 sc1
    v_mfma_f32_16x16x32_bf16 v[84:87], a[212:215], a[100:103], v[84:87]
    ds_read_b64_tr_b16 a[176:177], v19 offset:32768
    ds_read_b64_tr_b16 a[178:179], v19 offset:36864
    v_mfma_f32_16x16x32_bf16 v[84:87], a[216:219], a[104:107], v[84:87]
    ds_read_b64_tr_b16 a[180:181], v19 offset:40960
    v_mfma_f32_16x16x32_bf16 v[84:87], a[220:223], a[108:111], v[84:87]
    ds_read_b64_tr_b16 a[182:183], v19 offset:45056
    v_mfma_f32_16x16x32_bf16 v[84:87], a[224:227], a[112:115], v[84:87]
    ds_read_b64_tr_b16 a[184:185], v19 offset:49152
    v_cvt_pk_bf16_f32 v232, v80, v81
    v_mfma_f32_16x16x32_bf16 v[84:87], a[228:231], a[116:119], v[84:87]
    ds_read_b64_tr_b16 a[186:187], v19 offset:53248
    v_cvt_pk_bf16_f32 v233, v82, v83
    v_mfma_f32_16x16x32_bf16 v[84:87], a[232:235], a[120:123], v[84:87]
    buffer_load_dwordx4 v[200:203], v59, s[24:27], s45 offen offset:1024 sc1
    v_mfma_f32_16x16x32_bf16 v[84:87], a[236:239], a[124:127], v[84:87]
    s_waitcnt lgkmcnt(12)
    ds_read_b64_tr_b16 a[188:189], v19 offset:57344
    ds_read_b64_tr_b16 a[190:191], v19 offset:61440
    s_barrier
    v_mfma_f32_16x16x32_bf16 v[88:91], a[160:163], a[64:67], v[88:91]
    s_waitcnt lgkmcnt(12)
    ds_read_b64_tr_b16 a[208:209], v20 offset:32768
    v_mfma_f32_16x16x32_bf16 v[88:91], a[164:167], a[68:71], v[88:91]
    s_waitcnt lgkmcnt(11)
    s_mov_b32 s45, 20992
    ds_read_b64_tr_b16 a[210:211], v20 offset:36864
    v_mfma_f32_16x16x32_bf16 v[88:91], a[168:171], a[72:75], v[88:91]
    s_waitcnt lgkmcnt(10)
    buffer_load_dwordx4 v[204:207], v5, s[24:27], s45 offen offset:0 sc1
    v_mfma_f32_16x16x32_bf16 v[88:91], a[172:175], a[76:79], v[88:91]
    s_waitcnt lgkmcnt(8)
    ds_read_b64_tr_b16 a[212:213], v20 offset:40960
    ds_read_b64_tr_b16 a[214:215], v20 offset:45056
    v_mfma_f32_16x16x32_bf16 v[88:91], a[176:179], a[80:83], v[88:91]
    s_waitcnt lgkmcnt(8)
    ds_read_b64_tr_b16 a[216:217], v20 offset:49152
    v_cvt_pk_bf16_f32 v236, v84, v85
    v_mfma_f32_16x16x32_bf16 v[88:91], a[180:183], a[84:87], v[88:91]
    s_waitcnt lgkmcnt(7)
    ds_read_b64_tr_b16 a[218:219], v20 offset:53248
    v_cvt_pk_bf16_f32 v237, v86, v87
    v_mfma_f32_16x16x32_bf16 v[88:91], a[184:187], a[88:91], v[88:91]
    s_waitcnt lgkmcnt(6)
    ds_read_b64_tr_b16 a[220:221], v20 offset:57344
    v_mfma_f32_16x16x32_bf16 v[88:91], a[188:191], a[92:95], v[88:91]
    ds_read_b64_tr_b16 a[222:223], v20 offset:61440
    v_mfma_f32_16x16x32_bf16 v[92:95], a[160:163], a[96:99], v[92:95]
    buffer_load_dwordx4 v[208:211], v5, s[24:27], s45 offen offset:512 sc1
    v_mfma_f32_16x16x32_bf16 v[92:95], a[164:167], a[100:103], v[92:95]
    ds_read_b64_tr_b16 a[224:225], v24 offset:32768
    ds_read_b64_tr_b16 a[226:227], v24 offset:36864
    v_mfma_f32_16x16x32_bf16 v[92:95], a[168:171], a[104:107], v[92:95]
    ds_read_b64_tr_b16 a[228:229], v24 offset:40960
    v_mfma_f32_16x16x32_bf16 v[92:95], a[172:175], a[108:111], v[92:95]
    ds_read_b64_tr_b16 a[230:231], v24 offset:45056
    v_mfma_f32_16x16x32_bf16 v[92:95], a[176:179], a[112:115], v[92:95]
    ds_read_b64_tr_b16 a[232:233], v24 offset:49152
    v_cvt_pk_bf16_f32 v234, v88, v89
    v_mfma_f32_16x16x32_bf16 v[92:95], a[180:183], a[116:119], v[92:95]
    s_add_u32 s38, s93, 1152
    ds_read_b64_tr_b16 a[234:235], v24 offset:53248
    v_cvt_pk_bf16_f32 v235, v90, v91
    v_mfma_f32_16x16x32_bf16 v[92:95], a[184:187], a[120:123], v[92:95]
    buffer_store_dwordx4 v[232:235], v56, s[28:31], s38 offen sc1
    v_mfma_f32_16x16x32_bf16 v[92:95], a[188:191], a[124:127], v[92:95]
    s_waitcnt lgkmcnt(12)
    ds_read_b64_tr_b16 a[236:237], v24 offset:57344
    ds_read_b64_tr_b16 a[238:239], v24 offset:61440
    v_mfma_f32_16x16x32_bf16 v[96:99], a[208:211], v[128:131], 0
    s_waitcnt lgkmcnt(12)
    buffer_load_dwordx4 v[212:215], v59, s[24:27], s45 offen offset:1024 sc1
    v_mfma_f32_16x16x32_bf16 v[96:99], a[212:215], v[132:135], v[96:99]
    s_waitcnt lgkmcnt(10)
    ds_read_b64_tr_b16 a[160:161], v21 offset:32768
    ds_read_b64_tr_b16 a[162:163], v21 offset:36864
    v_mfma_f32_16x16x32_bf16 v[96:99], a[216:219], v[136:139], v[96:99]
    s_waitcnt lgkmcnt(10)
    ds_read_b64_tr_b16 a[164:165], v21 offset:40960
    v_mfma_f32_16x16x32_bf16 v[96:99], a[220:223], v[140:143], v[96:99]
    s_waitcnt lgkmcnt(9)
    ds_read_b64_tr_b16 a[166:167], v21 offset:45056
    v_mfma_f32_16x16x32_bf16 v[96:99], a[224:227], v[144:147], v[96:99]
    s_waitcnt lgkmcnt(8)
    ds_read_b64_tr_b16 a[168:169], v21 offset:49152
    v_cvt_pk_bf16_f32 v238, v92, v93
    v_mfma_f32_16x16x32_bf16 v[96:99], a[228:231], v[148:151], v[96:99]
    s_waitcnt lgkmcnt(7)
    s_add_u32 s38, s93, 164992
    ds_read_b64_tr_b16 a[170:171], v21 offset:53248
    v_cvt_pk_bf16_f32 v239, v94, v95
    v_mfma_f32_16x16x32_bf16 v[96:99], a[232:235], v[152:155], v[96:99]
    s_waitcnt lgkmcnt(6)
    buffer_store_dwordx4 v[236:239], v56, s[28:31], s38 offen sc1
    v_mfma_f32_16x16x32_bf16 v[96:99], a[236:239], v[156:159], v[96:99]
    s_mov_b32 s45, 19840
    ds_read_b64_tr_b16 a[172:173], v21 offset:57344
    ds_read_b64_tr_b16 a[174:175], v21 offset:61440
    v_mfma_f32_16x16x32_bf16 v[100:103], a[208:211], v[160:163], 0
    buffer_load_dwordx4 v[64:67], v5, s[24:27], s45 offen offset:0 sc1
    v_mfma_f32_16x16x32_bf16 v[100:103], a[212:215], v[164:167], v[100:103]
    ds_read_b64_tr_b16 a[176:177], v25 offset:32768
    ds_read_b64_tr_b16 a[178:179], v25 offset:36864
    v_mfma_f32_16x16x32_bf16 v[100:103], a[216:219], v[168:171], v[100:103]
    ds_read_b64_tr_b16 a[180:181], v25 offset:40960
    v_mfma_f32_16x16x32_bf16 v[100:103], a[220:223], v[172:175], v[100:103]
    ds_read_b64_tr_b16 a[182:183], v25 offset:45056
    v_mfma_f32_16x16x32_bf16 v[100:103], a[224:227], v[176:179], v[100:103]
    buffer_load_dwordx4 v[68:71], v5, s[24:27], s45 offen offset:512 sc1
    v_mfma_f32_16x16x32_bf16 v[100:103], a[228:231], v[180:183], v[100:103]
    ds_read_b64_tr_b16 a[184:185], v25 offset:49152
    ds_read_b64_tr_b16 a[186:187], v25 offset:53248
    v_mfma_f32_16x16x32_bf16 v[100:103], a[232:235], v[184:187], v[100:103]
    ds_read_b64_tr_b16 a[188:189], v25 offset:57344
    v_mfma_f32_16x16x32_bf16 v[100:103], a[236:239], v[188:191], v[100:103]
    s_waitcnt lgkmcnt(13)
    ds_read_b64_tr_b16 a[190:191], v25 offset:61440
    v_mfma_f32_16x16x32_bf16 v[104:107], a[160:163], v[128:131], 0
    s_waitcnt lgkmcnt(12)
    ds_read_b64_tr_b16 a[208:209], v22 offset:32768
    v_mfma_f32_16x16x32_bf16 v[104:107], a[164:167], v[132:135], v[104:107]
    s_waitcnt lgkmcnt(11)
    ds_read_b64_tr_b16 a[210:211], v22 offset:36864
    v_mfma_f32_16x16x32_bf16 v[104:107], a[168:171], v[136:139], v[104:107]
    s_waitcnt lgkmcnt(10)
    buffer_load_dwordx4 v[72:75], v59, s[24:27], s45 offen offset:1024 sc1
    v_mfma_f32_16x16x32_bf16 v[104:107], a[172:175], v[140:143], v[104:107]
    s_waitcnt lgkmcnt(8)
    ds_read_b64_tr_b16 a[212:213], v22 offset:40960
    ds_read_b64_tr_b16 a[214:215], v22 offset:45056
    v_mfma_f32_16x16x32_bf16 v[104:107], a[176:179], v[144:147], v[104:107]
    s_waitcnt lgkmcnt(8)
    ds_read_b64_tr_b16 a[216:217], v22 offset:49152
    v_mfma_f32_16x16x32_bf16 v[104:107], a[180:183], v[148:151], v[104:107]
    s_waitcnt lgkmcnt(7)
    ds_read_b64_tr_b16 a[218:219], v22 offset:53248
    v_mfma_f32_16x16x32_bf16 v[104:107], a[184:187], v[152:155], v[104:107]
    s_waitcnt lgkmcnt(6)
    ds_read_b64_tr_b16 a[220:221], v22 offset:57344
    v_mfma_f32_16x16x32_bf16 v[104:107], a[188:191], v[156:159], v[104:107]
    ds_read_b64_tr_b16 a[222:223], v22 offset:61440
    v_mfma_f32_16x16x32_bf16 v[108:111], a[160:163], v[160:163], 0
    buffer_load_dwordx2 v[76:77], v3, s[20:23], 0 offen offset:0
    v_mfma_f32_16x16x32_bf16 v[108:111], a[164:167], v[164:167], v[108:111]
    ds_read_b64_tr_b16 a[224:225], v26 offset:32768
    ds_read_b64_tr_b16 a[226:227], v26 offset:36864
    v_mfma_f32_16x16x32_bf16 v[108:111], a[168:171], v[168:171], v[108:111]
    ds_read_b64_tr_b16 a[228:229], v26 offset:40960
    v_mfma_f32_16x16x32_bf16 v[108:111], a[172:175], v[172:175], v[108:111]
    ds_read_b64_tr_b16 a[230:231], v26 offset:45056
    v_mfma_f32_16x16x32_bf16 v[108:111], a[176:179], v[176:179], v[108:111]
    ds_read_b64_tr_b16 a[232:233], v26 offset:49152
    v_mfma_f32_16x16x32_bf16 v[108:111], a[180:183], v[180:183], v[108:111]
    ds_read_b64_tr_b16 a[234:235], v26 offset:53248
    v_mfma_f32_16x16x32_bf16 v[108:111], a[184:187], v[184:187], v[108:111]
    buffer_load_dwordx2 v[78:79], v3, s[20:23], 0 offen offset:32
    v_mfma_f32_16x16x32_bf16 v[108:111], a[188:191], v[188:191], v[108:111]
    s_waitcnt lgkmcnt(12)
    ds_read_b64_tr_b16 a[236:237], v26 offset:57344
    ds_read_b64_tr_b16 a[238:239], v26 offset:61440
    v_mfma_f32_16x16x32_bf16 v[112:115], a[208:211], v[128:131], 0
    s_waitcnt lgkmcnt(12)
    ds_read_b64_tr_b16 a[160:161], v23 offset:32768
    v_mfma_f32_16x16x32_bf16 v[112:115], a[212:215], v[132:135], v[112:115]
    s_waitcnt lgkmcnt(11)
    ds_read_b64_tr_b16 a[162:163], v23 offset:36864
    v_mfma_f32_16x16x32_bf16 v[112:115], a[216:219], v[136:139], v[112:115]
    s_waitcnt lgkmcnt(10)
    ds_read_b64_tr_b16 a[164:165], v23 offset:40960
    v_mfma_f32_16x16x32_bf16 v[112:115], a[220:223], v[140:143], v[112:115]
    s_waitcnt lgkmcnt(9)
    ds_read_b64_tr_b16 a[166:167], v23 offset:45056
    v_mfma_f32_16x16x32_bf16 v[112:115], a[224:227], v[144:147], v[112:115]
    s_waitcnt lgkmcnt(8)
    buffer_load_dwordx2 v[80:81], v3, s[20:23], 0 offen offset:512
    v_mfma_f32_16x16x32_bf16 v[112:115], a[228:231], v[148:151], v[112:115]
    s_waitcnt lgkmcnt(6)
    ds_read_b64_tr_b16 a[168:169], v23 offset:49152
    ds_read_b64_tr_b16 a[170:171], v23 offset:53248
    v_mfma_f32_16x16x32_bf16 v[112:115], a[232:235], v[152:155], v[112:115]
    s_waitcnt lgkmcnt(6)
    ds_read_b64_tr_b16 a[172:173], v23 offset:57344
    v_mfma_f32_16x16x32_bf16 v[112:115], a[236:239], v[156:159], v[112:115]
    ds_read_b64_tr_b16 a[174:175], v23 offset:61440
    v_mfma_f32_16x16x32_bf16 v[116:119], a[208:211], v[160:163], 0
    ds_read_b64_tr_b16 a[176:177], v27 offset:32768
    v_mfma_f32_16x16x32_bf16 v[116:119], a[212:215], v[164:167], v[116:119]
    ds_read_b64_tr_b16 a[178:179], v27 offset:36864
    v_mfma_f32_16x16x32_bf16 v[116:119], a[216:219], v[168:171], v[116:119]
    buffer_load_dwordx2 v[82:83], v3, s[20:23], 0 offen offset:544
    v_mfma_f32_16x16x32_bf16 v[116:119], a[220:223], v[172:175], v[116:119]
    ds_read_b64_tr_b16 a[180:181], v27 offset:40960
    ds_read_b64_tr_b16 a[182:183], v27 offset:45056
    v_mfma_f32_16x16x32_bf16 v[116:119], a[224:227], v[176:179], v[116:119]
    ds_read_b64_tr_b16 a[184:185], v27 offset:49152
    v_mfma_f32_16x16x32_bf16 v[116:119], a[228:231], v[180:183], v[116:119]
    ds_read_b64_tr_b16 a[186:187], v27 offset:53248
    v_mfma_f32_16x16x32_bf16 v[116:119], a[232:235], v[184:187], v[116:119]
    buffer_load_dwordx2 v[84:85], v55, s[20:23], 0 offen offset:1024
    v_mfma_f32_16x16x32_bf16 v[116:119], a[236:239], v[188:191], v[116:119]
    ds_read_b64_tr_b16 a[188:189], v27 offset:57344
    ds_read_b64_tr_b16 a[190:191], v27 offset:61440
    s_waitcnt vmcnt(19)
    s_waitcnt lgkmcnt(0)
    s_barrier
    v_mfma_f32_16x16x32_bf16 v[120:123], a[160:163], v[128:131], 0
    ds_read_b64_tr_b16 a[208:209], v12 offset:0
    v_mfma_f32_16x16x32_bf16 v[120:123], a[164:167], v[132:135], v[120:123]
    ds_read_b64_tr_b16 a[210:211], v12 offset:4096
    v_mfma_f32_16x16x32_bf16 v[120:123], a[168:171], v[136:139], v[120:123]
    ds_read_b64_tr_b16 a[212:213], v12 offset:8192
    v_mfma_f32_16x16x32_bf16 v[120:123], a[172:175], v[140:143], v[120:123]
    ds_read_b64_tr_b16 a[214:215], v12 offset:12288
    v_mfma_f32_16x16x32_bf16 v[120:123], a[176:179], v[144:147], v[120:123]
    buffer_load_dwordx2 v[86:87], v55, s[20:23], 0 offen offset:1056
    v_mfma_f32_16x16x32_bf16 v[120:123], a[180:183], v[148:151], v[120:123]
    ds_read_b64_tr_b16 a[216:217], v12 offset:16384
    ds_read_b64_tr_b16 a[218:219], v12 offset:20480
    v_mfma_f32_16x16x32_bf16 v[120:123], a[184:187], v[152:155], v[120:123]
    ds_read_b64_tr_b16 a[220:221], v12 offset:24576
    v_mfma_f32_16x16x32_bf16 v[120:123], a[188:191], v[156:159], v[120:123]
    ds_read_b64_tr_b16 a[222:223], v12 offset:28672
    v_mfma_f32_16x16x32_bf16 v[124:127], a[160:163], v[160:163], 0
    ds_read_b64_tr_b16 a[224:225], v16 offset:0
    v_mfma_f32_16x16x32_bf16 v[124:127], a[164:167], v[164:167], v[124:127]
    s_mov_b32 s45, 22144
    ds_read_b64_tr_b16 a[226:227], v16 offset:4096
    v_mfma_f32_16x16x32_bf16 v[124:127], a[168:171], v[168:171], v[124:127]
    buffer_load_dwordx4 v[216:219], v5, s[24:27], s45 offen offset:0 sc1
    v_mfma_f32_16x16x32_bf16 v[124:127], a[172:175], v[172:175], v[124:127]
    ds_read_b64_tr_b16 a[228:229], v16 offset:8192
    ds_read_b64_tr_b16 a[230:231], v16 offset:12288
    v_mfma_f32_16x16x32_bf16 v[124:127], a[176:179], v[176:179], v[124:127]
    ds_read_b64_tr_b16 a[232:233], v16 offset:16384
    v_mfma_f32_16x16x32_bf16 v[124:127], a[180:183], v[180:183], v[124:127]
    ds_read_b64_tr_b16 a[234:235], v16 offset:20480
    v_mfma_f32_16x16x32_bf16 v[124:127], a[184:187], v[184:187], v[124:127]
    ds_read_b64_tr_b16 a[236:237], v16 offset:24576
    v_mfma_f32_16x16x32_bf16 v[124:127], a[188:191], v[188:191], v[124:127]
    s_waitcnt lgkmcnt(13)
    ds_read_b64_tr_b16 a[238:239], v16 offset:28672
    v_mfma_f32_16x16x32_bf16 v[96:99], a[208:211], a[64:67], v[96:99]
    s_waitcnt lgkmcnt(12)
    buffer_load_dwordx4 v[220:223], v5, s[24:27], s45 offen offset:512 sc1
    v_mfma_f32_16x16x32_bf16 v[96:99], a[212:215], a[68:71], v[96:99]
    s_waitcnt lgkmcnt(10)
    ds_read_b64_tr_b16 a[160:161], v13 offset:0
    ds_read_b64_tr_b16 a[162:163], v13 offset:4096
    v_mfma_f32_16x16x32_bf16 v[96:99], a[216:219], a[72:75], v[96:99]
    s_waitcnt lgkmcnt(10)
    ds_read_b64_tr_b16 a[164:165], v13 offset:8192
    v_mfma_f32_16x16x32_bf16 v[96:99], a[220:223], a[76:79], v[96:99]
    s_waitcnt lgkmcnt(9)
    ds_read_b64_tr_b16 a[166:167], v13 offset:12288
    v_mfma_f32_16x16x32_bf16 v[96:99], a[224:227], a[80:83], v[96:99]
    s_waitcnt lgkmcnt(8)
    ds_read_b64_tr_b16 a[168:169], v13 offset:16384
    v_mfma_f32_16x16x32_bf16 v[96:99], a[228:231], a[84:87], v[96:99]
    s_waitcnt lgkmcnt(7)
    ds_read_b64_tr_b16 a[170:171], v13 offset:20480
    v_mfma_f32_16x16x32_bf16 v[96:99], a[232:235], a[88:91], v[96:99]
    s_waitcnt lgkmcnt(6)
    buffer_load_dwordx4 v[88:91], v59, s[24:27], s45 offen offset:1024 sc1
    v_mfma_f32_16x16x32_bf16 v[96:99], a[236:239], a[92:95], v[96:99]
    ds_read_b64_tr_b16 a[172:173], v13 offset:24576
    ds_read_b64_tr_b16 a[174:175], v13 offset:28672
    v_mfma_f32_16x16x32_bf16 v[100:103], a[208:211], a[96:99], v[100:103]
    buffer_load_dword v11, v9, s[24:27], s39 offen sc1
    v_mfma_f32_16x16x32_bf16 v[100:103], a[212:215], a[100:103], v[100:103]
    ds_read_b64_tr_b16 a[176:177], v17 offset:0
    ds_read_b64_tr_b16 a[178:179], v17 offset:4096
    v_mfma_f32_16x16x32_bf16 v[100:103], a[216:219], a[104:107], v[100:103]
    ds_read_b64_tr_b16 a[180:181], v17 offset:8192
    v_mfma_f32_16x16x32_bf16 v[100:103], a[220:223], a[108:111], v[100:103]
    ds_read_b64_tr_b16 a[182:183], v17 offset:12288
    v_mfma_f32_16x16x32_bf16 v[100:103], a[224:227], a[112:115], v[100:103]
    ds_read_b64_tr_b16 a[184:185], v17 offset:16384
    v_cvt_pk_bf16_f32 v224, v96, v97
    v_mfma_f32_16x16x32_bf16 v[100:103], a[228:231], a[116:119], v[100:103]
    ds_read_b64_tr_b16 a[186:187], v17 offset:20480
    v_cvt_pk_bf16_f32 v225, v98, v99
    v_mfma_f32_16x16x32_bf16 v[100:103], a[232:235], a[120:123], v[100:103]
    ds_read_b64_tr_b16 a[188:189], v17 offset:24576
    v_mfma_f32_16x16x32_bf16 v[100:103], a[236:239], a[124:127], v[100:103]
    s_waitcnt lgkmcnt(13)
    ds_read_b64_tr_b16 a[190:191], v17 offset:28672
    v_mfma_f32_16x16x32_bf16 v[104:107], a[160:163], a[64:67], v[104:107]
    s_waitcnt lgkmcnt(12)
    ds_read_b64_tr_b16 a[208:209], v14 offset:0
    v_mfma_f32_16x16x32_bf16 v[104:107], a[164:167], a[68:71], v[104:107]
    s_waitcnt lgkmcnt(11)
    ds_read_b64_tr_b16 a[210:211], v14 offset:4096
    v_mfma_f32_16x16x32_bf16 v[104:107], a[168:171], a[72:75], v[104:107]
    s_waitcnt lgkmcnt(10)
    ds_read_b64_tr_b16 a[212:213], v14 offset:8192
    v_mfma_f32_16x16x32_bf16 v[104:107], a[172:175], a[76:79], v[104:107]
    s_waitcnt lgkmcnt(9)
    ds_read_b64_tr_b16 a[214:215], v14 offset:12288
    v_mfma_f32_16x16x32_bf16 v[104:107], a[176:179], a[80:83], v[104:107]
    s_waitcnt lgkmcnt(8)
    ds_read_b64_tr_b16 a[216:217], v14 offset:16384
    v_cvt_pk_bf16_f32 v228, v100, v101
    v_mfma_f32_16x16x32_bf16 v[104:107], a[180:183], a[84:87], v[104:107]
    s_waitcnt lgkmcnt(7)
    ds_read_b64_tr_b16 a[218:219], v14 offset:20480
    v_cvt_pk_bf16_f32 v229, v102, v103
    v_mfma_f32_16x16x32_bf16 v[104:107], a[184:187], a[88:91], v[104:107]
    s_waitcnt lgkmcnt(6)
    ds_read_b64_tr_b16 a[220:221], v14 offset:24576
    v_mfma_f32_16x16x32_bf16 v[104:107], a[188:191], a[92:95], v[104:107]
    ds_read_b64_tr_b16 a[222:223], v14 offset:28672
    v_mfma_f32_16x16x32_bf16 v[108:111], a[160:163], a[96:99], v[108:111]
    ds_read_b64_tr_b16 a[224:225], v18 offset:0
    v_mfma_f32_16x16x32_bf16 v[108:111], a[164:167], a[100:103], v[108:111]
    ds_read_b64_tr_b16 a[226:227], v18 offset:4096
    v_mfma_f32_16x16x32_bf16 v[108:111], a[168:171], a[104:107], v[108:111]
    ds_read_b64_tr_b16 a[228:229], v18 offset:8192
    v_mfma_f32_16x16x32_bf16 v[108:111], a[172:175], a[108:111], v[108:111]
    ds_read_b64_tr_b16 a[230:231], v18 offset:12288
    v_mfma_f32_16x16x32_bf16 v[108:111], a[176:179], a[112:115], v[108:111]
    ds_read_b64_tr_b16 a[232:233], v18 offset:16384
    v_cvt_pk_bf16_f32 v226, v104, v105
    v_mfma_f32_16x16x32_bf16 v[108:111], a[180:183], a[116:119], v[108:111]
    s_add_u32 s38, s93, 1536
    ds_read_b64_tr_b16 a[234:235], v18 offset:20480
    v_cvt_pk_bf16_f32 v227, v106, v107
    v_mfma_f32_16x16x32_bf16 v[108:111], a[184:187], a[120:123], v[108:111]
Ltour11:
    s_cbranch_execz Ltour15
    buffer_store_dwordx4 v[224:227], v56, s[28:31], s38 offen sc1
    v_mfma_f32_16x16x32_bf16 v[108:111], a[188:191], a[124:127], v[108:111]
    s_waitcnt lgkmcnt(12)
    ds_read_b64_tr_b16 a[236:237], v18 offset:24576
    ds_read_b64_tr_b16 a[238:239], v18 offset:28672
    v_mfma_f32_16x16x32_bf16 v[112:115], a[208:211], a[64:67], v[112:115]
    s_waitcnt lgkmcnt(12)
    ds_read_b64_tr_b16 a[160:161], v15 offset:0
    v_mfma_f32_16x16x32_bf16 v[112:115], a[212:215], a[68:71], v[112:115]
    s_waitcnt lgkmcnt(11)
    ds_read_b64_tr_b16 a[162:163], v15 offset:4096
    v_mfma_f32_16x16x32_bf16 v[112:115], a[216:219], a[72:75], v[112:115]
    s_waitcnt lgkmcnt(10)
    ds_read_b64_tr_b16 a[164:165], v15 offset:8192
    v_mfma_f32_16x16x32_bf16 v[112:115], a[220:223], a[76:79], v[112:115]
    s_waitcnt lgkmcnt(9)
    ds_read_b64_tr_b16 a[166:167], v15 offset:12288
    v_mfma_f32_16x16x32_bf16 v[112:115], a[224:227], a[80:83], v[112:115]
    s_waitcnt lgkmcnt(8)
    ds_read_b64_tr_b16 a[168:169], v15 offset:16384
    v_cvt_pk_bf16_f32 v230, v108, v109
    v_mfma_f32_16x16x32_bf16 v[112:115], a[228:231], a[84:87], v[112:115]
    s_waitcnt lgkmcnt(7)
    s_add_u32 s38, s93, 165376
    ds_read_b64_tr_b16 a[170:171], v15 offset:20480
    v_cvt_pk_bf16_f32 v231, v110, v111
    v_mfma_f32_16x16x32_bf16 v[112:115], a[232:235], a[88:91], v[112:115]
    s_waitcnt lgkmcnt(6)
    buffer_store_dwordx4 v[228:231], v56, s[28:31], s38 offen sc1
    v_mfma_f32_16x16x32_bf16 v[112:115], a[236:239], a[92:95], v[112:115]
    ds_read_b64_tr_b16 a[172:173], v15 offset:24576
    ds_read_b64_tr_b16 a[174:175], v15 offset:28672
    v_mfma_f32_16x16x32_bf16 v[116:119], a[208:211], a[96:99], v[116:119]
    ds_read_b64_tr_b16 a[176:177], v19 offset:0
    v_mfma_f32_16x16x32_bf16 v[116:119], a[212:215], a[100:103], v[116:119]
    ds_read_b64_tr_b16 a[178:179], v19 offset:4096
    v_mfma_f32_16x16x32_bf16 v[116:119], a[216:219], a[104:107], v[116:119]
    ds_read_b64_tr_b16 a[180:181], v19 offset:8192
    v_mfma_f32_16x16x32_bf16 v[116:119], a[220:223], a[108:111], v[116:119]
    ds_read_b64_tr_b16 a[182:183], v19 offset:12288
    v_mfma_f32_16x16x32_bf16 v[116:119], a[224:227], a[112:115], v[116:119]
    ds_read_b64_tr_b16 a[184:185], v19 offset:16384
    v_cvt_pk_bf16_f32 v232, v112, v113
    v_mfma_f32_16x16x32_bf16 v[116:119], a[228:231], a[116:119], v[116:119]
    ds_read_b64_tr_b16 a[186:187], v19 offset:20480
    v_cvt_pk_bf16_f32 v233, v114, v115
    v_mfma_f32_16x16x32_bf16 v[116:119], a[232:235], a[120:123], v[116:119]
    ds_read_b64_tr_b16 a[188:189], v19 offset:24576
    v_mfma_f32_16x16x32_bf16 v[116:119], a[236:239], a[124:127], v[116:119]
    s_waitcnt lgkmcnt(13)
    ds_read_b64_tr_b16 a[190:191], v19 offset:28672
    v_mfma_f32_16x16x32_bf16 v[120:123], a[160:163], a[64:67], v[120:123]
    s_waitcnt lgkmcnt(12)
    v_mfma_f32_16x16x32_bf16 v[120:123], a[164:167], a[68:71], v[120:123]
    s_waitcnt lgkmcnt(10)
    v_mfma_f32_16x16x32_bf16 v[120:123], a[168:171], a[72:75], v[120:123]
    s_waitcnt lgkmcnt(8)
    v_mfma_f32_16x16x32_bf16 v[120:123], a[172:175], a[76:79], v[120:123]
    s_waitcnt lgkmcnt(6)
    v_mfma_f32_16x16x32_bf16 v[120:123], a[176:179], a[80:83], v[120:123]
    s_waitcnt lgkmcnt(4)
    v_cvt_pk_bf16_f32 v236, v116, v117
    v_mfma_f32_16x16x32_bf16 v[120:123], a[180:183], a[84:87], v[120:123]
    s_waitcnt lgkmcnt(2)
    v_cvt_pk_bf16_f32 v237, v118, v119
    v_mfma_f32_16x16x32_bf16 v[120:123], a[184:187], a[88:91], v[120:123]
    s_waitcnt lgkmcnt(0)
    v_mfma_f32_16x16x32_bf16 v[120:123], a[188:191], a[92:95], v[120:123]
    v_mfma_f32_16x16x32_bf16 v[124:127], a[160:163], a[96:99], v[124:127]
    v_mfma_f32_16x16x32_bf16 v[124:127], a[164:167], a[100:103], v[124:127]
    v_mfma_f32_16x16x32_bf16 v[124:127], a[168:171], a[104:107], v[124:127]
    v_mfma_f32_16x16x32_bf16 v[124:127], a[172:175], a[108:111], v[124:127]
    v_mfma_f32_16x16x32_bf16 v[124:127], a[176:179], a[112:115], v[124:127]
    s_nop 2
    v_cvt_pk_bf16_f32 v234, v120, v121
    v_mfma_f32_16x16x32_bf16 v[124:127], a[180:183], a[116:119], v[124:127]
    s_add_u32 s38, s93, 1664
    v_cvt_pk_bf16_f32 v235, v122, v123
    v_mfma_f32_16x16x32_bf16 v[124:127], a[184:187], a[120:123], v[124:127]
    buffer_store_dwordx4 v[232:235], v56, s[28:31], s38 offen sc1
    v_mfma_f32_16x16x32_bf16 v[124:127], a[188:191], a[124:127], v[124:127]
    s_nop 7
    v_cvt_pk_bf16_f32 v238, v124, v125
    s_add_u32 s38, s93, 165504
    v_cvt_pk_bf16_f32 v239, v126, v127
    buffer_store_dwordx4 v[236:239], v56, s[28:31], s38 offen sc1
    s_waitcnt vmcnt(16)
    v_lshlrev_b32 v144, 16, v64
    v_and_b32 v145, 0xffff0000, v64
    v_lshlrev_b32 v146, 16, v65
    v_and_b32 v147, 0xffff0000, v65
    v_lshlrev_b32 v148, 16, v66
    v_and_b32 v149, 0xffff0000, v66
    v_lshlrev_b32 v150, 16, v67
    v_and_b32 v151, 0xffff0000, v67
    s_waitcnt vmcnt(15)
    v_lshlrev_b32 v152, 16, v68
    v_and_b32 v153, 0xffff0000, v68
    v_lshlrev_b32 v154, 16, v69
    v_and_b32 v155, 0xffff0000, v69
    v_lshlrev_b32 v156, 16, v70
    v_and_b32 v157, 0xffff0000, v70
    v_lshlrev_b32 v158, 16, v71
    v_and_b32 v159, 0xffff0000, v71
    s_waitcnt vmcnt(14)
    v_lshlrev_b32 v160, 16, v72
    v_and_b32 v161, 0xffff0000, v72
    v_lshlrev_b32 v162, 16, v73
    v_and_b32 v163, 0xffff0000, v73
    v_lshlrev_b32 v164, 16, v74
    v_and_b32 v165, 0xffff0000, v74
    v_lshlrev_b32 v166, 16, v75
    v_and_b32 v167, 0xffff0000, v75
    s_waitcnt vmcnt(13)
    v_lshlrev_b32 v168, 16, v76
    v_and_b32 v169, 0xffff0000, v76
    v_lshlrev_b32 v170, 16, v77
    v_and_b32 v171, 0xffff0000, v77
    s_waitcnt vmcnt(12)
    v_lshlrev_b32 v172, 16, v78
    v_and_b32 v173, 0xffff0000, v78
    v_lshlrev_b32 v174, 16, v79
    v_and_b32 v175, 0xffff0000, v79
    s_waitcnt vmcnt(11)
    v_lshlrev_b32 v176, 16, v80
    v_and_b32 v177, 0xffff0000, v80
    v_lshlrev_b32 v178, 16, v81
    v_and_b32 v179, 0xffff0000, v81
    s_waitcnt vmcnt(10)
    v_lshlrev_b32 v180, 16, v82
    v_and_b32 v181, 0xffff0000, v82
    v_lshlrev_b32 v182, 16, v83
    v_and_b32 v183, 0xffff0000, v83
    s_waitcnt vmcnt(9)
    v_lshlrev_b32 v184, 16, v84
    v_and_b32 v185, 0xffff0000, v84
    v_lshlrev_b32 v186, 16, v85
    v_and_b32 v187, 0xffff0000, v85
    s_waitcnt vmcnt(8)
    v_lshlrev_b32 v188, 16, v86
    v_and_b32 v189, 0xffff0000, v86
    v_lshlrev_b32 v190, 16, v87
    v_and_b32 v191, 0xffff0000, v87
    v_lshlrev_b32 v12, 16, v36
    v_and_b32 v13, 0xffff0000, v36
    v_lshlrev_b32 v14, 16, v37
    v_and_b32 v15, 0xffff0000, v37
    v_lshlrev_b32 v16, 16, v38
    v_and_b32 v17, 0xffff0000, v38
    v_lshlrev_b32 v18, 16, v39
    v_and_b32 v19, 0xffff0000, v39
    v_lshlrev_b32 v20, 16, v40
    v_and_b32 v21, 0xffff0000, v40
    v_lshlrev_b32 v22, 16, v41
    v_and_b32 v23, 0xffff0000, v41
    v_lshlrev_b32 v24, 16, v42
    v_and_b32 v25, 0xffff0000, v42
    v_lshlrev_b32 v26, 16, v43
    v_and_b32 v27, 0xffff0000, v43
    v_lshlrev_b32 v28, 16, v244
    v_and_b32 v29, 0xffff0000, v244
    v_lshlrev_b32 v30, 16, v245
    v_and_b32 v31, 0xffff0000, v245
    v_lshlrev_b32 v32, 16, v246
    v_and_b32 v33, 0xffff0000, v246
    v_lshlrev_b32 v34, 16, v247
    v_and_b32 v35, 0xffff0000, v247
    v_lshlrev_b32 v96, 16, v192
    v_and_b32 v97, 0xffff0000, v192
    v_lshlrev_b32 v98, 16, v193
    v_and_b32 v99, 0xffff0000, v193
    v_lshlrev_b32 v100, 16, v194
    v_and_b32 v101, 0xffff0000, v194
    v_lshlrev_b32 v102, 16, v195
    v_and_b32 v103, 0xffff0000, v195
    v_lshlrev_b32 v104, 16, v196
    v_and_b32 v105, 0xffff0000, v196
    v_lshlrev_b32 v106, 16, v197
    v_and_b32 v107, 0xffff0000, v197
    v_lshlrev_b32 v108, 16, v198
    v_and_b32 v109, 0xffff0000, v198
    v_lshlrev_b32 v110, 16, v199
    v_and_b32 v111, 0xffff0000, v199
    v_lshlrev_b32 v112, 16, v200
    v_and_b32 v113, 0xffff0000, v200
    v_lshlrev_b32 v114, 16, v201
    v_and_b32 v115, 0xffff0000, v201
    v_lshlrev_b32 v116, 16, v202
    v_and_b32 v117, 0xffff0000, v202
    v_lshlrev_b32 v118, 16, v203
    v_and_b32 v119, 0xffff0000, v203
    v_mov_b32 v244, 0
    v_mov_b32 v245, 0
    s_waitcnt vmcnt(0)
    buffer_store_dword v10, v8, s[24:27], s92 offen sc1
    v_cmp_ne_u32 s[54:55], s95, v11
    s_cmp_lg_u64 s[54:55], 0
    s_cbranch_scc1 Ltail_spin1
Ltail_got1:
    s_add_u32 s39, s39, 4
    s_add_u32 s45, s44, 0
    buffer_load_dwordx4 a[0:3], v2, s[28:31], s45 offen offset:0 sc1
    buffer_load_dwordx4 a[4:7], v2, s[28:31], s45 offen offset:2048 sc1
    s_add_u32 s45, s44, 4096
    buffer_load_dwordx4 a[8:11], v2, s[28:31], s45 offen offset:0 sc1
    buffer_load_dwordx4 a[12:15], v2, s[28:31], s45 offen offset:2048 sc1
    s_add_u32 s45, s44, 8192
    buffer_load_dwordx4 a[16:19], v2, s[28:31], s45 offen offset:0 sc1
    buffer_load_dwordx4 a[20:23], v2, s[28:31], s45 offen offset:2048 sc1
    s_add_u32 s45, s44, 12288
    buffer_load_dwordx4 a[24:27], v2, s[28:31], s45 offen offset:0 sc1
    buffer_load_dwordx4 a[28:31], v2, s[28:31], s45 offen offset:2048 sc1
    ds_write_b128 v51, a[128:131] offset:0
    ds_write_b128 v51, a[132:135] offset:4096
    ds_write_b128 v51, a[136:139] offset:8192
    ds_write_b128 v51, a[140:143] offset:12288
    ds_write_b128 v51, a[144:147] offset:16384
    ds_write_b128 v51, a[148:151] offset:20480
    ds_write_b128 v51, a[152:155] offset:24576
    ds_write_b128 v51, a[156:159] offset:28672
    ds_write_b128 v51, a[240:243] offset:32768
    ds_write_b128 v255, a[244:247] offset:40960
    ds_write_b128 v255, a[248:251] offset:45056
    ds_write_b128 v255, a[252:255] offset:49152
    v_lshlrev_b32 v120, 16, v204
    v_and_b32 v121, 0xffff0000, v204
    v_lshlrev_b32 v122, 16, v205
    v_and_b32 v123, 0xffff0000, v205
    v_lshlrev_b32 v124, 16, v206
    v_and_b32 v125, 0xffff0000, v206
    v_lshlrev_b32 v126, 16, v207
    v_and_b32 v127, 0xffff0000, v207
    v_lshlrev_b32 v128, 16, v208
    v_and_b32 v129, 0xffff0000, v208
    v_lshlrev_b32 v130, 16, v209
    v_and_b32 v131, 0xffff0000, v209
    v_lshlrev_b32 v132, 16, v210
    v_and_b32 v133, 0xffff0000, v210
    v_lshlrev_b32 v134, 16, v211
    v_and_b32 v135, 0xffff0000, v211
    v_lshlrev_b32 v136, 16, v212
    v_and_b32 v137, 0xffff0000, v212
    v_lshlrev_b32 v138, 16, v213
    v_and_b32 v139, 0xffff0000, v213
    v_lshlrev_b32 v140, 16, v214
    v_and_b32 v141, 0xffff0000, v214
    v_lshlrev_b32 v142, 16, v215
    v_and_b32 v143, 0xffff0000, v215
    v_lshlrev_b32 v192, 16, v216
    v_and_b32 v193, 0xffff0000, v216
    v_lshlrev_b32 v194, 16, v217
    v_and_b32 v195, 0xffff0000, v217
    v_lshlrev_b32 v196, 16, v218
    v_and_b32 v197, 0xffff0000, v218
    v_lshlrev_b32 v198, 16, v219
    v_and_b32 v199, 0xffff0000, v219
    v_lshlrev_b32 v200, 16, v220
    v_and_b32 v201, 0xffff0000, v220
    v_lshlrev_b32 v202, 16, v221
    v_and_b32 v203, 0xffff0000, v221
    v_lshlrev_b32 v204, 16, v222
    v_and_b32 v205, 0xffff0000, v222
    v_lshlrev_b32 v206, 16, v223
    v_and_b32 v207, 0xffff0000, v223
    v_lshlrev_b32 v208, 16, v88
    v_and_b32 v209, 0xffff0000, v88
    v_lshlrev_b32 v210, 16, v89
    v_and_b32 v211, 0xffff0000, v89
    v_lshlrev_b32 v212, 16, v90
    v_and_b32 v213, 0xffff0000, v90
    v_lshlrev_b32 v214, 16, v91
    v_and_b32 v215, 0xffff0000, v91
    buffer_load_dword v11, v9, s[24:27], s39 offen sc1
    s_add_u32 s45, s44, 16384
    buffer_load_dwordx4 a[32:35], v54, s[28:31], s45 offen offset:0 sc1
    buffer_load_dwordx4 a[36:39], v54, s[28:31], s45 offen offset:1024 sc1
    buffer_load_dwordx4 a[40:43], v54, s[28:31], s45 offen offset:2048 sc1
    buffer_load_dwordx4 a[44:47], v54, s[28:31], s45 offen offset:3072 sc1
    s_waitcnt vmcnt(4)
    v_cmp_ne_u32 s[54:55], s95, v11
    s_cmp_lg_u64 s[54:55], 0
    s_cbranch_scc1 Ltail_spin2
Ltail_got2:
    s_add_u32 s39, s39, 4
    s_add_u32 s45, s44, 0
    buffer_load_dwordx4 a[64:67], v2, s[28:31], s45 offen offset:1024 sc1
    buffer_load_dwordx4 a[68:71], v2, s[28:31], s45 offen offset:3072 sc1
    s_add_u32 s45, s44, 4096
    buffer_load_dwordx4 a[72:75], v2, s[28:31], s45 offen offset:1024 sc1
    buffer_load_dwordx4 a[76:79], v2, s[28:31], s45 offen offset:3072 sc1
    s_add_u32 s45, s44, 8192
    buffer_load_dwordx4 a[80:83], v2, s[28:31], s45 offen offset:1024 sc1
    buffer_load_dwordx4 a[84:87], v2, s[28:31], s45 offen offset:3072 sc1
    s_add_u32 s45, s44, 12288
    buffer_load_dwordx4 a[88:91], v2, s[28:31], s45 offen offset:1024 sc1
    buffer_load_dwordx4 a[92:95], v2, s[28:31], s45 offen offset:3072 sc1
    v_mfma_f32_16x16x32_bf16 v[64:67], v[250:253], a[0:3], 0
    v_mfma_f32_16x16x32_bf16 v[68:71], v[248:251], a[0:3], 0
    v_mfma_f32_16x16x32_bf16 v[64:67], v[250:253], a[4:7], v[64:67]
    v_mfma_f32_16x16x32_bf16 v[68:71], v[248:251], a[4:7], v[68:71]
    v_mfma_f32_16x16x32_bf16 v[64:67], v[250:253], a[8:11], v[64:67]
    v_mfma_f32_16x16x32_bf16 v[68:71], v[248:251], a[8:11], v[68:71]
    v_mfma_f32_16x16x32_bf16 v[64:67], v[250:253], a[12:15], v[64:67]
    v_mfma_f32_16x16x32_bf16 v[68:71], v[248:251], a[12:15], v[68:71]
    v_mfma_f32_16x16x32_bf16 v[64:67], v[250:253], a[16:19], v[64:67]
    v_mfma_f32_16x16x32_bf16 v[68:71], v[248:251], a[16:19], v[68:71]
    v_mfma_f32_16x16x32_bf16 v[64:67], v[250:253], a[20:23], v[64:67]
    v_mfma_f32_16x16x32_bf16 v[68:71], v[248:251], a[20:23], v[68:71]
    v_mfma_f32_16x16x32_bf16 v[64:67], v[250:253], a[24:27], v[64:67]
    v_mfma_f32_16x16x32_bf16 v[68:71], v[248:251], a[24:27], v[68:71]
    v_mfma_f32_16x16x32_bf16 v[64:67], v[250:253], a[28:31], v[64:67]
    v_mfma_f32_16x16x32_bf16 v[68:71], v[248:251], a[28:31], v[68:71]
    s_waitcnt vmcnt(11)
    v_mfma_f32_16x16x32_bf16 v[80:83], v[242:245], a[32:35], 0
    v_mfma_f32_16x16x32_bf16 v[84:87], v[240:243], a[32:35], 0
    s_waitcnt vmcnt(10)
    v_mfma_f32_16x16x32_bf16 v[80:83], v[242:245], a[36:39], v[80:83]
    v_mfma_f32_16x16x32_bf16 v[84:87], v[240:243], a[36:39], v[84:87]
    s_waitcnt vmcnt(9)
    v_mfma_f32_16x16x32_bf16 v[80:83], v[242:245], a[40:43], v[80:83]
    v_mfma_f32_16x16x32_bf16 v[84:87], v[240:243], a[40:43], v[84:87]
    s_waitcnt vmcnt(8)
    v_mfma_f32_16x16x32_bf16 v[80:83], v[242:245], a[44:47], v[80:83]
    v_mfma_f32_16x16x32_bf16 v[84:87], v[240:243], a[44:47], v[84:87]
    s_waitcnt vmcnt(7)
    s_nop 5
    v_mov_b32_dpp v80, v80 row_ror:8 row_mask:0x4 bank_mask:0xf
    v_mov_b32_dpp v81, v81 row_ror:8 row_mask:0x4 bank_mask:0xf
    v_mov_b32_dpp v82, v82 row_ror:8 row_mask:0x4 bank_mask:0xf
    v_mov_b32_dpp v83, v83 row_ror:8 row_mask:0x4 bank_mask:0xf
    v_mov_b32_dpp v84, v84 row_ror:8 row_mask:0x4 bank_mask:0xf
    v_mov_b32_dpp v85, v85 row_ror:8 row_mask:0x4 bank_mask:0xf
    v_mov_b32_dpp v86, v86 row_ror:8 row_mask:0x4 bank_mask:0xf
    v_mov_b32_dpp v87, v87 row_ror:8 row_mask:0x4 bank_mask:0xf
    v_pk_fma_f32 v[12:13], v[96:97], v[64:65], v[12:13]
    v_pk_fma_f32 v[14:15], v[98:99], v[66:67], v[14:15]
    v_pk_fma_f32 v[16:17], v[100:101], v[68:69], v[16:17]
    v_pk_fma_f32 v[18:19], v[102:103], v[70:71], v[18:19]
    v_cvt_pk_bf16_f32 v36, v12, v13
    v_cvt_pk_bf16_f32 v37, v14, v15
    v_cvt_pk_bf16_f32 v38, v16, v17
    v_cvt_pk_bf16_f32 v39, v18, v19
    v_lshlrev_b32 v12, 16, v36
    v_and_b32 v13, 0xffff0000, v36
    v_lshlrev_b32 v14, 16, v37
    v_and_b32 v15, 0xffff0000, v37
    v_lshlrev_b32 v16, 16, v38
    v_and_b32 v17, 0xffff0000, v38
    v_lshlrev_b32 v18, 16, v39
    v_and_b32 v19, 0xffff0000, v39
    v_pk_add_f32 v[48:49], v[12:13], v[14:15]
    v_pk_add_f32 v[50:51], v[16:17], v[18:19]
    v_pk_fma_f32 v[28:29], v[112:113], v[80:81], v[28:29]
    v_pk_fma_f32 v[30:31], v[114:115], v[82:83], v[30:31]
    v_pk_fma_f32 v[32:33], v[116:117], v[84:85], v[32:33]
    v_pk_fma_f32 v[34:35], v[118:119], v[86:87], v[34:35]
    v_cvt_pk_bf16_f32 v44, v28, v29
    v_cvt_pk_bf16_f32 v45, v30, v31
    v_cvt_pk_bf16_f32 v46, v32, v33
    v_cvt_pk_bf16_f32 v47, v34, v35
    v_lshlrev_b32 v28, 16, v44
    v_and_b32 v29, 0xffff0000, v44
    v_lshlrev_b32 v30, 16, v45
    v_and_b32 v31, 0xffff0000, v45
    v_lshlrev_b32 v32, 16, v46
    v_and_b32 v33, 0xffff0000, v46
    v_lshlrev_b32 v34, 16, v47
    v_and_b32 v35, 0xffff0000, v47
    v_pk_add_f32 v[48:49], v[48:49], v[28:29]
    v_pk_add_f32 v[50:51], v[50:51], v[30:31]
    v_pk_add_f32 v[48:49], v[48:49], v[32:33]
    v_pk_add_f32 v[50:51], v[50:51], v[34:35]
    v_mfma_f32_16x16x32_bf16 v[72:75], v[250:253], a[64:67], 0
    v_mfma_f32_16x16x32_bf16 v[76:79], v[248:251], a[64:67], 0
    s_waitcnt vmcnt(6)
    v_mfma_f32_16x16x32_bf16 v[72:75], v[250:253], a[68:71], v[72:75]
    v_mfma_f32_16x16x32_bf16 v[76:79], v[248:251], a[68:71], v[76:79]
    s_waitcnt vmcnt(5)
    v_mfma_f32_16x16x32_bf16 v[72:75], v[250:253], a[72:75], v[72:75]
    v_mfma_f32_16x16x32_bf16 v[76:79], v[248:251], a[72:75], v[76:79]
    s_waitcnt vmcnt(4)
    v_mfma_f32_16x16x32_bf16 v[72:75], v[250:253], a[76:79], v[72:75]
    v_mfma_f32_16x16x32_bf16 v[76:79], v[248:251], a[76:79], v[76:79]
    s_waitcnt vmcnt(3)
    v_mfma_f32_16x16x32_bf16 v[72:75], v[250:253], a[80:83], v[72:75]
    v_mfma_f32_16x16x32_bf16 v[76:79], v[248:251], a[80:83], v[76:79]
    s_waitcnt vmcnt(2)
    v_mfma_f32_16x16x32_bf16 v[72:75], v[250:253], a[84:87], v[72:75]
    v_mfma_f32_16x16x32_bf16 v[76:79], v[248:251], a[84:87], v[76:79]
    s_waitcnt vmcnt(1)
    v_mfma_f32_16x16x32_bf16 v[72:75], v[250:253], a[88:91], v[72:75]
    v_mfma_f32_16x16x32_bf16 v[76:79], v[248:251], a[88:91], v[76:79]
    s_waitcnt vmcnt(0)
    v_mfma_f32_16x16x32_bf16 v[72:75], v[250:253], a[92:95], v[72:75]
    v_mfma_f32_16x16x32_bf16 v[76:79], v[248:251], a[92:95], v[76:79]
    s_nop 6
    v_pk_fma_f32 v[20:21], v[104:105], v[72:73], v[20:21]
    v_pk_fma_f32 v[22:23], v[106:107], v[74:75], v[22:23]
    v_pk_fma_f32 v[24:25], v[108:109], v[76:77], v[24:25]
    v_pk_fma_f32 v[26:27], v[110:111], v[78:79], v[26:27]
    v_cvt_pk_bf16_f32 v40, v20, v21
    v_cvt_pk_bf16_f32 v41, v22, v23
    v_cvt_pk_bf16_f32 v42, v24, v25
    v_cvt_pk_bf16_f32 v43, v26, v27
    v_lshlrev_b32 v20, 16, v40
    v_and_b32 v21, 0xffff0000, v40
    v_lshlrev_b32 v22, 16, v41
    v_and_b32 v23, 0xffff0000, v41
    v_lshlrev_b32 v24, 16, v42
    v_and_b32 v25, 0xffff0000, v42
    v_lshlrev_b32 v26, 16, v43
    v_and_b32 v27, 0xffff0000, v43
    v_pk_add_f32 v[48:49], v[48:49], v[20:21]
    v_pk_add_f32 v[50:51], v[50:51], v[22:23]
    v_pk_add_f32 v[48:49], v[48:49], v[24:25]
    v_pk_add_f32 v[50:51], v[50:51], v[26:27]
    v_pk_add_f32 v[48:49], v[48:49], v[50:51]
    v_add_f32 v48, v48, v49
    s_nop 1
    v_add_f32_dpp v48, v48, v48 row_ror:1 row_mask:0xf bank_mask:0xf
    s_nop 1
    v_add_f32_dpp v48, v48, v48 row_ror:2 row_mask:0xf bank_mask:0xf
    s_nop 1
    v_add_f32_dpp v48, v48, v48 row_ror:4 row_mask:0xf bank_mask:0xf
    s_nop 1
    v_add_f32_dpp v48, v48, v48 row_ror:8 row_mask:0xf bank_mask:0xf
    v_mov_b32 v52, v48
    s_nop 1
    v_permlane16_swap_b32 v48, v52
    s_nop 0
    v_add_f32 v48, v48, v52
    v_mul_f32 v48, 0x3ae38e39, v48
    v_pk_add_f32 v[216:217], v[12:13], v[48:49] op_sel_hi:[1,0] neg_lo:[0,1] neg_hi:[0,1]
    v_pk_add_f32 v[218:219], v[14:15], v[48:49] op_sel_hi:[1,0] neg_lo:[0,1] neg_hi:[0,1]
    v_pk_add_f32 v[220:221], v[16:17], v[48:49] op_sel_hi:[1,0] neg_lo:[0,1] neg_hi:[0,1]
    v_pk_add_f32 v[222:223], v[18:19], v[48:49] op_sel_hi:[1,0] neg_lo:[0,1] neg_hi:[0,1]
    v_pk_add_f32 v[224:225], v[20:21], v[48:49] op_sel_hi:[1,0] neg_lo:[0,1] neg_hi:[0,1]
    v_pk_add_f32 v[226:227], v[22:23], v[48:49] op_sel_hi:[1,0] neg_lo:[0,1] neg_hi:[0,1]
    v_pk_add_f32 v[228:229], v[24:25], v[48:49] op_sel_hi:[1,0] neg_lo:[0,1] neg_hi:[0,1]
    v_pk_add_f32 v[230:231], v[26:27], v[48:49] op_sel_hi:[1,0] neg_lo:[0,1] neg_hi:[0,1]
    v_pk_add_f32 v[232:233], v[28:29], v[48:49] op_sel_hi:[1,0] neg_lo:[0,1] neg_hi:[0,1]
    v_pk_add_f32 v[234:235], v[30:31], v[48:49] op_sel_hi:[1,0] neg_lo:[0,1] neg_hi:[0,1]
    v_pk_add_f32 v[236:237], v[32:33], v[48:49] op_sel_hi:[1,0] neg_lo:[0,1] neg_hi:[0,1]
    v_pk_add_f32 v[238:239], v[34:35], v[48:49] op_sel_hi:[1,0] neg_lo:[0,1] neg_hi:[0,1]
    v_pk_mul_f32 v[50:51], v[216:217], v[216:217]
    v_pk_mul_f32 v[52:53], v[224:225], v[224:225]
    v_pk_mul_f32 v[62:63], v[232:233], v[232:233]
    v_pk_fma_f32 v[50:51], v[218:219], v[218:219], v[50:51]
    v_pk_fma_f32 v[52:53], v[226:227], v[226:227], v[52:53]
    v_pk_fma_f32 v[62:63], v[234:235], v[234:235], v[62:63]
    v_pk_fma_f32 v[50:51], v[220:221], v[220:221], v[50:51]
    v_pk_fma_f32 v[52:53], v[228:229], v[228:229], v[52:53]
    v_pk_fma_f32 v[62:63], v[236:237], v[236:237], v[62:63]
    v_pk_fma_f32 v[50:51], v[222:223], v[222:223], v[50:51]
    v_pk_fma_f32 v[52:53], v[230:231], v[230:231], v[52:53]
    v_pk_fma_f32 v[62:63], v[238:239], v[238:239], v[62:63]
    v_pk_add_f32 v[50:51], v[50:51], v[52:53]
    v_add_f32 v62, v62, v63
    v_add_f32 v50, v50, v51
    v_cndmask_b32 v62, 0, v62, vcc
    v_add_f32 v50, v50, v62
    s_nop 1
    v_add_f32_dpp v50, v50, v50 row_ror:1 row_mask:0xf bank_mask:0xf
    s_nop 1
    v_add_f32_dpp v50, v50, v50 row_ror:2 row_mask:0xf bank_mask:0xf
    s_nop 1
    v_add_f32_dpp v50, v50, v50 row_ror:4 row_mask:0xf bank_mask:0xf
    s_nop 1
    v_add_f32_dpp v50, v50, v50 row_ror:8 row_mask:0xf bank_mask:0xf
    v_mov_b32 v52, v50
    s_nop 1
    v_permlane16_swap_b32 v50, v52
    s_nop 0
    v_add_f32 v50, v50, v52
    v_mul_f32 v50, 0x3ae38e39, v50
    v_cvt_pk_bf16_f32 v52, v48, v50
    v_and_b32 v50, 0xffff0000, v52
    v_lshlrev_b32 v52, 16, v52
    v_add_f32 v50, 0x3727c5ac, v50
    v_sub_f32 v48, v48, v52
    v_cvt_pk_bf16_f32 v50, v50, v50
    v_and_b32 v50, 0xffff0000, v50
    v_sqrt_f32 v50, v50
    s_nop 0
    v_cvt_pk_bf16_f32 v50, v50, v50
    v_and_b32 v50, 0xffff0000, v50
    v_rcp_f32 v50, v50
    s_mov_b32 s45, 2621440
    v_mul_f32 v48, v48, v50
    v_pk_fma_f32 v[216:217], v[216:217], v[50:51], v[48:49] op_sel_hi:[1,0,0]
    v_pk_fma_f32 v[218:219], v[218:219], v[50:51], v[48:49] op_sel_hi:[1,0,0]
    v_pk_fma_f32 v[220:221], v[220:221], v[50:51], v[48:49] op_sel_hi:[1,0,0]
    v_pk_fma_f32 v[222:223], v[222:223], v[50:51], v[48:49] op_sel_hi:[1,0,0]
    v_pk_fma_f32 v[224:225], v[224:225], v[50:51], v[48:49] op_sel_hi:[1,0,0]
    v_pk_fma_f32 v[226:227], v[226:227], v[50:51], v[48:49] op_sel_hi:[1,0,0]
    v_pk_fma_f32 v[228:229], v[228:229], v[50:51], v[48:49] op_sel_hi:[1,0,0]
    v_pk_fma_f32 v[230:231], v[230:231], v[50:51], v[48:49] op_sel_hi:[1,0,0]
    v_pk_fma_f32 v[232:233], v[232:233], v[50:51], v[48:49] op_sel_hi:[1,0,0]
    v_pk_fma_f32 v[234:235], v[234:235], v[50:51], v[48:49] op_sel_hi:[1,0,0]
    v_pk_fma_f32 v[236:237], v[236:237], v[50:51], v[48:49] op_sel_hi:[1,0,0]
    v_pk_fma_f32 v[238:239], v[238:239], v[50:51], v[48:49] op_sel_hi:[1,0,0]
    v_pk_fma_f32 v[216:217], v[216:217], v[120:121], v[144:145]
    v_pk_fma_f32 v[218:219], v[218:219], v[122:123], v[146:147]
    v_pk_fma_f32 v[220:221], v[220:221], v[124:125], v[148:149]
    v_pk_fma_f32 v[222:223], v[222:223], v[126:127], v[150:151]
    v_pk_fma_f32 v[224:225], v[224:225], v[128:129], v[152:153]
    v_pk_fma_f32 v[226:227], v[226:227], v[130:131], v[154:155]
    v_pk_fma_f32 v[228:229], v[228:229], v[132:133], v[156:157]
    v_pk_fma_f32 v[230:231], v[230:231], v[134:135], v[158:159]
    v_pk_fma_f32 v[232:233], v[232:233], v[136:137], v[160:161]
    v_pk_fma_f32 v[234:235], v[234:235], v[138:139], v[162:163]
    v_pk_fma_f32 v[236:237], v[236:237], v[140:141], v[164:165]
    v_pk_fma_f32 v[238:239], v[238:239], v[142:143], v[166:167]
    v_cvt_pk_bf16_f32 v64, v216, v217
    v_cvt_pk_bf16_f32 v65, v218, v219
    v_cvt_pk_bf16_f32 v66, v220, v221
    v_cvt_pk_bf16_f32 v67, v222, v223
    v_cvt_pk_bf16_f32 v68, v224, v225
    v_cvt_pk_bf16_f32 v69, v226, v227
    v_cvt_pk_bf16_f32 v70, v228, v229
    v_cvt_pk_bf16_f32 v71, v230, v231
    v_cvt_pk_bf16_f32 v72, v232, v233
    v_cvt_pk_bf16_f32 v73, v234, v235
    v_cvt_pk_bf16_f32 v74, v236, v237
    v_cvt_pk_bf16_f32 v75, v238, v239
    v_lshlrev_b32 v216, 16, v64
    v_and_b32 v217, 0xffff0000, v64
    v_lshlrev_b32 v218, 16, v65
    v_and_b32 v219, 0xffff0000, v65
    v_lshlrev_b32 v220, 16, v66
    v_and_b32 v221, 0xffff0000, v66
    v_lshlrev_b32 v222, 16, v67
    v_and_b32 v223, 0xffff0000, v67
    v_lshlrev_b32 v224, 16, v68
    v_and_b32 v225, 0xffff0000, v68
    v_lshlrev_b32 v226, 16, v69
    v_and_b32 v227, 0xffff0000, v69
    v_lshlrev_b32 v228, 16, v70
    v_and_b32 v229, 0xffff0000, v70
    v_lshlrev_b32 v230, 16, v71
    v_and_b32 v231, 0xffff0000, v71
    v_lshlrev_b32 v232, 16, v72
    v_and_b32 v233, 0xffff0000, v72
    v_lshlrev_b32 v234, 16, v73
    v_and_b32 v235, 0xffff0000, v73
    v_lshlrev_b32 v236, 16, v74
    v_and_b32 v237, 0xffff0000, v74
    v_lshlrev_b32 v238, 16, v75
    v_and_b32 v239, 0xffff0000, v75
    v_pk_mul_f32 v[50:51], v[216:217], v[168:169]
    v_pk_mul_f32 v[52:53], v[224:225], v[176:177]
    v_pk_mul_f32 v[62:63], v[232:233], v[184:185]
    v_pk_fma_f32 v[50:51], v[218:219], v[170:171], v[50:51]
    v_pk_fma_f32 v[52:53], v[226:227], v[178:179], v[52:53]
    v_pk_fma_f32 v[62:63], v[234:235], v[186:187], v[62:63]
    v_pk_fma_f32 v[50:51], v[220:221], v[172:173], v[50:51]
    v_pk_fma_f32 v[52:53], v[228:229], v[180:181], v[52:53]
    v_pk_fma_f32 v[62:63], v[236:237], v[188:189], v[62:63]
    v_pk_fma_f32 v[50:51], v[222:223], v[174:175], v[50:51]
    v_pk_fma_f32 v[52:53], v[230:231], v[182:183], v[52:53]
    v_pk_fma_f32 v[62:63], v[238:239], v[190:191], v[62:63]
    v_pk_add_f32 v[50:51], v[50:51], v[52:53]
    v_add_f32 v62, v62, v63
    v_add_f32 v50, v50, v51
    v_add_f32 v50, v50, v62
    v_lshlrev_b32 v48, 2, v7
    v_and_b32 v48, 28, v48
    v_sub_u32 v49, 2047, v7
    v_add_f32_dpp v50, v50, v50 row_ror:1 row_mask:0xf bank_mask:0xf
    s_nop 1
    v_add_f32_dpp v50, v50, v50 row_ror:2 row_mask:0xf bank_mask:0xf
    s_nop 1
    v_add_f32_dpp v50, v50, v50 row_ror:4 row_mask:0xf bank_mask:0xf
    s_nop 1
    v_add_f32_dpp v50, v50, v50 row_ror:8 row_mask:0xf bank_mask:0xf
    v_mov_b32 v52, v50
    s_nop 1
    v_permlane16_swap_b32 v50, v52
    s_nop 0
    v_add_f32 v50, v50, v52
    v_ashrrev_i32 v52, 31, v50
    v_or_b32 v52, 0x80000000, v52
    v_xor_b32 v52, v52, v50
    v_and_b32 v52, 0xfffff800, v52
    v_min_u32 v52, 0xfffff000, v52
    v_or_b32 v52, v52, v49
    s_mov_b32 exec_lo, 1
    s_mov_b32 exec_hi, 1
    ds_write_b32 v48, v52 offset:36864
    s_mov_b64 exec, -1
    s_waitcnt lgkmcnt(0)
    s_barrier
    v_mov_b32 v141, 36864
    ds_read_b128 v[128:131], v141
    ds_read_b128 v[132:135], v141 offset:16
    s_lshl_b32 s45, s2, 7
    s_add_u32 s45, s45, 8912896
    s_cmp_eq_u32 s3, 0
    s_cselect_b32 s45, s45, 2147483648
    s_waitcnt lgkmcnt(1)
    v_max_u32 v136, v128, v129
    v_min_u32 v137, v128, v129
    v_med3_u32 v137, v136, v137, v130
    v_max_u32 v136, v136, v130
    v_med3_u32 v137, v136, v137, v131
    v_max_u32 v136, v136, v131
    s_waitcnt lgkmcnt(0)
    v_med3_u32 v137, v136, v137, v132
    v_max_u32 v136, v136, v132
    v_med3_u32 v137, v136, v137, v133
    v_max_u32 v136, v136, v133
    v_med3_u32 v137, v136, v137, v134
    v_max_u32 v136, v136, v134
    v_med3_u32 v137, v136, v137, v135
    v_max_u32 v136, v136, v135
    buffer_store_dwordx2 v[136:137], v8, s[24:27], s45 offen sc1
    v_and_b32 v138, 0x7ff, v136
    v_and_b32 v139, 0x7ff, v137
    v_cmp_eq_u32 vcc, v138, v49
    v_cmp_eq_u32 s[36:37], v139, v49
    v_mov_b32 v138, 2147483648
    s_or_b64 vcc, vcc, s[36:37]
    s_mov_b32 s45, 2621440
    s_nop 0
    v_cndmask_b32 v6, v138, v6, vcc
Ltour12:
    s_cbranch_execz Ltour16
    v_cndmask_b32 v60, v138, v60, vcc
    buffer_store_dwordx4 v[64:67], v6, s[24:27], s45 offen offset:0 sc1
    buffer_store_dwordx4 v[68:71], v6, s[24:27], s45 offen offset:512 sc1
    buffer_store_dwordx4 v[72:75], v60, s[24:27], s45 offen offset:1024 sc1
    buffer_store_dwordx4 v[36:39], v6, s[24:27], s45 offen offset:1152 sc1
    buffer_store_dwordx4 v[40:43], v6, s[24:27], s45 offen offset:1664 sc1
    buffer_store_dwordx4 v[44:47], v60, s[24:27], s45 offen offset:2176 sc1
    v_pk_mul_f32 v[192:193], v[192:193], v[216:217]
    v_pk_mul_f32 v[194:195], v[194:195], v[218:219]
    v_pk_mul_f32 v[196:197], v[196:197], v[220:221]
    v_pk_mul_f32 v[198:199], v[198:199], v[222:223]
    v_pk_mul_f32 v[200:201], v[200:201], v[224:225]
    v_pk_mul_f32 v[202:203], v[202:203], v[226:227]
    v_pk_mul_f32 v[204:205], v[204:205], v[228:229]
    v_pk_mul_f32 v[206:207], v[206:207], v[230:231]
    v_pk_mul_f32 v[208:209], v[208:209], v[232:233]
    v_pk_mul_f32 v[210:211], v[210:211], v[234:235]
    v_pk_mul_f32 v[212:213], v[212:213], v[236:237]
    v_pk_mul_f32 v[214:215], v[214:215], v[238:239]
    v_cvt_pk_bf16_f32 v144, v192, v193
    v_cvt_pk_bf16_f32 v145, v194, v195
    v_cvt_pk_bf16_f32 v146, v196, v197
    v_cvt_pk_bf16_f32 v147, v198, v199
    v_cvt_pk_bf16_f32 v148, v200, v201
    v_cvt_pk_bf16_f32 v149, v202, v203
    v_cvt_pk_bf16_f32 v150, v204, v205
    v_cvt_pk_bf16_f32 v151, v206, v207
    v_cvt_pk_bf16_f32 v152, v208, v209
    v_cvt_pk_bf16_f32 v153, v210, v211
    v_cvt_pk_bf16_f32 v154, v212, v213
    v_cvt_pk_bf16_f32 v155, v214, v215
    v_lshlrev_b32 v192, 16, v144
    v_and_b32 v193, 0xffff0000, v144
    v_lshlrev_b32 v194, 16, v145
    v_and_b32 v195, 0xffff0000, v145
    v_lshlrev_b32 v196, 16, v146
    v_and_b32 v197, 0xffff0000, v146
    v_lshlrev_b32 v198, 16, v147
    v_and_b32 v199, 0xffff0000, v147
    v_lshlrev_b32 v200, 16, v148
    v_and_b32 v201, 0xffff0000, v148
    v_lshlrev_b32 v202, 16, v149
    v_and_b32 v203, 0xffff0000, v149
    v_lshlrev_b32 v204, 16, v150
    v_and_b32 v205, 0xffff0000, v150
    v_lshlrev_b32 v206, 16, v151
    v_and_b32 v207, 0xffff0000, v151
    v_lshlrev_b32 v208, 16, v152
    v_and_b32 v209, 0xffff0000, v152
    v_lshlrev_b32 v210, 16, v153
    v_and_b32 v211, 0xffff0000, v153
    v_lshlrev_b32 v212, 16, v154
    v_and_b32 v213, 0xffff0000, v154
    v_lshlrev_b32 v214, 16, v155
    v_and_b32 v215, 0xffff0000, v155
    v_pk_add_f32 v[192:193], v[192:193], v[12:13]
    v_pk_add_f32 v[194:195], v[194:195], v[14:15]
    v_pk_add_f32 v[196:197], v[196:197], v[16:17]
    v_pk_add_f32 v[198:199], v[198:199], v[18:19]
    v_pk_add_f32 v[200:201], v[200:201], v[20:21]
    v_pk_add_f32 v[202:203], v[202:203], v[22:23]
    v_pk_add_f32 v[204:205], v[204:205], v[24:25]
    v_pk_add_f32 v[206:207], v[206:207], v[26:27]
    v_pk_add_f32 v[208:209], v[208:209], v[28:29]
    v_pk_add_f32 v[210:211], v[210:211], v[30:31]
    v_pk_add_f32 v[212:213], v[212:213], v[32:33]
    v_pk_add_f32 v[214:215], v[214:215], v[34:35]
    v_cvt_pk_bf16_f32 v156, v192, v193
    v_cvt_pk_bf16_f32 v157, v194, v195
    v_cvt_pk_bf16_f32 v158, v196, v197
    v_cvt_pk_bf16_f32 v159, v198, v199
    v_cvt_pk_bf16_f32 v160, v200, v201
    v_cvt_pk_bf16_f32 v161, v202, v203
    v_cvt_pk_bf16_f32 v162, v204, v205
    v_cvt_pk_bf16_f32 v163, v206, v207
    v_cvt_pk_bf16_f32 v164, v208, v209
    v_cvt_pk_bf16_f32 v165, v210, v211
    v_cvt_pk_bf16_f32 v166, v212, v213
    v_cvt_pk_bf16_f32 v167, v214, v215
    v_and_b32 v30, 2, v1
    v_cmp_ne_u32 vcc, 0, v30
    v_mul_u32_u24 v30, 1152, v7
    v_add_u32 v4, v30, v5
    v_add_u32 v58, v30, v59
    v_mov_b32_dpp v192, v158 quad_perm:[0,2,0,2] row_mask:0xf bank_mask:0xf
    v_mov_b32_dpp v193, v159 quad_perm:[0,2,0,2] row_mask:0xf bank_mask:0xf
    v_mov_b32_dpp v194, v158 quad_perm:[1,3,1,3] row_mask:0xf bank_mask:0xf
    v_mov_b32_dpp v195, v159 quad_perm:[1,3,1,3] row_mask:0xf bank_mask:0xf
    v_mov_b32_dpp v196, v162 quad_perm:[0,2,0,2] row_mask:0xf bank_mask:0xf
    v_mov_b32_dpp v197, v163 quad_perm:[0,2,0,2] row_mask:0xf bank_mask:0xf
    v_mov_b32_dpp v198, v162 quad_perm:[1,3,1,3] row_mask:0xf bank_mask:0xf
    v_mov_b32_dpp v199, v163 quad_perm:[1,3,1,3] row_mask:0xf bank_mask:0xf
    v_mov_b32_dpp v200, v166 quad_perm:[0,2,0,2] row_mask:0xf bank_mask:0xf
    v_mov_b32_dpp v201, v167 quad_perm:[0,2,0,2] row_mask:0xf bank_mask:0xf
    v_mov_b32_dpp v202, v166 quad_perm:[1,3,1,3] row_mask:0xf bank_mask:0xf
    v_mov_b32_dpp v203, v167 quad_perm:[1,3,1,3] row_mask:0xf bank_mask:0xf
    v_cndmask_b32_dpp v144, v156, v192, vcc quad_perm:[0,2,0,2] row_mask:0xf bank_mask:0xf
    v_cndmask_b32_dpp v145, v157, v193, vcc quad_perm:[0,2,0,2] row_mask:0xf bank_mask:0xf
    v_cndmask_b32_dpp v146, v156, v194, vcc quad_perm:[1,3,1,3] row_mask:0xf bank_mask:0xf
    v_cndmask_b32_dpp v147, v157, v195, vcc quad_perm:[1,3,1,3] row_mask:0xf bank_mask:0xf
    v_cndmask_b32_dpp v148, v160, v196, vcc quad_perm:[0,2,0,2] row_mask:0xf bank_mask:0xf
    v_cndmask_b32_dpp v149, v161, v197, vcc quad_perm:[0,2,0,2] row_mask:0xf bank_mask:0xf
    v_cndmask_b32_dpp v150, v160, v198, vcc quad_perm:[1,3,1,3] row_mask:0xf bank_mask:0xf
    v_cndmask_b32_dpp v151, v161, v199, vcc quad_perm:[1,3,1,3] row_mask:0xf bank_mask:0xf
    v_cndmask_b32_dpp v152, v164, v200, vcc quad_perm:[0,2,0,2] row_mask:0xf bank_mask:0xf
    v_cndmask_b32_dpp v153, v165, v201, vcc quad_perm:[0,2,0,2] row_mask:0xf bank_mask:0xf
    v_cndmask_b32_dpp v154, v164, v202, vcc quad_perm:[1,3,1,3] row_mask:0xf bank_mask:0xf
    v_cndmask_b32_dpp v155, v165, v203, vcc quad_perm:[1,3,1,3] row_mask:0xf bank_mask:0xf
    s_add_u32 s57, s59, 4096
    s_add_u32 m0, s6, -110592
    s_nop 0
    buffer_load_dwordx4 v255, s[84:87], s57 offen lds
    s_add_u32 s57, s59, 8192
    s_add_u32 m0, s6, -106496
    s_nop 0
    buffer_load_dwordx4 v255, s[84:87], s57 offen lds
    s_add_u32 s57, s59, 12288
    s_add_u32 m0, s6, -102400
    s_nop 0
    buffer_load_dwordx4 v255, s[84:87], s57 offen lds
    s_add_u32 s57, s59, 16384
    s_add_u32 m0, s6, -98304
    s_nop 0
    buffer_load_dwordx4 v255, s[84:87], s57 offen lds
    s_add_u32 s57, s59, 20480
    s_add_u32 m0, s6, -94208
    s_nop 0
    buffer_load_dwordx4 v255, s[84:87], s57 offen lds
    s_add_u32 s57, s59, 24576
    s_add_u32 m0, s6, -90112
    s_nop 0
    buffer_load_dwordx4 v255, s[84:87], s57 offen lds
    s_add_u32 s57, s59, 28672
    s_add_u32 m0, s6, -86016
    s_nop 0
    buffer_load_dwordx4 v255, s[84:87], s57 offen lds
    s_add_u32 s57, s59, 32768
    s_add_u32 m0, s6, -81920
    s_nop 0
    buffer_load_dwordx4 v255, s[84:87], s57 offen lds
    s_mov_b32 s38, 135168
    s_mov_b32 s39, 12288
    v_lshrrev_b32 v9, 2, v1
    v_and_b32 v10, 3, v1
    v_lshlrev_b32 v10, 3, v10
    s_and_b32 s45, s3, 1
    s_lshl_b32 s45, s45, 5
    v_lshl_add_u32 v11, v9, 6, v10
    v_add_u32 v11, s45, v11
    s_cmp_lt_u32 s3, 2
    s_cselect_b32 s44, 98304, s38
    s_cselect_b32 s45, 98304, s39
    v_add_u32 v12, s45, v11
    v_add_u32 v11, s44, v11
    ds_read_b64_tr_b16 a[0:1], v11 offset:0
    ds_read_b64_tr_b16 a[2:3], v11 offset:1024
    ds_read_b64_tr_b16 a[4:5], v11 offset:2048
    ds_read_b64_tr_b16 a[6:7], v11 offset:3072
    ds_read_b64_tr_b16 a[8:9], v11 offset:4096
    ds_read_b64_tr_b16 a[10:11], v11 offset:5120
    ds_read_b64_tr_b16 a[12:13], v11 offset:6144
    ds_read_b64_tr_b16 a[14:15], v11 offset:7168
    ds_read_b64_tr_b16 a[16:17], v11 offset:8192
    ds_read_b64_tr_b16 a[18:19], v11 offset:9216
    ds_read_b64_tr_b16 a[20:21], v11 offset:10240
    ds_read_b64_tr_b16 a[22:23], v11 offset:11264
    ds_read_b64_tr_b16 a[24:25], v11 offset:12288
    ds_read_b64_tr_b16 a[26:27], v11 offset:13312
    ds_read_b64_tr_b16 a[28:29], v11 offset:14336
    ds_read_b64_tr_b16 a[30:31], v11 offset:15360
    ds_read_b64_tr_b16 a[32:33], v11 offset:16384
    ds_read_b64_tr_b16 a[34:35], v11 offset:17408
    ds_read_b64_tr_b16 a[36:37], v11 offset:18432
    ds_read_b64_tr_b16 a[38:39], v11 offset:19456
    ds_read_b64_tr_b16 a[40:41], v11 offset:20480
    ds_read_b64_tr_b16 a[42:43], v11 offset:21504
    ds_read_b64_tr_b16 a[44:45], v11 offset:22528
    ds_read_b64_tr_b16 a[46:47], v11 offset:23552
    ds_read_b64_tr_b16 a[48:49], v11 offset:24576
    ds_read_b64_tr_b16 a[50:51], v11 offset:25600
    ds_read_b64_tr_b16 a[52:53], v11 offset:26624
    ds_read_b64_tr_b16 a[54:55], v11 offset:27648
    ds_read_b64_tr_b16 a[56:57], v12 offset:28672
    ds_read_b64_tr_b16 a[58:59], v12 offset:29696
    ds_read_b64_tr_b16 a[60:61], v12 offset:30720
    ds_read_b64_tr_b16 a[62:63], v12 offset:31744
    ds_read_b64_tr_b16 a[64:65], v12 offset:32768
    ds_read_b64_tr_b16 a[66:67], v12 offset:33792
    ds_read_b64_tr_b16 a[68:69], v12 offset:34816
    ds_read_b64_tr_b16 a[70:71], v12 offset:35840
    v_mul_u32_u24 v12, 1152, v9
    s_lshl_b32 s44, s3, 7
    s_add_u32 s44, s44, 49152
    v_add3_u32 v12, v12, v10, s44
    v_lshlrev_b32 v13, 4, v1
    v_add_u32 v13, 32768, v13
    s_lshl_b32 s44, s3, 10
    v_add_u32 v14, s44, v13
    v_and_b32 v13, 0xffffff1f, v13
    v_bfe_u32 v15, v1, 2, 2
    v_cmp_eq_u32 s[52:53], 0, v15
    v_cmp_eq_u32 s[54:55], 1, v15
    v_cmp_eq_u32 s[56:57], 2, v15
    v_cmp_eq_u32 s[58:59], 3, v15
    s_mul_i32 s43, s42, 18
    s_add_u32 s43, s43, s41
    s_lshl_b32 s43, s43, 9
    s_mul_i32 s44, s3, 73728
    s_add_u32 s43, s43, s44
    v_lshlrev_b32 v15, 3, v1
    v_lshlrev_b32 v140, 7, v0
    s_mov_b32 s45, 8912896
    s_lshl_b32 s36, s3, 3
    v_mov_b32 v141, s36
    s_mov_b32 s48, 16384
Ltail_pollk:
    buffer_load_dwordx2 v[136:137], v140, s[24:27], s45 offen sc1
    s_sub_u32 s48, s48, 1
    s_cbranch_scc1 Ltail_gotk
    s_waitcnt vmcnt(0)
    v_max_u32 v138, v136, v137
    v_cmp_eq_u32 vcc, -1, v138
    s_cbranch_vccnz Ltail_pollk
Ltail_gotk:
    s_waitcnt vmcnt(0)
    v_mov_b32_dpp v138, v136 row_ror:1 row_mask:0xf bank_mask:0xf
    v_mov_b32_dpp v139, v137 row_ror:1 row_mask:0xf bank_mask:0xf
    v_min_u32 v142, v136, v138
    v_max_u32 v136, v136, v138
    v_max3_u32 v137, v142, v137, v139
    s_nop 0
    v_mov_b32_dpp v138, v136 row_ror:2 row_mask:0xf bank_mask:0xf
    v_mov_b32_dpp v139, v137 row_ror:2 row_mask:0xf bank_mask:0xf
    v_min_u32 v142, v136, v138
    v_max_u32 v136, v136, v138
    v_max3_u32 v137, v142, v137, v139
    s_nop 0
    v_mov_b32_dpp v138, v136 row_ror:4 row_mask:0xf bank_mask:0xf
    v_mov_b32_dpp v139, v137 row_ror:4 row_mask:0xf bank_mask:0xf
    v_min_u32 v142, v136, v138
    v_max_u32 v136, v136, v138
    v_max3_u32 v137, v142, v137, v139
    s_nop 0
    v_mov_b32_dpp v138, v136 row_ror:8 row_mask:0xf bank_mask:0xf
    v_mov_b32_dpp v139, v137 row_ror:8 row_mask:0xf bank_mask:0xf
    v_min_u32 v142, v136, v138
    v_max_u32 v136, v136, v138
    v_max3_u32 v137, v142, v137, v139
    v_mov_b32 v138, v136
    v_mov_b32 v139, v137
    s_nop 0
    v_permlane16_swap_b32 v136, v138
    v_permlane16_swap_b32 v137, v139
    v_min_u32 v142, v136, v138
    v_max_u32 v136, v136, v138
    v_max3_u32 v137, v142, v137, v139
    v_mov_b32 v138, v136
    v_mov_b32 v139, v137
    s_nop 0
    v_permlane32_swap_b32 v136, v138
    v_permlane32_swap_b32 v137, v139
    v_min_u32 v142, v136, v138
    v_max_u32 v136, v136, v138
    v_max3_u32 v137, v142, v137, v139
    ds_write_b64 v141, v[136:137] offset:36928
    v_mov_b32 v141, 36928
    s_waitcnt lgkmcnt(0)
    s_barrier
    ds_read_b128 v[128:131], v141
    ds_read_b128 v[132:135], v141 offset:16
    s_or_b32 s36, s2, s3
    s_cselect_b32 s45, -4, 24576
    s_add_u32 s36, s94, 1
    v_mov_b32 v138, s36
    buffer_store_dword v138, v8, s[24:27], s45 offen sc1
    s_waitcnt lgkmcnt(1)
    v_max_u32 v136, v128, v129
    v_min_u32 v137, v128, v129
    v_med3_u32 v137, v136, v137, v130
    v_max_u32 v136, v136, v130
    v_med3_u32 v137, v136, v137, v131
    v_max_u32 v136, v136, v131
    s_waitcnt lgkmcnt(0)
    v_med3_u32 v137, v136, v137, v132
    v_max_u32 v136, v136, v132
    v_med3_u32 v137, v136, v137, v133
    v_max_u32 v136, v136, v133
    v_med3_u32 v137, v136, v137, v134
    v_max_u32 v136, v136, v134
    v_med3_u32 v137, v136, v137, v135
    v_max_u32 v136, v136, v135
    s_nop 0
    v_readfirstlane_b32 s92, v136
    v_readfirstlane_b32 s93, v137
    s_andn2_b32 s46, 0x7ff, s92
    s_andn2_b32 s47, 0x7ff, s93
    s_cmp_ge_u32 s41, 18
    s_cbranch_scc1 Ltail_noffn
    s_mul_i32 s44, s46, 2304
    s_mul_i32 s45, s47, 2304
    s_sub_u32 s45, s45, s44
    v_and_b32 v8, 1, v1
    v_mul_lo_u32 v8, v8, s45
    v_and_b32 v9, 48, v1
    v_add3_u32 v8, v8, v9, s44
    s_mov_b32 s45, 2621440
    s_mov_b32 s48, 16384
Ltail_pollh:
    s_mov_b32 exec_lo, 0x30003
    s_mov_b32 exec_hi, 0x30003
    buffer_load_dwordx4 a[120:123], v8, s[24:27], s45 offen offset:0 sc1
    buffer_load_dwordx4 a[124:127], v8, s[24:27], s45 offen offset:64 sc1
    buffer_load_dwordx4 a[128:131], v8, s[24:27], s45 offen offset:128 sc1
    buffer_load_dwordx4 a[132:135], v8, s[24:27], s45 offen offset:192 sc1
    buffer_load_dwordx4 a[136:139], v8, s[24:27], s45 offen offset:256 sc1
    buffer_load_dwordx4 a[140:143], v8, s[24:27], s45 offen offset:320 sc1
    buffer_load_dwordx4 a[144:147], v8, s[24:27], s45 offen offset:384 sc1
    buffer_load_dwordx4 a[148:151], v8, s[24:27], s45 offen offset:448 sc1
    buffer_load_dwordx4 a[152:155], v8, s[24:27], s45 offen offset:512 sc1
    buffer_load_dwordx4 a[156:159], v8, s[24:27], s45 offen offset:576 sc1
    buffer_load_dwordx4 a[160:163], v8, s[24:27], s45 offen offset:640 sc1
    buffer_load_dwordx4 a[164:167], v8, s[24:27], s45 offen offset:704 sc1
    buffer_load_dwordx4 a[168:171], v8, s[24:27], s45 offen offset:768 sc1
    buffer_load_dwordx4 a[172:175], v8, s[24:27], s45 offen offset:832 sc1
    buffer_load_dwordx4 a[176:179], v8, s[24:27], s45 offen offset:896 sc1
    buffer_load_dwordx4 a[180:183], v8, s[24:27], s45 offen offset:960 sc1
    buffer_load_dwordx4 a[184:187], v8, s[24:27], s45 offen offset:1024 sc1
    buffer_load_dwordx4 a[188:191], v8, s[24:27], s45 offen offset:1088 sc1
    s_mov_b64 exec, -1
    ds_read_b64_tr_b16 a[72:73], v12 offset:0
    ds_read_b64_tr_b16 a[74:75], v12 offset:18432
    ds_read_b64_tr_b16 a[76:77], v12 offset:32
    ds_read_b64_tr_b16 a[78:79], v12 offset:18464
    ds_read_b64_tr_b16 a[80:81], v12 offset:64
    ds_read_b64_tr_b16 a[82:83], v12 offset:18496
    ds_read_b64_tr_b16 a[84:85], v12 offset:96
    ds_read_b64_tr_b16 a[86:87], v12 offset:18528
    ds_read_b64_tr_b16 a[88:89], v12 offset:512
    ds_read_b64_tr_b16 a[90:91], v12 offset:18944
    ds_read_b64_tr_b16 a[92:93], v12 offset:544
    ds_read_b64_tr_b16 a[94:95], v12 offset:18976
    ds_read_b64_tr_b16 a[96:97], v12 offset:576
    ds_read_b64_tr_b16 a[98:99], v12 offset:19008
    ds_read_b64_tr_b16 a[100:101], v12 offset:608
    ds_read_b64_tr_b16 a[102:103], v12 offset:19040
    ds_read_b64_tr_b16 a[104:105], v12 offset:1024
    ds_read_b64_tr_b16 a[106:107], v12 offset:19456
    ds_read_b64_tr_b16 a[108:109], v12 offset:1056
    ds_read_b64_tr_b16 a[110:111], v12 offset:19488
    ds_read_b64_tr_b16 a[112:113], v12 offset:1088
    ds_read_b64_tr_b16 a[114:115], v12 offset:19520
    ds_read_b64_tr_b16 a[116:117], v12 offset:1120
    ds_read_b64_tr_b16 a[118:119], v12 offset:19552
    s_waitcnt vmcnt(17)
    v_mfma_f32_16x16x32_bf16 v[16:19], a[0:3], a[120:123], 0
    s_waitcnt vmcnt(16)
    v_mfma_f32_16x16x32_bf16 v[20:23], a[4:7], a[124:127], 0
    s_waitcnt vmcnt(15)
    v_mfma_f32_16x16x32_bf16 v[16:19], a[8:11], a[128:131], v[16:19]
    s_waitcnt vmcnt(14)
    v_mfma_f32_16x16x32_bf16 v[20:23], a[12:15], a[132:135], v[20:23]
    s_waitcnt vmcnt(13)
    v_mfma_f32_16x16x32_bf16 v[16:19], a[16:19], a[136:139], v[16:19]
    s_waitcnt vmcnt(12)
    v_mfma_f32_16x16x32_bf16 v[20:23], a[20:23], a[140:143], v[20:23]
    s_waitcnt vmcnt(11)
    v_mfma_f32_16x16x32_bf16 v[16:19], a[24:27], a[144:147], v[16:19]
    s_waitcnt vmcnt(10)
    v_mfma_f32_16x16x32_bf16 v[20:23], a[28:31], a[148:151], v[20:23]
    s_waitcnt vmcnt(9)
    v_mfma_f32_16x16x32_bf16 v[16:19], a[32:35], a[152:155], v[16:19]
    s_waitcnt vmcnt(8)
    v_mfma_f32_16x16x32_bf16 v[20:23], a[36:39], a[156:159], v[20:23]
    s_waitcnt vmcnt(7)
    v_mfma_f32_16x16x32_bf16 v[16:19], a[40:43], a[160:163], v[16:19]
    s_waitcnt vmcnt(6)
    v_mfma_f32_16x16x32_bf16 v[20:23], a[44:47], a[164:167], v[20:23]
    s_waitcnt vmcnt(5)
    v_mfma_f32_16x16x32_bf16 v[16:19], a[48:51], a[168:171], v[16:19]
    s_waitcnt vmcnt(4)
    v_mfma_f32_16x16x32_bf16 v[20:23], a[52:55], a[172:175], v[20:23]
    s_waitcnt vmcnt(3)
    v_mfma_f32_16x16x32_bf16 v[16:19], a[56:59], a[176:179], v[16:19]
    s_waitcnt vmcnt(2)
    v_mfma_f32_16x16x32_bf16 v[20:23], a[60:63], a[180:183], v[20:23]
    s_waitcnt vmcnt(1)
    v_mfma_f32_16x16x32_bf16 v[16:19], a[64:67], a[184:187], v[16:19]
    s_waitcnt vmcnt(0)
    v_mfma_f32_16x16x32_bf16 v[20:23], a[68:71], a[188:191], v[20:23]
    s_sub_u32 s48, s48, 1
    s_nop 6
    v_pk_add_f32 v[16:17], v[16:17], v[20:21]
    v_pk_add_f32 v[18:19], v[18:19], v[22:23]
    s_cbranch_scc1 Ltail_goth
    v_cmp_u_f32 vcc, v16, v16
    s_and_b32 s36, vcc_lo, 3
    s_cbranch_scc1 Ltail_pollh
Ltail_goth:
    ds_write_b128 v14, v[16:19]
    s_waitcnt lgkmcnt(0)
    s_barrier
    ds_read_b128 v[16:19], v13 offset:0
    ds_read_b128 v[20:23], v13 offset:1024
    ds_read_b128 v[24:27], v13 offset:2048
    ds_read_b128 v[28:31], v13 offset:3072
    s_mov_b32 s36, 0xbfb8aa3b
    s_mov_b32 s37, 0xbfb8aa3b
    s_waitcnt lgkmcnt(3)
    v_cvt_pk_bf16_f32 v32, v16, v17
    v_cvt_pk_bf16_f32 v33, v18, v19
    s_waitcnt lgkmcnt(2)
    v_cvt_pk_bf16_f32 v34, v20, v21
    v_cvt_pk_bf16_f32 v35, v22, v23
    v_lshlrev_b32 v16, 16, v32
    v_and_b32 v17, 0xffff0000, v32
    v_lshlrev_b32 v18, 16, v33
    v_and_b32 v19, 0xffff0000, v33
    v_lshlrev_b32 v20, 16, v34
    v_and_b32 v21, 0xffff0000, v34
    v_lshlrev_b32 v22, 16, v35
    v_and_b32 v23, 0xffff0000, v35
    v_pk_mul_f32 v[32:33], v[16:17], s[36:37]
    v_pk_mul_f32 v[34:35], v[18:19], s[36:37]
    v_pk_mul_f32 v[36:37], v[20:21], s[36:37]
    v_pk_mul_f32 v[38:39], v[22:23], s[36:37]
    v_exp_f32 v32, v32
    v_exp_f32 v33, v33
    v_exp_f32 v34, v34
    v_exp_f32 v35, v35
    v_exp_f32 v36, v36
    v_exp_f32 v37, v37
    v_exp_f32 v38, v38
    v_exp_f32 v39, v39
    s_waitcnt lgkmcnt(1)
    v_cvt_pk_bf16_f32 v60, v24, v25
    v_cvt_pk_bf16_f32 v61, v26, v27
    s_waitcnt lgkmcnt(0)
    v_cvt_pk_bf16_f32 v62, v28, v29
    v_cvt_pk_bf16_f32 v63, v30, v31
    v_pk_add_f32 v[32:33], v[32:33], 1.0 op_sel_hi:[1,0]
    v_pk_add_f32 v[34:35], v[34:35], 1.0 op_sel_hi:[1,0]
    v_pk_add_f32 v[36:37], v[36:37], 1.0 op_sel_hi:[1,0]
    v_pk_add_f32 v[38:39], v[38:39], 1.0 op_sel_hi:[1,0]
    v_rcp_f32 v32, v32
    v_rcp_f32 v33, v33
    v_rcp_f32 v34, v34
    v_rcp_f32 v35, v35
    v_rcp_f32 v36, v36
    v_rcp_f32 v37, v37
    v_rcp_f32 v38, v38
    v_rcp_f32 v39, v39
    v_lshlrev_b32 v24, 16, v60
    v_and_b32 v25, 0xffff0000, v60
    v_lshlrev_b32 v26, 16, v61
    v_and_b32 v27, 0xffff0000, v61
    v_lshlrev_b32 v28, 16, v62
    v_and_b32 v29, 0xffff0000, v62
    v_lshlrev_b32 v30, 16, v63
    v_and_b32 v31, 0xffff0000, v63
    v_pk_mul_f32 v[16:17], v[16:17], v[32:33]
    v_pk_mul_f32 v[18:19], v[18:19], v[34:35]
    v_pk_mul_f32 v[20:21], v[20:21], v[36:37]
    v_pk_mul_f32 v[22:23], v[22:23], v[38:39]
    v_cvt_pk_bf16_f32 v32, v16, v17
    v_cvt_pk_bf16_f32 v33, v18, v19
    v_cvt_pk_bf16_f32 v34, v20, v21
    v_cvt_pk_bf16_f32 v35, v22, v23
    v_lshlrev_b32 v16, 16, v32
    v_and_b32 v17, 0xffff0000, v32
    v_lshlrev_b32 v18, 16, v33
    v_and_b32 v19, 0xffff0000, v33
    v_lshlrev_b32 v20, 16, v34
    v_and_b32 v21, 0xffff0000, v34
    v_lshlrev_b32 v22, 16, v35
    v_and_b32 v23, 0xffff0000, v35
    v_pk_mul_f32 v[16:17], v[16:17], v[24:25]
    v_pk_mul_f32 v[18:19], v[18:19], v[26:27]
    v_pk_mul_f32 v[20:21], v[20:21], v[28:29]
    v_pk_mul_f32 v[22:23], v[22:23], v[30:31]
    v_cvt_pk_bf16_f32 v32, v16, v17
    v_cvt_pk_bf16_f32 v33, v18, v19
    v_cvt_pk_bf16_f32 v34, v20, v21
    v_cvt_pk_bf16_f32 v35, v22, v23
    v_cndmask_b32 v64, 0, v32, s[52:53]
    v_cndmask_b32 v65, 0, v33, s[52:53]
    v_cndmask_b32 v66, 0, v34, s[52:53]
    v_cndmask_b32 v67, 0, v35, s[52:53]
    v_cndmask_b32 v68, 0, v32, s[54:55]
    v_cndmask_b32 v69, 0, v33, s[54:55]
    v_cndmask_b32 v70, 0, v34, s[54:55]
    v_cndmask_b32 v71, 0, v35, s[54:55]
    v_cndmask_b32 v72, 0, v32, s[56:57]
    v_cndmask_b32 v73, 0, v33, s[56:57]
    v_cndmask_b32 v74, 0, v34, s[56:57]
    v_cndmask_b32 v75, 0, v35, s[56:57]
    v_cndmask_b32 v76, 0, v32, s[58:59]
    v_cndmask_b32 v77, 0, v33, s[58:59]
    v_cndmask_b32 v78, 0, v34, s[58:59]
    v_cndmask_b32 v79, 0, v35, s[58:59]
    v_mfma_f32_16x16x32_bf16 v[16:19], v[64:67], a[72:75], 0
    v_mfma_f32_16x16x32_bf16 v[16:19], v[68:71], a[76:79], v[16:19]
    v_mfma_f32_16x16x32_bf16 v[16:19], v[72:75], a[80:83], v[16:19]
    v_mfma_f32_16x16x32_bf16 v[16:19], v[76:79], a[84:87], v[16:19]
    v_mfma_f32_16x16x32_bf16 v[20:23], v[64:67], a[88:91], 0
    v_mfma_f32_16x16x32_bf16 v[20:23], v[68:71], a[92:95], v[20:23]
    v_mfma_f32_16x16x32_bf16 v[20:23], v[72:75], a[96:99], v[20:23]
    v_mfma_f32_16x16x32_bf16 v[20:23], v[76:79], a[100:103], v[20:23]
    v_mfma_f32_16x16x32_bf16 v[24:27], v[64:67], a[104:107], 0
    v_mfma_f32_16x16x32_bf16 v[24:27], v[68:71], a[108:111], v[24:27]
    v_mfma_f32_16x16x32_bf16 v[24:27], v[72:75], a[112:115], v[24:27]
    v_mfma_f32_16x16x32_bf16 v[24:27], v[76:79], a[116:119], v[24:27]
    v_min_u32 v16, -2, v16
    v_min_u32 v17, -2, v17
    buffer_store_dwordx2 v[16:17], v15, s[8:11], s43 offen sc1
    s_add_u32 s43, s43, 294912
    v_min_u32 v20, -2, v20
    v_min_u32 v21, -2, v21
    buffer_store_dwordx2 v[20:21], v15, s[8:11], s43 offen sc1
    s_add_u32 s43, s43, 294912
    v_min_u32 v24, -2, v24
    v_min_u32 v25, -2, v25
    buffer_store_dwordx2 v[24:25], v15, s[8:11], s43 offen sc1
    v_cmp_ne_u32 vcc, s46, v7
    v_cmp_ne_u32 s[36:37], s47, v7
    v_mov_b32 v31, 2147483648
    s_and_b64 vcc, vcc, s[36:37]
    s_nop 1
    v_cndmask_b32 v30, v31, v58, vcc
    v_cndmask_b32 v31, v31, v4, vcc
    buffer_store_dwordx4 v[144:147], v31, s[16:19], 0 offen offset:0 nt
    buffer_store_dwordx4 v[148:151], v31, s[16:19], 0 offen offset:512 nt
    buffer_store_dwordx4 v[152:155], v30, s[16:19], 0 offen offset:1024 nt
    s_branch Ltail_done
Ltail_noffn:
Ltour13:
    s_cbranch_execz Ltour17
    s_cmp_lt_u32 s41, 27
    s_cselect_b32 s36, s3, 1
    s_cmp_eq_u32 s36, 0
    s_cbranch_scc1 Ltail_final
    v_cmp_ne_u32 vcc, s46, v7
    v_cmp_ne_u32 s[36:37], s47, v7
    v_mov_b32 v31, 2147483648
    s_and_b64 vcc, vcc, s[36:37]
    s_nop 1
    v_cndmask_b32 v30, v31, v58, vcc
    v_cndmask_b32 v31, v31, v4, vcc
    buffer_store_dwordx4 v[144:147], v31, s[16:19], 0 offen offset:0 nt
    buffer_store_dwordx4 v[148:151], v31, s[16:19], 0 offen offset:512 nt
    buffer_store_dwordx4 v[152:155], v30, s[16:19], 0 offen offset:1024 nt
    s_branch Ltail_done
Ltail_final:
Ltour14:
    s_cbranch_execz Lmain
    s_mul_i32 s43, s42, 9
    s_add_u32 s43, s43, s41
    s_sub_u32 s43, s43, 18
    v_bfe_u32 v8, v1, 2, 1
    v_cmp_eq_u32 vcc, 1, v8
    v_mov_b32 v9, s46
    v_mov_b32 v10, s47
    v_and_b32 v11, 3, v1
    v_cndmask_b32 v9, v9, v10, vcc
    s_lshr_b32 s44, s43, 2
    s_lshl_b32 s44, s44, 6
    s_and_b32 s45, s43, 1
    s_lshl_b32 s45, s45, 5
    s_add_u32 s44, s44, s45
    s_and_b32 s45, s43, 2
    s_lshl_b32 s45, s45, 2
    s_add_u32 s44, s44, s45
    v_lshrrev_b32 v12, 1, v11
    v_lshl_add_u32 v12, v12, 4, s44
    v_and_b32 v13, 1, v11
    v_lshl_add_u32 v12, v13, 2, v12
    v_mul_u32_u24 v13, 1152, v9
    v_lshl_add_u32 v14, v13, 1, v12
    v_add_u32 v15, 2621440, v14
    s_mov_b32 s45, 22144
    buffer_load_dword v18, v12, s[24:27], s45 offen sc1
    v_mov_b32 v19, s92
    v_mov_b32 v10, s93
    v_cndmask_b32 v19, v19, v10, vcc
    v_and_b32 v19, 0xfffff800, v19
    v_or_b32 v19, 0x400, v19
    v_ashrrev_i32 v10, 31, v19
    v_not_b32 v10, v10
    v_or_b32 v10, 0x80000000, v10
    v_xor_b32 v19, v19, v10
    s_lshl_b32 s45, s43, 4
    v_lshl_add_u32 v13, v11, 2, v13
    v_add_u32 v13, s45, v13
    v_lshrrev_b32 v14, 2, v1
    v_lshlrev_b32 v14, 9, v14
    v_lshl_add_u32 v14, v11, 4, v14
    s_lshr_b32 s44, s43, 3
    s_mul_i32 s44, s44, 73728
    s_and_b32 s45, s43, 7
    s_lshl_b32 s45, s45, 6
    s_add_u32 s44, s44, s45
    v_cmp_ne_u32 vcc, s46, v7
    v_cmp_ne_u32 s[36:37], s47, v7
    v_mov_b32 v31, 2147483648
    s_and_b64 vcc, vcc, s[36:37]
    s_nop 1
    v_cndmask_b32 v30, v31, v58, vcc
    v_cndmask_b32 v31, v31, v4, vcc
    buffer_store_dwordx4 v[144:147], v31, s[16:19], 0 offen offset:0 nt
    buffer_store_dwordx4 v[148:151], v31, s[16:19], 0 offen offset:512 nt
    buffer_store_dwordx4 v[152:155], v30, s[16:19], 0 offen offset:1024 nt
    v_cmp_eq_u32 s[36:37], 1, v8
    v_cvt_pk_bf16_f32 v19, v19, v19
    v_and_b32 v19, 0xffff0000, v19
    v_mul_f32 v19, 0xbfb8aa3b, v19
    v_exp_f32 v19, v19
    s_waitcnt vmcnt(3)
    v_lshlrev_b32 v24, 16, v18
    v_and_b32 v25, 0xffff0000, v18
    v_add_f32 v19, 1.0, v19
    v_rcp_f32 v19, v19
    s_mov_b32 s48, 16384
    v_cvt_pk_bf16_f32 v19, v19, v19
    v_and_b32 v19, 0xffff0000, v19
Ltail_polly:
    s_add_u32 s45, s44, 0
    buffer_load_dwordx4 v[64:67], v14, s[8:11], s45 offen sc1
    s_add_u32 s45, s44, 8192
    buffer_load_dwordx4 v[68:71], v14, s[8:11], s45 offen sc1
    s_add_u32 s45, s44, 16384
    buffer_load_dwordx4 v[72:75], v14, s[8:11], s45 offen sc1
    s_add_u32 s45, s44, 24576
    buffer_load_dwordx4 v[76:79], v14, s[8:11], s45 offen sc1
    s_add_u32 s45, s44, 32768
    buffer_load_dwordx4 v[80:83], v14, s[8:11], s45 offen sc1
Ltour15:
    s_cbranch_execz Lmain
    s_add_u32 s45, s44, 40960
    buffer_load_dwordx4 v[84:87], v14, s[8:11], s45 offen sc1
    s_add_u32 s45, s44, 49152
    buffer_load_dwordx4 v[88:91], v14, s[8:11], s45 offen sc1
    s_add_u32 s45, s44, 57344
    buffer_load_dwordx4 v[92:95], v14, s[8:11], s45 offen sc1
    s_add_u32 s45, s44, 65536
    buffer_load_dwordx4 v[96:99], v14, s[8:11], s45 offen sc1
    s_mov_b32 s45, 1152
    buffer_load_dword v16, v15, s[24:27], s45 offen sc1
    buffer_load_dword v17, v15, s[24:27], 0 offen sc1
    s_sub_u32 s48, s48, 1
    s_cbranch_scc1 Ltail_goty
    s_waitcnt vmcnt(10)
    v_max3_u32 v26, v64, v65, v66
    s_waitcnt vmcnt(9)
    v_max3_u32 v26, v26, v67, v68
    v_max3_u32 v26, v26, v69, v70
    s_waitcnt vmcnt(8)
    v_max3_u32 v26, v26, v71, v72
    v_max3_u32 v26, v26, v73, v74
    s_waitcnt vmcnt(7)
    v_max3_u32 v26, v26, v75, v76
    v_max3_u32 v26, v26, v77, v78
    s_waitcnt vmcnt(6)
    v_max3_u32 v26, v26, v79, v80
    v_max3_u32 v26, v26, v81, v82
    s_waitcnt vmcnt(5)
    v_max3_u32 v26, v26, v83, v84
    v_max3_u32 v26, v26, v85, v86
    s_waitcnt vmcnt(4)
    v_max3_u32 v26, v26, v87, v88
    v_max3_u32 v26, v26, v89, v90
    s_waitcnt vmcnt(3)
    v_max3_u32 v26, v26, v91, v92
    v_max3_u32 v26, v26, v93, v94
    s_waitcnt vmcnt(2)
    v_max3_u32 v26, v26, v95, v96
    v_max3_u32 v26, v26, v97, v98
    v_max_u32 v26, v26, v99
    s_waitcnt vmcnt(0)
    v_max3_u32 v26, v26, v16, v17
    v_cmp_eq_u32 vcc, -1, v26
    s_cbranch_vccnz Ltail_polly
Ltail_goty:
    s_waitcnt vmcnt(0) lgkmcnt(0)
    v_lshlrev_b32 v20, 16, v16
    v_and_b32 v21, 0xffff0000, v16
    v_lshlrev_b32 v22, 16, v17
    v_and_b32 v23, 0xffff0000, v17
    v_pk_add_f32 v[64:65], v[64:65], v[68:69]
    v_pk_add_f32 v[66:67], v[66:67], v[70:71]
    v_pk_add_f32 v[64:65], v[64:65], v[72:73]
    v_pk_add_f32 v[66:67], v[66:67], v[74:75]
    v_pk_add_f32 v[64:65], v[64:65], v[76:77]
    v_pk_add_f32 v[66:67], v[66:67], v[78:79]
    v_pk_add_f32 v[64:65], v[64:65], v[80:81]
    v_pk_add_f32 v[66:67], v[66:67], v[82:83]
    v_pk_add_f32 v[64:65], v[64:65], v[84:85]
    v_pk_add_f32 v[66:67], v[66:67], v[86:87]
    v_pk_add_f32 v[64:65], v[64:65], v[88:89]
    v_pk_add_f32 v[66:67], v[66:67], v[90:91]
    v_pk_add_f32 v[64:65], v[64:65], v[92:93]
    v_pk_add_f32 v[66:67], v[66:67], v[94:95]
    v_pk_add_f32 v[64:65], v[64:65], v[96:97]
    v_pk_add_f32 v[66:67], v[66:67], v[98:99]
    s_nop 0
    v_add_f32_dpp v64, v64, v64 row_ror:4 row_mask:0xf bank_mask:0xf
    v_add_f32_dpp v65, v65, v65 row_ror:4 row_mask:0xf bank_mask:0xf
    v_add_f32_dpp v66, v66, v66 row_ror:4 row_mask:0xf bank_mask:0xf
    v_add_f32_dpp v67, v67, v67 row_ror:4 row_mask:0xf bank_mask:0xf
    v_add_f32_dpp v64, v64, v64 row_ror:8 row_mask:0xf bank_mask:0xf
    v_add_f32_dpp v65, v65, v65 row_ror:8 row_mask:0xf bank_mask:0xf
    v_add_f32_dpp v66, v66, v66 row_ror:8 row_mask:0xf bank_mask:0xf
    v_add_f32_dpp v67, v67, v67 row_ror:8 row_mask:0xf bank_mask:0xf
    v_mov_b32 v68, v64
    v_mov_b32 v69, v65
    v_mov_b32 v70, v66
    v_mov_b32 v71, v67
    v_permlane16_swap_b32 v64, v68
    v_permlane16_swap_b32 v65, v69
    v_permlane16_swap_b32 v66, v70
    v_permlane16_swap_b32 v67, v71
    v_add_f32 v64, v64, v68
    v_add_f32 v65, v65, v69
    v_add_f32 v66, v66, v70
    v_add_f32 v67, v67, v71
    v_mov_b32 v68, v64
    v_mov_b32 v69, v65
    v_mov_b32 v70, v66
    v_mov_b32 v71, v67
    v_permlane32_swap_b32 v64, v68
    v_permlane32_swap_b32 v65, v69
    v_permlane32_swap_b32 v66, v70
    v_permlane32_swap_b32 v67, v71
    v_add_f32 v64, v64, v68
    v_add_f32 v65, v65, v69
    v_add_f32 v66, v66, v70
    v_add_f32 v67, v67, v71
    v_cndmask_b32 v26, v64, v65, s[36:37]
    v_cndmask_b32 v27, v66, v67, s[36:37]
    v_cvt_pk_bf16_f32 v28, v26, v27
    v_lshlrev_b32 v26, 16, v28
    v_and_b32 v27, 0xffff0000, v28
    v_mul_f32 v26, v26, v19
    v_mul_f32 v27, v27, v19
    v_cvt_pk_bf16_f32 v28, v26, v27
    v_lshlrev_b32 v26, 16, v28
    v_and_b32 v27, 0xffff0000, v28
    v_pk_add_f32 v[26:27], v[26:27], v[22:23]
    v_cvt_pk_bf16_f32 v28, v26, v27
    v_lshlrev_b32 v26, 16, v28
    v_and_b32 v27, 0xffff0000, v28
    v_pk_mul_f32 v[26:27], v[26:27], v[24:25]
    v_cvt_pk_bf16_f32 v28, v26, v27
    v_lshlrev_b32 v26, 16, v28
    v_and_b32 v27, 0xffff0000, v28
    v_pk_add_f32 v[26:27], v[26:27], v[20:21]
    v_cvt_pk_bf16_f32 v28, v26, v27
    s_mov_b64 exec, 0xff
    buffer_store_dword v28, v13, s[16:19], 0 offen nt
Ltail_done:
    s_endpgm
Lattn_wb:
    buffer_wbl2 sc1
    s_waitcnt vmcnt(0)
    s_branch Lattn_wbdone
Lattn_xspin:
    s_mov_b32 s37, 16384
Lattn_xloop:
    buffer_load_dword v11, v8, s[24:27], s54 offen offset:8 sc1
    s_waitcnt vmcnt(0)
    v_readfirstlane_b32 s36, v11
    s_sub_u32 s37, s37, 1
    s_cbranch_scc1 Lattn_xgot
    s_cmp_lg_u32 s36, s95
    s_cbranch_scc1 Lattn_xloop
    s_branch Lattn_xgot
Ltail_spin1:
Ltour16:
    s_cbranch_execz Lmain
    s_mov_b32 s48, 16384
Ltail_spinl1:
    buffer_load_dword v11, v9, s[24:27], s39 offen sc1
    s_waitcnt vmcnt(0)
    v_cmp_ne_u32 s[54:55], s95, v11
    s_sub_u32 s48, s48, 1
    s_cbranch_scc1 Ltail_got1
    s_cmp_lg_u64 s[54:55], 0
    s_cbranch_scc1 Ltail_spinl1
    s_branch Ltail_got1
Ltail_spin2:
Ltour17:
    s_cbranch_execz Lmain
    s_mov_b32 s48, 16384
Ltail_spinl2:
    buffer_load_dword v11, v9, s[24:27], s39 offen sc1
    s_waitcnt vmcnt(0)
    v_cmp_ne_u32 s[54:55], s95, v11
    s_sub_u32 s48, s48, 1
    s_cbranch_scc1 Ltail_got2
    s_cmp_lg_u64 s[54:55], 0
    s_cbranch_scc1 Ltail_spinl2
    s_branch Ltail_got2
Lattn_redo:
    v_xor_b32 v8, 64, v9
    v_xor_b32 v10, 64, v11
    s_waitcnt vmcnt(0) lgkmcnt(0)
    s_barrier
    v_mov_b32 v232, 0xff800000
    v_mov_b32 v233, 0xff800000
    v_mov_b32 v234, 0xff800000
    v_mov_b32 v235, 0xff800000
    s_mov_b32 s40, 0
    s_mov_b32 s48, -1
Lattn_redo_loop:
    s_add_u32 m0, s42, 0
    s_nop 0
    buffer_load_dwordx4 v36, s[8:11], s40 offen lds
    buffer_load_dwordx4 v37, s[8:11], s40 offen offset:1024 lds
    buffer_load_dwordx4 v38, s[8:11], s40 offen offset:2048 lds
    buffer_load_dwordx4 v39, s[8:11], s40 offen offset:3072 lds
    s_add_u32 s40, s40, 16384
    s_waitcnt vmcnt(0) lgkmcnt(0)
    s_barrier
    ds_read_b128 a[208:211], v8 offset:0
    ds_read_b128 a[212:215], v9 offset:0
    ds_read_b128 a[216:219], v10 offset:0
    ds_read_b128 a[220:223], v11 offset:0
    s_waitcnt lgkmcnt(3)
    v_mfma_f32_16x16x32_bf16 v[216:219], a[208:211], v[64:67], 0
    s_waitcnt lgkmcnt(2)
    v_mfma_f32_16x16x32_bf16 v[216:219], a[212:215], v[68:71], v[216:219]
    s_waitcnt lgkmcnt(1)
    v_mfma_f32_16x16x32_bf16 v[216:219], a[216:219], v[72:75], v[216:219]
    s_waitcnt lgkmcnt(0)
    v_mfma_f32_16x16x32_bf16 v[216:219], a[220:223], v[76:79], v[216:219]
    v_mfma_f32_16x16x32_bf16 v[220:223], a[208:211], v[80:83], 0
    v_mfma_f32_16x16x32_bf16 v[220:223], a[212:215], v[84:87], v[220:223]
    v_mfma_f32_16x16x32_bf16 v[220:223], a[216:219], v[88:91], v[220:223]
    v_mfma_f32_16x16x32_bf16 v[220:223], a[220:223], v[92:95], v[220:223]
    v_mfma_f32_16x16x32_bf16 v[224:227], a[208:211], v[96:99], 0
    v_mfma_f32_16x16x32_bf16 v[224:227], a[212:215], v[100:103], v[224:227]
    v_mfma_f32_16x16x32_bf16 v[224:227], a[216:219], v[104:107], v[224:227]
    v_mfma_f32_16x16x32_bf16 v[224:227], a[220:223], v[108:111], v[224:227]
    v_mfma_f32_16x16x32_bf16 v[228:231], a[208:211], v[112:115], 0
    v_mfma_f32_16x16x32_bf16 v[228:231], a[212:215], v[116:119], v[228:231]
    v_mfma_f32_16x16x32_bf16 v[228:231], a[216:219], v[120:123], v[228:231]
    v_mfma_f32_16x16x32_bf16 v[228:231], a[220:223], v[124:127], v[228:231]
    v_max3_f32 v232, v232, v216, v217
    v_max3_f32 v232, v232, v218, v219
    v_max3_f32 v233, v233, v220, v221
    v_max3_f32 v233, v233, v222, v223
    v_max3_f32 v234, v234, v224, v225
    v_max3_f32 v234, v234, v226, v227
    s_nop 1
    v_max3_f32 v235, v235, v228, v229
    v_max3_f32 v235, v235, v230, v231
    ds_read_b128 a[224:227], v8 offset:4096
    ds_read_b128 a[228:231], v9 offset:4096
    ds_read_b128 a[232:235], v10 offset:4096
    ds_read_b128 a[236:239], v11 offset:4096
    s_waitcnt lgkmcnt(3)
    v_mfma_f32_16x16x32_bf16 v[216:219], a[224:227], v[64:67], 0
    s_waitcnt lgkmcnt(2)
    v_mfma_f32_16x16x32_bf16 v[216:219], a[228:231], v[68:71], v[216:219]
    s_waitcnt lgkmcnt(1)
    v_mfma_f32_16x16x32_bf16 v[216:219], a[232:235], v[72:75], v[216:219]
    s_waitcnt lgkmcnt(0)
    v_mfma_f32_16x16x32_bf16 v[216:219], a[236:239], v[76:79], v[216:219]
    v_mfma_f32_16x16x32_bf16 v[220:223], a[224:227], v[80:83], 0
    v_mfma_f32_16x16x32_bf16 v[220:223], a[228:231], v[84:87], v[220:223]
    v_mfma_f32_16x16x32_bf16 v[220:223], a[232:235], v[88:91], v[220:223]
    v_mfma_f32_16x16x32_bf16 v[220:223], a[236:239], v[92:95], v[220:223]
    v_mfma_f32_16x16x32_bf16 v[224:227], a[224:227], v[96:99], 0
    v_mfma_f32_16x16x32_bf16 v[224:227], a[228:231], v[100:103], v[224:227]
    v_mfma_f32_16x16x32_bf16 v[224:227], a[232:235], v[104:107], v[224:227]
    v_mfma_f32_16x16x32_bf16 v[224:227], a[236:239], v[108:111], v[224:227]
    v_mfma_f32_16x16x32_bf16 v[228:231], a[224:227], v[112:115], 0
    v_mfma_f32_16x16x32_bf16 v[228:231], a[228:231], v[116:119], v[228:231]
    v_mfma_f32_16x16x32_bf16 v[228:231], a[232:235], v[120:123], v[228:231]
    v_mfma_f32_16x16x32_bf16 v[228:231], a[236:239], v[124:127], v[228:231]
    v_max3_f32 v232, v232, v216, v217
    v_max3_f32 v232, v232, v218, v219
    v_max3_f32 v233, v233, v220, v221
    v_max3_f32 v233, v233, v222, v223
    v_max3_f32 v234, v234, v224, v225
    v_max3_f32 v234, v234, v226, v227
    s_nop 1
    v_max3_f32 v235, v235, v228, v229
    v_max3_f32 v235, v235, v230, v231
    ds_read_b128 a[208:211], v8 offset:8192
    ds_read_b128 a[212:215], v9 offset:8192
    ds_read_b128 a[216:219], v10 offset:8192
    ds_read_b128 a[220:223], v11 offset:8192
    s_waitcnt lgkmcnt(3)
    v_mfma_f32_16x16x32_bf16 v[216:219], a[208:211], v[64:67], 0
    s_waitcnt lgkmcnt(2)
    v_mfma_f32_16x16x32_bf16 v[216:219], a[212:215], v[68:71], v[216:219]
    s_waitcnt lgkmcnt(1)
    v_mfma_f32_16x16x32_bf16 v[216:219], a[216:219], v[72:75], v[216:219]
    s_waitcnt lgkmcnt(0)
    v_mfma_f32_16x16x32_bf16 v[216:219], a[220:223], v[76:79], v[216:219]
    v_mfma_f32_16x16x32_bf16 v[220:223], a[208:211], v[80:83], 0
    v_mfma_f32_16x16x32_bf16 v[220:223], a[212:215], v[84:87], v[220:223]
    v_mfma_f32_16x16x32_bf16 v[220:223], a[216:219], v[88:91], v[220:223]
    v_mfma_f32_16x16x32_bf16 v[220:223], a[220:223], v[92:95], v[220:223]
    v_mfma_f32_16x16x32_bf16 v[224:227], a[208:211], v[96:99], 0
    v_mfma_f32_16x16x32_bf16 v[224:227], a[212:215], v[100:103], v[224:227]
    v_mfma_f32_16x16x32_bf16 v[224:227], a[216:219], v[104:107], v[224:227]
    v_mfma_f32_16x16x32_bf16 v[224:227], a[220:223], v[108:111], v[224:227]
    v_mfma_f32_16x16x32_bf16 v[228:231], a[208:211], v[112:115], 0
    v_mfma_f32_16x16x32_bf16 v[228:231], a[212:215], v[116:119], v[228:231]
    v_mfma_f32_16x16x32_bf16 v[228:231], a[216:219], v[120:123], v[228:231]
    v_mfma_f32_16x16x32_bf16 v[228:231], a[220:223], v[124:127], v[228:231]
    v_max3_f32 v232, v232, v216, v217
    v_max3_f32 v232, v232, v218, v219
    v_max3_f32 v233, v233, v220, v221
    v_max3_f32 v233, v233, v222, v223
    v_max3_f32 v234, v234, v224, v225
    v_max3_f32 v234, v234, v226, v227
    s_nop 1
    v_max3_f32 v235, v235, v228, v229
    v_max3_f32 v235, v235, v230, v231
    ds_read_b128 a[224:227], v8 offset:12288
    ds_read_b128 a[228:231], v9 offset:12288
    ds_read_b128 a[232:235], v10 offset:12288
    ds_read_b128 a[236:239], v11 offset:12288
    s_waitcnt lgkmcnt(3)
    v_mfma_f32_16x16x32_bf16 v[216:219], a[224:227], v[64:67], 0
    s_waitcnt lgkmcnt(2)
    v_mfma_f32_16x16x32_bf16 v[216:219], a[228:231], v[68:71], v[216:219]
    s_waitcnt lgkmcnt(1)
    v_mfma_f32_16x16x32_bf16 v[216:219], a[232:235], v[72:75], v[216:219]
    s_waitcnt lgkmcnt(0)
    v_mfma_f32_16x16x32_bf16 v[216:219], a[236:239], v[76:79], v[216:219]
    v_mfma_f32_16x16x32_bf16 v[220:223], a[224:227], v[80:83], 0
    v_mfma_f32_16x16x32_bf16 v[220:223], a[228:231], v[84:87], v[220:223]
    v_mfma_f32_16x16x32_bf16 v[220:223], a[232:235], v[88:91], v[220:223]
    v_mfma_f32_16x16x32_bf16 v[220:223], a[236:239], v[92:95], v[220:223]
    v_mfma_f32_16x16x32_bf16 v[224:227], a[224:227], v[96:99], 0
    v_mfma_f32_16x16x32_bf16 v[224:227], a[228:231], v[100:103], v[224:227]
    v_mfma_f32_16x16x32_bf16 v[224:227], a[232:235], v[104:107], v[224:227]
    v_mfma_f32_16x16x32_bf16 v[224:227], a[236:239], v[108:111], v[224:227]
    v_mfma_f32_16x16x32_bf16 v[228:231], a[224:227], v[112:115], 0
    v_mfma_f32_16x16x32_bf16 v[228:231], a[228:231], v[116:119], v[228:231]
    v_mfma_f32_16x16x32_bf16 v[228:231], a[232:235], v[120:123], v[228:231]
    v_mfma_f32_16x16x32_bf16 v[228:231], a[236:239], v[124:127], v[228:231]
    v_max3_f32 v232, v232, v216, v217
    v_max3_f32 v232, v232, v218, v219
    v_max3_f32 v233, v233, v220, v221
    v_max3_f32 v233, v233, v222, v223
    v_max3_f32 v234, v234, v224, v225
    v_max3_f32 v234, v234, v226, v227
    s_nop 1
    v_max3_f32 v235, v235, v228, v229
    v_max3_f32 v235, v235, v230, v231
    s_barrier
    s_cmp_lt_u32 s40, 524288
    s_cbranch_scc1 Lattn_redo_loop
    v_mov_b32 v236, v232
    v_mov_b32 v237, v233
    v_mov_b32 v238, v234
    v_mov_b32 v239, v235
    v_permlane16_swap_b32 v232, v236
    v_permlane16_swap_b32 v233, v237
    v_permlane16_swap_b32 v234, v238
    v_permlane16_swap_b32 v235, v239
    v_max_f32 v232, v232, v236
    v_max_f32 v233, v233, v237
    v_max_f32 v234, v234, v238
    v_max_f32 v235, v235, v239
    v_mov_b32 v236, v232
    v_mov_b32 v237, v233
    v_mov_b32 v238, v234
    v_mov_b32 v239, v235
    v_permlane32_swap_b32 v232, v236
    v_permlane32_swap_b32 v233, v237
    v_permlane32_swap_b32 v234, v238
    v_permlane32_swap_b32 v235, v239
    v_max_f32 v232, v232, v236
    v_max_f32 v233, v233, v237
    v_max_f32 v234, v234, v238
    v_max_f32 v235, v235, v239
    v_sub_f32 v192, 0, v232
    v_sub_f32 v193, 0, v232
    v_sub_f32 v194, 0, v232
    v_sub_f32 v195, 0, v232
    v_sub_f32 v196, 0, v233
    v_sub_f32 v197, 0, v233
    v_sub_f32 v198, 0, v233
    v_sub_f32 v199, 0, v233
    v_sub_f32 v200, 0, v234
    v_sub_f32 v201, 0, v234
    v_sub_f32 v202, 0, v234
    v_sub_f32 v203, 0, v234
    v_sub_f32 v204, 0, v235
    v_sub_f32 v205, 0, v235
    v_sub_f32 v206, 0, v235
    v_sub_f32 v207, 0, v235
    s_mov_b32 s40, 0
    s_mov_b32 s41, 0
    s_add_u32 m0, s42, 0
    s_nop 0
    buffer_load_dwordx4 v36, s[8:11], s40 offen lds
    buffer_load_dwordx4 v37, s[8:11], s40 offen offset:1024 lds
    buffer_load_dwordx4 v38, s[8:11], s40 offen offset:2048 lds
    buffer_load_dwordx4 v39, s[8:11], s40 offen offset:3072 lds
    s_add_u32 s40, s40, 16384
    s_add_u32 m0, s42, 16384
    s_nop 0
    buffer_load_dwordx4 v36, s[8:11], s40 offen lds
    buffer_load_dwordx4 v37, s[8:11], s40 offen offset:1024 lds
    buffer_load_dwordx4 v38, s[8:11], s40 offen offset:2048 lds
    buffer_load_dwordx4 v39, s[8:11], s40 offen offset:3072 lds
    s_add_u32 s40, s40, 16384
    s_add_u32 m0, s42, 32768
    s_nop 0
    buffer_load_dwordx4 v36, s[8:11], s40 offen lds
    buffer_load_dwordx4 v37, s[8:11], s40 offen offset:1024 lds
    buffer_load_dwordx4 v38, s[8:11], s40 offen offset:2048 lds
    buffer_load_dwordx4 v39, s[8:11], s40 offen offset:3072 lds
    s_add_u32 s40, s40, 16384
    s_add_u32 m0, s42, 65536
    s_nop 0
    buffer_load_dwordx4 v40, s[12:15], s41 offen lds
    buffer_load_dwordx4 v41, s[12:15], s41 offen offset:1024 lds
    buffer_load_dwordx4 v40, s[12:15], s41 offen offset:2048 lds
    buffer_load_dwordx4 v41, s[12:15], s41 offen offset:3072 lds
    s_add_u32 s41, s41, 16384
    s_add_u32 m0, s42, 81920
    s_nop 0
    buffer_load_dwordx4 v40, s[12:15], s41 offen lds
    buffer_load_dwordx4 v41, s[12:15], s41 offen offset:1024 lds
    buffer_load_dwordx4 v40, s[12:15], s41 offen offset:2048 lds
    buffer_load_dwordx4 v41, s[12:15], s41 offen offset:3072 lds
    s_add_u32 s41, s41, 16384
    v_accvgpr_write_b32 a0, 0
    v_accvgpr_write_b32 a1, 0
    v_accvgpr_write_b32 a2, 0
    v_accvgpr_write_b32 a3, 0
    v_accvgpr_write_b32 a4, 0
    v_accvgpr_write_b32 a5, 0
    v_accvgpr_write_b32 a6, 0
    v_accvgpr_write_b32 a7, 0
    v_accvgpr_write_b32 a8, 0
    v_accvgpr_write_b32 a9, 0
    v_accvgpr_write_b32 a10, 0
    v_accvgpr_write_b32 a11, 0
    v_accvgpr_write_b32 a12, 0
    v_accvgpr_write_b32 a13, 0
    v_accvgpr_write_b32 a14, 0
    v_accvgpr_write_b32 a15, 0
    v_accvgpr_write_b32 a16, 0
    v_accvgpr_write_b32 a17, 0
    v_accvgpr_write_b32 a18, 0
    v_accvgpr_write_b32 a19, 0
    v_accvgpr_write_b32 a20, 0
    v_accvgpr_write_b32 a21, 0
    v_accvgpr_write_b32 a22, 0
    v_accvgpr_write_b32 a23, 0
    v_accvgpr_write_b32 a24, 0
    v_accvgpr_write_b32 a25, 0
    v_accvgpr_write_b32 a26, 0
    v_accvgpr_write_b32 a27, 0
    v_accvgpr_write_b32 a28, 0
    v_accvgpr_write_b32 a29, 0
    v_accvgpr_write_b32 a30, 0
    v_accvgpr_write_b32 a31, 0
    v_accvgpr_write_b32 a32, 0
    v_accvgpr_write_b32 a33, 0
    v_accvgpr_write_b32 a34, 0
    v_accvgpr_write_b32 a35, 0
    v_accvgpr_write_b32 a36, 0
    v_accvgpr_write_b32 a37, 0
    v_accvgpr_write_b32 a38, 0
    v_accvgpr_write_b32 a39, 0
    v_accvgpr_write_b32 a40, 0
    v_accvgpr_write_b32 a41, 0
    v_accvgpr_write_b32 a42, 0
    v_accvgpr_write_b32 a43, 0
    v_accvgpr_write_b32 a44, 0
    v_accvgpr_write_b32 a45, 0
    v_accvgpr_write_b32 a46, 0
    v_accvgpr_write_b32 a47, 0
    v_accvgpr_write_b32 a48, 0
    v_accvgpr_write_b32 a49, 0
    v_accvgpr_write_b32 a50, 0
    v_accvgpr_write_b32 a51, 0
    v_accvgpr_write_b32 a52, 0
    v_accvgpr_write_b32 a53, 0
    v_accvgpr_write_b32 a54, 0
    v_accvgpr_write_b32 a55, 0
    v_accvgpr_write_b32 a56, 0
    v_accvgpr_write_b32 a57, 0
    v_accvgpr_write_b32 a58, 0
    v_accvgpr_write_b32 a59, 0
    v_accvgpr_write_b32 a60, 0
    v_accvgpr_write_b32 a61, 0
    v_accvgpr_write_b32 a62, 0
    v_accvgpr_write_b32 a63, 0
    v_accvgpr_write_b32 a64, 0
    v_accvgpr_write_b32 a65, 0
    v_accvgpr_write_b32 a66, 0
    v_accvgpr_write_b32 a67, 0
    v_accvgpr_write_b32 a68, 0
    v_accvgpr_write_b32 a69, 0
    v_accvgpr_write_b32 a70, 0
    v_accvgpr_write_b32 a71, 0
    v_accvgpr_write_b32 a72, 0
    v_accvgpr_write_b32 a73, 0
    v_accvgpr_write_b32 a74, 0
    v_accvgpr_write_b32 a75, 0
    v_accvgpr_write_b32 a76, 0
    v_accvgpr_write_b32 a77, 0
    v_accvgpr_write_b32 a78, 0
    v_accvgpr_write_b32 a79, 0
    v_accvgpr_write_b32 a80, 0
    v_accvgpr_write_b32 a81, 0
    v_accvgpr_write_b32 a82, 0
    v_accvgpr_write_b32 a83, 0
    v_accvgpr_write_b32 a84, 0
    v_accvgpr_write_b32 a85, 0
    v_accvgpr_write_b32 a86, 0
    v_accvgpr_write_b32 a87, 0
    v_accvgpr_write_b32 a88, 0
    v_accvgpr_write_b32 a89, 0
    v_accvgpr_write_b32 a90, 0
    v_accvgpr_write_b32 a91, 0
    v_accvgpr_write_b32 a92, 0
    v_accvgpr_write_b32 a93, 0
    v_accvgpr_write_b32 a94, 0
    v_accvgpr_write_b32 a95, 0
    v_accvgpr_write_b32 a96, 0
    v_accvgpr_write_b32 a97, 0
    v_accvgpr_write_b32 a98, 0
    v_accvgpr_write_b32 a99, 0
    v_accvgpr_write_b32 a100, 0
    v_accvgpr_write_b32 a101, 0
    v_accvgpr_write_b32 a102, 0
    v_accvgpr_write_b32 a103, 0
    v_accvgpr_write_b32 a104, 0
    v_accvgpr_write_b32 a105, 0
    v_accvgpr_write_b32 a106, 0
    v_accvgpr_write_b32 a107, 0
    v_accvgpr_write_b32 a108, 0
    v_accvgpr_write_b32 a109, 0
    v_accvgpr_write_b32 a110, 0
    v_accvgpr_write_b32 a111, 0
    v_accvgpr_write_b32 a112, 0
    v_accvgpr_write_b32 a113, 0
    v_accvgpr_write_b32 a114, 0
    v_accvgpr_write_b32 a115, 0
    v_accvgpr_write_b32 a116, 0
    v_accvgpr_write_b32 a117, 0
    v_accvgpr_write_b32 a118, 0
    v_accvgpr_write_b32 a119, 0
    v_accvgpr_write_b32 a120, 0
    v_accvgpr_write_b32 a121, 0
    v_accvgpr_write_b32 a122, 0
    v_accvgpr_write_b32 a123, 0
    v_accvgpr_write_b32 a124, 0
    v_accvgpr_write_b32 a125, 0
    v_accvgpr_write_b32 a126, 0
    v_accvgpr_write_b32 a127, 0
    v_accvgpr_write_b32 a192, 0
    v_accvgpr_write_b32 a193, 0
    v_accvgpr_write_b32 a194, 0
    v_accvgpr_write_b32 a195, 0
    v_accvgpr_write_b32 a196, 0
    v_accvgpr_write_b32 a197, 0
    v_accvgpr_write_b32 a198, 0
    v_accvgpr_write_b32 a199, 0
    v_accvgpr_write_b32 a200, 0
    v_accvgpr_write_b32 a201, 0
    v_accvgpr_write_b32 a202, 0
    v_accvgpr_write_b32 a203, 0
    v_accvgpr_write_b32 a204, 0
    v_accvgpr_write_b32 a205, 0
    v_accvgpr_write_b32 a206, 0
    v_accvgpr_write_b32 a207, 0
    s_waitcnt vmcnt(0) lgkmcnt(0)
    s_barrier
    ds_read_b128 a[208:211], v8 offset:0
    ds_read_b128 a[212:215], v9 offset:0
    ds_read_b128 a[216:219], v10 offset:0
    ds_read_b128 a[220:223], v11 offset:0
    ds_read_b128 a[224:227], v8 offset:4096
    s_waitcnt vmcnt(0) lgkmcnt(0)
    s_branch Lattn_stage0
Lattn_armwait:
    s_mov_b32 s36, 16384
Lattn_armloop:
    v_mov_b32 v63, 0
    buffer_load_dword v63, v63, s[88:91], 0 offen sc1
    s_waitcnt vmcnt(0)
    v_readfirstlane_b32 s37, v63
    s_sub_u32 s36, s36, 1
    s_cbranch_scc1 Lattn_armed
    s_cmp_lt_u32 s37, 256
    s_cbranch_scc1 Lattn_armloop
    s_branch Lattn_armed
Lattn_end:
    s_endpgm
.section .rodata,"a"
.p2align 6
.amdhsa_kernel adaLN_cond__gqa_block_cached__moe_arch_mod__prompt_kernel
  .amdhsa_next_free_vgpr 512
  .amdhsa_next_free_sgpr 102
  .amdhsa_accum_offset 256
  .amdhsa_group_segment_fixed_size 0
  .amdhsa_kernarg_size 120
  .amdhsa_user_sgpr_count 2
  .amdhsa_user_sgpr_kernarg_segment_ptr 1
  .amdhsa_system_sgpr_workgroup_id_x 1
  .amdhsa_float_denorm_mode_32 3
.end_amdhsa_kernel
```

```asm
; @launch grid=(256,1,1) block=(256,1,1) lds=163840
.amdgcn_target "amdgcn-amd-amdhsa--gfx950"
.text
.globl adaLN_cond__gqa_block_cached__moe_arch_mod__prompt_kernel
.p2align 8
.type adaLN_cond__gqa_block_cached__moe_arch_mod__prompt_kernel,@function
adaLN_cond__gqa_block_cached__moe_arch_mod__prompt_kernel:
    s_cmp_ge_u32 s2, 256
    s_cbranch_scc1 Lattn_end
    s_load_dwordx2 s[8:9], s[0:1], 80
    s_load_dwordx2 s[12:13], s[0:1], 88
    s_load_dwordx2 s[20:21], s[0:1], 0
    s_load_dwordx2 s[50:51], s[0:1], 112
    s_load_dwordx8 s[52:59], s[0:1], 8
    s_load_dwordx4 s[80:83], s[0:1], 56
    s_load_dwordx2 s[84:85], s[0:1], 72
    s_load_dwordx2 s[88:89], s[0:1], 104
    s_getpc_b64 s[32:33]
Lattn_pc:
    s_mov_b32 s34, Lattn_end-Lattn_pc
    s_mov_b32 s35, 0x20000
    s_lshr_b32 s6, s2, 3
    s_lshl_b32 s7, s6, 6
    v_lshrrev_b32 v3, 6, v0
    v_and_b32 v1, 63, v0
    v_lshrrev_b32 v2, 2, v0
    v_lshlrev_b32 v2, 11, v2
    v_readfirstlane_b32 s3, v3
    buffer_load_dword v240, v2, s[32:35], s7 offen
    s_and_b32 s7, s2, 7
    s_lshl_b32 s4, s7, 1
    s_and_b32 s5, s6, 1
    s_add_u32 s4, s4, s5
    s_lshr_b32 s5, s2, 4
    s_lshr_b32 s38, s6, 2
    s_lshl_b32 s38, s38, 3
    s_add_u32 s38, s38, s7
    s_cmp_lt_u32 s38, 18
    s_cselect_b32 s39, 0, 2147483648
    s_lshl_b32 s38, s38, 2
    s_and_b32 s36, s6, 3
    s_add_u32 s38, s38, s36
    s_mov_b32 s14, 3981312
    s_mul_i32 s92, s6, 124416
    s_lshl_b32 s36, s7, 7
    s_add_u32 s92, s92, s36
    s_cmp_lt_u32 s7, 2
    s_cselect_b32 s36, 53, 35
    v_lshrrev_b32 v2, 2, v0
    v_min_u32 v2, s36, v2
    v_mul_u32_u24 v3, 57, v2
    v_lshrrev_b32 v3, 10, v3
    v_mul_i32_i24 v3, -123392, v3
    v_mul_u32_u24 v2, 6912, v2
    v_add_u32 v72, v2, v3
    s_mov_b32 s15, 0x20000
    s_mov_b32 s10, 1152
    s_mov_b32 s11, 0x20000
    s_mov_b32 s22, 2359296
    s_mov_b32 s23, 0x20000
    v_and_b32 v64, 0xfe, v0
    v_mul_u32_u24 v65, 3456, v64
    v_and_b32 v2, 1, v0
    v_lshl_add_u32 v65, v2, 4, v65
    s_lshl_b32 s36, s38, 5
    s_or_b32 s36, s36, s39
    v_and_b32 v4, 31, v1
    v_lshrrev_b32 v5, 5, v1
    v_cmp_gt_u32 vcc, 24, v4
    v_mov_b32 v6, 2147483648
    s_lshl_b32 s7, s5, 4
    s_add_u32 s7, s7, s4
    s_lshl_b32 s7, s7, 2
    s_add_u32 s7, s7, s3
    v_cndmask_b32 v6, v6, 0, vcc
    s_mul_i32 s49, s7, 2304
    v_lshrrev_b32 v7, 2, v4
    v_lshl_add_u32 v7, v7, 6, v6
    v_and_b32 v2, 3, v4
    v_lshl_add_u32 v7, v2, 3, v7
    v_mul_u32_u24 v2, 1152, v5
    v_add_u32 v66, v7, v2
    s_waitcnt lgkmcnt(0)
    s_load_dword s94, s[50:51], 24576
    buffer_load_dword v241, v72, s[12:15], s92 offen
    buffer_load_ushort v80, v64, s[8:11], 0 offen offset:0
    buffer_load_ushort v81, v64, s[8:11], 0 offen offset:256
    buffer_load_ushort v82, v64, s[8:11], 0 offen offset:512
    buffer_load_ushort v83, v64, s[8:11], 0 offen offset:768
    buffer_load_ushort v84, v64, s[8:11], 0 offen offset:1024
    buffer_load_dwordx4 v[88:91], v65, s[12:15], s36 offen
    s_add_u32 s36, s36, 884736
    buffer_load_dwordx4 v[92:95], v65, s[12:15], s36 offen
    s_add_u32 s36, s36, 884736
    buffer_load_dwordx4 v[96:99], v65, s[12:15], s36 offen
    s_add_u32 s36, s36, 884736
    buffer_load_dwordx4 v[100:103], v65, s[12:15], s36 offen
    s_add_u32 s36, s36, 884736
    buffer_load_dwordx4 v[104:107], v65, s[12:15], s36 offen
    s_mov_b32 s16, s56
    s_mov_b32 s17, s57
    s_mov_b32 s18, 4718592
    s_mov_b32 s19, 0x20000
    s_lshl_b32 s44, s4, 9
    s_mul_i32 s36, s5, 98304
    s_add_u32 s36, s36, 0
    v_lshrrev_b32 v2, 2, v0
    v_min_u32 v2, 47, v2
    v_lshrrev_b32 v3, 2, v2
    v_and_b32 v2, 3, v2
    v_lshl_add_u32 v2, v2, 7, s36
    v_lshl_add_u32 v71, v3, 13, v2
    s_mul_i32 s36, s5, 196608
    s_add_u32 s36, s36, 1572864
    v_lshrrev_b32 v2, 1, v0
    v_min_u32 v2, 95, v2
    v_lshrrev_b32 v3, 2, v2
    v_and_b32 v2, 3, v2
    v_lshl_add_u32 v2, v2, 7, s36
    v_lshl_add_u32 v70, v3, 13, v2
    s_add_u32 s92, s49, 65536
    v_lshl_add_u32 v7, v5, 4, v6
    v_lshl_add_u32 v67, v4, 5, v7
    v_min_u32 v4, 23, v4
    v_lshlrev_b32 v68, 4, v4
    s_mov_b32 s24, s50
    s_mov_b32 s25, s51
    s_mov_b32 s26, 10485760
    s_mov_b32 s27, 0x20000
    s_mov_b32 s90, 256
    s_mov_b32 s91, 0x20000
    s_cmp_ge_u32 s38, 36
    s_cselect_b32 s93, 1.0, 0
    s_lshl_b32 s36, s38, 7
    v_lshl_add_u32 v69, v0, 3, s36
    v_cmp_gt_u32 s[36:37], 8, v0
    v_mov_b32 v2, 2147483648
    v_mov_b32 v3, s39
    v_cndmask_b32 v2, v2, v3, s[36:37]
    v_or_b32 v69, v69, v2
    s_mul_i32 s36, s5, 3072
    s_lshl_b32 s37, s5, 11
    v_lshrrev_b32 v120, 3, v0
    v_min_u32 v120, 23, v120
    v_lshl_add_u32 v120, v120, 7, s36
    v_lshrrev_b32 v121, 4, v0
    v_lshl_add_u32 v121, v121, 7, s37
    s_lshl_b32 s42, s3, 12
    v_lshrrev_b32 v2, 4, v1
    v_and_b32 v3, 15, v1
    v_lshrrev_b32 v5, 1, v3
    v_mul_u32_u24 v5, 2304, v5
    v_lshl_add_u32 v5, v2, 5, v5
    v_and_b32 v6, 1, v3
    v_lshl_add_u32 v51, v6, 4, v5
    s_lshl_b32 s6, s5, 2
    s_add_u32 s6, s6, s3
    s_mul_i32 s46, s6, 36864
    s_add_u32 s46, s46, 65536
    s_add_u32 s43, s46, 18432
    s_mul_i32 s45, s4, 294912
    s_lshl_b32 s7, s3, 4
    v_add_u32 v4, s7, v2
    v_lshlrev_b32 v5, 1, v2
    v_xor_b32 v5, v5, v3
    v_xor_b32 v6, 8, v5
    v_lshlrev_b32 v7, 13, v4
    v_lshl_add_u32 v42, v5, 4, v7
    v_lshl_add_u32 v43, v6, 4, v7
    v_add_u32 v44, 63488, v42
    v_add_u32 v45, 95232, v43
    v_add_u32 v43, 31744, v43
    s_lshl_b32 s7, s4, 19
    s_add_u32 s8, s52, s7
    s_addc_u32 s9, s53, 0
    s_mov_b32 s10, 524288
    s_mov_b32 s11, 0x20000
    s_add_u32 s12, s54, s7
    s_addc_u32 s13, s55, 0
    s_mov_b32 s14, 524288
    s_mov_b32 s15, 0x20000
    s_add_u32 s28, s50, 10485760
    s_addc_u32 s29, s51, 0
    s_mov_b32 s30, 37748736
    s_mov_b32 s31, 0x20000
    v_lshlrev_b32 v7, 8, v4
    v_lshl_add_u32 v40, v5, 4, v7
    v_lshl_add_u32 v41, v6, 4, v7
    v_xor_b32 v224, v3, v2
    v_lshl_add_u32 v36, v224, 4, v7
    v_xor_b32 v37, 64, v36
    v_xor_b32 v38, 128, v36
    v_xor_b32 v39, 192, v36
    v_lshrrev_b32 v7, 3, v5
    v_lshl_add_u32 v7, v7, 7, v4
    v_mul_u32_u24 v7, 1152, v7
    v_and_b32 v225, 7, v5
    v_lshl_add_u32 v46, v225, 4, v7
    v_lshrrev_b32 v7, 3, v6
    v_lshl_add_u32 v7, v7, 7, v4
    v_mul_u32_u24 v7, 1152, v7
    v_and_b32 v225, 7, v6
    v_lshl_add_u32 v47, v225, 4, v7
    v_add_u32 v48, 7168, v46
    v_add_u32 v49, 10752, v47
    v_add_u32 v47, 3584, v47
    v_lshlrev_b32 v7, 8, v3
    v_lshl_add_u32 v8, v224, 4, v7
    v_xor_b32 v9, 64, v8
    v_xor_b32 v10, 128, v8
    v_xor_b32 v11, 192, v8
    v_lshrrev_b32 v5, 2, v1
    v_and_b32 v6, 7, v5
    v_lshlrev_b32 v6, 5, v6
    v_lshl_add_u32 v6, v5, 8, v6
    v_and_b32 v7, 3, v1
    v_lshl_add_u32 v12, v7, 3, v6
    v_xor_b32 v13, 32, v12
    v_xor_b32 v14, 64, v12
    v_xor_b32 v15, 96, v12
    v_xor_b32 v16, 128, v12
    v_xor_b32 v17, 160, v12
    v_xor_b32 v18, 192, v12
    v_xor_b32 v19, 224, v12
    v_add_u32 v20, 65536, v12
    v_add_u32 v21, 65536, v13
    v_add_u32 v22, 65536, v14
    v_add_u32 v23, 65536, v15
    v_add_u32 v24, 65536, v16
    v_add_u32 v25, 65536, v17
    v_add_u32 v26, 65536, v18
    v_add_u32 v27, 65536, v19
    v_add_u32 v28, 131072, v12
    v_add_u32 v29, 131072, v13
    v_add_u32 v30, 131072, v14
    v_add_u32 v31, 131072, v15
    v_add_u32 v32, 131072, v16
    v_add_u32 v33, 131072, v17
    v_add_u32 v34, 131072, v18
    v_add_u32 v35, 131072, v19
    v_mov_b32 v52, 0x3f803f80
    v_mov_b32 v53, 0x3f803f80
    v_mov_b32 v54, 0x3f803f80
    v_mov_b32 v55, 0x3f803f80
    v_and_b32 v5, 1, v1
    v_mul_u32_u24 v5, 0xaaaa, v5
    v_add_u32 v5, 0x4444, v5
    v_lshl_add_u32 v50, v5, 16, v5
    v_lshrrev_b32 v5, 1, v3
    v_mul_u32_u24 v5, 20480, v5
    v_lshl_add_u32 v5, v2, 5, v5
    v_and_b32 v6, 1, v3
    v_lshl_add_u32 v56, v6, 4, v5
    s_mul_i32 s47, s6, 327680
    s_mov_b32 s32, s82
    s_mov_b32 s33, s83
    s_mov_b32 s34, 5308416
    s_mov_b32 s35, 0x20000
    s_mov_b32 s82, 5308416
    s_mov_b32 s83, 0x20000
    s_mov_b32 s86, 5308416
    s_mov_b32 s87, 0x20000
    s_lshr_b32 s7, s2, 3
    s_mul_i32 s7, s7, 18
    s_add_u32 s7, s7, s3
    s_and_b32 s36, s2, 7
    s_mul_i32 s37, s36, 576
    s_add_u32 s37, s37, s7
    s_mul_i32 s37, s37, 1152
    s_mul_i32 s7, s7, 9216
    s_mul_i32 s36, s36, 1152
    s_add_u32 s7, s7, s36
    v_min_u32 v5, 17, v1
    v_lshl_add_u32 v57, v5, 6, s7
    v_lshl_add_u32 v62, v5, 6, s37
    s_mov_b32 s40, 0
    s_mov_b32 s41, 0
    s_mov_b32 s48, 0
    s_waitcnt vmcnt(9)
    v_lshlrev_b32 v80, 16, v80
    s_waitcnt vmcnt(8)
    v_lshlrev_b32 v81, 16, v81
    s_waitcnt vmcnt(7)
    v_lshlrev_b32 v82, 16, v82
    s_waitcnt vmcnt(6)
    v_lshlrev_b32 v83, 16, v83
    s_waitcnt vmcnt(5)
    v_lshlrev_b32 v84, 16, v84
    v_mul_f32 v144, 0xbfb8aa3b, v80
    v_mul_f32 v148, 0xbfb8aa3b, v81
    v_mul_f32 v152, 0xbfb8aa3b, v82
    v_mul_f32 v156, 0xbfb8aa3b, v83
    v_mul_f32 v160, 0xbfb8aa3b, v84
    v_min_f32 v144, 0x42fc0000, v144
    v_min_f32 v148, 0x42fc0000, v148
    v_min_f32 v152, 0x42fc0000, v152
    v_min_f32 v156, 0x42fc0000, v156
    v_min_f32 v160, 0x42fc0000, v160
    v_exp_f32 v144, v144
    v_exp_f32 v148, v148
    v_exp_f32 v152, v152
    v_exp_f32 v156, v156
    v_exp_f32 v160, v160
    v_add_f32 v144, 1.0, v144
    v_add_f32 v148, 1.0, v148
    v_add_f32 v152, 1.0, v152
    v_add_f32 v156, 1.0, v156
    v_add_f32 v160, 1.0, v160
    v_rcp_f32 v145, v144
    v_rcp_f32 v149, v148
    v_rcp_f32 v153, v152
    v_rcp_f32 v157, v156
    v_rcp_f32 v161, v160
    v_mul_f32 v146, v80, v145
    v_mul_f32 v150, v81, v149
    v_mul_f32 v154, v82, v153
    v_mul_f32 v158, v83, v157
    v_mul_f32 v162, v84, v161
    v_fma_f32 v144, -v146, v144, v80
    v_fma_f32 v148, -v150, v148, v81
    v_fma_f32 v152, -v154, v152, v82
    v_fma_f32 v156, -v158, v156, v83
    v_fma_f32 v160, -v162, v160, v84
    v_fma_f32 v80, v144, v145, v146
    v_fma_f32 v81, v148, v149, v150
    v_fma_f32 v82, v152, v153, v154
    v_fma_f32 v83, v156, v157, v158
    v_fma_f32 v84, v160, v161, v162
    v_cvt_pk_bf16_f32 v80, v80, v80
    v_cvt_pk_bf16_f32 v81, v81, v81
    v_cvt_pk_bf16_f32 v82, v82, v82
    v_cvt_pk_bf16_f32 v83, v83, v83
    v_cvt_pk_bf16_f32 v84, v84, v84
    v_and_b32 v80, 0xffff0000, v80
    v_and_b32 v81, 0xffff0000, v81
    v_and_b32 v82, 0xffff0000, v82
    v_and_b32 v83, 0xffff0000, v83
    v_and_b32 v84, 0xffff0000, v84
    buffer_load_dwordx2 v[108:109], v66, s[20:23], s49 offen offset:0
    buffer_load_dwordx2 v[110:111], v66, s[20:23], s49 offen offset:32
    buffer_load_dwordx2 v[112:113], v66, s[20:23], s49 offen offset:384
    buffer_load_dwordx2 v[114:115], v66, s[20:23], s49 offen offset:416
    buffer_load_dwordx2 v[116:117], v66, s[20:23], s49 offen offset:768
    buffer_load_dwordx2 v[118:119], v66, s[20:23], s49 offen offset:800
    s_mov_b32 s20, s58
    s_mov_b32 s21, s59
    s_mov_b32 s22, 4718592
    s_mov_b32 s23, 0x20000
    buffer_load_dword v242, v71, s[16:19], s44 offen
    s_waitcnt vmcnt(11)
    v_lshlrev_b32 v136, 16, v88
    v_and_b32 v137, 0xffff0000, v88
    v_lshlrev_b32 v138, 16, v89
    v_and_b32 v139, 0xffff0000, v89
    v_lshlrev_b32 v140, 16, v90
    v_and_b32 v141, 0xffff0000, v90
    v_lshlrev_b32 v142, 16, v91
    v_and_b32 v143, 0xffff0000, v91
    v_pk_mul_f32 v[128:129], v[136:137], v[80:81] op_sel:[0,0] op_sel_hi:[1,0]
    v_pk_mul_f32 v[130:131], v[138:139], v[80:81] op_sel:[0,0] op_sel_hi:[1,0]
    v_pk_mul_f32 v[132:133], v[140:141], v[80:81] op_sel:[0,0] op_sel_hi:[1,0]
    v_pk_mul_f32 v[134:135], v[142:143], v[80:81] op_sel:[0,0] op_sel_hi:[1,0]
    s_waitcnt vmcnt(10)
    v_lshlrev_b32 v136, 16, v92
    v_and_b32 v137, 0xffff0000, v92
    v_lshlrev_b32 v138, 16, v93
    v_and_b32 v139, 0xffff0000, v93
    v_lshlrev_b32 v140, 16, v94
    v_and_b32 v141, 0xffff0000, v94
    v_lshlrev_b32 v142, 16, v95
    v_and_b32 v143, 0xffff0000, v95
    v_pk_fma_f32 v[128:129], v[136:137], v[80:81], v[128:129] op_sel:[0,1,0] op_sel_hi:[1,1,1]
    v_pk_fma_f32 v[130:131], v[138:139], v[80:81], v[130:131] op_sel:[0,1,0] op_sel_hi:[1,1,1]
    v_pk_fma_f32 v[132:133], v[140:141], v[80:81], v[132:133] op_sel:[0,1,0] op_sel_hi:[1,1,1]
    v_pk_fma_f32 v[134:135], v[142:143], v[80:81], v[134:135] op_sel:[0,1,0] op_sel_hi:[1,1,1]
    s_waitcnt vmcnt(9)
    v_lshlrev_b32 v136, 16, v96
    v_and_b32 v137, 0xffff0000, v96
    v_lshlrev_b32 v138, 16, v97
    v_and_b32 v139, 0xffff0000, v97
    v_lshlrev_b32 v140, 16, v98
    v_and_b32 v141, 0xffff0000, v98
    v_lshlrev_b32 v142, 16, v99
    v_and_b32 v143, 0xffff0000, v99
    v_pk_fma_f32 v[128:129], v[136:137], v[82:83], v[128:129] op_sel:[0,0,0] op_sel_hi:[1,0,1]
    v_pk_fma_f32 v[130:131], v[138:139], v[82:83], v[130:131] op_sel:[0,0,0] op_sel_hi:[1,0,1]
    v_pk_fma_f32 v[132:133], v[140:141], v[82:83], v[132:133] op_sel:[0,0,0] op_sel_hi:[1,0,1]
    v_pk_fma_f32 v[134:135], v[142:143], v[82:83], v[134:135] op_sel:[0,0,0] op_sel_hi:[1,0,1]
    s_waitcnt vmcnt(8)
    v_lshlrev_b32 v136, 16, v100
    v_and_b32 v137, 0xffff0000, v100
    v_lshlrev_b32 v138, 16, v101
    v_and_b32 v139, 0xffff0000, v101
    v_lshlrev_b32 v140, 16, v102
    v_and_b32 v141, 0xffff0000, v102
    v_lshlrev_b32 v142, 16, v103
    v_and_b32 v143, 0xffff0000, v103
    v_pk_fma_f32 v[128:129], v[136:137], v[82:83], v[128:129] op_sel:[0,1,0] op_sel_hi:[1,1,1]
    v_pk_fma_f32 v[130:131], v[138:139], v[82:83], v[130:131] op_sel:[0,1,0] op_sel_hi:[1,1,1]
    v_pk_fma_f32 v[132:133], v[140:141], v[82:83], v[132:133] op_sel:[0,1,0] op_sel_hi:[1,1,1]
    v_pk_fma_f32 v[134:135], v[142:143], v[82:83], v[134:135] op_sel:[0,1,0] op_sel_hi:[1,1,1]
    s_waitcnt vmcnt(7)
    v_lshlrev_b32 v136, 16, v104
    v_and_b32 v137, 0xffff0000, v104
    v_lshlrev_b32 v138, 16, v105
    v_and_b32 v139, 0xffff0000, v105
    v_lshlrev_b32 v140, 16, v106
    v_and_b32 v141, 0xffff0000, v106
    v_lshlrev_b32 v142, 16, v107
    v_and_b32 v143, 0xffff0000, v107
    v_pk_fma_f32 v[128:129], v[136:137], v[84:85], v[128:129] op_sel:[0,0,0] op_sel_hi:[1,0,1]
    v_pk_fma_f32 v[130:131], v[138:139], v[84:85], v[130:131] op_sel:[0,0,0] op_sel_hi:[1,0,1]
    v_pk_fma_f32 v[132:133], v[140:141], v[84:85], v[132:133] op_sel:[0,0,0] op_sel_hi:[1,0,1]
    v_pk_fma_f32 v[134:135], v[142:143], v[84:85], v[134:135] op_sel:[0,0,0] op_sel_hi:[1,0,1]
    s_nop 0
    v_permlane32_swap_b32 v128, v132
    v_permlane32_swap_b32 v129, v133
    v_permlane32_swap_b32 v130, v134
    v_permlane32_swap_b32 v131, v135
    v_and_b32 v72, 1, v1
    v_pk_add_f32 v[128:129], v[128:129], v[132:133]
    v_pk_add_f32 v[130:131], v[130:131], v[134:135]
    v_lshlrev_b32 v72, 5, v72
    v_lshrrev_b32 v73, 4, v1
    v_permlane16_swap_b32 v128, v130
    v_permlane16_swap_b32 v129, v131
    v_lshl_add_u32 v72, v73, 3, v72
    v_pk_add_f32 v[128:129], v[128:129], v[130:131]
    s_lshl_b32 s36, s3, 6
    v_add_u32 v72, s36, v72
    v_add_f32_dpp v128, v128, v128 row_ror:2 row_mask:0xf bank_mask:0xf
    v_add_f32_dpp v129, v129, v129 row_ror:2 row_mask:0xf bank_mask:0xf
    s_nop 0
    v_add_f32_dpp v128, v128, v128 row_ror:4 row_mask:0xf bank_mask:0xf
    v_add_f32_dpp v129, v129, v129 row_ror:4 row_mask:0xf bank_mask:0xf
    s_nop 0
    v_add_f32_dpp v128, v128, v128 row_ror:8 row_mask:0xf bank_mask:0xf
    v_add_f32_dpp v129, v129, v129 row_ror:8 row_mask:0xf bank_mask:0xf
    ds_write_b64 v72, v[128:129] offset:0
    v_and_b32 v73, 7, v1
    v_lshlrev_b32 v73, 3, v73
    s_waitcnt lgkmcnt(0)
    s_barrier
    ds_read_b64 v[128:129], v73 offset:0
    ds_read_b64 v[130:131], v73 offset:64
    ds_read_b64 v[132:133], v73 offset:128
    ds_read_b64 v[134:135], v73 offset:192
    s_add_u32 s95, s94, 0x9e3779b9
    v_mov_b32 v137, s95
    s_mov_b32 s37, 32768
    s_waitcnt lgkmcnt(2)
    v_pk_add_f32 v[128:129], v[128:129], v[130:131]
    s_waitcnt lgkmcnt(0)
    v_pk_add_f32 v[132:133], v[132:133], v[134:135]
    v_pk_add_f32 v[128:129], v[128:129], v[132:133]
    v_cvt_pk_bf16_f32 v136, v128, v129
    v_lshlrev_b32 v128, 16, v136
    v_and_b32 v129, 0xffff0000, v136
    v_add_f32 v128, s93, v128
    v_add_f32 v129, s93, v129
    v_cvt_pk_bf16_f32 v136, v128, v129
    buffer_store_dwordx2 v[136:137], v69, s[24:27], s37 offen sc1
    s_waitcnt vmcnt(7)
    v_lshlrev_b32 v144, 16, v108
    v_and_b32 v145, 0xffff0000, v108
    v_lshlrev_b32 v146, 16, v109
    v_and_b32 v147, 0xffff0000, v109
    s_waitcnt vmcnt(6)
    v_lshlrev_b32 v148, 16, v110
    v_and_b32 v149, 0xffff0000, v110
    v_lshlrev_b32 v150, 16, v111
    v_and_b32 v151, 0xffff0000, v111
    s_waitcnt vmcnt(5)
    v_lshlrev_b32 v152, 16, v112
    v_and_b32 v153, 0xffff0000, v112
    v_lshlrev_b32 v154, 16, v113
    v_and_b32 v155, 0xffff0000, v113
    s_waitcnt vmcnt(4)
    v_lshlrev_b32 v156, 16, v114
    v_and_b32 v157, 0xffff0000, v114
    v_lshlrev_b32 v158, 16, v115
    v_and_b32 v159, 0xffff0000, v115
    s_waitcnt vmcnt(3)
    v_lshlrev_b32 v160, 16, v116
    v_and_b32 v161, 0xffff0000, v116
    v_lshlrev_b32 v162, 16, v117
    v_and_b32 v163, 0xffff0000, v117
    s_waitcnt vmcnt(2)
    v_lshlrev_b32 v164, 16, v118
    v_and_b32 v165, 0xffff0000, v118
    v_lshlrev_b32 v166, 16, v119
    v_and_b32 v167, 0xffff0000, v119
    v_pk_add_f32 v[72:73], v[144:145], v[148:149]
    v_pk_add_f32 v[76:77], v[146:147], v[150:151]
    v_pk_add_f32 v[72:73], v[72:73], v[152:153]
    v_pk_add_f32 v[76:77], v[76:77], v[154:155]
    v_pk_add_f32 v[72:73], v[72:73], v[156:157]
    v_pk_add_f32 v[76:77], v[76:77], v[158:159]
    v_pk_add_f32 v[72:73], v[72:73], v[160:161]
    v_pk_add_f32 v[76:77], v[76:77], v[162:163]
    v_pk_add_f32 v[72:73], v[72:73], v[164:165]
    v_pk_add_f32 v[76:77], v[76:77], v[166:167]
    v_pk_add_f32 v[72:73], v[72:73], v[76:77]
    v_add_f32 v72, v72, v73
    s_nop 1
    v_add_f32_dpp v72, v72, v72 row_ror:1 row_mask:0xf bank_mask:0xf
    s_nop 1
    v_add_f32_dpp v72, v72, v72 row_ror:2 row_mask:0xf bank_mask:0xf
    s_nop 1
    v_add_f32_dpp v72, v72, v72 row_ror:4 row_mask:0xf bank_mask:0xf
    s_nop 1
    v_add_f32_dpp v72, v72, v72 row_ror:8 row_mask:0xf bank_mask:0xf
    v_mov_b32 v76, v72
    s_nop 1
    v_permlane16_swap_b32 v72, v76
    s_nop 0
    v_add_f32 v72, v72, v76
    v_mul_f32 v72, 0x3ae38e39, v72
    v_pk_add_f32 v[168:169], v[144:145], v[72:73] op_sel_hi:[1,0] neg_lo:[0,1] neg_hi:[0,1]
    v_pk_add_f32 v[170:171], v[146:147], v[72:73] op_sel_hi:[1,0] neg_lo:[0,1] neg_hi:[0,1]
    v_pk_add_f32 v[172:173], v[148:149], v[72:73] op_sel_hi:[1,0] neg_lo:[0,1] neg_hi:[0,1]
    v_pk_add_f32 v[174:175], v[150:151], v[72:73] op_sel_hi:[1,0] neg_lo:[0,1] neg_hi:[0,1]
    v_pk_add_f32 v[176:177], v[152:153], v[72:73] op_sel_hi:[1,0] neg_lo:[0,1] neg_hi:[0,1]
    v_pk_add_f32 v[178:179], v[154:155], v[72:73] op_sel_hi:[1,0] neg_lo:[0,1] neg_hi:[0,1]
    v_pk_add_f32 v[180:181], v[156:157], v[72:73] op_sel_hi:[1,0] neg_lo:[0,1] neg_hi:[0,1]
    v_pk_add_f32 v[182:183], v[158:159], v[72:73] op_sel_hi:[1,0] neg_lo:[0,1] neg_hi:[0,1]
    v_pk_add_f32 v[184:185], v[160:161], v[72:73] op_sel_hi:[1,0] neg_lo:[0,1] neg_hi:[0,1]
    v_pk_add_f32 v[186:187], v[162:163], v[72:73] op_sel_hi:[1,0] neg_lo:[0,1] neg_hi:[0,1]
    v_pk_add_f32 v[188:189], v[164:165], v[72:73] op_sel_hi:[1,0] neg_lo:[0,1] neg_hi:[0,1]
    v_pk_add_f32 v[190:191], v[166:167], v[72:73] op_sel_hi:[1,0] neg_lo:[0,1] neg_hi:[0,1]
    v_pk_mul_f32 v[74:75], v[168:169], v[168:169]
    v_pk_mul_f32 v[76:77], v[170:171], v[170:171]
    v_pk_fma_f32 v[74:75], v[172:173], v[172:173], v[74:75]
    v_pk_fma_f32 v[76:77], v[174:175], v[174:175], v[76:77]
    v_pk_fma_f32 v[74:75], v[176:177], v[176:177], v[74:75]
    v_pk_fma_f32 v[76:77], v[178:179], v[178:179], v[76:77]
    v_pk_fma_f32 v[74:75], v[180:181], v[180:181], v[74:75]
    v_pk_fma_f32 v[76:77], v[182:183], v[182:183], v[76:77]
    v_pk_fma_f32 v[74:75], v[184:185], v[184:185], v[74:75]
    v_pk_fma_f32 v[76:77], v[186:187], v[186:187], v[76:77]
    v_pk_fma_f32 v[74:75], v[188:189], v[188:189], v[74:75]
    v_pk_fma_f32 v[76:77], v[190:191], v[190:191], v[76:77]
    v_pk_add_f32 v[74:75], v[74:75], v[76:77]
    v_add_f32 v74, v74, v75
    v_cndmask_b32 v74, 0, v74, vcc
    s_nop 1
    v_add_f32_dpp v74, v74, v74 row_ror:1 row_mask:0xf bank_mask:0xf
    s_nop 1
    v_add_f32_dpp v74, v74, v74 row_ror:2 row_mask:0xf bank_mask:0xf
    s_nop 1
    v_add_f32_dpp v74, v74, v74 row_ror:4 row_mask:0xf bank_mask:0xf
    s_nop 1
    v_add_f32_dpp v74, v74, v74 row_ror:8 row_mask:0xf bank_mask:0xf
    v_mov_b32 v76, v74
    s_nop 1
    v_permlane16_swap_b32 v74, v76
    s_nop 0
    v_add_f32 v74, v74, v76
    v_mul_f32 v74, 0x3ae38e39, v74
    v_cvt_pk_bf16_f32 v76, v72, v74
    v_and_b32 v74, 0xffff0000, v76
    v_lshlrev_b32 v72, 16, v76
    v_add_f32 v74, 0x3727c5ac, v74
    v_cvt_pk_bf16_f32 v74, v74, v74
    v_and_b32 v74, 0xffff0000, v74
    v_sqrt_f32 v74, v74
    v_pk_add_f32 v[168:169], v[144:145], v[72:73] op_sel_hi:[1,0] neg_lo:[0,1] neg_hi:[0,1]
    v_pk_add_f32 v[170:171], v[146:147], v[72:73] op_sel_hi:[1,0] neg_lo:[0,1] neg_hi:[0,1]
    v_pk_add_f32 v[172:173], v[148:149], v[72:73] op_sel_hi:[1,0] neg_lo:[0,1] neg_hi:[0,1]
    v_pk_add_f32 v[174:175], v[150:151], v[72:73] op_sel_hi:[1,0] neg_lo:[0,1] neg_hi:[0,1]
    v_pk_add_f32 v[176:177], v[152:153], v[72:73] op_sel_hi:[1,0] neg_lo:[0,1] neg_hi:[0,1]
    v_pk_add_f32 v[178:179], v[154:155], v[72:73] op_sel_hi:[1,0] neg_lo:[0,1] neg_hi:[0,1]
    v_pk_add_f32 v[180:181], v[156:157], v[72:73] op_sel_hi:[1,0] neg_lo:[0,1] neg_hi:[0,1]
    v_pk_add_f32 v[182:183], v[158:159], v[72:73] op_sel_hi:[1,0] neg_lo:[0,1] neg_hi:[0,1]
    v_pk_add_f32 v[184:185], v[160:161], v[72:73] op_sel_hi:[1,0] neg_lo:[0,1] neg_hi:[0,1]
    v_pk_add_f32 v[186:187], v[162:163], v[72:73] op_sel_hi:[1,0] neg_lo:[0,1] neg_hi:[0,1]
    v_pk_add_f32 v[188:189], v[164:165], v[72:73] op_sel_hi:[1,0] neg_lo:[0,1] neg_hi:[0,1]
    v_pk_add_f32 v[190:191], v[166:167], v[72:73] op_sel_hi:[1,0] neg_lo:[0,1] neg_hi:[0,1]
    v_cvt_pk_bf16_f32 v74, v74, v74
    v_and_b32 v74, 0xffff0000, v74
    v_rcp_f32 v74, v74
    v_cvt_pk_bf16_f32 v108, v168, v169
    v_cvt_pk_bf16_f32 v109, v170, v171
    v_cvt_pk_bf16_f32 v110, v172, v173
    v_cvt_pk_bf16_f32 v111, v174, v175
    v_cvt_pk_bf16_f32 v112, v176, v177
    v_cvt_pk_bf16_f32 v113, v178, v179
    v_cvt_pk_bf16_f32 v114, v180, v181
    v_cvt_pk_bf16_f32 v115, v182, v183
    v_cvt_pk_bf16_f32 v116, v184, v185
    v_cvt_pk_bf16_f32 v117, v186, v187
    v_cvt_pk_bf16_f32 v118, v188, v189
    v_cvt_pk_bf16_f32 v119, v190, v191
    v_lshlrev_b32 v168, 16, v108
    v_and_b32 v169, 0xffff0000, v108
    v_lshlrev_b32 v170, 16, v109
    v_and_b32 v171, 0xffff0000, v109
    v_lshlrev_b32 v172, 16, v110
    v_and_b32 v173, 0xffff0000, v110
    v_lshlrev_b32 v174, 16, v111
    v_and_b32 v175, 0xffff0000, v111
    v_lshlrev_b32 v176, 16, v112
    v_and_b32 v177, 0xffff0000, v112
    v_lshlrev_b32 v178, 16, v113
    v_and_b32 v179, 0xffff0000, v113
    v_lshlrev_b32 v180, 16, v114
    v_and_b32 v181, 0xffff0000, v114
    v_lshlrev_b32 v182, 16, v115
    v_and_b32 v183, 0xffff0000, v115
    v_lshlrev_b32 v184, 16, v116
    v_and_b32 v185, 0xffff0000, v116
    v_lshlrev_b32 v186, 16, v117
    v_and_b32 v187, 0xffff0000, v117
    v_lshlrev_b32 v188, 16, v118
    v_and_b32 v189, 0xffff0000, v118
    v_lshlrev_b32 v190, 16, v119
    v_and_b32 v191, 0xffff0000, v119
    v_pk_mul_f32 v[168:169], v[168:169], v[74:75] op_sel_hi:[1,0]
    v_pk_mul_f32 v[170:171], v[170:171], v[74:75] op_sel_hi:[1,0]
    v_pk_mul_f32 v[172:173], v[172:173], v[74:75] op_sel_hi:[1,0]
    v_pk_mul_f32 v[174:175], v[174:175], v[74:75] op_sel_hi:[1,0]
    v_pk_mul_f32 v[176:177], v[176:177], v[74:75] op_sel_hi:[1,0]
    v_pk_mul_f32 v[178:179], v[178:179], v[74:75] op_sel_hi:[1,0]
    v_pk_mul_f32 v[180:181], v[180:181], v[74:75] op_sel_hi:[1,0]
    v_pk_mul_f32 v[182:183], v[182:183], v[74:75] op_sel_hi:[1,0]
    v_pk_mul_f32 v[184:185], v[184:185], v[74:75] op_sel_hi:[1,0]
    v_pk_mul_f32 v[186:187], v[186:187], v[74:75] op_sel_hi:[1,0]
    v_pk_mul_f32 v[188:189], v[188:189], v[74:75] op_sel_hi:[1,0]
    v_pk_mul_f32 v[190:191], v[190:191], v[74:75] op_sel_hi:[1,0]
    v_cvt_pk_bf16_f32 v108, v168, v169
    v_cvt_pk_bf16_f32 v109, v170, v171
    v_cvt_pk_bf16_f32 v110, v172, v173
    v_cvt_pk_bf16_f32 v111, v174, v175
    v_cvt_pk_bf16_f32 v112, v176, v177
    v_cvt_pk_bf16_f32 v113, v178, v179
    v_cvt_pk_bf16_f32 v114, v180, v181
    v_cvt_pk_bf16_f32 v115, v182, v183
    v_cvt_pk_bf16_f32 v116, v184, v185
    v_cvt_pk_bf16_f32 v117, v186, v187
    v_cvt_pk_bf16_f32 v118, v188, v189
    v_cvt_pk_bf16_f32 v119, v190, v191
    v_lshlrev_b32 v168, 16, v108
    v_and_b32 v169, 0xffff0000, v108
    v_lshlrev_b32 v170, 16, v109
    v_and_b32 v171, 0xffff0000, v109
    v_lshlrev_b32 v172, 16, v110
    v_and_b32 v173, 0xffff0000, v110
    v_lshlrev_b32 v174, 16, v111
    v_and_b32 v175, 0xffff0000, v111
    v_lshlrev_b32 v176, 16, v112
    v_and_b32 v177, 0xffff0000, v112
    v_lshlrev_b32 v178, 16, v113
    v_and_b32 v179, 0xffff0000, v113
    v_lshlrev_b32 v180, 16, v114
    v_and_b32 v181, 0xffff0000, v114
    v_lshlrev_b32 v182, 16, v115
    v_and_b32 v183, 0xffff0000, v115
    v_lshlrev_b32 v184, 16, v116
    v_and_b32 v185, 0xffff0000, v116
    v_lshlrev_b32 v186, 16, v117
    v_and_b32 v187, 0xffff0000, v117
    v_lshlrev_b32 v188, 16, v118
    v_and_b32 v189, 0xffff0000, v118
    v_lshlrev_b32 v190, 16, v119
    v_and_b32 v191, 0xffff0000, v119
    s_mul_i32 s36, s3, 72
    v_add_u32 v72, s36, v1
    v_and_b32 v73, 7, v1
    s_add_u32 s36, s36, 64
    v_add_u32 v73, s36, v73
    s_movk_i32 s36, 1024
    v_and_b32 v76, 3, v72
    v_lshlrev_b32 v76, 4, v76
    v_lshrrev_b32 v72, 2, v72
    v_lshl_add_u32 v74, v72, 7, v76
    v_and_b32 v77, 1, v72
    v_lshl_add_u32 v76, v77, 3, v76
    v_lshrrev_b32 v72, 1, v72
    v_lshl_add_u32 v72, v72, 6, v76
    v_add_u32 v72, s36, v72
    v_and_b32 v76, 3, v73
    v_lshlrev_b32 v76, 4, v76
    v_lshrrev_b32 v73, 2, v73
    v_lshl_add_u32 v75, v73, 7, v76
    v_and_b32 v77, 1, v73
    v_lshl_add_u32 v76, v77, 3, v76
    v_lshrrev_b32 v73, 1, v73
    v_lshl_add_u32 v73, v73, 6, v76
    v_add_u32 v73, s36, v73
    s_mov_b64 exec, 0
    s_cmp_eq_u32 s3, 0
    s_cbranch_scc1 Ltour0
    s_cmp_eq_u32 s3, 1
    s_cbranch_scc1 Ltour1
    s_cmp_eq_u32 s3, 2
    s_cbranch_scc1 Ltour2
    s_branch Ltour3
.p2align 12
Lmain:
    s_mov_b64 exec, -1
    s_mov_b32 s38, 16384
Lhead_pollm:
    buffer_load_dwordx4 v[88:91], v74, s[24:27], s37 offen sc1
    buffer_load_dwordx4 v[92:95], v75, s[24:27], s37 offen sc1
    s_sub_u32 s38, s38, 1
    s_cbranch_scc1 Lhead_gotm
    s_waitcnt vmcnt(0) lgkmcnt(0)
    v_xor_b32 v89, s95, v89
    v_xor_b32 v91, s95, v91
    v_xor_b32 v93, s95, v93
    v_xor_b32 v95, s95, v95
    v_or3_b32 v89, v89, v91, v93
    v_or_b32 v89, v89, v95
    v_cmp_ne_u32 vcc, 0, v89
    s_cbranch_vccnz Lhead_pollm
Lhead_gotm:
    s_waitcnt vmcnt(0) lgkmcnt(0)
    ds_write2_b32 v72, v88, v90 offset0:0 offset1:1
    ds_write2_b32 v73, v92, v94 offset0:0 offset1:1
    s_waitcnt lgkmcnt(0)
    s_barrier
    ds_read_b128 v[144:147], v68 offset:2176
    ds_read_b128 v[148:151], v68 offset:2560
    ds_read_b128 v[152:155], v68 offset:2944
    ds_read_b128 v[156:159], v68 offset:1024
    ds_read_b128 v[160:163], v68 offset:1408
    ds_read_b128 v[164:167], v68 offset:1792
    s_waitcnt lgkmcnt(5)
    v_lshlrev_b32 v192, 16, v144
    v_and_b32 v193, 0xffff0000, v144
    v_lshlrev_b32 v194, 16, v145
    v_and_b32 v195, 0xffff0000, v145
    v_lshlrev_b32 v196, 16, v146
    v_and_b32 v197, 0xffff0000, v146
    v_lshlrev_b32 v198, 16, v147
    v_and_b32 v199, 0xffff0000, v147
    s_waitcnt lgkmcnt(4)
    v_lshlrev_b32 v200, 16, v148
    v_and_b32 v201, 0xffff0000, v148
    v_lshlrev_b32 v202, 16, v149
    v_and_b32 v203, 0xffff0000, v149
    v_lshlrev_b32 v204, 16, v150
    v_and_b32 v205, 0xffff0000, v150
    v_lshlrev_b32 v206, 16, v151
    v_and_b32 v207, 0xffff0000, v151
    s_waitcnt lgkmcnt(3)
    v_lshlrev_b32 v208, 16, v152
    v_and_b32 v209, 0xffff0000, v152
    v_lshlrev_b32 v210, 16, v153
    v_and_b32 v211, 0xffff0000, v153
    v_lshlrev_b32 v212, 16, v154
    v_and_b32 v213, 0xffff0000, v154
    v_lshlrev_b32 v214, 16, v155
    v_and_b32 v215, 0xffff0000, v155
    v_pk_mul_f32 v[168:169], v[168:169], v[192:193]
    v_pk_mul_f32 v[170:171], v[170:171], v[194:195]
    v_pk_mul_f32 v[172:173], v[172:173], v[196:197]
    v_pk_mul_f32 v[174:175], v[174:175], v[198:199]
    v_pk_mul_f32 v[176:177], v[176:177], v[200:201]
    v_pk_mul_f32 v[178:179], v[178:179], v[202:203]
    v_pk_mul_f32 v[180:181], v[180:181], v[204:205]
    v_pk_mul_f32 v[182:183], v[182:183], v[206:207]
    v_pk_mul_f32 v[184:185], v[184:185], v[208:209]
    v_pk_mul_f32 v[186:187], v[186:187], v[210:211]
    v_pk_mul_f32 v[188:189], v[188:189], v[212:213]
    v_pk_mul_f32 v[190:191], v[190:191], v[214:215]
    v_cvt_pk_bf16_f32 v108, v168, v169
    v_cvt_pk_bf16_f32 v109, v170, v171
    v_cvt_pk_bf16_f32 v110, v172, v173
    v_cvt_pk_bf16_f32 v111, v174, v175
    v_cvt_pk_bf16_f32 v112, v176, v177
    v_cvt_pk_bf16_f32 v113, v178, v179
    v_cvt_pk_bf16_f32 v114, v180, v181
    v_cvt_pk_bf16_f32 v115, v182, v183
    v_cvt_pk_bf16_f32 v116, v184, v185
    v_cvt_pk_bf16_f32 v117, v186, v187
    v_cvt_pk_bf16_f32 v118, v188, v189
    v_cvt_pk_bf16_f32 v119, v190, v191
    s_waitcnt lgkmcnt(2)
    v_lshlrev_b32 v216, 16, v156
    v_and_b32 v217, 0xffff0000, v156
    v_lshlrev_b32 v218, 16, v157
    v_and_b32 v219, 0xffff0000, v157
    v_lshlrev_b32 v220, 16, v158
    v_and_b32 v221, 0xffff0000, v158
    v_lshlrev_b32 v222, 16, v159
    v_and_b32 v223, 0xffff0000, v159
    s_waitcnt lgkmcnt(1)
    v_lshlrev_b32 v224, 16, v160
    v_and_b32 v225, 0xffff0000, v160
    v_lshlrev_b32 v226, 16, v161
    v_and_b32 v227, 0xffff0000, v161
    v_lshlrev_b32 v228, 16, v162
    v_and_b32 v229, 0xffff0000, v162
    v_lshlrev_b32 v230, 16, v163
    v_and_b32 v231, 0xffff0000, v163
    s_waitcnt lgkmcnt(0)
    v_lshlrev_b32 v232, 16, v164
    v_and_b32 v233, 0xffff0000, v164
    v_lshlrev_b32 v234, 16, v165
    v_and_b32 v235, 0xffff0000, v165
    v_lshlrev_b32 v236, 16, v166
    v_and_b32 v237, 0xffff0000, v166
    v_lshlrev_b32 v238, 16, v167
    v_and_b32 v239, 0xffff0000, v167
    v_lshlrev_b32 v168, 16, v108
    v_and_b32 v169, 0xffff0000, v108
    v_lshlrev_b32 v170, 16, v109
    v_and_b32 v171, 0xffff0000, v109
    v_lshlrev_b32 v172, 16, v110
    v_and_b32 v173, 0xffff0000, v110
    v_lshlrev_b32 v174, 16, v111
    v_and_b32 v175, 0xffff0000, v111
    v_lshlrev_b32 v176, 16, v112
    v_and_b32 v177, 0xffff0000, v112
    v_lshlrev_b32 v178, 16, v113
    v_and_b32 v179, 0xffff0000, v113
    v_lshlrev_b32 v180, 16, v114
    v_and_b32 v181, 0xffff0000, v114
    v_lshlrev_b32 v182, 16, v115
    v_and_b32 v183, 0xffff0000, v115
    v_lshlrev_b32 v184, 16, v116
    v_and_b32 v185, 0xffff0000, v116
    v_lshlrev_b32 v186, 16, v117
    v_and_b32 v187, 0xffff0000, v117
    v_lshlrev_b32 v188, 16, v118
    v_and_b32 v189, 0xffff0000, v118
    v_lshlrev_b32 v190, 16, v119
    v_and_b32 v191, 0xffff0000, v119
    v_pk_add_f32 v[168:169], v[168:169], v[216:217]
    v_pk_add_f32 v[170:171], v[170:171], v[218:219]
    v_pk_add_f32 v[172:173], v[172:173], v[220:221]
    v_pk_add_f32 v[174:175], v[174:175], v[222:223]
    v_cvt_pk_bf16_f32 v108, v168, v169
    v_cvt_pk_bf16_f32 v109, v170, v171
    v_cvt_pk_bf16_f32 v110, v172, v173
    v_cvt_pk_bf16_f32 v111, v174, v175
    buffer_store_dwordx4 v[108:111], v67, s[24:27], s92 offen offset:0 sc1
    v_pk_add_f32 v[176:177], v[176:177], v[224:225]
    v_pk_add_f32 v[178:179], v[178:179], v[226:227]
    v_pk_add_f32 v[180:181], v[180:181], v[228:229]
    v_pk_add_f32 v[182:183], v[182:183], v[230:231]
    v_cvt_pk_bf16_f32 v112, v176, v177
    v_cvt_pk_bf16_f32 v113, v178, v179
    v_cvt_pk_bf16_f32 v114, v180, v181
    v_cvt_pk_bf16_f32 v115, v182, v183
    buffer_store_dwordx4 v[112:115], v67, s[24:27], s92 offen offset:768 sc1
    v_pk_add_f32 v[184:185], v[184:185], v[232:233]
    v_pk_add_f32 v[186:187], v[186:187], v[234:235]
    v_pk_add_f32 v[188:189], v[188:189], v[236:237]
    v_pk_add_f32 v[190:191], v[190:191], v[238:239]
    v_cvt_pk_bf16_f32 v116, v184, v185
    v_cvt_pk_bf16_f32 v117, v186, v187
    v_cvt_pk_bf16_f32 v118, v188, v189
    v_cvt_pk_bf16_f32 v119, v190, v191
    buffer_store_dwordx4 v[116:119], v67, s[24:27], s92 offen offset:1536 sc1
    s_lshl_b32 s36, s5, 13
    s_add_u32 s36, s36, 8650752
    s_lshl_b32 s37, s4, 9
    s_add_u32 s37, s37, s36
    s_lshl_b32 s38, s3, 7
    s_add_u32 s37, s37, s38
    s_lshl_b32 s38, s3, 11
    s_add_u32 s36, s36, s38
    v_min_u32 v72, 1, v1
    v_lshlrev_b32 v72, 31, v72
    v_and_b32 v73, 15, v1
    v_lshlrev_b32 v73, 7, v73
    v_cmp_gt_u32 vcc, 162, v0
    v_mov_b32 v88, -1
    v_mov_b32 v89, -1
    v_mov_b32 v90, -1
    v_mov_b32 v91, -1
    s_mul_i32 s39, s2, 2592
    s_add_u32 s39, s39, 7864320
    v_lshl_add_u32 v74, v0, 4, s39
    s_lshl_b32 s39, s2, 7
    s_add_u32 s39, s39, 8912896
    v_mov_b32 v75, s39
    v_cndmask_b32 v74, v75, v74, vcc
    s_lshl_b32 s92, s5, 13
    s_add_u32 s92, s92, 8781824
    s_add_u32 s92, s92, s38
    s_lshl_b32 s38, s4, 7
    s_add_u32 s92, s92, s38
    s_getreg_b32 s38, hwreg(HW_REG_XCC_ID, 0, 4)
    s_add_u32 s38, s38, s95
    v_mov_b32 v76, s38
    v_mov_b32 v2, v80
    v_mov_b32 v3, v81
    v_mov_b32 v4, v82
    v_mov_b32 v5, v83
    v_mov_b32 v6, v84
    v_mov_b32 v7, v65
    s_waitcnt vmcnt(0)
    buffer_store_dword v137, v72, s[24:27], s37 offen sc1
    s_add_u32 s49, s44, 0
    s_add_u32 m0, s42, 32768
    s_nop 0
    buffer_load_dwordx4 v42, s[16:19], s49 offen lds
    buffer_load_dwordx4 v43, s[16:19], s49 offen offset:1024 lds
    buffer_load_dwordx4 v44, s[16:19], s49 offen offset:2048 lds
    buffer_load_dwordx4 v45, s[16:19], s49 offen offset:3072 lds
    s_add_u32 s49, s44, 256
    s_add_u32 m0, s42, 49152
    s_nop 0
    buffer_load_dwordx4 v42, s[16:19], s49 offen lds
    buffer_load_dwordx4 v43, s[16:19], s49 offen offset:1024 lds
    buffer_load_dwordx4 v44, s[16:19], s49 offen offset:2048 lds
    buffer_load_dwordx4 v45, s[16:19], s49 offen offset:3072 lds
    s_add_u32 s49, s44, 524288
    s_add_u32 m0, s42, 65536
    s_nop 0
    buffer_load_dwordx4 v42, s[16:19], s49 offen lds
    buffer_load_dwordx4 v43, s[16:19], s49 offen offset:1024 lds
    buffer_load_dwordx4 v44, s[16:19], s49 offen offset:2048 lds
    buffer_load_dwordx4 v45, s[16:19], s49 offen offset:3072 lds
    s_add_u32 s49, s44, 524544
    s_add_u32 m0, s42, 81920
    s_nop 0
    buffer_load_dwordx4 v42, s[16:19], s49 offen lds
    buffer_load_dwordx4 v43, s[16:19], s49 offen offset:1024 lds
    buffer_load_dwordx4 v44, s[16:19], s49 offen offset:2048 lds
    buffer_load_dwordx4 v45, s[16:19], s49 offen offset:3072 lds
    s_add_u32 s49, s44, 1048576
    s_add_u32 m0, s42, 98304
    s_nop 0
    buffer_load_dwordx4 v42, s[16:19], s49 offen lds
    buffer_load_dwordx4 v43, s[16:19], s49 offen offset:1024 lds
    buffer_load_dwordx4 v44, s[16:19], s49 offen offset:2048 lds
    buffer_load_dwordx4 v45, s[16:19], s49 offen offset:3072 lds
    s_add_u32 s49, s44, 1048832
    s_add_u32 m0, s42, 114688
    s_nop 0
    buffer_load_dwordx4 v42, s[16:19], s49 offen lds
    buffer_load_dwordx4 v43, s[16:19], s49 offen offset:1024 lds
    buffer_load_dwordx4 v44, s[16:19], s49 offen offset:2048 lds
    buffer_load_dwordx4 v45, s[16:19], s49 offen offset:3072 lds
    s_mov_b32 s38, 16384
Lhead_pollh:
    buffer_load_dword v75, v73, s[24:27], s36 offen sc1
    s_sub_u32 s38, s38, 1
    s_cbranch_scc1 Lhead_goth
    s_waitcnt vmcnt(0) lgkmcnt(0)
    v_cmp_ne_u32 vcc, s95, v75
    s_cbranch_vccnz Lhead_pollh
Lhead_goth:
    s_waitcnt vmcnt(0) lgkmcnt(0)
    buffer_load_dwordx4 a[0:3], v51, s[24:27], s46 offen offset:0 sc1
    buffer_load_dwordx4 a[8:11], v51, s[24:27], s46 offen offset:128 sc1
    buffer_load_dwordx4 a[4:7], v51, s[24:27], s43 offen offset:0 sc1
    buffer_load_dwordx4 a[12:15], v51, s[24:27], s43 offen offset:128 sc1
    s_barrier
    ds_read_b64_tr_b16 a[160:161], v12 offset:32768
    ds_read_b64_tr_b16 a[162:163], v12 offset:36864
    ds_read_b64_tr_b16 a[164:165], v12 offset:40960
    ds_read_b64_tr_b16 a[166:167], v12 offset:45056
    ds_read_b64_tr_b16 a[168:169], v13 offset:32768
    ds_read_b64_tr_b16 a[170:171], v13 offset:36864
    ds_read_b64_tr_b16 a[172:173], v13 offset:40960
    ds_read_b64_tr_b16 a[174:175], v13 offset:45056
    ds_read_b64_tr_b16 a[176:177], v14 offset:32768
    ds_read_b64_tr_b16 a[178:179], v14 offset:36864
    ds_read_b64_tr_b16 a[180:181], v14 offset:40960
    ds_read_b64_tr_b16 a[182:183], v14 offset:45056
    buffer_load_dwordx4 a[16:19], v51, s[24:27], s46 offen offset:256 sc1
    buffer_load_dwordx4 a[24:27], v51, s[24:27], s46 offen offset:384 sc1
    buffer_load_dwordx4 a[20:23], v51, s[24:27], s43 offen offset:256 sc1
    buffer_load_dwordx4 a[28:31], v51, s[24:27], s43 offen offset:384 sc1
    s_waitcnt lgkmcnt(10)
    s_waitcnt vmcnt(7)
    v_mfma_f32_16x16x32_bf16 v[128:131], a[160:163], a[0:3], 0
    s_waitcnt vmcnt(6)
    s_waitcnt lgkmcnt(8)
    ds_read_b64_tr_b16 a[184:185], v15 offset:32768
    v_mfma_f32_16x16x32_bf16 v[128:131], a[164:167], a[8:11], v[128:131]
    s_waitcnt vmcnt(5)
    ds_read_b64_tr_b16 a[186:187], v15 offset:36864
    v_mfma_f32_16x16x32_bf16 v[132:135], a[160:163], a[4:7], 0
    s_waitcnt vmcnt(4)
    ds_read_b64_tr_b16 a[188:189], v15 offset:40960
    v_mfma_f32_16x16x32_bf16 v[132:135], a[164:167], a[12:15], v[132:135]
    s_waitcnt lgkmcnt(9)
    buffer_load_dwordx4 a[32:35], v51, s[24:27], s46 offen offset:512 sc1
    v_mfma_f32_16x16x32_bf16 v[136:139], a[168:171], a[0:3], 0
    s_waitcnt lgkmcnt(7)
    ds_read_b64_tr_b16 a[190:191], v15 offset:45056
    ds_read_b64_tr_b16 a[160:161], v16 offset:32768
    v_mfma_f32_16x16x32_bf16 v[136:139], a[172:175], a[8:11], v[136:139]
    ds_read_b64_tr_b16 a[162:163], v16 offset:36864
    v_mfma_f32_16x16x32_bf16 v[140:143], a[168:171], a[4:7], 0
    ds_read_b64_tr_b16 a[164:165], v16 offset:40960
    v_mfma_f32_16x16x32_bf16 v[140:143], a[172:175], a[12:15], v[140:143]
    s_waitcnt lgkmcnt(9)
    buffer_load_dwordx4 a[40:43], v51, s[24:27], s46 offen offset:640 sc1
    v_mfma_f32_16x16x32_bf16 v[144:147], a[176:179], a[0:3], 0
    s_waitcnt lgkmcnt(7)
    ds_read_b64_tr_b16 a[166:167], v16 offset:45056
    ds_read_b64_tr_b16 a[168:169], v17 offset:32768
    v_mfma_f32_16x16x32_bf16 v[144:147], a[180:183], a[8:11], v[144:147]
    ds_read_b64_tr_b16 a[170:171], v17 offset:36864
    v_mfma_f32_16x16x32_bf16 v[148:151], a[176:179], a[4:7], 0
    ds_read_b64_tr_b16 a[172:173], v17 offset:40960
    v_mfma_f32_16x16x32_bf16 v[148:151], a[180:183], a[12:15], v[148:151]
    s_waitcnt lgkmcnt(9)
    buffer_load_dwordx4 a[36:39], v51, s[24:27], s43 offen offset:512 sc1
    v_mfma_f32_16x16x32_bf16 v[152:155], a[184:187], a[0:3], 0
    s_waitcnt lgkmcnt(7)
    ds_read_b64_tr_b16 a[174:175], v17 offset:45056
    ds_read_b64_tr_b16 a[176:177], v18 offset:32768
    v_mfma_f32_16x16x32_bf16 v[152:155], a[188:191], a[8:11], v[152:155]
    ds_read_b64_tr_b16 a[178:179], v18 offset:36864
    v_mfma_f32_16x16x32_bf16 v[156:159], a[184:187], a[4:7], 0
    ds_read_b64_tr_b16 a[180:181], v18 offset:40960
    v_mfma_f32_16x16x32_bf16 v[156:159], a[188:191], a[12:15], v[156:159]
    s_waitcnt lgkmcnt(9)
    buffer_load_dwordx4 a[44:47], v51, s[24:27], s43 offen offset:640 sc1
    v_mfma_f32_16x16x32_bf16 v[160:163], a[160:163], a[0:3], 0
    s_waitcnt lgkmcnt(7)
    ds_read_b64_tr_b16 a[182:183], v18 offset:45056
    ds_read_b64_tr_b16 a[184:185], v19 offset:32768
    v_mfma_f32_16x16x32_bf16 v[160:163], a[164:167], a[8:11], v[160:163]
    ds_read_b64_tr_b16 a[186:187], v19 offset:36864
    v_mfma_f32_16x16x32_bf16 v[164:167], a[160:163], a[4:7], 0
    ds_read_b64_tr_b16 a[188:189], v19 offset:40960
    v_mfma_f32_16x16x32_bf16 v[164:167], a[164:167], a[12:15], v[164:167]
    s_waitcnt lgkmcnt(9)
    buffer_load_dword v77, v70, s[16:19], s44 offen
    v_mfma_f32_16x16x32_bf16 v[168:171], a[168:171], a[0:3], 0
    s_waitcnt lgkmcnt(7)
    ds_read_b64_tr_b16 a[190:191], v19 offset:45056
    ds_read_b64_tr_b16 a[160:161], v12 offset:49152
    v_mfma_f32_16x16x32_bf16 v[168:171], a[172:175], a[8:11], v[168:171]
    ds_read_b64_tr_b16 a[162:163], v12 offset:53248
    v_mfma_f32_16x16x32_bf16 v[172:175], a[168:171], a[4:7], 0
    ds_read_b64_tr_b16 a[164:165], v12 offset:57344
    v_mfma_f32_16x16x32_bf16 v[172:175], a[172:175], a[12:15], v[172:175]
    s_waitcnt lgkmcnt(9)
    ds_read_b64_tr_b16 a[166:167], v12 offset:61440
    v_mfma_f32_16x16x32_bf16 v[176:179], a[176:179], a[0:3], 0
    s_waitcnt lgkmcnt(8)
    ds_read_b64_tr_b16 a[168:169], v13 offset:49152
    v_mfma_f32_16x16x32_bf16 v[176:179], a[180:183], a[8:11], v[176:179]
    ds_read_b64_tr_b16 a[170:171], v13 offset:53248
    v_mfma_f32_16x16x32_bf16 v[180:183], a[176:179], a[4:7], 0
    ds_read_b64_tr_b16 a[172:173], v13 offset:57344
    v_mfma_f32_16x16x32_bf16 v[180:183], a[180:183], a[12:15], v[180:183]
    s_waitcnt lgkmcnt(9)
    ds_read_b64_tr_b16 a[174:175], v13 offset:61440
    v_mfma_f32_16x16x32_bf16 v[184:187], a[184:187], a[0:3], 0
    s_waitcnt lgkmcnt(8)
    ds_read_b64_tr_b16 a[176:177], v14 offset:49152
    v_mfma_f32_16x16x32_bf16 v[184:187], a[188:191], a[8:11], v[184:187]
    ds_read_b64_tr_b16 a[178:179], v14 offset:53248
    v_mfma_f32_16x16x32_bf16 v[188:191], a[184:187], a[4:7], 0
    ds_read_b64_tr_b16 a[180:181], v14 offset:57344
    v_mfma_f32_16x16x32_bf16 v[188:191], a[188:191], a[12:15], v[188:191]
    s_waitcnt lgkmcnt(9)
    ds_read_b64_tr_b16 a[182:183], v14 offset:61440
    v_mfma_f32_16x16x32_bf16 v[192:195], a[160:163], a[0:3], 0
    s_waitcnt lgkmcnt(8)
    ds_read_b64_tr_b16 a[184:185], v15 offset:49152
    v_mfma_f32_16x16x32_bf16 v[192:195], a[164:167], a[8:11], v[192:195]
    ds_read_b64_tr_b16 a[186:187], v15 offset:53248
    v_mfma_f32_16x16x32_bf16 v[196:199], a[160:163], a[4:7], 0
    ds_read_b64_tr_b16 a[188:189], v15 offset:57344
    v_mfma_f32_16x16x32_bf16 v[196:199], a[164:167], a[12:15], v[196:199]
    s_waitcnt lgkmcnt(9)
    ds_read_b64_tr_b16 a[190:191], v15 offset:61440
    v_mfma_f32_16x16x32_bf16 v[200:203], a[168:171], a[0:3], 0
    s_waitcnt lgkmcnt(8)
    ds_read_b64_tr_b16 a[160:161], v16 offset:49152
    v_mfma_f32_16x16x32_bf16 v[200:203], a[172:175], a[8:11], v[200:203]
    ds_read_b64_tr_b16 a[162:163], v16 offset:53248
    v_mfma_f32_16x16x32_bf16 v[204:207], a[168:171], a[4:7], 0
    ds_read_b64_tr_b16 a[164:165], v16 offset:57344
    v_mfma_f32_16x16x32_bf16 v[204:207], a[172:175], a[12:15], v[204:207]
    s_waitcnt lgkmcnt(9)
    ds_read_b64_tr_b16 a[166:167], v16 offset:61440
    v_mfma_f32_16x16x32_bf16 v[208:211], a[176:179], a[0:3], 0
    s_waitcnt lgkmcnt(8)
    ds_read_b64_tr_b16 a[168:169], v17 offset:49152
    v_mfma_f32_16x16x32_bf16 v[208:211], a[180:183], a[8:11], v[208:211]
    ds_read_b64_tr_b16 a[170:171], v17 offset:53248
    v_mfma_f32_16x16x32_bf16 v[212:215], a[176:179], a[4:7], 0
    ds_read_b64_tr_b16 a[172:173], v17 offset:57344
    v_mfma_f32_16x16x32_bf16 v[212:215], a[180:183], a[12:15], v[212:215]
    s_waitcnt lgkmcnt(9)
    ds_read_b64_tr_b16 a[174:175], v17 offset:61440
    v_mfma_f32_16x16x32_bf16 v[216:219], a[184:187], a[0:3], 0
    s_waitcnt lgkmcnt(8)
    ds_read_b64_tr_b16 a[176:177], v18 offset:49152
    v_mfma_f32_16x16x32_bf16 v[216:219], a[188:191], a[8:11], v[216:219]
    ds_read_b64_tr_b16 a[178:179], v18 offset:53248
    v_mfma_f32_16x16x32_bf16 v[220:223], a[184:187], a[4:7], 0
    ds_read_b64_tr_b16 a[180:181], v18 offset:57344
    v_mfma_f32_16x16x32_bf16 v[220:223], a[188:191], a[12:15], v[220:223]
    s_waitcnt lgkmcnt(9)
    ds_read_b64_tr_b16 a[182:183], v18 offset:61440
    v_mfma_f32_16x16x32_bf16 v[224:227], a[160:163], a[0:3], 0
    s_waitcnt lgkmcnt(8)
    ds_read_b64_tr_b16 a[184:185], v19 offset:49152
    v_mfma_f32_16x16x32_bf16 v[224:227], a[164:167], a[8:11], v[224:227]
    ds_read_b64_tr_b16 a[186:187], v19 offset:53248
    v_mfma_f32_16x16x32_bf16 v[228:231], a[160:163], a[4:7], 0
    ds_read_b64_tr_b16 a[188:189], v19 offset:57344
    v_mfma_f32_16x16x32_bf16 v[228:231], a[164:167], a[12:15], v[228:231]
    s_waitcnt lgkmcnt(9)
    ds_read_b64_tr_b16 a[190:191], v19 offset:61440
    s_barrier
    v_mfma_f32_16x16x32_bf16 v[232:235], a[168:171], a[0:3], 0
    s_waitcnt lgkmcnt(8)
    ds_read_b64_tr_b16 a[160:161], v20 offset:0
    v_mfma_f32_16x16x32_bf16 v[232:235], a[172:175], a[8:11], v[232:235]
    s_add_u32 s49, s44, 1572864
    ds_read_b64_tr_b16 a[162:163], v20 offset:4096
    v_mfma_f32_16x16x32_bf16 v[236:239], a[168:171], a[4:7], 0
    s_add_u32 m0, s42, 131072
    ds_read_b64_tr_b16 a[164:165], v20 offset:8192
    v_mfma_f32_16x16x32_bf16 v[236:239], a[172:175], a[12:15], v[236:239]
    s_waitcnt lgkmcnt(9)
    buffer_load_dwordx4 v42, s[16:19], s49 offen lds
    v_mfma_f32_16x16x32_bf16 v[240:243], a[176:179], a[0:3], 0
    s_waitcnt lgkmcnt(7)
    ds_read_b64_tr_b16 a[166:167], v20 offset:12288
    ds_read_b64_tr_b16 a[168:169], v21 offset:0
    v_mfma_f32_16x16x32_bf16 v[240:243], a[180:183], a[8:11], v[240:243]
    ds_read_b64_tr_b16 a[170:171], v21 offset:4096
    v_mfma_f32_16x16x32_bf16 v[244:247], a[176:179], a[4:7], 0
    ds_read_b64_tr_b16 a[172:173], v21 offset:8192
    v_mfma_f32_16x16x32_bf16 v[244:247], a[180:183], a[12:15], v[244:247]
    s_waitcnt lgkmcnt(9)
    buffer_load_dwordx4 v43, s[16:19], s49 offen offset:1024 lds
    v_mfma_f32_16x16x32_bf16 v[248:251], a[184:187], a[0:3], 0
    s_waitcnt lgkmcnt(7)
    ds_read_b64_tr_b16 a[174:175], v21 offset:12288
    ds_read_b64_tr_b16 a[176:177], v22 offset:0
    v_mfma_f32_16x16x32_bf16 v[248:251], a[188:191], a[8:11], v[248:251]
    ds_read_b64_tr_b16 a[178:179], v22 offset:4096
    v_mfma_f32_16x16x32_bf16 v[252:255], a[184:187], a[4:7], 0
    ds_read_b64_tr_b16 a[180:181], v22 offset:8192
    v_mfma_f32_16x16x32_bf16 v[252:255], a[188:191], a[12:15], v[252:255]
    s_waitcnt vmcnt(10)
    s_waitcnt lgkmcnt(9)
    buffer_load_dwordx4 v44, s[16:19], s49 offen offset:2048 lds
    v_mfma_f32_16x16x32_bf16 v[128:131], a[160:163], a[16:19], v[128:131]
    s_waitcnt vmcnt(10)
    s_waitcnt lgkmcnt(7)
    ds_read_b64_tr_b16 a[182:183], v22 offset:12288
    ds_read_b64_tr_b16 a[184:185], v23 offset:0
    v_mfma_f32_16x16x32_bf16 v[128:131], a[164:167], a[24:27], v[128:131]
    s_waitcnt vmcnt(9)
    ds_read_b64_tr_b16 a[186:187], v23 offset:4096
    v_mfma_f32_16x16x32_bf16 v[132:135], a[160:163], a[20:23], v[132:135]
    s_waitcnt vmcnt(8)
    ds_read_b64_tr_b16 a[188:189], v23 offset:8192
    v_mfma_f32_16x16x32_bf16 v[132:135], a[164:167], a[28:31], v[132:135]
    s_waitcnt lgkmcnt(9)
    buffer_load_dwordx4 v45, s[16:19], s49 offen offset:3072 lds
    v_mfma_f32_16x16x32_bf16 v[136:139], a[168:171], a[16:19], v[136:139]
    s_waitcnt lgkmcnt(7)
    ds_read_b64_tr_b16 a[190:191], v23 offset:12288
    ds_read_b64_tr_b16 a[160:161], v24 offset:0
    v_mfma_f32_16x16x32_bf16 v[136:139], a[172:175], a[24:27], v[136:139]
    s_add_u32 s49, s44, 1573120
    ds_read_b64_tr_b16 a[162:163], v24 offset:4096
    v_mfma_f32_16x16x32_bf16 v[140:143], a[168:171], a[20:23], v[140:143]
    s_add_u32 m0, s42, 147456
    ds_read_b64_tr_b16 a[164:165], v24 offset:8192
    v_mfma_f32_16x16x32_bf16 v[140:143], a[172:175], a[28:31], v[140:143]
    s_waitcnt lgkmcnt(9)
    buffer_load_dwordx4 v42, s[16:19], s49 offen lds
    v_mfma_f32_16x16x32_bf16 v[144:147], a[176:179], a[16:19], v[144:147]
    s_waitcnt lgkmcnt(7)
    ds_read_b64_tr_b16 a[166:167], v24 offset:12288
    ds_read_b64_tr_b16 a[168:169], v25 offset:0
    v_mfma_f32_16x16x32_bf16 v[144:147], a[180:183], a[24:27], v[144:147]
    ds_read_b64_tr_b16 a[170:171], v25 offset:4096
    v_mfma_f32_16x16x32_bf16 v[148:151], a[176:179], a[20:23], v[148:151]
    ds_read_b64_tr_b16 a[172:173], v25 offset:8192
    v_mfma_f32_16x16x32_bf16 v[148:151], a[180:183], a[28:31], v[148:151]
    s_waitcnt lgkmcnt(9)
    buffer_load_dwordx4 v43, s[16:19], s49 offen offset:1024 lds
    v_mfma_f32_16x16x32_bf16 v[152:155], a[184:187], a[16:19], v[152:155]
    s_waitcnt lgkmcnt(7)
    ds_read_b64_tr_b16 a[174:175], v25 offset:12288
    ds_read_b64_tr_b16 a[176:177], v26 offset:0
    v_mfma_f32_16x16x32_bf16 v[152:155], a[188:191], a[24:27], v[152:155]
    ds_read_b64_tr_b16 a[178:179], v26 offset:4096
    v_mfma_f32_16x16x32_bf16 v[156:159], a[184:187], a[20:23], v[156:159]
    ds_read_b64_tr_b16 a[180:181], v26 offset:8192
    v_mfma_f32_16x16x32_bf16 v[156:159], a[188:191], a[28:31], v[156:159]
    s_waitcnt lgkmcnt(9)
    buffer_load_dwordx4 v44, s[16:19], s49 offen offset:2048 lds
    v_mfma_f32_16x16x32_bf16 v[160:163], a[160:163], a[16:19], v[160:163]
    s_waitcnt lgkmcnt(7)
    ds_read_b64_tr_b16 a[182:183], v26 offset:12288
    ds_read_b64_tr_b16 a[184:185], v27 offset:0
    v_mfma_f32_16x16x32_bf16 v[160:163], a[164:167], a[24:27], v[160:163]
    ds_read_b64_tr_b16 a[186:187], v27 offset:4096
    v_mfma_f32_16x16x32_bf16 v[164:167], a[160:163], a[20:23], v[164:167]
    ds_read_b64_tr_b16 a[188:189], v27 offset:8192
    v_mfma_f32_16x16x32_bf16 v[164:167], a[164:167], a[28:31], v[164:167]
    s_waitcnt lgkmcnt(9)
    buffer_load_dwordx4 v45, s[16:19], s49 offen offset:3072 lds
    v_mfma_f32_16x16x32_bf16 v[168:171], a[168:171], a[16:19], v[168:171]
    s_waitcnt lgkmcnt(7)
    ds_read_b64_tr_b16 a[190:191], v27 offset:12288
    ds_read_b64_tr_b16 a[160:161], v20 offset:16384
    v_mfma_f32_16x16x32_bf16 v[168:171], a[172:175], a[24:27], v[168:171]
    ds_read_b64_tr_b16 a[162:163], v20 offset:20480
    v_mfma_f32_16x16x32_bf16 v[172:175], a[168:171], a[20:23], v[172:175]
    ds_read_b64_tr_b16 a[164:165], v20 offset:24576
    v_mfma_f32_16x16x32_bf16 v[172:175], a[172:175], a[28:31], v[172:175]
    s_waitcnt lgkmcnt(9)
    buffer_load_dwordx4 a[48:51], v51, s[24:27], s46 offen offset:768 sc1
    v_mfma_f32_16x16x32_bf16 v[176:179], a[176:179], a[16:19], v[176:179]
    s_waitcnt lgkmcnt(7)
    ds_read_b64_tr_b16 a[166:167], v20 offset:28672
    ds_read_b64_tr_b16 a[168:169], v21 offset:16384
    v_mfma_f32_16x16x32_bf16 v[176:179], a[180:183], a[24:27], v[176:179]
    ds_read_b64_tr_b16 a[170:171], v21 offset:20480
    v_mfma_f32_16x16x32_bf16 v[180:183], a[176:179], a[20:23], v[180:183]
    ds_read_b64_tr_b16 a[172:173], v21 offset:24576
    v_mfma_f32_16x16x32_bf16 v[180:183], a[180:183], a[28:31], v[180:183]
    s_waitcnt lgkmcnt(9)
    buffer_load_dwordx4 a[56:59], v51, s[24:27], s46 offen offset:896 sc1
    v_mfma_f32_16x16x32_bf16 v[184:187], a[184:187], a[16:19], v[184:187]
    s_waitcnt lgkmcnt(7)
    ds_read_b64_tr_b16 a[174:175], v21 offset:28672
    ds_read_b64_tr_b16 a[176:177], v22 offset:16384
    v_mfma_f32_16x16x32_bf16 v[184:187], a[188:191], a[24:27], v[184:187]
    ds_read_b64_tr_b16 a[178:179], v22 offset:20480
    v_mfma_f32_16x16x32_bf16 v[188:191], a[184:187], a[20:23], v[188:191]
    ds_read_b64_tr_b16 a[180:181], v22 offset:24576
    v_mfma_f32_16x16x32_bf16 v[188:191], a[188:191], a[28:31], v[188:191]
    s_waitcnt lgkmcnt(9)
    buffer_load_dwordx4 a[52:55], v51, s[24:27], s43 offen offset:768 sc1
    v_mfma_f32_16x16x32_bf16 v[192:195], a[160:163], a[16:19], v[192:195]
    s_waitcnt lgkmcnt(7)
    ds_read_b64_tr_b16 a[182:183], v22 offset:28672
    ds_read_b64_tr_b16 a[184:185], v23 offset:16384
    v_mfma_f32_16x16x32_bf16 v[192:195], a[164:167], a[24:27], v[192:195]
    ds_read_b64_tr_b16 a[186:187], v23 offset:20480
    v_mfma_f32_16x16x32_bf16 v[196:199], a[160:163], a[20:23], v[196:199]
    ds_read_b64_tr_b16 a[188:189], v23 offset:24576
    v_mfma_f32_16x16x32_bf16 v[196:199], a[164:167], a[28:31], v[196:199]
    s_waitcnt lgkmcnt(9)
    buffer_load_dwordx4 a[60:63], v51, s[24:27], s43 offen offset:896 sc1
    v_mfma_f32_16x16x32_bf16 v[200:203], a[168:171], a[16:19], v[200:203]
    s_waitcnt lgkmcnt(7)
    ds_read_b64_tr_b16 a[190:191], v23 offset:28672
    ds_read_b64_tr_b16 a[160:161], v24 offset:16384
    v_mfma_f32_16x16x32_bf16 v[200:203], a[172:175], a[24:27], v[200:203]
    ds_read_b64_tr_b16 a[162:163], v24 offset:20480
    v_mfma_f32_16x16x32_bf16 v[204:207], a[168:171], a[20:23], v[204:207]
    ds_read_b64_tr_b16 a[164:165], v24 offset:24576
    v_mfma_f32_16x16x32_bf16 v[204:207], a[172:175], a[28:31], v[204:207]
    s_waitcnt lgkmcnt(9)
    ds_read_b64_tr_b16 a[166:167], v24 offset:28672
    v_mfma_f32_16x16x32_bf16 v[208:211], a[176:179], a[16:19], v[208:211]
    s_waitcnt lgkmcnt(8)
    ds_read_b64_tr_b16 a[168:169], v25 offset:16384
    v_mfma_f32_16x16x32_bf16 v[208:211], a[180:183], a[24:27], v[208:211]
    ds_read_b64_tr_b16 a[170:171], v25 offset:20480
    v_mfma_f32_16x16x32_bf16 v[212:215], a[176:179], a[20:23], v[212:215]
    ds_read_b64_tr_b16 a[172:173], v25 offset:24576
    v_mfma_f32_16x16x32_bf16 v[212:215], a[180:183], a[28:31], v[212:215]
    s_waitcnt lgkmcnt(9)
    ds_read_b64_tr_b16 a[174:175], v25 offset:28672
    v_mfma_f32_16x16x32_bf16 v[216:219], a[184:187], a[16:19], v[216:219]
    s_waitcnt lgkmcnt(8)
    ds_read_b64_tr_b16 a[176:177], v26 offset:16384
    v_mfma_f32_16x16x32_bf16 v[216:219], a[188:191], a[24:27], v[216:219]
    ds_read_b64_tr_b16 a[178:179], v26 offset:20480
    v_mfma_f32_16x16x32_bf16 v[220:223], a[184:187], a[20:23], v[220:223]
    ds_read_b64_tr_b16 a[180:181], v26 offset:24576
    v_mfma_f32_16x16x32_bf16 v[220:223], a[188:191], a[28:31], v[220:223]
    s_waitcnt lgkmcnt(9)
    ds_read_b64_tr_b16 a[182:183], v26 offset:28672
    v_mfma_f32_16x16x32_bf16 v[224:227], a[160:163], a[16:19], v[224:227]
    s_waitcnt lgkmcnt(8)
    ds_read_b64_tr_b16 a[184:185], v27 offset:16384
    v_mfma_f32_16x16x32_bf16 v[224:227], a[164:167], a[24:27], v[224:227]
    ds_read_b64_tr_b16 a[186:187], v27 offset:20480
    v_mfma_f32_16x16x32_bf16 v[228:231], a[160:163], a[20:23], v[228:231]
    ds_read_b64_tr_b16 a[188:189], v27 offset:24576
    v_mfma_f32_16x16x32_bf16 v[228:231], a[164:167], a[28:31], v[228:231]
    s_waitcnt lgkmcnt(9)
    ds_read_b64_tr_b16 a[190:191], v27 offset:28672
    s_barrier
    v_mfma_f32_16x16x32_bf16 v[232:235], a[168:171], a[16:19], v[232:235]
    s_waitcnt lgkmcnt(8)
    ds_read_b64_tr_b16 a[160:161], v20 offset:32768
    v_mfma_f32_16x16x32_bf16 v[232:235], a[172:175], a[24:27], v[232:235]
    s_add_u32 s49, s44, 2097152
    ds_read_b64_tr_b16 a[162:163], v20 offset:36864
    v_mfma_f32_16x16x32_bf16 v[236:239], a[168:171], a[20:23], v[236:239]
    s_add_u32 m0, s42, 0
    ds_read_b64_tr_b16 a[164:165], v20 offset:40960
    v_mfma_f32_16x16x32_bf16 v[236:239], a[172:175], a[28:31], v[236:239]
    s_waitcnt lgkmcnt(9)
    buffer_load_dwordx4 v42, s[16:19], s49 offen lds
    v_mfma_f32_16x16x32_bf16 v[240:243], a[176:179], a[16:19], v[240:243]
    s_waitcnt lgkmcnt(7)
    ds_read_b64_tr_b16 a[166:167], v20 offset:45056
    ds_read_b64_tr_b16 a[168:169], v21 offset:32768
    v_mfma_f32_16x16x32_bf16 v[240:243], a[180:183], a[24:27], v[240:243]
Ltour0:
    s_cbranch_execz Ltour4
    ds_read_b64_tr_b16 a[170:171], v21 offset:36864
    v_mfma_f32_16x16x32_bf16 v[244:247], a[176:179], a[20:23], v[244:247]
    ds_read_b64_tr_b16 a[172:173], v21 offset:40960
    v_mfma_f32_16x16x32_bf16 v[244:247], a[180:183], a[28:31], v[244:247]
    s_waitcnt lgkmcnt(9)
    buffer_load_dwordx4 v43, s[16:19], s49 offen offset:1024 lds
    v_mfma_f32_16x16x32_bf16 v[248:251], a[184:187], a[16:19], v[248:251]
    s_waitcnt lgkmcnt(7)
    ds_read_b64_tr_b16 a[174:175], v21 offset:45056
    ds_read_b64_tr_b16 a[176:177], v22 offset:32768
    v_mfma_f32_16x16x32_bf16 v[248:251], a[188:191], a[24:27], v[248:251]
    ds_read_b64_tr_b16 a[178:179], v22 offset:36864
    v_mfma_f32_16x16x32_bf16 v[252:255], a[184:187], a[20:23], v[252:255]
    ds_read_b64_tr_b16 a[180:181], v22 offset:40960
    v_mfma_f32_16x16x32_bf16 v[252:255], a[188:191], a[28:31], v[252:255]
    s_waitcnt vmcnt(18)
    s_waitcnt lgkmcnt(9)
    buffer_load_dwordx4 v44, s[16:19], s49 offen offset:2048 lds
    v_mfma_f32_16x16x32_bf16 v[128:131], a[160:163], a[32:35], v[128:131]
    s_waitcnt vmcnt(18)
    s_waitcnt lgkmcnt(7)
    ds_read_b64_tr_b16 a[182:183], v22 offset:45056
    ds_read_b64_tr_b16 a[184:185], v23 offset:32768
    v_mfma_f32_16x16x32_bf16 v[128:131], a[164:167], a[40:43], v[128:131]
    s_waitcnt vmcnt(17)
    ds_read_b64_tr_b16 a[186:187], v23 offset:36864
    v_mfma_f32_16x16x32_bf16 v[132:135], a[160:163], a[36:39], v[132:135]
    s_waitcnt vmcnt(16)
    ds_read_b64_tr_b16 a[188:189], v23 offset:40960
    v_mfma_f32_16x16x32_bf16 v[132:135], a[164:167], a[44:47], v[132:135]
    s_waitcnt lgkmcnt(9)
    buffer_load_dwordx4 v45, s[16:19], s49 offen offset:3072 lds
    v_mfma_f32_16x16x32_bf16 v[136:139], a[168:171], a[32:35], v[136:139]
    s_waitcnt lgkmcnt(7)
    ds_read_b64_tr_b16 a[190:191], v23 offset:45056
    ds_read_b64_tr_b16 a[160:161], v24 offset:32768
    v_mfma_f32_16x16x32_bf16 v[136:139], a[172:175], a[40:43], v[136:139]
    s_add_u32 s49, s44, 2097408
    ds_read_b64_tr_b16 a[162:163], v24 offset:36864
    v_mfma_f32_16x16x32_bf16 v[140:143], a[168:171], a[36:39], v[140:143]
    s_add_u32 m0, s42, 16384
    ds_read_b64_tr_b16 a[164:165], v24 offset:40960
    v_mfma_f32_16x16x32_bf16 v[140:143], a[172:175], a[44:47], v[140:143]
    s_waitcnt lgkmcnt(9)
    buffer_load_dwordx4 v42, s[16:19], s49 offen lds
    v_mfma_f32_16x16x32_bf16 v[144:147], a[176:179], a[32:35], v[144:147]
    s_waitcnt lgkmcnt(7)
    ds_read_b64_tr_b16 a[166:167], v24 offset:45056
    ds_read_b64_tr_b16 a[168:169], v25 offset:32768
    v_mfma_f32_16x16x32_bf16 v[144:147], a[180:183], a[40:43], v[144:147]
    ds_read_b64_tr_b16 a[170:171], v25 offset:36864
    v_mfma_f32_16x16x32_bf16 v[148:151], a[176:179], a[36:39], v[148:151]
    ds_read_b64_tr_b16 a[172:173], v25 offset:40960
    v_mfma_f32_16x16x32_bf16 v[148:151], a[180:183], a[44:47], v[148:151]
    s_waitcnt lgkmcnt(9)
    buffer_load_dwordx4 v43, s[16:19], s49 offen offset:1024 lds
    v_mfma_f32_16x16x32_bf16 v[152:155], a[184:187], a[32:35], v[152:155]
    s_waitcnt lgkmcnt(7)
    ds_read_b64_tr_b16 a[174:175], v25 offset:45056
    ds_read_b64_tr_b16 a[176:177], v26 offset:32768
    v_mfma_f32_16x16x32_bf16 v[152:155], a[188:191], a[40:43], v[152:155]
    ds_read_b64_tr_b16 a[178:179], v26 offset:36864
    v_mfma_f32_16x16x32_bf16 v[156:159], a[184:187], a[36:39], v[156:159]
    ds_read_b64_tr_b16 a[180:181], v26 offset:40960
    v_mfma_f32_16x16x32_bf16 v[156:159], a[188:191], a[44:47], v[156:159]
    s_waitcnt lgkmcnt(9)
    buffer_load_dwordx4 v44, s[16:19], s49 offen offset:2048 lds
    v_mfma_f32_16x16x32_bf16 v[160:163], a[160:163], a[32:35], v[160:163]
    s_waitcnt lgkmcnt(7)
    ds_read_b64_tr_b16 a[182:183], v26 offset:45056
    ds_read_b64_tr_b16 a[184:185], v27 offset:32768
    v_mfma_f32_16x16x32_bf16 v[160:163], a[164:167], a[40:43], v[160:163]
    ds_read_b64_tr_b16 a[186:187], v27 offset:36864
    v_mfma_f32_16x16x32_bf16 v[164:167], a[160:163], a[36:39], v[164:167]
    ds_read_b64_tr_b16 a[188:189], v27 offset:40960
    v_mfma_f32_16x16x32_bf16 v[164:167], a[164:167], a[44:47], v[164:167]
    s_waitcnt lgkmcnt(9)
    buffer_load_dwordx4 v45, s[16:19], s49 offen offset:3072 lds
    v_mfma_f32_16x16x32_bf16 v[168:171], a[168:171], a[32:35], v[168:171]
    s_waitcnt lgkmcnt(7)
    ds_read_b64_tr_b16 a[190:191], v27 offset:45056
    ds_read_b64_tr_b16 a[160:161], v20 offset:49152
    v_mfma_f32_16x16x32_bf16 v[168:171], a[172:175], a[40:43], v[168:171]
    ds_read_b64_tr_b16 a[162:163], v20 offset:53248
    v_mfma_f32_16x16x32_bf16 v[172:175], a[168:171], a[36:39], v[172:175]
    ds_read_b64_tr_b16 a[164:165], v20 offset:57344
    v_mfma_f32_16x16x32_bf16 v[172:175], a[172:175], a[44:47], v[172:175]
    s_waitcnt lgkmcnt(9)
    buffer_load_dwordx4 a[64:67], v51, s[24:27], s46 offen offset:1024 sc1
    v_mfma_f32_16x16x32_bf16 v[176:179], a[176:179], a[32:35], v[176:179]
    s_waitcnt lgkmcnt(7)
    ds_read_b64_tr_b16 a[166:167], v20 offset:61440
    ds_read_b64_tr_b16 a[168:169], v21 offset:49152
    v_mfma_f32_16x16x32_bf16 v[176:179], a[180:183], a[40:43], v[176:179]
    ds_read_b64_tr_b16 a[170:171], v21 offset:53248
    v_mfma_f32_16x16x32_bf16 v[180:183], a[176:179], a[36:39], v[180:183]
    ds_read_b64_tr_b16 a[172:173], v21 offset:57344
    v_mfma_f32_16x16x32_bf16 v[180:183], a[180:183], a[44:47], v[180:183]
    s_waitcnt lgkmcnt(9)
    buffer_load_dwordx4 a[72:75], v51, s[24:27], s46 offen offset:1152 sc1
    v_mfma_f32_16x16x32_bf16 v[184:187], a[184:187], a[32:35], v[184:187]
    s_waitcnt lgkmcnt(7)
    ds_read_b64_tr_b16 a[174:175], v21 offset:61440
    ds_read_b64_tr_b16 a[176:177], v22 offset:49152
    v_mfma_f32_16x16x32_bf16 v[184:187], a[188:191], a[40:43], v[184:187]
    ds_read_b64_tr_b16 a[178:179], v22 offset:53248
    v_mfma_f32_16x16x32_bf16 v[188:191], a[184:187], a[36:39], v[188:191]
    ds_read_b64_tr_b16 a[180:181], v22 offset:57344
    v_mfma_f32_16x16x32_bf16 v[188:191], a[188:191], a[44:47], v[188:191]
    s_waitcnt lgkmcnt(9)
    buffer_load_dwordx4 a[68:71], v51, s[24:27], s43 offen offset:1024 sc1
    v_mfma_f32_16x16x32_bf16 v[192:195], a[160:163], a[32:35], v[192:195]
    s_waitcnt lgkmcnt(7)
    ds_read_b64_tr_b16 a[182:183], v22 offset:61440
    ds_read_b64_tr_b16 a[184:185], v23 offset:49152
    v_mfma_f32_16x16x32_bf16 v[192:195], a[164:167], a[40:43], v[192:195]
    ds_read_b64_tr_b16 a[186:187], v23 offset:53248
    v_mfma_f32_16x16x32_bf16 v[196:199], a[160:163], a[36:39], v[196:199]
    ds_read_b64_tr_b16 a[188:189], v23 offset:57344
    v_mfma_f32_16x16x32_bf16 v[196:199], a[164:167], a[44:47], v[196:199]
    s_waitcnt lgkmcnt(9)
    buffer_load_dwordx4 a[76:79], v51, s[24:27], s43 offen offset:1152 sc1
    v_mfma_f32_16x16x32_bf16 v[200:203], a[168:171], a[32:35], v[200:203]
    s_waitcnt lgkmcnt(7)
    ds_read_b64_tr_b16 a[190:191], v23 offset:61440
    ds_read_b64_tr_b16 a[160:161], v24 offset:49152
    v_mfma_f32_16x16x32_bf16 v[200:203], a[172:175], a[40:43], v[200:203]
    ds_read_b64_tr_b16 a[162:163], v24 offset:53248
    v_mfma_f32_16x16x32_bf16 v[204:207], a[168:171], a[36:39], v[204:207]
    ds_read_b64_tr_b16 a[164:165], v24 offset:57344
    v_mfma_f32_16x16x32_bf16 v[204:207], a[172:175], a[44:47], v[204:207]
    s_waitcnt lgkmcnt(9)
    ds_read_b64_tr_b16 a[166:167], v24 offset:61440
    v_mfma_f32_16x16x32_bf16 v[208:211], a[176:179], a[32:35], v[208:211]
    s_waitcnt lgkmcnt(8)
    ds_read_b64_tr_b16 a[168:169], v25 offset:49152
    v_mfma_f32_16x16x32_bf16 v[208:211], a[180:183], a[40:43], v[208:211]
    ds_read_b64_tr_b16 a[170:171], v25 offset:53248
    v_mfma_f32_16x16x32_bf16 v[212:215], a[176:179], a[36:39], v[212:215]
    ds_read_b64_tr_b16 a[172:173], v25 offset:57344
    v_mfma_f32_16x16x32_bf16 v[212:215], a[180:183], a[44:47], v[212:215]
    s_waitcnt lgkmcnt(9)
    ds_read_b64_tr_b16 a[174:175], v25 offset:61440
    v_mfma_f32_16x16x32_bf16 v[216:219], a[184:187], a[32:35], v[216:219]
    s_waitcnt lgkmcnt(8)
    ds_read_b64_tr_b16 a[176:177], v26 offset:49152
    v_mfma_f32_16x16x32_bf16 v[216:219], a[188:191], a[40:43], v[216:219]
    ds_read_b64_tr_b16 a[178:179], v26 offset:53248
    v_mfma_f32_16x16x32_bf16 v[220:223], a[184:187], a[36:39], v[220:223]
    ds_read_b64_tr_b16 a[180:181], v26 offset:57344
    v_mfma_f32_16x16x32_bf16 v[220:223], a[188:191], a[44:47], v[220:223]
    s_waitcnt lgkmcnt(9)
    ds_read_b64_tr_b16 a[182:183], v26 offset:61440
    v_mfma_f32_16x16x32_bf16 v[224:227], a[160:163], a[32:35], v[224:227]
    s_waitcnt lgkmcnt(8)
    ds_read_b64_tr_b16 a[184:185], v27 offset:49152
    v_mfma_f32_16x16x32_bf16 v[224:227], a[164:167], a[40:43], v[224:227]
    ds_read_b64_tr_b16 a[186:187], v27 offset:53248
    v_mfma_f32_16x16x32_bf16 v[228:231], a[160:163], a[36:39], v[228:231]
    ds_read_b64_tr_b16 a[188:189], v27 offset:57344
    v_mfma_f32_16x16x32_bf16 v[228:231], a[164:167], a[44:47], v[228:231]
    s_waitcnt lgkmcnt(9)
    ds_read_b64_tr_b16 a[190:191], v27 offset:61440
    s_waitcnt vmcnt(16)
    s_barrier
    v_mfma_f32_16x16x32_bf16 v[232:235], a[168:171], a[32:35], v[232:235]
    s_waitcnt lgkmcnt(8)
    ds_read_b64_tr_b16 a[160:161], v28 offset:0
    v_mfma_f32_16x16x32_bf16 v[232:235], a[172:175], a[40:43], v[232:235]
    s_add_u32 s49, s44, 2621440
    ds_read_b64_tr_b16 a[162:163], v28 offset:4096
    v_mfma_f32_16x16x32_bf16 v[236:239], a[168:171], a[36:39], v[236:239]
    s_add_u32 m0, s42, 32768
    ds_read_b64_tr_b16 a[164:165], v28 offset:8192
    v_mfma_f32_16x16x32_bf16 v[236:239], a[172:175], a[44:47], v[236:239]
    s_waitcnt lgkmcnt(9)
    buffer_load_dwordx4 v42, s[16:19], s49 offen lds
    v_mfma_f32_16x16x32_bf16 v[240:243], a[176:179], a[32:35], v[240:243]
    s_waitcnt lgkmcnt(7)
    ds_read_b64_tr_b16 a[166:167], v28 offset:12288
    ds_read_b64_tr_b16 a[168:169], v29 offset:0
    v_mfma_f32_16x16x32_bf16 v[240:243], a[180:183], a[40:43], v[240:243]
    ds_read_b64_tr_b16 a[170:171], v29 offset:4096
    v_mfma_f32_16x16x32_bf16 v[244:247], a[176:179], a[36:39], v[244:247]
    ds_read_b64_tr_b16 a[172:173], v29 offset:8192
    v_mfma_f32_16x16x32_bf16 v[244:247], a[180:183], a[44:47], v[244:247]
    s_waitcnt lgkmcnt(9)
    buffer_load_dwordx4 v43, s[16:19], s49 offen offset:1024 lds
    v_mfma_f32_16x16x32_bf16 v[248:251], a[184:187], a[32:35], v[248:251]
    s_waitcnt lgkmcnt(7)
    ds_read_b64_tr_b16 a[174:175], v29 offset:12288
    ds_read_b64_tr_b16 a[176:177], v30 offset:0
    v_mfma_f32_16x16x32_bf16 v[248:251], a[188:191], a[40:43], v[248:251]
    ds_read_b64_tr_b16 a[178:179], v30 offset:4096
    v_mfma_f32_16x16x32_bf16 v[252:255], a[184:187], a[36:39], v[252:255]
    ds_read_b64_tr_b16 a[180:181], v30 offset:8192
    v_mfma_f32_16x16x32_bf16 v[252:255], a[188:191], a[44:47], v[252:255]
    s_waitcnt vmcnt(17)
    s_waitcnt lgkmcnt(9)
    buffer_load_dwordx4 v44, s[16:19], s49 offen offset:2048 lds
    v_mfma_f32_16x16x32_bf16 v[128:131], a[160:163], a[48:51], v[128:131]
    s_waitcnt vmcnt(17)
    s_waitcnt lgkmcnt(7)
    ds_read_b64_tr_b16 a[182:183], v30 offset:12288
    ds_read_b64_tr_b16 a[184:185], v31 offset:0
    v_mfma_f32_16x16x32_bf16 v[128:131], a[164:167], a[56:59], v[128:131]
    s_waitcnt vmcnt(16)
    ds_read_b64_tr_b16 a[186:187], v31 offset:4096
    v_mfma_f32_16x16x32_bf16 v[132:135], a[160:163], a[52:55], v[132:135]
    s_waitcnt vmcnt(15)
    ds_read_b64_tr_b16 a[188:189], v31 offset:8192
    v_mfma_f32_16x16x32_bf16 v[132:135], a[164:167], a[60:63], v[132:135]
    s_waitcnt lgkmcnt(9)
    buffer_load_dwordx4 v45, s[16:19], s49 offen offset:3072 lds
    v_mfma_f32_16x16x32_bf16 v[136:139], a[168:171], a[48:51], v[136:139]
    s_waitcnt lgkmcnt(7)
    ds_read_b64_tr_b16 a[190:191], v31 offset:12288
    ds_read_b64_tr_b16 a[160:161], v32 offset:0
    v_mfma_f32_16x16x32_bf16 v[136:139], a[172:175], a[56:59], v[136:139]
    s_add_u32 s49, s44, 2621696
    ds_read_b64_tr_b16 a[162:163], v32 offset:4096
    v_mfma_f32_16x16x32_bf16 v[140:143], a[168:171], a[52:55], v[140:143]
    s_add_u32 m0, s42, 49152
    ds_read_b64_tr_b16 a[164:165], v32 offset:8192
    v_mfma_f32_16x16x32_bf16 v[140:143], a[172:175], a[60:63], v[140:143]
    s_waitcnt lgkmcnt(9)
    buffer_load_dwordx4 v42, s[16:19], s49 offen lds
    v_mfma_f32_16x16x32_bf16 v[144:147], a[176:179], a[48:51], v[144:147]
    s_waitcnt lgkmcnt(7)
    ds_read_b64_tr_b16 a[166:167], v32 offset:12288
    ds_read_b64_tr_b16 a[168:169], v33 offset:0
    v_mfma_f32_16x16x32_bf16 v[144:147], a[180:183], a[56:59], v[144:147]
    ds_read_b64_tr_b16 a[170:171], v33 offset:4096
    v_mfma_f32_16x16x32_bf16 v[148:151], a[176:179], a[52:55], v[148:151]
    ds_read_b64_tr_b16 a[172:173], v33 offset:8192
    v_mfma_f32_16x16x32_bf16 v[148:151], a[180:183], a[60:63], v[148:151]
    s_waitcnt lgkmcnt(9)
    buffer_load_dwordx4 v43, s[16:19], s49 offen offset:1024 lds
    v_mfma_f32_16x16x32_bf16 v[152:155], a[184:187], a[48:51], v[152:155]
    s_waitcnt lgkmcnt(7)
    ds_read_b64_tr_b16 a[174:175], v33 offset:12288
    ds_read_b64_tr_b16 a[176:177], v34 offset:0
    v_mfma_f32_16x16x32_bf16 v[152:155], a[188:191], a[56:59], v[152:155]
    ds_read_b64_tr_b16 a[178:179], v34 offset:4096
    v_mfma_f32_16x16x32_bf16 v[156:159], a[184:187], a[52:55], v[156:159]
    ds_read_b64_tr_b16 a[180:181], v34 offset:8192
    v_mfma_f32_16x16x32_bf16 v[156:159], a[188:191], a[60:63], v[156:159]
    s_waitcnt lgkmcnt(9)
    buffer_load_dwordx4 v44, s[16:19], s49 offen offset:2048 lds
    v_mfma_f32_16x16x32_bf16 v[160:163], a[160:163], a[48:51], v[160:163]
    s_waitcnt lgkmcnt(7)
    ds_read_b64_tr_b16 a[182:183], v34 offset:12288
    ds_read_b64_tr_b16 a[184:185], v35 offset:0
    v_mfma_f32_16x16x32_bf16 v[160:163], a[164:167], a[56:59], v[160:163]
    ds_read_b64_tr_b16 a[186:187], v35 offset:4096
    v_mfma_f32_16x16x32_bf16 v[164:167], a[160:163], a[52:55], v[164:167]
    ds_read_b64_tr_b16 a[188:189], v35 offset:8192
    v_mfma_f32_16x16x32_bf16 v[164:167], a[164:167], a[60:63], v[164:167]
    s_waitcnt lgkmcnt(9)
    buffer_load_dwordx4 v45, s[16:19], s49 offen offset:3072 lds
    v_mfma_f32_16x16x32_bf16 v[168:171], a[168:171], a[48:51], v[168:171]
    s_waitcnt lgkmcnt(7)
    ds_read_b64_tr_b16 a[190:191], v35 offset:12288
    ds_read_b64_tr_b16 a[160:161], v28 offset:16384
    v_mfma_f32_16x16x32_bf16 v[168:171], a[172:175], a[56:59], v[168:171]
    ds_read_b64_tr_b16 a[162:163], v28 offset:20480
    v_mfma_f32_16x16x32_bf16 v[172:175], a[168:171], a[52:55], v[172:175]
    ds_read_b64_tr_b16 a[164:165], v28 offset:24576
    v_mfma_f32_16x16x32_bf16 v[172:175], a[172:175], a[60:63], v[172:175]
    s_waitcnt lgkmcnt(9)
    buffer_load_dwordx4 a[80:83], v51, s[24:27], s46 offen offset:1280 sc1
    v_mfma_f32_16x16x32_bf16 v[176:179], a[176:179], a[48:51], v[176:179]
    s_waitcnt lgkmcnt(7)
    ds_read_b64_tr_b16 a[166:167], v28 offset:28672
    ds_read_b64_tr_b16 a[168:169], v29 offset:16384
    v_mfma_f32_16x16x32_bf16 v[176:179], a[180:183], a[56:59], v[176:179]
    ds_read_b64_tr_b16 a[170:171], v29 offset:20480
    v_mfma_f32_16x16x32_bf16 v[180:183], a[176:179], a[52:55], v[180:183]
    ds_read_b64_tr_b16 a[172:173], v29 offset:24576
    v_mfma_f32_16x16x32_bf16 v[180:183], a[180:183], a[60:63], v[180:183]
    s_waitcnt lgkmcnt(9)
    buffer_load_dwordx4 a[88:91], v51, s[24:27], s46 offen offset:1408 sc1
    v_mfma_f32_16x16x32_bf16 v[184:187], a[184:187], a[48:51], v[184:187]
    s_waitcnt lgkmcnt(7)
    ds_read_b64_tr_b16 a[174:175], v29 offset:28672
    ds_read_b64_tr_b16 a[176:177], v30 offset:16384
    v_mfma_f32_16x16x32_bf16 v[184:187], a[188:191], a[56:59], v[184:187]
    ds_read_b64_tr_b16 a[178:179], v30 offset:20480
    v_mfma_f32_16x16x32_bf16 v[188:191], a[184:187], a[52:55], v[188:191]
    ds_read_b64_tr_b16 a[180:181], v30 offset:24576
    v_mfma_f32_16x16x32_bf16 v[188:191], a[188:191], a[60:63], v[188:191]
    s_waitcnt lgkmcnt(9)
    buffer_load_dwordx4 a[84:87], v51, s[24:27], s43 offen offset:1280 sc1
    v_mfma_f32_16x16x32_bf16 v[192:195], a[160:163], a[48:51], v[192:195]
    s_waitcnt lgkmcnt(7)
    ds_read_b64_tr_b16 a[182:183], v30 offset:28672
    ds_read_b64_tr_b16 a[184:185], v31 offset:16384
    v_mfma_f32_16x16x32_bf16 v[192:195], a[164:167], a[56:59], v[192:195]
    ds_read_b64_tr_b16 a[186:187], v31 offset:20480
    v_mfma_f32_16x16x32_bf16 v[196:199], a[160:163], a[52:55], v[196:199]
    ds_read_b64_tr_b16 a[188:189], v31 offset:24576
    v_mfma_f32_16x16x32_bf16 v[196:199], a[164:167], a[60:63], v[196:199]
    s_waitcnt lgkmcnt(9)
    buffer_load_dwordx4 a[92:95], v51, s[24:27], s43 offen offset:1408 sc1
    v_mfma_f32_16x16x32_bf16 v[200:203], a[168:171], a[48:51], v[200:203]
    s_waitcnt lgkmcnt(7)
    ds_read_b64_tr_b16 a[190:191], v31 offset:28672
    ds_read_b64_tr_b16 a[160:161], v32 offset:16384
    v_mfma_f32_16x16x32_bf16 v[200:203], a[172:175], a[56:59], v[200:203]
    ds_read_b64_tr_b16 a[162:163], v32 offset:20480
    v_mfma_f32_16x16x32_bf16 v[204:207], a[168:171], a[52:55], v[204:207]
    ds_read_b64_tr_b16 a[164:165], v32 offset:24576
    v_mfma_f32_16x16x32_bf16 v[204:207], a[172:175], a[60:63], v[204:207]
    s_waitcnt lgkmcnt(9)
    buffer_load_dword v78, v120, s[8:11], 0 offen
    v_mfma_f32_16x16x32_bf16 v[208:211], a[176:179], a[48:51], v[208:211]
    s_waitcnt lgkmcnt(7)
    ds_read_b64_tr_b16 a[166:167], v32 offset:28672
    ds_read_b64_tr_b16 a[168:169], v33 offset:16384
    v_mfma_f32_16x16x32_bf16 v[208:211], a[180:183], a[56:59], v[208:211]
    ds_read_b64_tr_b16 a[170:171], v33 offset:20480
    v_mfma_f32_16x16x32_bf16 v[212:215], a[176:179], a[52:55], v[212:215]
    ds_read_b64_tr_b16 a[172:173], v33 offset:24576
    v_mfma_f32_16x16x32_bf16 v[212:215], a[180:183], a[60:63], v[212:215]
    s_waitcnt lgkmcnt(9)
    buffer_load_dword v79, v121, s[12:15], 0 offen
    v_mfma_f32_16x16x32_bf16 v[216:219], a[184:187], a[48:51], v[216:219]
    s_waitcnt lgkmcnt(7)
    ds_read_b64_tr_b16 a[174:175], v33 offset:28672
    ds_read_b64_tr_b16 a[176:177], v34 offset:16384
    v_mfma_f32_16x16x32_bf16 v[216:219], a[188:191], a[56:59], v[216:219]
    ds_read_b64_tr_b16 a[178:179], v34 offset:20480
    v_mfma_f32_16x16x32_bf16 v[220:223], a[184:187], a[52:55], v[220:223]
    ds_read_b64_tr_b16 a[180:181], v34 offset:24576
    v_mfma_f32_16x16x32_bf16 v[220:223], a[188:191], a[60:63], v[220:223]
    s_waitcnt lgkmcnt(9)
    ds_read_b64_tr_b16 a[182:183], v34 offset:28672
    v_mfma_f32_16x16x32_bf16 v[224:227], a[160:163], a[48:51], v[224:227]
    s_waitcnt lgkmcnt(8)
    ds_read_b64_tr_b16 a[184:185], v35 offset:16384
    v_mfma_f32_16x16x32_bf16 v[224:227], a[164:167], a[56:59], v[224:227]
    ds_read_b64_tr_b16 a[186:187], v35 offset:20480
    v_mfma_f32_16x16x32_bf16 v[228:231], a[160:163], a[52:55], v[228:231]
    ds_read_b64_tr_b16 a[188:189], v35 offset:24576
    v_mfma_f32_16x16x32_bf16 v[228:231], a[164:167], a[60:63], v[228:231]
    s_waitcnt lgkmcnt(9)
    ds_read_b64_tr_b16 a[190:191], v35 offset:28672
    s_waitcnt vmcnt(18)
    s_barrier
    v_mfma_f32_16x16x32_bf16 v[232:235], a[168:171], a[48:51], v[232:235]
    s_waitcnt lgkmcnt(8)
    ds_read_b64_tr_b16 a[160:161], v12 offset:0
    v_mfma_f32_16x16x32_bf16 v[232:235], a[172:175], a[56:59], v[232:235]
    s_add_u32 s49, s44, 3145728
    ds_read_b64_tr_b16 a[162:163], v12 offset:4096
    v_mfma_f32_16x16x32_bf16 v[236:239], a[168:171], a[52:55], v[236:239]
    s_add_u32 m0, s42, 65536
    ds_read_b64_tr_b16 a[164:165], v12 offset:8192
    v_mfma_f32_16x16x32_bf16 v[236:239], a[172:175], a[60:63], v[236:239]
    s_waitcnt lgkmcnt(9)
    buffer_load_dwordx4 v42, s[16:19], s49 offen lds
    v_mfma_f32_16x16x32_bf16 v[240:243], a[176:179], a[48:51], v[240:243]
    s_waitcnt lgkmcnt(7)
    ds_read_b64_tr_b16 a[166:167], v12 offset:12288
    ds_read_b64_tr_b16 a[168:169], v13 offset:0
    v_mfma_f32_16x16x32_bf16 v[240:243], a[180:183], a[56:59], v[240:243]
    ds_read_b64_tr_b16 a[170:171], v13 offset:4096
    v_mfma_f32_16x16x32_bf16 v[244:247], a[176:179], a[52:55], v[244:247]
    ds_read_b64_tr_b16 a[172:173], v13 offset:8192
    v_mfma_f32_16x16x32_bf16 v[244:247], a[180:183], a[60:63], v[244:247]
    s_waitcnt lgkmcnt(9)
    buffer_load_dwordx4 v43, s[16:19], s49 offen offset:1024 lds
    v_mfma_f32_16x16x32_bf16 v[248:251], a[184:187], a[48:51], v[248:251]
    s_waitcnt lgkmcnt(7)
    ds_read_b64_tr_b16 a[174:175], v13 offset:12288
    ds_read_b64_tr_b16 a[176:177], v14 offset:0
    v_mfma_f32_16x16x32_bf16 v[248:251], a[188:191], a[56:59], v[248:251]
    ds_read_b64_tr_b16 a[178:179], v14 offset:4096
    v_mfma_f32_16x16x32_bf16 v[252:255], a[184:187], a[52:55], v[252:255]
    ds_read_b64_tr_b16 a[180:181], v14 offset:8192
    v_mfma_f32_16x16x32_bf16 v[252:255], a[188:191], a[60:63], v[252:255]
    s_waitcnt vmcnt(19)
    s_waitcnt lgkmcnt(9)
    buffer_load_dwordx4 v44, s[16:19], s49 offen offset:2048 lds
    v_mfma_f32_16x16x32_bf16 v[128:131], a[160:163], a[64:67], v[128:131]
    s_waitcnt vmcnt(19)
    s_waitcnt lgkmcnt(7)
    ds_read_b64_tr_b16 a[182:183], v14 offset:12288
    ds_read_b64_tr_b16 a[184:185], v15 offset:0
    v_mfma_f32_16x16x32_bf16 v[128:131], a[164:167], a[72:75], v[128:131]
    s_waitcnt vmcnt(18)
    ds_read_b64_tr_b16 a[186:187], v15 offset:4096
    v_mfma_f32_16x16x32_bf16 v[132:135], a[160:163], a[68:71], v[132:135]
    s_waitcnt vmcnt(17)
    ds_read_b64_tr_b16 a[188:189], v15 offset:8192
    v_mfma_f32_16x16x32_bf16 v[132:135], a[164:167], a[76:79], v[132:135]
    s_waitcnt lgkmcnt(9)
    buffer_load_dwordx4 v45, s[16:19], s49 offen offset:3072 lds
    v_mfma_f32_16x16x32_bf16 v[136:139], a[168:171], a[64:67], v[136:139]
    s_waitcnt lgkmcnt(7)
    ds_read_b64_tr_b16 a[190:191], v15 offset:12288
    ds_read_b64_tr_b16 a[160:161], v16 offset:0
    v_mfma_f32_16x16x32_bf16 v[136:139], a[172:175], a[72:75], v[136:139]
    s_add_u32 s49, s44, 3145984
    ds_read_b64_tr_b16 a[162:163], v16 offset:4096
    v_mfma_f32_16x16x32_bf16 v[140:143], a[168:171], a[68:71], v[140:143]
    s_add_u32 m0, s42, 81920
    ds_read_b64_tr_b16 a[164:165], v16 offset:8192
    v_mfma_f32_16x16x32_bf16 v[140:143], a[172:175], a[76:79], v[140:143]
    s_waitcnt lgkmcnt(9)
    buffer_load_dwordx4 v42, s[16:19], s49 offen lds
    v_mfma_f32_16x16x32_bf16 v[144:147], a[176:179], a[64:67], v[144:147]
    s_waitcnt lgkmcnt(7)
    ds_read_b64_tr_b16 a[166:167], v16 offset:12288
    ds_read_b64_tr_b16 a[168:169], v17 offset:0
    v_mfma_f32_16x16x32_bf16 v[144:147], a[180:183], a[72:75], v[144:147]
    ds_read_b64_tr_b16 a[170:171], v17 offset:4096
    v_mfma_f32_16x16x32_bf16 v[148:151], a[176:179], a[68:71], v[148:151]
    ds_read_b64_tr_b16 a[172:173], v17 offset:8192
    v_mfma_f32_16x16x32_bf16 v[148:151], a[180:183], a[76:79], v[148:151]
    s_waitcnt lgkmcnt(9)
    buffer_load_dwordx4 v43, s[16:19], s49 offen offset:1024 lds
    v_mfma_f32_16x16x32_bf16 v[152:155], a[184:187], a[64:67], v[152:155]
    s_waitcnt lgkmcnt(7)
    ds_read_b64_tr_b16 a[174:175], v17 offset:12288
    ds_read_b64_tr_b16 a[176:177], v18 offset:0
    v_mfma_f32_16x16x32_bf16 v[152:155], a[188:191], a[72:75], v[152:155]
    ds_read_b64_tr_b16 a[178:179], v18 offset:4096
    v_mfma_f32_16x16x32_bf16 v[156:159], a[184:187], a[68:71], v[156:159]
    ds_read_b64_tr_b16 a[180:181], v18 offset:8192
    v_mfma_f32_16x16x32_bf16 v[156:159], a[188:191], a[76:79], v[156:159]
    s_waitcnt lgkmcnt(9)
    buffer_load_dwordx4 v44, s[16:19], s49 offen offset:2048 lds
    v_mfma_f32_16x16x32_bf16 v[160:163], a[160:163], a[64:67], v[160:163]
    s_waitcnt lgkmcnt(7)
    ds_read_b64_tr_b16 a[182:183], v18 offset:12288
    ds_read_b64_tr_b16 a[184:185], v19 offset:0
    v_mfma_f32_16x16x32_bf16 v[160:163], a[164:167], a[72:75], v[160:163]
    ds_read_b64_tr_b16 a[186:187], v19 offset:4096
    v_mfma_f32_16x16x32_bf16 v[164:167], a[160:163], a[68:71], v[164:167]
    ds_read_b64_tr_b16 a[188:189], v19 offset:8192
    v_mfma_f32_16x16x32_bf16 v[164:167], a[164:167], a[76:79], v[164:167]
    s_waitcnt lgkmcnt(9)
    buffer_load_dwordx4 v45, s[16:19], s49 offen offset:3072 lds
    v_mfma_f32_16x16x32_bf16 v[168:171], a[168:171], a[64:67], v[168:171]
    s_waitcnt lgkmcnt(7)
    ds_read_b64_tr_b16 a[190:191], v19 offset:12288
    ds_read_b64_tr_b16 a[160:161], v12 offset:16384
    v_mfma_f32_16x16x32_bf16 v[168:171], a[172:175], a[72:75], v[168:171]
    ds_read_b64_tr_b16 a[162:163], v12 offset:20480
    v_mfma_f32_16x16x32_bf16 v[172:175], a[168:171], a[68:71], v[172:175]
    ds_read_b64_tr_b16 a[164:165], v12 offset:24576
    v_mfma_f32_16x16x32_bf16 v[172:175], a[172:175], a[76:79], v[172:175]
    s_waitcnt lgkmcnt(9)
    buffer_load_dwordx4 a[96:99], v51, s[24:27], s46 offen offset:1536 sc1
    v_mfma_f32_16x16x32_bf16 v[176:179], a[176:179], a[64:67], v[176:179]
    s_waitcnt lgkmcnt(7)
    ds_read_b64_tr_b16 a[166:167], v12 offset:28672
    ds_read_b64_tr_b16 a[168:169], v13 offset:16384
    v_mfma_f32_16x16x32_bf16 v[176:179], a[180:183], a[72:75], v[176:179]
    ds_read_b64_tr_b16 a[170:171], v13 offset:20480
    v_mfma_f32_16x16x32_bf16 v[180:183], a[176:179], a[68:71], v[180:183]
    ds_read_b64_tr_b16 a[172:173], v13 offset:24576
    v_mfma_f32_16x16x32_bf16 v[180:183], a[180:183], a[76:79], v[180:183]
    s_waitcnt lgkmcnt(9)
    buffer_load_dwordx4 a[104:107], v51, s[24:27], s46 offen offset:1664 sc1
    v_mfma_f32_16x16x32_bf16 v[184:187], a[184:187], a[64:67], v[184:187]
    s_waitcnt lgkmcnt(7)
    ds_read_b64_tr_b16 a[174:175], v13 offset:28672
    ds_read_b64_tr_b16 a[176:177], v14 offset:16384
    v_mfma_f32_16x16x32_bf16 v[184:187], a[188:191], a[72:75], v[184:187]
    ds_read_b64_tr_b16 a[178:179], v14 offset:20480
    v_mfma_f32_16x16x32_bf16 v[188:191], a[184:187], a[68:71], v[188:191]
    ds_read_b64_tr_b16 a[180:181], v14 offset:24576
    v_mfma_f32_16x16x32_bf16 v[188:191], a[188:191], a[76:79], v[188:191]
    s_waitcnt lgkmcnt(9)
    buffer_load_dwordx4 a[100:103], v51, s[24:27], s43 offen offset:1536 sc1
    v_mfma_f32_16x16x32_bf16 v[192:195], a[160:163], a[64:67], v[192:195]
    s_waitcnt lgkmcnt(7)
    ds_read_b64_tr_b16 a[182:183], v14 offset:28672
    ds_read_b64_tr_b16 a[184:185], v15 offset:16384
    v_mfma_f32_16x16x32_bf16 v[192:195], a[164:167], a[72:75], v[192:195]
    ds_read_b64_tr_b16 a[186:187], v15 offset:20480
    v_mfma_f32_16x16x32_bf16 v[196:199], a[160:163], a[68:71], v[196:199]
    ds_read_b64_tr_b16 a[188:189], v15 offset:24576
    v_mfma_f32_16x16x32_bf16 v[196:199], a[164:167], a[76:79], v[196:199]
    s_waitcnt lgkmcnt(9)
    buffer_load_dwordx4 a[108:111], v51, s[24:27], s43 offen offset:1664 sc1
    v_mfma_f32_16x16x32_bf16 v[200:203], a[168:171], a[64:67], v[200:203]
    s_waitcnt lgkmcnt(7)
    ds_read_b64_tr_b16 a[190:191], v15 offset:28672
    ds_read_b64_tr_b16 a[160:161], v16 offset:16384
    v_mfma_f32_16x16x32_bf16 v[200:203], a[172:175], a[72:75], v[200:203]
    ds_read_b64_tr_b16 a[162:163], v16 offset:20480
    v_mfma_f32_16x16x32_bf16 v[204:207], a[168:171], a[68:71], v[204:207]
    ds_read_b64_tr_b16 a[164:165], v16 offset:24576
    v_mfma_f32_16x16x32_bf16 v[204:207], a[172:175], a[76:79], v[204:207]
    s_waitcnt lgkmcnt(9)
    ds_read_b64_tr_b16 a[166:167], v16 offset:28672
    v_mfma_f32_16x16x32_bf16 v[208:211], a[176:179], a[64:67], v[208:211]
    s_waitcnt lgkmcnt(8)
    ds_read_b64_tr_b16 a[168:169], v17 offset:16384
    v_mfma_f32_16x16x32_bf16 v[208:211], a[180:183], a[72:75], v[208:211]
    ds_read_b64_tr_b16 a[170:171], v17 offset:20480
    v_mfma_f32_16x16x32_bf16 v[212:215], a[176:179], a[68:71], v[212:215]
    ds_read_b64_tr_b16 a[172:173], v17 offset:24576
    v_mfma_f32_16x16x32_bf16 v[212:215], a[180:183], a[76:79], v[212:215]
    s_waitcnt lgkmcnt(9)
    ds_read_b64_tr_b16 a[174:175], v17 offset:28672
    v_mfma_f32_16x16x32_bf16 v[216:219], a[184:187], a[64:67], v[216:219]
    s_waitcnt lgkmcnt(8)
    ds_read_b64_tr_b16 a[176:177], v18 offset:16384
    v_mfma_f32_16x16x32_bf16 v[216:219], a[188:191], a[72:75], v[216:219]
    ds_read_b64_tr_b16 a[178:179], v18 offset:20480
    v_mfma_f32_16x16x32_bf16 v[220:223], a[184:187], a[68:71], v[220:223]
    ds_read_b64_tr_b16 a[180:181], v18 offset:24576
    v_mfma_f32_16x16x32_bf16 v[220:223], a[188:191], a[76:79], v[220:223]
    s_waitcnt lgkmcnt(9)
    ds_read_b64_tr_b16 a[182:183], v18 offset:28672
    v_mfma_f32_16x16x32_bf16 v[224:227], a[160:163], a[64:67], v[224:227]
    s_waitcnt lgkmcnt(8)
    ds_read_b64_tr_b16 a[184:185], v19 offset:16384
    v_mfma_f32_16x16x32_bf16 v[224:227], a[164:167], a[72:75], v[224:227]
    ds_read_b64_tr_b16 a[186:187], v19 offset:20480
    v_mfma_f32_16x16x32_bf16 v[228:231], a[160:163], a[68:71], v[228:231]
    ds_read_b64_tr_b16 a[188:189], v19 offset:24576
    v_mfma_f32_16x16x32_bf16 v[228:231], a[164:167], a[76:79], v[228:231]
    s_waitcnt lgkmcnt(9)
    ds_read_b64_tr_b16 a[190:191], v19 offset:28672
    s_waitcnt vmcnt(18)
    s_barrier
    v_mfma_f32_16x16x32_bf16 v[232:235], a[168:171], a[64:67], v[232:235]
    s_waitcnt lgkmcnt(8)
    ds_read_b64_tr_b16 a[160:161], v12 offset:32768
    v_mfma_f32_16x16x32_bf16 v[232:235], a[172:175], a[72:75], v[232:235]
    s_add_u32 s49, s44, 3670016
    ds_read_b64_tr_b16 a[162:163], v12 offset:36864
    v_mfma_f32_16x16x32_bf16 v[236:239], a[168:171], a[68:71], v[236:239]
    s_add_u32 m0, s42, 98304
    ds_read_b64_tr_b16 a[164:165], v12 offset:40960
    v_mfma_f32_16x16x32_bf16 v[236:239], a[172:175], a[76:79], v[236:239]
    s_waitcnt lgkmcnt(9)
    buffer_load_dwordx4 v42, s[16:19], s49 offen lds
    v_mfma_f32_16x16x32_bf16 v[240:243], a[176:179], a[64:67], v[240:243]
    s_waitcnt lgkmcnt(7)
    ds_read_b64_tr_b16 a[166:167], v12 offset:45056
    ds_read_b64_tr_b16 a[168:169], v13 offset:32768
    v_mfma_f32_16x16x32_bf16 v[240:243], a[180:183], a[72:75], v[240:243]
    ds_read_b64_tr_b16 a[170:171], v13 offset:36864
    v_mfma_f32_16x16x32_bf16 v[244:247], a[176:179], a[68:71], v[244:247]
    ds_read_b64_tr_b16 a[172:173], v13 offset:40960
    v_mfma_f32_16x16x32_bf16 v[244:247], a[180:183], a[76:79], v[244:247]
    s_waitcnt lgkmcnt(9)
    buffer_load_dwordx4 v43, s[16:19], s49 offen offset:1024 lds
    v_mfma_f32_16x16x32_bf16 v[248:251], a[184:187], a[64:67], v[248:251]
    s_waitcnt lgkmcnt(7)
    ds_read_b64_tr_b16 a[174:175], v13 offset:45056
    ds_read_b64_tr_b16 a[176:177], v14 offset:32768
    v_mfma_f32_16x16x32_bf16 v[248:251], a[188:191], a[72:75], v[248:251]
    ds_read_b64_tr_b16 a[178:179], v14 offset:36864
    v_mfma_f32_16x16x32_bf16 v[252:255], a[184:187], a[68:71], v[252:255]
    ds_read_b64_tr_b16 a[180:181], v14 offset:40960
    v_mfma_f32_16x16x32_bf16 v[252:255], a[188:191], a[76:79], v[252:255]
    s_waitcnt vmcnt(19)
    s_waitcnt lgkmcnt(9)
    buffer_load_dwordx4 v44, s[16:19], s49 offen offset:2048 lds
    v_mfma_f32_16x16x32_bf16 v[128:131], a[160:163], a[80:83], v[128:131]
    s_waitcnt vmcnt(19)
    s_waitcnt lgkmcnt(7)
    ds_read_b64_tr_b16 a[182:183], v14 offset:45056
    ds_read_b64_tr_b16 a[184:185], v15 offset:32768
Ltour1:
    s_cbranch_execz Ltour5
    v_mfma_f32_16x16x32_bf16 v[128:131], a[164:167], a[88:91], v[128:131]
    s_waitcnt vmcnt(18)
    ds_read_b64_tr_b16 a[186:187], v15 offset:36864
    v_accvgpr_write_b32 a0, 0
    v_mfma_f32_16x16x32_bf16 v[132:135], a[160:163], a[84:87], v[132:135]
    s_waitcnt vmcnt(17)
    ds_read_b64_tr_b16 a[188:189], v15 offset:40960
    v_accvgpr_write_b32 a1, 0
    v_mfma_f32_16x16x32_bf16 v[132:135], a[164:167], a[92:95], v[132:135]
    s_waitcnt lgkmcnt(9)
    buffer_load_dwordx4 v45, s[16:19], s49 offen offset:3072 lds
    v_mfma_f32_16x16x32_bf16 v[136:139], a[168:171], a[80:83], v[136:139]
    s_waitcnt lgkmcnt(7)
    ds_read_b64_tr_b16 a[190:191], v15 offset:45056
    ds_read_b64_tr_b16 a[160:161], v16 offset:32768
    v_mfma_f32_16x16x32_bf16 v[136:139], a[172:175], a[88:91], v[136:139]
    s_add_u32 s49, s44, 3670272
    ds_read_b64_tr_b16 a[162:163], v16 offset:36864
    v_accvgpr_write_b32 a2, 0
    v_mfma_f32_16x16x32_bf16 v[140:143], a[168:171], a[84:87], v[140:143]
    s_add_u32 m0, s42, 114688
    ds_read_b64_tr_b16 a[164:165], v16 offset:40960
    v_accvgpr_write_b32 a3, 0
    v_mfma_f32_16x16x32_bf16 v[140:143], a[172:175], a[92:95], v[140:143]
    s_waitcnt lgkmcnt(9)
    buffer_load_dwordx4 v42, s[16:19], s49 offen lds
    v_mfma_f32_16x16x32_bf16 v[144:147], a[176:179], a[80:83], v[144:147]
    s_waitcnt lgkmcnt(7)
    ds_read_b64_tr_b16 a[166:167], v16 offset:45056
    ds_read_b64_tr_b16 a[168:169], v17 offset:32768
    v_mfma_f32_16x16x32_bf16 v[144:147], a[180:183], a[88:91], v[144:147]
    ds_read_b64_tr_b16 a[170:171], v17 offset:36864
    v_accvgpr_write_b32 a4, 0
    v_mfma_f32_16x16x32_bf16 v[148:151], a[176:179], a[84:87], v[148:151]
    ds_read_b64_tr_b16 a[172:173], v17 offset:40960
    v_accvgpr_write_b32 a5, 0
    v_mfma_f32_16x16x32_bf16 v[148:151], a[180:183], a[92:95], v[148:151]
    s_waitcnt lgkmcnt(9)
    buffer_load_dwordx4 v43, s[16:19], s49 offen offset:1024 lds
    v_mfma_f32_16x16x32_bf16 v[152:155], a[184:187], a[80:83], v[152:155]
    s_waitcnt lgkmcnt(7)
    ds_read_b64_tr_b16 a[174:175], v17 offset:45056
    ds_read_b64_tr_b16 a[176:177], v18 offset:32768
    v_mfma_f32_16x16x32_bf16 v[152:155], a[188:191], a[88:91], v[152:155]
    ds_read_b64_tr_b16 a[178:179], v18 offset:36864
    v_accvgpr_write_b32 a6, 0
    v_mfma_f32_16x16x32_bf16 v[156:159], a[184:187], a[84:87], v[156:159]
    ds_read_b64_tr_b16 a[180:181], v18 offset:40960
    v_accvgpr_write_b32 a7, 0
    v_mfma_f32_16x16x32_bf16 v[156:159], a[188:191], a[92:95], v[156:159]
    s_waitcnt lgkmcnt(9)
    buffer_load_dwordx4 v44, s[16:19], s49 offen offset:2048 lds
    v_mfma_f32_16x16x32_bf16 v[160:163], a[160:163], a[80:83], v[160:163]
    s_waitcnt lgkmcnt(7)
    ds_read_b64_tr_b16 a[182:183], v18 offset:45056
    ds_read_b64_tr_b16 a[184:185], v19 offset:32768
    v_mfma_f32_16x16x32_bf16 v[160:163], a[164:167], a[88:91], v[160:163]
    ds_read_b64_tr_b16 a[186:187], v19 offset:36864
    v_accvgpr_write_b32 a8, 0
    v_mfma_f32_16x16x32_bf16 v[164:167], a[160:163], a[84:87], v[164:167]
    ds_read_b64_tr_b16 a[188:189], v19 offset:40960
    v_accvgpr_write_b32 a9, 0
    v_mfma_f32_16x16x32_bf16 v[164:167], a[164:167], a[92:95], v[164:167]
    s_waitcnt lgkmcnt(9)
    buffer_load_dwordx4 v45, s[16:19], s49 offen offset:3072 lds
    v_mfma_f32_16x16x32_bf16 v[168:171], a[168:171], a[80:83], v[168:171]
    s_waitcnt lgkmcnt(7)
    ds_read_b64_tr_b16 a[190:191], v19 offset:45056
    ds_read_b64_tr_b16 a[160:161], v12 offset:49152
    v_mfma_f32_16x16x32_bf16 v[168:171], a[172:175], a[88:91], v[168:171]
    ds_read_b64_tr_b16 a[162:163], v12 offset:53248
    v_accvgpr_write_b32 a10, 0
    v_mfma_f32_16x16x32_bf16 v[172:175], a[168:171], a[84:87], v[172:175]
    ds_read_b64_tr_b16 a[164:165], v12 offset:57344
    v_accvgpr_write_b32 a11, 0
    v_mfma_f32_16x16x32_bf16 v[172:175], a[172:175], a[92:95], v[172:175]
    s_waitcnt lgkmcnt(9)
    buffer_load_dwordx4 a[112:115], v51, s[24:27], s46 offen offset:1792 sc1
    v_mfma_f32_16x16x32_bf16 v[176:179], a[176:179], a[80:83], v[176:179]
    s_waitcnt lgkmcnt(7)
    ds_read_b64_tr_b16 a[166:167], v12 offset:61440
    ds_read_b64_tr_b16 a[168:169], v13 offset:49152
    v_mfma_f32_16x16x32_bf16 v[176:179], a[180:183], a[88:91], v[176:179]
    ds_read_b64_tr_b16 a[170:171], v13 offset:53248
    v_accvgpr_write_b32 a12, 0
    v_mfma_f32_16x16x32_bf16 v[180:183], a[176:179], a[84:87], v[180:183]
    ds_read_b64_tr_b16 a[172:173], v13 offset:57344
    v_accvgpr_write_b32 a13, 0
    v_mfma_f32_16x16x32_bf16 v[180:183], a[180:183], a[92:95], v[180:183]
    s_waitcnt lgkmcnt(9)
    buffer_load_dwordx4 a[120:123], v51, s[24:27], s46 offen offset:1920 sc1
    v_mfma_f32_16x16x32_bf16 v[184:187], a[184:187], a[80:83], v[184:187]
    s_waitcnt lgkmcnt(7)
    ds_read_b64_tr_b16 a[174:175], v13 offset:61440
    ds_read_b64_tr_b16 a[176:177], v14 offset:49152
    v_mfma_f32_16x16x32_bf16 v[184:187], a[188:191], a[88:91], v[184:187]
    ds_read_b64_tr_b16 a[178:179], v14 offset:53248
    v_accvgpr_write_b32 a14, 0
    v_mfma_f32_16x16x32_bf16 v[188:191], a[184:187], a[84:87], v[188:191]
    ds_read_b64_tr_b16 a[180:181], v14 offset:57344
    v_accvgpr_write_b32 a15, 0
    v_mfma_f32_16x16x32_bf16 v[188:191], a[188:191], a[92:95], v[188:191]
    s_waitcnt lgkmcnt(9)
    buffer_load_dwordx4 a[116:119], v51, s[24:27], s43 offen offset:1792 sc1
    v_mfma_f32_16x16x32_bf16 v[192:195], a[160:163], a[80:83], v[192:195]
    s_waitcnt lgkmcnt(7)
    ds_read_b64_tr_b16 a[182:183], v14 offset:61440
    ds_read_b64_tr_b16 a[184:185], v15 offset:49152
    v_mfma_f32_16x16x32_bf16 v[192:195], a[164:167], a[88:91], v[192:195]
    ds_read_b64_tr_b16 a[186:187], v15 offset:53248
    v_accvgpr_write_b32 a16, 0
    v_mfma_f32_16x16x32_bf16 v[196:199], a[160:163], a[84:87], v[196:199]
    ds_read_b64_tr_b16 a[188:189], v15 offset:57344
    v_accvgpr_write_b32 a17, 0
    v_mfma_f32_16x16x32_bf16 v[196:199], a[164:167], a[92:95], v[196:199]
    s_waitcnt lgkmcnt(9)
    buffer_load_dwordx4 a[124:127], v51, s[24:27], s43 offen offset:1920 sc1
    v_mfma_f32_16x16x32_bf16 v[200:203], a[168:171], a[80:83], v[200:203]
    s_waitcnt lgkmcnt(7)
    ds_read_b64_tr_b16 a[190:191], v15 offset:61440
    ds_read_b64_tr_b16 a[160:161], v16 offset:49152
    v_mfma_f32_16x16x32_bf16 v[200:203], a[172:175], a[88:91], v[200:203]
    ds_read_b64_tr_b16 a[162:163], v16 offset:53248
    v_accvgpr_write_b32 a18, 0
    v_mfma_f32_16x16x32_bf16 v[204:207], a[168:171], a[84:87], v[204:207]
    ds_read_b64_tr_b16 a[164:165], v16 offset:57344
    v_accvgpr_write_b32 a19, 0
    v_mfma_f32_16x16x32_bf16 v[204:207], a[172:175], a[92:95], v[204:207]
    s_waitcnt lgkmcnt(9)
    ds_read_b64_tr_b16 a[166:167], v16 offset:61440
    v_accvgpr_write_b32 a20, 0
    v_mfma_f32_16x16x32_bf16 v[208:211], a[176:179], a[80:83], v[208:211]
    s_waitcnt lgkmcnt(8)
    ds_read_b64_tr_b16 a[168:169], v17 offset:49152
    v_accvgpr_write_b32 a21, 0
    v_mfma_f32_16x16x32_bf16 v[208:211], a[180:183], a[88:91], v[208:211]
    ds_read_b64_tr_b16 a[170:171], v17 offset:53248
    v_accvgpr_write_b32 a22, 0
    v_mfma_f32_16x16x32_bf16 v[212:215], a[176:179], a[84:87], v[212:215]
    ds_read_b64_tr_b16 a[172:173], v17 offset:57344
    v_accvgpr_write_b32 a23, 0
    v_mfma_f32_16x16x32_bf16 v[212:215], a[180:183], a[92:95], v[212:215]
    s_waitcnt lgkmcnt(9)
    ds_read_b64_tr_b16 a[174:175], v17 offset:61440
    v_accvgpr_write_b32 a24, 0
    v_mfma_f32_16x16x32_bf16 v[216:219], a[184:187], a[80:83], v[216:219]
    s_waitcnt lgkmcnt(8)
    ds_read_b64_tr_b16 a[176:177], v18 offset:49152
    v_accvgpr_write_b32 a25, 0
    v_mfma_f32_16x16x32_bf16 v[216:219], a[188:191], a[88:91], v[216:219]
    ds_read_b64_tr_b16 a[178:179], v18 offset:53248
    v_accvgpr_write_b32 a26, 0
    v_mfma_f32_16x16x32_bf16 v[220:223], a[184:187], a[84:87], v[220:223]
    ds_read_b64_tr_b16 a[180:181], v18 offset:57344
    v_accvgpr_write_b32 a27, 0
    v_mfma_f32_16x16x32_bf16 v[220:223], a[188:191], a[92:95], v[220:223]
    s_waitcnt lgkmcnt(9)
    ds_read_b64_tr_b16 a[182:183], v18 offset:61440
    v_accvgpr_write_b32 a28, 0
    v_mfma_f32_16x16x32_bf16 v[224:227], a[160:163], a[80:83], v[224:227]
    s_waitcnt lgkmcnt(8)
    ds_read_b64_tr_b16 a[184:185], v19 offset:49152
    v_accvgpr_write_b32 a29, 0
    v_mfma_f32_16x16x32_bf16 v[224:227], a[164:167], a[88:91], v[224:227]
    ds_read_b64_tr_b16 a[186:187], v19 offset:53248
    v_accvgpr_write_b32 a30, 0
    v_mfma_f32_16x16x32_bf16 v[228:231], a[160:163], a[84:87], v[228:231]
    ds_read_b64_tr_b16 a[188:189], v19 offset:57344
    v_accvgpr_write_b32 a31, 0
    v_mfma_f32_16x16x32_bf16 v[228:231], a[164:167], a[92:95], v[228:231]
    s_waitcnt lgkmcnt(9)
    ds_read_b64_tr_b16 a[190:191], v19 offset:61440
    v_accvgpr_write_b32 a32, 0
    s_waitcnt vmcnt(16)
    s_barrier
    v_mfma_f32_16x16x32_bf16 v[232:235], a[168:171], a[80:83], v[232:235]
    s_waitcnt lgkmcnt(8)
    ds_read_b64_tr_b16 a[160:161], v20 offset:0
    v_accvgpr_write_b32 a33, 0
    v_mfma_f32_16x16x32_bf16 v[232:235], a[172:175], a[88:91], v[232:235]
    s_add_u32 s49, s44, 4194304
    ds_read_b64_tr_b16 a[162:163], v20 offset:4096
    v_accvgpr_write_b32 a34, 0
    v_mfma_f32_16x16x32_bf16 v[236:239], a[168:171], a[84:87], v[236:239]
    s_add_u32 m0, s42, 131072
    ds_read_b64_tr_b16 a[164:165], v20 offset:8192
    v_accvgpr_write_b32 a35, 0
    v_mfma_f32_16x16x32_bf16 v[236:239], a[172:175], a[92:95], v[236:239]
    s_waitcnt lgkmcnt(9)
    buffer_load_dwordx4 v42, s[16:19], s49 offen lds
    v_mfma_f32_16x16x32_bf16 v[240:243], a[176:179], a[80:83], v[240:243]
    s_waitcnt lgkmcnt(7)
    ds_read_b64_tr_b16 a[166:167], v20 offset:12288
    ds_read_b64_tr_b16 a[168:169], v21 offset:0
    v_mfma_f32_16x16x32_bf16 v[240:243], a[180:183], a[88:91], v[240:243]
    ds_read_b64_tr_b16 a[170:171], v21 offset:4096
    v_accvgpr_write_b32 a36, 0
    v_mfma_f32_16x16x32_bf16 v[244:247], a[176:179], a[84:87], v[244:247]
    ds_read_b64_tr_b16 a[172:173], v21 offset:8192
    v_accvgpr_write_b32 a37, 0
    v_mfma_f32_16x16x32_bf16 v[244:247], a[180:183], a[92:95], v[244:247]
    s_waitcnt lgkmcnt(9)
    buffer_load_dwordx4 v43, s[16:19], s49 offen offset:1024 lds
    v_mfma_f32_16x16x32_bf16 v[248:251], a[184:187], a[80:83], v[248:251]
    s_waitcnt lgkmcnt(7)
    ds_read_b64_tr_b16 a[174:175], v21 offset:12288
    ds_read_b64_tr_b16 a[176:177], v22 offset:0
    v_mfma_f32_16x16x32_bf16 v[248:251], a[188:191], a[88:91], v[248:251]
    ds_read_b64_tr_b16 a[178:179], v22 offset:4096
    v_accvgpr_write_b32 a38, 0
    v_mfma_f32_16x16x32_bf16 v[252:255], a[184:187], a[84:87], v[252:255]
    ds_read_b64_tr_b16 a[180:181], v22 offset:8192
    v_accvgpr_write_b32 a39, 0
    v_mfma_f32_16x16x32_bf16 v[252:255], a[188:191], a[92:95], v[252:255]
    s_waitcnt vmcnt(17)
    s_waitcnt lgkmcnt(9)
    buffer_load_dwordx4 v44, s[16:19], s49 offen offset:2048 lds
    v_mfma_f32_16x16x32_bf16 v[128:131], a[160:163], a[96:99], v[128:131]
    s_waitcnt vmcnt(17)
    s_waitcnt lgkmcnt(7)
    ds_read_b64_tr_b16 a[182:183], v22 offset:12288
    ds_read_b64_tr_b16 a[184:185], v23 offset:0
    v_mfma_f32_16x16x32_bf16 v[128:131], a[164:167], a[104:107], v[128:131]
    s_waitcnt vmcnt(16)
    ds_read_b64_tr_b16 a[186:187], v23 offset:4096
    v_accvgpr_write_b32 a40, 0
    v_mfma_f32_16x16x32_bf16 v[132:135], a[160:163], a[100:103], v[132:135]
    s_waitcnt vmcnt(15)
    ds_read_b64_tr_b16 a[188:189], v23 offset:8192
    v_accvgpr_write_b32 a41, 0
    v_mfma_f32_16x16x32_bf16 v[132:135], a[164:167], a[108:111], v[132:135]
    s_waitcnt lgkmcnt(9)
    buffer_load_dwordx4 v45, s[16:19], s49 offen offset:3072 lds
    v_mfma_f32_16x16x32_bf16 v[136:139], a[168:171], a[96:99], v[136:139]
    s_waitcnt lgkmcnt(7)
    ds_read_b64_tr_b16 a[190:191], v23 offset:12288
    ds_read_b64_tr_b16 a[160:161], v24 offset:0
    v_mfma_f32_16x16x32_bf16 v[136:139], a[172:175], a[104:107], v[136:139]
    s_add_u32 s49, s44, 4194560
    ds_read_b64_tr_b16 a[162:163], v24 offset:4096
    v_accvgpr_write_b32 a42, 0
    v_mfma_f32_16x16x32_bf16 v[140:143], a[168:171], a[100:103], v[140:143]
    s_add_u32 m0, s42, 147456
    ds_read_b64_tr_b16 a[164:165], v24 offset:8192
    v_accvgpr_write_b32 a43, 0
    v_mfma_f32_16x16x32_bf16 v[140:143], a[172:175], a[108:111], v[140:143]
    s_waitcnt lgkmcnt(9)
    buffer_load_dwordx4 v42, s[16:19], s49 offen lds
    v_mfma_f32_16x16x32_bf16 v[144:147], a[176:179], a[96:99], v[144:147]
    s_waitcnt lgkmcnt(7)
    ds_read_b64_tr_b16 a[166:167], v24 offset:12288
    ds_read_b64_tr_b16 a[168:169], v25 offset:0
    v_mfma_f32_16x16x32_bf16 v[144:147], a[180:183], a[104:107], v[144:147]
    ds_read_b64_tr_b16 a[170:171], v25 offset:4096
    v_accvgpr_write_b32 a44, 0
    v_mfma_f32_16x16x32_bf16 v[148:151], a[176:179], a[100:103], v[148:151]
    ds_read_b64_tr_b16 a[172:173], v25 offset:8192
    v_accvgpr_write_b32 a45, 0
    v_mfma_f32_16x16x32_bf16 v[148:151], a[180:183], a[108:111], v[148:151]
    s_waitcnt lgkmcnt(9)
    buffer_load_dwordx4 v43, s[16:19], s49 offen offset:1024 lds
    v_mfma_f32_16x16x32_bf16 v[152:155], a[184:187], a[96:99], v[152:155]
    s_waitcnt lgkmcnt(7)
    ds_read_b64_tr_b16 a[174:175], v25 offset:12288
    ds_read_b64_tr_b16 a[176:177], v26 offset:0
    v_mfma_f32_16x16x32_bf16 v[152:155], a[188:191], a[104:107], v[152:155]
    ds_read_b64_tr_b16 a[178:179], v26 offset:4096
    v_accvgpr_write_b32 a46, 0
    v_mfma_f32_16x16x32_bf16 v[156:159], a[184:187], a[100:103], v[156:159]
    ds_read_b64_tr_b16 a[180:181], v26 offset:8192
    v_accvgpr_write_b32 a47, 0
    v_mfma_f32_16x16x32_bf16 v[156:159], a[188:191], a[108:111], v[156:159]
    s_waitcnt lgkmcnt(9)
    buffer_load_dwordx4 v44, s[16:19], s49 offen offset:2048 lds
    v_mfma_f32_16x16x32_bf16 v[160:163], a[160:163], a[96:99], v[160:163]
    s_waitcnt lgkmcnt(7)
    ds_read_b64_tr_b16 a[182:183], v26 offset:12288
    ds_read_b64_tr_b16 a[184:185], v27 offset:0
    v_mfma_f32_16x16x32_bf16 v[160:163], a[164:167], a[104:107], v[160:163]
    ds_read_b64_tr_b16 a[186:187], v27 offset:4096
    v_accvgpr_write_b32 a48, 0
    v_mfma_f32_16x16x32_bf16 v[164:167], a[160:163], a[100:103], v[164:167]
    ds_read_b64_tr_b16 a[188:189], v27 offset:8192
    v_accvgpr_write_b32 a49, 0
    v_mfma_f32_16x16x32_bf16 v[164:167], a[164:167], a[108:111], v[164:167]
    s_waitcnt lgkmcnt(9)
    buffer_load_dwordx4 v45, s[16:19], s49 offen offset:3072 lds
    v_mfma_f32_16x16x32_bf16 v[168:171], a[168:171], a[96:99], v[168:171]
    s_waitcnt lgkmcnt(7)
    ds_read_b64_tr_b16 a[190:191], v27 offset:12288
    ds_read_b64_tr_b16 a[160:161], v20 offset:16384
    v_mfma_f32_16x16x32_bf16 v[168:171], a[172:175], a[104:107], v[168:171]
    ds_read_b64_tr_b16 a[162:163], v20 offset:20480
    v_accvgpr_write_b32 a50, 0
    v_mfma_f32_16x16x32_bf16 v[172:175], a[168:171], a[100:103], v[172:175]
    ds_read_b64_tr_b16 a[164:165], v20 offset:24576
    v_accvgpr_write_b32 a51, 0
    v_mfma_f32_16x16x32_bf16 v[172:175], a[172:175], a[108:111], v[172:175]
    s_waitcnt lgkmcnt(9)
    buffer_load_dwordx4 a[128:131], v51, s[24:27], s46 offen offset:2048 sc1
    v_mfma_f32_16x16x32_bf16 v[176:179], a[176:179], a[96:99], v[176:179]
    s_waitcnt lgkmcnt(7)
    ds_read_b64_tr_b16 a[166:167], v20 offset:28672
    ds_read_b64_tr_b16 a[168:169], v21 offset:16384
    v_mfma_f32_16x16x32_bf16 v[176:179], a[180:183], a[104:107], v[176:179]
    ds_read_b64_tr_b16 a[170:171], v21 offset:20480
    v_accvgpr_write_b32 a52, 0
    v_mfma_f32_16x16x32_bf16 v[180:183], a[176:179], a[100:103], v[180:183]
    ds_read_b64_tr_b16 a[172:173], v21 offset:24576
    v_accvgpr_write_b32 a53, 0
    v_mfma_f32_16x16x32_bf16 v[180:183], a[180:183], a[108:111], v[180:183]
    s_waitcnt lgkmcnt(9)
    buffer_load_dwordx4 a[136:139], v51, s[24:27], s46 offen offset:2176 sc1
    v_mfma_f32_16x16x32_bf16 v[184:187], a[184:187], a[96:99], v[184:187]
    s_waitcnt lgkmcnt(7)
    ds_read_b64_tr_b16 a[174:175], v21 offset:28672
    ds_read_b64_tr_b16 a[176:177], v22 offset:16384
    v_mfma_f32_16x16x32_bf16 v[184:187], a[188:191], a[104:107], v[184:187]
    ds_read_b64_tr_b16 a[178:179], v22 offset:20480
    v_accvgpr_write_b32 a54, 0
    v_mfma_f32_16x16x32_bf16 v[188:191], a[184:187], a[100:103], v[188:191]
    ds_read_b64_tr_b16 a[180:181], v22 offset:24576
    v_accvgpr_write_b32 a55, 0
    v_mfma_f32_16x16x32_bf16 v[188:191], a[188:191], a[108:111], v[188:191]
    s_waitcnt lgkmcnt(9)
    buffer_load_dwordx4 a[132:135], v51, s[24:27], s43 offen offset:2048 sc1
    v_mfma_f32_16x16x32_bf16 v[192:195], a[160:163], a[96:99], v[192:195]
    s_waitcnt lgkmcnt(7)
    ds_read_b64_tr_b16 a[182:183], v22 offset:28672
    ds_read_b64_tr_b16 a[184:185], v23 offset:16384
    v_mfma_f32_16x16x32_bf16 v[192:195], a[164:167], a[104:107], v[192:195]
    ds_read_b64_tr_b16 a[186:187], v23 offset:20480
    v_accvgpr_write_b32 a56, 0
    v_mfma_f32_16x16x32_bf16 v[196:199], a[160:163], a[100:103], v[196:199]
    ds_read_b64_tr_b16 a[188:189], v23 offset:24576
    v_accvgpr_write_b32 a57, 0
    v_mfma_f32_16x16x32_bf16 v[196:199], a[164:167], a[108:111], v[196:199]
    s_waitcnt lgkmcnt(9)
    buffer_load_dwordx4 a[140:143], v51, s[24:27], s43 offen offset:2176 sc1
    v_mfma_f32_16x16x32_bf16 v[200:203], a[168:171], a[96:99], v[200:203]
    s_waitcnt lgkmcnt(7)
    ds_read_b64_tr_b16 a[190:191], v23 offset:28672
    ds_read_b64_tr_b16 a[160:161], v24 offset:16384
    v_mfma_f32_16x16x32_bf16 v[200:203], a[172:175], a[104:107], v[200:203]
    ds_read_b64_tr_b16 a[162:163], v24 offset:20480
    v_accvgpr_write_b32 a58, 0
    v_mfma_f32_16x16x32_bf16 v[204:207], a[168:171], a[100:103], v[204:207]
    ds_read_b64_tr_b16 a[164:165], v24 offset:24576
    v_accvgpr_write_b32 a59, 0
    v_mfma_f32_16x16x32_bf16 v[204:207], a[172:175], a[108:111], v[204:207]
    s_waitcnt lgkmcnt(9)
    ds_read_b64_tr_b16 a[166:167], v24 offset:28672
    v_accvgpr_write_b32 a60, 0
    v_mfma_f32_16x16x32_bf16 v[208:211], a[176:179], a[96:99], v[208:211]
    s_waitcnt lgkmcnt(8)
    ds_read_b64_tr_b16 a[168:169], v25 offset:16384
    v_accvgpr_write_b32 a61, 0
    v_mfma_f32_16x16x32_bf16 v[208:211], a[180:183], a[104:107], v[208:211]
    ds_read_b64_tr_b16 a[170:171], v25 offset:20480
    v_accvgpr_write_b32 a62, 0
    v_mfma_f32_16x16x32_bf16 v[212:215], a[176:179], a[100:103], v[212:215]
    ds_read_b64_tr_b16 a[172:173], v25 offset:24576
    v_accvgpr_write_b32 a63, 0
    v_mfma_f32_16x16x32_bf16 v[212:215], a[180:183], a[108:111], v[212:215]
    s_waitcnt lgkmcnt(9)
    ds_read_b64_tr_b16 a[174:175], v25 offset:28672
    v_accvgpr_write_b32 a64, 0
    v_mfma_f32_16x16x32_bf16 v[216:219], a[184:187], a[96:99], v[216:219]
    s_waitcnt lgkmcnt(8)
    ds_read_b64_tr_b16 a[176:177], v26 offset:16384
    v_accvgpr_write_b32 a65, 0
    v_mfma_f32_16x16x32_bf16 v[216:219], a[188:191], a[104:107], v[216:219]
    ds_read_b64_tr_b16 a[178:179], v26 offset:20480
    v_accvgpr_write_b32 a66, 0
    v_mfma_f32_16x16x32_bf16 v[220:223], a[184:187], a[100:103], v[220:223]
    ds_read_b64_tr_b16 a[180:181], v26 offset:24576
    v_accvgpr_write_b32 a67, 0
    v_mfma_f32_16x16x32_bf16 v[220:223], a[188:191], a[108:111], v[220:223]
    s_waitcnt lgkmcnt(9)
    ds_read_b64_tr_b16 a[182:183], v26 offset:28672
    v_accvgpr_write_b32 a68, 0
    v_mfma_f32_16x16x32_bf16 v[224:227], a[160:163], a[96:99], v[224:227]
    s_waitcnt lgkmcnt(8)
    ds_read_b64_tr_b16 a[184:185], v27 offset:16384
    v_accvgpr_write_b32 a69, 0
    v_mfma_f32_16x16x32_bf16 v[224:227], a[164:167], a[104:107], v[224:227]
    ds_read_b64_tr_b16 a[186:187], v27 offset:20480
    v_accvgpr_write_b32 a70, 0
    v_mfma_f32_16x16x32_bf16 v[228:231], a[160:163], a[100:103], v[228:231]
    ds_read_b64_tr_b16 a[188:189], v27 offset:24576
    v_accvgpr_write_b32 a71, 0
    v_mfma_f32_16x16x32_bf16 v[228:231], a[164:167], a[108:111], v[228:231]
    s_waitcnt lgkmcnt(9)
    ds_read_b64_tr_b16 a[190:191], v27 offset:28672
    v_accvgpr_write_b32 a72, 0
    s_waitcnt vmcnt(16)
    s_barrier
    v_mfma_f32_16x16x32_bf16 v[232:235], a[168:171], a[96:99], v[232:235]
    s_waitcnt lgkmcnt(8)
    ds_read_b64_tr_b16 a[160:161], v20 offset:32768
    v_accvgpr_write_b32 a73, 0
    v_mfma_f32_16x16x32_bf16 v[232:235], a[172:175], a[104:107], v[232:235]
    ds_read_b64_tr_b16 a[162:163], v20 offset:36864
    v_accvgpr_write_b32 a74, 0
    v_mfma_f32_16x16x32_bf16 v[236:239], a[168:171], a[100:103], v[236:239]
    s_add_u32 m0, s42, 0
    ds_read_b64_tr_b16 a[164:165], v20 offset:40960
    v_accvgpr_write_b32 a75, 0
    v_mfma_f32_16x16x32_bf16 v[236:239], a[172:175], a[108:111], v[236:239]
    s_waitcnt lgkmcnt(9)
    buffer_load_dwordx4 v36, s[8:11], s40 offen lds
    v_mfma_f32_16x16x32_bf16 v[240:243], a[176:179], a[96:99], v[240:243]
    s_waitcnt lgkmcnt(7)
    ds_read_b64_tr_b16 a[166:167], v20 offset:45056
    ds_read_b64_tr_b16 a[168:169], v21 offset:32768
    v_mfma_f32_16x16x32_bf16 v[240:243], a[180:183], a[104:107], v[240:243]
    ds_read_b64_tr_b16 a[170:171], v21 offset:36864
    v_accvgpr_write_b32 a76, 0
    v_mfma_f32_16x16x32_bf16 v[244:247], a[176:179], a[100:103], v[244:247]
    ds_read_b64_tr_b16 a[172:173], v21 offset:40960
    v_accvgpr_write_b32 a77, 0
    v_mfma_f32_16x16x32_bf16 v[244:247], a[180:183], a[108:111], v[244:247]
    s_waitcnt lgkmcnt(9)
    buffer_load_dwordx4 v37, s[8:11], s40 offen offset:1024 lds
    v_mfma_f32_16x16x32_bf16 v[248:251], a[184:187], a[96:99], v[248:251]
    s_waitcnt lgkmcnt(7)
    ds_read_b64_tr_b16 a[174:175], v21 offset:45056
    ds_read_b64_tr_b16 a[176:177], v22 offset:32768
    v_mfma_f32_16x16x32_bf16 v[248:251], a[188:191], a[104:107], v[248:251]
    ds_read_b64_tr_b16 a[178:179], v22 offset:36864
    v_accvgpr_write_b32 a78, 0
    v_mfma_f32_16x16x32_bf16 v[252:255], a[184:187], a[100:103], v[252:255]
    ds_read_b64_tr_b16 a[180:181], v22 offset:40960
    v_accvgpr_write_b32 a79, 0
    v_mfma_f32_16x16x32_bf16 v[252:255], a[188:191], a[108:111], v[252:255]
    s_waitcnt vmcnt(17)
    s_waitcnt lgkmcnt(9)
    buffer_load_dwordx4 v38, s[8:11], s40 offen offset:2048 lds
    v_mfma_f32_16x16x32_bf16 v[128:131], a[160:163], a[112:115], v[128:131]
    s_waitcnt vmcnt(17)
    s_waitcnt lgkmcnt(7)
    ds_read_b64_tr_b16 a[182:183], v22 offset:45056
    ds_read_b64_tr_b16 a[184:185], v23 offset:32768
    v_mfma_f32_16x16x32_bf16 v[128:131], a[164:167], a[120:123], v[128:131]
    s_waitcnt vmcnt(16)
    ds_read_b64_tr_b16 a[186:187], v23 offset:36864
    v_accvgpr_write_b32 a80, 0
    v_mfma_f32_16x16x32_bf16 v[132:135], a[160:163], a[116:119], v[132:135]
    s_waitcnt vmcnt(15)
    ds_read_b64_tr_b16 a[188:189], v23 offset:40960
    v_accvgpr_write_b32 a81, 0
    v_mfma_f32_16x16x32_bf16 v[132:135], a[164:167], a[124:127], v[132:135]
    s_waitcnt lgkmcnt(9)
    buffer_load_dwordx4 v39, s[8:11], s40 offen offset:3072 lds
    v_mfma_f32_16x16x32_bf16 v[136:139], a[168:171], a[112:115], v[136:139]
    s_waitcnt lgkmcnt(7)
    s_add_u32 s40, s40, 16384
    ds_read_b64_tr_b16 a[190:191], v23 offset:45056
    ds_read_b64_tr_b16 a[160:161], v24 offset:32768
    v_mfma_f32_16x16x32_bf16 v[136:139], a[172:175], a[120:123], v[136:139]
    ds_read_b64_tr_b16 a[162:163], v24 offset:36864
    v_accvgpr_write_b32 a82, 0
    v_mfma_f32_16x16x32_bf16 v[140:143], a[168:171], a[116:119], v[140:143]
    s_add_u32 m0, s42, 16384
    ds_read_b64_tr_b16 a[164:165], v24 offset:40960
    v_accvgpr_write_b32 a83, 0
    v_mfma_f32_16x16x32_bf16 v[140:143], a[172:175], a[124:127], v[140:143]
    s_waitcnt lgkmcnt(9)
    buffer_load_dwordx4 v36, s[8:11], s40 offen lds
    v_mfma_f32_16x16x32_bf16 v[144:147], a[176:179], a[112:115], v[144:147]
    s_waitcnt lgkmcnt(7)
    ds_read_b64_tr_b16 a[166:167], v24 offset:45056
    ds_read_b64_tr_b16 a[168:169], v25 offset:32768
    v_mfma_f32_16x16x32_bf16 v[144:147], a[180:183], a[120:123], v[144:147]
    ds_read_b64_tr_b16 a[170:171], v25 offset:36864
    v_accvgpr_write_b32 a84, 0
    v_mfma_f32_16x16x32_bf16 v[148:151], a[176:179], a[116:119], v[148:151]
    ds_read_b64_tr_b16 a[172:173], v25 offset:40960
    v_accvgpr_write_b32 a85, 0
    v_mfma_f32_16x16x32_bf16 v[148:151], a[180:183], a[124:127], v[148:151]
    s_waitcnt lgkmcnt(9)
    buffer_load_dwordx4 v37, s[8:11], s40 offen offset:1024 lds
    v_mfma_f32_16x16x32_bf16 v[152:155], a[184:187], a[112:115], v[152:155]
    s_waitcnt lgkmcnt(7)
    ds_read_b64_tr_b16 a[174:175], v25 offset:45056
    ds_read_b64_tr_b16 a[176:177], v26 offset:32768
    v_mfma_f32_16x16x32_bf16 v[152:155], a[188:191], a[120:123], v[152:155]
    ds_read_b64_tr_b16 a[178:179], v26 offset:36864
    v_accvgpr_write_b32 a86, 0
    v_mfma_f32_16x16x32_bf16 v[156:159], a[184:187], a[116:119], v[156:159]
    ds_read_b64_tr_b16 a[180:181], v26 offset:40960
    v_accvgpr_write_b32 a87, 0
    v_mfma_f32_16x16x32_bf16 v[156:159], a[188:191], a[124:127], v[156:159]
    s_waitcnt lgkmcnt(9)
    buffer_load_dwordx4 v38, s[8:11], s40 offen offset:2048 lds
    v_mfma_f32_16x16x32_bf16 v[160:163], a[160:163], a[112:115], v[160:163]
    s_waitcnt lgkmcnt(7)
    ds_read_b64_tr_b16 a[182:183], v26 offset:45056
    ds_read_b64_tr_b16 a[184:185], v27 offset:32768
    v_mfma_f32_16x16x32_bf16 v[160:163], a[164:167], a[120:123], v[160:163]
    ds_read_b64_tr_b16 a[186:187], v27 offset:36864
    v_accvgpr_write_b32 a88, 0
    v_mfma_f32_16x16x32_bf16 v[164:167], a[160:163], a[116:119], v[164:167]
    ds_read_b64_tr_b16 a[188:189], v27 offset:40960
    v_accvgpr_write_b32 a89, 0
    v_mfma_f32_16x16x32_bf16 v[164:167], a[164:167], a[124:127], v[164:167]
    s_waitcnt lgkmcnt(9)
    buffer_load_dwordx4 v39, s[8:11], s40 offen offset:3072 lds
    v_mfma_f32_16x16x32_bf16 v[168:171], a[168:171], a[112:115], v[168:171]
    s_waitcnt lgkmcnt(7)
    s_add_u32 s40, s40, 16384
    ds_read_b64_tr_b16 a[190:191], v27 offset:45056
    ds_read_b64_tr_b16 a[160:161], v20 offset:49152
    v_mfma_f32_16x16x32_bf16 v[168:171], a[172:175], a[120:123], v[168:171]
    ds_read_b64_tr_b16 a[162:163], v20 offset:53248
    v_accvgpr_write_b32 a90, 0
    v_mfma_f32_16x16x32_bf16 v[172:175], a[168:171], a[116:119], v[172:175]
    ds_read_b64_tr_b16 a[164:165], v20 offset:57344
    v_accvgpr_write_b32 a91, 0
    v_mfma_f32_16x16x32_bf16 v[172:175], a[172:175], a[124:127], v[172:175]
    s_waitcnt lgkmcnt(9)
    buffer_store_dword v76, v72, s[24:27], s92 offen offset:12 sc1
    v_mfma_f32_16x16x32_bf16 v[176:179], a[176:179], a[112:115], v[176:179]
    s_waitcnt lgkmcnt(7)
    ds_read_b64_tr_b16 a[166:167], v20 offset:61440
    ds_read_b64_tr_b16 a[168:169], v21 offset:49152
    v_mfma_f32_16x16x32_bf16 v[176:179], a[180:183], a[120:123], v[176:179]
    ds_read_b64_tr_b16 a[170:171], v21 offset:53248
    v_accvgpr_write_b32 a92, 0
    v_mfma_f32_16x16x32_bf16 v[180:183], a[176:179], a[116:119], v[180:183]
    ds_read_b64_tr_b16 a[172:173], v21 offset:57344
    v_accvgpr_write_b32 a93, 0
    v_mfma_f32_16x16x32_bf16 v[180:183], a[180:183], a[124:127], v[180:183]
    s_waitcnt lgkmcnt(9)
    buffer_store_dwordx4 v[88:91], v74, s[24:27], 0 offen sc1
    v_mfma_f32_16x16x32_bf16 v[184:187], a[184:187], a[112:115], v[184:187]
    s_waitcnt lgkmcnt(7)
    ds_read_b64_tr_b16 a[174:175], v21 offset:61440
    ds_read_b64_tr_b16 a[176:177], v22 offset:49152
    v_mfma_f32_16x16x32_bf16 v[184:187], a[188:191], a[120:123], v[184:187]
    ds_read_b64_tr_b16 a[178:179], v22 offset:53248
    v_accvgpr_write_b32 a94, 0
    v_mfma_f32_16x16x32_bf16 v[188:191], a[184:187], a[116:119], v[188:191]
    ds_read_b64_tr_b16 a[180:181], v22 offset:57344
    v_accvgpr_write_b32 a95, 0
    v_mfma_f32_16x16x32_bf16 v[188:191], a[188:191], a[124:127], v[188:191]
    s_waitcnt lgkmcnt(9)
    ds_read_b64_tr_b16 a[182:183], v22 offset:61440
    v_accvgpr_write_b32 a96, 0
    v_mfma_f32_16x16x32_bf16 v[192:195], a[160:163], a[112:115], v[192:195]
    s_waitcnt lgkmcnt(8)
    ds_read_b64_tr_b16 a[184:185], v23 offset:49152
    v_accvgpr_write_b32 a97, 0
    v_mfma_f32_16x16x32_bf16 v[192:195], a[164:167], a[120:123], v[192:195]
Ltour2:
    s_cbranch_execz Ltour6
    ds_read_b64_tr_b16 a[186:187], v23 offset:53248
    v_accvgpr_write_b32 a98, 0
    v_mfma_f32_16x16x32_bf16 v[196:199], a[160:163], a[116:119], v[196:199]
    ds_read_b64_tr_b16 a[188:189], v23 offset:57344
    v_accvgpr_write_b32 a99, 0
    v_mfma_f32_16x16x32_bf16 v[196:199], a[164:167], a[124:127], v[196:199]
    s_waitcnt lgkmcnt(9)
    ds_read_b64_tr_b16 a[190:191], v23 offset:61440
    v_accvgpr_write_b32 a100, 0
    v_mfma_f32_16x16x32_bf16 v[200:203], a[168:171], a[112:115], v[200:203]
    s_waitcnt lgkmcnt(8)
    ds_read_b64_tr_b16 a[160:161], v24 offset:49152
    v_accvgpr_write_b32 a101, 0
    v_mfma_f32_16x16x32_bf16 v[200:203], a[172:175], a[120:123], v[200:203]
    ds_read_b64_tr_b16 a[162:163], v24 offset:53248
    v_accvgpr_write_b32 a102, 0
    v_mfma_f32_16x16x32_bf16 v[204:207], a[168:171], a[116:119], v[204:207]
    ds_read_b64_tr_b16 a[164:165], v24 offset:57344
    v_accvgpr_write_b32 a103, 0
    v_mfma_f32_16x16x32_bf16 v[204:207], a[172:175], a[124:127], v[204:207]
    s_waitcnt lgkmcnt(9)
    ds_read_b64_tr_b16 a[166:167], v24 offset:61440
    v_accvgpr_write_b32 a104, 0
    v_mfma_f32_16x16x32_bf16 v[208:211], a[176:179], a[112:115], v[208:211]
    s_waitcnt lgkmcnt(8)
    ds_read_b64_tr_b16 a[168:169], v25 offset:49152
    v_accvgpr_write_b32 a105, 0
    v_mfma_f32_16x16x32_bf16 v[208:211], a[180:183], a[120:123], v[208:211]
    ds_read_b64_tr_b16 a[170:171], v25 offset:53248
    v_accvgpr_write_b32 a106, 0
    v_mfma_f32_16x16x32_bf16 v[212:215], a[176:179], a[116:119], v[212:215]
    ds_read_b64_tr_b16 a[172:173], v25 offset:57344
    v_accvgpr_write_b32 a107, 0
    v_mfma_f32_16x16x32_bf16 v[212:215], a[180:183], a[124:127], v[212:215]
    s_waitcnt lgkmcnt(9)
    ds_read_b64_tr_b16 a[174:175], v25 offset:61440
    v_accvgpr_write_b32 a108, 0
    v_mfma_f32_16x16x32_bf16 v[216:219], a[184:187], a[112:115], v[216:219]
    s_waitcnt lgkmcnt(8)
    ds_read_b64_tr_b16 a[176:177], v26 offset:49152
    v_accvgpr_write_b32 a109, 0
    v_mfma_f32_16x16x32_bf16 v[216:219], a[188:191], a[120:123], v[216:219]
    ds_read_b64_tr_b16 a[178:179], v26 offset:53248
    v_accvgpr_write_b32 a110, 0
    v_mfma_f32_16x16x32_bf16 v[220:223], a[184:187], a[116:119], v[220:223]
    ds_read_b64_tr_b16 a[180:181], v26 offset:57344
    v_accvgpr_write_b32 a111, 0
    v_mfma_f32_16x16x32_bf16 v[220:223], a[188:191], a[124:127], v[220:223]
    s_waitcnt lgkmcnt(9)
    ds_read_b64_tr_b16 a[182:183], v26 offset:61440
    v_accvgpr_write_b32 a192, 0
    v_mfma_f32_16x16x32_bf16 v[224:227], a[160:163], a[112:115], v[224:227]
    s_waitcnt lgkmcnt(8)
    ds_read_b64_tr_b16 a[184:185], v27 offset:49152
    v_accvgpr_write_b32 a193, 0
    v_mfma_f32_16x16x32_bf16 v[224:227], a[164:167], a[120:123], v[224:227]
    ds_read_b64_tr_b16 a[186:187], v27 offset:53248
    v_accvgpr_write_b32 a194, 0
    v_mfma_f32_16x16x32_bf16 v[228:231], a[160:163], a[116:119], v[228:231]
    ds_read_b64_tr_b16 a[188:189], v27 offset:57344
    v_accvgpr_write_b32 a195, 0
    v_mfma_f32_16x16x32_bf16 v[228:231], a[164:167], a[124:127], v[228:231]
    s_waitcnt lgkmcnt(9)
    ds_read_b64_tr_b16 a[190:191], v27 offset:61440
    v_accvgpr_write_b32 a196, 0
    s_waitcnt vmcnt(14)
    s_barrier
    v_mfma_f32_16x16x32_bf16 v[232:235], a[168:171], a[112:115], v[232:235]
    s_waitcnt lgkmcnt(8)
    ds_read_b64_tr_b16 a[160:161], v28 offset:0
    v_accvgpr_write_b32 a197, 0
    v_mfma_f32_16x16x32_bf16 v[232:235], a[172:175], a[120:123], v[232:235]
    ds_read_b64_tr_b16 a[162:163], v28 offset:4096
    v_accvgpr_write_b32 a198, 0
    v_mfma_f32_16x16x32_bf16 v[236:239], a[168:171], a[116:119], v[236:239]
    s_add_u32 m0, s42, 32768
    ds_read_b64_tr_b16 a[164:165], v28 offset:8192
    v_accvgpr_write_b32 a199, 0
    v_mfma_f32_16x16x32_bf16 v[236:239], a[172:175], a[124:127], v[236:239]
    s_waitcnt lgkmcnt(9)
    buffer_load_dwordx4 v36, s[8:11], s40 offen lds
    v_mfma_f32_16x16x32_bf16 v[240:243], a[176:179], a[112:115], v[240:243]
    s_waitcnt lgkmcnt(7)
    ds_read_b64_tr_b16 a[166:167], v28 offset:12288
    ds_read_b64_tr_b16 a[168:169], v29 offset:0
    v_mfma_f32_16x16x32_bf16 v[240:243], a[180:183], a[120:123], v[240:243]
    ds_read_b64_tr_b16 a[170:171], v29 offset:4096
    v_accvgpr_write_b32 a200, 0
    v_mfma_f32_16x16x32_bf16 v[244:247], a[176:179], a[116:119], v[244:247]
    ds_read_b64_tr_b16 a[172:173], v29 offset:8192
    v_accvgpr_write_b32 a201, 0
    v_mfma_f32_16x16x32_bf16 v[244:247], a[180:183], a[124:127], v[244:247]
    s_waitcnt lgkmcnt(9)
    buffer_load_dwordx4 v37, s[8:11], s40 offen offset:1024 lds
    v_mfma_f32_16x16x32_bf16 v[248:251], a[184:187], a[112:115], v[248:251]
    s_waitcnt lgkmcnt(7)
    ds_read_b64_tr_b16 a[174:175], v29 offset:12288
    ds_read_b64_tr_b16 a[176:177], v30 offset:0
    v_mfma_f32_16x16x32_bf16 v[248:251], a[188:191], a[120:123], v[248:251]
    ds_read_b64_tr_b16 a[178:179], v30 offset:4096
    v_accvgpr_write_b32 a202, 0
    v_mfma_f32_16x16x32_bf16 v[252:255], a[184:187], a[116:119], v[252:255]
    ds_read_b64_tr_b16 a[180:181], v30 offset:8192
    v_accvgpr_write_b32 a203, 0
    v_mfma_f32_16x16x32_bf16 v[252:255], a[188:191], a[124:127], v[252:255]
    s_waitcnt vmcnt(15)
    s_waitcnt lgkmcnt(9)
    buffer_load_dwordx4 v38, s[8:11], s40 offen offset:2048 lds
    v_mfma_f32_16x16x32_bf16 v[128:131], a[160:163], a[128:131], v[128:131]
    s_waitcnt vmcnt(15)
    s_waitcnt lgkmcnt(7)
    ds_read_b64_tr_b16 a[182:183], v30 offset:12288
    ds_read_b64_tr_b16 a[184:185], v31 offset:0
    v_mfma_f32_16x16x32_bf16 v[128:131], a[164:167], a[136:139], v[128:131]
    s_waitcnt vmcnt(14)
    ds_read_b64_tr_b16 a[186:187], v31 offset:4096
    v_accvgpr_write_b32 a204, 0
    v_mfma_f32_16x16x32_bf16 v[132:135], a[160:163], a[132:135], v[132:135]
    s_waitcnt vmcnt(13)
    ds_read_b64_tr_b16 a[188:189], v31 offset:8192
    v_accvgpr_write_b32 a205, 0
    v_mfma_f32_16x16x32_bf16 v[132:135], a[164:167], a[140:143], v[132:135]
    s_waitcnt lgkmcnt(9)
    buffer_load_dwordx4 v39, s[8:11], s40 offen offset:3072 lds
    v_mfma_f32_16x16x32_bf16 v[136:139], a[168:171], a[128:131], v[136:139]
    s_waitcnt lgkmcnt(7)
    s_add_u32 s40, s40, 16384
    ds_read_b64_tr_b16 a[190:191], v31 offset:12288
    ds_read_b64_tr_b16 a[160:161], v32 offset:0
    v_mfma_f32_16x16x32_bf16 v[136:139], a[172:175], a[136:139], v[136:139]
    ds_read_b64_tr_b16 a[162:163], v32 offset:4096
    v_accvgpr_write_b32 a206, 0
    v_mfma_f32_16x16x32_bf16 v[140:143], a[168:171], a[132:135], v[140:143]
    s_add_u32 m0, s42, 65536
    ds_read_b64_tr_b16 a[164:165], v32 offset:8192
    v_accvgpr_write_b32 a207, 0
    v_mfma_f32_16x16x32_bf16 v[140:143], a[172:175], a[140:143], v[140:143]
    s_waitcnt lgkmcnt(9)
    buffer_load_dwordx4 v40, s[12:15], s41 offen lds
    v_mfma_f32_16x16x32_bf16 v[144:147], a[176:179], a[128:131], v[144:147]
    s_waitcnt lgkmcnt(7)
    ds_read_b64_tr_b16 a[166:167], v32 offset:12288
    ds_read_b64_tr_b16 a[168:169], v33 offset:0
    v_mfma_f32_16x16x32_bf16 v[144:147], a[180:183], a[136:139], v[144:147]
    ds_read_b64_tr_b16 a[170:171], v33 offset:4096
    v_accvgpr_write_b32 a112, 0
    v_mfma_f32_16x16x32_bf16 v[148:151], a[176:179], a[132:135], v[148:151]
    ds_read_b64_tr_b16 a[172:173], v33 offset:8192
    v_accvgpr_write_b32 a113, 0
    v_mfma_f32_16x16x32_bf16 v[148:151], a[180:183], a[140:143], v[148:151]
    s_waitcnt lgkmcnt(9)
    buffer_load_dwordx4 v41, s[12:15], s41 offen offset:1024 lds
    v_mfma_f32_16x16x32_bf16 v[152:155], a[184:187], a[128:131], v[152:155]
    s_waitcnt lgkmcnt(7)
    ds_read_b64_tr_b16 a[174:175], v33 offset:12288
    ds_read_b64_tr_b16 a[176:177], v34 offset:0
    v_mfma_f32_16x16x32_bf16 v[152:155], a[188:191], a[136:139], v[152:155]
    ds_read_b64_tr_b16 a[178:179], v34 offset:4096
    v_accvgpr_write_b32 a114, 0
    v_mfma_f32_16x16x32_bf16 v[156:159], a[184:187], a[132:135], v[156:159]
    ds_read_b64_tr_b16 a[180:181], v34 offset:8192
    v_accvgpr_write_b32 a115, 0
    v_mfma_f32_16x16x32_bf16 v[156:159], a[188:191], a[140:143], v[156:159]
    s_waitcnt lgkmcnt(9)
    buffer_load_dwordx4 v40, s[12:15], s41 offen offset:2048 lds
    v_mfma_f32_16x16x32_bf16 v[160:163], a[160:163], a[128:131], v[160:163]
    s_waitcnt lgkmcnt(7)
    ds_read_b64_tr_b16 a[182:183], v34 offset:12288
    ds_read_b64_tr_b16 a[184:185], v35 offset:0
    v_mfma_f32_16x16x32_bf16 v[160:163], a[164:167], a[136:139], v[160:163]
    ds_read_b64_tr_b16 a[186:187], v35 offset:4096
    v_accvgpr_write_b32 a116, 0
    v_mfma_f32_16x16x32_bf16 v[164:167], a[160:163], a[132:135], v[164:167]
    ds_read_b64_tr_b16 a[188:189], v35 offset:8192
    v_accvgpr_write_b32 a117, 0
    v_mfma_f32_16x16x32_bf16 v[164:167], a[164:167], a[140:143], v[164:167]
    s_waitcnt lgkmcnt(9)
    buffer_load_dwordx4 v41, s[12:15], s41 offen offset:3072 lds
    v_mfma_f32_16x16x32_bf16 v[168:171], a[168:171], a[128:131], v[168:171]
    s_waitcnt lgkmcnt(7)
    s_add_u32 s41, s41, 16384
    ds_read_b64_tr_b16 a[190:191], v35 offset:12288
    ds_read_b64_tr_b16 a[160:161], v28 offset:16384
    v_mfma_f32_16x16x32_bf16 v[168:171], a[172:175], a[136:139], v[168:171]
    ds_read_b64_tr_b16 a[162:163], v28 offset:20480
    v_accvgpr_write_b32 a118, 0
    v_mfma_f32_16x16x32_bf16 v[172:175], a[168:171], a[132:135], v[172:175]
    s_add_u32 m0, s42, 81920
    ds_read_b64_tr_b16 a[164:165], v28 offset:24576
    v_accvgpr_write_b32 a119, 0
    v_mfma_f32_16x16x32_bf16 v[172:175], a[172:175], a[140:143], v[172:175]
    s_waitcnt lgkmcnt(9)
    buffer_load_dwordx4 v40, s[12:15], s41 offen lds
    v_mfma_f32_16x16x32_bf16 v[176:179], a[176:179], a[128:131], v[176:179]
    s_waitcnt lgkmcnt(7)
    ds_read_b64_tr_b16 a[166:167], v28 offset:28672
    ds_read_b64_tr_b16 a[168:169], v29 offset:16384
    v_mfma_f32_16x16x32_bf16 v[176:179], a[180:183], a[136:139], v[176:179]
    ds_read_b64_tr_b16 a[170:171], v29 offset:20480
    v_accvgpr_write_b32 a120, 0
    v_mfma_f32_16x16x32_bf16 v[180:183], a[176:179], a[132:135], v[180:183]
    ds_read_b64_tr_b16 a[172:173], v29 offset:24576
    v_accvgpr_write_b32 a121, 0
    v_mfma_f32_16x16x32_bf16 v[180:183], a[180:183], a[140:143], v[180:183]
    s_waitcnt lgkmcnt(9)
    buffer_load_dwordx4 v41, s[12:15], s41 offen offset:1024 lds
    v_mfma_f32_16x16x32_bf16 v[184:187], a[184:187], a[128:131], v[184:187]
    s_waitcnt lgkmcnt(7)
    ds_read_b64_tr_b16 a[174:175], v29 offset:28672
    ds_read_b64_tr_b16 a[176:177], v30 offset:16384
    v_mfma_f32_16x16x32_bf16 v[184:187], a[188:191], a[136:139], v[184:187]
    ds_read_b64_tr_b16 a[178:179], v30 offset:20480
    v_accvgpr_write_b32 a122, 0
    v_mfma_f32_16x16x32_bf16 v[188:191], a[184:187], a[132:135], v[188:191]
    ds_read_b64_tr_b16 a[180:181], v30 offset:24576
    v_accvgpr_write_b32 a123, 0
    v_mfma_f32_16x16x32_bf16 v[188:191], a[188:191], a[140:143], v[188:191]
    s_waitcnt lgkmcnt(9)
    buffer_load_dwordx4 v40, s[12:15], s41 offen offset:2048 lds
    v_mfma_f32_16x16x32_bf16 v[192:195], a[160:163], a[128:131], v[192:195]
    s_waitcnt lgkmcnt(7)
    ds_read_b64_tr_b16 a[182:183], v30 offset:28672
    ds_read_b64_tr_b16 a[184:185], v31 offset:16384
    v_mfma_f32_16x16x32_bf16 v[192:195], a[164:167], a[136:139], v[192:195]
    ds_read_b64_tr_b16 a[186:187], v31 offset:20480
    v_accvgpr_write_b32 a124, 0
    v_mfma_f32_16x16x32_bf16 v[196:199], a[160:163], a[132:135], v[196:199]
    ds_read_b64_tr_b16 a[188:189], v31 offset:24576
    v_accvgpr_write_b32 a125, 0
    v_mfma_f32_16x16x32_bf16 v[196:199], a[164:167], a[140:143], v[196:199]
    s_waitcnt lgkmcnt(9)
    buffer_load_dwordx4 v41, s[12:15], s41 offen offset:3072 lds
    v_mfma_f32_16x16x32_bf16 v[200:203], a[168:171], a[128:131], v[200:203]
    s_waitcnt lgkmcnt(7)
    s_add_u32 s41, s41, 16384
    ds_read_b64_tr_b16 a[190:191], v31 offset:28672
    ds_read_b64_tr_b16 a[160:161], v32 offset:16384
    v_mfma_f32_16x16x32_bf16 v[200:203], a[172:175], a[136:139], v[200:203]
    ds_read_b64_tr_b16 a[162:163], v32 offset:20480
    v_accvgpr_write_b32 a126, 0
    v_mfma_f32_16x16x32_bf16 v[204:207], a[168:171], a[132:135], v[204:207]
    ds_read_b64_tr_b16 a[164:165], v32 offset:24576
    v_accvgpr_write_b32 a127, 0
    v_mfma_f32_16x16x32_bf16 v[204:207], a[172:175], a[140:143], v[204:207]
    s_waitcnt lgkmcnt(9)
    ds_read_b64_tr_b16 a[166:167], v32 offset:28672
    v_mfma_f32_16x16x32_bf16 v[208:211], a[176:179], a[128:131], v[208:211]
    s_waitcnt lgkmcnt(8)
    ds_read_b64_tr_b16 a[168:169], v33 offset:16384
    v_mfma_f32_16x16x32_bf16 v[208:211], a[180:183], a[136:139], v[208:211]
    ds_read_b64_tr_b16 a[170:171], v33 offset:20480
    v_mfma_f32_16x16x32_bf16 v[212:215], a[176:179], a[132:135], v[212:215]
    ds_read_b64_tr_b16 a[172:173], v33 offset:24576
    v_mfma_f32_16x16x32_bf16 v[212:215], a[180:183], a[140:143], v[212:215]
    s_waitcnt lgkmcnt(9)
    ds_read_b64_tr_b16 a[174:175], v33 offset:28672
    v_mfma_f32_16x16x32_bf16 v[216:219], a[184:187], a[128:131], v[216:219]
    s_waitcnt lgkmcnt(8)
    ds_read_b64_tr_b16 a[176:177], v34 offset:16384
    v_mfma_f32_16x16x32_bf16 v[216:219], a[188:191], a[136:139], v[216:219]
    ds_read_b64_tr_b16 a[178:179], v34 offset:20480
    v_mfma_f32_16x16x32_bf16 v[220:223], a[184:187], a[132:135], v[220:223]
    ds_read_b64_tr_b16 a[180:181], v34 offset:24576
    v_mfma_f32_16x16x32_bf16 v[220:223], a[188:191], a[140:143], v[220:223]
    s_waitcnt lgkmcnt(9)
    ds_read_b64_tr_b16 a[182:183], v34 offset:28672
    v_mfma_f32_16x16x32_bf16 v[224:227], a[160:163], a[128:131], v[224:227]
    s_waitcnt lgkmcnt(8)
    ds_read_b64_tr_b16 a[184:185], v35 offset:16384
    v_mfma_f32_16x16x32_bf16 v[224:227], a[164:167], a[136:139], v[224:227]
    ds_read_b64_tr_b16 a[186:187], v35 offset:20480
    v_mfma_f32_16x16x32_bf16 v[228:231], a[160:163], a[132:135], v[228:231]
    ds_read_b64_tr_b16 a[188:189], v35 offset:24576
    v_mfma_f32_16x16x32_bf16 v[228:231], a[164:167], a[140:143], v[228:231]
    s_waitcnt lgkmcnt(9)
    ds_read_b64_tr_b16 a[190:191], v35 offset:28672
    v_mfma_f32_16x16x32_bf16 v[232:235], a[168:171], a[128:131], v[232:235]
    s_waitcnt lgkmcnt(8)
    v_mfma_f32_16x16x32_bf16 v[232:235], a[172:175], a[136:139], v[232:235]
    v_mfma_f32_16x16x32_bf16 v[236:239], a[168:171], a[132:135], v[236:239]
    v_mfma_f32_16x16x32_bf16 v[236:239], a[172:175], a[140:143], v[236:239]
    s_waitcnt lgkmcnt(6)
    s_waitcnt vmcnt(18)
    s_barrier
    v_mfma_f32_16x16x32_bf16 v[240:243], a[176:179], a[128:131], v[240:243]
    s_waitcnt lgkmcnt(4)
    ds_read_b128 a[208:211], v8 offset:0
    v_mfma_f32_16x16x32_bf16 v[240:243], a[180:183], a[136:139], v[240:243]
    ds_read_b128 a[212:215], v9 offset:0
    v_mfma_f32_16x16x32_bf16 v[244:247], a[176:179], a[132:135], v[244:247]
    ds_read_b128 a[216:219], v10 offset:0
    v_mfma_f32_16x16x32_bf16 v[244:247], a[180:183], a[140:143], v[244:247]
    s_waitcnt lgkmcnt(5)
    ds_read_b128 a[220:223], v11 offset:0
    v_mfma_f32_16x16x32_bf16 v[248:251], a[184:187], a[128:131], v[248:251]
    s_waitcnt lgkmcnt(4)
    ds_read_b128 a[224:227], v8 offset:4096
    v_mfma_f32_16x16x32_bf16 v[248:251], a[188:191], a[136:139], v[248:251]
    v_mfma_f32_16x16x32_bf16 v[252:255], a[184:187], a[132:135], v[252:255]
    s_load_dwordx2 s[16:17], s[0:1], 88
    v_mfma_f32_16x16x32_bf16 v[252:255], a[188:191], a[140:143], v[252:255]
    s_mov_b32 s36, 1040356334
    s_mov_b32 s37, 1040356334
    v_pk_mul_f32 v[128:129], v[128:129], s[36:37]
    v_pk_mul_f32 v[130:131], v[130:131], s[36:37]
    v_pk_mul_f32 v[136:137], v[136:137], s[36:37]
    v_pk_mul_f32 v[138:139], v[138:139], s[36:37]
    v_cvt_pk_bf16_f32 v64, v128, v129
    v_cvt_pk_bf16_f32 v65, v130, v131
    v_cvt_pk_bf16_f32 v66, v136, v137
    v_cvt_pk_bf16_f32 v67, v138, v139
    v_pk_mul_f32 v[132:133], v[132:133], s[36:37]
    v_pk_mul_f32 v[134:135], v[134:135], s[36:37]
    v_pk_mul_f32 v[140:141], v[140:141], s[36:37]
    v_pk_mul_f32 v[142:143], v[142:143], s[36:37]
    v_cvt_pk_bf16_f32 v80, v132, v133
    v_cvt_pk_bf16_f32 v81, v134, v135
    v_cvt_pk_bf16_f32 v82, v140, v141
    v_cvt_pk_bf16_f32 v83, v142, v143
    v_permlane32_swap_b32 v64, v66
    v_permlane32_swap_b32 v65, v67
    v_permlane32_swap_b32 v80, v82
    v_permlane32_swap_b32 v81, v83
    v_permlane16_swap_b32 v64, v66
    v_permlane16_swap_b32 v65, v67
    v_permlane16_swap_b32 v80, v82
    v_permlane16_swap_b32 v81, v83
    v_pk_mul_f32 v[144:145], v[144:145], s[36:37]
    v_pk_mul_f32 v[146:147], v[146:147], s[36:37]
    v_pk_mul_f32 v[152:153], v[152:153], s[36:37]
    v_pk_mul_f32 v[154:155], v[154:155], s[36:37]
    v_cvt_pk_bf16_f32 v68, v144, v145
    v_cvt_pk_bf16_f32 v69, v146, v147
    v_cvt_pk_bf16_f32 v70, v152, v153
    v_cvt_pk_bf16_f32 v71, v154, v155
    v_pk_mul_f32 v[148:149], v[148:149], s[36:37]
    v_pk_mul_f32 v[150:151], v[150:151], s[36:37]
    v_pk_mul_f32 v[156:157], v[156:157], s[36:37]
    v_pk_mul_f32 v[158:159], v[158:159], s[36:37]
    v_cvt_pk_bf16_f32 v84, v148, v149
    v_cvt_pk_bf16_f32 v85, v150, v151
    v_cvt_pk_bf16_f32 v86, v156, v157
    v_cvt_pk_bf16_f32 v87, v158, v159
    v_permlane32_swap_b32 v68, v70
    v_permlane32_swap_b32 v69, v71
    v_permlane32_swap_b32 v84, v86
    v_permlane32_swap_b32 v85, v87
    v_permlane16_swap_b32 v68, v70
    v_permlane16_swap_b32 v69, v71
    v_permlane16_swap_b32 v84, v86
    v_permlane16_swap_b32 v85, v87
    v_pk_mul_f32 v[160:161], v[160:161], s[36:37]
    v_pk_mul_f32 v[162:163], v[162:163], s[36:37]
    v_pk_mul_f32 v[168:169], v[168:169], s[36:37]
    v_pk_mul_f32 v[170:171], v[170:171], s[36:37]
    v_cvt_pk_bf16_f32 v72, v160, v161
    v_cvt_pk_bf16_f32 v73, v162, v163
    v_cvt_pk_bf16_f32 v74, v168, v169
    v_cvt_pk_bf16_f32 v75, v170, v171
    v_pk_mul_f32 v[164:165], v[164:165], s[36:37]
    v_pk_mul_f32 v[166:167], v[166:167], s[36:37]
    v_pk_mul_f32 v[172:173], v[172:173], s[36:37]
    v_pk_mul_f32 v[174:175], v[174:175], s[36:37]
    v_cvt_pk_bf16_f32 v88, v164, v165
    v_cvt_pk_bf16_f32 v89, v166, v167
    v_cvt_pk_bf16_f32 v90, v172, v173
    v_cvt_pk_bf16_f32 v91, v174, v175
    v_permlane32_swap_b32 v72, v74
    v_permlane32_swap_b32 v73, v75
    v_permlane32_swap_b32 v88, v90
    v_permlane32_swap_b32 v89, v91
    v_permlane16_swap_b32 v72, v74
    v_permlane16_swap_b32 v73, v75
    v_permlane16_swap_b32 v88, v90
    v_permlane16_swap_b32 v89, v91
    v_pk_mul_f32 v[176:177], v[176:177], s[36:37]
    v_pk_mul_f32 v[178:179], v[178:179], s[36:37]
    v_pk_mul_f32 v[184:185], v[184:185], s[36:37]
    v_pk_mul_f32 v[186:187], v[186:187], s[36:37]
    v_cvt_pk_bf16_f32 v76, v176, v177
    v_cvt_pk_bf16_f32 v77, v178, v179
    v_cvt_pk_bf16_f32 v78, v184, v185
    v_cvt_pk_bf16_f32 v79, v186, v187
    v_pk_mul_f32 v[180:181], v[180:181], s[36:37]
    v_pk_mul_f32 v[182:183], v[182:183], s[36:37]
    v_pk_mul_f32 v[188:189], v[188:189], s[36:37]
    v_pk_mul_f32 v[190:191], v[190:191], s[36:37]
    v_cvt_pk_bf16_f32 v92, v180, v181
    v_cvt_pk_bf16_f32 v93, v182, v183
    v_cvt_pk_bf16_f32 v94, v188, v189
    v_cvt_pk_bf16_f32 v95, v190, v191
    v_permlane32_swap_b32 v76, v78
    v_permlane32_swap_b32 v77, v79
    v_permlane32_swap_b32 v92, v94
    v_permlane32_swap_b32 v93, v95
    v_permlane16_swap_b32 v76, v78
    v_permlane16_swap_b32 v77, v79
    v_permlane16_swap_b32 v92, v94
    v_permlane16_swap_b32 v93, v95
    v_pk_mul_f32 v[192:193], v[192:193], s[36:37]
    v_pk_mul_f32 v[194:195], v[194:195], s[36:37]
    v_pk_mul_f32 v[200:201], v[200:201], s[36:37]
    v_pk_mul_f32 v[202:203], v[202:203], s[36:37]
    v_cvt_pk_bf16_f32 v96, v192, v193
    v_cvt_pk_bf16_f32 v97, v194, v195
    v_cvt_pk_bf16_f32 v98, v200, v201
    v_cvt_pk_bf16_f32 v99, v202, v203
    v_pk_mul_f32 v[196:197], v[196:197], s[36:37]
    v_pk_mul_f32 v[198:199], v[198:199], s[36:37]
    v_pk_mul_f32 v[204:205], v[204:205], s[36:37]
    v_pk_mul_f32 v[206:207], v[206:207], s[36:37]
    v_cvt_pk_bf16_f32 v112, v196, v197
    v_cvt_pk_bf16_f32 v113, v198, v199
    v_cvt_pk_bf16_f32 v114, v204, v205
    v_cvt_pk_bf16_f32 v115, v206, v207
    v_permlane32_swap_b32 v96, v98
    v_permlane32_swap_b32 v97, v99
    v_permlane32_swap_b32 v112, v114
    v_permlane32_swap_b32 v113, v115
    v_permlane16_swap_b32 v96, v98
    v_permlane16_swap_b32 v97, v99
    v_permlane16_swap_b32 v112, v114
    v_permlane16_swap_b32 v113, v115
    v_pk_mul_f32 v[208:209], v[208:209], s[36:37]
    v_pk_mul_f32 v[210:211], v[210:211], s[36:37]
    v_pk_mul_f32 v[216:217], v[216:217], s[36:37]
    v_pk_mul_f32 v[218:219], v[218:219], s[36:37]
    v_cvt_pk_bf16_f32 v100, v208, v209
    v_cvt_pk_bf16_f32 v101, v210, v211
    v_cvt_pk_bf16_f32 v102, v216, v217
    v_cvt_pk_bf16_f32 v103, v218, v219
    v_pk_mul_f32 v[212:213], v[212:213], s[36:37]
    v_pk_mul_f32 v[214:215], v[214:215], s[36:37]
    v_pk_mul_f32 v[220:221], v[220:221], s[36:37]
    v_pk_mul_f32 v[222:223], v[222:223], s[36:37]
    v_cvt_pk_bf16_f32 v116, v212, v213
    v_cvt_pk_bf16_f32 v117, v214, v215
    v_cvt_pk_bf16_f32 v118, v220, v221
    v_cvt_pk_bf16_f32 v119, v222, v223
    v_permlane32_swap_b32 v100, v102
    v_permlane32_swap_b32 v101, v103
    v_permlane32_swap_b32 v116, v118
    v_permlane32_swap_b32 v117, v119
    v_permlane16_swap_b32 v100, v102
    v_permlane16_swap_b32 v101, v103
    v_permlane16_swap_b32 v116, v118
    v_permlane16_swap_b32 v117, v119
    v_pk_mul_f32 v[224:225], v[224:225], s[36:37]
    v_pk_mul_f32 v[226:227], v[226:227], s[36:37]
    v_pk_mul_f32 v[232:233], v[232:233], s[36:37]
    v_pk_mul_f32 v[234:235], v[234:235], s[36:37]
    v_cvt_pk_bf16_f32 v104, v224, v225
    v_cvt_pk_bf16_f32 v105, v226, v227
    v_cvt_pk_bf16_f32 v106, v232, v233
    v_cvt_pk_bf16_f32 v107, v234, v235
    v_pk_mul_f32 v[228:229], v[228:229], s[36:37]
    v_pk_mul_f32 v[230:231], v[230:231], s[36:37]
    v_pk_mul_f32 v[236:237], v[236:237], s[36:37]
    v_pk_mul_f32 v[238:239], v[238:239], s[36:37]
    v_cvt_pk_bf16_f32 v120, v228, v229
    v_cvt_pk_bf16_f32 v121, v230, v231
    v_cvt_pk_bf16_f32 v122, v236, v237
    v_cvt_pk_bf16_f32 v123, v238, v239
    v_permlane32_swap_b32 v104, v106
    v_permlane32_swap_b32 v105, v107
    v_permlane32_swap_b32 v120, v122
    v_permlane32_swap_b32 v121, v123
    v_permlane16_swap_b32 v104, v106
    v_permlane16_swap_b32 v105, v107
    v_permlane16_swap_b32 v120, v122
    v_permlane16_swap_b32 v121, v123
    v_pk_mul_f32 v[240:241], v[240:241], s[36:37]
    v_pk_mul_f32 v[242:243], v[242:243], s[36:37]
    v_pk_mul_f32 v[248:249], v[248:249], s[36:37]
    v_pk_mul_f32 v[250:251], v[250:251], s[36:37]
    v_cvt_pk_bf16_f32 v108, v240, v241
    v_cvt_pk_bf16_f32 v109, v242, v243
    v_cvt_pk_bf16_f32 v110, v248, v249
    v_cvt_pk_bf16_f32 v111, v250, v251
    v_pk_mul_f32 v[244:245], v[244:245], s[36:37]
    v_pk_mul_f32 v[246:247], v[246:247], s[36:37]
    v_pk_mul_f32 v[252:253], v[252:253], s[36:37]
    v_pk_mul_f32 v[254:255], v[254:255], s[36:37]
    v_cvt_pk_bf16_f32 v124, v244, v245
    v_cvt_pk_bf16_f32 v125, v246, v247
    v_cvt_pk_bf16_f32 v126, v252, v253
    v_cvt_pk_bf16_f32 v127, v254, v255
    v_permlane32_swap_b32 v108, v110
    v_permlane32_swap_b32 v109, v111
    v_permlane32_swap_b32 v124, v126
    v_permlane32_swap_b32 v125, v127
    v_permlane16_swap_b32 v108, v110
    v_permlane16_swap_b32 v109, v111
    v_permlane16_swap_b32 v124, v126
    v_permlane16_swap_b32 v125, v127
    s_waitcnt lgkmcnt(0)
    v_mfma_f32_16x16x32_bf16 v[216:219], a[208:211], v[64:67], 0
    v_mfma_f32_16x16x32_bf16 v[216:219], a[212:215], v[68:71], v[216:219]
    v_mfma_f32_16x16x32_bf16 v[216:219], a[216:219], v[72:75], v[216:219]
    v_mfma_f32_16x16x32_bf16 v[216:219], a[220:223], v[76:79], v[216:219]
    v_mfma_f32_16x16x32_bf16 v[220:223], a[208:211], v[80:83], 0
    v_mfma_f32_16x16x32_bf16 v[220:223], a[212:215], v[84:87], v[220:223]
    v_mfma_f32_16x16x32_bf16 v[220:223], a[216:219], v[88:91], v[220:223]
    v_mfma_f32_16x16x32_bf16 v[220:223], a[220:223], v[92:95], v[220:223]
    v_mfma_f32_16x16x32_bf16 v[224:227], a[208:211], v[96:99], 0
    v_mfma_f32_16x16x32_bf16 v[224:227], a[212:215], v[100:103], v[224:227]
    v_mfma_f32_16x16x32_bf16 v[224:227], a[216:219], v[104:107], v[224:227]
    v_mfma_f32_16x16x32_bf16 v[224:227], a[220:223], v[108:111], v[224:227]
    v_mfma_f32_16x16x32_bf16 v[228:231], a[208:211], v[112:115], 0
    v_mfma_f32_16x16x32_bf16 v[228:231], a[212:215], v[116:119], v[228:231]
    v_mfma_f32_16x16x32_bf16 v[228:231], a[216:219], v[120:123], v[228:231]
    v_mfma_f32_16x16x32_bf16 v[228:231], a[220:223], v[124:127], v[228:231]
    v_max3_f32 v232, v216, v217, v218
    v_max_f32 v232, v232, v219
    v_max3_f32 v233, v220, v221, v222
    v_max_f32 v233, v233, v223
    v_max3_f32 v234, v224, v225, v226
    v_max_f32 v234, v234, v227
    s_nop 1
    v_max3_f32 v235, v228, v229, v230
    v_max_f32 v235, v235, v231
    v_mov_b32 v236, v232
    v_mov_b32 v237, v233
    v_mov_b32 v238, v234
    v_mov_b32 v239, v235
    v_permlane16_swap_b32 v232, v236
    v_permlane16_swap_b32 v233, v237
    v_permlane16_swap_b32 v234, v238
    v_permlane16_swap_b32 v235, v239
    v_max_f32 v232, v232, v236
    v_max_f32 v233, v233, v237
    v_max_f32 v234, v234, v238
    v_max_f32 v235, v235, v239
    v_mov_b32 v236, v232
    v_mov_b32 v237, v233
    v_mov_b32 v238, v234
    v_mov_b32 v239, v235
    v_permlane32_swap_b32 v232, v236
    v_permlane32_swap_b32 v233, v237
    v_permlane32_swap_b32 v234, v238
    v_permlane32_swap_b32 v235, v239
    v_max_f32 v232, v232, v236
    v_max_f32 v233, v233, v237
    v_max_f32 v234, v234, v238
    v_max_f32 v235, v235, v239
    v_sub_f32 v192, 3250585600, v232
    v_sub_f32 v193, 3250585600, v232
    v_sub_f32 v194, 3250585600, v232
    v_sub_f32 v195, 3250585600, v232
    v_sub_f32 v196, 3250585600, v233
    v_sub_f32 v197, 3250585600, v233
    v_sub_f32 v198, 3250585600, v233
    v_sub_f32 v199, 3250585600, v233
    v_sub_f32 v200, 3250585600, v234
    v_sub_f32 v201, 3250585600, v234
    v_sub_f32 v202, 3250585600, v234
    v_sub_f32 v203, 3250585600, v234
    v_sub_f32 v204, 3250585600, v235
    v_sub_f32 v205, 3250585600, v235
    v_sub_f32 v206, 3250585600, v235
    v_sub_f32 v207, 3250585600, v235
Lattn_stage0:
    s_mov_b32 s43, 7
    v_mfma_f32_16x16x32_bf16 v[208:211], a[208:211], v[64:67], v[192:195]
    s_lshl_b32 s53, s5, 4
    v_mfma_f32_16x16x32_bf16 v[208:211], a[212:215], v[68:71], v[208:211]
    s_add_u32 s53, s53, s4
    v_mfma_f32_16x16x32_bf16 v[208:211], a[216:219], v[72:75], v[208:211]
    s_lshl_b32 s53, s53, 2
    v_mfma_f32_16x16x32_bf16 v[208:211], a[220:223], v[76:79], v[208:211]
    s_add_u32 s53, s53, s3
    ds_read_b128 a[228:231], v9 offset:4096
    v_mfma_f32_16x16x32_bf16 v[212:215], a[208:211], v[80:83], v[196:199]
    s_mul_i32 s53, s53, 4608
    s_nop 3
    v_exp_f32 v208, v208
    v_mfma_f32_16x16x32_bf16 v[212:215], a[212:215], v[84:87], v[212:215]
    s_add_u32 s53, s53, 2621440
    v_exp_f32 v209, v209
    v_mfma_f32_16x16x32_bf16 v[212:215], a[216:219], v[88:91], v[212:215]
    s_lshr_b32 s44, s2, 5
    v_exp_f32 v210, v210
    v_mfma_f32_16x16x32_bf16 v[212:215], a[220:223], v[92:95], v[212:215]
    s_lshl_b32 s44, s44, 3
    v_exp_f32 v211, v211
    v_cvt_pk_bf16_f32 v128, v208, v209
    ds_read_b128 a[232:235], v10 offset:4096
    v_cvt_pk_bf16_f32 v129, v210, v211
    v_mfma_f32_16x16x32_bf16 v[208:211], a[208:211], v[96:99], v[200:203]
    s_and_b32 s37, s2, 7
    s_nop 0
    v_exp_f32 v212, v212
    v_mfma_f32_16x16x32_bf16 v[208:211], a[212:215], v[100:103], v[208:211]
    s_add_u32 s44, s44, s37
    v_exp_f32 v213, v213
    v_mfma_f32_16x16x32_bf16 v[208:211], a[216:219], v[104:107], v[208:211]
    s_lshl_b32 s44, s44, 2
    v_exp_f32 v214, v214
    v_mfma_f32_16x16x32_bf16 v[208:211], a[220:223], v[108:111], v[208:211]
    s_bfe_u32 s37, s2, 0x20003
    v_exp_f32 v215, v215
    v_cvt_pk_bf16_f32 v136, v212, v213
Ltour3:
    s_cbranch_execz Ltour7
    ds_read_b128 a[236:239], v11 offset:4096
    v_cvt_pk_bf16_f32 v137, v214, v215
    v_mfma_f32_16x16x32_bf16 v[212:215], a[208:211], v[112:115], v[204:207]
    s_add_u32 s44, s44, s37
    s_nop 0
    v_exp_f32 v208, v208
    v_mfma_f32_16x16x32_bf16 v[212:215], a[212:215], v[116:119], v[212:215]
    s_add_u32 s44, s44, 72
    v_exp_f32 v209, v209
    v_mfma_f32_16x16x32_bf16 v[212:215], a[216:219], v[120:123], v[212:215]
    s_cmp_lt_u32 s44, 216
    s_cselect_b32 s37, 0, 2147483648
    v_exp_f32 v210, v210
    v_mfma_f32_16x16x32_bf16 v[212:215], a[220:223], v[124:127], v[212:215]
    s_lshl_b32 s44, s44, 5
    v_exp_f32 v211, v211
    v_cvt_pk_bf16_f32 v144, v208, v209
    ds_read_b128 a[208:211], v8 offset:8192
    v_cvt_pk_bf16_f32 v145, v210, v211
    v_mfma_f32_16x16x32_bf16 v[208:211], a[224:227], v[64:67], v[192:195]
    s_waitcnt lgkmcnt(3)
    s_or_b32 s44, s44, s37
    v_exp_f32 v212, v212
    v_mfma_f32_16x16x32_bf16 v[208:211], a[228:231], v[68:71], v[208:211]
    s_waitcnt lgkmcnt(2)
    s_mov_b32 s18, 3981312
    v_exp_f32 v213, v213
    v_mfma_f32_16x16x32_bf16 v[208:211], a[232:235], v[72:75], v[208:211]
    s_waitcnt lgkmcnt(1)
    s_lshr_b32 s6, s2, 3
    v_exp_f32 v214, v214
    v_mfma_f32_16x16x32_bf16 v[208:211], a[236:239], v[76:79], v[208:211]
    s_and_b32 s7, s2, 7
    v_exp_f32 v215, v215
    v_cvt_pk_bf16_f32 v152, v212, v213
    ds_read_b128 a[212:215], v9 offset:8192
    v_cvt_pk_bf16_f32 v153, v214, v215
    v_mfma_f32_16x16x32_bf16 v[212:215], a[224:227], v[80:83], v[196:199]
    s_mul_i32 s7, s7, 18
    s_nop 0
    v_exp_f32 v208, v208
    v_mfma_f32_16x16x32_bf16 v[212:215], a[228:231], v[84:87], v[212:215]
    s_add_u32 s7, s7, s6
    v_exp_f32 v209, v209
    v_mfma_f32_16x16x32_bf16 v[212:215], a[232:235], v[88:91], v[212:215]
    s_lshl_b32 s58, s7, 6
    v_exp_f32 v210, v210
    v_mfma_f32_16x16x32_bf16 v[212:215], a[236:239], v[92:95], v[212:215]
    s_mul_i32 s59, s7, 36864
    v_exp_f32 v211, v211
    v_cvt_pk_bf16_f32 v130, v208, v209
    ds_read_b128 a[216:219], v10 offset:8192
    v_cvt_pk_bf16_f32 v131, v210, v211
    v_mfma_f32_16x16x32_bf16 v[208:211], a[224:227], v[96:99], v[200:203]
    s_cmp_lt_u32 s6, 18
    s_cselect_b32 s7, 0, 2147483648
    v_exp_f32 v212, v212
    v_mfma_f32_16x16x32_bf16 v[208:211], a[228:231], v[100:103], v[208:211]
    s_or_b32 s58, s58, s7
    v_exp_f32 v213, v213
    v_mfma_f32_16x16x32_bf16 v[208:211], a[232:235], v[104:107], v[208:211]
    s_or_b32 s59, s59, s7
    v_exp_f32 v214, v214
    v_mfma_f32_16x16x32_bf16 v[208:211], a[236:239], v[108:111], v[208:211]
    s_and_b32 s7, s4, 1
    v_exp_f32 v215, v215
    v_cvt_pk_bf16_f32 v138, v212, v213
    ds_read_b128 a[220:223], v11 offset:8192
    v_cvt_pk_bf16_f32 v139, v214, v215
    s_mov_b32 s39, 221184
    s_mov_b32 s38, 27648
    v_mfma_f32_16x16x32_bf16 v[212:215], a[224:227], v[112:115], v[204:207]
    s_lshl_b32 s6, s7, 7
    v_exp_f32 v208, v208
    v_mfma_f32_16x16x32_bf16 v[212:215], a[228:231], v[116:119], v[212:215]
    s_xor_b32 s36, s4, 1
    v_exp_f32 v209, v209
    v_mfma_f32_16x16x32_bf16 v[212:215], a[232:235], v[120:123], v[212:215]
    s_mul_i32 s36, s36, 294912
    v_exp_f32 v210, v210
    v_mfma_f32_16x16x32_bf16 v[212:215], a[236:239], v[124:127], v[212:215]
    s_waitcnt lgkmcnt(3)
    s_add_u32 s46, s36, s6
    v_exp_f32 v211, v211
    v_cvt_pk_bf16_f32 v146, v208, v209
    ds_read_b128 a[224:227], v8 offset:12288
    v_cvt_pk_bf16_f32 v147, v210, v211
    v_mfma_f32_16x16x32_bf16 v[208:211], a[208:211], v[64:67], v[192:195]
    s_waitcnt lgkmcnt(3)
    s_lshl_b32 s36, s4, 8
    v_exp_f32 v212, v212
    v_mfma_f32_16x16x32_bf16 v[208:211], a[212:215], v[68:71], v[208:211]
    s_waitcnt lgkmcnt(2)
    s_add_u32 s56, s47, s36
    v_exp_f32 v213, v213
    v_mfma_f32_16x16x32_bf16 v[208:211], a[216:219], v[72:75], v[208:211]
    s_waitcnt lgkmcnt(1)
    s_lshr_b32 s36, s4, 1
    v_exp_f32 v214, v214
    v_mfma_f32_16x16x32_bf16 v[208:211], a[220:223], v[76:79], v[208:211]
    s_lshl_b32 s36, s36, 11
    v_exp_f32 v215, v215
    v_cvt_pk_bf16_f32 v154, v212, v213
    ds_read_b128 a[228:231], v9 offset:12288
    v_cvt_pk_bf16_f32 v155, v214, v215
    v_mfma_f32_16x16x32_bf16 v[212:215], a[208:211], v[80:83], v[196:199]
    s_lshl_b32 s7, s7, 8
    s_nop 0
    v_exp_f32 v208, v208
    v_mfma_f32_16x16x32_bf16 v[212:215], a[212:215], v[84:87], v[212:215]
    s_add_u32 s36, s36, s7
    v_exp_f32 v209, v209
    v_mfma_f32_16x16x32_bf16 v[212:215], a[216:219], v[88:91], v[212:215]
    s_add_u32 s93, s47, s36
    v_exp_f32 v210, v210
    v_mfma_f32_16x16x32_bf16 v[212:215], a[220:223], v[92:95], v[212:215]
    s_lshr_b32 s36, s4, 1
    v_exp_f32 v211, v211
    v_cvt_pk_bf16_f32 v132, v208, v209
    ds_read_b128 a[232:235], v10 offset:12288
    v_cvt_pk_bf16_f32 v133, v210, v211
    v_mfma_f32_16x16x32_bf16 v[208:211], a[208:211], v[96:99], v[200:203]
    s_lshl_b32 s36, s36, 4
    s_nop 0
    v_exp_f32 v212, v212
    v_mfma_f32_16x16x32_bf16 v[208:211], a[212:215], v[100:103], v[208:211]
    s_add_u32 s36, s36, s5
    v_exp_f32 v213, v213
    v_mfma_f32_16x16x32_bf16 v[208:211], a[216:219], v[104:107], v[208:211]
    s_lshl_b32 s36, s36, 9
    v_exp_f32 v214, v214
    v_mfma_f32_16x16x32_bf16 v[208:211], a[220:223], v[108:111], v[208:211]
    s_add_u32 s36, s36, s7
    v_exp_f32 v215, v215
    v_cvt_pk_bf16_f32 v140, v212, v213
    ds_read_b128 a[236:239], v11 offset:12288
    v_cvt_pk_bf16_f32 v141, v214, v215
    s_waitcnt vmcnt(4)
    s_barrier
    v_mfma_f32_16x16x32_bf16 v[212:215], a[208:211], v[112:115], v[204:207]
    s_lshl_b32 s36, s36, 8
    v_exp_f32 v208, v208
    v_mfma_f32_16x16x32_bf16 v[212:215], a[212:215], v[116:119], v[212:215]
    s_add_u32 m0, s42, 49152
    s_add_u32 s55, s36, 20971520
    v_exp_f32 v209, v209
    v_mfma_f32_16x16x32_bf16 v[212:215], a[216:219], v[120:123], v[212:215]
    s_add_u32 s7, s45, s6
    v_exp_f32 v210, v210
    v_mfma_f32_16x16x32_bf16 v[212:215], a[220:223], v[124:127], v[212:215]
    s_waitcnt lgkmcnt(3)
    s_xor_b32 s54, s92, 128
    v_exp_f32 v211, v211
    v_cvt_pk_bf16_f32 v148, v208, v209
    ds_read_b128 a[208:211], v8 offset:16384
    v_cvt_pk_bf16_f32 v149, v210, v211
    buffer_load_dwordx4 v36, s[8:11], s40 offen lds
    v_mfma_f32_16x16x32_bf16 v[208:211], a[224:227], v[64:67], v[192:195]
    s_waitcnt lgkmcnt(3)
    s_lshl_b32 s36, s3, 14
    v_exp_f32 v212, v212
    v_mfma_f32_16x16x32_bf16 v[208:211], a[228:231], v[68:71], v[208:211]
    s_waitcnt lgkmcnt(2)
    v_exp_f32 v213, v213
    v_mfma_f32_16x16x32_bf16 v[208:211], a[232:235], v[72:75], v[208:211]
    s_waitcnt lgkmcnt(1)
    v_exp_f32 v214, v214
    v_mfma_f32_16x16x32_bf16 v[208:211], a[236:239], v[76:79], v[208:211]
    v_exp_f32 v215, v215
    v_cvt_pk_bf16_f32 v156, v212, v213
    ds_read_b128 a[212:215], v9 offset:16384
    v_cvt_pk_bf16_f32 v157, v214, v215
    v_mfma_f32_16x16x32_bf16 v[212:215], a[224:227], v[80:83], v[196:199]
    s_nop 2
    v_exp_f32 v208, v208
    v_mfma_f32_16x16x32_bf16 v[212:215], a[228:231], v[84:87], v[212:215]
    v_exp_f32 v209, v209
    v_mfma_f32_16x16x32_bf16 v[212:215], a[232:235], v[88:91], v[212:215]
    v_exp_f32 v210, v210
    v_mfma_f32_16x16x32_bf16 v[212:215], a[236:239], v[92:95], v[212:215]
    v_exp_f32 v211, v211
    ds_read_b64_tr_b16 a[160:161], v20 offset:0
    v_cvt_pk_bf16_f32 v134, v208, v209
    v_lshrrev_b32 v51, 2, v0
    v_mul_u32_u24 v51, 9216, v51
    v_and_b32 v254, 3, v0
    v_lshl_add_u32 v254, v254, 4, v51
    v_lshlrev_b32 v255, 4, v0
    v_add_u32 v51, 98304, v255
    v_lshl_add_u32 v252, v1, 4, s36
    v_mov_b32 v224, 0
    v_mov_b32 v225, 0
    v_mov_b32 v226, 0
    v_mov_b32 v227, 0
    v_mov_b32 v228, 0
    v_mov_b32 v229, 0
    v_mov_b32 v230, 0
    v_mov_b32 v231, 0
    v_mov_b32 v248, -1
    v_mov_b32 v249, -1
    v_mov_b32 v250, -1
    v_mov_b32 v251, -1
    v_min_u32 v232, 41, v1
    v_lshlrev_b32 v232, 4, v232
    s_mov_b32 s57, s58
    s_lshl_b32 s6, s3, 10
    s_add_u32 s6, s6, 135168
    s_lshr_b32 s37, s2, 3
    s_mul_i32 s37, s37, -129024
    s_add_u32 s37, s37, 4128768
    ds_read_b64_tr_b16 a[162:163], v20 offset:4096
    ds_read_b128 a[216:219], v10 offset:16384
    v_cvt_pk_bf16_f32 v135, v210, v211
    buffer_load_dwordx4 v37, s[8:11], s40 offen offset:1024 lds
    v_mfma_f32_16x16x32_bf16 v[208:211], a[224:227], v[96:99], v[200:203]
    v_exp_f32 v212, v212
    v_mfma_f32_16x16x32_bf16 v[208:211], a[228:231], v[100:103], v[208:211]
    v_exp_f32 v213, v213
    v_mfma_f32_16x16x32_bf16 v[208:211], a[232:235], v[104:107], v[208:211]
    v_exp_f32 v214, v214
    v_mfma_f32_16x16x32_bf16 v[208:211], a[236:239], v[108:111], v[208:211]
    s_mov_b32 s52, s55
    v_exp_f32 v215, v215
    ds_read_b64_tr_b16 a[164:165], v20 offset:8192
    v_cvt_pk_bf16_f32 v142, v212, v213
    ds_read_b64_tr_b16 a[166:167], v20 offset:12288
    v_min_u32 v237, 19, v1
    v_lshl_add_u32 v237, v237, 7, s36
    v_lshl_add_u32 v238, v1, 7, s36
    ds_read_b128 a[220:223], v11 offset:16384
    v_cvt_pk_bf16_f32 v143, v214, v215
    buffer_load_dword v217, v57, s[32:35], s37 offen
    v_mfma_f32_16x16x32_bf16 v[212:215], a[224:227], v[112:115], v[204:207]
    v_exp_f32 v208, v208
    v_mfma_f32_16x16x32_bf16 v[212:215], a[228:231], v[116:119], v[212:215]
    v_exp_f32 v209, v209
    v_mfma_f32_16x16x32_bf16 v[212:215], a[232:235], v[120:123], v[212:215]
    s_mul_i32 s37, s5, 18432
    v_exp_f32 v210, v210
    v_mfma_f32_16x16x32_bf16 v[212:215], a[236:239], v[124:127], v[212:215]
    s_add_u32 s37, s37, s45
    v_exp_f32 v211, v211
    ds_read_b64_tr_b16 a[168:169], v21 offset:0
    v_cvt_pk_bf16_f32 v150, v208, v209
    ds_read_b64_tr_b16 a[170:171], v21 offset:4096
    v_min_u32 v236, 143, v0
    v_lshl_add_u32 v236, v236, 7, s37
    v_mul_u32_u24 v235, 24, v0
    v_lshrrev_b32 v235, 8, v235
    v_lshl_add_u32 v235, v235, 7, s37
    ds_read_b128 a[224:227], v8 offset:20480
    v_cvt_pk_bf16_f32 v151, v210, v211
    s_waitcnt lgkmcnt(3)
    buffer_load_dwordx4 v38, s[8:11], s40 offen offset:2048 lds
Lattn_loop:
    v_mfma_f32_16x16x32_bf16 v[208:211], a[208:211], v[64:67], v[192:195]
    v_exp_f32 v212, v212
    v_mfma_f32_16x16x32_bf16 v[208:211], a[212:215], v[68:71], v[208:211]
    v_exp_f32 v213, v213
    v_mfma_f32_16x16x32_bf16 v[208:211], a[216:219], v[72:75], v[208:211]
    v_exp_f32 v214, v214
    v_mfma_f32_16x16x32_bf16 v[208:211], a[220:223], v[76:79], v[208:211]
    v_exp_f32 v215, v215
    v_mfma_f32_16x16x32_bf16 a[0:3], a[160:163], v[128:131], a[0:3]
    ds_read_b64_tr_b16 a[172:173], v21 offset:8192
    v_cvt_pk_bf16_f32 v158, v212, v213
    v_mfma_f32_16x16x32_bf16 a[0:3], a[164:167], v[132:135], a[0:3]
    ds_read_b64_tr_b16 a[174:175], v21 offset:12288
    v_mfma_f32_16x16x32_bf16 a[4:7], a[160:163], v[136:139], a[4:7]
    ds_read_b128 a[228:231], v9 offset:20480
    v_cvt_pk_bf16_f32 v159, v214, v215
    v_mfma_f32_16x16x32_bf16 a[4:7], a[164:167], v[140:143], a[4:7]
    v_mfma_f32_16x16x32_bf16 v[212:215], a[208:211], v[80:83], v[196:199]
    v_exp_f32 v208, v208
    v_mfma_f32_16x16x32_bf16 v[212:215], a[212:215], v[84:87], v[212:215]
    v_exp_f32 v209, v209
    v_mfma_f32_16x16x32_bf16 v[212:215], a[216:219], v[88:91], v[212:215]
    v_exp_f32 v210, v210
    v_mfma_f32_16x16x32_bf16 v[212:215], a[220:223], v[92:95], v[212:215]
    v_exp_f32 v211, v211
    v_mfma_f32_16x16x32_bf16 a[8:11], a[160:163], v[144:147], a[8:11]
    ds_read_b64_tr_b16 a[176:177], v22 offset:0
    v_cvt_pk_bf16_f32 v160, v208, v209
    v_mfma_f32_16x16x32_bf16 a[8:11], a[164:167], v[148:151], a[8:11]
    ds_read_b64_tr_b16 a[178:179], v22 offset:4096
    v_mfma_f32_16x16x32_bf16 a[12:15], a[160:163], v[152:155], a[12:15]
    ds_read_b128 a[232:235], v10 offset:20480
    v_cvt_pk_bf16_f32 v161, v210, v211
    v_mfma_f32_16x16x32_bf16 a[12:15], a[164:167], v[156:159], a[12:15]
    s_waitcnt lgkmcnt(3)
    buffer_load_dwordx4 v39, s[8:11], s40 offen offset:3072 lds
    v_mfma_f32_16x16x32_bf16 v[208:211], a[208:211], v[96:99], v[200:203]
    v_exp_f32 v212, v212
    v_mfma_f32_16x16x32_bf16 v[208:211], a[212:215], v[100:103], v[208:211]
    s_add_u32 s40, s40, 16384
    v_exp_f32 v213, v213
    v_mfma_f32_16x16x32_bf16 v[208:211], a[216:219], v[104:107], v[208:211]
    s_mov_b32 m0, s6
    v_exp_f32 v214, v214
    v_mfma_f32_16x16x32_bf16 v[208:211], a[220:223], v[108:111], v[208:211]
    v_exp_f32 v215, v215
    v_mfma_f32_16x16x32_bf16 a[16:19], a[168:171], v[128:131], a[16:19]
    ds_read_b64_tr_b16 a[180:181], v22 offset:8192
    v_cvt_pk_bf16_f32 v168, v212, v213
    v_mfma_f32_16x16x32_bf16 a[16:19], a[172:175], v[132:135], a[16:19]
    ds_read_b64_tr_b16 a[182:183], v22 offset:12288
    v_mfma_f32_16x16x32_bf16 a[20:23], a[168:171], v[136:139], a[20:23]
    ds_read_b128 a[236:239], v11 offset:20480
    v_cvt_pk_bf16_f32 v169, v214, v215
    v_mfma_f32_16x16x32_bf16 a[20:23], a[172:175], v[140:143], a[20:23]
    buffer_load_dwordx4 v254, s[32:35], s57 offen  lds
    v_smfmac_f32_16x16x64_bf16 a[192:195], v[52:55], v[128:135], v50
    v_mfma_f32_16x16x32_bf16 v[212:215], a[208:211], v[112:115], v[204:207]
    v_exp_f32 v208, v208
    v_mfma_f32_16x16x32_bf16 v[212:215], a[212:215], v[116:119], v[212:215]
    s_add_u32 m0, s42, 98304
    v_exp_f32 v209, v209
    v_mfma_f32_16x16x32_bf16 v[212:215], a[216:219], v[120:123], v[212:215]
    v_exp_f32 v210, v210
    v_mfma_f32_16x16x32_bf16 v[212:215], a[220:223], v[124:127], v[212:215]
    v_exp_f32 v211, v211
    v_mfma_f32_16x16x32_bf16 a[24:27], a[168:171], v[144:147], a[24:27]
    ds_read_b64_tr_b16 a[184:185], v23 offset:0
    v_cvt_pk_bf16_f32 v176, v208, v209
    v_mfma_f32_16x16x32_bf16 a[24:27], a[172:175], v[148:151], a[24:27]
    ds_read_b64_tr_b16 a[186:187], v23 offset:4096
    v_mfma_f32_16x16x32_bf16 a[28:31], a[168:171], v[152:155], a[28:31]
    ds_read_b128 a[208:211], v8 offset:24576
    v_cvt_pk_bf16_f32 v177, v210, v211
    v_mfma_f32_16x16x32_bf16 a[28:31], a[172:175], v[156:159], a[28:31]
    s_waitcnt lgkmcnt(3)
    buffer_load_dwordx4 v40, s[12:15], s41 offen lds
    v_mfma_f32_16x16x32_bf16 v[208:211], a[224:227], v[64:67], v[192:195]
    v_exp_f32 v212, v212
    v_mfma_f32_16x16x32_bf16 v[208:211], a[228:231], v[68:71], v[208:211]
    s_add_u32 s6, s6, 4096
    v_exp_f32 v213, v213
    v_mfma_f32_16x16x32_bf16 v[208:211], a[232:235], v[72:75], v[208:211]
    s_add_u32 s57, s57, 589824
    v_exp_f32 v214, v214
    v_mfma_f32_16x16x32_bf16 v[208:211], a[236:239], v[76:79], v[208:211]
    v_exp_f32 v215, v215
    v_mfma_f32_16x16x32_bf16 a[32:35], a[176:179], v[128:131], a[32:35]
    ds_read_b64_tr_b16 a[188:189], v23 offset:8192
    v_cvt_pk_bf16_f32 v184, v212, v213
    v_mfma_f32_16x16x32_bf16 a[32:35], a[180:183], v[132:135], a[32:35]
    ds_read_b64_tr_b16 a[190:191], v23 offset:12288
    v_mfma_f32_16x16x32_bf16 a[36:39], a[176:179], v[136:139], a[36:39]
    ds_read_b128 a[212:215], v9 offset:24576
    v_cvt_pk_bf16_f32 v185, v214, v215
    v_mfma_f32_16x16x32_bf16 a[36:39], a[180:183], v[140:143], a[36:39]
    v_smfmac_f32_16x16x64_bf16 a[196:199], v[52:55], v[136:143], v50
    v_mfma_f32_16x16x32_bf16 v[212:215], a[224:227], v[80:83], v[196:199]
    v_exp_f32 v208, v208
    v_mfma_f32_16x16x32_bf16 v[212:215], a[228:231], v[84:87], v[212:215]
    v_exp_f32 v209, v209
    v_mfma_f32_16x16x32_bf16 v[212:215], a[232:235], v[88:91], v[212:215]
    v_exp_f32 v210, v210
    v_mfma_f32_16x16x32_bf16 v[212:215], a[236:239], v[92:95], v[212:215]
    v_exp_f32 v211, v211
    v_mfma_f32_16x16x32_bf16 a[40:43], a[176:179], v[144:147], a[40:43]
    ds_read_b64_tr_b16 a[160:161], v24 offset:0
    v_cvt_pk_bf16_f32 v162, v208, v209
    v_mfma_f32_16x16x32_bf16 a[40:43], a[180:183], v[148:151], a[40:43]
    ds_read_b64_tr_b16 a[162:163], v24 offset:4096
    v_mfma_f32_16x16x32_bf16 a[44:47], a[176:179], v[152:155], a[44:47]
    ds_read_b128 a[216:219], v10 offset:24576
    v_cvt_pk_bf16_f32 v163, v210, v211
    v_mfma_f32_16x16x32_bf16 a[44:47], a[180:183], v[156:159], a[44:47]
    s_waitcnt lgkmcnt(3)
    buffer_load_dwordx4 v41, s[12:15], s41 offen offset:1024 lds
    v_mfma_f32_16x16x32_bf16 v[208:211], a[224:227], v[96:99], v[200:203]
    v_exp_f32 v212, v212
    v_mfma_f32_16x16x32_bf16 v[208:211], a[228:231], v[100:103], v[208:211]
    v_exp_f32 v213, v213
    v_mfma_f32_16x16x32_bf16 v[208:211], a[232:235], v[104:107], v[208:211]
    v_exp_f32 v214, v214
    v_mfma_f32_16x16x32_bf16 v[208:211], a[236:239], v[108:111], v[208:211]
    v_exp_f32 v215, v215
    v_mfma_f32_16x16x32_bf16 a[48:51], a[184:187], v[128:131], a[48:51]
    ds_read_b64_tr_b16 a[164:165], v24 offset:8192
    v_cvt_pk_bf16_f32 v170, v212, v213
    v_mfma_f32_16x16x32_bf16 a[48:51], a[188:191], v[132:135], a[48:51]
    ds_read_b64_tr_b16 a[166:167], v24 offset:12288
    v_mfma_f32_16x16x32_bf16 a[52:55], a[184:187], v[136:139], a[52:55]
    ds_read_b128 a[220:223], v11 offset:24576
    v_cvt_pk_bf16_f32 v171, v214, v215
    v_mfma_f32_16x16x32_bf16 a[52:55], a[188:191], v[140:143], a[52:55]
    v_smfmac_f32_16x16x64_bf16 a[200:203], v[52:55], v[144:151], v50
    v_mfma_f32_16x16x32_bf16 v[212:215], a[224:227], v[112:115], v[204:207]
    v_exp_f32 v208, v208
    v_mfma_f32_16x16x32_bf16 v[212:215], a[228:231], v[116:119], v[212:215]
    v_exp_f32 v209, v209
    v_mfma_f32_16x16x32_bf16 v[212:215], a[232:235], v[120:123], v[212:215]
    v_exp_f32 v210, v210
    v_mfma_f32_16x16x32_bf16 v[212:215], a[236:239], v[124:127], v[212:215]
    v_exp_f32 v211, v211
    v_mfma_f32_16x16x32_bf16 a[56:59], a[184:187], v[144:147], a[56:59]
    ds_read_b64_tr_b16 a[168:169], v25 offset:0
    v_cvt_pk_bf16_f32 v178, v208, v209
    v_mfma_f32_16x16x32_bf16 a[56:59], a[188:191], v[148:151], a[56:59]
    ds_read_b64_tr_b16 a[170:171], v25 offset:4096
    v_mfma_f32_16x16x32_bf16 a[60:63], a[184:187], v[152:155], a[60:63]
    ds_read_b128 a[224:227], v8 offset:28672
    v_cvt_pk_bf16_f32 v179, v210, v211
    v_mfma_f32_16x16x32_bf16 a[60:63], a[188:191], v[156:159], a[60:63]
    s_waitcnt lgkmcnt(3)
    buffer_load_dwordx4 v40, s[12:15], s41 offen offset:2048 lds
    v_mfma_f32_16x16x32_bf16 v[208:211], a[208:211], v[64:67], v[192:195]
    v_exp_f32 v212, v212
    v_mfma_f32_16x16x32_bf16 v[208:211], a[212:215], v[68:71], v[208:211]
    v_exp_f32 v213, v213
    v_mfma_f32_16x16x32_bf16 v[208:211], a[216:219], v[72:75], v[208:211]
    v_exp_f32 v214, v214
    v_mfma_f32_16x16x32_bf16 v[208:211], a[220:223], v[76:79], v[208:211]
    v_exp_f32 v215, v215
    v_mfma_f32_16x16x32_bf16 a[64:67], a[160:163], v[128:131], a[64:67]
    ds_read_b64_tr_b16 a[172:173], v25 offset:8192
    v_cvt_pk_bf16_f32 v186, v212, v213
    v_mfma_f32_16x16x32_bf16 a[64:67], a[164:167], v[132:135], a[64:67]
    ds_read_b64_tr_b16 a[174:175], v25 offset:12288
    v_mfma_f32_16x16x32_bf16 a[68:71], a[160:163], v[136:139], a[68:71]
    ds_read_b128 a[228:231], v9 offset:28672
    v_cvt_pk_bf16_f32 v187, v214, v215
    v_mfma_f32_16x16x32_bf16 a[68:71], a[164:167], v[140:143], a[68:71]
    v_smfmac_f32_16x16x64_bf16 a[204:207], v[52:55], v[152:159], v50
    v_mfma_f32_16x16x32_bf16 v[212:215], a[208:211], v[80:83], v[196:199]
    v_exp_f32 v208, v208
    v_mfma_f32_16x16x32_bf16 v[212:215], a[212:215], v[84:87], v[212:215]
    v_exp_f32 v209, v209
    v_mfma_f32_16x16x32_bf16 v[212:215], a[216:219], v[88:91], v[212:215]
    v_exp_f32 v210, v210
    v_mfma_f32_16x16x32_bf16 v[212:215], a[220:223], v[92:95], v[212:215]
    v_exp_f32 v211, v211
    v_mfma_f32_16x16x32_bf16 a[72:75], a[160:163], v[144:147], a[72:75]
    ds_read_b64_tr_b16 a[176:177], v26 offset:0
    v_cvt_pk_bf16_f32 v164, v208, v209
    v_mfma_f32_16x16x32_bf16 a[72:75], a[164:167], v[148:151], a[72:75]
    ds_read_b64_tr_b16 a[178:179], v26 offset:4096
    v_mfma_f32_16x16x32_bf16 a[76:79], a[160:163], v[152:155], a[76:79]
    ds_read_b128 a[232:235], v10 offset:28672
    v_cvt_pk_bf16_f32 v165, v210, v211
    v_mfma_f32_16x16x32_bf16 a[76:79], a[164:167], v[156:159], a[76:79]
    s_waitcnt lgkmcnt(3)
    buffer_load_dwordx4 v41, s[12:15], s41 offen offset:3072 lds
    v_mfma_f32_16x16x32_bf16 v[208:211], a[208:211], v[96:99], v[200:203]
    v_exp_f32 v212, v212
    v_mfma_f32_16x16x32_bf16 v[208:211], a[212:215], v[100:103], v[208:211]
    s_add_u32 s41, s41, 16384
    v_exp_f32 v213, v213
    v_mfma_f32_16x16x32_bf16 v[208:211], a[216:219], v[104:107], v[208:211]
    v_exp_f32 v214, v214
    v_mfma_f32_16x16x32_bf16 v[208:211], a[220:223], v[108:111], v[208:211]
    v_exp_f32 v215, v215
    v_mfma_f32_16x16x32_bf16 a[80:83], a[168:171], v[128:131], a[80:83]
    ds_read_b64_tr_b16 a[180:181], v26 offset:8192
    v_cvt_pk_bf16_f32 v172, v212, v213
    v_mfma_f32_16x16x32_bf16 a[80:83], a[172:175], v[132:135], a[80:83]
    ds_read_b64_tr_b16 a[182:183], v26 offset:12288
    v_mfma_f32_16x16x32_bf16 a[84:87], a[168:171], v[136:139], a[84:87]
    ds_read_b128 a[236:239], v11 offset:28672
    v_cvt_pk_bf16_f32 v173, v214, v215
    v_mfma_f32_16x16x32_bf16 a[84:87], a[172:175], v[140:143], a[84:87]
    s_waitcnt vmcnt(10)
    s_barrier
    v_mfma_f32_16x16x32_bf16 v[212:215], a[208:211], v[112:115], v[204:207]
    v_exp_f32 v208, v208
    v_mfma_f32_16x16x32_bf16 v[212:215], a[212:215], v[116:119], v[212:215]
    s_add_u32 m0, s42, 0
    v_exp_f32 v209, v209
    v_mfma_f32_16x16x32_bf16 v[212:215], a[216:219], v[120:123], v[212:215]
    v_exp_f32 v210, v210
    v_mfma_f32_16x16x32_bf16 v[212:215], a[220:223], v[124:127], v[212:215]
    v_exp_f32 v211, v211
    v_mfma_f32_16x16x32_bf16 a[88:91], a[168:171], v[144:147], a[88:91]
    ds_read_b64_tr_b16 a[184:185], v27 offset:0
    v_cvt_pk_bf16_f32 v180, v208, v209
    v_mfma_f32_16x16x32_bf16 a[88:91], a[172:175], v[148:151], a[88:91]
    ds_read_b64_tr_b16 a[186:187], v27 offset:4096
    v_mfma_f32_16x16x32_bf16 a[92:95], a[168:171], v[152:155], a[92:95]
    ds_read_b128 a[208:211], v8 offset:32768
    v_cvt_pk_bf16_f32 v181, v210, v211
    v_mfma_f32_16x16x32_bf16 a[92:95], a[172:175], v[156:159], a[92:95]
    s_waitcnt lgkmcnt(3)
    buffer_load_dwordx4 v36, s[8:11], s40 offen lds
    v_mfma_f32_16x16x32_bf16 v[208:211], a[224:227], v[64:67], v[192:195]
    v_exp_f32 v212, v212
    v_mfma_f32_16x16x32_bf16 v[208:211], a[228:231], v[68:71], v[208:211]
    v_exp_f32 v213, v213
    v_mfma_f32_16x16x32_bf16 v[208:211], a[232:235], v[72:75], v[208:211]
    v_exp_f32 v214, v214
    v_mfma_f32_16x16x32_bf16 v[208:211], a[236:239], v[76:79], v[208:211]
    v_exp_f32 v215, v215
    v_mfma_f32_16x16x32_bf16 a[96:99], a[176:179], v[128:131], a[96:99]
    ds_read_b64_tr_b16 a[188:189], v27 offset:8192
    v_cvt_pk_bf16_f32 v188, v212, v213
    v_mfma_f32_16x16x32_bf16 a[96:99], a[180:183], v[132:135], a[96:99]
    ds_read_b64_tr_b16 a[190:191], v27 offset:12288
    v_mfma_f32_16x16x32_bf16 a[100:103], a[176:179], v[136:139], a[100:103]
    ds_read_b128 a[212:215], v9 offset:32768
    v_cvt_pk_bf16_f32 v189, v214, v215
    v_mfma_f32_16x16x32_bf16 a[100:103], a[180:183], v[140:143], a[100:103]
    v_mfma_f32_16x16x32_bf16 v[212:215], a[224:227], v[80:83], v[196:199]
    v_exp_f32 v208, v208
    v_mfma_f32_16x16x32_bf16 v[212:215], a[228:231], v[84:87], v[212:215]
    v_exp_f32 v209, v209
    v_mfma_f32_16x16x32_bf16 v[212:215], a[232:235], v[88:91], v[212:215]
    v_exp_f32 v210, v210
    v_mfma_f32_16x16x32_bf16 v[212:215], a[236:239], v[92:95], v[212:215]
    v_exp_f32 v211, v211
    v_mfma_f32_16x16x32_bf16 a[104:107], a[176:179], v[144:147], a[104:107]
    ds_read_b64_tr_b16 a[160:161], v20 offset:16384
    v_cvt_pk_bf16_f32 v166, v208, v209
    v_mfma_f32_16x16x32_bf16 a[104:107], a[180:183], v[148:151], a[104:107]
    ds_read_b64_tr_b16 a[162:163], v20 offset:20480
    v_mfma_f32_16x16x32_bf16 a[108:111], a[176:179], v[152:155], a[108:111]
    ds_read_b128 a[216:219], v10 offset:32768
    v_cvt_pk_bf16_f32 v167, v210, v211
    v_mfma_f32_16x16x32_bf16 a[108:111], a[180:183], v[156:159], a[108:111]
    s_waitcnt lgkmcnt(3)
    buffer_load_dwordx4 v37, s[8:11], s40 offen offset:1024 lds
    v_mfma_f32_16x16x32_bf16 v[208:211], a[224:227], v[96:99], v[200:203]
    v_exp_f32 v212, v212
    v_mfma_f32_16x16x32_bf16 v[208:211], a[228:231], v[100:103], v[208:211]
    v_exp_f32 v213, v213
    v_mfma_f32_16x16x32_bf16 v[208:211], a[232:235], v[104:107], v[208:211]
    v_exp_f32 v214, v214
    v_mfma_f32_16x16x32_bf16 v[208:211], a[236:239], v[108:111], v[208:211]
    v_exp_f32 v215, v215
    v_mfma_f32_16x16x32_bf16 a[112:115], a[184:187], v[128:131], a[112:115]
    ds_read_b64_tr_b16 a[164:165], v20 offset:24576
    v_cvt_pk_bf16_f32 v174, v212, v213
    v_mfma_f32_16x16x32_bf16 a[112:115], a[188:191], v[132:135], a[112:115]
    ds_read_b64_tr_b16 a[166:167], v20 offset:28672
    v_mfma_f32_16x16x32_bf16 a[116:119], a[184:187], v[136:139], a[116:119]
    ds_read_b128 a[220:223], v11 offset:32768
    v_cvt_pk_bf16_f32 v175, v214, v215
    v_mfma_f32_16x16x32_bf16 a[116:119], a[188:191], v[140:143], a[116:119]
    buffer_load_dwordx4 v[240:243], v7, s[16:19], s44 offen
    v_mfma_f32_16x16x32_bf16 v[212:215], a[224:227], v[112:115], v[204:207]
    v_exp_f32 v208, v208
    v_mfma_f32_16x16x32_bf16 v[212:215], a[228:231], v[116:119], v[212:215]
    v_exp_f32 v209, v209
    v_mfma_f32_16x16x32_bf16 v[212:215], a[232:235], v[120:123], v[212:215]
    v_exp_f32 v210, v210
    v_mfma_f32_16x16x32_bf16 v[212:215], a[236:239], v[124:127], v[212:215]
    s_add_u32 s44, s44, 884736
    v_exp_f32 v211, v211
    v_mfma_f32_16x16x32_bf16 a[120:123], a[184:187], v[144:147], a[120:123]
    ds_read_b64_tr_b16 a[168:169], v21 offset:16384
    v_cvt_pk_bf16_f32 v182, v208, v209
    v_mfma_f32_16x16x32_bf16 a[120:123], a[188:191], v[148:151], a[120:123]
    ds_read_b64_tr_b16 a[170:171], v21 offset:20480
    v_mfma_f32_16x16x32_bf16 a[124:127], a[184:187], v[152:155], a[124:127]
    ds_read_b128 a[224:227], v8 offset:36864
    v_cvt_pk_bf16_f32 v183, v210, v211
    v_mfma_f32_16x16x32_bf16 a[124:127], a[188:191], v[156:159], a[124:127]
    s_waitcnt lgkmcnt(3)
    buffer_load_dwordx4 v38, s[8:11], s40 offen offset:2048 lds
    v_mfma_f32_16x16x32_bf16 v[208:211], a[208:211], v[64:67], v[192:195]
    v_exp_f32 v212, v212
    v_mfma_f32_16x16x32_bf16 v[208:211], a[212:215], v[68:71], v[208:211]
    v_exp_f32 v213, v213
    v_mfma_f32_16x16x32_bf16 v[208:211], a[216:219], v[72:75], v[208:211]
    v_exp_f32 v214, v214
    v_mfma_f32_16x16x32_bf16 v[208:211], a[220:223], v[76:79], v[208:211]
    v_exp_f32 v215, v215
    v_mfma_f32_16x16x32_bf16 a[0:3], a[160:163], v[160:163], a[0:3]
    ds_read_b64_tr_b16 a[172:173], v21 offset:24576
    v_cvt_pk_bf16_f32 v190, v212, v213
    v_mfma_f32_16x16x32_bf16 a[0:3], a[164:167], v[164:167], a[0:3]
    ds_read_b64_tr_b16 a[174:175], v21 offset:28672
    v_mfma_f32_16x16x32_bf16 a[4:7], a[160:163], v[168:171], a[4:7]
    ds_read_b128 a[228:231], v9 offset:36864
    v_cvt_pk_bf16_f32 v191, v214, v215
    v_mfma_f32_16x16x32_bf16 a[4:7], a[164:167], v[172:175], a[4:7]
    v_mfma_f32_16x16x32_bf16 v[212:215], a[208:211], v[80:83], v[196:199]
    v_exp_f32 v208, v208
    v_mfma_f32_16x16x32_bf16 v[212:215], a[212:215], v[84:87], v[212:215]
    v_exp_f32 v209, v209
    v_mfma_f32_16x16x32_bf16 v[212:215], a[216:219], v[88:91], v[212:215]
    v_exp_f32 v210, v210
    v_mfma_f32_16x16x32_bf16 v[212:215], a[220:223], v[92:95], v[212:215]
    v_exp_f32 v211, v211
    v_mfma_f32_16x16x32_bf16 a[8:11], a[160:163], v[176:179], a[8:11]
    ds_read_b64_tr_b16 a[176:177], v22 offset:16384
    v_cvt_pk_bf16_f32 v128, v208, v209
    v_mfma_f32_16x16x32_bf16 a[8:11], a[164:167], v[180:183], a[8:11]
    ds_read_b64_tr_b16 a[178:179], v22 offset:20480
    v_mfma_f32_16x16x32_bf16 a[12:15], a[160:163], v[184:187], a[12:15]
    ds_read_b128 a[232:235], v10 offset:36864
    v_cvt_pk_bf16_f32 v129, v210, v211
    v_mfma_f32_16x16x32_bf16 a[12:15], a[164:167], v[188:191], a[12:15]
    s_waitcnt lgkmcnt(3)
    buffer_load_dwordx4 v39, s[8:11], s40 offen offset:3072 lds
    v_mfma_f32_16x16x32_bf16 v[208:211], a[208:211], v[96:99], v[200:203]
    v_exp_f32 v212, v212
    v_mfma_f32_16x16x32_bf16 v[208:211], a[212:215], v[100:103], v[208:211]
    s_add_u32 s40, s40, 16384
    v_exp_f32 v213, v213
    v_mfma_f32_16x16x32_bf16 v[208:211], a[216:219], v[104:107], v[208:211]
    v_exp_f32 v214, v214
    v_mfma_f32_16x16x32_bf16 v[208:211], a[220:223], v[108:111], v[208:211]
    v_exp_f32 v215, v215
    v_mfma_f32_16x16x32_bf16 a[16:19], a[168:171], v[160:163], a[16:19]
    ds_read_b64_tr_b16 a[180:181], v22 offset:24576
    v_cvt_pk_bf16_f32 v136, v212, v213
    v_mfma_f32_16x16x32_bf16 a[16:19], a[172:175], v[164:167], a[16:19]
    ds_read_b64_tr_b16 a[182:183], v22 offset:28672
    v_mfma_f32_16x16x32_bf16 a[20:23], a[168:171], v[168:171], a[20:23]
    ds_read_b128 a[236:239], v11 offset:36864
    v_cvt_pk_bf16_f32 v137, v214, v215
    v_mfma_f32_16x16x32_bf16 a[20:23], a[172:175], v[172:175], a[20:23]
    v_smfmac_f32_16x16x64_bf16 a[192:195], v[52:55], v[160:167], v50
    v_mfma_f32_16x16x32_bf16 v[212:215], a[208:211], v[112:115], v[204:207]
Ltour4:
    s_cbranch_execz Ltour8
    v_exp_f32 v208, v208
    v_mfma_f32_16x16x32_bf16 v[212:215], a[212:215], v[116:119], v[212:215]
    s_add_u32 m0, s42, 114688
    v_exp_f32 v209, v209
    v_mfma_f32_16x16x32_bf16 v[212:215], a[216:219], v[120:123], v[212:215]
    v_exp_f32 v210, v210
    v_mfma_f32_16x16x32_bf16 v[212:215], a[220:223], v[124:127], v[212:215]
    v_exp_f32 v211, v211
    v_mfma_f32_16x16x32_bf16 a[24:27], a[168:171], v[176:179], a[24:27]
    ds_read_b64_tr_b16 a[184:185], v23 offset:16384
    v_cvt_pk_bf16_f32 v144, v208, v209
    v_mfma_f32_16x16x32_bf16 a[24:27], a[172:175], v[180:183], a[24:27]
    ds_read_b64_tr_b16 a[186:187], v23 offset:20480
    v_mfma_f32_16x16x32_bf16 a[28:31], a[168:171], v[184:187], a[28:31]
    ds_read_b128 a[208:211], v8 offset:40960
    v_cvt_pk_bf16_f32 v145, v210, v211
    v_mfma_f32_16x16x32_bf16 a[28:31], a[172:175], v[188:191], a[28:31]
    s_waitcnt lgkmcnt(3)
    buffer_load_dwordx4 v40, s[12:15], s41 offen lds
    v_mfma_f32_16x16x32_bf16 v[208:211], a[224:227], v[64:67], v[192:195]
    v_exp_f32 v212, v212
    v_mfma_f32_16x16x32_bf16 v[208:211], a[228:231], v[68:71], v[208:211]
    v_exp_f32 v213, v213
    v_mfma_f32_16x16x32_bf16 v[208:211], a[232:235], v[72:75], v[208:211]
    v_exp_f32 v214, v214
    v_mfma_f32_16x16x32_bf16 v[208:211], a[236:239], v[76:79], v[208:211]
    v_exp_f32 v215, v215
    v_mfma_f32_16x16x32_bf16 a[32:35], a[176:179], v[160:163], a[32:35]
    ds_read_b64_tr_b16 a[188:189], v23 offset:24576
    v_cvt_pk_bf16_f32 v152, v212, v213
    v_mfma_f32_16x16x32_bf16 a[32:35], a[180:183], v[164:167], a[32:35]
    ds_read_b64_tr_b16 a[190:191], v23 offset:28672
    v_mfma_f32_16x16x32_bf16 a[36:39], a[176:179], v[168:171], a[36:39]
    ds_read_b128 a[212:215], v9 offset:40960
    v_cvt_pk_bf16_f32 v153, v214, v215
    v_mfma_f32_16x16x32_bf16 a[36:39], a[180:183], v[172:175], a[36:39]
    v_smfmac_f32_16x16x64_bf16 a[196:199], v[52:55], v[168:175], v50
    v_mfma_f32_16x16x32_bf16 v[212:215], a[224:227], v[80:83], v[196:199]
    v_exp_f32 v208, v208
    v_mfma_f32_16x16x32_bf16 v[212:215], a[228:231], v[84:87], v[212:215]
    v_exp_f32 v209, v209
    v_mfma_f32_16x16x32_bf16 v[212:215], a[232:235], v[88:91], v[212:215]
    v_exp_f32 v210, v210
    v_mfma_f32_16x16x32_bf16 v[212:215], a[236:239], v[92:95], v[212:215]
    v_exp_f32 v211, v211
    v_mfma_f32_16x16x32_bf16 a[40:43], a[176:179], v[176:179], a[40:43]
    ds_read_b64_tr_b16 a[160:161], v24 offset:16384
    v_cvt_pk_bf16_f32 v130, v208, v209
    v_mfma_f32_16x16x32_bf16 a[40:43], a[180:183], v[180:183], a[40:43]
    ds_read_b64_tr_b16 a[162:163], v24 offset:20480
    v_mfma_f32_16x16x32_bf16 a[44:47], a[176:179], v[184:187], a[44:47]
    ds_read_b128 a[216:219], v10 offset:40960
    v_cvt_pk_bf16_f32 v131, v210, v211
    v_mfma_f32_16x16x32_bf16 a[44:47], a[180:183], v[188:191], a[44:47]
    s_waitcnt lgkmcnt(3)
    buffer_load_dwordx4 v41, s[12:15], s41 offen offset:1024 lds
    v_mfma_f32_16x16x32_bf16 v[208:211], a[224:227], v[96:99], v[200:203]
    v_exp_f32 v212, v212
    v_mfma_f32_16x16x32_bf16 v[208:211], a[228:231], v[100:103], v[208:211]
    v_exp_f32 v213, v213
    v_mfma_f32_16x16x32_bf16 v[208:211], a[232:235], v[104:107], v[208:211]
    v_exp_f32 v214, v214
    v_mfma_f32_16x16x32_bf16 v[208:211], a[236:239], v[108:111], v[208:211]
    v_exp_f32 v215, v215
    v_mfma_f32_16x16x32_bf16 a[48:51], a[184:187], v[160:163], a[48:51]
    ds_read_b64_tr_b16 a[164:165], v24 offset:24576
    v_cvt_pk_bf16_f32 v138, v212, v213
    v_mfma_f32_16x16x32_bf16 a[48:51], a[188:191], v[164:167], a[48:51]
    ds_read_b64_tr_b16 a[166:167], v24 offset:28672
    v_mfma_f32_16x16x32_bf16 a[52:55], a[184:187], v[168:171], a[52:55]
    ds_read_b128 a[220:223], v11 offset:40960
    v_cvt_pk_bf16_f32 v139, v214, v215
    v_mfma_f32_16x16x32_bf16 a[52:55], a[188:191], v[172:175], a[52:55]
    v_smfmac_f32_16x16x64_bf16 a[200:203], v[52:55], v[176:183], v50
    v_mfma_f32_16x16x32_bf16 v[212:215], a[224:227], v[112:115], v[204:207]
    v_exp_f32 v208, v208
    v_mfma_f32_16x16x32_bf16 v[212:215], a[228:231], v[116:119], v[212:215]
    v_exp_f32 v209, v209
    v_mfma_f32_16x16x32_bf16 v[212:215], a[232:235], v[120:123], v[212:215]
    v_exp_f32 v210, v210
    v_mfma_f32_16x16x32_bf16 v[212:215], a[236:239], v[124:127], v[212:215]
    v_exp_f32 v211, v211
    v_mfma_f32_16x16x32_bf16 a[56:59], a[184:187], v[176:179], a[56:59]
    ds_read_b64_tr_b16 a[168:169], v25 offset:16384
    v_cvt_pk_bf16_f32 v146, v208, v209
    v_mfma_f32_16x16x32_bf16 a[56:59], a[188:191], v[180:183], a[56:59]
    ds_read_b64_tr_b16 a[170:171], v25 offset:20480
    v_mfma_f32_16x16x32_bf16 a[60:63], a[184:187], v[184:187], a[60:63]
    ds_read_b128 a[224:227], v8 offset:45056
    v_cvt_pk_bf16_f32 v147, v210, v211
    v_mfma_f32_16x16x32_bf16 a[60:63], a[188:191], v[188:191], a[60:63]
    s_waitcnt lgkmcnt(3)
    buffer_load_dwordx4 v40, s[12:15], s41 offen offset:2048 lds
    v_mfma_f32_16x16x32_bf16 v[208:211], a[208:211], v[64:67], v[192:195]
    v_exp_f32 v212, v212
    v_mfma_f32_16x16x32_bf16 v[208:211], a[212:215], v[68:71], v[208:211]
    v_exp_f32 v213, v213
    v_mfma_f32_16x16x32_bf16 v[208:211], a[216:219], v[72:75], v[208:211]
    v_exp_f32 v214, v214
    v_mfma_f32_16x16x32_bf16 v[208:211], a[220:223], v[76:79], v[208:211]
    v_exp_f32 v215, v215
    v_mfma_f32_16x16x32_bf16 a[64:67], a[160:163], v[160:163], a[64:67]
    ds_read_b64_tr_b16 a[172:173], v25 offset:24576
    v_cvt_pk_bf16_f32 v154, v212, v213
    v_mfma_f32_16x16x32_bf16 a[64:67], a[164:167], v[164:167], a[64:67]
    ds_read_b64_tr_b16 a[174:175], v25 offset:28672
    v_mfma_f32_16x16x32_bf16 a[68:71], a[160:163], v[168:171], a[68:71]
    ds_read_b128 a[228:231], v9 offset:45056
    v_cvt_pk_bf16_f32 v155, v214, v215
    v_mfma_f32_16x16x32_bf16 a[68:71], a[164:167], v[172:175], a[68:71]
    v_smfmac_f32_16x16x64_bf16 a[204:207], v[52:55], v[184:191], v50
    v_mfma_f32_16x16x32_bf16 v[212:215], a[208:211], v[80:83], v[196:199]
    v_exp_f32 v208, v208
    v_mfma_f32_16x16x32_bf16 v[212:215], a[212:215], v[84:87], v[212:215]
    v_exp_f32 v209, v209
    v_mfma_f32_16x16x32_bf16 v[212:215], a[216:219], v[88:91], v[212:215]
    v_exp_f32 v210, v210
    v_mfma_f32_16x16x32_bf16 v[212:215], a[220:223], v[92:95], v[212:215]
    v_exp_f32 v211, v211
    v_mfma_f32_16x16x32_bf16 a[72:75], a[160:163], v[176:179], a[72:75]
    ds_read_b64_tr_b16 a[176:177], v26 offset:16384
    v_cvt_pk_bf16_f32 v132, v208, v209
    v_mfma_f32_16x16x32_bf16 a[72:75], a[164:167], v[180:183], a[72:75]
    ds_read_b64_tr_b16 a[178:179], v26 offset:20480
    v_mfma_f32_16x16x32_bf16 a[76:79], a[160:163], v[184:187], a[76:79]
    ds_read_b128 a[232:235], v10 offset:45056
    v_cvt_pk_bf16_f32 v133, v210, v211
    v_mfma_f32_16x16x32_bf16 a[76:79], a[164:167], v[188:191], a[76:79]
    s_waitcnt lgkmcnt(3)
    buffer_load_dwordx4 v41, s[12:15], s41 offen offset:3072 lds
    v_mfma_f32_16x16x32_bf16 v[208:211], a[208:211], v[96:99], v[200:203]
    v_exp_f32 v212, v212
    v_mfma_f32_16x16x32_bf16 v[208:211], a[212:215], v[100:103], v[208:211]
    s_add_u32 s41, s41, 16384
    v_exp_f32 v213, v213
    v_mfma_f32_16x16x32_bf16 v[208:211], a[216:219], v[104:107], v[208:211]
    v_exp_f32 v214, v214
    v_mfma_f32_16x16x32_bf16 v[208:211], a[220:223], v[108:111], v[208:211]
    v_exp_f32 v215, v215
    v_mfma_f32_16x16x32_bf16 a[80:83], a[168:171], v[160:163], a[80:83]
    ds_read_b64_tr_b16 a[180:181], v26 offset:24576
    v_cvt_pk_bf16_f32 v140, v212, v213
    v_mfma_f32_16x16x32_bf16 a[80:83], a[172:175], v[164:167], a[80:83]
    ds_read_b64_tr_b16 a[182:183], v26 offset:28672
    v_mfma_f32_16x16x32_bf16 a[84:87], a[168:171], v[168:171], a[84:87]
    ds_read_b128 a[236:239], v11 offset:45056
    v_cvt_pk_bf16_f32 v141, v214, v215
    v_mfma_f32_16x16x32_bf16 a[84:87], a[172:175], v[172:175], a[84:87]
    s_waitcnt vmcnt(9)
    s_barrier
    v_mfma_f32_16x16x32_bf16 v[212:215], a[208:211], v[112:115], v[204:207]
    v_exp_f32 v208, v208
    v_mfma_f32_16x16x32_bf16 v[212:215], a[212:215], v[116:119], v[212:215]
    s_add_u32 m0, s42, 16384
    v_exp_f32 v209, v209
    v_mfma_f32_16x16x32_bf16 v[212:215], a[216:219], v[120:123], v[212:215]
    v_exp_f32 v210, v210
    v_mfma_f32_16x16x32_bf16 v[212:215], a[220:223], v[124:127], v[212:215]
    v_exp_f32 v211, v211
    v_mfma_f32_16x16x32_bf16 a[88:91], a[168:171], v[176:179], a[88:91]
    ds_read_b64_tr_b16 a[184:185], v27 offset:16384
    v_cvt_pk_bf16_f32 v148, v208, v209
    v_mfma_f32_16x16x32_bf16 a[88:91], a[172:175], v[180:183], a[88:91]
    ds_read_b64_tr_b16 a[186:187], v27 offset:20480
    v_mfma_f32_16x16x32_bf16 a[92:95], a[168:171], v[184:187], a[92:95]
    ds_read_b128 a[208:211], v8 offset:49152
    v_cvt_pk_bf16_f32 v149, v210, v211
    v_mfma_f32_16x16x32_bf16 a[92:95], a[172:175], v[188:191], a[92:95]
    s_waitcnt lgkmcnt(3)
    buffer_load_dwordx4 v36, s[8:11], s40 offen lds
    v_mfma_f32_16x16x32_bf16 v[208:211], a[224:227], v[64:67], v[192:195]
    v_exp_f32 v212, v212
    v_mfma_f32_16x16x32_bf16 v[208:211], a[228:231], v[68:71], v[208:211]
    v_exp_f32 v213, v213
    v_mfma_f32_16x16x32_bf16 v[208:211], a[232:235], v[72:75], v[208:211]
    v_exp_f32 v214, v214
    v_mfma_f32_16x16x32_bf16 v[208:211], a[236:239], v[76:79], v[208:211]
    v_exp_f32 v215, v215
    v_mfma_f32_16x16x32_bf16 a[96:99], a[176:179], v[160:163], a[96:99]
    ds_read_b64_tr_b16 a[188:189], v27 offset:24576
    v_cvt_pk_bf16_f32 v156, v212, v213
    v_mfma_f32_16x16x32_bf16 a[96:99], a[180:183], v[164:167], a[96:99]
    ds_read_b64_tr_b16 a[190:191], v27 offset:28672
    v_mfma_f32_16x16x32_bf16 a[100:103], a[176:179], v[168:171], a[100:103]
    ds_read_b128 a[212:215], v9 offset:49152
    v_cvt_pk_bf16_f32 v157, v214, v215
    v_mfma_f32_16x16x32_bf16 a[100:103], a[180:183], v[172:175], a[100:103]
    buffer_load_dword v218, v57, s[80:83], s39 offen
    v_mfma_f32_16x16x32_bf16 v[212:215], a[224:227], v[80:83], v[196:199]
    v_exp_f32 v208, v208
    v_mfma_f32_16x16x32_bf16 v[212:215], a[228:231], v[84:87], v[212:215]
    v_exp_f32 v209, v209
    v_mfma_f32_16x16x32_bf16 v[212:215], a[232:235], v[88:91], v[212:215]
    v_exp_f32 v210, v210
    v_mfma_f32_16x16x32_bf16 v[212:215], a[236:239], v[92:95], v[212:215]
    v_exp_f32 v211, v211
    v_mfma_f32_16x16x32_bf16 a[104:107], a[176:179], v[176:179], a[104:107]
    ds_read_b64_tr_b16 a[160:161], v20 offset:32768
    v_cvt_pk_bf16_f32 v134, v208, v209
    v_mfma_f32_16x16x32_bf16 a[104:107], a[180:183], v[180:183], a[104:107]
    ds_read_b64_tr_b16 a[162:163], v20 offset:36864
    v_mfma_f32_16x16x32_bf16 a[108:111], a[176:179], v[184:187], a[108:111]
    ds_read_b128 a[216:219], v10 offset:49152
    v_cvt_pk_bf16_f32 v135, v210, v211
    v_mfma_f32_16x16x32_bf16 a[108:111], a[180:183], v[188:191], a[108:111]
    s_waitcnt lgkmcnt(3)
    buffer_load_dwordx4 v37, s[8:11], s40 offen offset:1024 lds
    v_mfma_f32_16x16x32_bf16 v[208:211], a[224:227], v[96:99], v[200:203]
    v_exp_f32 v212, v212
    v_mfma_f32_16x16x32_bf16 v[208:211], a[228:231], v[100:103], v[208:211]
    v_exp_f32 v213, v213
    v_mfma_f32_16x16x32_bf16 v[208:211], a[232:235], v[104:107], v[208:211]
    v_exp_f32 v214, v214
    v_mfma_f32_16x16x32_bf16 v[208:211], a[236:239], v[108:111], v[208:211]
    v_exp_f32 v215, v215
    v_mfma_f32_16x16x32_bf16 a[112:115], a[184:187], v[160:163], a[112:115]
    ds_read_b64_tr_b16 a[164:165], v20 offset:40960
    v_cvt_pk_bf16_f32 v142, v212, v213
    v_mfma_f32_16x16x32_bf16 a[112:115], a[188:191], v[164:167], a[112:115]
    ds_read_b64_tr_b16 a[166:167], v20 offset:45056
    v_mfma_f32_16x16x32_bf16 a[116:119], a[184:187], v[168:171], a[116:119]
    ds_read_b128 a[220:223], v11 offset:49152
    v_cvt_pk_bf16_f32 v143, v214, v215
    v_mfma_f32_16x16x32_bf16 a[116:119], a[188:191], v[172:175], a[116:119]
    buffer_store_dwordx4 v[248:251], v232, s[24:27], s53 offen sc1
    v_mfma_f32_16x16x32_bf16 v[212:215], a[224:227], v[112:115], v[204:207]
    v_exp_f32 v208, v208
    v_mfma_f32_16x16x32_bf16 v[212:215], a[228:231], v[116:119], v[212:215]
    v_exp_f32 v209, v209
    v_mfma_f32_16x16x32_bf16 v[212:215], a[232:235], v[120:123], v[212:215]
    v_exp_f32 v210, v210
    v_mfma_f32_16x16x32_bf16 v[212:215], a[236:239], v[124:127], v[212:215]
    s_add_u32 s53, s53, 656
    v_exp_f32 v211, v211
    v_mfma_f32_16x16x32_bf16 a[120:123], a[184:187], v[176:179], a[120:123]
    ds_read_b64_tr_b16 a[168:169], v21 offset:32768
    v_cvt_pk_bf16_f32 v150, v208, v209
    v_mfma_f32_16x16x32_bf16 a[120:123], a[188:191], v[180:183], a[120:123]
    ds_read_b64_tr_b16 a[170:171], v21 offset:36864
    v_mfma_f32_16x16x32_bf16 a[124:127], a[184:187], v[184:187], a[124:127]
    ds_read_b128 a[224:227], v8 offset:53248
    v_cvt_pk_bf16_f32 v151, v210, v211
    v_mfma_f32_16x16x32_bf16 a[124:127], a[188:191], v[188:191], a[124:127]
    s_waitcnt lgkmcnt(3)
    buffer_load_dwordx4 v38, s[8:11], s40 offen offset:2048 lds
    v_mfma_f32_16x16x32_bf16 v[208:211], a[208:211], v[64:67], v[192:195]
    v_exp_f32 v212, v212
    v_mfma_f32_16x16x32_bf16 v[208:211], a[212:215], v[68:71], v[208:211]
    v_exp_f32 v213, v213
    v_mfma_f32_16x16x32_bf16 v[208:211], a[216:219], v[72:75], v[208:211]
    v_exp_f32 v214, v214
    v_mfma_f32_16x16x32_bf16 v[208:211], a[220:223], v[76:79], v[208:211]
    v_exp_f32 v215, v215
    v_mfma_f32_16x16x32_bf16 a[0:3], a[160:163], v[128:131], a[0:3]
    ds_read_b64_tr_b16 a[172:173], v21 offset:40960
    v_cvt_pk_bf16_f32 v158, v212, v213
    v_mfma_f32_16x16x32_bf16 a[0:3], a[164:167], v[132:135], a[0:3]
    ds_read_b64_tr_b16 a[174:175], v21 offset:45056
    v_mfma_f32_16x16x32_bf16 a[4:7], a[160:163], v[136:139], a[4:7]
    ds_read_b128 a[228:231], v9 offset:53248
    v_cvt_pk_bf16_f32 v159, v214, v215
    v_mfma_f32_16x16x32_bf16 a[4:7], a[164:167], v[140:143], a[4:7]
    v_mfma_f32_16x16x32_bf16 v[212:215], a[208:211], v[80:83], v[196:199]
    v_exp_f32 v208, v208
    v_mfma_f32_16x16x32_bf16 v[212:215], a[212:215], v[84:87], v[212:215]
    v_exp_f32 v209, v209
    v_mfma_f32_16x16x32_bf16 v[212:215], a[216:219], v[88:91], v[212:215]
    v_exp_f32 v210, v210
    v_mfma_f32_16x16x32_bf16 v[212:215], a[220:223], v[92:95], v[212:215]
    v_exp_f32 v211, v211
    v_mfma_f32_16x16x32_bf16 a[8:11], a[160:163], v[144:147], a[8:11]
    ds_read_b64_tr_b16 a[176:177], v22 offset:32768
    v_cvt_pk_bf16_f32 v160, v208, v209
    v_mfma_f32_16x16x32_bf16 a[8:11], a[164:167], v[148:151], a[8:11]
    ds_read_b64_tr_b16 a[178:179], v22 offset:36864
    v_mfma_f32_16x16x32_bf16 a[12:15], a[160:163], v[152:155], a[12:15]
    ds_read_b128 a[232:235], v10 offset:53248
    v_cvt_pk_bf16_f32 v161, v210, v211
    v_mfma_f32_16x16x32_bf16 a[12:15], a[164:167], v[156:159], a[12:15]
    s_waitcnt lgkmcnt(3)
    buffer_load_dwordx4 v39, s[8:11], s40 offen offset:3072 lds
    v_mfma_f32_16x16x32_bf16 v[208:211], a[208:211], v[96:99], v[200:203]
    v_exp_f32 v212, v212
    v_mfma_f32_16x16x32_bf16 v[208:211], a[212:215], v[100:103], v[208:211]
    s_add_u32 s40, s40, 16384
    v_exp_f32 v213, v213
    v_mfma_f32_16x16x32_bf16 v[208:211], a[216:219], v[104:107], v[208:211]
    v_exp_f32 v214, v214
    v_mfma_f32_16x16x32_bf16 v[208:211], a[220:223], v[108:111], v[208:211]
    v_exp_f32 v215, v215
    v_mfma_f32_16x16x32_bf16 a[16:19], a[168:171], v[128:131], a[16:19]
    ds_read_b64_tr_b16 a[180:181], v22 offset:40960
    v_cvt_pk_bf16_f32 v168, v212, v213
    v_mfma_f32_16x16x32_bf16 a[16:19], a[172:175], v[132:135], a[16:19]
    ds_read_b64_tr_b16 a[182:183], v22 offset:45056
    v_mfma_f32_16x16x32_bf16 a[20:23], a[168:171], v[136:139], a[20:23]
    ds_read_b128 a[236:239], v11 offset:53248
    v_cvt_pk_bf16_f32 v169, v214, v215
    v_mfma_f32_16x16x32_bf16 a[20:23], a[172:175], v[140:143], a[20:23]
    v_smfmac_f32_16x16x64_bf16 a[192:195], v[52:55], v[128:135], v50
    v_mfma_f32_16x16x32_bf16 v[212:215], a[208:211], v[112:115], v[204:207]
    v_exp_f32 v208, v208
    v_mfma_f32_16x16x32_bf16 v[212:215], a[212:215], v[116:119], v[212:215]
    s_add_u32 m0, s42, 65536
    v_exp_f32 v209, v209
    v_mfma_f32_16x16x32_bf16 v[212:215], a[216:219], v[120:123], v[212:215]
    v_exp_f32 v210, v210
    v_mfma_f32_16x16x32_bf16 v[212:215], a[220:223], v[124:127], v[212:215]
    v_exp_f32 v211, v211
    v_mfma_f32_16x16x32_bf16 a[24:27], a[168:171], v[144:147], a[24:27]
    ds_read_b64_tr_b16 a[184:185], v23 offset:32768
    v_cvt_pk_bf16_f32 v176, v208, v209
    v_mfma_f32_16x16x32_bf16 a[24:27], a[172:175], v[148:151], a[24:27]
    ds_read_b64_tr_b16 a[186:187], v23 offset:36864
    v_mfma_f32_16x16x32_bf16 a[28:31], a[168:171], v[152:155], a[28:31]
    ds_read_b128 a[208:211], v8 offset:57344
    v_cvt_pk_bf16_f32 v177, v210, v211
    v_mfma_f32_16x16x32_bf16 a[28:31], a[172:175], v[156:159], a[28:31]
    s_waitcnt lgkmcnt(3)
    buffer_load_dwordx4 v40, s[12:15], s41 offen lds
    v_mfma_f32_16x16x32_bf16 v[208:211], a[224:227], v[64:67], v[192:195]
    v_exp_f32 v212, v212
    v_mfma_f32_16x16x32_bf16 v[208:211], a[228:231], v[68:71], v[208:211]
    v_exp_f32 v213, v213
    v_mfma_f32_16x16x32_bf16 v[208:211], a[232:235], v[72:75], v[208:211]
    v_exp_f32 v214, v214
    v_mfma_f32_16x16x32_bf16 v[208:211], a[236:239], v[76:79], v[208:211]
    v_exp_f32 v215, v215
    v_mfma_f32_16x16x32_bf16 a[32:35], a[176:179], v[128:131], a[32:35]
    ds_read_b64_tr_b16 a[188:189], v23 offset:40960
    v_cvt_pk_bf16_f32 v184, v212, v213
    v_mfma_f32_16x16x32_bf16 a[32:35], a[180:183], v[132:135], a[32:35]
    ds_read_b64_tr_b16 a[190:191], v23 offset:45056
    v_mfma_f32_16x16x32_bf16 a[36:39], a[176:179], v[136:139], a[36:39]
    ds_read_b128 a[212:215], v9 offset:57344
    v_cvt_pk_bf16_f32 v185, v214, v215
    v_mfma_f32_16x16x32_bf16 a[36:39], a[180:183], v[140:143], a[36:39]
    v_smfmac_f32_16x16x64_bf16 a[196:199], v[52:55], v[136:143], v50
    v_mfma_f32_16x16x32_bf16 v[212:215], a[224:227], v[80:83], v[196:199]
    v_exp_f32 v208, v208
    v_mfma_f32_16x16x32_bf16 v[212:215], a[228:231], v[84:87], v[212:215]
    v_exp_f32 v209, v209
    v_mfma_f32_16x16x32_bf16 v[212:215], a[232:235], v[88:91], v[212:215]
    v_exp_f32 v210, v210
    v_mfma_f32_16x16x32_bf16 v[212:215], a[236:239], v[92:95], v[212:215]
    v_exp_f32 v211, v211
    v_mfma_f32_16x16x32_bf16 a[40:43], a[176:179], v[144:147], a[40:43]
    ds_read_b64_tr_b16 a[160:161], v24 offset:32768
    v_cvt_pk_bf16_f32 v162, v208, v209
    v_mfma_f32_16x16x32_bf16 a[40:43], a[180:183], v[148:151], a[40:43]
    ds_read_b64_tr_b16 a[162:163], v24 offset:36864
    v_mfma_f32_16x16x32_bf16 a[44:47], a[176:179], v[152:155], a[44:47]
    ds_read_b128 a[216:219], v10 offset:57344
    v_cvt_pk_bf16_f32 v163, v210, v211
    v_mfma_f32_16x16x32_bf16 a[44:47], a[180:183], v[156:159], a[44:47]
    s_waitcnt lgkmcnt(3)
    buffer_load_dwordx4 v41, s[12:15], s41 offen offset:1024 lds
    v_mfma_f32_16x16x32_bf16 v[208:211], a[224:227], v[96:99], v[200:203]
    v_exp_f32 v212, v212
    v_mfma_f32_16x16x32_bf16 v[208:211], a[228:231], v[100:103], v[208:211]
    v_exp_f32 v213, v213
    v_mfma_f32_16x16x32_bf16 v[208:211], a[232:235], v[104:107], v[208:211]
    v_exp_f32 v214, v214
    v_mfma_f32_16x16x32_bf16 v[208:211], a[236:239], v[108:111], v[208:211]
    v_exp_f32 v215, v215
    v_mfma_f32_16x16x32_bf16 a[48:51], a[184:187], v[128:131], a[48:51]
    ds_read_b64_tr_b16 a[164:165], v24 offset:40960
    v_cvt_pk_bf16_f32 v170, v212, v213
    v_mfma_f32_16x16x32_bf16 a[48:51], a[188:191], v[132:135], a[48:51]
    ds_read_b64_tr_b16 a[166:167], v24 offset:45056
    v_mfma_f32_16x16x32_bf16 a[52:55], a[184:187], v[136:139], a[52:55]
    ds_read_b128 a[220:223], v11 offset:57344
    v_cvt_pk_bf16_f32 v171, v214, v215
    v_mfma_f32_16x16x32_bf16 a[52:55], a[188:191], v[140:143], a[52:55]
    v_smfmac_f32_16x16x64_bf16 a[200:203], v[52:55], v[144:151], v50
    v_mfma_f32_16x16x32_bf16 v[212:215], a[224:227], v[112:115], v[204:207]
    v_exp_f32 v208, v208
    v_mfma_f32_16x16x32_bf16 v[212:215], a[228:231], v[116:119], v[212:215]
    v_exp_f32 v209, v209
    v_mfma_f32_16x16x32_bf16 v[212:215], a[232:235], v[120:123], v[212:215]
    v_exp_f32 v210, v210
    v_mfma_f32_16x16x32_bf16 v[212:215], a[236:239], v[124:127], v[212:215]
    v_exp_f32 v211, v211
    v_mfma_f32_16x16x32_bf16 a[56:59], a[184:187], v[144:147], a[56:59]
    ds_read_b64_tr_b16 a[168:169], v25 offset:32768
    v_cvt_pk_bf16_f32 v178, v208, v209
    v_mfma_f32_16x16x32_bf16 a[56:59], a[188:191], v[148:151], a[56:59]
    ds_read_b64_tr_b16 a[170:171], v25 offset:36864
    v_mfma_f32_16x16x32_bf16 a[60:63], a[184:187], v[152:155], a[60:63]
    ds_read_b128 a[224:227], v8 offset:61440
    v_cvt_pk_bf16_f32 v179, v210, v211
    v_mfma_f32_16x16x32_bf16 a[60:63], a[188:191], v[156:159], a[60:63]
    s_waitcnt lgkmcnt(3)
    buffer_load_dwordx4 v40, s[12:15], s41 offen offset:2048 lds
    v_mfma_f32_16x16x32_bf16 v[208:211], a[208:211], v[64:67], v[192:195]
    v_exp_f32 v212, v212
    v_mfma_f32_16x16x32_bf16 v[208:211], a[212:215], v[68:71], v[208:211]
    v_exp_f32 v213, v213
    v_mfma_f32_16x16x32_bf16 v[208:211], a[216:219], v[72:75], v[208:211]
    v_exp_f32 v214, v214
    v_mfma_f32_16x16x32_bf16 v[208:211], a[220:223], v[76:79], v[208:211]
    v_exp_f32 v215, v215
    v_mfma_f32_16x16x32_bf16 a[64:67], a[160:163], v[128:131], a[64:67]
    ds_read_b64_tr_b16 a[172:173], v25 offset:40960
    v_cvt_pk_bf16_f32 v186, v212, v213
    v_mfma_f32_16x16x32_bf16 a[64:67], a[164:167], v[132:135], a[64:67]
    ds_read_b64_tr_b16 a[174:175], v25 offset:45056
    v_mfma_f32_16x16x32_bf16 a[68:71], a[160:163], v[136:139], a[68:71]
    ds_read_b128 a[228:231], v9 offset:61440
    v_cvt_pk_bf16_f32 v187, v214, v215
    v_mfma_f32_16x16x32_bf16 a[68:71], a[164:167], v[140:143], a[68:71]
    v_smfmac_f32_16x16x64_bf16 a[204:207], v[52:55], v[152:159], v50
    v_mfma_f32_16x16x32_bf16 v[212:215], a[208:211], v[80:83], v[196:199]
    v_exp_f32 v208, v208
    v_mfma_f32_16x16x32_bf16 v[212:215], a[212:215], v[84:87], v[212:215]
    v_exp_f32 v209, v209
    v_mfma_f32_16x16x32_bf16 v[212:215], a[216:219], v[88:91], v[212:215]
    v_exp_f32 v210, v210
    v_mfma_f32_16x16x32_bf16 v[212:215], a[220:223], v[92:95], v[212:215]
    v_exp_f32 v211, v211
    v_mfma_f32_16x16x32_bf16 a[72:75], a[160:163], v[144:147], a[72:75]
    ds_read_b64_tr_b16 a[176:177], v26 offset:32768
    v_cvt_pk_bf16_f32 v164, v208, v209
    v_mfma_f32_16x16x32_bf16 a[72:75], a[164:167], v[148:151], a[72:75]
    ds_read_b64_tr_b16 a[178:179], v26 offset:36864
    v_mfma_f32_16x16x32_bf16 a[76:79], a[160:163], v[152:155], a[76:79]
    ds_read_b128 a[232:235], v10 offset:61440
    v_cvt_pk_bf16_f32 v165, v210, v211
    v_mfma_f32_16x16x32_bf16 a[76:79], a[164:167], v[156:159], a[76:79]
    s_waitcnt lgkmcnt(3)
    buffer_load_dwordx4 v41, s[12:15], s41 offen offset:3072 lds
    v_mfma_f32_16x16x32_bf16 v[208:211], a[208:211], v[96:99], v[200:203]
    v_exp_f32 v212, v212
    v_mfma_f32_16x16x32_bf16 v[208:211], a[212:215], v[100:103], v[208:211]
    s_add_u32 s41, s41, 16384
    v_exp_f32 v213, v213
    v_mfma_f32_16x16x32_bf16 v[208:211], a[216:219], v[104:107], v[208:211]
    v_exp_f32 v214, v214
    v_mfma_f32_16x16x32_bf16 v[208:211], a[220:223], v[108:111], v[208:211]
    v_exp_f32 v215, v215
    v_mfma_f32_16x16x32_bf16 a[80:83], a[168:171], v[128:131], a[80:83]
    ds_read_b64_tr_b16 a[180:181], v26 offset:40960
    v_cvt_pk_bf16_f32 v172, v212, v213
    v_mfma_f32_16x16x32_bf16 a[80:83], a[172:175], v[132:135], a[80:83]
    ds_read_b64_tr_b16 a[182:183], v26 offset:45056
    v_mfma_f32_16x16x32_bf16 a[84:87], a[168:171], v[136:139], a[84:87]
    ds_read_b128 a[236:239], v11 offset:61440
    v_cvt_pk_bf16_f32 v173, v214, v215
    v_mfma_f32_16x16x32_bf16 a[84:87], a[172:175], v[140:143], a[84:87]
    s_waitcnt vmcnt(10)
    s_barrier
    v_mfma_f32_16x16x32_bf16 v[212:215], a[208:211], v[112:115], v[204:207]
    v_exp_f32 v208, v208
    v_mfma_f32_16x16x32_bf16 v[212:215], a[212:215], v[116:119], v[212:215]
    s_add_u32 m0, s42, 32768
    v_exp_f32 v209, v209
    v_mfma_f32_16x16x32_bf16 v[212:215], a[216:219], v[120:123], v[212:215]
    v_exp_f32 v210, v210
    v_mfma_f32_16x16x32_bf16 v[212:215], a[220:223], v[124:127], v[212:215]
    v_exp_f32 v211, v211
    v_mfma_f32_16x16x32_bf16 a[88:91], a[168:171], v[144:147], a[88:91]
    ds_read_b64_tr_b16 a[184:185], v27 offset:32768
    v_cvt_pk_bf16_f32 v180, v208, v209
    v_mfma_f32_16x16x32_bf16 a[88:91], a[172:175], v[148:151], a[88:91]
    ds_read_b64_tr_b16 a[186:187], v27 offset:36864
    v_mfma_f32_16x16x32_bf16 a[92:95], a[168:171], v[152:155], a[92:95]
    ds_read_b128 a[208:211], v8 offset:0
    v_cvt_pk_bf16_f32 v181, v210, v211
    v_mfma_f32_16x16x32_bf16 a[92:95], a[172:175], v[156:159], a[92:95]
    s_waitcnt lgkmcnt(3)
    buffer_load_dwordx4 v36, s[8:11], s40 offen lds
    v_mfma_f32_16x16x32_bf16 v[208:211], a[224:227], v[64:67], v[192:195]
    v_exp_f32 v212, v212
    v_mfma_f32_16x16x32_bf16 v[208:211], a[228:231], v[68:71], v[208:211]
    v_exp_f32 v213, v213
    v_mfma_f32_16x16x32_bf16 v[208:211], a[232:235], v[72:75], v[208:211]
    v_exp_f32 v214, v214
    v_mfma_f32_16x16x32_bf16 v[208:211], a[236:239], v[76:79], v[208:211]
    v_exp_f32 v215, v215
    v_mfma_f32_16x16x32_bf16 a[96:99], a[176:179], v[128:131], a[96:99]
    ds_read_b64_tr_b16 a[188:189], v27 offset:40960
    v_cvt_pk_bf16_f32 v188, v212, v213
    v_mfma_f32_16x16x32_bf16 a[96:99], a[180:183], v[132:135], a[96:99]
    ds_read_b64_tr_b16 a[190:191], v27 offset:45056
    v_mfma_f32_16x16x32_bf16 a[100:103], a[176:179], v[136:139], a[100:103]
    ds_read_b128 a[212:215], v9 offset:0
    v_cvt_pk_bf16_f32 v189, v214, v215
    v_mfma_f32_16x16x32_bf16 a[100:103], a[180:183], v[140:143], a[100:103]
    buffer_load_dword v219, v62, s[84:87], s38 offen
    v_mfma_f32_16x16x32_bf16 v[212:215], a[224:227], v[80:83], v[196:199]
    v_exp_f32 v208, v208
    v_mfma_f32_16x16x32_bf16 v[212:215], a[228:231], v[84:87], v[212:215]
    v_exp_f32 v209, v209
    v_mfma_f32_16x16x32_bf16 v[212:215], a[232:235], v[88:91], v[212:215]
    v_exp_f32 v210, v210
    v_mfma_f32_16x16x32_bf16 v[212:215], a[236:239], v[92:95], v[212:215]
    v_exp_f32 v211, v211
    v_mfma_f32_16x16x32_bf16 a[104:107], a[176:179], v[144:147], a[104:107]
    ds_read_b64_tr_b16 a[160:161], v20 offset:49152
    v_cvt_pk_bf16_f32 v166, v208, v209
    v_mfma_f32_16x16x32_bf16 a[104:107], a[180:183], v[148:151], a[104:107]
    ds_read_b64_tr_b16 a[162:163], v20 offset:53248
    v_mfma_f32_16x16x32_bf16 a[108:111], a[176:179], v[152:155], a[108:111]
    ds_read_b128 a[216:219], v10 offset:0
    v_cvt_pk_bf16_f32 v167, v210, v211
    v_mfma_f32_16x16x32_bf16 a[108:111], a[180:183], v[156:159], a[108:111]
    s_waitcnt lgkmcnt(3)
    buffer_load_dwordx4 v37, s[8:11], s40 offen offset:1024 lds
    v_mfma_f32_16x16x32_bf16 v[208:211], a[224:227], v[96:99], v[200:203]
    v_exp_f32 v212, v212
    v_mfma_f32_16x16x32_bf16 v[208:211], a[228:231], v[100:103], v[208:211]
    v_exp_f32 v213, v213
    v_mfma_f32_16x16x32_bf16 v[208:211], a[232:235], v[104:107], v[208:211]
    v_exp_f32 v214, v214
    v_mfma_f32_16x16x32_bf16 v[208:211], a[236:239], v[108:111], v[208:211]
    v_exp_f32 v215, v215
    v_mfma_f32_16x16x32_bf16 a[112:115], a[184:187], v[128:131], a[112:115]
    ds_read_b64_tr_b16 a[164:165], v20 offset:57344
    v_cvt_pk_bf16_f32 v174, v212, v213
    v_mfma_f32_16x16x32_bf16 a[112:115], a[188:191], v[132:135], a[112:115]
    ds_read_b64_tr_b16 a[166:167], v20 offset:61440
    v_mfma_f32_16x16x32_bf16 a[116:119], a[184:187], v[136:139], a[116:119]
    ds_read_b128 a[220:223], v11 offset:0
    v_cvt_pk_bf16_f32 v175, v214, v215
    v_mfma_f32_16x16x32_bf16 a[116:119], a[188:191], v[140:143], a[116:119]
    buffer_load_dword v221, v235, s[20:23], 0 offen
    v_mfma_f32_16x16x32_bf16 v[212:215], a[224:227], v[112:115], v[204:207]
    v_exp_f32 v208, v208
    v_mfma_f32_16x16x32_bf16 v[212:215], a[228:231], v[116:119], v[212:215]
    v_exp_f32 v209, v209
    v_mfma_f32_16x16x32_bf16 v[212:215], a[232:235], v[120:123], v[212:215]
    v_exp_f32 v210, v210
    v_mfma_f32_16x16x32_bf16 v[212:215], a[236:239], v[124:127], v[212:215]
    v_exp_f32 v211, v211
    v_mfma_f32_16x16x32_bf16 a[120:123], a[184:187], v[144:147], a[120:123]
    ds_read_b64_tr_b16 a[168:169], v21 offset:49152
    v_cvt_pk_bf16_f32 v182, v208, v209
    v_mfma_f32_16x16x32_bf16 a[120:123], a[188:191], v[148:151], a[120:123]
    ds_read_b64_tr_b16 a[170:171], v21 offset:53248
    v_add_u32 v235, 2560, v235
    v_mfma_f32_16x16x32_bf16 a[124:127], a[184:187], v[152:155], a[124:127]
    ds_read_b128 a[224:227], v8 offset:4096
    v_cvt_pk_bf16_f32 v183, v210, v211
    v_mfma_f32_16x16x32_bf16 a[124:127], a[188:191], v[156:159], a[124:127]
    s_waitcnt lgkmcnt(3)
    buffer_load_dwordx4 v38, s[8:11], s40 offen offset:2048 lds
    v_mfma_f32_16x16x32_bf16 v[208:211], a[208:211], v[64:67], v[192:195]
    v_exp_f32 v212, v212
    v_mfma_f32_16x16x32_bf16 v[208:211], a[212:215], v[68:71], v[208:211]
    v_exp_f32 v213, v213
    v_mfma_f32_16x16x32_bf16 v[208:211], a[216:219], v[72:75], v[208:211]
    v_exp_f32 v214, v214
    v_mfma_f32_16x16x32_bf16 v[208:211], a[220:223], v[76:79], v[208:211]
    v_exp_f32 v215, v215
    v_mfma_f32_16x16x32_bf16 a[0:3], a[160:163], v[160:163], a[0:3]
    ds_read_b64_tr_b16 a[172:173], v21 offset:57344
    v_cvt_pk_bf16_f32 v190, v212, v213
    v_mfma_f32_16x16x32_bf16 a[0:3], a[164:167], v[164:167], a[0:3]
    ds_read_b64_tr_b16 a[174:175], v21 offset:61440
    v_lshlrev_b32 v244, 16, v240
    v_mfma_f32_16x16x32_bf16 a[4:7], a[160:163], v[168:171], a[4:7]
    ds_read_b128 a[228:231], v9 offset:4096
    v_cvt_pk_bf16_f32 v191, v214, v215
    v_mfma_f32_16x16x32_bf16 a[4:7], a[164:167], v[172:175], a[4:7]
    v_and_b32 v245, 0xffff0000, v240
    v_fmac_f32 v224, v2, v244
    v_mfma_f32_16x16x32_bf16 v[212:215], a[208:211], v[80:83], v[196:199]
    v_exp_f32 v208, v208
    v_mfma_f32_16x16x32_bf16 v[212:215], a[212:215], v[84:87], v[212:215]
    v_exp_f32 v209, v209
    v_mfma_f32_16x16x32_bf16 v[212:215], a[216:219], v[88:91], v[212:215]
    v_exp_f32 v210, v210
    v_mfma_f32_16x16x32_bf16 v[212:215], a[220:223], v[92:95], v[212:215]
    v_exp_f32 v211, v211
    v_mfma_f32_16x16x32_bf16 a[8:11], a[160:163], v[176:179], a[8:11]
    ds_read_b64_tr_b16 a[176:177], v22 offset:49152
    v_cvt_pk_bf16_f32 v128, v208, v209
    v_mfma_f32_16x16x32_bf16 a[8:11], a[164:167], v[180:183], a[8:11]
    ds_read_b64_tr_b16 a[178:179], v22 offset:53248
    v_fmac_f32 v225, v2, v245
    v_mfma_f32_16x16x32_bf16 a[12:15], a[160:163], v[184:187], a[12:15]
    ds_read_b128 a[232:235], v10 offset:4096
    v_cvt_pk_bf16_f32 v129, v210, v211
    v_mfma_f32_16x16x32_bf16 a[12:15], a[164:167], v[188:191], a[12:15]
    s_waitcnt lgkmcnt(3)
    buffer_load_dwordx4 v39, s[8:11], s40 offen offset:3072 lds
    v_mfma_f32_16x16x32_bf16 v[208:211], a[208:211], v[96:99], v[200:203]
Ltour5:
    s_cbranch_execz Ltour9
    v_exp_f32 v212, v212
    v_mfma_f32_16x16x32_bf16 v[208:211], a[212:215], v[100:103], v[208:211]
    s_add_u32 s40, s40, 16384
    v_exp_f32 v213, v213
    v_mfma_f32_16x16x32_bf16 v[208:211], a[216:219], v[104:107], v[208:211]
    v_exp_f32 v214, v214
    v_mfma_f32_16x16x32_bf16 v[208:211], a[220:223], v[108:111], v[208:211]
    v_exp_f32 v215, v215
    v_mfma_f32_16x16x32_bf16 a[16:19], a[168:171], v[160:163], a[16:19]
    ds_read_b64_tr_b16 a[180:181], v22 offset:57344
    v_cvt_pk_bf16_f32 v136, v212, v213
    v_mfma_f32_16x16x32_bf16 a[16:19], a[172:175], v[164:167], a[16:19]
    ds_read_b64_tr_b16 a[182:183], v22 offset:61440
    v_lshlrev_b32 v246, 16, v241
    v_mfma_f32_16x16x32_bf16 a[20:23], a[168:171], v[168:171], a[20:23]
    ds_read_b128 a[236:239], v11 offset:4096
    v_cvt_pk_bf16_f32 v137, v214, v215
    v_mfma_f32_16x16x32_bf16 a[20:23], a[172:175], v[172:175], a[20:23]
    v_and_b32 v247, 0xffff0000, v241
    v_fmac_f32 v226, v2, v246
    v_smfmac_f32_16x16x64_bf16 a[192:195], v[52:55], v[160:167], v50
    v_mfma_f32_16x16x32_bf16 v[212:215], a[208:211], v[112:115], v[204:207]
    v_exp_f32 v208, v208
    v_mfma_f32_16x16x32_bf16 v[212:215], a[212:215], v[116:119], v[212:215]
    s_add_u32 m0, s42, 81920
    v_exp_f32 v209, v209
    v_mfma_f32_16x16x32_bf16 v[212:215], a[216:219], v[120:123], v[212:215]
    v_exp_f32 v210, v210
    v_mfma_f32_16x16x32_bf16 v[212:215], a[220:223], v[124:127], v[212:215]
    v_exp_f32 v211, v211
    v_mfma_f32_16x16x32_bf16 a[24:27], a[168:171], v[176:179], a[24:27]
    ds_read_b64_tr_b16 a[184:185], v23 offset:49152
    v_cvt_pk_bf16_f32 v144, v208, v209
    v_mfma_f32_16x16x32_bf16 a[24:27], a[172:175], v[180:183], a[24:27]
    ds_read_b64_tr_b16 a[186:187], v23 offset:53248
    v_fmac_f32 v227, v2, v247
    v_mfma_f32_16x16x32_bf16 a[28:31], a[168:171], v[184:187], a[28:31]
    ds_read_b128 a[208:211], v8 offset:8192
    v_cvt_pk_bf16_f32 v145, v210, v211
    v_mfma_f32_16x16x32_bf16 a[28:31], a[172:175], v[188:191], a[28:31]
    s_waitcnt lgkmcnt(3)
    buffer_load_dwordx4 v40, s[12:15], s41 offen lds
    v_mfma_f32_16x16x32_bf16 v[208:211], a[224:227], v[64:67], v[192:195]
    v_exp_f32 v212, v212
    v_mfma_f32_16x16x32_bf16 v[208:211], a[228:231], v[68:71], v[208:211]
    v_exp_f32 v213, v213
    v_mfma_f32_16x16x32_bf16 v[208:211], a[232:235], v[72:75], v[208:211]
    v_exp_f32 v214, v214
    v_mfma_f32_16x16x32_bf16 v[208:211], a[236:239], v[76:79], v[208:211]
    v_exp_f32 v215, v215
    v_mfma_f32_16x16x32_bf16 a[32:35], a[176:179], v[160:163], a[32:35]
    ds_read_b64_tr_b16 a[188:189], v23 offset:57344
    v_cvt_pk_bf16_f32 v152, v212, v213
    v_mfma_f32_16x16x32_bf16 a[32:35], a[180:183], v[164:167], a[32:35]
    ds_read_b64_tr_b16 a[190:191], v23 offset:61440
    v_lshlrev_b32 v244, 16, v242
    v_mfma_f32_16x16x32_bf16 a[36:39], a[176:179], v[168:171], a[36:39]
    ds_read_b128 a[212:215], v9 offset:8192
    v_cvt_pk_bf16_f32 v153, v214, v215
    v_mfma_f32_16x16x32_bf16 a[36:39], a[180:183], v[172:175], a[36:39]
    v_and_b32 v245, 0xffff0000, v242
    v_fmac_f32 v228, v2, v244
    v_smfmac_f32_16x16x64_bf16 a[196:199], v[52:55], v[168:175], v50
    v_mfma_f32_16x16x32_bf16 v[212:215], a[224:227], v[80:83], v[196:199]
    v_exp_f32 v208, v208
    v_mfma_f32_16x16x32_bf16 v[212:215], a[228:231], v[84:87], v[212:215]
    v_exp_f32 v209, v209
    v_mfma_f32_16x16x32_bf16 v[212:215], a[232:235], v[88:91], v[212:215]
    v_exp_f32 v210, v210
    v_mfma_f32_16x16x32_bf16 v[212:215], a[236:239], v[92:95], v[212:215]
    v_exp_f32 v211, v211
    v_mfma_f32_16x16x32_bf16 a[40:43], a[176:179], v[176:179], a[40:43]
    ds_read_b64_tr_b16 a[160:161], v24 offset:49152
    v_cvt_pk_bf16_f32 v130, v208, v209
    v_mfma_f32_16x16x32_bf16 a[40:43], a[180:183], v[180:183], a[40:43]
    ds_read_b64_tr_b16 a[162:163], v24 offset:53248
    v_fmac_f32 v229, v2, v245
    v_mfma_f32_16x16x32_bf16 a[44:47], a[176:179], v[184:187], a[44:47]
    ds_read_b128 a[216:219], v10 offset:8192
    v_cvt_pk_bf16_f32 v131, v210, v211
    v_mfma_f32_16x16x32_bf16 a[44:47], a[180:183], v[188:191], a[44:47]
    s_waitcnt lgkmcnt(3)
    buffer_load_dwordx4 v41, s[12:15], s41 offen offset:1024 lds
    v_mfma_f32_16x16x32_bf16 v[208:211], a[224:227], v[96:99], v[200:203]
    v_exp_f32 v212, v212
    v_mfma_f32_16x16x32_bf16 v[208:211], a[228:231], v[100:103], v[208:211]
    v_exp_f32 v213, v213
    v_mfma_f32_16x16x32_bf16 v[208:211], a[232:235], v[104:107], v[208:211]
    v_exp_f32 v214, v214
    v_mfma_f32_16x16x32_bf16 v[208:211], a[236:239], v[108:111], v[208:211]
    v_exp_f32 v215, v215
    v_mfma_f32_16x16x32_bf16 a[48:51], a[184:187], v[160:163], a[48:51]
    ds_read_b64_tr_b16 a[164:165], v24 offset:57344
    v_cvt_pk_bf16_f32 v138, v212, v213
    v_mfma_f32_16x16x32_bf16 a[48:51], a[188:191], v[164:167], a[48:51]
    ds_read_b64_tr_b16 a[166:167], v24 offset:61440
    v_lshlrev_b32 v246, 16, v243
    v_mfma_f32_16x16x32_bf16 a[52:55], a[184:187], v[168:171], a[52:55]
    ds_read_b128 a[220:223], v11 offset:8192
    v_cvt_pk_bf16_f32 v139, v214, v215
    v_mfma_f32_16x16x32_bf16 a[52:55], a[188:191], v[172:175], a[52:55]
    v_and_b32 v247, 0xffff0000, v243
    v_fmac_f32 v230, v2, v246
    v_smfmac_f32_16x16x64_bf16 a[200:203], v[52:55], v[176:183], v50
    v_mfma_f32_16x16x32_bf16 v[212:215], a[224:227], v[112:115], v[204:207]
    v_exp_f32 v208, v208
    v_mfma_f32_16x16x32_bf16 v[212:215], a[228:231], v[116:119], v[212:215]
    v_exp_f32 v209, v209
    v_mfma_f32_16x16x32_bf16 v[212:215], a[232:235], v[120:123], v[212:215]
    v_exp_f32 v210, v210
    v_mfma_f32_16x16x32_bf16 v[212:215], a[236:239], v[124:127], v[212:215]
    v_exp_f32 v211, v211
    v_mfma_f32_16x16x32_bf16 a[56:59], a[184:187], v[176:179], a[56:59]
    ds_read_b64_tr_b16 a[168:169], v25 offset:49152
    v_cvt_pk_bf16_f32 v146, v208, v209
    v_mfma_f32_16x16x32_bf16 a[56:59], a[188:191], v[180:183], a[56:59]
    ds_read_b64_tr_b16 a[170:171], v25 offset:53248
    v_fmac_f32 v231, v2, v247
    v_mfma_f32_16x16x32_bf16 a[60:63], a[184:187], v[184:187], a[60:63]
    ds_read_b128 a[224:227], v8 offset:12288
    v_cvt_pk_bf16_f32 v147, v210, v211
    v_mfma_f32_16x16x32_bf16 a[60:63], a[188:191], v[188:191], a[60:63]
    s_waitcnt lgkmcnt(3)
    buffer_load_dwordx4 v40, s[12:15], s41 offen offset:2048 lds
    v_mfma_f32_16x16x32_bf16 v[208:211], a[208:211], v[64:67], v[192:195]
    v_exp_f32 v212, v212
    v_mfma_f32_16x16x32_bf16 v[208:211], a[212:215], v[68:71], v[208:211]
    v_exp_f32 v213, v213
    v_mfma_f32_16x16x32_bf16 v[208:211], a[216:219], v[72:75], v[208:211]
    v_exp_f32 v214, v214
    v_mfma_f32_16x16x32_bf16 v[208:211], a[220:223], v[76:79], v[208:211]
    v_exp_f32 v215, v215
    v_mfma_f32_16x16x32_bf16 a[64:67], a[160:163], v[160:163], a[64:67]
    ds_read_b64_tr_b16 a[172:173], v25 offset:57344
    v_cvt_pk_bf16_f32 v154, v212, v213
    v_mfma_f32_16x16x32_bf16 a[64:67], a[164:167], v[164:167], a[64:67]
    ds_read_b64_tr_b16 a[174:175], v25 offset:61440
    v_mov_b32 v2, v3
    v_mfma_f32_16x16x32_bf16 a[68:71], a[160:163], v[168:171], a[68:71]
    ds_read_b128 a[228:231], v9 offset:12288
    v_cvt_pk_bf16_f32 v155, v214, v215
    v_mfma_f32_16x16x32_bf16 a[68:71], a[164:167], v[172:175], a[68:71]
    v_mov_b32 v3, v4
    v_mov_b32 v4, v5
    v_smfmac_f32_16x16x64_bf16 a[204:207], v[52:55], v[184:191], v50
    v_mfma_f32_16x16x32_bf16 v[212:215], a[208:211], v[80:83], v[196:199]
    v_exp_f32 v208, v208
    v_mfma_f32_16x16x32_bf16 v[212:215], a[212:215], v[84:87], v[212:215]
    v_exp_f32 v209, v209
    v_mfma_f32_16x16x32_bf16 v[212:215], a[216:219], v[88:91], v[212:215]
    v_exp_f32 v210, v210
    v_mfma_f32_16x16x32_bf16 v[212:215], a[220:223], v[92:95], v[212:215]
    v_exp_f32 v211, v211
    v_mfma_f32_16x16x32_bf16 a[72:75], a[160:163], v[176:179], a[72:75]
    ds_read_b64_tr_b16 a[176:177], v26 offset:49152
    v_cvt_pk_bf16_f32 v132, v208, v209
    v_mfma_f32_16x16x32_bf16 a[72:75], a[164:167], v[180:183], a[72:75]
    ds_read_b64_tr_b16 a[178:179], v26 offset:53248
    v_mov_b32 v5, v6
    v_mfma_f32_16x16x32_bf16 a[76:79], a[160:163], v[184:187], a[76:79]
    ds_read_b128 a[232:235], v10 offset:12288
    v_cvt_pk_bf16_f32 v133, v210, v211
    v_mfma_f32_16x16x32_bf16 a[76:79], a[164:167], v[188:191], a[76:79]
    s_waitcnt lgkmcnt(3)
    buffer_load_dwordx4 v41, s[12:15], s41 offen offset:3072 lds
    v_mfma_f32_16x16x32_bf16 v[208:211], a[208:211], v[96:99], v[200:203]
    v_exp_f32 v212, v212
    v_mfma_f32_16x16x32_bf16 v[208:211], a[212:215], v[100:103], v[208:211]
    s_add_u32 s41, s41, 16384
    v_exp_f32 v213, v213
    v_mfma_f32_16x16x32_bf16 v[208:211], a[216:219], v[104:107], v[208:211]
    v_exp_f32 v214, v214
    v_mfma_f32_16x16x32_bf16 v[208:211], a[220:223], v[108:111], v[208:211]
    v_exp_f32 v215, v215
    v_mfma_f32_16x16x32_bf16 a[80:83], a[168:171], v[160:163], a[80:83]
    ds_read_b64_tr_b16 a[180:181], v26 offset:57344
    v_cvt_pk_bf16_f32 v140, v212, v213
    v_mfma_f32_16x16x32_bf16 a[80:83], a[172:175], v[164:167], a[80:83]
    ds_read_b64_tr_b16 a[182:183], v26 offset:61440
    v_mfma_f32_16x16x32_bf16 a[84:87], a[168:171], v[168:171], a[84:87]
    ds_read_b128 a[236:239], v11 offset:12288
    v_cvt_pk_bf16_f32 v141, v214, v215
    v_mfma_f32_16x16x32_bf16 a[84:87], a[172:175], v[172:175], a[84:87]
    s_waitcnt vmcnt(10)
    s_barrier
    v_mfma_f32_16x16x32_bf16 v[212:215], a[208:211], v[112:115], v[204:207]
    v_exp_f32 v208, v208
    v_mfma_f32_16x16x32_bf16 v[212:215], a[212:215], v[116:119], v[212:215]
    s_add_u32 m0, s42, 49152
    v_exp_f32 v209, v209
    v_mfma_f32_16x16x32_bf16 v[212:215], a[216:219], v[120:123], v[212:215]
    v_exp_f32 v210, v210
    v_mfma_f32_16x16x32_bf16 v[212:215], a[220:223], v[124:127], v[212:215]
    v_exp_f32 v211, v211
    v_mfma_f32_16x16x32_bf16 a[88:91], a[168:171], v[176:179], a[88:91]
    ds_read_b64_tr_b16 a[184:185], v27 offset:49152
    v_cvt_pk_bf16_f32 v148, v208, v209
    v_mfma_f32_16x16x32_bf16 a[88:91], a[172:175], v[180:183], a[88:91]
    ds_read_b64_tr_b16 a[186:187], v27 offset:53248
    v_mfma_f32_16x16x32_bf16 a[92:95], a[168:171], v[184:187], a[92:95]
    ds_read_b128 a[208:211], v8 offset:16384
    v_cvt_pk_bf16_f32 v149, v210, v211
    v_mfma_f32_16x16x32_bf16 a[92:95], a[172:175], v[188:191], a[92:95]
    s_waitcnt lgkmcnt(3)
    buffer_load_dwordx4 v36, s[8:11], s40 offen lds
    v_mfma_f32_16x16x32_bf16 v[208:211], a[224:227], v[64:67], v[192:195]
    v_exp_f32 v212, v212
    v_mfma_f32_16x16x32_bf16 v[208:211], a[228:231], v[68:71], v[208:211]
    v_exp_f32 v213, v213
    v_mfma_f32_16x16x32_bf16 v[208:211], a[232:235], v[72:75], v[208:211]
    v_exp_f32 v214, v214
    v_mfma_f32_16x16x32_bf16 v[208:211], a[236:239], v[76:79], v[208:211]
    v_exp_f32 v215, v215
    v_mfma_f32_16x16x32_bf16 a[96:99], a[176:179], v[160:163], a[96:99]
    ds_read_b64_tr_b16 a[188:189], v27 offset:57344
    v_cvt_pk_bf16_f32 v156, v212, v213
    v_mfma_f32_16x16x32_bf16 a[96:99], a[180:183], v[164:167], a[96:99]
    ds_read_b64_tr_b16 a[190:191], v27 offset:61440
    v_mfma_f32_16x16x32_bf16 a[100:103], a[176:179], v[168:171], a[100:103]
    ds_read_b128 a[212:215], v9 offset:16384
    v_cvt_pk_bf16_f32 v157, v214, v215
    v_mfma_f32_16x16x32_bf16 a[100:103], a[180:183], v[172:175], a[100:103]
    buffer_load_dword v216, v237, s[28:31], s52 offen
    v_mfma_f32_16x16x32_bf16 v[212:215], a[224:227], v[80:83], v[196:199]
    v_exp_f32 v208, v208
    v_mfma_f32_16x16x32_bf16 v[212:215], a[228:231], v[84:87], v[212:215]
    s_sub_u32 s39, s39, 36864
    v_exp_f32 v209, v209
    v_mfma_f32_16x16x32_bf16 v[212:215], a[232:235], v[88:91], v[212:215]
    s_sub_u32 s38, s38, 4608
    v_exp_f32 v210, v210
    v_mfma_f32_16x16x32_bf16 v[212:215], a[236:239], v[92:95], v[212:215]
    s_add_u32 s52, s52, 2304
    v_exp_f32 v211, v211
    v_mfma_f32_16x16x32_bf16 a[104:107], a[176:179], v[176:179], a[104:107]
    ds_read_b64_tr_b16 a[160:161], v20 offset:0
    v_cvt_pk_bf16_f32 v134, v208, v209
    v_mfma_f32_16x16x32_bf16 a[104:107], a[180:183], v[180:183], a[104:107]
    ds_read_b64_tr_b16 a[162:163], v20 offset:4096
    v_mfma_f32_16x16x32_bf16 a[108:111], a[176:179], v[184:187], a[108:111]
    ds_read_b128 a[216:219], v10 offset:16384
    v_cvt_pk_bf16_f32 v135, v210, v211
    v_mfma_f32_16x16x32_bf16 a[108:111], a[180:183], v[188:191], a[108:111]
    s_waitcnt lgkmcnt(3)
    buffer_load_dwordx4 v37, s[8:11], s40 offen offset:1024 lds
    v_mfma_f32_16x16x32_bf16 v[208:211], a[224:227], v[96:99], v[200:203]
    v_exp_f32 v212, v212
    v_mfma_f32_16x16x32_bf16 v[208:211], a[228:231], v[100:103], v[208:211]
    v_exp_f32 v213, v213
    v_mfma_f32_16x16x32_bf16 v[208:211], a[232:235], v[104:107], v[208:211]
    v_exp_f32 v214, v214
    v_mfma_f32_16x16x32_bf16 v[208:211], a[236:239], v[108:111], v[208:211]
    v_exp_f32 v215, v215
    v_mfma_f32_16x16x32_bf16 a[112:115], a[184:187], v[160:163], a[112:115]
    ds_read_b64_tr_b16 a[164:165], v20 offset:8192
    v_cvt_pk_bf16_f32 v142, v212, v213
    v_mfma_f32_16x16x32_bf16 a[112:115], a[188:191], v[164:167], a[112:115]
    ds_read_b64_tr_b16 a[166:167], v20 offset:12288
    v_mfma_f32_16x16x32_bf16 a[116:119], a[184:187], v[168:171], a[116:119]
    ds_read_b128 a[220:223], v11 offset:16384
    v_cvt_pk_bf16_f32 v143, v214, v215
    v_mfma_f32_16x16x32_bf16 a[116:119], a[188:191], v[172:175], a[116:119]
    v_mfma_f32_16x16x32_bf16 v[212:215], a[224:227], v[112:115], v[204:207]
    v_exp_f32 v208, v208
    v_mfma_f32_16x16x32_bf16 v[212:215], a[228:231], v[116:119], v[212:215]
    v_exp_f32 v209, v209
    v_mfma_f32_16x16x32_bf16 v[212:215], a[232:235], v[120:123], v[212:215]
    v_exp_f32 v210, v210
    v_mfma_f32_16x16x32_bf16 v[212:215], a[236:239], v[124:127], v[212:215]
    v_exp_f32 v211, v211
    v_mfma_f32_16x16x32_bf16 a[120:123], a[184:187], v[176:179], a[120:123]
    ds_read_b64_tr_b16 a[168:169], v21 offset:0
    v_cvt_pk_bf16_f32 v150, v208, v209
    v_mfma_f32_16x16x32_bf16 a[120:123], a[188:191], v[180:183], a[120:123]
    ds_read_b64_tr_b16 a[170:171], v21 offset:4096
    v_mfma_f32_16x16x32_bf16 a[124:127], a[184:187], v[184:187], a[124:127]
    ds_read_b128 a[224:227], v8 offset:20480
    v_cvt_pk_bf16_f32 v151, v210, v211
    v_mfma_f32_16x16x32_bf16 a[124:127], a[188:191], v[188:191], a[124:127]
    s_waitcnt lgkmcnt(3)
    buffer_load_dwordx4 v38, s[8:11], s40 offen offset:2048 lds
    s_sub_u32 s43, s43, 1
    s_cmp_lg_u32 s43, 0
    s_cbranch_scc1 Lattn_loop
    v_mfma_f32_16x16x32_bf16 v[208:211], a[208:211], v[64:67], v[192:195]
    s_lshl_b32 s38, s3, 6
    v_exp_f32 v212, v212
    v_mfma_f32_16x16x32_bf16 v[208:211], a[212:215], v[68:71], v[208:211]
    s_add_u32 s38, s38, 131136
    v_exp_f32 v213, v213
    v_mfma_f32_16x16x32_bf16 v[208:211], a[216:219], v[72:75], v[208:211]
    v_exp_f32 v214, v214
    v_mfma_f32_16x16x32_bf16 v[208:211], a[220:223], v[76:79], v[208:211]
    s_add_u32 s57, s58, 0
    v_exp_f32 v215, v215
    v_mfma_f32_16x16x32_bf16 a[0:3], a[160:163], v[128:131], a[0:3]
    ds_read_b64_tr_b16 a[172:173], v21 offset:8192
    v_cvt_pk_bf16_f32 v158, v212, v213
    v_mfma_f32_16x16x32_bf16 a[0:3], a[164:167], v[132:135], a[0:3]
    ds_read_b64_tr_b16 a[174:175], v21 offset:12288
    v_permlane32_swap_b32 v224, v228
    v_mfma_f32_16x16x32_bf16 a[4:7], a[160:163], v[136:139], a[4:7]
    ds_read_b128 a[228:231], v9 offset:20480
    v_cvt_pk_bf16_f32 v159, v214, v215
    v_mfma_f32_16x16x32_bf16 a[4:7], a[164:167], v[140:143], a[4:7]
    buffer_load_dwordx4 a[128:131], v254, s[80:83], s57 offen
    v_mfma_f32_16x16x32_bf16 v[212:215], a[208:211], v[80:83], v[196:199]
    v_exp_f32 v208, v208
    v_mfma_f32_16x16x32_bf16 v[212:215], a[212:215], v[84:87], v[212:215]
    v_exp_f32 v209, v209
    v_mfma_f32_16x16x32_bf16 v[212:215], a[216:219], v[88:91], v[212:215]
    v_exp_f32 v210, v210
    v_mfma_f32_16x16x32_bf16 v[212:215], a[220:223], v[92:95], v[212:215]
    v_exp_f32 v211, v211
    v_mfma_f32_16x16x32_bf16 a[8:11], a[160:163], v[144:147], a[8:11]
    ds_read_b64_tr_b16 a[176:177], v22 offset:0
    v_cvt_pk_bf16_f32 v160, v208, v209
    v_mfma_f32_16x16x32_bf16 a[8:11], a[164:167], v[148:151], a[8:11]
    ds_read_b64_tr_b16 a[178:179], v22 offset:4096
    v_permlane32_swap_b32 v225, v229
    v_mfma_f32_16x16x32_bf16 a[12:15], a[160:163], v[152:155], a[12:15]
    ds_read_b128 a[232:235], v10 offset:20480
    v_cvt_pk_bf16_f32 v161, v210, v211
    v_mfma_f32_16x16x32_bf16 a[12:15], a[164:167], v[156:159], a[12:15]
    s_waitcnt lgkmcnt(3)
    buffer_load_dwordx4 v39, s[8:11], s40 offen offset:3072 lds
    v_mfma_f32_16x16x32_bf16 v[208:211], a[208:211], v[96:99], v[200:203]
    v_exp_f32 v212, v212
    v_mfma_f32_16x16x32_bf16 v[208:211], a[212:215], v[100:103], v[208:211]
    s_add_u32 s40, s40, 16384
    v_exp_f32 v213, v213
    v_mfma_f32_16x16x32_bf16 v[208:211], a[216:219], v[104:107], v[208:211]
    v_exp_f32 v214, v214
    v_mfma_f32_16x16x32_bf16 v[208:211], a[220:223], v[108:111], v[208:211]
    v_exp_f32 v215, v215
    v_mfma_f32_16x16x32_bf16 a[16:19], a[168:171], v[128:131], a[16:19]
    ds_read_b64_tr_b16 a[180:181], v22 offset:8192
    v_cvt_pk_bf16_f32 v168, v212, v213
    v_mfma_f32_16x16x32_bf16 a[16:19], a[172:175], v[132:135], a[16:19]
    ds_read_b64_tr_b16 a[182:183], v22 offset:12288
    v_permlane32_swap_b32 v226, v230
    v_mfma_f32_16x16x32_bf16 a[20:23], a[168:171], v[136:139], a[20:23]
    ds_read_b128 a[236:239], v11 offset:20480
    v_cvt_pk_bf16_f32 v169, v214, v215
    v_mfma_f32_16x16x32_bf16 a[20:23], a[172:175], v[140:143], a[20:23]
    v_permlane32_swap_b32 v227, v231
    v_add_f32 v224, v224, v228
    v_smfmac_f32_16x16x64_bf16 a[192:195], v[52:55], v[128:135], v50
    v_mfma_f32_16x16x32_bf16 v[212:215], a[208:211], v[112:115], v[204:207]
    v_exp_f32 v208, v208
    v_mfma_f32_16x16x32_bf16 v[212:215], a[212:215], v[116:119], v[212:215]
    s_add_u32 m0, s42, 98304
    v_exp_f32 v209, v209
    v_mfma_f32_16x16x32_bf16 v[212:215], a[216:219], v[120:123], v[212:215]
    v_exp_f32 v210, v210
    v_mfma_f32_16x16x32_bf16 v[212:215], a[220:223], v[124:127], v[212:215]
    v_exp_f32 v211, v211
    v_mfma_f32_16x16x32_bf16 a[24:27], a[168:171], v[144:147], a[24:27]
    ds_read_b64_tr_b16 a[184:185], v23 offset:0
    v_cvt_pk_bf16_f32 v176, v208, v209
    v_mfma_f32_16x16x32_bf16 a[24:27], a[172:175], v[148:151], a[24:27]
    ds_read_b64_tr_b16 a[186:187], v23 offset:4096
    v_add_f32 v225, v225, v229
    v_mfma_f32_16x16x32_bf16 a[28:31], a[168:171], v[152:155], a[28:31]
    ds_read_b128 a[208:211], v8 offset:24576
    v_cvt_pk_bf16_f32 v177, v210, v211
    v_mfma_f32_16x16x32_bf16 a[28:31], a[172:175], v[156:159], a[28:31]
    s_waitcnt lgkmcnt(3)
    buffer_load_dwordx4 v40, s[12:15], s41 offen lds
    v_mfma_f32_16x16x32_bf16 v[208:211], a[224:227], v[64:67], v[192:195]
    v_exp_f32 v212, v212
    v_mfma_f32_16x16x32_bf16 v[208:211], a[228:231], v[68:71], v[208:211]
    v_exp_f32 v213, v213
    v_mfma_f32_16x16x32_bf16 v[208:211], a[232:235], v[72:75], v[208:211]
    v_exp_f32 v214, v214
    v_mfma_f32_16x16x32_bf16 v[208:211], a[236:239], v[76:79], v[208:211]
    s_add_u32 s57, s58, 589824
    v_exp_f32 v215, v215
    v_mfma_f32_16x16x32_bf16 a[32:35], a[176:179], v[128:131], a[32:35]
    ds_read_b64_tr_b16 a[188:189], v23 offset:8192
    v_cvt_pk_bf16_f32 v184, v212, v213
    v_mfma_f32_16x16x32_bf16 a[32:35], a[180:183], v[132:135], a[32:35]
    ds_read_b64_tr_b16 a[190:191], v23 offset:12288
    v_add_f32 v226, v226, v230
    v_mfma_f32_16x16x32_bf16 a[36:39], a[176:179], v[136:139], a[36:39]
    ds_read_b128 a[212:215], v9 offset:24576
    v_cvt_pk_bf16_f32 v185, v214, v215
    v_mfma_f32_16x16x32_bf16 a[36:39], a[180:183], v[140:143], a[36:39]
    buffer_load_dwordx4 a[132:135], v254, s[80:83], s57 offen
    v_smfmac_f32_16x16x64_bf16 a[196:199], v[52:55], v[136:143], v50
    v_mfma_f32_16x16x32_bf16 v[212:215], a[224:227], v[80:83], v[196:199]
    v_exp_f32 v208, v208
    v_mfma_f32_16x16x32_bf16 v[212:215], a[228:231], v[84:87], v[212:215]
    v_exp_f32 v209, v209
    v_mfma_f32_16x16x32_bf16 v[212:215], a[232:235], v[88:91], v[212:215]
    v_exp_f32 v210, v210
    v_mfma_f32_16x16x32_bf16 v[212:215], a[236:239], v[92:95], v[212:215]
    v_exp_f32 v211, v211
    v_mfma_f32_16x16x32_bf16 a[40:43], a[176:179], v[144:147], a[40:43]
    ds_read_b64_tr_b16 a[160:161], v24 offset:0
    v_cvt_pk_bf16_f32 v162, v208, v209
    v_mfma_f32_16x16x32_bf16 a[40:43], a[180:183], v[148:151], a[40:43]
    ds_read_b64_tr_b16 a[162:163], v24 offset:4096
    v_add_f32 v227, v227, v231
    v_mfma_f32_16x16x32_bf16 a[44:47], a[176:179], v[152:155], a[44:47]
    ds_read_b128 a[216:219], v10 offset:24576
    v_cvt_pk_bf16_f32 v163, v210, v211
    v_mfma_f32_16x16x32_bf16 a[44:47], a[180:183], v[156:159], a[44:47]
    s_waitcnt lgkmcnt(3)
    buffer_load_dwordx4 v41, s[12:15], s41 offen offset:1024 lds
    v_mfma_f32_16x16x32_bf16 v[208:211], a[224:227], v[96:99], v[200:203]
    v_exp_f32 v212, v212
    v_mfma_f32_16x16x32_bf16 v[208:211], a[228:231], v[100:103], v[208:211]
    v_exp_f32 v213, v213
    v_mfma_f32_16x16x32_bf16 v[208:211], a[232:235], v[104:107], v[208:211]
    v_exp_f32 v214, v214
    v_mfma_f32_16x16x32_bf16 v[208:211], a[236:239], v[108:111], v[208:211]
    v_exp_f32 v215, v215
    v_mfma_f32_16x16x32_bf16 a[48:51], a[184:187], v[128:131], a[48:51]
    ds_read_b64_tr_b16 a[164:165], v24 offset:8192
    v_cvt_pk_bf16_f32 v170, v212, v213
    v_mfma_f32_16x16x32_bf16 a[48:51], a[188:191], v[132:135], a[48:51]
    ds_read_b64_tr_b16 a[166:167], v24 offset:12288
    v_and_b32 v244, 1, v1
    v_mfma_f32_16x16x32_bf16 a[52:55], a[184:187], v[136:139], a[52:55]
    ds_read_b128 a[220:223], v11 offset:24576
    v_cvt_pk_bf16_f32 v171, v214, v215
    v_mfma_f32_16x16x32_bf16 a[52:55], a[188:191], v[140:143], a[52:55]
    s_waitcnt vmcnt(15)
    buffer_load_dword v221, v236, s[20:23], 0 offen
    v_smfmac_f32_16x16x64_bf16 a[200:203], v[52:55], v[144:151], v50
    v_mfma_f32_16x16x32_bf16 v[212:215], a[224:227], v[112:115], v[204:207]
    v_exp_f32 v208, v208
    v_mfma_f32_16x16x32_bf16 v[212:215], a[228:231], v[116:119], v[212:215]
    v_exp_f32 v209, v209
    v_mfma_f32_16x16x32_bf16 v[212:215], a[232:235], v[120:123], v[212:215]
    v_exp_f32 v210, v210
    v_mfma_f32_16x16x32_bf16 v[212:215], a[236:239], v[124:127], v[212:215]
    v_exp_f32 v211, v211
    v_mfma_f32_16x16x32_bf16 a[56:59], a[184:187], v[144:147], a[56:59]
    ds_read_b64_tr_b16 a[168:169], v25 offset:0
    v_cvt_pk_bf16_f32 v178, v208, v209
    v_mfma_f32_16x16x32_bf16 a[56:59], a[188:191], v[148:151], a[56:59]
    ds_read_b64_tr_b16 a[170:171], v25 offset:4096
    v_permlane16_swap_b32 v224, v226
    v_mfma_f32_16x16x32_bf16 a[60:63], a[184:187], v[152:155], a[60:63]
    ds_read_b128 a[224:227], v8 offset:28672
    v_cvt_pk_bf16_f32 v179, v210, v211
    v_mfma_f32_16x16x32_bf16 a[60:63], a[188:191], v[156:159], a[60:63]
    s_waitcnt lgkmcnt(3)
    buffer_load_dwordx4 v40, s[12:15], s41 offen offset:2048 lds
    v_mfma_f32_16x16x32_bf16 v[208:211], a[208:211], v[64:67], v[192:195]
    v_exp_f32 v212, v212
    v_mfma_f32_16x16x32_bf16 v[208:211], a[212:215], v[68:71], v[208:211]
    v_exp_f32 v213, v213
    v_mfma_f32_16x16x32_bf16 v[208:211], a[216:219], v[72:75], v[208:211]
    v_exp_f32 v214, v214
    v_mfma_f32_16x16x32_bf16 v[208:211], a[220:223], v[76:79], v[208:211]
    s_add_u32 s57, s58, 1179648
    v_exp_f32 v215, v215
    v_mfma_f32_16x16x32_bf16 a[64:67], a[160:163], v[128:131], a[64:67]
    ds_read_b64_tr_b16 a[172:173], v25 offset:8192
    v_cvt_pk_bf16_f32 v186, v212, v213
    v_mfma_f32_16x16x32_bf16 a[64:67], a[164:167], v[132:135], a[64:67]
    ds_read_b64_tr_b16 a[174:175], v25 offset:12288
    v_permlane16_swap_b32 v225, v227
    v_mfma_f32_16x16x32_bf16 a[68:71], a[160:163], v[136:139], a[68:71]
    ds_read_b128 a[228:231], v9 offset:28672
    v_cvt_pk_bf16_f32 v187, v214, v215
    v_mfma_f32_16x16x32_bf16 a[68:71], a[164:167], v[140:143], a[68:71]
    buffer_load_dwordx4 a[136:139], v254, s[80:83], s57 offen
    v_smfmac_f32_16x16x64_bf16 a[204:207], v[52:55], v[152:159], v50
    v_mfma_f32_16x16x32_bf16 v[212:215], a[208:211], v[80:83], v[196:199]
    v_exp_f32 v208, v208
    v_mfma_f32_16x16x32_bf16 v[212:215], a[212:215], v[84:87], v[212:215]
    v_exp_f32 v209, v209
    v_mfma_f32_16x16x32_bf16 v[212:215], a[216:219], v[88:91], v[212:215]
    v_exp_f32 v210, v210
    v_mfma_f32_16x16x32_bf16 v[212:215], a[220:223], v[92:95], v[212:215]
    v_exp_f32 v211, v211
    v_mfma_f32_16x16x32_bf16 a[72:75], a[160:163], v[144:147], a[72:75]
    ds_read_b64_tr_b16 a[176:177], v26 offset:0
    v_cvt_pk_bf16_f32 v164, v208, v209
    v_mfma_f32_16x16x32_bf16 a[72:75], a[164:167], v[148:151], a[72:75]
    ds_read_b64_tr_b16 a[178:179], v26 offset:4096
    v_lshlrev_b32 v244, 5, v244
    v_mfma_f32_16x16x32_bf16 a[76:79], a[160:163], v[152:155], a[76:79]
    ds_read_b128 a[232:235], v10 offset:28672
    v_cvt_pk_bf16_f32 v165, v210, v211
    v_mfma_f32_16x16x32_bf16 a[76:79], a[164:167], v[156:159], a[76:79]
    s_waitcnt lgkmcnt(3)
    buffer_load_dwordx4 v41, s[12:15], s41 offen offset:3072 lds
    v_mfma_f32_16x16x32_bf16 v[208:211], a[208:211], v[96:99], v[200:203]
    v_exp_f32 v212, v212
    v_mfma_f32_16x16x32_bf16 v[208:211], a[212:215], v[100:103], v[208:211]
    s_add_u32 s41, s41, 16384
    v_exp_f32 v213, v213
    v_mfma_f32_16x16x32_bf16 v[208:211], a[216:219], v[104:107], v[208:211]
    v_exp_f32 v214, v214
    v_mfma_f32_16x16x32_bf16 v[208:211], a[220:223], v[108:111], v[208:211]
    v_exp_f32 v215, v215
    v_mfma_f32_16x16x32_bf16 a[80:83], a[168:171], v[128:131], a[80:83]
    ds_read_b64_tr_b16 a[180:181], v26 offset:8192
    v_cvt_pk_bf16_f32 v172, v212, v213
    v_mfma_f32_16x16x32_bf16 a[80:83], a[172:175], v[132:135], a[80:83]
    ds_read_b64_tr_b16 a[182:183], v26 offset:12288
    v_add_f32 v224, v224, v226
    v_mfma_f32_16x16x32_bf16 a[84:87], a[168:171], v[136:139], a[84:87]
    ds_read_b128 a[236:239], v11 offset:28672
    v_cvt_pk_bf16_f32 v173, v214, v215
    v_mfma_f32_16x16x32_bf16 a[84:87], a[172:175], v[140:143], a[84:87]
    s_waitcnt vmcnt(13)
    s_barrier
    v_mfma_f32_16x16x32_bf16 v[212:215], a[208:211], v[112:115], v[204:207]
    v_exp_f32 v208, v208
    v_mfma_f32_16x16x32_bf16 v[212:215], a[212:215], v[116:119], v[212:215]
    s_add_u32 s49, s45, 1024
    v_exp_f32 v209, v209
    v_mfma_f32_16x16x32_bf16 v[212:215], a[216:219], v[120:123], v[212:215]
    s_add_u32 m0, s42, 0
    v_exp_f32 v210, v210
    v_mfma_f32_16x16x32_bf16 v[212:215], a[220:223], v[124:127], v[212:215]
    v_exp_f32 v211, v211
    v_mfma_f32_16x16x32_bf16 a[88:91], a[168:171], v[144:147], a[88:91]
    ds_read_b64_tr_b16 a[184:185], v27 offset:0
    v_cvt_pk_bf16_f32 v180, v208, v209
    v_mfma_f32_16x16x32_bf16 a[88:91], a[172:175], v[148:151], a[88:91]
    ds_read_b64_tr_b16 a[186:187], v27 offset:4096
    v_add_f32 v225, v225, v227
    v_mfma_f32_16x16x32_bf16 a[92:95], a[168:171], v[152:155], a[92:95]
    ds_read_b128 a[208:211], v8 offset:32768
    v_cvt_pk_bf16_f32 v181, v210, v211
    v_mfma_f32_16x16x32_bf16 a[92:95], a[172:175], v[156:159], a[92:95]
    s_waitcnt lgkmcnt(3)
    buffer_load_dwordx4 v46, s[20:23], s49 offen lds
    v_mfma_f32_16x16x32_bf16 v[208:211], a[224:227], v[64:67], v[192:195]
    v_exp_f32 v212, v212
    v_mfma_f32_16x16x32_bf16 v[208:211], a[228:231], v[68:71], v[208:211]
    v_exp_f32 v213, v213
    v_mfma_f32_16x16x32_bf16 v[208:211], a[232:235], v[72:75], v[208:211]
    v_exp_f32 v214, v214
    v_mfma_f32_16x16x32_bf16 v[208:211], a[236:239], v[76:79], v[208:211]
    s_add_u32 s37, s55, 0
    v_exp_f32 v215, v215
    v_mfma_f32_16x16x32_bf16 a[96:99], a[176:179], v[128:131], a[96:99]
    ds_read_b64_tr_b16 a[188:189], v27 offset:8192
    v_cvt_pk_bf16_f32 v188, v212, v213
    v_mfma_f32_16x16x32_bf16 a[96:99], a[180:183], v[132:135], a[96:99]
    ds_read_b64_tr_b16 a[190:191], v27 offset:12288
    v_lshrrev_b32 v245, 4, v1
    v_mfma_f32_16x16x32_bf16 a[100:103], a[176:179], v[136:139], a[100:103]
    ds_read_b128 a[212:215], v9 offset:32768
    v_cvt_pk_bf16_f32 v189, v214, v215
    v_mfma_f32_16x16x32_bf16 a[100:103], a[180:183], v[140:143], a[100:103]
    buffer_load_dword v239, v238, s[28:31], s37 offen
    v_mfma_f32_16x16x32_bf16 v[212:215], a[224:227], v[80:83], v[196:199]
    v_exp_f32 v208, v208
    v_mfma_f32_16x16x32_bf16 v[212:215], a[228:231], v[84:87], v[212:215]
    v_exp_f32 v209, v209
    v_mfma_f32_16x16x32_bf16 v[212:215], a[232:235], v[88:91], v[212:215]
    v_exp_f32 v210, v210
    v_mfma_f32_16x16x32_bf16 v[212:215], a[236:239], v[92:95], v[212:215]
    v_exp_f32 v211, v211
    v_mfma_f32_16x16x32_bf16 a[104:107], a[176:179], v[144:147], a[104:107]
    ds_read_b64_tr_b16 a[160:161], v20 offset:16384
    v_cvt_pk_bf16_f32 v166, v208, v209
    v_mfma_f32_16x16x32_bf16 a[104:107], a[180:183], v[148:151], a[104:107]
    ds_read_b64_tr_b16 a[162:163], v20 offset:20480
    v_lshl_add_u32 v244, v245, 3, v244
    v_mfma_f32_16x16x32_bf16 a[108:111], a[176:179], v[152:155], a[108:111]
    ds_read_b128 a[216:219], v10 offset:32768
    v_cvt_pk_bf16_f32 v167, v210, v211
    v_mfma_f32_16x16x32_bf16 a[108:111], a[180:183], v[156:159], a[108:111]
    s_waitcnt lgkmcnt(3)
    buffer_load_dwordx4 v47, s[20:23], s49 offen offset:1024 lds
    v_mfma_f32_16x16x32_bf16 v[208:211], a[224:227], v[96:99], v[200:203]
    v_exp_f32 v212, v212
    v_mfma_f32_16x16x32_bf16 v[208:211], a[228:231], v[100:103], v[208:211]
    v_exp_f32 v213, v213
    v_mfma_f32_16x16x32_bf16 v[208:211], a[232:235], v[104:107], v[208:211]
    v_exp_f32 v214, v214
    v_mfma_f32_16x16x32_bf16 v[208:211], a[236:239], v[108:111], v[208:211]
    s_add_u32 s57, s58, 1769472
    v_exp_f32 v215, v215
    v_mfma_f32_16x16x32_bf16 a[112:115], a[184:187], v[128:131], a[112:115]
    ds_read_b64_tr_b16 a[164:165], v20 offset:24576
    v_cvt_pk_bf16_f32 v174, v212, v213
    v_mfma_f32_16x16x32_bf16 a[112:115], a[188:191], v[132:135], a[112:115]
    ds_read_b64_tr_b16 a[166:167], v20 offset:28672
    v_mfma_f32_16x16x32_bf16 a[116:119], a[184:187], v[136:139], a[116:119]
    ds_read_b128 a[220:223], v11 offset:32768
    v_cvt_pk_bf16_f32 v175, v214, v215
    v_mfma_f32_16x16x32_bf16 a[116:119], a[188:191], v[140:143], a[116:119]
    buffer_load_dwordx4 a[140:143], v254, s[80:83], s57 offen
    v_mfma_f32_16x16x32_bf16 v[212:215], a[224:227], v[112:115], v[204:207]
Ltour6:
    s_cbranch_execz Ltour10
    v_exp_f32 v208, v208
    v_mfma_f32_16x16x32_bf16 v[212:215], a[228:231], v[116:119], v[212:215]
    v_exp_f32 v209, v209
    v_mfma_f32_16x16x32_bf16 v[212:215], a[232:235], v[120:123], v[212:215]
    v_exp_f32 v210, v210
    v_mfma_f32_16x16x32_bf16 v[212:215], a[236:239], v[124:127], v[212:215]
    v_exp_f32 v211, v211
    v_mfma_f32_16x16x32_bf16 a[120:123], a[184:187], v[144:147], a[120:123]
    ds_read_b64_tr_b16 a[168:169], v21 offset:16384
    v_cvt_pk_bf16_f32 v182, v208, v209
    v_mfma_f32_16x16x32_bf16 a[120:123], a[188:191], v[148:151], a[120:123]
    ds_read_b64_tr_b16 a[170:171], v21 offset:20480
    v_mfma_f32_16x16x32_bf16 a[124:127], a[184:187], v[152:155], a[124:127]
    ds_read_b128 a[224:227], v8 offset:36864
    v_cvt_pk_bf16_f32 v183, v210, v211
    v_mfma_f32_16x16x32_bf16 a[124:127], a[188:191], v[156:159], a[124:127]
    s_waitcnt lgkmcnt(3)
    buffer_load_dwordx4 v48, s[20:23], s49 offen offset:2048 lds
    v_mfma_f32_16x16x32_bf16 v[208:211], a[208:211], v[64:67], v[192:195]
    v_exp_f32 v212, v212
    v_mfma_f32_16x16x32_bf16 v[208:211], a[212:215], v[68:71], v[208:211]
    v_exp_f32 v213, v213
    v_mfma_f32_16x16x32_bf16 v[208:211], a[216:219], v[72:75], v[208:211]
    v_exp_f32 v214, v214
    v_mfma_f32_16x16x32_bf16 v[208:211], a[220:223], v[76:79], v[208:211]
    s_add_u32 s57, s58, 2359296
    v_exp_f32 v215, v215
    v_mfma_f32_16x16x32_bf16 a[0:3], a[160:163], v[160:163], a[0:3]
    ds_read_b64_tr_b16 a[172:173], v21 offset:24576
    v_cvt_pk_bf16_f32 v190, v212, v213
    v_mfma_f32_16x16x32_bf16 a[0:3], a[164:167], v[164:167], a[0:3]
    ds_read_b64_tr_b16 a[174:175], v21 offset:28672
    v_mov_b32 v63, 0
    v_mfma_f32_16x16x32_bf16 a[4:7], a[160:163], v[168:171], a[4:7]
    ds_read_b128 a[228:231], v9 offset:36864
    v_cvt_pk_bf16_f32 v191, v214, v215
    v_mfma_f32_16x16x32_bf16 a[4:7], a[164:167], v[172:175], a[4:7]
    buffer_load_dwordx4 a[144:147], v254, s[80:83], s57 offen
    v_mfma_f32_16x16x32_bf16 v[212:215], a[208:211], v[80:83], v[196:199]
    v_exp_f32 v208, v208
    v_mfma_f32_16x16x32_bf16 v[212:215], a[212:215], v[84:87], v[212:215]
    v_exp_f32 v209, v209
    v_mfma_f32_16x16x32_bf16 v[212:215], a[216:219], v[88:91], v[212:215]
    v_exp_f32 v210, v210
    v_mfma_f32_16x16x32_bf16 v[212:215], a[220:223], v[92:95], v[212:215]
    v_exp_f32 v211, v211
    v_mfma_f32_16x16x32_bf16 a[8:11], a[160:163], v[176:179], a[8:11]
    ds_read_b64_tr_b16 a[176:177], v22 offset:16384
    v_cvt_pk_bf16_f32 v128, v208, v209
    v_mfma_f32_16x16x32_bf16 a[8:11], a[164:167], v[180:183], a[8:11]
    ds_read_b64_tr_b16 a[178:179], v22 offset:20480
    v_add_f32_dpp v224, v224, v224 row_ror:2 row_mask:0xf bank_mask:0xf
    v_mfma_f32_16x16x32_bf16 a[12:15], a[160:163], v[184:187], a[12:15]
    ds_read_b128 a[232:235], v10 offset:36864
    v_cvt_pk_bf16_f32 v129, v210, v211
    v_mfma_f32_16x16x32_bf16 a[12:15], a[164:167], v[188:191], a[12:15]
    s_waitcnt lgkmcnt(3)
    buffer_load_dwordx4 v49, s[20:23], s49 offen offset:3072 lds
    v_mfma_f32_16x16x32_bf16 v[208:211], a[208:211], v[96:99], v[200:203]
    s_lshr_b32 s39, s2, 5
    v_exp_f32 v212, v212
    v_mfma_f32_16x16x32_bf16 v[208:211], a[212:215], v[100:103], v[208:211]
    s_lshl_b32 s39, s39, 3
    v_exp_f32 v213, v213
    v_mfma_f32_16x16x32_bf16 v[208:211], a[216:219], v[104:107], v[208:211]
    s_and_b32 s43, s2, 7
    v_exp_f32 v214, v214
    v_mfma_f32_16x16x32_bf16 v[208:211], a[220:223], v[108:111], v[208:211]
    s_add_u32 s39, s39, s43
    v_exp_f32 v215, v215
    v_mfma_f32_16x16x32_bf16 a[16:19], a[168:171], v[160:163], a[16:19]
    ds_read_b64_tr_b16 a[180:181], v22 offset:24576
    v_cvt_pk_bf16_f32 v136, v212, v213
    v_mfma_f32_16x16x32_bf16 a[16:19], a[172:175], v[164:167], a[16:19]
    ds_read_b64_tr_b16 a[182:183], v22 offset:28672
    v_add_f32_dpp v225, v225, v225 row_ror:2 row_mask:0xf bank_mask:0xf
    v_mfma_f32_16x16x32_bf16 a[20:23], a[168:171], v[168:171], a[20:23]
    ds_read_b128 a[236:239], v11 offset:36864
    v_cvt_pk_bf16_f32 v137, v214, v215
    v_mfma_f32_16x16x32_bf16 a[20:23], a[172:175], v[172:175], a[20:23]
    buffer_load_dword v253, v63, s[24:27], s54 offen offset:12 sc1
    v_smfmac_f32_16x16x64_bf16 a[192:195], v[52:55], v[160:167], v50
    v_mfma_f32_16x16x32_bf16 v[212:215], a[208:211], v[112:115], v[204:207]
    s_lshl_b32 s39, s39, 2
    v_exp_f32 v208, v208
    v_mfma_f32_16x16x32_bf16 v[212:215], a[212:215], v[116:119], v[212:215]
    s_add_u32 m0, s42, 114688
    v_exp_f32 v209, v209
    v_mfma_f32_16x16x32_bf16 v[212:215], a[216:219], v[120:123], v[212:215]
    s_bfe_u32 s43, s2, 0x20003
    v_exp_f32 v210, v210
    v_mfma_f32_16x16x32_bf16 v[212:215], a[220:223], v[124:127], v[212:215]
    s_add_u32 s39, s39, s43
    v_exp_f32 v211, v211
    v_mfma_f32_16x16x32_bf16 a[24:27], a[168:171], v[176:179], a[24:27]
    ds_read_b64_tr_b16 a[184:185], v23 offset:16384
    v_cvt_pk_bf16_f32 v144, v208, v209
    v_mfma_f32_16x16x32_bf16 a[24:27], a[172:175], v[180:183], a[24:27]
    ds_read_b64_tr_b16 a[186:187], v23 offset:20480
    v_add_f32_dpp v224, v224, v224 row_ror:4 row_mask:0xf bank_mask:0xf
    v_mfma_f32_16x16x32_bf16 a[28:31], a[168:171], v[184:187], a[28:31]
    ds_read_b128 a[208:211], v8 offset:40960
    v_cvt_pk_bf16_f32 v145, v210, v211
    v_mfma_f32_16x16x32_bf16 a[28:31], a[172:175], v[188:191], a[28:31]
    s_waitcnt lgkmcnt(3)
    buffer_load_dwordx4 v40, s[12:15], s41 offen lds
    v_mfma_f32_16x16x32_bf16 v[208:211], a[224:227], v[64:67], v[192:195]
    s_add_u32 s39, s39, 72
    v_exp_f32 v212, v212
    v_mfma_f32_16x16x32_bf16 v[208:211], a[228:231], v[68:71], v[208:211]
    s_cmp_lt_u32 s39, 216
    s_cselect_b32 s43, 0, 2147483648
    v_exp_f32 v213, v213
    v_mfma_f32_16x16x32_bf16 v[208:211], a[232:235], v[72:75], v[208:211]
    s_or_b32 s43, s43, s48
    v_exp_f32 v214, v214
    v_mfma_f32_16x16x32_bf16 v[208:211], a[236:239], v[76:79], v[208:211]
    s_add_u32 s57, s58, 2949120
    v_exp_f32 v215, v215
    v_mfma_f32_16x16x32_bf16 a[32:35], a[176:179], v[160:163], a[32:35]
    ds_read_b64_tr_b16 a[188:189], v23 offset:24576
    v_cvt_pk_bf16_f32 v152, v212, v213
    v_mfma_f32_16x16x32_bf16 a[32:35], a[180:183], v[164:167], a[32:35]
    ds_read_b64_tr_b16 a[190:191], v23 offset:28672
    v_add_f32_dpp v225, v225, v225 row_ror:4 row_mask:0xf bank_mask:0xf
    v_mfma_f32_16x16x32_bf16 a[36:39], a[176:179], v[168:171], a[36:39]
    ds_read_b128 a[212:215], v9 offset:40960
    v_cvt_pk_bf16_f32 v153, v214, v215
    v_mfma_f32_16x16x32_bf16 a[36:39], a[180:183], v[172:175], a[36:39]
    buffer_load_dwordx4 a[148:151], v254, s[80:83], s57 offen
    v_smfmac_f32_16x16x64_bf16 a[196:199], v[52:55], v[168:175], v50
    v_mfma_f32_16x16x32_bf16 v[212:215], a[224:227], v[80:83], v[196:199]
    s_and_b32 s43, s43, 2147483648
    v_exp_f32 v208, v208
    v_mfma_f32_16x16x32_bf16 v[212:215], a[228:231], v[84:87], v[212:215]
    s_sub_u32 s36, s39, 144
    v_exp_f32 v209, v209
    v_mfma_f32_16x16x32_bf16 v[212:215], a[232:235], v[88:91], v[212:215]
    s_cmp_lt_u32 s36, 36
    s_cselect_b32 s36, 1.0, 0
    v_exp_f32 v210, v210
    v_mfma_f32_16x16x32_bf16 v[212:215], a[236:239], v[92:95], v[212:215]
    s_lshr_b32 s44, s39, 1
    v_exp_f32 v211, v211
    v_mfma_f32_16x16x32_bf16 a[40:43], a[176:179], v[176:179], a[40:43]
    ds_read_b64_tr_b16 a[160:161], v24 offset:16384
    v_cvt_pk_bf16_f32 v130, v208, v209
    v_mfma_f32_16x16x32_bf16 a[40:43], a[180:183], v[180:183], a[40:43]
    ds_read_b64_tr_b16 a[162:163], v24 offset:20480
    v_add_f32_dpp v224, v224, v224 row_ror:8 row_mask:0xf bank_mask:0xf
    v_mfma_f32_16x16x32_bf16 a[44:47], a[176:179], v[184:187], a[44:47]
    ds_read_b128 a[216:219], v10 offset:40960
    v_cvt_pk_bf16_f32 v131, v210, v211
    v_mfma_f32_16x16x32_bf16 a[44:47], a[180:183], v[188:191], a[44:47]
    s_waitcnt lgkmcnt(3)
    buffer_load_dwordx4 v41, s[12:15], s41 offen offset:1024 lds
    v_mfma_f32_16x16x32_bf16 v[208:211], a[224:227], v[96:99], v[200:203]
    s_lshl_b32 s44, s44, 6
    v_exp_f32 v212, v212
    v_mfma_f32_16x16x32_bf16 v[208:211], a[228:231], v[100:103], v[208:211]
    s_and_b32 s39, s39, 1
    v_exp_f32 v213, v213
    v_mfma_f32_16x16x32_bf16 v[208:211], a[232:235], v[104:107], v[208:211]
    s_lshl_b32 s39, s39, 3
    v_exp_f32 v214, v214
    v_mfma_f32_16x16x32_bf16 v[208:211], a[236:239], v[108:111], v[208:211]
    s_add_u32 s39, s39, s44
    v_exp_f32 v215, v215
    v_mfma_f32_16x16x32_bf16 a[48:51], a[184:187], v[160:163], a[48:51]
    ds_read_b64_tr_b16 a[164:165], v24 offset:24576
    v_cvt_pk_bf16_f32 v138, v212, v213
    v_mfma_f32_16x16x32_bf16 a[48:51], a[188:191], v[164:167], a[48:51]
    ds_read_b64_tr_b16 a[166:167], v24 offset:28672
    v_add_f32_dpp v225, v225, v225 row_ror:8 row_mask:0xf bank_mask:0xf
    v_mfma_f32_16x16x32_bf16 a[52:55], a[184:187], v[168:171], a[52:55]
    ds_read_b128 a[220:223], v11 offset:40960
    v_cvt_pk_bf16_f32 v139, v214, v215
    v_mfma_f32_16x16x32_bf16 a[52:55], a[188:191], v[172:175], a[52:55]
    v_add_u32 v244, s38, v244
    v_and_b32 v245, 7, v1
    v_smfmac_f32_16x16x64_bf16 a[200:203], v[52:55], v[176:183], v50
    v_mfma_f32_16x16x32_bf16 v[212:215], a[224:227], v[112:115], v[204:207]
    s_add_u32 s39, s39, 16384
    v_exp_f32 v208, v208
    v_mfma_f32_16x16x32_bf16 v[212:215], a[228:231], v[116:119], v[212:215]
    s_or_b32 s39, s39, s43
    v_exp_f32 v209, v209
    v_mfma_f32_16x16x32_bf16 v[212:215], a[232:235], v[120:123], v[212:215]
    v_exp_f32 v210, v210
    v_mfma_f32_16x16x32_bf16 v[212:215], a[236:239], v[124:127], v[212:215]
    v_exp_f32 v211, v211
    v_mfma_f32_16x16x32_bf16 a[56:59], a[184:187], v[176:179], a[56:59]
    ds_read_b64_tr_b16 a[168:169], v25 offset:16384
    v_cvt_pk_bf16_f32 v146, v208, v209
    v_mfma_f32_16x16x32_bf16 a[56:59], a[188:191], v[180:183], a[56:59]
    ds_read_b64_tr_b16 a[170:171], v25 offset:20480
    v_mfma_f32_16x16x32_bf16 a[60:63], a[184:187], v[184:187], a[60:63]
    ds_read_b128 a[224:227], v8 offset:45056
    v_cvt_pk_bf16_f32 v147, v210, v211
    v_mfma_f32_16x16x32_bf16 a[60:63], a[188:191], v[188:191], a[60:63]
    s_waitcnt lgkmcnt(3)
    buffer_load_dwordx4 v40, s[12:15], s41 offen offset:2048 lds
    v_mfma_f32_16x16x32_bf16 v[208:211], a[208:211], v[64:67], v[192:195]
    v_exp_f32 v212, v212
    v_mfma_f32_16x16x32_bf16 v[208:211], a[212:215], v[68:71], v[208:211]
    v_exp_f32 v213, v213
    v_mfma_f32_16x16x32_bf16 v[208:211], a[216:219], v[72:75], v[208:211]
    v_exp_f32 v214, v214
    v_mfma_f32_16x16x32_bf16 v[208:211], a[220:223], v[76:79], v[208:211]
    s_add_u32 s57, s58, 3538944
    v_exp_f32 v215, v215
    v_mfma_f32_16x16x32_bf16 a[64:67], a[160:163], v[160:163], a[64:67]
    ds_read_b64_tr_b16 a[172:173], v25 offset:24576
    v_cvt_pk_bf16_f32 v154, v212, v213
    v_mfma_f32_16x16x32_bf16 a[64:67], a[164:167], v[164:167], a[64:67]
    ds_read_b64_tr_b16 a[174:175], v25 offset:28672
    v_lshlrev_b32 v245, 3, v245
    v_mfma_f32_16x16x32_bf16 a[68:71], a[160:163], v[168:171], a[68:71]
    ds_read_b128 a[228:231], v9 offset:45056
    v_cvt_pk_bf16_f32 v155, v214, v215
    v_mfma_f32_16x16x32_bf16 a[68:71], a[164:167], v[172:175], a[68:71]
    buffer_load_dwordx4 a[152:155], v254, s[80:83], s57 offen
    v_smfmac_f32_16x16x64_bf16 a[204:207], v[52:55], v[184:191], v50
    ds_write_b64 v244, v[224:225]
    v_mfma_f32_16x16x32_bf16 v[212:215], a[208:211], v[80:83], v[196:199]
    v_exp_f32 v208, v208
    v_mfma_f32_16x16x32_bf16 v[212:215], a[212:215], v[84:87], v[212:215]
    v_exp_f32 v209, v209
    v_mfma_f32_16x16x32_bf16 v[212:215], a[216:219], v[88:91], v[212:215]
    v_exp_f32 v210, v210
    v_mfma_f32_16x16x32_bf16 v[212:215], a[220:223], v[92:95], v[212:215]
    v_exp_f32 v211, v211
    v_mfma_f32_16x16x32_bf16 a[72:75], a[160:163], v[176:179], a[72:75]
    ds_read_b64_tr_b16 a[176:177], v26 offset:16384
    v_cvt_pk_bf16_f32 v132, v208, v209
    v_mfma_f32_16x16x32_bf16 a[72:75], a[164:167], v[180:183], a[72:75]
    ds_read_b64_tr_b16 a[178:179], v26 offset:20480
    v_add_u32 v245, 131136, v245
    v_mfma_f32_16x16x32_bf16 a[76:79], a[160:163], v[184:187], a[76:79]
    ds_read_b128 a[232:235], v10 offset:45056
    v_cvt_pk_bf16_f32 v133, v210, v211
    v_mfma_f32_16x16x32_bf16 a[76:79], a[164:167], v[188:191], a[76:79]
    s_waitcnt lgkmcnt(3)
    buffer_load_dwordx4 v41, s[12:15], s41 offen offset:3072 lds
    v_mfma_f32_16x16x32_bf16 v[208:211], a[208:211], v[96:99], v[200:203]
    v_exp_f32 v212, v212
    v_mfma_f32_16x16x32_bf16 v[208:211], a[212:215], v[100:103], v[208:211]
    s_add_u32 s41, s41, 16384
    v_exp_f32 v213, v213
    v_mfma_f32_16x16x32_bf16 v[208:211], a[216:219], v[104:107], v[208:211]
    v_exp_f32 v214, v214
    v_mfma_f32_16x16x32_bf16 v[208:211], a[220:223], v[108:111], v[208:211]
    v_exp_f32 v215, v215
    v_mfma_f32_16x16x32_bf16 a[80:83], a[168:171], v[160:163], a[80:83]
    ds_read_b64_tr_b16 a[180:181], v26 offset:24576
    v_cvt_pk_bf16_f32 v140, v212, v213
    v_mfma_f32_16x16x32_bf16 a[80:83], a[172:175], v[164:167], a[80:83]
    ds_read_b64_tr_b16 a[182:183], v26 offset:28672
    v_mfma_f32_16x16x32_bf16 a[84:87], a[168:171], v[168:171], a[84:87]
    ds_read_b128 a[236:239], v11 offset:45056
    v_cvt_pk_bf16_f32 v141, v214, v215
    v_mfma_f32_16x16x32_bf16 a[84:87], a[172:175], v[172:175], a[84:87]
    s_waitcnt vmcnt(14)
    s_barrier
    v_mfma_f32_16x16x32_bf16 v[212:215], a[208:211], v[112:115], v[204:207]
    v_exp_f32 v208, v208
    v_mfma_f32_16x16x32_bf16 v[212:215], a[212:215], v[116:119], v[212:215]
    s_add_u32 s49, s45, 74752
    v_exp_f32 v209, v209
    v_mfma_f32_16x16x32_bf16 v[212:215], a[216:219], v[120:123], v[212:215]
    s_add_u32 m0, s42, 16384
    v_exp_f32 v210, v210
    v_mfma_f32_16x16x32_bf16 v[212:215], a[220:223], v[124:127], v[212:215]
    v_exp_f32 v211, v211
    v_mfma_f32_16x16x32_bf16 a[88:91], a[168:171], v[176:179], a[88:91]
    ds_read_b64_tr_b16 a[184:185], v27 offset:16384
    v_cvt_pk_bf16_f32 v148, v208, v209
    v_mfma_f32_16x16x32_bf16 a[88:91], a[172:175], v[180:183], a[88:91]
    ds_read_b64_tr_b16 a[186:187], v27 offset:20480
    ds_read_b64 v[224:225], v245 offset:0
    v_mfma_f32_16x16x32_bf16 a[92:95], a[168:171], v[184:187], a[92:95]
    ds_read_b128 a[208:211], v8 offset:49152
    v_cvt_pk_bf16_f32 v149, v210, v211
    v_mfma_f32_16x16x32_bf16 a[92:95], a[172:175], v[188:191], a[92:95]
    s_waitcnt lgkmcnt(3)
    buffer_load_dwordx4 v46, s[20:23], s49 offen lds
    v_mfma_f32_16x16x32_bf16 v[208:211], a[224:227], v[64:67], v[192:195]
    v_exp_f32 v212, v212
    v_mfma_f32_16x16x32_bf16 v[208:211], a[228:231], v[68:71], v[208:211]
    v_exp_f32 v213, v213
    v_mfma_f32_16x16x32_bf16 v[208:211], a[232:235], v[72:75], v[208:211]
    v_exp_f32 v214, v214
    v_mfma_f32_16x16x32_bf16 v[208:211], a[236:239], v[76:79], v[208:211]
    v_exp_f32 v215, v215
    v_mfma_f32_16x16x32_bf16 a[96:99], a[176:179], v[160:163], a[96:99]
    ds_read_b64_tr_b16 a[188:189], v27 offset:24576
    v_cvt_pk_bf16_f32 v156, v212, v213
    v_mfma_f32_16x16x32_bf16 a[96:99], a[180:183], v[164:167], a[96:99]
    ds_read_b64_tr_b16 a[190:191], v27 offset:28672
    ds_read_b64 v[226:227], v245 offset:64
    v_mfma_f32_16x16x32_bf16 a[100:103], a[176:179], v[168:171], a[100:103]
    ds_read_b128 a[212:215], v9 offset:49152
    v_cvt_pk_bf16_f32 v157, v214, v215
    v_mfma_f32_16x16x32_bf16 a[100:103], a[180:183], v[172:175], a[100:103]
    v_mfma_f32_16x16x32_bf16 v[212:215], a[224:227], v[80:83], v[196:199]
    v_exp_f32 v208, v208
    v_mfma_f32_16x16x32_bf16 v[212:215], a[228:231], v[84:87], v[212:215]
    v_exp_f32 v209, v209
    v_mfma_f32_16x16x32_bf16 v[212:215], a[232:235], v[88:91], v[212:215]
    v_exp_f32 v210, v210
    v_mfma_f32_16x16x32_bf16 v[212:215], a[236:239], v[92:95], v[212:215]
    v_exp_f32 v211, v211
    v_mfma_f32_16x16x32_bf16 a[104:107], a[176:179], v[176:179], a[104:107]
    ds_read_b64_tr_b16 a[160:161], v20 offset:32768
    v_cvt_pk_bf16_f32 v134, v208, v209
    v_mfma_f32_16x16x32_bf16 a[104:107], a[180:183], v[180:183], a[104:107]
    ds_read_b64_tr_b16 a[162:163], v20 offset:36864
    ds_read_b64 v[228:229], v245 offset:128
    v_mfma_f32_16x16x32_bf16 a[108:111], a[176:179], v[184:187], a[108:111]
    ds_read_b128 a[216:219], v10 offset:49152
    v_cvt_pk_bf16_f32 v135, v210, v211
    v_mfma_f32_16x16x32_bf16 a[108:111], a[180:183], v[188:191], a[108:111]
    s_waitcnt lgkmcnt(3)
    buffer_load_dwordx4 v47, s[20:23], s49 offen offset:1024 lds
    v_mfma_f32_16x16x32_bf16 v[208:211], a[224:227], v[96:99], v[200:203]
    v_exp_f32 v212, v212
    v_mfma_f32_16x16x32_bf16 v[208:211], a[228:231], v[100:103], v[208:211]
    v_exp_f32 v213, v213
    v_mfma_f32_16x16x32_bf16 v[208:211], a[232:235], v[104:107], v[208:211]
    v_exp_f32 v214, v214
    v_mfma_f32_16x16x32_bf16 v[208:211], a[236:239], v[108:111], v[208:211]
    s_add_u32 s57, s58, 4128768
    v_exp_f32 v215, v215
    v_mfma_f32_16x16x32_bf16 a[112:115], a[184:187], v[160:163], a[112:115]
    ds_read_b64_tr_b16 a[164:165], v20 offset:40960
    v_cvt_pk_bf16_f32 v142, v212, v213
    v_mfma_f32_16x16x32_bf16 a[112:115], a[188:191], v[164:167], a[112:115]
    ds_read_b64_tr_b16 a[166:167], v20 offset:45056
    ds_read_b64 v[230:231], v245 offset:192
    v_mfma_f32_16x16x32_bf16 a[116:119], a[184:187], v[168:171], a[116:119]
    ds_read_b128 a[220:223], v11 offset:49152
    v_cvt_pk_bf16_f32 v143, v214, v215
    v_mfma_f32_16x16x32_bf16 a[116:119], a[188:191], v[172:175], a[116:119]
    buffer_load_dwordx4 a[156:159], v254, s[80:83], s57 offen
    v_mfma_f32_16x16x32_bf16 v[212:215], a[224:227], v[112:115], v[204:207]
    v_exp_f32 v208, v208
    v_mfma_f32_16x16x32_bf16 v[212:215], a[228:231], v[116:119], v[212:215]
    v_exp_f32 v209, v209
    v_mfma_f32_16x16x32_bf16 v[212:215], a[232:235], v[120:123], v[212:215]
    v_exp_f32 v210, v210
    v_mfma_f32_16x16x32_bf16 v[212:215], a[236:239], v[124:127], v[212:215]
    v_exp_f32 v211, v211
    v_mfma_f32_16x16x32_bf16 a[120:123], a[184:187], v[176:179], a[120:123]
    ds_read_b64_tr_b16 a[168:169], v21 offset:32768
    v_cvt_pk_bf16_f32 v150, v208, v209
    v_mfma_f32_16x16x32_bf16 a[120:123], a[188:191], v[180:183], a[120:123]
    ds_read_b64_tr_b16 a[170:171], v21 offset:36864
    v_mfma_f32_16x16x32_bf16 a[124:127], a[184:187], v[184:187], a[124:127]
    ds_read_b128 a[224:227], v8 offset:53248
    v_cvt_pk_bf16_f32 v151, v210, v211
    v_mfma_f32_16x16x32_bf16 a[124:127], a[188:191], v[188:191], a[124:127]
    s_waitcnt lgkmcnt(3)
    buffer_load_dwordx4 v48, s[20:23], s49 offen offset:2048 lds
    v_mfma_f32_16x16x32_bf16 v[208:211], a[208:211], v[64:67], v[192:195]
    v_exp_f32 v212, v212
    v_mfma_f32_16x16x32_bf16 v[208:211], a[212:215], v[68:71], v[208:211]
    v_exp_f32 v213, v213
    v_mfma_f32_16x16x32_bf16 v[208:211], a[216:219], v[72:75], v[208:211]
    v_exp_f32 v214, v214
    v_mfma_f32_16x16x32_bf16 v[208:211], a[220:223], v[76:79], v[208:211]
    s_add_u32 s57, s58, 4718592
    v_exp_f32 v215, v215
    v_mfma_f32_16x16x32_bf16 a[0:3], a[160:163], v[128:131], a[0:3]
    ds_read_b64_tr_b16 a[172:173], v21 offset:40960
    v_cvt_pk_bf16_f32 v158, v212, v213
    v_mfma_f32_16x16x32_bf16 a[0:3], a[164:167], v[132:135], a[0:3]
    ds_read_b64_tr_b16 a[174:175], v21 offset:45056
    v_add_f32 v224, v224, v228
    v_mfma_f32_16x16x32_bf16 a[4:7], a[160:163], v[136:139], a[4:7]
    ds_read_b128 a[228:231], v9 offset:53248
    v_cvt_pk_bf16_f32 v159, v214, v215
    v_mfma_f32_16x16x32_bf16 a[4:7], a[164:167], v[140:143], a[4:7]
    buffer_load_dwordx4 a[240:243], v254, s[80:83], s57 offen
    v_mfma_f32_16x16x32_bf16 v[212:215], a[208:211], v[80:83], v[196:199]
    v_exp_f32 v208, v208
    v_mfma_f32_16x16x32_bf16 v[212:215], a[212:215], v[84:87], v[212:215]
    v_exp_f32 v209, v209
    v_mfma_f32_16x16x32_bf16 v[212:215], a[216:219], v[88:91], v[212:215]
    v_exp_f32 v210, v210
    v_mfma_f32_16x16x32_bf16 v[212:215], a[220:223], v[92:95], v[212:215]
    v_exp_f32 v211, v211
    v_mfma_f32_16x16x32_bf16 a[8:11], a[160:163], v[144:147], a[8:11]
    ds_read_b64_tr_b16 a[176:177], v22 offset:32768
    v_cvt_pk_bf16_f32 v160, v208, v209
    v_mfma_f32_16x16x32_bf16 a[8:11], a[164:167], v[148:151], a[8:11]
    ds_read_b64_tr_b16 a[178:179], v22 offset:36864
    v_add_f32 v225, v225, v229
    v_mfma_f32_16x16x32_bf16 a[12:15], a[160:163], v[152:155], a[12:15]
    ds_read_b128 a[232:235], v10 offset:53248
    v_cvt_pk_bf16_f32 v161, v210, v211
    v_mfma_f32_16x16x32_bf16 a[12:15], a[164:167], v[156:159], a[12:15]
    s_waitcnt lgkmcnt(3)
    buffer_load_dwordx4 v49, s[20:23], s49 offen offset:3072 lds
    v_mfma_f32_16x16x32_bf16 v[208:211], a[208:211], v[96:99], v[200:203]
    v_exp_f32 v212, v212
    v_mfma_f32_16x16x32_bf16 v[208:211], a[212:215], v[100:103], v[208:211]
    v_exp_f32 v213, v213
    v_mfma_f32_16x16x32_bf16 v[208:211], a[216:219], v[104:107], v[208:211]
    v_exp_f32 v214, v214
    v_mfma_f32_16x16x32_bf16 v[208:211], a[220:223], v[108:111], v[208:211]
    v_exp_f32 v215, v215
    v_mfma_f32_16x16x32_bf16 a[16:19], a[168:171], v[128:131], a[16:19]
    ds_read_b64_tr_b16 a[180:181], v22 offset:40960
    v_cvt_pk_bf16_f32 v168, v212, v213
    v_mfma_f32_16x16x32_bf16 a[16:19], a[172:175], v[132:135], a[16:19]
    ds_read_b64_tr_b16 a[182:183], v22 offset:45056
    v_add_f32 v226, v226, v230
    v_mfma_f32_16x16x32_bf16 a[20:23], a[168:171], v[136:139], a[20:23]
    ds_read_b128 a[236:239], v11 offset:53248
    v_cvt_pk_bf16_f32 v169, v214, v215
    v_mfma_f32_16x16x32_bf16 a[20:23], a[172:175], v[140:143], a[20:23]
    v_add_f32 v227, v227, v231
    v_add_f32 v224, v224, v226
    v_smfmac_f32_16x16x64_bf16 a[192:195], v[52:55], v[128:135], v50
    v_mfma_f32_16x16x32_bf16 v[212:215], a[208:211], v[112:115], v[204:207]
    v_exp_f32 v208, v208
    v_mfma_f32_16x16x32_bf16 v[212:215], a[212:215], v[116:119], v[212:215]
    s_add_u32 s49, s7, 0
    v_exp_f32 v209, v209
    v_mfma_f32_16x16x32_bf16 v[212:215], a[216:219], v[120:123], v[212:215]
    s_add_u32 m0, s42, 65536
    v_exp_f32 v210, v210
    v_mfma_f32_16x16x32_bf16 v[212:215], a[220:223], v[124:127], v[212:215]
    v_exp_f32 v211, v211
    v_mfma_f32_16x16x32_bf16 a[24:27], a[168:171], v[144:147], a[24:27]
    ds_read_b64_tr_b16 a[184:185], v23 offset:32768
    v_cvt_pk_bf16_f32 v176, v208, v209
    v_mfma_f32_16x16x32_bf16 a[24:27], a[172:175], v[148:151], a[24:27]
    ds_read_b64_tr_b16 a[186:187], v23 offset:36864
    v_add_f32 v225, v225, v227
    v_mfma_f32_16x16x32_bf16 a[28:31], a[168:171], v[152:155], a[28:31]
    ds_read_b128 a[208:211], v8 offset:57344
    v_cvt_pk_bf16_f32 v177, v210, v211
    v_mfma_f32_16x16x32_bf16 a[28:31], a[172:175], v[156:159], a[28:31]
    s_waitcnt lgkmcnt(3)
    buffer_load_dwordx4 v46, s[20:23], s49 offen lds
    v_mfma_f32_16x16x32_bf16 v[208:211], a[224:227], v[64:67], v[192:195]
    v_exp_f32 v212, v212
    v_mfma_f32_16x16x32_bf16 v[208:211], a[228:231], v[68:71], v[208:211]
    v_exp_f32 v213, v213
    v_mfma_f32_16x16x32_bf16 v[208:211], a[232:235], v[72:75], v[208:211]
    v_exp_f32 v214, v214
    v_mfma_f32_16x16x32_bf16 v[208:211], a[236:239], v[76:79], v[208:211]
    s_add_u32 s57, s58, 4128768
    v_exp_f32 v215, v215
    v_mfma_f32_16x16x32_bf16 a[32:35], a[176:179], v[128:131], a[32:35]
    ds_read_b64_tr_b16 a[188:189], v23 offset:40960
    v_cvt_pk_bf16_f32 v184, v212, v213
    v_mfma_f32_16x16x32_bf16 a[32:35], a[180:183], v[132:135], a[32:35]
    ds_read_b64_tr_b16 a[190:191], v23 offset:45056
    v_cvt_pk_bf16_f32 v246, v224, v225
    v_mfma_f32_16x16x32_bf16 a[36:39], a[176:179], v[136:139], a[36:39]
    ds_read_b128 a[212:215], v9 offset:57344
    v_cvt_pk_bf16_f32 v185, v214, v215
    v_mfma_f32_16x16x32_bf16 a[36:39], a[180:183], v[140:143], a[36:39]
    buffer_load_dwordx4 a[244:247], v254, s[32:35], s57 offen
    v_smfmac_f32_16x16x64_bf16 a[196:199], v[52:55], v[136:143], v50
    v_mfma_f32_16x16x32_bf16 v[212:215], a[224:227], v[80:83], v[196:199]
    v_exp_f32 v208, v208
    v_mfma_f32_16x16x32_bf16 v[212:215], a[228:231], v[84:87], v[212:215]
    v_exp_f32 v209, v209
    v_mfma_f32_16x16x32_bf16 v[212:215], a[232:235], v[88:91], v[212:215]
    v_exp_f32 v210, v210
    v_mfma_f32_16x16x32_bf16 v[212:215], a[236:239], v[92:95], v[212:215]
    v_exp_f32 v211, v211
    v_mfma_f32_16x16x32_bf16 a[40:43], a[176:179], v[144:147], a[40:43]
    ds_read_b64_tr_b16 a[160:161], v24 offset:32768
    v_cvt_pk_bf16_f32 v162, v208, v209
    v_mfma_f32_16x16x32_bf16 a[40:43], a[180:183], v[148:151], a[40:43]
    ds_read_b64_tr_b16 a[162:163], v24 offset:36864
    v_lshlrev_b32 v224, 16, v246
    v_mfma_f32_16x16x32_bf16 a[44:47], a[176:179], v[152:155], a[44:47]
    ds_read_b128 a[216:219], v10 offset:57344
    v_cvt_pk_bf16_f32 v163, v210, v211
    v_mfma_f32_16x16x32_bf16 a[44:47], a[180:183], v[156:159], a[44:47]
    s_waitcnt lgkmcnt(3)
    buffer_load_dwordx4 v47, s[20:23], s49 offen offset:1024 lds
    v_mfma_f32_16x16x32_bf16 v[208:211], a[224:227], v[96:99], v[200:203]
    v_exp_f32 v212, v212
    v_mfma_f32_16x16x32_bf16 v[208:211], a[228:231], v[100:103], v[208:211]
    v_exp_f32 v213, v213
    v_mfma_f32_16x16x32_bf16 v[208:211], a[232:235], v[104:107], v[208:211]
    v_exp_f32 v214, v214
    v_mfma_f32_16x16x32_bf16 v[208:211], a[236:239], v[108:111], v[208:211]
    v_exp_f32 v215, v215
    v_mfma_f32_16x16x32_bf16 a[48:51], a[184:187], v[128:131], a[48:51]
    ds_read_b64_tr_b16 a[164:165], v24 offset:40960
    v_cvt_pk_bf16_f32 v170, v212, v213
    v_mfma_f32_16x16x32_bf16 a[48:51], a[188:191], v[132:135], a[48:51]
    ds_read_b64_tr_b16 a[166:167], v24 offset:45056
    v_and_b32 v225, 0xffff0000, v246
    v_mfma_f32_16x16x32_bf16 a[52:55], a[184:187], v[136:139], a[52:55]
    ds_read_b128 a[220:223], v11 offset:57344
    v_cvt_pk_bf16_f32 v171, v214, v215
    v_mfma_f32_16x16x32_bf16 a[52:55], a[188:191], v[140:143], a[52:55]
    v_add_f32 v224, s36, v224
    v_add_f32 v225, s36, v225
    v_smfmac_f32_16x16x64_bf16 a[200:203], v[52:55], v[144:151], v50
    v_mfma_f32_16x16x32_bf16 v[212:215], a[224:227], v[112:115], v[204:207]
    v_exp_f32 v208, v208
    v_mfma_f32_16x16x32_bf16 v[212:215], a[228:231], v[116:119], v[212:215]
    v_exp_f32 v209, v209
    v_mfma_f32_16x16x32_bf16 v[212:215], a[232:235], v[120:123], v[212:215]
    v_exp_f32 v210, v210
    v_mfma_f32_16x16x32_bf16 v[212:215], a[236:239], v[124:127], v[212:215]
    v_exp_f32 v211, v211
    v_mfma_f32_16x16x32_bf16 a[56:59], a[184:187], v[144:147], a[56:59]
    ds_read_b64_tr_b16 a[168:169], v25 offset:32768
    v_cvt_pk_bf16_f32 v178, v208, v209
    v_mfma_f32_16x16x32_bf16 a[56:59], a[188:191], v[148:151], a[56:59]
    ds_read_b64_tr_b16 a[170:171], v25 offset:36864
    v_cvt_pk_bf16_f32 v246, v224, v225
    v_mfma_f32_16x16x32_bf16 a[60:63], a[184:187], v[152:155], a[60:63]
    ds_read_b128 a[224:227], v8 offset:61440
    v_cvt_pk_bf16_f32 v179, v210, v211
    v_mfma_f32_16x16x32_bf16 a[60:63], a[188:191], v[156:159], a[60:63]
    s_waitcnt lgkmcnt(3)
    buffer_load_dwordx4 v48, s[20:23], s49 offen offset:2048 lds
    v_mfma_f32_16x16x32_bf16 v[208:211], a[208:211], v[64:67], v[192:195]
    v_exp_f32 v212, v212
    v_mfma_f32_16x16x32_bf16 v[208:211], a[212:215], v[68:71], v[208:211]
    v_exp_f32 v213, v213
    v_mfma_f32_16x16x32_bf16 v[208:211], a[216:219], v[72:75], v[208:211]
    v_exp_f32 v214, v214
    v_mfma_f32_16x16x32_bf16 v[208:211], a[220:223], v[76:79], v[208:211]
    s_add_u32 s57, s58, 4718592
    v_exp_f32 v215, v215
    v_mfma_f32_16x16x32_bf16 a[64:67], a[160:163], v[128:131], a[64:67]
    ds_read_b64_tr_b16 a[172:173], v25 offset:40960
    v_cvt_pk_bf16_f32 v186, v212, v213
    v_mfma_f32_16x16x32_bf16 a[64:67], a[164:167], v[132:135], a[64:67]
    ds_read_b64_tr_b16 a[174:175], v25 offset:45056
    v_lshrrev_b32 v244, 1, v0
    v_mfma_f32_16x16x32_bf16 a[68:71], a[160:163], v[136:139], a[68:71]
    ds_read_b128 a[228:231], v9 offset:61440
    v_cvt_pk_bf16_f32 v187, v214, v215
    v_mfma_f32_16x16x32_bf16 a[68:71], a[164:167], v[140:143], a[68:71]
    buffer_load_dwordx4 a[248:251], v254, s[32:35], s57 offen
    v_smfmac_f32_16x16x64_bf16 a[204:207], v[52:55], v[152:159], v50
    v_mfma_f32_16x16x32_bf16 v[212:215], a[208:211], v[80:83], v[196:199]
    v_exp_f32 v208, v208
    v_mfma_f32_16x16x32_bf16 v[212:215], a[212:215], v[84:87], v[212:215]
    v_exp_f32 v209, v209
    v_mfma_f32_16x16x32_bf16 v[212:215], a[216:219], v[88:91], v[212:215]
    v_exp_f32 v210, v210
    v_mfma_f32_16x16x32_bf16 v[212:215], a[220:223], v[92:95], v[212:215]
    v_exp_f32 v211, v211
    v_mfma_f32_16x16x32_bf16 a[72:75], a[160:163], v[144:147], a[72:75]
    ds_read_b64_tr_b16 a[176:177], v26 offset:32768
    v_cvt_pk_bf16_f32 v164, v208, v209
    v_mfma_f32_16x16x32_bf16 a[72:75], a[164:167], v[148:151], a[72:75]
    ds_read_b64_tr_b16 a[178:179], v26 offset:36864
    v_lshlrev_b32 v244, 4, v244
    v_mfma_f32_16x16x32_bf16 a[76:79], a[160:163], v[152:155], a[76:79]
    ds_read_b128 a[232:235], v10 offset:61440
    v_cvt_pk_bf16_f32 v165, v210, v211
    v_mfma_f32_16x16x32_bf16 a[76:79], a[164:167], v[156:159], a[76:79]
    s_waitcnt lgkmcnt(3)
    buffer_load_dwordx4 v49, s[20:23], s49 offen offset:3072 lds
    v_mfma_f32_16x16x32_bf16 v[208:211], a[208:211], v[96:99], v[200:203]
    v_exp_f32 v212, v212
    v_mfma_f32_16x16x32_bf16 v[208:211], a[212:215], v[100:103], v[208:211]
    v_exp_f32 v213, v213
    v_mfma_f32_16x16x32_bf16 v[208:211], a[216:219], v[104:107], v[208:211]
    v_exp_f32 v214, v214
    v_mfma_f32_16x16x32_bf16 v[208:211], a[220:223], v[108:111], v[208:211]
    v_exp_f32 v215, v215
    v_mfma_f32_16x16x32_bf16 a[80:83], a[168:171], v[128:131], a[80:83]
    ds_read_b64_tr_b16 a[180:181], v26 offset:40960
    v_cvt_pk_bf16_f32 v172, v212, v213
    v_mfma_f32_16x16x32_bf16 a[80:83], a[172:175], v[132:135], a[80:83]
    ds_read_b64_tr_b16 a[182:183], v26 offset:45056
    v_and_b32 v245, 1, v0
    v_mfma_f32_16x16x32_bf16 a[84:87], a[168:171], v[136:139], a[84:87]
    ds_read_b128 a[236:239], v11 offset:61440
    v_cvt_pk_bf16_f32 v173, v214, v215
    v_mfma_f32_16x16x32_bf16 a[84:87], a[172:175], v[140:143], a[84:87]
    s_waitcnt vmcnt(12)
    s_barrier
    v_mfma_f32_16x16x32_bf16 v[212:215], a[208:211], v[112:115], v[204:207]
    v_exp_f32 v208, v208
    v_mfma_f32_16x16x32_bf16 v[212:215], a[212:215], v[116:119], v[212:215]
    s_add_u32 s49, s7, 73728
    v_exp_f32 v209, v209
    v_mfma_f32_16x16x32_bf16 v[212:215], a[216:219], v[120:123], v[212:215]
    s_add_u32 m0, s42, 81920
    v_exp_f32 v210, v210
    v_mfma_f32_16x16x32_bf16 v[212:215], a[220:223], v[124:127], v[212:215]
Ltour7:
    s_cbranch_execz Ltour11
    v_exp_f32 v211, v211
    v_mfma_f32_16x16x32_bf16 a[88:91], a[168:171], v[144:147], a[88:91]
    ds_read_b64_tr_b16 a[184:185], v27 offset:32768
    v_cvt_pk_bf16_f32 v180, v208, v209
    v_mfma_f32_16x16x32_bf16 a[88:91], a[172:175], v[148:151], a[88:91]
    ds_read_b64_tr_b16 a[186:187], v27 offset:36864
    v_lshl_add_u32 v244, v245, 2, v244
    v_mfma_f32_16x16x32_bf16 a[92:95], a[168:171], v[152:155], a[92:95]
    v_cvt_pk_bf16_f32 v181, v210, v211
    v_mfma_f32_16x16x32_bf16 a[92:95], a[172:175], v[156:159], a[92:95]
    s_waitcnt lgkmcnt(3)
    buffer_load_dwordx4 v46, s[20:23], s49 offen lds
    v_mfma_f32_16x16x32_bf16 v[208:211], a[224:227], v[64:67], v[192:195]
    v_exp_f32 v212, v212
    v_mfma_f32_16x16x32_bf16 v[208:211], a[228:231], v[68:71], v[208:211]
    v_exp_f32 v213, v213
    v_mfma_f32_16x16x32_bf16 v[208:211], a[232:235], v[72:75], v[208:211]
    s_waitcnt lgkmcnt(2)
    v_exp_f32 v214, v214
    v_mfma_f32_16x16x32_bf16 v[208:211], a[236:239], v[76:79], v[208:211]
    s_add_u32 s37, s55, 8192
    v_exp_f32 v215, v215
    v_mfma_f32_16x16x32_bf16 a[96:99], a[176:179], v[128:131], a[96:99]
    ds_read_b64_tr_b16 a[188:189], v27 offset:40960
    v_cvt_pk_bf16_f32 v188, v212, v213
    v_mfma_f32_16x16x32_bf16 a[96:99], a[180:183], v[132:135], a[96:99]
    ds_read_b64_tr_b16 a[190:191], v27 offset:45056
    v_lshrrev_b32 v245, 3, v0
    v_mfma_f32_16x16x32_bf16 a[100:103], a[176:179], v[136:139], a[100:103]
    v_cvt_pk_bf16_f32 v189, v214, v215
    v_mfma_f32_16x16x32_bf16 a[100:103], a[180:183], v[140:143], a[100:103]
    buffer_load_dword v239, v238, s[28:31], s37 offen
    v_mfma_f32_16x16x32_bf16 v[212:215], a[224:227], v[80:83], v[196:199]
    v_exp_f32 v208, v208
    v_mfma_f32_16x16x32_bf16 v[212:215], a[228:231], v[84:87], v[212:215]
    v_exp_f32 v209, v209
    v_mfma_f32_16x16x32_bf16 v[212:215], a[232:235], v[88:91], v[212:215]
    v_exp_f32 v210, v210
    v_mfma_f32_16x16x32_bf16 v[212:215], a[236:239], v[92:95], v[212:215]
    v_exp_f32 v211, v211
    v_mfma_f32_16x16x32_bf16 a[104:107], a[176:179], v[144:147], a[104:107]
    ds_read_b64_tr_b16 a[160:161], v20 offset:49152
    v_cvt_pk_bf16_f32 v166, v208, v209
    v_mfma_f32_16x16x32_bf16 a[104:107], a[180:183], v[148:151], a[104:107]
    ds_read_b64_tr_b16 a[162:163], v20 offset:53248
    v_min_u32 v245, 1, v245
    v_mfma_f32_16x16x32_bf16 a[108:111], a[176:179], v[152:155], a[108:111]
    v_cvt_pk_bf16_f32 v167, v210, v211
    v_mfma_f32_16x16x32_bf16 a[108:111], a[180:183], v[156:159], a[108:111]
    s_waitcnt lgkmcnt(3)
    buffer_load_dwordx4 v47, s[20:23], s49 offen offset:1024 lds
    v_mfma_f32_16x16x32_bf16 v[208:211], a[224:227], v[96:99], v[200:203]
    v_exp_f32 v212, v212
    v_mfma_f32_16x16x32_bf16 v[208:211], a[228:231], v[100:103], v[208:211]
    v_exp_f32 v213, v213
    v_mfma_f32_16x16x32_bf16 v[208:211], a[232:235], v[104:107], v[208:211]
    v_exp_f32 v214, v214
    v_mfma_f32_16x16x32_bf16 v[208:211], a[236:239], v[108:111], v[208:211]
    s_add_u32 s57, s59, 0
    v_exp_f32 v215, v215
    v_mfma_f32_16x16x32_bf16 a[112:115], a[184:187], v[128:131], a[112:115]
    s_waitcnt lgkmcnt(2)
    ds_read_b64_tr_b16 a[164:165], v20 offset:57344
    v_cvt_pk_bf16_f32 v174, v212, v213
    v_mfma_f32_16x16x32_bf16 a[112:115], a[188:191], v[132:135], a[112:115]
    ds_read_b64_tr_b16 a[166:167], v20 offset:61440
    v_lshl_or_b32 v244, v245, 31, v244
    v_mfma_f32_16x16x32_bf16 a[116:119], a[184:187], v[136:139], a[116:119]
    v_cvt_pk_bf16_f32 v175, v214, v215
    v_mfma_f32_16x16x32_bf16 a[116:119], a[188:191], v[140:143], a[116:119]
    buffer_load_dwordx4 a[252:255], v255, s[84:87], s57 offen
    v_mfma_f32_16x16x32_bf16 v[212:215], a[224:227], v[112:115], v[204:207]
    v_exp_f32 v208, v208
    v_mfma_f32_16x16x32_bf16 v[212:215], a[228:231], v[116:119], v[212:215]
    v_exp_f32 v209, v209
    v_mfma_f32_16x16x32_bf16 v[212:215], a[232:235], v[120:123], v[212:215]
    v_exp_f32 v210, v210
    v_mfma_f32_16x16x32_bf16 v[212:215], a[236:239], v[124:127], v[212:215]
    v_exp_f32 v211, v211
    v_mfma_f32_16x16x32_bf16 a[120:123], a[184:187], v[144:147], a[120:123]
    ds_read_b64_tr_b16 a[168:169], v21 offset:49152
    v_cvt_pk_bf16_f32 v182, v208, v209
    v_mfma_f32_16x16x32_bf16 a[120:123], a[188:191], v[148:151], a[120:123]
    ds_read_b64_tr_b16 a[170:171], v21 offset:53248
    v_mfma_f32_16x16x32_bf16 a[124:127], a[184:187], v[152:155], a[124:127]
    v_cvt_pk_bf16_f32 v183, v210, v211
    v_mfma_f32_16x16x32_bf16 a[124:127], a[188:191], v[156:159], a[124:127]
    s_waitcnt lgkmcnt(3)
    buffer_load_dwordx4 v48, s[20:23], s49 offen offset:2048 lds
    v_exp_f32 v212, v212
    v_exp_f32 v213, v213
    v_exp_f32 v214, v214
    v_exp_f32 v215, v215
    v_mfma_f32_16x16x32_bf16 a[0:3], a[160:163], v[160:163], a[0:3]
    s_waitcnt lgkmcnt(2)
    ds_read_b64_tr_b16 a[172:173], v21 offset:57344
    v_cvt_pk_bf16_f32 v190, v212, v213
    v_mfma_f32_16x16x32_bf16 a[0:3], a[164:167], v[164:167], a[0:3]
    ds_read_b64_tr_b16 a[174:175], v21 offset:61440
    v_mfma_f32_16x16x32_bf16 a[4:7], a[160:163], v[168:171], a[4:7]
    v_cvt_pk_bf16_f32 v191, v214, v215
    v_mfma_f32_16x16x32_bf16 a[4:7], a[164:167], v[172:175], a[4:7]
    buffer_store_dword v246, v244, s[24:27], s39 offen sc1
    v_mfma_f32_16x16x32_bf16 a[8:11], a[160:163], v[176:179], a[8:11]
    ds_read_b64_tr_b16 a[176:177], v22 offset:49152
    v_mfma_f32_16x16x32_bf16 a[8:11], a[164:167], v[180:183], a[8:11]
    ds_read_b64_tr_b16 a[178:179], v22 offset:53248
    v_mfma_f32_16x16x32_bf16 a[12:15], a[160:163], v[184:187], a[12:15]
    v_mfma_f32_16x16x32_bf16 a[12:15], a[164:167], v[188:191], a[12:15]
    buffer_load_dwordx4 v49, s[20:23], s49 offen offset:3072 lds
    v_smfmac_f32_16x16x64_bf16 a[192:195], v[52:55], v[160:167], v50
    s_waitcnt lgkmcnt(4)
    v_mfma_f32_16x16x32_bf16 a[16:19], a[168:171], v[160:163], a[16:19]
    s_waitcnt lgkmcnt(2)
    ds_read_b64_tr_b16 a[180:181], v22 offset:57344
    v_mfma_f32_16x16x32_bf16 a[16:19], a[172:175], v[164:167], a[16:19]
    ds_read_b64_tr_b16 a[182:183], v22 offset:61440
    v_mfma_f32_16x16x32_bf16 a[20:23], a[168:171], v[168:171], a[20:23]
    v_min_u32 v240, 1, v0
    v_mfma_f32_16x16x32_bf16 a[20:23], a[172:175], v[172:175], a[20:23]
    v_smfmac_f32_16x16x64_bf16 a[196:199], v[52:55], v[168:175], v50
    s_add_u32 s49, s7, 256
    s_add_u32 m0, s42, 32768
    v_mfma_f32_16x16x32_bf16 a[24:27], a[168:171], v[176:179], a[24:27]
    ds_read_b64_tr_b16 a[184:185], v23 offset:49152
    v_mfma_f32_16x16x32_bf16 a[24:27], a[172:175], v[180:183], a[24:27]
    ds_read_b64_tr_b16 a[186:187], v23 offset:53248
    v_mfma_f32_16x16x32_bf16 a[28:31], a[168:171], v[184:187], a[28:31]
    v_lshlrev_b32 v240, 31, v240
    v_mfma_f32_16x16x32_bf16 a[28:31], a[172:175], v[188:191], a[28:31]
    buffer_load_dwordx4 v46, s[20:23], s49 offen lds
    v_smfmac_f32_16x16x64_bf16 a[200:203], v[52:55], v[176:183], v50
    s_waitcnt lgkmcnt(4)
    v_mfma_f32_16x16x32_bf16 a[32:35], a[176:179], v[160:163], a[32:35]
    s_waitcnt lgkmcnt(2)
    ds_read_b64_tr_b16 a[188:189], v23 offset:57344
    v_mfma_f32_16x16x32_bf16 a[32:35], a[180:183], v[164:167], a[32:35]
    ds_read_b64_tr_b16 a[190:191], v23 offset:61440
    v_mfma_f32_16x16x32_bf16 a[36:39], a[176:179], v[168:171], a[36:39]
    v_mov_b32 v241, 1
    v_mfma_f32_16x16x32_bf16 a[36:39], a[180:183], v[172:175], a[36:39]
    v_smfmac_f32_16x16x64_bf16 a[204:207], v[52:55], v[184:191], v50
    v_mfma_f32_16x16x32_bf16 a[40:43], a[176:179], v[176:179], a[40:43]
    ds_read_b64_tr_b16 a[160:161], v24 offset:49152
    v_mfma_f32_16x16x32_bf16 a[40:43], a[180:183], v[180:183], a[40:43]
    ds_read_b64_tr_b16 a[162:163], v24 offset:53248
    v_mfma_f32_16x16x32_bf16 a[44:47], a[176:179], v[184:187], a[44:47]
    v_mfma_f32_16x16x32_bf16 a[44:47], a[180:183], v[188:191], a[44:47]
    s_waitcnt lgkmcnt(4)
    buffer_load_dwordx4 v47, s[20:23], s49 offen offset:1024 lds
    v_mfma_f32_16x16x32_bf16 a[48:51], a[184:187], v[160:163], a[48:51]
    s_waitcnt lgkmcnt(2)
    ds_read_b64_tr_b16 a[164:165], v24 offset:57344
    v_accvgpr_read_b32 v216, a192
    v_mfma_f32_16x16x32_bf16 a[48:51], a[188:191], v[164:167], a[48:51]
    ds_read_b64_tr_b16 a[166:167], v24 offset:61440
    v_accvgpr_read_b32 v217, a193
    v_mfma_f32_16x16x32_bf16 a[52:55], a[184:187], v[168:171], a[52:55]
    v_accvgpr_read_b32 v218, a196
    v_accvgpr_read_b32 v219, a197
    v_mfma_f32_16x16x32_bf16 a[52:55], a[188:191], v[172:175], a[52:55]
    v_accvgpr_read_b32 v220, a200
    v_accvgpr_read_b32 v221, a201
    v_mfma_f32_16x16x32_bf16 a[56:59], a[184:187], v[176:179], a[56:59]
    ds_read_b64_tr_b16 a[168:169], v25 offset:49152
    v_accvgpr_read_b32 v222, a204
    v_mfma_f32_16x16x32_bf16 a[56:59], a[188:191], v[180:183], a[56:59]
    ds_read_b64_tr_b16 a[170:171], v25 offset:53248
    v_accvgpr_read_b32 v223, a205
    v_mfma_f32_16x16x32_bf16 a[60:63], a[184:187], v[184:187], a[60:63]
    v_add_f32 v58, v216, v217
    v_add_f32 v59, v218, v219
    v_mfma_f32_16x16x32_bf16 a[60:63], a[188:191], v[188:191], a[60:63]
    s_waitcnt lgkmcnt(4)
    buffer_load_dwordx4 v48, s[20:23], s49 offen offset:2048 lds
    v_add_f32 v60, v220, v221
    v_add_f32 v61, v222, v223
    v_mfma_f32_16x16x32_bf16 a[64:67], a[160:163], v[160:163], a[64:67]
    s_waitcnt lgkmcnt(2)
    ds_read_b64_tr_b16 a[172:173], v25 offset:57344
    v_add_f32 v216, v58, v59
    v_mfma_f32_16x16x32_bf16 a[64:67], a[164:167], v[164:167], a[64:67]
    ds_read_b64_tr_b16 a[174:175], v25 offset:61440
    v_add_f32 v217, v60, v61
    v_mfma_f32_16x16x32_bf16 a[68:71], a[160:163], v[168:171], a[68:71]
    v_add_f32 v216, v216, v217
    v_cmp_ngt_f32 vcc, 1669332992, v216
    v_mfma_f32_16x16x32_bf16 a[68:71], a[164:167], v[172:175], a[68:71]
    v_rcp_f32 v58, v58
    v_rcp_f32 v59, v59
    v_mfma_f32_16x16x32_bf16 a[72:75], a[160:163], v[176:179], a[72:75]
    ds_read_b64_tr_b16 a[176:177], v26 offset:49152
    v_rcp_f32 v60, v60
    v_mfma_f32_16x16x32_bf16 a[72:75], a[164:167], v[180:183], a[72:75]
    ds_read_b64_tr_b16 a[178:179], v26 offset:53248
    v_rcp_f32 v61, v61
    v_mfma_f32_16x16x32_bf16 a[76:79], a[160:163], v[184:187], a[76:79]
    v_mov_b32 v228, 131072
    s_or_b32 s36, vcc_lo, vcc_hi
    v_mfma_f32_16x16x32_bf16 a[76:79], a[164:167], v[188:191], a[76:79]
    s_waitcnt lgkmcnt(4)
    buffer_load_dwordx4 v49, s[20:23], s49 offen offset:3072 lds
    v_mov_b32 v218, s36
    s_lshl_b32 s37, s3, 2
    v_mfma_f32_16x16x32_bf16 a[80:83], a[168:171], v[160:163], a[80:83]
    s_waitcnt lgkmcnt(2)
    ds_read_b64_tr_b16 a[180:181], v26 offset:57344
    v_add_u32 v219, s37, v228
    ds_write_b32 v219, v218
    v_mfma_f32_16x16x32_bf16 a[80:83], a[172:175], v[164:167], a[80:83]
    ds_read_b64_tr_b16 a[182:183], v26 offset:61440
    v_mfma_f32_16x16x32_bf16 a[84:87], a[168:171], v[168:171], a[84:87]
    v_mfma_f32_16x16x32_bf16 a[84:87], a[172:175], v[172:175], a[84:87]
    s_waitcnt lgkmcnt(1)
    s_waitcnt vmcnt(17)
    s_barrier
    v_mfma_f32_16x16x32_bf16 a[88:91], a[168:171], v[176:179], a[88:91]
    ds_read_b64_tr_b16 a[184:185], v27 offset:49152
    v_mfma_f32_16x16x32_bf16 a[88:91], a[172:175], v[180:183], a[88:91]
    ds_read_b64_tr_b16 a[186:187], v27 offset:53248
    v_mfma_f32_16x16x32_bf16 a[92:95], a[168:171], v[184:187], a[92:95]
    ds_read_b128 v[224:227], v228
    v_mfma_f32_16x16x32_bf16 a[92:95], a[172:175], v[188:191], a[92:95]
    s_add_u32 s49, s7, 73984
    v_mfma_f32_16x16x32_bf16 a[96:99], a[176:179], v[160:163], a[96:99]
    s_waitcnt lgkmcnt(3)
    s_add_u32 m0, s42, 49152
    ds_read_b64_tr_b16 a[188:189], v27 offset:57344
    v_mfma_f32_16x16x32_bf16 a[96:99], a[180:183], v[164:167], a[96:99]
    buffer_load_dwordx4 v46, s[20:23], s49 offen lds
    v_mfma_f32_16x16x32_bf16 a[100:103], a[176:179], v[168:171], a[100:103]
    ds_read_b64_tr_b16 a[190:191], v27 offset:61440
    v_mfma_f32_16x16x32_bf16 a[100:103], a[180:183], v[172:175], a[100:103]
    buffer_load_dwordx4 v47, s[20:23], s49 offen offset:1024 lds
    v_mfma_f32_16x16x32_bf16 a[104:107], a[176:179], v[176:179], a[104:107]
    v_mfma_f32_16x16x32_bf16 a[104:107], a[180:183], v[180:183], a[104:107]
    buffer_load_dwordx4 v48, s[20:23], s49 offen offset:2048 lds
    v_mfma_f32_16x16x32_bf16 a[108:111], a[176:179], v[184:187], a[108:111]
    v_mfma_f32_16x16x32_bf16 a[108:111], a[180:183], v[188:191], a[108:111]
    s_waitcnt lgkmcnt(3)
    buffer_load_dwordx4 v49, s[20:23], s49 offen offset:3072 lds
    s_add_u32 s49, s46, 0
    v_mfma_f32_16x16x32_bf16 a[112:115], a[184:187], v[160:163], a[112:115]
    s_waitcnt lgkmcnt(0)
    s_add_u32 m0, s42, 98304
    v_mfma_f32_16x16x32_bf16 a[112:115], a[188:191], v[164:167], a[112:115]
    buffer_load_dwordx4 v46, s[20:23], s49 offen lds
    v_mfma_f32_16x16x32_bf16 a[116:119], a[184:187], v[168:171], a[116:119]
    v_mfma_f32_16x16x32_bf16 a[116:119], a[188:191], v[172:175], a[116:119]
    buffer_load_dwordx4 v47, s[20:23], s49 offen offset:1024 lds
    v_mfma_f32_16x16x32_bf16 a[120:123], a[184:187], v[176:179], a[120:123]
    v_mfma_f32_16x16x32_bf16 a[120:123], a[188:191], v[180:183], a[120:123]
    buffer_load_dwordx4 v48, s[20:23], s49 offen offset:2048 lds
    v_mfma_f32_16x16x32_bf16 a[124:127], a[184:187], v[184:187], a[124:127]
    v_mfma_f32_16x16x32_bf16 a[124:127], a[188:191], v[188:191], a[124:127]
    buffer_load_dwordx4 v49, s[20:23], s49 offen offset:3072 lds
    v_or3_b32 v224, v224, v225, v226
    v_or_b32 v224, v224, v227
    s_nop 0
    v_readfirstlane_b32 s36, v224
    v_readfirstlane_b32 s38, v253
    v_min_u32 v8, 1, v1
    v_lshlrev_b32 v8, 31, v8
    v_mov_b32 v10, s95
    s_getreg_b32 s39, hwreg(HW_REG_XCC_ID, 0, 4)
    s_add_u32 s39, s39, s95
    s_cmp_eq_u32 s38, s39
    s_cselect_b32 s53, 1, 0
    ds_read_b64_tr_b16 a[208:209], v12 offset:0
    ds_read_b64_tr_b16 a[210:211], v12 offset:4096
    ds_read_b64_tr_b16 a[212:213], v12 offset:8192
    ds_read_b64_tr_b16 a[214:215], v12 offset:12288
    ds_read_b64_tr_b16 a[216:217], v12 offset:16384
    ds_read_b64_tr_b16 a[218:219], v12 offset:20480
    ds_read_b64_tr_b16 a[220:221], v12 offset:24576
    ds_read_b64_tr_b16 a[222:223], v12 offset:28672
    ds_read_b64_tr_b16 a[224:225], v16 offset:0
    ds_read_b64_tr_b16 a[226:227], v16 offset:4096
    ds_read_b64_tr_b16 a[228:229], v16 offset:8192
    ds_read_b64_tr_b16 a[230:231], v16 offset:12288
    ds_read_b64_tr_b16 a[232:233], v16 offset:16384
    ds_read_b64_tr_b16 a[234:235], v16 offset:20480
    ds_read_b64_tr_b16 a[236:237], v16 offset:24576
    ds_read_b64_tr_b16 a[238:239], v16 offset:28672
    s_andn2_b32 s36, s36, s48
    s_cbranch_scc1 Lattn_redo
    v_accvgpr_read_b32 v216, a0
    v_accvgpr_read_b32 v217, a1
    v_accvgpr_read_b32 v218, a2
    v_accvgpr_read_b32 v219, a3
    v_pk_mul_f32 v[216:217], v[216:217], v[58:59] op_sel:[0,0] op_sel_hi:[1,0]
    v_pk_mul_f32 v[218:219], v[218:219], v[58:59] op_sel:[0,0] op_sel_hi:[1,0]
    v_cvt_pk_bf16_f32 v128, v216, v217
    v_cvt_pk_bf16_f32 v129, v218, v219
    v_accvgpr_read_b32 v220, a4
    v_accvgpr_read_b32 v221, a5
    v_accvgpr_read_b32 v222, a6
    v_accvgpr_read_b32 v223, a7
    v_pk_mul_f32 v[220:221], v[220:221], v[58:59] op_sel:[0,1] op_sel_hi:[1,1]
    v_pk_mul_f32 v[222:223], v[222:223], v[58:59] op_sel:[0,1] op_sel_hi:[1,1]
    v_cvt_pk_bf16_f32 v160, v220, v221
    v_cvt_pk_bf16_f32 v161, v222, v223
    v_accvgpr_read_b32 v224, a8
    v_accvgpr_read_b32 v225, a9
    v_accvgpr_read_b32 v226, a10
    v_accvgpr_read_b32 v227, a11
    v_pk_mul_f32 v[224:225], v[224:225], v[60:61] op_sel:[0,0] op_sel_hi:[1,0]
    v_pk_mul_f32 v[226:227], v[226:227], v[60:61] op_sel:[0,0] op_sel_hi:[1,0]
    v_cvt_pk_bf16_f32 v144, v224, v225
    v_cvt_pk_bf16_f32 v145, v226, v227
    v_accvgpr_read_b32 v228, a12
    v_accvgpr_read_b32 v229, a13
    v_accvgpr_read_b32 v230, a14
    v_accvgpr_read_b32 v231, a15
    v_pk_mul_f32 v[228:229], v[228:229], v[60:61] op_sel:[0,1] op_sel_hi:[1,1]
    v_pk_mul_f32 v[230:231], v[230:231], v[60:61] op_sel:[0,1] op_sel_hi:[1,1]
    v_cvt_pk_bf16_f32 v176, v228, v229
    v_cvt_pk_bf16_f32 v177, v230, v231
    v_accvgpr_read_b32 v216, a16
    v_accvgpr_read_b32 v217, a17
    v_accvgpr_read_b32 v218, a18
    v_accvgpr_read_b32 v219, a19
    v_pk_mul_f32 v[216:217], v[216:217], v[58:59] op_sel:[0,0] op_sel_hi:[1,0]
    v_pk_mul_f32 v[218:219], v[218:219], v[58:59] op_sel:[0,0] op_sel_hi:[1,0]
    v_cvt_pk_bf16_f32 v130, v216, v217
    v_cvt_pk_bf16_f32 v131, v218, v219
    s_add_u32 s37, s55, 0
    buffer_store_dwordx4 v[128:131], v252, s[28:31], s37 offen offset:0
    v_accvgpr_read_b32 v220, a20
    v_accvgpr_read_b32 v221, a21
    v_accvgpr_read_b32 v222, a22
    v_accvgpr_read_b32 v223, a23
    v_pk_mul_f32 v[220:221], v[220:221], v[58:59] op_sel:[0,1] op_sel_hi:[1,1]
    v_pk_mul_f32 v[222:223], v[222:223], v[58:59] op_sel:[0,1] op_sel_hi:[1,1]
    v_cvt_pk_bf16_f32 v162, v220, v221
    v_cvt_pk_bf16_f32 v163, v222, v223
    s_add_u32 s37, s55, 8192
    buffer_store_dwordx4 v[160:163], v252, s[28:31], s37 offen offset:0
    v_accvgpr_read_b32 v224, a24
    v_accvgpr_read_b32 v225, a25
    v_accvgpr_read_b32 v226, a26
    v_accvgpr_read_b32 v227, a27
    v_pk_mul_f32 v[224:225], v[224:225], v[60:61] op_sel:[0,0] op_sel_hi:[1,0]
    v_pk_mul_f32 v[226:227], v[226:227], v[60:61] op_sel:[0,0] op_sel_hi:[1,0]
    v_cvt_pk_bf16_f32 v146, v224, v225
    v_cvt_pk_bf16_f32 v147, v226, v227
    s_add_u32 s37, s55, 4096
    buffer_store_dwordx4 v[144:147], v252, s[28:31], s37 offen offset:0
    v_accvgpr_read_b32 v228, a28
    v_accvgpr_read_b32 v229, a29
    v_accvgpr_read_b32 v230, a30
    v_accvgpr_read_b32 v231, a31
    v_pk_mul_f32 v[228:229], v[228:229], v[60:61] op_sel:[0,1] op_sel_hi:[1,1]
    v_pk_mul_f32 v[230:231], v[230:231], v[60:61] op_sel:[0,1] op_sel_hi:[1,1]
    v_cvt_pk_bf16_f32 v178, v228, v229
    v_cvt_pk_bf16_f32 v179, v230, v231
    s_add_u32 s37, s55, 12288
    buffer_store_dwordx4 v[176:179], v252, s[28:31], s37 offen offset:0
    v_accvgpr_read_b32 v216, a32
    v_accvgpr_read_b32 v217, a33
    v_accvgpr_read_b32 v218, a34
    v_accvgpr_read_b32 v219, a35
    v_pk_mul_f32 v[216:217], v[216:217], v[58:59] op_sel:[0,0] op_sel_hi:[1,0]
    v_pk_mul_f32 v[218:219], v[218:219], v[58:59] op_sel:[0,0] op_sel_hi:[1,0]
    v_cvt_pk_bf16_f32 v132, v216, v217
    v_cvt_pk_bf16_f32 v133, v218, v219
    v_accvgpr_read_b32 v220, a36
    v_accvgpr_read_b32 v221, a37
    v_accvgpr_read_b32 v222, a38
    v_accvgpr_read_b32 v223, a39
    v_pk_mul_f32 v[220:221], v[220:221], v[58:59] op_sel:[0,1] op_sel_hi:[1,1]
    v_pk_mul_f32 v[222:223], v[222:223], v[58:59] op_sel:[0,1] op_sel_hi:[1,1]
    v_cvt_pk_bf16_f32 v164, v220, v221
    v_cvt_pk_bf16_f32 v165, v222, v223
    v_accvgpr_read_b32 v224, a40
    v_accvgpr_read_b32 v225, a41
    v_accvgpr_read_b32 v226, a42
    v_accvgpr_read_b32 v227, a43
    v_pk_mul_f32 v[224:225], v[224:225], v[60:61] op_sel:[0,0] op_sel_hi:[1,0]
    v_pk_mul_f32 v[226:227], v[226:227], v[60:61] op_sel:[0,0] op_sel_hi:[1,0]
    v_cvt_pk_bf16_f32 v148, v224, v225
    v_cvt_pk_bf16_f32 v149, v226, v227
    v_accvgpr_read_b32 v228, a44
    v_accvgpr_read_b32 v229, a45
    v_accvgpr_read_b32 v230, a46
    v_accvgpr_read_b32 v231, a47
    v_pk_mul_f32 v[228:229], v[228:229], v[60:61] op_sel:[0,1] op_sel_hi:[1,1]
    v_pk_mul_f32 v[230:231], v[230:231], v[60:61] op_sel:[0,1] op_sel_hi:[1,1]
    v_cvt_pk_bf16_f32 v180, v228, v229
    v_cvt_pk_bf16_f32 v181, v230, v231
    v_accvgpr_read_b32 v216, a48
    v_accvgpr_read_b32 v217, a49
    v_accvgpr_read_b32 v218, a50
    v_accvgpr_read_b32 v219, a51
    v_pk_mul_f32 v[216:217], v[216:217], v[58:59] op_sel:[0,0] op_sel_hi:[1,0]
    v_pk_mul_f32 v[218:219], v[218:219], v[58:59] op_sel:[0,0] op_sel_hi:[1,0]
    v_cvt_pk_bf16_f32 v134, v216, v217
    v_cvt_pk_bf16_f32 v135, v218, v219
    s_add_u32 s37, s55, 0
    buffer_store_dwordx4 v[132:135], v252, s[28:31], s37 offen offset:1024
    v_accvgpr_read_b32 v220, a52
    v_accvgpr_read_b32 v221, a53
    v_accvgpr_read_b32 v222, a54
    v_accvgpr_read_b32 v223, a55
    v_pk_mul_f32 v[220:221], v[220:221], v[58:59] op_sel:[0,1] op_sel_hi:[1,1]
    v_pk_mul_f32 v[222:223], v[222:223], v[58:59] op_sel:[0,1] op_sel_hi:[1,1]
    v_cvt_pk_bf16_f32 v166, v220, v221
    v_cvt_pk_bf16_f32 v167, v222, v223
    s_add_u32 s37, s55, 8192
    buffer_store_dwordx4 v[164:167], v252, s[28:31], s37 offen offset:1024
    v_accvgpr_read_b32 v224, a56
    v_accvgpr_read_b32 v225, a57
    v_accvgpr_read_b32 v226, a58
    v_accvgpr_read_b32 v227, a59
    v_pk_mul_f32 v[224:225], v[224:225], v[60:61] op_sel:[0,0] op_sel_hi:[1,0]
    v_pk_mul_f32 v[226:227], v[226:227], v[60:61] op_sel:[0,0] op_sel_hi:[1,0]
    v_cvt_pk_bf16_f32 v150, v224, v225
    v_cvt_pk_bf16_f32 v151, v226, v227
    s_add_u32 s37, s55, 4096
    buffer_store_dwordx4 v[148:151], v252, s[28:31], s37 offen offset:1024
    v_accvgpr_read_b32 v228, a60
    v_accvgpr_read_b32 v229, a61
    v_accvgpr_read_b32 v230, a62
    v_accvgpr_read_b32 v231, a63
    v_pk_mul_f32 v[228:229], v[228:229], v[60:61] op_sel:[0,1] op_sel_hi:[1,1]
    v_pk_mul_f32 v[230:231], v[230:231], v[60:61] op_sel:[0,1] op_sel_hi:[1,1]
    v_cvt_pk_bf16_f32 v182, v228, v229
    v_cvt_pk_bf16_f32 v183, v230, v231
    s_add_u32 s37, s55, 12288
    buffer_store_dwordx4 v[180:183], v252, s[28:31], s37 offen offset:1024
    v_accvgpr_read_b32 v216, a64
    v_accvgpr_read_b32 v217, a65
    v_accvgpr_read_b32 v218, a66
    v_accvgpr_read_b32 v219, a67
    v_pk_mul_f32 v[216:217], v[216:217], v[58:59] op_sel:[0,0] op_sel_hi:[1,0]
    v_pk_mul_f32 v[218:219], v[218:219], v[58:59] op_sel:[0,0] op_sel_hi:[1,0]
    v_cvt_pk_bf16_f32 v136, v216, v217
    v_cvt_pk_bf16_f32 v137, v218, v219
    v_accvgpr_read_b32 v220, a68
    v_accvgpr_read_b32 v221, a69
    v_accvgpr_read_b32 v222, a70
    v_accvgpr_read_b32 v223, a71
    v_pk_mul_f32 v[220:221], v[220:221], v[58:59] op_sel:[0,1] op_sel_hi:[1,1]
    v_pk_mul_f32 v[222:223], v[222:223], v[58:59] op_sel:[0,1] op_sel_hi:[1,1]
    v_cvt_pk_bf16_f32 v168, v220, v221
    v_cvt_pk_bf16_f32 v169, v222, v223
    v_accvgpr_read_b32 v224, a72
    v_accvgpr_read_b32 v225, a73
    v_accvgpr_read_b32 v226, a74
    v_accvgpr_read_b32 v227, a75
    v_pk_mul_f32 v[224:225], v[224:225], v[60:61] op_sel:[0,0] op_sel_hi:[1,0]
    v_pk_mul_f32 v[226:227], v[226:227], v[60:61] op_sel:[0,0] op_sel_hi:[1,0]
    v_cvt_pk_bf16_f32 v152, v224, v225
    v_cvt_pk_bf16_f32 v153, v226, v227
    v_accvgpr_read_b32 v228, a76
    v_accvgpr_read_b32 v229, a77
    v_accvgpr_read_b32 v230, a78
    v_accvgpr_read_b32 v231, a79
    v_pk_mul_f32 v[228:229], v[228:229], v[60:61] op_sel:[0,1] op_sel_hi:[1,1]
    v_pk_mul_f32 v[230:231], v[230:231], v[60:61] op_sel:[0,1] op_sel_hi:[1,1]
    v_cvt_pk_bf16_f32 v184, v228, v229
    v_cvt_pk_bf16_f32 v185, v230, v231
    v_accvgpr_read_b32 v216, a80
    v_accvgpr_read_b32 v217, a81
    v_accvgpr_read_b32 v218, a82
    v_accvgpr_read_b32 v219, a83
    v_pk_mul_f32 v[216:217], v[216:217], v[58:59] op_sel:[0,0] op_sel_hi:[1,0]
    v_pk_mul_f32 v[218:219], v[218:219], v[58:59] op_sel:[0,0] op_sel_hi:[1,0]
    v_cvt_pk_bf16_f32 v138, v216, v217
    v_cvt_pk_bf16_f32 v139, v218, v219
    s_add_u32 s37, s55, 0
    buffer_store_dwordx4 v[136:139], v252, s[28:31], s37 offen offset:2048
    v_accvgpr_read_b32 v220, a84
    v_accvgpr_read_b32 v221, a85
    v_accvgpr_read_b32 v222, a86
    v_accvgpr_read_b32 v223, a87
    v_pk_mul_f32 v[220:221], v[220:221], v[58:59] op_sel:[0,1] op_sel_hi:[1,1]
    v_pk_mul_f32 v[222:223], v[222:223], v[58:59] op_sel:[0,1] op_sel_hi:[1,1]
    v_cvt_pk_bf16_f32 v170, v220, v221
    v_cvt_pk_bf16_f32 v171, v222, v223
    s_add_u32 s37, s55, 8192
    buffer_store_dwordx4 v[168:171], v252, s[28:31], s37 offen offset:2048
    v_accvgpr_read_b32 v224, a88
    v_accvgpr_read_b32 v225, a89
    v_accvgpr_read_b32 v226, a90
    v_accvgpr_read_b32 v227, a91
    v_pk_mul_f32 v[224:225], v[224:225], v[60:61] op_sel:[0,0] op_sel_hi:[1,0]
    v_pk_mul_f32 v[226:227], v[226:227], v[60:61] op_sel:[0,0] op_sel_hi:[1,0]
    v_cvt_pk_bf16_f32 v154, v224, v225
    v_cvt_pk_bf16_f32 v155, v226, v227
    s_add_u32 s37, s55, 4096
    buffer_store_dwordx4 v[152:155], v252, s[28:31], s37 offen offset:2048
    v_accvgpr_read_b32 v228, a92
    v_accvgpr_read_b32 v229, a93
    v_accvgpr_read_b32 v230, a94
    v_accvgpr_read_b32 v231, a95
    v_pk_mul_f32 v[228:229], v[228:229], v[60:61] op_sel:[0,1] op_sel_hi:[1,1]
    v_pk_mul_f32 v[230:231], v[230:231], v[60:61] op_sel:[0,1] op_sel_hi:[1,1]
    v_cvt_pk_bf16_f32 v186, v228, v229
    v_cvt_pk_bf16_f32 v187, v230, v231
    s_add_u32 s37, s55, 12288
    buffer_store_dwordx4 v[184:187], v252, s[28:31], s37 offen offset:2048
    v_accvgpr_read_b32 v216, a96
    v_accvgpr_read_b32 v217, a97
    v_accvgpr_read_b32 v218, a98
    v_accvgpr_read_b32 v219, a99
    v_pk_mul_f32 v[216:217], v[216:217], v[58:59] op_sel:[0,0] op_sel_hi:[1,0]
    v_pk_mul_f32 v[218:219], v[218:219], v[58:59] op_sel:[0,0] op_sel_hi:[1,0]
    v_cvt_pk_bf16_f32 v140, v216, v217
    v_cvt_pk_bf16_f32 v141, v218, v219
    v_accvgpr_read_b32 v220, a100
    v_accvgpr_read_b32 v221, a101
    v_accvgpr_read_b32 v222, a102
    v_accvgpr_read_b32 v223, a103
    v_pk_mul_f32 v[220:221], v[220:221], v[58:59] op_sel:[0,1] op_sel_hi:[1,1]
    v_pk_mul_f32 v[222:223], v[222:223], v[58:59] op_sel:[0,1] op_sel_hi:[1,1]
    v_cvt_pk_bf16_f32 v172, v220, v221
    v_cvt_pk_bf16_f32 v173, v222, v223
    v_accvgpr_read_b32 v224, a104
    v_accvgpr_read_b32 v225, a105
    v_accvgpr_read_b32 v226, a106
    v_accvgpr_read_b32 v227, a107
    v_pk_mul_f32 v[224:225], v[224:225], v[60:61] op_sel:[0,0] op_sel_hi:[1,0]
    v_pk_mul_f32 v[226:227], v[226:227], v[60:61] op_sel:[0,0] op_sel_hi:[1,0]
    v_cvt_pk_bf16_f32 v156, v224, v225
    v_cvt_pk_bf16_f32 v157, v226, v227
    v_accvgpr_read_b32 v228, a108
    v_accvgpr_read_b32 v229, a109
    v_accvgpr_read_b32 v230, a110
    v_accvgpr_read_b32 v231, a111
    v_pk_mul_f32 v[228:229], v[228:229], v[60:61] op_sel:[0,1] op_sel_hi:[1,1]
    v_pk_mul_f32 v[230:231], v[230:231], v[60:61] op_sel:[0,1] op_sel_hi:[1,1]
    v_cvt_pk_bf16_f32 v188, v228, v229
    v_cvt_pk_bf16_f32 v189, v230, v231
    v_accvgpr_read_b32 v216, a112
    v_accvgpr_read_b32 v217, a113
    v_accvgpr_read_b32 v218, a114
    v_accvgpr_read_b32 v219, a115
    v_pk_mul_f32 v[216:217], v[216:217], v[58:59] op_sel:[0,0] op_sel_hi:[1,0]
    v_pk_mul_f32 v[218:219], v[218:219], v[58:59] op_sel:[0,0] op_sel_hi:[1,0]
    v_cvt_pk_bf16_f32 v142, v216, v217
    v_cvt_pk_bf16_f32 v143, v218, v219
    s_add_u32 s37, s55, 0
    buffer_store_dwordx4 v[140:143], v252, s[28:31], s37 offen offset:3072
    v_accvgpr_read_b32 v220, a116
    v_accvgpr_read_b32 v221, a117
    v_accvgpr_read_b32 v222, a118
    v_accvgpr_read_b32 v223, a119
    v_pk_mul_f32 v[220:221], v[220:221], v[58:59] op_sel:[0,1] op_sel_hi:[1,1]
    v_pk_mul_f32 v[222:223], v[222:223], v[58:59] op_sel:[0,1] op_sel_hi:[1,1]
    v_cvt_pk_bf16_f32 v174, v220, v221
    v_cvt_pk_bf16_f32 v175, v222, v223
    s_add_u32 s37, s55, 8192
Ltour8:
    s_cbranch_execz Ltour12
    buffer_store_dwordx4 v[172:175], v252, s[28:31], s37 offen offset:3072
    v_accvgpr_read_b32 v224, a120
    v_accvgpr_read_b32 v225, a121
    v_accvgpr_read_b32 v226, a122
    v_accvgpr_read_b32 v227, a123
    v_pk_mul_f32 v[224:225], v[224:225], v[60:61] op_sel:[0,0] op_sel_hi:[1,0]
    v_pk_mul_f32 v[226:227], v[226:227], v[60:61] op_sel:[0,0] op_sel_hi:[1,0]
    v_cvt_pk_bf16_f32 v158, v224, v225
    v_cvt_pk_bf16_f32 v159, v226, v227
    s_add_u32 s37, s55, 4096
    buffer_store_dwordx4 v[156:159], v252, s[28:31], s37 offen offset:3072
    v_accvgpr_read_b32 v228, a124
    v_accvgpr_read_b32 v229, a125
    v_accvgpr_read_b32 v230, a126
    v_accvgpr_read_b32 v231, a127
    v_pk_mul_f32 v[228:229], v[228:229], v[60:61] op_sel:[0,1] op_sel_hi:[1,1]
    v_pk_mul_f32 v[230:231], v[230:231], v[60:61] op_sel:[0,1] op_sel_hi:[1,1]
    v_cvt_pk_bf16_f32 v190, v228, v229
    v_cvt_pk_bf16_f32 v191, v230, v231
    s_add_u32 s37, s55, 12288
    buffer_store_dwordx4 v[188:191], v252, s[28:31], s37 offen offset:3072
    s_waitcnt lgkmcnt(14)
    v_mfma_f32_16x16x32_bf16 v[96:99], a[208:211], v[128:131], 0
    s_waitcnt lgkmcnt(12)
    ds_read_b64_tr_b16 a[160:161], v13 offset:0
    v_mfma_f32_16x16x32_bf16 v[96:99], a[212:215], v[132:135], v[96:99]
    s_waitcnt lgkmcnt(11)
    ds_read_b64_tr_b16 a[162:163], v13 offset:4096
    v_mfma_f32_16x16x32_bf16 v[96:99], a[216:219], v[136:139], v[96:99]
    s_waitcnt lgkmcnt(10)
    ds_read_b64_tr_b16 a[164:165], v13 offset:8192
    v_mfma_f32_16x16x32_bf16 v[96:99], a[220:223], v[140:143], v[96:99]
    s_waitcnt lgkmcnt(9)
    ds_read_b64_tr_b16 a[166:167], v13 offset:12288
    v_mfma_f32_16x16x32_bf16 v[96:99], a[224:227], v[144:147], v[96:99]
    s_waitcnt lgkmcnt(8)
    ds_read_b64_tr_b16 a[168:169], v13 offset:16384
    v_mfma_f32_16x16x32_bf16 v[96:99], a[228:231], v[148:151], v[96:99]
    s_waitcnt lgkmcnt(7)
    ds_read_b64_tr_b16 a[170:171], v13 offset:20480
    v_mfma_f32_16x16x32_bf16 v[96:99], a[232:235], v[152:155], v[96:99]
    s_waitcnt lgkmcnt(6)
    ds_read_b64_tr_b16 a[172:173], v13 offset:24576
    v_mfma_f32_16x16x32_bf16 v[96:99], a[236:239], v[156:159], v[96:99]
    ds_read_b64_tr_b16 a[174:175], v13 offset:28672
    v_mfma_f32_16x16x32_bf16 v[100:103], a[208:211], v[160:163], 0
    ds_read_b64_tr_b16 a[176:177], v17 offset:0
    v_mfma_f32_16x16x32_bf16 v[100:103], a[212:215], v[164:167], v[100:103]
    ds_read_b64_tr_b16 a[178:179], v17 offset:4096
    v_mfma_f32_16x16x32_bf16 v[100:103], a[216:219], v[168:171], v[100:103]
    ds_read_b64_tr_b16 a[180:181], v17 offset:8192
    v_mfma_f32_16x16x32_bf16 v[100:103], a[220:223], v[172:175], v[100:103]
    ds_read_b64_tr_b16 a[182:183], v17 offset:12288
    v_mfma_f32_16x16x32_bf16 v[100:103], a[224:227], v[176:179], v[100:103]
    ds_read_b64_tr_b16 a[184:185], v17 offset:16384
    v_cvt_pk_bf16_f32 v224, v96, v97
    v_mfma_f32_16x16x32_bf16 v[100:103], a[228:231], v[180:183], v[100:103]
    ds_read_b64_tr_b16 a[186:187], v17 offset:20480
    v_cvt_pk_bf16_f32 v225, v98, v99
    v_mfma_f32_16x16x32_bf16 v[100:103], a[232:235], v[184:187], v[100:103]
    ds_read_b64_tr_b16 a[188:189], v17 offset:24576
    v_mfma_f32_16x16x32_bf16 v[100:103], a[236:239], v[188:191], v[100:103]
    s_waitcnt lgkmcnt(13)
    ds_read_b64_tr_b16 a[190:191], v17 offset:28672
    v_mfma_f32_16x16x32_bf16 v[104:107], a[160:163], v[128:131], 0
    s_waitcnt lgkmcnt(12)
    ds_read_b64_tr_b16 a[208:209], v14 offset:0
    v_mfma_f32_16x16x32_bf16 v[104:107], a[164:167], v[132:135], v[104:107]
    s_waitcnt lgkmcnt(11)
    ds_read_b64_tr_b16 a[210:211], v14 offset:4096
    v_mfma_f32_16x16x32_bf16 v[104:107], a[168:171], v[136:139], v[104:107]
    s_waitcnt lgkmcnt(10)
    ds_read_b64_tr_b16 a[212:213], v14 offset:8192
    v_mfma_f32_16x16x32_bf16 v[104:107], a[172:175], v[140:143], v[104:107]
    s_waitcnt lgkmcnt(9)
    ds_read_b64_tr_b16 a[214:215], v14 offset:12288
    v_mfma_f32_16x16x32_bf16 v[104:107], a[176:179], v[144:147], v[104:107]
    s_waitcnt lgkmcnt(8)
    ds_read_b64_tr_b16 a[216:217], v14 offset:16384
    v_cvt_pk_bf16_f32 v228, v100, v101
    v_mfma_f32_16x16x32_bf16 v[104:107], a[180:183], v[148:151], v[104:107]
    s_waitcnt lgkmcnt(7)
    ds_read_b64_tr_b16 a[218:219], v14 offset:20480
    v_cvt_pk_bf16_f32 v229, v102, v103
    v_mfma_f32_16x16x32_bf16 v[104:107], a[184:187], v[152:155], v[104:107]
    s_waitcnt lgkmcnt(6)
    ds_read_b64_tr_b16 a[220:221], v14 offset:24576
    v_mfma_f32_16x16x32_bf16 v[104:107], a[188:191], v[156:159], v[104:107]
    ds_read_b64_tr_b16 a[222:223], v14 offset:28672
    s_waitcnt vmcnt(0)
    s_cmp_eq_u32 s53, 0
    s_cbranch_scc1 Lattn_wb
Lattn_wbdone:
    v_mfma_f32_16x16x32_bf16 v[108:111], a[160:163], v[160:163], 0
    buffer_store_dword v10, v8, s[24:27], s92 offen offset:8 sc1
    v_mfma_f32_16x16x32_bf16 v[108:111], a[164:167], v[164:167], v[108:111]
    s_xor_b32 s55, s55, 65536
    ds_read_b64_tr_b16 a[224:225], v18 offset:0
    ds_read_b64_tr_b16 a[226:227], v18 offset:4096
    v_mfma_f32_16x16x32_bf16 v[108:111], a[168:171], v[168:171], v[108:111]
    buffer_atomic_add v241, v240, s[88:91], 0 offen sc1
    v_mfma_f32_16x16x32_bf16 v[108:111], a[172:175], v[172:175], v[108:111]
    ds_read_b64_tr_b16 a[228:229], v18 offset:8192
    ds_read_b64_tr_b16 a[230:231], v18 offset:12288
    s_load_dwordx2 s[12:13], s[0:1], 0
    v_mfma_f32_16x16x32_bf16 v[108:111], a[176:179], v[176:179], v[108:111]
    ds_read_b64_tr_b16 a[232:233], v18 offset:16384
    v_cvt_pk_bf16_f32 v226, v104, v105
    v_mfma_f32_16x16x32_bf16 v[108:111], a[180:183], v[180:183], v[108:111]
    s_add_u32 s38, s56, 16384
    ds_read_b64_tr_b16 a[234:235], v18 offset:20480
    v_cvt_pk_bf16_f32 v227, v106, v107
    s_load_dwordx2 s[16:17], s[0:1], 96
    v_mfma_f32_16x16x32_bf16 v[108:111], a[184:187], v[184:187], v[108:111]
    buffer_store_dwordx4 v[224:227], v56, s[28:31], s38 offen sc1
    v_mfma_f32_16x16x32_bf16 v[108:111], a[188:191], v[188:191], v[108:111]
    s_waitcnt lgkmcnt(12)
    ds_read_b64_tr_b16 a[236:237], v18 offset:24576
    ds_read_b64_tr_b16 a[238:239], v18 offset:28672
    s_load_dwordx2 s[52:53], s[0:1], 48
    v_mfma_f32_16x16x32_bf16 v[112:115], a[208:211], v[128:131], 0
    s_waitcnt lgkmcnt(12)
    ds_read_b64_tr_b16 a[160:161], v15 offset:0
    v_mfma_f32_16x16x32_bf16 v[112:115], a[212:215], v[132:135], v[112:115]
    s_waitcnt lgkmcnt(11)
    ds_read_b64_tr_b16 a[162:163], v15 offset:4096
    v_mfma_f32_16x16x32_bf16 v[112:115], a[216:219], v[136:139], v[112:115]
    s_waitcnt lgkmcnt(10)
    ds_read_b64_tr_b16 a[164:165], v15 offset:8192
    v_mfma_f32_16x16x32_bf16 v[112:115], a[220:223], v[140:143], v[112:115]
    s_waitcnt lgkmcnt(9)
    ds_read_b64_tr_b16 a[166:167], v15 offset:12288
    v_mfma_f32_16x16x32_bf16 v[112:115], a[224:227], v[144:147], v[112:115]
    s_waitcnt lgkmcnt(8)
    ds_read_b64_tr_b16 a[168:169], v15 offset:16384
    v_cvt_pk_bf16_f32 v230, v108, v109
    v_mfma_f32_16x16x32_bf16 v[112:115], a[228:231], v[148:151], v[112:115]
    s_waitcnt lgkmcnt(7)
    s_add_u32 s38, s56, 180224
    ds_read_b64_tr_b16 a[170:171], v15 offset:20480
    v_cvt_pk_bf16_f32 v231, v110, v111
    v_mfma_f32_16x16x32_bf16 v[112:115], a[232:235], v[152:155], v[112:115]
    s_waitcnt lgkmcnt(6)
    buffer_store_dwordx4 v[228:231], v56, s[28:31], s38 offen sc1
    v_mfma_f32_16x16x32_bf16 v[112:115], a[236:239], v[156:159], v[112:115]
    ds_read_b64_tr_b16 a[172:173], v15 offset:24576
    ds_read_b64_tr_b16 a[174:175], v15 offset:28672
    v_mfma_f32_16x16x32_bf16 v[116:119], a[208:211], v[160:163], 0
    ds_read_b64_tr_b16 a[176:177], v19 offset:0
    v_mfma_f32_16x16x32_bf16 v[116:119], a[212:215], v[164:167], v[116:119]
    ds_read_b64_tr_b16 a[178:179], v19 offset:4096
    v_mfma_f32_16x16x32_bf16 v[116:119], a[216:219], v[168:171], v[116:119]
    ds_read_b64_tr_b16 a[180:181], v19 offset:8192
    v_mfma_f32_16x16x32_bf16 v[116:119], a[220:223], v[172:175], v[116:119]
    ds_read_b64_tr_b16 a[182:183], v19 offset:12288
    v_mfma_f32_16x16x32_bf16 v[116:119], a[224:227], v[176:179], v[116:119]
    ds_read_b64_tr_b16 a[184:185], v19 offset:16384
    v_cvt_pk_bf16_f32 v232, v112, v113
    v_mfma_f32_16x16x32_bf16 v[116:119], a[228:231], v[180:183], v[116:119]
    ds_read_b64_tr_b16 a[186:187], v19 offset:20480
    v_cvt_pk_bf16_f32 v233, v114, v115
    v_mfma_f32_16x16x32_bf16 v[116:119], a[232:235], v[184:187], v[116:119]
    ds_read_b64_tr_b16 a[188:189], v19 offset:24576
    v_mfma_f32_16x16x32_bf16 v[116:119], a[236:239], v[188:191], v[116:119]
    s_waitcnt lgkmcnt(13)
    ds_read_b64_tr_b16 a[190:191], v19 offset:28672
    s_barrier
    v_mfma_f32_16x16x32_bf16 v[120:123], a[160:163], v[128:131], 0
    s_waitcnt lgkmcnt(12)
    buffer_load_dword v11, v8, s[24:27], s54 offen offset:8 sc1
    v_mfma_f32_16x16x32_bf16 v[120:123], a[164:167], v[132:135], v[120:123]
    s_waitcnt lgkmcnt(10)
    ds_read_b64_tr_b16 a[208:209], v20 offset:0
    ds_read_b64_tr_b16 a[210:211], v20 offset:4096
    v_mfma_f32_16x16x32_bf16 v[120:123], a[168:171], v[136:139], v[120:123]
    s_waitcnt lgkmcnt(10)
    ds_read_b64_tr_b16 a[212:213], v20 offset:8192
    v_mfma_f32_16x16x32_bf16 v[120:123], a[172:175], v[140:143], v[120:123]
    s_waitcnt lgkmcnt(9)
    ds_read_b64_tr_b16 a[214:215], v20 offset:12288
    v_mfma_f32_16x16x32_bf16 v[120:123], a[176:179], v[144:147], v[120:123]
    s_waitcnt lgkmcnt(8)
    ds_read_b64_tr_b16 a[216:217], v20 offset:16384
    v_cvt_pk_bf16_f32 v236, v116, v117
    v_mfma_f32_16x16x32_bf16 v[120:123], a[180:183], v[148:151], v[120:123]
    s_waitcnt lgkmcnt(7)
    ds_read_b64_tr_b16 a[218:219], v20 offset:20480
    v_cvt_pk_bf16_f32 v237, v118, v119
    v_mfma_f32_16x16x32_bf16 v[120:123], a[184:187], v[152:155], v[120:123]
    s_waitcnt lgkmcnt(6)
    s_add_u32 s49, s46, 73728
    ds_read_b64_tr_b16 a[220:221], v20 offset:24576
    v_mfma_f32_16x16x32_bf16 v[120:123], a[188:191], v[156:159], v[120:123]
    s_add_u32 m0, s42, 114688
    ds_read_b64_tr_b16 a[222:223], v20 offset:28672
    v_mfma_f32_16x16x32_bf16 v[124:127], a[160:163], v[160:163], 0
    buffer_load_dwordx4 v46, s[20:23], s49 offen lds
    v_mfma_f32_16x16x32_bf16 v[124:127], a[164:167], v[164:167], v[124:127]
    ds_read_b64_tr_b16 a[224:225], v24 offset:0
    ds_read_b64_tr_b16 a[226:227], v24 offset:4096
    v_mfma_f32_16x16x32_bf16 v[124:127], a[168:171], v[168:171], v[124:127]
    buffer_load_dwordx4 v47, s[20:23], s49 offen offset:1024 lds
    v_mfma_f32_16x16x32_bf16 v[124:127], a[172:175], v[172:175], v[124:127]
    ds_read_b64_tr_b16 a[228:229], v24 offset:8192
    ds_read_b64_tr_b16 a[230:231], v24 offset:12288
    v_mfma_f32_16x16x32_bf16 v[124:127], a[176:179], v[176:179], v[124:127]
    ds_read_b64_tr_b16 a[232:233], v24 offset:16384
    v_cvt_pk_bf16_f32 v234, v120, v121
    v_mfma_f32_16x16x32_bf16 v[124:127], a[180:183], v[180:183], v[124:127]
    s_add_u32 s38, s56, 16512
    ds_read_b64_tr_b16 a[234:235], v24 offset:20480
    v_cvt_pk_bf16_f32 v235, v122, v123
    v_mfma_f32_16x16x32_bf16 v[124:127], a[184:187], v[184:187], v[124:127]
    buffer_store_dwordx4 v[232:235], v56, s[28:31], s38 offen sc1
    v_mfma_f32_16x16x32_bf16 v[124:127], a[188:191], v[188:191], v[124:127]
    s_waitcnt lgkmcnt(12)
    ds_read_b64_tr_b16 a[236:237], v24 offset:24576
    ds_read_b64_tr_b16 a[238:239], v24 offset:28672
    v_mfma_f32_16x16x32_bf16 v[64:67], a[208:211], v[128:131], 0
    s_waitcnt lgkmcnt(12)
    buffer_load_dwordx4 v48, s[20:23], s49 offen offset:2048 lds
    v_mfma_f32_16x16x32_bf16 v[64:67], a[212:215], v[132:135], v[64:67]
    s_waitcnt lgkmcnt(10)
    ds_read_b64_tr_b16 a[160:161], v21 offset:0
    ds_read_b64_tr_b16 a[162:163], v21 offset:4096
    v_mfma_f32_16x16x32_bf16 v[64:67], a[216:219], v[136:139], v[64:67]
    s_waitcnt lgkmcnt(10)
    buffer_load_dwordx4 v49, s[20:23], s49 offen offset:3072 lds
    v_mfma_f32_16x16x32_bf16 v[64:67], a[220:223], v[140:143], v[64:67]
    s_waitcnt lgkmcnt(8)
    ds_read_b64_tr_b16 a[164:165], v21 offset:8192
    ds_read_b64_tr_b16 a[166:167], v21 offset:12288
    v_mfma_f32_16x16x32_bf16 v[64:67], a[224:227], v[144:147], v[64:67]
    s_waitcnt lgkmcnt(8)
    ds_read_b64_tr_b16 a[168:169], v21 offset:16384
    v_cvt_pk_bf16_f32 v238, v124, v125
    v_mfma_f32_16x16x32_bf16 v[64:67], a[228:231], v[148:151], v[64:67]
    s_waitcnt lgkmcnt(7)
    s_add_u32 s38, s56, 180352
    ds_read_b64_tr_b16 a[170:171], v21 offset:20480
    v_cvt_pk_bf16_f32 v239, v126, v127
    v_mfma_f32_16x16x32_bf16 v[64:67], a[232:235], v[152:155], v[64:67]
    s_waitcnt lgkmcnt(6)
    buffer_store_dwordx4 v[236:239], v56, s[28:31], s38 offen sc1
    v_mfma_f32_16x16x32_bf16 v[64:67], a[236:239], v[156:159], v[64:67]
    ds_read_b64_tr_b16 a[172:173], v21 offset:24576
    ds_read_b64_tr_b16 a[174:175], v21 offset:28672
    v_mfma_f32_16x16x32_bf16 v[68:71], a[208:211], v[160:163], 0
    ds_read_b64_tr_b16 a[176:177], v25 offset:0
    v_mfma_f32_16x16x32_bf16 v[68:71], a[212:215], v[164:167], v[68:71]
    ds_read_b64_tr_b16 a[178:179], v25 offset:4096
    v_mfma_f32_16x16x32_bf16 v[68:71], a[216:219], v[168:171], v[68:71]
    ds_read_b64_tr_b16 a[180:181], v25 offset:8192
    v_mfma_f32_16x16x32_bf16 v[68:71], a[220:223], v[172:175], v[68:71]
    ds_read_b64_tr_b16 a[182:183], v25 offset:12288
    v_mfma_f32_16x16x32_bf16 v[68:71], a[224:227], v[176:179], v[68:71]
    ds_read_b64_tr_b16 a[184:185], v25 offset:16384
    v_mfma_f32_16x16x32_bf16 v[68:71], a[228:231], v[180:183], v[68:71]
    ds_read_b64_tr_b16 a[186:187], v25 offset:20480
    v_mfma_f32_16x16x32_bf16 v[68:71], a[232:235], v[184:187], v[68:71]
    ds_read_b64_tr_b16 a[188:189], v25 offset:24576
    v_mfma_f32_16x16x32_bf16 v[68:71], a[236:239], v[188:191], v[68:71]
    s_waitcnt lgkmcnt(13)
    ds_read_b64_tr_b16 a[190:191], v25 offset:28672
    v_mfma_f32_16x16x32_bf16 v[72:75], a[160:163], v[128:131], 0
    s_waitcnt lgkmcnt(12)
    ds_read_b64_tr_b16 a[208:209], v22 offset:0
    v_mfma_f32_16x16x32_bf16 v[72:75], a[164:167], v[132:135], v[72:75]
    s_waitcnt lgkmcnt(11)
    ds_read_b64_tr_b16 a[210:211], v22 offset:4096
    v_mfma_f32_16x16x32_bf16 v[72:75], a[168:171], v[136:139], v[72:75]
    s_waitcnt lgkmcnt(10)
    ds_read_b64_tr_b16 a[212:213], v22 offset:8192
    v_mfma_f32_16x16x32_bf16 v[72:75], a[172:175], v[140:143], v[72:75]
    s_waitcnt lgkmcnt(9)
    ds_read_b64_tr_b16 a[214:215], v22 offset:12288
    v_mfma_f32_16x16x32_bf16 v[72:75], a[176:179], v[144:147], v[72:75]
    s_waitcnt lgkmcnt(8)
    ds_read_b64_tr_b16 a[216:217], v22 offset:16384
    v_mfma_f32_16x16x32_bf16 v[72:75], a[180:183], v[148:151], v[72:75]
    s_waitcnt lgkmcnt(7)
    ds_read_b64_tr_b16 a[218:219], v22 offset:20480
    v_mfma_f32_16x16x32_bf16 v[72:75], a[184:187], v[152:155], v[72:75]
    s_waitcnt lgkmcnt(6)
    ds_read_b64_tr_b16 a[220:221], v22 offset:24576
    v_mfma_f32_16x16x32_bf16 v[72:75], a[188:191], v[156:159], v[72:75]
    ds_read_b64_tr_b16 a[222:223], v22 offset:28672
    v_mfma_f32_16x16x32_bf16 v[76:79], a[160:163], v[160:163], 0
    ds_read_b64_tr_b16 a[224:225], v26 offset:0
    v_mfma_f32_16x16x32_bf16 v[76:79], a[164:167], v[164:167], v[76:79]
    ds_read_b64_tr_b16 a[226:227], v26 offset:4096
    v_mfma_f32_16x16x32_bf16 v[76:79], a[168:171], v[168:171], v[76:79]
    ds_read_b64_tr_b16 a[228:229], v26 offset:8192
    v_mfma_f32_16x16x32_bf16 v[76:79], a[172:175], v[172:175], v[76:79]
    ds_read_b64_tr_b16 a[230:231], v26 offset:12288
    v_mfma_f32_16x16x32_bf16 v[76:79], a[176:179], v[176:179], v[76:79]
    ds_read_b64_tr_b16 a[232:233], v26 offset:16384
    v_mfma_f32_16x16x32_bf16 v[76:79], a[180:183], v[180:183], v[76:79]
    ds_read_b64_tr_b16 a[234:235], v26 offset:20480
    v_mfma_f32_16x16x32_bf16 v[76:79], a[184:187], v[184:187], v[76:79]
    ds_read_b64_tr_b16 a[236:237], v26 offset:24576
    v_mfma_f32_16x16x32_bf16 v[76:79], a[188:191], v[188:191], v[76:79]
    s_waitcnt lgkmcnt(13)
    ds_read_b64_tr_b16 a[238:239], v26 offset:28672
    v_mfma_f32_16x16x32_bf16 v[80:83], a[208:211], v[128:131], 0
    s_waitcnt lgkmcnt(12)
    ds_read_b64_tr_b16 a[160:161], v23 offset:0
    v_mfma_f32_16x16x32_bf16 v[80:83], a[212:215], v[132:135], v[80:83]
    s_waitcnt lgkmcnt(11)
    ds_read_b64_tr_b16 a[162:163], v23 offset:4096
    v_mfma_f32_16x16x32_bf16 v[80:83], a[216:219], v[136:139], v[80:83]
    s_waitcnt lgkmcnt(10)
    ds_read_b64_tr_b16 a[164:165], v23 offset:8192
    s_waitcnt vmcnt(6)
    v_readfirstlane_b32 s36, v11
    v_mfma_f32_16x16x32_bf16 v[80:83], a[220:223], v[140:143], v[80:83]
    s_waitcnt lgkmcnt(9)
    ds_read_b64_tr_b16 a[166:167], v23 offset:12288
    v_mfma_f32_16x16x32_bf16 v[80:83], a[224:227], v[144:147], v[80:83]
    ds_read_b64_tr_b16 a[168:169], v23 offset:16384
    s_cmp_lg_u32 s36, s95
    s_cbranch_scc1 Lattn_xspin
Lattn_xgot:
    s_waitcnt lgkmcnt(9)
    v_mfma_f32_16x16x32_bf16 v[80:83], a[228:231], v[148:151], v[80:83]
    s_waitcnt lgkmcnt(7)
    ds_read_b64_tr_b16 a[170:171], v23 offset:20480
    v_mfma_f32_16x16x32_bf16 v[80:83], a[232:235], v[152:155], v[80:83]
    s_waitcnt lgkmcnt(6)
    ds_read_b64_tr_b16 a[172:173], v23 offset:24576
    v_mfma_f32_16x16x32_bf16 v[80:83], a[236:239], v[156:159], v[80:83]
    s_add_u32 s37, s55, 0
    ds_read_b64_tr_b16 a[174:175], v23 offset:28672
    v_mfma_f32_16x16x32_bf16 v[84:87], a[208:211], v[160:163], 0
    buffer_load_dwordx4 a[64:67], v252, s[28:31], s37 offen offset:0 sc1
    v_mfma_f32_16x16x32_bf16 v[84:87], a[212:215], v[164:167], v[84:87]
    ds_read_b64_tr_b16 a[176:177], v27 offset:0
    ds_read_b64_tr_b16 a[178:179], v27 offset:4096
    v_mfma_f32_16x16x32_bf16 v[84:87], a[216:219], v[168:171], v[84:87]
    buffer_load_dwordx4 a[68:71], v252, s[28:31], s37 offen offset:1024 sc1
    v_mfma_f32_16x16x32_bf16 v[84:87], a[220:223], v[172:175], v[84:87]
    ds_read_b64_tr_b16 a[180:181], v27 offset:8192
    ds_read_b64_tr_b16 a[182:183], v27 offset:12288
    v_mfma_f32_16x16x32_bf16 v[84:87], a[224:227], v[176:179], v[84:87]
    ds_read_b64_tr_b16 a[184:185], v27 offset:16384
    v_mfma_f32_16x16x32_bf16 v[84:87], a[228:231], v[180:183], v[84:87]
    ds_read_b64_tr_b16 a[186:187], v27 offset:20480
    v_mfma_f32_16x16x32_bf16 v[84:87], a[232:235], v[184:187], v[84:87]
    buffer_load_dwordx4 a[72:75], v252, s[28:31], s37 offen offset:2048 sc1
    v_mfma_f32_16x16x32_bf16 v[84:87], a[236:239], v[188:191], v[84:87]
    s_waitcnt lgkmcnt(12)
    ds_read_b64_tr_b16 a[188:189], v27 offset:24576
    ds_read_b64_tr_b16 a[190:191], v27 offset:28672
    s_barrier
    v_mfma_f32_16x16x32_bf16 v[88:91], a[160:163], v[128:131], 0
    s_waitcnt lgkmcnt(12)
    ds_read_b64_tr_b16 a[208:209], v12 offset:32768
    v_mfma_f32_16x16x32_bf16 v[88:91], a[164:167], v[132:135], v[88:91]
    s_waitcnt lgkmcnt(11)
    ds_read_b64_tr_b16 a[210:211], v12 offset:36864
    v_mfma_f32_16x16x32_bf16 v[88:91], a[168:171], v[136:139], v[88:91]
    s_waitcnt lgkmcnt(10)
    buffer_load_dwordx4 a[76:79], v252, s[28:31], s37 offen offset:3072 sc1
    v_mfma_f32_16x16x32_bf16 v[88:91], a[172:175], v[140:143], v[88:91]
    s_waitcnt lgkmcnt(8)
    ds_read_b64_tr_b16 a[212:213], v12 offset:40960
    ds_read_b64_tr_b16 a[214:215], v12 offset:45056
    v_mfma_f32_16x16x32_bf16 v[88:91], a[176:179], v[144:147], v[88:91]
    s_waitcnt lgkmcnt(8)
    ds_read_b64_tr_b16 a[216:217], v12 offset:49152
    v_mfma_f32_16x16x32_bf16 v[88:91], a[180:183], v[148:151], v[88:91]
    s_waitcnt lgkmcnt(7)
    s_add_u32 s37, s55, 4096
    ds_read_b64_tr_b16 a[218:219], v12 offset:53248
    v_mfma_f32_16x16x32_bf16 v[88:91], a[184:187], v[152:155], v[88:91]
    s_waitcnt lgkmcnt(6)
    s_add_u32 s49, s46, 256
    buffer_load_dwordx4 a[80:83], v252, s[28:31], s37 offen offset:0 sc1
    v_mfma_f32_16x16x32_bf16 v[88:91], a[188:191], v[156:159], v[88:91]
    s_add_u32 m0, s42, 0
    ds_read_b64_tr_b16 a[220:221], v12 offset:57344
    ds_read_b64_tr_b16 a[222:223], v12 offset:61440
    v_mfma_f32_16x16x32_bf16 v[92:95], a[160:163], v[160:163], 0
    buffer_load_dwordx4 v46, s[20:23], s49 offen lds
    v_mfma_f32_16x16x32_bf16 v[92:95], a[164:167], v[164:167], v[92:95]
    ds_read_b64_tr_b16 a[224:225], v16 offset:32768
    ds_read_b64_tr_b16 a[226:227], v16 offset:36864
    v_mfma_f32_16x16x32_bf16 v[92:95], a[168:171], v[168:171], v[92:95]
    buffer_load_dwordx4 v47, s[20:23], s49 offen offset:1024 lds
    v_mfma_f32_16x16x32_bf16 v[92:95], a[172:175], v[172:175], v[92:95]
    ds_read_b64_tr_b16 a[228:229], v16 offset:40960
    ds_read_b64_tr_b16 a[230:231], v16 offset:45056
    v_mfma_f32_16x16x32_bf16 v[92:95], a[176:179], v[176:179], v[92:95]
    buffer_load_dwordx4 a[84:87], v252, s[28:31], s37 offen offset:1024 sc1
    v_mfma_f32_16x16x32_bf16 v[92:95], a[180:183], v[180:183], v[92:95]
    ds_read_b64_tr_b16 a[232:233], v16 offset:49152
    ds_read_b64_tr_b16 a[234:235], v16 offset:53248
    v_mfma_f32_16x16x32_bf16 v[92:95], a[184:187], v[184:187], v[92:95]
    ds_read_b64_tr_b16 a[236:237], v16 offset:57344
    v_mfma_f32_16x16x32_bf16 v[92:95], a[188:191], v[188:191], v[92:95]
    s_waitcnt lgkmcnt(13)
    ds_read_b64_tr_b16 a[238:239], v16 offset:61440
    v_mfma_f32_16x16x32_bf16 v[96:99], a[208:211], v[128:131], 0
    s_waitcnt lgkmcnt(12)
    buffer_load_dwordx4 v48, s[20:23], s49 offen offset:2048 lds
    v_mfma_f32_16x16x32_bf16 v[96:99], a[212:215], v[132:135], v[96:99]
    s_waitcnt lgkmcnt(10)
    ds_read_b64_tr_b16 a[160:161], v13 offset:32768
    ds_read_b64_tr_b16 a[162:163], v13 offset:36864
    v_mfma_f32_16x16x32_bf16 v[96:99], a[216:219], v[136:139], v[96:99]
    s_waitcnt lgkmcnt(10)
    buffer_load_dwordx4 v49, s[20:23], s49 offen offset:3072 lds
    v_mfma_f32_16x16x32_bf16 v[96:99], a[220:223], v[140:143], v[96:99]
    s_waitcnt lgkmcnt(8)
    ds_read_b64_tr_b16 a[164:165], v13 offset:40960
    ds_read_b64_tr_b16 a[166:167], v13 offset:45056
    v_mfma_f32_16x16x32_bf16 v[96:99], a[224:227], v[144:147], v[96:99]
    s_waitcnt lgkmcnt(8)
    buffer_load_dwordx4 a[88:91], v252, s[28:31], s37 offen offset:2048 sc1
    v_mfma_f32_16x16x32_bf16 v[96:99], a[228:231], v[148:151], v[96:99]
    s_waitcnt lgkmcnt(6)
    ds_read_b64_tr_b16 a[168:169], v13 offset:49152
    ds_read_b64_tr_b16 a[170:171], v13 offset:53248
    v_mfma_f32_16x16x32_bf16 v[96:99], a[232:235], v[152:155], v[96:99]
    s_waitcnt lgkmcnt(6)
    s_add_u32 s49, s46, 73984
    ds_read_b64_tr_b16 a[172:173], v13 offset:57344
    v_mfma_f32_16x16x32_bf16 v[96:99], a[236:239], v[156:159], v[96:99]
    s_add_u32 m0, s42, 16384
    ds_read_b64_tr_b16 a[174:175], v13 offset:61440
    v_mfma_f32_16x16x32_bf16 v[100:103], a[208:211], v[160:163], 0
    buffer_load_dwordx4 v46, s[20:23], s49 offen lds
    v_mfma_f32_16x16x32_bf16 v[100:103], a[212:215], v[164:167], v[100:103]
    ds_read_b64_tr_b16 a[176:177], v17 offset:32768
    ds_read_b64_tr_b16 a[178:179], v17 offset:36864
    v_mfma_f32_16x16x32_bf16 v[100:103], a[216:219], v[168:171], v[100:103]
    buffer_load_dwordx4 v47, s[20:23], s49 offen offset:1024 lds
    v_mfma_f32_16x16x32_bf16 v[100:103], a[220:223], v[172:175], v[100:103]
    ds_read_b64_tr_b16 a[180:181], v17 offset:40960
    ds_read_b64_tr_b16 a[182:183], v17 offset:45056
    v_mfma_f32_16x16x32_bf16 v[100:103], a[224:227], v[176:179], v[100:103]
    buffer_load_dwordx4 a[92:95], v252, s[28:31], s37 offen offset:3072 sc1
    v_mfma_f32_16x16x32_bf16 v[100:103], a[228:231], v[180:183], v[100:103]
    ds_read_b64_tr_b16 a[184:185], v17 offset:49152
    ds_read_b64_tr_b16 a[186:187], v17 offset:53248
    v_mfma_f32_16x16x32_bf16 v[100:103], a[232:235], v[184:187], v[100:103]
    ds_read_b64_tr_b16 a[188:189], v17 offset:57344
    v_mfma_f32_16x16x32_bf16 v[100:103], a[236:239], v[188:191], v[100:103]
    s_waitcnt lgkmcnt(13)
    ds_read_b64_tr_b16 a[190:191], v17 offset:61440
    v_mfma_f32_16x16x32_bf16 v[104:107], a[160:163], v[128:131], 0
    s_waitcnt lgkmcnt(12)
    buffer_load_dwordx4 v48, s[20:23], s49 offen offset:2048 lds
    v_mfma_f32_16x16x32_bf16 v[104:107], a[164:167], v[132:135], v[104:107]
    s_waitcnt lgkmcnt(10)
    ds_read_b64_tr_b16 a[208:209], v14 offset:32768
    ds_read_b64_tr_b16 a[210:211], v14 offset:36864
    v_mfma_f32_16x16x32_bf16 v[104:107], a[168:171], v[136:139], v[104:107]
    s_waitcnt lgkmcnt(10)
    buffer_load_dwordx4 v49, s[20:23], s49 offen offset:3072 lds
    v_mfma_f32_16x16x32_bf16 v[104:107], a[172:175], v[140:143], v[104:107]
    s_waitcnt lgkmcnt(8)
    s_add_u32 s37, s55, 8192
    ds_read_b64_tr_b16 a[212:213], v14 offset:40960
    ds_read_b64_tr_b16 a[214:215], v14 offset:45056
    v_mfma_f32_16x16x32_bf16 v[104:107], a[176:179], v[144:147], v[104:107]
    s_waitcnt lgkmcnt(8)
    buffer_load_dwordx4 a[96:99], v252, s[28:31], s37 offen offset:0 sc1
    v_mfma_f32_16x16x32_bf16 v[104:107], a[180:183], v[148:151], v[104:107]
    s_waitcnt lgkmcnt(6)
    ds_read_b64_tr_b16 a[216:217], v14 offset:49152
    ds_read_b64_tr_b16 a[218:219], v14 offset:53248
    v_mfma_f32_16x16x32_bf16 v[104:107], a[184:187], v[152:155], v[104:107]
    s_waitcnt lgkmcnt(6)
    buffer_load_dwordx4 a[100:103], v252, s[28:31], s37 offen offset:1024 sc1
    v_mfma_f32_16x16x32_bf16 v[104:107], a[188:191], v[156:159], v[104:107]
    ds_read_b64_tr_b16 a[220:221], v14 offset:57344
    ds_read_b64_tr_b16 a[222:223], v14 offset:61440
    v_mfma_f32_16x16x32_bf16 v[108:111], a[160:163], v[160:163], 0
    ds_read_b64_tr_b16 a[224:225], v18 offset:32768
    v_mfma_f32_16x16x32_bf16 v[108:111], a[164:167], v[164:167], v[108:111]
    ds_read_b64_tr_b16 a[226:227], v18 offset:36864
    v_mfma_f32_16x16x32_bf16 v[108:111], a[168:171], v[168:171], v[108:111]
    buffer_load_dwordx4 a[104:107], v252, s[28:31], s37 offen offset:2048 sc1
    v_mfma_f32_16x16x32_bf16 v[108:111], a[172:175], v[172:175], v[108:111]
    ds_read_b64_tr_b16 a[228:229], v18 offset:40960
    ds_read_b64_tr_b16 a[230:231], v18 offset:45056
    v_mfma_f32_16x16x32_bf16 v[108:111], a[176:179], v[176:179], v[108:111]
    ds_read_b64_tr_b16 a[232:233], v18 offset:49152
    v_mfma_f32_16x16x32_bf16 v[108:111], a[180:183], v[180:183], v[108:111]
    ds_read_b64_tr_b16 a[234:235], v18 offset:53248
    v_mfma_f32_16x16x32_bf16 v[108:111], a[184:187], v[184:187], v[108:111]
    buffer_load_dwordx4 a[108:111], v252, s[28:31], s37 offen offset:3072 sc1
    v_mfma_f32_16x16x32_bf16 v[108:111], a[188:191], v[188:191], v[108:111]
    s_waitcnt lgkmcnt(12)
    ds_read_b64_tr_b16 a[236:237], v18 offset:57344
    ds_read_b64_tr_b16 a[238:239], v18 offset:61440
    v_mfma_f32_16x16x32_bf16 v[112:115], a[208:211], v[128:131], 0
    s_waitcnt lgkmcnt(12)
    ds_read_b64_tr_b16 a[160:161], v15 offset:32768
    v_mfma_f32_16x16x32_bf16 v[112:115], a[212:215], v[132:135], v[112:115]
    s_waitcnt lgkmcnt(11)
    s_add_u32 s37, s55, 12288
    ds_read_b64_tr_b16 a[162:163], v15 offset:36864
    v_mfma_f32_16x16x32_bf16 v[112:115], a[216:219], v[136:139], v[112:115]
    s_waitcnt lgkmcnt(10)
    buffer_load_dwordx4 a[112:115], v252, s[28:31], s37 offen offset:0 sc1
    v_mfma_f32_16x16x32_bf16 v[112:115], a[220:223], v[140:143], v[112:115]
    s_waitcnt lgkmcnt(8)
    ds_read_b64_tr_b16 a[164:165], v15 offset:40960
    ds_read_b64_tr_b16 a[166:167], v15 offset:45056
    v_mfma_f32_16x16x32_bf16 v[112:115], a[224:227], v[144:147], v[112:115]
    s_waitcnt lgkmcnt(8)
    buffer_load_dwordx4 a[116:119], v252, s[28:31], s37 offen offset:1024 sc1
    v_mfma_f32_16x16x32_bf16 v[112:115], a[228:231], v[148:151], v[112:115]
    s_waitcnt lgkmcnt(6)
    ds_read_b64_tr_b16 a[168:169], v15 offset:49152
    ds_read_b64_tr_b16 a[170:171], v15 offset:53248
    v_mfma_f32_16x16x32_bf16 v[112:115], a[232:235], v[152:155], v[112:115]
    s_waitcnt lgkmcnt(6)
    ds_read_b64_tr_b16 a[172:173], v15 offset:57344
    v_mfma_f32_16x16x32_bf16 v[112:115], a[236:239], v[156:159], v[112:115]
    ds_read_b64_tr_b16 a[174:175], v15 offset:61440
    v_mfma_f32_16x16x32_bf16 v[116:119], a[208:211], v[160:163], 0
    buffer_load_dwordx4 a[120:123], v252, s[28:31], s37 offen offset:2048 sc1
    v_mfma_f32_16x16x32_bf16 v[116:119], a[212:215], v[164:167], v[116:119]
    ds_read_b64_tr_b16 a[176:177], v19 offset:32768
    ds_read_b64_tr_b16 a[178:179], v19 offset:36864
    v_mfma_f32_16x16x32_bf16 v[116:119], a[216:219], v[168:171], v[116:119]
    ds_read_b64_tr_b16 a[180:181], v19 offset:40960
    v_mfma_f32_16x16x32_bf16 v[116:119], a[220:223], v[172:175], v[116:119]
    ds_read_b64_tr_b16 a[182:183], v19 offset:45056
    v_mfma_f32_16x16x32_bf16 v[116:119], a[224:227], v[176:179], v[116:119]
    buffer_load_dwordx4 a[124:127], v252, s[28:31], s37 offen offset:3072 sc1
    v_mfma_f32_16x16x32_bf16 v[116:119], a[228:231], v[180:183], v[116:119]
    ds_read_b64_tr_b16 a[184:185], v19 offset:49152
    ds_read_b64_tr_b16 a[186:187], v19 offset:53248
    v_mfma_f32_16x16x32_bf16 v[116:119], a[232:235], v[184:187], v[116:119]
    ds_read_b64_tr_b16 a[188:189], v19 offset:57344
    v_mfma_f32_16x16x32_bf16 v[116:119], a[236:239], v[188:191], v[116:119]
    ds_read_b64_tr_b16 a[190:191], v19 offset:61440
    s_waitcnt vmcnt(25)
    s_waitcnt lgkmcnt(0)
    s_barrier
    v_mfma_f32_16x16x32_bf16 v[120:123], a[160:163], v[128:131], 0
    ds_read_b64_tr_b16 a[208:209], v20 offset:32768
    v_mfma_f32_16x16x32_bf16 v[120:123], a[164:167], v[132:135], v[120:123]
    ds_read_b64_tr_b16 a[210:211], v20 offset:36864
    v_mfma_f32_16x16x32_bf16 v[120:123], a[168:171], v[136:139], v[120:123]
    ds_read_b64_tr_b16 a[212:213], v20 offset:40960
    v_mfma_f32_16x16x32_bf16 v[120:123], a[172:175], v[140:143], v[120:123]
    ds_read_b64_tr_b16 a[214:215], v20 offset:45056
    v_mfma_f32_16x16x32_bf16 v[120:123], a[176:179], v[144:147], v[120:123]
    ds_read_b64_tr_b16 a[216:217], v20 offset:49152
    v_mfma_f32_16x16x32_bf16 v[120:123], a[180:183], v[148:151], v[120:123]
    ds_read_b64_tr_b16 a[218:219], v20 offset:53248
    v_mfma_f32_16x16x32_bf16 v[120:123], a[184:187], v[152:155], v[120:123]
    s_add_u32 s49, s7, 512
    ds_read_b64_tr_b16 a[220:221], v20 offset:57344
    v_mfma_f32_16x16x32_bf16 v[120:123], a[188:191], v[156:159], v[120:123]
    s_add_u32 m0, s42, 65536
    ds_read_b64_tr_b16 a[222:223], v20 offset:61440
    v_mfma_f32_16x16x32_bf16 v[124:127], a[160:163], v[160:163], 0
Ltour9:
    s_cbranch_execz Ltour13
    buffer_load_dwordx4 v46, s[20:23], s49 offen lds
    v_mfma_f32_16x16x32_bf16 v[124:127], a[164:167], v[164:167], v[124:127]
    ds_read_b64_tr_b16 a[224:225], v24 offset:32768
    ds_read_b64_tr_b16 a[226:227], v24 offset:36864
    v_mfma_f32_16x16x32_bf16 v[124:127], a[168:171], v[168:171], v[124:127]
    buffer_load_dwordx4 v47, s[20:23], s49 offen offset:1024 lds
    v_mfma_f32_16x16x32_bf16 v[124:127], a[172:175], v[172:175], v[124:127]
    ds_read_b64_tr_b16 a[228:229], v24 offset:40960
    ds_read_b64_tr_b16 a[230:231], v24 offset:45056
    v_mfma_f32_16x16x32_bf16 v[124:127], a[176:179], v[176:179], v[124:127]
    ds_read_b64_tr_b16 a[232:233], v24 offset:49152
    v_mfma_f32_16x16x32_bf16 v[124:127], a[180:183], v[180:183], v[124:127]
    ds_read_b64_tr_b16 a[234:235], v24 offset:53248
    v_mfma_f32_16x16x32_bf16 v[124:127], a[184:187], v[184:187], v[124:127]
    ds_read_b64_tr_b16 a[236:237], v24 offset:57344
    v_mfma_f32_16x16x32_bf16 v[124:127], a[188:191], v[188:191], v[124:127]
    s_waitcnt vmcnt(25)
    s_waitcnt lgkmcnt(13)
    ds_read_b64_tr_b16 a[238:239], v24 offset:61440
    v_mfma_f32_16x16x32_bf16 v[64:67], a[208:211], a[64:67], v[64:67]
    s_waitcnt vmcnt(24)
    s_waitcnt lgkmcnt(12)
    buffer_load_dwordx4 v48, s[20:23], s49 offen offset:2048 lds
    v_mfma_f32_16x16x32_bf16 v[64:67], a[212:215], a[68:71], v[64:67]
    s_waitcnt vmcnt(24)
    s_waitcnt lgkmcnt(10)
    s_lshl_b32 s40, s5, 4
    ds_read_b64_tr_b16 a[160:161], v21 offset:32768
    ds_read_b64_tr_b16 a[162:163], v21 offset:36864
    v_mfma_f32_16x16x32_bf16 v[64:67], a[216:219], a[72:75], v[64:67]
    s_waitcnt vmcnt(23)
    s_waitcnt lgkmcnt(10)
    buffer_load_dwordx4 v49, s[20:23], s49 offen offset:3072 lds
    v_mfma_f32_16x16x32_bf16 v[64:67], a[220:223], a[76:79], v[64:67]
    s_waitcnt vmcnt(23)
    s_waitcnt lgkmcnt(8)
    s_add_u32 s40, s40, s4
    ds_read_b64_tr_b16 a[164:165], v21 offset:40960
    ds_read_b64_tr_b16 a[166:167], v21 offset:45056
    v_mfma_f32_16x16x32_bf16 v[64:67], a[224:227], a[80:83], v[64:67]
    s_waitcnt vmcnt(20)
    s_waitcnt lgkmcnt(8)
    ds_read_b64_tr_b16 a[168:169], v21 offset:49152
    v_and_b32 v240, 31, v1
    v_mfma_f32_16x16x32_bf16 v[64:67], a[228:231], a[84:87], v[64:67]
    s_waitcnt vmcnt(17)
    s_waitcnt lgkmcnt(7)
    ds_read_b64_tr_b16 a[170:171], v21 offset:53248
    v_lshrrev_b32 v241, 5, v1
    v_mfma_f32_16x16x32_bf16 v[64:67], a[232:235], a[88:91], v[64:67]
    s_waitcnt vmcnt(14)
    s_waitcnt lgkmcnt(6)
    s_add_u32 s49, s7, 74240
    ds_read_b64_tr_b16 a[172:173], v21 offset:57344
    v_cmp_gt_u32 vcc, 8, v240
    v_mfma_f32_16x16x32_bf16 v[64:67], a[236:239], a[92:95], v[64:67]
    s_waitcnt vmcnt(11)
    s_add_u32 m0, s42, 81920
    ds_read_b64_tr_b16 a[174:175], v21 offset:61440
    v_mov_b32 v242, 2147483648
    v_mfma_f32_16x16x32_bf16 v[68:71], a[208:211], a[96:99], v[68:71]
    s_waitcnt vmcnt(10)
    buffer_load_dwordx4 v46, s[20:23], s49 offen lds
    v_mfma_f32_16x16x32_bf16 v[68:71], a[212:215], a[100:103], v[68:71]
    s_waitcnt vmcnt(10)
    s_lshl_b32 s43, s40, 3
    ds_read_b64_tr_b16 a[176:177], v25 offset:32768
    ds_read_b64_tr_b16 a[178:179], v25 offset:36864
    v_mfma_f32_16x16x32_bf16 v[68:71], a[216:219], a[104:107], v[68:71]
    s_waitcnt vmcnt(9)
    buffer_load_dwordx4 v47, s[20:23], s49 offen offset:1024 lds
    v_mfma_f32_16x16x32_bf16 v[68:71], a[220:223], a[108:111], v[68:71]
    s_waitcnt vmcnt(9)
    s_lshl_b32 s44, s3, 1
    ds_read_b64_tr_b16 a[180:181], v25 offset:40960
    ds_read_b64_tr_b16 a[182:183], v25 offset:45056
    v_mfma_f32_16x16x32_bf16 v[68:71], a[224:227], a[112:115], v[68:71]
    s_waitcnt vmcnt(8)
    ds_read_b64_tr_b16 a[184:185], v25 offset:49152
    v_cvt_pk_bf16_f32 v224, v64, v65
    v_mfma_f32_16x16x32_bf16 v[68:71], a[228:231], a[116:119], v[68:71]
    s_waitcnt vmcnt(7)
    ds_read_b64_tr_b16 a[186:187], v25 offset:53248
    v_cvt_pk_bf16_f32 v225, v66, v67
    v_mfma_f32_16x16x32_bf16 v[68:71], a[232:235], a[120:123], v[68:71]
    s_waitcnt vmcnt(6)
    s_add_u32 s43, s43, s44
    ds_read_b64_tr_b16 a[188:189], v25 offset:57344
    v_cndmask_b32 v242, v242, 0, vcc
    v_mfma_f32_16x16x32_bf16 v[68:71], a[236:239], a[124:127], v[68:71]
    s_waitcnt lgkmcnt(13)
    ds_read_b64_tr_b16 a[190:191], v25 offset:61440
    v_add_u32 v7, s43, v241
    v_mfma_f32_16x16x32_bf16 v[72:75], a[160:163], a[64:67], v[72:75]
    s_waitcnt lgkmcnt(12)
    buffer_load_dwordx4 v48, s[20:23], s49 offen offset:2048 lds
    v_mfma_f32_16x16x32_bf16 v[72:75], a[164:167], a[68:71], v[72:75]
    s_waitcnt lgkmcnt(10)
    ds_read_b64_tr_b16 a[208:209], v22 offset:32768
    ds_read_b64_tr_b16 a[210:211], v22 offset:36864
    v_mfma_f32_16x16x32_bf16 v[72:75], a[168:171], a[72:75], v[72:75]
    s_waitcnt lgkmcnt(10)
    buffer_load_dwordx4 v49, s[20:23], s49 offen offset:3072 lds
    v_mfma_f32_16x16x32_bf16 v[72:75], a[172:175], a[76:79], v[72:75]
    s_waitcnt lgkmcnt(8)
    ds_read_b64_tr_b16 a[212:213], v22 offset:40960
    ds_read_b64_tr_b16 a[214:215], v22 offset:45056
    v_mfma_f32_16x16x32_bf16 v[72:75], a[176:179], a[80:83], v[72:75]
    s_waitcnt lgkmcnt(8)
    ds_read_b64_tr_b16 a[216:217], v22 offset:49152
    v_cvt_pk_bf16_f32 v228, v68, v69
    v_mfma_f32_16x16x32_bf16 v[72:75], a[180:183], a[84:87], v[72:75]
    s_waitcnt lgkmcnt(7)
    ds_read_b64_tr_b16 a[218:219], v22 offset:53248
    v_cvt_pk_bf16_f32 v229, v70, v71
    v_mfma_f32_16x16x32_bf16 v[72:75], a[184:187], a[88:91], v[72:75]
    s_waitcnt lgkmcnt(6)
    ds_read_b64_tr_b16 a[220:221], v22 offset:57344
    v_lshlrev_b32 v5, 4, v240
    v_mfma_f32_16x16x32_bf16 v[72:75], a[188:191], a[92:95], v[72:75]
    ds_read_b64_tr_b16 a[222:223], v22 offset:61440
    v_lshlrev_b32 v243, 4, v241
    v_mfma_f32_16x16x32_bf16 v[76:79], a[160:163], a[96:99], v[76:79]
    ds_read_b64_tr_b16 a[224:225], v26 offset:32768
    v_lshl_add_u32 v2, v240, 5, v243
    v_mfma_f32_16x16x32_bf16 v[76:79], a[164:167], a[100:103], v[76:79]
    s_mul_i32 s44, s43, 10240
    ds_read_b64_tr_b16 a[226:227], v26 offset:36864
    v_lshrrev_b32 v243, 2, v240
    v_mfma_f32_16x16x32_bf16 v[76:79], a[168:171], a[104:107], v[76:79]
    ds_read_b64_tr_b16 a[228:229], v26 offset:40960
    v_lshlrev_b32 v243, 6, v243
    v_mfma_f32_16x16x32_bf16 v[76:79], a[172:175], a[108:111], v[76:79]
    ds_read_b64_tr_b16 a[230:231], v26 offset:45056
    v_and_b32 v241, 3, v240
    v_mfma_f32_16x16x32_bf16 v[76:79], a[176:179], a[112:115], v[76:79]
    ds_read_b64_tr_b16 a[232:233], v26 offset:49152
    v_cvt_pk_bf16_f32 v226, v72, v73
    v_mfma_f32_16x16x32_bf16 v[76:79], a[180:183], a[116:119], v[76:79]
    s_add_u32 s38, s93, 0
    ds_read_b64_tr_b16 a[234:235], v26 offset:53248
    v_cvt_pk_bf16_f32 v227, v74, v75
    v_mfma_f32_16x16x32_bf16 v[76:79], a[184:187], a[120:123], v[76:79]
    buffer_store_dwordx4 v[224:227], v56, s[28:31], s38 offen sc1
    v_mfma_f32_16x16x32_bf16 v[76:79], a[188:191], a[124:127], v[76:79]
    s_waitcnt lgkmcnt(12)
    ds_read_b64_tr_b16 a[236:237], v26 offset:57344
    ds_read_b64_tr_b16 a[238:239], v26 offset:61440
    v_mfma_f32_16x16x32_bf16 v[80:83], a[208:211], a[64:67], v[80:83]
    s_waitcnt lgkmcnt(12)
    ds_read_b64_tr_b16 a[160:161], v23 offset:32768
    v_lshl_add_u32 v3, v241, 3, v243
    v_mfma_f32_16x16x32_bf16 v[80:83], a[212:215], a[68:71], v[80:83]
    s_waitcnt lgkmcnt(11)
    ds_read_b64_tr_b16 a[162:163], v23 offset:36864
    v_mul_u32_u24 v243, 1152, v7
    v_mfma_f32_16x16x32_bf16 v[80:83], a[216:219], a[72:75], v[80:83]
    s_waitcnt lgkmcnt(10)
    ds_read_b64_tr_b16 a[164:165], v23 offset:40960
    v_add_u32 v4, v243, v3
    v_mfma_f32_16x16x32_bf16 v[80:83], a[220:223], a[76:79], v[80:83]
    s_waitcnt lgkmcnt(9)
    ds_read_b64_tr_b16 a[166:167], v23 offset:45056
    v_lshl_add_u32 v6, v243, 1, v5
    v_mfma_f32_16x16x32_bf16 v[80:83], a[224:227], a[80:83], v[80:83]
    s_waitcnt lgkmcnt(8)
    ds_read_b64_tr_b16 a[168:169], v23 offset:49152
    v_cvt_pk_bf16_f32 v230, v76, v77
    v_mfma_f32_16x16x32_bf16 v[80:83], a[228:231], a[84:87], v[80:83]
    s_waitcnt lgkmcnt(7)
    s_add_u32 s38, s93, 163840
    ds_read_b64_tr_b16 a[170:171], v23 offset:53248
    v_cvt_pk_bf16_f32 v231, v78, v79
    v_mfma_f32_16x16x32_bf16 v[80:83], a[232:235], a[88:91], v[80:83]
    s_waitcnt lgkmcnt(6)
    buffer_store_dwordx4 v[228:231], v56, s[28:31], s38 offen sc1
    v_mfma_f32_16x16x32_bf16 v[80:83], a[236:239], a[92:95], v[80:83]
    ds_read_b64_tr_b16 a[172:173], v23 offset:57344
    ds_read_b64_tr_b16 a[174:175], v23 offset:61440
    v_mfma_f32_16x16x32_bf16 v[84:87], a[208:211], a[96:99], v[84:87]
    ds_read_b64_tr_b16 a[176:177], v27 offset:32768
    v_or_b32 v55, v3, v242
    v_mfma_f32_16x16x32_bf16 v[84:87], a[212:215], a[100:103], v[84:87]
    ds_read_b64_tr_b16 a[178:179], v27 offset:36864
    v_or_b32 v58, v4, v242
    v_mfma_f32_16x16x32_bf16 v[84:87], a[216:219], a[104:107], v[84:87]
    ds_read_b64_tr_b16 a[180:181], v27 offset:40960
    v_or_b32 v59, v5, v242
    v_mfma_f32_16x16x32_bf16 v[84:87], a[220:223], a[108:111], v[84:87]
    ds_read_b64_tr_b16 a[182:183], v27 offset:45056
    v_or_b32 v60, v6, v242
    v_mfma_f32_16x16x32_bf16 v[84:87], a[224:227], a[112:115], v[84:87]
    ds_read_b64_tr_b16 a[184:185], v27 offset:49152
    v_cvt_pk_bf16_f32 v232, v80, v81
    v_mfma_f32_16x16x32_bf16 v[84:87], a[228:231], a[116:119], v[84:87]
    ds_read_b64_tr_b16 a[186:187], v27 offset:53248
    v_cvt_pk_bf16_f32 v233, v82, v83
    v_mfma_f32_16x16x32_bf16 v[84:87], a[232:235], a[120:123], v[84:87]
    ds_read_b64_tr_b16 a[188:189], v27 offset:57344
    v_lshrrev_b32 v243, 4, v1
    v_mfma_f32_16x16x32_bf16 v[84:87], a[236:239], a[124:127], v[84:87]
    s_waitcnt lgkmcnt(13)
    ds_read_b64_tr_b16 a[190:191], v27 offset:61440
    v_lshlrev_b32 v243, 8, v243
    s_barrier
    v_mfma_f32_16x16x32_bf16 v[88:91], a[160:163], a[64:67], v[88:91]
    s_waitcnt lgkmcnt(12)
    ds_read_b64_tr_b16 a[208:209], v12 offset:0
    v_and_b32 v241, 7, v1
    v_mfma_f32_16x16x32_bf16 v[88:91], a[164:167], a[68:71], v[88:91]
    s_waitcnt lgkmcnt(11)
    ds_read_b64_tr_b16 a[210:211], v12 offset:4096
    v_lshl_add_u32 v243, v241, 5, v243
    v_mfma_f32_16x16x32_bf16 v[88:91], a[168:171], a[72:75], v[88:91]
    s_waitcnt lgkmcnt(10)
    ds_read_b64_tr_b16 a[212:213], v12 offset:8192
    v_and_b32 v241, 8, v1
    v_mfma_f32_16x16x32_bf16 v[88:91], a[172:175], a[76:79], v[88:91]
    s_waitcnt lgkmcnt(9)
    ds_read_b64_tr_b16 a[214:215], v12 offset:12288
    v_lshl_add_u32 v54, v241, 1, v243
    v_mfma_f32_16x16x32_bf16 v[88:91], a[176:179], a[80:83], v[88:91]
    s_waitcnt lgkmcnt(8)
    ds_read_b64_tr_b16 a[216:217], v12 offset:16384
    v_cvt_pk_bf16_f32 v236, v84, v85
    v_mfma_f32_16x16x32_bf16 v[88:91], a[180:183], a[84:87], v[88:91]
    s_waitcnt lgkmcnt(7)
    ds_read_b64_tr_b16 a[218:219], v12 offset:20480
    v_cvt_pk_bf16_f32 v237, v86, v87
    v_mfma_f32_16x16x32_bf16 v[88:91], a[184:187], a[88:91], v[88:91]
    s_waitcnt lgkmcnt(6)
    s_add_u32 s49, s46, 512
    ds_read_b64_tr_b16 a[220:221], v12 offset:24576
    v_mfma_f32_16x16x32_bf16 v[88:91], a[188:191], a[92:95], v[88:91]
    s_add_u32 m0, s42, 32768
    ds_read_b64_tr_b16 a[222:223], v12 offset:28672
    v_mfma_f32_16x16x32_bf16 v[92:95], a[160:163], a[96:99], v[92:95]
    buffer_load_dwordx4 v46, s[20:23], s49 offen lds
    v_mfma_f32_16x16x32_bf16 v[92:95], a[164:167], a[100:103], v[92:95]
    s_lshr_b32 s41, s2, 3
    ds_read_b64_tr_b16 a[224:225], v16 offset:0
    ds_read_b64_tr_b16 a[226:227], v16 offset:4096
    v_mfma_f32_16x16x32_bf16 v[92:95], a[168:171], a[104:107], v[92:95]
    buffer_load_dwordx4 v47, s[20:23], s49 offen offset:1024 lds
    v_mfma_f32_16x16x32_bf16 v[92:95], a[172:175], a[108:111], v[92:95]
    s_mov_b32 s14, 2359296
    ds_read_b64_tr_b16 a[228:229], v16 offset:8192
    ds_read_b64_tr_b16 a[230:231], v16 offset:12288
    v_mfma_f32_16x16x32_bf16 v[92:95], a[176:179], a[112:115], v[92:95]
    ds_read_b64_tr_b16 a[232:233], v16 offset:16384
    v_cvt_pk_bf16_f32 v234, v88, v89
    v_mfma_f32_16x16x32_bf16 v[92:95], a[180:183], a[116:119], v[92:95]
    s_add_u32 s38, s93, 128
    ds_read_b64_tr_b16 a[234:235], v16 offset:20480
    v_cvt_pk_bf16_f32 v235, v90, v91
    v_mfma_f32_16x16x32_bf16 v[92:95], a[184:187], a[120:123], v[92:95]
    buffer_store_dwordx4 v[232:235], v56, s[28:31], s38 offen sc1
    v_mfma_f32_16x16x32_bf16 v[92:95], a[188:191], a[124:127], v[92:95]
    s_waitcnt lgkmcnt(12)
    s_mov_b32 s15, 0x20000
    ds_read_b64_tr_b16 a[236:237], v16 offset:24576
    ds_read_b64_tr_b16 a[238:239], v16 offset:28672
    v_mfma_f32_16x16x32_bf16 v[96:99], a[208:211], a[64:67], v[96:99]
    s_waitcnt lgkmcnt(12)
    buffer_load_dwordx4 v48, s[20:23], s49 offen offset:2048 lds
    v_mfma_f32_16x16x32_bf16 v[96:99], a[212:215], a[68:71], v[96:99]
    s_waitcnt lgkmcnt(10)
    s_mov_b32 s18, 2359296
    ds_read_b64_tr_b16 a[160:161], v13 offset:0
    ds_read_b64_tr_b16 a[162:163], v13 offset:4096
    v_mfma_f32_16x16x32_bf16 v[96:99], a[216:219], a[72:75], v[96:99]
    s_waitcnt lgkmcnt(10)
    buffer_load_dwordx4 v49, s[20:23], s49 offen offset:3072 lds
    v_mfma_f32_16x16x32_bf16 v[96:99], a[220:223], a[76:79], v[96:99]
    s_waitcnt lgkmcnt(8)
    s_mov_b32 s19, 0x20000
    ds_read_b64_tr_b16 a[164:165], v13 offset:8192
    ds_read_b64_tr_b16 a[166:167], v13 offset:12288
    v_mfma_f32_16x16x32_bf16 v[96:99], a[224:227], a[80:83], v[96:99]
    s_waitcnt lgkmcnt(8)
    ds_read_b64_tr_b16 a[168:169], v13 offset:16384
    v_cvt_pk_bf16_f32 v238, v92, v93
    v_mfma_f32_16x16x32_bf16 v[96:99], a[228:231], a[84:87], v[96:99]
    s_waitcnt lgkmcnt(7)
    s_add_u32 s38, s93, 163968
    ds_read_b64_tr_b16 a[170:171], v13 offset:20480
    v_cvt_pk_bf16_f32 v239, v94, v95
    v_mfma_f32_16x16x32_bf16 v[96:99], a[232:235], a[88:91], v[96:99]
    s_waitcnt lgkmcnt(6)
    s_add_u32 s49, s46, 74240
    buffer_store_dwordx4 v[236:239], v56, s[28:31], s38 offen sc1
    v_mfma_f32_16x16x32_bf16 v[96:99], a[236:239], a[92:95], v[96:99]
    s_add_u32 m0, s42, 49152
    ds_read_b64_tr_b16 a[172:173], v13 offset:24576
    ds_read_b64_tr_b16 a[174:175], v13 offset:28672
    v_mfma_f32_16x16x32_bf16 v[100:103], a[208:211], a[96:99], v[100:103]
    buffer_load_dwordx4 v46, s[20:23], s49 offen lds
    v_mfma_f32_16x16x32_bf16 v[100:103], a[212:215], a[100:103], v[100:103]
    s_add_u32 s8, s50, 7864320
    s_addc_u32 s9, s51, 0
    ds_read_b64_tr_b16 a[176:177], v17 offset:0
    ds_read_b64_tr_b16 a[178:179], v17 offset:4096
    v_mfma_f32_16x16x32_bf16 v[100:103], a[216:219], a[104:107], v[100:103]
    buffer_load_dwordx4 v47, s[20:23], s49 offen offset:1024 lds
    v_mfma_f32_16x16x32_bf16 v[100:103], a[220:223], a[108:111], v[100:103]
    s_mov_b32 s10, 663552
    ds_read_b64_tr_b16 a[180:181], v17 offset:8192
    ds_read_b64_tr_b16 a[182:183], v17 offset:12288
    v_mfma_f32_16x16x32_bf16 v[100:103], a[224:227], a[112:115], v[100:103]
    ds_read_b64_tr_b16 a[184:185], v17 offset:16384
    v_cvt_pk_bf16_f32 v224, v96, v97
    v_mfma_f32_16x16x32_bf16 v[100:103], a[228:231], a[116:119], v[100:103]
    ds_read_b64_tr_b16 a[186:187], v17 offset:20480
    v_cvt_pk_bf16_f32 v225, v98, v99
    v_mfma_f32_16x16x32_bf16 v[100:103], a[232:235], a[120:123], v[100:103]
    s_mov_b32 s11, 0x20000
    ds_read_b64_tr_b16 a[188:189], v17 offset:24576
    v_mfma_f32_16x16x32_bf16 v[100:103], a[236:239], a[124:127], v[100:103]
    s_waitcnt lgkmcnt(13)
    s_lshl_b32 s39, s5, 13
    ds_read_b64_tr_b16 a[190:191], v17 offset:28672
    v_mfma_f32_16x16x32_bf16 v[104:107], a[160:163], a[64:67], v[104:107]
    s_waitcnt lgkmcnt(12)
    buffer_load_dwordx4 v48, s[20:23], s49 offen offset:2048 lds
    v_mfma_f32_16x16x32_bf16 v[104:107], a[164:167], a[68:71], v[104:107]
    s_waitcnt lgkmcnt(10)
    s_add_u32 s39, s39, 8781824
    ds_read_b64_tr_b16 a[208:209], v14 offset:0
    ds_read_b64_tr_b16 a[210:211], v14 offset:4096
    v_mfma_f32_16x16x32_bf16 v[104:107], a[168:171], a[72:75], v[104:107]
    s_waitcnt lgkmcnt(10)
    buffer_load_dwordx4 v49, s[20:23], s49 offen offset:3072 lds
    v_mfma_f32_16x16x32_bf16 v[104:107], a[172:175], a[76:79], v[104:107]
    s_waitcnt lgkmcnt(8)
    s_lshr_b32 s45, s4, 2
    ds_read_b64_tr_b16 a[212:213], v14 offset:8192
    ds_read_b64_tr_b16 a[214:215], v14 offset:12288
    v_mfma_f32_16x16x32_bf16 v[104:107], a[176:179], a[80:83], v[104:107]
    s_waitcnt lgkmcnt(8)
    ds_read_b64_tr_b16 a[216:217], v14 offset:16384
    v_cvt_pk_bf16_f32 v228, v100, v101
    v_mfma_f32_16x16x32_bf16 v[104:107], a[180:183], a[84:87], v[104:107]
    s_waitcnt lgkmcnt(7)
    ds_read_b64_tr_b16 a[218:219], v14 offset:20480
    v_cvt_pk_bf16_f32 v229, v102, v103
    v_mfma_f32_16x16x32_bf16 v[104:107], a[184:187], a[88:91], v[104:107]
    s_waitcnt lgkmcnt(6)
    s_lshl_b32 s45, s45, 11
    ds_read_b64_tr_b16 a[220:221], v14 offset:24576
    v_mfma_f32_16x16x32_bf16 v[104:107], a[188:191], a[92:95], v[104:107]
    s_add_u32 s39, s39, s45
    ds_read_b64_tr_b16 a[222:223], v14 offset:28672
    v_and_b32 v9, 15, v1
    v_mfma_f32_16x16x32_bf16 v[108:111], a[160:163], a[96:99], v[108:111]
    ds_read_b64_tr_b16 a[224:225], v18 offset:0
    v_lshlrev_b32 v9, 7, v9
    v_mfma_f32_16x16x32_bf16 v[108:111], a[164:167], a[100:103], v[108:111]
    ds_read_b64_tr_b16 a[226:227], v18 offset:4096
    v_lshrrev_b32 v240, 4, v1
    v_mfma_f32_16x16x32_bf16 v[108:111], a[168:171], a[104:107], v[108:111]
    ds_read_b64_tr_b16 a[228:229], v18 offset:8192
    v_bfe_u32 v241, v1, 2, 2
    v_mfma_f32_16x16x32_bf16 v[108:111], a[172:175], a[108:111], v[108:111]
    ds_read_b64_tr_b16 a[230:231], v18 offset:12288
    v_cmp_eq_u32 s[54:55], v240, v241
    v_mfma_f32_16x16x32_bf16 v[108:111], a[176:179], a[112:115], v[108:111]
    ds_read_b64_tr_b16 a[232:233], v18 offset:16384
    v_cvt_pk_bf16_f32 v226, v104, v105
    v_mfma_f32_16x16x32_bf16 v[108:111], a[180:183], a[116:119], v[108:111]
    s_add_u32 s38, s93, 512
    ds_read_b64_tr_b16 a[234:235], v18 offset:20480
    v_cvt_pk_bf16_f32 v227, v106, v107
    v_mfma_f32_16x16x32_bf16 v[108:111], a[184:187], a[120:123], v[108:111]
    buffer_store_dwordx4 v[224:227], v56, s[28:31], s38 offen sc1
    v_mfma_f32_16x16x32_bf16 v[108:111], a[188:191], a[124:127], v[108:111]
    s_waitcnt lgkmcnt(12)
    ds_read_b64_tr_b16 a[236:237], v18 offset:24576
    ds_read_b64_tr_b16 a[238:239], v18 offset:28672
    v_mfma_f32_16x16x32_bf16 v[112:115], a[208:211], a[64:67], v[112:115]
    s_waitcnt lgkmcnt(12)
    ds_read_b64_tr_b16 a[160:161], v15 offset:0
    v_and_b32 v240, 1, v1
    v_mfma_f32_16x16x32_bf16 v[112:115], a[212:215], a[68:71], v[112:115]
    s_waitcnt lgkmcnt(11)
    ds_read_b64_tr_b16 a[162:163], v15 offset:4096
    v_lshlrev_b32 v240, 4, v240
    v_mfma_f32_16x16x32_bf16 v[112:115], a[216:219], a[72:75], v[112:115]
    s_waitcnt lgkmcnt(10)
    ds_read_b64_tr_b16 a[164:165], v15 offset:8192
    v_mov_b32 v241, 0x3f80
    v_mfma_f32_16x16x32_bf16 v[112:115], a[220:223], a[76:79], v[112:115]
    s_waitcnt lgkmcnt(9)
    ds_read_b64_tr_b16 a[166:167], v15 offset:12288
    v_lshlrev_b32 v240, v240, v241
    v_mfma_f32_16x16x32_bf16 v[112:115], a[224:227], a[80:83], v[112:115]
    s_waitcnt lgkmcnt(8)
    ds_read_b64_tr_b16 a[168:169], v15 offset:16384
    v_cvt_pk_bf16_f32 v230, v108, v109
    v_mfma_f32_16x16x32_bf16 v[112:115], a[228:231], a[84:87], v[112:115]
    s_waitcnt lgkmcnt(7)
    s_add_u32 s38, s93, 164352
    ds_read_b64_tr_b16 a[170:171], v15 offset:20480
    v_cvt_pk_bf16_f32 v231, v110, v111
    v_mfma_f32_16x16x32_bf16 v[112:115], a[232:235], a[88:91], v[112:115]
    s_waitcnt lgkmcnt(6)
    buffer_store_dwordx4 v[228:231], v56, s[28:31], s38 offen sc1
    v_mfma_f32_16x16x32_bf16 v[112:115], a[236:239], a[92:95], v[112:115]
    ds_read_b64_tr_b16 a[172:173], v15 offset:24576
    ds_read_b64_tr_b16 a[174:175], v15 offset:28672
    v_mfma_f32_16x16x32_bf16 v[116:119], a[208:211], a[96:99], v[116:119]
    ds_read_b64_tr_b16 a[176:177], v19 offset:0
    v_bfe_i32 v241, v1, 1, 1
    v_mfma_f32_16x16x32_bf16 v[116:119], a[212:215], a[100:103], v[116:119]
    ds_read_b64_tr_b16 a[178:179], v19 offset:4096
    v_and_b32 v243, v240, v241
    v_mfma_f32_16x16x32_bf16 v[116:119], a[216:219], a[104:107], v[116:119]
    ds_read_b64_tr_b16 a[180:181], v19 offset:8192
    v_xor_b32 v242, v240, v243
    v_mfma_f32_16x16x32_bf16 v[116:119], a[220:223], a[108:111], v[116:119]
    ds_read_b64_tr_b16 a[182:183], v19 offset:12288
    v_cndmask_b32 v250, 0, v242, s[54:55]
    v_mfma_f32_16x16x32_bf16 v[116:119], a[224:227], a[112:115], v[116:119]
    ds_read_b64_tr_b16 a[184:185], v19 offset:16384
    v_cvt_pk_bf16_f32 v232, v112, v113
    v_mfma_f32_16x16x32_bf16 v[116:119], a[228:231], a[116:119], v[116:119]
    ds_read_b64_tr_b16 a[186:187], v19 offset:20480
    v_cvt_pk_bf16_f32 v233, v114, v115
    v_mfma_f32_16x16x32_bf16 v[116:119], a[232:235], a[120:123], v[116:119]
    ds_read_b64_tr_b16 a[188:189], v19 offset:24576
    v_cndmask_b32 v251, 0, v243, s[54:55]
    v_mfma_f32_16x16x32_bf16 v[116:119], a[236:239], a[124:127], v[116:119]
    s_waitcnt lgkmcnt(13)
    ds_read_b64_tr_b16 a[190:191], v19 offset:28672
    v_mov_b32 v248, 0
    s_waitcnt vmcnt(14)
    s_barrier
    v_mfma_f32_16x16x32_bf16 v[120:123], a[160:163], a[64:67], v[120:123]
    s_waitcnt lgkmcnt(12)
    ds_read_b64_tr_b16 a[208:209], v20 offset:0
    v_mov_b32 v249, 0
    v_mfma_f32_16x16x32_bf16 v[120:123], a[164:167], a[68:71], v[120:123]
    s_waitcnt lgkmcnt(11)
    ds_read_b64_tr_b16 a[210:211], v20 offset:4096
    v_mov_b32 v252, 0
    v_mfma_f32_16x16x32_bf16 v[120:123], a[168:171], a[72:75], v[120:123]
    s_waitcnt lgkmcnt(10)
    ds_read_b64_tr_b16 a[212:213], v20 offset:8192
    v_mov_b32 v253, 0
    v_mfma_f32_16x16x32_bf16 v[120:123], a[172:175], a[76:79], v[120:123]
    s_waitcnt lgkmcnt(9)
    ds_read_b64_tr_b16 a[214:215], v20 offset:12288
    v_mov_b32 v240, 0
    v_mfma_f32_16x16x32_bf16 v[120:123], a[176:179], a[80:83], v[120:123]
    s_waitcnt lgkmcnt(8)
    ds_read_b64_tr_b16 a[216:217], v20 offset:16384
    v_cvt_pk_bf16_f32 v236, v116, v117
    v_mfma_f32_16x16x32_bf16 v[120:123], a[180:183], a[84:87], v[120:123]
    s_waitcnt lgkmcnt(7)
    ds_read_b64_tr_b16 a[218:219], v20 offset:20480
    v_cvt_pk_bf16_f32 v237, v118, v119
    v_mfma_f32_16x16x32_bf16 v[120:123], a[184:187], a[88:91], v[120:123]
    s_waitcnt lgkmcnt(6)
    s_add_u32 s49, s7, 768
    ds_read_b64_tr_b16 a[220:221], v20 offset:24576
    v_mov_b32 v241, 0
    v_mfma_f32_16x16x32_bf16 v[120:123], a[188:191], a[92:95], v[120:123]
    s_add_u32 m0, s42, 98304
    ds_read_b64_tr_b16 a[222:223], v20 offset:28672
    v_mfma_f32_16x16x32_bf16 v[124:127], a[160:163], a[96:99], v[124:127]
    buffer_load_dwordx4 v46, s[20:23], s49 offen lds
    v_mfma_f32_16x16x32_bf16 v[124:127], a[164:167], a[100:103], v[124:127]
    ds_read_b64_tr_b16 a[224:225], v24 offset:0
    ds_read_b64_tr_b16 a[226:227], v24 offset:4096
    v_mfma_f32_16x16x32_bf16 v[124:127], a[168:171], a[104:107], v[124:127]
    buffer_load_dwordx4 v47, s[20:23], s49 offen offset:1024 lds
    v_mfma_f32_16x16x32_bf16 v[124:127], a[172:175], a[108:111], v[124:127]
    ds_read_b64_tr_b16 a[228:229], v24 offset:8192
    ds_read_b64_tr_b16 a[230:231], v24 offset:12288
    v_mfma_f32_16x16x32_bf16 v[124:127], a[176:179], a[112:115], v[124:127]
    ds_read_b64_tr_b16 a[232:233], v24 offset:16384
    v_cvt_pk_bf16_f32 v234, v120, v121
    v_mfma_f32_16x16x32_bf16 v[124:127], a[180:183], a[116:119], v[124:127]
    s_add_u32 s38, s93, 640
    ds_read_b64_tr_b16 a[234:235], v24 offset:20480
    v_cvt_pk_bf16_f32 v235, v122, v123
    v_mfma_f32_16x16x32_bf16 v[124:127], a[184:187], a[120:123], v[124:127]
    buffer_store_dwordx4 v[232:235], v56, s[28:31], s38 offen sc1
    v_mfma_f32_16x16x32_bf16 v[124:127], a[188:191], a[124:127], v[124:127]
    s_waitcnt lgkmcnt(12)
    ds_read_b64_tr_b16 a[236:237], v24 offset:24576
    ds_read_b64_tr_b16 a[238:239], v24 offset:28672
    v_mfma_f32_16x16x32_bf16 v[64:67], a[208:211], v[128:131], 0
    s_waitcnt lgkmcnt(12)
    buffer_load_dwordx4 v48, s[20:23], s49 offen offset:2048 lds
    v_mfma_f32_16x16x32_bf16 v[64:67], a[212:215], v[132:135], v[64:67]
    s_waitcnt lgkmcnt(10)
    ds_read_b64_tr_b16 a[160:161], v21 offset:0
    ds_read_b64_tr_b16 a[162:163], v21 offset:4096
    v_mfma_f32_16x16x32_bf16 v[64:67], a[216:219], v[136:139], v[64:67]
    s_waitcnt lgkmcnt(10)
    buffer_load_dwordx4 v49, s[20:23], s49 offen offset:3072 lds
    v_mfma_f32_16x16x32_bf16 v[64:67], a[220:223], v[140:143], v[64:67]
    s_waitcnt lgkmcnt(8)
    ds_read_b64_tr_b16 a[164:165], v21 offset:8192
    ds_read_b64_tr_b16 a[166:167], v21 offset:12288
    v_mfma_f32_16x16x32_bf16 v[64:67], a[224:227], v[144:147], v[64:67]
    s_waitcnt lgkmcnt(8)
    ds_read_b64_tr_b16 a[168:169], v21 offset:16384
    v_cvt_pk_bf16_f32 v238, v124, v125
    v_mfma_f32_16x16x32_bf16 v[64:67], a[228:231], v[148:151], v[64:67]
    s_waitcnt lgkmcnt(7)
    s_add_u32 s38, s93, 164480
    ds_read_b64_tr_b16 a[170:171], v21 offset:20480
    v_cvt_pk_bf16_f32 v239, v126, v127
    v_mfma_f32_16x16x32_bf16 v[64:67], a[232:235], v[152:155], v[64:67]
    s_waitcnt lgkmcnt(6)
    s_add_u32 s49, s7, 74496
    buffer_store_dwordx4 v[236:239], v56, s[28:31], s38 offen sc1
    v_mfma_f32_16x16x32_bf16 v[64:67], a[236:239], v[156:159], v[64:67]
    s_add_u32 m0, s42, 114688
    ds_read_b64_tr_b16 a[172:173], v21 offset:24576
    ds_read_b64_tr_b16 a[174:175], v21 offset:28672
    v_mfma_f32_16x16x32_bf16 v[68:71], a[208:211], v[160:163], 0
    buffer_load_dwordx4 v46, s[20:23], s49 offen lds
    v_mfma_f32_16x16x32_bf16 v[68:71], a[212:215], v[164:167], v[68:71]
    ds_read_b64_tr_b16 a[176:177], v25 offset:0
    ds_read_b64_tr_b16 a[178:179], v25 offset:4096
    v_mfma_f32_16x16x32_bf16 v[68:71], a[216:219], v[168:171], v[68:71]
    buffer_load_dwordx4 v47, s[20:23], s49 offen offset:1024 lds
    v_mfma_f32_16x16x32_bf16 v[68:71], a[220:223], v[172:175], v[68:71]
    ds_read_b64_tr_b16 a[180:181], v25 offset:8192
    ds_read_b64_tr_b16 a[182:183], v25 offset:12288
    v_mfma_f32_16x16x32_bf16 v[68:71], a[224:227], v[176:179], v[68:71]
    buffer_load_dwordx2 v[36:37], v4, s[12:15], 0 offen offset:0
    v_mfma_f32_16x16x32_bf16 v[68:71], a[228:231], v[180:183], v[68:71]
    ds_read_b64_tr_b16 a[184:185], v25 offset:16384
    ds_read_b64_tr_b16 a[186:187], v25 offset:20480
    v_mfma_f32_16x16x32_bf16 v[68:71], a[232:235], v[184:187], v[68:71]
    ds_read_b64_tr_b16 a[188:189], v25 offset:24576
    v_mfma_f32_16x16x32_bf16 v[68:71], a[236:239], v[188:191], v[68:71]
    s_waitcnt lgkmcnt(13)
    ds_read_b64_tr_b16 a[190:191], v25 offset:28672
    v_mfma_f32_16x16x32_bf16 v[72:75], a[160:163], v[128:131], 0
    s_waitcnt lgkmcnt(12)
    buffer_load_dwordx4 v48, s[20:23], s49 offen offset:2048 lds
    v_mfma_f32_16x16x32_bf16 v[72:75], a[164:167], v[132:135], v[72:75]
    s_waitcnt lgkmcnt(10)
    ds_read_b64_tr_b16 a[208:209], v22 offset:0
    ds_read_b64_tr_b16 a[210:211], v22 offset:4096
    v_mfma_f32_16x16x32_bf16 v[72:75], a[168:171], v[136:139], v[72:75]
    s_waitcnt lgkmcnt(10)
    buffer_load_dwordx4 v49, s[20:23], s49 offen offset:3072 lds
    v_mfma_f32_16x16x32_bf16 v[72:75], a[172:175], v[140:143], v[72:75]
    s_waitcnt lgkmcnt(8)
    ds_read_b64_tr_b16 a[212:213], v22 offset:8192
    ds_read_b64_tr_b16 a[214:215], v22 offset:12288
    v_mfma_f32_16x16x32_bf16 v[72:75], a[176:179], v[144:147], v[72:75]
    s_waitcnt lgkmcnt(8)
    ds_read_b64_tr_b16 a[216:217], v22 offset:16384
    v_mfma_f32_16x16x32_bf16 v[72:75], a[180:183], v[148:151], v[72:75]
    s_waitcnt lgkmcnt(7)
    ds_read_b64_tr_b16 a[218:219], v22 offset:20480
    v_mfma_f32_16x16x32_bf16 v[72:75], a[184:187], v[152:155], v[72:75]
    s_waitcnt lgkmcnt(6)
    ds_read_b64_tr_b16 a[220:221], v22 offset:24576
    v_mfma_f32_16x16x32_bf16 v[72:75], a[188:191], v[156:159], v[72:75]
    ds_read_b64_tr_b16 a[222:223], v22 offset:28672
    v_mfma_f32_16x16x32_bf16 v[76:79], a[160:163], v[160:163], 0
    buffer_load_dwordx2 v[38:39], v4, s[12:15], 0 offen offset:32
    v_mfma_f32_16x16x32_bf16 v[76:79], a[164:167], v[164:167], v[76:79]
    ds_read_b64_tr_b16 a[224:225], v26 offset:0
    ds_read_b64_tr_b16 a[226:227], v26 offset:4096
    v_mfma_f32_16x16x32_bf16 v[76:79], a[168:171], v[168:171], v[76:79]
    ds_read_b64_tr_b16 a[228:229], v26 offset:8192
    v_mfma_f32_16x16x32_bf16 v[76:79], a[172:175], v[172:175], v[76:79]
    ds_read_b64_tr_b16 a[230:231], v26 offset:12288
    v_mfma_f32_16x16x32_bf16 v[76:79], a[176:179], v[176:179], v[76:79]
    ds_read_b64_tr_b16 a[232:233], v26 offset:16384
    v_mfma_f32_16x16x32_bf16 v[76:79], a[180:183], v[180:183], v[76:79]
Ltour10:
    s_cbranch_execz Ltour14
    ds_read_b64_tr_b16 a[234:235], v26 offset:20480
    v_mfma_f32_16x16x32_bf16 v[76:79], a[184:187], v[184:187], v[76:79]
    buffer_load_dword v63, v63, s[88:91], 0 offen sc1
    v_mfma_f32_16x16x32_bf16 v[76:79], a[188:191], v[188:191], v[76:79]
    s_waitcnt lgkmcnt(12)
    ds_read_b64_tr_b16 a[236:237], v26 offset:24576
    ds_read_b64_tr_b16 a[238:239], v26 offset:28672
    v_mfma_f32_16x16x32_bf16 v[80:83], a[208:211], v[128:131], 0
    s_waitcnt lgkmcnt(12)
    ds_read_b64_tr_b16 a[160:161], v23 offset:0
    v_mfma_f32_16x16x32_bf16 v[80:83], a[212:215], v[132:135], v[80:83]
    s_waitcnt lgkmcnt(11)
    ds_read_b64_tr_b16 a[162:163], v23 offset:4096
    v_mfma_f32_16x16x32_bf16 v[80:83], a[216:219], v[136:139], v[80:83]
    s_waitcnt lgkmcnt(10)
    buffer_load_dwordx2 v[40:41], v4, s[12:15], 0 offen offset:512
    v_mfma_f32_16x16x32_bf16 v[80:83], a[220:223], v[140:143], v[80:83]
    s_waitcnt lgkmcnt(8)
    ds_read_b64_tr_b16 a[164:165], v23 offset:8192
    ds_read_b64_tr_b16 a[166:167], v23 offset:12288
    v_mfma_f32_16x16x32_bf16 v[80:83], a[224:227], v[144:147], v[80:83]
    s_waitcnt lgkmcnt(8)
    ds_read_b64_tr_b16 a[168:169], v23 offset:16384
    v_mfma_f32_16x16x32_bf16 v[80:83], a[228:231], v[148:151], v[80:83]
    s_waitcnt lgkmcnt(7)
    ds_read_b64_tr_b16 a[170:171], v23 offset:20480
    v_mfma_f32_16x16x32_bf16 v[80:83], a[232:235], v[152:155], v[80:83]
    s_waitcnt lgkmcnt(6)
    ds_read_b64_tr_b16 a[172:173], v23 offset:24576
    v_mfma_f32_16x16x32_bf16 v[80:83], a[236:239], v[156:159], v[80:83]
    ds_read_b64_tr_b16 a[174:175], v23 offset:28672
    v_mfma_f32_16x16x32_bf16 v[84:87], a[208:211], v[160:163], 0
    ds_read_b64_tr_b16 a[176:177], v27 offset:0
    v_mfma_f32_16x16x32_bf16 v[84:87], a[212:215], v[164:167], v[84:87]
    ds_read_b64_tr_b16 a[178:179], v27 offset:4096
    v_mfma_f32_16x16x32_bf16 v[84:87], a[216:219], v[168:171], v[84:87]
    buffer_load_dwordx2 v[42:43], v4, s[12:15], 0 offen offset:544
    v_mfma_f32_16x16x32_bf16 v[84:87], a[220:223], v[172:175], v[84:87]
    ds_read_b64_tr_b16 a[180:181], v27 offset:8192
    ds_read_b64_tr_b16 a[182:183], v27 offset:12288
    v_mfma_f32_16x16x32_bf16 v[84:87], a[224:227], v[176:179], v[84:87]
    ds_read_b64_tr_b16 a[184:185], v27 offset:16384
    v_mfma_f32_16x16x32_bf16 v[84:87], a[228:231], v[180:183], v[84:87]
    ds_read_b64_tr_b16 a[186:187], v27 offset:20480
    v_mfma_f32_16x16x32_bf16 v[84:87], a[232:235], v[184:187], v[84:87]
    ds_read_b64_tr_b16 a[188:189], v27 offset:24576
    v_mfma_f32_16x16x32_bf16 v[84:87], a[236:239], v[188:191], v[84:87]
    s_waitcnt lgkmcnt(13)
    ds_read_b64_tr_b16 a[190:191], v27 offset:28672
    s_waitcnt vmcnt(17)
    s_barrier
    v_mfma_f32_16x16x32_bf16 v[88:91], a[160:163], v[128:131], 0
    s_waitcnt lgkmcnt(12)
    ds_read_b64_tr_b16 a[208:209], v12 offset:32768
    v_mfma_f32_16x16x32_bf16 v[88:91], a[164:167], v[132:135], v[88:91]
    s_waitcnt lgkmcnt(11)
    ds_read_b64_tr_b16 a[210:211], v12 offset:36864
    v_mfma_f32_16x16x32_bf16 v[88:91], a[168:171], v[136:139], v[88:91]
    s_waitcnt lgkmcnt(10)
    buffer_load_dwordx2 v[244:245], v58, s[12:15], 0 offen offset:1024
    v_mfma_f32_16x16x32_bf16 v[88:91], a[172:175], v[140:143], v[88:91]
    s_waitcnt lgkmcnt(8)
    ds_read_b64_tr_b16 a[212:213], v12 offset:40960
    ds_read_b64_tr_b16 a[214:215], v12 offset:45056
    v_mfma_f32_16x16x32_bf16 v[88:91], a[176:179], v[144:147], v[88:91]
    s_waitcnt lgkmcnt(8)
    ds_read_b64_tr_b16 a[216:217], v12 offset:49152
    v_mfma_f32_16x16x32_bf16 v[88:91], a[180:183], v[148:151], v[88:91]
    s_waitcnt lgkmcnt(7)
    ds_read_b64_tr_b16 a[218:219], v12 offset:53248
    v_mfma_f32_16x16x32_bf16 v[88:91], a[184:187], v[152:155], v[88:91]
    s_waitcnt lgkmcnt(6)
    s_add_u32 s49, s46, 768
    ds_read_b64_tr_b16 a[220:221], v12 offset:57344
    v_mfma_f32_16x16x32_bf16 v[88:91], a[188:191], v[156:159], v[88:91]
    s_add_u32 m0, s42, 0
    ds_read_b64_tr_b16 a[222:223], v12 offset:61440
    v_mfma_f32_16x16x32_bf16 v[92:95], a[160:163], v[160:163], 0
    buffer_load_dwordx4 v46, s[20:23], s49 offen lds
    v_mfma_f32_16x16x32_bf16 v[92:95], a[164:167], v[164:167], v[92:95]
    ds_read_b64_tr_b16 a[224:225], v16 offset:32768
    ds_read_b64_tr_b16 a[226:227], v16 offset:36864
    v_mfma_f32_16x16x32_bf16 v[92:95], a[168:171], v[168:171], v[92:95]
    buffer_load_dwordx4 v47, s[20:23], s49 offen offset:1024 lds
    v_mfma_f32_16x16x32_bf16 v[92:95], a[172:175], v[172:175], v[92:95]
    ds_read_b64_tr_b16 a[228:229], v16 offset:40960
    ds_read_b64_tr_b16 a[230:231], v16 offset:45056
    v_mfma_f32_16x16x32_bf16 v[92:95], a[176:179], v[176:179], v[92:95]
    ds_read_b64_tr_b16 a[232:233], v16 offset:49152
    v_mfma_f32_16x16x32_bf16 v[92:95], a[180:183], v[180:183], v[92:95]
    ds_read_b64_tr_b16 a[234:235], v16 offset:53248
    v_mfma_f32_16x16x32_bf16 v[92:95], a[184:187], v[184:187], v[92:95]
    buffer_load_dwordx2 v[246:247], v58, s[12:15], 0 offen offset:1056
    v_mfma_f32_16x16x32_bf16 v[92:95], a[188:191], v[188:191], v[92:95]
    s_waitcnt lgkmcnt(12)
    ds_read_b64_tr_b16 a[236:237], v16 offset:57344
    ds_read_b64_tr_b16 a[238:239], v16 offset:61440
    v_mfma_f32_16x16x32_bf16 v[64:67], a[208:211], a[64:67], v[64:67]
    s_waitcnt lgkmcnt(12)
    buffer_load_dwordx4 v48, s[20:23], s49 offen offset:2048 lds
    v_mfma_f32_16x16x32_bf16 v[64:67], a[212:215], a[68:71], v[64:67]
    s_waitcnt lgkmcnt(10)
    ds_read_b64_tr_b16 a[160:161], v13 offset:32768
    ds_read_b64_tr_b16 a[162:163], v13 offset:36864
    v_mfma_f32_16x16x32_bf16 v[64:67], a[216:219], a[72:75], v[64:67]
    s_waitcnt lgkmcnt(10)
    buffer_load_dwordx4 v49, s[20:23], s49 offen offset:3072 lds
    v_mfma_f32_16x16x32_bf16 v[64:67], a[220:223], a[76:79], v[64:67]
    s_waitcnt lgkmcnt(8)
    ds_read_b64_tr_b16 a[164:165], v13 offset:40960
    ds_read_b64_tr_b16 a[166:167], v13 offset:45056
    v_mfma_f32_16x16x32_bf16 v[64:67], a[224:227], a[80:83], v[64:67]
    s_waitcnt lgkmcnt(8)
    ds_read_b64_tr_b16 a[168:169], v13 offset:49152
    v_mfma_f32_16x16x32_bf16 v[64:67], a[228:231], a[84:87], v[64:67]
    s_waitcnt lgkmcnt(7)
    ds_read_b64_tr_b16 a[170:171], v13 offset:53248
    v_mfma_f32_16x16x32_bf16 v[64:67], a[232:235], a[88:91], v[64:67]
    s_waitcnt lgkmcnt(6)
    s_add_u32 s49, s46, 74496
    ds_read_b64_tr_b16 a[172:173], v13 offset:57344
    v_mfma_f32_16x16x32_bf16 v[64:67], a[236:239], a[92:95], v[64:67]
    s_add_u32 m0, s42, 16384
    ds_read_b64_tr_b16 a[174:175], v13 offset:61440
    v_mfma_f32_16x16x32_bf16 v[68:71], a[208:211], a[96:99], v[68:71]
    buffer_load_dwordx4 v46, s[20:23], s49 offen lds
    v_mfma_f32_16x16x32_bf16 v[68:71], a[212:215], a[100:103], v[68:71]
    ds_read_b64_tr_b16 a[176:177], v17 offset:32768
    ds_read_b64_tr_b16 a[178:179], v17 offset:36864
    v_mfma_f32_16x16x32_bf16 v[68:71], a[216:219], a[104:107], v[68:71]
    buffer_load_dwordx4 v47, s[20:23], s49 offen offset:1024 lds
    v_mfma_f32_16x16x32_bf16 v[68:71], a[220:223], a[108:111], v[68:71]
    ds_read_b64_tr_b16 a[180:181], v17 offset:40960
    ds_read_b64_tr_b16 a[182:183], v17 offset:45056
    v_mfma_f32_16x16x32_bf16 v[68:71], a[224:227], a[112:115], v[68:71]
    ds_read_b64_tr_b16 a[184:185], v17 offset:49152
    v_cvt_pk_bf16_f32 v224, v64, v65
    v_mfma_f32_16x16x32_bf16 v[68:71], a[228:231], a[116:119], v[68:71]
    ds_read_b64_tr_b16 a[186:187], v17 offset:53248
    v_cvt_pk_bf16_f32 v225, v66, v67
    v_mfma_f32_16x16x32_bf16 v[68:71], a[232:235], a[120:123], v[68:71]
    ds_read_b64_tr_b16 a[188:189], v17 offset:57344
    v_mfma_f32_16x16x32_bf16 v[68:71], a[236:239], a[124:127], v[68:71]
    s_waitcnt lgkmcnt(13)
    ds_read_b64_tr_b16 a[190:191], v17 offset:61440
    v_mfma_f32_16x16x32_bf16 v[72:75], a[160:163], a[64:67], v[72:75]
    s_waitcnt lgkmcnt(12)
    buffer_load_dwordx4 v48, s[20:23], s49 offen offset:2048 lds
    v_mfma_f32_16x16x32_bf16 v[72:75], a[164:167], a[68:71], v[72:75]
    s_waitcnt lgkmcnt(10)
    ds_read_b64_tr_b16 a[208:209], v14 offset:32768
    ds_read_b64_tr_b16 a[210:211], v14 offset:36864
    v_mfma_f32_16x16x32_bf16 v[72:75], a[168:171], a[72:75], v[72:75]
    s_waitcnt lgkmcnt(10)
    buffer_load_dwordx4 v49, s[20:23], s49 offen offset:3072 lds
    v_mfma_f32_16x16x32_bf16 v[72:75], a[172:175], a[76:79], v[72:75]
    s_waitcnt lgkmcnt(8)
    ds_read_b64_tr_b16 a[212:213], v14 offset:40960
    ds_read_b64_tr_b16 a[214:215], v14 offset:45056
    v_mfma_f32_16x16x32_bf16 v[72:75], a[176:179], a[80:83], v[72:75]
    s_waitcnt lgkmcnt(8)
    ds_read_b64_tr_b16 a[216:217], v14 offset:49152
    v_cvt_pk_bf16_f32 v228, v68, v69
    v_mfma_f32_16x16x32_bf16 v[72:75], a[180:183], a[84:87], v[72:75]
    s_waitcnt lgkmcnt(7)
    s_waitcnt vmcnt(19)
    ds_read_b64_tr_b16 a[218:219], v14 offset:53248
    v_cvt_pk_bf16_f32 v229, v70, v71
    v_mfma_f32_16x16x32_bf16 v[72:75], a[184:187], a[88:91], v[72:75]
    s_waitcnt lgkmcnt(6)
    s_and_b32 s42, s2, 7
    buffer_store_dword v10, v8, s[24:27], s92 offen sc1
    v_mfma_f32_16x16x32_bf16 v[72:75], a[188:191], a[92:95], v[72:75]
    s_mov_b64 s[20:21], s[52:53]
    s_add_u32 s92, s92, 4
    ds_read_b64_tr_b16 a[220:221], v14 offset:57344
    ds_read_b64_tr_b16 a[222:223], v14 offset:61440
    v_mfma_f32_16x16x32_bf16 v[76:79], a[160:163], a[96:99], v[76:79]
    s_mov_b32 s22, 1152
    ds_read_b64_tr_b16 a[224:225], v18 offset:32768
    s_waitcnt vmcnt(13)
    v_readfirstlane_b32 s37, v63
    v_mfma_f32_16x16x32_bf16 v[76:79], a[164:167], a[100:103], v[76:79]
    s_mov_b32 s23, 0x20000
    ds_read_b64_tr_b16 a[226:227], v18 offset:36864
    v_mfma_f32_16x16x32_bf16 v[76:79], a[168:171], a[104:107], v[76:79]
    ds_read_b64_tr_b16 a[228:229], v18 offset:40960
    s_cmp_lt_u32 s37, 256
    s_cbranch_scc1 Lattn_armwait
Lattn_armed:
    v_mfma_f32_16x16x32_bf16 v[76:79], a[172:175], a[108:111], v[76:79]
    ds_read_b64_tr_b16 a[230:231], v18 offset:45056
    v_mfma_f32_16x16x32_bf16 v[76:79], a[176:179], a[112:115], v[76:79]
    ds_read_b64_tr_b16 a[232:233], v18 offset:49152
    v_cvt_pk_bf16_f32 v226, v72, v73
    v_mfma_f32_16x16x32_bf16 v[76:79], a[180:183], a[116:119], v[76:79]
    s_add_u32 s38, s93, 1024
    ds_read_b64_tr_b16 a[234:235], v18 offset:53248
    v_cvt_pk_bf16_f32 v227, v74, v75
    v_mfma_f32_16x16x32_bf16 v[76:79], a[184:187], a[120:123], v[76:79]
    buffer_store_dwordx4 v[224:227], v56, s[28:31], s38 offen sc1
    v_mfma_f32_16x16x32_bf16 v[76:79], a[188:191], a[124:127], v[76:79]
    s_waitcnt lgkmcnt(12)
    s_mov_b32 s45, 18688
    ds_read_b64_tr_b16 a[236:237], v18 offset:57344
    ds_read_b64_tr_b16 a[238:239], v18 offset:61440
    v_mfma_f32_16x16x32_bf16 v[80:83], a[208:211], a[64:67], v[80:83]
    s_waitcnt lgkmcnt(12)
    buffer_load_dwordx4 v[192:195], v5, s[24:27], s45 offen offset:0 sc1
    v_mfma_f32_16x16x32_bf16 v[80:83], a[212:215], a[68:71], v[80:83]
    s_waitcnt lgkmcnt(10)
    ds_read_b64_tr_b16 a[160:161], v15 offset:32768
    ds_read_b64_tr_b16 a[162:163], v15 offset:36864
    v_mfma_f32_16x16x32_bf16 v[80:83], a[216:219], a[72:75], v[80:83]
    s_waitcnt lgkmcnt(10)
    ds_read_b64_tr_b16 a[164:165], v15 offset:40960
    v_mfma_f32_16x16x32_bf16 v[80:83], a[220:223], a[76:79], v[80:83]
    s_waitcnt lgkmcnt(9)
    ds_read_b64_tr_b16 a[166:167], v15 offset:45056
    v_mfma_f32_16x16x32_bf16 v[80:83], a[224:227], a[80:83], v[80:83]
    s_waitcnt lgkmcnt(8)
    ds_read_b64_tr_b16 a[168:169], v15 offset:49152
    v_cvt_pk_bf16_f32 v230, v76, v77
    v_mfma_f32_16x16x32_bf16 v[80:83], a[228:231], a[84:87], v[80:83]
    s_waitcnt lgkmcnt(7)
    s_add_u32 s38, s93, 164864
    ds_read_b64_tr_b16 a[170:171], v15 offset:53248
    v_cvt_pk_bf16_f32 v231, v78, v79
    v_mfma_f32_16x16x32_bf16 v[80:83], a[232:235], a[88:91], v[80:83]
    s_waitcnt lgkmcnt(6)
    buffer_store_dwordx4 v[228:231], v56, s[28:31], s38 offen sc1
    v_mfma_f32_16x16x32_bf16 v[80:83], a[236:239], a[92:95], v[80:83]
    ds_read_b64_tr_b16 a[172:173], v15 offset:57344
    ds_read_b64_tr_b16 a[174:175], v15 offset:61440
    v_mfma_f32_16x16x32_bf16 v[84:87], a[208:211], a[96:99], v[84:87]
    buffer_load_dwordx4 v[196:199], v5, s[24:27], s45 offen offset:512 sc1
    v_mfma_f32_16x16x32_bf16 v[84:87], a[212:215], a[100:103], v[84:87]
    ds_read_b64_tr_b16 a[176:177], v19 offset:32768
    ds_read_b64_tr_b16 a[178:179], v19 offset:36864
    v_mfma_f32_16x16x32_bf16 v[84:87], a[216:219], a[104:107], v[84:87]
    ds_read_b64_tr_b16 a[180:181], v19 offset:40960
    v_mfma_f32_16x16x32_bf16 v[84:87], a[220:223], a[108:111], v[84:87]
    ds_read_b64_tr_b16 a[182:183], v19 offset:45056
    v_mfma_f32_16x16x32_bf16 v[84:87], a[224:227], a[112:115], v[84:87]
    ds_read_b64_tr_b16 a[184:185], v19 offset:49152
    v_cvt_pk_bf16_f32 v232, v80, v81
    v_mfma_f32_16x16x32_bf16 v[84:87], a[228:231], a[116:119], v[84:87]
    ds_read_b64_tr_b16 a[186:187], v19 offset:53248
    v_cvt_pk_bf16_f32 v233, v82, v83
    v_mfma_f32_16x16x32_bf16 v[84:87], a[232:235], a[120:123], v[84:87]
    buffer_load_dwordx4 v[200:203], v59, s[24:27], s45 offen offset:1024 sc1
    v_mfma_f32_16x16x32_bf16 v[84:87], a[236:239], a[124:127], v[84:87]
    s_waitcnt lgkmcnt(12)
    ds_read_b64_tr_b16 a[188:189], v19 offset:57344
    ds_read_b64_tr_b16 a[190:191], v19 offset:61440
    s_barrier
    v_mfma_f32_16x16x32_bf16 v[88:91], a[160:163], a[64:67], v[88:91]
    s_waitcnt lgkmcnt(12)
    ds_read_b64_tr_b16 a[208:209], v20 offset:32768
    v_mfma_f32_16x16x32_bf16 v[88:91], a[164:167], a[68:71], v[88:91]
    s_waitcnt lgkmcnt(11)
    s_mov_b32 s45, 20992
    ds_read_b64_tr_b16 a[210:211], v20 offset:36864
    v_mfma_f32_16x16x32_bf16 v[88:91], a[168:171], a[72:75], v[88:91]
    s_waitcnt lgkmcnt(10)
    buffer_load_dwordx4 v[204:207], v5, s[24:27], s45 offen offset:0 sc1
    v_mfma_f32_16x16x32_bf16 v[88:91], a[172:175], a[76:79], v[88:91]
    s_waitcnt lgkmcnt(8)
    ds_read_b64_tr_b16 a[212:213], v20 offset:40960
    ds_read_b64_tr_b16 a[214:215], v20 offset:45056
    v_mfma_f32_16x16x32_bf16 v[88:91], a[176:179], a[80:83], v[88:91]
    s_waitcnt lgkmcnt(8)
    ds_read_b64_tr_b16 a[216:217], v20 offset:49152
    v_cvt_pk_bf16_f32 v236, v84, v85
    v_mfma_f32_16x16x32_bf16 v[88:91], a[180:183], a[84:87], v[88:91]
    s_waitcnt lgkmcnt(7)
    ds_read_b64_tr_b16 a[218:219], v20 offset:53248
    v_cvt_pk_bf16_f32 v237, v86, v87
    v_mfma_f32_16x16x32_bf16 v[88:91], a[184:187], a[88:91], v[88:91]
    s_waitcnt lgkmcnt(6)
    ds_read_b64_tr_b16 a[220:221], v20 offset:57344
    v_mfma_f32_16x16x32_bf16 v[88:91], a[188:191], a[92:95], v[88:91]
    ds_read_b64_tr_b16 a[222:223], v20 offset:61440
    v_mfma_f32_16x16x32_bf16 v[92:95], a[160:163], a[96:99], v[92:95]
    buffer_load_dwordx4 v[208:211], v5, s[24:27], s45 offen offset:512 sc1
    v_mfma_f32_16x16x32_bf16 v[92:95], a[164:167], a[100:103], v[92:95]
    ds_read_b64_tr_b16 a[224:225], v24 offset:32768
    ds_read_b64_tr_b16 a[226:227], v24 offset:36864
    v_mfma_f32_16x16x32_bf16 v[92:95], a[168:171], a[104:107], v[92:95]
    ds_read_b64_tr_b16 a[228:229], v24 offset:40960
    v_mfma_f32_16x16x32_bf16 v[92:95], a[172:175], a[108:111], v[92:95]
    ds_read_b64_tr_b16 a[230:231], v24 offset:45056
    v_mfma_f32_16x16x32_bf16 v[92:95], a[176:179], a[112:115], v[92:95]
    ds_read_b64_tr_b16 a[232:233], v24 offset:49152
    v_cvt_pk_bf16_f32 v234, v88, v89
    v_mfma_f32_16x16x32_bf16 v[92:95], a[180:183], a[116:119], v[92:95]
    s_add_u32 s38, s93, 1152
    ds_read_b64_tr_b16 a[234:235], v24 offset:53248
    v_cvt_pk_bf16_f32 v235, v90, v91
    v_mfma_f32_16x16x32_bf16 v[92:95], a[184:187], a[120:123], v[92:95]
    buffer_store_dwordx4 v[232:235], v56, s[28:31], s38 offen sc1
    v_mfma_f32_16x16x32_bf16 v[92:95], a[188:191], a[124:127], v[92:95]
    s_waitcnt lgkmcnt(12)
    ds_read_b64_tr_b16 a[236:237], v24 offset:57344
    ds_read_b64_tr_b16 a[238:239], v24 offset:61440
    v_mfma_f32_16x16x32_bf16 v[96:99], a[208:211], v[128:131], 0
    s_waitcnt lgkmcnt(12)
    buffer_load_dwordx4 v[212:215], v59, s[24:27], s45 offen offset:1024 sc1
    v_mfma_f32_16x16x32_bf16 v[96:99], a[212:215], v[132:135], v[96:99]
    s_waitcnt lgkmcnt(10)
    ds_read_b64_tr_b16 a[160:161], v21 offset:32768
    ds_read_b64_tr_b16 a[162:163], v21 offset:36864
    v_mfma_f32_16x16x32_bf16 v[96:99], a[216:219], v[136:139], v[96:99]
    s_waitcnt lgkmcnt(10)
    ds_read_b64_tr_b16 a[164:165], v21 offset:40960
    v_mfma_f32_16x16x32_bf16 v[96:99], a[220:223], v[140:143], v[96:99]
    s_waitcnt lgkmcnt(9)
    ds_read_b64_tr_b16 a[166:167], v21 offset:45056
    v_mfma_f32_16x16x32_bf16 v[96:99], a[224:227], v[144:147], v[96:99]
    s_waitcnt lgkmcnt(8)
    ds_read_b64_tr_b16 a[168:169], v21 offset:49152
    v_cvt_pk_bf16_f32 v238, v92, v93
    v_mfma_f32_16x16x32_bf16 v[96:99], a[228:231], v[148:151], v[96:99]
    s_waitcnt lgkmcnt(7)
    s_add_u32 s38, s93, 164992
    ds_read_b64_tr_b16 a[170:171], v21 offset:53248
    v_cvt_pk_bf16_f32 v239, v94, v95
    v_mfma_f32_16x16x32_bf16 v[96:99], a[232:235], v[152:155], v[96:99]
    s_waitcnt lgkmcnt(6)
    buffer_store_dwordx4 v[236:239], v56, s[28:31], s38 offen sc1
    v_mfma_f32_16x16x32_bf16 v[96:99], a[236:239], v[156:159], v[96:99]
    s_mov_b32 s45, 19840
    ds_read_b64_tr_b16 a[172:173], v21 offset:57344
    ds_read_b64_tr_b16 a[174:175], v21 offset:61440
    v_mfma_f32_16x16x32_bf16 v[100:103], a[208:211], v[160:163], 0
    buffer_load_dwordx4 v[64:67], v5, s[24:27], s45 offen offset:0 sc1
    v_mfma_f32_16x16x32_bf16 v[100:103], a[212:215], v[164:167], v[100:103]
    ds_read_b64_tr_b16 a[176:177], v25 offset:32768
    ds_read_b64_tr_b16 a[178:179], v25 offset:36864
    v_mfma_f32_16x16x32_bf16 v[100:103], a[216:219], v[168:171], v[100:103]
    ds_read_b64_tr_b16 a[180:181], v25 offset:40960
    v_mfma_f32_16x16x32_bf16 v[100:103], a[220:223], v[172:175], v[100:103]
    ds_read_b64_tr_b16 a[182:183], v25 offset:45056
    v_mfma_f32_16x16x32_bf16 v[100:103], a[224:227], v[176:179], v[100:103]
    buffer_load_dwordx4 v[68:71], v5, s[24:27], s45 offen offset:512 sc1
    v_mfma_f32_16x16x32_bf16 v[100:103], a[228:231], v[180:183], v[100:103]
    ds_read_b64_tr_b16 a[184:185], v25 offset:49152
    ds_read_b64_tr_b16 a[186:187], v25 offset:53248
    v_mfma_f32_16x16x32_bf16 v[100:103], a[232:235], v[184:187], v[100:103]
    ds_read_b64_tr_b16 a[188:189], v25 offset:57344
    v_mfma_f32_16x16x32_bf16 v[100:103], a[236:239], v[188:191], v[100:103]
    s_waitcnt lgkmcnt(13)
    ds_read_b64_tr_b16 a[190:191], v25 offset:61440
    v_mfma_f32_16x16x32_bf16 v[104:107], a[160:163], v[128:131], 0
    s_waitcnt lgkmcnt(12)
    ds_read_b64_tr_b16 a[208:209], v22 offset:32768
    v_mfma_f32_16x16x32_bf16 v[104:107], a[164:167], v[132:135], v[104:107]
    s_waitcnt lgkmcnt(11)
    ds_read_b64_tr_b16 a[210:211], v22 offset:36864
    v_mfma_f32_16x16x32_bf16 v[104:107], a[168:171], v[136:139], v[104:107]
    s_waitcnt lgkmcnt(10)
    buffer_load_dwordx4 v[72:75], v59, s[24:27], s45 offen offset:1024 sc1
    v_mfma_f32_16x16x32_bf16 v[104:107], a[172:175], v[140:143], v[104:107]
    s_waitcnt lgkmcnt(8)
    ds_read_b64_tr_b16 a[212:213], v22 offset:40960
    ds_read_b64_tr_b16 a[214:215], v22 offset:45056
    v_mfma_f32_16x16x32_bf16 v[104:107], a[176:179], v[144:147], v[104:107]
    s_waitcnt lgkmcnt(8)
    ds_read_b64_tr_b16 a[216:217], v22 offset:49152
    v_mfma_f32_16x16x32_bf16 v[104:107], a[180:183], v[148:151], v[104:107]
    s_waitcnt lgkmcnt(7)
    ds_read_b64_tr_b16 a[218:219], v22 offset:53248
    v_mfma_f32_16x16x32_bf16 v[104:107], a[184:187], v[152:155], v[104:107]
    s_waitcnt lgkmcnt(6)
    ds_read_b64_tr_b16 a[220:221], v22 offset:57344
    v_mfma_f32_16x16x32_bf16 v[104:107], a[188:191], v[156:159], v[104:107]
    ds_read_b64_tr_b16 a[222:223], v22 offset:61440
    v_mfma_f32_16x16x32_bf16 v[108:111], a[160:163], v[160:163], 0
    buffer_load_dwordx2 v[76:77], v3, s[20:23], 0 offen offset:0
    v_mfma_f32_16x16x32_bf16 v[108:111], a[164:167], v[164:167], v[108:111]
    ds_read_b64_tr_b16 a[224:225], v26 offset:32768
    ds_read_b64_tr_b16 a[226:227], v26 offset:36864
    v_mfma_f32_16x16x32_bf16 v[108:111], a[168:171], v[168:171], v[108:111]
    ds_read_b64_tr_b16 a[228:229], v26 offset:40960
    v_mfma_f32_16x16x32_bf16 v[108:111], a[172:175], v[172:175], v[108:111]
    ds_read_b64_tr_b16 a[230:231], v26 offset:45056
    v_mfma_f32_16x16x32_bf16 v[108:111], a[176:179], v[176:179], v[108:111]
    ds_read_b64_tr_b16 a[232:233], v26 offset:49152
    v_mfma_f32_16x16x32_bf16 v[108:111], a[180:183], v[180:183], v[108:111]
    ds_read_b64_tr_b16 a[234:235], v26 offset:53248
    v_mfma_f32_16x16x32_bf16 v[108:111], a[184:187], v[184:187], v[108:111]
    buffer_load_dwordx2 v[78:79], v3, s[20:23], 0 offen offset:32
    v_mfma_f32_16x16x32_bf16 v[108:111], a[188:191], v[188:191], v[108:111]
    s_waitcnt lgkmcnt(12)
    ds_read_b64_tr_b16 a[236:237], v26 offset:57344
    ds_read_b64_tr_b16 a[238:239], v26 offset:61440
    v_mfma_f32_16x16x32_bf16 v[112:115], a[208:211], v[128:131], 0
    s_waitcnt lgkmcnt(12)
    ds_read_b64_tr_b16 a[160:161], v23 offset:32768
    v_mfma_f32_16x16x32_bf16 v[112:115], a[212:215], v[132:135], v[112:115]
    s_waitcnt lgkmcnt(11)
    ds_read_b64_tr_b16 a[162:163], v23 offset:36864
    v_mfma_f32_16x16x32_bf16 v[112:115], a[216:219], v[136:139], v[112:115]
    s_waitcnt lgkmcnt(10)
    ds_read_b64_tr_b16 a[164:165], v23 offset:40960
    v_mfma_f32_16x16x32_bf16 v[112:115], a[220:223], v[140:143], v[112:115]
    s_waitcnt lgkmcnt(9)
    ds_read_b64_tr_b16 a[166:167], v23 offset:45056
    v_mfma_f32_16x16x32_bf16 v[112:115], a[224:227], v[144:147], v[112:115]
    s_waitcnt lgkmcnt(8)
    buffer_load_dwordx2 v[80:81], v3, s[20:23], 0 offen offset:512
    v_mfma_f32_16x16x32_bf16 v[112:115], a[228:231], v[148:151], v[112:115]
    s_waitcnt lgkmcnt(6)
    ds_read_b64_tr_b16 a[168:169], v23 offset:49152
    ds_read_b64_tr_b16 a[170:171], v23 offset:53248
    v_mfma_f32_16x16x32_bf16 v[112:115], a[232:235], v[152:155], v[112:115]
    s_waitcnt lgkmcnt(6)
    ds_read_b64_tr_b16 a[172:173], v23 offset:57344
    v_mfma_f32_16x16x32_bf16 v[112:115], a[236:239], v[156:159], v[112:115]
    ds_read_b64_tr_b16 a[174:175], v23 offset:61440
    v_mfma_f32_16x16x32_bf16 v[116:119], a[208:211], v[160:163], 0
    ds_read_b64_tr_b16 a[176:177], v27 offset:32768
    v_mfma_f32_16x16x32_bf16 v[116:119], a[212:215], v[164:167], v[116:119]
    ds_read_b64_tr_b16 a[178:179], v27 offset:36864
    v_mfma_f32_16x16x32_bf16 v[116:119], a[216:219], v[168:171], v[116:119]
    buffer_load_dwordx2 v[82:83], v3, s[20:23], 0 offen offset:544
    v_mfma_f32_16x16x32_bf16 v[116:119], a[220:223], v[172:175], v[116:119]
    ds_read_b64_tr_b16 a[180:181], v27 offset:40960
    ds_read_b64_tr_b16 a[182:183], v27 offset:45056
    v_mfma_f32_16x16x32_bf16 v[116:119], a[224:227], v[176:179], v[116:119]
    ds_read_b64_tr_b16 a[184:185], v27 offset:49152
    v_mfma_f32_16x16x32_bf16 v[116:119], a[228:231], v[180:183], v[116:119]
    ds_read_b64_tr_b16 a[186:187], v27 offset:53248
    v_mfma_f32_16x16x32_bf16 v[116:119], a[232:235], v[184:187], v[116:119]
    buffer_load_dwordx2 v[84:85], v55, s[20:23], 0 offen offset:1024
    v_mfma_f32_16x16x32_bf16 v[116:119], a[236:239], v[188:191], v[116:119]
    ds_read_b64_tr_b16 a[188:189], v27 offset:57344
    ds_read_b64_tr_b16 a[190:191], v27 offset:61440
    s_waitcnt vmcnt(19)
    s_waitcnt lgkmcnt(0)
    s_barrier
    v_mfma_f32_16x16x32_bf16 v[120:123], a[160:163], v[128:131], 0
    ds_read_b64_tr_b16 a[208:209], v12 offset:0
    v_mfma_f32_16x16x32_bf16 v[120:123], a[164:167], v[132:135], v[120:123]
    ds_read_b64_tr_b16 a[210:211], v12 offset:4096
    v_mfma_f32_16x16x32_bf16 v[120:123], a[168:171], v[136:139], v[120:123]
    ds_read_b64_tr_b16 a[212:213], v12 offset:8192
    v_mfma_f32_16x16x32_bf16 v[120:123], a[172:175], v[140:143], v[120:123]
    ds_read_b64_tr_b16 a[214:215], v12 offset:12288
    v_mfma_f32_16x16x32_bf16 v[120:123], a[176:179], v[144:147], v[120:123]
    buffer_load_dwordx2 v[86:87], v55, s[20:23], 0 offen offset:1056
    v_mfma_f32_16x16x32_bf16 v[120:123], a[180:183], v[148:151], v[120:123]
    ds_read_b64_tr_b16 a[216:217], v12 offset:16384
    ds_read_b64_tr_b16 a[218:219], v12 offset:20480
    v_mfma_f32_16x16x32_bf16 v[120:123], a[184:187], v[152:155], v[120:123]
    ds_read_b64_tr_b16 a[220:221], v12 offset:24576
    v_mfma_f32_16x16x32_bf16 v[120:123], a[188:191], v[156:159], v[120:123]
    ds_read_b64_tr_b16 a[222:223], v12 offset:28672
    v_mfma_f32_16x16x32_bf16 v[124:127], a[160:163], v[160:163], 0
    ds_read_b64_tr_b16 a[224:225], v16 offset:0
    v_mfma_f32_16x16x32_bf16 v[124:127], a[164:167], v[164:167], v[124:127]
    s_mov_b32 s45, 22144
    ds_read_b64_tr_b16 a[226:227], v16 offset:4096
    v_mfma_f32_16x16x32_bf16 v[124:127], a[168:171], v[168:171], v[124:127]
    buffer_load_dwordx4 v[216:219], v5, s[24:27], s45 offen offset:0 sc1
    v_mfma_f32_16x16x32_bf16 v[124:127], a[172:175], v[172:175], v[124:127]
    ds_read_b64_tr_b16 a[228:229], v16 offset:8192
    ds_read_b64_tr_b16 a[230:231], v16 offset:12288
    v_mfma_f32_16x16x32_bf16 v[124:127], a[176:179], v[176:179], v[124:127]
    ds_read_b64_tr_b16 a[232:233], v16 offset:16384
    v_mfma_f32_16x16x32_bf16 v[124:127], a[180:183], v[180:183], v[124:127]
    ds_read_b64_tr_b16 a[234:235], v16 offset:20480
    v_mfma_f32_16x16x32_bf16 v[124:127], a[184:187], v[184:187], v[124:127]
    ds_read_b64_tr_b16 a[236:237], v16 offset:24576
    v_mfma_f32_16x16x32_bf16 v[124:127], a[188:191], v[188:191], v[124:127]
    s_waitcnt lgkmcnt(13)
    ds_read_b64_tr_b16 a[238:239], v16 offset:28672
    v_mfma_f32_16x16x32_bf16 v[96:99], a[208:211], a[64:67], v[96:99]
    s_waitcnt lgkmcnt(12)
    buffer_load_dwordx4 v[220:223], v5, s[24:27], s45 offen offset:512 sc1
    v_mfma_f32_16x16x32_bf16 v[96:99], a[212:215], a[68:71], v[96:99]
    s_waitcnt lgkmcnt(10)
    ds_read_b64_tr_b16 a[160:161], v13 offset:0
    ds_read_b64_tr_b16 a[162:163], v13 offset:4096
    v_mfma_f32_16x16x32_bf16 v[96:99], a[216:219], a[72:75], v[96:99]
    s_waitcnt lgkmcnt(10)
    ds_read_b64_tr_b16 a[164:165], v13 offset:8192
    v_mfma_f32_16x16x32_bf16 v[96:99], a[220:223], a[76:79], v[96:99]
    s_waitcnt lgkmcnt(9)
    ds_read_b64_tr_b16 a[166:167], v13 offset:12288
    v_mfma_f32_16x16x32_bf16 v[96:99], a[224:227], a[80:83], v[96:99]
    s_waitcnt lgkmcnt(8)
    ds_read_b64_tr_b16 a[168:169], v13 offset:16384
    v_mfma_f32_16x16x32_bf16 v[96:99], a[228:231], a[84:87], v[96:99]
    s_waitcnt lgkmcnt(7)
    ds_read_b64_tr_b16 a[170:171], v13 offset:20480
    v_mfma_f32_16x16x32_bf16 v[96:99], a[232:235], a[88:91], v[96:99]
    s_waitcnt lgkmcnt(6)
    buffer_load_dwordx4 v[88:91], v59, s[24:27], s45 offen offset:1024 sc1
    v_mfma_f32_16x16x32_bf16 v[96:99], a[236:239], a[92:95], v[96:99]
    ds_read_b64_tr_b16 a[172:173], v13 offset:24576
    ds_read_b64_tr_b16 a[174:175], v13 offset:28672
    v_mfma_f32_16x16x32_bf16 v[100:103], a[208:211], a[96:99], v[100:103]
    buffer_load_dword v11, v9, s[24:27], s39 offen sc1
    v_mfma_f32_16x16x32_bf16 v[100:103], a[212:215], a[100:103], v[100:103]
    ds_read_b64_tr_b16 a[176:177], v17 offset:0
    ds_read_b64_tr_b16 a[178:179], v17 offset:4096
    v_mfma_f32_16x16x32_bf16 v[100:103], a[216:219], a[104:107], v[100:103]
    ds_read_b64_tr_b16 a[180:181], v17 offset:8192
    v_mfma_f32_16x16x32_bf16 v[100:103], a[220:223], a[108:111], v[100:103]
    ds_read_b64_tr_b16 a[182:183], v17 offset:12288
    v_mfma_f32_16x16x32_bf16 v[100:103], a[224:227], a[112:115], v[100:103]
    ds_read_b64_tr_b16 a[184:185], v17 offset:16384
    v_cvt_pk_bf16_f32 v224, v96, v97
    v_mfma_f32_16x16x32_bf16 v[100:103], a[228:231], a[116:119], v[100:103]
    ds_read_b64_tr_b16 a[186:187], v17 offset:20480
    v_cvt_pk_bf16_f32 v225, v98, v99
    v_mfma_f32_16x16x32_bf16 v[100:103], a[232:235], a[120:123], v[100:103]
    ds_read_b64_tr_b16 a[188:189], v17 offset:24576
    v_mfma_f32_16x16x32_bf16 v[100:103], a[236:239], a[124:127], v[100:103]
    s_waitcnt lgkmcnt(13)
    ds_read_b64_tr_b16 a[190:191], v17 offset:28672
    v_mfma_f32_16x16x32_bf16 v[104:107], a[160:163], a[64:67], v[104:107]
    s_waitcnt lgkmcnt(12)
    ds_read_b64_tr_b16 a[208:209], v14 offset:0
    v_mfma_f32_16x16x32_bf16 v[104:107], a[164:167], a[68:71], v[104:107]
    s_waitcnt lgkmcnt(11)
    ds_read_b64_tr_b16 a[210:211], v14 offset:4096
    v_mfma_f32_16x16x32_bf16 v[104:107], a[168:171], a[72:75], v[104:107]
    s_waitcnt lgkmcnt(10)
    ds_read_b64_tr_b16 a[212:213], v14 offset:8192
    v_mfma_f32_16x16x32_bf16 v[104:107], a[172:175], a[76:79], v[104:107]
    s_waitcnt lgkmcnt(9)
    ds_read_b64_tr_b16 a[214:215], v14 offset:12288
    v_mfma_f32_16x16x32_bf16 v[104:107], a[176:179], a[80:83], v[104:107]
    s_waitcnt lgkmcnt(8)
    ds_read_b64_tr_b16 a[216:217], v14 offset:16384
    v_cvt_pk_bf16_f32 v228, v100, v101
    v_mfma_f32_16x16x32_bf16 v[104:107], a[180:183], a[84:87], v[104:107]
    s_waitcnt lgkmcnt(7)
    ds_read_b64_tr_b16 a[218:219], v14 offset:20480
    v_cvt_pk_bf16_f32 v229, v102, v103
    v_mfma_f32_16x16x32_bf16 v[104:107], a[184:187], a[88:91], v[104:107]
    s_waitcnt lgkmcnt(6)
    ds_read_b64_tr_b16 a[220:221], v14 offset:24576
    v_mfma_f32_16x16x32_bf16 v[104:107], a[188:191], a[92:95], v[104:107]
    ds_read_b64_tr_b16 a[222:223], v14 offset:28672
    v_mfma_f32_16x16x32_bf16 v[108:111], a[160:163], a[96:99], v[108:111]
    ds_read_b64_tr_b16 a[224:225], v18 offset:0
    v_mfma_f32_16x16x32_bf16 v[108:111], a[164:167], a[100:103], v[108:111]
    ds_read_b64_tr_b16 a[226:227], v18 offset:4096
    v_mfma_f32_16x16x32_bf16 v[108:111], a[168:171], a[104:107], v[108:111]
    ds_read_b64_tr_b16 a[228:229], v18 offset:8192
    v_mfma_f32_16x16x32_bf16 v[108:111], a[172:175], a[108:111], v[108:111]
    ds_read_b64_tr_b16 a[230:231], v18 offset:12288
    v_mfma_f32_16x16x32_bf16 v[108:111], a[176:179], a[112:115], v[108:111]
    ds_read_b64_tr_b16 a[232:233], v18 offset:16384
    v_cvt_pk_bf16_f32 v226, v104, v105
    v_mfma_f32_16x16x32_bf16 v[108:111], a[180:183], a[116:119], v[108:111]
    s_add_u32 s38, s93, 1536
    ds_read_b64_tr_b16 a[234:235], v18 offset:20480
    v_cvt_pk_bf16_f32 v227, v106, v107
    v_mfma_f32_16x16x32_bf16 v[108:111], a[184:187], a[120:123], v[108:111]
    buffer_store_dwordx4 v[224:227], v56, s[28:31], s38 offen sc1
    v_mfma_f32_16x16x32_bf16 v[108:111], a[188:191], a[124:127], v[108:111]
    s_waitcnt lgkmcnt(12)
    ds_read_b64_tr_b16 a[236:237], v18 offset:24576
    ds_read_b64_tr_b16 a[238:239], v18 offset:28672
    v_mfma_f32_16x16x32_bf16 v[112:115], a[208:211], a[64:67], v[112:115]
Ltour11:
    s_cbranch_execz Ltour15
    s_waitcnt lgkmcnt(12)
    ds_read_b64_tr_b16 a[160:161], v15 offset:0
    v_mfma_f32_16x16x32_bf16 v[112:115], a[212:215], a[68:71], v[112:115]
    s_waitcnt lgkmcnt(11)
    ds_read_b64_tr_b16 a[162:163], v15 offset:4096
    v_mfma_f32_16x16x32_bf16 v[112:115], a[216:219], a[72:75], v[112:115]
    s_waitcnt lgkmcnt(10)
    ds_read_b64_tr_b16 a[164:165], v15 offset:8192
    v_mfma_f32_16x16x32_bf16 v[112:115], a[220:223], a[76:79], v[112:115]
    s_waitcnt lgkmcnt(9)
    ds_read_b64_tr_b16 a[166:167], v15 offset:12288
    v_mfma_f32_16x16x32_bf16 v[112:115], a[224:227], a[80:83], v[112:115]
    s_waitcnt lgkmcnt(8)
    ds_read_b64_tr_b16 a[168:169], v15 offset:16384
    v_cvt_pk_bf16_f32 v230, v108, v109
    v_mfma_f32_16x16x32_bf16 v[112:115], a[228:231], a[84:87], v[112:115]
    s_waitcnt lgkmcnt(7)
    s_add_u32 s38, s93, 165376
    ds_read_b64_tr_b16 a[170:171], v15 offset:20480
    v_cvt_pk_bf16_f32 v231, v110, v111
    v_mfma_f32_16x16x32_bf16 v[112:115], a[232:235], a[88:91], v[112:115]
    s_waitcnt lgkmcnt(6)
    buffer_store_dwordx4 v[228:231], v56, s[28:31], s38 offen sc1
    v_mfma_f32_16x16x32_bf16 v[112:115], a[236:239], a[92:95], v[112:115]
    ds_read_b64_tr_b16 a[172:173], v15 offset:24576
    ds_read_b64_tr_b16 a[174:175], v15 offset:28672
    v_mfma_f32_16x16x32_bf16 v[116:119], a[208:211], a[96:99], v[116:119]
    ds_read_b64_tr_b16 a[176:177], v19 offset:0
    v_mfma_f32_16x16x32_bf16 v[116:119], a[212:215], a[100:103], v[116:119]
    ds_read_b64_tr_b16 a[178:179], v19 offset:4096
    v_mfma_f32_16x16x32_bf16 v[116:119], a[216:219], a[104:107], v[116:119]
    ds_read_b64_tr_b16 a[180:181], v19 offset:8192
    v_mfma_f32_16x16x32_bf16 v[116:119], a[220:223], a[108:111], v[116:119]
    ds_read_b64_tr_b16 a[182:183], v19 offset:12288
    v_mfma_f32_16x16x32_bf16 v[116:119], a[224:227], a[112:115], v[116:119]
    ds_read_b64_tr_b16 a[184:185], v19 offset:16384
    v_cvt_pk_bf16_f32 v232, v112, v113
    v_mfma_f32_16x16x32_bf16 v[116:119], a[228:231], a[116:119], v[116:119]
    ds_read_b64_tr_b16 a[186:187], v19 offset:20480
    v_cvt_pk_bf16_f32 v233, v114, v115
    v_mfma_f32_16x16x32_bf16 v[116:119], a[232:235], a[120:123], v[116:119]
    ds_read_b64_tr_b16 a[188:189], v19 offset:24576
    v_mfma_f32_16x16x32_bf16 v[116:119], a[236:239], a[124:127], v[116:119]
    s_waitcnt lgkmcnt(13)
    ds_read_b64_tr_b16 a[190:191], v19 offset:28672
    v_mfma_f32_16x16x32_bf16 v[120:123], a[160:163], a[64:67], v[120:123]
    s_waitcnt lgkmcnt(12)
    v_mfma_f32_16x16x32_bf16 v[120:123], a[164:167], a[68:71], v[120:123]
    s_waitcnt lgkmcnt(10)
    v_mfma_f32_16x16x32_bf16 v[120:123], a[168:171], a[72:75], v[120:123]
    s_waitcnt lgkmcnt(8)
    v_mfma_f32_16x16x32_bf16 v[120:123], a[172:175], a[76:79], v[120:123]
    s_waitcnt lgkmcnt(6)
    v_mfma_f32_16x16x32_bf16 v[120:123], a[176:179], a[80:83], v[120:123]
    s_waitcnt lgkmcnt(4)
    v_cvt_pk_bf16_f32 v236, v116, v117
    v_mfma_f32_16x16x32_bf16 v[120:123], a[180:183], a[84:87], v[120:123]
    s_waitcnt lgkmcnt(2)
    v_cvt_pk_bf16_f32 v237, v118, v119
    v_mfma_f32_16x16x32_bf16 v[120:123], a[184:187], a[88:91], v[120:123]
    s_waitcnt lgkmcnt(0)
    v_mfma_f32_16x16x32_bf16 v[120:123], a[188:191], a[92:95], v[120:123]
    v_mfma_f32_16x16x32_bf16 v[124:127], a[160:163], a[96:99], v[124:127]
    v_mfma_f32_16x16x32_bf16 v[124:127], a[164:167], a[100:103], v[124:127]
    v_mfma_f32_16x16x32_bf16 v[124:127], a[168:171], a[104:107], v[124:127]
    v_mfma_f32_16x16x32_bf16 v[124:127], a[172:175], a[108:111], v[124:127]
    v_mfma_f32_16x16x32_bf16 v[124:127], a[176:179], a[112:115], v[124:127]
    s_nop 2
    v_cvt_pk_bf16_f32 v234, v120, v121
    v_mfma_f32_16x16x32_bf16 v[124:127], a[180:183], a[116:119], v[124:127]
    s_add_u32 s38, s93, 1664
    v_cvt_pk_bf16_f32 v235, v122, v123
    v_mfma_f32_16x16x32_bf16 v[124:127], a[184:187], a[120:123], v[124:127]
    buffer_store_dwordx4 v[232:235], v56, s[28:31], s38 offen sc1
    v_mfma_f32_16x16x32_bf16 v[124:127], a[188:191], a[124:127], v[124:127]
    s_nop 7
    v_cvt_pk_bf16_f32 v238, v124, v125
    s_add_u32 s38, s93, 165504
    v_cvt_pk_bf16_f32 v239, v126, v127
    buffer_store_dwordx4 v[236:239], v56, s[28:31], s38 offen sc1
    s_waitcnt vmcnt(16)
    v_lshlrev_b32 v144, 16, v64
    v_and_b32 v145, 0xffff0000, v64
    v_lshlrev_b32 v146, 16, v65
    v_and_b32 v147, 0xffff0000, v65
    v_lshlrev_b32 v148, 16, v66
    v_and_b32 v149, 0xffff0000, v66
    v_lshlrev_b32 v150, 16, v67
    v_and_b32 v151, 0xffff0000, v67
    s_waitcnt vmcnt(15)
    v_lshlrev_b32 v152, 16, v68
    v_and_b32 v153, 0xffff0000, v68
    v_lshlrev_b32 v154, 16, v69
    v_and_b32 v155, 0xffff0000, v69
    v_lshlrev_b32 v156, 16, v70
    v_and_b32 v157, 0xffff0000, v70
    v_lshlrev_b32 v158, 16, v71
    v_and_b32 v159, 0xffff0000, v71
    s_waitcnt vmcnt(14)
    v_lshlrev_b32 v160, 16, v72
    v_and_b32 v161, 0xffff0000, v72
    v_lshlrev_b32 v162, 16, v73
    v_and_b32 v163, 0xffff0000, v73
    v_lshlrev_b32 v164, 16, v74
    v_and_b32 v165, 0xffff0000, v74
    v_lshlrev_b32 v166, 16, v75
    v_and_b32 v167, 0xffff0000, v75
    s_waitcnt vmcnt(13)
    v_lshlrev_b32 v168, 16, v76
    v_and_b32 v169, 0xffff0000, v76
    v_lshlrev_b32 v170, 16, v77
    v_and_b32 v171, 0xffff0000, v77
    s_waitcnt vmcnt(12)
    v_lshlrev_b32 v172, 16, v78
    v_and_b32 v173, 0xffff0000, v78
    v_lshlrev_b32 v174, 16, v79
    v_and_b32 v175, 0xffff0000, v79
    s_waitcnt vmcnt(11)
    v_lshlrev_b32 v176, 16, v80
    v_and_b32 v177, 0xffff0000, v80
    v_lshlrev_b32 v178, 16, v81
    v_and_b32 v179, 0xffff0000, v81
    s_waitcnt vmcnt(10)
    v_lshlrev_b32 v180, 16, v82
    v_and_b32 v181, 0xffff0000, v82
    v_lshlrev_b32 v182, 16, v83
    v_and_b32 v183, 0xffff0000, v83
    s_waitcnt vmcnt(9)
    v_lshlrev_b32 v184, 16, v84
    v_and_b32 v185, 0xffff0000, v84
    v_lshlrev_b32 v186, 16, v85
    v_and_b32 v187, 0xffff0000, v85
    s_waitcnt vmcnt(8)
    v_lshlrev_b32 v188, 16, v86
    v_and_b32 v189, 0xffff0000, v86
    v_lshlrev_b32 v190, 16, v87
    v_and_b32 v191, 0xffff0000, v87
    v_lshlrev_b32 v12, 16, v36
    v_and_b32 v13, 0xffff0000, v36
    v_lshlrev_b32 v14, 16, v37
    v_and_b32 v15, 0xffff0000, v37
    v_lshlrev_b32 v16, 16, v38
    v_and_b32 v17, 0xffff0000, v38
    v_lshlrev_b32 v18, 16, v39
    v_and_b32 v19, 0xffff0000, v39
    v_lshlrev_b32 v20, 16, v40
    v_and_b32 v21, 0xffff0000, v40
    v_lshlrev_b32 v22, 16, v41
    v_and_b32 v23, 0xffff0000, v41
    v_lshlrev_b32 v24, 16, v42
    v_and_b32 v25, 0xffff0000, v42
    v_lshlrev_b32 v26, 16, v43
    v_and_b32 v27, 0xffff0000, v43
    v_lshlrev_b32 v28, 16, v244
    v_and_b32 v29, 0xffff0000, v244
    v_lshlrev_b32 v30, 16, v245
    v_and_b32 v31, 0xffff0000, v245
    v_lshlrev_b32 v32, 16, v246
    v_and_b32 v33, 0xffff0000, v246
    v_lshlrev_b32 v34, 16, v247
    v_and_b32 v35, 0xffff0000, v247
    v_lshlrev_b32 v96, 16, v192
    v_and_b32 v97, 0xffff0000, v192
    v_lshlrev_b32 v98, 16, v193
    v_and_b32 v99, 0xffff0000, v193
    v_lshlrev_b32 v100, 16, v194
    v_and_b32 v101, 0xffff0000, v194
    v_lshlrev_b32 v102, 16, v195
    v_and_b32 v103, 0xffff0000, v195
    v_lshlrev_b32 v104, 16, v196
    v_and_b32 v105, 0xffff0000, v196
    v_lshlrev_b32 v106, 16, v197
    v_and_b32 v107, 0xffff0000, v197
    v_lshlrev_b32 v108, 16, v198
    v_and_b32 v109, 0xffff0000, v198
    v_lshlrev_b32 v110, 16, v199
    v_and_b32 v111, 0xffff0000, v199
    v_lshlrev_b32 v112, 16, v200
    v_and_b32 v113, 0xffff0000, v200
    v_lshlrev_b32 v114, 16, v201
    v_and_b32 v115, 0xffff0000, v201
    v_lshlrev_b32 v116, 16, v202
    v_and_b32 v117, 0xffff0000, v202
    v_lshlrev_b32 v118, 16, v203
    v_and_b32 v119, 0xffff0000, v203
    v_mov_b32 v244, 0
    v_mov_b32 v245, 0
    s_waitcnt vmcnt(0)
    buffer_store_dword v10, v8, s[24:27], s92 offen sc1
    v_cmp_ne_u32 s[54:55], s95, v11
    s_cmp_lg_u64 s[54:55], 0
    s_cbranch_scc1 Ltail_spin1
Ltail_got1:
    s_add_u32 s39, s39, 4
    s_add_u32 s45, s44, 0
    buffer_load_dwordx4 a[0:3], v2, s[28:31], s45 offen offset:0 sc1
    buffer_load_dwordx4 a[4:7], v2, s[28:31], s45 offen offset:2048 sc1
    s_add_u32 s45, s44, 4096
    buffer_load_dwordx4 a[8:11], v2, s[28:31], s45 offen offset:0 sc1
    buffer_load_dwordx4 a[12:15], v2, s[28:31], s45 offen offset:2048 sc1
    s_add_u32 s45, s44, 8192
    buffer_load_dwordx4 a[16:19], v2, s[28:31], s45 offen offset:0 sc1
    buffer_load_dwordx4 a[20:23], v2, s[28:31], s45 offen offset:2048 sc1
    s_add_u32 s45, s44, 12288
    buffer_load_dwordx4 a[24:27], v2, s[28:31], s45 offen offset:0 sc1
    buffer_load_dwordx4 a[28:31], v2, s[28:31], s45 offen offset:2048 sc1
    ds_write_b128 v51, a[128:131] offset:0
    ds_write_b128 v51, a[132:135] offset:4096
    ds_write_b128 v51, a[136:139] offset:8192
    ds_write_b128 v51, a[140:143] offset:12288
    ds_write_b128 v51, a[144:147] offset:16384
    ds_write_b128 v51, a[148:151] offset:20480
    ds_write_b128 v51, a[152:155] offset:24576
    ds_write_b128 v51, a[156:159] offset:28672
    ds_write_b128 v51, a[240:243] offset:32768
    ds_write_b128 v255, a[244:247] offset:40960
    ds_write_b128 v255, a[248:251] offset:45056
    ds_write_b128 v255, a[252:255] offset:49152
    v_lshlrev_b32 v120, 16, v204
    v_and_b32 v121, 0xffff0000, v204
    v_lshlrev_b32 v122, 16, v205
    v_and_b32 v123, 0xffff0000, v205
    v_lshlrev_b32 v124, 16, v206
    v_and_b32 v125, 0xffff0000, v206
    v_lshlrev_b32 v126, 16, v207
    v_and_b32 v127, 0xffff0000, v207
    v_lshlrev_b32 v128, 16, v208
    v_and_b32 v129, 0xffff0000, v208
    v_lshlrev_b32 v130, 16, v209
    v_and_b32 v131, 0xffff0000, v209
    v_lshlrev_b32 v132, 16, v210
    v_and_b32 v133, 0xffff0000, v210
    v_lshlrev_b32 v134, 16, v211
    v_and_b32 v135, 0xffff0000, v211
    v_lshlrev_b32 v136, 16, v212
    v_and_b32 v137, 0xffff0000, v212
    v_lshlrev_b32 v138, 16, v213
    v_and_b32 v139, 0xffff0000, v213
    v_lshlrev_b32 v140, 16, v214
    v_and_b32 v141, 0xffff0000, v214
    v_lshlrev_b32 v142, 16, v215
    v_and_b32 v143, 0xffff0000, v215
    v_lshlrev_b32 v192, 16, v216
    v_and_b32 v193, 0xffff0000, v216
    v_lshlrev_b32 v194, 16, v217
    v_and_b32 v195, 0xffff0000, v217
    v_lshlrev_b32 v196, 16, v218
    v_and_b32 v197, 0xffff0000, v218
    v_lshlrev_b32 v198, 16, v219
    v_and_b32 v199, 0xffff0000, v219
    v_lshlrev_b32 v200, 16, v220
    v_and_b32 v201, 0xffff0000, v220
    v_lshlrev_b32 v202, 16, v221
    v_and_b32 v203, 0xffff0000, v221
    v_lshlrev_b32 v204, 16, v222
    v_and_b32 v205, 0xffff0000, v222
    v_lshlrev_b32 v206, 16, v223
    v_and_b32 v207, 0xffff0000, v223
    v_lshlrev_b32 v208, 16, v88
    v_and_b32 v209, 0xffff0000, v88
    v_lshlrev_b32 v210, 16, v89
    v_and_b32 v211, 0xffff0000, v89
    v_lshlrev_b32 v212, 16, v90
    v_and_b32 v213, 0xffff0000, v90
    v_lshlrev_b32 v214, 16, v91
    v_and_b32 v215, 0xffff0000, v91
    buffer_load_dword v11, v9, s[24:27], s39 offen sc1
    s_add_u32 s45, s44, 16384
    buffer_load_dwordx4 a[32:35], v54, s[28:31], s45 offen offset:0 sc1
    buffer_load_dwordx4 a[36:39], v54, s[28:31], s45 offen offset:1024 sc1
    buffer_load_dwordx4 a[40:43], v54, s[28:31], s45 offen offset:2048 sc1
    buffer_load_dwordx4 a[44:47], v54, s[28:31], s45 offen offset:3072 sc1
    s_waitcnt vmcnt(4)
    v_cmp_ne_u32 s[54:55], s95, v11
    s_cmp_lg_u64 s[54:55], 0
    s_cbranch_scc1 Ltail_spin2
Ltail_got2:
    s_add_u32 s39, s39, 4
    s_add_u32 s45, s44, 0
    buffer_load_dwordx4 a[64:67], v2, s[28:31], s45 offen offset:1024 sc1
    buffer_load_dwordx4 a[68:71], v2, s[28:31], s45 offen offset:3072 sc1
    s_add_u32 s45, s44, 4096
    buffer_load_dwordx4 a[72:75], v2, s[28:31], s45 offen offset:1024 sc1
    buffer_load_dwordx4 a[76:79], v2, s[28:31], s45 offen offset:3072 sc1
    s_add_u32 s45, s44, 8192
    buffer_load_dwordx4 a[80:83], v2, s[28:31], s45 offen offset:1024 sc1
    buffer_load_dwordx4 a[84:87], v2, s[28:31], s45 offen offset:3072 sc1
    s_add_u32 s45, s44, 12288
    buffer_load_dwordx4 a[88:91], v2, s[28:31], s45 offen offset:1024 sc1
    buffer_load_dwordx4 a[92:95], v2, s[28:31], s45 offen offset:3072 sc1
    v_mfma_f32_16x16x32_bf16 v[64:67], v[250:253], a[0:3], 0
    v_mfma_f32_16x16x32_bf16 v[68:71], v[248:251], a[0:3], 0
    v_mfma_f32_16x16x32_bf16 v[64:67], v[250:253], a[4:7], v[64:67]
    v_mfma_f32_16x16x32_bf16 v[68:71], v[248:251], a[4:7], v[68:71]
    v_mfma_f32_16x16x32_bf16 v[64:67], v[250:253], a[8:11], v[64:67]
    v_mfma_f32_16x16x32_bf16 v[68:71], v[248:251], a[8:11], v[68:71]
    v_mfma_f32_16x16x32_bf16 v[64:67], v[250:253], a[12:15], v[64:67]
    v_mfma_f32_16x16x32_bf16 v[68:71], v[248:251], a[12:15], v[68:71]
    v_mfma_f32_16x16x32_bf16 v[64:67], v[250:253], a[16:19], v[64:67]
    v_mfma_f32_16x16x32_bf16 v[68:71], v[248:251], a[16:19], v[68:71]
    v_mfma_f32_16x16x32_bf16 v[64:67], v[250:253], a[20:23], v[64:67]
    v_mfma_f32_16x16x32_bf16 v[68:71], v[248:251], a[20:23], v[68:71]
    v_mfma_f32_16x16x32_bf16 v[64:67], v[250:253], a[24:27], v[64:67]
    v_mfma_f32_16x16x32_bf16 v[68:71], v[248:251], a[24:27], v[68:71]
    v_mfma_f32_16x16x32_bf16 v[64:67], v[250:253], a[28:31], v[64:67]
    v_mfma_f32_16x16x32_bf16 v[68:71], v[248:251], a[28:31], v[68:71]
    s_waitcnt vmcnt(11)
    v_mfma_f32_16x16x32_bf16 v[80:83], v[242:245], a[32:35], 0
    v_mfma_f32_16x16x32_bf16 v[84:87], v[240:243], a[32:35], 0
    s_waitcnt vmcnt(10)
    v_mfma_f32_16x16x32_bf16 v[80:83], v[242:245], a[36:39], v[80:83]
    v_mfma_f32_16x16x32_bf16 v[84:87], v[240:243], a[36:39], v[84:87]
    s_waitcnt vmcnt(9)
    v_mfma_f32_16x16x32_bf16 v[80:83], v[242:245], a[40:43], v[80:83]
    v_mfma_f32_16x16x32_bf16 v[84:87], v[240:243], a[40:43], v[84:87]
    s_waitcnt vmcnt(8)
    v_mfma_f32_16x16x32_bf16 v[80:83], v[242:245], a[44:47], v[80:83]
    v_mfma_f32_16x16x32_bf16 v[84:87], v[240:243], a[44:47], v[84:87]
    s_waitcnt vmcnt(7)
    s_nop 5
    v_mov_b32_dpp v80, v80 row_ror:8 row_mask:0x4 bank_mask:0xf
    v_mov_b32_dpp v81, v81 row_ror:8 row_mask:0x4 bank_mask:0xf
    v_mov_b32_dpp v82, v82 row_ror:8 row_mask:0x4 bank_mask:0xf
    v_mov_b32_dpp v83, v83 row_ror:8 row_mask:0x4 bank_mask:0xf
    v_mov_b32_dpp v84, v84 row_ror:8 row_mask:0x4 bank_mask:0xf
    v_mov_b32_dpp v85, v85 row_ror:8 row_mask:0x4 bank_mask:0xf
    v_mov_b32_dpp v86, v86 row_ror:8 row_mask:0x4 bank_mask:0xf
    v_mov_b32_dpp v87, v87 row_ror:8 row_mask:0x4 bank_mask:0xf
    v_pk_fma_f32 v[12:13], v[96:97], v[64:65], v[12:13]
    v_pk_fma_f32 v[14:15], v[98:99], v[66:67], v[14:15]
    v_pk_fma_f32 v[16:17], v[100:101], v[68:69], v[16:17]
    v_pk_fma_f32 v[18:19], v[102:103], v[70:71], v[18:19]
    v_cvt_pk_bf16_f32 v36, v12, v13
    v_cvt_pk_bf16_f32 v37, v14, v15
    v_cvt_pk_bf16_f32 v38, v16, v17
    v_cvt_pk_bf16_f32 v39, v18, v19
    v_lshlrev_b32 v12, 16, v36
    v_and_b32 v13, 0xffff0000, v36
    v_lshlrev_b32 v14, 16, v37
    v_and_b32 v15, 0xffff0000, v37
    v_lshlrev_b32 v16, 16, v38
    v_and_b32 v17, 0xffff0000, v38
    v_lshlrev_b32 v18, 16, v39
    v_and_b32 v19, 0xffff0000, v39
    v_pk_add_f32 v[48:49], v[12:13], v[14:15]
    v_pk_add_f32 v[50:51], v[16:17], v[18:19]
    v_pk_fma_f32 v[28:29], v[112:113], v[80:81], v[28:29]
    v_pk_fma_f32 v[30:31], v[114:115], v[82:83], v[30:31]
    v_pk_fma_f32 v[32:33], v[116:117], v[84:85], v[32:33]
    v_pk_fma_f32 v[34:35], v[118:119], v[86:87], v[34:35]
    v_cvt_pk_bf16_f32 v44, v28, v29
    v_cvt_pk_bf16_f32 v45, v30, v31
    v_cvt_pk_bf16_f32 v46, v32, v33
    v_cvt_pk_bf16_f32 v47, v34, v35
    v_lshlrev_b32 v28, 16, v44
    v_and_b32 v29, 0xffff0000, v44
    v_lshlrev_b32 v30, 16, v45
    v_and_b32 v31, 0xffff0000, v45
    v_lshlrev_b32 v32, 16, v46
    v_and_b32 v33, 0xffff0000, v46
    v_lshlrev_b32 v34, 16, v47
    v_and_b32 v35, 0xffff0000, v47
    v_pk_add_f32 v[48:49], v[48:49], v[28:29]
    v_pk_add_f32 v[50:51], v[50:51], v[30:31]
    v_pk_add_f32 v[48:49], v[48:49], v[32:33]
    v_pk_add_f32 v[50:51], v[50:51], v[34:35]
    v_mfma_f32_16x16x32_bf16 v[72:75], v[250:253], a[64:67], 0
    v_mfma_f32_16x16x32_bf16 v[76:79], v[248:251], a[64:67], 0
    s_waitcnt vmcnt(6)
    v_mfma_f32_16x16x32_bf16 v[72:75], v[250:253], a[68:71], v[72:75]
    v_mfma_f32_16x16x32_bf16 v[76:79], v[248:251], a[68:71], v[76:79]
    s_waitcnt vmcnt(5)
    v_mfma_f32_16x16x32_bf16 v[72:75], v[250:253], a[72:75], v[72:75]
    v_mfma_f32_16x16x32_bf16 v[76:79], v[248:251], a[72:75], v[76:79]
    s_waitcnt vmcnt(4)
    v_mfma_f32_16x16x32_bf16 v[72:75], v[250:253], a[76:79], v[72:75]
    v_mfma_f32_16x16x32_bf16 v[76:79], v[248:251], a[76:79], v[76:79]
    s_waitcnt vmcnt(3)
    v_mfma_f32_16x16x32_bf16 v[72:75], v[250:253], a[80:83], v[72:75]
    v_mfma_f32_16x16x32_bf16 v[76:79], v[248:251], a[80:83], v[76:79]
    s_waitcnt vmcnt(2)
    v_mfma_f32_16x16x32_bf16 v[72:75], v[250:253], a[84:87], v[72:75]
    v_mfma_f32_16x16x32_bf16 v[76:79], v[248:251], a[84:87], v[76:79]
    s_waitcnt vmcnt(1)
    v_mfma_f32_16x16x32_bf16 v[72:75], v[250:253], a[88:91], v[72:75]
    v_mfma_f32_16x16x32_bf16 v[76:79], v[248:251], a[88:91], v[76:79]
    s_waitcnt vmcnt(0)
    v_mfma_f32_16x16x32_bf16 v[72:75], v[250:253], a[92:95], v[72:75]
    v_mfma_f32_16x16x32_bf16 v[76:79], v[248:251], a[92:95], v[76:79]
    s_nop 6
    v_pk_fma_f32 v[20:21], v[104:105], v[72:73], v[20:21]
    v_pk_fma_f32 v[22:23], v[106:107], v[74:75], v[22:23]
    v_pk_fma_f32 v[24:25], v[108:109], v[76:77], v[24:25]
    v_pk_fma_f32 v[26:27], v[110:111], v[78:79], v[26:27]
    v_cvt_pk_bf16_f32 v40, v20, v21
    v_cvt_pk_bf16_f32 v41, v22, v23
    v_cvt_pk_bf16_f32 v42, v24, v25
    v_cvt_pk_bf16_f32 v43, v26, v27
    v_lshlrev_b32 v20, 16, v40
    v_and_b32 v21, 0xffff0000, v40
    v_lshlrev_b32 v22, 16, v41
    v_and_b32 v23, 0xffff0000, v41
    v_lshlrev_b32 v24, 16, v42
    v_and_b32 v25, 0xffff0000, v42
    v_lshlrev_b32 v26, 16, v43
    v_and_b32 v27, 0xffff0000, v43
    v_pk_add_f32 v[48:49], v[48:49], v[20:21]
    v_pk_add_f32 v[50:51], v[50:51], v[22:23]
    v_pk_add_f32 v[48:49], v[48:49], v[24:25]
    v_pk_add_f32 v[50:51], v[50:51], v[26:27]
    v_pk_add_f32 v[48:49], v[48:49], v[50:51]
    v_add_f32 v48, v48, v49
    s_nop 1
    v_add_f32_dpp v48, v48, v48 row_ror:1 row_mask:0xf bank_mask:0xf
    s_nop 1
    v_add_f32_dpp v48, v48, v48 row_ror:2 row_mask:0xf bank_mask:0xf
    s_nop 1
    v_add_f32_dpp v48, v48, v48 row_ror:4 row_mask:0xf bank_mask:0xf
    s_nop 1
    v_add_f32_dpp v48, v48, v48 row_ror:8 row_mask:0xf bank_mask:0xf
    v_mov_b32 v52, v48
    s_nop 1
    v_permlane16_swap_b32 v48, v52
    s_nop 0
    v_add_f32 v48, v48, v52
    v_mul_f32 v48, 0x3ae38e39, v48
    v_pk_add_f32 v[216:217], v[12:13], v[48:49] op_sel_hi:[1,0] neg_lo:[0,1] neg_hi:[0,1]
    v_pk_add_f32 v[218:219], v[14:15], v[48:49] op_sel_hi:[1,0] neg_lo:[0,1] neg_hi:[0,1]
    v_pk_add_f32 v[220:221], v[16:17], v[48:49] op_sel_hi:[1,0] neg_lo:[0,1] neg_hi:[0,1]
    v_pk_add_f32 v[222:223], v[18:19], v[48:49] op_sel_hi:[1,0] neg_lo:[0,1] neg_hi:[0,1]
    v_pk_add_f32 v[224:225], v[20:21], v[48:49] op_sel_hi:[1,0] neg_lo:[0,1] neg_hi:[0,1]
    v_pk_add_f32 v[226:227], v[22:23], v[48:49] op_sel_hi:[1,0] neg_lo:[0,1] neg_hi:[0,1]
    v_pk_add_f32 v[228:229], v[24:25], v[48:49] op_sel_hi:[1,0] neg_lo:[0,1] neg_hi:[0,1]
    v_pk_add_f32 v[230:231], v[26:27], v[48:49] op_sel_hi:[1,0] neg_lo:[0,1] neg_hi:[0,1]
    v_pk_add_f32 v[232:233], v[28:29], v[48:49] op_sel_hi:[1,0] neg_lo:[0,1] neg_hi:[0,1]
    v_pk_add_f32 v[234:235], v[30:31], v[48:49] op_sel_hi:[1,0] neg_lo:[0,1] neg_hi:[0,1]
    v_pk_add_f32 v[236:237], v[32:33], v[48:49] op_sel_hi:[1,0] neg_lo:[0,1] neg_hi:[0,1]
    v_pk_add_f32 v[238:239], v[34:35], v[48:49] op_sel_hi:[1,0] neg_lo:[0,1] neg_hi:[0,1]
    v_pk_mul_f32 v[50:51], v[216:217], v[216:217]
    v_pk_mul_f32 v[52:53], v[224:225], v[224:225]
    v_pk_mul_f32 v[62:63], v[232:233], v[232:233]
    v_pk_fma_f32 v[50:51], v[218:219], v[218:219], v[50:51]
    v_pk_fma_f32 v[52:53], v[226:227], v[226:227], v[52:53]
    v_pk_fma_f32 v[62:63], v[234:235], v[234:235], v[62:63]
    v_pk_fma_f32 v[50:51], v[220:221], v[220:221], v[50:51]
    v_pk_fma_f32 v[52:53], v[228:229], v[228:229], v[52:53]
    v_pk_fma_f32 v[62:63], v[236:237], v[236:237], v[62:63]
    v_pk_fma_f32 v[50:51], v[222:223], v[222:223], v[50:51]
    v_pk_fma_f32 v[52:53], v[230:231], v[230:231], v[52:53]
    v_pk_fma_f32 v[62:63], v[238:239], v[238:239], v[62:63]
    v_pk_add_f32 v[50:51], v[50:51], v[52:53]
    v_add_f32 v62, v62, v63
    v_add_f32 v50, v50, v51
    v_cndmask_b32 v62, 0, v62, vcc
    v_add_f32 v50, v50, v62
    s_nop 1
    v_add_f32_dpp v50, v50, v50 row_ror:1 row_mask:0xf bank_mask:0xf
    s_nop 1
    v_add_f32_dpp v50, v50, v50 row_ror:2 row_mask:0xf bank_mask:0xf
    s_nop 1
    v_add_f32_dpp v50, v50, v50 row_ror:4 row_mask:0xf bank_mask:0xf
    s_nop 1
    v_add_f32_dpp v50, v50, v50 row_ror:8 row_mask:0xf bank_mask:0xf
    v_mov_b32 v52, v50
    s_nop 1
    v_permlane16_swap_b32 v50, v52
    s_nop 0
    v_add_f32 v50, v50, v52
    v_mul_f32 v50, 0x3ae38e39, v50
    v_cvt_pk_bf16_f32 v52, v48, v50
    v_and_b32 v50, 0xffff0000, v52
    v_lshlrev_b32 v52, 16, v52
    v_add_f32 v50, 0x3727c5ac, v50
    v_sub_f32 v48, v48, v52
    v_cvt_pk_bf16_f32 v50, v50, v50
    v_and_b32 v50, 0xffff0000, v50
    v_sqrt_f32 v50, v50
    s_nop 0
    v_cvt_pk_bf16_f32 v50, v50, v50
    v_and_b32 v50, 0xffff0000, v50
    v_rcp_f32 v50, v50
    s_mov_b32 s45, 2621440
    v_mul_f32 v48, v48, v50
    v_pk_fma_f32 v[216:217], v[216:217], v[50:51], v[48:49] op_sel_hi:[1,0,0]
    v_pk_fma_f32 v[218:219], v[218:219], v[50:51], v[48:49] op_sel_hi:[1,0,0]
    v_pk_fma_f32 v[220:221], v[220:221], v[50:51], v[48:49] op_sel_hi:[1,0,0]
    v_pk_fma_f32 v[222:223], v[222:223], v[50:51], v[48:49] op_sel_hi:[1,0,0]
    v_pk_fma_f32 v[224:225], v[224:225], v[50:51], v[48:49] op_sel_hi:[1,0,0]
    v_pk_fma_f32 v[226:227], v[226:227], v[50:51], v[48:49] op_sel_hi:[1,0,0]
    v_pk_fma_f32 v[228:229], v[228:229], v[50:51], v[48:49] op_sel_hi:[1,0,0]
    v_pk_fma_f32 v[230:231], v[230:231], v[50:51], v[48:49] op_sel_hi:[1,0,0]
    v_pk_fma_f32 v[232:233], v[232:233], v[50:51], v[48:49] op_sel_hi:[1,0,0]
    v_pk_fma_f32 v[234:235], v[234:235], v[50:51], v[48:49] op_sel_hi:[1,0,0]
    v_pk_fma_f32 v[236:237], v[236:237], v[50:51], v[48:49] op_sel_hi:[1,0,0]
    v_pk_fma_f32 v[238:239], v[238:239], v[50:51], v[48:49] op_sel_hi:[1,0,0]
    v_pk_fma_f32 v[216:217], v[216:217], v[120:121], v[144:145]
    v_pk_fma_f32 v[218:219], v[218:219], v[122:123], v[146:147]
    v_pk_fma_f32 v[220:221], v[220:221], v[124:125], v[148:149]
    v_pk_fma_f32 v[222:223], v[222:223], v[126:127], v[150:151]
    v_pk_fma_f32 v[224:225], v[224:225], v[128:129], v[152:153]
    v_pk_fma_f32 v[226:227], v[226:227], v[130:131], v[154:155]
    v_pk_fma_f32 v[228:229], v[228:229], v[132:133], v[156:157]
    v_pk_fma_f32 v[230:231], v[230:231], v[134:135], v[158:159]
    v_pk_fma_f32 v[232:233], v[232:233], v[136:137], v[160:161]
    v_pk_fma_f32 v[234:235], v[234:235], v[138:139], v[162:163]
    v_pk_fma_f32 v[236:237], v[236:237], v[140:141], v[164:165]
    v_pk_fma_f32 v[238:239], v[238:239], v[142:143], v[166:167]
    v_cvt_pk_bf16_f32 v64, v216, v217
    v_cvt_pk_bf16_f32 v65, v218, v219
    v_cvt_pk_bf16_f32 v66, v220, v221
    v_cvt_pk_bf16_f32 v67, v222, v223
    v_cvt_pk_bf16_f32 v68, v224, v225
    v_cvt_pk_bf16_f32 v69, v226, v227
    v_cvt_pk_bf16_f32 v70, v228, v229
    v_cvt_pk_bf16_f32 v71, v230, v231
    v_cvt_pk_bf16_f32 v72, v232, v233
    v_cvt_pk_bf16_f32 v73, v234, v235
    v_cvt_pk_bf16_f32 v74, v236, v237
    v_cvt_pk_bf16_f32 v75, v238, v239
    v_lshlrev_b32 v216, 16, v64
    v_and_b32 v217, 0xffff0000, v64
    v_lshlrev_b32 v218, 16, v65
    v_and_b32 v219, 0xffff0000, v65
    v_lshlrev_b32 v220, 16, v66
    v_and_b32 v221, 0xffff0000, v66
    v_lshlrev_b32 v222, 16, v67
    v_and_b32 v223, 0xffff0000, v67
    v_lshlrev_b32 v224, 16, v68
    v_and_b32 v225, 0xffff0000, v68
    v_lshlrev_b32 v226, 16, v69
    v_and_b32 v227, 0xffff0000, v69
    v_lshlrev_b32 v228, 16, v70
    v_and_b32 v229, 0xffff0000, v70
    v_lshlrev_b32 v230, 16, v71
    v_and_b32 v231, 0xffff0000, v71
    v_lshlrev_b32 v232, 16, v72
    v_and_b32 v233, 0xffff0000, v72
    v_lshlrev_b32 v234, 16, v73
    v_and_b32 v235, 0xffff0000, v73
    v_lshlrev_b32 v236, 16, v74
    v_and_b32 v237, 0xffff0000, v74
    v_lshlrev_b32 v238, 16, v75
    v_and_b32 v239, 0xffff0000, v75
    v_pk_mul_f32 v[50:51], v[216:217], v[168:169]
    v_pk_mul_f32 v[52:53], v[224:225], v[176:177]
    v_pk_mul_f32 v[62:63], v[232:233], v[184:185]
    v_pk_fma_f32 v[50:51], v[218:219], v[170:171], v[50:51]
    v_pk_fma_f32 v[52:53], v[226:227], v[178:179], v[52:53]
    v_pk_fma_f32 v[62:63], v[234:235], v[186:187], v[62:63]
    v_pk_fma_f32 v[50:51], v[220:221], v[172:173], v[50:51]
    v_pk_fma_f32 v[52:53], v[228:229], v[180:181], v[52:53]
    v_pk_fma_f32 v[62:63], v[236:237], v[188:189], v[62:63]
    v_pk_fma_f32 v[50:51], v[222:223], v[174:175], v[50:51]
    v_pk_fma_f32 v[52:53], v[230:231], v[182:183], v[52:53]
    v_pk_fma_f32 v[62:63], v[238:239], v[190:191], v[62:63]
    v_pk_add_f32 v[50:51], v[50:51], v[52:53]
    v_add_f32 v62, v62, v63
    v_add_f32 v50, v50, v51
    v_add_f32 v50, v50, v62
    v_lshlrev_b32 v48, 2, v7
    v_and_b32 v48, 28, v48
    v_sub_u32 v49, 2047, v7
    v_add_f32_dpp v50, v50, v50 row_ror:1 row_mask:0xf bank_mask:0xf
    s_nop 1
    v_add_f32_dpp v50, v50, v50 row_ror:2 row_mask:0xf bank_mask:0xf
    s_nop 1
    v_add_f32_dpp v50, v50, v50 row_ror:4 row_mask:0xf bank_mask:0xf
    s_nop 1
    v_add_f32_dpp v50, v50, v50 row_ror:8 row_mask:0xf bank_mask:0xf
    v_mov_b32 v52, v50
    s_nop 1
    v_permlane16_swap_b32 v50, v52
    s_nop 0
    v_add_f32 v50, v50, v52
    v_ashrrev_i32 v52, 31, v50
    v_or_b32 v52, 0x80000000, v52
    v_xor_b32 v52, v52, v50
    v_and_b32 v52, 0xfffff800, v52
    v_min_u32 v52, 0xfffff000, v52
    v_or_b32 v52, v52, v49
    s_mov_b32 exec_lo, 1
    s_mov_b32 exec_hi, 1
    ds_write_b32 v48, v52 offset:36864
    s_mov_b64 exec, -1
    s_waitcnt lgkmcnt(0)
    s_barrier
    v_mov_b32 v141, 36864
    ds_read_b128 v[128:131], v141
    ds_read_b128 v[132:135], v141 offset:16
    s_lshl_b32 s45, s2, 7
    s_add_u32 s45, s45, 8912896
    s_cmp_eq_u32 s3, 0
    s_cselect_b32 s45, s45, 2147483648
    s_waitcnt lgkmcnt(1)
    v_max_u32 v136, v128, v129
    v_min_u32 v137, v128, v129
    v_med3_u32 v137, v136, v137, v130
    v_max_u32 v136, v136, v130
    v_med3_u32 v137, v136, v137, v131
    v_max_u32 v136, v136, v131
    s_waitcnt lgkmcnt(0)
    v_med3_u32 v137, v136, v137, v132
    v_max_u32 v136, v136, v132
    v_med3_u32 v137, v136, v137, v133
    v_max_u32 v136, v136, v133
    v_med3_u32 v137, v136, v137, v134
    v_max_u32 v136, v136, v134
    v_med3_u32 v137, v136, v137, v135
    v_max_u32 v136, v136, v135
    buffer_store_dwordx2 v[136:137], v8, s[24:27], s45 offen sc1
    v_and_b32 v138, 0x7ff, v136
    v_and_b32 v139, 0x7ff, v137
    v_cmp_eq_u32 vcc, v138, v49
    v_cmp_eq_u32 s[36:37], v139, v49
    v_mov_b32 v138, 2147483648
    s_or_b64 vcc, vcc, s[36:37]
    s_mov_b32 s45, 2621440
    s_nop 0
    v_cndmask_b32 v6, v138, v6, vcc
    v_cndmask_b32 v60, v138, v60, vcc
    buffer_store_dwordx4 v[64:67], v6, s[24:27], s45 offen offset:0 sc1
Ltour12:
    s_cbranch_execz Ltour16
    buffer_store_dwordx4 v[68:71], v6, s[24:27], s45 offen offset:512 sc1
    buffer_store_dwordx4 v[72:75], v60, s[24:27], s45 offen offset:1024 sc1
    v_pk_mul_f32 v[192:193], v[192:193], v[216:217]
    v_pk_mul_f32 v[194:195], v[194:195], v[218:219]
    v_pk_mul_f32 v[196:197], v[196:197], v[220:221]
    v_pk_mul_f32 v[198:199], v[198:199], v[222:223]
    v_pk_mul_f32 v[200:201], v[200:201], v[224:225]
    v_pk_mul_f32 v[202:203], v[202:203], v[226:227]
    v_pk_mul_f32 v[204:205], v[204:205], v[228:229]
    v_pk_mul_f32 v[206:207], v[206:207], v[230:231]
    v_pk_mul_f32 v[208:209], v[208:209], v[232:233]
    v_pk_mul_f32 v[210:211], v[210:211], v[234:235]
    v_pk_mul_f32 v[212:213], v[212:213], v[236:237]
    v_pk_mul_f32 v[214:215], v[214:215], v[238:239]
    v_cvt_pk_bf16_f32 v144, v192, v193
    v_cvt_pk_bf16_f32 v145, v194, v195
    v_cvt_pk_bf16_f32 v146, v196, v197
    v_cvt_pk_bf16_f32 v147, v198, v199
    v_cvt_pk_bf16_f32 v148, v200, v201
    v_cvt_pk_bf16_f32 v149, v202, v203
    v_cvt_pk_bf16_f32 v150, v204, v205
    v_cvt_pk_bf16_f32 v151, v206, v207
    v_cvt_pk_bf16_f32 v152, v208, v209
    v_cvt_pk_bf16_f32 v153, v210, v211
    v_cvt_pk_bf16_f32 v154, v212, v213
    v_cvt_pk_bf16_f32 v155, v214, v215
    v_lshlrev_b32 v192, 16, v144
    v_and_b32 v193, 0xffff0000, v144
    v_lshlrev_b32 v194, 16, v145
    v_and_b32 v195, 0xffff0000, v145
    v_lshlrev_b32 v196, 16, v146
    v_and_b32 v197, 0xffff0000, v146
    v_lshlrev_b32 v198, 16, v147
    v_and_b32 v199, 0xffff0000, v147
    v_lshlrev_b32 v200, 16, v148
    v_and_b32 v201, 0xffff0000, v148
    v_lshlrev_b32 v202, 16, v149
    v_and_b32 v203, 0xffff0000, v149
    v_lshlrev_b32 v204, 16, v150
    v_and_b32 v205, 0xffff0000, v150
    v_lshlrev_b32 v206, 16, v151
    v_and_b32 v207, 0xffff0000, v151
    v_lshlrev_b32 v208, 16, v152
    v_and_b32 v209, 0xffff0000, v152
    v_lshlrev_b32 v210, 16, v153
    v_and_b32 v211, 0xffff0000, v153
    v_lshlrev_b32 v212, 16, v154
    v_and_b32 v213, 0xffff0000, v154
    v_lshlrev_b32 v214, 16, v155
    v_and_b32 v215, 0xffff0000, v155
    v_pk_add_f32 v[192:193], v[192:193], v[12:13]
    v_pk_add_f32 v[194:195], v[194:195], v[14:15]
    v_pk_add_f32 v[196:197], v[196:197], v[16:17]
    v_pk_add_f32 v[198:199], v[198:199], v[18:19]
    v_pk_add_f32 v[200:201], v[200:201], v[20:21]
    v_pk_add_f32 v[202:203], v[202:203], v[22:23]
    v_pk_add_f32 v[204:205], v[204:205], v[24:25]
    v_pk_add_f32 v[206:207], v[206:207], v[26:27]
    v_pk_add_f32 v[208:209], v[208:209], v[28:29]
    v_pk_add_f32 v[210:211], v[210:211], v[30:31]
    v_pk_add_f32 v[212:213], v[212:213], v[32:33]
    v_pk_add_f32 v[214:215], v[214:215], v[34:35]
    v_cvt_pk_bf16_f32 v156, v192, v193
    v_cvt_pk_bf16_f32 v157, v194, v195
    v_cvt_pk_bf16_f32 v158, v196, v197
    v_cvt_pk_bf16_f32 v159, v198, v199
    v_cvt_pk_bf16_f32 v160, v200, v201
    v_cvt_pk_bf16_f32 v161, v202, v203
    v_cvt_pk_bf16_f32 v162, v204, v205
    v_cvt_pk_bf16_f32 v163, v206, v207
    v_cvt_pk_bf16_f32 v164, v208, v209
    v_cvt_pk_bf16_f32 v165, v210, v211
    v_cvt_pk_bf16_f32 v166, v212, v213
    v_cvt_pk_bf16_f32 v167, v214, v215
    v_and_b32 v30, 2, v1
    v_cmp_ne_u32 vcc, 0, v30
    v_mul_u32_u24 v30, 1152, v7
    v_add_u32 v4, v30, v5
    v_add_u32 v58, v30, v59
    v_mov_b32_dpp v192, v158 quad_perm:[0,2,0,2] row_mask:0xf bank_mask:0xf
    v_mov_b32_dpp v193, v159 quad_perm:[0,2,0,2] row_mask:0xf bank_mask:0xf
    v_mov_b32_dpp v194, v158 quad_perm:[1,3,1,3] row_mask:0xf bank_mask:0xf
    v_mov_b32_dpp v195, v159 quad_perm:[1,3,1,3] row_mask:0xf bank_mask:0xf
    v_mov_b32_dpp v196, v162 quad_perm:[0,2,0,2] row_mask:0xf bank_mask:0xf
    v_mov_b32_dpp v197, v163 quad_perm:[0,2,0,2] row_mask:0xf bank_mask:0xf
    v_mov_b32_dpp v198, v162 quad_perm:[1,3,1,3] row_mask:0xf bank_mask:0xf
    v_mov_b32_dpp v199, v163 quad_perm:[1,3,1,3] row_mask:0xf bank_mask:0xf
    v_mov_b32_dpp v200, v166 quad_perm:[0,2,0,2] row_mask:0xf bank_mask:0xf
    v_mov_b32_dpp v201, v167 quad_perm:[0,2,0,2] row_mask:0xf bank_mask:0xf
    v_mov_b32_dpp v202, v166 quad_perm:[1,3,1,3] row_mask:0xf bank_mask:0xf
    v_mov_b32_dpp v203, v167 quad_perm:[1,3,1,3] row_mask:0xf bank_mask:0xf
    v_cndmask_b32_dpp v144, v156, v192, vcc quad_perm:[0,2,0,2] row_mask:0xf bank_mask:0xf
    v_cndmask_b32_dpp v145, v157, v193, vcc quad_perm:[0,2,0,2] row_mask:0xf bank_mask:0xf
    v_cndmask_b32_dpp v146, v156, v194, vcc quad_perm:[1,3,1,3] row_mask:0xf bank_mask:0xf
    v_cndmask_b32_dpp v147, v157, v195, vcc quad_perm:[1,3,1,3] row_mask:0xf bank_mask:0xf
    v_cndmask_b32_dpp v148, v160, v196, vcc quad_perm:[0,2,0,2] row_mask:0xf bank_mask:0xf
    v_cndmask_b32_dpp v149, v161, v197, vcc quad_perm:[0,2,0,2] row_mask:0xf bank_mask:0xf
    v_cndmask_b32_dpp v150, v160, v198, vcc quad_perm:[1,3,1,3] row_mask:0xf bank_mask:0xf
    v_cndmask_b32_dpp v151, v161, v199, vcc quad_perm:[1,3,1,3] row_mask:0xf bank_mask:0xf
    v_cndmask_b32_dpp v152, v164, v200, vcc quad_perm:[0,2,0,2] row_mask:0xf bank_mask:0xf
    v_cndmask_b32_dpp v153, v165, v201, vcc quad_perm:[0,2,0,2] row_mask:0xf bank_mask:0xf
    v_cndmask_b32_dpp v154, v164, v202, vcc quad_perm:[1,3,1,3] row_mask:0xf bank_mask:0xf
    v_cndmask_b32_dpp v155, v165, v203, vcc quad_perm:[1,3,1,3] row_mask:0xf bank_mask:0xf
    buffer_store_dwordx4 v[144:147], v4, s[16:19], 0 offen offset:0 sc1
    buffer_store_dwordx4 v[148:151], v4, s[16:19], 0 offen offset:512 sc1
    buffer_store_dwordx4 v[152:155], v58, s[16:19], 0 offen offset:1024 sc1
    s_cmp_ge_u32 s41, 18
    s_cbranch_scc1 Ltail_idle
    s_add_u32 s57, s59, 4096
    s_add_u32 m0, s6, -110592
    s_nop 0
    buffer_load_dwordx4 v255, s[84:87], s57 offen lds
    s_add_u32 s57, s59, 8192
    s_add_u32 m0, s6, -106496
    s_nop 0
    buffer_load_dwordx4 v255, s[84:87], s57 offen lds
    s_add_u32 s57, s59, 12288
    s_add_u32 m0, s6, -102400
    s_nop 0
    buffer_load_dwordx4 v255, s[84:87], s57 offen lds
    s_add_u32 s57, s59, 16384
    s_add_u32 m0, s6, -98304
    s_nop 0
    buffer_load_dwordx4 v255, s[84:87], s57 offen lds
    s_add_u32 s57, s59, 20480
    s_add_u32 m0, s6, -94208
    s_nop 0
    buffer_load_dwordx4 v255, s[84:87], s57 offen lds
    s_add_u32 s57, s59, 24576
    s_add_u32 m0, s6, -90112
    s_nop 0
    buffer_load_dwordx4 v255, s[84:87], s57 offen lds
    s_add_u32 s57, s59, 28672
    s_add_u32 m0, s6, -86016
    s_nop 0
    buffer_load_dwordx4 v255, s[84:87], s57 offen lds
    s_add_u32 s57, s59, 32768
    s_add_u32 m0, s6, -81920
    s_nop 0
    buffer_load_dwordx4 v255, s[84:87], s57 offen lds
    s_mov_b32 s38, 135168
    s_mov_b32 s39, 12288
    v_lshrrev_b32 v9, 2, v1
    v_and_b32 v10, 3, v1
    v_lshlrev_b32 v10, 3, v10
    s_and_b32 s45, s3, 1
    s_lshl_b32 s45, s45, 5
    v_lshl_add_u32 v11, v9, 6, v10
    v_add_u32 v11, s45, v11
    s_cmp_lt_u32 s3, 2
    s_cselect_b32 s44, 98304, s38
    s_cselect_b32 s45, 98304, s39
    v_add_u32 v12, s45, v11
    v_add_u32 v11, s44, v11
    ds_read_b64_tr_b16 a[0:1], v11 offset:0
    ds_read_b64_tr_b16 a[2:3], v11 offset:1024
    ds_read_b64_tr_b16 a[4:5], v11 offset:2048
    ds_read_b64_tr_b16 a[6:7], v11 offset:3072
    ds_read_b64_tr_b16 a[8:9], v11 offset:4096
    ds_read_b64_tr_b16 a[10:11], v11 offset:5120
    ds_read_b64_tr_b16 a[12:13], v11 offset:6144
    ds_read_b64_tr_b16 a[14:15], v11 offset:7168
    ds_read_b64_tr_b16 a[16:17], v11 offset:8192
    ds_read_b64_tr_b16 a[18:19], v11 offset:9216
    ds_read_b64_tr_b16 a[20:21], v11 offset:10240
    ds_read_b64_tr_b16 a[22:23], v11 offset:11264
    ds_read_b64_tr_b16 a[24:25], v11 offset:12288
    ds_read_b64_tr_b16 a[26:27], v11 offset:13312
    ds_read_b64_tr_b16 a[28:29], v11 offset:14336
    ds_read_b64_tr_b16 a[30:31], v11 offset:15360
    ds_read_b64_tr_b16 a[32:33], v11 offset:16384
    ds_read_b64_tr_b16 a[34:35], v11 offset:17408
    ds_read_b64_tr_b16 a[36:37], v11 offset:18432
    ds_read_b64_tr_b16 a[38:39], v11 offset:19456
    ds_read_b64_tr_b16 a[40:41], v11 offset:20480
    ds_read_b64_tr_b16 a[42:43], v11 offset:21504
    ds_read_b64_tr_b16 a[44:45], v11 offset:22528
    ds_read_b64_tr_b16 a[46:47], v11 offset:23552
    ds_read_b64_tr_b16 a[48:49], v11 offset:24576
    ds_read_b64_tr_b16 a[50:51], v11 offset:25600
    ds_read_b64_tr_b16 a[52:53], v11 offset:26624
    ds_read_b64_tr_b16 a[54:55], v11 offset:27648
    ds_read_b64_tr_b16 a[56:57], v12 offset:28672
    ds_read_b64_tr_b16 a[58:59], v12 offset:29696
    ds_read_b64_tr_b16 a[60:61], v12 offset:30720
    ds_read_b64_tr_b16 a[62:63], v12 offset:31744
    ds_read_b64_tr_b16 a[64:65], v12 offset:32768
    ds_read_b64_tr_b16 a[66:67], v12 offset:33792
    ds_read_b64_tr_b16 a[68:69], v12 offset:34816
    ds_read_b64_tr_b16 a[70:71], v12 offset:35840
    v_mul_u32_u24 v12, 1152, v9
    s_lshl_b32 s44, s3, 7
    s_add_u32 s44, s44, 49152
    v_add3_u32 v12, v12, v10, s44
    v_lshlrev_b32 v13, 4, v1
    v_add_u32 v13, 32768, v13
    s_lshl_b32 s44, s3, 10
    v_add_u32 v14, s44, v13
    v_and_b32 v13, 0xffffff1f, v13
    v_bfe_u32 v15, v1, 2, 2
    v_cmp_eq_u32 s[52:53], 0, v15
    v_cmp_eq_u32 s[54:55], 1, v15
    v_cmp_eq_u32 s[56:57], 2, v15
    v_cmp_eq_u32 s[58:59], 3, v15
    s_mul_i32 s43, s42, 18
    s_add_u32 s43, s43, s41
    s_lshl_b32 s43, s43, 9
    s_mul_i32 s44, s3, 73728
    s_add_u32 s43, s43, s44
    v_lshlrev_b32 v15, 3, v1
    v_lshlrev_b32 v140, 7, v0
    s_mov_b32 s45, 8912896
    s_lshl_b32 s36, s3, 3
    v_mov_b32 v141, s36
    s_mov_b32 s48, 16384
Ltail_pollk:
    buffer_load_dwordx2 v[136:137], v140, s[24:27], s45 offen sc1
    s_sub_u32 s48, s48, 1
    s_cbranch_scc1 Ltail_gotk
    s_waitcnt vmcnt(0)
    v_max_u32 v138, v136, v137
    v_cmp_eq_u32 vcc, -1, v138
    s_cbranch_vccnz Ltail_pollk
Ltail_gotk:
    s_waitcnt vmcnt(0)
    s_mov_b32 s36, 2622592
    buffer_store_dwordx4 v[36:39], v6, s[24:27], s36 offen offset:0 sc1
    buffer_store_dwordx4 v[40:43], v6, s[24:27], s36 offen offset:512 sc1
    buffer_store_dwordx4 v[44:47], v60, s[24:27], s36 offen offset:1024 sc1
    v_mov_b32_dpp v138, v136 row_ror:1 row_mask:0xf bank_mask:0xf
    v_mov_b32_dpp v139, v137 row_ror:1 row_mask:0xf bank_mask:0xf
    v_min_u32 v142, v136, v138
    v_max_u32 v136, v136, v138
    v_max3_u32 v137, v142, v137, v139
    s_nop 0
    v_mov_b32_dpp v138, v136 row_ror:2 row_mask:0xf bank_mask:0xf
    v_mov_b32_dpp v139, v137 row_ror:2 row_mask:0xf bank_mask:0xf
    v_min_u32 v142, v136, v138
    v_max_u32 v136, v136, v138
    v_max3_u32 v137, v142, v137, v139
    s_nop 0
    v_mov_b32_dpp v138, v136 row_ror:4 row_mask:0xf bank_mask:0xf
    v_mov_b32_dpp v139, v137 row_ror:4 row_mask:0xf bank_mask:0xf
    v_min_u32 v142, v136, v138
    v_max_u32 v136, v136, v138
    v_max3_u32 v137, v142, v137, v139
    s_nop 0
    v_mov_b32_dpp v138, v136 row_ror:8 row_mask:0xf bank_mask:0xf
    v_mov_b32_dpp v139, v137 row_ror:8 row_mask:0xf bank_mask:0xf
    v_min_u32 v142, v136, v138
    v_max_u32 v136, v136, v138
    v_max3_u32 v137, v142, v137, v139
    v_mov_b32 v138, v136
    v_mov_b32 v139, v137
    s_nop 0
    v_permlane16_swap_b32 v136, v138
    v_permlane16_swap_b32 v137, v139
    v_min_u32 v142, v136, v138
    v_max_u32 v136, v136, v138
    v_max3_u32 v137, v142, v137, v139
    v_mov_b32 v138, v136
    v_mov_b32 v139, v137
    s_nop 0
    v_permlane32_swap_b32 v136, v138
    v_permlane32_swap_b32 v137, v139
    v_min_u32 v142, v136, v138
    v_max_u32 v136, v136, v138
    v_max3_u32 v137, v142, v137, v139
    ds_write_b64 v141, v[136:137] offset:36928
    v_mov_b32 v141, 36928
    s_waitcnt lgkmcnt(0)
    s_barrier
    ds_read_b128 v[128:131], v141
    ds_read_b128 v[132:135], v141 offset:16
    s_or_b32 s36, s2, s3
    s_cselect_b32 s45, -4, 24576
    s_add_u32 s36, s94, 1
    v_mov_b32 v138, s36
    buffer_store_dword v138, v8, s[24:27], s45 offen sc1
    s_waitcnt lgkmcnt(1)
    v_max_u32 v136, v128, v129
    v_min_u32 v137, v128, v129
    v_med3_u32 v137, v136, v137, v130
    v_max_u32 v136, v136, v130
    v_med3_u32 v137, v136, v137, v131
    v_max_u32 v136, v136, v131
    s_waitcnt lgkmcnt(0)
    v_med3_u32 v137, v136, v137, v132
    v_max_u32 v136, v136, v132
    v_med3_u32 v137, v136, v137, v133
    v_max_u32 v136, v136, v133
    v_med3_u32 v137, v136, v137, v134
    v_max_u32 v136, v136, v134
    v_med3_u32 v137, v136, v137, v135
    v_max_u32 v136, v136, v135
    s_nop 0
    v_readfirstlane_b32 s92, v136
    v_readfirstlane_b32 s93, v137
    s_andn2_b32 s46, 0x7ff, s92
    s_andn2_b32 s47, 0x7ff, s93
    s_cmp_ge_u32 s41, 18
    s_cbranch_scc1 Ltail_noffn
    s_mul_i32 s44, s46, 2304
    s_mul_i32 s45, s47, 2304
    s_sub_u32 s45, s45, s44
    v_and_b32 v8, 1, v1
    v_mul_lo_u32 v8, v8, s45
    v_and_b32 v9, 48, v1
    v_add3_u32 v8, v8, v9, s44
    s_mov_b32 s45, 2621440
    s_mov_b32 s48, 16384
Ltail_pollh:
    s_mov_b32 exec_lo, 0x30003
    s_mov_b32 exec_hi, 0x30003
    buffer_load_dwordx4 a[120:123], v8, s[24:27], s45 offen offset:0 sc1
    buffer_load_dwordx4 a[124:127], v8, s[24:27], s45 offen offset:64 sc1
    buffer_load_dwordx4 a[128:131], v8, s[24:27], s45 offen offset:128 sc1
    buffer_load_dwordx4 a[132:135], v8, s[24:27], s45 offen offset:192 sc1
    buffer_load_dwordx4 a[136:139], v8, s[24:27], s45 offen offset:256 sc1
    buffer_load_dwordx4 a[140:143], v8, s[24:27], s45 offen offset:320 sc1
    buffer_load_dwordx4 a[144:147], v8, s[24:27], s45 offen offset:384 sc1
    buffer_load_dwordx4 a[148:151], v8, s[24:27], s45 offen offset:448 sc1
    buffer_load_dwordx4 a[152:155], v8, s[24:27], s45 offen offset:512 sc1
    buffer_load_dwordx4 a[156:159], v8, s[24:27], s45 offen offset:576 sc1
    buffer_load_dwordx4 a[160:163], v8, s[24:27], s45 offen offset:640 sc1
    buffer_load_dwordx4 a[164:167], v8, s[24:27], s45 offen offset:704 sc1
    buffer_load_dwordx4 a[168:171], v8, s[24:27], s45 offen offset:768 sc1
    buffer_load_dwordx4 a[172:175], v8, s[24:27], s45 offen offset:832 sc1
    buffer_load_dwordx4 a[176:179], v8, s[24:27], s45 offen offset:896 sc1
    buffer_load_dwordx4 a[180:183], v8, s[24:27], s45 offen offset:960 sc1
    buffer_load_dwordx4 a[184:187], v8, s[24:27], s45 offen offset:1024 sc1
    buffer_load_dwordx4 a[188:191], v8, s[24:27], s45 offen offset:1088 sc1
    s_mov_b64 exec, -1
    ds_read_b64_tr_b16 a[72:73], v12 offset:0
    ds_read_b64_tr_b16 a[74:75], v12 offset:18432
    ds_read_b64_tr_b16 a[76:77], v12 offset:32
    ds_read_b64_tr_b16 a[78:79], v12 offset:18464
    ds_read_b64_tr_b16 a[80:81], v12 offset:64
    ds_read_b64_tr_b16 a[82:83], v12 offset:18496
    ds_read_b64_tr_b16 a[84:85], v12 offset:96
    ds_read_b64_tr_b16 a[86:87], v12 offset:18528
    ds_read_b64_tr_b16 a[88:89], v12 offset:512
    ds_read_b64_tr_b16 a[90:91], v12 offset:18944
    ds_read_b64_tr_b16 a[92:93], v12 offset:544
    ds_read_b64_tr_b16 a[94:95], v12 offset:18976
    ds_read_b64_tr_b16 a[96:97], v12 offset:576
    ds_read_b64_tr_b16 a[98:99], v12 offset:19008
    ds_read_b64_tr_b16 a[100:101], v12 offset:608
    ds_read_b64_tr_b16 a[102:103], v12 offset:19040
    ds_read_b64_tr_b16 a[104:105], v12 offset:1024
    ds_read_b64_tr_b16 a[106:107], v12 offset:19456
    ds_read_b64_tr_b16 a[108:109], v12 offset:1056
    ds_read_b64_tr_b16 a[110:111], v12 offset:19488
    ds_read_b64_tr_b16 a[112:113], v12 offset:1088
    ds_read_b64_tr_b16 a[114:115], v12 offset:19520
    ds_read_b64_tr_b16 a[116:117], v12 offset:1120
    ds_read_b64_tr_b16 a[118:119], v12 offset:19552
    s_waitcnt vmcnt(17)
    v_mfma_f32_16x16x32_bf16 v[16:19], a[0:3], a[120:123], 0
    s_waitcnt vmcnt(16)
    v_mfma_f32_16x16x32_bf16 v[20:23], a[4:7], a[124:127], 0
    s_waitcnt vmcnt(15)
    v_mfma_f32_16x16x32_bf16 v[16:19], a[8:11], a[128:131], v[16:19]
    s_waitcnt vmcnt(14)
    v_mfma_f32_16x16x32_bf16 v[20:23], a[12:15], a[132:135], v[20:23]
    s_waitcnt vmcnt(13)
    v_mfma_f32_16x16x32_bf16 v[16:19], a[16:19], a[136:139], v[16:19]
    s_waitcnt vmcnt(12)
    v_mfma_f32_16x16x32_bf16 v[20:23], a[20:23], a[140:143], v[20:23]
    s_waitcnt vmcnt(11)
    v_mfma_f32_16x16x32_bf16 v[16:19], a[24:27], a[144:147], v[16:19]
    s_waitcnt vmcnt(10)
    v_mfma_f32_16x16x32_bf16 v[20:23], a[28:31], a[148:151], v[20:23]
    s_waitcnt vmcnt(9)
    v_mfma_f32_16x16x32_bf16 v[16:19], a[32:35], a[152:155], v[16:19]
    s_waitcnt vmcnt(8)
    v_mfma_f32_16x16x32_bf16 v[20:23], a[36:39], a[156:159], v[20:23]
    s_waitcnt vmcnt(7)
    v_mfma_f32_16x16x32_bf16 v[16:19], a[40:43], a[160:163], v[16:19]
    s_waitcnt vmcnt(6)
    v_mfma_f32_16x16x32_bf16 v[20:23], a[44:47], a[164:167], v[20:23]
    s_waitcnt vmcnt(5)
    v_mfma_f32_16x16x32_bf16 v[16:19], a[48:51], a[168:171], v[16:19]
    s_waitcnt vmcnt(4)
    v_mfma_f32_16x16x32_bf16 v[20:23], a[52:55], a[172:175], v[20:23]
    s_waitcnt vmcnt(3)
    v_mfma_f32_16x16x32_bf16 v[16:19], a[56:59], a[176:179], v[16:19]
    s_waitcnt vmcnt(2)
    v_mfma_f32_16x16x32_bf16 v[20:23], a[60:63], a[180:183], v[20:23]
    s_waitcnt vmcnt(1)
    v_mfma_f32_16x16x32_bf16 v[16:19], a[64:67], a[184:187], v[16:19]
    s_waitcnt vmcnt(0)
    v_mfma_f32_16x16x32_bf16 v[20:23], a[68:71], a[188:191], v[20:23]
    s_sub_u32 s48, s48, 1
    s_nop 6
    v_pk_add_f32 v[16:17], v[16:17], v[20:21]
    v_pk_add_f32 v[18:19], v[18:19], v[22:23]
    s_cbranch_scc1 Ltail_goth
    v_cmp_u_f32 vcc, v16, v16
    s_and_b32 s36, vcc_lo, 3
    s_cbranch_scc1 Ltail_pollh
Ltail_goth:
    ds_write_b128 v14, v[16:19]
    s_waitcnt lgkmcnt(0)
    s_barrier
    ds_read_b128 v[16:19], v13 offset:0
    ds_read_b128 v[20:23], v13 offset:1024
    ds_read_b128 v[24:27], v13 offset:2048
    ds_read_b128 v[28:31], v13 offset:3072
    s_mov_b32 s36, 0xbfb8aa3b
    s_mov_b32 s37, 0xbfb8aa3b
    s_waitcnt lgkmcnt(3)
    v_cvt_pk_bf16_f32 v32, v16, v17
    v_cvt_pk_bf16_f32 v33, v18, v19
    s_waitcnt lgkmcnt(2)
    v_cvt_pk_bf16_f32 v34, v20, v21
    v_cvt_pk_bf16_f32 v35, v22, v23
    v_lshlrev_b32 v16, 16, v32
    v_and_b32 v17, 0xffff0000, v32
    v_lshlrev_b32 v18, 16, v33
    v_and_b32 v19, 0xffff0000, v33
    v_lshlrev_b32 v20, 16, v34
    v_and_b32 v21, 0xffff0000, v34
    v_lshlrev_b32 v22, 16, v35
    v_and_b32 v23, 0xffff0000, v35
    v_pk_mul_f32 v[32:33], v[16:17], s[36:37]
    v_pk_mul_f32 v[34:35], v[18:19], s[36:37]
    v_pk_mul_f32 v[36:37], v[20:21], s[36:37]
    v_pk_mul_f32 v[38:39], v[22:23], s[36:37]
    v_exp_f32 v32, v32
    v_exp_f32 v33, v33
    v_exp_f32 v34, v34
    v_exp_f32 v35, v35
    v_exp_f32 v36, v36
    v_exp_f32 v37, v37
    v_exp_f32 v38, v38
    v_exp_f32 v39, v39
    s_waitcnt lgkmcnt(1)
    v_cvt_pk_bf16_f32 v60, v24, v25
    v_cvt_pk_bf16_f32 v61, v26, v27
    s_waitcnt lgkmcnt(0)
    v_cvt_pk_bf16_f32 v62, v28, v29
    v_cvt_pk_bf16_f32 v63, v30, v31
    v_pk_add_f32 v[32:33], v[32:33], 1.0 op_sel_hi:[1,0]
    v_pk_add_f32 v[34:35], v[34:35], 1.0 op_sel_hi:[1,0]
    v_pk_add_f32 v[36:37], v[36:37], 1.0 op_sel_hi:[1,0]
    v_pk_add_f32 v[38:39], v[38:39], 1.0 op_sel_hi:[1,0]
    v_rcp_f32 v32, v32
    v_rcp_f32 v33, v33
    v_rcp_f32 v34, v34
    v_rcp_f32 v35, v35
    v_rcp_f32 v36, v36
    v_rcp_f32 v37, v37
    v_rcp_f32 v38, v38
    v_rcp_f32 v39, v39
    v_lshlrev_b32 v24, 16, v60
    v_and_b32 v25, 0xffff0000, v60
    v_lshlrev_b32 v26, 16, v61
    v_and_b32 v27, 0xffff0000, v61
    v_lshlrev_b32 v28, 16, v62
    v_and_b32 v29, 0xffff0000, v62
    v_lshlrev_b32 v30, 16, v63
    v_and_b32 v31, 0xffff0000, v63
    v_pk_mul_f32 v[16:17], v[16:17], v[32:33]
    v_pk_mul_f32 v[18:19], v[18:19], v[34:35]
    v_pk_mul_f32 v[20:21], v[20:21], v[36:37]
    v_pk_mul_f32 v[22:23], v[22:23], v[38:39]
    v_cvt_pk_bf16_f32 v32, v16, v17
    v_cvt_pk_bf16_f32 v33, v18, v19
    v_cvt_pk_bf16_f32 v34, v20, v21
    v_cvt_pk_bf16_f32 v35, v22, v23
    v_lshlrev_b32 v16, 16, v32
    v_and_b32 v17, 0xffff0000, v32
    v_lshlrev_b32 v18, 16, v33
    v_and_b32 v19, 0xffff0000, v33
    v_lshlrev_b32 v20, 16, v34
    v_and_b32 v21, 0xffff0000, v34
    v_lshlrev_b32 v22, 16, v35
    v_and_b32 v23, 0xffff0000, v35
    v_pk_mul_f32 v[16:17], v[16:17], v[24:25]
    v_pk_mul_f32 v[18:19], v[18:19], v[26:27]
    v_pk_mul_f32 v[20:21], v[20:21], v[28:29]
    v_pk_mul_f32 v[22:23], v[22:23], v[30:31]
    v_cvt_pk_bf16_f32 v32, v16, v17
    v_cvt_pk_bf16_f32 v33, v18, v19
    v_cvt_pk_bf16_f32 v34, v20, v21
    v_cvt_pk_bf16_f32 v35, v22, v23
    v_cndmask_b32 v64, 0, v32, s[52:53]
    v_cndmask_b32 v65, 0, v33, s[52:53]
    v_cndmask_b32 v66, 0, v34, s[52:53]
    v_cndmask_b32 v67, 0, v35, s[52:53]
    v_cndmask_b32 v68, 0, v32, s[54:55]
    v_cndmask_b32 v69, 0, v33, s[54:55]
    v_cndmask_b32 v70, 0, v34, s[54:55]
    v_cndmask_b32 v71, 0, v35, s[54:55]
    v_cndmask_b32 v72, 0, v32, s[56:57]
    v_cndmask_b32 v73, 0, v33, s[56:57]
    v_cndmask_b32 v74, 0, v34, s[56:57]
    v_cndmask_b32 v75, 0, v35, s[56:57]
    v_cndmask_b32 v76, 0, v32, s[58:59]
    v_cndmask_b32 v77, 0, v33, s[58:59]
    v_cndmask_b32 v78, 0, v34, s[58:59]
    v_cndmask_b32 v79, 0, v35, s[58:59]
    v_mfma_f32_16x16x32_bf16 v[16:19], v[64:67], a[72:75], 0
    v_mfma_f32_16x16x32_bf16 v[16:19], v[68:71], a[76:79], v[16:19]
    v_mfma_f32_16x16x32_bf16 v[16:19], v[72:75], a[80:83], v[16:19]
    v_mfma_f32_16x16x32_bf16 v[16:19], v[76:79], a[84:87], v[16:19]
    v_mfma_f32_16x16x32_bf16 v[20:23], v[64:67], a[88:91], 0
    v_mfma_f32_16x16x32_bf16 v[20:23], v[68:71], a[92:95], v[20:23]
    v_mfma_f32_16x16x32_bf16 v[20:23], v[72:75], a[96:99], v[20:23]
    v_mfma_f32_16x16x32_bf16 v[20:23], v[76:79], a[100:103], v[20:23]
    v_mfma_f32_16x16x32_bf16 v[24:27], v[64:67], a[104:107], 0
    v_mfma_f32_16x16x32_bf16 v[24:27], v[68:71], a[108:111], v[24:27]
    v_mfma_f32_16x16x32_bf16 v[24:27], v[72:75], a[112:115], v[24:27]
    v_mfma_f32_16x16x32_bf16 v[24:27], v[76:79], a[116:119], v[24:27]
    v_min_u32 v16, -2, v16
    v_min_u32 v17, -2, v17
    buffer_store_dwordx2 v[16:17], v15, s[8:11], s43 offen sc1
    s_add_u32 s43, s43, 294912
    v_min_u32 v20, -2, v20
    v_min_u32 v21, -2, v21
    buffer_store_dwordx2 v[20:21], v15, s[8:11], s43 offen sc1
    s_add_u32 s43, s43, 294912
    v_min_u32 v24, -2, v24
    v_min_u32 v25, -2, v25
    buffer_store_dwordx2 v[24:25], v15, s[8:11], s43 offen sc1
    s_cmp_lt_u32 s41, 9
    s_cselect_b32 s36, s3, 0
    s_cmp_eq_u32 s36, 3
    s_cbranch_scc1 Ltail_final
Ltail_noffn:
    s_branch Ltail_done
Ltail_idle:
    s_waitcnt vmcnt(0)
    s_mov_b32 s36, 2622592
    buffer_store_dwordx4 v[36:39], v6, s[24:27], s36 offen offset:0 sc1
    buffer_store_dwordx4 v[40:43], v6, s[24:27], s36 offen offset:512 sc1
    buffer_store_dwordx4 v[44:47], v60, s[24:27], s36 offen offset:1024 sc1
    s_branch Ltail_done
Ltail_final:
Ltour13:
    s_cbranch_execz Ltour17
    s_mul_i32 s43, s42, 9
    s_add_u32 s43, s43, s41
    v_bfe_u32 v8, v1, 2, 1
    v_cmp_eq_u32 vcc, 1, v8
    v_mov_b32 v9, s46
    v_mov_b32 v10, s47
    v_and_b32 v11, 3, v1
    v_cndmask_b32 v9, v9, v10, vcc
    s_lshr_b32 s44, s43, 2
    s_lshl_b32 s44, s44, 6
    s_and_b32 s45, s43, 1
    s_lshl_b32 s45, s45, 5
    s_add_u32 s44, s44, s45
    s_and_b32 s45, s43, 2
    s_lshl_b32 s45, s45, 2
    s_add_u32 s44, s44, s45
    v_lshrrev_b32 v12, 1, v11
    v_lshl_add_u32 v12, v12, 4, s44
    v_and_b32 v13, 1, v11
    v_lshl_add_u32 v12, v13, 2, v12
    v_mul_u32_u24 v13, 1152, v9
    v_lshl_add_u32 v14, v13, 1, v12
    v_add_u32 v15, 2621440, v14
    s_mov_b32 s45, 22144
    buffer_load_dword v18, v12, s[24:27], s45 offen sc1
    v_mov_b32 v19, s92
    v_mov_b32 v10, s93
    v_cndmask_b32 v19, v19, v10, vcc
    v_and_b32 v19, 0xfffff800, v19
    v_or_b32 v19, 0x400, v19
    v_ashrrev_i32 v10, 31, v19
    v_not_b32 v10, v10
    v_or_b32 v10, 0x80000000, v10
    v_xor_b32 v19, v19, v10
    s_lshl_b32 s45, s43, 4
    v_lshl_add_u32 v13, v11, 2, v13
    v_add_u32 v13, s45, v13
    v_lshrrev_b32 v14, 2, v1
    v_lshlrev_b32 v14, 9, v14
    v_lshl_add_u32 v14, v11, 4, v14
    s_lshr_b32 s44, s43, 3
    s_mul_i32 s44, s44, 73728
    s_and_b32 s45, s43, 7
    s_lshl_b32 s45, s45, 6
    s_add_u32 s44, s44, s45
    v_cmp_eq_u32 s[38:39], 1, v8
    v_cvt_pk_bf16_f32 v19, v19, v19
    v_and_b32 v19, 0xffff0000, v19
    v_mul_f32 v19, 0xbfb8aa3b, v19
    v_exp_f32 v19, v19
    s_waitcnt vmcnt(0)
    v_lshlrev_b32 v24, 16, v18
    v_and_b32 v25, 0xffff0000, v18
    v_add_f32 v19, 1.0, v19
    v_rcp_f32 v19, v19
    s_mov_b32 s48, 16384
    v_cvt_pk_bf16_f32 v19, v19, v19
    v_and_b32 v19, 0xffff0000, v19
Ltail_polly:
    s_add_u32 s45, s44, 0
    buffer_load_dwordx4 v[64:67], v14, s[8:11], s45 offen sc1
    s_add_u32 s45, s44, 8192
    buffer_load_dwordx4 v[68:71], v14, s[8:11], s45 offen sc1
    s_add_u32 s45, s44, 16384
    buffer_load_dwordx4 v[72:75], v14, s[8:11], s45 offen sc1
    s_add_u32 s45, s44, 24576
    buffer_load_dwordx4 v[76:79], v14, s[8:11], s45 offen sc1
    s_add_u32 s45, s44, 32768
    buffer_load_dwordx4 v[80:83], v14, s[8:11], s45 offen sc1
    s_add_u32 s45, s44, 40960
    buffer_load_dwordx4 v[84:87], v14, s[8:11], s45 offen sc1
    s_add_u32 s45, s44, 49152
    buffer_load_dwordx4 v[88:91], v14, s[8:11], s45 offen sc1
    s_add_u32 s45, s44, 57344
    buffer_load_dwordx4 v[92:95], v14, s[8:11], s45 offen sc1
    s_add_u32 s45, s44, 65536
    buffer_load_dwordx4 v[96:99], v14, s[8:11], s45 offen sc1
    s_mov_b32 s45, 1152
    buffer_load_dword v16, v15, s[24:27], s45 offen sc1
    buffer_load_dword v17, v15, s[24:27], 0 offen sc1
    s_sub_u32 s48, s48, 1
    s_cbranch_scc1 Ltail_goty
    s_waitcnt vmcnt(10)
    v_max3_u32 v26, v64, v65, v66
    s_waitcnt vmcnt(9)
    v_max3_u32 v26, v26, v67, v68
    v_max3_u32 v26, v26, v69, v70
Ltour14:
    s_cbranch_execz Lmain
    s_waitcnt vmcnt(8)
    v_max3_u32 v26, v26, v71, v72
    v_max3_u32 v26, v26, v73, v74
    s_waitcnt vmcnt(7)
    v_max3_u32 v26, v26, v75, v76
    v_max3_u32 v26, v26, v77, v78
    s_waitcnt vmcnt(6)
    v_max3_u32 v26, v26, v79, v80
    v_max3_u32 v26, v26, v81, v82
    s_waitcnt vmcnt(5)
    v_max3_u32 v26, v26, v83, v84
    v_max3_u32 v26, v26, v85, v86
    s_waitcnt vmcnt(4)
    v_max3_u32 v26, v26, v87, v88
    v_max3_u32 v26, v26, v89, v90
    s_waitcnt vmcnt(3)
    v_max3_u32 v26, v26, v91, v92
    v_max3_u32 v26, v26, v93, v94
    s_waitcnt vmcnt(2)
    v_max3_u32 v26, v26, v95, v96
    v_max3_u32 v26, v26, v97, v98
    v_max_u32 v26, v26, v99
    s_waitcnt vmcnt(0)
    v_max3_u32 v26, v26, v16, v17
    v_cmp_eq_u32 vcc, -1, v26
    s_cbranch_vccnz Ltail_polly
Ltail_goty:
    s_waitcnt vmcnt(0) lgkmcnt(0)
    v_lshlrev_b32 v20, 16, v16
    v_and_b32 v21, 0xffff0000, v16
    v_lshlrev_b32 v22, 16, v17
    v_and_b32 v23, 0xffff0000, v17
    v_pk_add_f32 v[64:65], v[64:65], v[68:69]
    v_pk_add_f32 v[66:67], v[66:67], v[70:71]
    v_pk_add_f32 v[64:65], v[64:65], v[72:73]
    v_pk_add_f32 v[66:67], v[66:67], v[74:75]
    v_pk_add_f32 v[64:65], v[64:65], v[76:77]
    v_pk_add_f32 v[66:67], v[66:67], v[78:79]
    v_pk_add_f32 v[64:65], v[64:65], v[80:81]
    v_pk_add_f32 v[66:67], v[66:67], v[82:83]
    v_pk_add_f32 v[64:65], v[64:65], v[84:85]
    v_pk_add_f32 v[66:67], v[66:67], v[86:87]
    v_pk_add_f32 v[64:65], v[64:65], v[88:89]
    v_pk_add_f32 v[66:67], v[66:67], v[90:91]
    v_pk_add_f32 v[64:65], v[64:65], v[92:93]
    v_pk_add_f32 v[66:67], v[66:67], v[94:95]
    v_pk_add_f32 v[64:65], v[64:65], v[96:97]
    v_pk_add_f32 v[66:67], v[66:67], v[98:99]
    s_nop 0
    v_add_f32_dpp v64, v64, v64 row_ror:4 row_mask:0xf bank_mask:0xf
    v_add_f32_dpp v65, v65, v65 row_ror:4 row_mask:0xf bank_mask:0xf
    v_add_f32_dpp v66, v66, v66 row_ror:4 row_mask:0xf bank_mask:0xf
    v_add_f32_dpp v67, v67, v67 row_ror:4 row_mask:0xf bank_mask:0xf
    v_add_f32_dpp v64, v64, v64 row_ror:8 row_mask:0xf bank_mask:0xf
    v_add_f32_dpp v65, v65, v65 row_ror:8 row_mask:0xf bank_mask:0xf
    v_add_f32_dpp v66, v66, v66 row_ror:8 row_mask:0xf bank_mask:0xf
    v_add_f32_dpp v67, v67, v67 row_ror:8 row_mask:0xf bank_mask:0xf
    v_mov_b32 v68, v64
    v_mov_b32 v69, v65
    v_mov_b32 v70, v66
    v_mov_b32 v71, v67
    v_permlane16_swap_b32 v64, v68
    v_permlane16_swap_b32 v65, v69
    v_permlane16_swap_b32 v66, v70
    v_permlane16_swap_b32 v67, v71
    v_add_f32 v64, v64, v68
    v_add_f32 v65, v65, v69
    v_add_f32 v66, v66, v70
    v_add_f32 v67, v67, v71
    v_mov_b32 v68, v64
    v_mov_b32 v69, v65
    v_mov_b32 v70, v66
    v_mov_b32 v71, v67
    v_permlane32_swap_b32 v64, v68
    v_permlane32_swap_b32 v65, v69
    v_permlane32_swap_b32 v66, v70
    v_permlane32_swap_b32 v67, v71
    v_add_f32 v64, v64, v68
    v_add_f32 v65, v65, v69
    v_add_f32 v66, v66, v70
    v_add_f32 v67, v67, v71
    v_cndmask_b32 v26, v64, v65, s[38:39]
    v_cndmask_b32 v27, v66, v67, s[38:39]
    v_cvt_pk_bf16_f32 v28, v26, v27
    v_lshlrev_b32 v26, 16, v28
    v_and_b32 v27, 0xffff0000, v28
    v_mul_f32 v26, v26, v19
    v_mul_f32 v27, v27, v19
    v_cvt_pk_bf16_f32 v28, v26, v27
    v_lshlrev_b32 v26, 16, v28
    v_and_b32 v27, 0xffff0000, v28
    v_pk_add_f32 v[26:27], v[26:27], v[22:23]
    v_cvt_pk_bf16_f32 v28, v26, v27
    v_lshlrev_b32 v26, 16, v28
    v_and_b32 v27, 0xffff0000, v28
    v_pk_mul_f32 v[26:27], v[26:27], v[24:25]
    v_cvt_pk_bf16_f32 v28, v26, v27
    v_lshlrev_b32 v26, 16, v28
    v_and_b32 v27, 0xffff0000, v28
    v_pk_add_f32 v[26:27], v[26:27], v[20:21]
    v_cvt_pk_bf16_f32 v28, v26, v27
    s_mov_b64 exec, 0xff
    buffer_store_dword v28, v13, s[16:19], 0 offen nt
Ltail_done:
    s_endpgm
Lattn_wb:
    buffer_wbl2 sc1
    s_waitcnt vmcnt(0)
    s_branch Lattn_wbdone
Lattn_xspin:
Ltour15:
    s_cbranch_execz Lmain
    s_mov_b32 s37, 16384
Lattn_xloop:
    buffer_load_dword v11, v8, s[24:27], s54 offen offset:8 sc1
    s_waitcnt vmcnt(0)
    v_readfirstlane_b32 s36, v11
    s_sub_u32 s37, s37, 1
    s_cbranch_scc1 Lattn_xgot
    s_cmp_lg_u32 s36, s95
    s_cbranch_scc1 Lattn_xloop
    s_branch Lattn_xgot
Ltail_spin1:
Ltour16:
    s_cbranch_execz Lmain
    s_mov_b32 s48, 16384
Ltail_spinl1:
    buffer_load_dword v11, v9, s[24:27], s39 offen sc1
    s_waitcnt vmcnt(0)
    v_cmp_ne_u32 s[54:55], s95, v11
    s_sub_u32 s48, s48, 1
    s_cbranch_scc1 Ltail_got1
    s_cmp_lg_u64 s[54:55], 0
    s_cbranch_scc1 Ltail_spinl1
    s_branch Ltail_got1
Ltail_spin2:
Ltour17:
    s_cbranch_execz Lmain
    s_mov_b32 s48, 16384
Ltail_spinl2:
    buffer_load_dword v11, v9, s[24:27], s39 offen sc1
    s_waitcnt vmcnt(0)
    v_cmp_ne_u32 s[54:55], s95, v11
    s_sub_u32 s48, s48, 1
    s_cbranch_scc1 Ltail_got2
    s_cmp_lg_u64 s[54:55], 0
    s_cbranch_scc1 Ltail_spinl2
    s_branch Ltail_got2
Lattn_redo:
    v_xor_b32 v8, 64, v9
    v_xor_b32 v10, 64, v11
    s_waitcnt vmcnt(0) lgkmcnt(0)
    s_barrier
    v_mov_b32 v232, 0xff800000
    v_mov_b32 v233, 0xff800000
    v_mov_b32 v234, 0xff800000
    v_mov_b32 v235, 0xff800000
    s_mov_b32 s40, 0
    s_mov_b32 s48, -1
Lattn_redo_loop:
    s_add_u32 m0, s42, 0
    s_nop 0
    buffer_load_dwordx4 v36, s[8:11], s40 offen lds
    buffer_load_dwordx4 v37, s[8:11], s40 offen offset:1024 lds
    buffer_load_dwordx4 v38, s[8:11], s40 offen offset:2048 lds
    buffer_load_dwordx4 v39, s[8:11], s40 offen offset:3072 lds
    s_add_u32 s40, s40, 16384
    s_waitcnt vmcnt(0) lgkmcnt(0)
    s_barrier
    ds_read_b128 a[208:211], v8 offset:0
    ds_read_b128 a[212:215], v9 offset:0
    ds_read_b128 a[216:219], v10 offset:0
    ds_read_b128 a[220:223], v11 offset:0
    s_waitcnt lgkmcnt(3)
    v_mfma_f32_16x16x32_bf16 v[216:219], a[208:211], v[64:67], 0
    s_waitcnt lgkmcnt(2)
    v_mfma_f32_16x16x32_bf16 v[216:219], a[212:215], v[68:71], v[216:219]
    s_waitcnt lgkmcnt(1)
    v_mfma_f32_16x16x32_bf16 v[216:219], a[216:219], v[72:75], v[216:219]
    s_waitcnt lgkmcnt(0)
    v_mfma_f32_16x16x32_bf16 v[216:219], a[220:223], v[76:79], v[216:219]
    v_mfma_f32_16x16x32_bf16 v[220:223], a[208:211], v[80:83], 0
    v_mfma_f32_16x16x32_bf16 v[220:223], a[212:215], v[84:87], v[220:223]
    v_mfma_f32_16x16x32_bf16 v[220:223], a[216:219], v[88:91], v[220:223]
    v_mfma_f32_16x16x32_bf16 v[220:223], a[220:223], v[92:95], v[220:223]
    v_mfma_f32_16x16x32_bf16 v[224:227], a[208:211], v[96:99], 0
    v_mfma_f32_16x16x32_bf16 v[224:227], a[212:215], v[100:103], v[224:227]
    v_mfma_f32_16x16x32_bf16 v[224:227], a[216:219], v[104:107], v[224:227]
    v_mfma_f32_16x16x32_bf16 v[224:227], a[220:223], v[108:111], v[224:227]
    v_mfma_f32_16x16x32_bf16 v[228:231], a[208:211], v[112:115], 0
    v_mfma_f32_16x16x32_bf16 v[228:231], a[212:215], v[116:119], v[228:231]
    v_mfma_f32_16x16x32_bf16 v[228:231], a[216:219], v[120:123], v[228:231]
    v_mfma_f32_16x16x32_bf16 v[228:231], a[220:223], v[124:127], v[228:231]
    v_max3_f32 v232, v232, v216, v217
    v_max3_f32 v232, v232, v218, v219
    v_max3_f32 v233, v233, v220, v221
    v_max3_f32 v233, v233, v222, v223
    v_max3_f32 v234, v234, v224, v225
    v_max3_f32 v234, v234, v226, v227
    s_nop 1
    v_max3_f32 v235, v235, v228, v229
    v_max3_f32 v235, v235, v230, v231
    ds_read_b128 a[224:227], v8 offset:4096
    ds_read_b128 a[228:231], v9 offset:4096
    ds_read_b128 a[232:235], v10 offset:4096
    ds_read_b128 a[236:239], v11 offset:4096
    s_waitcnt lgkmcnt(3)
    v_mfma_f32_16x16x32_bf16 v[216:219], a[224:227], v[64:67], 0
    s_waitcnt lgkmcnt(2)
    v_mfma_f32_16x16x32_bf16 v[216:219], a[228:231], v[68:71], v[216:219]
    s_waitcnt lgkmcnt(1)
    v_mfma_f32_16x16x32_bf16 v[216:219], a[232:235], v[72:75], v[216:219]
    s_waitcnt lgkmcnt(0)
    v_mfma_f32_16x16x32_bf16 v[216:219], a[236:239], v[76:79], v[216:219]
    v_mfma_f32_16x16x32_bf16 v[220:223], a[224:227], v[80:83], 0
    v_mfma_f32_16x16x32_bf16 v[220:223], a[228:231], v[84:87], v[220:223]
    v_mfma_f32_16x16x32_bf16 v[220:223], a[232:235], v[88:91], v[220:223]
    v_mfma_f32_16x16x32_bf16 v[220:223], a[236:239], v[92:95], v[220:223]
    v_mfma_f32_16x16x32_bf16 v[224:227], a[224:227], v[96:99], 0
    v_mfma_f32_16x16x32_bf16 v[224:227], a[228:231], v[100:103], v[224:227]
    v_mfma_f32_16x16x32_bf16 v[224:227], a[232:235], v[104:107], v[224:227]
    v_mfma_f32_16x16x32_bf16 v[224:227], a[236:239], v[108:111], v[224:227]
    v_mfma_f32_16x16x32_bf16 v[228:231], a[224:227], v[112:115], 0
    v_mfma_f32_16x16x32_bf16 v[228:231], a[228:231], v[116:119], v[228:231]
    v_mfma_f32_16x16x32_bf16 v[228:231], a[232:235], v[120:123], v[228:231]
    v_mfma_f32_16x16x32_bf16 v[228:231], a[236:239], v[124:127], v[228:231]
    v_max3_f32 v232, v232, v216, v217
    v_max3_f32 v232, v232, v218, v219
    v_max3_f32 v233, v233, v220, v221
    v_max3_f32 v233, v233, v222, v223
    v_max3_f32 v234, v234, v224, v225
    v_max3_f32 v234, v234, v226, v227
    s_nop 1
    v_max3_f32 v235, v235, v228, v229
    v_max3_f32 v235, v235, v230, v231
    ds_read_b128 a[208:211], v8 offset:8192
    ds_read_b128 a[212:215], v9 offset:8192
    ds_read_b128 a[216:219], v10 offset:8192
    ds_read_b128 a[220:223], v11 offset:8192
    s_waitcnt lgkmcnt(3)
    v_mfma_f32_16x16x32_bf16 v[216:219], a[208:211], v[64:67], 0
    s_waitcnt lgkmcnt(2)
    v_mfma_f32_16x16x32_bf16 v[216:219], a[212:215], v[68:71], v[216:219]
    s_waitcnt lgkmcnt(1)
    v_mfma_f32_16x16x32_bf16 v[216:219], a[216:219], v[72:75], v[216:219]
    s_waitcnt lgkmcnt(0)
    v_mfma_f32_16x16x32_bf16 v[216:219], a[220:223], v[76:79], v[216:219]
    v_mfma_f32_16x16x32_bf16 v[220:223], a[208:211], v[80:83], 0
    v_mfma_f32_16x16x32_bf16 v[220:223], a[212:215], v[84:87], v[220:223]
    v_mfma_f32_16x16x32_bf16 v[220:223], a[216:219], v[88:91], v[220:223]
    v_mfma_f32_16x16x32_bf16 v[220:223], a[220:223], v[92:95], v[220:223]
    v_mfma_f32_16x16x32_bf16 v[224:227], a[208:211], v[96:99], 0
    v_mfma_f32_16x16x32_bf16 v[224:227], a[212:215], v[100:103], v[224:227]
    v_mfma_f32_16x16x32_bf16 v[224:227], a[216:219], v[104:107], v[224:227]
    v_mfma_f32_16x16x32_bf16 v[224:227], a[220:223], v[108:111], v[224:227]
    v_mfma_f32_16x16x32_bf16 v[228:231], a[208:211], v[112:115], 0
    v_mfma_f32_16x16x32_bf16 v[228:231], a[212:215], v[116:119], v[228:231]
    v_mfma_f32_16x16x32_bf16 v[228:231], a[216:219], v[120:123], v[228:231]
    v_mfma_f32_16x16x32_bf16 v[228:231], a[220:223], v[124:127], v[228:231]
    v_max3_f32 v232, v232, v216, v217
    v_max3_f32 v232, v232, v218, v219
    v_max3_f32 v233, v233, v220, v221
    v_max3_f32 v233, v233, v222, v223
    v_max3_f32 v234, v234, v224, v225
    v_max3_f32 v234, v234, v226, v227
    s_nop 1
    v_max3_f32 v235, v235, v228, v229
    v_max3_f32 v235, v235, v230, v231
    ds_read_b128 a[224:227], v8 offset:12288
    ds_read_b128 a[228:231], v9 offset:12288
    ds_read_b128 a[232:235], v10 offset:12288
    ds_read_b128 a[236:239], v11 offset:12288
    s_waitcnt lgkmcnt(3)
    v_mfma_f32_16x16x32_bf16 v[216:219], a[224:227], v[64:67], 0
    s_waitcnt lgkmcnt(2)
    v_mfma_f32_16x16x32_bf16 v[216:219], a[228:231], v[68:71], v[216:219]
    s_waitcnt lgkmcnt(1)
    v_mfma_f32_16x16x32_bf16 v[216:219], a[232:235], v[72:75], v[216:219]
    s_waitcnt lgkmcnt(0)
    v_mfma_f32_16x16x32_bf16 v[216:219], a[236:239], v[76:79], v[216:219]
    v_mfma_f32_16x16x32_bf16 v[220:223], a[224:227], v[80:83], 0
    v_mfma_f32_16x16x32_bf16 v[220:223], a[228:231], v[84:87], v[220:223]
    v_mfma_f32_16x16x32_bf16 v[220:223], a[232:235], v[88:91], v[220:223]
    v_mfma_f32_16x16x32_bf16 v[220:223], a[236:239], v[92:95], v[220:223]
    v_mfma_f32_16x16x32_bf16 v[224:227], a[224:227], v[96:99], 0
    v_mfma_f32_16x16x32_bf16 v[224:227], a[228:231], v[100:103], v[224:227]
    v_mfma_f32_16x16x32_bf16 v[224:227], a[232:235], v[104:107], v[224:227]
    v_mfma_f32_16x16x32_bf16 v[224:227], a[236:239], v[108:111], v[224:227]
    v_mfma_f32_16x16x32_bf16 v[228:231], a[224:227], v[112:115], 0
    v_mfma_f32_16x16x32_bf16 v[228:231], a[228:231], v[116:119], v[228:231]
    v_mfma_f32_16x16x32_bf16 v[228:231], a[232:235], v[120:123], v[228:231]
    v_mfma_f32_16x16x32_bf16 v[228:231], a[236:239], v[124:127], v[228:231]
    v_max3_f32 v232, v232, v216, v217
    v_max3_f32 v232, v232, v218, v219
    v_max3_f32 v233, v233, v220, v221
    v_max3_f32 v233, v233, v222, v223
    v_max3_f32 v234, v234, v224, v225
    v_max3_f32 v234, v234, v226, v227
    s_nop 1
    v_max3_f32 v235, v235, v228, v229
    v_max3_f32 v235, v235, v230, v231
    s_barrier
    s_cmp_lt_u32 s40, 524288
    s_cbranch_scc1 Lattn_redo_loop
    v_mov_b32 v236, v232
    v_mov_b32 v237, v233
    v_mov_b32 v238, v234
    v_mov_b32 v239, v235
    v_permlane16_swap_b32 v232, v236
    v_permlane16_swap_b32 v233, v237
    v_permlane16_swap_b32 v234, v238
    v_permlane16_swap_b32 v235, v239
    v_max_f32 v232, v232, v236
    v_max_f32 v233, v233, v237
    v_max_f32 v234, v234, v238
    v_max_f32 v235, v235, v239
    v_mov_b32 v236, v232
    v_mov_b32 v237, v233
    v_mov_b32 v238, v234
    v_mov_b32 v239, v235
    v_permlane32_swap_b32 v232, v236
    v_permlane32_swap_b32 v233, v237
    v_permlane32_swap_b32 v234, v238
    v_permlane32_swap_b32 v235, v239
    v_max_f32 v232, v232, v236
    v_max_f32 v233, v233, v237
    v_max_f32 v234, v234, v238
    v_max_f32 v235, v235, v239
    v_sub_f32 v192, 0, v232
    v_sub_f32 v193, 0, v232
    v_sub_f32 v194, 0, v232
    v_sub_f32 v195, 0, v232
    v_sub_f32 v196, 0, v233
    v_sub_f32 v197, 0, v233
    v_sub_f32 v198, 0, v233
    v_sub_f32 v199, 0, v233
    v_sub_f32 v200, 0, v234
    v_sub_f32 v201, 0, v234
    v_sub_f32 v202, 0, v234
    v_sub_f32 v203, 0, v234
    v_sub_f32 v204, 0, v235
    v_sub_f32 v205, 0, v235
    v_sub_f32 v206, 0, v235
    v_sub_f32 v207, 0, v235
    s_mov_b32 s40, 0
    s_mov_b32 s41, 0
    s_add_u32 m0, s42, 0
    s_nop 0
    buffer_load_dwordx4 v36, s[8:11], s40 offen lds
    buffer_load_dwordx4 v37, s[8:11], s40 offen offset:1024 lds
    buffer_load_dwordx4 v38, s[8:11], s40 offen offset:2048 lds
    buffer_load_dwordx4 v39, s[8:11], s40 offen offset:3072 lds
    s_add_u32 s40, s40, 16384
    s_add_u32 m0, s42, 16384
    s_nop 0
    buffer_load_dwordx4 v36, s[8:11], s40 offen lds
    buffer_load_dwordx4 v37, s[8:11], s40 offen offset:1024 lds
    buffer_load_dwordx4 v38, s[8:11], s40 offen offset:2048 lds
    buffer_load_dwordx4 v39, s[8:11], s40 offen offset:3072 lds
    s_add_u32 s40, s40, 16384
    s_add_u32 m0, s42, 32768
    s_nop 0
    buffer_load_dwordx4 v36, s[8:11], s40 offen lds
    buffer_load_dwordx4 v37, s[8:11], s40 offen offset:1024 lds
    buffer_load_dwordx4 v38, s[8:11], s40 offen offset:2048 lds
    buffer_load_dwordx4 v39, s[8:11], s40 offen offset:3072 lds
    s_add_u32 s40, s40, 16384
    s_add_u32 m0, s42, 65536
    s_nop 0
    buffer_load_dwordx4 v40, s[12:15], s41 offen lds
    buffer_load_dwordx4 v41, s[12:15], s41 offen offset:1024 lds
    buffer_load_dwordx4 v40, s[12:15], s41 offen offset:2048 lds
    buffer_load_dwordx4 v41, s[12:15], s41 offen offset:3072 lds
    s_add_u32 s41, s41, 16384
    s_add_u32 m0, s42, 81920
    s_nop 0
    buffer_load_dwordx4 v40, s[12:15], s41 offen lds
    buffer_load_dwordx4 v41, s[12:15], s41 offen offset:1024 lds
    buffer_load_dwordx4 v40, s[12:15], s41 offen offset:2048 lds
    buffer_load_dwordx4 v41, s[12:15], s41 offen offset:3072 lds
    s_add_u32 s41, s41, 16384
    v_accvgpr_write_b32 a0, 0
    v_accvgpr_write_b32 a1, 0
    v_accvgpr_write_b32 a2, 0
    v_accvgpr_write_b32 a3, 0
    v_accvgpr_write_b32 a4, 0
    v_accvgpr_write_b32 a5, 0
    v_accvgpr_write_b32 a6, 0
    v_accvgpr_write_b32 a7, 0
    v_accvgpr_write_b32 a8, 0
    v_accvgpr_write_b32 a9, 0
    v_accvgpr_write_b32 a10, 0
    v_accvgpr_write_b32 a11, 0
    v_accvgpr_write_b32 a12, 0
    v_accvgpr_write_b32 a13, 0
    v_accvgpr_write_b32 a14, 0
    v_accvgpr_write_b32 a15, 0
    v_accvgpr_write_b32 a16, 0
    v_accvgpr_write_b32 a17, 0
    v_accvgpr_write_b32 a18, 0
    v_accvgpr_write_b32 a19, 0
    v_accvgpr_write_b32 a20, 0
    v_accvgpr_write_b32 a21, 0
    v_accvgpr_write_b32 a22, 0
    v_accvgpr_write_b32 a23, 0
    v_accvgpr_write_b32 a24, 0
    v_accvgpr_write_b32 a25, 0
    v_accvgpr_write_b32 a26, 0
    v_accvgpr_write_b32 a27, 0
    v_accvgpr_write_b32 a28, 0
    v_accvgpr_write_b32 a29, 0
    v_accvgpr_write_b32 a30, 0
    v_accvgpr_write_b32 a31, 0
    v_accvgpr_write_b32 a32, 0
    v_accvgpr_write_b32 a33, 0
    v_accvgpr_write_b32 a34, 0
    v_accvgpr_write_b32 a35, 0
    v_accvgpr_write_b32 a36, 0
    v_accvgpr_write_b32 a37, 0
    v_accvgpr_write_b32 a38, 0
    v_accvgpr_write_b32 a39, 0
    v_accvgpr_write_b32 a40, 0
    v_accvgpr_write_b32 a41, 0
    v_accvgpr_write_b32 a42, 0
    v_accvgpr_write_b32 a43, 0
    v_accvgpr_write_b32 a44, 0
    v_accvgpr_write_b32 a45, 0
    v_accvgpr_write_b32 a46, 0
    v_accvgpr_write_b32 a47, 0
    v_accvgpr_write_b32 a48, 0
    v_accvgpr_write_b32 a49, 0
    v_accvgpr_write_b32 a50, 0
    v_accvgpr_write_b32 a51, 0
    v_accvgpr_write_b32 a52, 0
    v_accvgpr_write_b32 a53, 0
    v_accvgpr_write_b32 a54, 0
    v_accvgpr_write_b32 a55, 0
    v_accvgpr_write_b32 a56, 0
    v_accvgpr_write_b32 a57, 0
    v_accvgpr_write_b32 a58, 0
    v_accvgpr_write_b32 a59, 0
    v_accvgpr_write_b32 a60, 0
    v_accvgpr_write_b32 a61, 0
    v_accvgpr_write_b32 a62, 0
    v_accvgpr_write_b32 a63, 0
    v_accvgpr_write_b32 a64, 0
    v_accvgpr_write_b32 a65, 0
    v_accvgpr_write_b32 a66, 0
    v_accvgpr_write_b32 a67, 0
    v_accvgpr_write_b32 a68, 0
    v_accvgpr_write_b32 a69, 0
    v_accvgpr_write_b32 a70, 0
    v_accvgpr_write_b32 a71, 0
    v_accvgpr_write_b32 a72, 0
    v_accvgpr_write_b32 a73, 0
    v_accvgpr_write_b32 a74, 0
    v_accvgpr_write_b32 a75, 0
    v_accvgpr_write_b32 a76, 0
    v_accvgpr_write_b32 a77, 0
    v_accvgpr_write_b32 a78, 0
    v_accvgpr_write_b32 a79, 0
    v_accvgpr_write_b32 a80, 0
    v_accvgpr_write_b32 a81, 0
    v_accvgpr_write_b32 a82, 0
    v_accvgpr_write_b32 a83, 0
    v_accvgpr_write_b32 a84, 0
    v_accvgpr_write_b32 a85, 0
    v_accvgpr_write_b32 a86, 0
    v_accvgpr_write_b32 a87, 0
    v_accvgpr_write_b32 a88, 0
    v_accvgpr_write_b32 a89, 0
    v_accvgpr_write_b32 a90, 0
    v_accvgpr_write_b32 a91, 0
    v_accvgpr_write_b32 a92, 0
    v_accvgpr_write_b32 a93, 0
    v_accvgpr_write_b32 a94, 0
    v_accvgpr_write_b32 a95, 0
    v_accvgpr_write_b32 a96, 0
    v_accvgpr_write_b32 a97, 0
    v_accvgpr_write_b32 a98, 0
    v_accvgpr_write_b32 a99, 0
    v_accvgpr_write_b32 a100, 0
    v_accvgpr_write_b32 a101, 0
    v_accvgpr_write_b32 a102, 0
    v_accvgpr_write_b32 a103, 0
    v_accvgpr_write_b32 a104, 0
    v_accvgpr_write_b32 a105, 0
    v_accvgpr_write_b32 a106, 0
    v_accvgpr_write_b32 a107, 0
    v_accvgpr_write_b32 a108, 0
    v_accvgpr_write_b32 a109, 0
    v_accvgpr_write_b32 a110, 0
    v_accvgpr_write_b32 a111, 0
    v_accvgpr_write_b32 a112, 0
    v_accvgpr_write_b32 a113, 0
    v_accvgpr_write_b32 a114, 0
    v_accvgpr_write_b32 a115, 0
    v_accvgpr_write_b32 a116, 0
    v_accvgpr_write_b32 a117, 0
    v_accvgpr_write_b32 a118, 0
    v_accvgpr_write_b32 a119, 0
    v_accvgpr_write_b32 a120, 0
    v_accvgpr_write_b32 a121, 0
    v_accvgpr_write_b32 a122, 0
    v_accvgpr_write_b32 a123, 0
    v_accvgpr_write_b32 a124, 0
    v_accvgpr_write_b32 a125, 0
    v_accvgpr_write_b32 a126, 0
    v_accvgpr_write_b32 a127, 0
    v_accvgpr_write_b32 a192, 0
    v_accvgpr_write_b32 a193, 0
    v_accvgpr_write_b32 a194, 0
    v_accvgpr_write_b32 a195, 0
    v_accvgpr_write_b32 a196, 0
    v_accvgpr_write_b32 a197, 0
    v_accvgpr_write_b32 a198, 0
    v_accvgpr_write_b32 a199, 0
    v_accvgpr_write_b32 a200, 0
    v_accvgpr_write_b32 a201, 0
    v_accvgpr_write_b32 a202, 0
    v_accvgpr_write_b32 a203, 0
    v_accvgpr_write_b32 a204, 0
    v_accvgpr_write_b32 a205, 0
    v_accvgpr_write_b32 a206, 0
    v_accvgpr_write_b32 a207, 0
    s_waitcnt vmcnt(0) lgkmcnt(0)
    s_barrier
    ds_read_b128 a[208:211], v8 offset:0
    ds_read_b128 a[212:215], v9 offset:0
    ds_read_b128 a[216:219], v10 offset:0
    ds_read_b128 a[220:223], v11 offset:0
    ds_read_b128 a[224:227], v8 offset:4096
    s_waitcnt vmcnt(0) lgkmcnt(0)
    s_branch Lattn_stage0
Lattn_armwait:
    s_mov_b32 s36, 16384
Lattn_armloop:
    v_mov_b32 v63, 0
    buffer_load_dword v63, v63, s[88:91], 0 offen sc1
    s_waitcnt vmcnt(0)
    v_readfirstlane_b32 s37, v63
    s_sub_u32 s36, s36, 1
    s_cbranch_scc1 Lattn_armed
    s_cmp_lt_u32 s37, 256
    s_cbranch_scc1 Lattn_armloop
    s_branch Lattn_armed
Lattn_end:
    s_endpgm
.section .rodata,"a"
.p2align 6
.amdhsa_kernel adaLN_cond__gqa_block_cached__moe_arch_mod__prompt_kernel
  .amdhsa_next_free_vgpr 512
  .amdhsa_next_free_sgpr 102
  .amdhsa_accum_offset 256
  .amdhsa_group_segment_fixed_size 0
  .amdhsa_kernarg_size 120
  .amdhsa_user_sgpr_count 2
  .amdhsa_user_sgpr_kernarg_segment_ptr 1
  .amdhsa_system_sgpr_workgroup_id_x 1
  .amdhsa_float_denorm_mode_32 3
.end_amdhsa_kernel
```

```asm
; @launch grid=(256,1,1) block=(256,1,1) lds=163840
.amdgcn_target "amdgcn-amd-amdhsa--gfx950"
.text
.globl adaLN_cond__gqa_block_cached__moe_arch_mod__prompt_kernel
.p2align 8
.type adaLN_cond__gqa_block_cached__moe_arch_mod__prompt_kernel,@function
adaLN_cond__gqa_block_cached__moe_arch_mod__prompt_kernel:
    s_cmp_ge_u32 s2, 256
    s_cbranch_scc1 Lattn_end
    s_load_dwordx2 s[8:9], s[0:1], 80
    s_load_dwordx2 s[12:13], s[0:1], 88
    s_load_dwordx2 s[20:21], s[0:1], 0
    s_load_dwordx2 s[50:51], s[0:1], 112
    s_load_dwordx8 s[52:59], s[0:1], 8
    s_load_dwordx4 s[80:83], s[0:1], 56
    s_load_dwordx2 s[84:85], s[0:1], 72
    s_load_dwordx2 s[88:89], s[0:1], 104
    s_load_dwordx2 s[28:29], s[0:1], 48
    s_getpc_b64 s[32:33]
Lattn_pc:
    s_mov_b32 s34, Lattn_end-Lattn_pc
    s_mov_b32 s35, 0x20000
    s_lshr_b32 s6, s2, 3
    s_lshl_b32 s7, s6, 6
    v_lshrrev_b32 v3, 6, v0
    v_and_b32 v1, 63, v0
    v_lshrrev_b32 v2, 2, v0
    v_lshlrev_b32 v2, 11, v2
    v_readfirstlane_b32 s3, v3
    buffer_load_dword v240, v2, s[32:35], s7 offen
    s_and_b32 s7, s2, 7
    s_lshl_b32 s4, s7, 1
    s_and_b32 s5, s6, 1
    s_add_u32 s4, s4, s5
    s_lshr_b32 s5, s2, 4
    s_lshr_b32 s38, s6, 2
    s_lshl_b32 s38, s38, 3
    s_add_u32 s38, s38, s7
    s_cmp_lt_u32 s38, 18
    s_cselect_b32 s39, 0, 2147483648
    s_lshl_b32 s38, s38, 2
    s_and_b32 s36, s6, 3
    s_add_u32 s38, s38, s36
    s_mov_b32 s14, 3981312
    s_mul_i32 s92, s6, 124416
    s_lshl_b32 s36, s7, 7
    s_add_u32 s92, s92, s36
    s_cmp_lt_u32 s7, 2
    s_cselect_b32 s36, 53, 35
    v_lshrrev_b32 v2, 2, v0
    v_min_u32 v2, s36, v2
    v_mul_u32_u24 v3, 57, v2
    v_lshrrev_b32 v3, 10, v3
    v_mul_i32_i24 v3, -123392, v3
    v_mul_u32_u24 v2, 6912, v2
    v_add_u32 v72, v2, v3
    s_mov_b32 s15, 0x20000
    s_mov_b32 s10, 1152
    s_mov_b32 s11, 0x20000
    s_mov_b32 s22, 2359296
    s_mov_b32 s23, 0x20000
    v_and_b32 v64, 0xfe, v0
    v_mul_u32_u24 v65, 3456, v64
    v_and_b32 v2, 1, v0
    v_lshl_add_u32 v65, v2, 4, v65
    s_lshl_b32 s36, s38, 5
    s_or_b32 s36, s36, s39
    v_and_b32 v4, 31, v1
    v_lshrrev_b32 v5, 5, v1
    v_cmp_gt_u32 vcc, 24, v4
    v_mov_b32 v6, 2147483648
    s_lshl_b32 s7, s5, 4
    s_add_u32 s7, s7, s4
    s_lshl_b32 s7, s7, 2
    s_add_u32 s7, s7, s3
    v_cndmask_b32 v6, v6, 0, vcc
    s_mul_i32 s49, s7, 2304
    v_lshrrev_b32 v7, 2, v4
    v_lshl_add_u32 v7, v7, 6, v6
    v_and_b32 v2, 3, v4
    v_lshl_add_u32 v7, v2, 3, v7
    v_mul_u32_u24 v2, 1152, v5
    v_add_u32 v66, v7, v2
    s_waitcnt lgkmcnt(0)
    s_load_dword s94, s[50:51], 24576
    buffer_load_dword v241, v72, s[12:15], s92 offen
    buffer_load_ushort v80, v64, s[8:11], 0 offen offset:0
    buffer_load_ushort v81, v64, s[8:11], 0 offen offset:256
    buffer_load_ushort v82, v64, s[8:11], 0 offen offset:512
    buffer_load_ushort v83, v64, s[8:11], 0 offen offset:768
    buffer_load_ushort v84, v64, s[8:11], 0 offen offset:1024
    buffer_load_dwordx4 v[88:91], v65, s[12:15], s36 offen
    s_add_u32 s36, s36, 884736
    buffer_load_dwordx4 v[92:95], v65, s[12:15], s36 offen
    s_add_u32 s36, s36, 884736
    buffer_load_dwordx4 v[96:99], v65, s[12:15], s36 offen
    s_add_u32 s36, s36, 884736
    buffer_load_dwordx4 v[100:103], v65, s[12:15], s36 offen
    s_add_u32 s36, s36, 884736
    buffer_load_dwordx4 v[104:107], v65, s[12:15], s36 offen
    s_mov_b32 s16, s56
    s_mov_b32 s17, s57
    s_mov_b32 s18, 4718592
    s_mov_b32 s19, 0x20000
    s_lshl_b32 s44, s4, 9
    s_mul_i32 s36, s5, 98304
    s_add_u32 s36, s36, 0
    v_lshrrev_b32 v2, 2, v0
    v_min_u32 v2, 47, v2
    v_lshrrev_b32 v3, 2, v2
    v_and_b32 v2, 3, v2
    v_lshl_add_u32 v2, v2, 7, s36
    v_lshl_add_u32 v71, v3, 13, v2
    s_mul_i32 s36, s5, 196608
    s_add_u32 s36, s36, 1572864
    v_lshrrev_b32 v2, 1, v0
    v_min_u32 v2, 95, v2
    v_lshrrev_b32 v3, 2, v2
    v_and_b32 v2, 3, v2
    v_lshl_add_u32 v2, v2, 7, s36
    v_lshl_add_u32 v70, v3, 13, v2
    s_add_u32 s92, s49, 65536
    v_lshl_add_u32 v7, v5, 4, v6
    v_lshl_add_u32 v67, v4, 5, v7
    v_min_u32 v4, 23, v4
    v_lshlrev_b32 v68, 4, v4
    s_mov_b32 s24, s50
    s_mov_b32 s25, s51
    s_mov_b32 s26, 10485760
    s_mov_b32 s27, 0x20000
    s_mov_b32 s90, 256
    s_mov_b32 s91, 0x20000
    s_cmp_ge_u32 s38, 36
    s_cselect_b32 s93, 1.0, 0
    s_lshl_b32 s36, s38, 7
    v_lshl_add_u32 v69, v0, 3, s36
    v_cmp_gt_u32 s[36:37], 8, v0
    v_mov_b32 v2, 2147483648
    v_mov_b32 v3, s39
    v_cndmask_b32 v2, v2, v3, s[36:37]
    v_or_b32 v69, v69, v2
    s_mul_i32 s36, s5, 3072
    s_lshl_b32 s37, s5, 11
    v_lshrrev_b32 v120, 3, v0
    v_min_u32 v120, 23, v120
    v_lshl_add_u32 v120, v120, 7, s36
    v_lshrrev_b32 v121, 4, v0
    v_lshl_add_u32 v121, v121, 7, s37
    s_lshl_b32 s42, s3, 12
    v_lshrrev_b32 v2, 4, v1
    v_and_b32 v3, 15, v1
    v_lshrrev_b32 v5, 1, v3
    v_mul_u32_u24 v5, 2304, v5
    v_lshl_add_u32 v5, v2, 5, v5
    v_and_b32 v6, 1, v3
    v_lshl_add_u32 v51, v6, 4, v5
    s_lshl_b32 s6, s5, 2
    s_add_u32 s6, s6, s3
    s_mul_i32 s46, s6, 36864
    s_add_u32 s46, s46, 65536
    s_add_u32 s43, s46, 18432
    s_mul_i32 s45, s4, 294912
    s_lshl_b32 s7, s3, 4
    v_add_u32 v4, s7, v2
    v_lshlrev_b32 v5, 1, v2
    v_xor_b32 v5, v5, v3
    v_xor_b32 v6, 8, v5
    v_lshlrev_b32 v7, 13, v4
    v_lshl_add_u32 v42, v5, 4, v7
    v_lshl_add_u32 v43, v6, 4, v7
    v_add_u32 v44, 63488, v42
    v_add_u32 v45, 95232, v43
    v_add_u32 v43, 31744, v43
    s_lshl_b32 s7, s4, 19
    s_add_u32 s8, s52, s7
    s_addc_u32 s9, s53, 0
    s_mov_b32 s10, 524288
    s_mov_b32 s11, 0x20000
    s_add_u32 s12, s54, s7
    s_addc_u32 s13, s55, 0
    s_mov_b32 s14, 524288
    s_mov_b32 s15, 0x20000
    s_add_u32 s28, s50, 10485760
    s_addc_u32 s29, s51, 0
    s_mov_b32 s30, 37748736
    s_mov_b32 s31, 0x20000
    v_lshlrev_b32 v7, 8, v4
    v_lshl_add_u32 v40, v5, 4, v7
    v_lshl_add_u32 v41, v6, 4, v7
    v_xor_b32 v224, v3, v2
    v_lshl_add_u32 v36, v224, 4, v7
    v_xor_b32 v37, 64, v36
    v_xor_b32 v38, 128, v36
    v_xor_b32 v39, 192, v36
    v_lshrrev_b32 v7, 3, v5
    v_lshl_add_u32 v7, v7, 7, v4
    v_mul_u32_u24 v7, 1152, v7
    v_and_b32 v225, 7, v5
    v_lshl_add_u32 v46, v225, 4, v7
    v_lshrrev_b32 v7, 3, v6
    v_lshl_add_u32 v7, v7, 7, v4
    v_mul_u32_u24 v7, 1152, v7
    v_and_b32 v225, 7, v6
    v_lshl_add_u32 v47, v225, 4, v7
    v_add_u32 v48, 7168, v46
    v_add_u32 v49, 10752, v47
    v_add_u32 v47, 3584, v47
    v_lshlrev_b32 v7, 8, v3
    v_lshl_add_u32 v8, v224, 4, v7
    v_xor_b32 v9, 64, v8
    v_xor_b32 v10, 128, v8
    v_xor_b32 v11, 192, v8
    v_lshrrev_b32 v5, 2, v1
    v_and_b32 v6, 7, v5
    v_lshlrev_b32 v6, 5, v6
    v_lshl_add_u32 v6, v5, 8, v6
    v_and_b32 v7, 3, v1
    v_lshl_add_u32 v12, v7, 3, v6
    v_xor_b32 v13, 32, v12
    v_xor_b32 v14, 64, v12
    v_xor_b32 v15, 96, v12
    v_xor_b32 v16, 128, v12
    v_xor_b32 v17, 160, v12
    v_xor_b32 v18, 192, v12
    v_xor_b32 v19, 224, v12
    v_add_u32 v20, 65536, v12
    v_add_u32 v21, 65536, v13
    v_add_u32 v22, 65536, v14
    v_add_u32 v23, 65536, v15
    v_add_u32 v24, 65536, v16
    v_add_u32 v25, 65536, v17
    v_add_u32 v26, 65536, v18
    v_add_u32 v27, 65536, v19
    v_add_u32 v28, 131072, v12
    v_add_u32 v29, 131072, v13
    v_add_u32 v30, 131072, v14
    v_add_u32 v31, 131072, v15
    v_add_u32 v32, 131072, v16
    v_add_u32 v33, 131072, v17
    v_add_u32 v34, 131072, v18
    v_add_u32 v35, 131072, v19
    v_mov_b32 v52, 0x3f803f80
    v_mov_b32 v53, 0x3f803f80
    v_mov_b32 v54, 0x3f803f80
    v_mov_b32 v55, 0x3f803f80
    v_and_b32 v5, 1, v1
    v_mul_u32_u24 v5, 0xaaaa, v5
    v_add_u32 v5, 0x4444, v5
    v_lshl_add_u32 v50, v5, 16, v5
    v_lshrrev_b32 v5, 1, v3
    v_mul_u32_u24 v5, 20480, v5
    v_lshl_add_u32 v5, v2, 5, v5
    v_and_b32 v6, 1, v3
    v_lshl_add_u32 v56, v6, 4, v5
    s_mul_i32 s47, s6, 327680
    s_mov_b32 s32, s82
    s_mov_b32 s33, s83
    s_mov_b32 s34, 5308416
    s_mov_b32 s35, 0x20000
    s_mov_b32 s82, 5308416
    s_mov_b32 s83, 0x20000
    s_mov_b32 s86, 5308416
    s_mov_b32 s87, 0x20000
    s_lshr_b32 s7, s2, 3
    s_mul_i32 s7, s7, 18
    s_add_u32 s7, s7, s3
    s_and_b32 s36, s2, 7
    s_mul_i32 s37, s36, 576
    s_add_u32 s37, s37, s7
    s_mul_i32 s37, s37, 1152
    s_mul_i32 s7, s7, 9216
    s_mul_i32 s36, s36, 1152
    s_add_u32 s7, s7, s36
    v_min_u32 v5, 17, v1
    v_lshl_add_u32 v57, v5, 6, s7
    v_lshl_add_u32 v62, v5, 6, s37
    s_mov_b32 s40, 0
    s_mov_b32 s41, 0
    s_mov_b32 s48, 0
    s_waitcnt vmcnt(9)
    v_lshlrev_b32 v80, 16, v80
    s_waitcnt vmcnt(8)
    v_lshlrev_b32 v81, 16, v81
    s_waitcnt vmcnt(7)
    v_lshlrev_b32 v82, 16, v82
    s_waitcnt vmcnt(6)
    v_lshlrev_b32 v83, 16, v83
    s_waitcnt vmcnt(5)
    v_lshlrev_b32 v84, 16, v84
    v_mul_f32 v144, 0xbfb8aa3b, v80
    v_mul_f32 v148, 0xbfb8aa3b, v81
    v_mul_f32 v152, 0xbfb8aa3b, v82
    v_mul_f32 v156, 0xbfb8aa3b, v83
    v_mul_f32 v160, 0xbfb8aa3b, v84
    v_min_f32 v144, 0x42fc0000, v144
    v_min_f32 v148, 0x42fc0000, v148
    v_min_f32 v152, 0x42fc0000, v152
    v_min_f32 v156, 0x42fc0000, v156
    v_min_f32 v160, 0x42fc0000, v160
    v_exp_f32 v144, v144
    v_exp_f32 v148, v148
    v_exp_f32 v152, v152
    v_exp_f32 v156, v156
    v_exp_f32 v160, v160
    v_add_f32 v144, 1.0, v144
    v_add_f32 v148, 1.0, v148
    v_add_f32 v152, 1.0, v152
    v_add_f32 v156, 1.0, v156
    v_add_f32 v160, 1.0, v160
    v_rcp_f32 v145, v144
    v_rcp_f32 v149, v148
    v_rcp_f32 v153, v152
    v_rcp_f32 v157, v156
    v_rcp_f32 v161, v160
    v_mul_f32 v146, v80, v145
    v_mul_f32 v150, v81, v149
    v_mul_f32 v154, v82, v153
    v_mul_f32 v158, v83, v157
    v_mul_f32 v162, v84, v161
    v_fma_f32 v144, -v146, v144, v80
    v_fma_f32 v148, -v150, v148, v81
    v_fma_f32 v152, -v154, v152, v82
    v_fma_f32 v156, -v158, v156, v83
    v_fma_f32 v160, -v162, v160, v84
    v_fma_f32 v80, v144, v145, v146
    v_fma_f32 v81, v148, v149, v150
    v_fma_f32 v82, v152, v153, v154
    v_fma_f32 v83, v156, v157, v158
    v_fma_f32 v84, v160, v161, v162
    v_cvt_pk_bf16_f32 v80, v80, v80
    v_cvt_pk_bf16_f32 v81, v81, v81
    v_cvt_pk_bf16_f32 v82, v82, v82
    v_cvt_pk_bf16_f32 v83, v83, v83
    v_cvt_pk_bf16_f32 v84, v84, v84
    v_and_b32 v80, 0xffff0000, v80
    v_and_b32 v81, 0xffff0000, v81
    v_and_b32 v82, 0xffff0000, v82
    v_and_b32 v83, 0xffff0000, v83
    v_and_b32 v84, 0xffff0000, v84
    buffer_load_dwordx2 v[108:109], v66, s[20:23], s49 offen offset:0
    buffer_load_dwordx2 v[110:111], v66, s[20:23], s49 offen offset:32
    buffer_load_dwordx2 v[112:113], v66, s[20:23], s49 offen offset:384
    buffer_load_dwordx2 v[114:115], v66, s[20:23], s49 offen offset:416
    buffer_load_dwordx2 v[116:117], v66, s[20:23], s49 offen offset:768
    buffer_load_dwordx2 v[118:119], v66, s[20:23], s49 offen offset:800
    s_mov_b32 s20, s58
    s_mov_b32 s21, s59
    s_mov_b32 s22, 4718592
    s_mov_b32 s23, 0x20000
    buffer_load_dword v242, v71, s[16:19], s44 offen
    s_waitcnt vmcnt(11)
    v_lshlrev_b32 v136, 16, v88
    v_and_b32 v137, 0xffff0000, v88
    v_lshlrev_b32 v138, 16, v89
    v_and_b32 v139, 0xffff0000, v89
    v_lshlrev_b32 v140, 16, v90
    v_and_b32 v141, 0xffff0000, v90
    v_lshlrev_b32 v142, 16, v91
    v_and_b32 v143, 0xffff0000, v91
    v_pk_mul_f32 v[128:129], v[136:137], v[80:81] op_sel:[0,0] op_sel_hi:[1,0]
    v_pk_mul_f32 v[130:131], v[138:139], v[80:81] op_sel:[0,0] op_sel_hi:[1,0]
    v_pk_mul_f32 v[132:133], v[140:141], v[80:81] op_sel:[0,0] op_sel_hi:[1,0]
    v_pk_mul_f32 v[134:135], v[142:143], v[80:81] op_sel:[0,0] op_sel_hi:[1,0]
    s_waitcnt vmcnt(10)
    v_lshlrev_b32 v136, 16, v92
    v_and_b32 v137, 0xffff0000, v92
    v_lshlrev_b32 v138, 16, v93
    v_and_b32 v139, 0xffff0000, v93
    v_lshlrev_b32 v140, 16, v94
    v_and_b32 v141, 0xffff0000, v94
    v_lshlrev_b32 v142, 16, v95
    v_and_b32 v143, 0xffff0000, v95
    v_pk_fma_f32 v[128:129], v[136:137], v[80:81], v[128:129] op_sel:[0,1,0] op_sel_hi:[1,1,1]
    v_pk_fma_f32 v[130:131], v[138:139], v[80:81], v[130:131] op_sel:[0,1,0] op_sel_hi:[1,1,1]
    v_pk_fma_f32 v[132:133], v[140:141], v[80:81], v[132:133] op_sel:[0,1,0] op_sel_hi:[1,1,1]
    v_pk_fma_f32 v[134:135], v[142:143], v[80:81], v[134:135] op_sel:[0,1,0] op_sel_hi:[1,1,1]
    s_waitcnt vmcnt(9)
    v_lshlrev_b32 v136, 16, v96
    v_and_b32 v137, 0xffff0000, v96
    v_lshlrev_b32 v138, 16, v97
    v_and_b32 v139, 0xffff0000, v97
    v_lshlrev_b32 v140, 16, v98
    v_and_b32 v141, 0xffff0000, v98
    v_lshlrev_b32 v142, 16, v99
    v_and_b32 v143, 0xffff0000, v99
    v_pk_fma_f32 v[128:129], v[136:137], v[82:83], v[128:129] op_sel:[0,0,0] op_sel_hi:[1,0,1]
    v_pk_fma_f32 v[130:131], v[138:139], v[82:83], v[130:131] op_sel:[0,0,0] op_sel_hi:[1,0,1]
    v_pk_fma_f32 v[132:133], v[140:141], v[82:83], v[132:133] op_sel:[0,0,0] op_sel_hi:[1,0,1]
    v_pk_fma_f32 v[134:135], v[142:143], v[82:83], v[134:135] op_sel:[0,0,0] op_sel_hi:[1,0,1]
    s_waitcnt vmcnt(8)
    v_lshlrev_b32 v136, 16, v100
    v_and_b32 v137, 0xffff0000, v100
    v_lshlrev_b32 v138, 16, v101
    v_and_b32 v139, 0xffff0000, v101
    v_lshlrev_b32 v140, 16, v102
    v_and_b32 v141, 0xffff0000, v102
    v_lshlrev_b32 v142, 16, v103
    v_and_b32 v143, 0xffff0000, v103
    v_pk_fma_f32 v[128:129], v[136:137], v[82:83], v[128:129] op_sel:[0,1,0] op_sel_hi:[1,1,1]
    v_pk_fma_f32 v[130:131], v[138:139], v[82:83], v[130:131] op_sel:[0,1,0] op_sel_hi:[1,1,1]
    v_pk_fma_f32 v[132:133], v[140:141], v[82:83], v[132:133] op_sel:[0,1,0] op_sel_hi:[1,1,1]
    v_pk_fma_f32 v[134:135], v[142:143], v[82:83], v[134:135] op_sel:[0,1,0] op_sel_hi:[1,1,1]
    s_waitcnt vmcnt(7)
    v_lshlrev_b32 v136, 16, v104
    v_and_b32 v137, 0xffff0000, v104
    v_lshlrev_b32 v138, 16, v105
    v_and_b32 v139, 0xffff0000, v105
    v_lshlrev_b32 v140, 16, v106
    v_and_b32 v141, 0xffff0000, v106
    v_lshlrev_b32 v142, 16, v107
    v_and_b32 v143, 0xffff0000, v107
    v_pk_fma_f32 v[128:129], v[136:137], v[84:85], v[128:129] op_sel:[0,0,0] op_sel_hi:[1,0,1]
    v_pk_fma_f32 v[130:131], v[138:139], v[84:85], v[130:131] op_sel:[0,0,0] op_sel_hi:[1,0,1]
    v_pk_fma_f32 v[132:133], v[140:141], v[84:85], v[132:133] op_sel:[0,0,0] op_sel_hi:[1,0,1]
    v_pk_fma_f32 v[134:135], v[142:143], v[84:85], v[134:135] op_sel:[0,0,0] op_sel_hi:[1,0,1]
    s_nop 0
    v_permlane32_swap_b32 v128, v132
    v_permlane32_swap_b32 v129, v133
    v_permlane32_swap_b32 v130, v134
    v_permlane32_swap_b32 v131, v135
    v_and_b32 v72, 1, v1
    v_pk_add_f32 v[128:129], v[128:129], v[132:133]
    v_pk_add_f32 v[130:131], v[130:131], v[134:135]
    v_lshlrev_b32 v72, 5, v72
    v_lshrrev_b32 v73, 4, v1
    v_permlane16_swap_b32 v128, v130
    v_permlane16_swap_b32 v129, v131
    v_lshl_add_u32 v72, v73, 3, v72
    v_pk_add_f32 v[128:129], v[128:129], v[130:131]
    s_lshl_b32 s36, s3, 6
    v_add_u32 v72, s36, v72
    v_add_f32_dpp v128, v128, v128 row_ror:2 row_mask:0xf bank_mask:0xf
    v_add_f32_dpp v129, v129, v129 row_ror:2 row_mask:0xf bank_mask:0xf
    s_nop 0
    v_add_f32_dpp v128, v128, v128 row_ror:4 row_mask:0xf bank_mask:0xf
    v_add_f32_dpp v129, v129, v129 row_ror:4 row_mask:0xf bank_mask:0xf
    s_nop 0
    v_add_f32_dpp v128, v128, v128 row_ror:8 row_mask:0xf bank_mask:0xf
    v_add_f32_dpp v129, v129, v129 row_ror:8 row_mask:0xf bank_mask:0xf
    ds_write_b64 v72, v[128:129] offset:0
    v_and_b32 v73, 7, v1
    v_lshlrev_b32 v73, 3, v73
    s_waitcnt lgkmcnt(0)
    s_barrier
    ds_read_b64 v[128:129], v73 offset:0
    ds_read_b64 v[130:131], v73 offset:64
    ds_read_b64 v[132:133], v73 offset:128
    ds_read_b64 v[134:135], v73 offset:192
    s_add_u32 s95, s94, 0x9e3779b9
    v_mov_b32 v137, s95
    s_mov_b32 s37, 32768
    s_waitcnt lgkmcnt(2)
    v_pk_add_f32 v[128:129], v[128:129], v[130:131]
    s_waitcnt lgkmcnt(0)
    v_pk_add_f32 v[132:133], v[132:133], v[134:135]
    v_pk_add_f32 v[128:129], v[128:129], v[132:133]
    v_cvt_pk_bf16_f32 v136, v128, v129
    v_lshlrev_b32 v128, 16, v136
    v_and_b32 v129, 0xffff0000, v136
    v_add_f32 v128, s93, v128
    v_add_f32 v129, s93, v129
    v_cvt_pk_bf16_f32 v136, v128, v129
    buffer_store_dwordx2 v[136:137], v69, s[24:27], s37 offen sc1
    s_lshl_b32 s36, s5, 13
    s_add_u32 s36, s36, 8650752
    s_lshl_b32 s38, s4, 9
    s_add_u32 s38, s38, s36
    s_lshl_b32 s36, s3, 7
    s_add_u32 s38, s38, s36
    v_min_u32 v2, 1, v1
    v_lshlrev_b32 v2, 31, v2
    buffer_store_dword v2, v2, s[24:27], s38 offen offset:4 sc1
    s_waitcnt vmcnt(8)
    v_lshlrev_b32 v144, 16, v108
    v_and_b32 v145, 0xffff0000, v108
    v_lshlrev_b32 v146, 16, v109
    v_and_b32 v147, 0xffff0000, v109
    s_waitcnt vmcnt(7)
    v_lshlrev_b32 v148, 16, v110
    v_and_b32 v149, 0xffff0000, v110
    v_lshlrev_b32 v150, 16, v111
    v_and_b32 v151, 0xffff0000, v111
    s_waitcnt vmcnt(6)
    v_lshlrev_b32 v152, 16, v112
    v_and_b32 v153, 0xffff0000, v112
    v_lshlrev_b32 v154, 16, v113
    v_and_b32 v155, 0xffff0000, v113
    s_waitcnt vmcnt(5)
    v_lshlrev_b32 v156, 16, v114
    v_and_b32 v157, 0xffff0000, v114
    v_lshlrev_b32 v158, 16, v115
    v_and_b32 v159, 0xffff0000, v115
    s_waitcnt vmcnt(4)
    v_lshlrev_b32 v160, 16, v116
    v_and_b32 v161, 0xffff0000, v116
    v_lshlrev_b32 v162, 16, v117
    v_and_b32 v163, 0xffff0000, v117
    s_waitcnt vmcnt(3)
    v_lshlrev_b32 v164, 16, v118
    v_and_b32 v165, 0xffff0000, v118
    v_lshlrev_b32 v166, 16, v119
    v_and_b32 v167, 0xffff0000, v119
    v_pk_add_f32 v[72:73], v[144:145], v[148:149]
    v_pk_add_f32 v[76:77], v[146:147], v[150:151]
    v_pk_add_f32 v[72:73], v[72:73], v[152:153]
    v_pk_add_f32 v[76:77], v[76:77], v[154:155]
    v_pk_add_f32 v[72:73], v[72:73], v[156:157]
    v_pk_add_f32 v[76:77], v[76:77], v[158:159]
    v_pk_add_f32 v[72:73], v[72:73], v[160:161]
    v_pk_add_f32 v[76:77], v[76:77], v[162:163]
    v_pk_add_f32 v[72:73], v[72:73], v[164:165]
    v_pk_add_f32 v[76:77], v[76:77], v[166:167]
    v_pk_add_f32 v[72:73], v[72:73], v[76:77]
    v_add_f32 v72, v72, v73
    s_nop 1
    v_add_f32_dpp v72, v72, v72 row_ror:1 row_mask:0xf bank_mask:0xf
    s_nop 1
    v_add_f32_dpp v72, v72, v72 row_ror:2 row_mask:0xf bank_mask:0xf
    s_nop 1
    v_add_f32_dpp v72, v72, v72 row_ror:4 row_mask:0xf bank_mask:0xf
    s_nop 1
    v_add_f32_dpp v72, v72, v72 row_ror:8 row_mask:0xf bank_mask:0xf
    v_mov_b32 v76, v72
    s_nop 1
    v_permlane16_swap_b32 v72, v76
    s_nop 0
    v_add_f32 v72, v72, v76
    v_mul_f32 v72, 0x3ae38e39, v72
    v_pk_add_f32 v[168:169], v[144:145], v[72:73] op_sel_hi:[1,0] neg_lo:[0,1] neg_hi:[0,1]
    v_pk_add_f32 v[170:171], v[146:147], v[72:73] op_sel_hi:[1,0] neg_lo:[0,1] neg_hi:[0,1]
    v_pk_add_f32 v[172:173], v[148:149], v[72:73] op_sel_hi:[1,0] neg_lo:[0,1] neg_hi:[0,1]
    v_pk_add_f32 v[174:175], v[150:151], v[72:73] op_sel_hi:[1,0] neg_lo:[0,1] neg_hi:[0,1]
    v_pk_add_f32 v[176:177], v[152:153], v[72:73] op_sel_hi:[1,0] neg_lo:[0,1] neg_hi:[0,1]
    v_pk_add_f32 v[178:179], v[154:155], v[72:73] op_sel_hi:[1,0] neg_lo:[0,1] neg_hi:[0,1]
    v_pk_add_f32 v[180:181], v[156:157], v[72:73] op_sel_hi:[1,0] neg_lo:[0,1] neg_hi:[0,1]
    v_pk_add_f32 v[182:183], v[158:159], v[72:73] op_sel_hi:[1,0] neg_lo:[0,1] neg_hi:[0,1]
    v_pk_add_f32 v[184:185], v[160:161], v[72:73] op_sel_hi:[1,0] neg_lo:[0,1] neg_hi:[0,1]
    v_pk_add_f32 v[186:187], v[162:163], v[72:73] op_sel_hi:[1,0] neg_lo:[0,1] neg_hi:[0,1]
    v_pk_add_f32 v[188:189], v[164:165], v[72:73] op_sel_hi:[1,0] neg_lo:[0,1] neg_hi:[0,1]
    v_pk_add_f32 v[190:191], v[166:167], v[72:73] op_sel_hi:[1,0] neg_lo:[0,1] neg_hi:[0,1]
    v_pk_mul_f32 v[74:75], v[168:169], v[168:169]
    v_pk_mul_f32 v[76:77], v[170:171], v[170:171]
    v_pk_fma_f32 v[74:75], v[172:173], v[172:173], v[74:75]
    v_pk_fma_f32 v[76:77], v[174:175], v[174:175], v[76:77]
    v_pk_fma_f32 v[74:75], v[176:177], v[176:177], v[74:75]
    v_pk_fma_f32 v[76:77], v[178:179], v[178:179], v[76:77]
    v_pk_fma_f32 v[74:75], v[180:181], v[180:181], v[74:75]
    v_pk_fma_f32 v[76:77], v[182:183], v[182:183], v[76:77]
    v_pk_fma_f32 v[74:75], v[184:185], v[184:185], v[74:75]
    v_pk_fma_f32 v[76:77], v[186:187], v[186:187], v[76:77]
    v_pk_fma_f32 v[74:75], v[188:189], v[188:189], v[74:75]
    v_pk_fma_f32 v[76:77], v[190:191], v[190:191], v[76:77]
    v_pk_add_f32 v[74:75], v[74:75], v[76:77]
    v_add_f32 v74, v74, v75
    v_cndmask_b32 v74, 0, v74, vcc
    s_nop 1
    v_add_f32_dpp v74, v74, v74 row_ror:1 row_mask:0xf bank_mask:0xf
    s_nop 1
    v_add_f32_dpp v74, v74, v74 row_ror:2 row_mask:0xf bank_mask:0xf
    s_nop 1
    v_add_f32_dpp v74, v74, v74 row_ror:4 row_mask:0xf bank_mask:0xf
    s_nop 1
    v_add_f32_dpp v74, v74, v74 row_ror:8 row_mask:0xf bank_mask:0xf
    v_mov_b32 v76, v74
    s_nop 1
    v_permlane16_swap_b32 v74, v76
    s_nop 0
    v_add_f32 v74, v74, v76
    v_mul_f32 v74, 0x3ae38e39, v74
    v_cvt_pk_bf16_f32 v76, v72, v74
    v_and_b32 v74, 0xffff0000, v76
    v_lshlrev_b32 v72, 16, v76
    v_add_f32 v74, 0x3727c5ac, v74
    v_cvt_pk_bf16_f32 v74, v74, v74
    v_and_b32 v74, 0xffff0000, v74
    v_sqrt_f32 v74, v74
    v_pk_add_f32 v[168:169], v[144:145], v[72:73] op_sel_hi:[1,0] neg_lo:[0,1] neg_hi:[0,1]
    v_pk_add_f32 v[170:171], v[146:147], v[72:73] op_sel_hi:[1,0] neg_lo:[0,1] neg_hi:[0,1]
    v_pk_add_f32 v[172:173], v[148:149], v[72:73] op_sel_hi:[1,0] neg_lo:[0,1] neg_hi:[0,1]
    v_pk_add_f32 v[174:175], v[150:151], v[72:73] op_sel_hi:[1,0] neg_lo:[0,1] neg_hi:[0,1]
    v_pk_add_f32 v[176:177], v[152:153], v[72:73] op_sel_hi:[1,0] neg_lo:[0,1] neg_hi:[0,1]
    v_pk_add_f32 v[178:179], v[154:155], v[72:73] op_sel_hi:[1,0] neg_lo:[0,1] neg_hi:[0,1]
    v_pk_add_f32 v[180:181], v[156:157], v[72:73] op_sel_hi:[1,0] neg_lo:[0,1] neg_hi:[0,1]
    v_pk_add_f32 v[182:183], v[158:159], v[72:73] op_sel_hi:[1,0] neg_lo:[0,1] neg_hi:[0,1]
    v_pk_add_f32 v[184:185], v[160:161], v[72:73] op_sel_hi:[1,0] neg_lo:[0,1] neg_hi:[0,1]
    v_pk_add_f32 v[186:187], v[162:163], v[72:73] op_sel_hi:[1,0] neg_lo:[0,1] neg_hi:[0,1]
    v_pk_add_f32 v[188:189], v[164:165], v[72:73] op_sel_hi:[1,0] neg_lo:[0,1] neg_hi:[0,1]
    v_pk_add_f32 v[190:191], v[166:167], v[72:73] op_sel_hi:[1,0] neg_lo:[0,1] neg_hi:[0,1]
    v_cvt_pk_bf16_f32 v74, v74, v74
    v_and_b32 v74, 0xffff0000, v74
    v_rcp_f32 v74, v74
    v_cvt_pk_bf16_f32 v108, v168, v169
    v_cvt_pk_bf16_f32 v109, v170, v171
    v_cvt_pk_bf16_f32 v110, v172, v173
    v_cvt_pk_bf16_f32 v111, v174, v175
    v_cvt_pk_bf16_f32 v112, v176, v177
    v_cvt_pk_bf16_f32 v113, v178, v179
    v_cvt_pk_bf16_f32 v114, v180, v181
    v_cvt_pk_bf16_f32 v115, v182, v183
    v_cvt_pk_bf16_f32 v116, v184, v185
    v_cvt_pk_bf16_f32 v117, v186, v187
    v_cvt_pk_bf16_f32 v118, v188, v189
    v_cvt_pk_bf16_f32 v119, v190, v191
    v_lshlrev_b32 v168, 16, v108
    v_and_b32 v169, 0xffff0000, v108
    v_lshlrev_b32 v170, 16, v109
    v_and_b32 v171, 0xffff0000, v109
    v_lshlrev_b32 v172, 16, v110
    v_and_b32 v173, 0xffff0000, v110
    v_lshlrev_b32 v174, 16, v111
    v_and_b32 v175, 0xffff0000, v111
    v_lshlrev_b32 v176, 16, v112
    v_and_b32 v177, 0xffff0000, v112
    v_lshlrev_b32 v178, 16, v113
    v_and_b32 v179, 0xffff0000, v113
    v_lshlrev_b32 v180, 16, v114
    v_and_b32 v181, 0xffff0000, v114
    v_lshlrev_b32 v182, 16, v115
    v_and_b32 v183, 0xffff0000, v115
    v_lshlrev_b32 v184, 16, v116
    v_and_b32 v185, 0xffff0000, v116
    v_lshlrev_b32 v186, 16, v117
    v_and_b32 v187, 0xffff0000, v117
    v_lshlrev_b32 v188, 16, v118
    v_and_b32 v189, 0xffff0000, v118
    v_lshlrev_b32 v190, 16, v119
    v_and_b32 v191, 0xffff0000, v119
    v_pk_mul_f32 v[168:169], v[168:169], v[74:75] op_sel_hi:[1,0]
    v_pk_mul_f32 v[170:171], v[170:171], v[74:75] op_sel_hi:[1,0]
    v_pk_mul_f32 v[172:173], v[172:173], v[74:75] op_sel_hi:[1,0]
    v_pk_mul_f32 v[174:175], v[174:175], v[74:75] op_sel_hi:[1,0]
    v_pk_mul_f32 v[176:177], v[176:177], v[74:75] op_sel_hi:[1,0]
    v_pk_mul_f32 v[178:179], v[178:179], v[74:75] op_sel_hi:[1,0]
    v_pk_mul_f32 v[180:181], v[180:181], v[74:75] op_sel_hi:[1,0]
    v_pk_mul_f32 v[182:183], v[182:183], v[74:75] op_sel_hi:[1,0]
    v_pk_mul_f32 v[184:185], v[184:185], v[74:75] op_sel_hi:[1,0]
    v_pk_mul_f32 v[186:187], v[186:187], v[74:75] op_sel_hi:[1,0]
    v_pk_mul_f32 v[188:189], v[188:189], v[74:75] op_sel_hi:[1,0]
    v_pk_mul_f32 v[190:191], v[190:191], v[74:75] op_sel_hi:[1,0]
    v_cvt_pk_bf16_f32 v108, v168, v169
    v_cvt_pk_bf16_f32 v109, v170, v171
    v_cvt_pk_bf16_f32 v110, v172, v173
    v_cvt_pk_bf16_f32 v111, v174, v175
    v_cvt_pk_bf16_f32 v112, v176, v177
    v_cvt_pk_bf16_f32 v113, v178, v179
    v_cvt_pk_bf16_f32 v114, v180, v181
    v_cvt_pk_bf16_f32 v115, v182, v183
    v_cvt_pk_bf16_f32 v116, v184, v185
    v_cvt_pk_bf16_f32 v117, v186, v187
    v_cvt_pk_bf16_f32 v118, v188, v189
    v_cvt_pk_bf16_f32 v119, v190, v191
    v_lshlrev_b32 v168, 16, v108
    v_and_b32 v169, 0xffff0000, v108
    v_lshlrev_b32 v170, 16, v109
    v_and_b32 v171, 0xffff0000, v109
    v_lshlrev_b32 v172, 16, v110
    v_and_b32 v173, 0xffff0000, v110
    v_lshlrev_b32 v174, 16, v111
    v_and_b32 v175, 0xffff0000, v111
    v_lshlrev_b32 v176, 16, v112
    v_and_b32 v177, 0xffff0000, v112
    v_lshlrev_b32 v178, 16, v113
    v_and_b32 v179, 0xffff0000, v113
    v_lshlrev_b32 v180, 16, v114
    v_and_b32 v181, 0xffff0000, v114
    v_lshlrev_b32 v182, 16, v115
    v_and_b32 v183, 0xffff0000, v115
    v_lshlrev_b32 v184, 16, v116
    v_and_b32 v185, 0xffff0000, v116
    v_lshlrev_b32 v186, 16, v117
    v_and_b32 v187, 0xffff0000, v117
    v_lshlrev_b32 v188, 16, v118
    v_and_b32 v189, 0xffff0000, v118
    v_lshlrev_b32 v190, 16, v119
    v_and_b32 v191, 0xffff0000, v119
    s_mul_i32 s36, s3, 72
    v_add_u32 v72, s36, v1
    v_and_b32 v73, 7, v1
    s_add_u32 s36, s36, 64
    v_add_u32 v73, s36, v73
    s_movk_i32 s36, 1024
    v_and_b32 v76, 3, v72
    v_lshlrev_b32 v76, 4, v76
    v_lshrrev_b32 v72, 2, v72
    v_lshl_add_u32 v74, v72, 7, v76
    v_and_b32 v77, 1, v72
    v_lshl_add_u32 v76, v77, 3, v76
    v_lshrrev_b32 v72, 1, v72
    v_lshl_add_u32 v72, v72, 6, v76
    v_add_u32 v72, s36, v72
    v_and_b32 v76, 3, v73
    v_lshlrev_b32 v76, 4, v76
    v_lshrrev_b32 v73, 2, v73
    v_lshl_add_u32 v75, v73, 7, v76
    v_and_b32 v77, 1, v73
    v_lshl_add_u32 v76, v77, 3, v76
    v_lshrrev_b32 v73, 1, v73
    v_lshl_add_u32 v73, v73, 6, v76
    v_add_u32 v73, s36, v73
    s_mov_b64 exec, 0
    s_cmp_eq_u32 s3, 0
    s_cbranch_scc1 Ltour0
    s_cmp_eq_u32 s3, 1
    s_cbranch_scc1 Ltour1
    s_cmp_eq_u32 s3, 2
    s_cbranch_scc1 Ltour2
    s_branch Ltour3
.p2align 12
Lmain:
    s_mov_b64 exec, -1
    s_mov_b32 s38, 16384
Lhead_pollm:
    buffer_load_dwordx4 v[88:91], v74, s[24:27], s37 offen sc1
    buffer_load_dwordx4 v[92:95], v75, s[24:27], s37 offen sc1
    s_sub_u32 s38, s38, 1
    s_cbranch_scc1 Lhead_gotm
    s_waitcnt vmcnt(0) lgkmcnt(0)
    v_xor_b32 v89, s95, v89
    v_xor_b32 v91, s95, v91
    v_xor_b32 v93, s95, v93
    v_xor_b32 v95, s95, v95
    v_or3_b32 v89, v89, v91, v93
    v_or_b32 v89, v89, v95
    v_cmp_ne_u32 vcc, 0, v89
    s_cbranch_vccnz Lhead_pollm
Lhead_gotm:
    s_waitcnt vmcnt(0) lgkmcnt(0)
    ds_write2_b32 v72, v88, v90 offset0:0 offset1:1
    ds_write2_b32 v73, v92, v94 offset0:0 offset1:1
    s_waitcnt lgkmcnt(0)
    s_barrier
    ds_read_b128 v[144:147], v68 offset:2176
    ds_read_b128 v[148:151], v68 offset:2560
    ds_read_b128 v[152:155], v68 offset:2944
    ds_read_b128 v[156:159], v68 offset:1024
    ds_read_b128 v[160:163], v68 offset:1408
    ds_read_b128 v[164:167], v68 offset:1792
    s_waitcnt lgkmcnt(5)
    v_lshlrev_b32 v192, 16, v144
    v_and_b32 v193, 0xffff0000, v144
    v_lshlrev_b32 v194, 16, v145
    v_and_b32 v195, 0xffff0000, v145
    v_lshlrev_b32 v196, 16, v146
    v_and_b32 v197, 0xffff0000, v146
    v_lshlrev_b32 v198, 16, v147
    v_and_b32 v199, 0xffff0000, v147
    s_waitcnt lgkmcnt(4)
    v_lshlrev_b32 v200, 16, v148
    v_and_b32 v201, 0xffff0000, v148
    v_lshlrev_b32 v202, 16, v149
    v_and_b32 v203, 0xffff0000, v149
    v_lshlrev_b32 v204, 16, v150
    v_and_b32 v205, 0xffff0000, v150
    v_lshlrev_b32 v206, 16, v151
    v_and_b32 v207, 0xffff0000, v151
    s_waitcnt lgkmcnt(3)
    v_lshlrev_b32 v208, 16, v152
    v_and_b32 v209, 0xffff0000, v152
    v_lshlrev_b32 v210, 16, v153
    v_and_b32 v211, 0xffff0000, v153
    v_lshlrev_b32 v212, 16, v154
    v_and_b32 v213, 0xffff0000, v154
    v_lshlrev_b32 v214, 16, v155
    v_and_b32 v215, 0xffff0000, v155
    v_pk_mul_f32 v[168:169], v[168:169], v[192:193]
    v_pk_mul_f32 v[170:171], v[170:171], v[194:195]
    v_pk_mul_f32 v[172:173], v[172:173], v[196:197]
    v_pk_mul_f32 v[174:175], v[174:175], v[198:199]
    v_pk_mul_f32 v[176:177], v[176:177], v[200:201]
    v_pk_mul_f32 v[178:179], v[178:179], v[202:203]
    v_pk_mul_f32 v[180:181], v[180:181], v[204:205]
    v_pk_mul_f32 v[182:183], v[182:183], v[206:207]
    v_pk_mul_f32 v[184:185], v[184:185], v[208:209]
    v_pk_mul_f32 v[186:187], v[186:187], v[210:211]
    v_pk_mul_f32 v[188:189], v[188:189], v[212:213]
    v_pk_mul_f32 v[190:191], v[190:191], v[214:215]
    v_cvt_pk_bf16_f32 v108, v168, v169
    v_cvt_pk_bf16_f32 v109, v170, v171
    v_cvt_pk_bf16_f32 v110, v172, v173
    v_cvt_pk_bf16_f32 v111, v174, v175
    v_cvt_pk_bf16_f32 v112, v176, v177
    v_cvt_pk_bf16_f32 v113, v178, v179
    v_cvt_pk_bf16_f32 v114, v180, v181
    v_cvt_pk_bf16_f32 v115, v182, v183
    v_cvt_pk_bf16_f32 v116, v184, v185
    v_cvt_pk_bf16_f32 v117, v186, v187
    v_cvt_pk_bf16_f32 v118, v188, v189
    v_cvt_pk_bf16_f32 v119, v190, v191
    s_waitcnt lgkmcnt(2)
    v_lshlrev_b32 v216, 16, v156
    v_and_b32 v217, 0xffff0000, v156
    v_lshlrev_b32 v218, 16, v157
    v_and_b32 v219, 0xffff0000, v157
    v_lshlrev_b32 v220, 16, v158
    v_and_b32 v221, 0xffff0000, v158
    v_lshlrev_b32 v222, 16, v159
    v_and_b32 v223, 0xffff0000, v159
    s_waitcnt lgkmcnt(1)
    v_lshlrev_b32 v224, 16, v160
    v_and_b32 v225, 0xffff0000, v160
    v_lshlrev_b32 v226, 16, v161
    v_and_b32 v227, 0xffff0000, v161
    v_lshlrev_b32 v228, 16, v162
    v_and_b32 v229, 0xffff0000, v162
    v_lshlrev_b32 v230, 16, v163
    v_and_b32 v231, 0xffff0000, v163
    s_waitcnt lgkmcnt(0)
    v_lshlrev_b32 v232, 16, v164
    v_and_b32 v233, 0xffff0000, v164
    v_lshlrev_b32 v234, 16, v165
    v_and_b32 v235, 0xffff0000, v165
    v_lshlrev_b32 v236, 16, v166
    v_and_b32 v237, 0xffff0000, v166
    v_lshlrev_b32 v238, 16, v167
    v_and_b32 v239, 0xffff0000, v167
    v_lshlrev_b32 v168, 16, v108
    v_and_b32 v169, 0xffff0000, v108
    v_lshlrev_b32 v170, 16, v109
    v_and_b32 v171, 0xffff0000, v109
    v_lshlrev_b32 v172, 16, v110
    v_and_b32 v173, 0xffff0000, v110
    v_lshlrev_b32 v174, 16, v111
    v_and_b32 v175, 0xffff0000, v111
    v_lshlrev_b32 v176, 16, v112
    v_and_b32 v177, 0xffff0000, v112
    v_lshlrev_b32 v178, 16, v113
    v_and_b32 v179, 0xffff0000, v113
    v_lshlrev_b32 v180, 16, v114
    v_and_b32 v181, 0xffff0000, v114
    v_lshlrev_b32 v182, 16, v115
    v_and_b32 v183, 0xffff0000, v115
    v_lshlrev_b32 v184, 16, v116
    v_and_b32 v185, 0xffff0000, v116
    v_lshlrev_b32 v186, 16, v117
    v_and_b32 v187, 0xffff0000, v117
    v_lshlrev_b32 v188, 16, v118
    v_and_b32 v189, 0xffff0000, v118
    v_lshlrev_b32 v190, 16, v119
    v_and_b32 v191, 0xffff0000, v119
    v_pk_add_f32 v[168:169], v[168:169], v[216:217]
    v_pk_add_f32 v[170:171], v[170:171], v[218:219]
    v_pk_add_f32 v[172:173], v[172:173], v[220:221]
    v_pk_add_f32 v[174:175], v[174:175], v[222:223]
    v_cvt_pk_bf16_f32 v108, v168, v169
    v_cvt_pk_bf16_f32 v109, v170, v171
    v_cvt_pk_bf16_f32 v110, v172, v173
    v_cvt_pk_bf16_f32 v111, v174, v175
    buffer_store_dwordx4 v[108:111], v67, s[24:27], s92 offen offset:0 sc1
    v_pk_add_f32 v[176:177], v[176:177], v[224:225]
    v_pk_add_f32 v[178:179], v[178:179], v[226:227]
    v_pk_add_f32 v[180:181], v[180:181], v[228:229]
    v_pk_add_f32 v[182:183], v[182:183], v[230:231]
    v_cvt_pk_bf16_f32 v112, v176, v177
    v_cvt_pk_bf16_f32 v113, v178, v179
    v_cvt_pk_bf16_f32 v114, v180, v181
    v_cvt_pk_bf16_f32 v115, v182, v183
    buffer_store_dwordx4 v[112:115], v67, s[24:27], s92 offen offset:768 sc1
    v_pk_add_f32 v[184:185], v[184:185], v[232:233]
    v_pk_add_f32 v[186:187], v[186:187], v[234:235]
    v_pk_add_f32 v[188:189], v[188:189], v[236:237]
    v_pk_add_f32 v[190:191], v[190:191], v[238:239]
    v_cvt_pk_bf16_f32 v116, v184, v185
    v_cvt_pk_bf16_f32 v117, v186, v187
    v_cvt_pk_bf16_f32 v118, v188, v189
    v_cvt_pk_bf16_f32 v119, v190, v191
    buffer_store_dwordx4 v[116:119], v67, s[24:27], s92 offen offset:1536 sc1
    s_lshl_b32 s36, s5, 13
    s_add_u32 s36, s36, 8650752
    s_lshl_b32 s37, s4, 9
    s_add_u32 s37, s37, s36
    s_lshl_b32 s38, s3, 7
    s_add_u32 s37, s37, s38
    s_lshl_b32 s38, s3, 11
    s_add_u32 s36, s36, s38
    v_min_u32 v72, 1, v1
    v_lshlrev_b32 v72, 31, v72
    v_and_b32 v73, 15, v1
    v_lshlrev_b32 v73, 7, v73
    v_cmp_gt_u32 vcc, 162, v0
    v_mov_b32 v88, -1
    v_mov_b32 v89, -1
    v_mov_b32 v90, -1
    v_mov_b32 v91, -1
    s_mul_i32 s39, s2, 2592
    s_add_u32 s39, s39, 7864320
    v_lshl_add_u32 v74, v0, 4, s39
    s_lshl_b32 s39, s2, 7
    s_add_u32 s39, s39, 9306112
    v_mov_b32 v75, s39
    v_cndmask_b32 v74, v75, v74, vcc
    s_lshl_b32 s92, s5, 13
    s_add_u32 s92, s92, 8781824
    s_add_u32 s92, s92, s38
    s_lshl_b32 s38, s4, 7
    s_add_u32 s92, s92, s38
    s_getreg_b32 s38, hwreg(HW_REG_XCC_ID, 0, 4)
    s_add_u32 s38, s38, s95
    v_mov_b32 v76, s38
    v_mov_b32 v2, v80
    v_mov_b32 v3, v81
    v_mov_b32 v4, v82
    v_mov_b32 v5, v83
    v_mov_b32 v6, v84
    v_mov_b32 v7, v65
    s_waitcnt vmcnt(0)
    buffer_store_dword v137, v72, s[24:27], s37 offen sc1
    s_add_u32 s49, s44, 0
    s_add_u32 m0, s42, 32768
    s_nop 0
    buffer_load_dwordx4 v42, s[16:19], s49 offen lds
    buffer_load_dwordx4 v43, s[16:19], s49 offen offset:1024 lds
    buffer_load_dwordx4 v44, s[16:19], s49 offen offset:2048 lds
    buffer_load_dwordx4 v45, s[16:19], s49 offen offset:3072 lds
    s_add_u32 s49, s44, 256
    s_add_u32 m0, s42, 49152
    s_nop 0
    buffer_load_dwordx4 v42, s[16:19], s49 offen lds
    buffer_load_dwordx4 v43, s[16:19], s49 offen offset:1024 lds
    buffer_load_dwordx4 v44, s[16:19], s49 offen offset:2048 lds
    buffer_load_dwordx4 v45, s[16:19], s49 offen offset:3072 lds
    s_add_u32 s49, s44, 524288
    s_add_u32 m0, s42, 65536
    s_nop 0
    buffer_load_dwordx4 v42, s[16:19], s49 offen lds
    buffer_load_dwordx4 v43, s[16:19], s49 offen offset:1024 lds
    buffer_load_dwordx4 v44, s[16:19], s49 offen offset:2048 lds
    buffer_load_dwordx4 v45, s[16:19], s49 offen offset:3072 lds
    s_add_u32 s49, s44, 524544
    s_add_u32 m0, s42, 81920
    s_nop 0
    buffer_load_dwordx4 v42, s[16:19], s49 offen lds
    buffer_load_dwordx4 v43, s[16:19], s49 offen offset:1024 lds
    buffer_load_dwordx4 v44, s[16:19], s49 offen offset:2048 lds
    buffer_load_dwordx4 v45, s[16:19], s49 offen offset:3072 lds
    s_add_u32 s49, s44, 1048576
    s_add_u32 m0, s42, 98304
    s_nop 0
    buffer_load_dwordx4 v42, s[16:19], s49 offen lds
    buffer_load_dwordx4 v43, s[16:19], s49 offen offset:1024 lds
    buffer_load_dwordx4 v44, s[16:19], s49 offen offset:2048 lds
    buffer_load_dwordx4 v45, s[16:19], s49 offen offset:3072 lds
    s_add_u32 s49, s44, 1048832
    s_add_u32 m0, s42, 114688
    s_nop 0
    buffer_load_dwordx4 v42, s[16:19], s49 offen lds
    buffer_load_dwordx4 v43, s[16:19], s49 offen offset:1024 lds
    buffer_load_dwordx4 v44, s[16:19], s49 offen offset:2048 lds
    buffer_load_dwordx4 v45, s[16:19], s49 offen offset:3072 lds
    s_mov_b32 s38, 16384
Lhead_pollh:
    buffer_load_dword v75, v73, s[24:27], s36 offen sc1
    s_sub_u32 s38, s38, 1
    s_cbranch_scc1 Lhead_goth
    s_waitcnt vmcnt(0) lgkmcnt(0)
    v_cmp_ne_u32 vcc, s95, v75
    s_cbranch_vccnz Lhead_pollh
Lhead_goth:
    s_waitcnt vmcnt(0) lgkmcnt(0)
    buffer_load_dwordx4 a[0:3], v51, s[24:27], s46 offen offset:0 sc1
    buffer_load_dwordx4 a[8:11], v51, s[24:27], s46 offen offset:128 sc1
    buffer_load_dwordx4 a[4:7], v51, s[24:27], s43 offen offset:0 sc1
    buffer_load_dwordx4 a[12:15], v51, s[24:27], s43 offen offset:128 sc1
    s_barrier
    ds_read_b64_tr_b16 a[160:161], v12 offset:32768
    ds_read_b64_tr_b16 a[162:163], v12 offset:36864
    ds_read_b64_tr_b16 a[164:165], v12 offset:40960
    ds_read_b64_tr_b16 a[166:167], v12 offset:45056
    ds_read_b64_tr_b16 a[168:169], v13 offset:32768
    ds_read_b64_tr_b16 a[170:171], v13 offset:36864
    ds_read_b64_tr_b16 a[172:173], v13 offset:40960
    ds_read_b64_tr_b16 a[174:175], v13 offset:45056
    ds_read_b64_tr_b16 a[176:177], v14 offset:32768
    ds_read_b64_tr_b16 a[178:179], v14 offset:36864
    ds_read_b64_tr_b16 a[180:181], v14 offset:40960
    ds_read_b64_tr_b16 a[182:183], v14 offset:45056
    buffer_load_dwordx4 a[16:19], v51, s[24:27], s46 offen offset:256 sc1
    buffer_load_dwordx4 a[24:27], v51, s[24:27], s46 offen offset:384 sc1
    buffer_load_dwordx4 a[20:23], v51, s[24:27], s43 offen offset:256 sc1
    buffer_load_dwordx4 a[28:31], v51, s[24:27], s43 offen offset:384 sc1
    s_waitcnt lgkmcnt(10)
    s_waitcnt vmcnt(7)
    v_mfma_f32_16x16x32_bf16 v[128:131], a[160:163], a[0:3], 0
    s_waitcnt vmcnt(6)
    s_waitcnt lgkmcnt(8)
    ds_read_b64_tr_b16 a[184:185], v15 offset:32768
    v_mfma_f32_16x16x32_bf16 v[128:131], a[164:167], a[8:11], v[128:131]
    s_waitcnt vmcnt(5)
    ds_read_b64_tr_b16 a[186:187], v15 offset:36864
    v_mfma_f32_16x16x32_bf16 v[132:135], a[160:163], a[4:7], 0
    s_waitcnt vmcnt(4)
    ds_read_b64_tr_b16 a[188:189], v15 offset:40960
    v_mfma_f32_16x16x32_bf16 v[132:135], a[164:167], a[12:15], v[132:135]
    s_waitcnt lgkmcnt(9)
    buffer_load_dwordx4 a[32:35], v51, s[24:27], s46 offen offset:512 sc1
    v_mfma_f32_16x16x32_bf16 v[136:139], a[168:171], a[0:3], 0
    s_waitcnt lgkmcnt(7)
    ds_read_b64_tr_b16 a[190:191], v15 offset:45056
    ds_read_b64_tr_b16 a[160:161], v16 offset:32768
    v_mfma_f32_16x16x32_bf16 v[136:139], a[172:175], a[8:11], v[136:139]
    ds_read_b64_tr_b16 a[162:163], v16 offset:36864
    v_mfma_f32_16x16x32_bf16 v[140:143], a[168:171], a[4:7], 0
    ds_read_b64_tr_b16 a[164:165], v16 offset:40960
    v_mfma_f32_16x16x32_bf16 v[140:143], a[172:175], a[12:15], v[140:143]
    s_waitcnt lgkmcnt(9)
    buffer_load_dwordx4 a[40:43], v51, s[24:27], s46 offen offset:640 sc1
    v_mfma_f32_16x16x32_bf16 v[144:147], a[176:179], a[0:3], 0
    s_waitcnt lgkmcnt(7)
    ds_read_b64_tr_b16 a[166:167], v16 offset:45056
    ds_read_b64_tr_b16 a[168:169], v17 offset:32768
    v_mfma_f32_16x16x32_bf16 v[144:147], a[180:183], a[8:11], v[144:147]
    ds_read_b64_tr_b16 a[170:171], v17 offset:36864
    v_mfma_f32_16x16x32_bf16 v[148:151], a[176:179], a[4:7], 0
    ds_read_b64_tr_b16 a[172:173], v17 offset:40960
    v_mfma_f32_16x16x32_bf16 v[148:151], a[180:183], a[12:15], v[148:151]
    s_waitcnt lgkmcnt(9)
    buffer_load_dwordx4 a[36:39], v51, s[24:27], s43 offen offset:512 sc1
    v_mfma_f32_16x16x32_bf16 v[152:155], a[184:187], a[0:3], 0
    s_waitcnt lgkmcnt(7)
    ds_read_b64_tr_b16 a[174:175], v17 offset:45056
    ds_read_b64_tr_b16 a[176:177], v18 offset:32768
    v_mfma_f32_16x16x32_bf16 v[152:155], a[188:191], a[8:11], v[152:155]
    ds_read_b64_tr_b16 a[178:179], v18 offset:36864
    v_mfma_f32_16x16x32_bf16 v[156:159], a[184:187], a[4:7], 0
    ds_read_b64_tr_b16 a[180:181], v18 offset:40960
    v_mfma_f32_16x16x32_bf16 v[156:159], a[188:191], a[12:15], v[156:159]
    s_waitcnt lgkmcnt(9)
    buffer_load_dwordx4 a[44:47], v51, s[24:27], s43 offen offset:640 sc1
    v_mfma_f32_16x16x32_bf16 v[160:163], a[160:163], a[0:3], 0
    s_waitcnt lgkmcnt(7)
    ds_read_b64_tr_b16 a[182:183], v18 offset:45056
    ds_read_b64_tr_b16 a[184:185], v19 offset:32768
    v_mfma_f32_16x16x32_bf16 v[160:163], a[164:167], a[8:11], v[160:163]
    ds_read_b64_tr_b16 a[186:187], v19 offset:36864
    v_mfma_f32_16x16x32_bf16 v[164:167], a[160:163], a[4:7], 0
    ds_read_b64_tr_b16 a[188:189], v19 offset:40960
    v_mfma_f32_16x16x32_bf16 v[164:167], a[164:167], a[12:15], v[164:167]
    s_waitcnt lgkmcnt(9)
    buffer_load_dword v77, v70, s[16:19], s44 offen
    v_mfma_f32_16x16x32_bf16 v[168:171], a[168:171], a[0:3], 0
    s_waitcnt lgkmcnt(7)
    ds_read_b64_tr_b16 a[190:191], v19 offset:45056
    ds_read_b64_tr_b16 a[160:161], v12 offset:49152
    v_mfma_f32_16x16x32_bf16 v[168:171], a[172:175], a[8:11], v[168:171]
    ds_read_b64_tr_b16 a[162:163], v12 offset:53248
    v_mfma_f32_16x16x32_bf16 v[172:175], a[168:171], a[4:7], 0
    ds_read_b64_tr_b16 a[164:165], v12 offset:57344
    v_mfma_f32_16x16x32_bf16 v[172:175], a[172:175], a[12:15], v[172:175]
    s_waitcnt lgkmcnt(9)
    ds_read_b64_tr_b16 a[166:167], v12 offset:61440
    v_mfma_f32_16x16x32_bf16 v[176:179], a[176:179], a[0:3], 0
    s_waitcnt lgkmcnt(8)
    ds_read_b64_tr_b16 a[168:169], v13 offset:49152
    v_mfma_f32_16x16x32_bf16 v[176:179], a[180:183], a[8:11], v[176:179]
    ds_read_b64_tr_b16 a[170:171], v13 offset:53248
    v_mfma_f32_16x16x32_bf16 v[180:183], a[176:179], a[4:7], 0
    ds_read_b64_tr_b16 a[172:173], v13 offset:57344
    v_mfma_f32_16x16x32_bf16 v[180:183], a[180:183], a[12:15], v[180:183]
    s_waitcnt lgkmcnt(9)
    ds_read_b64_tr_b16 a[174:175], v13 offset:61440
    v_mfma_f32_16x16x32_bf16 v[184:187], a[184:187], a[0:3], 0
    s_waitcnt lgkmcnt(8)
    ds_read_b64_tr_b16 a[176:177], v14 offset:49152
    v_mfma_f32_16x16x32_bf16 v[184:187], a[188:191], a[8:11], v[184:187]
    ds_read_b64_tr_b16 a[178:179], v14 offset:53248
    v_mfma_f32_16x16x32_bf16 v[188:191], a[184:187], a[4:7], 0
    ds_read_b64_tr_b16 a[180:181], v14 offset:57344
    v_mfma_f32_16x16x32_bf16 v[188:191], a[188:191], a[12:15], v[188:191]
    s_waitcnt lgkmcnt(9)
    ds_read_b64_tr_b16 a[182:183], v14 offset:61440
    v_mfma_f32_16x16x32_bf16 v[192:195], a[160:163], a[0:3], 0
    s_waitcnt lgkmcnt(8)
    ds_read_b64_tr_b16 a[184:185], v15 offset:49152
    v_mfma_f32_16x16x32_bf16 v[192:195], a[164:167], a[8:11], v[192:195]
    ds_read_b64_tr_b16 a[186:187], v15 offset:53248
    v_mfma_f32_16x16x32_bf16 v[196:199], a[160:163], a[4:7], 0
    ds_read_b64_tr_b16 a[188:189], v15 offset:57344
    v_mfma_f32_16x16x32_bf16 v[196:199], a[164:167], a[12:15], v[196:199]
    s_waitcnt lgkmcnt(9)
    ds_read_b64_tr_b16 a[190:191], v15 offset:61440
    v_mfma_f32_16x16x32_bf16 v[200:203], a[168:171], a[0:3], 0
    s_waitcnt lgkmcnt(8)
    ds_read_b64_tr_b16 a[160:161], v16 offset:49152
    v_mfma_f32_16x16x32_bf16 v[200:203], a[172:175], a[8:11], v[200:203]
    ds_read_b64_tr_b16 a[162:163], v16 offset:53248
    v_mfma_f32_16x16x32_bf16 v[204:207], a[168:171], a[4:7], 0
    ds_read_b64_tr_b16 a[164:165], v16 offset:57344
    v_mfma_f32_16x16x32_bf16 v[204:207], a[172:175], a[12:15], v[204:207]
    s_waitcnt lgkmcnt(9)
    ds_read_b64_tr_b16 a[166:167], v16 offset:61440
    v_mfma_f32_16x16x32_bf16 v[208:211], a[176:179], a[0:3], 0
    s_waitcnt lgkmcnt(8)
    ds_read_b64_tr_b16 a[168:169], v17 offset:49152
    v_mfma_f32_16x16x32_bf16 v[208:211], a[180:183], a[8:11], v[208:211]
    ds_read_b64_tr_b16 a[170:171], v17 offset:53248
    v_mfma_f32_16x16x32_bf16 v[212:215], a[176:179], a[4:7], 0
    ds_read_b64_tr_b16 a[172:173], v17 offset:57344
    v_mfma_f32_16x16x32_bf16 v[212:215], a[180:183], a[12:15], v[212:215]
    s_waitcnt lgkmcnt(9)
    ds_read_b64_tr_b16 a[174:175], v17 offset:61440
    v_mfma_f32_16x16x32_bf16 v[216:219], a[184:187], a[0:3], 0
    s_waitcnt lgkmcnt(8)
    ds_read_b64_tr_b16 a[176:177], v18 offset:49152
    v_mfma_f32_16x16x32_bf16 v[216:219], a[188:191], a[8:11], v[216:219]
    ds_read_b64_tr_b16 a[178:179], v18 offset:53248
    v_mfma_f32_16x16x32_bf16 v[220:223], a[184:187], a[4:7], 0
    ds_read_b64_tr_b16 a[180:181], v18 offset:57344
    v_mfma_f32_16x16x32_bf16 v[220:223], a[188:191], a[12:15], v[220:223]
    s_waitcnt lgkmcnt(9)
    ds_read_b64_tr_b16 a[182:183], v18 offset:61440
    v_mfma_f32_16x16x32_bf16 v[224:227], a[160:163], a[0:3], 0
    s_waitcnt lgkmcnt(8)
    ds_read_b64_tr_b16 a[184:185], v19 offset:49152
    v_mfma_f32_16x16x32_bf16 v[224:227], a[164:167], a[8:11], v[224:227]
    ds_read_b64_tr_b16 a[186:187], v19 offset:53248
    v_mfma_f32_16x16x32_bf16 v[228:231], a[160:163], a[4:7], 0
    ds_read_b64_tr_b16 a[188:189], v19 offset:57344
    v_mfma_f32_16x16x32_bf16 v[228:231], a[164:167], a[12:15], v[228:231]
    s_waitcnt lgkmcnt(9)
    ds_read_b64_tr_b16 a[190:191], v19 offset:61440
    s_barrier
    v_mfma_f32_16x16x32_bf16 v[232:235], a[168:171], a[0:3], 0
    s_waitcnt lgkmcnt(8)
    ds_read_b64_tr_b16 a[160:161], v20 offset:0
    v_mfma_f32_16x16x32_bf16 v[232:235], a[172:175], a[8:11], v[232:235]
    s_add_u32 s49, s44, 1572864
    ds_read_b64_tr_b16 a[162:163], v20 offset:4096
    v_mfma_f32_16x16x32_bf16 v[236:239], a[168:171], a[4:7], 0
    s_add_u32 m0, s42, 131072
    ds_read_b64_tr_b16 a[164:165], v20 offset:8192
    v_mfma_f32_16x16x32_bf16 v[236:239], a[172:175], a[12:15], v[236:239]
    s_waitcnt lgkmcnt(9)
    buffer_load_dwordx4 v42, s[16:19], s49 offen lds
    v_mfma_f32_16x16x32_bf16 v[240:243], a[176:179], a[0:3], 0
    s_waitcnt lgkmcnt(7)
    ds_read_b64_tr_b16 a[166:167], v20 offset:12288
    ds_read_b64_tr_b16 a[168:169], v21 offset:0
    v_mfma_f32_16x16x32_bf16 v[240:243], a[180:183], a[8:11], v[240:243]
    ds_read_b64_tr_b16 a[170:171], v21 offset:4096
    v_mfma_f32_16x16x32_bf16 v[244:247], a[176:179], a[4:7], 0
    ds_read_b64_tr_b16 a[172:173], v21 offset:8192
    v_mfma_f32_16x16x32_bf16 v[244:247], a[180:183], a[12:15], v[244:247]
    s_waitcnt lgkmcnt(9)
    buffer_load_dwordx4 v43, s[16:19], s49 offen offset:1024 lds
    v_mfma_f32_16x16x32_bf16 v[248:251], a[184:187], a[0:3], 0
    s_waitcnt lgkmcnt(7)
    ds_read_b64_tr_b16 a[174:175], v21 offset:12288
    ds_read_b64_tr_b16 a[176:177], v22 offset:0
    v_mfma_f32_16x16x32_bf16 v[248:251], a[188:191], a[8:11], v[248:251]
    ds_read_b64_tr_b16 a[178:179], v22 offset:4096
    v_mfma_f32_16x16x32_bf16 v[252:255], a[184:187], a[4:7], 0
    ds_read_b64_tr_b16 a[180:181], v22 offset:8192
    v_mfma_f32_16x16x32_bf16 v[252:255], a[188:191], a[12:15], v[252:255]
    s_waitcnt vmcnt(10)
    s_waitcnt lgkmcnt(9)
    buffer_load_dwordx4 v44, s[16:19], s49 offen offset:2048 lds
    v_mfma_f32_16x16x32_bf16 v[128:131], a[160:163], a[16:19], v[128:131]
    s_waitcnt vmcnt(10)
    s_waitcnt lgkmcnt(7)
    ds_read_b64_tr_b16 a[182:183], v22 offset:12288
    ds_read_b64_tr_b16 a[184:185], v23 offset:0
    v_mfma_f32_16x16x32_bf16 v[128:131], a[164:167], a[24:27], v[128:131]
    s_waitcnt vmcnt(9)
    ds_read_b64_tr_b16 a[186:187], v23 offset:4096
    v_mfma_f32_16x16x32_bf16 v[132:135], a[160:163], a[20:23], v[132:135]
    s_waitcnt vmcnt(8)
    ds_read_b64_tr_b16 a[188:189], v23 offset:8192
    v_mfma_f32_16x16x32_bf16 v[132:135], a[164:167], a[28:31], v[132:135]
    s_waitcnt lgkmcnt(9)
    buffer_load_dwordx4 v45, s[16:19], s49 offen offset:3072 lds
    v_mfma_f32_16x16x32_bf16 v[136:139], a[168:171], a[16:19], v[136:139]
    s_waitcnt lgkmcnt(7)
    ds_read_b64_tr_b16 a[190:191], v23 offset:12288
    ds_read_b64_tr_b16 a[160:161], v24 offset:0
    v_mfma_f32_16x16x32_bf16 v[136:139], a[172:175], a[24:27], v[136:139]
    s_add_u32 s49, s44, 1573120
    ds_read_b64_tr_b16 a[162:163], v24 offset:4096
    v_mfma_f32_16x16x32_bf16 v[140:143], a[168:171], a[20:23], v[140:143]
    s_add_u32 m0, s42, 147456
    ds_read_b64_tr_b16 a[164:165], v24 offset:8192
    v_mfma_f32_16x16x32_bf16 v[140:143], a[172:175], a[28:31], v[140:143]
    s_waitcnt lgkmcnt(9)
    buffer_load_dwordx4 v42, s[16:19], s49 offen lds
    v_mfma_f32_16x16x32_bf16 v[144:147], a[176:179], a[16:19], v[144:147]
    s_waitcnt lgkmcnt(7)
    ds_read_b64_tr_b16 a[166:167], v24 offset:12288
    ds_read_b64_tr_b16 a[168:169], v25 offset:0
    v_mfma_f32_16x16x32_bf16 v[144:147], a[180:183], a[24:27], v[144:147]
    ds_read_b64_tr_b16 a[170:171], v25 offset:4096
    v_mfma_f32_16x16x32_bf16 v[148:151], a[176:179], a[20:23], v[148:151]
    ds_read_b64_tr_b16 a[172:173], v25 offset:8192
    v_mfma_f32_16x16x32_bf16 v[148:151], a[180:183], a[28:31], v[148:151]
    s_waitcnt lgkmcnt(9)
    buffer_load_dwordx4 v43, s[16:19], s49 offen offset:1024 lds
    v_mfma_f32_16x16x32_bf16 v[152:155], a[184:187], a[16:19], v[152:155]
    s_waitcnt lgkmcnt(7)
    ds_read_b64_tr_b16 a[174:175], v25 offset:12288
    ds_read_b64_tr_b16 a[176:177], v26 offset:0
    v_mfma_f32_16x16x32_bf16 v[152:155], a[188:191], a[24:27], v[152:155]
    ds_read_b64_tr_b16 a[178:179], v26 offset:4096
    v_mfma_f32_16x16x32_bf16 v[156:159], a[184:187], a[20:23], v[156:159]
    ds_read_b64_tr_b16 a[180:181], v26 offset:8192
    v_mfma_f32_16x16x32_bf16 v[156:159], a[188:191], a[28:31], v[156:159]
    s_waitcnt lgkmcnt(9)
    buffer_load_dwordx4 v44, s[16:19], s49 offen offset:2048 lds
    v_mfma_f32_16x16x32_bf16 v[160:163], a[160:163], a[16:19], v[160:163]
    s_waitcnt lgkmcnt(7)
    ds_read_b64_tr_b16 a[182:183], v26 offset:12288
    ds_read_b64_tr_b16 a[184:185], v27 offset:0
    v_mfma_f32_16x16x32_bf16 v[160:163], a[164:167], a[24:27], v[160:163]
    ds_read_b64_tr_b16 a[186:187], v27 offset:4096
    v_mfma_f32_16x16x32_bf16 v[164:167], a[160:163], a[20:23], v[164:167]
    ds_read_b64_tr_b16 a[188:189], v27 offset:8192
    v_mfma_f32_16x16x32_bf16 v[164:167], a[164:167], a[28:31], v[164:167]
    s_waitcnt lgkmcnt(9)
    buffer_load_dwordx4 v45, s[16:19], s49 offen offset:3072 lds
    v_mfma_f32_16x16x32_bf16 v[168:171], a[168:171], a[16:19], v[168:171]
    s_waitcnt lgkmcnt(7)
    ds_read_b64_tr_b16 a[190:191], v27 offset:12288
    ds_read_b64_tr_b16 a[160:161], v20 offset:16384
    v_mfma_f32_16x16x32_bf16 v[168:171], a[172:175], a[24:27], v[168:171]
    ds_read_b64_tr_b16 a[162:163], v20 offset:20480
    v_mfma_f32_16x16x32_bf16 v[172:175], a[168:171], a[20:23], v[172:175]
    ds_read_b64_tr_b16 a[164:165], v20 offset:24576
    v_mfma_f32_16x16x32_bf16 v[172:175], a[172:175], a[28:31], v[172:175]
    s_waitcnt lgkmcnt(9)
    buffer_load_dwordx4 a[48:51], v51, s[24:27], s46 offen offset:768 sc1
    v_mfma_f32_16x16x32_bf16 v[176:179], a[176:179], a[16:19], v[176:179]
    s_waitcnt lgkmcnt(7)
    ds_read_b64_tr_b16 a[166:167], v20 offset:28672
    ds_read_b64_tr_b16 a[168:169], v21 offset:16384
    v_mfma_f32_16x16x32_bf16 v[176:179], a[180:183], a[24:27], v[176:179]
    ds_read_b64_tr_b16 a[170:171], v21 offset:20480
    v_mfma_f32_16x16x32_bf16 v[180:183], a[176:179], a[20:23], v[180:183]
    ds_read_b64_tr_b16 a[172:173], v21 offset:24576
    v_mfma_f32_16x16x32_bf16 v[180:183], a[180:183], a[28:31], v[180:183]
    s_waitcnt lgkmcnt(9)
    buffer_load_dwordx4 a[56:59], v51, s[24:27], s46 offen offset:896 sc1
    v_mfma_f32_16x16x32_bf16 v[184:187], a[184:187], a[16:19], v[184:187]
    s_waitcnt lgkmcnt(7)
    ds_read_b64_tr_b16 a[174:175], v21 offset:28672
    ds_read_b64_tr_b16 a[176:177], v22 offset:16384
    v_mfma_f32_16x16x32_bf16 v[184:187], a[188:191], a[24:27], v[184:187]
    ds_read_b64_tr_b16 a[178:179], v22 offset:20480
    v_mfma_f32_16x16x32_bf16 v[188:191], a[184:187], a[20:23], v[188:191]
    ds_read_b64_tr_b16 a[180:181], v22 offset:24576
    v_mfma_f32_16x16x32_bf16 v[188:191], a[188:191], a[28:31], v[188:191]
    s_waitcnt lgkmcnt(9)
    buffer_load_dwordx4 a[52:55], v51, s[24:27], s43 offen offset:768 sc1
    v_mfma_f32_16x16x32_bf16 v[192:195], a[160:163], a[16:19], v[192:195]
    s_waitcnt lgkmcnt(7)
    ds_read_b64_tr_b16 a[182:183], v22 offset:28672
    ds_read_b64_tr_b16 a[184:185], v23 offset:16384
    v_mfma_f32_16x16x32_bf16 v[192:195], a[164:167], a[24:27], v[192:195]
    ds_read_b64_tr_b16 a[186:187], v23 offset:20480
    v_mfma_f32_16x16x32_bf16 v[196:199], a[160:163], a[20:23], v[196:199]
    ds_read_b64_tr_b16 a[188:189], v23 offset:24576
    v_mfma_f32_16x16x32_bf16 v[196:199], a[164:167], a[28:31], v[196:199]
    s_waitcnt lgkmcnt(9)
    buffer_load_dwordx4 a[60:63], v51, s[24:27], s43 offen offset:896 sc1
    v_mfma_f32_16x16x32_bf16 v[200:203], a[168:171], a[16:19], v[200:203]
    s_waitcnt lgkmcnt(7)
    ds_read_b64_tr_b16 a[190:191], v23 offset:28672
    ds_read_b64_tr_b16 a[160:161], v24 offset:16384
    v_mfma_f32_16x16x32_bf16 v[200:203], a[172:175], a[24:27], v[200:203]
    ds_read_b64_tr_b16 a[162:163], v24 offset:20480
    v_mfma_f32_16x16x32_bf16 v[204:207], a[168:171], a[20:23], v[204:207]
    ds_read_b64_tr_b16 a[164:165], v24 offset:24576
    v_mfma_f32_16x16x32_bf16 v[204:207], a[172:175], a[28:31], v[204:207]
    s_waitcnt lgkmcnt(9)
    ds_read_b64_tr_b16 a[166:167], v24 offset:28672
    v_mfma_f32_16x16x32_bf16 v[208:211], a[176:179], a[16:19], v[208:211]
    s_waitcnt lgkmcnt(8)
    ds_read_b64_tr_b16 a[168:169], v25 offset:16384
    v_mfma_f32_16x16x32_bf16 v[208:211], a[180:183], a[24:27], v[208:211]
    ds_read_b64_tr_b16 a[170:171], v25 offset:20480
    v_mfma_f32_16x16x32_bf16 v[212:215], a[176:179], a[20:23], v[212:215]
    ds_read_b64_tr_b16 a[172:173], v25 offset:24576
    v_mfma_f32_16x16x32_bf16 v[212:215], a[180:183], a[28:31], v[212:215]
    s_waitcnt lgkmcnt(9)
    ds_read_b64_tr_b16 a[174:175], v25 offset:28672
    v_mfma_f32_16x16x32_bf16 v[216:219], a[184:187], a[16:19], v[216:219]
    s_waitcnt lgkmcnt(8)
    ds_read_b64_tr_b16 a[176:177], v26 offset:16384
    v_mfma_f32_16x16x32_bf16 v[216:219], a[188:191], a[24:27], v[216:219]
    ds_read_b64_tr_b16 a[178:179], v26 offset:20480
    v_mfma_f32_16x16x32_bf16 v[220:223], a[184:187], a[20:23], v[220:223]
    ds_read_b64_tr_b16 a[180:181], v26 offset:24576
    v_mfma_f32_16x16x32_bf16 v[220:223], a[188:191], a[28:31], v[220:223]
    s_waitcnt lgkmcnt(9)
    ds_read_b64_tr_b16 a[182:183], v26 offset:28672
    v_mfma_f32_16x16x32_bf16 v[224:227], a[160:163], a[16:19], v[224:227]
    s_waitcnt lgkmcnt(8)
    ds_read_b64_tr_b16 a[184:185], v27 offset:16384
    v_mfma_f32_16x16x32_bf16 v[224:227], a[164:167], a[24:27], v[224:227]
    ds_read_b64_tr_b16 a[186:187], v27 offset:20480
    v_mfma_f32_16x16x32_bf16 v[228:231], a[160:163], a[20:23], v[228:231]
    ds_read_b64_tr_b16 a[188:189], v27 offset:24576
    v_mfma_f32_16x16x32_bf16 v[228:231], a[164:167], a[28:31], v[228:231]
    s_waitcnt lgkmcnt(9)
    ds_read_b64_tr_b16 a[190:191], v27 offset:28672
    s_barrier
    v_mfma_f32_16x16x32_bf16 v[232:235], a[168:171], a[16:19], v[232:235]
    s_waitcnt lgkmcnt(8)
    ds_read_b64_tr_b16 a[160:161], v20 offset:32768
    v_mfma_f32_16x16x32_bf16 v[232:235], a[172:175], a[24:27], v[232:235]
    s_add_u32 s49, s44, 2097152
    ds_read_b64_tr_b16 a[162:163], v20 offset:36864
    v_mfma_f32_16x16x32_bf16 v[236:239], a[168:171], a[20:23], v[236:239]
    s_add_u32 m0, s42, 0
    ds_read_b64_tr_b16 a[164:165], v20 offset:40960
    v_mfma_f32_16x16x32_bf16 v[236:239], a[172:175], a[28:31], v[236:239]
    s_waitcnt lgkmcnt(9)
    buffer_load_dwordx4 v42, s[16:19], s49 offen lds
    v_mfma_f32_16x16x32_bf16 v[240:243], a[176:179], a[16:19], v[240:243]
    s_waitcnt lgkmcnt(7)
    ds_read_b64_tr_b16 a[166:167], v20 offset:45056
    ds_read_b64_tr_b16 a[168:169], v21 offset:32768
    v_mfma_f32_16x16x32_bf16 v[240:243], a[180:183], a[24:27], v[240:243]
Ltour0:
    s_cbranch_execz Ltour4
    ds_read_b64_tr_b16 a[170:171], v21 offset:36864
    v_mfma_f32_16x16x32_bf16 v[244:247], a[176:179], a[20:23], v[244:247]
    ds_read_b64_tr_b16 a[172:173], v21 offset:40960
    v_mfma_f32_16x16x32_bf16 v[244:247], a[180:183], a[28:31], v[244:247]
    s_waitcnt lgkmcnt(9)
    buffer_load_dwordx4 v43, s[16:19], s49 offen offset:1024 lds
    v_mfma_f32_16x16x32_bf16 v[248:251], a[184:187], a[16:19], v[248:251]
    s_waitcnt lgkmcnt(7)
    ds_read_b64_tr_b16 a[174:175], v21 offset:45056
    ds_read_b64_tr_b16 a[176:177], v22 offset:32768
    v_mfma_f32_16x16x32_bf16 v[248:251], a[188:191], a[24:27], v[248:251]
    ds_read_b64_tr_b16 a[178:179], v22 offset:36864
    v_mfma_f32_16x16x32_bf16 v[252:255], a[184:187], a[20:23], v[252:255]
    ds_read_b64_tr_b16 a[180:181], v22 offset:40960
    v_mfma_f32_16x16x32_bf16 v[252:255], a[188:191], a[28:31], v[252:255]
    s_waitcnt vmcnt(18)
    s_waitcnt lgkmcnt(9)
    buffer_load_dwordx4 v44, s[16:19], s49 offen offset:2048 lds
    v_mfma_f32_16x16x32_bf16 v[128:131], a[160:163], a[32:35], v[128:131]
    s_waitcnt vmcnt(18)
    s_waitcnt lgkmcnt(7)
    ds_read_b64_tr_b16 a[182:183], v22 offset:45056
    ds_read_b64_tr_b16 a[184:185], v23 offset:32768
    v_mfma_f32_16x16x32_bf16 v[128:131], a[164:167], a[40:43], v[128:131]
    s_waitcnt vmcnt(17)
    ds_read_b64_tr_b16 a[186:187], v23 offset:36864
    v_mfma_f32_16x16x32_bf16 v[132:135], a[160:163], a[36:39], v[132:135]
    s_waitcnt vmcnt(16)
    ds_read_b64_tr_b16 a[188:189], v23 offset:40960
    v_mfma_f32_16x16x32_bf16 v[132:135], a[164:167], a[44:47], v[132:135]
    s_waitcnt lgkmcnt(9)
    buffer_load_dwordx4 v45, s[16:19], s49 offen offset:3072 lds
    v_mfma_f32_16x16x32_bf16 v[136:139], a[168:171], a[32:35], v[136:139]
    s_waitcnt lgkmcnt(7)
    ds_read_b64_tr_b16 a[190:191], v23 offset:45056
    ds_read_b64_tr_b16 a[160:161], v24 offset:32768
    v_mfma_f32_16x16x32_bf16 v[136:139], a[172:175], a[40:43], v[136:139]
    s_add_u32 s49, s44, 2097408
    ds_read_b64_tr_b16 a[162:163], v24 offset:36864
    v_mfma_f32_16x16x32_bf16 v[140:143], a[168:171], a[36:39], v[140:143]
    s_add_u32 m0, s42, 16384
    ds_read_b64_tr_b16 a[164:165], v24 offset:40960
    v_mfma_f32_16x16x32_bf16 v[140:143], a[172:175], a[44:47], v[140:143]
    s_waitcnt lgkmcnt(9)
    buffer_load_dwordx4 v42, s[16:19], s49 offen lds
    v_mfma_f32_16x16x32_bf16 v[144:147], a[176:179], a[32:35], v[144:147]
    s_waitcnt lgkmcnt(7)
    ds_read_b64_tr_b16 a[166:167], v24 offset:45056
    ds_read_b64_tr_b16 a[168:169], v25 offset:32768
    v_mfma_f32_16x16x32_bf16 v[144:147], a[180:183], a[40:43], v[144:147]
    ds_read_b64_tr_b16 a[170:171], v25 offset:36864
    v_mfma_f32_16x16x32_bf16 v[148:151], a[176:179], a[36:39], v[148:151]
    ds_read_b64_tr_b16 a[172:173], v25 offset:40960
    v_mfma_f32_16x16x32_bf16 v[148:151], a[180:183], a[44:47], v[148:151]
    s_waitcnt lgkmcnt(9)
    buffer_load_dwordx4 v43, s[16:19], s49 offen offset:1024 lds
    v_mfma_f32_16x16x32_bf16 v[152:155], a[184:187], a[32:35], v[152:155]
    s_waitcnt lgkmcnt(7)
    ds_read_b64_tr_b16 a[174:175], v25 offset:45056
    ds_read_b64_tr_b16 a[176:177], v26 offset:32768
    v_mfma_f32_16x16x32_bf16 v[152:155], a[188:191], a[40:43], v[152:155]
    ds_read_b64_tr_b16 a[178:179], v26 offset:36864
    v_mfma_f32_16x16x32_bf16 v[156:159], a[184:187], a[36:39], v[156:159]
    ds_read_b64_tr_b16 a[180:181], v26 offset:40960
    v_mfma_f32_16x16x32_bf16 v[156:159], a[188:191], a[44:47], v[156:159]
    s_waitcnt lgkmcnt(9)
    buffer_load_dwordx4 v44, s[16:19], s49 offen offset:2048 lds
    v_mfma_f32_16x16x32_bf16 v[160:163], a[160:163], a[32:35], v[160:163]
    s_waitcnt lgkmcnt(7)
    ds_read_b64_tr_b16 a[182:183], v26 offset:45056
    ds_read_b64_tr_b16 a[184:185], v27 offset:32768
    v_mfma_f32_16x16x32_bf16 v[160:163], a[164:167], a[40:43], v[160:163]
    ds_read_b64_tr_b16 a[186:187], v27 offset:36864
    v_mfma_f32_16x16x32_bf16 v[164:167], a[160:163], a[36:39], v[164:167]
    ds_read_b64_tr_b16 a[188:189], v27 offset:40960
    v_mfma_f32_16x16x32_bf16 v[164:167], a[164:167], a[44:47], v[164:167]
    s_waitcnt lgkmcnt(9)
    buffer_load_dwordx4 v45, s[16:19], s49 offen offset:3072 lds
    v_mfma_f32_16x16x32_bf16 v[168:171], a[168:171], a[32:35], v[168:171]
    s_waitcnt lgkmcnt(7)
    ds_read_b64_tr_b16 a[190:191], v27 offset:45056
    ds_read_b64_tr_b16 a[160:161], v20 offset:49152
    v_mfma_f32_16x16x32_bf16 v[168:171], a[172:175], a[40:43], v[168:171]
    ds_read_b64_tr_b16 a[162:163], v20 offset:53248
    v_mfma_f32_16x16x32_bf16 v[172:175], a[168:171], a[36:39], v[172:175]
    ds_read_b64_tr_b16 a[164:165], v20 offset:57344
    v_mfma_f32_16x16x32_bf16 v[172:175], a[172:175], a[44:47], v[172:175]
    s_waitcnt lgkmcnt(9)
    buffer_load_dwordx4 a[64:67], v51, s[24:27], s46 offen offset:1024 sc1
    v_mfma_f32_16x16x32_bf16 v[176:179], a[176:179], a[32:35], v[176:179]
    s_waitcnt lgkmcnt(7)
    ds_read_b64_tr_b16 a[166:167], v20 offset:61440
    ds_read_b64_tr_b16 a[168:169], v21 offset:49152
    v_mfma_f32_16x16x32_bf16 v[176:179], a[180:183], a[40:43], v[176:179]
    ds_read_b64_tr_b16 a[170:171], v21 offset:53248
    v_mfma_f32_16x16x32_bf16 v[180:183], a[176:179], a[36:39], v[180:183]
    ds_read_b64_tr_b16 a[172:173], v21 offset:57344
    v_mfma_f32_16x16x32_bf16 v[180:183], a[180:183], a[44:47], v[180:183]
    s_waitcnt lgkmcnt(9)
    buffer_load_dwordx4 a[72:75], v51, s[24:27], s46 offen offset:1152 sc1
    v_mfma_f32_16x16x32_bf16 v[184:187], a[184:187], a[32:35], v[184:187]
    s_waitcnt lgkmcnt(7)
    ds_read_b64_tr_b16 a[174:175], v21 offset:61440
    ds_read_b64_tr_b16 a[176:177], v22 offset:49152
    v_mfma_f32_16x16x32_bf16 v[184:187], a[188:191], a[40:43], v[184:187]
    ds_read_b64_tr_b16 a[178:179], v22 offset:53248
    v_mfma_f32_16x16x32_bf16 v[188:191], a[184:187], a[36:39], v[188:191]
    ds_read_b64_tr_b16 a[180:181], v22 offset:57344
    v_mfma_f32_16x16x32_bf16 v[188:191], a[188:191], a[44:47], v[188:191]
    s_waitcnt lgkmcnt(9)
    buffer_load_dwordx4 a[68:71], v51, s[24:27], s43 offen offset:1024 sc1
    v_mfma_f32_16x16x32_bf16 v[192:195], a[160:163], a[32:35], v[192:195]
    s_waitcnt lgkmcnt(7)
    ds_read_b64_tr_b16 a[182:183], v22 offset:61440
    ds_read_b64_tr_b16 a[184:185], v23 offset:49152
    v_mfma_f32_16x16x32_bf16 v[192:195], a[164:167], a[40:43], v[192:195]
    ds_read_b64_tr_b16 a[186:187], v23 offset:53248
    v_mfma_f32_16x16x32_bf16 v[196:199], a[160:163], a[36:39], v[196:199]
    ds_read_b64_tr_b16 a[188:189], v23 offset:57344
    v_mfma_f32_16x16x32_bf16 v[196:199], a[164:167], a[44:47], v[196:199]
    s_waitcnt lgkmcnt(9)
    buffer_load_dwordx4 a[76:79], v51, s[24:27], s43 offen offset:1152 sc1
    v_mfma_f32_16x16x32_bf16 v[200:203], a[168:171], a[32:35], v[200:203]
    s_waitcnt lgkmcnt(7)
    ds_read_b64_tr_b16 a[190:191], v23 offset:61440
    ds_read_b64_tr_b16 a[160:161], v24 offset:49152
    v_mfma_f32_16x16x32_bf16 v[200:203], a[172:175], a[40:43], v[200:203]
    ds_read_b64_tr_b16 a[162:163], v24 offset:53248
    v_mfma_f32_16x16x32_bf16 v[204:207], a[168:171], a[36:39], v[204:207]
    ds_read_b64_tr_b16 a[164:165], v24 offset:57344
    v_mfma_f32_16x16x32_bf16 v[204:207], a[172:175], a[44:47], v[204:207]
    s_waitcnt lgkmcnt(9)
    ds_read_b64_tr_b16 a[166:167], v24 offset:61440
    v_mfma_f32_16x16x32_bf16 v[208:211], a[176:179], a[32:35], v[208:211]
    s_waitcnt lgkmcnt(8)
    ds_read_b64_tr_b16 a[168:169], v25 offset:49152
    v_mfma_f32_16x16x32_bf16 v[208:211], a[180:183], a[40:43], v[208:211]
    ds_read_b64_tr_b16 a[170:171], v25 offset:53248
    v_mfma_f32_16x16x32_bf16 v[212:215], a[176:179], a[36:39], v[212:215]
    ds_read_b64_tr_b16 a[172:173], v25 offset:57344
    v_mfma_f32_16x16x32_bf16 v[212:215], a[180:183], a[44:47], v[212:215]
    s_waitcnt lgkmcnt(9)
    ds_read_b64_tr_b16 a[174:175], v25 offset:61440
    v_mfma_f32_16x16x32_bf16 v[216:219], a[184:187], a[32:35], v[216:219]
    s_waitcnt lgkmcnt(8)
    ds_read_b64_tr_b16 a[176:177], v26 offset:49152
    v_mfma_f32_16x16x32_bf16 v[216:219], a[188:191], a[40:43], v[216:219]
    ds_read_b64_tr_b16 a[178:179], v26 offset:53248
    v_mfma_f32_16x16x32_bf16 v[220:223], a[184:187], a[36:39], v[220:223]
    ds_read_b64_tr_b16 a[180:181], v26 offset:57344
    v_mfma_f32_16x16x32_bf16 v[220:223], a[188:191], a[44:47], v[220:223]
    s_waitcnt lgkmcnt(9)
    ds_read_b64_tr_b16 a[182:183], v26 offset:61440
    v_mfma_f32_16x16x32_bf16 v[224:227], a[160:163], a[32:35], v[224:227]
    s_waitcnt lgkmcnt(8)
    ds_read_b64_tr_b16 a[184:185], v27 offset:49152
    v_mfma_f32_16x16x32_bf16 v[224:227], a[164:167], a[40:43], v[224:227]
    ds_read_b64_tr_b16 a[186:187], v27 offset:53248
    v_mfma_f32_16x16x32_bf16 v[228:231], a[160:163], a[36:39], v[228:231]
    ds_read_b64_tr_b16 a[188:189], v27 offset:57344
    v_mfma_f32_16x16x32_bf16 v[228:231], a[164:167], a[44:47], v[228:231]
    s_waitcnt lgkmcnt(9)
    ds_read_b64_tr_b16 a[190:191], v27 offset:61440
    s_waitcnt vmcnt(16)
    s_barrier
    v_mfma_f32_16x16x32_bf16 v[232:235], a[168:171], a[32:35], v[232:235]
    s_waitcnt lgkmcnt(8)
    ds_read_b64_tr_b16 a[160:161], v28 offset:0
    v_mfma_f32_16x16x32_bf16 v[232:235], a[172:175], a[40:43], v[232:235]
    s_add_u32 s49, s44, 2621440
    ds_read_b64_tr_b16 a[162:163], v28 offset:4096
    v_mfma_f32_16x16x32_bf16 v[236:239], a[168:171], a[36:39], v[236:239]
    s_add_u32 m0, s42, 32768
    ds_read_b64_tr_b16 a[164:165], v28 offset:8192
    v_mfma_f32_16x16x32_bf16 v[236:239], a[172:175], a[44:47], v[236:239]
    s_waitcnt lgkmcnt(9)
    buffer_load_dwordx4 v42, s[16:19], s49 offen lds
    v_mfma_f32_16x16x32_bf16 v[240:243], a[176:179], a[32:35], v[240:243]
    s_waitcnt lgkmcnt(7)
    ds_read_b64_tr_b16 a[166:167], v28 offset:12288
    ds_read_b64_tr_b16 a[168:169], v29 offset:0
    v_mfma_f32_16x16x32_bf16 v[240:243], a[180:183], a[40:43], v[240:243]
    ds_read_b64_tr_b16 a[170:171], v29 offset:4096
    v_mfma_f32_16x16x32_bf16 v[244:247], a[176:179], a[36:39], v[244:247]
    ds_read_b64_tr_b16 a[172:173], v29 offset:8192
    v_mfma_f32_16x16x32_bf16 v[244:247], a[180:183], a[44:47], v[244:247]
    s_waitcnt lgkmcnt(9)
    buffer_load_dwordx4 v43, s[16:19], s49 offen offset:1024 lds
    v_mfma_f32_16x16x32_bf16 v[248:251], a[184:187], a[32:35], v[248:251]
    s_waitcnt lgkmcnt(7)
    ds_read_b64_tr_b16 a[174:175], v29 offset:12288
    ds_read_b64_tr_b16 a[176:177], v30 offset:0
    v_mfma_f32_16x16x32_bf16 v[248:251], a[188:191], a[40:43], v[248:251]
    ds_read_b64_tr_b16 a[178:179], v30 offset:4096
    v_mfma_f32_16x16x32_bf16 v[252:255], a[184:187], a[36:39], v[252:255]
    ds_read_b64_tr_b16 a[180:181], v30 offset:8192
    v_mfma_f32_16x16x32_bf16 v[252:255], a[188:191], a[44:47], v[252:255]
    s_waitcnt vmcnt(17)
    s_waitcnt lgkmcnt(9)
    buffer_load_dwordx4 v44, s[16:19], s49 offen offset:2048 lds
    v_mfma_f32_16x16x32_bf16 v[128:131], a[160:163], a[48:51], v[128:131]
    s_waitcnt vmcnt(17)
    s_waitcnt lgkmcnt(7)
    ds_read_b64_tr_b16 a[182:183], v30 offset:12288
    ds_read_b64_tr_b16 a[184:185], v31 offset:0
    v_mfma_f32_16x16x32_bf16 v[128:131], a[164:167], a[56:59], v[128:131]
    s_waitcnt vmcnt(16)
    ds_read_b64_tr_b16 a[186:187], v31 offset:4096
    v_mfma_f32_16x16x32_bf16 v[132:135], a[160:163], a[52:55], v[132:135]
    s_waitcnt vmcnt(15)
    ds_read_b64_tr_b16 a[188:189], v31 offset:8192
    v_mfma_f32_16x16x32_bf16 v[132:135], a[164:167], a[60:63], v[132:135]
    s_waitcnt lgkmcnt(9)
    buffer_load_dwordx4 v45, s[16:19], s49 offen offset:3072 lds
    v_mfma_f32_16x16x32_bf16 v[136:139], a[168:171], a[48:51], v[136:139]
    s_waitcnt lgkmcnt(7)
    ds_read_b64_tr_b16 a[190:191], v31 offset:12288
    ds_read_b64_tr_b16 a[160:161], v32 offset:0
    v_mfma_f32_16x16x32_bf16 v[136:139], a[172:175], a[56:59], v[136:139]
    s_add_u32 s49, s44, 2621696
    ds_read_b64_tr_b16 a[162:163], v32 offset:4096
    v_mfma_f32_16x16x32_bf16 v[140:143], a[168:171], a[52:55], v[140:143]
    s_add_u32 m0, s42, 49152
    ds_read_b64_tr_b16 a[164:165], v32 offset:8192
    v_mfma_f32_16x16x32_bf16 v[140:143], a[172:175], a[60:63], v[140:143]
    s_waitcnt lgkmcnt(9)
    buffer_load_dwordx4 v42, s[16:19], s49 offen lds
    v_mfma_f32_16x16x32_bf16 v[144:147], a[176:179], a[48:51], v[144:147]
    s_waitcnt lgkmcnt(7)
    ds_read_b64_tr_b16 a[166:167], v32 offset:12288
    ds_read_b64_tr_b16 a[168:169], v33 offset:0
    v_mfma_f32_16x16x32_bf16 v[144:147], a[180:183], a[56:59], v[144:147]
    ds_read_b64_tr_b16 a[170:171], v33 offset:4096
    v_mfma_f32_16x16x32_bf16 v[148:151], a[176:179], a[52:55], v[148:151]
    ds_read_b64_tr_b16 a[172:173], v33 offset:8192
    v_mfma_f32_16x16x32_bf16 v[148:151], a[180:183], a[60:63], v[148:151]
    s_waitcnt lgkmcnt(9)
    buffer_load_dwordx4 v43, s[16:19], s49 offen offset:1024 lds
    v_mfma_f32_16x16x32_bf16 v[152:155], a[184:187], a[48:51], v[152:155]
    s_waitcnt lgkmcnt(7)
    ds_read_b64_tr_b16 a[174:175], v33 offset:12288
    ds_read_b64_tr_b16 a[176:177], v34 offset:0
    v_mfma_f32_16x16x32_bf16 v[152:155], a[188:191], a[56:59], v[152:155]
    ds_read_b64_tr_b16 a[178:179], v34 offset:4096
    v_mfma_f32_16x16x32_bf16 v[156:159], a[184:187], a[52:55], v[156:159]
    ds_read_b64_tr_b16 a[180:181], v34 offset:8192
    v_mfma_f32_16x16x32_bf16 v[156:159], a[188:191], a[60:63], v[156:159]
    s_waitcnt lgkmcnt(9)
    buffer_load_dwordx4 v44, s[16:19], s49 offen offset:2048 lds
    v_mfma_f32_16x16x32_bf16 v[160:163], a[160:163], a[48:51], v[160:163]
    s_waitcnt lgkmcnt(7)
    ds_read_b64_tr_b16 a[182:183], v34 offset:12288
    ds_read_b64_tr_b16 a[184:185], v35 offset:0
    v_mfma_f32_16x16x32_bf16 v[160:163], a[164:167], a[56:59], v[160:163]
    ds_read_b64_tr_b16 a[186:187], v35 offset:4096
    v_mfma_f32_16x16x32_bf16 v[164:167], a[160:163], a[52:55], v[164:167]
    ds_read_b64_tr_b16 a[188:189], v35 offset:8192
    v_mfma_f32_16x16x32_bf16 v[164:167], a[164:167], a[60:63], v[164:167]
    s_waitcnt lgkmcnt(9)
    buffer_load_dwordx4 v45, s[16:19], s49 offen offset:3072 lds
    v_mfma_f32_16x16x32_bf16 v[168:171], a[168:171], a[48:51], v[168:171]
    s_waitcnt lgkmcnt(7)
    ds_read_b64_tr_b16 a[190:191], v35 offset:12288
    ds_read_b64_tr_b16 a[160:161], v28 offset:16384
    v_mfma_f32_16x16x32_bf16 v[168:171], a[172:175], a[56:59], v[168:171]
    ds_read_b64_tr_b16 a[162:163], v28 offset:20480
    v_mfma_f32_16x16x32_bf16 v[172:175], a[168:171], a[52:55], v[172:175]
    ds_read_b64_tr_b16 a[164:165], v28 offset:24576
    v_mfma_f32_16x16x32_bf16 v[172:175], a[172:175], a[60:63], v[172:175]
    s_waitcnt lgkmcnt(9)
    buffer_load_dwordx4 a[80:83], v51, s[24:27], s46 offen offset:1280 sc1
    v_mfma_f32_16x16x32_bf16 v[176:179], a[176:179], a[48:51], v[176:179]
    s_waitcnt lgkmcnt(7)
    ds_read_b64_tr_b16 a[166:167], v28 offset:28672
    ds_read_b64_tr_b16 a[168:169], v29 offset:16384
    v_mfma_f32_16x16x32_bf16 v[176:179], a[180:183], a[56:59], v[176:179]
    ds_read_b64_tr_b16 a[170:171], v29 offset:20480
    v_mfma_f32_16x16x32_bf16 v[180:183], a[176:179], a[52:55], v[180:183]
    ds_read_b64_tr_b16 a[172:173], v29 offset:24576
    v_mfma_f32_16x16x32_bf16 v[180:183], a[180:183], a[60:63], v[180:183]
    s_waitcnt lgkmcnt(9)
    buffer_load_dwordx4 a[88:91], v51, s[24:27], s46 offen offset:1408 sc1
    v_mfma_f32_16x16x32_bf16 v[184:187], a[184:187], a[48:51], v[184:187]
    s_waitcnt lgkmcnt(7)
    ds_read_b64_tr_b16 a[174:175], v29 offset:28672
    ds_read_b64_tr_b16 a[176:177], v30 offset:16384
    v_mfma_f32_16x16x32_bf16 v[184:187], a[188:191], a[56:59], v[184:187]
    ds_read_b64_tr_b16 a[178:179], v30 offset:20480
    v_mfma_f32_16x16x32_bf16 v[188:191], a[184:187], a[52:55], v[188:191]
    ds_read_b64_tr_b16 a[180:181], v30 offset:24576
    v_mfma_f32_16x16x32_bf16 v[188:191], a[188:191], a[60:63], v[188:191]
    s_waitcnt lgkmcnt(9)
    buffer_load_dwordx4 a[84:87], v51, s[24:27], s43 offen offset:1280 sc1
    v_mfma_f32_16x16x32_bf16 v[192:195], a[160:163], a[48:51], v[192:195]
    s_waitcnt lgkmcnt(7)
    ds_read_b64_tr_b16 a[182:183], v30 offset:28672
    ds_read_b64_tr_b16 a[184:185], v31 offset:16384
    v_mfma_f32_16x16x32_bf16 v[192:195], a[164:167], a[56:59], v[192:195]
    ds_read_b64_tr_b16 a[186:187], v31 offset:20480
    v_mfma_f32_16x16x32_bf16 v[196:199], a[160:163], a[52:55], v[196:199]
    ds_read_b64_tr_b16 a[188:189], v31 offset:24576
    v_mfma_f32_16x16x32_bf16 v[196:199], a[164:167], a[60:63], v[196:199]
    s_waitcnt lgkmcnt(9)
    buffer_load_dwordx4 a[92:95], v51, s[24:27], s43 offen offset:1408 sc1
    v_mfma_f32_16x16x32_bf16 v[200:203], a[168:171], a[48:51], v[200:203]
    s_waitcnt lgkmcnt(7)
    ds_read_b64_tr_b16 a[190:191], v31 offset:28672
    ds_read_b64_tr_b16 a[160:161], v32 offset:16384
    v_mfma_f32_16x16x32_bf16 v[200:203], a[172:175], a[56:59], v[200:203]
    ds_read_b64_tr_b16 a[162:163], v32 offset:20480
    v_mfma_f32_16x16x32_bf16 v[204:207], a[168:171], a[52:55], v[204:207]
    ds_read_b64_tr_b16 a[164:165], v32 offset:24576
    v_mfma_f32_16x16x32_bf16 v[204:207], a[172:175], a[60:63], v[204:207]
    s_waitcnt lgkmcnt(9)
    buffer_load_dword v78, v120, s[8:11], 0 offen
    v_mfma_f32_16x16x32_bf16 v[208:211], a[176:179], a[48:51], v[208:211]
    s_waitcnt lgkmcnt(7)
    ds_read_b64_tr_b16 a[166:167], v32 offset:28672
    ds_read_b64_tr_b16 a[168:169], v33 offset:16384
    v_mfma_f32_16x16x32_bf16 v[208:211], a[180:183], a[56:59], v[208:211]
    ds_read_b64_tr_b16 a[170:171], v33 offset:20480
    v_mfma_f32_16x16x32_bf16 v[212:215], a[176:179], a[52:55], v[212:215]
    ds_read_b64_tr_b16 a[172:173], v33 offset:24576
    v_mfma_f32_16x16x32_bf16 v[212:215], a[180:183], a[60:63], v[212:215]
    s_waitcnt lgkmcnt(9)
    buffer_load_dword v79, v121, s[12:15], 0 offen
    v_mfma_f32_16x16x32_bf16 v[216:219], a[184:187], a[48:51], v[216:219]
    s_waitcnt lgkmcnt(7)
    ds_read_b64_tr_b16 a[174:175], v33 offset:28672
    ds_read_b64_tr_b16 a[176:177], v34 offset:16384
    v_mfma_f32_16x16x32_bf16 v[216:219], a[188:191], a[56:59], v[216:219]
    ds_read_b64_tr_b16 a[178:179], v34 offset:20480
    v_mfma_f32_16x16x32_bf16 v[220:223], a[184:187], a[52:55], v[220:223]
    ds_read_b64_tr_b16 a[180:181], v34 offset:24576
    v_mfma_f32_16x16x32_bf16 v[220:223], a[188:191], a[60:63], v[220:223]
    s_waitcnt lgkmcnt(9)
    ds_read_b64_tr_b16 a[182:183], v34 offset:28672
    v_mfma_f32_16x16x32_bf16 v[224:227], a[160:163], a[48:51], v[224:227]
    s_waitcnt lgkmcnt(8)
    ds_read_b64_tr_b16 a[184:185], v35 offset:16384
    v_mfma_f32_16x16x32_bf16 v[224:227], a[164:167], a[56:59], v[224:227]
    ds_read_b64_tr_b16 a[186:187], v35 offset:20480
    v_mfma_f32_16x16x32_bf16 v[228:231], a[160:163], a[52:55], v[228:231]
    ds_read_b64_tr_b16 a[188:189], v35 offset:24576
    v_mfma_f32_16x16x32_bf16 v[228:231], a[164:167], a[60:63], v[228:231]
    s_waitcnt lgkmcnt(9)
    ds_read_b64_tr_b16 a[190:191], v35 offset:28672
    s_waitcnt vmcnt(18)
    s_barrier
    v_mfma_f32_16x16x32_bf16 v[232:235], a[168:171], a[48:51], v[232:235]
    s_waitcnt lgkmcnt(8)
    ds_read_b64_tr_b16 a[160:161], v12 offset:0
    v_mfma_f32_16x16x32_bf16 v[232:235], a[172:175], a[56:59], v[232:235]
    s_add_u32 s49, s44, 3145728
    ds_read_b64_tr_b16 a[162:163], v12 offset:4096
    v_mfma_f32_16x16x32_bf16 v[236:239], a[168:171], a[52:55], v[236:239]
    s_add_u32 m0, s42, 65536
    ds_read_b64_tr_b16 a[164:165], v12 offset:8192
    v_mfma_f32_16x16x32_bf16 v[236:239], a[172:175], a[60:63], v[236:239]
    s_waitcnt lgkmcnt(9)
    buffer_load_dwordx4 v42, s[16:19], s49 offen lds
    v_mfma_f32_16x16x32_bf16 v[240:243], a[176:179], a[48:51], v[240:243]
    s_waitcnt lgkmcnt(7)
    ds_read_b64_tr_b16 a[166:167], v12 offset:12288
    ds_read_b64_tr_b16 a[168:169], v13 offset:0
    v_mfma_f32_16x16x32_bf16 v[240:243], a[180:183], a[56:59], v[240:243]
    ds_read_b64_tr_b16 a[170:171], v13 offset:4096
    v_mfma_f32_16x16x32_bf16 v[244:247], a[176:179], a[52:55], v[244:247]
    ds_read_b64_tr_b16 a[172:173], v13 offset:8192
    v_mfma_f32_16x16x32_bf16 v[244:247], a[180:183], a[60:63], v[244:247]
    s_waitcnt lgkmcnt(9)
    buffer_load_dwordx4 v43, s[16:19], s49 offen offset:1024 lds
    v_mfma_f32_16x16x32_bf16 v[248:251], a[184:187], a[48:51], v[248:251]
    s_waitcnt lgkmcnt(7)
    ds_read_b64_tr_b16 a[174:175], v13 offset:12288
    ds_read_b64_tr_b16 a[176:177], v14 offset:0
    v_mfma_f32_16x16x32_bf16 v[248:251], a[188:191], a[56:59], v[248:251]
    ds_read_b64_tr_b16 a[178:179], v14 offset:4096
    v_mfma_f32_16x16x32_bf16 v[252:255], a[184:187], a[52:55], v[252:255]
    ds_read_b64_tr_b16 a[180:181], v14 offset:8192
    v_mfma_f32_16x16x32_bf16 v[252:255], a[188:191], a[60:63], v[252:255]
    s_waitcnt vmcnt(19)
    s_waitcnt lgkmcnt(9)
    buffer_load_dwordx4 v44, s[16:19], s49 offen offset:2048 lds
    v_mfma_f32_16x16x32_bf16 v[128:131], a[160:163], a[64:67], v[128:131]
    s_waitcnt vmcnt(19)
    s_waitcnt lgkmcnt(7)
    ds_read_b64_tr_b16 a[182:183], v14 offset:12288
    ds_read_b64_tr_b16 a[184:185], v15 offset:0
    v_mfma_f32_16x16x32_bf16 v[128:131], a[164:167], a[72:75], v[128:131]
    s_waitcnt vmcnt(18)
    ds_read_b64_tr_b16 a[186:187], v15 offset:4096
    v_mfma_f32_16x16x32_bf16 v[132:135], a[160:163], a[68:71], v[132:135]
    s_waitcnt vmcnt(17)
    ds_read_b64_tr_b16 a[188:189], v15 offset:8192
    v_mfma_f32_16x16x32_bf16 v[132:135], a[164:167], a[76:79], v[132:135]
    s_waitcnt lgkmcnt(9)
    buffer_load_dwordx4 v45, s[16:19], s49 offen offset:3072 lds
    v_mfma_f32_16x16x32_bf16 v[136:139], a[168:171], a[64:67], v[136:139]
    s_waitcnt lgkmcnt(7)
    ds_read_b64_tr_b16 a[190:191], v15 offset:12288
    ds_read_b64_tr_b16 a[160:161], v16 offset:0
    v_mfma_f32_16x16x32_bf16 v[136:139], a[172:175], a[72:75], v[136:139]
    s_add_u32 s49, s44, 3145984
    ds_read_b64_tr_b16 a[162:163], v16 offset:4096
    v_mfma_f32_16x16x32_bf16 v[140:143], a[168:171], a[68:71], v[140:143]
    s_add_u32 m0, s42, 81920
    ds_read_b64_tr_b16 a[164:165], v16 offset:8192
    v_mfma_f32_16x16x32_bf16 v[140:143], a[172:175], a[76:79], v[140:143]
    s_waitcnt lgkmcnt(9)
    buffer_load_dwordx4 v42, s[16:19], s49 offen lds
    v_mfma_f32_16x16x32_bf16 v[144:147], a[176:179], a[64:67], v[144:147]
    s_waitcnt lgkmcnt(7)
    ds_read_b64_tr_b16 a[166:167], v16 offset:12288
    ds_read_b64_tr_b16 a[168:169], v17 offset:0
    v_mfma_f32_16x16x32_bf16 v[144:147], a[180:183], a[72:75], v[144:147]
    ds_read_b64_tr_b16 a[170:171], v17 offset:4096
    v_mfma_f32_16x16x32_bf16 v[148:151], a[176:179], a[68:71], v[148:151]
    ds_read_b64_tr_b16 a[172:173], v17 offset:8192
    v_mfma_f32_16x16x32_bf16 v[148:151], a[180:183], a[76:79], v[148:151]
    s_waitcnt lgkmcnt(9)
    buffer_load_dwordx4 v43, s[16:19], s49 offen offset:1024 lds
    v_mfma_f32_16x16x32_bf16 v[152:155], a[184:187], a[64:67], v[152:155]
    s_waitcnt lgkmcnt(7)
    ds_read_b64_tr_b16 a[174:175], v17 offset:12288
    ds_read_b64_tr_b16 a[176:177], v18 offset:0
    v_mfma_f32_16x16x32_bf16 v[152:155], a[188:191], a[72:75], v[152:155]
    ds_read_b64_tr_b16 a[178:179], v18 offset:4096
    v_mfma_f32_16x16x32_bf16 v[156:159], a[184:187], a[68:71], v[156:159]
    ds_read_b64_tr_b16 a[180:181], v18 offset:8192
    v_mfma_f32_16x16x32_bf16 v[156:159], a[188:191], a[76:79], v[156:159]
    s_waitcnt lgkmcnt(9)
    buffer_load_dwordx4 v44, s[16:19], s49 offen offset:2048 lds
    v_mfma_f32_16x16x32_bf16 v[160:163], a[160:163], a[64:67], v[160:163]
    s_waitcnt lgkmcnt(7)
    ds_read_b64_tr_b16 a[182:183], v18 offset:12288
    ds_read_b64_tr_b16 a[184:185], v19 offset:0
    v_mfma_f32_16x16x32_bf16 v[160:163], a[164:167], a[72:75], v[160:163]
    ds_read_b64_tr_b16 a[186:187], v19 offset:4096
    v_mfma_f32_16x16x32_bf16 v[164:167], a[160:163], a[68:71], v[164:167]
    ds_read_b64_tr_b16 a[188:189], v19 offset:8192
    v_mfma_f32_16x16x32_bf16 v[164:167], a[164:167], a[76:79], v[164:167]
    s_waitcnt lgkmcnt(9)
    buffer_load_dwordx4 v45, s[16:19], s49 offen offset:3072 lds
    v_mfma_f32_16x16x32_bf16 v[168:171], a[168:171], a[64:67], v[168:171]
    s_waitcnt lgkmcnt(7)
    ds_read_b64_tr_b16 a[190:191], v19 offset:12288
    ds_read_b64_tr_b16 a[160:161], v12 offset:16384
    v_mfma_f32_16x16x32_bf16 v[168:171], a[172:175], a[72:75], v[168:171]
    ds_read_b64_tr_b16 a[162:163], v12 offset:20480
    v_mfma_f32_16x16x32_bf16 v[172:175], a[168:171], a[68:71], v[172:175]
    ds_read_b64_tr_b16 a[164:165], v12 offset:24576
    v_mfma_f32_16x16x32_bf16 v[172:175], a[172:175], a[76:79], v[172:175]
    s_waitcnt lgkmcnt(9)
    buffer_load_dwordx4 a[96:99], v51, s[24:27], s46 offen offset:1536 sc1
    v_mfma_f32_16x16x32_bf16 v[176:179], a[176:179], a[64:67], v[176:179]
    s_waitcnt lgkmcnt(7)
    ds_read_b64_tr_b16 a[166:167], v12 offset:28672
    ds_read_b64_tr_b16 a[168:169], v13 offset:16384
    v_mfma_f32_16x16x32_bf16 v[176:179], a[180:183], a[72:75], v[176:179]
    ds_read_b64_tr_b16 a[170:171], v13 offset:20480
    v_mfma_f32_16x16x32_bf16 v[180:183], a[176:179], a[68:71], v[180:183]
    ds_read_b64_tr_b16 a[172:173], v13 offset:24576
    v_mfma_f32_16x16x32_bf16 v[180:183], a[180:183], a[76:79], v[180:183]
    s_waitcnt lgkmcnt(9)
    buffer_load_dwordx4 a[104:107], v51, s[24:27], s46 offen offset:1664 sc1
    v_mfma_f32_16x16x32_bf16 v[184:187], a[184:187], a[64:67], v[184:187]
    s_waitcnt lgkmcnt(7)
    ds_read_b64_tr_b16 a[174:175], v13 offset:28672
    ds_read_b64_tr_b16 a[176:177], v14 offset:16384
    v_mfma_f32_16x16x32_bf16 v[184:187], a[188:191], a[72:75], v[184:187]
    ds_read_b64_tr_b16 a[178:179], v14 offset:20480
    v_mfma_f32_16x16x32_bf16 v[188:191], a[184:187], a[68:71], v[188:191]
    ds_read_b64_tr_b16 a[180:181], v14 offset:24576
    v_mfma_f32_16x16x32_bf16 v[188:191], a[188:191], a[76:79], v[188:191]
    s_waitcnt lgkmcnt(9)
    buffer_load_dwordx4 a[100:103], v51, s[24:27], s43 offen offset:1536 sc1
    v_mfma_f32_16x16x32_bf16 v[192:195], a[160:163], a[64:67], v[192:195]
    s_waitcnt lgkmcnt(7)
    ds_read_b64_tr_b16 a[182:183], v14 offset:28672
    ds_read_b64_tr_b16 a[184:185], v15 offset:16384
    v_mfma_f32_16x16x32_bf16 v[192:195], a[164:167], a[72:75], v[192:195]
    ds_read_b64_tr_b16 a[186:187], v15 offset:20480
    v_mfma_f32_16x16x32_bf16 v[196:199], a[160:163], a[68:71], v[196:199]
    ds_read_b64_tr_b16 a[188:189], v15 offset:24576
    v_mfma_f32_16x16x32_bf16 v[196:199], a[164:167], a[76:79], v[196:199]
    s_waitcnt lgkmcnt(9)
    buffer_load_dwordx4 a[108:111], v51, s[24:27], s43 offen offset:1664 sc1
    v_mfma_f32_16x16x32_bf16 v[200:203], a[168:171], a[64:67], v[200:203]
    s_waitcnt lgkmcnt(7)
    ds_read_b64_tr_b16 a[190:191], v15 offset:28672
    ds_read_b64_tr_b16 a[160:161], v16 offset:16384
    v_mfma_f32_16x16x32_bf16 v[200:203], a[172:175], a[72:75], v[200:203]
    ds_read_b64_tr_b16 a[162:163], v16 offset:20480
    v_mfma_f32_16x16x32_bf16 v[204:207], a[168:171], a[68:71], v[204:207]
    ds_read_b64_tr_b16 a[164:165], v16 offset:24576
    v_mfma_f32_16x16x32_bf16 v[204:207], a[172:175], a[76:79], v[204:207]
    s_waitcnt lgkmcnt(9)
    ds_read_b64_tr_b16 a[166:167], v16 offset:28672
    v_mfma_f32_16x16x32_bf16 v[208:211], a[176:179], a[64:67], v[208:211]
    s_waitcnt lgkmcnt(8)
    ds_read_b64_tr_b16 a[168:169], v17 offset:16384
    v_mfma_f32_16x16x32_bf16 v[208:211], a[180:183], a[72:75], v[208:211]
    ds_read_b64_tr_b16 a[170:171], v17 offset:20480
    v_mfma_f32_16x16x32_bf16 v[212:215], a[176:179], a[68:71], v[212:215]
    ds_read_b64_tr_b16 a[172:173], v17 offset:24576
    v_mfma_f32_16x16x32_bf16 v[212:215], a[180:183], a[76:79], v[212:215]
    s_waitcnt lgkmcnt(9)
    ds_read_b64_tr_b16 a[174:175], v17 offset:28672
    v_mfma_f32_16x16x32_bf16 v[216:219], a[184:187], a[64:67], v[216:219]
    s_waitcnt lgkmcnt(8)
    ds_read_b64_tr_b16 a[176:177], v18 offset:16384
    v_mfma_f32_16x16x32_bf16 v[216:219], a[188:191], a[72:75], v[216:219]
    ds_read_b64_tr_b16 a[178:179], v18 offset:20480
    v_mfma_f32_16x16x32_bf16 v[220:223], a[184:187], a[68:71], v[220:223]
    ds_read_b64_tr_b16 a[180:181], v18 offset:24576
    v_mfma_f32_16x16x32_bf16 v[220:223], a[188:191], a[76:79], v[220:223]
    s_waitcnt lgkmcnt(9)
    ds_read_b64_tr_b16 a[182:183], v18 offset:28672
    v_mfma_f32_16x16x32_bf16 v[224:227], a[160:163], a[64:67], v[224:227]
    s_waitcnt lgkmcnt(8)
    ds_read_b64_tr_b16 a[184:185], v19 offset:16384
    v_mfma_f32_16x16x32_bf16 v[224:227], a[164:167], a[72:75], v[224:227]
    ds_read_b64_tr_b16 a[186:187], v19 offset:20480
    v_mfma_f32_16x16x32_bf16 v[228:231], a[160:163], a[68:71], v[228:231]
    ds_read_b64_tr_b16 a[188:189], v19 offset:24576
    v_mfma_f32_16x16x32_bf16 v[228:231], a[164:167], a[76:79], v[228:231]
    s_waitcnt lgkmcnt(9)
    ds_read_b64_tr_b16 a[190:191], v19 offset:28672
    s_waitcnt vmcnt(18)
    s_barrier
    v_mfma_f32_16x16x32_bf16 v[232:235], a[168:171], a[64:67], v[232:235]
    s_waitcnt lgkmcnt(8)
    ds_read_b64_tr_b16 a[160:161], v12 offset:32768
    v_mfma_f32_16x16x32_bf16 v[232:235], a[172:175], a[72:75], v[232:235]
    s_add_u32 s49, s44, 3670016
    ds_read_b64_tr_b16 a[162:163], v12 offset:36864
    v_mfma_f32_16x16x32_bf16 v[236:239], a[168:171], a[68:71], v[236:239]
    s_add_u32 m0, s42, 98304
    ds_read_b64_tr_b16 a[164:165], v12 offset:40960
    v_mfma_f32_16x16x32_bf16 v[236:239], a[172:175], a[76:79], v[236:239]
    s_waitcnt lgkmcnt(9)
    buffer_load_dwordx4 v42, s[16:19], s49 offen lds
    v_mfma_f32_16x16x32_bf16 v[240:243], a[176:179], a[64:67], v[240:243]
    s_waitcnt lgkmcnt(7)
    ds_read_b64_tr_b16 a[166:167], v12 offset:45056
    ds_read_b64_tr_b16 a[168:169], v13 offset:32768
    v_mfma_f32_16x16x32_bf16 v[240:243], a[180:183], a[72:75], v[240:243]
    ds_read_b64_tr_b16 a[170:171], v13 offset:36864
    v_mfma_f32_16x16x32_bf16 v[244:247], a[176:179], a[68:71], v[244:247]
    ds_read_b64_tr_b16 a[172:173], v13 offset:40960
    v_mfma_f32_16x16x32_bf16 v[244:247], a[180:183], a[76:79], v[244:247]
    s_waitcnt lgkmcnt(9)
    buffer_load_dwordx4 v43, s[16:19], s49 offen offset:1024 lds
    v_mfma_f32_16x16x32_bf16 v[248:251], a[184:187], a[64:67], v[248:251]
    s_waitcnt lgkmcnt(7)
    ds_read_b64_tr_b16 a[174:175], v13 offset:45056
    ds_read_b64_tr_b16 a[176:177], v14 offset:32768
    v_mfma_f32_16x16x32_bf16 v[248:251], a[188:191], a[72:75], v[248:251]
    ds_read_b64_tr_b16 a[178:179], v14 offset:36864
    v_mfma_f32_16x16x32_bf16 v[252:255], a[184:187], a[68:71], v[252:255]
    ds_read_b64_tr_b16 a[180:181], v14 offset:40960
    v_mfma_f32_16x16x32_bf16 v[252:255], a[188:191], a[76:79], v[252:255]
    s_waitcnt vmcnt(19)
    s_waitcnt lgkmcnt(9)
    buffer_load_dwordx4 v44, s[16:19], s49 offen offset:2048 lds
    v_mfma_f32_16x16x32_bf16 v[128:131], a[160:163], a[80:83], v[128:131]
    s_waitcnt vmcnt(19)
    s_waitcnt lgkmcnt(7)
    ds_read_b64_tr_b16 a[182:183], v14 offset:45056
    ds_read_b64_tr_b16 a[184:185], v15 offset:32768
Ltour1:
    s_cbranch_execz Ltour5
    v_mfma_f32_16x16x32_bf16 v[128:131], a[164:167], a[88:91], v[128:131]
    s_waitcnt vmcnt(18)
    ds_read_b64_tr_b16 a[186:187], v15 offset:36864
    v_accvgpr_write_b32 a0, 0
    v_mfma_f32_16x16x32_bf16 v[132:135], a[160:163], a[84:87], v[132:135]
    s_waitcnt vmcnt(17)
    ds_read_b64_tr_b16 a[188:189], v15 offset:40960
    v_accvgpr_write_b32 a1, 0
    v_mfma_f32_16x16x32_bf16 v[132:135], a[164:167], a[92:95], v[132:135]
    s_waitcnt lgkmcnt(9)
    buffer_load_dwordx4 v45, s[16:19], s49 offen offset:3072 lds
    v_mfma_f32_16x16x32_bf16 v[136:139], a[168:171], a[80:83], v[136:139]
    s_waitcnt lgkmcnt(7)
    ds_read_b64_tr_b16 a[190:191], v15 offset:45056
    ds_read_b64_tr_b16 a[160:161], v16 offset:32768
    v_mfma_f32_16x16x32_bf16 v[136:139], a[172:175], a[88:91], v[136:139]
    s_add_u32 s49, s44, 3670272
    ds_read_b64_tr_b16 a[162:163], v16 offset:36864
    v_accvgpr_write_b32 a2, 0
    v_mfma_f32_16x16x32_bf16 v[140:143], a[168:171], a[84:87], v[140:143]
    s_add_u32 m0, s42, 114688
    ds_read_b64_tr_b16 a[164:165], v16 offset:40960
    v_accvgpr_write_b32 a3, 0
    v_mfma_f32_16x16x32_bf16 v[140:143], a[172:175], a[92:95], v[140:143]
    s_waitcnt lgkmcnt(9)
    buffer_load_dwordx4 v42, s[16:19], s49 offen lds
    v_mfma_f32_16x16x32_bf16 v[144:147], a[176:179], a[80:83], v[144:147]
    s_waitcnt lgkmcnt(7)
    ds_read_b64_tr_b16 a[166:167], v16 offset:45056
    ds_read_b64_tr_b16 a[168:169], v17 offset:32768
    v_mfma_f32_16x16x32_bf16 v[144:147], a[180:183], a[88:91], v[144:147]
    ds_read_b64_tr_b16 a[170:171], v17 offset:36864
    v_accvgpr_write_b32 a4, 0
    v_mfma_f32_16x16x32_bf16 v[148:151], a[176:179], a[84:87], v[148:151]
    ds_read_b64_tr_b16 a[172:173], v17 offset:40960
    v_accvgpr_write_b32 a5, 0
    v_mfma_f32_16x16x32_bf16 v[148:151], a[180:183], a[92:95], v[148:151]
    s_waitcnt lgkmcnt(9)
    buffer_load_dwordx4 v43, s[16:19], s49 offen offset:1024 lds
    v_mfma_f32_16x16x32_bf16 v[152:155], a[184:187], a[80:83], v[152:155]
    s_waitcnt lgkmcnt(7)
    ds_read_b64_tr_b16 a[174:175], v17 offset:45056
    ds_read_b64_tr_b16 a[176:177], v18 offset:32768
    v_mfma_f32_16x16x32_bf16 v[152:155], a[188:191], a[88:91], v[152:155]
    ds_read_b64_tr_b16 a[178:179], v18 offset:36864
    v_accvgpr_write_b32 a6, 0
    v_mfma_f32_16x16x32_bf16 v[156:159], a[184:187], a[84:87], v[156:159]
    ds_read_b64_tr_b16 a[180:181], v18 offset:40960
    v_accvgpr_write_b32 a7, 0
    v_mfma_f32_16x16x32_bf16 v[156:159], a[188:191], a[92:95], v[156:159]
    s_waitcnt lgkmcnt(9)
    buffer_load_dwordx4 v44, s[16:19], s49 offen offset:2048 lds
    v_mfma_f32_16x16x32_bf16 v[160:163], a[160:163], a[80:83], v[160:163]
    s_waitcnt lgkmcnt(7)
    ds_read_b64_tr_b16 a[182:183], v18 offset:45056
    ds_read_b64_tr_b16 a[184:185], v19 offset:32768
    v_mfma_f32_16x16x32_bf16 v[160:163], a[164:167], a[88:91], v[160:163]
    ds_read_b64_tr_b16 a[186:187], v19 offset:36864
    v_accvgpr_write_b32 a8, 0
    v_mfma_f32_16x16x32_bf16 v[164:167], a[160:163], a[84:87], v[164:167]
    ds_read_b64_tr_b16 a[188:189], v19 offset:40960
    v_accvgpr_write_b32 a9, 0
    v_mfma_f32_16x16x32_bf16 v[164:167], a[164:167], a[92:95], v[164:167]
    s_waitcnt lgkmcnt(9)
    buffer_load_dwordx4 v45, s[16:19], s49 offen offset:3072 lds
    v_mfma_f32_16x16x32_bf16 v[168:171], a[168:171], a[80:83], v[168:171]
    s_waitcnt lgkmcnt(7)
    ds_read_b64_tr_b16 a[190:191], v19 offset:45056
    ds_read_b64_tr_b16 a[160:161], v12 offset:49152
    v_mfma_f32_16x16x32_bf16 v[168:171], a[172:175], a[88:91], v[168:171]
    ds_read_b64_tr_b16 a[162:163], v12 offset:53248
    v_accvgpr_write_b32 a10, 0
    v_mfma_f32_16x16x32_bf16 v[172:175], a[168:171], a[84:87], v[172:175]
    ds_read_b64_tr_b16 a[164:165], v12 offset:57344
    v_accvgpr_write_b32 a11, 0
    v_mfma_f32_16x16x32_bf16 v[172:175], a[172:175], a[92:95], v[172:175]
    s_waitcnt lgkmcnt(9)
    buffer_load_dwordx4 a[112:115], v51, s[24:27], s46 offen offset:1792 sc1
    v_mfma_f32_16x16x32_bf16 v[176:179], a[176:179], a[80:83], v[176:179]
    s_waitcnt lgkmcnt(7)
    ds_read_b64_tr_b16 a[166:167], v12 offset:61440
    ds_read_b64_tr_b16 a[168:169], v13 offset:49152
    v_mfma_f32_16x16x32_bf16 v[176:179], a[180:183], a[88:91], v[176:179]
    ds_read_b64_tr_b16 a[170:171], v13 offset:53248
    v_accvgpr_write_b32 a12, 0
    v_mfma_f32_16x16x32_bf16 v[180:183], a[176:179], a[84:87], v[180:183]
    ds_read_b64_tr_b16 a[172:173], v13 offset:57344
    v_accvgpr_write_b32 a13, 0
    v_mfma_f32_16x16x32_bf16 v[180:183], a[180:183], a[92:95], v[180:183]
    s_waitcnt lgkmcnt(9)
    buffer_load_dwordx4 a[120:123], v51, s[24:27], s46 offen offset:1920 sc1
    v_mfma_f32_16x16x32_bf16 v[184:187], a[184:187], a[80:83], v[184:187]
    s_waitcnt lgkmcnt(7)
    ds_read_b64_tr_b16 a[174:175], v13 offset:61440
    ds_read_b64_tr_b16 a[176:177], v14 offset:49152
    v_mfma_f32_16x16x32_bf16 v[184:187], a[188:191], a[88:91], v[184:187]
    ds_read_b64_tr_b16 a[178:179], v14 offset:53248
    v_accvgpr_write_b32 a14, 0
    v_mfma_f32_16x16x32_bf16 v[188:191], a[184:187], a[84:87], v[188:191]
    ds_read_b64_tr_b16 a[180:181], v14 offset:57344
    v_accvgpr_write_b32 a15, 0
    v_mfma_f32_16x16x32_bf16 v[188:191], a[188:191], a[92:95], v[188:191]
    s_waitcnt lgkmcnt(9)
    buffer_load_dwordx4 a[116:119], v51, s[24:27], s43 offen offset:1792 sc1
    v_mfma_f32_16x16x32_bf16 v[192:195], a[160:163], a[80:83], v[192:195]
    s_waitcnt lgkmcnt(7)
    ds_read_b64_tr_b16 a[182:183], v14 offset:61440
    ds_read_b64_tr_b16 a[184:185], v15 offset:49152
    v_mfma_f32_16x16x32_bf16 v[192:195], a[164:167], a[88:91], v[192:195]
    ds_read_b64_tr_b16 a[186:187], v15 offset:53248
    v_accvgpr_write_b32 a16, 0
    v_mfma_f32_16x16x32_bf16 v[196:199], a[160:163], a[84:87], v[196:199]
    ds_read_b64_tr_b16 a[188:189], v15 offset:57344
    v_accvgpr_write_b32 a17, 0
    v_mfma_f32_16x16x32_bf16 v[196:199], a[164:167], a[92:95], v[196:199]
    s_waitcnt lgkmcnt(9)
    buffer_load_dwordx4 a[124:127], v51, s[24:27], s43 offen offset:1920 sc1
    v_mfma_f32_16x16x32_bf16 v[200:203], a[168:171], a[80:83], v[200:203]
    s_waitcnt lgkmcnt(7)
    ds_read_b64_tr_b16 a[190:191], v15 offset:61440
    ds_read_b64_tr_b16 a[160:161], v16 offset:49152
    v_mfma_f32_16x16x32_bf16 v[200:203], a[172:175], a[88:91], v[200:203]
    ds_read_b64_tr_b16 a[162:163], v16 offset:53248
    v_accvgpr_write_b32 a18, 0
    v_mfma_f32_16x16x32_bf16 v[204:207], a[168:171], a[84:87], v[204:207]
    ds_read_b64_tr_b16 a[164:165], v16 offset:57344
    v_accvgpr_write_b32 a19, 0
    v_mfma_f32_16x16x32_bf16 v[204:207], a[172:175], a[92:95], v[204:207]
    s_waitcnt lgkmcnt(9)
    ds_read_b64_tr_b16 a[166:167], v16 offset:61440
    v_accvgpr_write_b32 a20, 0
    v_mfma_f32_16x16x32_bf16 v[208:211], a[176:179], a[80:83], v[208:211]
    s_waitcnt lgkmcnt(8)
    ds_read_b64_tr_b16 a[168:169], v17 offset:49152
    v_accvgpr_write_b32 a21, 0
    v_mfma_f32_16x16x32_bf16 v[208:211], a[180:183], a[88:91], v[208:211]
    ds_read_b64_tr_b16 a[170:171], v17 offset:53248
    v_accvgpr_write_b32 a22, 0
    v_mfma_f32_16x16x32_bf16 v[212:215], a[176:179], a[84:87], v[212:215]
    ds_read_b64_tr_b16 a[172:173], v17 offset:57344
    v_accvgpr_write_b32 a23, 0
    v_mfma_f32_16x16x32_bf16 v[212:215], a[180:183], a[92:95], v[212:215]
    s_waitcnt lgkmcnt(9)
    ds_read_b64_tr_b16 a[174:175], v17 offset:61440
    v_accvgpr_write_b32 a24, 0
    v_mfma_f32_16x16x32_bf16 v[216:219], a[184:187], a[80:83], v[216:219]
    s_waitcnt lgkmcnt(8)
    ds_read_b64_tr_b16 a[176:177], v18 offset:49152
    v_accvgpr_write_b32 a25, 0
    v_mfma_f32_16x16x32_bf16 v[216:219], a[188:191], a[88:91], v[216:219]
    ds_read_b64_tr_b16 a[178:179], v18 offset:53248
    v_accvgpr_write_b32 a26, 0
    v_mfma_f32_16x16x32_bf16 v[220:223], a[184:187], a[84:87], v[220:223]
    ds_read_b64_tr_b16 a[180:181], v18 offset:57344
    v_accvgpr_write_b32 a27, 0
    v_mfma_f32_16x16x32_bf16 v[220:223], a[188:191], a[92:95], v[220:223]
    s_waitcnt lgkmcnt(9)
    ds_read_b64_tr_b16 a[182:183], v18 offset:61440
    v_accvgpr_write_b32 a28, 0
    v_mfma_f32_16x16x32_bf16 v[224:227], a[160:163], a[80:83], v[224:227]
    s_waitcnt lgkmcnt(8)
    ds_read_b64_tr_b16 a[184:185], v19 offset:49152
    v_accvgpr_write_b32 a29, 0
    v_mfma_f32_16x16x32_bf16 v[224:227], a[164:167], a[88:91], v[224:227]
    ds_read_b64_tr_b16 a[186:187], v19 offset:53248
    v_accvgpr_write_b32 a30, 0
    v_mfma_f32_16x16x32_bf16 v[228:231], a[160:163], a[84:87], v[228:231]
    ds_read_b64_tr_b16 a[188:189], v19 offset:57344
    v_accvgpr_write_b32 a31, 0
    v_mfma_f32_16x16x32_bf16 v[228:231], a[164:167], a[92:95], v[228:231]
    s_waitcnt lgkmcnt(9)
    ds_read_b64_tr_b16 a[190:191], v19 offset:61440
    v_accvgpr_write_b32 a32, 0
    s_waitcnt vmcnt(16)
    s_barrier
    v_mfma_f32_16x16x32_bf16 v[232:235], a[168:171], a[80:83], v[232:235]
    s_waitcnt lgkmcnt(8)
    ds_read_b64_tr_b16 a[160:161], v20 offset:0
    v_accvgpr_write_b32 a33, 0
    v_mfma_f32_16x16x32_bf16 v[232:235], a[172:175], a[88:91], v[232:235]
    s_add_u32 s49, s44, 4194304
    ds_read_b64_tr_b16 a[162:163], v20 offset:4096
    v_accvgpr_write_b32 a34, 0
    v_mfma_f32_16x16x32_bf16 v[236:239], a[168:171], a[84:87], v[236:239]
    s_add_u32 m0, s42, 131072
    ds_read_b64_tr_b16 a[164:165], v20 offset:8192
    v_accvgpr_write_b32 a35, 0
    v_mfma_f32_16x16x32_bf16 v[236:239], a[172:175], a[92:95], v[236:239]
    s_waitcnt lgkmcnt(9)
    buffer_load_dwordx4 v42, s[16:19], s49 offen lds
    v_mfma_f32_16x16x32_bf16 v[240:243], a[176:179], a[80:83], v[240:243]
    s_waitcnt lgkmcnt(7)
    ds_read_b64_tr_b16 a[166:167], v20 offset:12288
    ds_read_b64_tr_b16 a[168:169], v21 offset:0
    v_mfma_f32_16x16x32_bf16 v[240:243], a[180:183], a[88:91], v[240:243]
    ds_read_b64_tr_b16 a[170:171], v21 offset:4096
    v_accvgpr_write_b32 a36, 0
    v_mfma_f32_16x16x32_bf16 v[244:247], a[176:179], a[84:87], v[244:247]
    ds_read_b64_tr_b16 a[172:173], v21 offset:8192
    v_accvgpr_write_b32 a37, 0
    v_mfma_f32_16x16x32_bf16 v[244:247], a[180:183], a[92:95], v[244:247]
    s_waitcnt lgkmcnt(9)
    buffer_load_dwordx4 v43, s[16:19], s49 offen offset:1024 lds
    v_mfma_f32_16x16x32_bf16 v[248:251], a[184:187], a[80:83], v[248:251]
    s_waitcnt lgkmcnt(7)
    ds_read_b64_tr_b16 a[174:175], v21 offset:12288
    ds_read_b64_tr_b16 a[176:177], v22 offset:0
    v_mfma_f32_16x16x32_bf16 v[248:251], a[188:191], a[88:91], v[248:251]
    ds_read_b64_tr_b16 a[178:179], v22 offset:4096
    v_accvgpr_write_b32 a38, 0
    v_mfma_f32_16x16x32_bf16 v[252:255], a[184:187], a[84:87], v[252:255]
    ds_read_b64_tr_b16 a[180:181], v22 offset:8192
    v_accvgpr_write_b32 a39, 0
    v_mfma_f32_16x16x32_bf16 v[252:255], a[188:191], a[92:95], v[252:255]
    s_waitcnt vmcnt(17)
    s_waitcnt lgkmcnt(9)
    buffer_load_dwordx4 v44, s[16:19], s49 offen offset:2048 lds
    v_mfma_f32_16x16x32_bf16 v[128:131], a[160:163], a[96:99], v[128:131]
    s_waitcnt vmcnt(17)
    s_waitcnt lgkmcnt(7)
    ds_read_b64_tr_b16 a[182:183], v22 offset:12288
    ds_read_b64_tr_b16 a[184:185], v23 offset:0
    v_mfma_f32_16x16x32_bf16 v[128:131], a[164:167], a[104:107], v[128:131]
    s_waitcnt vmcnt(16)
    ds_read_b64_tr_b16 a[186:187], v23 offset:4096
    v_accvgpr_write_b32 a40, 0
    v_mfma_f32_16x16x32_bf16 v[132:135], a[160:163], a[100:103], v[132:135]
    s_waitcnt vmcnt(15)
    ds_read_b64_tr_b16 a[188:189], v23 offset:8192
    v_accvgpr_write_b32 a41, 0
    v_mfma_f32_16x16x32_bf16 v[132:135], a[164:167], a[108:111], v[132:135]
    s_waitcnt lgkmcnt(9)
    buffer_load_dwordx4 v45, s[16:19], s49 offen offset:3072 lds
    v_mfma_f32_16x16x32_bf16 v[136:139], a[168:171], a[96:99], v[136:139]
    s_waitcnt lgkmcnt(7)
    ds_read_b64_tr_b16 a[190:191], v23 offset:12288
    ds_read_b64_tr_b16 a[160:161], v24 offset:0
    v_mfma_f32_16x16x32_bf16 v[136:139], a[172:175], a[104:107], v[136:139]
    s_add_u32 s49, s44, 4194560
    ds_read_b64_tr_b16 a[162:163], v24 offset:4096
    v_accvgpr_write_b32 a42, 0
    v_mfma_f32_16x16x32_bf16 v[140:143], a[168:171], a[100:103], v[140:143]
    s_add_u32 m0, s42, 147456
    ds_read_b64_tr_b16 a[164:165], v24 offset:8192
    v_accvgpr_write_b32 a43, 0
    v_mfma_f32_16x16x32_bf16 v[140:143], a[172:175], a[108:111], v[140:143]
    s_waitcnt lgkmcnt(9)
    buffer_load_dwordx4 v42, s[16:19], s49 offen lds
    v_mfma_f32_16x16x32_bf16 v[144:147], a[176:179], a[96:99], v[144:147]
    s_waitcnt lgkmcnt(7)
    ds_read_b64_tr_b16 a[166:167], v24 offset:12288
    ds_read_b64_tr_b16 a[168:169], v25 offset:0
    v_mfma_f32_16x16x32_bf16 v[144:147], a[180:183], a[104:107], v[144:147]
    ds_read_b64_tr_b16 a[170:171], v25 offset:4096
    v_accvgpr_write_b32 a44, 0
    v_mfma_f32_16x16x32_bf16 v[148:151], a[176:179], a[100:103], v[148:151]
    ds_read_b64_tr_b16 a[172:173], v25 offset:8192
    v_accvgpr_write_b32 a45, 0
    v_mfma_f32_16x16x32_bf16 v[148:151], a[180:183], a[108:111], v[148:151]
    s_waitcnt lgkmcnt(9)
    buffer_load_dwordx4 v43, s[16:19], s49 offen offset:1024 lds
    v_mfma_f32_16x16x32_bf16 v[152:155], a[184:187], a[96:99], v[152:155]
    s_waitcnt lgkmcnt(7)
    ds_read_b64_tr_b16 a[174:175], v25 offset:12288
    ds_read_b64_tr_b16 a[176:177], v26 offset:0
    v_mfma_f32_16x16x32_bf16 v[152:155], a[188:191], a[104:107], v[152:155]
    ds_read_b64_tr_b16 a[178:179], v26 offset:4096
    v_accvgpr_write_b32 a46, 0
    v_mfma_f32_16x16x32_bf16 v[156:159], a[184:187], a[100:103], v[156:159]
    ds_read_b64_tr_b16 a[180:181], v26 offset:8192
    v_accvgpr_write_b32 a47, 0
    v_mfma_f32_16x16x32_bf16 v[156:159], a[188:191], a[108:111], v[156:159]
    s_waitcnt lgkmcnt(9)
    buffer_load_dwordx4 v44, s[16:19], s49 offen offset:2048 lds
    v_mfma_f32_16x16x32_bf16 v[160:163], a[160:163], a[96:99], v[160:163]
    s_waitcnt lgkmcnt(7)
    ds_read_b64_tr_b16 a[182:183], v26 offset:12288
    ds_read_b64_tr_b16 a[184:185], v27 offset:0
    v_mfma_f32_16x16x32_bf16 v[160:163], a[164:167], a[104:107], v[160:163]
    ds_read_b64_tr_b16 a[186:187], v27 offset:4096
    v_accvgpr_write_b32 a48, 0
    v_mfma_f32_16x16x32_bf16 v[164:167], a[160:163], a[100:103], v[164:167]
    ds_read_b64_tr_b16 a[188:189], v27 offset:8192
    v_accvgpr_write_b32 a49, 0
    v_mfma_f32_16x16x32_bf16 v[164:167], a[164:167], a[108:111], v[164:167]
    s_waitcnt lgkmcnt(9)
    buffer_load_dwordx4 v45, s[16:19], s49 offen offset:3072 lds
    v_mfma_f32_16x16x32_bf16 v[168:171], a[168:171], a[96:99], v[168:171]
    s_waitcnt lgkmcnt(7)
    ds_read_b64_tr_b16 a[190:191], v27 offset:12288
    ds_read_b64_tr_b16 a[160:161], v20 offset:16384
    v_mfma_f32_16x16x32_bf16 v[168:171], a[172:175], a[104:107], v[168:171]
    ds_read_b64_tr_b16 a[162:163], v20 offset:20480
    v_accvgpr_write_b32 a50, 0
    v_mfma_f32_16x16x32_bf16 v[172:175], a[168:171], a[100:103], v[172:175]
    ds_read_b64_tr_b16 a[164:165], v20 offset:24576
    v_accvgpr_write_b32 a51, 0
    v_mfma_f32_16x16x32_bf16 v[172:175], a[172:175], a[108:111], v[172:175]
    s_waitcnt lgkmcnt(9)
    buffer_load_dwordx4 a[128:131], v51, s[24:27], s46 offen offset:2048 sc1
    v_mfma_f32_16x16x32_bf16 v[176:179], a[176:179], a[96:99], v[176:179]
    s_waitcnt lgkmcnt(7)
    ds_read_b64_tr_b16 a[166:167], v20 offset:28672
    ds_read_b64_tr_b16 a[168:169], v21 offset:16384
    v_mfma_f32_16x16x32_bf16 v[176:179], a[180:183], a[104:107], v[176:179]
    ds_read_b64_tr_b16 a[170:171], v21 offset:20480
    v_accvgpr_write_b32 a52, 0
    v_mfma_f32_16x16x32_bf16 v[180:183], a[176:179], a[100:103], v[180:183]
    ds_read_b64_tr_b16 a[172:173], v21 offset:24576
    v_accvgpr_write_b32 a53, 0
    v_mfma_f32_16x16x32_bf16 v[180:183], a[180:183], a[108:111], v[180:183]
    s_waitcnt lgkmcnt(9)
    buffer_load_dwordx4 a[136:139], v51, s[24:27], s46 offen offset:2176 sc1
    v_mfma_f32_16x16x32_bf16 v[184:187], a[184:187], a[96:99], v[184:187]
    s_waitcnt lgkmcnt(7)
    ds_read_b64_tr_b16 a[174:175], v21 offset:28672
    ds_read_b64_tr_b16 a[176:177], v22 offset:16384
    v_mfma_f32_16x16x32_bf16 v[184:187], a[188:191], a[104:107], v[184:187]
    ds_read_b64_tr_b16 a[178:179], v22 offset:20480
    v_accvgpr_write_b32 a54, 0
    v_mfma_f32_16x16x32_bf16 v[188:191], a[184:187], a[100:103], v[188:191]
    ds_read_b64_tr_b16 a[180:181], v22 offset:24576
    v_accvgpr_write_b32 a55, 0
    v_mfma_f32_16x16x32_bf16 v[188:191], a[188:191], a[108:111], v[188:191]
    s_waitcnt lgkmcnt(9)
    buffer_load_dwordx4 a[132:135], v51, s[24:27], s43 offen offset:2048 sc1
    v_mfma_f32_16x16x32_bf16 v[192:195], a[160:163], a[96:99], v[192:195]
    s_waitcnt lgkmcnt(7)
    ds_read_b64_tr_b16 a[182:183], v22 offset:28672
    ds_read_b64_tr_b16 a[184:185], v23 offset:16384
    v_mfma_f32_16x16x32_bf16 v[192:195], a[164:167], a[104:107], v[192:195]
    ds_read_b64_tr_b16 a[186:187], v23 offset:20480
    v_accvgpr_write_b32 a56, 0
    v_mfma_f32_16x16x32_bf16 v[196:199], a[160:163], a[100:103], v[196:199]
    ds_read_b64_tr_b16 a[188:189], v23 offset:24576
    v_accvgpr_write_b32 a57, 0
    v_mfma_f32_16x16x32_bf16 v[196:199], a[164:167], a[108:111], v[196:199]
    s_waitcnt lgkmcnt(9)
    buffer_load_dwordx4 a[140:143], v51, s[24:27], s43 offen offset:2176 sc1
    v_mfma_f32_16x16x32_bf16 v[200:203], a[168:171], a[96:99], v[200:203]
    s_waitcnt lgkmcnt(7)
    ds_read_b64_tr_b16 a[190:191], v23 offset:28672
    ds_read_b64_tr_b16 a[160:161], v24 offset:16384
    v_mfma_f32_16x16x32_bf16 v[200:203], a[172:175], a[104:107], v[200:203]
    ds_read_b64_tr_b16 a[162:163], v24 offset:20480
    v_accvgpr_write_b32 a58, 0
    v_mfma_f32_16x16x32_bf16 v[204:207], a[168:171], a[100:103], v[204:207]
    ds_read_b64_tr_b16 a[164:165], v24 offset:24576
    v_accvgpr_write_b32 a59, 0
    v_mfma_f32_16x16x32_bf16 v[204:207], a[172:175], a[108:111], v[204:207]
    s_waitcnt lgkmcnt(9)
    ds_read_b64_tr_b16 a[166:167], v24 offset:28672
    v_accvgpr_write_b32 a60, 0
    v_mfma_f32_16x16x32_bf16 v[208:211], a[176:179], a[96:99], v[208:211]
    s_waitcnt lgkmcnt(8)
    ds_read_b64_tr_b16 a[168:169], v25 offset:16384
    v_accvgpr_write_b32 a61, 0
    v_mfma_f32_16x16x32_bf16 v[208:211], a[180:183], a[104:107], v[208:211]
    ds_read_b64_tr_b16 a[170:171], v25 offset:20480
    v_accvgpr_write_b32 a62, 0
    v_mfma_f32_16x16x32_bf16 v[212:215], a[176:179], a[100:103], v[212:215]
    ds_read_b64_tr_b16 a[172:173], v25 offset:24576
    v_accvgpr_write_b32 a63, 0
    v_mfma_f32_16x16x32_bf16 v[212:215], a[180:183], a[108:111], v[212:215]
    s_waitcnt lgkmcnt(9)
    ds_read_b64_tr_b16 a[174:175], v25 offset:28672
    v_accvgpr_write_b32 a64, 0
    v_mfma_f32_16x16x32_bf16 v[216:219], a[184:187], a[96:99], v[216:219]
    s_waitcnt lgkmcnt(8)
    ds_read_b64_tr_b16 a[176:177], v26 offset:16384
    v_accvgpr_write_b32 a65, 0
    v_mfma_f32_16x16x32_bf16 v[216:219], a[188:191], a[104:107], v[216:219]
    ds_read_b64_tr_b16 a[178:179], v26 offset:20480
    v_accvgpr_write_b32 a66, 0
    v_mfma_f32_16x16x32_bf16 v[220:223], a[184:187], a[100:103], v[220:223]
    ds_read_b64_tr_b16 a[180:181], v26 offset:24576
    v_accvgpr_write_b32 a67, 0
    v_mfma_f32_16x16x32_bf16 v[220:223], a[188:191], a[108:111], v[220:223]
    s_waitcnt lgkmcnt(9)
    ds_read_b64_tr_b16 a[182:183], v26 offset:28672
    v_accvgpr_write_b32 a68, 0
    v_mfma_f32_16x16x32_bf16 v[224:227], a[160:163], a[96:99], v[224:227]
    s_waitcnt lgkmcnt(8)
    ds_read_b64_tr_b16 a[184:185], v27 offset:16384
    v_accvgpr_write_b32 a69, 0
    v_mfma_f32_16x16x32_bf16 v[224:227], a[164:167], a[104:107], v[224:227]
    ds_read_b64_tr_b16 a[186:187], v27 offset:20480
    v_accvgpr_write_b32 a70, 0
    v_mfma_f32_16x16x32_bf16 v[228:231], a[160:163], a[100:103], v[228:231]
    ds_read_b64_tr_b16 a[188:189], v27 offset:24576
    v_accvgpr_write_b32 a71, 0
    v_mfma_f32_16x16x32_bf16 v[228:231], a[164:167], a[108:111], v[228:231]
    s_waitcnt lgkmcnt(9)
    ds_read_b64_tr_b16 a[190:191], v27 offset:28672
    v_accvgpr_write_b32 a72, 0
    s_waitcnt vmcnt(16)
    s_barrier
    v_mfma_f32_16x16x32_bf16 v[232:235], a[168:171], a[96:99], v[232:235]
    s_waitcnt lgkmcnt(8)
    ds_read_b64_tr_b16 a[160:161], v20 offset:32768
    v_accvgpr_write_b32 a73, 0
    v_mfma_f32_16x16x32_bf16 v[232:235], a[172:175], a[104:107], v[232:235]
    ds_read_b64_tr_b16 a[162:163], v20 offset:36864
    v_accvgpr_write_b32 a74, 0
    v_mfma_f32_16x16x32_bf16 v[236:239], a[168:171], a[100:103], v[236:239]
    s_add_u32 m0, s42, 0
    ds_read_b64_tr_b16 a[164:165], v20 offset:40960
    v_accvgpr_write_b32 a75, 0
    v_mfma_f32_16x16x32_bf16 v[236:239], a[172:175], a[108:111], v[236:239]
    s_waitcnt lgkmcnt(9)
    buffer_load_dwordx4 v36, s[8:11], s40 offen lds
    v_mfma_f32_16x16x32_bf16 v[240:243], a[176:179], a[96:99], v[240:243]
    s_waitcnt lgkmcnt(7)
    ds_read_b64_tr_b16 a[166:167], v20 offset:45056
    ds_read_b64_tr_b16 a[168:169], v21 offset:32768
    v_mfma_f32_16x16x32_bf16 v[240:243], a[180:183], a[104:107], v[240:243]
    ds_read_b64_tr_b16 a[170:171], v21 offset:36864
    v_accvgpr_write_b32 a76, 0
    v_mfma_f32_16x16x32_bf16 v[244:247], a[176:179], a[100:103], v[244:247]
    ds_read_b64_tr_b16 a[172:173], v21 offset:40960
    v_accvgpr_write_b32 a77, 0
    v_mfma_f32_16x16x32_bf16 v[244:247], a[180:183], a[108:111], v[244:247]
    s_waitcnt lgkmcnt(9)
    buffer_load_dwordx4 v37, s[8:11], s40 offen offset:1024 lds
    v_mfma_f32_16x16x32_bf16 v[248:251], a[184:187], a[96:99], v[248:251]
    s_waitcnt lgkmcnt(7)
    ds_read_b64_tr_b16 a[174:175], v21 offset:45056
    ds_read_b64_tr_b16 a[176:177], v22 offset:32768
    v_mfma_f32_16x16x32_bf16 v[248:251], a[188:191], a[104:107], v[248:251]
    ds_read_b64_tr_b16 a[178:179], v22 offset:36864
    v_accvgpr_write_b32 a78, 0
    v_mfma_f32_16x16x32_bf16 v[252:255], a[184:187], a[100:103], v[252:255]
    ds_read_b64_tr_b16 a[180:181], v22 offset:40960
    v_accvgpr_write_b32 a79, 0
    v_mfma_f32_16x16x32_bf16 v[252:255], a[188:191], a[108:111], v[252:255]
    s_waitcnt vmcnt(17)
    s_waitcnt lgkmcnt(9)
    buffer_load_dwordx4 v38, s[8:11], s40 offen offset:2048 lds
    v_mfma_f32_16x16x32_bf16 v[128:131], a[160:163], a[112:115], v[128:131]
    s_waitcnt vmcnt(17)
    s_waitcnt lgkmcnt(7)
    ds_read_b64_tr_b16 a[182:183], v22 offset:45056
    ds_read_b64_tr_b16 a[184:185], v23 offset:32768
    v_mfma_f32_16x16x32_bf16 v[128:131], a[164:167], a[120:123], v[128:131]
    s_waitcnt vmcnt(16)
    ds_read_b64_tr_b16 a[186:187], v23 offset:36864
    v_accvgpr_write_b32 a80, 0
    v_mfma_f32_16x16x32_bf16 v[132:135], a[160:163], a[116:119], v[132:135]
    s_waitcnt vmcnt(15)
    ds_read_b64_tr_b16 a[188:189], v23 offset:40960
    v_accvgpr_write_b32 a81, 0
    v_mfma_f32_16x16x32_bf16 v[132:135], a[164:167], a[124:127], v[132:135]
    s_waitcnt lgkmcnt(9)
    buffer_load_dwordx4 v39, s[8:11], s40 offen offset:3072 lds
    v_mfma_f32_16x16x32_bf16 v[136:139], a[168:171], a[112:115], v[136:139]
    s_waitcnt lgkmcnt(7)
    s_add_u32 s40, s40, 16384
    ds_read_b64_tr_b16 a[190:191], v23 offset:45056
    ds_read_b64_tr_b16 a[160:161], v24 offset:32768
    v_mfma_f32_16x16x32_bf16 v[136:139], a[172:175], a[120:123], v[136:139]
    ds_read_b64_tr_b16 a[162:163], v24 offset:36864
    v_accvgpr_write_b32 a82, 0
    v_mfma_f32_16x16x32_bf16 v[140:143], a[168:171], a[116:119], v[140:143]
    s_add_u32 m0, s42, 16384
    ds_read_b64_tr_b16 a[164:165], v24 offset:40960
    v_accvgpr_write_b32 a83, 0
    v_mfma_f32_16x16x32_bf16 v[140:143], a[172:175], a[124:127], v[140:143]
    s_waitcnt lgkmcnt(9)
    buffer_load_dwordx4 v36, s[8:11], s40 offen lds
    v_mfma_f32_16x16x32_bf16 v[144:147], a[176:179], a[112:115], v[144:147]
    s_waitcnt lgkmcnt(7)
    ds_read_b64_tr_b16 a[166:167], v24 offset:45056
    ds_read_b64_tr_b16 a[168:169], v25 offset:32768
    v_mfma_f32_16x16x32_bf16 v[144:147], a[180:183], a[120:123], v[144:147]
    ds_read_b64_tr_b16 a[170:171], v25 offset:36864
    v_accvgpr_write_b32 a84, 0
    v_mfma_f32_16x16x32_bf16 v[148:151], a[176:179], a[116:119], v[148:151]
    ds_read_b64_tr_b16 a[172:173], v25 offset:40960
    v_accvgpr_write_b32 a85, 0
    v_mfma_f32_16x16x32_bf16 v[148:151], a[180:183], a[124:127], v[148:151]
    s_waitcnt lgkmcnt(9)
    buffer_load_dwordx4 v37, s[8:11], s40 offen offset:1024 lds
    v_mfma_f32_16x16x32_bf16 v[152:155], a[184:187], a[112:115], v[152:155]
    s_waitcnt lgkmcnt(7)
    ds_read_b64_tr_b16 a[174:175], v25 offset:45056
    ds_read_b64_tr_b16 a[176:177], v26 offset:32768
    v_mfma_f32_16x16x32_bf16 v[152:155], a[188:191], a[120:123], v[152:155]
    ds_read_b64_tr_b16 a[178:179], v26 offset:36864
    v_accvgpr_write_b32 a86, 0
    v_mfma_f32_16x16x32_bf16 v[156:159], a[184:187], a[116:119], v[156:159]
    ds_read_b64_tr_b16 a[180:181], v26 offset:40960
    v_accvgpr_write_b32 a87, 0
    v_mfma_f32_16x16x32_bf16 v[156:159], a[188:191], a[124:127], v[156:159]
    s_waitcnt lgkmcnt(9)
    buffer_load_dwordx4 v38, s[8:11], s40 offen offset:2048 lds
    v_mfma_f32_16x16x32_bf16 v[160:163], a[160:163], a[112:115], v[160:163]
    s_waitcnt lgkmcnt(7)
    ds_read_b64_tr_b16 a[182:183], v26 offset:45056
    ds_read_b64_tr_b16 a[184:185], v27 offset:32768
    v_mfma_f32_16x16x32_bf16 v[160:163], a[164:167], a[120:123], v[160:163]
    ds_read_b64_tr_b16 a[186:187], v27 offset:36864
    v_accvgpr_write_b32 a88, 0
    v_mfma_f32_16x16x32_bf16 v[164:167], a[160:163], a[116:119], v[164:167]
    ds_read_b64_tr_b16 a[188:189], v27 offset:40960
    v_accvgpr_write_b32 a89, 0
    v_mfma_f32_16x16x32_bf16 v[164:167], a[164:167], a[124:127], v[164:167]
    s_waitcnt lgkmcnt(9)
    buffer_load_dwordx4 v39, s[8:11], s40 offen offset:3072 lds
    v_mfma_f32_16x16x32_bf16 v[168:171], a[168:171], a[112:115], v[168:171]
    s_waitcnt lgkmcnt(7)
    s_add_u32 s40, s40, 16384
    ds_read_b64_tr_b16 a[190:191], v27 offset:45056
    ds_read_b64_tr_b16 a[160:161], v20 offset:49152
    v_mfma_f32_16x16x32_bf16 v[168:171], a[172:175], a[120:123], v[168:171]
    ds_read_b64_tr_b16 a[162:163], v20 offset:53248
    v_accvgpr_write_b32 a90, 0
    v_mfma_f32_16x16x32_bf16 v[172:175], a[168:171], a[116:119], v[172:175]
    ds_read_b64_tr_b16 a[164:165], v20 offset:57344
    v_accvgpr_write_b32 a91, 0
    v_mfma_f32_16x16x32_bf16 v[172:175], a[172:175], a[124:127], v[172:175]
    s_waitcnt lgkmcnt(9)
    buffer_store_dword v76, v72, s[24:27], s92 offen offset:12 sc1
    v_mfma_f32_16x16x32_bf16 v[176:179], a[176:179], a[112:115], v[176:179]
    s_waitcnt lgkmcnt(7)
    ds_read_b64_tr_b16 a[166:167], v20 offset:61440
    ds_read_b64_tr_b16 a[168:169], v21 offset:49152
    v_mfma_f32_16x16x32_bf16 v[176:179], a[180:183], a[120:123], v[176:179]
    ds_read_b64_tr_b16 a[170:171], v21 offset:53248
    v_accvgpr_write_b32 a92, 0
    v_mfma_f32_16x16x32_bf16 v[180:183], a[176:179], a[116:119], v[180:183]
    ds_read_b64_tr_b16 a[172:173], v21 offset:57344
    v_accvgpr_write_b32 a93, 0
    v_mfma_f32_16x16x32_bf16 v[180:183], a[180:183], a[124:127], v[180:183]
    s_waitcnt lgkmcnt(9)
    buffer_store_dwordx4 v[88:91], v74, s[24:27], 0 offen sc1
    v_mfma_f32_16x16x32_bf16 v[184:187], a[184:187], a[112:115], v[184:187]
    s_waitcnt lgkmcnt(7)
    ds_read_b64_tr_b16 a[174:175], v21 offset:61440
    ds_read_b64_tr_b16 a[176:177], v22 offset:49152
    v_mfma_f32_16x16x32_bf16 v[184:187], a[188:191], a[120:123], v[184:187]
    ds_read_b64_tr_b16 a[178:179], v22 offset:53248
    v_accvgpr_write_b32 a94, 0
    v_mfma_f32_16x16x32_bf16 v[188:191], a[184:187], a[116:119], v[188:191]
    ds_read_b64_tr_b16 a[180:181], v22 offset:57344
    v_accvgpr_write_b32 a95, 0
    v_mfma_f32_16x16x32_bf16 v[188:191], a[188:191], a[124:127], v[188:191]
    s_waitcnt lgkmcnt(9)
    ds_read_b64_tr_b16 a[182:183], v22 offset:61440
    v_accvgpr_write_b32 a96, 0
    v_mfma_f32_16x16x32_bf16 v[192:195], a[160:163], a[112:115], v[192:195]
    s_waitcnt lgkmcnt(8)
    ds_read_b64_tr_b16 a[184:185], v23 offset:49152
    v_accvgpr_write_b32 a97, 0
    v_mfma_f32_16x16x32_bf16 v[192:195], a[164:167], a[120:123], v[192:195]
Ltour2:
    s_cbranch_execz Ltour6
    ds_read_b64_tr_b16 a[186:187], v23 offset:53248
    v_accvgpr_write_b32 a98, 0
    v_mfma_f32_16x16x32_bf16 v[196:199], a[160:163], a[116:119], v[196:199]
    ds_read_b64_tr_b16 a[188:189], v23 offset:57344
    v_accvgpr_write_b32 a99, 0
    v_mfma_f32_16x16x32_bf16 v[196:199], a[164:167], a[124:127], v[196:199]
    s_waitcnt lgkmcnt(9)
    ds_read_b64_tr_b16 a[190:191], v23 offset:61440
    v_accvgpr_write_b32 a100, 0
    v_mfma_f32_16x16x32_bf16 v[200:203], a[168:171], a[112:115], v[200:203]
    s_waitcnt lgkmcnt(8)
    ds_read_b64_tr_b16 a[160:161], v24 offset:49152
    v_accvgpr_write_b32 a101, 0
    v_mfma_f32_16x16x32_bf16 v[200:203], a[172:175], a[120:123], v[200:203]
    ds_read_b64_tr_b16 a[162:163], v24 offset:53248
    v_accvgpr_write_b32 a102, 0
    v_mfma_f32_16x16x32_bf16 v[204:207], a[168:171], a[116:119], v[204:207]
    ds_read_b64_tr_b16 a[164:165], v24 offset:57344
    v_accvgpr_write_b32 a103, 0
    v_mfma_f32_16x16x32_bf16 v[204:207], a[172:175], a[124:127], v[204:207]
    s_waitcnt lgkmcnt(9)
    ds_read_b64_tr_b16 a[166:167], v24 offset:61440
    v_accvgpr_write_b32 a104, 0
    v_mfma_f32_16x16x32_bf16 v[208:211], a[176:179], a[112:115], v[208:211]
    s_waitcnt lgkmcnt(8)
    ds_read_b64_tr_b16 a[168:169], v25 offset:49152
    v_accvgpr_write_b32 a105, 0
    v_mfma_f32_16x16x32_bf16 v[208:211], a[180:183], a[120:123], v[208:211]
    ds_read_b64_tr_b16 a[170:171], v25 offset:53248
    v_accvgpr_write_b32 a106, 0
    v_mfma_f32_16x16x32_bf16 v[212:215], a[176:179], a[116:119], v[212:215]
    ds_read_b64_tr_b16 a[172:173], v25 offset:57344
    v_accvgpr_write_b32 a107, 0
    v_mfma_f32_16x16x32_bf16 v[212:215], a[180:183], a[124:127], v[212:215]
    s_waitcnt lgkmcnt(9)
    ds_read_b64_tr_b16 a[174:175], v25 offset:61440
    v_accvgpr_write_b32 a108, 0
    v_mfma_f32_16x16x32_bf16 v[216:219], a[184:187], a[112:115], v[216:219]
    s_waitcnt lgkmcnt(8)
    ds_read_b64_tr_b16 a[176:177], v26 offset:49152
    v_accvgpr_write_b32 a109, 0
    v_mfma_f32_16x16x32_bf16 v[216:219], a[188:191], a[120:123], v[216:219]
    ds_read_b64_tr_b16 a[178:179], v26 offset:53248
    v_accvgpr_write_b32 a110, 0
    v_mfma_f32_16x16x32_bf16 v[220:223], a[184:187], a[116:119], v[220:223]
    ds_read_b64_tr_b16 a[180:181], v26 offset:57344
    v_accvgpr_write_b32 a111, 0
    v_mfma_f32_16x16x32_bf16 v[220:223], a[188:191], a[124:127], v[220:223]
    s_waitcnt lgkmcnt(9)
    ds_read_b64_tr_b16 a[182:183], v26 offset:61440
    v_accvgpr_write_b32 a192, 0
    v_mfma_f32_16x16x32_bf16 v[224:227], a[160:163], a[112:115], v[224:227]
    s_waitcnt lgkmcnt(8)
    ds_read_b64_tr_b16 a[184:185], v27 offset:49152
    v_accvgpr_write_b32 a193, 0
    v_mfma_f32_16x16x32_bf16 v[224:227], a[164:167], a[120:123], v[224:227]
    ds_read_b64_tr_b16 a[186:187], v27 offset:53248
    v_accvgpr_write_b32 a194, 0
    v_mfma_f32_16x16x32_bf16 v[228:231], a[160:163], a[116:119], v[228:231]
    ds_read_b64_tr_b16 a[188:189], v27 offset:57344
    v_accvgpr_write_b32 a195, 0
    v_mfma_f32_16x16x32_bf16 v[228:231], a[164:167], a[124:127], v[228:231]
    s_waitcnt lgkmcnt(9)
    ds_read_b64_tr_b16 a[190:191], v27 offset:61440
    v_accvgpr_write_b32 a196, 0
    s_waitcnt vmcnt(14)
    s_barrier
    v_mfma_f32_16x16x32_bf16 v[232:235], a[168:171], a[112:115], v[232:235]
    s_waitcnt lgkmcnt(8)
    ds_read_b64_tr_b16 a[160:161], v28 offset:0
    v_accvgpr_write_b32 a197, 0
    v_mfma_f32_16x16x32_bf16 v[232:235], a[172:175], a[120:123], v[232:235]
    ds_read_b64_tr_b16 a[162:163], v28 offset:4096
    v_accvgpr_write_b32 a198, 0
    v_mfma_f32_16x16x32_bf16 v[236:239], a[168:171], a[116:119], v[236:239]
    s_add_u32 m0, s42, 32768
    ds_read_b64_tr_b16 a[164:165], v28 offset:8192
    v_accvgpr_write_b32 a199, 0
    v_mfma_f32_16x16x32_bf16 v[236:239], a[172:175], a[124:127], v[236:239]
    s_waitcnt lgkmcnt(9)
    buffer_load_dwordx4 v36, s[8:11], s40 offen lds
    v_mfma_f32_16x16x32_bf16 v[240:243], a[176:179], a[112:115], v[240:243]
    s_waitcnt lgkmcnt(7)
    ds_read_b64_tr_b16 a[166:167], v28 offset:12288
    ds_read_b64_tr_b16 a[168:169], v29 offset:0
    v_mfma_f32_16x16x32_bf16 v[240:243], a[180:183], a[120:123], v[240:243]
    ds_read_b64_tr_b16 a[170:171], v29 offset:4096
    v_accvgpr_write_b32 a200, 0
    v_mfma_f32_16x16x32_bf16 v[244:247], a[176:179], a[116:119], v[244:247]
    ds_read_b64_tr_b16 a[172:173], v29 offset:8192
    v_accvgpr_write_b32 a201, 0
    v_mfma_f32_16x16x32_bf16 v[244:247], a[180:183], a[124:127], v[244:247]
    s_waitcnt lgkmcnt(9)
    buffer_load_dwordx4 v37, s[8:11], s40 offen offset:1024 lds
    v_mfma_f32_16x16x32_bf16 v[248:251], a[184:187], a[112:115], v[248:251]
    s_waitcnt lgkmcnt(7)
    ds_read_b64_tr_b16 a[174:175], v29 offset:12288
    ds_read_b64_tr_b16 a[176:177], v30 offset:0
    v_mfma_f32_16x16x32_bf16 v[248:251], a[188:191], a[120:123], v[248:251]
    ds_read_b64_tr_b16 a[178:179], v30 offset:4096
    v_accvgpr_write_b32 a202, 0
    v_mfma_f32_16x16x32_bf16 v[252:255], a[184:187], a[116:119], v[252:255]
    ds_read_b64_tr_b16 a[180:181], v30 offset:8192
    v_accvgpr_write_b32 a203, 0
    v_mfma_f32_16x16x32_bf16 v[252:255], a[188:191], a[124:127], v[252:255]
    s_waitcnt vmcnt(15)
    s_waitcnt lgkmcnt(9)
    buffer_load_dwordx4 v38, s[8:11], s40 offen offset:2048 lds
    v_mfma_f32_16x16x32_bf16 v[128:131], a[160:163], a[128:131], v[128:131]
    s_waitcnt vmcnt(15)
    s_waitcnt lgkmcnt(7)
    ds_read_b64_tr_b16 a[182:183], v30 offset:12288
    ds_read_b64_tr_b16 a[184:185], v31 offset:0
    v_mfma_f32_16x16x32_bf16 v[128:131], a[164:167], a[136:139], v[128:131]
    s_waitcnt vmcnt(14)
    ds_read_b64_tr_b16 a[186:187], v31 offset:4096
    v_accvgpr_write_b32 a204, 0
    v_mfma_f32_16x16x32_bf16 v[132:135], a[160:163], a[132:135], v[132:135]
    s_waitcnt vmcnt(13)
    ds_read_b64_tr_b16 a[188:189], v31 offset:8192
    v_accvgpr_write_b32 a205, 0
    v_mfma_f32_16x16x32_bf16 v[132:135], a[164:167], a[140:143], v[132:135]
    s_waitcnt lgkmcnt(9)
    buffer_load_dwordx4 v39, s[8:11], s40 offen offset:3072 lds
    v_mfma_f32_16x16x32_bf16 v[136:139], a[168:171], a[128:131], v[136:139]
    s_waitcnt lgkmcnt(7)
    s_add_u32 s40, s40, 16384
    ds_read_b64_tr_b16 a[190:191], v31 offset:12288
    ds_read_b64_tr_b16 a[160:161], v32 offset:0
    v_mfma_f32_16x16x32_bf16 v[136:139], a[172:175], a[136:139], v[136:139]
    ds_read_b64_tr_b16 a[162:163], v32 offset:4096
    v_accvgpr_write_b32 a206, 0
    v_mfma_f32_16x16x32_bf16 v[140:143], a[168:171], a[132:135], v[140:143]
    s_add_u32 m0, s42, 65536
    ds_read_b64_tr_b16 a[164:165], v32 offset:8192
    v_accvgpr_write_b32 a207, 0
    v_mfma_f32_16x16x32_bf16 v[140:143], a[172:175], a[140:143], v[140:143]
    s_waitcnt lgkmcnt(9)
    buffer_load_dwordx4 v40, s[12:15], s41 offen lds
    v_mfma_f32_16x16x32_bf16 v[144:147], a[176:179], a[128:131], v[144:147]
    s_waitcnt lgkmcnt(7)
    ds_read_b64_tr_b16 a[166:167], v32 offset:12288
    ds_read_b64_tr_b16 a[168:169], v33 offset:0
    v_mfma_f32_16x16x32_bf16 v[144:147], a[180:183], a[136:139], v[144:147]
    ds_read_b64_tr_b16 a[170:171], v33 offset:4096
    v_accvgpr_write_b32 a112, 0
    v_mfma_f32_16x16x32_bf16 v[148:151], a[176:179], a[132:135], v[148:151]
    ds_read_b64_tr_b16 a[172:173], v33 offset:8192
    v_accvgpr_write_b32 a113, 0
    v_mfma_f32_16x16x32_bf16 v[148:151], a[180:183], a[140:143], v[148:151]
    s_waitcnt lgkmcnt(9)
    buffer_load_dwordx4 v41, s[12:15], s41 offen offset:1024 lds
    v_mfma_f32_16x16x32_bf16 v[152:155], a[184:187], a[128:131], v[152:155]
    s_waitcnt lgkmcnt(7)
    ds_read_b64_tr_b16 a[174:175], v33 offset:12288
    ds_read_b64_tr_b16 a[176:177], v34 offset:0
    v_mfma_f32_16x16x32_bf16 v[152:155], a[188:191], a[136:139], v[152:155]
    ds_read_b64_tr_b16 a[178:179], v34 offset:4096
    v_accvgpr_write_b32 a114, 0
    v_mfma_f32_16x16x32_bf16 v[156:159], a[184:187], a[132:135], v[156:159]
    ds_read_b64_tr_b16 a[180:181], v34 offset:8192
    v_accvgpr_write_b32 a115, 0
    v_mfma_f32_16x16x32_bf16 v[156:159], a[188:191], a[140:143], v[156:159]
    s_waitcnt lgkmcnt(9)
    buffer_load_dwordx4 v40, s[12:15], s41 offen offset:2048 lds
    v_mfma_f32_16x16x32_bf16 v[160:163], a[160:163], a[128:131], v[160:163]
    s_waitcnt lgkmcnt(7)
    ds_read_b64_tr_b16 a[182:183], v34 offset:12288
    ds_read_b64_tr_b16 a[184:185], v35 offset:0
    v_mfma_f32_16x16x32_bf16 v[160:163], a[164:167], a[136:139], v[160:163]
    ds_read_b64_tr_b16 a[186:187], v35 offset:4096
    v_accvgpr_write_b32 a116, 0
    v_mfma_f32_16x16x32_bf16 v[164:167], a[160:163], a[132:135], v[164:167]
    ds_read_b64_tr_b16 a[188:189], v35 offset:8192
    v_accvgpr_write_b32 a117, 0
    v_mfma_f32_16x16x32_bf16 v[164:167], a[164:167], a[140:143], v[164:167]
    s_waitcnt lgkmcnt(9)
    buffer_load_dwordx4 v41, s[12:15], s41 offen offset:3072 lds
    v_mfma_f32_16x16x32_bf16 v[168:171], a[168:171], a[128:131], v[168:171]
    s_waitcnt lgkmcnt(7)
    s_add_u32 s41, s41, 16384
    ds_read_b64_tr_b16 a[190:191], v35 offset:12288
    ds_read_b64_tr_b16 a[160:161], v28 offset:16384
    v_mfma_f32_16x16x32_bf16 v[168:171], a[172:175], a[136:139], v[168:171]
    ds_read_b64_tr_b16 a[162:163], v28 offset:20480
    v_accvgpr_write_b32 a118, 0
    v_mfma_f32_16x16x32_bf16 v[172:175], a[168:171], a[132:135], v[172:175]
    s_add_u32 m0, s42, 81920
    ds_read_b64_tr_b16 a[164:165], v28 offset:24576
    v_accvgpr_write_b32 a119, 0
    v_mfma_f32_16x16x32_bf16 v[172:175], a[172:175], a[140:143], v[172:175]
    s_waitcnt lgkmcnt(9)
    buffer_load_dwordx4 v40, s[12:15], s41 offen lds
    v_mfma_f32_16x16x32_bf16 v[176:179], a[176:179], a[128:131], v[176:179]
    s_waitcnt lgkmcnt(7)
    ds_read_b64_tr_b16 a[166:167], v28 offset:28672
    ds_read_b64_tr_b16 a[168:169], v29 offset:16384
    v_mfma_f32_16x16x32_bf16 v[176:179], a[180:183], a[136:139], v[176:179]
    ds_read_b64_tr_b16 a[170:171], v29 offset:20480
    v_accvgpr_write_b32 a120, 0
    v_mfma_f32_16x16x32_bf16 v[180:183], a[176:179], a[132:135], v[180:183]
    ds_read_b64_tr_b16 a[172:173], v29 offset:24576
    v_accvgpr_write_b32 a121, 0
    v_mfma_f32_16x16x32_bf16 v[180:183], a[180:183], a[140:143], v[180:183]
    s_waitcnt lgkmcnt(9)
    buffer_load_dwordx4 v41, s[12:15], s41 offen offset:1024 lds
    v_mfma_f32_16x16x32_bf16 v[184:187], a[184:187], a[128:131], v[184:187]
    s_waitcnt lgkmcnt(7)
    ds_read_b64_tr_b16 a[174:175], v29 offset:28672
    ds_read_b64_tr_b16 a[176:177], v30 offset:16384
    v_mfma_f32_16x16x32_bf16 v[184:187], a[188:191], a[136:139], v[184:187]
    ds_read_b64_tr_b16 a[178:179], v30 offset:20480
    v_accvgpr_write_b32 a122, 0
    v_mfma_f32_16x16x32_bf16 v[188:191], a[184:187], a[132:135], v[188:191]
    ds_read_b64_tr_b16 a[180:181], v30 offset:24576
    v_accvgpr_write_b32 a123, 0
    v_mfma_f32_16x16x32_bf16 v[188:191], a[188:191], a[140:143], v[188:191]
    s_waitcnt lgkmcnt(9)
    buffer_load_dwordx4 v40, s[12:15], s41 offen offset:2048 lds
    v_mfma_f32_16x16x32_bf16 v[192:195], a[160:163], a[128:131], v[192:195]
    s_waitcnt lgkmcnt(7)
    ds_read_b64_tr_b16 a[182:183], v30 offset:28672
    ds_read_b64_tr_b16 a[184:185], v31 offset:16384
    v_mfma_f32_16x16x32_bf16 v[192:195], a[164:167], a[136:139], v[192:195]
    ds_read_b64_tr_b16 a[186:187], v31 offset:20480
    v_accvgpr_write_b32 a124, 0
    v_mfma_f32_16x16x32_bf16 v[196:199], a[160:163], a[132:135], v[196:199]
    ds_read_b64_tr_b16 a[188:189], v31 offset:24576
    v_accvgpr_write_b32 a125, 0
    v_mfma_f32_16x16x32_bf16 v[196:199], a[164:167], a[140:143], v[196:199]
    s_waitcnt lgkmcnt(9)
    buffer_load_dwordx4 v41, s[12:15], s41 offen offset:3072 lds
    v_mfma_f32_16x16x32_bf16 v[200:203], a[168:171], a[128:131], v[200:203]
    s_waitcnt lgkmcnt(7)
    s_add_u32 s41, s41, 16384
    ds_read_b64_tr_b16 a[190:191], v31 offset:28672
    ds_read_b64_tr_b16 a[160:161], v32 offset:16384
    v_mfma_f32_16x16x32_bf16 v[200:203], a[172:175], a[136:139], v[200:203]
    ds_read_b64_tr_b16 a[162:163], v32 offset:20480
    v_accvgpr_write_b32 a126, 0
    v_mfma_f32_16x16x32_bf16 v[204:207], a[168:171], a[132:135], v[204:207]
    ds_read_b64_tr_b16 a[164:165], v32 offset:24576
    v_accvgpr_write_b32 a127, 0
    v_mfma_f32_16x16x32_bf16 v[204:207], a[172:175], a[140:143], v[204:207]
    s_waitcnt lgkmcnt(9)
    ds_read_b64_tr_b16 a[166:167], v32 offset:28672
    v_mfma_f32_16x16x32_bf16 v[208:211], a[176:179], a[128:131], v[208:211]
    s_waitcnt lgkmcnt(8)
    ds_read_b64_tr_b16 a[168:169], v33 offset:16384
    v_mfma_f32_16x16x32_bf16 v[208:211], a[180:183], a[136:139], v[208:211]
    ds_read_b64_tr_b16 a[170:171], v33 offset:20480
    v_mfma_f32_16x16x32_bf16 v[212:215], a[176:179], a[132:135], v[212:215]
    ds_read_b64_tr_b16 a[172:173], v33 offset:24576
    v_mfma_f32_16x16x32_bf16 v[212:215], a[180:183], a[140:143], v[212:215]
    s_waitcnt lgkmcnt(9)
    ds_read_b64_tr_b16 a[174:175], v33 offset:28672
    v_mfma_f32_16x16x32_bf16 v[216:219], a[184:187], a[128:131], v[216:219]
    s_waitcnt lgkmcnt(8)
    ds_read_b64_tr_b16 a[176:177], v34 offset:16384
    v_mfma_f32_16x16x32_bf16 v[216:219], a[188:191], a[136:139], v[216:219]
    ds_read_b64_tr_b16 a[178:179], v34 offset:20480
    v_mfma_f32_16x16x32_bf16 v[220:223], a[184:187], a[132:135], v[220:223]
    ds_read_b64_tr_b16 a[180:181], v34 offset:24576
    v_mfma_f32_16x16x32_bf16 v[220:223], a[188:191], a[140:143], v[220:223]
    s_waitcnt lgkmcnt(9)
    ds_read_b64_tr_b16 a[182:183], v34 offset:28672
    v_mfma_f32_16x16x32_bf16 v[224:227], a[160:163], a[128:131], v[224:227]
    s_waitcnt lgkmcnt(8)
    ds_read_b64_tr_b16 a[184:185], v35 offset:16384
    v_mfma_f32_16x16x32_bf16 v[224:227], a[164:167], a[136:139], v[224:227]
    ds_read_b64_tr_b16 a[186:187], v35 offset:20480
    v_mfma_f32_16x16x32_bf16 v[228:231], a[160:163], a[132:135], v[228:231]
    ds_read_b64_tr_b16 a[188:189], v35 offset:24576
    v_mfma_f32_16x16x32_bf16 v[228:231], a[164:167], a[140:143], v[228:231]
    s_waitcnt lgkmcnt(9)
    ds_read_b64_tr_b16 a[190:191], v35 offset:28672
    v_mfma_f32_16x16x32_bf16 v[232:235], a[168:171], a[128:131], v[232:235]
    s_waitcnt lgkmcnt(8)
    v_mfma_f32_16x16x32_bf16 v[232:235], a[172:175], a[136:139], v[232:235]
    v_mfma_f32_16x16x32_bf16 v[236:239], a[168:171], a[132:135], v[236:239]
    v_mfma_f32_16x16x32_bf16 v[236:239], a[172:175], a[140:143], v[236:239]
    s_waitcnt lgkmcnt(6)
    s_waitcnt vmcnt(18)
    s_barrier
    v_mfma_f32_16x16x32_bf16 v[240:243], a[176:179], a[128:131], v[240:243]
    s_waitcnt lgkmcnt(4)
    ds_read_b128 a[208:211], v8 offset:0
    v_mfma_f32_16x16x32_bf16 v[240:243], a[180:183], a[136:139], v[240:243]
    ds_read_b128 a[212:215], v9 offset:0
    v_mfma_f32_16x16x32_bf16 v[244:247], a[176:179], a[132:135], v[244:247]
    ds_read_b128 a[216:219], v10 offset:0
    v_mfma_f32_16x16x32_bf16 v[244:247], a[180:183], a[140:143], v[244:247]
    s_waitcnt lgkmcnt(5)
    ds_read_b128 a[220:223], v11 offset:0
    v_mfma_f32_16x16x32_bf16 v[248:251], a[184:187], a[128:131], v[248:251]
    s_waitcnt lgkmcnt(4)
    ds_read_b128 a[224:227], v8 offset:4096
    v_mfma_f32_16x16x32_bf16 v[248:251], a[188:191], a[136:139], v[248:251]
    v_mfma_f32_16x16x32_bf16 v[252:255], a[184:187], a[132:135], v[252:255]
    s_load_dwordx2 s[16:17], s[0:1], 88
    v_mfma_f32_16x16x32_bf16 v[252:255], a[188:191], a[140:143], v[252:255]
    s_mov_b32 s36, 1040356334
    s_mov_b32 s37, 1040356334
    v_pk_mul_f32 v[128:129], v[128:129], s[36:37]
    v_pk_mul_f32 v[130:131], v[130:131], s[36:37]
    v_pk_mul_f32 v[136:137], v[136:137], s[36:37]
    v_pk_mul_f32 v[138:139], v[138:139], s[36:37]
    v_cvt_pk_bf16_f32 v64, v128, v129
    v_cvt_pk_bf16_f32 v65, v130, v131
    v_cvt_pk_bf16_f32 v66, v136, v137
    v_cvt_pk_bf16_f32 v67, v138, v139
    v_pk_mul_f32 v[132:133], v[132:133], s[36:37]
    v_pk_mul_f32 v[134:135], v[134:135], s[36:37]
    v_pk_mul_f32 v[140:141], v[140:141], s[36:37]
    v_pk_mul_f32 v[142:143], v[142:143], s[36:37]
    v_cvt_pk_bf16_f32 v80, v132, v133
    v_cvt_pk_bf16_f32 v81, v134, v135
    v_cvt_pk_bf16_f32 v82, v140, v141
    v_cvt_pk_bf16_f32 v83, v142, v143
    v_permlane32_swap_b32 v64, v66
    v_permlane32_swap_b32 v65, v67
    v_permlane32_swap_b32 v80, v82
    v_permlane32_swap_b32 v81, v83
    v_permlane16_swap_b32 v64, v66
    v_permlane16_swap_b32 v65, v67
    v_permlane16_swap_b32 v80, v82
    v_permlane16_swap_b32 v81, v83
    v_pk_mul_f32 v[144:145], v[144:145], s[36:37]
    v_pk_mul_f32 v[146:147], v[146:147], s[36:37]
    v_pk_mul_f32 v[152:153], v[152:153], s[36:37]
    v_pk_mul_f32 v[154:155], v[154:155], s[36:37]
    v_cvt_pk_bf16_f32 v68, v144, v145
    v_cvt_pk_bf16_f32 v69, v146, v147
    v_cvt_pk_bf16_f32 v70, v152, v153
    v_cvt_pk_bf16_f32 v71, v154, v155
    v_pk_mul_f32 v[148:149], v[148:149], s[36:37]
    v_pk_mul_f32 v[150:151], v[150:151], s[36:37]
    v_pk_mul_f32 v[156:157], v[156:157], s[36:37]
    v_pk_mul_f32 v[158:159], v[158:159], s[36:37]
    v_cvt_pk_bf16_f32 v84, v148, v149
    v_cvt_pk_bf16_f32 v85, v150, v151
    v_cvt_pk_bf16_f32 v86, v156, v157
    v_cvt_pk_bf16_f32 v87, v158, v159
    v_permlane32_swap_b32 v68, v70
    v_permlane32_swap_b32 v69, v71
    v_permlane32_swap_b32 v84, v86
    v_permlane32_swap_b32 v85, v87
    v_permlane16_swap_b32 v68, v70
    v_permlane16_swap_b32 v69, v71
    v_permlane16_swap_b32 v84, v86
    v_permlane16_swap_b32 v85, v87
    v_pk_mul_f32 v[160:161], v[160:161], s[36:37]
    v_pk_mul_f32 v[162:163], v[162:163], s[36:37]
    v_pk_mul_f32 v[168:169], v[168:169], s[36:37]
    v_pk_mul_f32 v[170:171], v[170:171], s[36:37]
    v_cvt_pk_bf16_f32 v72, v160, v161
    v_cvt_pk_bf16_f32 v73, v162, v163
    v_cvt_pk_bf16_f32 v74, v168, v169
    v_cvt_pk_bf16_f32 v75, v170, v171
    v_pk_mul_f32 v[164:165], v[164:165], s[36:37]
    v_pk_mul_f32 v[166:167], v[166:167], s[36:37]
    v_pk_mul_f32 v[172:173], v[172:173], s[36:37]
    v_pk_mul_f32 v[174:175], v[174:175], s[36:37]
    v_cvt_pk_bf16_f32 v88, v164, v165
    v_cvt_pk_bf16_f32 v89, v166, v167
    v_cvt_pk_bf16_f32 v90, v172, v173
    v_cvt_pk_bf16_f32 v91, v174, v175
    v_permlane32_swap_b32 v72, v74
    v_permlane32_swap_b32 v73, v75
    v_permlane32_swap_b32 v88, v90
    v_permlane32_swap_b32 v89, v91
    v_permlane16_swap_b32 v72, v74
    v_permlane16_swap_b32 v73, v75
    v_permlane16_swap_b32 v88, v90
    v_permlane16_swap_b32 v89, v91
    v_pk_mul_f32 v[176:177], v[176:177], s[36:37]
    v_pk_mul_f32 v[178:179], v[178:179], s[36:37]
    v_pk_mul_f32 v[184:185], v[184:185], s[36:37]
    v_pk_mul_f32 v[186:187], v[186:187], s[36:37]
    v_cvt_pk_bf16_f32 v76, v176, v177
    v_cvt_pk_bf16_f32 v77, v178, v179
    v_cvt_pk_bf16_f32 v78, v184, v185
    v_cvt_pk_bf16_f32 v79, v186, v187
    v_pk_mul_f32 v[180:181], v[180:181], s[36:37]
    v_pk_mul_f32 v[182:183], v[182:183], s[36:37]
    v_pk_mul_f32 v[188:189], v[188:189], s[36:37]
    v_pk_mul_f32 v[190:191], v[190:191], s[36:37]
    v_cvt_pk_bf16_f32 v92, v180, v181
    v_cvt_pk_bf16_f32 v93, v182, v183
    v_cvt_pk_bf16_f32 v94, v188, v189
    v_cvt_pk_bf16_f32 v95, v190, v191
    v_permlane32_swap_b32 v76, v78
    v_permlane32_swap_b32 v77, v79
    v_permlane32_swap_b32 v92, v94
    v_permlane32_swap_b32 v93, v95
    v_permlane16_swap_b32 v76, v78
    v_permlane16_swap_b32 v77, v79
    v_permlane16_swap_b32 v92, v94
    v_permlane16_swap_b32 v93, v95
    v_pk_mul_f32 v[192:193], v[192:193], s[36:37]
    v_pk_mul_f32 v[194:195], v[194:195], s[36:37]
    v_pk_mul_f32 v[200:201], v[200:201], s[36:37]
    v_pk_mul_f32 v[202:203], v[202:203], s[36:37]
    v_cvt_pk_bf16_f32 v96, v192, v193
    v_cvt_pk_bf16_f32 v97, v194, v195
    v_cvt_pk_bf16_f32 v98, v200, v201
    v_cvt_pk_bf16_f32 v99, v202, v203
    v_pk_mul_f32 v[196:197], v[196:197], s[36:37]
    v_pk_mul_f32 v[198:199], v[198:199], s[36:37]
    v_pk_mul_f32 v[204:205], v[204:205], s[36:37]
    v_pk_mul_f32 v[206:207], v[206:207], s[36:37]
    v_cvt_pk_bf16_f32 v112, v196, v197
    v_cvt_pk_bf16_f32 v113, v198, v199
    v_cvt_pk_bf16_f32 v114, v204, v205
    v_cvt_pk_bf16_f32 v115, v206, v207
    v_permlane32_swap_b32 v96, v98
    v_permlane32_swap_b32 v97, v99
    v_permlane32_swap_b32 v112, v114
    v_permlane32_swap_b32 v113, v115
    v_permlane16_swap_b32 v96, v98
    v_permlane16_swap_b32 v97, v99
    v_permlane16_swap_b32 v112, v114
    v_permlane16_swap_b32 v113, v115
    v_pk_mul_f32 v[208:209], v[208:209], s[36:37]
    v_pk_mul_f32 v[210:211], v[210:211], s[36:37]
    v_pk_mul_f32 v[216:217], v[216:217], s[36:37]
    v_pk_mul_f32 v[218:219], v[218:219], s[36:37]
    v_cvt_pk_bf16_f32 v100, v208, v209
    v_cvt_pk_bf16_f32 v101, v210, v211
    v_cvt_pk_bf16_f32 v102, v216, v217
    v_cvt_pk_bf16_f32 v103, v218, v219
    v_pk_mul_f32 v[212:213], v[212:213], s[36:37]
    v_pk_mul_f32 v[214:215], v[214:215], s[36:37]
    v_pk_mul_f32 v[220:221], v[220:221], s[36:37]
    v_pk_mul_f32 v[222:223], v[222:223], s[36:37]
    v_cvt_pk_bf16_f32 v116, v212, v213
    v_cvt_pk_bf16_f32 v117, v214, v215
    v_cvt_pk_bf16_f32 v118, v220, v221
    v_cvt_pk_bf16_f32 v119, v222, v223
    v_permlane32_swap_b32 v100, v102
    v_permlane32_swap_b32 v101, v103
    v_permlane32_swap_b32 v116, v118
    v_permlane32_swap_b32 v117, v119
    v_permlane16_swap_b32 v100, v102
    v_permlane16_swap_b32 v101, v103
    v_permlane16_swap_b32 v116, v118
    v_permlane16_swap_b32 v117, v119
    v_pk_mul_f32 v[224:225], v[224:225], s[36:37]
    v_pk_mul_f32 v[226:227], v[226:227], s[36:37]
    v_pk_mul_f32 v[232:233], v[232:233], s[36:37]
    v_pk_mul_f32 v[234:235], v[234:235], s[36:37]
    v_cvt_pk_bf16_f32 v104, v224, v225
    v_cvt_pk_bf16_f32 v105, v226, v227
    v_cvt_pk_bf16_f32 v106, v232, v233
    v_cvt_pk_bf16_f32 v107, v234, v235
    v_pk_mul_f32 v[228:229], v[228:229], s[36:37]
    v_pk_mul_f32 v[230:231], v[230:231], s[36:37]
    v_pk_mul_f32 v[236:237], v[236:237], s[36:37]
    v_pk_mul_f32 v[238:239], v[238:239], s[36:37]
    v_cvt_pk_bf16_f32 v120, v228, v229
    v_cvt_pk_bf16_f32 v121, v230, v231
    v_cvt_pk_bf16_f32 v122, v236, v237
    v_cvt_pk_bf16_f32 v123, v238, v239
    v_permlane32_swap_b32 v104, v106
    v_permlane32_swap_b32 v105, v107
    v_permlane32_swap_b32 v120, v122
    v_permlane32_swap_b32 v121, v123
    v_permlane16_swap_b32 v104, v106
    v_permlane16_swap_b32 v105, v107
    v_permlane16_swap_b32 v120, v122
    v_permlane16_swap_b32 v121, v123
    v_pk_mul_f32 v[240:241], v[240:241], s[36:37]
    v_pk_mul_f32 v[242:243], v[242:243], s[36:37]
    v_pk_mul_f32 v[248:249], v[248:249], s[36:37]
    v_pk_mul_f32 v[250:251], v[250:251], s[36:37]
    v_cvt_pk_bf16_f32 v108, v240, v241
    v_cvt_pk_bf16_f32 v109, v242, v243
    v_cvt_pk_bf16_f32 v110, v248, v249
    v_cvt_pk_bf16_f32 v111, v250, v251
    v_pk_mul_f32 v[244:245], v[244:245], s[36:37]
    v_pk_mul_f32 v[246:247], v[246:247], s[36:37]
    v_pk_mul_f32 v[252:253], v[252:253], s[36:37]
    v_pk_mul_f32 v[254:255], v[254:255], s[36:37]
    v_cvt_pk_bf16_f32 v124, v244, v245
    v_cvt_pk_bf16_f32 v125, v246, v247
    v_cvt_pk_bf16_f32 v126, v252, v253
    v_cvt_pk_bf16_f32 v127, v254, v255
    v_permlane32_swap_b32 v108, v110
    v_permlane32_swap_b32 v109, v111
    v_permlane32_swap_b32 v124, v126
    v_permlane32_swap_b32 v125, v127
    v_permlane16_swap_b32 v108, v110
    v_permlane16_swap_b32 v109, v111
    v_permlane16_swap_b32 v124, v126
    v_permlane16_swap_b32 v125, v127
    s_waitcnt lgkmcnt(0)
    v_mfma_f32_16x16x32_bf16 v[216:219], a[208:211], v[64:67], 0
    v_mfma_f32_16x16x32_bf16 v[216:219], a[212:215], v[68:71], v[216:219]
    v_mfma_f32_16x16x32_bf16 v[216:219], a[216:219], v[72:75], v[216:219]
    v_mfma_f32_16x16x32_bf16 v[216:219], a[220:223], v[76:79], v[216:219]
    v_mfma_f32_16x16x32_bf16 v[220:223], a[208:211], v[80:83], 0
    v_mfma_f32_16x16x32_bf16 v[220:223], a[212:215], v[84:87], v[220:223]
    v_mfma_f32_16x16x32_bf16 v[220:223], a[216:219], v[88:91], v[220:223]
    v_mfma_f32_16x16x32_bf16 v[220:223], a[220:223], v[92:95], v[220:223]
    v_mfma_f32_16x16x32_bf16 v[224:227], a[208:211], v[96:99], 0
    v_mfma_f32_16x16x32_bf16 v[224:227], a[212:215], v[100:103], v[224:227]
    v_mfma_f32_16x16x32_bf16 v[224:227], a[216:219], v[104:107], v[224:227]
    v_mfma_f32_16x16x32_bf16 v[224:227], a[220:223], v[108:111], v[224:227]
    v_mfma_f32_16x16x32_bf16 v[228:231], a[208:211], v[112:115], 0
    v_mfma_f32_16x16x32_bf16 v[228:231], a[212:215], v[116:119], v[228:231]
    v_mfma_f32_16x16x32_bf16 v[228:231], a[216:219], v[120:123], v[228:231]
    v_mfma_f32_16x16x32_bf16 v[228:231], a[220:223], v[124:127], v[228:231]
    v_max3_f32 v232, v216, v217, v218
    v_max_f32 v232, v232, v219
    v_max3_f32 v233, v220, v221, v222
    v_max_f32 v233, v233, v223
    v_max3_f32 v234, v224, v225, v226
    v_max_f32 v234, v234, v227
    s_nop 1
    v_max3_f32 v235, v228, v229, v230
    v_max_f32 v235, v235, v231
    v_mov_b32 v236, v232
    v_mov_b32 v237, v233
    v_mov_b32 v238, v234
    v_mov_b32 v239, v235
    v_permlane16_swap_b32 v232, v236
    v_permlane16_swap_b32 v233, v237
    v_permlane16_swap_b32 v234, v238
    v_permlane16_swap_b32 v235, v239
    v_max_f32 v232, v232, v236
    v_max_f32 v233, v233, v237
    v_max_f32 v234, v234, v238
    v_max_f32 v235, v235, v239
    v_mov_b32 v236, v232
    v_mov_b32 v237, v233
    v_mov_b32 v238, v234
    v_mov_b32 v239, v235
    v_permlane32_swap_b32 v232, v236
    v_permlane32_swap_b32 v233, v237
    v_permlane32_swap_b32 v234, v238
    v_permlane32_swap_b32 v235, v239
    v_max_f32 v232, v232, v236
    v_max_f32 v233, v233, v237
    v_max_f32 v234, v234, v238
    v_max_f32 v235, v235, v239
    v_sub_f32 v192, 3250585600, v232
    v_sub_f32 v193, 3250585600, v232
    v_sub_f32 v194, 3250585600, v232
    v_sub_f32 v195, 3250585600, v232
    v_sub_f32 v196, 3250585600, v233
    v_sub_f32 v197, 3250585600, v233
    v_sub_f32 v198, 3250585600, v233
    v_sub_f32 v199, 3250585600, v233
    v_sub_f32 v200, 3250585600, v234
    v_sub_f32 v201, 3250585600, v234
    v_sub_f32 v202, 3250585600, v234
    v_sub_f32 v203, 3250585600, v234
    v_sub_f32 v204, 3250585600, v235
    v_sub_f32 v205, 3250585600, v235
    v_sub_f32 v206, 3250585600, v235
    v_sub_f32 v207, 3250585600, v235
Lattn_stage0:
    s_mov_b32 s43, 7
    v_mfma_f32_16x16x32_bf16 v[208:211], a[208:211], v[64:67], v[192:195]
    s_lshl_b32 s53, s5, 4
    v_mfma_f32_16x16x32_bf16 v[208:211], a[212:215], v[68:71], v[208:211]
    s_add_u32 s53, s53, s4
    v_mfma_f32_16x16x32_bf16 v[208:211], a[216:219], v[72:75], v[208:211]
    s_lshl_b32 s53, s53, 2
    v_mfma_f32_16x16x32_bf16 v[208:211], a[220:223], v[76:79], v[208:211]
    s_add_u32 s53, s53, s3
    ds_read_b128 a[228:231], v9 offset:4096
    v_mfma_f32_16x16x32_bf16 v[212:215], a[208:211], v[80:83], v[196:199]
    s_mul_i32 s53, s53, 4608
    s_nop 3
    v_exp_f32 v208, v208
    v_mfma_f32_16x16x32_bf16 v[212:215], a[212:215], v[84:87], v[212:215]
    s_add_u32 s53, s53, 2621440
    v_exp_f32 v209, v209
    v_mfma_f32_16x16x32_bf16 v[212:215], a[216:219], v[88:91], v[212:215]
    s_lshr_b32 s44, s2, 5
    v_exp_f32 v210, v210
    v_mfma_f32_16x16x32_bf16 v[212:215], a[220:223], v[92:95], v[212:215]
    s_lshl_b32 s44, s44, 3
    v_exp_f32 v211, v211
    v_cvt_pk_bf16_f32 v128, v208, v209
    ds_read_b128 a[232:235], v10 offset:4096
    v_cvt_pk_bf16_f32 v129, v210, v211
    v_mfma_f32_16x16x32_bf16 v[208:211], a[208:211], v[96:99], v[200:203]
    s_and_b32 s37, s2, 7
    s_nop 0
    v_exp_f32 v212, v212
    v_mfma_f32_16x16x32_bf16 v[208:211], a[212:215], v[100:103], v[208:211]
    s_add_u32 s44, s44, s37
    v_exp_f32 v213, v213
    v_mfma_f32_16x16x32_bf16 v[208:211], a[216:219], v[104:107], v[208:211]
    s_lshl_b32 s44, s44, 2
    v_exp_f32 v214, v214
    v_mfma_f32_16x16x32_bf16 v[208:211], a[220:223], v[108:111], v[208:211]
    s_bfe_u32 s37, s2, 0x20003
    v_exp_f32 v215, v215
    v_cvt_pk_bf16_f32 v136, v212, v213
Ltour3:
    s_cbranch_execz Ltour7
    ds_read_b128 a[236:239], v11 offset:4096
    v_cvt_pk_bf16_f32 v137, v214, v215
    v_mfma_f32_16x16x32_bf16 v[212:215], a[208:211], v[112:115], v[204:207]
    s_add_u32 s44, s44, s37
    s_nop 0
    v_exp_f32 v208, v208
    v_mfma_f32_16x16x32_bf16 v[212:215], a[212:215], v[116:119], v[212:215]
    s_add_u32 s44, s44, 72
    v_exp_f32 v209, v209
    v_mfma_f32_16x16x32_bf16 v[212:215], a[216:219], v[120:123], v[212:215]
    s_cmp_lt_u32 s44, 216
    s_cselect_b32 s37, 0, 2147483648
    v_exp_f32 v210, v210
    v_mfma_f32_16x16x32_bf16 v[212:215], a[220:223], v[124:127], v[212:215]
    s_lshl_b32 s44, s44, 5
    v_exp_f32 v211, v211
    v_cvt_pk_bf16_f32 v144, v208, v209
    ds_read_b128 a[208:211], v8 offset:8192
    v_cvt_pk_bf16_f32 v145, v210, v211
    v_mfma_f32_16x16x32_bf16 v[208:211], a[224:227], v[64:67], v[192:195]
    s_waitcnt lgkmcnt(3)
    s_or_b32 s44, s44, s37
    v_exp_f32 v212, v212
    v_mfma_f32_16x16x32_bf16 v[208:211], a[228:231], v[68:71], v[208:211]
    s_waitcnt lgkmcnt(2)
    s_mov_b32 s18, 3981312
    v_exp_f32 v213, v213
    v_mfma_f32_16x16x32_bf16 v[208:211], a[232:235], v[72:75], v[208:211]
    s_waitcnt lgkmcnt(1)
    s_lshr_b32 s6, s2, 3
    v_exp_f32 v214, v214
    v_mfma_f32_16x16x32_bf16 v[208:211], a[236:239], v[76:79], v[208:211]
    s_and_b32 s7, s2, 7
    v_exp_f32 v215, v215
    v_cvt_pk_bf16_f32 v152, v212, v213
    ds_read_b128 a[212:215], v9 offset:8192
    v_cvt_pk_bf16_f32 v153, v214, v215
    v_mfma_f32_16x16x32_bf16 v[212:215], a[224:227], v[80:83], v[196:199]
    s_mul_i32 s7, s7, 18
    s_nop 0
    v_exp_f32 v208, v208
    v_mfma_f32_16x16x32_bf16 v[212:215], a[228:231], v[84:87], v[212:215]
    s_add_u32 s7, s7, s6
    v_exp_f32 v209, v209
    v_mfma_f32_16x16x32_bf16 v[212:215], a[232:235], v[88:91], v[212:215]
    s_lshl_b32 s58, s7, 6
    v_exp_f32 v210, v210
    v_mfma_f32_16x16x32_bf16 v[212:215], a[236:239], v[92:95], v[212:215]
    s_mul_i32 s59, s7, 36864
    v_exp_f32 v211, v211
    v_cvt_pk_bf16_f32 v130, v208, v209
    ds_read_b128 a[216:219], v10 offset:8192
    v_cvt_pk_bf16_f32 v131, v210, v211
    v_mfma_f32_16x16x32_bf16 v[208:211], a[224:227], v[96:99], v[200:203]
    s_cmp_lt_u32 s6, 18
    s_cselect_b32 s7, 0, 2147483648
    v_exp_f32 v212, v212
    v_mfma_f32_16x16x32_bf16 v[208:211], a[228:231], v[100:103], v[208:211]
    s_or_b32 s58, s58, s7
    v_exp_f32 v213, v213
    v_mfma_f32_16x16x32_bf16 v[208:211], a[232:235], v[104:107], v[208:211]
    s_or_b32 s59, s59, s7
    v_exp_f32 v214, v214
    v_mfma_f32_16x16x32_bf16 v[208:211], a[236:239], v[108:111], v[208:211]
    s_and_b32 s7, s4, 1
    v_exp_f32 v215, v215
    v_cvt_pk_bf16_f32 v138, v212, v213
    ds_read_b128 a[220:223], v11 offset:8192
    v_cvt_pk_bf16_f32 v139, v214, v215
    s_mov_b32 s39, 221184
    s_mov_b32 s38, 27648
    v_mfma_f32_16x16x32_bf16 v[212:215], a[224:227], v[112:115], v[204:207]
    s_lshl_b32 s6, s7, 7
    v_exp_f32 v208, v208
    v_mfma_f32_16x16x32_bf16 v[212:215], a[228:231], v[116:119], v[212:215]
    s_xor_b32 s36, s4, 1
    v_exp_f32 v209, v209
    v_mfma_f32_16x16x32_bf16 v[212:215], a[232:235], v[120:123], v[212:215]
    s_mul_i32 s36, s36, 294912
    v_exp_f32 v210, v210
    v_mfma_f32_16x16x32_bf16 v[212:215], a[236:239], v[124:127], v[212:215]
    s_waitcnt lgkmcnt(3)
    s_add_u32 s46, s36, s6
    v_exp_f32 v211, v211
    v_cvt_pk_bf16_f32 v146, v208, v209
    ds_read_b128 a[224:227], v8 offset:12288
    v_cvt_pk_bf16_f32 v147, v210, v211
    v_mfma_f32_16x16x32_bf16 v[208:211], a[208:211], v[64:67], v[192:195]
    s_waitcnt lgkmcnt(3)
    s_lshl_b32 s36, s4, 8
    v_exp_f32 v212, v212
    v_mfma_f32_16x16x32_bf16 v[208:211], a[212:215], v[68:71], v[208:211]
    s_waitcnt lgkmcnt(2)
    s_add_u32 s56, s47, s36
    v_exp_f32 v213, v213
    v_mfma_f32_16x16x32_bf16 v[208:211], a[216:219], v[72:75], v[208:211]
    s_waitcnt lgkmcnt(1)
    s_lshr_b32 s36, s4, 1
    v_exp_f32 v214, v214
    v_mfma_f32_16x16x32_bf16 v[208:211], a[220:223], v[76:79], v[208:211]
    s_lshl_b32 s36, s36, 11
    v_exp_f32 v215, v215
    v_cvt_pk_bf16_f32 v154, v212, v213
    ds_read_b128 a[228:231], v9 offset:12288
    v_cvt_pk_bf16_f32 v155, v214, v215
    v_mfma_f32_16x16x32_bf16 v[212:215], a[208:211], v[80:83], v[196:199]
    s_lshl_b32 s7, s7, 8
    s_nop 0
    v_exp_f32 v208, v208
    v_mfma_f32_16x16x32_bf16 v[212:215], a[212:215], v[84:87], v[212:215]
    s_add_u32 s36, s36, s7
    v_exp_f32 v209, v209
    v_mfma_f32_16x16x32_bf16 v[212:215], a[216:219], v[88:91], v[212:215]
    s_add_u32 s93, s47, s36
    v_exp_f32 v210, v210
    v_mfma_f32_16x16x32_bf16 v[212:215], a[220:223], v[92:95], v[212:215]
    s_lshr_b32 s36, s4, 1
    v_exp_f32 v211, v211
    v_cvt_pk_bf16_f32 v132, v208, v209
    ds_read_b128 a[232:235], v10 offset:12288
    v_cvt_pk_bf16_f32 v133, v210, v211
    v_mfma_f32_16x16x32_bf16 v[208:211], a[208:211], v[96:99], v[200:203]
    s_lshl_b32 s36, s36, 4
    s_nop 0
    v_exp_f32 v212, v212
    v_mfma_f32_16x16x32_bf16 v[208:211], a[212:215], v[100:103], v[208:211]
    s_add_u32 s36, s36, s5
    v_exp_f32 v213, v213
    v_mfma_f32_16x16x32_bf16 v[208:211], a[216:219], v[104:107], v[208:211]
    s_lshl_b32 s36, s36, 9
    v_exp_f32 v214, v214
    v_mfma_f32_16x16x32_bf16 v[208:211], a[220:223], v[108:111], v[208:211]
    s_add_u32 s36, s36, s7
    v_exp_f32 v215, v215
    v_cvt_pk_bf16_f32 v140, v212, v213
    ds_read_b128 a[236:239], v11 offset:12288
    v_cvt_pk_bf16_f32 v141, v214, v215
    s_waitcnt vmcnt(4)
    s_barrier
    v_mfma_f32_16x16x32_bf16 v[212:215], a[208:211], v[112:115], v[204:207]
    s_lshl_b32 s36, s36, 8
    v_exp_f32 v208, v208
    v_mfma_f32_16x16x32_bf16 v[212:215], a[212:215], v[116:119], v[212:215]
    s_add_u32 m0, s42, 49152
    s_add_u32 s55, s36, 20971520
    v_exp_f32 v209, v209
    v_mfma_f32_16x16x32_bf16 v[212:215], a[216:219], v[120:123], v[212:215]
    s_add_u32 s7, s45, s6
    v_exp_f32 v210, v210
    v_mfma_f32_16x16x32_bf16 v[212:215], a[220:223], v[124:127], v[212:215]
    s_waitcnt lgkmcnt(3)
    s_xor_b32 s54, s92, 128
    v_exp_f32 v211, v211
    v_cvt_pk_bf16_f32 v148, v208, v209
    ds_read_b128 a[208:211], v8 offset:16384
    v_cvt_pk_bf16_f32 v149, v210, v211
    buffer_load_dwordx4 v36, s[8:11], s40 offen lds
    v_mfma_f32_16x16x32_bf16 v[208:211], a[224:227], v[64:67], v[192:195]
    s_waitcnt lgkmcnt(3)
    s_lshl_b32 s36, s3, 14
    v_exp_f32 v212, v212
    v_mfma_f32_16x16x32_bf16 v[208:211], a[228:231], v[68:71], v[208:211]
    s_waitcnt lgkmcnt(2)
    v_exp_f32 v213, v213
    v_mfma_f32_16x16x32_bf16 v[208:211], a[232:235], v[72:75], v[208:211]
    s_waitcnt lgkmcnt(1)
    v_exp_f32 v214, v214
    v_mfma_f32_16x16x32_bf16 v[208:211], a[236:239], v[76:79], v[208:211]
    v_exp_f32 v215, v215
    v_cvt_pk_bf16_f32 v156, v212, v213
    ds_read_b128 a[212:215], v9 offset:16384
    v_cvt_pk_bf16_f32 v157, v214, v215
    v_mfma_f32_16x16x32_bf16 v[212:215], a[224:227], v[80:83], v[196:199]
    s_nop 2
    v_exp_f32 v208, v208
    v_mfma_f32_16x16x32_bf16 v[212:215], a[228:231], v[84:87], v[212:215]
    v_exp_f32 v209, v209
    v_mfma_f32_16x16x32_bf16 v[212:215], a[232:235], v[88:91], v[212:215]
    v_exp_f32 v210, v210
    v_mfma_f32_16x16x32_bf16 v[212:215], a[236:239], v[92:95], v[212:215]
    v_exp_f32 v211, v211
    ds_read_b64_tr_b16 a[160:161], v20 offset:0
    v_cvt_pk_bf16_f32 v134, v208, v209
    v_lshrrev_b32 v51, 2, v0
    v_mul_u32_u24 v51, 9216, v51
    v_and_b32 v254, 3, v0
    v_lshl_add_u32 v254, v254, 4, v51
    v_lshlrev_b32 v255, 4, v0
    v_add_u32 v51, 98304, v255
    v_lshl_add_u32 v252, v1, 4, s36
    v_mov_b32 v224, 0
    v_mov_b32 v225, 0
    v_mov_b32 v226, 0
    v_mov_b32 v227, 0
    v_mov_b32 v228, 0
    v_mov_b32 v229, 0
    v_mov_b32 v230, 0
    v_mov_b32 v231, 0
    v_mov_b32 v248, -1
    v_mov_b32 v249, -1
    v_mov_b32 v250, -1
    v_mov_b32 v251, -1
    v_min_u32 v232, 41, v1
    v_lshlrev_b32 v232, 4, v232
    s_mov_b32 s57, s58
    s_lshl_b32 s6, s3, 10
    s_add_u32 s6, s6, 135168
    s_lshr_b32 s37, s2, 3
    s_mul_i32 s37, s37, -129024
    s_add_u32 s37, s37, 4128768
    ds_read_b64_tr_b16 a[162:163], v20 offset:4096
    ds_read_b128 a[216:219], v10 offset:16384
    v_cvt_pk_bf16_f32 v135, v210, v211
    buffer_load_dwordx4 v37, s[8:11], s40 offen offset:1024 lds
    v_mfma_f32_16x16x32_bf16 v[208:211], a[224:227], v[96:99], v[200:203]
    v_exp_f32 v212, v212
    v_mfma_f32_16x16x32_bf16 v[208:211], a[228:231], v[100:103], v[208:211]
    v_exp_f32 v213, v213
    v_mfma_f32_16x16x32_bf16 v[208:211], a[232:235], v[104:107], v[208:211]
    v_exp_f32 v214, v214
    v_mfma_f32_16x16x32_bf16 v[208:211], a[236:239], v[108:111], v[208:211]
    s_mov_b32 s52, s55
    v_exp_f32 v215, v215
    ds_read_b64_tr_b16 a[164:165], v20 offset:8192
    v_cvt_pk_bf16_f32 v142, v212, v213
    ds_read_b64_tr_b16 a[166:167], v20 offset:12288
    v_min_u32 v237, 19, v1
    v_lshl_add_u32 v237, v237, 7, s36
    v_lshl_add_u32 v238, v1, 7, s36
    ds_read_b128 a[220:223], v11 offset:16384
    v_cvt_pk_bf16_f32 v143, v214, v215
    buffer_load_dword v217, v57, s[32:35], s37 offen
    v_mfma_f32_16x16x32_bf16 v[212:215], a[224:227], v[112:115], v[204:207]
    v_exp_f32 v208, v208
    v_mfma_f32_16x16x32_bf16 v[212:215], a[228:231], v[116:119], v[212:215]
    v_exp_f32 v209, v209
    v_mfma_f32_16x16x32_bf16 v[212:215], a[232:235], v[120:123], v[212:215]
    s_mul_i32 s37, s5, 18432
    v_exp_f32 v210, v210
    v_mfma_f32_16x16x32_bf16 v[212:215], a[236:239], v[124:127], v[212:215]
    s_add_u32 s37, s37, s45
    v_exp_f32 v211, v211
    ds_read_b64_tr_b16 a[168:169], v21 offset:0
    v_cvt_pk_bf16_f32 v150, v208, v209
    ds_read_b64_tr_b16 a[170:171], v21 offset:4096
    v_min_u32 v236, 143, v0
    v_lshl_add_u32 v236, v236, 7, s37
    v_mul_u32_u24 v235, 24, v0
    v_lshrrev_b32 v235, 8, v235
    v_lshl_add_u32 v235, v235, 7, s37
    ds_read_b128 a[224:227], v8 offset:20480
    v_cvt_pk_bf16_f32 v151, v210, v211
    s_waitcnt lgkmcnt(3)
    buffer_load_dwordx4 v38, s[8:11], s40 offen offset:2048 lds
Lattn_loop:
    v_mfma_f32_16x16x32_bf16 v[208:211], a[208:211], v[64:67], v[192:195]
    v_exp_f32 v212, v212
    v_mfma_f32_16x16x32_bf16 v[208:211], a[212:215], v[68:71], v[208:211]
    v_exp_f32 v213, v213
    v_mfma_f32_16x16x32_bf16 v[208:211], a[216:219], v[72:75], v[208:211]
    v_exp_f32 v214, v214
    v_mfma_f32_16x16x32_bf16 v[208:211], a[220:223], v[76:79], v[208:211]
    v_exp_f32 v215, v215
    v_mfma_f32_16x16x32_bf16 a[0:3], a[160:163], v[128:131], a[0:3]
    ds_read_b64_tr_b16 a[172:173], v21 offset:8192
    v_cvt_pk_bf16_f32 v158, v212, v213
    v_mfma_f32_16x16x32_bf16 a[0:3], a[164:167], v[132:135], a[0:3]
    ds_read_b64_tr_b16 a[174:175], v21 offset:12288
    v_mfma_f32_16x16x32_bf16 a[4:7], a[160:163], v[136:139], a[4:7]
    ds_read_b128 a[228:231], v9 offset:20480
    v_cvt_pk_bf16_f32 v159, v214, v215
    v_mfma_f32_16x16x32_bf16 a[4:7], a[164:167], v[140:143], a[4:7]
    v_mfma_f32_16x16x32_bf16 v[212:215], a[208:211], v[80:83], v[196:199]
    v_exp_f32 v208, v208
    v_mfma_f32_16x16x32_bf16 v[212:215], a[212:215], v[84:87], v[212:215]
    v_exp_f32 v209, v209
    v_mfma_f32_16x16x32_bf16 v[212:215], a[216:219], v[88:91], v[212:215]
    v_exp_f32 v210, v210
    v_mfma_f32_16x16x32_bf16 v[212:215], a[220:223], v[92:95], v[212:215]
    v_exp_f32 v211, v211
    v_mfma_f32_16x16x32_bf16 a[8:11], a[160:163], v[144:147], a[8:11]
    ds_read_b64_tr_b16 a[176:177], v22 offset:0
    v_cvt_pk_bf16_f32 v160, v208, v209
    v_mfma_f32_16x16x32_bf16 a[8:11], a[164:167], v[148:151], a[8:11]
    ds_read_b64_tr_b16 a[178:179], v22 offset:4096
    v_mfma_f32_16x16x32_bf16 a[12:15], a[160:163], v[152:155], a[12:15]
    ds_read_b128 a[232:235], v10 offset:20480
    v_cvt_pk_bf16_f32 v161, v210, v211
    v_mfma_f32_16x16x32_bf16 a[12:15], a[164:167], v[156:159], a[12:15]
    s_waitcnt lgkmcnt(3)
    buffer_load_dwordx4 v39, s[8:11], s40 offen offset:3072 lds
    v_mfma_f32_16x16x32_bf16 v[208:211], a[208:211], v[96:99], v[200:203]
    v_exp_f32 v212, v212
    v_mfma_f32_16x16x32_bf16 v[208:211], a[212:215], v[100:103], v[208:211]
    s_add_u32 s40, s40, 16384
    v_exp_f32 v213, v213
    v_mfma_f32_16x16x32_bf16 v[208:211], a[216:219], v[104:107], v[208:211]
    s_mov_b32 m0, s6
    v_exp_f32 v214, v214
    v_mfma_f32_16x16x32_bf16 v[208:211], a[220:223], v[108:111], v[208:211]
    v_exp_f32 v215, v215
    v_mfma_f32_16x16x32_bf16 a[16:19], a[168:171], v[128:131], a[16:19]
    ds_read_b64_tr_b16 a[180:181], v22 offset:8192
    v_cvt_pk_bf16_f32 v168, v212, v213
    v_mfma_f32_16x16x32_bf16 a[16:19], a[172:175], v[132:135], a[16:19]
    ds_read_b64_tr_b16 a[182:183], v22 offset:12288
    v_mfma_f32_16x16x32_bf16 a[20:23], a[168:171], v[136:139], a[20:23]
    ds_read_b128 a[236:239], v11 offset:20480
    v_cvt_pk_bf16_f32 v169, v214, v215
    v_mfma_f32_16x16x32_bf16 a[20:23], a[172:175], v[140:143], a[20:23]
    buffer_load_dwordx4 v254, s[32:35], s57 offen  lds
    v_smfmac_f32_16x16x64_bf16 a[192:195], v[52:55], v[128:135], v50
    v_mfma_f32_16x16x32_bf16 v[212:215], a[208:211], v[112:115], v[204:207]
    v_exp_f32 v208, v208
    v_mfma_f32_16x16x32_bf16 v[212:215], a[212:215], v[116:119], v[212:215]
    s_add_u32 m0, s42, 98304
    v_exp_f32 v209, v209
    v_mfma_f32_16x16x32_bf16 v[212:215], a[216:219], v[120:123], v[212:215]
    v_exp_f32 v210, v210
    v_mfma_f32_16x16x32_bf16 v[212:215], a[220:223], v[124:127], v[212:215]
    v_exp_f32 v211, v211
    v_mfma_f32_16x16x32_bf16 a[24:27], a[168:171], v[144:147], a[24:27]
    ds_read_b64_tr_b16 a[184:185], v23 offset:0
    v_cvt_pk_bf16_f32 v176, v208, v209
    v_mfma_f32_16x16x32_bf16 a[24:27], a[172:175], v[148:151], a[24:27]
    ds_read_b64_tr_b16 a[186:187], v23 offset:4096
    v_mfma_f32_16x16x32_bf16 a[28:31], a[168:171], v[152:155], a[28:31]
    ds_read_b128 a[208:211], v8 offset:24576
    v_cvt_pk_bf16_f32 v177, v210, v211
    v_mfma_f32_16x16x32_bf16 a[28:31], a[172:175], v[156:159], a[28:31]
    s_waitcnt lgkmcnt(3)
    buffer_load_dwordx4 v40, s[12:15], s41 offen lds
    v_mfma_f32_16x16x32_bf16 v[208:211], a[224:227], v[64:67], v[192:195]
    v_exp_f32 v212, v212
    v_mfma_f32_16x16x32_bf16 v[208:211], a[228:231], v[68:71], v[208:211]
    s_add_u32 s6, s6, 4096
    v_exp_f32 v213, v213
    v_mfma_f32_16x16x32_bf16 v[208:211], a[232:235], v[72:75], v[208:211]
    s_add_u32 s57, s57, 589824
    v_exp_f32 v214, v214
    v_mfma_f32_16x16x32_bf16 v[208:211], a[236:239], v[76:79], v[208:211]
    v_exp_f32 v215, v215
    v_mfma_f32_16x16x32_bf16 a[32:35], a[176:179], v[128:131], a[32:35]
    ds_read_b64_tr_b16 a[188:189], v23 offset:8192
    v_cvt_pk_bf16_f32 v184, v212, v213
    v_mfma_f32_16x16x32_bf16 a[32:35], a[180:183], v[132:135], a[32:35]
    ds_read_b64_tr_b16 a[190:191], v23 offset:12288
    v_mfma_f32_16x16x32_bf16 a[36:39], a[176:179], v[136:139], a[36:39]
    ds_read_b128 a[212:215], v9 offset:24576
    v_cvt_pk_bf16_f32 v185, v214, v215
    v_mfma_f32_16x16x32_bf16 a[36:39], a[180:183], v[140:143], a[36:39]
    v_smfmac_f32_16x16x64_bf16 a[196:199], v[52:55], v[136:143], v50
    v_mfma_f32_16x16x32_bf16 v[212:215], a[224:227], v[80:83], v[196:199]
    v_exp_f32 v208, v208
    v_mfma_f32_16x16x32_bf16 v[212:215], a[228:231], v[84:87], v[212:215]
    v_exp_f32 v209, v209
    v_mfma_f32_16x16x32_bf16 v[212:215], a[232:235], v[88:91], v[212:215]
    v_exp_f32 v210, v210
    v_mfma_f32_16x16x32_bf16 v[212:215], a[236:239], v[92:95], v[212:215]
    v_exp_f32 v211, v211
    v_mfma_f32_16x16x32_bf16 a[40:43], a[176:179], v[144:147], a[40:43]
    ds_read_b64_tr_b16 a[160:161], v24 offset:0
    v_cvt_pk_bf16_f32 v162, v208, v209
    v_mfma_f32_16x16x32_bf16 a[40:43], a[180:183], v[148:151], a[40:43]
    ds_read_b64_tr_b16 a[162:163], v24 offset:4096
    v_mfma_f32_16x16x32_bf16 a[44:47], a[176:179], v[152:155], a[44:47]
    ds_read_b128 a[216:219], v10 offset:24576
    v_cvt_pk_bf16_f32 v163, v210, v211
    v_mfma_f32_16x16x32_bf16 a[44:47], a[180:183], v[156:159], a[44:47]
    s_waitcnt lgkmcnt(3)
    buffer_load_dwordx4 v41, s[12:15], s41 offen offset:1024 lds
    v_mfma_f32_16x16x32_bf16 v[208:211], a[224:227], v[96:99], v[200:203]
    v_exp_f32 v212, v212
    v_mfma_f32_16x16x32_bf16 v[208:211], a[228:231], v[100:103], v[208:211]
    v_exp_f32 v213, v213
    v_mfma_f32_16x16x32_bf16 v[208:211], a[232:235], v[104:107], v[208:211]
    v_exp_f32 v214, v214
    v_mfma_f32_16x16x32_bf16 v[208:211], a[236:239], v[108:111], v[208:211]
    v_exp_f32 v215, v215
    v_mfma_f32_16x16x32_bf16 a[48:51], a[184:187], v[128:131], a[48:51]
    ds_read_b64_tr_b16 a[164:165], v24 offset:8192
    v_cvt_pk_bf16_f32 v170, v212, v213
    v_mfma_f32_16x16x32_bf16 a[48:51], a[188:191], v[132:135], a[48:51]
    ds_read_b64_tr_b16 a[166:167], v24 offset:12288
    v_mfma_f32_16x16x32_bf16 a[52:55], a[184:187], v[136:139], a[52:55]
    ds_read_b128 a[220:223], v11 offset:24576
    v_cvt_pk_bf16_f32 v171, v214, v215
    v_mfma_f32_16x16x32_bf16 a[52:55], a[188:191], v[140:143], a[52:55]
    v_smfmac_f32_16x16x64_bf16 a[200:203], v[52:55], v[144:151], v50
    v_mfma_f32_16x16x32_bf16 v[212:215], a[224:227], v[112:115], v[204:207]
    v_exp_f32 v208, v208
    v_mfma_f32_16x16x32_bf16 v[212:215], a[228:231], v[116:119], v[212:215]
    v_exp_f32 v209, v209
    v_mfma_f32_16x16x32_bf16 v[212:215], a[232:235], v[120:123], v[212:215]
    v_exp_f32 v210, v210
    v_mfma_f32_16x16x32_bf16 v[212:215], a[236:239], v[124:127], v[212:215]
    v_exp_f32 v211, v211
    v_mfma_f32_16x16x32_bf16 a[56:59], a[184:187], v[144:147], a[56:59]
    ds_read_b64_tr_b16 a[168:169], v25 offset:0
    v_cvt_pk_bf16_f32 v178, v208, v209
    v_mfma_f32_16x16x32_bf16 a[56:59], a[188:191], v[148:151], a[56:59]
    ds_read_b64_tr_b16 a[170:171], v25 offset:4096
    v_mfma_f32_16x16x32_bf16 a[60:63], a[184:187], v[152:155], a[60:63]
    ds_read_b128 a[224:227], v8 offset:28672
    v_cvt_pk_bf16_f32 v179, v210, v211
    v_mfma_f32_16x16x32_bf16 a[60:63], a[188:191], v[156:159], a[60:63]
    s_waitcnt lgkmcnt(3)
    buffer_load_dwordx4 v40, s[12:15], s41 offen offset:2048 lds
    v_mfma_f32_16x16x32_bf16 v[208:211], a[208:211], v[64:67], v[192:195]
    v_exp_f32 v212, v212
    v_mfma_f32_16x16x32_bf16 v[208:211], a[212:215], v[68:71], v[208:211]
    v_exp_f32 v213, v213
    v_mfma_f32_16x16x32_bf16 v[208:211], a[216:219], v[72:75], v[208:211]
    v_exp_f32 v214, v214
    v_mfma_f32_16x16x32_bf16 v[208:211], a[220:223], v[76:79], v[208:211]
    v_exp_f32 v215, v215
    v_mfma_f32_16x16x32_bf16 a[64:67], a[160:163], v[128:131], a[64:67]
    ds_read_b64_tr_b16 a[172:173], v25 offset:8192
    v_cvt_pk_bf16_f32 v186, v212, v213
    v_mfma_f32_16x16x32_bf16 a[64:67], a[164:167], v[132:135], a[64:67]
    ds_read_b64_tr_b16 a[174:175], v25 offset:12288
    v_mfma_f32_16x16x32_bf16 a[68:71], a[160:163], v[136:139], a[68:71]
    ds_read_b128 a[228:231], v9 offset:28672
    v_cvt_pk_bf16_f32 v187, v214, v215
    v_mfma_f32_16x16x32_bf16 a[68:71], a[164:167], v[140:143], a[68:71]
    v_smfmac_f32_16x16x64_bf16 a[204:207], v[52:55], v[152:159], v50
    v_mfma_f32_16x16x32_bf16 v[212:215], a[208:211], v[80:83], v[196:199]
    v_exp_f32 v208, v208
    v_mfma_f32_16x16x32_bf16 v[212:215], a[212:215], v[84:87], v[212:215]
    v_exp_f32 v209, v209
    v_mfma_f32_16x16x32_bf16 v[212:215], a[216:219], v[88:91], v[212:215]
    v_exp_f32 v210, v210
    v_mfma_f32_16x16x32_bf16 v[212:215], a[220:223], v[92:95], v[212:215]
    v_exp_f32 v211, v211
    v_mfma_f32_16x16x32_bf16 a[72:75], a[160:163], v[144:147], a[72:75]
    ds_read_b64_tr_b16 a[176:177], v26 offset:0
    v_cvt_pk_bf16_f32 v164, v208, v209
    v_mfma_f32_16x16x32_bf16 a[72:75], a[164:167], v[148:151], a[72:75]
    ds_read_b64_tr_b16 a[178:179], v26 offset:4096
    v_mfma_f32_16x16x32_bf16 a[76:79], a[160:163], v[152:155], a[76:79]
    ds_read_b128 a[232:235], v10 offset:28672
    v_cvt_pk_bf16_f32 v165, v210, v211
    v_mfma_f32_16x16x32_bf16 a[76:79], a[164:167], v[156:159], a[76:79]
    s_waitcnt lgkmcnt(3)
    buffer_load_dwordx4 v41, s[12:15], s41 offen offset:3072 lds
    v_mfma_f32_16x16x32_bf16 v[208:211], a[208:211], v[96:99], v[200:203]
    v_exp_f32 v212, v212
    v_mfma_f32_16x16x32_bf16 v[208:211], a[212:215], v[100:103], v[208:211]
    s_add_u32 s41, s41, 16384
    v_exp_f32 v213, v213
    v_mfma_f32_16x16x32_bf16 v[208:211], a[216:219], v[104:107], v[208:211]
    v_exp_f32 v214, v214
    v_mfma_f32_16x16x32_bf16 v[208:211], a[220:223], v[108:111], v[208:211]
    v_exp_f32 v215, v215
    v_mfma_f32_16x16x32_bf16 a[80:83], a[168:171], v[128:131], a[80:83]
    ds_read_b64_tr_b16 a[180:181], v26 offset:8192
    v_cvt_pk_bf16_f32 v172, v212, v213
    v_mfma_f32_16x16x32_bf16 a[80:83], a[172:175], v[132:135], a[80:83]
    ds_read_b64_tr_b16 a[182:183], v26 offset:12288
    v_mfma_f32_16x16x32_bf16 a[84:87], a[168:171], v[136:139], a[84:87]
    ds_read_b128 a[236:239], v11 offset:28672
    v_cvt_pk_bf16_f32 v173, v214, v215
    v_mfma_f32_16x16x32_bf16 a[84:87], a[172:175], v[140:143], a[84:87]
    s_waitcnt vmcnt(10)
    s_barrier
    v_mfma_f32_16x16x32_bf16 v[212:215], a[208:211], v[112:115], v[204:207]
    v_exp_f32 v208, v208
    v_mfma_f32_16x16x32_bf16 v[212:215], a[212:215], v[116:119], v[212:215]
    s_add_u32 m0, s42, 0
    v_exp_f32 v209, v209
    v_mfma_f32_16x16x32_bf16 v[212:215], a[216:219], v[120:123], v[212:215]
    v_exp_f32 v210, v210
    v_mfma_f32_16x16x32_bf16 v[212:215], a[220:223], v[124:127], v[212:215]
    v_exp_f32 v211, v211
    v_mfma_f32_16x16x32_bf16 a[88:91], a[168:171], v[144:147], a[88:91]
    ds_read_b64_tr_b16 a[184:185], v27 offset:0
    v_cvt_pk_bf16_f32 v180, v208, v209
    v_mfma_f32_16x16x32_bf16 a[88:91], a[172:175], v[148:151], a[88:91]
    ds_read_b64_tr_b16 a[186:187], v27 offset:4096
    v_mfma_f32_16x16x32_bf16 a[92:95], a[168:171], v[152:155], a[92:95]
    ds_read_b128 a[208:211], v8 offset:32768
    v_cvt_pk_bf16_f32 v181, v210, v211
    v_mfma_f32_16x16x32_bf16 a[92:95], a[172:175], v[156:159], a[92:95]
    s_waitcnt lgkmcnt(3)
    buffer_load_dwordx4 v36, s[8:11], s40 offen lds
    v_mfma_f32_16x16x32_bf16 v[208:211], a[224:227], v[64:67], v[192:195]
    v_exp_f32 v212, v212
    v_mfma_f32_16x16x32_bf16 v[208:211], a[228:231], v[68:71], v[208:211]
    v_exp_f32 v213, v213
    v_mfma_f32_16x16x32_bf16 v[208:211], a[232:235], v[72:75], v[208:211]
    v_exp_f32 v214, v214
    v_mfma_f32_16x16x32_bf16 v[208:211], a[236:239], v[76:79], v[208:211]
    v_exp_f32 v215, v215
    v_mfma_f32_16x16x32_bf16 a[96:99], a[176:179], v[128:131], a[96:99]
    ds_read_b64_tr_b16 a[188:189], v27 offset:8192
    v_cvt_pk_bf16_f32 v188, v212, v213
    v_mfma_f32_16x16x32_bf16 a[96:99], a[180:183], v[132:135], a[96:99]
    ds_read_b64_tr_b16 a[190:191], v27 offset:12288
    v_mfma_f32_16x16x32_bf16 a[100:103], a[176:179], v[136:139], a[100:103]
    ds_read_b128 a[212:215], v9 offset:32768
    v_cvt_pk_bf16_f32 v189, v214, v215
    v_mfma_f32_16x16x32_bf16 a[100:103], a[180:183], v[140:143], a[100:103]
    v_mfma_f32_16x16x32_bf16 v[212:215], a[224:227], v[80:83], v[196:199]
    v_exp_f32 v208, v208
    v_mfma_f32_16x16x32_bf16 v[212:215], a[228:231], v[84:87], v[212:215]
    v_exp_f32 v209, v209
    v_mfma_f32_16x16x32_bf16 v[212:215], a[232:235], v[88:91], v[212:215]
    v_exp_f32 v210, v210
    v_mfma_f32_16x16x32_bf16 v[212:215], a[236:239], v[92:95], v[212:215]
    v_exp_f32 v211, v211
    v_mfma_f32_16x16x32_bf16 a[104:107], a[176:179], v[144:147], a[104:107]
    ds_read_b64_tr_b16 a[160:161], v20 offset:16384
    v_cvt_pk_bf16_f32 v166, v208, v209
    v_mfma_f32_16x16x32_bf16 a[104:107], a[180:183], v[148:151], a[104:107]
    ds_read_b64_tr_b16 a[162:163], v20 offset:20480
    v_mfma_f32_16x16x32_bf16 a[108:111], a[176:179], v[152:155], a[108:111]
    ds_read_b128 a[216:219], v10 offset:32768
    v_cvt_pk_bf16_f32 v167, v210, v211
    v_mfma_f32_16x16x32_bf16 a[108:111], a[180:183], v[156:159], a[108:111]
    s_waitcnt lgkmcnt(3)
    buffer_load_dwordx4 v37, s[8:11], s40 offen offset:1024 lds
    v_mfma_f32_16x16x32_bf16 v[208:211], a[224:227], v[96:99], v[200:203]
    v_exp_f32 v212, v212
    v_mfma_f32_16x16x32_bf16 v[208:211], a[228:231], v[100:103], v[208:211]
    v_exp_f32 v213, v213
    v_mfma_f32_16x16x32_bf16 v[208:211], a[232:235], v[104:107], v[208:211]
    v_exp_f32 v214, v214
    v_mfma_f32_16x16x32_bf16 v[208:211], a[236:239], v[108:111], v[208:211]
    v_exp_f32 v215, v215
    v_mfma_f32_16x16x32_bf16 a[112:115], a[184:187], v[128:131], a[112:115]
    ds_read_b64_tr_b16 a[164:165], v20 offset:24576
    v_cvt_pk_bf16_f32 v174, v212, v213
    v_mfma_f32_16x16x32_bf16 a[112:115], a[188:191], v[132:135], a[112:115]
    ds_read_b64_tr_b16 a[166:167], v20 offset:28672
    v_mfma_f32_16x16x32_bf16 a[116:119], a[184:187], v[136:139], a[116:119]
    ds_read_b128 a[220:223], v11 offset:32768
    v_cvt_pk_bf16_f32 v175, v214, v215
    v_mfma_f32_16x16x32_bf16 a[116:119], a[188:191], v[140:143], a[116:119]
    buffer_load_dwordx4 v[240:243], v7, s[16:19], s44 offen
    v_mfma_f32_16x16x32_bf16 v[212:215], a[224:227], v[112:115], v[204:207]
    v_exp_f32 v208, v208
    v_mfma_f32_16x16x32_bf16 v[212:215], a[228:231], v[116:119], v[212:215]
    v_exp_f32 v209, v209
    v_mfma_f32_16x16x32_bf16 v[212:215], a[232:235], v[120:123], v[212:215]
    v_exp_f32 v210, v210
    v_mfma_f32_16x16x32_bf16 v[212:215], a[236:239], v[124:127], v[212:215]
    s_add_u32 s44, s44, 884736
    v_exp_f32 v211, v211
    v_mfma_f32_16x16x32_bf16 a[120:123], a[184:187], v[144:147], a[120:123]
    ds_read_b64_tr_b16 a[168:169], v21 offset:16384
    v_cvt_pk_bf16_f32 v182, v208, v209
    v_mfma_f32_16x16x32_bf16 a[120:123], a[188:191], v[148:151], a[120:123]
    ds_read_b64_tr_b16 a[170:171], v21 offset:20480
    v_mfma_f32_16x16x32_bf16 a[124:127], a[184:187], v[152:155], a[124:127]
    ds_read_b128 a[224:227], v8 offset:36864
    v_cvt_pk_bf16_f32 v183, v210, v211
    v_mfma_f32_16x16x32_bf16 a[124:127], a[188:191], v[156:159], a[124:127]
    s_waitcnt lgkmcnt(3)
    buffer_load_dwordx4 v38, s[8:11], s40 offen offset:2048 lds
    v_mfma_f32_16x16x32_bf16 v[208:211], a[208:211], v[64:67], v[192:195]
    v_exp_f32 v212, v212
    v_mfma_f32_16x16x32_bf16 v[208:211], a[212:215], v[68:71], v[208:211]
    v_exp_f32 v213, v213
    v_mfma_f32_16x16x32_bf16 v[208:211], a[216:219], v[72:75], v[208:211]
    v_exp_f32 v214, v214
    v_mfma_f32_16x16x32_bf16 v[208:211], a[220:223], v[76:79], v[208:211]
    v_exp_f32 v215, v215
    v_mfma_f32_16x16x32_bf16 a[0:3], a[160:163], v[160:163], a[0:3]
    ds_read_b64_tr_b16 a[172:173], v21 offset:24576
    v_cvt_pk_bf16_f32 v190, v212, v213
    v_mfma_f32_16x16x32_bf16 a[0:3], a[164:167], v[164:167], a[0:3]
    ds_read_b64_tr_b16 a[174:175], v21 offset:28672
    v_mfma_f32_16x16x32_bf16 a[4:7], a[160:163], v[168:171], a[4:7]
    ds_read_b128 a[228:231], v9 offset:36864
    v_cvt_pk_bf16_f32 v191, v214, v215
    v_mfma_f32_16x16x32_bf16 a[4:7], a[164:167], v[172:175], a[4:7]
    v_mfma_f32_16x16x32_bf16 v[212:215], a[208:211], v[80:83], v[196:199]
    v_exp_f32 v208, v208
    v_mfma_f32_16x16x32_bf16 v[212:215], a[212:215], v[84:87], v[212:215]
    v_exp_f32 v209, v209
    v_mfma_f32_16x16x32_bf16 v[212:215], a[216:219], v[88:91], v[212:215]
    v_exp_f32 v210, v210
    v_mfma_f32_16x16x32_bf16 v[212:215], a[220:223], v[92:95], v[212:215]
    v_exp_f32 v211, v211
    v_mfma_f32_16x16x32_bf16 a[8:11], a[160:163], v[176:179], a[8:11]
    ds_read_b64_tr_b16 a[176:177], v22 offset:16384
    v_cvt_pk_bf16_f32 v128, v208, v209
    v_mfma_f32_16x16x32_bf16 a[8:11], a[164:167], v[180:183], a[8:11]
    ds_read_b64_tr_b16 a[178:179], v22 offset:20480
    v_mfma_f32_16x16x32_bf16 a[12:15], a[160:163], v[184:187], a[12:15]
    ds_read_b128 a[232:235], v10 offset:36864
    v_cvt_pk_bf16_f32 v129, v210, v211
    v_mfma_f32_16x16x32_bf16 a[12:15], a[164:167], v[188:191], a[12:15]
    s_waitcnt lgkmcnt(3)
    buffer_load_dwordx4 v39, s[8:11], s40 offen offset:3072 lds
    v_mfma_f32_16x16x32_bf16 v[208:211], a[208:211], v[96:99], v[200:203]
    v_exp_f32 v212, v212
    v_mfma_f32_16x16x32_bf16 v[208:211], a[212:215], v[100:103], v[208:211]
    s_add_u32 s40, s40, 16384
    v_exp_f32 v213, v213
    v_mfma_f32_16x16x32_bf16 v[208:211], a[216:219], v[104:107], v[208:211]
    v_exp_f32 v214, v214
    v_mfma_f32_16x16x32_bf16 v[208:211], a[220:223], v[108:111], v[208:211]
    v_exp_f32 v215, v215
    v_mfma_f32_16x16x32_bf16 a[16:19], a[168:171], v[160:163], a[16:19]
    ds_read_b64_tr_b16 a[180:181], v22 offset:24576
    v_cvt_pk_bf16_f32 v136, v212, v213
    v_mfma_f32_16x16x32_bf16 a[16:19], a[172:175], v[164:167], a[16:19]
    ds_read_b64_tr_b16 a[182:183], v22 offset:28672
    v_mfma_f32_16x16x32_bf16 a[20:23], a[168:171], v[168:171], a[20:23]
    ds_read_b128 a[236:239], v11 offset:36864
    v_cvt_pk_bf16_f32 v137, v214, v215
    v_mfma_f32_16x16x32_bf16 a[20:23], a[172:175], v[172:175], a[20:23]
    v_smfmac_f32_16x16x64_bf16 a[192:195], v[52:55], v[160:167], v50
    v_mfma_f32_16x16x32_bf16 v[212:215], a[208:211], v[112:115], v[204:207]
Ltour4:
    s_cbranch_execz Ltour8
    v_exp_f32 v208, v208
    v_mfma_f32_16x16x32_bf16 v[212:215], a[212:215], v[116:119], v[212:215]
    s_add_u32 m0, s42, 114688
    v_exp_f32 v209, v209
    v_mfma_f32_16x16x32_bf16 v[212:215], a[216:219], v[120:123], v[212:215]
    v_exp_f32 v210, v210
    v_mfma_f32_16x16x32_bf16 v[212:215], a[220:223], v[124:127], v[212:215]
    v_exp_f32 v211, v211
    v_mfma_f32_16x16x32_bf16 a[24:27], a[168:171], v[176:179], a[24:27]
    ds_read_b64_tr_b16 a[184:185], v23 offset:16384
    v_cvt_pk_bf16_f32 v144, v208, v209
    v_mfma_f32_16x16x32_bf16 a[24:27], a[172:175], v[180:183], a[24:27]
    ds_read_b64_tr_b16 a[186:187], v23 offset:20480
    v_mfma_f32_16x16x32_bf16 a[28:31], a[168:171], v[184:187], a[28:31]
    ds_read_b128 a[208:211], v8 offset:40960
    v_cvt_pk_bf16_f32 v145, v210, v211
    v_mfma_f32_16x16x32_bf16 a[28:31], a[172:175], v[188:191], a[28:31]
    s_waitcnt lgkmcnt(3)
    buffer_load_dwordx4 v40, s[12:15], s41 offen lds
    v_mfma_f32_16x16x32_bf16 v[208:211], a[224:227], v[64:67], v[192:195]
    v_exp_f32 v212, v212
    v_mfma_f32_16x16x32_bf16 v[208:211], a[228:231], v[68:71], v[208:211]
    v_exp_f32 v213, v213
    v_mfma_f32_16x16x32_bf16 v[208:211], a[232:235], v[72:75], v[208:211]
    v_exp_f32 v214, v214
    v_mfma_f32_16x16x32_bf16 v[208:211], a[236:239], v[76:79], v[208:211]
    v_exp_f32 v215, v215
    v_mfma_f32_16x16x32_bf16 a[32:35], a[176:179], v[160:163], a[32:35]
    ds_read_b64_tr_b16 a[188:189], v23 offset:24576
    v_cvt_pk_bf16_f32 v152, v212, v213
    v_mfma_f32_16x16x32_bf16 a[32:35], a[180:183], v[164:167], a[32:35]
    ds_read_b64_tr_b16 a[190:191], v23 offset:28672
    v_mfma_f32_16x16x32_bf16 a[36:39], a[176:179], v[168:171], a[36:39]
    ds_read_b128 a[212:215], v9 offset:40960
    v_cvt_pk_bf16_f32 v153, v214, v215
    v_mfma_f32_16x16x32_bf16 a[36:39], a[180:183], v[172:175], a[36:39]
    v_smfmac_f32_16x16x64_bf16 a[196:199], v[52:55], v[168:175], v50
    v_mfma_f32_16x16x32_bf16 v[212:215], a[224:227], v[80:83], v[196:199]
    v_exp_f32 v208, v208
    v_mfma_f32_16x16x32_bf16 v[212:215], a[228:231], v[84:87], v[212:215]
    v_exp_f32 v209, v209
    v_mfma_f32_16x16x32_bf16 v[212:215], a[232:235], v[88:91], v[212:215]
    v_exp_f32 v210, v210
    v_mfma_f32_16x16x32_bf16 v[212:215], a[236:239], v[92:95], v[212:215]
    v_exp_f32 v211, v211
    v_mfma_f32_16x16x32_bf16 a[40:43], a[176:179], v[176:179], a[40:43]
    ds_read_b64_tr_b16 a[160:161], v24 offset:16384
    v_cvt_pk_bf16_f32 v130, v208, v209
    v_mfma_f32_16x16x32_bf16 a[40:43], a[180:183], v[180:183], a[40:43]
    ds_read_b64_tr_b16 a[162:163], v24 offset:20480
    v_mfma_f32_16x16x32_bf16 a[44:47], a[176:179], v[184:187], a[44:47]
    ds_read_b128 a[216:219], v10 offset:40960
    v_cvt_pk_bf16_f32 v131, v210, v211
    v_mfma_f32_16x16x32_bf16 a[44:47], a[180:183], v[188:191], a[44:47]
    s_waitcnt lgkmcnt(3)
    buffer_load_dwordx4 v41, s[12:15], s41 offen offset:1024 lds
    v_mfma_f32_16x16x32_bf16 v[208:211], a[224:227], v[96:99], v[200:203]
    v_exp_f32 v212, v212
    v_mfma_f32_16x16x32_bf16 v[208:211], a[228:231], v[100:103], v[208:211]
    v_exp_f32 v213, v213
    v_mfma_f32_16x16x32_bf16 v[208:211], a[232:235], v[104:107], v[208:211]
    v_exp_f32 v214, v214
    v_mfma_f32_16x16x32_bf16 v[208:211], a[236:239], v[108:111], v[208:211]
    v_exp_f32 v215, v215
    v_mfma_f32_16x16x32_bf16 a[48:51], a[184:187], v[160:163], a[48:51]
    ds_read_b64_tr_b16 a[164:165], v24 offset:24576
    v_cvt_pk_bf16_f32 v138, v212, v213
    v_mfma_f32_16x16x32_bf16 a[48:51], a[188:191], v[164:167], a[48:51]
    ds_read_b64_tr_b16 a[166:167], v24 offset:28672
    v_mfma_f32_16x16x32_bf16 a[52:55], a[184:187], v[168:171], a[52:55]
    ds_read_b128 a[220:223], v11 offset:40960
    v_cvt_pk_bf16_f32 v139, v214, v215
    v_mfma_f32_16x16x32_bf16 a[52:55], a[188:191], v[172:175], a[52:55]
    v_smfmac_f32_16x16x64_bf16 a[200:203], v[52:55], v[176:183], v50
    v_mfma_f32_16x16x32_bf16 v[212:215], a[224:227], v[112:115], v[204:207]
    v_exp_f32 v208, v208
    v_mfma_f32_16x16x32_bf16 v[212:215], a[228:231], v[116:119], v[212:215]
    v_exp_f32 v209, v209
    v_mfma_f32_16x16x32_bf16 v[212:215], a[232:235], v[120:123], v[212:215]
    v_exp_f32 v210, v210
    v_mfma_f32_16x16x32_bf16 v[212:215], a[236:239], v[124:127], v[212:215]
    v_exp_f32 v211, v211
    v_mfma_f32_16x16x32_bf16 a[56:59], a[184:187], v[176:179], a[56:59]
    ds_read_b64_tr_b16 a[168:169], v25 offset:16384
    v_cvt_pk_bf16_f32 v146, v208, v209
    v_mfma_f32_16x16x32_bf16 a[56:59], a[188:191], v[180:183], a[56:59]
    ds_read_b64_tr_b16 a[170:171], v25 offset:20480
    v_mfma_f32_16x16x32_bf16 a[60:63], a[184:187], v[184:187], a[60:63]
    ds_read_b128 a[224:227], v8 offset:45056
    v_cvt_pk_bf16_f32 v147, v210, v211
    v_mfma_f32_16x16x32_bf16 a[60:63], a[188:191], v[188:191], a[60:63]
    s_waitcnt lgkmcnt(3)
    buffer_load_dwordx4 v40, s[12:15], s41 offen offset:2048 lds
    v_mfma_f32_16x16x32_bf16 v[208:211], a[208:211], v[64:67], v[192:195]
    v_exp_f32 v212, v212
    v_mfma_f32_16x16x32_bf16 v[208:211], a[212:215], v[68:71], v[208:211]
    v_exp_f32 v213, v213
    v_mfma_f32_16x16x32_bf16 v[208:211], a[216:219], v[72:75], v[208:211]
    v_exp_f32 v214, v214
    v_mfma_f32_16x16x32_bf16 v[208:211], a[220:223], v[76:79], v[208:211]
    v_exp_f32 v215, v215
    v_mfma_f32_16x16x32_bf16 a[64:67], a[160:163], v[160:163], a[64:67]
    ds_read_b64_tr_b16 a[172:173], v25 offset:24576
    v_cvt_pk_bf16_f32 v154, v212, v213
    v_mfma_f32_16x16x32_bf16 a[64:67], a[164:167], v[164:167], a[64:67]
    ds_read_b64_tr_b16 a[174:175], v25 offset:28672
    v_mfma_f32_16x16x32_bf16 a[68:71], a[160:163], v[168:171], a[68:71]
    ds_read_b128 a[228:231], v9 offset:45056
    v_cvt_pk_bf16_f32 v155, v214, v215
    v_mfma_f32_16x16x32_bf16 a[68:71], a[164:167], v[172:175], a[68:71]
    v_smfmac_f32_16x16x64_bf16 a[204:207], v[52:55], v[184:191], v50
    v_mfma_f32_16x16x32_bf16 v[212:215], a[208:211], v[80:83], v[196:199]
    v_exp_f32 v208, v208
    v_mfma_f32_16x16x32_bf16 v[212:215], a[212:215], v[84:87], v[212:215]
    v_exp_f32 v209, v209
    v_mfma_f32_16x16x32_bf16 v[212:215], a[216:219], v[88:91], v[212:215]
    v_exp_f32 v210, v210
    v_mfma_f32_16x16x32_bf16 v[212:215], a[220:223], v[92:95], v[212:215]
    v_exp_f32 v211, v211
    v_mfma_f32_16x16x32_bf16 a[72:75], a[160:163], v[176:179], a[72:75]
    ds_read_b64_tr_b16 a[176:177], v26 offset:16384
    v_cvt_pk_bf16_f32 v132, v208, v209
    v_mfma_f32_16x16x32_bf16 a[72:75], a[164:167], v[180:183], a[72:75]
    ds_read_b64_tr_b16 a[178:179], v26 offset:20480
    v_mfma_f32_16x16x32_bf16 a[76:79], a[160:163], v[184:187], a[76:79]
    ds_read_b128 a[232:235], v10 offset:45056
    v_cvt_pk_bf16_f32 v133, v210, v211
    v_mfma_f32_16x16x32_bf16 a[76:79], a[164:167], v[188:191], a[76:79]
    s_waitcnt lgkmcnt(3)
    buffer_load_dwordx4 v41, s[12:15], s41 offen offset:3072 lds
    v_mfma_f32_16x16x32_bf16 v[208:211], a[208:211], v[96:99], v[200:203]
    v_exp_f32 v212, v212
    v_mfma_f32_16x16x32_bf16 v[208:211], a[212:215], v[100:103], v[208:211]
    s_add_u32 s41, s41, 16384
    v_exp_f32 v213, v213
    v_mfma_f32_16x16x32_bf16 v[208:211], a[216:219], v[104:107], v[208:211]
    v_exp_f32 v214, v214
    v_mfma_f32_16x16x32_bf16 v[208:211], a[220:223], v[108:111], v[208:211]
    v_exp_f32 v215, v215
    v_mfma_f32_16x16x32_bf16 a[80:83], a[168:171], v[160:163], a[80:83]
    ds_read_b64_tr_b16 a[180:181], v26 offset:24576
    v_cvt_pk_bf16_f32 v140, v212, v213
    v_mfma_f32_16x16x32_bf16 a[80:83], a[172:175], v[164:167], a[80:83]
    ds_read_b64_tr_b16 a[182:183], v26 offset:28672
    v_mfma_f32_16x16x32_bf16 a[84:87], a[168:171], v[168:171], a[84:87]
    ds_read_b128 a[236:239], v11 offset:45056
    v_cvt_pk_bf16_f32 v141, v214, v215
    v_mfma_f32_16x16x32_bf16 a[84:87], a[172:175], v[172:175], a[84:87]
    s_waitcnt vmcnt(9)
    s_barrier
    v_mfma_f32_16x16x32_bf16 v[212:215], a[208:211], v[112:115], v[204:207]
    v_exp_f32 v208, v208
    v_mfma_f32_16x16x32_bf16 v[212:215], a[212:215], v[116:119], v[212:215]
    s_add_u32 m0, s42, 16384
    v_exp_f32 v209, v209
    v_mfma_f32_16x16x32_bf16 v[212:215], a[216:219], v[120:123], v[212:215]
    v_exp_f32 v210, v210
    v_mfma_f32_16x16x32_bf16 v[212:215], a[220:223], v[124:127], v[212:215]
    v_exp_f32 v211, v211
    v_mfma_f32_16x16x32_bf16 a[88:91], a[168:171], v[176:179], a[88:91]
    ds_read_b64_tr_b16 a[184:185], v27 offset:16384
    v_cvt_pk_bf16_f32 v148, v208, v209
    v_mfma_f32_16x16x32_bf16 a[88:91], a[172:175], v[180:183], a[88:91]
    ds_read_b64_tr_b16 a[186:187], v27 offset:20480
    v_mfma_f32_16x16x32_bf16 a[92:95], a[168:171], v[184:187], a[92:95]
    ds_read_b128 a[208:211], v8 offset:49152
    v_cvt_pk_bf16_f32 v149, v210, v211
    v_mfma_f32_16x16x32_bf16 a[92:95], a[172:175], v[188:191], a[92:95]
    s_waitcnt lgkmcnt(3)
    buffer_load_dwordx4 v36, s[8:11], s40 offen lds
    v_mfma_f32_16x16x32_bf16 v[208:211], a[224:227], v[64:67], v[192:195]
    v_exp_f32 v212, v212
    v_mfma_f32_16x16x32_bf16 v[208:211], a[228:231], v[68:71], v[208:211]
    v_exp_f32 v213, v213
    v_mfma_f32_16x16x32_bf16 v[208:211], a[232:235], v[72:75], v[208:211]
    v_exp_f32 v214, v214
    v_mfma_f32_16x16x32_bf16 v[208:211], a[236:239], v[76:79], v[208:211]
    v_exp_f32 v215, v215
    v_mfma_f32_16x16x32_bf16 a[96:99], a[176:179], v[160:163], a[96:99]
    ds_read_b64_tr_b16 a[188:189], v27 offset:24576
    v_cvt_pk_bf16_f32 v156, v212, v213
    v_mfma_f32_16x16x32_bf16 a[96:99], a[180:183], v[164:167], a[96:99]
    ds_read_b64_tr_b16 a[190:191], v27 offset:28672
    v_mfma_f32_16x16x32_bf16 a[100:103], a[176:179], v[168:171], a[100:103]
    ds_read_b128 a[212:215], v9 offset:49152
    v_cvt_pk_bf16_f32 v157, v214, v215
    v_mfma_f32_16x16x32_bf16 a[100:103], a[180:183], v[172:175], a[100:103]
    buffer_load_dword v218, v57, s[80:83], s39 offen
    v_mfma_f32_16x16x32_bf16 v[212:215], a[224:227], v[80:83], v[196:199]
    v_exp_f32 v208, v208
    v_mfma_f32_16x16x32_bf16 v[212:215], a[228:231], v[84:87], v[212:215]
    v_exp_f32 v209, v209
    v_mfma_f32_16x16x32_bf16 v[212:215], a[232:235], v[88:91], v[212:215]
    v_exp_f32 v210, v210
    v_mfma_f32_16x16x32_bf16 v[212:215], a[236:239], v[92:95], v[212:215]
    v_exp_f32 v211, v211
    v_mfma_f32_16x16x32_bf16 a[104:107], a[176:179], v[176:179], a[104:107]
    ds_read_b64_tr_b16 a[160:161], v20 offset:32768
    v_cvt_pk_bf16_f32 v134, v208, v209
    v_mfma_f32_16x16x32_bf16 a[104:107], a[180:183], v[180:183], a[104:107]
    ds_read_b64_tr_b16 a[162:163], v20 offset:36864
    v_mfma_f32_16x16x32_bf16 a[108:111], a[176:179], v[184:187], a[108:111]
    ds_read_b128 a[216:219], v10 offset:49152
    v_cvt_pk_bf16_f32 v135, v210, v211
    v_mfma_f32_16x16x32_bf16 a[108:111], a[180:183], v[188:191], a[108:111]
    s_waitcnt lgkmcnt(3)
    buffer_load_dwordx4 v37, s[8:11], s40 offen offset:1024 lds
    v_mfma_f32_16x16x32_bf16 v[208:211], a[224:227], v[96:99], v[200:203]
    v_exp_f32 v212, v212
    v_mfma_f32_16x16x32_bf16 v[208:211], a[228:231], v[100:103], v[208:211]
    v_exp_f32 v213, v213
    v_mfma_f32_16x16x32_bf16 v[208:211], a[232:235], v[104:107], v[208:211]
    v_exp_f32 v214, v214
    v_mfma_f32_16x16x32_bf16 v[208:211], a[236:239], v[108:111], v[208:211]
    v_exp_f32 v215, v215
    v_mfma_f32_16x16x32_bf16 a[112:115], a[184:187], v[160:163], a[112:115]
    ds_read_b64_tr_b16 a[164:165], v20 offset:40960
    v_cvt_pk_bf16_f32 v142, v212, v213
    v_mfma_f32_16x16x32_bf16 a[112:115], a[188:191], v[164:167], a[112:115]
    ds_read_b64_tr_b16 a[166:167], v20 offset:45056
    v_mfma_f32_16x16x32_bf16 a[116:119], a[184:187], v[168:171], a[116:119]
    ds_read_b128 a[220:223], v11 offset:49152
    v_cvt_pk_bf16_f32 v143, v214, v215
    v_mfma_f32_16x16x32_bf16 a[116:119], a[188:191], v[172:175], a[116:119]
    buffer_store_dwordx4 v[248:251], v232, s[24:27], s53 offen sc1
    v_mfma_f32_16x16x32_bf16 v[212:215], a[224:227], v[112:115], v[204:207]
    v_exp_f32 v208, v208
    v_mfma_f32_16x16x32_bf16 v[212:215], a[228:231], v[116:119], v[212:215]
    v_exp_f32 v209, v209
    v_mfma_f32_16x16x32_bf16 v[212:215], a[232:235], v[120:123], v[212:215]
    v_exp_f32 v210, v210
    v_mfma_f32_16x16x32_bf16 v[212:215], a[236:239], v[124:127], v[212:215]
    s_add_u32 s53, s53, 656
    v_exp_f32 v211, v211
    v_mfma_f32_16x16x32_bf16 a[120:123], a[184:187], v[176:179], a[120:123]
    ds_read_b64_tr_b16 a[168:169], v21 offset:32768
    v_cvt_pk_bf16_f32 v150, v208, v209
    v_mfma_f32_16x16x32_bf16 a[120:123], a[188:191], v[180:183], a[120:123]
    ds_read_b64_tr_b16 a[170:171], v21 offset:36864
    v_mfma_f32_16x16x32_bf16 a[124:127], a[184:187], v[184:187], a[124:127]
    ds_read_b128 a[224:227], v8 offset:53248
    v_cvt_pk_bf16_f32 v151, v210, v211
    v_mfma_f32_16x16x32_bf16 a[124:127], a[188:191], v[188:191], a[124:127]
    s_waitcnt lgkmcnt(3)
    buffer_load_dwordx4 v38, s[8:11], s40 offen offset:2048 lds
    v_mfma_f32_16x16x32_bf16 v[208:211], a[208:211], v[64:67], v[192:195]
    v_exp_f32 v212, v212
    v_mfma_f32_16x16x32_bf16 v[208:211], a[212:215], v[68:71], v[208:211]
    v_exp_f32 v213, v213
    v_mfma_f32_16x16x32_bf16 v[208:211], a[216:219], v[72:75], v[208:211]
    v_exp_f32 v214, v214
    v_mfma_f32_16x16x32_bf16 v[208:211], a[220:223], v[76:79], v[208:211]
    v_exp_f32 v215, v215
    v_mfma_f32_16x16x32_bf16 a[0:3], a[160:163], v[128:131], a[0:3]
    ds_read_b64_tr_b16 a[172:173], v21 offset:40960
    v_cvt_pk_bf16_f32 v158, v212, v213
    v_mfma_f32_16x16x32_bf16 a[0:3], a[164:167], v[132:135], a[0:3]
    ds_read_b64_tr_b16 a[174:175], v21 offset:45056
    v_mfma_f32_16x16x32_bf16 a[4:7], a[160:163], v[136:139], a[4:7]
    ds_read_b128 a[228:231], v9 offset:53248
    v_cvt_pk_bf16_f32 v159, v214, v215
    v_mfma_f32_16x16x32_bf16 a[4:7], a[164:167], v[140:143], a[4:7]
    v_mfma_f32_16x16x32_bf16 v[212:215], a[208:211], v[80:83], v[196:199]
    v_exp_f32 v208, v208
    v_mfma_f32_16x16x32_bf16 v[212:215], a[212:215], v[84:87], v[212:215]
    v_exp_f32 v209, v209
    v_mfma_f32_16x16x32_bf16 v[212:215], a[216:219], v[88:91], v[212:215]
    v_exp_f32 v210, v210
    v_mfma_f32_16x16x32_bf16 v[212:215], a[220:223], v[92:95], v[212:215]
    v_exp_f32 v211, v211
    v_mfma_f32_16x16x32_bf16 a[8:11], a[160:163], v[144:147], a[8:11]
    ds_read_b64_tr_b16 a[176:177], v22 offset:32768
    v_cvt_pk_bf16_f32 v160, v208, v209
    v_mfma_f32_16x16x32_bf16 a[8:11], a[164:167], v[148:151], a[8:11]
    ds_read_b64_tr_b16 a[178:179], v22 offset:36864
    v_mfma_f32_16x16x32_bf16 a[12:15], a[160:163], v[152:155], a[12:15]
    ds_read_b128 a[232:235], v10 offset:53248
    v_cvt_pk_bf16_f32 v161, v210, v211
    v_mfma_f32_16x16x32_bf16 a[12:15], a[164:167], v[156:159], a[12:15]
    s_waitcnt lgkmcnt(3)
    buffer_load_dwordx4 v39, s[8:11], s40 offen offset:3072 lds
    v_mfma_f32_16x16x32_bf16 v[208:211], a[208:211], v[96:99], v[200:203]
    v_exp_f32 v212, v212
    v_mfma_f32_16x16x32_bf16 v[208:211], a[212:215], v[100:103], v[208:211]
    s_add_u32 s40, s40, 16384
    v_exp_f32 v213, v213
    v_mfma_f32_16x16x32_bf16 v[208:211], a[216:219], v[104:107], v[208:211]
    v_exp_f32 v214, v214
    v_mfma_f32_16x16x32_bf16 v[208:211], a[220:223], v[108:111], v[208:211]
    v_exp_f32 v215, v215
    v_mfma_f32_16x16x32_bf16 a[16:19], a[168:171], v[128:131], a[16:19]
    ds_read_b64_tr_b16 a[180:181], v22 offset:40960
    v_cvt_pk_bf16_f32 v168, v212, v213
    v_mfma_f32_16x16x32_bf16 a[16:19], a[172:175], v[132:135], a[16:19]
    ds_read_b64_tr_b16 a[182:183], v22 offset:45056
    v_mfma_f32_16x16x32_bf16 a[20:23], a[168:171], v[136:139], a[20:23]
    ds_read_b128 a[236:239], v11 offset:53248
    v_cvt_pk_bf16_f32 v169, v214, v215
    v_mfma_f32_16x16x32_bf16 a[20:23], a[172:175], v[140:143], a[20:23]
    v_smfmac_f32_16x16x64_bf16 a[192:195], v[52:55], v[128:135], v50
    v_mfma_f32_16x16x32_bf16 v[212:215], a[208:211], v[112:115], v[204:207]
    v_exp_f32 v208, v208
    v_mfma_f32_16x16x32_bf16 v[212:215], a[212:215], v[116:119], v[212:215]
    s_add_u32 m0, s42, 65536
    v_exp_f32 v209, v209
    v_mfma_f32_16x16x32_bf16 v[212:215], a[216:219], v[120:123], v[212:215]
    v_exp_f32 v210, v210
    v_mfma_f32_16x16x32_bf16 v[212:215], a[220:223], v[124:127], v[212:215]
    v_exp_f32 v211, v211
    v_mfma_f32_16x16x32_bf16 a[24:27], a[168:171], v[144:147], a[24:27]
    ds_read_b64_tr_b16 a[184:185], v23 offset:32768
    v_cvt_pk_bf16_f32 v176, v208, v209
    v_mfma_f32_16x16x32_bf16 a[24:27], a[172:175], v[148:151], a[24:27]
    ds_read_b64_tr_b16 a[186:187], v23 offset:36864
    v_mfma_f32_16x16x32_bf16 a[28:31], a[168:171], v[152:155], a[28:31]
    ds_read_b128 a[208:211], v8 offset:57344
    v_cvt_pk_bf16_f32 v177, v210, v211
    v_mfma_f32_16x16x32_bf16 a[28:31], a[172:175], v[156:159], a[28:31]
    s_waitcnt lgkmcnt(3)
    buffer_load_dwordx4 v40, s[12:15], s41 offen lds
    v_mfma_f32_16x16x32_bf16 v[208:211], a[224:227], v[64:67], v[192:195]
    v_exp_f32 v212, v212
    v_mfma_f32_16x16x32_bf16 v[208:211], a[228:231], v[68:71], v[208:211]
    v_exp_f32 v213, v213
    v_mfma_f32_16x16x32_bf16 v[208:211], a[232:235], v[72:75], v[208:211]
    v_exp_f32 v214, v214
    v_mfma_f32_16x16x32_bf16 v[208:211], a[236:239], v[76:79], v[208:211]
    v_exp_f32 v215, v215
    v_mfma_f32_16x16x32_bf16 a[32:35], a[176:179], v[128:131], a[32:35]
    ds_read_b64_tr_b16 a[188:189], v23 offset:40960
    v_cvt_pk_bf16_f32 v184, v212, v213
    v_mfma_f32_16x16x32_bf16 a[32:35], a[180:183], v[132:135], a[32:35]
    ds_read_b64_tr_b16 a[190:191], v23 offset:45056
    v_mfma_f32_16x16x32_bf16 a[36:39], a[176:179], v[136:139], a[36:39]
    ds_read_b128 a[212:215], v9 offset:57344
    v_cvt_pk_bf16_f32 v185, v214, v215
    v_mfma_f32_16x16x32_bf16 a[36:39], a[180:183], v[140:143], a[36:39]
    v_smfmac_f32_16x16x64_bf16 a[196:199], v[52:55], v[136:143], v50
    v_mfma_f32_16x16x32_bf16 v[212:215], a[224:227], v[80:83], v[196:199]
    v_exp_f32 v208, v208
    v_mfma_f32_16x16x32_bf16 v[212:215], a[228:231], v[84:87], v[212:215]
    v_exp_f32 v209, v209
    v_mfma_f32_16x16x32_bf16 v[212:215], a[232:235], v[88:91], v[212:215]
    v_exp_f32 v210, v210
    v_mfma_f32_16x16x32_bf16 v[212:215], a[236:239], v[92:95], v[212:215]
    v_exp_f32 v211, v211
    v_mfma_f32_16x16x32_bf16 a[40:43], a[176:179], v[144:147], a[40:43]
    ds_read_b64_tr_b16 a[160:161], v24 offset:32768
    v_cvt_pk_bf16_f32 v162, v208, v209
    v_mfma_f32_16x16x32_bf16 a[40:43], a[180:183], v[148:151], a[40:43]
    ds_read_b64_tr_b16 a[162:163], v24 offset:36864
    v_mfma_f32_16x16x32_bf16 a[44:47], a[176:179], v[152:155], a[44:47]
    ds_read_b128 a[216:219], v10 offset:57344
    v_cvt_pk_bf16_f32 v163, v210, v211
    v_mfma_f32_16x16x32_bf16 a[44:47], a[180:183], v[156:159], a[44:47]
    s_waitcnt lgkmcnt(3)
    buffer_load_dwordx4 v41, s[12:15], s41 offen offset:1024 lds
    v_mfma_f32_16x16x32_bf16 v[208:211], a[224:227], v[96:99], v[200:203]
    v_exp_f32 v212, v212
    v_mfma_f32_16x16x32_bf16 v[208:211], a[228:231], v[100:103], v[208:211]
    v_exp_f32 v213, v213
    v_mfma_f32_16x16x32_bf16 v[208:211], a[232:235], v[104:107], v[208:211]
    v_exp_f32 v214, v214
    v_mfma_f32_16x16x32_bf16 v[208:211], a[236:239], v[108:111], v[208:211]
    v_exp_f32 v215, v215
    v_mfma_f32_16x16x32_bf16 a[48:51], a[184:187], v[128:131], a[48:51]
    ds_read_b64_tr_b16 a[164:165], v24 offset:40960
    v_cvt_pk_bf16_f32 v170, v212, v213
    v_mfma_f32_16x16x32_bf16 a[48:51], a[188:191], v[132:135], a[48:51]
    ds_read_b64_tr_b16 a[166:167], v24 offset:45056
    v_mfma_f32_16x16x32_bf16 a[52:55], a[184:187], v[136:139], a[52:55]
    ds_read_b128 a[220:223], v11 offset:57344
    v_cvt_pk_bf16_f32 v171, v214, v215
    v_mfma_f32_16x16x32_bf16 a[52:55], a[188:191], v[140:143], a[52:55]
    v_smfmac_f32_16x16x64_bf16 a[200:203], v[52:55], v[144:151], v50
    v_mfma_f32_16x16x32_bf16 v[212:215], a[224:227], v[112:115], v[204:207]
    v_exp_f32 v208, v208
    v_mfma_f32_16x16x32_bf16 v[212:215], a[228:231], v[116:119], v[212:215]
    v_exp_f32 v209, v209
    v_mfma_f32_16x16x32_bf16 v[212:215], a[232:235], v[120:123], v[212:215]
    v_exp_f32 v210, v210
    v_mfma_f32_16x16x32_bf16 v[212:215], a[236:239], v[124:127], v[212:215]
    v_exp_f32 v211, v211
    v_mfma_f32_16x16x32_bf16 a[56:59], a[184:187], v[144:147], a[56:59]
    ds_read_b64_tr_b16 a[168:169], v25 offset:32768
    v_cvt_pk_bf16_f32 v178, v208, v209
    v_mfma_f32_16x16x32_bf16 a[56:59], a[188:191], v[148:151], a[56:59]
    ds_read_b64_tr_b16 a[170:171], v25 offset:36864
    v_mfma_f32_16x16x32_bf16 a[60:63], a[184:187], v[152:155], a[60:63]
    ds_read_b128 a[224:227], v8 offset:61440
    v_cvt_pk_bf16_f32 v179, v210, v211
    v_mfma_f32_16x16x32_bf16 a[60:63], a[188:191], v[156:159], a[60:63]
    s_waitcnt lgkmcnt(3)
    buffer_load_dwordx4 v40, s[12:15], s41 offen offset:2048 lds
    v_mfma_f32_16x16x32_bf16 v[208:211], a[208:211], v[64:67], v[192:195]
    v_exp_f32 v212, v212
    v_mfma_f32_16x16x32_bf16 v[208:211], a[212:215], v[68:71], v[208:211]
    v_exp_f32 v213, v213
    v_mfma_f32_16x16x32_bf16 v[208:211], a[216:219], v[72:75], v[208:211]
    v_exp_f32 v214, v214
    v_mfma_f32_16x16x32_bf16 v[208:211], a[220:223], v[76:79], v[208:211]
    v_exp_f32 v215, v215
    v_mfma_f32_16x16x32_bf16 a[64:67], a[160:163], v[128:131], a[64:67]
    ds_read_b64_tr_b16 a[172:173], v25 offset:40960
    v_cvt_pk_bf16_f32 v186, v212, v213
    v_mfma_f32_16x16x32_bf16 a[64:67], a[164:167], v[132:135], a[64:67]
    ds_read_b64_tr_b16 a[174:175], v25 offset:45056
    v_mfma_f32_16x16x32_bf16 a[68:71], a[160:163], v[136:139], a[68:71]
    ds_read_b128 a[228:231], v9 offset:61440
    v_cvt_pk_bf16_f32 v187, v214, v215
    v_mfma_f32_16x16x32_bf16 a[68:71], a[164:167], v[140:143], a[68:71]
    v_smfmac_f32_16x16x64_bf16 a[204:207], v[52:55], v[152:159], v50
    v_mfma_f32_16x16x32_bf16 v[212:215], a[208:211], v[80:83], v[196:199]
    v_exp_f32 v208, v208
    v_mfma_f32_16x16x32_bf16 v[212:215], a[212:215], v[84:87], v[212:215]
    v_exp_f32 v209, v209
    v_mfma_f32_16x16x32_bf16 v[212:215], a[216:219], v[88:91], v[212:215]
    v_exp_f32 v210, v210
    v_mfma_f32_16x16x32_bf16 v[212:215], a[220:223], v[92:95], v[212:215]
    v_exp_f32 v211, v211
    v_mfma_f32_16x16x32_bf16 a[72:75], a[160:163], v[144:147], a[72:75]
    ds_read_b64_tr_b16 a[176:177], v26 offset:32768
    v_cvt_pk_bf16_f32 v164, v208, v209
    v_mfma_f32_16x16x32_bf16 a[72:75], a[164:167], v[148:151], a[72:75]
    ds_read_b64_tr_b16 a[178:179], v26 offset:36864
    v_mfma_f32_16x16x32_bf16 a[76:79], a[160:163], v[152:155], a[76:79]
    ds_read_b128 a[232:235], v10 offset:61440
    v_cvt_pk_bf16_f32 v165, v210, v211
    v_mfma_f32_16x16x32_bf16 a[76:79], a[164:167], v[156:159], a[76:79]
    s_waitcnt lgkmcnt(3)
    buffer_load_dwordx4 v41, s[12:15], s41 offen offset:3072 lds
    v_mfma_f32_16x16x32_bf16 v[208:211], a[208:211], v[96:99], v[200:203]
    v_exp_f32 v212, v212
    v_mfma_f32_16x16x32_bf16 v[208:211], a[212:215], v[100:103], v[208:211]
    s_add_u32 s41, s41, 16384
    v_exp_f32 v213, v213
    v_mfma_f32_16x16x32_bf16 v[208:211], a[216:219], v[104:107], v[208:211]
    v_exp_f32 v214, v214
    v_mfma_f32_16x16x32_bf16 v[208:211], a[220:223], v[108:111], v[208:211]
    v_exp_f32 v215, v215
    v_mfma_f32_16x16x32_bf16 a[80:83], a[168:171], v[128:131], a[80:83]
    ds_read_b64_tr_b16 a[180:181], v26 offset:40960
    v_cvt_pk_bf16_f32 v172, v212, v213
    v_mfma_f32_16x16x32_bf16 a[80:83], a[172:175], v[132:135], a[80:83]
    ds_read_b64_tr_b16 a[182:183], v26 offset:45056
    v_mfma_f32_16x16x32_bf16 a[84:87], a[168:171], v[136:139], a[84:87]
    ds_read_b128 a[236:239], v11 offset:61440
    v_cvt_pk_bf16_f32 v173, v214, v215
    v_mfma_f32_16x16x32_bf16 a[84:87], a[172:175], v[140:143], a[84:87]
    s_waitcnt vmcnt(10)
    s_barrier
    v_mfma_f32_16x16x32_bf16 v[212:215], a[208:211], v[112:115], v[204:207]
    v_exp_f32 v208, v208
    v_mfma_f32_16x16x32_bf16 v[212:215], a[212:215], v[116:119], v[212:215]
    s_add_u32 m0, s42, 32768
    v_exp_f32 v209, v209
    v_mfma_f32_16x16x32_bf16 v[212:215], a[216:219], v[120:123], v[212:215]
    v_exp_f32 v210, v210
    v_mfma_f32_16x16x32_bf16 v[212:215], a[220:223], v[124:127], v[212:215]
    v_exp_f32 v211, v211
    v_mfma_f32_16x16x32_bf16 a[88:91], a[168:171], v[144:147], a[88:91]
    ds_read_b64_tr_b16 a[184:185], v27 offset:32768
    v_cvt_pk_bf16_f32 v180, v208, v209
    v_mfma_f32_16x16x32_bf16 a[88:91], a[172:175], v[148:151], a[88:91]
    ds_read_b64_tr_b16 a[186:187], v27 offset:36864
    v_mfma_f32_16x16x32_bf16 a[92:95], a[168:171], v[152:155], a[92:95]
    ds_read_b128 a[208:211], v8 offset:0
    v_cvt_pk_bf16_f32 v181, v210, v211
    v_mfma_f32_16x16x32_bf16 a[92:95], a[172:175], v[156:159], a[92:95]
    s_waitcnt lgkmcnt(3)
    buffer_load_dwordx4 v36, s[8:11], s40 offen lds
    v_mfma_f32_16x16x32_bf16 v[208:211], a[224:227], v[64:67], v[192:195]
    v_exp_f32 v212, v212
    v_mfma_f32_16x16x32_bf16 v[208:211], a[228:231], v[68:71], v[208:211]
    v_exp_f32 v213, v213
    v_mfma_f32_16x16x32_bf16 v[208:211], a[232:235], v[72:75], v[208:211]
    v_exp_f32 v214, v214
    v_mfma_f32_16x16x32_bf16 v[208:211], a[236:239], v[76:79], v[208:211]
    v_exp_f32 v215, v215
    v_mfma_f32_16x16x32_bf16 a[96:99], a[176:179], v[128:131], a[96:99]
    ds_read_b64_tr_b16 a[188:189], v27 offset:40960
    v_cvt_pk_bf16_f32 v188, v212, v213
    v_mfma_f32_16x16x32_bf16 a[96:99], a[180:183], v[132:135], a[96:99]
    ds_read_b64_tr_b16 a[190:191], v27 offset:45056
    v_mfma_f32_16x16x32_bf16 a[100:103], a[176:179], v[136:139], a[100:103]
    ds_read_b128 a[212:215], v9 offset:0
    v_cvt_pk_bf16_f32 v189, v214, v215
    v_mfma_f32_16x16x32_bf16 a[100:103], a[180:183], v[140:143], a[100:103]
    buffer_load_dword v219, v62, s[84:87], s38 offen
    v_mfma_f32_16x16x32_bf16 v[212:215], a[224:227], v[80:83], v[196:199]
    v_exp_f32 v208, v208
    v_mfma_f32_16x16x32_bf16 v[212:215], a[228:231], v[84:87], v[212:215]
    v_exp_f32 v209, v209
    v_mfma_f32_16x16x32_bf16 v[212:215], a[232:235], v[88:91], v[212:215]
    v_exp_f32 v210, v210
    v_mfma_f32_16x16x32_bf16 v[212:215], a[236:239], v[92:95], v[212:215]
    v_exp_f32 v211, v211
    v_mfma_f32_16x16x32_bf16 a[104:107], a[176:179], v[144:147], a[104:107]
    ds_read_b64_tr_b16 a[160:161], v20 offset:49152
    v_cvt_pk_bf16_f32 v166, v208, v209
    v_mfma_f32_16x16x32_bf16 a[104:107], a[180:183], v[148:151], a[104:107]
    ds_read_b64_tr_b16 a[162:163], v20 offset:53248
    v_mfma_f32_16x16x32_bf16 a[108:111], a[176:179], v[152:155], a[108:111]
    ds_read_b128 a[216:219], v10 offset:0
    v_cvt_pk_bf16_f32 v167, v210, v211
    v_mfma_f32_16x16x32_bf16 a[108:111], a[180:183], v[156:159], a[108:111]
    s_waitcnt lgkmcnt(3)
    buffer_load_dwordx4 v37, s[8:11], s40 offen offset:1024 lds
    v_mfma_f32_16x16x32_bf16 v[208:211], a[224:227], v[96:99], v[200:203]
    v_exp_f32 v212, v212
    v_mfma_f32_16x16x32_bf16 v[208:211], a[228:231], v[100:103], v[208:211]
    v_exp_f32 v213, v213
    v_mfma_f32_16x16x32_bf16 v[208:211], a[232:235], v[104:107], v[208:211]
    v_exp_f32 v214, v214
    v_mfma_f32_16x16x32_bf16 v[208:211], a[236:239], v[108:111], v[208:211]
    v_exp_f32 v215, v215
    v_mfma_f32_16x16x32_bf16 a[112:115], a[184:187], v[128:131], a[112:115]
    ds_read_b64_tr_b16 a[164:165], v20 offset:57344
    v_cvt_pk_bf16_f32 v174, v212, v213
    v_mfma_f32_16x16x32_bf16 a[112:115], a[188:191], v[132:135], a[112:115]
    ds_read_b64_tr_b16 a[166:167], v20 offset:61440
    v_mfma_f32_16x16x32_bf16 a[116:119], a[184:187], v[136:139], a[116:119]
    ds_read_b128 a[220:223], v11 offset:0
    v_cvt_pk_bf16_f32 v175, v214, v215
    v_mfma_f32_16x16x32_bf16 a[116:119], a[188:191], v[140:143], a[116:119]
    buffer_load_dword v221, v235, s[20:23], 0 offen
    v_mfma_f32_16x16x32_bf16 v[212:215], a[224:227], v[112:115], v[204:207]
    v_exp_f32 v208, v208
    v_mfma_f32_16x16x32_bf16 v[212:215], a[228:231], v[116:119], v[212:215]
    v_exp_f32 v209, v209
    v_mfma_f32_16x16x32_bf16 v[212:215], a[232:235], v[120:123], v[212:215]
    v_exp_f32 v210, v210
    v_mfma_f32_16x16x32_bf16 v[212:215], a[236:239], v[124:127], v[212:215]
    v_exp_f32 v211, v211
    v_mfma_f32_16x16x32_bf16 a[120:123], a[184:187], v[144:147], a[120:123]
    ds_read_b64_tr_b16 a[168:169], v21 offset:49152
    v_cvt_pk_bf16_f32 v182, v208, v209
    v_mfma_f32_16x16x32_bf16 a[120:123], a[188:191], v[148:151], a[120:123]
    ds_read_b64_tr_b16 a[170:171], v21 offset:53248
    v_add_u32 v235, 2560, v235
    v_mfma_f32_16x16x32_bf16 a[124:127], a[184:187], v[152:155], a[124:127]
    ds_read_b128 a[224:227], v8 offset:4096
    v_cvt_pk_bf16_f32 v183, v210, v211
    v_mfma_f32_16x16x32_bf16 a[124:127], a[188:191], v[156:159], a[124:127]
    s_waitcnt lgkmcnt(3)
    buffer_load_dwordx4 v38, s[8:11], s40 offen offset:2048 lds
    v_mfma_f32_16x16x32_bf16 v[208:211], a[208:211], v[64:67], v[192:195]
    v_exp_f32 v212, v212
    v_mfma_f32_16x16x32_bf16 v[208:211], a[212:215], v[68:71], v[208:211]
    v_exp_f32 v213, v213
    v_mfma_f32_16x16x32_bf16 v[208:211], a[216:219], v[72:75], v[208:211]
    v_exp_f32 v214, v214
    v_mfma_f32_16x16x32_bf16 v[208:211], a[220:223], v[76:79], v[208:211]
    v_exp_f32 v215, v215
    v_mfma_f32_16x16x32_bf16 a[0:3], a[160:163], v[160:163], a[0:3]
    ds_read_b64_tr_b16 a[172:173], v21 offset:57344
    v_cvt_pk_bf16_f32 v190, v212, v213
    v_mfma_f32_16x16x32_bf16 a[0:3], a[164:167], v[164:167], a[0:3]
    ds_read_b64_tr_b16 a[174:175], v21 offset:61440
    v_lshlrev_b32 v244, 16, v240
    v_mfma_f32_16x16x32_bf16 a[4:7], a[160:163], v[168:171], a[4:7]
    ds_read_b128 a[228:231], v9 offset:4096
    v_cvt_pk_bf16_f32 v191, v214, v215
    v_mfma_f32_16x16x32_bf16 a[4:7], a[164:167], v[172:175], a[4:7]
    v_and_b32 v245, 0xffff0000, v240
    v_fmac_f32 v224, v2, v244
    v_mfma_f32_16x16x32_bf16 v[212:215], a[208:211], v[80:83], v[196:199]
    v_exp_f32 v208, v208
    v_mfma_f32_16x16x32_bf16 v[212:215], a[212:215], v[84:87], v[212:215]
    v_exp_f32 v209, v209
    v_mfma_f32_16x16x32_bf16 v[212:215], a[216:219], v[88:91], v[212:215]
    v_exp_f32 v210, v210
    v_mfma_f32_16x16x32_bf16 v[212:215], a[220:223], v[92:95], v[212:215]
    v_exp_f32 v211, v211
    v_mfma_f32_16x16x32_bf16 a[8:11], a[160:163], v[176:179], a[8:11]
    ds_read_b64_tr_b16 a[176:177], v22 offset:49152
    v_cvt_pk_bf16_f32 v128, v208, v209
    v_mfma_f32_16x16x32_bf16 a[8:11], a[164:167], v[180:183], a[8:11]
    ds_read_b64_tr_b16 a[178:179], v22 offset:53248
    v_fmac_f32 v225, v2, v245
    v_mfma_f32_16x16x32_bf16 a[12:15], a[160:163], v[184:187], a[12:15]
    ds_read_b128 a[232:235], v10 offset:4096
    v_cvt_pk_bf16_f32 v129, v210, v211
    v_mfma_f32_16x16x32_bf16 a[12:15], a[164:167], v[188:191], a[12:15]
    s_waitcnt lgkmcnt(3)
    buffer_load_dwordx4 v39, s[8:11], s40 offen offset:3072 lds
    v_mfma_f32_16x16x32_bf16 v[208:211], a[208:211], v[96:99], v[200:203]
Ltour5:
    s_cbranch_execz Ltour9
    v_exp_f32 v212, v212
    v_mfma_f32_16x16x32_bf16 v[208:211], a[212:215], v[100:103], v[208:211]
    s_add_u32 s40, s40, 16384
    v_exp_f32 v213, v213
    v_mfma_f32_16x16x32_bf16 v[208:211], a[216:219], v[104:107], v[208:211]
    v_exp_f32 v214, v214
    v_mfma_f32_16x16x32_bf16 v[208:211], a[220:223], v[108:111], v[208:211]
    v_exp_f32 v215, v215
    v_mfma_f32_16x16x32_bf16 a[16:19], a[168:171], v[160:163], a[16:19]
    ds_read_b64_tr_b16 a[180:181], v22 offset:57344
    v_cvt_pk_bf16_f32 v136, v212, v213
    v_mfma_f32_16x16x32_bf16 a[16:19], a[172:175], v[164:167], a[16:19]
    ds_read_b64_tr_b16 a[182:183], v22 offset:61440
    v_lshlrev_b32 v246, 16, v241
    v_mfma_f32_16x16x32_bf16 a[20:23], a[168:171], v[168:171], a[20:23]
    ds_read_b128 a[236:239], v11 offset:4096
    v_cvt_pk_bf16_f32 v137, v214, v215
    v_mfma_f32_16x16x32_bf16 a[20:23], a[172:175], v[172:175], a[20:23]
    v_and_b32 v247, 0xffff0000, v241
    v_fmac_f32 v226, v2, v246
    v_smfmac_f32_16x16x64_bf16 a[192:195], v[52:55], v[160:167], v50
    v_mfma_f32_16x16x32_bf16 v[212:215], a[208:211], v[112:115], v[204:207]
    v_exp_f32 v208, v208
    v_mfma_f32_16x16x32_bf16 v[212:215], a[212:215], v[116:119], v[212:215]
    s_add_u32 m0, s42, 81920
    v_exp_f32 v209, v209
    v_mfma_f32_16x16x32_bf16 v[212:215], a[216:219], v[120:123], v[212:215]
    v_exp_f32 v210, v210
    v_mfma_f32_16x16x32_bf16 v[212:215], a[220:223], v[124:127], v[212:215]
    v_exp_f32 v211, v211
    v_mfma_f32_16x16x32_bf16 a[24:27], a[168:171], v[176:179], a[24:27]
    ds_read_b64_tr_b16 a[184:185], v23 offset:49152
    v_cvt_pk_bf16_f32 v144, v208, v209
    v_mfma_f32_16x16x32_bf16 a[24:27], a[172:175], v[180:183], a[24:27]
    ds_read_b64_tr_b16 a[186:187], v23 offset:53248
    v_fmac_f32 v227, v2, v247
    v_mfma_f32_16x16x32_bf16 a[28:31], a[168:171], v[184:187], a[28:31]
    ds_read_b128 a[208:211], v8 offset:8192
    v_cvt_pk_bf16_f32 v145, v210, v211
    v_mfma_f32_16x16x32_bf16 a[28:31], a[172:175], v[188:191], a[28:31]
    s_waitcnt lgkmcnt(3)
    buffer_load_dwordx4 v40, s[12:15], s41 offen lds
    v_mfma_f32_16x16x32_bf16 v[208:211], a[224:227], v[64:67], v[192:195]
    v_exp_f32 v212, v212
    v_mfma_f32_16x16x32_bf16 v[208:211], a[228:231], v[68:71], v[208:211]
    v_exp_f32 v213, v213
    v_mfma_f32_16x16x32_bf16 v[208:211], a[232:235], v[72:75], v[208:211]
    v_exp_f32 v214, v214
    v_mfma_f32_16x16x32_bf16 v[208:211], a[236:239], v[76:79], v[208:211]
    v_exp_f32 v215, v215
    v_mfma_f32_16x16x32_bf16 a[32:35], a[176:179], v[160:163], a[32:35]
    ds_read_b64_tr_b16 a[188:189], v23 offset:57344
    v_cvt_pk_bf16_f32 v152, v212, v213
    v_mfma_f32_16x16x32_bf16 a[32:35], a[180:183], v[164:167], a[32:35]
    ds_read_b64_tr_b16 a[190:191], v23 offset:61440
    v_lshlrev_b32 v244, 16, v242
    v_mfma_f32_16x16x32_bf16 a[36:39], a[176:179], v[168:171], a[36:39]
    ds_read_b128 a[212:215], v9 offset:8192
    v_cvt_pk_bf16_f32 v153, v214, v215
    v_mfma_f32_16x16x32_bf16 a[36:39], a[180:183], v[172:175], a[36:39]
    v_and_b32 v245, 0xffff0000, v242
    v_fmac_f32 v228, v2, v244
    v_smfmac_f32_16x16x64_bf16 a[196:199], v[52:55], v[168:175], v50
    v_mfma_f32_16x16x32_bf16 v[212:215], a[224:227], v[80:83], v[196:199]
    v_exp_f32 v208, v208
    v_mfma_f32_16x16x32_bf16 v[212:215], a[228:231], v[84:87], v[212:215]
    v_exp_f32 v209, v209
    v_mfma_f32_16x16x32_bf16 v[212:215], a[232:235], v[88:91], v[212:215]
    v_exp_f32 v210, v210
    v_mfma_f32_16x16x32_bf16 v[212:215], a[236:239], v[92:95], v[212:215]
    v_exp_f32 v211, v211
    v_mfma_f32_16x16x32_bf16 a[40:43], a[176:179], v[176:179], a[40:43]
    ds_read_b64_tr_b16 a[160:161], v24 offset:49152
    v_cvt_pk_bf16_f32 v130, v208, v209
    v_mfma_f32_16x16x32_bf16 a[40:43], a[180:183], v[180:183], a[40:43]
    ds_read_b64_tr_b16 a[162:163], v24 offset:53248
    v_fmac_f32 v229, v2, v245
    v_mfma_f32_16x16x32_bf16 a[44:47], a[176:179], v[184:187], a[44:47]
    ds_read_b128 a[216:219], v10 offset:8192
    v_cvt_pk_bf16_f32 v131, v210, v211
    v_mfma_f32_16x16x32_bf16 a[44:47], a[180:183], v[188:191], a[44:47]
    s_waitcnt lgkmcnt(3)
    buffer_load_dwordx4 v41, s[12:15], s41 offen offset:1024 lds
    v_mfma_f32_16x16x32_bf16 v[208:211], a[224:227], v[96:99], v[200:203]
    v_exp_f32 v212, v212
    v_mfma_f32_16x16x32_bf16 v[208:211], a[228:231], v[100:103], v[208:211]
    v_exp_f32 v213, v213
    v_mfma_f32_16x16x32_bf16 v[208:211], a[232:235], v[104:107], v[208:211]
    v_exp_f32 v214, v214
    v_mfma_f32_16x16x32_bf16 v[208:211], a[236:239], v[108:111], v[208:211]
    v_exp_f32 v215, v215
    v_mfma_f32_16x16x32_bf16 a[48:51], a[184:187], v[160:163], a[48:51]
    ds_read_b64_tr_b16 a[164:165], v24 offset:57344
    v_cvt_pk_bf16_f32 v138, v212, v213
    v_mfma_f32_16x16x32_bf16 a[48:51], a[188:191], v[164:167], a[48:51]
    ds_read_b64_tr_b16 a[166:167], v24 offset:61440
    v_lshlrev_b32 v246, 16, v243
    v_mfma_f32_16x16x32_bf16 a[52:55], a[184:187], v[168:171], a[52:55]
    ds_read_b128 a[220:223], v11 offset:8192
    v_cvt_pk_bf16_f32 v139, v214, v215
    v_mfma_f32_16x16x32_bf16 a[52:55], a[188:191], v[172:175], a[52:55]
    v_and_b32 v247, 0xffff0000, v243
    v_fmac_f32 v230, v2, v246
    v_smfmac_f32_16x16x64_bf16 a[200:203], v[52:55], v[176:183], v50
    v_mfma_f32_16x16x32_bf16 v[212:215], a[224:227], v[112:115], v[204:207]
    v_exp_f32 v208, v208
    v_mfma_f32_16x16x32_bf16 v[212:215], a[228:231], v[116:119], v[212:215]
    v_exp_f32 v209, v209
    v_mfma_f32_16x16x32_bf16 v[212:215], a[232:235], v[120:123], v[212:215]
    v_exp_f32 v210, v210
    v_mfma_f32_16x16x32_bf16 v[212:215], a[236:239], v[124:127], v[212:215]
    v_exp_f32 v211, v211
    v_mfma_f32_16x16x32_bf16 a[56:59], a[184:187], v[176:179], a[56:59]
    ds_read_b64_tr_b16 a[168:169], v25 offset:49152
    v_cvt_pk_bf16_f32 v146, v208, v209
    v_mfma_f32_16x16x32_bf16 a[56:59], a[188:191], v[180:183], a[56:59]
    ds_read_b64_tr_b16 a[170:171], v25 offset:53248
    v_fmac_f32 v231, v2, v247
    v_mfma_f32_16x16x32_bf16 a[60:63], a[184:187], v[184:187], a[60:63]
    ds_read_b128 a[224:227], v8 offset:12288
    v_cvt_pk_bf16_f32 v147, v210, v211
    v_mfma_f32_16x16x32_bf16 a[60:63], a[188:191], v[188:191], a[60:63]
    s_waitcnt lgkmcnt(3)
    buffer_load_dwordx4 v40, s[12:15], s41 offen offset:2048 lds
    v_mfma_f32_16x16x32_bf16 v[208:211], a[208:211], v[64:67], v[192:195]
    v_exp_f32 v212, v212
    v_mfma_f32_16x16x32_bf16 v[208:211], a[212:215], v[68:71], v[208:211]
    v_exp_f32 v213, v213
    v_mfma_f32_16x16x32_bf16 v[208:211], a[216:219], v[72:75], v[208:211]
    v_exp_f32 v214, v214
    v_mfma_f32_16x16x32_bf16 v[208:211], a[220:223], v[76:79], v[208:211]
    v_exp_f32 v215, v215
    v_mfma_f32_16x16x32_bf16 a[64:67], a[160:163], v[160:163], a[64:67]
    ds_read_b64_tr_b16 a[172:173], v25 offset:57344
    v_cvt_pk_bf16_f32 v154, v212, v213
    v_mfma_f32_16x16x32_bf16 a[64:67], a[164:167], v[164:167], a[64:67]
    ds_read_b64_tr_b16 a[174:175], v25 offset:61440
    v_mov_b32 v2, v3
    v_mfma_f32_16x16x32_bf16 a[68:71], a[160:163], v[168:171], a[68:71]
    ds_read_b128 a[228:231], v9 offset:12288
    v_cvt_pk_bf16_f32 v155, v214, v215
    v_mfma_f32_16x16x32_bf16 a[68:71], a[164:167], v[172:175], a[68:71]
    v_mov_b32 v3, v4
    v_mov_b32 v4, v5
    v_smfmac_f32_16x16x64_bf16 a[204:207], v[52:55], v[184:191], v50
    v_mfma_f32_16x16x32_bf16 v[212:215], a[208:211], v[80:83], v[196:199]
    v_exp_f32 v208, v208
    v_mfma_f32_16x16x32_bf16 v[212:215], a[212:215], v[84:87], v[212:215]
    v_exp_f32 v209, v209
    v_mfma_f32_16x16x32_bf16 v[212:215], a[216:219], v[88:91], v[212:215]
    v_exp_f32 v210, v210
    v_mfma_f32_16x16x32_bf16 v[212:215], a[220:223], v[92:95], v[212:215]
    v_exp_f32 v211, v211
    v_mfma_f32_16x16x32_bf16 a[72:75], a[160:163], v[176:179], a[72:75]
    ds_read_b64_tr_b16 a[176:177], v26 offset:49152
    v_cvt_pk_bf16_f32 v132, v208, v209
    v_mfma_f32_16x16x32_bf16 a[72:75], a[164:167], v[180:183], a[72:75]
    ds_read_b64_tr_b16 a[178:179], v26 offset:53248
    v_mov_b32 v5, v6
    v_mfma_f32_16x16x32_bf16 a[76:79], a[160:163], v[184:187], a[76:79]
    ds_read_b128 a[232:235], v10 offset:12288
    v_cvt_pk_bf16_f32 v133, v210, v211
    v_mfma_f32_16x16x32_bf16 a[76:79], a[164:167], v[188:191], a[76:79]
    s_waitcnt lgkmcnt(3)
    buffer_load_dwordx4 v41, s[12:15], s41 offen offset:3072 lds
    v_mfma_f32_16x16x32_bf16 v[208:211], a[208:211], v[96:99], v[200:203]
    v_exp_f32 v212, v212
    v_mfma_f32_16x16x32_bf16 v[208:211], a[212:215], v[100:103], v[208:211]
    s_add_u32 s41, s41, 16384
    v_exp_f32 v213, v213
    v_mfma_f32_16x16x32_bf16 v[208:211], a[216:219], v[104:107], v[208:211]
    v_exp_f32 v214, v214
    v_mfma_f32_16x16x32_bf16 v[208:211], a[220:223], v[108:111], v[208:211]
    v_exp_f32 v215, v215
    v_mfma_f32_16x16x32_bf16 a[80:83], a[168:171], v[160:163], a[80:83]
    ds_read_b64_tr_b16 a[180:181], v26 offset:57344
    v_cvt_pk_bf16_f32 v140, v212, v213
    v_mfma_f32_16x16x32_bf16 a[80:83], a[172:175], v[164:167], a[80:83]
    ds_read_b64_tr_b16 a[182:183], v26 offset:61440
    v_mfma_f32_16x16x32_bf16 a[84:87], a[168:171], v[168:171], a[84:87]
    ds_read_b128 a[236:239], v11 offset:12288
    v_cvt_pk_bf16_f32 v141, v214, v215
    v_mfma_f32_16x16x32_bf16 a[84:87], a[172:175], v[172:175], a[84:87]
    s_waitcnt vmcnt(10)
    s_barrier
    v_mfma_f32_16x16x32_bf16 v[212:215], a[208:211], v[112:115], v[204:207]
    v_exp_f32 v208, v208
    v_mfma_f32_16x16x32_bf16 v[212:215], a[212:215], v[116:119], v[212:215]
    s_add_u32 m0, s42, 49152
    v_exp_f32 v209, v209
    v_mfma_f32_16x16x32_bf16 v[212:215], a[216:219], v[120:123], v[212:215]
    v_exp_f32 v210, v210
    v_mfma_f32_16x16x32_bf16 v[212:215], a[220:223], v[124:127], v[212:215]
    v_exp_f32 v211, v211
    v_mfma_f32_16x16x32_bf16 a[88:91], a[168:171], v[176:179], a[88:91]
    ds_read_b64_tr_b16 a[184:185], v27 offset:49152
    v_cvt_pk_bf16_f32 v148, v208, v209
    v_mfma_f32_16x16x32_bf16 a[88:91], a[172:175], v[180:183], a[88:91]
    ds_read_b64_tr_b16 a[186:187], v27 offset:53248
    v_mfma_f32_16x16x32_bf16 a[92:95], a[168:171], v[184:187], a[92:95]
    ds_read_b128 a[208:211], v8 offset:16384
    v_cvt_pk_bf16_f32 v149, v210, v211
    v_mfma_f32_16x16x32_bf16 a[92:95], a[172:175], v[188:191], a[92:95]
    s_waitcnt lgkmcnt(3)
    buffer_load_dwordx4 v36, s[8:11], s40 offen lds
    v_mfma_f32_16x16x32_bf16 v[208:211], a[224:227], v[64:67], v[192:195]
    v_exp_f32 v212, v212
    v_mfma_f32_16x16x32_bf16 v[208:211], a[228:231], v[68:71], v[208:211]
    v_exp_f32 v213, v213
    v_mfma_f32_16x16x32_bf16 v[208:211], a[232:235], v[72:75], v[208:211]
    v_exp_f32 v214, v214
    v_mfma_f32_16x16x32_bf16 v[208:211], a[236:239], v[76:79], v[208:211]
    v_exp_f32 v215, v215
    v_mfma_f32_16x16x32_bf16 a[96:99], a[176:179], v[160:163], a[96:99]
    ds_read_b64_tr_b16 a[188:189], v27 offset:57344
    v_cvt_pk_bf16_f32 v156, v212, v213
    v_mfma_f32_16x16x32_bf16 a[96:99], a[180:183], v[164:167], a[96:99]
    ds_read_b64_tr_b16 a[190:191], v27 offset:61440
    v_mfma_f32_16x16x32_bf16 a[100:103], a[176:179], v[168:171], a[100:103]
    ds_read_b128 a[212:215], v9 offset:16384
    v_cvt_pk_bf16_f32 v157, v214, v215
    v_mfma_f32_16x16x32_bf16 a[100:103], a[180:183], v[172:175], a[100:103]
    buffer_load_dword v216, v237, s[28:31], s52 offen
    v_mfma_f32_16x16x32_bf16 v[212:215], a[224:227], v[80:83], v[196:199]
    v_exp_f32 v208, v208
    v_mfma_f32_16x16x32_bf16 v[212:215], a[228:231], v[84:87], v[212:215]
    s_sub_u32 s39, s39, 36864
    v_exp_f32 v209, v209
    v_mfma_f32_16x16x32_bf16 v[212:215], a[232:235], v[88:91], v[212:215]
    s_sub_u32 s38, s38, 4608
    v_exp_f32 v210, v210
    v_mfma_f32_16x16x32_bf16 v[212:215], a[236:239], v[92:95], v[212:215]
    s_add_u32 s52, s52, 2304
    v_exp_f32 v211, v211
    v_mfma_f32_16x16x32_bf16 a[104:107], a[176:179], v[176:179], a[104:107]
    ds_read_b64_tr_b16 a[160:161], v20 offset:0
    v_cvt_pk_bf16_f32 v134, v208, v209
    v_mfma_f32_16x16x32_bf16 a[104:107], a[180:183], v[180:183], a[104:107]
    ds_read_b64_tr_b16 a[162:163], v20 offset:4096
    v_mfma_f32_16x16x32_bf16 a[108:111], a[176:179], v[184:187], a[108:111]
    ds_read_b128 a[216:219], v10 offset:16384
    v_cvt_pk_bf16_f32 v135, v210, v211
    v_mfma_f32_16x16x32_bf16 a[108:111], a[180:183], v[188:191], a[108:111]
    s_waitcnt lgkmcnt(3)
    buffer_load_dwordx4 v37, s[8:11], s40 offen offset:1024 lds
    v_mfma_f32_16x16x32_bf16 v[208:211], a[224:227], v[96:99], v[200:203]
    v_exp_f32 v212, v212
    v_mfma_f32_16x16x32_bf16 v[208:211], a[228:231], v[100:103], v[208:211]
    v_exp_f32 v213, v213
    v_mfma_f32_16x16x32_bf16 v[208:211], a[232:235], v[104:107], v[208:211]
    v_exp_f32 v214, v214
    v_mfma_f32_16x16x32_bf16 v[208:211], a[236:239], v[108:111], v[208:211]
    v_exp_f32 v215, v215
    v_mfma_f32_16x16x32_bf16 a[112:115], a[184:187], v[160:163], a[112:115]
    ds_read_b64_tr_b16 a[164:165], v20 offset:8192
    v_cvt_pk_bf16_f32 v142, v212, v213
    v_mfma_f32_16x16x32_bf16 a[112:115], a[188:191], v[164:167], a[112:115]
    ds_read_b64_tr_b16 a[166:167], v20 offset:12288
    v_mfma_f32_16x16x32_bf16 a[116:119], a[184:187], v[168:171], a[116:119]
    ds_read_b128 a[220:223], v11 offset:16384
    v_cvt_pk_bf16_f32 v143, v214, v215
    v_mfma_f32_16x16x32_bf16 a[116:119], a[188:191], v[172:175], a[116:119]
    v_mfma_f32_16x16x32_bf16 v[212:215], a[224:227], v[112:115], v[204:207]
    v_exp_f32 v208, v208
    v_mfma_f32_16x16x32_bf16 v[212:215], a[228:231], v[116:119], v[212:215]
    v_exp_f32 v209, v209
    v_mfma_f32_16x16x32_bf16 v[212:215], a[232:235], v[120:123], v[212:215]
    v_exp_f32 v210, v210
    v_mfma_f32_16x16x32_bf16 v[212:215], a[236:239], v[124:127], v[212:215]
    v_exp_f32 v211, v211
    v_mfma_f32_16x16x32_bf16 a[120:123], a[184:187], v[176:179], a[120:123]
    ds_read_b64_tr_b16 a[168:169], v21 offset:0
    v_cvt_pk_bf16_f32 v150, v208, v209
    v_mfma_f32_16x16x32_bf16 a[120:123], a[188:191], v[180:183], a[120:123]
    ds_read_b64_tr_b16 a[170:171], v21 offset:4096
    v_mfma_f32_16x16x32_bf16 a[124:127], a[184:187], v[184:187], a[124:127]
    ds_read_b128 a[224:227], v8 offset:20480
    v_cvt_pk_bf16_f32 v151, v210, v211
    v_mfma_f32_16x16x32_bf16 a[124:127], a[188:191], v[188:191], a[124:127]
    s_waitcnt lgkmcnt(3)
    buffer_load_dwordx4 v38, s[8:11], s40 offen offset:2048 lds
    s_sub_u32 s43, s43, 1
    s_cmp_lg_u32 s43, 0
    s_cbranch_scc1 Lattn_loop
    v_mfma_f32_16x16x32_bf16 v[208:211], a[208:211], v[64:67], v[192:195]
    s_lshl_b32 s38, s3, 6
    v_exp_f32 v212, v212
    v_mfma_f32_16x16x32_bf16 v[208:211], a[212:215], v[68:71], v[208:211]
    s_add_u32 s38, s38, 131136
    v_exp_f32 v213, v213
    v_mfma_f32_16x16x32_bf16 v[208:211], a[216:219], v[72:75], v[208:211]
    v_exp_f32 v214, v214
    v_mfma_f32_16x16x32_bf16 v[208:211], a[220:223], v[76:79], v[208:211]
    s_add_u32 s57, s58, 0
    v_exp_f32 v215, v215
    v_mfma_f32_16x16x32_bf16 a[0:3], a[160:163], v[128:131], a[0:3]
    ds_read_b64_tr_b16 a[172:173], v21 offset:8192
    v_cvt_pk_bf16_f32 v158, v212, v213
    v_mfma_f32_16x16x32_bf16 a[0:3], a[164:167], v[132:135], a[0:3]
    ds_read_b64_tr_b16 a[174:175], v21 offset:12288
    v_permlane32_swap_b32 v224, v228
    v_mfma_f32_16x16x32_bf16 a[4:7], a[160:163], v[136:139], a[4:7]
    ds_read_b128 a[228:231], v9 offset:20480
    v_cvt_pk_bf16_f32 v159, v214, v215
    v_mfma_f32_16x16x32_bf16 a[4:7], a[164:167], v[140:143], a[4:7]
    buffer_load_dwordx4 a[128:131], v254, s[80:83], s57 offen
    v_mfma_f32_16x16x32_bf16 v[212:215], a[208:211], v[80:83], v[196:199]
    v_exp_f32 v208, v208
    v_mfma_f32_16x16x32_bf16 v[212:215], a[212:215], v[84:87], v[212:215]
    v_exp_f32 v209, v209
    v_mfma_f32_16x16x32_bf16 v[212:215], a[216:219], v[88:91], v[212:215]
    v_exp_f32 v210, v210
    v_mfma_f32_16x16x32_bf16 v[212:215], a[220:223], v[92:95], v[212:215]
    v_exp_f32 v211, v211
    v_mfma_f32_16x16x32_bf16 a[8:11], a[160:163], v[144:147], a[8:11]
    ds_read_b64_tr_b16 a[176:177], v22 offset:0
    v_cvt_pk_bf16_f32 v160, v208, v209
    v_mfma_f32_16x16x32_bf16 a[8:11], a[164:167], v[148:151], a[8:11]
    ds_read_b64_tr_b16 a[178:179], v22 offset:4096
    v_permlane32_swap_b32 v225, v229
    v_mfma_f32_16x16x32_bf16 a[12:15], a[160:163], v[152:155], a[12:15]
    ds_read_b128 a[232:235], v10 offset:20480
    v_cvt_pk_bf16_f32 v161, v210, v211
    v_mfma_f32_16x16x32_bf16 a[12:15], a[164:167], v[156:159], a[12:15]
    s_waitcnt lgkmcnt(3)
    buffer_load_dwordx4 v39, s[8:11], s40 offen offset:3072 lds
    v_mfma_f32_16x16x32_bf16 v[208:211], a[208:211], v[96:99], v[200:203]
    v_exp_f32 v212, v212
    v_mfma_f32_16x16x32_bf16 v[208:211], a[212:215], v[100:103], v[208:211]
    s_add_u32 s40, s40, 16384
    v_exp_f32 v213, v213
    v_mfma_f32_16x16x32_bf16 v[208:211], a[216:219], v[104:107], v[208:211]
    v_exp_f32 v214, v214
    v_mfma_f32_16x16x32_bf16 v[208:211], a[220:223], v[108:111], v[208:211]
    v_exp_f32 v215, v215
    v_mfma_f32_16x16x32_bf16 a[16:19], a[168:171], v[128:131], a[16:19]
    ds_read_b64_tr_b16 a[180:181], v22 offset:8192
    v_cvt_pk_bf16_f32 v168, v212, v213
    v_mfma_f32_16x16x32_bf16 a[16:19], a[172:175], v[132:135], a[16:19]
    ds_read_b64_tr_b16 a[182:183], v22 offset:12288
    v_permlane32_swap_b32 v226, v230
    v_mfma_f32_16x16x32_bf16 a[20:23], a[168:171], v[136:139], a[20:23]
    ds_read_b128 a[236:239], v11 offset:20480
    v_cvt_pk_bf16_f32 v169, v214, v215
    v_mfma_f32_16x16x32_bf16 a[20:23], a[172:175], v[140:143], a[20:23]
    v_permlane32_swap_b32 v227, v231
    v_add_f32 v224, v224, v228
    v_smfmac_f32_16x16x64_bf16 a[192:195], v[52:55], v[128:135], v50
    v_mfma_f32_16x16x32_bf16 v[212:215], a[208:211], v[112:115], v[204:207]
    v_exp_f32 v208, v208
    v_mfma_f32_16x16x32_bf16 v[212:215], a[212:215], v[116:119], v[212:215]
    s_add_u32 m0, s42, 98304
    v_exp_f32 v209, v209
    v_mfma_f32_16x16x32_bf16 v[212:215], a[216:219], v[120:123], v[212:215]
    v_exp_f32 v210, v210
    v_mfma_f32_16x16x32_bf16 v[212:215], a[220:223], v[124:127], v[212:215]
    v_exp_f32 v211, v211
    v_mfma_f32_16x16x32_bf16 a[24:27], a[168:171], v[144:147], a[24:27]
    ds_read_b64_tr_b16 a[184:185], v23 offset:0
    v_cvt_pk_bf16_f32 v176, v208, v209
    v_mfma_f32_16x16x32_bf16 a[24:27], a[172:175], v[148:151], a[24:27]
    ds_read_b64_tr_b16 a[186:187], v23 offset:4096
    v_add_f32 v225, v225, v229
    v_mfma_f32_16x16x32_bf16 a[28:31], a[168:171], v[152:155], a[28:31]
    ds_read_b128 a[208:211], v8 offset:24576
    v_cvt_pk_bf16_f32 v177, v210, v211
    v_mfma_f32_16x16x32_bf16 a[28:31], a[172:175], v[156:159], a[28:31]
    s_waitcnt lgkmcnt(3)
    buffer_load_dwordx4 v40, s[12:15], s41 offen lds
    v_mfma_f32_16x16x32_bf16 v[208:211], a[224:227], v[64:67], v[192:195]
    v_exp_f32 v212, v212
    v_mfma_f32_16x16x32_bf16 v[208:211], a[228:231], v[68:71], v[208:211]
    v_exp_f32 v213, v213
    v_mfma_f32_16x16x32_bf16 v[208:211], a[232:235], v[72:75], v[208:211]
    v_exp_f32 v214, v214
    v_mfma_f32_16x16x32_bf16 v[208:211], a[236:239], v[76:79], v[208:211]
    s_add_u32 s57, s58, 589824
    v_exp_f32 v215, v215
    v_mfma_f32_16x16x32_bf16 a[32:35], a[176:179], v[128:131], a[32:35]
    ds_read_b64_tr_b16 a[188:189], v23 offset:8192
    v_cvt_pk_bf16_f32 v184, v212, v213
    v_mfma_f32_16x16x32_bf16 a[32:35], a[180:183], v[132:135], a[32:35]
    ds_read_b64_tr_b16 a[190:191], v23 offset:12288
    v_add_f32 v226, v226, v230
    v_mfma_f32_16x16x32_bf16 a[36:39], a[176:179], v[136:139], a[36:39]
    ds_read_b128 a[212:215], v9 offset:24576
    v_cvt_pk_bf16_f32 v185, v214, v215
    v_mfma_f32_16x16x32_bf16 a[36:39], a[180:183], v[140:143], a[36:39]
    buffer_load_dwordx4 a[132:135], v254, s[80:83], s57 offen
    v_smfmac_f32_16x16x64_bf16 a[196:199], v[52:55], v[136:143], v50
    v_mfma_f32_16x16x32_bf16 v[212:215], a[224:227], v[80:83], v[196:199]
    v_exp_f32 v208, v208
    v_mfma_f32_16x16x32_bf16 v[212:215], a[228:231], v[84:87], v[212:215]
    v_exp_f32 v209, v209
    v_mfma_f32_16x16x32_bf16 v[212:215], a[232:235], v[88:91], v[212:215]
    v_exp_f32 v210, v210
    v_mfma_f32_16x16x32_bf16 v[212:215], a[236:239], v[92:95], v[212:215]
    v_exp_f32 v211, v211
    v_mfma_f32_16x16x32_bf16 a[40:43], a[176:179], v[144:147], a[40:43]
    ds_read_b64_tr_b16 a[160:161], v24 offset:0
    v_cvt_pk_bf16_f32 v162, v208, v209
    v_mfma_f32_16x16x32_bf16 a[40:43], a[180:183], v[148:151], a[40:43]
    ds_read_b64_tr_b16 a[162:163], v24 offset:4096
    v_add_f32 v227, v227, v231
    v_mfma_f32_16x16x32_bf16 a[44:47], a[176:179], v[152:155], a[44:47]
    ds_read_b128 a[216:219], v10 offset:24576
    v_cvt_pk_bf16_f32 v163, v210, v211
    v_mfma_f32_16x16x32_bf16 a[44:47], a[180:183], v[156:159], a[44:47]
    s_waitcnt lgkmcnt(3)
    buffer_load_dwordx4 v41, s[12:15], s41 offen offset:1024 lds
    v_mfma_f32_16x16x32_bf16 v[208:211], a[224:227], v[96:99], v[200:203]
    v_exp_f32 v212, v212
    v_mfma_f32_16x16x32_bf16 v[208:211], a[228:231], v[100:103], v[208:211]
    v_exp_f32 v213, v213
    v_mfma_f32_16x16x32_bf16 v[208:211], a[232:235], v[104:107], v[208:211]
    v_exp_f32 v214, v214
    v_mfma_f32_16x16x32_bf16 v[208:211], a[236:239], v[108:111], v[208:211]
    v_exp_f32 v215, v215
    v_mfma_f32_16x16x32_bf16 a[48:51], a[184:187], v[128:131], a[48:51]
    ds_read_b64_tr_b16 a[164:165], v24 offset:8192
    v_cvt_pk_bf16_f32 v170, v212, v213
    v_mfma_f32_16x16x32_bf16 a[48:51], a[188:191], v[132:135], a[48:51]
    ds_read_b64_tr_b16 a[166:167], v24 offset:12288
    v_and_b32 v244, 1, v1
    v_mfma_f32_16x16x32_bf16 a[52:55], a[184:187], v[136:139], a[52:55]
    ds_read_b128 a[220:223], v11 offset:24576
    v_cvt_pk_bf16_f32 v171, v214, v215
    v_mfma_f32_16x16x32_bf16 a[52:55], a[188:191], v[140:143], a[52:55]
    s_waitcnt vmcnt(15)
    buffer_load_dword v221, v236, s[20:23], 0 offen
    v_smfmac_f32_16x16x64_bf16 a[200:203], v[52:55], v[144:151], v50
    v_mfma_f32_16x16x32_bf16 v[212:215], a[224:227], v[112:115], v[204:207]
    v_exp_f32 v208, v208
    v_mfma_f32_16x16x32_bf16 v[212:215], a[228:231], v[116:119], v[212:215]
    v_exp_f32 v209, v209
    v_mfma_f32_16x16x32_bf16 v[212:215], a[232:235], v[120:123], v[212:215]
    v_exp_f32 v210, v210
    v_mfma_f32_16x16x32_bf16 v[212:215], a[236:239], v[124:127], v[212:215]
    v_exp_f32 v211, v211
    v_mfma_f32_16x16x32_bf16 a[56:59], a[184:187], v[144:147], a[56:59]
    ds_read_b64_tr_b16 a[168:169], v25 offset:0
    v_cvt_pk_bf16_f32 v178, v208, v209
    v_mfma_f32_16x16x32_bf16 a[56:59], a[188:191], v[148:151], a[56:59]
    ds_read_b64_tr_b16 a[170:171], v25 offset:4096
    v_permlane16_swap_b32 v224, v226
    v_mfma_f32_16x16x32_bf16 a[60:63], a[184:187], v[152:155], a[60:63]
    ds_read_b128 a[224:227], v8 offset:28672
    v_cvt_pk_bf16_f32 v179, v210, v211
    v_mfma_f32_16x16x32_bf16 a[60:63], a[188:191], v[156:159], a[60:63]
    s_waitcnt lgkmcnt(3)
    buffer_load_dwordx4 v40, s[12:15], s41 offen offset:2048 lds
    v_mfma_f32_16x16x32_bf16 v[208:211], a[208:211], v[64:67], v[192:195]
    v_exp_f32 v212, v212
    v_mfma_f32_16x16x32_bf16 v[208:211], a[212:215], v[68:71], v[208:211]
    v_exp_f32 v213, v213
    v_mfma_f32_16x16x32_bf16 v[208:211], a[216:219], v[72:75], v[208:211]
    v_exp_f32 v214, v214
    v_mfma_f32_16x16x32_bf16 v[208:211], a[220:223], v[76:79], v[208:211]
    s_add_u32 s57, s58, 1179648
    v_exp_f32 v215, v215
    v_mfma_f32_16x16x32_bf16 a[64:67], a[160:163], v[128:131], a[64:67]
    ds_read_b64_tr_b16 a[172:173], v25 offset:8192
    v_cvt_pk_bf16_f32 v186, v212, v213
    v_mfma_f32_16x16x32_bf16 a[64:67], a[164:167], v[132:135], a[64:67]
    ds_read_b64_tr_b16 a[174:175], v25 offset:12288
    v_permlane16_swap_b32 v225, v227
    v_mfma_f32_16x16x32_bf16 a[68:71], a[160:163], v[136:139], a[68:71]
    ds_read_b128 a[228:231], v9 offset:28672
    v_cvt_pk_bf16_f32 v187, v214, v215
    v_mfma_f32_16x16x32_bf16 a[68:71], a[164:167], v[140:143], a[68:71]
    buffer_load_dwordx4 a[136:139], v254, s[80:83], s57 offen
    v_smfmac_f32_16x16x64_bf16 a[204:207], v[52:55], v[152:159], v50
    v_mfma_f32_16x16x32_bf16 v[212:215], a[208:211], v[80:83], v[196:199]
    v_exp_f32 v208, v208
    v_mfma_f32_16x16x32_bf16 v[212:215], a[212:215], v[84:87], v[212:215]
    v_exp_f32 v209, v209
    v_mfma_f32_16x16x32_bf16 v[212:215], a[216:219], v[88:91], v[212:215]
    v_exp_f32 v210, v210
    v_mfma_f32_16x16x32_bf16 v[212:215], a[220:223], v[92:95], v[212:215]
    v_exp_f32 v211, v211
    v_mfma_f32_16x16x32_bf16 a[72:75], a[160:163], v[144:147], a[72:75]
    ds_read_b64_tr_b16 a[176:177], v26 offset:0
    v_cvt_pk_bf16_f32 v164, v208, v209
    v_mfma_f32_16x16x32_bf16 a[72:75], a[164:167], v[148:151], a[72:75]
    ds_read_b64_tr_b16 a[178:179], v26 offset:4096
    v_lshlrev_b32 v244, 5, v244
    v_mfma_f32_16x16x32_bf16 a[76:79], a[160:163], v[152:155], a[76:79]
    ds_read_b128 a[232:235], v10 offset:28672
    v_cvt_pk_bf16_f32 v165, v210, v211
    v_mfma_f32_16x16x32_bf16 a[76:79], a[164:167], v[156:159], a[76:79]
    s_waitcnt lgkmcnt(3)
    buffer_load_dwordx4 v41, s[12:15], s41 offen offset:3072 lds
    v_mfma_f32_16x16x32_bf16 v[208:211], a[208:211], v[96:99], v[200:203]
    v_exp_f32 v212, v212
    v_mfma_f32_16x16x32_bf16 v[208:211], a[212:215], v[100:103], v[208:211]
    s_add_u32 s41, s41, 16384
    v_exp_f32 v213, v213
    v_mfma_f32_16x16x32_bf16 v[208:211], a[216:219], v[104:107], v[208:211]
    v_exp_f32 v214, v214
    v_mfma_f32_16x16x32_bf16 v[208:211], a[220:223], v[108:111], v[208:211]
    v_exp_f32 v215, v215
    v_mfma_f32_16x16x32_bf16 a[80:83], a[168:171], v[128:131], a[80:83]
    ds_read_b64_tr_b16 a[180:181], v26 offset:8192
    v_cvt_pk_bf16_f32 v172, v212, v213
    v_mfma_f32_16x16x32_bf16 a[80:83], a[172:175], v[132:135], a[80:83]
    ds_read_b64_tr_b16 a[182:183], v26 offset:12288
    v_add_f32 v224, v224, v226
    v_mfma_f32_16x16x32_bf16 a[84:87], a[168:171], v[136:139], a[84:87]
    ds_read_b128 a[236:239], v11 offset:28672
    v_cvt_pk_bf16_f32 v173, v214, v215
    v_mfma_f32_16x16x32_bf16 a[84:87], a[172:175], v[140:143], a[84:87]
    s_waitcnt vmcnt(13)
    s_barrier
    v_mfma_f32_16x16x32_bf16 v[212:215], a[208:211], v[112:115], v[204:207]
    v_exp_f32 v208, v208
    v_mfma_f32_16x16x32_bf16 v[212:215], a[212:215], v[116:119], v[212:215]
    s_add_u32 s49, s45, 1024
    v_exp_f32 v209, v209
    v_mfma_f32_16x16x32_bf16 v[212:215], a[216:219], v[120:123], v[212:215]
    s_add_u32 m0, s42, 0
    v_exp_f32 v210, v210
    v_mfma_f32_16x16x32_bf16 v[212:215], a[220:223], v[124:127], v[212:215]
    v_exp_f32 v211, v211
    v_mfma_f32_16x16x32_bf16 a[88:91], a[168:171], v[144:147], a[88:91]
    ds_read_b64_tr_b16 a[184:185], v27 offset:0
    v_cvt_pk_bf16_f32 v180, v208, v209
    v_mfma_f32_16x16x32_bf16 a[88:91], a[172:175], v[148:151], a[88:91]
    ds_read_b64_tr_b16 a[186:187], v27 offset:4096
    v_add_f32 v225, v225, v227
    v_mfma_f32_16x16x32_bf16 a[92:95], a[168:171], v[152:155], a[92:95]
    ds_read_b128 a[208:211], v8 offset:32768
    v_cvt_pk_bf16_f32 v181, v210, v211
    v_mfma_f32_16x16x32_bf16 a[92:95], a[172:175], v[156:159], a[92:95]
    s_waitcnt lgkmcnt(3)
    buffer_load_dwordx4 v46, s[20:23], s49 offen lds
    v_mfma_f32_16x16x32_bf16 v[208:211], a[224:227], v[64:67], v[192:195]
    v_exp_f32 v212, v212
    v_mfma_f32_16x16x32_bf16 v[208:211], a[228:231], v[68:71], v[208:211]
    v_exp_f32 v213, v213
    v_mfma_f32_16x16x32_bf16 v[208:211], a[232:235], v[72:75], v[208:211]
    v_exp_f32 v214, v214
    v_mfma_f32_16x16x32_bf16 v[208:211], a[236:239], v[76:79], v[208:211]
    s_add_u32 s37, s55, 0
    v_exp_f32 v215, v215
    v_mfma_f32_16x16x32_bf16 a[96:99], a[176:179], v[128:131], a[96:99]
    ds_read_b64_tr_b16 a[188:189], v27 offset:8192
    v_cvt_pk_bf16_f32 v188, v212, v213
    v_mfma_f32_16x16x32_bf16 a[96:99], a[180:183], v[132:135], a[96:99]
    ds_read_b64_tr_b16 a[190:191], v27 offset:12288
    v_lshrrev_b32 v245, 4, v1
    v_mfma_f32_16x16x32_bf16 a[100:103], a[176:179], v[136:139], a[100:103]
    ds_read_b128 a[212:215], v9 offset:32768
    v_cvt_pk_bf16_f32 v189, v214, v215
    v_mfma_f32_16x16x32_bf16 a[100:103], a[180:183], v[140:143], a[100:103]
    buffer_load_dword v239, v238, s[28:31], s37 offen
    v_mfma_f32_16x16x32_bf16 v[212:215], a[224:227], v[80:83], v[196:199]
    v_exp_f32 v208, v208
    v_mfma_f32_16x16x32_bf16 v[212:215], a[228:231], v[84:87], v[212:215]
    v_exp_f32 v209, v209
    v_mfma_f32_16x16x32_bf16 v[212:215], a[232:235], v[88:91], v[212:215]
    v_exp_f32 v210, v210
    v_mfma_f32_16x16x32_bf16 v[212:215], a[236:239], v[92:95], v[212:215]
    v_exp_f32 v211, v211
    v_mfma_f32_16x16x32_bf16 a[104:107], a[176:179], v[144:147], a[104:107]
    ds_read_b64_tr_b16 a[160:161], v20 offset:16384
    v_cvt_pk_bf16_f32 v166, v208, v209
    v_mfma_f32_16x16x32_bf16 a[104:107], a[180:183], v[148:151], a[104:107]
    ds_read_b64_tr_b16 a[162:163], v20 offset:20480
    v_lshl_add_u32 v244, v245, 3, v244
    v_mfma_f32_16x16x32_bf16 a[108:111], a[176:179], v[152:155], a[108:111]
    ds_read_b128 a[216:219], v10 offset:32768
    v_cvt_pk_bf16_f32 v167, v210, v211
    v_mfma_f32_16x16x32_bf16 a[108:111], a[180:183], v[156:159], a[108:111]
    s_waitcnt lgkmcnt(3)
    buffer_load_dwordx4 v47, s[20:23], s49 offen offset:1024 lds
    v_mfma_f32_16x16x32_bf16 v[208:211], a[224:227], v[96:99], v[200:203]
    v_exp_f32 v212, v212
    v_mfma_f32_16x16x32_bf16 v[208:211], a[228:231], v[100:103], v[208:211]
    v_exp_f32 v213, v213
    v_mfma_f32_16x16x32_bf16 v[208:211], a[232:235], v[104:107], v[208:211]
    v_exp_f32 v214, v214
    v_mfma_f32_16x16x32_bf16 v[208:211], a[236:239], v[108:111], v[208:211]
    s_add_u32 s57, s58, 1769472
    v_exp_f32 v215, v215
    v_mfma_f32_16x16x32_bf16 a[112:115], a[184:187], v[128:131], a[112:115]
    ds_read_b64_tr_b16 a[164:165], v20 offset:24576
    v_cvt_pk_bf16_f32 v174, v212, v213
    v_mfma_f32_16x16x32_bf16 a[112:115], a[188:191], v[132:135], a[112:115]
    ds_read_b64_tr_b16 a[166:167], v20 offset:28672
    v_mfma_f32_16x16x32_bf16 a[116:119], a[184:187], v[136:139], a[116:119]
    ds_read_b128 a[220:223], v11 offset:32768
    v_cvt_pk_bf16_f32 v175, v214, v215
    v_mfma_f32_16x16x32_bf16 a[116:119], a[188:191], v[140:143], a[116:119]
    buffer_load_dwordx4 a[140:143], v254, s[80:83], s57 offen
    v_mfma_f32_16x16x32_bf16 v[212:215], a[224:227], v[112:115], v[204:207]
Ltour6:
    s_cbranch_execz Ltour10
    v_exp_f32 v208, v208
    v_mfma_f32_16x16x32_bf16 v[212:215], a[228:231], v[116:119], v[212:215]
    v_exp_f32 v209, v209
    v_mfma_f32_16x16x32_bf16 v[212:215], a[232:235], v[120:123], v[212:215]
    v_exp_f32 v210, v210
    v_mfma_f32_16x16x32_bf16 v[212:215], a[236:239], v[124:127], v[212:215]
    v_exp_f32 v211, v211
    v_mfma_f32_16x16x32_bf16 a[120:123], a[184:187], v[144:147], a[120:123]
    ds_read_b64_tr_b16 a[168:169], v21 offset:16384
    v_cvt_pk_bf16_f32 v182, v208, v209
    v_mfma_f32_16x16x32_bf16 a[120:123], a[188:191], v[148:151], a[120:123]
    ds_read_b64_tr_b16 a[170:171], v21 offset:20480
    v_mfma_f32_16x16x32_bf16 a[124:127], a[184:187], v[152:155], a[124:127]
    ds_read_b128 a[224:227], v8 offset:36864
    v_cvt_pk_bf16_f32 v183, v210, v211
    v_mfma_f32_16x16x32_bf16 a[124:127], a[188:191], v[156:159], a[124:127]
    s_waitcnt lgkmcnt(3)
    buffer_load_dwordx4 v48, s[20:23], s49 offen offset:2048 lds
    v_mfma_f32_16x16x32_bf16 v[208:211], a[208:211], v[64:67], v[192:195]
    v_exp_f32 v212, v212
    v_mfma_f32_16x16x32_bf16 v[208:211], a[212:215], v[68:71], v[208:211]
    v_exp_f32 v213, v213
    v_mfma_f32_16x16x32_bf16 v[208:211], a[216:219], v[72:75], v[208:211]
    v_exp_f32 v214, v214
    v_mfma_f32_16x16x32_bf16 v[208:211], a[220:223], v[76:79], v[208:211]
    s_add_u32 s57, s58, 2359296
    v_exp_f32 v215, v215
    v_mfma_f32_16x16x32_bf16 a[0:3], a[160:163], v[160:163], a[0:3]
    ds_read_b64_tr_b16 a[172:173], v21 offset:24576
    v_cvt_pk_bf16_f32 v190, v212, v213
    v_mfma_f32_16x16x32_bf16 a[0:3], a[164:167], v[164:167], a[0:3]
    ds_read_b64_tr_b16 a[174:175], v21 offset:28672
    v_mov_b32 v63, 0
    v_mfma_f32_16x16x32_bf16 a[4:7], a[160:163], v[168:171], a[4:7]
    ds_read_b128 a[228:231], v9 offset:36864
    v_cvt_pk_bf16_f32 v191, v214, v215
    v_mfma_f32_16x16x32_bf16 a[4:7], a[164:167], v[172:175], a[4:7]
    buffer_load_dwordx4 a[144:147], v254, s[80:83], s57 offen
    v_mfma_f32_16x16x32_bf16 v[212:215], a[208:211], v[80:83], v[196:199]
    v_exp_f32 v208, v208
    v_mfma_f32_16x16x32_bf16 v[212:215], a[212:215], v[84:87], v[212:215]
    v_exp_f32 v209, v209
    v_mfma_f32_16x16x32_bf16 v[212:215], a[216:219], v[88:91], v[212:215]
    v_exp_f32 v210, v210
    v_mfma_f32_16x16x32_bf16 v[212:215], a[220:223], v[92:95], v[212:215]
    v_exp_f32 v211, v211
    v_mfma_f32_16x16x32_bf16 a[8:11], a[160:163], v[176:179], a[8:11]
    ds_read_b64_tr_b16 a[176:177], v22 offset:16384
    v_cvt_pk_bf16_f32 v128, v208, v209
    v_mfma_f32_16x16x32_bf16 a[8:11], a[164:167], v[180:183], a[8:11]
    ds_read_b64_tr_b16 a[178:179], v22 offset:20480
    v_add_f32_dpp v224, v224, v224 row_ror:2 row_mask:0xf bank_mask:0xf
    v_mfma_f32_16x16x32_bf16 a[12:15], a[160:163], v[184:187], a[12:15]
    ds_read_b128 a[232:235], v10 offset:36864
    v_cvt_pk_bf16_f32 v129, v210, v211
    v_mfma_f32_16x16x32_bf16 a[12:15], a[164:167], v[188:191], a[12:15]
    s_waitcnt lgkmcnt(3)
    buffer_load_dwordx4 v49, s[20:23], s49 offen offset:3072 lds
    v_mfma_f32_16x16x32_bf16 v[208:211], a[208:211], v[96:99], v[200:203]
    s_lshr_b32 s39, s2, 5
    v_exp_f32 v212, v212
    v_mfma_f32_16x16x32_bf16 v[208:211], a[212:215], v[100:103], v[208:211]
    s_lshl_b32 s39, s39, 3
    v_exp_f32 v213, v213
    v_mfma_f32_16x16x32_bf16 v[208:211], a[216:219], v[104:107], v[208:211]
    s_and_b32 s43, s2, 7
    v_exp_f32 v214, v214
    v_mfma_f32_16x16x32_bf16 v[208:211], a[220:223], v[108:111], v[208:211]
    s_add_u32 s39, s39, s43
    v_exp_f32 v215, v215
    v_mfma_f32_16x16x32_bf16 a[16:19], a[168:171], v[160:163], a[16:19]
    ds_read_b64_tr_b16 a[180:181], v22 offset:24576
    v_cvt_pk_bf16_f32 v136, v212, v213
    v_mfma_f32_16x16x32_bf16 a[16:19], a[172:175], v[164:167], a[16:19]
    ds_read_b64_tr_b16 a[182:183], v22 offset:28672
    v_add_f32_dpp v225, v225, v225 row_ror:2 row_mask:0xf bank_mask:0xf
    v_mfma_f32_16x16x32_bf16 a[20:23], a[168:171], v[168:171], a[20:23]
    ds_read_b128 a[236:239], v11 offset:36864
    v_cvt_pk_bf16_f32 v137, v214, v215
    v_mfma_f32_16x16x32_bf16 a[20:23], a[172:175], v[172:175], a[20:23]
    buffer_load_dword v253, v63, s[24:27], s54 offen offset:12 sc1
    v_smfmac_f32_16x16x64_bf16 a[192:195], v[52:55], v[160:167], v50
    v_mfma_f32_16x16x32_bf16 v[212:215], a[208:211], v[112:115], v[204:207]
    s_lshl_b32 s39, s39, 2
    v_exp_f32 v208, v208
    v_mfma_f32_16x16x32_bf16 v[212:215], a[212:215], v[116:119], v[212:215]
    s_add_u32 m0, s42, 114688
    v_exp_f32 v209, v209
    v_mfma_f32_16x16x32_bf16 v[212:215], a[216:219], v[120:123], v[212:215]
    s_bfe_u32 s43, s2, 0x20003
    v_exp_f32 v210, v210
    v_mfma_f32_16x16x32_bf16 v[212:215], a[220:223], v[124:127], v[212:215]
    s_add_u32 s39, s39, s43
    v_exp_f32 v211, v211
    v_mfma_f32_16x16x32_bf16 a[24:27], a[168:171], v[176:179], a[24:27]
    ds_read_b64_tr_b16 a[184:185], v23 offset:16384
    v_cvt_pk_bf16_f32 v144, v208, v209
    v_mfma_f32_16x16x32_bf16 a[24:27], a[172:175], v[180:183], a[24:27]
    ds_read_b64_tr_b16 a[186:187], v23 offset:20480
    v_add_f32_dpp v224, v224, v224 row_ror:4 row_mask:0xf bank_mask:0xf
    v_mfma_f32_16x16x32_bf16 a[28:31], a[168:171], v[184:187], a[28:31]
    ds_read_b128 a[208:211], v8 offset:40960
    v_cvt_pk_bf16_f32 v145, v210, v211
    v_mfma_f32_16x16x32_bf16 a[28:31], a[172:175], v[188:191], a[28:31]
    s_waitcnt lgkmcnt(3)
    buffer_load_dwordx4 v40, s[12:15], s41 offen lds
    v_mfma_f32_16x16x32_bf16 v[208:211], a[224:227], v[64:67], v[192:195]
    s_add_u32 s39, s39, 72
    v_exp_f32 v212, v212
    v_mfma_f32_16x16x32_bf16 v[208:211], a[228:231], v[68:71], v[208:211]
    s_cmp_lt_u32 s39, 216
    s_cselect_b32 s43, 0, 2147483648
    v_exp_f32 v213, v213
    v_mfma_f32_16x16x32_bf16 v[208:211], a[232:235], v[72:75], v[208:211]
    s_or_b32 s43, s43, s48
    v_exp_f32 v214, v214
    v_mfma_f32_16x16x32_bf16 v[208:211], a[236:239], v[76:79], v[208:211]
    s_add_u32 s57, s58, 2949120
    v_exp_f32 v215, v215
    v_mfma_f32_16x16x32_bf16 a[32:35], a[176:179], v[160:163], a[32:35]
    ds_read_b64_tr_b16 a[188:189], v23 offset:24576
    v_cvt_pk_bf16_f32 v152, v212, v213
    v_mfma_f32_16x16x32_bf16 a[32:35], a[180:183], v[164:167], a[32:35]
    ds_read_b64_tr_b16 a[190:191], v23 offset:28672
    v_add_f32_dpp v225, v225, v225 row_ror:4 row_mask:0xf bank_mask:0xf
    v_mfma_f32_16x16x32_bf16 a[36:39], a[176:179], v[168:171], a[36:39]
    ds_read_b128 a[212:215], v9 offset:40960
    v_cvt_pk_bf16_f32 v153, v214, v215
    v_mfma_f32_16x16x32_bf16 a[36:39], a[180:183], v[172:175], a[36:39]
    buffer_load_dwordx4 a[148:151], v254, s[80:83], s57 offen
    v_smfmac_f32_16x16x64_bf16 a[196:199], v[52:55], v[168:175], v50
    v_mfma_f32_16x16x32_bf16 v[212:215], a[224:227], v[80:83], v[196:199]
    s_and_b32 s43, s43, 2147483648
    v_exp_f32 v208, v208
    v_mfma_f32_16x16x32_bf16 v[212:215], a[228:231], v[84:87], v[212:215]
    s_sub_u32 s36, s39, 144
    v_exp_f32 v209, v209
    v_mfma_f32_16x16x32_bf16 v[212:215], a[232:235], v[88:91], v[212:215]
    s_cmp_lt_u32 s36, 36
    s_cselect_b32 s36, 1.0, 0
    v_exp_f32 v210, v210
    v_mfma_f32_16x16x32_bf16 v[212:215], a[236:239], v[92:95], v[212:215]
    s_lshr_b32 s44, s39, 1
    v_exp_f32 v211, v211
    v_mfma_f32_16x16x32_bf16 a[40:43], a[176:179], v[176:179], a[40:43]
    ds_read_b64_tr_b16 a[160:161], v24 offset:16384
    v_cvt_pk_bf16_f32 v130, v208, v209
    v_mfma_f32_16x16x32_bf16 a[40:43], a[180:183], v[180:183], a[40:43]
    ds_read_b64_tr_b16 a[162:163], v24 offset:20480
    v_add_f32_dpp v224, v224, v224 row_ror:8 row_mask:0xf bank_mask:0xf
    v_mfma_f32_16x16x32_bf16 a[44:47], a[176:179], v[184:187], a[44:47]
    ds_read_b128 a[216:219], v10 offset:40960
    v_cvt_pk_bf16_f32 v131, v210, v211
    v_mfma_f32_16x16x32_bf16 a[44:47], a[180:183], v[188:191], a[44:47]
    s_waitcnt lgkmcnt(3)
    buffer_load_dwordx4 v41, s[12:15], s41 offen offset:1024 lds
    v_mfma_f32_16x16x32_bf16 v[208:211], a[224:227], v[96:99], v[200:203]
    s_lshl_b32 s44, s44, 6
    v_exp_f32 v212, v212
    v_mfma_f32_16x16x32_bf16 v[208:211], a[228:231], v[100:103], v[208:211]
    s_and_b32 s39, s39, 1
    v_exp_f32 v213, v213
    v_mfma_f32_16x16x32_bf16 v[208:211], a[232:235], v[104:107], v[208:211]
    s_lshl_b32 s39, s39, 3
    v_exp_f32 v214, v214
    v_mfma_f32_16x16x32_bf16 v[208:211], a[236:239], v[108:111], v[208:211]
    s_add_u32 s39, s39, s44
    v_exp_f32 v215, v215
    v_mfma_f32_16x16x32_bf16 a[48:51], a[184:187], v[160:163], a[48:51]
    ds_read_b64_tr_b16 a[164:165], v24 offset:24576
    v_cvt_pk_bf16_f32 v138, v212, v213
    v_mfma_f32_16x16x32_bf16 a[48:51], a[188:191], v[164:167], a[48:51]
    ds_read_b64_tr_b16 a[166:167], v24 offset:28672
    v_add_f32_dpp v225, v225, v225 row_ror:8 row_mask:0xf bank_mask:0xf
    v_mfma_f32_16x16x32_bf16 a[52:55], a[184:187], v[168:171], a[52:55]
    ds_read_b128 a[220:223], v11 offset:40960
    v_cvt_pk_bf16_f32 v139, v214, v215
    v_mfma_f32_16x16x32_bf16 a[52:55], a[188:191], v[172:175], a[52:55]
    v_add_u32 v244, s38, v244
    v_and_b32 v245, 7, v1
    v_smfmac_f32_16x16x64_bf16 a[200:203], v[52:55], v[176:183], v50
    v_mfma_f32_16x16x32_bf16 v[212:215], a[224:227], v[112:115], v[204:207]
    s_add_u32 s39, s39, 16384
    v_exp_f32 v208, v208
    v_mfma_f32_16x16x32_bf16 v[212:215], a[228:231], v[116:119], v[212:215]
    s_or_b32 s39, s39, s43
    v_exp_f32 v209, v209
    v_mfma_f32_16x16x32_bf16 v[212:215], a[232:235], v[120:123], v[212:215]
    v_exp_f32 v210, v210
    v_mfma_f32_16x16x32_bf16 v[212:215], a[236:239], v[124:127], v[212:215]
    v_exp_f32 v211, v211
    v_mfma_f32_16x16x32_bf16 a[56:59], a[184:187], v[176:179], a[56:59]
    ds_read_b64_tr_b16 a[168:169], v25 offset:16384
    v_cvt_pk_bf16_f32 v146, v208, v209
    v_mfma_f32_16x16x32_bf16 a[56:59], a[188:191], v[180:183], a[56:59]
    ds_read_b64_tr_b16 a[170:171], v25 offset:20480
    v_mfma_f32_16x16x32_bf16 a[60:63], a[184:187], v[184:187], a[60:63]
    ds_read_b128 a[224:227], v8 offset:45056
    v_cvt_pk_bf16_f32 v147, v210, v211
    v_mfma_f32_16x16x32_bf16 a[60:63], a[188:191], v[188:191], a[60:63]
    s_waitcnt lgkmcnt(3)
    buffer_load_dwordx4 v40, s[12:15], s41 offen offset:2048 lds
    v_mfma_f32_16x16x32_bf16 v[208:211], a[208:211], v[64:67], v[192:195]
    v_exp_f32 v212, v212
    v_mfma_f32_16x16x32_bf16 v[208:211], a[212:215], v[68:71], v[208:211]
    v_exp_f32 v213, v213
    v_mfma_f32_16x16x32_bf16 v[208:211], a[216:219], v[72:75], v[208:211]
    v_exp_f32 v214, v214
    v_mfma_f32_16x16x32_bf16 v[208:211], a[220:223], v[76:79], v[208:211]
    s_add_u32 s57, s58, 3538944
    v_exp_f32 v215, v215
    v_mfma_f32_16x16x32_bf16 a[64:67], a[160:163], v[160:163], a[64:67]
    ds_read_b64_tr_b16 a[172:173], v25 offset:24576
    v_cvt_pk_bf16_f32 v154, v212, v213
    v_mfma_f32_16x16x32_bf16 a[64:67], a[164:167], v[164:167], a[64:67]
    ds_read_b64_tr_b16 a[174:175], v25 offset:28672
    v_lshlrev_b32 v245, 3, v245
    v_mfma_f32_16x16x32_bf16 a[68:71], a[160:163], v[168:171], a[68:71]
    ds_read_b128 a[228:231], v9 offset:45056
    v_cvt_pk_bf16_f32 v155, v214, v215
    v_mfma_f32_16x16x32_bf16 a[68:71], a[164:167], v[172:175], a[68:71]
    buffer_load_dwordx4 a[152:155], v254, s[80:83], s57 offen
    v_smfmac_f32_16x16x64_bf16 a[204:207], v[52:55], v[184:191], v50
    ds_write_b64 v244, v[224:225]
    v_mfma_f32_16x16x32_bf16 v[212:215], a[208:211], v[80:83], v[196:199]
    v_exp_f32 v208, v208
    v_mfma_f32_16x16x32_bf16 v[212:215], a[212:215], v[84:87], v[212:215]
    v_exp_f32 v209, v209
    v_mfma_f32_16x16x32_bf16 v[212:215], a[216:219], v[88:91], v[212:215]
    v_exp_f32 v210, v210
    v_mfma_f32_16x16x32_bf16 v[212:215], a[220:223], v[92:95], v[212:215]
    v_exp_f32 v211, v211
    v_mfma_f32_16x16x32_bf16 a[72:75], a[160:163], v[176:179], a[72:75]
    ds_read_b64_tr_b16 a[176:177], v26 offset:16384
    v_cvt_pk_bf16_f32 v132, v208, v209
    v_mfma_f32_16x16x32_bf16 a[72:75], a[164:167], v[180:183], a[72:75]
    ds_read_b64_tr_b16 a[178:179], v26 offset:20480
    v_add_u32 v245, 131136, v245
    v_mfma_f32_16x16x32_bf16 a[76:79], a[160:163], v[184:187], a[76:79]
    ds_read_b128 a[232:235], v10 offset:45056
    v_cvt_pk_bf16_f32 v133, v210, v211
    v_mfma_f32_16x16x32_bf16 a[76:79], a[164:167], v[188:191], a[76:79]
    s_waitcnt lgkmcnt(3)
    buffer_load_dwordx4 v41, s[12:15], s41 offen offset:3072 lds
    v_mfma_f32_16x16x32_bf16 v[208:211], a[208:211], v[96:99], v[200:203]
    v_exp_f32 v212, v212
    v_mfma_f32_16x16x32_bf16 v[208:211], a[212:215], v[100:103], v[208:211]
    s_add_u32 s41, s41, 16384
    v_exp_f32 v213, v213
    v_mfma_f32_16x16x32_bf16 v[208:211], a[216:219], v[104:107], v[208:211]
    v_exp_f32 v214, v214
    v_mfma_f32_16x16x32_bf16 v[208:211], a[220:223], v[108:111], v[208:211]
    v_exp_f32 v215, v215
    v_mfma_f32_16x16x32_bf16 a[80:83], a[168:171], v[160:163], a[80:83]
    ds_read_b64_tr_b16 a[180:181], v26 offset:24576
    v_cvt_pk_bf16_f32 v140, v212, v213
    v_mfma_f32_16x16x32_bf16 a[80:83], a[172:175], v[164:167], a[80:83]
    ds_read_b64_tr_b16 a[182:183], v26 offset:28672
    v_mfma_f32_16x16x32_bf16 a[84:87], a[168:171], v[168:171], a[84:87]
    ds_read_b128 a[236:239], v11 offset:45056
    v_cvt_pk_bf16_f32 v141, v214, v215
    v_mfma_f32_16x16x32_bf16 a[84:87], a[172:175], v[172:175], a[84:87]
    s_waitcnt vmcnt(14)
    s_barrier
    v_mfma_f32_16x16x32_bf16 v[212:215], a[208:211], v[112:115], v[204:207]
    v_exp_f32 v208, v208
    v_mfma_f32_16x16x32_bf16 v[212:215], a[212:215], v[116:119], v[212:215]
    s_add_u32 s49, s45, 74752
    v_exp_f32 v209, v209
    v_mfma_f32_16x16x32_bf16 v[212:215], a[216:219], v[120:123], v[212:215]
    s_add_u32 m0, s42, 16384
    v_exp_f32 v210, v210
    v_mfma_f32_16x16x32_bf16 v[212:215], a[220:223], v[124:127], v[212:215]
    v_exp_f32 v211, v211
    v_mfma_f32_16x16x32_bf16 a[88:91], a[168:171], v[176:179], a[88:91]
    ds_read_b64_tr_b16 a[184:185], v27 offset:16384
    v_cvt_pk_bf16_f32 v148, v208, v209
    v_mfma_f32_16x16x32_bf16 a[88:91], a[172:175], v[180:183], a[88:91]
    ds_read_b64_tr_b16 a[186:187], v27 offset:20480
    ds_read_b64 v[224:225], v245 offset:0
    v_mfma_f32_16x16x32_bf16 a[92:95], a[168:171], v[184:187], a[92:95]
    ds_read_b128 a[208:211], v8 offset:49152
    v_cvt_pk_bf16_f32 v149, v210, v211
    v_mfma_f32_16x16x32_bf16 a[92:95], a[172:175], v[188:191], a[92:95]
    s_waitcnt lgkmcnt(3)
    buffer_load_dwordx4 v46, s[20:23], s49 offen lds
    v_mfma_f32_16x16x32_bf16 v[208:211], a[224:227], v[64:67], v[192:195]
    v_exp_f32 v212, v212
    v_mfma_f32_16x16x32_bf16 v[208:211], a[228:231], v[68:71], v[208:211]
    v_exp_f32 v213, v213
    v_mfma_f32_16x16x32_bf16 v[208:211], a[232:235], v[72:75], v[208:211]
    v_exp_f32 v214, v214
    v_mfma_f32_16x16x32_bf16 v[208:211], a[236:239], v[76:79], v[208:211]
    v_exp_f32 v215, v215
    v_mfma_f32_16x16x32_bf16 a[96:99], a[176:179], v[160:163], a[96:99]
    ds_read_b64_tr_b16 a[188:189], v27 offset:24576
    v_cvt_pk_bf16_f32 v156, v212, v213
    v_mfma_f32_16x16x32_bf16 a[96:99], a[180:183], v[164:167], a[96:99]
    ds_read_b64_tr_b16 a[190:191], v27 offset:28672
    ds_read_b64 v[226:227], v245 offset:64
    v_mfma_f32_16x16x32_bf16 a[100:103], a[176:179], v[168:171], a[100:103]
    ds_read_b128 a[212:215], v9 offset:49152
    v_cvt_pk_bf16_f32 v157, v214, v215
    v_mfma_f32_16x16x32_bf16 a[100:103], a[180:183], v[172:175], a[100:103]
    v_mfma_f32_16x16x32_bf16 v[212:215], a[224:227], v[80:83], v[196:199]
    v_exp_f32 v208, v208
    v_mfma_f32_16x16x32_bf16 v[212:215], a[228:231], v[84:87], v[212:215]
    v_exp_f32 v209, v209
    v_mfma_f32_16x16x32_bf16 v[212:215], a[232:235], v[88:91], v[212:215]
    v_exp_f32 v210, v210
    v_mfma_f32_16x16x32_bf16 v[212:215], a[236:239], v[92:95], v[212:215]
    v_exp_f32 v211, v211
    v_mfma_f32_16x16x32_bf16 a[104:107], a[176:179], v[176:179], a[104:107]
    ds_read_b64_tr_b16 a[160:161], v20 offset:32768
    v_cvt_pk_bf16_f32 v134, v208, v209
    v_mfma_f32_16x16x32_bf16 a[104:107], a[180:183], v[180:183], a[104:107]
    ds_read_b64_tr_b16 a[162:163], v20 offset:36864
    ds_read_b64 v[228:229], v245 offset:128
    v_mfma_f32_16x16x32_bf16 a[108:111], a[176:179], v[184:187], a[108:111]
    ds_read_b128 a[216:219], v10 offset:49152
    v_cvt_pk_bf16_f32 v135, v210, v211
    v_mfma_f32_16x16x32_bf16 a[108:111], a[180:183], v[188:191], a[108:111]
    s_waitcnt lgkmcnt(3)
    buffer_load_dwordx4 v47, s[20:23], s49 offen offset:1024 lds
    v_mfma_f32_16x16x32_bf16 v[208:211], a[224:227], v[96:99], v[200:203]
    v_exp_f32 v212, v212
    v_mfma_f32_16x16x32_bf16 v[208:211], a[228:231], v[100:103], v[208:211]
    v_exp_f32 v213, v213
    v_mfma_f32_16x16x32_bf16 v[208:211], a[232:235], v[104:107], v[208:211]
    v_exp_f32 v214, v214
    v_mfma_f32_16x16x32_bf16 v[208:211], a[236:239], v[108:111], v[208:211]
    s_add_u32 s57, s58, 4128768
    v_exp_f32 v215, v215
    v_mfma_f32_16x16x32_bf16 a[112:115], a[184:187], v[160:163], a[112:115]
    ds_read_b64_tr_b16 a[164:165], v20 offset:40960
    v_cvt_pk_bf16_f32 v142, v212, v213
    v_mfma_f32_16x16x32_bf16 a[112:115], a[188:191], v[164:167], a[112:115]
    ds_read_b64_tr_b16 a[166:167], v20 offset:45056
    ds_read_b64 v[230:231], v245 offset:192
    v_mfma_f32_16x16x32_bf16 a[116:119], a[184:187], v[168:171], a[116:119]
    ds_read_b128 a[220:223], v11 offset:49152
    v_cvt_pk_bf16_f32 v143, v214, v215
    v_mfma_f32_16x16x32_bf16 a[116:119], a[188:191], v[172:175], a[116:119]
    buffer_load_dwordx4 a[156:159], v254, s[80:83], s57 offen
    v_mfma_f32_16x16x32_bf16 v[212:215], a[224:227], v[112:115], v[204:207]
    v_exp_f32 v208, v208
    v_mfma_f32_16x16x32_bf16 v[212:215], a[228:231], v[116:119], v[212:215]
    v_exp_f32 v209, v209
    v_mfma_f32_16x16x32_bf16 v[212:215], a[232:235], v[120:123], v[212:215]
    v_exp_f32 v210, v210
    v_mfma_f32_16x16x32_bf16 v[212:215], a[236:239], v[124:127], v[212:215]
    v_exp_f32 v211, v211
    v_mfma_f32_16x16x32_bf16 a[120:123], a[184:187], v[176:179], a[120:123]
    ds_read_b64_tr_b16 a[168:169], v21 offset:32768
    v_cvt_pk_bf16_f32 v150, v208, v209
    v_mfma_f32_16x16x32_bf16 a[120:123], a[188:191], v[180:183], a[120:123]
    ds_read_b64_tr_b16 a[170:171], v21 offset:36864
    v_mfma_f32_16x16x32_bf16 a[124:127], a[184:187], v[184:187], a[124:127]
    ds_read_b128 a[224:227], v8 offset:53248
    v_cvt_pk_bf16_f32 v151, v210, v211
    v_mfma_f32_16x16x32_bf16 a[124:127], a[188:191], v[188:191], a[124:127]
    s_waitcnt lgkmcnt(3)
    buffer_load_dwordx4 v48, s[20:23], s49 offen offset:2048 lds
    v_mfma_f32_16x16x32_bf16 v[208:211], a[208:211], v[64:67], v[192:195]
    v_exp_f32 v212, v212
    v_mfma_f32_16x16x32_bf16 v[208:211], a[212:215], v[68:71], v[208:211]
    v_exp_f32 v213, v213
    v_mfma_f32_16x16x32_bf16 v[208:211], a[216:219], v[72:75], v[208:211]
    v_exp_f32 v214, v214
    v_mfma_f32_16x16x32_bf16 v[208:211], a[220:223], v[76:79], v[208:211]
    s_add_u32 s57, s58, 4718592
    v_exp_f32 v215, v215
    v_mfma_f32_16x16x32_bf16 a[0:3], a[160:163], v[128:131], a[0:3]
    ds_read_b64_tr_b16 a[172:173], v21 offset:40960
    v_cvt_pk_bf16_f32 v158, v212, v213
    v_mfma_f32_16x16x32_bf16 a[0:3], a[164:167], v[132:135], a[0:3]
    ds_read_b64_tr_b16 a[174:175], v21 offset:45056
    v_add_f32 v224, v224, v228
    v_mfma_f32_16x16x32_bf16 a[4:7], a[160:163], v[136:139], a[4:7]
    ds_read_b128 a[228:231], v9 offset:53248
    v_cvt_pk_bf16_f32 v159, v214, v215
    v_mfma_f32_16x16x32_bf16 a[4:7], a[164:167], v[140:143], a[4:7]
    buffer_load_dwordx4 a[240:243], v254, s[80:83], s57 offen
    v_mfma_f32_16x16x32_bf16 v[212:215], a[208:211], v[80:83], v[196:199]
    v_exp_f32 v208, v208
    v_mfma_f32_16x16x32_bf16 v[212:215], a[212:215], v[84:87], v[212:215]
    v_exp_f32 v209, v209
    v_mfma_f32_16x16x32_bf16 v[212:215], a[216:219], v[88:91], v[212:215]
    v_exp_f32 v210, v210
    v_mfma_f32_16x16x32_bf16 v[212:215], a[220:223], v[92:95], v[212:215]
    v_exp_f32 v211, v211
    v_mfma_f32_16x16x32_bf16 a[8:11], a[160:163], v[144:147], a[8:11]
    ds_read_b64_tr_b16 a[176:177], v22 offset:32768
    v_cvt_pk_bf16_f32 v160, v208, v209
    v_mfma_f32_16x16x32_bf16 a[8:11], a[164:167], v[148:151], a[8:11]
    ds_read_b64_tr_b16 a[178:179], v22 offset:36864
    v_add_f32 v225, v225, v229
    v_mfma_f32_16x16x32_bf16 a[12:15], a[160:163], v[152:155], a[12:15]
    ds_read_b128 a[232:235], v10 offset:53248
    v_cvt_pk_bf16_f32 v161, v210, v211
    v_mfma_f32_16x16x32_bf16 a[12:15], a[164:167], v[156:159], a[12:15]
    s_waitcnt lgkmcnt(3)
    buffer_load_dwordx4 v49, s[20:23], s49 offen offset:3072 lds
    v_mfma_f32_16x16x32_bf16 v[208:211], a[208:211], v[96:99], v[200:203]
    v_exp_f32 v212, v212
    v_mfma_f32_16x16x32_bf16 v[208:211], a[212:215], v[100:103], v[208:211]
    v_exp_f32 v213, v213
    v_mfma_f32_16x16x32_bf16 v[208:211], a[216:219], v[104:107], v[208:211]
    v_exp_f32 v214, v214
    v_mfma_f32_16x16x32_bf16 v[208:211], a[220:223], v[108:111], v[208:211]
    v_exp_f32 v215, v215
    v_mfma_f32_16x16x32_bf16 a[16:19], a[168:171], v[128:131], a[16:19]
    ds_read_b64_tr_b16 a[180:181], v22 offset:40960
    v_cvt_pk_bf16_f32 v168, v212, v213
    v_mfma_f32_16x16x32_bf16 a[16:19], a[172:175], v[132:135], a[16:19]
    ds_read_b64_tr_b16 a[182:183], v22 offset:45056
    v_add_f32 v226, v226, v230
    v_mfma_f32_16x16x32_bf16 a[20:23], a[168:171], v[136:139], a[20:23]
    ds_read_b128 a[236:239], v11 offset:53248
    v_cvt_pk_bf16_f32 v169, v214, v215
    v_mfma_f32_16x16x32_bf16 a[20:23], a[172:175], v[140:143], a[20:23]
    v_add_f32 v227, v227, v231
    v_add_f32 v224, v224, v226
    v_smfmac_f32_16x16x64_bf16 a[192:195], v[52:55], v[128:135], v50
    v_mfma_f32_16x16x32_bf16 v[212:215], a[208:211], v[112:115], v[204:207]
    v_exp_f32 v208, v208
    v_mfma_f32_16x16x32_bf16 v[212:215], a[212:215], v[116:119], v[212:215]
    s_add_u32 s49, s7, 0
    v_exp_f32 v209, v209
    v_mfma_f32_16x16x32_bf16 v[212:215], a[216:219], v[120:123], v[212:215]
    s_add_u32 m0, s42, 65536
    v_exp_f32 v210, v210
    v_mfma_f32_16x16x32_bf16 v[212:215], a[220:223], v[124:127], v[212:215]
    v_exp_f32 v211, v211
    v_mfma_f32_16x16x32_bf16 a[24:27], a[168:171], v[144:147], a[24:27]
    ds_read_b64_tr_b16 a[184:185], v23 offset:32768
    v_cvt_pk_bf16_f32 v176, v208, v209
    v_mfma_f32_16x16x32_bf16 a[24:27], a[172:175], v[148:151], a[24:27]
    ds_read_b64_tr_b16 a[186:187], v23 offset:36864
    v_add_f32 v225, v225, v227
    v_mfma_f32_16x16x32_bf16 a[28:31], a[168:171], v[152:155], a[28:31]
    ds_read_b128 a[208:211], v8 offset:57344
    v_cvt_pk_bf16_f32 v177, v210, v211
    v_mfma_f32_16x16x32_bf16 a[28:31], a[172:175], v[156:159], a[28:31]
    s_waitcnt lgkmcnt(3)
    buffer_load_dwordx4 v46, s[20:23], s49 offen lds
    v_mfma_f32_16x16x32_bf16 v[208:211], a[224:227], v[64:67], v[192:195]
    v_exp_f32 v212, v212
    v_mfma_f32_16x16x32_bf16 v[208:211], a[228:231], v[68:71], v[208:211]
    v_exp_f32 v213, v213
    v_mfma_f32_16x16x32_bf16 v[208:211], a[232:235], v[72:75], v[208:211]
    v_exp_f32 v214, v214
    v_mfma_f32_16x16x32_bf16 v[208:211], a[236:239], v[76:79], v[208:211]
    s_add_u32 s57, s58, 4128768
    v_exp_f32 v215, v215
    v_mfma_f32_16x16x32_bf16 a[32:35], a[176:179], v[128:131], a[32:35]
    ds_read_b64_tr_b16 a[188:189], v23 offset:40960
    v_cvt_pk_bf16_f32 v184, v212, v213
    v_mfma_f32_16x16x32_bf16 a[32:35], a[180:183], v[132:135], a[32:35]
    ds_read_b64_tr_b16 a[190:191], v23 offset:45056
    v_cvt_pk_bf16_f32 v246, v224, v225
    v_mfma_f32_16x16x32_bf16 a[36:39], a[176:179], v[136:139], a[36:39]
    ds_read_b128 a[212:215], v9 offset:57344
    v_cvt_pk_bf16_f32 v185, v214, v215
    v_mfma_f32_16x16x32_bf16 a[36:39], a[180:183], v[140:143], a[36:39]
    buffer_load_dwordx4 a[244:247], v254, s[32:35], s57 offen
    v_smfmac_f32_16x16x64_bf16 a[196:199], v[52:55], v[136:143], v50
    v_mfma_f32_16x16x32_bf16 v[212:215], a[224:227], v[80:83], v[196:199]
    v_exp_f32 v208, v208
    v_mfma_f32_16x16x32_bf16 v[212:215], a[228:231], v[84:87], v[212:215]
    v_exp_f32 v209, v209
    v_mfma_f32_16x16x32_bf16 v[212:215], a[232:235], v[88:91], v[212:215]
    v_exp_f32 v210, v210
    v_mfma_f32_16x16x32_bf16 v[212:215], a[236:239], v[92:95], v[212:215]
    v_exp_f32 v211, v211
    v_mfma_f32_16x16x32_bf16 a[40:43], a[176:179], v[144:147], a[40:43]
    ds_read_b64_tr_b16 a[160:161], v24 offset:32768
    v_cvt_pk_bf16_f32 v162, v208, v209
    v_mfma_f32_16x16x32_bf16 a[40:43], a[180:183], v[148:151], a[40:43]
    ds_read_b64_tr_b16 a[162:163], v24 offset:36864
    v_lshlrev_b32 v224, 16, v246
    v_mfma_f32_16x16x32_bf16 a[44:47], a[176:179], v[152:155], a[44:47]
    ds_read_b128 a[216:219], v10 offset:57344
    v_cvt_pk_bf16_f32 v163, v210, v211
    v_mfma_f32_16x16x32_bf16 a[44:47], a[180:183], v[156:159], a[44:47]
    s_waitcnt lgkmcnt(3)
    buffer_load_dwordx4 v47, s[20:23], s49 offen offset:1024 lds
    v_mfma_f32_16x16x32_bf16 v[208:211], a[224:227], v[96:99], v[200:203]
    v_exp_f32 v212, v212
    v_mfma_f32_16x16x32_bf16 v[208:211], a[228:231], v[100:103], v[208:211]
    v_exp_f32 v213, v213
    v_mfma_f32_16x16x32_bf16 v[208:211], a[232:235], v[104:107], v[208:211]
    v_exp_f32 v214, v214
    v_mfma_f32_16x16x32_bf16 v[208:211], a[236:239], v[108:111], v[208:211]
    v_exp_f32 v215, v215
    v_mfma_f32_16x16x32_bf16 a[48:51], a[184:187], v[128:131], a[48:51]
    ds_read_b64_tr_b16 a[164:165], v24 offset:40960
    v_cvt_pk_bf16_f32 v170, v212, v213
    v_mfma_f32_16x16x32_bf16 a[48:51], a[188:191], v[132:135], a[48:51]
    ds_read_b64_tr_b16 a[166:167], v24 offset:45056
    v_and_b32 v225, 0xffff0000, v246
    v_mfma_f32_16x16x32_bf16 a[52:55], a[184:187], v[136:139], a[52:55]
    ds_read_b128 a[220:223], v11 offset:57344
    v_cvt_pk_bf16_f32 v171, v214, v215
    v_mfma_f32_16x16x32_bf16 a[52:55], a[188:191], v[140:143], a[52:55]
    v_add_f32 v224, s36, v224
    v_add_f32 v225, s36, v225
    v_smfmac_f32_16x16x64_bf16 a[200:203], v[52:55], v[144:151], v50
    v_mfma_f32_16x16x32_bf16 v[212:215], a[224:227], v[112:115], v[204:207]
    v_exp_f32 v208, v208
    v_mfma_f32_16x16x32_bf16 v[212:215], a[228:231], v[116:119], v[212:215]
    v_exp_f32 v209, v209
    v_mfma_f32_16x16x32_bf16 v[212:215], a[232:235], v[120:123], v[212:215]
    v_exp_f32 v210, v210
    v_mfma_f32_16x16x32_bf16 v[212:215], a[236:239], v[124:127], v[212:215]
    v_exp_f32 v211, v211
    v_mfma_f32_16x16x32_bf16 a[56:59], a[184:187], v[144:147], a[56:59]
    ds_read_b64_tr_b16 a[168:169], v25 offset:32768
    v_cvt_pk_bf16_f32 v178, v208, v209
    v_mfma_f32_16x16x32_bf16 a[56:59], a[188:191], v[148:151], a[56:59]
    ds_read_b64_tr_b16 a[170:171], v25 offset:36864
    v_cvt_pk_bf16_f32 v246, v224, v225
    v_mfma_f32_16x16x32_bf16 a[60:63], a[184:187], v[152:155], a[60:63]
    ds_read_b128 a[224:227], v8 offset:61440
    v_cvt_pk_bf16_f32 v179, v210, v211
    v_mfma_f32_16x16x32_bf16 a[60:63], a[188:191], v[156:159], a[60:63]
    s_waitcnt lgkmcnt(3)
    buffer_load_dwordx4 v48, s[20:23], s49 offen offset:2048 lds
    v_mfma_f32_16x16x32_bf16 v[208:211], a[208:211], v[64:67], v[192:195]
    v_exp_f32 v212, v212
    v_mfma_f32_16x16x32_bf16 v[208:211], a[212:215], v[68:71], v[208:211]
    v_exp_f32 v213, v213
    v_mfma_f32_16x16x32_bf16 v[208:211], a[216:219], v[72:75], v[208:211]
    v_exp_f32 v214, v214
    v_mfma_f32_16x16x32_bf16 v[208:211], a[220:223], v[76:79], v[208:211]
    s_add_u32 s57, s58, 4718592
    v_exp_f32 v215, v215
    v_mfma_f32_16x16x32_bf16 a[64:67], a[160:163], v[128:131], a[64:67]
    ds_read_b64_tr_b16 a[172:173], v25 offset:40960
    v_cvt_pk_bf16_f32 v186, v212, v213
    v_mfma_f32_16x16x32_bf16 a[64:67], a[164:167], v[132:135], a[64:67]
    ds_read_b64_tr_b16 a[174:175], v25 offset:45056
    v_lshrrev_b32 v244, 1, v0
    v_mfma_f32_16x16x32_bf16 a[68:71], a[160:163], v[136:139], a[68:71]
    ds_read_b128 a[228:231], v9 offset:61440
    v_cvt_pk_bf16_f32 v187, v214, v215
    v_mfma_f32_16x16x32_bf16 a[68:71], a[164:167], v[140:143], a[68:71]
    buffer_load_dwordx4 a[248:251], v254, s[32:35], s57 offen
    v_smfmac_f32_16x16x64_bf16 a[204:207], v[52:55], v[152:159], v50
    v_mfma_f32_16x16x32_bf16 v[212:215], a[208:211], v[80:83], v[196:199]
    v_exp_f32 v208, v208
    v_mfma_f32_16x16x32_bf16 v[212:215], a[212:215], v[84:87], v[212:215]
    v_exp_f32 v209, v209
    v_mfma_f32_16x16x32_bf16 v[212:215], a[216:219], v[88:91], v[212:215]
    v_exp_f32 v210, v210
    v_mfma_f32_16x16x32_bf16 v[212:215], a[220:223], v[92:95], v[212:215]
    v_exp_f32 v211, v211
    v_mfma_f32_16x16x32_bf16 a[72:75], a[160:163], v[144:147], a[72:75]
    ds_read_b64_tr_b16 a[176:177], v26 offset:32768
    v_cvt_pk_bf16_f32 v164, v208, v209
    v_mfma_f32_16x16x32_bf16 a[72:75], a[164:167], v[148:151], a[72:75]
    ds_read_b64_tr_b16 a[178:179], v26 offset:36864
    v_lshlrev_b32 v244, 4, v244
    v_mfma_f32_16x16x32_bf16 a[76:79], a[160:163], v[152:155], a[76:79]
    ds_read_b128 a[232:235], v10 offset:61440
    v_cvt_pk_bf16_f32 v165, v210, v211
    v_mfma_f32_16x16x32_bf16 a[76:79], a[164:167], v[156:159], a[76:79]
    s_waitcnt lgkmcnt(3)
    buffer_load_dwordx4 v49, s[20:23], s49 offen offset:3072 lds
    v_mfma_f32_16x16x32_bf16 v[208:211], a[208:211], v[96:99], v[200:203]
    v_exp_f32 v212, v212
    v_mfma_f32_16x16x32_bf16 v[208:211], a[212:215], v[100:103], v[208:211]
    v_exp_f32 v213, v213
    v_mfma_f32_16x16x32_bf16 v[208:211], a[216:219], v[104:107], v[208:211]
    v_exp_f32 v214, v214
    v_mfma_f32_16x16x32_bf16 v[208:211], a[220:223], v[108:111], v[208:211]
    v_exp_f32 v215, v215
    v_mfma_f32_16x16x32_bf16 a[80:83], a[168:171], v[128:131], a[80:83]
    ds_read_b64_tr_b16 a[180:181], v26 offset:40960
    v_cvt_pk_bf16_f32 v172, v212, v213
    v_mfma_f32_16x16x32_bf16 a[80:83], a[172:175], v[132:135], a[80:83]
    ds_read_b64_tr_b16 a[182:183], v26 offset:45056
    v_and_b32 v245, 1, v0
    v_mfma_f32_16x16x32_bf16 a[84:87], a[168:171], v[136:139], a[84:87]
    ds_read_b128 a[236:239], v11 offset:61440
    v_cvt_pk_bf16_f32 v173, v214, v215
    v_mfma_f32_16x16x32_bf16 a[84:87], a[172:175], v[140:143], a[84:87]
    s_waitcnt vmcnt(12)
    s_barrier
    v_mfma_f32_16x16x32_bf16 v[212:215], a[208:211], v[112:115], v[204:207]
    v_exp_f32 v208, v208
    v_mfma_f32_16x16x32_bf16 v[212:215], a[212:215], v[116:119], v[212:215]
    s_add_u32 s49, s7, 73728
    v_exp_f32 v209, v209
    v_mfma_f32_16x16x32_bf16 v[212:215], a[216:219], v[120:123], v[212:215]
    s_add_u32 m0, s42, 81920
    v_exp_f32 v210, v210
    v_mfma_f32_16x16x32_bf16 v[212:215], a[220:223], v[124:127], v[212:215]
Ltour7:
    s_cbranch_execz Ltour11
    v_exp_f32 v211, v211
    v_mfma_f32_16x16x32_bf16 a[88:91], a[168:171], v[144:147], a[88:91]
    ds_read_b64_tr_b16 a[184:185], v27 offset:32768
    v_cvt_pk_bf16_f32 v180, v208, v209
    v_mfma_f32_16x16x32_bf16 a[88:91], a[172:175], v[148:151], a[88:91]
    ds_read_b64_tr_b16 a[186:187], v27 offset:36864
    v_lshl_add_u32 v244, v245, 2, v244
    v_mfma_f32_16x16x32_bf16 a[92:95], a[168:171], v[152:155], a[92:95]
    v_cvt_pk_bf16_f32 v181, v210, v211
    v_mfma_f32_16x16x32_bf16 a[92:95], a[172:175], v[156:159], a[92:95]
    s_waitcnt lgkmcnt(3)
    buffer_load_dwordx4 v46, s[20:23], s49 offen lds
    v_mfma_f32_16x16x32_bf16 v[208:211], a[224:227], v[64:67], v[192:195]
    v_exp_f32 v212, v212
    v_mfma_f32_16x16x32_bf16 v[208:211], a[228:231], v[68:71], v[208:211]
    v_exp_f32 v213, v213
    v_mfma_f32_16x16x32_bf16 v[208:211], a[232:235], v[72:75], v[208:211]
    s_waitcnt lgkmcnt(2)
    v_exp_f32 v214, v214
    v_mfma_f32_16x16x32_bf16 v[208:211], a[236:239], v[76:79], v[208:211]
    s_add_u32 s37, s55, 8192
    v_exp_f32 v215, v215
    v_mfma_f32_16x16x32_bf16 a[96:99], a[176:179], v[128:131], a[96:99]
    ds_read_b64_tr_b16 a[188:189], v27 offset:40960
    v_cvt_pk_bf16_f32 v188, v212, v213
    v_mfma_f32_16x16x32_bf16 a[96:99], a[180:183], v[132:135], a[96:99]
    ds_read_b64_tr_b16 a[190:191], v27 offset:45056
    v_lshrrev_b32 v245, 3, v0
    v_mfma_f32_16x16x32_bf16 a[100:103], a[176:179], v[136:139], a[100:103]
    v_cvt_pk_bf16_f32 v189, v214, v215
    v_mfma_f32_16x16x32_bf16 a[100:103], a[180:183], v[140:143], a[100:103]
    buffer_load_dword v239, v238, s[28:31], s37 offen
    v_mfma_f32_16x16x32_bf16 v[212:215], a[224:227], v[80:83], v[196:199]
    v_exp_f32 v208, v208
    v_mfma_f32_16x16x32_bf16 v[212:215], a[228:231], v[84:87], v[212:215]
    v_exp_f32 v209, v209
    v_mfma_f32_16x16x32_bf16 v[212:215], a[232:235], v[88:91], v[212:215]
    v_exp_f32 v210, v210
    v_mfma_f32_16x16x32_bf16 v[212:215], a[236:239], v[92:95], v[212:215]
    v_exp_f32 v211, v211
    v_mfma_f32_16x16x32_bf16 a[104:107], a[176:179], v[144:147], a[104:107]
    ds_read_b64_tr_b16 a[160:161], v20 offset:49152
    v_cvt_pk_bf16_f32 v166, v208, v209
    v_mfma_f32_16x16x32_bf16 a[104:107], a[180:183], v[148:151], a[104:107]
    ds_read_b64_tr_b16 a[162:163], v20 offset:53248
    v_min_u32 v245, 1, v245
    v_mfma_f32_16x16x32_bf16 a[108:111], a[176:179], v[152:155], a[108:111]
    v_cvt_pk_bf16_f32 v167, v210, v211
    v_mfma_f32_16x16x32_bf16 a[108:111], a[180:183], v[156:159], a[108:111]
    s_waitcnt lgkmcnt(3)
    buffer_load_dwordx4 v47, s[20:23], s49 offen offset:1024 lds
    v_mfma_f32_16x16x32_bf16 v[208:211], a[224:227], v[96:99], v[200:203]
    v_exp_f32 v212, v212
    v_mfma_f32_16x16x32_bf16 v[208:211], a[228:231], v[100:103], v[208:211]
    v_exp_f32 v213, v213
    v_mfma_f32_16x16x32_bf16 v[208:211], a[232:235], v[104:107], v[208:211]
    v_exp_f32 v214, v214
    v_mfma_f32_16x16x32_bf16 v[208:211], a[236:239], v[108:111], v[208:211]
    s_add_u32 s57, s59, 0
    v_exp_f32 v215, v215
    v_mfma_f32_16x16x32_bf16 a[112:115], a[184:187], v[128:131], a[112:115]
    s_waitcnt lgkmcnt(2)
    ds_read_b64_tr_b16 a[164:165], v20 offset:57344
    v_cvt_pk_bf16_f32 v174, v212, v213
    v_mfma_f32_16x16x32_bf16 a[112:115], a[188:191], v[132:135], a[112:115]
    ds_read_b64_tr_b16 a[166:167], v20 offset:61440
    v_lshl_or_b32 v244, v245, 31, v244
    v_mfma_f32_16x16x32_bf16 a[116:119], a[184:187], v[136:139], a[116:119]
    v_cvt_pk_bf16_f32 v175, v214, v215
    v_mfma_f32_16x16x32_bf16 a[116:119], a[188:191], v[140:143], a[116:119]
    buffer_load_dwordx4 a[252:255], v255, s[84:87], s57 offen
    v_mfma_f32_16x16x32_bf16 v[212:215], a[224:227], v[112:115], v[204:207]
    v_exp_f32 v208, v208
    v_mfma_f32_16x16x32_bf16 v[212:215], a[228:231], v[116:119], v[212:215]
    v_exp_f32 v209, v209
    v_mfma_f32_16x16x32_bf16 v[212:215], a[232:235], v[120:123], v[212:215]
    v_exp_f32 v210, v210
    v_mfma_f32_16x16x32_bf16 v[212:215], a[236:239], v[124:127], v[212:215]
    v_exp_f32 v211, v211
    v_mfma_f32_16x16x32_bf16 a[120:123], a[184:187], v[144:147], a[120:123]
    ds_read_b64_tr_b16 a[168:169], v21 offset:49152
    v_cvt_pk_bf16_f32 v182, v208, v209
    v_mfma_f32_16x16x32_bf16 a[120:123], a[188:191], v[148:151], a[120:123]
    ds_read_b64_tr_b16 a[170:171], v21 offset:53248
    v_mfma_f32_16x16x32_bf16 a[124:127], a[184:187], v[152:155], a[124:127]
    v_cvt_pk_bf16_f32 v183, v210, v211
    v_mfma_f32_16x16x32_bf16 a[124:127], a[188:191], v[156:159], a[124:127]
    s_waitcnt lgkmcnt(3)
    buffer_load_dwordx4 v48, s[20:23], s49 offen offset:2048 lds
    v_exp_f32 v212, v212
    v_exp_f32 v213, v213
    v_exp_f32 v214, v214
    v_exp_f32 v215, v215
    v_mfma_f32_16x16x32_bf16 a[0:3], a[160:163], v[160:163], a[0:3]
    s_waitcnt lgkmcnt(2)
    ds_read_b64_tr_b16 a[172:173], v21 offset:57344
    v_cvt_pk_bf16_f32 v190, v212, v213
    v_mfma_f32_16x16x32_bf16 a[0:3], a[164:167], v[164:167], a[0:3]
    ds_read_b64_tr_b16 a[174:175], v21 offset:61440
    v_mfma_f32_16x16x32_bf16 a[4:7], a[160:163], v[168:171], a[4:7]
    v_cvt_pk_bf16_f32 v191, v214, v215
    v_mfma_f32_16x16x32_bf16 a[4:7], a[164:167], v[172:175], a[4:7]
    buffer_store_dword v246, v244, s[24:27], s39 offen sc1
    v_mfma_f32_16x16x32_bf16 a[8:11], a[160:163], v[176:179], a[8:11]
    ds_read_b64_tr_b16 a[176:177], v22 offset:49152
    v_mfma_f32_16x16x32_bf16 a[8:11], a[164:167], v[180:183], a[8:11]
    ds_read_b64_tr_b16 a[178:179], v22 offset:53248
    v_mfma_f32_16x16x32_bf16 a[12:15], a[160:163], v[184:187], a[12:15]
    v_mfma_f32_16x16x32_bf16 a[12:15], a[164:167], v[188:191], a[12:15]
    buffer_load_dwordx4 v49, s[20:23], s49 offen offset:3072 lds
    v_smfmac_f32_16x16x64_bf16 a[192:195], v[52:55], v[160:167], v50
    s_waitcnt lgkmcnt(4)
    v_mfma_f32_16x16x32_bf16 a[16:19], a[168:171], v[160:163], a[16:19]
    s_waitcnt lgkmcnt(2)
    ds_read_b64_tr_b16 a[180:181], v22 offset:57344
    v_mfma_f32_16x16x32_bf16 a[16:19], a[172:175], v[164:167], a[16:19]
    ds_read_b64_tr_b16 a[182:183], v22 offset:61440
    v_mfma_f32_16x16x32_bf16 a[20:23], a[168:171], v[168:171], a[20:23]
    v_min_u32 v240, 1, v0
    v_mfma_f32_16x16x32_bf16 a[20:23], a[172:175], v[172:175], a[20:23]
    v_smfmac_f32_16x16x64_bf16 a[196:199], v[52:55], v[168:175], v50
    s_add_u32 s49, s7, 256
    s_add_u32 m0, s42, 32768
    v_mfma_f32_16x16x32_bf16 a[24:27], a[168:171], v[176:179], a[24:27]
    ds_read_b64_tr_b16 a[184:185], v23 offset:49152
    v_mfma_f32_16x16x32_bf16 a[24:27], a[172:175], v[180:183], a[24:27]
    ds_read_b64_tr_b16 a[186:187], v23 offset:53248
    v_mfma_f32_16x16x32_bf16 a[28:31], a[168:171], v[184:187], a[28:31]
    v_lshlrev_b32 v240, 31, v240
    v_mfma_f32_16x16x32_bf16 a[28:31], a[172:175], v[188:191], a[28:31]
    buffer_load_dwordx4 v46, s[20:23], s49 offen lds
    v_smfmac_f32_16x16x64_bf16 a[200:203], v[52:55], v[176:183], v50
    s_waitcnt lgkmcnt(4)
    v_mfma_f32_16x16x32_bf16 a[32:35], a[176:179], v[160:163], a[32:35]
    s_waitcnt lgkmcnt(2)
    ds_read_b64_tr_b16 a[188:189], v23 offset:57344
    v_mfma_f32_16x16x32_bf16 a[32:35], a[180:183], v[164:167], a[32:35]
    ds_read_b64_tr_b16 a[190:191], v23 offset:61440
    v_mfma_f32_16x16x32_bf16 a[36:39], a[176:179], v[168:171], a[36:39]
    v_mov_b32 v241, 1
    v_mfma_f32_16x16x32_bf16 a[36:39], a[180:183], v[172:175], a[36:39]
    v_smfmac_f32_16x16x64_bf16 a[204:207], v[52:55], v[184:191], v50
    v_mfma_f32_16x16x32_bf16 a[40:43], a[176:179], v[176:179], a[40:43]
    ds_read_b64_tr_b16 a[160:161], v24 offset:49152
    v_mfma_f32_16x16x32_bf16 a[40:43], a[180:183], v[180:183], a[40:43]
    ds_read_b64_tr_b16 a[162:163], v24 offset:53248
    v_mfma_f32_16x16x32_bf16 a[44:47], a[176:179], v[184:187], a[44:47]
    v_mfma_f32_16x16x32_bf16 a[44:47], a[180:183], v[188:191], a[44:47]
    s_waitcnt lgkmcnt(4)
    buffer_load_dwordx4 v47, s[20:23], s49 offen offset:1024 lds
    v_mfma_f32_16x16x32_bf16 a[48:51], a[184:187], v[160:163], a[48:51]
    s_waitcnt lgkmcnt(2)
    ds_read_b64_tr_b16 a[164:165], v24 offset:57344
    v_accvgpr_read_b32 v216, a192
    v_mfma_f32_16x16x32_bf16 a[48:51], a[188:191], v[164:167], a[48:51]
    ds_read_b64_tr_b16 a[166:167], v24 offset:61440
    v_accvgpr_read_b32 v217, a193
    v_mfma_f32_16x16x32_bf16 a[52:55], a[184:187], v[168:171], a[52:55]
    v_accvgpr_read_b32 v218, a196
    v_accvgpr_read_b32 v219, a197
    v_mfma_f32_16x16x32_bf16 a[52:55], a[188:191], v[172:175], a[52:55]
    v_accvgpr_read_b32 v220, a200
    v_accvgpr_read_b32 v221, a201
    v_mfma_f32_16x16x32_bf16 a[56:59], a[184:187], v[176:179], a[56:59]
    ds_read_b64_tr_b16 a[168:169], v25 offset:49152
    v_accvgpr_read_b32 v222, a204
    v_mfma_f32_16x16x32_bf16 a[56:59], a[188:191], v[180:183], a[56:59]
    ds_read_b64_tr_b16 a[170:171], v25 offset:53248
    v_accvgpr_read_b32 v223, a205
    v_mfma_f32_16x16x32_bf16 a[60:63], a[184:187], v[184:187], a[60:63]
    v_add_f32 v58, v216, v217
    v_add_f32 v59, v218, v219
    v_mfma_f32_16x16x32_bf16 a[60:63], a[188:191], v[188:191], a[60:63]
    s_waitcnt lgkmcnt(4)
    buffer_load_dwordx4 v48, s[20:23], s49 offen offset:2048 lds
    v_add_f32 v60, v220, v221
    v_add_f32 v61, v222, v223
    v_mfma_f32_16x16x32_bf16 a[64:67], a[160:163], v[160:163], a[64:67]
    s_waitcnt lgkmcnt(2)
    ds_read_b64_tr_b16 a[172:173], v25 offset:57344
    v_add_f32 v216, v58, v59
    v_mfma_f32_16x16x32_bf16 a[64:67], a[164:167], v[164:167], a[64:67]
    ds_read_b64_tr_b16 a[174:175], v25 offset:61440
    v_add_f32 v217, v60, v61
    v_mfma_f32_16x16x32_bf16 a[68:71], a[160:163], v[168:171], a[68:71]
    v_add_f32 v216, v216, v217
    v_cmp_ngt_f32 vcc, 1669332992, v216
    v_mfma_f32_16x16x32_bf16 a[68:71], a[164:167], v[172:175], a[68:71]
    v_rcp_f32 v58, v58
    v_rcp_f32 v59, v59
    v_mfma_f32_16x16x32_bf16 a[72:75], a[160:163], v[176:179], a[72:75]
    ds_read_b64_tr_b16 a[176:177], v26 offset:49152
    v_rcp_f32 v60, v60
    v_mfma_f32_16x16x32_bf16 a[72:75], a[164:167], v[180:183], a[72:75]
    ds_read_b64_tr_b16 a[178:179], v26 offset:53248
    v_rcp_f32 v61, v61
    v_mfma_f32_16x16x32_bf16 a[76:79], a[160:163], v[184:187], a[76:79]
    v_mov_b32 v228, 131072
    s_or_b32 s36, vcc_lo, vcc_hi
    v_mfma_f32_16x16x32_bf16 a[76:79], a[164:167], v[188:191], a[76:79]
    s_waitcnt lgkmcnt(4)
    buffer_load_dwordx4 v49, s[20:23], s49 offen offset:3072 lds
    v_mov_b32 v218, s36
    s_lshl_b32 s37, s3, 2
    v_mfma_f32_16x16x32_bf16 a[80:83], a[168:171], v[160:163], a[80:83]
    s_waitcnt lgkmcnt(2)
    ds_read_b64_tr_b16 a[180:181], v26 offset:57344
    v_add_u32 v219, s37, v228
    ds_write_b32 v219, v218
    v_mfma_f32_16x16x32_bf16 a[80:83], a[172:175], v[164:167], a[80:83]
    ds_read_b64_tr_b16 a[182:183], v26 offset:61440
    v_mfma_f32_16x16x32_bf16 a[84:87], a[168:171], v[168:171], a[84:87]
    v_mfma_f32_16x16x32_bf16 a[84:87], a[172:175], v[172:175], a[84:87]
    s_waitcnt lgkmcnt(1)
    s_waitcnt vmcnt(17)
    s_barrier
    v_mfma_f32_16x16x32_bf16 a[88:91], a[168:171], v[176:179], a[88:91]
    ds_read_b64_tr_b16 a[184:185], v27 offset:49152
    v_mfma_f32_16x16x32_bf16 a[88:91], a[172:175], v[180:183], a[88:91]
    ds_read_b64_tr_b16 a[186:187], v27 offset:53248
    v_mfma_f32_16x16x32_bf16 a[92:95], a[168:171], v[184:187], a[92:95]
    ds_read_b128 v[224:227], v228
    v_mfma_f32_16x16x32_bf16 a[92:95], a[172:175], v[188:191], a[92:95]
    s_add_u32 s49, s7, 73984
    v_mfma_f32_16x16x32_bf16 a[96:99], a[176:179], v[160:163], a[96:99]
    s_waitcnt lgkmcnt(3)
    s_add_u32 m0, s42, 49152
    ds_read_b64_tr_b16 a[188:189], v27 offset:57344
    v_mfma_f32_16x16x32_bf16 a[96:99], a[180:183], v[164:167], a[96:99]
    buffer_load_dwordx4 v46, s[20:23], s49 offen lds
    v_mfma_f32_16x16x32_bf16 a[100:103], a[176:179], v[168:171], a[100:103]
    ds_read_b64_tr_b16 a[190:191], v27 offset:61440
    v_mfma_f32_16x16x32_bf16 a[100:103], a[180:183], v[172:175], a[100:103]
    buffer_load_dwordx4 v47, s[20:23], s49 offen offset:1024 lds
    v_mfma_f32_16x16x32_bf16 a[104:107], a[176:179], v[176:179], a[104:107]
    v_mfma_f32_16x16x32_bf16 a[104:107], a[180:183], v[180:183], a[104:107]
    buffer_load_dwordx4 v48, s[20:23], s49 offen offset:2048 lds
    v_mfma_f32_16x16x32_bf16 a[108:111], a[176:179], v[184:187], a[108:111]
    v_mfma_f32_16x16x32_bf16 a[108:111], a[180:183], v[188:191], a[108:111]
    s_waitcnt lgkmcnt(3)
    buffer_load_dwordx4 v49, s[20:23], s49 offen offset:3072 lds
    s_add_u32 s49, s46, 0
    v_mfma_f32_16x16x32_bf16 a[112:115], a[184:187], v[160:163], a[112:115]
    s_waitcnt lgkmcnt(0)
    s_add_u32 m0, s42, 98304
    v_mfma_f32_16x16x32_bf16 a[112:115], a[188:191], v[164:167], a[112:115]
    buffer_load_dwordx4 v46, s[20:23], s49 offen lds
    v_mfma_f32_16x16x32_bf16 a[116:119], a[184:187], v[168:171], a[116:119]
    v_mfma_f32_16x16x32_bf16 a[116:119], a[188:191], v[172:175], a[116:119]
    buffer_load_dwordx4 v47, s[20:23], s49 offen offset:1024 lds
    v_mfma_f32_16x16x32_bf16 a[120:123], a[184:187], v[176:179], a[120:123]
    v_mfma_f32_16x16x32_bf16 a[120:123], a[188:191], v[180:183], a[120:123]
    buffer_load_dwordx4 v48, s[20:23], s49 offen offset:2048 lds
    v_mfma_f32_16x16x32_bf16 a[124:127], a[184:187], v[184:187], a[124:127]
    v_mfma_f32_16x16x32_bf16 a[124:127], a[188:191], v[188:191], a[124:127]
    buffer_load_dwordx4 v49, s[20:23], s49 offen offset:3072 lds
    v_or3_b32 v224, v224, v225, v226
    v_or_b32 v224, v224, v227
    s_nop 0
    v_readfirstlane_b32 s36, v224
    v_readfirstlane_b32 s38, v253
    v_min_u32 v8, 1, v1
    v_lshlrev_b32 v8, 31, v8
    v_mov_b32 v10, s95
    s_getreg_b32 s39, hwreg(HW_REG_XCC_ID, 0, 4)
    s_add_u32 s39, s39, s95
    s_cmp_eq_u32 s38, s39
    s_cselect_b32 s53, 1, 0
    ds_read_b64_tr_b16 a[208:209], v12 offset:0
    ds_read_b64_tr_b16 a[210:211], v12 offset:4096
    ds_read_b64_tr_b16 a[212:213], v12 offset:8192
    ds_read_b64_tr_b16 a[214:215], v12 offset:12288
    ds_read_b64_tr_b16 a[216:217], v12 offset:16384
    ds_read_b64_tr_b16 a[218:219], v12 offset:20480
    ds_read_b64_tr_b16 a[220:221], v12 offset:24576
    ds_read_b64_tr_b16 a[222:223], v12 offset:28672
    ds_read_b64_tr_b16 a[224:225], v16 offset:0
    ds_read_b64_tr_b16 a[226:227], v16 offset:4096
    ds_read_b64_tr_b16 a[228:229], v16 offset:8192
    ds_read_b64_tr_b16 a[230:231], v16 offset:12288
    ds_read_b64_tr_b16 a[232:233], v16 offset:16384
    ds_read_b64_tr_b16 a[234:235], v16 offset:20480
    ds_read_b64_tr_b16 a[236:237], v16 offset:24576
    ds_read_b64_tr_b16 a[238:239], v16 offset:28672
    s_andn2_b32 s36, s36, s48
    s_cbranch_scc1 Lattn_redo
    v_accvgpr_read_b32 v216, a0
    v_accvgpr_read_b32 v217, a1
    v_accvgpr_read_b32 v218, a2
    v_accvgpr_read_b32 v219, a3
    v_pk_mul_f32 v[216:217], v[216:217], v[58:59] op_sel:[0,0] op_sel_hi:[1,0]
    v_pk_mul_f32 v[218:219], v[218:219], v[58:59] op_sel:[0,0] op_sel_hi:[1,0]
    v_cvt_pk_bf16_f32 v128, v216, v217
    v_cvt_pk_bf16_f32 v129, v218, v219
    v_accvgpr_read_b32 v220, a4
    v_accvgpr_read_b32 v221, a5
    v_accvgpr_read_b32 v222, a6
    v_accvgpr_read_b32 v223, a7
    v_pk_mul_f32 v[220:221], v[220:221], v[58:59] op_sel:[0,1] op_sel_hi:[1,1]
    v_pk_mul_f32 v[222:223], v[222:223], v[58:59] op_sel:[0,1] op_sel_hi:[1,1]
    v_cvt_pk_bf16_f32 v160, v220, v221
    v_cvt_pk_bf16_f32 v161, v222, v223
    v_accvgpr_read_b32 v224, a8
    v_accvgpr_read_b32 v225, a9
    v_accvgpr_read_b32 v226, a10
    v_accvgpr_read_b32 v227, a11
    v_pk_mul_f32 v[224:225], v[224:225], v[60:61] op_sel:[0,0] op_sel_hi:[1,0]
    v_pk_mul_f32 v[226:227], v[226:227], v[60:61] op_sel:[0,0] op_sel_hi:[1,0]
    v_cvt_pk_bf16_f32 v144, v224, v225
    v_cvt_pk_bf16_f32 v145, v226, v227
    v_accvgpr_read_b32 v228, a12
    v_accvgpr_read_b32 v229, a13
    v_accvgpr_read_b32 v230, a14
    v_accvgpr_read_b32 v231, a15
    v_pk_mul_f32 v[228:229], v[228:229], v[60:61] op_sel:[0,1] op_sel_hi:[1,1]
    v_pk_mul_f32 v[230:231], v[230:231], v[60:61] op_sel:[0,1] op_sel_hi:[1,1]
    v_cvt_pk_bf16_f32 v176, v228, v229
    v_cvt_pk_bf16_f32 v177, v230, v231
    v_accvgpr_read_b32 v216, a16
    v_accvgpr_read_b32 v217, a17
    v_accvgpr_read_b32 v218, a18
    v_accvgpr_read_b32 v219, a19
    v_pk_mul_f32 v[216:217], v[216:217], v[58:59] op_sel:[0,0] op_sel_hi:[1,0]
    v_pk_mul_f32 v[218:219], v[218:219], v[58:59] op_sel:[0,0] op_sel_hi:[1,0]
    v_cvt_pk_bf16_f32 v130, v216, v217
    v_cvt_pk_bf16_f32 v131, v218, v219
    s_add_u32 s37, s55, 0
    buffer_store_dwordx4 v[128:131], v252, s[28:31], s37 offen offset:0
    v_accvgpr_read_b32 v220, a20
    v_accvgpr_read_b32 v221, a21
    v_accvgpr_read_b32 v222, a22
    v_accvgpr_read_b32 v223, a23
    v_pk_mul_f32 v[220:221], v[220:221], v[58:59] op_sel:[0,1] op_sel_hi:[1,1]
    v_pk_mul_f32 v[222:223], v[222:223], v[58:59] op_sel:[0,1] op_sel_hi:[1,1]
    v_cvt_pk_bf16_f32 v162, v220, v221
    v_cvt_pk_bf16_f32 v163, v222, v223
    s_add_u32 s37, s55, 8192
    buffer_store_dwordx4 v[160:163], v252, s[28:31], s37 offen offset:0
    v_accvgpr_read_b32 v224, a24
    v_accvgpr_read_b32 v225, a25
    v_accvgpr_read_b32 v226, a26
    v_accvgpr_read_b32 v227, a27
    v_pk_mul_f32 v[224:225], v[224:225], v[60:61] op_sel:[0,0] op_sel_hi:[1,0]
    v_pk_mul_f32 v[226:227], v[226:227], v[60:61] op_sel:[0,0] op_sel_hi:[1,0]
    v_cvt_pk_bf16_f32 v146, v224, v225
    v_cvt_pk_bf16_f32 v147, v226, v227
    s_add_u32 s37, s55, 4096
    buffer_store_dwordx4 v[144:147], v252, s[28:31], s37 offen offset:0
    v_accvgpr_read_b32 v228, a28
    v_accvgpr_read_b32 v229, a29
    v_accvgpr_read_b32 v230, a30
    v_accvgpr_read_b32 v231, a31
    v_pk_mul_f32 v[228:229], v[228:229], v[60:61] op_sel:[0,1] op_sel_hi:[1,1]
    v_pk_mul_f32 v[230:231], v[230:231], v[60:61] op_sel:[0,1] op_sel_hi:[1,1]
    v_cvt_pk_bf16_f32 v178, v228, v229
    v_cvt_pk_bf16_f32 v179, v230, v231
    s_add_u32 s37, s55, 12288
    buffer_store_dwordx4 v[176:179], v252, s[28:31], s37 offen offset:0
    v_accvgpr_read_b32 v216, a32
    v_accvgpr_read_b32 v217, a33
    v_accvgpr_read_b32 v218, a34
    v_accvgpr_read_b32 v219, a35
    v_pk_mul_f32 v[216:217], v[216:217], v[58:59] op_sel:[0,0] op_sel_hi:[1,0]
    v_pk_mul_f32 v[218:219], v[218:219], v[58:59] op_sel:[0,0] op_sel_hi:[1,0]
    v_cvt_pk_bf16_f32 v132, v216, v217
    v_cvt_pk_bf16_f32 v133, v218, v219
    v_accvgpr_read_b32 v220, a36
    v_accvgpr_read_b32 v221, a37
    v_accvgpr_read_b32 v222, a38
    v_accvgpr_read_b32 v223, a39
    v_pk_mul_f32 v[220:221], v[220:221], v[58:59] op_sel:[0,1] op_sel_hi:[1,1]
    v_pk_mul_f32 v[222:223], v[222:223], v[58:59] op_sel:[0,1] op_sel_hi:[1,1]
    v_cvt_pk_bf16_f32 v164, v220, v221
    v_cvt_pk_bf16_f32 v165, v222, v223
    v_accvgpr_read_b32 v224, a40
    v_accvgpr_read_b32 v225, a41
    v_accvgpr_read_b32 v226, a42
    v_accvgpr_read_b32 v227, a43
    v_pk_mul_f32 v[224:225], v[224:225], v[60:61] op_sel:[0,0] op_sel_hi:[1,0]
    v_pk_mul_f32 v[226:227], v[226:227], v[60:61] op_sel:[0,0] op_sel_hi:[1,0]
    v_cvt_pk_bf16_f32 v148, v224, v225
    v_cvt_pk_bf16_f32 v149, v226, v227
    v_accvgpr_read_b32 v228, a44
    v_accvgpr_read_b32 v229, a45
    v_accvgpr_read_b32 v230, a46
    v_accvgpr_read_b32 v231, a47
    v_pk_mul_f32 v[228:229], v[228:229], v[60:61] op_sel:[0,1] op_sel_hi:[1,1]
    v_pk_mul_f32 v[230:231], v[230:231], v[60:61] op_sel:[0,1] op_sel_hi:[1,1]
    v_cvt_pk_bf16_f32 v180, v228, v229
    v_cvt_pk_bf16_f32 v181, v230, v231
    v_accvgpr_read_b32 v216, a48
    v_accvgpr_read_b32 v217, a49
    v_accvgpr_read_b32 v218, a50
    v_accvgpr_read_b32 v219, a51
    v_pk_mul_f32 v[216:217], v[216:217], v[58:59] op_sel:[0,0] op_sel_hi:[1,0]
    v_pk_mul_f32 v[218:219], v[218:219], v[58:59] op_sel:[0,0] op_sel_hi:[1,0]
    v_cvt_pk_bf16_f32 v134, v216, v217
    v_cvt_pk_bf16_f32 v135, v218, v219
    s_add_u32 s37, s55, 0
    buffer_store_dwordx4 v[132:135], v252, s[28:31], s37 offen offset:1024
    v_accvgpr_read_b32 v220, a52
    v_accvgpr_read_b32 v221, a53
    v_accvgpr_read_b32 v222, a54
    v_accvgpr_read_b32 v223, a55
    v_pk_mul_f32 v[220:221], v[220:221], v[58:59] op_sel:[0,1] op_sel_hi:[1,1]
    v_pk_mul_f32 v[222:223], v[222:223], v[58:59] op_sel:[0,1] op_sel_hi:[1,1]
    v_cvt_pk_bf16_f32 v166, v220, v221
    v_cvt_pk_bf16_f32 v167, v222, v223
    s_add_u32 s37, s55, 8192
    buffer_store_dwordx4 v[164:167], v252, s[28:31], s37 offen offset:1024
    v_accvgpr_read_b32 v224, a56
    v_accvgpr_read_b32 v225, a57
    v_accvgpr_read_b32 v226, a58
    v_accvgpr_read_b32 v227, a59
    v_pk_mul_f32 v[224:225], v[224:225], v[60:61] op_sel:[0,0] op_sel_hi:[1,0]
    v_pk_mul_f32 v[226:227], v[226:227], v[60:61] op_sel:[0,0] op_sel_hi:[1,0]
    v_cvt_pk_bf16_f32 v150, v224, v225
    v_cvt_pk_bf16_f32 v151, v226, v227
    s_add_u32 s37, s55, 4096
    buffer_store_dwordx4 v[148:151], v252, s[28:31], s37 offen offset:1024
    v_accvgpr_read_b32 v228, a60
    v_accvgpr_read_b32 v229, a61
    v_accvgpr_read_b32 v230, a62
    v_accvgpr_read_b32 v231, a63
    v_pk_mul_f32 v[228:229], v[228:229], v[60:61] op_sel:[0,1] op_sel_hi:[1,1]
    v_pk_mul_f32 v[230:231], v[230:231], v[60:61] op_sel:[0,1] op_sel_hi:[1,1]
    v_cvt_pk_bf16_f32 v182, v228, v229
    v_cvt_pk_bf16_f32 v183, v230, v231
    s_add_u32 s37, s55, 12288
    buffer_store_dwordx4 v[180:183], v252, s[28:31], s37 offen offset:1024
    v_accvgpr_read_b32 v216, a64
    v_accvgpr_read_b32 v217, a65
    v_accvgpr_read_b32 v218, a66
    v_accvgpr_read_b32 v219, a67
    v_pk_mul_f32 v[216:217], v[216:217], v[58:59] op_sel:[0,0] op_sel_hi:[1,0]
    v_pk_mul_f32 v[218:219], v[218:219], v[58:59] op_sel:[0,0] op_sel_hi:[1,0]
    v_cvt_pk_bf16_f32 v136, v216, v217
    v_cvt_pk_bf16_f32 v137, v218, v219
    v_accvgpr_read_b32 v220, a68
    v_accvgpr_read_b32 v221, a69
    v_accvgpr_read_b32 v222, a70
    v_accvgpr_read_b32 v223, a71
    v_pk_mul_f32 v[220:221], v[220:221], v[58:59] op_sel:[0,1] op_sel_hi:[1,1]
    v_pk_mul_f32 v[222:223], v[222:223], v[58:59] op_sel:[0,1] op_sel_hi:[1,1]
    v_cvt_pk_bf16_f32 v168, v220, v221
    v_cvt_pk_bf16_f32 v169, v222, v223
    v_accvgpr_read_b32 v224, a72
    v_accvgpr_read_b32 v225, a73
    v_accvgpr_read_b32 v226, a74
    v_accvgpr_read_b32 v227, a75
    v_pk_mul_f32 v[224:225], v[224:225], v[60:61] op_sel:[0,0] op_sel_hi:[1,0]
    v_pk_mul_f32 v[226:227], v[226:227], v[60:61] op_sel:[0,0] op_sel_hi:[1,0]
    v_cvt_pk_bf16_f32 v152, v224, v225
    v_cvt_pk_bf16_f32 v153, v226, v227
    v_accvgpr_read_b32 v228, a76
    v_accvgpr_read_b32 v229, a77
    v_accvgpr_read_b32 v230, a78
    v_accvgpr_read_b32 v231, a79
    v_pk_mul_f32 v[228:229], v[228:229], v[60:61] op_sel:[0,1] op_sel_hi:[1,1]
    v_pk_mul_f32 v[230:231], v[230:231], v[60:61] op_sel:[0,1] op_sel_hi:[1,1]
    v_cvt_pk_bf16_f32 v184, v228, v229
    v_cvt_pk_bf16_f32 v185, v230, v231
    v_accvgpr_read_b32 v216, a80
    v_accvgpr_read_b32 v217, a81
    v_accvgpr_read_b32 v218, a82
    v_accvgpr_read_b32 v219, a83
    v_pk_mul_f32 v[216:217], v[216:217], v[58:59] op_sel:[0,0] op_sel_hi:[1,0]
    v_pk_mul_f32 v[218:219], v[218:219], v[58:59] op_sel:[0,0] op_sel_hi:[1,0]
    v_cvt_pk_bf16_f32 v138, v216, v217
    v_cvt_pk_bf16_f32 v139, v218, v219
    s_add_u32 s37, s55, 0
    buffer_store_dwordx4 v[136:139], v252, s[28:31], s37 offen offset:2048
    v_accvgpr_read_b32 v220, a84
    v_accvgpr_read_b32 v221, a85
    v_accvgpr_read_b32 v222, a86
    v_accvgpr_read_b32 v223, a87
    v_pk_mul_f32 v[220:221], v[220:221], v[58:59] op_sel:[0,1] op_sel_hi:[1,1]
    v_pk_mul_f32 v[222:223], v[222:223], v[58:59] op_sel:[0,1] op_sel_hi:[1,1]
    v_cvt_pk_bf16_f32 v170, v220, v221
    v_cvt_pk_bf16_f32 v171, v222, v223
    s_add_u32 s37, s55, 8192
    buffer_store_dwordx4 v[168:171], v252, s[28:31], s37 offen offset:2048
    v_accvgpr_read_b32 v224, a88
    v_accvgpr_read_b32 v225, a89
    v_accvgpr_read_b32 v226, a90
    v_accvgpr_read_b32 v227, a91
    v_pk_mul_f32 v[224:225], v[224:225], v[60:61] op_sel:[0,0] op_sel_hi:[1,0]
    v_pk_mul_f32 v[226:227], v[226:227], v[60:61] op_sel:[0,0] op_sel_hi:[1,0]
    v_cvt_pk_bf16_f32 v154, v224, v225
    v_cvt_pk_bf16_f32 v155, v226, v227
    s_add_u32 s37, s55, 4096
    buffer_store_dwordx4 v[152:155], v252, s[28:31], s37 offen offset:2048
    v_accvgpr_read_b32 v228, a92
    v_accvgpr_read_b32 v229, a93
    v_accvgpr_read_b32 v230, a94
    v_accvgpr_read_b32 v231, a95
    v_pk_mul_f32 v[228:229], v[228:229], v[60:61] op_sel:[0,1] op_sel_hi:[1,1]
    v_pk_mul_f32 v[230:231], v[230:231], v[60:61] op_sel:[0,1] op_sel_hi:[1,1]
    v_cvt_pk_bf16_f32 v186, v228, v229
    v_cvt_pk_bf16_f32 v187, v230, v231
    s_add_u32 s37, s55, 12288
    buffer_store_dwordx4 v[184:187], v252, s[28:31], s37 offen offset:2048
    v_accvgpr_read_b32 v216, a96
    v_accvgpr_read_b32 v217, a97
    v_accvgpr_read_b32 v218, a98
    v_accvgpr_read_b32 v219, a99
    v_pk_mul_f32 v[216:217], v[216:217], v[58:59] op_sel:[0,0] op_sel_hi:[1,0]
    v_pk_mul_f32 v[218:219], v[218:219], v[58:59] op_sel:[0,0] op_sel_hi:[1,0]
    v_cvt_pk_bf16_f32 v140, v216, v217
    v_cvt_pk_bf16_f32 v141, v218, v219
    v_accvgpr_read_b32 v220, a100
    v_accvgpr_read_b32 v221, a101
    v_accvgpr_read_b32 v222, a102
    v_accvgpr_read_b32 v223, a103
    v_pk_mul_f32 v[220:221], v[220:221], v[58:59] op_sel:[0,1] op_sel_hi:[1,1]
    v_pk_mul_f32 v[222:223], v[222:223], v[58:59] op_sel:[0,1] op_sel_hi:[1,1]
    v_cvt_pk_bf16_f32 v172, v220, v221
    v_cvt_pk_bf16_f32 v173, v222, v223
    v_accvgpr_read_b32 v224, a104
    v_accvgpr_read_b32 v225, a105
    v_accvgpr_read_b32 v226, a106
    v_accvgpr_read_b32 v227, a107
    v_pk_mul_f32 v[224:225], v[224:225], v[60:61] op_sel:[0,0] op_sel_hi:[1,0]
    v_pk_mul_f32 v[226:227], v[226:227], v[60:61] op_sel:[0,0] op_sel_hi:[1,0]
    v_cvt_pk_bf16_f32 v156, v224, v225
    v_cvt_pk_bf16_f32 v157, v226, v227
    v_accvgpr_read_b32 v228, a108
    v_accvgpr_read_b32 v229, a109
    v_accvgpr_read_b32 v230, a110
    v_accvgpr_read_b32 v231, a111
    v_pk_mul_f32 v[228:229], v[228:229], v[60:61] op_sel:[0,1] op_sel_hi:[1,1]
    v_pk_mul_f32 v[230:231], v[230:231], v[60:61] op_sel:[0,1] op_sel_hi:[1,1]
    v_cvt_pk_bf16_f32 v188, v228, v229
    v_cvt_pk_bf16_f32 v189, v230, v231
    v_accvgpr_read_b32 v216, a112
    v_accvgpr_read_b32 v217, a113
    v_accvgpr_read_b32 v218, a114
    v_accvgpr_read_b32 v219, a115
    v_pk_mul_f32 v[216:217], v[216:217], v[58:59] op_sel:[0,0] op_sel_hi:[1,0]
    v_pk_mul_f32 v[218:219], v[218:219], v[58:59] op_sel:[0,0] op_sel_hi:[1,0]
    v_cvt_pk_bf16_f32 v142, v216, v217
    v_cvt_pk_bf16_f32 v143, v218, v219
    s_add_u32 s37, s55, 0
    buffer_store_dwordx4 v[140:143], v252, s[28:31], s37 offen offset:3072
    v_accvgpr_read_b32 v220, a116
    v_accvgpr_read_b32 v221, a117
    v_accvgpr_read_b32 v222, a118
    v_accvgpr_read_b32 v223, a119
    v_pk_mul_f32 v[220:221], v[220:221], v[58:59] op_sel:[0,1] op_sel_hi:[1,1]
    v_pk_mul_f32 v[222:223], v[222:223], v[58:59] op_sel:[0,1] op_sel_hi:[1,1]
    v_cvt_pk_bf16_f32 v174, v220, v221
    v_cvt_pk_bf16_f32 v175, v222, v223
    s_add_u32 s37, s55, 8192
Ltour8:
    s_cbranch_execz Ltour12
    buffer_store_dwordx4 v[172:175], v252, s[28:31], s37 offen offset:3072
    v_accvgpr_read_b32 v224, a120
    v_accvgpr_read_b32 v225, a121
    v_accvgpr_read_b32 v226, a122
    v_accvgpr_read_b32 v227, a123
    v_pk_mul_f32 v[224:225], v[224:225], v[60:61] op_sel:[0,0] op_sel_hi:[1,0]
    v_pk_mul_f32 v[226:227], v[226:227], v[60:61] op_sel:[0,0] op_sel_hi:[1,0]
    v_cvt_pk_bf16_f32 v158, v224, v225
    v_cvt_pk_bf16_f32 v159, v226, v227
    s_add_u32 s37, s55, 4096
    buffer_store_dwordx4 v[156:159], v252, s[28:31], s37 offen offset:3072
    v_accvgpr_read_b32 v228, a124
    v_accvgpr_read_b32 v229, a125
    v_accvgpr_read_b32 v230, a126
    v_accvgpr_read_b32 v231, a127
    v_pk_mul_f32 v[228:229], v[228:229], v[60:61] op_sel:[0,1] op_sel_hi:[1,1]
    v_pk_mul_f32 v[230:231], v[230:231], v[60:61] op_sel:[0,1] op_sel_hi:[1,1]
    v_cvt_pk_bf16_f32 v190, v228, v229
    v_cvt_pk_bf16_f32 v191, v230, v231
    s_add_u32 s37, s55, 12288
    buffer_store_dwordx4 v[188:191], v252, s[28:31], s37 offen offset:3072
    s_waitcnt lgkmcnt(14)
    v_mfma_f32_16x16x32_bf16 v[96:99], a[208:211], v[128:131], 0
    s_waitcnt lgkmcnt(12)
    ds_read_b64_tr_b16 a[160:161], v13 offset:0
    v_mfma_f32_16x16x32_bf16 v[96:99], a[212:215], v[132:135], v[96:99]
    s_waitcnt lgkmcnt(11)
    ds_read_b64_tr_b16 a[162:163], v13 offset:4096
    v_mfma_f32_16x16x32_bf16 v[96:99], a[216:219], v[136:139], v[96:99]
    s_waitcnt lgkmcnt(10)
    ds_read_b64_tr_b16 a[164:165], v13 offset:8192
    v_mfma_f32_16x16x32_bf16 v[96:99], a[220:223], v[140:143], v[96:99]
    s_waitcnt lgkmcnt(9)
    ds_read_b64_tr_b16 a[166:167], v13 offset:12288
    v_mfma_f32_16x16x32_bf16 v[96:99], a[224:227], v[144:147], v[96:99]
    s_waitcnt lgkmcnt(8)
    ds_read_b64_tr_b16 a[168:169], v13 offset:16384
    v_mfma_f32_16x16x32_bf16 v[96:99], a[228:231], v[148:151], v[96:99]
    s_waitcnt lgkmcnt(7)
    ds_read_b64_tr_b16 a[170:171], v13 offset:20480
    v_mfma_f32_16x16x32_bf16 v[96:99], a[232:235], v[152:155], v[96:99]
    s_waitcnt lgkmcnt(6)
    ds_read_b64_tr_b16 a[172:173], v13 offset:24576
    v_mfma_f32_16x16x32_bf16 v[96:99], a[236:239], v[156:159], v[96:99]
    ds_read_b64_tr_b16 a[174:175], v13 offset:28672
    v_mfma_f32_16x16x32_bf16 v[100:103], a[208:211], v[160:163], 0
    ds_read_b64_tr_b16 a[176:177], v17 offset:0
    v_mfma_f32_16x16x32_bf16 v[100:103], a[212:215], v[164:167], v[100:103]
    ds_read_b64_tr_b16 a[178:179], v17 offset:4096
    v_mfma_f32_16x16x32_bf16 v[100:103], a[216:219], v[168:171], v[100:103]
    ds_read_b64_tr_b16 a[180:181], v17 offset:8192
    v_mfma_f32_16x16x32_bf16 v[100:103], a[220:223], v[172:175], v[100:103]
    ds_read_b64_tr_b16 a[182:183], v17 offset:12288
    v_mfma_f32_16x16x32_bf16 v[100:103], a[224:227], v[176:179], v[100:103]
    ds_read_b64_tr_b16 a[184:185], v17 offset:16384
    v_cvt_pk_bf16_f32 v224, v96, v97
    v_mfma_f32_16x16x32_bf16 v[100:103], a[228:231], v[180:183], v[100:103]
    ds_read_b64_tr_b16 a[186:187], v17 offset:20480
    v_cvt_pk_bf16_f32 v225, v98, v99
    v_mfma_f32_16x16x32_bf16 v[100:103], a[232:235], v[184:187], v[100:103]
    ds_read_b64_tr_b16 a[188:189], v17 offset:24576
    v_mfma_f32_16x16x32_bf16 v[100:103], a[236:239], v[188:191], v[100:103]
    s_waitcnt lgkmcnt(13)
    ds_read_b64_tr_b16 a[190:191], v17 offset:28672
    v_mfma_f32_16x16x32_bf16 v[104:107], a[160:163], v[128:131], 0
    s_waitcnt lgkmcnt(12)
    ds_read_b64_tr_b16 a[208:209], v14 offset:0
    v_mfma_f32_16x16x32_bf16 v[104:107], a[164:167], v[132:135], v[104:107]
    s_waitcnt lgkmcnt(11)
    ds_read_b64_tr_b16 a[210:211], v14 offset:4096
    v_mfma_f32_16x16x32_bf16 v[104:107], a[168:171], v[136:139], v[104:107]
    s_waitcnt lgkmcnt(10)
    ds_read_b64_tr_b16 a[212:213], v14 offset:8192
    v_mfma_f32_16x16x32_bf16 v[104:107], a[172:175], v[140:143], v[104:107]
    s_waitcnt lgkmcnt(9)
    ds_read_b64_tr_b16 a[214:215], v14 offset:12288
    v_mfma_f32_16x16x32_bf16 v[104:107], a[176:179], v[144:147], v[104:107]
    s_waitcnt lgkmcnt(8)
    ds_read_b64_tr_b16 a[216:217], v14 offset:16384
    v_cvt_pk_bf16_f32 v228, v100, v101
    v_mfma_f32_16x16x32_bf16 v[104:107], a[180:183], v[148:151], v[104:107]
    s_waitcnt lgkmcnt(7)
    ds_read_b64_tr_b16 a[218:219], v14 offset:20480
    v_cvt_pk_bf16_f32 v229, v102, v103
    v_mfma_f32_16x16x32_bf16 v[104:107], a[184:187], v[152:155], v[104:107]
    s_waitcnt lgkmcnt(6)
    ds_read_b64_tr_b16 a[220:221], v14 offset:24576
    v_mfma_f32_16x16x32_bf16 v[104:107], a[188:191], v[156:159], v[104:107]
    ds_read_b64_tr_b16 a[222:223], v14 offset:28672
    s_waitcnt vmcnt(0)
    s_cmp_eq_u32 s53, 0
    s_cbranch_scc1 Lattn_wb
Lattn_wbdone:
    v_mfma_f32_16x16x32_bf16 v[108:111], a[160:163], v[160:163], 0
    buffer_store_dword v10, v8, s[24:27], s92 offen offset:8 sc1
    v_mfma_f32_16x16x32_bf16 v[108:111], a[164:167], v[164:167], v[108:111]
    s_xor_b32 s55, s55, 65536
    ds_read_b64_tr_b16 a[224:225], v18 offset:0
    ds_read_b64_tr_b16 a[226:227], v18 offset:4096
    v_mfma_f32_16x16x32_bf16 v[108:111], a[168:171], v[168:171], v[108:111]
    buffer_atomic_add v241, v240, s[88:91], 0 offen sc1
    v_mfma_f32_16x16x32_bf16 v[108:111], a[172:175], v[172:175], v[108:111]
    ds_read_b64_tr_b16 a[228:229], v18 offset:8192
    ds_read_b64_tr_b16 a[230:231], v18 offset:12288
    s_load_dwordx2 s[12:13], s[0:1], 0
    v_mfma_f32_16x16x32_bf16 v[108:111], a[176:179], v[176:179], v[108:111]
    ds_read_b64_tr_b16 a[232:233], v18 offset:16384
    v_cvt_pk_bf16_f32 v226, v104, v105
    v_mfma_f32_16x16x32_bf16 v[108:111], a[180:183], v[180:183], v[108:111]
    s_add_u32 s38, s56, 16384
    ds_read_b64_tr_b16 a[234:235], v18 offset:20480
    v_cvt_pk_bf16_f32 v227, v106, v107
    s_load_dwordx2 s[16:17], s[0:1], 96
    v_mfma_f32_16x16x32_bf16 v[108:111], a[184:187], v[184:187], v[108:111]
    buffer_store_dwordx4 v[224:227], v56, s[28:31], s38 offen sc1
    v_mfma_f32_16x16x32_bf16 v[108:111], a[188:191], v[188:191], v[108:111]
    s_waitcnt lgkmcnt(12)
    ds_read_b64_tr_b16 a[236:237], v18 offset:24576
    ds_read_b64_tr_b16 a[238:239], v18 offset:28672
    s_load_dwordx2 s[52:53], s[0:1], 48
    v_mfma_f32_16x16x32_bf16 v[112:115], a[208:211], v[128:131], 0
    s_waitcnt lgkmcnt(12)
    ds_read_b64_tr_b16 a[160:161], v15 offset:0
    v_mfma_f32_16x16x32_bf16 v[112:115], a[212:215], v[132:135], v[112:115]
    s_waitcnt lgkmcnt(11)
    ds_read_b64_tr_b16 a[162:163], v15 offset:4096
    v_mfma_f32_16x16x32_bf16 v[112:115], a[216:219], v[136:139], v[112:115]
    s_waitcnt lgkmcnt(10)
    ds_read_b64_tr_b16 a[164:165], v15 offset:8192
    v_mfma_f32_16x16x32_bf16 v[112:115], a[220:223], v[140:143], v[112:115]
    s_waitcnt lgkmcnt(9)
    ds_read_b64_tr_b16 a[166:167], v15 offset:12288
    v_mfma_f32_16x16x32_bf16 v[112:115], a[224:227], v[144:147], v[112:115]
    s_waitcnt lgkmcnt(8)
    ds_read_b64_tr_b16 a[168:169], v15 offset:16384
    v_cvt_pk_bf16_f32 v230, v108, v109
    v_mfma_f32_16x16x32_bf16 v[112:115], a[228:231], v[148:151], v[112:115]
    s_waitcnt lgkmcnt(7)
    s_add_u32 s38, s56, 180224
    ds_read_b64_tr_b16 a[170:171], v15 offset:20480
    v_cvt_pk_bf16_f32 v231, v110, v111
    v_mfma_f32_16x16x32_bf16 v[112:115], a[232:235], v[152:155], v[112:115]
    s_waitcnt lgkmcnt(6)
    buffer_store_dwordx4 v[228:231], v56, s[28:31], s38 offen sc1
    v_mfma_f32_16x16x32_bf16 v[112:115], a[236:239], v[156:159], v[112:115]
    ds_read_b64_tr_b16 a[172:173], v15 offset:24576
    ds_read_b64_tr_b16 a[174:175], v15 offset:28672
    v_mfma_f32_16x16x32_bf16 v[116:119], a[208:211], v[160:163], 0
    ds_read_b64_tr_b16 a[176:177], v19 offset:0
    v_mfma_f32_16x16x32_bf16 v[116:119], a[212:215], v[164:167], v[116:119]
    ds_read_b64_tr_b16 a[178:179], v19 offset:4096
    v_mfma_f32_16x16x32_bf16 v[116:119], a[216:219], v[168:171], v[116:119]
    ds_read_b64_tr_b16 a[180:181], v19 offset:8192
    v_mfma_f32_16x16x32_bf16 v[116:119], a[220:223], v[172:175], v[116:119]
    ds_read_b64_tr_b16 a[182:183], v19 offset:12288
    v_mfma_f32_16x16x32_bf16 v[116:119], a[224:227], v[176:179], v[116:119]
    ds_read_b64_tr_b16 a[184:185], v19 offset:16384
    v_cvt_pk_bf16_f32 v232, v112, v113
    v_mfma_f32_16x16x32_bf16 v[116:119], a[228:231], v[180:183], v[116:119]
    ds_read_b64_tr_b16 a[186:187], v19 offset:20480
    v_cvt_pk_bf16_f32 v233, v114, v115
    v_mfma_f32_16x16x32_bf16 v[116:119], a[232:235], v[184:187], v[116:119]
    ds_read_b64_tr_b16 a[188:189], v19 offset:24576
    v_mfma_f32_16x16x32_bf16 v[116:119], a[236:239], v[188:191], v[116:119]
    s_waitcnt lgkmcnt(13)
    ds_read_b64_tr_b16 a[190:191], v19 offset:28672
    s_barrier
    v_mfma_f32_16x16x32_bf16 v[120:123], a[160:163], v[128:131], 0
    s_waitcnt lgkmcnt(12)
    buffer_load_dword v11, v8, s[24:27], s54 offen offset:8 sc1
    v_mfma_f32_16x16x32_bf16 v[120:123], a[164:167], v[132:135], v[120:123]
    s_waitcnt lgkmcnt(10)
    ds_read_b64_tr_b16 a[208:209], v20 offset:0
    ds_read_b64_tr_b16 a[210:211], v20 offset:4096
    v_mfma_f32_16x16x32_bf16 v[120:123], a[168:171], v[136:139], v[120:123]
    s_waitcnt lgkmcnt(10)
    ds_read_b64_tr_b16 a[212:213], v20 offset:8192
    v_mfma_f32_16x16x32_bf16 v[120:123], a[172:175], v[140:143], v[120:123]
    s_waitcnt lgkmcnt(9)
    ds_read_b64_tr_b16 a[214:215], v20 offset:12288
    v_mfma_f32_16x16x32_bf16 v[120:123], a[176:179], v[144:147], v[120:123]
    s_waitcnt lgkmcnt(8)
    ds_read_b64_tr_b16 a[216:217], v20 offset:16384
    v_cvt_pk_bf16_f32 v236, v116, v117
    v_mfma_f32_16x16x32_bf16 v[120:123], a[180:183], v[148:151], v[120:123]
    s_waitcnt lgkmcnt(7)
    ds_read_b64_tr_b16 a[218:219], v20 offset:20480
    v_cvt_pk_bf16_f32 v237, v118, v119
    v_mfma_f32_16x16x32_bf16 v[120:123], a[184:187], v[152:155], v[120:123]
    s_waitcnt lgkmcnt(6)
    s_add_u32 s49, s46, 73728
    ds_read_b64_tr_b16 a[220:221], v20 offset:24576
    v_mfma_f32_16x16x32_bf16 v[120:123], a[188:191], v[156:159], v[120:123]
    s_add_u32 m0, s42, 114688
    ds_read_b64_tr_b16 a[222:223], v20 offset:28672
    v_mfma_f32_16x16x32_bf16 v[124:127], a[160:163], v[160:163], 0
    buffer_load_dwordx4 v46, s[20:23], s49 offen lds
    v_mfma_f32_16x16x32_bf16 v[124:127], a[164:167], v[164:167], v[124:127]
    ds_read_b64_tr_b16 a[224:225], v24 offset:0
    ds_read_b64_tr_b16 a[226:227], v24 offset:4096
    v_mfma_f32_16x16x32_bf16 v[124:127], a[168:171], v[168:171], v[124:127]
    buffer_load_dwordx4 v47, s[20:23], s49 offen offset:1024 lds
    v_mfma_f32_16x16x32_bf16 v[124:127], a[172:175], v[172:175], v[124:127]
    ds_read_b64_tr_b16 a[228:229], v24 offset:8192
    ds_read_b64_tr_b16 a[230:231], v24 offset:12288
    v_mfma_f32_16x16x32_bf16 v[124:127], a[176:179], v[176:179], v[124:127]
    ds_read_b64_tr_b16 a[232:233], v24 offset:16384
    v_cvt_pk_bf16_f32 v234, v120, v121
    v_mfma_f32_16x16x32_bf16 v[124:127], a[180:183], v[180:183], v[124:127]
    s_add_u32 s38, s56, 16512
    ds_read_b64_tr_b16 a[234:235], v24 offset:20480
    v_cvt_pk_bf16_f32 v235, v122, v123
    v_mfma_f32_16x16x32_bf16 v[124:127], a[184:187], v[184:187], v[124:127]
    buffer_store_dwordx4 v[232:235], v56, s[28:31], s38 offen sc1
    v_mfma_f32_16x16x32_bf16 v[124:127], a[188:191], v[188:191], v[124:127]
    s_waitcnt lgkmcnt(12)
    ds_read_b64_tr_b16 a[236:237], v24 offset:24576
    ds_read_b64_tr_b16 a[238:239], v24 offset:28672
    v_mfma_f32_16x16x32_bf16 v[64:67], a[208:211], v[128:131], 0
    s_waitcnt lgkmcnt(12)
    buffer_load_dwordx4 v48, s[20:23], s49 offen offset:2048 lds
    v_mfma_f32_16x16x32_bf16 v[64:67], a[212:215], v[132:135], v[64:67]
    s_waitcnt lgkmcnt(10)
    ds_read_b64_tr_b16 a[160:161], v21 offset:0
    ds_read_b64_tr_b16 a[162:163], v21 offset:4096
    v_mfma_f32_16x16x32_bf16 v[64:67], a[216:219], v[136:139], v[64:67]
    s_waitcnt lgkmcnt(10)
    buffer_load_dwordx4 v49, s[20:23], s49 offen offset:3072 lds
    v_mfma_f32_16x16x32_bf16 v[64:67], a[220:223], v[140:143], v[64:67]
    s_waitcnt lgkmcnt(8)
    ds_read_b64_tr_b16 a[164:165], v21 offset:8192
    ds_read_b64_tr_b16 a[166:167], v21 offset:12288
    v_mfma_f32_16x16x32_bf16 v[64:67], a[224:227], v[144:147], v[64:67]
    s_waitcnt lgkmcnt(8)
    ds_read_b64_tr_b16 a[168:169], v21 offset:16384
    v_cvt_pk_bf16_f32 v238, v124, v125
    v_mfma_f32_16x16x32_bf16 v[64:67], a[228:231], v[148:151], v[64:67]
    s_waitcnt lgkmcnt(7)
    s_add_u32 s38, s56, 180352
    ds_read_b64_tr_b16 a[170:171], v21 offset:20480
    v_cvt_pk_bf16_f32 v239, v126, v127
    v_mfma_f32_16x16x32_bf16 v[64:67], a[232:235], v[152:155], v[64:67]
    s_waitcnt lgkmcnt(6)
    buffer_store_dwordx4 v[236:239], v56, s[28:31], s38 offen sc1
    v_mfma_f32_16x16x32_bf16 v[64:67], a[236:239], v[156:159], v[64:67]
    ds_read_b64_tr_b16 a[172:173], v21 offset:24576
    ds_read_b64_tr_b16 a[174:175], v21 offset:28672
    v_mfma_f32_16x16x32_bf16 v[68:71], a[208:211], v[160:163], 0
    s_lshl_b32 s40, s5, 4
    ds_read_b64_tr_b16 a[176:177], v25 offset:0
    v_mfma_f32_16x16x32_bf16 v[68:71], a[212:215], v[164:167], v[68:71]
    s_add_u32 s40, s40, s4
    ds_read_b64_tr_b16 a[178:179], v25 offset:4096
    v_and_b32 v240, 31, v1
    v_mfma_f32_16x16x32_bf16 v[68:71], a[216:219], v[168:171], v[68:71]
    ds_read_b64_tr_b16 a[180:181], v25 offset:8192
    v_lshrrev_b32 v241, 5, v1
    v_mfma_f32_16x16x32_bf16 v[68:71], a[220:223], v[172:175], v[68:71]
    ds_read_b64_tr_b16 a[182:183], v25 offset:12288
    v_cmp_gt_u32 vcc, 8, v240
    v_mfma_f32_16x16x32_bf16 v[68:71], a[224:227], v[176:179], v[68:71]
    ds_read_b64_tr_b16 a[184:185], v25 offset:16384
    v_mov_b32 v242, 2147483648
    v_mfma_f32_16x16x32_bf16 v[68:71], a[228:231], v[180:183], v[68:71]
    s_lshl_b32 s43, s40, 3
    ds_read_b64_tr_b16 a[186:187], v25 offset:20480
    v_mfma_f32_16x16x32_bf16 v[68:71], a[232:235], v[184:187], v[68:71]
    s_lshl_b32 s44, s3, 1
    ds_read_b64_tr_b16 a[188:189], v25 offset:24576
    v_mfma_f32_16x16x32_bf16 v[68:71], a[236:239], v[188:191], v[68:71]
    s_waitcnt lgkmcnt(13)
    s_add_u32 s43, s43, s44
    ds_read_b64_tr_b16 a[190:191], v25 offset:28672
    v_cndmask_b32 v242, v242, 0, vcc
    v_mfma_f32_16x16x32_bf16 v[72:75], a[160:163], v[128:131], 0
    s_waitcnt lgkmcnt(12)
    ds_read_b64_tr_b16 a[208:209], v22 offset:0
    v_add_u32 v7, s43, v241
    v_mfma_f32_16x16x32_bf16 v[72:75], a[164:167], v[132:135], v[72:75]
    s_waitcnt lgkmcnt(11)
    ds_read_b64_tr_b16 a[210:211], v22 offset:4096
    v_lshlrev_b32 v5, 4, v240
    v_mfma_f32_16x16x32_bf16 v[72:75], a[168:171], v[136:139], v[72:75]
    s_waitcnt lgkmcnt(10)
    ds_read_b64_tr_b16 a[212:213], v22 offset:8192
    v_lshlrev_b32 v243, 4, v241
    v_mfma_f32_16x16x32_bf16 v[72:75], a[172:175], v[140:143], v[72:75]
    s_waitcnt lgkmcnt(9)
    ds_read_b64_tr_b16 a[214:215], v22 offset:12288
    v_lshl_add_u32 v2, v240, 5, v243
    v_mfma_f32_16x16x32_bf16 v[72:75], a[176:179], v[144:147], v[72:75]
    s_waitcnt lgkmcnt(8)
    ds_read_b64_tr_b16 a[216:217], v22 offset:16384
    v_lshrrev_b32 v243, 4, v240
    v_mfma_f32_16x16x32_bf16 v[72:75], a[180:183], v[148:151], v[72:75]
    s_waitcnt lgkmcnt(7)
    ds_read_b64_tr_b16 a[218:219], v22 offset:20480
    v_mul_u32_u24 v243, 1536, v243
    v_mfma_f32_16x16x32_bf16 v[72:75], a[184:187], v[152:155], v[72:75]
    s_waitcnt lgkmcnt(6)
    ds_read_b64_tr_b16 a[220:221], v22 offset:24576
    v_add_u32 v2, v2, v243
    v_mfma_f32_16x16x32_bf16 v[72:75], a[188:191], v[156:159], v[72:75]
    s_mul_i32 s44, s43, 10240
    ds_read_b64_tr_b16 a[222:223], v22 offset:28672
    v_lshrrev_b32 v243, 2, v240
    v_mfma_f32_16x16x32_bf16 v[76:79], a[160:163], v[160:163], 0
    ds_read_b64_tr_b16 a[224:225], v26 offset:0
    v_lshlrev_b32 v243, 6, v243
    v_mfma_f32_16x16x32_bf16 v[76:79], a[164:167], v[164:167], v[76:79]
    ds_read_b64_tr_b16 a[226:227], v26 offset:4096
    v_and_b32 v241, 3, v240
    v_mfma_f32_16x16x32_bf16 v[76:79], a[168:171], v[168:171], v[76:79]
    ds_read_b64_tr_b16 a[228:229], v26 offset:8192
    v_lshl_add_u32 v3, v241, 3, v243
    v_mfma_f32_16x16x32_bf16 v[76:79], a[172:175], v[172:175], v[76:79]
    ds_read_b64_tr_b16 a[230:231], v26 offset:12288
    v_mul_u32_u24 v243, 1152, v7
    v_mfma_f32_16x16x32_bf16 v[76:79], a[176:179], v[176:179], v[76:79]
    ds_read_b64_tr_b16 a[232:233], v26 offset:16384
    v_add_u32 v4, v243, v3
    v_mfma_f32_16x16x32_bf16 v[76:79], a[180:183], v[180:183], v[76:79]
    ds_read_b64_tr_b16 a[234:235], v26 offset:20480
    v_lshl_add_u32 v6, v243, 1, v5
    v_mfma_f32_16x16x32_bf16 v[76:79], a[184:187], v[184:187], v[76:79]
    ds_read_b64_tr_b16 a[236:237], v26 offset:24576
    v_or_b32 v55, v3, v242
    v_mfma_f32_16x16x32_bf16 v[76:79], a[188:191], v[188:191], v[76:79]
    s_waitcnt lgkmcnt(13)
    ds_read_b64_tr_b16 a[238:239], v26 offset:28672
    v_or_b32 v58, v4, v242
    v_mfma_f32_16x16x32_bf16 v[80:83], a[208:211], v[128:131], 0
    s_waitcnt lgkmcnt(12)
    ds_read_b64_tr_b16 a[160:161], v23 offset:0
    v_or_b32 v59, v5, v242
    v_mfma_f32_16x16x32_bf16 v[80:83], a[212:215], v[132:135], v[80:83]
    s_waitcnt lgkmcnt(11)
    ds_read_b64_tr_b16 a[162:163], v23 offset:4096
    v_or_b32 v60, v6, v242
    v_mfma_f32_16x16x32_bf16 v[80:83], a[216:219], v[136:139], v[80:83]
    s_waitcnt lgkmcnt(10)
    ds_read_b64_tr_b16 a[164:165], v23 offset:8192
    s_waitcnt vmcnt(6)
    v_readfirstlane_b32 s36, v11
    v_mfma_f32_16x16x32_bf16 v[80:83], a[220:223], v[140:143], v[80:83]
    s_waitcnt lgkmcnt(9)
    ds_read_b64_tr_b16 a[166:167], v23 offset:12288
    v_lshrrev_b32 v243, 4, v1
    v_mfma_f32_16x16x32_bf16 v[80:83], a[224:227], v[144:147], v[80:83]
    ds_read_b64_tr_b16 a[168:169], v23 offset:16384
    v_lshlrev_b32 v243, 8, v243
    s_cmp_lg_u32 s36, s95
    s_cbranch_scc1 Lattn_xspin
Lattn_xgot:
    s_waitcnt lgkmcnt(9)
    v_mfma_f32_16x16x32_bf16 v[80:83], a[228:231], v[148:151], v[80:83]
    s_waitcnt lgkmcnt(7)
    ds_read_b64_tr_b16 a[170:171], v23 offset:20480
    v_and_b32 v241, 7, v1
    v_mfma_f32_16x16x32_bf16 v[80:83], a[232:235], v[152:155], v[80:83]
    s_waitcnt lgkmcnt(6)
    ds_read_b64_tr_b16 a[172:173], v23 offset:24576
    v_lshl_add_u32 v243, v241, 5, v243
    v_mfma_f32_16x16x32_bf16 v[80:83], a[236:239], v[156:159], v[80:83]
    s_add_u32 s37, s55, 0
    ds_read_b64_tr_b16 a[174:175], v23 offset:28672
    v_and_b32 v241, 8, v1
    v_mfma_f32_16x16x32_bf16 v[84:87], a[208:211], v[160:163], 0
    buffer_load_dwordx4 a[64:67], v252, s[28:31], s37 offen offset:0 sc1
    v_mfma_f32_16x16x32_bf16 v[84:87], a[212:215], v[164:167], v[84:87]
    ds_read_b64_tr_b16 a[176:177], v27 offset:0
    ds_read_b64_tr_b16 a[178:179], v27 offset:4096
    v_mfma_f32_16x16x32_bf16 v[84:87], a[216:219], v[168:171], v[84:87]
    buffer_load_dwordx4 a[68:71], v252, s[28:31], s37 offen offset:1024 sc1
    v_mfma_f32_16x16x32_bf16 v[84:87], a[220:223], v[172:175], v[84:87]
    ds_read_b64_tr_b16 a[180:181], v27 offset:8192
    ds_read_b64_tr_b16 a[182:183], v27 offset:12288
    v_mfma_f32_16x16x32_bf16 v[84:87], a[224:227], v[176:179], v[84:87]
    ds_read_b64_tr_b16 a[184:185], v27 offset:16384
    v_lshl_add_u32 v54, v241, 1, v243
    v_mfma_f32_16x16x32_bf16 v[84:87], a[228:231], v[180:183], v[84:87]
    s_lshr_b32 s41, s2, 3
    ds_read_b64_tr_b16 a[186:187], v27 offset:20480
    v_mfma_f32_16x16x32_bf16 v[84:87], a[232:235], v[184:187], v[84:87]
    buffer_load_dwordx4 a[72:75], v252, s[28:31], s37 offen offset:2048 sc1
    v_mfma_f32_16x16x32_bf16 v[84:87], a[236:239], v[188:191], v[84:87]
    s_waitcnt lgkmcnt(12)
    s_mov_b32 s14, 2359296
    ds_read_b64_tr_b16 a[188:189], v27 offset:24576
    ds_read_b64_tr_b16 a[190:191], v27 offset:28672
    s_barrier
    v_mfma_f32_16x16x32_bf16 v[88:91], a[160:163], v[128:131], 0
    s_waitcnt lgkmcnt(12)
    s_mov_b32 s15, 0x20000
    ds_read_b64_tr_b16 a[208:209], v12 offset:32768
    v_mfma_f32_16x16x32_bf16 v[88:91], a[164:167], v[132:135], v[88:91]
    s_waitcnt lgkmcnt(11)
    s_mov_b32 s18, 2359296
    ds_read_b64_tr_b16 a[210:211], v12 offset:36864
    v_mfma_f32_16x16x32_bf16 v[88:91], a[168:171], v[136:139], v[88:91]
    s_waitcnt lgkmcnt(10)
    buffer_load_dwordx4 a[76:79], v252, s[28:31], s37 offen offset:3072 sc1
    v_mfma_f32_16x16x32_bf16 v[88:91], a[172:175], v[140:143], v[88:91]
    s_waitcnt lgkmcnt(8)
    s_mov_b32 s19, 0x20000
    ds_read_b64_tr_b16 a[212:213], v12 offset:40960
    ds_read_b64_tr_b16 a[214:215], v12 offset:45056
    v_mfma_f32_16x16x32_bf16 v[88:91], a[176:179], v[144:147], v[88:91]
    s_waitcnt lgkmcnt(8)
    s_add_u32 s8, s50, 7864320
    s_addc_u32 s9, s51, 0
    ds_read_b64_tr_b16 a[216:217], v12 offset:49152
    v_mfma_f32_16x16x32_bf16 v[88:91], a[180:183], v[148:151], v[88:91]
    s_waitcnt lgkmcnt(7)
    s_add_u32 s37, s55, 4096
    ds_read_b64_tr_b16 a[218:219], v12 offset:53248
    v_mfma_f32_16x16x32_bf16 v[88:91], a[184:187], v[152:155], v[88:91]
    s_waitcnt lgkmcnt(6)
    s_add_u32 s49, s46, 256
    buffer_load_dwordx4 a[80:83], v252, s[28:31], s37 offen offset:0 sc1
    v_mfma_f32_16x16x32_bf16 v[88:91], a[188:191], v[156:159], v[88:91]
    s_add_u32 m0, s42, 0
    ds_read_b64_tr_b16 a[220:221], v12 offset:57344
    ds_read_b64_tr_b16 a[222:223], v12 offset:61440
    v_mfma_f32_16x16x32_bf16 v[92:95], a[160:163], v[160:163], 0
    buffer_load_dwordx4 v46, s[20:23], s49 offen lds
    v_mfma_f32_16x16x32_bf16 v[92:95], a[164:167], v[164:167], v[92:95]
    s_mov_b32 s10, 663552
    ds_read_b64_tr_b16 a[224:225], v16 offset:32768
    ds_read_b64_tr_b16 a[226:227], v16 offset:36864
    v_mfma_f32_16x16x32_bf16 v[92:95], a[168:171], v[168:171], v[92:95]
    buffer_load_dwordx4 v47, s[20:23], s49 offen offset:1024 lds
    v_mfma_f32_16x16x32_bf16 v[92:95], a[172:175], v[172:175], v[92:95]
    s_mov_b32 s11, 0x20000
    ds_read_b64_tr_b16 a[228:229], v16 offset:40960
    ds_read_b64_tr_b16 a[230:231], v16 offset:45056
    v_mfma_f32_16x16x32_bf16 v[92:95], a[176:179], v[176:179], v[92:95]
    buffer_load_dwordx4 a[84:87], v252, s[28:31], s37 offen offset:1024 sc1
    v_mfma_f32_16x16x32_bf16 v[92:95], a[180:183], v[180:183], v[92:95]
    s_lshl_b32 s39, s5, 13
    ds_read_b64_tr_b16 a[232:233], v16 offset:49152
    ds_read_b64_tr_b16 a[234:235], v16 offset:53248
    v_mfma_f32_16x16x32_bf16 v[92:95], a[184:187], v[184:187], v[92:95]
    s_add_u32 s39, s39, 8781824
    ds_read_b64_tr_b16 a[236:237], v16 offset:57344
    v_mfma_f32_16x16x32_bf16 v[92:95], a[188:191], v[188:191], v[92:95]
    s_waitcnt lgkmcnt(13)
    s_lshr_b32 s45, s4, 2
    ds_read_b64_tr_b16 a[238:239], v16 offset:61440
    v_mfma_f32_16x16x32_bf16 v[96:99], a[208:211], v[128:131], 0
    s_waitcnt lgkmcnt(12)
    buffer_load_dwordx4 v48, s[20:23], s49 offen offset:2048 lds
    v_mfma_f32_16x16x32_bf16 v[96:99], a[212:215], v[132:135], v[96:99]
    s_waitcnt lgkmcnt(10)
    s_lshl_b32 s45, s45, 11
    ds_read_b64_tr_b16 a[160:161], v13 offset:32768
    ds_read_b64_tr_b16 a[162:163], v13 offset:36864
    v_mfma_f32_16x16x32_bf16 v[96:99], a[216:219], v[136:139], v[96:99]
    s_waitcnt lgkmcnt(10)
    buffer_load_dwordx4 v49, s[20:23], s49 offen offset:3072 lds
    v_mfma_f32_16x16x32_bf16 v[96:99], a[220:223], v[140:143], v[96:99]
    s_waitcnt lgkmcnt(8)
    s_add_u32 s39, s39, s45
    ds_read_b64_tr_b16 a[164:165], v13 offset:40960
    ds_read_b64_tr_b16 a[166:167], v13 offset:45056
    v_mfma_f32_16x16x32_bf16 v[96:99], a[224:227], v[144:147], v[96:99]
    s_waitcnt lgkmcnt(8)
    buffer_load_dwordx4 a[88:91], v252, s[28:31], s37 offen offset:2048 sc1
    v_mfma_f32_16x16x32_bf16 v[96:99], a[228:231], v[148:151], v[96:99]
    s_waitcnt lgkmcnt(6)
    ds_read_b64_tr_b16 a[168:169], v13 offset:49152
    ds_read_b64_tr_b16 a[170:171], v13 offset:53248
    v_mfma_f32_16x16x32_bf16 v[96:99], a[232:235], v[152:155], v[96:99]
    s_waitcnt lgkmcnt(6)
    s_add_u32 s49, s46, 73984
    ds_read_b64_tr_b16 a[172:173], v13 offset:57344
    v_and_b32 v9, 15, v1
    v_mfma_f32_16x16x32_bf16 v[96:99], a[236:239], v[156:159], v[96:99]
    s_add_u32 m0, s42, 16384
    ds_read_b64_tr_b16 a[174:175], v13 offset:61440
    v_lshlrev_b32 v9, 7, v9
    v_mfma_f32_16x16x32_bf16 v[100:103], a[208:211], v[160:163], 0
    buffer_load_dwordx4 v46, s[20:23], s49 offen lds
    v_mfma_f32_16x16x32_bf16 v[100:103], a[212:215], v[164:167], v[100:103]
    ds_read_b64_tr_b16 a[176:177], v17 offset:32768
    ds_read_b64_tr_b16 a[178:179], v17 offset:36864
    v_mfma_f32_16x16x32_bf16 v[100:103], a[216:219], v[168:171], v[100:103]
    buffer_load_dwordx4 v47, s[20:23], s49 offen offset:1024 lds
    v_mfma_f32_16x16x32_bf16 v[100:103], a[220:223], v[172:175], v[100:103]
    ds_read_b64_tr_b16 a[180:181], v17 offset:40960
    ds_read_b64_tr_b16 a[182:183], v17 offset:45056
    v_mfma_f32_16x16x32_bf16 v[100:103], a[224:227], v[176:179], v[100:103]
    buffer_load_dwordx4 a[92:95], v252, s[28:31], s37 offen offset:3072 sc1
    v_mfma_f32_16x16x32_bf16 v[100:103], a[228:231], v[180:183], v[100:103]
    ds_read_b64_tr_b16 a[184:185], v17 offset:49152
    ds_read_b64_tr_b16 a[186:187], v17 offset:53248
    v_mfma_f32_16x16x32_bf16 v[100:103], a[232:235], v[184:187], v[100:103]
    ds_read_b64_tr_b16 a[188:189], v17 offset:57344
    v_mfma_f32_16x16x32_bf16 v[100:103], a[236:239], v[188:191], v[100:103]
    s_waitcnt lgkmcnt(13)
    ds_read_b64_tr_b16 a[190:191], v17 offset:61440
    v_mfma_f32_16x16x32_bf16 v[104:107], a[160:163], v[128:131], 0
    s_waitcnt lgkmcnt(12)
    buffer_load_dwordx4 v48, s[20:23], s49 offen offset:2048 lds
    v_mfma_f32_16x16x32_bf16 v[104:107], a[164:167], v[132:135], v[104:107]
    s_waitcnt lgkmcnt(10)
    ds_read_b64_tr_b16 a[208:209], v14 offset:32768
    ds_read_b64_tr_b16 a[210:211], v14 offset:36864
    v_mfma_f32_16x16x32_bf16 v[104:107], a[168:171], v[136:139], v[104:107]
    s_waitcnt lgkmcnt(10)
    buffer_load_dwordx4 v49, s[20:23], s49 offen offset:3072 lds
    v_mfma_f32_16x16x32_bf16 v[104:107], a[172:175], v[140:143], v[104:107]
    s_waitcnt lgkmcnt(8)
    s_add_u32 s37, s55, 8192
    ds_read_b64_tr_b16 a[212:213], v14 offset:40960
    ds_read_b64_tr_b16 a[214:215], v14 offset:45056
    v_mfma_f32_16x16x32_bf16 v[104:107], a[176:179], v[144:147], v[104:107]
    s_waitcnt lgkmcnt(8)
    buffer_load_dwordx4 a[96:99], v252, s[28:31], s37 offen offset:0 sc1
    v_mfma_f32_16x16x32_bf16 v[104:107], a[180:183], v[148:151], v[104:107]
    s_waitcnt lgkmcnt(6)
    ds_read_b64_tr_b16 a[216:217], v14 offset:49152
    ds_read_b64_tr_b16 a[218:219], v14 offset:53248
    v_mfma_f32_16x16x32_bf16 v[104:107], a[184:187], v[152:155], v[104:107]
    s_waitcnt lgkmcnt(6)
    buffer_load_dwordx4 a[100:103], v252, s[28:31], s37 offen offset:1024 sc1
    v_mfma_f32_16x16x32_bf16 v[104:107], a[188:191], v[156:159], v[104:107]
    ds_read_b64_tr_b16 a[220:221], v14 offset:57344
    ds_read_b64_tr_b16 a[222:223], v14 offset:61440
    v_mfma_f32_16x16x32_bf16 v[108:111], a[160:163], v[160:163], 0
    ds_read_b64_tr_b16 a[224:225], v18 offset:32768
    v_mfma_f32_16x16x32_bf16 v[108:111], a[164:167], v[164:167], v[108:111]
    ds_read_b64_tr_b16 a[226:227], v18 offset:36864
    v_mfma_f32_16x16x32_bf16 v[108:111], a[168:171], v[168:171], v[108:111]
    buffer_load_dwordx4 a[104:107], v252, s[28:31], s37 offen offset:2048 sc1
    v_mfma_f32_16x16x32_bf16 v[108:111], a[172:175], v[172:175], v[108:111]
    ds_read_b64_tr_b16 a[228:229], v18 offset:40960
    ds_read_b64_tr_b16 a[230:231], v18 offset:45056
    v_mfma_f32_16x16x32_bf16 v[108:111], a[176:179], v[176:179], v[108:111]
    ds_read_b64_tr_b16 a[232:233], v18 offset:49152
    v_mfma_f32_16x16x32_bf16 v[108:111], a[180:183], v[180:183], v[108:111]
    ds_read_b64_tr_b16 a[234:235], v18 offset:53248
    v_mfma_f32_16x16x32_bf16 v[108:111], a[184:187], v[184:187], v[108:111]
    buffer_load_dwordx4 a[108:111], v252, s[28:31], s37 offen offset:3072 sc1
    v_mfma_f32_16x16x32_bf16 v[108:111], a[188:191], v[188:191], v[108:111]
    s_waitcnt lgkmcnt(12)
    ds_read_b64_tr_b16 a[236:237], v18 offset:57344
    ds_read_b64_tr_b16 a[238:239], v18 offset:61440
    v_mfma_f32_16x16x32_bf16 v[112:115], a[208:211], v[128:131], 0
    s_waitcnt lgkmcnt(12)
    ds_read_b64_tr_b16 a[160:161], v15 offset:32768
    v_mfma_f32_16x16x32_bf16 v[112:115], a[212:215], v[132:135], v[112:115]
    s_waitcnt lgkmcnt(11)
    s_add_u32 s37, s55, 12288
    ds_read_b64_tr_b16 a[162:163], v15 offset:36864
    v_mfma_f32_16x16x32_bf16 v[112:115], a[216:219], v[136:139], v[112:115]
    s_waitcnt lgkmcnt(10)
    buffer_load_dwordx4 a[112:115], v252, s[28:31], s37 offen offset:0 sc1
    v_mfma_f32_16x16x32_bf16 v[112:115], a[220:223], v[140:143], v[112:115]
    s_waitcnt lgkmcnt(8)
    ds_read_b64_tr_b16 a[164:165], v15 offset:40960
    ds_read_b64_tr_b16 a[166:167], v15 offset:45056
    v_mfma_f32_16x16x32_bf16 v[112:115], a[224:227], v[144:147], v[112:115]
    s_waitcnt lgkmcnt(8)
    buffer_load_dwordx4 a[116:119], v252, s[28:31], s37 offen offset:1024 sc1
    v_mfma_f32_16x16x32_bf16 v[112:115], a[228:231], v[148:151], v[112:115]
    s_waitcnt lgkmcnt(6)
    ds_read_b64_tr_b16 a[168:169], v15 offset:49152
    ds_read_b64_tr_b16 a[170:171], v15 offset:53248
    v_mfma_f32_16x16x32_bf16 v[112:115], a[232:235], v[152:155], v[112:115]
    s_waitcnt lgkmcnt(6)
    ds_read_b64_tr_b16 a[172:173], v15 offset:57344
    v_mfma_f32_16x16x32_bf16 v[112:115], a[236:239], v[156:159], v[112:115]
    ds_read_b64_tr_b16 a[174:175], v15 offset:61440
    v_mfma_f32_16x16x32_bf16 v[116:119], a[208:211], v[160:163], 0
Ltour9:
    s_cbranch_execz Ltour13
    buffer_load_dwordx4 a[120:123], v252, s[28:31], s37 offen offset:2048 sc1
    v_mfma_f32_16x16x32_bf16 v[116:119], a[212:215], v[164:167], v[116:119]
    ds_read_b64_tr_b16 a[176:177], v19 offset:32768
    ds_read_b64_tr_b16 a[178:179], v19 offset:36864
    v_mfma_f32_16x16x32_bf16 v[116:119], a[216:219], v[168:171], v[116:119]
    ds_read_b64_tr_b16 a[180:181], v19 offset:40960
    v_mfma_f32_16x16x32_bf16 v[116:119], a[220:223], v[172:175], v[116:119]
    ds_read_b64_tr_b16 a[182:183], v19 offset:45056
    v_mfma_f32_16x16x32_bf16 v[116:119], a[224:227], v[176:179], v[116:119]
    buffer_load_dwordx4 a[124:127], v252, s[28:31], s37 offen offset:3072 sc1
    v_mfma_f32_16x16x32_bf16 v[116:119], a[228:231], v[180:183], v[116:119]
    ds_read_b64_tr_b16 a[184:185], v19 offset:49152
    ds_read_b64_tr_b16 a[186:187], v19 offset:53248
    v_mfma_f32_16x16x32_bf16 v[116:119], a[232:235], v[184:187], v[116:119]
    ds_read_b64_tr_b16 a[188:189], v19 offset:57344
    v_mfma_f32_16x16x32_bf16 v[116:119], a[236:239], v[188:191], v[116:119]
    ds_read_b64_tr_b16 a[190:191], v19 offset:61440
    s_waitcnt vmcnt(25)
    s_waitcnt lgkmcnt(0)
    s_barrier
    v_mfma_f32_16x16x32_bf16 v[120:123], a[160:163], v[128:131], 0
    ds_read_b64_tr_b16 a[208:209], v20 offset:32768
    v_mfma_f32_16x16x32_bf16 v[120:123], a[164:167], v[132:135], v[120:123]
    ds_read_b64_tr_b16 a[210:211], v20 offset:36864
    v_mfma_f32_16x16x32_bf16 v[120:123], a[168:171], v[136:139], v[120:123]
    ds_read_b64_tr_b16 a[212:213], v20 offset:40960
    v_mfma_f32_16x16x32_bf16 v[120:123], a[172:175], v[140:143], v[120:123]
    ds_read_b64_tr_b16 a[214:215], v20 offset:45056
    v_mfma_f32_16x16x32_bf16 v[120:123], a[176:179], v[144:147], v[120:123]
    ds_read_b64_tr_b16 a[216:217], v20 offset:49152
    v_mfma_f32_16x16x32_bf16 v[120:123], a[180:183], v[148:151], v[120:123]
    ds_read_b64_tr_b16 a[218:219], v20 offset:53248
    v_mfma_f32_16x16x32_bf16 v[120:123], a[184:187], v[152:155], v[120:123]
    s_add_u32 s49, s7, 512
    ds_read_b64_tr_b16 a[220:221], v20 offset:57344
    v_mfma_f32_16x16x32_bf16 v[120:123], a[188:191], v[156:159], v[120:123]
    s_add_u32 m0, s42, 65536
    ds_read_b64_tr_b16 a[222:223], v20 offset:61440
    v_mfma_f32_16x16x32_bf16 v[124:127], a[160:163], v[160:163], 0
    buffer_load_dwordx4 v46, s[20:23], s49 offen lds
    v_mfma_f32_16x16x32_bf16 v[124:127], a[164:167], v[164:167], v[124:127]
    ds_read_b64_tr_b16 a[224:225], v24 offset:32768
    ds_read_b64_tr_b16 a[226:227], v24 offset:36864
    v_mfma_f32_16x16x32_bf16 v[124:127], a[168:171], v[168:171], v[124:127]
    buffer_load_dwordx4 v47, s[20:23], s49 offen offset:1024 lds
    v_mfma_f32_16x16x32_bf16 v[124:127], a[172:175], v[172:175], v[124:127]
    ds_read_b64_tr_b16 a[228:229], v24 offset:40960
    ds_read_b64_tr_b16 a[230:231], v24 offset:45056
    v_mfma_f32_16x16x32_bf16 v[124:127], a[176:179], v[176:179], v[124:127]
    ds_read_b64_tr_b16 a[232:233], v24 offset:49152
    v_mfma_f32_16x16x32_bf16 v[124:127], a[180:183], v[180:183], v[124:127]
    ds_read_b64_tr_b16 a[234:235], v24 offset:53248
    v_mfma_f32_16x16x32_bf16 v[124:127], a[184:187], v[184:187], v[124:127]
    ds_read_b64_tr_b16 a[236:237], v24 offset:57344
    v_lshrrev_b32 v240, 4, v1
    v_mfma_f32_16x16x32_bf16 v[124:127], a[188:191], v[188:191], v[124:127]
    s_waitcnt vmcnt(25)
    s_waitcnt lgkmcnt(13)
    ds_read_b64_tr_b16 a[238:239], v24 offset:61440
    v_and_b32 v240, 2, v240
    v_mfma_f32_16x16x32_bf16 v[64:67], a[208:211], a[64:67], v[64:67]
    s_waitcnt vmcnt(24)
    s_waitcnt lgkmcnt(12)
    buffer_load_dwordx4 v48, s[20:23], s49 offen offset:2048 lds
    v_mfma_f32_16x16x32_bf16 v[64:67], a[212:215], a[68:71], v[64:67]
    s_waitcnt vmcnt(24)
    s_waitcnt lgkmcnt(10)
    ds_read_b64_tr_b16 a[160:161], v21 offset:32768
    ds_read_b64_tr_b16 a[162:163], v21 offset:36864
    v_mfma_f32_16x16x32_bf16 v[64:67], a[216:219], a[72:75], v[64:67]
    s_waitcnt vmcnt(23)
    s_waitcnt lgkmcnt(10)
    buffer_load_dwordx4 v49, s[20:23], s49 offen offset:3072 lds
    v_mfma_f32_16x16x32_bf16 v[64:67], a[220:223], a[76:79], v[64:67]
    s_waitcnt vmcnt(23)
    s_waitcnt lgkmcnt(8)
    ds_read_b64_tr_b16 a[164:165], v21 offset:40960
    ds_read_b64_tr_b16 a[166:167], v21 offset:45056
    v_mfma_f32_16x16x32_bf16 v[64:67], a[224:227], a[80:83], v[64:67]
    s_waitcnt vmcnt(20)
    s_waitcnt lgkmcnt(8)
    ds_read_b64_tr_b16 a[168:169], v21 offset:49152
    v_bfe_u32 v241, v1, 2, 2
    v_mfma_f32_16x16x32_bf16 v[64:67], a[228:231], a[84:87], v[64:67]
    s_waitcnt vmcnt(17)
    s_waitcnt lgkmcnt(7)
    ds_read_b64_tr_b16 a[170:171], v21 offset:53248
    v_cmp_eq_u32 s[54:55], v240, v241
    v_mfma_f32_16x16x32_bf16 v[64:67], a[232:235], a[88:91], v[64:67]
    s_waitcnt vmcnt(14)
    s_waitcnt lgkmcnt(6)
    s_add_u32 s49, s7, 74240
    ds_read_b64_tr_b16 a[172:173], v21 offset:57344
    v_or_b32 v240, 1, v240
    v_mfma_f32_16x16x32_bf16 v[64:67], a[236:239], a[92:95], v[64:67]
    s_waitcnt vmcnt(11)
    s_add_u32 m0, s42, 81920
    ds_read_b64_tr_b16 a[174:175], v21 offset:61440
    v_cmp_eq_u32 s[36:37], v240, v241
    v_mfma_f32_16x16x32_bf16 v[68:71], a[208:211], a[96:99], v[68:71]
    s_waitcnt vmcnt(10)
    buffer_load_dwordx4 v46, s[20:23], s49 offen lds
    v_mfma_f32_16x16x32_bf16 v[68:71], a[212:215], a[100:103], v[68:71]
    s_waitcnt vmcnt(10)
    ds_read_b64_tr_b16 a[176:177], v25 offset:32768
    ds_read_b64_tr_b16 a[178:179], v25 offset:36864
    v_mfma_f32_16x16x32_bf16 v[68:71], a[216:219], a[104:107], v[68:71]
    s_waitcnt vmcnt(9)
    buffer_load_dwordx4 v47, s[20:23], s49 offen offset:1024 lds
    v_mfma_f32_16x16x32_bf16 v[68:71], a[220:223], a[108:111], v[68:71]
    s_waitcnt vmcnt(9)
    ds_read_b64_tr_b16 a[180:181], v25 offset:40960
    ds_read_b64_tr_b16 a[182:183], v25 offset:45056
    v_mfma_f32_16x16x32_bf16 v[68:71], a[224:227], a[112:115], v[68:71]
    s_waitcnt vmcnt(8)
    ds_read_b64_tr_b16 a[184:185], v25 offset:49152
    v_cvt_pk_bf16_f32 v224, v64, v65
    v_mfma_f32_16x16x32_bf16 v[68:71], a[228:231], a[116:119], v[68:71]
    s_waitcnt vmcnt(7)
    ds_read_b64_tr_b16 a[186:187], v25 offset:53248
    v_cvt_pk_bf16_f32 v225, v66, v67
    v_mfma_f32_16x16x32_bf16 v[68:71], a[232:235], a[120:123], v[68:71]
    s_waitcnt vmcnt(6)
    buffer_load_dwordx2 v[36:37], v4, s[12:15], 0 offen offset:0
    v_mfma_f32_16x16x32_bf16 v[68:71], a[236:239], a[124:127], v[68:71]
    s_waitcnt lgkmcnt(12)
    ds_read_b64_tr_b16 a[188:189], v25 offset:57344
    ds_read_b64_tr_b16 a[190:191], v25 offset:61440
    v_mfma_f32_16x16x32_bf16 v[72:75], a[160:163], a[64:67], v[72:75]
    s_waitcnt lgkmcnt(12)
    buffer_load_dwordx4 v48, s[20:23], s49 offen offset:2048 lds
    v_mfma_f32_16x16x32_bf16 v[72:75], a[164:167], a[68:71], v[72:75]
    s_waitcnt lgkmcnt(10)
    ds_read_b64_tr_b16 a[208:209], v22 offset:32768
    ds_read_b64_tr_b16 a[210:211], v22 offset:36864
    v_mfma_f32_16x16x32_bf16 v[72:75], a[168:171], a[72:75], v[72:75]
    s_waitcnt lgkmcnt(10)
    buffer_load_dwordx4 v49, s[20:23], s49 offen offset:3072 lds
    v_mfma_f32_16x16x32_bf16 v[72:75], a[172:175], a[76:79], v[72:75]
    s_waitcnt lgkmcnt(8)
    ds_read_b64_tr_b16 a[212:213], v22 offset:40960
    ds_read_b64_tr_b16 a[214:215], v22 offset:45056
    v_mfma_f32_16x16x32_bf16 v[72:75], a[176:179], a[80:83], v[72:75]
    s_waitcnt lgkmcnt(8)
    ds_read_b64_tr_b16 a[216:217], v22 offset:49152
    v_cvt_pk_bf16_f32 v228, v68, v69
    v_mfma_f32_16x16x32_bf16 v[72:75], a[180:183], a[84:87], v[72:75]
    s_waitcnt lgkmcnt(7)
    ds_read_b64_tr_b16 a[218:219], v22 offset:53248
    v_cvt_pk_bf16_f32 v229, v70, v71
    v_mfma_f32_16x16x32_bf16 v[72:75], a[184:187], a[88:91], v[72:75]
    s_waitcnt lgkmcnt(6)
    ds_read_b64_tr_b16 a[220:221], v22 offset:57344
    v_and_b32 v240, 1, v1
    v_mfma_f32_16x16x32_bf16 v[72:75], a[188:191], a[92:95], v[72:75]
    ds_read_b64_tr_b16 a[222:223], v22 offset:61440
    v_lshlrev_b32 v240, 4, v240
    v_mfma_f32_16x16x32_bf16 v[76:79], a[160:163], a[96:99], v[76:79]
    buffer_load_dwordx2 v[38:39], v4, s[12:15], 0 offen offset:32
    v_mfma_f32_16x16x32_bf16 v[76:79], a[164:167], a[100:103], v[76:79]
    ds_read_b64_tr_b16 a[224:225], v26 offset:32768
    ds_read_b64_tr_b16 a[226:227], v26 offset:36864
    v_mfma_f32_16x16x32_bf16 v[76:79], a[168:171], a[104:107], v[76:79]
    ds_read_b64_tr_b16 a[228:229], v26 offset:40960
    v_mov_b32 v241, 0x3f80
    v_mfma_f32_16x16x32_bf16 v[76:79], a[172:175], a[108:111], v[76:79]
    ds_read_b64_tr_b16 a[230:231], v26 offset:45056
    v_lshlrev_b32 v240, v240, v241
    v_mfma_f32_16x16x32_bf16 v[76:79], a[176:179], a[112:115], v[76:79]
    ds_read_b64_tr_b16 a[232:233], v26 offset:49152
    v_cvt_pk_bf16_f32 v226, v72, v73
    v_mfma_f32_16x16x32_bf16 v[76:79], a[180:183], a[116:119], v[76:79]
    s_add_u32 s38, s93, 0
    ds_read_b64_tr_b16 a[234:235], v26 offset:53248
    v_cvt_pk_bf16_f32 v227, v74, v75
    v_mfma_f32_16x16x32_bf16 v[76:79], a[184:187], a[120:123], v[76:79]
    buffer_store_dwordx4 v[224:227], v56, s[28:31], s38 offen sc1
    v_mfma_f32_16x16x32_bf16 v[76:79], a[188:191], a[124:127], v[76:79]
    s_waitcnt lgkmcnt(12)
    ds_read_b64_tr_b16 a[236:237], v26 offset:57344
    ds_read_b64_tr_b16 a[238:239], v26 offset:61440
    v_mfma_f32_16x16x32_bf16 v[80:83], a[208:211], a[64:67], v[80:83]
    s_waitcnt lgkmcnt(12)
    ds_read_b64_tr_b16 a[160:161], v23 offset:32768
    v_bfe_i32 v241, v1, 1, 1
    v_mfma_f32_16x16x32_bf16 v[80:83], a[212:215], a[68:71], v[80:83]
    s_waitcnt lgkmcnt(11)
    ds_read_b64_tr_b16 a[162:163], v23 offset:36864
    v_and_b32 v243, v240, v241
    v_mfma_f32_16x16x32_bf16 v[80:83], a[216:219], a[72:75], v[80:83]
    s_waitcnt lgkmcnt(10)
    buffer_load_dwordx2 v[40:41], v4, s[12:15], 0 offen offset:512
    v_mfma_f32_16x16x32_bf16 v[80:83], a[220:223], a[76:79], v[80:83]
    s_waitcnt lgkmcnt(8)
    ds_read_b64_tr_b16 a[164:165], v23 offset:40960
    ds_read_b64_tr_b16 a[166:167], v23 offset:45056
    v_mfma_f32_16x16x32_bf16 v[80:83], a[224:227], a[80:83], v[80:83]
    s_waitcnt lgkmcnt(8)
    ds_read_b64_tr_b16 a[168:169], v23 offset:49152
    v_cvt_pk_bf16_f32 v230, v76, v77
    v_mfma_f32_16x16x32_bf16 v[80:83], a[228:231], a[84:87], v[80:83]
    s_waitcnt lgkmcnt(7)
    s_add_u32 s38, s93, 163840
    ds_read_b64_tr_b16 a[170:171], v23 offset:53248
    v_cvt_pk_bf16_f32 v231, v78, v79
    v_mfma_f32_16x16x32_bf16 v[80:83], a[232:235], a[88:91], v[80:83]
    s_waitcnt lgkmcnt(6)
    buffer_store_dwordx4 v[228:231], v56, s[28:31], s38 offen sc1
    v_mfma_f32_16x16x32_bf16 v[80:83], a[236:239], a[92:95], v[80:83]
    ds_read_b64_tr_b16 a[172:173], v23 offset:57344
    ds_read_b64_tr_b16 a[174:175], v23 offset:61440
    v_mfma_f32_16x16x32_bf16 v[84:87], a[208:211], a[96:99], v[84:87]
    ds_read_b64_tr_b16 a[176:177], v27 offset:32768
    v_xor_b32 v242, v240, v243
    v_mfma_f32_16x16x32_bf16 v[84:87], a[212:215], a[100:103], v[84:87]
    ds_read_b64_tr_b16 a[178:179], v27 offset:36864
    v_cndmask_b32 v246, 0, v242, s[54:55]
    v_mfma_f32_16x16x32_bf16 v[84:87], a[216:219], a[104:107], v[84:87]
    ds_read_b64_tr_b16 a[180:181], v27 offset:40960
    v_cndmask_b32 v247, 0, v243, s[54:55]
    v_mfma_f32_16x16x32_bf16 v[84:87], a[220:223], a[108:111], v[84:87]
    ds_read_b64_tr_b16 a[182:183], v27 offset:45056
    v_cndmask_b32 v250, 0, v242, s[36:37]
    v_mfma_f32_16x16x32_bf16 v[84:87], a[224:227], a[112:115], v[84:87]
    ds_read_b64_tr_b16 a[184:185], v27 offset:49152
    v_cvt_pk_bf16_f32 v232, v80, v81
    v_mfma_f32_16x16x32_bf16 v[84:87], a[228:231], a[116:119], v[84:87]
    ds_read_b64_tr_b16 a[186:187], v27 offset:53248
    v_cvt_pk_bf16_f32 v233, v82, v83
    v_mfma_f32_16x16x32_bf16 v[84:87], a[232:235], a[120:123], v[84:87]
    buffer_load_dwordx2 v[42:43], v4, s[12:15], 0 offen offset:544
    v_mfma_f32_16x16x32_bf16 v[84:87], a[236:239], a[124:127], v[84:87]
    s_waitcnt lgkmcnt(12)
    ds_read_b64_tr_b16 a[188:189], v27 offset:57344
    ds_read_b64_tr_b16 a[190:191], v27 offset:61440
    s_barrier
    v_mfma_f32_16x16x32_bf16 v[88:91], a[160:163], a[64:67], v[88:91]
    s_waitcnt lgkmcnt(12)
    ds_read_b64_tr_b16 a[208:209], v12 offset:0
    v_cndmask_b32 v251, 0, v243, s[36:37]
    v_mfma_f32_16x16x32_bf16 v[88:91], a[164:167], a[68:71], v[88:91]
    s_waitcnt lgkmcnt(11)
    ds_read_b64_tr_b16 a[210:211], v12 offset:4096
    v_mov_b32 v240, 0
    v_mfma_f32_16x16x32_bf16 v[88:91], a[168:171], a[72:75], v[88:91]
    s_waitcnt lgkmcnt(10)
    ds_read_b64_tr_b16 a[212:213], v12 offset:8192
    v_mov_b32 v241, 0
    v_mfma_f32_16x16x32_bf16 v[88:91], a[172:175], a[76:79], v[88:91]
    s_waitcnt lgkmcnt(9)
    ds_read_b64_tr_b16 a[214:215], v12 offset:12288
    v_mov_b32 v244, 0
    v_mfma_f32_16x16x32_bf16 v[88:91], a[176:179], a[80:83], v[88:91]
    s_waitcnt lgkmcnt(8)
    ds_read_b64_tr_b16 a[216:217], v12 offset:16384
    v_cvt_pk_bf16_f32 v236, v84, v85
    v_mfma_f32_16x16x32_bf16 v[88:91], a[180:183], a[84:87], v[88:91]
    s_waitcnt lgkmcnt(7)
    ds_read_b64_tr_b16 a[218:219], v12 offset:20480
    v_cvt_pk_bf16_f32 v237, v86, v87
    v_mfma_f32_16x16x32_bf16 v[88:91], a[184:187], a[88:91], v[88:91]
    s_waitcnt lgkmcnt(6)
    s_add_u32 s49, s46, 512
    ds_read_b64_tr_b16 a[220:221], v12 offset:24576
    v_mov_b32 v245, 0
    v_mfma_f32_16x16x32_bf16 v[88:91], a[188:191], a[92:95], v[88:91]
    s_add_u32 m0, s42, 32768
    ds_read_b64_tr_b16 a[222:223], v12 offset:28672
    v_mov_b32 v248, 0
    v_mfma_f32_16x16x32_bf16 v[92:95], a[160:163], a[96:99], v[92:95]
    buffer_load_dwordx4 v46, s[20:23], s49 offen lds
    v_mfma_f32_16x16x32_bf16 v[92:95], a[164:167], a[100:103], v[92:95]
    ds_read_b64_tr_b16 a[224:225], v16 offset:0
    ds_read_b64_tr_b16 a[226:227], v16 offset:4096
    v_mfma_f32_16x16x32_bf16 v[92:95], a[168:171], a[104:107], v[92:95]
    buffer_load_dwordx4 v47, s[20:23], s49 offen offset:1024 lds
    v_mfma_f32_16x16x32_bf16 v[92:95], a[172:175], a[108:111], v[92:95]
    ds_read_b64_tr_b16 a[228:229], v16 offset:8192
    ds_read_b64_tr_b16 a[230:231], v16 offset:12288
    v_mfma_f32_16x16x32_bf16 v[92:95], a[176:179], a[112:115], v[92:95]
    ds_read_b64_tr_b16 a[232:233], v16 offset:16384
    v_cvt_pk_bf16_f32 v234, v88, v89
    v_mfma_f32_16x16x32_bf16 v[92:95], a[180:183], a[116:119], v[92:95]
    s_add_u32 s38, s93, 128
    ds_read_b64_tr_b16 a[234:235], v16 offset:20480
    v_cvt_pk_bf16_f32 v235, v90, v91
    v_mfma_f32_16x16x32_bf16 v[92:95], a[184:187], a[120:123], v[92:95]
    buffer_store_dwordx4 v[232:235], v56, s[28:31], s38 offen sc1
    v_mfma_f32_16x16x32_bf16 v[92:95], a[188:191], a[124:127], v[92:95]
    s_waitcnt lgkmcnt(12)
    ds_read_b64_tr_b16 a[236:237], v16 offset:24576
    ds_read_b64_tr_b16 a[238:239], v16 offset:28672
    v_mfma_f32_16x16x32_bf16 v[96:99], a[208:211], a[64:67], v[96:99]
    s_waitcnt lgkmcnt(12)
    buffer_load_dwordx4 v48, s[20:23], s49 offen offset:2048 lds
    v_mfma_f32_16x16x32_bf16 v[96:99], a[212:215], a[68:71], v[96:99]
    s_waitcnt lgkmcnt(10)
    ds_read_b64_tr_b16 a[160:161], v13 offset:0
    ds_read_b64_tr_b16 a[162:163], v13 offset:4096
    v_mfma_f32_16x16x32_bf16 v[96:99], a[216:219], a[72:75], v[96:99]
    s_waitcnt lgkmcnt(10)
    buffer_load_dwordx4 v49, s[20:23], s49 offen offset:3072 lds
    v_mfma_f32_16x16x32_bf16 v[96:99], a[220:223], a[76:79], v[96:99]
    s_waitcnt lgkmcnt(8)
    ds_read_b64_tr_b16 a[164:165], v13 offset:8192
    ds_read_b64_tr_b16 a[166:167], v13 offset:12288
    v_mfma_f32_16x16x32_bf16 v[96:99], a[224:227], a[80:83], v[96:99]
    s_waitcnt lgkmcnt(8)
    ds_read_b64_tr_b16 a[168:169], v13 offset:16384
    v_cvt_pk_bf16_f32 v238, v92, v93
    v_mfma_f32_16x16x32_bf16 v[96:99], a[228:231], a[84:87], v[96:99]
    s_waitcnt lgkmcnt(7)
    s_add_u32 s38, s93, 163968
    ds_read_b64_tr_b16 a[170:171], v13 offset:20480
    v_cvt_pk_bf16_f32 v239, v94, v95
    v_mfma_f32_16x16x32_bf16 v[96:99], a[232:235], a[88:91], v[96:99]
    s_waitcnt lgkmcnt(6)
    s_add_u32 s49, s46, 74240
    buffer_store_dwordx4 v[236:239], v56, s[28:31], s38 offen sc1
    v_mfma_f32_16x16x32_bf16 v[96:99], a[236:239], a[92:95], v[96:99]
    s_add_u32 m0, s42, 49152
    ds_read_b64_tr_b16 a[172:173], v13 offset:24576
    ds_read_b64_tr_b16 a[174:175], v13 offset:28672
    v_mfma_f32_16x16x32_bf16 v[100:103], a[208:211], a[96:99], v[100:103]
    buffer_load_dwordx4 v46, s[20:23], s49 offen lds
    v_mfma_f32_16x16x32_bf16 v[100:103], a[212:215], a[100:103], v[100:103]
    ds_read_b64_tr_b16 a[176:177], v17 offset:0
    ds_read_b64_tr_b16 a[178:179], v17 offset:4096
    v_mfma_f32_16x16x32_bf16 v[100:103], a[216:219], a[104:107], v[100:103]
    buffer_load_dwordx4 v47, s[20:23], s49 offen offset:1024 lds
    v_mfma_f32_16x16x32_bf16 v[100:103], a[220:223], a[108:111], v[100:103]
    ds_read_b64_tr_b16 a[180:181], v17 offset:8192
    ds_read_b64_tr_b16 a[182:183], v17 offset:12288
    v_mfma_f32_16x16x32_bf16 v[100:103], a[224:227], a[112:115], v[100:103]
    ds_read_b64_tr_b16 a[184:185], v17 offset:16384
    v_cvt_pk_bf16_f32 v224, v96, v97
    v_mfma_f32_16x16x32_bf16 v[100:103], a[228:231], a[116:119], v[100:103]
    ds_read_b64_tr_b16 a[186:187], v17 offset:20480
    v_cvt_pk_bf16_f32 v225, v98, v99
    v_mfma_f32_16x16x32_bf16 v[100:103], a[232:235], a[120:123], v[100:103]
    ds_read_b64_tr_b16 a[188:189], v17 offset:24576
    v_mov_b32 v249, 0
    v_mfma_f32_16x16x32_bf16 v[100:103], a[236:239], a[124:127], v[100:103]
    s_waitcnt lgkmcnt(13)
    ds_read_b64_tr_b16 a[190:191], v17 offset:28672
    v_mov_b32 v252, 0
    v_mfma_f32_16x16x32_bf16 v[104:107], a[160:163], a[64:67], v[104:107]
    s_waitcnt lgkmcnt(12)
    buffer_load_dwordx4 v48, s[20:23], s49 offen offset:2048 lds
    v_mfma_f32_16x16x32_bf16 v[104:107], a[164:167], a[68:71], v[104:107]
    s_waitcnt lgkmcnt(10)
    ds_read_b64_tr_b16 a[208:209], v14 offset:0
    ds_read_b64_tr_b16 a[210:211], v14 offset:4096
    v_mfma_f32_16x16x32_bf16 v[104:107], a[168:171], a[72:75], v[104:107]
    s_waitcnt lgkmcnt(10)
    buffer_load_dwordx4 v49, s[20:23], s49 offen offset:3072 lds
    v_mfma_f32_16x16x32_bf16 v[104:107], a[172:175], a[76:79], v[104:107]
    s_waitcnt lgkmcnt(8)
    ds_read_b64_tr_b16 a[212:213], v14 offset:8192
    ds_read_b64_tr_b16 a[214:215], v14 offset:12288
    v_mfma_f32_16x16x32_bf16 v[104:107], a[176:179], a[80:83], v[104:107]
    s_waitcnt lgkmcnt(8)
    ds_read_b64_tr_b16 a[216:217], v14 offset:16384
    v_cvt_pk_bf16_f32 v228, v100, v101
    v_mfma_f32_16x16x32_bf16 v[104:107], a[180:183], a[84:87], v[104:107]
    s_waitcnt lgkmcnt(7)
    ds_read_b64_tr_b16 a[218:219], v14 offset:20480
    v_cvt_pk_bf16_f32 v229, v102, v103
    v_mfma_f32_16x16x32_bf16 v[104:107], a[184:187], a[88:91], v[104:107]
    s_waitcnt lgkmcnt(6)
    ds_read_b64_tr_b16 a[220:221], v14 offset:24576
    v_mov_b32 v253, 0
    v_mfma_f32_16x16x32_bf16 v[104:107], a[188:191], a[92:95], v[104:107]
    ds_read_b64_tr_b16 a[222:223], v14 offset:28672
    v_mfma_f32_16x16x32_bf16 v[108:111], a[160:163], a[96:99], v[108:111]
    ds_read_b64_tr_b16 a[224:225], v18 offset:0
    v_mfma_f32_16x16x32_bf16 v[108:111], a[164:167], a[100:103], v[108:111]
    ds_read_b64_tr_b16 a[226:227], v18 offset:4096
    v_mfma_f32_16x16x32_bf16 v[108:111], a[168:171], a[104:107], v[108:111]
    ds_read_b64_tr_b16 a[228:229], v18 offset:8192
    v_mfma_f32_16x16x32_bf16 v[108:111], a[172:175], a[108:111], v[108:111]
    ds_read_b64_tr_b16 a[230:231], v18 offset:12288
    v_mfma_f32_16x16x32_bf16 v[108:111], a[176:179], a[112:115], v[108:111]
    ds_read_b64_tr_b16 a[232:233], v18 offset:16384
    v_cvt_pk_bf16_f32 v226, v104, v105
    v_mfma_f32_16x16x32_bf16 v[108:111], a[180:183], a[116:119], v[108:111]
    s_add_u32 s38, s93, 512
    ds_read_b64_tr_b16 a[234:235], v18 offset:20480
    v_cvt_pk_bf16_f32 v227, v106, v107
    v_mfma_f32_16x16x32_bf16 v[108:111], a[184:187], a[120:123], v[108:111]
    buffer_store_dwordx4 v[224:227], v56, s[28:31], s38 offen sc1
    v_mfma_f32_16x16x32_bf16 v[108:111], a[188:191], a[124:127], v[108:111]
    s_waitcnt lgkmcnt(12)
    ds_read_b64_tr_b16 a[236:237], v18 offset:24576
    ds_read_b64_tr_b16 a[238:239], v18 offset:28672
    v_mfma_f32_16x16x32_bf16 v[112:115], a[208:211], a[64:67], v[112:115]
    s_waitcnt lgkmcnt(12)
    ds_read_b64_tr_b16 a[160:161], v15 offset:0
    v_mfma_f32_16x16x32_bf16 v[112:115], a[212:215], a[68:71], v[112:115]
    s_waitcnt lgkmcnt(11)
    ds_read_b64_tr_b16 a[162:163], v15 offset:4096
    v_mfma_f32_16x16x32_bf16 v[112:115], a[216:219], a[72:75], v[112:115]
    s_waitcnt lgkmcnt(10)
    ds_read_b64_tr_b16 a[164:165], v15 offset:8192
    v_mfma_f32_16x16x32_bf16 v[112:115], a[220:223], a[76:79], v[112:115]
    s_waitcnt lgkmcnt(9)
    ds_read_b64_tr_b16 a[166:167], v15 offset:12288
    v_mfma_f32_16x16x32_bf16 v[112:115], a[224:227], a[80:83], v[112:115]
    s_waitcnt lgkmcnt(8)
    ds_read_b64_tr_b16 a[168:169], v15 offset:16384
    v_cvt_pk_bf16_f32 v230, v108, v109
    v_mfma_f32_16x16x32_bf16 v[112:115], a[228:231], a[84:87], v[112:115]
    s_waitcnt lgkmcnt(7)
    s_add_u32 s38, s93, 164352
    ds_read_b64_tr_b16 a[170:171], v15 offset:20480
    v_cvt_pk_bf16_f32 v231, v110, v111
    v_mfma_f32_16x16x32_bf16 v[112:115], a[232:235], a[88:91], v[112:115]
    s_waitcnt lgkmcnt(6)
    buffer_store_dwordx4 v[228:231], v56, s[28:31], s38 offen sc1
    v_mfma_f32_16x16x32_bf16 v[112:115], a[236:239], a[92:95], v[112:115]
    ds_read_b64_tr_b16 a[172:173], v15 offset:24576
    ds_read_b64_tr_b16 a[174:175], v15 offset:28672
    v_mfma_f32_16x16x32_bf16 v[116:119], a[208:211], a[96:99], v[116:119]
    ds_read_b64_tr_b16 a[176:177], v19 offset:0
    v_mfma_f32_16x16x32_bf16 v[116:119], a[212:215], a[100:103], v[116:119]
    ds_read_b64_tr_b16 a[178:179], v19 offset:4096
    v_mfma_f32_16x16x32_bf16 v[116:119], a[216:219], a[104:107], v[116:119]
    ds_read_b64_tr_b16 a[180:181], v19 offset:8192
    v_mfma_f32_16x16x32_bf16 v[116:119], a[220:223], a[108:111], v[116:119]
    ds_read_b64_tr_b16 a[182:183], v19 offset:12288
    v_mfma_f32_16x16x32_bf16 v[116:119], a[224:227], a[112:115], v[116:119]
    ds_read_b64_tr_b16 a[184:185], v19 offset:16384
    v_cvt_pk_bf16_f32 v232, v112, v113
    v_mfma_f32_16x16x32_bf16 v[116:119], a[228:231], a[116:119], v[116:119]
    ds_read_b64_tr_b16 a[186:187], v19 offset:20480
    v_cvt_pk_bf16_f32 v233, v114, v115
    v_mfma_f32_16x16x32_bf16 v[116:119], a[232:235], a[120:123], v[116:119]
    ds_read_b64_tr_b16 a[188:189], v19 offset:24576
    v_mfma_f32_16x16x32_bf16 v[116:119], a[236:239], a[124:127], v[116:119]
    s_waitcnt lgkmcnt(13)
    ds_read_b64_tr_b16 a[190:191], v19 offset:28672
    s_waitcnt vmcnt(17)
    s_barrier
    v_mfma_f32_16x16x32_bf16 v[120:123], a[160:163], a[64:67], v[120:123]
    s_waitcnt lgkmcnt(12)
    ds_read_b64_tr_b16 a[208:209], v20 offset:0
    v_mfma_f32_16x16x32_bf16 v[120:123], a[164:167], a[68:71], v[120:123]
    s_waitcnt lgkmcnt(11)
    ds_read_b64_tr_b16 a[210:211], v20 offset:4096
    v_mfma_f32_16x16x32_bf16 v[120:123], a[168:171], a[72:75], v[120:123]
    s_waitcnt lgkmcnt(10)
    ds_read_b64_tr_b16 a[212:213], v20 offset:8192
    v_mfma_f32_16x16x32_bf16 v[120:123], a[172:175], a[76:79], v[120:123]
    s_waitcnt lgkmcnt(9)
    ds_read_b64_tr_b16 a[214:215], v20 offset:12288
    v_mfma_f32_16x16x32_bf16 v[120:123], a[176:179], a[80:83], v[120:123]
    s_waitcnt lgkmcnt(8)
    ds_read_b64_tr_b16 a[216:217], v20 offset:16384
    v_cvt_pk_bf16_f32 v236, v116, v117
    v_mfma_f32_16x16x32_bf16 v[120:123], a[180:183], a[84:87], v[120:123]
    s_waitcnt lgkmcnt(7)
    ds_read_b64_tr_b16 a[218:219], v20 offset:20480
    v_cvt_pk_bf16_f32 v237, v118, v119
    v_mfma_f32_16x16x32_bf16 v[120:123], a[184:187], a[88:91], v[120:123]
    s_waitcnt lgkmcnt(6)
    s_add_u32 s49, s7, 768
    ds_read_b64_tr_b16 a[220:221], v20 offset:24576
    v_mfma_f32_16x16x32_bf16 v[120:123], a[188:191], a[92:95], v[120:123]
    s_add_u32 m0, s42, 98304
    ds_read_b64_tr_b16 a[222:223], v20 offset:28672
    v_mfma_f32_16x16x32_bf16 v[124:127], a[160:163], a[96:99], v[124:127]
    buffer_load_dwordx4 v46, s[20:23], s49 offen lds
    v_mfma_f32_16x16x32_bf16 v[124:127], a[164:167], a[100:103], v[124:127]
    ds_read_b64_tr_b16 a[224:225], v24 offset:0
    ds_read_b64_tr_b16 a[226:227], v24 offset:4096
    v_mfma_f32_16x16x32_bf16 v[124:127], a[168:171], a[104:107], v[124:127]
    buffer_load_dwordx4 v47, s[20:23], s49 offen offset:1024 lds
    v_mfma_f32_16x16x32_bf16 v[124:127], a[172:175], a[108:111], v[124:127]
    ds_read_b64_tr_b16 a[228:229], v24 offset:8192
    ds_read_b64_tr_b16 a[230:231], v24 offset:12288
    v_mfma_f32_16x16x32_bf16 v[124:127], a[176:179], a[112:115], v[124:127]
    ds_read_b64_tr_b16 a[232:233], v24 offset:16384
    v_cvt_pk_bf16_f32 v234, v120, v121
    v_mfma_f32_16x16x32_bf16 v[124:127], a[180:183], a[116:119], v[124:127]
    s_add_u32 s38, s93, 640
    ds_read_b64_tr_b16 a[234:235], v24 offset:20480
    v_cvt_pk_bf16_f32 v235, v122, v123
    v_mfma_f32_16x16x32_bf16 v[124:127], a[184:187], a[120:123], v[124:127]
    buffer_store_dwordx4 v[232:235], v56, s[28:31], s38 offen sc1
    v_mfma_f32_16x16x32_bf16 v[124:127], a[188:191], a[124:127], v[124:127]
    s_waitcnt lgkmcnt(12)
    ds_read_b64_tr_b16 a[236:237], v24 offset:24576
    ds_read_b64_tr_b16 a[238:239], v24 offset:28672
    v_mfma_f32_16x16x32_bf16 v[64:67], a[208:211], v[128:131], 0
    s_waitcnt lgkmcnt(12)
    buffer_load_dwordx4 v48, s[20:23], s49 offen offset:2048 lds
    v_mfma_f32_16x16x32_bf16 v[64:67], a[212:215], v[132:135], v[64:67]
    s_waitcnt lgkmcnt(10)
    ds_read_b64_tr_b16 a[160:161], v21 offset:0
    ds_read_b64_tr_b16 a[162:163], v21 offset:4096
    v_mfma_f32_16x16x32_bf16 v[64:67], a[216:219], v[136:139], v[64:67]
    s_waitcnt lgkmcnt(10)
    buffer_load_dwordx4 v49, s[20:23], s49 offen offset:3072 lds
    v_mfma_f32_16x16x32_bf16 v[64:67], a[220:223], v[140:143], v[64:67]
    s_waitcnt lgkmcnt(8)
    ds_read_b64_tr_b16 a[164:165], v21 offset:8192
    ds_read_b64_tr_b16 a[166:167], v21 offset:12288
    v_mfma_f32_16x16x32_bf16 v[64:67], a[224:227], v[144:147], v[64:67]
    s_waitcnt lgkmcnt(8)
    ds_read_b64_tr_b16 a[168:169], v21 offset:16384
    v_cvt_pk_bf16_f32 v238, v124, v125
    v_mfma_f32_16x16x32_bf16 v[64:67], a[228:231], v[148:151], v[64:67]
    s_waitcnt lgkmcnt(7)
    s_add_u32 s38, s93, 164480
    ds_read_b64_tr_b16 a[170:171], v21 offset:20480
    v_cvt_pk_bf16_f32 v239, v126, v127
    v_mfma_f32_16x16x32_bf16 v[64:67], a[232:235], v[152:155], v[64:67]
    s_waitcnt lgkmcnt(6)
    s_add_u32 s49, s7, 74496
    buffer_store_dwordx4 v[236:239], v56, s[28:31], s38 offen sc1
    v_mfma_f32_16x16x32_bf16 v[64:67], a[236:239], v[156:159], v[64:67]
    s_add_u32 m0, s42, 114688
    ds_read_b64_tr_b16 a[172:173], v21 offset:24576
    ds_read_b64_tr_b16 a[174:175], v21 offset:28672
    v_mfma_f32_16x16x32_bf16 v[68:71], a[208:211], v[160:163], 0
    buffer_load_dwordx4 v46, s[20:23], s49 offen lds
    v_mfma_f32_16x16x32_bf16 v[68:71], a[212:215], v[164:167], v[68:71]
    ds_read_b64_tr_b16 a[176:177], v25 offset:0
    ds_read_b64_tr_b16 a[178:179], v25 offset:4096
    v_mfma_f32_16x16x32_bf16 v[68:71], a[216:219], v[168:171], v[68:71]
    buffer_load_dwordx4 v47, s[20:23], s49 offen offset:1024 lds
    v_mfma_f32_16x16x32_bf16 v[68:71], a[220:223], v[172:175], v[68:71]
    ds_read_b64_tr_b16 a[180:181], v25 offset:8192
    ds_read_b64_tr_b16 a[182:183], v25 offset:12288
    v_mfma_f32_16x16x32_bf16 v[68:71], a[224:227], v[176:179], v[68:71]
    ds_read_b64_tr_b16 a[184:185], v25 offset:16384
    v_mfma_f32_16x16x32_bf16 v[68:71], a[228:231], v[180:183], v[68:71]
    ds_read_b64_tr_b16 a[186:187], v25 offset:20480
    v_mfma_f32_16x16x32_bf16 v[68:71], a[232:235], v[184:187], v[68:71]
    ds_read_b64_tr_b16 a[188:189], v25 offset:24576
    v_mfma_f32_16x16x32_bf16 v[68:71], a[236:239], v[188:191], v[68:71]
    s_waitcnt lgkmcnt(13)
    ds_read_b64_tr_b16 a[190:191], v25 offset:28672
    v_mfma_f32_16x16x32_bf16 v[72:75], a[160:163], v[128:131], 0
    s_waitcnt lgkmcnt(12)
    buffer_load_dwordx4 v48, s[20:23], s49 offen offset:2048 lds
    v_mfma_f32_16x16x32_bf16 v[72:75], a[164:167], v[132:135], v[72:75]
    s_waitcnt lgkmcnt(10)
    ds_read_b64_tr_b16 a[208:209], v22 offset:0
    ds_read_b64_tr_b16 a[210:211], v22 offset:4096
    v_mfma_f32_16x16x32_bf16 v[72:75], a[168:171], v[136:139], v[72:75]
    s_waitcnt lgkmcnt(10)
    buffer_load_dwordx4 v49, s[20:23], s49 offen offset:3072 lds
    v_mfma_f32_16x16x32_bf16 v[72:75], a[172:175], v[140:143], v[72:75]
    s_waitcnt lgkmcnt(8)
    ds_read_b64_tr_b16 a[212:213], v22 offset:8192
    ds_read_b64_tr_b16 a[214:215], v22 offset:12288
    v_mfma_f32_16x16x32_bf16 v[72:75], a[176:179], v[144:147], v[72:75]
    s_waitcnt lgkmcnt(8)
    ds_read_b64_tr_b16 a[216:217], v22 offset:16384
    v_mfma_f32_16x16x32_bf16 v[72:75], a[180:183], v[148:151], v[72:75]
    s_waitcnt lgkmcnt(7)
    ds_read_b64_tr_b16 a[218:219], v22 offset:20480
    v_mfma_f32_16x16x32_bf16 v[72:75], a[184:187], v[152:155], v[72:75]
    s_waitcnt lgkmcnt(6)
    ds_read_b64_tr_b16 a[220:221], v22 offset:24576
    v_mfma_f32_16x16x32_bf16 v[72:75], a[188:191], v[156:159], v[72:75]
    ds_read_b64_tr_b16 a[222:223], v22 offset:28672
    v_mfma_f32_16x16x32_bf16 v[76:79], a[160:163], v[160:163], 0
    ds_read_b64_tr_b16 a[224:225], v26 offset:0
    v_mfma_f32_16x16x32_bf16 v[76:79], a[164:167], v[164:167], v[76:79]
Ltour10:
    s_cbranch_execz Ltour14
    ds_read_b64_tr_b16 a[226:227], v26 offset:4096
    v_mfma_f32_16x16x32_bf16 v[76:79], a[168:171], v[168:171], v[76:79]
    ds_read_b64_tr_b16 a[228:229], v26 offset:8192
    v_mfma_f32_16x16x32_bf16 v[76:79], a[172:175], v[172:175], v[76:79]
    ds_read_b64_tr_b16 a[230:231], v26 offset:12288
    v_mfma_f32_16x16x32_bf16 v[76:79], a[176:179], v[176:179], v[76:79]
    ds_read_b64_tr_b16 a[232:233], v26 offset:16384
    v_mfma_f32_16x16x32_bf16 v[76:79], a[180:183], v[180:183], v[76:79]
    ds_read_b64_tr_b16 a[234:235], v26 offset:20480
    v_mfma_f32_16x16x32_bf16 v[76:79], a[184:187], v[184:187], v[76:79]
    buffer_load_dword v63, v63, s[88:91], 0 offen sc1
    v_mfma_f32_16x16x32_bf16 v[76:79], a[188:191], v[188:191], v[76:79]
    s_waitcnt lgkmcnt(12)
    ds_read_b64_tr_b16 a[236:237], v26 offset:24576
    ds_read_b64_tr_b16 a[238:239], v26 offset:28672
    v_mfma_f32_16x16x32_bf16 v[80:83], a[208:211], v[128:131], 0
    s_waitcnt lgkmcnt(12)
    ds_read_b64_tr_b16 a[160:161], v23 offset:0
    v_mfma_f32_16x16x32_bf16 v[80:83], a[212:215], v[132:135], v[80:83]
    s_waitcnt lgkmcnt(11)
    ds_read_b64_tr_b16 a[162:163], v23 offset:4096
    v_mfma_f32_16x16x32_bf16 v[80:83], a[216:219], v[136:139], v[80:83]
    s_waitcnt lgkmcnt(10)
    ds_read_b64_tr_b16 a[164:165], v23 offset:8192
    v_mfma_f32_16x16x32_bf16 v[80:83], a[220:223], v[140:143], v[80:83]
    s_waitcnt lgkmcnt(9)
    ds_read_b64_tr_b16 a[166:167], v23 offset:12288
    v_mfma_f32_16x16x32_bf16 v[80:83], a[224:227], v[144:147], v[80:83]
    s_waitcnt lgkmcnt(8)
    ds_read_b64_tr_b16 a[168:169], v23 offset:16384
    v_mfma_f32_16x16x32_bf16 v[80:83], a[228:231], v[148:151], v[80:83]
    s_waitcnt lgkmcnt(7)
    ds_read_b64_tr_b16 a[170:171], v23 offset:20480
    v_mfma_f32_16x16x32_bf16 v[80:83], a[232:235], v[152:155], v[80:83]
    s_waitcnt lgkmcnt(6)
    ds_read_b64_tr_b16 a[172:173], v23 offset:24576
    v_mfma_f32_16x16x32_bf16 v[80:83], a[236:239], v[156:159], v[80:83]
    ds_read_b64_tr_b16 a[174:175], v23 offset:28672
    v_mfma_f32_16x16x32_bf16 v[84:87], a[208:211], v[160:163], 0
    ds_read_b64_tr_b16 a[176:177], v27 offset:0
    v_mfma_f32_16x16x32_bf16 v[84:87], a[212:215], v[164:167], v[84:87]
    ds_read_b64_tr_b16 a[178:179], v27 offset:4096
    v_mfma_f32_16x16x32_bf16 v[84:87], a[216:219], v[168:171], v[84:87]
    ds_read_b64_tr_b16 a[180:181], v27 offset:8192
    v_mfma_f32_16x16x32_bf16 v[84:87], a[220:223], v[172:175], v[84:87]
    ds_read_b64_tr_b16 a[182:183], v27 offset:12288
    v_mfma_f32_16x16x32_bf16 v[84:87], a[224:227], v[176:179], v[84:87]
    ds_read_b64_tr_b16 a[184:185], v27 offset:16384
    v_mfma_f32_16x16x32_bf16 v[84:87], a[228:231], v[180:183], v[84:87]
    ds_read_b64_tr_b16 a[186:187], v27 offset:20480
    v_mfma_f32_16x16x32_bf16 v[84:87], a[232:235], v[184:187], v[84:87]
    ds_read_b64_tr_b16 a[188:189], v27 offset:24576
    v_mfma_f32_16x16x32_bf16 v[84:87], a[236:239], v[188:191], v[84:87]
    s_waitcnt lgkmcnt(13)
    ds_read_b64_tr_b16 a[190:191], v27 offset:28672
    s_waitcnt vmcnt(13)
    s_barrier
    v_mfma_f32_16x16x32_bf16 v[88:91], a[160:163], v[128:131], 0
    s_waitcnt lgkmcnt(12)
    ds_read_b64_tr_b16 a[208:209], v12 offset:32768
    v_mfma_f32_16x16x32_bf16 v[88:91], a[164:167], v[132:135], v[88:91]
    s_waitcnt lgkmcnt(11)
    ds_read_b64_tr_b16 a[210:211], v12 offset:36864
    v_mfma_f32_16x16x32_bf16 v[88:91], a[168:171], v[136:139], v[88:91]
    s_waitcnt lgkmcnt(10)
    ds_read_b64_tr_b16 a[212:213], v12 offset:40960
    v_mfma_f32_16x16x32_bf16 v[88:91], a[172:175], v[140:143], v[88:91]
    s_waitcnt lgkmcnt(9)
    ds_read_b64_tr_b16 a[214:215], v12 offset:45056
    v_mfma_f32_16x16x32_bf16 v[88:91], a[176:179], v[144:147], v[88:91]
    s_waitcnt lgkmcnt(8)
    ds_read_b64_tr_b16 a[216:217], v12 offset:49152
    v_mfma_f32_16x16x32_bf16 v[88:91], a[180:183], v[148:151], v[88:91]
    s_waitcnt lgkmcnt(7)
    ds_read_b64_tr_b16 a[218:219], v12 offset:53248
    v_mfma_f32_16x16x32_bf16 v[88:91], a[184:187], v[152:155], v[88:91]
    s_waitcnt lgkmcnt(6)
    s_add_u32 s49, s46, 768
    ds_read_b64_tr_b16 a[220:221], v12 offset:57344
    v_mfma_f32_16x16x32_bf16 v[88:91], a[188:191], v[156:159], v[88:91]
    s_add_u32 m0, s42, 0
    ds_read_b64_tr_b16 a[222:223], v12 offset:61440
    v_mfma_f32_16x16x32_bf16 v[92:95], a[160:163], v[160:163], 0
    buffer_load_dwordx4 v46, s[20:23], s49 offen lds
    v_mfma_f32_16x16x32_bf16 v[92:95], a[164:167], v[164:167], v[92:95]
    ds_read_b64_tr_b16 a[224:225], v16 offset:32768
    ds_read_b64_tr_b16 a[226:227], v16 offset:36864
    v_mfma_f32_16x16x32_bf16 v[92:95], a[168:171], v[168:171], v[92:95]
    buffer_load_dwordx4 v47, s[20:23], s49 offen offset:1024 lds
    v_mfma_f32_16x16x32_bf16 v[92:95], a[172:175], v[172:175], v[92:95]
    ds_read_b64_tr_b16 a[228:229], v16 offset:40960
    ds_read_b64_tr_b16 a[230:231], v16 offset:45056
    v_mfma_f32_16x16x32_bf16 v[92:95], a[176:179], v[176:179], v[92:95]
    ds_read_b64_tr_b16 a[232:233], v16 offset:49152
    v_mfma_f32_16x16x32_bf16 v[92:95], a[180:183], v[180:183], v[92:95]
    ds_read_b64_tr_b16 a[234:235], v16 offset:53248
    v_mfma_f32_16x16x32_bf16 v[92:95], a[184:187], v[184:187], v[92:95]
    ds_read_b64_tr_b16 a[236:237], v16 offset:57344
    v_mfma_f32_16x16x32_bf16 v[92:95], a[188:191], v[188:191], v[92:95]
    s_waitcnt lgkmcnt(13)
    ds_read_b64_tr_b16 a[238:239], v16 offset:61440
    v_mfma_f32_16x16x32_bf16 v[64:67], a[208:211], a[64:67], v[64:67]
    s_waitcnt lgkmcnt(12)
    buffer_load_dwordx4 v48, s[20:23], s49 offen offset:2048 lds
    v_mfma_f32_16x16x32_bf16 v[64:67], a[212:215], a[68:71], v[64:67]
    s_waitcnt lgkmcnt(10)
    ds_read_b64_tr_b16 a[160:161], v13 offset:32768
    ds_read_b64_tr_b16 a[162:163], v13 offset:36864
    v_mfma_f32_16x16x32_bf16 v[64:67], a[216:219], a[72:75], v[64:67]
    s_waitcnt lgkmcnt(10)
    s_add_u32 s92, s92, 16
    buffer_load_dwordx4 v49, s[20:23], s49 offen offset:3072 lds
    v_mfma_f32_16x16x32_bf16 v[64:67], a[220:223], a[76:79], v[64:67]
    s_waitcnt lgkmcnt(8)
    s_waitcnt vmcnt(9)
    ds_read_b64_tr_b16 a[164:165], v13 offset:40960
    ds_read_b64_tr_b16 a[166:167], v13 offset:45056
    v_mfma_f32_16x16x32_bf16 v[64:67], a[224:227], a[80:83], v[64:67]
    s_waitcnt lgkmcnt(8)
    buffer_store_dword v10, v8, s[24:27], s92 offen sc1
    v_mfma_f32_16x16x32_bf16 v[64:67], a[228:231], a[84:87], v[64:67]
    s_waitcnt lgkmcnt(6)
    ds_read_b64_tr_b16 a[168:169], v13 offset:49152
    ds_read_b64_tr_b16 a[170:171], v13 offset:53248
    v_mfma_f32_16x16x32_bf16 v[64:67], a[232:235], a[88:91], v[64:67]
    s_waitcnt lgkmcnt(6)
    s_add_u32 s49, s46, 74496
    ds_read_b64_tr_b16 a[172:173], v13 offset:57344
    v_mfma_f32_16x16x32_bf16 v[64:67], a[236:239], a[92:95], v[64:67]
    s_add_u32 m0, s42, 16384
    ds_read_b64_tr_b16 a[174:175], v13 offset:61440
    v_mfma_f32_16x16x32_bf16 v[68:71], a[208:211], a[96:99], v[68:71]
    buffer_load_dwordx4 v46, s[20:23], s49 offen lds
    v_mfma_f32_16x16x32_bf16 v[68:71], a[212:215], a[100:103], v[68:71]
    ds_read_b64_tr_b16 a[176:177], v17 offset:32768
    ds_read_b64_tr_b16 a[178:179], v17 offset:36864
    v_mfma_f32_16x16x32_bf16 v[68:71], a[216:219], a[104:107], v[68:71]
    buffer_load_dwordx4 v47, s[20:23], s49 offen offset:1024 lds
    v_mfma_f32_16x16x32_bf16 v[68:71], a[220:223], a[108:111], v[68:71]
    ds_read_b64_tr_b16 a[180:181], v17 offset:40960
    ds_read_b64_tr_b16 a[182:183], v17 offset:45056
    v_mfma_f32_16x16x32_bf16 v[68:71], a[224:227], a[112:115], v[68:71]
    ds_read_b64_tr_b16 a[184:185], v17 offset:49152
    v_cvt_pk_bf16_f32 v224, v64, v65
    v_mfma_f32_16x16x32_bf16 v[68:71], a[228:231], a[116:119], v[68:71]
    ds_read_b64_tr_b16 a[186:187], v17 offset:53248
    v_cvt_pk_bf16_f32 v225, v66, v67
    v_mfma_f32_16x16x32_bf16 v[68:71], a[232:235], a[120:123], v[68:71]
    ds_read_b64_tr_b16 a[188:189], v17 offset:57344
    v_mfma_f32_16x16x32_bf16 v[68:71], a[236:239], a[124:127], v[68:71]
    s_waitcnt lgkmcnt(13)
    ds_read_b64_tr_b16 a[190:191], v17 offset:61440
    v_mfma_f32_16x16x32_bf16 v[72:75], a[160:163], a[64:67], v[72:75]
    s_waitcnt lgkmcnt(12)
    buffer_load_dwordx4 v48, s[20:23], s49 offen offset:2048 lds
    v_mfma_f32_16x16x32_bf16 v[72:75], a[164:167], a[68:71], v[72:75]
    s_waitcnt lgkmcnt(10)
    ds_read_b64_tr_b16 a[208:209], v14 offset:32768
    ds_read_b64_tr_b16 a[210:211], v14 offset:36864
    v_mfma_f32_16x16x32_bf16 v[72:75], a[168:171], a[72:75], v[72:75]
    s_waitcnt lgkmcnt(10)
    buffer_load_dwordx4 v49, s[20:23], s49 offen offset:3072 lds
    v_mfma_f32_16x16x32_bf16 v[72:75], a[172:175], a[76:79], v[72:75]
    s_waitcnt lgkmcnt(8)
    ds_read_b64_tr_b16 a[212:213], v14 offset:40960
    ds_read_b64_tr_b16 a[214:215], v14 offset:45056
    v_mfma_f32_16x16x32_bf16 v[72:75], a[176:179], a[80:83], v[72:75]
    s_waitcnt lgkmcnt(8)
    ds_read_b64_tr_b16 a[216:217], v14 offset:49152
    v_cvt_pk_bf16_f32 v228, v68, v69
    v_mfma_f32_16x16x32_bf16 v[72:75], a[180:183], a[84:87], v[72:75]
    s_waitcnt lgkmcnt(7)
    ds_read_b64_tr_b16 a[218:219], v14 offset:53248
    v_cvt_pk_bf16_f32 v229, v70, v71
    v_mfma_f32_16x16x32_bf16 v[72:75], a[184:187], a[88:91], v[72:75]
    s_waitcnt lgkmcnt(6)
    s_and_b32 s42, s2, 7
    ds_read_b64_tr_b16 a[220:221], v14 offset:57344
    v_mfma_f32_16x16x32_bf16 v[72:75], a[188:191], a[92:95], v[72:75]
    s_mov_b64 s[20:21], s[52:53]
    ds_read_b64_tr_b16 a[222:223], v14 offset:61440
    v_mfma_f32_16x16x32_bf16 v[76:79], a[160:163], a[96:99], v[76:79]
    ds_read_b64_tr_b16 a[224:225], v18 offset:32768
    s_waitcnt vmcnt(9)
    v_readfirstlane_b32 s37, v63
    v_mfma_f32_16x16x32_bf16 v[76:79], a[164:167], a[100:103], v[76:79]
    s_mov_b32 s22, 1152
    ds_read_b64_tr_b16 a[226:227], v18 offset:36864
    v_mfma_f32_16x16x32_bf16 v[76:79], a[168:171], a[104:107], v[76:79]
    s_mov_b32 s23, 0x20000
    ds_read_b64_tr_b16 a[228:229], v18 offset:40960
    s_cmp_lt_u32 s37, 256
    s_cbranch_scc1 Lattn_armwait
Lattn_armed:
    v_mfma_f32_16x16x32_bf16 v[76:79], a[172:175], a[108:111], v[76:79]
    ds_read_b64_tr_b16 a[230:231], v18 offset:45056
    v_mfma_f32_16x16x32_bf16 v[76:79], a[176:179], a[112:115], v[76:79]
    ds_read_b64_tr_b16 a[232:233], v18 offset:49152
    v_cvt_pk_bf16_f32 v226, v72, v73
    v_mfma_f32_16x16x32_bf16 v[76:79], a[180:183], a[116:119], v[76:79]
    s_add_u32 s38, s93, 1024
    ds_read_b64_tr_b16 a[234:235], v18 offset:53248
    v_cvt_pk_bf16_f32 v227, v74, v75
    v_mfma_f32_16x16x32_bf16 v[76:79], a[184:187], a[120:123], v[76:79]
    buffer_store_dwordx4 v[224:227], v56, s[28:31], s38 offen sc1
    v_mfma_f32_16x16x32_bf16 v[76:79], a[188:191], a[124:127], v[76:79]
    s_waitcnt lgkmcnt(12)
    s_mov_b32 s45, 18688
    ds_read_b64_tr_b16 a[236:237], v18 offset:57344
    ds_read_b64_tr_b16 a[238:239], v18 offset:61440
    v_mfma_f32_16x16x32_bf16 v[80:83], a[208:211], a[64:67], v[80:83]
    s_waitcnt lgkmcnt(12)
    buffer_load_dwordx4 v[192:195], v5, s[24:27], s45 offen offset:0 sc1
    v_mfma_f32_16x16x32_bf16 v[80:83], a[212:215], a[68:71], v[80:83]
    s_waitcnt lgkmcnt(10)
    ds_read_b64_tr_b16 a[160:161], v15 offset:32768
    ds_read_b64_tr_b16 a[162:163], v15 offset:36864
    v_mfma_f32_16x16x32_bf16 v[80:83], a[216:219], a[72:75], v[80:83]
    s_waitcnt lgkmcnt(10)
    ds_read_b64_tr_b16 a[164:165], v15 offset:40960
    v_mfma_f32_16x16x32_bf16 v[80:83], a[220:223], a[76:79], v[80:83]
    s_waitcnt lgkmcnt(9)
    ds_read_b64_tr_b16 a[166:167], v15 offset:45056
    v_mfma_f32_16x16x32_bf16 v[80:83], a[224:227], a[80:83], v[80:83]
    s_waitcnt lgkmcnt(8)
    ds_read_b64_tr_b16 a[168:169], v15 offset:49152
    v_cvt_pk_bf16_f32 v230, v76, v77
    v_mfma_f32_16x16x32_bf16 v[80:83], a[228:231], a[84:87], v[80:83]
    s_waitcnt lgkmcnt(7)
    s_add_u32 s38, s93, 164864
    ds_read_b64_tr_b16 a[170:171], v15 offset:53248
    v_cvt_pk_bf16_f32 v231, v78, v79
    v_mfma_f32_16x16x32_bf16 v[80:83], a[232:235], a[88:91], v[80:83]
    s_waitcnt lgkmcnt(6)
    buffer_store_dwordx4 v[228:231], v56, s[28:31], s38 offen sc1
    v_mfma_f32_16x16x32_bf16 v[80:83], a[236:239], a[92:95], v[80:83]
    ds_read_b64_tr_b16 a[172:173], v15 offset:57344
    ds_read_b64_tr_b16 a[174:175], v15 offset:61440
    v_mfma_f32_16x16x32_bf16 v[84:87], a[208:211], a[96:99], v[84:87]
    buffer_load_dwordx4 v[196:199], v5, s[24:27], s45 offen offset:512 sc1
    v_mfma_f32_16x16x32_bf16 v[84:87], a[212:215], a[100:103], v[84:87]
    ds_read_b64_tr_b16 a[176:177], v19 offset:32768
    ds_read_b64_tr_b16 a[178:179], v19 offset:36864
    v_mfma_f32_16x16x32_bf16 v[84:87], a[216:219], a[104:107], v[84:87]
    ds_read_b64_tr_b16 a[180:181], v19 offset:40960
    v_mfma_f32_16x16x32_bf16 v[84:87], a[220:223], a[108:111], v[84:87]
    ds_read_b64_tr_b16 a[182:183], v19 offset:45056
    v_mfma_f32_16x16x32_bf16 v[84:87], a[224:227], a[112:115], v[84:87]
    ds_read_b64_tr_b16 a[184:185], v19 offset:49152
    v_cvt_pk_bf16_f32 v232, v80, v81
    v_mfma_f32_16x16x32_bf16 v[84:87], a[228:231], a[116:119], v[84:87]
    ds_read_b64_tr_b16 a[186:187], v19 offset:53248
    v_cvt_pk_bf16_f32 v233, v82, v83
    v_mfma_f32_16x16x32_bf16 v[84:87], a[232:235], a[120:123], v[84:87]
    buffer_load_dwordx4 v[200:203], v59, s[24:27], s45 offen offset:1024 sc1
    v_mfma_f32_16x16x32_bf16 v[84:87], a[236:239], a[124:127], v[84:87]
    s_waitcnt lgkmcnt(12)
    ds_read_b64_tr_b16 a[188:189], v19 offset:57344
    ds_read_b64_tr_b16 a[190:191], v19 offset:61440
    s_barrier
    v_mfma_f32_16x16x32_bf16 v[88:91], a[160:163], a[64:67], v[88:91]
    s_waitcnt lgkmcnt(12)
    ds_read_b64_tr_b16 a[208:209], v20 offset:32768
    v_mfma_f32_16x16x32_bf16 v[88:91], a[164:167], a[68:71], v[88:91]
    s_waitcnt lgkmcnt(11)
    s_mov_b32 s45, 20992
    ds_read_b64_tr_b16 a[210:211], v20 offset:36864
    v_mfma_f32_16x16x32_bf16 v[88:91], a[168:171], a[72:75], v[88:91]
    s_waitcnt lgkmcnt(10)
    buffer_load_dwordx4 v[204:207], v5, s[24:27], s45 offen offset:0 sc1
    v_mfma_f32_16x16x32_bf16 v[88:91], a[172:175], a[76:79], v[88:91]
    s_waitcnt lgkmcnt(8)
    ds_read_b64_tr_b16 a[212:213], v20 offset:40960
    ds_read_b64_tr_b16 a[214:215], v20 offset:45056
    v_mfma_f32_16x16x32_bf16 v[88:91], a[176:179], a[80:83], v[88:91]
    s_waitcnt lgkmcnt(8)
    ds_read_b64_tr_b16 a[216:217], v20 offset:49152
    v_cvt_pk_bf16_f32 v236, v84, v85
    v_mfma_f32_16x16x32_bf16 v[88:91], a[180:183], a[84:87], v[88:91]
    s_waitcnt lgkmcnt(7)
    ds_read_b64_tr_b16 a[218:219], v20 offset:53248
    v_cvt_pk_bf16_f32 v237, v86, v87
    v_mfma_f32_16x16x32_bf16 v[88:91], a[184:187], a[88:91], v[88:91]
    s_waitcnt lgkmcnt(6)
    ds_read_b64_tr_b16 a[220:221], v20 offset:57344
    v_mfma_f32_16x16x32_bf16 v[88:91], a[188:191], a[92:95], v[88:91]
    ds_read_b64_tr_b16 a[222:223], v20 offset:61440
    v_mfma_f32_16x16x32_bf16 v[92:95], a[160:163], a[96:99], v[92:95]
    buffer_load_dwordx4 v[208:211], v5, s[24:27], s45 offen offset:512 sc1
    v_mfma_f32_16x16x32_bf16 v[92:95], a[164:167], a[100:103], v[92:95]
    ds_read_b64_tr_b16 a[224:225], v24 offset:32768
    ds_read_b64_tr_b16 a[226:227], v24 offset:36864
    v_mfma_f32_16x16x32_bf16 v[92:95], a[168:171], a[104:107], v[92:95]
    ds_read_b64_tr_b16 a[228:229], v24 offset:40960
    v_mfma_f32_16x16x32_bf16 v[92:95], a[172:175], a[108:111], v[92:95]
    ds_read_b64_tr_b16 a[230:231], v24 offset:45056
    v_mfma_f32_16x16x32_bf16 v[92:95], a[176:179], a[112:115], v[92:95]
    ds_read_b64_tr_b16 a[232:233], v24 offset:49152
    v_cvt_pk_bf16_f32 v234, v88, v89
    v_mfma_f32_16x16x32_bf16 v[92:95], a[180:183], a[116:119], v[92:95]
    s_add_u32 s38, s93, 1152
    ds_read_b64_tr_b16 a[234:235], v24 offset:53248
    v_cvt_pk_bf16_f32 v235, v90, v91
    v_mfma_f32_16x16x32_bf16 v[92:95], a[184:187], a[120:123], v[92:95]
    buffer_store_dwordx4 v[232:235], v56, s[28:31], s38 offen sc1
    v_mfma_f32_16x16x32_bf16 v[92:95], a[188:191], a[124:127], v[92:95]
    s_waitcnt lgkmcnt(12)
    ds_read_b64_tr_b16 a[236:237], v24 offset:57344
    ds_read_b64_tr_b16 a[238:239], v24 offset:61440
    v_mfma_f32_16x16x32_bf16 v[96:99], a[208:211], v[128:131], 0
    s_waitcnt lgkmcnt(12)
    buffer_load_dwordx4 v[212:215], v59, s[24:27], s45 offen offset:1024 sc1
    v_mfma_f32_16x16x32_bf16 v[96:99], a[212:215], v[132:135], v[96:99]
    s_waitcnt lgkmcnt(10)
    ds_read_b64_tr_b16 a[160:161], v21 offset:32768
    ds_read_b64_tr_b16 a[162:163], v21 offset:36864
    v_mfma_f32_16x16x32_bf16 v[96:99], a[216:219], v[136:139], v[96:99]
    s_waitcnt lgkmcnt(10)
    ds_read_b64_tr_b16 a[164:165], v21 offset:40960
    v_mfma_f32_16x16x32_bf16 v[96:99], a[220:223], v[140:143], v[96:99]
    s_waitcnt lgkmcnt(9)
    ds_read_b64_tr_b16 a[166:167], v21 offset:45056
    v_mfma_f32_16x16x32_bf16 v[96:99], a[224:227], v[144:147], v[96:99]
    s_waitcnt lgkmcnt(8)
    ds_read_b64_tr_b16 a[168:169], v21 offset:49152
    v_cvt_pk_bf16_f32 v238, v92, v93
    v_mfma_f32_16x16x32_bf16 v[96:99], a[228:231], v[148:151], v[96:99]
    s_waitcnt lgkmcnt(7)
    s_add_u32 s38, s93, 164992
    ds_read_b64_tr_b16 a[170:171], v21 offset:53248
    v_cvt_pk_bf16_f32 v239, v94, v95
    v_mfma_f32_16x16x32_bf16 v[96:99], a[232:235], v[152:155], v[96:99]
    s_waitcnt lgkmcnt(6)
    buffer_store_dwordx4 v[236:239], v56, s[28:31], s38 offen sc1
    v_mfma_f32_16x16x32_bf16 v[96:99], a[236:239], v[156:159], v[96:99]
    ds_read_b64_tr_b16 a[172:173], v21 offset:57344
    ds_read_b64_tr_b16 a[174:175], v21 offset:61440
    v_mfma_f32_16x16x32_bf16 v[100:103], a[208:211], v[160:163], 0
    buffer_load_dwordx2 v[92:93], v58, s[12:15], 0 offen offset:1024
    v_mfma_f32_16x16x32_bf16 v[100:103], a[212:215], v[164:167], v[100:103]
    ds_read_b64_tr_b16 a[176:177], v25 offset:32768
    ds_read_b64_tr_b16 a[178:179], v25 offset:36864
    v_mfma_f32_16x16x32_bf16 v[100:103], a[216:219], v[168:171], v[100:103]
    ds_read_b64_tr_b16 a[180:181], v25 offset:40960
    v_mfma_f32_16x16x32_bf16 v[100:103], a[220:223], v[172:175], v[100:103]
    ds_read_b64_tr_b16 a[182:183], v25 offset:45056
    v_mfma_f32_16x16x32_bf16 v[100:103], a[224:227], v[176:179], v[100:103]
    buffer_load_dwordx2 v[94:95], v58, s[12:15], 0 offen offset:1056
    v_mfma_f32_16x16x32_bf16 v[100:103], a[228:231], v[180:183], v[100:103]
    ds_read_b64_tr_b16 a[184:185], v25 offset:49152
    ds_read_b64_tr_b16 a[186:187], v25 offset:53248
    v_mfma_f32_16x16x32_bf16 v[100:103], a[232:235], v[184:187], v[100:103]
    ds_read_b64_tr_b16 a[188:189], v25 offset:57344
    v_mfma_f32_16x16x32_bf16 v[100:103], a[236:239], v[188:191], v[100:103]
    s_waitcnt lgkmcnt(13)
    ds_read_b64_tr_b16 a[190:191], v25 offset:61440
    v_mfma_f32_16x16x32_bf16 v[104:107], a[160:163], v[128:131], 0
    s_waitcnt lgkmcnt(12)
    ds_read_b64_tr_b16 a[208:209], v22 offset:32768
    v_mfma_f32_16x16x32_bf16 v[104:107], a[164:167], v[132:135], v[104:107]
    s_waitcnt lgkmcnt(11)
    s_mov_b32 s45, 19840
    ds_read_b64_tr_b16 a[210:211], v22 offset:36864
    v_mfma_f32_16x16x32_bf16 v[104:107], a[168:171], v[136:139], v[104:107]
    s_waitcnt lgkmcnt(10)
    buffer_load_dwordx4 v[64:67], v5, s[24:27], s45 offen offset:0 sc1
    v_mfma_f32_16x16x32_bf16 v[104:107], a[172:175], v[140:143], v[104:107]
    s_waitcnt lgkmcnt(8)
    ds_read_b64_tr_b16 a[212:213], v22 offset:40960
    ds_read_b64_tr_b16 a[214:215], v22 offset:45056
    v_mfma_f32_16x16x32_bf16 v[104:107], a[176:179], v[144:147], v[104:107]
    s_waitcnt lgkmcnt(8)
    ds_read_b64_tr_b16 a[216:217], v22 offset:49152
    v_mfma_f32_16x16x32_bf16 v[104:107], a[180:183], v[148:151], v[104:107]
    s_waitcnt lgkmcnt(7)
    ds_read_b64_tr_b16 a[218:219], v22 offset:53248
    v_mfma_f32_16x16x32_bf16 v[104:107], a[184:187], v[152:155], v[104:107]
    s_waitcnt lgkmcnt(6)
    buffer_load_dwordx4 v[68:71], v5, s[24:27], s45 offen offset:512 sc1
    v_mfma_f32_16x16x32_bf16 v[104:107], a[188:191], v[156:159], v[104:107]
    ds_read_b64_tr_b16 a[220:221], v22 offset:57344
    ds_read_b64_tr_b16 a[222:223], v22 offset:61440
    v_mfma_f32_16x16x32_bf16 v[108:111], a[160:163], v[160:163], 0
    ds_read_b64_tr_b16 a[224:225], v26 offset:32768
    v_mfma_f32_16x16x32_bf16 v[108:111], a[164:167], v[164:167], v[108:111]
    ds_read_b64_tr_b16 a[226:227], v26 offset:36864
    v_mfma_f32_16x16x32_bf16 v[108:111], a[168:171], v[168:171], v[108:111]
    ds_read_b64_tr_b16 a[228:229], v26 offset:40960
    v_mfma_f32_16x16x32_bf16 v[108:111], a[172:175], v[172:175], v[108:111]
    ds_read_b64_tr_b16 a[230:231], v26 offset:45056
    v_mfma_f32_16x16x32_bf16 v[108:111], a[176:179], v[176:179], v[108:111]
    buffer_load_dwordx4 v[72:75], v59, s[24:27], s45 offen offset:1024 sc1
    v_mfma_f32_16x16x32_bf16 v[108:111], a[180:183], v[180:183], v[108:111]
    ds_read_b64_tr_b16 a[232:233], v26 offset:49152
    ds_read_b64_tr_b16 a[234:235], v26 offset:53248
    v_mfma_f32_16x16x32_bf16 v[108:111], a[184:187], v[184:187], v[108:111]
    ds_read_b64_tr_b16 a[236:237], v26 offset:57344
    v_mfma_f32_16x16x32_bf16 v[108:111], a[188:191], v[188:191], v[108:111]
    s_waitcnt lgkmcnt(13)
    ds_read_b64_tr_b16 a[238:239], v26 offset:61440
    v_mfma_f32_16x16x32_bf16 v[112:115], a[208:211], v[128:131], 0
    s_waitcnt lgkmcnt(12)
    ds_read_b64_tr_b16 a[160:161], v23 offset:32768
    v_mfma_f32_16x16x32_bf16 v[112:115], a[212:215], v[132:135], v[112:115]
    s_waitcnt lgkmcnt(11)
    ds_read_b64_tr_b16 a[162:163], v23 offset:36864
    v_mfma_f32_16x16x32_bf16 v[112:115], a[216:219], v[136:139], v[112:115]
    s_waitcnt lgkmcnt(10)
    buffer_load_dwordx2 v[76:77], v3, s[20:23], 0 offen offset:0
    v_mfma_f32_16x16x32_bf16 v[112:115], a[220:223], v[140:143], v[112:115]
    s_waitcnt lgkmcnt(8)
    ds_read_b64_tr_b16 a[164:165], v23 offset:40960
    ds_read_b64_tr_b16 a[166:167], v23 offset:45056
    v_mfma_f32_16x16x32_bf16 v[112:115], a[224:227], v[144:147], v[112:115]
    s_waitcnt lgkmcnt(8)
    ds_read_b64_tr_b16 a[168:169], v23 offset:49152
    v_mfma_f32_16x16x32_bf16 v[112:115], a[228:231], v[148:151], v[112:115]
    s_waitcnt lgkmcnt(7)
    ds_read_b64_tr_b16 a[170:171], v23 offset:53248
    v_mfma_f32_16x16x32_bf16 v[112:115], a[232:235], v[152:155], v[112:115]
    s_waitcnt lgkmcnt(6)
    buffer_load_dwordx2 v[78:79], v3, s[20:23], 0 offen offset:32
    v_mfma_f32_16x16x32_bf16 v[112:115], a[236:239], v[156:159], v[112:115]
    ds_read_b64_tr_b16 a[172:173], v23 offset:57344
    ds_read_b64_tr_b16 a[174:175], v23 offset:61440
    v_mfma_f32_16x16x32_bf16 v[116:119], a[208:211], v[160:163], 0
    ds_read_b64_tr_b16 a[176:177], v27 offset:32768
    v_mfma_f32_16x16x32_bf16 v[116:119], a[212:215], v[164:167], v[116:119]
    ds_read_b64_tr_b16 a[178:179], v27 offset:36864
    v_mfma_f32_16x16x32_bf16 v[116:119], a[216:219], v[168:171], v[116:119]
    ds_read_b64_tr_b16 a[180:181], v27 offset:40960
    v_mfma_f32_16x16x32_bf16 v[116:119], a[220:223], v[172:175], v[116:119]
    ds_read_b64_tr_b16 a[182:183], v27 offset:45056
    v_mfma_f32_16x16x32_bf16 v[116:119], a[224:227], v[176:179], v[116:119]
    buffer_load_dwordx2 v[80:81], v3, s[20:23], 0 offen offset:512
    v_mfma_f32_16x16x32_bf16 v[116:119], a[228:231], v[180:183], v[116:119]
    ds_read_b64_tr_b16 a[184:185], v27 offset:49152
    ds_read_b64_tr_b16 a[186:187], v27 offset:53248
    v_mfma_f32_16x16x32_bf16 v[116:119], a[232:235], v[184:187], v[116:119]
    ds_read_b64_tr_b16 a[188:189], v27 offset:57344
    v_mfma_f32_16x16x32_bf16 v[116:119], a[236:239], v[188:191], v[116:119]
    ds_read_b64_tr_b16 a[190:191], v27 offset:61440
    s_waitcnt vmcnt(18)
    s_waitcnt lgkmcnt(0)
    s_barrier
    v_mfma_f32_16x16x32_bf16 v[120:123], a[160:163], v[128:131], 0
    ds_read_b64_tr_b16 a[208:209], v12 offset:0
    v_mfma_f32_16x16x32_bf16 v[120:123], a[164:167], v[132:135], v[120:123]
    ds_read_b64_tr_b16 a[210:211], v12 offset:4096
    v_mfma_f32_16x16x32_bf16 v[120:123], a[168:171], v[136:139], v[120:123]
    buffer_load_dwordx2 v[82:83], v3, s[20:23], 0 offen offset:544
    v_mfma_f32_16x16x32_bf16 v[120:123], a[172:175], v[140:143], v[120:123]
    s_add_u32 s39, s39, 16
    ds_read_b64_tr_b16 a[212:213], v12 offset:8192
    ds_read_b64_tr_b16 a[214:215], v12 offset:12288
    v_mfma_f32_16x16x32_bf16 v[120:123], a[176:179], v[144:147], v[120:123]
    buffer_load_dword v11, v9, s[24:27], s39 offen sc1
    v_mfma_f32_16x16x32_bf16 v[120:123], a[180:183], v[148:151], v[120:123]
    ds_read_b64_tr_b16 a[216:217], v12 offset:16384
    ds_read_b64_tr_b16 a[218:219], v12 offset:20480
    v_mfma_f32_16x16x32_bf16 v[120:123], a[184:187], v[152:155], v[120:123]
    ds_read_b64_tr_b16 a[220:221], v12 offset:24576
    v_mfma_f32_16x16x32_bf16 v[120:123], a[188:191], v[156:159], v[120:123]
    ds_read_b64_tr_b16 a[222:223], v12 offset:28672
    v_mfma_f32_16x16x32_bf16 v[124:127], a[160:163], v[160:163], 0
    buffer_load_dwordx2 v[84:85], v55, s[20:23], 0 offen offset:1024
    v_mfma_f32_16x16x32_bf16 v[124:127], a[164:167], v[164:167], v[124:127]
    ds_read_b64_tr_b16 a[224:225], v16 offset:0
    ds_read_b64_tr_b16 a[226:227], v16 offset:4096
    v_mfma_f32_16x16x32_bf16 v[124:127], a[168:171], v[168:171], v[124:127]
    ds_read_b64_tr_b16 a[228:229], v16 offset:8192
    v_mfma_f32_16x16x32_bf16 v[124:127], a[172:175], v[172:175], v[124:127]
    ds_read_b64_tr_b16 a[230:231], v16 offset:12288
    v_mfma_f32_16x16x32_bf16 v[124:127], a[176:179], v[176:179], v[124:127]
    ds_read_b64_tr_b16 a[232:233], v16 offset:16384
    v_mfma_f32_16x16x32_bf16 v[124:127], a[180:183], v[180:183], v[124:127]
    ds_read_b64_tr_b16 a[234:235], v16 offset:20480
    v_mfma_f32_16x16x32_bf16 v[124:127], a[184:187], v[184:187], v[124:127]
    buffer_load_dwordx2 v[86:87], v55, s[20:23], 0 offen offset:1056
    v_mfma_f32_16x16x32_bf16 v[124:127], a[188:191], v[188:191], v[124:127]
    s_waitcnt lgkmcnt(12)
    ds_read_b64_tr_b16 a[236:237], v16 offset:24576
    ds_read_b64_tr_b16 a[238:239], v16 offset:28672
    v_mfma_f32_16x16x32_bf16 v[96:99], a[208:211], a[64:67], v[96:99]
    s_waitcnt lgkmcnt(12)
    ds_read_b64_tr_b16 a[160:161], v13 offset:0
    v_mfma_f32_16x16x32_bf16 v[96:99], a[212:215], a[68:71], v[96:99]
    s_waitcnt lgkmcnt(11)
    ds_read_b64_tr_b16 a[162:163], v13 offset:4096
    v_mfma_f32_16x16x32_bf16 v[96:99], a[216:219], a[72:75], v[96:99]
    s_waitcnt lgkmcnt(10)
    ds_read_b64_tr_b16 a[164:165], v13 offset:8192
    v_mfma_f32_16x16x32_bf16 v[96:99], a[220:223], a[76:79], v[96:99]
    s_waitcnt lgkmcnt(9)
    s_mov_b32 s45, 22144
    ds_read_b64_tr_b16 a[166:167], v13 offset:12288
    v_mfma_f32_16x16x32_bf16 v[96:99], a[224:227], a[80:83], v[96:99]
    s_waitcnt lgkmcnt(8)
    buffer_load_dwordx4 v[216:219], v5, s[24:27], s45 offen offset:0 sc1
    v_mfma_f32_16x16x32_bf16 v[96:99], a[228:231], a[84:87], v[96:99]
    s_waitcnt lgkmcnt(6)
    ds_read_b64_tr_b16 a[168:169], v13 offset:16384
    ds_read_b64_tr_b16 a[170:171], v13 offset:20480
    v_mfma_f32_16x16x32_bf16 v[96:99], a[232:235], a[88:91], v[96:99]
    s_waitcnt lgkmcnt(6)
    ds_read_b64_tr_b16 a[172:173], v13 offset:24576
    v_mfma_f32_16x16x32_bf16 v[96:99], a[236:239], a[92:95], v[96:99]
    ds_read_b64_tr_b16 a[174:175], v13 offset:28672
    v_mfma_f32_16x16x32_bf16 v[100:103], a[208:211], a[96:99], v[100:103]
    buffer_load_dwordx4 v[220:223], v5, s[24:27], s45 offen offset:512 sc1
    v_mfma_f32_16x16x32_bf16 v[100:103], a[212:215], a[100:103], v[100:103]
    ds_read_b64_tr_b16 a[176:177], v17 offset:0
    ds_read_b64_tr_b16 a[178:179], v17 offset:4096
    v_mfma_f32_16x16x32_bf16 v[100:103], a[216:219], a[104:107], v[100:103]
    ds_read_b64_tr_b16 a[180:181], v17 offset:8192
    v_mfma_f32_16x16x32_bf16 v[100:103], a[220:223], a[108:111], v[100:103]
    ds_read_b64_tr_b16 a[182:183], v17 offset:12288
    v_mfma_f32_16x16x32_bf16 v[100:103], a[224:227], a[112:115], v[100:103]
    ds_read_b64_tr_b16 a[184:185], v17 offset:16384
    v_cvt_pk_bf16_f32 v224, v96, v97
    v_mfma_f32_16x16x32_bf16 v[100:103], a[228:231], a[116:119], v[100:103]
    ds_read_b64_tr_b16 a[186:187], v17 offset:20480
    v_cvt_pk_bf16_f32 v225, v98, v99
    v_mfma_f32_16x16x32_bf16 v[100:103], a[232:235], a[120:123], v[100:103]
    ds_read_b64_tr_b16 a[188:189], v17 offset:24576
    v_mfma_f32_16x16x32_bf16 v[100:103], a[236:239], a[124:127], v[100:103]
    s_waitcnt lgkmcnt(13)
    ds_read_b64_tr_b16 a[190:191], v17 offset:28672
    v_mfma_f32_16x16x32_bf16 v[104:107], a[160:163], a[64:67], v[104:107]
    s_waitcnt lgkmcnt(12)
    buffer_load_dwordx4 v[88:91], v59, s[24:27], s45 offen offset:1024 sc1
    v_mfma_f32_16x16x32_bf16 v[104:107], a[164:167], a[68:71], v[104:107]
    s_waitcnt lgkmcnt(10)
    ds_read_b64_tr_b16 a[208:209], v14 offset:0
    ds_read_b64_tr_b16 a[210:211], v14 offset:4096
    v_mfma_f32_16x16x32_bf16 v[104:107], a[168:171], a[72:75], v[104:107]
    s_waitcnt lgkmcnt(10)
    ds_read_b64_tr_b16 a[212:213], v14 offset:8192
    v_mfma_f32_16x16x32_bf16 v[104:107], a[172:175], a[76:79], v[104:107]
    s_waitcnt lgkmcnt(9)
    ds_read_b64_tr_b16 a[214:215], v14 offset:12288
    v_mfma_f32_16x16x32_bf16 v[104:107], a[176:179], a[80:83], v[104:107]
    s_waitcnt lgkmcnt(8)
    ds_read_b64_tr_b16 a[216:217], v14 offset:16384
    v_cvt_pk_bf16_f32 v228, v100, v101
    v_mfma_f32_16x16x32_bf16 v[104:107], a[180:183], a[84:87], v[104:107]
    s_waitcnt lgkmcnt(7)
    ds_read_b64_tr_b16 a[218:219], v14 offset:20480
    v_cvt_pk_bf16_f32 v229, v102, v103
    v_mfma_f32_16x16x32_bf16 v[104:107], a[184:187], a[88:91], v[104:107]
    s_waitcnt lgkmcnt(6)
    ds_read_b64_tr_b16 a[220:221], v14 offset:24576
    v_mfma_f32_16x16x32_bf16 v[104:107], a[188:191], a[92:95], v[104:107]
    ds_read_b64_tr_b16 a[222:223], v14 offset:28672
    v_mfma_f32_16x16x32_bf16 v[108:111], a[160:163], a[96:99], v[108:111]
    ds_read_b64_tr_b16 a[224:225], v18 offset:0
    v_mfma_f32_16x16x32_bf16 v[108:111], a[164:167], a[100:103], v[108:111]
    ds_read_b64_tr_b16 a[226:227], v18 offset:4096
    v_mfma_f32_16x16x32_bf16 v[108:111], a[168:171], a[104:107], v[108:111]
    ds_read_b64_tr_b16 a[228:229], v18 offset:8192
    v_mfma_f32_16x16x32_bf16 v[108:111], a[172:175], a[108:111], v[108:111]
    ds_read_b64_tr_b16 a[230:231], v18 offset:12288
    v_mfma_f32_16x16x32_bf16 v[108:111], a[176:179], a[112:115], v[108:111]
Ltour11:
    s_cbranch_execz Ltour15
    ds_read_b64_tr_b16 a[232:233], v18 offset:16384
    v_cvt_pk_bf16_f32 v226, v104, v105
    v_mfma_f32_16x16x32_bf16 v[108:111], a[180:183], a[116:119], v[108:111]
    s_add_u32 s38, s93, 1536
    ds_read_b64_tr_b16 a[234:235], v18 offset:20480
    v_cvt_pk_bf16_f32 v227, v106, v107
    v_mfma_f32_16x16x32_bf16 v[108:111], a[184:187], a[120:123], v[108:111]
    buffer_store_dwordx4 v[224:227], v56, s[28:31], s38 offen sc1
    v_mfma_f32_16x16x32_bf16 v[108:111], a[188:191], a[124:127], v[108:111]
    s_waitcnt lgkmcnt(12)
    ds_read_b64_tr_b16 a[236:237], v18 offset:24576
    ds_read_b64_tr_b16 a[238:239], v18 offset:28672
    v_mfma_f32_16x16x32_bf16 v[112:115], a[208:211], a[64:67], v[112:115]
    s_waitcnt lgkmcnt(12)
    ds_read_b64_tr_b16 a[160:161], v15 offset:0
    v_mfma_f32_16x16x32_bf16 v[112:115], a[212:215], a[68:71], v[112:115]
    s_waitcnt lgkmcnt(11)
    ds_read_b64_tr_b16 a[162:163], v15 offset:4096
    v_mfma_f32_16x16x32_bf16 v[112:115], a[216:219], a[72:75], v[112:115]
    s_waitcnt lgkmcnt(10)
    ds_read_b64_tr_b16 a[164:165], v15 offset:8192
    v_mfma_f32_16x16x32_bf16 v[112:115], a[220:223], a[76:79], v[112:115]
    s_waitcnt lgkmcnt(9)
    ds_read_b64_tr_b16 a[166:167], v15 offset:12288
    v_mfma_f32_16x16x32_bf16 v[112:115], a[224:227], a[80:83], v[112:115]
    s_waitcnt lgkmcnt(8)
    ds_read_b64_tr_b16 a[168:169], v15 offset:16384
    v_cvt_pk_bf16_f32 v230, v108, v109
    v_mfma_f32_16x16x32_bf16 v[112:115], a[228:231], a[84:87], v[112:115]
    s_waitcnt lgkmcnt(7)
    s_add_u32 s38, s93, 165376
    ds_read_b64_tr_b16 a[170:171], v15 offset:20480
    v_cvt_pk_bf16_f32 v231, v110, v111
    v_mfma_f32_16x16x32_bf16 v[112:115], a[232:235], a[88:91], v[112:115]
    s_waitcnt lgkmcnt(6)
    buffer_store_dwordx4 v[228:231], v56, s[28:31], s38 offen sc1
    v_mfma_f32_16x16x32_bf16 v[112:115], a[236:239], a[92:95], v[112:115]
    ds_read_b64_tr_b16 a[172:173], v15 offset:24576
    ds_read_b64_tr_b16 a[174:175], v15 offset:28672
    v_mfma_f32_16x16x32_bf16 v[116:119], a[208:211], a[96:99], v[116:119]
    ds_read_b64_tr_b16 a[176:177], v19 offset:0
    v_mfma_f32_16x16x32_bf16 v[116:119], a[212:215], a[100:103], v[116:119]
    ds_read_b64_tr_b16 a[178:179], v19 offset:4096
    v_mfma_f32_16x16x32_bf16 v[116:119], a[216:219], a[104:107], v[116:119]
    ds_read_b64_tr_b16 a[180:181], v19 offset:8192
    v_mfma_f32_16x16x32_bf16 v[116:119], a[220:223], a[108:111], v[116:119]
    ds_read_b64_tr_b16 a[182:183], v19 offset:12288
    v_mfma_f32_16x16x32_bf16 v[116:119], a[224:227], a[112:115], v[116:119]
    ds_read_b64_tr_b16 a[184:185], v19 offset:16384
    v_cvt_pk_bf16_f32 v232, v112, v113
    v_mfma_f32_16x16x32_bf16 v[116:119], a[228:231], a[116:119], v[116:119]
    ds_read_b64_tr_b16 a[186:187], v19 offset:20480
    v_cvt_pk_bf16_f32 v233, v114, v115
    v_mfma_f32_16x16x32_bf16 v[116:119], a[232:235], a[120:123], v[116:119]
    ds_read_b64_tr_b16 a[188:189], v19 offset:24576
    v_mfma_f32_16x16x32_bf16 v[116:119], a[236:239], a[124:127], v[116:119]
    s_waitcnt lgkmcnt(13)
    ds_read_b64_tr_b16 a[190:191], v19 offset:28672
    v_mfma_f32_16x16x32_bf16 v[120:123], a[160:163], a[64:67], v[120:123]
    s_waitcnt lgkmcnt(12)
    v_mfma_f32_16x16x32_bf16 v[120:123], a[164:167], a[68:71], v[120:123]
    s_waitcnt lgkmcnt(10)
    v_mfma_f32_16x16x32_bf16 v[120:123], a[168:171], a[72:75], v[120:123]
    s_waitcnt lgkmcnt(8)
    v_mfma_f32_16x16x32_bf16 v[120:123], a[172:175], a[76:79], v[120:123]
    s_waitcnt lgkmcnt(6)
    v_mfma_f32_16x16x32_bf16 v[120:123], a[176:179], a[80:83], v[120:123]
    s_waitcnt lgkmcnt(4)
    v_cvt_pk_bf16_f32 v236, v116, v117
    v_mfma_f32_16x16x32_bf16 v[120:123], a[180:183], a[84:87], v[120:123]
    s_waitcnt lgkmcnt(2)
    v_cvt_pk_bf16_f32 v237, v118, v119
    v_mfma_f32_16x16x32_bf16 v[120:123], a[184:187], a[88:91], v[120:123]
    s_waitcnt lgkmcnt(0)
    v_mfma_f32_16x16x32_bf16 v[120:123], a[188:191], a[92:95], v[120:123]
    v_mfma_f32_16x16x32_bf16 v[124:127], a[160:163], a[96:99], v[124:127]
    v_mfma_f32_16x16x32_bf16 v[124:127], a[164:167], a[100:103], v[124:127]
    v_mfma_f32_16x16x32_bf16 v[124:127], a[168:171], a[104:107], v[124:127]
    v_mfma_f32_16x16x32_bf16 v[124:127], a[172:175], a[108:111], v[124:127]
    v_mfma_f32_16x16x32_bf16 v[124:127], a[176:179], a[112:115], v[124:127]
    s_nop 2
    v_cvt_pk_bf16_f32 v234, v120, v121
    v_mfma_f32_16x16x32_bf16 v[124:127], a[180:183], a[116:119], v[124:127]
    s_add_u32 s38, s93, 1664
    v_cvt_pk_bf16_f32 v235, v122, v123
    v_mfma_f32_16x16x32_bf16 v[124:127], a[184:187], a[120:123], v[124:127]
    buffer_store_dwordx4 v[232:235], v56, s[28:31], s38 offen sc1
    v_mfma_f32_16x16x32_bf16 v[124:127], a[188:191], a[124:127], v[124:127]
    s_nop 7
    v_cvt_pk_bf16_f32 v238, v124, v125
    s_add_u32 s38, s93, 165504
    v_cvt_pk_bf16_f32 v239, v126, v127
    buffer_store_dwordx4 v[236:239], v56, s[28:31], s38 offen sc1
    s_waitcnt vmcnt(16)
    v_lshlrev_b32 v144, 16, v64
    v_and_b32 v145, 0xffff0000, v64
    v_lshlrev_b32 v146, 16, v65
    v_and_b32 v147, 0xffff0000, v65
    v_lshlrev_b32 v148, 16, v66
    v_and_b32 v149, 0xffff0000, v66
    v_lshlrev_b32 v150, 16, v67
    v_and_b32 v151, 0xffff0000, v67
    s_waitcnt vmcnt(15)
    v_lshlrev_b32 v152, 16, v68
    v_and_b32 v153, 0xffff0000, v68
    v_lshlrev_b32 v154, 16, v69
    v_and_b32 v155, 0xffff0000, v69
    v_lshlrev_b32 v156, 16, v70
    v_and_b32 v157, 0xffff0000, v70
    v_lshlrev_b32 v158, 16, v71
    v_and_b32 v159, 0xffff0000, v71
    s_waitcnt vmcnt(14)
    v_lshlrev_b32 v160, 16, v72
    v_and_b32 v161, 0xffff0000, v72
    v_lshlrev_b32 v162, 16, v73
    v_and_b32 v163, 0xffff0000, v73
    v_lshlrev_b32 v164, 16, v74
    v_and_b32 v165, 0xffff0000, v74
    v_lshlrev_b32 v166, 16, v75
    v_and_b32 v167, 0xffff0000, v75
    s_waitcnt vmcnt(13)
    v_lshlrev_b32 v168, 16, v76
    v_and_b32 v169, 0xffff0000, v76
    v_lshlrev_b32 v170, 16, v77
    v_and_b32 v171, 0xffff0000, v77
    s_waitcnt vmcnt(12)
    v_lshlrev_b32 v172, 16, v78
    v_and_b32 v173, 0xffff0000, v78
    v_lshlrev_b32 v174, 16, v79
    v_and_b32 v175, 0xffff0000, v79
    s_waitcnt vmcnt(11)
    v_lshlrev_b32 v176, 16, v80
    v_and_b32 v177, 0xffff0000, v80
    v_lshlrev_b32 v178, 16, v81
    v_and_b32 v179, 0xffff0000, v81
    s_waitcnt vmcnt(10)
    v_lshlrev_b32 v180, 16, v82
    v_and_b32 v181, 0xffff0000, v82
    v_lshlrev_b32 v182, 16, v83
    v_and_b32 v183, 0xffff0000, v83
    s_waitcnt vmcnt(8)
    v_lshlrev_b32 v184, 16, v84
    v_and_b32 v185, 0xffff0000, v84
    v_lshlrev_b32 v186, 16, v85
    v_and_b32 v187, 0xffff0000, v85
    s_waitcnt vmcnt(7)
    v_lshlrev_b32 v188, 16, v86
    v_and_b32 v189, 0xffff0000, v86
    v_lshlrev_b32 v190, 16, v87
    v_and_b32 v191, 0xffff0000, v87
    v_lshlrev_b32 v12, 16, v36
    v_and_b32 v13, 0xffff0000, v36
    v_lshlrev_b32 v14, 16, v37
    v_and_b32 v15, 0xffff0000, v37
    v_lshlrev_b32 v16, 16, v38
    v_and_b32 v17, 0xffff0000, v38
    v_lshlrev_b32 v18, 16, v39
    v_and_b32 v19, 0xffff0000, v39
    v_lshlrev_b32 v20, 16, v40
    v_and_b32 v21, 0xffff0000, v40
    v_lshlrev_b32 v22, 16, v41
    v_and_b32 v23, 0xffff0000, v41
    v_lshlrev_b32 v24, 16, v42
    v_and_b32 v25, 0xffff0000, v42
    v_lshlrev_b32 v26, 16, v43
    v_and_b32 v27, 0xffff0000, v43
    v_lshlrev_b32 v28, 16, v92
    v_and_b32 v29, 0xffff0000, v92
    v_lshlrev_b32 v30, 16, v93
    v_and_b32 v31, 0xffff0000, v93
    v_lshlrev_b32 v32, 16, v94
    v_and_b32 v33, 0xffff0000, v94
    v_lshlrev_b32 v34, 16, v95
    v_and_b32 v35, 0xffff0000, v95
    v_lshlrev_b32 v96, 16, v192
    v_and_b32 v97, 0xffff0000, v192
    v_lshlrev_b32 v98, 16, v193
    v_and_b32 v99, 0xffff0000, v193
    v_lshlrev_b32 v100, 16, v194
    v_and_b32 v101, 0xffff0000, v194
    v_lshlrev_b32 v102, 16, v195
    v_and_b32 v103, 0xffff0000, v195
    v_lshlrev_b32 v104, 16, v196
    v_and_b32 v105, 0xffff0000, v196
    v_lshlrev_b32 v106, 16, v197
    v_and_b32 v107, 0xffff0000, v197
    v_lshlrev_b32 v108, 16, v198
    v_and_b32 v109, 0xffff0000, v198
    v_lshlrev_b32 v110, 16, v199
    v_and_b32 v111, 0xffff0000, v199
    v_lshlrev_b32 v112, 16, v200
    v_and_b32 v113, 0xffff0000, v200
    v_lshlrev_b32 v114, 16, v201
    v_and_b32 v115, 0xffff0000, v201
    v_lshlrev_b32 v116, 16, v202
    v_and_b32 v117, 0xffff0000, v202
    v_lshlrev_b32 v118, 16, v203
    v_and_b32 v119, 0xffff0000, v203
    s_waitcnt vmcnt(0)
    s_add_u32 s92, s92, 16
    buffer_store_dword v10, v8, s[24:27], s92 offen sc1
    v_cmp_ne_u32 s[54:55], s95, v11
    s_cmp_lg_u64 s[54:55], 0
    s_cbranch_scc1 Ltail_spin1
Ltail_got1:
    s_add_u32 s56, s44, 16384
    buffer_load_dwordx4 a[0:3], v54, s[28:31], s56 offen offset:0 sc1
    buffer_load_dwordx4 a[4:7], v54, s[28:31], s56 offen offset:1024 sc1
    buffer_load_dwordx4 a[8:11], v54, s[28:31], s56 offen offset:2048 sc1
    buffer_load_dwordx4 a[12:15], v54, s[28:31], s56 offen offset:3072 sc1
    s_add_u32 s56, s44, 0
    buffer_load_dwordx4 a[16:19], v2, s[28:31], s56 offen offset:0 sc1
    s_add_u32 s56, s44, 4096
    buffer_load_dwordx4 a[20:23], v2, s[28:31], s56 offen offset:0 sc1
    s_add_u32 s56, s44, 8192
    buffer_load_dwordx4 a[24:27], v2, s[28:31], s56 offen offset:0 sc1
    s_add_u32 s56, s44, 12288
    buffer_load_dwordx4 a[28:31], v2, s[28:31], s56 offen offset:0 sc1
    ds_write_b128 v51, a[128:131] offset:0
    ds_write_b128 v51, a[132:135] offset:4096
    ds_write_b128 v51, a[136:139] offset:8192
    ds_write_b128 v51, a[140:143] offset:12288
    ds_write_b128 v51, a[144:147] offset:16384
    ds_write_b128 v51, a[148:151] offset:20480
    ds_write_b128 v51, a[152:155] offset:24576
    ds_write_b128 v51, a[156:159] offset:28672
    ds_write_b128 v51, a[240:243] offset:32768
    ds_write_b128 v255, a[244:247] offset:40960
    ds_write_b128 v255, a[248:251] offset:45056
    ds_write_b128 v255, a[252:255] offset:49152
    v_lshlrev_b32 v120, 16, v204
    v_and_b32 v121, 0xffff0000, v204
    v_lshlrev_b32 v122, 16, v205
    v_and_b32 v123, 0xffff0000, v205
    v_lshlrev_b32 v124, 16, v206
    v_and_b32 v125, 0xffff0000, v206
    v_lshlrev_b32 v126, 16, v207
    v_and_b32 v127, 0xffff0000, v207
    v_lshlrev_b32 v128, 16, v208
    v_and_b32 v129, 0xffff0000, v208
    v_lshlrev_b32 v130, 16, v209
    v_and_b32 v131, 0xffff0000, v209
    v_lshlrev_b32 v132, 16, v210
    v_and_b32 v133, 0xffff0000, v210
    v_lshlrev_b32 v134, 16, v211
    v_and_b32 v135, 0xffff0000, v211
    v_lshlrev_b32 v136, 16, v212
    v_and_b32 v137, 0xffff0000, v212
    v_lshlrev_b32 v138, 16, v213
    v_and_b32 v139, 0xffff0000, v213
    v_lshlrev_b32 v140, 16, v214
    v_and_b32 v141, 0xffff0000, v214
    v_lshlrev_b32 v142, 16, v215
    v_and_b32 v143, 0xffff0000, v215
    v_lshlrev_b32 v192, 16, v216
    v_and_b32 v193, 0xffff0000, v216
    v_lshlrev_b32 v194, 16, v217
    v_and_b32 v195, 0xffff0000, v217
    v_lshlrev_b32 v196, 16, v218
    v_and_b32 v197, 0xffff0000, v218
    v_lshlrev_b32 v198, 16, v219
    v_and_b32 v199, 0xffff0000, v219
    v_lshlrev_b32 v200, 16, v220
    v_and_b32 v201, 0xffff0000, v220
    v_lshlrev_b32 v202, 16, v221
    v_and_b32 v203, 0xffff0000, v221
    v_lshlrev_b32 v204, 16, v222
    v_and_b32 v205, 0xffff0000, v222
    v_lshlrev_b32 v206, 16, v223
    v_and_b32 v207, 0xffff0000, v223
    v_lshlrev_b32 v208, 16, v88
    v_and_b32 v209, 0xffff0000, v88
    v_lshlrev_b32 v210, 16, v89
    v_and_b32 v211, 0xffff0000, v89
    v_lshlrev_b32 v212, 16, v90
    v_and_b32 v213, 0xffff0000, v90
    v_lshlrev_b32 v214, 16, v91
    v_and_b32 v215, 0xffff0000, v91
    s_add_u32 s39, s39, 16
    buffer_load_dword v11, v9, s[24:27], s39 offen sc1
    s_add_u32 s56, s44, 0
    buffer_load_dwordx4 a[32:35], v2, s[28:31], s56 offen offset:512 sc1
    s_add_u32 s56, s44, 4096
    buffer_load_dwordx4 a[36:39], v2, s[28:31], s56 offen offset:512 sc1
    s_add_u32 s56, s44, 8192
    buffer_load_dwordx4 a[40:43], v2, s[28:31], s56 offen offset:512 sc1
    s_add_u32 s56, s44, 12288
    buffer_load_dwordx4 a[44:47], v2, s[28:31], s56 offen offset:512 sc1
    s_waitcnt vmcnt(4)
    v_cmp_ne_u32 s[54:55], s95, v11
    s_cmp_lg_u64 s[54:55], 0
    s_cbranch_scc1 Ltail_spin2
Ltail_got2:
    s_add_u32 s56, s44, 0
    buffer_load_dwordx4 a[48:51], v2, s[28:31], s56 offen offset:1024 sc1
    s_add_u32 s56, s44, 4096
    buffer_load_dwordx4 a[52:55], v2, s[28:31], s56 offen offset:1024 sc1
    s_add_u32 s56, s44, 8192
    buffer_load_dwordx4 a[56:59], v2, s[28:31], s56 offen offset:1024 sc1
    s_add_u32 s56, s44, 12288
    buffer_load_dwordx4 a[60:63], v2, s[28:31], s56 offen offset:1024 sc1
    s_add_u32 s56, s44, 0
    buffer_load_dwordx4 a[64:67], v2, s[28:31], s56 offen offset:1536 sc1
    s_add_u32 s56, s44, 4096
    buffer_load_dwordx4 a[68:71], v2, s[28:31], s56 offen offset:1536 sc1
    s_add_u32 s56, s44, 8192
    buffer_load_dwordx4 a[72:75], v2, s[28:31], s56 offen offset:1536 sc1
    s_add_u32 s56, s44, 12288
    buffer_load_dwordx4 a[76:79], v2, s[28:31], s56 offen offset:1536 sc1
    v_mfma_f32_16x16x32_bf16 v[80:83], v[242:245], a[0:3], 0
    v_mfma_f32_16x16x32_bf16 v[84:87], v[240:243], a[0:3], 0
    v_mfma_f32_16x16x32_bf16 v[80:83], v[242:245], a[4:7], v[80:83]
    v_mfma_f32_16x16x32_bf16 v[84:87], v[240:243], a[4:7], v[84:87]
    v_mfma_f32_16x16x32_bf16 v[80:83], v[242:245], a[8:11], v[80:83]
    v_mfma_f32_16x16x32_bf16 v[84:87], v[240:243], a[8:11], v[84:87]
    v_mfma_f32_16x16x32_bf16 v[80:83], v[242:245], a[12:15], v[80:83]
    v_mfma_f32_16x16x32_bf16 v[84:87], v[240:243], a[12:15], v[84:87]
    s_nop 6
    v_mov_b32_dpp v80, v80 row_ror:8 row_mask:0x4 bank_mask:0xf
    v_mov_b32_dpp v81, v81 row_ror:8 row_mask:0x4 bank_mask:0xf
    v_mov_b32_dpp v82, v82 row_ror:8 row_mask:0x4 bank_mask:0xf
    v_mov_b32_dpp v83, v83 row_ror:8 row_mask:0x4 bank_mask:0xf
    v_mov_b32_dpp v84, v84 row_ror:8 row_mask:0x4 bank_mask:0xf
    v_mov_b32_dpp v85, v85 row_ror:8 row_mask:0x4 bank_mask:0xf
    v_mov_b32_dpp v86, v86 row_ror:8 row_mask:0x4 bank_mask:0xf
    v_mov_b32_dpp v87, v87 row_ror:8 row_mask:0x4 bank_mask:0xf
    v_pk_fma_f32 v[28:29], v[112:113], v[80:81], v[28:29]
    v_pk_fma_f32 v[30:31], v[114:115], v[82:83], v[30:31]
    v_pk_fma_f32 v[32:33], v[116:117], v[84:85], v[32:33]
    v_pk_fma_f32 v[34:35], v[118:119], v[86:87], v[34:35]
    v_cvt_pk_bf16_f32 v44, v28, v29
    v_cvt_pk_bf16_f32 v45, v30, v31
    v_cvt_pk_bf16_f32 v46, v32, v33
    v_cvt_pk_bf16_f32 v47, v34, v35
    v_lshlrev_b32 v28, 16, v44
    v_and_b32 v29, 0xffff0000, v44
    v_lshlrev_b32 v30, 16, v45
    v_and_b32 v31, 0xffff0000, v45
    v_lshlrev_b32 v32, 16, v46
    v_and_b32 v33, 0xffff0000, v46
    v_lshlrev_b32 v34, 16, v47
    v_and_b32 v35, 0xffff0000, v47
    v_pk_add_f32 v[48:49], v[28:29], v[30:31]
    v_pk_add_f32 v[50:51], v[32:33], v[34:35]
    v_mfma_f32_16x16x32_bf16 v[64:67], v[246:249], a[16:19], 0
    v_mfma_f32_16x16x32_bf16 v[68:71], v[244:247], a[16:19], 0
    v_mfma_f32_16x16x32_bf16 v[64:67], v[246:249], a[20:23], v[64:67]
    v_mfma_f32_16x16x32_bf16 v[68:71], v[244:247], a[20:23], v[68:71]
    v_mfma_f32_16x16x32_bf16 v[64:67], v[246:249], a[24:27], v[64:67]
    v_mfma_f32_16x16x32_bf16 v[68:71], v[244:247], a[24:27], v[68:71]
    v_mfma_f32_16x16x32_bf16 v[64:67], v[246:249], a[28:31], v[64:67]
    v_mfma_f32_16x16x32_bf16 v[68:71], v[244:247], a[28:31], v[68:71]
    s_waitcnt vmcnt(11)
    v_mfma_f32_16x16x32_bf16 v[64:67], v[250:253], a[32:35], v[64:67]
    v_mfma_f32_16x16x32_bf16 v[68:71], v[248:251], a[32:35], v[68:71]
    s_waitcnt vmcnt(10)
    v_mfma_f32_16x16x32_bf16 v[64:67], v[250:253], a[36:39], v[64:67]
    v_mfma_f32_16x16x32_bf16 v[68:71], v[248:251], a[36:39], v[68:71]
    s_waitcnt vmcnt(9)
    v_mfma_f32_16x16x32_bf16 v[64:67], v[250:253], a[40:43], v[64:67]
    v_mfma_f32_16x16x32_bf16 v[68:71], v[248:251], a[40:43], v[68:71]
    s_waitcnt vmcnt(8)
    v_mfma_f32_16x16x32_bf16 v[64:67], v[250:253], a[44:47], v[64:67]
    v_mfma_f32_16x16x32_bf16 v[68:71], v[248:251], a[44:47], v[68:71]
    s_waitcnt vmcnt(7)
    s_nop 5
    v_pk_fma_f32 v[12:13], v[96:97], v[64:65], v[12:13]
    v_pk_fma_f32 v[14:15], v[98:99], v[66:67], v[14:15]
    v_pk_fma_f32 v[16:17], v[100:101], v[68:69], v[16:17]
    v_pk_fma_f32 v[18:19], v[102:103], v[70:71], v[18:19]
    v_cvt_pk_bf16_f32 v36, v12, v13
    v_cvt_pk_bf16_f32 v37, v14, v15
    v_cvt_pk_bf16_f32 v38, v16, v17
    v_cvt_pk_bf16_f32 v39, v18, v19
    v_lshlrev_b32 v12, 16, v36
    v_and_b32 v13, 0xffff0000, v36
    v_lshlrev_b32 v14, 16, v37
    v_and_b32 v15, 0xffff0000, v37
    v_lshlrev_b32 v16, 16, v38
    v_and_b32 v17, 0xffff0000, v38
    v_lshlrev_b32 v18, 16, v39
    v_and_b32 v19, 0xffff0000, v39
    v_pk_add_f32 v[48:49], v[48:49], v[12:13]
    v_pk_add_f32 v[50:51], v[50:51], v[14:15]
    v_pk_add_f32 v[48:49], v[48:49], v[16:17]
    v_pk_add_f32 v[50:51], v[50:51], v[18:19]
    v_mfma_f32_16x16x32_bf16 v[72:75], v[246:249], a[48:51], 0
    v_mfma_f32_16x16x32_bf16 v[76:79], v[244:247], a[48:51], 0
    s_waitcnt vmcnt(6)
    v_mfma_f32_16x16x32_bf16 v[72:75], v[246:249], a[52:55], v[72:75]
    v_mfma_f32_16x16x32_bf16 v[76:79], v[244:247], a[52:55], v[76:79]
    s_waitcnt vmcnt(5)
    v_mfma_f32_16x16x32_bf16 v[72:75], v[246:249], a[56:59], v[72:75]
    v_mfma_f32_16x16x32_bf16 v[76:79], v[244:247], a[56:59], v[76:79]
    s_waitcnt vmcnt(4)
    v_mfma_f32_16x16x32_bf16 v[72:75], v[246:249], a[60:63], v[72:75]
    v_mfma_f32_16x16x32_bf16 v[76:79], v[244:247], a[60:63], v[76:79]
    s_waitcnt vmcnt(3)
    v_mfma_f32_16x16x32_bf16 v[72:75], v[250:253], a[64:67], v[72:75]
    v_mfma_f32_16x16x32_bf16 v[76:79], v[248:251], a[64:67], v[76:79]
    s_waitcnt vmcnt(2)
    v_mfma_f32_16x16x32_bf16 v[72:75], v[250:253], a[68:71], v[72:75]
    v_mfma_f32_16x16x32_bf16 v[76:79], v[248:251], a[68:71], v[76:79]
    s_waitcnt vmcnt(1)
    v_mfma_f32_16x16x32_bf16 v[72:75], v[250:253], a[72:75], v[72:75]
    v_mfma_f32_16x16x32_bf16 v[76:79], v[248:251], a[72:75], v[76:79]
    s_waitcnt vmcnt(0)
    v_mfma_f32_16x16x32_bf16 v[72:75], v[250:253], a[76:79], v[72:75]
    v_mfma_f32_16x16x32_bf16 v[76:79], v[248:251], a[76:79], v[76:79]
    s_nop 6
    v_pk_fma_f32 v[20:21], v[104:105], v[72:73], v[20:21]
    v_pk_fma_f32 v[22:23], v[106:107], v[74:75], v[22:23]
    v_pk_fma_f32 v[24:25], v[108:109], v[76:77], v[24:25]
    v_pk_fma_f32 v[26:27], v[110:111], v[78:79], v[26:27]
    v_cvt_pk_bf16_f32 v40, v20, v21
    v_cvt_pk_bf16_f32 v41, v22, v23
    v_cvt_pk_bf16_f32 v42, v24, v25
    v_cvt_pk_bf16_f32 v43, v26, v27
    v_lshlrev_b32 v20, 16, v40
    v_and_b32 v21, 0xffff0000, v40
    v_lshlrev_b32 v22, 16, v41
    v_and_b32 v23, 0xffff0000, v41
    v_lshlrev_b32 v24, 16, v42
    v_and_b32 v25, 0xffff0000, v42
    v_lshlrev_b32 v26, 16, v43
    v_and_b32 v27, 0xffff0000, v43
    v_pk_add_f32 v[48:49], v[48:49], v[20:21]
    v_pk_add_f32 v[50:51], v[50:51], v[22:23]
    v_pk_add_f32 v[48:49], v[48:49], v[24:25]
    v_pk_add_f32 v[50:51], v[50:51], v[26:27]
    v_pk_add_f32 v[48:49], v[48:49], v[50:51]
    v_add_f32 v48, v48, v49
    s_nop 1
    v_add_f32_dpp v48, v48, v48 row_ror:1 row_mask:0xf bank_mask:0xf
    s_nop 1
    v_add_f32_dpp v48, v48, v48 row_ror:2 row_mask:0xf bank_mask:0xf
    s_nop 1
    v_add_f32_dpp v48, v48, v48 row_ror:4 row_mask:0xf bank_mask:0xf
    s_nop 1
    v_add_f32_dpp v48, v48, v48 row_ror:8 row_mask:0xf bank_mask:0xf
    v_mov_b32 v52, v48
    s_nop 1
    v_permlane16_swap_b32 v48, v52
    s_nop 0
    v_add_f32 v48, v48, v52
    v_mul_f32 v48, 0x3ae38e39, v48
    v_pk_add_f32 v[216:217], v[12:13], v[48:49] op_sel_hi:[1,0] neg_lo:[0,1] neg_hi:[0,1]
    v_pk_add_f32 v[218:219], v[14:15], v[48:49] op_sel_hi:[1,0] neg_lo:[0,1] neg_hi:[0,1]
    v_pk_add_f32 v[220:221], v[16:17], v[48:49] op_sel_hi:[1,0] neg_lo:[0,1] neg_hi:[0,1]
    v_pk_add_f32 v[222:223], v[18:19], v[48:49] op_sel_hi:[1,0] neg_lo:[0,1] neg_hi:[0,1]
    v_pk_add_f32 v[224:225], v[20:21], v[48:49] op_sel_hi:[1,0] neg_lo:[0,1] neg_hi:[0,1]
    v_pk_add_f32 v[226:227], v[22:23], v[48:49] op_sel_hi:[1,0] neg_lo:[0,1] neg_hi:[0,1]
    v_pk_add_f32 v[228:229], v[24:25], v[48:49] op_sel_hi:[1,0] neg_lo:[0,1] neg_hi:[0,1]
    v_pk_add_f32 v[230:231], v[26:27], v[48:49] op_sel_hi:[1,0] neg_lo:[0,1] neg_hi:[0,1]
    v_pk_add_f32 v[232:233], v[28:29], v[48:49] op_sel_hi:[1,0] neg_lo:[0,1] neg_hi:[0,1]
    v_pk_add_f32 v[234:235], v[30:31], v[48:49] op_sel_hi:[1,0] neg_lo:[0,1] neg_hi:[0,1]
    v_pk_add_f32 v[236:237], v[32:33], v[48:49] op_sel_hi:[1,0] neg_lo:[0,1] neg_hi:[0,1]
    v_pk_add_f32 v[238:239], v[34:35], v[48:49] op_sel_hi:[1,0] neg_lo:[0,1] neg_hi:[0,1]
    v_pk_mul_f32 v[50:51], v[216:217], v[216:217]
    v_pk_mul_f32 v[52:53], v[224:225], v[224:225]
    v_pk_mul_f32 v[62:63], v[232:233], v[232:233]
    v_pk_fma_f32 v[50:51], v[218:219], v[218:219], v[50:51]
    v_pk_fma_f32 v[52:53], v[226:227], v[226:227], v[52:53]
    v_pk_fma_f32 v[62:63], v[234:235], v[234:235], v[62:63]
    v_pk_fma_f32 v[50:51], v[220:221], v[220:221], v[50:51]
    v_pk_fma_f32 v[52:53], v[228:229], v[228:229], v[52:53]
    v_pk_fma_f32 v[62:63], v[236:237], v[236:237], v[62:63]
    v_pk_fma_f32 v[50:51], v[222:223], v[222:223], v[50:51]
    v_pk_fma_f32 v[52:53], v[230:231], v[230:231], v[52:53]
    v_pk_fma_f32 v[62:63], v[238:239], v[238:239], v[62:63]
    v_pk_add_f32 v[50:51], v[50:51], v[52:53]
    v_add_f32 v62, v62, v63
    v_add_f32 v50, v50, v51
    v_cndmask_b32 v62, 0, v62, vcc
    v_add_f32 v50, v50, v62
    s_nop 1
    v_add_f32_dpp v50, v50, v50 row_ror:1 row_mask:0xf bank_mask:0xf
    s_nop 1
    v_add_f32_dpp v50, v50, v50 row_ror:2 row_mask:0xf bank_mask:0xf
    s_nop 1
    v_add_f32_dpp v50, v50, v50 row_ror:4 row_mask:0xf bank_mask:0xf
    s_nop 1
    v_add_f32_dpp v50, v50, v50 row_ror:8 row_mask:0xf bank_mask:0xf
    v_mov_b32 v52, v50
    s_nop 1
    v_permlane16_swap_b32 v50, v52
    s_nop 0
    v_add_f32 v50, v50, v52
    v_mul_f32 v50, 0x3ae38e39, v50
    v_cvt_pk_bf16_f32 v52, v48, v50
    v_and_b32 v50, 0xffff0000, v52
    v_lshlrev_b32 v52, 16, v52
    v_add_f32 v50, 0x3727c5ac, v50
    v_sub_f32 v48, v48, v52
    v_cvt_pk_bf16_f32 v50, v50, v50
    v_and_b32 v50, 0xffff0000, v50
    v_sqrt_f32 v50, v50
    s_nop 0
    v_cvt_pk_bf16_f32 v50, v50, v50
    v_and_b32 v50, 0xffff0000, v50
    v_rcp_f32 v50, v50
    s_mov_b32 s45, 2621440
    v_mul_f32 v48, v48, v50
    v_pk_fma_f32 v[216:217], v[216:217], v[50:51], v[48:49] op_sel_hi:[1,0,0]
    v_pk_fma_f32 v[218:219], v[218:219], v[50:51], v[48:49] op_sel_hi:[1,0,0]
    v_pk_fma_f32 v[220:221], v[220:221], v[50:51], v[48:49] op_sel_hi:[1,0,0]
    v_pk_fma_f32 v[222:223], v[222:223], v[50:51], v[48:49] op_sel_hi:[1,0,0]
    v_pk_fma_f32 v[224:225], v[224:225], v[50:51], v[48:49] op_sel_hi:[1,0,0]
    v_pk_fma_f32 v[226:227], v[226:227], v[50:51], v[48:49] op_sel_hi:[1,0,0]
    v_pk_fma_f32 v[228:229], v[228:229], v[50:51], v[48:49] op_sel_hi:[1,0,0]
    v_pk_fma_f32 v[230:231], v[230:231], v[50:51], v[48:49] op_sel_hi:[1,0,0]
    v_pk_fma_f32 v[232:233], v[232:233], v[50:51], v[48:49] op_sel_hi:[1,0,0]
    v_pk_fma_f32 v[234:235], v[234:235], v[50:51], v[48:49] op_sel_hi:[1,0,0]
    v_pk_fma_f32 v[236:237], v[236:237], v[50:51], v[48:49] op_sel_hi:[1,0,0]
    v_pk_fma_f32 v[238:239], v[238:239], v[50:51], v[48:49] op_sel_hi:[1,0,0]
    v_pk_fma_f32 v[216:217], v[216:217], v[120:121], v[144:145]
    v_pk_fma_f32 v[218:219], v[218:219], v[122:123], v[146:147]
    v_pk_fma_f32 v[220:221], v[220:221], v[124:125], v[148:149]
    v_pk_fma_f32 v[222:223], v[222:223], v[126:127], v[150:151]
    v_pk_fma_f32 v[224:225], v[224:225], v[128:129], v[152:153]
    v_pk_fma_f32 v[226:227], v[226:227], v[130:131], v[154:155]
    v_pk_fma_f32 v[228:229], v[228:229], v[132:133], v[156:157]
    v_pk_fma_f32 v[230:231], v[230:231], v[134:135], v[158:159]
    v_pk_fma_f32 v[232:233], v[232:233], v[136:137], v[160:161]
    v_pk_fma_f32 v[234:235], v[234:235], v[138:139], v[162:163]
    v_pk_fma_f32 v[236:237], v[236:237], v[140:141], v[164:165]
    v_pk_fma_f32 v[238:239], v[238:239], v[142:143], v[166:167]
    v_cvt_pk_bf16_f32 v64, v216, v217
    v_cvt_pk_bf16_f32 v65, v218, v219
    v_cvt_pk_bf16_f32 v66, v220, v221
    v_cvt_pk_bf16_f32 v67, v222, v223
    v_cvt_pk_bf16_f32 v68, v224, v225
    v_cvt_pk_bf16_f32 v69, v226, v227
    v_cvt_pk_bf16_f32 v70, v228, v229
    v_cvt_pk_bf16_f32 v71, v230, v231
    v_cvt_pk_bf16_f32 v72, v232, v233
    v_cvt_pk_bf16_f32 v73, v234, v235
    v_cvt_pk_bf16_f32 v74, v236, v237
    v_cvt_pk_bf16_f32 v75, v238, v239
    v_lshlrev_b32 v216, 16, v64
    v_and_b32 v217, 0xffff0000, v64
    v_lshlrev_b32 v218, 16, v65
    v_and_b32 v219, 0xffff0000, v65
    v_lshlrev_b32 v220, 16, v66
    v_and_b32 v221, 0xffff0000, v66
    v_lshlrev_b32 v222, 16, v67
    v_and_b32 v223, 0xffff0000, v67
    v_lshlrev_b32 v224, 16, v68
    v_and_b32 v225, 0xffff0000, v68
    v_lshlrev_b32 v226, 16, v69
    v_and_b32 v227, 0xffff0000, v69
    v_lshlrev_b32 v228, 16, v70
    v_and_b32 v229, 0xffff0000, v70
    v_lshlrev_b32 v230, 16, v71
    v_and_b32 v231, 0xffff0000, v71
    v_lshlrev_b32 v232, 16, v72
    v_and_b32 v233, 0xffff0000, v72
    v_lshlrev_b32 v234, 16, v73
    v_and_b32 v235, 0xffff0000, v73
    v_lshlrev_b32 v236, 16, v74
    v_and_b32 v237, 0xffff0000, v74
    v_lshlrev_b32 v238, 16, v75
    v_and_b32 v239, 0xffff0000, v75
    v_pk_mul_f32 v[50:51], v[216:217], v[168:169]
    v_pk_mul_f32 v[52:53], v[224:225], v[176:177]
    v_pk_mul_f32 v[62:63], v[232:233], v[184:185]
    v_pk_fma_f32 v[50:51], v[218:219], v[170:171], v[50:51]
    v_pk_fma_f32 v[52:53], v[226:227], v[178:179], v[52:53]
    v_pk_fma_f32 v[62:63], v[234:235], v[186:187], v[62:63]
    v_pk_fma_f32 v[50:51], v[220:221], v[172:173], v[50:51]
    v_pk_fma_f32 v[52:53], v[228:229], v[180:181], v[52:53]
    v_pk_fma_f32 v[62:63], v[236:237], v[188:189], v[62:63]
    v_pk_fma_f32 v[50:51], v[222:223], v[174:175], v[50:51]
    v_pk_fma_f32 v[52:53], v[230:231], v[182:183], v[52:53]
    v_pk_fma_f32 v[62:63], v[238:239], v[190:191], v[62:63]
    v_pk_add_f32 v[50:51], v[50:51], v[52:53]
    v_add_f32 v62, v62, v63
    v_add_f32 v50, v50, v51
    v_add_f32 v50, v50, v62
    v_lshlrev_b32 v48, 2, v7
    v_and_b32 v48, 28, v48
    v_sub_u32 v49, 2047, v7
    v_add_f32_dpp v50, v50, v50 row_ror:1 row_mask:0xf bank_mask:0xf
    s_nop 1
    v_add_f32_dpp v50, v50, v50 row_ror:2 row_mask:0xf bank_mask:0xf
    s_nop 1
    v_add_f32_dpp v50, v50, v50 row_ror:4 row_mask:0xf bank_mask:0xf
    s_nop 1
    v_add_f32_dpp v50, v50, v50 row_ror:8 row_mask:0xf bank_mask:0xf
    v_mov_b32 v52, v50
    s_nop 1
    v_permlane16_swap_b32 v50, v52
    s_nop 0
    v_add_f32 v50, v50, v52
    v_ashrrev_i32 v52, 31, v50
    v_or_b32 v52, 0x80000000, v52
    v_xor_b32 v52, v52, v50
    v_and_b32 v52, 0xfffff800, v52
    v_min_u32 v52, 0xfffff000, v52
    v_or_b32 v52, v52, v49
    s_mov_b32 exec_lo, 1
    s_mov_b32 exec_hi, 1
    ds_write_b32 v48, v52 offset:36864
    s_mov_b64 exec, -1
    s_waitcnt lgkmcnt(0)
    s_barrier
    v_mov_b32 v141, 36864
    ds_read_b128 v[128:131], v141
    ds_read_b128 v[132:135], v141 offset:16
    s_lshl_b32 s45, s2, 7
    s_add_u32 s45, s45, 9306112
    s_cmp_eq_u32 s3, 0
    s_cselect_b32 s45, s45, 2147483648
    s_waitcnt lgkmcnt(1)
    v_max_u32 v136, v128, v129
    v_min_u32 v137, v128, v129
    v_med3_u32 v137, v136, v137, v130
    v_max_u32 v136, v136, v130
    v_med3_u32 v137, v136, v137, v131
    v_max_u32 v136, v136, v131
    s_waitcnt lgkmcnt(0)
    v_med3_u32 v137, v136, v137, v132
    v_max_u32 v136, v136, v132
Ltour12:
    s_cbranch_execz Ltour16
    v_med3_u32 v137, v136, v137, v133
    v_max_u32 v136, v136, v133
    v_med3_u32 v137, v136, v137, v134
    v_max_u32 v136, v136, v134
    v_med3_u32 v137, v136, v137, v135
    v_max_u32 v136, v136, v135
    buffer_store_dwordx2 v[136:137], v8, s[24:27], s45 offen sc1
    v_and_b32 v138, 0x7ff, v136
    v_and_b32 v139, 0x7ff, v137
    v_cmp_eq_u32 vcc, v138, v49
    v_cmp_eq_u32 s[36:37], v139, v49
    v_mov_b32 v138, 2147483648
    s_or_b64 vcc, vcc, s[36:37]
    s_mov_b32 s45, 2621440
    s_nop 0
    v_cndmask_b32 v6, v138, v6, vcc
    v_cndmask_b32 v60, v138, v60, vcc
    buffer_store_dwordx4 v[64:67], v6, s[24:27], s45 offen offset:0 sc1
    buffer_store_dwordx4 v[68:71], v6, s[24:27], s45 offen offset:512 sc1
    buffer_store_dwordx4 v[72:75], v60, s[24:27], s45 offen offset:1024 sc1
    v_pk_mul_f32 v[192:193], v[192:193], v[216:217]
    v_pk_mul_f32 v[194:195], v[194:195], v[218:219]
    v_pk_mul_f32 v[196:197], v[196:197], v[220:221]
    v_pk_mul_f32 v[198:199], v[198:199], v[222:223]
    v_pk_mul_f32 v[200:201], v[200:201], v[224:225]
    v_pk_mul_f32 v[202:203], v[202:203], v[226:227]
    v_pk_mul_f32 v[204:205], v[204:205], v[228:229]
    v_pk_mul_f32 v[206:207], v[206:207], v[230:231]
    v_pk_mul_f32 v[208:209], v[208:209], v[232:233]
    v_pk_mul_f32 v[210:211], v[210:211], v[234:235]
    v_pk_mul_f32 v[212:213], v[212:213], v[236:237]
    v_pk_mul_f32 v[214:215], v[214:215], v[238:239]
    v_cvt_pk_bf16_f32 v144, v192, v193
    v_cvt_pk_bf16_f32 v145, v194, v195
    v_cvt_pk_bf16_f32 v146, v196, v197
    v_cvt_pk_bf16_f32 v147, v198, v199
    v_cvt_pk_bf16_f32 v148, v200, v201
    v_cvt_pk_bf16_f32 v149, v202, v203
    v_cvt_pk_bf16_f32 v150, v204, v205
    v_cvt_pk_bf16_f32 v151, v206, v207
    v_cvt_pk_bf16_f32 v152, v208, v209
    v_cvt_pk_bf16_f32 v153, v210, v211
    v_cvt_pk_bf16_f32 v154, v212, v213
    v_cvt_pk_bf16_f32 v155, v214, v215
    v_lshlrev_b32 v192, 16, v144
    v_and_b32 v193, 0xffff0000, v144
    v_lshlrev_b32 v194, 16, v145
    v_and_b32 v195, 0xffff0000, v145
    v_lshlrev_b32 v196, 16, v146
    v_and_b32 v197, 0xffff0000, v146
    v_lshlrev_b32 v198, 16, v147
    v_and_b32 v199, 0xffff0000, v147
    v_lshlrev_b32 v200, 16, v148
    v_and_b32 v201, 0xffff0000, v148
    v_lshlrev_b32 v202, 16, v149
    v_and_b32 v203, 0xffff0000, v149
    v_lshlrev_b32 v204, 16, v150
    v_and_b32 v205, 0xffff0000, v150
    v_lshlrev_b32 v206, 16, v151
    v_and_b32 v207, 0xffff0000, v151
    v_lshlrev_b32 v208, 16, v152
    v_and_b32 v209, 0xffff0000, v152
    v_lshlrev_b32 v210, 16, v153
    v_and_b32 v211, 0xffff0000, v153
    v_lshlrev_b32 v212, 16, v154
    v_and_b32 v213, 0xffff0000, v154
    v_lshlrev_b32 v214, 16, v155
    v_and_b32 v215, 0xffff0000, v155
    v_pk_add_f32 v[192:193], v[192:193], v[12:13]
    v_pk_add_f32 v[194:195], v[194:195], v[14:15]
    v_pk_add_f32 v[196:197], v[196:197], v[16:17]
    v_pk_add_f32 v[198:199], v[198:199], v[18:19]
    v_pk_add_f32 v[200:201], v[200:201], v[20:21]
    v_pk_add_f32 v[202:203], v[202:203], v[22:23]
    v_pk_add_f32 v[204:205], v[204:205], v[24:25]
    v_pk_add_f32 v[206:207], v[206:207], v[26:27]
    v_pk_add_f32 v[208:209], v[208:209], v[28:29]
    v_pk_add_f32 v[210:211], v[210:211], v[30:31]
    v_pk_add_f32 v[212:213], v[212:213], v[32:33]
    v_pk_add_f32 v[214:215], v[214:215], v[34:35]
    v_cvt_pk_bf16_f32 v156, v192, v193
    v_cvt_pk_bf16_f32 v157, v194, v195
    v_cvt_pk_bf16_f32 v158, v196, v197
    v_cvt_pk_bf16_f32 v159, v198, v199
    v_cvt_pk_bf16_f32 v160, v200, v201
    v_cvt_pk_bf16_f32 v161, v202, v203
    v_cvt_pk_bf16_f32 v162, v204, v205
    v_cvt_pk_bf16_f32 v163, v206, v207
    v_cvt_pk_bf16_f32 v164, v208, v209
    v_cvt_pk_bf16_f32 v165, v210, v211
    v_cvt_pk_bf16_f32 v166, v212, v213
    v_cvt_pk_bf16_f32 v167, v214, v215
    v_and_b32 v30, 2, v1
    v_cmp_ne_u32 vcc, 0, v30
    v_mul_u32_u24 v30, 1152, v7
    v_add_u32 v4, v30, v5
    v_add_u32 v58, v30, v59
    v_mov_b32_dpp v192, v158 quad_perm:[0,2,0,2] row_mask:0xf bank_mask:0xf
    v_mov_b32_dpp v193, v159 quad_perm:[0,2,0,2] row_mask:0xf bank_mask:0xf
    v_mov_b32_dpp v194, v158 quad_perm:[1,3,1,3] row_mask:0xf bank_mask:0xf
    v_mov_b32_dpp v195, v159 quad_perm:[1,3,1,3] row_mask:0xf bank_mask:0xf
    v_mov_b32_dpp v196, v162 quad_perm:[0,2,0,2] row_mask:0xf bank_mask:0xf
    v_mov_b32_dpp v197, v163 quad_perm:[0,2,0,2] row_mask:0xf bank_mask:0xf
    v_mov_b32_dpp v198, v162 quad_perm:[1,3,1,3] row_mask:0xf bank_mask:0xf
    v_mov_b32_dpp v199, v163 quad_perm:[1,3,1,3] row_mask:0xf bank_mask:0xf
    v_mov_b32_dpp v200, v166 quad_perm:[0,2,0,2] row_mask:0xf bank_mask:0xf
    v_mov_b32_dpp v201, v167 quad_perm:[0,2,0,2] row_mask:0xf bank_mask:0xf
    v_mov_b32_dpp v202, v166 quad_perm:[1,3,1,3] row_mask:0xf bank_mask:0xf
    v_mov_b32_dpp v203, v167 quad_perm:[1,3,1,3] row_mask:0xf bank_mask:0xf
    v_cndmask_b32_dpp v144, v156, v192, vcc quad_perm:[0,2,0,2] row_mask:0xf bank_mask:0xf
    v_cndmask_b32_dpp v145, v157, v193, vcc quad_perm:[0,2,0,2] row_mask:0xf bank_mask:0xf
    v_cndmask_b32_dpp v146, v156, v194, vcc quad_perm:[1,3,1,3] row_mask:0xf bank_mask:0xf
    v_cndmask_b32_dpp v147, v157, v195, vcc quad_perm:[1,3,1,3] row_mask:0xf bank_mask:0xf
    v_cndmask_b32_dpp v148, v160, v196, vcc quad_perm:[0,2,0,2] row_mask:0xf bank_mask:0xf
    v_cndmask_b32_dpp v149, v161, v197, vcc quad_perm:[0,2,0,2] row_mask:0xf bank_mask:0xf
    v_cndmask_b32_dpp v150, v160, v198, vcc quad_perm:[1,3,1,3] row_mask:0xf bank_mask:0xf
    v_cndmask_b32_dpp v151, v161, v199, vcc quad_perm:[1,3,1,3] row_mask:0xf bank_mask:0xf
    v_cndmask_b32_dpp v152, v164, v200, vcc quad_perm:[0,2,0,2] row_mask:0xf bank_mask:0xf
    v_cndmask_b32_dpp v153, v165, v201, vcc quad_perm:[0,2,0,2] row_mask:0xf bank_mask:0xf
    v_cndmask_b32_dpp v154, v164, v202, vcc quad_perm:[1,3,1,3] row_mask:0xf bank_mask:0xf
    v_cndmask_b32_dpp v155, v165, v203, vcc quad_perm:[1,3,1,3] row_mask:0xf bank_mask:0xf
    buffer_store_dwordx4 v[144:147], v4, s[16:19], 0 offen offset:0 sc1
    buffer_store_dwordx4 v[148:151], v4, s[16:19], 0 offen offset:512 sc1
    buffer_store_dwordx4 v[152:155], v58, s[16:19], 0 offen offset:1024 sc1
    s_cmp_ge_u32 s41, 18
    s_cbranch_scc1 Ltail_idle
    s_add_u32 s57, s59, 4096
    s_add_u32 m0, s6, -110592
    s_nop 0
    buffer_load_dwordx4 v255, s[84:87], s57 offen lds
    s_add_u32 s57, s59, 8192
    s_add_u32 m0, s6, -106496
    s_nop 0
    buffer_load_dwordx4 v255, s[84:87], s57 offen lds
    s_add_u32 s57, s59, 12288
    s_add_u32 m0, s6, -102400
    s_nop 0
    buffer_load_dwordx4 v255, s[84:87], s57 offen lds
    s_add_u32 s57, s59, 16384
    s_add_u32 m0, s6, -98304
    s_nop 0
    buffer_load_dwordx4 v255, s[84:87], s57 offen lds
    s_add_u32 s57, s59, 20480
    s_add_u32 m0, s6, -94208
    s_nop 0
    buffer_load_dwordx4 v255, s[84:87], s57 offen lds
    s_add_u32 s57, s59, 24576
    s_add_u32 m0, s6, -90112
    s_nop 0
    buffer_load_dwordx4 v255, s[84:87], s57 offen lds
    s_add_u32 s57, s59, 28672
    s_add_u32 m0, s6, -86016
    s_nop 0
    buffer_load_dwordx4 v255, s[84:87], s57 offen lds
    s_add_u32 s57, s59, 32768
    s_add_u32 m0, s6, -81920
    s_nop 0
    buffer_load_dwordx4 v255, s[84:87], s57 offen lds
    s_mov_b32 s38, 135168
    s_mov_b32 s39, 12288
    v_lshrrev_b32 v9, 2, v1
    v_and_b32 v10, 3, v1
    v_lshlrev_b32 v10, 3, v10
    s_and_b32 s45, s3, 1
    s_lshl_b32 s45, s45, 5
    v_lshl_add_u32 v11, v9, 6, v10
    v_add_u32 v11, s45, v11
    s_cmp_lt_u32 s3, 2
    s_cselect_b32 s44, 98304, s38
    s_cselect_b32 s45, 98304, s39
    v_add_u32 v12, s45, v11
    v_add_u32 v11, s44, v11
    ds_read_b64_tr_b16 a[0:1], v11 offset:0
    ds_read_b64_tr_b16 a[2:3], v11 offset:1024
    ds_read_b64_tr_b16 a[4:5], v11 offset:2048
    ds_read_b64_tr_b16 a[6:7], v11 offset:3072
    ds_read_b64_tr_b16 a[8:9], v11 offset:4096
    ds_read_b64_tr_b16 a[10:11], v11 offset:5120
    ds_read_b64_tr_b16 a[12:13], v11 offset:6144
    ds_read_b64_tr_b16 a[14:15], v11 offset:7168
    ds_read_b64_tr_b16 a[16:17], v11 offset:8192
    ds_read_b64_tr_b16 a[18:19], v11 offset:9216
    ds_read_b64_tr_b16 a[20:21], v11 offset:10240
    ds_read_b64_tr_b16 a[22:23], v11 offset:11264
    ds_read_b64_tr_b16 a[24:25], v11 offset:12288
    ds_read_b64_tr_b16 a[26:27], v11 offset:13312
    ds_read_b64_tr_b16 a[28:29], v11 offset:14336
    ds_read_b64_tr_b16 a[30:31], v11 offset:15360
    ds_read_b64_tr_b16 a[32:33], v11 offset:16384
    ds_read_b64_tr_b16 a[34:35], v11 offset:17408
    ds_read_b64_tr_b16 a[36:37], v11 offset:18432
    ds_read_b64_tr_b16 a[38:39], v11 offset:19456
    ds_read_b64_tr_b16 a[40:41], v11 offset:20480
    ds_read_b64_tr_b16 a[42:43], v11 offset:21504
    ds_read_b64_tr_b16 a[44:45], v11 offset:22528
    ds_read_b64_tr_b16 a[46:47], v11 offset:23552
    ds_read_b64_tr_b16 a[48:49], v11 offset:24576
    ds_read_b64_tr_b16 a[50:51], v11 offset:25600
    ds_read_b64_tr_b16 a[52:53], v11 offset:26624
    ds_read_b64_tr_b16 a[54:55], v11 offset:27648
    ds_read_b64_tr_b16 a[56:57], v12 offset:28672
    ds_read_b64_tr_b16 a[58:59], v12 offset:29696
    ds_read_b64_tr_b16 a[60:61], v12 offset:30720
    ds_read_b64_tr_b16 a[62:63], v12 offset:31744
    ds_read_b64_tr_b16 a[64:65], v12 offset:32768
    ds_read_b64_tr_b16 a[66:67], v12 offset:33792
    ds_read_b64_tr_b16 a[68:69], v12 offset:34816
    ds_read_b64_tr_b16 a[70:71], v12 offset:35840
    v_mul_u32_u24 v12, 1152, v9
    s_lshl_b32 s44, s3, 7
    s_add_u32 s44, s44, 49152
    v_add3_u32 v12, v12, v10, s44
    v_lshlrev_b32 v13, 4, v1
    v_add_u32 v13, 32768, v13
    s_lshl_b32 s44, s3, 10
    v_add_u32 v14, s44, v13
    v_and_b32 v13, 0xffffff1f, v13
    v_bfe_u32 v15, v1, 2, 2
    v_cmp_eq_u32 s[52:53], 0, v15
    v_cmp_eq_u32 s[54:55], 1, v15
    v_cmp_eq_u32 s[56:57], 2, v15
    v_cmp_eq_u32 s[58:59], 3, v15
    s_mul_i32 s43, s42, 18
    s_add_u32 s43, s43, s41
    s_lshl_b32 s43, s43, 9
    s_mul_i32 s44, s3, 73728
    s_add_u32 s43, s43, s44
    v_lshlrev_b32 v15, 3, v1
    v_lshlrev_b32 v140, 7, v0
    s_mov_b32 s45, 9306112
    s_lshl_b32 s36, s3, 3
    v_mov_b32 v141, s36
    s_mov_b32 s48, 16384
Ltail_pollk:
    buffer_load_dwordx2 v[136:137], v140, s[24:27], s45 offen sc1
    s_sub_u32 s48, s48, 1
    s_cbranch_scc1 Ltail_gotk
    s_waitcnt vmcnt(0)
    v_max_u32 v138, v136, v137
    v_cmp_eq_u32 vcc, -1, v138
    s_cbranch_vccnz Ltail_pollk
Ltail_gotk:
    s_waitcnt vmcnt(0)
    s_mov_b32 s36, 2622592
    buffer_store_dwordx4 v[36:39], v6, s[24:27], s36 offen offset:0 sc1
    buffer_store_dwordx4 v[40:43], v6, s[24:27], s36 offen offset:512 sc1
    buffer_store_dwordx4 v[44:47], v60, s[24:27], s36 offen offset:1024 sc1
    v_mov_b32_dpp v138, v136 row_ror:1 row_mask:0xf bank_mask:0xf
    v_mov_b32_dpp v139, v137 row_ror:1 row_mask:0xf bank_mask:0xf
    v_min_u32 v142, v136, v138
    v_max_u32 v136, v136, v138
    v_max3_u32 v137, v142, v137, v139
    s_nop 0
    v_mov_b32_dpp v138, v136 row_ror:2 row_mask:0xf bank_mask:0xf
    v_mov_b32_dpp v139, v137 row_ror:2 row_mask:0xf bank_mask:0xf
    v_min_u32 v142, v136, v138
    v_max_u32 v136, v136, v138
    v_max3_u32 v137, v142, v137, v139
    s_nop 0
    v_mov_b32_dpp v138, v136 row_ror:4 row_mask:0xf bank_mask:0xf
    v_mov_b32_dpp v139, v137 row_ror:4 row_mask:0xf bank_mask:0xf
    v_min_u32 v142, v136, v138
    v_max_u32 v136, v136, v138
    v_max3_u32 v137, v142, v137, v139
    s_nop 0
    v_mov_b32_dpp v138, v136 row_ror:8 row_mask:0xf bank_mask:0xf
    v_mov_b32_dpp v139, v137 row_ror:8 row_mask:0xf bank_mask:0xf
    v_min_u32 v142, v136, v138
    v_max_u32 v136, v136, v138
    v_max3_u32 v137, v142, v137, v139
    v_mov_b32 v138, v136
    v_mov_b32 v139, v137
    s_nop 0
    v_permlane16_swap_b32 v136, v138
    v_permlane16_swap_b32 v137, v139
    v_min_u32 v142, v136, v138
    v_max_u32 v136, v136, v138
    v_max3_u32 v137, v142, v137, v139
    v_mov_b32 v138, v136
    v_mov_b32 v139, v137
    s_nop 0
    v_permlane32_swap_b32 v136, v138
    v_permlane32_swap_b32 v137, v139
    v_min_u32 v142, v136, v138
    v_max_u32 v136, v136, v138
    v_max3_u32 v137, v142, v137, v139
    ds_write_b64 v141, v[136:137] offset:36928
    v_mov_b32 v141, 36928
    s_waitcnt lgkmcnt(0)
    s_barrier
    ds_read_b128 v[128:131], v141
    ds_read_b128 v[132:135], v141 offset:16
    s_or_b32 s36, s2, s3
    s_cselect_b32 s45, -4, 24576
    s_add_u32 s36, s94, 1
    v_mov_b32 v138, s36
    buffer_store_dword v138, v8, s[24:27], s45 offen sc1
    s_waitcnt lgkmcnt(1)
    v_max_u32 v136, v128, v129
    v_min_u32 v137, v128, v129
    v_med3_u32 v137, v136, v137, v130
    v_max_u32 v136, v136, v130
    v_med3_u32 v137, v136, v137, v131
    v_max_u32 v136, v136, v131
    s_waitcnt lgkmcnt(0)
    v_med3_u32 v137, v136, v137, v132
    v_max_u32 v136, v136, v132
    v_med3_u32 v137, v136, v137, v133
    v_max_u32 v136, v136, v133
    v_med3_u32 v137, v136, v137, v134
    v_max_u32 v136, v136, v134
    v_med3_u32 v137, v136, v137, v135
    v_max_u32 v136, v136, v135
    s_nop 0
    v_readfirstlane_b32 s92, v136
    v_readfirstlane_b32 s93, v137
    s_andn2_b32 s46, 0x7ff, s92
    s_andn2_b32 s47, 0x7ff, s93
    s_cmp_ge_u32 s41, 18
    s_cbranch_scc1 Ltail_noffn
    s_mul_i32 s44, s46, 2304
    s_mul_i32 s45, s47, 2304
    s_sub_u32 s45, s45, s44
    v_and_b32 v8, 1, v1
    v_mul_lo_u32 v8, v8, s45
    v_and_b32 v9, 48, v1
    v_add3_u32 v8, v8, v9, s44
    s_mov_b32 s45, 2621440
    s_mov_b32 s48, 16384
Ltail_pollh:
    s_mov_b32 exec_lo, 0x30003
    s_mov_b32 exec_hi, 0x30003
    buffer_load_dwordx4 a[120:123], v8, s[24:27], s45 offen offset:0 sc1
    buffer_load_dwordx4 a[124:127], v8, s[24:27], s45 offen offset:64 sc1
    buffer_load_dwordx4 a[128:131], v8, s[24:27], s45 offen offset:128 sc1
    buffer_load_dwordx4 a[132:135], v8, s[24:27], s45 offen offset:192 sc1
    buffer_load_dwordx4 a[136:139], v8, s[24:27], s45 offen offset:256 sc1
    buffer_load_dwordx4 a[140:143], v8, s[24:27], s45 offen offset:320 sc1
    buffer_load_dwordx4 a[144:147], v8, s[24:27], s45 offen offset:384 sc1
    buffer_load_dwordx4 a[148:151], v8, s[24:27], s45 offen offset:448 sc1
    buffer_load_dwordx4 a[152:155], v8, s[24:27], s45 offen offset:512 sc1
    buffer_load_dwordx4 a[156:159], v8, s[24:27], s45 offen offset:576 sc1
    buffer_load_dwordx4 a[160:163], v8, s[24:27], s45 offen offset:640 sc1
    buffer_load_dwordx4 a[164:167], v8, s[24:27], s45 offen offset:704 sc1
    buffer_load_dwordx4 a[168:171], v8, s[24:27], s45 offen offset:768 sc1
    buffer_load_dwordx4 a[172:175], v8, s[24:27], s45 offen offset:832 sc1
    buffer_load_dwordx4 a[176:179], v8, s[24:27], s45 offen offset:896 sc1
    buffer_load_dwordx4 a[180:183], v8, s[24:27], s45 offen offset:960 sc1
    buffer_load_dwordx4 a[184:187], v8, s[24:27], s45 offen offset:1024 sc1
    buffer_load_dwordx4 a[188:191], v8, s[24:27], s45 offen offset:1088 sc1
    s_mov_b64 exec, -1
    ds_read_b64_tr_b16 a[72:73], v12 offset:0
    ds_read_b64_tr_b16 a[74:75], v12 offset:18432
    ds_read_b64_tr_b16 a[76:77], v12 offset:32
    ds_read_b64_tr_b16 a[78:79], v12 offset:18464
    ds_read_b64_tr_b16 a[80:81], v12 offset:64
    ds_read_b64_tr_b16 a[82:83], v12 offset:18496
    ds_read_b64_tr_b16 a[84:85], v12 offset:96
    ds_read_b64_tr_b16 a[86:87], v12 offset:18528
    ds_read_b64_tr_b16 a[88:89], v12 offset:512
    ds_read_b64_tr_b16 a[90:91], v12 offset:18944
    ds_read_b64_tr_b16 a[92:93], v12 offset:544
    ds_read_b64_tr_b16 a[94:95], v12 offset:18976
    ds_read_b64_tr_b16 a[96:97], v12 offset:576
    ds_read_b64_tr_b16 a[98:99], v12 offset:19008
    ds_read_b64_tr_b16 a[100:101], v12 offset:608
    ds_read_b64_tr_b16 a[102:103], v12 offset:19040
    ds_read_b64_tr_b16 a[104:105], v12 offset:1024
    ds_read_b64_tr_b16 a[106:107], v12 offset:19456
    ds_read_b64_tr_b16 a[108:109], v12 offset:1056
    ds_read_b64_tr_b16 a[110:111], v12 offset:19488
    ds_read_b64_tr_b16 a[112:113], v12 offset:1088
    ds_read_b64_tr_b16 a[114:115], v12 offset:19520
    ds_read_b64_tr_b16 a[116:117], v12 offset:1120
    ds_read_b64_tr_b16 a[118:119], v12 offset:19552
    s_waitcnt vmcnt(17)
    v_mfma_f32_16x16x32_bf16 v[16:19], a[0:3], a[120:123], 0
    s_waitcnt vmcnt(16)
    v_mfma_f32_16x16x32_bf16 v[20:23], a[4:7], a[124:127], 0
    s_waitcnt vmcnt(15)
    v_mfma_f32_16x16x32_bf16 v[16:19], a[8:11], a[128:131], v[16:19]
    s_waitcnt vmcnt(14)
    v_mfma_f32_16x16x32_bf16 v[20:23], a[12:15], a[132:135], v[20:23]
    s_waitcnt vmcnt(13)
    v_mfma_f32_16x16x32_bf16 v[16:19], a[16:19], a[136:139], v[16:19]
    s_waitcnt vmcnt(12)
    v_mfma_f32_16x16x32_bf16 v[20:23], a[20:23], a[140:143], v[20:23]
    s_waitcnt vmcnt(11)
    v_mfma_f32_16x16x32_bf16 v[16:19], a[24:27], a[144:147], v[16:19]
    s_waitcnt vmcnt(10)
    v_mfma_f32_16x16x32_bf16 v[20:23], a[28:31], a[148:151], v[20:23]
    s_waitcnt vmcnt(9)
    v_mfma_f32_16x16x32_bf16 v[16:19], a[32:35], a[152:155], v[16:19]
    s_waitcnt vmcnt(8)
    v_mfma_f32_16x16x32_bf16 v[20:23], a[36:39], a[156:159], v[20:23]
    s_waitcnt vmcnt(7)
    v_mfma_f32_16x16x32_bf16 v[16:19], a[40:43], a[160:163], v[16:19]
    s_waitcnt vmcnt(6)
    v_mfma_f32_16x16x32_bf16 v[20:23], a[44:47], a[164:167], v[20:23]
    s_waitcnt vmcnt(5)
    v_mfma_f32_16x16x32_bf16 v[16:19], a[48:51], a[168:171], v[16:19]
    s_waitcnt vmcnt(4)
    v_mfma_f32_16x16x32_bf16 v[20:23], a[52:55], a[172:175], v[20:23]
    s_waitcnt vmcnt(3)
    v_mfma_f32_16x16x32_bf16 v[16:19], a[56:59], a[176:179], v[16:19]
    s_waitcnt vmcnt(2)
    v_mfma_f32_16x16x32_bf16 v[20:23], a[60:63], a[180:183], v[20:23]
    s_waitcnt vmcnt(1)
    v_mfma_f32_16x16x32_bf16 v[16:19], a[64:67], a[184:187], v[16:19]
    s_waitcnt vmcnt(0)
    v_mfma_f32_16x16x32_bf16 v[20:23], a[68:71], a[188:191], v[20:23]
    s_sub_u32 s48, s48, 1
    s_nop 6
    v_pk_add_f32 v[16:17], v[16:17], v[20:21]
    v_pk_add_f32 v[18:19], v[18:19], v[22:23]
    s_cbranch_scc1 Ltail_goth
    v_cmp_u_f32 vcc, v16, v16
    s_and_b32 s36, vcc_lo, 3
    s_cbranch_scc1 Ltail_pollh
Ltail_goth:
    ds_write_b128 v14, v[16:19]
    s_waitcnt lgkmcnt(0)
    s_barrier
    ds_read_b128 v[16:19], v13 offset:0
    ds_read_b128 v[20:23], v13 offset:1024
    ds_read_b128 v[24:27], v13 offset:2048
    ds_read_b128 v[28:31], v13 offset:3072
    s_mov_b32 s36, 0xbfb8aa3b
    s_mov_b32 s37, 0xbfb8aa3b
    s_waitcnt lgkmcnt(3)
    v_cvt_pk_bf16_f32 v32, v16, v17
    v_cvt_pk_bf16_f32 v33, v18, v19
    s_waitcnt lgkmcnt(2)
    v_cvt_pk_bf16_f32 v34, v20, v21
    v_cvt_pk_bf16_f32 v35, v22, v23
    v_lshlrev_b32 v16, 16, v32
    v_and_b32 v17, 0xffff0000, v32
    v_lshlrev_b32 v18, 16, v33
    v_and_b32 v19, 0xffff0000, v33
    v_lshlrev_b32 v20, 16, v34
    v_and_b32 v21, 0xffff0000, v34
    v_lshlrev_b32 v22, 16, v35
    v_and_b32 v23, 0xffff0000, v35
    v_pk_mul_f32 v[32:33], v[16:17], s[36:37]
    v_pk_mul_f32 v[34:35], v[18:19], s[36:37]
    v_pk_mul_f32 v[36:37], v[20:21], s[36:37]
    v_pk_mul_f32 v[38:39], v[22:23], s[36:37]
    v_exp_f32 v32, v32
    v_exp_f32 v33, v33
    v_exp_f32 v34, v34
    v_exp_f32 v35, v35
    v_exp_f32 v36, v36
    v_exp_f32 v37, v37
    v_exp_f32 v38, v38
    v_exp_f32 v39, v39
    s_waitcnt lgkmcnt(1)
    v_cvt_pk_bf16_f32 v60, v24, v25
    v_cvt_pk_bf16_f32 v61, v26, v27
    s_waitcnt lgkmcnt(0)
    v_cvt_pk_bf16_f32 v62, v28, v29
    v_cvt_pk_bf16_f32 v63, v30, v31
    v_pk_add_f32 v[32:33], v[32:33], 1.0 op_sel_hi:[1,0]
    v_pk_add_f32 v[34:35], v[34:35], 1.0 op_sel_hi:[1,0]
    v_pk_add_f32 v[36:37], v[36:37], 1.0 op_sel_hi:[1,0]
    v_pk_add_f32 v[38:39], v[38:39], 1.0 op_sel_hi:[1,0]
    v_rcp_f32 v32, v32
    v_rcp_f32 v33, v33
    v_rcp_f32 v34, v34
    v_rcp_f32 v35, v35
    v_rcp_f32 v36, v36
    v_rcp_f32 v37, v37
    v_rcp_f32 v38, v38
    v_rcp_f32 v39, v39
    v_lshlrev_b32 v24, 16, v60
    v_and_b32 v25, 0xffff0000, v60
    v_lshlrev_b32 v26, 16, v61
    v_and_b32 v27, 0xffff0000, v61
    v_lshlrev_b32 v28, 16, v62
    v_and_b32 v29, 0xffff0000, v62
    v_lshlrev_b32 v30, 16, v63
    v_and_b32 v31, 0xffff0000, v63
    v_pk_mul_f32 v[16:17], v[16:17], v[32:33]
    v_pk_mul_f32 v[18:19], v[18:19], v[34:35]
    v_pk_mul_f32 v[20:21], v[20:21], v[36:37]
    v_pk_mul_f32 v[22:23], v[22:23], v[38:39]
    v_cvt_pk_bf16_f32 v32, v16, v17
    v_cvt_pk_bf16_f32 v33, v18, v19
    v_cvt_pk_bf16_f32 v34, v20, v21
    v_cvt_pk_bf16_f32 v35, v22, v23
    v_lshlrev_b32 v16, 16, v32
    v_and_b32 v17, 0xffff0000, v32
    v_lshlrev_b32 v18, 16, v33
    v_and_b32 v19, 0xffff0000, v33
    v_lshlrev_b32 v20, 16, v34
    v_and_b32 v21, 0xffff0000, v34
    v_lshlrev_b32 v22, 16, v35
    v_and_b32 v23, 0xffff0000, v35
    v_pk_mul_f32 v[16:17], v[16:17], v[24:25]
    v_pk_mul_f32 v[18:19], v[18:19], v[26:27]
    v_pk_mul_f32 v[20:21], v[20:21], v[28:29]
    v_pk_mul_f32 v[22:23], v[22:23], v[30:31]
    v_cvt_pk_bf16_f32 v32, v16, v17
    v_cvt_pk_bf16_f32 v33, v18, v19
    v_cvt_pk_bf16_f32 v34, v20, v21
    v_cvt_pk_bf16_f32 v35, v22, v23
    v_cndmask_b32 v64, 0, v32, s[52:53]
    v_cndmask_b32 v65, 0, v33, s[52:53]
    v_cndmask_b32 v66, 0, v34, s[52:53]
    v_cndmask_b32 v67, 0, v35, s[52:53]
    v_cndmask_b32 v68, 0, v32, s[54:55]
    v_cndmask_b32 v69, 0, v33, s[54:55]
    v_cndmask_b32 v70, 0, v34, s[54:55]
    v_cndmask_b32 v71, 0, v35, s[54:55]
    v_cndmask_b32 v72, 0, v32, s[56:57]
    v_cndmask_b32 v73, 0, v33, s[56:57]
    v_cndmask_b32 v74, 0, v34, s[56:57]
    v_cndmask_b32 v75, 0, v35, s[56:57]
    v_cndmask_b32 v76, 0, v32, s[58:59]
    v_cndmask_b32 v77, 0, v33, s[58:59]
    v_cndmask_b32 v78, 0, v34, s[58:59]
    v_cndmask_b32 v79, 0, v35, s[58:59]
    v_mfma_f32_16x16x32_bf16 v[16:19], v[64:67], a[72:75], 0
    v_mfma_f32_16x16x32_bf16 v[16:19], v[68:71], a[76:79], v[16:19]
    v_mfma_f32_16x16x32_bf16 v[16:19], v[72:75], a[80:83], v[16:19]
    v_mfma_f32_16x16x32_bf16 v[16:19], v[76:79], a[84:87], v[16:19]
    v_mfma_f32_16x16x32_bf16 v[20:23], v[64:67], a[88:91], 0
    v_mfma_f32_16x16x32_bf16 v[20:23], v[68:71], a[92:95], v[20:23]
    v_mfma_f32_16x16x32_bf16 v[20:23], v[72:75], a[96:99], v[20:23]
    v_mfma_f32_16x16x32_bf16 v[20:23], v[76:79], a[100:103], v[20:23]
    v_mfma_f32_16x16x32_bf16 v[24:27], v[64:67], a[104:107], 0
    v_mfma_f32_16x16x32_bf16 v[24:27], v[68:71], a[108:111], v[24:27]
    v_mfma_f32_16x16x32_bf16 v[24:27], v[72:75], a[112:115], v[24:27]
    v_mfma_f32_16x16x32_bf16 v[24:27], v[76:79], a[116:119], v[24:27]
    v_min_u32 v16, -2, v16
    v_min_u32 v17, -2, v17
    buffer_store_dwordx2 v[16:17], v15, s[8:11], s43 offen sc1
    s_add_u32 s43, s43, 294912
    v_min_u32 v20, -2, v20
    v_min_u32 v21, -2, v21
    buffer_store_dwordx2 v[20:21], v15, s[8:11], s43 offen sc1
    s_add_u32 s43, s43, 294912
    v_min_u32 v24, -2, v24
    v_min_u32 v25, -2, v25
    buffer_store_dwordx2 v[24:25], v15, s[8:11], s43 offen sc1
    s_cmp_lt_u32 s41, 9
    s_cselect_b32 s36, s3, 0
    s_cmp_eq_u32 s36, 3
    s_cbranch_scc1 Ltail_final
Ltail_noffn:
    s_branch Ltail_done
Ltail_idle:
    s_waitcnt vmcnt(0)
    s_mov_b32 s36, 2622592
    buffer_store_dwordx4 v[36:39], v6, s[24:27], s36 offen offset:0 sc1
    buffer_store_dwordx4 v[40:43], v6, s[24:27], s36 offen offset:512 sc1
    buffer_store_dwordx4 v[44:47], v60, s[24:27], s36 offen offset:1024 sc1
    s_branch Ltail_done
Ltail_final:
Ltour13:
    s_cbranch_execz Ltour17
    s_mul_i32 s43, s42, 9
    s_add_u32 s43, s43, s41
    v_bfe_u32 v8, v1, 2, 1
    v_cmp_eq_u32 vcc, 1, v8
    v_mov_b32 v9, s46
    v_mov_b32 v10, s47
    v_and_b32 v11, 3, v1
    v_cndmask_b32 v9, v9, v10, vcc
    s_lshr_b32 s44, s43, 2
    s_lshl_b32 s44, s44, 6
    s_and_b32 s45, s43, 1
    s_lshl_b32 s45, s45, 5
    s_add_u32 s44, s44, s45
    s_and_b32 s45, s43, 2
    s_lshl_b32 s45, s45, 2
    s_add_u32 s44, s44, s45
    v_lshrrev_b32 v12, 1, v11
    v_lshl_add_u32 v12, v12, 4, s44
    v_and_b32 v13, 1, v11
    v_lshl_add_u32 v12, v13, 2, v12
    v_mul_u32_u24 v13, 1152, v9
    v_lshl_add_u32 v14, v13, 1, v12
    v_add_u32 v15, 2621440, v14
    s_mov_b32 s45, 22144
    buffer_load_dword v18, v12, s[24:27], s45 offen sc1
    v_mov_b32 v19, s92
    v_mov_b32 v10, s93
    v_cndmask_b32 v19, v19, v10, vcc
    v_and_b32 v19, 0xfffff800, v19
    v_or_b32 v19, 0x400, v19
    v_ashrrev_i32 v10, 31, v19
    v_not_b32 v10, v10
    v_or_b32 v10, 0x80000000, v10
    v_xor_b32 v19, v19, v10
    s_lshl_b32 s45, s43, 4
    v_lshl_add_u32 v13, v11, 2, v13
    v_add_u32 v13, s45, v13
    v_lshrrev_b32 v14, 2, v1
    v_lshlrev_b32 v14, 9, v14
    v_lshl_add_u32 v14, v11, 4, v14
    s_lshr_b32 s44, s43, 3
    s_mul_i32 s44, s44, 73728
    s_and_b32 s45, s43, 7
    s_lshl_b32 s45, s45, 6
    s_add_u32 s44, s44, s45
    v_cmp_eq_u32 s[38:39], 1, v8
    v_cvt_pk_bf16_f32 v19, v19, v19
    v_and_b32 v19, 0xffff0000, v19
    v_mul_f32 v19, 0xbfb8aa3b, v19
    v_exp_f32 v19, v19
    s_waitcnt vmcnt(0)
    v_lshlrev_b32 v24, 16, v18
    v_and_b32 v25, 0xffff0000, v18
    v_add_f32 v19, 1.0, v19
    v_rcp_f32 v19, v19
    s_mov_b32 s48, 16384
    v_cvt_pk_bf16_f32 v19, v19, v19
    v_and_b32 v19, 0xffff0000, v19
Ltail_polly:
    s_add_u32 s45, s44, 0
    buffer_load_dwordx4 v[64:67], v14, s[8:11], s45 offen sc1
    s_add_u32 s45, s44, 8192
    buffer_load_dwordx4 v[68:71], v14, s[8:11], s45 offen sc1
    s_add_u32 s45, s44, 16384
    buffer_load_dwordx4 v[72:75], v14, s[8:11], s45 offen sc1
    s_add_u32 s45, s44, 24576
    buffer_load_dwordx4 v[76:79], v14, s[8:11], s45 offen sc1
    s_add_u32 s45, s44, 32768
    buffer_load_dwordx4 v[80:83], v14, s[8:11], s45 offen sc1
    s_add_u32 s45, s44, 40960
    buffer_load_dwordx4 v[84:87], v14, s[8:11], s45 offen sc1
Ltour14:
    s_cbranch_execz Lmain
    s_add_u32 s45, s44, 49152
    buffer_load_dwordx4 v[88:91], v14, s[8:11], s45 offen sc1
    s_add_u32 s45, s44, 57344
    buffer_load_dwordx4 v[92:95], v14, s[8:11], s45 offen sc1
    s_add_u32 s45, s44, 65536
    buffer_load_dwordx4 v[96:99], v14, s[8:11], s45 offen sc1
    s_mov_b32 s45, 1152
    buffer_load_dword v16, v15, s[24:27], s45 offen sc1
    buffer_load_dword v17, v15, s[24:27], 0 offen sc1
    s_sub_u32 s48, s48, 1
    s_cbranch_scc1 Ltail_goty
    s_waitcnt vmcnt(10)
    v_max3_u32 v26, v64, v65, v66
    s_waitcnt vmcnt(9)
    v_max3_u32 v26, v26, v67, v68
    v_max3_u32 v26, v26, v69, v70
    s_waitcnt vmcnt(8)
    v_max3_u32 v26, v26, v71, v72
    v_max3_u32 v26, v26, v73, v74
    s_waitcnt vmcnt(7)
    v_max3_u32 v26, v26, v75, v76
    v_max3_u32 v26, v26, v77, v78
    s_waitcnt vmcnt(6)
    v_max3_u32 v26, v26, v79, v80
    v_max3_u32 v26, v26, v81, v82
    s_waitcnt vmcnt(5)
    v_max3_u32 v26, v26, v83, v84
    v_max3_u32 v26, v26, v85, v86
    s_waitcnt vmcnt(4)
    v_max3_u32 v26, v26, v87, v88
    v_max3_u32 v26, v26, v89, v90
    s_waitcnt vmcnt(3)
    v_max3_u32 v26, v26, v91, v92
    v_max3_u32 v26, v26, v93, v94
    s_waitcnt vmcnt(2)
    v_max3_u32 v26, v26, v95, v96
    v_max3_u32 v26, v26, v97, v98
    v_max_u32 v26, v26, v99
    s_waitcnt vmcnt(0)
    v_max3_u32 v26, v26, v16, v17
    v_cmp_eq_u32 vcc, -1, v26
    s_cbranch_vccnz Ltail_polly
Ltail_goty:
    s_waitcnt vmcnt(0) lgkmcnt(0)
    v_lshlrev_b32 v20, 16, v16
    v_and_b32 v21, 0xffff0000, v16
    v_lshlrev_b32 v22, 16, v17
    v_and_b32 v23, 0xffff0000, v17
    v_pk_add_f32 v[64:65], v[64:65], v[68:69]
    v_pk_add_f32 v[66:67], v[66:67], v[70:71]
    v_pk_add_f32 v[64:65], v[64:65], v[72:73]
    v_pk_add_f32 v[66:67], v[66:67], v[74:75]
    v_pk_add_f32 v[64:65], v[64:65], v[76:77]
    v_pk_add_f32 v[66:67], v[66:67], v[78:79]
    v_pk_add_f32 v[64:65], v[64:65], v[80:81]
    v_pk_add_f32 v[66:67], v[66:67], v[82:83]
    v_pk_add_f32 v[64:65], v[64:65], v[84:85]
    v_pk_add_f32 v[66:67], v[66:67], v[86:87]
    v_pk_add_f32 v[64:65], v[64:65], v[88:89]
    v_pk_add_f32 v[66:67], v[66:67], v[90:91]
    v_pk_add_f32 v[64:65], v[64:65], v[92:93]
    v_pk_add_f32 v[66:67], v[66:67], v[94:95]
    v_pk_add_f32 v[64:65], v[64:65], v[96:97]
    v_pk_add_f32 v[66:67], v[66:67], v[98:99]
    s_nop 0
    v_add_f32_dpp v64, v64, v64 row_ror:4 row_mask:0xf bank_mask:0xf
    v_add_f32_dpp v65, v65, v65 row_ror:4 row_mask:0xf bank_mask:0xf
    v_add_f32_dpp v66, v66, v66 row_ror:4 row_mask:0xf bank_mask:0xf
    v_add_f32_dpp v67, v67, v67 row_ror:4 row_mask:0xf bank_mask:0xf
    v_add_f32_dpp v64, v64, v64 row_ror:8 row_mask:0xf bank_mask:0xf
    v_add_f32_dpp v65, v65, v65 row_ror:8 row_mask:0xf bank_mask:0xf
    v_add_f32_dpp v66, v66, v66 row_ror:8 row_mask:0xf bank_mask:0xf
    v_add_f32_dpp v67, v67, v67 row_ror:8 row_mask:0xf bank_mask:0xf
    v_mov_b32 v68, v64
    v_mov_b32 v69, v65
    v_mov_b32 v70, v66
    v_mov_b32 v71, v67
    v_permlane16_swap_b32 v64, v68
    v_permlane16_swap_b32 v65, v69
    v_permlane16_swap_b32 v66, v70
    v_permlane16_swap_b32 v67, v71
    v_add_f32 v64, v64, v68
    v_add_f32 v65, v65, v69
    v_add_f32 v66, v66, v70
    v_add_f32 v67, v67, v71
    v_mov_b32 v68, v64
    v_mov_b32 v69, v65
    v_mov_b32 v70, v66
    v_mov_b32 v71, v67
    v_permlane32_swap_b32 v64, v68
    v_permlane32_swap_b32 v65, v69
    v_permlane32_swap_b32 v66, v70
    v_permlane32_swap_b32 v67, v71
    v_add_f32 v64, v64, v68
    v_add_f32 v65, v65, v69
    v_add_f32 v66, v66, v70
    v_add_f32 v67, v67, v71
    v_cndmask_b32 v26, v64, v65, s[38:39]
    v_cndmask_b32 v27, v66, v67, s[38:39]
    v_cvt_pk_bf16_f32 v28, v26, v27
    v_lshlrev_b32 v26, 16, v28
    v_and_b32 v27, 0xffff0000, v28
    v_mul_f32 v26, v26, v19
    v_mul_f32 v27, v27, v19
    v_cvt_pk_bf16_f32 v28, v26, v27
    v_lshlrev_b32 v26, 16, v28
    v_and_b32 v27, 0xffff0000, v28
    v_pk_add_f32 v[26:27], v[26:27], v[22:23]
    v_cvt_pk_bf16_f32 v28, v26, v27
    v_lshlrev_b32 v26, 16, v28
    v_and_b32 v27, 0xffff0000, v28
    v_pk_mul_f32 v[26:27], v[26:27], v[24:25]
    v_cvt_pk_bf16_f32 v28, v26, v27
    v_lshlrev_b32 v26, 16, v28
    v_and_b32 v27, 0xffff0000, v28
    v_pk_add_f32 v[26:27], v[26:27], v[20:21]
    v_cvt_pk_bf16_f32 v28, v26, v27
    s_mov_b64 exec, 0xff
    buffer_store_dword v28, v13, s[16:19], 0 offen nt
Ltail_done:
    s_endpgm
Lattn_wb:
    buffer_wbl2 sc1
    s_waitcnt vmcnt(0)
    s_branch Lattn_wbdone
Lattn_xspin:
Ltour15:
    s_cbranch_execz Lmain
    s_mov_b32 s37, 16384
Lattn_xloop:
    buffer_load_dword v11, v8, s[24:27], s54 offen offset:8 sc1
    s_waitcnt vmcnt(0)
    v_readfirstlane_b32 s36, v11
    s_sub_u32 s37, s37, 1
    s_cbranch_scc1 Lattn_xgot
    s_cmp_lg_u32 s36, s95
    s_cbranch_scc1 Lattn_xloop
    s_branch Lattn_xgot
Ltail_spin1:
Ltour16:
    s_cbranch_execz Lmain
    s_mov_b32 s48, 16384
Ltail_spinl1:
    buffer_load_dword v11, v9, s[24:27], s39 offen sc1
    s_waitcnt vmcnt(0)
    v_cmp_ne_u32 s[54:55], s95, v11
    s_sub_u32 s48, s48, 1
    s_cbranch_scc1 Ltail_got1
    s_cmp_lg_u64 s[54:55], 0
    s_cbranch_scc1 Ltail_spinl1
    s_branch Ltail_got1
Ltail_spin2:
Ltour17:
    s_cbranch_execz Lmain
    s_mov_b32 s48, 16384
Ltail_spinl2:
    buffer_load_dword v11, v9, s[24:27], s39 offen sc1
    s_waitcnt vmcnt(0)
    v_cmp_ne_u32 s[54:55], s95, v11
    s_sub_u32 s48, s48, 1
    s_cbranch_scc1 Ltail_got2
    s_cmp_lg_u64 s[54:55], 0
    s_cbranch_scc1 Ltail_spinl2
    s_branch Ltail_got2
Lattn_redo:
    v_xor_b32 v8, 64, v9
    v_xor_b32 v10, 64, v11
    s_waitcnt vmcnt(0) lgkmcnt(0)
    s_barrier
    v_mov_b32 v232, 0xff800000
    v_mov_b32 v233, 0xff800000
    v_mov_b32 v234, 0xff800000
    v_mov_b32 v235, 0xff800000
    s_mov_b32 s40, 0
    s_mov_b32 s48, -1
Lattn_redo_loop:
    s_add_u32 m0, s42, 0
    s_nop 0
    buffer_load_dwordx4 v36, s[8:11], s40 offen lds
    buffer_load_dwordx4 v37, s[8:11], s40 offen offset:1024 lds
    buffer_load_dwordx4 v38, s[8:11], s40 offen offset:2048 lds
    buffer_load_dwordx4 v39, s[8:11], s40 offen offset:3072 lds
    s_add_u32 s40, s40, 16384
    s_waitcnt vmcnt(0) lgkmcnt(0)
    s_barrier
    ds_read_b128 a[208:211], v8 offset:0
    ds_read_b128 a[212:215], v9 offset:0
    ds_read_b128 a[216:219], v10 offset:0
    ds_read_b128 a[220:223], v11 offset:0
    s_waitcnt lgkmcnt(3)
    v_mfma_f32_16x16x32_bf16 v[216:219], a[208:211], v[64:67], 0
    s_waitcnt lgkmcnt(2)
    v_mfma_f32_16x16x32_bf16 v[216:219], a[212:215], v[68:71], v[216:219]
    s_waitcnt lgkmcnt(1)
    v_mfma_f32_16x16x32_bf16 v[216:219], a[216:219], v[72:75], v[216:219]
    s_waitcnt lgkmcnt(0)
    v_mfma_f32_16x16x32_bf16 v[216:219], a[220:223], v[76:79], v[216:219]
    v_mfma_f32_16x16x32_bf16 v[220:223], a[208:211], v[80:83], 0
    v_mfma_f32_16x16x32_bf16 v[220:223], a[212:215], v[84:87], v[220:223]
    v_mfma_f32_16x16x32_bf16 v[220:223], a[216:219], v[88:91], v[220:223]
    v_mfma_f32_16x16x32_bf16 v[220:223], a[220:223], v[92:95], v[220:223]
    v_mfma_f32_16x16x32_bf16 v[224:227], a[208:211], v[96:99], 0
    v_mfma_f32_16x16x32_bf16 v[224:227], a[212:215], v[100:103], v[224:227]
    v_mfma_f32_16x16x32_bf16 v[224:227], a[216:219], v[104:107], v[224:227]
    v_mfma_f32_16x16x32_bf16 v[224:227], a[220:223], v[108:111], v[224:227]
    v_mfma_f32_16x16x32_bf16 v[228:231], a[208:211], v[112:115], 0
    v_mfma_f32_16x16x32_bf16 v[228:231], a[212:215], v[116:119], v[228:231]
    v_mfma_f32_16x16x32_bf16 v[228:231], a[216:219], v[120:123], v[228:231]
    v_mfma_f32_16x16x32_bf16 v[228:231], a[220:223], v[124:127], v[228:231]
    v_max3_f32 v232, v232, v216, v217
    v_max3_f32 v232, v232, v218, v219
    v_max3_f32 v233, v233, v220, v221
    v_max3_f32 v233, v233, v222, v223
    v_max3_f32 v234, v234, v224, v225
    v_max3_f32 v234, v234, v226, v227
    s_nop 1
    v_max3_f32 v235, v235, v228, v229
    v_max3_f32 v235, v235, v230, v231
    ds_read_b128 a[224:227], v8 offset:4096
    ds_read_b128 a[228:231], v9 offset:4096
    ds_read_b128 a[232:235], v10 offset:4096
    ds_read_b128 a[236:239], v11 offset:4096
    s_waitcnt lgkmcnt(3)
    v_mfma_f32_16x16x32_bf16 v[216:219], a[224:227], v[64:67], 0
    s_waitcnt lgkmcnt(2)
    v_mfma_f32_16x16x32_bf16 v[216:219], a[228:231], v[68:71], v[216:219]
    s_waitcnt lgkmcnt(1)
    v_mfma_f32_16x16x32_bf16 v[216:219], a[232:235], v[72:75], v[216:219]
    s_waitcnt lgkmcnt(0)
    v_mfma_f32_16x16x32_bf16 v[216:219], a[236:239], v[76:79], v[216:219]
    v_mfma_f32_16x16x32_bf16 v[220:223], a[224:227], v[80:83], 0
    v_mfma_f32_16x16x32_bf16 v[220:223], a[228:231], v[84:87], v[220:223]
    v_mfma_f32_16x16x32_bf16 v[220:223], a[232:235], v[88:91], v[220:223]
    v_mfma_f32_16x16x32_bf16 v[220:223], a[236:239], v[92:95], v[220:223]
    v_mfma_f32_16x16x32_bf16 v[224:227], a[224:227], v[96:99], 0
    v_mfma_f32_16x16x32_bf16 v[224:227], a[228:231], v[100:103], v[224:227]
    v_mfma_f32_16x16x32_bf16 v[224:227], a[232:235], v[104:107], v[224:227]
    v_mfma_f32_16x16x32_bf16 v[224:227], a[236:239], v[108:111], v[224:227]
    v_mfma_f32_16x16x32_bf16 v[228:231], a[224:227], v[112:115], 0
    v_mfma_f32_16x16x32_bf16 v[228:231], a[228:231], v[116:119], v[228:231]
    v_mfma_f32_16x16x32_bf16 v[228:231], a[232:235], v[120:123], v[228:231]
    v_mfma_f32_16x16x32_bf16 v[228:231], a[236:239], v[124:127], v[228:231]
    v_max3_f32 v232, v232, v216, v217
    v_max3_f32 v232, v232, v218, v219
    v_max3_f32 v233, v233, v220, v221
    v_max3_f32 v233, v233, v222, v223
    v_max3_f32 v234, v234, v224, v225
    v_max3_f32 v234, v234, v226, v227
    s_nop 1
    v_max3_f32 v235, v235, v228, v229
    v_max3_f32 v235, v235, v230, v231
    ds_read_b128 a[208:211], v8 offset:8192
    ds_read_b128 a[212:215], v9 offset:8192
    ds_read_b128 a[216:219], v10 offset:8192
    ds_read_b128 a[220:223], v11 offset:8192
    s_waitcnt lgkmcnt(3)
    v_mfma_f32_16x16x32_bf16 v[216:219], a[208:211], v[64:67], 0
    s_waitcnt lgkmcnt(2)
    v_mfma_f32_16x16x32_bf16 v[216:219], a[212:215], v[68:71], v[216:219]
    s_waitcnt lgkmcnt(1)
    v_mfma_f32_16x16x32_bf16 v[216:219], a[216:219], v[72:75], v[216:219]
    s_waitcnt lgkmcnt(0)
    v_mfma_f32_16x16x32_bf16 v[216:219], a[220:223], v[76:79], v[216:219]
    v_mfma_f32_16x16x32_bf16 v[220:223], a[208:211], v[80:83], 0
    v_mfma_f32_16x16x32_bf16 v[220:223], a[212:215], v[84:87], v[220:223]
    v_mfma_f32_16x16x32_bf16 v[220:223], a[216:219], v[88:91], v[220:223]
    v_mfma_f32_16x16x32_bf16 v[220:223], a[220:223], v[92:95], v[220:223]
    v_mfma_f32_16x16x32_bf16 v[224:227], a[208:211], v[96:99], 0
    v_mfma_f32_16x16x32_bf16 v[224:227], a[212:215], v[100:103], v[224:227]
    v_mfma_f32_16x16x32_bf16 v[224:227], a[216:219], v[104:107], v[224:227]
    v_mfma_f32_16x16x32_bf16 v[224:227], a[220:223], v[108:111], v[224:227]
    v_mfma_f32_16x16x32_bf16 v[228:231], a[208:211], v[112:115], 0
    v_mfma_f32_16x16x32_bf16 v[228:231], a[212:215], v[116:119], v[228:231]
    v_mfma_f32_16x16x32_bf16 v[228:231], a[216:219], v[120:123], v[228:231]
    v_mfma_f32_16x16x32_bf16 v[228:231], a[220:223], v[124:127], v[228:231]
    v_max3_f32 v232, v232, v216, v217
    v_max3_f32 v232, v232, v218, v219
    v_max3_f32 v233, v233, v220, v221
    v_max3_f32 v233, v233, v222, v223
    v_max3_f32 v234, v234, v224, v225
    v_max3_f32 v234, v234, v226, v227
    s_nop 1
    v_max3_f32 v235, v235, v228, v229
    v_max3_f32 v235, v235, v230, v231
    ds_read_b128 a[224:227], v8 offset:12288
    ds_read_b128 a[228:231], v9 offset:12288
    ds_read_b128 a[232:235], v10 offset:12288
    ds_read_b128 a[236:239], v11 offset:12288
    s_waitcnt lgkmcnt(3)
    v_mfma_f32_16x16x32_bf16 v[216:219], a[224:227], v[64:67], 0
    s_waitcnt lgkmcnt(2)
    v_mfma_f32_16x16x32_bf16 v[216:219], a[228:231], v[68:71], v[216:219]
    s_waitcnt lgkmcnt(1)
    v_mfma_f32_16x16x32_bf16 v[216:219], a[232:235], v[72:75], v[216:219]
    s_waitcnt lgkmcnt(0)
    v_mfma_f32_16x16x32_bf16 v[216:219], a[236:239], v[76:79], v[216:219]
    v_mfma_f32_16x16x32_bf16 v[220:223], a[224:227], v[80:83], 0
    v_mfma_f32_16x16x32_bf16 v[220:223], a[228:231], v[84:87], v[220:223]
    v_mfma_f32_16x16x32_bf16 v[220:223], a[232:235], v[88:91], v[220:223]
    v_mfma_f32_16x16x32_bf16 v[220:223], a[236:239], v[92:95], v[220:223]
    v_mfma_f32_16x16x32_bf16 v[224:227], a[224:227], v[96:99], 0
    v_mfma_f32_16x16x32_bf16 v[224:227], a[228:231], v[100:103], v[224:227]
    v_mfma_f32_16x16x32_bf16 v[224:227], a[232:235], v[104:107], v[224:227]
    v_mfma_f32_16x16x32_bf16 v[224:227], a[236:239], v[108:111], v[224:227]
    v_mfma_f32_16x16x32_bf16 v[228:231], a[224:227], v[112:115], 0
    v_mfma_f32_16x16x32_bf16 v[228:231], a[228:231], v[116:119], v[228:231]
    v_mfma_f32_16x16x32_bf16 v[228:231], a[232:235], v[120:123], v[228:231]
    v_mfma_f32_16x16x32_bf16 v[228:231], a[236:239], v[124:127], v[228:231]
    v_max3_f32 v232, v232, v216, v217
    v_max3_f32 v232, v232, v218, v219
    v_max3_f32 v233, v233, v220, v221
    v_max3_f32 v233, v233, v222, v223
    v_max3_f32 v234, v234, v224, v225
    v_max3_f32 v234, v234, v226, v227
    s_nop 1
    v_max3_f32 v235, v235, v228, v229
    v_max3_f32 v235, v235, v230, v231
    s_barrier
    s_cmp_lt_u32 s40, 524288
    s_cbranch_scc1 Lattn_redo_loop
    v_mov_b32 v236, v232
    v_mov_b32 v237, v233
    v_mov_b32 v238, v234
    v_mov_b32 v239, v235
    v_permlane16_swap_b32 v232, v236
    v_permlane16_swap_b32 v233, v237
    v_permlane16_swap_b32 v234, v238
    v_permlane16_swap_b32 v235, v239
    v_max_f32 v232, v232, v236
    v_max_f32 v233, v233, v237
    v_max_f32 v234, v234, v238
    v_max_f32 v235, v235, v239
    v_mov_b32 v236, v232
    v_mov_b32 v237, v233
    v_mov_b32 v238, v234
    v_mov_b32 v239, v235
    v_permlane32_swap_b32 v232, v236
    v_permlane32_swap_b32 v233, v237
    v_permlane32_swap_b32 v234, v238
    v_permlane32_swap_b32 v235, v239
    v_max_f32 v232, v232, v236
    v_max_f32 v233, v233, v237
    v_max_f32 v234, v234, v238
    v_max_f32 v235, v235, v239
    v_sub_f32 v192, 0, v232
    v_sub_f32 v193, 0, v232
    v_sub_f32 v194, 0, v232
    v_sub_f32 v195, 0, v232
    v_sub_f32 v196, 0, v233
    v_sub_f32 v197, 0, v233
    v_sub_f32 v198, 0, v233
    v_sub_f32 v199, 0, v233
    v_sub_f32 v200, 0, v234
    v_sub_f32 v201, 0, v234
    v_sub_f32 v202, 0, v234
    v_sub_f32 v203, 0, v234
    v_sub_f32 v204, 0, v235
    v_sub_f32 v205, 0, v235
    v_sub_f32 v206, 0, v235
    v_sub_f32 v207, 0, v235
    s_mov_b32 s40, 0
    s_mov_b32 s41, 0
    s_add_u32 m0, s42, 0
    s_nop 0
    buffer_load_dwordx4 v36, s[8:11], s40 offen lds
    buffer_load_dwordx4 v37, s[8:11], s40 offen offset:1024 lds
    buffer_load_dwordx4 v38, s[8:11], s40 offen offset:2048 lds
    buffer_load_dwordx4 v39, s[8:11], s40 offen offset:3072 lds
    s_add_u32 s40, s40, 16384
    s_add_u32 m0, s42, 16384
    s_nop 0
    buffer_load_dwordx4 v36, s[8:11], s40 offen lds
    buffer_load_dwordx4 v37, s[8:11], s40 offen offset:1024 lds
    buffer_load_dwordx4 v38, s[8:11], s40 offen offset:2048 lds
    buffer_load_dwordx4 v39, s[8:11], s40 offen offset:3072 lds
    s_add_u32 s40, s40, 16384
    s_add_u32 m0, s42, 32768
    s_nop 0
    buffer_load_dwordx4 v36, s[8:11], s40 offen lds
    buffer_load_dwordx4 v37, s[8:11], s40 offen offset:1024 lds
    buffer_load_dwordx4 v38, s[8:11], s40 offen offset:2048 lds
    buffer_load_dwordx4 v39, s[8:11], s40 offen offset:3072 lds
    s_add_u32 s40, s40, 16384
    s_add_u32 m0, s42, 65536
    s_nop 0
    buffer_load_dwordx4 v40, s[12:15], s41 offen lds
    buffer_load_dwordx4 v41, s[12:15], s41 offen offset:1024 lds
    buffer_load_dwordx4 v40, s[12:15], s41 offen offset:2048 lds
    buffer_load_dwordx4 v41, s[12:15], s41 offen offset:3072 lds
    s_add_u32 s41, s41, 16384
    s_add_u32 m0, s42, 81920
    s_nop 0
    buffer_load_dwordx4 v40, s[12:15], s41 offen lds
    buffer_load_dwordx4 v41, s[12:15], s41 offen offset:1024 lds
    buffer_load_dwordx4 v40, s[12:15], s41 offen offset:2048 lds
    buffer_load_dwordx4 v41, s[12:15], s41 offen offset:3072 lds
    s_add_u32 s41, s41, 16384
    v_accvgpr_write_b32 a0, 0
    v_accvgpr_write_b32 a1, 0
    v_accvgpr_write_b32 a2, 0
    v_accvgpr_write_b32 a3, 0
    v_accvgpr_write_b32 a4, 0
    v_accvgpr_write_b32 a5, 0
    v_accvgpr_write_b32 a6, 0
    v_accvgpr_write_b32 a7, 0
    v_accvgpr_write_b32 a8, 0
    v_accvgpr_write_b32 a9, 0
    v_accvgpr_write_b32 a10, 0
    v_accvgpr_write_b32 a11, 0
    v_accvgpr_write_b32 a12, 0
    v_accvgpr_write_b32 a13, 0
    v_accvgpr_write_b32 a14, 0
    v_accvgpr_write_b32 a15, 0
    v_accvgpr_write_b32 a16, 0
    v_accvgpr_write_b32 a17, 0
    v_accvgpr_write_b32 a18, 0
    v_accvgpr_write_b32 a19, 0
    v_accvgpr_write_b32 a20, 0
    v_accvgpr_write_b32 a21, 0
    v_accvgpr_write_b32 a22, 0
    v_accvgpr_write_b32 a23, 0
    v_accvgpr_write_b32 a24, 0
    v_accvgpr_write_b32 a25, 0
    v_accvgpr_write_b32 a26, 0
    v_accvgpr_write_b32 a27, 0
    v_accvgpr_write_b32 a28, 0
    v_accvgpr_write_b32 a29, 0
    v_accvgpr_write_b32 a30, 0
    v_accvgpr_write_b32 a31, 0
    v_accvgpr_write_b32 a32, 0
    v_accvgpr_write_b32 a33, 0
    v_accvgpr_write_b32 a34, 0
    v_accvgpr_write_b32 a35, 0
    v_accvgpr_write_b32 a36, 0
    v_accvgpr_write_b32 a37, 0
    v_accvgpr_write_b32 a38, 0
    v_accvgpr_write_b32 a39, 0
    v_accvgpr_write_b32 a40, 0
    v_accvgpr_write_b32 a41, 0
    v_accvgpr_write_b32 a42, 0
    v_accvgpr_write_b32 a43, 0
    v_accvgpr_write_b32 a44, 0
    v_accvgpr_write_b32 a45, 0
    v_accvgpr_write_b32 a46, 0
    v_accvgpr_write_b32 a47, 0
    v_accvgpr_write_b32 a48, 0
    v_accvgpr_write_b32 a49, 0
    v_accvgpr_write_b32 a50, 0
    v_accvgpr_write_b32 a51, 0
    v_accvgpr_write_b32 a52, 0
    v_accvgpr_write_b32 a53, 0
    v_accvgpr_write_b32 a54, 0
    v_accvgpr_write_b32 a55, 0
    v_accvgpr_write_b32 a56, 0
    v_accvgpr_write_b32 a57, 0
    v_accvgpr_write_b32 a58, 0
    v_accvgpr_write_b32 a59, 0
    v_accvgpr_write_b32 a60, 0
    v_accvgpr_write_b32 a61, 0
    v_accvgpr_write_b32 a62, 0
    v_accvgpr_write_b32 a63, 0
    v_accvgpr_write_b32 a64, 0
    v_accvgpr_write_b32 a65, 0
    v_accvgpr_write_b32 a66, 0
    v_accvgpr_write_b32 a67, 0
    v_accvgpr_write_b32 a68, 0
    v_accvgpr_write_b32 a69, 0
    v_accvgpr_write_b32 a70, 0
    v_accvgpr_write_b32 a71, 0
    v_accvgpr_write_b32 a72, 0
    v_accvgpr_write_b32 a73, 0
    v_accvgpr_write_b32 a74, 0
    v_accvgpr_write_b32 a75, 0
    v_accvgpr_write_b32 a76, 0
    v_accvgpr_write_b32 a77, 0
    v_accvgpr_write_b32 a78, 0
    v_accvgpr_write_b32 a79, 0
    v_accvgpr_write_b32 a80, 0
    v_accvgpr_write_b32 a81, 0
    v_accvgpr_write_b32 a82, 0
    v_accvgpr_write_b32 a83, 0
    v_accvgpr_write_b32 a84, 0
    v_accvgpr_write_b32 a85, 0
    v_accvgpr_write_b32 a86, 0
    v_accvgpr_write_b32 a87, 0
    v_accvgpr_write_b32 a88, 0
    v_accvgpr_write_b32 a89, 0
    v_accvgpr_write_b32 a90, 0
    v_accvgpr_write_b32 a91, 0
    v_accvgpr_write_b32 a92, 0
    v_accvgpr_write_b32 a93, 0
    v_accvgpr_write_b32 a94, 0
    v_accvgpr_write_b32 a95, 0
    v_accvgpr_write_b32 a96, 0
    v_accvgpr_write_b32 a97, 0
    v_accvgpr_write_b32 a98, 0
    v_accvgpr_write_b32 a99, 0
    v_accvgpr_write_b32 a100, 0
    v_accvgpr_write_b32 a101, 0
    v_accvgpr_write_b32 a102, 0
    v_accvgpr_write_b32 a103, 0
    v_accvgpr_write_b32 a104, 0
    v_accvgpr_write_b32 a105, 0
    v_accvgpr_write_b32 a106, 0
    v_accvgpr_write_b32 a107, 0
    v_accvgpr_write_b32 a108, 0
    v_accvgpr_write_b32 a109, 0
    v_accvgpr_write_b32 a110, 0
    v_accvgpr_write_b32 a111, 0
    v_accvgpr_write_b32 a112, 0
    v_accvgpr_write_b32 a113, 0
    v_accvgpr_write_b32 a114, 0
    v_accvgpr_write_b32 a115, 0
    v_accvgpr_write_b32 a116, 0
    v_accvgpr_write_b32 a117, 0
    v_accvgpr_write_b32 a118, 0
    v_accvgpr_write_b32 a119, 0
    v_accvgpr_write_b32 a120, 0
    v_accvgpr_write_b32 a121, 0
    v_accvgpr_write_b32 a122, 0
    v_accvgpr_write_b32 a123, 0
    v_accvgpr_write_b32 a124, 0
    v_accvgpr_write_b32 a125, 0
    v_accvgpr_write_b32 a126, 0
    v_accvgpr_write_b32 a127, 0
    v_accvgpr_write_b32 a192, 0
    v_accvgpr_write_b32 a193, 0
    v_accvgpr_write_b32 a194, 0
    v_accvgpr_write_b32 a195, 0
    v_accvgpr_write_b32 a196, 0
    v_accvgpr_write_b32 a197, 0
    v_accvgpr_write_b32 a198, 0
    v_accvgpr_write_b32 a199, 0
    v_accvgpr_write_b32 a200, 0
    v_accvgpr_write_b32 a201, 0
    v_accvgpr_write_b32 a202, 0
    v_accvgpr_write_b32 a203, 0
    v_accvgpr_write_b32 a204, 0
    v_accvgpr_write_b32 a205, 0
    v_accvgpr_write_b32 a206, 0
    v_accvgpr_write_b32 a207, 0
    s_waitcnt vmcnt(0) lgkmcnt(0)
    s_barrier
    ds_read_b128 a[208:211], v8 offset:0
    ds_read_b128 a[212:215], v9 offset:0
    ds_read_b128 a[216:219], v10 offset:0
    ds_read_b128 a[220:223], v11 offset:0
    ds_read_b128 a[224:227], v8 offset:4096
    s_waitcnt vmcnt(0) lgkmcnt(0)
    s_branch Lattn_stage0
Lattn_armwait:
    s_mov_b32 s36, 16384
Lattn_armloop:
    v_mov_b32 v63, 0
    buffer_load_dword v63, v63, s[88:91], 0 offen sc1
    s_waitcnt vmcnt(0)
    v_readfirstlane_b32 s37, v63
    s_sub_u32 s36, s36, 1
    s_cbranch_scc1 Lattn_armed
    s_cmp_lt_u32 s37, 256
    s_cbranch_scc1 Lattn_armloop
    s_branch Lattn_armed
Lattn_end:
    s_endpgm
.section .rodata,"a"
.p2align 6
.amdhsa_kernel adaLN_cond__gqa_block_cached__moe_arch_mod__prompt_kernel
  .amdhsa_next_free_vgpr 512
  .amdhsa_next_free_sgpr 102
  .amdhsa_accum_offset 256
  .amdhsa_group_segment_fixed_size 0
  .amdhsa_kernarg_size 120
  .amdhsa_user_sgpr_count 2
  .amdhsa_user_sgpr_kernarg_segment_ptr 1
  .amdhsa_system_sgpr_workgroup_id_x 1
  .amdhsa_float_denorm_mode_32 3
.end_amdhsa_kernel
```

```asm
; @launch grid=(256,1,1) block=(256,1,1) lds=163840
.amdgcn_target "amdgcn-amd-amdhsa--gfx950"
.text
.globl adaLN_cond__gqa_block_cached__moe_arch_mod__prompt_kernel
.p2align 8
.type adaLN_cond__gqa_block_cached__moe_arch_mod__prompt_kernel,@function
adaLN_cond__gqa_block_cached__moe_arch_mod__prompt_kernel:
    s_cmp_ge_u32 s2, 256
    s_cbranch_scc1 Lattn_end
    s_load_dwordx2 s[8:9], s[0:1], 80
    s_load_dwordx2 s[12:13], s[0:1], 88
    s_load_dwordx2 s[20:21], s[0:1], 0
    s_load_dwordx2 s[50:51], s[0:1], 112
    s_load_dwordx8 s[52:59], s[0:1], 8
    s_load_dwordx4 s[80:83], s[0:1], 56
    s_load_dwordx2 s[84:85], s[0:1], 72
    s_load_dwordx2 s[88:89], s[0:1], 104
    s_load_dwordx2 s[28:29], s[0:1], 48
    s_getpc_b64 s[32:33]
Lattn_pc:
    s_mov_b32 s34, Lattn_end-Lattn_pc
    s_mov_b32 s35, 0x20000
    s_lshr_b32 s6, s2, 3
    s_lshl_b32 s7, s6, 6
    v_lshrrev_b32 v3, 6, v0
    v_and_b32 v1, 63, v0
    v_lshrrev_b32 v2, 2, v0
    v_lshlrev_b32 v2, 11, v2
    v_readfirstlane_b32 s3, v3
    buffer_load_dword v240, v2, s[32:35], s7 offen
    s_and_b32 s7, s2, 7
    s_lshl_b32 s4, s7, 1
    s_and_b32 s5, s6, 1
    s_add_u32 s4, s4, s5
    s_lshr_b32 s5, s2, 4
    s_lshr_b32 s38, s6, 2
    s_lshl_b32 s38, s38, 3
    s_add_u32 s38, s38, s7
    s_cmp_lt_u32 s38, 18
    s_cselect_b32 s39, 0, 2147483648
    s_lshl_b32 s38, s38, 2
    s_and_b32 s36, s6, 3
    s_add_u32 s38, s38, s36
    s_mov_b32 s14, 3981312
    s_mul_i32 s92, s6, 124416
    s_lshl_b32 s36, s7, 7
    s_add_u32 s92, s92, s36
    s_cmp_lt_u32 s7, 2
    s_cselect_b32 s36, 53, 35
    v_lshrrev_b32 v2, 2, v0
    v_min_u32 v2, s36, v2
    v_mul_u32_u24 v3, 57, v2
    v_lshrrev_b32 v3, 10, v3
    v_mul_i32_i24 v3, -123392, v3
    v_mul_u32_u24 v2, 6912, v2
    v_add_u32 v72, v2, v3
    s_mov_b32 s15, 0x20000
    s_mov_b32 s10, 1152
    s_mov_b32 s11, 0x20000
    s_mov_b32 s22, 2359296
    s_mov_b32 s23, 0x20000
    v_and_b32 v64, 0xfe, v0
    v_mul_u32_u24 v65, 3456, v64
    v_and_b32 v2, 1, v0
    v_lshl_add_u32 v65, v2, 4, v65
    s_lshl_b32 s36, s38, 5
    s_or_b32 s36, s36, s39
    v_and_b32 v4, 31, v1
    v_lshrrev_b32 v5, 5, v1
    v_cmp_gt_u32 vcc, 24, v4
    v_mov_b32 v6, 2147483648
    s_lshl_b32 s7, s5, 4
    s_add_u32 s7, s7, s4
    s_lshl_b32 s7, s7, 2
    s_add_u32 s7, s7, s3
    v_cndmask_b32 v6, v6, 0, vcc
    s_mul_i32 s49, s7, 2304
    v_lshrrev_b32 v7, 2, v4
    v_lshl_add_u32 v7, v7, 6, v6
    v_and_b32 v2, 3, v4
    v_lshl_add_u32 v7, v2, 3, v7
    v_mul_u32_u24 v2, 1152, v5
    v_add_u32 v66, v7, v2
    s_waitcnt lgkmcnt(0)
    s_load_dword s94, s[50:51], 24576
    buffer_load_dword v241, v72, s[12:15], s92 offen
    buffer_load_ushort v80, v64, s[8:11], 0 offen offset:0
    buffer_load_ushort v81, v64, s[8:11], 0 offen offset:256
    buffer_load_ushort v82, v64, s[8:11], 0 offen offset:512
    buffer_load_ushort v83, v64, s[8:11], 0 offen offset:768
    buffer_load_ushort v84, v64, s[8:11], 0 offen offset:1024
    buffer_load_dwordx4 v[88:91], v65, s[12:15], s36 offen
    s_add_u32 s36, s36, 884736
    buffer_load_dwordx4 v[92:95], v65, s[12:15], s36 offen
    s_add_u32 s36, s36, 884736
    buffer_load_dwordx4 v[96:99], v65, s[12:15], s36 offen
    s_add_u32 s36, s36, 884736
    buffer_load_dwordx4 v[100:103], v65, s[12:15], s36 offen
    s_add_u32 s36, s36, 884736
    buffer_load_dwordx4 v[104:107], v65, s[12:15], s36 offen
    s_mov_b32 s16, s56
    s_mov_b32 s17, s57
    s_mov_b32 s18, 4718592
    s_mov_b32 s19, 0x20000
    s_lshl_b32 s44, s4, 9
    s_mul_i32 s36, s5, 98304
    s_add_u32 s36, s36, 0
    v_lshrrev_b32 v2, 2, v0
    v_min_u32 v2, 47, v2
    v_lshrrev_b32 v3, 2, v2
    v_and_b32 v2, 3, v2
    v_lshl_add_u32 v2, v2, 7, s36
    v_lshl_add_u32 v71, v3, 13, v2
    s_mul_i32 s36, s5, 196608
    s_add_u32 s36, s36, 1572864
    v_lshrrev_b32 v2, 1, v0
    v_min_u32 v2, 95, v2
    v_lshrrev_b32 v3, 2, v2
    v_and_b32 v2, 3, v2
    v_lshl_add_u32 v2, v2, 7, s36
    v_lshl_add_u32 v70, v3, 13, v2
    s_add_u32 s92, s49, 65536
    v_lshl_add_u32 v7, v5, 4, v6
    v_lshl_add_u32 v67, v4, 5, v7
    v_min_u32 v4, 23, v4
    v_lshlrev_b32 v68, 4, v4
    s_mov_b32 s24, s50
    s_mov_b32 s25, s51
    s_mov_b32 s26, 10485760
    s_mov_b32 s27, 0x20000
    s_mov_b32 s90, 256
    s_mov_b32 s91, 0x20000
    s_cmp_ge_u32 s38, 36
    s_cselect_b32 s93, 1.0, 0
    s_lshl_b32 s36, s38, 7
    v_lshl_add_u32 v69, v0, 3, s36
    v_cmp_gt_u32 s[36:37], 8, v0
    v_mov_b32 v2, 2147483648
    v_mov_b32 v3, s39
    v_cndmask_b32 v2, v2, v3, s[36:37]
    v_or_b32 v69, v69, v2
    s_mul_i32 s36, s5, 3072
    s_lshl_b32 s37, s5, 11
    v_lshrrev_b32 v120, 3, v0
    v_min_u32 v120, 23, v120
    v_lshl_add_u32 v120, v120, 7, s36
    v_lshrrev_b32 v121, 4, v0
    v_lshl_add_u32 v121, v121, 7, s37
    s_lshl_b32 s42, s3, 12
    v_lshrrev_b32 v2, 4, v1
    v_and_b32 v3, 15, v1
    v_lshrrev_b32 v5, 1, v3
    v_mul_u32_u24 v5, 2304, v5
    v_lshl_add_u32 v5, v2, 5, v5
    v_and_b32 v6, 1, v3
    v_lshl_add_u32 v51, v6, 4, v5
    s_lshl_b32 s6, s5, 2
    s_add_u32 s6, s6, s3
    s_mul_i32 s46, s6, 36864
    s_add_u32 s46, s46, 65536
    s_add_u32 s43, s46, 18432
    s_mul_i32 s45, s4, 294912
    s_lshl_b32 s7, s3, 4
    v_add_u32 v4, s7, v2
    v_lshlrev_b32 v5, 1, v2
    v_xor_b32 v5, v5, v3
    v_xor_b32 v6, 8, v5
    v_lshlrev_b32 v7, 13, v4
    v_lshl_add_u32 v42, v5, 4, v7
    v_lshl_add_u32 v43, v6, 4, v7
    v_add_u32 v44, 63488, v42
    v_add_u32 v45, 95232, v43
    v_add_u32 v43, 31744, v43
    s_lshl_b32 s7, s4, 19
    s_add_u32 s8, s52, s7
    s_addc_u32 s9, s53, 0
    s_mov_b32 s10, 524288
    s_mov_b32 s11, 0x20000
    s_add_u32 s12, s54, s7
    s_addc_u32 s13, s55, 0
    s_mov_b32 s14, 524288
    s_mov_b32 s15, 0x20000
    s_add_u32 s28, s50, 10485760
    s_addc_u32 s29, s51, 0
    s_mov_b32 s30, 37748736
    s_mov_b32 s31, 0x20000
    v_lshlrev_b32 v7, 8, v4
    v_lshl_add_u32 v40, v5, 4, v7
    v_lshl_add_u32 v41, v6, 4, v7
    v_xor_b32 v224, v3, v2
    v_lshl_add_u32 v36, v224, 4, v7
    v_xor_b32 v37, 64, v36
    v_xor_b32 v38, 128, v36
    v_xor_b32 v39, 192, v36
    v_lshrrev_b32 v7, 3, v5
    v_lshl_add_u32 v7, v7, 7, v4
    v_mul_u32_u24 v7, 1152, v7
    v_and_b32 v225, 7, v5
    v_lshl_add_u32 v46, v225, 4, v7
    v_lshrrev_b32 v7, 3, v6
    v_lshl_add_u32 v7, v7, 7, v4
    v_mul_u32_u24 v7, 1152, v7
    v_and_b32 v225, 7, v6
    v_lshl_add_u32 v47, v225, 4, v7
    v_add_u32 v48, 7168, v46
    v_add_u32 v49, 10752, v47
    v_add_u32 v47, 3584, v47
    v_lshlrev_b32 v7, 8, v3
    v_lshl_add_u32 v8, v224, 4, v7
    v_xor_b32 v9, 64, v8
    v_xor_b32 v10, 128, v8
    v_xor_b32 v11, 192, v8
    v_lshrrev_b32 v5, 2, v1
    v_and_b32 v6, 7, v5
    v_lshlrev_b32 v6, 5, v6
    v_lshl_add_u32 v6, v5, 8, v6
    v_and_b32 v7, 3, v1
    v_lshl_add_u32 v12, v7, 3, v6
    v_xor_b32 v13, 32, v12
    v_xor_b32 v14, 64, v12
    v_xor_b32 v15, 96, v12
    v_xor_b32 v16, 128, v12
    v_xor_b32 v17, 160, v12
    v_xor_b32 v18, 192, v12
    v_xor_b32 v19, 224, v12
    v_add_u32 v20, 65536, v12
    v_add_u32 v21, 65536, v13
    v_add_u32 v22, 65536, v14
    v_add_u32 v23, 65536, v15
    v_add_u32 v24, 65536, v16
    v_add_u32 v25, 65536, v17
    v_add_u32 v26, 65536, v18
    v_add_u32 v27, 65536, v19
    v_add_u32 v28, 131072, v12
    v_add_u32 v29, 131072, v13
    v_add_u32 v30, 131072, v14
    v_add_u32 v31, 131072, v15
    v_add_u32 v32, 131072, v16
    v_add_u32 v33, 131072, v17
    v_add_u32 v34, 131072, v18
    v_add_u32 v35, 131072, v19
    v_mov_b32 v52, 0x3f803f80
    v_mov_b32 v53, 0x3f803f80
    v_mov_b32 v54, 0x3f803f80
    v_mov_b32 v55, 0x3f803f80
    v_and_b32 v5, 1, v1
    v_mul_u32_u24 v5, 0xaaaa, v5
    v_add_u32 v5, 0x4444, v5
    v_lshl_add_u32 v50, v5, 16, v5
    v_lshrrev_b32 v5, 1, v3
    v_mul_u32_u24 v5, 20480, v5
    v_lshl_add_u32 v5, v2, 5, v5
    v_and_b32 v6, 1, v3
    v_lshl_add_u32 v56, v6, 4, v5
    s_mul_i32 s47, s6, 327680
    s_mov_b32 s32, s82
    s_mov_b32 s33, s83
    s_mov_b32 s34, 5308416
    s_mov_b32 s35, 0x20000
    s_mov_b32 s82, 5308416
    s_mov_b32 s83, 0x20000
    s_mov_b32 s86, 5308416
    s_mov_b32 s87, 0x20000
    s_lshr_b32 s7, s2, 3
    s_mul_i32 s7, s7, 18
    s_add_u32 s7, s7, s3
    s_and_b32 s36, s2, 7
    s_mul_i32 s37, s36, 576
    s_add_u32 s37, s37, s7
    s_mul_i32 s37, s37, 1152
    s_mul_i32 s7, s7, 9216
    s_mul_i32 s36, s36, 1152
    s_add_u32 s7, s7, s36
    v_min_u32 v5, 17, v1
    v_lshl_add_u32 v57, v5, 6, s7
    v_lshl_add_u32 v62, v5, 6, s37
    s_mov_b32 s40, 0
    s_mov_b32 s41, 0
    s_mov_b32 s48, 0
    s_waitcnt vmcnt(9)
    v_lshlrev_b32 v80, 16, v80
    s_waitcnt vmcnt(8)
    v_lshlrev_b32 v81, 16, v81
    s_waitcnt vmcnt(7)
    v_lshlrev_b32 v82, 16, v82
    s_waitcnt vmcnt(6)
    v_lshlrev_b32 v83, 16, v83
    s_waitcnt vmcnt(5)
    v_lshlrev_b32 v84, 16, v84
    v_mul_f32 v144, 0xbfb8aa3b, v80
    v_mul_f32 v148, 0xbfb8aa3b, v81
    v_mul_f32 v152, 0xbfb8aa3b, v82
    v_mul_f32 v156, 0xbfb8aa3b, v83
    v_mul_f32 v160, 0xbfb8aa3b, v84
    v_min_f32 v144, 0x42fc0000, v144
    v_min_f32 v148, 0x42fc0000, v148
    v_min_f32 v152, 0x42fc0000, v152
    v_min_f32 v156, 0x42fc0000, v156
    v_min_f32 v160, 0x42fc0000, v160
    v_exp_f32 v144, v144
    v_exp_f32 v148, v148
    v_exp_f32 v152, v152
    v_exp_f32 v156, v156
    v_exp_f32 v160, v160
    v_add_f32 v144, 1.0, v144
    v_add_f32 v148, 1.0, v148
    v_add_f32 v152, 1.0, v152
    v_add_f32 v156, 1.0, v156
    v_add_f32 v160, 1.0, v160
    v_rcp_f32 v145, v144
    v_rcp_f32 v149, v148
    v_rcp_f32 v153, v152
    v_rcp_f32 v157, v156
    v_rcp_f32 v161, v160
    v_mul_f32 v146, v80, v145
    v_mul_f32 v150, v81, v149
    v_mul_f32 v154, v82, v153
    v_mul_f32 v158, v83, v157
    v_mul_f32 v162, v84, v161
    v_fma_f32 v144, -v146, v144, v80
    v_fma_f32 v148, -v150, v148, v81
    v_fma_f32 v152, -v154, v152, v82
    v_fma_f32 v156, -v158, v156, v83
    v_fma_f32 v160, -v162, v160, v84
    v_fma_f32 v80, v144, v145, v146
    v_fma_f32 v81, v148, v149, v150
    v_fma_f32 v82, v152, v153, v154
    v_fma_f32 v83, v156, v157, v158
    v_fma_f32 v84, v160, v161, v162
    v_cvt_pk_bf16_f32 v80, v80, v80
    v_cvt_pk_bf16_f32 v81, v81, v81
    v_cvt_pk_bf16_f32 v82, v82, v82
    v_cvt_pk_bf16_f32 v83, v83, v83
    v_cvt_pk_bf16_f32 v84, v84, v84
    v_and_b32 v80, 0xffff0000, v80
    v_and_b32 v81, 0xffff0000, v81
    v_and_b32 v82, 0xffff0000, v82
    v_and_b32 v83, 0xffff0000, v83
    v_and_b32 v84, 0xffff0000, v84
    buffer_load_dwordx2 v[108:109], v66, s[20:23], s49 offen offset:0
    buffer_load_dwordx2 v[110:111], v66, s[20:23], s49 offen offset:32
    buffer_load_dwordx2 v[112:113], v66, s[20:23], s49 offen offset:384
    buffer_load_dwordx2 v[114:115], v66, s[20:23], s49 offen offset:416
    buffer_load_dwordx2 v[116:117], v66, s[20:23], s49 offen offset:768
    buffer_load_dwordx2 v[118:119], v66, s[20:23], s49 offen offset:800
    s_mov_b32 s20, s58
    s_mov_b32 s21, s59
    s_mov_b32 s22, 4718592
    s_mov_b32 s23, 0x20000
    buffer_load_dword v242, v71, s[16:19], s44 offen
    s_waitcnt vmcnt(11)
    v_lshlrev_b32 v136, 16, v88
    v_and_b32 v137, 0xffff0000, v88
    v_lshlrev_b32 v138, 16, v89
    v_and_b32 v139, 0xffff0000, v89
    v_lshlrev_b32 v140, 16, v90
    v_and_b32 v141, 0xffff0000, v90
    v_lshlrev_b32 v142, 16, v91
    v_and_b32 v143, 0xffff0000, v91
    v_pk_mul_f32 v[128:129], v[136:137], v[80:81] op_sel:[0,0] op_sel_hi:[1,0]
    v_pk_mul_f32 v[130:131], v[138:139], v[80:81] op_sel:[0,0] op_sel_hi:[1,0]
    v_pk_mul_f32 v[132:133], v[140:141], v[80:81] op_sel:[0,0] op_sel_hi:[1,0]
    v_pk_mul_f32 v[134:135], v[142:143], v[80:81] op_sel:[0,0] op_sel_hi:[1,0]
    s_waitcnt vmcnt(10)
    v_lshlrev_b32 v136, 16, v92
    v_and_b32 v137, 0xffff0000, v92
    v_lshlrev_b32 v138, 16, v93
    v_and_b32 v139, 0xffff0000, v93
    v_lshlrev_b32 v140, 16, v94
    v_and_b32 v141, 0xffff0000, v94
    v_lshlrev_b32 v142, 16, v95
    v_and_b32 v143, 0xffff0000, v95
    v_pk_fma_f32 v[128:129], v[136:137], v[80:81], v[128:129] op_sel:[0,1,0] op_sel_hi:[1,1,1]
    v_pk_fma_f32 v[130:131], v[138:139], v[80:81], v[130:131] op_sel:[0,1,0] op_sel_hi:[1,1,1]
    v_pk_fma_f32 v[132:133], v[140:141], v[80:81], v[132:133] op_sel:[0,1,0] op_sel_hi:[1,1,1]
    v_pk_fma_f32 v[134:135], v[142:143], v[80:81], v[134:135] op_sel:[0,1,0] op_sel_hi:[1,1,1]
    s_waitcnt vmcnt(9)
    v_lshlrev_b32 v136, 16, v96
    v_and_b32 v137, 0xffff0000, v96
    v_lshlrev_b32 v138, 16, v97
    v_and_b32 v139, 0xffff0000, v97
    v_lshlrev_b32 v140, 16, v98
    v_and_b32 v141, 0xffff0000, v98
    v_lshlrev_b32 v142, 16, v99
    v_and_b32 v143, 0xffff0000, v99
    v_pk_fma_f32 v[128:129], v[136:137], v[82:83], v[128:129] op_sel:[0,0,0] op_sel_hi:[1,0,1]
    v_pk_fma_f32 v[130:131], v[138:139], v[82:83], v[130:131] op_sel:[0,0,0] op_sel_hi:[1,0,1]
    v_pk_fma_f32 v[132:133], v[140:141], v[82:83], v[132:133] op_sel:[0,0,0] op_sel_hi:[1,0,1]
    v_pk_fma_f32 v[134:135], v[142:143], v[82:83], v[134:135] op_sel:[0,0,0] op_sel_hi:[1,0,1]
    s_waitcnt vmcnt(8)
    v_lshlrev_b32 v136, 16, v100
    v_and_b32 v137, 0xffff0000, v100
    v_lshlrev_b32 v138, 16, v101
    v_and_b32 v139, 0xffff0000, v101
    v_lshlrev_b32 v140, 16, v102
    v_and_b32 v141, 0xffff0000, v102
    v_lshlrev_b32 v142, 16, v103
    v_and_b32 v143, 0xffff0000, v103
    v_pk_fma_f32 v[128:129], v[136:137], v[82:83], v[128:129] op_sel:[0,1,0] op_sel_hi:[1,1,1]
    v_pk_fma_f32 v[130:131], v[138:139], v[82:83], v[130:131] op_sel:[0,1,0] op_sel_hi:[1,1,1]
    v_pk_fma_f32 v[132:133], v[140:141], v[82:83], v[132:133] op_sel:[0,1,0] op_sel_hi:[1,1,1]
    v_pk_fma_f32 v[134:135], v[142:143], v[82:83], v[134:135] op_sel:[0,1,0] op_sel_hi:[1,1,1]
    s_waitcnt vmcnt(7)
    v_lshlrev_b32 v136, 16, v104
    v_and_b32 v137, 0xffff0000, v104
    v_lshlrev_b32 v138, 16, v105
    v_and_b32 v139, 0xffff0000, v105
    v_lshlrev_b32 v140, 16, v106
    v_and_b32 v141, 0xffff0000, v106
    v_lshlrev_b32 v142, 16, v107
    v_and_b32 v143, 0xffff0000, v107
    v_pk_fma_f32 v[128:129], v[136:137], v[84:85], v[128:129] op_sel:[0,0,0] op_sel_hi:[1,0,1]
    v_pk_fma_f32 v[130:131], v[138:139], v[84:85], v[130:131] op_sel:[0,0,0] op_sel_hi:[1,0,1]
    v_pk_fma_f32 v[132:133], v[140:141], v[84:85], v[132:133] op_sel:[0,0,0] op_sel_hi:[1,0,1]
    v_pk_fma_f32 v[134:135], v[142:143], v[84:85], v[134:135] op_sel:[0,0,0] op_sel_hi:[1,0,1]
    s_nop 0
    v_permlane32_swap_b32 v128, v132
    v_permlane32_swap_b32 v129, v133
    v_permlane32_swap_b32 v130, v134
    v_permlane32_swap_b32 v131, v135
    v_and_b32 v72, 1, v1
    v_pk_add_f32 v[128:129], v[128:129], v[132:133]
    v_pk_add_f32 v[130:131], v[130:131], v[134:135]
    v_lshlrev_b32 v72, 5, v72
    v_lshrrev_b32 v73, 4, v1
    v_permlane16_swap_b32 v128, v130
    v_permlane16_swap_b32 v129, v131
    v_lshl_add_u32 v72, v73, 3, v72
    v_pk_add_f32 v[128:129], v[128:129], v[130:131]
    s_lshl_b32 s36, s3, 6
    v_add_u32 v72, s36, v72
    v_add_f32_dpp v128, v128, v128 row_ror:2 row_mask:0xf bank_mask:0xf
    v_add_f32_dpp v129, v129, v129 row_ror:2 row_mask:0xf bank_mask:0xf
    s_nop 0
    v_add_f32_dpp v128, v128, v128 row_ror:4 row_mask:0xf bank_mask:0xf
    v_add_f32_dpp v129, v129, v129 row_ror:4 row_mask:0xf bank_mask:0xf
    s_nop 0
    v_add_f32_dpp v128, v128, v128 row_ror:8 row_mask:0xf bank_mask:0xf
    v_add_f32_dpp v129, v129, v129 row_ror:8 row_mask:0xf bank_mask:0xf
    ds_write_b64 v72, v[128:129] offset:0
    v_and_b32 v73, 7, v1
    v_lshlrev_b32 v73, 3, v73
    s_waitcnt lgkmcnt(0)
    s_barrier
    ds_read_b64 v[128:129], v73 offset:0
    ds_read_b64 v[130:131], v73 offset:64
    ds_read_b64 v[132:133], v73 offset:128
    ds_read_b64 v[134:135], v73 offset:192
    s_add_u32 s95, s94, 0x9e3779b9
    v_mov_b32 v137, s95
    s_mov_b32 s37, 32768
    s_waitcnt lgkmcnt(2)
    v_pk_add_f32 v[128:129], v[128:129], v[130:131]
    s_waitcnt lgkmcnt(0)
    v_pk_add_f32 v[132:133], v[132:133], v[134:135]
    v_pk_add_f32 v[128:129], v[128:129], v[132:133]
    v_cvt_pk_bf16_f32 v136, v128, v129
    v_lshlrev_b32 v128, 16, v136
    v_and_b32 v129, 0xffff0000, v136
    v_add_f32 v128, s93, v128
    v_add_f32 v129, s93, v129
    v_cvt_pk_bf16_f32 v136, v128, v129
    buffer_store_dwordx2 v[136:137], v69, s[24:27], s37 offen sc1
    s_lshl_b32 s36, s5, 13
    s_add_u32 s36, s36, 8650752
    s_lshl_b32 s38, s4, 9
    s_add_u32 s38, s38, s36
    s_lshl_b32 s36, s3, 7
    s_add_u32 s38, s38, s36
    v_min_u32 v2, 1, v1
    v_lshlrev_b32 v2, 31, v2
    buffer_store_dword v2, v2, s[24:27], s38 offen offset:4 sc1
    s_waitcnt vmcnt(8)
    v_lshlrev_b32 v144, 16, v108
    v_and_b32 v145, 0xffff0000, v108
    v_lshlrev_b32 v146, 16, v109
    v_and_b32 v147, 0xffff0000, v109
    s_waitcnt vmcnt(7)
    v_lshlrev_b32 v148, 16, v110
    v_and_b32 v149, 0xffff0000, v110
    v_lshlrev_b32 v150, 16, v111
    v_and_b32 v151, 0xffff0000, v111
    s_waitcnt vmcnt(6)
    v_lshlrev_b32 v152, 16, v112
    v_and_b32 v153, 0xffff0000, v112
    v_lshlrev_b32 v154, 16, v113
    v_and_b32 v155, 0xffff0000, v113
    s_waitcnt vmcnt(5)
    v_lshlrev_b32 v156, 16, v114
    v_and_b32 v157, 0xffff0000, v114
    v_lshlrev_b32 v158, 16, v115
    v_and_b32 v159, 0xffff0000, v115
    s_waitcnt vmcnt(4)
    v_lshlrev_b32 v160, 16, v116
    v_and_b32 v161, 0xffff0000, v116
    v_lshlrev_b32 v162, 16, v117
    v_and_b32 v163, 0xffff0000, v117
    s_waitcnt vmcnt(3)
    v_lshlrev_b32 v164, 16, v118
    v_and_b32 v165, 0xffff0000, v118
    v_lshlrev_b32 v166, 16, v119
    v_and_b32 v167, 0xffff0000, v119
    v_pk_add_f32 v[72:73], v[144:145], v[148:149]
    v_pk_add_f32 v[76:77], v[146:147], v[150:151]
    v_pk_add_f32 v[72:73], v[72:73], v[152:153]
    v_pk_add_f32 v[76:77], v[76:77], v[154:155]
    v_pk_add_f32 v[72:73], v[72:73], v[156:157]
    v_pk_add_f32 v[76:77], v[76:77], v[158:159]
    v_pk_add_f32 v[72:73], v[72:73], v[160:161]
    v_pk_add_f32 v[76:77], v[76:77], v[162:163]
    v_pk_add_f32 v[72:73], v[72:73], v[164:165]
    v_pk_add_f32 v[76:77], v[76:77], v[166:167]
    v_pk_add_f32 v[72:73], v[72:73], v[76:77]
    v_add_f32 v72, v72, v73
    s_nop 1
    v_add_f32_dpp v72, v72, v72 row_ror:1 row_mask:0xf bank_mask:0xf
    s_nop 1
    v_add_f32_dpp v72, v72, v72 row_ror:2 row_mask:0xf bank_mask:0xf
    s_nop 1
    v_add_f32_dpp v72, v72, v72 row_ror:4 row_mask:0xf bank_mask:0xf
    s_nop 1
    v_add_f32_dpp v72, v72, v72 row_ror:8 row_mask:0xf bank_mask:0xf
    v_mov_b32 v76, v72
    s_nop 1
    v_permlane16_swap_b32 v72, v76
    s_nop 0
    v_add_f32 v72, v72, v76
    v_mul_f32 v72, 0x3ae38e39, v72
    v_pk_add_f32 v[168:169], v[144:145], v[72:73] op_sel_hi:[1,0] neg_lo:[0,1] neg_hi:[0,1]
    v_pk_add_f32 v[170:171], v[146:147], v[72:73] op_sel_hi:[1,0] neg_lo:[0,1] neg_hi:[0,1]
    v_pk_add_f32 v[172:173], v[148:149], v[72:73] op_sel_hi:[1,0] neg_lo:[0,1] neg_hi:[0,1]
    v_pk_add_f32 v[174:175], v[150:151], v[72:73] op_sel_hi:[1,0] neg_lo:[0,1] neg_hi:[0,1]
    v_pk_add_f32 v[176:177], v[152:153], v[72:73] op_sel_hi:[1,0] neg_lo:[0,1] neg_hi:[0,1]
    v_pk_add_f32 v[178:179], v[154:155], v[72:73] op_sel_hi:[1,0] neg_lo:[0,1] neg_hi:[0,1]
    v_pk_add_f32 v[180:181], v[156:157], v[72:73] op_sel_hi:[1,0] neg_lo:[0,1] neg_hi:[0,1]
    v_pk_add_f32 v[182:183], v[158:159], v[72:73] op_sel_hi:[1,0] neg_lo:[0,1] neg_hi:[0,1]
    v_pk_add_f32 v[184:185], v[160:161], v[72:73] op_sel_hi:[1,0] neg_lo:[0,1] neg_hi:[0,1]
    v_pk_add_f32 v[186:187], v[162:163], v[72:73] op_sel_hi:[1,0] neg_lo:[0,1] neg_hi:[0,1]
    v_pk_add_f32 v[188:189], v[164:165], v[72:73] op_sel_hi:[1,0] neg_lo:[0,1] neg_hi:[0,1]
    v_pk_add_f32 v[190:191], v[166:167], v[72:73] op_sel_hi:[1,0] neg_lo:[0,1] neg_hi:[0,1]
    v_pk_mul_f32 v[74:75], v[168:169], v[168:169]
    v_pk_mul_f32 v[76:77], v[170:171], v[170:171]
    v_pk_fma_f32 v[74:75], v[172:173], v[172:173], v[74:75]
    v_pk_fma_f32 v[76:77], v[174:175], v[174:175], v[76:77]
    v_pk_fma_f32 v[74:75], v[176:177], v[176:177], v[74:75]
    v_pk_fma_f32 v[76:77], v[178:179], v[178:179], v[76:77]
    v_pk_fma_f32 v[74:75], v[180:181], v[180:181], v[74:75]
    v_pk_fma_f32 v[76:77], v[182:183], v[182:183], v[76:77]
    v_pk_fma_f32 v[74:75], v[184:185], v[184:185], v[74:75]
    v_pk_fma_f32 v[76:77], v[186:187], v[186:187], v[76:77]
    v_pk_fma_f32 v[74:75], v[188:189], v[188:189], v[74:75]
    v_pk_fma_f32 v[76:77], v[190:191], v[190:191], v[76:77]
    v_pk_add_f32 v[74:75], v[74:75], v[76:77]
    v_add_f32 v74, v74, v75
    v_cndmask_b32 v74, 0, v74, vcc
    s_nop 1
    v_add_f32_dpp v74, v74, v74 row_ror:1 row_mask:0xf bank_mask:0xf
    s_nop 1
    v_add_f32_dpp v74, v74, v74 row_ror:2 row_mask:0xf bank_mask:0xf
    s_nop 1
    v_add_f32_dpp v74, v74, v74 row_ror:4 row_mask:0xf bank_mask:0xf
    s_nop 1
    v_add_f32_dpp v74, v74, v74 row_ror:8 row_mask:0xf bank_mask:0xf
    v_mov_b32 v76, v74
    s_nop 1
    v_permlane16_swap_b32 v74, v76
    s_nop 0
    v_add_f32 v74, v74, v76
    v_mul_f32 v74, 0x3ae38e39, v74
    v_cvt_pk_bf16_f32 v76, v72, v74
    v_and_b32 v74, 0xffff0000, v76
    v_lshlrev_b32 v72, 16, v76
    v_add_f32 v74, 0x3727c5ac, v74
    v_cvt_pk_bf16_f32 v74, v74, v74
    v_and_b32 v74, 0xffff0000, v74
    v_sqrt_f32 v74, v74
    v_pk_add_f32 v[168:169], v[144:145], v[72:73] op_sel_hi:[1,0] neg_lo:[0,1] neg_hi:[0,1]
    v_pk_add_f32 v[170:171], v[146:147], v[72:73] op_sel_hi:[1,0] neg_lo:[0,1] neg_hi:[0,1]
    v_pk_add_f32 v[172:173], v[148:149], v[72:73] op_sel_hi:[1,0] neg_lo:[0,1] neg_hi:[0,1]
    v_pk_add_f32 v[174:175], v[150:151], v[72:73] op_sel_hi:[1,0] neg_lo:[0,1] neg_hi:[0,1]
    v_pk_add_f32 v[176:177], v[152:153], v[72:73] op_sel_hi:[1,0] neg_lo:[0,1] neg_hi:[0,1]
    v_pk_add_f32 v[178:179], v[154:155], v[72:73] op_sel_hi:[1,0] neg_lo:[0,1] neg_hi:[0,1]
    v_pk_add_f32 v[180:181], v[156:157], v[72:73] op_sel_hi:[1,0] neg_lo:[0,1] neg_hi:[0,1]
    v_pk_add_f32 v[182:183], v[158:159], v[72:73] op_sel_hi:[1,0] neg_lo:[0,1] neg_hi:[0,1]
    v_pk_add_f32 v[184:185], v[160:161], v[72:73] op_sel_hi:[1,0] neg_lo:[0,1] neg_hi:[0,1]
    v_pk_add_f32 v[186:187], v[162:163], v[72:73] op_sel_hi:[1,0] neg_lo:[0,1] neg_hi:[0,1]
    v_pk_add_f32 v[188:189], v[164:165], v[72:73] op_sel_hi:[1,0] neg_lo:[0,1] neg_hi:[0,1]
    v_pk_add_f32 v[190:191], v[166:167], v[72:73] op_sel_hi:[1,0] neg_lo:[0,1] neg_hi:[0,1]
    v_cvt_pk_bf16_f32 v74, v74, v74
    v_and_b32 v74, 0xffff0000, v74
    v_rcp_f32 v74, v74
    v_cvt_pk_bf16_f32 v108, v168, v169
    v_cvt_pk_bf16_f32 v109, v170, v171
    v_cvt_pk_bf16_f32 v110, v172, v173
    v_cvt_pk_bf16_f32 v111, v174, v175
    v_cvt_pk_bf16_f32 v112, v176, v177
    v_cvt_pk_bf16_f32 v113, v178, v179
    v_cvt_pk_bf16_f32 v114, v180, v181
    v_cvt_pk_bf16_f32 v115, v182, v183
    v_cvt_pk_bf16_f32 v116, v184, v185
    v_cvt_pk_bf16_f32 v117, v186, v187
    v_cvt_pk_bf16_f32 v118, v188, v189
    v_cvt_pk_bf16_f32 v119, v190, v191
    v_lshlrev_b32 v168, 16, v108
    v_and_b32 v169, 0xffff0000, v108
    v_lshlrev_b32 v170, 16, v109
    v_and_b32 v171, 0xffff0000, v109
    v_lshlrev_b32 v172, 16, v110
    v_and_b32 v173, 0xffff0000, v110
    v_lshlrev_b32 v174, 16, v111
    v_and_b32 v175, 0xffff0000, v111
    v_lshlrev_b32 v176, 16, v112
    v_and_b32 v177, 0xffff0000, v112
    v_lshlrev_b32 v178, 16, v113
    v_and_b32 v179, 0xffff0000, v113
    v_lshlrev_b32 v180, 16, v114
    v_and_b32 v181, 0xffff0000, v114
    v_lshlrev_b32 v182, 16, v115
    v_and_b32 v183, 0xffff0000, v115
    v_lshlrev_b32 v184, 16, v116
    v_and_b32 v185, 0xffff0000, v116
    v_lshlrev_b32 v186, 16, v117
    v_and_b32 v187, 0xffff0000, v117
    v_lshlrev_b32 v188, 16, v118
    v_and_b32 v189, 0xffff0000, v118
    v_lshlrev_b32 v190, 16, v119
    v_and_b32 v191, 0xffff0000, v119
    v_pk_mul_f32 v[168:169], v[168:169], v[74:75] op_sel_hi:[1,0]
    v_pk_mul_f32 v[170:171], v[170:171], v[74:75] op_sel_hi:[1,0]
    v_pk_mul_f32 v[172:173], v[172:173], v[74:75] op_sel_hi:[1,0]
    v_pk_mul_f32 v[174:175], v[174:175], v[74:75] op_sel_hi:[1,0]
    v_pk_mul_f32 v[176:177], v[176:177], v[74:75] op_sel_hi:[1,0]
    v_pk_mul_f32 v[178:179], v[178:179], v[74:75] op_sel_hi:[1,0]
    v_pk_mul_f32 v[180:181], v[180:181], v[74:75] op_sel_hi:[1,0]
    v_pk_mul_f32 v[182:183], v[182:183], v[74:75] op_sel_hi:[1,0]
    v_pk_mul_f32 v[184:185], v[184:185], v[74:75] op_sel_hi:[1,0]
    v_pk_mul_f32 v[186:187], v[186:187], v[74:75] op_sel_hi:[1,0]
    v_pk_mul_f32 v[188:189], v[188:189], v[74:75] op_sel_hi:[1,0]
    v_pk_mul_f32 v[190:191], v[190:191], v[74:75] op_sel_hi:[1,0]
    v_cvt_pk_bf16_f32 v108, v168, v169
    v_cvt_pk_bf16_f32 v109, v170, v171
    v_cvt_pk_bf16_f32 v110, v172, v173
    v_cvt_pk_bf16_f32 v111, v174, v175
    v_cvt_pk_bf16_f32 v112, v176, v177
    v_cvt_pk_bf16_f32 v113, v178, v179
    v_cvt_pk_bf16_f32 v114, v180, v181
    v_cvt_pk_bf16_f32 v115, v182, v183
    v_cvt_pk_bf16_f32 v116, v184, v185
    v_cvt_pk_bf16_f32 v117, v186, v187
    v_cvt_pk_bf16_f32 v118, v188, v189
    v_cvt_pk_bf16_f32 v119, v190, v191
    v_lshlrev_b32 v168, 16, v108
    v_and_b32 v169, 0xffff0000, v108
    v_lshlrev_b32 v170, 16, v109
    v_and_b32 v171, 0xffff0000, v109
    v_lshlrev_b32 v172, 16, v110
    v_and_b32 v173, 0xffff0000, v110
    v_lshlrev_b32 v174, 16, v111
    v_and_b32 v175, 0xffff0000, v111
    v_lshlrev_b32 v176, 16, v112
    v_and_b32 v177, 0xffff0000, v112
    v_lshlrev_b32 v178, 16, v113
    v_and_b32 v179, 0xffff0000, v113
    v_lshlrev_b32 v180, 16, v114
    v_and_b32 v181, 0xffff0000, v114
    v_lshlrev_b32 v182, 16, v115
    v_and_b32 v183, 0xffff0000, v115
    v_lshlrev_b32 v184, 16, v116
    v_and_b32 v185, 0xffff0000, v116
    v_lshlrev_b32 v186, 16, v117
    v_and_b32 v187, 0xffff0000, v117
    v_lshlrev_b32 v188, 16, v118
    v_and_b32 v189, 0xffff0000, v118
    v_lshlrev_b32 v190, 16, v119
    v_and_b32 v191, 0xffff0000, v119
    s_mul_i32 s36, s3, 72
    v_add_u32 v72, s36, v1
    v_and_b32 v73, 7, v1
    s_add_u32 s36, s36, 64
    v_add_u32 v73, s36, v73
    s_movk_i32 s36, 1024
    v_and_b32 v76, 3, v72
    v_lshlrev_b32 v76, 4, v76
    v_lshrrev_b32 v72, 2, v72
    v_lshl_add_u32 v74, v72, 7, v76
    v_and_b32 v77, 1, v72
    v_lshl_add_u32 v76, v77, 3, v76
    v_lshrrev_b32 v72, 1, v72
    v_lshl_add_u32 v72, v72, 6, v76
    v_add_u32 v72, s36, v72
    v_and_b32 v76, 3, v73
    v_lshlrev_b32 v76, 4, v76
    v_lshrrev_b32 v73, 2, v73
    v_lshl_add_u32 v75, v73, 7, v76
    v_and_b32 v77, 1, v73
    v_lshl_add_u32 v76, v77, 3, v76
    v_lshrrev_b32 v73, 1, v73
    v_lshl_add_u32 v73, v73, 6, v76
    v_add_u32 v73, s36, v73
    s_mov_b64 exec, 0
    s_cmp_eq_u32 s3, 0
    s_cbranch_scc1 Ltour0
    s_cmp_eq_u32 s3, 1
    s_cbranch_scc1 Ltour1
    s_cmp_eq_u32 s3, 2
    s_cbranch_scc1 Ltour2
    s_branch Ltour3
.p2align 12
Lmain:
    s_mov_b64 exec, -1
    s_mov_b32 s38, 16384
Lhead_pollm:
    buffer_load_dwordx4 v[88:91], v74, s[24:27], s37 offen sc1
    buffer_load_dwordx4 v[92:95], v75, s[24:27], s37 offen sc1
    s_sub_u32 s38, s38, 1
    s_cbranch_scc1 Lhead_gotm
    s_waitcnt vmcnt(0) lgkmcnt(0)
    v_xor_b32 v89, s95, v89
    v_xor_b32 v91, s95, v91
    v_xor_b32 v93, s95, v93
    v_xor_b32 v95, s95, v95
    v_or3_b32 v89, v89, v91, v93
    v_or_b32 v89, v89, v95
    v_cmp_ne_u32 vcc, 0, v89
    s_cbranch_vccnz Lhead_pollm
Lhead_gotm:
    s_waitcnt vmcnt(0) lgkmcnt(0)
    ds_write2_b32 v72, v88, v90 offset0:0 offset1:1
    ds_write2_b32 v73, v92, v94 offset0:0 offset1:1
    s_waitcnt lgkmcnt(0)
    s_barrier
    ds_read_b128 v[144:147], v68 offset:2176
    ds_read_b128 v[148:151], v68 offset:2560
    ds_read_b128 v[152:155], v68 offset:2944
    ds_read_b128 v[156:159], v68 offset:1024
    ds_read_b128 v[160:163], v68 offset:1408
    ds_read_b128 v[164:167], v68 offset:1792
    s_waitcnt lgkmcnt(5)
    v_lshlrev_b32 v192, 16, v144
    v_and_b32 v193, 0xffff0000, v144
    v_lshlrev_b32 v194, 16, v145
    v_and_b32 v195, 0xffff0000, v145
    v_lshlrev_b32 v196, 16, v146
    v_and_b32 v197, 0xffff0000, v146
    v_lshlrev_b32 v198, 16, v147
    v_and_b32 v199, 0xffff0000, v147
    s_waitcnt lgkmcnt(4)
    v_lshlrev_b32 v200, 16, v148
    v_and_b32 v201, 0xffff0000, v148
    v_lshlrev_b32 v202, 16, v149
    v_and_b32 v203, 0xffff0000, v149
    v_lshlrev_b32 v204, 16, v150
    v_and_b32 v205, 0xffff0000, v150
    v_lshlrev_b32 v206, 16, v151
    v_and_b32 v207, 0xffff0000, v151
    s_waitcnt lgkmcnt(3)
    v_lshlrev_b32 v208, 16, v152
    v_and_b32 v209, 0xffff0000, v152
    v_lshlrev_b32 v210, 16, v153
    v_and_b32 v211, 0xffff0000, v153
    v_lshlrev_b32 v212, 16, v154
    v_and_b32 v213, 0xffff0000, v154
    v_lshlrev_b32 v214, 16, v155
    v_and_b32 v215, 0xffff0000, v155
    v_pk_mul_f32 v[168:169], v[168:169], v[192:193]
    v_pk_mul_f32 v[170:171], v[170:171], v[194:195]
    v_pk_mul_f32 v[172:173], v[172:173], v[196:197]
    v_pk_mul_f32 v[174:175], v[174:175], v[198:199]
    v_pk_mul_f32 v[176:177], v[176:177], v[200:201]
    v_pk_mul_f32 v[178:179], v[178:179], v[202:203]
    v_pk_mul_f32 v[180:181], v[180:181], v[204:205]
    v_pk_mul_f32 v[182:183], v[182:183], v[206:207]
    v_pk_mul_f32 v[184:185], v[184:185], v[208:209]
    v_pk_mul_f32 v[186:187], v[186:187], v[210:211]
    v_pk_mul_f32 v[188:189], v[188:189], v[212:213]
    v_pk_mul_f32 v[190:191], v[190:191], v[214:215]
    v_cvt_pk_bf16_f32 v108, v168, v169
    v_cvt_pk_bf16_f32 v109, v170, v171
    v_cvt_pk_bf16_f32 v110, v172, v173
    v_cvt_pk_bf16_f32 v111, v174, v175
    v_cvt_pk_bf16_f32 v112, v176, v177
    v_cvt_pk_bf16_f32 v113, v178, v179
    v_cvt_pk_bf16_f32 v114, v180, v181
    v_cvt_pk_bf16_f32 v115, v182, v183
    v_cvt_pk_bf16_f32 v116, v184, v185
    v_cvt_pk_bf16_f32 v117, v186, v187
    v_cvt_pk_bf16_f32 v118, v188, v189
    v_cvt_pk_bf16_f32 v119, v190, v191
    s_waitcnt lgkmcnt(2)
    v_lshlrev_b32 v216, 16, v156
    v_and_b32 v217, 0xffff0000, v156
    v_lshlrev_b32 v218, 16, v157
    v_and_b32 v219, 0xffff0000, v157
    v_lshlrev_b32 v220, 16, v158
    v_and_b32 v221, 0xffff0000, v158
    v_lshlrev_b32 v222, 16, v159
    v_and_b32 v223, 0xffff0000, v159
    s_waitcnt lgkmcnt(1)
    v_lshlrev_b32 v224, 16, v160
    v_and_b32 v225, 0xffff0000, v160
    v_lshlrev_b32 v226, 16, v161
    v_and_b32 v227, 0xffff0000, v161
    v_lshlrev_b32 v228, 16, v162
    v_and_b32 v229, 0xffff0000, v162
    v_lshlrev_b32 v230, 16, v163
    v_and_b32 v231, 0xffff0000, v163
    s_waitcnt lgkmcnt(0)
    v_lshlrev_b32 v232, 16, v164
    v_and_b32 v233, 0xffff0000, v164
    v_lshlrev_b32 v234, 16, v165
    v_and_b32 v235, 0xffff0000, v165
    v_lshlrev_b32 v236, 16, v166
    v_and_b32 v237, 0xffff0000, v166
    v_lshlrev_b32 v238, 16, v167
    v_and_b32 v239, 0xffff0000, v167
    v_lshlrev_b32 v168, 16, v108
    v_and_b32 v169, 0xffff0000, v108
    v_lshlrev_b32 v170, 16, v109
    v_and_b32 v171, 0xffff0000, v109
    v_lshlrev_b32 v172, 16, v110
    v_and_b32 v173, 0xffff0000, v110
    v_lshlrev_b32 v174, 16, v111
    v_and_b32 v175, 0xffff0000, v111
    v_lshlrev_b32 v176, 16, v112
    v_and_b32 v177, 0xffff0000, v112
    v_lshlrev_b32 v178, 16, v113
    v_and_b32 v179, 0xffff0000, v113
    v_lshlrev_b32 v180, 16, v114
    v_and_b32 v181, 0xffff0000, v114
    v_lshlrev_b32 v182, 16, v115
    v_and_b32 v183, 0xffff0000, v115
    v_lshlrev_b32 v184, 16, v116
    v_and_b32 v185, 0xffff0000, v116
    v_lshlrev_b32 v186, 16, v117
    v_and_b32 v187, 0xffff0000, v117
    v_lshlrev_b32 v188, 16, v118
    v_and_b32 v189, 0xffff0000, v118
    v_lshlrev_b32 v190, 16, v119
    v_and_b32 v191, 0xffff0000, v119
    v_pk_add_f32 v[168:169], v[168:169], v[216:217]
    v_pk_add_f32 v[170:171], v[170:171], v[218:219]
    v_pk_add_f32 v[172:173], v[172:173], v[220:221]
    v_pk_add_f32 v[174:175], v[174:175], v[222:223]
    v_cvt_pk_bf16_f32 v108, v168, v169
    v_cvt_pk_bf16_f32 v109, v170, v171
    v_cvt_pk_bf16_f32 v110, v172, v173
    v_cvt_pk_bf16_f32 v111, v174, v175
    buffer_store_dwordx4 v[108:111], v67, s[24:27], s92 offen offset:0 sc1
    v_pk_add_f32 v[176:177], v[176:177], v[224:225]
    v_pk_add_f32 v[178:179], v[178:179], v[226:227]
    v_pk_add_f32 v[180:181], v[180:181], v[228:229]
    v_pk_add_f32 v[182:183], v[182:183], v[230:231]
    v_cvt_pk_bf16_f32 v112, v176, v177
    v_cvt_pk_bf16_f32 v113, v178, v179
    v_cvt_pk_bf16_f32 v114, v180, v181
    v_cvt_pk_bf16_f32 v115, v182, v183
    buffer_store_dwordx4 v[112:115], v67, s[24:27], s92 offen offset:768 sc1
    v_pk_add_f32 v[184:185], v[184:185], v[232:233]
    v_pk_add_f32 v[186:187], v[186:187], v[234:235]
    v_pk_add_f32 v[188:189], v[188:189], v[236:237]
    v_pk_add_f32 v[190:191], v[190:191], v[238:239]
    v_cvt_pk_bf16_f32 v116, v184, v185
    v_cvt_pk_bf16_f32 v117, v186, v187
    v_cvt_pk_bf16_f32 v118, v188, v189
    v_cvt_pk_bf16_f32 v119, v190, v191
    buffer_store_dwordx4 v[116:119], v67, s[24:27], s92 offen offset:1536 sc1
    s_lshl_b32 s36, s5, 13
    s_add_u32 s36, s36, 8650752
    s_lshl_b32 s37, s4, 9
    s_add_u32 s37, s37, s36
    s_lshl_b32 s38, s3, 7
    s_add_u32 s37, s37, s38
    s_lshl_b32 s38, s3, 11
    s_add_u32 s36, s36, s38
    v_min_u32 v72, 1, v1
    v_lshlrev_b32 v72, 31, v72
    v_and_b32 v73, 15, v1
    v_lshlrev_b32 v73, 7, v73
    v_cmp_gt_u32 vcc, 162, v0
    v_mov_b32 v88, -1
    v_mov_b32 v89, -1
    v_mov_b32 v90, -1
    v_mov_b32 v91, -1
    s_mul_i32 s39, s2, 2592
    s_add_u32 s39, s39, 7864320
    v_lshl_add_u32 v74, v0, 4, s39
    s_lshl_b32 s39, s2, 7
    s_add_u32 s39, s39, 9306112
    v_mov_b32 v75, s39
    v_cndmask_b32 v74, v75, v74, vcc
    s_lshl_b32 s92, s5, 13
    s_add_u32 s92, s92, 8781824
    s_add_u32 s92, s92, s38
    s_lshl_b32 s38, s4, 7
    s_add_u32 s92, s92, s38
    s_getreg_b32 s38, hwreg(HW_REG_XCC_ID, 0, 4)
    s_add_u32 s38, s38, s95
    v_mov_b32 v76, s38
    v_mov_b32 v2, v80
    v_mov_b32 v3, v81
    v_mov_b32 v4, v82
    v_mov_b32 v5, v83
    v_mov_b32 v6, v84
    v_mov_b32 v7, v65
    s_waitcnt vmcnt(0)
    buffer_store_dword v137, v72, s[24:27], s37 offen sc1
    s_add_u32 s49, s44, 0
    s_add_u32 m0, s42, 32768
    s_nop 0
    buffer_load_dwordx4 v42, s[16:19], s49 offen lds
    buffer_load_dwordx4 v43, s[16:19], s49 offen offset:1024 lds
    buffer_load_dwordx4 v44, s[16:19], s49 offen offset:2048 lds
    buffer_load_dwordx4 v45, s[16:19], s49 offen offset:3072 lds
    s_add_u32 s49, s44, 256
    s_add_u32 m0, s42, 49152
    s_nop 0
    buffer_load_dwordx4 v42, s[16:19], s49 offen lds
    buffer_load_dwordx4 v43, s[16:19], s49 offen offset:1024 lds
    buffer_load_dwordx4 v44, s[16:19], s49 offen offset:2048 lds
    buffer_load_dwordx4 v45, s[16:19], s49 offen offset:3072 lds
    s_add_u32 s49, s44, 524288
    s_add_u32 m0, s42, 65536
    s_nop 0
    buffer_load_dwordx4 v42, s[16:19], s49 offen lds
    buffer_load_dwordx4 v43, s[16:19], s49 offen offset:1024 lds
    buffer_load_dwordx4 v44, s[16:19], s49 offen offset:2048 lds
    buffer_load_dwordx4 v45, s[16:19], s49 offen offset:3072 lds
    s_add_u32 s49, s44, 524544
    s_add_u32 m0, s42, 81920
    s_nop 0
    buffer_load_dwordx4 v42, s[16:19], s49 offen lds
    buffer_load_dwordx4 v43, s[16:19], s49 offen offset:1024 lds
    buffer_load_dwordx4 v44, s[16:19], s49 offen offset:2048 lds
    buffer_load_dwordx4 v45, s[16:19], s49 offen offset:3072 lds
    s_add_u32 s49, s44, 1048576
    s_add_u32 m0, s42, 98304
    s_nop 0
    buffer_load_dwordx4 v42, s[16:19], s49 offen lds
    buffer_load_dwordx4 v43, s[16:19], s49 offen offset:1024 lds
    buffer_load_dwordx4 v44, s[16:19], s49 offen offset:2048 lds
    buffer_load_dwordx4 v45, s[16:19], s49 offen offset:3072 lds
    s_add_u32 s49, s44, 1048832
    s_add_u32 m0, s42, 114688
    s_nop 0
    buffer_load_dwordx4 v42, s[16:19], s49 offen lds
    buffer_load_dwordx4 v43, s[16:19], s49 offen offset:1024 lds
    buffer_load_dwordx4 v44, s[16:19], s49 offen offset:2048 lds
    buffer_load_dwordx4 v45, s[16:19], s49 offen offset:3072 lds
    s_mov_b32 s38, 16384
Lhead_pollh:
    buffer_load_dword v75, v73, s[24:27], s36 offen sc1
    s_sub_u32 s38, s38, 1
    s_cbranch_scc1 Lhead_goth
    s_waitcnt vmcnt(0) lgkmcnt(0)
    v_cmp_ne_u32 vcc, s95, v75
    s_cbranch_vccnz Lhead_pollh
Lhead_goth:
    s_waitcnt vmcnt(0) lgkmcnt(0)
    buffer_load_dwordx4 a[0:3], v51, s[24:27], s46 offen offset:0 sc1
    buffer_load_dwordx4 a[8:11], v51, s[24:27], s46 offen offset:128 sc1
    buffer_load_dwordx4 a[4:7], v51, s[24:27], s43 offen offset:0 sc1
    buffer_load_dwordx4 a[12:15], v51, s[24:27], s43 offen offset:128 sc1
    s_barrier
    ds_read_b64_tr_b16 a[160:161], v12 offset:32768
    ds_read_b64_tr_b16 a[162:163], v12 offset:36864
    ds_read_b64_tr_b16 a[164:165], v12 offset:40960
    ds_read_b64_tr_b16 a[166:167], v12 offset:45056
    ds_read_b64_tr_b16 a[168:169], v13 offset:32768
    ds_read_b64_tr_b16 a[170:171], v13 offset:36864
    ds_read_b64_tr_b16 a[172:173], v13 offset:40960
    ds_read_b64_tr_b16 a[174:175], v13 offset:45056
    ds_read_b64_tr_b16 a[176:177], v14 offset:32768
    ds_read_b64_tr_b16 a[178:179], v14 offset:36864
    ds_read_b64_tr_b16 a[180:181], v14 offset:40960
    ds_read_b64_tr_b16 a[182:183], v14 offset:45056
    buffer_load_dwordx4 a[16:19], v51, s[24:27], s46 offen offset:256 sc1
    buffer_load_dwordx4 a[24:27], v51, s[24:27], s46 offen offset:384 sc1
    buffer_load_dwordx4 a[20:23], v51, s[24:27], s43 offen offset:256 sc1
    buffer_load_dwordx4 a[28:31], v51, s[24:27], s43 offen offset:384 sc1
    s_waitcnt lgkmcnt(10)
    s_waitcnt vmcnt(7)
    v_mfma_f32_16x16x32_bf16 v[128:131], a[160:163], a[0:3], 0
    s_waitcnt vmcnt(6)
    s_waitcnt lgkmcnt(8)
    ds_read_b64_tr_b16 a[184:185], v15 offset:32768
    v_mfma_f32_16x16x32_bf16 v[128:131], a[164:167], a[8:11], v[128:131]
    s_waitcnt vmcnt(5)
    ds_read_b64_tr_b16 a[186:187], v15 offset:36864
    v_mfma_f32_16x16x32_bf16 v[132:135], a[160:163], a[4:7], 0
    s_waitcnt vmcnt(4)
    ds_read_b64_tr_b16 a[188:189], v15 offset:40960
    v_mfma_f32_16x16x32_bf16 v[132:135], a[164:167], a[12:15], v[132:135]
    s_waitcnt lgkmcnt(9)
    buffer_load_dwordx4 a[32:35], v51, s[24:27], s46 offen offset:512 sc1
    v_mfma_f32_16x16x32_bf16 v[136:139], a[168:171], a[0:3], 0
    s_waitcnt lgkmcnt(7)
    ds_read_b64_tr_b16 a[190:191], v15 offset:45056
    ds_read_b64_tr_b16 a[160:161], v16 offset:32768
    v_mfma_f32_16x16x32_bf16 v[136:139], a[172:175], a[8:11], v[136:139]
    ds_read_b64_tr_b16 a[162:163], v16 offset:36864
    v_mfma_f32_16x16x32_bf16 v[140:143], a[168:171], a[4:7], 0
    ds_read_b64_tr_b16 a[164:165], v16 offset:40960
    v_mfma_f32_16x16x32_bf16 v[140:143], a[172:175], a[12:15], v[140:143]
    s_waitcnt lgkmcnt(9)
    buffer_load_dwordx4 a[40:43], v51, s[24:27], s46 offen offset:640 sc1
    v_mfma_f32_16x16x32_bf16 v[144:147], a[176:179], a[0:3], 0
    s_waitcnt lgkmcnt(7)
    ds_read_b64_tr_b16 a[166:167], v16 offset:45056
    ds_read_b64_tr_b16 a[168:169], v17 offset:32768
    v_mfma_f32_16x16x32_bf16 v[144:147], a[180:183], a[8:11], v[144:147]
    ds_read_b64_tr_b16 a[170:171], v17 offset:36864
    v_mfma_f32_16x16x32_bf16 v[148:151], a[176:179], a[4:7], 0
    ds_read_b64_tr_b16 a[172:173], v17 offset:40960
    v_mfma_f32_16x16x32_bf16 v[148:151], a[180:183], a[12:15], v[148:151]
    s_waitcnt lgkmcnt(9)
    buffer_load_dwordx4 a[36:39], v51, s[24:27], s43 offen offset:512 sc1
    v_mfma_f32_16x16x32_bf16 v[152:155], a[184:187], a[0:3], 0
    s_waitcnt lgkmcnt(7)
    ds_read_b64_tr_b16 a[174:175], v17 offset:45056
    ds_read_b64_tr_b16 a[176:177], v18 offset:32768
    v_mfma_f32_16x16x32_bf16 v[152:155], a[188:191], a[8:11], v[152:155]
    ds_read_b64_tr_b16 a[178:179], v18 offset:36864
    v_mfma_f32_16x16x32_bf16 v[156:159], a[184:187], a[4:7], 0
    ds_read_b64_tr_b16 a[180:181], v18 offset:40960
    v_mfma_f32_16x16x32_bf16 v[156:159], a[188:191], a[12:15], v[156:159]
    s_waitcnt lgkmcnt(9)
    buffer_load_dwordx4 a[44:47], v51, s[24:27], s43 offen offset:640 sc1
    v_mfma_f32_16x16x32_bf16 v[160:163], a[160:163], a[0:3], 0
    s_waitcnt lgkmcnt(7)
    ds_read_b64_tr_b16 a[182:183], v18 offset:45056
    ds_read_b64_tr_b16 a[184:185], v19 offset:32768
    v_mfma_f32_16x16x32_bf16 v[160:163], a[164:167], a[8:11], v[160:163]
    ds_read_b64_tr_b16 a[186:187], v19 offset:36864
    v_mfma_f32_16x16x32_bf16 v[164:167], a[160:163], a[4:7], 0
    ds_read_b64_tr_b16 a[188:189], v19 offset:40960
    v_mfma_f32_16x16x32_bf16 v[164:167], a[164:167], a[12:15], v[164:167]
    s_waitcnt lgkmcnt(9)
    buffer_load_dword v77, v70, s[16:19], s44 offen
    v_mfma_f32_16x16x32_bf16 v[168:171], a[168:171], a[0:3], 0
    s_waitcnt lgkmcnt(7)
    ds_read_b64_tr_b16 a[190:191], v19 offset:45056
    ds_read_b64_tr_b16 a[160:161], v12 offset:49152
    v_mfma_f32_16x16x32_bf16 v[168:171], a[172:175], a[8:11], v[168:171]
    ds_read_b64_tr_b16 a[162:163], v12 offset:53248
    v_mfma_f32_16x16x32_bf16 v[172:175], a[168:171], a[4:7], 0
    ds_read_b64_tr_b16 a[164:165], v12 offset:57344
    v_mfma_f32_16x16x32_bf16 v[172:175], a[172:175], a[12:15], v[172:175]
    s_waitcnt lgkmcnt(9)
    ds_read_b64_tr_b16 a[166:167], v12 offset:61440
    v_mfma_f32_16x16x32_bf16 v[176:179], a[176:179], a[0:3], 0
    s_waitcnt lgkmcnt(8)
    ds_read_b64_tr_b16 a[168:169], v13 offset:49152
    v_mfma_f32_16x16x32_bf16 v[176:179], a[180:183], a[8:11], v[176:179]
    ds_read_b64_tr_b16 a[170:171], v13 offset:53248
    v_mfma_f32_16x16x32_bf16 v[180:183], a[176:179], a[4:7], 0
    ds_read_b64_tr_b16 a[172:173], v13 offset:57344
    v_mfma_f32_16x16x32_bf16 v[180:183], a[180:183], a[12:15], v[180:183]
    s_waitcnt lgkmcnt(9)
    ds_read_b64_tr_b16 a[174:175], v13 offset:61440
    v_mfma_f32_16x16x32_bf16 v[184:187], a[184:187], a[0:3], 0
    s_waitcnt lgkmcnt(8)
    ds_read_b64_tr_b16 a[176:177], v14 offset:49152
    v_mfma_f32_16x16x32_bf16 v[184:187], a[188:191], a[8:11], v[184:187]
    ds_read_b64_tr_b16 a[178:179], v14 offset:53248
    v_mfma_f32_16x16x32_bf16 v[188:191], a[184:187], a[4:7], 0
    ds_read_b64_tr_b16 a[180:181], v14 offset:57344
    v_mfma_f32_16x16x32_bf16 v[188:191], a[188:191], a[12:15], v[188:191]
    s_waitcnt lgkmcnt(9)
    ds_read_b64_tr_b16 a[182:183], v14 offset:61440
    v_mfma_f32_16x16x32_bf16 v[192:195], a[160:163], a[0:3], 0
    s_waitcnt lgkmcnt(8)
    ds_read_b64_tr_b16 a[184:185], v15 offset:49152
    v_mfma_f32_16x16x32_bf16 v[192:195], a[164:167], a[8:11], v[192:195]
    ds_read_b64_tr_b16 a[186:187], v15 offset:53248
    v_mfma_f32_16x16x32_bf16 v[196:199], a[160:163], a[4:7], 0
    ds_read_b64_tr_b16 a[188:189], v15 offset:57344
    v_mfma_f32_16x16x32_bf16 v[196:199], a[164:167], a[12:15], v[196:199]
    s_waitcnt lgkmcnt(9)
    ds_read_b64_tr_b16 a[190:191], v15 offset:61440
    v_mfma_f32_16x16x32_bf16 v[200:203], a[168:171], a[0:3], 0
    s_waitcnt lgkmcnt(8)
    ds_read_b64_tr_b16 a[160:161], v16 offset:49152
    v_mfma_f32_16x16x32_bf16 v[200:203], a[172:175], a[8:11], v[200:203]
    ds_read_b64_tr_b16 a[162:163], v16 offset:53248
    v_mfma_f32_16x16x32_bf16 v[204:207], a[168:171], a[4:7], 0
    ds_read_b64_tr_b16 a[164:165], v16 offset:57344
    v_mfma_f32_16x16x32_bf16 v[204:207], a[172:175], a[12:15], v[204:207]
    s_waitcnt lgkmcnt(9)
    ds_read_b64_tr_b16 a[166:167], v16 offset:61440
    v_mfma_f32_16x16x32_bf16 v[208:211], a[176:179], a[0:3], 0
    s_waitcnt lgkmcnt(8)
    ds_read_b64_tr_b16 a[168:169], v17 offset:49152
    v_mfma_f32_16x16x32_bf16 v[208:211], a[180:183], a[8:11], v[208:211]
    ds_read_b64_tr_b16 a[170:171], v17 offset:53248
    v_mfma_f32_16x16x32_bf16 v[212:215], a[176:179], a[4:7], 0
    ds_read_b64_tr_b16 a[172:173], v17 offset:57344
    v_mfma_f32_16x16x32_bf16 v[212:215], a[180:183], a[12:15], v[212:215]
    s_waitcnt lgkmcnt(9)
    ds_read_b64_tr_b16 a[174:175], v17 offset:61440
    v_mfma_f32_16x16x32_bf16 v[216:219], a[184:187], a[0:3], 0
    s_waitcnt lgkmcnt(8)
    ds_read_b64_tr_b16 a[176:177], v18 offset:49152
    v_mfma_f32_16x16x32_bf16 v[216:219], a[188:191], a[8:11], v[216:219]
    ds_read_b64_tr_b16 a[178:179], v18 offset:53248
    v_mfma_f32_16x16x32_bf16 v[220:223], a[184:187], a[4:7], 0
    ds_read_b64_tr_b16 a[180:181], v18 offset:57344
    v_mfma_f32_16x16x32_bf16 v[220:223], a[188:191], a[12:15], v[220:223]
    s_waitcnt lgkmcnt(9)
    ds_read_b64_tr_b16 a[182:183], v18 offset:61440
    v_mfma_f32_16x16x32_bf16 v[224:227], a[160:163], a[0:3], 0
    s_waitcnt lgkmcnt(8)
    ds_read_b64_tr_b16 a[184:185], v19 offset:49152
    v_mfma_f32_16x16x32_bf16 v[224:227], a[164:167], a[8:11], v[224:227]
    ds_read_b64_tr_b16 a[186:187], v19 offset:53248
    v_mfma_f32_16x16x32_bf16 v[228:231], a[160:163], a[4:7], 0
    ds_read_b64_tr_b16 a[188:189], v19 offset:57344
    v_mfma_f32_16x16x32_bf16 v[228:231], a[164:167], a[12:15], v[228:231]
    s_waitcnt lgkmcnt(9)
    ds_read_b64_tr_b16 a[190:191], v19 offset:61440
    s_barrier
    v_mfma_f32_16x16x32_bf16 v[232:235], a[168:171], a[0:3], 0
    s_waitcnt lgkmcnt(8)
    ds_read_b64_tr_b16 a[160:161], v20 offset:0
    v_mfma_f32_16x16x32_bf16 v[232:235], a[172:175], a[8:11], v[232:235]
    s_add_u32 s49, s44, 1572864
    ds_read_b64_tr_b16 a[162:163], v20 offset:4096
    v_mfma_f32_16x16x32_bf16 v[236:239], a[168:171], a[4:7], 0
    s_add_u32 m0, s42, 131072
    ds_read_b64_tr_b16 a[164:165], v20 offset:8192
    v_mfma_f32_16x16x32_bf16 v[236:239], a[172:175], a[12:15], v[236:239]
    s_waitcnt lgkmcnt(9)
    buffer_load_dwordx4 v42, s[16:19], s49 offen lds
    v_mfma_f32_16x16x32_bf16 v[240:243], a[176:179], a[0:3], 0
    s_waitcnt lgkmcnt(7)
    ds_read_b64_tr_b16 a[166:167], v20 offset:12288
    ds_read_b64_tr_b16 a[168:169], v21 offset:0
    v_mfma_f32_16x16x32_bf16 v[240:243], a[180:183], a[8:11], v[240:243]
    ds_read_b64_tr_b16 a[170:171], v21 offset:4096
    v_mfma_f32_16x16x32_bf16 v[244:247], a[176:179], a[4:7], 0
    ds_read_b64_tr_b16 a[172:173], v21 offset:8192
    v_mfma_f32_16x16x32_bf16 v[244:247], a[180:183], a[12:15], v[244:247]
    s_waitcnt lgkmcnt(9)
    buffer_load_dwordx4 v43, s[16:19], s49 offen offset:1024 lds
    v_mfma_f32_16x16x32_bf16 v[248:251], a[184:187], a[0:3], 0
    s_waitcnt lgkmcnt(7)
    ds_read_b64_tr_b16 a[174:175], v21 offset:12288
    ds_read_b64_tr_b16 a[176:177], v22 offset:0
    v_mfma_f32_16x16x32_bf16 v[248:251], a[188:191], a[8:11], v[248:251]
    ds_read_b64_tr_b16 a[178:179], v22 offset:4096
    v_mfma_f32_16x16x32_bf16 v[252:255], a[184:187], a[4:7], 0
    ds_read_b64_tr_b16 a[180:181], v22 offset:8192
    v_mfma_f32_16x16x32_bf16 v[252:255], a[188:191], a[12:15], v[252:255]
    s_waitcnt vmcnt(10)
    s_waitcnt lgkmcnt(9)
    buffer_load_dwordx4 v44, s[16:19], s49 offen offset:2048 lds
    v_mfma_f32_16x16x32_bf16 v[128:131], a[160:163], a[16:19], v[128:131]
    s_waitcnt vmcnt(10)
    s_waitcnt lgkmcnt(7)
    ds_read_b64_tr_b16 a[182:183], v22 offset:12288
    ds_read_b64_tr_b16 a[184:185], v23 offset:0
    v_mfma_f32_16x16x32_bf16 v[128:131], a[164:167], a[24:27], v[128:131]
    s_waitcnt vmcnt(9)
    ds_read_b64_tr_b16 a[186:187], v23 offset:4096
    v_mfma_f32_16x16x32_bf16 v[132:135], a[160:163], a[20:23], v[132:135]
    s_waitcnt vmcnt(8)
    ds_read_b64_tr_b16 a[188:189], v23 offset:8192
    v_mfma_f32_16x16x32_bf16 v[132:135], a[164:167], a[28:31], v[132:135]
    s_waitcnt lgkmcnt(9)
    buffer_load_dwordx4 v45, s[16:19], s49 offen offset:3072 lds
    v_mfma_f32_16x16x32_bf16 v[136:139], a[168:171], a[16:19], v[136:139]
    s_waitcnt lgkmcnt(7)
    ds_read_b64_tr_b16 a[190:191], v23 offset:12288
    ds_read_b64_tr_b16 a[160:161], v24 offset:0
    v_mfma_f32_16x16x32_bf16 v[136:139], a[172:175], a[24:27], v[136:139]
    s_add_u32 s49, s44, 1573120
    ds_read_b64_tr_b16 a[162:163], v24 offset:4096
    v_mfma_f32_16x16x32_bf16 v[140:143], a[168:171], a[20:23], v[140:143]
    s_add_u32 m0, s42, 147456
    ds_read_b64_tr_b16 a[164:165], v24 offset:8192
    v_mfma_f32_16x16x32_bf16 v[140:143], a[172:175], a[28:31], v[140:143]
    s_waitcnt lgkmcnt(9)
    buffer_load_dwordx4 v42, s[16:19], s49 offen lds
    v_mfma_f32_16x16x32_bf16 v[144:147], a[176:179], a[16:19], v[144:147]
    s_waitcnt lgkmcnt(7)
    ds_read_b64_tr_b16 a[166:167], v24 offset:12288
    ds_read_b64_tr_b16 a[168:169], v25 offset:0
    v_mfma_f32_16x16x32_bf16 v[144:147], a[180:183], a[24:27], v[144:147]
    ds_read_b64_tr_b16 a[170:171], v25 offset:4096
    v_mfma_f32_16x16x32_bf16 v[148:151], a[176:179], a[20:23], v[148:151]
    ds_read_b64_tr_b16 a[172:173], v25 offset:8192
    v_mfma_f32_16x16x32_bf16 v[148:151], a[180:183], a[28:31], v[148:151]
    s_waitcnt lgkmcnt(9)
    buffer_load_dwordx4 v43, s[16:19], s49 offen offset:1024 lds
    v_mfma_f32_16x16x32_bf16 v[152:155], a[184:187], a[16:19], v[152:155]
    s_waitcnt lgkmcnt(7)
    ds_read_b64_tr_b16 a[174:175], v25 offset:12288
    ds_read_b64_tr_b16 a[176:177], v26 offset:0
    v_mfma_f32_16x16x32_bf16 v[152:155], a[188:191], a[24:27], v[152:155]
    ds_read_b64_tr_b16 a[178:179], v26 offset:4096
    v_mfma_f32_16x16x32_bf16 v[156:159], a[184:187], a[20:23], v[156:159]
    ds_read_b64_tr_b16 a[180:181], v26 offset:8192
    v_mfma_f32_16x16x32_bf16 v[156:159], a[188:191], a[28:31], v[156:159]
    s_waitcnt lgkmcnt(9)
    buffer_load_dwordx4 v44, s[16:19], s49 offen offset:2048 lds
    v_mfma_f32_16x16x32_bf16 v[160:163], a[160:163], a[16:19], v[160:163]
    s_waitcnt lgkmcnt(7)
    ds_read_b64_tr_b16 a[182:183], v26 offset:12288
    ds_read_b64_tr_b16 a[184:185], v27 offset:0
    v_mfma_f32_16x16x32_bf16 v[160:163], a[164:167], a[24:27], v[160:163]
    ds_read_b64_tr_b16 a[186:187], v27 offset:4096
    v_mfma_f32_16x16x32_bf16 v[164:167], a[160:163], a[20:23], v[164:167]
    ds_read_b64_tr_b16 a[188:189], v27 offset:8192
    v_mfma_f32_16x16x32_bf16 v[164:167], a[164:167], a[28:31], v[164:167]
    s_waitcnt lgkmcnt(9)
    buffer_load_dwordx4 v45, s[16:19], s49 offen offset:3072 lds
    v_mfma_f32_16x16x32_bf16 v[168:171], a[168:171], a[16:19], v[168:171]
    s_waitcnt lgkmcnt(7)
    ds_read_b64_tr_b16 a[190:191], v27 offset:12288
    ds_read_b64_tr_b16 a[160:161], v20 offset:16384
    v_mfma_f32_16x16x32_bf16 v[168:171], a[172:175], a[24:27], v[168:171]
    ds_read_b64_tr_b16 a[162:163], v20 offset:20480
    v_mfma_f32_16x16x32_bf16 v[172:175], a[168:171], a[20:23], v[172:175]
    ds_read_b64_tr_b16 a[164:165], v20 offset:24576
    v_mfma_f32_16x16x32_bf16 v[172:175], a[172:175], a[28:31], v[172:175]
    s_waitcnt lgkmcnt(9)
    buffer_load_dwordx4 a[48:51], v51, s[24:27], s46 offen offset:768 sc1
    v_mfma_f32_16x16x32_bf16 v[176:179], a[176:179], a[16:19], v[176:179]
    s_waitcnt lgkmcnt(7)
    ds_read_b64_tr_b16 a[166:167], v20 offset:28672
    ds_read_b64_tr_b16 a[168:169], v21 offset:16384
    v_mfma_f32_16x16x32_bf16 v[176:179], a[180:183], a[24:27], v[176:179]
    ds_read_b64_tr_b16 a[170:171], v21 offset:20480
    v_mfma_f32_16x16x32_bf16 v[180:183], a[176:179], a[20:23], v[180:183]
    ds_read_b64_tr_b16 a[172:173], v21 offset:24576
    v_mfma_f32_16x16x32_bf16 v[180:183], a[180:183], a[28:31], v[180:183]
    s_waitcnt lgkmcnt(9)
    buffer_load_dwordx4 a[56:59], v51, s[24:27], s46 offen offset:896 sc1
    v_mfma_f32_16x16x32_bf16 v[184:187], a[184:187], a[16:19], v[184:187]
    s_waitcnt lgkmcnt(7)
    ds_read_b64_tr_b16 a[174:175], v21 offset:28672
    ds_read_b64_tr_b16 a[176:177], v22 offset:16384
    v_mfma_f32_16x16x32_bf16 v[184:187], a[188:191], a[24:27], v[184:187]
    ds_read_b64_tr_b16 a[178:179], v22 offset:20480
    v_mfma_f32_16x16x32_bf16 v[188:191], a[184:187], a[20:23], v[188:191]
    ds_read_b64_tr_b16 a[180:181], v22 offset:24576
    v_mfma_f32_16x16x32_bf16 v[188:191], a[188:191], a[28:31], v[188:191]
    s_waitcnt lgkmcnt(9)
    buffer_load_dwordx4 a[52:55], v51, s[24:27], s43 offen offset:768 sc1
    v_mfma_f32_16x16x32_bf16 v[192:195], a[160:163], a[16:19], v[192:195]
    s_waitcnt lgkmcnt(7)
    ds_read_b64_tr_b16 a[182:183], v22 offset:28672
    ds_read_b64_tr_b16 a[184:185], v23 offset:16384
    v_mfma_f32_16x16x32_bf16 v[192:195], a[164:167], a[24:27], v[192:195]
    ds_read_b64_tr_b16 a[186:187], v23 offset:20480
    v_mfma_f32_16x16x32_bf16 v[196:199], a[160:163], a[20:23], v[196:199]
    ds_read_b64_tr_b16 a[188:189], v23 offset:24576
    v_mfma_f32_16x16x32_bf16 v[196:199], a[164:167], a[28:31], v[196:199]
    s_waitcnt lgkmcnt(9)
    buffer_load_dwordx4 a[60:63], v51, s[24:27], s43 offen offset:896 sc1
    v_mfma_f32_16x16x32_bf16 v[200:203], a[168:171], a[16:19], v[200:203]
    s_waitcnt lgkmcnt(7)
    ds_read_b64_tr_b16 a[190:191], v23 offset:28672
    ds_read_b64_tr_b16 a[160:161], v24 offset:16384
    v_mfma_f32_16x16x32_bf16 v[200:203], a[172:175], a[24:27], v[200:203]
    ds_read_b64_tr_b16 a[162:163], v24 offset:20480
    v_mfma_f32_16x16x32_bf16 v[204:207], a[168:171], a[20:23], v[204:207]
    ds_read_b64_tr_b16 a[164:165], v24 offset:24576
    v_mfma_f32_16x16x32_bf16 v[204:207], a[172:175], a[28:31], v[204:207]
    s_waitcnt lgkmcnt(9)
    ds_read_b64_tr_b16 a[166:167], v24 offset:28672
    v_mfma_f32_16x16x32_bf16 v[208:211], a[176:179], a[16:19], v[208:211]
    s_waitcnt lgkmcnt(8)
    ds_read_b64_tr_b16 a[168:169], v25 offset:16384
    v_mfma_f32_16x16x32_bf16 v[208:211], a[180:183], a[24:27], v[208:211]
    ds_read_b64_tr_b16 a[170:171], v25 offset:20480
    v_mfma_f32_16x16x32_bf16 v[212:215], a[176:179], a[20:23], v[212:215]
    ds_read_b64_tr_b16 a[172:173], v25 offset:24576
    v_mfma_f32_16x16x32_bf16 v[212:215], a[180:183], a[28:31], v[212:215]
    s_waitcnt lgkmcnt(9)
    ds_read_b64_tr_b16 a[174:175], v25 offset:28672
    v_mfma_f32_16x16x32_bf16 v[216:219], a[184:187], a[16:19], v[216:219]
    s_waitcnt lgkmcnt(8)
    ds_read_b64_tr_b16 a[176:177], v26 offset:16384
    v_mfma_f32_16x16x32_bf16 v[216:219], a[188:191], a[24:27], v[216:219]
    ds_read_b64_tr_b16 a[178:179], v26 offset:20480
    v_mfma_f32_16x16x32_bf16 v[220:223], a[184:187], a[20:23], v[220:223]
    ds_read_b64_tr_b16 a[180:181], v26 offset:24576
    v_mfma_f32_16x16x32_bf16 v[220:223], a[188:191], a[28:31], v[220:223]
    s_waitcnt lgkmcnt(9)
    ds_read_b64_tr_b16 a[182:183], v26 offset:28672
    v_mfma_f32_16x16x32_bf16 v[224:227], a[160:163], a[16:19], v[224:227]
    s_waitcnt lgkmcnt(8)
    ds_read_b64_tr_b16 a[184:185], v27 offset:16384
    v_mfma_f32_16x16x32_bf16 v[224:227], a[164:167], a[24:27], v[224:227]
    ds_read_b64_tr_b16 a[186:187], v27 offset:20480
    v_mfma_f32_16x16x32_bf16 v[228:231], a[160:163], a[20:23], v[228:231]
    ds_read_b64_tr_b16 a[188:189], v27 offset:24576
    v_mfma_f32_16x16x32_bf16 v[228:231], a[164:167], a[28:31], v[228:231]
    s_waitcnt lgkmcnt(9)
    ds_read_b64_tr_b16 a[190:191], v27 offset:28672
    s_barrier
    v_mfma_f32_16x16x32_bf16 v[232:235], a[168:171], a[16:19], v[232:235]
    s_waitcnt lgkmcnt(8)
    ds_read_b64_tr_b16 a[160:161], v20 offset:32768
    v_mfma_f32_16x16x32_bf16 v[232:235], a[172:175], a[24:27], v[232:235]
    s_add_u32 s49, s44, 2097152
    ds_read_b64_tr_b16 a[162:163], v20 offset:36864
    v_mfma_f32_16x16x32_bf16 v[236:239], a[168:171], a[20:23], v[236:239]
    s_add_u32 m0, s42, 0
    ds_read_b64_tr_b16 a[164:165], v20 offset:40960
    v_mfma_f32_16x16x32_bf16 v[236:239], a[172:175], a[28:31], v[236:239]
    s_waitcnt lgkmcnt(9)
    buffer_load_dwordx4 v42, s[16:19], s49 offen lds
    v_mfma_f32_16x16x32_bf16 v[240:243], a[176:179], a[16:19], v[240:243]
    s_waitcnt lgkmcnt(7)
    ds_read_b64_tr_b16 a[166:167], v20 offset:45056
    ds_read_b64_tr_b16 a[168:169], v21 offset:32768
    v_mfma_f32_16x16x32_bf16 v[240:243], a[180:183], a[24:27], v[240:243]
Ltour0:
    s_cbranch_execz Ltour4
    ds_read_b64_tr_b16 a[170:171], v21 offset:36864
    v_mfma_f32_16x16x32_bf16 v[244:247], a[176:179], a[20:23], v[244:247]
    ds_read_b64_tr_b16 a[172:173], v21 offset:40960
    v_mfma_f32_16x16x32_bf16 v[244:247], a[180:183], a[28:31], v[244:247]
    s_waitcnt lgkmcnt(9)
    buffer_load_dwordx4 v43, s[16:19], s49 offen offset:1024 lds
    v_mfma_f32_16x16x32_bf16 v[248:251], a[184:187], a[16:19], v[248:251]
    s_waitcnt lgkmcnt(7)
    ds_read_b64_tr_b16 a[174:175], v21 offset:45056
    ds_read_b64_tr_b16 a[176:177], v22 offset:32768
    v_mfma_f32_16x16x32_bf16 v[248:251], a[188:191], a[24:27], v[248:251]
    ds_read_b64_tr_b16 a[178:179], v22 offset:36864
    v_mfma_f32_16x16x32_bf16 v[252:255], a[184:187], a[20:23], v[252:255]
    ds_read_b64_tr_b16 a[180:181], v22 offset:40960
    v_mfma_f32_16x16x32_bf16 v[252:255], a[188:191], a[28:31], v[252:255]
    s_waitcnt vmcnt(18)
    s_waitcnt lgkmcnt(9)
    buffer_load_dwordx4 v44, s[16:19], s49 offen offset:2048 lds
    v_mfma_f32_16x16x32_bf16 v[128:131], a[160:163], a[32:35], v[128:131]
    s_waitcnt vmcnt(18)
    s_waitcnt lgkmcnt(7)
    ds_read_b64_tr_b16 a[182:183], v22 offset:45056
    ds_read_b64_tr_b16 a[184:185], v23 offset:32768
    v_mfma_f32_16x16x32_bf16 v[128:131], a[164:167], a[40:43], v[128:131]
    s_waitcnt vmcnt(17)
    ds_read_b64_tr_b16 a[186:187], v23 offset:36864
    v_mfma_f32_16x16x32_bf16 v[132:135], a[160:163], a[36:39], v[132:135]
    s_waitcnt vmcnt(16)
    ds_read_b64_tr_b16 a[188:189], v23 offset:40960
    v_mfma_f32_16x16x32_bf16 v[132:135], a[164:167], a[44:47], v[132:135]
    s_waitcnt lgkmcnt(9)
    buffer_load_dwordx4 v45, s[16:19], s49 offen offset:3072 lds
    v_mfma_f32_16x16x32_bf16 v[136:139], a[168:171], a[32:35], v[136:139]
    s_waitcnt lgkmcnt(7)
    ds_read_b64_tr_b16 a[190:191], v23 offset:45056
    ds_read_b64_tr_b16 a[160:161], v24 offset:32768
    v_mfma_f32_16x16x32_bf16 v[136:139], a[172:175], a[40:43], v[136:139]
    s_add_u32 s49, s44, 2097408
    ds_read_b64_tr_b16 a[162:163], v24 offset:36864
    v_mfma_f32_16x16x32_bf16 v[140:143], a[168:171], a[36:39], v[140:143]
    s_add_u32 m0, s42, 16384
    ds_read_b64_tr_b16 a[164:165], v24 offset:40960
    v_mfma_f32_16x16x32_bf16 v[140:143], a[172:175], a[44:47], v[140:143]
    s_waitcnt lgkmcnt(9)
    buffer_load_dwordx4 v42, s[16:19], s49 offen lds
    v_mfma_f32_16x16x32_bf16 v[144:147], a[176:179], a[32:35], v[144:147]
    s_waitcnt lgkmcnt(7)
    ds_read_b64_tr_b16 a[166:167], v24 offset:45056
    ds_read_b64_tr_b16 a[168:169], v25 offset:32768
    v_mfma_f32_16x16x32_bf16 v[144:147], a[180:183], a[40:43], v[144:147]
    ds_read_b64_tr_b16 a[170:171], v25 offset:36864
    v_mfma_f32_16x16x32_bf16 v[148:151], a[176:179], a[36:39], v[148:151]
    ds_read_b64_tr_b16 a[172:173], v25 offset:40960
    v_mfma_f32_16x16x32_bf16 v[148:151], a[180:183], a[44:47], v[148:151]
    s_waitcnt lgkmcnt(9)
    buffer_load_dwordx4 v43, s[16:19], s49 offen offset:1024 lds
    v_mfma_f32_16x16x32_bf16 v[152:155], a[184:187], a[32:35], v[152:155]
    s_waitcnt lgkmcnt(7)
    ds_read_b64_tr_b16 a[174:175], v25 offset:45056
    ds_read_b64_tr_b16 a[176:177], v26 offset:32768
    v_mfma_f32_16x16x32_bf16 v[152:155], a[188:191], a[40:43], v[152:155]
    ds_read_b64_tr_b16 a[178:179], v26 offset:36864
    v_mfma_f32_16x16x32_bf16 v[156:159], a[184:187], a[36:39], v[156:159]
    ds_read_b64_tr_b16 a[180:181], v26 offset:40960
    v_mfma_f32_16x16x32_bf16 v[156:159], a[188:191], a[44:47], v[156:159]
    s_waitcnt lgkmcnt(9)
    buffer_load_dwordx4 v44, s[16:19], s49 offen offset:2048 lds
    v_mfma_f32_16x16x32_bf16 v[160:163], a[160:163], a[32:35], v[160:163]
    s_waitcnt lgkmcnt(7)
    ds_read_b64_tr_b16 a[182:183], v26 offset:45056
    ds_read_b64_tr_b16 a[184:185], v27 offset:32768
    v_mfma_f32_16x16x32_bf16 v[160:163], a[164:167], a[40:43], v[160:163]
    ds_read_b64_tr_b16 a[186:187], v27 offset:36864
    v_mfma_f32_16x16x32_bf16 v[164:167], a[160:163], a[36:39], v[164:167]
    ds_read_b64_tr_b16 a[188:189], v27 offset:40960
    v_mfma_f32_16x16x32_bf16 v[164:167], a[164:167], a[44:47], v[164:167]
    s_waitcnt lgkmcnt(9)
    buffer_load_dwordx4 v45, s[16:19], s49 offen offset:3072 lds
    v_mfma_f32_16x16x32_bf16 v[168:171], a[168:171], a[32:35], v[168:171]
    s_waitcnt lgkmcnt(7)
    ds_read_b64_tr_b16 a[190:191], v27 offset:45056
    ds_read_b64_tr_b16 a[160:161], v20 offset:49152
    v_mfma_f32_16x16x32_bf16 v[168:171], a[172:175], a[40:43], v[168:171]
    ds_read_b64_tr_b16 a[162:163], v20 offset:53248
    v_mfma_f32_16x16x32_bf16 v[172:175], a[168:171], a[36:39], v[172:175]
    ds_read_b64_tr_b16 a[164:165], v20 offset:57344
    v_mfma_f32_16x16x32_bf16 v[172:175], a[172:175], a[44:47], v[172:175]
    s_waitcnt lgkmcnt(9)
    buffer_load_dwordx4 a[64:67], v51, s[24:27], s46 offen offset:1024 sc1
    v_mfma_f32_16x16x32_bf16 v[176:179], a[176:179], a[32:35], v[176:179]
    s_waitcnt lgkmcnt(7)
    ds_read_b64_tr_b16 a[166:167], v20 offset:61440
    ds_read_b64_tr_b16 a[168:169], v21 offset:49152
    v_mfma_f32_16x16x32_bf16 v[176:179], a[180:183], a[40:43], v[176:179]
    ds_read_b64_tr_b16 a[170:171], v21 offset:53248
    v_mfma_f32_16x16x32_bf16 v[180:183], a[176:179], a[36:39], v[180:183]
    ds_read_b64_tr_b16 a[172:173], v21 offset:57344
    v_mfma_f32_16x16x32_bf16 v[180:183], a[180:183], a[44:47], v[180:183]
    s_waitcnt lgkmcnt(9)
    buffer_load_dwordx4 a[72:75], v51, s[24:27], s46 offen offset:1152 sc1
    v_mfma_f32_16x16x32_bf16 v[184:187], a[184:187], a[32:35], v[184:187]
    s_waitcnt lgkmcnt(7)
    ds_read_b64_tr_b16 a[174:175], v21 offset:61440
    ds_read_b64_tr_b16 a[176:177], v22 offset:49152
    v_mfma_f32_16x16x32_bf16 v[184:187], a[188:191], a[40:43], v[184:187]
    ds_read_b64_tr_b16 a[178:179], v22 offset:53248
    v_mfma_f32_16x16x32_bf16 v[188:191], a[184:187], a[36:39], v[188:191]
    ds_read_b64_tr_b16 a[180:181], v22 offset:57344
    v_mfma_f32_16x16x32_bf16 v[188:191], a[188:191], a[44:47], v[188:191]
    s_waitcnt lgkmcnt(9)
    buffer_load_dwordx4 a[68:71], v51, s[24:27], s43 offen offset:1024 sc1
    v_mfma_f32_16x16x32_bf16 v[192:195], a[160:163], a[32:35], v[192:195]
    s_waitcnt lgkmcnt(7)
    ds_read_b64_tr_b16 a[182:183], v22 offset:61440
    ds_read_b64_tr_b16 a[184:185], v23 offset:49152
    v_mfma_f32_16x16x32_bf16 v[192:195], a[164:167], a[40:43], v[192:195]
    ds_read_b64_tr_b16 a[186:187], v23 offset:53248
    v_mfma_f32_16x16x32_bf16 v[196:199], a[160:163], a[36:39], v[196:199]
    ds_read_b64_tr_b16 a[188:189], v23 offset:57344
    v_mfma_f32_16x16x32_bf16 v[196:199], a[164:167], a[44:47], v[196:199]
    s_waitcnt lgkmcnt(9)
    buffer_load_dwordx4 a[76:79], v51, s[24:27], s43 offen offset:1152 sc1
    v_mfma_f32_16x16x32_bf16 v[200:203], a[168:171], a[32:35], v[200:203]
    s_waitcnt lgkmcnt(7)
    ds_read_b64_tr_b16 a[190:191], v23 offset:61440
    ds_read_b64_tr_b16 a[160:161], v24 offset:49152
    v_mfma_f32_16x16x32_bf16 v[200:203], a[172:175], a[40:43], v[200:203]
    ds_read_b64_tr_b16 a[162:163], v24 offset:53248
    v_mfma_f32_16x16x32_bf16 v[204:207], a[168:171], a[36:39], v[204:207]
    ds_read_b64_tr_b16 a[164:165], v24 offset:57344
    v_mfma_f32_16x16x32_bf16 v[204:207], a[172:175], a[44:47], v[204:207]
    s_waitcnt lgkmcnt(9)
    ds_read_b64_tr_b16 a[166:167], v24 offset:61440
    v_mfma_f32_16x16x32_bf16 v[208:211], a[176:179], a[32:35], v[208:211]
    s_waitcnt lgkmcnt(8)
    ds_read_b64_tr_b16 a[168:169], v25 offset:49152
    v_mfma_f32_16x16x32_bf16 v[208:211], a[180:183], a[40:43], v[208:211]
    ds_read_b64_tr_b16 a[170:171], v25 offset:53248
    v_mfma_f32_16x16x32_bf16 v[212:215], a[176:179], a[36:39], v[212:215]
    ds_read_b64_tr_b16 a[172:173], v25 offset:57344
    v_mfma_f32_16x16x32_bf16 v[212:215], a[180:183], a[44:47], v[212:215]
    s_waitcnt lgkmcnt(9)
    ds_read_b64_tr_b16 a[174:175], v25 offset:61440
    v_mfma_f32_16x16x32_bf16 v[216:219], a[184:187], a[32:35], v[216:219]
    s_waitcnt lgkmcnt(8)
    ds_read_b64_tr_b16 a[176:177], v26 offset:49152
    v_mfma_f32_16x16x32_bf16 v[216:219], a[188:191], a[40:43], v[216:219]
    ds_read_b64_tr_b16 a[178:179], v26 offset:53248
    v_mfma_f32_16x16x32_bf16 v[220:223], a[184:187], a[36:39], v[220:223]
    ds_read_b64_tr_b16 a[180:181], v26 offset:57344
    v_mfma_f32_16x16x32_bf16 v[220:223], a[188:191], a[44:47], v[220:223]
    s_waitcnt lgkmcnt(9)
    ds_read_b64_tr_b16 a[182:183], v26 offset:61440
    v_mfma_f32_16x16x32_bf16 v[224:227], a[160:163], a[32:35], v[224:227]
    s_waitcnt lgkmcnt(8)
    ds_read_b64_tr_b16 a[184:185], v27 offset:49152
    v_mfma_f32_16x16x32_bf16 v[224:227], a[164:167], a[40:43], v[224:227]
    ds_read_b64_tr_b16 a[186:187], v27 offset:53248
    v_mfma_f32_16x16x32_bf16 v[228:231], a[160:163], a[36:39], v[228:231]
    ds_read_b64_tr_b16 a[188:189], v27 offset:57344
    v_mfma_f32_16x16x32_bf16 v[228:231], a[164:167], a[44:47], v[228:231]
    s_waitcnt lgkmcnt(9)
    ds_read_b64_tr_b16 a[190:191], v27 offset:61440
    s_waitcnt vmcnt(16)
    s_barrier
    v_mfma_f32_16x16x32_bf16 v[232:235], a[168:171], a[32:35], v[232:235]
    s_waitcnt lgkmcnt(8)
    ds_read_b64_tr_b16 a[160:161], v28 offset:0
    v_mfma_f32_16x16x32_bf16 v[232:235], a[172:175], a[40:43], v[232:235]
    s_add_u32 s49, s44, 2621440
    ds_read_b64_tr_b16 a[162:163], v28 offset:4096
    v_mfma_f32_16x16x32_bf16 v[236:239], a[168:171], a[36:39], v[236:239]
    s_add_u32 m0, s42, 32768
    ds_read_b64_tr_b16 a[164:165], v28 offset:8192
    v_mfma_f32_16x16x32_bf16 v[236:239], a[172:175], a[44:47], v[236:239]
    s_waitcnt lgkmcnt(9)
    buffer_load_dwordx4 v42, s[16:19], s49 offen lds
    v_mfma_f32_16x16x32_bf16 v[240:243], a[176:179], a[32:35], v[240:243]
    s_waitcnt lgkmcnt(7)
    ds_read_b64_tr_b16 a[166:167], v28 offset:12288
    ds_read_b64_tr_b16 a[168:169], v29 offset:0
    v_mfma_f32_16x16x32_bf16 v[240:243], a[180:183], a[40:43], v[240:243]
    ds_read_b64_tr_b16 a[170:171], v29 offset:4096
    v_mfma_f32_16x16x32_bf16 v[244:247], a[176:179], a[36:39], v[244:247]
    ds_read_b64_tr_b16 a[172:173], v29 offset:8192
    v_mfma_f32_16x16x32_bf16 v[244:247], a[180:183], a[44:47], v[244:247]
    s_waitcnt lgkmcnt(9)
    buffer_load_dwordx4 v43, s[16:19], s49 offen offset:1024 lds
    v_mfma_f32_16x16x32_bf16 v[248:251], a[184:187], a[32:35], v[248:251]
    s_waitcnt lgkmcnt(7)
    ds_read_b64_tr_b16 a[174:175], v29 offset:12288
    ds_read_b64_tr_b16 a[176:177], v30 offset:0
    v_mfma_f32_16x16x32_bf16 v[248:251], a[188:191], a[40:43], v[248:251]
    ds_read_b64_tr_b16 a[178:179], v30 offset:4096
    v_mfma_f32_16x16x32_bf16 v[252:255], a[184:187], a[36:39], v[252:255]
    ds_read_b64_tr_b16 a[180:181], v30 offset:8192
    v_mfma_f32_16x16x32_bf16 v[252:255], a[188:191], a[44:47], v[252:255]
    s_waitcnt vmcnt(17)
    s_waitcnt lgkmcnt(9)
    buffer_load_dwordx4 v44, s[16:19], s49 offen offset:2048 lds
    v_mfma_f32_16x16x32_bf16 v[128:131], a[160:163], a[48:51], v[128:131]
    s_waitcnt vmcnt(17)
    s_waitcnt lgkmcnt(7)
    ds_read_b64_tr_b16 a[182:183], v30 offset:12288
    ds_read_b64_tr_b16 a[184:185], v31 offset:0
    v_mfma_f32_16x16x32_bf16 v[128:131], a[164:167], a[56:59], v[128:131]
    s_waitcnt vmcnt(16)
    ds_read_b64_tr_b16 a[186:187], v31 offset:4096
    v_mfma_f32_16x16x32_bf16 v[132:135], a[160:163], a[52:55], v[132:135]
    s_waitcnt vmcnt(15)
    ds_read_b64_tr_b16 a[188:189], v31 offset:8192
    v_mfma_f32_16x16x32_bf16 v[132:135], a[164:167], a[60:63], v[132:135]
    s_waitcnt lgkmcnt(9)
    buffer_load_dwordx4 v45, s[16:19], s49 offen offset:3072 lds
    v_mfma_f32_16x16x32_bf16 v[136:139], a[168:171], a[48:51], v[136:139]
    s_waitcnt lgkmcnt(7)
    ds_read_b64_tr_b16 a[190:191], v31 offset:12288
    ds_read_b64_tr_b16 a[160:161], v32 offset:0
    v_mfma_f32_16x16x32_bf16 v[136:139], a[172:175], a[56:59], v[136:139]
    s_add_u32 s49, s44, 2621696
    ds_read_b64_tr_b16 a[162:163], v32 offset:4096
    v_mfma_f32_16x16x32_bf16 v[140:143], a[168:171], a[52:55], v[140:143]
    s_add_u32 m0, s42, 49152
    ds_read_b64_tr_b16 a[164:165], v32 offset:8192
    v_mfma_f32_16x16x32_bf16 v[140:143], a[172:175], a[60:63], v[140:143]
    s_waitcnt lgkmcnt(9)
    buffer_load_dwordx4 v42, s[16:19], s49 offen lds
    v_mfma_f32_16x16x32_bf16 v[144:147], a[176:179], a[48:51], v[144:147]
    s_waitcnt lgkmcnt(7)
    ds_read_b64_tr_b16 a[166:167], v32 offset:12288
    ds_read_b64_tr_b16 a[168:169], v33 offset:0
    v_mfma_f32_16x16x32_bf16 v[144:147], a[180:183], a[56:59], v[144:147]
    ds_read_b64_tr_b16 a[170:171], v33 offset:4096
    v_mfma_f32_16x16x32_bf16 v[148:151], a[176:179], a[52:55], v[148:151]
    ds_read_b64_tr_b16 a[172:173], v33 offset:8192
    v_mfma_f32_16x16x32_bf16 v[148:151], a[180:183], a[60:63], v[148:151]
    s_waitcnt lgkmcnt(9)
    buffer_load_dwordx4 v43, s[16:19], s49 offen offset:1024 lds
    v_mfma_f32_16x16x32_bf16 v[152:155], a[184:187], a[48:51], v[152:155]
    s_waitcnt lgkmcnt(7)
    ds_read_b64_tr_b16 a[174:175], v33 offset:12288
    ds_read_b64_tr_b16 a[176:177], v34 offset:0
    v_mfma_f32_16x16x32_bf16 v[152:155], a[188:191], a[56:59], v[152:155]
    ds_read_b64_tr_b16 a[178:179], v34 offset:4096
    v_mfma_f32_16x16x32_bf16 v[156:159], a[184:187], a[52:55], v[156:159]
    ds_read_b64_tr_b16 a[180:181], v34 offset:8192
    v_mfma_f32_16x16x32_bf16 v[156:159], a[188:191], a[60:63], v[156:159]
    s_waitcnt lgkmcnt(9)
    buffer_load_dwordx4 v44, s[16:19], s49 offen offset:2048 lds
    v_mfma_f32_16x16x32_bf16 v[160:163], a[160:163], a[48:51], v[160:163]
    s_waitcnt lgkmcnt(7)
    ds_read_b64_tr_b16 a[182:183], v34 offset:12288
    ds_read_b64_tr_b16 a[184:185], v35 offset:0
    v_mfma_f32_16x16x32_bf16 v[160:163], a[164:167], a[56:59], v[160:163]
    ds_read_b64_tr_b16 a[186:187], v35 offset:4096
    v_mfma_f32_16x16x32_bf16 v[164:167], a[160:163], a[52:55], v[164:167]
    ds_read_b64_tr_b16 a[188:189], v35 offset:8192
    v_mfma_f32_16x16x32_bf16 v[164:167], a[164:167], a[60:63], v[164:167]
    s_waitcnt lgkmcnt(9)
    buffer_load_dwordx4 v45, s[16:19], s49 offen offset:3072 lds
    v_mfma_f32_16x16x32_bf16 v[168:171], a[168:171], a[48:51], v[168:171]
    s_waitcnt lgkmcnt(7)
    ds_read_b64_tr_b16 a[190:191], v35 offset:12288
    ds_read_b64_tr_b16 a[160:161], v28 offset:16384
    v_mfma_f32_16x16x32_bf16 v[168:171], a[172:175], a[56:59], v[168:171]
    ds_read_b64_tr_b16 a[162:163], v28 offset:20480
    v_mfma_f32_16x16x32_bf16 v[172:175], a[168:171], a[52:55], v[172:175]
    ds_read_b64_tr_b16 a[164:165], v28 offset:24576
    v_mfma_f32_16x16x32_bf16 v[172:175], a[172:175], a[60:63], v[172:175]
    s_waitcnt lgkmcnt(9)
    buffer_load_dwordx4 a[80:83], v51, s[24:27], s46 offen offset:1280 sc1
    v_mfma_f32_16x16x32_bf16 v[176:179], a[176:179], a[48:51], v[176:179]
    s_waitcnt lgkmcnt(7)
    ds_read_b64_tr_b16 a[166:167], v28 offset:28672
    ds_read_b64_tr_b16 a[168:169], v29 offset:16384
    v_mfma_f32_16x16x32_bf16 v[176:179], a[180:183], a[56:59], v[176:179]
    ds_read_b64_tr_b16 a[170:171], v29 offset:20480
    v_mfma_f32_16x16x32_bf16 v[180:183], a[176:179], a[52:55], v[180:183]
    ds_read_b64_tr_b16 a[172:173], v29 offset:24576
    v_mfma_f32_16x16x32_bf16 v[180:183], a[180:183], a[60:63], v[180:183]
    s_waitcnt lgkmcnt(9)
    buffer_load_dwordx4 a[88:91], v51, s[24:27], s46 offen offset:1408 sc1
    v_mfma_f32_16x16x32_bf16 v[184:187], a[184:187], a[48:51], v[184:187]
    s_waitcnt lgkmcnt(7)
    ds_read_b64_tr_b16 a[174:175], v29 offset:28672
    ds_read_b64_tr_b16 a[176:177], v30 offset:16384
    v_mfma_f32_16x16x32_bf16 v[184:187], a[188:191], a[56:59], v[184:187]
    ds_read_b64_tr_b16 a[178:179], v30 offset:20480
    v_mfma_f32_16x16x32_bf16 v[188:191], a[184:187], a[52:55], v[188:191]
    ds_read_b64_tr_b16 a[180:181], v30 offset:24576
    v_mfma_f32_16x16x32_bf16 v[188:191], a[188:191], a[60:63], v[188:191]
    s_waitcnt lgkmcnt(9)
    buffer_load_dwordx4 a[84:87], v51, s[24:27], s43 offen offset:1280 sc1
    v_mfma_f32_16x16x32_bf16 v[192:195], a[160:163], a[48:51], v[192:195]
    s_waitcnt lgkmcnt(7)
    ds_read_b64_tr_b16 a[182:183], v30 offset:28672
    ds_read_b64_tr_b16 a[184:185], v31 offset:16384
    v_mfma_f32_16x16x32_bf16 v[192:195], a[164:167], a[56:59], v[192:195]
    ds_read_b64_tr_b16 a[186:187], v31 offset:20480
    v_mfma_f32_16x16x32_bf16 v[196:199], a[160:163], a[52:55], v[196:199]
    ds_read_b64_tr_b16 a[188:189], v31 offset:24576
    v_mfma_f32_16x16x32_bf16 v[196:199], a[164:167], a[60:63], v[196:199]
    s_waitcnt lgkmcnt(9)
    buffer_load_dwordx4 a[92:95], v51, s[24:27], s43 offen offset:1408 sc1
    v_mfma_f32_16x16x32_bf16 v[200:203], a[168:171], a[48:51], v[200:203]
    s_waitcnt lgkmcnt(7)
    ds_read_b64_tr_b16 a[190:191], v31 offset:28672
    ds_read_b64_tr_b16 a[160:161], v32 offset:16384
    v_mfma_f32_16x16x32_bf16 v[200:203], a[172:175], a[56:59], v[200:203]
    ds_read_b64_tr_b16 a[162:163], v32 offset:20480
    v_mfma_f32_16x16x32_bf16 v[204:207], a[168:171], a[52:55], v[204:207]
    ds_read_b64_tr_b16 a[164:165], v32 offset:24576
    v_mfma_f32_16x16x32_bf16 v[204:207], a[172:175], a[60:63], v[204:207]
    s_waitcnt lgkmcnt(9)
    buffer_load_dword v78, v120, s[8:11], 0 offen
    v_mfma_f32_16x16x32_bf16 v[208:211], a[176:179], a[48:51], v[208:211]
    s_waitcnt lgkmcnt(7)
    ds_read_b64_tr_b16 a[166:167], v32 offset:28672
    ds_read_b64_tr_b16 a[168:169], v33 offset:16384
    v_mfma_f32_16x16x32_bf16 v[208:211], a[180:183], a[56:59], v[208:211]
    ds_read_b64_tr_b16 a[170:171], v33 offset:20480
    v_mfma_f32_16x16x32_bf16 v[212:215], a[176:179], a[52:55], v[212:215]
    ds_read_b64_tr_b16 a[172:173], v33 offset:24576
    v_mfma_f32_16x16x32_bf16 v[212:215], a[180:183], a[60:63], v[212:215]
    s_waitcnt lgkmcnt(9)
    buffer_load_dword v79, v121, s[12:15], 0 offen
    v_mfma_f32_16x16x32_bf16 v[216:219], a[184:187], a[48:51], v[216:219]
    s_waitcnt lgkmcnt(7)
    ds_read_b64_tr_b16 a[174:175], v33 offset:28672
    ds_read_b64_tr_b16 a[176:177], v34 offset:16384
    v_mfma_f32_16x16x32_bf16 v[216:219], a[188:191], a[56:59], v[216:219]
    ds_read_b64_tr_b16 a[178:179], v34 offset:20480
    v_mfma_f32_16x16x32_bf16 v[220:223], a[184:187], a[52:55], v[220:223]
    ds_read_b64_tr_b16 a[180:181], v34 offset:24576
    v_mfma_f32_16x16x32_bf16 v[220:223], a[188:191], a[60:63], v[220:223]
    s_waitcnt lgkmcnt(9)
    ds_read_b64_tr_b16 a[182:183], v34 offset:28672
    v_mfma_f32_16x16x32_bf16 v[224:227], a[160:163], a[48:51], v[224:227]
    s_waitcnt lgkmcnt(8)
    ds_read_b64_tr_b16 a[184:185], v35 offset:16384
    v_mfma_f32_16x16x32_bf16 v[224:227], a[164:167], a[56:59], v[224:227]
    ds_read_b64_tr_b16 a[186:187], v35 offset:20480
    v_mfma_f32_16x16x32_bf16 v[228:231], a[160:163], a[52:55], v[228:231]
    ds_read_b64_tr_b16 a[188:189], v35 offset:24576
    v_mfma_f32_16x16x32_bf16 v[228:231], a[164:167], a[60:63], v[228:231]
    s_waitcnt lgkmcnt(9)
    ds_read_b64_tr_b16 a[190:191], v35 offset:28672
    s_waitcnt vmcnt(18)
    s_barrier
    v_mfma_f32_16x16x32_bf16 v[232:235], a[168:171], a[48:51], v[232:235]
    s_waitcnt lgkmcnt(8)
    ds_read_b64_tr_b16 a[160:161], v12 offset:0
    v_mfma_f32_16x16x32_bf16 v[232:235], a[172:175], a[56:59], v[232:235]
    s_add_u32 s49, s44, 3145728
    ds_read_b64_tr_b16 a[162:163], v12 offset:4096
    v_mfma_f32_16x16x32_bf16 v[236:239], a[168:171], a[52:55], v[236:239]
    s_add_u32 m0, s42, 65536
    ds_read_b64_tr_b16 a[164:165], v12 offset:8192
    v_mfma_f32_16x16x32_bf16 v[236:239], a[172:175], a[60:63], v[236:239]
    s_waitcnt lgkmcnt(9)
    buffer_load_dwordx4 v42, s[16:19], s49 offen lds
    v_mfma_f32_16x16x32_bf16 v[240:243], a[176:179], a[48:51], v[240:243]
    s_waitcnt lgkmcnt(7)
    ds_read_b64_tr_b16 a[166:167], v12 offset:12288
    ds_read_b64_tr_b16 a[168:169], v13 offset:0
    v_mfma_f32_16x16x32_bf16 v[240:243], a[180:183], a[56:59], v[240:243]
    ds_read_b64_tr_b16 a[170:171], v13 offset:4096
    v_mfma_f32_16x16x32_bf16 v[244:247], a[176:179], a[52:55], v[244:247]
    ds_read_b64_tr_b16 a[172:173], v13 offset:8192
    v_mfma_f32_16x16x32_bf16 v[244:247], a[180:183], a[60:63], v[244:247]
    s_waitcnt lgkmcnt(9)
    buffer_load_dwordx4 v43, s[16:19], s49 offen offset:1024 lds
    v_mfma_f32_16x16x32_bf16 v[248:251], a[184:187], a[48:51], v[248:251]
    s_waitcnt lgkmcnt(7)
    ds_read_b64_tr_b16 a[174:175], v13 offset:12288
    ds_read_b64_tr_b16 a[176:177], v14 offset:0
    v_mfma_f32_16x16x32_bf16 v[248:251], a[188:191], a[56:59], v[248:251]
    ds_read_b64_tr_b16 a[178:179], v14 offset:4096
    v_mfma_f32_16x16x32_bf16 v[252:255], a[184:187], a[52:55], v[252:255]
    ds_read_b64_tr_b16 a[180:181], v14 offset:8192
    v_mfma_f32_16x16x32_bf16 v[252:255], a[188:191], a[60:63], v[252:255]
    s_waitcnt vmcnt(19)
    s_waitcnt lgkmcnt(9)
    buffer_load_dwordx4 v44, s[16:19], s49 offen offset:2048 lds
    v_mfma_f32_16x16x32_bf16 v[128:131], a[160:163], a[64:67], v[128:131]
    s_waitcnt vmcnt(19)
    s_waitcnt lgkmcnt(7)
    ds_read_b64_tr_b16 a[182:183], v14 offset:12288
    ds_read_b64_tr_b16 a[184:185], v15 offset:0
    v_mfma_f32_16x16x32_bf16 v[128:131], a[164:167], a[72:75], v[128:131]
    s_waitcnt vmcnt(18)
    ds_read_b64_tr_b16 a[186:187], v15 offset:4096
    v_mfma_f32_16x16x32_bf16 v[132:135], a[160:163], a[68:71], v[132:135]
    s_waitcnt vmcnt(17)
    ds_read_b64_tr_b16 a[188:189], v15 offset:8192
    v_mfma_f32_16x16x32_bf16 v[132:135], a[164:167], a[76:79], v[132:135]
    s_waitcnt lgkmcnt(9)
    buffer_load_dwordx4 v45, s[16:19], s49 offen offset:3072 lds
    v_mfma_f32_16x16x32_bf16 v[136:139], a[168:171], a[64:67], v[136:139]
    s_waitcnt lgkmcnt(7)
    ds_read_b64_tr_b16 a[190:191], v15 offset:12288
    ds_read_b64_tr_b16 a[160:161], v16 offset:0
    v_mfma_f32_16x16x32_bf16 v[136:139], a[172:175], a[72:75], v[136:139]
    s_add_u32 s49, s44, 3145984
    ds_read_b64_tr_b16 a[162:163], v16 offset:4096
    v_mfma_f32_16x16x32_bf16 v[140:143], a[168:171], a[68:71], v[140:143]
    s_add_u32 m0, s42, 81920
    ds_read_b64_tr_b16 a[164:165], v16 offset:8192
    v_mfma_f32_16x16x32_bf16 v[140:143], a[172:175], a[76:79], v[140:143]
    s_waitcnt lgkmcnt(9)
    buffer_load_dwordx4 v42, s[16:19], s49 offen lds
    v_mfma_f32_16x16x32_bf16 v[144:147], a[176:179], a[64:67], v[144:147]
    s_waitcnt lgkmcnt(7)
    ds_read_b64_tr_b16 a[166:167], v16 offset:12288
    ds_read_b64_tr_b16 a[168:169], v17 offset:0
    v_mfma_f32_16x16x32_bf16 v[144:147], a[180:183], a[72:75], v[144:147]
    ds_read_b64_tr_b16 a[170:171], v17 offset:4096
    v_mfma_f32_16x16x32_bf16 v[148:151], a[176:179], a[68:71], v[148:151]
    ds_read_b64_tr_b16 a[172:173], v17 offset:8192
    v_mfma_f32_16x16x32_bf16 v[148:151], a[180:183], a[76:79], v[148:151]
    s_waitcnt lgkmcnt(9)
    buffer_load_dwordx4 v43, s[16:19], s49 offen offset:1024 lds
    v_mfma_f32_16x16x32_bf16 v[152:155], a[184:187], a[64:67], v[152:155]
    s_waitcnt lgkmcnt(7)
    ds_read_b64_tr_b16 a[174:175], v17 offset:12288
    ds_read_b64_tr_b16 a[176:177], v18 offset:0
    v_mfma_f32_16x16x32_bf16 v[152:155], a[188:191], a[72:75], v[152:155]
    ds_read_b64_tr_b16 a[178:179], v18 offset:4096
    v_mfma_f32_16x16x32_bf16 v[156:159], a[184:187], a[68:71], v[156:159]
    ds_read_b64_tr_b16 a[180:181], v18 offset:8192
    v_mfma_f32_16x16x32_bf16 v[156:159], a[188:191], a[76:79], v[156:159]
    s_waitcnt lgkmcnt(9)
    buffer_load_dwordx4 v44, s[16:19], s49 offen offset:2048 lds
    v_mfma_f32_16x16x32_bf16 v[160:163], a[160:163], a[64:67], v[160:163]
    s_waitcnt lgkmcnt(7)
    ds_read_b64_tr_b16 a[182:183], v18 offset:12288
    ds_read_b64_tr_b16 a[184:185], v19 offset:0
    v_mfma_f32_16x16x32_bf16 v[160:163], a[164:167], a[72:75], v[160:163]
    ds_read_b64_tr_b16 a[186:187], v19 offset:4096
    v_mfma_f32_16x16x32_bf16 v[164:167], a[160:163], a[68:71], v[164:167]
    ds_read_b64_tr_b16 a[188:189], v19 offset:8192
    v_mfma_f32_16x16x32_bf16 v[164:167], a[164:167], a[76:79], v[164:167]
    s_waitcnt lgkmcnt(9)
    buffer_load_dwordx4 v45, s[16:19], s49 offen offset:3072 lds
    v_mfma_f32_16x16x32_bf16 v[168:171], a[168:171], a[64:67], v[168:171]
    s_waitcnt lgkmcnt(7)
    ds_read_b64_tr_b16 a[190:191], v19 offset:12288
    ds_read_b64_tr_b16 a[160:161], v12 offset:16384
    v_mfma_f32_16x16x32_bf16 v[168:171], a[172:175], a[72:75], v[168:171]
    ds_read_b64_tr_b16 a[162:163], v12 offset:20480
    v_mfma_f32_16x16x32_bf16 v[172:175], a[168:171], a[68:71], v[172:175]
    ds_read_b64_tr_b16 a[164:165], v12 offset:24576
    v_mfma_f32_16x16x32_bf16 v[172:175], a[172:175], a[76:79], v[172:175]
    s_waitcnt lgkmcnt(9)
    buffer_load_dwordx4 a[96:99], v51, s[24:27], s46 offen offset:1536 sc1
    v_mfma_f32_16x16x32_bf16 v[176:179], a[176:179], a[64:67], v[176:179]
    s_waitcnt lgkmcnt(7)
    ds_read_b64_tr_b16 a[166:167], v12 offset:28672
    ds_read_b64_tr_b16 a[168:169], v13 offset:16384
    v_mfma_f32_16x16x32_bf16 v[176:179], a[180:183], a[72:75], v[176:179]
    ds_read_b64_tr_b16 a[170:171], v13 offset:20480
    v_mfma_f32_16x16x32_bf16 v[180:183], a[176:179], a[68:71], v[180:183]
    ds_read_b64_tr_b16 a[172:173], v13 offset:24576
    v_mfma_f32_16x16x32_bf16 v[180:183], a[180:183], a[76:79], v[180:183]
    s_waitcnt lgkmcnt(9)
    buffer_load_dwordx4 a[104:107], v51, s[24:27], s46 offen offset:1664 sc1
    v_mfma_f32_16x16x32_bf16 v[184:187], a[184:187], a[64:67], v[184:187]
    s_waitcnt lgkmcnt(7)
    ds_read_b64_tr_b16 a[174:175], v13 offset:28672
    ds_read_b64_tr_b16 a[176:177], v14 offset:16384
    v_mfma_f32_16x16x32_bf16 v[184:187], a[188:191], a[72:75], v[184:187]
    ds_read_b64_tr_b16 a[178:179], v14 offset:20480
    v_mfma_f32_16x16x32_bf16 v[188:191], a[184:187], a[68:71], v[188:191]
    ds_read_b64_tr_b16 a[180:181], v14 offset:24576
    v_mfma_f32_16x16x32_bf16 v[188:191], a[188:191], a[76:79], v[188:191]
    s_waitcnt lgkmcnt(9)
    buffer_load_dwordx4 a[100:103], v51, s[24:27], s43 offen offset:1536 sc1
    v_mfma_f32_16x16x32_bf16 v[192:195], a[160:163], a[64:67], v[192:195]
    s_waitcnt lgkmcnt(7)
    ds_read_b64_tr_b16 a[182:183], v14 offset:28672
    ds_read_b64_tr_b16 a[184:185], v15 offset:16384
    v_mfma_f32_16x16x32_bf16 v[192:195], a[164:167], a[72:75], v[192:195]
    ds_read_b64_tr_b16 a[186:187], v15 offset:20480
    v_mfma_f32_16x16x32_bf16 v[196:199], a[160:163], a[68:71], v[196:199]
    ds_read_b64_tr_b16 a[188:189], v15 offset:24576
    v_mfma_f32_16x16x32_bf16 v[196:199], a[164:167], a[76:79], v[196:199]
    s_waitcnt lgkmcnt(9)
    buffer_load_dwordx4 a[108:111], v51, s[24:27], s43 offen offset:1664 sc1
    v_mfma_f32_16x16x32_bf16 v[200:203], a[168:171], a[64:67], v[200:203]
    s_waitcnt lgkmcnt(7)
    ds_read_b64_tr_b16 a[190:191], v15 offset:28672
    ds_read_b64_tr_b16 a[160:161], v16 offset:16384
    v_mfma_f32_16x16x32_bf16 v[200:203], a[172:175], a[72:75], v[200:203]
    ds_read_b64_tr_b16 a[162:163], v16 offset:20480
    v_mfma_f32_16x16x32_bf16 v[204:207], a[168:171], a[68:71], v[204:207]
    ds_read_b64_tr_b16 a[164:165], v16 offset:24576
    v_mfma_f32_16x16x32_bf16 v[204:207], a[172:175], a[76:79], v[204:207]
    s_waitcnt lgkmcnt(9)
    ds_read_b64_tr_b16 a[166:167], v16 offset:28672
    v_mfma_f32_16x16x32_bf16 v[208:211], a[176:179], a[64:67], v[208:211]
    s_waitcnt lgkmcnt(8)
    ds_read_b64_tr_b16 a[168:169], v17 offset:16384
    v_mfma_f32_16x16x32_bf16 v[208:211], a[180:183], a[72:75], v[208:211]
    ds_read_b64_tr_b16 a[170:171], v17 offset:20480
    v_mfma_f32_16x16x32_bf16 v[212:215], a[176:179], a[68:71], v[212:215]
    ds_read_b64_tr_b16 a[172:173], v17 offset:24576
    v_mfma_f32_16x16x32_bf16 v[212:215], a[180:183], a[76:79], v[212:215]
    s_waitcnt lgkmcnt(9)
    ds_read_b64_tr_b16 a[174:175], v17 offset:28672
    v_mfma_f32_16x16x32_bf16 v[216:219], a[184:187], a[64:67], v[216:219]
    s_waitcnt lgkmcnt(8)
    ds_read_b64_tr_b16 a[176:177], v18 offset:16384
    v_mfma_f32_16x16x32_bf16 v[216:219], a[188:191], a[72:75], v[216:219]
    ds_read_b64_tr_b16 a[178:179], v18 offset:20480
    v_mfma_f32_16x16x32_bf16 v[220:223], a[184:187], a[68:71], v[220:223]
    ds_read_b64_tr_b16 a[180:181], v18 offset:24576
    v_mfma_f32_16x16x32_bf16 v[220:223], a[188:191], a[76:79], v[220:223]
    s_waitcnt lgkmcnt(9)
    ds_read_b64_tr_b16 a[182:183], v18 offset:28672
    v_mfma_f32_16x16x32_bf16 v[224:227], a[160:163], a[64:67], v[224:227]
    s_waitcnt lgkmcnt(8)
    ds_read_b64_tr_b16 a[184:185], v19 offset:16384
    v_mfma_f32_16x16x32_bf16 v[224:227], a[164:167], a[72:75], v[224:227]
    ds_read_b64_tr_b16 a[186:187], v19 offset:20480
    v_mfma_f32_16x16x32_bf16 v[228:231], a[160:163], a[68:71], v[228:231]
    ds_read_b64_tr_b16 a[188:189], v19 offset:24576
    v_mfma_f32_16x16x32_bf16 v[228:231], a[164:167], a[76:79], v[228:231]
    s_waitcnt lgkmcnt(9)
    ds_read_b64_tr_b16 a[190:191], v19 offset:28672
    s_waitcnt vmcnt(18)
    s_barrier
    v_mfma_f32_16x16x32_bf16 v[232:235], a[168:171], a[64:67], v[232:235]
    s_waitcnt lgkmcnt(8)
    ds_read_b64_tr_b16 a[160:161], v12 offset:32768
    v_mfma_f32_16x16x32_bf16 v[232:235], a[172:175], a[72:75], v[232:235]
    s_add_u32 s49, s44, 3670016
    ds_read_b64_tr_b16 a[162:163], v12 offset:36864
    v_mfma_f32_16x16x32_bf16 v[236:239], a[168:171], a[68:71], v[236:239]
    s_add_u32 m0, s42, 98304
    ds_read_b64_tr_b16 a[164:165], v12 offset:40960
    v_mfma_f32_16x16x32_bf16 v[236:239], a[172:175], a[76:79], v[236:239]
    s_waitcnt lgkmcnt(9)
    buffer_load_dwordx4 v42, s[16:19], s49 offen lds
    v_mfma_f32_16x16x32_bf16 v[240:243], a[176:179], a[64:67], v[240:243]
    s_waitcnt lgkmcnt(7)
    ds_read_b64_tr_b16 a[166:167], v12 offset:45056
    ds_read_b64_tr_b16 a[168:169], v13 offset:32768
    v_mfma_f32_16x16x32_bf16 v[240:243], a[180:183], a[72:75], v[240:243]
    ds_read_b64_tr_b16 a[170:171], v13 offset:36864
    v_mfma_f32_16x16x32_bf16 v[244:247], a[176:179], a[68:71], v[244:247]
    ds_read_b64_tr_b16 a[172:173], v13 offset:40960
    v_mfma_f32_16x16x32_bf16 v[244:247], a[180:183], a[76:79], v[244:247]
    s_waitcnt lgkmcnt(9)
    buffer_load_dwordx4 v43, s[16:19], s49 offen offset:1024 lds
    v_mfma_f32_16x16x32_bf16 v[248:251], a[184:187], a[64:67], v[248:251]
    s_waitcnt lgkmcnt(7)
    ds_read_b64_tr_b16 a[174:175], v13 offset:45056
    ds_read_b64_tr_b16 a[176:177], v14 offset:32768
    v_mfma_f32_16x16x32_bf16 v[248:251], a[188:191], a[72:75], v[248:251]
    ds_read_b64_tr_b16 a[178:179], v14 offset:36864
    v_mfma_f32_16x16x32_bf16 v[252:255], a[184:187], a[68:71], v[252:255]
    ds_read_b64_tr_b16 a[180:181], v14 offset:40960
    v_mfma_f32_16x16x32_bf16 v[252:255], a[188:191], a[76:79], v[252:255]
    s_waitcnt vmcnt(19)
    s_waitcnt lgkmcnt(9)
    buffer_load_dwordx4 v44, s[16:19], s49 offen offset:2048 lds
    v_mfma_f32_16x16x32_bf16 v[128:131], a[160:163], a[80:83], v[128:131]
    s_waitcnt vmcnt(19)
    s_waitcnt lgkmcnt(7)
    ds_read_b64_tr_b16 a[182:183], v14 offset:45056
    ds_read_b64_tr_b16 a[184:185], v15 offset:32768
Ltour1:
    s_cbranch_execz Ltour5
    v_mfma_f32_16x16x32_bf16 v[128:131], a[164:167], a[88:91], v[128:131]
    s_waitcnt vmcnt(18)
    ds_read_b64_tr_b16 a[186:187], v15 offset:36864
    v_accvgpr_write_b32 a0, 0
    v_mfma_f32_16x16x32_bf16 v[132:135], a[160:163], a[84:87], v[132:135]
    s_waitcnt vmcnt(17)
    ds_read_b64_tr_b16 a[188:189], v15 offset:40960
    v_accvgpr_write_b32 a1, 0
    v_mfma_f32_16x16x32_bf16 v[132:135], a[164:167], a[92:95], v[132:135]
    s_waitcnt lgkmcnt(9)
    buffer_load_dwordx4 v45, s[16:19], s49 offen offset:3072 lds
    v_mfma_f32_16x16x32_bf16 v[136:139], a[168:171], a[80:83], v[136:139]
    s_waitcnt lgkmcnt(7)
    ds_read_b64_tr_b16 a[190:191], v15 offset:45056
    ds_read_b64_tr_b16 a[160:161], v16 offset:32768
    v_mfma_f32_16x16x32_bf16 v[136:139], a[172:175], a[88:91], v[136:139]
    s_add_u32 s49, s44, 3670272
    ds_read_b64_tr_b16 a[162:163], v16 offset:36864
    v_accvgpr_write_b32 a2, 0
    v_mfma_f32_16x16x32_bf16 v[140:143], a[168:171], a[84:87], v[140:143]
    s_add_u32 m0, s42, 114688
    ds_read_b64_tr_b16 a[164:165], v16 offset:40960
    v_accvgpr_write_b32 a3, 0
    v_mfma_f32_16x16x32_bf16 v[140:143], a[172:175], a[92:95], v[140:143]
    s_waitcnt lgkmcnt(9)
    buffer_load_dwordx4 v42, s[16:19], s49 offen lds
    v_mfma_f32_16x16x32_bf16 v[144:147], a[176:179], a[80:83], v[144:147]
    s_waitcnt lgkmcnt(7)
    ds_read_b64_tr_b16 a[166:167], v16 offset:45056
    ds_read_b64_tr_b16 a[168:169], v17 offset:32768
    v_mfma_f32_16x16x32_bf16 v[144:147], a[180:183], a[88:91], v[144:147]
    ds_read_b64_tr_b16 a[170:171], v17 offset:36864
    v_accvgpr_write_b32 a4, 0
    v_mfma_f32_16x16x32_bf16 v[148:151], a[176:179], a[84:87], v[148:151]
    ds_read_b64_tr_b16 a[172:173], v17 offset:40960
    v_accvgpr_write_b32 a5, 0
    v_mfma_f32_16x16x32_bf16 v[148:151], a[180:183], a[92:95], v[148:151]
    s_waitcnt lgkmcnt(9)
    buffer_load_dwordx4 v43, s[16:19], s49 offen offset:1024 lds
    v_mfma_f32_16x16x32_bf16 v[152:155], a[184:187], a[80:83], v[152:155]
    s_waitcnt lgkmcnt(7)
    ds_read_b64_tr_b16 a[174:175], v17 offset:45056
    ds_read_b64_tr_b16 a[176:177], v18 offset:32768
    v_mfma_f32_16x16x32_bf16 v[152:155], a[188:191], a[88:91], v[152:155]
    ds_read_b64_tr_b16 a[178:179], v18 offset:36864
    v_accvgpr_write_b32 a6, 0
    v_mfma_f32_16x16x32_bf16 v[156:159], a[184:187], a[84:87], v[156:159]
    ds_read_b64_tr_b16 a[180:181], v18 offset:40960
    v_accvgpr_write_b32 a7, 0
    v_mfma_f32_16x16x32_bf16 v[156:159], a[188:191], a[92:95], v[156:159]
    s_waitcnt lgkmcnt(9)
    buffer_load_dwordx4 v44, s[16:19], s49 offen offset:2048 lds
    v_mfma_f32_16x16x32_bf16 v[160:163], a[160:163], a[80:83], v[160:163]
    s_waitcnt lgkmcnt(7)
    ds_read_b64_tr_b16 a[182:183], v18 offset:45056
    ds_read_b64_tr_b16 a[184:185], v19 offset:32768
    v_mfma_f32_16x16x32_bf16 v[160:163], a[164:167], a[88:91], v[160:163]
    ds_read_b64_tr_b16 a[186:187], v19 offset:36864
    v_accvgpr_write_b32 a8, 0
    v_mfma_f32_16x16x32_bf16 v[164:167], a[160:163], a[84:87], v[164:167]
    ds_read_b64_tr_b16 a[188:189], v19 offset:40960
    v_accvgpr_write_b32 a9, 0
    v_mfma_f32_16x16x32_bf16 v[164:167], a[164:167], a[92:95], v[164:167]
    s_waitcnt lgkmcnt(9)
    buffer_load_dwordx4 v45, s[16:19], s49 offen offset:3072 lds
    v_mfma_f32_16x16x32_bf16 v[168:171], a[168:171], a[80:83], v[168:171]
    s_waitcnt lgkmcnt(7)
    ds_read_b64_tr_b16 a[190:191], v19 offset:45056
    ds_read_b64_tr_b16 a[160:161], v12 offset:49152
    v_mfma_f32_16x16x32_bf16 v[168:171], a[172:175], a[88:91], v[168:171]
    ds_read_b64_tr_b16 a[162:163], v12 offset:53248
    v_accvgpr_write_b32 a10, 0
    v_mfma_f32_16x16x32_bf16 v[172:175], a[168:171], a[84:87], v[172:175]
    ds_read_b64_tr_b16 a[164:165], v12 offset:57344
    v_accvgpr_write_b32 a11, 0
    v_mfma_f32_16x16x32_bf16 v[172:175], a[172:175], a[92:95], v[172:175]
    s_waitcnt lgkmcnt(9)
    buffer_load_dwordx4 a[112:115], v51, s[24:27], s46 offen offset:1792 sc1
    v_mfma_f32_16x16x32_bf16 v[176:179], a[176:179], a[80:83], v[176:179]
    s_waitcnt lgkmcnt(7)
    ds_read_b64_tr_b16 a[166:167], v12 offset:61440
    ds_read_b64_tr_b16 a[168:169], v13 offset:49152
    v_mfma_f32_16x16x32_bf16 v[176:179], a[180:183], a[88:91], v[176:179]
    ds_read_b64_tr_b16 a[170:171], v13 offset:53248
    v_accvgpr_write_b32 a12, 0
    v_mfma_f32_16x16x32_bf16 v[180:183], a[176:179], a[84:87], v[180:183]
    ds_read_b64_tr_b16 a[172:173], v13 offset:57344
    v_accvgpr_write_b32 a13, 0
    v_mfma_f32_16x16x32_bf16 v[180:183], a[180:183], a[92:95], v[180:183]
    s_waitcnt lgkmcnt(9)
    buffer_load_dwordx4 a[120:123], v51, s[24:27], s46 offen offset:1920 sc1
    v_mfma_f32_16x16x32_bf16 v[184:187], a[184:187], a[80:83], v[184:187]
    s_waitcnt lgkmcnt(7)
    ds_read_b64_tr_b16 a[174:175], v13 offset:61440
    ds_read_b64_tr_b16 a[176:177], v14 offset:49152
    v_mfma_f32_16x16x32_bf16 v[184:187], a[188:191], a[88:91], v[184:187]
    ds_read_b64_tr_b16 a[178:179], v14 offset:53248
    v_accvgpr_write_b32 a14, 0
    v_mfma_f32_16x16x32_bf16 v[188:191], a[184:187], a[84:87], v[188:191]
    ds_read_b64_tr_b16 a[180:181], v14 offset:57344
    v_accvgpr_write_b32 a15, 0
    v_mfma_f32_16x16x32_bf16 v[188:191], a[188:191], a[92:95], v[188:191]
    s_waitcnt lgkmcnt(9)
    buffer_load_dwordx4 a[116:119], v51, s[24:27], s43 offen offset:1792 sc1
    v_mfma_f32_16x16x32_bf16 v[192:195], a[160:163], a[80:83], v[192:195]
    s_waitcnt lgkmcnt(7)
    ds_read_b64_tr_b16 a[182:183], v14 offset:61440
    ds_read_b64_tr_b16 a[184:185], v15 offset:49152
    v_mfma_f32_16x16x32_bf16 v[192:195], a[164:167], a[88:91], v[192:195]
    ds_read_b64_tr_b16 a[186:187], v15 offset:53248
    v_accvgpr_write_b32 a16, 0
    v_mfma_f32_16x16x32_bf16 v[196:199], a[160:163], a[84:87], v[196:199]
    ds_read_b64_tr_b16 a[188:189], v15 offset:57344
    v_accvgpr_write_b32 a17, 0
    v_mfma_f32_16x16x32_bf16 v[196:199], a[164:167], a[92:95], v[196:199]
    s_waitcnt lgkmcnt(9)
    buffer_load_dwordx4 a[124:127], v51, s[24:27], s43 offen offset:1920 sc1
    v_mfma_f32_16x16x32_bf16 v[200:203], a[168:171], a[80:83], v[200:203]
    s_waitcnt lgkmcnt(7)
    ds_read_b64_tr_b16 a[190:191], v15 offset:61440
    ds_read_b64_tr_b16 a[160:161], v16 offset:49152
    v_mfma_f32_16x16x32_bf16 v[200:203], a[172:175], a[88:91], v[200:203]
    ds_read_b64_tr_b16 a[162:163], v16 offset:53248
    v_accvgpr_write_b32 a18, 0
    v_mfma_f32_16x16x32_bf16 v[204:207], a[168:171], a[84:87], v[204:207]
    ds_read_b64_tr_b16 a[164:165], v16 offset:57344
    v_accvgpr_write_b32 a19, 0
    v_mfma_f32_16x16x32_bf16 v[204:207], a[172:175], a[92:95], v[204:207]
    s_waitcnt lgkmcnt(9)
    ds_read_b64_tr_b16 a[166:167], v16 offset:61440
    v_accvgpr_write_b32 a20, 0
    v_mfma_f32_16x16x32_bf16 v[208:211], a[176:179], a[80:83], v[208:211]
    s_waitcnt lgkmcnt(8)
    ds_read_b64_tr_b16 a[168:169], v17 offset:49152
    v_accvgpr_write_b32 a21, 0
    v_mfma_f32_16x16x32_bf16 v[208:211], a[180:183], a[88:91], v[208:211]
    ds_read_b64_tr_b16 a[170:171], v17 offset:53248
    v_accvgpr_write_b32 a22, 0
    v_mfma_f32_16x16x32_bf16 v[212:215], a[176:179], a[84:87], v[212:215]
    ds_read_b64_tr_b16 a[172:173], v17 offset:57344
    v_accvgpr_write_b32 a23, 0
    v_mfma_f32_16x16x32_bf16 v[212:215], a[180:183], a[92:95], v[212:215]
    s_waitcnt lgkmcnt(9)
    ds_read_b64_tr_b16 a[174:175], v17 offset:61440
    v_accvgpr_write_b32 a24, 0
    v_mfma_f32_16x16x32_bf16 v[216:219], a[184:187], a[80:83], v[216:219]
    s_waitcnt lgkmcnt(8)
    ds_read_b64_tr_b16 a[176:177], v18 offset:49152
    v_accvgpr_write_b32 a25, 0
    v_mfma_f32_16x16x32_bf16 v[216:219], a[188:191], a[88:91], v[216:219]
    ds_read_b64_tr_b16 a[178:179], v18 offset:53248
    v_accvgpr_write_b32 a26, 0
    v_mfma_f32_16x16x32_bf16 v[220:223], a[184:187], a[84:87], v[220:223]
    ds_read_b64_tr_b16 a[180:181], v18 offset:57344
    v_accvgpr_write_b32 a27, 0
    v_mfma_f32_16x16x32_bf16 v[220:223], a[188:191], a[92:95], v[220:223]
    s_waitcnt lgkmcnt(9)
    ds_read_b64_tr_b16 a[182:183], v18 offset:61440
    v_accvgpr_write_b32 a28, 0
    v_mfma_f32_16x16x32_bf16 v[224:227], a[160:163], a[80:83], v[224:227]
    s_waitcnt lgkmcnt(8)
    ds_read_b64_tr_b16 a[184:185], v19 offset:49152
    v_accvgpr_write_b32 a29, 0
    v_mfma_f32_16x16x32_bf16 v[224:227], a[164:167], a[88:91], v[224:227]
    ds_read_b64_tr_b16 a[186:187], v19 offset:53248
    v_accvgpr_write_b32 a30, 0
    v_mfma_f32_16x16x32_bf16 v[228:231], a[160:163], a[84:87], v[228:231]
    ds_read_b64_tr_b16 a[188:189], v19 offset:57344
    v_accvgpr_write_b32 a31, 0
    v_mfma_f32_16x16x32_bf16 v[228:231], a[164:167], a[92:95], v[228:231]
    s_waitcnt lgkmcnt(9)
    ds_read_b64_tr_b16 a[190:191], v19 offset:61440
    v_accvgpr_write_b32 a32, 0
    s_waitcnt vmcnt(16)
    s_barrier
    v_mfma_f32_16x16x32_bf16 v[232:235], a[168:171], a[80:83], v[232:235]
    s_waitcnt lgkmcnt(8)
    ds_read_b64_tr_b16 a[160:161], v20 offset:0
    v_accvgpr_write_b32 a33, 0
    v_mfma_f32_16x16x32_bf16 v[232:235], a[172:175], a[88:91], v[232:235]
    s_add_u32 s49, s44, 4194304
    ds_read_b64_tr_b16 a[162:163], v20 offset:4096
    v_accvgpr_write_b32 a34, 0
    v_mfma_f32_16x16x32_bf16 v[236:239], a[168:171], a[84:87], v[236:239]
    s_add_u32 m0, s42, 131072
    ds_read_b64_tr_b16 a[164:165], v20 offset:8192
    v_accvgpr_write_b32 a35, 0
    v_mfma_f32_16x16x32_bf16 v[236:239], a[172:175], a[92:95], v[236:239]
    s_waitcnt lgkmcnt(9)
    buffer_load_dwordx4 v42, s[16:19], s49 offen lds
    v_mfma_f32_16x16x32_bf16 v[240:243], a[176:179], a[80:83], v[240:243]
    s_waitcnt lgkmcnt(7)
    ds_read_b64_tr_b16 a[166:167], v20 offset:12288
    ds_read_b64_tr_b16 a[168:169], v21 offset:0
    v_mfma_f32_16x16x32_bf16 v[240:243], a[180:183], a[88:91], v[240:243]
    ds_read_b64_tr_b16 a[170:171], v21 offset:4096
    v_accvgpr_write_b32 a36, 0
    v_mfma_f32_16x16x32_bf16 v[244:247], a[176:179], a[84:87], v[244:247]
    ds_read_b64_tr_b16 a[172:173], v21 offset:8192
    v_accvgpr_write_b32 a37, 0
    v_mfma_f32_16x16x32_bf16 v[244:247], a[180:183], a[92:95], v[244:247]
    s_waitcnt lgkmcnt(9)
    buffer_load_dwordx4 v43, s[16:19], s49 offen offset:1024 lds
    v_mfma_f32_16x16x32_bf16 v[248:251], a[184:187], a[80:83], v[248:251]
    s_waitcnt lgkmcnt(7)
    ds_read_b64_tr_b16 a[174:175], v21 offset:12288
    ds_read_b64_tr_b16 a[176:177], v22 offset:0
    v_mfma_f32_16x16x32_bf16 v[248:251], a[188:191], a[88:91], v[248:251]
    ds_read_b64_tr_b16 a[178:179], v22 offset:4096
    v_accvgpr_write_b32 a38, 0
    v_mfma_f32_16x16x32_bf16 v[252:255], a[184:187], a[84:87], v[252:255]
    ds_read_b64_tr_b16 a[180:181], v22 offset:8192
    v_accvgpr_write_b32 a39, 0
    v_mfma_f32_16x16x32_bf16 v[252:255], a[188:191], a[92:95], v[252:255]
    s_waitcnt vmcnt(17)
    s_waitcnt lgkmcnt(9)
    buffer_load_dwordx4 v44, s[16:19], s49 offen offset:2048 lds
    v_mfma_f32_16x16x32_bf16 v[128:131], a[160:163], a[96:99], v[128:131]
    s_waitcnt vmcnt(17)
    s_waitcnt lgkmcnt(7)
    ds_read_b64_tr_b16 a[182:183], v22 offset:12288
    ds_read_b64_tr_b16 a[184:185], v23 offset:0
    v_mfma_f32_16x16x32_bf16 v[128:131], a[164:167], a[104:107], v[128:131]
    s_waitcnt vmcnt(16)
    ds_read_b64_tr_b16 a[186:187], v23 offset:4096
    v_accvgpr_write_b32 a40, 0
    v_mfma_f32_16x16x32_bf16 v[132:135], a[160:163], a[100:103], v[132:135]
    s_waitcnt vmcnt(15)
    ds_read_b64_tr_b16 a[188:189], v23 offset:8192
    v_accvgpr_write_b32 a41, 0
    v_mfma_f32_16x16x32_bf16 v[132:135], a[164:167], a[108:111], v[132:135]
    s_waitcnt lgkmcnt(9)
    buffer_load_dwordx4 v45, s[16:19], s49 offen offset:3072 lds
    v_mfma_f32_16x16x32_bf16 v[136:139], a[168:171], a[96:99], v[136:139]
    s_waitcnt lgkmcnt(7)
    ds_read_b64_tr_b16 a[190:191], v23 offset:12288
    ds_read_b64_tr_b16 a[160:161], v24 offset:0
    v_mfma_f32_16x16x32_bf16 v[136:139], a[172:175], a[104:107], v[136:139]
    s_add_u32 s49, s44, 4194560
    ds_read_b64_tr_b16 a[162:163], v24 offset:4096
    v_accvgpr_write_b32 a42, 0
    v_mfma_f32_16x16x32_bf16 v[140:143], a[168:171], a[100:103], v[140:143]
    s_add_u32 m0, s42, 147456
    ds_read_b64_tr_b16 a[164:165], v24 offset:8192
    v_accvgpr_write_b32 a43, 0
    v_mfma_f32_16x16x32_bf16 v[140:143], a[172:175], a[108:111], v[140:143]
    s_waitcnt lgkmcnt(9)
    buffer_load_dwordx4 v42, s[16:19], s49 offen lds
    v_mfma_f32_16x16x32_bf16 v[144:147], a[176:179], a[96:99], v[144:147]
    s_waitcnt lgkmcnt(7)
    ds_read_b64_tr_b16 a[166:167], v24 offset:12288
    ds_read_b64_tr_b16 a[168:169], v25 offset:0
    v_mfma_f32_16x16x32_bf16 v[144:147], a[180:183], a[104:107], v[144:147]
    ds_read_b64_tr_b16 a[170:171], v25 offset:4096
    v_accvgpr_write_b32 a44, 0
    v_mfma_f32_16x16x32_bf16 v[148:151], a[176:179], a[100:103], v[148:151]
    ds_read_b64_tr_b16 a[172:173], v25 offset:8192
    v_accvgpr_write_b32 a45, 0
    v_mfma_f32_16x16x32_bf16 v[148:151], a[180:183], a[108:111], v[148:151]
    s_waitcnt lgkmcnt(9)
    buffer_load_dwordx4 v43, s[16:19], s49 offen offset:1024 lds
    v_mfma_f32_16x16x32_bf16 v[152:155], a[184:187], a[96:99], v[152:155]
    s_waitcnt lgkmcnt(7)
    ds_read_b64_tr_b16 a[174:175], v25 offset:12288
    ds_read_b64_tr_b16 a[176:177], v26 offset:0
    v_mfma_f32_16x16x32_bf16 v[152:155], a[188:191], a[104:107], v[152:155]
    ds_read_b64_tr_b16 a[178:179], v26 offset:4096
    v_accvgpr_write_b32 a46, 0
    v_mfma_f32_16x16x32_bf16 v[156:159], a[184:187], a[100:103], v[156:159]
    ds_read_b64_tr_b16 a[180:181], v26 offset:8192
    v_accvgpr_write_b32 a47, 0
    v_mfma_f32_16x16x32_bf16 v[156:159], a[188:191], a[108:111], v[156:159]
    s_waitcnt lgkmcnt(9)
    buffer_load_dwordx4 v44, s[16:19], s49 offen offset:2048 lds
    v_mfma_f32_16x16x32_bf16 v[160:163], a[160:163], a[96:99], v[160:163]
    s_waitcnt lgkmcnt(7)
    ds_read_b64_tr_b16 a[182:183], v26 offset:12288
    ds_read_b64_tr_b16 a[184:185], v27 offset:0
    v_mfma_f32_16x16x32_bf16 v[160:163], a[164:167], a[104:107], v[160:163]
    ds_read_b64_tr_b16 a[186:187], v27 offset:4096
    v_accvgpr_write_b32 a48, 0
    v_mfma_f32_16x16x32_bf16 v[164:167], a[160:163], a[100:103], v[164:167]
    ds_read_b64_tr_b16 a[188:189], v27 offset:8192
    v_accvgpr_write_b32 a49, 0
    v_mfma_f32_16x16x32_bf16 v[164:167], a[164:167], a[108:111], v[164:167]
    s_waitcnt lgkmcnt(9)
    buffer_load_dwordx4 v45, s[16:19], s49 offen offset:3072 lds
    v_mfma_f32_16x16x32_bf16 v[168:171], a[168:171], a[96:99], v[168:171]
    s_waitcnt lgkmcnt(7)
    ds_read_b64_tr_b16 a[190:191], v27 offset:12288
    ds_read_b64_tr_b16 a[160:161], v20 offset:16384
    v_mfma_f32_16x16x32_bf16 v[168:171], a[172:175], a[104:107], v[168:171]
    ds_read_b64_tr_b16 a[162:163], v20 offset:20480
    v_accvgpr_write_b32 a50, 0
    v_mfma_f32_16x16x32_bf16 v[172:175], a[168:171], a[100:103], v[172:175]
    ds_read_b64_tr_b16 a[164:165], v20 offset:24576
    v_accvgpr_write_b32 a51, 0
    v_mfma_f32_16x16x32_bf16 v[172:175], a[172:175], a[108:111], v[172:175]
    s_waitcnt lgkmcnt(9)
    buffer_load_dwordx4 a[128:131], v51, s[24:27], s46 offen offset:2048 sc1
    v_mfma_f32_16x16x32_bf16 v[176:179], a[176:179], a[96:99], v[176:179]
    s_waitcnt lgkmcnt(7)
    ds_read_b64_tr_b16 a[166:167], v20 offset:28672
    ds_read_b64_tr_b16 a[168:169], v21 offset:16384
    v_mfma_f32_16x16x32_bf16 v[176:179], a[180:183], a[104:107], v[176:179]
    ds_read_b64_tr_b16 a[170:171], v21 offset:20480
    v_accvgpr_write_b32 a52, 0
    v_mfma_f32_16x16x32_bf16 v[180:183], a[176:179], a[100:103], v[180:183]
    ds_read_b64_tr_b16 a[172:173], v21 offset:24576
    v_accvgpr_write_b32 a53, 0
    v_mfma_f32_16x16x32_bf16 v[180:183], a[180:183], a[108:111], v[180:183]
    s_waitcnt lgkmcnt(9)
    buffer_load_dwordx4 a[136:139], v51, s[24:27], s46 offen offset:2176 sc1
    v_mfma_f32_16x16x32_bf16 v[184:187], a[184:187], a[96:99], v[184:187]
    s_waitcnt lgkmcnt(7)
    ds_read_b64_tr_b16 a[174:175], v21 offset:28672
    ds_read_b64_tr_b16 a[176:177], v22 offset:16384
    v_mfma_f32_16x16x32_bf16 v[184:187], a[188:191], a[104:107], v[184:187]
    ds_read_b64_tr_b16 a[178:179], v22 offset:20480
    v_accvgpr_write_b32 a54, 0
    v_mfma_f32_16x16x32_bf16 v[188:191], a[184:187], a[100:103], v[188:191]
    ds_read_b64_tr_b16 a[180:181], v22 offset:24576
    v_accvgpr_write_b32 a55, 0
    v_mfma_f32_16x16x32_bf16 v[188:191], a[188:191], a[108:111], v[188:191]
    s_waitcnt lgkmcnt(9)
    buffer_load_dwordx4 a[132:135], v51, s[24:27], s43 offen offset:2048 sc1
    v_mfma_f32_16x16x32_bf16 v[192:195], a[160:163], a[96:99], v[192:195]
    s_waitcnt lgkmcnt(7)
    ds_read_b64_tr_b16 a[182:183], v22 offset:28672
    ds_read_b64_tr_b16 a[184:185], v23 offset:16384
    v_mfma_f32_16x16x32_bf16 v[192:195], a[164:167], a[104:107], v[192:195]
    ds_read_b64_tr_b16 a[186:187], v23 offset:20480
    v_accvgpr_write_b32 a56, 0
    v_mfma_f32_16x16x32_bf16 v[196:199], a[160:163], a[100:103], v[196:199]
    ds_read_b64_tr_b16 a[188:189], v23 offset:24576
    v_accvgpr_write_b32 a57, 0
    v_mfma_f32_16x16x32_bf16 v[196:199], a[164:167], a[108:111], v[196:199]
    s_waitcnt lgkmcnt(9)
    buffer_load_dwordx4 a[140:143], v51, s[24:27], s43 offen offset:2176 sc1
    v_mfma_f32_16x16x32_bf16 v[200:203], a[168:171], a[96:99], v[200:203]
    s_waitcnt lgkmcnt(7)
    ds_read_b64_tr_b16 a[190:191], v23 offset:28672
    ds_read_b64_tr_b16 a[160:161], v24 offset:16384
    v_mfma_f32_16x16x32_bf16 v[200:203], a[172:175], a[104:107], v[200:203]
    ds_read_b64_tr_b16 a[162:163], v24 offset:20480
    v_accvgpr_write_b32 a58, 0
    v_mfma_f32_16x16x32_bf16 v[204:207], a[168:171], a[100:103], v[204:207]
    ds_read_b64_tr_b16 a[164:165], v24 offset:24576
    v_accvgpr_write_b32 a59, 0
    v_mfma_f32_16x16x32_bf16 v[204:207], a[172:175], a[108:111], v[204:207]
    s_waitcnt lgkmcnt(9)
    ds_read_b64_tr_b16 a[166:167], v24 offset:28672
    v_accvgpr_write_b32 a60, 0
    v_mfma_f32_16x16x32_bf16 v[208:211], a[176:179], a[96:99], v[208:211]
    s_waitcnt lgkmcnt(8)
    ds_read_b64_tr_b16 a[168:169], v25 offset:16384
    v_accvgpr_write_b32 a61, 0
    v_mfma_f32_16x16x32_bf16 v[208:211], a[180:183], a[104:107], v[208:211]
    ds_read_b64_tr_b16 a[170:171], v25 offset:20480
    v_accvgpr_write_b32 a62, 0
    v_mfma_f32_16x16x32_bf16 v[212:215], a[176:179], a[100:103], v[212:215]
    ds_read_b64_tr_b16 a[172:173], v25 offset:24576
    v_accvgpr_write_b32 a63, 0
    v_mfma_f32_16x16x32_bf16 v[212:215], a[180:183], a[108:111], v[212:215]
    s_waitcnt lgkmcnt(9)
    ds_read_b64_tr_b16 a[174:175], v25 offset:28672
    v_accvgpr_write_b32 a64, 0
    v_mfma_f32_16x16x32_bf16 v[216:219], a[184:187], a[96:99], v[216:219]
    s_waitcnt lgkmcnt(8)
    ds_read_b64_tr_b16 a[176:177], v26 offset:16384
    v_accvgpr_write_b32 a65, 0
    v_mfma_f32_16x16x32_bf16 v[216:219], a[188:191], a[104:107], v[216:219]
    ds_read_b64_tr_b16 a[178:179], v26 offset:20480
    v_accvgpr_write_b32 a66, 0
    v_mfma_f32_16x16x32_bf16 v[220:223], a[184:187], a[100:103], v[220:223]
    ds_read_b64_tr_b16 a[180:181], v26 offset:24576
    v_accvgpr_write_b32 a67, 0
    v_mfma_f32_16x16x32_bf16 v[220:223], a[188:191], a[108:111], v[220:223]
    s_waitcnt lgkmcnt(9)
    ds_read_b64_tr_b16 a[182:183], v26 offset:28672
    v_accvgpr_write_b32 a68, 0
    v_mfma_f32_16x16x32_bf16 v[224:227], a[160:163], a[96:99], v[224:227]
    s_waitcnt lgkmcnt(8)
    ds_read_b64_tr_b16 a[184:185], v27 offset:16384
    v_accvgpr_write_b32 a69, 0
    v_mfma_f32_16x16x32_bf16 v[224:227], a[164:167], a[104:107], v[224:227]
    ds_read_b64_tr_b16 a[186:187], v27 offset:20480
    v_accvgpr_write_b32 a70, 0
    v_mfma_f32_16x16x32_bf16 v[228:231], a[160:163], a[100:103], v[228:231]
    ds_read_b64_tr_b16 a[188:189], v27 offset:24576
    v_accvgpr_write_b32 a71, 0
    v_mfma_f32_16x16x32_bf16 v[228:231], a[164:167], a[108:111], v[228:231]
    s_waitcnt lgkmcnt(9)
    ds_read_b64_tr_b16 a[190:191], v27 offset:28672
    v_accvgpr_write_b32 a72, 0
    s_waitcnt vmcnt(16)
    s_barrier
    v_mfma_f32_16x16x32_bf16 v[232:235], a[168:171], a[96:99], v[232:235]
    s_waitcnt lgkmcnt(8)
    ds_read_b64_tr_b16 a[160:161], v20 offset:32768
    v_accvgpr_write_b32 a73, 0
    v_mfma_f32_16x16x32_bf16 v[232:235], a[172:175], a[104:107], v[232:235]
    ds_read_b64_tr_b16 a[162:163], v20 offset:36864
    v_accvgpr_write_b32 a74, 0
    v_mfma_f32_16x16x32_bf16 v[236:239], a[168:171], a[100:103], v[236:239]
    s_add_u32 m0, s42, 0
    ds_read_b64_tr_b16 a[164:165], v20 offset:40960
    v_accvgpr_write_b32 a75, 0
    v_mfma_f32_16x16x32_bf16 v[236:239], a[172:175], a[108:111], v[236:239]
    s_waitcnt lgkmcnt(9)
    buffer_load_dwordx4 v36, s[8:11], s40 offen lds
    v_mfma_f32_16x16x32_bf16 v[240:243], a[176:179], a[96:99], v[240:243]
    s_waitcnt lgkmcnt(7)
    ds_read_b64_tr_b16 a[166:167], v20 offset:45056
    ds_read_b64_tr_b16 a[168:169], v21 offset:32768
    v_mfma_f32_16x16x32_bf16 v[240:243], a[180:183], a[104:107], v[240:243]
    ds_read_b64_tr_b16 a[170:171], v21 offset:36864
    v_accvgpr_write_b32 a76, 0
    v_mfma_f32_16x16x32_bf16 v[244:247], a[176:179], a[100:103], v[244:247]
    ds_read_b64_tr_b16 a[172:173], v21 offset:40960
    v_accvgpr_write_b32 a77, 0
    v_mfma_f32_16x16x32_bf16 v[244:247], a[180:183], a[108:111], v[244:247]
    s_waitcnt lgkmcnt(9)
    buffer_load_dwordx4 v37, s[8:11], s40 offen offset:1024 lds
    v_mfma_f32_16x16x32_bf16 v[248:251], a[184:187], a[96:99], v[248:251]
    s_waitcnt lgkmcnt(7)
    ds_read_b64_tr_b16 a[174:175], v21 offset:45056
    ds_read_b64_tr_b16 a[176:177], v22 offset:32768
    v_mfma_f32_16x16x32_bf16 v[248:251], a[188:191], a[104:107], v[248:251]
    ds_read_b64_tr_b16 a[178:179], v22 offset:36864
    v_accvgpr_write_b32 a78, 0
    v_mfma_f32_16x16x32_bf16 v[252:255], a[184:187], a[100:103], v[252:255]
    ds_read_b64_tr_b16 a[180:181], v22 offset:40960
    v_accvgpr_write_b32 a79, 0
    v_mfma_f32_16x16x32_bf16 v[252:255], a[188:191], a[108:111], v[252:255]
    s_waitcnt vmcnt(17)
    s_waitcnt lgkmcnt(9)
    buffer_load_dwordx4 v38, s[8:11], s40 offen offset:2048 lds
    v_mfma_f32_16x16x32_bf16 v[128:131], a[160:163], a[112:115], v[128:131]
    s_waitcnt vmcnt(17)
    s_waitcnt lgkmcnt(7)
    ds_read_b64_tr_b16 a[182:183], v22 offset:45056
    ds_read_b64_tr_b16 a[184:185], v23 offset:32768
    v_mfma_f32_16x16x32_bf16 v[128:131], a[164:167], a[120:123], v[128:131]
    s_waitcnt vmcnt(16)
    ds_read_b64_tr_b16 a[186:187], v23 offset:36864
    v_accvgpr_write_b32 a80, 0
    v_mfma_f32_16x16x32_bf16 v[132:135], a[160:163], a[116:119], v[132:135]
    s_waitcnt vmcnt(15)
    ds_read_b64_tr_b16 a[188:189], v23 offset:40960
    v_accvgpr_write_b32 a81, 0
    v_mfma_f32_16x16x32_bf16 v[132:135], a[164:167], a[124:127], v[132:135]
    s_waitcnt lgkmcnt(9)
    buffer_load_dwordx4 v39, s[8:11], s40 offen offset:3072 lds
    v_mfma_f32_16x16x32_bf16 v[136:139], a[168:171], a[112:115], v[136:139]
    s_waitcnt lgkmcnt(7)
    s_add_u32 s40, s40, 16384
    ds_read_b64_tr_b16 a[190:191], v23 offset:45056
    ds_read_b64_tr_b16 a[160:161], v24 offset:32768
    v_mfma_f32_16x16x32_bf16 v[136:139], a[172:175], a[120:123], v[136:139]
    ds_read_b64_tr_b16 a[162:163], v24 offset:36864
    v_accvgpr_write_b32 a82, 0
    v_mfma_f32_16x16x32_bf16 v[140:143], a[168:171], a[116:119], v[140:143]
    s_add_u32 m0, s42, 16384
    ds_read_b64_tr_b16 a[164:165], v24 offset:40960
    v_accvgpr_write_b32 a83, 0
    v_mfma_f32_16x16x32_bf16 v[140:143], a[172:175], a[124:127], v[140:143]
    s_waitcnt lgkmcnt(9)
    buffer_load_dwordx4 v36, s[8:11], s40 offen lds
    v_mfma_f32_16x16x32_bf16 v[144:147], a[176:179], a[112:115], v[144:147]
    s_waitcnt lgkmcnt(7)
    ds_read_b64_tr_b16 a[166:167], v24 offset:45056
    ds_read_b64_tr_b16 a[168:169], v25 offset:32768
    v_mfma_f32_16x16x32_bf16 v[144:147], a[180:183], a[120:123], v[144:147]
    ds_read_b64_tr_b16 a[170:171], v25 offset:36864
    v_accvgpr_write_b32 a84, 0
    v_mfma_f32_16x16x32_bf16 v[148:151], a[176:179], a[116:119], v[148:151]
    ds_read_b64_tr_b16 a[172:173], v25 offset:40960
    v_accvgpr_write_b32 a85, 0
    v_mfma_f32_16x16x32_bf16 v[148:151], a[180:183], a[124:127], v[148:151]
    s_waitcnt lgkmcnt(9)
    buffer_load_dwordx4 v37, s[8:11], s40 offen offset:1024 lds
    v_mfma_f32_16x16x32_bf16 v[152:155], a[184:187], a[112:115], v[152:155]
    s_waitcnt lgkmcnt(7)
    ds_read_b64_tr_b16 a[174:175], v25 offset:45056
    ds_read_b64_tr_b16 a[176:177], v26 offset:32768
    v_mfma_f32_16x16x32_bf16 v[152:155], a[188:191], a[120:123], v[152:155]
    ds_read_b64_tr_b16 a[178:179], v26 offset:36864
    v_accvgpr_write_b32 a86, 0
    v_mfma_f32_16x16x32_bf16 v[156:159], a[184:187], a[116:119], v[156:159]
    ds_read_b64_tr_b16 a[180:181], v26 offset:40960
    v_accvgpr_write_b32 a87, 0
    v_mfma_f32_16x16x32_bf16 v[156:159], a[188:191], a[124:127], v[156:159]
    s_waitcnt lgkmcnt(9)
    buffer_load_dwordx4 v38, s[8:11], s40 offen offset:2048 lds
    v_mfma_f32_16x16x32_bf16 v[160:163], a[160:163], a[112:115], v[160:163]
    s_waitcnt lgkmcnt(7)
    ds_read_b64_tr_b16 a[182:183], v26 offset:45056
    ds_read_b64_tr_b16 a[184:185], v27 offset:32768
    v_mfma_f32_16x16x32_bf16 v[160:163], a[164:167], a[120:123], v[160:163]
    ds_read_b64_tr_b16 a[186:187], v27 offset:36864
    v_accvgpr_write_b32 a88, 0
    v_mfma_f32_16x16x32_bf16 v[164:167], a[160:163], a[116:119], v[164:167]
    ds_read_b64_tr_b16 a[188:189], v27 offset:40960
    v_accvgpr_write_b32 a89, 0
    v_mfma_f32_16x16x32_bf16 v[164:167], a[164:167], a[124:127], v[164:167]
    s_waitcnt lgkmcnt(9)
    buffer_load_dwordx4 v39, s[8:11], s40 offen offset:3072 lds
    v_mfma_f32_16x16x32_bf16 v[168:171], a[168:171], a[112:115], v[168:171]
    s_waitcnt lgkmcnt(7)
    s_add_u32 s40, s40, 16384
    ds_read_b64_tr_b16 a[190:191], v27 offset:45056
    ds_read_b64_tr_b16 a[160:161], v20 offset:49152
    v_mfma_f32_16x16x32_bf16 v[168:171], a[172:175], a[120:123], v[168:171]
    ds_read_b64_tr_b16 a[162:163], v20 offset:53248
    v_accvgpr_write_b32 a90, 0
    v_mfma_f32_16x16x32_bf16 v[172:175], a[168:171], a[116:119], v[172:175]
    ds_read_b64_tr_b16 a[164:165], v20 offset:57344
    v_accvgpr_write_b32 a91, 0
    v_mfma_f32_16x16x32_bf16 v[172:175], a[172:175], a[124:127], v[172:175]
    s_waitcnt lgkmcnt(9)
    buffer_store_dword v76, v72, s[24:27], s92 offen offset:12 sc1
    v_mfma_f32_16x16x32_bf16 v[176:179], a[176:179], a[112:115], v[176:179]
    s_waitcnt lgkmcnt(7)
    ds_read_b64_tr_b16 a[166:167], v20 offset:61440
    ds_read_b64_tr_b16 a[168:169], v21 offset:49152
    v_mfma_f32_16x16x32_bf16 v[176:179], a[180:183], a[120:123], v[176:179]
    ds_read_b64_tr_b16 a[170:171], v21 offset:53248
    v_accvgpr_write_b32 a92, 0
    v_mfma_f32_16x16x32_bf16 v[180:183], a[176:179], a[116:119], v[180:183]
    ds_read_b64_tr_b16 a[172:173], v21 offset:57344
    v_accvgpr_write_b32 a93, 0
    v_mfma_f32_16x16x32_bf16 v[180:183], a[180:183], a[124:127], v[180:183]
    s_waitcnt lgkmcnt(9)
    buffer_store_dwordx4 v[88:91], v74, s[24:27], 0 offen sc1
    v_mfma_f32_16x16x32_bf16 v[184:187], a[184:187], a[112:115], v[184:187]
    s_waitcnt lgkmcnt(7)
    ds_read_b64_tr_b16 a[174:175], v21 offset:61440
    ds_read_b64_tr_b16 a[176:177], v22 offset:49152
    v_mfma_f32_16x16x32_bf16 v[184:187], a[188:191], a[120:123], v[184:187]
    ds_read_b64_tr_b16 a[178:179], v22 offset:53248
    v_accvgpr_write_b32 a94, 0
    v_mfma_f32_16x16x32_bf16 v[188:191], a[184:187], a[116:119], v[188:191]
    ds_read_b64_tr_b16 a[180:181], v22 offset:57344
    v_accvgpr_write_b32 a95, 0
    v_mfma_f32_16x16x32_bf16 v[188:191], a[188:191], a[124:127], v[188:191]
    s_waitcnt lgkmcnt(9)
    ds_read_b64_tr_b16 a[182:183], v22 offset:61440
    v_accvgpr_write_b32 a96, 0
    v_mfma_f32_16x16x32_bf16 v[192:195], a[160:163], a[112:115], v[192:195]
    s_waitcnt lgkmcnt(8)
    ds_read_b64_tr_b16 a[184:185], v23 offset:49152
    v_accvgpr_write_b32 a97, 0
    v_mfma_f32_16x16x32_bf16 v[192:195], a[164:167], a[120:123], v[192:195]
Ltour2:
    s_cbranch_execz Ltour6
    ds_read_b64_tr_b16 a[186:187], v23 offset:53248
    v_accvgpr_write_b32 a98, 0
    v_mfma_f32_16x16x32_bf16 v[196:199], a[160:163], a[116:119], v[196:199]
    ds_read_b64_tr_b16 a[188:189], v23 offset:57344
    v_accvgpr_write_b32 a99, 0
    v_mfma_f32_16x16x32_bf16 v[196:199], a[164:167], a[124:127], v[196:199]
    s_waitcnt lgkmcnt(9)
    ds_read_b64_tr_b16 a[190:191], v23 offset:61440
    v_accvgpr_write_b32 a100, 0
    v_mfma_f32_16x16x32_bf16 v[200:203], a[168:171], a[112:115], v[200:203]
    s_waitcnt lgkmcnt(8)
    ds_read_b64_tr_b16 a[160:161], v24 offset:49152
    v_accvgpr_write_b32 a101, 0
    v_mfma_f32_16x16x32_bf16 v[200:203], a[172:175], a[120:123], v[200:203]
    ds_read_b64_tr_b16 a[162:163], v24 offset:53248
    v_accvgpr_write_b32 a102, 0
    v_mfma_f32_16x16x32_bf16 v[204:207], a[168:171], a[116:119], v[204:207]
    ds_read_b64_tr_b16 a[164:165], v24 offset:57344
    v_accvgpr_write_b32 a103, 0
    v_mfma_f32_16x16x32_bf16 v[204:207], a[172:175], a[124:127], v[204:207]
    s_waitcnt lgkmcnt(9)
    ds_read_b64_tr_b16 a[166:167], v24 offset:61440
    v_accvgpr_write_b32 a104, 0
    v_mfma_f32_16x16x32_bf16 v[208:211], a[176:179], a[112:115], v[208:211]
    s_waitcnt lgkmcnt(8)
    ds_read_b64_tr_b16 a[168:169], v25 offset:49152
    v_accvgpr_write_b32 a105, 0
    v_mfma_f32_16x16x32_bf16 v[208:211], a[180:183], a[120:123], v[208:211]
    ds_read_b64_tr_b16 a[170:171], v25 offset:53248
    v_accvgpr_write_b32 a106, 0
    v_mfma_f32_16x16x32_bf16 v[212:215], a[176:179], a[116:119], v[212:215]
    ds_read_b64_tr_b16 a[172:173], v25 offset:57344
    v_accvgpr_write_b32 a107, 0
    v_mfma_f32_16x16x32_bf16 v[212:215], a[180:183], a[124:127], v[212:215]
    s_waitcnt lgkmcnt(9)
    ds_read_b64_tr_b16 a[174:175], v25 offset:61440
    v_accvgpr_write_b32 a108, 0
    v_mfma_f32_16x16x32_bf16 v[216:219], a[184:187], a[112:115], v[216:219]
    s_waitcnt lgkmcnt(8)
    ds_read_b64_tr_b16 a[176:177], v26 offset:49152
    v_accvgpr_write_b32 a109, 0
    v_mfma_f32_16x16x32_bf16 v[216:219], a[188:191], a[120:123], v[216:219]
    ds_read_b64_tr_b16 a[178:179], v26 offset:53248
    v_accvgpr_write_b32 a110, 0
    v_mfma_f32_16x16x32_bf16 v[220:223], a[184:187], a[116:119], v[220:223]
    ds_read_b64_tr_b16 a[180:181], v26 offset:57344
    v_accvgpr_write_b32 a111, 0
    v_mfma_f32_16x16x32_bf16 v[220:223], a[188:191], a[124:127], v[220:223]
    s_waitcnt lgkmcnt(9)
    ds_read_b64_tr_b16 a[182:183], v26 offset:61440
    v_accvgpr_write_b32 a192, 0
    v_mfma_f32_16x16x32_bf16 v[224:227], a[160:163], a[112:115], v[224:227]
    s_waitcnt lgkmcnt(8)
    ds_read_b64_tr_b16 a[184:185], v27 offset:49152
    v_accvgpr_write_b32 a193, 0
    v_mfma_f32_16x16x32_bf16 v[224:227], a[164:167], a[120:123], v[224:227]
    ds_read_b64_tr_b16 a[186:187], v27 offset:53248
    v_accvgpr_write_b32 a194, 0
    v_mfma_f32_16x16x32_bf16 v[228:231], a[160:163], a[116:119], v[228:231]
    ds_read_b64_tr_b16 a[188:189], v27 offset:57344
    v_accvgpr_write_b32 a195, 0
    v_mfma_f32_16x16x32_bf16 v[228:231], a[164:167], a[124:127], v[228:231]
    s_waitcnt lgkmcnt(9)
    ds_read_b64_tr_b16 a[190:191], v27 offset:61440
    v_accvgpr_write_b32 a196, 0
    s_waitcnt vmcnt(14)
    s_barrier
    v_mfma_f32_16x16x32_bf16 v[232:235], a[168:171], a[112:115], v[232:235]
    s_waitcnt lgkmcnt(8)
    ds_read_b64_tr_b16 a[160:161], v28 offset:0
    v_accvgpr_write_b32 a197, 0
    v_mfma_f32_16x16x32_bf16 v[232:235], a[172:175], a[120:123], v[232:235]
    ds_read_b64_tr_b16 a[162:163], v28 offset:4096
    v_accvgpr_write_b32 a198, 0
    v_mfma_f32_16x16x32_bf16 v[236:239], a[168:171], a[116:119], v[236:239]
    s_add_u32 m0, s42, 32768
    ds_read_b64_tr_b16 a[164:165], v28 offset:8192
    v_accvgpr_write_b32 a199, 0
    v_mfma_f32_16x16x32_bf16 v[236:239], a[172:175], a[124:127], v[236:239]
    s_waitcnt lgkmcnt(9)
    buffer_load_dwordx4 v36, s[8:11], s40 offen lds
    v_mfma_f32_16x16x32_bf16 v[240:243], a[176:179], a[112:115], v[240:243]
    s_waitcnt lgkmcnt(7)
    ds_read_b64_tr_b16 a[166:167], v28 offset:12288
    ds_read_b64_tr_b16 a[168:169], v29 offset:0
    v_mfma_f32_16x16x32_bf16 v[240:243], a[180:183], a[120:123], v[240:243]
    ds_read_b64_tr_b16 a[170:171], v29 offset:4096
    v_accvgpr_write_b32 a200, 0
    v_mfma_f32_16x16x32_bf16 v[244:247], a[176:179], a[116:119], v[244:247]
    ds_read_b64_tr_b16 a[172:173], v29 offset:8192
    v_accvgpr_write_b32 a201, 0
    v_mfma_f32_16x16x32_bf16 v[244:247], a[180:183], a[124:127], v[244:247]
    s_waitcnt lgkmcnt(9)
    buffer_load_dwordx4 v37, s[8:11], s40 offen offset:1024 lds
    v_mfma_f32_16x16x32_bf16 v[248:251], a[184:187], a[112:115], v[248:251]
    s_waitcnt lgkmcnt(7)
    ds_read_b64_tr_b16 a[174:175], v29 offset:12288
    ds_read_b64_tr_b16 a[176:177], v30 offset:0
    v_mfma_f32_16x16x32_bf16 v[248:251], a[188:191], a[120:123], v[248:251]
    ds_read_b64_tr_b16 a[178:179], v30 offset:4096
    v_accvgpr_write_b32 a202, 0
    v_mfma_f32_16x16x32_bf16 v[252:255], a[184:187], a[116:119], v[252:255]
    ds_read_b64_tr_b16 a[180:181], v30 offset:8192
    v_accvgpr_write_b32 a203, 0
    v_mfma_f32_16x16x32_bf16 v[252:255], a[188:191], a[124:127], v[252:255]
    s_waitcnt vmcnt(15)
    s_waitcnt lgkmcnt(9)
    buffer_load_dwordx4 v38, s[8:11], s40 offen offset:2048 lds
    v_mfma_f32_16x16x32_bf16 v[128:131], a[160:163], a[128:131], v[128:131]
    s_waitcnt vmcnt(15)
    s_waitcnt lgkmcnt(7)
    ds_read_b64_tr_b16 a[182:183], v30 offset:12288
    ds_read_b64_tr_b16 a[184:185], v31 offset:0
    v_mfma_f32_16x16x32_bf16 v[128:131], a[164:167], a[136:139], v[128:131]
    s_waitcnt vmcnt(14)
    ds_read_b64_tr_b16 a[186:187], v31 offset:4096
    v_accvgpr_write_b32 a204, 0
    v_mfma_f32_16x16x32_bf16 v[132:135], a[160:163], a[132:135], v[132:135]
    s_waitcnt vmcnt(13)
    ds_read_b64_tr_b16 a[188:189], v31 offset:8192
    v_accvgpr_write_b32 a205, 0
    v_mfma_f32_16x16x32_bf16 v[132:135], a[164:167], a[140:143], v[132:135]
    s_waitcnt lgkmcnt(9)
    buffer_load_dwordx4 v39, s[8:11], s40 offen offset:3072 lds
    v_mfma_f32_16x16x32_bf16 v[136:139], a[168:171], a[128:131], v[136:139]
    s_waitcnt lgkmcnt(7)
    s_add_u32 s40, s40, 16384
    ds_read_b64_tr_b16 a[190:191], v31 offset:12288
    ds_read_b64_tr_b16 a[160:161], v32 offset:0
    v_mfma_f32_16x16x32_bf16 v[136:139], a[172:175], a[136:139], v[136:139]
    ds_read_b64_tr_b16 a[162:163], v32 offset:4096
    v_accvgpr_write_b32 a206, 0
    v_mfma_f32_16x16x32_bf16 v[140:143], a[168:171], a[132:135], v[140:143]
    s_add_u32 m0, s42, 65536
    ds_read_b64_tr_b16 a[164:165], v32 offset:8192
    v_accvgpr_write_b32 a207, 0
    v_mfma_f32_16x16x32_bf16 v[140:143], a[172:175], a[140:143], v[140:143]
    s_waitcnt lgkmcnt(9)
    buffer_load_dwordx4 v40, s[12:15], s41 offen lds
    v_mfma_f32_16x16x32_bf16 v[144:147], a[176:179], a[128:131], v[144:147]
    s_waitcnt lgkmcnt(7)
    ds_read_b64_tr_b16 a[166:167], v32 offset:12288
    ds_read_b64_tr_b16 a[168:169], v33 offset:0
    v_mfma_f32_16x16x32_bf16 v[144:147], a[180:183], a[136:139], v[144:147]
    ds_read_b64_tr_b16 a[170:171], v33 offset:4096
    v_accvgpr_write_b32 a112, 0
    v_mfma_f32_16x16x32_bf16 v[148:151], a[176:179], a[132:135], v[148:151]
    ds_read_b64_tr_b16 a[172:173], v33 offset:8192
    v_accvgpr_write_b32 a113, 0
    v_mfma_f32_16x16x32_bf16 v[148:151], a[180:183], a[140:143], v[148:151]
    s_waitcnt lgkmcnt(9)
    buffer_load_dwordx4 v41, s[12:15], s41 offen offset:1024 lds
    v_mfma_f32_16x16x32_bf16 v[152:155], a[184:187], a[128:131], v[152:155]
    s_waitcnt lgkmcnt(7)
    ds_read_b64_tr_b16 a[174:175], v33 offset:12288
    ds_read_b64_tr_b16 a[176:177], v34 offset:0
    v_mfma_f32_16x16x32_bf16 v[152:155], a[188:191], a[136:139], v[152:155]
    ds_read_b64_tr_b16 a[178:179], v34 offset:4096
    v_accvgpr_write_b32 a114, 0
    v_mfma_f32_16x16x32_bf16 v[156:159], a[184:187], a[132:135], v[156:159]
    ds_read_b64_tr_b16 a[180:181], v34 offset:8192
    v_accvgpr_write_b32 a115, 0
    v_mfma_f32_16x16x32_bf16 v[156:159], a[188:191], a[140:143], v[156:159]
    s_waitcnt lgkmcnt(9)
    buffer_load_dwordx4 v40, s[12:15], s41 offen offset:2048 lds
    v_mfma_f32_16x16x32_bf16 v[160:163], a[160:163], a[128:131], v[160:163]
    s_waitcnt lgkmcnt(7)
    ds_read_b64_tr_b16 a[182:183], v34 offset:12288
    ds_read_b64_tr_b16 a[184:185], v35 offset:0
    v_mfma_f32_16x16x32_bf16 v[160:163], a[164:167], a[136:139], v[160:163]
    ds_read_b64_tr_b16 a[186:187], v35 offset:4096
    v_accvgpr_write_b32 a116, 0
    v_mfma_f32_16x16x32_bf16 v[164:167], a[160:163], a[132:135], v[164:167]
    ds_read_b64_tr_b16 a[188:189], v35 offset:8192
    v_accvgpr_write_b32 a117, 0
    v_mfma_f32_16x16x32_bf16 v[164:167], a[164:167], a[140:143], v[164:167]
    s_waitcnt lgkmcnt(9)
    buffer_load_dwordx4 v41, s[12:15], s41 offen offset:3072 lds
    v_mfma_f32_16x16x32_bf16 v[168:171], a[168:171], a[128:131], v[168:171]
    s_waitcnt lgkmcnt(7)
    s_add_u32 s41, s41, 16384
    ds_read_b64_tr_b16 a[190:191], v35 offset:12288
    ds_read_b64_tr_b16 a[160:161], v28 offset:16384
    v_mfma_f32_16x16x32_bf16 v[168:171], a[172:175], a[136:139], v[168:171]
    ds_read_b64_tr_b16 a[162:163], v28 offset:20480
    v_accvgpr_write_b32 a118, 0
    v_mfma_f32_16x16x32_bf16 v[172:175], a[168:171], a[132:135], v[172:175]
    s_add_u32 m0, s42, 81920
    ds_read_b64_tr_b16 a[164:165], v28 offset:24576
    v_accvgpr_write_b32 a119, 0
    v_mfma_f32_16x16x32_bf16 v[172:175], a[172:175], a[140:143], v[172:175]
    s_waitcnt lgkmcnt(9)
    buffer_load_dwordx4 v40, s[12:15], s41 offen lds
    v_mfma_f32_16x16x32_bf16 v[176:179], a[176:179], a[128:131], v[176:179]
    s_waitcnt lgkmcnt(7)
    ds_read_b64_tr_b16 a[166:167], v28 offset:28672
    ds_read_b64_tr_b16 a[168:169], v29 offset:16384
    v_mfma_f32_16x16x32_bf16 v[176:179], a[180:183], a[136:139], v[176:179]
    ds_read_b64_tr_b16 a[170:171], v29 offset:20480
    v_accvgpr_write_b32 a120, 0
    v_mfma_f32_16x16x32_bf16 v[180:183], a[176:179], a[132:135], v[180:183]
    ds_read_b64_tr_b16 a[172:173], v29 offset:24576
    v_accvgpr_write_b32 a121, 0
    v_mfma_f32_16x16x32_bf16 v[180:183], a[180:183], a[140:143], v[180:183]
    s_waitcnt lgkmcnt(9)
    buffer_load_dwordx4 v41, s[12:15], s41 offen offset:1024 lds
    v_mfma_f32_16x16x32_bf16 v[184:187], a[184:187], a[128:131], v[184:187]
    s_waitcnt lgkmcnt(7)
    ds_read_b64_tr_b16 a[174:175], v29 offset:28672
    ds_read_b64_tr_b16 a[176:177], v30 offset:16384
    v_mfma_f32_16x16x32_bf16 v[184:187], a[188:191], a[136:139], v[184:187]
    ds_read_b64_tr_b16 a[178:179], v30 offset:20480
    v_accvgpr_write_b32 a122, 0
    v_mfma_f32_16x16x32_bf16 v[188:191], a[184:187], a[132:135], v[188:191]
    ds_read_b64_tr_b16 a[180:181], v30 offset:24576
    v_accvgpr_write_b32 a123, 0
    v_mfma_f32_16x16x32_bf16 v[188:191], a[188:191], a[140:143], v[188:191]
    s_waitcnt lgkmcnt(9)
    buffer_load_dwordx4 v40, s[12:15], s41 offen offset:2048 lds
    v_mfma_f32_16x16x32_bf16 v[192:195], a[160:163], a[128:131], v[192:195]
    s_waitcnt lgkmcnt(7)
    ds_read_b64_tr_b16 a[182:183], v30 offset:28672
    ds_read_b64_tr_b16 a[184:185], v31 offset:16384
    v_mfma_f32_16x16x32_bf16 v[192:195], a[164:167], a[136:139], v[192:195]
    ds_read_b64_tr_b16 a[186:187], v31 offset:20480
    v_accvgpr_write_b32 a124, 0
    v_mfma_f32_16x16x32_bf16 v[196:199], a[160:163], a[132:135], v[196:199]
    ds_read_b64_tr_b16 a[188:189], v31 offset:24576
    v_accvgpr_write_b32 a125, 0
    v_mfma_f32_16x16x32_bf16 v[196:199], a[164:167], a[140:143], v[196:199]
    s_waitcnt lgkmcnt(9)
    buffer_load_dwordx4 v41, s[12:15], s41 offen offset:3072 lds
    v_mfma_f32_16x16x32_bf16 v[200:203], a[168:171], a[128:131], v[200:203]
    s_waitcnt lgkmcnt(7)
    s_add_u32 s41, s41, 16384
    ds_read_b64_tr_b16 a[190:191], v31 offset:28672
    ds_read_b64_tr_b16 a[160:161], v32 offset:16384
    v_mfma_f32_16x16x32_bf16 v[200:203], a[172:175], a[136:139], v[200:203]
    ds_read_b64_tr_b16 a[162:163], v32 offset:20480
    v_accvgpr_write_b32 a126, 0
    v_mfma_f32_16x16x32_bf16 v[204:207], a[168:171], a[132:135], v[204:207]
    ds_read_b64_tr_b16 a[164:165], v32 offset:24576
    v_accvgpr_write_b32 a127, 0
    v_mfma_f32_16x16x32_bf16 v[204:207], a[172:175], a[140:143], v[204:207]
    s_waitcnt lgkmcnt(9)
    ds_read_b64_tr_b16 a[166:167], v32 offset:28672
    v_mfma_f32_16x16x32_bf16 v[208:211], a[176:179], a[128:131], v[208:211]
    s_waitcnt lgkmcnt(8)
    ds_read_b64_tr_b16 a[168:169], v33 offset:16384
    v_mfma_f32_16x16x32_bf16 v[208:211], a[180:183], a[136:139], v[208:211]
    ds_read_b64_tr_b16 a[170:171], v33 offset:20480
    v_mfma_f32_16x16x32_bf16 v[212:215], a[176:179], a[132:135], v[212:215]
    ds_read_b64_tr_b16 a[172:173], v33 offset:24576
    v_mfma_f32_16x16x32_bf16 v[212:215], a[180:183], a[140:143], v[212:215]
    s_waitcnt lgkmcnt(9)
    ds_read_b64_tr_b16 a[174:175], v33 offset:28672
    v_mfma_f32_16x16x32_bf16 v[216:219], a[184:187], a[128:131], v[216:219]
    s_waitcnt lgkmcnt(8)
    ds_read_b64_tr_b16 a[176:177], v34 offset:16384
    v_mfma_f32_16x16x32_bf16 v[216:219], a[188:191], a[136:139], v[216:219]
    ds_read_b64_tr_b16 a[178:179], v34 offset:20480
    v_mfma_f32_16x16x32_bf16 v[220:223], a[184:187], a[132:135], v[220:223]
    ds_read_b64_tr_b16 a[180:181], v34 offset:24576
    v_mfma_f32_16x16x32_bf16 v[220:223], a[188:191], a[140:143], v[220:223]
    s_waitcnt lgkmcnt(9)
    ds_read_b64_tr_b16 a[182:183], v34 offset:28672
    v_mfma_f32_16x16x32_bf16 v[224:227], a[160:163], a[128:131], v[224:227]
    s_waitcnt lgkmcnt(8)
    ds_read_b64_tr_b16 a[184:185], v35 offset:16384
    v_mfma_f32_16x16x32_bf16 v[224:227], a[164:167], a[136:139], v[224:227]
    ds_read_b64_tr_b16 a[186:187], v35 offset:20480
    v_mfma_f32_16x16x32_bf16 v[228:231], a[160:163], a[132:135], v[228:231]
    ds_read_b64_tr_b16 a[188:189], v35 offset:24576
    v_mfma_f32_16x16x32_bf16 v[228:231], a[164:167], a[140:143], v[228:231]
    s_waitcnt lgkmcnt(9)
    ds_read_b64_tr_b16 a[190:191], v35 offset:28672
    v_mfma_f32_16x16x32_bf16 v[232:235], a[168:171], a[128:131], v[232:235]
    s_waitcnt lgkmcnt(8)
    v_mfma_f32_16x16x32_bf16 v[232:235], a[172:175], a[136:139], v[232:235]
    v_mfma_f32_16x16x32_bf16 v[236:239], a[168:171], a[132:135], v[236:239]
    v_mfma_f32_16x16x32_bf16 v[236:239], a[172:175], a[140:143], v[236:239]
    s_waitcnt lgkmcnt(6)
    s_waitcnt vmcnt(18)
    s_barrier
    v_mfma_f32_16x16x32_bf16 v[240:243], a[176:179], a[128:131], v[240:243]
    s_waitcnt lgkmcnt(4)
    ds_read_b128 a[208:211], v8 offset:0
    v_mfma_f32_16x16x32_bf16 v[240:243], a[180:183], a[136:139], v[240:243]
    ds_read_b128 a[212:215], v9 offset:0
    v_mfma_f32_16x16x32_bf16 v[244:247], a[176:179], a[132:135], v[244:247]
    ds_read_b128 a[216:219], v10 offset:0
    v_mfma_f32_16x16x32_bf16 v[244:247], a[180:183], a[140:143], v[244:247]
    s_waitcnt lgkmcnt(5)
    ds_read_b128 a[220:223], v11 offset:0
    v_mfma_f32_16x16x32_bf16 v[248:251], a[184:187], a[128:131], v[248:251]
    s_waitcnt lgkmcnt(4)
    ds_read_b128 a[224:227], v8 offset:4096
    v_mfma_f32_16x16x32_bf16 v[248:251], a[188:191], a[136:139], v[248:251]
    v_mfma_f32_16x16x32_bf16 v[252:255], a[184:187], a[132:135], v[252:255]
    s_load_dwordx2 s[16:17], s[0:1], 88
    v_mfma_f32_16x16x32_bf16 v[252:255], a[188:191], a[140:143], v[252:255]
    s_mov_b32 s36, 1040356334
    s_mov_b32 s37, 1040356334
    v_pk_mul_f32 v[128:129], v[128:129], s[36:37]
    v_pk_mul_f32 v[130:131], v[130:131], s[36:37]
    v_pk_mul_f32 v[136:137], v[136:137], s[36:37]
    v_pk_mul_f32 v[138:139], v[138:139], s[36:37]
    v_cvt_pk_bf16_f32 v64, v128, v129
    v_cvt_pk_bf16_f32 v65, v130, v131
    v_cvt_pk_bf16_f32 v66, v136, v137
    v_cvt_pk_bf16_f32 v67, v138, v139
    v_pk_mul_f32 v[132:133], v[132:133], s[36:37]
    v_pk_mul_f32 v[134:135], v[134:135], s[36:37]
    v_pk_mul_f32 v[140:141], v[140:141], s[36:37]
    v_pk_mul_f32 v[142:143], v[142:143], s[36:37]
    v_cvt_pk_bf16_f32 v80, v132, v133
    v_cvt_pk_bf16_f32 v81, v134, v135
    v_cvt_pk_bf16_f32 v82, v140, v141
    v_cvt_pk_bf16_f32 v83, v142, v143
    v_permlane32_swap_b32 v64, v66
    v_permlane32_swap_b32 v65, v67
    v_permlane32_swap_b32 v80, v82
    v_permlane32_swap_b32 v81, v83
    v_permlane16_swap_b32 v64, v66
    v_permlane16_swap_b32 v65, v67
    v_permlane16_swap_b32 v80, v82
    v_permlane16_swap_b32 v81, v83
    v_pk_mul_f32 v[144:145], v[144:145], s[36:37]
    v_pk_mul_f32 v[146:147], v[146:147], s[36:37]
    v_pk_mul_f32 v[152:153], v[152:153], s[36:37]
    v_pk_mul_f32 v[154:155], v[154:155], s[36:37]
    v_cvt_pk_bf16_f32 v68, v144, v145
    v_cvt_pk_bf16_f32 v69, v146, v147
    v_cvt_pk_bf16_f32 v70, v152, v153
    v_cvt_pk_bf16_f32 v71, v154, v155
    v_pk_mul_f32 v[148:149], v[148:149], s[36:37]
    v_pk_mul_f32 v[150:151], v[150:151], s[36:37]
    v_pk_mul_f32 v[156:157], v[156:157], s[36:37]
    v_pk_mul_f32 v[158:159], v[158:159], s[36:37]
    v_cvt_pk_bf16_f32 v84, v148, v149
    v_cvt_pk_bf16_f32 v85, v150, v151
    v_cvt_pk_bf16_f32 v86, v156, v157
    v_cvt_pk_bf16_f32 v87, v158, v159
    v_permlane32_swap_b32 v68, v70
    v_permlane32_swap_b32 v69, v71
    v_permlane32_swap_b32 v84, v86
    v_permlane32_swap_b32 v85, v87
    v_permlane16_swap_b32 v68, v70
    v_permlane16_swap_b32 v69, v71
    v_permlane16_swap_b32 v84, v86
    v_permlane16_swap_b32 v85, v87
    v_pk_mul_f32 v[160:161], v[160:161], s[36:37]
    v_pk_mul_f32 v[162:163], v[162:163], s[36:37]
    v_pk_mul_f32 v[168:169], v[168:169], s[36:37]
    v_pk_mul_f32 v[170:171], v[170:171], s[36:37]
    v_cvt_pk_bf16_f32 v72, v160, v161
    v_cvt_pk_bf16_f32 v73, v162, v163
    v_cvt_pk_bf16_f32 v74, v168, v169
    v_cvt_pk_bf16_f32 v75, v170, v171
    v_pk_mul_f32 v[164:165], v[164:165], s[36:37]
    v_pk_mul_f32 v[166:167], v[166:167], s[36:37]
    v_pk_mul_f32 v[172:173], v[172:173], s[36:37]
    v_pk_mul_f32 v[174:175], v[174:175], s[36:37]
    v_cvt_pk_bf16_f32 v88, v164, v165
    v_cvt_pk_bf16_f32 v89, v166, v167
    v_cvt_pk_bf16_f32 v90, v172, v173
    v_cvt_pk_bf16_f32 v91, v174, v175
    v_permlane32_swap_b32 v72, v74
    v_permlane32_swap_b32 v73, v75
    v_permlane32_swap_b32 v88, v90
    v_permlane32_swap_b32 v89, v91
    v_permlane16_swap_b32 v72, v74
    v_permlane16_swap_b32 v73, v75
    v_permlane16_swap_b32 v88, v90
    v_permlane16_swap_b32 v89, v91
    v_pk_mul_f32 v[176:177], v[176:177], s[36:37]
    v_pk_mul_f32 v[178:179], v[178:179], s[36:37]
    v_pk_mul_f32 v[184:185], v[184:185], s[36:37]
    v_pk_mul_f32 v[186:187], v[186:187], s[36:37]
    v_cvt_pk_bf16_f32 v76, v176, v177
    v_cvt_pk_bf16_f32 v77, v178, v179
    v_cvt_pk_bf16_f32 v78, v184, v185
    v_cvt_pk_bf16_f32 v79, v186, v187
    v_pk_mul_f32 v[180:181], v[180:181], s[36:37]
    v_pk_mul_f32 v[182:183], v[182:183], s[36:37]
    v_pk_mul_f32 v[188:189], v[188:189], s[36:37]
    v_pk_mul_f32 v[190:191], v[190:191], s[36:37]
    v_cvt_pk_bf16_f32 v92, v180, v181
    v_cvt_pk_bf16_f32 v93, v182, v183
    v_cvt_pk_bf16_f32 v94, v188, v189
    v_cvt_pk_bf16_f32 v95, v190, v191
    v_permlane32_swap_b32 v76, v78
    v_permlane32_swap_b32 v77, v79
    v_permlane32_swap_b32 v92, v94
    v_permlane32_swap_b32 v93, v95
    v_permlane16_swap_b32 v76, v78
    v_permlane16_swap_b32 v77, v79
    v_permlane16_swap_b32 v92, v94
    v_permlane16_swap_b32 v93, v95
    v_pk_mul_f32 v[192:193], v[192:193], s[36:37]
    v_pk_mul_f32 v[194:195], v[194:195], s[36:37]
    v_pk_mul_f32 v[200:201], v[200:201], s[36:37]
    v_pk_mul_f32 v[202:203], v[202:203], s[36:37]
    v_cvt_pk_bf16_f32 v96, v192, v193
    v_cvt_pk_bf16_f32 v97, v194, v195
    v_cvt_pk_bf16_f32 v98, v200, v201
    v_cvt_pk_bf16_f32 v99, v202, v203
    v_pk_mul_f32 v[196:197], v[196:197], s[36:37]
    v_pk_mul_f32 v[198:199], v[198:199], s[36:37]
    v_pk_mul_f32 v[204:205], v[204:205], s[36:37]
    v_pk_mul_f32 v[206:207], v[206:207], s[36:37]
    v_cvt_pk_bf16_f32 v112, v196, v197
    v_cvt_pk_bf16_f32 v113, v198, v199
    v_cvt_pk_bf16_f32 v114, v204, v205
    v_cvt_pk_bf16_f32 v115, v206, v207
    v_permlane32_swap_b32 v96, v98
    v_permlane32_swap_b32 v97, v99
    v_permlane32_swap_b32 v112, v114
    v_permlane32_swap_b32 v113, v115
    v_permlane16_swap_b32 v96, v98
    v_permlane16_swap_b32 v97, v99
    v_permlane16_swap_b32 v112, v114
    v_permlane16_swap_b32 v113, v115
    v_pk_mul_f32 v[208:209], v[208:209], s[36:37]
    v_pk_mul_f32 v[210:211], v[210:211], s[36:37]
    v_pk_mul_f32 v[216:217], v[216:217], s[36:37]
    v_pk_mul_f32 v[218:219], v[218:219], s[36:37]
    v_cvt_pk_bf16_f32 v100, v208, v209
    v_cvt_pk_bf16_f32 v101, v210, v211
    v_cvt_pk_bf16_f32 v102, v216, v217
    v_cvt_pk_bf16_f32 v103, v218, v219
    v_pk_mul_f32 v[212:213], v[212:213], s[36:37]
    v_pk_mul_f32 v[214:215], v[214:215], s[36:37]
    v_pk_mul_f32 v[220:221], v[220:221], s[36:37]
    v_pk_mul_f32 v[222:223], v[222:223], s[36:37]
    v_cvt_pk_bf16_f32 v116, v212, v213
    v_cvt_pk_bf16_f32 v117, v214, v215
    v_cvt_pk_bf16_f32 v118, v220, v221
    v_cvt_pk_bf16_f32 v119, v222, v223
    v_permlane32_swap_b32 v100, v102
    v_permlane32_swap_b32 v101, v103
    v_permlane32_swap_b32 v116, v118
    v_permlane32_swap_b32 v117, v119
    v_permlane16_swap_b32 v100, v102
    v_permlane16_swap_b32 v101, v103
    v_permlane16_swap_b32 v116, v118
    v_permlane16_swap_b32 v117, v119
    v_pk_mul_f32 v[224:225], v[224:225], s[36:37]
    v_pk_mul_f32 v[226:227], v[226:227], s[36:37]
    v_pk_mul_f32 v[232:233], v[232:233], s[36:37]
    v_pk_mul_f32 v[234:235], v[234:235], s[36:37]
    v_cvt_pk_bf16_f32 v104, v224, v225
    v_cvt_pk_bf16_f32 v105, v226, v227
    v_cvt_pk_bf16_f32 v106, v232, v233
    v_cvt_pk_bf16_f32 v107, v234, v235
    v_pk_mul_f32 v[228:229], v[228:229], s[36:37]
    v_pk_mul_f32 v[230:231], v[230:231], s[36:37]
    v_pk_mul_f32 v[236:237], v[236:237], s[36:37]
    v_pk_mul_f32 v[238:239], v[238:239], s[36:37]
    v_cvt_pk_bf16_f32 v120, v228, v229
    v_cvt_pk_bf16_f32 v121, v230, v231
    v_cvt_pk_bf16_f32 v122, v236, v237
    v_cvt_pk_bf16_f32 v123, v238, v239
    v_permlane32_swap_b32 v104, v106
    v_permlane32_swap_b32 v105, v107
    v_permlane32_swap_b32 v120, v122
    v_permlane32_swap_b32 v121, v123
    v_permlane16_swap_b32 v104, v106
    v_permlane16_swap_b32 v105, v107
    v_permlane16_swap_b32 v120, v122
    v_permlane16_swap_b32 v121, v123
    v_pk_mul_f32 v[240:241], v[240:241], s[36:37]
    v_pk_mul_f32 v[242:243], v[242:243], s[36:37]
    v_pk_mul_f32 v[248:249], v[248:249], s[36:37]
    v_pk_mul_f32 v[250:251], v[250:251], s[36:37]
    v_cvt_pk_bf16_f32 v108, v240, v241
    v_cvt_pk_bf16_f32 v109, v242, v243
    v_cvt_pk_bf16_f32 v110, v248, v249
    v_cvt_pk_bf16_f32 v111, v250, v251
    v_pk_mul_f32 v[244:245], v[244:245], s[36:37]
    v_pk_mul_f32 v[246:247], v[246:247], s[36:37]
    v_pk_mul_f32 v[252:253], v[252:253], s[36:37]
    v_pk_mul_f32 v[254:255], v[254:255], s[36:37]
    v_cvt_pk_bf16_f32 v124, v244, v245
    v_cvt_pk_bf16_f32 v125, v246, v247
    v_cvt_pk_bf16_f32 v126, v252, v253
    v_cvt_pk_bf16_f32 v127, v254, v255
    v_permlane32_swap_b32 v108, v110
    v_permlane32_swap_b32 v109, v111
    v_permlane32_swap_b32 v124, v126
    v_permlane32_swap_b32 v125, v127
    v_permlane16_swap_b32 v108, v110
    v_permlane16_swap_b32 v109, v111
    v_permlane16_swap_b32 v124, v126
    v_permlane16_swap_b32 v125, v127
    s_waitcnt lgkmcnt(0)
    v_mfma_f32_16x16x32_bf16 v[216:219], a[208:211], v[64:67], 0
    v_mfma_f32_16x16x32_bf16 v[216:219], a[212:215], v[68:71], v[216:219]
    v_mfma_f32_16x16x32_bf16 v[216:219], a[216:219], v[72:75], v[216:219]
    v_mfma_f32_16x16x32_bf16 v[216:219], a[220:223], v[76:79], v[216:219]
    v_mfma_f32_16x16x32_bf16 v[220:223], a[208:211], v[80:83], 0
    v_mfma_f32_16x16x32_bf16 v[220:223], a[212:215], v[84:87], v[220:223]
    v_mfma_f32_16x16x32_bf16 v[220:223], a[216:219], v[88:91], v[220:223]
    v_mfma_f32_16x16x32_bf16 v[220:223], a[220:223], v[92:95], v[220:223]
    v_mfma_f32_16x16x32_bf16 v[224:227], a[208:211], v[96:99], 0
    v_mfma_f32_16x16x32_bf16 v[224:227], a[212:215], v[100:103], v[224:227]
    v_mfma_f32_16x16x32_bf16 v[224:227], a[216:219], v[104:107], v[224:227]
    v_mfma_f32_16x16x32_bf16 v[224:227], a[220:223], v[108:111], v[224:227]
    v_mfma_f32_16x16x32_bf16 v[228:231], a[208:211], v[112:115], 0
    v_mfma_f32_16x16x32_bf16 v[228:231], a[212:215], v[116:119], v[228:231]
    v_mfma_f32_16x16x32_bf16 v[228:231], a[216:219], v[120:123], v[228:231]
    v_mfma_f32_16x16x32_bf16 v[228:231], a[220:223], v[124:127], v[228:231]
    v_max3_f32 v232, v216, v217, v218
    v_max_f32 v232, v232, v219
    v_max3_f32 v233, v220, v221, v222
    v_max_f32 v233, v233, v223
    v_max3_f32 v234, v224, v225, v226
    v_max_f32 v234, v234, v227
    s_nop 1
    v_max3_f32 v235, v228, v229, v230
    v_max_f32 v235, v235, v231
    v_mov_b32 v236, v232
    v_mov_b32 v237, v233
    v_mov_b32 v238, v234
    v_mov_b32 v239, v235
    v_permlane16_swap_b32 v232, v236
    v_permlane16_swap_b32 v233, v237
    v_permlane16_swap_b32 v234, v238
    v_permlane16_swap_b32 v235, v239
    v_max_f32 v232, v232, v236
    v_max_f32 v233, v233, v237
    v_max_f32 v234, v234, v238
    v_max_f32 v235, v235, v239
    v_mov_b32 v236, v232
    v_mov_b32 v237, v233
    v_mov_b32 v238, v234
    v_mov_b32 v239, v235
    v_permlane32_swap_b32 v232, v236
    v_permlane32_swap_b32 v233, v237
    v_permlane32_swap_b32 v234, v238
    v_permlane32_swap_b32 v235, v239
    v_max_f32 v232, v232, v236
    v_max_f32 v233, v233, v237
    v_max_f32 v234, v234, v238
    v_max_f32 v235, v235, v239
    v_sub_f32 v192, 3250585600, v232
    v_sub_f32 v193, 3250585600, v232
    v_sub_f32 v194, 3250585600, v232
    v_sub_f32 v195, 3250585600, v232
    v_sub_f32 v196, 3250585600, v233
    v_sub_f32 v197, 3250585600, v233
    v_sub_f32 v198, 3250585600, v233
    v_sub_f32 v199, 3250585600, v233
    v_sub_f32 v200, 3250585600, v234
    v_sub_f32 v201, 3250585600, v234
    v_sub_f32 v202, 3250585600, v234
    v_sub_f32 v203, 3250585600, v234
    v_sub_f32 v204, 3250585600, v235
    v_sub_f32 v205, 3250585600, v235
    v_sub_f32 v206, 3250585600, v235
    v_sub_f32 v207, 3250585600, v235
Lattn_stage0:
    s_mov_b32 s43, 7
    v_mfma_f32_16x16x32_bf16 v[208:211], a[208:211], v[64:67], v[192:195]
    s_lshl_b32 s53, s5, 4
    v_mfma_f32_16x16x32_bf16 v[208:211], a[212:215], v[68:71], v[208:211]
    s_add_u32 s53, s53, s4
    v_mfma_f32_16x16x32_bf16 v[208:211], a[216:219], v[72:75], v[208:211]
    s_lshl_b32 s53, s53, 2
    v_mfma_f32_16x16x32_bf16 v[208:211], a[220:223], v[76:79], v[208:211]
    s_add_u32 s53, s53, s3
    ds_read_b128 a[228:231], v9 offset:4096
    v_mfma_f32_16x16x32_bf16 v[212:215], a[208:211], v[80:83], v[196:199]
    s_mul_i32 s53, s53, 4608
    s_nop 3
    v_exp_f32 v208, v208
    v_mfma_f32_16x16x32_bf16 v[212:215], a[212:215], v[84:87], v[212:215]
    s_add_u32 s53, s53, 2621440
    v_exp_f32 v209, v209
    v_mfma_f32_16x16x32_bf16 v[212:215], a[216:219], v[88:91], v[212:215]
    s_lshr_b32 s44, s2, 5
    v_exp_f32 v210, v210
    v_mfma_f32_16x16x32_bf16 v[212:215], a[220:223], v[92:95], v[212:215]
    s_lshl_b32 s44, s44, 3
    v_exp_f32 v211, v211
    v_cvt_pk_bf16_f32 v128, v208, v209
    ds_read_b128 a[232:235], v10 offset:4096
    v_cvt_pk_bf16_f32 v129, v210, v211
    v_mfma_f32_16x16x32_bf16 v[208:211], a[208:211], v[96:99], v[200:203]
    s_and_b32 s37, s2, 7
    s_nop 0
    v_exp_f32 v212, v212
    v_mfma_f32_16x16x32_bf16 v[208:211], a[212:215], v[100:103], v[208:211]
    s_add_u32 s44, s44, s37
    v_exp_f32 v213, v213
    v_mfma_f32_16x16x32_bf16 v[208:211], a[216:219], v[104:107], v[208:211]
    s_lshl_b32 s44, s44, 2
    v_exp_f32 v214, v214
    v_mfma_f32_16x16x32_bf16 v[208:211], a[220:223], v[108:111], v[208:211]
    s_bfe_u32 s37, s2, 0x20003
    v_exp_f32 v215, v215
    v_cvt_pk_bf16_f32 v136, v212, v213
Ltour3:
    s_cbranch_execz Ltour7
    ds_read_b128 a[236:239], v11 offset:4096
    v_cvt_pk_bf16_f32 v137, v214, v215
    v_mfma_f32_16x16x32_bf16 v[212:215], a[208:211], v[112:115], v[204:207]
    s_add_u32 s44, s44, s37
    s_nop 0
    v_exp_f32 v208, v208
    v_mfma_f32_16x16x32_bf16 v[212:215], a[212:215], v[116:119], v[212:215]
    s_add_u32 s44, s44, 72
    v_exp_f32 v209, v209
    v_mfma_f32_16x16x32_bf16 v[212:215], a[216:219], v[120:123], v[212:215]
    s_cmp_lt_u32 s44, 216
    s_cselect_b32 s37, 0, 2147483648
    v_exp_f32 v210, v210
    v_mfma_f32_16x16x32_bf16 v[212:215], a[220:223], v[124:127], v[212:215]
    s_lshl_b32 s44, s44, 5
    v_exp_f32 v211, v211
    v_cvt_pk_bf16_f32 v144, v208, v209
    ds_read_b128 a[208:211], v8 offset:8192
    v_cvt_pk_bf16_f32 v145, v210, v211
    v_mfma_f32_16x16x32_bf16 v[208:211], a[224:227], v[64:67], v[192:195]
    s_waitcnt lgkmcnt(3)
    s_or_b32 s44, s44, s37
    v_exp_f32 v212, v212
    v_mfma_f32_16x16x32_bf16 v[208:211], a[228:231], v[68:71], v[208:211]
    s_waitcnt lgkmcnt(2)
    s_mov_b32 s18, 3981312
    v_exp_f32 v213, v213
    v_mfma_f32_16x16x32_bf16 v[208:211], a[232:235], v[72:75], v[208:211]
    s_waitcnt lgkmcnt(1)
    s_lshr_b32 s6, s2, 3
    v_exp_f32 v214, v214
    v_mfma_f32_16x16x32_bf16 v[208:211], a[236:239], v[76:79], v[208:211]
    s_and_b32 s7, s2, 7
    v_exp_f32 v215, v215
    v_cvt_pk_bf16_f32 v152, v212, v213
    ds_read_b128 a[212:215], v9 offset:8192
    v_cvt_pk_bf16_f32 v153, v214, v215
    v_mfma_f32_16x16x32_bf16 v[212:215], a[224:227], v[80:83], v[196:199]
    s_mul_i32 s7, s7, 18
    s_nop 0
    v_exp_f32 v208, v208
    v_mfma_f32_16x16x32_bf16 v[212:215], a[228:231], v[84:87], v[212:215]
    s_add_u32 s7, s7, s6
    v_exp_f32 v209, v209
    v_mfma_f32_16x16x32_bf16 v[212:215], a[232:235], v[88:91], v[212:215]
    s_lshl_b32 s58, s7, 6
    v_exp_f32 v210, v210
    v_mfma_f32_16x16x32_bf16 v[212:215], a[236:239], v[92:95], v[212:215]
    s_mul_i32 s59, s7, 36864
    v_exp_f32 v211, v211
    v_cvt_pk_bf16_f32 v130, v208, v209
    ds_read_b128 a[216:219], v10 offset:8192
    v_cvt_pk_bf16_f32 v131, v210, v211
    v_mfma_f32_16x16x32_bf16 v[208:211], a[224:227], v[96:99], v[200:203]
    s_cmp_lt_u32 s6, 18
    s_cselect_b32 s7, 0, 2147483648
    v_exp_f32 v212, v212
    v_mfma_f32_16x16x32_bf16 v[208:211], a[228:231], v[100:103], v[208:211]
    s_or_b32 s58, s58, s7
    v_exp_f32 v213, v213
    v_mfma_f32_16x16x32_bf16 v[208:211], a[232:235], v[104:107], v[208:211]
    s_or_b32 s59, s59, s7
    v_exp_f32 v214, v214
    v_mfma_f32_16x16x32_bf16 v[208:211], a[236:239], v[108:111], v[208:211]
    s_and_b32 s7, s4, 1
    v_exp_f32 v215, v215
    v_cvt_pk_bf16_f32 v138, v212, v213
    ds_read_b128 a[220:223], v11 offset:8192
    v_cvt_pk_bf16_f32 v139, v214, v215
    s_mov_b32 s39, 221184
    s_mov_b32 s38, 27648
    v_mfma_f32_16x16x32_bf16 v[212:215], a[224:227], v[112:115], v[204:207]
    s_lshl_b32 s6, s7, 7
    v_exp_f32 v208, v208
    v_mfma_f32_16x16x32_bf16 v[212:215], a[228:231], v[116:119], v[212:215]
    s_xor_b32 s36, s4, 1
    v_exp_f32 v209, v209
    v_mfma_f32_16x16x32_bf16 v[212:215], a[232:235], v[120:123], v[212:215]
    s_mul_i32 s36, s36, 294912
    v_exp_f32 v210, v210
    v_mfma_f32_16x16x32_bf16 v[212:215], a[236:239], v[124:127], v[212:215]
    s_waitcnt lgkmcnt(3)
    s_add_u32 s46, s36, s6
    v_exp_f32 v211, v211
    v_cvt_pk_bf16_f32 v146, v208, v209
    ds_read_b128 a[224:227], v8 offset:12288
    v_cvt_pk_bf16_f32 v147, v210, v211
    v_mfma_f32_16x16x32_bf16 v[208:211], a[208:211], v[64:67], v[192:195]
    s_waitcnt lgkmcnt(3)
    s_lshl_b32 s36, s4, 8
    v_exp_f32 v212, v212
    v_mfma_f32_16x16x32_bf16 v[208:211], a[212:215], v[68:71], v[208:211]
    s_waitcnt lgkmcnt(2)
    s_add_u32 s56, s47, s36
    v_exp_f32 v213, v213
    v_mfma_f32_16x16x32_bf16 v[208:211], a[216:219], v[72:75], v[208:211]
    s_waitcnt lgkmcnt(1)
    s_lshr_b32 s36, s4, 1
    v_exp_f32 v214, v214
    v_mfma_f32_16x16x32_bf16 v[208:211], a[220:223], v[76:79], v[208:211]
    s_lshl_b32 s36, s36, 11
    v_exp_f32 v215, v215
    v_cvt_pk_bf16_f32 v154, v212, v213
    ds_read_b128 a[228:231], v9 offset:12288
    v_cvt_pk_bf16_f32 v155, v214, v215
    v_mfma_f32_16x16x32_bf16 v[212:215], a[208:211], v[80:83], v[196:199]
    s_lshl_b32 s7, s7, 8
    s_nop 0
    v_exp_f32 v208, v208
    v_mfma_f32_16x16x32_bf16 v[212:215], a[212:215], v[84:87], v[212:215]
    s_add_u32 s36, s36, s7
    v_exp_f32 v209, v209
    v_mfma_f32_16x16x32_bf16 v[212:215], a[216:219], v[88:91], v[212:215]
    s_add_u32 s93, s47, s36
    v_exp_f32 v210, v210
    v_mfma_f32_16x16x32_bf16 v[212:215], a[220:223], v[92:95], v[212:215]
    s_lshr_b32 s36, s4, 1
    v_exp_f32 v211, v211
    v_cvt_pk_bf16_f32 v132, v208, v209
    ds_read_b128 a[232:235], v10 offset:12288
    v_cvt_pk_bf16_f32 v133, v210, v211
    v_mfma_f32_16x16x32_bf16 v[208:211], a[208:211], v[96:99], v[200:203]
    s_lshl_b32 s36, s36, 4
    s_nop 0
    v_exp_f32 v212, v212
    v_mfma_f32_16x16x32_bf16 v[208:211], a[212:215], v[100:103], v[208:211]
    s_add_u32 s36, s36, s5
    v_exp_f32 v213, v213
    v_mfma_f32_16x16x32_bf16 v[208:211], a[216:219], v[104:107], v[208:211]
    s_lshl_b32 s36, s36, 9
    v_exp_f32 v214, v214
    v_mfma_f32_16x16x32_bf16 v[208:211], a[220:223], v[108:111], v[208:211]
    s_add_u32 s36, s36, s7
    v_exp_f32 v215, v215
    v_cvt_pk_bf16_f32 v140, v212, v213
    ds_read_b128 a[236:239], v11 offset:12288
    v_cvt_pk_bf16_f32 v141, v214, v215
    s_waitcnt vmcnt(4)
    s_barrier
    v_mfma_f32_16x16x32_bf16 v[212:215], a[208:211], v[112:115], v[204:207]
    s_lshl_b32 s36, s36, 8
    v_exp_f32 v208, v208
    v_mfma_f32_16x16x32_bf16 v[212:215], a[212:215], v[116:119], v[212:215]
    s_add_u32 m0, s42, 49152
    s_add_u32 s55, s36, 20971520
    v_exp_f32 v209, v209
    v_mfma_f32_16x16x32_bf16 v[212:215], a[216:219], v[120:123], v[212:215]
    s_add_u32 s7, s45, s6
    v_exp_f32 v210, v210
    v_mfma_f32_16x16x32_bf16 v[212:215], a[220:223], v[124:127], v[212:215]
    s_waitcnt lgkmcnt(3)
    s_xor_b32 s54, s92, 128
    v_exp_f32 v211, v211
    v_cvt_pk_bf16_f32 v148, v208, v209
    ds_read_b128 a[208:211], v8 offset:16384
    v_cvt_pk_bf16_f32 v149, v210, v211
    buffer_load_dwordx4 v36, s[8:11], s40 offen lds
    v_mfma_f32_16x16x32_bf16 v[208:211], a[224:227], v[64:67], v[192:195]
    s_waitcnt lgkmcnt(3)
    s_lshl_b32 s36, s3, 14
    v_exp_f32 v212, v212
    v_mfma_f32_16x16x32_bf16 v[208:211], a[228:231], v[68:71], v[208:211]
    s_waitcnt lgkmcnt(2)
    v_exp_f32 v213, v213
    v_mfma_f32_16x16x32_bf16 v[208:211], a[232:235], v[72:75], v[208:211]
    s_waitcnt lgkmcnt(1)
    v_exp_f32 v214, v214
    v_mfma_f32_16x16x32_bf16 v[208:211], a[236:239], v[76:79], v[208:211]
    v_exp_f32 v215, v215
    v_cvt_pk_bf16_f32 v156, v212, v213
    ds_read_b128 a[212:215], v9 offset:16384
    v_cvt_pk_bf16_f32 v157, v214, v215
    v_mfma_f32_16x16x32_bf16 v[212:215], a[224:227], v[80:83], v[196:199]
    s_nop 2
    v_exp_f32 v208, v208
    v_mfma_f32_16x16x32_bf16 v[212:215], a[228:231], v[84:87], v[212:215]
    v_exp_f32 v209, v209
    v_mfma_f32_16x16x32_bf16 v[212:215], a[232:235], v[88:91], v[212:215]
    v_exp_f32 v210, v210
    v_mfma_f32_16x16x32_bf16 v[212:215], a[236:239], v[92:95], v[212:215]
    v_exp_f32 v211, v211
    ds_read_b64_tr_b16 a[160:161], v20 offset:0
    v_cvt_pk_bf16_f32 v134, v208, v209
    v_lshrrev_b32 v51, 2, v0
    v_mul_u32_u24 v51, 9216, v51
    v_and_b32 v254, 3, v0
    v_lshl_add_u32 v254, v254, 4, v51
    v_lshlrev_b32 v255, 4, v0
    v_add_u32 v51, 98304, v255
    v_lshl_add_u32 v252, v1, 4, s36
    v_mov_b32 v224, 0
    v_mov_b32 v225, 0
    v_mov_b32 v226, 0
    v_mov_b32 v227, 0
    v_mov_b32 v228, 0
    v_mov_b32 v229, 0
    v_mov_b32 v230, 0
    v_mov_b32 v231, 0
    v_mov_b32 v248, -1
    v_mov_b32 v249, -1
    v_mov_b32 v250, -1
    v_mov_b32 v251, -1
    v_min_u32 v232, 41, v1
    v_lshlrev_b32 v232, 4, v232
    s_mov_b32 s57, s58
    s_lshl_b32 s6, s3, 10
    s_add_u32 s6, s6, 135168
    s_lshr_b32 s37, s2, 3
    s_mul_i32 s37, s37, -129024
    s_add_u32 s37, s37, 4128768
    ds_read_b64_tr_b16 a[162:163], v20 offset:4096
    ds_read_b128 a[216:219], v10 offset:16384
    v_cvt_pk_bf16_f32 v135, v210, v211
    buffer_load_dwordx4 v37, s[8:11], s40 offen offset:1024 lds
    v_mfma_f32_16x16x32_bf16 v[208:211], a[224:227], v[96:99], v[200:203]
    v_exp_f32 v212, v212
    v_mfma_f32_16x16x32_bf16 v[208:211], a[228:231], v[100:103], v[208:211]
    v_exp_f32 v213, v213
    v_mfma_f32_16x16x32_bf16 v[208:211], a[232:235], v[104:107], v[208:211]
    v_exp_f32 v214, v214
    v_mfma_f32_16x16x32_bf16 v[208:211], a[236:239], v[108:111], v[208:211]
    s_mov_b32 s52, s55
    v_exp_f32 v215, v215
    ds_read_b64_tr_b16 a[164:165], v20 offset:8192
    v_cvt_pk_bf16_f32 v142, v212, v213
    ds_read_b64_tr_b16 a[166:167], v20 offset:12288
    v_min_u32 v237, 19, v1
    v_lshl_add_u32 v237, v237, 7, s36
    v_lshl_add_u32 v238, v1, 7, s36
    ds_read_b128 a[220:223], v11 offset:16384
    v_cvt_pk_bf16_f32 v143, v214, v215
    buffer_load_dword v217, v57, s[32:35], s37 offen
    v_mfma_f32_16x16x32_bf16 v[212:215], a[224:227], v[112:115], v[204:207]
    v_exp_f32 v208, v208
    v_mfma_f32_16x16x32_bf16 v[212:215], a[228:231], v[116:119], v[212:215]
    v_exp_f32 v209, v209
    v_mfma_f32_16x16x32_bf16 v[212:215], a[232:235], v[120:123], v[212:215]
    s_mul_i32 s37, s5, 18432
    v_exp_f32 v210, v210
    v_mfma_f32_16x16x32_bf16 v[212:215], a[236:239], v[124:127], v[212:215]
    s_add_u32 s37, s37, s45
    v_exp_f32 v211, v211
    ds_read_b64_tr_b16 a[168:169], v21 offset:0
    v_cvt_pk_bf16_f32 v150, v208, v209
    ds_read_b64_tr_b16 a[170:171], v21 offset:4096
    v_min_u32 v236, 143, v0
    v_lshl_add_u32 v236, v236, 7, s37
    v_mul_u32_u24 v235, 24, v0
    v_lshrrev_b32 v235, 8, v235
    v_lshl_add_u32 v235, v235, 7, s37
    ds_read_b128 a[224:227], v8 offset:20480
    v_cvt_pk_bf16_f32 v151, v210, v211
    s_waitcnt lgkmcnt(3)
    buffer_load_dwordx4 v38, s[8:11], s40 offen offset:2048 lds
Lattn_loop:
    v_mfma_f32_16x16x32_bf16 v[208:211], a[208:211], v[64:67], v[192:195]
    v_exp_f32 v212, v212
    v_mfma_f32_16x16x32_bf16 v[208:211], a[212:215], v[68:71], v[208:211]
    v_exp_f32 v213, v213
    v_mfma_f32_16x16x32_bf16 v[208:211], a[216:219], v[72:75], v[208:211]
    v_exp_f32 v214, v214
    v_mfma_f32_16x16x32_bf16 v[208:211], a[220:223], v[76:79], v[208:211]
    v_exp_f32 v215, v215
    v_mfma_f32_16x16x32_bf16 a[0:3], a[160:163], v[128:131], a[0:3]
    ds_read_b64_tr_b16 a[172:173], v21 offset:8192
    v_cvt_pk_bf16_f32 v158, v212, v213
    v_mfma_f32_16x16x32_bf16 a[0:3], a[164:167], v[132:135], a[0:3]
    ds_read_b64_tr_b16 a[174:175], v21 offset:12288
    v_mfma_f32_16x16x32_bf16 a[4:7], a[160:163], v[136:139], a[4:7]
    ds_read_b128 a[228:231], v9 offset:20480
    v_cvt_pk_bf16_f32 v159, v214, v215
    v_mfma_f32_16x16x32_bf16 a[4:7], a[164:167], v[140:143], a[4:7]
    v_mfma_f32_16x16x32_bf16 v[212:215], a[208:211], v[80:83], v[196:199]
    v_exp_f32 v208, v208
    v_mfma_f32_16x16x32_bf16 v[212:215], a[212:215], v[84:87], v[212:215]
    v_exp_f32 v209, v209
    v_mfma_f32_16x16x32_bf16 v[212:215], a[216:219], v[88:91], v[212:215]
    v_exp_f32 v210, v210
    v_mfma_f32_16x16x32_bf16 v[212:215], a[220:223], v[92:95], v[212:215]
    v_exp_f32 v211, v211
    v_mfma_f32_16x16x32_bf16 a[8:11], a[160:163], v[144:147], a[8:11]
    ds_read_b64_tr_b16 a[176:177], v22 offset:0
    v_cvt_pk_bf16_f32 v160, v208, v209
    v_mfma_f32_16x16x32_bf16 a[8:11], a[164:167], v[148:151], a[8:11]
    ds_read_b64_tr_b16 a[178:179], v22 offset:4096
    v_mfma_f32_16x16x32_bf16 a[12:15], a[160:163], v[152:155], a[12:15]
    ds_read_b128 a[232:235], v10 offset:20480
    v_cvt_pk_bf16_f32 v161, v210, v211
    v_mfma_f32_16x16x32_bf16 a[12:15], a[164:167], v[156:159], a[12:15]
    s_waitcnt lgkmcnt(3)
    buffer_load_dwordx4 v39, s[8:11], s40 offen offset:3072 lds
    v_mfma_f32_16x16x32_bf16 v[208:211], a[208:211], v[96:99], v[200:203]
    v_exp_f32 v212, v212
    v_mfma_f32_16x16x32_bf16 v[208:211], a[212:215], v[100:103], v[208:211]
    s_add_u32 s40, s40, 16384
    v_exp_f32 v213, v213
    v_mfma_f32_16x16x32_bf16 v[208:211], a[216:219], v[104:107], v[208:211]
    s_mov_b32 m0, s6
    v_exp_f32 v214, v214
    v_mfma_f32_16x16x32_bf16 v[208:211], a[220:223], v[108:111], v[208:211]
    v_exp_f32 v215, v215
    v_mfma_f32_16x16x32_bf16 a[16:19], a[168:171], v[128:131], a[16:19]
    ds_read_b64_tr_b16 a[180:181], v22 offset:8192
    v_cvt_pk_bf16_f32 v168, v212, v213
    v_mfma_f32_16x16x32_bf16 a[16:19], a[172:175], v[132:135], a[16:19]
    ds_read_b64_tr_b16 a[182:183], v22 offset:12288
    v_mfma_f32_16x16x32_bf16 a[20:23], a[168:171], v[136:139], a[20:23]
    ds_read_b128 a[236:239], v11 offset:20480
    v_cvt_pk_bf16_f32 v169, v214, v215
    v_mfma_f32_16x16x32_bf16 a[20:23], a[172:175], v[140:143], a[20:23]
    buffer_load_dwordx4 v254, s[32:35], s57 offen  lds
    v_smfmac_f32_16x16x64_bf16 a[192:195], v[52:55], v[128:135], v50
    v_mfma_f32_16x16x32_bf16 v[212:215], a[208:211], v[112:115], v[204:207]
    v_exp_f32 v208, v208
    v_mfma_f32_16x16x32_bf16 v[212:215], a[212:215], v[116:119], v[212:215]
    s_add_u32 m0, s42, 98304
    v_exp_f32 v209, v209
    v_mfma_f32_16x16x32_bf16 v[212:215], a[216:219], v[120:123], v[212:215]
    v_exp_f32 v210, v210
    v_mfma_f32_16x16x32_bf16 v[212:215], a[220:223], v[124:127], v[212:215]
    v_exp_f32 v211, v211
    v_mfma_f32_16x16x32_bf16 a[24:27], a[168:171], v[144:147], a[24:27]
    ds_read_b64_tr_b16 a[184:185], v23 offset:0
    v_cvt_pk_bf16_f32 v176, v208, v209
    v_mfma_f32_16x16x32_bf16 a[24:27], a[172:175], v[148:151], a[24:27]
    ds_read_b64_tr_b16 a[186:187], v23 offset:4096
    v_mfma_f32_16x16x32_bf16 a[28:31], a[168:171], v[152:155], a[28:31]
    ds_read_b128 a[208:211], v8 offset:24576
    v_cvt_pk_bf16_f32 v177, v210, v211
    v_mfma_f32_16x16x32_bf16 a[28:31], a[172:175], v[156:159], a[28:31]
    s_waitcnt lgkmcnt(3)
    buffer_load_dwordx4 v40, s[12:15], s41 offen lds
    v_mfma_f32_16x16x32_bf16 v[208:211], a[224:227], v[64:67], v[192:195]
    v_exp_f32 v212, v212
    v_mfma_f32_16x16x32_bf16 v[208:211], a[228:231], v[68:71], v[208:211]
    s_add_u32 s6, s6, 4096
    v_exp_f32 v213, v213
    v_mfma_f32_16x16x32_bf16 v[208:211], a[232:235], v[72:75], v[208:211]
    s_add_u32 s57, s57, 589824
    v_exp_f32 v214, v214
    v_mfma_f32_16x16x32_bf16 v[208:211], a[236:239], v[76:79], v[208:211]
    v_exp_f32 v215, v215
    v_mfma_f32_16x16x32_bf16 a[32:35], a[176:179], v[128:131], a[32:35]
    ds_read_b64_tr_b16 a[188:189], v23 offset:8192
    v_cvt_pk_bf16_f32 v184, v212, v213
    v_mfma_f32_16x16x32_bf16 a[32:35], a[180:183], v[132:135], a[32:35]
    ds_read_b64_tr_b16 a[190:191], v23 offset:12288
    v_mfma_f32_16x16x32_bf16 a[36:39], a[176:179], v[136:139], a[36:39]
    ds_read_b128 a[212:215], v9 offset:24576
    v_cvt_pk_bf16_f32 v185, v214, v215
    v_mfma_f32_16x16x32_bf16 a[36:39], a[180:183], v[140:143], a[36:39]
    v_smfmac_f32_16x16x64_bf16 a[196:199], v[52:55], v[136:143], v50
    v_mfma_f32_16x16x32_bf16 v[212:215], a[224:227], v[80:83], v[196:199]
    v_exp_f32 v208, v208
    v_mfma_f32_16x16x32_bf16 v[212:215], a[228:231], v[84:87], v[212:215]
    v_exp_f32 v209, v209
    v_mfma_f32_16x16x32_bf16 v[212:215], a[232:235], v[88:91], v[212:215]
    v_exp_f32 v210, v210
    v_mfma_f32_16x16x32_bf16 v[212:215], a[236:239], v[92:95], v[212:215]
    v_exp_f32 v211, v211
    v_mfma_f32_16x16x32_bf16 a[40:43], a[176:179], v[144:147], a[40:43]
    ds_read_b64_tr_b16 a[160:161], v24 offset:0
    v_cvt_pk_bf16_f32 v162, v208, v209
    v_mfma_f32_16x16x32_bf16 a[40:43], a[180:183], v[148:151], a[40:43]
    ds_read_b64_tr_b16 a[162:163], v24 offset:4096
    v_mfma_f32_16x16x32_bf16 a[44:47], a[176:179], v[152:155], a[44:47]
    ds_read_b128 a[216:219], v10 offset:24576
    v_cvt_pk_bf16_f32 v163, v210, v211
    v_mfma_f32_16x16x32_bf16 a[44:47], a[180:183], v[156:159], a[44:47]
    s_waitcnt lgkmcnt(3)
    buffer_load_dwordx4 v41, s[12:15], s41 offen offset:1024 lds
    v_mfma_f32_16x16x32_bf16 v[208:211], a[224:227], v[96:99], v[200:203]
    v_exp_f32 v212, v212
    v_mfma_f32_16x16x32_bf16 v[208:211], a[228:231], v[100:103], v[208:211]
    v_exp_f32 v213, v213
    v_mfma_f32_16x16x32_bf16 v[208:211], a[232:235], v[104:107], v[208:211]
    v_exp_f32 v214, v214
    v_mfma_f32_16x16x32_bf16 v[208:211], a[236:239], v[108:111], v[208:211]
    v_exp_f32 v215, v215
    v_mfma_f32_16x16x32_bf16 a[48:51], a[184:187], v[128:131], a[48:51]
    ds_read_b64_tr_b16 a[164:165], v24 offset:8192
    v_cvt_pk_bf16_f32 v170, v212, v213
    v_mfma_f32_16x16x32_bf16 a[48:51], a[188:191], v[132:135], a[48:51]
    ds_read_b64_tr_b16 a[166:167], v24 offset:12288
    v_mfma_f32_16x16x32_bf16 a[52:55], a[184:187], v[136:139], a[52:55]
    ds_read_b128 a[220:223], v11 offset:24576
    v_cvt_pk_bf16_f32 v171, v214, v215
    v_mfma_f32_16x16x32_bf16 a[52:55], a[188:191], v[140:143], a[52:55]
    v_smfmac_f32_16x16x64_bf16 a[200:203], v[52:55], v[144:151], v50
    v_mfma_f32_16x16x32_bf16 v[212:215], a[224:227], v[112:115], v[204:207]
    v_exp_f32 v208, v208
    v_mfma_f32_16x16x32_bf16 v[212:215], a[228:231], v[116:119], v[212:215]
    v_exp_f32 v209, v209
    v_mfma_f32_16x16x32_bf16 v[212:215], a[232:235], v[120:123], v[212:215]
    v_exp_f32 v210, v210
    v_mfma_f32_16x16x32_bf16 v[212:215], a[236:239], v[124:127], v[212:215]
    v_exp_f32 v211, v211
    v_mfma_f32_16x16x32_bf16 a[56:59], a[184:187], v[144:147], a[56:59]
    ds_read_b64_tr_b16 a[168:169], v25 offset:0
    v_cvt_pk_bf16_f32 v178, v208, v209
    v_mfma_f32_16x16x32_bf16 a[56:59], a[188:191], v[148:151], a[56:59]
    ds_read_b64_tr_b16 a[170:171], v25 offset:4096
    v_mfma_f32_16x16x32_bf16 a[60:63], a[184:187], v[152:155], a[60:63]
    ds_read_b128 a[224:227], v8 offset:28672
    v_cvt_pk_bf16_f32 v179, v210, v211
    v_mfma_f32_16x16x32_bf16 a[60:63], a[188:191], v[156:159], a[60:63]
    s_waitcnt lgkmcnt(3)
    buffer_load_dwordx4 v40, s[12:15], s41 offen offset:2048 lds
    v_mfma_f32_16x16x32_bf16 v[208:211], a[208:211], v[64:67], v[192:195]
    v_exp_f32 v212, v212
    v_mfma_f32_16x16x32_bf16 v[208:211], a[212:215], v[68:71], v[208:211]
    v_exp_f32 v213, v213
    v_mfma_f32_16x16x32_bf16 v[208:211], a[216:219], v[72:75], v[208:211]
    v_exp_f32 v214, v214
    v_mfma_f32_16x16x32_bf16 v[208:211], a[220:223], v[76:79], v[208:211]
    v_exp_f32 v215, v215
    v_mfma_f32_16x16x32_bf16 a[64:67], a[160:163], v[128:131], a[64:67]
    ds_read_b64_tr_b16 a[172:173], v25 offset:8192
    v_cvt_pk_bf16_f32 v186, v212, v213
    v_mfma_f32_16x16x32_bf16 a[64:67], a[164:167], v[132:135], a[64:67]
    ds_read_b64_tr_b16 a[174:175], v25 offset:12288
    v_mfma_f32_16x16x32_bf16 a[68:71], a[160:163], v[136:139], a[68:71]
    ds_read_b128 a[228:231], v9 offset:28672
    v_cvt_pk_bf16_f32 v187, v214, v215
    v_mfma_f32_16x16x32_bf16 a[68:71], a[164:167], v[140:143], a[68:71]
    v_smfmac_f32_16x16x64_bf16 a[204:207], v[52:55], v[152:159], v50
    v_mfma_f32_16x16x32_bf16 v[212:215], a[208:211], v[80:83], v[196:199]
    v_exp_f32 v208, v208
    v_mfma_f32_16x16x32_bf16 v[212:215], a[212:215], v[84:87], v[212:215]
    v_exp_f32 v209, v209
    v_mfma_f32_16x16x32_bf16 v[212:215], a[216:219], v[88:91], v[212:215]
    v_exp_f32 v210, v210
    v_mfma_f32_16x16x32_bf16 v[212:215], a[220:223], v[92:95], v[212:215]
    v_exp_f32 v211, v211
    v_mfma_f32_16x16x32_bf16 a[72:75], a[160:163], v[144:147], a[72:75]
    ds_read_b64_tr_b16 a[176:177], v26 offset:0
    v_cvt_pk_bf16_f32 v164, v208, v209
    v_mfma_f32_16x16x32_bf16 a[72:75], a[164:167], v[148:151], a[72:75]
    ds_read_b64_tr_b16 a[178:179], v26 offset:4096
    v_mfma_f32_16x16x32_bf16 a[76:79], a[160:163], v[152:155], a[76:79]
    ds_read_b128 a[232:235], v10 offset:28672
    v_cvt_pk_bf16_f32 v165, v210, v211
    v_mfma_f32_16x16x32_bf16 a[76:79], a[164:167], v[156:159], a[76:79]
    s_waitcnt lgkmcnt(3)
    buffer_load_dwordx4 v41, s[12:15], s41 offen offset:3072 lds
    v_mfma_f32_16x16x32_bf16 v[208:211], a[208:211], v[96:99], v[200:203]
    v_exp_f32 v212, v212
    v_mfma_f32_16x16x32_bf16 v[208:211], a[212:215], v[100:103], v[208:211]
    s_add_u32 s41, s41, 16384
    v_exp_f32 v213, v213
    v_mfma_f32_16x16x32_bf16 v[208:211], a[216:219], v[104:107], v[208:211]
    v_exp_f32 v214, v214
    v_mfma_f32_16x16x32_bf16 v[208:211], a[220:223], v[108:111], v[208:211]
    v_exp_f32 v215, v215
    v_mfma_f32_16x16x32_bf16 a[80:83], a[168:171], v[128:131], a[80:83]
    ds_read_b64_tr_b16 a[180:181], v26 offset:8192
    v_cvt_pk_bf16_f32 v172, v212, v213
    v_mfma_f32_16x16x32_bf16 a[80:83], a[172:175], v[132:135], a[80:83]
    ds_read_b64_tr_b16 a[182:183], v26 offset:12288
    v_mfma_f32_16x16x32_bf16 a[84:87], a[168:171], v[136:139], a[84:87]
    ds_read_b128 a[236:239], v11 offset:28672
    v_cvt_pk_bf16_f32 v173, v214, v215
    v_mfma_f32_16x16x32_bf16 a[84:87], a[172:175], v[140:143], a[84:87]
    s_waitcnt vmcnt(10)
    s_barrier
    v_mfma_f32_16x16x32_bf16 v[212:215], a[208:211], v[112:115], v[204:207]
    v_exp_f32 v208, v208
    v_mfma_f32_16x16x32_bf16 v[212:215], a[212:215], v[116:119], v[212:215]
    s_add_u32 m0, s42, 0
    v_exp_f32 v209, v209
    v_mfma_f32_16x16x32_bf16 v[212:215], a[216:219], v[120:123], v[212:215]
    v_exp_f32 v210, v210
    v_mfma_f32_16x16x32_bf16 v[212:215], a[220:223], v[124:127], v[212:215]
    v_exp_f32 v211, v211
    v_mfma_f32_16x16x32_bf16 a[88:91], a[168:171], v[144:147], a[88:91]
    ds_read_b64_tr_b16 a[184:185], v27 offset:0
    v_cvt_pk_bf16_f32 v180, v208, v209
    v_mfma_f32_16x16x32_bf16 a[88:91], a[172:175], v[148:151], a[88:91]
    ds_read_b64_tr_b16 a[186:187], v27 offset:4096
    v_mfma_f32_16x16x32_bf16 a[92:95], a[168:171], v[152:155], a[92:95]
    ds_read_b128 a[208:211], v8 offset:32768
    v_cvt_pk_bf16_f32 v181, v210, v211
    v_mfma_f32_16x16x32_bf16 a[92:95], a[172:175], v[156:159], a[92:95]
    s_waitcnt lgkmcnt(3)
    buffer_load_dwordx4 v36, s[8:11], s40 offen lds
    v_mfma_f32_16x16x32_bf16 v[208:211], a[224:227], v[64:67], v[192:195]
    v_exp_f32 v212, v212
    v_mfma_f32_16x16x32_bf16 v[208:211], a[228:231], v[68:71], v[208:211]
    v_exp_f32 v213, v213
    v_mfma_f32_16x16x32_bf16 v[208:211], a[232:235], v[72:75], v[208:211]
    v_exp_f32 v214, v214
    v_mfma_f32_16x16x32_bf16 v[208:211], a[236:239], v[76:79], v[208:211]
    v_exp_f32 v215, v215
    v_mfma_f32_16x16x32_bf16 a[96:99], a[176:179], v[128:131], a[96:99]
    ds_read_b64_tr_b16 a[188:189], v27 offset:8192
    v_cvt_pk_bf16_f32 v188, v212, v213
    v_mfma_f32_16x16x32_bf16 a[96:99], a[180:183], v[132:135], a[96:99]
    ds_read_b64_tr_b16 a[190:191], v27 offset:12288
    v_mfma_f32_16x16x32_bf16 a[100:103], a[176:179], v[136:139], a[100:103]
    ds_read_b128 a[212:215], v9 offset:32768
    v_cvt_pk_bf16_f32 v189, v214, v215
    v_mfma_f32_16x16x32_bf16 a[100:103], a[180:183], v[140:143], a[100:103]
    v_mfma_f32_16x16x32_bf16 v[212:215], a[224:227], v[80:83], v[196:199]
    v_exp_f32 v208, v208
    v_mfma_f32_16x16x32_bf16 v[212:215], a[228:231], v[84:87], v[212:215]
    v_exp_f32 v209, v209
    v_mfma_f32_16x16x32_bf16 v[212:215], a[232:235], v[88:91], v[212:215]
    v_exp_f32 v210, v210
    v_mfma_f32_16x16x32_bf16 v[212:215], a[236:239], v[92:95], v[212:215]
    v_exp_f32 v211, v211
    v_mfma_f32_16x16x32_bf16 a[104:107], a[176:179], v[144:147], a[104:107]
    ds_read_b64_tr_b16 a[160:161], v20 offset:16384
    v_cvt_pk_bf16_f32 v166, v208, v209
    v_mfma_f32_16x16x32_bf16 a[104:107], a[180:183], v[148:151], a[104:107]
    ds_read_b64_tr_b16 a[162:163], v20 offset:20480
    v_mfma_f32_16x16x32_bf16 a[108:111], a[176:179], v[152:155], a[108:111]
    ds_read_b128 a[216:219], v10 offset:32768
    v_cvt_pk_bf16_f32 v167, v210, v211
    v_mfma_f32_16x16x32_bf16 a[108:111], a[180:183], v[156:159], a[108:111]
    s_waitcnt lgkmcnt(3)
    buffer_load_dwordx4 v37, s[8:11], s40 offen offset:1024 lds
    v_mfma_f32_16x16x32_bf16 v[208:211], a[224:227], v[96:99], v[200:203]
    v_exp_f32 v212, v212
    v_mfma_f32_16x16x32_bf16 v[208:211], a[228:231], v[100:103], v[208:211]
    v_exp_f32 v213, v213
    v_mfma_f32_16x16x32_bf16 v[208:211], a[232:235], v[104:107], v[208:211]
    v_exp_f32 v214, v214
    v_mfma_f32_16x16x32_bf16 v[208:211], a[236:239], v[108:111], v[208:211]
    v_exp_f32 v215, v215
    v_mfma_f32_16x16x32_bf16 a[112:115], a[184:187], v[128:131], a[112:115]
    ds_read_b64_tr_b16 a[164:165], v20 offset:24576
    v_cvt_pk_bf16_f32 v174, v212, v213
    v_mfma_f32_16x16x32_bf16 a[112:115], a[188:191], v[132:135], a[112:115]
    ds_read_b64_tr_b16 a[166:167], v20 offset:28672
    v_mfma_f32_16x16x32_bf16 a[116:119], a[184:187], v[136:139], a[116:119]
    ds_read_b128 a[220:223], v11 offset:32768
    v_cvt_pk_bf16_f32 v175, v214, v215
    v_mfma_f32_16x16x32_bf16 a[116:119], a[188:191], v[140:143], a[116:119]
    buffer_load_dwordx4 v[240:243], v7, s[16:19], s44 offen
    v_mfma_f32_16x16x32_bf16 v[212:215], a[224:227], v[112:115], v[204:207]
    v_exp_f32 v208, v208
    v_mfma_f32_16x16x32_bf16 v[212:215], a[228:231], v[116:119], v[212:215]
    v_exp_f32 v209, v209
    v_mfma_f32_16x16x32_bf16 v[212:215], a[232:235], v[120:123], v[212:215]
    v_exp_f32 v210, v210
    v_mfma_f32_16x16x32_bf16 v[212:215], a[236:239], v[124:127], v[212:215]
    s_add_u32 s44, s44, 884736
    v_exp_f32 v211, v211
    v_mfma_f32_16x16x32_bf16 a[120:123], a[184:187], v[144:147], a[120:123]
    ds_read_b64_tr_b16 a[168:169], v21 offset:16384
    v_cvt_pk_bf16_f32 v182, v208, v209
    v_mfma_f32_16x16x32_bf16 a[120:123], a[188:191], v[148:151], a[120:123]
    ds_read_b64_tr_b16 a[170:171], v21 offset:20480
    v_mfma_f32_16x16x32_bf16 a[124:127], a[184:187], v[152:155], a[124:127]
    ds_read_b128 a[224:227], v8 offset:36864
    v_cvt_pk_bf16_f32 v183, v210, v211
    v_mfma_f32_16x16x32_bf16 a[124:127], a[188:191], v[156:159], a[124:127]
    s_waitcnt lgkmcnt(3)
    buffer_load_dwordx4 v38, s[8:11], s40 offen offset:2048 lds
    v_mfma_f32_16x16x32_bf16 v[208:211], a[208:211], v[64:67], v[192:195]
    v_exp_f32 v212, v212
    v_mfma_f32_16x16x32_bf16 v[208:211], a[212:215], v[68:71], v[208:211]
    v_exp_f32 v213, v213
    v_mfma_f32_16x16x32_bf16 v[208:211], a[216:219], v[72:75], v[208:211]
    v_exp_f32 v214, v214
    v_mfma_f32_16x16x32_bf16 v[208:211], a[220:223], v[76:79], v[208:211]
    v_exp_f32 v215, v215
    v_mfma_f32_16x16x32_bf16 a[0:3], a[160:163], v[160:163], a[0:3]
    ds_read_b64_tr_b16 a[172:173], v21 offset:24576
    v_cvt_pk_bf16_f32 v190, v212, v213
    v_mfma_f32_16x16x32_bf16 a[0:3], a[164:167], v[164:167], a[0:3]
    ds_read_b64_tr_b16 a[174:175], v21 offset:28672
    v_mfma_f32_16x16x32_bf16 a[4:7], a[160:163], v[168:171], a[4:7]
    ds_read_b128 a[228:231], v9 offset:36864
    v_cvt_pk_bf16_f32 v191, v214, v215
    v_mfma_f32_16x16x32_bf16 a[4:7], a[164:167], v[172:175], a[4:7]
    v_mfma_f32_16x16x32_bf16 v[212:215], a[208:211], v[80:83], v[196:199]
    v_exp_f32 v208, v208
    v_mfma_f32_16x16x32_bf16 v[212:215], a[212:215], v[84:87], v[212:215]
    v_exp_f32 v209, v209
    v_mfma_f32_16x16x32_bf16 v[212:215], a[216:219], v[88:91], v[212:215]
    v_exp_f32 v210, v210
    v_mfma_f32_16x16x32_bf16 v[212:215], a[220:223], v[92:95], v[212:215]
    v_exp_f32 v211, v211
    v_mfma_f32_16x16x32_bf16 a[8:11], a[160:163], v[176:179], a[8:11]
    ds_read_b64_tr_b16 a[176:177], v22 offset:16384
    v_cvt_pk_bf16_f32 v128, v208, v209
    v_mfma_f32_16x16x32_bf16 a[8:11], a[164:167], v[180:183], a[8:11]
    ds_read_b64_tr_b16 a[178:179], v22 offset:20480
    v_mfma_f32_16x16x32_bf16 a[12:15], a[160:163], v[184:187], a[12:15]
    ds_read_b128 a[232:235], v10 offset:36864
    v_cvt_pk_bf16_f32 v129, v210, v211
    v_mfma_f32_16x16x32_bf16 a[12:15], a[164:167], v[188:191], a[12:15]
    s_waitcnt lgkmcnt(3)
    buffer_load_dwordx4 v39, s[8:11], s40 offen offset:3072 lds
    v_mfma_f32_16x16x32_bf16 v[208:211], a[208:211], v[96:99], v[200:203]
    v_exp_f32 v212, v212
    v_mfma_f32_16x16x32_bf16 v[208:211], a[212:215], v[100:103], v[208:211]
    s_add_u32 s40, s40, 16384
    v_exp_f32 v213, v213
    v_mfma_f32_16x16x32_bf16 v[208:211], a[216:219], v[104:107], v[208:211]
    v_exp_f32 v214, v214
    v_mfma_f32_16x16x32_bf16 v[208:211], a[220:223], v[108:111], v[208:211]
    v_exp_f32 v215, v215
    v_mfma_f32_16x16x32_bf16 a[16:19], a[168:171], v[160:163], a[16:19]
    ds_read_b64_tr_b16 a[180:181], v22 offset:24576
    v_cvt_pk_bf16_f32 v136, v212, v213
    v_mfma_f32_16x16x32_bf16 a[16:19], a[172:175], v[164:167], a[16:19]
    ds_read_b64_tr_b16 a[182:183], v22 offset:28672
    v_mfma_f32_16x16x32_bf16 a[20:23], a[168:171], v[168:171], a[20:23]
    ds_read_b128 a[236:239], v11 offset:36864
    v_cvt_pk_bf16_f32 v137, v214, v215
    v_mfma_f32_16x16x32_bf16 a[20:23], a[172:175], v[172:175], a[20:23]
    v_smfmac_f32_16x16x64_bf16 a[192:195], v[52:55], v[160:167], v50
    v_mfma_f32_16x16x32_bf16 v[212:215], a[208:211], v[112:115], v[204:207]
Ltour4:
    s_cbranch_execz Ltour8
    v_exp_f32 v208, v208
    v_mfma_f32_16x16x32_bf16 v[212:215], a[212:215], v[116:119], v[212:215]
    s_add_u32 m0, s42, 114688
    v_exp_f32 v209, v209
    v_mfma_f32_16x16x32_bf16 v[212:215], a[216:219], v[120:123], v[212:215]
    v_exp_f32 v210, v210
    v_mfma_f32_16x16x32_bf16 v[212:215], a[220:223], v[124:127], v[212:215]
    v_exp_f32 v211, v211
    v_mfma_f32_16x16x32_bf16 a[24:27], a[168:171], v[176:179], a[24:27]
    ds_read_b64_tr_b16 a[184:185], v23 offset:16384
    v_cvt_pk_bf16_f32 v144, v208, v209
    v_mfma_f32_16x16x32_bf16 a[24:27], a[172:175], v[180:183], a[24:27]
    ds_read_b64_tr_b16 a[186:187], v23 offset:20480
    v_mfma_f32_16x16x32_bf16 a[28:31], a[168:171], v[184:187], a[28:31]
    ds_read_b128 a[208:211], v8 offset:40960
    v_cvt_pk_bf16_f32 v145, v210, v211
    v_mfma_f32_16x16x32_bf16 a[28:31], a[172:175], v[188:191], a[28:31]
    s_waitcnt lgkmcnt(3)
    buffer_load_dwordx4 v40, s[12:15], s41 offen lds
    v_mfma_f32_16x16x32_bf16 v[208:211], a[224:227], v[64:67], v[192:195]
    v_exp_f32 v212, v212
    v_mfma_f32_16x16x32_bf16 v[208:211], a[228:231], v[68:71], v[208:211]
    v_exp_f32 v213, v213
    v_mfma_f32_16x16x32_bf16 v[208:211], a[232:235], v[72:75], v[208:211]
    v_exp_f32 v214, v214
    v_mfma_f32_16x16x32_bf16 v[208:211], a[236:239], v[76:79], v[208:211]
    v_exp_f32 v215, v215
    v_mfma_f32_16x16x32_bf16 a[32:35], a[176:179], v[160:163], a[32:35]
    ds_read_b64_tr_b16 a[188:189], v23 offset:24576
    v_cvt_pk_bf16_f32 v152, v212, v213
    v_mfma_f32_16x16x32_bf16 a[32:35], a[180:183], v[164:167], a[32:35]
    ds_read_b64_tr_b16 a[190:191], v23 offset:28672
    v_mfma_f32_16x16x32_bf16 a[36:39], a[176:179], v[168:171], a[36:39]
    ds_read_b128 a[212:215], v9 offset:40960
    v_cvt_pk_bf16_f32 v153, v214, v215
    v_mfma_f32_16x16x32_bf16 a[36:39], a[180:183], v[172:175], a[36:39]
    v_smfmac_f32_16x16x64_bf16 a[196:199], v[52:55], v[168:175], v50
    v_mfma_f32_16x16x32_bf16 v[212:215], a[224:227], v[80:83], v[196:199]
    v_exp_f32 v208, v208
    v_mfma_f32_16x16x32_bf16 v[212:215], a[228:231], v[84:87], v[212:215]
    v_exp_f32 v209, v209
    v_mfma_f32_16x16x32_bf16 v[212:215], a[232:235], v[88:91], v[212:215]
    v_exp_f32 v210, v210
    v_mfma_f32_16x16x32_bf16 v[212:215], a[236:239], v[92:95], v[212:215]
    v_exp_f32 v211, v211
    v_mfma_f32_16x16x32_bf16 a[40:43], a[176:179], v[176:179], a[40:43]
    ds_read_b64_tr_b16 a[160:161], v24 offset:16384
    v_cvt_pk_bf16_f32 v130, v208, v209
    v_mfma_f32_16x16x32_bf16 a[40:43], a[180:183], v[180:183], a[40:43]
    ds_read_b64_tr_b16 a[162:163], v24 offset:20480
    v_mfma_f32_16x16x32_bf16 a[44:47], a[176:179], v[184:187], a[44:47]
    ds_read_b128 a[216:219], v10 offset:40960
    v_cvt_pk_bf16_f32 v131, v210, v211
    v_mfma_f32_16x16x32_bf16 a[44:47], a[180:183], v[188:191], a[44:47]
    s_waitcnt lgkmcnt(3)
    buffer_load_dwordx4 v41, s[12:15], s41 offen offset:1024 lds
    v_mfma_f32_16x16x32_bf16 v[208:211], a[224:227], v[96:99], v[200:203]
    v_exp_f32 v212, v212
    v_mfma_f32_16x16x32_bf16 v[208:211], a[228:231], v[100:103], v[208:211]
    v_exp_f32 v213, v213
    v_mfma_f32_16x16x32_bf16 v[208:211], a[232:235], v[104:107], v[208:211]
    v_exp_f32 v214, v214
    v_mfma_f32_16x16x32_bf16 v[208:211], a[236:239], v[108:111], v[208:211]
    v_exp_f32 v215, v215
    v_mfma_f32_16x16x32_bf16 a[48:51], a[184:187], v[160:163], a[48:51]
    ds_read_b64_tr_b16 a[164:165], v24 offset:24576
    v_cvt_pk_bf16_f32 v138, v212, v213
    v_mfma_f32_16x16x32_bf16 a[48:51], a[188:191], v[164:167], a[48:51]
    ds_read_b64_tr_b16 a[166:167], v24 offset:28672
    v_mfma_f32_16x16x32_bf16 a[52:55], a[184:187], v[168:171], a[52:55]
    ds_read_b128 a[220:223], v11 offset:40960
    v_cvt_pk_bf16_f32 v139, v214, v215
    v_mfma_f32_16x16x32_bf16 a[52:55], a[188:191], v[172:175], a[52:55]
    v_smfmac_f32_16x16x64_bf16 a[200:203], v[52:55], v[176:183], v50
    v_mfma_f32_16x16x32_bf16 v[212:215], a[224:227], v[112:115], v[204:207]
    v_exp_f32 v208, v208
    v_mfma_f32_16x16x32_bf16 v[212:215], a[228:231], v[116:119], v[212:215]
    v_exp_f32 v209, v209
    v_mfma_f32_16x16x32_bf16 v[212:215], a[232:235], v[120:123], v[212:215]
    v_exp_f32 v210, v210
    v_mfma_f32_16x16x32_bf16 v[212:215], a[236:239], v[124:127], v[212:215]
    v_exp_f32 v211, v211
    v_mfma_f32_16x16x32_bf16 a[56:59], a[184:187], v[176:179], a[56:59]
    ds_read_b64_tr_b16 a[168:169], v25 offset:16384
    v_cvt_pk_bf16_f32 v146, v208, v209
    v_mfma_f32_16x16x32_bf16 a[56:59], a[188:191], v[180:183], a[56:59]
    ds_read_b64_tr_b16 a[170:171], v25 offset:20480
    v_mfma_f32_16x16x32_bf16 a[60:63], a[184:187], v[184:187], a[60:63]
    ds_read_b128 a[224:227], v8 offset:45056
    v_cvt_pk_bf16_f32 v147, v210, v211
    v_mfma_f32_16x16x32_bf16 a[60:63], a[188:191], v[188:191], a[60:63]
    s_waitcnt lgkmcnt(3)
    buffer_load_dwordx4 v40, s[12:15], s41 offen offset:2048 lds
    v_mfma_f32_16x16x32_bf16 v[208:211], a[208:211], v[64:67], v[192:195]
    v_exp_f32 v212, v212
    v_mfma_f32_16x16x32_bf16 v[208:211], a[212:215], v[68:71], v[208:211]
    v_exp_f32 v213, v213
    v_mfma_f32_16x16x32_bf16 v[208:211], a[216:219], v[72:75], v[208:211]
    v_exp_f32 v214, v214
    v_mfma_f32_16x16x32_bf16 v[208:211], a[220:223], v[76:79], v[208:211]
    v_exp_f32 v215, v215
    v_mfma_f32_16x16x32_bf16 a[64:67], a[160:163], v[160:163], a[64:67]
    ds_read_b64_tr_b16 a[172:173], v25 offset:24576
    v_cvt_pk_bf16_f32 v154, v212, v213
    v_mfma_f32_16x16x32_bf16 a[64:67], a[164:167], v[164:167], a[64:67]
    ds_read_b64_tr_b16 a[174:175], v25 offset:28672
    v_mfma_f32_16x16x32_bf16 a[68:71], a[160:163], v[168:171], a[68:71]
    ds_read_b128 a[228:231], v9 offset:45056
    v_cvt_pk_bf16_f32 v155, v214, v215
    v_mfma_f32_16x16x32_bf16 a[68:71], a[164:167], v[172:175], a[68:71]
    v_smfmac_f32_16x16x64_bf16 a[204:207], v[52:55], v[184:191], v50
    v_mfma_f32_16x16x32_bf16 v[212:215], a[208:211], v[80:83], v[196:199]
    v_exp_f32 v208, v208
    v_mfma_f32_16x16x32_bf16 v[212:215], a[212:215], v[84:87], v[212:215]
    v_exp_f32 v209, v209
    v_mfma_f32_16x16x32_bf16 v[212:215], a[216:219], v[88:91], v[212:215]
    v_exp_f32 v210, v210
    v_mfma_f32_16x16x32_bf16 v[212:215], a[220:223], v[92:95], v[212:215]
    v_exp_f32 v211, v211
    v_mfma_f32_16x16x32_bf16 a[72:75], a[160:163], v[176:179], a[72:75]
    ds_read_b64_tr_b16 a[176:177], v26 offset:16384
    v_cvt_pk_bf16_f32 v132, v208, v209
    v_mfma_f32_16x16x32_bf16 a[72:75], a[164:167], v[180:183], a[72:75]
    ds_read_b64_tr_b16 a[178:179], v26 offset:20480
    v_mfma_f32_16x16x32_bf16 a[76:79], a[160:163], v[184:187], a[76:79]
    ds_read_b128 a[232:235], v10 offset:45056
    v_cvt_pk_bf16_f32 v133, v210, v211
    v_mfma_f32_16x16x32_bf16 a[76:79], a[164:167], v[188:191], a[76:79]
    s_waitcnt lgkmcnt(3)
    buffer_load_dwordx4 v41, s[12:15], s41 offen offset:3072 lds
    v_mfma_f32_16x16x32_bf16 v[208:211], a[208:211], v[96:99], v[200:203]
    v_exp_f32 v212, v212
    v_mfma_f32_16x16x32_bf16 v[208:211], a[212:215], v[100:103], v[208:211]
    s_add_u32 s41, s41, 16384
    v_exp_f32 v213, v213
    v_mfma_f32_16x16x32_bf16 v[208:211], a[216:219], v[104:107], v[208:211]
    v_exp_f32 v214, v214
    v_mfma_f32_16x16x32_bf16 v[208:211], a[220:223], v[108:111], v[208:211]
    v_exp_f32 v215, v215
    v_mfma_f32_16x16x32_bf16 a[80:83], a[168:171], v[160:163], a[80:83]
    ds_read_b64_tr_b16 a[180:181], v26 offset:24576
    v_cvt_pk_bf16_f32 v140, v212, v213
    v_mfma_f32_16x16x32_bf16 a[80:83], a[172:175], v[164:167], a[80:83]
    ds_read_b64_tr_b16 a[182:183], v26 offset:28672
    v_mfma_f32_16x16x32_bf16 a[84:87], a[168:171], v[168:171], a[84:87]
    ds_read_b128 a[236:239], v11 offset:45056
    v_cvt_pk_bf16_f32 v141, v214, v215
    v_mfma_f32_16x16x32_bf16 a[84:87], a[172:175], v[172:175], a[84:87]
    s_waitcnt vmcnt(9)
    s_barrier
    v_mfma_f32_16x16x32_bf16 v[212:215], a[208:211], v[112:115], v[204:207]
    v_exp_f32 v208, v208
    v_mfma_f32_16x16x32_bf16 v[212:215], a[212:215], v[116:119], v[212:215]
    s_add_u32 m0, s42, 16384
    v_exp_f32 v209, v209
    v_mfma_f32_16x16x32_bf16 v[212:215], a[216:219], v[120:123], v[212:215]
    v_exp_f32 v210, v210
    v_mfma_f32_16x16x32_bf16 v[212:215], a[220:223], v[124:127], v[212:215]
    v_exp_f32 v211, v211
    v_mfma_f32_16x16x32_bf16 a[88:91], a[168:171], v[176:179], a[88:91]
    ds_read_b64_tr_b16 a[184:185], v27 offset:16384
    v_cvt_pk_bf16_f32 v148, v208, v209
    v_mfma_f32_16x16x32_bf16 a[88:91], a[172:175], v[180:183], a[88:91]
    ds_read_b64_tr_b16 a[186:187], v27 offset:20480
    v_mfma_f32_16x16x32_bf16 a[92:95], a[168:171], v[184:187], a[92:95]
    ds_read_b128 a[208:211], v8 offset:49152
    v_cvt_pk_bf16_f32 v149, v210, v211
    v_mfma_f32_16x16x32_bf16 a[92:95], a[172:175], v[188:191], a[92:95]
    s_waitcnt lgkmcnt(3)
    buffer_load_dwordx4 v36, s[8:11], s40 offen lds
    v_mfma_f32_16x16x32_bf16 v[208:211], a[224:227], v[64:67], v[192:195]
    v_exp_f32 v212, v212
    v_mfma_f32_16x16x32_bf16 v[208:211], a[228:231], v[68:71], v[208:211]
    v_exp_f32 v213, v213
    v_mfma_f32_16x16x32_bf16 v[208:211], a[232:235], v[72:75], v[208:211]
    v_exp_f32 v214, v214
    v_mfma_f32_16x16x32_bf16 v[208:211], a[236:239], v[76:79], v[208:211]
    v_exp_f32 v215, v215
    v_mfma_f32_16x16x32_bf16 a[96:99], a[176:179], v[160:163], a[96:99]
    ds_read_b64_tr_b16 a[188:189], v27 offset:24576
    v_cvt_pk_bf16_f32 v156, v212, v213
    v_mfma_f32_16x16x32_bf16 a[96:99], a[180:183], v[164:167], a[96:99]
    ds_read_b64_tr_b16 a[190:191], v27 offset:28672
    v_mfma_f32_16x16x32_bf16 a[100:103], a[176:179], v[168:171], a[100:103]
    ds_read_b128 a[212:215], v9 offset:49152
    v_cvt_pk_bf16_f32 v157, v214, v215
    v_mfma_f32_16x16x32_bf16 a[100:103], a[180:183], v[172:175], a[100:103]
    buffer_load_dword v218, v57, s[80:83], s39 offen
    v_mfma_f32_16x16x32_bf16 v[212:215], a[224:227], v[80:83], v[196:199]
    v_exp_f32 v208, v208
    v_mfma_f32_16x16x32_bf16 v[212:215], a[228:231], v[84:87], v[212:215]
    v_exp_f32 v209, v209
    v_mfma_f32_16x16x32_bf16 v[212:215], a[232:235], v[88:91], v[212:215]
    v_exp_f32 v210, v210
    v_mfma_f32_16x16x32_bf16 v[212:215], a[236:239], v[92:95], v[212:215]
    v_exp_f32 v211, v211
    v_mfma_f32_16x16x32_bf16 a[104:107], a[176:179], v[176:179], a[104:107]
    ds_read_b64_tr_b16 a[160:161], v20 offset:32768
    v_cvt_pk_bf16_f32 v134, v208, v209
    v_mfma_f32_16x16x32_bf16 a[104:107], a[180:183], v[180:183], a[104:107]
    ds_read_b64_tr_b16 a[162:163], v20 offset:36864
    v_mfma_f32_16x16x32_bf16 a[108:111], a[176:179], v[184:187], a[108:111]
    ds_read_b128 a[216:219], v10 offset:49152
    v_cvt_pk_bf16_f32 v135, v210, v211
    v_mfma_f32_16x16x32_bf16 a[108:111], a[180:183], v[188:191], a[108:111]
    s_waitcnt lgkmcnt(3)
    buffer_load_dwordx4 v37, s[8:11], s40 offen offset:1024 lds
    v_mfma_f32_16x16x32_bf16 v[208:211], a[224:227], v[96:99], v[200:203]
    v_exp_f32 v212, v212
    v_mfma_f32_16x16x32_bf16 v[208:211], a[228:231], v[100:103], v[208:211]
    v_exp_f32 v213, v213
    v_mfma_f32_16x16x32_bf16 v[208:211], a[232:235], v[104:107], v[208:211]
    v_exp_f32 v214, v214
    v_mfma_f32_16x16x32_bf16 v[208:211], a[236:239], v[108:111], v[208:211]
    v_exp_f32 v215, v215
    v_mfma_f32_16x16x32_bf16 a[112:115], a[184:187], v[160:163], a[112:115]
    ds_read_b64_tr_b16 a[164:165], v20 offset:40960
    v_cvt_pk_bf16_f32 v142, v212, v213
    v_mfma_f32_16x16x32_bf16 a[112:115], a[188:191], v[164:167], a[112:115]
    ds_read_b64_tr_b16 a[166:167], v20 offset:45056
    v_mfma_f32_16x16x32_bf16 a[116:119], a[184:187], v[168:171], a[116:119]
    ds_read_b128 a[220:223], v11 offset:49152
    v_cvt_pk_bf16_f32 v143, v214, v215
    v_mfma_f32_16x16x32_bf16 a[116:119], a[188:191], v[172:175], a[116:119]
    buffer_store_dwordx4 v[248:251], v232, s[24:27], s53 offen sc1
    v_mfma_f32_16x16x32_bf16 v[212:215], a[224:227], v[112:115], v[204:207]
    v_exp_f32 v208, v208
    v_mfma_f32_16x16x32_bf16 v[212:215], a[228:231], v[116:119], v[212:215]
    v_exp_f32 v209, v209
    v_mfma_f32_16x16x32_bf16 v[212:215], a[232:235], v[120:123], v[212:215]
    v_exp_f32 v210, v210
    v_mfma_f32_16x16x32_bf16 v[212:215], a[236:239], v[124:127], v[212:215]
    s_add_u32 s53, s53, 656
    v_exp_f32 v211, v211
    v_mfma_f32_16x16x32_bf16 a[120:123], a[184:187], v[176:179], a[120:123]
    ds_read_b64_tr_b16 a[168:169], v21 offset:32768
    v_cvt_pk_bf16_f32 v150, v208, v209
    v_mfma_f32_16x16x32_bf16 a[120:123], a[188:191], v[180:183], a[120:123]
    ds_read_b64_tr_b16 a[170:171], v21 offset:36864
    v_mfma_f32_16x16x32_bf16 a[124:127], a[184:187], v[184:187], a[124:127]
    ds_read_b128 a[224:227], v8 offset:53248
    v_cvt_pk_bf16_f32 v151, v210, v211
    v_mfma_f32_16x16x32_bf16 a[124:127], a[188:191], v[188:191], a[124:127]
    s_waitcnt lgkmcnt(3)
    buffer_load_dwordx4 v38, s[8:11], s40 offen offset:2048 lds
    v_mfma_f32_16x16x32_bf16 v[208:211], a[208:211], v[64:67], v[192:195]
    v_exp_f32 v212, v212
    v_mfma_f32_16x16x32_bf16 v[208:211], a[212:215], v[68:71], v[208:211]
    v_exp_f32 v213, v213
    v_mfma_f32_16x16x32_bf16 v[208:211], a[216:219], v[72:75], v[208:211]
    v_exp_f32 v214, v214
    v_mfma_f32_16x16x32_bf16 v[208:211], a[220:223], v[76:79], v[208:211]
    v_exp_f32 v215, v215
    v_mfma_f32_16x16x32_bf16 a[0:3], a[160:163], v[128:131], a[0:3]
    ds_read_b64_tr_b16 a[172:173], v21 offset:40960
    v_cvt_pk_bf16_f32 v158, v212, v213
    v_mfma_f32_16x16x32_bf16 a[0:3], a[164:167], v[132:135], a[0:3]
    ds_read_b64_tr_b16 a[174:175], v21 offset:45056
    v_mfma_f32_16x16x32_bf16 a[4:7], a[160:163], v[136:139], a[4:7]
    ds_read_b128 a[228:231], v9 offset:53248
    v_cvt_pk_bf16_f32 v159, v214, v215
    v_mfma_f32_16x16x32_bf16 a[4:7], a[164:167], v[140:143], a[4:7]
    v_mfma_f32_16x16x32_bf16 v[212:215], a[208:211], v[80:83], v[196:199]
    v_exp_f32 v208, v208
    v_mfma_f32_16x16x32_bf16 v[212:215], a[212:215], v[84:87], v[212:215]
    v_exp_f32 v209, v209
    v_mfma_f32_16x16x32_bf16 v[212:215], a[216:219], v[88:91], v[212:215]
    v_exp_f32 v210, v210
    v_mfma_f32_16x16x32_bf16 v[212:215], a[220:223], v[92:95], v[212:215]
    v_exp_f32 v211, v211
    v_mfma_f32_16x16x32_bf16 a[8:11], a[160:163], v[144:147], a[8:11]
    ds_read_b64_tr_b16 a[176:177], v22 offset:32768
    v_cvt_pk_bf16_f32 v160, v208, v209
    v_mfma_f32_16x16x32_bf16 a[8:11], a[164:167], v[148:151], a[8:11]
    ds_read_b64_tr_b16 a[178:179], v22 offset:36864
    v_mfma_f32_16x16x32_bf16 a[12:15], a[160:163], v[152:155], a[12:15]
    ds_read_b128 a[232:235], v10 offset:53248
    v_cvt_pk_bf16_f32 v161, v210, v211
    v_mfma_f32_16x16x32_bf16 a[12:15], a[164:167], v[156:159], a[12:15]
    s_waitcnt lgkmcnt(3)
    buffer_load_dwordx4 v39, s[8:11], s40 offen offset:3072 lds
    v_mfma_f32_16x16x32_bf16 v[208:211], a[208:211], v[96:99], v[200:203]
    v_exp_f32 v212, v212
    v_mfma_f32_16x16x32_bf16 v[208:211], a[212:215], v[100:103], v[208:211]
    s_add_u32 s40, s40, 16384
    v_exp_f32 v213, v213
    v_mfma_f32_16x16x32_bf16 v[208:211], a[216:219], v[104:107], v[208:211]
    v_exp_f32 v214, v214
    v_mfma_f32_16x16x32_bf16 v[208:211], a[220:223], v[108:111], v[208:211]
    v_exp_f32 v215, v215
    v_mfma_f32_16x16x32_bf16 a[16:19], a[168:171], v[128:131], a[16:19]
    ds_read_b64_tr_b16 a[180:181], v22 offset:40960
    v_cvt_pk_bf16_f32 v168, v212, v213
    v_mfma_f32_16x16x32_bf16 a[16:19], a[172:175], v[132:135], a[16:19]
    ds_read_b64_tr_b16 a[182:183], v22 offset:45056
    v_mfma_f32_16x16x32_bf16 a[20:23], a[168:171], v[136:139], a[20:23]
    ds_read_b128 a[236:239], v11 offset:53248
    v_cvt_pk_bf16_f32 v169, v214, v215
    v_mfma_f32_16x16x32_bf16 a[20:23], a[172:175], v[140:143], a[20:23]
    v_smfmac_f32_16x16x64_bf16 a[192:195], v[52:55], v[128:135], v50
    v_mfma_f32_16x16x32_bf16 v[212:215], a[208:211], v[112:115], v[204:207]
    v_exp_f32 v208, v208
    v_mfma_f32_16x16x32_bf16 v[212:215], a[212:215], v[116:119], v[212:215]
    s_add_u32 m0, s42, 65536
    v_exp_f32 v209, v209
    v_mfma_f32_16x16x32_bf16 v[212:215], a[216:219], v[120:123], v[212:215]
    v_exp_f32 v210, v210
    v_mfma_f32_16x16x32_bf16 v[212:215], a[220:223], v[124:127], v[212:215]
    v_exp_f32 v211, v211
    v_mfma_f32_16x16x32_bf16 a[24:27], a[168:171], v[144:147], a[24:27]
    ds_read_b64_tr_b16 a[184:185], v23 offset:32768
    v_cvt_pk_bf16_f32 v176, v208, v209
    v_mfma_f32_16x16x32_bf16 a[24:27], a[172:175], v[148:151], a[24:27]
    ds_read_b64_tr_b16 a[186:187], v23 offset:36864
    v_mfma_f32_16x16x32_bf16 a[28:31], a[168:171], v[152:155], a[28:31]
    ds_read_b128 a[208:211], v8 offset:57344
    v_cvt_pk_bf16_f32 v177, v210, v211
    v_mfma_f32_16x16x32_bf16 a[28:31], a[172:175], v[156:159], a[28:31]
    s_waitcnt lgkmcnt(3)
    buffer_load_dwordx4 v40, s[12:15], s41 offen lds
    v_mfma_f32_16x16x32_bf16 v[208:211], a[224:227], v[64:67], v[192:195]
    v_exp_f32 v212, v212
    v_mfma_f32_16x16x32_bf16 v[208:211], a[228:231], v[68:71], v[208:211]
    v_exp_f32 v213, v213
    v_mfma_f32_16x16x32_bf16 v[208:211], a[232:235], v[72:75], v[208:211]
    v_exp_f32 v214, v214
    v_mfma_f32_16x16x32_bf16 v[208:211], a[236:239], v[76:79], v[208:211]
    v_exp_f32 v215, v215
    v_mfma_f32_16x16x32_bf16 a[32:35], a[176:179], v[128:131], a[32:35]
    ds_read_b64_tr_b16 a[188:189], v23 offset:40960
    v_cvt_pk_bf16_f32 v184, v212, v213
    v_mfma_f32_16x16x32_bf16 a[32:35], a[180:183], v[132:135], a[32:35]
    ds_read_b64_tr_b16 a[190:191], v23 offset:45056
    v_mfma_f32_16x16x32_bf16 a[36:39], a[176:179], v[136:139], a[36:39]
    ds_read_b128 a[212:215], v9 offset:57344
    v_cvt_pk_bf16_f32 v185, v214, v215
    v_mfma_f32_16x16x32_bf16 a[36:39], a[180:183], v[140:143], a[36:39]
    v_smfmac_f32_16x16x64_bf16 a[196:199], v[52:55], v[136:143], v50
    v_mfma_f32_16x16x32_bf16 v[212:215], a[224:227], v[80:83], v[196:199]
    v_exp_f32 v208, v208
    v_mfma_f32_16x16x32_bf16 v[212:215], a[228:231], v[84:87], v[212:215]
    v_exp_f32 v209, v209
    v_mfma_f32_16x16x32_bf16 v[212:215], a[232:235], v[88:91], v[212:215]
    v_exp_f32 v210, v210
    v_mfma_f32_16x16x32_bf16 v[212:215], a[236:239], v[92:95], v[212:215]
    v_exp_f32 v211, v211
    v_mfma_f32_16x16x32_bf16 a[40:43], a[176:179], v[144:147], a[40:43]
    ds_read_b64_tr_b16 a[160:161], v24 offset:32768
    v_cvt_pk_bf16_f32 v162, v208, v209
    v_mfma_f32_16x16x32_bf16 a[40:43], a[180:183], v[148:151], a[40:43]
    ds_read_b64_tr_b16 a[162:163], v24 offset:36864
    v_mfma_f32_16x16x32_bf16 a[44:47], a[176:179], v[152:155], a[44:47]
    ds_read_b128 a[216:219], v10 offset:57344
    v_cvt_pk_bf16_f32 v163, v210, v211
    v_mfma_f32_16x16x32_bf16 a[44:47], a[180:183], v[156:159], a[44:47]
    s_waitcnt lgkmcnt(3)
    buffer_load_dwordx4 v41, s[12:15], s41 offen offset:1024 lds
    v_mfma_f32_16x16x32_bf16 v[208:211], a[224:227], v[96:99], v[200:203]
    v_exp_f32 v212, v212
    v_mfma_f32_16x16x32_bf16 v[208:211], a[228:231], v[100:103], v[208:211]
    v_exp_f32 v213, v213
    v_mfma_f32_16x16x32_bf16 v[208:211], a[232:235], v[104:107], v[208:211]
    v_exp_f32 v214, v214
    v_mfma_f32_16x16x32_bf16 v[208:211], a[236:239], v[108:111], v[208:211]
    v_exp_f32 v215, v215
    v_mfma_f32_16x16x32_bf16 a[48:51], a[184:187], v[128:131], a[48:51]
    ds_read_b64_tr_b16 a[164:165], v24 offset:40960
    v_cvt_pk_bf16_f32 v170, v212, v213
    v_mfma_f32_16x16x32_bf16 a[48:51], a[188:191], v[132:135], a[48:51]
    ds_read_b64_tr_b16 a[166:167], v24 offset:45056
    v_mfma_f32_16x16x32_bf16 a[52:55], a[184:187], v[136:139], a[52:55]
    ds_read_b128 a[220:223], v11 offset:57344
    v_cvt_pk_bf16_f32 v171, v214, v215
    v_mfma_f32_16x16x32_bf16 a[52:55], a[188:191], v[140:143], a[52:55]
    v_smfmac_f32_16x16x64_bf16 a[200:203], v[52:55], v[144:151], v50
    v_mfma_f32_16x16x32_bf16 v[212:215], a[224:227], v[112:115], v[204:207]
    v_exp_f32 v208, v208
    v_mfma_f32_16x16x32_bf16 v[212:215], a[228:231], v[116:119], v[212:215]
    v_exp_f32 v209, v209
    v_mfma_f32_16x16x32_bf16 v[212:215], a[232:235], v[120:123], v[212:215]
    v_exp_f32 v210, v210
    v_mfma_f32_16x16x32_bf16 v[212:215], a[236:239], v[124:127], v[212:215]
    v_exp_f32 v211, v211
    v_mfma_f32_16x16x32_bf16 a[56:59], a[184:187], v[144:147], a[56:59]
    ds_read_b64_tr_b16 a[168:169], v25 offset:32768
    v_cvt_pk_bf16_f32 v178, v208, v209
    v_mfma_f32_16x16x32_bf16 a[56:59], a[188:191], v[148:151], a[56:59]
    ds_read_b64_tr_b16 a[170:171], v25 offset:36864
    v_mfma_f32_16x16x32_bf16 a[60:63], a[184:187], v[152:155], a[60:63]
    ds_read_b128 a[224:227], v8 offset:61440
    v_cvt_pk_bf16_f32 v179, v210, v211
    v_mfma_f32_16x16x32_bf16 a[60:63], a[188:191], v[156:159], a[60:63]
    s_waitcnt lgkmcnt(3)
    buffer_load_dwordx4 v40, s[12:15], s41 offen offset:2048 lds
    v_mfma_f32_16x16x32_bf16 v[208:211], a[208:211], v[64:67], v[192:195]
    v_exp_f32 v212, v212
    v_mfma_f32_16x16x32_bf16 v[208:211], a[212:215], v[68:71], v[208:211]
    v_exp_f32 v213, v213
    v_mfma_f32_16x16x32_bf16 v[208:211], a[216:219], v[72:75], v[208:211]
    v_exp_f32 v214, v214
    v_mfma_f32_16x16x32_bf16 v[208:211], a[220:223], v[76:79], v[208:211]
    v_exp_f32 v215, v215
    v_mfma_f32_16x16x32_bf16 a[64:67], a[160:163], v[128:131], a[64:67]
    ds_read_b64_tr_b16 a[172:173], v25 offset:40960
    v_cvt_pk_bf16_f32 v186, v212, v213
    v_mfma_f32_16x16x32_bf16 a[64:67], a[164:167], v[132:135], a[64:67]
    ds_read_b64_tr_b16 a[174:175], v25 offset:45056
    v_mfma_f32_16x16x32_bf16 a[68:71], a[160:163], v[136:139], a[68:71]
    ds_read_b128 a[228:231], v9 offset:61440
    v_cvt_pk_bf16_f32 v187, v214, v215
    v_mfma_f32_16x16x32_bf16 a[68:71], a[164:167], v[140:143], a[68:71]
    v_smfmac_f32_16x16x64_bf16 a[204:207], v[52:55], v[152:159], v50
    v_mfma_f32_16x16x32_bf16 v[212:215], a[208:211], v[80:83], v[196:199]
    v_exp_f32 v208, v208
    v_mfma_f32_16x16x32_bf16 v[212:215], a[212:215], v[84:87], v[212:215]
    v_exp_f32 v209, v209
    v_mfma_f32_16x16x32_bf16 v[212:215], a[216:219], v[88:91], v[212:215]
    v_exp_f32 v210, v210
    v_mfma_f32_16x16x32_bf16 v[212:215], a[220:223], v[92:95], v[212:215]
    v_exp_f32 v211, v211
    v_mfma_f32_16x16x32_bf16 a[72:75], a[160:163], v[144:147], a[72:75]
    ds_read_b64_tr_b16 a[176:177], v26 offset:32768
    v_cvt_pk_bf16_f32 v164, v208, v209
    v_mfma_f32_16x16x32_bf16 a[72:75], a[164:167], v[148:151], a[72:75]
    ds_read_b64_tr_b16 a[178:179], v26 offset:36864
    v_mfma_f32_16x16x32_bf16 a[76:79], a[160:163], v[152:155], a[76:79]
    ds_read_b128 a[232:235], v10 offset:61440
    v_cvt_pk_bf16_f32 v165, v210, v211
    v_mfma_f32_16x16x32_bf16 a[76:79], a[164:167], v[156:159], a[76:79]
    s_waitcnt lgkmcnt(3)
    buffer_load_dwordx4 v41, s[12:15], s41 offen offset:3072 lds
    v_mfma_f32_16x16x32_bf16 v[208:211], a[208:211], v[96:99], v[200:203]
    v_exp_f32 v212, v212
    v_mfma_f32_16x16x32_bf16 v[208:211], a[212:215], v[100:103], v[208:211]
    s_add_u32 s41, s41, 16384
    v_exp_f32 v213, v213
    v_mfma_f32_16x16x32_bf16 v[208:211], a[216:219], v[104:107], v[208:211]
    v_exp_f32 v214, v214
    v_mfma_f32_16x16x32_bf16 v[208:211], a[220:223], v[108:111], v[208:211]
    v_exp_f32 v215, v215
    v_mfma_f32_16x16x32_bf16 a[80:83], a[168:171], v[128:131], a[80:83]
    ds_read_b64_tr_b16 a[180:181], v26 offset:40960
    v_cvt_pk_bf16_f32 v172, v212, v213
    v_mfma_f32_16x16x32_bf16 a[80:83], a[172:175], v[132:135], a[80:83]
    ds_read_b64_tr_b16 a[182:183], v26 offset:45056
    v_mfma_f32_16x16x32_bf16 a[84:87], a[168:171], v[136:139], a[84:87]
    ds_read_b128 a[236:239], v11 offset:61440
    v_cvt_pk_bf16_f32 v173, v214, v215
    v_mfma_f32_16x16x32_bf16 a[84:87], a[172:175], v[140:143], a[84:87]
    s_waitcnt vmcnt(10)
    s_barrier
    v_mfma_f32_16x16x32_bf16 v[212:215], a[208:211], v[112:115], v[204:207]
    v_exp_f32 v208, v208
    v_mfma_f32_16x16x32_bf16 v[212:215], a[212:215], v[116:119], v[212:215]
    s_add_u32 m0, s42, 32768
    v_exp_f32 v209, v209
    v_mfma_f32_16x16x32_bf16 v[212:215], a[216:219], v[120:123], v[212:215]
    v_exp_f32 v210, v210
    v_mfma_f32_16x16x32_bf16 v[212:215], a[220:223], v[124:127], v[212:215]
    v_exp_f32 v211, v211
    v_mfma_f32_16x16x32_bf16 a[88:91], a[168:171], v[144:147], a[88:91]
    ds_read_b64_tr_b16 a[184:185], v27 offset:32768
    v_cvt_pk_bf16_f32 v180, v208, v209
    v_mfma_f32_16x16x32_bf16 a[88:91], a[172:175], v[148:151], a[88:91]
    ds_read_b64_tr_b16 a[186:187], v27 offset:36864
    v_mfma_f32_16x16x32_bf16 a[92:95], a[168:171], v[152:155], a[92:95]
    ds_read_b128 a[208:211], v8 offset:0
    v_cvt_pk_bf16_f32 v181, v210, v211
    v_mfma_f32_16x16x32_bf16 a[92:95], a[172:175], v[156:159], a[92:95]
    s_waitcnt lgkmcnt(3)
    buffer_load_dwordx4 v36, s[8:11], s40 offen lds
    v_mfma_f32_16x16x32_bf16 v[208:211], a[224:227], v[64:67], v[192:195]
    v_exp_f32 v212, v212
    v_mfma_f32_16x16x32_bf16 v[208:211], a[228:231], v[68:71], v[208:211]
    v_exp_f32 v213, v213
    v_mfma_f32_16x16x32_bf16 v[208:211], a[232:235], v[72:75], v[208:211]
    v_exp_f32 v214, v214
    v_mfma_f32_16x16x32_bf16 v[208:211], a[236:239], v[76:79], v[208:211]
    v_exp_f32 v215, v215
    v_mfma_f32_16x16x32_bf16 a[96:99], a[176:179], v[128:131], a[96:99]
    ds_read_b64_tr_b16 a[188:189], v27 offset:40960
    v_cvt_pk_bf16_f32 v188, v212, v213
    v_mfma_f32_16x16x32_bf16 a[96:99], a[180:183], v[132:135], a[96:99]
    ds_read_b64_tr_b16 a[190:191], v27 offset:45056
    v_mfma_f32_16x16x32_bf16 a[100:103], a[176:179], v[136:139], a[100:103]
    ds_read_b128 a[212:215], v9 offset:0
    v_cvt_pk_bf16_f32 v189, v214, v215
    v_mfma_f32_16x16x32_bf16 a[100:103], a[180:183], v[140:143], a[100:103]
    buffer_load_dword v219, v62, s[84:87], s38 offen
    v_mfma_f32_16x16x32_bf16 v[212:215], a[224:227], v[80:83], v[196:199]
    v_exp_f32 v208, v208
    v_mfma_f32_16x16x32_bf16 v[212:215], a[228:231], v[84:87], v[212:215]
    v_exp_f32 v209, v209
    v_mfma_f32_16x16x32_bf16 v[212:215], a[232:235], v[88:91], v[212:215]
    v_exp_f32 v210, v210
    v_mfma_f32_16x16x32_bf16 v[212:215], a[236:239], v[92:95], v[212:215]
    v_exp_f32 v211, v211
    v_mfma_f32_16x16x32_bf16 a[104:107], a[176:179], v[144:147], a[104:107]
    ds_read_b64_tr_b16 a[160:161], v20 offset:49152
    v_cvt_pk_bf16_f32 v166, v208, v209
    v_mfma_f32_16x16x32_bf16 a[104:107], a[180:183], v[148:151], a[104:107]
    ds_read_b64_tr_b16 a[162:163], v20 offset:53248
    v_mfma_f32_16x16x32_bf16 a[108:111], a[176:179], v[152:155], a[108:111]
    ds_read_b128 a[216:219], v10 offset:0
    v_cvt_pk_bf16_f32 v167, v210, v211
    v_mfma_f32_16x16x32_bf16 a[108:111], a[180:183], v[156:159], a[108:111]
    s_waitcnt lgkmcnt(3)
    buffer_load_dwordx4 v37, s[8:11], s40 offen offset:1024 lds
    v_mfma_f32_16x16x32_bf16 v[208:211], a[224:227], v[96:99], v[200:203]
    v_exp_f32 v212, v212
    v_mfma_f32_16x16x32_bf16 v[208:211], a[228:231], v[100:103], v[208:211]
    v_exp_f32 v213, v213
    v_mfma_f32_16x16x32_bf16 v[208:211], a[232:235], v[104:107], v[208:211]
    v_exp_f32 v214, v214
    v_mfma_f32_16x16x32_bf16 v[208:211], a[236:239], v[108:111], v[208:211]
    v_exp_f32 v215, v215
    v_mfma_f32_16x16x32_bf16 a[112:115], a[184:187], v[128:131], a[112:115]
    ds_read_b64_tr_b16 a[164:165], v20 offset:57344
    v_cvt_pk_bf16_f32 v174, v212, v213
    v_mfma_f32_16x16x32_bf16 a[112:115], a[188:191], v[132:135], a[112:115]
    ds_read_b64_tr_b16 a[166:167], v20 offset:61440
    v_mfma_f32_16x16x32_bf16 a[116:119], a[184:187], v[136:139], a[116:119]
    ds_read_b128 a[220:223], v11 offset:0
    v_cvt_pk_bf16_f32 v175, v214, v215
    v_mfma_f32_16x16x32_bf16 a[116:119], a[188:191], v[140:143], a[116:119]
    buffer_load_dword v221, v235, s[20:23], 0 offen
    v_mfma_f32_16x16x32_bf16 v[212:215], a[224:227], v[112:115], v[204:207]
    v_exp_f32 v208, v208
    v_mfma_f32_16x16x32_bf16 v[212:215], a[228:231], v[116:119], v[212:215]
    v_exp_f32 v209, v209
    v_mfma_f32_16x16x32_bf16 v[212:215], a[232:235], v[120:123], v[212:215]
    v_exp_f32 v210, v210
    v_mfma_f32_16x16x32_bf16 v[212:215], a[236:239], v[124:127], v[212:215]
    v_exp_f32 v211, v211
    v_mfma_f32_16x16x32_bf16 a[120:123], a[184:187], v[144:147], a[120:123]
    ds_read_b64_tr_b16 a[168:169], v21 offset:49152
    v_cvt_pk_bf16_f32 v182, v208, v209
    v_mfma_f32_16x16x32_bf16 a[120:123], a[188:191], v[148:151], a[120:123]
    ds_read_b64_tr_b16 a[170:171], v21 offset:53248
    v_add_u32 v235, 2560, v235
    v_mfma_f32_16x16x32_bf16 a[124:127], a[184:187], v[152:155], a[124:127]
    ds_read_b128 a[224:227], v8 offset:4096
    v_cvt_pk_bf16_f32 v183, v210, v211
    v_mfma_f32_16x16x32_bf16 a[124:127], a[188:191], v[156:159], a[124:127]
    s_waitcnt lgkmcnt(3)
    buffer_load_dwordx4 v38, s[8:11], s40 offen offset:2048 lds
    v_mfma_f32_16x16x32_bf16 v[208:211], a[208:211], v[64:67], v[192:195]
    v_exp_f32 v212, v212
    v_mfma_f32_16x16x32_bf16 v[208:211], a[212:215], v[68:71], v[208:211]
    v_exp_f32 v213, v213
    v_mfma_f32_16x16x32_bf16 v[208:211], a[216:219], v[72:75], v[208:211]
    v_exp_f32 v214, v214
    v_mfma_f32_16x16x32_bf16 v[208:211], a[220:223], v[76:79], v[208:211]
    v_exp_f32 v215, v215
    v_mfma_f32_16x16x32_bf16 a[0:3], a[160:163], v[160:163], a[0:3]
    ds_read_b64_tr_b16 a[172:173], v21 offset:57344
    v_cvt_pk_bf16_f32 v190, v212, v213
    v_mfma_f32_16x16x32_bf16 a[0:3], a[164:167], v[164:167], a[0:3]
    ds_read_b64_tr_b16 a[174:175], v21 offset:61440
    v_lshlrev_b32 v244, 16, v240
    v_mfma_f32_16x16x32_bf16 a[4:7], a[160:163], v[168:171], a[4:7]
    ds_read_b128 a[228:231], v9 offset:4096
    v_cvt_pk_bf16_f32 v191, v214, v215
    v_mfma_f32_16x16x32_bf16 a[4:7], a[164:167], v[172:175], a[4:7]
    v_and_b32 v245, 0xffff0000, v240
    v_fmac_f32 v224, v2, v244
    v_mfma_f32_16x16x32_bf16 v[212:215], a[208:211], v[80:83], v[196:199]
    v_exp_f32 v208, v208
    v_mfma_f32_16x16x32_bf16 v[212:215], a[212:215], v[84:87], v[212:215]
    v_exp_f32 v209, v209
    v_mfma_f32_16x16x32_bf16 v[212:215], a[216:219], v[88:91], v[212:215]
    v_exp_f32 v210, v210
    v_mfma_f32_16x16x32_bf16 v[212:215], a[220:223], v[92:95], v[212:215]
    v_exp_f32 v211, v211
    v_mfma_f32_16x16x32_bf16 a[8:11], a[160:163], v[176:179], a[8:11]
    ds_read_b64_tr_b16 a[176:177], v22 offset:49152
    v_cvt_pk_bf16_f32 v128, v208, v209
    v_mfma_f32_16x16x32_bf16 a[8:11], a[164:167], v[180:183], a[8:11]
    ds_read_b64_tr_b16 a[178:179], v22 offset:53248
    v_fmac_f32 v225, v2, v245
    v_mfma_f32_16x16x32_bf16 a[12:15], a[160:163], v[184:187], a[12:15]
    ds_read_b128 a[232:235], v10 offset:4096
    v_cvt_pk_bf16_f32 v129, v210, v211
    v_mfma_f32_16x16x32_bf16 a[12:15], a[164:167], v[188:191], a[12:15]
    s_waitcnt lgkmcnt(3)
    buffer_load_dwordx4 v39, s[8:11], s40 offen offset:3072 lds
    v_mfma_f32_16x16x32_bf16 v[208:211], a[208:211], v[96:99], v[200:203]
Ltour5:
    s_cbranch_execz Ltour9
    v_exp_f32 v212, v212
    v_mfma_f32_16x16x32_bf16 v[208:211], a[212:215], v[100:103], v[208:211]
    s_add_u32 s40, s40, 16384
    v_exp_f32 v213, v213
    v_mfma_f32_16x16x32_bf16 v[208:211], a[216:219], v[104:107], v[208:211]
    v_exp_f32 v214, v214
    v_mfma_f32_16x16x32_bf16 v[208:211], a[220:223], v[108:111], v[208:211]
    v_exp_f32 v215, v215
    v_mfma_f32_16x16x32_bf16 a[16:19], a[168:171], v[160:163], a[16:19]
    ds_read_b64_tr_b16 a[180:181], v22 offset:57344
    v_cvt_pk_bf16_f32 v136, v212, v213
    v_mfma_f32_16x16x32_bf16 a[16:19], a[172:175], v[164:167], a[16:19]
    ds_read_b64_tr_b16 a[182:183], v22 offset:61440
    v_lshlrev_b32 v246, 16, v241
    v_mfma_f32_16x16x32_bf16 a[20:23], a[168:171], v[168:171], a[20:23]
    ds_read_b128 a[236:239], v11 offset:4096
    v_cvt_pk_bf16_f32 v137, v214, v215
    v_mfma_f32_16x16x32_bf16 a[20:23], a[172:175], v[172:175], a[20:23]
    v_and_b32 v247, 0xffff0000, v241
    v_fmac_f32 v226, v2, v246
    v_smfmac_f32_16x16x64_bf16 a[192:195], v[52:55], v[160:167], v50
    v_mfma_f32_16x16x32_bf16 v[212:215], a[208:211], v[112:115], v[204:207]
    v_exp_f32 v208, v208
    v_mfma_f32_16x16x32_bf16 v[212:215], a[212:215], v[116:119], v[212:215]
    s_add_u32 m0, s42, 81920
    v_exp_f32 v209, v209
    v_mfma_f32_16x16x32_bf16 v[212:215], a[216:219], v[120:123], v[212:215]
    v_exp_f32 v210, v210
    v_mfma_f32_16x16x32_bf16 v[212:215], a[220:223], v[124:127], v[212:215]
    v_exp_f32 v211, v211
    v_mfma_f32_16x16x32_bf16 a[24:27], a[168:171], v[176:179], a[24:27]
    ds_read_b64_tr_b16 a[184:185], v23 offset:49152
    v_cvt_pk_bf16_f32 v144, v208, v209
    v_mfma_f32_16x16x32_bf16 a[24:27], a[172:175], v[180:183], a[24:27]
    ds_read_b64_tr_b16 a[186:187], v23 offset:53248
    v_fmac_f32 v227, v2, v247
    v_mfma_f32_16x16x32_bf16 a[28:31], a[168:171], v[184:187], a[28:31]
    ds_read_b128 a[208:211], v8 offset:8192
    v_cvt_pk_bf16_f32 v145, v210, v211
    v_mfma_f32_16x16x32_bf16 a[28:31], a[172:175], v[188:191], a[28:31]
    s_waitcnt lgkmcnt(3)
    buffer_load_dwordx4 v40, s[12:15], s41 offen lds
    v_mfma_f32_16x16x32_bf16 v[208:211], a[224:227], v[64:67], v[192:195]
    v_exp_f32 v212, v212
    v_mfma_f32_16x16x32_bf16 v[208:211], a[228:231], v[68:71], v[208:211]
    v_exp_f32 v213, v213
    v_mfma_f32_16x16x32_bf16 v[208:211], a[232:235], v[72:75], v[208:211]
    v_exp_f32 v214, v214
    v_mfma_f32_16x16x32_bf16 v[208:211], a[236:239], v[76:79], v[208:211]
    v_exp_f32 v215, v215
    v_mfma_f32_16x16x32_bf16 a[32:35], a[176:179], v[160:163], a[32:35]
    ds_read_b64_tr_b16 a[188:189], v23 offset:57344
    v_cvt_pk_bf16_f32 v152, v212, v213
    v_mfma_f32_16x16x32_bf16 a[32:35], a[180:183], v[164:167], a[32:35]
    ds_read_b64_tr_b16 a[190:191], v23 offset:61440
    v_lshlrev_b32 v244, 16, v242
    v_mfma_f32_16x16x32_bf16 a[36:39], a[176:179], v[168:171], a[36:39]
    ds_read_b128 a[212:215], v9 offset:8192
    v_cvt_pk_bf16_f32 v153, v214, v215
    v_mfma_f32_16x16x32_bf16 a[36:39], a[180:183], v[172:175], a[36:39]
    v_and_b32 v245, 0xffff0000, v242
    v_fmac_f32 v228, v2, v244
    v_smfmac_f32_16x16x64_bf16 a[196:199], v[52:55], v[168:175], v50
    v_mfma_f32_16x16x32_bf16 v[212:215], a[224:227], v[80:83], v[196:199]
    v_exp_f32 v208, v208
    v_mfma_f32_16x16x32_bf16 v[212:215], a[228:231], v[84:87], v[212:215]
    v_exp_f32 v209, v209
    v_mfma_f32_16x16x32_bf16 v[212:215], a[232:235], v[88:91], v[212:215]
    v_exp_f32 v210, v210
    v_mfma_f32_16x16x32_bf16 v[212:215], a[236:239], v[92:95], v[212:215]
    v_exp_f32 v211, v211
    v_mfma_f32_16x16x32_bf16 a[40:43], a[176:179], v[176:179], a[40:43]
    ds_read_b64_tr_b16 a[160:161], v24 offset:49152
    v_cvt_pk_bf16_f32 v130, v208, v209
    v_mfma_f32_16x16x32_bf16 a[40:43], a[180:183], v[180:183], a[40:43]
    ds_read_b64_tr_b16 a[162:163], v24 offset:53248
    v_fmac_f32 v229, v2, v245
    v_mfma_f32_16x16x32_bf16 a[44:47], a[176:179], v[184:187], a[44:47]
    ds_read_b128 a[216:219], v10 offset:8192
    v_cvt_pk_bf16_f32 v131, v210, v211
    v_mfma_f32_16x16x32_bf16 a[44:47], a[180:183], v[188:191], a[44:47]
    s_waitcnt lgkmcnt(3)
    buffer_load_dwordx4 v41, s[12:15], s41 offen offset:1024 lds
    v_mfma_f32_16x16x32_bf16 v[208:211], a[224:227], v[96:99], v[200:203]
    v_exp_f32 v212, v212
    v_mfma_f32_16x16x32_bf16 v[208:211], a[228:231], v[100:103], v[208:211]
    v_exp_f32 v213, v213
    v_mfma_f32_16x16x32_bf16 v[208:211], a[232:235], v[104:107], v[208:211]
    v_exp_f32 v214, v214
    v_mfma_f32_16x16x32_bf16 v[208:211], a[236:239], v[108:111], v[208:211]
    v_exp_f32 v215, v215
    v_mfma_f32_16x16x32_bf16 a[48:51], a[184:187], v[160:163], a[48:51]
    ds_read_b64_tr_b16 a[164:165], v24 offset:57344
    v_cvt_pk_bf16_f32 v138, v212, v213
    v_mfma_f32_16x16x32_bf16 a[48:51], a[188:191], v[164:167], a[48:51]
    ds_read_b64_tr_b16 a[166:167], v24 offset:61440
    v_lshlrev_b32 v246, 16, v243
    v_mfma_f32_16x16x32_bf16 a[52:55], a[184:187], v[168:171], a[52:55]
    ds_read_b128 a[220:223], v11 offset:8192
    v_cvt_pk_bf16_f32 v139, v214, v215
    v_mfma_f32_16x16x32_bf16 a[52:55], a[188:191], v[172:175], a[52:55]
    v_and_b32 v247, 0xffff0000, v243
    v_fmac_f32 v230, v2, v246
    v_smfmac_f32_16x16x64_bf16 a[200:203], v[52:55], v[176:183], v50
    v_mfma_f32_16x16x32_bf16 v[212:215], a[224:227], v[112:115], v[204:207]
    v_exp_f32 v208, v208
    v_mfma_f32_16x16x32_bf16 v[212:215], a[228:231], v[116:119], v[212:215]
    v_exp_f32 v209, v209
    v_mfma_f32_16x16x32_bf16 v[212:215], a[232:235], v[120:123], v[212:215]
    v_exp_f32 v210, v210
    v_mfma_f32_16x16x32_bf16 v[212:215], a[236:239], v[124:127], v[212:215]
    v_exp_f32 v211, v211
    v_mfma_f32_16x16x32_bf16 a[56:59], a[184:187], v[176:179], a[56:59]
    ds_read_b64_tr_b16 a[168:169], v25 offset:49152
    v_cvt_pk_bf16_f32 v146, v208, v209
    v_mfma_f32_16x16x32_bf16 a[56:59], a[188:191], v[180:183], a[56:59]
    ds_read_b64_tr_b16 a[170:171], v25 offset:53248
    v_fmac_f32 v231, v2, v247
    v_mfma_f32_16x16x32_bf16 a[60:63], a[184:187], v[184:187], a[60:63]
    ds_read_b128 a[224:227], v8 offset:12288
    v_cvt_pk_bf16_f32 v147, v210, v211
    v_mfma_f32_16x16x32_bf16 a[60:63], a[188:191], v[188:191], a[60:63]
    s_waitcnt lgkmcnt(3)
    buffer_load_dwordx4 v40, s[12:15], s41 offen offset:2048 lds
    v_mfma_f32_16x16x32_bf16 v[208:211], a[208:211], v[64:67], v[192:195]
    v_exp_f32 v212, v212
    v_mfma_f32_16x16x32_bf16 v[208:211], a[212:215], v[68:71], v[208:211]
    v_exp_f32 v213, v213
    v_mfma_f32_16x16x32_bf16 v[208:211], a[216:219], v[72:75], v[208:211]
    v_exp_f32 v214, v214
    v_mfma_f32_16x16x32_bf16 v[208:211], a[220:223], v[76:79], v[208:211]
    v_exp_f32 v215, v215
    v_mfma_f32_16x16x32_bf16 a[64:67], a[160:163], v[160:163], a[64:67]
    ds_read_b64_tr_b16 a[172:173], v25 offset:57344
    v_cvt_pk_bf16_f32 v154, v212, v213
    v_mfma_f32_16x16x32_bf16 a[64:67], a[164:167], v[164:167], a[64:67]
    ds_read_b64_tr_b16 a[174:175], v25 offset:61440
    v_mov_b32 v2, v3
    v_mfma_f32_16x16x32_bf16 a[68:71], a[160:163], v[168:171], a[68:71]
    ds_read_b128 a[228:231], v9 offset:12288
    v_cvt_pk_bf16_f32 v155, v214, v215
    v_mfma_f32_16x16x32_bf16 a[68:71], a[164:167], v[172:175], a[68:71]
    v_mov_b32 v3, v4
    v_mov_b32 v4, v5
    v_smfmac_f32_16x16x64_bf16 a[204:207], v[52:55], v[184:191], v50
    v_mfma_f32_16x16x32_bf16 v[212:215], a[208:211], v[80:83], v[196:199]
    v_exp_f32 v208, v208
    v_mfma_f32_16x16x32_bf16 v[212:215], a[212:215], v[84:87], v[212:215]
    v_exp_f32 v209, v209
    v_mfma_f32_16x16x32_bf16 v[212:215], a[216:219], v[88:91], v[212:215]
    v_exp_f32 v210, v210
    v_mfma_f32_16x16x32_bf16 v[212:215], a[220:223], v[92:95], v[212:215]
    v_exp_f32 v211, v211
    v_mfma_f32_16x16x32_bf16 a[72:75], a[160:163], v[176:179], a[72:75]
    ds_read_b64_tr_b16 a[176:177], v26 offset:49152
    v_cvt_pk_bf16_f32 v132, v208, v209
    v_mfma_f32_16x16x32_bf16 a[72:75], a[164:167], v[180:183], a[72:75]
    ds_read_b64_tr_b16 a[178:179], v26 offset:53248
    v_mov_b32 v5, v6
    v_mfma_f32_16x16x32_bf16 a[76:79], a[160:163], v[184:187], a[76:79]
    ds_read_b128 a[232:235], v10 offset:12288
    v_cvt_pk_bf16_f32 v133, v210, v211
    v_mfma_f32_16x16x32_bf16 a[76:79], a[164:167], v[188:191], a[76:79]
    s_waitcnt lgkmcnt(3)
    buffer_load_dwordx4 v41, s[12:15], s41 offen offset:3072 lds
    v_mfma_f32_16x16x32_bf16 v[208:211], a[208:211], v[96:99], v[200:203]
    v_exp_f32 v212, v212
    v_mfma_f32_16x16x32_bf16 v[208:211], a[212:215], v[100:103], v[208:211]
    s_add_u32 s41, s41, 16384
    v_exp_f32 v213, v213
    v_mfma_f32_16x16x32_bf16 v[208:211], a[216:219], v[104:107], v[208:211]
    v_exp_f32 v214, v214
    v_mfma_f32_16x16x32_bf16 v[208:211], a[220:223], v[108:111], v[208:211]
    v_exp_f32 v215, v215
    v_mfma_f32_16x16x32_bf16 a[80:83], a[168:171], v[160:163], a[80:83]
    ds_read_b64_tr_b16 a[180:181], v26 offset:57344
    v_cvt_pk_bf16_f32 v140, v212, v213
    v_mfma_f32_16x16x32_bf16 a[80:83], a[172:175], v[164:167], a[80:83]
    ds_read_b64_tr_b16 a[182:183], v26 offset:61440
    v_mfma_f32_16x16x32_bf16 a[84:87], a[168:171], v[168:171], a[84:87]
    ds_read_b128 a[236:239], v11 offset:12288
    v_cvt_pk_bf16_f32 v141, v214, v215
    v_mfma_f32_16x16x32_bf16 a[84:87], a[172:175], v[172:175], a[84:87]
    s_waitcnt vmcnt(10)
    s_barrier
    v_mfma_f32_16x16x32_bf16 v[212:215], a[208:211], v[112:115], v[204:207]
    v_exp_f32 v208, v208
    v_mfma_f32_16x16x32_bf16 v[212:215], a[212:215], v[116:119], v[212:215]
    s_add_u32 m0, s42, 49152
    v_exp_f32 v209, v209
    v_mfma_f32_16x16x32_bf16 v[212:215], a[216:219], v[120:123], v[212:215]
    v_exp_f32 v210, v210
    v_mfma_f32_16x16x32_bf16 v[212:215], a[220:223], v[124:127], v[212:215]
    v_exp_f32 v211, v211
    v_mfma_f32_16x16x32_bf16 a[88:91], a[168:171], v[176:179], a[88:91]
    ds_read_b64_tr_b16 a[184:185], v27 offset:49152
    v_cvt_pk_bf16_f32 v148, v208, v209
    v_mfma_f32_16x16x32_bf16 a[88:91], a[172:175], v[180:183], a[88:91]
    ds_read_b64_tr_b16 a[186:187], v27 offset:53248
    v_mfma_f32_16x16x32_bf16 a[92:95], a[168:171], v[184:187], a[92:95]
    ds_read_b128 a[208:211], v8 offset:16384
    v_cvt_pk_bf16_f32 v149, v210, v211
    v_mfma_f32_16x16x32_bf16 a[92:95], a[172:175], v[188:191], a[92:95]
    s_waitcnt lgkmcnt(3)
    buffer_load_dwordx4 v36, s[8:11], s40 offen lds
    v_mfma_f32_16x16x32_bf16 v[208:211], a[224:227], v[64:67], v[192:195]
    v_exp_f32 v212, v212
    v_mfma_f32_16x16x32_bf16 v[208:211], a[228:231], v[68:71], v[208:211]
    v_exp_f32 v213, v213
    v_mfma_f32_16x16x32_bf16 v[208:211], a[232:235], v[72:75], v[208:211]
    v_exp_f32 v214, v214
    v_mfma_f32_16x16x32_bf16 v[208:211], a[236:239], v[76:79], v[208:211]
    v_exp_f32 v215, v215
    v_mfma_f32_16x16x32_bf16 a[96:99], a[176:179], v[160:163], a[96:99]
    ds_read_b64_tr_b16 a[188:189], v27 offset:57344
    v_cvt_pk_bf16_f32 v156, v212, v213
    v_mfma_f32_16x16x32_bf16 a[96:99], a[180:183], v[164:167], a[96:99]
    ds_read_b64_tr_b16 a[190:191], v27 offset:61440
    v_mfma_f32_16x16x32_bf16 a[100:103], a[176:179], v[168:171], a[100:103]
    ds_read_b128 a[212:215], v9 offset:16384
    v_cvt_pk_bf16_f32 v157, v214, v215
    v_mfma_f32_16x16x32_bf16 a[100:103], a[180:183], v[172:175], a[100:103]
    buffer_load_dword v216, v237, s[28:31], s52 offen
    v_mfma_f32_16x16x32_bf16 v[212:215], a[224:227], v[80:83], v[196:199]
    v_exp_f32 v208, v208
    v_mfma_f32_16x16x32_bf16 v[212:215], a[228:231], v[84:87], v[212:215]
    s_sub_u32 s39, s39, 36864
    v_exp_f32 v209, v209
    v_mfma_f32_16x16x32_bf16 v[212:215], a[232:235], v[88:91], v[212:215]
    s_sub_u32 s38, s38, 4608
    v_exp_f32 v210, v210
    v_mfma_f32_16x16x32_bf16 v[212:215], a[236:239], v[92:95], v[212:215]
    s_add_u32 s52, s52, 2304
    v_exp_f32 v211, v211
    v_mfma_f32_16x16x32_bf16 a[104:107], a[176:179], v[176:179], a[104:107]
    ds_read_b64_tr_b16 a[160:161], v20 offset:0
    v_cvt_pk_bf16_f32 v134, v208, v209
    v_mfma_f32_16x16x32_bf16 a[104:107], a[180:183], v[180:183], a[104:107]
    ds_read_b64_tr_b16 a[162:163], v20 offset:4096
    v_mfma_f32_16x16x32_bf16 a[108:111], a[176:179], v[184:187], a[108:111]
    ds_read_b128 a[216:219], v10 offset:16384
    v_cvt_pk_bf16_f32 v135, v210, v211
    v_mfma_f32_16x16x32_bf16 a[108:111], a[180:183], v[188:191], a[108:111]
    s_waitcnt lgkmcnt(3)
    buffer_load_dwordx4 v37, s[8:11], s40 offen offset:1024 lds
    v_mfma_f32_16x16x32_bf16 v[208:211], a[224:227], v[96:99], v[200:203]
    v_exp_f32 v212, v212
    v_mfma_f32_16x16x32_bf16 v[208:211], a[228:231], v[100:103], v[208:211]
    v_exp_f32 v213, v213
    v_mfma_f32_16x16x32_bf16 v[208:211], a[232:235], v[104:107], v[208:211]
    v_exp_f32 v214, v214
    v_mfma_f32_16x16x32_bf16 v[208:211], a[236:239], v[108:111], v[208:211]
    v_exp_f32 v215, v215
    v_mfma_f32_16x16x32_bf16 a[112:115], a[184:187], v[160:163], a[112:115]
    ds_read_b64_tr_b16 a[164:165], v20 offset:8192
    v_cvt_pk_bf16_f32 v142, v212, v213
    v_mfma_f32_16x16x32_bf16 a[112:115], a[188:191], v[164:167], a[112:115]
    ds_read_b64_tr_b16 a[166:167], v20 offset:12288
    v_mfma_f32_16x16x32_bf16 a[116:119], a[184:187], v[168:171], a[116:119]
    ds_read_b128 a[220:223], v11 offset:16384
    v_cvt_pk_bf16_f32 v143, v214, v215
    v_mfma_f32_16x16x32_bf16 a[116:119], a[188:191], v[172:175], a[116:119]
    v_mfma_f32_16x16x32_bf16 v[212:215], a[224:227], v[112:115], v[204:207]
    v_exp_f32 v208, v208
    v_mfma_f32_16x16x32_bf16 v[212:215], a[228:231], v[116:119], v[212:215]
    v_exp_f32 v209, v209
    v_mfma_f32_16x16x32_bf16 v[212:215], a[232:235], v[120:123], v[212:215]
    v_exp_f32 v210, v210
    v_mfma_f32_16x16x32_bf16 v[212:215], a[236:239], v[124:127], v[212:215]
    v_exp_f32 v211, v211
    v_mfma_f32_16x16x32_bf16 a[120:123], a[184:187], v[176:179], a[120:123]
    ds_read_b64_tr_b16 a[168:169], v21 offset:0
    v_cvt_pk_bf16_f32 v150, v208, v209
    v_mfma_f32_16x16x32_bf16 a[120:123], a[188:191], v[180:183], a[120:123]
    ds_read_b64_tr_b16 a[170:171], v21 offset:4096
    v_mfma_f32_16x16x32_bf16 a[124:127], a[184:187], v[184:187], a[124:127]
    ds_read_b128 a[224:227], v8 offset:20480
    v_cvt_pk_bf16_f32 v151, v210, v211
    v_mfma_f32_16x16x32_bf16 a[124:127], a[188:191], v[188:191], a[124:127]
    s_waitcnt lgkmcnt(3)
    buffer_load_dwordx4 v38, s[8:11], s40 offen offset:2048 lds
    s_sub_u32 s43, s43, 1
    s_cmp_lg_u32 s43, 0
    s_cbranch_scc1 Lattn_loop
    v_mfma_f32_16x16x32_bf16 v[208:211], a[208:211], v[64:67], v[192:195]
    s_lshl_b32 s38, s3, 6
    v_exp_f32 v212, v212
    v_mfma_f32_16x16x32_bf16 v[208:211], a[212:215], v[68:71], v[208:211]
    s_add_u32 s38, s38, 131136
    v_exp_f32 v213, v213
    v_mfma_f32_16x16x32_bf16 v[208:211], a[216:219], v[72:75], v[208:211]
    v_exp_f32 v214, v214
    v_mfma_f32_16x16x32_bf16 v[208:211], a[220:223], v[76:79], v[208:211]
    s_add_u32 s57, s58, 0
    v_exp_f32 v215, v215
    v_mfma_f32_16x16x32_bf16 a[0:3], a[160:163], v[128:131], a[0:3]
    ds_read_b64_tr_b16 a[172:173], v21 offset:8192
    v_cvt_pk_bf16_f32 v158, v212, v213
    v_mfma_f32_16x16x32_bf16 a[0:3], a[164:167], v[132:135], a[0:3]
    ds_read_b64_tr_b16 a[174:175], v21 offset:12288
    v_permlane32_swap_b32 v224, v228
    v_mfma_f32_16x16x32_bf16 a[4:7], a[160:163], v[136:139], a[4:7]
    ds_read_b128 a[228:231], v9 offset:20480
    v_cvt_pk_bf16_f32 v159, v214, v215
    v_mfma_f32_16x16x32_bf16 a[4:7], a[164:167], v[140:143], a[4:7]
    buffer_load_dwordx4 a[128:131], v254, s[80:83], s57 offen
    v_mfma_f32_16x16x32_bf16 v[212:215], a[208:211], v[80:83], v[196:199]
    v_exp_f32 v208, v208
    v_mfma_f32_16x16x32_bf16 v[212:215], a[212:215], v[84:87], v[212:215]
    v_exp_f32 v209, v209
    v_mfma_f32_16x16x32_bf16 v[212:215], a[216:219], v[88:91], v[212:215]
    v_exp_f32 v210, v210
    v_mfma_f32_16x16x32_bf16 v[212:215], a[220:223], v[92:95], v[212:215]
    v_exp_f32 v211, v211
    v_mfma_f32_16x16x32_bf16 a[8:11], a[160:163], v[144:147], a[8:11]
    ds_read_b64_tr_b16 a[176:177], v22 offset:0
    v_cvt_pk_bf16_f32 v160, v208, v209
    v_mfma_f32_16x16x32_bf16 a[8:11], a[164:167], v[148:151], a[8:11]
    ds_read_b64_tr_b16 a[178:179], v22 offset:4096
    v_permlane32_swap_b32 v225, v229
    v_mfma_f32_16x16x32_bf16 a[12:15], a[160:163], v[152:155], a[12:15]
    ds_read_b128 a[232:235], v10 offset:20480
    v_cvt_pk_bf16_f32 v161, v210, v211
    v_mfma_f32_16x16x32_bf16 a[12:15], a[164:167], v[156:159], a[12:15]
    s_waitcnt lgkmcnt(3)
    buffer_load_dwordx4 v39, s[8:11], s40 offen offset:3072 lds
    v_mfma_f32_16x16x32_bf16 v[208:211], a[208:211], v[96:99], v[200:203]
    v_exp_f32 v212, v212
    v_mfma_f32_16x16x32_bf16 v[208:211], a[212:215], v[100:103], v[208:211]
    s_add_u32 s40, s40, 16384
    v_exp_f32 v213, v213
    v_mfma_f32_16x16x32_bf16 v[208:211], a[216:219], v[104:107], v[208:211]
    v_exp_f32 v214, v214
    v_mfma_f32_16x16x32_bf16 v[208:211], a[220:223], v[108:111], v[208:211]
    v_exp_f32 v215, v215
    v_mfma_f32_16x16x32_bf16 a[16:19], a[168:171], v[128:131], a[16:19]
    ds_read_b64_tr_b16 a[180:181], v22 offset:8192
    v_cvt_pk_bf16_f32 v168, v212, v213
    v_mfma_f32_16x16x32_bf16 a[16:19], a[172:175], v[132:135], a[16:19]
    ds_read_b64_tr_b16 a[182:183], v22 offset:12288
    v_permlane32_swap_b32 v226, v230
    v_mfma_f32_16x16x32_bf16 a[20:23], a[168:171], v[136:139], a[20:23]
    ds_read_b128 a[236:239], v11 offset:20480
    v_cvt_pk_bf16_f32 v169, v214, v215
    v_mfma_f32_16x16x32_bf16 a[20:23], a[172:175], v[140:143], a[20:23]
    v_permlane32_swap_b32 v227, v231
    v_add_f32 v224, v224, v228
    v_smfmac_f32_16x16x64_bf16 a[192:195], v[52:55], v[128:135], v50
    v_mfma_f32_16x16x32_bf16 v[212:215], a[208:211], v[112:115], v[204:207]
    v_exp_f32 v208, v208
    v_mfma_f32_16x16x32_bf16 v[212:215], a[212:215], v[116:119], v[212:215]
    s_add_u32 m0, s42, 98304
    v_exp_f32 v209, v209
    v_mfma_f32_16x16x32_bf16 v[212:215], a[216:219], v[120:123], v[212:215]
    v_exp_f32 v210, v210
    v_mfma_f32_16x16x32_bf16 v[212:215], a[220:223], v[124:127], v[212:215]
    v_exp_f32 v211, v211
    v_mfma_f32_16x16x32_bf16 a[24:27], a[168:171], v[144:147], a[24:27]
    ds_read_b64_tr_b16 a[184:185], v23 offset:0
    v_cvt_pk_bf16_f32 v176, v208, v209
    v_mfma_f32_16x16x32_bf16 a[24:27], a[172:175], v[148:151], a[24:27]
    ds_read_b64_tr_b16 a[186:187], v23 offset:4096
    v_add_f32 v225, v225, v229
    v_mfma_f32_16x16x32_bf16 a[28:31], a[168:171], v[152:155], a[28:31]
    ds_read_b128 a[208:211], v8 offset:24576
    v_cvt_pk_bf16_f32 v177, v210, v211
    v_mfma_f32_16x16x32_bf16 a[28:31], a[172:175], v[156:159], a[28:31]
    s_waitcnt lgkmcnt(3)
    buffer_load_dwordx4 v40, s[12:15], s41 offen lds
    v_mfma_f32_16x16x32_bf16 v[208:211], a[224:227], v[64:67], v[192:195]
    v_exp_f32 v212, v212
    v_mfma_f32_16x16x32_bf16 v[208:211], a[228:231], v[68:71], v[208:211]
    v_exp_f32 v213, v213
    v_mfma_f32_16x16x32_bf16 v[208:211], a[232:235], v[72:75], v[208:211]
    v_exp_f32 v214, v214
    v_mfma_f32_16x16x32_bf16 v[208:211], a[236:239], v[76:79], v[208:211]
    s_add_u32 s57, s58, 589824
    v_exp_f32 v215, v215
    v_mfma_f32_16x16x32_bf16 a[32:35], a[176:179], v[128:131], a[32:35]
    ds_read_b64_tr_b16 a[188:189], v23 offset:8192
    v_cvt_pk_bf16_f32 v184, v212, v213
    v_mfma_f32_16x16x32_bf16 a[32:35], a[180:183], v[132:135], a[32:35]
    ds_read_b64_tr_b16 a[190:191], v23 offset:12288
    v_add_f32 v226, v226, v230
    v_mfma_f32_16x16x32_bf16 a[36:39], a[176:179], v[136:139], a[36:39]
    ds_read_b128 a[212:215], v9 offset:24576
    v_cvt_pk_bf16_f32 v185, v214, v215
    v_mfma_f32_16x16x32_bf16 a[36:39], a[180:183], v[140:143], a[36:39]
    buffer_load_dwordx4 a[132:135], v254, s[80:83], s57 offen
    v_smfmac_f32_16x16x64_bf16 a[196:199], v[52:55], v[136:143], v50
    v_mfma_f32_16x16x32_bf16 v[212:215], a[224:227], v[80:83], v[196:199]
    v_exp_f32 v208, v208
    v_mfma_f32_16x16x32_bf16 v[212:215], a[228:231], v[84:87], v[212:215]
    v_exp_f32 v209, v209
    v_mfma_f32_16x16x32_bf16 v[212:215], a[232:235], v[88:91], v[212:215]
    v_exp_f32 v210, v210
    v_mfma_f32_16x16x32_bf16 v[212:215], a[236:239], v[92:95], v[212:215]
    v_exp_f32 v211, v211
    v_mfma_f32_16x16x32_bf16 a[40:43], a[176:179], v[144:147], a[40:43]
    ds_read_b64_tr_b16 a[160:161], v24 offset:0
    v_cvt_pk_bf16_f32 v162, v208, v209
    v_mfma_f32_16x16x32_bf16 a[40:43], a[180:183], v[148:151], a[40:43]
    ds_read_b64_tr_b16 a[162:163], v24 offset:4096
    v_add_f32 v227, v227, v231
    v_mfma_f32_16x16x32_bf16 a[44:47], a[176:179], v[152:155], a[44:47]
    ds_read_b128 a[216:219], v10 offset:24576
    v_cvt_pk_bf16_f32 v163, v210, v211
    v_mfma_f32_16x16x32_bf16 a[44:47], a[180:183], v[156:159], a[44:47]
    s_waitcnt lgkmcnt(3)
    buffer_load_dwordx4 v41, s[12:15], s41 offen offset:1024 lds
    v_mfma_f32_16x16x32_bf16 v[208:211], a[224:227], v[96:99], v[200:203]
    v_exp_f32 v212, v212
    v_mfma_f32_16x16x32_bf16 v[208:211], a[228:231], v[100:103], v[208:211]
    v_exp_f32 v213, v213
    v_mfma_f32_16x16x32_bf16 v[208:211], a[232:235], v[104:107], v[208:211]
    v_exp_f32 v214, v214
    v_mfma_f32_16x16x32_bf16 v[208:211], a[236:239], v[108:111], v[208:211]
    v_exp_f32 v215, v215
    v_mfma_f32_16x16x32_bf16 a[48:51], a[184:187], v[128:131], a[48:51]
    ds_read_b64_tr_b16 a[164:165], v24 offset:8192
    v_cvt_pk_bf16_f32 v170, v212, v213
    v_mfma_f32_16x16x32_bf16 a[48:51], a[188:191], v[132:135], a[48:51]
    ds_read_b64_tr_b16 a[166:167], v24 offset:12288
    v_and_b32 v244, 1, v1
    v_mfma_f32_16x16x32_bf16 a[52:55], a[184:187], v[136:139], a[52:55]
    ds_read_b128 a[220:223], v11 offset:24576
    v_cvt_pk_bf16_f32 v171, v214, v215
    v_mfma_f32_16x16x32_bf16 a[52:55], a[188:191], v[140:143], a[52:55]
    s_waitcnt vmcnt(15)
    buffer_load_dword v221, v236, s[20:23], 0 offen
    v_smfmac_f32_16x16x64_bf16 a[200:203], v[52:55], v[144:151], v50
    v_mfma_f32_16x16x32_bf16 v[212:215], a[224:227], v[112:115], v[204:207]
    v_exp_f32 v208, v208
    v_mfma_f32_16x16x32_bf16 v[212:215], a[228:231], v[116:119], v[212:215]
    v_exp_f32 v209, v209
    v_mfma_f32_16x16x32_bf16 v[212:215], a[232:235], v[120:123], v[212:215]
    v_exp_f32 v210, v210
    v_mfma_f32_16x16x32_bf16 v[212:215], a[236:239], v[124:127], v[212:215]
    v_exp_f32 v211, v211
    v_mfma_f32_16x16x32_bf16 a[56:59], a[184:187], v[144:147], a[56:59]
    ds_read_b64_tr_b16 a[168:169], v25 offset:0
    v_cvt_pk_bf16_f32 v178, v208, v209
    v_mfma_f32_16x16x32_bf16 a[56:59], a[188:191], v[148:151], a[56:59]
    ds_read_b64_tr_b16 a[170:171], v25 offset:4096
    v_permlane16_swap_b32 v224, v226
    v_mfma_f32_16x16x32_bf16 a[60:63], a[184:187], v[152:155], a[60:63]
    ds_read_b128 a[224:227], v8 offset:28672
    v_cvt_pk_bf16_f32 v179, v210, v211
    v_mfma_f32_16x16x32_bf16 a[60:63], a[188:191], v[156:159], a[60:63]
    s_waitcnt lgkmcnt(3)
    buffer_load_dwordx4 v40, s[12:15], s41 offen offset:2048 lds
    v_mfma_f32_16x16x32_bf16 v[208:211], a[208:211], v[64:67], v[192:195]
    v_exp_f32 v212, v212
    v_mfma_f32_16x16x32_bf16 v[208:211], a[212:215], v[68:71], v[208:211]
    v_exp_f32 v213, v213
    v_mfma_f32_16x16x32_bf16 v[208:211], a[216:219], v[72:75], v[208:211]
    v_exp_f32 v214, v214
    v_mfma_f32_16x16x32_bf16 v[208:211], a[220:223], v[76:79], v[208:211]
    s_add_u32 s57, s58, 1179648
    v_exp_f32 v215, v215
    v_mfma_f32_16x16x32_bf16 a[64:67], a[160:163], v[128:131], a[64:67]
    ds_read_b64_tr_b16 a[172:173], v25 offset:8192
    v_cvt_pk_bf16_f32 v186, v212, v213
    v_mfma_f32_16x16x32_bf16 a[64:67], a[164:167], v[132:135], a[64:67]
    ds_read_b64_tr_b16 a[174:175], v25 offset:12288
    v_permlane16_swap_b32 v225, v227
    v_mfma_f32_16x16x32_bf16 a[68:71], a[160:163], v[136:139], a[68:71]
    ds_read_b128 a[228:231], v9 offset:28672
    v_cvt_pk_bf16_f32 v187, v214, v215
    v_mfma_f32_16x16x32_bf16 a[68:71], a[164:167], v[140:143], a[68:71]
    buffer_load_dwordx4 a[136:139], v254, s[80:83], s57 offen
    v_smfmac_f32_16x16x64_bf16 a[204:207], v[52:55], v[152:159], v50
    v_mfma_f32_16x16x32_bf16 v[212:215], a[208:211], v[80:83], v[196:199]
    v_exp_f32 v208, v208
    v_mfma_f32_16x16x32_bf16 v[212:215], a[212:215], v[84:87], v[212:215]
    v_exp_f32 v209, v209
    v_mfma_f32_16x16x32_bf16 v[212:215], a[216:219], v[88:91], v[212:215]
    v_exp_f32 v210, v210
    v_mfma_f32_16x16x32_bf16 v[212:215], a[220:223], v[92:95], v[212:215]
    v_exp_f32 v211, v211
    v_mfma_f32_16x16x32_bf16 a[72:75], a[160:163], v[144:147], a[72:75]
    ds_read_b64_tr_b16 a[176:177], v26 offset:0
    v_cvt_pk_bf16_f32 v164, v208, v209
    v_mfma_f32_16x16x32_bf16 a[72:75], a[164:167], v[148:151], a[72:75]
    ds_read_b64_tr_b16 a[178:179], v26 offset:4096
    v_lshlrev_b32 v244, 5, v244
    v_mfma_f32_16x16x32_bf16 a[76:79], a[160:163], v[152:155], a[76:79]
    ds_read_b128 a[232:235], v10 offset:28672
    v_cvt_pk_bf16_f32 v165, v210, v211
    v_mfma_f32_16x16x32_bf16 a[76:79], a[164:167], v[156:159], a[76:79]
    s_waitcnt lgkmcnt(3)
    buffer_load_dwordx4 v41, s[12:15], s41 offen offset:3072 lds
    v_mfma_f32_16x16x32_bf16 v[208:211], a[208:211], v[96:99], v[200:203]
    v_exp_f32 v212, v212
    v_mfma_f32_16x16x32_bf16 v[208:211], a[212:215], v[100:103], v[208:211]
    s_add_u32 s41, s41, 16384
    v_exp_f32 v213, v213
    v_mfma_f32_16x16x32_bf16 v[208:211], a[216:219], v[104:107], v[208:211]
    v_exp_f32 v214, v214
    v_mfma_f32_16x16x32_bf16 v[208:211], a[220:223], v[108:111], v[208:211]
    v_exp_f32 v215, v215
    v_mfma_f32_16x16x32_bf16 a[80:83], a[168:171], v[128:131], a[80:83]
    ds_read_b64_tr_b16 a[180:181], v26 offset:8192
    v_cvt_pk_bf16_f32 v172, v212, v213
    v_mfma_f32_16x16x32_bf16 a[80:83], a[172:175], v[132:135], a[80:83]
    ds_read_b64_tr_b16 a[182:183], v26 offset:12288
    v_add_f32 v224, v224, v226
    v_mfma_f32_16x16x32_bf16 a[84:87], a[168:171], v[136:139], a[84:87]
    ds_read_b128 a[236:239], v11 offset:28672
    v_cvt_pk_bf16_f32 v173, v214, v215
    v_mfma_f32_16x16x32_bf16 a[84:87], a[172:175], v[140:143], a[84:87]
    s_waitcnt vmcnt(13)
    s_barrier
    v_mfma_f32_16x16x32_bf16 v[212:215], a[208:211], v[112:115], v[204:207]
    v_exp_f32 v208, v208
    v_mfma_f32_16x16x32_bf16 v[212:215], a[212:215], v[116:119], v[212:215]
    s_add_u32 s49, s45, 1024
    v_exp_f32 v209, v209
    v_mfma_f32_16x16x32_bf16 v[212:215], a[216:219], v[120:123], v[212:215]
    s_add_u32 m0, s42, 0
    v_exp_f32 v210, v210
    v_mfma_f32_16x16x32_bf16 v[212:215], a[220:223], v[124:127], v[212:215]
    v_exp_f32 v211, v211
    v_mfma_f32_16x16x32_bf16 a[88:91], a[168:171], v[144:147], a[88:91]
    ds_read_b64_tr_b16 a[184:185], v27 offset:0
    v_cvt_pk_bf16_f32 v180, v208, v209
    v_mfma_f32_16x16x32_bf16 a[88:91], a[172:175], v[148:151], a[88:91]
    ds_read_b64_tr_b16 a[186:187], v27 offset:4096
    v_add_f32 v225, v225, v227
    v_mfma_f32_16x16x32_bf16 a[92:95], a[168:171], v[152:155], a[92:95]
    ds_read_b128 a[208:211], v8 offset:32768
    v_cvt_pk_bf16_f32 v181, v210, v211
    v_mfma_f32_16x16x32_bf16 a[92:95], a[172:175], v[156:159], a[92:95]
    s_waitcnt lgkmcnt(3)
    buffer_load_dwordx4 v46, s[20:23], s49 offen lds
    v_mfma_f32_16x16x32_bf16 v[208:211], a[224:227], v[64:67], v[192:195]
    v_exp_f32 v212, v212
    v_mfma_f32_16x16x32_bf16 v[208:211], a[228:231], v[68:71], v[208:211]
    v_exp_f32 v213, v213
    v_mfma_f32_16x16x32_bf16 v[208:211], a[232:235], v[72:75], v[208:211]
    v_exp_f32 v214, v214
    v_mfma_f32_16x16x32_bf16 v[208:211], a[236:239], v[76:79], v[208:211]
    s_add_u32 s37, s55, 0
    v_exp_f32 v215, v215
    v_mfma_f32_16x16x32_bf16 a[96:99], a[176:179], v[128:131], a[96:99]
    ds_read_b64_tr_b16 a[188:189], v27 offset:8192
    v_cvt_pk_bf16_f32 v188, v212, v213
    v_mfma_f32_16x16x32_bf16 a[96:99], a[180:183], v[132:135], a[96:99]
    ds_read_b64_tr_b16 a[190:191], v27 offset:12288
    v_lshrrev_b32 v245, 4, v1
    v_mfma_f32_16x16x32_bf16 a[100:103], a[176:179], v[136:139], a[100:103]
    ds_read_b128 a[212:215], v9 offset:32768
    v_cvt_pk_bf16_f32 v189, v214, v215
    v_mfma_f32_16x16x32_bf16 a[100:103], a[180:183], v[140:143], a[100:103]
    buffer_load_dword v239, v238, s[28:31], s37 offen
    v_mfma_f32_16x16x32_bf16 v[212:215], a[224:227], v[80:83], v[196:199]
    v_exp_f32 v208, v208
    v_mfma_f32_16x16x32_bf16 v[212:215], a[228:231], v[84:87], v[212:215]
    v_exp_f32 v209, v209
    v_mfma_f32_16x16x32_bf16 v[212:215], a[232:235], v[88:91], v[212:215]
    v_exp_f32 v210, v210
    v_mfma_f32_16x16x32_bf16 v[212:215], a[236:239], v[92:95], v[212:215]
    v_exp_f32 v211, v211
    v_mfma_f32_16x16x32_bf16 a[104:107], a[176:179], v[144:147], a[104:107]
    ds_read_b64_tr_b16 a[160:161], v20 offset:16384
    v_cvt_pk_bf16_f32 v166, v208, v209
    v_mfma_f32_16x16x32_bf16 a[104:107], a[180:183], v[148:151], a[104:107]
    ds_read_b64_tr_b16 a[162:163], v20 offset:20480
    v_lshl_add_u32 v244, v245, 3, v244
    v_mfma_f32_16x16x32_bf16 a[108:111], a[176:179], v[152:155], a[108:111]
    ds_read_b128 a[216:219], v10 offset:32768
    v_cvt_pk_bf16_f32 v167, v210, v211
    v_mfma_f32_16x16x32_bf16 a[108:111], a[180:183], v[156:159], a[108:111]
    s_waitcnt lgkmcnt(3)
    buffer_load_dwordx4 v47, s[20:23], s49 offen offset:1024 lds
    v_mfma_f32_16x16x32_bf16 v[208:211], a[224:227], v[96:99], v[200:203]
    v_exp_f32 v212, v212
    v_mfma_f32_16x16x32_bf16 v[208:211], a[228:231], v[100:103], v[208:211]
    v_exp_f32 v213, v213
    v_mfma_f32_16x16x32_bf16 v[208:211], a[232:235], v[104:107], v[208:211]
    v_exp_f32 v214, v214
    v_mfma_f32_16x16x32_bf16 v[208:211], a[236:239], v[108:111], v[208:211]
    s_add_u32 s57, s58, 1769472
    v_exp_f32 v215, v215
    v_mfma_f32_16x16x32_bf16 a[112:115], a[184:187], v[128:131], a[112:115]
    ds_read_b64_tr_b16 a[164:165], v20 offset:24576
    v_cvt_pk_bf16_f32 v174, v212, v213
    v_mfma_f32_16x16x32_bf16 a[112:115], a[188:191], v[132:135], a[112:115]
    ds_read_b64_tr_b16 a[166:167], v20 offset:28672
    v_mfma_f32_16x16x32_bf16 a[116:119], a[184:187], v[136:139], a[116:119]
    ds_read_b128 a[220:223], v11 offset:32768
    v_cvt_pk_bf16_f32 v175, v214, v215
    v_mfma_f32_16x16x32_bf16 a[116:119], a[188:191], v[140:143], a[116:119]
    buffer_load_dwordx4 a[140:143], v254, s[80:83], s57 offen
    v_mfma_f32_16x16x32_bf16 v[212:215], a[224:227], v[112:115], v[204:207]
Ltour6:
    s_cbranch_execz Ltour10
    v_exp_f32 v208, v208
    v_mfma_f32_16x16x32_bf16 v[212:215], a[228:231], v[116:119], v[212:215]
    v_exp_f32 v209, v209
    v_mfma_f32_16x16x32_bf16 v[212:215], a[232:235], v[120:123], v[212:215]
    v_exp_f32 v210, v210
    v_mfma_f32_16x16x32_bf16 v[212:215], a[236:239], v[124:127], v[212:215]
    v_exp_f32 v211, v211
    v_mfma_f32_16x16x32_bf16 a[120:123], a[184:187], v[144:147], a[120:123]
    ds_read_b64_tr_b16 a[168:169], v21 offset:16384
    v_cvt_pk_bf16_f32 v182, v208, v209
    v_mfma_f32_16x16x32_bf16 a[120:123], a[188:191], v[148:151], a[120:123]
    ds_read_b64_tr_b16 a[170:171], v21 offset:20480
    v_mfma_f32_16x16x32_bf16 a[124:127], a[184:187], v[152:155], a[124:127]
    ds_read_b128 a[224:227], v8 offset:36864
    v_cvt_pk_bf16_f32 v183, v210, v211
    v_mfma_f32_16x16x32_bf16 a[124:127], a[188:191], v[156:159], a[124:127]
    s_waitcnt lgkmcnt(3)
    buffer_load_dwordx4 v48, s[20:23], s49 offen offset:2048 lds
    v_mfma_f32_16x16x32_bf16 v[208:211], a[208:211], v[64:67], v[192:195]
    v_exp_f32 v212, v212
    v_mfma_f32_16x16x32_bf16 v[208:211], a[212:215], v[68:71], v[208:211]
    v_exp_f32 v213, v213
    v_mfma_f32_16x16x32_bf16 v[208:211], a[216:219], v[72:75], v[208:211]
    v_exp_f32 v214, v214
    v_mfma_f32_16x16x32_bf16 v[208:211], a[220:223], v[76:79], v[208:211]
    s_add_u32 s57, s58, 2359296
    v_exp_f32 v215, v215
    v_mfma_f32_16x16x32_bf16 a[0:3], a[160:163], v[160:163], a[0:3]
    ds_read_b64_tr_b16 a[172:173], v21 offset:24576
    v_cvt_pk_bf16_f32 v190, v212, v213
    v_mfma_f32_16x16x32_bf16 a[0:3], a[164:167], v[164:167], a[0:3]
    ds_read_b64_tr_b16 a[174:175], v21 offset:28672
    v_mov_b32 v63, 0
    v_mfma_f32_16x16x32_bf16 a[4:7], a[160:163], v[168:171], a[4:7]
    ds_read_b128 a[228:231], v9 offset:36864
    v_cvt_pk_bf16_f32 v191, v214, v215
    v_mfma_f32_16x16x32_bf16 a[4:7], a[164:167], v[172:175], a[4:7]
    buffer_load_dwordx4 a[144:147], v254, s[80:83], s57 offen
    v_mfma_f32_16x16x32_bf16 v[212:215], a[208:211], v[80:83], v[196:199]
    v_exp_f32 v208, v208
    v_mfma_f32_16x16x32_bf16 v[212:215], a[212:215], v[84:87], v[212:215]
    v_exp_f32 v209, v209
    v_mfma_f32_16x16x32_bf16 v[212:215], a[216:219], v[88:91], v[212:215]
    v_exp_f32 v210, v210
    v_mfma_f32_16x16x32_bf16 v[212:215], a[220:223], v[92:95], v[212:215]
    v_exp_f32 v211, v211
    v_mfma_f32_16x16x32_bf16 a[8:11], a[160:163], v[176:179], a[8:11]
    ds_read_b64_tr_b16 a[176:177], v22 offset:16384
    v_cvt_pk_bf16_f32 v128, v208, v209
    v_mfma_f32_16x16x32_bf16 a[8:11], a[164:167], v[180:183], a[8:11]
    ds_read_b64_tr_b16 a[178:179], v22 offset:20480
    v_add_f32_dpp v224, v224, v224 row_ror:2 row_mask:0xf bank_mask:0xf
    v_mfma_f32_16x16x32_bf16 a[12:15], a[160:163], v[184:187], a[12:15]
    ds_read_b128 a[232:235], v10 offset:36864
    v_cvt_pk_bf16_f32 v129, v210, v211
    v_mfma_f32_16x16x32_bf16 a[12:15], a[164:167], v[188:191], a[12:15]
    s_waitcnt lgkmcnt(3)
    buffer_load_dwordx4 v49, s[20:23], s49 offen offset:3072 lds
    v_mfma_f32_16x16x32_bf16 v[208:211], a[208:211], v[96:99], v[200:203]
    s_lshr_b32 s39, s2, 5
    v_exp_f32 v212, v212
    v_mfma_f32_16x16x32_bf16 v[208:211], a[212:215], v[100:103], v[208:211]
    s_lshl_b32 s39, s39, 3
    v_exp_f32 v213, v213
    v_mfma_f32_16x16x32_bf16 v[208:211], a[216:219], v[104:107], v[208:211]
    s_and_b32 s43, s2, 7
    v_exp_f32 v214, v214
    v_mfma_f32_16x16x32_bf16 v[208:211], a[220:223], v[108:111], v[208:211]
    s_add_u32 s39, s39, s43
    v_exp_f32 v215, v215
    v_mfma_f32_16x16x32_bf16 a[16:19], a[168:171], v[160:163], a[16:19]
    ds_read_b64_tr_b16 a[180:181], v22 offset:24576
    v_cvt_pk_bf16_f32 v136, v212, v213
    v_mfma_f32_16x16x32_bf16 a[16:19], a[172:175], v[164:167], a[16:19]
    ds_read_b64_tr_b16 a[182:183], v22 offset:28672
    v_add_f32_dpp v225, v225, v225 row_ror:2 row_mask:0xf bank_mask:0xf
    v_mfma_f32_16x16x32_bf16 a[20:23], a[168:171], v[168:171], a[20:23]
    ds_read_b128 a[236:239], v11 offset:36864
    v_cvt_pk_bf16_f32 v137, v214, v215
    v_mfma_f32_16x16x32_bf16 a[20:23], a[172:175], v[172:175], a[20:23]
    buffer_load_dword v253, v63, s[24:27], s54 offen offset:12 sc1
    v_smfmac_f32_16x16x64_bf16 a[192:195], v[52:55], v[160:167], v50
    v_mfma_f32_16x16x32_bf16 v[212:215], a[208:211], v[112:115], v[204:207]
    s_lshl_b32 s39, s39, 2
    v_exp_f32 v208, v208
    v_mfma_f32_16x16x32_bf16 v[212:215], a[212:215], v[116:119], v[212:215]
    s_add_u32 m0, s42, 114688
    v_exp_f32 v209, v209
    v_mfma_f32_16x16x32_bf16 v[212:215], a[216:219], v[120:123], v[212:215]
    s_bfe_u32 s43, s2, 0x20003
    v_exp_f32 v210, v210
    v_mfma_f32_16x16x32_bf16 v[212:215], a[220:223], v[124:127], v[212:215]
    s_add_u32 s39, s39, s43
    v_exp_f32 v211, v211
    v_mfma_f32_16x16x32_bf16 a[24:27], a[168:171], v[176:179], a[24:27]
    ds_read_b64_tr_b16 a[184:185], v23 offset:16384
    v_cvt_pk_bf16_f32 v144, v208, v209
    v_mfma_f32_16x16x32_bf16 a[24:27], a[172:175], v[180:183], a[24:27]
    ds_read_b64_tr_b16 a[186:187], v23 offset:20480
    v_add_f32_dpp v224, v224, v224 row_ror:4 row_mask:0xf bank_mask:0xf
    v_mfma_f32_16x16x32_bf16 a[28:31], a[168:171], v[184:187], a[28:31]
    ds_read_b128 a[208:211], v8 offset:40960
    v_cvt_pk_bf16_f32 v145, v210, v211
    v_mfma_f32_16x16x32_bf16 a[28:31], a[172:175], v[188:191], a[28:31]
    s_waitcnt lgkmcnt(3)
    buffer_load_dwordx4 v40, s[12:15], s41 offen lds
    v_mfma_f32_16x16x32_bf16 v[208:211], a[224:227], v[64:67], v[192:195]
    s_add_u32 s39, s39, 72
    v_exp_f32 v212, v212
    v_mfma_f32_16x16x32_bf16 v[208:211], a[228:231], v[68:71], v[208:211]
    s_cmp_lt_u32 s39, 216
    s_cselect_b32 s43, 0, 2147483648
    v_exp_f32 v213, v213
    v_mfma_f32_16x16x32_bf16 v[208:211], a[232:235], v[72:75], v[208:211]
    s_or_b32 s43, s43, s48
    v_exp_f32 v214, v214
    v_mfma_f32_16x16x32_bf16 v[208:211], a[236:239], v[76:79], v[208:211]
    s_add_u32 s57, s58, 2949120
    v_exp_f32 v215, v215
    v_mfma_f32_16x16x32_bf16 a[32:35], a[176:179], v[160:163], a[32:35]
    ds_read_b64_tr_b16 a[188:189], v23 offset:24576
    v_cvt_pk_bf16_f32 v152, v212, v213
    v_mfma_f32_16x16x32_bf16 a[32:35], a[180:183], v[164:167], a[32:35]
    ds_read_b64_tr_b16 a[190:191], v23 offset:28672
    v_add_f32_dpp v225, v225, v225 row_ror:4 row_mask:0xf bank_mask:0xf
    v_mfma_f32_16x16x32_bf16 a[36:39], a[176:179], v[168:171], a[36:39]
    ds_read_b128 a[212:215], v9 offset:40960
    v_cvt_pk_bf16_f32 v153, v214, v215
    v_mfma_f32_16x16x32_bf16 a[36:39], a[180:183], v[172:175], a[36:39]
    buffer_load_dwordx4 a[148:151], v254, s[80:83], s57 offen
    v_smfmac_f32_16x16x64_bf16 a[196:199], v[52:55], v[168:175], v50
    v_mfma_f32_16x16x32_bf16 v[212:215], a[224:227], v[80:83], v[196:199]
    s_and_b32 s43, s43, 2147483648
    v_exp_f32 v208, v208
    v_mfma_f32_16x16x32_bf16 v[212:215], a[228:231], v[84:87], v[212:215]
    s_sub_u32 s36, s39, 144
    v_exp_f32 v209, v209
    v_mfma_f32_16x16x32_bf16 v[212:215], a[232:235], v[88:91], v[212:215]
    s_cmp_lt_u32 s36, 36
    s_cselect_b32 s36, 1.0, 0
    v_exp_f32 v210, v210
    v_mfma_f32_16x16x32_bf16 v[212:215], a[236:239], v[92:95], v[212:215]
    s_lshr_b32 s44, s39, 1
    v_exp_f32 v211, v211
    v_mfma_f32_16x16x32_bf16 a[40:43], a[176:179], v[176:179], a[40:43]
    ds_read_b64_tr_b16 a[160:161], v24 offset:16384
    v_cvt_pk_bf16_f32 v130, v208, v209
    v_mfma_f32_16x16x32_bf16 a[40:43], a[180:183], v[180:183], a[40:43]
    ds_read_b64_tr_b16 a[162:163], v24 offset:20480
    v_add_f32_dpp v224, v224, v224 row_ror:8 row_mask:0xf bank_mask:0xf
    v_mfma_f32_16x16x32_bf16 a[44:47], a[176:179], v[184:187], a[44:47]
    ds_read_b128 a[216:219], v10 offset:40960
    v_cvt_pk_bf16_f32 v131, v210, v211
    v_mfma_f32_16x16x32_bf16 a[44:47], a[180:183], v[188:191], a[44:47]
    s_waitcnt lgkmcnt(3)
    buffer_load_dwordx4 v41, s[12:15], s41 offen offset:1024 lds
    v_mfma_f32_16x16x32_bf16 v[208:211], a[224:227], v[96:99], v[200:203]
    s_lshl_b32 s44, s44, 6
    v_exp_f32 v212, v212
    v_mfma_f32_16x16x32_bf16 v[208:211], a[228:231], v[100:103], v[208:211]
    s_and_b32 s39, s39, 1
    v_exp_f32 v213, v213
    v_mfma_f32_16x16x32_bf16 v[208:211], a[232:235], v[104:107], v[208:211]
    s_lshl_b32 s39, s39, 3
    v_exp_f32 v214, v214
    v_mfma_f32_16x16x32_bf16 v[208:211], a[236:239], v[108:111], v[208:211]
    s_add_u32 s39, s39, s44
    v_exp_f32 v215, v215
    v_mfma_f32_16x16x32_bf16 a[48:51], a[184:187], v[160:163], a[48:51]
    ds_read_b64_tr_b16 a[164:165], v24 offset:24576
    v_cvt_pk_bf16_f32 v138, v212, v213
    v_mfma_f32_16x16x32_bf16 a[48:51], a[188:191], v[164:167], a[48:51]
    ds_read_b64_tr_b16 a[166:167], v24 offset:28672
    v_add_f32_dpp v225, v225, v225 row_ror:8 row_mask:0xf bank_mask:0xf
    v_mfma_f32_16x16x32_bf16 a[52:55], a[184:187], v[168:171], a[52:55]
    ds_read_b128 a[220:223], v11 offset:40960
    v_cvt_pk_bf16_f32 v139, v214, v215
    v_mfma_f32_16x16x32_bf16 a[52:55], a[188:191], v[172:175], a[52:55]
    v_add_u32 v244, s38, v244
    v_and_b32 v245, 7, v1
    v_smfmac_f32_16x16x64_bf16 a[200:203], v[52:55], v[176:183], v50
    v_mfma_f32_16x16x32_bf16 v[212:215], a[224:227], v[112:115], v[204:207]
    s_add_u32 s39, s39, 16384
    v_exp_f32 v208, v208
    v_mfma_f32_16x16x32_bf16 v[212:215], a[228:231], v[116:119], v[212:215]
    s_or_b32 s39, s39, s43
    v_exp_f32 v209, v209
    v_mfma_f32_16x16x32_bf16 v[212:215], a[232:235], v[120:123], v[212:215]
    v_exp_f32 v210, v210
    v_mfma_f32_16x16x32_bf16 v[212:215], a[236:239], v[124:127], v[212:215]
    v_exp_f32 v211, v211
    v_mfma_f32_16x16x32_bf16 a[56:59], a[184:187], v[176:179], a[56:59]
    ds_read_b64_tr_b16 a[168:169], v25 offset:16384
    v_cvt_pk_bf16_f32 v146, v208, v209
    v_mfma_f32_16x16x32_bf16 a[56:59], a[188:191], v[180:183], a[56:59]
    ds_read_b64_tr_b16 a[170:171], v25 offset:20480
    v_mfma_f32_16x16x32_bf16 a[60:63], a[184:187], v[184:187], a[60:63]
    ds_read_b128 a[224:227], v8 offset:45056
    v_cvt_pk_bf16_f32 v147, v210, v211
    v_mfma_f32_16x16x32_bf16 a[60:63], a[188:191], v[188:191], a[60:63]
    s_waitcnt lgkmcnt(3)
    buffer_load_dwordx4 v40, s[12:15], s41 offen offset:2048 lds
    v_mfma_f32_16x16x32_bf16 v[208:211], a[208:211], v[64:67], v[192:195]
    v_exp_f32 v212, v212
    v_mfma_f32_16x16x32_bf16 v[208:211], a[212:215], v[68:71], v[208:211]
    v_exp_f32 v213, v213
    v_mfma_f32_16x16x32_bf16 v[208:211], a[216:219], v[72:75], v[208:211]
    v_exp_f32 v214, v214
    v_mfma_f32_16x16x32_bf16 v[208:211], a[220:223], v[76:79], v[208:211]
    s_add_u32 s57, s58, 3538944
    v_exp_f32 v215, v215
    v_mfma_f32_16x16x32_bf16 a[64:67], a[160:163], v[160:163], a[64:67]
    ds_read_b64_tr_b16 a[172:173], v25 offset:24576
    v_cvt_pk_bf16_f32 v154, v212, v213
    v_mfma_f32_16x16x32_bf16 a[64:67], a[164:167], v[164:167], a[64:67]
    ds_read_b64_tr_b16 a[174:175], v25 offset:28672
    v_lshlrev_b32 v245, 3, v245
    v_mfma_f32_16x16x32_bf16 a[68:71], a[160:163], v[168:171], a[68:71]
    ds_read_b128 a[228:231], v9 offset:45056
    v_cvt_pk_bf16_f32 v155, v214, v215
    v_mfma_f32_16x16x32_bf16 a[68:71], a[164:167], v[172:175], a[68:71]
    buffer_load_dwordx4 a[152:155], v254, s[80:83], s57 offen
    v_smfmac_f32_16x16x64_bf16 a[204:207], v[52:55], v[184:191], v50
    ds_write_b64 v244, v[224:225]
    v_mfma_f32_16x16x32_bf16 v[212:215], a[208:211], v[80:83], v[196:199]
    v_exp_f32 v208, v208
    v_mfma_f32_16x16x32_bf16 v[212:215], a[212:215], v[84:87], v[212:215]
    v_exp_f32 v209, v209
    v_mfma_f32_16x16x32_bf16 v[212:215], a[216:219], v[88:91], v[212:215]
    v_exp_f32 v210, v210
    v_mfma_f32_16x16x32_bf16 v[212:215], a[220:223], v[92:95], v[212:215]
    v_exp_f32 v211, v211
    v_mfma_f32_16x16x32_bf16 a[72:75], a[160:163], v[176:179], a[72:75]
    ds_read_b64_tr_b16 a[176:177], v26 offset:16384
    v_cvt_pk_bf16_f32 v132, v208, v209
    v_mfma_f32_16x16x32_bf16 a[72:75], a[164:167], v[180:183], a[72:75]
    ds_read_b64_tr_b16 a[178:179], v26 offset:20480
    v_add_u32 v245, 131136, v245
    v_mfma_f32_16x16x32_bf16 a[76:79], a[160:163], v[184:187], a[76:79]
    ds_read_b128 a[232:235], v10 offset:45056
    v_cvt_pk_bf16_f32 v133, v210, v211
    v_mfma_f32_16x16x32_bf16 a[76:79], a[164:167], v[188:191], a[76:79]
    s_waitcnt lgkmcnt(3)
    buffer_load_dwordx4 v41, s[12:15], s41 offen offset:3072 lds
    v_mfma_f32_16x16x32_bf16 v[208:211], a[208:211], v[96:99], v[200:203]
    v_exp_f32 v212, v212
    v_mfma_f32_16x16x32_bf16 v[208:211], a[212:215], v[100:103], v[208:211]
    s_add_u32 s41, s41, 16384
    v_exp_f32 v213, v213
    v_mfma_f32_16x16x32_bf16 v[208:211], a[216:219], v[104:107], v[208:211]
    v_exp_f32 v214, v214
    v_mfma_f32_16x16x32_bf16 v[208:211], a[220:223], v[108:111], v[208:211]
    v_exp_f32 v215, v215
    v_mfma_f32_16x16x32_bf16 a[80:83], a[168:171], v[160:163], a[80:83]
    ds_read_b64_tr_b16 a[180:181], v26 offset:24576
    v_cvt_pk_bf16_f32 v140, v212, v213
    v_mfma_f32_16x16x32_bf16 a[80:83], a[172:175], v[164:167], a[80:83]
    ds_read_b64_tr_b16 a[182:183], v26 offset:28672
    v_mfma_f32_16x16x32_bf16 a[84:87], a[168:171], v[168:171], a[84:87]
    ds_read_b128 a[236:239], v11 offset:45056
    v_cvt_pk_bf16_f32 v141, v214, v215
    v_mfma_f32_16x16x32_bf16 a[84:87], a[172:175], v[172:175], a[84:87]
    s_waitcnt vmcnt(14)
    s_barrier
    v_mfma_f32_16x16x32_bf16 v[212:215], a[208:211], v[112:115], v[204:207]
    v_exp_f32 v208, v208
    v_mfma_f32_16x16x32_bf16 v[212:215], a[212:215], v[116:119], v[212:215]
    s_add_u32 s49, s45, 74752
    v_exp_f32 v209, v209
    v_mfma_f32_16x16x32_bf16 v[212:215], a[216:219], v[120:123], v[212:215]
    s_add_u32 m0, s42, 16384
    v_exp_f32 v210, v210
    v_mfma_f32_16x16x32_bf16 v[212:215], a[220:223], v[124:127], v[212:215]
    v_exp_f32 v211, v211
    v_mfma_f32_16x16x32_bf16 a[88:91], a[168:171], v[176:179], a[88:91]
    ds_read_b64_tr_b16 a[184:185], v27 offset:16384
    v_cvt_pk_bf16_f32 v148, v208, v209
    v_mfma_f32_16x16x32_bf16 a[88:91], a[172:175], v[180:183], a[88:91]
    ds_read_b64_tr_b16 a[186:187], v27 offset:20480
    ds_read_b64 v[224:225], v245 offset:0
    v_mfma_f32_16x16x32_bf16 a[92:95], a[168:171], v[184:187], a[92:95]
    ds_read_b128 a[208:211], v8 offset:49152
    v_cvt_pk_bf16_f32 v149, v210, v211
    v_mfma_f32_16x16x32_bf16 a[92:95], a[172:175], v[188:191], a[92:95]
    s_waitcnt lgkmcnt(3)
    buffer_load_dwordx4 v46, s[20:23], s49 offen lds
    v_mfma_f32_16x16x32_bf16 v[208:211], a[224:227], v[64:67], v[192:195]
    v_exp_f32 v212, v212
    v_mfma_f32_16x16x32_bf16 v[208:211], a[228:231], v[68:71], v[208:211]
    v_exp_f32 v213, v213
    v_mfma_f32_16x16x32_bf16 v[208:211], a[232:235], v[72:75], v[208:211]
    v_exp_f32 v214, v214
    v_mfma_f32_16x16x32_bf16 v[208:211], a[236:239], v[76:79], v[208:211]
    v_exp_f32 v215, v215
    v_mfma_f32_16x16x32_bf16 a[96:99], a[176:179], v[160:163], a[96:99]
    ds_read_b64_tr_b16 a[188:189], v27 offset:24576
    v_cvt_pk_bf16_f32 v156, v212, v213
    v_mfma_f32_16x16x32_bf16 a[96:99], a[180:183], v[164:167], a[96:99]
    ds_read_b64_tr_b16 a[190:191], v27 offset:28672
    ds_read_b64 v[226:227], v245 offset:64
    v_mfma_f32_16x16x32_bf16 a[100:103], a[176:179], v[168:171], a[100:103]
    ds_read_b128 a[212:215], v9 offset:49152
    v_cvt_pk_bf16_f32 v157, v214, v215
    v_mfma_f32_16x16x32_bf16 a[100:103], a[180:183], v[172:175], a[100:103]
    v_mfma_f32_16x16x32_bf16 v[212:215], a[224:227], v[80:83], v[196:199]
    v_exp_f32 v208, v208
    v_mfma_f32_16x16x32_bf16 v[212:215], a[228:231], v[84:87], v[212:215]
    v_exp_f32 v209, v209
    v_mfma_f32_16x16x32_bf16 v[212:215], a[232:235], v[88:91], v[212:215]
    v_exp_f32 v210, v210
    v_mfma_f32_16x16x32_bf16 v[212:215], a[236:239], v[92:95], v[212:215]
    v_exp_f32 v211, v211
    v_mfma_f32_16x16x32_bf16 a[104:107], a[176:179], v[176:179], a[104:107]
    ds_read_b64_tr_b16 a[160:161], v20 offset:32768
    v_cvt_pk_bf16_f32 v134, v208, v209
    v_mfma_f32_16x16x32_bf16 a[104:107], a[180:183], v[180:183], a[104:107]
    ds_read_b64_tr_b16 a[162:163], v20 offset:36864
    ds_read_b64 v[228:229], v245 offset:128
    v_mfma_f32_16x16x32_bf16 a[108:111], a[176:179], v[184:187], a[108:111]
    ds_read_b128 a[216:219], v10 offset:49152
    v_cvt_pk_bf16_f32 v135, v210, v211
    v_mfma_f32_16x16x32_bf16 a[108:111], a[180:183], v[188:191], a[108:111]
    s_waitcnt lgkmcnt(3)
    buffer_load_dwordx4 v47, s[20:23], s49 offen offset:1024 lds
    v_mfma_f32_16x16x32_bf16 v[208:211], a[224:227], v[96:99], v[200:203]
    v_exp_f32 v212, v212
    v_mfma_f32_16x16x32_bf16 v[208:211], a[228:231], v[100:103], v[208:211]
    v_exp_f32 v213, v213
    v_mfma_f32_16x16x32_bf16 v[208:211], a[232:235], v[104:107], v[208:211]
    v_exp_f32 v214, v214
    v_mfma_f32_16x16x32_bf16 v[208:211], a[236:239], v[108:111], v[208:211]
    s_add_u32 s57, s58, 4128768
    v_exp_f32 v215, v215
    v_mfma_f32_16x16x32_bf16 a[112:115], a[184:187], v[160:163], a[112:115]
    ds_read_b64_tr_b16 a[164:165], v20 offset:40960
    v_cvt_pk_bf16_f32 v142, v212, v213
    v_mfma_f32_16x16x32_bf16 a[112:115], a[188:191], v[164:167], a[112:115]
    ds_read_b64_tr_b16 a[166:167], v20 offset:45056
    ds_read_b64 v[230:231], v245 offset:192
    v_mfma_f32_16x16x32_bf16 a[116:119], a[184:187], v[168:171], a[116:119]
    ds_read_b128 a[220:223], v11 offset:49152
    v_cvt_pk_bf16_f32 v143, v214, v215
    v_mfma_f32_16x16x32_bf16 a[116:119], a[188:191], v[172:175], a[116:119]
    buffer_load_dwordx4 a[156:159], v254, s[80:83], s57 offen
    v_mfma_f32_16x16x32_bf16 v[212:215], a[224:227], v[112:115], v[204:207]
    v_exp_f32 v208, v208
    v_mfma_f32_16x16x32_bf16 v[212:215], a[228:231], v[116:119], v[212:215]
    v_exp_f32 v209, v209
    v_mfma_f32_16x16x32_bf16 v[212:215], a[232:235], v[120:123], v[212:215]
    v_exp_f32 v210, v210
    v_mfma_f32_16x16x32_bf16 v[212:215], a[236:239], v[124:127], v[212:215]
    v_exp_f32 v211, v211
    v_mfma_f32_16x16x32_bf16 a[120:123], a[184:187], v[176:179], a[120:123]
    ds_read_b64_tr_b16 a[168:169], v21 offset:32768
    v_cvt_pk_bf16_f32 v150, v208, v209
    v_mfma_f32_16x16x32_bf16 a[120:123], a[188:191], v[180:183], a[120:123]
    ds_read_b64_tr_b16 a[170:171], v21 offset:36864
    v_mfma_f32_16x16x32_bf16 a[124:127], a[184:187], v[184:187], a[124:127]
    ds_read_b128 a[224:227], v8 offset:53248
    v_cvt_pk_bf16_f32 v151, v210, v211
    v_mfma_f32_16x16x32_bf16 a[124:127], a[188:191], v[188:191], a[124:127]
    s_waitcnt lgkmcnt(3)
    buffer_load_dwordx4 v48, s[20:23], s49 offen offset:2048 lds
    v_mfma_f32_16x16x32_bf16 v[208:211], a[208:211], v[64:67], v[192:195]
    v_exp_f32 v212, v212
    v_mfma_f32_16x16x32_bf16 v[208:211], a[212:215], v[68:71], v[208:211]
    v_exp_f32 v213, v213
    v_mfma_f32_16x16x32_bf16 v[208:211], a[216:219], v[72:75], v[208:211]
    v_exp_f32 v214, v214
    v_mfma_f32_16x16x32_bf16 v[208:211], a[220:223], v[76:79], v[208:211]
    s_add_u32 s57, s58, 4718592
    v_exp_f32 v215, v215
    v_mfma_f32_16x16x32_bf16 a[0:3], a[160:163], v[128:131], a[0:3]
    ds_read_b64_tr_b16 a[172:173], v21 offset:40960
    v_cvt_pk_bf16_f32 v158, v212, v213
    v_mfma_f32_16x16x32_bf16 a[0:3], a[164:167], v[132:135], a[0:3]
    ds_read_b64_tr_b16 a[174:175], v21 offset:45056
    v_add_f32 v224, v224, v228
    v_mfma_f32_16x16x32_bf16 a[4:7], a[160:163], v[136:139], a[4:7]
    ds_read_b128 a[228:231], v9 offset:53248
    v_cvt_pk_bf16_f32 v159, v214, v215
    v_mfma_f32_16x16x32_bf16 a[4:7], a[164:167], v[140:143], a[4:7]
    buffer_load_dwordx4 a[240:243], v254, s[80:83], s57 offen
    v_mfma_f32_16x16x32_bf16 v[212:215], a[208:211], v[80:83], v[196:199]
    v_exp_f32 v208, v208
    v_mfma_f32_16x16x32_bf16 v[212:215], a[212:215], v[84:87], v[212:215]
    v_exp_f32 v209, v209
    v_mfma_f32_16x16x32_bf16 v[212:215], a[216:219], v[88:91], v[212:215]
    v_exp_f32 v210, v210
    v_mfma_f32_16x16x32_bf16 v[212:215], a[220:223], v[92:95], v[212:215]
    v_exp_f32 v211, v211
    v_mfma_f32_16x16x32_bf16 a[8:11], a[160:163], v[144:147], a[8:11]
    ds_read_b64_tr_b16 a[176:177], v22 offset:32768
    v_cvt_pk_bf16_f32 v160, v208, v209
    v_mfma_f32_16x16x32_bf16 a[8:11], a[164:167], v[148:151], a[8:11]
    ds_read_b64_tr_b16 a[178:179], v22 offset:36864
    v_add_f32 v225, v225, v229
    v_mfma_f32_16x16x32_bf16 a[12:15], a[160:163], v[152:155], a[12:15]
    ds_read_b128 a[232:235], v10 offset:53248
    v_cvt_pk_bf16_f32 v161, v210, v211
    v_mfma_f32_16x16x32_bf16 a[12:15], a[164:167], v[156:159], a[12:15]
    s_waitcnt lgkmcnt(3)
    buffer_load_dwordx4 v49, s[20:23], s49 offen offset:3072 lds
    v_mfma_f32_16x16x32_bf16 v[208:211], a[208:211], v[96:99], v[200:203]
    v_exp_f32 v212, v212
    v_mfma_f32_16x16x32_bf16 v[208:211], a[212:215], v[100:103], v[208:211]
    v_exp_f32 v213, v213
    v_mfma_f32_16x16x32_bf16 v[208:211], a[216:219], v[104:107], v[208:211]
    v_exp_f32 v214, v214
    v_mfma_f32_16x16x32_bf16 v[208:211], a[220:223], v[108:111], v[208:211]
    v_exp_f32 v215, v215
    v_mfma_f32_16x16x32_bf16 a[16:19], a[168:171], v[128:131], a[16:19]
    ds_read_b64_tr_b16 a[180:181], v22 offset:40960
    v_cvt_pk_bf16_f32 v168, v212, v213
    v_mfma_f32_16x16x32_bf16 a[16:19], a[172:175], v[132:135], a[16:19]
    ds_read_b64_tr_b16 a[182:183], v22 offset:45056
    v_add_f32 v226, v226, v230
    v_mfma_f32_16x16x32_bf16 a[20:23], a[168:171], v[136:139], a[20:23]
    ds_read_b128 a[236:239], v11 offset:53248
    v_cvt_pk_bf16_f32 v169, v214, v215
    v_mfma_f32_16x16x32_bf16 a[20:23], a[172:175], v[140:143], a[20:23]
    v_add_f32 v227, v227, v231
    v_add_f32 v224, v224, v226
    v_smfmac_f32_16x16x64_bf16 a[192:195], v[52:55], v[128:135], v50
    v_mfma_f32_16x16x32_bf16 v[212:215], a[208:211], v[112:115], v[204:207]
    v_exp_f32 v208, v208
    v_mfma_f32_16x16x32_bf16 v[212:215], a[212:215], v[116:119], v[212:215]
    s_add_u32 s49, s7, 0
    v_exp_f32 v209, v209
    v_mfma_f32_16x16x32_bf16 v[212:215], a[216:219], v[120:123], v[212:215]
    s_add_u32 m0, s42, 65536
    v_exp_f32 v210, v210
    v_mfma_f32_16x16x32_bf16 v[212:215], a[220:223], v[124:127], v[212:215]
    v_exp_f32 v211, v211
    v_mfma_f32_16x16x32_bf16 a[24:27], a[168:171], v[144:147], a[24:27]
    ds_read_b64_tr_b16 a[184:185], v23 offset:32768
    v_cvt_pk_bf16_f32 v176, v208, v209
    v_mfma_f32_16x16x32_bf16 a[24:27], a[172:175], v[148:151], a[24:27]
    ds_read_b64_tr_b16 a[186:187], v23 offset:36864
    v_add_f32 v225, v225, v227
    v_mfma_f32_16x16x32_bf16 a[28:31], a[168:171], v[152:155], a[28:31]
    ds_read_b128 a[208:211], v8 offset:57344
    v_cvt_pk_bf16_f32 v177, v210, v211
    v_mfma_f32_16x16x32_bf16 a[28:31], a[172:175], v[156:159], a[28:31]
    s_waitcnt lgkmcnt(3)
    buffer_load_dwordx4 v46, s[20:23], s49 offen lds
    v_mfma_f32_16x16x32_bf16 v[208:211], a[224:227], v[64:67], v[192:195]
    v_exp_f32 v212, v212
    v_mfma_f32_16x16x32_bf16 v[208:211], a[228:231], v[68:71], v[208:211]
    v_exp_f32 v213, v213
    v_mfma_f32_16x16x32_bf16 v[208:211], a[232:235], v[72:75], v[208:211]
    v_exp_f32 v214, v214
    v_mfma_f32_16x16x32_bf16 v[208:211], a[236:239], v[76:79], v[208:211]
    s_add_u32 s57, s58, 4128768
    v_exp_f32 v215, v215
    v_mfma_f32_16x16x32_bf16 a[32:35], a[176:179], v[128:131], a[32:35]
    ds_read_b64_tr_b16 a[188:189], v23 offset:40960
    v_cvt_pk_bf16_f32 v184, v212, v213
    v_mfma_f32_16x16x32_bf16 a[32:35], a[180:183], v[132:135], a[32:35]
    ds_read_b64_tr_b16 a[190:191], v23 offset:45056
    v_cvt_pk_bf16_f32 v246, v224, v225
    v_mfma_f32_16x16x32_bf16 a[36:39], a[176:179], v[136:139], a[36:39]
    ds_read_b128 a[212:215], v9 offset:57344
    v_cvt_pk_bf16_f32 v185, v214, v215
    v_mfma_f32_16x16x32_bf16 a[36:39], a[180:183], v[140:143], a[36:39]
    buffer_load_dwordx4 a[244:247], v254, s[32:35], s57 offen
    v_smfmac_f32_16x16x64_bf16 a[196:199], v[52:55], v[136:143], v50
    v_mfma_f32_16x16x32_bf16 v[212:215], a[224:227], v[80:83], v[196:199]
    v_exp_f32 v208, v208
    v_mfma_f32_16x16x32_bf16 v[212:215], a[228:231], v[84:87], v[212:215]
    v_exp_f32 v209, v209
    v_mfma_f32_16x16x32_bf16 v[212:215], a[232:235], v[88:91], v[212:215]
    v_exp_f32 v210, v210
    v_mfma_f32_16x16x32_bf16 v[212:215], a[236:239], v[92:95], v[212:215]
    v_exp_f32 v211, v211
    v_mfma_f32_16x16x32_bf16 a[40:43], a[176:179], v[144:147], a[40:43]
    ds_read_b64_tr_b16 a[160:161], v24 offset:32768
    v_cvt_pk_bf16_f32 v162, v208, v209
    v_mfma_f32_16x16x32_bf16 a[40:43], a[180:183], v[148:151], a[40:43]
    ds_read_b64_tr_b16 a[162:163], v24 offset:36864
    v_lshlrev_b32 v224, 16, v246
    v_mfma_f32_16x16x32_bf16 a[44:47], a[176:179], v[152:155], a[44:47]
    ds_read_b128 a[216:219], v10 offset:57344
    v_cvt_pk_bf16_f32 v163, v210, v211
    v_mfma_f32_16x16x32_bf16 a[44:47], a[180:183], v[156:159], a[44:47]
    s_waitcnt lgkmcnt(3)
    buffer_load_dwordx4 v47, s[20:23], s49 offen offset:1024 lds
    v_mfma_f32_16x16x32_bf16 v[208:211], a[224:227], v[96:99], v[200:203]
    v_exp_f32 v212, v212
    v_mfma_f32_16x16x32_bf16 v[208:211], a[228:231], v[100:103], v[208:211]
    v_exp_f32 v213, v213
    v_mfma_f32_16x16x32_bf16 v[208:211], a[232:235], v[104:107], v[208:211]
    v_exp_f32 v214, v214
    v_mfma_f32_16x16x32_bf16 v[208:211], a[236:239], v[108:111], v[208:211]
    v_exp_f32 v215, v215
    v_mfma_f32_16x16x32_bf16 a[48:51], a[184:187], v[128:131], a[48:51]
    ds_read_b64_tr_b16 a[164:165], v24 offset:40960
    v_cvt_pk_bf16_f32 v170, v212, v213
    v_mfma_f32_16x16x32_bf16 a[48:51], a[188:191], v[132:135], a[48:51]
    ds_read_b64_tr_b16 a[166:167], v24 offset:45056
    v_and_b32 v225, 0xffff0000, v246
    v_mfma_f32_16x16x32_bf16 a[52:55], a[184:187], v[136:139], a[52:55]
    ds_read_b128 a[220:223], v11 offset:57344
    v_cvt_pk_bf16_f32 v171, v214, v215
    v_mfma_f32_16x16x32_bf16 a[52:55], a[188:191], v[140:143], a[52:55]
    v_add_f32 v224, s36, v224
    v_add_f32 v225, s36, v225
    v_smfmac_f32_16x16x64_bf16 a[200:203], v[52:55], v[144:151], v50
    v_mfma_f32_16x16x32_bf16 v[212:215], a[224:227], v[112:115], v[204:207]
    v_exp_f32 v208, v208
    v_mfma_f32_16x16x32_bf16 v[212:215], a[228:231], v[116:119], v[212:215]
    v_exp_f32 v209, v209
    v_mfma_f32_16x16x32_bf16 v[212:215], a[232:235], v[120:123], v[212:215]
    v_exp_f32 v210, v210
    v_mfma_f32_16x16x32_bf16 v[212:215], a[236:239], v[124:127], v[212:215]
    v_exp_f32 v211, v211
    v_mfma_f32_16x16x32_bf16 a[56:59], a[184:187], v[144:147], a[56:59]
    ds_read_b64_tr_b16 a[168:169], v25 offset:32768
    v_cvt_pk_bf16_f32 v178, v208, v209
    v_mfma_f32_16x16x32_bf16 a[56:59], a[188:191], v[148:151], a[56:59]
    ds_read_b64_tr_b16 a[170:171], v25 offset:36864
    v_cvt_pk_bf16_f32 v246, v224, v225
    v_mfma_f32_16x16x32_bf16 a[60:63], a[184:187], v[152:155], a[60:63]
    ds_read_b128 a[224:227], v8 offset:61440
    v_cvt_pk_bf16_f32 v179, v210, v211
    v_mfma_f32_16x16x32_bf16 a[60:63], a[188:191], v[156:159], a[60:63]
    s_waitcnt lgkmcnt(3)
    buffer_load_dwordx4 v48, s[20:23], s49 offen offset:2048 lds
    v_mfma_f32_16x16x32_bf16 v[208:211], a[208:211], v[64:67], v[192:195]
    v_exp_f32 v212, v212
    v_mfma_f32_16x16x32_bf16 v[208:211], a[212:215], v[68:71], v[208:211]
    v_exp_f32 v213, v213
    v_mfma_f32_16x16x32_bf16 v[208:211], a[216:219], v[72:75], v[208:211]
    v_exp_f32 v214, v214
    v_mfma_f32_16x16x32_bf16 v[208:211], a[220:223], v[76:79], v[208:211]
    s_add_u32 s57, s58, 4718592
    v_exp_f32 v215, v215
    v_mfma_f32_16x16x32_bf16 a[64:67], a[160:163], v[128:131], a[64:67]
    ds_read_b64_tr_b16 a[172:173], v25 offset:40960
    v_cvt_pk_bf16_f32 v186, v212, v213
    v_mfma_f32_16x16x32_bf16 a[64:67], a[164:167], v[132:135], a[64:67]
    ds_read_b64_tr_b16 a[174:175], v25 offset:45056
    v_lshrrev_b32 v244, 1, v0
    v_mfma_f32_16x16x32_bf16 a[68:71], a[160:163], v[136:139], a[68:71]
    ds_read_b128 a[228:231], v9 offset:61440
    v_cvt_pk_bf16_f32 v187, v214, v215
    v_mfma_f32_16x16x32_bf16 a[68:71], a[164:167], v[140:143], a[68:71]
    buffer_load_dwordx4 a[248:251], v254, s[32:35], s57 offen
    v_smfmac_f32_16x16x64_bf16 a[204:207], v[52:55], v[152:159], v50
    v_mfma_f32_16x16x32_bf16 v[212:215], a[208:211], v[80:83], v[196:199]
    v_exp_f32 v208, v208
    v_mfma_f32_16x16x32_bf16 v[212:215], a[212:215], v[84:87], v[212:215]
    v_exp_f32 v209, v209
    v_mfma_f32_16x16x32_bf16 v[212:215], a[216:219], v[88:91], v[212:215]
    v_exp_f32 v210, v210
    v_mfma_f32_16x16x32_bf16 v[212:215], a[220:223], v[92:95], v[212:215]
    v_exp_f32 v211, v211
    v_mfma_f32_16x16x32_bf16 a[72:75], a[160:163], v[144:147], a[72:75]
    ds_read_b64_tr_b16 a[176:177], v26 offset:32768
    v_cvt_pk_bf16_f32 v164, v208, v209
    v_mfma_f32_16x16x32_bf16 a[72:75], a[164:167], v[148:151], a[72:75]
    ds_read_b64_tr_b16 a[178:179], v26 offset:36864
    v_lshlrev_b32 v244, 4, v244
    v_mfma_f32_16x16x32_bf16 a[76:79], a[160:163], v[152:155], a[76:79]
    ds_read_b128 a[232:235], v10 offset:61440
    v_cvt_pk_bf16_f32 v165, v210, v211
    v_mfma_f32_16x16x32_bf16 a[76:79], a[164:167], v[156:159], a[76:79]
    s_waitcnt lgkmcnt(3)
    buffer_load_dwordx4 v49, s[20:23], s49 offen offset:3072 lds
    v_mfma_f32_16x16x32_bf16 v[208:211], a[208:211], v[96:99], v[200:203]
    v_exp_f32 v212, v212
    v_mfma_f32_16x16x32_bf16 v[208:211], a[212:215], v[100:103], v[208:211]
    v_exp_f32 v213, v213
    v_mfma_f32_16x16x32_bf16 v[208:211], a[216:219], v[104:107], v[208:211]
    v_exp_f32 v214, v214
    v_mfma_f32_16x16x32_bf16 v[208:211], a[220:223], v[108:111], v[208:211]
    v_exp_f32 v215, v215
    v_mfma_f32_16x16x32_bf16 a[80:83], a[168:171], v[128:131], a[80:83]
    ds_read_b64_tr_b16 a[180:181], v26 offset:40960
    v_cvt_pk_bf16_f32 v172, v212, v213
    v_mfma_f32_16x16x32_bf16 a[80:83], a[172:175], v[132:135], a[80:83]
    ds_read_b64_tr_b16 a[182:183], v26 offset:45056
    v_and_b32 v245, 1, v0
    v_mfma_f32_16x16x32_bf16 a[84:87], a[168:171], v[136:139], a[84:87]
    ds_read_b128 a[236:239], v11 offset:61440
    v_cvt_pk_bf16_f32 v173, v214, v215
    v_mfma_f32_16x16x32_bf16 a[84:87], a[172:175], v[140:143], a[84:87]
    s_waitcnt vmcnt(12)
    s_barrier
    v_mfma_f32_16x16x32_bf16 v[212:215], a[208:211], v[112:115], v[204:207]
    v_exp_f32 v208, v208
    v_mfma_f32_16x16x32_bf16 v[212:215], a[212:215], v[116:119], v[212:215]
    s_add_u32 s49, s7, 73728
    v_exp_f32 v209, v209
    v_mfma_f32_16x16x32_bf16 v[212:215], a[216:219], v[120:123], v[212:215]
    s_add_u32 m0, s42, 81920
    v_exp_f32 v210, v210
    v_mfma_f32_16x16x32_bf16 v[212:215], a[220:223], v[124:127], v[212:215]
Ltour7:
    s_cbranch_execz Ltour11
    v_exp_f32 v211, v211
    v_mfma_f32_16x16x32_bf16 a[88:91], a[168:171], v[144:147], a[88:91]
    ds_read_b64_tr_b16 a[184:185], v27 offset:32768
    v_cvt_pk_bf16_f32 v180, v208, v209
    v_mfma_f32_16x16x32_bf16 a[88:91], a[172:175], v[148:151], a[88:91]
    ds_read_b64_tr_b16 a[186:187], v27 offset:36864
    v_lshl_add_u32 v244, v245, 2, v244
    v_mfma_f32_16x16x32_bf16 a[92:95], a[168:171], v[152:155], a[92:95]
    v_cvt_pk_bf16_f32 v181, v210, v211
    v_mfma_f32_16x16x32_bf16 a[92:95], a[172:175], v[156:159], a[92:95]
    s_waitcnt lgkmcnt(3)
    buffer_load_dwordx4 v46, s[20:23], s49 offen lds
    v_mfma_f32_16x16x32_bf16 v[208:211], a[224:227], v[64:67], v[192:195]
    v_exp_f32 v212, v212
    v_mfma_f32_16x16x32_bf16 v[208:211], a[228:231], v[68:71], v[208:211]
    v_exp_f32 v213, v213
    v_mfma_f32_16x16x32_bf16 v[208:211], a[232:235], v[72:75], v[208:211]
    s_waitcnt lgkmcnt(2)
    v_exp_f32 v214, v214
    v_mfma_f32_16x16x32_bf16 v[208:211], a[236:239], v[76:79], v[208:211]
    s_add_u32 s37, s55, 8192
    v_exp_f32 v215, v215
    v_mfma_f32_16x16x32_bf16 a[96:99], a[176:179], v[128:131], a[96:99]
    ds_read_b64_tr_b16 a[188:189], v27 offset:40960
    v_cvt_pk_bf16_f32 v188, v212, v213
    v_mfma_f32_16x16x32_bf16 a[96:99], a[180:183], v[132:135], a[96:99]
    ds_read_b64_tr_b16 a[190:191], v27 offset:45056
    v_lshrrev_b32 v245, 3, v0
    v_mfma_f32_16x16x32_bf16 a[100:103], a[176:179], v[136:139], a[100:103]
    v_cvt_pk_bf16_f32 v189, v214, v215
    v_mfma_f32_16x16x32_bf16 a[100:103], a[180:183], v[140:143], a[100:103]
    buffer_load_dword v239, v238, s[28:31], s37 offen
    v_mfma_f32_16x16x32_bf16 v[212:215], a[224:227], v[80:83], v[196:199]
    v_exp_f32 v208, v208
    v_mfma_f32_16x16x32_bf16 v[212:215], a[228:231], v[84:87], v[212:215]
    v_exp_f32 v209, v209
    v_mfma_f32_16x16x32_bf16 v[212:215], a[232:235], v[88:91], v[212:215]
    v_exp_f32 v210, v210
    v_mfma_f32_16x16x32_bf16 v[212:215], a[236:239], v[92:95], v[212:215]
    v_exp_f32 v211, v211
    v_mfma_f32_16x16x32_bf16 a[104:107], a[176:179], v[144:147], a[104:107]
    ds_read_b64_tr_b16 a[160:161], v20 offset:49152
    v_cvt_pk_bf16_f32 v166, v208, v209
    v_mfma_f32_16x16x32_bf16 a[104:107], a[180:183], v[148:151], a[104:107]
    ds_read_b64_tr_b16 a[162:163], v20 offset:53248
    v_min_u32 v245, 1, v245
    v_mfma_f32_16x16x32_bf16 a[108:111], a[176:179], v[152:155], a[108:111]
    v_cvt_pk_bf16_f32 v167, v210, v211
    v_mfma_f32_16x16x32_bf16 a[108:111], a[180:183], v[156:159], a[108:111]
    s_waitcnt lgkmcnt(3)
    buffer_load_dwordx4 v47, s[20:23], s49 offen offset:1024 lds
    v_mfma_f32_16x16x32_bf16 v[208:211], a[224:227], v[96:99], v[200:203]
    v_exp_f32 v212, v212
    v_mfma_f32_16x16x32_bf16 v[208:211], a[228:231], v[100:103], v[208:211]
    v_exp_f32 v213, v213
    v_mfma_f32_16x16x32_bf16 v[208:211], a[232:235], v[104:107], v[208:211]
    v_exp_f32 v214, v214
    v_mfma_f32_16x16x32_bf16 v[208:211], a[236:239], v[108:111], v[208:211]
    s_add_u32 s57, s59, 0
    v_exp_f32 v215, v215
    v_mfma_f32_16x16x32_bf16 a[112:115], a[184:187], v[128:131], a[112:115]
    s_waitcnt lgkmcnt(2)
    ds_read_b64_tr_b16 a[164:165], v20 offset:57344
    v_cvt_pk_bf16_f32 v174, v212, v213
    v_mfma_f32_16x16x32_bf16 a[112:115], a[188:191], v[132:135], a[112:115]
    ds_read_b64_tr_b16 a[166:167], v20 offset:61440
    v_lshl_or_b32 v244, v245, 31, v244
    v_mfma_f32_16x16x32_bf16 a[116:119], a[184:187], v[136:139], a[116:119]
    v_cvt_pk_bf16_f32 v175, v214, v215
    v_mfma_f32_16x16x32_bf16 a[116:119], a[188:191], v[140:143], a[116:119]
    buffer_load_dwordx4 a[252:255], v255, s[84:87], s57 offen
    v_mfma_f32_16x16x32_bf16 v[212:215], a[224:227], v[112:115], v[204:207]
    v_exp_f32 v208, v208
    v_mfma_f32_16x16x32_bf16 v[212:215], a[228:231], v[116:119], v[212:215]
    v_exp_f32 v209, v209
    v_mfma_f32_16x16x32_bf16 v[212:215], a[232:235], v[120:123], v[212:215]
    v_exp_f32 v210, v210
    v_mfma_f32_16x16x32_bf16 v[212:215], a[236:239], v[124:127], v[212:215]
    v_exp_f32 v211, v211
    v_mfma_f32_16x16x32_bf16 a[120:123], a[184:187], v[144:147], a[120:123]
    ds_read_b64_tr_b16 a[168:169], v21 offset:49152
    v_cvt_pk_bf16_f32 v182, v208, v209
    v_mfma_f32_16x16x32_bf16 a[120:123], a[188:191], v[148:151], a[120:123]
    ds_read_b64_tr_b16 a[170:171], v21 offset:53248
    v_mfma_f32_16x16x32_bf16 a[124:127], a[184:187], v[152:155], a[124:127]
    v_cvt_pk_bf16_f32 v183, v210, v211
    v_mfma_f32_16x16x32_bf16 a[124:127], a[188:191], v[156:159], a[124:127]
    s_waitcnt lgkmcnt(3)
    buffer_load_dwordx4 v48, s[20:23], s49 offen offset:2048 lds
    v_smfmac_f32_16x16x64_bf16 a[192:195], v[52:55], v[160:167], v50
    v_exp_f32 v212, v212
    v_smfmac_f32_16x16x64_bf16 a[196:199], v[52:55], v[168:175], v50
    v_exp_f32 v213, v213
    v_smfmac_f32_16x16x64_bf16 a[200:203], v[52:55], v[176:183], v50
    v_exp_f32 v214, v214
    v_exp_f32 v215, v215
    v_mfma_f32_16x16x32_bf16 a[0:3], a[160:163], v[160:163], a[0:3]
    s_waitcnt lgkmcnt(2)
    ds_read_b64_tr_b16 a[172:173], v21 offset:57344
    v_cvt_pk_bf16_f32 v190, v212, v213
    v_mfma_f32_16x16x32_bf16 a[0:3], a[164:167], v[164:167], a[0:3]
    ds_read_b64_tr_b16 a[174:175], v21 offset:61440
    v_mfma_f32_16x16x32_bf16 a[4:7], a[160:163], v[168:171], a[4:7]
    v_cvt_pk_bf16_f32 v191, v214, v215
    v_mfma_f32_16x16x32_bf16 a[4:7], a[164:167], v[172:175], a[4:7]
    buffer_store_dword v246, v244, s[24:27], s39 offen sc1
    v_smfmac_f32_16x16x64_bf16 a[204:207], v[52:55], v[184:191], v50
    v_mfma_f32_16x16x32_bf16 a[8:11], a[160:163], v[176:179], a[8:11]
    ds_read_b64_tr_b16 a[176:177], v22 offset:49152
    v_mfma_f32_16x16x32_bf16 a[8:11], a[164:167], v[180:183], a[8:11]
    ds_read_b64_tr_b16 a[178:179], v22 offset:53248
    v_accvgpr_read_b32 v216, a192
    v_accvgpr_read_b32 v217, a193
    v_mfma_f32_16x16x32_bf16 a[12:15], a[160:163], v[184:187], a[12:15]
    v_accvgpr_read_b32 v218, a196
    v_accvgpr_read_b32 v219, a197
    v_mfma_f32_16x16x32_bf16 a[12:15], a[164:167], v[188:191], a[12:15]
    s_waitcnt lgkmcnt(4)
    buffer_load_dwordx4 v49, s[20:23], s49 offen offset:3072 lds
    v_accvgpr_read_b32 v220, a200
    v_accvgpr_read_b32 v221, a201
    v_mfma_f32_16x16x32_bf16 a[16:19], a[168:171], v[160:163], a[16:19]
    s_waitcnt lgkmcnt(2)
    ds_read_b64_tr_b16 a[180:181], v22 offset:57344
    v_accvgpr_read_b32 v222, a204
    v_mfma_f32_16x16x32_bf16 a[16:19], a[172:175], v[164:167], a[16:19]
    ds_read_b64_tr_b16 a[182:183], v22 offset:61440
    v_accvgpr_read_b32 v223, a205
    v_add_f32 v58, v216, v217
    v_mfma_f32_16x16x32_bf16 a[20:23], a[168:171], v[168:171], a[20:23]
    v_add_f32 v59, v218, v219
    v_add_f32 v60, v220, v221
    v_mfma_f32_16x16x32_bf16 a[20:23], a[172:175], v[172:175], a[20:23]
    v_add_f32 v61, v222, v223
    v_add_f32 v216, v58, v59
    s_add_u32 s49, s7, 256
    s_add_u32 m0, s42, 32768
    v_mfma_f32_16x16x32_bf16 a[24:27], a[168:171], v[176:179], a[24:27]
    ds_read_b64_tr_b16 a[184:185], v23 offset:49152
    v_add_f32 v217, v60, v61
    v_mfma_f32_16x16x32_bf16 a[24:27], a[172:175], v[180:183], a[24:27]
    ds_read_b64_tr_b16 a[186:187], v23 offset:53248
    v_add_f32 v216, v216, v217
    v_cmp_ngt_f32 vcc, 1669332992, v216
    v_mfma_f32_16x16x32_bf16 a[28:31], a[168:171], v[184:187], a[28:31]
    v_rcp_f32 v58, v58
    v_rcp_f32 v59, v59
    v_mfma_f32_16x16x32_bf16 a[28:31], a[172:175], v[188:191], a[28:31]
    s_waitcnt lgkmcnt(4)
    buffer_load_dwordx4 v46, s[20:23], s49 offen lds
    v_rcp_f32 v60, v60
    v_rcp_f32 v61, v61
    v_mfma_f32_16x16x32_bf16 a[32:35], a[176:179], v[160:163], a[32:35]
    s_waitcnt lgkmcnt(2)
    ds_read_b64_tr_b16 a[188:189], v23 offset:57344
    v_mov_b32 v228, 131072
    v_mfma_f32_16x16x32_bf16 a[32:35], a[180:183], v[164:167], a[32:35]
    ds_read_b64_tr_b16 a[190:191], v23 offset:61440
    s_or_b32 s36, vcc_lo, vcc_hi
    v_mfma_f32_16x16x32_bf16 a[36:39], a[176:179], v[168:171], a[36:39]
    v_accvgpr_read_b32 v208, a0
    v_accvgpr_read_b32 v209, a1
    v_accvgpr_read_b32 v210, a2
    v_accvgpr_read_b32 v211, a3
    v_pk_mul_f32 v[208:209], v[208:209], v[58:59] op_sel:[0,0] op_sel_hi:[1,0]
    v_pk_mul_f32 v[210:211], v[210:211], v[58:59] op_sel:[0,0] op_sel_hi:[1,0]
    v_cvt_pk_bf16_f32 v128, v208, v209
    v_cvt_pk_bf16_f32 v129, v210, v211
    v_mfma_f32_16x16x32_bf16 a[36:39], a[180:183], v[172:175], a[36:39]
    v_accvgpr_read_b32 v212, a4
    v_accvgpr_read_b32 v213, a5
    v_accvgpr_read_b32 v214, a6
    v_accvgpr_read_b32 v215, a7
    v_pk_mul_f32 v[212:213], v[212:213], v[58:59] op_sel:[0,1] op_sel_hi:[1,1]
    v_pk_mul_f32 v[214:215], v[214:215], v[58:59] op_sel:[0,1] op_sel_hi:[1,1]
    v_cvt_pk_bf16_f32 v132, v212, v213
    v_cvt_pk_bf16_f32 v133, v214, v215
    v_mfma_f32_16x16x32_bf16 a[40:43], a[176:179], v[176:179], a[40:43]
    ds_read_b64_tr_b16 a[160:161], v24 offset:49152
    v_mov_b32 v218, s36
    v_mfma_f32_16x16x32_bf16 a[40:43], a[180:183], v[180:183], a[40:43]
    ds_read_b64_tr_b16 a[162:163], v24 offset:53248
    s_lshl_b32 s38, s3, 2
    v_mfma_f32_16x16x32_bf16 a[44:47], a[176:179], v[184:187], a[44:47]
    v_accvgpr_read_b32 v208, a8
    v_accvgpr_read_b32 v209, a9
    v_accvgpr_read_b32 v210, a10
    v_accvgpr_read_b32 v211, a11
    v_pk_mul_f32 v[208:209], v[208:209], v[60:61] op_sel:[0,0] op_sel_hi:[1,0]
    v_pk_mul_f32 v[210:211], v[210:211], v[60:61] op_sel:[0,0] op_sel_hi:[1,0]
    v_cvt_pk_bf16_f32 v136, v208, v209
    v_cvt_pk_bf16_f32 v137, v210, v211
    v_mfma_f32_16x16x32_bf16 a[44:47], a[180:183], v[188:191], a[44:47]
    s_waitcnt lgkmcnt(4)
    buffer_load_dwordx4 v47, s[20:23], s49 offen offset:1024 lds
    v_accvgpr_read_b32 v212, a12
    v_accvgpr_read_b32 v213, a13
    v_accvgpr_read_b32 v214, a14
    v_accvgpr_read_b32 v215, a15
    v_pk_mul_f32 v[212:213], v[212:213], v[60:61] op_sel:[0,1] op_sel_hi:[1,1]
    v_pk_mul_f32 v[214:215], v[214:215], v[60:61] op_sel:[0,1] op_sel_hi:[1,1]
    v_cvt_pk_bf16_f32 v140, v212, v213
    v_cvt_pk_bf16_f32 v141, v214, v215
    v_mfma_f32_16x16x32_bf16 a[48:51], a[184:187], v[160:163], a[48:51]
    s_waitcnt lgkmcnt(2)
    ds_read_b64_tr_b16 a[164:165], v24 offset:57344
    v_add_u32 v219, s38, v228
    v_mfma_f32_16x16x32_bf16 a[48:51], a[188:191], v[164:167], a[48:51]
    ds_read_b64_tr_b16 a[166:167], v24 offset:61440
    ds_write_b32 v219, v218
    v_mfma_f32_16x16x32_bf16 a[52:55], a[184:187], v[168:171], a[52:55]
    v_accvgpr_read_b32 v208, a16
    v_accvgpr_read_b32 v209, a17
    v_accvgpr_read_b32 v210, a18
    v_accvgpr_read_b32 v211, a19
    v_pk_mul_f32 v[208:209], v[208:209], v[58:59] op_sel:[0,0] op_sel_hi:[1,0]
    v_pk_mul_f32 v[210:211], v[210:211], v[58:59] op_sel:[0,0] op_sel_hi:[1,0]
    v_cvt_pk_bf16_f32 v130, v208, v209
    v_cvt_pk_bf16_f32 v131, v210, v211
    s_add_u32 s37, s55, 0
    buffer_store_dwordx4 v[128:131], v252, s[28:31], s37 offen offset:0
    v_mfma_f32_16x16x32_bf16 a[52:55], a[188:191], v[172:175], a[52:55]
    v_accvgpr_read_b32 v212, a20
    v_accvgpr_read_b32 v213, a21
    v_accvgpr_read_b32 v214, a22
    v_accvgpr_read_b32 v215, a23
    v_pk_mul_f32 v[212:213], v[212:213], v[58:59] op_sel:[0,1] op_sel_hi:[1,1]
    v_pk_mul_f32 v[214:215], v[214:215], v[58:59] op_sel:[0,1] op_sel_hi:[1,1]
    v_cvt_pk_bf16_f32 v134, v212, v213
    v_cvt_pk_bf16_f32 v135, v214, v215
    s_add_u32 s37, s55, 8192
    buffer_store_dwordx4 v[132:135], v252, s[28:31], s37 offen offset:0
    v_mfma_f32_16x16x32_bf16 a[56:59], a[184:187], v[176:179], a[56:59]
    ds_read_b64_tr_b16 a[168:169], v25 offset:49152
    v_min_u32 v240, 1, v0
    v_mfma_f32_16x16x32_bf16 a[56:59], a[188:191], v[180:183], a[56:59]
    ds_read_b64_tr_b16 a[170:171], v25 offset:53248
    v_mfma_f32_16x16x32_bf16 a[60:63], a[184:187], v[184:187], a[60:63]
    v_accvgpr_read_b32 v208, a24
    v_accvgpr_read_b32 v209, a25
    v_accvgpr_read_b32 v210, a26
    v_accvgpr_read_b32 v211, a27
    v_pk_mul_f32 v[208:209], v[208:209], v[60:61] op_sel:[0,0] op_sel_hi:[1,0]
    v_pk_mul_f32 v[210:211], v[210:211], v[60:61] op_sel:[0,0] op_sel_hi:[1,0]
    v_cvt_pk_bf16_f32 v138, v208, v209
    v_cvt_pk_bf16_f32 v139, v210, v211
    s_add_u32 s37, s55, 4096
    buffer_store_dwordx4 v[136:139], v252, s[28:31], s37 offen offset:0
    v_mfma_f32_16x16x32_bf16 a[60:63], a[188:191], v[188:191], a[60:63]
    s_waitcnt lgkmcnt(5)
    buffer_load_dwordx4 v48, s[20:23], s49 offen offset:2048 lds
    v_accvgpr_read_b32 v212, a28
    v_accvgpr_read_b32 v213, a29
    v_accvgpr_read_b32 v214, a30
    v_accvgpr_read_b32 v215, a31
    v_pk_mul_f32 v[212:213], v[212:213], v[60:61] op_sel:[0,1] op_sel_hi:[1,1]
    v_pk_mul_f32 v[214:215], v[214:215], v[60:61] op_sel:[0,1] op_sel_hi:[1,1]
    v_cvt_pk_bf16_f32 v142, v212, v213
    v_cvt_pk_bf16_f32 v143, v214, v215
    s_add_u32 s37, s55, 12288
    buffer_store_dwordx4 v[140:143], v252, s[28:31], s37 offen offset:0
    v_mfma_f32_16x16x32_bf16 a[64:67], a[160:163], v[160:163], a[64:67]
    s_waitcnt lgkmcnt(3)
    ds_read_b64_tr_b16 a[172:173], v25 offset:57344
    v_lshlrev_b32 v240, 31, v240
    v_mfma_f32_16x16x32_bf16 a[64:67], a[164:167], v[164:167], a[64:67]
    ds_read_b64_tr_b16 a[174:175], v25 offset:61440
    v_mfma_f32_16x16x32_bf16 a[68:71], a[160:163], v[168:171], a[68:71]
    v_accvgpr_read_b32 v208, a32
    v_accvgpr_read_b32 v209, a33
    v_accvgpr_read_b32 v210, a34
    v_accvgpr_read_b32 v211, a35
    v_pk_mul_f32 v[208:209], v[208:209], v[58:59] op_sel:[0,0] op_sel_hi:[1,0]
    v_pk_mul_f32 v[210:211], v[210:211], v[58:59] op_sel:[0,0] op_sel_hi:[1,0]
    v_cvt_pk_bf16_f32 v144, v208, v209
    v_cvt_pk_bf16_f32 v145, v210, v211
    v_mfma_f32_16x16x32_bf16 a[68:71], a[164:167], v[172:175], a[68:71]
    v_accvgpr_read_b32 v212, a36
    v_accvgpr_read_b32 v213, a37
    v_accvgpr_read_b32 v214, a38
    v_accvgpr_read_b32 v215, a39
    v_pk_mul_f32 v[212:213], v[212:213], v[58:59] op_sel:[0,1] op_sel_hi:[1,1]
    v_pk_mul_f32 v[214:215], v[214:215], v[58:59] op_sel:[0,1] op_sel_hi:[1,1]
    v_cvt_pk_bf16_f32 v148, v212, v213
    v_cvt_pk_bf16_f32 v149, v214, v215
    v_mfma_f32_16x16x32_bf16 a[72:75], a[160:163], v[176:179], a[72:75]
    ds_read_b64_tr_b16 a[176:177], v26 offset:49152
    v_mov_b32 v241, 1
    v_mfma_f32_16x16x32_bf16 a[72:75], a[164:167], v[180:183], a[72:75]
    ds_read_b64_tr_b16 a[178:179], v26 offset:53248
    v_mfma_f32_16x16x32_bf16 a[76:79], a[160:163], v[184:187], a[76:79]
    v_accvgpr_read_b32 v208, a40
    v_accvgpr_read_b32 v209, a41
    v_accvgpr_read_b32 v210, a42
    v_accvgpr_read_b32 v211, a43
    v_pk_mul_f32 v[208:209], v[208:209], v[60:61] op_sel:[0,0] op_sel_hi:[1,0]
    v_pk_mul_f32 v[210:211], v[210:211], v[60:61] op_sel:[0,0] op_sel_hi:[1,0]
    v_cvt_pk_bf16_f32 v152, v208, v209
    v_cvt_pk_bf16_f32 v153, v210, v211
    v_mfma_f32_16x16x32_bf16 a[76:79], a[164:167], v[188:191], a[76:79]
    s_waitcnt lgkmcnt(4)
    buffer_load_dwordx4 v49, s[20:23], s49 offen offset:3072 lds
    v_accvgpr_read_b32 v212, a44
    v_accvgpr_read_b32 v213, a45
    v_accvgpr_read_b32 v214, a46
    v_accvgpr_read_b32 v215, a47
    v_pk_mul_f32 v[212:213], v[212:213], v[60:61] op_sel:[0,1] op_sel_hi:[1,1]
    v_pk_mul_f32 v[214:215], v[214:215], v[60:61] op_sel:[0,1] op_sel_hi:[1,1]
    v_cvt_pk_bf16_f32 v156, v212, v213
    v_cvt_pk_bf16_f32 v157, v214, v215
    v_mfma_f32_16x16x32_bf16 a[80:83], a[168:171], v[160:163], a[80:83]
    s_waitcnt lgkmcnt(2)
    ds_read_b64_tr_b16 a[180:181], v26 offset:57344
    v_mfma_f32_16x16x32_bf16 a[80:83], a[172:175], v[164:167], a[80:83]
    ds_read_b64_tr_b16 a[182:183], v26 offset:61440
    v_mfma_f32_16x16x32_bf16 a[84:87], a[168:171], v[168:171], a[84:87]
    v_accvgpr_read_b32 v208, a48
    v_accvgpr_read_b32 v209, a49
    v_accvgpr_read_b32 v210, a50
    v_accvgpr_read_b32 v211, a51
    v_pk_mul_f32 v[208:209], v[208:209], v[58:59] op_sel:[0,0] op_sel_hi:[1,0]
    v_pk_mul_f32 v[210:211], v[210:211], v[58:59] op_sel:[0,0] op_sel_hi:[1,0]
    v_cvt_pk_bf16_f32 v146, v208, v209
    v_cvt_pk_bf16_f32 v147, v210, v211
    s_add_u32 s37, s55, 0
    buffer_store_dwordx4 v[144:147], v252, s[28:31], s37 offen offset:1024
    v_mfma_f32_16x16x32_bf16 a[84:87], a[172:175], v[172:175], a[84:87]
    v_accvgpr_read_b32 v212, a52
    v_accvgpr_read_b32 v213, a53
    v_accvgpr_read_b32 v214, a54
    v_accvgpr_read_b32 v215, a55
    v_pk_mul_f32 v[212:213], v[212:213], v[58:59] op_sel:[0,1] op_sel_hi:[1,1]
    v_pk_mul_f32 v[214:215], v[214:215], v[58:59] op_sel:[0,1] op_sel_hi:[1,1]
    v_cvt_pk_bf16_f32 v150, v212, v213
    v_cvt_pk_bf16_f32 v151, v214, v215
    s_add_u32 s37, s55, 8192
    buffer_store_dwordx4 v[148:151], v252, s[28:31], s37 offen offset:1024
    s_waitcnt vmcnt(23)
    s_barrier
    v_mfma_f32_16x16x32_bf16 a[88:91], a[168:171], v[176:179], a[88:91]
    ds_read_b64_tr_b16 a[184:185], v27 offset:49152
    v_mfma_f32_16x16x32_bf16 a[88:91], a[172:175], v[180:183], a[88:91]
    ds_read_b64_tr_b16 a[186:187], v27 offset:53248
    v_mfma_f32_16x16x32_bf16 a[92:95], a[168:171], v[184:187], a[92:95]
    ds_read_b128 v[224:227], v228
    v_accvgpr_read_b32 v208, a56
    v_accvgpr_read_b32 v209, a57
    v_accvgpr_read_b32 v210, a58
    v_accvgpr_read_b32 v211, a59
    v_pk_mul_f32 v[208:209], v[208:209], v[60:61] op_sel:[0,0] op_sel_hi:[1,0]
    v_pk_mul_f32 v[210:211], v[210:211], v[60:61] op_sel:[0,0] op_sel_hi:[1,0]
    v_cvt_pk_bf16_f32 v154, v208, v209
    v_cvt_pk_bf16_f32 v155, v210, v211
    s_add_u32 s37, s55, 4096
    buffer_store_dwordx4 v[152:155], v252, s[28:31], s37 offen offset:1024
    v_mfma_f32_16x16x32_bf16 a[92:95], a[172:175], v[188:191], a[92:95]
    s_waitcnt lgkmcnt(5)
    v_accvgpr_read_b32 v212, a60
    v_accvgpr_read_b32 v213, a61
    v_accvgpr_read_b32 v214, a62
    v_accvgpr_read_b32 v215, a63
    v_pk_mul_f32 v[212:213], v[212:213], v[60:61] op_sel:[0,1] op_sel_hi:[1,1]
    v_pk_mul_f32 v[214:215], v[214:215], v[60:61] op_sel:[0,1] op_sel_hi:[1,1]
    v_cvt_pk_bf16_f32 v158, v212, v213
    v_cvt_pk_bf16_f32 v159, v214, v215
    s_add_u32 s37, s55, 12288
    buffer_store_dwordx4 v[156:159], v252, s[28:31], s37 offen offset:1024
    s_add_u32 s49, s7, 73984
    v_mfma_f32_16x16x32_bf16 a[96:99], a[176:179], v[160:163], a[96:99]
    s_waitcnt lgkmcnt(3)
    s_add_u32 m0, s42, 49152
    ds_read_b64_tr_b16 a[188:189], v27 offset:57344
    v_mfma_f32_16x16x32_bf16 a[96:99], a[180:183], v[164:167], a[96:99]
    buffer_load_dwordx4 v46, s[20:23], s49 offen lds
    v_mfma_f32_16x16x32_bf16 a[100:103], a[176:179], v[168:171], a[100:103]
    ds_read_b64_tr_b16 a[190:191], v27 offset:61440
    v_accvgpr_read_b32 v208, a64
    v_accvgpr_read_b32 v209, a65
    v_accvgpr_read_b32 v210, a66
    v_accvgpr_read_b32 v211, a67
    v_pk_mul_f32 v[208:209], v[208:209], v[58:59] op_sel:[0,0] op_sel_hi:[1,0]
    v_pk_mul_f32 v[210:211], v[210:211], v[58:59] op_sel:[0,0] op_sel_hi:[1,0]
    v_cvt_pk_bf16_f32 v192, v208, v209
    v_cvt_pk_bf16_f32 v193, v210, v211
    v_mfma_f32_16x16x32_bf16 a[100:103], a[180:183], v[172:175], a[100:103]
    buffer_load_dwordx4 v47, s[20:23], s49 offen offset:1024 lds
    v_accvgpr_read_b32 v212, a68
    v_accvgpr_read_b32 v213, a69
    v_accvgpr_read_b32 v214, a70
    v_accvgpr_read_b32 v215, a71
    v_pk_mul_f32 v[212:213], v[212:213], v[58:59] op_sel:[0,1] op_sel_hi:[1,1]
    v_pk_mul_f32 v[214:215], v[214:215], v[58:59] op_sel:[0,1] op_sel_hi:[1,1]
    v_cvt_pk_bf16_f32 v196, v212, v213
    v_cvt_pk_bf16_f32 v197, v214, v215
    v_mfma_f32_16x16x32_bf16 a[104:107], a[176:179], v[176:179], a[104:107]
    v_mfma_f32_16x16x32_bf16 a[104:107], a[180:183], v[180:183], a[104:107]
    buffer_load_dwordx4 v48, s[20:23], s49 offen offset:2048 lds
    v_mfma_f32_16x16x32_bf16 a[108:111], a[176:179], v[184:187], a[108:111]
    v_accvgpr_read_b32 v208, a72
    v_accvgpr_read_b32 v209, a73
    v_accvgpr_read_b32 v210, a74
    v_accvgpr_read_b32 v211, a75
    v_pk_mul_f32 v[208:209], v[208:209], v[60:61] op_sel:[0,0] op_sel_hi:[1,0]
    v_pk_mul_f32 v[210:211], v[210:211], v[60:61] op_sel:[0,0] op_sel_hi:[1,0]
    v_cvt_pk_bf16_f32 v200, v208, v209
    v_cvt_pk_bf16_f32 v201, v210, v211
    v_mfma_f32_16x16x32_bf16 a[108:111], a[180:183], v[188:191], a[108:111]
    s_waitcnt lgkmcnt(3)
    buffer_load_dwordx4 v49, s[20:23], s49 offen offset:3072 lds
    v_accvgpr_read_b32 v212, a76
    v_accvgpr_read_b32 v213, a77
    v_accvgpr_read_b32 v214, a78
    v_accvgpr_read_b32 v215, a79
    v_pk_mul_f32 v[212:213], v[212:213], v[60:61] op_sel:[0,1] op_sel_hi:[1,1]
    v_pk_mul_f32 v[214:215], v[214:215], v[60:61] op_sel:[0,1] op_sel_hi:[1,1]
    v_cvt_pk_bf16_f32 v204, v212, v213
    v_cvt_pk_bf16_f32 v205, v214, v215
    s_add_u32 s49, s46, 0
    v_mfma_f32_16x16x32_bf16 a[112:115], a[184:187], v[160:163], a[112:115]
    s_waitcnt lgkmcnt(0)
    s_add_u32 m0, s42, 98304
    v_mfma_f32_16x16x32_bf16 a[112:115], a[188:191], v[164:167], a[112:115]
    buffer_load_dwordx4 v46, s[20:23], s49 offen lds
    v_mfma_f32_16x16x32_bf16 a[116:119], a[184:187], v[168:171], a[116:119]
    v_accvgpr_read_b32 v208, a80
    v_accvgpr_read_b32 v209, a81
    v_accvgpr_read_b32 v210, a82
    v_accvgpr_read_b32 v211, a83
    v_pk_mul_f32 v[208:209], v[208:209], v[58:59] op_sel:[0,0] op_sel_hi:[1,0]
    v_pk_mul_f32 v[210:211], v[210:211], v[58:59] op_sel:[0,0] op_sel_hi:[1,0]
    v_cvt_pk_bf16_f32 v194, v208, v209
    v_cvt_pk_bf16_f32 v195, v210, v211
    s_add_u32 s37, s55, 0
    buffer_store_dwordx4 v[192:195], v252, s[28:31], s37 offen offset:2048
    v_mfma_f32_16x16x32_bf16 a[116:119], a[188:191], v[172:175], a[116:119]
    buffer_load_dwordx4 v47, s[20:23], s49 offen offset:1024 lds
    v_accvgpr_read_b32 v212, a84
    v_accvgpr_read_b32 v213, a85
    v_accvgpr_read_b32 v214, a86
    v_accvgpr_read_b32 v215, a87
    v_pk_mul_f32 v[212:213], v[212:213], v[58:59] op_sel:[0,1] op_sel_hi:[1,1]
    v_pk_mul_f32 v[214:215], v[214:215], v[58:59] op_sel:[0,1] op_sel_hi:[1,1]
    v_cvt_pk_bf16_f32 v198, v212, v213
    v_cvt_pk_bf16_f32 v199, v214, v215
    s_add_u32 s37, s55, 8192
    buffer_store_dwordx4 v[196:199], v252, s[28:31], s37 offen offset:2048
    v_mfma_f32_16x16x32_bf16 a[120:123], a[184:187], v[176:179], a[120:123]
    v_mfma_f32_16x16x32_bf16 a[120:123], a[188:191], v[180:183], a[120:123]
    buffer_load_dwordx4 v48, s[20:23], s49 offen offset:2048 lds
    v_mfma_f32_16x16x32_bf16 a[124:127], a[184:187], v[184:187], a[124:127]
    v_accvgpr_read_b32 v208, a88
    v_accvgpr_read_b32 v209, a89
    v_accvgpr_read_b32 v210, a90
    v_accvgpr_read_b32 v211, a91
    v_pk_mul_f32 v[208:209], v[208:209], v[60:61] op_sel:[0,0] op_sel_hi:[1,0]
    v_pk_mul_f32 v[210:211], v[210:211], v[60:61] op_sel:[0,0] op_sel_hi:[1,0]
    v_cvt_pk_bf16_f32 v202, v208, v209
    v_cvt_pk_bf16_f32 v203, v210, v211
    s_add_u32 s37, s55, 4096
    buffer_store_dwordx4 v[200:203], v252, s[28:31], s37 offen offset:2048
    v_mfma_f32_16x16x32_bf16 a[124:127], a[188:191], v[188:191], a[124:127]
    buffer_load_dwordx4 v49, s[20:23], s49 offen offset:3072 lds
    v_accvgpr_read_b32 v212, a92
    v_accvgpr_read_b32 v213, a93
    v_accvgpr_read_b32 v214, a94
    v_accvgpr_read_b32 v215, a95
    v_pk_mul_f32 v[212:213], v[212:213], v[60:61] op_sel:[0,1] op_sel_hi:[1,1]
    v_pk_mul_f32 v[214:215], v[214:215], v[60:61] op_sel:[0,1] op_sel_hi:[1,1]
    v_cvt_pk_bf16_f32 v206, v212, v213
    v_cvt_pk_bf16_f32 v207, v214, v215
    s_add_u32 s37, s55, 12288
    buffer_store_dwordx4 v[204:207], v252, s[28:31], s37 offen offset:2048
    v_or3_b32 v224, v224, v225, v226
    v_or_b32 v224, v224, v227
    s_nop 0
    v_readfirstlane_b32 s36, v224
    v_readfirstlane_b32 s38, v253
    v_min_u32 v8, 1, v1
    v_lshlrev_b32 v8, 31, v8
    v_mov_b32 v10, s95
    s_getreg_b32 s39, hwreg(HW_REG_XCC_ID, 0, 4)
    s_add_u32 s39, s39, s95
    s_cmp_eq_u32 s38, s39
    s_cselect_b32 s53, 1, 0
    ds_read_b64_tr_b16 a[208:209], v12 offset:0
    ds_read_b64_tr_b16 a[210:211], v12 offset:4096
    ds_read_b64_tr_b16 a[212:213], v12 offset:8192
    ds_read_b64_tr_b16 a[214:215], v12 offset:12288
    ds_read_b64_tr_b16 a[216:217], v12 offset:16384
    ds_read_b64_tr_b16 a[218:219], v12 offset:20480
    ds_read_b64_tr_b16 a[220:221], v12 offset:24576
    ds_read_b64_tr_b16 a[222:223], v12 offset:28672
    ds_read_b64_tr_b16 a[224:225], v16 offset:0
    ds_read_b64_tr_b16 a[226:227], v16 offset:4096
    ds_read_b64_tr_b16 a[228:229], v16 offset:8192
    ds_read_b64_tr_b16 a[230:231], v16 offset:12288
    ds_read_b64_tr_b16 a[232:233], v16 offset:16384
    ds_read_b64_tr_b16 a[234:235], v16 offset:20480
    ds_read_b64_tr_b16 a[236:237], v16 offset:24576
    ds_read_b64_tr_b16 a[238:239], v16 offset:28672
    s_andn2_b32 s36, s36, s48
    s_cbranch_scc1 Lattn_redo
    v_accvgpr_read_b32 v208, a96
    v_accvgpr_read_b32 v209, a97
    v_accvgpr_read_b32 v210, a98
    v_accvgpr_read_b32 v211, a99
    v_pk_mul_f32 v[208:209], v[208:209], v[58:59] op_sel:[0,0] op_sel_hi:[1,0]
    v_pk_mul_f32 v[210:211], v[210:211], v[58:59] op_sel:[0,0] op_sel_hi:[1,0]
    v_cvt_pk_bf16_f32 v176, v208, v209
    v_cvt_pk_bf16_f32 v177, v210, v211
    v_accvgpr_read_b32 v212, a100
    v_accvgpr_read_b32 v213, a101
    v_accvgpr_read_b32 v214, a102
    v_accvgpr_read_b32 v215, a103
    v_pk_mul_f32 v[212:213], v[212:213], v[58:59] op_sel:[0,1] op_sel_hi:[1,1]
    v_pk_mul_f32 v[214:215], v[214:215], v[58:59] op_sel:[0,1] op_sel_hi:[1,1]
    v_cvt_pk_bf16_f32 v180, v212, v213
    v_cvt_pk_bf16_f32 v181, v214, v215
    v_accvgpr_read_b32 v208, a104
    v_accvgpr_read_b32 v209, a105
    v_accvgpr_read_b32 v210, a106
    v_accvgpr_read_b32 v211, a107
    v_pk_mul_f32 v[208:209], v[208:209], v[60:61] op_sel:[0,0] op_sel_hi:[1,0]
    v_pk_mul_f32 v[210:211], v[210:211], v[60:61] op_sel:[0,0] op_sel_hi:[1,0]
    v_cvt_pk_bf16_f32 v184, v208, v209
    v_cvt_pk_bf16_f32 v185, v210, v211
    v_accvgpr_read_b32 v212, a108
    v_accvgpr_read_b32 v213, a109
    v_accvgpr_read_b32 v214, a110
    v_accvgpr_read_b32 v215, a111
    v_pk_mul_f32 v[212:213], v[212:213], v[60:61] op_sel:[0,1] op_sel_hi:[1,1]
    v_pk_mul_f32 v[214:215], v[214:215], v[60:61] op_sel:[0,1] op_sel_hi:[1,1]
    v_cvt_pk_bf16_f32 v188, v212, v213
    v_cvt_pk_bf16_f32 v189, v214, v215
    v_accvgpr_read_b32 v208, a112
    v_accvgpr_read_b32 v209, a113
    v_accvgpr_read_b32 v210, a114
    v_accvgpr_read_b32 v211, a115
    v_pk_mul_f32 v[208:209], v[208:209], v[58:59] op_sel:[0,0] op_sel_hi:[1,0]
    v_pk_mul_f32 v[210:211], v[210:211], v[58:59] op_sel:[0,0] op_sel_hi:[1,0]
    v_cvt_pk_bf16_f32 v178, v208, v209
    v_cvt_pk_bf16_f32 v179, v210, v211
    s_add_u32 s37, s55, 0
    buffer_store_dwordx4 v[176:179], v252, s[28:31], s37 offen offset:3072
    v_accvgpr_read_b32 v212, a116
    v_accvgpr_read_b32 v213, a117
    v_accvgpr_read_b32 v214, a118
    v_accvgpr_read_b32 v215, a119
    v_pk_mul_f32 v[212:213], v[212:213], v[58:59] op_sel:[0,1] op_sel_hi:[1,1]
    v_pk_mul_f32 v[214:215], v[214:215], v[58:59] op_sel:[0,1] op_sel_hi:[1,1]
    v_cvt_pk_bf16_f32 v182, v212, v213
    v_cvt_pk_bf16_f32 v183, v214, v215
    s_add_u32 s37, s55, 8192
Ltour8:
    s_cbranch_execz Ltour12
    buffer_store_dwordx4 v[180:183], v252, s[28:31], s37 offen offset:3072
    v_accvgpr_read_b32 v208, a120
    v_accvgpr_read_b32 v209, a121
    v_accvgpr_read_b32 v210, a122
    v_accvgpr_read_b32 v211, a123
    v_pk_mul_f32 v[208:209], v[208:209], v[60:61] op_sel:[0,0] op_sel_hi:[1,0]
    v_pk_mul_f32 v[210:211], v[210:211], v[60:61] op_sel:[0,0] op_sel_hi:[1,0]
    v_cvt_pk_bf16_f32 v186, v208, v209
    v_cvt_pk_bf16_f32 v187, v210, v211
    s_add_u32 s37, s55, 4096
    buffer_store_dwordx4 v[184:187], v252, s[28:31], s37 offen offset:3072
    v_accvgpr_read_b32 v212, a124
    v_accvgpr_read_b32 v213, a125
    v_accvgpr_read_b32 v214, a126
    v_accvgpr_read_b32 v215, a127
    v_pk_mul_f32 v[212:213], v[212:213], v[60:61] op_sel:[0,1] op_sel_hi:[1,1]
    v_pk_mul_f32 v[214:215], v[214:215], v[60:61] op_sel:[0,1] op_sel_hi:[1,1]
    v_cvt_pk_bf16_f32 v190, v212, v213
    v_cvt_pk_bf16_f32 v191, v214, v215
    s_add_u32 s37, s55, 12288
    buffer_store_dwordx4 v[188:191], v252, s[28:31], s37 offen offset:3072
    s_waitcnt lgkmcnt(14)
    v_mfma_f32_16x16x32_bf16 v[96:99], a[208:211], v[128:131], 0
    s_waitcnt lgkmcnt(12)
    ds_read_b64_tr_b16 a[160:161], v13 offset:0
    v_mfma_f32_16x16x32_bf16 v[96:99], a[212:215], v[144:147], v[96:99]
    s_waitcnt lgkmcnt(11)
    ds_read_b64_tr_b16 a[162:163], v13 offset:4096
    v_mfma_f32_16x16x32_bf16 v[96:99], a[216:219], v[192:195], v[96:99]
    s_waitcnt lgkmcnt(10)
    ds_read_b64_tr_b16 a[164:165], v13 offset:8192
    v_mfma_f32_16x16x32_bf16 v[96:99], a[220:223], v[176:179], v[96:99]
    s_waitcnt lgkmcnt(9)
    ds_read_b64_tr_b16 a[166:167], v13 offset:12288
    v_mfma_f32_16x16x32_bf16 v[96:99], a[224:227], v[136:139], v[96:99]
    s_waitcnt lgkmcnt(8)
    ds_read_b64_tr_b16 a[168:169], v13 offset:16384
    v_mfma_f32_16x16x32_bf16 v[96:99], a[228:231], v[152:155], v[96:99]
    s_waitcnt lgkmcnt(7)
    ds_read_b64_tr_b16 a[170:171], v13 offset:20480
    v_mfma_f32_16x16x32_bf16 v[96:99], a[232:235], v[200:203], v[96:99]
    s_waitcnt lgkmcnt(6)
    ds_read_b64_tr_b16 a[172:173], v13 offset:24576
    v_mfma_f32_16x16x32_bf16 v[96:99], a[236:239], v[184:187], v[96:99]
    ds_read_b64_tr_b16 a[174:175], v13 offset:28672
    v_mfma_f32_16x16x32_bf16 v[100:103], a[208:211], v[132:135], 0
    ds_read_b64_tr_b16 a[176:177], v17 offset:0
    v_mfma_f32_16x16x32_bf16 v[100:103], a[212:215], v[148:151], v[100:103]
    ds_read_b64_tr_b16 a[178:179], v17 offset:4096
    v_mfma_f32_16x16x32_bf16 v[100:103], a[216:219], v[196:199], v[100:103]
    ds_read_b64_tr_b16 a[180:181], v17 offset:8192
    v_mfma_f32_16x16x32_bf16 v[100:103], a[220:223], v[180:183], v[100:103]
    ds_read_b64_tr_b16 a[182:183], v17 offset:12288
    v_mfma_f32_16x16x32_bf16 v[100:103], a[224:227], v[140:143], v[100:103]
    ds_read_b64_tr_b16 a[184:185], v17 offset:16384
    v_cvt_pk_bf16_f32 v224, v96, v97
    v_mfma_f32_16x16x32_bf16 v[100:103], a[228:231], v[156:159], v[100:103]
    ds_read_b64_tr_b16 a[186:187], v17 offset:20480
    v_cvt_pk_bf16_f32 v225, v98, v99
    v_mfma_f32_16x16x32_bf16 v[100:103], a[232:235], v[204:207], v[100:103]
    ds_read_b64_tr_b16 a[188:189], v17 offset:24576
    v_mfma_f32_16x16x32_bf16 v[100:103], a[236:239], v[188:191], v[100:103]
    s_waitcnt lgkmcnt(13)
    ds_read_b64_tr_b16 a[190:191], v17 offset:28672
    v_mfma_f32_16x16x32_bf16 v[104:107], a[160:163], v[128:131], 0
    s_waitcnt lgkmcnt(12)
    ds_read_b64_tr_b16 a[208:209], v14 offset:0
    v_mfma_f32_16x16x32_bf16 v[104:107], a[164:167], v[144:147], v[104:107]
    s_waitcnt lgkmcnt(11)
    ds_read_b64_tr_b16 a[210:211], v14 offset:4096
    v_mfma_f32_16x16x32_bf16 v[104:107], a[168:171], v[192:195], v[104:107]
    s_waitcnt lgkmcnt(10)
    ds_read_b64_tr_b16 a[212:213], v14 offset:8192
    v_mfma_f32_16x16x32_bf16 v[104:107], a[172:175], v[176:179], v[104:107]
    s_waitcnt lgkmcnt(9)
    ds_read_b64_tr_b16 a[214:215], v14 offset:12288
    v_mfma_f32_16x16x32_bf16 v[104:107], a[176:179], v[136:139], v[104:107]
    s_waitcnt lgkmcnt(8)
    ds_read_b64_tr_b16 a[216:217], v14 offset:16384
    v_cvt_pk_bf16_f32 v228, v100, v101
    v_mfma_f32_16x16x32_bf16 v[104:107], a[180:183], v[152:155], v[104:107]
    s_waitcnt lgkmcnt(7)
    ds_read_b64_tr_b16 a[218:219], v14 offset:20480
    v_cvt_pk_bf16_f32 v229, v102, v103
    v_mfma_f32_16x16x32_bf16 v[104:107], a[184:187], v[200:203], v[104:107]
    s_waitcnt lgkmcnt(6)
    ds_read_b64_tr_b16 a[220:221], v14 offset:24576
    v_mfma_f32_16x16x32_bf16 v[104:107], a[188:191], v[184:187], v[104:107]
    ds_read_b64_tr_b16 a[222:223], v14 offset:28672
    s_waitcnt vmcnt(0)
    s_cmp_eq_u32 s53, 0
    s_cbranch_scc1 Lattn_wb
Lattn_wbdone:
    v_mfma_f32_16x16x32_bf16 v[108:111], a[160:163], v[132:135], 0
    buffer_store_dword v10, v8, s[24:27], s92 offen offset:8 sc1
    v_mfma_f32_16x16x32_bf16 v[108:111], a[164:167], v[148:151], v[108:111]
    s_xor_b32 s55, s55, 65536
    ds_read_b64_tr_b16 a[224:225], v18 offset:0
    ds_read_b64_tr_b16 a[226:227], v18 offset:4096
    v_mfma_f32_16x16x32_bf16 v[108:111], a[168:171], v[196:199], v[108:111]
    buffer_atomic_add v241, v240, s[88:91], 0 offen sc1
    v_mfma_f32_16x16x32_bf16 v[108:111], a[172:175], v[180:183], v[108:111]
    ds_read_b64_tr_b16 a[228:229], v18 offset:8192
    ds_read_b64_tr_b16 a[230:231], v18 offset:12288
    s_load_dwordx2 s[12:13], s[0:1], 0
    v_mfma_f32_16x16x32_bf16 v[108:111], a[176:179], v[140:143], v[108:111]
    ds_read_b64_tr_b16 a[232:233], v18 offset:16384
    v_cvt_pk_bf16_f32 v226, v104, v105
    v_mfma_f32_16x16x32_bf16 v[108:111], a[180:183], v[156:159], v[108:111]
    s_add_u32 s38, s56, 16384
    ds_read_b64_tr_b16 a[234:235], v18 offset:20480
    v_cvt_pk_bf16_f32 v227, v106, v107
    s_load_dwordx2 s[16:17], s[0:1], 96
    v_mfma_f32_16x16x32_bf16 v[108:111], a[184:187], v[204:207], v[108:111]
    buffer_store_dwordx4 v[224:227], v56, s[28:31], s38 offen sc1
    v_mfma_f32_16x16x32_bf16 v[108:111], a[188:191], v[188:191], v[108:111]
    s_waitcnt lgkmcnt(12)
    ds_read_b64_tr_b16 a[236:237], v18 offset:24576
    ds_read_b64_tr_b16 a[238:239], v18 offset:28672
    s_load_dwordx2 s[52:53], s[0:1], 48
    v_mfma_f32_16x16x32_bf16 v[112:115], a[208:211], v[128:131], 0
    s_waitcnt lgkmcnt(12)
    ds_read_b64_tr_b16 a[160:161], v15 offset:0
    v_mfma_f32_16x16x32_bf16 v[112:115], a[212:215], v[144:147], v[112:115]
    s_waitcnt lgkmcnt(11)
    ds_read_b64_tr_b16 a[162:163], v15 offset:4096
    v_mfma_f32_16x16x32_bf16 v[112:115], a[216:219], v[192:195], v[112:115]
    s_waitcnt lgkmcnt(10)
    ds_read_b64_tr_b16 a[164:165], v15 offset:8192
    v_mfma_f32_16x16x32_bf16 v[112:115], a[220:223], v[176:179], v[112:115]
    s_waitcnt lgkmcnt(9)
    ds_read_b64_tr_b16 a[166:167], v15 offset:12288
    v_mfma_f32_16x16x32_bf16 v[112:115], a[224:227], v[136:139], v[112:115]
    s_waitcnt lgkmcnt(8)
    ds_read_b64_tr_b16 a[168:169], v15 offset:16384
    v_cvt_pk_bf16_f32 v230, v108, v109
    v_mfma_f32_16x16x32_bf16 v[112:115], a[228:231], v[152:155], v[112:115]
    s_waitcnt lgkmcnt(7)
    s_add_u32 s38, s56, 180224
    ds_read_b64_tr_b16 a[170:171], v15 offset:20480
    v_cvt_pk_bf16_f32 v231, v110, v111
    v_mfma_f32_16x16x32_bf16 v[112:115], a[232:235], v[200:203], v[112:115]
    s_waitcnt lgkmcnt(6)
    buffer_store_dwordx4 v[228:231], v56, s[28:31], s38 offen sc1
    v_mfma_f32_16x16x32_bf16 v[112:115], a[236:239], v[184:187], v[112:115]
    ds_read_b64_tr_b16 a[172:173], v15 offset:24576
    ds_read_b64_tr_b16 a[174:175], v15 offset:28672
    v_mfma_f32_16x16x32_bf16 v[116:119], a[208:211], v[132:135], 0
    ds_read_b64_tr_b16 a[176:177], v19 offset:0
    v_mfma_f32_16x16x32_bf16 v[116:119], a[212:215], v[148:151], v[116:119]
    ds_read_b64_tr_b16 a[178:179], v19 offset:4096
    v_mfma_f32_16x16x32_bf16 v[116:119], a[216:219], v[196:199], v[116:119]
    ds_read_b64_tr_b16 a[180:181], v19 offset:8192
    v_mfma_f32_16x16x32_bf16 v[116:119], a[220:223], v[180:183], v[116:119]
    ds_read_b64_tr_b16 a[182:183], v19 offset:12288
    v_mfma_f32_16x16x32_bf16 v[116:119], a[224:227], v[140:143], v[116:119]
    ds_read_b64_tr_b16 a[184:185], v19 offset:16384
    v_cvt_pk_bf16_f32 v232, v112, v113
    v_mfma_f32_16x16x32_bf16 v[116:119], a[228:231], v[156:159], v[116:119]
    ds_read_b64_tr_b16 a[186:187], v19 offset:20480
    v_cvt_pk_bf16_f32 v233, v114, v115
    v_mfma_f32_16x16x32_bf16 v[116:119], a[232:235], v[204:207], v[116:119]
    ds_read_b64_tr_b16 a[188:189], v19 offset:24576
    v_mfma_f32_16x16x32_bf16 v[116:119], a[236:239], v[188:191], v[116:119]
    s_waitcnt lgkmcnt(13)
    ds_read_b64_tr_b16 a[190:191], v19 offset:28672
    s_barrier
    v_mfma_f32_16x16x32_bf16 v[120:123], a[160:163], v[128:131], 0
    s_waitcnt lgkmcnt(12)
    buffer_load_dword v11, v8, s[24:27], s54 offen offset:8 sc1
    v_mfma_f32_16x16x32_bf16 v[120:123], a[164:167], v[144:147], v[120:123]
    s_waitcnt lgkmcnt(10)
    ds_read_b64_tr_b16 a[208:209], v20 offset:0
    ds_read_b64_tr_b16 a[210:211], v20 offset:4096
    v_mfma_f32_16x16x32_bf16 v[120:123], a[168:171], v[192:195], v[120:123]
    s_waitcnt lgkmcnt(10)
    ds_read_b64_tr_b16 a[212:213], v20 offset:8192
    v_mfma_f32_16x16x32_bf16 v[120:123], a[172:175], v[176:179], v[120:123]
    s_waitcnt lgkmcnt(9)
    ds_read_b64_tr_b16 a[214:215], v20 offset:12288
    v_mfma_f32_16x16x32_bf16 v[120:123], a[176:179], v[136:139], v[120:123]
    s_waitcnt lgkmcnt(8)
    ds_read_b64_tr_b16 a[216:217], v20 offset:16384
    v_cvt_pk_bf16_f32 v236, v116, v117
    v_mfma_f32_16x16x32_bf16 v[120:123], a[180:183], v[152:155], v[120:123]
    s_waitcnt lgkmcnt(7)
    ds_read_b64_tr_b16 a[218:219], v20 offset:20480
    v_cvt_pk_bf16_f32 v237, v118, v119
    v_mfma_f32_16x16x32_bf16 v[120:123], a[184:187], v[200:203], v[120:123]
    s_waitcnt lgkmcnt(6)
    s_add_u32 s49, s46, 73728
    ds_read_b64_tr_b16 a[220:221], v20 offset:24576
    v_mfma_f32_16x16x32_bf16 v[120:123], a[188:191], v[184:187], v[120:123]
    s_add_u32 m0, s42, 114688
    ds_read_b64_tr_b16 a[222:223], v20 offset:28672
    v_mfma_f32_16x16x32_bf16 v[124:127], a[160:163], v[132:135], 0
    buffer_load_dwordx4 v46, s[20:23], s49 offen lds
    v_mfma_f32_16x16x32_bf16 v[124:127], a[164:167], v[148:151], v[124:127]
    ds_read_b64_tr_b16 a[224:225], v24 offset:0
    ds_read_b64_tr_b16 a[226:227], v24 offset:4096
    v_mfma_f32_16x16x32_bf16 v[124:127], a[168:171], v[196:199], v[124:127]
    buffer_load_dwordx4 v47, s[20:23], s49 offen offset:1024 lds
    v_mfma_f32_16x16x32_bf16 v[124:127], a[172:175], v[180:183], v[124:127]
    ds_read_b64_tr_b16 a[228:229], v24 offset:8192
    ds_read_b64_tr_b16 a[230:231], v24 offset:12288
    v_mfma_f32_16x16x32_bf16 v[124:127], a[176:179], v[140:143], v[124:127]
    ds_read_b64_tr_b16 a[232:233], v24 offset:16384
    v_cvt_pk_bf16_f32 v234, v120, v121
    v_mfma_f32_16x16x32_bf16 v[124:127], a[180:183], v[156:159], v[124:127]
    s_add_u32 s38, s56, 16512
    ds_read_b64_tr_b16 a[234:235], v24 offset:20480
    v_cvt_pk_bf16_f32 v235, v122, v123
    v_mfma_f32_16x16x32_bf16 v[124:127], a[184:187], v[204:207], v[124:127]
    buffer_store_dwordx4 v[232:235], v56, s[28:31], s38 offen sc1
    v_mfma_f32_16x16x32_bf16 v[124:127], a[188:191], v[188:191], v[124:127]
    s_waitcnt lgkmcnt(12)
    ds_read_b64_tr_b16 a[236:237], v24 offset:24576
    ds_read_b64_tr_b16 a[238:239], v24 offset:28672
    v_mfma_f32_16x16x32_bf16 v[64:67], a[208:211], v[128:131], 0
    s_waitcnt lgkmcnt(12)
    buffer_load_dwordx4 v48, s[20:23], s49 offen offset:2048 lds
    v_mfma_f32_16x16x32_bf16 v[64:67], a[212:215], v[144:147], v[64:67]
    s_waitcnt lgkmcnt(10)
    ds_read_b64_tr_b16 a[160:161], v21 offset:0
    ds_read_b64_tr_b16 a[162:163], v21 offset:4096
    v_mfma_f32_16x16x32_bf16 v[64:67], a[216:219], v[192:195], v[64:67]
    s_waitcnt lgkmcnt(10)
    buffer_load_dwordx4 v49, s[20:23], s49 offen offset:3072 lds
    v_mfma_f32_16x16x32_bf16 v[64:67], a[220:223], v[176:179], v[64:67]
    s_waitcnt lgkmcnt(8)
    ds_read_b64_tr_b16 a[164:165], v21 offset:8192
    ds_read_b64_tr_b16 a[166:167], v21 offset:12288
    v_mfma_f32_16x16x32_bf16 v[64:67], a[224:227], v[136:139], v[64:67]
    s_waitcnt lgkmcnt(8)
    ds_read_b64_tr_b16 a[168:169], v21 offset:16384
    v_cvt_pk_bf16_f32 v238, v124, v125
    v_mfma_f32_16x16x32_bf16 v[64:67], a[228:231], v[152:155], v[64:67]
    s_waitcnt lgkmcnt(7)
    s_add_u32 s38, s56, 180352
    ds_read_b64_tr_b16 a[170:171], v21 offset:20480
    v_cvt_pk_bf16_f32 v239, v126, v127
    v_mfma_f32_16x16x32_bf16 v[64:67], a[232:235], v[200:203], v[64:67]
    s_waitcnt lgkmcnt(6)
    buffer_store_dwordx4 v[236:239], v56, s[28:31], s38 offen sc1
    v_mfma_f32_16x16x32_bf16 v[64:67], a[236:239], v[184:187], v[64:67]
    ds_read_b64_tr_b16 a[172:173], v21 offset:24576
    ds_read_b64_tr_b16 a[174:175], v21 offset:28672
    v_mfma_f32_16x16x32_bf16 v[68:71], a[208:211], v[132:135], 0
    s_lshl_b32 s40, s5, 4
    ds_read_b64_tr_b16 a[176:177], v25 offset:0
    v_mfma_f32_16x16x32_bf16 v[68:71], a[212:215], v[148:151], v[68:71]
    s_add_u32 s40, s40, s4
    ds_read_b64_tr_b16 a[178:179], v25 offset:4096
    v_and_b32 v240, 31, v1
    v_mfma_f32_16x16x32_bf16 v[68:71], a[216:219], v[196:199], v[68:71]
    ds_read_b64_tr_b16 a[180:181], v25 offset:8192
    v_lshrrev_b32 v241, 5, v1
    v_mfma_f32_16x16x32_bf16 v[68:71], a[220:223], v[180:183], v[68:71]
    ds_read_b64_tr_b16 a[182:183], v25 offset:12288
    v_cmp_gt_u32 vcc, 8, v240
    v_mfma_f32_16x16x32_bf16 v[68:71], a[224:227], v[140:143], v[68:71]
    ds_read_b64_tr_b16 a[184:185], v25 offset:16384
    v_mov_b32 v242, 2147483648
    v_mfma_f32_16x16x32_bf16 v[68:71], a[228:231], v[156:159], v[68:71]
    s_lshl_b32 s43, s40, 3
    ds_read_b64_tr_b16 a[186:187], v25 offset:20480
    v_mfma_f32_16x16x32_bf16 v[68:71], a[232:235], v[204:207], v[68:71]
    s_lshl_b32 s44, s3, 1
    ds_read_b64_tr_b16 a[188:189], v25 offset:24576
    v_mfma_f32_16x16x32_bf16 v[68:71], a[236:239], v[188:191], v[68:71]
    s_waitcnt lgkmcnt(13)
    s_add_u32 s43, s43, s44
    ds_read_b64_tr_b16 a[190:191], v25 offset:28672
    v_cndmask_b32 v242, v242, 0, vcc
    v_mfma_f32_16x16x32_bf16 v[72:75], a[160:163], v[128:131], 0
    s_waitcnt lgkmcnt(12)
    ds_read_b64_tr_b16 a[208:209], v22 offset:0
    v_add_u32 v7, s43, v241
    v_mfma_f32_16x16x32_bf16 v[72:75], a[164:167], v[144:147], v[72:75]
    s_waitcnt lgkmcnt(11)
    ds_read_b64_tr_b16 a[210:211], v22 offset:4096
    v_lshlrev_b32 v5, 4, v240
    v_mfma_f32_16x16x32_bf16 v[72:75], a[168:171], v[192:195], v[72:75]
    s_waitcnt lgkmcnt(10)
    ds_read_b64_tr_b16 a[212:213], v22 offset:8192
    v_lshlrev_b32 v243, 4, v241
    v_mfma_f32_16x16x32_bf16 v[72:75], a[172:175], v[176:179], v[72:75]
    s_waitcnt lgkmcnt(9)
    ds_read_b64_tr_b16 a[214:215], v22 offset:12288
    v_lshl_add_u32 v2, v240, 5, v243
    v_mfma_f32_16x16x32_bf16 v[72:75], a[176:179], v[136:139], v[72:75]
    s_waitcnt lgkmcnt(8)
    ds_read_b64_tr_b16 a[216:217], v22 offset:16384
    v_lshrrev_b32 v243, 4, v240
    v_mfma_f32_16x16x32_bf16 v[72:75], a[180:183], v[152:155], v[72:75]
    s_waitcnt lgkmcnt(7)
    ds_read_b64_tr_b16 a[218:219], v22 offset:20480
    v_mul_u32_u24 v243, 1536, v243
    v_mfma_f32_16x16x32_bf16 v[72:75], a[184:187], v[200:203], v[72:75]
    s_waitcnt lgkmcnt(6)
    ds_read_b64_tr_b16 a[220:221], v22 offset:24576
    v_add_u32 v2, v2, v243
    v_mfma_f32_16x16x32_bf16 v[72:75], a[188:191], v[184:187], v[72:75]
    s_mul_i32 s44, s43, 10240
    ds_read_b64_tr_b16 a[222:223], v22 offset:28672
    v_lshrrev_b32 v243, 2, v240
    v_mfma_f32_16x16x32_bf16 v[76:79], a[160:163], v[132:135], 0
    ds_read_b64_tr_b16 a[224:225], v26 offset:0
    v_lshlrev_b32 v243, 6, v243
    v_mfma_f32_16x16x32_bf16 v[76:79], a[164:167], v[148:151], v[76:79]
    ds_read_b64_tr_b16 a[226:227], v26 offset:4096
    v_and_b32 v241, 3, v240
    v_mfma_f32_16x16x32_bf16 v[76:79], a[168:171], v[196:199], v[76:79]
    ds_read_b64_tr_b16 a[228:229], v26 offset:8192
    v_lshl_add_u32 v3, v241, 3, v243
    v_mfma_f32_16x16x32_bf16 v[76:79], a[172:175], v[180:183], v[76:79]
    ds_read_b64_tr_b16 a[230:231], v26 offset:12288
    v_mul_u32_u24 v243, 1152, v7
    v_mfma_f32_16x16x32_bf16 v[76:79], a[176:179], v[140:143], v[76:79]
    ds_read_b64_tr_b16 a[232:233], v26 offset:16384
    v_add_u32 v4, v243, v3
    v_mfma_f32_16x16x32_bf16 v[76:79], a[180:183], v[156:159], v[76:79]
    ds_read_b64_tr_b16 a[234:235], v26 offset:20480
    v_lshl_add_u32 v6, v243, 1, v5
    v_mfma_f32_16x16x32_bf16 v[76:79], a[184:187], v[204:207], v[76:79]
    ds_read_b64_tr_b16 a[236:237], v26 offset:24576
    v_or_b32 v55, v3, v242
    v_mfma_f32_16x16x32_bf16 v[76:79], a[188:191], v[188:191], v[76:79]
    s_waitcnt lgkmcnt(13)
    ds_read_b64_tr_b16 a[238:239], v26 offset:28672
    v_or_b32 v58, v4, v242
    v_mfma_f32_16x16x32_bf16 v[80:83], a[208:211], v[128:131], 0
    s_waitcnt lgkmcnt(12)
    ds_read_b64_tr_b16 a[160:161], v23 offset:0
    v_or_b32 v59, v5, v242
    v_mfma_f32_16x16x32_bf16 v[80:83], a[212:215], v[144:147], v[80:83]
    s_waitcnt lgkmcnt(11)
    ds_read_b64_tr_b16 a[162:163], v23 offset:4096
    v_or_b32 v60, v6, v242
    v_mfma_f32_16x16x32_bf16 v[80:83], a[216:219], v[192:195], v[80:83]
    s_waitcnt lgkmcnt(10)
    ds_read_b64_tr_b16 a[164:165], v23 offset:8192
    s_waitcnt vmcnt(6)
    v_readfirstlane_b32 s36, v11
    v_mfma_f32_16x16x32_bf16 v[80:83], a[220:223], v[176:179], v[80:83]
    s_waitcnt lgkmcnt(9)
    ds_read_b64_tr_b16 a[166:167], v23 offset:12288
    v_lshrrev_b32 v243, 4, v1
    v_mfma_f32_16x16x32_bf16 v[80:83], a[224:227], v[136:139], v[80:83]
    ds_read_b64_tr_b16 a[168:169], v23 offset:16384
    v_lshlrev_b32 v243, 8, v243
    s_cmp_lg_u32 s36, s95
    s_cbranch_scc1 Lattn_xspin
Lattn_xgot:
    s_waitcnt lgkmcnt(9)
    v_mfma_f32_16x16x32_bf16 v[80:83], a[228:231], v[152:155], v[80:83]
    s_waitcnt lgkmcnt(7)
    ds_read_b64_tr_b16 a[170:171], v23 offset:20480
    v_and_b32 v241, 7, v1
    v_mfma_f32_16x16x32_bf16 v[80:83], a[232:235], v[200:203], v[80:83]
    s_waitcnt lgkmcnt(6)
    ds_read_b64_tr_b16 a[172:173], v23 offset:24576
    v_lshl_add_u32 v243, v241, 5, v243
    v_mfma_f32_16x16x32_bf16 v[80:83], a[236:239], v[184:187], v[80:83]
    s_add_u32 s37, s55, 0
    ds_read_b64_tr_b16 a[174:175], v23 offset:28672
    v_and_b32 v241, 8, v1
    v_mfma_f32_16x16x32_bf16 v[84:87], a[208:211], v[132:135], 0
    buffer_load_dwordx4 a[64:67], v252, s[28:31], s37 offen offset:0 sc1
    v_mfma_f32_16x16x32_bf16 v[84:87], a[212:215], v[148:151], v[84:87]
    ds_read_b64_tr_b16 a[176:177], v27 offset:0
    ds_read_b64_tr_b16 a[178:179], v27 offset:4096
    v_mfma_f32_16x16x32_bf16 v[84:87], a[216:219], v[196:199], v[84:87]
    buffer_load_dwordx4 a[68:71], v252, s[28:31], s37 offen offset:1024 sc1
    v_mfma_f32_16x16x32_bf16 v[84:87], a[220:223], v[180:183], v[84:87]
    ds_read_b64_tr_b16 a[180:181], v27 offset:8192
    ds_read_b64_tr_b16 a[182:183], v27 offset:12288
    v_mfma_f32_16x16x32_bf16 v[84:87], a[224:227], v[140:143], v[84:87]
    ds_read_b64_tr_b16 a[184:185], v27 offset:16384
    v_lshl_add_u32 v54, v241, 1, v243
    v_mfma_f32_16x16x32_bf16 v[84:87], a[228:231], v[156:159], v[84:87]
    s_lshr_b32 s41, s2, 3
    ds_read_b64_tr_b16 a[186:187], v27 offset:20480
    v_mfma_f32_16x16x32_bf16 v[84:87], a[232:235], v[204:207], v[84:87]
    buffer_load_dwordx4 a[72:75], v252, s[28:31], s37 offen offset:2048 sc1
    v_mfma_f32_16x16x32_bf16 v[84:87], a[236:239], v[188:191], v[84:87]
    s_waitcnt lgkmcnt(12)
    s_mov_b32 s14, 2359296
    ds_read_b64_tr_b16 a[188:189], v27 offset:24576
    ds_read_b64_tr_b16 a[190:191], v27 offset:28672
    s_barrier
    v_mfma_f32_16x16x32_bf16 v[88:91], a[160:163], v[128:131], 0
    s_waitcnt lgkmcnt(12)
    s_mov_b32 s15, 0x20000
    ds_read_b64_tr_b16 a[208:209], v12 offset:32768
    v_mfma_f32_16x16x32_bf16 v[88:91], a[164:167], v[144:147], v[88:91]
    s_waitcnt lgkmcnt(11)
    s_mov_b32 s18, 2359296
    ds_read_b64_tr_b16 a[210:211], v12 offset:36864
    v_mfma_f32_16x16x32_bf16 v[88:91], a[168:171], v[192:195], v[88:91]
    s_waitcnt lgkmcnt(10)
    buffer_load_dwordx4 a[76:79], v252, s[28:31], s37 offen offset:3072 sc1
    v_mfma_f32_16x16x32_bf16 v[88:91], a[172:175], v[176:179], v[88:91]
    s_waitcnt lgkmcnt(8)
    s_mov_b32 s19, 0x20000
    ds_read_b64_tr_b16 a[212:213], v12 offset:40960
    ds_read_b64_tr_b16 a[214:215], v12 offset:45056
    v_mfma_f32_16x16x32_bf16 v[88:91], a[176:179], v[136:139], v[88:91]
    s_waitcnt lgkmcnt(8)
    s_add_u32 s8, s50, 7864320
    s_addc_u32 s9, s51, 0
    ds_read_b64_tr_b16 a[216:217], v12 offset:49152
    v_mfma_f32_16x16x32_bf16 v[88:91], a[180:183], v[152:155], v[88:91]
    s_waitcnt lgkmcnt(7)
    s_add_u32 s37, s55, 4096
    ds_read_b64_tr_b16 a[218:219], v12 offset:53248
    v_mfma_f32_16x16x32_bf16 v[88:91], a[184:187], v[200:203], v[88:91]
    s_waitcnt lgkmcnt(6)
    s_add_u32 s49, s46, 256
    buffer_load_dwordx4 a[80:83], v252, s[28:31], s37 offen offset:0 sc1
    v_mfma_f32_16x16x32_bf16 v[88:91], a[188:191], v[184:187], v[88:91]
    s_add_u32 m0, s42, 0
    ds_read_b64_tr_b16 a[220:221], v12 offset:57344
    ds_read_b64_tr_b16 a[222:223], v12 offset:61440
    v_mfma_f32_16x16x32_bf16 v[92:95], a[160:163], v[132:135], 0
    buffer_load_dwordx4 v46, s[20:23], s49 offen lds
    v_mfma_f32_16x16x32_bf16 v[92:95], a[164:167], v[148:151], v[92:95]
    s_mov_b32 s10, 663552
    ds_read_b64_tr_b16 a[224:225], v16 offset:32768
    ds_read_b64_tr_b16 a[226:227], v16 offset:36864
    v_mfma_f32_16x16x32_bf16 v[92:95], a[168:171], v[196:199], v[92:95]
    buffer_load_dwordx4 v47, s[20:23], s49 offen offset:1024 lds
    v_mfma_f32_16x16x32_bf16 v[92:95], a[172:175], v[180:183], v[92:95]
    s_mov_b32 s11, 0x20000
    ds_read_b64_tr_b16 a[228:229], v16 offset:40960
    ds_read_b64_tr_b16 a[230:231], v16 offset:45056
    v_mfma_f32_16x16x32_bf16 v[92:95], a[176:179], v[140:143], v[92:95]
    buffer_load_dwordx4 a[84:87], v252, s[28:31], s37 offen offset:1024 sc1
    v_mfma_f32_16x16x32_bf16 v[92:95], a[180:183], v[156:159], v[92:95]
    s_lshl_b32 s39, s5, 13
    ds_read_b64_tr_b16 a[232:233], v16 offset:49152
    ds_read_b64_tr_b16 a[234:235], v16 offset:53248
    v_mfma_f32_16x16x32_bf16 v[92:95], a[184:187], v[204:207], v[92:95]
    s_add_u32 s39, s39, 8781824
    ds_read_b64_tr_b16 a[236:237], v16 offset:57344
    v_mfma_f32_16x16x32_bf16 v[92:95], a[188:191], v[188:191], v[92:95]
    s_waitcnt lgkmcnt(13)
    s_lshr_b32 s45, s4, 2
    ds_read_b64_tr_b16 a[238:239], v16 offset:61440
    v_mfma_f32_16x16x32_bf16 v[96:99], a[208:211], v[128:131], 0
    s_waitcnt lgkmcnt(12)
    buffer_load_dwordx4 v48, s[20:23], s49 offen offset:2048 lds
    v_mfma_f32_16x16x32_bf16 v[96:99], a[212:215], v[144:147], v[96:99]
    s_waitcnt lgkmcnt(10)
    s_lshl_b32 s45, s45, 11
    ds_read_b64_tr_b16 a[160:161], v13 offset:32768
    ds_read_b64_tr_b16 a[162:163], v13 offset:36864
    v_mfma_f32_16x16x32_bf16 v[96:99], a[216:219], v[192:195], v[96:99]
    s_waitcnt lgkmcnt(10)
    buffer_load_dwordx4 v49, s[20:23], s49 offen offset:3072 lds
    v_mfma_f32_16x16x32_bf16 v[96:99], a[220:223], v[176:179], v[96:99]
    s_waitcnt lgkmcnt(8)
    s_add_u32 s39, s39, s45
    ds_read_b64_tr_b16 a[164:165], v13 offset:40960
    ds_read_b64_tr_b16 a[166:167], v13 offset:45056
    v_mfma_f32_16x16x32_bf16 v[96:99], a[224:227], v[136:139], v[96:99]
    s_waitcnt lgkmcnt(8)
    buffer_load_dwordx4 a[88:91], v252, s[28:31], s37 offen offset:2048 sc1
    v_mfma_f32_16x16x32_bf16 v[96:99], a[228:231], v[152:155], v[96:99]
    s_waitcnt lgkmcnt(6)
    ds_read_b64_tr_b16 a[168:169], v13 offset:49152
    ds_read_b64_tr_b16 a[170:171], v13 offset:53248
    v_mfma_f32_16x16x32_bf16 v[96:99], a[232:235], v[200:203], v[96:99]
    s_waitcnt lgkmcnt(6)
    s_add_u32 s49, s46, 73984
    ds_read_b64_tr_b16 a[172:173], v13 offset:57344
    v_and_b32 v9, 15, v1
    v_mfma_f32_16x16x32_bf16 v[96:99], a[236:239], v[184:187], v[96:99]
    s_add_u32 m0, s42, 16384
    ds_read_b64_tr_b16 a[174:175], v13 offset:61440
    v_lshlrev_b32 v9, 7, v9
    v_mfma_f32_16x16x32_bf16 v[100:103], a[208:211], v[132:135], 0
    buffer_load_dwordx4 v46, s[20:23], s49 offen lds
    v_mfma_f32_16x16x32_bf16 v[100:103], a[212:215], v[148:151], v[100:103]
    ds_read_b64_tr_b16 a[176:177], v17 offset:32768
    ds_read_b64_tr_b16 a[178:179], v17 offset:36864
    v_mfma_f32_16x16x32_bf16 v[100:103], a[216:219], v[196:199], v[100:103]
    buffer_load_dwordx4 v47, s[20:23], s49 offen offset:1024 lds
    v_mfma_f32_16x16x32_bf16 v[100:103], a[220:223], v[180:183], v[100:103]
    ds_read_b64_tr_b16 a[180:181], v17 offset:40960
    ds_read_b64_tr_b16 a[182:183], v17 offset:45056
    v_mfma_f32_16x16x32_bf16 v[100:103], a[224:227], v[140:143], v[100:103]
    buffer_load_dwordx4 a[92:95], v252, s[28:31], s37 offen offset:3072 sc1
    v_mfma_f32_16x16x32_bf16 v[100:103], a[228:231], v[156:159], v[100:103]
    ds_read_b64_tr_b16 a[184:185], v17 offset:49152
    ds_read_b64_tr_b16 a[186:187], v17 offset:53248
    v_mfma_f32_16x16x32_bf16 v[100:103], a[232:235], v[204:207], v[100:103]
    ds_read_b64_tr_b16 a[188:189], v17 offset:57344
    v_mfma_f32_16x16x32_bf16 v[100:103], a[236:239], v[188:191], v[100:103]
    s_waitcnt lgkmcnt(13)
    ds_read_b64_tr_b16 a[190:191], v17 offset:61440
    v_mfma_f32_16x16x32_bf16 v[104:107], a[160:163], v[128:131], 0
    s_waitcnt lgkmcnt(12)
    buffer_load_dwordx4 v48, s[20:23], s49 offen offset:2048 lds
    v_mfma_f32_16x16x32_bf16 v[104:107], a[164:167], v[144:147], v[104:107]
    s_waitcnt lgkmcnt(10)
    ds_read_b64_tr_b16 a[208:209], v14 offset:32768
    ds_read_b64_tr_b16 a[210:211], v14 offset:36864
    v_mfma_f32_16x16x32_bf16 v[104:107], a[168:171], v[192:195], v[104:107]
    s_waitcnt lgkmcnt(10)
    buffer_load_dwordx4 v49, s[20:23], s49 offen offset:3072 lds
    v_mfma_f32_16x16x32_bf16 v[104:107], a[172:175], v[176:179], v[104:107]
    s_waitcnt lgkmcnt(8)
    s_add_u32 s37, s55, 8192
    ds_read_b64_tr_b16 a[212:213], v14 offset:40960
    ds_read_b64_tr_b16 a[214:215], v14 offset:45056
    v_mfma_f32_16x16x32_bf16 v[104:107], a[176:179], v[136:139], v[104:107]
    s_waitcnt lgkmcnt(8)
    buffer_load_dwordx4 a[96:99], v252, s[28:31], s37 offen offset:0 sc1
    v_mfma_f32_16x16x32_bf16 v[104:107], a[180:183], v[152:155], v[104:107]
    s_waitcnt lgkmcnt(6)
    ds_read_b64_tr_b16 a[216:217], v14 offset:49152
    ds_read_b64_tr_b16 a[218:219], v14 offset:53248
    v_mfma_f32_16x16x32_bf16 v[104:107], a[184:187], v[200:203], v[104:107]
    s_waitcnt lgkmcnt(6)
    buffer_load_dwordx4 a[100:103], v252, s[28:31], s37 offen offset:1024 sc1
    v_mfma_f32_16x16x32_bf16 v[104:107], a[188:191], v[184:187], v[104:107]
    ds_read_b64_tr_b16 a[220:221], v14 offset:57344
    ds_read_b64_tr_b16 a[222:223], v14 offset:61440
    v_mfma_f32_16x16x32_bf16 v[108:111], a[160:163], v[132:135], 0
    ds_read_b64_tr_b16 a[224:225], v18 offset:32768
    v_mfma_f32_16x16x32_bf16 v[108:111], a[164:167], v[148:151], v[108:111]
    ds_read_b64_tr_b16 a[226:227], v18 offset:36864
    v_mfma_f32_16x16x32_bf16 v[108:111], a[168:171], v[196:199], v[108:111]
    buffer_load_dwordx4 a[104:107], v252, s[28:31], s37 offen offset:2048 sc1
    v_mfma_f32_16x16x32_bf16 v[108:111], a[172:175], v[180:183], v[108:111]
    ds_read_b64_tr_b16 a[228:229], v18 offset:40960
    ds_read_b64_tr_b16 a[230:231], v18 offset:45056
    v_mfma_f32_16x16x32_bf16 v[108:111], a[176:179], v[140:143], v[108:111]
    ds_read_b64_tr_b16 a[232:233], v18 offset:49152
    v_mfma_f32_16x16x32_bf16 v[108:111], a[180:183], v[156:159], v[108:111]
    ds_read_b64_tr_b16 a[234:235], v18 offset:53248
    v_mfma_f32_16x16x32_bf16 v[108:111], a[184:187], v[204:207], v[108:111]
    buffer_load_dwordx4 a[108:111], v252, s[28:31], s37 offen offset:3072 sc1
    v_mfma_f32_16x16x32_bf16 v[108:111], a[188:191], v[188:191], v[108:111]
    s_waitcnt lgkmcnt(12)
    ds_read_b64_tr_b16 a[236:237], v18 offset:57344
    ds_read_b64_tr_b16 a[238:239], v18 offset:61440
    v_mfma_f32_16x16x32_bf16 v[112:115], a[208:211], v[128:131], 0
    s_waitcnt lgkmcnt(12)
    ds_read_b64_tr_b16 a[160:161], v15 offset:32768
    v_mfma_f32_16x16x32_bf16 v[112:115], a[212:215], v[144:147], v[112:115]
    s_waitcnt lgkmcnt(11)
    s_add_u32 s37, s55, 12288
    ds_read_b64_tr_b16 a[162:163], v15 offset:36864
    v_mfma_f32_16x16x32_bf16 v[112:115], a[216:219], v[192:195], v[112:115]
    s_waitcnt lgkmcnt(10)
    buffer_load_dwordx4 a[112:115], v252, s[28:31], s37 offen offset:0 sc1
    v_mfma_f32_16x16x32_bf16 v[112:115], a[220:223], v[176:179], v[112:115]
    s_waitcnt lgkmcnt(8)
    ds_read_b64_tr_b16 a[164:165], v15 offset:40960
    ds_read_b64_tr_b16 a[166:167], v15 offset:45056
    v_mfma_f32_16x16x32_bf16 v[112:115], a[224:227], v[136:139], v[112:115]
    s_waitcnt lgkmcnt(8)
    buffer_load_dwordx4 a[116:119], v252, s[28:31], s37 offen offset:1024 sc1
    v_mfma_f32_16x16x32_bf16 v[112:115], a[228:231], v[152:155], v[112:115]
    s_waitcnt lgkmcnt(6)
    ds_read_b64_tr_b16 a[168:169], v15 offset:49152
    ds_read_b64_tr_b16 a[170:171], v15 offset:53248
    v_mfma_f32_16x16x32_bf16 v[112:115], a[232:235], v[200:203], v[112:115]
    s_waitcnt lgkmcnt(6)
    ds_read_b64_tr_b16 a[172:173], v15 offset:57344
    v_mfma_f32_16x16x32_bf16 v[112:115], a[236:239], v[184:187], v[112:115]
    ds_read_b64_tr_b16 a[174:175], v15 offset:61440
    v_mfma_f32_16x16x32_bf16 v[116:119], a[208:211], v[132:135], 0
Ltour9:
    s_cbranch_execz Ltour13
    buffer_load_dwordx4 a[120:123], v252, s[28:31], s37 offen offset:2048 sc1
    v_mfma_f32_16x16x32_bf16 v[116:119], a[212:215], v[148:151], v[116:119]
    ds_read_b64_tr_b16 a[176:177], v19 offset:32768
    ds_read_b64_tr_b16 a[178:179], v19 offset:36864
    v_mfma_f32_16x16x32_bf16 v[116:119], a[216:219], v[196:199], v[116:119]
    ds_read_b64_tr_b16 a[180:181], v19 offset:40960
    v_mfma_f32_16x16x32_bf16 v[116:119], a[220:223], v[180:183], v[116:119]
    ds_read_b64_tr_b16 a[182:183], v19 offset:45056
    v_mfma_f32_16x16x32_bf16 v[116:119], a[224:227], v[140:143], v[116:119]
    buffer_load_dwordx4 a[124:127], v252, s[28:31], s37 offen offset:3072 sc1
    v_mfma_f32_16x16x32_bf16 v[116:119], a[228:231], v[156:159], v[116:119]
    ds_read_b64_tr_b16 a[184:185], v19 offset:49152
    ds_read_b64_tr_b16 a[186:187], v19 offset:53248
    v_mfma_f32_16x16x32_bf16 v[116:119], a[232:235], v[204:207], v[116:119]
    ds_read_b64_tr_b16 a[188:189], v19 offset:57344
    v_mfma_f32_16x16x32_bf16 v[116:119], a[236:239], v[188:191], v[116:119]
    ds_read_b64_tr_b16 a[190:191], v19 offset:61440
    s_waitcnt vmcnt(25)
    s_waitcnt lgkmcnt(0)
    s_barrier
    v_mfma_f32_16x16x32_bf16 v[120:123], a[160:163], v[128:131], 0
    ds_read_b64_tr_b16 a[208:209], v20 offset:32768
    v_mfma_f32_16x16x32_bf16 v[120:123], a[164:167], v[144:147], v[120:123]
    ds_read_b64_tr_b16 a[210:211], v20 offset:36864
    v_mfma_f32_16x16x32_bf16 v[120:123], a[168:171], v[192:195], v[120:123]
    ds_read_b64_tr_b16 a[212:213], v20 offset:40960
    v_mfma_f32_16x16x32_bf16 v[120:123], a[172:175], v[176:179], v[120:123]
    ds_read_b64_tr_b16 a[214:215], v20 offset:45056
    v_mfma_f32_16x16x32_bf16 v[120:123], a[176:179], v[136:139], v[120:123]
    ds_read_b64_tr_b16 a[216:217], v20 offset:49152
    v_mfma_f32_16x16x32_bf16 v[120:123], a[180:183], v[152:155], v[120:123]
    ds_read_b64_tr_b16 a[218:219], v20 offset:53248
    v_mfma_f32_16x16x32_bf16 v[120:123], a[184:187], v[200:203], v[120:123]
    s_add_u32 s49, s7, 512
    ds_read_b64_tr_b16 a[220:221], v20 offset:57344
    v_mfma_f32_16x16x32_bf16 v[120:123], a[188:191], v[184:187], v[120:123]
    s_add_u32 m0, s42, 65536
    ds_read_b64_tr_b16 a[222:223], v20 offset:61440
    v_mfma_f32_16x16x32_bf16 v[124:127], a[160:163], v[132:135], 0
    buffer_load_dwordx4 v46, s[20:23], s49 offen lds
    v_mfma_f32_16x16x32_bf16 v[124:127], a[164:167], v[148:151], v[124:127]
    ds_read_b64_tr_b16 a[224:225], v24 offset:32768
    ds_read_b64_tr_b16 a[226:227], v24 offset:36864
    v_mfma_f32_16x16x32_bf16 v[124:127], a[168:171], v[196:199], v[124:127]
    buffer_load_dwordx4 v47, s[20:23], s49 offen offset:1024 lds
    v_mfma_f32_16x16x32_bf16 v[124:127], a[172:175], v[180:183], v[124:127]
    ds_read_b64_tr_b16 a[228:229], v24 offset:40960
    ds_read_b64_tr_b16 a[230:231], v24 offset:45056
    v_mfma_f32_16x16x32_bf16 v[124:127], a[176:179], v[140:143], v[124:127]
    ds_read_b64_tr_b16 a[232:233], v24 offset:49152
    v_mfma_f32_16x16x32_bf16 v[124:127], a[180:183], v[156:159], v[124:127]
    ds_read_b64_tr_b16 a[234:235], v24 offset:53248
    v_mfma_f32_16x16x32_bf16 v[124:127], a[184:187], v[204:207], v[124:127]
    ds_read_b64_tr_b16 a[236:237], v24 offset:57344
    v_lshrrev_b32 v240, 4, v1
    v_mfma_f32_16x16x32_bf16 v[124:127], a[188:191], v[188:191], v[124:127]
    s_waitcnt vmcnt(25)
    s_waitcnt lgkmcnt(13)
    ds_read_b64_tr_b16 a[238:239], v24 offset:61440
    v_and_b32 v240, 2, v240
    v_mfma_f32_16x16x32_bf16 v[64:67], a[208:211], a[64:67], v[64:67]
    s_waitcnt vmcnt(24)
    s_waitcnt lgkmcnt(12)
    buffer_load_dwordx4 v48, s[20:23], s49 offen offset:2048 lds
    v_mfma_f32_16x16x32_bf16 v[64:67], a[212:215], a[68:71], v[64:67]
    s_waitcnt vmcnt(24)
    s_waitcnt lgkmcnt(10)
    ds_read_b64_tr_b16 a[160:161], v21 offset:32768
    ds_read_b64_tr_b16 a[162:163], v21 offset:36864
    v_mfma_f32_16x16x32_bf16 v[64:67], a[216:219], a[72:75], v[64:67]
    s_waitcnt vmcnt(23)
    s_waitcnt lgkmcnt(10)
    buffer_load_dwordx4 v49, s[20:23], s49 offen offset:3072 lds
    v_mfma_f32_16x16x32_bf16 v[64:67], a[220:223], a[76:79], v[64:67]
    s_waitcnt vmcnt(23)
    s_waitcnt lgkmcnt(8)
    ds_read_b64_tr_b16 a[164:165], v21 offset:40960
    ds_read_b64_tr_b16 a[166:167], v21 offset:45056
    v_mfma_f32_16x16x32_bf16 v[64:67], a[224:227], a[80:83], v[64:67]
    s_waitcnt vmcnt(20)
    s_waitcnt lgkmcnt(8)
    ds_read_b64_tr_b16 a[168:169], v21 offset:49152
    v_bfe_u32 v241, v1, 2, 2
    v_mfma_f32_16x16x32_bf16 v[64:67], a[228:231], a[84:87], v[64:67]
    s_waitcnt vmcnt(17)
    s_waitcnt lgkmcnt(7)
    ds_read_b64_tr_b16 a[170:171], v21 offset:53248
    v_cmp_eq_u32 s[54:55], v240, v241
    v_mfma_f32_16x16x32_bf16 v[64:67], a[232:235], a[88:91], v[64:67]
    s_waitcnt vmcnt(14)
    s_waitcnt lgkmcnt(6)
    s_add_u32 s49, s7, 74240
    ds_read_b64_tr_b16 a[172:173], v21 offset:57344
    v_or_b32 v240, 1, v240
    v_mfma_f32_16x16x32_bf16 v[64:67], a[236:239], a[92:95], v[64:67]
    s_waitcnt vmcnt(11)
    s_add_u32 m0, s42, 81920
    ds_read_b64_tr_b16 a[174:175], v21 offset:61440
    v_cmp_eq_u32 s[36:37], v240, v241
    v_mfma_f32_16x16x32_bf16 v[68:71], a[208:211], a[96:99], v[68:71]
    s_waitcnt vmcnt(10)
    buffer_load_dwordx4 v46, s[20:23], s49 offen lds
    v_mfma_f32_16x16x32_bf16 v[68:71], a[212:215], a[100:103], v[68:71]
    s_waitcnt vmcnt(10)
    ds_read_b64_tr_b16 a[176:177], v25 offset:32768
    ds_read_b64_tr_b16 a[178:179], v25 offset:36864
    v_mfma_f32_16x16x32_bf16 v[68:71], a[216:219], a[104:107], v[68:71]
    s_waitcnt vmcnt(9)
    buffer_load_dwordx4 v47, s[20:23], s49 offen offset:1024 lds
    v_mfma_f32_16x16x32_bf16 v[68:71], a[220:223], a[108:111], v[68:71]
    s_waitcnt vmcnt(9)
    ds_read_b64_tr_b16 a[180:181], v25 offset:40960
    ds_read_b64_tr_b16 a[182:183], v25 offset:45056
    v_mfma_f32_16x16x32_bf16 v[68:71], a[224:227], a[112:115], v[68:71]
    s_waitcnt vmcnt(8)
    ds_read_b64_tr_b16 a[184:185], v25 offset:49152
    v_cvt_pk_bf16_f32 v224, v64, v65
    v_mfma_f32_16x16x32_bf16 v[68:71], a[228:231], a[116:119], v[68:71]
    s_waitcnt vmcnt(7)
    ds_read_b64_tr_b16 a[186:187], v25 offset:53248
    v_cvt_pk_bf16_f32 v225, v66, v67
    v_mfma_f32_16x16x32_bf16 v[68:71], a[232:235], a[120:123], v[68:71]
    s_waitcnt vmcnt(6)
    buffer_load_dwordx2 v[36:37], v4, s[12:15], 0 offen offset:0
    v_mfma_f32_16x16x32_bf16 v[68:71], a[236:239], a[124:127], v[68:71]
    s_waitcnt lgkmcnt(12)
    ds_read_b64_tr_b16 a[188:189], v25 offset:57344
    ds_read_b64_tr_b16 a[190:191], v25 offset:61440
    v_mfma_f32_16x16x32_bf16 v[72:75], a[160:163], a[64:67], v[72:75]
    s_waitcnt lgkmcnt(12)
    buffer_load_dwordx4 v48, s[20:23], s49 offen offset:2048 lds
    v_mfma_f32_16x16x32_bf16 v[72:75], a[164:167], a[68:71], v[72:75]
    s_waitcnt lgkmcnt(10)
    ds_read_b64_tr_b16 a[208:209], v22 offset:32768
    ds_read_b64_tr_b16 a[210:211], v22 offset:36864
    v_mfma_f32_16x16x32_bf16 v[72:75], a[168:171], a[72:75], v[72:75]
    s_waitcnt lgkmcnt(10)
    buffer_load_dwordx4 v49, s[20:23], s49 offen offset:3072 lds
    v_mfma_f32_16x16x32_bf16 v[72:75], a[172:175], a[76:79], v[72:75]
    s_waitcnt lgkmcnt(8)
    ds_read_b64_tr_b16 a[212:213], v22 offset:40960
    ds_read_b64_tr_b16 a[214:215], v22 offset:45056
    v_mfma_f32_16x16x32_bf16 v[72:75], a[176:179], a[80:83], v[72:75]
    s_waitcnt lgkmcnt(8)
    ds_read_b64_tr_b16 a[216:217], v22 offset:49152
    v_cvt_pk_bf16_f32 v228, v68, v69
    v_mfma_f32_16x16x32_bf16 v[72:75], a[180:183], a[84:87], v[72:75]
    s_waitcnt lgkmcnt(7)
    ds_read_b64_tr_b16 a[218:219], v22 offset:53248
    v_cvt_pk_bf16_f32 v229, v70, v71
    v_mfma_f32_16x16x32_bf16 v[72:75], a[184:187], a[88:91], v[72:75]
    s_waitcnt lgkmcnt(6)
    ds_read_b64_tr_b16 a[220:221], v22 offset:57344
    v_and_b32 v240, 1, v1
    v_mfma_f32_16x16x32_bf16 v[72:75], a[188:191], a[92:95], v[72:75]
    ds_read_b64_tr_b16 a[222:223], v22 offset:61440
    v_lshlrev_b32 v240, 4, v240
    v_mfma_f32_16x16x32_bf16 v[76:79], a[160:163], a[96:99], v[76:79]
    buffer_load_dwordx2 v[38:39], v4, s[12:15], 0 offen offset:32
    v_mfma_f32_16x16x32_bf16 v[76:79], a[164:167], a[100:103], v[76:79]
    ds_read_b64_tr_b16 a[224:225], v26 offset:32768
    ds_read_b64_tr_b16 a[226:227], v26 offset:36864
    v_mfma_f32_16x16x32_bf16 v[76:79], a[168:171], a[104:107], v[76:79]
    ds_read_b64_tr_b16 a[228:229], v26 offset:40960
    v_mov_b32 v241, 0x3f80
    v_mfma_f32_16x16x32_bf16 v[76:79], a[172:175], a[108:111], v[76:79]
    ds_read_b64_tr_b16 a[230:231], v26 offset:45056
    v_lshlrev_b32 v240, v240, v241
    v_mfma_f32_16x16x32_bf16 v[76:79], a[176:179], a[112:115], v[76:79]
    ds_read_b64_tr_b16 a[232:233], v26 offset:49152
    v_cvt_pk_bf16_f32 v226, v72, v73
    v_mfma_f32_16x16x32_bf16 v[76:79], a[180:183], a[116:119], v[76:79]
    s_add_u32 s38, s93, 0
    ds_read_b64_tr_b16 a[234:235], v26 offset:53248
    v_cvt_pk_bf16_f32 v227, v74, v75
    v_mfma_f32_16x16x32_bf16 v[76:79], a[184:187], a[120:123], v[76:79]
    buffer_store_dwordx4 v[224:227], v56, s[28:31], s38 offen sc1
    v_mfma_f32_16x16x32_bf16 v[76:79], a[188:191], a[124:127], v[76:79]
    s_waitcnt lgkmcnt(12)
    ds_read_b64_tr_b16 a[236:237], v26 offset:57344
    ds_read_b64_tr_b16 a[238:239], v26 offset:61440
    v_mfma_f32_16x16x32_bf16 v[80:83], a[208:211], a[64:67], v[80:83]
    s_waitcnt lgkmcnt(12)
    ds_read_b64_tr_b16 a[160:161], v23 offset:32768
    v_bfe_i32 v241, v1, 1, 1
    v_mfma_f32_16x16x32_bf16 v[80:83], a[212:215], a[68:71], v[80:83]
    s_waitcnt lgkmcnt(11)
    ds_read_b64_tr_b16 a[162:163], v23 offset:36864
    v_and_b32 v243, v240, v241
    v_mfma_f32_16x16x32_bf16 v[80:83], a[216:219], a[72:75], v[80:83]
    s_waitcnt lgkmcnt(10)
    buffer_load_dwordx2 v[40:41], v4, s[12:15], 0 offen offset:512
    v_mfma_f32_16x16x32_bf16 v[80:83], a[220:223], a[76:79], v[80:83]
    s_waitcnt lgkmcnt(8)
    ds_read_b64_tr_b16 a[164:165], v23 offset:40960
    ds_read_b64_tr_b16 a[166:167], v23 offset:45056
    v_mfma_f32_16x16x32_bf16 v[80:83], a[224:227], a[80:83], v[80:83]
    s_waitcnt lgkmcnt(8)
    ds_read_b64_tr_b16 a[168:169], v23 offset:49152
    v_cvt_pk_bf16_f32 v230, v76, v77
    v_mfma_f32_16x16x32_bf16 v[80:83], a[228:231], a[84:87], v[80:83]
    s_waitcnt lgkmcnt(7)
    s_add_u32 s38, s93, 163840
    ds_read_b64_tr_b16 a[170:171], v23 offset:53248
    v_cvt_pk_bf16_f32 v231, v78, v79
    v_mfma_f32_16x16x32_bf16 v[80:83], a[232:235], a[88:91], v[80:83]
    s_waitcnt lgkmcnt(6)
    buffer_store_dwordx4 v[228:231], v56, s[28:31], s38 offen sc1
    v_mfma_f32_16x16x32_bf16 v[80:83], a[236:239], a[92:95], v[80:83]
    ds_read_b64_tr_b16 a[172:173], v23 offset:57344
    ds_read_b64_tr_b16 a[174:175], v23 offset:61440
    v_mfma_f32_16x16x32_bf16 v[84:87], a[208:211], a[96:99], v[84:87]
    ds_read_b64_tr_b16 a[176:177], v27 offset:32768
    v_xor_b32 v242, v240, v243
    v_mfma_f32_16x16x32_bf16 v[84:87], a[212:215], a[100:103], v[84:87]
    ds_read_b64_tr_b16 a[178:179], v27 offset:36864
    v_cndmask_b32 v246, 0, v242, s[54:55]
    v_mfma_f32_16x16x32_bf16 v[84:87], a[216:219], a[104:107], v[84:87]
    ds_read_b64_tr_b16 a[180:181], v27 offset:40960
    v_cndmask_b32 v247, 0, v243, s[54:55]
    v_mfma_f32_16x16x32_bf16 v[84:87], a[220:223], a[108:111], v[84:87]
    ds_read_b64_tr_b16 a[182:183], v27 offset:45056
    v_cndmask_b32 v250, 0, v242, s[36:37]
    v_mfma_f32_16x16x32_bf16 v[84:87], a[224:227], a[112:115], v[84:87]
    ds_read_b64_tr_b16 a[184:185], v27 offset:49152
    v_cvt_pk_bf16_f32 v232, v80, v81
    v_mfma_f32_16x16x32_bf16 v[84:87], a[228:231], a[116:119], v[84:87]
    ds_read_b64_tr_b16 a[186:187], v27 offset:53248
    v_cvt_pk_bf16_f32 v233, v82, v83
    v_mfma_f32_16x16x32_bf16 v[84:87], a[232:235], a[120:123], v[84:87]
    buffer_load_dwordx2 v[42:43], v4, s[12:15], 0 offen offset:544
    v_mfma_f32_16x16x32_bf16 v[84:87], a[236:239], a[124:127], v[84:87]
    s_waitcnt lgkmcnt(12)
    ds_read_b64_tr_b16 a[188:189], v27 offset:57344
    ds_read_b64_tr_b16 a[190:191], v27 offset:61440
    s_barrier
    v_mfma_f32_16x16x32_bf16 v[88:91], a[160:163], a[64:67], v[88:91]
    s_waitcnt lgkmcnt(12)
    ds_read_b64_tr_b16 a[208:209], v12 offset:0
    v_cndmask_b32 v251, 0, v243, s[36:37]
    v_mfma_f32_16x16x32_bf16 v[88:91], a[164:167], a[68:71], v[88:91]
    s_waitcnt lgkmcnt(11)
    ds_read_b64_tr_b16 a[210:211], v12 offset:4096
    v_mov_b32 v240, 0
    v_mfma_f32_16x16x32_bf16 v[88:91], a[168:171], a[72:75], v[88:91]
    s_waitcnt lgkmcnt(10)
    ds_read_b64_tr_b16 a[212:213], v12 offset:8192
    v_mov_b32 v241, 0
    v_mfma_f32_16x16x32_bf16 v[88:91], a[172:175], a[76:79], v[88:91]
    s_waitcnt lgkmcnt(9)
    ds_read_b64_tr_b16 a[214:215], v12 offset:12288
    v_mov_b32 v244, 0
    v_mfma_f32_16x16x32_bf16 v[88:91], a[176:179], a[80:83], v[88:91]
    s_waitcnt lgkmcnt(8)
    ds_read_b64_tr_b16 a[216:217], v12 offset:16384
    v_cvt_pk_bf16_f32 v236, v84, v85
    v_mfma_f32_16x16x32_bf16 v[88:91], a[180:183], a[84:87], v[88:91]
    s_waitcnt lgkmcnt(7)
    ds_read_b64_tr_b16 a[218:219], v12 offset:20480
    v_cvt_pk_bf16_f32 v237, v86, v87
    v_mfma_f32_16x16x32_bf16 v[88:91], a[184:187], a[88:91], v[88:91]
    s_waitcnt lgkmcnt(6)
    s_add_u32 s49, s46, 512
    ds_read_b64_tr_b16 a[220:221], v12 offset:24576
    v_mov_b32 v245, 0
    v_mfma_f32_16x16x32_bf16 v[88:91], a[188:191], a[92:95], v[88:91]
    s_add_u32 m0, s42, 32768
    ds_read_b64_tr_b16 a[222:223], v12 offset:28672
    v_mov_b32 v248, 0
    v_mfma_f32_16x16x32_bf16 v[92:95], a[160:163], a[96:99], v[92:95]
    buffer_load_dwordx4 v46, s[20:23], s49 offen lds
    v_mfma_f32_16x16x32_bf16 v[92:95], a[164:167], a[100:103], v[92:95]
    ds_read_b64_tr_b16 a[224:225], v16 offset:0
    ds_read_b64_tr_b16 a[226:227], v16 offset:4096
    v_mfma_f32_16x16x32_bf16 v[92:95], a[168:171], a[104:107], v[92:95]
    buffer_load_dwordx4 v47, s[20:23], s49 offen offset:1024 lds
    v_mfma_f32_16x16x32_bf16 v[92:95], a[172:175], a[108:111], v[92:95]
    ds_read_b64_tr_b16 a[228:229], v16 offset:8192
    ds_read_b64_tr_b16 a[230:231], v16 offset:12288
    v_mfma_f32_16x16x32_bf16 v[92:95], a[176:179], a[112:115], v[92:95]
    ds_read_b64_tr_b16 a[232:233], v16 offset:16384
    v_cvt_pk_bf16_f32 v234, v88, v89
    v_mfma_f32_16x16x32_bf16 v[92:95], a[180:183], a[116:119], v[92:95]
    s_add_u32 s38, s93, 128
    ds_read_b64_tr_b16 a[234:235], v16 offset:20480
    v_cvt_pk_bf16_f32 v235, v90, v91
    v_mfma_f32_16x16x32_bf16 v[92:95], a[184:187], a[120:123], v[92:95]
    buffer_store_dwordx4 v[232:235], v56, s[28:31], s38 offen sc1
    v_mfma_f32_16x16x32_bf16 v[92:95], a[188:191], a[124:127], v[92:95]
    s_waitcnt lgkmcnt(12)
    ds_read_b64_tr_b16 a[236:237], v16 offset:24576
    ds_read_b64_tr_b16 a[238:239], v16 offset:28672
    v_mfma_f32_16x16x32_bf16 v[96:99], a[208:211], a[64:67], v[96:99]
    s_waitcnt lgkmcnt(12)
    buffer_load_dwordx4 v48, s[20:23], s49 offen offset:2048 lds
    v_mfma_f32_16x16x32_bf16 v[96:99], a[212:215], a[68:71], v[96:99]
    s_waitcnt lgkmcnt(10)
    ds_read_b64_tr_b16 a[160:161], v13 offset:0
    ds_read_b64_tr_b16 a[162:163], v13 offset:4096
    v_mfma_f32_16x16x32_bf16 v[96:99], a[216:219], a[72:75], v[96:99]
    s_waitcnt lgkmcnt(10)
    buffer_load_dwordx4 v49, s[20:23], s49 offen offset:3072 lds
    v_mfma_f32_16x16x32_bf16 v[96:99], a[220:223], a[76:79], v[96:99]
    s_waitcnt lgkmcnt(8)
    ds_read_b64_tr_b16 a[164:165], v13 offset:8192
    ds_read_b64_tr_b16 a[166:167], v13 offset:12288
    v_mfma_f32_16x16x32_bf16 v[96:99], a[224:227], a[80:83], v[96:99]
    s_waitcnt lgkmcnt(8)
    ds_read_b64_tr_b16 a[168:169], v13 offset:16384
    v_cvt_pk_bf16_f32 v238, v92, v93
    v_mfma_f32_16x16x32_bf16 v[96:99], a[228:231], a[84:87], v[96:99]
    s_waitcnt lgkmcnt(7)
    s_add_u32 s38, s93, 163968
    ds_read_b64_tr_b16 a[170:171], v13 offset:20480
    v_cvt_pk_bf16_f32 v239, v94, v95
    v_mfma_f32_16x16x32_bf16 v[96:99], a[232:235], a[88:91], v[96:99]
    s_waitcnt lgkmcnt(6)
    s_add_u32 s49, s46, 74240
    buffer_store_dwordx4 v[236:239], v56, s[28:31], s38 offen sc1
    v_mfma_f32_16x16x32_bf16 v[96:99], a[236:239], a[92:95], v[96:99]
    s_add_u32 m0, s42, 49152
    ds_read_b64_tr_b16 a[172:173], v13 offset:24576
    ds_read_b64_tr_b16 a[174:175], v13 offset:28672
    v_mfma_f32_16x16x32_bf16 v[100:103], a[208:211], a[96:99], v[100:103]
    buffer_load_dwordx4 v46, s[20:23], s49 offen lds
    v_mfma_f32_16x16x32_bf16 v[100:103], a[212:215], a[100:103], v[100:103]
    ds_read_b64_tr_b16 a[176:177], v17 offset:0
    ds_read_b64_tr_b16 a[178:179], v17 offset:4096
    v_mfma_f32_16x16x32_bf16 v[100:103], a[216:219], a[104:107], v[100:103]
    buffer_load_dwordx4 v47, s[20:23], s49 offen offset:1024 lds
    v_mfma_f32_16x16x32_bf16 v[100:103], a[220:223], a[108:111], v[100:103]
    ds_read_b64_tr_b16 a[180:181], v17 offset:8192
    ds_read_b64_tr_b16 a[182:183], v17 offset:12288
    v_mfma_f32_16x16x32_bf16 v[100:103], a[224:227], a[112:115], v[100:103]
    ds_read_b64_tr_b16 a[184:185], v17 offset:16384
    v_cvt_pk_bf16_f32 v224, v96, v97
    v_mfma_f32_16x16x32_bf16 v[100:103], a[228:231], a[116:119], v[100:103]
    ds_read_b64_tr_b16 a[186:187], v17 offset:20480
    v_cvt_pk_bf16_f32 v225, v98, v99
    v_mfma_f32_16x16x32_bf16 v[100:103], a[232:235], a[120:123], v[100:103]
    ds_read_b64_tr_b16 a[188:189], v17 offset:24576
    v_mov_b32 v249, 0
    v_mfma_f32_16x16x32_bf16 v[100:103], a[236:239], a[124:127], v[100:103]
    s_waitcnt lgkmcnt(13)
    ds_read_b64_tr_b16 a[190:191], v17 offset:28672
    v_mov_b32 v252, 0
    v_mfma_f32_16x16x32_bf16 v[104:107], a[160:163], a[64:67], v[104:107]
    s_waitcnt lgkmcnt(12)
    buffer_load_dwordx4 v48, s[20:23], s49 offen offset:2048 lds
    v_mfma_f32_16x16x32_bf16 v[104:107], a[164:167], a[68:71], v[104:107]
    s_waitcnt lgkmcnt(10)
    ds_read_b64_tr_b16 a[208:209], v14 offset:0
    ds_read_b64_tr_b16 a[210:211], v14 offset:4096
    v_mfma_f32_16x16x32_bf16 v[104:107], a[168:171], a[72:75], v[104:107]
    s_waitcnt lgkmcnt(10)
    buffer_load_dwordx4 v49, s[20:23], s49 offen offset:3072 lds
    v_mfma_f32_16x16x32_bf16 v[104:107], a[172:175], a[76:79], v[104:107]
    s_waitcnt lgkmcnt(8)
    ds_read_b64_tr_b16 a[212:213], v14 offset:8192
    ds_read_b64_tr_b16 a[214:215], v14 offset:12288
    v_mfma_f32_16x16x32_bf16 v[104:107], a[176:179], a[80:83], v[104:107]
    s_waitcnt lgkmcnt(8)
    ds_read_b64_tr_b16 a[216:217], v14 offset:16384
    v_cvt_pk_bf16_f32 v228, v100, v101
    v_mfma_f32_16x16x32_bf16 v[104:107], a[180:183], a[84:87], v[104:107]
    s_waitcnt lgkmcnt(7)
    ds_read_b64_tr_b16 a[218:219], v14 offset:20480
    v_cvt_pk_bf16_f32 v229, v102, v103
    v_mfma_f32_16x16x32_bf16 v[104:107], a[184:187], a[88:91], v[104:107]
    s_waitcnt lgkmcnt(6)
    ds_read_b64_tr_b16 a[220:221], v14 offset:24576
    v_mov_b32 v253, 0
    v_mfma_f32_16x16x32_bf16 v[104:107], a[188:191], a[92:95], v[104:107]
    ds_read_b64_tr_b16 a[222:223], v14 offset:28672
    v_mfma_f32_16x16x32_bf16 v[108:111], a[160:163], a[96:99], v[108:111]
    ds_read_b64_tr_b16 a[224:225], v18 offset:0
    v_mfma_f32_16x16x32_bf16 v[108:111], a[164:167], a[100:103], v[108:111]
    ds_read_b64_tr_b16 a[226:227], v18 offset:4096
    v_mfma_f32_16x16x32_bf16 v[108:111], a[168:171], a[104:107], v[108:111]
    ds_read_b64_tr_b16 a[228:229], v18 offset:8192
    v_mfma_f32_16x16x32_bf16 v[108:111], a[172:175], a[108:111], v[108:111]
    ds_read_b64_tr_b16 a[230:231], v18 offset:12288
    v_mfma_f32_16x16x32_bf16 v[108:111], a[176:179], a[112:115], v[108:111]
    ds_read_b64_tr_b16 a[232:233], v18 offset:16384
    v_cvt_pk_bf16_f32 v226, v104, v105
    v_mfma_f32_16x16x32_bf16 v[108:111], a[180:183], a[116:119], v[108:111]
    s_add_u32 s38, s93, 512
    ds_read_b64_tr_b16 a[234:235], v18 offset:20480
    v_cvt_pk_bf16_f32 v227, v106, v107
    v_mfma_f32_16x16x32_bf16 v[108:111], a[184:187], a[120:123], v[108:111]
    buffer_store_dwordx4 v[224:227], v56, s[28:31], s38 offen sc1
    v_mfma_f32_16x16x32_bf16 v[108:111], a[188:191], a[124:127], v[108:111]
    s_waitcnt lgkmcnt(12)
    ds_read_b64_tr_b16 a[236:237], v18 offset:24576
    ds_read_b64_tr_b16 a[238:239], v18 offset:28672
    v_mfma_f32_16x16x32_bf16 v[112:115], a[208:211], a[64:67], v[112:115]
    s_waitcnt lgkmcnt(12)
    ds_read_b64_tr_b16 a[160:161], v15 offset:0
    v_mfma_f32_16x16x32_bf16 v[112:115], a[212:215], a[68:71], v[112:115]
    s_waitcnt lgkmcnt(11)
    ds_read_b64_tr_b16 a[162:163], v15 offset:4096
    v_mfma_f32_16x16x32_bf16 v[112:115], a[216:219], a[72:75], v[112:115]
    s_waitcnt lgkmcnt(10)
    ds_read_b64_tr_b16 a[164:165], v15 offset:8192
    v_mfma_f32_16x16x32_bf16 v[112:115], a[220:223], a[76:79], v[112:115]
    s_waitcnt lgkmcnt(9)
    ds_read_b64_tr_b16 a[166:167], v15 offset:12288
    v_mfma_f32_16x16x32_bf16 v[112:115], a[224:227], a[80:83], v[112:115]
    s_waitcnt lgkmcnt(8)
    ds_read_b64_tr_b16 a[168:169], v15 offset:16384
    v_cvt_pk_bf16_f32 v230, v108, v109
    v_mfma_f32_16x16x32_bf16 v[112:115], a[228:231], a[84:87], v[112:115]
    s_waitcnt lgkmcnt(7)
    s_add_u32 s38, s93, 164352
    ds_read_b64_tr_b16 a[170:171], v15 offset:20480
    v_cvt_pk_bf16_f32 v231, v110, v111
    v_mfma_f32_16x16x32_bf16 v[112:115], a[232:235], a[88:91], v[112:115]
    s_waitcnt lgkmcnt(6)
    buffer_store_dwordx4 v[228:231], v56, s[28:31], s38 offen sc1
    v_mfma_f32_16x16x32_bf16 v[112:115], a[236:239], a[92:95], v[112:115]
    ds_read_b64_tr_b16 a[172:173], v15 offset:24576
    ds_read_b64_tr_b16 a[174:175], v15 offset:28672
    v_mfma_f32_16x16x32_bf16 v[116:119], a[208:211], a[96:99], v[116:119]
    ds_read_b64_tr_b16 a[176:177], v19 offset:0
    v_mfma_f32_16x16x32_bf16 v[116:119], a[212:215], a[100:103], v[116:119]
    ds_read_b64_tr_b16 a[178:179], v19 offset:4096
    v_mfma_f32_16x16x32_bf16 v[116:119], a[216:219], a[104:107], v[116:119]
    ds_read_b64_tr_b16 a[180:181], v19 offset:8192
    v_mfma_f32_16x16x32_bf16 v[116:119], a[220:223], a[108:111], v[116:119]
    ds_read_b64_tr_b16 a[182:183], v19 offset:12288
    v_mfma_f32_16x16x32_bf16 v[116:119], a[224:227], a[112:115], v[116:119]
    ds_read_b64_tr_b16 a[184:185], v19 offset:16384
    v_cvt_pk_bf16_f32 v232, v112, v113
    v_mfma_f32_16x16x32_bf16 v[116:119], a[228:231], a[116:119], v[116:119]
    ds_read_b64_tr_b16 a[186:187], v19 offset:20480
    v_cvt_pk_bf16_f32 v233, v114, v115
    v_mfma_f32_16x16x32_bf16 v[116:119], a[232:235], a[120:123], v[116:119]
    ds_read_b64_tr_b16 a[188:189], v19 offset:24576
    v_mfma_f32_16x16x32_bf16 v[116:119], a[236:239], a[124:127], v[116:119]
    s_waitcnt lgkmcnt(13)
    ds_read_b64_tr_b16 a[190:191], v19 offset:28672
    s_waitcnt vmcnt(17)
    s_barrier
    v_mfma_f32_16x16x32_bf16 v[120:123], a[160:163], a[64:67], v[120:123]
    s_waitcnt lgkmcnt(12)
    ds_read_b64_tr_b16 a[208:209], v20 offset:0
    v_mfma_f32_16x16x32_bf16 v[120:123], a[164:167], a[68:71], v[120:123]
    s_waitcnt lgkmcnt(11)
    ds_read_b64_tr_b16 a[210:211], v20 offset:4096
    v_mfma_f32_16x16x32_bf16 v[120:123], a[168:171], a[72:75], v[120:123]
    s_waitcnt lgkmcnt(10)
    ds_read_b64_tr_b16 a[212:213], v20 offset:8192
    v_mfma_f32_16x16x32_bf16 v[120:123], a[172:175], a[76:79], v[120:123]
    s_waitcnt lgkmcnt(9)
    ds_read_b64_tr_b16 a[214:215], v20 offset:12288
    v_mfma_f32_16x16x32_bf16 v[120:123], a[176:179], a[80:83], v[120:123]
    s_waitcnt lgkmcnt(8)
    ds_read_b64_tr_b16 a[216:217], v20 offset:16384
    v_cvt_pk_bf16_f32 v236, v116, v117
    v_mfma_f32_16x16x32_bf16 v[120:123], a[180:183], a[84:87], v[120:123]
    s_waitcnt lgkmcnt(7)
    ds_read_b64_tr_b16 a[218:219], v20 offset:20480
    v_cvt_pk_bf16_f32 v237, v118, v119
    v_mfma_f32_16x16x32_bf16 v[120:123], a[184:187], a[88:91], v[120:123]
    s_waitcnt lgkmcnt(6)
    s_add_u32 s49, s7, 768
    ds_read_b64_tr_b16 a[220:221], v20 offset:24576
    v_mfma_f32_16x16x32_bf16 v[120:123], a[188:191], a[92:95], v[120:123]
    s_add_u32 m0, s42, 98304
    ds_read_b64_tr_b16 a[222:223], v20 offset:28672
    v_mfma_f32_16x16x32_bf16 v[124:127], a[160:163], a[96:99], v[124:127]
    buffer_load_dwordx4 v46, s[20:23], s49 offen lds
    v_mfma_f32_16x16x32_bf16 v[124:127], a[164:167], a[100:103], v[124:127]
    ds_read_b64_tr_b16 a[224:225], v24 offset:0
    ds_read_b64_tr_b16 a[226:227], v24 offset:4096
    v_mfma_f32_16x16x32_bf16 v[124:127], a[168:171], a[104:107], v[124:127]
    buffer_load_dwordx4 v47, s[20:23], s49 offen offset:1024 lds
    v_mfma_f32_16x16x32_bf16 v[124:127], a[172:175], a[108:111], v[124:127]
    ds_read_b64_tr_b16 a[228:229], v24 offset:8192
    ds_read_b64_tr_b16 a[230:231], v24 offset:12288
    v_mfma_f32_16x16x32_bf16 v[124:127], a[176:179], a[112:115], v[124:127]
    ds_read_b64_tr_b16 a[232:233], v24 offset:16384
    v_cvt_pk_bf16_f32 v234, v120, v121
    v_mfma_f32_16x16x32_bf16 v[124:127], a[180:183], a[116:119], v[124:127]
    s_add_u32 s38, s93, 640
    ds_read_b64_tr_b16 a[234:235], v24 offset:20480
    v_cvt_pk_bf16_f32 v235, v122, v123
    v_mfma_f32_16x16x32_bf16 v[124:127], a[184:187], a[120:123], v[124:127]
    buffer_store_dwordx4 v[232:235], v56, s[28:31], s38 offen sc1
    v_mfma_f32_16x16x32_bf16 v[124:127], a[188:191], a[124:127], v[124:127]
    s_waitcnt lgkmcnt(12)
    ds_read_b64_tr_b16 a[236:237], v24 offset:24576
    ds_read_b64_tr_b16 a[238:239], v24 offset:28672
    v_mfma_f32_16x16x32_bf16 v[64:67], a[208:211], v[128:131], 0
    s_waitcnt lgkmcnt(12)
    buffer_load_dwordx4 v48, s[20:23], s49 offen offset:2048 lds
    v_mfma_f32_16x16x32_bf16 v[64:67], a[212:215], v[144:147], v[64:67]
    s_waitcnt lgkmcnt(10)
    ds_read_b64_tr_b16 a[160:161], v21 offset:0
    ds_read_b64_tr_b16 a[162:163], v21 offset:4096
    v_mfma_f32_16x16x32_bf16 v[64:67], a[216:219], v[192:195], v[64:67]
    s_waitcnt lgkmcnt(10)
    buffer_load_dwordx4 v49, s[20:23], s49 offen offset:3072 lds
    v_mfma_f32_16x16x32_bf16 v[64:67], a[220:223], v[176:179], v[64:67]
    s_waitcnt lgkmcnt(8)
    ds_read_b64_tr_b16 a[164:165], v21 offset:8192
    ds_read_b64_tr_b16 a[166:167], v21 offset:12288
    v_mfma_f32_16x16x32_bf16 v[64:67], a[224:227], v[136:139], v[64:67]
    s_waitcnt lgkmcnt(8)
    ds_read_b64_tr_b16 a[168:169], v21 offset:16384
    v_cvt_pk_bf16_f32 v238, v124, v125
    v_mfma_f32_16x16x32_bf16 v[64:67], a[228:231], v[152:155], v[64:67]
    s_waitcnt lgkmcnt(7)
    s_add_u32 s38, s93, 164480
    ds_read_b64_tr_b16 a[170:171], v21 offset:20480
    v_cvt_pk_bf16_f32 v239, v126, v127
    v_mfma_f32_16x16x32_bf16 v[64:67], a[232:235], v[200:203], v[64:67]
    s_waitcnt lgkmcnt(6)
    s_add_u32 s49, s7, 74496
    buffer_store_dwordx4 v[236:239], v56, s[28:31], s38 offen sc1
    v_mfma_f32_16x16x32_bf16 v[64:67], a[236:239], v[184:187], v[64:67]
    s_add_u32 m0, s42, 114688
    ds_read_b64_tr_b16 a[172:173], v21 offset:24576
    ds_read_b64_tr_b16 a[174:175], v21 offset:28672
    v_mfma_f32_16x16x32_bf16 v[68:71], a[208:211], v[132:135], 0
    buffer_load_dwordx4 v46, s[20:23], s49 offen lds
    v_mfma_f32_16x16x32_bf16 v[68:71], a[212:215], v[148:151], v[68:71]
    ds_read_b64_tr_b16 a[176:177], v25 offset:0
    ds_read_b64_tr_b16 a[178:179], v25 offset:4096
    v_mfma_f32_16x16x32_bf16 v[68:71], a[216:219], v[196:199], v[68:71]
    buffer_load_dwordx4 v47, s[20:23], s49 offen offset:1024 lds
    v_mfma_f32_16x16x32_bf16 v[68:71], a[220:223], v[180:183], v[68:71]
    ds_read_b64_tr_b16 a[180:181], v25 offset:8192
    ds_read_b64_tr_b16 a[182:183], v25 offset:12288
    v_mfma_f32_16x16x32_bf16 v[68:71], a[224:227], v[140:143], v[68:71]
    ds_read_b64_tr_b16 a[184:185], v25 offset:16384
    v_mfma_f32_16x16x32_bf16 v[68:71], a[228:231], v[156:159], v[68:71]
    ds_read_b64_tr_b16 a[186:187], v25 offset:20480
    v_mfma_f32_16x16x32_bf16 v[68:71], a[232:235], v[204:207], v[68:71]
    ds_read_b64_tr_b16 a[188:189], v25 offset:24576
    v_mfma_f32_16x16x32_bf16 v[68:71], a[236:239], v[188:191], v[68:71]
    s_waitcnt lgkmcnt(13)
    ds_read_b64_tr_b16 a[190:191], v25 offset:28672
    v_mfma_f32_16x16x32_bf16 v[72:75], a[160:163], v[128:131], 0
    s_waitcnt lgkmcnt(12)
    buffer_load_dwordx4 v48, s[20:23], s49 offen offset:2048 lds
    v_mfma_f32_16x16x32_bf16 v[72:75], a[164:167], v[144:147], v[72:75]
    s_waitcnt lgkmcnt(10)
    ds_read_b64_tr_b16 a[208:209], v22 offset:0
    ds_read_b64_tr_b16 a[210:211], v22 offset:4096
    v_mfma_f32_16x16x32_bf16 v[72:75], a[168:171], v[192:195], v[72:75]
    s_waitcnt lgkmcnt(10)
    buffer_load_dwordx4 v49, s[20:23], s49 offen offset:3072 lds
    v_mfma_f32_16x16x32_bf16 v[72:75], a[172:175], v[176:179], v[72:75]
    s_waitcnt lgkmcnt(8)
    ds_read_b64_tr_b16 a[212:213], v22 offset:8192
    ds_read_b64_tr_b16 a[214:215], v22 offset:12288
    v_mfma_f32_16x16x32_bf16 v[72:75], a[176:179], v[136:139], v[72:75]
    s_waitcnt lgkmcnt(8)
    ds_read_b64_tr_b16 a[216:217], v22 offset:16384
    v_mfma_f32_16x16x32_bf16 v[72:75], a[180:183], v[152:155], v[72:75]
    s_waitcnt lgkmcnt(7)
    ds_read_b64_tr_b16 a[218:219], v22 offset:20480
    v_mfma_f32_16x16x32_bf16 v[72:75], a[184:187], v[200:203], v[72:75]
    s_waitcnt lgkmcnt(6)
    ds_read_b64_tr_b16 a[220:221], v22 offset:24576
    v_mfma_f32_16x16x32_bf16 v[72:75], a[188:191], v[184:187], v[72:75]
    ds_read_b64_tr_b16 a[222:223], v22 offset:28672
    v_mfma_f32_16x16x32_bf16 v[76:79], a[160:163], v[132:135], 0
    ds_read_b64_tr_b16 a[224:225], v26 offset:0
    v_mfma_f32_16x16x32_bf16 v[76:79], a[164:167], v[148:151], v[76:79]
Ltour10:
    s_cbranch_execz Ltour14
    ds_read_b64_tr_b16 a[226:227], v26 offset:4096
    v_mfma_f32_16x16x32_bf16 v[76:79], a[168:171], v[196:199], v[76:79]
    ds_read_b64_tr_b16 a[228:229], v26 offset:8192
    v_mfma_f32_16x16x32_bf16 v[76:79], a[172:175], v[180:183], v[76:79]
    ds_read_b64_tr_b16 a[230:231], v26 offset:12288
    v_mfma_f32_16x16x32_bf16 v[76:79], a[176:179], v[140:143], v[76:79]
    ds_read_b64_tr_b16 a[232:233], v26 offset:16384
    v_mfma_f32_16x16x32_bf16 v[76:79], a[180:183], v[156:159], v[76:79]
    ds_read_b64_tr_b16 a[234:235], v26 offset:20480
    v_mfma_f32_16x16x32_bf16 v[76:79], a[184:187], v[204:207], v[76:79]
    buffer_load_dword v63, v63, s[88:91], 0 offen sc1
    v_mfma_f32_16x16x32_bf16 v[76:79], a[188:191], v[188:191], v[76:79]
    s_waitcnt lgkmcnt(12)
    ds_read_b64_tr_b16 a[236:237], v26 offset:24576
    ds_read_b64_tr_b16 a[238:239], v26 offset:28672
    v_mfma_f32_16x16x32_bf16 v[80:83], a[208:211], v[128:131], 0
    s_waitcnt lgkmcnt(12)
    ds_read_b64_tr_b16 a[160:161], v23 offset:0
    v_mfma_f32_16x16x32_bf16 v[80:83], a[212:215], v[144:147], v[80:83]
    s_waitcnt lgkmcnt(11)
    ds_read_b64_tr_b16 a[162:163], v23 offset:4096
    v_mfma_f32_16x16x32_bf16 v[80:83], a[216:219], v[192:195], v[80:83]
    s_waitcnt lgkmcnt(10)
    ds_read_b64_tr_b16 a[164:165], v23 offset:8192
    v_mfma_f32_16x16x32_bf16 v[80:83], a[220:223], v[176:179], v[80:83]
    s_waitcnt lgkmcnt(9)
    ds_read_b64_tr_b16 a[166:167], v23 offset:12288
    v_mfma_f32_16x16x32_bf16 v[80:83], a[224:227], v[136:139], v[80:83]
    s_waitcnt lgkmcnt(8)
    ds_read_b64_tr_b16 a[168:169], v23 offset:16384
    v_mfma_f32_16x16x32_bf16 v[80:83], a[228:231], v[152:155], v[80:83]
    s_waitcnt lgkmcnt(7)
    ds_read_b64_tr_b16 a[170:171], v23 offset:20480
    v_mfma_f32_16x16x32_bf16 v[80:83], a[232:235], v[200:203], v[80:83]
    s_waitcnt lgkmcnt(6)
    ds_read_b64_tr_b16 a[172:173], v23 offset:24576
    v_mfma_f32_16x16x32_bf16 v[80:83], a[236:239], v[184:187], v[80:83]
    ds_read_b64_tr_b16 a[174:175], v23 offset:28672
    v_mfma_f32_16x16x32_bf16 v[84:87], a[208:211], v[132:135], 0
    ds_read_b64_tr_b16 a[176:177], v27 offset:0
    v_mfma_f32_16x16x32_bf16 v[84:87], a[212:215], v[148:151], v[84:87]
    ds_read_b64_tr_b16 a[178:179], v27 offset:4096
    v_mfma_f32_16x16x32_bf16 v[84:87], a[216:219], v[196:199], v[84:87]
    ds_read_b64_tr_b16 a[180:181], v27 offset:8192
    v_mfma_f32_16x16x32_bf16 v[84:87], a[220:223], v[180:183], v[84:87]
    ds_read_b64_tr_b16 a[182:183], v27 offset:12288
    v_mfma_f32_16x16x32_bf16 v[84:87], a[224:227], v[140:143], v[84:87]
    ds_read_b64_tr_b16 a[184:185], v27 offset:16384
    v_mfma_f32_16x16x32_bf16 v[84:87], a[228:231], v[156:159], v[84:87]
    ds_read_b64_tr_b16 a[186:187], v27 offset:20480
    v_mfma_f32_16x16x32_bf16 v[84:87], a[232:235], v[204:207], v[84:87]
    ds_read_b64_tr_b16 a[188:189], v27 offset:24576
    v_mfma_f32_16x16x32_bf16 v[84:87], a[236:239], v[188:191], v[84:87]
    s_waitcnt lgkmcnt(13)
    ds_read_b64_tr_b16 a[190:191], v27 offset:28672
    s_waitcnt vmcnt(13)
    s_barrier
    v_mfma_f32_16x16x32_bf16 v[88:91], a[160:163], v[128:131], 0
    s_waitcnt lgkmcnt(12)
    ds_read_b64_tr_b16 a[208:209], v12 offset:32768
    v_mfma_f32_16x16x32_bf16 v[88:91], a[164:167], v[144:147], v[88:91]
    s_waitcnt lgkmcnt(11)
    ds_read_b64_tr_b16 a[210:211], v12 offset:36864
    v_mfma_f32_16x16x32_bf16 v[88:91], a[168:171], v[192:195], v[88:91]
    s_waitcnt lgkmcnt(10)
    ds_read_b64_tr_b16 a[212:213], v12 offset:40960
    v_mfma_f32_16x16x32_bf16 v[88:91], a[172:175], v[176:179], v[88:91]
    s_waitcnt lgkmcnt(9)
    ds_read_b64_tr_b16 a[214:215], v12 offset:45056
    v_mfma_f32_16x16x32_bf16 v[88:91], a[176:179], v[136:139], v[88:91]
    s_waitcnt lgkmcnt(8)
    ds_read_b64_tr_b16 a[216:217], v12 offset:49152
    v_mfma_f32_16x16x32_bf16 v[88:91], a[180:183], v[152:155], v[88:91]
    s_waitcnt lgkmcnt(7)
    ds_read_b64_tr_b16 a[218:219], v12 offset:53248
    v_mfma_f32_16x16x32_bf16 v[88:91], a[184:187], v[200:203], v[88:91]
    s_waitcnt lgkmcnt(6)
    s_add_u32 s49, s46, 768
    ds_read_b64_tr_b16 a[220:221], v12 offset:57344
    v_mfma_f32_16x16x32_bf16 v[88:91], a[188:191], v[184:187], v[88:91]
    s_add_u32 m0, s42, 0
    ds_read_b64_tr_b16 a[222:223], v12 offset:61440
    v_mfma_f32_16x16x32_bf16 v[92:95], a[160:163], v[132:135], 0
    buffer_load_dwordx4 v46, s[20:23], s49 offen lds
    v_mfma_f32_16x16x32_bf16 v[92:95], a[164:167], v[148:151], v[92:95]
    ds_read_b64_tr_b16 a[224:225], v16 offset:32768
    ds_read_b64_tr_b16 a[226:227], v16 offset:36864
    v_mfma_f32_16x16x32_bf16 v[92:95], a[168:171], v[196:199], v[92:95]
    buffer_load_dwordx4 v47, s[20:23], s49 offen offset:1024 lds
    v_mfma_f32_16x16x32_bf16 v[92:95], a[172:175], v[180:183], v[92:95]
    ds_read_b64_tr_b16 a[228:229], v16 offset:40960
    ds_read_b64_tr_b16 a[230:231], v16 offset:45056
    v_mfma_f32_16x16x32_bf16 v[92:95], a[176:179], v[140:143], v[92:95]
    ds_read_b64_tr_b16 a[232:233], v16 offset:49152
    v_mfma_f32_16x16x32_bf16 v[92:95], a[180:183], v[156:159], v[92:95]
    ds_read_b64_tr_b16 a[234:235], v16 offset:53248
    v_mfma_f32_16x16x32_bf16 v[92:95], a[184:187], v[204:207], v[92:95]
    ds_read_b64_tr_b16 a[236:237], v16 offset:57344
    v_mfma_f32_16x16x32_bf16 v[92:95], a[188:191], v[188:191], v[92:95]
    s_waitcnt lgkmcnt(13)
    ds_read_b64_tr_b16 a[238:239], v16 offset:61440
    v_mfma_f32_16x16x32_bf16 v[64:67], a[208:211], a[64:67], v[64:67]
    s_waitcnt lgkmcnt(12)
    buffer_load_dwordx4 v48, s[20:23], s49 offen offset:2048 lds
    v_mfma_f32_16x16x32_bf16 v[64:67], a[212:215], a[68:71], v[64:67]
    s_waitcnt lgkmcnt(10)
    ds_read_b64_tr_b16 a[160:161], v13 offset:32768
    ds_read_b64_tr_b16 a[162:163], v13 offset:36864
    v_mfma_f32_16x16x32_bf16 v[64:67], a[216:219], a[72:75], v[64:67]
    s_waitcnt lgkmcnt(10)
    s_add_u32 s92, s92, 16
    buffer_load_dwordx4 v49, s[20:23], s49 offen offset:3072 lds
    v_mfma_f32_16x16x32_bf16 v[64:67], a[220:223], a[76:79], v[64:67]
    s_waitcnt lgkmcnt(8)
    s_waitcnt vmcnt(9)
    ds_read_b64_tr_b16 a[164:165], v13 offset:40960
    ds_read_b64_tr_b16 a[166:167], v13 offset:45056
    v_mfma_f32_16x16x32_bf16 v[64:67], a[224:227], a[80:83], v[64:67]
    s_waitcnt lgkmcnt(8)
    buffer_store_dword v10, v8, s[24:27], s92 offen sc1
    v_mfma_f32_16x16x32_bf16 v[64:67], a[228:231], a[84:87], v[64:67]
    s_waitcnt lgkmcnt(6)
    ds_read_b64_tr_b16 a[168:169], v13 offset:49152
    ds_read_b64_tr_b16 a[170:171], v13 offset:53248
    v_mfma_f32_16x16x32_bf16 v[64:67], a[232:235], a[88:91], v[64:67]
    s_waitcnt lgkmcnt(6)
    s_add_u32 s49, s46, 74496
    ds_read_b64_tr_b16 a[172:173], v13 offset:57344
    v_mfma_f32_16x16x32_bf16 v[64:67], a[236:239], a[92:95], v[64:67]
    s_add_u32 m0, s42, 16384
    ds_read_b64_tr_b16 a[174:175], v13 offset:61440
    v_mfma_f32_16x16x32_bf16 v[68:71], a[208:211], a[96:99], v[68:71]
    buffer_load_dwordx4 v46, s[20:23], s49 offen lds
    v_mfma_f32_16x16x32_bf16 v[68:71], a[212:215], a[100:103], v[68:71]
    ds_read_b64_tr_b16 a[176:177], v17 offset:32768
    ds_read_b64_tr_b16 a[178:179], v17 offset:36864
    v_mfma_f32_16x16x32_bf16 v[68:71], a[216:219], a[104:107], v[68:71]
    buffer_load_dwordx4 v47, s[20:23], s49 offen offset:1024 lds
    v_mfma_f32_16x16x32_bf16 v[68:71], a[220:223], a[108:111], v[68:71]
    ds_read_b64_tr_b16 a[180:181], v17 offset:40960
    ds_read_b64_tr_b16 a[182:183], v17 offset:45056
    v_mfma_f32_16x16x32_bf16 v[68:71], a[224:227], a[112:115], v[68:71]
    ds_read_b64_tr_b16 a[184:185], v17 offset:49152
    v_cvt_pk_bf16_f32 v224, v64, v65
    v_mfma_f32_16x16x32_bf16 v[68:71], a[228:231], a[116:119], v[68:71]
    ds_read_b64_tr_b16 a[186:187], v17 offset:53248
    v_cvt_pk_bf16_f32 v225, v66, v67
    v_mfma_f32_16x16x32_bf16 v[68:71], a[232:235], a[120:123], v[68:71]
    ds_read_b64_tr_b16 a[188:189], v17 offset:57344
    v_mfma_f32_16x16x32_bf16 v[68:71], a[236:239], a[124:127], v[68:71]
    s_waitcnt lgkmcnt(13)
    ds_read_b64_tr_b16 a[190:191], v17 offset:61440
    v_mfma_f32_16x16x32_bf16 v[72:75], a[160:163], a[64:67], v[72:75]
    s_waitcnt lgkmcnt(12)
    buffer_load_dwordx4 v48, s[20:23], s49 offen offset:2048 lds
    v_mfma_f32_16x16x32_bf16 v[72:75], a[164:167], a[68:71], v[72:75]
    s_waitcnt lgkmcnt(10)
    ds_read_b64_tr_b16 a[208:209], v14 offset:32768
    ds_read_b64_tr_b16 a[210:211], v14 offset:36864
    v_mfma_f32_16x16x32_bf16 v[72:75], a[168:171], a[72:75], v[72:75]
    s_waitcnt lgkmcnt(10)
    buffer_load_dwordx4 v49, s[20:23], s49 offen offset:3072 lds
    v_mfma_f32_16x16x32_bf16 v[72:75], a[172:175], a[76:79], v[72:75]
    s_waitcnt lgkmcnt(8)
    ds_read_b64_tr_b16 a[212:213], v14 offset:40960
    ds_read_b64_tr_b16 a[214:215], v14 offset:45056
    v_mfma_f32_16x16x32_bf16 v[72:75], a[176:179], a[80:83], v[72:75]
    s_waitcnt lgkmcnt(8)
    ds_read_b64_tr_b16 a[216:217], v14 offset:49152
    v_cvt_pk_bf16_f32 v228, v68, v69
    v_mfma_f32_16x16x32_bf16 v[72:75], a[180:183], a[84:87], v[72:75]
    s_waitcnt lgkmcnt(7)
    ds_read_b64_tr_b16 a[218:219], v14 offset:53248
    v_cvt_pk_bf16_f32 v229, v70, v71
    v_mfma_f32_16x16x32_bf16 v[72:75], a[184:187], a[88:91], v[72:75]
    s_waitcnt lgkmcnt(6)
    s_and_b32 s42, s2, 7
    ds_read_b64_tr_b16 a[220:221], v14 offset:57344
    v_mfma_f32_16x16x32_bf16 v[72:75], a[188:191], a[92:95], v[72:75]
    s_mov_b64 s[20:21], s[52:53]
    ds_read_b64_tr_b16 a[222:223], v14 offset:61440
    v_mfma_f32_16x16x32_bf16 v[76:79], a[160:163], a[96:99], v[76:79]
    ds_read_b64_tr_b16 a[224:225], v18 offset:32768
    s_waitcnt vmcnt(9)
    v_readfirstlane_b32 s37, v63
    v_mfma_f32_16x16x32_bf16 v[76:79], a[164:167], a[100:103], v[76:79]
    s_mov_b32 s22, 1152
    ds_read_b64_tr_b16 a[226:227], v18 offset:36864
    v_mfma_f32_16x16x32_bf16 v[76:79], a[168:171], a[104:107], v[76:79]
    s_mov_b32 s23, 0x20000
    ds_read_b64_tr_b16 a[228:229], v18 offset:40960
    s_cmp_lt_u32 s37, 256
    s_cbranch_scc1 Lattn_armwait
Lattn_armed:
    v_mfma_f32_16x16x32_bf16 v[76:79], a[172:175], a[108:111], v[76:79]
    ds_read_b64_tr_b16 a[230:231], v18 offset:45056
    v_mfma_f32_16x16x32_bf16 v[76:79], a[176:179], a[112:115], v[76:79]
    ds_read_b64_tr_b16 a[232:233], v18 offset:49152
    v_cvt_pk_bf16_f32 v226, v72, v73
    v_mfma_f32_16x16x32_bf16 v[76:79], a[180:183], a[116:119], v[76:79]
    s_add_u32 s38, s93, 1024
    ds_read_b64_tr_b16 a[234:235], v18 offset:53248
    v_cvt_pk_bf16_f32 v227, v74, v75
    v_mfma_f32_16x16x32_bf16 v[76:79], a[184:187], a[120:123], v[76:79]
    buffer_store_dwordx4 v[224:227], v56, s[28:31], s38 offen sc1
    v_mfma_f32_16x16x32_bf16 v[76:79], a[188:191], a[124:127], v[76:79]
    s_waitcnt lgkmcnt(12)
    s_mov_b32 s45, 18688
    ds_read_b64_tr_b16 a[236:237], v18 offset:57344
    ds_read_b64_tr_b16 a[238:239], v18 offset:61440
    v_mfma_f32_16x16x32_bf16 v[80:83], a[208:211], a[64:67], v[80:83]
    s_waitcnt lgkmcnt(12)
    buffer_load_dwordx4 v[160:163], v5, s[24:27], s45 offen offset:0 sc1
    v_mfma_f32_16x16x32_bf16 v[80:83], a[212:215], a[68:71], v[80:83]
    s_waitcnt lgkmcnt(10)
    ds_read_b64_tr_b16 a[160:161], v15 offset:32768
    ds_read_b64_tr_b16 a[162:163], v15 offset:36864
    v_mfma_f32_16x16x32_bf16 v[80:83], a[216:219], a[72:75], v[80:83]
    s_waitcnt lgkmcnt(10)
    ds_read_b64_tr_b16 a[164:165], v15 offset:40960
    v_mfma_f32_16x16x32_bf16 v[80:83], a[220:223], a[76:79], v[80:83]
    s_waitcnt lgkmcnt(9)
    ds_read_b64_tr_b16 a[166:167], v15 offset:45056
    v_mfma_f32_16x16x32_bf16 v[80:83], a[224:227], a[80:83], v[80:83]
    s_waitcnt lgkmcnt(8)
    ds_read_b64_tr_b16 a[168:169], v15 offset:49152
    v_cvt_pk_bf16_f32 v230, v76, v77
    v_mfma_f32_16x16x32_bf16 v[80:83], a[228:231], a[84:87], v[80:83]
    s_waitcnt lgkmcnt(7)
    s_add_u32 s38, s93, 164864
    ds_read_b64_tr_b16 a[170:171], v15 offset:53248
    v_cvt_pk_bf16_f32 v231, v78, v79
    v_mfma_f32_16x16x32_bf16 v[80:83], a[232:235], a[88:91], v[80:83]
    s_waitcnt lgkmcnt(6)
    buffer_store_dwordx4 v[228:231], v56, s[28:31], s38 offen sc1
    v_mfma_f32_16x16x32_bf16 v[80:83], a[236:239], a[92:95], v[80:83]
    ds_read_b64_tr_b16 a[172:173], v15 offset:57344
    ds_read_b64_tr_b16 a[174:175], v15 offset:61440
    v_mfma_f32_16x16x32_bf16 v[84:87], a[208:211], a[96:99], v[84:87]
    buffer_load_dwordx4 v[164:167], v5, s[24:27], s45 offen offset:512 sc1
    v_mfma_f32_16x16x32_bf16 v[84:87], a[212:215], a[100:103], v[84:87]
    ds_read_b64_tr_b16 a[176:177], v19 offset:32768
    ds_read_b64_tr_b16 a[178:179], v19 offset:36864
    v_mfma_f32_16x16x32_bf16 v[84:87], a[216:219], a[104:107], v[84:87]
    ds_read_b64_tr_b16 a[180:181], v19 offset:40960
    v_mfma_f32_16x16x32_bf16 v[84:87], a[220:223], a[108:111], v[84:87]
    ds_read_b64_tr_b16 a[182:183], v19 offset:45056
    v_mfma_f32_16x16x32_bf16 v[84:87], a[224:227], a[112:115], v[84:87]
    ds_read_b64_tr_b16 a[184:185], v19 offset:49152
    v_cvt_pk_bf16_f32 v232, v80, v81
    v_mfma_f32_16x16x32_bf16 v[84:87], a[228:231], a[116:119], v[84:87]
    ds_read_b64_tr_b16 a[186:187], v19 offset:53248
    v_cvt_pk_bf16_f32 v233, v82, v83
    v_mfma_f32_16x16x32_bf16 v[84:87], a[232:235], a[120:123], v[84:87]
    buffer_load_dwordx4 v[168:171], v59, s[24:27], s45 offen offset:1024 sc1
    v_mfma_f32_16x16x32_bf16 v[84:87], a[236:239], a[124:127], v[84:87]
    s_waitcnt lgkmcnt(12)
    ds_read_b64_tr_b16 a[188:189], v19 offset:57344
    ds_read_b64_tr_b16 a[190:191], v19 offset:61440
    s_barrier
    v_mfma_f32_16x16x32_bf16 v[88:91], a[160:163], a[64:67], v[88:91]
    s_waitcnt lgkmcnt(12)
    ds_read_b64_tr_b16 a[208:209], v20 offset:32768
    v_mfma_f32_16x16x32_bf16 v[88:91], a[164:167], a[68:71], v[88:91]
    s_waitcnt lgkmcnt(11)
    s_mov_b32 s45, 20992
    ds_read_b64_tr_b16 a[210:211], v20 offset:36864
    v_mfma_f32_16x16x32_bf16 v[88:91], a[168:171], a[72:75], v[88:91]
    s_waitcnt lgkmcnt(10)
    buffer_load_dwordx4 v[172:175], v5, s[24:27], s45 offen offset:0 sc1
    v_mfma_f32_16x16x32_bf16 v[88:91], a[172:175], a[76:79], v[88:91]
    s_waitcnt lgkmcnt(8)
    ds_read_b64_tr_b16 a[212:213], v20 offset:40960
    ds_read_b64_tr_b16 a[214:215], v20 offset:45056
    v_mfma_f32_16x16x32_bf16 v[88:91], a[176:179], a[80:83], v[88:91]
    s_waitcnt lgkmcnt(8)
    ds_read_b64_tr_b16 a[216:217], v20 offset:49152
    v_cvt_pk_bf16_f32 v236, v84, v85
    v_mfma_f32_16x16x32_bf16 v[88:91], a[180:183], a[84:87], v[88:91]
    s_waitcnt lgkmcnt(7)
    ds_read_b64_tr_b16 a[218:219], v20 offset:53248
    v_cvt_pk_bf16_f32 v237, v86, v87
    v_mfma_f32_16x16x32_bf16 v[88:91], a[184:187], a[88:91], v[88:91]
    s_waitcnt lgkmcnt(6)
    ds_read_b64_tr_b16 a[220:221], v20 offset:57344
    v_mfma_f32_16x16x32_bf16 v[88:91], a[188:191], a[92:95], v[88:91]
    ds_read_b64_tr_b16 a[222:223], v20 offset:61440
    v_mfma_f32_16x16x32_bf16 v[92:95], a[160:163], a[96:99], v[92:95]
    buffer_load_dwordx4 v[208:211], v5, s[24:27], s45 offen offset:512 sc1
    v_mfma_f32_16x16x32_bf16 v[92:95], a[164:167], a[100:103], v[92:95]
    ds_read_b64_tr_b16 a[224:225], v24 offset:32768
    ds_read_b64_tr_b16 a[226:227], v24 offset:36864
    v_mfma_f32_16x16x32_bf16 v[92:95], a[168:171], a[104:107], v[92:95]
    ds_read_b64_tr_b16 a[228:229], v24 offset:40960
    v_mfma_f32_16x16x32_bf16 v[92:95], a[172:175], a[108:111], v[92:95]
    ds_read_b64_tr_b16 a[230:231], v24 offset:45056
    v_mfma_f32_16x16x32_bf16 v[92:95], a[176:179], a[112:115], v[92:95]
    ds_read_b64_tr_b16 a[232:233], v24 offset:49152
    v_cvt_pk_bf16_f32 v234, v88, v89
    v_mfma_f32_16x16x32_bf16 v[92:95], a[180:183], a[116:119], v[92:95]
    s_add_u32 s38, s93, 1152
    ds_read_b64_tr_b16 a[234:235], v24 offset:53248
    v_cvt_pk_bf16_f32 v235, v90, v91
    v_mfma_f32_16x16x32_bf16 v[92:95], a[184:187], a[120:123], v[92:95]
    buffer_store_dwordx4 v[232:235], v56, s[28:31], s38 offen sc1
    v_mfma_f32_16x16x32_bf16 v[92:95], a[188:191], a[124:127], v[92:95]
    s_waitcnt lgkmcnt(12)
    ds_read_b64_tr_b16 a[236:237], v24 offset:57344
    ds_read_b64_tr_b16 a[238:239], v24 offset:61440
    v_mfma_f32_16x16x32_bf16 v[96:99], a[208:211], v[128:131], 0
    s_waitcnt lgkmcnt(12)
    buffer_load_dwordx4 v[212:215], v59, s[24:27], s45 offen offset:1024 sc1
    v_mfma_f32_16x16x32_bf16 v[96:99], a[212:215], v[144:147], v[96:99]
    s_waitcnt lgkmcnt(10)
    ds_read_b64_tr_b16 a[160:161], v21 offset:32768
    ds_read_b64_tr_b16 a[162:163], v21 offset:36864
    v_mfma_f32_16x16x32_bf16 v[96:99], a[216:219], v[192:195], v[96:99]
    s_waitcnt lgkmcnt(10)
    ds_read_b64_tr_b16 a[164:165], v21 offset:40960
    v_mfma_f32_16x16x32_bf16 v[96:99], a[220:223], v[176:179], v[96:99]
    s_waitcnt lgkmcnt(9)
    ds_read_b64_tr_b16 a[166:167], v21 offset:45056
    v_mfma_f32_16x16x32_bf16 v[96:99], a[224:227], v[136:139], v[96:99]
    s_waitcnt lgkmcnt(8)
    ds_read_b64_tr_b16 a[168:169], v21 offset:49152
    v_cvt_pk_bf16_f32 v238, v92, v93
    v_mfma_f32_16x16x32_bf16 v[96:99], a[228:231], v[152:155], v[96:99]
    s_waitcnt lgkmcnt(7)
    s_add_u32 s38, s93, 164992
    ds_read_b64_tr_b16 a[170:171], v21 offset:53248
    v_cvt_pk_bf16_f32 v239, v94, v95
    v_mfma_f32_16x16x32_bf16 v[96:99], a[232:235], v[200:203], v[96:99]
    s_waitcnt lgkmcnt(6)
    buffer_store_dwordx4 v[236:239], v56, s[28:31], s38 offen sc1
    v_mfma_f32_16x16x32_bf16 v[96:99], a[236:239], v[184:187], v[96:99]
    ds_read_b64_tr_b16 a[172:173], v21 offset:57344
    ds_read_b64_tr_b16 a[174:175], v21 offset:61440
    v_mfma_f32_16x16x32_bf16 v[100:103], a[208:211], v[132:135], 0
    buffer_load_dwordx2 v[92:93], v58, s[12:15], 0 offen offset:1024
    v_mfma_f32_16x16x32_bf16 v[100:103], a[212:215], v[148:151], v[100:103]
    ds_read_b64_tr_b16 a[176:177], v25 offset:32768
    ds_read_b64_tr_b16 a[178:179], v25 offset:36864
    v_mfma_f32_16x16x32_bf16 v[100:103], a[216:219], v[196:199], v[100:103]
    ds_read_b64_tr_b16 a[180:181], v25 offset:40960
    v_mfma_f32_16x16x32_bf16 v[100:103], a[220:223], v[180:183], v[100:103]
    ds_read_b64_tr_b16 a[182:183], v25 offset:45056
    v_mfma_f32_16x16x32_bf16 v[100:103], a[224:227], v[140:143], v[100:103]
    buffer_load_dwordx2 v[94:95], v58, s[12:15], 0 offen offset:1056
    v_mfma_f32_16x16x32_bf16 v[100:103], a[228:231], v[156:159], v[100:103]
    ds_read_b64_tr_b16 a[184:185], v25 offset:49152
    ds_read_b64_tr_b16 a[186:187], v25 offset:53248
    v_mfma_f32_16x16x32_bf16 v[100:103], a[232:235], v[204:207], v[100:103]
    ds_read_b64_tr_b16 a[188:189], v25 offset:57344
    v_mfma_f32_16x16x32_bf16 v[100:103], a[236:239], v[188:191], v[100:103]
    s_waitcnt lgkmcnt(13)
    ds_read_b64_tr_b16 a[190:191], v25 offset:61440
    v_mfma_f32_16x16x32_bf16 v[104:107], a[160:163], v[128:131], 0
    s_waitcnt lgkmcnt(12)
    ds_read_b64_tr_b16 a[208:209], v22 offset:32768
    v_mfma_f32_16x16x32_bf16 v[104:107], a[164:167], v[144:147], v[104:107]
    s_waitcnt lgkmcnt(11)
    s_mov_b32 s45, 19840
    ds_read_b64_tr_b16 a[210:211], v22 offset:36864
    v_mfma_f32_16x16x32_bf16 v[104:107], a[168:171], v[192:195], v[104:107]
    s_waitcnt lgkmcnt(10)
    buffer_load_dwordx4 v[64:67], v5, s[24:27], s45 offen offset:0 sc1
    v_mfma_f32_16x16x32_bf16 v[104:107], a[172:175], v[176:179], v[104:107]
    s_waitcnt lgkmcnt(8)
    ds_read_b64_tr_b16 a[212:213], v22 offset:40960
    ds_read_b64_tr_b16 a[214:215], v22 offset:45056
    v_mfma_f32_16x16x32_bf16 v[104:107], a[176:179], v[136:139], v[104:107]
    s_waitcnt lgkmcnt(8)
    ds_read_b64_tr_b16 a[216:217], v22 offset:49152
    v_mfma_f32_16x16x32_bf16 v[104:107], a[180:183], v[152:155], v[104:107]
    s_waitcnt lgkmcnt(7)
    ds_read_b64_tr_b16 a[218:219], v22 offset:53248
    v_mfma_f32_16x16x32_bf16 v[104:107], a[184:187], v[200:203], v[104:107]
    s_waitcnt lgkmcnt(6)
    buffer_load_dwordx4 v[68:71], v5, s[24:27], s45 offen offset:512 sc1
    v_mfma_f32_16x16x32_bf16 v[104:107], a[188:191], v[184:187], v[104:107]
    ds_read_b64_tr_b16 a[220:221], v22 offset:57344
    ds_read_b64_tr_b16 a[222:223], v22 offset:61440
    v_mfma_f32_16x16x32_bf16 v[108:111], a[160:163], v[132:135], 0
    ds_read_b64_tr_b16 a[224:225], v26 offset:32768
    v_mfma_f32_16x16x32_bf16 v[108:111], a[164:167], v[148:151], v[108:111]
    ds_read_b64_tr_b16 a[226:227], v26 offset:36864
    v_mfma_f32_16x16x32_bf16 v[108:111], a[168:171], v[196:199], v[108:111]
    ds_read_b64_tr_b16 a[228:229], v26 offset:40960
    v_mfma_f32_16x16x32_bf16 v[108:111], a[172:175], v[180:183], v[108:111]
    ds_read_b64_tr_b16 a[230:231], v26 offset:45056
    v_mfma_f32_16x16x32_bf16 v[108:111], a[176:179], v[140:143], v[108:111]
    buffer_load_dwordx4 v[72:75], v59, s[24:27], s45 offen offset:1024 sc1
    v_mfma_f32_16x16x32_bf16 v[108:111], a[180:183], v[156:159], v[108:111]
    ds_read_b64_tr_b16 a[232:233], v26 offset:49152
    ds_read_b64_tr_b16 a[234:235], v26 offset:53248
    v_mfma_f32_16x16x32_bf16 v[108:111], a[184:187], v[204:207], v[108:111]
    ds_read_b64_tr_b16 a[236:237], v26 offset:57344
    v_mfma_f32_16x16x32_bf16 v[108:111], a[188:191], v[188:191], v[108:111]
    s_waitcnt lgkmcnt(13)
    ds_read_b64_tr_b16 a[238:239], v26 offset:61440
    v_mfma_f32_16x16x32_bf16 v[112:115], a[208:211], v[128:131], 0
    s_waitcnt lgkmcnt(12)
    ds_read_b64_tr_b16 a[160:161], v23 offset:32768
    v_mfma_f32_16x16x32_bf16 v[112:115], a[212:215], v[144:147], v[112:115]
    s_waitcnt lgkmcnt(11)
    ds_read_b64_tr_b16 a[162:163], v23 offset:36864
    v_mfma_f32_16x16x32_bf16 v[112:115], a[216:219], v[192:195], v[112:115]
    s_waitcnt lgkmcnt(10)
    buffer_load_dwordx2 v[76:77], v3, s[20:23], 0 offen offset:0
    v_mfma_f32_16x16x32_bf16 v[112:115], a[220:223], v[176:179], v[112:115]
    s_waitcnt lgkmcnt(8)
    ds_read_b64_tr_b16 a[164:165], v23 offset:40960
    ds_read_b64_tr_b16 a[166:167], v23 offset:45056
    v_mfma_f32_16x16x32_bf16 v[112:115], a[224:227], v[136:139], v[112:115]
    s_waitcnt lgkmcnt(8)
    ds_read_b64_tr_b16 a[168:169], v23 offset:49152
    v_mfma_f32_16x16x32_bf16 v[112:115], a[228:231], v[152:155], v[112:115]
    s_waitcnt lgkmcnt(7)
    ds_read_b64_tr_b16 a[170:171], v23 offset:53248
    v_mfma_f32_16x16x32_bf16 v[112:115], a[232:235], v[200:203], v[112:115]
    s_waitcnt lgkmcnt(6)
    buffer_load_dwordx2 v[78:79], v3, s[20:23], 0 offen offset:32
    v_mfma_f32_16x16x32_bf16 v[112:115], a[236:239], v[184:187], v[112:115]
    ds_read_b64_tr_b16 a[172:173], v23 offset:57344
    ds_read_b64_tr_b16 a[174:175], v23 offset:61440
    v_mfma_f32_16x16x32_bf16 v[116:119], a[208:211], v[132:135], 0
    ds_read_b64_tr_b16 a[176:177], v27 offset:32768
    v_mfma_f32_16x16x32_bf16 v[116:119], a[212:215], v[148:151], v[116:119]
    ds_read_b64_tr_b16 a[178:179], v27 offset:36864
    v_mfma_f32_16x16x32_bf16 v[116:119], a[216:219], v[196:199], v[116:119]
    ds_read_b64_tr_b16 a[180:181], v27 offset:40960
    v_mfma_f32_16x16x32_bf16 v[116:119], a[220:223], v[180:183], v[116:119]
    ds_read_b64_tr_b16 a[182:183], v27 offset:45056
    v_mfma_f32_16x16x32_bf16 v[116:119], a[224:227], v[140:143], v[116:119]
    buffer_load_dwordx2 v[80:81], v3, s[20:23], 0 offen offset:512
    v_mfma_f32_16x16x32_bf16 v[116:119], a[228:231], v[156:159], v[116:119]
    ds_read_b64_tr_b16 a[184:185], v27 offset:49152
    ds_read_b64_tr_b16 a[186:187], v27 offset:53248
    v_mfma_f32_16x16x32_bf16 v[116:119], a[232:235], v[204:207], v[116:119]
    ds_read_b64_tr_b16 a[188:189], v27 offset:57344
    v_mfma_f32_16x16x32_bf16 v[116:119], a[236:239], v[188:191], v[116:119]
    ds_read_b64_tr_b16 a[190:191], v27 offset:61440
    s_waitcnt vmcnt(18)
    s_waitcnt lgkmcnt(0)
    s_barrier
    v_mfma_f32_16x16x32_bf16 v[120:123], a[160:163], v[128:131], 0
    ds_read_b64_tr_b16 a[208:209], v12 offset:0
    v_mfma_f32_16x16x32_bf16 v[120:123], a[164:167], v[144:147], v[120:123]
    ds_read_b64_tr_b16 a[210:211], v12 offset:4096
    v_mfma_f32_16x16x32_bf16 v[120:123], a[168:171], v[192:195], v[120:123]
    buffer_load_dwordx2 v[82:83], v3, s[20:23], 0 offen offset:544
    v_mfma_f32_16x16x32_bf16 v[120:123], a[172:175], v[176:179], v[120:123]
    s_add_u32 s39, s39, 16
    ds_read_b64_tr_b16 a[212:213], v12 offset:8192
    ds_read_b64_tr_b16 a[214:215], v12 offset:12288
    v_mfma_f32_16x16x32_bf16 v[120:123], a[176:179], v[136:139], v[120:123]
    buffer_load_dword v11, v9, s[24:27], s39 offen sc1
    v_mfma_f32_16x16x32_bf16 v[120:123], a[180:183], v[152:155], v[120:123]
    ds_read_b64_tr_b16 a[216:217], v12 offset:16384
    ds_read_b64_tr_b16 a[218:219], v12 offset:20480
    v_mfma_f32_16x16x32_bf16 v[120:123], a[184:187], v[200:203], v[120:123]
    ds_read_b64_tr_b16 a[220:221], v12 offset:24576
    v_mfma_f32_16x16x32_bf16 v[120:123], a[188:191], v[184:187], v[120:123]
    ds_read_b64_tr_b16 a[222:223], v12 offset:28672
    v_mfma_f32_16x16x32_bf16 v[124:127], a[160:163], v[132:135], 0
    buffer_load_dwordx2 v[84:85], v55, s[20:23], 0 offen offset:1024
    v_mfma_f32_16x16x32_bf16 v[124:127], a[164:167], v[148:151], v[124:127]
    ds_read_b64_tr_b16 a[224:225], v16 offset:0
    ds_read_b64_tr_b16 a[226:227], v16 offset:4096
    v_mfma_f32_16x16x32_bf16 v[124:127], a[168:171], v[196:199], v[124:127]
    ds_read_b64_tr_b16 a[228:229], v16 offset:8192
    v_mfma_f32_16x16x32_bf16 v[124:127], a[172:175], v[180:183], v[124:127]
    ds_read_b64_tr_b16 a[230:231], v16 offset:12288
    v_mfma_f32_16x16x32_bf16 v[124:127], a[176:179], v[140:143], v[124:127]
    ds_read_b64_tr_b16 a[232:233], v16 offset:16384
    v_mfma_f32_16x16x32_bf16 v[124:127], a[180:183], v[156:159], v[124:127]
    ds_read_b64_tr_b16 a[234:235], v16 offset:20480
    v_mfma_f32_16x16x32_bf16 v[124:127], a[184:187], v[204:207], v[124:127]
    buffer_load_dwordx2 v[86:87], v55, s[20:23], 0 offen offset:1056
    v_mfma_f32_16x16x32_bf16 v[124:127], a[188:191], v[188:191], v[124:127]
    s_waitcnt lgkmcnt(12)
    ds_read_b64_tr_b16 a[236:237], v16 offset:24576
    ds_read_b64_tr_b16 a[238:239], v16 offset:28672
    v_mfma_f32_16x16x32_bf16 v[96:99], a[208:211], a[64:67], v[96:99]
    s_waitcnt lgkmcnt(12)
    ds_read_b64_tr_b16 a[160:161], v13 offset:0
    v_mfma_f32_16x16x32_bf16 v[96:99], a[212:215], a[68:71], v[96:99]
    s_waitcnt lgkmcnt(11)
    ds_read_b64_tr_b16 a[162:163], v13 offset:4096
    v_mfma_f32_16x16x32_bf16 v[96:99], a[216:219], a[72:75], v[96:99]
    s_waitcnt lgkmcnt(10)
    ds_read_b64_tr_b16 a[164:165], v13 offset:8192
    v_mfma_f32_16x16x32_bf16 v[96:99], a[220:223], a[76:79], v[96:99]
    s_waitcnt lgkmcnt(9)
    s_mov_b32 s45, 22144
    ds_read_b64_tr_b16 a[166:167], v13 offset:12288
    v_mfma_f32_16x16x32_bf16 v[96:99], a[224:227], a[80:83], v[96:99]
    s_waitcnt lgkmcnt(8)
    buffer_load_dwordx4 v[216:219], v5, s[24:27], s45 offen offset:0 sc1
    v_mfma_f32_16x16x32_bf16 v[96:99], a[228:231], a[84:87], v[96:99]
    s_waitcnt lgkmcnt(6)
    ds_read_b64_tr_b16 a[168:169], v13 offset:16384
    ds_read_b64_tr_b16 a[170:171], v13 offset:20480
    v_mfma_f32_16x16x32_bf16 v[96:99], a[232:235], a[88:91], v[96:99]
    s_waitcnt lgkmcnt(6)
    ds_read_b64_tr_b16 a[172:173], v13 offset:24576
    v_mfma_f32_16x16x32_bf16 v[96:99], a[236:239], a[92:95], v[96:99]
    ds_read_b64_tr_b16 a[174:175], v13 offset:28672
    v_mfma_f32_16x16x32_bf16 v[100:103], a[208:211], a[96:99], v[100:103]
    buffer_load_dwordx4 v[220:223], v5, s[24:27], s45 offen offset:512 sc1
    v_mfma_f32_16x16x32_bf16 v[100:103], a[212:215], a[100:103], v[100:103]
    ds_read_b64_tr_b16 a[176:177], v17 offset:0
    ds_read_b64_tr_b16 a[178:179], v17 offset:4096
    v_mfma_f32_16x16x32_bf16 v[100:103], a[216:219], a[104:107], v[100:103]
    ds_read_b64_tr_b16 a[180:181], v17 offset:8192
    v_mfma_f32_16x16x32_bf16 v[100:103], a[220:223], a[108:111], v[100:103]
    ds_read_b64_tr_b16 a[182:183], v17 offset:12288
    v_mfma_f32_16x16x32_bf16 v[100:103], a[224:227], a[112:115], v[100:103]
    ds_read_b64_tr_b16 a[184:185], v17 offset:16384
    v_cvt_pk_bf16_f32 v224, v96, v97
    v_mfma_f32_16x16x32_bf16 v[100:103], a[228:231], a[116:119], v[100:103]
    ds_read_b64_tr_b16 a[186:187], v17 offset:20480
    v_cvt_pk_bf16_f32 v225, v98, v99
    v_mfma_f32_16x16x32_bf16 v[100:103], a[232:235], a[120:123], v[100:103]
    ds_read_b64_tr_b16 a[188:189], v17 offset:24576
    v_mfma_f32_16x16x32_bf16 v[100:103], a[236:239], a[124:127], v[100:103]
    s_waitcnt lgkmcnt(13)
    ds_read_b64_tr_b16 a[190:191], v17 offset:28672
    v_mfma_f32_16x16x32_bf16 v[104:107], a[160:163], a[64:67], v[104:107]
    s_waitcnt lgkmcnt(12)
    buffer_load_dwordx4 v[88:91], v59, s[24:27], s45 offen offset:1024 sc1
    v_mfma_f32_16x16x32_bf16 v[104:107], a[164:167], a[68:71], v[104:107]
    s_waitcnt lgkmcnt(10)
    ds_read_b64_tr_b16 a[208:209], v14 offset:0
    ds_read_b64_tr_b16 a[210:211], v14 offset:4096
    v_mfma_f32_16x16x32_bf16 v[104:107], a[168:171], a[72:75], v[104:107]
    s_waitcnt lgkmcnt(10)
    ds_read_b64_tr_b16 a[212:213], v14 offset:8192
    v_mfma_f32_16x16x32_bf16 v[104:107], a[172:175], a[76:79], v[104:107]
    s_waitcnt lgkmcnt(9)
    ds_read_b64_tr_b16 a[214:215], v14 offset:12288
    v_mfma_f32_16x16x32_bf16 v[104:107], a[176:179], a[80:83], v[104:107]
    s_waitcnt lgkmcnt(8)
    ds_read_b64_tr_b16 a[216:217], v14 offset:16384
    v_cvt_pk_bf16_f32 v228, v100, v101
    v_mfma_f32_16x16x32_bf16 v[104:107], a[180:183], a[84:87], v[104:107]
    s_waitcnt lgkmcnt(7)
    ds_read_b64_tr_b16 a[218:219], v14 offset:20480
    v_cvt_pk_bf16_f32 v229, v102, v103
    v_mfma_f32_16x16x32_bf16 v[104:107], a[184:187], a[88:91], v[104:107]
    s_waitcnt lgkmcnt(6)
    ds_read_b64_tr_b16 a[220:221], v14 offset:24576
    v_mfma_f32_16x16x32_bf16 v[104:107], a[188:191], a[92:95], v[104:107]
    ds_read_b64_tr_b16 a[222:223], v14 offset:28672
    v_mfma_f32_16x16x32_bf16 v[108:111], a[160:163], a[96:99], v[108:111]
    ds_read_b64_tr_b16 a[224:225], v18 offset:0
    v_mfma_f32_16x16x32_bf16 v[108:111], a[164:167], a[100:103], v[108:111]
    ds_read_b64_tr_b16 a[226:227], v18 offset:4096
    v_mfma_f32_16x16x32_bf16 v[108:111], a[168:171], a[104:107], v[108:111]
    ds_read_b64_tr_b16 a[228:229], v18 offset:8192
    v_mfma_f32_16x16x32_bf16 v[108:111], a[172:175], a[108:111], v[108:111]
    ds_read_b64_tr_b16 a[230:231], v18 offset:12288
    v_mfma_f32_16x16x32_bf16 v[108:111], a[176:179], a[112:115], v[108:111]
Ltour11:
    s_cbranch_execz Ltour15
    ds_read_b64_tr_b16 a[232:233], v18 offset:16384
    v_cvt_pk_bf16_f32 v226, v104, v105
    v_mfma_f32_16x16x32_bf16 v[108:111], a[180:183], a[116:119], v[108:111]
    s_add_u32 s38, s93, 1536
    ds_read_b64_tr_b16 a[234:235], v18 offset:20480
    v_cvt_pk_bf16_f32 v227, v106, v107
    v_mfma_f32_16x16x32_bf16 v[108:111], a[184:187], a[120:123], v[108:111]
    buffer_store_dwordx4 v[224:227], v56, s[28:31], s38 offen sc1
    v_mfma_f32_16x16x32_bf16 v[108:111], a[188:191], a[124:127], v[108:111]
    s_waitcnt lgkmcnt(12)
    ds_read_b64_tr_b16 a[236:237], v18 offset:24576
    ds_read_b64_tr_b16 a[238:239], v18 offset:28672
    v_mfma_f32_16x16x32_bf16 v[112:115], a[208:211], a[64:67], v[112:115]
    s_waitcnt lgkmcnt(12)
    ds_read_b64_tr_b16 a[160:161], v15 offset:0
    v_mfma_f32_16x16x32_bf16 v[112:115], a[212:215], a[68:71], v[112:115]
    s_waitcnt lgkmcnt(11)
    ds_read_b64_tr_b16 a[162:163], v15 offset:4096
    v_mfma_f32_16x16x32_bf16 v[112:115], a[216:219], a[72:75], v[112:115]
    s_waitcnt lgkmcnt(10)
    ds_read_b64_tr_b16 a[164:165], v15 offset:8192
    v_mfma_f32_16x16x32_bf16 v[112:115], a[220:223], a[76:79], v[112:115]
    s_waitcnt lgkmcnt(9)
    ds_read_b64_tr_b16 a[166:167], v15 offset:12288
    v_mfma_f32_16x16x32_bf16 v[112:115], a[224:227], a[80:83], v[112:115]
    s_waitcnt lgkmcnt(8)
    ds_read_b64_tr_b16 a[168:169], v15 offset:16384
    v_cvt_pk_bf16_f32 v230, v108, v109
    v_mfma_f32_16x16x32_bf16 v[112:115], a[228:231], a[84:87], v[112:115]
    s_waitcnt lgkmcnt(7)
    s_add_u32 s38, s93, 165376
    ds_read_b64_tr_b16 a[170:171], v15 offset:20480
    v_cvt_pk_bf16_f32 v231, v110, v111
    v_mfma_f32_16x16x32_bf16 v[112:115], a[232:235], a[88:91], v[112:115]
    s_waitcnt lgkmcnt(6)
    buffer_store_dwordx4 v[228:231], v56, s[28:31], s38 offen sc1
    v_mfma_f32_16x16x32_bf16 v[112:115], a[236:239], a[92:95], v[112:115]
    ds_read_b64_tr_b16 a[172:173], v15 offset:24576
    ds_read_b64_tr_b16 a[174:175], v15 offset:28672
    v_mfma_f32_16x16x32_bf16 v[116:119], a[208:211], a[96:99], v[116:119]
    ds_read_b64_tr_b16 a[176:177], v19 offset:0
    v_mfma_f32_16x16x32_bf16 v[116:119], a[212:215], a[100:103], v[116:119]
    ds_read_b64_tr_b16 a[178:179], v19 offset:4096
    v_mfma_f32_16x16x32_bf16 v[116:119], a[216:219], a[104:107], v[116:119]
    ds_read_b64_tr_b16 a[180:181], v19 offset:8192
    v_mfma_f32_16x16x32_bf16 v[116:119], a[220:223], a[108:111], v[116:119]
    ds_read_b64_tr_b16 a[182:183], v19 offset:12288
    v_mfma_f32_16x16x32_bf16 v[116:119], a[224:227], a[112:115], v[116:119]
    ds_read_b64_tr_b16 a[184:185], v19 offset:16384
    v_cvt_pk_bf16_f32 v232, v112, v113
    v_mfma_f32_16x16x32_bf16 v[116:119], a[228:231], a[116:119], v[116:119]
    ds_read_b64_tr_b16 a[186:187], v19 offset:20480
    v_cvt_pk_bf16_f32 v233, v114, v115
    v_mfma_f32_16x16x32_bf16 v[116:119], a[232:235], a[120:123], v[116:119]
    ds_read_b64_tr_b16 a[188:189], v19 offset:24576
    v_mfma_f32_16x16x32_bf16 v[116:119], a[236:239], a[124:127], v[116:119]
    s_waitcnt lgkmcnt(13)
    ds_read_b64_tr_b16 a[190:191], v19 offset:28672
    v_mfma_f32_16x16x32_bf16 v[120:123], a[160:163], a[64:67], v[120:123]
    s_waitcnt lgkmcnt(12)
    v_mfma_f32_16x16x32_bf16 v[120:123], a[164:167], a[68:71], v[120:123]
    s_waitcnt lgkmcnt(10)
    v_mfma_f32_16x16x32_bf16 v[120:123], a[168:171], a[72:75], v[120:123]
    s_waitcnt lgkmcnt(8)
    v_mfma_f32_16x16x32_bf16 v[120:123], a[172:175], a[76:79], v[120:123]
    s_waitcnt lgkmcnt(6)
    v_mfma_f32_16x16x32_bf16 v[120:123], a[176:179], a[80:83], v[120:123]
    s_waitcnt lgkmcnt(4)
    v_cvt_pk_bf16_f32 v236, v116, v117
    v_mfma_f32_16x16x32_bf16 v[120:123], a[180:183], a[84:87], v[120:123]
    s_waitcnt lgkmcnt(2)
    v_cvt_pk_bf16_f32 v237, v118, v119
    v_mfma_f32_16x16x32_bf16 v[120:123], a[184:187], a[88:91], v[120:123]
    s_waitcnt lgkmcnt(0)
    v_mfma_f32_16x16x32_bf16 v[120:123], a[188:191], a[92:95], v[120:123]
    v_mfma_f32_16x16x32_bf16 v[124:127], a[160:163], a[96:99], v[124:127]
    v_mfma_f32_16x16x32_bf16 v[124:127], a[164:167], a[100:103], v[124:127]
    v_mfma_f32_16x16x32_bf16 v[124:127], a[168:171], a[104:107], v[124:127]
    v_mfma_f32_16x16x32_bf16 v[124:127], a[172:175], a[108:111], v[124:127]
    v_mfma_f32_16x16x32_bf16 v[124:127], a[176:179], a[112:115], v[124:127]
    s_nop 2
    v_cvt_pk_bf16_f32 v234, v120, v121
    v_mfma_f32_16x16x32_bf16 v[124:127], a[180:183], a[116:119], v[124:127]
    s_add_u32 s38, s93, 1664
    v_cvt_pk_bf16_f32 v235, v122, v123
    v_mfma_f32_16x16x32_bf16 v[124:127], a[184:187], a[120:123], v[124:127]
    buffer_store_dwordx4 v[232:235], v56, s[28:31], s38 offen sc1
    v_mfma_f32_16x16x32_bf16 v[124:127], a[188:191], a[124:127], v[124:127]
    s_nop 7
    v_cvt_pk_bf16_f32 v238, v124, v125
    s_add_u32 s38, s93, 165504
    v_cvt_pk_bf16_f32 v239, v126, v127
    buffer_store_dwordx4 v[236:239], v56, s[28:31], s38 offen sc1
    s_waitcnt vmcnt(27)
    v_lshlrev_b32 v96, 16, v160
    v_and_b32 v97, 0xffff0000, v160
    v_lshlrev_b32 v98, 16, v161
    v_and_b32 v99, 0xffff0000, v161
    v_lshlrev_b32 v100, 16, v162
    v_and_b32 v101, 0xffff0000, v162
    v_lshlrev_b32 v102, 16, v163
    v_and_b32 v103, 0xffff0000, v163
    s_waitcnt vmcnt(25)
    v_lshlrev_b32 v104, 16, v164
    v_and_b32 v105, 0xffff0000, v164
    v_lshlrev_b32 v106, 16, v165
    v_and_b32 v107, 0xffff0000, v165
    v_lshlrev_b32 v108, 16, v166
    v_and_b32 v109, 0xffff0000, v166
    v_lshlrev_b32 v110, 16, v167
    v_and_b32 v111, 0xffff0000, v167
    s_waitcnt vmcnt(24)
    v_lshlrev_b32 v112, 16, v168
    v_and_b32 v113, 0xffff0000, v168
    v_lshlrev_b32 v114, 16, v169
    v_and_b32 v115, 0xffff0000, v169
    v_lshlrev_b32 v116, 16, v170
    v_and_b32 v117, 0xffff0000, v170
    v_lshlrev_b32 v118, 16, v171
    v_and_b32 v119, 0xffff0000, v171
    s_waitcnt vmcnt(23)
    v_lshlrev_b32 v120, 16, v172
    v_and_b32 v121, 0xffff0000, v172
    v_lshlrev_b32 v122, 16, v173
    v_and_b32 v123, 0xffff0000, v173
    v_lshlrev_b32 v124, 16, v174
    v_and_b32 v125, 0xffff0000, v174
    v_lshlrev_b32 v126, 16, v175
    v_and_b32 v127, 0xffff0000, v175
    s_waitcnt vmcnt(22)
    v_lshlrev_b32 v128, 16, v208
    v_and_b32 v129, 0xffff0000, v208
    v_lshlrev_b32 v130, 16, v209
    v_and_b32 v131, 0xffff0000, v209
    v_lshlrev_b32 v132, 16, v210
    v_and_b32 v133, 0xffff0000, v210
    v_lshlrev_b32 v134, 16, v211
    v_and_b32 v135, 0xffff0000, v211
    s_waitcnt vmcnt(20)
    v_lshlrev_b32 v136, 16, v212
    v_and_b32 v137, 0xffff0000, v212
    v_lshlrev_b32 v138, 16, v213
    v_and_b32 v139, 0xffff0000, v213
    v_lshlrev_b32 v140, 16, v214
    v_and_b32 v141, 0xffff0000, v214
    v_lshlrev_b32 v142, 16, v215
    v_and_b32 v143, 0xffff0000, v215
    s_waitcnt vmcnt(16)
    v_lshlrev_b32 v144, 16, v64
    v_and_b32 v145, 0xffff0000, v64
    v_lshlrev_b32 v146, 16, v65
    v_and_b32 v147, 0xffff0000, v65
    v_lshlrev_b32 v148, 16, v66
    v_and_b32 v149, 0xffff0000, v66
    v_lshlrev_b32 v150, 16, v67
    v_and_b32 v151, 0xffff0000, v67
    s_waitcnt vmcnt(15)
    v_lshlrev_b32 v152, 16, v68
    v_and_b32 v153, 0xffff0000, v68
    v_lshlrev_b32 v154, 16, v69
    v_and_b32 v155, 0xffff0000, v69
    v_lshlrev_b32 v156, 16, v70
    v_and_b32 v157, 0xffff0000, v70
    v_lshlrev_b32 v158, 16, v71
    v_and_b32 v159, 0xffff0000, v71
    s_waitcnt vmcnt(14)
    v_lshlrev_b32 v160, 16, v72
    v_and_b32 v161, 0xffff0000, v72
    v_lshlrev_b32 v162, 16, v73
    v_and_b32 v163, 0xffff0000, v73
    v_lshlrev_b32 v164, 16, v74
    v_and_b32 v165, 0xffff0000, v74
    v_lshlrev_b32 v166, 16, v75
    v_and_b32 v167, 0xffff0000, v75
    s_waitcnt vmcnt(13)
    v_lshlrev_b32 v168, 16, v76
    v_and_b32 v169, 0xffff0000, v76
    v_lshlrev_b32 v170, 16, v77
    v_and_b32 v171, 0xffff0000, v77
    s_waitcnt vmcnt(12)
    v_lshlrev_b32 v172, 16, v78
    v_and_b32 v173, 0xffff0000, v78
    v_lshlrev_b32 v174, 16, v79
    v_and_b32 v175, 0xffff0000, v79
    s_waitcnt vmcnt(11)
    v_lshlrev_b32 v176, 16, v80
    v_and_b32 v177, 0xffff0000, v80
    v_lshlrev_b32 v178, 16, v81
    v_and_b32 v179, 0xffff0000, v81
    s_waitcnt vmcnt(10)
    v_lshlrev_b32 v180, 16, v82
    v_and_b32 v181, 0xffff0000, v82
    v_lshlrev_b32 v182, 16, v83
    v_and_b32 v183, 0xffff0000, v83
    s_waitcnt vmcnt(8)
    v_lshlrev_b32 v184, 16, v84
    v_and_b32 v185, 0xffff0000, v84
    v_lshlrev_b32 v186, 16, v85
    v_and_b32 v187, 0xffff0000, v85
    s_waitcnt vmcnt(7)
    v_lshlrev_b32 v188, 16, v86
    v_and_b32 v189, 0xffff0000, v86
    v_lshlrev_b32 v190, 16, v87
    v_and_b32 v191, 0xffff0000, v87
    s_waitcnt vmcnt(0)
    s_add_u32 s92, s92, 16
    buffer_store_dword v10, v8, s[24:27], s92 offen sc1
    v_cmp_ne_u32 s[54:55], s95, v11
    s_cmp_lg_u64 s[54:55], 0
    s_cbranch_scc1 Ltail_spin1
Ltail_got1:
    s_add_u32 s56, s44, 16384
    buffer_load_dwordx4 a[0:3], v54, s[28:31], s56 offen offset:0 sc1
    buffer_load_dwordx4 a[4:7], v54, s[28:31], s56 offen offset:1024 sc1
    buffer_load_dwordx4 a[8:11], v54, s[28:31], s56 offen offset:2048 sc1
    buffer_load_dwordx4 a[12:15], v54, s[28:31], s56 offen offset:3072 sc1
    s_add_u32 s56, s44, 0
    buffer_load_dwordx4 a[16:19], v2, s[28:31], s56 offen offset:0 sc1
    s_add_u32 s56, s44, 4096
    buffer_load_dwordx4 a[20:23], v2, s[28:31], s56 offen offset:0 sc1
    s_add_u32 s56, s44, 8192
    buffer_load_dwordx4 a[24:27], v2, s[28:31], s56 offen offset:0 sc1
    s_add_u32 s56, s44, 12288
    buffer_load_dwordx4 a[28:31], v2, s[28:31], s56 offen offset:0 sc1
    ds_write_b128 v51, a[128:131] offset:0
    ds_write_b128 v51, a[132:135] offset:4096
    ds_write_b128 v51, a[136:139] offset:8192
    ds_write_b128 v51, a[140:143] offset:12288
    ds_write_b128 v51, a[144:147] offset:16384
    ds_write_b128 v51, a[148:151] offset:20480
    ds_write_b128 v51, a[152:155] offset:24576
    ds_write_b128 v51, a[156:159] offset:28672
    ds_write_b128 v51, a[240:243] offset:32768
    ds_write_b128 v255, a[244:247] offset:40960
    ds_write_b128 v255, a[248:251] offset:45056
    ds_write_b128 v255, a[252:255] offset:49152
    v_lshlrev_b32 v12, 16, v36
    v_and_b32 v13, 0xffff0000, v36
    v_lshlrev_b32 v14, 16, v37
    v_and_b32 v15, 0xffff0000, v37
    v_lshlrev_b32 v16, 16, v38
    v_and_b32 v17, 0xffff0000, v38
    v_lshlrev_b32 v18, 16, v39
    v_and_b32 v19, 0xffff0000, v39
    v_lshlrev_b32 v20, 16, v40
    v_and_b32 v21, 0xffff0000, v40
    v_lshlrev_b32 v22, 16, v41
    v_and_b32 v23, 0xffff0000, v41
    v_lshlrev_b32 v24, 16, v42
    v_and_b32 v25, 0xffff0000, v42
    v_lshlrev_b32 v26, 16, v43
    v_and_b32 v27, 0xffff0000, v43
    v_lshlrev_b32 v28, 16, v92
    v_and_b32 v29, 0xffff0000, v92
    v_lshlrev_b32 v30, 16, v93
    v_and_b32 v31, 0xffff0000, v93
    v_lshlrev_b32 v32, 16, v94
    v_and_b32 v33, 0xffff0000, v94
    v_lshlrev_b32 v34, 16, v95
    v_and_b32 v35, 0xffff0000, v95
    v_lshlrev_b32 v192, 16, v216
    v_and_b32 v193, 0xffff0000, v216
    v_lshlrev_b32 v194, 16, v217
    v_and_b32 v195, 0xffff0000, v217
    v_lshlrev_b32 v196, 16, v218
    v_and_b32 v197, 0xffff0000, v218
    v_lshlrev_b32 v198, 16, v219
    v_and_b32 v199, 0xffff0000, v219
    v_lshlrev_b32 v200, 16, v220
    v_and_b32 v201, 0xffff0000, v220
    v_lshlrev_b32 v202, 16, v221
    v_and_b32 v203, 0xffff0000, v221
    v_lshlrev_b32 v204, 16, v222
    v_and_b32 v205, 0xffff0000, v222
    v_lshlrev_b32 v206, 16, v223
    v_and_b32 v207, 0xffff0000, v223
    v_lshlrev_b32 v208, 16, v88
    v_and_b32 v209, 0xffff0000, v88
    v_lshlrev_b32 v210, 16, v89
    v_and_b32 v211, 0xffff0000, v89
    v_lshlrev_b32 v212, 16, v90
    v_and_b32 v213, 0xffff0000, v90
    v_lshlrev_b32 v214, 16, v91
    v_and_b32 v215, 0xffff0000, v91
    s_add_u32 s39, s39, 16
    buffer_load_dword v11, v9, s[24:27], s39 offen sc1
    s_add_u32 s56, s44, 0
    buffer_load_dwordx4 a[32:35], v2, s[28:31], s56 offen offset:512 sc1
    s_add_u32 s56, s44, 4096
    buffer_load_dwordx4 a[36:39], v2, s[28:31], s56 offen offset:512 sc1
    s_add_u32 s56, s44, 8192
    buffer_load_dwordx4 a[40:43], v2, s[28:31], s56 offen offset:512 sc1
    s_add_u32 s56, s44, 12288
    buffer_load_dwordx4 a[44:47], v2, s[28:31], s56 offen offset:512 sc1
    s_waitcnt vmcnt(4)
    v_cmp_ne_u32 s[54:55], s95, v11
    s_cmp_lg_u64 s[54:55], 0
    s_cbranch_scc1 Ltail_spin2
Ltail_got2:
    s_add_u32 s56, s44, 0
    buffer_load_dwordx4 a[48:51], v2, s[28:31], s56 offen offset:1024 sc1
    s_add_u32 s56, s44, 4096
    buffer_load_dwordx4 a[52:55], v2, s[28:31], s56 offen offset:1024 sc1
    s_add_u32 s56, s44, 8192
    buffer_load_dwordx4 a[56:59], v2, s[28:31], s56 offen offset:1024 sc1
    s_add_u32 s56, s44, 12288
    buffer_load_dwordx4 a[60:63], v2, s[28:31], s56 offen offset:1024 sc1
    s_add_u32 s56, s44, 0
    buffer_load_dwordx4 a[64:67], v2, s[28:31], s56 offen offset:1536 sc1
    s_add_u32 s56, s44, 4096
    buffer_load_dwordx4 a[68:71], v2, s[28:31], s56 offen offset:1536 sc1
    s_add_u32 s56, s44, 8192
    buffer_load_dwordx4 a[72:75], v2, s[28:31], s56 offen offset:1536 sc1
    s_add_u32 s56, s44, 12288
    buffer_load_dwordx4 a[76:79], v2, s[28:31], s56 offen offset:1536 sc1
    v_mfma_f32_16x16x32_bf16 v[80:83], v[242:245], a[0:3], 0
    v_mfma_f32_16x16x32_bf16 v[84:87], v[240:243], a[0:3], 0
    v_mfma_f32_16x16x32_bf16 v[80:83], v[242:245], a[4:7], v[80:83]
    v_mfma_f32_16x16x32_bf16 v[84:87], v[240:243], a[4:7], v[84:87]
    v_mfma_f32_16x16x32_bf16 v[80:83], v[242:245], a[8:11], v[80:83]
    v_mfma_f32_16x16x32_bf16 v[84:87], v[240:243], a[8:11], v[84:87]
    v_mfma_f32_16x16x32_bf16 v[80:83], v[242:245], a[12:15], v[80:83]
    v_mfma_f32_16x16x32_bf16 v[84:87], v[240:243], a[12:15], v[84:87]
    s_nop 6
    v_mov_b32_dpp v80, v80 row_ror:8 row_mask:0x4 bank_mask:0xf
    v_mov_b32_dpp v81, v81 row_ror:8 row_mask:0x4 bank_mask:0xf
    v_mov_b32_dpp v82, v82 row_ror:8 row_mask:0x4 bank_mask:0xf
    v_mov_b32_dpp v83, v83 row_ror:8 row_mask:0x4 bank_mask:0xf
    v_mov_b32_dpp v84, v84 row_ror:8 row_mask:0x4 bank_mask:0xf
    v_mov_b32_dpp v85, v85 row_ror:8 row_mask:0x4 bank_mask:0xf
    v_mov_b32_dpp v86, v86 row_ror:8 row_mask:0x4 bank_mask:0xf
    v_mov_b32_dpp v87, v87 row_ror:8 row_mask:0x4 bank_mask:0xf
    v_pk_fma_f32 v[28:29], v[112:113], v[80:81], v[28:29]
    v_pk_fma_f32 v[30:31], v[114:115], v[82:83], v[30:31]
    v_pk_fma_f32 v[32:33], v[116:117], v[84:85], v[32:33]
    v_pk_fma_f32 v[34:35], v[118:119], v[86:87], v[34:35]
    v_cvt_pk_bf16_f32 v44, v28, v29
    v_cvt_pk_bf16_f32 v45, v30, v31
    v_cvt_pk_bf16_f32 v46, v32, v33
    v_cvt_pk_bf16_f32 v47, v34, v35
    v_lshlrev_b32 v28, 16, v44
    v_and_b32 v29, 0xffff0000, v44
    v_lshlrev_b32 v30, 16, v45
    v_and_b32 v31, 0xffff0000, v45
    v_lshlrev_b32 v32, 16, v46
    v_and_b32 v33, 0xffff0000, v46
    v_lshlrev_b32 v34, 16, v47
    v_and_b32 v35, 0xffff0000, v47
    v_pk_add_f32 v[48:49], v[28:29], v[30:31]
    v_pk_add_f32 v[50:51], v[32:33], v[34:35]
    v_mfma_f32_16x16x32_bf16 v[64:67], v[246:249], a[16:19], 0
    v_mfma_f32_16x16x32_bf16 v[68:71], v[244:247], a[16:19], 0
    v_mfma_f32_16x16x32_bf16 v[64:67], v[246:249], a[20:23], v[64:67]
    v_mfma_f32_16x16x32_bf16 v[68:71], v[244:247], a[20:23], v[68:71]
    v_mfma_f32_16x16x32_bf16 v[64:67], v[246:249], a[24:27], v[64:67]
    v_mfma_f32_16x16x32_bf16 v[68:71], v[244:247], a[24:27], v[68:71]
    v_mfma_f32_16x16x32_bf16 v[64:67], v[246:249], a[28:31], v[64:67]
    v_mfma_f32_16x16x32_bf16 v[68:71], v[244:247], a[28:31], v[68:71]
    s_waitcnt vmcnt(11)
    v_mfma_f32_16x16x32_bf16 v[64:67], v[250:253], a[32:35], v[64:67]
    v_mfma_f32_16x16x32_bf16 v[68:71], v[248:251], a[32:35], v[68:71]
    s_waitcnt vmcnt(10)
    v_mfma_f32_16x16x32_bf16 v[64:67], v[250:253], a[36:39], v[64:67]
    v_mfma_f32_16x16x32_bf16 v[68:71], v[248:251], a[36:39], v[68:71]
    s_waitcnt vmcnt(9)
    v_mfma_f32_16x16x32_bf16 v[64:67], v[250:253], a[40:43], v[64:67]
    v_mfma_f32_16x16x32_bf16 v[68:71], v[248:251], a[40:43], v[68:71]
    s_waitcnt vmcnt(8)
    v_mfma_f32_16x16x32_bf16 v[64:67], v[250:253], a[44:47], v[64:67]
    v_mfma_f32_16x16x32_bf16 v[68:71], v[248:251], a[44:47], v[68:71]
    s_waitcnt vmcnt(7)
    s_nop 5
    v_pk_fma_f32 v[12:13], v[96:97], v[64:65], v[12:13]
    v_pk_fma_f32 v[14:15], v[98:99], v[66:67], v[14:15]
    v_pk_fma_f32 v[16:17], v[100:101], v[68:69], v[16:17]
    v_pk_fma_f32 v[18:19], v[102:103], v[70:71], v[18:19]
    v_cvt_pk_bf16_f32 v36, v12, v13
    v_cvt_pk_bf16_f32 v37, v14, v15
    v_cvt_pk_bf16_f32 v38, v16, v17
    v_cvt_pk_bf16_f32 v39, v18, v19
    v_lshlrev_b32 v12, 16, v36
    v_and_b32 v13, 0xffff0000, v36
    v_lshlrev_b32 v14, 16, v37
    v_and_b32 v15, 0xffff0000, v37
    v_lshlrev_b32 v16, 16, v38
    v_and_b32 v17, 0xffff0000, v38
    v_lshlrev_b32 v18, 16, v39
    v_and_b32 v19, 0xffff0000, v39
    v_pk_add_f32 v[48:49], v[48:49], v[12:13]
    v_pk_add_f32 v[50:51], v[50:51], v[14:15]
    v_pk_add_f32 v[48:49], v[48:49], v[16:17]
    v_pk_add_f32 v[50:51], v[50:51], v[18:19]
    v_mfma_f32_16x16x32_bf16 v[72:75], v[246:249], a[48:51], 0
    v_mfma_f32_16x16x32_bf16 v[76:79], v[244:247], a[48:51], 0
    s_waitcnt vmcnt(6)
    v_mfma_f32_16x16x32_bf16 v[72:75], v[246:249], a[52:55], v[72:75]
    v_mfma_f32_16x16x32_bf16 v[76:79], v[244:247], a[52:55], v[76:79]
    s_waitcnt vmcnt(5)
    v_mfma_f32_16x16x32_bf16 v[72:75], v[246:249], a[56:59], v[72:75]
    v_mfma_f32_16x16x32_bf16 v[76:79], v[244:247], a[56:59], v[76:79]
    s_waitcnt vmcnt(4)
    v_mfma_f32_16x16x32_bf16 v[72:75], v[246:249], a[60:63], v[72:75]
    v_mfma_f32_16x16x32_bf16 v[76:79], v[244:247], a[60:63], v[76:79]
    s_waitcnt vmcnt(3)
    v_mfma_f32_16x16x32_bf16 v[72:75], v[250:253], a[64:67], v[72:75]
    v_mfma_f32_16x16x32_bf16 v[76:79], v[248:251], a[64:67], v[76:79]
    s_waitcnt vmcnt(2)
    v_mfma_f32_16x16x32_bf16 v[72:75], v[250:253], a[68:71], v[72:75]
    v_mfma_f32_16x16x32_bf16 v[76:79], v[248:251], a[68:71], v[76:79]
    s_waitcnt vmcnt(1)
    v_mfma_f32_16x16x32_bf16 v[72:75], v[250:253], a[72:75], v[72:75]
    v_mfma_f32_16x16x32_bf16 v[76:79], v[248:251], a[72:75], v[76:79]
    s_waitcnt vmcnt(0)
    v_mfma_f32_16x16x32_bf16 v[72:75], v[250:253], a[76:79], v[72:75]
    v_mfma_f32_16x16x32_bf16 v[76:79], v[248:251], a[76:79], v[76:79]
    s_nop 6
    v_pk_fma_f32 v[20:21], v[104:105], v[72:73], v[20:21]
    v_pk_fma_f32 v[22:23], v[106:107], v[74:75], v[22:23]
    v_pk_fma_f32 v[24:25], v[108:109], v[76:77], v[24:25]
    v_pk_fma_f32 v[26:27], v[110:111], v[78:79], v[26:27]
    v_cvt_pk_bf16_f32 v40, v20, v21
    v_cvt_pk_bf16_f32 v41, v22, v23
    v_cvt_pk_bf16_f32 v42, v24, v25
    v_cvt_pk_bf16_f32 v43, v26, v27
    v_lshlrev_b32 v20, 16, v40
    v_and_b32 v21, 0xffff0000, v40
    v_lshlrev_b32 v22, 16, v41
    v_and_b32 v23, 0xffff0000, v41
    v_lshlrev_b32 v24, 16, v42
    v_and_b32 v25, 0xffff0000, v42
    v_lshlrev_b32 v26, 16, v43
    v_and_b32 v27, 0xffff0000, v43
    v_pk_add_f32 v[48:49], v[48:49], v[20:21]
    v_pk_add_f32 v[50:51], v[50:51], v[22:23]
    v_pk_add_f32 v[48:49], v[48:49], v[24:25]
    v_pk_add_f32 v[50:51], v[50:51], v[26:27]
    v_pk_add_f32 v[48:49], v[48:49], v[50:51]
    v_add_f32 v48, v48, v49
    s_nop 1
    v_add_f32_dpp v48, v48, v48 row_ror:1 row_mask:0xf bank_mask:0xf
    s_nop 1
    v_add_f32_dpp v48, v48, v48 row_ror:2 row_mask:0xf bank_mask:0xf
    s_nop 1
    v_add_f32_dpp v48, v48, v48 row_ror:4 row_mask:0xf bank_mask:0xf
    s_nop 1
    v_add_f32_dpp v48, v48, v48 row_ror:8 row_mask:0xf bank_mask:0xf
    v_mov_b32 v52, v48
    s_nop 1
    v_permlane16_swap_b32 v48, v52
    s_nop 0
    v_add_f32 v48, v48, v52
    v_mul_f32 v48, 0x3ae38e39, v48
    v_pk_add_f32 v[216:217], v[12:13], v[48:49] op_sel_hi:[1,0] neg_lo:[0,1] neg_hi:[0,1]
    v_pk_add_f32 v[218:219], v[14:15], v[48:49] op_sel_hi:[1,0] neg_lo:[0,1] neg_hi:[0,1]
    v_pk_add_f32 v[220:221], v[16:17], v[48:49] op_sel_hi:[1,0] neg_lo:[0,1] neg_hi:[0,1]
    v_pk_add_f32 v[222:223], v[18:19], v[48:49] op_sel_hi:[1,0] neg_lo:[0,1] neg_hi:[0,1]
    v_pk_add_f32 v[224:225], v[20:21], v[48:49] op_sel_hi:[1,0] neg_lo:[0,1] neg_hi:[0,1]
    v_pk_add_f32 v[226:227], v[22:23], v[48:49] op_sel_hi:[1,0] neg_lo:[0,1] neg_hi:[0,1]
    v_pk_add_f32 v[228:229], v[24:25], v[48:49] op_sel_hi:[1,0] neg_lo:[0,1] neg_hi:[0,1]
    v_pk_add_f32 v[230:231], v[26:27], v[48:49] op_sel_hi:[1,0] neg_lo:[0,1] neg_hi:[0,1]
    v_pk_add_f32 v[232:233], v[28:29], v[48:49] op_sel_hi:[1,0] neg_lo:[0,1] neg_hi:[0,1]
    v_pk_add_f32 v[234:235], v[30:31], v[48:49] op_sel_hi:[1,0] neg_lo:[0,1] neg_hi:[0,1]
    v_pk_add_f32 v[236:237], v[32:33], v[48:49] op_sel_hi:[1,0] neg_lo:[0,1] neg_hi:[0,1]
    v_pk_add_f32 v[238:239], v[34:35], v[48:49] op_sel_hi:[1,0] neg_lo:[0,1] neg_hi:[0,1]
    v_pk_mul_f32 v[50:51], v[216:217], v[216:217]
    v_pk_mul_f32 v[52:53], v[224:225], v[224:225]
    v_pk_mul_f32 v[62:63], v[232:233], v[232:233]
    v_pk_fma_f32 v[50:51], v[218:219], v[218:219], v[50:51]
    v_pk_fma_f32 v[52:53], v[226:227], v[226:227], v[52:53]
    v_pk_fma_f32 v[62:63], v[234:235], v[234:235], v[62:63]
    v_pk_fma_f32 v[50:51], v[220:221], v[220:221], v[50:51]
    v_pk_fma_f32 v[52:53], v[228:229], v[228:229], v[52:53]
    v_pk_fma_f32 v[62:63], v[236:237], v[236:237], v[62:63]
    v_pk_fma_f32 v[50:51], v[222:223], v[222:223], v[50:51]
    v_pk_fma_f32 v[52:53], v[230:231], v[230:231], v[52:53]
    v_pk_fma_f32 v[62:63], v[238:239], v[238:239], v[62:63]
    v_pk_add_f32 v[50:51], v[50:51], v[52:53]
    v_add_f32 v62, v62, v63
    v_add_f32 v50, v50, v51
    v_cndmask_b32 v62, 0, v62, vcc
    v_add_f32 v50, v50, v62
    s_nop 1
    v_add_f32_dpp v50, v50, v50 row_ror:1 row_mask:0xf bank_mask:0xf
    s_nop 1
    v_add_f32_dpp v50, v50, v50 row_ror:2 row_mask:0xf bank_mask:0xf
    s_nop 1
    v_add_f32_dpp v50, v50, v50 row_ror:4 row_mask:0xf bank_mask:0xf
    s_nop 1
    v_add_f32_dpp v50, v50, v50 row_ror:8 row_mask:0xf bank_mask:0xf
    v_mov_b32 v52, v50
    s_nop 1
    v_permlane16_swap_b32 v50, v52
    s_nop 0
    v_add_f32 v50, v50, v52
    v_mul_f32 v50, 0x3ae38e39, v50
    v_cvt_pk_bf16_f32 v52, v48, v50
    v_and_b32 v50, 0xffff0000, v52
    v_lshlrev_b32 v52, 16, v52
    v_add_f32 v50, 0x3727c5ac, v50
    v_sub_f32 v48, v48, v52
    v_cvt_pk_bf16_f32 v50, v50, v50
    v_and_b32 v50, 0xffff0000, v50
    v_sqrt_f32 v50, v50
    s_nop 0
    v_cvt_pk_bf16_f32 v50, v50, v50
    v_and_b32 v50, 0xffff0000, v50
    v_rcp_f32 v50, v50
    s_mov_b32 s45, 2621440
    v_mul_f32 v48, v48, v50
    v_pk_fma_f32 v[216:217], v[216:217], v[50:51], v[48:49] op_sel_hi:[1,0,0]
    v_pk_fma_f32 v[218:219], v[218:219], v[50:51], v[48:49] op_sel_hi:[1,0,0]
    v_pk_fma_f32 v[220:221], v[220:221], v[50:51], v[48:49] op_sel_hi:[1,0,0]
    v_pk_fma_f32 v[222:223], v[222:223], v[50:51], v[48:49] op_sel_hi:[1,0,0]
    v_pk_fma_f32 v[224:225], v[224:225], v[50:51], v[48:49] op_sel_hi:[1,0,0]
    v_pk_fma_f32 v[226:227], v[226:227], v[50:51], v[48:49] op_sel_hi:[1,0,0]
    v_pk_fma_f32 v[228:229], v[228:229], v[50:51], v[48:49] op_sel_hi:[1,0,0]
    v_pk_fma_f32 v[230:231], v[230:231], v[50:51], v[48:49] op_sel_hi:[1,0,0]
    v_pk_fma_f32 v[232:233], v[232:233], v[50:51], v[48:49] op_sel_hi:[1,0,0]
    v_pk_fma_f32 v[234:235], v[234:235], v[50:51], v[48:49] op_sel_hi:[1,0,0]
    v_pk_fma_f32 v[236:237], v[236:237], v[50:51], v[48:49] op_sel_hi:[1,0,0]
    v_pk_fma_f32 v[238:239], v[238:239], v[50:51], v[48:49] op_sel_hi:[1,0,0]
    v_pk_fma_f32 v[216:217], v[216:217], v[120:121], v[144:145]
    v_pk_fma_f32 v[218:219], v[218:219], v[122:123], v[146:147]
    v_pk_fma_f32 v[220:221], v[220:221], v[124:125], v[148:149]
    v_pk_fma_f32 v[222:223], v[222:223], v[126:127], v[150:151]
    v_pk_fma_f32 v[224:225], v[224:225], v[128:129], v[152:153]
    v_pk_fma_f32 v[226:227], v[226:227], v[130:131], v[154:155]
    v_pk_fma_f32 v[228:229], v[228:229], v[132:133], v[156:157]
    v_pk_fma_f32 v[230:231], v[230:231], v[134:135], v[158:159]
    v_pk_fma_f32 v[232:233], v[232:233], v[136:137], v[160:161]
    v_pk_fma_f32 v[234:235], v[234:235], v[138:139], v[162:163]
    v_pk_fma_f32 v[236:237], v[236:237], v[140:141], v[164:165]
    v_pk_fma_f32 v[238:239], v[238:239], v[142:143], v[166:167]
    v_cvt_pk_bf16_f32 v64, v216, v217
    v_cvt_pk_bf16_f32 v65, v218, v219
    v_cvt_pk_bf16_f32 v66, v220, v221
    v_cvt_pk_bf16_f32 v67, v222, v223
    v_cvt_pk_bf16_f32 v68, v224, v225
    v_cvt_pk_bf16_f32 v69, v226, v227
    v_cvt_pk_bf16_f32 v70, v228, v229
    v_cvt_pk_bf16_f32 v71, v230, v231
    v_cvt_pk_bf16_f32 v72, v232, v233
    v_cvt_pk_bf16_f32 v73, v234, v235
    v_cvt_pk_bf16_f32 v74, v236, v237
    v_cvt_pk_bf16_f32 v75, v238, v239
    v_lshlrev_b32 v216, 16, v64
    v_and_b32 v217, 0xffff0000, v64
    v_lshlrev_b32 v218, 16, v65
    v_and_b32 v219, 0xffff0000, v65
    v_lshlrev_b32 v220, 16, v66
    v_and_b32 v221, 0xffff0000, v66
    v_lshlrev_b32 v222, 16, v67
    v_and_b32 v223, 0xffff0000, v67
    v_lshlrev_b32 v224, 16, v68
    v_and_b32 v225, 0xffff0000, v68
    v_lshlrev_b32 v226, 16, v69
    v_and_b32 v227, 0xffff0000, v69
    v_lshlrev_b32 v228, 16, v70
    v_and_b32 v229, 0xffff0000, v70
    v_lshlrev_b32 v230, 16, v71
    v_and_b32 v231, 0xffff0000, v71
    v_lshlrev_b32 v232, 16, v72
    v_and_b32 v233, 0xffff0000, v72
    v_lshlrev_b32 v234, 16, v73
    v_and_b32 v235, 0xffff0000, v73
    v_lshlrev_b32 v236, 16, v74
    v_and_b32 v237, 0xffff0000, v74
    v_lshlrev_b32 v238, 16, v75
    v_and_b32 v239, 0xffff0000, v75
    v_pk_mul_f32 v[50:51], v[216:217], v[168:169]
    v_pk_mul_f32 v[52:53], v[224:225], v[176:177]
    v_pk_mul_f32 v[62:63], v[232:233], v[184:185]
    v_pk_fma_f32 v[50:51], v[218:219], v[170:171], v[50:51]
    v_pk_fma_f32 v[52:53], v[226:227], v[178:179], v[52:53]
    v_pk_fma_f32 v[62:63], v[234:235], v[186:187], v[62:63]
    v_pk_fma_f32 v[50:51], v[220:221], v[172:173], v[50:51]
    v_pk_fma_f32 v[52:53], v[228:229], v[180:181], v[52:53]
    v_pk_fma_f32 v[62:63], v[236:237], v[188:189], v[62:63]
    v_pk_fma_f32 v[50:51], v[222:223], v[174:175], v[50:51]
    v_pk_fma_f32 v[52:53], v[230:231], v[182:183], v[52:53]
    v_pk_fma_f32 v[62:63], v[238:239], v[190:191], v[62:63]
    v_pk_add_f32 v[50:51], v[50:51], v[52:53]
    v_add_f32 v62, v62, v63
    v_add_f32 v50, v50, v51
    v_add_f32 v50, v50, v62
    v_lshlrev_b32 v48, 2, v7
    v_and_b32 v48, 28, v48
    v_sub_u32 v49, 2047, v7
    v_add_f32_dpp v50, v50, v50 row_ror:1 row_mask:0xf bank_mask:0xf
    s_nop 1
    v_add_f32_dpp v50, v50, v50 row_ror:2 row_mask:0xf bank_mask:0xf
    s_nop 1
    v_add_f32_dpp v50, v50, v50 row_ror:4 row_mask:0xf bank_mask:0xf
    s_nop 1
    v_add_f32_dpp v50, v50, v50 row_ror:8 row_mask:0xf bank_mask:0xf
    v_mov_b32 v52, v50
    s_nop 1
    v_permlane16_swap_b32 v50, v52
    s_nop 0
    v_add_f32 v50, v50, v52
    v_ashrrev_i32 v52, 31, v50
    v_or_b32 v52, 0x80000000, v52
    v_xor_b32 v52, v52, v50
    v_and_b32 v52, 0xfffff800, v52
    v_min_u32 v52, 0xfffff000, v52
    v_or_b32 v52, v52, v49
    s_mov_b32 exec_lo, 1
    s_mov_b32 exec_hi, 1
    ds_write_b32 v48, v52 offset:36864
    s_mov_b64 exec, -1
    s_waitcnt lgkmcnt(0)
    s_barrier
    v_mov_b32 v141, 36864
    ds_read_b128 v[128:131], v141
    ds_read_b128 v[132:135], v141 offset:16
    s_lshl_b32 s45, s2, 7
    s_add_u32 s45, s45, 9306112
    s_cmp_eq_u32 s3, 0
    s_cselect_b32 s45, s45, 2147483648
    s_waitcnt lgkmcnt(1)
    v_max_u32 v136, v128, v129
    v_min_u32 v137, v128, v129
    v_med3_u32 v137, v136, v137, v130
    v_max_u32 v136, v136, v130
    v_med3_u32 v137, v136, v137, v131
Ltour12:
    s_cbranch_execz Ltour16
    v_max_u32 v136, v136, v131
    s_waitcnt lgkmcnt(0)
    v_med3_u32 v137, v136, v137, v132
    v_max_u32 v136, v136, v132
    v_med3_u32 v137, v136, v137, v133
    v_max_u32 v136, v136, v133
    v_med3_u32 v137, v136, v137, v134
    v_max_u32 v136, v136, v134
    v_med3_u32 v137, v136, v137, v135
    v_max_u32 v136, v136, v135
    buffer_store_dwordx2 v[136:137], v8, s[24:27], s45 offen sc1
    v_and_b32 v138, 0x7ff, v136
    v_and_b32 v139, 0x7ff, v137
    v_cmp_eq_u32 vcc, v138, v49
    v_cmp_eq_u32 s[36:37], v139, v49
    v_mov_b32 v138, 2147483648
    s_or_b64 vcc, vcc, s[36:37]
    s_mov_b32 s45, 2621440
    s_nop 0
    v_cndmask_b32 v6, v138, v6, vcc
    v_cndmask_b32 v60, v138, v60, vcc
    buffer_store_dwordx4 v[64:67], v6, s[24:27], s45 offen offset:0 sc1
    buffer_store_dwordx4 v[68:71], v6, s[24:27], s45 offen offset:512 sc1
    buffer_store_dwordx4 v[72:75], v60, s[24:27], s45 offen offset:1024 sc1
    v_pk_mul_f32 v[192:193], v[192:193], v[216:217]
    v_pk_mul_f32 v[194:195], v[194:195], v[218:219]
    v_pk_mul_f32 v[196:197], v[196:197], v[220:221]
    v_pk_mul_f32 v[198:199], v[198:199], v[222:223]
    v_pk_mul_f32 v[200:201], v[200:201], v[224:225]
    v_pk_mul_f32 v[202:203], v[202:203], v[226:227]
    v_pk_mul_f32 v[204:205], v[204:205], v[228:229]
    v_pk_mul_f32 v[206:207], v[206:207], v[230:231]
    v_pk_mul_f32 v[208:209], v[208:209], v[232:233]
    v_pk_mul_f32 v[210:211], v[210:211], v[234:235]
    v_pk_mul_f32 v[212:213], v[212:213], v[236:237]
    v_pk_mul_f32 v[214:215], v[214:215], v[238:239]
    v_cvt_pk_bf16_f32 v144, v192, v193
    v_cvt_pk_bf16_f32 v145, v194, v195
    v_cvt_pk_bf16_f32 v146, v196, v197
    v_cvt_pk_bf16_f32 v147, v198, v199
    v_cvt_pk_bf16_f32 v148, v200, v201
    v_cvt_pk_bf16_f32 v149, v202, v203
    v_cvt_pk_bf16_f32 v150, v204, v205
    v_cvt_pk_bf16_f32 v151, v206, v207
    v_cvt_pk_bf16_f32 v152, v208, v209
    v_cvt_pk_bf16_f32 v153, v210, v211
    v_cvt_pk_bf16_f32 v154, v212, v213
    v_cvt_pk_bf16_f32 v155, v214, v215
    v_lshlrev_b32 v192, 16, v144
    v_and_b32 v193, 0xffff0000, v144
    v_lshlrev_b32 v194, 16, v145
    v_and_b32 v195, 0xffff0000, v145
    v_lshlrev_b32 v196, 16, v146
    v_and_b32 v197, 0xffff0000, v146
    v_lshlrev_b32 v198, 16, v147
    v_and_b32 v199, 0xffff0000, v147
    v_lshlrev_b32 v200, 16, v148
    v_and_b32 v201, 0xffff0000, v148
    v_lshlrev_b32 v202, 16, v149
    v_and_b32 v203, 0xffff0000, v149
    v_lshlrev_b32 v204, 16, v150
    v_and_b32 v205, 0xffff0000, v150
    v_lshlrev_b32 v206, 16, v151
    v_and_b32 v207, 0xffff0000, v151
    v_lshlrev_b32 v208, 16, v152
    v_and_b32 v209, 0xffff0000, v152
    v_lshlrev_b32 v210, 16, v153
    v_and_b32 v211, 0xffff0000, v153
    v_lshlrev_b32 v212, 16, v154
    v_and_b32 v213, 0xffff0000, v154
    v_lshlrev_b32 v214, 16, v155
    v_and_b32 v215, 0xffff0000, v155
    v_pk_add_f32 v[192:193], v[192:193], v[12:13]
    v_pk_add_f32 v[194:195], v[194:195], v[14:15]
    v_pk_add_f32 v[196:197], v[196:197], v[16:17]
    v_pk_add_f32 v[198:199], v[198:199], v[18:19]
    v_pk_add_f32 v[200:201], v[200:201], v[20:21]
    v_pk_add_f32 v[202:203], v[202:203], v[22:23]
    v_pk_add_f32 v[204:205], v[204:205], v[24:25]
    v_pk_add_f32 v[206:207], v[206:207], v[26:27]
    v_pk_add_f32 v[208:209], v[208:209], v[28:29]
    v_pk_add_f32 v[210:211], v[210:211], v[30:31]
    v_pk_add_f32 v[212:213], v[212:213], v[32:33]
    v_pk_add_f32 v[214:215], v[214:215], v[34:35]
    v_cvt_pk_bf16_f32 v156, v192, v193
    v_cvt_pk_bf16_f32 v157, v194, v195
    v_cvt_pk_bf16_f32 v158, v196, v197
    v_cvt_pk_bf16_f32 v159, v198, v199
    v_cvt_pk_bf16_f32 v160, v200, v201
    v_cvt_pk_bf16_f32 v161, v202, v203
    v_cvt_pk_bf16_f32 v162, v204, v205
    v_cvt_pk_bf16_f32 v163, v206, v207
    v_cvt_pk_bf16_f32 v164, v208, v209
    v_cvt_pk_bf16_f32 v165, v210, v211
    v_cvt_pk_bf16_f32 v166, v212, v213
    v_cvt_pk_bf16_f32 v167, v214, v215
    v_and_b32 v30, 2, v1
    v_cmp_ne_u32 vcc, 0, v30
    v_mul_u32_u24 v30, 1152, v7
    v_add_u32 v4, v30, v5
    v_add_u32 v58, v30, v59
    v_mov_b32_dpp v192, v158 quad_perm:[0,2,0,2] row_mask:0xf bank_mask:0xf
    v_mov_b32_dpp v193, v159 quad_perm:[0,2,0,2] row_mask:0xf bank_mask:0xf
    v_mov_b32_dpp v194, v158 quad_perm:[1,3,1,3] row_mask:0xf bank_mask:0xf
    v_mov_b32_dpp v195, v159 quad_perm:[1,3,1,3] row_mask:0xf bank_mask:0xf
    v_mov_b32_dpp v196, v162 quad_perm:[0,2,0,2] row_mask:0xf bank_mask:0xf
    v_mov_b32_dpp v197, v163 quad_perm:[0,2,0,2] row_mask:0xf bank_mask:0xf
    v_mov_b32_dpp v198, v162 quad_perm:[1,3,1,3] row_mask:0xf bank_mask:0xf
    v_mov_b32_dpp v199, v163 quad_perm:[1,3,1,3] row_mask:0xf bank_mask:0xf
    v_mov_b32_dpp v200, v166 quad_perm:[0,2,0,2] row_mask:0xf bank_mask:0xf
    v_mov_b32_dpp v201, v167 quad_perm:[0,2,0,2] row_mask:0xf bank_mask:0xf
    v_mov_b32_dpp v202, v166 quad_perm:[1,3,1,3] row_mask:0xf bank_mask:0xf
    v_mov_b32_dpp v203, v167 quad_perm:[1,3,1,3] row_mask:0xf bank_mask:0xf
    v_cndmask_b32_dpp v144, v156, v192, vcc quad_perm:[0,2,0,2] row_mask:0xf bank_mask:0xf
    v_cndmask_b32_dpp v145, v157, v193, vcc quad_perm:[0,2,0,2] row_mask:0xf bank_mask:0xf
    v_cndmask_b32_dpp v146, v156, v194, vcc quad_perm:[1,3,1,3] row_mask:0xf bank_mask:0xf
    v_cndmask_b32_dpp v147, v157, v195, vcc quad_perm:[1,3,1,3] row_mask:0xf bank_mask:0xf
    v_cndmask_b32_dpp v148, v160, v196, vcc quad_perm:[0,2,0,2] row_mask:0xf bank_mask:0xf
    v_cndmask_b32_dpp v149, v161, v197, vcc quad_perm:[0,2,0,2] row_mask:0xf bank_mask:0xf
    v_cndmask_b32_dpp v150, v160, v198, vcc quad_perm:[1,3,1,3] row_mask:0xf bank_mask:0xf
    v_cndmask_b32_dpp v151, v161, v199, vcc quad_perm:[1,3,1,3] row_mask:0xf bank_mask:0xf
    v_cndmask_b32_dpp v152, v164, v200, vcc quad_perm:[0,2,0,2] row_mask:0xf bank_mask:0xf
    v_cndmask_b32_dpp v153, v165, v201, vcc quad_perm:[0,2,0,2] row_mask:0xf bank_mask:0xf
    v_cndmask_b32_dpp v154, v164, v202, vcc quad_perm:[1,3,1,3] row_mask:0xf bank_mask:0xf
    v_cndmask_b32_dpp v155, v165, v203, vcc quad_perm:[1,3,1,3] row_mask:0xf bank_mask:0xf
    buffer_store_dwordx4 v[144:147], v4, s[16:19], 0 offen offset:0 sc1
    buffer_store_dwordx4 v[148:151], v4, s[16:19], 0 offen offset:512 sc1
    buffer_store_dwordx4 v[152:155], v58, s[16:19], 0 offen offset:1024 sc1
    s_cmp_ge_u32 s41, 18
    s_cbranch_scc1 Ltail_idle
    s_add_u32 s57, s59, 4096
    s_add_u32 m0, s6, -110592
    s_nop 0
    buffer_load_dwordx4 v255, s[84:87], s57 offen lds
    s_add_u32 s57, s59, 8192
    s_add_u32 m0, s6, -106496
    s_nop 0
    buffer_load_dwordx4 v255, s[84:87], s57 offen lds
    s_add_u32 s57, s59, 12288
    s_add_u32 m0, s6, -102400
    s_nop 0
    buffer_load_dwordx4 v255, s[84:87], s57 offen lds
    s_add_u32 s57, s59, 16384
    s_add_u32 m0, s6, -98304
    s_nop 0
    buffer_load_dwordx4 v255, s[84:87], s57 offen lds
    s_add_u32 s57, s59, 20480
    s_add_u32 m0, s6, -94208
    s_nop 0
    buffer_load_dwordx4 v255, s[84:87], s57 offen lds
    s_add_u32 s57, s59, 24576
    s_add_u32 m0, s6, -90112
    s_nop 0
    buffer_load_dwordx4 v255, s[84:87], s57 offen lds
    s_add_u32 s57, s59, 28672
    s_add_u32 m0, s6, -86016
    s_nop 0
    buffer_load_dwordx4 v255, s[84:87], s57 offen lds
    s_add_u32 s57, s59, 32768
    s_add_u32 m0, s6, -81920
    s_nop 0
    buffer_load_dwordx4 v255, s[84:87], s57 offen lds
    s_mov_b32 s38, 135168
    s_mov_b32 s39, 12288
    v_lshrrev_b32 v9, 2, v1
    v_and_b32 v10, 3, v1
    v_lshlrev_b32 v10, 3, v10
    s_and_b32 s45, s3, 1
    s_lshl_b32 s45, s45, 5
    v_lshl_add_u32 v11, v9, 6, v10
    v_add_u32 v11, s45, v11
    s_cmp_lt_u32 s3, 2
    s_cselect_b32 s44, 98304, s38
    s_cselect_b32 s45, 98304, s39
    v_add_u32 v12, s45, v11
    v_add_u32 v11, s44, v11
    ds_read_b64_tr_b16 a[0:1], v11 offset:0
    ds_read_b64_tr_b16 a[2:3], v11 offset:1024
    ds_read_b64_tr_b16 a[4:5], v11 offset:2048
    ds_read_b64_tr_b16 a[6:7], v11 offset:3072
    ds_read_b64_tr_b16 a[8:9], v11 offset:4096
    ds_read_b64_tr_b16 a[10:11], v11 offset:5120
    ds_read_b64_tr_b16 a[12:13], v11 offset:6144
    ds_read_b64_tr_b16 a[14:15], v11 offset:7168
    ds_read_b64_tr_b16 a[16:17], v11 offset:8192
    ds_read_b64_tr_b16 a[18:19], v11 offset:9216
    ds_read_b64_tr_b16 a[20:21], v11 offset:10240
    ds_read_b64_tr_b16 a[22:23], v11 offset:11264
    ds_read_b64_tr_b16 a[24:25], v11 offset:12288
    ds_read_b64_tr_b16 a[26:27], v11 offset:13312
    ds_read_b64_tr_b16 a[28:29], v11 offset:14336
    ds_read_b64_tr_b16 a[30:31], v11 offset:15360
    ds_read_b64_tr_b16 a[32:33], v11 offset:16384
    ds_read_b64_tr_b16 a[34:35], v11 offset:17408
    ds_read_b64_tr_b16 a[36:37], v11 offset:18432
    ds_read_b64_tr_b16 a[38:39], v11 offset:19456
    ds_read_b64_tr_b16 a[40:41], v11 offset:20480
    ds_read_b64_tr_b16 a[42:43], v11 offset:21504
    ds_read_b64_tr_b16 a[44:45], v11 offset:22528
    ds_read_b64_tr_b16 a[46:47], v11 offset:23552
    ds_read_b64_tr_b16 a[48:49], v11 offset:24576
    ds_read_b64_tr_b16 a[50:51], v11 offset:25600
    ds_read_b64_tr_b16 a[52:53], v11 offset:26624
    ds_read_b64_tr_b16 a[54:55], v11 offset:27648
    ds_read_b64_tr_b16 a[56:57], v12 offset:28672
    ds_read_b64_tr_b16 a[58:59], v12 offset:29696
    ds_read_b64_tr_b16 a[60:61], v12 offset:30720
    ds_read_b64_tr_b16 a[62:63], v12 offset:31744
    ds_read_b64_tr_b16 a[64:65], v12 offset:32768
    ds_read_b64_tr_b16 a[66:67], v12 offset:33792
    ds_read_b64_tr_b16 a[68:69], v12 offset:34816
    ds_read_b64_tr_b16 a[70:71], v12 offset:35840
    v_mul_u32_u24 v12, 1152, v9
    s_lshl_b32 s44, s3, 7
    s_add_u32 s44, s44, 49152
    v_add3_u32 v12, v12, v10, s44
    v_lshlrev_b32 v13, 4, v1
    v_add_u32 v13, 32768, v13
    s_lshl_b32 s44, s3, 10
    v_add_u32 v14, s44, v13
    v_and_b32 v13, 0xffffff1f, v13
    v_bfe_u32 v15, v1, 2, 2
    v_cmp_eq_u32 s[52:53], 0, v15
    v_cmp_eq_u32 s[54:55], 1, v15
    v_cmp_eq_u32 s[56:57], 2, v15
    v_cmp_eq_u32 s[58:59], 3, v15
    s_mul_i32 s43, s42, 18
    s_add_u32 s43, s43, s41
    s_lshl_b32 s43, s43, 9
    s_mul_i32 s44, s3, 73728
    s_add_u32 s43, s43, s44
    v_lshlrev_b32 v15, 3, v1
    v_lshlrev_b32 v140, 7, v0
    s_mov_b32 s45, 9306112
    s_lshl_b32 s36, s3, 3
    v_mov_b32 v141, s36
    s_mov_b32 s48, 16384
Ltail_pollk:
    buffer_load_dwordx2 v[136:137], v140, s[24:27], s45 offen sc1
    s_sub_u32 s48, s48, 1
    s_cbranch_scc1 Ltail_gotk
    s_waitcnt vmcnt(0)
    v_max_u32 v138, v136, v137
    v_cmp_eq_u32 vcc, -1, v138
    s_cbranch_vccnz Ltail_pollk
Ltail_gotk:
    s_waitcnt vmcnt(0)
    s_mov_b32 s36, 2622592
    buffer_store_dwordx4 v[36:39], v6, s[24:27], s36 offen offset:0 sc1
    buffer_store_dwordx4 v[40:43], v6, s[24:27], s36 offen offset:512 sc1
    buffer_store_dwordx4 v[44:47], v60, s[24:27], s36 offen offset:1024 sc1
    v_mov_b32_dpp v138, v136 row_ror:1 row_mask:0xf bank_mask:0xf
    v_mov_b32_dpp v139, v137 row_ror:1 row_mask:0xf bank_mask:0xf
    v_min_u32 v142, v136, v138
    v_max_u32 v136, v136, v138
    v_max3_u32 v137, v142, v137, v139
    s_nop 0
    v_mov_b32_dpp v138, v136 row_ror:2 row_mask:0xf bank_mask:0xf
    v_mov_b32_dpp v139, v137 row_ror:2 row_mask:0xf bank_mask:0xf
    v_min_u32 v142, v136, v138
    v_max_u32 v136, v136, v138
    v_max3_u32 v137, v142, v137, v139
    s_nop 0
    v_mov_b32_dpp v138, v136 row_ror:4 row_mask:0xf bank_mask:0xf
    v_mov_b32_dpp v139, v137 row_ror:4 row_mask:0xf bank_mask:0xf
    v_min_u32 v142, v136, v138
    v_max_u32 v136, v136, v138
    v_max3_u32 v137, v142, v137, v139
    s_nop 0
    v_mov_b32_dpp v138, v136 row_ror:8 row_mask:0xf bank_mask:0xf
    v_mov_b32_dpp v139, v137 row_ror:8 row_mask:0xf bank_mask:0xf
    v_min_u32 v142, v136, v138
    v_max_u32 v136, v136, v138
    v_max3_u32 v137, v142, v137, v139
    v_mov_b32 v138, v136
    v_mov_b32 v139, v137
    s_nop 0
    v_permlane16_swap_b32 v136, v138
    v_permlane16_swap_b32 v137, v139
    v_min_u32 v142, v136, v138
    v_max_u32 v136, v136, v138
    v_max3_u32 v137, v142, v137, v139
    v_mov_b32 v138, v136
    v_mov_b32 v139, v137
    s_nop 0
    v_permlane32_swap_b32 v136, v138
    v_permlane32_swap_b32 v137, v139
    v_min_u32 v142, v136, v138
    v_max_u32 v136, v136, v138
    v_max3_u32 v137, v142, v137, v139
    ds_write_b64 v141, v[136:137] offset:36928
    v_mov_b32 v141, 36928
    s_waitcnt lgkmcnt(0)
    s_barrier
    ds_read_b128 v[128:131], v141
    ds_read_b128 v[132:135], v141 offset:16
    s_or_b32 s36, s2, s3
    s_cselect_b32 s45, -4, 24576
    s_add_u32 s36, s94, 1
    v_mov_b32 v138, s36
    buffer_store_dword v138, v8, s[24:27], s45 offen sc1
    s_waitcnt lgkmcnt(1)
    v_max_u32 v136, v128, v129
    v_min_u32 v137, v128, v129
    v_med3_u32 v137, v136, v137, v130
    v_max_u32 v136, v136, v130
    v_med3_u32 v137, v136, v137, v131
    v_max_u32 v136, v136, v131
    s_waitcnt lgkmcnt(0)
    v_med3_u32 v137, v136, v137, v132
    v_max_u32 v136, v136, v132
    v_med3_u32 v137, v136, v137, v133
    v_max_u32 v136, v136, v133
    v_med3_u32 v137, v136, v137, v134
    v_max_u32 v136, v136, v134
    v_med3_u32 v137, v136, v137, v135
    v_max_u32 v136, v136, v135
    s_nop 0
    v_readfirstlane_b32 s92, v136
    v_readfirstlane_b32 s93, v137
    s_andn2_b32 s46, 0x7ff, s92
    s_andn2_b32 s47, 0x7ff, s93
    s_cmp_ge_u32 s41, 18
    s_cbranch_scc1 Ltail_noffn
    s_mul_i32 s44, s46, 2304
    s_mul_i32 s45, s47, 2304
    s_sub_u32 s45, s45, s44
    v_and_b32 v8, 1, v1
    v_mul_lo_u32 v8, v8, s45
    v_and_b32 v9, 48, v1
    v_add3_u32 v8, v8, v9, s44
    s_mov_b32 s45, 2621440
    s_mov_b32 s48, 16384
Ltail_pollh:
    s_mov_b32 exec_lo, 0x30003
    s_mov_b32 exec_hi, 0x30003
    buffer_load_dwordx4 a[120:123], v8, s[24:27], s45 offen offset:0 sc1
    buffer_load_dwordx4 a[124:127], v8, s[24:27], s45 offen offset:64 sc1
    buffer_load_dwordx4 a[128:131], v8, s[24:27], s45 offen offset:128 sc1
    buffer_load_dwordx4 a[132:135], v8, s[24:27], s45 offen offset:192 sc1
    buffer_load_dwordx4 a[136:139], v8, s[24:27], s45 offen offset:256 sc1
    buffer_load_dwordx4 a[140:143], v8, s[24:27], s45 offen offset:320 sc1
    buffer_load_dwordx4 a[144:147], v8, s[24:27], s45 offen offset:384 sc1
    buffer_load_dwordx4 a[148:151], v8, s[24:27], s45 offen offset:448 sc1
    buffer_load_dwordx4 a[152:155], v8, s[24:27], s45 offen offset:512 sc1
    buffer_load_dwordx4 a[156:159], v8, s[24:27], s45 offen offset:576 sc1
    buffer_load_dwordx4 a[160:163], v8, s[24:27], s45 offen offset:640 sc1
    buffer_load_dwordx4 a[164:167], v8, s[24:27], s45 offen offset:704 sc1
    buffer_load_dwordx4 a[168:171], v8, s[24:27], s45 offen offset:768 sc1
    buffer_load_dwordx4 a[172:175], v8, s[24:27], s45 offen offset:832 sc1
    buffer_load_dwordx4 a[176:179], v8, s[24:27], s45 offen offset:896 sc1
    buffer_load_dwordx4 a[180:183], v8, s[24:27], s45 offen offset:960 sc1
    buffer_load_dwordx4 a[184:187], v8, s[24:27], s45 offen offset:1024 sc1
    buffer_load_dwordx4 a[188:191], v8, s[24:27], s45 offen offset:1088 sc1
    s_mov_b64 exec, -1
    ds_read_b64_tr_b16 a[72:73], v12 offset:0
    ds_read_b64_tr_b16 a[74:75], v12 offset:18432
    ds_read_b64_tr_b16 a[76:77], v12 offset:32
    ds_read_b64_tr_b16 a[78:79], v12 offset:18464
    ds_read_b64_tr_b16 a[80:81], v12 offset:64
    ds_read_b64_tr_b16 a[82:83], v12 offset:18496
    ds_read_b64_tr_b16 a[84:85], v12 offset:96
    ds_read_b64_tr_b16 a[86:87], v12 offset:18528
    ds_read_b64_tr_b16 a[88:89], v12 offset:512
    ds_read_b64_tr_b16 a[90:91], v12 offset:18944
    ds_read_b64_tr_b16 a[92:93], v12 offset:544
    ds_read_b64_tr_b16 a[94:95], v12 offset:18976
    ds_read_b64_tr_b16 a[96:97], v12 offset:576
    ds_read_b64_tr_b16 a[98:99], v12 offset:19008
    ds_read_b64_tr_b16 a[100:101], v12 offset:608
    ds_read_b64_tr_b16 a[102:103], v12 offset:19040
    ds_read_b64_tr_b16 a[104:105], v12 offset:1024
    ds_read_b64_tr_b16 a[106:107], v12 offset:19456
    ds_read_b64_tr_b16 a[108:109], v12 offset:1056
    ds_read_b64_tr_b16 a[110:111], v12 offset:19488
    ds_read_b64_tr_b16 a[112:113], v12 offset:1088
    ds_read_b64_tr_b16 a[114:115], v12 offset:19520
    ds_read_b64_tr_b16 a[116:117], v12 offset:1120
    ds_read_b64_tr_b16 a[118:119], v12 offset:19552
    s_waitcnt vmcnt(17)
    v_mfma_f32_16x16x32_bf16 v[16:19], a[0:3], a[120:123], 0
    s_waitcnt vmcnt(16)
    v_mfma_f32_16x16x32_bf16 v[20:23], a[4:7], a[124:127], 0
    s_waitcnt vmcnt(15)
    v_mfma_f32_16x16x32_bf16 v[16:19], a[8:11], a[128:131], v[16:19]
    s_waitcnt vmcnt(14)
    v_mfma_f32_16x16x32_bf16 v[20:23], a[12:15], a[132:135], v[20:23]
    s_waitcnt vmcnt(13)
    v_mfma_f32_16x16x32_bf16 v[16:19], a[16:19], a[136:139], v[16:19]
    s_waitcnt vmcnt(12)
    v_mfma_f32_16x16x32_bf16 v[20:23], a[20:23], a[140:143], v[20:23]
    s_waitcnt vmcnt(11)
    v_mfma_f32_16x16x32_bf16 v[16:19], a[24:27], a[144:147], v[16:19]
    s_waitcnt vmcnt(10)
    v_mfma_f32_16x16x32_bf16 v[20:23], a[28:31], a[148:151], v[20:23]
    s_waitcnt vmcnt(9)
    v_mfma_f32_16x16x32_bf16 v[16:19], a[32:35], a[152:155], v[16:19]
    s_waitcnt vmcnt(8)
    v_mfma_f32_16x16x32_bf16 v[20:23], a[36:39], a[156:159], v[20:23]
    s_waitcnt vmcnt(7)
    v_mfma_f32_16x16x32_bf16 v[16:19], a[40:43], a[160:163], v[16:19]
    s_waitcnt vmcnt(6)
    v_mfma_f32_16x16x32_bf16 v[20:23], a[44:47], a[164:167], v[20:23]
    s_waitcnt vmcnt(5)
    v_mfma_f32_16x16x32_bf16 v[16:19], a[48:51], a[168:171], v[16:19]
    s_waitcnt vmcnt(4)
    v_mfma_f32_16x16x32_bf16 v[20:23], a[52:55], a[172:175], v[20:23]
    s_waitcnt vmcnt(3)
    v_mfma_f32_16x16x32_bf16 v[16:19], a[56:59], a[176:179], v[16:19]
    s_waitcnt vmcnt(2)
    v_mfma_f32_16x16x32_bf16 v[20:23], a[60:63], a[180:183], v[20:23]
    s_waitcnt vmcnt(1)
    v_mfma_f32_16x16x32_bf16 v[16:19], a[64:67], a[184:187], v[16:19]
    s_waitcnt vmcnt(0)
    v_mfma_f32_16x16x32_bf16 v[20:23], a[68:71], a[188:191], v[20:23]
    s_sub_u32 s48, s48, 1
    s_nop 6
    v_pk_add_f32 v[16:17], v[16:17], v[20:21]
    v_pk_add_f32 v[18:19], v[18:19], v[22:23]
    s_cbranch_scc1 Ltail_goth
    v_cmp_u_f32 vcc, v16, v16
    s_and_b32 s36, vcc_lo, 3
    s_cbranch_scc1 Ltail_pollh
Ltail_goth:
    ds_write_b128 v14, v[16:19]
    s_waitcnt lgkmcnt(0)
    s_barrier
    ds_read_b128 v[16:19], v13 offset:0
    ds_read_b128 v[20:23], v13 offset:1024
    ds_read_b128 v[24:27], v13 offset:2048
    ds_read_b128 v[28:31], v13 offset:3072
    s_mov_b32 s36, 0xbfb8aa3b
    s_mov_b32 s37, 0xbfb8aa3b
    s_waitcnt lgkmcnt(3)
    v_cvt_pk_bf16_f32 v32, v16, v17
    v_cvt_pk_bf16_f32 v33, v18, v19
    s_waitcnt lgkmcnt(2)
    v_cvt_pk_bf16_f32 v34, v20, v21
    v_cvt_pk_bf16_f32 v35, v22, v23
    v_lshlrev_b32 v16, 16, v32
    v_and_b32 v17, 0xffff0000, v32
    v_lshlrev_b32 v18, 16, v33
    v_and_b32 v19, 0xffff0000, v33
    v_lshlrev_b32 v20, 16, v34
    v_and_b32 v21, 0xffff0000, v34
    v_lshlrev_b32 v22, 16, v35
    v_and_b32 v23, 0xffff0000, v35
    v_pk_mul_f32 v[32:33], v[16:17], s[36:37]
    v_pk_mul_f32 v[34:35], v[18:19], s[36:37]
    v_pk_mul_f32 v[36:37], v[20:21], s[36:37]
    v_pk_mul_f32 v[38:39], v[22:23], s[36:37]
    v_exp_f32 v32, v32
    v_exp_f32 v33, v33
    v_exp_f32 v34, v34
    v_exp_f32 v35, v35
    v_exp_f32 v36, v36
    v_exp_f32 v37, v37
    v_exp_f32 v38, v38
    v_exp_f32 v39, v39
    s_waitcnt lgkmcnt(1)
    v_cvt_pk_bf16_f32 v60, v24, v25
    v_cvt_pk_bf16_f32 v61, v26, v27
    s_waitcnt lgkmcnt(0)
    v_cvt_pk_bf16_f32 v62, v28, v29
    v_cvt_pk_bf16_f32 v63, v30, v31
    v_pk_add_f32 v[32:33], v[32:33], 1.0 op_sel_hi:[1,0]
    v_pk_add_f32 v[34:35], v[34:35], 1.0 op_sel_hi:[1,0]
    v_pk_add_f32 v[36:37], v[36:37], 1.0 op_sel_hi:[1,0]
    v_pk_add_f32 v[38:39], v[38:39], 1.0 op_sel_hi:[1,0]
    v_rcp_f32 v32, v32
    v_rcp_f32 v33, v33
    v_rcp_f32 v34, v34
    v_rcp_f32 v35, v35
    v_rcp_f32 v36, v36
    v_rcp_f32 v37, v37
    v_rcp_f32 v38, v38
    v_rcp_f32 v39, v39
    v_lshlrev_b32 v24, 16, v60
    v_and_b32 v25, 0xffff0000, v60
    v_lshlrev_b32 v26, 16, v61
    v_and_b32 v27, 0xffff0000, v61
    v_lshlrev_b32 v28, 16, v62
    v_and_b32 v29, 0xffff0000, v62
    v_lshlrev_b32 v30, 16, v63
    v_and_b32 v31, 0xffff0000, v63
    v_pk_mul_f32 v[16:17], v[16:17], v[32:33]
    v_pk_mul_f32 v[18:19], v[18:19], v[34:35]
    v_pk_mul_f32 v[20:21], v[20:21], v[36:37]
    v_pk_mul_f32 v[22:23], v[22:23], v[38:39]
    v_cvt_pk_bf16_f32 v32, v16, v17
    v_cvt_pk_bf16_f32 v33, v18, v19
    v_cvt_pk_bf16_f32 v34, v20, v21
    v_cvt_pk_bf16_f32 v35, v22, v23
    v_lshlrev_b32 v16, 16, v32
    v_and_b32 v17, 0xffff0000, v32
    v_lshlrev_b32 v18, 16, v33
    v_and_b32 v19, 0xffff0000, v33
    v_lshlrev_b32 v20, 16, v34
    v_and_b32 v21, 0xffff0000, v34
    v_lshlrev_b32 v22, 16, v35
    v_and_b32 v23, 0xffff0000, v35
    v_pk_mul_f32 v[16:17], v[16:17], v[24:25]
    v_pk_mul_f32 v[18:19], v[18:19], v[26:27]
    v_pk_mul_f32 v[20:21], v[20:21], v[28:29]
    v_pk_mul_f32 v[22:23], v[22:23], v[30:31]
    v_cvt_pk_bf16_f32 v32, v16, v17
    v_cvt_pk_bf16_f32 v33, v18, v19
    v_cvt_pk_bf16_f32 v34, v20, v21
    v_cvt_pk_bf16_f32 v35, v22, v23
    v_cndmask_b32 v64, 0, v32, s[52:53]
    v_cndmask_b32 v65, 0, v33, s[52:53]
    v_cndmask_b32 v66, 0, v34, s[52:53]
    v_cndmask_b32 v67, 0, v35, s[52:53]
    v_cndmask_b32 v68, 0, v32, s[54:55]
    v_cndmask_b32 v69, 0, v33, s[54:55]
    v_cndmask_b32 v70, 0, v34, s[54:55]
    v_cndmask_b32 v71, 0, v35, s[54:55]
    v_cndmask_b32 v72, 0, v32, s[56:57]
    v_cndmask_b32 v73, 0, v33, s[56:57]
    v_cndmask_b32 v74, 0, v34, s[56:57]
    v_cndmask_b32 v75, 0, v35, s[56:57]
    v_cndmask_b32 v76, 0, v32, s[58:59]
    v_cndmask_b32 v77, 0, v33, s[58:59]
    v_cndmask_b32 v78, 0, v34, s[58:59]
    v_cndmask_b32 v79, 0, v35, s[58:59]
    v_mfma_f32_16x16x32_bf16 v[16:19], v[64:67], a[72:75], 0
    v_mfma_f32_16x16x32_bf16 v[16:19], v[68:71], a[76:79], v[16:19]
    v_mfma_f32_16x16x32_bf16 v[16:19], v[72:75], a[80:83], v[16:19]
    v_mfma_f32_16x16x32_bf16 v[16:19], v[76:79], a[84:87], v[16:19]
    v_mfma_f32_16x16x32_bf16 v[20:23], v[64:67], a[88:91], 0
    v_mfma_f32_16x16x32_bf16 v[20:23], v[68:71], a[92:95], v[20:23]
    v_mfma_f32_16x16x32_bf16 v[20:23], v[72:75], a[96:99], v[20:23]
    v_mfma_f32_16x16x32_bf16 v[20:23], v[76:79], a[100:103], v[20:23]
    v_mfma_f32_16x16x32_bf16 v[24:27], v[64:67], a[104:107], 0
    v_mfma_f32_16x16x32_bf16 v[24:27], v[68:71], a[108:111], v[24:27]
    v_mfma_f32_16x16x32_bf16 v[24:27], v[72:75], a[112:115], v[24:27]
    v_mfma_f32_16x16x32_bf16 v[24:27], v[76:79], a[116:119], v[24:27]
    v_min_u32 v16, -2, v16
    v_min_u32 v17, -2, v17
    buffer_store_dwordx2 v[16:17], v15, s[8:11], s43 offen sc1
    s_add_u32 s43, s43, 294912
    v_min_u32 v20, -2, v20
    v_min_u32 v21, -2, v21
    buffer_store_dwordx2 v[20:21], v15, s[8:11], s43 offen sc1
    s_add_u32 s43, s43, 294912
    v_min_u32 v24, -2, v24
    v_min_u32 v25, -2, v25
    buffer_store_dwordx2 v[24:25], v15, s[8:11], s43 offen sc1
    s_cmp_lt_u32 s41, 9
    s_cselect_b32 s36, s3, 0
    s_cmp_eq_u32 s36, 3
    s_cbranch_scc1 Ltail_final
Ltail_noffn:
    s_branch Ltail_done
Ltail_idle:
    s_waitcnt vmcnt(0)
    s_mov_b32 s36, 2622592
    buffer_store_dwordx4 v[36:39], v6, s[24:27], s36 offen offset:0 sc1
    buffer_store_dwordx4 v[40:43], v6, s[24:27], s36 offen offset:512 sc1
    buffer_store_dwordx4 v[44:47], v60, s[24:27], s36 offen offset:1024 sc1
    s_branch Ltail_done
Ltail_final:
Ltour13:
    s_cbranch_execz Ltour17
    s_mul_i32 s43, s42, 9
    s_add_u32 s43, s43, s41
    v_bfe_u32 v8, v1, 2, 1
    v_cmp_eq_u32 vcc, 1, v8
    v_mov_b32 v9, s46
    v_mov_b32 v10, s47
    v_and_b32 v11, 3, v1
    v_cndmask_b32 v9, v9, v10, vcc
    s_lshr_b32 s44, s43, 2
    s_lshl_b32 s44, s44, 6
    s_and_b32 s45, s43, 1
    s_lshl_b32 s45, s45, 5
    s_add_u32 s44, s44, s45
    s_and_b32 s45, s43, 2
    s_lshl_b32 s45, s45, 2
    s_add_u32 s44, s44, s45
    v_lshrrev_b32 v12, 1, v11
    v_lshl_add_u32 v12, v12, 4, s44
    v_and_b32 v13, 1, v11
    v_lshl_add_u32 v12, v13, 2, v12
    v_mul_u32_u24 v13, 1152, v9
    v_lshl_add_u32 v14, v13, 1, v12
    v_add_u32 v15, 2621440, v14
    s_mov_b32 s45, 22144
    buffer_load_dword v18, v12, s[24:27], s45 offen sc1
    v_mov_b32 v19, s92
    v_mov_b32 v10, s93
    v_cndmask_b32 v19, v19, v10, vcc
    v_and_b32 v19, 0xfffff800, v19
    v_or_b32 v19, 0x400, v19
    v_ashrrev_i32 v10, 31, v19
    v_not_b32 v10, v10
    v_or_b32 v10, 0x80000000, v10
    v_xor_b32 v19, v19, v10
    s_lshl_b32 s45, s43, 4
    v_lshl_add_u32 v13, v11, 2, v13
    v_add_u32 v13, s45, v13
    v_lshrrev_b32 v14, 2, v1
    v_lshlrev_b32 v14, 9, v14
    v_lshl_add_u32 v14, v11, 4, v14
    s_lshr_b32 s44, s43, 3
    s_mul_i32 s44, s44, 73728
    s_and_b32 s45, s43, 7
    s_lshl_b32 s45, s45, 6
    s_add_u32 s44, s44, s45
    v_cmp_eq_u32 s[38:39], 1, v8
    v_cvt_pk_bf16_f32 v19, v19, v19
    v_and_b32 v19, 0xffff0000, v19
    v_mul_f32 v19, 0xbfb8aa3b, v19
    v_exp_f32 v19, v19
    s_waitcnt vmcnt(0)
    v_lshlrev_b32 v24, 16, v18
    v_and_b32 v25, 0xffff0000, v18
    v_add_f32 v19, 1.0, v19
    v_rcp_f32 v19, v19
    s_mov_b32 s48, 16384
    v_cvt_pk_bf16_f32 v19, v19, v19
    v_and_b32 v19, 0xffff0000, v19
Ltail_polly:
    s_add_u32 s45, s44, 0
    buffer_load_dwordx4 v[64:67], v14, s[8:11], s45 offen sc1
    s_add_u32 s45, s44, 8192
    buffer_load_dwordx4 v[68:71], v14, s[8:11], s45 offen sc1
    s_add_u32 s45, s44, 16384
    buffer_load_dwordx4 v[72:75], v14, s[8:11], s45 offen sc1
    s_add_u32 s45, s44, 24576
    buffer_load_dwordx4 v[76:79], v14, s[8:11], s45 offen sc1
    s_add_u32 s45, s44, 32768
Ltour14:
    s_cbranch_execz Lmain
    buffer_load_dwordx4 v[80:83], v14, s[8:11], s45 offen sc1
    s_add_u32 s45, s44, 40960
    buffer_load_dwordx4 v[84:87], v14, s[8:11], s45 offen sc1
    s_add_u32 s45, s44, 49152
    buffer_load_dwordx4 v[88:91], v14, s[8:11], s45 offen sc1
    s_add_u32 s45, s44, 57344
    buffer_load_dwordx4 v[92:95], v14, s[8:11], s45 offen sc1
    s_add_u32 s45, s44, 65536
    buffer_load_dwordx4 v[96:99], v14, s[8:11], s45 offen sc1
    s_mov_b32 s45, 1152
    buffer_load_dword v16, v15, s[24:27], s45 offen sc1
    buffer_load_dword v17, v15, s[24:27], 0 offen sc1
    s_sub_u32 s48, s48, 1
    s_cbranch_scc1 Ltail_goty
    s_waitcnt vmcnt(10)
    v_max3_u32 v26, v64, v65, v66
    s_waitcnt vmcnt(9)
    v_max3_u32 v26, v26, v67, v68
    v_max3_u32 v26, v26, v69, v70
    s_waitcnt vmcnt(8)
    v_max3_u32 v26, v26, v71, v72
    v_max3_u32 v26, v26, v73, v74
    s_waitcnt vmcnt(7)
    v_max3_u32 v26, v26, v75, v76
    v_max3_u32 v26, v26, v77, v78
    s_waitcnt vmcnt(6)
    v_max3_u32 v26, v26, v79, v80
    v_max3_u32 v26, v26, v81, v82
    s_waitcnt vmcnt(5)
    v_max3_u32 v26, v26, v83, v84
    v_max3_u32 v26, v26, v85, v86
    s_waitcnt vmcnt(4)
    v_max3_u32 v26, v26, v87, v88
    v_max3_u32 v26, v26, v89, v90
    s_waitcnt vmcnt(3)
    v_max3_u32 v26, v26, v91, v92
    v_max3_u32 v26, v26, v93, v94
    s_waitcnt vmcnt(2)
    v_max3_u32 v26, v26, v95, v96
    v_max3_u32 v26, v26, v97, v98
    v_max_u32 v26, v26, v99
    s_waitcnt vmcnt(0)
    v_max3_u32 v26, v26, v16, v17
    v_cmp_eq_u32 vcc, -1, v26
    s_cbranch_vccnz Ltail_polly
Ltail_goty:
    s_waitcnt vmcnt(0) lgkmcnt(0)
    v_lshlrev_b32 v20, 16, v16
    v_and_b32 v21, 0xffff0000, v16
    v_lshlrev_b32 v22, 16, v17
    v_and_b32 v23, 0xffff0000, v17
    v_pk_add_f32 v[64:65], v[64:65], v[68:69]
    v_pk_add_f32 v[66:67], v[66:67], v[70:71]
    v_pk_add_f32 v[64:65], v[64:65], v[72:73]
    v_pk_add_f32 v[66:67], v[66:67], v[74:75]
    v_pk_add_f32 v[64:65], v[64:65], v[76:77]
    v_pk_add_f32 v[66:67], v[66:67], v[78:79]
    v_pk_add_f32 v[64:65], v[64:65], v[80:81]
    v_pk_add_f32 v[66:67], v[66:67], v[82:83]
    v_pk_add_f32 v[64:65], v[64:65], v[84:85]
    v_pk_add_f32 v[66:67], v[66:67], v[86:87]
    v_pk_add_f32 v[64:65], v[64:65], v[88:89]
    v_pk_add_f32 v[66:67], v[66:67], v[90:91]
    v_pk_add_f32 v[64:65], v[64:65], v[92:93]
    v_pk_add_f32 v[66:67], v[66:67], v[94:95]
    v_pk_add_f32 v[64:65], v[64:65], v[96:97]
    v_pk_add_f32 v[66:67], v[66:67], v[98:99]
    s_nop 0
    v_add_f32_dpp v64, v64, v64 row_ror:4 row_mask:0xf bank_mask:0xf
    v_add_f32_dpp v65, v65, v65 row_ror:4 row_mask:0xf bank_mask:0xf
    v_add_f32_dpp v66, v66, v66 row_ror:4 row_mask:0xf bank_mask:0xf
    v_add_f32_dpp v67, v67, v67 row_ror:4 row_mask:0xf bank_mask:0xf
    v_add_f32_dpp v64, v64, v64 row_ror:8 row_mask:0xf bank_mask:0xf
    v_add_f32_dpp v65, v65, v65 row_ror:8 row_mask:0xf bank_mask:0xf
    v_add_f32_dpp v66, v66, v66 row_ror:8 row_mask:0xf bank_mask:0xf
    v_add_f32_dpp v67, v67, v67 row_ror:8 row_mask:0xf bank_mask:0xf
    v_mov_b32 v68, v64
    v_mov_b32 v69, v65
    v_mov_b32 v70, v66
    v_mov_b32 v71, v67
    v_permlane16_swap_b32 v64, v68
    v_permlane16_swap_b32 v65, v69
    v_permlane16_swap_b32 v66, v70
    v_permlane16_swap_b32 v67, v71
    v_add_f32 v64, v64, v68
    v_add_f32 v65, v65, v69
    v_add_f32 v66, v66, v70
    v_add_f32 v67, v67, v71
    v_mov_b32 v68, v64
    v_mov_b32 v69, v65
    v_mov_b32 v70, v66
    v_mov_b32 v71, v67
    v_permlane32_swap_b32 v64, v68
    v_permlane32_swap_b32 v65, v69
    v_permlane32_swap_b32 v66, v70
    v_permlane32_swap_b32 v67, v71
    v_add_f32 v64, v64, v68
    v_add_f32 v65, v65, v69
    v_add_f32 v66, v66, v70
    v_add_f32 v67, v67, v71
    v_cndmask_b32 v26, v64, v65, s[38:39]
    v_cndmask_b32 v27, v66, v67, s[38:39]
    v_cvt_pk_bf16_f32 v28, v26, v27
    v_lshlrev_b32 v26, 16, v28
    v_and_b32 v27, 0xffff0000, v28
    v_mul_f32 v26, v26, v19
    v_mul_f32 v27, v27, v19
    v_cvt_pk_bf16_f32 v28, v26, v27
    v_lshlrev_b32 v26, 16, v28
    v_and_b32 v27, 0xffff0000, v28
    v_pk_add_f32 v[26:27], v[26:27], v[22:23]
    v_cvt_pk_bf16_f32 v28, v26, v27
    v_lshlrev_b32 v26, 16, v28
    v_and_b32 v27, 0xffff0000, v28
    v_pk_mul_f32 v[26:27], v[26:27], v[24:25]
    v_cvt_pk_bf16_f32 v28, v26, v27
    v_lshlrev_b32 v26, 16, v28
    v_and_b32 v27, 0xffff0000, v28
    v_pk_add_f32 v[26:27], v[26:27], v[20:21]
    v_cvt_pk_bf16_f32 v28, v26, v27
    s_mov_b64 exec, 0xff
    buffer_store_dword v28, v13, s[16:19], 0 offen nt
Ltail_done:
    s_endpgm
Lattn_wb:
    buffer_wbl2 sc1
    s_waitcnt vmcnt(0)
    s_branch Lattn_wbdone
Lattn_xspin:
Ltour15:
    s_cbranch_execz Lmain
    s_mov_b32 s37, 16384
Lattn_xloop:
    buffer_load_dword v11, v8, s[24:27], s54 offen offset:8 sc1
    s_waitcnt vmcnt(0)
    v_readfirstlane_b32 s36, v11
    s_sub_u32 s37, s37, 1
    s_cbranch_scc1 Lattn_xgot
    s_cmp_lg_u32 s36, s95
    s_cbranch_scc1 Lattn_xloop
    s_branch Lattn_xgot
Ltail_spin1:
Ltour16:
    s_cbranch_execz Lmain
    s_mov_b32 s48, 16384
Ltail_spinl1:
    buffer_load_dword v11, v9, s[24:27], s39 offen sc1
    s_waitcnt vmcnt(0)
    v_cmp_ne_u32 s[54:55], s95, v11
    s_sub_u32 s48, s48, 1
    s_cbranch_scc1 Ltail_got1
    s_cmp_lg_u64 s[54:55], 0
    s_cbranch_scc1 Ltail_spinl1
    s_branch Ltail_got1
Ltail_spin2:
Ltour17:
    s_cbranch_execz Lmain
    s_mov_b32 s48, 16384
Ltail_spinl2:
    buffer_load_dword v11, v9, s[24:27], s39 offen sc1
    s_waitcnt vmcnt(0)
    v_cmp_ne_u32 s[54:55], s95, v11
    s_sub_u32 s48, s48, 1
    s_cbranch_scc1 Ltail_got2
    s_cmp_lg_u64 s[54:55], 0
    s_cbranch_scc1 Ltail_spinl2
    s_branch Ltail_got2
Lattn_redo:
    v_xor_b32 v8, 64, v9
    v_xor_b32 v10, 64, v11
    s_waitcnt vmcnt(0) lgkmcnt(0)
    s_barrier
    v_mov_b32 v232, 0xff800000
    v_mov_b32 v233, 0xff800000
    v_mov_b32 v234, 0xff800000
    v_mov_b32 v235, 0xff800000
    s_mov_b32 s40, 0
    s_mov_b32 s48, -1
Lattn_redo_loop:
    s_add_u32 m0, s42, 0
    s_nop 0
    buffer_load_dwordx4 v36, s[8:11], s40 offen lds
    buffer_load_dwordx4 v37, s[8:11], s40 offen offset:1024 lds
    buffer_load_dwordx4 v38, s[8:11], s40 offen offset:2048 lds
    buffer_load_dwordx4 v39, s[8:11], s40 offen offset:3072 lds
    s_add_u32 s40, s40, 16384
    s_waitcnt vmcnt(0) lgkmcnt(0)
    s_barrier
    ds_read_b128 a[208:211], v8 offset:0
    ds_read_b128 a[212:215], v9 offset:0
    ds_read_b128 a[216:219], v10 offset:0
    ds_read_b128 a[220:223], v11 offset:0
    s_waitcnt lgkmcnt(3)
    v_mfma_f32_16x16x32_bf16 v[216:219], a[208:211], v[64:67], 0
    s_waitcnt lgkmcnt(2)
    v_mfma_f32_16x16x32_bf16 v[216:219], a[212:215], v[68:71], v[216:219]
    s_waitcnt lgkmcnt(1)
    v_mfma_f32_16x16x32_bf16 v[216:219], a[216:219], v[72:75], v[216:219]
    s_waitcnt lgkmcnt(0)
    v_mfma_f32_16x16x32_bf16 v[216:219], a[220:223], v[76:79], v[216:219]
    v_mfma_f32_16x16x32_bf16 v[220:223], a[208:211], v[80:83], 0
    v_mfma_f32_16x16x32_bf16 v[220:223], a[212:215], v[84:87], v[220:223]
    v_mfma_f32_16x16x32_bf16 v[220:223], a[216:219], v[88:91], v[220:223]
    v_mfma_f32_16x16x32_bf16 v[220:223], a[220:223], v[92:95], v[220:223]
    v_mfma_f32_16x16x32_bf16 v[224:227], a[208:211], v[96:99], 0
    v_mfma_f32_16x16x32_bf16 v[224:227], a[212:215], v[100:103], v[224:227]
    v_mfma_f32_16x16x32_bf16 v[224:227], a[216:219], v[104:107], v[224:227]
    v_mfma_f32_16x16x32_bf16 v[224:227], a[220:223], v[108:111], v[224:227]
    v_mfma_f32_16x16x32_bf16 v[228:231], a[208:211], v[112:115], 0
    v_mfma_f32_16x16x32_bf16 v[228:231], a[212:215], v[116:119], v[228:231]
    v_mfma_f32_16x16x32_bf16 v[228:231], a[216:219], v[120:123], v[228:231]
    v_mfma_f32_16x16x32_bf16 v[228:231], a[220:223], v[124:127], v[228:231]
    v_max3_f32 v232, v232, v216, v217
    v_max3_f32 v232, v232, v218, v219
    v_max3_f32 v233, v233, v220, v221
    v_max3_f32 v233, v233, v222, v223
    v_max3_f32 v234, v234, v224, v225
    v_max3_f32 v234, v234, v226, v227
    s_nop 1
    v_max3_f32 v235, v235, v228, v229
    v_max3_f32 v235, v235, v230, v231
    ds_read_b128 a[224:227], v8 offset:4096
    ds_read_b128 a[228:231], v9 offset:4096
    ds_read_b128 a[232:235], v10 offset:4096
    ds_read_b128 a[236:239], v11 offset:4096
    s_waitcnt lgkmcnt(3)
    v_mfma_f32_16x16x32_bf16 v[216:219], a[224:227], v[64:67], 0
    s_waitcnt lgkmcnt(2)
    v_mfma_f32_16x16x32_bf16 v[216:219], a[228:231], v[68:71], v[216:219]
    s_waitcnt lgkmcnt(1)
    v_mfma_f32_16x16x32_bf16 v[216:219], a[232:235], v[72:75], v[216:219]
    s_waitcnt lgkmcnt(0)
    v_mfma_f32_16x16x32_bf16 v[216:219], a[236:239], v[76:79], v[216:219]
    v_mfma_f32_16x16x32_bf16 v[220:223], a[224:227], v[80:83], 0
    v_mfma_f32_16x16x32_bf16 v[220:223], a[228:231], v[84:87], v[220:223]
    v_mfma_f32_16x16x32_bf16 v[220:223], a[232:235], v[88:91], v[220:223]
    v_mfma_f32_16x16x32_bf16 v[220:223], a[236:239], v[92:95], v[220:223]
    v_mfma_f32_16x16x32_bf16 v[224:227], a[224:227], v[96:99], 0
    v_mfma_f32_16x16x32_bf16 v[224:227], a[228:231], v[100:103], v[224:227]
    v_mfma_f32_16x16x32_bf16 v[224:227], a[232:235], v[104:107], v[224:227]
    v_mfma_f32_16x16x32_bf16 v[224:227], a[236:239], v[108:111], v[224:227]
    v_mfma_f32_16x16x32_bf16 v[228:231], a[224:227], v[112:115], 0
    v_mfma_f32_16x16x32_bf16 v[228:231], a[228:231], v[116:119], v[228:231]
    v_mfma_f32_16x16x32_bf16 v[228:231], a[232:235], v[120:123], v[228:231]
    v_mfma_f32_16x16x32_bf16 v[228:231], a[236:239], v[124:127], v[228:231]
    v_max3_f32 v232, v232, v216, v217
    v_max3_f32 v232, v232, v218, v219
    v_max3_f32 v233, v233, v220, v221
    v_max3_f32 v233, v233, v222, v223
    v_max3_f32 v234, v234, v224, v225
    v_max3_f32 v234, v234, v226, v227
    s_nop 1
    v_max3_f32 v235, v235, v228, v229
    v_max3_f32 v235, v235, v230, v231
    ds_read_b128 a[208:211], v8 offset:8192
    ds_read_b128 a[212:215], v9 offset:8192
    ds_read_b128 a[216:219], v10 offset:8192
    ds_read_b128 a[220:223], v11 offset:8192
    s_waitcnt lgkmcnt(3)
    v_mfma_f32_16x16x32_bf16 v[216:219], a[208:211], v[64:67], 0
    s_waitcnt lgkmcnt(2)
    v_mfma_f32_16x16x32_bf16 v[216:219], a[212:215], v[68:71], v[216:219]
    s_waitcnt lgkmcnt(1)
    v_mfma_f32_16x16x32_bf16 v[216:219], a[216:219], v[72:75], v[216:219]
    s_waitcnt lgkmcnt(0)
    v_mfma_f32_16x16x32_bf16 v[216:219], a[220:223], v[76:79], v[216:219]
    v_mfma_f32_16x16x32_bf16 v[220:223], a[208:211], v[80:83], 0
    v_mfma_f32_16x16x32_bf16 v[220:223], a[212:215], v[84:87], v[220:223]
    v_mfma_f32_16x16x32_bf16 v[220:223], a[216:219], v[88:91], v[220:223]
    v_mfma_f32_16x16x32_bf16 v[220:223], a[220:223], v[92:95], v[220:223]
    v_mfma_f32_16x16x32_bf16 v[224:227], a[208:211], v[96:99], 0
    v_mfma_f32_16x16x32_bf16 v[224:227], a[212:215], v[100:103], v[224:227]
    v_mfma_f32_16x16x32_bf16 v[224:227], a[216:219], v[104:107], v[224:227]
    v_mfma_f32_16x16x32_bf16 v[224:227], a[220:223], v[108:111], v[224:227]
    v_mfma_f32_16x16x32_bf16 v[228:231], a[208:211], v[112:115], 0
    v_mfma_f32_16x16x32_bf16 v[228:231], a[212:215], v[116:119], v[228:231]
    v_mfma_f32_16x16x32_bf16 v[228:231], a[216:219], v[120:123], v[228:231]
    v_mfma_f32_16x16x32_bf16 v[228:231], a[220:223], v[124:127], v[228:231]
    v_max3_f32 v232, v232, v216, v217
    v_max3_f32 v232, v232, v218, v219
    v_max3_f32 v233, v233, v220, v221
    v_max3_f32 v233, v233, v222, v223
    v_max3_f32 v234, v234, v224, v225
    v_max3_f32 v234, v234, v226, v227
    s_nop 1
    v_max3_f32 v235, v235, v228, v229
    v_max3_f32 v235, v235, v230, v231
    ds_read_b128 a[224:227], v8 offset:12288
    ds_read_b128 a[228:231], v9 offset:12288
    ds_read_b128 a[232:235], v10 offset:12288
    ds_read_b128 a[236:239], v11 offset:12288
    s_waitcnt lgkmcnt(3)
    v_mfma_f32_16x16x32_bf16 v[216:219], a[224:227], v[64:67], 0
    s_waitcnt lgkmcnt(2)
    v_mfma_f32_16x16x32_bf16 v[216:219], a[228:231], v[68:71], v[216:219]
    s_waitcnt lgkmcnt(1)
    v_mfma_f32_16x16x32_bf16 v[216:219], a[232:235], v[72:75], v[216:219]
    s_waitcnt lgkmcnt(0)
    v_mfma_f32_16x16x32_bf16 v[216:219], a[236:239], v[76:79], v[216:219]
    v_mfma_f32_16x16x32_bf16 v[220:223], a[224:227], v[80:83], 0
    v_mfma_f32_16x16x32_bf16 v[220:223], a[228:231], v[84:87], v[220:223]
    v_mfma_f32_16x16x32_bf16 v[220:223], a[232:235], v[88:91], v[220:223]
    v_mfma_f32_16x16x32_bf16 v[220:223], a[236:239], v[92:95], v[220:223]
    v_mfma_f32_16x16x32_bf16 v[224:227], a[224:227], v[96:99], 0
    v_mfma_f32_16x16x32_bf16 v[224:227], a[228:231], v[100:103], v[224:227]
    v_mfma_f32_16x16x32_bf16 v[224:227], a[232:235], v[104:107], v[224:227]
    v_mfma_f32_16x16x32_bf16 v[224:227], a[236:239], v[108:111], v[224:227]
    v_mfma_f32_16x16x32_bf16 v[228:231], a[224:227], v[112:115], 0
    v_mfma_f32_16x16x32_bf16 v[228:231], a[228:231], v[116:119], v[228:231]
    v_mfma_f32_16x16x32_bf16 v[228:231], a[232:235], v[120:123], v[228:231]
    v_mfma_f32_16x16x32_bf16 v[228:231], a[236:239], v[124:127], v[228:231]
    v_max3_f32 v232, v232, v216, v217
    v_max3_f32 v232, v232, v218, v219
    v_max3_f32 v233, v233, v220, v221
    v_max3_f32 v233, v233, v222, v223
    v_max3_f32 v234, v234, v224, v225
    v_max3_f32 v234, v234, v226, v227
    s_nop 1
    v_max3_f32 v235, v235, v228, v229
    v_max3_f32 v235, v235, v230, v231
    s_barrier
    s_cmp_lt_u32 s40, 524288
    s_cbranch_scc1 Lattn_redo_loop
    v_mov_b32 v236, v232
    v_mov_b32 v237, v233
    v_mov_b32 v238, v234
    v_mov_b32 v239, v235
    v_permlane16_swap_b32 v232, v236
    v_permlane16_swap_b32 v233, v237
    v_permlane16_swap_b32 v234, v238
    v_permlane16_swap_b32 v235, v239
    v_max_f32 v232, v232, v236
    v_max_f32 v233, v233, v237
    v_max_f32 v234, v234, v238
    v_max_f32 v235, v235, v239
    v_mov_b32 v236, v232
    v_mov_b32 v237, v233
    v_mov_b32 v238, v234
    v_mov_b32 v239, v235
    v_permlane32_swap_b32 v232, v236
    v_permlane32_swap_b32 v233, v237
    v_permlane32_swap_b32 v234, v238
    v_permlane32_swap_b32 v235, v239
    v_max_f32 v232, v232, v236
    v_max_f32 v233, v233, v237
    v_max_f32 v234, v234, v238
    v_max_f32 v235, v235, v239
    v_sub_f32 v192, 0, v232
    v_sub_f32 v193, 0, v232
    v_sub_f32 v194, 0, v232
    v_sub_f32 v195, 0, v232
    v_sub_f32 v196, 0, v233
    v_sub_f32 v197, 0, v233
    v_sub_f32 v198, 0, v233
    v_sub_f32 v199, 0, v233
    v_sub_f32 v200, 0, v234
    v_sub_f32 v201, 0, v234
    v_sub_f32 v202, 0, v234
    v_sub_f32 v203, 0, v234
    v_sub_f32 v204, 0, v235
    v_sub_f32 v205, 0, v235
    v_sub_f32 v206, 0, v235
    v_sub_f32 v207, 0, v235
    s_mov_b32 s40, 0
    s_mov_b32 s41, 0
    s_add_u32 m0, s42, 0
    s_nop 0
    buffer_load_dwordx4 v36, s[8:11], s40 offen lds
    buffer_load_dwordx4 v37, s[8:11], s40 offen offset:1024 lds
    buffer_load_dwordx4 v38, s[8:11], s40 offen offset:2048 lds
    buffer_load_dwordx4 v39, s[8:11], s40 offen offset:3072 lds
    s_add_u32 s40, s40, 16384
    s_add_u32 m0, s42, 16384
    s_nop 0
    buffer_load_dwordx4 v36, s[8:11], s40 offen lds
    buffer_load_dwordx4 v37, s[8:11], s40 offen offset:1024 lds
    buffer_load_dwordx4 v38, s[8:11], s40 offen offset:2048 lds
    buffer_load_dwordx4 v39, s[8:11], s40 offen offset:3072 lds
    s_add_u32 s40, s40, 16384
    s_add_u32 m0, s42, 32768
    s_nop 0
    buffer_load_dwordx4 v36, s[8:11], s40 offen lds
    buffer_load_dwordx4 v37, s[8:11], s40 offen offset:1024 lds
    buffer_load_dwordx4 v38, s[8:11], s40 offen offset:2048 lds
    buffer_load_dwordx4 v39, s[8:11], s40 offen offset:3072 lds
    s_add_u32 s40, s40, 16384
    s_add_u32 m0, s42, 65536
    s_nop 0
    buffer_load_dwordx4 v40, s[12:15], s41 offen lds
    buffer_load_dwordx4 v41, s[12:15], s41 offen offset:1024 lds
    buffer_load_dwordx4 v40, s[12:15], s41 offen offset:2048 lds
    buffer_load_dwordx4 v41, s[12:15], s41 offen offset:3072 lds
    s_add_u32 s41, s41, 16384
    s_add_u32 m0, s42, 81920
    s_nop 0
    buffer_load_dwordx4 v40, s[12:15], s41 offen lds
    buffer_load_dwordx4 v41, s[12:15], s41 offen offset:1024 lds
    buffer_load_dwordx4 v40, s[12:15], s41 offen offset:2048 lds
    buffer_load_dwordx4 v41, s[12:15], s41 offen offset:3072 lds
    s_add_u32 s41, s41, 16384
    v_accvgpr_write_b32 a0, 0
    v_accvgpr_write_b32 a1, 0
    v_accvgpr_write_b32 a2, 0
    v_accvgpr_write_b32 a3, 0
    v_accvgpr_write_b32 a4, 0
    v_accvgpr_write_b32 a5, 0
    v_accvgpr_write_b32 a6, 0
    v_accvgpr_write_b32 a7, 0
    v_accvgpr_write_b32 a8, 0
    v_accvgpr_write_b32 a9, 0
    v_accvgpr_write_b32 a10, 0
    v_accvgpr_write_b32 a11, 0
    v_accvgpr_write_b32 a12, 0
    v_accvgpr_write_b32 a13, 0
    v_accvgpr_write_b32 a14, 0
    v_accvgpr_write_b32 a15, 0
    v_accvgpr_write_b32 a16, 0
    v_accvgpr_write_b32 a17, 0
    v_accvgpr_write_b32 a18, 0
    v_accvgpr_write_b32 a19, 0
    v_accvgpr_write_b32 a20, 0
    v_accvgpr_write_b32 a21, 0
    v_accvgpr_write_b32 a22, 0
    v_accvgpr_write_b32 a23, 0
    v_accvgpr_write_b32 a24, 0
    v_accvgpr_write_b32 a25, 0
    v_accvgpr_write_b32 a26, 0
    v_accvgpr_write_b32 a27, 0
    v_accvgpr_write_b32 a28, 0
    v_accvgpr_write_b32 a29, 0
    v_accvgpr_write_b32 a30, 0
    v_accvgpr_write_b32 a31, 0
    v_accvgpr_write_b32 a32, 0
    v_accvgpr_write_b32 a33, 0
    v_accvgpr_write_b32 a34, 0
    v_accvgpr_write_b32 a35, 0
    v_accvgpr_write_b32 a36, 0
    v_accvgpr_write_b32 a37, 0
    v_accvgpr_write_b32 a38, 0
    v_accvgpr_write_b32 a39, 0
    v_accvgpr_write_b32 a40, 0
    v_accvgpr_write_b32 a41, 0
    v_accvgpr_write_b32 a42, 0
    v_accvgpr_write_b32 a43, 0
    v_accvgpr_write_b32 a44, 0
    v_accvgpr_write_b32 a45, 0
    v_accvgpr_write_b32 a46, 0
    v_accvgpr_write_b32 a47, 0
    v_accvgpr_write_b32 a48, 0
    v_accvgpr_write_b32 a49, 0
    v_accvgpr_write_b32 a50, 0
    v_accvgpr_write_b32 a51, 0
    v_accvgpr_write_b32 a52, 0
    v_accvgpr_write_b32 a53, 0
    v_accvgpr_write_b32 a54, 0
    v_accvgpr_write_b32 a55, 0
    v_accvgpr_write_b32 a56, 0
    v_accvgpr_write_b32 a57, 0
    v_accvgpr_write_b32 a58, 0
    v_accvgpr_write_b32 a59, 0
    v_accvgpr_write_b32 a60, 0
    v_accvgpr_write_b32 a61, 0
    v_accvgpr_write_b32 a62, 0
    v_accvgpr_write_b32 a63, 0
    v_accvgpr_write_b32 a64, 0
    v_accvgpr_write_b32 a65, 0
    v_accvgpr_write_b32 a66, 0
    v_accvgpr_write_b32 a67, 0
    v_accvgpr_write_b32 a68, 0
    v_accvgpr_write_b32 a69, 0
    v_accvgpr_write_b32 a70, 0
    v_accvgpr_write_b32 a71, 0
    v_accvgpr_write_b32 a72, 0
    v_accvgpr_write_b32 a73, 0
    v_accvgpr_write_b32 a74, 0
    v_accvgpr_write_b32 a75, 0
    v_accvgpr_write_b32 a76, 0
    v_accvgpr_write_b32 a77, 0
    v_accvgpr_write_b32 a78, 0
    v_accvgpr_write_b32 a79, 0
    v_accvgpr_write_b32 a80, 0
    v_accvgpr_write_b32 a81, 0
    v_accvgpr_write_b32 a82, 0
    v_accvgpr_write_b32 a83, 0
    v_accvgpr_write_b32 a84, 0
    v_accvgpr_write_b32 a85, 0
    v_accvgpr_write_b32 a86, 0
    v_accvgpr_write_b32 a87, 0
    v_accvgpr_write_b32 a88, 0
    v_accvgpr_write_b32 a89, 0
    v_accvgpr_write_b32 a90, 0
    v_accvgpr_write_b32 a91, 0
    v_accvgpr_write_b32 a92, 0
    v_accvgpr_write_b32 a93, 0
    v_accvgpr_write_b32 a94, 0
    v_accvgpr_write_b32 a95, 0
    v_accvgpr_write_b32 a96, 0
    v_accvgpr_write_b32 a97, 0
    v_accvgpr_write_b32 a98, 0
    v_accvgpr_write_b32 a99, 0
    v_accvgpr_write_b32 a100, 0
    v_accvgpr_write_b32 a101, 0
    v_accvgpr_write_b32 a102, 0
    v_accvgpr_write_b32 a103, 0
    v_accvgpr_write_b32 a104, 0
    v_accvgpr_write_b32 a105, 0
    v_accvgpr_write_b32 a106, 0
    v_accvgpr_write_b32 a107, 0
    v_accvgpr_write_b32 a108, 0
    v_accvgpr_write_b32 a109, 0
    v_accvgpr_write_b32 a110, 0
    v_accvgpr_write_b32 a111, 0
    v_accvgpr_write_b32 a112, 0
    v_accvgpr_write_b32 a113, 0
    v_accvgpr_write_b32 a114, 0
    v_accvgpr_write_b32 a115, 0
    v_accvgpr_write_b32 a116, 0
    v_accvgpr_write_b32 a117, 0
    v_accvgpr_write_b32 a118, 0
    v_accvgpr_write_b32 a119, 0
    v_accvgpr_write_b32 a120, 0
    v_accvgpr_write_b32 a121, 0
    v_accvgpr_write_b32 a122, 0
    v_accvgpr_write_b32 a123, 0
    v_accvgpr_write_b32 a124, 0
    v_accvgpr_write_b32 a125, 0
    v_accvgpr_write_b32 a126, 0
    v_accvgpr_write_b32 a127, 0
    v_accvgpr_write_b32 a192, 0
    v_accvgpr_write_b32 a193, 0
    v_accvgpr_write_b32 a194, 0
    v_accvgpr_write_b32 a195, 0
    v_accvgpr_write_b32 a196, 0
    v_accvgpr_write_b32 a197, 0
    v_accvgpr_write_b32 a198, 0
    v_accvgpr_write_b32 a199, 0
    v_accvgpr_write_b32 a200, 0
    v_accvgpr_write_b32 a201, 0
    v_accvgpr_write_b32 a202, 0
    v_accvgpr_write_b32 a203, 0
    v_accvgpr_write_b32 a204, 0
    v_accvgpr_write_b32 a205, 0
    v_accvgpr_write_b32 a206, 0
    v_accvgpr_write_b32 a207, 0
    s_waitcnt vmcnt(0) lgkmcnt(0)
    s_barrier
    ds_read_b128 a[208:211], v8 offset:0
    ds_read_b128 a[212:215], v9 offset:0
    ds_read_b128 a[216:219], v10 offset:0
    ds_read_b128 a[220:223], v11 offset:0
    ds_read_b128 a[224:227], v8 offset:4096
    s_waitcnt vmcnt(0) lgkmcnt(0)
    s_branch Lattn_stage0
Lattn_armwait:
    s_mov_b32 s36, 16384
Lattn_armloop:
    v_mov_b32 v63, 0
    buffer_load_dword v63, v63, s[88:91], 0 offen sc1
    s_waitcnt vmcnt(0)
    v_readfirstlane_b32 s37, v63
    s_sub_u32 s36, s36, 1
    s_cbranch_scc1 Lattn_armed
    s_cmp_lt_u32 s37, 256
    s_cbranch_scc1 Lattn_armloop
    s_branch Lattn_armed
Lattn_end:
    s_endpgm
.section .rodata,"a"
.p2align 6
.amdhsa_kernel adaLN_cond__gqa_block_cached__moe_arch_mod__prompt_kernel
  .amdhsa_next_free_vgpr 512
  .amdhsa_next_free_sgpr 102
  .amdhsa_accum_offset 256
  .amdhsa_group_segment_fixed_size 0
  .amdhsa_kernarg_size 120
  .amdhsa_user_sgpr_count 2
  .amdhsa_user_sgpr_kernarg_segment_ptr 1
  .amdhsa_system_sgpr_workgroup_id_x 1
  .amdhsa_float_denorm_mode_32 3
.end_amdhsa_kernel
```

```asm
; @launch grid=(256,1,1) block=(256,1,1) lds=163840
.amdgcn_target "amdgcn-amd-amdhsa--gfx950"
.text
.globl adaLN_cond__gqa_block_cached__moe_arch_mod__prompt_kernel
.p2align 8
.type adaLN_cond__gqa_block_cached__moe_arch_mod__prompt_kernel,@function
adaLN_cond__gqa_block_cached__moe_arch_mod__prompt_kernel:
    s_cmp_ge_u32 s2, 256
    s_cbranch_scc1 Lattn_end
    s_load_dwordx2 s[8:9], s[0:1], 80
    s_load_dwordx2 s[12:13], s[0:1], 88
    s_load_dwordx2 s[20:21], s[0:1], 0
    s_load_dwordx2 s[50:51], s[0:1], 112
    s_load_dwordx8 s[52:59], s[0:1], 8
    s_load_dwordx4 s[80:83], s[0:1], 56
    s_load_dwordx2 s[84:85], s[0:1], 72
    s_load_dwordx2 s[88:89], s[0:1], 104
    s_load_dwordx2 s[28:29], s[0:1], 48
    s_getpc_b64 s[32:33]
Lattn_pc:
    s_mov_b32 s34, Lattn_end-Lattn_pc
    s_mov_b32 s35, 0x20000
    s_lshr_b32 s6, s2, 3
    s_lshl_b32 s7, s6, 6
    v_lshrrev_b32 v3, 6, v0
    v_and_b32 v1, 63, v0
    v_lshrrev_b32 v2, 2, v0
    v_lshlrev_b32 v2, 11, v2
    v_readfirstlane_b32 s3, v3
    buffer_load_dword v240, v2, s[32:35], s7 offen
    s_and_b32 s7, s2, 7
    s_lshl_b32 s4, s7, 1
    s_and_b32 s5, s6, 1
    s_add_u32 s4, s4, s5
    s_lshr_b32 s5, s2, 4
    s_lshr_b32 s38, s6, 2
    s_lshl_b32 s38, s38, 3
    s_add_u32 s38, s38, s7
    s_cmp_lt_u32 s38, 18
    s_cselect_b32 s39, 0, 2147483648
    s_lshl_b32 s38, s38, 2
    s_and_b32 s36, s6, 3
    s_add_u32 s38, s38, s36
    s_mov_b32 s14, 3981312
    s_mul_i32 s92, s6, 124416
    s_lshl_b32 s36, s7, 7
    s_add_u32 s92, s92, s36
    s_cmp_lt_u32 s7, 2
    s_cselect_b32 s36, 53, 35
    v_lshrrev_b32 v2, 2, v0
    v_min_u32 v2, s36, v2
    v_mul_u32_u24 v3, 57, v2
    v_lshrrev_b32 v3, 10, v3
    v_mul_i32_i24 v3, -123392, v3
    v_mul_u32_u24 v2, 6912, v2
    v_add_u32 v72, v2, v3
    s_mov_b32 s15, 0x20000
    s_mov_b32 s10, 1152
    s_mov_b32 s11, 0x20000
    s_mov_b32 s22, 2359296
    s_mov_b32 s23, 0x20000
    v_and_b32 v64, 0xfe, v0
    v_mul_u32_u24 v65, 3456, v64
    v_and_b32 v2, 1, v0
    v_lshl_add_u32 v65, v2, 4, v65
    s_lshl_b32 s36, s38, 5
    s_or_b32 s36, s36, s39
    v_and_b32 v4, 31, v1
    v_lshrrev_b32 v5, 5, v1
    v_cmp_gt_u32 vcc, 24, v4
    v_mov_b32 v6, 2147483648
    s_lshl_b32 s7, s5, 4
    s_add_u32 s7, s7, s4
    s_lshl_b32 s7, s7, 2
    s_add_u32 s7, s7, s3
    v_cndmask_b32 v6, v6, 0, vcc
    s_mul_i32 s49, s7, 2304
    v_lshrrev_b32 v7, 2, v4
    v_lshl_add_u32 v7, v7, 6, v6
    v_and_b32 v2, 3, v4
    v_lshl_add_u32 v7, v2, 3, v7
    v_mul_u32_u24 v2, 1152, v5
    v_add_u32 v66, v7, v2
    s_waitcnt lgkmcnt(0)
    s_load_dword s94, s[50:51], 24576
    buffer_load_dword v241, v72, s[12:15], s92 offen
    buffer_load_ushort v80, v64, s[8:11], 0 offen offset:0
    buffer_load_ushort v81, v64, s[8:11], 0 offen offset:256
    buffer_load_ushort v82, v64, s[8:11], 0 offen offset:512
    buffer_load_ushort v83, v64, s[8:11], 0 offen offset:768
    buffer_load_ushort v84, v64, s[8:11], 0 offen offset:1024
    buffer_load_dwordx4 v[88:91], v65, s[12:15], s36 offen
    s_add_u32 s36, s36, 884736
    buffer_load_dwordx4 v[92:95], v65, s[12:15], s36 offen
    s_add_u32 s36, s36, 884736
    buffer_load_dwordx4 v[96:99], v65, s[12:15], s36 offen
    s_add_u32 s36, s36, 884736
    buffer_load_dwordx4 v[100:103], v65, s[12:15], s36 offen
    s_add_u32 s36, s36, 884736
    buffer_load_dwordx4 v[104:107], v65, s[12:15], s36 offen
    s_mov_b32 s16, s56
    s_mov_b32 s17, s57
    s_mov_b32 s18, 4718592
    s_mov_b32 s19, 0x20000
    s_lshl_b32 s44, s4, 9
    s_mul_i32 s36, s5, 98304
    s_add_u32 s36, s36, 0
    v_lshrrev_b32 v2, 2, v0
    v_min_u32 v2, 47, v2
    v_lshrrev_b32 v3, 2, v2
    v_and_b32 v2, 3, v2
    v_lshl_add_u32 v2, v2, 7, s36
    v_lshl_add_u32 v71, v3, 13, v2
    s_mul_i32 s36, s5, 196608
    s_add_u32 s36, s36, 1572864
    v_lshrrev_b32 v2, 1, v0
    v_min_u32 v2, 95, v2
    v_lshrrev_b32 v3, 2, v2
    v_and_b32 v2, 3, v2
    v_lshl_add_u32 v2, v2, 7, s36
    v_lshl_add_u32 v70, v3, 13, v2
    s_add_u32 s92, s49, 65536
    v_lshl_add_u32 v7, v5, 4, v6
    v_lshl_add_u32 v67, v4, 5, v7
    v_min_u32 v4, 23, v4
    v_lshlrev_b32 v68, 4, v4
    s_mov_b32 s24, s50
    s_mov_b32 s25, s51
    s_mov_b32 s26, 10485760
    s_mov_b32 s27, 0x20000
    s_mov_b32 s90, 256
    s_mov_b32 s91, 0x20000
    s_cmp_ge_u32 s38, 36
    s_cselect_b32 s93, 1.0, 0
    s_lshl_b32 s36, s38, 7
    v_lshl_add_u32 v69, v0, 3, s36
    v_cmp_gt_u32 s[36:37], 16, v0
    v_mov_b32 v2, 2147483648
    v_mov_b32 v3, s39
    v_cndmask_b32 v2, v2, v3, s[36:37]
    v_or_b32 v69, v69, v2
    s_mul_i32 s36, s5, 3072
    s_lshl_b32 s37, s5, 11
    v_lshrrev_b32 v120, 3, v0
    v_min_u32 v120, 23, v120
    v_lshl_add_u32 v120, v120, 7, s36
    v_lshrrev_b32 v121, 4, v0
    v_lshl_add_u32 v121, v121, 7, s37
    s_lshl_b32 s42, s3, 12
    v_lshrrev_b32 v2, 4, v1
    v_and_b32 v3, 15, v1
    v_lshrrev_b32 v5, 1, v3
    v_mul_u32_u24 v5, 2304, v5
    v_lshl_add_u32 v5, v2, 5, v5
    v_and_b32 v6, 1, v3
    v_lshl_add_u32 v51, v6, 4, v5
    s_lshl_b32 s6, s5, 2
    s_add_u32 s6, s6, s3
    s_mul_i32 s46, s6, 36864
    s_add_u32 s46, s46, 65536
    s_add_u32 s43, s46, 18432
    s_mul_i32 s45, s4, 294912
    s_lshl_b32 s7, s3, 4
    v_add_u32 v4, s7, v2
    v_lshlrev_b32 v5, 1, v2
    v_xor_b32 v5, v5, v3
    v_xor_b32 v6, 8, v5
    v_lshlrev_b32 v7, 13, v4
    v_lshl_add_u32 v42, v5, 4, v7
    v_lshl_add_u32 v43, v6, 4, v7
    v_add_u32 v44, 63488, v42
    v_add_u32 v45, 95232, v43
    v_add_u32 v43, 31744, v43
    s_lshl_b32 s7, s4, 19
    s_add_u32 s8, s52, s7
    s_addc_u32 s9, s53, 0
    s_mov_b32 s10, 524288
    s_mov_b32 s11, 0x20000
    s_add_u32 s12, s54, s7
    s_addc_u32 s13, s55, 0
    s_mov_b32 s14, 524288
    s_mov_b32 s15, 0x20000
    s_add_u32 s28, s50, 10485760
    s_addc_u32 s29, s51, 0
    s_mov_b32 s30, 37748736
    s_mov_b32 s31, 0x20000
    v_lshlrev_b32 v7, 8, v4
    v_lshl_add_u32 v40, v5, 4, v7
    v_lshl_add_u32 v41, v6, 4, v7
    v_xor_b32 v224, v3, v2
    v_lshl_add_u32 v36, v224, 4, v7
    v_xor_b32 v37, 64, v36
    v_xor_b32 v38, 128, v36
    v_xor_b32 v39, 192, v36
    v_lshrrev_b32 v7, 3, v5
    v_lshl_add_u32 v7, v7, 7, v4
    v_mul_u32_u24 v7, 1152, v7
    v_and_b32 v225, 7, v5
    v_lshl_add_u32 v46, v225, 4, v7
    v_lshrrev_b32 v7, 3, v6
    v_lshl_add_u32 v7, v7, 7, v4
    v_mul_u32_u24 v7, 1152, v7
    v_and_b32 v225, 7, v6
    v_lshl_add_u32 v47, v225, 4, v7
    v_add_u32 v48, 7168, v46
    v_add_u32 v49, 10752, v47
    v_add_u32 v47, 3584, v47
    v_lshlrev_b32 v7, 8, v3
    v_lshl_add_u32 v8, v224, 4, v7
    v_xor_b32 v9, 64, v8
    v_xor_b32 v10, 128, v8
    v_xor_b32 v11, 192, v8
    v_lshrrev_b32 v5, 2, v1
    v_and_b32 v6, 7, v5
    v_lshlrev_b32 v6, 5, v6
    v_lshl_add_u32 v6, v5, 8, v6
    v_and_b32 v7, 3, v1
    v_lshl_add_u32 v12, v7, 3, v6
    v_xor_b32 v13, 32, v12
    v_xor_b32 v14, 64, v12
    v_xor_b32 v15, 96, v12
    v_xor_b32 v16, 128, v12
    v_xor_b32 v17, 160, v12
    v_xor_b32 v18, 192, v12
    v_xor_b32 v19, 224, v12
    v_add_u32 v20, 65536, v12
    v_add_u32 v21, 65536, v13
    v_add_u32 v22, 65536, v14
    v_add_u32 v23, 65536, v15
    v_add_u32 v24, 65536, v16
    v_add_u32 v25, 65536, v17
    v_add_u32 v26, 65536, v18
    v_add_u32 v27, 65536, v19
    v_add_u32 v28, 131072, v12
    v_add_u32 v29, 131072, v13
    v_add_u32 v30, 131072, v14
    v_add_u32 v31, 131072, v15
    v_add_u32 v32, 131072, v16
    v_add_u32 v33, 131072, v17
    v_add_u32 v34, 131072, v18
    v_add_u32 v35, 131072, v19
    v_mov_b32 v52, 0x3f803f80
    v_mov_b32 v53, 0x3f803f80
    v_mov_b32 v54, 0x3f803f80
    v_mov_b32 v55, 0x3f803f80
    v_and_b32 v5, 1, v1
    v_mul_u32_u24 v5, 0xaaaa, v5
    v_add_u32 v5, 0x4444, v5
    v_lshl_add_u32 v50, v5, 16, v5
    v_lshrrev_b32 v5, 1, v3
    v_mul_u32_u24 v5, 20480, v5
    v_lshl_add_u32 v5, v2, 5, v5
    v_and_b32 v6, 1, v3
    v_lshl_add_u32 v56, v6, 4, v5
    s_mul_i32 s47, s6, 327680
    s_mov_b32 s32, s82
    s_mov_b32 s33, s83
    s_mov_b32 s34, 5308416
    s_mov_b32 s35, 0x20000
    s_mov_b32 s82, 5308416
    s_mov_b32 s83, 0x20000
    s_mov_b32 s86, 5308416
    s_mov_b32 s87, 0x20000
    s_lshr_b32 s7, s2, 3
    s_mul_i32 s7, s7, 18
    s_add_u32 s7, s7, s3
    s_and_b32 s36, s2, 7
    s_mul_i32 s37, s36, 576
    s_add_u32 s37, s37, s7
    s_mul_i32 s37, s37, 1152
    s_mul_i32 s7, s7, 9216
    s_mul_i32 s36, s36, 1152
    s_add_u32 s7, s7, s36
    v_min_u32 v5, 17, v1
    v_lshl_add_u32 v57, v5, 6, s7
    v_lshl_add_u32 v62, v5, 6, s37
    s_mov_b32 s40, 0
    s_mov_b32 s41, 0
    s_mov_b32 s48, 0
    s_waitcnt vmcnt(9)
    v_lshlrev_b32 v80, 16, v80
    s_waitcnt vmcnt(8)
    v_lshlrev_b32 v81, 16, v81
    s_waitcnt vmcnt(7)
    v_lshlrev_b32 v82, 16, v82
    s_waitcnt vmcnt(6)
    v_lshlrev_b32 v83, 16, v83
    s_waitcnt vmcnt(5)
    v_lshlrev_b32 v84, 16, v84
    v_mul_f32 v144, 0xbfb8aa3b, v80
    v_mul_f32 v148, 0xbfb8aa3b, v81
    v_mul_f32 v152, 0xbfb8aa3b, v82
    v_mul_f32 v156, 0xbfb8aa3b, v83
    v_mul_f32 v160, 0xbfb8aa3b, v84
    v_min_f32 v144, 0x42fc0000, v144
    v_min_f32 v148, 0x42fc0000, v148
    v_min_f32 v152, 0x42fc0000, v152
    v_min_f32 v156, 0x42fc0000, v156
    v_min_f32 v160, 0x42fc0000, v160
    v_exp_f32 v144, v144
    v_exp_f32 v148, v148
    v_exp_f32 v152, v152
    v_exp_f32 v156, v156
    v_exp_f32 v160, v160
    v_add_f32 v144, 1.0, v144
    v_add_f32 v148, 1.0, v148
    v_add_f32 v152, 1.0, v152
    v_add_f32 v156, 1.0, v156
    v_add_f32 v160, 1.0, v160
    v_rcp_f32 v145, v144
    v_rcp_f32 v149, v148
    v_rcp_f32 v153, v152
    v_rcp_f32 v157, v156
    v_rcp_f32 v161, v160
    v_mul_f32 v146, v80, v145
    v_mul_f32 v150, v81, v149
    v_mul_f32 v154, v82, v153
    v_mul_f32 v158, v83, v157
    v_mul_f32 v162, v84, v161
    v_fma_f32 v144, -v146, v144, v80
    v_fma_f32 v148, -v150, v148, v81
    v_fma_f32 v152, -v154, v152, v82
    v_fma_f32 v156, -v158, v156, v83
    v_fma_f32 v160, -v162, v160, v84
    v_fma_f32 v80, v144, v145, v146
    v_fma_f32 v81, v148, v149, v150
    v_fma_f32 v82, v152, v153, v154
    v_fma_f32 v83, v156, v157, v158
    v_fma_f32 v84, v160, v161, v162
    v_cvt_pk_bf16_f32 v80, v80, v80
    v_cvt_pk_bf16_f32 v81, v81, v81
    v_cvt_pk_bf16_f32 v82, v82, v82
    v_cvt_pk_bf16_f32 v83, v83, v83
    v_cvt_pk_bf16_f32 v84, v84, v84
    v_and_b32 v80, 0xffff0000, v80
    v_and_b32 v81, 0xffff0000, v81
    v_and_b32 v82, 0xffff0000, v82
    v_and_b32 v83, 0xffff0000, v83
    v_and_b32 v84, 0xffff0000, v84
    buffer_load_dwordx2 v[108:109], v66, s[20:23], s49 offen offset:0
    buffer_load_dwordx2 v[110:111], v66, s[20:23], s49 offen offset:32
    buffer_load_dwordx2 v[112:113], v66, s[20:23], s49 offen offset:384
    buffer_load_dwordx2 v[114:115], v66, s[20:23], s49 offen offset:416
    buffer_load_dwordx2 v[116:117], v66, s[20:23], s49 offen offset:768
    buffer_load_dwordx2 v[118:119], v66, s[20:23], s49 offen offset:800
    s_mov_b32 s20, s58
    s_mov_b32 s21, s59
    s_mov_b32 s22, 4718592
    s_mov_b32 s23, 0x20000
    s_waitcnt vmcnt(10)
    v_lshlrev_b32 v136, 16, v88
    v_and_b32 v137, 0xffff0000, v88
    v_lshlrev_b32 v138, 16, v89
    v_and_b32 v139, 0xffff0000, v89
    v_lshlrev_b32 v140, 16, v90
    v_and_b32 v141, 0xffff0000, v90
    v_lshlrev_b32 v142, 16, v91
    v_and_b32 v143, 0xffff0000, v91
    v_pk_mul_f32 v[128:129], v[136:137], v[80:81] op_sel:[0,0] op_sel_hi:[1,0]
    v_pk_mul_f32 v[130:131], v[138:139], v[80:81] op_sel:[0,0] op_sel_hi:[1,0]
    v_pk_mul_f32 v[132:133], v[140:141], v[80:81] op_sel:[0,0] op_sel_hi:[1,0]
    v_pk_mul_f32 v[134:135], v[142:143], v[80:81] op_sel:[0,0] op_sel_hi:[1,0]
    s_waitcnt vmcnt(9)
    v_lshlrev_b32 v136, 16, v92
    v_and_b32 v137, 0xffff0000, v92
    v_lshlrev_b32 v138, 16, v93
    v_and_b32 v139, 0xffff0000, v93
    v_lshlrev_b32 v140, 16, v94
    v_and_b32 v141, 0xffff0000, v94
    v_lshlrev_b32 v142, 16, v95
    v_and_b32 v143, 0xffff0000, v95
    v_pk_fma_f32 v[128:129], v[136:137], v[80:81], v[128:129] op_sel:[0,1,0] op_sel_hi:[1,1,1]
    v_pk_fma_f32 v[130:131], v[138:139], v[80:81], v[130:131] op_sel:[0,1,0] op_sel_hi:[1,1,1]
    v_pk_fma_f32 v[132:133], v[140:141], v[80:81], v[132:133] op_sel:[0,1,0] op_sel_hi:[1,1,1]
    v_pk_fma_f32 v[134:135], v[142:143], v[80:81], v[134:135] op_sel:[0,1,0] op_sel_hi:[1,1,1]
    s_waitcnt vmcnt(8)
    v_lshlrev_b32 v136, 16, v96
    v_and_b32 v137, 0xffff0000, v96
    v_lshlrev_b32 v138, 16, v97
    v_and_b32 v139, 0xffff0000, v97
    v_lshlrev_b32 v140, 16, v98
    v_and_b32 v141, 0xffff0000, v98
    v_lshlrev_b32 v142, 16, v99
    v_and_b32 v143, 0xffff0000, v99
    v_pk_fma_f32 v[128:129], v[136:137], v[82:83], v[128:129] op_sel:[0,0,0] op_sel_hi:[1,0,1]
    v_pk_fma_f32 v[130:131], v[138:139], v[82:83], v[130:131] op_sel:[0,0,0] op_sel_hi:[1,0,1]
    v_pk_fma_f32 v[132:133], v[140:141], v[82:83], v[132:133] op_sel:[0,0,0] op_sel_hi:[1,0,1]
    v_pk_fma_f32 v[134:135], v[142:143], v[82:83], v[134:135] op_sel:[0,0,0] op_sel_hi:[1,0,1]
    s_waitcnt vmcnt(7)
    v_lshlrev_b32 v136, 16, v100
    v_and_b32 v137, 0xffff0000, v100
    v_lshlrev_b32 v138, 16, v101
    v_and_b32 v139, 0xffff0000, v101
    v_lshlrev_b32 v140, 16, v102
    v_and_b32 v141, 0xffff0000, v102
    v_lshlrev_b32 v142, 16, v103
    v_and_b32 v143, 0xffff0000, v103
    v_pk_fma_f32 v[128:129], v[136:137], v[82:83], v[128:129] op_sel:[0,1,0] op_sel_hi:[1,1,1]
    v_pk_fma_f32 v[130:131], v[138:139], v[82:83], v[130:131] op_sel:[0,1,0] op_sel_hi:[1,1,1]
    v_pk_fma_f32 v[132:133], v[140:141], v[82:83], v[132:133] op_sel:[0,1,0] op_sel_hi:[1,1,1]
    v_pk_fma_f32 v[134:135], v[142:143], v[82:83], v[134:135] op_sel:[0,1,0] op_sel_hi:[1,1,1]
    s_waitcnt vmcnt(6)
    v_lshlrev_b32 v136, 16, v104
    v_and_b32 v137, 0xffff0000, v104
    v_lshlrev_b32 v138, 16, v105
    v_and_b32 v139, 0xffff0000, v105
    v_lshlrev_b32 v140, 16, v106
    v_and_b32 v141, 0xffff0000, v106
    v_lshlrev_b32 v142, 16, v107
    v_and_b32 v143, 0xffff0000, v107
    v_pk_fma_f32 v[128:129], v[136:137], v[84:85], v[128:129] op_sel:[0,0,0] op_sel_hi:[1,0,1]
    v_pk_fma_f32 v[130:131], v[138:139], v[84:85], v[130:131] op_sel:[0,0,0] op_sel_hi:[1,0,1]
    v_pk_fma_f32 v[132:133], v[140:141], v[84:85], v[132:133] op_sel:[0,0,0] op_sel_hi:[1,0,1]
    v_pk_fma_f32 v[134:135], v[142:143], v[84:85], v[134:135] op_sel:[0,0,0] op_sel_hi:[1,0,1]
    s_nop 0
    v_permlane32_swap_b32 v128, v132
    v_permlane32_swap_b32 v129, v133
    v_permlane32_swap_b32 v130, v134
    v_permlane32_swap_b32 v131, v135
    v_and_b32 v72, 1, v1
    v_pk_add_f32 v[128:129], v[128:129], v[132:133]
    v_pk_add_f32 v[130:131], v[130:131], v[134:135]
    v_lshlrev_b32 v72, 5, v72
    v_lshrrev_b32 v73, 4, v1
    v_permlane16_swap_b32 v128, v130
    v_permlane16_swap_b32 v129, v131
    v_lshl_add_u32 v72, v73, 3, v72
    v_pk_add_f32 v[128:129], v[128:129], v[130:131]
    s_lshl_b32 s36, s3, 6
    v_add_u32 v72, s36, v72
    v_add_f32_dpp v128, v128, v128 row_ror:2 row_mask:0xf bank_mask:0xf
    v_add_f32_dpp v129, v129, v129 row_ror:2 row_mask:0xf bank_mask:0xf
    s_nop 0
    v_add_f32_dpp v128, v128, v128 row_ror:4 row_mask:0xf bank_mask:0xf
    v_add_f32_dpp v129, v129, v129 row_ror:4 row_mask:0xf bank_mask:0xf
    s_nop 0
    v_add_f32_dpp v128, v128, v128 row_ror:8 row_mask:0xf bank_mask:0xf
    v_add_f32_dpp v129, v129, v129 row_ror:8 row_mask:0xf bank_mask:0xf
    ds_write_b64 v72, v[128:129] offset:0
    v_and_b32 v73, 7, v1
    v_lshlrev_b32 v73, 3, v73
    s_waitcnt lgkmcnt(0)
    s_barrier
    ds_read_b64 v[128:129], v73 offset:0
    ds_read_b64 v[130:131], v73 offset:64
    ds_read_b64 v[132:133], v73 offset:128
    ds_read_b64 v[134:135], v73 offset:192
    s_add_u32 s95, s94, 0x9e3779b9
    v_mov_b32 v137, s95
    s_mov_b32 s37, 32768
    s_waitcnt lgkmcnt(2)
    v_pk_add_f32 v[128:129], v[128:129], v[130:131]
    s_waitcnt lgkmcnt(0)
    v_pk_add_f32 v[132:133], v[132:133], v[134:135]
    v_pk_add_f32 v[128:129], v[128:129], v[132:133]
    v_cvt_pk_bf16_f32 v136, v128, v129
    v_lshlrev_b32 v128, 16, v136
    v_and_b32 v129, 0xffff0000, v136
    v_add_f32 v128, s93, v128
    v_add_f32 v129, s93, v129
    v_cvt_pk_bf16_f32 v136, v128, v129
    buffer_store_dwordx2 v[136:137], v69, s[24:27], s37 offen sc1
    s_mul_i32 s36, s3, 72
    v_add_u32 v122, s36, v1
    v_and_b32 v123, 7, v1
    s_add_u32 s36, s36, 64
    v_add_u32 v123, s36, v123
    s_movk_i32 s36, 1024
    v_and_b32 v76, 3, v122
    v_lshlrev_b32 v76, 4, v76
    v_lshrrev_b32 v122, 2, v122
    v_lshl_add_u32 v124, v122, 7, v76
    v_and_b32 v77, 1, v122
    v_lshl_add_u32 v76, v77, 3, v76
    v_lshrrev_b32 v122, 1, v122
    v_lshl_add_u32 v122, v122, 6, v76
    v_add_u32 v122, s36, v122
    v_and_b32 v76, 3, v123
    v_lshlrev_b32 v76, 4, v76
    v_lshrrev_b32 v123, 2, v123
    v_lshl_add_u32 v125, v123, 7, v76
    v_and_b32 v77, 1, v123
    v_lshl_add_u32 v76, v77, 3, v76
    v_lshrrev_b32 v123, 1, v123
    v_lshl_add_u32 v123, v123, 6, v76
    v_add_u32 v123, s36, v123
    s_mov_b64 exec, 0
    s_cmp_eq_u32 s3, 0
    s_cbranch_scc1 Ltour0
    s_cmp_eq_u32 s3, 1
    s_cbranch_scc1 Ltour1
    s_cmp_eq_u32 s3, 2
    s_cbranch_scc1 Ltour2
    s_branch Ltour3
.p2align 12
Lmain:
    s_mov_b64 exec, -1
    s_waitcnt vmcnt(6)
    v_lshlrev_b32 v144, 16, v108
    v_and_b32 v145, 0xffff0000, v108
    v_lshlrev_b32 v146, 16, v109
    v_and_b32 v147, 0xffff0000, v109
    s_waitcnt vmcnt(5)
    v_lshlrev_b32 v148, 16, v110
    v_and_b32 v149, 0xffff0000, v110
    v_lshlrev_b32 v150, 16, v111
    v_and_b32 v151, 0xffff0000, v111
    s_waitcnt vmcnt(4)
    v_lshlrev_b32 v152, 16, v112
    v_and_b32 v153, 0xffff0000, v112
    v_lshlrev_b32 v154, 16, v113
    v_and_b32 v155, 0xffff0000, v113
    s_waitcnt vmcnt(3)
    v_lshlrev_b32 v156, 16, v114
    v_and_b32 v157, 0xffff0000, v114
    v_lshlrev_b32 v158, 16, v115
    v_and_b32 v159, 0xffff0000, v115
    s_waitcnt vmcnt(2)
    v_lshlrev_b32 v160, 16, v116
    v_and_b32 v161, 0xffff0000, v116
    v_lshlrev_b32 v162, 16, v117
    v_and_b32 v163, 0xffff0000, v117
    s_waitcnt vmcnt(1)
    v_lshlrev_b32 v164, 16, v118
    v_and_b32 v165, 0xffff0000, v118
    v_lshlrev_b32 v166, 16, v119
    v_and_b32 v167, 0xffff0000, v119
    buffer_load_dwordx4 v[88:91], v124, s[24:27], s37 offen sc1
    buffer_load_dwordx4 v[92:95], v125, s[24:27], s37 offen sc1
    buffer_load_dword v242, v71, s[16:19], s44 offen
    v_pk_add_f32 v[72:73], v[144:145], v[148:149]
    v_pk_add_f32 v[76:77], v[146:147], v[150:151]
    v_pk_add_f32 v[72:73], v[72:73], v[152:153]
    v_pk_add_f32 v[76:77], v[76:77], v[154:155]
    v_pk_add_f32 v[72:73], v[72:73], v[156:157]
    v_pk_add_f32 v[76:77], v[76:77], v[158:159]
    v_pk_add_f32 v[72:73], v[72:73], v[160:161]
    v_pk_add_f32 v[76:77], v[76:77], v[162:163]
    v_pk_add_f32 v[72:73], v[72:73], v[164:165]
    v_pk_add_f32 v[76:77], v[76:77], v[166:167]
    v_pk_add_f32 v[72:73], v[72:73], v[76:77]
    v_add_f32 v72, v72, v73
    s_nop 1
    v_add_f32_dpp v72, v72, v72 row_ror:1 row_mask:0xf bank_mask:0xf
    s_nop 1
    v_add_f32_dpp v72, v72, v72 row_ror:2 row_mask:0xf bank_mask:0xf
    s_nop 1
    v_add_f32_dpp v72, v72, v72 row_ror:4 row_mask:0xf bank_mask:0xf
    s_nop 1
    v_add_f32_dpp v72, v72, v72 row_ror:8 row_mask:0xf bank_mask:0xf
    v_mov_b32 v76, v72
    s_nop 1
    v_permlane16_swap_b32 v72, v76
    s_nop 0
    v_add_f32 v72, v72, v76
    v_mul_f32 v72, 0x3ae38e39, v72
    v_pk_add_f32 v[168:169], v[144:145], v[72:73] op_sel_hi:[1,0] neg_lo:[0,1] neg_hi:[0,1]
    v_pk_add_f32 v[170:171], v[146:147], v[72:73] op_sel_hi:[1,0] neg_lo:[0,1] neg_hi:[0,1]
    v_pk_add_f32 v[172:173], v[148:149], v[72:73] op_sel_hi:[1,0] neg_lo:[0,1] neg_hi:[0,1]
    v_pk_add_f32 v[174:175], v[150:151], v[72:73] op_sel_hi:[1,0] neg_lo:[0,1] neg_hi:[0,1]
    v_pk_add_f32 v[176:177], v[152:153], v[72:73] op_sel_hi:[1,0] neg_lo:[0,1] neg_hi:[0,1]
    v_pk_add_f32 v[178:179], v[154:155], v[72:73] op_sel_hi:[1,0] neg_lo:[0,1] neg_hi:[0,1]
    v_pk_add_f32 v[180:181], v[156:157], v[72:73] op_sel_hi:[1,0] neg_lo:[0,1] neg_hi:[0,1]
    v_pk_add_f32 v[182:183], v[158:159], v[72:73] op_sel_hi:[1,0] neg_lo:[0,1] neg_hi:[0,1]
    v_pk_add_f32 v[184:185], v[160:161], v[72:73] op_sel_hi:[1,0] neg_lo:[0,1] neg_hi:[0,1]
    v_pk_add_f32 v[186:187], v[162:163], v[72:73] op_sel_hi:[1,0] neg_lo:[0,1] neg_hi:[0,1]
    v_pk_add_f32 v[188:189], v[164:165], v[72:73] op_sel_hi:[1,0] neg_lo:[0,1] neg_hi:[0,1]
    v_pk_add_f32 v[190:191], v[166:167], v[72:73] op_sel_hi:[1,0] neg_lo:[0,1] neg_hi:[0,1]
    v_pk_mul_f32 v[74:75], v[168:169], v[168:169]
    v_pk_mul_f32 v[76:77], v[170:171], v[170:171]
    v_pk_fma_f32 v[74:75], v[172:173], v[172:173], v[74:75]
    v_pk_fma_f32 v[76:77], v[174:175], v[174:175], v[76:77]
    v_pk_fma_f32 v[74:75], v[176:177], v[176:177], v[74:75]
    v_pk_fma_f32 v[76:77], v[178:179], v[178:179], v[76:77]
    v_pk_fma_f32 v[74:75], v[180:181], v[180:181], v[74:75]
    v_pk_fma_f32 v[76:77], v[182:183], v[182:183], v[76:77]
    v_pk_fma_f32 v[74:75], v[184:185], v[184:185], v[74:75]
    v_pk_fma_f32 v[76:77], v[186:187], v[186:187], v[76:77]
    v_pk_fma_f32 v[74:75], v[188:189], v[188:189], v[74:75]
    v_pk_fma_f32 v[76:77], v[190:191], v[190:191], v[76:77]
    v_pk_add_f32 v[74:75], v[74:75], v[76:77]
    v_add_f32 v74, v74, v75
    v_cndmask_b32 v74, 0, v74, vcc
    s_nop 1
    v_add_f32_dpp v74, v74, v74 row_ror:1 row_mask:0xf bank_mask:0xf
    s_nop 1
    v_add_f32_dpp v74, v74, v74 row_ror:2 row_mask:0xf bank_mask:0xf
    s_nop 1
    v_add_f32_dpp v74, v74, v74 row_ror:4 row_mask:0xf bank_mask:0xf
    s_nop 1
    v_add_f32_dpp v74, v74, v74 row_ror:8 row_mask:0xf bank_mask:0xf
    v_mov_b32 v76, v74
    s_nop 1
    v_permlane16_swap_b32 v74, v76
    s_nop 0
    v_add_f32 v74, v74, v76
    v_mul_f32 v74, 0x3ae38e39, v74
    v_cvt_pk_bf16_f32 v76, v72, v74
    v_and_b32 v74, 0xffff0000, v76
    v_lshlrev_b32 v72, 16, v76
    v_add_f32 v74, 0x3727c5ac, v74
    v_cvt_pk_bf16_f32 v74, v74, v74
    v_and_b32 v74, 0xffff0000, v74
    v_sqrt_f32 v74, v74
    v_pk_add_f32 v[168:169], v[144:145], v[72:73] op_sel_hi:[1,0] neg_lo:[0,1] neg_hi:[0,1]
    v_pk_add_f32 v[170:171], v[146:147], v[72:73] op_sel_hi:[1,0] neg_lo:[0,1] neg_hi:[0,1]
    v_pk_add_f32 v[172:173], v[148:149], v[72:73] op_sel_hi:[1,0] neg_lo:[0,1] neg_hi:[0,1]
    v_pk_add_f32 v[174:175], v[150:151], v[72:73] op_sel_hi:[1,0] neg_lo:[0,1] neg_hi:[0,1]
    v_pk_add_f32 v[176:177], v[152:153], v[72:73] op_sel_hi:[1,0] neg_lo:[0,1] neg_hi:[0,1]
    v_pk_add_f32 v[178:179], v[154:155], v[72:73] op_sel_hi:[1,0] neg_lo:[0,1] neg_hi:[0,1]
    v_pk_add_f32 v[180:181], v[156:157], v[72:73] op_sel_hi:[1,0] neg_lo:[0,1] neg_hi:[0,1]
    v_pk_add_f32 v[182:183], v[158:159], v[72:73] op_sel_hi:[1,0] neg_lo:[0,1] neg_hi:[0,1]
    v_pk_add_f32 v[184:185], v[160:161], v[72:73] op_sel_hi:[1,0] neg_lo:[0,1] neg_hi:[0,1]
    v_pk_add_f32 v[186:187], v[162:163], v[72:73] op_sel_hi:[1,0] neg_lo:[0,1] neg_hi:[0,1]
    v_pk_add_f32 v[188:189], v[164:165], v[72:73] op_sel_hi:[1,0] neg_lo:[0,1] neg_hi:[0,1]
    v_pk_add_f32 v[190:191], v[166:167], v[72:73] op_sel_hi:[1,0] neg_lo:[0,1] neg_hi:[0,1]
    v_cvt_pk_bf16_f32 v74, v74, v74
    v_and_b32 v74, 0xffff0000, v74
    v_rcp_f32 v74, v74
    v_cvt_pk_bf16_f32 v108, v168, v169
    v_cvt_pk_bf16_f32 v109, v170, v171
    v_cvt_pk_bf16_f32 v110, v172, v173
    v_cvt_pk_bf16_f32 v111, v174, v175
    v_cvt_pk_bf16_f32 v112, v176, v177
    v_cvt_pk_bf16_f32 v113, v178, v179
    v_cvt_pk_bf16_f32 v114, v180, v181
    v_cvt_pk_bf16_f32 v115, v182, v183
    v_cvt_pk_bf16_f32 v116, v184, v185
    v_cvt_pk_bf16_f32 v117, v186, v187
    v_cvt_pk_bf16_f32 v118, v188, v189
    v_cvt_pk_bf16_f32 v119, v190, v191
    v_lshlrev_b32 v168, 16, v108
    v_and_b32 v169, 0xffff0000, v108
    v_lshlrev_b32 v170, 16, v109
    v_and_b32 v171, 0xffff0000, v109
    v_lshlrev_b32 v172, 16, v110
    v_and_b32 v173, 0xffff0000, v110
    v_lshlrev_b32 v174, 16, v111
    v_and_b32 v175, 0xffff0000, v111
    v_lshlrev_b32 v176, 16, v112
    v_and_b32 v177, 0xffff0000, v112
    v_lshlrev_b32 v178, 16, v113
    v_and_b32 v179, 0xffff0000, v113
    v_lshlrev_b32 v180, 16, v114
    v_and_b32 v181, 0xffff0000, v114
    v_lshlrev_b32 v182, 16, v115
    v_and_b32 v183, 0xffff0000, v115
    v_lshlrev_b32 v184, 16, v116
    v_and_b32 v185, 0xffff0000, v116
    v_lshlrev_b32 v186, 16, v117
    v_and_b32 v187, 0xffff0000, v117
    v_lshlrev_b32 v188, 16, v118
    v_and_b32 v189, 0xffff0000, v118
    v_lshlrev_b32 v190, 16, v119
    v_and_b32 v191, 0xffff0000, v119
    v_pk_mul_f32 v[168:169], v[168:169], v[74:75] op_sel_hi:[1,0]
    v_pk_mul_f32 v[170:171], v[170:171], v[74:75] op_sel_hi:[1,0]
    v_pk_mul_f32 v[172:173], v[172:173], v[74:75] op_sel_hi:[1,0]
    v_pk_mul_f32 v[174:175], v[174:175], v[74:75] op_sel_hi:[1,0]
    v_pk_mul_f32 v[176:177], v[176:177], v[74:75] op_sel_hi:[1,0]
    v_pk_mul_f32 v[178:179], v[178:179], v[74:75] op_sel_hi:[1,0]
    v_pk_mul_f32 v[180:181], v[180:181], v[74:75] op_sel_hi:[1,0]
    v_pk_mul_f32 v[182:183], v[182:183], v[74:75] op_sel_hi:[1,0]
    v_pk_mul_f32 v[184:185], v[184:185], v[74:75] op_sel_hi:[1,0]
    v_pk_mul_f32 v[186:187], v[186:187], v[74:75] op_sel_hi:[1,0]
    v_pk_mul_f32 v[188:189], v[188:189], v[74:75] op_sel_hi:[1,0]
    v_pk_mul_f32 v[190:191], v[190:191], v[74:75] op_sel_hi:[1,0]
    v_cvt_pk_bf16_f32 v108, v168, v169
    v_cvt_pk_bf16_f32 v109, v170, v171
    v_cvt_pk_bf16_f32 v110, v172, v173
    v_cvt_pk_bf16_f32 v111, v174, v175
    v_cvt_pk_bf16_f32 v112, v176, v177
    v_cvt_pk_bf16_f32 v113, v178, v179
    v_cvt_pk_bf16_f32 v114, v180, v181
    v_cvt_pk_bf16_f32 v115, v182, v183
    v_cvt_pk_bf16_f32 v116, v184, v185
    v_cvt_pk_bf16_f32 v117, v186, v187
    v_cvt_pk_bf16_f32 v118, v188, v189
    v_cvt_pk_bf16_f32 v119, v190, v191
    v_lshlrev_b32 v168, 16, v108
    v_and_b32 v169, 0xffff0000, v108
    v_lshlrev_b32 v170, 16, v109
    v_and_b32 v171, 0xffff0000, v109
    v_lshlrev_b32 v172, 16, v110
    v_and_b32 v173, 0xffff0000, v110
    v_lshlrev_b32 v174, 16, v111
    v_and_b32 v175, 0xffff0000, v111
    v_lshlrev_b32 v176, 16, v112
    v_and_b32 v177, 0xffff0000, v112
    v_lshlrev_b32 v178, 16, v113
    v_and_b32 v179, 0xffff0000, v113
    v_lshlrev_b32 v180, 16, v114
    v_and_b32 v181, 0xffff0000, v114
    v_lshlrev_b32 v182, 16, v115
    v_and_b32 v183, 0xffff0000, v115
    v_lshlrev_b32 v184, 16, v116
    v_and_b32 v185, 0xffff0000, v116
    v_lshlrev_b32 v186, 16, v117
    v_and_b32 v187, 0xffff0000, v117
    v_lshlrev_b32 v188, 16, v118
    v_and_b32 v189, 0xffff0000, v118
    v_lshlrev_b32 v190, 16, v119
    v_and_b32 v191, 0xffff0000, v119
    s_mov_b32 s38, 16384
    s_waitcnt vmcnt(2)
    v_xor_b32 v89, s95, v89
    v_xor_b32 v91, s95, v91
    s_waitcnt vmcnt(1)
    v_xor_b32 v93, s95, v93
    v_xor_b32 v95, s95, v95
    v_or3_b32 v89, v89, v91, v93
    v_or_b32 v89, v89, v95
    v_cmp_ne_u32 vcc, 0, v89
    s_cbranch_vccz Lhead_gotm
Lhead_pollm:
    buffer_load_dwordx4 v[88:91], v124, s[24:27], s37 offen sc1
    buffer_load_dwordx4 v[92:95], v125, s[24:27], s37 offen sc1
    s_waitcnt vmcnt(0)
    s_sub_u32 s38, s38, 1
    s_cbranch_scc1 Lhead_gotm
    v_xor_b32 v89, s95, v89
    v_xor_b32 v91, s95, v91
    v_xor_b32 v93, s95, v93
    v_xor_b32 v95, s95, v95
    v_or3_b32 v89, v89, v91, v93
    v_or_b32 v89, v89, v95
    v_cmp_ne_u32 vcc, 0, v89
    s_cbranch_vccnz Lhead_pollm
Lhead_gotm:
    ds_write2_b32 v122, v88, v90 offset0:0 offset1:1
    ds_write2_b32 v123, v92, v94 offset0:0 offset1:1
    s_waitcnt lgkmcnt(0)
    s_barrier
    ds_read_b128 v[144:147], v68 offset:2176
    ds_read_b128 v[148:151], v68 offset:2560
    ds_read_b128 v[152:155], v68 offset:2944
    ds_read_b128 v[156:159], v68 offset:1024
    ds_read_b128 v[160:163], v68 offset:1408
    ds_read_b128 v[164:167], v68 offset:1792
    s_waitcnt lgkmcnt(5)
    v_lshlrev_b32 v192, 16, v144
    v_and_b32 v193, 0xffff0000, v144
    v_lshlrev_b32 v194, 16, v145
    v_and_b32 v195, 0xffff0000, v145
    v_lshlrev_b32 v196, 16, v146
    v_and_b32 v197, 0xffff0000, v146
    v_lshlrev_b32 v198, 16, v147
    v_and_b32 v199, 0xffff0000, v147
    s_waitcnt lgkmcnt(4)
    v_lshlrev_b32 v200, 16, v148
    v_and_b32 v201, 0xffff0000, v148
    v_lshlrev_b32 v202, 16, v149
    v_and_b32 v203, 0xffff0000, v149
    v_lshlrev_b32 v204, 16, v150
    v_and_b32 v205, 0xffff0000, v150
    v_lshlrev_b32 v206, 16, v151
    v_and_b32 v207, 0xffff0000, v151
    s_waitcnt lgkmcnt(3)
    v_lshlrev_b32 v208, 16, v152
    v_and_b32 v209, 0xffff0000, v152
    v_lshlrev_b32 v210, 16, v153
    v_and_b32 v211, 0xffff0000, v153
    v_lshlrev_b32 v212, 16, v154
    v_and_b32 v213, 0xffff0000, v154
    v_lshlrev_b32 v214, 16, v155
    v_and_b32 v215, 0xffff0000, v155
    v_pk_mul_f32 v[168:169], v[168:169], v[192:193]
    v_pk_mul_f32 v[170:171], v[170:171], v[194:195]
    v_pk_mul_f32 v[172:173], v[172:173], v[196:197]
    v_pk_mul_f32 v[174:175], v[174:175], v[198:199]
    v_pk_mul_f32 v[176:177], v[176:177], v[200:201]
    v_pk_mul_f32 v[178:179], v[178:179], v[202:203]
    v_pk_mul_f32 v[180:181], v[180:181], v[204:205]
    v_pk_mul_f32 v[182:183], v[182:183], v[206:207]
    v_pk_mul_f32 v[184:185], v[184:185], v[208:209]
    v_pk_mul_f32 v[186:187], v[186:187], v[210:211]
    v_pk_mul_f32 v[188:189], v[188:189], v[212:213]
    v_pk_mul_f32 v[190:191], v[190:191], v[214:215]
    v_cvt_pk_bf16_f32 v108, v168, v169
    v_cvt_pk_bf16_f32 v109, v170, v171
    v_cvt_pk_bf16_f32 v110, v172, v173
    v_cvt_pk_bf16_f32 v111, v174, v175
    v_cvt_pk_bf16_f32 v112, v176, v177
    v_cvt_pk_bf16_f32 v113, v178, v179
    v_cvt_pk_bf16_f32 v114, v180, v181
    v_cvt_pk_bf16_f32 v115, v182, v183
    v_cvt_pk_bf16_f32 v116, v184, v185
    v_cvt_pk_bf16_f32 v117, v186, v187
    v_cvt_pk_bf16_f32 v118, v188, v189
    v_cvt_pk_bf16_f32 v119, v190, v191
    s_waitcnt lgkmcnt(2)
    v_lshlrev_b32 v216, 16, v156
    v_and_b32 v217, 0xffff0000, v156
    v_lshlrev_b32 v218, 16, v157
    v_and_b32 v219, 0xffff0000, v157
    v_lshlrev_b32 v220, 16, v158
    v_and_b32 v221, 0xffff0000, v158
    v_lshlrev_b32 v222, 16, v159
    v_and_b32 v223, 0xffff0000, v159
    s_waitcnt lgkmcnt(1)
    v_lshlrev_b32 v224, 16, v160
    v_and_b32 v225, 0xffff0000, v160
    v_lshlrev_b32 v226, 16, v161
    v_and_b32 v227, 0xffff0000, v161
    v_lshlrev_b32 v228, 16, v162
    v_and_b32 v229, 0xffff0000, v162
    v_lshlrev_b32 v230, 16, v163
    v_and_b32 v231, 0xffff0000, v163
    s_waitcnt lgkmcnt(0)
    v_lshlrev_b32 v232, 16, v164
    v_and_b32 v233, 0xffff0000, v164
    v_lshlrev_b32 v234, 16, v165
    v_and_b32 v235, 0xffff0000, v165
    v_lshlrev_b32 v236, 16, v166
    v_and_b32 v237, 0xffff0000, v166
    v_lshlrev_b32 v238, 16, v167
    v_and_b32 v239, 0xffff0000, v167
    v_lshlrev_b32 v168, 16, v108
    v_and_b32 v169, 0xffff0000, v108
    v_lshlrev_b32 v170, 16, v109
    v_and_b32 v171, 0xffff0000, v109
    v_lshlrev_b32 v172, 16, v110
    v_and_b32 v173, 0xffff0000, v110
    v_lshlrev_b32 v174, 16, v111
    v_and_b32 v175, 0xffff0000, v111
    v_lshlrev_b32 v176, 16, v112
    v_and_b32 v177, 0xffff0000, v112
    v_lshlrev_b32 v178, 16, v113
    v_and_b32 v179, 0xffff0000, v113
    v_lshlrev_b32 v180, 16, v114
    v_and_b32 v181, 0xffff0000, v114
    v_lshlrev_b32 v182, 16, v115
    v_and_b32 v183, 0xffff0000, v115
    v_lshlrev_b32 v184, 16, v116
    v_and_b32 v185, 0xffff0000, v116
    v_lshlrev_b32 v186, 16, v117
    v_and_b32 v187, 0xffff0000, v117
    v_lshlrev_b32 v188, 16, v118
    v_and_b32 v189, 0xffff0000, v118
    v_lshlrev_b32 v190, 16, v119
    v_and_b32 v191, 0xffff0000, v119
    v_pk_add_f32 v[168:169], v[168:169], v[216:217]
    v_pk_add_f32 v[170:171], v[170:171], v[218:219]
    v_pk_add_f32 v[172:173], v[172:173], v[220:221]
    v_pk_add_f32 v[174:175], v[174:175], v[222:223]
    v_cvt_pk_bf16_f32 v108, v168, v169
    v_cvt_pk_bf16_f32 v109, v170, v171
    v_cvt_pk_bf16_f32 v110, v172, v173
    v_cvt_pk_bf16_f32 v111, v174, v175
    buffer_store_dwordx4 v[108:111], v67, s[24:27], s92 offen offset:0 sc1
    v_pk_add_f32 v[176:177], v[176:177], v[224:225]
    v_pk_add_f32 v[178:179], v[178:179], v[226:227]
    v_pk_add_f32 v[180:181], v[180:181], v[228:229]
    v_pk_add_f32 v[182:183], v[182:183], v[230:231]
    v_cvt_pk_bf16_f32 v112, v176, v177
    v_cvt_pk_bf16_f32 v113, v178, v179
    v_cvt_pk_bf16_f32 v114, v180, v181
    v_cvt_pk_bf16_f32 v115, v182, v183
    buffer_store_dwordx4 v[112:115], v67, s[24:27], s92 offen offset:768 sc1
    v_pk_add_f32 v[184:185], v[184:185], v[232:233]
    v_pk_add_f32 v[186:187], v[186:187], v[234:235]
    v_pk_add_f32 v[188:189], v[188:189], v[236:237]
    v_pk_add_f32 v[190:191], v[190:191], v[238:239]
    v_cvt_pk_bf16_f32 v116, v184, v185
    v_cvt_pk_bf16_f32 v117, v186, v187
    v_cvt_pk_bf16_f32 v118, v188, v189
    v_cvt_pk_bf16_f32 v119, v190, v191
    buffer_store_dwordx4 v[116:119], v67, s[24:27], s92 offen offset:1536 sc1
    s_lshl_b32 s36, s5, 13
    s_add_u32 s36, s36, 8650752
    s_lshl_b32 s37, s4, 9
    s_add_u32 s37, s37, s36
    s_lshl_b32 s38, s3, 7
    s_add_u32 s37, s37, s38
    s_lshl_b32 s38, s3, 11
    s_add_u32 s36, s36, s38
    v_min_u32 v72, 1, v1
    v_lshlrev_b32 v72, 31, v72
    v_and_b32 v73, 15, v1
    v_lshlrev_b32 v73, 7, v73
    v_cmp_gt_u32 vcc, 162, v0
    v_mov_b32 v88, -1
    v_mov_b32 v89, -1
    v_mov_b32 v90, -1
    v_mov_b32 v91, -1
    s_mul_i32 s39, s2, 2592
    s_add_u32 s39, s39, 7864320
    v_lshl_add_u32 v74, v0, 4, s39
    s_lshl_b32 s39, s2, 7
    s_add_u32 s39, s39, 9306112
    v_mov_b32 v75, s39
    v_cndmask_b32 v74, v75, v74, vcc
    s_lshl_b32 s92, s5, 13
    s_add_u32 s92, s92, 8781824
    s_add_u32 s92, s92, s38
    s_lshl_b32 s38, s4, 7
    s_add_u32 s92, s92, s38
    s_getreg_b32 s38, hwreg(HW_REG_XCC_ID, 0, 4)
    s_add_u32 s38, s38, s95
    v_mov_b32 v76, s38
    v_mov_b32 v2, v80
    v_mov_b32 v3, v81
    v_mov_b32 v4, v82
    v_mov_b32 v5, v83
    v_mov_b32 v6, v84
    v_mov_b32 v7, v65
    v_and_b32 v126, 31, v1
    v_lshlrev_b32 v126, 2, v126
    s_waitcnt vmcnt(0)
    buffer_store_dword v137, v126, s[24:27], s37 offen sc1
    s_add_u32 s49, s44, 0
    s_add_u32 m0, s42, 32768
    s_nop 0
    buffer_load_dwordx4 v42, s[16:19], s49 offen lds
    buffer_load_dwordx4 v43, s[16:19], s49 offen offset:1024 lds
    buffer_load_dwordx4 v44, s[16:19], s49 offen offset:2048 lds
    buffer_load_dwordx4 v45, s[16:19], s49 offen offset:3072 lds
    s_add_u32 s49, s44, 256
    s_add_u32 m0, s42, 49152
    s_nop 0
    buffer_load_dwordx4 v42, s[16:19], s49 offen lds
    buffer_load_dwordx4 v43, s[16:19], s49 offen offset:1024 lds
    buffer_load_dwordx4 v44, s[16:19], s49 offen offset:2048 lds
    buffer_load_dwordx4 v45, s[16:19], s49 offen offset:3072 lds
    s_add_u32 s49, s44, 524288
    s_add_u32 m0, s42, 65536
    s_nop 0
    buffer_load_dwordx4 v42, s[16:19], s49 offen lds
    buffer_load_dwordx4 v43, s[16:19], s49 offen offset:1024 lds
    buffer_load_dwordx4 v44, s[16:19], s49 offen offset:2048 lds
    buffer_load_dwordx4 v45, s[16:19], s49 offen offset:3072 lds
    s_add_u32 s49, s44, 524544
    s_add_u32 m0, s42, 81920
    s_nop 0
    buffer_load_dwordx4 v42, s[16:19], s49 offen lds
    buffer_load_dwordx4 v43, s[16:19], s49 offen offset:1024 lds
    buffer_load_dwordx4 v44, s[16:19], s49 offen offset:2048 lds
    buffer_load_dwordx4 v45, s[16:19], s49 offen offset:3072 lds
    s_add_u32 s49, s44, 1048576
    s_add_u32 m0, s42, 98304
    s_nop 0
    buffer_load_dwordx4 v42, s[16:19], s49 offen lds
    buffer_load_dwordx4 v43, s[16:19], s49 offen offset:1024 lds
    buffer_load_dwordx4 v44, s[16:19], s49 offen offset:2048 lds
    buffer_load_dwordx4 v45, s[16:19], s49 offen offset:3072 lds
    s_add_u32 s49, s44, 1048832
    s_add_u32 m0, s42, 114688
    s_nop 0
    buffer_load_dwordx4 v42, s[16:19], s49 offen lds
    buffer_load_dwordx4 v43, s[16:19], s49 offen offset:1024 lds
    buffer_load_dwordx4 v44, s[16:19], s49 offen offset:2048 lds
    buffer_load_dwordx4 v45, s[16:19], s49 offen offset:3072 lds
    s_mov_b32 s38, 16384
Lhead_pollh:
    buffer_load_dword v75, v73, s[24:27], s36 offen sc1
    s_sub_u32 s38, s38, 1
    s_cbranch_scc1 Lhead_goth
    s_waitcnt vmcnt(0) lgkmcnt(0)
    v_cmp_ne_u32 vcc, s95, v75
    s_cbranch_vccnz Lhead_pollh
Lhead_goth:
    s_waitcnt vmcnt(0) lgkmcnt(0)
    buffer_load_dwordx4 a[0:3], v51, s[24:27], s46 offen offset:0 sc1
    buffer_load_dwordx4 a[8:11], v51, s[24:27], s46 offen offset:128 sc1
    buffer_load_dwordx4 a[4:7], v51, s[24:27], s43 offen offset:0 sc1
    buffer_load_dwordx4 a[12:15], v51, s[24:27], s43 offen offset:128 sc1
    s_barrier
    ds_read_b64_tr_b16 a[160:161], v12 offset:32768
    ds_read_b64_tr_b16 a[162:163], v12 offset:36864
    ds_read_b64_tr_b16 a[164:165], v12 offset:40960
    ds_read_b64_tr_b16 a[166:167], v12 offset:45056
    ds_read_b64_tr_b16 a[168:169], v13 offset:32768
    ds_read_b64_tr_b16 a[170:171], v13 offset:36864
    ds_read_b64_tr_b16 a[172:173], v13 offset:40960
    ds_read_b64_tr_b16 a[174:175], v13 offset:45056
    ds_read_b64_tr_b16 a[176:177], v14 offset:32768
    ds_read_b64_tr_b16 a[178:179], v14 offset:36864
    ds_read_b64_tr_b16 a[180:181], v14 offset:40960
    ds_read_b64_tr_b16 a[182:183], v14 offset:45056
    buffer_load_dwordx4 a[16:19], v51, s[24:27], s46 offen offset:256 sc1
    buffer_load_dwordx4 a[24:27], v51, s[24:27], s46 offen offset:384 sc1
    buffer_load_dwordx4 a[20:23], v51, s[24:27], s43 offen offset:256 sc1
    buffer_load_dwordx4 a[28:31], v51, s[24:27], s43 offen offset:384 sc1
    s_waitcnt lgkmcnt(10)
    s_waitcnt vmcnt(7)
    v_mfma_f32_16x16x32_bf16 v[128:131], a[160:163], a[0:3], 0
    s_waitcnt vmcnt(6)
    s_waitcnt lgkmcnt(8)
    ds_read_b64_tr_b16 a[184:185], v15 offset:32768
    v_mfma_f32_16x16x32_bf16 v[128:131], a[164:167], a[8:11], v[128:131]
    s_waitcnt vmcnt(5)
    ds_read_b64_tr_b16 a[186:187], v15 offset:36864
    v_mfma_f32_16x16x32_bf16 v[132:135], a[160:163], a[4:7], 0
    s_waitcnt vmcnt(4)
    ds_read_b64_tr_b16 a[188:189], v15 offset:40960
    v_mfma_f32_16x16x32_bf16 v[132:135], a[164:167], a[12:15], v[132:135]
    s_waitcnt lgkmcnt(9)
    buffer_load_dwordx4 a[32:35], v51, s[24:27], s46 offen offset:512 sc1
    v_mfma_f32_16x16x32_bf16 v[136:139], a[168:171], a[0:3], 0
    s_waitcnt lgkmcnt(7)
    ds_read_b64_tr_b16 a[190:191], v15 offset:45056
    ds_read_b64_tr_b16 a[160:161], v16 offset:32768
    v_mfma_f32_16x16x32_bf16 v[136:139], a[172:175], a[8:11], v[136:139]
    ds_read_b64_tr_b16 a[162:163], v16 offset:36864
    v_mfma_f32_16x16x32_bf16 v[140:143], a[168:171], a[4:7], 0
    ds_read_b64_tr_b16 a[164:165], v16 offset:40960
    v_mfma_f32_16x16x32_bf16 v[140:143], a[172:175], a[12:15], v[140:143]
    s_waitcnt lgkmcnt(9)
    buffer_load_dwordx4 a[40:43], v51, s[24:27], s46 offen offset:640 sc1
    v_mfma_f32_16x16x32_bf16 v[144:147], a[176:179], a[0:3], 0
    s_waitcnt lgkmcnt(7)
    ds_read_b64_tr_b16 a[166:167], v16 offset:45056
    ds_read_b64_tr_b16 a[168:169], v17 offset:32768
    v_mfma_f32_16x16x32_bf16 v[144:147], a[180:183], a[8:11], v[144:147]
    ds_read_b64_tr_b16 a[170:171], v17 offset:36864
    v_mfma_f32_16x16x32_bf16 v[148:151], a[176:179], a[4:7], 0
    ds_read_b64_tr_b16 a[172:173], v17 offset:40960
    v_mfma_f32_16x16x32_bf16 v[148:151], a[180:183], a[12:15], v[148:151]
    s_waitcnt lgkmcnt(9)
    buffer_load_dwordx4 a[36:39], v51, s[24:27], s43 offen offset:512 sc1
    v_mfma_f32_16x16x32_bf16 v[152:155], a[184:187], a[0:3], 0
    s_waitcnt lgkmcnt(7)
    ds_read_b64_tr_b16 a[174:175], v17 offset:45056
    ds_read_b64_tr_b16 a[176:177], v18 offset:32768
    v_mfma_f32_16x16x32_bf16 v[152:155], a[188:191], a[8:11], v[152:155]
    ds_read_b64_tr_b16 a[178:179], v18 offset:36864
    v_mfma_f32_16x16x32_bf16 v[156:159], a[184:187], a[4:7], 0
    ds_read_b64_tr_b16 a[180:181], v18 offset:40960
    v_mfma_f32_16x16x32_bf16 v[156:159], a[188:191], a[12:15], v[156:159]
    s_waitcnt lgkmcnt(9)
    buffer_load_dwordx4 a[44:47], v51, s[24:27], s43 offen offset:640 sc1
    v_mfma_f32_16x16x32_bf16 v[160:163], a[160:163], a[0:3], 0
    s_waitcnt lgkmcnt(7)
    ds_read_b64_tr_b16 a[182:183], v18 offset:45056
    ds_read_b64_tr_b16 a[184:185], v19 offset:32768
    v_mfma_f32_16x16x32_bf16 v[160:163], a[164:167], a[8:11], v[160:163]
    ds_read_b64_tr_b16 a[186:187], v19 offset:36864
    v_mfma_f32_16x16x32_bf16 v[164:167], a[160:163], a[4:7], 0
    ds_read_b64_tr_b16 a[188:189], v19 offset:40960
    v_mfma_f32_16x16x32_bf16 v[164:167], a[164:167], a[12:15], v[164:167]
    s_waitcnt lgkmcnt(9)
    buffer_load_dword v77, v70, s[16:19], s44 offen
    v_mfma_f32_16x16x32_bf16 v[168:171], a[168:171], a[0:3], 0
    s_waitcnt lgkmcnt(7)
    ds_read_b64_tr_b16 a[190:191], v19 offset:45056
    ds_read_b64_tr_b16 a[160:161], v12 offset:49152
    v_mfma_f32_16x16x32_bf16 v[168:171], a[172:175], a[8:11], v[168:171]
    ds_read_b64_tr_b16 a[162:163], v12 offset:53248
    v_mfma_f32_16x16x32_bf16 v[172:175], a[168:171], a[4:7], 0
    ds_read_b64_tr_b16 a[164:165], v12 offset:57344
    v_mfma_f32_16x16x32_bf16 v[172:175], a[172:175], a[12:15], v[172:175]
    s_waitcnt lgkmcnt(9)
    ds_read_b64_tr_b16 a[166:167], v12 offset:61440
    v_mfma_f32_16x16x32_bf16 v[176:179], a[176:179], a[0:3], 0
    s_waitcnt lgkmcnt(8)
    ds_read_b64_tr_b16 a[168:169], v13 offset:49152
    v_mfma_f32_16x16x32_bf16 v[176:179], a[180:183], a[8:11], v[176:179]
    ds_read_b64_tr_b16 a[170:171], v13 offset:53248
    v_mfma_f32_16x16x32_bf16 v[180:183], a[176:179], a[4:7], 0
    ds_read_b64_tr_b16 a[172:173], v13 offset:57344
    v_mfma_f32_16x16x32_bf16 v[180:183], a[180:183], a[12:15], v[180:183]
    s_waitcnt lgkmcnt(9)
    ds_read_b64_tr_b16 a[174:175], v13 offset:61440
    v_mfma_f32_16x16x32_bf16 v[184:187], a[184:187], a[0:3], 0
    s_waitcnt lgkmcnt(8)
    ds_read_b64_tr_b16 a[176:177], v14 offset:49152
    v_mfma_f32_16x16x32_bf16 v[184:187], a[188:191], a[8:11], v[184:187]
    ds_read_b64_tr_b16 a[178:179], v14 offset:53248
    v_mfma_f32_16x16x32_bf16 v[188:191], a[184:187], a[4:7], 0
    ds_read_b64_tr_b16 a[180:181], v14 offset:57344
    v_mfma_f32_16x16x32_bf16 v[188:191], a[188:191], a[12:15], v[188:191]
    s_waitcnt lgkmcnt(9)
    ds_read_b64_tr_b16 a[182:183], v14 offset:61440
    v_mfma_f32_16x16x32_bf16 v[192:195], a[160:163], a[0:3], 0
    s_waitcnt lgkmcnt(8)
    ds_read_b64_tr_b16 a[184:185], v15 offset:49152
    v_mfma_f32_16x16x32_bf16 v[192:195], a[164:167], a[8:11], v[192:195]
    ds_read_b64_tr_b16 a[186:187], v15 offset:53248
    v_mfma_f32_16x16x32_bf16 v[196:199], a[160:163], a[4:7], 0
    ds_read_b64_tr_b16 a[188:189], v15 offset:57344
    v_mfma_f32_16x16x32_bf16 v[196:199], a[164:167], a[12:15], v[196:199]
    s_waitcnt lgkmcnt(9)
    ds_read_b64_tr_b16 a[190:191], v15 offset:61440
    v_mfma_f32_16x16x32_bf16 v[200:203], a[168:171], a[0:3], 0
    s_waitcnt lgkmcnt(8)
    ds_read_b64_tr_b16 a[160:161], v16 offset:49152
    v_mfma_f32_16x16x32_bf16 v[200:203], a[172:175], a[8:11], v[200:203]
    ds_read_b64_tr_b16 a[162:163], v16 offset:53248
    v_mfma_f32_16x16x32_bf16 v[204:207], a[168:171], a[4:7], 0
    ds_read_b64_tr_b16 a[164:165], v16 offset:57344
    v_mfma_f32_16x16x32_bf16 v[204:207], a[172:175], a[12:15], v[204:207]
    s_waitcnt lgkmcnt(9)
    ds_read_b64_tr_b16 a[166:167], v16 offset:61440
    v_mfma_f32_16x16x32_bf16 v[208:211], a[176:179], a[0:3], 0
    s_waitcnt lgkmcnt(8)
    ds_read_b64_tr_b16 a[168:169], v17 offset:49152
    v_mfma_f32_16x16x32_bf16 v[208:211], a[180:183], a[8:11], v[208:211]
    ds_read_b64_tr_b16 a[170:171], v17 offset:53248
    v_mfma_f32_16x16x32_bf16 v[212:215], a[176:179], a[4:7], 0
    ds_read_b64_tr_b16 a[172:173], v17 offset:57344
    v_mfma_f32_16x16x32_bf16 v[212:215], a[180:183], a[12:15], v[212:215]
    s_waitcnt lgkmcnt(9)
    ds_read_b64_tr_b16 a[174:175], v17 offset:61440
    v_mfma_f32_16x16x32_bf16 v[216:219], a[184:187], a[0:3], 0
    s_waitcnt lgkmcnt(8)
    ds_read_b64_tr_b16 a[176:177], v18 offset:49152
    v_mfma_f32_16x16x32_bf16 v[216:219], a[188:191], a[8:11], v[216:219]
    ds_read_b64_tr_b16 a[178:179], v18 offset:53248
    v_mfma_f32_16x16x32_bf16 v[220:223], a[184:187], a[4:7], 0
    ds_read_b64_tr_b16 a[180:181], v18 offset:57344
    v_mfma_f32_16x16x32_bf16 v[220:223], a[188:191], a[12:15], v[220:223]
    s_waitcnt lgkmcnt(9)
    ds_read_b64_tr_b16 a[182:183], v18 offset:61440
    v_mfma_f32_16x16x32_bf16 v[224:227], a[160:163], a[0:3], 0
    s_waitcnt lgkmcnt(8)
    ds_read_b64_tr_b16 a[184:185], v19 offset:49152
    v_mfma_f32_16x16x32_bf16 v[224:227], a[164:167], a[8:11], v[224:227]
Ltour0:
    s_cbranch_execz Ltour4
    ds_read_b64_tr_b16 a[186:187], v19 offset:53248
    v_mfma_f32_16x16x32_bf16 v[228:231], a[160:163], a[4:7], 0
    ds_read_b64_tr_b16 a[188:189], v19 offset:57344
    v_mfma_f32_16x16x32_bf16 v[228:231], a[164:167], a[12:15], v[228:231]
    s_waitcnt lgkmcnt(9)
    ds_read_b64_tr_b16 a[190:191], v19 offset:61440
    s_barrier
    v_mfma_f32_16x16x32_bf16 v[232:235], a[168:171], a[0:3], 0
    s_waitcnt lgkmcnt(8)
    ds_read_b64_tr_b16 a[160:161], v20 offset:0
    v_mfma_f32_16x16x32_bf16 v[232:235], a[172:175], a[8:11], v[232:235]
    s_add_u32 s49, s44, 1572864
    ds_read_b64_tr_b16 a[162:163], v20 offset:4096
    v_mfma_f32_16x16x32_bf16 v[236:239], a[168:171], a[4:7], 0
    s_add_u32 m0, s42, 131072
    ds_read_b64_tr_b16 a[164:165], v20 offset:8192
    v_mfma_f32_16x16x32_bf16 v[236:239], a[172:175], a[12:15], v[236:239]
    s_waitcnt lgkmcnt(9)
    buffer_load_dwordx4 v42, s[16:19], s49 offen lds
    v_mfma_f32_16x16x32_bf16 v[240:243], a[176:179], a[0:3], 0
    s_waitcnt lgkmcnt(7)
    ds_read_b64_tr_b16 a[166:167], v20 offset:12288
    ds_read_b64_tr_b16 a[168:169], v21 offset:0
    v_mfma_f32_16x16x32_bf16 v[240:243], a[180:183], a[8:11], v[240:243]
    ds_read_b64_tr_b16 a[170:171], v21 offset:4096
    v_mfma_f32_16x16x32_bf16 v[244:247], a[176:179], a[4:7], 0
    ds_read_b64_tr_b16 a[172:173], v21 offset:8192
    v_mfma_f32_16x16x32_bf16 v[244:247], a[180:183], a[12:15], v[244:247]
    s_waitcnt lgkmcnt(9)
    buffer_load_dwordx4 v43, s[16:19], s49 offen offset:1024 lds
    v_mfma_f32_16x16x32_bf16 v[248:251], a[184:187], a[0:3], 0
    s_waitcnt lgkmcnt(7)
    ds_read_b64_tr_b16 a[174:175], v21 offset:12288
    ds_read_b64_tr_b16 a[176:177], v22 offset:0
    v_mfma_f32_16x16x32_bf16 v[248:251], a[188:191], a[8:11], v[248:251]
    ds_read_b64_tr_b16 a[178:179], v22 offset:4096
    v_mfma_f32_16x16x32_bf16 v[252:255], a[184:187], a[4:7], 0
    ds_read_b64_tr_b16 a[180:181], v22 offset:8192
    v_mfma_f32_16x16x32_bf16 v[252:255], a[188:191], a[12:15], v[252:255]
    s_waitcnt vmcnt(10)
    s_waitcnt lgkmcnt(9)
    buffer_load_dwordx4 v44, s[16:19], s49 offen offset:2048 lds
    v_mfma_f32_16x16x32_bf16 v[128:131], a[160:163], a[16:19], v[128:131]
    s_waitcnt vmcnt(10)
    s_waitcnt lgkmcnt(7)
    ds_read_b64_tr_b16 a[182:183], v22 offset:12288
    ds_read_b64_tr_b16 a[184:185], v23 offset:0
    v_mfma_f32_16x16x32_bf16 v[128:131], a[164:167], a[24:27], v[128:131]
    s_waitcnt vmcnt(9)
    ds_read_b64_tr_b16 a[186:187], v23 offset:4096
    v_mfma_f32_16x16x32_bf16 v[132:135], a[160:163], a[20:23], v[132:135]
    s_waitcnt vmcnt(8)
    ds_read_b64_tr_b16 a[188:189], v23 offset:8192
    v_mfma_f32_16x16x32_bf16 v[132:135], a[164:167], a[28:31], v[132:135]
    s_waitcnt lgkmcnt(9)
    buffer_load_dwordx4 v45, s[16:19], s49 offen offset:3072 lds
    v_mfma_f32_16x16x32_bf16 v[136:139], a[168:171], a[16:19], v[136:139]
    s_waitcnt lgkmcnt(7)
    ds_read_b64_tr_b16 a[190:191], v23 offset:12288
    ds_read_b64_tr_b16 a[160:161], v24 offset:0
    v_mfma_f32_16x16x32_bf16 v[136:139], a[172:175], a[24:27], v[136:139]
    s_add_u32 s49, s44, 1573120
    ds_read_b64_tr_b16 a[162:163], v24 offset:4096
    v_mfma_f32_16x16x32_bf16 v[140:143], a[168:171], a[20:23], v[140:143]
    s_add_u32 m0, s42, 147456
    ds_read_b64_tr_b16 a[164:165], v24 offset:8192
    v_mfma_f32_16x16x32_bf16 v[140:143], a[172:175], a[28:31], v[140:143]
    s_waitcnt lgkmcnt(9)
    buffer_load_dwordx4 v42, s[16:19], s49 offen lds
    v_mfma_f32_16x16x32_bf16 v[144:147], a[176:179], a[16:19], v[144:147]
    s_waitcnt lgkmcnt(7)
    ds_read_b64_tr_b16 a[166:167], v24 offset:12288
    ds_read_b64_tr_b16 a[168:169], v25 offset:0
    v_mfma_f32_16x16x32_bf16 v[144:147], a[180:183], a[24:27], v[144:147]
    ds_read_b64_tr_b16 a[170:171], v25 offset:4096
    v_mfma_f32_16x16x32_bf16 v[148:151], a[176:179], a[20:23], v[148:151]
    ds_read_b64_tr_b16 a[172:173], v25 offset:8192
    v_mfma_f32_16x16x32_bf16 v[148:151], a[180:183], a[28:31], v[148:151]
    s_waitcnt lgkmcnt(9)
    buffer_load_dwordx4 v43, s[16:19], s49 offen offset:1024 lds
    v_mfma_f32_16x16x32_bf16 v[152:155], a[184:187], a[16:19], v[152:155]
    s_waitcnt lgkmcnt(7)
    ds_read_b64_tr_b16 a[174:175], v25 offset:12288
    ds_read_b64_tr_b16 a[176:177], v26 offset:0
    v_mfma_f32_16x16x32_bf16 v[152:155], a[188:191], a[24:27], v[152:155]
    ds_read_b64_tr_b16 a[178:179], v26 offset:4096
    v_mfma_f32_16x16x32_bf16 v[156:159], a[184:187], a[20:23], v[156:159]
    ds_read_b64_tr_b16 a[180:181], v26 offset:8192
    v_mfma_f32_16x16x32_bf16 v[156:159], a[188:191], a[28:31], v[156:159]
    s_waitcnt lgkmcnt(9)
    buffer_load_dwordx4 v44, s[16:19], s49 offen offset:2048 lds
    v_mfma_f32_16x16x32_bf16 v[160:163], a[160:163], a[16:19], v[160:163]
    s_waitcnt lgkmcnt(7)
    ds_read_b64_tr_b16 a[182:183], v26 offset:12288
    ds_read_b64_tr_b16 a[184:185], v27 offset:0
    v_mfma_f32_16x16x32_bf16 v[160:163], a[164:167], a[24:27], v[160:163]
    ds_read_b64_tr_b16 a[186:187], v27 offset:4096
    v_mfma_f32_16x16x32_bf16 v[164:167], a[160:163], a[20:23], v[164:167]
    ds_read_b64_tr_b16 a[188:189], v27 offset:8192
    v_mfma_f32_16x16x32_bf16 v[164:167], a[164:167], a[28:31], v[164:167]
    s_waitcnt lgkmcnt(9)
    buffer_load_dwordx4 v45, s[16:19], s49 offen offset:3072 lds
    v_mfma_f32_16x16x32_bf16 v[168:171], a[168:171], a[16:19], v[168:171]
    s_waitcnt lgkmcnt(7)
    ds_read_b64_tr_b16 a[190:191], v27 offset:12288
    ds_read_b64_tr_b16 a[160:161], v20 offset:16384
    v_mfma_f32_16x16x32_bf16 v[168:171], a[172:175], a[24:27], v[168:171]
    ds_read_b64_tr_b16 a[162:163], v20 offset:20480
    v_mfma_f32_16x16x32_bf16 v[172:175], a[168:171], a[20:23], v[172:175]
    ds_read_b64_tr_b16 a[164:165], v20 offset:24576
    v_mfma_f32_16x16x32_bf16 v[172:175], a[172:175], a[28:31], v[172:175]
    s_waitcnt lgkmcnt(9)
    buffer_load_dwordx4 a[48:51], v51, s[24:27], s46 offen offset:768 sc1
    v_mfma_f32_16x16x32_bf16 v[176:179], a[176:179], a[16:19], v[176:179]
    s_waitcnt lgkmcnt(7)
    ds_read_b64_tr_b16 a[166:167], v20 offset:28672
    ds_read_b64_tr_b16 a[168:169], v21 offset:16384
    v_mfma_f32_16x16x32_bf16 v[176:179], a[180:183], a[24:27], v[176:179]
    ds_read_b64_tr_b16 a[170:171], v21 offset:20480
    v_mfma_f32_16x16x32_bf16 v[180:183], a[176:179], a[20:23], v[180:183]
    ds_read_b64_tr_b16 a[172:173], v21 offset:24576
    v_mfma_f32_16x16x32_bf16 v[180:183], a[180:183], a[28:31], v[180:183]
    s_waitcnt lgkmcnt(9)
    buffer_load_dwordx4 a[56:59], v51, s[24:27], s46 offen offset:896 sc1
    v_mfma_f32_16x16x32_bf16 v[184:187], a[184:187], a[16:19], v[184:187]
    s_waitcnt lgkmcnt(7)
    ds_read_b64_tr_b16 a[174:175], v21 offset:28672
    ds_read_b64_tr_b16 a[176:177], v22 offset:16384
    v_mfma_f32_16x16x32_bf16 v[184:187], a[188:191], a[24:27], v[184:187]
    ds_read_b64_tr_b16 a[178:179], v22 offset:20480
    v_mfma_f32_16x16x32_bf16 v[188:191], a[184:187], a[20:23], v[188:191]
    ds_read_b64_tr_b16 a[180:181], v22 offset:24576
    v_mfma_f32_16x16x32_bf16 v[188:191], a[188:191], a[28:31], v[188:191]
    s_waitcnt lgkmcnt(9)
    buffer_load_dwordx4 a[52:55], v51, s[24:27], s43 offen offset:768 sc1
    v_mfma_f32_16x16x32_bf16 v[192:195], a[160:163], a[16:19], v[192:195]
    s_waitcnt lgkmcnt(7)
    ds_read_b64_tr_b16 a[182:183], v22 offset:28672
    ds_read_b64_tr_b16 a[184:185], v23 offset:16384
    v_mfma_f32_16x16x32_bf16 v[192:195], a[164:167], a[24:27], v[192:195]
    ds_read_b64_tr_b16 a[186:187], v23 offset:20480
    v_mfma_f32_16x16x32_bf16 v[196:199], a[160:163], a[20:23], v[196:199]
    ds_read_b64_tr_b16 a[188:189], v23 offset:24576
    v_mfma_f32_16x16x32_bf16 v[196:199], a[164:167], a[28:31], v[196:199]
    s_waitcnt lgkmcnt(9)
    buffer_load_dwordx4 a[60:63], v51, s[24:27], s43 offen offset:896 sc1
    v_mfma_f32_16x16x32_bf16 v[200:203], a[168:171], a[16:19], v[200:203]
    s_waitcnt lgkmcnt(7)
    ds_read_b64_tr_b16 a[190:191], v23 offset:28672
    ds_read_b64_tr_b16 a[160:161], v24 offset:16384
    v_mfma_f32_16x16x32_bf16 v[200:203], a[172:175], a[24:27], v[200:203]
    ds_read_b64_tr_b16 a[162:163], v24 offset:20480
    v_mfma_f32_16x16x32_bf16 v[204:207], a[168:171], a[20:23], v[204:207]
    ds_read_b64_tr_b16 a[164:165], v24 offset:24576
    v_mfma_f32_16x16x32_bf16 v[204:207], a[172:175], a[28:31], v[204:207]
    s_waitcnt lgkmcnt(9)
    ds_read_b64_tr_b16 a[166:167], v24 offset:28672
    v_mfma_f32_16x16x32_bf16 v[208:211], a[176:179], a[16:19], v[208:211]
    s_waitcnt lgkmcnt(8)
    ds_read_b64_tr_b16 a[168:169], v25 offset:16384
    v_mfma_f32_16x16x32_bf16 v[208:211], a[180:183], a[24:27], v[208:211]
    ds_read_b64_tr_b16 a[170:171], v25 offset:20480
    v_mfma_f32_16x16x32_bf16 v[212:215], a[176:179], a[20:23], v[212:215]
    ds_read_b64_tr_b16 a[172:173], v25 offset:24576
    v_mfma_f32_16x16x32_bf16 v[212:215], a[180:183], a[28:31], v[212:215]
    s_waitcnt lgkmcnt(9)
    ds_read_b64_tr_b16 a[174:175], v25 offset:28672
    v_mfma_f32_16x16x32_bf16 v[216:219], a[184:187], a[16:19], v[216:219]
    s_waitcnt lgkmcnt(8)
    ds_read_b64_tr_b16 a[176:177], v26 offset:16384
    v_mfma_f32_16x16x32_bf16 v[216:219], a[188:191], a[24:27], v[216:219]
    ds_read_b64_tr_b16 a[178:179], v26 offset:20480
    v_mfma_f32_16x16x32_bf16 v[220:223], a[184:187], a[20:23], v[220:223]
    ds_read_b64_tr_b16 a[180:181], v26 offset:24576
    v_mfma_f32_16x16x32_bf16 v[220:223], a[188:191], a[28:31], v[220:223]
    s_waitcnt lgkmcnt(9)
    ds_read_b64_tr_b16 a[182:183], v26 offset:28672
    v_mfma_f32_16x16x32_bf16 v[224:227], a[160:163], a[16:19], v[224:227]
    s_waitcnt lgkmcnt(8)
    ds_read_b64_tr_b16 a[184:185], v27 offset:16384
    v_mfma_f32_16x16x32_bf16 v[224:227], a[164:167], a[24:27], v[224:227]
    ds_read_b64_tr_b16 a[186:187], v27 offset:20480
    v_mfma_f32_16x16x32_bf16 v[228:231], a[160:163], a[20:23], v[228:231]
    ds_read_b64_tr_b16 a[188:189], v27 offset:24576
    v_mfma_f32_16x16x32_bf16 v[228:231], a[164:167], a[28:31], v[228:231]
    s_waitcnt lgkmcnt(9)
    ds_read_b64_tr_b16 a[190:191], v27 offset:28672
    s_barrier
    v_mfma_f32_16x16x32_bf16 v[232:235], a[168:171], a[16:19], v[232:235]
    s_waitcnt lgkmcnt(8)
    ds_read_b64_tr_b16 a[160:161], v20 offset:32768
    v_mfma_f32_16x16x32_bf16 v[232:235], a[172:175], a[24:27], v[232:235]
    s_add_u32 s49, s44, 2097152
    ds_read_b64_tr_b16 a[162:163], v20 offset:36864
    v_mfma_f32_16x16x32_bf16 v[236:239], a[168:171], a[20:23], v[236:239]
    s_add_u32 m0, s42, 0
    ds_read_b64_tr_b16 a[164:165], v20 offset:40960
    v_mfma_f32_16x16x32_bf16 v[236:239], a[172:175], a[28:31], v[236:239]
    s_waitcnt lgkmcnt(9)
    buffer_load_dwordx4 v42, s[16:19], s49 offen lds
    v_mfma_f32_16x16x32_bf16 v[240:243], a[176:179], a[16:19], v[240:243]
    s_waitcnt lgkmcnt(7)
    ds_read_b64_tr_b16 a[166:167], v20 offset:45056
    ds_read_b64_tr_b16 a[168:169], v21 offset:32768
    v_mfma_f32_16x16x32_bf16 v[240:243], a[180:183], a[24:27], v[240:243]
    ds_read_b64_tr_b16 a[170:171], v21 offset:36864
    v_mfma_f32_16x16x32_bf16 v[244:247], a[176:179], a[20:23], v[244:247]
    ds_read_b64_tr_b16 a[172:173], v21 offset:40960
    v_mfma_f32_16x16x32_bf16 v[244:247], a[180:183], a[28:31], v[244:247]
    s_waitcnt lgkmcnt(9)
    buffer_load_dwordx4 v43, s[16:19], s49 offen offset:1024 lds
    v_mfma_f32_16x16x32_bf16 v[248:251], a[184:187], a[16:19], v[248:251]
    s_waitcnt lgkmcnt(7)
    ds_read_b64_tr_b16 a[174:175], v21 offset:45056
    ds_read_b64_tr_b16 a[176:177], v22 offset:32768
    v_mfma_f32_16x16x32_bf16 v[248:251], a[188:191], a[24:27], v[248:251]
    ds_read_b64_tr_b16 a[178:179], v22 offset:36864
    v_mfma_f32_16x16x32_bf16 v[252:255], a[184:187], a[20:23], v[252:255]
    ds_read_b64_tr_b16 a[180:181], v22 offset:40960
    v_mfma_f32_16x16x32_bf16 v[252:255], a[188:191], a[28:31], v[252:255]
    s_waitcnt vmcnt(18)
    s_waitcnt lgkmcnt(9)
    buffer_load_dwordx4 v44, s[16:19], s49 offen offset:2048 lds
    v_mfma_f32_16x16x32_bf16 v[128:131], a[160:163], a[32:35], v[128:131]
    s_waitcnt vmcnt(18)
    s_waitcnt lgkmcnt(7)
    ds_read_b64_tr_b16 a[182:183], v22 offset:45056
    ds_read_b64_tr_b16 a[184:185], v23 offset:32768
    v_mfma_f32_16x16x32_bf16 v[128:131], a[164:167], a[40:43], v[128:131]
    s_waitcnt vmcnt(17)
    ds_read_b64_tr_b16 a[186:187], v23 offset:36864
    v_mfma_f32_16x16x32_bf16 v[132:135], a[160:163], a[36:39], v[132:135]
    s_waitcnt vmcnt(16)
    ds_read_b64_tr_b16 a[188:189], v23 offset:40960
    v_mfma_f32_16x16x32_bf16 v[132:135], a[164:167], a[44:47], v[132:135]
    s_waitcnt lgkmcnt(9)
    buffer_load_dwordx4 v45, s[16:19], s49 offen offset:3072 lds
    v_mfma_f32_16x16x32_bf16 v[136:139], a[168:171], a[32:35], v[136:139]
    s_waitcnt lgkmcnt(7)
    ds_read_b64_tr_b16 a[190:191], v23 offset:45056
    ds_read_b64_tr_b16 a[160:161], v24 offset:32768
    v_mfma_f32_16x16x32_bf16 v[136:139], a[172:175], a[40:43], v[136:139]
    s_add_u32 s49, s44, 2097408
    ds_read_b64_tr_b16 a[162:163], v24 offset:36864
    v_mfma_f32_16x16x32_bf16 v[140:143], a[168:171], a[36:39], v[140:143]
    s_add_u32 m0, s42, 16384
    ds_read_b64_tr_b16 a[164:165], v24 offset:40960
    v_mfma_f32_16x16x32_bf16 v[140:143], a[172:175], a[44:47], v[140:143]
    s_waitcnt lgkmcnt(9)
    buffer_load_dwordx4 v42, s[16:19], s49 offen lds
    v_mfma_f32_16x16x32_bf16 v[144:147], a[176:179], a[32:35], v[144:147]
    s_waitcnt lgkmcnt(7)
    ds_read_b64_tr_b16 a[166:167], v24 offset:45056
    ds_read_b64_tr_b16 a[168:169], v25 offset:32768
    v_mfma_f32_16x16x32_bf16 v[144:147], a[180:183], a[40:43], v[144:147]
    ds_read_b64_tr_b16 a[170:171], v25 offset:36864
    v_mfma_f32_16x16x32_bf16 v[148:151], a[176:179], a[36:39], v[148:151]
    ds_read_b64_tr_b16 a[172:173], v25 offset:40960
    v_mfma_f32_16x16x32_bf16 v[148:151], a[180:183], a[44:47], v[148:151]
    s_waitcnt lgkmcnt(9)
    buffer_load_dwordx4 v43, s[16:19], s49 offen offset:1024 lds
    v_mfma_f32_16x16x32_bf16 v[152:155], a[184:187], a[32:35], v[152:155]
    s_waitcnt lgkmcnt(7)
    ds_read_b64_tr_b16 a[174:175], v25 offset:45056
    ds_read_b64_tr_b16 a[176:177], v26 offset:32768
    v_mfma_f32_16x16x32_bf16 v[152:155], a[188:191], a[40:43], v[152:155]
    ds_read_b64_tr_b16 a[178:179], v26 offset:36864
    v_mfma_f32_16x16x32_bf16 v[156:159], a[184:187], a[36:39], v[156:159]
    ds_read_b64_tr_b16 a[180:181], v26 offset:40960
    v_mfma_f32_16x16x32_bf16 v[156:159], a[188:191], a[44:47], v[156:159]
    s_waitcnt lgkmcnt(9)
    buffer_load_dwordx4 v44, s[16:19], s49 offen offset:2048 lds
    v_mfma_f32_16x16x32_bf16 v[160:163], a[160:163], a[32:35], v[160:163]
    s_waitcnt lgkmcnt(7)
    ds_read_b64_tr_b16 a[182:183], v26 offset:45056
    ds_read_b64_tr_b16 a[184:185], v27 offset:32768
    v_mfma_f32_16x16x32_bf16 v[160:163], a[164:167], a[40:43], v[160:163]
    ds_read_b64_tr_b16 a[186:187], v27 offset:36864
    v_mfma_f32_16x16x32_bf16 v[164:167], a[160:163], a[36:39], v[164:167]
    ds_read_b64_tr_b16 a[188:189], v27 offset:40960
    v_mfma_f32_16x16x32_bf16 v[164:167], a[164:167], a[44:47], v[164:167]
    s_waitcnt lgkmcnt(9)
    buffer_load_dwordx4 v45, s[16:19], s49 offen offset:3072 lds
    v_mfma_f32_16x16x32_bf16 v[168:171], a[168:171], a[32:35], v[168:171]
    s_waitcnt lgkmcnt(7)
    ds_read_b64_tr_b16 a[190:191], v27 offset:45056
    ds_read_b64_tr_b16 a[160:161], v20 offset:49152
    v_mfma_f32_16x16x32_bf16 v[168:171], a[172:175], a[40:43], v[168:171]
    ds_read_b64_tr_b16 a[162:163], v20 offset:53248
    v_mfma_f32_16x16x32_bf16 v[172:175], a[168:171], a[36:39], v[172:175]
    ds_read_b64_tr_b16 a[164:165], v20 offset:57344
    v_mfma_f32_16x16x32_bf16 v[172:175], a[172:175], a[44:47], v[172:175]
    s_waitcnt lgkmcnt(9)
    buffer_load_dwordx4 a[64:67], v51, s[24:27], s46 offen offset:1024 sc1
    v_mfma_f32_16x16x32_bf16 v[176:179], a[176:179], a[32:35], v[176:179]
    s_waitcnt lgkmcnt(7)
    ds_read_b64_tr_b16 a[166:167], v20 offset:61440
    ds_read_b64_tr_b16 a[168:169], v21 offset:49152
    v_mfma_f32_16x16x32_bf16 v[176:179], a[180:183], a[40:43], v[176:179]
    ds_read_b64_tr_b16 a[170:171], v21 offset:53248
    v_mfma_f32_16x16x32_bf16 v[180:183], a[176:179], a[36:39], v[180:183]
    ds_read_b64_tr_b16 a[172:173], v21 offset:57344
    v_mfma_f32_16x16x32_bf16 v[180:183], a[180:183], a[44:47], v[180:183]
    s_waitcnt lgkmcnt(9)
    buffer_load_dwordx4 a[72:75], v51, s[24:27], s46 offen offset:1152 sc1
    v_mfma_f32_16x16x32_bf16 v[184:187], a[184:187], a[32:35], v[184:187]
    s_waitcnt lgkmcnt(7)
    ds_read_b64_tr_b16 a[174:175], v21 offset:61440
    ds_read_b64_tr_b16 a[176:177], v22 offset:49152
    v_mfma_f32_16x16x32_bf16 v[184:187], a[188:191], a[40:43], v[184:187]
    ds_read_b64_tr_b16 a[178:179], v22 offset:53248
    v_mfma_f32_16x16x32_bf16 v[188:191], a[184:187], a[36:39], v[188:191]
    ds_read_b64_tr_b16 a[180:181], v22 offset:57344
    v_mfma_f32_16x16x32_bf16 v[188:191], a[188:191], a[44:47], v[188:191]
    s_waitcnt lgkmcnt(9)
    buffer_load_dwordx4 a[68:71], v51, s[24:27], s43 offen offset:1024 sc1
    v_mfma_f32_16x16x32_bf16 v[192:195], a[160:163], a[32:35], v[192:195]
    s_waitcnt lgkmcnt(7)
    ds_read_b64_tr_b16 a[182:183], v22 offset:61440
    ds_read_b64_tr_b16 a[184:185], v23 offset:49152
    v_mfma_f32_16x16x32_bf16 v[192:195], a[164:167], a[40:43], v[192:195]
    ds_read_b64_tr_b16 a[186:187], v23 offset:53248
    v_mfma_f32_16x16x32_bf16 v[196:199], a[160:163], a[36:39], v[196:199]
    ds_read_b64_tr_b16 a[188:189], v23 offset:57344
    v_mfma_f32_16x16x32_bf16 v[196:199], a[164:167], a[44:47], v[196:199]
    s_waitcnt lgkmcnt(9)
    buffer_load_dwordx4 a[76:79], v51, s[24:27], s43 offen offset:1152 sc1
    v_mfma_f32_16x16x32_bf16 v[200:203], a[168:171], a[32:35], v[200:203]
    s_waitcnt lgkmcnt(7)
    ds_read_b64_tr_b16 a[190:191], v23 offset:61440
    ds_read_b64_tr_b16 a[160:161], v24 offset:49152
    v_mfma_f32_16x16x32_bf16 v[200:203], a[172:175], a[40:43], v[200:203]
    ds_read_b64_tr_b16 a[162:163], v24 offset:53248
    v_mfma_f32_16x16x32_bf16 v[204:207], a[168:171], a[36:39], v[204:207]
    ds_read_b64_tr_b16 a[164:165], v24 offset:57344
    v_mfma_f32_16x16x32_bf16 v[204:207], a[172:175], a[44:47], v[204:207]
    s_waitcnt lgkmcnt(9)
    ds_read_b64_tr_b16 a[166:167], v24 offset:61440
    v_mfma_f32_16x16x32_bf16 v[208:211], a[176:179], a[32:35], v[208:211]
    s_waitcnt lgkmcnt(8)
    ds_read_b64_tr_b16 a[168:169], v25 offset:49152
    v_mfma_f32_16x16x32_bf16 v[208:211], a[180:183], a[40:43], v[208:211]
    ds_read_b64_tr_b16 a[170:171], v25 offset:53248
    v_mfma_f32_16x16x32_bf16 v[212:215], a[176:179], a[36:39], v[212:215]
    ds_read_b64_tr_b16 a[172:173], v25 offset:57344
    v_mfma_f32_16x16x32_bf16 v[212:215], a[180:183], a[44:47], v[212:215]
    s_waitcnt lgkmcnt(9)
    ds_read_b64_tr_b16 a[174:175], v25 offset:61440
    v_mfma_f32_16x16x32_bf16 v[216:219], a[184:187], a[32:35], v[216:219]
    s_waitcnt lgkmcnt(8)
    ds_read_b64_tr_b16 a[176:177], v26 offset:49152
    v_mfma_f32_16x16x32_bf16 v[216:219], a[188:191], a[40:43], v[216:219]
    ds_read_b64_tr_b16 a[178:179], v26 offset:53248
    v_mfma_f32_16x16x32_bf16 v[220:223], a[184:187], a[36:39], v[220:223]
    ds_read_b64_tr_b16 a[180:181], v26 offset:57344
    v_mfma_f32_16x16x32_bf16 v[220:223], a[188:191], a[44:47], v[220:223]
    s_waitcnt lgkmcnt(9)
    ds_read_b64_tr_b16 a[182:183], v26 offset:61440
    v_mfma_f32_16x16x32_bf16 v[224:227], a[160:163], a[32:35], v[224:227]
    s_waitcnt lgkmcnt(8)
    ds_read_b64_tr_b16 a[184:185], v27 offset:49152
    v_mfma_f32_16x16x32_bf16 v[224:227], a[164:167], a[40:43], v[224:227]
    ds_read_b64_tr_b16 a[186:187], v27 offset:53248
    v_mfma_f32_16x16x32_bf16 v[228:231], a[160:163], a[36:39], v[228:231]
    ds_read_b64_tr_b16 a[188:189], v27 offset:57344
    v_mfma_f32_16x16x32_bf16 v[228:231], a[164:167], a[44:47], v[228:231]
    s_waitcnt lgkmcnt(9)
    ds_read_b64_tr_b16 a[190:191], v27 offset:61440
    s_waitcnt vmcnt(16)
    s_barrier
    v_mfma_f32_16x16x32_bf16 v[232:235], a[168:171], a[32:35], v[232:235]
    s_waitcnt lgkmcnt(8)
    ds_read_b64_tr_b16 a[160:161], v28 offset:0
    v_mfma_f32_16x16x32_bf16 v[232:235], a[172:175], a[40:43], v[232:235]
    s_add_u32 s49, s44, 2621440
    ds_read_b64_tr_b16 a[162:163], v28 offset:4096
    v_mfma_f32_16x16x32_bf16 v[236:239], a[168:171], a[36:39], v[236:239]
    s_add_u32 m0, s42, 32768
    ds_read_b64_tr_b16 a[164:165], v28 offset:8192
    v_mfma_f32_16x16x32_bf16 v[236:239], a[172:175], a[44:47], v[236:239]
    s_waitcnt lgkmcnt(9)
    buffer_load_dwordx4 v42, s[16:19], s49 offen lds
    v_mfma_f32_16x16x32_bf16 v[240:243], a[176:179], a[32:35], v[240:243]
    s_waitcnt lgkmcnt(7)
    ds_read_b64_tr_b16 a[166:167], v28 offset:12288
    ds_read_b64_tr_b16 a[168:169], v29 offset:0
    v_mfma_f32_16x16x32_bf16 v[240:243], a[180:183], a[40:43], v[240:243]
    ds_read_b64_tr_b16 a[170:171], v29 offset:4096
    v_mfma_f32_16x16x32_bf16 v[244:247], a[176:179], a[36:39], v[244:247]
    ds_read_b64_tr_b16 a[172:173], v29 offset:8192
    v_mfma_f32_16x16x32_bf16 v[244:247], a[180:183], a[44:47], v[244:247]
    s_waitcnt lgkmcnt(9)
    buffer_load_dwordx4 v43, s[16:19], s49 offen offset:1024 lds
    v_mfma_f32_16x16x32_bf16 v[248:251], a[184:187], a[32:35], v[248:251]
    s_waitcnt lgkmcnt(7)
    ds_read_b64_tr_b16 a[174:175], v29 offset:12288
    ds_read_b64_tr_b16 a[176:177], v30 offset:0
    v_mfma_f32_16x16x32_bf16 v[248:251], a[188:191], a[40:43], v[248:251]
    ds_read_b64_tr_b16 a[178:179], v30 offset:4096
    v_mfma_f32_16x16x32_bf16 v[252:255], a[184:187], a[36:39], v[252:255]
    ds_read_b64_tr_b16 a[180:181], v30 offset:8192
    v_mfma_f32_16x16x32_bf16 v[252:255], a[188:191], a[44:47], v[252:255]
    s_waitcnt vmcnt(17)
    s_waitcnt lgkmcnt(9)
    buffer_load_dwordx4 v44, s[16:19], s49 offen offset:2048 lds
    v_mfma_f32_16x16x32_bf16 v[128:131], a[160:163], a[48:51], v[128:131]
    s_waitcnt vmcnt(17)
    s_waitcnt lgkmcnt(7)
    ds_read_b64_tr_b16 a[182:183], v30 offset:12288
    ds_read_b64_tr_b16 a[184:185], v31 offset:0
    v_mfma_f32_16x16x32_bf16 v[128:131], a[164:167], a[56:59], v[128:131]
    s_waitcnt vmcnt(16)
    ds_read_b64_tr_b16 a[186:187], v31 offset:4096
    v_mfma_f32_16x16x32_bf16 v[132:135], a[160:163], a[52:55], v[132:135]
    s_waitcnt vmcnt(15)
    ds_read_b64_tr_b16 a[188:189], v31 offset:8192
    v_mfma_f32_16x16x32_bf16 v[132:135], a[164:167], a[60:63], v[132:135]
    s_waitcnt lgkmcnt(9)
    buffer_load_dwordx4 v45, s[16:19], s49 offen offset:3072 lds
    v_mfma_f32_16x16x32_bf16 v[136:139], a[168:171], a[48:51], v[136:139]
    s_waitcnt lgkmcnt(7)
    ds_read_b64_tr_b16 a[190:191], v31 offset:12288
    ds_read_b64_tr_b16 a[160:161], v32 offset:0
    v_mfma_f32_16x16x32_bf16 v[136:139], a[172:175], a[56:59], v[136:139]
    s_add_u32 s49, s44, 2621696
    ds_read_b64_tr_b16 a[162:163], v32 offset:4096
    v_mfma_f32_16x16x32_bf16 v[140:143], a[168:171], a[52:55], v[140:143]
    s_add_u32 m0, s42, 49152
    ds_read_b64_tr_b16 a[164:165], v32 offset:8192
    v_mfma_f32_16x16x32_bf16 v[140:143], a[172:175], a[60:63], v[140:143]
    s_waitcnt lgkmcnt(9)
    buffer_load_dwordx4 v42, s[16:19], s49 offen lds
    v_mfma_f32_16x16x32_bf16 v[144:147], a[176:179], a[48:51], v[144:147]
    s_waitcnt lgkmcnt(7)
    ds_read_b64_tr_b16 a[166:167], v32 offset:12288
    ds_read_b64_tr_b16 a[168:169], v33 offset:0
    v_mfma_f32_16x16x32_bf16 v[144:147], a[180:183], a[56:59], v[144:147]
    ds_read_b64_tr_b16 a[170:171], v33 offset:4096
    v_mfma_f32_16x16x32_bf16 v[148:151], a[176:179], a[52:55], v[148:151]
    ds_read_b64_tr_b16 a[172:173], v33 offset:8192
    v_mfma_f32_16x16x32_bf16 v[148:151], a[180:183], a[60:63], v[148:151]
    s_waitcnt lgkmcnt(9)
    buffer_load_dwordx4 v43, s[16:19], s49 offen offset:1024 lds
    v_mfma_f32_16x16x32_bf16 v[152:155], a[184:187], a[48:51], v[152:155]
    s_waitcnt lgkmcnt(7)
    ds_read_b64_tr_b16 a[174:175], v33 offset:12288
    ds_read_b64_tr_b16 a[176:177], v34 offset:0
    v_mfma_f32_16x16x32_bf16 v[152:155], a[188:191], a[56:59], v[152:155]
    ds_read_b64_tr_b16 a[178:179], v34 offset:4096
    v_mfma_f32_16x16x32_bf16 v[156:159], a[184:187], a[52:55], v[156:159]
    ds_read_b64_tr_b16 a[180:181], v34 offset:8192
    v_mfma_f32_16x16x32_bf16 v[156:159], a[188:191], a[60:63], v[156:159]
    s_waitcnt lgkmcnt(9)
    buffer_load_dwordx4 v44, s[16:19], s49 offen offset:2048 lds
    v_mfma_f32_16x16x32_bf16 v[160:163], a[160:163], a[48:51], v[160:163]
    s_waitcnt lgkmcnt(7)
    ds_read_b64_tr_b16 a[182:183], v34 offset:12288
    ds_read_b64_tr_b16 a[184:185], v35 offset:0
    v_mfma_f32_16x16x32_bf16 v[160:163], a[164:167], a[56:59], v[160:163]
    ds_read_b64_tr_b16 a[186:187], v35 offset:4096
    v_mfma_f32_16x16x32_bf16 v[164:167], a[160:163], a[52:55], v[164:167]
    ds_read_b64_tr_b16 a[188:189], v35 offset:8192
    v_mfma_f32_16x16x32_bf16 v[164:167], a[164:167], a[60:63], v[164:167]
    s_waitcnt lgkmcnt(9)
    buffer_load_dwordx4 v45, s[16:19], s49 offen offset:3072 lds
    v_mfma_f32_16x16x32_bf16 v[168:171], a[168:171], a[48:51], v[168:171]
    s_waitcnt lgkmcnt(7)
    ds_read_b64_tr_b16 a[190:191], v35 offset:12288
    ds_read_b64_tr_b16 a[160:161], v28 offset:16384
    v_mfma_f32_16x16x32_bf16 v[168:171], a[172:175], a[56:59], v[168:171]
    ds_read_b64_tr_b16 a[162:163], v28 offset:20480
    v_mfma_f32_16x16x32_bf16 v[172:175], a[168:171], a[52:55], v[172:175]
    ds_read_b64_tr_b16 a[164:165], v28 offset:24576
    v_mfma_f32_16x16x32_bf16 v[172:175], a[172:175], a[60:63], v[172:175]
    s_waitcnt lgkmcnt(9)
    buffer_load_dwordx4 a[80:83], v51, s[24:27], s46 offen offset:1280 sc1
    v_mfma_f32_16x16x32_bf16 v[176:179], a[176:179], a[48:51], v[176:179]
    s_waitcnt lgkmcnt(7)
    ds_read_b64_tr_b16 a[166:167], v28 offset:28672
    ds_read_b64_tr_b16 a[168:169], v29 offset:16384
    v_mfma_f32_16x16x32_bf16 v[176:179], a[180:183], a[56:59], v[176:179]
    ds_read_b64_tr_b16 a[170:171], v29 offset:20480
    v_mfma_f32_16x16x32_bf16 v[180:183], a[176:179], a[52:55], v[180:183]
    ds_read_b64_tr_b16 a[172:173], v29 offset:24576
    v_mfma_f32_16x16x32_bf16 v[180:183], a[180:183], a[60:63], v[180:183]
    s_waitcnt lgkmcnt(9)
    buffer_load_dwordx4 a[88:91], v51, s[24:27], s46 offen offset:1408 sc1
    v_mfma_f32_16x16x32_bf16 v[184:187], a[184:187], a[48:51], v[184:187]
    s_waitcnt lgkmcnt(7)
    ds_read_b64_tr_b16 a[174:175], v29 offset:28672
    ds_read_b64_tr_b16 a[176:177], v30 offset:16384
    v_mfma_f32_16x16x32_bf16 v[184:187], a[188:191], a[56:59], v[184:187]
    ds_read_b64_tr_b16 a[178:179], v30 offset:20480
    v_mfma_f32_16x16x32_bf16 v[188:191], a[184:187], a[52:55], v[188:191]
    ds_read_b64_tr_b16 a[180:181], v30 offset:24576
    v_mfma_f32_16x16x32_bf16 v[188:191], a[188:191], a[60:63], v[188:191]
    s_waitcnt lgkmcnt(9)
    buffer_load_dwordx4 a[84:87], v51, s[24:27], s43 offen offset:1280 sc1
    v_mfma_f32_16x16x32_bf16 v[192:195], a[160:163], a[48:51], v[192:195]
    s_waitcnt lgkmcnt(7)
    ds_read_b64_tr_b16 a[182:183], v30 offset:28672
    ds_read_b64_tr_b16 a[184:185], v31 offset:16384
    v_mfma_f32_16x16x32_bf16 v[192:195], a[164:167], a[56:59], v[192:195]
    ds_read_b64_tr_b16 a[186:187], v31 offset:20480
    v_mfma_f32_16x16x32_bf16 v[196:199], a[160:163], a[52:55], v[196:199]
    ds_read_b64_tr_b16 a[188:189], v31 offset:24576
    v_mfma_f32_16x16x32_bf16 v[196:199], a[164:167], a[60:63], v[196:199]
    s_waitcnt lgkmcnt(9)
    buffer_load_dwordx4 a[92:95], v51, s[24:27], s43 offen offset:1408 sc1
    v_mfma_f32_16x16x32_bf16 v[200:203], a[168:171], a[48:51], v[200:203]
    s_waitcnt lgkmcnt(7)
    ds_read_b64_tr_b16 a[190:191], v31 offset:28672
    ds_read_b64_tr_b16 a[160:161], v32 offset:16384
    v_mfma_f32_16x16x32_bf16 v[200:203], a[172:175], a[56:59], v[200:203]
    ds_read_b64_tr_b16 a[162:163], v32 offset:20480
    v_mfma_f32_16x16x32_bf16 v[204:207], a[168:171], a[52:55], v[204:207]
    ds_read_b64_tr_b16 a[164:165], v32 offset:24576
    v_mfma_f32_16x16x32_bf16 v[204:207], a[172:175], a[60:63], v[204:207]
    s_waitcnt lgkmcnt(9)
    buffer_load_dword v78, v120, s[8:11], 0 offen
    v_mfma_f32_16x16x32_bf16 v[208:211], a[176:179], a[48:51], v[208:211]
    s_waitcnt lgkmcnt(7)
    ds_read_b64_tr_b16 a[166:167], v32 offset:28672
    ds_read_b64_tr_b16 a[168:169], v33 offset:16384
    v_mfma_f32_16x16x32_bf16 v[208:211], a[180:183], a[56:59], v[208:211]
    ds_read_b64_tr_b16 a[170:171], v33 offset:20480
    v_mfma_f32_16x16x32_bf16 v[212:215], a[176:179], a[52:55], v[212:215]
    ds_read_b64_tr_b16 a[172:173], v33 offset:24576
    v_mfma_f32_16x16x32_bf16 v[212:215], a[180:183], a[60:63], v[212:215]
    s_waitcnt lgkmcnt(9)
    buffer_load_dword v79, v121, s[12:15], 0 offen
    v_mfma_f32_16x16x32_bf16 v[216:219], a[184:187], a[48:51], v[216:219]
    s_waitcnt lgkmcnt(7)
    ds_read_b64_tr_b16 a[174:175], v33 offset:28672
    ds_read_b64_tr_b16 a[176:177], v34 offset:16384
    v_mfma_f32_16x16x32_bf16 v[216:219], a[188:191], a[56:59], v[216:219]
    ds_read_b64_tr_b16 a[178:179], v34 offset:20480
    v_mfma_f32_16x16x32_bf16 v[220:223], a[184:187], a[52:55], v[220:223]
    ds_read_b64_tr_b16 a[180:181], v34 offset:24576
    v_mfma_f32_16x16x32_bf16 v[220:223], a[188:191], a[60:63], v[220:223]
    s_waitcnt lgkmcnt(9)
    ds_read_b64_tr_b16 a[182:183], v34 offset:28672
    v_mfma_f32_16x16x32_bf16 v[224:227], a[160:163], a[48:51], v[224:227]
    s_waitcnt lgkmcnt(8)
    ds_read_b64_tr_b16 a[184:185], v35 offset:16384
    v_mfma_f32_16x16x32_bf16 v[224:227], a[164:167], a[56:59], v[224:227]
    ds_read_b64_tr_b16 a[186:187], v35 offset:20480
    v_mfma_f32_16x16x32_bf16 v[228:231], a[160:163], a[52:55], v[228:231]
    ds_read_b64_tr_b16 a[188:189], v35 offset:24576
    v_mfma_f32_16x16x32_bf16 v[228:231], a[164:167], a[60:63], v[228:231]
    s_waitcnt lgkmcnt(9)
    ds_read_b64_tr_b16 a[190:191], v35 offset:28672
    s_waitcnt vmcnt(18)
    s_barrier
    v_mfma_f32_16x16x32_bf16 v[232:235], a[168:171], a[48:51], v[232:235]
    s_waitcnt lgkmcnt(8)
    ds_read_b64_tr_b16 a[160:161], v12 offset:0
    v_mfma_f32_16x16x32_bf16 v[232:235], a[172:175], a[56:59], v[232:235]
    s_add_u32 s49, s44, 3145728
    ds_read_b64_tr_b16 a[162:163], v12 offset:4096
    v_mfma_f32_16x16x32_bf16 v[236:239], a[168:171], a[52:55], v[236:239]
    s_add_u32 m0, s42, 65536
    ds_read_b64_tr_b16 a[164:165], v12 offset:8192
    v_mfma_f32_16x16x32_bf16 v[236:239], a[172:175], a[60:63], v[236:239]
    s_waitcnt lgkmcnt(9)
    buffer_load_dwordx4 v42, s[16:19], s49 offen lds
    v_mfma_f32_16x16x32_bf16 v[240:243], a[176:179], a[48:51], v[240:243]
    s_waitcnt lgkmcnt(7)
    ds_read_b64_tr_b16 a[166:167], v12 offset:12288
    ds_read_b64_tr_b16 a[168:169], v13 offset:0
    v_mfma_f32_16x16x32_bf16 v[240:243], a[180:183], a[56:59], v[240:243]
Ltour1:
    s_cbranch_execz Ltour5
    ds_read_b64_tr_b16 a[170:171], v13 offset:4096
    v_mfma_f32_16x16x32_bf16 v[244:247], a[176:179], a[52:55], v[244:247]
    ds_read_b64_tr_b16 a[172:173], v13 offset:8192
    v_mfma_f32_16x16x32_bf16 v[244:247], a[180:183], a[60:63], v[244:247]
    s_waitcnt lgkmcnt(9)
    buffer_load_dwordx4 v43, s[16:19], s49 offen offset:1024 lds
    v_mfma_f32_16x16x32_bf16 v[248:251], a[184:187], a[48:51], v[248:251]
    s_waitcnt lgkmcnt(7)
    ds_read_b64_tr_b16 a[174:175], v13 offset:12288
    ds_read_b64_tr_b16 a[176:177], v14 offset:0
    v_mfma_f32_16x16x32_bf16 v[248:251], a[188:191], a[56:59], v[248:251]
    ds_read_b64_tr_b16 a[178:179], v14 offset:4096
    v_mfma_f32_16x16x32_bf16 v[252:255], a[184:187], a[52:55], v[252:255]
    ds_read_b64_tr_b16 a[180:181], v14 offset:8192
    v_mfma_f32_16x16x32_bf16 v[252:255], a[188:191], a[60:63], v[252:255]
    s_waitcnt vmcnt(19)
    s_waitcnt lgkmcnt(9)
    buffer_load_dwordx4 v44, s[16:19], s49 offen offset:2048 lds
    v_mfma_f32_16x16x32_bf16 v[128:131], a[160:163], a[64:67], v[128:131]
    s_waitcnt vmcnt(19)
    s_waitcnt lgkmcnt(7)
    ds_read_b64_tr_b16 a[182:183], v14 offset:12288
    ds_read_b64_tr_b16 a[184:185], v15 offset:0
    v_mfma_f32_16x16x32_bf16 v[128:131], a[164:167], a[72:75], v[128:131]
    s_waitcnt vmcnt(18)
    ds_read_b64_tr_b16 a[186:187], v15 offset:4096
    v_mfma_f32_16x16x32_bf16 v[132:135], a[160:163], a[68:71], v[132:135]
    s_waitcnt vmcnt(17)
    ds_read_b64_tr_b16 a[188:189], v15 offset:8192
    v_mfma_f32_16x16x32_bf16 v[132:135], a[164:167], a[76:79], v[132:135]
    s_waitcnt lgkmcnt(9)
    buffer_load_dwordx4 v45, s[16:19], s49 offen offset:3072 lds
    v_mfma_f32_16x16x32_bf16 v[136:139], a[168:171], a[64:67], v[136:139]
    s_waitcnt lgkmcnt(7)
    ds_read_b64_tr_b16 a[190:191], v15 offset:12288
    ds_read_b64_tr_b16 a[160:161], v16 offset:0
    v_mfma_f32_16x16x32_bf16 v[136:139], a[172:175], a[72:75], v[136:139]
    s_add_u32 s49, s44, 3145984
    ds_read_b64_tr_b16 a[162:163], v16 offset:4096
    v_mfma_f32_16x16x32_bf16 v[140:143], a[168:171], a[68:71], v[140:143]
    s_add_u32 m0, s42, 81920
    ds_read_b64_tr_b16 a[164:165], v16 offset:8192
    v_mfma_f32_16x16x32_bf16 v[140:143], a[172:175], a[76:79], v[140:143]
    s_waitcnt lgkmcnt(9)
    buffer_load_dwordx4 v42, s[16:19], s49 offen lds
    v_mfma_f32_16x16x32_bf16 v[144:147], a[176:179], a[64:67], v[144:147]
    s_waitcnt lgkmcnt(7)
    ds_read_b64_tr_b16 a[166:167], v16 offset:12288
    ds_read_b64_tr_b16 a[168:169], v17 offset:0
    v_mfma_f32_16x16x32_bf16 v[144:147], a[180:183], a[72:75], v[144:147]
    ds_read_b64_tr_b16 a[170:171], v17 offset:4096
    v_mfma_f32_16x16x32_bf16 v[148:151], a[176:179], a[68:71], v[148:151]
    ds_read_b64_tr_b16 a[172:173], v17 offset:8192
    v_mfma_f32_16x16x32_bf16 v[148:151], a[180:183], a[76:79], v[148:151]
    s_waitcnt lgkmcnt(9)
    buffer_load_dwordx4 v43, s[16:19], s49 offen offset:1024 lds
    v_mfma_f32_16x16x32_bf16 v[152:155], a[184:187], a[64:67], v[152:155]
    s_waitcnt lgkmcnt(7)
    ds_read_b64_tr_b16 a[174:175], v17 offset:12288
    ds_read_b64_tr_b16 a[176:177], v18 offset:0
    v_mfma_f32_16x16x32_bf16 v[152:155], a[188:191], a[72:75], v[152:155]
    ds_read_b64_tr_b16 a[178:179], v18 offset:4096
    v_mfma_f32_16x16x32_bf16 v[156:159], a[184:187], a[68:71], v[156:159]
    ds_read_b64_tr_b16 a[180:181], v18 offset:8192
    v_mfma_f32_16x16x32_bf16 v[156:159], a[188:191], a[76:79], v[156:159]
    s_waitcnt lgkmcnt(9)
    buffer_load_dwordx4 v44, s[16:19], s49 offen offset:2048 lds
    v_mfma_f32_16x16x32_bf16 v[160:163], a[160:163], a[64:67], v[160:163]
    s_waitcnt lgkmcnt(7)
    ds_read_b64_tr_b16 a[182:183], v18 offset:12288
    ds_read_b64_tr_b16 a[184:185], v19 offset:0
    v_mfma_f32_16x16x32_bf16 v[160:163], a[164:167], a[72:75], v[160:163]
    ds_read_b64_tr_b16 a[186:187], v19 offset:4096
    v_mfma_f32_16x16x32_bf16 v[164:167], a[160:163], a[68:71], v[164:167]
    ds_read_b64_tr_b16 a[188:189], v19 offset:8192
    v_mfma_f32_16x16x32_bf16 v[164:167], a[164:167], a[76:79], v[164:167]
    s_waitcnt lgkmcnt(9)
    buffer_load_dwordx4 v45, s[16:19], s49 offen offset:3072 lds
    v_mfma_f32_16x16x32_bf16 v[168:171], a[168:171], a[64:67], v[168:171]
    s_waitcnt lgkmcnt(7)
    ds_read_b64_tr_b16 a[190:191], v19 offset:12288
    ds_read_b64_tr_b16 a[160:161], v12 offset:16384
    v_mfma_f32_16x16x32_bf16 v[168:171], a[172:175], a[72:75], v[168:171]
    ds_read_b64_tr_b16 a[162:163], v12 offset:20480
    v_mfma_f32_16x16x32_bf16 v[172:175], a[168:171], a[68:71], v[172:175]
    ds_read_b64_tr_b16 a[164:165], v12 offset:24576
    v_mfma_f32_16x16x32_bf16 v[172:175], a[172:175], a[76:79], v[172:175]
    s_waitcnt lgkmcnt(9)
    buffer_load_dwordx4 a[96:99], v51, s[24:27], s46 offen offset:1536 sc1
    v_mfma_f32_16x16x32_bf16 v[176:179], a[176:179], a[64:67], v[176:179]
    s_waitcnt lgkmcnt(7)
    ds_read_b64_tr_b16 a[166:167], v12 offset:28672
    ds_read_b64_tr_b16 a[168:169], v13 offset:16384
    v_mfma_f32_16x16x32_bf16 v[176:179], a[180:183], a[72:75], v[176:179]
    ds_read_b64_tr_b16 a[170:171], v13 offset:20480
    v_mfma_f32_16x16x32_bf16 v[180:183], a[176:179], a[68:71], v[180:183]
    ds_read_b64_tr_b16 a[172:173], v13 offset:24576
    v_mfma_f32_16x16x32_bf16 v[180:183], a[180:183], a[76:79], v[180:183]
    s_waitcnt lgkmcnt(9)
    buffer_load_dwordx4 a[104:107], v51, s[24:27], s46 offen offset:1664 sc1
    v_mfma_f32_16x16x32_bf16 v[184:187], a[184:187], a[64:67], v[184:187]
    s_waitcnt lgkmcnt(7)
    ds_read_b64_tr_b16 a[174:175], v13 offset:28672
    ds_read_b64_tr_b16 a[176:177], v14 offset:16384
    v_mfma_f32_16x16x32_bf16 v[184:187], a[188:191], a[72:75], v[184:187]
    ds_read_b64_tr_b16 a[178:179], v14 offset:20480
    v_mfma_f32_16x16x32_bf16 v[188:191], a[184:187], a[68:71], v[188:191]
    ds_read_b64_tr_b16 a[180:181], v14 offset:24576
    v_mfma_f32_16x16x32_bf16 v[188:191], a[188:191], a[76:79], v[188:191]
    s_waitcnt lgkmcnt(9)
    buffer_load_dwordx4 a[100:103], v51, s[24:27], s43 offen offset:1536 sc1
    v_mfma_f32_16x16x32_bf16 v[192:195], a[160:163], a[64:67], v[192:195]
    s_waitcnt lgkmcnt(7)
    ds_read_b64_tr_b16 a[182:183], v14 offset:28672
    ds_read_b64_tr_b16 a[184:185], v15 offset:16384
    v_mfma_f32_16x16x32_bf16 v[192:195], a[164:167], a[72:75], v[192:195]
    ds_read_b64_tr_b16 a[186:187], v15 offset:20480
    v_mfma_f32_16x16x32_bf16 v[196:199], a[160:163], a[68:71], v[196:199]
    ds_read_b64_tr_b16 a[188:189], v15 offset:24576
    v_mfma_f32_16x16x32_bf16 v[196:199], a[164:167], a[76:79], v[196:199]
    s_waitcnt lgkmcnt(9)
    buffer_load_dwordx4 a[108:111], v51, s[24:27], s43 offen offset:1664 sc1
    v_mfma_f32_16x16x32_bf16 v[200:203], a[168:171], a[64:67], v[200:203]
    s_waitcnt lgkmcnt(7)
    ds_read_b64_tr_b16 a[190:191], v15 offset:28672
    ds_read_b64_tr_b16 a[160:161], v16 offset:16384
    v_mfma_f32_16x16x32_bf16 v[200:203], a[172:175], a[72:75], v[200:203]
    ds_read_b64_tr_b16 a[162:163], v16 offset:20480
    v_mfma_f32_16x16x32_bf16 v[204:207], a[168:171], a[68:71], v[204:207]
    ds_read_b64_tr_b16 a[164:165], v16 offset:24576
    v_mfma_f32_16x16x32_bf16 v[204:207], a[172:175], a[76:79], v[204:207]
    s_waitcnt lgkmcnt(9)
    ds_read_b64_tr_b16 a[166:167], v16 offset:28672
    v_mfma_f32_16x16x32_bf16 v[208:211], a[176:179], a[64:67], v[208:211]
    s_waitcnt lgkmcnt(8)
    ds_read_b64_tr_b16 a[168:169], v17 offset:16384
    v_mfma_f32_16x16x32_bf16 v[208:211], a[180:183], a[72:75], v[208:211]
    ds_read_b64_tr_b16 a[170:171], v17 offset:20480
    v_mfma_f32_16x16x32_bf16 v[212:215], a[176:179], a[68:71], v[212:215]
    ds_read_b64_tr_b16 a[172:173], v17 offset:24576
    v_mfma_f32_16x16x32_bf16 v[212:215], a[180:183], a[76:79], v[212:215]
    s_waitcnt lgkmcnt(9)
    ds_read_b64_tr_b16 a[174:175], v17 offset:28672
    v_mfma_f32_16x16x32_bf16 v[216:219], a[184:187], a[64:67], v[216:219]
    s_waitcnt lgkmcnt(8)
    ds_read_b64_tr_b16 a[176:177], v18 offset:16384
    v_mfma_f32_16x16x32_bf16 v[216:219], a[188:191], a[72:75], v[216:219]
    ds_read_b64_tr_b16 a[178:179], v18 offset:20480
    v_mfma_f32_16x16x32_bf16 v[220:223], a[184:187], a[68:71], v[220:223]
    ds_read_b64_tr_b16 a[180:181], v18 offset:24576
    v_mfma_f32_16x16x32_bf16 v[220:223], a[188:191], a[76:79], v[220:223]
    s_waitcnt lgkmcnt(9)
    ds_read_b64_tr_b16 a[182:183], v18 offset:28672
    v_mfma_f32_16x16x32_bf16 v[224:227], a[160:163], a[64:67], v[224:227]
    s_waitcnt lgkmcnt(8)
    ds_read_b64_tr_b16 a[184:185], v19 offset:16384
    v_mfma_f32_16x16x32_bf16 v[224:227], a[164:167], a[72:75], v[224:227]
    ds_read_b64_tr_b16 a[186:187], v19 offset:20480
    v_mfma_f32_16x16x32_bf16 v[228:231], a[160:163], a[68:71], v[228:231]
    ds_read_b64_tr_b16 a[188:189], v19 offset:24576
    v_mfma_f32_16x16x32_bf16 v[228:231], a[164:167], a[76:79], v[228:231]
    s_waitcnt lgkmcnt(9)
    ds_read_b64_tr_b16 a[190:191], v19 offset:28672
    s_waitcnt vmcnt(18)
    s_barrier
    v_mfma_f32_16x16x32_bf16 v[232:235], a[168:171], a[64:67], v[232:235]
    s_waitcnt lgkmcnt(8)
    ds_read_b64_tr_b16 a[160:161], v12 offset:32768
    v_mfma_f32_16x16x32_bf16 v[232:235], a[172:175], a[72:75], v[232:235]
    s_add_u32 s49, s44, 3670016
    ds_read_b64_tr_b16 a[162:163], v12 offset:36864
    v_mfma_f32_16x16x32_bf16 v[236:239], a[168:171], a[68:71], v[236:239]
    s_add_u32 m0, s42, 98304
    ds_read_b64_tr_b16 a[164:165], v12 offset:40960
    v_mfma_f32_16x16x32_bf16 v[236:239], a[172:175], a[76:79], v[236:239]
    s_waitcnt lgkmcnt(9)
    buffer_load_dwordx4 v42, s[16:19], s49 offen lds
    v_mfma_f32_16x16x32_bf16 v[240:243], a[176:179], a[64:67], v[240:243]
    s_waitcnt lgkmcnt(7)
    ds_read_b64_tr_b16 a[166:167], v12 offset:45056
    ds_read_b64_tr_b16 a[168:169], v13 offset:32768
    v_mfma_f32_16x16x32_bf16 v[240:243], a[180:183], a[72:75], v[240:243]
    ds_read_b64_tr_b16 a[170:171], v13 offset:36864
    v_mfma_f32_16x16x32_bf16 v[244:247], a[176:179], a[68:71], v[244:247]
    ds_read_b64_tr_b16 a[172:173], v13 offset:40960
    v_mfma_f32_16x16x32_bf16 v[244:247], a[180:183], a[76:79], v[244:247]
    s_waitcnt lgkmcnt(9)
    buffer_load_dwordx4 v43, s[16:19], s49 offen offset:1024 lds
    v_mfma_f32_16x16x32_bf16 v[248:251], a[184:187], a[64:67], v[248:251]
    s_waitcnt lgkmcnt(7)
    ds_read_b64_tr_b16 a[174:175], v13 offset:45056
    ds_read_b64_tr_b16 a[176:177], v14 offset:32768
    v_mfma_f32_16x16x32_bf16 v[248:251], a[188:191], a[72:75], v[248:251]
    ds_read_b64_tr_b16 a[178:179], v14 offset:36864
    v_mfma_f32_16x16x32_bf16 v[252:255], a[184:187], a[68:71], v[252:255]
    ds_read_b64_tr_b16 a[180:181], v14 offset:40960
    v_mfma_f32_16x16x32_bf16 v[252:255], a[188:191], a[76:79], v[252:255]
    s_waitcnt vmcnt(19)
    s_waitcnt lgkmcnt(9)
    buffer_load_dwordx4 v44, s[16:19], s49 offen offset:2048 lds
    v_mfma_f32_16x16x32_bf16 v[128:131], a[160:163], a[80:83], v[128:131]
    s_waitcnt vmcnt(19)
    s_waitcnt lgkmcnt(7)
    ds_read_b64_tr_b16 a[182:183], v14 offset:45056
    ds_read_b64_tr_b16 a[184:185], v15 offset:32768
    v_mfma_f32_16x16x32_bf16 v[128:131], a[164:167], a[88:91], v[128:131]
    s_waitcnt vmcnt(18)
    ds_read_b64_tr_b16 a[186:187], v15 offset:36864
    v_accvgpr_write_b32 a0, 0
    v_mfma_f32_16x16x32_bf16 v[132:135], a[160:163], a[84:87], v[132:135]
    s_waitcnt vmcnt(17)
    ds_read_b64_tr_b16 a[188:189], v15 offset:40960
    v_accvgpr_write_b32 a1, 0
    v_mfma_f32_16x16x32_bf16 v[132:135], a[164:167], a[92:95], v[132:135]
    s_waitcnt lgkmcnt(9)
    buffer_load_dwordx4 v45, s[16:19], s49 offen offset:3072 lds
    v_mfma_f32_16x16x32_bf16 v[136:139], a[168:171], a[80:83], v[136:139]
    s_waitcnt lgkmcnt(7)
    ds_read_b64_tr_b16 a[190:191], v15 offset:45056
    ds_read_b64_tr_b16 a[160:161], v16 offset:32768
    v_mfma_f32_16x16x32_bf16 v[136:139], a[172:175], a[88:91], v[136:139]
    s_add_u32 s49, s44, 3670272
    ds_read_b64_tr_b16 a[162:163], v16 offset:36864
    v_accvgpr_write_b32 a2, 0
    v_mfma_f32_16x16x32_bf16 v[140:143], a[168:171], a[84:87], v[140:143]
    s_add_u32 m0, s42, 114688
    ds_read_b64_tr_b16 a[164:165], v16 offset:40960
    v_accvgpr_write_b32 a3, 0
    v_mfma_f32_16x16x32_bf16 v[140:143], a[172:175], a[92:95], v[140:143]
    s_waitcnt lgkmcnt(9)
    buffer_load_dwordx4 v42, s[16:19], s49 offen lds
    v_mfma_f32_16x16x32_bf16 v[144:147], a[176:179], a[80:83], v[144:147]
    s_waitcnt lgkmcnt(7)
    ds_read_b64_tr_b16 a[166:167], v16 offset:45056
    ds_read_b64_tr_b16 a[168:169], v17 offset:32768
    v_mfma_f32_16x16x32_bf16 v[144:147], a[180:183], a[88:91], v[144:147]
    ds_read_b64_tr_b16 a[170:171], v17 offset:36864
    v_accvgpr_write_b32 a4, 0
    v_mfma_f32_16x16x32_bf16 v[148:151], a[176:179], a[84:87], v[148:151]
    ds_read_b64_tr_b16 a[172:173], v17 offset:40960
    v_accvgpr_write_b32 a5, 0
    v_mfma_f32_16x16x32_bf16 v[148:151], a[180:183], a[92:95], v[148:151]
    s_waitcnt lgkmcnt(9)
    buffer_load_dwordx4 v43, s[16:19], s49 offen offset:1024 lds
    v_mfma_f32_16x16x32_bf16 v[152:155], a[184:187], a[80:83], v[152:155]
    s_waitcnt lgkmcnt(7)
    ds_read_b64_tr_b16 a[174:175], v17 offset:45056
    ds_read_b64_tr_b16 a[176:177], v18 offset:32768
    v_mfma_f32_16x16x32_bf16 v[152:155], a[188:191], a[88:91], v[152:155]
    ds_read_b64_tr_b16 a[178:179], v18 offset:36864
    v_accvgpr_write_b32 a6, 0
    v_mfma_f32_16x16x32_bf16 v[156:159], a[184:187], a[84:87], v[156:159]
    ds_read_b64_tr_b16 a[180:181], v18 offset:40960
    v_accvgpr_write_b32 a7, 0
    v_mfma_f32_16x16x32_bf16 v[156:159], a[188:191], a[92:95], v[156:159]
    s_waitcnt lgkmcnt(9)
    buffer_load_dwordx4 v44, s[16:19], s49 offen offset:2048 lds
    v_mfma_f32_16x16x32_bf16 v[160:163], a[160:163], a[80:83], v[160:163]
    s_waitcnt lgkmcnt(7)
    ds_read_b64_tr_b16 a[182:183], v18 offset:45056
    ds_read_b64_tr_b16 a[184:185], v19 offset:32768
    v_mfma_f32_16x16x32_bf16 v[160:163], a[164:167], a[88:91], v[160:163]
    ds_read_b64_tr_b16 a[186:187], v19 offset:36864
    v_accvgpr_write_b32 a8, 0
    v_mfma_f32_16x16x32_bf16 v[164:167], a[160:163], a[84:87], v[164:167]
    ds_read_b64_tr_b16 a[188:189], v19 offset:40960
    v_accvgpr_write_b32 a9, 0
    v_mfma_f32_16x16x32_bf16 v[164:167], a[164:167], a[92:95], v[164:167]
    s_waitcnt lgkmcnt(9)
    buffer_load_dwordx4 v45, s[16:19], s49 offen offset:3072 lds
    v_mfma_f32_16x16x32_bf16 v[168:171], a[168:171], a[80:83], v[168:171]
    s_waitcnt lgkmcnt(7)
    ds_read_b64_tr_b16 a[190:191], v19 offset:45056
    ds_read_b64_tr_b16 a[160:161], v12 offset:49152
    v_mfma_f32_16x16x32_bf16 v[168:171], a[172:175], a[88:91], v[168:171]
    ds_read_b64_tr_b16 a[162:163], v12 offset:53248
    v_accvgpr_write_b32 a10, 0
    v_mfma_f32_16x16x32_bf16 v[172:175], a[168:171], a[84:87], v[172:175]
    ds_read_b64_tr_b16 a[164:165], v12 offset:57344
    v_accvgpr_write_b32 a11, 0
    v_mfma_f32_16x16x32_bf16 v[172:175], a[172:175], a[92:95], v[172:175]
    s_waitcnt lgkmcnt(9)
    buffer_load_dwordx4 a[112:115], v51, s[24:27], s46 offen offset:1792 sc1
    v_mfma_f32_16x16x32_bf16 v[176:179], a[176:179], a[80:83], v[176:179]
    s_waitcnt lgkmcnt(7)
    ds_read_b64_tr_b16 a[166:167], v12 offset:61440
    ds_read_b64_tr_b16 a[168:169], v13 offset:49152
    v_mfma_f32_16x16x32_bf16 v[176:179], a[180:183], a[88:91], v[176:179]
    ds_read_b64_tr_b16 a[170:171], v13 offset:53248
    v_accvgpr_write_b32 a12, 0
    v_mfma_f32_16x16x32_bf16 v[180:183], a[176:179], a[84:87], v[180:183]
    ds_read_b64_tr_b16 a[172:173], v13 offset:57344
    v_accvgpr_write_b32 a13, 0
    v_mfma_f32_16x16x32_bf16 v[180:183], a[180:183], a[92:95], v[180:183]
    s_waitcnt lgkmcnt(9)
    buffer_load_dwordx4 a[120:123], v51, s[24:27], s46 offen offset:1920 sc1
    v_mfma_f32_16x16x32_bf16 v[184:187], a[184:187], a[80:83], v[184:187]
    s_waitcnt lgkmcnt(7)
    ds_read_b64_tr_b16 a[174:175], v13 offset:61440
    ds_read_b64_tr_b16 a[176:177], v14 offset:49152
    v_mfma_f32_16x16x32_bf16 v[184:187], a[188:191], a[88:91], v[184:187]
    ds_read_b64_tr_b16 a[178:179], v14 offset:53248
    v_accvgpr_write_b32 a14, 0
    v_mfma_f32_16x16x32_bf16 v[188:191], a[184:187], a[84:87], v[188:191]
    ds_read_b64_tr_b16 a[180:181], v14 offset:57344
    v_accvgpr_write_b32 a15, 0
    v_mfma_f32_16x16x32_bf16 v[188:191], a[188:191], a[92:95], v[188:191]
    s_waitcnt lgkmcnt(9)
    buffer_load_dwordx4 a[116:119], v51, s[24:27], s43 offen offset:1792 sc1
    v_mfma_f32_16x16x32_bf16 v[192:195], a[160:163], a[80:83], v[192:195]
    s_waitcnt lgkmcnt(7)
    ds_read_b64_tr_b16 a[182:183], v14 offset:61440
    ds_read_b64_tr_b16 a[184:185], v15 offset:49152
    v_mfma_f32_16x16x32_bf16 v[192:195], a[164:167], a[88:91], v[192:195]
    ds_read_b64_tr_b16 a[186:187], v15 offset:53248
    v_accvgpr_write_b32 a16, 0
    v_mfma_f32_16x16x32_bf16 v[196:199], a[160:163], a[84:87], v[196:199]
    ds_read_b64_tr_b16 a[188:189], v15 offset:57344
    v_accvgpr_write_b32 a17, 0
    v_mfma_f32_16x16x32_bf16 v[196:199], a[164:167], a[92:95], v[196:199]
    s_waitcnt lgkmcnt(9)
    buffer_load_dwordx4 a[124:127], v51, s[24:27], s43 offen offset:1920 sc1
    v_mfma_f32_16x16x32_bf16 v[200:203], a[168:171], a[80:83], v[200:203]
    s_waitcnt lgkmcnt(7)
    ds_read_b64_tr_b16 a[190:191], v15 offset:61440
    ds_read_b64_tr_b16 a[160:161], v16 offset:49152
    v_mfma_f32_16x16x32_bf16 v[200:203], a[172:175], a[88:91], v[200:203]
    ds_read_b64_tr_b16 a[162:163], v16 offset:53248
    v_accvgpr_write_b32 a18, 0
    v_mfma_f32_16x16x32_bf16 v[204:207], a[168:171], a[84:87], v[204:207]
    ds_read_b64_tr_b16 a[164:165], v16 offset:57344
    v_accvgpr_write_b32 a19, 0
    v_mfma_f32_16x16x32_bf16 v[204:207], a[172:175], a[92:95], v[204:207]
    s_waitcnt lgkmcnt(9)
    ds_read_b64_tr_b16 a[166:167], v16 offset:61440
    v_accvgpr_write_b32 a20, 0
    v_mfma_f32_16x16x32_bf16 v[208:211], a[176:179], a[80:83], v[208:211]
    s_waitcnt lgkmcnt(8)
    ds_read_b64_tr_b16 a[168:169], v17 offset:49152
    v_accvgpr_write_b32 a21, 0
    v_mfma_f32_16x16x32_bf16 v[208:211], a[180:183], a[88:91], v[208:211]
    ds_read_b64_tr_b16 a[170:171], v17 offset:53248
    v_accvgpr_write_b32 a22, 0
    v_mfma_f32_16x16x32_bf16 v[212:215], a[176:179], a[84:87], v[212:215]
    ds_read_b64_tr_b16 a[172:173], v17 offset:57344
    v_accvgpr_write_b32 a23, 0
    v_mfma_f32_16x16x32_bf16 v[212:215], a[180:183], a[92:95], v[212:215]
    s_waitcnt lgkmcnt(9)
    ds_read_b64_tr_b16 a[174:175], v17 offset:61440
    v_accvgpr_write_b32 a24, 0
    v_mfma_f32_16x16x32_bf16 v[216:219], a[184:187], a[80:83], v[216:219]
    s_waitcnt lgkmcnt(8)
    ds_read_b64_tr_b16 a[176:177], v18 offset:49152
    v_accvgpr_write_b32 a25, 0
    v_mfma_f32_16x16x32_bf16 v[216:219], a[188:191], a[88:91], v[216:219]
    ds_read_b64_tr_b16 a[178:179], v18 offset:53248
    v_accvgpr_write_b32 a26, 0
    v_mfma_f32_16x16x32_bf16 v[220:223], a[184:187], a[84:87], v[220:223]
    ds_read_b64_tr_b16 a[180:181], v18 offset:57344
    v_accvgpr_write_b32 a27, 0
    v_mfma_f32_16x16x32_bf16 v[220:223], a[188:191], a[92:95], v[220:223]
    s_waitcnt lgkmcnt(9)
    ds_read_b64_tr_b16 a[182:183], v18 offset:61440
    v_accvgpr_write_b32 a28, 0
    v_mfma_f32_16x16x32_bf16 v[224:227], a[160:163], a[80:83], v[224:227]
    s_waitcnt lgkmcnt(8)
    ds_read_b64_tr_b16 a[184:185], v19 offset:49152
    v_accvgpr_write_b32 a29, 0
    v_mfma_f32_16x16x32_bf16 v[224:227], a[164:167], a[88:91], v[224:227]
    ds_read_b64_tr_b16 a[186:187], v19 offset:53248
    v_accvgpr_write_b32 a30, 0
    v_mfma_f32_16x16x32_bf16 v[228:231], a[160:163], a[84:87], v[228:231]
    ds_read_b64_tr_b16 a[188:189], v19 offset:57344
    v_accvgpr_write_b32 a31, 0
    v_mfma_f32_16x16x32_bf16 v[228:231], a[164:167], a[92:95], v[228:231]
    s_waitcnt lgkmcnt(9)
    ds_read_b64_tr_b16 a[190:191], v19 offset:61440
    v_accvgpr_write_b32 a32, 0
    s_waitcnt vmcnt(16)
    s_barrier
    v_mfma_f32_16x16x32_bf16 v[232:235], a[168:171], a[80:83], v[232:235]
    s_waitcnt lgkmcnt(8)
    ds_read_b64_tr_b16 a[160:161], v20 offset:0
    v_accvgpr_write_b32 a33, 0
    v_mfma_f32_16x16x32_bf16 v[232:235], a[172:175], a[88:91], v[232:235]
    s_add_u32 s49, s44, 4194304
    ds_read_b64_tr_b16 a[162:163], v20 offset:4096
    v_accvgpr_write_b32 a34, 0
    v_mfma_f32_16x16x32_bf16 v[236:239], a[168:171], a[84:87], v[236:239]
    s_add_u32 m0, s42, 131072
    ds_read_b64_tr_b16 a[164:165], v20 offset:8192
    v_accvgpr_write_b32 a35, 0
    v_mfma_f32_16x16x32_bf16 v[236:239], a[172:175], a[92:95], v[236:239]
    s_waitcnt lgkmcnt(9)
    buffer_load_dwordx4 v42, s[16:19], s49 offen lds
    v_mfma_f32_16x16x32_bf16 v[240:243], a[176:179], a[80:83], v[240:243]
    s_waitcnt lgkmcnt(7)
    ds_read_b64_tr_b16 a[166:167], v20 offset:12288
    ds_read_b64_tr_b16 a[168:169], v21 offset:0
    v_mfma_f32_16x16x32_bf16 v[240:243], a[180:183], a[88:91], v[240:243]
    ds_read_b64_tr_b16 a[170:171], v21 offset:4096
    v_accvgpr_write_b32 a36, 0
    v_mfma_f32_16x16x32_bf16 v[244:247], a[176:179], a[84:87], v[244:247]
    ds_read_b64_tr_b16 a[172:173], v21 offset:8192
    v_accvgpr_write_b32 a37, 0
    v_mfma_f32_16x16x32_bf16 v[244:247], a[180:183], a[92:95], v[244:247]
    s_waitcnt lgkmcnt(9)
    buffer_load_dwordx4 v43, s[16:19], s49 offen offset:1024 lds
    v_mfma_f32_16x16x32_bf16 v[248:251], a[184:187], a[80:83], v[248:251]
    s_waitcnt lgkmcnt(7)
    ds_read_b64_tr_b16 a[174:175], v21 offset:12288
    ds_read_b64_tr_b16 a[176:177], v22 offset:0
    v_mfma_f32_16x16x32_bf16 v[248:251], a[188:191], a[88:91], v[248:251]
    ds_read_b64_tr_b16 a[178:179], v22 offset:4096
    v_accvgpr_write_b32 a38, 0
    v_mfma_f32_16x16x32_bf16 v[252:255], a[184:187], a[84:87], v[252:255]
    ds_read_b64_tr_b16 a[180:181], v22 offset:8192
    v_accvgpr_write_b32 a39, 0
    v_mfma_f32_16x16x32_bf16 v[252:255], a[188:191], a[92:95], v[252:255]
    s_waitcnt vmcnt(17)
    s_waitcnt lgkmcnt(9)
    buffer_load_dwordx4 v44, s[16:19], s49 offen offset:2048 lds
    v_mfma_f32_16x16x32_bf16 v[128:131], a[160:163], a[96:99], v[128:131]
    s_waitcnt vmcnt(17)
    s_waitcnt lgkmcnt(7)
    ds_read_b64_tr_b16 a[182:183], v22 offset:12288
    ds_read_b64_tr_b16 a[184:185], v23 offset:0
    v_mfma_f32_16x16x32_bf16 v[128:131], a[164:167], a[104:107], v[128:131]
    s_waitcnt vmcnt(16)
    ds_read_b64_tr_b16 a[186:187], v23 offset:4096
    v_accvgpr_write_b32 a40, 0
    v_mfma_f32_16x16x32_bf16 v[132:135], a[160:163], a[100:103], v[132:135]
    s_waitcnt vmcnt(15)
    ds_read_b64_tr_b16 a[188:189], v23 offset:8192
    v_accvgpr_write_b32 a41, 0
    v_mfma_f32_16x16x32_bf16 v[132:135], a[164:167], a[108:111], v[132:135]
    s_waitcnt lgkmcnt(9)
    buffer_load_dwordx4 v45, s[16:19], s49 offen offset:3072 lds
    v_mfma_f32_16x16x32_bf16 v[136:139], a[168:171], a[96:99], v[136:139]
    s_waitcnt lgkmcnt(7)
    ds_read_b64_tr_b16 a[190:191], v23 offset:12288
    ds_read_b64_tr_b16 a[160:161], v24 offset:0
    v_mfma_f32_16x16x32_bf16 v[136:139], a[172:175], a[104:107], v[136:139]
    s_add_u32 s49, s44, 4194560
    ds_read_b64_tr_b16 a[162:163], v24 offset:4096
    v_accvgpr_write_b32 a42, 0
    v_mfma_f32_16x16x32_bf16 v[140:143], a[168:171], a[100:103], v[140:143]
    s_add_u32 m0, s42, 147456
    ds_read_b64_tr_b16 a[164:165], v24 offset:8192
    v_accvgpr_write_b32 a43, 0
    v_mfma_f32_16x16x32_bf16 v[140:143], a[172:175], a[108:111], v[140:143]
    s_waitcnt lgkmcnt(9)
    buffer_load_dwordx4 v42, s[16:19], s49 offen lds
    v_mfma_f32_16x16x32_bf16 v[144:147], a[176:179], a[96:99], v[144:147]
    s_waitcnt lgkmcnt(7)
    ds_read_b64_tr_b16 a[166:167], v24 offset:12288
    ds_read_b64_tr_b16 a[168:169], v25 offset:0
    v_mfma_f32_16x16x32_bf16 v[144:147], a[180:183], a[104:107], v[144:147]
    ds_read_b64_tr_b16 a[170:171], v25 offset:4096
    v_accvgpr_write_b32 a44, 0
    v_mfma_f32_16x16x32_bf16 v[148:151], a[176:179], a[100:103], v[148:151]
    ds_read_b64_tr_b16 a[172:173], v25 offset:8192
    v_accvgpr_write_b32 a45, 0
    v_mfma_f32_16x16x32_bf16 v[148:151], a[180:183], a[108:111], v[148:151]
    s_waitcnt lgkmcnt(9)
    buffer_load_dwordx4 v43, s[16:19], s49 offen offset:1024 lds
    v_mfma_f32_16x16x32_bf16 v[152:155], a[184:187], a[96:99], v[152:155]
    s_waitcnt lgkmcnt(7)
    ds_read_b64_tr_b16 a[174:175], v25 offset:12288
    ds_read_b64_tr_b16 a[176:177], v26 offset:0
    v_mfma_f32_16x16x32_bf16 v[152:155], a[188:191], a[104:107], v[152:155]
    ds_read_b64_tr_b16 a[178:179], v26 offset:4096
    v_accvgpr_write_b32 a46, 0
    v_mfma_f32_16x16x32_bf16 v[156:159], a[184:187], a[100:103], v[156:159]
    ds_read_b64_tr_b16 a[180:181], v26 offset:8192
    v_accvgpr_write_b32 a47, 0
    v_mfma_f32_16x16x32_bf16 v[156:159], a[188:191], a[108:111], v[156:159]
    s_waitcnt lgkmcnt(9)
    buffer_load_dwordx4 v44, s[16:19], s49 offen offset:2048 lds
    v_mfma_f32_16x16x32_bf16 v[160:163], a[160:163], a[96:99], v[160:163]
    s_waitcnt lgkmcnt(7)
    ds_read_b64_tr_b16 a[182:183], v26 offset:12288
    ds_read_b64_tr_b16 a[184:185], v27 offset:0
    v_mfma_f32_16x16x32_bf16 v[160:163], a[164:167], a[104:107], v[160:163]
    ds_read_b64_tr_b16 a[186:187], v27 offset:4096
    v_accvgpr_write_b32 a48, 0
    v_mfma_f32_16x16x32_bf16 v[164:167], a[160:163], a[100:103], v[164:167]
    ds_read_b64_tr_b16 a[188:189], v27 offset:8192
    v_accvgpr_write_b32 a49, 0
    v_mfma_f32_16x16x32_bf16 v[164:167], a[164:167], a[108:111], v[164:167]
    s_waitcnt lgkmcnt(9)
    buffer_load_dwordx4 v45, s[16:19], s49 offen offset:3072 lds
    v_mfma_f32_16x16x32_bf16 v[168:171], a[168:171], a[96:99], v[168:171]
    s_waitcnt lgkmcnt(7)
    ds_read_b64_tr_b16 a[190:191], v27 offset:12288
    ds_read_b64_tr_b16 a[160:161], v20 offset:16384
    v_mfma_f32_16x16x32_bf16 v[168:171], a[172:175], a[104:107], v[168:171]
    ds_read_b64_tr_b16 a[162:163], v20 offset:20480
    v_accvgpr_write_b32 a50, 0
    v_mfma_f32_16x16x32_bf16 v[172:175], a[168:171], a[100:103], v[172:175]
    ds_read_b64_tr_b16 a[164:165], v20 offset:24576
    v_accvgpr_write_b32 a51, 0
    v_mfma_f32_16x16x32_bf16 v[172:175], a[172:175], a[108:111], v[172:175]
    s_waitcnt lgkmcnt(9)
    buffer_load_dwordx4 a[128:131], v51, s[24:27], s46 offen offset:2048 sc1
    v_mfma_f32_16x16x32_bf16 v[176:179], a[176:179], a[96:99], v[176:179]
    s_waitcnt lgkmcnt(7)
    ds_read_b64_tr_b16 a[166:167], v20 offset:28672
    ds_read_b64_tr_b16 a[168:169], v21 offset:16384
    v_mfma_f32_16x16x32_bf16 v[176:179], a[180:183], a[104:107], v[176:179]
    ds_read_b64_tr_b16 a[170:171], v21 offset:20480
    v_accvgpr_write_b32 a52, 0
    v_mfma_f32_16x16x32_bf16 v[180:183], a[176:179], a[100:103], v[180:183]
    ds_read_b64_tr_b16 a[172:173], v21 offset:24576
    v_accvgpr_write_b32 a53, 0
    v_mfma_f32_16x16x32_bf16 v[180:183], a[180:183], a[108:111], v[180:183]
    s_waitcnt lgkmcnt(9)
    buffer_load_dwordx4 a[136:139], v51, s[24:27], s46 offen offset:2176 sc1
    v_mfma_f32_16x16x32_bf16 v[184:187], a[184:187], a[96:99], v[184:187]
    s_waitcnt lgkmcnt(7)
    ds_read_b64_tr_b16 a[174:175], v21 offset:28672
    ds_read_b64_tr_b16 a[176:177], v22 offset:16384
    v_mfma_f32_16x16x32_bf16 v[184:187], a[188:191], a[104:107], v[184:187]
    ds_read_b64_tr_b16 a[178:179], v22 offset:20480
    v_accvgpr_write_b32 a54, 0
    v_mfma_f32_16x16x32_bf16 v[188:191], a[184:187], a[100:103], v[188:191]
    ds_read_b64_tr_b16 a[180:181], v22 offset:24576
    v_accvgpr_write_b32 a55, 0
    v_mfma_f32_16x16x32_bf16 v[188:191], a[188:191], a[108:111], v[188:191]
    s_waitcnt lgkmcnt(9)
    buffer_load_dwordx4 a[132:135], v51, s[24:27], s43 offen offset:2048 sc1
    v_mfma_f32_16x16x32_bf16 v[192:195], a[160:163], a[96:99], v[192:195]
    s_waitcnt lgkmcnt(7)
    ds_read_b64_tr_b16 a[182:183], v22 offset:28672
    ds_read_b64_tr_b16 a[184:185], v23 offset:16384
    v_mfma_f32_16x16x32_bf16 v[192:195], a[164:167], a[104:107], v[192:195]
    ds_read_b64_tr_b16 a[186:187], v23 offset:20480
    v_accvgpr_write_b32 a56, 0
    v_mfma_f32_16x16x32_bf16 v[196:199], a[160:163], a[100:103], v[196:199]
    ds_read_b64_tr_b16 a[188:189], v23 offset:24576
    v_accvgpr_write_b32 a57, 0
    v_mfma_f32_16x16x32_bf16 v[196:199], a[164:167], a[108:111], v[196:199]
    s_waitcnt lgkmcnt(9)
    buffer_load_dwordx4 a[140:143], v51, s[24:27], s43 offen offset:2176 sc1
    v_mfma_f32_16x16x32_bf16 v[200:203], a[168:171], a[96:99], v[200:203]
    s_waitcnt lgkmcnt(7)
    ds_read_b64_tr_b16 a[190:191], v23 offset:28672
    ds_read_b64_tr_b16 a[160:161], v24 offset:16384
    v_mfma_f32_16x16x32_bf16 v[200:203], a[172:175], a[104:107], v[200:203]
    ds_read_b64_tr_b16 a[162:163], v24 offset:20480
    v_accvgpr_write_b32 a58, 0
    v_mfma_f32_16x16x32_bf16 v[204:207], a[168:171], a[100:103], v[204:207]
    ds_read_b64_tr_b16 a[164:165], v24 offset:24576
    v_accvgpr_write_b32 a59, 0
    v_mfma_f32_16x16x32_bf16 v[204:207], a[172:175], a[108:111], v[204:207]
    s_waitcnt lgkmcnt(9)
    ds_read_b64_tr_b16 a[166:167], v24 offset:28672
    v_accvgpr_write_b32 a60, 0
    v_mfma_f32_16x16x32_bf16 v[208:211], a[176:179], a[96:99], v[208:211]
    s_waitcnt lgkmcnt(8)
    ds_read_b64_tr_b16 a[168:169], v25 offset:16384
    v_accvgpr_write_b32 a61, 0
    v_mfma_f32_16x16x32_bf16 v[208:211], a[180:183], a[104:107], v[208:211]
Ltour2:
    s_cbranch_execz Ltour6
    ds_read_b64_tr_b16 a[170:171], v25 offset:20480
    v_accvgpr_write_b32 a62, 0
    v_mfma_f32_16x16x32_bf16 v[212:215], a[176:179], a[100:103], v[212:215]
    ds_read_b64_tr_b16 a[172:173], v25 offset:24576
    v_accvgpr_write_b32 a63, 0
    v_mfma_f32_16x16x32_bf16 v[212:215], a[180:183], a[108:111], v[212:215]
    s_waitcnt lgkmcnt(9)
    ds_read_b64_tr_b16 a[174:175], v25 offset:28672
    v_accvgpr_write_b32 a64, 0
    v_mfma_f32_16x16x32_bf16 v[216:219], a[184:187], a[96:99], v[216:219]
    s_waitcnt lgkmcnt(8)
    ds_read_b64_tr_b16 a[176:177], v26 offset:16384
    v_accvgpr_write_b32 a65, 0
    v_mfma_f32_16x16x32_bf16 v[216:219], a[188:191], a[104:107], v[216:219]
    ds_read_b64_tr_b16 a[178:179], v26 offset:20480
    v_accvgpr_write_b32 a66, 0
    v_mfma_f32_16x16x32_bf16 v[220:223], a[184:187], a[100:103], v[220:223]
    ds_read_b64_tr_b16 a[180:181], v26 offset:24576
    v_accvgpr_write_b32 a67, 0
    v_mfma_f32_16x16x32_bf16 v[220:223], a[188:191], a[108:111], v[220:223]
    s_waitcnt lgkmcnt(9)
    ds_read_b64_tr_b16 a[182:183], v26 offset:28672
    v_accvgpr_write_b32 a68, 0
    v_mfma_f32_16x16x32_bf16 v[224:227], a[160:163], a[96:99], v[224:227]
    s_waitcnt lgkmcnt(8)
    ds_read_b64_tr_b16 a[184:185], v27 offset:16384
    v_accvgpr_write_b32 a69, 0
    v_mfma_f32_16x16x32_bf16 v[224:227], a[164:167], a[104:107], v[224:227]
    ds_read_b64_tr_b16 a[186:187], v27 offset:20480
    v_accvgpr_write_b32 a70, 0
    v_mfma_f32_16x16x32_bf16 v[228:231], a[160:163], a[100:103], v[228:231]
    ds_read_b64_tr_b16 a[188:189], v27 offset:24576
    v_accvgpr_write_b32 a71, 0
    v_mfma_f32_16x16x32_bf16 v[228:231], a[164:167], a[108:111], v[228:231]
    s_waitcnt lgkmcnt(9)
    ds_read_b64_tr_b16 a[190:191], v27 offset:28672
    v_accvgpr_write_b32 a72, 0
    s_waitcnt vmcnt(16)
    s_barrier
    v_mfma_f32_16x16x32_bf16 v[232:235], a[168:171], a[96:99], v[232:235]
    s_waitcnt lgkmcnt(8)
    ds_read_b64_tr_b16 a[160:161], v20 offset:32768
    v_accvgpr_write_b32 a73, 0
    v_mfma_f32_16x16x32_bf16 v[232:235], a[172:175], a[104:107], v[232:235]
    ds_read_b64_tr_b16 a[162:163], v20 offset:36864
    v_accvgpr_write_b32 a74, 0
    v_mfma_f32_16x16x32_bf16 v[236:239], a[168:171], a[100:103], v[236:239]
    s_add_u32 m0, s42, 0
    ds_read_b64_tr_b16 a[164:165], v20 offset:40960
    v_accvgpr_write_b32 a75, 0
    v_mfma_f32_16x16x32_bf16 v[236:239], a[172:175], a[108:111], v[236:239]
    s_waitcnt lgkmcnt(9)
    buffer_load_dwordx4 v36, s[8:11], s40 offen lds
    v_mfma_f32_16x16x32_bf16 v[240:243], a[176:179], a[96:99], v[240:243]
    s_waitcnt lgkmcnt(7)
    ds_read_b64_tr_b16 a[166:167], v20 offset:45056
    ds_read_b64_tr_b16 a[168:169], v21 offset:32768
    v_mfma_f32_16x16x32_bf16 v[240:243], a[180:183], a[104:107], v[240:243]
    ds_read_b64_tr_b16 a[170:171], v21 offset:36864
    v_accvgpr_write_b32 a76, 0
    v_mfma_f32_16x16x32_bf16 v[244:247], a[176:179], a[100:103], v[244:247]
    ds_read_b64_tr_b16 a[172:173], v21 offset:40960
    v_accvgpr_write_b32 a77, 0
    v_mfma_f32_16x16x32_bf16 v[244:247], a[180:183], a[108:111], v[244:247]
    s_waitcnt lgkmcnt(9)
    buffer_load_dwordx4 v37, s[8:11], s40 offen offset:1024 lds
    v_mfma_f32_16x16x32_bf16 v[248:251], a[184:187], a[96:99], v[248:251]
    s_waitcnt lgkmcnt(7)
    ds_read_b64_tr_b16 a[174:175], v21 offset:45056
    ds_read_b64_tr_b16 a[176:177], v22 offset:32768
    v_mfma_f32_16x16x32_bf16 v[248:251], a[188:191], a[104:107], v[248:251]
    ds_read_b64_tr_b16 a[178:179], v22 offset:36864
    v_accvgpr_write_b32 a78, 0
    v_mfma_f32_16x16x32_bf16 v[252:255], a[184:187], a[100:103], v[252:255]
    ds_read_b64_tr_b16 a[180:181], v22 offset:40960
    v_accvgpr_write_b32 a79, 0
    v_mfma_f32_16x16x32_bf16 v[252:255], a[188:191], a[108:111], v[252:255]
    s_waitcnt vmcnt(17)
    s_waitcnt lgkmcnt(9)
    buffer_load_dwordx4 v38, s[8:11], s40 offen offset:2048 lds
    v_mfma_f32_16x16x32_bf16 v[128:131], a[160:163], a[112:115], v[128:131]
    s_waitcnt vmcnt(17)
    s_waitcnt lgkmcnt(7)
    ds_read_b64_tr_b16 a[182:183], v22 offset:45056
    ds_read_b64_tr_b16 a[184:185], v23 offset:32768
    v_mfma_f32_16x16x32_bf16 v[128:131], a[164:167], a[120:123], v[128:131]
    s_waitcnt vmcnt(16)
    ds_read_b64_tr_b16 a[186:187], v23 offset:36864
    v_accvgpr_write_b32 a80, 0
    v_mfma_f32_16x16x32_bf16 v[132:135], a[160:163], a[116:119], v[132:135]
    s_waitcnt vmcnt(15)
    ds_read_b64_tr_b16 a[188:189], v23 offset:40960
    v_accvgpr_write_b32 a81, 0
    v_mfma_f32_16x16x32_bf16 v[132:135], a[164:167], a[124:127], v[132:135]
    s_waitcnt lgkmcnt(9)
    buffer_load_dwordx4 v39, s[8:11], s40 offen offset:3072 lds
    v_mfma_f32_16x16x32_bf16 v[136:139], a[168:171], a[112:115], v[136:139]
    s_waitcnt lgkmcnt(7)
    s_add_u32 s40, s40, 16384
    ds_read_b64_tr_b16 a[190:191], v23 offset:45056
    ds_read_b64_tr_b16 a[160:161], v24 offset:32768
    v_mfma_f32_16x16x32_bf16 v[136:139], a[172:175], a[120:123], v[136:139]
    ds_read_b64_tr_b16 a[162:163], v24 offset:36864
    v_accvgpr_write_b32 a82, 0
    v_mfma_f32_16x16x32_bf16 v[140:143], a[168:171], a[116:119], v[140:143]
    s_add_u32 m0, s42, 16384
    ds_read_b64_tr_b16 a[164:165], v24 offset:40960
    v_accvgpr_write_b32 a83, 0
    v_mfma_f32_16x16x32_bf16 v[140:143], a[172:175], a[124:127], v[140:143]
    s_waitcnt lgkmcnt(9)
    buffer_load_dwordx4 v36, s[8:11], s40 offen lds
    v_mfma_f32_16x16x32_bf16 v[144:147], a[176:179], a[112:115], v[144:147]
    s_waitcnt lgkmcnt(7)
    ds_read_b64_tr_b16 a[166:167], v24 offset:45056
    ds_read_b64_tr_b16 a[168:169], v25 offset:32768
    v_mfma_f32_16x16x32_bf16 v[144:147], a[180:183], a[120:123], v[144:147]
    ds_read_b64_tr_b16 a[170:171], v25 offset:36864
    v_accvgpr_write_b32 a84, 0
    v_mfma_f32_16x16x32_bf16 v[148:151], a[176:179], a[116:119], v[148:151]
    ds_read_b64_tr_b16 a[172:173], v25 offset:40960
    v_accvgpr_write_b32 a85, 0
    v_mfma_f32_16x16x32_bf16 v[148:151], a[180:183], a[124:127], v[148:151]
    s_waitcnt lgkmcnt(9)
    buffer_load_dwordx4 v37, s[8:11], s40 offen offset:1024 lds
    v_mfma_f32_16x16x32_bf16 v[152:155], a[184:187], a[112:115], v[152:155]
    s_waitcnt lgkmcnt(7)
    ds_read_b64_tr_b16 a[174:175], v25 offset:45056
    ds_read_b64_tr_b16 a[176:177], v26 offset:32768
    v_mfma_f32_16x16x32_bf16 v[152:155], a[188:191], a[120:123], v[152:155]
    ds_read_b64_tr_b16 a[178:179], v26 offset:36864
    v_accvgpr_write_b32 a86, 0
    v_mfma_f32_16x16x32_bf16 v[156:159], a[184:187], a[116:119], v[156:159]
    ds_read_b64_tr_b16 a[180:181], v26 offset:40960
    v_accvgpr_write_b32 a87, 0
    v_mfma_f32_16x16x32_bf16 v[156:159], a[188:191], a[124:127], v[156:159]
    s_waitcnt lgkmcnt(9)
    buffer_load_dwordx4 v38, s[8:11], s40 offen offset:2048 lds
    v_mfma_f32_16x16x32_bf16 v[160:163], a[160:163], a[112:115], v[160:163]
    s_waitcnt lgkmcnt(7)
    ds_read_b64_tr_b16 a[182:183], v26 offset:45056
    ds_read_b64_tr_b16 a[184:185], v27 offset:32768
    v_mfma_f32_16x16x32_bf16 v[160:163], a[164:167], a[120:123], v[160:163]
    ds_read_b64_tr_b16 a[186:187], v27 offset:36864
    v_accvgpr_write_b32 a88, 0
    v_mfma_f32_16x16x32_bf16 v[164:167], a[160:163], a[116:119], v[164:167]
    ds_read_b64_tr_b16 a[188:189], v27 offset:40960
    v_accvgpr_write_b32 a89, 0
    v_mfma_f32_16x16x32_bf16 v[164:167], a[164:167], a[124:127], v[164:167]
    s_waitcnt lgkmcnt(9)
    buffer_load_dwordx4 v39, s[8:11], s40 offen offset:3072 lds
    v_mfma_f32_16x16x32_bf16 v[168:171], a[168:171], a[112:115], v[168:171]
    s_waitcnt lgkmcnt(7)
    s_add_u32 s40, s40, 16384
    ds_read_b64_tr_b16 a[190:191], v27 offset:45056
    ds_read_b64_tr_b16 a[160:161], v20 offset:49152
    v_mfma_f32_16x16x32_bf16 v[168:171], a[172:175], a[120:123], v[168:171]
    ds_read_b64_tr_b16 a[162:163], v20 offset:53248
    v_accvgpr_write_b32 a90, 0
    v_mfma_f32_16x16x32_bf16 v[172:175], a[168:171], a[116:119], v[172:175]
    ds_read_b64_tr_b16 a[164:165], v20 offset:57344
    v_accvgpr_write_b32 a91, 0
    v_mfma_f32_16x16x32_bf16 v[172:175], a[172:175], a[124:127], v[172:175]
    s_waitcnt lgkmcnt(9)
    buffer_store_dword v76, v72, s[24:27], s92 offen offset:12 sc1
    v_mfma_f32_16x16x32_bf16 v[176:179], a[176:179], a[112:115], v[176:179]
    s_waitcnt lgkmcnt(7)
    ds_read_b64_tr_b16 a[166:167], v20 offset:61440
    ds_read_b64_tr_b16 a[168:169], v21 offset:49152
    v_mfma_f32_16x16x32_bf16 v[176:179], a[180:183], a[120:123], v[176:179]
    ds_read_b64_tr_b16 a[170:171], v21 offset:53248
    v_accvgpr_write_b32 a92, 0
    v_mfma_f32_16x16x32_bf16 v[180:183], a[176:179], a[116:119], v[180:183]
    ds_read_b64_tr_b16 a[172:173], v21 offset:57344
    v_accvgpr_write_b32 a93, 0
    v_mfma_f32_16x16x32_bf16 v[180:183], a[180:183], a[124:127], v[180:183]
    s_waitcnt lgkmcnt(9)
    buffer_store_dwordx4 v[88:91], v74, s[24:27], 0 offen sc1
    v_mfma_f32_16x16x32_bf16 v[184:187], a[184:187], a[112:115], v[184:187]
    s_waitcnt lgkmcnt(7)
    ds_read_b64_tr_b16 a[174:175], v21 offset:61440
    ds_read_b64_tr_b16 a[176:177], v22 offset:49152
    v_mfma_f32_16x16x32_bf16 v[184:187], a[188:191], a[120:123], v[184:187]
    ds_read_b64_tr_b16 a[178:179], v22 offset:53248
    v_accvgpr_write_b32 a94, 0
    v_mfma_f32_16x16x32_bf16 v[188:191], a[184:187], a[116:119], v[188:191]
    ds_read_b64_tr_b16 a[180:181], v22 offset:57344
    v_accvgpr_write_b32 a95, 0
    v_mfma_f32_16x16x32_bf16 v[188:191], a[188:191], a[124:127], v[188:191]
    s_waitcnt lgkmcnt(9)
    ds_read_b64_tr_b16 a[182:183], v22 offset:61440
    v_accvgpr_write_b32 a96, 0
    v_mfma_f32_16x16x32_bf16 v[192:195], a[160:163], a[112:115], v[192:195]
    s_waitcnt lgkmcnt(8)
    ds_read_b64_tr_b16 a[184:185], v23 offset:49152
    v_accvgpr_write_b32 a97, 0
    v_mfma_f32_16x16x32_bf16 v[192:195], a[164:167], a[120:123], v[192:195]
    ds_read_b64_tr_b16 a[186:187], v23 offset:53248
    v_accvgpr_write_b32 a98, 0
    v_mfma_f32_16x16x32_bf16 v[196:199], a[160:163], a[116:119], v[196:199]
    ds_read_b64_tr_b16 a[188:189], v23 offset:57344
    v_accvgpr_write_b32 a99, 0
    v_mfma_f32_16x16x32_bf16 v[196:199], a[164:167], a[124:127], v[196:199]
    s_waitcnt lgkmcnt(9)
    ds_read_b64_tr_b16 a[190:191], v23 offset:61440
    v_accvgpr_write_b32 a100, 0
    v_mfma_f32_16x16x32_bf16 v[200:203], a[168:171], a[112:115], v[200:203]
    s_waitcnt lgkmcnt(8)
    ds_read_b64_tr_b16 a[160:161], v24 offset:49152
    v_accvgpr_write_b32 a101, 0
    v_mfma_f32_16x16x32_bf16 v[200:203], a[172:175], a[120:123], v[200:203]
    ds_read_b64_tr_b16 a[162:163], v24 offset:53248
    v_accvgpr_write_b32 a102, 0
    v_mfma_f32_16x16x32_bf16 v[204:207], a[168:171], a[116:119], v[204:207]
    ds_read_b64_tr_b16 a[164:165], v24 offset:57344
    v_accvgpr_write_b32 a103, 0
    v_mfma_f32_16x16x32_bf16 v[204:207], a[172:175], a[124:127], v[204:207]
    s_waitcnt lgkmcnt(9)
    ds_read_b64_tr_b16 a[166:167], v24 offset:61440
    v_accvgpr_write_b32 a104, 0
    v_mfma_f32_16x16x32_bf16 v[208:211], a[176:179], a[112:115], v[208:211]
    s_waitcnt lgkmcnt(8)
    ds_read_b64_tr_b16 a[168:169], v25 offset:49152
    v_accvgpr_write_b32 a105, 0
    v_mfma_f32_16x16x32_bf16 v[208:211], a[180:183], a[120:123], v[208:211]
    ds_read_b64_tr_b16 a[170:171], v25 offset:53248
    v_accvgpr_write_b32 a106, 0
    v_mfma_f32_16x16x32_bf16 v[212:215], a[176:179], a[116:119], v[212:215]
    ds_read_b64_tr_b16 a[172:173], v25 offset:57344
    v_accvgpr_write_b32 a107, 0
    v_mfma_f32_16x16x32_bf16 v[212:215], a[180:183], a[124:127], v[212:215]
    s_waitcnt lgkmcnt(9)
    ds_read_b64_tr_b16 a[174:175], v25 offset:61440
    v_accvgpr_write_b32 a108, 0
    v_mfma_f32_16x16x32_bf16 v[216:219], a[184:187], a[112:115], v[216:219]
    s_waitcnt lgkmcnt(8)
    ds_read_b64_tr_b16 a[176:177], v26 offset:49152
    v_accvgpr_write_b32 a109, 0
    v_mfma_f32_16x16x32_bf16 v[216:219], a[188:191], a[120:123], v[216:219]
    ds_read_b64_tr_b16 a[178:179], v26 offset:53248
    v_accvgpr_write_b32 a110, 0
    v_mfma_f32_16x16x32_bf16 v[220:223], a[184:187], a[116:119], v[220:223]
    ds_read_b64_tr_b16 a[180:181], v26 offset:57344
    v_accvgpr_write_b32 a111, 0
    v_mfma_f32_16x16x32_bf16 v[220:223], a[188:191], a[124:127], v[220:223]
    s_waitcnt lgkmcnt(9)
    ds_read_b64_tr_b16 a[182:183], v26 offset:61440
    v_accvgpr_write_b32 a192, 0
    v_mfma_f32_16x16x32_bf16 v[224:227], a[160:163], a[112:115], v[224:227]
    s_waitcnt lgkmcnt(8)
    ds_read_b64_tr_b16 a[184:185], v27 offset:49152
    v_accvgpr_write_b32 a193, 0
    v_mfma_f32_16x16x32_bf16 v[224:227], a[164:167], a[120:123], v[224:227]
    ds_read_b64_tr_b16 a[186:187], v27 offset:53248
    v_accvgpr_write_b32 a194, 0
    v_mfma_f32_16x16x32_bf16 v[228:231], a[160:163], a[116:119], v[228:231]
    ds_read_b64_tr_b16 a[188:189], v27 offset:57344
    v_accvgpr_write_b32 a195, 0
    v_mfma_f32_16x16x32_bf16 v[228:231], a[164:167], a[124:127], v[228:231]
    s_waitcnt lgkmcnt(9)
    ds_read_b64_tr_b16 a[190:191], v27 offset:61440
    v_accvgpr_write_b32 a196, 0
    s_waitcnt vmcnt(14)
    s_barrier
    v_mfma_f32_16x16x32_bf16 v[232:235], a[168:171], a[112:115], v[232:235]
    s_waitcnt lgkmcnt(8)
    ds_read_b64_tr_b16 a[160:161], v28 offset:0
    v_accvgpr_write_b32 a197, 0
    v_mfma_f32_16x16x32_bf16 v[232:235], a[172:175], a[120:123], v[232:235]
    ds_read_b64_tr_b16 a[162:163], v28 offset:4096
    v_accvgpr_write_b32 a198, 0
    v_mfma_f32_16x16x32_bf16 v[236:239], a[168:171], a[116:119], v[236:239]
    s_add_u32 m0, s42, 32768
    ds_read_b64_tr_b16 a[164:165], v28 offset:8192
    v_accvgpr_write_b32 a199, 0
    v_mfma_f32_16x16x32_bf16 v[236:239], a[172:175], a[124:127], v[236:239]
    s_waitcnt lgkmcnt(9)
    buffer_load_dwordx4 v36, s[8:11], s40 offen lds
    v_mfma_f32_16x16x32_bf16 v[240:243], a[176:179], a[112:115], v[240:243]
    s_waitcnt lgkmcnt(7)
    ds_read_b64_tr_b16 a[166:167], v28 offset:12288
    ds_read_b64_tr_b16 a[168:169], v29 offset:0
    v_mfma_f32_16x16x32_bf16 v[240:243], a[180:183], a[120:123], v[240:243]
    ds_read_b64_tr_b16 a[170:171], v29 offset:4096
    v_accvgpr_write_b32 a200, 0
    v_mfma_f32_16x16x32_bf16 v[244:247], a[176:179], a[116:119], v[244:247]
    ds_read_b64_tr_b16 a[172:173], v29 offset:8192
    v_accvgpr_write_b32 a201, 0
    v_mfma_f32_16x16x32_bf16 v[244:247], a[180:183], a[124:127], v[244:247]
    s_waitcnt lgkmcnt(9)
    buffer_load_dwordx4 v37, s[8:11], s40 offen offset:1024 lds
    v_mfma_f32_16x16x32_bf16 v[248:251], a[184:187], a[112:115], v[248:251]
    s_waitcnt lgkmcnt(7)
    ds_read_b64_tr_b16 a[174:175], v29 offset:12288
    ds_read_b64_tr_b16 a[176:177], v30 offset:0
    v_mfma_f32_16x16x32_bf16 v[248:251], a[188:191], a[120:123], v[248:251]
    ds_read_b64_tr_b16 a[178:179], v30 offset:4096
    v_accvgpr_write_b32 a202, 0
    v_mfma_f32_16x16x32_bf16 v[252:255], a[184:187], a[116:119], v[252:255]
    ds_read_b64_tr_b16 a[180:181], v30 offset:8192
    v_accvgpr_write_b32 a203, 0
    v_mfma_f32_16x16x32_bf16 v[252:255], a[188:191], a[124:127], v[252:255]
    s_waitcnt vmcnt(15)
    s_waitcnt lgkmcnt(9)
    buffer_load_dwordx4 v38, s[8:11], s40 offen offset:2048 lds
    v_mfma_f32_16x16x32_bf16 v[128:131], a[160:163], a[128:131], v[128:131]
    s_waitcnt vmcnt(15)
    s_waitcnt lgkmcnt(7)
    ds_read_b64_tr_b16 a[182:183], v30 offset:12288
    ds_read_b64_tr_b16 a[184:185], v31 offset:0
    v_mfma_f32_16x16x32_bf16 v[128:131], a[164:167], a[136:139], v[128:131]
    s_waitcnt vmcnt(14)
    ds_read_b64_tr_b16 a[186:187], v31 offset:4096
    v_accvgpr_write_b32 a204, 0
    v_mfma_f32_16x16x32_bf16 v[132:135], a[160:163], a[132:135], v[132:135]
    s_waitcnt vmcnt(13)
    ds_read_b64_tr_b16 a[188:189], v31 offset:8192
    v_accvgpr_write_b32 a205, 0
    v_mfma_f32_16x16x32_bf16 v[132:135], a[164:167], a[140:143], v[132:135]
    s_waitcnt lgkmcnt(9)
    buffer_load_dwordx4 v39, s[8:11], s40 offen offset:3072 lds
    v_mfma_f32_16x16x32_bf16 v[136:139], a[168:171], a[128:131], v[136:139]
    s_waitcnt lgkmcnt(7)
    s_add_u32 s40, s40, 16384
    ds_read_b64_tr_b16 a[190:191], v31 offset:12288
    ds_read_b64_tr_b16 a[160:161], v32 offset:0
    v_mfma_f32_16x16x32_bf16 v[136:139], a[172:175], a[136:139], v[136:139]
    ds_read_b64_tr_b16 a[162:163], v32 offset:4096
    v_accvgpr_write_b32 a206, 0
    v_mfma_f32_16x16x32_bf16 v[140:143], a[168:171], a[132:135], v[140:143]
    s_add_u32 m0, s42, 65536
    ds_read_b64_tr_b16 a[164:165], v32 offset:8192
    v_accvgpr_write_b32 a207, 0
    v_mfma_f32_16x16x32_bf16 v[140:143], a[172:175], a[140:143], v[140:143]
    s_waitcnt lgkmcnt(9)
    buffer_load_dwordx4 v40, s[12:15], s41 offen lds
    v_mfma_f32_16x16x32_bf16 v[144:147], a[176:179], a[128:131], v[144:147]
    s_waitcnt lgkmcnt(7)
    ds_read_b64_tr_b16 a[166:167], v32 offset:12288
    ds_read_b64_tr_b16 a[168:169], v33 offset:0
    v_mfma_f32_16x16x32_bf16 v[144:147], a[180:183], a[136:139], v[144:147]
    ds_read_b64_tr_b16 a[170:171], v33 offset:4096
    v_accvgpr_write_b32 a112, 0
    v_mfma_f32_16x16x32_bf16 v[148:151], a[176:179], a[132:135], v[148:151]
    ds_read_b64_tr_b16 a[172:173], v33 offset:8192
    v_accvgpr_write_b32 a113, 0
    v_mfma_f32_16x16x32_bf16 v[148:151], a[180:183], a[140:143], v[148:151]
    s_waitcnt lgkmcnt(9)
    buffer_load_dwordx4 v41, s[12:15], s41 offen offset:1024 lds
    v_mfma_f32_16x16x32_bf16 v[152:155], a[184:187], a[128:131], v[152:155]
    s_waitcnt lgkmcnt(7)
    ds_read_b64_tr_b16 a[174:175], v33 offset:12288
    ds_read_b64_tr_b16 a[176:177], v34 offset:0
    v_mfma_f32_16x16x32_bf16 v[152:155], a[188:191], a[136:139], v[152:155]
    ds_read_b64_tr_b16 a[178:179], v34 offset:4096
    v_accvgpr_write_b32 a114, 0
    v_mfma_f32_16x16x32_bf16 v[156:159], a[184:187], a[132:135], v[156:159]
    ds_read_b64_tr_b16 a[180:181], v34 offset:8192
    v_accvgpr_write_b32 a115, 0
    v_mfma_f32_16x16x32_bf16 v[156:159], a[188:191], a[140:143], v[156:159]
    s_waitcnt lgkmcnt(9)
    buffer_load_dwordx4 v40, s[12:15], s41 offen offset:2048 lds
    v_mfma_f32_16x16x32_bf16 v[160:163], a[160:163], a[128:131], v[160:163]
    s_waitcnt lgkmcnt(7)
    ds_read_b64_tr_b16 a[182:183], v34 offset:12288
    ds_read_b64_tr_b16 a[184:185], v35 offset:0
    v_mfma_f32_16x16x32_bf16 v[160:163], a[164:167], a[136:139], v[160:163]
    ds_read_b64_tr_b16 a[186:187], v35 offset:4096
    v_accvgpr_write_b32 a116, 0
    v_mfma_f32_16x16x32_bf16 v[164:167], a[160:163], a[132:135], v[164:167]
    ds_read_b64_tr_b16 a[188:189], v35 offset:8192
    v_accvgpr_write_b32 a117, 0
    v_mfma_f32_16x16x32_bf16 v[164:167], a[164:167], a[140:143], v[164:167]
    s_waitcnt lgkmcnt(9)
    buffer_load_dwordx4 v41, s[12:15], s41 offen offset:3072 lds
    v_mfma_f32_16x16x32_bf16 v[168:171], a[168:171], a[128:131], v[168:171]
    s_waitcnt lgkmcnt(7)
    s_add_u32 s41, s41, 16384
    ds_read_b64_tr_b16 a[190:191], v35 offset:12288
    ds_read_b64_tr_b16 a[160:161], v28 offset:16384
    v_mfma_f32_16x16x32_bf16 v[168:171], a[172:175], a[136:139], v[168:171]
    ds_read_b64_tr_b16 a[162:163], v28 offset:20480
    v_accvgpr_write_b32 a118, 0
    v_mfma_f32_16x16x32_bf16 v[172:175], a[168:171], a[132:135], v[172:175]
    s_add_u32 m0, s42, 81920
    ds_read_b64_tr_b16 a[164:165], v28 offset:24576
    v_accvgpr_write_b32 a119, 0
    v_mfma_f32_16x16x32_bf16 v[172:175], a[172:175], a[140:143], v[172:175]
    s_waitcnt lgkmcnt(9)
    buffer_load_dwordx4 v40, s[12:15], s41 offen lds
    v_mfma_f32_16x16x32_bf16 v[176:179], a[176:179], a[128:131], v[176:179]
    s_waitcnt lgkmcnt(7)
    ds_read_b64_tr_b16 a[166:167], v28 offset:28672
    ds_read_b64_tr_b16 a[168:169], v29 offset:16384
    v_mfma_f32_16x16x32_bf16 v[176:179], a[180:183], a[136:139], v[176:179]
    ds_read_b64_tr_b16 a[170:171], v29 offset:20480
    v_accvgpr_write_b32 a120, 0
    v_mfma_f32_16x16x32_bf16 v[180:183], a[176:179], a[132:135], v[180:183]
    ds_read_b64_tr_b16 a[172:173], v29 offset:24576
    v_accvgpr_write_b32 a121, 0
    v_mfma_f32_16x16x32_bf16 v[180:183], a[180:183], a[140:143], v[180:183]
    s_waitcnt lgkmcnt(9)
    buffer_load_dwordx4 v41, s[12:15], s41 offen offset:1024 lds
    v_mfma_f32_16x16x32_bf16 v[184:187], a[184:187], a[128:131], v[184:187]
    s_waitcnt lgkmcnt(7)
    ds_read_b64_tr_b16 a[174:175], v29 offset:28672
    ds_read_b64_tr_b16 a[176:177], v30 offset:16384
    v_mfma_f32_16x16x32_bf16 v[184:187], a[188:191], a[136:139], v[184:187]
    ds_read_b64_tr_b16 a[178:179], v30 offset:20480
    v_accvgpr_write_b32 a122, 0
    v_mfma_f32_16x16x32_bf16 v[188:191], a[184:187], a[132:135], v[188:191]
    ds_read_b64_tr_b16 a[180:181], v30 offset:24576
    v_accvgpr_write_b32 a123, 0
    v_mfma_f32_16x16x32_bf16 v[188:191], a[188:191], a[140:143], v[188:191]
    s_waitcnt lgkmcnt(9)
    buffer_load_dwordx4 v40, s[12:15], s41 offen offset:2048 lds
    v_mfma_f32_16x16x32_bf16 v[192:195], a[160:163], a[128:131], v[192:195]
    s_waitcnt lgkmcnt(7)
    ds_read_b64_tr_b16 a[182:183], v30 offset:28672
    ds_read_b64_tr_b16 a[184:185], v31 offset:16384
    v_mfma_f32_16x16x32_bf16 v[192:195], a[164:167], a[136:139], v[192:195]
    ds_read_b64_tr_b16 a[186:187], v31 offset:20480
    v_accvgpr_write_b32 a124, 0
    v_mfma_f32_16x16x32_bf16 v[196:199], a[160:163], a[132:135], v[196:199]
    ds_read_b64_tr_b16 a[188:189], v31 offset:24576
    v_accvgpr_write_b32 a125, 0
    v_mfma_f32_16x16x32_bf16 v[196:199], a[164:167], a[140:143], v[196:199]
    s_waitcnt lgkmcnt(9)
    buffer_load_dwordx4 v41, s[12:15], s41 offen offset:3072 lds
    v_mfma_f32_16x16x32_bf16 v[200:203], a[168:171], a[128:131], v[200:203]
    s_waitcnt lgkmcnt(7)
    s_add_u32 s41, s41, 16384
    ds_read_b64_tr_b16 a[190:191], v31 offset:28672
    ds_read_b64_tr_b16 a[160:161], v32 offset:16384
    v_mfma_f32_16x16x32_bf16 v[200:203], a[172:175], a[136:139], v[200:203]
    ds_read_b64_tr_b16 a[162:163], v32 offset:20480
    v_accvgpr_write_b32 a126, 0
    v_mfma_f32_16x16x32_bf16 v[204:207], a[168:171], a[132:135], v[204:207]
    ds_read_b64_tr_b16 a[164:165], v32 offset:24576
    v_accvgpr_write_b32 a127, 0
    v_mfma_f32_16x16x32_bf16 v[204:207], a[172:175], a[140:143], v[204:207]
    s_waitcnt lgkmcnt(9)
    ds_read_b64_tr_b16 a[166:167], v32 offset:28672
    v_mfma_f32_16x16x32_bf16 v[208:211], a[176:179], a[128:131], v[208:211]
    s_waitcnt lgkmcnt(8)
    ds_read_b64_tr_b16 a[168:169], v33 offset:16384
    v_mfma_f32_16x16x32_bf16 v[208:211], a[180:183], a[136:139], v[208:211]
    ds_read_b64_tr_b16 a[170:171], v33 offset:20480
    v_mfma_f32_16x16x32_bf16 v[212:215], a[176:179], a[132:135], v[212:215]
    ds_read_b64_tr_b16 a[172:173], v33 offset:24576
    v_mfma_f32_16x16x32_bf16 v[212:215], a[180:183], a[140:143], v[212:215]
    s_waitcnt lgkmcnt(9)
    ds_read_b64_tr_b16 a[174:175], v33 offset:28672
    v_mfma_f32_16x16x32_bf16 v[216:219], a[184:187], a[128:131], v[216:219]
    s_waitcnt lgkmcnt(8)
    ds_read_b64_tr_b16 a[176:177], v34 offset:16384
    v_mfma_f32_16x16x32_bf16 v[216:219], a[188:191], a[136:139], v[216:219]
    ds_read_b64_tr_b16 a[178:179], v34 offset:20480
    v_mfma_f32_16x16x32_bf16 v[220:223], a[184:187], a[132:135], v[220:223]
    ds_read_b64_tr_b16 a[180:181], v34 offset:24576
    v_mfma_f32_16x16x32_bf16 v[220:223], a[188:191], a[140:143], v[220:223]
    s_waitcnt lgkmcnt(9)
    ds_read_b64_tr_b16 a[182:183], v34 offset:28672
    v_mfma_f32_16x16x32_bf16 v[224:227], a[160:163], a[128:131], v[224:227]
    s_waitcnt lgkmcnt(8)
    ds_read_b64_tr_b16 a[184:185], v35 offset:16384
    v_mfma_f32_16x16x32_bf16 v[224:227], a[164:167], a[136:139], v[224:227]
    ds_read_b64_tr_b16 a[186:187], v35 offset:20480
    v_mfma_f32_16x16x32_bf16 v[228:231], a[160:163], a[132:135], v[228:231]
    ds_read_b64_tr_b16 a[188:189], v35 offset:24576
    v_mfma_f32_16x16x32_bf16 v[228:231], a[164:167], a[140:143], v[228:231]
    s_waitcnt lgkmcnt(9)
    ds_read_b64_tr_b16 a[190:191], v35 offset:28672
    v_mfma_f32_16x16x32_bf16 v[232:235], a[168:171], a[128:131], v[232:235]
    s_waitcnt lgkmcnt(8)
    v_mfma_f32_16x16x32_bf16 v[232:235], a[172:175], a[136:139], v[232:235]
    v_mfma_f32_16x16x32_bf16 v[236:239], a[168:171], a[132:135], v[236:239]
    v_mfma_f32_16x16x32_bf16 v[236:239], a[172:175], a[140:143], v[236:239]
    s_waitcnt lgkmcnt(6)
    s_waitcnt vmcnt(18)
    s_barrier
    v_mfma_f32_16x16x32_bf16 v[240:243], a[176:179], a[128:131], v[240:243]
    s_waitcnt lgkmcnt(4)
    ds_read_b128 a[208:211], v8 offset:0
    v_mfma_f32_16x16x32_bf16 v[240:243], a[180:183], a[136:139], v[240:243]
    ds_read_b128 a[212:215], v9 offset:0
    v_mfma_f32_16x16x32_bf16 v[244:247], a[176:179], a[132:135], v[244:247]
    ds_read_b128 a[216:219], v10 offset:0
    v_mfma_f32_16x16x32_bf16 v[244:247], a[180:183], a[140:143], v[244:247]
    s_waitcnt lgkmcnt(5)
    ds_read_b128 a[220:223], v11 offset:0
    v_mfma_f32_16x16x32_bf16 v[248:251], a[184:187], a[128:131], v[248:251]
    s_waitcnt lgkmcnt(4)
    ds_read_b128 a[224:227], v8 offset:4096
    v_mfma_f32_16x16x32_bf16 v[248:251], a[188:191], a[136:139], v[248:251]
    v_mfma_f32_16x16x32_bf16 v[252:255], a[184:187], a[132:135], v[252:255]
    s_load_dwordx2 s[16:17], s[0:1], 88
    v_mfma_f32_16x16x32_bf16 v[252:255], a[188:191], a[140:143], v[252:255]
    s_mov_b32 s36, 1040356334
    s_mov_b32 s37, 1040356334
    v_pk_mul_f32 v[128:129], v[128:129], s[36:37]
    v_pk_mul_f32 v[130:131], v[130:131], s[36:37]
    v_pk_mul_f32 v[136:137], v[136:137], s[36:37]
    v_pk_mul_f32 v[138:139], v[138:139], s[36:37]
    v_cvt_pk_bf16_f32 v64, v128, v129
    v_cvt_pk_bf16_f32 v65, v130, v131
    v_cvt_pk_bf16_f32 v66, v136, v137
    v_cvt_pk_bf16_f32 v67, v138, v139
    v_pk_mul_f32 v[132:133], v[132:133], s[36:37]
    v_pk_mul_f32 v[134:135], v[134:135], s[36:37]
    v_pk_mul_f32 v[140:141], v[140:141], s[36:37]
    v_pk_mul_f32 v[142:143], v[142:143], s[36:37]
    v_cvt_pk_bf16_f32 v80, v132, v133
    v_cvt_pk_bf16_f32 v81, v134, v135
    v_cvt_pk_bf16_f32 v82, v140, v141
    v_cvt_pk_bf16_f32 v83, v142, v143
    v_permlane32_swap_b32 v64, v66
    v_permlane32_swap_b32 v65, v67
    v_permlane32_swap_b32 v80, v82
    v_permlane32_swap_b32 v81, v83
    v_permlane16_swap_b32 v64, v66
    v_permlane16_swap_b32 v65, v67
    v_permlane16_swap_b32 v80, v82
    v_permlane16_swap_b32 v81, v83
    v_pk_mul_f32 v[144:145], v[144:145], s[36:37]
    v_pk_mul_f32 v[146:147], v[146:147], s[36:37]
    v_pk_mul_f32 v[152:153], v[152:153], s[36:37]
    v_pk_mul_f32 v[154:155], v[154:155], s[36:37]
    v_cvt_pk_bf16_f32 v68, v144, v145
    v_cvt_pk_bf16_f32 v69, v146, v147
    v_cvt_pk_bf16_f32 v70, v152, v153
    v_cvt_pk_bf16_f32 v71, v154, v155
    v_pk_mul_f32 v[148:149], v[148:149], s[36:37]
    v_pk_mul_f32 v[150:151], v[150:151], s[36:37]
    v_pk_mul_f32 v[156:157], v[156:157], s[36:37]
    v_pk_mul_f32 v[158:159], v[158:159], s[36:37]
    v_cvt_pk_bf16_f32 v84, v148, v149
    v_cvt_pk_bf16_f32 v85, v150, v151
    v_cvt_pk_bf16_f32 v86, v156, v157
    v_cvt_pk_bf16_f32 v87, v158, v159
    v_permlane32_swap_b32 v68, v70
    v_permlane32_swap_b32 v69, v71
    v_permlane32_swap_b32 v84, v86
    v_permlane32_swap_b32 v85, v87
    v_permlane16_swap_b32 v68, v70
    v_permlane16_swap_b32 v69, v71
    v_permlane16_swap_b32 v84, v86
    v_permlane16_swap_b32 v85, v87
    v_pk_mul_f32 v[160:161], v[160:161], s[36:37]
    v_pk_mul_f32 v[162:163], v[162:163], s[36:37]
    v_pk_mul_f32 v[168:169], v[168:169], s[36:37]
    v_pk_mul_f32 v[170:171], v[170:171], s[36:37]
    v_cvt_pk_bf16_f32 v72, v160, v161
    v_cvt_pk_bf16_f32 v73, v162, v163
    v_cvt_pk_bf16_f32 v74, v168, v169
    v_cvt_pk_bf16_f32 v75, v170, v171
    v_pk_mul_f32 v[164:165], v[164:165], s[36:37]
    v_pk_mul_f32 v[166:167], v[166:167], s[36:37]
    v_pk_mul_f32 v[172:173], v[172:173], s[36:37]
    v_pk_mul_f32 v[174:175], v[174:175], s[36:37]
    v_cvt_pk_bf16_f32 v88, v164, v165
    v_cvt_pk_bf16_f32 v89, v166, v167
    v_cvt_pk_bf16_f32 v90, v172, v173
    v_cvt_pk_bf16_f32 v91, v174, v175
    v_permlane32_swap_b32 v72, v74
    v_permlane32_swap_b32 v73, v75
    v_permlane32_swap_b32 v88, v90
    v_permlane32_swap_b32 v89, v91
    v_permlane16_swap_b32 v72, v74
    v_permlane16_swap_b32 v73, v75
    v_permlane16_swap_b32 v88, v90
    v_permlane16_swap_b32 v89, v91
    v_pk_mul_f32 v[176:177], v[176:177], s[36:37]
    v_pk_mul_f32 v[178:179], v[178:179], s[36:37]
Ltour3:
    s_cbranch_execz Ltour7
    v_pk_mul_f32 v[184:185], v[184:185], s[36:37]
    v_pk_mul_f32 v[186:187], v[186:187], s[36:37]
    v_cvt_pk_bf16_f32 v76, v176, v177
    v_cvt_pk_bf16_f32 v77, v178, v179
    v_cvt_pk_bf16_f32 v78, v184, v185
    v_cvt_pk_bf16_f32 v79, v186, v187
    v_pk_mul_f32 v[180:181], v[180:181], s[36:37]
    v_pk_mul_f32 v[182:183], v[182:183], s[36:37]
    v_pk_mul_f32 v[188:189], v[188:189], s[36:37]
    v_pk_mul_f32 v[190:191], v[190:191], s[36:37]
    v_cvt_pk_bf16_f32 v92, v180, v181
    v_cvt_pk_bf16_f32 v93, v182, v183
    v_cvt_pk_bf16_f32 v94, v188, v189
    v_cvt_pk_bf16_f32 v95, v190, v191
    v_permlane32_swap_b32 v76, v78
    v_permlane32_swap_b32 v77, v79
    v_permlane32_swap_b32 v92, v94
    v_permlane32_swap_b32 v93, v95
    v_permlane16_swap_b32 v76, v78
    v_permlane16_swap_b32 v77, v79
    v_permlane16_swap_b32 v92, v94
    v_permlane16_swap_b32 v93, v95
    v_pk_mul_f32 v[192:193], v[192:193], s[36:37]
    v_pk_mul_f32 v[194:195], v[194:195], s[36:37]
    v_pk_mul_f32 v[200:201], v[200:201], s[36:37]
    v_pk_mul_f32 v[202:203], v[202:203], s[36:37]
    v_cvt_pk_bf16_f32 v96, v192, v193
    v_cvt_pk_bf16_f32 v97, v194, v195
    v_cvt_pk_bf16_f32 v98, v200, v201
    v_cvt_pk_bf16_f32 v99, v202, v203
    v_pk_mul_f32 v[196:197], v[196:197], s[36:37]
    v_pk_mul_f32 v[198:199], v[198:199], s[36:37]
    v_pk_mul_f32 v[204:205], v[204:205], s[36:37]
    v_pk_mul_f32 v[206:207], v[206:207], s[36:37]
    v_cvt_pk_bf16_f32 v112, v196, v197
    v_cvt_pk_bf16_f32 v113, v198, v199
    v_cvt_pk_bf16_f32 v114, v204, v205
    v_cvt_pk_bf16_f32 v115, v206, v207
    v_permlane32_swap_b32 v96, v98
    v_permlane32_swap_b32 v97, v99
    v_permlane32_swap_b32 v112, v114
    v_permlane32_swap_b32 v113, v115
    v_permlane16_swap_b32 v96, v98
    v_permlane16_swap_b32 v97, v99
    v_permlane16_swap_b32 v112, v114
    v_permlane16_swap_b32 v113, v115
    v_pk_mul_f32 v[208:209], v[208:209], s[36:37]
    v_pk_mul_f32 v[210:211], v[210:211], s[36:37]
    v_pk_mul_f32 v[216:217], v[216:217], s[36:37]
    v_pk_mul_f32 v[218:219], v[218:219], s[36:37]
    v_cvt_pk_bf16_f32 v100, v208, v209
    v_cvt_pk_bf16_f32 v101, v210, v211
    v_cvt_pk_bf16_f32 v102, v216, v217
    v_cvt_pk_bf16_f32 v103, v218, v219
    v_pk_mul_f32 v[212:213], v[212:213], s[36:37]
    v_pk_mul_f32 v[214:215], v[214:215], s[36:37]
    v_pk_mul_f32 v[220:221], v[220:221], s[36:37]
    v_pk_mul_f32 v[222:223], v[222:223], s[36:37]
    v_cvt_pk_bf16_f32 v116, v212, v213
    v_cvt_pk_bf16_f32 v117, v214, v215
    v_cvt_pk_bf16_f32 v118, v220, v221
    v_cvt_pk_bf16_f32 v119, v222, v223
    v_permlane32_swap_b32 v100, v102
    v_permlane32_swap_b32 v101, v103
    v_permlane32_swap_b32 v116, v118
    v_permlane32_swap_b32 v117, v119
    v_permlane16_swap_b32 v100, v102
    v_permlane16_swap_b32 v101, v103
    v_permlane16_swap_b32 v116, v118
    v_permlane16_swap_b32 v117, v119
    v_pk_mul_f32 v[224:225], v[224:225], s[36:37]
    v_pk_mul_f32 v[226:227], v[226:227], s[36:37]
    v_pk_mul_f32 v[232:233], v[232:233], s[36:37]
    v_pk_mul_f32 v[234:235], v[234:235], s[36:37]
    v_cvt_pk_bf16_f32 v104, v224, v225
    v_cvt_pk_bf16_f32 v105, v226, v227
    v_cvt_pk_bf16_f32 v106, v232, v233
    v_cvt_pk_bf16_f32 v107, v234, v235
    v_pk_mul_f32 v[228:229], v[228:229], s[36:37]
    v_pk_mul_f32 v[230:231], v[230:231], s[36:37]
    v_pk_mul_f32 v[236:237], v[236:237], s[36:37]
    v_pk_mul_f32 v[238:239], v[238:239], s[36:37]
    v_cvt_pk_bf16_f32 v120, v228, v229
    v_cvt_pk_bf16_f32 v121, v230, v231
    v_cvt_pk_bf16_f32 v122, v236, v237
    v_cvt_pk_bf16_f32 v123, v238, v239
    v_permlane32_swap_b32 v104, v106
    v_permlane32_swap_b32 v105, v107
    v_permlane32_swap_b32 v120, v122
    v_permlane32_swap_b32 v121, v123
    v_permlane16_swap_b32 v104, v106
    v_permlane16_swap_b32 v105, v107
    v_permlane16_swap_b32 v120, v122
    v_permlane16_swap_b32 v121, v123
    v_pk_mul_f32 v[240:241], v[240:241], s[36:37]
    v_pk_mul_f32 v[242:243], v[242:243], s[36:37]
    v_pk_mul_f32 v[248:249], v[248:249], s[36:37]
    v_pk_mul_f32 v[250:251], v[250:251], s[36:37]
    v_cvt_pk_bf16_f32 v108, v240, v241
    v_cvt_pk_bf16_f32 v109, v242, v243
    v_cvt_pk_bf16_f32 v110, v248, v249
    v_cvt_pk_bf16_f32 v111, v250, v251
    v_pk_mul_f32 v[244:245], v[244:245], s[36:37]
    v_pk_mul_f32 v[246:247], v[246:247], s[36:37]
    v_pk_mul_f32 v[252:253], v[252:253], s[36:37]
    v_pk_mul_f32 v[254:255], v[254:255], s[36:37]
    v_cvt_pk_bf16_f32 v124, v244, v245
    v_cvt_pk_bf16_f32 v125, v246, v247
    v_cvt_pk_bf16_f32 v126, v252, v253
    v_cvt_pk_bf16_f32 v127, v254, v255
    v_permlane32_swap_b32 v108, v110
    v_permlane32_swap_b32 v109, v111
    v_permlane32_swap_b32 v124, v126
    v_permlane32_swap_b32 v125, v127
    v_permlane16_swap_b32 v108, v110
    v_permlane16_swap_b32 v109, v111
    v_permlane16_swap_b32 v124, v126
    v_permlane16_swap_b32 v125, v127
    s_waitcnt lgkmcnt(0)
    v_mfma_f32_16x16x32_bf16 v[216:219], a[208:211], v[64:67], 0
    v_mfma_f32_16x16x32_bf16 v[216:219], a[212:215], v[68:71], v[216:219]
    v_mfma_f32_16x16x32_bf16 v[216:219], a[216:219], v[72:75], v[216:219]
    v_mfma_f32_16x16x32_bf16 v[216:219], a[220:223], v[76:79], v[216:219]
    v_mfma_f32_16x16x32_bf16 v[220:223], a[208:211], v[80:83], 0
    v_mfma_f32_16x16x32_bf16 v[220:223], a[212:215], v[84:87], v[220:223]
    v_mfma_f32_16x16x32_bf16 v[220:223], a[216:219], v[88:91], v[220:223]
    v_mfma_f32_16x16x32_bf16 v[220:223], a[220:223], v[92:95], v[220:223]
    v_mfma_f32_16x16x32_bf16 v[224:227], a[208:211], v[96:99], 0
    v_mfma_f32_16x16x32_bf16 v[224:227], a[212:215], v[100:103], v[224:227]
    v_mfma_f32_16x16x32_bf16 v[224:227], a[216:219], v[104:107], v[224:227]
    v_mfma_f32_16x16x32_bf16 v[224:227], a[220:223], v[108:111], v[224:227]
    v_mfma_f32_16x16x32_bf16 v[228:231], a[208:211], v[112:115], 0
    v_mfma_f32_16x16x32_bf16 v[228:231], a[212:215], v[116:119], v[228:231]
    v_mfma_f32_16x16x32_bf16 v[228:231], a[216:219], v[120:123], v[228:231]
    v_mfma_f32_16x16x32_bf16 v[228:231], a[220:223], v[124:127], v[228:231]
    v_max3_f32 v232, v216, v217, v218
    v_max_f32 v232, v232, v219
    v_max3_f32 v233, v220, v221, v222
    v_max_f32 v233, v233, v223
    v_max3_f32 v234, v224, v225, v226
    v_max_f32 v234, v234, v227
    s_nop 1
    v_max3_f32 v235, v228, v229, v230
    v_max_f32 v235, v235, v231
    v_mov_b32 v236, v232
    v_mov_b32 v237, v233
    v_mov_b32 v238, v234
    v_mov_b32 v239, v235
    v_permlane16_swap_b32 v232, v236
    v_permlane16_swap_b32 v233, v237
    v_permlane16_swap_b32 v234, v238
    v_permlane16_swap_b32 v235, v239
    v_max_f32 v232, v232, v236
    v_max_f32 v233, v233, v237
    v_max_f32 v234, v234, v238
    v_max_f32 v235, v235, v239
    v_mov_b32 v236, v232
    v_mov_b32 v237, v233
    v_mov_b32 v238, v234
    v_mov_b32 v239, v235
    v_permlane32_swap_b32 v232, v236
    v_permlane32_swap_b32 v233, v237
    v_permlane32_swap_b32 v234, v238
    v_permlane32_swap_b32 v235, v239
    v_max_f32 v232, v232, v236
    v_max_f32 v233, v233, v237
    v_max_f32 v234, v234, v238
    v_max_f32 v235, v235, v239
    v_sub_f32 v192, 3250585600, v232
    v_sub_f32 v193, 3250585600, v232
    v_sub_f32 v194, 3250585600, v232
    v_sub_f32 v195, 3250585600, v232
    v_sub_f32 v196, 3250585600, v233
    v_sub_f32 v197, 3250585600, v233
    v_sub_f32 v198, 3250585600, v233
    v_sub_f32 v199, 3250585600, v233
    v_sub_f32 v200, 3250585600, v234
    v_sub_f32 v201, 3250585600, v234
    v_sub_f32 v202, 3250585600, v234
    v_sub_f32 v203, 3250585600, v234
    v_sub_f32 v204, 3250585600, v235
    v_sub_f32 v205, 3250585600, v235
    v_sub_f32 v206, 3250585600, v235
    v_sub_f32 v207, 3250585600, v235
Lattn_stage0:
    s_mov_b32 s43, 7
    v_mfma_f32_16x16x32_bf16 v[208:211], a[208:211], v[64:67], v[192:195]
    s_lshl_b32 s53, s5, 4
    v_mfma_f32_16x16x32_bf16 v[208:211], a[212:215], v[68:71], v[208:211]
    s_add_u32 s53, s53, s4
    v_mfma_f32_16x16x32_bf16 v[208:211], a[216:219], v[72:75], v[208:211]
    s_lshl_b32 s53, s53, 2
    v_mfma_f32_16x16x32_bf16 v[208:211], a[220:223], v[76:79], v[208:211]
    s_add_u32 s53, s53, s3
    ds_read_b128 a[228:231], v9 offset:4096
    v_mfma_f32_16x16x32_bf16 v[212:215], a[208:211], v[80:83], v[196:199]
    s_mul_i32 s53, s53, 4608
    s_nop 3
    v_exp_f32 v208, v208
    v_mfma_f32_16x16x32_bf16 v[212:215], a[212:215], v[84:87], v[212:215]
    s_add_u32 s53, s53, 2621440
    v_exp_f32 v209, v209
    v_mfma_f32_16x16x32_bf16 v[212:215], a[216:219], v[88:91], v[212:215]
    s_lshr_b32 s44, s2, 5
    v_exp_f32 v210, v210
    v_mfma_f32_16x16x32_bf16 v[212:215], a[220:223], v[92:95], v[212:215]
    s_lshl_b32 s44, s44, 3
    v_exp_f32 v211, v211
    v_cvt_pk_bf16_f32 v128, v208, v209
    ds_read_b128 a[232:235], v10 offset:4096
    v_cvt_pk_bf16_f32 v129, v210, v211
    v_mfma_f32_16x16x32_bf16 v[208:211], a[208:211], v[96:99], v[200:203]
    s_and_b32 s37, s2, 7
    s_nop 0
    v_exp_f32 v212, v212
    v_mfma_f32_16x16x32_bf16 v[208:211], a[212:215], v[100:103], v[208:211]
    s_add_u32 s44, s44, s37
    v_exp_f32 v213, v213
    v_mfma_f32_16x16x32_bf16 v[208:211], a[216:219], v[104:107], v[208:211]
    s_lshl_b32 s44, s44, 2
    v_exp_f32 v214, v214
    v_mfma_f32_16x16x32_bf16 v[208:211], a[220:223], v[108:111], v[208:211]
    s_bfe_u32 s37, s2, 0x20003
    v_exp_f32 v215, v215
    v_cvt_pk_bf16_f32 v136, v212, v213
    ds_read_b128 a[236:239], v11 offset:4096
    v_cvt_pk_bf16_f32 v137, v214, v215
    v_mfma_f32_16x16x32_bf16 v[212:215], a[208:211], v[112:115], v[204:207]
    s_add_u32 s44, s44, s37
    s_nop 0
    v_exp_f32 v208, v208
    v_mfma_f32_16x16x32_bf16 v[212:215], a[212:215], v[116:119], v[212:215]
    s_add_u32 s44, s44, 72
    v_exp_f32 v209, v209
    v_mfma_f32_16x16x32_bf16 v[212:215], a[216:219], v[120:123], v[212:215]
    s_cmp_lt_u32 s44, 216
    s_cselect_b32 s37, 0, 2147483648
    v_exp_f32 v210, v210
    v_mfma_f32_16x16x32_bf16 v[212:215], a[220:223], v[124:127], v[212:215]
    s_lshl_b32 s44, s44, 5
    v_exp_f32 v211, v211
    v_cvt_pk_bf16_f32 v144, v208, v209
    ds_read_b128 a[208:211], v8 offset:8192
    v_cvt_pk_bf16_f32 v145, v210, v211
    v_mfma_f32_16x16x32_bf16 v[208:211], a[224:227], v[64:67], v[192:195]
    s_waitcnt lgkmcnt(3)
    s_or_b32 s44, s44, s37
    v_exp_f32 v212, v212
    v_mfma_f32_16x16x32_bf16 v[208:211], a[228:231], v[68:71], v[208:211]
    s_waitcnt lgkmcnt(2)
    s_mov_b32 s18, 3981312
    v_exp_f32 v213, v213
    v_mfma_f32_16x16x32_bf16 v[208:211], a[232:235], v[72:75], v[208:211]
    s_waitcnt lgkmcnt(1)
    s_lshr_b32 s6, s2, 3
    v_exp_f32 v214, v214
    v_mfma_f32_16x16x32_bf16 v[208:211], a[236:239], v[76:79], v[208:211]
    s_and_b32 s7, s2, 7
    v_exp_f32 v215, v215
    v_cvt_pk_bf16_f32 v152, v212, v213
    ds_read_b128 a[212:215], v9 offset:8192
    v_cvt_pk_bf16_f32 v153, v214, v215
    v_mfma_f32_16x16x32_bf16 v[212:215], a[224:227], v[80:83], v[196:199]
    s_mul_i32 s7, s7, 18
    s_nop 0
    v_exp_f32 v208, v208
    v_mfma_f32_16x16x32_bf16 v[212:215], a[228:231], v[84:87], v[212:215]
    s_add_u32 s7, s7, s6
    v_exp_f32 v209, v209
    v_mfma_f32_16x16x32_bf16 v[212:215], a[232:235], v[88:91], v[212:215]
    s_lshl_b32 s58, s7, 6
    v_exp_f32 v210, v210
    v_mfma_f32_16x16x32_bf16 v[212:215], a[236:239], v[92:95], v[212:215]
    s_mul_i32 s59, s7, 36864
    v_exp_f32 v211, v211
    v_cvt_pk_bf16_f32 v130, v208, v209
    ds_read_b128 a[216:219], v10 offset:8192
    v_cvt_pk_bf16_f32 v131, v210, v211
    v_mfma_f32_16x16x32_bf16 v[208:211], a[224:227], v[96:99], v[200:203]
    s_cmp_lt_u32 s6, 18
    s_cselect_b32 s7, 0, 2147483648
    v_exp_f32 v212, v212
    v_mfma_f32_16x16x32_bf16 v[208:211], a[228:231], v[100:103], v[208:211]
    s_or_b32 s58, s58, s7
    v_exp_f32 v213, v213
    v_mfma_f32_16x16x32_bf16 v[208:211], a[232:235], v[104:107], v[208:211]
    s_or_b32 s59, s59, s7
    v_exp_f32 v214, v214
    v_mfma_f32_16x16x32_bf16 v[208:211], a[236:239], v[108:111], v[208:211]
    s_and_b32 s7, s4, 1
    v_exp_f32 v215, v215
    v_cvt_pk_bf16_f32 v138, v212, v213
    ds_read_b128 a[220:223], v11 offset:8192
    v_cvt_pk_bf16_f32 v139, v214, v215
    s_mov_b32 s39, 221184
    s_mov_b32 s38, 27648
    v_mfma_f32_16x16x32_bf16 v[212:215], a[224:227], v[112:115], v[204:207]
    s_lshl_b32 s6, s7, 7
    v_exp_f32 v208, v208
    v_mfma_f32_16x16x32_bf16 v[212:215], a[228:231], v[116:119], v[212:215]
    s_xor_b32 s36, s4, 1
    v_exp_f32 v209, v209
    v_mfma_f32_16x16x32_bf16 v[212:215], a[232:235], v[120:123], v[212:215]
    s_mul_i32 s36, s36, 294912
    v_exp_f32 v210, v210
    v_mfma_f32_16x16x32_bf16 v[212:215], a[236:239], v[124:127], v[212:215]
    s_waitcnt lgkmcnt(3)
    s_add_u32 s46, s36, s6
    v_exp_f32 v211, v211
    v_cvt_pk_bf16_f32 v146, v208, v209
    ds_read_b128 a[224:227], v8 offset:12288
    v_cvt_pk_bf16_f32 v147, v210, v211
    v_mfma_f32_16x16x32_bf16 v[208:211], a[208:211], v[64:67], v[192:195]
    s_waitcnt lgkmcnt(3)
    s_lshl_b32 s36, s4, 8
    v_exp_f32 v212, v212
    v_mfma_f32_16x16x32_bf16 v[208:211], a[212:215], v[68:71], v[208:211]
    s_waitcnt lgkmcnt(2)
    s_add_u32 s56, s47, s36
    v_exp_f32 v213, v213
    v_mfma_f32_16x16x32_bf16 v[208:211], a[216:219], v[72:75], v[208:211]
    s_waitcnt lgkmcnt(1)
    s_lshr_b32 s36, s4, 1
    v_exp_f32 v214, v214
    v_mfma_f32_16x16x32_bf16 v[208:211], a[220:223], v[76:79], v[208:211]
    s_lshl_b32 s36, s36, 11
    v_exp_f32 v215, v215
    v_cvt_pk_bf16_f32 v154, v212, v213
    ds_read_b128 a[228:231], v9 offset:12288
    v_cvt_pk_bf16_f32 v155, v214, v215
    v_mfma_f32_16x16x32_bf16 v[212:215], a[208:211], v[80:83], v[196:199]
    s_lshl_b32 s7, s7, 8
    s_nop 0
    v_exp_f32 v208, v208
    v_mfma_f32_16x16x32_bf16 v[212:215], a[212:215], v[84:87], v[212:215]
    s_add_u32 s36, s36, s7
    v_exp_f32 v209, v209
    v_mfma_f32_16x16x32_bf16 v[212:215], a[216:219], v[88:91], v[212:215]
    s_add_u32 s93, s47, s36
    v_exp_f32 v210, v210
    v_mfma_f32_16x16x32_bf16 v[212:215], a[220:223], v[92:95], v[212:215]
    s_lshr_b32 s36, s4, 1
    v_exp_f32 v211, v211
    v_cvt_pk_bf16_f32 v132, v208, v209
    ds_read_b128 a[232:235], v10 offset:12288
    v_cvt_pk_bf16_f32 v133, v210, v211
    v_mfma_f32_16x16x32_bf16 v[208:211], a[208:211], v[96:99], v[200:203]
    s_lshl_b32 s36, s36, 4
    s_nop 0
    v_exp_f32 v212, v212
    v_mfma_f32_16x16x32_bf16 v[208:211], a[212:215], v[100:103], v[208:211]
    s_add_u32 s36, s36, s5
    v_exp_f32 v213, v213
    v_mfma_f32_16x16x32_bf16 v[208:211], a[216:219], v[104:107], v[208:211]
    s_lshl_b32 s36, s36, 9
    v_exp_f32 v214, v214
    v_mfma_f32_16x16x32_bf16 v[208:211], a[220:223], v[108:111], v[208:211]
    s_add_u32 s36, s36, s7
    v_exp_f32 v215, v215
    v_cvt_pk_bf16_f32 v140, v212, v213
    ds_read_b128 a[236:239], v11 offset:12288
    v_cvt_pk_bf16_f32 v141, v214, v215
    s_waitcnt vmcnt(4)
    s_barrier
    v_mfma_f32_16x16x32_bf16 v[212:215], a[208:211], v[112:115], v[204:207]
    s_lshl_b32 s36, s36, 8
    v_exp_f32 v208, v208
    v_mfma_f32_16x16x32_bf16 v[212:215], a[212:215], v[116:119], v[212:215]
    s_add_u32 m0, s42, 49152
    s_add_u32 s55, s36, 20971520
    v_exp_f32 v209, v209
    v_mfma_f32_16x16x32_bf16 v[212:215], a[216:219], v[120:123], v[212:215]
    s_add_u32 s7, s45, s6
    v_exp_f32 v210, v210
    v_mfma_f32_16x16x32_bf16 v[212:215], a[220:223], v[124:127], v[212:215]
    s_waitcnt lgkmcnt(3)
    s_xor_b32 s54, s92, 128
    v_exp_f32 v211, v211
    v_cvt_pk_bf16_f32 v148, v208, v209
    ds_read_b128 a[208:211], v8 offset:16384
    v_cvt_pk_bf16_f32 v149, v210, v211
    buffer_load_dwordx4 v36, s[8:11], s40 offen lds
    v_mfma_f32_16x16x32_bf16 v[208:211], a[224:227], v[64:67], v[192:195]
    s_waitcnt lgkmcnt(3)
    s_lshl_b32 s36, s3, 14
    v_exp_f32 v212, v212
    v_mfma_f32_16x16x32_bf16 v[208:211], a[228:231], v[68:71], v[208:211]
    s_waitcnt lgkmcnt(2)
    v_exp_f32 v213, v213
    v_mfma_f32_16x16x32_bf16 v[208:211], a[232:235], v[72:75], v[208:211]
    s_waitcnt lgkmcnt(1)
    v_exp_f32 v214, v214
    v_mfma_f32_16x16x32_bf16 v[208:211], a[236:239], v[76:79], v[208:211]
    v_exp_f32 v215, v215
    v_cvt_pk_bf16_f32 v156, v212, v213
    ds_read_b128 a[212:215], v9 offset:16384
    v_cvt_pk_bf16_f32 v157, v214, v215
    v_mfma_f32_16x16x32_bf16 v[212:215], a[224:227], v[80:83], v[196:199]
    s_nop 2
    v_exp_f32 v208, v208
    v_mfma_f32_16x16x32_bf16 v[212:215], a[228:231], v[84:87], v[212:215]
    v_exp_f32 v209, v209
    v_mfma_f32_16x16x32_bf16 v[212:215], a[232:235], v[88:91], v[212:215]
    v_exp_f32 v210, v210
    v_mfma_f32_16x16x32_bf16 v[212:215], a[236:239], v[92:95], v[212:215]
    v_exp_f32 v211, v211
    ds_read_b64_tr_b16 a[160:161], v20 offset:0
    v_cvt_pk_bf16_f32 v134, v208, v209
    v_lshrrev_b32 v51, 2, v0
    v_mul_u32_u24 v51, 9216, v51
    v_and_b32 v254, 3, v0
    v_lshl_add_u32 v254, v254, 4, v51
    v_lshlrev_b32 v255, 4, v0
    v_add_u32 v51, 98304, v255
    v_lshl_add_u32 v252, v1, 4, s36
    v_mov_b32 v224, 0
    v_mov_b32 v225, 0
    v_mov_b32 v226, 0
    v_mov_b32 v227, 0
    v_mov_b32 v228, 0
    v_mov_b32 v229, 0
    v_mov_b32 v230, 0
    v_mov_b32 v231, 0
    v_mov_b32 v248, -1
    v_mov_b32 v249, -1
    v_mov_b32 v250, -1
    v_mov_b32 v251, -1
    v_min_u32 v232, 41, v1
    v_lshlrev_b32 v232, 4, v232
    s_mov_b32 s57, s58
    s_lshl_b32 s6, s3, 10
    s_add_u32 s6, s6, 135168
    s_lshr_b32 s37, s2, 3
    s_mul_i32 s37, s37, -129024
    s_add_u32 s37, s37, 4128768
    ds_read_b64_tr_b16 a[162:163], v20 offset:4096
    ds_read_b128 a[216:219], v10 offset:16384
    v_cvt_pk_bf16_f32 v135, v210, v211
    buffer_load_dwordx4 v37, s[8:11], s40 offen offset:1024 lds
    v_mfma_f32_16x16x32_bf16 v[208:211], a[224:227], v[96:99], v[200:203]
    v_exp_f32 v212, v212
    v_mfma_f32_16x16x32_bf16 v[208:211], a[228:231], v[100:103], v[208:211]
    v_exp_f32 v213, v213
    v_mfma_f32_16x16x32_bf16 v[208:211], a[232:235], v[104:107], v[208:211]
    v_exp_f32 v214, v214
    v_mfma_f32_16x16x32_bf16 v[208:211], a[236:239], v[108:111], v[208:211]
    s_mov_b32 s52, s55
    v_exp_f32 v215, v215
    ds_read_b64_tr_b16 a[164:165], v20 offset:8192
    v_cvt_pk_bf16_f32 v142, v212, v213
    ds_read_b64_tr_b16 a[166:167], v20 offset:12288
    v_min_u32 v237, 19, v1
    v_lshl_add_u32 v237, v237, 7, s36
    v_lshl_add_u32 v238, v1, 7, s36
    ds_read_b128 a[220:223], v11 offset:16384
    v_cvt_pk_bf16_f32 v143, v214, v215
    buffer_load_dword v217, v57, s[32:35], s37 offen
    v_mfma_f32_16x16x32_bf16 v[212:215], a[224:227], v[112:115], v[204:207]
    v_exp_f32 v208, v208
    v_mfma_f32_16x16x32_bf16 v[212:215], a[228:231], v[116:119], v[212:215]
    v_exp_f32 v209, v209
    v_mfma_f32_16x16x32_bf16 v[212:215], a[232:235], v[120:123], v[212:215]
    s_mul_i32 s37, s5, 18432
    v_exp_f32 v210, v210
    v_mfma_f32_16x16x32_bf16 v[212:215], a[236:239], v[124:127], v[212:215]
    s_add_u32 s37, s37, s45
    v_exp_f32 v211, v211
    ds_read_b64_tr_b16 a[168:169], v21 offset:0
    v_cvt_pk_bf16_f32 v150, v208, v209
    ds_read_b64_tr_b16 a[170:171], v21 offset:4096
    v_min_u32 v236, 143, v0
    v_lshl_add_u32 v236, v236, 7, s37
    v_mul_u32_u24 v235, 24, v0
    v_lshrrev_b32 v235, 8, v235
    v_lshl_add_u32 v235, v235, 7, s37
    ds_read_b128 a[224:227], v8 offset:20480
    v_cvt_pk_bf16_f32 v151, v210, v211
    s_waitcnt lgkmcnt(3)
    buffer_load_dwordx4 v38, s[8:11], s40 offen offset:2048 lds
Lattn_loop:
    v_mfma_f32_16x16x32_bf16 v[208:211], a[208:211], v[64:67], v[192:195]
    v_exp_f32 v212, v212
    v_mfma_f32_16x16x32_bf16 v[208:211], a[212:215], v[68:71], v[208:211]
    v_exp_f32 v213, v213
    v_mfma_f32_16x16x32_bf16 v[208:211], a[216:219], v[72:75], v[208:211]
    v_exp_f32 v214, v214
    v_mfma_f32_16x16x32_bf16 v[208:211], a[220:223], v[76:79], v[208:211]
    v_exp_f32 v215, v215
    v_mfma_f32_16x16x32_bf16 a[0:3], a[160:163], v[128:131], a[0:3]
    ds_read_b64_tr_b16 a[172:173], v21 offset:8192
    v_cvt_pk_bf16_f32 v158, v212, v213
    v_mfma_f32_16x16x32_bf16 a[0:3], a[164:167], v[132:135], a[0:3]
    ds_read_b64_tr_b16 a[174:175], v21 offset:12288
    v_mfma_f32_16x16x32_bf16 a[4:7], a[160:163], v[136:139], a[4:7]
    ds_read_b128 a[228:231], v9 offset:20480
    v_cvt_pk_bf16_f32 v159, v214, v215
    v_mfma_f32_16x16x32_bf16 a[4:7], a[164:167], v[140:143], a[4:7]
    v_mfma_f32_16x16x32_bf16 v[212:215], a[208:211], v[80:83], v[196:199]
    v_exp_f32 v208, v208
    v_mfma_f32_16x16x32_bf16 v[212:215], a[212:215], v[84:87], v[212:215]
    v_exp_f32 v209, v209
    v_mfma_f32_16x16x32_bf16 v[212:215], a[216:219], v[88:91], v[212:215]
    v_exp_f32 v210, v210
    v_mfma_f32_16x16x32_bf16 v[212:215], a[220:223], v[92:95], v[212:215]
    v_exp_f32 v211, v211
    v_mfma_f32_16x16x32_bf16 a[8:11], a[160:163], v[144:147], a[8:11]
    ds_read_b64_tr_b16 a[176:177], v22 offset:0
    v_cvt_pk_bf16_f32 v160, v208, v209
    v_mfma_f32_16x16x32_bf16 a[8:11], a[164:167], v[148:151], a[8:11]
    ds_read_b64_tr_b16 a[178:179], v22 offset:4096
    v_mfma_f32_16x16x32_bf16 a[12:15], a[160:163], v[152:155], a[12:15]
    ds_read_b128 a[232:235], v10 offset:20480
    v_cvt_pk_bf16_f32 v161, v210, v211
    v_mfma_f32_16x16x32_bf16 a[12:15], a[164:167], v[156:159], a[12:15]
    s_waitcnt lgkmcnt(3)
    buffer_load_dwordx4 v39, s[8:11], s40 offen offset:3072 lds
    v_mfma_f32_16x16x32_bf16 v[208:211], a[208:211], v[96:99], v[200:203]
    v_exp_f32 v212, v212
    v_mfma_f32_16x16x32_bf16 v[208:211], a[212:215], v[100:103], v[208:211]
    s_add_u32 s40, s40, 16384
    v_exp_f32 v213, v213
    v_mfma_f32_16x16x32_bf16 v[208:211], a[216:219], v[104:107], v[208:211]
    s_mov_b32 m0, s6
    v_exp_f32 v214, v214
    v_mfma_f32_16x16x32_bf16 v[208:211], a[220:223], v[108:111], v[208:211]
    v_exp_f32 v215, v215
    v_mfma_f32_16x16x32_bf16 a[16:19], a[168:171], v[128:131], a[16:19]
    ds_read_b64_tr_b16 a[180:181], v22 offset:8192
    v_cvt_pk_bf16_f32 v168, v212, v213
    v_mfma_f32_16x16x32_bf16 a[16:19], a[172:175], v[132:135], a[16:19]
    ds_read_b64_tr_b16 a[182:183], v22 offset:12288
    v_mfma_f32_16x16x32_bf16 a[20:23], a[168:171], v[136:139], a[20:23]
    ds_read_b128 a[236:239], v11 offset:20480
    v_cvt_pk_bf16_f32 v169, v214, v215
    v_mfma_f32_16x16x32_bf16 a[20:23], a[172:175], v[140:143], a[20:23]
    buffer_load_dwordx4 v254, s[32:35], s57 offen  lds
    v_smfmac_f32_16x16x64_bf16 a[192:195], v[52:55], v[128:135], v50
    v_mfma_f32_16x16x32_bf16 v[212:215], a[208:211], v[112:115], v[204:207]
    v_exp_f32 v208, v208
    v_mfma_f32_16x16x32_bf16 v[212:215], a[212:215], v[116:119], v[212:215]
    s_add_u32 m0, s42, 98304
    v_exp_f32 v209, v209
    v_mfma_f32_16x16x32_bf16 v[212:215], a[216:219], v[120:123], v[212:215]
    v_exp_f32 v210, v210
    v_mfma_f32_16x16x32_bf16 v[212:215], a[220:223], v[124:127], v[212:215]
    v_exp_f32 v211, v211
    v_mfma_f32_16x16x32_bf16 a[24:27], a[168:171], v[144:147], a[24:27]
    ds_read_b64_tr_b16 a[184:185], v23 offset:0
    v_cvt_pk_bf16_f32 v176, v208, v209
    v_mfma_f32_16x16x32_bf16 a[24:27], a[172:175], v[148:151], a[24:27]
    ds_read_b64_tr_b16 a[186:187], v23 offset:4096
    v_mfma_f32_16x16x32_bf16 a[28:31], a[168:171], v[152:155], a[28:31]
    ds_read_b128 a[208:211], v8 offset:24576
    v_cvt_pk_bf16_f32 v177, v210, v211
    v_mfma_f32_16x16x32_bf16 a[28:31], a[172:175], v[156:159], a[28:31]
    s_waitcnt lgkmcnt(3)
    buffer_load_dwordx4 v40, s[12:15], s41 offen lds
    v_mfma_f32_16x16x32_bf16 v[208:211], a[224:227], v[64:67], v[192:195]
    v_exp_f32 v212, v212
    v_mfma_f32_16x16x32_bf16 v[208:211], a[228:231], v[68:71], v[208:211]
    s_add_u32 s6, s6, 4096
    v_exp_f32 v213, v213
    v_mfma_f32_16x16x32_bf16 v[208:211], a[232:235], v[72:75], v[208:211]
    s_add_u32 s57, s57, 589824
    v_exp_f32 v214, v214
    v_mfma_f32_16x16x32_bf16 v[208:211], a[236:239], v[76:79], v[208:211]
    v_exp_f32 v215, v215
    v_mfma_f32_16x16x32_bf16 a[32:35], a[176:179], v[128:131], a[32:35]
    ds_read_b64_tr_b16 a[188:189], v23 offset:8192
    v_cvt_pk_bf16_f32 v184, v212, v213
    v_mfma_f32_16x16x32_bf16 a[32:35], a[180:183], v[132:135], a[32:35]
    ds_read_b64_tr_b16 a[190:191], v23 offset:12288
    v_mfma_f32_16x16x32_bf16 a[36:39], a[176:179], v[136:139], a[36:39]
    ds_read_b128 a[212:215], v9 offset:24576
    v_cvt_pk_bf16_f32 v185, v214, v215
    v_mfma_f32_16x16x32_bf16 a[36:39], a[180:183], v[140:143], a[36:39]
    v_smfmac_f32_16x16x64_bf16 a[196:199], v[52:55], v[136:143], v50
    v_mfma_f32_16x16x32_bf16 v[212:215], a[224:227], v[80:83], v[196:199]
    v_exp_f32 v208, v208
    v_mfma_f32_16x16x32_bf16 v[212:215], a[228:231], v[84:87], v[212:215]
    v_exp_f32 v209, v209
    v_mfma_f32_16x16x32_bf16 v[212:215], a[232:235], v[88:91], v[212:215]
    v_exp_f32 v210, v210
    v_mfma_f32_16x16x32_bf16 v[212:215], a[236:239], v[92:95], v[212:215]
    v_exp_f32 v211, v211
    v_mfma_f32_16x16x32_bf16 a[40:43], a[176:179], v[144:147], a[40:43]
    ds_read_b64_tr_b16 a[160:161], v24 offset:0
    v_cvt_pk_bf16_f32 v162, v208, v209
    v_mfma_f32_16x16x32_bf16 a[40:43], a[180:183], v[148:151], a[40:43]
    ds_read_b64_tr_b16 a[162:163], v24 offset:4096
    v_mfma_f32_16x16x32_bf16 a[44:47], a[176:179], v[152:155], a[44:47]
    ds_read_b128 a[216:219], v10 offset:24576
    v_cvt_pk_bf16_f32 v163, v210, v211
    v_mfma_f32_16x16x32_bf16 a[44:47], a[180:183], v[156:159], a[44:47]
    s_waitcnt lgkmcnt(3)
    buffer_load_dwordx4 v41, s[12:15], s41 offen offset:1024 lds
    v_mfma_f32_16x16x32_bf16 v[208:211], a[224:227], v[96:99], v[200:203]
    v_exp_f32 v212, v212
    v_mfma_f32_16x16x32_bf16 v[208:211], a[228:231], v[100:103], v[208:211]
    v_exp_f32 v213, v213
    v_mfma_f32_16x16x32_bf16 v[208:211], a[232:235], v[104:107], v[208:211]
    v_exp_f32 v214, v214
    v_mfma_f32_16x16x32_bf16 v[208:211], a[236:239], v[108:111], v[208:211]
    v_exp_f32 v215, v215
    v_mfma_f32_16x16x32_bf16 a[48:51], a[184:187], v[128:131], a[48:51]
    ds_read_b64_tr_b16 a[164:165], v24 offset:8192
    v_cvt_pk_bf16_f32 v170, v212, v213
    v_mfma_f32_16x16x32_bf16 a[48:51], a[188:191], v[132:135], a[48:51]
    ds_read_b64_tr_b16 a[166:167], v24 offset:12288
    v_mfma_f32_16x16x32_bf16 a[52:55], a[184:187], v[136:139], a[52:55]
    ds_read_b128 a[220:223], v11 offset:24576
    v_cvt_pk_bf16_f32 v171, v214, v215
    v_mfma_f32_16x16x32_bf16 a[52:55], a[188:191], v[140:143], a[52:55]
    v_smfmac_f32_16x16x64_bf16 a[200:203], v[52:55], v[144:151], v50
    v_mfma_f32_16x16x32_bf16 v[212:215], a[224:227], v[112:115], v[204:207]
    v_exp_f32 v208, v208
    v_mfma_f32_16x16x32_bf16 v[212:215], a[228:231], v[116:119], v[212:215]
    v_exp_f32 v209, v209
    v_mfma_f32_16x16x32_bf16 v[212:215], a[232:235], v[120:123], v[212:215]
    v_exp_f32 v210, v210
    v_mfma_f32_16x16x32_bf16 v[212:215], a[236:239], v[124:127], v[212:215]
    v_exp_f32 v211, v211
    v_mfma_f32_16x16x32_bf16 a[56:59], a[184:187], v[144:147], a[56:59]
    ds_read_b64_tr_b16 a[168:169], v25 offset:0
    v_cvt_pk_bf16_f32 v178, v208, v209
    v_mfma_f32_16x16x32_bf16 a[56:59], a[188:191], v[148:151], a[56:59]
    ds_read_b64_tr_b16 a[170:171], v25 offset:4096
    v_mfma_f32_16x16x32_bf16 a[60:63], a[184:187], v[152:155], a[60:63]
    ds_read_b128 a[224:227], v8 offset:28672
    v_cvt_pk_bf16_f32 v179, v210, v211
    v_mfma_f32_16x16x32_bf16 a[60:63], a[188:191], v[156:159], a[60:63]
    s_waitcnt lgkmcnt(3)
    buffer_load_dwordx4 v40, s[12:15], s41 offen offset:2048 lds
    v_mfma_f32_16x16x32_bf16 v[208:211], a[208:211], v[64:67], v[192:195]
    v_exp_f32 v212, v212
    v_mfma_f32_16x16x32_bf16 v[208:211], a[212:215], v[68:71], v[208:211]
Ltour4:
    s_cbranch_execz Ltour8
    v_exp_f32 v213, v213
    v_mfma_f32_16x16x32_bf16 v[208:211], a[216:219], v[72:75], v[208:211]
    v_exp_f32 v214, v214
    v_mfma_f32_16x16x32_bf16 v[208:211], a[220:223], v[76:79], v[208:211]
    v_exp_f32 v215, v215
    v_mfma_f32_16x16x32_bf16 a[64:67], a[160:163], v[128:131], a[64:67]
    ds_read_b64_tr_b16 a[172:173], v25 offset:8192
    v_cvt_pk_bf16_f32 v186, v212, v213
    v_mfma_f32_16x16x32_bf16 a[64:67], a[164:167], v[132:135], a[64:67]
    ds_read_b64_tr_b16 a[174:175], v25 offset:12288
    v_mfma_f32_16x16x32_bf16 a[68:71], a[160:163], v[136:139], a[68:71]
    ds_read_b128 a[228:231], v9 offset:28672
    v_cvt_pk_bf16_f32 v187, v214, v215
    v_mfma_f32_16x16x32_bf16 a[68:71], a[164:167], v[140:143], a[68:71]
    v_smfmac_f32_16x16x64_bf16 a[204:207], v[52:55], v[152:159], v50
    v_mfma_f32_16x16x32_bf16 v[212:215], a[208:211], v[80:83], v[196:199]
    v_exp_f32 v208, v208
    v_mfma_f32_16x16x32_bf16 v[212:215], a[212:215], v[84:87], v[212:215]
    v_exp_f32 v209, v209
    v_mfma_f32_16x16x32_bf16 v[212:215], a[216:219], v[88:91], v[212:215]
    v_exp_f32 v210, v210
    v_mfma_f32_16x16x32_bf16 v[212:215], a[220:223], v[92:95], v[212:215]
    v_exp_f32 v211, v211
    v_mfma_f32_16x16x32_bf16 a[72:75], a[160:163], v[144:147], a[72:75]
    ds_read_b64_tr_b16 a[176:177], v26 offset:0
    v_cvt_pk_bf16_f32 v164, v208, v209
    v_mfma_f32_16x16x32_bf16 a[72:75], a[164:167], v[148:151], a[72:75]
    ds_read_b64_tr_b16 a[178:179], v26 offset:4096
    v_mfma_f32_16x16x32_bf16 a[76:79], a[160:163], v[152:155], a[76:79]
    ds_read_b128 a[232:235], v10 offset:28672
    v_cvt_pk_bf16_f32 v165, v210, v211
    v_mfma_f32_16x16x32_bf16 a[76:79], a[164:167], v[156:159], a[76:79]
    s_waitcnt lgkmcnt(3)
    buffer_load_dwordx4 v41, s[12:15], s41 offen offset:3072 lds
    v_mfma_f32_16x16x32_bf16 v[208:211], a[208:211], v[96:99], v[200:203]
    v_exp_f32 v212, v212
    v_mfma_f32_16x16x32_bf16 v[208:211], a[212:215], v[100:103], v[208:211]
    s_add_u32 s41, s41, 16384
    v_exp_f32 v213, v213
    v_mfma_f32_16x16x32_bf16 v[208:211], a[216:219], v[104:107], v[208:211]
    v_exp_f32 v214, v214
    v_mfma_f32_16x16x32_bf16 v[208:211], a[220:223], v[108:111], v[208:211]
    v_exp_f32 v215, v215
    v_mfma_f32_16x16x32_bf16 a[80:83], a[168:171], v[128:131], a[80:83]
    ds_read_b64_tr_b16 a[180:181], v26 offset:8192
    v_cvt_pk_bf16_f32 v172, v212, v213
    v_mfma_f32_16x16x32_bf16 a[80:83], a[172:175], v[132:135], a[80:83]
    ds_read_b64_tr_b16 a[182:183], v26 offset:12288
    v_mfma_f32_16x16x32_bf16 a[84:87], a[168:171], v[136:139], a[84:87]
    ds_read_b128 a[236:239], v11 offset:28672
    v_cvt_pk_bf16_f32 v173, v214, v215
    v_mfma_f32_16x16x32_bf16 a[84:87], a[172:175], v[140:143], a[84:87]
    s_waitcnt vmcnt(10)
    s_barrier
    v_mfma_f32_16x16x32_bf16 v[212:215], a[208:211], v[112:115], v[204:207]
    v_exp_f32 v208, v208
    v_mfma_f32_16x16x32_bf16 v[212:215], a[212:215], v[116:119], v[212:215]
    s_add_u32 m0, s42, 0
    v_exp_f32 v209, v209
    v_mfma_f32_16x16x32_bf16 v[212:215], a[216:219], v[120:123], v[212:215]
    v_exp_f32 v210, v210
    v_mfma_f32_16x16x32_bf16 v[212:215], a[220:223], v[124:127], v[212:215]
    v_exp_f32 v211, v211
    v_mfma_f32_16x16x32_bf16 a[88:91], a[168:171], v[144:147], a[88:91]
    ds_read_b64_tr_b16 a[184:185], v27 offset:0
    v_cvt_pk_bf16_f32 v180, v208, v209
    v_mfma_f32_16x16x32_bf16 a[88:91], a[172:175], v[148:151], a[88:91]
    ds_read_b64_tr_b16 a[186:187], v27 offset:4096
    v_mfma_f32_16x16x32_bf16 a[92:95], a[168:171], v[152:155], a[92:95]
    ds_read_b128 a[208:211], v8 offset:32768
    v_cvt_pk_bf16_f32 v181, v210, v211
    v_mfma_f32_16x16x32_bf16 a[92:95], a[172:175], v[156:159], a[92:95]
    s_waitcnt lgkmcnt(3)
    buffer_load_dwordx4 v36, s[8:11], s40 offen lds
    v_mfma_f32_16x16x32_bf16 v[208:211], a[224:227], v[64:67], v[192:195]
    v_exp_f32 v212, v212
    v_mfma_f32_16x16x32_bf16 v[208:211], a[228:231], v[68:71], v[208:211]
    v_exp_f32 v213, v213
    v_mfma_f32_16x16x32_bf16 v[208:211], a[232:235], v[72:75], v[208:211]
    v_exp_f32 v214, v214
    v_mfma_f32_16x16x32_bf16 v[208:211], a[236:239], v[76:79], v[208:211]
    v_exp_f32 v215, v215
    v_mfma_f32_16x16x32_bf16 a[96:99], a[176:179], v[128:131], a[96:99]
    ds_read_b64_tr_b16 a[188:189], v27 offset:8192
    v_cvt_pk_bf16_f32 v188, v212, v213
    v_mfma_f32_16x16x32_bf16 a[96:99], a[180:183], v[132:135], a[96:99]
    ds_read_b64_tr_b16 a[190:191], v27 offset:12288
    v_mfma_f32_16x16x32_bf16 a[100:103], a[176:179], v[136:139], a[100:103]
    ds_read_b128 a[212:215], v9 offset:32768
    v_cvt_pk_bf16_f32 v189, v214, v215
    v_mfma_f32_16x16x32_bf16 a[100:103], a[180:183], v[140:143], a[100:103]
    v_mfma_f32_16x16x32_bf16 v[212:215], a[224:227], v[80:83], v[196:199]
    v_exp_f32 v208, v208
    v_mfma_f32_16x16x32_bf16 v[212:215], a[228:231], v[84:87], v[212:215]
    v_exp_f32 v209, v209
    v_mfma_f32_16x16x32_bf16 v[212:215], a[232:235], v[88:91], v[212:215]
    v_exp_f32 v210, v210
    v_mfma_f32_16x16x32_bf16 v[212:215], a[236:239], v[92:95], v[212:215]
    v_exp_f32 v211, v211
    v_mfma_f32_16x16x32_bf16 a[104:107], a[176:179], v[144:147], a[104:107]
    ds_read_b64_tr_b16 a[160:161], v20 offset:16384
    v_cvt_pk_bf16_f32 v166, v208, v209
    v_mfma_f32_16x16x32_bf16 a[104:107], a[180:183], v[148:151], a[104:107]
    ds_read_b64_tr_b16 a[162:163], v20 offset:20480
    v_mfma_f32_16x16x32_bf16 a[108:111], a[176:179], v[152:155], a[108:111]
    ds_read_b128 a[216:219], v10 offset:32768
    v_cvt_pk_bf16_f32 v167, v210, v211
    v_mfma_f32_16x16x32_bf16 a[108:111], a[180:183], v[156:159], a[108:111]
    s_waitcnt lgkmcnt(3)
    buffer_load_dwordx4 v37, s[8:11], s40 offen offset:1024 lds
    v_mfma_f32_16x16x32_bf16 v[208:211], a[224:227], v[96:99], v[200:203]
    v_exp_f32 v212, v212
    v_mfma_f32_16x16x32_bf16 v[208:211], a[228:231], v[100:103], v[208:211]
    v_exp_f32 v213, v213
    v_mfma_f32_16x16x32_bf16 v[208:211], a[232:235], v[104:107], v[208:211]
    v_exp_f32 v214, v214
    v_mfma_f32_16x16x32_bf16 v[208:211], a[236:239], v[108:111], v[208:211]
    v_exp_f32 v215, v215
    v_mfma_f32_16x16x32_bf16 a[112:115], a[184:187], v[128:131], a[112:115]
    ds_read_b64_tr_b16 a[164:165], v20 offset:24576
    v_cvt_pk_bf16_f32 v174, v212, v213
    v_mfma_f32_16x16x32_bf16 a[112:115], a[188:191], v[132:135], a[112:115]
    ds_read_b64_tr_b16 a[166:167], v20 offset:28672
    v_mfma_f32_16x16x32_bf16 a[116:119], a[184:187], v[136:139], a[116:119]
    ds_read_b128 a[220:223], v11 offset:32768
    v_cvt_pk_bf16_f32 v175, v214, v215
    v_mfma_f32_16x16x32_bf16 a[116:119], a[188:191], v[140:143], a[116:119]
    buffer_load_dwordx4 v[240:243], v7, s[16:19], s44 offen
    v_mfma_f32_16x16x32_bf16 v[212:215], a[224:227], v[112:115], v[204:207]
    v_exp_f32 v208, v208
    v_mfma_f32_16x16x32_bf16 v[212:215], a[228:231], v[116:119], v[212:215]
    v_exp_f32 v209, v209
    v_mfma_f32_16x16x32_bf16 v[212:215], a[232:235], v[120:123], v[212:215]
    v_exp_f32 v210, v210
    v_mfma_f32_16x16x32_bf16 v[212:215], a[236:239], v[124:127], v[212:215]
    s_add_u32 s44, s44, 884736
    v_exp_f32 v211, v211
    v_mfma_f32_16x16x32_bf16 a[120:123], a[184:187], v[144:147], a[120:123]
    ds_read_b64_tr_b16 a[168:169], v21 offset:16384
    v_cvt_pk_bf16_f32 v182, v208, v209
    v_mfma_f32_16x16x32_bf16 a[120:123], a[188:191], v[148:151], a[120:123]
    ds_read_b64_tr_b16 a[170:171], v21 offset:20480
    v_mfma_f32_16x16x32_bf16 a[124:127], a[184:187], v[152:155], a[124:127]
    ds_read_b128 a[224:227], v8 offset:36864
    v_cvt_pk_bf16_f32 v183, v210, v211
    v_mfma_f32_16x16x32_bf16 a[124:127], a[188:191], v[156:159], a[124:127]
    s_waitcnt lgkmcnt(3)
    buffer_load_dwordx4 v38, s[8:11], s40 offen offset:2048 lds
    v_mfma_f32_16x16x32_bf16 v[208:211], a[208:211], v[64:67], v[192:195]
    v_exp_f32 v212, v212
    v_mfma_f32_16x16x32_bf16 v[208:211], a[212:215], v[68:71], v[208:211]
    v_exp_f32 v213, v213
    v_mfma_f32_16x16x32_bf16 v[208:211], a[216:219], v[72:75], v[208:211]
    v_exp_f32 v214, v214
    v_mfma_f32_16x16x32_bf16 v[208:211], a[220:223], v[76:79], v[208:211]
    v_exp_f32 v215, v215
    v_mfma_f32_16x16x32_bf16 a[0:3], a[160:163], v[160:163], a[0:3]
    ds_read_b64_tr_b16 a[172:173], v21 offset:24576
    v_cvt_pk_bf16_f32 v190, v212, v213
    v_mfma_f32_16x16x32_bf16 a[0:3], a[164:167], v[164:167], a[0:3]
    ds_read_b64_tr_b16 a[174:175], v21 offset:28672
    v_mfma_f32_16x16x32_bf16 a[4:7], a[160:163], v[168:171], a[4:7]
    ds_read_b128 a[228:231], v9 offset:36864
    v_cvt_pk_bf16_f32 v191, v214, v215
    v_mfma_f32_16x16x32_bf16 a[4:7], a[164:167], v[172:175], a[4:7]
    v_mfma_f32_16x16x32_bf16 v[212:215], a[208:211], v[80:83], v[196:199]
    v_exp_f32 v208, v208
    v_mfma_f32_16x16x32_bf16 v[212:215], a[212:215], v[84:87], v[212:215]
    v_exp_f32 v209, v209
    v_mfma_f32_16x16x32_bf16 v[212:215], a[216:219], v[88:91], v[212:215]
    v_exp_f32 v210, v210
    v_mfma_f32_16x16x32_bf16 v[212:215], a[220:223], v[92:95], v[212:215]
    v_exp_f32 v211, v211
    v_mfma_f32_16x16x32_bf16 a[8:11], a[160:163], v[176:179], a[8:11]
    ds_read_b64_tr_b16 a[176:177], v22 offset:16384
    v_cvt_pk_bf16_f32 v128, v208, v209
    v_mfma_f32_16x16x32_bf16 a[8:11], a[164:167], v[180:183], a[8:11]
    ds_read_b64_tr_b16 a[178:179], v22 offset:20480
    v_mfma_f32_16x16x32_bf16 a[12:15], a[160:163], v[184:187], a[12:15]
    ds_read_b128 a[232:235], v10 offset:36864
    v_cvt_pk_bf16_f32 v129, v210, v211
    v_mfma_f32_16x16x32_bf16 a[12:15], a[164:167], v[188:191], a[12:15]
    s_waitcnt lgkmcnt(3)
    buffer_load_dwordx4 v39, s[8:11], s40 offen offset:3072 lds
    v_mfma_f32_16x16x32_bf16 v[208:211], a[208:211], v[96:99], v[200:203]
    v_exp_f32 v212, v212
    v_mfma_f32_16x16x32_bf16 v[208:211], a[212:215], v[100:103], v[208:211]
    s_add_u32 s40, s40, 16384
    v_exp_f32 v213, v213
    v_mfma_f32_16x16x32_bf16 v[208:211], a[216:219], v[104:107], v[208:211]
    v_exp_f32 v214, v214
    v_mfma_f32_16x16x32_bf16 v[208:211], a[220:223], v[108:111], v[208:211]
    v_exp_f32 v215, v215
    v_mfma_f32_16x16x32_bf16 a[16:19], a[168:171], v[160:163], a[16:19]
    ds_read_b64_tr_b16 a[180:181], v22 offset:24576
    v_cvt_pk_bf16_f32 v136, v212, v213
    v_mfma_f32_16x16x32_bf16 a[16:19], a[172:175], v[164:167], a[16:19]
    ds_read_b64_tr_b16 a[182:183], v22 offset:28672
    v_mfma_f32_16x16x32_bf16 a[20:23], a[168:171], v[168:171], a[20:23]
    ds_read_b128 a[236:239], v11 offset:36864
    v_cvt_pk_bf16_f32 v137, v214, v215
    v_mfma_f32_16x16x32_bf16 a[20:23], a[172:175], v[172:175], a[20:23]
    v_smfmac_f32_16x16x64_bf16 a[192:195], v[52:55], v[160:167], v50
    v_mfma_f32_16x16x32_bf16 v[212:215], a[208:211], v[112:115], v[204:207]
    v_exp_f32 v208, v208
    v_mfma_f32_16x16x32_bf16 v[212:215], a[212:215], v[116:119], v[212:215]
    s_add_u32 m0, s42, 114688
    v_exp_f32 v209, v209
    v_mfma_f32_16x16x32_bf16 v[212:215], a[216:219], v[120:123], v[212:215]
    v_exp_f32 v210, v210
    v_mfma_f32_16x16x32_bf16 v[212:215], a[220:223], v[124:127], v[212:215]
    v_exp_f32 v211, v211
    v_mfma_f32_16x16x32_bf16 a[24:27], a[168:171], v[176:179], a[24:27]
    ds_read_b64_tr_b16 a[184:185], v23 offset:16384
    v_cvt_pk_bf16_f32 v144, v208, v209
    v_mfma_f32_16x16x32_bf16 a[24:27], a[172:175], v[180:183], a[24:27]
    ds_read_b64_tr_b16 a[186:187], v23 offset:20480
    v_mfma_f32_16x16x32_bf16 a[28:31], a[168:171], v[184:187], a[28:31]
    ds_read_b128 a[208:211], v8 offset:40960
    v_cvt_pk_bf16_f32 v145, v210, v211
    v_mfma_f32_16x16x32_bf16 a[28:31], a[172:175], v[188:191], a[28:31]
    s_waitcnt lgkmcnt(3)
    buffer_load_dwordx4 v40, s[12:15], s41 offen lds
    v_mfma_f32_16x16x32_bf16 v[208:211], a[224:227], v[64:67], v[192:195]
    v_exp_f32 v212, v212
    v_mfma_f32_16x16x32_bf16 v[208:211], a[228:231], v[68:71], v[208:211]
    v_exp_f32 v213, v213
    v_mfma_f32_16x16x32_bf16 v[208:211], a[232:235], v[72:75], v[208:211]
    v_exp_f32 v214, v214
    v_mfma_f32_16x16x32_bf16 v[208:211], a[236:239], v[76:79], v[208:211]
    v_exp_f32 v215, v215
    v_mfma_f32_16x16x32_bf16 a[32:35], a[176:179], v[160:163], a[32:35]
    ds_read_b64_tr_b16 a[188:189], v23 offset:24576
    v_cvt_pk_bf16_f32 v152, v212, v213
    v_mfma_f32_16x16x32_bf16 a[32:35], a[180:183], v[164:167], a[32:35]
    ds_read_b64_tr_b16 a[190:191], v23 offset:28672
    v_mfma_f32_16x16x32_bf16 a[36:39], a[176:179], v[168:171], a[36:39]
    ds_read_b128 a[212:215], v9 offset:40960
    v_cvt_pk_bf16_f32 v153, v214, v215
    v_mfma_f32_16x16x32_bf16 a[36:39], a[180:183], v[172:175], a[36:39]
    v_smfmac_f32_16x16x64_bf16 a[196:199], v[52:55], v[168:175], v50
    v_mfma_f32_16x16x32_bf16 v[212:215], a[224:227], v[80:83], v[196:199]
    v_exp_f32 v208, v208
    v_mfma_f32_16x16x32_bf16 v[212:215], a[228:231], v[84:87], v[212:215]
    v_exp_f32 v209, v209
    v_mfma_f32_16x16x32_bf16 v[212:215], a[232:235], v[88:91], v[212:215]
    v_exp_f32 v210, v210
    v_mfma_f32_16x16x32_bf16 v[212:215], a[236:239], v[92:95], v[212:215]
    v_exp_f32 v211, v211
    v_mfma_f32_16x16x32_bf16 a[40:43], a[176:179], v[176:179], a[40:43]
    ds_read_b64_tr_b16 a[160:161], v24 offset:16384
    v_cvt_pk_bf16_f32 v130, v208, v209
    v_mfma_f32_16x16x32_bf16 a[40:43], a[180:183], v[180:183], a[40:43]
    ds_read_b64_tr_b16 a[162:163], v24 offset:20480
    v_mfma_f32_16x16x32_bf16 a[44:47], a[176:179], v[184:187], a[44:47]
    ds_read_b128 a[216:219], v10 offset:40960
    v_cvt_pk_bf16_f32 v131, v210, v211
    v_mfma_f32_16x16x32_bf16 a[44:47], a[180:183], v[188:191], a[44:47]
    s_waitcnt lgkmcnt(3)
    buffer_load_dwordx4 v41, s[12:15], s41 offen offset:1024 lds
    v_mfma_f32_16x16x32_bf16 v[208:211], a[224:227], v[96:99], v[200:203]
    v_exp_f32 v212, v212
    v_mfma_f32_16x16x32_bf16 v[208:211], a[228:231], v[100:103], v[208:211]
    v_exp_f32 v213, v213
    v_mfma_f32_16x16x32_bf16 v[208:211], a[232:235], v[104:107], v[208:211]
    v_exp_f32 v214, v214
    v_mfma_f32_16x16x32_bf16 v[208:211], a[236:239], v[108:111], v[208:211]
    v_exp_f32 v215, v215
    v_mfma_f32_16x16x32_bf16 a[48:51], a[184:187], v[160:163], a[48:51]
    ds_read_b64_tr_b16 a[164:165], v24 offset:24576
    v_cvt_pk_bf16_f32 v138, v212, v213
    v_mfma_f32_16x16x32_bf16 a[48:51], a[188:191], v[164:167], a[48:51]
    ds_read_b64_tr_b16 a[166:167], v24 offset:28672
    v_mfma_f32_16x16x32_bf16 a[52:55], a[184:187], v[168:171], a[52:55]
    ds_read_b128 a[220:223], v11 offset:40960
    v_cvt_pk_bf16_f32 v139, v214, v215
    v_mfma_f32_16x16x32_bf16 a[52:55], a[188:191], v[172:175], a[52:55]
    v_smfmac_f32_16x16x64_bf16 a[200:203], v[52:55], v[176:183], v50
    v_mfma_f32_16x16x32_bf16 v[212:215], a[224:227], v[112:115], v[204:207]
    v_exp_f32 v208, v208
    v_mfma_f32_16x16x32_bf16 v[212:215], a[228:231], v[116:119], v[212:215]
    v_exp_f32 v209, v209
    v_mfma_f32_16x16x32_bf16 v[212:215], a[232:235], v[120:123], v[212:215]
    v_exp_f32 v210, v210
    v_mfma_f32_16x16x32_bf16 v[212:215], a[236:239], v[124:127], v[212:215]
    v_exp_f32 v211, v211
    v_mfma_f32_16x16x32_bf16 a[56:59], a[184:187], v[176:179], a[56:59]
    ds_read_b64_tr_b16 a[168:169], v25 offset:16384
    v_cvt_pk_bf16_f32 v146, v208, v209
    v_mfma_f32_16x16x32_bf16 a[56:59], a[188:191], v[180:183], a[56:59]
    ds_read_b64_tr_b16 a[170:171], v25 offset:20480
    v_mfma_f32_16x16x32_bf16 a[60:63], a[184:187], v[184:187], a[60:63]
    ds_read_b128 a[224:227], v8 offset:45056
    v_cvt_pk_bf16_f32 v147, v210, v211
    v_mfma_f32_16x16x32_bf16 a[60:63], a[188:191], v[188:191], a[60:63]
    s_waitcnt lgkmcnt(3)
    buffer_load_dwordx4 v40, s[12:15], s41 offen offset:2048 lds
    v_mfma_f32_16x16x32_bf16 v[208:211], a[208:211], v[64:67], v[192:195]
    v_exp_f32 v212, v212
    v_mfma_f32_16x16x32_bf16 v[208:211], a[212:215], v[68:71], v[208:211]
    v_exp_f32 v213, v213
    v_mfma_f32_16x16x32_bf16 v[208:211], a[216:219], v[72:75], v[208:211]
    v_exp_f32 v214, v214
    v_mfma_f32_16x16x32_bf16 v[208:211], a[220:223], v[76:79], v[208:211]
    v_exp_f32 v215, v215
    v_mfma_f32_16x16x32_bf16 a[64:67], a[160:163], v[160:163], a[64:67]
    ds_read_b64_tr_b16 a[172:173], v25 offset:24576
    v_cvt_pk_bf16_f32 v154, v212, v213
    v_mfma_f32_16x16x32_bf16 a[64:67], a[164:167], v[164:167], a[64:67]
    ds_read_b64_tr_b16 a[174:175], v25 offset:28672
    v_mfma_f32_16x16x32_bf16 a[68:71], a[160:163], v[168:171], a[68:71]
    ds_read_b128 a[228:231], v9 offset:45056
    v_cvt_pk_bf16_f32 v155, v214, v215
    v_mfma_f32_16x16x32_bf16 a[68:71], a[164:167], v[172:175], a[68:71]
    v_smfmac_f32_16x16x64_bf16 a[204:207], v[52:55], v[184:191], v50
    v_mfma_f32_16x16x32_bf16 v[212:215], a[208:211], v[80:83], v[196:199]
    v_exp_f32 v208, v208
    v_mfma_f32_16x16x32_bf16 v[212:215], a[212:215], v[84:87], v[212:215]
    v_exp_f32 v209, v209
    v_mfma_f32_16x16x32_bf16 v[212:215], a[216:219], v[88:91], v[212:215]
    v_exp_f32 v210, v210
    v_mfma_f32_16x16x32_bf16 v[212:215], a[220:223], v[92:95], v[212:215]
    v_exp_f32 v211, v211
    v_mfma_f32_16x16x32_bf16 a[72:75], a[160:163], v[176:179], a[72:75]
    ds_read_b64_tr_b16 a[176:177], v26 offset:16384
    v_cvt_pk_bf16_f32 v132, v208, v209
    v_mfma_f32_16x16x32_bf16 a[72:75], a[164:167], v[180:183], a[72:75]
    ds_read_b64_tr_b16 a[178:179], v26 offset:20480
    v_mfma_f32_16x16x32_bf16 a[76:79], a[160:163], v[184:187], a[76:79]
    ds_read_b128 a[232:235], v10 offset:45056
    v_cvt_pk_bf16_f32 v133, v210, v211
    v_mfma_f32_16x16x32_bf16 a[76:79], a[164:167], v[188:191], a[76:79]
    s_waitcnt lgkmcnt(3)
    buffer_load_dwordx4 v41, s[12:15], s41 offen offset:3072 lds
    v_mfma_f32_16x16x32_bf16 v[208:211], a[208:211], v[96:99], v[200:203]
    v_exp_f32 v212, v212
    v_mfma_f32_16x16x32_bf16 v[208:211], a[212:215], v[100:103], v[208:211]
    s_add_u32 s41, s41, 16384
    v_exp_f32 v213, v213
    v_mfma_f32_16x16x32_bf16 v[208:211], a[216:219], v[104:107], v[208:211]
    v_exp_f32 v214, v214
    v_mfma_f32_16x16x32_bf16 v[208:211], a[220:223], v[108:111], v[208:211]
    v_exp_f32 v215, v215
    v_mfma_f32_16x16x32_bf16 a[80:83], a[168:171], v[160:163], a[80:83]
    ds_read_b64_tr_b16 a[180:181], v26 offset:24576
    v_cvt_pk_bf16_f32 v140, v212, v213
    v_mfma_f32_16x16x32_bf16 a[80:83], a[172:175], v[164:167], a[80:83]
    ds_read_b64_tr_b16 a[182:183], v26 offset:28672
    v_mfma_f32_16x16x32_bf16 a[84:87], a[168:171], v[168:171], a[84:87]
    ds_read_b128 a[236:239], v11 offset:45056
    v_cvt_pk_bf16_f32 v141, v214, v215
    v_mfma_f32_16x16x32_bf16 a[84:87], a[172:175], v[172:175], a[84:87]
    s_waitcnt vmcnt(9)
    s_barrier
    v_mfma_f32_16x16x32_bf16 v[212:215], a[208:211], v[112:115], v[204:207]
    v_exp_f32 v208, v208
    v_mfma_f32_16x16x32_bf16 v[212:215], a[212:215], v[116:119], v[212:215]
    s_add_u32 m0, s42, 16384
    v_exp_f32 v209, v209
    v_mfma_f32_16x16x32_bf16 v[212:215], a[216:219], v[120:123], v[212:215]
    v_exp_f32 v210, v210
    v_mfma_f32_16x16x32_bf16 v[212:215], a[220:223], v[124:127], v[212:215]
    v_exp_f32 v211, v211
    v_mfma_f32_16x16x32_bf16 a[88:91], a[168:171], v[176:179], a[88:91]
    ds_read_b64_tr_b16 a[184:185], v27 offset:16384
    v_cvt_pk_bf16_f32 v148, v208, v209
    v_mfma_f32_16x16x32_bf16 a[88:91], a[172:175], v[180:183], a[88:91]
    ds_read_b64_tr_b16 a[186:187], v27 offset:20480
    v_mfma_f32_16x16x32_bf16 a[92:95], a[168:171], v[184:187], a[92:95]
    ds_read_b128 a[208:211], v8 offset:49152
    v_cvt_pk_bf16_f32 v149, v210, v211
    v_mfma_f32_16x16x32_bf16 a[92:95], a[172:175], v[188:191], a[92:95]
    s_waitcnt lgkmcnt(3)
    buffer_load_dwordx4 v36, s[8:11], s40 offen lds
    v_mfma_f32_16x16x32_bf16 v[208:211], a[224:227], v[64:67], v[192:195]
    v_exp_f32 v212, v212
    v_mfma_f32_16x16x32_bf16 v[208:211], a[228:231], v[68:71], v[208:211]
    v_exp_f32 v213, v213
    v_mfma_f32_16x16x32_bf16 v[208:211], a[232:235], v[72:75], v[208:211]
    v_exp_f32 v214, v214
    v_mfma_f32_16x16x32_bf16 v[208:211], a[236:239], v[76:79], v[208:211]
    v_exp_f32 v215, v215
    v_mfma_f32_16x16x32_bf16 a[96:99], a[176:179], v[160:163], a[96:99]
    ds_read_b64_tr_b16 a[188:189], v27 offset:24576
    v_cvt_pk_bf16_f32 v156, v212, v213
    v_mfma_f32_16x16x32_bf16 a[96:99], a[180:183], v[164:167], a[96:99]
    ds_read_b64_tr_b16 a[190:191], v27 offset:28672
    v_mfma_f32_16x16x32_bf16 a[100:103], a[176:179], v[168:171], a[100:103]
    ds_read_b128 a[212:215], v9 offset:49152
    v_cvt_pk_bf16_f32 v157, v214, v215
    v_mfma_f32_16x16x32_bf16 a[100:103], a[180:183], v[172:175], a[100:103]
    buffer_load_dword v218, v57, s[80:83], s39 offen
    v_mfma_f32_16x16x32_bf16 v[212:215], a[224:227], v[80:83], v[196:199]
    v_exp_f32 v208, v208
    v_mfma_f32_16x16x32_bf16 v[212:215], a[228:231], v[84:87], v[212:215]
    v_exp_f32 v209, v209
    v_mfma_f32_16x16x32_bf16 v[212:215], a[232:235], v[88:91], v[212:215]
    v_exp_f32 v210, v210
    v_mfma_f32_16x16x32_bf16 v[212:215], a[236:239], v[92:95], v[212:215]
    v_exp_f32 v211, v211
    v_mfma_f32_16x16x32_bf16 a[104:107], a[176:179], v[176:179], a[104:107]
    ds_read_b64_tr_b16 a[160:161], v20 offset:32768
    v_cvt_pk_bf16_f32 v134, v208, v209
    v_mfma_f32_16x16x32_bf16 a[104:107], a[180:183], v[180:183], a[104:107]
    ds_read_b64_tr_b16 a[162:163], v20 offset:36864
    v_mfma_f32_16x16x32_bf16 a[108:111], a[176:179], v[184:187], a[108:111]
    ds_read_b128 a[216:219], v10 offset:49152
    v_cvt_pk_bf16_f32 v135, v210, v211
    v_mfma_f32_16x16x32_bf16 a[108:111], a[180:183], v[188:191], a[108:111]
    s_waitcnt lgkmcnt(3)
    buffer_load_dwordx4 v37, s[8:11], s40 offen offset:1024 lds
    v_mfma_f32_16x16x32_bf16 v[208:211], a[224:227], v[96:99], v[200:203]
    v_exp_f32 v212, v212
    v_mfma_f32_16x16x32_bf16 v[208:211], a[228:231], v[100:103], v[208:211]
    v_exp_f32 v213, v213
    v_mfma_f32_16x16x32_bf16 v[208:211], a[232:235], v[104:107], v[208:211]
    v_exp_f32 v214, v214
    v_mfma_f32_16x16x32_bf16 v[208:211], a[236:239], v[108:111], v[208:211]
    v_exp_f32 v215, v215
    v_mfma_f32_16x16x32_bf16 a[112:115], a[184:187], v[160:163], a[112:115]
    ds_read_b64_tr_b16 a[164:165], v20 offset:40960
    v_cvt_pk_bf16_f32 v142, v212, v213
    v_mfma_f32_16x16x32_bf16 a[112:115], a[188:191], v[164:167], a[112:115]
    ds_read_b64_tr_b16 a[166:167], v20 offset:45056
    v_mfma_f32_16x16x32_bf16 a[116:119], a[184:187], v[168:171], a[116:119]
    ds_read_b128 a[220:223], v11 offset:49152
    v_cvt_pk_bf16_f32 v143, v214, v215
    v_mfma_f32_16x16x32_bf16 a[116:119], a[188:191], v[172:175], a[116:119]
    buffer_store_dwordx4 v[248:251], v232, s[24:27], s53 offen sc1
    v_mfma_f32_16x16x32_bf16 v[212:215], a[224:227], v[112:115], v[204:207]
    v_exp_f32 v208, v208
    v_mfma_f32_16x16x32_bf16 v[212:215], a[228:231], v[116:119], v[212:215]
    v_exp_f32 v209, v209
    v_mfma_f32_16x16x32_bf16 v[212:215], a[232:235], v[120:123], v[212:215]
    v_exp_f32 v210, v210
    v_mfma_f32_16x16x32_bf16 v[212:215], a[236:239], v[124:127], v[212:215]
    s_add_u32 s53, s53, 656
    v_exp_f32 v211, v211
    v_mfma_f32_16x16x32_bf16 a[120:123], a[184:187], v[176:179], a[120:123]
    ds_read_b64_tr_b16 a[168:169], v21 offset:32768
    v_cvt_pk_bf16_f32 v150, v208, v209
    v_mfma_f32_16x16x32_bf16 a[120:123], a[188:191], v[180:183], a[120:123]
    ds_read_b64_tr_b16 a[170:171], v21 offset:36864
    v_mfma_f32_16x16x32_bf16 a[124:127], a[184:187], v[184:187], a[124:127]
    ds_read_b128 a[224:227], v8 offset:53248
    v_cvt_pk_bf16_f32 v151, v210, v211
    v_mfma_f32_16x16x32_bf16 a[124:127], a[188:191], v[188:191], a[124:127]
    s_waitcnt lgkmcnt(3)
    buffer_load_dwordx4 v38, s[8:11], s40 offen offset:2048 lds
    v_mfma_f32_16x16x32_bf16 v[208:211], a[208:211], v[64:67], v[192:195]
    v_exp_f32 v212, v212
    v_mfma_f32_16x16x32_bf16 v[208:211], a[212:215], v[68:71], v[208:211]
    v_exp_f32 v213, v213
    v_mfma_f32_16x16x32_bf16 v[208:211], a[216:219], v[72:75], v[208:211]
    v_exp_f32 v214, v214
    v_mfma_f32_16x16x32_bf16 v[208:211], a[220:223], v[76:79], v[208:211]
    v_exp_f32 v215, v215
    v_mfma_f32_16x16x32_bf16 a[0:3], a[160:163], v[128:131], a[0:3]
    ds_read_b64_tr_b16 a[172:173], v21 offset:40960
    v_cvt_pk_bf16_f32 v158, v212, v213
    v_mfma_f32_16x16x32_bf16 a[0:3], a[164:167], v[132:135], a[0:3]
    ds_read_b64_tr_b16 a[174:175], v21 offset:45056
    v_mfma_f32_16x16x32_bf16 a[4:7], a[160:163], v[136:139], a[4:7]
    ds_read_b128 a[228:231], v9 offset:53248
    v_cvt_pk_bf16_f32 v159, v214, v215
    v_mfma_f32_16x16x32_bf16 a[4:7], a[164:167], v[140:143], a[4:7]
    v_mfma_f32_16x16x32_bf16 v[212:215], a[208:211], v[80:83], v[196:199]
    v_exp_f32 v208, v208
    v_mfma_f32_16x16x32_bf16 v[212:215], a[212:215], v[84:87], v[212:215]
    v_exp_f32 v209, v209
    v_mfma_f32_16x16x32_bf16 v[212:215], a[216:219], v[88:91], v[212:215]
    v_exp_f32 v210, v210
    v_mfma_f32_16x16x32_bf16 v[212:215], a[220:223], v[92:95], v[212:215]
    v_exp_f32 v211, v211
    v_mfma_f32_16x16x32_bf16 a[8:11], a[160:163], v[144:147], a[8:11]
    ds_read_b64_tr_b16 a[176:177], v22 offset:32768
    v_cvt_pk_bf16_f32 v160, v208, v209
    v_mfma_f32_16x16x32_bf16 a[8:11], a[164:167], v[148:151], a[8:11]
    ds_read_b64_tr_b16 a[178:179], v22 offset:36864
    v_mfma_f32_16x16x32_bf16 a[12:15], a[160:163], v[152:155], a[12:15]
    ds_read_b128 a[232:235], v10 offset:53248
    v_cvt_pk_bf16_f32 v161, v210, v211
    v_mfma_f32_16x16x32_bf16 a[12:15], a[164:167], v[156:159], a[12:15]
    s_waitcnt lgkmcnt(3)
    buffer_load_dwordx4 v39, s[8:11], s40 offen offset:3072 lds
    v_mfma_f32_16x16x32_bf16 v[208:211], a[208:211], v[96:99], v[200:203]
    v_exp_f32 v212, v212
    v_mfma_f32_16x16x32_bf16 v[208:211], a[212:215], v[100:103], v[208:211]
    s_add_u32 s40, s40, 16384
    v_exp_f32 v213, v213
    v_mfma_f32_16x16x32_bf16 v[208:211], a[216:219], v[104:107], v[208:211]
    v_exp_f32 v214, v214
    v_mfma_f32_16x16x32_bf16 v[208:211], a[220:223], v[108:111], v[208:211]
    v_exp_f32 v215, v215
    v_mfma_f32_16x16x32_bf16 a[16:19], a[168:171], v[128:131], a[16:19]
    ds_read_b64_tr_b16 a[180:181], v22 offset:40960
    v_cvt_pk_bf16_f32 v168, v212, v213
    v_mfma_f32_16x16x32_bf16 a[16:19], a[172:175], v[132:135], a[16:19]
    ds_read_b64_tr_b16 a[182:183], v22 offset:45056
    v_mfma_f32_16x16x32_bf16 a[20:23], a[168:171], v[136:139], a[20:23]
    ds_read_b128 a[236:239], v11 offset:53248
    v_cvt_pk_bf16_f32 v169, v214, v215
    v_mfma_f32_16x16x32_bf16 a[20:23], a[172:175], v[140:143], a[20:23]
    v_smfmac_f32_16x16x64_bf16 a[192:195], v[52:55], v[128:135], v50
    v_mfma_f32_16x16x32_bf16 v[212:215], a[208:211], v[112:115], v[204:207]
    v_exp_f32 v208, v208
    v_mfma_f32_16x16x32_bf16 v[212:215], a[212:215], v[116:119], v[212:215]
    s_add_u32 m0, s42, 65536
    v_exp_f32 v209, v209
    v_mfma_f32_16x16x32_bf16 v[212:215], a[216:219], v[120:123], v[212:215]
    v_exp_f32 v210, v210
    v_mfma_f32_16x16x32_bf16 v[212:215], a[220:223], v[124:127], v[212:215]
    v_exp_f32 v211, v211
    v_mfma_f32_16x16x32_bf16 a[24:27], a[168:171], v[144:147], a[24:27]
    ds_read_b64_tr_b16 a[184:185], v23 offset:32768
    v_cvt_pk_bf16_f32 v176, v208, v209
    v_mfma_f32_16x16x32_bf16 a[24:27], a[172:175], v[148:151], a[24:27]
    ds_read_b64_tr_b16 a[186:187], v23 offset:36864
    v_mfma_f32_16x16x32_bf16 a[28:31], a[168:171], v[152:155], a[28:31]
    ds_read_b128 a[208:211], v8 offset:57344
    v_cvt_pk_bf16_f32 v177, v210, v211
    v_mfma_f32_16x16x32_bf16 a[28:31], a[172:175], v[156:159], a[28:31]
    s_waitcnt lgkmcnt(3)
    buffer_load_dwordx4 v40, s[12:15], s41 offen lds
    v_mfma_f32_16x16x32_bf16 v[208:211], a[224:227], v[64:67], v[192:195]
    v_exp_f32 v212, v212
    v_mfma_f32_16x16x32_bf16 v[208:211], a[228:231], v[68:71], v[208:211]
    v_exp_f32 v213, v213
    v_mfma_f32_16x16x32_bf16 v[208:211], a[232:235], v[72:75], v[208:211]
    v_exp_f32 v214, v214
    v_mfma_f32_16x16x32_bf16 v[208:211], a[236:239], v[76:79], v[208:211]
    v_exp_f32 v215, v215
    v_mfma_f32_16x16x32_bf16 a[32:35], a[176:179], v[128:131], a[32:35]
    ds_read_b64_tr_b16 a[188:189], v23 offset:40960
    v_cvt_pk_bf16_f32 v184, v212, v213
    v_mfma_f32_16x16x32_bf16 a[32:35], a[180:183], v[132:135], a[32:35]
    ds_read_b64_tr_b16 a[190:191], v23 offset:45056
    v_mfma_f32_16x16x32_bf16 a[36:39], a[176:179], v[136:139], a[36:39]
    ds_read_b128 a[212:215], v9 offset:57344
    v_cvt_pk_bf16_f32 v185, v214, v215
    v_mfma_f32_16x16x32_bf16 a[36:39], a[180:183], v[140:143], a[36:39]
    v_smfmac_f32_16x16x64_bf16 a[196:199], v[52:55], v[136:143], v50
    v_mfma_f32_16x16x32_bf16 v[212:215], a[224:227], v[80:83], v[196:199]
    v_exp_f32 v208, v208
    v_mfma_f32_16x16x32_bf16 v[212:215], a[228:231], v[84:87], v[212:215]
    v_exp_f32 v209, v209
    v_mfma_f32_16x16x32_bf16 v[212:215], a[232:235], v[88:91], v[212:215]
    v_exp_f32 v210, v210
    v_mfma_f32_16x16x32_bf16 v[212:215], a[236:239], v[92:95], v[212:215]
    v_exp_f32 v211, v211
    v_mfma_f32_16x16x32_bf16 a[40:43], a[176:179], v[144:147], a[40:43]
    ds_read_b64_tr_b16 a[160:161], v24 offset:32768
    v_cvt_pk_bf16_f32 v162, v208, v209
    v_mfma_f32_16x16x32_bf16 a[40:43], a[180:183], v[148:151], a[40:43]
    ds_read_b64_tr_b16 a[162:163], v24 offset:36864
    v_mfma_f32_16x16x32_bf16 a[44:47], a[176:179], v[152:155], a[44:47]
    ds_read_b128 a[216:219], v10 offset:57344
    v_cvt_pk_bf16_f32 v163, v210, v211
    v_mfma_f32_16x16x32_bf16 a[44:47], a[180:183], v[156:159], a[44:47]
    s_waitcnt lgkmcnt(3)
    buffer_load_dwordx4 v41, s[12:15], s41 offen offset:1024 lds
    v_mfma_f32_16x16x32_bf16 v[208:211], a[224:227], v[96:99], v[200:203]
    v_exp_f32 v212, v212
    v_mfma_f32_16x16x32_bf16 v[208:211], a[228:231], v[100:103], v[208:211]
    v_exp_f32 v213, v213
    v_mfma_f32_16x16x32_bf16 v[208:211], a[232:235], v[104:107], v[208:211]
    v_exp_f32 v214, v214
    v_mfma_f32_16x16x32_bf16 v[208:211], a[236:239], v[108:111], v[208:211]
    v_exp_f32 v215, v215
    v_mfma_f32_16x16x32_bf16 a[48:51], a[184:187], v[128:131], a[48:51]
    ds_read_b64_tr_b16 a[164:165], v24 offset:40960
    v_cvt_pk_bf16_f32 v170, v212, v213
    v_mfma_f32_16x16x32_bf16 a[48:51], a[188:191], v[132:135], a[48:51]
    ds_read_b64_tr_b16 a[166:167], v24 offset:45056
    v_mfma_f32_16x16x32_bf16 a[52:55], a[184:187], v[136:139], a[52:55]
    ds_read_b128 a[220:223], v11 offset:57344
    v_cvt_pk_bf16_f32 v171, v214, v215
    v_mfma_f32_16x16x32_bf16 a[52:55], a[188:191], v[140:143], a[52:55]
    v_smfmac_f32_16x16x64_bf16 a[200:203], v[52:55], v[144:151], v50
    v_mfma_f32_16x16x32_bf16 v[212:215], a[224:227], v[112:115], v[204:207]
    v_exp_f32 v208, v208
    v_mfma_f32_16x16x32_bf16 v[212:215], a[228:231], v[116:119], v[212:215]
    v_exp_f32 v209, v209
    v_mfma_f32_16x16x32_bf16 v[212:215], a[232:235], v[120:123], v[212:215]
Ltour5:
    s_cbranch_execz Ltour9
    v_exp_f32 v210, v210
    v_mfma_f32_16x16x32_bf16 v[212:215], a[236:239], v[124:127], v[212:215]
    v_exp_f32 v211, v211
    v_mfma_f32_16x16x32_bf16 a[56:59], a[184:187], v[144:147], a[56:59]
    ds_read_b64_tr_b16 a[168:169], v25 offset:32768
    v_cvt_pk_bf16_f32 v178, v208, v209
    v_mfma_f32_16x16x32_bf16 a[56:59], a[188:191], v[148:151], a[56:59]
    ds_read_b64_tr_b16 a[170:171], v25 offset:36864
    v_mfma_f32_16x16x32_bf16 a[60:63], a[184:187], v[152:155], a[60:63]
    ds_read_b128 a[224:227], v8 offset:61440
    v_cvt_pk_bf16_f32 v179, v210, v211
    v_mfma_f32_16x16x32_bf16 a[60:63], a[188:191], v[156:159], a[60:63]
    s_waitcnt lgkmcnt(3)
    buffer_load_dwordx4 v40, s[12:15], s41 offen offset:2048 lds
    v_mfma_f32_16x16x32_bf16 v[208:211], a[208:211], v[64:67], v[192:195]
    v_exp_f32 v212, v212
    v_mfma_f32_16x16x32_bf16 v[208:211], a[212:215], v[68:71], v[208:211]
    v_exp_f32 v213, v213
    v_mfma_f32_16x16x32_bf16 v[208:211], a[216:219], v[72:75], v[208:211]
    v_exp_f32 v214, v214
    v_mfma_f32_16x16x32_bf16 v[208:211], a[220:223], v[76:79], v[208:211]
    v_exp_f32 v215, v215
    v_mfma_f32_16x16x32_bf16 a[64:67], a[160:163], v[128:131], a[64:67]
    ds_read_b64_tr_b16 a[172:173], v25 offset:40960
    v_cvt_pk_bf16_f32 v186, v212, v213
    v_mfma_f32_16x16x32_bf16 a[64:67], a[164:167], v[132:135], a[64:67]
    ds_read_b64_tr_b16 a[174:175], v25 offset:45056
    v_mfma_f32_16x16x32_bf16 a[68:71], a[160:163], v[136:139], a[68:71]
    ds_read_b128 a[228:231], v9 offset:61440
    v_cvt_pk_bf16_f32 v187, v214, v215
    v_mfma_f32_16x16x32_bf16 a[68:71], a[164:167], v[140:143], a[68:71]
    v_smfmac_f32_16x16x64_bf16 a[204:207], v[52:55], v[152:159], v50
    v_mfma_f32_16x16x32_bf16 v[212:215], a[208:211], v[80:83], v[196:199]
    v_exp_f32 v208, v208
    v_mfma_f32_16x16x32_bf16 v[212:215], a[212:215], v[84:87], v[212:215]
    v_exp_f32 v209, v209
    v_mfma_f32_16x16x32_bf16 v[212:215], a[216:219], v[88:91], v[212:215]
    v_exp_f32 v210, v210
    v_mfma_f32_16x16x32_bf16 v[212:215], a[220:223], v[92:95], v[212:215]
    v_exp_f32 v211, v211
    v_mfma_f32_16x16x32_bf16 a[72:75], a[160:163], v[144:147], a[72:75]
    ds_read_b64_tr_b16 a[176:177], v26 offset:32768
    v_cvt_pk_bf16_f32 v164, v208, v209
    v_mfma_f32_16x16x32_bf16 a[72:75], a[164:167], v[148:151], a[72:75]
    ds_read_b64_tr_b16 a[178:179], v26 offset:36864
    v_mfma_f32_16x16x32_bf16 a[76:79], a[160:163], v[152:155], a[76:79]
    ds_read_b128 a[232:235], v10 offset:61440
    v_cvt_pk_bf16_f32 v165, v210, v211
    v_mfma_f32_16x16x32_bf16 a[76:79], a[164:167], v[156:159], a[76:79]
    s_waitcnt lgkmcnt(3)
    buffer_load_dwordx4 v41, s[12:15], s41 offen offset:3072 lds
    v_mfma_f32_16x16x32_bf16 v[208:211], a[208:211], v[96:99], v[200:203]
    v_exp_f32 v212, v212
    v_mfma_f32_16x16x32_bf16 v[208:211], a[212:215], v[100:103], v[208:211]
    s_add_u32 s41, s41, 16384
    v_exp_f32 v213, v213
    v_mfma_f32_16x16x32_bf16 v[208:211], a[216:219], v[104:107], v[208:211]
    v_exp_f32 v214, v214
    v_mfma_f32_16x16x32_bf16 v[208:211], a[220:223], v[108:111], v[208:211]
    v_exp_f32 v215, v215
    v_mfma_f32_16x16x32_bf16 a[80:83], a[168:171], v[128:131], a[80:83]
    ds_read_b64_tr_b16 a[180:181], v26 offset:40960
    v_cvt_pk_bf16_f32 v172, v212, v213
    v_mfma_f32_16x16x32_bf16 a[80:83], a[172:175], v[132:135], a[80:83]
    ds_read_b64_tr_b16 a[182:183], v26 offset:45056
    v_mfma_f32_16x16x32_bf16 a[84:87], a[168:171], v[136:139], a[84:87]
    ds_read_b128 a[236:239], v11 offset:61440
    v_cvt_pk_bf16_f32 v173, v214, v215
    v_mfma_f32_16x16x32_bf16 a[84:87], a[172:175], v[140:143], a[84:87]
    s_waitcnt vmcnt(10)
    s_barrier
    v_mfma_f32_16x16x32_bf16 v[212:215], a[208:211], v[112:115], v[204:207]
    v_exp_f32 v208, v208
    v_mfma_f32_16x16x32_bf16 v[212:215], a[212:215], v[116:119], v[212:215]
    s_add_u32 m0, s42, 32768
    v_exp_f32 v209, v209
    v_mfma_f32_16x16x32_bf16 v[212:215], a[216:219], v[120:123], v[212:215]
    v_exp_f32 v210, v210
    v_mfma_f32_16x16x32_bf16 v[212:215], a[220:223], v[124:127], v[212:215]
    v_exp_f32 v211, v211
    v_mfma_f32_16x16x32_bf16 a[88:91], a[168:171], v[144:147], a[88:91]
    ds_read_b64_tr_b16 a[184:185], v27 offset:32768
    v_cvt_pk_bf16_f32 v180, v208, v209
    v_mfma_f32_16x16x32_bf16 a[88:91], a[172:175], v[148:151], a[88:91]
    ds_read_b64_tr_b16 a[186:187], v27 offset:36864
    v_mfma_f32_16x16x32_bf16 a[92:95], a[168:171], v[152:155], a[92:95]
    ds_read_b128 a[208:211], v8 offset:0
    v_cvt_pk_bf16_f32 v181, v210, v211
    v_mfma_f32_16x16x32_bf16 a[92:95], a[172:175], v[156:159], a[92:95]
    s_waitcnt lgkmcnt(3)
    buffer_load_dwordx4 v36, s[8:11], s40 offen lds
    v_mfma_f32_16x16x32_bf16 v[208:211], a[224:227], v[64:67], v[192:195]
    v_exp_f32 v212, v212
    v_mfma_f32_16x16x32_bf16 v[208:211], a[228:231], v[68:71], v[208:211]
    v_exp_f32 v213, v213
    v_mfma_f32_16x16x32_bf16 v[208:211], a[232:235], v[72:75], v[208:211]
    v_exp_f32 v214, v214
    v_mfma_f32_16x16x32_bf16 v[208:211], a[236:239], v[76:79], v[208:211]
    v_exp_f32 v215, v215
    v_mfma_f32_16x16x32_bf16 a[96:99], a[176:179], v[128:131], a[96:99]
    ds_read_b64_tr_b16 a[188:189], v27 offset:40960
    v_cvt_pk_bf16_f32 v188, v212, v213
    v_mfma_f32_16x16x32_bf16 a[96:99], a[180:183], v[132:135], a[96:99]
    ds_read_b64_tr_b16 a[190:191], v27 offset:45056
    v_mfma_f32_16x16x32_bf16 a[100:103], a[176:179], v[136:139], a[100:103]
    ds_read_b128 a[212:215], v9 offset:0
    v_cvt_pk_bf16_f32 v189, v214, v215
    v_mfma_f32_16x16x32_bf16 a[100:103], a[180:183], v[140:143], a[100:103]
    buffer_load_dword v219, v62, s[84:87], s38 offen
    v_mfma_f32_16x16x32_bf16 v[212:215], a[224:227], v[80:83], v[196:199]
    v_exp_f32 v208, v208
    v_mfma_f32_16x16x32_bf16 v[212:215], a[228:231], v[84:87], v[212:215]
    v_exp_f32 v209, v209
    v_mfma_f32_16x16x32_bf16 v[212:215], a[232:235], v[88:91], v[212:215]
    v_exp_f32 v210, v210
    v_mfma_f32_16x16x32_bf16 v[212:215], a[236:239], v[92:95], v[212:215]
    v_exp_f32 v211, v211
    v_mfma_f32_16x16x32_bf16 a[104:107], a[176:179], v[144:147], a[104:107]
    ds_read_b64_tr_b16 a[160:161], v20 offset:49152
    v_cvt_pk_bf16_f32 v166, v208, v209
    v_mfma_f32_16x16x32_bf16 a[104:107], a[180:183], v[148:151], a[104:107]
    ds_read_b64_tr_b16 a[162:163], v20 offset:53248
    v_mfma_f32_16x16x32_bf16 a[108:111], a[176:179], v[152:155], a[108:111]
    ds_read_b128 a[216:219], v10 offset:0
    v_cvt_pk_bf16_f32 v167, v210, v211
    v_mfma_f32_16x16x32_bf16 a[108:111], a[180:183], v[156:159], a[108:111]
    s_waitcnt lgkmcnt(3)
    buffer_load_dwordx4 v37, s[8:11], s40 offen offset:1024 lds
    v_mfma_f32_16x16x32_bf16 v[208:211], a[224:227], v[96:99], v[200:203]
    v_exp_f32 v212, v212
    v_mfma_f32_16x16x32_bf16 v[208:211], a[228:231], v[100:103], v[208:211]
    v_exp_f32 v213, v213
    v_mfma_f32_16x16x32_bf16 v[208:211], a[232:235], v[104:107], v[208:211]
    v_exp_f32 v214, v214
    v_mfma_f32_16x16x32_bf16 v[208:211], a[236:239], v[108:111], v[208:211]
    v_exp_f32 v215, v215
    v_mfma_f32_16x16x32_bf16 a[112:115], a[184:187], v[128:131], a[112:115]
    ds_read_b64_tr_b16 a[164:165], v20 offset:57344
    v_cvt_pk_bf16_f32 v174, v212, v213
    v_mfma_f32_16x16x32_bf16 a[112:115], a[188:191], v[132:135], a[112:115]
    ds_read_b64_tr_b16 a[166:167], v20 offset:61440
    v_mfma_f32_16x16x32_bf16 a[116:119], a[184:187], v[136:139], a[116:119]
    ds_read_b128 a[220:223], v11 offset:0
    v_cvt_pk_bf16_f32 v175, v214, v215
    v_mfma_f32_16x16x32_bf16 a[116:119], a[188:191], v[140:143], a[116:119]
    buffer_load_dword v221, v235, s[20:23], 0 offen
    v_mfma_f32_16x16x32_bf16 v[212:215], a[224:227], v[112:115], v[204:207]
    v_exp_f32 v208, v208
    v_mfma_f32_16x16x32_bf16 v[212:215], a[228:231], v[116:119], v[212:215]
    v_exp_f32 v209, v209
    v_mfma_f32_16x16x32_bf16 v[212:215], a[232:235], v[120:123], v[212:215]
    v_exp_f32 v210, v210
    v_mfma_f32_16x16x32_bf16 v[212:215], a[236:239], v[124:127], v[212:215]
    v_exp_f32 v211, v211
    v_mfma_f32_16x16x32_bf16 a[120:123], a[184:187], v[144:147], a[120:123]
    ds_read_b64_tr_b16 a[168:169], v21 offset:49152
    v_cvt_pk_bf16_f32 v182, v208, v209
    v_mfma_f32_16x16x32_bf16 a[120:123], a[188:191], v[148:151], a[120:123]
    ds_read_b64_tr_b16 a[170:171], v21 offset:53248
    v_add_u32 v235, 2560, v235
    v_mfma_f32_16x16x32_bf16 a[124:127], a[184:187], v[152:155], a[124:127]
    ds_read_b128 a[224:227], v8 offset:4096
    v_cvt_pk_bf16_f32 v183, v210, v211
    v_mfma_f32_16x16x32_bf16 a[124:127], a[188:191], v[156:159], a[124:127]
    s_waitcnt lgkmcnt(3)
    buffer_load_dwordx4 v38, s[8:11], s40 offen offset:2048 lds
    v_mfma_f32_16x16x32_bf16 v[208:211], a[208:211], v[64:67], v[192:195]
    v_exp_f32 v212, v212
    v_mfma_f32_16x16x32_bf16 v[208:211], a[212:215], v[68:71], v[208:211]
    v_exp_f32 v213, v213
    v_mfma_f32_16x16x32_bf16 v[208:211], a[216:219], v[72:75], v[208:211]
    v_exp_f32 v214, v214
    v_mfma_f32_16x16x32_bf16 v[208:211], a[220:223], v[76:79], v[208:211]
    v_exp_f32 v215, v215
    v_mfma_f32_16x16x32_bf16 a[0:3], a[160:163], v[160:163], a[0:3]
    ds_read_b64_tr_b16 a[172:173], v21 offset:57344
    v_cvt_pk_bf16_f32 v190, v212, v213
    v_mfma_f32_16x16x32_bf16 a[0:3], a[164:167], v[164:167], a[0:3]
    ds_read_b64_tr_b16 a[174:175], v21 offset:61440
    v_lshlrev_b32 v244, 16, v240
    v_mfma_f32_16x16x32_bf16 a[4:7], a[160:163], v[168:171], a[4:7]
    ds_read_b128 a[228:231], v9 offset:4096
    v_cvt_pk_bf16_f32 v191, v214, v215
    v_mfma_f32_16x16x32_bf16 a[4:7], a[164:167], v[172:175], a[4:7]
    v_and_b32 v245, 0xffff0000, v240
    v_fmac_f32 v224, v2, v244
    v_mfma_f32_16x16x32_bf16 v[212:215], a[208:211], v[80:83], v[196:199]
    v_exp_f32 v208, v208
    v_mfma_f32_16x16x32_bf16 v[212:215], a[212:215], v[84:87], v[212:215]
    v_exp_f32 v209, v209
    v_mfma_f32_16x16x32_bf16 v[212:215], a[216:219], v[88:91], v[212:215]
    v_exp_f32 v210, v210
    v_mfma_f32_16x16x32_bf16 v[212:215], a[220:223], v[92:95], v[212:215]
    v_exp_f32 v211, v211
    v_mfma_f32_16x16x32_bf16 a[8:11], a[160:163], v[176:179], a[8:11]
    ds_read_b64_tr_b16 a[176:177], v22 offset:49152
    v_cvt_pk_bf16_f32 v128, v208, v209
    v_mfma_f32_16x16x32_bf16 a[8:11], a[164:167], v[180:183], a[8:11]
    ds_read_b64_tr_b16 a[178:179], v22 offset:53248
    v_fmac_f32 v225, v2, v245
    v_mfma_f32_16x16x32_bf16 a[12:15], a[160:163], v[184:187], a[12:15]
    ds_read_b128 a[232:235], v10 offset:4096
    v_cvt_pk_bf16_f32 v129, v210, v211
    v_mfma_f32_16x16x32_bf16 a[12:15], a[164:167], v[188:191], a[12:15]
    s_waitcnt lgkmcnt(3)
    buffer_load_dwordx4 v39, s[8:11], s40 offen offset:3072 lds
    v_mfma_f32_16x16x32_bf16 v[208:211], a[208:211], v[96:99], v[200:203]
    v_exp_f32 v212, v212
    v_mfma_f32_16x16x32_bf16 v[208:211], a[212:215], v[100:103], v[208:211]
    s_add_u32 s40, s40, 16384
    v_exp_f32 v213, v213
    v_mfma_f32_16x16x32_bf16 v[208:211], a[216:219], v[104:107], v[208:211]
    v_exp_f32 v214, v214
    v_mfma_f32_16x16x32_bf16 v[208:211], a[220:223], v[108:111], v[208:211]
    v_exp_f32 v215, v215
    v_mfma_f32_16x16x32_bf16 a[16:19], a[168:171], v[160:163], a[16:19]
    ds_read_b64_tr_b16 a[180:181], v22 offset:57344
    v_cvt_pk_bf16_f32 v136, v212, v213
    v_mfma_f32_16x16x32_bf16 a[16:19], a[172:175], v[164:167], a[16:19]
    ds_read_b64_tr_b16 a[182:183], v22 offset:61440
    v_lshlrev_b32 v246, 16, v241
    v_mfma_f32_16x16x32_bf16 a[20:23], a[168:171], v[168:171], a[20:23]
    ds_read_b128 a[236:239], v11 offset:4096
    v_cvt_pk_bf16_f32 v137, v214, v215
    v_mfma_f32_16x16x32_bf16 a[20:23], a[172:175], v[172:175], a[20:23]
    v_and_b32 v247, 0xffff0000, v241
    v_fmac_f32 v226, v2, v246
    v_smfmac_f32_16x16x64_bf16 a[192:195], v[52:55], v[160:167], v50
    v_mfma_f32_16x16x32_bf16 v[212:215], a[208:211], v[112:115], v[204:207]
    v_exp_f32 v208, v208
    v_mfma_f32_16x16x32_bf16 v[212:215], a[212:215], v[116:119], v[212:215]
    s_add_u32 m0, s42, 81920
    v_exp_f32 v209, v209
    v_mfma_f32_16x16x32_bf16 v[212:215], a[216:219], v[120:123], v[212:215]
    v_exp_f32 v210, v210
    v_mfma_f32_16x16x32_bf16 v[212:215], a[220:223], v[124:127], v[212:215]
    v_exp_f32 v211, v211
    v_mfma_f32_16x16x32_bf16 a[24:27], a[168:171], v[176:179], a[24:27]
    ds_read_b64_tr_b16 a[184:185], v23 offset:49152
    v_cvt_pk_bf16_f32 v144, v208, v209
    v_mfma_f32_16x16x32_bf16 a[24:27], a[172:175], v[180:183], a[24:27]
    ds_read_b64_tr_b16 a[186:187], v23 offset:53248
    v_fmac_f32 v227, v2, v247
    v_mfma_f32_16x16x32_bf16 a[28:31], a[168:171], v[184:187], a[28:31]
    ds_read_b128 a[208:211], v8 offset:8192
    v_cvt_pk_bf16_f32 v145, v210, v211
    v_mfma_f32_16x16x32_bf16 a[28:31], a[172:175], v[188:191], a[28:31]
    s_waitcnt lgkmcnt(3)
    buffer_load_dwordx4 v40, s[12:15], s41 offen lds
    v_mfma_f32_16x16x32_bf16 v[208:211], a[224:227], v[64:67], v[192:195]
    v_exp_f32 v212, v212
    v_mfma_f32_16x16x32_bf16 v[208:211], a[228:231], v[68:71], v[208:211]
    v_exp_f32 v213, v213
    v_mfma_f32_16x16x32_bf16 v[208:211], a[232:235], v[72:75], v[208:211]
    v_exp_f32 v214, v214
    v_mfma_f32_16x16x32_bf16 v[208:211], a[236:239], v[76:79], v[208:211]
    v_exp_f32 v215, v215
    v_mfma_f32_16x16x32_bf16 a[32:35], a[176:179], v[160:163], a[32:35]
    ds_read_b64_tr_b16 a[188:189], v23 offset:57344
    v_cvt_pk_bf16_f32 v152, v212, v213
    v_mfma_f32_16x16x32_bf16 a[32:35], a[180:183], v[164:167], a[32:35]
    ds_read_b64_tr_b16 a[190:191], v23 offset:61440
    v_lshlrev_b32 v244, 16, v242
    v_mfma_f32_16x16x32_bf16 a[36:39], a[176:179], v[168:171], a[36:39]
    ds_read_b128 a[212:215], v9 offset:8192
    v_cvt_pk_bf16_f32 v153, v214, v215
    v_mfma_f32_16x16x32_bf16 a[36:39], a[180:183], v[172:175], a[36:39]
    v_and_b32 v245, 0xffff0000, v242
    v_fmac_f32 v228, v2, v244
    v_smfmac_f32_16x16x64_bf16 a[196:199], v[52:55], v[168:175], v50
    v_mfma_f32_16x16x32_bf16 v[212:215], a[224:227], v[80:83], v[196:199]
    v_exp_f32 v208, v208
    v_mfma_f32_16x16x32_bf16 v[212:215], a[228:231], v[84:87], v[212:215]
    v_exp_f32 v209, v209
    v_mfma_f32_16x16x32_bf16 v[212:215], a[232:235], v[88:91], v[212:215]
    v_exp_f32 v210, v210
    v_mfma_f32_16x16x32_bf16 v[212:215], a[236:239], v[92:95], v[212:215]
    v_exp_f32 v211, v211
    v_mfma_f32_16x16x32_bf16 a[40:43], a[176:179], v[176:179], a[40:43]
    ds_read_b64_tr_b16 a[160:161], v24 offset:49152
    v_cvt_pk_bf16_f32 v130, v208, v209
    v_mfma_f32_16x16x32_bf16 a[40:43], a[180:183], v[180:183], a[40:43]
    ds_read_b64_tr_b16 a[162:163], v24 offset:53248
    v_fmac_f32 v229, v2, v245
    v_mfma_f32_16x16x32_bf16 a[44:47], a[176:179], v[184:187], a[44:47]
    ds_read_b128 a[216:219], v10 offset:8192
    v_cvt_pk_bf16_f32 v131, v210, v211
    v_mfma_f32_16x16x32_bf16 a[44:47], a[180:183], v[188:191], a[44:47]
    s_waitcnt lgkmcnt(3)
    buffer_load_dwordx4 v41, s[12:15], s41 offen offset:1024 lds
    v_mfma_f32_16x16x32_bf16 v[208:211], a[224:227], v[96:99], v[200:203]
    v_exp_f32 v212, v212
    v_mfma_f32_16x16x32_bf16 v[208:211], a[228:231], v[100:103], v[208:211]
    v_exp_f32 v213, v213
    v_mfma_f32_16x16x32_bf16 v[208:211], a[232:235], v[104:107], v[208:211]
    v_exp_f32 v214, v214
    v_mfma_f32_16x16x32_bf16 v[208:211], a[236:239], v[108:111], v[208:211]
    v_exp_f32 v215, v215
    v_mfma_f32_16x16x32_bf16 a[48:51], a[184:187], v[160:163], a[48:51]
    ds_read_b64_tr_b16 a[164:165], v24 offset:57344
    v_cvt_pk_bf16_f32 v138, v212, v213
    v_mfma_f32_16x16x32_bf16 a[48:51], a[188:191], v[164:167], a[48:51]
    ds_read_b64_tr_b16 a[166:167], v24 offset:61440
    v_lshlrev_b32 v246, 16, v243
    v_mfma_f32_16x16x32_bf16 a[52:55], a[184:187], v[168:171], a[52:55]
    ds_read_b128 a[220:223], v11 offset:8192
    v_cvt_pk_bf16_f32 v139, v214, v215
    v_mfma_f32_16x16x32_bf16 a[52:55], a[188:191], v[172:175], a[52:55]
    v_and_b32 v247, 0xffff0000, v243
    v_fmac_f32 v230, v2, v246
    v_smfmac_f32_16x16x64_bf16 a[200:203], v[52:55], v[176:183], v50
    v_mfma_f32_16x16x32_bf16 v[212:215], a[224:227], v[112:115], v[204:207]
    v_exp_f32 v208, v208
    v_mfma_f32_16x16x32_bf16 v[212:215], a[228:231], v[116:119], v[212:215]
    v_exp_f32 v209, v209
    v_mfma_f32_16x16x32_bf16 v[212:215], a[232:235], v[120:123], v[212:215]
    v_exp_f32 v210, v210
    v_mfma_f32_16x16x32_bf16 v[212:215], a[236:239], v[124:127], v[212:215]
    v_exp_f32 v211, v211
    v_mfma_f32_16x16x32_bf16 a[56:59], a[184:187], v[176:179], a[56:59]
    ds_read_b64_tr_b16 a[168:169], v25 offset:49152
    v_cvt_pk_bf16_f32 v146, v208, v209
    v_mfma_f32_16x16x32_bf16 a[56:59], a[188:191], v[180:183], a[56:59]
    ds_read_b64_tr_b16 a[170:171], v25 offset:53248
    v_fmac_f32 v231, v2, v247
    v_mfma_f32_16x16x32_bf16 a[60:63], a[184:187], v[184:187], a[60:63]
    ds_read_b128 a[224:227], v8 offset:12288
    v_cvt_pk_bf16_f32 v147, v210, v211
    v_mfma_f32_16x16x32_bf16 a[60:63], a[188:191], v[188:191], a[60:63]
    s_waitcnt lgkmcnt(3)
    buffer_load_dwordx4 v40, s[12:15], s41 offen offset:2048 lds
    v_mfma_f32_16x16x32_bf16 v[208:211], a[208:211], v[64:67], v[192:195]
    v_exp_f32 v212, v212
    v_mfma_f32_16x16x32_bf16 v[208:211], a[212:215], v[68:71], v[208:211]
    v_exp_f32 v213, v213
    v_mfma_f32_16x16x32_bf16 v[208:211], a[216:219], v[72:75], v[208:211]
    v_exp_f32 v214, v214
    v_mfma_f32_16x16x32_bf16 v[208:211], a[220:223], v[76:79], v[208:211]
    v_exp_f32 v215, v215
    v_mfma_f32_16x16x32_bf16 a[64:67], a[160:163], v[160:163], a[64:67]
    ds_read_b64_tr_b16 a[172:173], v25 offset:57344
    v_cvt_pk_bf16_f32 v154, v212, v213
    v_mfma_f32_16x16x32_bf16 a[64:67], a[164:167], v[164:167], a[64:67]
    ds_read_b64_tr_b16 a[174:175], v25 offset:61440
    v_mov_b32 v2, v3
    v_mfma_f32_16x16x32_bf16 a[68:71], a[160:163], v[168:171], a[68:71]
    ds_read_b128 a[228:231], v9 offset:12288
    v_cvt_pk_bf16_f32 v155, v214, v215
    v_mfma_f32_16x16x32_bf16 a[68:71], a[164:167], v[172:175], a[68:71]
    v_mov_b32 v3, v4
    v_mov_b32 v4, v5
    v_smfmac_f32_16x16x64_bf16 a[204:207], v[52:55], v[184:191], v50
    v_mfma_f32_16x16x32_bf16 v[212:215], a[208:211], v[80:83], v[196:199]
    v_exp_f32 v208, v208
    v_mfma_f32_16x16x32_bf16 v[212:215], a[212:215], v[84:87], v[212:215]
    v_exp_f32 v209, v209
    v_mfma_f32_16x16x32_bf16 v[212:215], a[216:219], v[88:91], v[212:215]
    v_exp_f32 v210, v210
    v_mfma_f32_16x16x32_bf16 v[212:215], a[220:223], v[92:95], v[212:215]
    v_exp_f32 v211, v211
    v_mfma_f32_16x16x32_bf16 a[72:75], a[160:163], v[176:179], a[72:75]
    ds_read_b64_tr_b16 a[176:177], v26 offset:49152
    v_cvt_pk_bf16_f32 v132, v208, v209
    v_mfma_f32_16x16x32_bf16 a[72:75], a[164:167], v[180:183], a[72:75]
    ds_read_b64_tr_b16 a[178:179], v26 offset:53248
    v_mov_b32 v5, v6
    v_mfma_f32_16x16x32_bf16 a[76:79], a[160:163], v[184:187], a[76:79]
    ds_read_b128 a[232:235], v10 offset:12288
    v_cvt_pk_bf16_f32 v133, v210, v211
    v_mfma_f32_16x16x32_bf16 a[76:79], a[164:167], v[188:191], a[76:79]
    s_waitcnt lgkmcnt(3)
    buffer_load_dwordx4 v41, s[12:15], s41 offen offset:3072 lds
    v_mfma_f32_16x16x32_bf16 v[208:211], a[208:211], v[96:99], v[200:203]
    v_exp_f32 v212, v212
    v_mfma_f32_16x16x32_bf16 v[208:211], a[212:215], v[100:103], v[208:211]
    s_add_u32 s41, s41, 16384
    v_exp_f32 v213, v213
    v_mfma_f32_16x16x32_bf16 v[208:211], a[216:219], v[104:107], v[208:211]
    v_exp_f32 v214, v214
    v_mfma_f32_16x16x32_bf16 v[208:211], a[220:223], v[108:111], v[208:211]
    v_exp_f32 v215, v215
    v_mfma_f32_16x16x32_bf16 a[80:83], a[168:171], v[160:163], a[80:83]
    ds_read_b64_tr_b16 a[180:181], v26 offset:57344
    v_cvt_pk_bf16_f32 v140, v212, v213
    v_mfma_f32_16x16x32_bf16 a[80:83], a[172:175], v[164:167], a[80:83]
    ds_read_b64_tr_b16 a[182:183], v26 offset:61440
    v_mfma_f32_16x16x32_bf16 a[84:87], a[168:171], v[168:171], a[84:87]
    ds_read_b128 a[236:239], v11 offset:12288
    v_cvt_pk_bf16_f32 v141, v214, v215
    v_mfma_f32_16x16x32_bf16 a[84:87], a[172:175], v[172:175], a[84:87]
    s_waitcnt vmcnt(10)
    s_barrier
    v_mfma_f32_16x16x32_bf16 v[212:215], a[208:211], v[112:115], v[204:207]
    v_exp_f32 v208, v208
    v_mfma_f32_16x16x32_bf16 v[212:215], a[212:215], v[116:119], v[212:215]
    s_add_u32 m0, s42, 49152
    v_exp_f32 v209, v209
    v_mfma_f32_16x16x32_bf16 v[212:215], a[216:219], v[120:123], v[212:215]
    v_exp_f32 v210, v210
    v_mfma_f32_16x16x32_bf16 v[212:215], a[220:223], v[124:127], v[212:215]
    v_exp_f32 v211, v211
    v_mfma_f32_16x16x32_bf16 a[88:91], a[168:171], v[176:179], a[88:91]
    ds_read_b64_tr_b16 a[184:185], v27 offset:49152
    v_cvt_pk_bf16_f32 v148, v208, v209
    v_mfma_f32_16x16x32_bf16 a[88:91], a[172:175], v[180:183], a[88:91]
    ds_read_b64_tr_b16 a[186:187], v27 offset:53248
    v_mfma_f32_16x16x32_bf16 a[92:95], a[168:171], v[184:187], a[92:95]
    ds_read_b128 a[208:211], v8 offset:16384
    v_cvt_pk_bf16_f32 v149, v210, v211
    v_mfma_f32_16x16x32_bf16 a[92:95], a[172:175], v[188:191], a[92:95]
    s_waitcnt lgkmcnt(3)
    buffer_load_dwordx4 v36, s[8:11], s40 offen lds
    v_mfma_f32_16x16x32_bf16 v[208:211], a[224:227], v[64:67], v[192:195]
    v_exp_f32 v212, v212
    v_mfma_f32_16x16x32_bf16 v[208:211], a[228:231], v[68:71], v[208:211]
    v_exp_f32 v213, v213
    v_mfma_f32_16x16x32_bf16 v[208:211], a[232:235], v[72:75], v[208:211]
    v_exp_f32 v214, v214
    v_mfma_f32_16x16x32_bf16 v[208:211], a[236:239], v[76:79], v[208:211]
    v_exp_f32 v215, v215
    v_mfma_f32_16x16x32_bf16 a[96:99], a[176:179], v[160:163], a[96:99]
    ds_read_b64_tr_b16 a[188:189], v27 offset:57344
    v_cvt_pk_bf16_f32 v156, v212, v213
    v_mfma_f32_16x16x32_bf16 a[96:99], a[180:183], v[164:167], a[96:99]
    ds_read_b64_tr_b16 a[190:191], v27 offset:61440
    v_mfma_f32_16x16x32_bf16 a[100:103], a[176:179], v[168:171], a[100:103]
    ds_read_b128 a[212:215], v9 offset:16384
    v_cvt_pk_bf16_f32 v157, v214, v215
    v_mfma_f32_16x16x32_bf16 a[100:103], a[180:183], v[172:175], a[100:103]
    buffer_load_dword v216, v237, s[28:31], s52 offen
    v_mfma_f32_16x16x32_bf16 v[212:215], a[224:227], v[80:83], v[196:199]
    v_exp_f32 v208, v208
    v_mfma_f32_16x16x32_bf16 v[212:215], a[228:231], v[84:87], v[212:215]
    s_sub_u32 s39, s39, 36864
    v_exp_f32 v209, v209
    v_mfma_f32_16x16x32_bf16 v[212:215], a[232:235], v[88:91], v[212:215]
    s_sub_u32 s38, s38, 4608
    v_exp_f32 v210, v210
    v_mfma_f32_16x16x32_bf16 v[212:215], a[236:239], v[92:95], v[212:215]
    s_add_u32 s52, s52, 2304
    v_exp_f32 v211, v211
    v_mfma_f32_16x16x32_bf16 a[104:107], a[176:179], v[176:179], a[104:107]
    ds_read_b64_tr_b16 a[160:161], v20 offset:0
    v_cvt_pk_bf16_f32 v134, v208, v209
    v_mfma_f32_16x16x32_bf16 a[104:107], a[180:183], v[180:183], a[104:107]
    ds_read_b64_tr_b16 a[162:163], v20 offset:4096
    v_mfma_f32_16x16x32_bf16 a[108:111], a[176:179], v[184:187], a[108:111]
    ds_read_b128 a[216:219], v10 offset:16384
    v_cvt_pk_bf16_f32 v135, v210, v211
    v_mfma_f32_16x16x32_bf16 a[108:111], a[180:183], v[188:191], a[108:111]
    s_waitcnt lgkmcnt(3)
    buffer_load_dwordx4 v37, s[8:11], s40 offen offset:1024 lds
    v_mfma_f32_16x16x32_bf16 v[208:211], a[224:227], v[96:99], v[200:203]
    v_exp_f32 v212, v212
    v_mfma_f32_16x16x32_bf16 v[208:211], a[228:231], v[100:103], v[208:211]
    v_exp_f32 v213, v213
    v_mfma_f32_16x16x32_bf16 v[208:211], a[232:235], v[104:107], v[208:211]
    v_exp_f32 v214, v214
    v_mfma_f32_16x16x32_bf16 v[208:211], a[236:239], v[108:111], v[208:211]
    v_exp_f32 v215, v215
    v_mfma_f32_16x16x32_bf16 a[112:115], a[184:187], v[160:163], a[112:115]
    ds_read_b64_tr_b16 a[164:165], v20 offset:8192
    v_cvt_pk_bf16_f32 v142, v212, v213
    v_mfma_f32_16x16x32_bf16 a[112:115], a[188:191], v[164:167], a[112:115]
    ds_read_b64_tr_b16 a[166:167], v20 offset:12288
    v_mfma_f32_16x16x32_bf16 a[116:119], a[184:187], v[168:171], a[116:119]
    ds_read_b128 a[220:223], v11 offset:16384
    v_cvt_pk_bf16_f32 v143, v214, v215
    v_mfma_f32_16x16x32_bf16 a[116:119], a[188:191], v[172:175], a[116:119]
    v_mfma_f32_16x16x32_bf16 v[212:215], a[224:227], v[112:115], v[204:207]
    v_exp_f32 v208, v208
    v_mfma_f32_16x16x32_bf16 v[212:215], a[228:231], v[116:119], v[212:215]
    v_exp_f32 v209, v209
    v_mfma_f32_16x16x32_bf16 v[212:215], a[232:235], v[120:123], v[212:215]
    v_exp_f32 v210, v210
    v_mfma_f32_16x16x32_bf16 v[212:215], a[236:239], v[124:127], v[212:215]
    v_exp_f32 v211, v211
    v_mfma_f32_16x16x32_bf16 a[120:123], a[184:187], v[176:179], a[120:123]
    ds_read_b64_tr_b16 a[168:169], v21 offset:0
    v_cvt_pk_bf16_f32 v150, v208, v209
    v_mfma_f32_16x16x32_bf16 a[120:123], a[188:191], v[180:183], a[120:123]
    ds_read_b64_tr_b16 a[170:171], v21 offset:4096
    v_mfma_f32_16x16x32_bf16 a[124:127], a[184:187], v[184:187], a[124:127]
    ds_read_b128 a[224:227], v8 offset:20480
    v_cvt_pk_bf16_f32 v151, v210, v211
    v_mfma_f32_16x16x32_bf16 a[124:127], a[188:191], v[188:191], a[124:127]
    s_waitcnt lgkmcnt(3)
    buffer_load_dwordx4 v38, s[8:11], s40 offen offset:2048 lds
    s_sub_u32 s43, s43, 1
    s_cmp_lg_u32 s43, 0
    s_cbranch_scc1 Lattn_loop
    v_mfma_f32_16x16x32_bf16 v[208:211], a[208:211], v[64:67], v[192:195]
    s_lshl_b32 s38, s3, 6
    v_exp_f32 v212, v212
    v_mfma_f32_16x16x32_bf16 v[208:211], a[212:215], v[68:71], v[208:211]
    s_add_u32 s38, s38, 131136
    v_exp_f32 v213, v213
    v_mfma_f32_16x16x32_bf16 v[208:211], a[216:219], v[72:75], v[208:211]
    v_exp_f32 v214, v214
    v_mfma_f32_16x16x32_bf16 v[208:211], a[220:223], v[76:79], v[208:211]
    s_add_u32 s57, s58, 0
    v_exp_f32 v215, v215
    v_mfma_f32_16x16x32_bf16 a[0:3], a[160:163], v[128:131], a[0:3]
    ds_read_b64_tr_b16 a[172:173], v21 offset:8192
    v_cvt_pk_bf16_f32 v158, v212, v213
    v_mfma_f32_16x16x32_bf16 a[0:3], a[164:167], v[132:135], a[0:3]
    ds_read_b64_tr_b16 a[174:175], v21 offset:12288
    v_permlane32_swap_b32 v224, v228
    v_mfma_f32_16x16x32_bf16 a[4:7], a[160:163], v[136:139], a[4:7]
    ds_read_b128 a[228:231], v9 offset:20480
    v_cvt_pk_bf16_f32 v159, v214, v215
    v_mfma_f32_16x16x32_bf16 a[4:7], a[164:167], v[140:143], a[4:7]
    buffer_load_dwordx4 a[128:131], v254, s[80:83], s57 offen
    v_mfma_f32_16x16x32_bf16 v[212:215], a[208:211], v[80:83], v[196:199]
    v_exp_f32 v208, v208
    v_mfma_f32_16x16x32_bf16 v[212:215], a[212:215], v[84:87], v[212:215]
    v_exp_f32 v209, v209
    v_mfma_f32_16x16x32_bf16 v[212:215], a[216:219], v[88:91], v[212:215]
    v_exp_f32 v210, v210
    v_mfma_f32_16x16x32_bf16 v[212:215], a[220:223], v[92:95], v[212:215]
    v_exp_f32 v211, v211
    v_mfma_f32_16x16x32_bf16 a[8:11], a[160:163], v[144:147], a[8:11]
    ds_read_b64_tr_b16 a[176:177], v22 offset:0
    v_cvt_pk_bf16_f32 v160, v208, v209
    v_mfma_f32_16x16x32_bf16 a[8:11], a[164:167], v[148:151], a[8:11]
    ds_read_b64_tr_b16 a[178:179], v22 offset:4096
    v_permlane32_swap_b32 v225, v229
    v_mfma_f32_16x16x32_bf16 a[12:15], a[160:163], v[152:155], a[12:15]
    ds_read_b128 a[232:235], v10 offset:20480
    v_cvt_pk_bf16_f32 v161, v210, v211
    v_mfma_f32_16x16x32_bf16 a[12:15], a[164:167], v[156:159], a[12:15]
    s_waitcnt lgkmcnt(3)
    buffer_load_dwordx4 v39, s[8:11], s40 offen offset:3072 lds
    v_mfma_f32_16x16x32_bf16 v[208:211], a[208:211], v[96:99], v[200:203]
    v_exp_f32 v212, v212
    v_mfma_f32_16x16x32_bf16 v[208:211], a[212:215], v[100:103], v[208:211]
    s_add_u32 s40, s40, 16384
    v_exp_f32 v213, v213
    v_mfma_f32_16x16x32_bf16 v[208:211], a[216:219], v[104:107], v[208:211]
    v_exp_f32 v214, v214
    v_mfma_f32_16x16x32_bf16 v[208:211], a[220:223], v[108:111], v[208:211]
    v_exp_f32 v215, v215
    v_mfma_f32_16x16x32_bf16 a[16:19], a[168:171], v[128:131], a[16:19]
    ds_read_b64_tr_b16 a[180:181], v22 offset:8192
    v_cvt_pk_bf16_f32 v168, v212, v213
    v_mfma_f32_16x16x32_bf16 a[16:19], a[172:175], v[132:135], a[16:19]
    ds_read_b64_tr_b16 a[182:183], v22 offset:12288
    v_permlane32_swap_b32 v226, v230
    v_mfma_f32_16x16x32_bf16 a[20:23], a[168:171], v[136:139], a[20:23]
    ds_read_b128 a[236:239], v11 offset:20480
    v_cvt_pk_bf16_f32 v169, v214, v215
    v_mfma_f32_16x16x32_bf16 a[20:23], a[172:175], v[140:143], a[20:23]
    v_permlane32_swap_b32 v227, v231
    v_add_f32 v224, v224, v228
    v_smfmac_f32_16x16x64_bf16 a[192:195], v[52:55], v[128:135], v50
    v_mfma_f32_16x16x32_bf16 v[212:215], a[208:211], v[112:115], v[204:207]
    v_exp_f32 v208, v208
    v_mfma_f32_16x16x32_bf16 v[212:215], a[212:215], v[116:119], v[212:215]
    s_add_u32 m0, s42, 98304
    v_exp_f32 v209, v209
    v_mfma_f32_16x16x32_bf16 v[212:215], a[216:219], v[120:123], v[212:215]
    v_exp_f32 v210, v210
    v_mfma_f32_16x16x32_bf16 v[212:215], a[220:223], v[124:127], v[212:215]
    v_exp_f32 v211, v211
    v_mfma_f32_16x16x32_bf16 a[24:27], a[168:171], v[144:147], a[24:27]
    ds_read_b64_tr_b16 a[184:185], v23 offset:0
    v_cvt_pk_bf16_f32 v176, v208, v209
    v_mfma_f32_16x16x32_bf16 a[24:27], a[172:175], v[148:151], a[24:27]
    ds_read_b64_tr_b16 a[186:187], v23 offset:4096
    v_add_f32 v225, v225, v229
    v_mfma_f32_16x16x32_bf16 a[28:31], a[168:171], v[152:155], a[28:31]
    ds_read_b128 a[208:211], v8 offset:24576
    v_cvt_pk_bf16_f32 v177, v210, v211
    v_mfma_f32_16x16x32_bf16 a[28:31], a[172:175], v[156:159], a[28:31]
    s_waitcnt lgkmcnt(3)
    buffer_load_dwordx4 v40, s[12:15], s41 offen lds
    v_mfma_f32_16x16x32_bf16 v[208:211], a[224:227], v[64:67], v[192:195]
    v_exp_f32 v212, v212
    v_mfma_f32_16x16x32_bf16 v[208:211], a[228:231], v[68:71], v[208:211]
    v_exp_f32 v213, v213
    v_mfma_f32_16x16x32_bf16 v[208:211], a[232:235], v[72:75], v[208:211]
    v_exp_f32 v214, v214
    v_mfma_f32_16x16x32_bf16 v[208:211], a[236:239], v[76:79], v[208:211]
    s_add_u32 s57, s58, 589824
    v_exp_f32 v215, v215
    v_mfma_f32_16x16x32_bf16 a[32:35], a[176:179], v[128:131], a[32:35]
    ds_read_b64_tr_b16 a[188:189], v23 offset:8192
    v_cvt_pk_bf16_f32 v184, v212, v213
    v_mfma_f32_16x16x32_bf16 a[32:35], a[180:183], v[132:135], a[32:35]
    ds_read_b64_tr_b16 a[190:191], v23 offset:12288
    v_add_f32 v226, v226, v230
    v_mfma_f32_16x16x32_bf16 a[36:39], a[176:179], v[136:139], a[36:39]
    ds_read_b128 a[212:215], v9 offset:24576
    v_cvt_pk_bf16_f32 v185, v214, v215
    v_mfma_f32_16x16x32_bf16 a[36:39], a[180:183], v[140:143], a[36:39]
Ltour6:
    s_cbranch_execz Ltour10
    buffer_load_dwordx4 a[132:135], v254, s[80:83], s57 offen
    v_smfmac_f32_16x16x64_bf16 a[196:199], v[52:55], v[136:143], v50
    v_mfma_f32_16x16x32_bf16 v[212:215], a[224:227], v[80:83], v[196:199]
    v_exp_f32 v208, v208
    v_mfma_f32_16x16x32_bf16 v[212:215], a[228:231], v[84:87], v[212:215]
    v_exp_f32 v209, v209
    v_mfma_f32_16x16x32_bf16 v[212:215], a[232:235], v[88:91], v[212:215]
    v_exp_f32 v210, v210
    v_mfma_f32_16x16x32_bf16 v[212:215], a[236:239], v[92:95], v[212:215]
    v_exp_f32 v211, v211
    v_mfma_f32_16x16x32_bf16 a[40:43], a[176:179], v[144:147], a[40:43]
    ds_read_b64_tr_b16 a[160:161], v24 offset:0
    v_cvt_pk_bf16_f32 v162, v208, v209
    v_mfma_f32_16x16x32_bf16 a[40:43], a[180:183], v[148:151], a[40:43]
    ds_read_b64_tr_b16 a[162:163], v24 offset:4096
    v_add_f32 v227, v227, v231
    v_mfma_f32_16x16x32_bf16 a[44:47], a[176:179], v[152:155], a[44:47]
    ds_read_b128 a[216:219], v10 offset:24576
    v_cvt_pk_bf16_f32 v163, v210, v211
    v_mfma_f32_16x16x32_bf16 a[44:47], a[180:183], v[156:159], a[44:47]
    s_waitcnt lgkmcnt(3)
    buffer_load_dwordx4 v41, s[12:15], s41 offen offset:1024 lds
    v_mfma_f32_16x16x32_bf16 v[208:211], a[224:227], v[96:99], v[200:203]
    v_exp_f32 v212, v212
    v_mfma_f32_16x16x32_bf16 v[208:211], a[228:231], v[100:103], v[208:211]
    v_exp_f32 v213, v213
    v_mfma_f32_16x16x32_bf16 v[208:211], a[232:235], v[104:107], v[208:211]
    v_exp_f32 v214, v214
    v_mfma_f32_16x16x32_bf16 v[208:211], a[236:239], v[108:111], v[208:211]
    v_exp_f32 v215, v215
    v_mfma_f32_16x16x32_bf16 a[48:51], a[184:187], v[128:131], a[48:51]
    ds_read_b64_tr_b16 a[164:165], v24 offset:8192
    v_cvt_pk_bf16_f32 v170, v212, v213
    v_mfma_f32_16x16x32_bf16 a[48:51], a[188:191], v[132:135], a[48:51]
    ds_read_b64_tr_b16 a[166:167], v24 offset:12288
    v_and_b32 v244, 1, v1
    v_mfma_f32_16x16x32_bf16 a[52:55], a[184:187], v[136:139], a[52:55]
    ds_read_b128 a[220:223], v11 offset:24576
    v_cvt_pk_bf16_f32 v171, v214, v215
    v_mfma_f32_16x16x32_bf16 a[52:55], a[188:191], v[140:143], a[52:55]
    s_waitcnt vmcnt(15)
    buffer_load_dword v221, v236, s[20:23], 0 offen
    v_smfmac_f32_16x16x64_bf16 a[200:203], v[52:55], v[144:151], v50
    v_mfma_f32_16x16x32_bf16 v[212:215], a[224:227], v[112:115], v[204:207]
    v_exp_f32 v208, v208
    v_mfma_f32_16x16x32_bf16 v[212:215], a[228:231], v[116:119], v[212:215]
    v_exp_f32 v209, v209
    v_mfma_f32_16x16x32_bf16 v[212:215], a[232:235], v[120:123], v[212:215]
    v_exp_f32 v210, v210
    v_mfma_f32_16x16x32_bf16 v[212:215], a[236:239], v[124:127], v[212:215]
    v_exp_f32 v211, v211
    v_mfma_f32_16x16x32_bf16 a[56:59], a[184:187], v[144:147], a[56:59]
    ds_read_b64_tr_b16 a[168:169], v25 offset:0
    v_cvt_pk_bf16_f32 v178, v208, v209
    v_mfma_f32_16x16x32_bf16 a[56:59], a[188:191], v[148:151], a[56:59]
    ds_read_b64_tr_b16 a[170:171], v25 offset:4096
    v_permlane16_swap_b32 v224, v226
    v_mfma_f32_16x16x32_bf16 a[60:63], a[184:187], v[152:155], a[60:63]
    ds_read_b128 a[224:227], v8 offset:28672
    v_cvt_pk_bf16_f32 v179, v210, v211
    v_mfma_f32_16x16x32_bf16 a[60:63], a[188:191], v[156:159], a[60:63]
    s_waitcnt lgkmcnt(3)
    buffer_load_dwordx4 v40, s[12:15], s41 offen offset:2048 lds
    v_mfma_f32_16x16x32_bf16 v[208:211], a[208:211], v[64:67], v[192:195]
    v_exp_f32 v212, v212
    v_mfma_f32_16x16x32_bf16 v[208:211], a[212:215], v[68:71], v[208:211]
    v_exp_f32 v213, v213
    v_mfma_f32_16x16x32_bf16 v[208:211], a[216:219], v[72:75], v[208:211]
    v_exp_f32 v214, v214
    v_mfma_f32_16x16x32_bf16 v[208:211], a[220:223], v[76:79], v[208:211]
    s_add_u32 s57, s58, 1179648
    v_exp_f32 v215, v215
    v_mfma_f32_16x16x32_bf16 a[64:67], a[160:163], v[128:131], a[64:67]
    ds_read_b64_tr_b16 a[172:173], v25 offset:8192
    v_cvt_pk_bf16_f32 v186, v212, v213
    v_mfma_f32_16x16x32_bf16 a[64:67], a[164:167], v[132:135], a[64:67]
    ds_read_b64_tr_b16 a[174:175], v25 offset:12288
    v_permlane16_swap_b32 v225, v227
    v_mfma_f32_16x16x32_bf16 a[68:71], a[160:163], v[136:139], a[68:71]
    ds_read_b128 a[228:231], v9 offset:28672
    v_cvt_pk_bf16_f32 v187, v214, v215
    v_mfma_f32_16x16x32_bf16 a[68:71], a[164:167], v[140:143], a[68:71]
    buffer_load_dwordx4 a[136:139], v254, s[80:83], s57 offen
    v_smfmac_f32_16x16x64_bf16 a[204:207], v[52:55], v[152:159], v50
    v_mfma_f32_16x16x32_bf16 v[212:215], a[208:211], v[80:83], v[196:199]
    v_exp_f32 v208, v208
    v_mfma_f32_16x16x32_bf16 v[212:215], a[212:215], v[84:87], v[212:215]
    v_exp_f32 v209, v209
    v_mfma_f32_16x16x32_bf16 v[212:215], a[216:219], v[88:91], v[212:215]
    v_exp_f32 v210, v210
    v_mfma_f32_16x16x32_bf16 v[212:215], a[220:223], v[92:95], v[212:215]
    v_exp_f32 v211, v211
    v_mfma_f32_16x16x32_bf16 a[72:75], a[160:163], v[144:147], a[72:75]
    ds_read_b64_tr_b16 a[176:177], v26 offset:0
    v_cvt_pk_bf16_f32 v164, v208, v209
    v_mfma_f32_16x16x32_bf16 a[72:75], a[164:167], v[148:151], a[72:75]
    ds_read_b64_tr_b16 a[178:179], v26 offset:4096
    v_lshlrev_b32 v244, 5, v244
    v_mfma_f32_16x16x32_bf16 a[76:79], a[160:163], v[152:155], a[76:79]
    ds_read_b128 a[232:235], v10 offset:28672
    v_cvt_pk_bf16_f32 v165, v210, v211
    v_mfma_f32_16x16x32_bf16 a[76:79], a[164:167], v[156:159], a[76:79]
    s_waitcnt lgkmcnt(3)
    buffer_load_dwordx4 v41, s[12:15], s41 offen offset:3072 lds
    v_mfma_f32_16x16x32_bf16 v[208:211], a[208:211], v[96:99], v[200:203]
    v_exp_f32 v212, v212
    v_mfma_f32_16x16x32_bf16 v[208:211], a[212:215], v[100:103], v[208:211]
    s_add_u32 s41, s41, 16384
    v_exp_f32 v213, v213
    v_mfma_f32_16x16x32_bf16 v[208:211], a[216:219], v[104:107], v[208:211]
    v_exp_f32 v214, v214
    v_mfma_f32_16x16x32_bf16 v[208:211], a[220:223], v[108:111], v[208:211]
    v_exp_f32 v215, v215
    v_mfma_f32_16x16x32_bf16 a[80:83], a[168:171], v[128:131], a[80:83]
    ds_read_b64_tr_b16 a[180:181], v26 offset:8192
    v_cvt_pk_bf16_f32 v172, v212, v213
    v_mfma_f32_16x16x32_bf16 a[80:83], a[172:175], v[132:135], a[80:83]
    ds_read_b64_tr_b16 a[182:183], v26 offset:12288
    v_add_f32 v224, v224, v226
    v_mfma_f32_16x16x32_bf16 a[84:87], a[168:171], v[136:139], a[84:87]
    ds_read_b128 a[236:239], v11 offset:28672
    v_cvt_pk_bf16_f32 v173, v214, v215
    v_mfma_f32_16x16x32_bf16 a[84:87], a[172:175], v[140:143], a[84:87]
    s_waitcnt vmcnt(13)
    s_barrier
    v_mfma_f32_16x16x32_bf16 v[212:215], a[208:211], v[112:115], v[204:207]
    v_exp_f32 v208, v208
    v_mfma_f32_16x16x32_bf16 v[212:215], a[212:215], v[116:119], v[212:215]
    s_add_u32 s49, s45, 1024
    v_exp_f32 v209, v209
    v_mfma_f32_16x16x32_bf16 v[212:215], a[216:219], v[120:123], v[212:215]
    s_add_u32 m0, s42, 0
    v_exp_f32 v210, v210
    v_mfma_f32_16x16x32_bf16 v[212:215], a[220:223], v[124:127], v[212:215]
    v_exp_f32 v211, v211
    v_mfma_f32_16x16x32_bf16 a[88:91], a[168:171], v[144:147], a[88:91]
    ds_read_b64_tr_b16 a[184:185], v27 offset:0
    v_cvt_pk_bf16_f32 v180, v208, v209
    v_mfma_f32_16x16x32_bf16 a[88:91], a[172:175], v[148:151], a[88:91]
    ds_read_b64_tr_b16 a[186:187], v27 offset:4096
    v_add_f32 v225, v225, v227
    v_mfma_f32_16x16x32_bf16 a[92:95], a[168:171], v[152:155], a[92:95]
    ds_read_b128 a[208:211], v8 offset:32768
    v_cvt_pk_bf16_f32 v181, v210, v211
    v_mfma_f32_16x16x32_bf16 a[92:95], a[172:175], v[156:159], a[92:95]
    s_waitcnt lgkmcnt(3)
    buffer_load_dwordx4 v46, s[20:23], s49 offen lds
    v_mfma_f32_16x16x32_bf16 v[208:211], a[224:227], v[64:67], v[192:195]
    v_exp_f32 v212, v212
    v_mfma_f32_16x16x32_bf16 v[208:211], a[228:231], v[68:71], v[208:211]
    v_exp_f32 v213, v213
    v_mfma_f32_16x16x32_bf16 v[208:211], a[232:235], v[72:75], v[208:211]
    v_exp_f32 v214, v214
    v_mfma_f32_16x16x32_bf16 v[208:211], a[236:239], v[76:79], v[208:211]
    s_add_u32 s37, s55, 0
    v_exp_f32 v215, v215
    v_mfma_f32_16x16x32_bf16 a[96:99], a[176:179], v[128:131], a[96:99]
    ds_read_b64_tr_b16 a[188:189], v27 offset:8192
    v_cvt_pk_bf16_f32 v188, v212, v213
    v_mfma_f32_16x16x32_bf16 a[96:99], a[180:183], v[132:135], a[96:99]
    ds_read_b64_tr_b16 a[190:191], v27 offset:12288
    v_lshrrev_b32 v245, 4, v1
    v_mfma_f32_16x16x32_bf16 a[100:103], a[176:179], v[136:139], a[100:103]
    ds_read_b128 a[212:215], v9 offset:32768
    v_cvt_pk_bf16_f32 v189, v214, v215
    v_mfma_f32_16x16x32_bf16 a[100:103], a[180:183], v[140:143], a[100:103]
    buffer_load_dword v239, v238, s[28:31], s37 offen
    v_mfma_f32_16x16x32_bf16 v[212:215], a[224:227], v[80:83], v[196:199]
    v_exp_f32 v208, v208
    v_mfma_f32_16x16x32_bf16 v[212:215], a[228:231], v[84:87], v[212:215]
    v_exp_f32 v209, v209
    v_mfma_f32_16x16x32_bf16 v[212:215], a[232:235], v[88:91], v[212:215]
    v_exp_f32 v210, v210
    v_mfma_f32_16x16x32_bf16 v[212:215], a[236:239], v[92:95], v[212:215]
    v_exp_f32 v211, v211
    v_mfma_f32_16x16x32_bf16 a[104:107], a[176:179], v[144:147], a[104:107]
    ds_read_b64_tr_b16 a[160:161], v20 offset:16384
    v_cvt_pk_bf16_f32 v166, v208, v209
    v_mfma_f32_16x16x32_bf16 a[104:107], a[180:183], v[148:151], a[104:107]
    ds_read_b64_tr_b16 a[162:163], v20 offset:20480
    v_lshl_add_u32 v244, v245, 3, v244
    v_mfma_f32_16x16x32_bf16 a[108:111], a[176:179], v[152:155], a[108:111]
    ds_read_b128 a[216:219], v10 offset:32768
    v_cvt_pk_bf16_f32 v167, v210, v211
    v_mfma_f32_16x16x32_bf16 a[108:111], a[180:183], v[156:159], a[108:111]
    s_waitcnt lgkmcnt(3)
    buffer_load_dwordx4 v47, s[20:23], s49 offen offset:1024 lds
    v_mfma_f32_16x16x32_bf16 v[208:211], a[224:227], v[96:99], v[200:203]
    v_exp_f32 v212, v212
    v_mfma_f32_16x16x32_bf16 v[208:211], a[228:231], v[100:103], v[208:211]
    v_exp_f32 v213, v213
    v_mfma_f32_16x16x32_bf16 v[208:211], a[232:235], v[104:107], v[208:211]
    v_exp_f32 v214, v214
    v_mfma_f32_16x16x32_bf16 v[208:211], a[236:239], v[108:111], v[208:211]
    s_add_u32 s57, s58, 1769472
    v_exp_f32 v215, v215
    v_mfma_f32_16x16x32_bf16 a[112:115], a[184:187], v[128:131], a[112:115]
    ds_read_b64_tr_b16 a[164:165], v20 offset:24576
    v_cvt_pk_bf16_f32 v174, v212, v213
    v_mfma_f32_16x16x32_bf16 a[112:115], a[188:191], v[132:135], a[112:115]
    ds_read_b64_tr_b16 a[166:167], v20 offset:28672
    v_mfma_f32_16x16x32_bf16 a[116:119], a[184:187], v[136:139], a[116:119]
    ds_read_b128 a[220:223], v11 offset:32768
    v_cvt_pk_bf16_f32 v175, v214, v215
    v_mfma_f32_16x16x32_bf16 a[116:119], a[188:191], v[140:143], a[116:119]
    buffer_load_dwordx4 a[140:143], v254, s[80:83], s57 offen
    v_mfma_f32_16x16x32_bf16 v[212:215], a[224:227], v[112:115], v[204:207]
    v_exp_f32 v208, v208
    v_mfma_f32_16x16x32_bf16 v[212:215], a[228:231], v[116:119], v[212:215]
    v_exp_f32 v209, v209
    v_mfma_f32_16x16x32_bf16 v[212:215], a[232:235], v[120:123], v[212:215]
    v_exp_f32 v210, v210
    v_mfma_f32_16x16x32_bf16 v[212:215], a[236:239], v[124:127], v[212:215]
    v_exp_f32 v211, v211
    v_mfma_f32_16x16x32_bf16 a[120:123], a[184:187], v[144:147], a[120:123]
    ds_read_b64_tr_b16 a[168:169], v21 offset:16384
    v_cvt_pk_bf16_f32 v182, v208, v209
    v_mfma_f32_16x16x32_bf16 a[120:123], a[188:191], v[148:151], a[120:123]
    ds_read_b64_tr_b16 a[170:171], v21 offset:20480
    v_mfma_f32_16x16x32_bf16 a[124:127], a[184:187], v[152:155], a[124:127]
    ds_read_b128 a[224:227], v8 offset:36864
    v_cvt_pk_bf16_f32 v183, v210, v211
    v_mfma_f32_16x16x32_bf16 a[124:127], a[188:191], v[156:159], a[124:127]
    s_waitcnt lgkmcnt(3)
    buffer_load_dwordx4 v48, s[20:23], s49 offen offset:2048 lds
    v_mfma_f32_16x16x32_bf16 v[208:211], a[208:211], v[64:67], v[192:195]
    v_exp_f32 v212, v212
    v_mfma_f32_16x16x32_bf16 v[208:211], a[212:215], v[68:71], v[208:211]
    v_exp_f32 v213, v213
    v_mfma_f32_16x16x32_bf16 v[208:211], a[216:219], v[72:75], v[208:211]
    v_exp_f32 v214, v214
    v_mfma_f32_16x16x32_bf16 v[208:211], a[220:223], v[76:79], v[208:211]
    s_add_u32 s57, s58, 2359296
    v_exp_f32 v215, v215
    v_mfma_f32_16x16x32_bf16 a[0:3], a[160:163], v[160:163], a[0:3]
    ds_read_b64_tr_b16 a[172:173], v21 offset:24576
    v_cvt_pk_bf16_f32 v190, v212, v213
    v_mfma_f32_16x16x32_bf16 a[0:3], a[164:167], v[164:167], a[0:3]
    ds_read_b64_tr_b16 a[174:175], v21 offset:28672
    v_mov_b32 v63, 0
    v_mfma_f32_16x16x32_bf16 a[4:7], a[160:163], v[168:171], a[4:7]
    ds_read_b128 a[228:231], v9 offset:36864
    v_cvt_pk_bf16_f32 v191, v214, v215
    v_mfma_f32_16x16x32_bf16 a[4:7], a[164:167], v[172:175], a[4:7]
    buffer_load_dwordx4 a[144:147], v254, s[80:83], s57 offen
    v_mfma_f32_16x16x32_bf16 v[212:215], a[208:211], v[80:83], v[196:199]
    v_exp_f32 v208, v208
    v_mfma_f32_16x16x32_bf16 v[212:215], a[212:215], v[84:87], v[212:215]
    v_exp_f32 v209, v209
    v_mfma_f32_16x16x32_bf16 v[212:215], a[216:219], v[88:91], v[212:215]
    v_exp_f32 v210, v210
    v_mfma_f32_16x16x32_bf16 v[212:215], a[220:223], v[92:95], v[212:215]
    v_exp_f32 v211, v211
    v_mfma_f32_16x16x32_bf16 a[8:11], a[160:163], v[176:179], a[8:11]
    ds_read_b64_tr_b16 a[176:177], v22 offset:16384
    v_cvt_pk_bf16_f32 v128, v208, v209
    v_mfma_f32_16x16x32_bf16 a[8:11], a[164:167], v[180:183], a[8:11]
    ds_read_b64_tr_b16 a[178:179], v22 offset:20480
    v_add_f32_dpp v224, v224, v224 row_ror:2 row_mask:0xf bank_mask:0xf
    v_mfma_f32_16x16x32_bf16 a[12:15], a[160:163], v[184:187], a[12:15]
    ds_read_b128 a[232:235], v10 offset:36864
    v_cvt_pk_bf16_f32 v129, v210, v211
    v_mfma_f32_16x16x32_bf16 a[12:15], a[164:167], v[188:191], a[12:15]
    s_waitcnt lgkmcnt(3)
    buffer_load_dwordx4 v49, s[20:23], s49 offen offset:3072 lds
    v_mfma_f32_16x16x32_bf16 v[208:211], a[208:211], v[96:99], v[200:203]
    s_lshr_b32 s39, s2, 5
    v_exp_f32 v212, v212
    v_mfma_f32_16x16x32_bf16 v[208:211], a[212:215], v[100:103], v[208:211]
    s_lshl_b32 s39, s39, 3
    v_exp_f32 v213, v213
    v_mfma_f32_16x16x32_bf16 v[208:211], a[216:219], v[104:107], v[208:211]
    s_and_b32 s43, s2, 7
    v_exp_f32 v214, v214
    v_mfma_f32_16x16x32_bf16 v[208:211], a[220:223], v[108:111], v[208:211]
    s_add_u32 s39, s39, s43
    v_exp_f32 v215, v215
    v_mfma_f32_16x16x32_bf16 a[16:19], a[168:171], v[160:163], a[16:19]
    ds_read_b64_tr_b16 a[180:181], v22 offset:24576
    v_cvt_pk_bf16_f32 v136, v212, v213
    v_mfma_f32_16x16x32_bf16 a[16:19], a[172:175], v[164:167], a[16:19]
    ds_read_b64_tr_b16 a[182:183], v22 offset:28672
    v_add_f32_dpp v225, v225, v225 row_ror:2 row_mask:0xf bank_mask:0xf
    v_mfma_f32_16x16x32_bf16 a[20:23], a[168:171], v[168:171], a[20:23]
    ds_read_b128 a[236:239], v11 offset:36864
    v_cvt_pk_bf16_f32 v137, v214, v215
    v_mfma_f32_16x16x32_bf16 a[20:23], a[172:175], v[172:175], a[20:23]
    buffer_load_dword v253, v63, s[24:27], s54 offen offset:12 sc1
    v_smfmac_f32_16x16x64_bf16 a[192:195], v[52:55], v[160:167], v50
    v_mfma_f32_16x16x32_bf16 v[212:215], a[208:211], v[112:115], v[204:207]
    s_lshl_b32 s39, s39, 2
    v_exp_f32 v208, v208
    v_mfma_f32_16x16x32_bf16 v[212:215], a[212:215], v[116:119], v[212:215]
    s_add_u32 m0, s42, 114688
    v_exp_f32 v209, v209
    v_mfma_f32_16x16x32_bf16 v[212:215], a[216:219], v[120:123], v[212:215]
    s_bfe_u32 s43, s2, 0x20003
    v_exp_f32 v210, v210
    v_mfma_f32_16x16x32_bf16 v[212:215], a[220:223], v[124:127], v[212:215]
    s_add_u32 s39, s39, s43
    v_exp_f32 v211, v211
    v_mfma_f32_16x16x32_bf16 a[24:27], a[168:171], v[176:179], a[24:27]
    ds_read_b64_tr_b16 a[184:185], v23 offset:16384
    v_cvt_pk_bf16_f32 v144, v208, v209
    v_mfma_f32_16x16x32_bf16 a[24:27], a[172:175], v[180:183], a[24:27]
    ds_read_b64_tr_b16 a[186:187], v23 offset:20480
    v_add_f32_dpp v224, v224, v224 row_ror:4 row_mask:0xf bank_mask:0xf
    v_mfma_f32_16x16x32_bf16 a[28:31], a[168:171], v[184:187], a[28:31]
    ds_read_b128 a[208:211], v8 offset:40960
    v_cvt_pk_bf16_f32 v145, v210, v211
    v_mfma_f32_16x16x32_bf16 a[28:31], a[172:175], v[188:191], a[28:31]
    s_waitcnt lgkmcnt(3)
    buffer_load_dwordx4 v40, s[12:15], s41 offen lds
    v_mfma_f32_16x16x32_bf16 v[208:211], a[224:227], v[64:67], v[192:195]
    s_add_u32 s39, s39, 72
    v_exp_f32 v212, v212
    v_mfma_f32_16x16x32_bf16 v[208:211], a[228:231], v[68:71], v[208:211]
    s_cmp_lt_u32 s39, 216
    s_cselect_b32 s43, 0, 2147483648
    v_exp_f32 v213, v213
    v_mfma_f32_16x16x32_bf16 v[208:211], a[232:235], v[72:75], v[208:211]
    s_or_b32 s43, s43, s48
    v_exp_f32 v214, v214
    v_mfma_f32_16x16x32_bf16 v[208:211], a[236:239], v[76:79], v[208:211]
    s_add_u32 s57, s58, 2949120
    v_exp_f32 v215, v215
    v_mfma_f32_16x16x32_bf16 a[32:35], a[176:179], v[160:163], a[32:35]
    ds_read_b64_tr_b16 a[188:189], v23 offset:24576
    v_cvt_pk_bf16_f32 v152, v212, v213
    v_mfma_f32_16x16x32_bf16 a[32:35], a[180:183], v[164:167], a[32:35]
    ds_read_b64_tr_b16 a[190:191], v23 offset:28672
    v_add_f32_dpp v225, v225, v225 row_ror:4 row_mask:0xf bank_mask:0xf
    v_mfma_f32_16x16x32_bf16 a[36:39], a[176:179], v[168:171], a[36:39]
    ds_read_b128 a[212:215], v9 offset:40960
    v_cvt_pk_bf16_f32 v153, v214, v215
    v_mfma_f32_16x16x32_bf16 a[36:39], a[180:183], v[172:175], a[36:39]
    buffer_load_dwordx4 a[148:151], v254, s[80:83], s57 offen
    v_smfmac_f32_16x16x64_bf16 a[196:199], v[52:55], v[168:175], v50
    v_mfma_f32_16x16x32_bf16 v[212:215], a[224:227], v[80:83], v[196:199]
    s_and_b32 s43, s43, 2147483648
    v_exp_f32 v208, v208
    v_mfma_f32_16x16x32_bf16 v[212:215], a[228:231], v[84:87], v[212:215]
    s_sub_u32 s36, s39, 144
    v_exp_f32 v209, v209
    v_mfma_f32_16x16x32_bf16 v[212:215], a[232:235], v[88:91], v[212:215]
    s_cmp_lt_u32 s36, 36
    s_cselect_b32 s36, 1.0, 0
    v_exp_f32 v210, v210
    v_mfma_f32_16x16x32_bf16 v[212:215], a[236:239], v[92:95], v[212:215]
    s_lshr_b32 s44, s39, 1
    v_exp_f32 v211, v211
    v_mfma_f32_16x16x32_bf16 a[40:43], a[176:179], v[176:179], a[40:43]
    ds_read_b64_tr_b16 a[160:161], v24 offset:16384
    v_cvt_pk_bf16_f32 v130, v208, v209
    v_mfma_f32_16x16x32_bf16 a[40:43], a[180:183], v[180:183], a[40:43]
    ds_read_b64_tr_b16 a[162:163], v24 offset:20480
    v_add_f32_dpp v224, v224, v224 row_ror:8 row_mask:0xf bank_mask:0xf
    v_mfma_f32_16x16x32_bf16 a[44:47], a[176:179], v[184:187], a[44:47]
    ds_read_b128 a[216:219], v10 offset:40960
    v_cvt_pk_bf16_f32 v131, v210, v211
    v_mfma_f32_16x16x32_bf16 a[44:47], a[180:183], v[188:191], a[44:47]
    s_waitcnt lgkmcnt(3)
    buffer_load_dwordx4 v41, s[12:15], s41 offen offset:1024 lds
    v_mfma_f32_16x16x32_bf16 v[208:211], a[224:227], v[96:99], v[200:203]
    s_lshl_b32 s44, s44, 6
    v_exp_f32 v212, v212
    v_mfma_f32_16x16x32_bf16 v[208:211], a[228:231], v[100:103], v[208:211]
    s_and_b32 s39, s39, 1
    v_exp_f32 v213, v213
    v_mfma_f32_16x16x32_bf16 v[208:211], a[232:235], v[104:107], v[208:211]
    s_lshl_b32 s39, s39, 3
    v_exp_f32 v214, v214
    v_mfma_f32_16x16x32_bf16 v[208:211], a[236:239], v[108:111], v[208:211]
    s_add_u32 s39, s39, s44
    v_exp_f32 v215, v215
    v_mfma_f32_16x16x32_bf16 a[48:51], a[184:187], v[160:163], a[48:51]
    ds_read_b64_tr_b16 a[164:165], v24 offset:24576
    v_cvt_pk_bf16_f32 v138, v212, v213
    v_mfma_f32_16x16x32_bf16 a[48:51], a[188:191], v[164:167], a[48:51]
    ds_read_b64_tr_b16 a[166:167], v24 offset:28672
    v_add_f32_dpp v225, v225, v225 row_ror:8 row_mask:0xf bank_mask:0xf
    v_mfma_f32_16x16x32_bf16 a[52:55], a[184:187], v[168:171], a[52:55]
    ds_read_b128 a[220:223], v11 offset:40960
    v_cvt_pk_bf16_f32 v139, v214, v215
    v_mfma_f32_16x16x32_bf16 a[52:55], a[188:191], v[172:175], a[52:55]
    v_add_u32 v244, s38, v244
    v_and_b32 v245, 7, v1
    v_smfmac_f32_16x16x64_bf16 a[200:203], v[52:55], v[176:183], v50
    v_mfma_f32_16x16x32_bf16 v[212:215], a[224:227], v[112:115], v[204:207]
    s_add_u32 s39, s39, 16384
    v_exp_f32 v208, v208
    v_mfma_f32_16x16x32_bf16 v[212:215], a[228:231], v[116:119], v[212:215]
    s_or_b32 s39, s39, s43
    v_exp_f32 v209, v209
    v_mfma_f32_16x16x32_bf16 v[212:215], a[232:235], v[120:123], v[212:215]
    v_exp_f32 v210, v210
    v_mfma_f32_16x16x32_bf16 v[212:215], a[236:239], v[124:127], v[212:215]
    v_exp_f32 v211, v211
    v_mfma_f32_16x16x32_bf16 a[56:59], a[184:187], v[176:179], a[56:59]
    ds_read_b64_tr_b16 a[168:169], v25 offset:16384
    v_cvt_pk_bf16_f32 v146, v208, v209
    v_mfma_f32_16x16x32_bf16 a[56:59], a[188:191], v[180:183], a[56:59]
    ds_read_b64_tr_b16 a[170:171], v25 offset:20480
    v_mfma_f32_16x16x32_bf16 a[60:63], a[184:187], v[184:187], a[60:63]
    ds_read_b128 a[224:227], v8 offset:45056
    v_cvt_pk_bf16_f32 v147, v210, v211
    v_mfma_f32_16x16x32_bf16 a[60:63], a[188:191], v[188:191], a[60:63]
    s_waitcnt lgkmcnt(3)
    buffer_load_dwordx4 v40, s[12:15], s41 offen offset:2048 lds
    v_mfma_f32_16x16x32_bf16 v[208:211], a[208:211], v[64:67], v[192:195]
    v_exp_f32 v212, v212
    v_mfma_f32_16x16x32_bf16 v[208:211], a[212:215], v[68:71], v[208:211]
    v_exp_f32 v213, v213
    v_mfma_f32_16x16x32_bf16 v[208:211], a[216:219], v[72:75], v[208:211]
    v_exp_f32 v214, v214
    v_mfma_f32_16x16x32_bf16 v[208:211], a[220:223], v[76:79], v[208:211]
    s_add_u32 s57, s58, 3538944
    v_exp_f32 v215, v215
    v_mfma_f32_16x16x32_bf16 a[64:67], a[160:163], v[160:163], a[64:67]
    ds_read_b64_tr_b16 a[172:173], v25 offset:24576
    v_cvt_pk_bf16_f32 v154, v212, v213
    v_mfma_f32_16x16x32_bf16 a[64:67], a[164:167], v[164:167], a[64:67]
    ds_read_b64_tr_b16 a[174:175], v25 offset:28672
    v_lshlrev_b32 v245, 3, v245
    v_mfma_f32_16x16x32_bf16 a[68:71], a[160:163], v[168:171], a[68:71]
    ds_read_b128 a[228:231], v9 offset:45056
    v_cvt_pk_bf16_f32 v155, v214, v215
    v_mfma_f32_16x16x32_bf16 a[68:71], a[164:167], v[172:175], a[68:71]
    buffer_load_dwordx4 a[152:155], v254, s[80:83], s57 offen
    v_smfmac_f32_16x16x64_bf16 a[204:207], v[52:55], v[184:191], v50
    ds_write_b64 v244, v[224:225]
    v_mfma_f32_16x16x32_bf16 v[212:215], a[208:211], v[80:83], v[196:199]
    v_exp_f32 v208, v208
    v_mfma_f32_16x16x32_bf16 v[212:215], a[212:215], v[84:87], v[212:215]
    v_exp_f32 v209, v209
    v_mfma_f32_16x16x32_bf16 v[212:215], a[216:219], v[88:91], v[212:215]
    v_exp_f32 v210, v210
    v_mfma_f32_16x16x32_bf16 v[212:215], a[220:223], v[92:95], v[212:215]
    v_exp_f32 v211, v211
    v_mfma_f32_16x16x32_bf16 a[72:75], a[160:163], v[176:179], a[72:75]
    ds_read_b64_tr_b16 a[176:177], v26 offset:16384
    v_cvt_pk_bf16_f32 v132, v208, v209
    v_mfma_f32_16x16x32_bf16 a[72:75], a[164:167], v[180:183], a[72:75]
    ds_read_b64_tr_b16 a[178:179], v26 offset:20480
    v_add_u32 v245, 131136, v245
    v_mfma_f32_16x16x32_bf16 a[76:79], a[160:163], v[184:187], a[76:79]
    ds_read_b128 a[232:235], v10 offset:45056
    v_cvt_pk_bf16_f32 v133, v210, v211
    v_mfma_f32_16x16x32_bf16 a[76:79], a[164:167], v[188:191], a[76:79]
    s_waitcnt lgkmcnt(3)
    buffer_load_dwordx4 v41, s[12:15], s41 offen offset:3072 lds
    v_mfma_f32_16x16x32_bf16 v[208:211], a[208:211], v[96:99], v[200:203]
    v_exp_f32 v212, v212
    v_mfma_f32_16x16x32_bf16 v[208:211], a[212:215], v[100:103], v[208:211]
    s_add_u32 s41, s41, 16384
    v_exp_f32 v213, v213
    v_mfma_f32_16x16x32_bf16 v[208:211], a[216:219], v[104:107], v[208:211]
    v_exp_f32 v214, v214
    v_mfma_f32_16x16x32_bf16 v[208:211], a[220:223], v[108:111], v[208:211]
    v_exp_f32 v215, v215
    v_mfma_f32_16x16x32_bf16 a[80:83], a[168:171], v[160:163], a[80:83]
    ds_read_b64_tr_b16 a[180:181], v26 offset:24576
    v_cvt_pk_bf16_f32 v140, v212, v213
    v_mfma_f32_16x16x32_bf16 a[80:83], a[172:175], v[164:167], a[80:83]
    ds_read_b64_tr_b16 a[182:183], v26 offset:28672
    v_mfma_f32_16x16x32_bf16 a[84:87], a[168:171], v[168:171], a[84:87]
    ds_read_b128 a[236:239], v11 offset:45056
    v_cvt_pk_bf16_f32 v141, v214, v215
    v_mfma_f32_16x16x32_bf16 a[84:87], a[172:175], v[172:175], a[84:87]
    s_waitcnt vmcnt(14)
    s_barrier
    v_mfma_f32_16x16x32_bf16 v[212:215], a[208:211], v[112:115], v[204:207]
    v_exp_f32 v208, v208
    v_mfma_f32_16x16x32_bf16 v[212:215], a[212:215], v[116:119], v[212:215]
    s_add_u32 s49, s45, 74752
    v_exp_f32 v209, v209
    v_mfma_f32_16x16x32_bf16 v[212:215], a[216:219], v[120:123], v[212:215]
    s_add_u32 m0, s42, 16384
    v_exp_f32 v210, v210
    v_mfma_f32_16x16x32_bf16 v[212:215], a[220:223], v[124:127], v[212:215]
    v_exp_f32 v211, v211
    v_mfma_f32_16x16x32_bf16 a[88:91], a[168:171], v[176:179], a[88:91]
    ds_read_b64_tr_b16 a[184:185], v27 offset:16384
    v_cvt_pk_bf16_f32 v148, v208, v209
    v_mfma_f32_16x16x32_bf16 a[88:91], a[172:175], v[180:183], a[88:91]
    ds_read_b64_tr_b16 a[186:187], v27 offset:20480
    ds_read_b64 v[224:225], v245 offset:0
    v_mfma_f32_16x16x32_bf16 a[92:95], a[168:171], v[184:187], a[92:95]
    ds_read_b128 a[208:211], v8 offset:49152
    v_cvt_pk_bf16_f32 v149, v210, v211
    v_mfma_f32_16x16x32_bf16 a[92:95], a[172:175], v[188:191], a[92:95]
    s_waitcnt lgkmcnt(3)
    buffer_load_dwordx4 v46, s[20:23], s49 offen lds
    v_mfma_f32_16x16x32_bf16 v[208:211], a[224:227], v[64:67], v[192:195]
    v_exp_f32 v212, v212
    v_mfma_f32_16x16x32_bf16 v[208:211], a[228:231], v[68:71], v[208:211]
    v_exp_f32 v213, v213
    v_mfma_f32_16x16x32_bf16 v[208:211], a[232:235], v[72:75], v[208:211]
    v_exp_f32 v214, v214
    v_mfma_f32_16x16x32_bf16 v[208:211], a[236:239], v[76:79], v[208:211]
    s_add_u32 s37, s55, 8192
    v_exp_f32 v215, v215
    v_mfma_f32_16x16x32_bf16 a[96:99], a[176:179], v[160:163], a[96:99]
    ds_read_b64_tr_b16 a[188:189], v27 offset:24576
    v_cvt_pk_bf16_f32 v156, v212, v213
    v_mfma_f32_16x16x32_bf16 a[96:99], a[180:183], v[164:167], a[96:99]
    ds_read_b64_tr_b16 a[190:191], v27 offset:28672
    ds_read_b64 v[226:227], v245 offset:64
    v_mfma_f32_16x16x32_bf16 a[100:103], a[176:179], v[168:171], a[100:103]
    ds_read_b128 a[212:215], v9 offset:49152
    v_cvt_pk_bf16_f32 v157, v214, v215
    v_mfma_f32_16x16x32_bf16 a[100:103], a[180:183], v[172:175], a[100:103]
    buffer_load_dword v234, v238, s[28:31], s37 offen
    v_mfma_f32_16x16x32_bf16 v[212:215], a[224:227], v[80:83], v[196:199]
    v_exp_f32 v208, v208
    v_mfma_f32_16x16x32_bf16 v[212:215], a[228:231], v[84:87], v[212:215]
    v_exp_f32 v209, v209
    v_mfma_f32_16x16x32_bf16 v[212:215], a[232:235], v[88:91], v[212:215]
    v_exp_f32 v210, v210
    v_mfma_f32_16x16x32_bf16 v[212:215], a[236:239], v[92:95], v[212:215]
    v_exp_f32 v211, v211
    v_mfma_f32_16x16x32_bf16 a[104:107], a[176:179], v[176:179], a[104:107]
    ds_read_b64_tr_b16 a[160:161], v20 offset:32768
    v_cvt_pk_bf16_f32 v134, v208, v209
    v_mfma_f32_16x16x32_bf16 a[104:107], a[180:183], v[180:183], a[104:107]
    ds_read_b64_tr_b16 a[162:163], v20 offset:36864
    ds_read_b64 v[228:229], v245 offset:128
    v_mfma_f32_16x16x32_bf16 a[108:111], a[176:179], v[184:187], a[108:111]
    ds_read_b128 a[216:219], v10 offset:49152
    v_cvt_pk_bf16_f32 v135, v210, v211
    v_mfma_f32_16x16x32_bf16 a[108:111], a[180:183], v[188:191], a[108:111]
    s_waitcnt lgkmcnt(3)
    buffer_load_dwordx4 v47, s[20:23], s49 offen offset:1024 lds
    v_mfma_f32_16x16x32_bf16 v[208:211], a[224:227], v[96:99], v[200:203]
    v_exp_f32 v212, v212
    v_mfma_f32_16x16x32_bf16 v[208:211], a[228:231], v[100:103], v[208:211]
    v_exp_f32 v213, v213
    v_mfma_f32_16x16x32_bf16 v[208:211], a[232:235], v[104:107], v[208:211]
    v_exp_f32 v214, v214
    v_mfma_f32_16x16x32_bf16 v[208:211], a[236:239], v[108:111], v[208:211]
    s_add_u32 s57, s58, 4128768
    v_exp_f32 v215, v215
    v_mfma_f32_16x16x32_bf16 a[112:115], a[184:187], v[160:163], a[112:115]
    ds_read_b64_tr_b16 a[164:165], v20 offset:40960
    v_cvt_pk_bf16_f32 v142, v212, v213
    v_mfma_f32_16x16x32_bf16 a[112:115], a[188:191], v[164:167], a[112:115]
    ds_read_b64_tr_b16 a[166:167], v20 offset:45056
    ds_read_b64 v[230:231], v245 offset:192
    v_mfma_f32_16x16x32_bf16 a[116:119], a[184:187], v[168:171], a[116:119]
    ds_read_b128 a[220:223], v11 offset:49152
    v_cvt_pk_bf16_f32 v143, v214, v215
    v_mfma_f32_16x16x32_bf16 a[116:119], a[188:191], v[172:175], a[116:119]
    buffer_load_dwordx4 a[156:159], v254, s[80:83], s57 offen
    v_mfma_f32_16x16x32_bf16 v[212:215], a[224:227], v[112:115], v[204:207]
    v_exp_f32 v208, v208
    v_mfma_f32_16x16x32_bf16 v[212:215], a[228:231], v[116:119], v[212:215]
    v_exp_f32 v209, v209
    v_mfma_f32_16x16x32_bf16 v[212:215], a[232:235], v[120:123], v[212:215]
    v_exp_f32 v210, v210
    v_mfma_f32_16x16x32_bf16 v[212:215], a[236:239], v[124:127], v[212:215]
    v_exp_f32 v211, v211
    v_mfma_f32_16x16x32_bf16 a[120:123], a[184:187], v[176:179], a[120:123]
    ds_read_b64_tr_b16 a[168:169], v21 offset:32768
    v_cvt_pk_bf16_f32 v150, v208, v209
    v_mfma_f32_16x16x32_bf16 a[120:123], a[188:191], v[180:183], a[120:123]
    ds_read_b64_tr_b16 a[170:171], v21 offset:36864
    v_mfma_f32_16x16x32_bf16 a[124:127], a[184:187], v[184:187], a[124:127]
    ds_read_b128 a[224:227], v8 offset:53248
    v_cvt_pk_bf16_f32 v151, v210, v211
    v_mfma_f32_16x16x32_bf16 a[124:127], a[188:191], v[188:191], a[124:127]
    s_waitcnt lgkmcnt(3)
    buffer_load_dwordx4 v48, s[20:23], s49 offen offset:2048 lds
    v_mfma_f32_16x16x32_bf16 v[208:211], a[208:211], v[64:67], v[192:195]
    v_exp_f32 v212, v212
    v_mfma_f32_16x16x32_bf16 v[208:211], a[212:215], v[68:71], v[208:211]
    v_exp_f32 v213, v213
    v_mfma_f32_16x16x32_bf16 v[208:211], a[216:219], v[72:75], v[208:211]
    v_exp_f32 v214, v214
    v_mfma_f32_16x16x32_bf16 v[208:211], a[220:223], v[76:79], v[208:211]
    s_add_u32 s57, s58, 4718592
    v_exp_f32 v215, v215
    v_mfma_f32_16x16x32_bf16 a[0:3], a[160:163], v[128:131], a[0:3]
    ds_read_b64_tr_b16 a[172:173], v21 offset:40960
    v_cvt_pk_bf16_f32 v158, v212, v213
    v_mfma_f32_16x16x32_bf16 a[0:3], a[164:167], v[132:135], a[0:3]
    ds_read_b64_tr_b16 a[174:175], v21 offset:45056
    v_add_f32 v224, v224, v228
    v_mfma_f32_16x16x32_bf16 a[4:7], a[160:163], v[136:139], a[4:7]
    ds_read_b128 a[228:231], v9 offset:53248
    v_cvt_pk_bf16_f32 v159, v214, v215
    v_mfma_f32_16x16x32_bf16 a[4:7], a[164:167], v[140:143], a[4:7]
Ltour7:
    s_cbranch_execz Ltour11
    buffer_load_dwordx4 a[240:243], v254, s[80:83], s57 offen
    v_mfma_f32_16x16x32_bf16 v[212:215], a[208:211], v[80:83], v[196:199]
    v_exp_f32 v208, v208
    v_mfma_f32_16x16x32_bf16 v[212:215], a[212:215], v[84:87], v[212:215]
    v_exp_f32 v209, v209
    v_mfma_f32_16x16x32_bf16 v[212:215], a[216:219], v[88:91], v[212:215]
    v_exp_f32 v210, v210
    v_mfma_f32_16x16x32_bf16 v[212:215], a[220:223], v[92:95], v[212:215]
    v_exp_f32 v211, v211
    v_mfma_f32_16x16x32_bf16 a[8:11], a[160:163], v[144:147], a[8:11]
    ds_read_b64_tr_b16 a[176:177], v22 offset:32768
    v_cvt_pk_bf16_f32 v160, v208, v209
    v_mfma_f32_16x16x32_bf16 a[8:11], a[164:167], v[148:151], a[8:11]
    ds_read_b64_tr_b16 a[178:179], v22 offset:36864
    v_add_f32 v225, v225, v229
    v_mfma_f32_16x16x32_bf16 a[12:15], a[160:163], v[152:155], a[12:15]
    ds_read_b128 a[232:235], v10 offset:53248
    v_cvt_pk_bf16_f32 v161, v210, v211
    v_mfma_f32_16x16x32_bf16 a[12:15], a[164:167], v[156:159], a[12:15]
    s_waitcnt lgkmcnt(3)
    buffer_load_dwordx4 v49, s[20:23], s49 offen offset:3072 lds
    v_mfma_f32_16x16x32_bf16 v[208:211], a[208:211], v[96:99], v[200:203]
    v_exp_f32 v212, v212
    v_mfma_f32_16x16x32_bf16 v[208:211], a[212:215], v[100:103], v[208:211]
    v_exp_f32 v213, v213
    v_mfma_f32_16x16x32_bf16 v[208:211], a[216:219], v[104:107], v[208:211]
    v_exp_f32 v214, v214
    v_mfma_f32_16x16x32_bf16 v[208:211], a[220:223], v[108:111], v[208:211]
    v_exp_f32 v215, v215
    v_mfma_f32_16x16x32_bf16 a[16:19], a[168:171], v[128:131], a[16:19]
    ds_read_b64_tr_b16 a[180:181], v22 offset:40960
    v_cvt_pk_bf16_f32 v168, v212, v213
    v_mfma_f32_16x16x32_bf16 a[16:19], a[172:175], v[132:135], a[16:19]
    ds_read_b64_tr_b16 a[182:183], v22 offset:45056
    v_add_f32 v226, v226, v230
    v_mfma_f32_16x16x32_bf16 a[20:23], a[168:171], v[136:139], a[20:23]
    ds_read_b128 a[236:239], v11 offset:53248
    v_cvt_pk_bf16_f32 v169, v214, v215
    v_mfma_f32_16x16x32_bf16 a[20:23], a[172:175], v[140:143], a[20:23]
    v_add_f32 v227, v227, v231
    v_add_f32 v224, v224, v226
    v_smfmac_f32_16x16x64_bf16 a[192:195], v[52:55], v[128:135], v50
    v_mfma_f32_16x16x32_bf16 v[212:215], a[208:211], v[112:115], v[204:207]
    v_exp_f32 v208, v208
    v_mfma_f32_16x16x32_bf16 v[212:215], a[212:215], v[116:119], v[212:215]
    s_add_u32 s49, s7, 0
    v_exp_f32 v209, v209
    v_mfma_f32_16x16x32_bf16 v[212:215], a[216:219], v[120:123], v[212:215]
    s_add_u32 m0, s42, 65536
    v_exp_f32 v210, v210
    v_mfma_f32_16x16x32_bf16 v[212:215], a[220:223], v[124:127], v[212:215]
    v_exp_f32 v211, v211
    v_mfma_f32_16x16x32_bf16 a[24:27], a[168:171], v[144:147], a[24:27]
    ds_read_b64_tr_b16 a[184:185], v23 offset:32768
    v_cvt_pk_bf16_f32 v176, v208, v209
    v_mfma_f32_16x16x32_bf16 a[24:27], a[172:175], v[148:151], a[24:27]
    ds_read_b64_tr_b16 a[186:187], v23 offset:36864
    v_add_f32 v225, v225, v227
    v_mfma_f32_16x16x32_bf16 a[28:31], a[168:171], v[152:155], a[28:31]
    ds_read_b128 a[208:211], v8 offset:57344
    v_cvt_pk_bf16_f32 v177, v210, v211
    v_mfma_f32_16x16x32_bf16 a[28:31], a[172:175], v[156:159], a[28:31]
    s_waitcnt lgkmcnt(3)
    buffer_load_dwordx4 v46, s[20:23], s49 offen lds
    v_mfma_f32_16x16x32_bf16 v[208:211], a[224:227], v[64:67], v[192:195]
    v_exp_f32 v212, v212
    v_mfma_f32_16x16x32_bf16 v[208:211], a[228:231], v[68:71], v[208:211]
    v_exp_f32 v213, v213
    v_mfma_f32_16x16x32_bf16 v[208:211], a[232:235], v[72:75], v[208:211]
    v_exp_f32 v214, v214
    v_mfma_f32_16x16x32_bf16 v[208:211], a[236:239], v[76:79], v[208:211]
    s_add_u32 s57, s58, 4128768
    v_exp_f32 v215, v215
    v_mfma_f32_16x16x32_bf16 a[32:35], a[176:179], v[128:131], a[32:35]
    ds_read_b64_tr_b16 a[188:189], v23 offset:40960
    v_cvt_pk_bf16_f32 v184, v212, v213
    v_mfma_f32_16x16x32_bf16 a[32:35], a[180:183], v[132:135], a[32:35]
    ds_read_b64_tr_b16 a[190:191], v23 offset:45056
    v_cvt_pk_bf16_f32 v246, v224, v225
    v_mfma_f32_16x16x32_bf16 a[36:39], a[176:179], v[136:139], a[36:39]
    ds_read_b128 a[212:215], v9 offset:57344
    v_cvt_pk_bf16_f32 v185, v214, v215
    v_mfma_f32_16x16x32_bf16 a[36:39], a[180:183], v[140:143], a[36:39]
    buffer_load_dwordx4 a[244:247], v254, s[32:35], s57 offen
    v_smfmac_f32_16x16x64_bf16 a[196:199], v[52:55], v[136:143], v50
    v_mfma_f32_16x16x32_bf16 v[212:215], a[224:227], v[80:83], v[196:199]
    v_exp_f32 v208, v208
    v_mfma_f32_16x16x32_bf16 v[212:215], a[228:231], v[84:87], v[212:215]
    v_exp_f32 v209, v209
    v_mfma_f32_16x16x32_bf16 v[212:215], a[232:235], v[88:91], v[212:215]
    v_exp_f32 v210, v210
    v_mfma_f32_16x16x32_bf16 v[212:215], a[236:239], v[92:95], v[212:215]
    v_exp_f32 v211, v211
    v_mfma_f32_16x16x32_bf16 a[40:43], a[176:179], v[144:147], a[40:43]
    ds_read_b64_tr_b16 a[160:161], v24 offset:32768
    v_cvt_pk_bf16_f32 v162, v208, v209
    v_mfma_f32_16x16x32_bf16 a[40:43], a[180:183], v[148:151], a[40:43]
    ds_read_b64_tr_b16 a[162:163], v24 offset:36864
    v_lshlrev_b32 v224, 16, v246
    v_mfma_f32_16x16x32_bf16 a[44:47], a[176:179], v[152:155], a[44:47]
    ds_read_b128 a[216:219], v10 offset:57344
    v_cvt_pk_bf16_f32 v163, v210, v211
    v_mfma_f32_16x16x32_bf16 a[44:47], a[180:183], v[156:159], a[44:47]
    s_waitcnt lgkmcnt(3)
    buffer_load_dwordx4 v47, s[20:23], s49 offen offset:1024 lds
    v_mfma_f32_16x16x32_bf16 v[208:211], a[224:227], v[96:99], v[200:203]
    v_exp_f32 v212, v212
    v_mfma_f32_16x16x32_bf16 v[208:211], a[228:231], v[100:103], v[208:211]
    v_exp_f32 v213, v213
    v_mfma_f32_16x16x32_bf16 v[208:211], a[232:235], v[104:107], v[208:211]
    v_exp_f32 v214, v214
    v_mfma_f32_16x16x32_bf16 v[208:211], a[236:239], v[108:111], v[208:211]
    v_exp_f32 v215, v215
    v_mfma_f32_16x16x32_bf16 a[48:51], a[184:187], v[128:131], a[48:51]
    ds_read_b64_tr_b16 a[164:165], v24 offset:40960
    v_cvt_pk_bf16_f32 v170, v212, v213
    v_mfma_f32_16x16x32_bf16 a[48:51], a[188:191], v[132:135], a[48:51]
    ds_read_b64_tr_b16 a[166:167], v24 offset:45056
    v_and_b32 v225, 0xffff0000, v246
    v_mfma_f32_16x16x32_bf16 a[52:55], a[184:187], v[136:139], a[52:55]
    ds_read_b128 a[220:223], v11 offset:57344
    v_cvt_pk_bf16_f32 v171, v214, v215
    v_mfma_f32_16x16x32_bf16 a[52:55], a[188:191], v[140:143], a[52:55]
    v_add_f32 v224, s36, v224
    v_add_f32 v225, s36, v225
    v_smfmac_f32_16x16x64_bf16 a[200:203], v[52:55], v[144:151], v50
    v_mfma_f32_16x16x32_bf16 v[212:215], a[224:227], v[112:115], v[204:207]
    v_exp_f32 v208, v208
    v_mfma_f32_16x16x32_bf16 v[212:215], a[228:231], v[116:119], v[212:215]
    v_exp_f32 v209, v209
    v_mfma_f32_16x16x32_bf16 v[212:215], a[232:235], v[120:123], v[212:215]
    v_exp_f32 v210, v210
    v_mfma_f32_16x16x32_bf16 v[212:215], a[236:239], v[124:127], v[212:215]
    v_exp_f32 v211, v211
    v_mfma_f32_16x16x32_bf16 a[56:59], a[184:187], v[144:147], a[56:59]
    ds_read_b64_tr_b16 a[168:169], v25 offset:32768
    v_cvt_pk_bf16_f32 v178, v208, v209
    v_mfma_f32_16x16x32_bf16 a[56:59], a[188:191], v[148:151], a[56:59]
    ds_read_b64_tr_b16 a[170:171], v25 offset:36864
    v_cvt_pk_bf16_f32 v246, v224, v225
    v_mfma_f32_16x16x32_bf16 a[60:63], a[184:187], v[152:155], a[60:63]
    ds_read_b128 a[224:227], v8 offset:61440
    v_cvt_pk_bf16_f32 v179, v210, v211
    v_mfma_f32_16x16x32_bf16 a[60:63], a[188:191], v[156:159], a[60:63]
    s_waitcnt lgkmcnt(3)
    buffer_load_dwordx4 v48, s[20:23], s49 offen offset:2048 lds
    v_mfma_f32_16x16x32_bf16 v[208:211], a[208:211], v[64:67], v[192:195]
    v_exp_f32 v212, v212
    v_mfma_f32_16x16x32_bf16 v[208:211], a[212:215], v[68:71], v[208:211]
    v_exp_f32 v213, v213
    v_mfma_f32_16x16x32_bf16 v[208:211], a[216:219], v[72:75], v[208:211]
    v_exp_f32 v214, v214
    v_mfma_f32_16x16x32_bf16 v[208:211], a[220:223], v[76:79], v[208:211]
    s_add_u32 s57, s58, 4718592
    v_exp_f32 v215, v215
    v_mfma_f32_16x16x32_bf16 a[64:67], a[160:163], v[128:131], a[64:67]
    ds_read_b64_tr_b16 a[172:173], v25 offset:40960
    v_cvt_pk_bf16_f32 v186, v212, v213
    v_mfma_f32_16x16x32_bf16 a[64:67], a[164:167], v[132:135], a[64:67]
    ds_read_b64_tr_b16 a[174:175], v25 offset:45056
    v_lshrrev_b32 v244, 1, v0
    v_mfma_f32_16x16x32_bf16 a[68:71], a[160:163], v[136:139], a[68:71]
    ds_read_b128 a[228:231], v9 offset:61440
    v_cvt_pk_bf16_f32 v187, v214, v215
    v_mfma_f32_16x16x32_bf16 a[68:71], a[164:167], v[140:143], a[68:71]
    buffer_load_dwordx4 a[248:251], v254, s[32:35], s57 offen
    v_smfmac_f32_16x16x64_bf16 a[204:207], v[52:55], v[152:159], v50
    v_mfma_f32_16x16x32_bf16 v[212:215], a[208:211], v[80:83], v[196:199]
    v_exp_f32 v208, v208
    v_mfma_f32_16x16x32_bf16 v[212:215], a[212:215], v[84:87], v[212:215]
    v_exp_f32 v209, v209
    v_mfma_f32_16x16x32_bf16 v[212:215], a[216:219], v[88:91], v[212:215]
    v_exp_f32 v210, v210
    v_mfma_f32_16x16x32_bf16 v[212:215], a[220:223], v[92:95], v[212:215]
    v_exp_f32 v211, v211
    v_mfma_f32_16x16x32_bf16 a[72:75], a[160:163], v[144:147], a[72:75]
    ds_read_b64_tr_b16 a[176:177], v26 offset:32768
    v_cvt_pk_bf16_f32 v164, v208, v209
    v_mfma_f32_16x16x32_bf16 a[72:75], a[164:167], v[148:151], a[72:75]
    ds_read_b64_tr_b16 a[178:179], v26 offset:36864
    v_lshlrev_b32 v244, 4, v244
    v_mfma_f32_16x16x32_bf16 a[76:79], a[160:163], v[152:155], a[76:79]
    ds_read_b128 a[232:235], v10 offset:61440
    v_cvt_pk_bf16_f32 v165, v210, v211
    v_mfma_f32_16x16x32_bf16 a[76:79], a[164:167], v[156:159], a[76:79]
    s_waitcnt lgkmcnt(3)
    buffer_load_dwordx4 v49, s[20:23], s49 offen offset:3072 lds
    v_mfma_f32_16x16x32_bf16 v[208:211], a[208:211], v[96:99], v[200:203]
    v_exp_f32 v212, v212
    v_mfma_f32_16x16x32_bf16 v[208:211], a[212:215], v[100:103], v[208:211]
    v_exp_f32 v213, v213
    v_mfma_f32_16x16x32_bf16 v[208:211], a[216:219], v[104:107], v[208:211]
    v_exp_f32 v214, v214
    v_mfma_f32_16x16x32_bf16 v[208:211], a[220:223], v[108:111], v[208:211]
    v_exp_f32 v215, v215
    v_mfma_f32_16x16x32_bf16 a[80:83], a[168:171], v[128:131], a[80:83]
    ds_read_b64_tr_b16 a[180:181], v26 offset:40960
    v_cvt_pk_bf16_f32 v172, v212, v213
    v_mfma_f32_16x16x32_bf16 a[80:83], a[172:175], v[132:135], a[80:83]
    ds_read_b64_tr_b16 a[182:183], v26 offset:45056
    v_and_b32 v245, 1, v0
    v_mfma_f32_16x16x32_bf16 a[84:87], a[168:171], v[136:139], a[84:87]
    ds_read_b128 a[236:239], v11 offset:61440
    v_cvt_pk_bf16_f32 v173, v214, v215
    v_mfma_f32_16x16x32_bf16 a[84:87], a[172:175], v[140:143], a[84:87]
    s_waitcnt vmcnt(13)
    s_barrier
    v_mfma_f32_16x16x32_bf16 v[212:215], a[208:211], v[112:115], v[204:207]
    v_exp_f32 v208, v208
    v_mfma_f32_16x16x32_bf16 v[212:215], a[212:215], v[116:119], v[212:215]
    s_add_u32 s49, s7, 73728
    v_exp_f32 v209, v209
    v_mfma_f32_16x16x32_bf16 v[212:215], a[216:219], v[120:123], v[212:215]
    s_add_u32 m0, s42, 81920
    v_exp_f32 v210, v210
    v_mfma_f32_16x16x32_bf16 v[212:215], a[220:223], v[124:127], v[212:215]
    v_exp_f32 v211, v211
    v_mfma_f32_16x16x32_bf16 a[88:91], a[168:171], v[144:147], a[88:91]
    ds_read_b64_tr_b16 a[184:185], v27 offset:32768
    v_cvt_pk_bf16_f32 v180, v208, v209
    v_mfma_f32_16x16x32_bf16 a[88:91], a[172:175], v[148:151], a[88:91]
    ds_read_b64_tr_b16 a[186:187], v27 offset:36864
    v_lshl_add_u32 v244, v245, 2, v244
    v_mfma_f32_16x16x32_bf16 a[92:95], a[168:171], v[152:155], a[92:95]
    v_cvt_pk_bf16_f32 v181, v210, v211
    v_mfma_f32_16x16x32_bf16 a[92:95], a[172:175], v[156:159], a[92:95]
    s_waitcnt lgkmcnt(3)
    buffer_load_dwordx4 v46, s[20:23], s49 offen lds
    v_mfma_f32_16x16x32_bf16 v[208:211], a[224:227], v[64:67], v[192:195]
    v_exp_f32 v212, v212
    v_mfma_f32_16x16x32_bf16 v[208:211], a[228:231], v[68:71], v[208:211]
    v_exp_f32 v213, v213
    v_mfma_f32_16x16x32_bf16 v[208:211], a[232:235], v[72:75], v[208:211]
    s_waitcnt lgkmcnt(2)
    v_exp_f32 v214, v214
    v_mfma_f32_16x16x32_bf16 v[208:211], a[236:239], v[76:79], v[208:211]
    v_exp_f32 v215, v215
    v_mfma_f32_16x16x32_bf16 a[96:99], a[176:179], v[128:131], a[96:99]
    ds_read_b64_tr_b16 a[188:189], v27 offset:40960
    v_cvt_pk_bf16_f32 v188, v212, v213
    v_mfma_f32_16x16x32_bf16 a[96:99], a[180:183], v[132:135], a[96:99]
    ds_read_b64_tr_b16 a[190:191], v27 offset:45056
    v_lshrrev_b32 v245, 3, v0
    v_mfma_f32_16x16x32_bf16 a[100:103], a[176:179], v[136:139], a[100:103]
    v_cvt_pk_bf16_f32 v189, v214, v215
    v_mfma_f32_16x16x32_bf16 a[100:103], a[180:183], v[140:143], a[100:103]
    v_min_u32 v245, 1, v245
    v_lshl_or_b32 v244, v245, 31, v244
    v_mfma_f32_16x16x32_bf16 v[212:215], a[224:227], v[80:83], v[196:199]
    v_exp_f32 v208, v208
    v_mfma_f32_16x16x32_bf16 v[212:215], a[228:231], v[84:87], v[212:215]
    v_exp_f32 v209, v209
    v_mfma_f32_16x16x32_bf16 v[212:215], a[232:235], v[88:91], v[212:215]
    v_exp_f32 v210, v210
    v_mfma_f32_16x16x32_bf16 v[212:215], a[236:239], v[92:95], v[212:215]
    v_exp_f32 v211, v211
    v_mfma_f32_16x16x32_bf16 a[104:107], a[176:179], v[144:147], a[104:107]
    ds_read_b64_tr_b16 a[160:161], v20 offset:49152
    v_cvt_pk_bf16_f32 v166, v208, v209
    v_mfma_f32_16x16x32_bf16 a[104:107], a[180:183], v[148:151], a[104:107]
    ds_read_b64_tr_b16 a[162:163], v20 offset:53248
    v_mfma_f32_16x16x32_bf16 a[108:111], a[176:179], v[152:155], a[108:111]
    v_cvt_pk_bf16_f32 v167, v210, v211
    v_mfma_f32_16x16x32_bf16 a[108:111], a[180:183], v[156:159], a[108:111]
    s_waitcnt lgkmcnt(3)
    buffer_load_dwordx4 v47, s[20:23], s49 offen offset:1024 lds
    v_mfma_f32_16x16x32_bf16 v[208:211], a[224:227], v[96:99], v[200:203]
    v_exp_f32 v212, v212
    v_mfma_f32_16x16x32_bf16 v[208:211], a[228:231], v[100:103], v[208:211]
    v_exp_f32 v213, v213
    v_mfma_f32_16x16x32_bf16 v[208:211], a[232:235], v[104:107], v[208:211]
    v_exp_f32 v214, v214
    v_mfma_f32_16x16x32_bf16 v[208:211], a[236:239], v[108:111], v[208:211]
    s_add_u32 s57, s59, 0
    v_exp_f32 v215, v215
    v_mfma_f32_16x16x32_bf16 a[112:115], a[184:187], v[128:131], a[112:115]
    s_waitcnt lgkmcnt(2)
    ds_read_b64_tr_b16 a[164:165], v20 offset:57344
    v_cvt_pk_bf16_f32 v174, v212, v213
    v_mfma_f32_16x16x32_bf16 a[112:115], a[188:191], v[132:135], a[112:115]
    ds_read_b64_tr_b16 a[166:167], v20 offset:61440
    v_mfma_f32_16x16x32_bf16 a[116:119], a[184:187], v[136:139], a[116:119]
    v_cvt_pk_bf16_f32 v175, v214, v215
    v_mfma_f32_16x16x32_bf16 a[116:119], a[188:191], v[140:143], a[116:119]
    buffer_load_dwordx4 a[252:255], v255, s[84:87], s57 offen
    v_mfma_f32_16x16x32_bf16 v[212:215], a[224:227], v[112:115], v[204:207]
    v_exp_f32 v208, v208
    v_mfma_f32_16x16x32_bf16 v[212:215], a[228:231], v[116:119], v[212:215]
    v_exp_f32 v209, v209
    v_mfma_f32_16x16x32_bf16 v[212:215], a[232:235], v[120:123], v[212:215]
    v_exp_f32 v210, v210
    v_mfma_f32_16x16x32_bf16 v[212:215], a[236:239], v[124:127], v[212:215]
    v_exp_f32 v211, v211
    v_mfma_f32_16x16x32_bf16 a[120:123], a[184:187], v[144:147], a[120:123]
    ds_read_b64_tr_b16 a[168:169], v21 offset:49152
    v_cvt_pk_bf16_f32 v182, v208, v209
    v_mfma_f32_16x16x32_bf16 a[120:123], a[188:191], v[148:151], a[120:123]
    ds_read_b64_tr_b16 a[170:171], v21 offset:53248
    v_mfma_f32_16x16x32_bf16 a[124:127], a[184:187], v[152:155], a[124:127]
    v_cvt_pk_bf16_f32 v183, v210, v211
    v_mfma_f32_16x16x32_bf16 a[124:127], a[188:191], v[156:159], a[124:127]
    s_waitcnt lgkmcnt(3)
    buffer_load_dwordx4 v48, s[20:23], s49 offen offset:2048 lds
    v_smfmac_f32_16x16x64_bf16 a[192:195], v[52:55], v[160:167], v50
    v_exp_f32 v212, v212
    v_smfmac_f32_16x16x64_bf16 a[196:199], v[52:55], v[168:175], v50
    v_exp_f32 v213, v213
    v_smfmac_f32_16x16x64_bf16 a[200:203], v[52:55], v[176:183], v50
    v_exp_f32 v214, v214
    v_exp_f32 v215, v215
    v_mfma_f32_16x16x32_bf16 a[0:3], a[160:163], v[160:163], a[0:3]
    s_waitcnt lgkmcnt(2)
    ds_read_b64_tr_b16 a[172:173], v21 offset:57344
    v_cvt_pk_bf16_f32 v190, v212, v213
    v_mfma_f32_16x16x32_bf16 a[0:3], a[164:167], v[164:167], a[0:3]
    ds_read_b64_tr_b16 a[174:175], v21 offset:61440
    v_mfma_f32_16x16x32_bf16 a[4:7], a[160:163], v[168:171], a[4:7]
    v_cvt_pk_bf16_f32 v191, v214, v215
    v_mfma_f32_16x16x32_bf16 a[4:7], a[164:167], v[172:175], a[4:7]
    buffer_store_dword v246, v244, s[24:27], s39 offen sc1
    v_smfmac_f32_16x16x64_bf16 a[204:207], v[52:55], v[184:191], v50
    v_mfma_f32_16x16x32_bf16 a[8:11], a[160:163], v[176:179], a[8:11]
    ds_read_b64_tr_b16 a[176:177], v22 offset:49152
    v_mfma_f32_16x16x32_bf16 a[8:11], a[164:167], v[180:183], a[8:11]
    ds_read_b64_tr_b16 a[178:179], v22 offset:53248
    v_accvgpr_read_b32 v216, a192
    v_accvgpr_read_b32 v217, a193
    v_mfma_f32_16x16x32_bf16 a[12:15], a[160:163], v[184:187], a[12:15]
    v_accvgpr_read_b32 v218, a196
    v_accvgpr_read_b32 v219, a197
    v_mfma_f32_16x16x32_bf16 a[12:15], a[164:167], v[188:191], a[12:15]
    s_waitcnt lgkmcnt(4)
    buffer_load_dwordx4 v49, s[20:23], s49 offen offset:3072 lds
    v_accvgpr_read_b32 v220, a200
    v_accvgpr_read_b32 v221, a201
    v_mfma_f32_16x16x32_bf16 a[16:19], a[168:171], v[160:163], a[16:19]
    s_waitcnt lgkmcnt(2)
    ds_read_b64_tr_b16 a[180:181], v22 offset:57344
    v_accvgpr_read_b32 v222, a204
    v_mfma_f32_16x16x32_bf16 a[16:19], a[172:175], v[164:167], a[16:19]
    ds_read_b64_tr_b16 a[182:183], v22 offset:61440
    v_accvgpr_read_b32 v223, a205
    v_add_f32 v58, v216, v217
    v_mfma_f32_16x16x32_bf16 a[20:23], a[168:171], v[168:171], a[20:23]
    v_add_f32 v59, v218, v219
    v_add_f32 v60, v220, v221
    v_mfma_f32_16x16x32_bf16 a[20:23], a[172:175], v[172:175], a[20:23]
    v_add_f32 v61, v222, v223
    v_add_f32 v216, v58, v59
    s_add_u32 s49, s7, 256
    s_add_u32 m0, s42, 32768
    v_mfma_f32_16x16x32_bf16 a[24:27], a[168:171], v[176:179], a[24:27]
    ds_read_b64_tr_b16 a[184:185], v23 offset:49152
    v_add_f32 v217, v60, v61
    v_mfma_f32_16x16x32_bf16 a[24:27], a[172:175], v[180:183], a[24:27]
    ds_read_b64_tr_b16 a[186:187], v23 offset:53248
    v_add_f32 v216, v216, v217
    v_cmp_ngt_f32 vcc, 1669332992, v216
    v_mfma_f32_16x16x32_bf16 a[28:31], a[168:171], v[184:187], a[28:31]
    v_rcp_f32 v58, v58
    v_rcp_f32 v59, v59
    v_mfma_f32_16x16x32_bf16 a[28:31], a[172:175], v[188:191], a[28:31]
    s_waitcnt lgkmcnt(4)
    buffer_load_dwordx4 v46, s[20:23], s49 offen lds
    v_rcp_f32 v60, v60
    v_rcp_f32 v61, v61
    v_mfma_f32_16x16x32_bf16 a[32:35], a[176:179], v[160:163], a[32:35]
    s_waitcnt lgkmcnt(2)
    ds_read_b64_tr_b16 a[188:189], v23 offset:57344
    v_mov_b32 v228, 131072
    v_mfma_f32_16x16x32_bf16 a[32:35], a[180:183], v[164:167], a[32:35]
    ds_read_b64_tr_b16 a[190:191], v23 offset:61440
    s_or_b32 s36, vcc_lo, vcc_hi
    v_mfma_f32_16x16x32_bf16 a[36:39], a[176:179], v[168:171], a[36:39]
    v_accvgpr_read_b32 v208, a0
    v_accvgpr_read_b32 v209, a1
    v_accvgpr_read_b32 v210, a2
    v_accvgpr_read_b32 v211, a3
    v_pk_mul_f32 v[208:209], v[208:209], v[58:59] op_sel:[0,0] op_sel_hi:[1,0]
    v_pk_mul_f32 v[210:211], v[210:211], v[58:59] op_sel:[0,0] op_sel_hi:[1,0]
    v_cvt_pk_bf16_f32 v128, v208, v209
    v_cvt_pk_bf16_f32 v129, v210, v211
    v_mfma_f32_16x16x32_bf16 a[36:39], a[180:183], v[172:175], a[36:39]
    v_accvgpr_read_b32 v212, a4
    v_accvgpr_read_b32 v213, a5
    v_accvgpr_read_b32 v214, a6
    v_accvgpr_read_b32 v215, a7
    v_pk_mul_f32 v[212:213], v[212:213], v[58:59] op_sel:[0,1] op_sel_hi:[1,1]
    v_pk_mul_f32 v[214:215], v[214:215], v[58:59] op_sel:[0,1] op_sel_hi:[1,1]
    v_cvt_pk_bf16_f32 v132, v212, v213
    v_cvt_pk_bf16_f32 v133, v214, v215
    v_mfma_f32_16x16x32_bf16 a[40:43], a[176:179], v[176:179], a[40:43]
    ds_read_b64_tr_b16 a[160:161], v24 offset:49152
    v_mov_b32 v218, s36
    v_mfma_f32_16x16x32_bf16 a[40:43], a[180:183], v[180:183], a[40:43]
    ds_read_b64_tr_b16 a[162:163], v24 offset:53248
    s_lshl_b32 s38, s3, 2
    v_mfma_f32_16x16x32_bf16 a[44:47], a[176:179], v[184:187], a[44:47]
    v_accvgpr_read_b32 v208, a8
    v_accvgpr_read_b32 v209, a9
    v_accvgpr_read_b32 v210, a10
    v_accvgpr_read_b32 v211, a11
    v_pk_mul_f32 v[208:209], v[208:209], v[60:61] op_sel:[0,0] op_sel_hi:[1,0]
    v_pk_mul_f32 v[210:211], v[210:211], v[60:61] op_sel:[0,0] op_sel_hi:[1,0]
    v_cvt_pk_bf16_f32 v136, v208, v209
    v_cvt_pk_bf16_f32 v137, v210, v211
    v_mfma_f32_16x16x32_bf16 a[44:47], a[180:183], v[188:191], a[44:47]
    s_waitcnt lgkmcnt(4)
    buffer_load_dwordx4 v47, s[20:23], s49 offen offset:1024 lds
    v_accvgpr_read_b32 v212, a12
    v_accvgpr_read_b32 v213, a13
    v_accvgpr_read_b32 v214, a14
    v_accvgpr_read_b32 v215, a15
    v_pk_mul_f32 v[212:213], v[212:213], v[60:61] op_sel:[0,1] op_sel_hi:[1,1]
    v_pk_mul_f32 v[214:215], v[214:215], v[60:61] op_sel:[0,1] op_sel_hi:[1,1]
    v_cvt_pk_bf16_f32 v140, v212, v213
    v_cvt_pk_bf16_f32 v141, v214, v215
    v_mfma_f32_16x16x32_bf16 a[48:51], a[184:187], v[160:163], a[48:51]
    s_waitcnt lgkmcnt(2)
    ds_read_b64_tr_b16 a[164:165], v24 offset:57344
    v_add_u32 v219, s38, v228
    v_mfma_f32_16x16x32_bf16 a[48:51], a[188:191], v[164:167], a[48:51]
    ds_read_b64_tr_b16 a[166:167], v24 offset:61440
    ds_write_b32 v219, v218
    v_mfma_f32_16x16x32_bf16 a[52:55], a[184:187], v[168:171], a[52:55]
    v_accvgpr_read_b32 v208, a16
    v_accvgpr_read_b32 v209, a17
    v_accvgpr_read_b32 v210, a18
    v_accvgpr_read_b32 v211, a19
    v_pk_mul_f32 v[208:209], v[208:209], v[58:59] op_sel:[0,0] op_sel_hi:[1,0]
    v_pk_mul_f32 v[210:211], v[210:211], v[58:59] op_sel:[0,0] op_sel_hi:[1,0]
    v_cvt_pk_bf16_f32 v130, v208, v209
    v_cvt_pk_bf16_f32 v131, v210, v211
    s_add_u32 s37, s55, 0
    buffer_store_dwordx4 v[128:131], v252, s[28:31], s37 offen offset:0
    v_mfma_f32_16x16x32_bf16 a[52:55], a[188:191], v[172:175], a[52:55]
    v_accvgpr_read_b32 v212, a20
    v_accvgpr_read_b32 v213, a21
    v_accvgpr_read_b32 v214, a22
    v_accvgpr_read_b32 v215, a23
    v_pk_mul_f32 v[212:213], v[212:213], v[58:59] op_sel:[0,1] op_sel_hi:[1,1]
    v_pk_mul_f32 v[214:215], v[214:215], v[58:59] op_sel:[0,1] op_sel_hi:[1,1]
    v_cvt_pk_bf16_f32 v134, v212, v213
    v_cvt_pk_bf16_f32 v135, v214, v215
    s_add_u32 s37, s55, 8192
    buffer_store_dwordx4 v[132:135], v252, s[28:31], s37 offen offset:0
    v_mfma_f32_16x16x32_bf16 a[56:59], a[184:187], v[176:179], a[56:59]
    ds_read_b64_tr_b16 a[168:169], v25 offset:49152
    v_min_u32 v240, 1, v0
    v_mfma_f32_16x16x32_bf16 a[56:59], a[188:191], v[180:183], a[56:59]
    ds_read_b64_tr_b16 a[170:171], v25 offset:53248
    v_mfma_f32_16x16x32_bf16 a[60:63], a[184:187], v[184:187], a[60:63]
    v_accvgpr_read_b32 v208, a24
    v_accvgpr_read_b32 v209, a25
    v_accvgpr_read_b32 v210, a26
    v_accvgpr_read_b32 v211, a27
    v_pk_mul_f32 v[208:209], v[208:209], v[60:61] op_sel:[0,0] op_sel_hi:[1,0]
    v_pk_mul_f32 v[210:211], v[210:211], v[60:61] op_sel:[0,0] op_sel_hi:[1,0]
    v_cvt_pk_bf16_f32 v138, v208, v209
    v_cvt_pk_bf16_f32 v139, v210, v211
    s_add_u32 s37, s55, 4096
    buffer_store_dwordx4 v[136:139], v252, s[28:31], s37 offen offset:0
    v_mfma_f32_16x16x32_bf16 a[60:63], a[188:191], v[188:191], a[60:63]
    s_waitcnt lgkmcnt(5)
    buffer_load_dwordx4 v48, s[20:23], s49 offen offset:2048 lds
    v_accvgpr_read_b32 v212, a28
    v_accvgpr_read_b32 v213, a29
    v_accvgpr_read_b32 v214, a30
    v_accvgpr_read_b32 v215, a31
    v_pk_mul_f32 v[212:213], v[212:213], v[60:61] op_sel:[0,1] op_sel_hi:[1,1]
    v_pk_mul_f32 v[214:215], v[214:215], v[60:61] op_sel:[0,1] op_sel_hi:[1,1]
    v_cvt_pk_bf16_f32 v142, v212, v213
    v_cvt_pk_bf16_f32 v143, v214, v215
    s_add_u32 s37, s55, 12288
    buffer_store_dwordx4 v[140:143], v252, s[28:31], s37 offen offset:0
    v_mfma_f32_16x16x32_bf16 a[64:67], a[160:163], v[160:163], a[64:67]
    s_waitcnt lgkmcnt(3)
    ds_read_b64_tr_b16 a[172:173], v25 offset:57344
    v_lshlrev_b32 v240, 31, v240
    v_mfma_f32_16x16x32_bf16 a[64:67], a[164:167], v[164:167], a[64:67]
    ds_read_b64_tr_b16 a[174:175], v25 offset:61440
    v_mfma_f32_16x16x32_bf16 a[68:71], a[160:163], v[168:171], a[68:71]
    v_accvgpr_read_b32 v208, a32
    v_accvgpr_read_b32 v209, a33
    v_accvgpr_read_b32 v210, a34
    v_accvgpr_read_b32 v211, a35
    v_pk_mul_f32 v[208:209], v[208:209], v[58:59] op_sel:[0,0] op_sel_hi:[1,0]
    v_pk_mul_f32 v[210:211], v[210:211], v[58:59] op_sel:[0,0] op_sel_hi:[1,0]
    v_cvt_pk_bf16_f32 v144, v208, v209
    v_cvt_pk_bf16_f32 v145, v210, v211
    v_mfma_f32_16x16x32_bf16 a[68:71], a[164:167], v[172:175], a[68:71]
    v_accvgpr_read_b32 v212, a36
    v_accvgpr_read_b32 v213, a37
    v_accvgpr_read_b32 v214, a38
    v_accvgpr_read_b32 v215, a39
    v_pk_mul_f32 v[212:213], v[212:213], v[58:59] op_sel:[0,1] op_sel_hi:[1,1]
    v_pk_mul_f32 v[214:215], v[214:215], v[58:59] op_sel:[0,1] op_sel_hi:[1,1]
    v_cvt_pk_bf16_f32 v148, v212, v213
    v_cvt_pk_bf16_f32 v149, v214, v215
    v_mfma_f32_16x16x32_bf16 a[72:75], a[160:163], v[176:179], a[72:75]
    ds_read_b64_tr_b16 a[176:177], v26 offset:49152
    v_mov_b32 v241, 1
    v_mfma_f32_16x16x32_bf16 a[72:75], a[164:167], v[180:183], a[72:75]
    ds_read_b64_tr_b16 a[178:179], v26 offset:53248
    v_mfma_f32_16x16x32_bf16 a[76:79], a[160:163], v[184:187], a[76:79]
    v_accvgpr_read_b32 v208, a40
    v_accvgpr_read_b32 v209, a41
    v_accvgpr_read_b32 v210, a42
    v_accvgpr_read_b32 v211, a43
    v_pk_mul_f32 v[208:209], v[208:209], v[60:61] op_sel:[0,0] op_sel_hi:[1,0]
    v_pk_mul_f32 v[210:211], v[210:211], v[60:61] op_sel:[0,0] op_sel_hi:[1,0]
    v_cvt_pk_bf16_f32 v152, v208, v209
    v_cvt_pk_bf16_f32 v153, v210, v211
    v_mfma_f32_16x16x32_bf16 a[76:79], a[164:167], v[188:191], a[76:79]
    s_waitcnt lgkmcnt(4)
    buffer_load_dwordx4 v49, s[20:23], s49 offen offset:3072 lds
    v_accvgpr_read_b32 v212, a44
    v_accvgpr_read_b32 v213, a45
    v_accvgpr_read_b32 v214, a46
    v_accvgpr_read_b32 v215, a47
    v_pk_mul_f32 v[212:213], v[212:213], v[60:61] op_sel:[0,1] op_sel_hi:[1,1]
    v_pk_mul_f32 v[214:215], v[214:215], v[60:61] op_sel:[0,1] op_sel_hi:[1,1]
    v_cvt_pk_bf16_f32 v156, v212, v213
    v_cvt_pk_bf16_f32 v157, v214, v215
    v_mfma_f32_16x16x32_bf16 a[80:83], a[168:171], v[160:163], a[80:83]
    s_waitcnt lgkmcnt(2)
    ds_read_b64_tr_b16 a[180:181], v26 offset:57344
    v_mfma_f32_16x16x32_bf16 a[80:83], a[172:175], v[164:167], a[80:83]
    ds_read_b64_tr_b16 a[182:183], v26 offset:61440
    v_mfma_f32_16x16x32_bf16 a[84:87], a[168:171], v[168:171], a[84:87]
    v_accvgpr_read_b32 v208, a48
    v_accvgpr_read_b32 v209, a49
    v_accvgpr_read_b32 v210, a50
    v_accvgpr_read_b32 v211, a51
    v_pk_mul_f32 v[208:209], v[208:209], v[58:59] op_sel:[0,0] op_sel_hi:[1,0]
    v_pk_mul_f32 v[210:211], v[210:211], v[58:59] op_sel:[0,0] op_sel_hi:[1,0]
    v_cvt_pk_bf16_f32 v146, v208, v209
    v_cvt_pk_bf16_f32 v147, v210, v211
    s_add_u32 s37, s55, 0
    buffer_store_dwordx4 v[144:147], v252, s[28:31], s37 offen offset:1024
    v_mfma_f32_16x16x32_bf16 a[84:87], a[172:175], v[172:175], a[84:87]
    v_accvgpr_read_b32 v212, a52
    v_accvgpr_read_b32 v213, a53
    v_accvgpr_read_b32 v214, a54
    v_accvgpr_read_b32 v215, a55
    v_pk_mul_f32 v[212:213], v[212:213], v[58:59] op_sel:[0,1] op_sel_hi:[1,1]
    v_pk_mul_f32 v[214:215], v[214:215], v[58:59] op_sel:[0,1] op_sel_hi:[1,1]
    v_cvt_pk_bf16_f32 v150, v212, v213
    v_cvt_pk_bf16_f32 v151, v214, v215
    s_add_u32 s37, s55, 8192
    buffer_store_dwordx4 v[148:151], v252, s[28:31], s37 offen offset:1024
    s_waitcnt vmcnt(22)
    s_barrier
    v_mfma_f32_16x16x32_bf16 a[88:91], a[168:171], v[176:179], a[88:91]
    ds_read_b64_tr_b16 a[184:185], v27 offset:49152
    v_mfma_f32_16x16x32_bf16 a[88:91], a[172:175], v[180:183], a[88:91]
    ds_read_b64_tr_b16 a[186:187], v27 offset:53248
    v_mfma_f32_16x16x32_bf16 a[92:95], a[168:171], v[184:187], a[92:95]
    ds_read_b128 v[224:227], v228
    v_accvgpr_read_b32 v208, a56
    v_accvgpr_read_b32 v209, a57
    v_accvgpr_read_b32 v210, a58
    v_accvgpr_read_b32 v211, a59
    v_pk_mul_f32 v[208:209], v[208:209], v[60:61] op_sel:[0,0] op_sel_hi:[1,0]
    v_pk_mul_f32 v[210:211], v[210:211], v[60:61] op_sel:[0,0] op_sel_hi:[1,0]
    v_cvt_pk_bf16_f32 v154, v208, v209
    v_cvt_pk_bf16_f32 v155, v210, v211
    s_add_u32 s37, s55, 4096
    buffer_store_dwordx4 v[152:155], v252, s[28:31], s37 offen offset:1024
    v_mfma_f32_16x16x32_bf16 a[92:95], a[172:175], v[188:191], a[92:95]
    s_waitcnt lgkmcnt(5)
    v_accvgpr_read_b32 v212, a60
    v_accvgpr_read_b32 v213, a61
    v_accvgpr_read_b32 v214, a62
    v_accvgpr_read_b32 v215, a63
    v_pk_mul_f32 v[212:213], v[212:213], v[60:61] op_sel:[0,1] op_sel_hi:[1,1]
    v_pk_mul_f32 v[214:215], v[214:215], v[60:61] op_sel:[0,1] op_sel_hi:[1,1]
    v_cvt_pk_bf16_f32 v158, v212, v213
Ltour8:
    s_cbranch_execz Ltour12
    v_cvt_pk_bf16_f32 v159, v214, v215
    s_add_u32 s37, s55, 12288
    buffer_store_dwordx4 v[156:159], v252, s[28:31], s37 offen offset:1024
    s_add_u32 s49, s7, 73984
    v_mfma_f32_16x16x32_bf16 a[96:99], a[176:179], v[160:163], a[96:99]
    s_waitcnt lgkmcnt(3)
    s_add_u32 m0, s42, 49152
    ds_read_b64_tr_b16 a[188:189], v27 offset:57344
    v_mfma_f32_16x16x32_bf16 a[96:99], a[180:183], v[164:167], a[96:99]
    buffer_load_dwordx4 v46, s[20:23], s49 offen lds
    v_mfma_f32_16x16x32_bf16 a[100:103], a[176:179], v[168:171], a[100:103]
    ds_read_b64_tr_b16 a[190:191], v27 offset:61440
    v_accvgpr_read_b32 v208, a64
    v_accvgpr_read_b32 v209, a65
    v_accvgpr_read_b32 v210, a66
    v_accvgpr_read_b32 v211, a67
    v_pk_mul_f32 v[208:209], v[208:209], v[58:59] op_sel:[0,0] op_sel_hi:[1,0]
    v_pk_mul_f32 v[210:211], v[210:211], v[58:59] op_sel:[0,0] op_sel_hi:[1,0]
    v_cvt_pk_bf16_f32 v192, v208, v209
    v_cvt_pk_bf16_f32 v193, v210, v211
    v_mfma_f32_16x16x32_bf16 a[100:103], a[180:183], v[172:175], a[100:103]
    buffer_load_dwordx4 v47, s[20:23], s49 offen offset:1024 lds
    v_accvgpr_read_b32 v212, a68
    v_accvgpr_read_b32 v213, a69
    v_accvgpr_read_b32 v214, a70
    v_accvgpr_read_b32 v215, a71
    v_pk_mul_f32 v[212:213], v[212:213], v[58:59] op_sel:[0,1] op_sel_hi:[1,1]
    v_pk_mul_f32 v[214:215], v[214:215], v[58:59] op_sel:[0,1] op_sel_hi:[1,1]
    v_cvt_pk_bf16_f32 v196, v212, v213
    v_cvt_pk_bf16_f32 v197, v214, v215
    v_mfma_f32_16x16x32_bf16 a[104:107], a[176:179], v[176:179], a[104:107]
    v_mfma_f32_16x16x32_bf16 a[104:107], a[180:183], v[180:183], a[104:107]
    buffer_load_dwordx4 v48, s[20:23], s49 offen offset:2048 lds
    v_mfma_f32_16x16x32_bf16 a[108:111], a[176:179], v[184:187], a[108:111]
    v_accvgpr_read_b32 v208, a72
    v_accvgpr_read_b32 v209, a73
    v_accvgpr_read_b32 v210, a74
    v_accvgpr_read_b32 v211, a75
    v_pk_mul_f32 v[208:209], v[208:209], v[60:61] op_sel:[0,0] op_sel_hi:[1,0]
    v_pk_mul_f32 v[210:211], v[210:211], v[60:61] op_sel:[0,0] op_sel_hi:[1,0]
    v_cvt_pk_bf16_f32 v200, v208, v209
    v_cvt_pk_bf16_f32 v201, v210, v211
    v_mfma_f32_16x16x32_bf16 a[108:111], a[180:183], v[188:191], a[108:111]
    s_waitcnt lgkmcnt(3)
    buffer_load_dwordx4 v49, s[20:23], s49 offen offset:3072 lds
    v_accvgpr_read_b32 v212, a76
    v_accvgpr_read_b32 v213, a77
    v_accvgpr_read_b32 v214, a78
    v_accvgpr_read_b32 v215, a79
    v_pk_mul_f32 v[212:213], v[212:213], v[60:61] op_sel:[0,1] op_sel_hi:[1,1]
    v_pk_mul_f32 v[214:215], v[214:215], v[60:61] op_sel:[0,1] op_sel_hi:[1,1]
    v_cvt_pk_bf16_f32 v204, v212, v213
    v_cvt_pk_bf16_f32 v205, v214, v215
    s_add_u32 s49, s46, 0
    v_mfma_f32_16x16x32_bf16 a[112:115], a[184:187], v[160:163], a[112:115]
    s_waitcnt lgkmcnt(0)
    s_add_u32 m0, s42, 98304
    v_mfma_f32_16x16x32_bf16 a[112:115], a[188:191], v[164:167], a[112:115]
    buffer_load_dwordx4 v46, s[20:23], s49 offen lds
    v_mfma_f32_16x16x32_bf16 a[116:119], a[184:187], v[168:171], a[116:119]
    v_accvgpr_read_b32 v208, a80
    v_accvgpr_read_b32 v209, a81
    v_accvgpr_read_b32 v210, a82
    v_accvgpr_read_b32 v211, a83
    v_pk_mul_f32 v[208:209], v[208:209], v[58:59] op_sel:[0,0] op_sel_hi:[1,0]
    v_pk_mul_f32 v[210:211], v[210:211], v[58:59] op_sel:[0,0] op_sel_hi:[1,0]
    v_cvt_pk_bf16_f32 v194, v208, v209
    v_cvt_pk_bf16_f32 v195, v210, v211
    s_add_u32 s37, s55, 0
    buffer_store_dwordx4 v[192:195], v252, s[28:31], s37 offen offset:2048
    v_mfma_f32_16x16x32_bf16 a[116:119], a[188:191], v[172:175], a[116:119]
    buffer_load_dwordx4 v47, s[20:23], s49 offen offset:1024 lds
    v_accvgpr_read_b32 v212, a84
    v_accvgpr_read_b32 v213, a85
    v_accvgpr_read_b32 v214, a86
    v_accvgpr_read_b32 v215, a87
    v_pk_mul_f32 v[212:213], v[212:213], v[58:59] op_sel:[0,1] op_sel_hi:[1,1]
    v_pk_mul_f32 v[214:215], v[214:215], v[58:59] op_sel:[0,1] op_sel_hi:[1,1]
    v_cvt_pk_bf16_f32 v198, v212, v213
    v_cvt_pk_bf16_f32 v199, v214, v215
    s_add_u32 s37, s55, 8192
    buffer_store_dwordx4 v[196:199], v252, s[28:31], s37 offen offset:2048
    v_mfma_f32_16x16x32_bf16 a[120:123], a[184:187], v[176:179], a[120:123]
    v_mfma_f32_16x16x32_bf16 a[120:123], a[188:191], v[180:183], a[120:123]
    buffer_load_dwordx4 v48, s[20:23], s49 offen offset:2048 lds
    v_mfma_f32_16x16x32_bf16 a[124:127], a[184:187], v[184:187], a[124:127]
    v_accvgpr_read_b32 v208, a88
    v_accvgpr_read_b32 v209, a89
    v_accvgpr_read_b32 v210, a90
    v_accvgpr_read_b32 v211, a91
    v_pk_mul_f32 v[208:209], v[208:209], v[60:61] op_sel:[0,0] op_sel_hi:[1,0]
    v_pk_mul_f32 v[210:211], v[210:211], v[60:61] op_sel:[0,0] op_sel_hi:[1,0]
    v_cvt_pk_bf16_f32 v202, v208, v209
    v_cvt_pk_bf16_f32 v203, v210, v211
    s_add_u32 s37, s55, 4096
    buffer_store_dwordx4 v[200:203], v252, s[28:31], s37 offen offset:2048
    v_mfma_f32_16x16x32_bf16 a[124:127], a[188:191], v[188:191], a[124:127]
    buffer_load_dwordx4 v49, s[20:23], s49 offen offset:3072 lds
    v_accvgpr_read_b32 v212, a92
    v_accvgpr_read_b32 v213, a93
    v_accvgpr_read_b32 v214, a94
    v_accvgpr_read_b32 v215, a95
    v_pk_mul_f32 v[212:213], v[212:213], v[60:61] op_sel:[0,1] op_sel_hi:[1,1]
    v_pk_mul_f32 v[214:215], v[214:215], v[60:61] op_sel:[0,1] op_sel_hi:[1,1]
    v_cvt_pk_bf16_f32 v206, v212, v213
    v_cvt_pk_bf16_f32 v207, v214, v215
    s_add_u32 s37, s55, 12288
    buffer_store_dwordx4 v[204:207], v252, s[28:31], s37 offen offset:2048
    v_or3_b32 v224, v224, v225, v226
    v_or_b32 v224, v224, v227
    s_nop 0
    v_readfirstlane_b32 s36, v224
    v_readfirstlane_b32 s38, v253
    v_min_u32 v8, 1, v1
    v_lshlrev_b32 v8, 31, v8
    v_mov_b32 v10, s95
    s_getreg_b32 s39, hwreg(HW_REG_XCC_ID, 0, 4)
    s_add_u32 s39, s39, s95
    s_cmp_eq_u32 s38, s39
    s_cselect_b32 s53, 1, 0
    ds_read_b64_tr_b16 a[208:209], v12 offset:0
    ds_read_b64_tr_b16 a[210:211], v12 offset:4096
    ds_read_b64_tr_b16 a[212:213], v12 offset:8192
    ds_read_b64_tr_b16 a[214:215], v12 offset:12288
    ds_read_b64_tr_b16 a[216:217], v12 offset:16384
    ds_read_b64_tr_b16 a[218:219], v12 offset:20480
    ds_read_b64_tr_b16 a[220:221], v12 offset:24576
    ds_read_b64_tr_b16 a[222:223], v12 offset:28672
    ds_read_b64_tr_b16 a[224:225], v16 offset:0
    ds_read_b64_tr_b16 a[226:227], v16 offset:4096
    ds_read_b64_tr_b16 a[228:229], v16 offset:8192
    ds_read_b64_tr_b16 a[230:231], v16 offset:12288
    ds_read_b64_tr_b16 a[232:233], v16 offset:16384
    ds_read_b64_tr_b16 a[234:235], v16 offset:20480
    ds_read_b64_tr_b16 a[236:237], v16 offset:24576
    ds_read_b64_tr_b16 a[238:239], v16 offset:28672
    s_andn2_b32 s36, s36, s48
    s_cbranch_scc1 Lattn_redo
    v_accvgpr_read_b32 v208, a96
    v_accvgpr_read_b32 v209, a97
    v_accvgpr_read_b32 v210, a98
    v_accvgpr_read_b32 v211, a99
    v_pk_mul_f32 v[208:209], v[208:209], v[58:59] op_sel:[0,0] op_sel_hi:[1,0]
    v_pk_mul_f32 v[210:211], v[210:211], v[58:59] op_sel:[0,0] op_sel_hi:[1,0]
    v_cvt_pk_bf16_f32 v176, v208, v209
    v_cvt_pk_bf16_f32 v177, v210, v211
    v_accvgpr_read_b32 v212, a100
    v_accvgpr_read_b32 v213, a101
    v_accvgpr_read_b32 v214, a102
    v_accvgpr_read_b32 v215, a103
    v_pk_mul_f32 v[212:213], v[212:213], v[58:59] op_sel:[0,1] op_sel_hi:[1,1]
    v_pk_mul_f32 v[214:215], v[214:215], v[58:59] op_sel:[0,1] op_sel_hi:[1,1]
    v_cvt_pk_bf16_f32 v180, v212, v213
    v_cvt_pk_bf16_f32 v181, v214, v215
    v_accvgpr_read_b32 v208, a104
    v_accvgpr_read_b32 v209, a105
    v_accvgpr_read_b32 v210, a106
    v_accvgpr_read_b32 v211, a107
    v_pk_mul_f32 v[208:209], v[208:209], v[60:61] op_sel:[0,0] op_sel_hi:[1,0]
    v_pk_mul_f32 v[210:211], v[210:211], v[60:61] op_sel:[0,0] op_sel_hi:[1,0]
    v_cvt_pk_bf16_f32 v184, v208, v209
    v_cvt_pk_bf16_f32 v185, v210, v211
    v_accvgpr_read_b32 v212, a108
    v_accvgpr_read_b32 v213, a109
    v_accvgpr_read_b32 v214, a110
    v_accvgpr_read_b32 v215, a111
    v_pk_mul_f32 v[212:213], v[212:213], v[60:61] op_sel:[0,1] op_sel_hi:[1,1]
    v_pk_mul_f32 v[214:215], v[214:215], v[60:61] op_sel:[0,1] op_sel_hi:[1,1]
    v_cvt_pk_bf16_f32 v188, v212, v213
    v_cvt_pk_bf16_f32 v189, v214, v215
    v_accvgpr_read_b32 v208, a112
    v_accvgpr_read_b32 v209, a113
    v_accvgpr_read_b32 v210, a114
    v_accvgpr_read_b32 v211, a115
    v_pk_mul_f32 v[208:209], v[208:209], v[58:59] op_sel:[0,0] op_sel_hi:[1,0]
    v_pk_mul_f32 v[210:211], v[210:211], v[58:59] op_sel:[0,0] op_sel_hi:[1,0]
    v_cvt_pk_bf16_f32 v178, v208, v209
    v_cvt_pk_bf16_f32 v179, v210, v211
    s_add_u32 s37, s55, 0
    buffer_store_dwordx4 v[176:179], v252, s[28:31], s37 offen offset:3072
    v_accvgpr_read_b32 v212, a116
    v_accvgpr_read_b32 v213, a117
    v_accvgpr_read_b32 v214, a118
    v_accvgpr_read_b32 v215, a119
    v_pk_mul_f32 v[212:213], v[212:213], v[58:59] op_sel:[0,1] op_sel_hi:[1,1]
    v_pk_mul_f32 v[214:215], v[214:215], v[58:59] op_sel:[0,1] op_sel_hi:[1,1]
    v_cvt_pk_bf16_f32 v182, v212, v213
    v_cvt_pk_bf16_f32 v183, v214, v215
    s_add_u32 s37, s55, 8192
    buffer_store_dwordx4 v[180:183], v252, s[28:31], s37 offen offset:3072
    v_accvgpr_read_b32 v208, a120
    v_accvgpr_read_b32 v209, a121
    v_accvgpr_read_b32 v210, a122
    v_accvgpr_read_b32 v211, a123
    v_pk_mul_f32 v[208:209], v[208:209], v[60:61] op_sel:[0,0] op_sel_hi:[1,0]
    v_pk_mul_f32 v[210:211], v[210:211], v[60:61] op_sel:[0,0] op_sel_hi:[1,0]
    v_cvt_pk_bf16_f32 v186, v208, v209
    v_cvt_pk_bf16_f32 v187, v210, v211
    s_add_u32 s37, s55, 4096
    buffer_store_dwordx4 v[184:187], v252, s[28:31], s37 offen offset:3072
    v_accvgpr_read_b32 v212, a124
    v_accvgpr_read_b32 v213, a125
    v_accvgpr_read_b32 v214, a126
    v_accvgpr_read_b32 v215, a127
    v_pk_mul_f32 v[212:213], v[212:213], v[60:61] op_sel:[0,1] op_sel_hi:[1,1]
    v_pk_mul_f32 v[214:215], v[214:215], v[60:61] op_sel:[0,1] op_sel_hi:[1,1]
    v_cvt_pk_bf16_f32 v190, v212, v213
    v_cvt_pk_bf16_f32 v191, v214, v215
    s_add_u32 s37, s55, 12288
    buffer_store_dwordx4 v[188:191], v252, s[28:31], s37 offen offset:3072
    s_waitcnt lgkmcnt(14)
    v_mfma_f32_16x16x32_bf16 v[96:99], a[208:211], v[128:131], 0
    s_waitcnt lgkmcnt(12)
    ds_read_b64_tr_b16 a[160:161], v13 offset:0
    v_mfma_f32_16x16x32_bf16 v[96:99], a[212:215], v[144:147], v[96:99]
    s_waitcnt lgkmcnt(11)
    ds_read_b64_tr_b16 a[162:163], v13 offset:4096
    v_mfma_f32_16x16x32_bf16 v[96:99], a[216:219], v[192:195], v[96:99]
    s_waitcnt lgkmcnt(10)
    ds_read_b64_tr_b16 a[164:165], v13 offset:8192
    v_mfma_f32_16x16x32_bf16 v[96:99], a[220:223], v[176:179], v[96:99]
    s_waitcnt lgkmcnt(9)
    ds_read_b64_tr_b16 a[166:167], v13 offset:12288
    v_mfma_f32_16x16x32_bf16 v[96:99], a[224:227], v[136:139], v[96:99]
    s_waitcnt lgkmcnt(8)
    ds_read_b64_tr_b16 a[168:169], v13 offset:16384
    v_mfma_f32_16x16x32_bf16 v[96:99], a[228:231], v[152:155], v[96:99]
    s_waitcnt lgkmcnt(7)
    ds_read_b64_tr_b16 a[170:171], v13 offset:20480
    v_mfma_f32_16x16x32_bf16 v[96:99], a[232:235], v[200:203], v[96:99]
    s_waitcnt lgkmcnt(6)
    ds_read_b64_tr_b16 a[172:173], v13 offset:24576
    v_mfma_f32_16x16x32_bf16 v[96:99], a[236:239], v[184:187], v[96:99]
    ds_read_b64_tr_b16 a[174:175], v13 offset:28672
    v_mfma_f32_16x16x32_bf16 v[100:103], a[208:211], v[132:135], 0
    ds_read_b64_tr_b16 a[176:177], v17 offset:0
    v_mfma_f32_16x16x32_bf16 v[100:103], a[212:215], v[148:151], v[100:103]
    ds_read_b64_tr_b16 a[178:179], v17 offset:4096
    v_mfma_f32_16x16x32_bf16 v[100:103], a[216:219], v[196:199], v[100:103]
    ds_read_b64_tr_b16 a[180:181], v17 offset:8192
    v_mfma_f32_16x16x32_bf16 v[100:103], a[220:223], v[180:183], v[100:103]
    ds_read_b64_tr_b16 a[182:183], v17 offset:12288
    v_mfma_f32_16x16x32_bf16 v[100:103], a[224:227], v[140:143], v[100:103]
    ds_read_b64_tr_b16 a[184:185], v17 offset:16384
    v_cvt_pk_bf16_f32 v224, v96, v97
    v_mfma_f32_16x16x32_bf16 v[100:103], a[228:231], v[156:159], v[100:103]
    ds_read_b64_tr_b16 a[186:187], v17 offset:20480
    v_cvt_pk_bf16_f32 v225, v98, v99
    v_mfma_f32_16x16x32_bf16 v[100:103], a[232:235], v[204:207], v[100:103]
    ds_read_b64_tr_b16 a[188:189], v17 offset:24576
    v_mfma_f32_16x16x32_bf16 v[100:103], a[236:239], v[188:191], v[100:103]
    s_waitcnt lgkmcnt(13)
    ds_read_b64_tr_b16 a[190:191], v17 offset:28672
    v_mfma_f32_16x16x32_bf16 v[104:107], a[160:163], v[128:131], 0
    s_waitcnt lgkmcnt(12)
    ds_read_b64_tr_b16 a[208:209], v14 offset:0
    v_mfma_f32_16x16x32_bf16 v[104:107], a[164:167], v[144:147], v[104:107]
    s_waitcnt lgkmcnt(11)
    ds_read_b64_tr_b16 a[210:211], v14 offset:4096
    v_mfma_f32_16x16x32_bf16 v[104:107], a[168:171], v[192:195], v[104:107]
    s_waitcnt lgkmcnt(10)
    ds_read_b64_tr_b16 a[212:213], v14 offset:8192
    v_mfma_f32_16x16x32_bf16 v[104:107], a[172:175], v[176:179], v[104:107]
    s_waitcnt lgkmcnt(9)
    ds_read_b64_tr_b16 a[214:215], v14 offset:12288
    v_mfma_f32_16x16x32_bf16 v[104:107], a[176:179], v[136:139], v[104:107]
    s_waitcnt lgkmcnt(8)
    ds_read_b64_tr_b16 a[216:217], v14 offset:16384
    v_cvt_pk_bf16_f32 v228, v100, v101
    v_mfma_f32_16x16x32_bf16 v[104:107], a[180:183], v[152:155], v[104:107]
    s_waitcnt lgkmcnt(7)
    ds_read_b64_tr_b16 a[218:219], v14 offset:20480
    v_cvt_pk_bf16_f32 v229, v102, v103
    v_mfma_f32_16x16x32_bf16 v[104:107], a[184:187], v[200:203], v[104:107]
    s_waitcnt lgkmcnt(6)
    ds_read_b64_tr_b16 a[220:221], v14 offset:24576
    v_mfma_f32_16x16x32_bf16 v[104:107], a[188:191], v[184:187], v[104:107]
    ds_read_b64_tr_b16 a[222:223], v14 offset:28672
    s_waitcnt vmcnt(0)
    s_cmp_eq_u32 s53, 0
    s_cbranch_scc1 Lattn_wb
Lattn_wbdone:
    v_mfma_f32_16x16x32_bf16 v[108:111], a[160:163], v[132:135], 0
    buffer_store_dword v10, v8, s[24:27], s92 offen offset:8 sc1
    v_mfma_f32_16x16x32_bf16 v[108:111], a[164:167], v[148:151], v[108:111]
    s_xor_b32 s55, s55, 65536
    ds_read_b64_tr_b16 a[224:225], v18 offset:0
    ds_read_b64_tr_b16 a[226:227], v18 offset:4096
    v_mfma_f32_16x16x32_bf16 v[108:111], a[168:171], v[196:199], v[108:111]
    buffer_atomic_add v241, v240, s[88:91], 0 offen sc1
    v_mfma_f32_16x16x32_bf16 v[108:111], a[172:175], v[180:183], v[108:111]
    ds_read_b64_tr_b16 a[228:229], v18 offset:8192
    ds_read_b64_tr_b16 a[230:231], v18 offset:12288
    s_load_dwordx2 s[12:13], s[0:1], 0
    v_mfma_f32_16x16x32_bf16 v[108:111], a[176:179], v[140:143], v[108:111]
    ds_read_b64_tr_b16 a[232:233], v18 offset:16384
    v_cvt_pk_bf16_f32 v226, v104, v105
    v_mfma_f32_16x16x32_bf16 v[108:111], a[180:183], v[156:159], v[108:111]
    s_add_u32 s38, s56, 16384
    ds_read_b64_tr_b16 a[234:235], v18 offset:20480
    v_cvt_pk_bf16_f32 v227, v106, v107
    s_load_dwordx2 s[16:17], s[0:1], 96
    v_mfma_f32_16x16x32_bf16 v[108:111], a[184:187], v[204:207], v[108:111]
    buffer_store_dwordx4 v[224:227], v56, s[28:31], s38 offen sc1
    v_mfma_f32_16x16x32_bf16 v[108:111], a[188:191], v[188:191], v[108:111]
    s_waitcnt lgkmcnt(12)
    ds_read_b64_tr_b16 a[236:237], v18 offset:24576
    ds_read_b64_tr_b16 a[238:239], v18 offset:28672
    s_load_dwordx2 s[52:53], s[0:1], 48
    v_mfma_f32_16x16x32_bf16 v[112:115], a[208:211], v[128:131], 0
    s_waitcnt lgkmcnt(12)
    ds_read_b64_tr_b16 a[160:161], v15 offset:0
    v_mfma_f32_16x16x32_bf16 v[112:115], a[212:215], v[144:147], v[112:115]
    s_waitcnt lgkmcnt(11)
    ds_read_b64_tr_b16 a[162:163], v15 offset:4096
    v_mfma_f32_16x16x32_bf16 v[112:115], a[216:219], v[192:195], v[112:115]
    s_waitcnt lgkmcnt(10)
    ds_read_b64_tr_b16 a[164:165], v15 offset:8192
    v_mfma_f32_16x16x32_bf16 v[112:115], a[220:223], v[176:179], v[112:115]
    s_waitcnt lgkmcnt(9)
    ds_read_b64_tr_b16 a[166:167], v15 offset:12288
    v_mfma_f32_16x16x32_bf16 v[112:115], a[224:227], v[136:139], v[112:115]
    s_waitcnt lgkmcnt(8)
    ds_read_b64_tr_b16 a[168:169], v15 offset:16384
    v_cvt_pk_bf16_f32 v230, v108, v109
    v_mfma_f32_16x16x32_bf16 v[112:115], a[228:231], v[152:155], v[112:115]
    s_waitcnt lgkmcnt(7)
    s_add_u32 s38, s56, 180224
    ds_read_b64_tr_b16 a[170:171], v15 offset:20480
    v_cvt_pk_bf16_f32 v231, v110, v111
    v_mfma_f32_16x16x32_bf16 v[112:115], a[232:235], v[200:203], v[112:115]
    s_waitcnt lgkmcnt(6)
    buffer_store_dwordx4 v[228:231], v56, s[28:31], s38 offen sc1
    v_mfma_f32_16x16x32_bf16 v[112:115], a[236:239], v[184:187], v[112:115]
    ds_read_b64_tr_b16 a[172:173], v15 offset:24576
    ds_read_b64_tr_b16 a[174:175], v15 offset:28672
    v_mfma_f32_16x16x32_bf16 v[116:119], a[208:211], v[132:135], 0
    ds_read_b64_tr_b16 a[176:177], v19 offset:0
    v_mfma_f32_16x16x32_bf16 v[116:119], a[212:215], v[148:151], v[116:119]
    ds_read_b64_tr_b16 a[178:179], v19 offset:4096
    v_mfma_f32_16x16x32_bf16 v[116:119], a[216:219], v[196:199], v[116:119]
    ds_read_b64_tr_b16 a[180:181], v19 offset:8192
    v_mfma_f32_16x16x32_bf16 v[116:119], a[220:223], v[180:183], v[116:119]
    ds_read_b64_tr_b16 a[182:183], v19 offset:12288
    v_mfma_f32_16x16x32_bf16 v[116:119], a[224:227], v[140:143], v[116:119]
    ds_read_b64_tr_b16 a[184:185], v19 offset:16384
    v_cvt_pk_bf16_f32 v232, v112, v113
    v_mfma_f32_16x16x32_bf16 v[116:119], a[228:231], v[156:159], v[116:119]
    ds_read_b64_tr_b16 a[186:187], v19 offset:20480
    v_cvt_pk_bf16_f32 v233, v114, v115
    v_mfma_f32_16x16x32_bf16 v[116:119], a[232:235], v[204:207], v[116:119]
    ds_read_b64_tr_b16 a[188:189], v19 offset:24576
    v_mfma_f32_16x16x32_bf16 v[116:119], a[236:239], v[188:191], v[116:119]
    s_waitcnt lgkmcnt(13)
    ds_read_b64_tr_b16 a[190:191], v19 offset:28672
    s_barrier
    v_mfma_f32_16x16x32_bf16 v[120:123], a[160:163], v[128:131], 0
    s_waitcnt lgkmcnt(12)
    buffer_load_dword v11, v8, s[24:27], s54 offen offset:8 sc1
    v_mfma_f32_16x16x32_bf16 v[120:123], a[164:167], v[144:147], v[120:123]
    s_waitcnt lgkmcnt(10)
    ds_read_b64_tr_b16 a[208:209], v20 offset:0
    ds_read_b64_tr_b16 a[210:211], v20 offset:4096
    v_mfma_f32_16x16x32_bf16 v[120:123], a[168:171], v[192:195], v[120:123]
    s_waitcnt lgkmcnt(10)
    ds_read_b64_tr_b16 a[212:213], v20 offset:8192
    v_mfma_f32_16x16x32_bf16 v[120:123], a[172:175], v[176:179], v[120:123]
    s_waitcnt lgkmcnt(9)
    ds_read_b64_tr_b16 a[214:215], v20 offset:12288
    v_mfma_f32_16x16x32_bf16 v[120:123], a[176:179], v[136:139], v[120:123]
    s_waitcnt lgkmcnt(8)
    ds_read_b64_tr_b16 a[216:217], v20 offset:16384
    v_cvt_pk_bf16_f32 v236, v116, v117
    v_mfma_f32_16x16x32_bf16 v[120:123], a[180:183], v[152:155], v[120:123]
    s_waitcnt lgkmcnt(7)
    ds_read_b64_tr_b16 a[218:219], v20 offset:20480
    v_cvt_pk_bf16_f32 v237, v118, v119
    v_mfma_f32_16x16x32_bf16 v[120:123], a[184:187], v[200:203], v[120:123]
    s_waitcnt lgkmcnt(6)
    s_add_u32 s49, s46, 73728
    ds_read_b64_tr_b16 a[220:221], v20 offset:24576
    v_mfma_f32_16x16x32_bf16 v[120:123], a[188:191], v[184:187], v[120:123]
    s_add_u32 m0, s42, 114688
    ds_read_b64_tr_b16 a[222:223], v20 offset:28672
    v_mfma_f32_16x16x32_bf16 v[124:127], a[160:163], v[132:135], 0
    buffer_load_dwordx4 v46, s[20:23], s49 offen lds
    v_mfma_f32_16x16x32_bf16 v[124:127], a[164:167], v[148:151], v[124:127]
    ds_read_b64_tr_b16 a[224:225], v24 offset:0
    ds_read_b64_tr_b16 a[226:227], v24 offset:4096
    v_mfma_f32_16x16x32_bf16 v[124:127], a[168:171], v[196:199], v[124:127]
    buffer_load_dwordx4 v47, s[20:23], s49 offen offset:1024 lds
    v_mfma_f32_16x16x32_bf16 v[124:127], a[172:175], v[180:183], v[124:127]
    ds_read_b64_tr_b16 a[228:229], v24 offset:8192
    ds_read_b64_tr_b16 a[230:231], v24 offset:12288
    v_mfma_f32_16x16x32_bf16 v[124:127], a[176:179], v[140:143], v[124:127]
    ds_read_b64_tr_b16 a[232:233], v24 offset:16384
    v_cvt_pk_bf16_f32 v234, v120, v121
    v_mfma_f32_16x16x32_bf16 v[124:127], a[180:183], v[156:159], v[124:127]
    s_add_u32 s38, s56, 16512
    ds_read_b64_tr_b16 a[234:235], v24 offset:20480
    v_cvt_pk_bf16_f32 v235, v122, v123
    v_mfma_f32_16x16x32_bf16 v[124:127], a[184:187], v[204:207], v[124:127]
    buffer_store_dwordx4 v[232:235], v56, s[28:31], s38 offen sc1
    v_mfma_f32_16x16x32_bf16 v[124:127], a[188:191], v[188:191], v[124:127]
    s_waitcnt lgkmcnt(12)
    ds_read_b64_tr_b16 a[236:237], v24 offset:24576
    ds_read_b64_tr_b16 a[238:239], v24 offset:28672
    v_mfma_f32_16x16x32_bf16 v[64:67], a[208:211], v[128:131], 0
    s_waitcnt lgkmcnt(12)
    buffer_load_dwordx4 v48, s[20:23], s49 offen offset:2048 lds
    v_mfma_f32_16x16x32_bf16 v[64:67], a[212:215], v[144:147], v[64:67]
    s_waitcnt lgkmcnt(10)
    ds_read_b64_tr_b16 a[160:161], v21 offset:0
    ds_read_b64_tr_b16 a[162:163], v21 offset:4096
    v_mfma_f32_16x16x32_bf16 v[64:67], a[216:219], v[192:195], v[64:67]
    s_waitcnt lgkmcnt(10)
    buffer_load_dwordx4 v49, s[20:23], s49 offen offset:3072 lds
    v_mfma_f32_16x16x32_bf16 v[64:67], a[220:223], v[176:179], v[64:67]
    s_waitcnt lgkmcnt(8)
    ds_read_b64_tr_b16 a[164:165], v21 offset:8192
    ds_read_b64_tr_b16 a[166:167], v21 offset:12288
    v_mfma_f32_16x16x32_bf16 v[64:67], a[224:227], v[136:139], v[64:67]
    s_waitcnt lgkmcnt(8)
    ds_read_b64_tr_b16 a[168:169], v21 offset:16384
    v_cvt_pk_bf16_f32 v238, v124, v125
    v_mfma_f32_16x16x32_bf16 v[64:67], a[228:231], v[152:155], v[64:67]
    s_waitcnt lgkmcnt(7)
    s_add_u32 s38, s56, 180352
    ds_read_b64_tr_b16 a[170:171], v21 offset:20480
    v_cvt_pk_bf16_f32 v239, v126, v127
    v_mfma_f32_16x16x32_bf16 v[64:67], a[232:235], v[200:203], v[64:67]
    s_waitcnt lgkmcnt(6)
    buffer_store_dwordx4 v[236:239], v56, s[28:31], s38 offen sc1
    v_mfma_f32_16x16x32_bf16 v[64:67], a[236:239], v[184:187], v[64:67]
    ds_read_b64_tr_b16 a[172:173], v21 offset:24576
    ds_read_b64_tr_b16 a[174:175], v21 offset:28672
    v_mfma_f32_16x16x32_bf16 v[68:71], a[208:211], v[132:135], 0
    s_lshl_b32 s40, s5, 4
    ds_read_b64_tr_b16 a[176:177], v25 offset:0
    v_mfma_f32_16x16x32_bf16 v[68:71], a[212:215], v[148:151], v[68:71]
    s_add_u32 s40, s40, s4
    ds_read_b64_tr_b16 a[178:179], v25 offset:4096
    v_and_b32 v240, 31, v1
    v_mfma_f32_16x16x32_bf16 v[68:71], a[216:219], v[196:199], v[68:71]
    ds_read_b64_tr_b16 a[180:181], v25 offset:8192
    v_lshrrev_b32 v241, 5, v1
    v_mfma_f32_16x16x32_bf16 v[68:71], a[220:223], v[180:183], v[68:71]
    ds_read_b64_tr_b16 a[182:183], v25 offset:12288
    v_cmp_gt_u32 vcc, 8, v240
    v_mfma_f32_16x16x32_bf16 v[68:71], a[224:227], v[140:143], v[68:71]
    ds_read_b64_tr_b16 a[184:185], v25 offset:16384
    v_mov_b32 v242, 2147483648
    v_mfma_f32_16x16x32_bf16 v[68:71], a[228:231], v[156:159], v[68:71]
    s_lshl_b32 s43, s40, 3
    ds_read_b64_tr_b16 a[186:187], v25 offset:20480
    v_mfma_f32_16x16x32_bf16 v[68:71], a[232:235], v[204:207], v[68:71]
    s_lshl_b32 s44, s3, 1
    ds_read_b64_tr_b16 a[188:189], v25 offset:24576
    v_mfma_f32_16x16x32_bf16 v[68:71], a[236:239], v[188:191], v[68:71]
    s_waitcnt lgkmcnt(13)
    s_add_u32 s43, s43, s44
    ds_read_b64_tr_b16 a[190:191], v25 offset:28672
    v_cndmask_b32 v242, v242, 0, vcc
    v_mfma_f32_16x16x32_bf16 v[72:75], a[160:163], v[128:131], 0
    s_waitcnt lgkmcnt(12)
    ds_read_b64_tr_b16 a[208:209], v22 offset:0
    v_add_u32 v7, s43, v241
    v_mfma_f32_16x16x32_bf16 v[72:75], a[164:167], v[144:147], v[72:75]
    s_waitcnt lgkmcnt(11)
    ds_read_b64_tr_b16 a[210:211], v22 offset:4096
    v_lshlrev_b32 v5, 4, v240
    v_mfma_f32_16x16x32_bf16 v[72:75], a[168:171], v[192:195], v[72:75]
    s_waitcnt lgkmcnt(10)
    ds_read_b64_tr_b16 a[212:213], v22 offset:8192
    v_lshlrev_b32 v243, 4, v241
    v_mfma_f32_16x16x32_bf16 v[72:75], a[172:175], v[176:179], v[72:75]
    s_waitcnt lgkmcnt(9)
    ds_read_b64_tr_b16 a[214:215], v22 offset:12288
    v_lshl_add_u32 v2, v240, 5, v243
    v_mfma_f32_16x16x32_bf16 v[72:75], a[176:179], v[136:139], v[72:75]
    s_waitcnt lgkmcnt(8)
    ds_read_b64_tr_b16 a[216:217], v22 offset:16384
    v_lshrrev_b32 v243, 4, v240
    v_mfma_f32_16x16x32_bf16 v[72:75], a[180:183], v[152:155], v[72:75]
    s_waitcnt lgkmcnt(7)
    ds_read_b64_tr_b16 a[218:219], v22 offset:20480
    v_mul_u32_u24 v243, 1536, v243
    v_mfma_f32_16x16x32_bf16 v[72:75], a[184:187], v[200:203], v[72:75]
    s_waitcnt lgkmcnt(6)
    ds_read_b64_tr_b16 a[220:221], v22 offset:24576
    v_add_u32 v2, v2, v243
    v_mfma_f32_16x16x32_bf16 v[72:75], a[188:191], v[184:187], v[72:75]
    s_mul_i32 s44, s43, 10240
    ds_read_b64_tr_b16 a[222:223], v22 offset:28672
    v_lshrrev_b32 v243, 2, v240
    v_mfma_f32_16x16x32_bf16 v[76:79], a[160:163], v[132:135], 0
    ds_read_b64_tr_b16 a[224:225], v26 offset:0
    v_lshlrev_b32 v243, 6, v243
    v_mfma_f32_16x16x32_bf16 v[76:79], a[164:167], v[148:151], v[76:79]
    ds_read_b64_tr_b16 a[226:227], v26 offset:4096
    v_and_b32 v241, 3, v240
    v_mfma_f32_16x16x32_bf16 v[76:79], a[168:171], v[196:199], v[76:79]
    ds_read_b64_tr_b16 a[228:229], v26 offset:8192
    v_lshl_add_u32 v3, v241, 3, v243
    v_mfma_f32_16x16x32_bf16 v[76:79], a[172:175], v[180:183], v[76:79]
    ds_read_b64_tr_b16 a[230:231], v26 offset:12288
    v_mul_u32_u24 v243, 1152, v7
    v_mfma_f32_16x16x32_bf16 v[76:79], a[176:179], v[140:143], v[76:79]
    ds_read_b64_tr_b16 a[232:233], v26 offset:16384
    v_add_u32 v4, v243, v3
    v_mfma_f32_16x16x32_bf16 v[76:79], a[180:183], v[156:159], v[76:79]
    ds_read_b64_tr_b16 a[234:235], v26 offset:20480
    v_lshl_add_u32 v6, v243, 1, v5
    v_mfma_f32_16x16x32_bf16 v[76:79], a[184:187], v[204:207], v[76:79]
    ds_read_b64_tr_b16 a[236:237], v26 offset:24576
    v_or_b32 v55, v3, v242
    v_mfma_f32_16x16x32_bf16 v[76:79], a[188:191], v[188:191], v[76:79]
    s_waitcnt lgkmcnt(13)
    ds_read_b64_tr_b16 a[238:239], v26 offset:28672
    v_or_b32 v58, v4, v242
    v_mfma_f32_16x16x32_bf16 v[80:83], a[208:211], v[128:131], 0
    s_waitcnt lgkmcnt(12)
    ds_read_b64_tr_b16 a[160:161], v23 offset:0
    v_or_b32 v59, v5, v242
    v_mfma_f32_16x16x32_bf16 v[80:83], a[212:215], v[144:147], v[80:83]
    s_waitcnt lgkmcnt(11)
    ds_read_b64_tr_b16 a[162:163], v23 offset:4096
    v_or_b32 v60, v6, v242
    v_mfma_f32_16x16x32_bf16 v[80:83], a[216:219], v[192:195], v[80:83]
    s_waitcnt lgkmcnt(10)
    ds_read_b64_tr_b16 a[164:165], v23 offset:8192
    s_waitcnt vmcnt(6)
    v_readfirstlane_b32 s36, v11
    v_mfma_f32_16x16x32_bf16 v[80:83], a[220:223], v[176:179], v[80:83]
    s_waitcnt lgkmcnt(9)
    ds_read_b64_tr_b16 a[166:167], v23 offset:12288
    v_lshrrev_b32 v243, 4, v1
    v_mfma_f32_16x16x32_bf16 v[80:83], a[224:227], v[136:139], v[80:83]
    ds_read_b64_tr_b16 a[168:169], v23 offset:16384
    v_lshlrev_b32 v243, 8, v243
    s_cmp_lg_u32 s36, s95
    s_cbranch_scc1 Lattn_xspin
Lattn_xgot:
    s_waitcnt lgkmcnt(9)
    v_mfma_f32_16x16x32_bf16 v[80:83], a[228:231], v[152:155], v[80:83]
    s_waitcnt lgkmcnt(7)
    ds_read_b64_tr_b16 a[170:171], v23 offset:20480
    v_and_b32 v241, 7, v1
    v_mfma_f32_16x16x32_bf16 v[80:83], a[232:235], v[200:203], v[80:83]
    s_waitcnt lgkmcnt(6)
    ds_read_b64_tr_b16 a[172:173], v23 offset:24576
    v_lshl_add_u32 v243, v241, 5, v243
    v_mfma_f32_16x16x32_bf16 v[80:83], a[236:239], v[184:187], v[80:83]
    s_add_u32 s37, s55, 0
    ds_read_b64_tr_b16 a[174:175], v23 offset:28672
    v_and_b32 v241, 8, v1
    v_mfma_f32_16x16x32_bf16 v[84:87], a[208:211], v[132:135], 0
    buffer_load_dwordx4 a[64:67], v252, s[28:31], s37 offen offset:0 sc1
    v_mfma_f32_16x16x32_bf16 v[84:87], a[212:215], v[148:151], v[84:87]
    ds_read_b64_tr_b16 a[176:177], v27 offset:0
    ds_read_b64_tr_b16 a[178:179], v27 offset:4096
    v_mfma_f32_16x16x32_bf16 v[84:87], a[216:219], v[196:199], v[84:87]
    buffer_load_dwordx4 a[68:71], v252, s[28:31], s37 offen offset:1024 sc1
    v_mfma_f32_16x16x32_bf16 v[84:87], a[220:223], v[180:183], v[84:87]
Ltour9:
    s_cbranch_execz Ltour13
    ds_read_b64_tr_b16 a[180:181], v27 offset:8192
    ds_read_b64_tr_b16 a[182:183], v27 offset:12288
    v_mfma_f32_16x16x32_bf16 v[84:87], a[224:227], v[140:143], v[84:87]
    ds_read_b64_tr_b16 a[184:185], v27 offset:16384
    v_lshl_add_u32 v54, v241, 1, v243
    v_mfma_f32_16x16x32_bf16 v[84:87], a[228:231], v[156:159], v[84:87]
    s_lshr_b32 s41, s2, 3
    ds_read_b64_tr_b16 a[186:187], v27 offset:20480
    v_mfma_f32_16x16x32_bf16 v[84:87], a[232:235], v[204:207], v[84:87]
    buffer_load_dwordx4 a[72:75], v252, s[28:31], s37 offen offset:2048 sc1
    v_mfma_f32_16x16x32_bf16 v[84:87], a[236:239], v[188:191], v[84:87]
    s_waitcnt lgkmcnt(12)
    s_mov_b32 s14, 2359296
    ds_read_b64_tr_b16 a[188:189], v27 offset:24576
    ds_read_b64_tr_b16 a[190:191], v27 offset:28672
    s_barrier
    v_mfma_f32_16x16x32_bf16 v[88:91], a[160:163], v[128:131], 0
    s_waitcnt lgkmcnt(12)
    s_mov_b32 s15, 0x20000
    ds_read_b64_tr_b16 a[208:209], v12 offset:32768
    v_mfma_f32_16x16x32_bf16 v[88:91], a[164:167], v[144:147], v[88:91]
    s_waitcnt lgkmcnt(11)
    s_mov_b32 s18, 2359296
    ds_read_b64_tr_b16 a[210:211], v12 offset:36864
    v_mfma_f32_16x16x32_bf16 v[88:91], a[168:171], v[192:195], v[88:91]
    s_waitcnt lgkmcnt(10)
    buffer_load_dwordx4 a[76:79], v252, s[28:31], s37 offen offset:3072 sc1
    v_mfma_f32_16x16x32_bf16 v[88:91], a[172:175], v[176:179], v[88:91]
    s_waitcnt lgkmcnt(8)
    s_mov_b32 s19, 0x20000
    ds_read_b64_tr_b16 a[212:213], v12 offset:40960
    ds_read_b64_tr_b16 a[214:215], v12 offset:45056
    v_mfma_f32_16x16x32_bf16 v[88:91], a[176:179], v[136:139], v[88:91]
    s_waitcnt lgkmcnt(8)
    s_add_u32 s8, s50, 7864320
    s_addc_u32 s9, s51, 0
    ds_read_b64_tr_b16 a[216:217], v12 offset:49152
    v_mfma_f32_16x16x32_bf16 v[88:91], a[180:183], v[152:155], v[88:91]
    s_waitcnt lgkmcnt(7)
    s_add_u32 s37, s55, 4096
    ds_read_b64_tr_b16 a[218:219], v12 offset:53248
    v_mfma_f32_16x16x32_bf16 v[88:91], a[184:187], v[200:203], v[88:91]
    s_waitcnt lgkmcnt(6)
    s_add_u32 s49, s46, 256
    buffer_load_dwordx4 a[80:83], v252, s[28:31], s37 offen offset:0 sc1
    v_mfma_f32_16x16x32_bf16 v[88:91], a[188:191], v[184:187], v[88:91]
    s_add_u32 m0, s42, 0
    ds_read_b64_tr_b16 a[220:221], v12 offset:57344
    ds_read_b64_tr_b16 a[222:223], v12 offset:61440
    v_mfma_f32_16x16x32_bf16 v[92:95], a[160:163], v[132:135], 0
    buffer_load_dwordx4 v46, s[20:23], s49 offen lds
    v_mfma_f32_16x16x32_bf16 v[92:95], a[164:167], v[148:151], v[92:95]
    s_mov_b32 s10, 663552
    ds_read_b64_tr_b16 a[224:225], v16 offset:32768
    ds_read_b64_tr_b16 a[226:227], v16 offset:36864
    v_mfma_f32_16x16x32_bf16 v[92:95], a[168:171], v[196:199], v[92:95]
    buffer_load_dwordx4 v47, s[20:23], s49 offen offset:1024 lds
    v_mfma_f32_16x16x32_bf16 v[92:95], a[172:175], v[180:183], v[92:95]
    s_mov_b32 s11, 0x20000
    ds_read_b64_tr_b16 a[228:229], v16 offset:40960
    ds_read_b64_tr_b16 a[230:231], v16 offset:45056
    v_mfma_f32_16x16x32_bf16 v[92:95], a[176:179], v[140:143], v[92:95]
    buffer_load_dwordx4 a[84:87], v252, s[28:31], s37 offen offset:1024 sc1
    v_mfma_f32_16x16x32_bf16 v[92:95], a[180:183], v[156:159], v[92:95]
    s_lshl_b32 s39, s5, 13
    ds_read_b64_tr_b16 a[232:233], v16 offset:49152
    ds_read_b64_tr_b16 a[234:235], v16 offset:53248
    v_mfma_f32_16x16x32_bf16 v[92:95], a[184:187], v[204:207], v[92:95]
    s_add_u32 s39, s39, 8781824
    ds_read_b64_tr_b16 a[236:237], v16 offset:57344
    v_mfma_f32_16x16x32_bf16 v[92:95], a[188:191], v[188:191], v[92:95]
    s_waitcnt lgkmcnt(13)
    s_lshr_b32 s45, s4, 2
    ds_read_b64_tr_b16 a[238:239], v16 offset:61440
    v_mfma_f32_16x16x32_bf16 v[96:99], a[208:211], v[128:131], 0
    s_waitcnt lgkmcnt(12)
    buffer_load_dwordx4 v48, s[20:23], s49 offen offset:2048 lds
    v_mfma_f32_16x16x32_bf16 v[96:99], a[212:215], v[144:147], v[96:99]
    s_waitcnt lgkmcnt(10)
    s_lshl_b32 s45, s45, 11
    ds_read_b64_tr_b16 a[160:161], v13 offset:32768
    ds_read_b64_tr_b16 a[162:163], v13 offset:36864
    v_mfma_f32_16x16x32_bf16 v[96:99], a[216:219], v[192:195], v[96:99]
    s_waitcnt lgkmcnt(10)
    buffer_load_dwordx4 v49, s[20:23], s49 offen offset:3072 lds
    v_mfma_f32_16x16x32_bf16 v[96:99], a[220:223], v[176:179], v[96:99]
    s_waitcnt lgkmcnt(8)
    s_add_u32 s39, s39, s45
    ds_read_b64_tr_b16 a[164:165], v13 offset:40960
    ds_read_b64_tr_b16 a[166:167], v13 offset:45056
    v_mfma_f32_16x16x32_bf16 v[96:99], a[224:227], v[136:139], v[96:99]
    s_waitcnt lgkmcnt(8)
    buffer_load_dwordx4 a[88:91], v252, s[28:31], s37 offen offset:2048 sc1
    v_mfma_f32_16x16x32_bf16 v[96:99], a[228:231], v[152:155], v[96:99]
    s_waitcnt lgkmcnt(6)
    ds_read_b64_tr_b16 a[168:169], v13 offset:49152
    ds_read_b64_tr_b16 a[170:171], v13 offset:53248
    v_mfma_f32_16x16x32_bf16 v[96:99], a[232:235], v[200:203], v[96:99]
    s_waitcnt lgkmcnt(6)
    s_add_u32 s49, s46, 73984
    ds_read_b64_tr_b16 a[172:173], v13 offset:57344
    v_and_b32 v9, 15, v1
    v_mfma_f32_16x16x32_bf16 v[96:99], a[236:239], v[184:187], v[96:99]
    s_add_u32 m0, s42, 16384
    ds_read_b64_tr_b16 a[174:175], v13 offset:61440
    v_lshlrev_b32 v9, 7, v9
    v_mfma_f32_16x16x32_bf16 v[100:103], a[208:211], v[132:135], 0
    buffer_load_dwordx4 v46, s[20:23], s49 offen lds
    v_mfma_f32_16x16x32_bf16 v[100:103], a[212:215], v[148:151], v[100:103]
    ds_read_b64_tr_b16 a[176:177], v17 offset:32768
    ds_read_b64_tr_b16 a[178:179], v17 offset:36864
    v_mfma_f32_16x16x32_bf16 v[100:103], a[216:219], v[196:199], v[100:103]
    buffer_load_dwordx4 v47, s[20:23], s49 offen offset:1024 lds
    v_mfma_f32_16x16x32_bf16 v[100:103], a[220:223], v[180:183], v[100:103]
    ds_read_b64_tr_b16 a[180:181], v17 offset:40960
    ds_read_b64_tr_b16 a[182:183], v17 offset:45056
    v_mfma_f32_16x16x32_bf16 v[100:103], a[224:227], v[140:143], v[100:103]
    buffer_load_dwordx4 a[92:95], v252, s[28:31], s37 offen offset:3072 sc1
    v_mfma_f32_16x16x32_bf16 v[100:103], a[228:231], v[156:159], v[100:103]
    ds_read_b64_tr_b16 a[184:185], v17 offset:49152
    ds_read_b64_tr_b16 a[186:187], v17 offset:53248
    v_mfma_f32_16x16x32_bf16 v[100:103], a[232:235], v[204:207], v[100:103]
    ds_read_b64_tr_b16 a[188:189], v17 offset:57344
    v_mfma_f32_16x16x32_bf16 v[100:103], a[236:239], v[188:191], v[100:103]
    s_waitcnt lgkmcnt(13)
    ds_read_b64_tr_b16 a[190:191], v17 offset:61440
    v_mfma_f32_16x16x32_bf16 v[104:107], a[160:163], v[128:131], 0
    s_waitcnt lgkmcnt(12)
    buffer_load_dwordx4 v48, s[20:23], s49 offen offset:2048 lds
    v_mfma_f32_16x16x32_bf16 v[104:107], a[164:167], v[144:147], v[104:107]
    s_waitcnt lgkmcnt(10)
    ds_read_b64_tr_b16 a[208:209], v14 offset:32768
    ds_read_b64_tr_b16 a[210:211], v14 offset:36864
    v_mfma_f32_16x16x32_bf16 v[104:107], a[168:171], v[192:195], v[104:107]
    s_waitcnt lgkmcnt(10)
    buffer_load_dwordx4 v49, s[20:23], s49 offen offset:3072 lds
    v_mfma_f32_16x16x32_bf16 v[104:107], a[172:175], v[176:179], v[104:107]
    s_waitcnt lgkmcnt(8)
    s_add_u32 s37, s55, 8192
    ds_read_b64_tr_b16 a[212:213], v14 offset:40960
    ds_read_b64_tr_b16 a[214:215], v14 offset:45056
    v_mfma_f32_16x16x32_bf16 v[104:107], a[176:179], v[136:139], v[104:107]
    s_waitcnt lgkmcnt(8)
    buffer_load_dwordx4 a[96:99], v252, s[28:31], s37 offen offset:0 sc1
    v_mfma_f32_16x16x32_bf16 v[104:107], a[180:183], v[152:155], v[104:107]
    s_waitcnt lgkmcnt(6)
    ds_read_b64_tr_b16 a[216:217], v14 offset:49152
    ds_read_b64_tr_b16 a[218:219], v14 offset:53248
    v_mfma_f32_16x16x32_bf16 v[104:107], a[184:187], v[200:203], v[104:107]
    s_waitcnt lgkmcnt(6)
    buffer_load_dwordx4 a[100:103], v252, s[28:31], s37 offen offset:1024 sc1
    v_mfma_f32_16x16x32_bf16 v[104:107], a[188:191], v[184:187], v[104:107]
    ds_read_b64_tr_b16 a[220:221], v14 offset:57344
    ds_read_b64_tr_b16 a[222:223], v14 offset:61440
    v_mfma_f32_16x16x32_bf16 v[108:111], a[160:163], v[132:135], 0
    ds_read_b64_tr_b16 a[224:225], v18 offset:32768
    v_mfma_f32_16x16x32_bf16 v[108:111], a[164:167], v[148:151], v[108:111]
    ds_read_b64_tr_b16 a[226:227], v18 offset:36864
    v_mfma_f32_16x16x32_bf16 v[108:111], a[168:171], v[196:199], v[108:111]
    buffer_load_dwordx4 a[104:107], v252, s[28:31], s37 offen offset:2048 sc1
    v_mfma_f32_16x16x32_bf16 v[108:111], a[172:175], v[180:183], v[108:111]
    ds_read_b64_tr_b16 a[228:229], v18 offset:40960
    ds_read_b64_tr_b16 a[230:231], v18 offset:45056
    v_mfma_f32_16x16x32_bf16 v[108:111], a[176:179], v[140:143], v[108:111]
    ds_read_b64_tr_b16 a[232:233], v18 offset:49152
    v_mfma_f32_16x16x32_bf16 v[108:111], a[180:183], v[156:159], v[108:111]
    ds_read_b64_tr_b16 a[234:235], v18 offset:53248
    v_mfma_f32_16x16x32_bf16 v[108:111], a[184:187], v[204:207], v[108:111]
    buffer_load_dwordx4 a[108:111], v252, s[28:31], s37 offen offset:3072 sc1
    v_mfma_f32_16x16x32_bf16 v[108:111], a[188:191], v[188:191], v[108:111]
    s_waitcnt lgkmcnt(12)
    ds_read_b64_tr_b16 a[236:237], v18 offset:57344
    ds_read_b64_tr_b16 a[238:239], v18 offset:61440
    v_mfma_f32_16x16x32_bf16 v[112:115], a[208:211], v[128:131], 0
    s_waitcnt lgkmcnt(12)
    ds_read_b64_tr_b16 a[160:161], v15 offset:32768
    v_mfma_f32_16x16x32_bf16 v[112:115], a[212:215], v[144:147], v[112:115]
    s_waitcnt lgkmcnt(11)
    s_add_u32 s37, s55, 12288
    ds_read_b64_tr_b16 a[162:163], v15 offset:36864
    v_mfma_f32_16x16x32_bf16 v[112:115], a[216:219], v[192:195], v[112:115]
    s_waitcnt lgkmcnt(10)
    buffer_load_dwordx4 a[112:115], v252, s[28:31], s37 offen offset:0 sc1
    v_mfma_f32_16x16x32_bf16 v[112:115], a[220:223], v[176:179], v[112:115]
    s_waitcnt lgkmcnt(8)
    ds_read_b64_tr_b16 a[164:165], v15 offset:40960
    ds_read_b64_tr_b16 a[166:167], v15 offset:45056
    v_mfma_f32_16x16x32_bf16 v[112:115], a[224:227], v[136:139], v[112:115]
    s_waitcnt lgkmcnt(8)
    buffer_load_dwordx4 a[116:119], v252, s[28:31], s37 offen offset:1024 sc1
    v_mfma_f32_16x16x32_bf16 v[112:115], a[228:231], v[152:155], v[112:115]
    s_waitcnt lgkmcnt(6)
    ds_read_b64_tr_b16 a[168:169], v15 offset:49152
    ds_read_b64_tr_b16 a[170:171], v15 offset:53248
    v_mfma_f32_16x16x32_bf16 v[112:115], a[232:235], v[200:203], v[112:115]
    s_waitcnt lgkmcnt(6)
    ds_read_b64_tr_b16 a[172:173], v15 offset:57344
    v_mfma_f32_16x16x32_bf16 v[112:115], a[236:239], v[184:187], v[112:115]
    ds_read_b64_tr_b16 a[174:175], v15 offset:61440
    v_mfma_f32_16x16x32_bf16 v[116:119], a[208:211], v[132:135], 0
    buffer_load_dwordx4 a[120:123], v252, s[28:31], s37 offen offset:2048 sc1
    v_mfma_f32_16x16x32_bf16 v[116:119], a[212:215], v[148:151], v[116:119]
    ds_read_b64_tr_b16 a[176:177], v19 offset:32768
    ds_read_b64_tr_b16 a[178:179], v19 offset:36864
    v_mfma_f32_16x16x32_bf16 v[116:119], a[216:219], v[196:199], v[116:119]
    ds_read_b64_tr_b16 a[180:181], v19 offset:40960
    v_mfma_f32_16x16x32_bf16 v[116:119], a[220:223], v[180:183], v[116:119]
    ds_read_b64_tr_b16 a[182:183], v19 offset:45056
    v_mfma_f32_16x16x32_bf16 v[116:119], a[224:227], v[140:143], v[116:119]
    buffer_load_dwordx4 a[124:127], v252, s[28:31], s37 offen offset:3072 sc1
    v_mfma_f32_16x16x32_bf16 v[116:119], a[228:231], v[156:159], v[116:119]
    ds_read_b64_tr_b16 a[184:185], v19 offset:49152
    ds_read_b64_tr_b16 a[186:187], v19 offset:53248
    v_mfma_f32_16x16x32_bf16 v[116:119], a[232:235], v[204:207], v[116:119]
    ds_read_b64_tr_b16 a[188:189], v19 offset:57344
    v_mfma_f32_16x16x32_bf16 v[116:119], a[236:239], v[188:191], v[116:119]
    ds_read_b64_tr_b16 a[190:191], v19 offset:61440
    s_waitcnt vmcnt(25)
    s_waitcnt lgkmcnt(0)
    s_barrier
    v_mfma_f32_16x16x32_bf16 v[120:123], a[160:163], v[128:131], 0
    ds_read_b64_tr_b16 a[208:209], v20 offset:32768
    v_mfma_f32_16x16x32_bf16 v[120:123], a[164:167], v[144:147], v[120:123]
    ds_read_b64_tr_b16 a[210:211], v20 offset:36864
    v_mfma_f32_16x16x32_bf16 v[120:123], a[168:171], v[192:195], v[120:123]
    ds_read_b64_tr_b16 a[212:213], v20 offset:40960
    v_mfma_f32_16x16x32_bf16 v[120:123], a[172:175], v[176:179], v[120:123]
    ds_read_b64_tr_b16 a[214:215], v20 offset:45056
    v_mfma_f32_16x16x32_bf16 v[120:123], a[176:179], v[136:139], v[120:123]
    ds_read_b64_tr_b16 a[216:217], v20 offset:49152
    v_mfma_f32_16x16x32_bf16 v[120:123], a[180:183], v[152:155], v[120:123]
    ds_read_b64_tr_b16 a[218:219], v20 offset:53248
    v_mfma_f32_16x16x32_bf16 v[120:123], a[184:187], v[200:203], v[120:123]
    s_add_u32 s49, s7, 512
    ds_read_b64_tr_b16 a[220:221], v20 offset:57344
    v_mfma_f32_16x16x32_bf16 v[120:123], a[188:191], v[184:187], v[120:123]
    s_add_u32 m0, s42, 65536
    ds_read_b64_tr_b16 a[222:223], v20 offset:61440
    v_mfma_f32_16x16x32_bf16 v[124:127], a[160:163], v[132:135], 0
    buffer_load_dwordx4 v46, s[20:23], s49 offen lds
    v_mfma_f32_16x16x32_bf16 v[124:127], a[164:167], v[148:151], v[124:127]
    ds_read_b64_tr_b16 a[224:225], v24 offset:32768
    ds_read_b64_tr_b16 a[226:227], v24 offset:36864
    v_mfma_f32_16x16x32_bf16 v[124:127], a[168:171], v[196:199], v[124:127]
    buffer_load_dwordx4 v47, s[20:23], s49 offen offset:1024 lds
    v_mfma_f32_16x16x32_bf16 v[124:127], a[172:175], v[180:183], v[124:127]
    ds_read_b64_tr_b16 a[228:229], v24 offset:40960
    ds_read_b64_tr_b16 a[230:231], v24 offset:45056
    v_mfma_f32_16x16x32_bf16 v[124:127], a[176:179], v[140:143], v[124:127]
    ds_read_b64_tr_b16 a[232:233], v24 offset:49152
    v_mfma_f32_16x16x32_bf16 v[124:127], a[180:183], v[156:159], v[124:127]
    ds_read_b64_tr_b16 a[234:235], v24 offset:53248
    v_mfma_f32_16x16x32_bf16 v[124:127], a[184:187], v[204:207], v[124:127]
    ds_read_b64_tr_b16 a[236:237], v24 offset:57344
    v_lshrrev_b32 v240, 4, v1
    v_mfma_f32_16x16x32_bf16 v[124:127], a[188:191], v[188:191], v[124:127]
    s_waitcnt vmcnt(25)
    s_waitcnt lgkmcnt(13)
    ds_read_b64_tr_b16 a[238:239], v24 offset:61440
    v_and_b32 v240, 2, v240
    v_mfma_f32_16x16x32_bf16 v[64:67], a[208:211], a[64:67], v[64:67]
    s_waitcnt vmcnt(24)
    s_waitcnt lgkmcnt(12)
    buffer_load_dwordx4 v48, s[20:23], s49 offen offset:2048 lds
    v_mfma_f32_16x16x32_bf16 v[64:67], a[212:215], a[68:71], v[64:67]
    s_waitcnt vmcnt(24)
    s_waitcnt lgkmcnt(10)
    ds_read_b64_tr_b16 a[160:161], v21 offset:32768
    ds_read_b64_tr_b16 a[162:163], v21 offset:36864
    v_mfma_f32_16x16x32_bf16 v[64:67], a[216:219], a[72:75], v[64:67]
    s_waitcnt vmcnt(23)
    s_waitcnt lgkmcnt(10)
    buffer_load_dwordx4 v49, s[20:23], s49 offen offset:3072 lds
    v_mfma_f32_16x16x32_bf16 v[64:67], a[220:223], a[76:79], v[64:67]
    s_waitcnt vmcnt(23)
    s_waitcnt lgkmcnt(8)
    ds_read_b64_tr_b16 a[164:165], v21 offset:40960
    ds_read_b64_tr_b16 a[166:167], v21 offset:45056
    v_mfma_f32_16x16x32_bf16 v[64:67], a[224:227], a[80:83], v[64:67]
    s_waitcnt vmcnt(20)
    s_waitcnt lgkmcnt(8)
    ds_read_b64_tr_b16 a[168:169], v21 offset:49152
    v_bfe_u32 v241, v1, 2, 2
    v_mfma_f32_16x16x32_bf16 v[64:67], a[228:231], a[84:87], v[64:67]
    s_waitcnt vmcnt(17)
    s_waitcnt lgkmcnt(7)
    ds_read_b64_tr_b16 a[170:171], v21 offset:53248
    v_cmp_eq_u32 s[54:55], v240, v241
    v_mfma_f32_16x16x32_bf16 v[64:67], a[232:235], a[88:91], v[64:67]
    s_waitcnt vmcnt(14)
    s_waitcnt lgkmcnt(6)
    s_add_u32 s49, s7, 74240
    ds_read_b64_tr_b16 a[172:173], v21 offset:57344
    v_or_b32 v240, 1, v240
    v_mfma_f32_16x16x32_bf16 v[64:67], a[236:239], a[92:95], v[64:67]
    s_waitcnt vmcnt(11)
    s_add_u32 m0, s42, 81920
    ds_read_b64_tr_b16 a[174:175], v21 offset:61440
    v_cmp_eq_u32 s[36:37], v240, v241
    v_mfma_f32_16x16x32_bf16 v[68:71], a[208:211], a[96:99], v[68:71]
    s_waitcnt vmcnt(10)
    buffer_load_dwordx4 v46, s[20:23], s49 offen lds
    v_mfma_f32_16x16x32_bf16 v[68:71], a[212:215], a[100:103], v[68:71]
    s_waitcnt vmcnt(10)
    ds_read_b64_tr_b16 a[176:177], v25 offset:32768
    ds_read_b64_tr_b16 a[178:179], v25 offset:36864
    v_mfma_f32_16x16x32_bf16 v[68:71], a[216:219], a[104:107], v[68:71]
    s_waitcnt vmcnt(9)
    buffer_load_dwordx4 v47, s[20:23], s49 offen offset:1024 lds
    v_mfma_f32_16x16x32_bf16 v[68:71], a[220:223], a[108:111], v[68:71]
    s_waitcnt vmcnt(9)
    ds_read_b64_tr_b16 a[180:181], v25 offset:40960
    ds_read_b64_tr_b16 a[182:183], v25 offset:45056
    v_mfma_f32_16x16x32_bf16 v[68:71], a[224:227], a[112:115], v[68:71]
    s_waitcnt vmcnt(8)
    ds_read_b64_tr_b16 a[184:185], v25 offset:49152
    v_cvt_pk_bf16_f32 v224, v64, v65
    v_mfma_f32_16x16x32_bf16 v[68:71], a[228:231], a[116:119], v[68:71]
    s_waitcnt vmcnt(7)
    ds_read_b64_tr_b16 a[186:187], v25 offset:53248
    v_cvt_pk_bf16_f32 v225, v66, v67
    v_mfma_f32_16x16x32_bf16 v[68:71], a[232:235], a[120:123], v[68:71]
    s_waitcnt vmcnt(6)
    buffer_load_dwordx2 v[36:37], v4, s[12:15], 0 offen offset:0
    v_mfma_f32_16x16x32_bf16 v[68:71], a[236:239], a[124:127], v[68:71]
    s_waitcnt lgkmcnt(12)
    ds_read_b64_tr_b16 a[188:189], v25 offset:57344
    ds_read_b64_tr_b16 a[190:191], v25 offset:61440
    v_mfma_f32_16x16x32_bf16 v[72:75], a[160:163], a[64:67], v[72:75]
    s_waitcnt lgkmcnt(12)
    buffer_load_dwordx4 v48, s[20:23], s49 offen offset:2048 lds
    v_mfma_f32_16x16x32_bf16 v[72:75], a[164:167], a[68:71], v[72:75]
    s_waitcnt lgkmcnt(10)
    ds_read_b64_tr_b16 a[208:209], v22 offset:32768
    ds_read_b64_tr_b16 a[210:211], v22 offset:36864
    v_mfma_f32_16x16x32_bf16 v[72:75], a[168:171], a[72:75], v[72:75]
    s_waitcnt lgkmcnt(10)
    buffer_load_dwordx4 v49, s[20:23], s49 offen offset:3072 lds
    v_mfma_f32_16x16x32_bf16 v[72:75], a[172:175], a[76:79], v[72:75]
    s_waitcnt lgkmcnt(8)
    ds_read_b64_tr_b16 a[212:213], v22 offset:40960
    ds_read_b64_tr_b16 a[214:215], v22 offset:45056
    v_mfma_f32_16x16x32_bf16 v[72:75], a[176:179], a[80:83], v[72:75]
    s_waitcnt lgkmcnt(8)
    ds_read_b64_tr_b16 a[216:217], v22 offset:49152
    v_cvt_pk_bf16_f32 v228, v68, v69
    v_mfma_f32_16x16x32_bf16 v[72:75], a[180:183], a[84:87], v[72:75]
    s_waitcnt lgkmcnt(7)
    ds_read_b64_tr_b16 a[218:219], v22 offset:53248
    v_cvt_pk_bf16_f32 v229, v70, v71
    v_mfma_f32_16x16x32_bf16 v[72:75], a[184:187], a[88:91], v[72:75]
    s_waitcnt lgkmcnt(6)
    ds_read_b64_tr_b16 a[220:221], v22 offset:57344
    v_and_b32 v240, 1, v1
    v_mfma_f32_16x16x32_bf16 v[72:75], a[188:191], a[92:95], v[72:75]
    ds_read_b64_tr_b16 a[222:223], v22 offset:61440
    v_lshlrev_b32 v240, 4, v240
    v_mfma_f32_16x16x32_bf16 v[76:79], a[160:163], a[96:99], v[76:79]
    buffer_load_dwordx2 v[38:39], v4, s[12:15], 0 offen offset:32
    v_mfma_f32_16x16x32_bf16 v[76:79], a[164:167], a[100:103], v[76:79]
    ds_read_b64_tr_b16 a[224:225], v26 offset:32768
    ds_read_b64_tr_b16 a[226:227], v26 offset:36864
    v_mfma_f32_16x16x32_bf16 v[76:79], a[168:171], a[104:107], v[76:79]
    ds_read_b64_tr_b16 a[228:229], v26 offset:40960
    v_mov_b32 v241, 0x3f80
    v_mfma_f32_16x16x32_bf16 v[76:79], a[172:175], a[108:111], v[76:79]
    ds_read_b64_tr_b16 a[230:231], v26 offset:45056
    v_lshlrev_b32 v240, v240, v241
    v_mfma_f32_16x16x32_bf16 v[76:79], a[176:179], a[112:115], v[76:79]
    ds_read_b64_tr_b16 a[232:233], v26 offset:49152
    v_cvt_pk_bf16_f32 v226, v72, v73
    v_mfma_f32_16x16x32_bf16 v[76:79], a[180:183], a[116:119], v[76:79]
    s_add_u32 s38, s93, 0
    ds_read_b64_tr_b16 a[234:235], v26 offset:53248
    v_cvt_pk_bf16_f32 v227, v74, v75
    v_mfma_f32_16x16x32_bf16 v[76:79], a[184:187], a[120:123], v[76:79]
    buffer_store_dwordx4 v[224:227], v56, s[28:31], s38 offen sc1
    v_mfma_f32_16x16x32_bf16 v[76:79], a[188:191], a[124:127], v[76:79]
    s_waitcnt lgkmcnt(12)
    ds_read_b64_tr_b16 a[236:237], v26 offset:57344
    ds_read_b64_tr_b16 a[238:239], v26 offset:61440
    v_mfma_f32_16x16x32_bf16 v[80:83], a[208:211], a[64:67], v[80:83]
    s_waitcnt lgkmcnt(12)
    ds_read_b64_tr_b16 a[160:161], v23 offset:32768
    v_bfe_i32 v241, v1, 1, 1
    v_mfma_f32_16x16x32_bf16 v[80:83], a[212:215], a[68:71], v[80:83]
    s_waitcnt lgkmcnt(11)
    ds_read_b64_tr_b16 a[162:163], v23 offset:36864
    v_and_b32 v243, v240, v241
    v_mfma_f32_16x16x32_bf16 v[80:83], a[216:219], a[72:75], v[80:83]
    s_waitcnt lgkmcnt(10)
    buffer_load_dwordx2 v[40:41], v4, s[12:15], 0 offen offset:512
    v_mfma_f32_16x16x32_bf16 v[80:83], a[220:223], a[76:79], v[80:83]
    s_waitcnt lgkmcnt(8)
    ds_read_b64_tr_b16 a[164:165], v23 offset:40960
    ds_read_b64_tr_b16 a[166:167], v23 offset:45056
    v_mfma_f32_16x16x32_bf16 v[80:83], a[224:227], a[80:83], v[80:83]
    s_waitcnt lgkmcnt(8)
    ds_read_b64_tr_b16 a[168:169], v23 offset:49152
    v_cvt_pk_bf16_f32 v230, v76, v77
    v_mfma_f32_16x16x32_bf16 v[80:83], a[228:231], a[84:87], v[80:83]
    s_waitcnt lgkmcnt(7)
    s_add_u32 s38, s93, 163840
    ds_read_b64_tr_b16 a[170:171], v23 offset:53248
    v_cvt_pk_bf16_f32 v231, v78, v79
    v_mfma_f32_16x16x32_bf16 v[80:83], a[232:235], a[88:91], v[80:83]
    s_waitcnt lgkmcnt(6)
    buffer_store_dwordx4 v[228:231], v56, s[28:31], s38 offen sc1
    v_mfma_f32_16x16x32_bf16 v[80:83], a[236:239], a[92:95], v[80:83]
    ds_read_b64_tr_b16 a[172:173], v23 offset:57344
    ds_read_b64_tr_b16 a[174:175], v23 offset:61440
    v_mfma_f32_16x16x32_bf16 v[84:87], a[208:211], a[96:99], v[84:87]
    ds_read_b64_tr_b16 a[176:177], v27 offset:32768
    v_xor_b32 v242, v240, v243
    v_mfma_f32_16x16x32_bf16 v[84:87], a[212:215], a[100:103], v[84:87]
    ds_read_b64_tr_b16 a[178:179], v27 offset:36864
    v_cndmask_b32 v246, 0, v242, s[54:55]
    v_mfma_f32_16x16x32_bf16 v[84:87], a[216:219], a[104:107], v[84:87]
    ds_read_b64_tr_b16 a[180:181], v27 offset:40960
    v_cndmask_b32 v247, 0, v243, s[54:55]
    v_mfma_f32_16x16x32_bf16 v[84:87], a[220:223], a[108:111], v[84:87]
    ds_read_b64_tr_b16 a[182:183], v27 offset:45056
    v_cndmask_b32 v250, 0, v242, s[36:37]
    v_mfma_f32_16x16x32_bf16 v[84:87], a[224:227], a[112:115], v[84:87]
    ds_read_b64_tr_b16 a[184:185], v27 offset:49152
    v_cvt_pk_bf16_f32 v232, v80, v81
    v_mfma_f32_16x16x32_bf16 v[84:87], a[228:231], a[116:119], v[84:87]
    ds_read_b64_tr_b16 a[186:187], v27 offset:53248
    v_cvt_pk_bf16_f32 v233, v82, v83
    v_mfma_f32_16x16x32_bf16 v[84:87], a[232:235], a[120:123], v[84:87]
    buffer_load_dwordx2 v[42:43], v4, s[12:15], 0 offen offset:544
    v_mfma_f32_16x16x32_bf16 v[84:87], a[236:239], a[124:127], v[84:87]
    s_waitcnt lgkmcnt(12)
    ds_read_b64_tr_b16 a[188:189], v27 offset:57344
    ds_read_b64_tr_b16 a[190:191], v27 offset:61440
    s_barrier
    v_mfma_f32_16x16x32_bf16 v[88:91], a[160:163], a[64:67], v[88:91]
    s_waitcnt lgkmcnt(12)
    ds_read_b64_tr_b16 a[208:209], v12 offset:0
    v_cndmask_b32 v251, 0, v243, s[36:37]
    v_mfma_f32_16x16x32_bf16 v[88:91], a[164:167], a[68:71], v[88:91]
    s_waitcnt lgkmcnt(11)
    ds_read_b64_tr_b16 a[210:211], v12 offset:4096
    v_mov_b32 v240, 0
    v_mfma_f32_16x16x32_bf16 v[88:91], a[168:171], a[72:75], v[88:91]
    s_waitcnt lgkmcnt(10)
    ds_read_b64_tr_b16 a[212:213], v12 offset:8192
    v_mov_b32 v241, 0
    v_mfma_f32_16x16x32_bf16 v[88:91], a[172:175], a[76:79], v[88:91]
    s_waitcnt lgkmcnt(9)
    ds_read_b64_tr_b16 a[214:215], v12 offset:12288
    v_mov_b32 v244, 0
    v_mfma_f32_16x16x32_bf16 v[88:91], a[176:179], a[80:83], v[88:91]
    s_waitcnt lgkmcnt(8)
    ds_read_b64_tr_b16 a[216:217], v12 offset:16384
    v_cvt_pk_bf16_f32 v236, v84, v85
    v_mfma_f32_16x16x32_bf16 v[88:91], a[180:183], a[84:87], v[88:91]
    s_waitcnt lgkmcnt(7)
    ds_read_b64_tr_b16 a[218:219], v12 offset:20480
    v_cvt_pk_bf16_f32 v237, v86, v87
    v_mfma_f32_16x16x32_bf16 v[88:91], a[184:187], a[88:91], v[88:91]
    s_waitcnt lgkmcnt(6)
    s_add_u32 s49, s46, 512
    ds_read_b64_tr_b16 a[220:221], v12 offset:24576
    v_mov_b32 v245, 0
    v_mfma_f32_16x16x32_bf16 v[88:91], a[188:191], a[92:95], v[88:91]
    s_add_u32 m0, s42, 32768
    ds_read_b64_tr_b16 a[222:223], v12 offset:28672
    v_mov_b32 v248, 0
    v_mfma_f32_16x16x32_bf16 v[92:95], a[160:163], a[96:99], v[92:95]
    buffer_load_dwordx4 v46, s[20:23], s49 offen lds
    v_mfma_f32_16x16x32_bf16 v[92:95], a[164:167], a[100:103], v[92:95]
    ds_read_b64_tr_b16 a[224:225], v16 offset:0
    ds_read_b64_tr_b16 a[226:227], v16 offset:4096
    v_mfma_f32_16x16x32_bf16 v[92:95], a[168:171], a[104:107], v[92:95]
    buffer_load_dwordx4 v47, s[20:23], s49 offen offset:1024 lds
    v_mfma_f32_16x16x32_bf16 v[92:95], a[172:175], a[108:111], v[92:95]
    ds_read_b64_tr_b16 a[228:229], v16 offset:8192
    ds_read_b64_tr_b16 a[230:231], v16 offset:12288
    v_mfma_f32_16x16x32_bf16 v[92:95], a[176:179], a[112:115], v[92:95]
    ds_read_b64_tr_b16 a[232:233], v16 offset:16384
    v_cvt_pk_bf16_f32 v234, v88, v89
    v_mfma_f32_16x16x32_bf16 v[92:95], a[180:183], a[116:119], v[92:95]
    s_add_u32 s38, s93, 128
    ds_read_b64_tr_b16 a[234:235], v16 offset:20480
    v_cvt_pk_bf16_f32 v235, v90, v91
    v_mfma_f32_16x16x32_bf16 v[92:95], a[184:187], a[120:123], v[92:95]
    buffer_store_dwordx4 v[232:235], v56, s[28:31], s38 offen sc1
    v_mfma_f32_16x16x32_bf16 v[92:95], a[188:191], a[124:127], v[92:95]
    s_waitcnt lgkmcnt(12)
    ds_read_b64_tr_b16 a[236:237], v16 offset:24576
    ds_read_b64_tr_b16 a[238:239], v16 offset:28672
    v_mfma_f32_16x16x32_bf16 v[96:99], a[208:211], a[64:67], v[96:99]
    s_waitcnt lgkmcnt(12)
    buffer_load_dwordx4 v48, s[20:23], s49 offen offset:2048 lds
    v_mfma_f32_16x16x32_bf16 v[96:99], a[212:215], a[68:71], v[96:99]
    s_waitcnt lgkmcnt(10)
    ds_read_b64_tr_b16 a[160:161], v13 offset:0
    ds_read_b64_tr_b16 a[162:163], v13 offset:4096
    v_mfma_f32_16x16x32_bf16 v[96:99], a[216:219], a[72:75], v[96:99]
    s_waitcnt lgkmcnt(10)
    buffer_load_dwordx4 v49, s[20:23], s49 offen offset:3072 lds
    v_mfma_f32_16x16x32_bf16 v[96:99], a[220:223], a[76:79], v[96:99]
    s_waitcnt lgkmcnt(8)
    ds_read_b64_tr_b16 a[164:165], v13 offset:8192
    ds_read_b64_tr_b16 a[166:167], v13 offset:12288
    v_mfma_f32_16x16x32_bf16 v[96:99], a[224:227], a[80:83], v[96:99]
    s_waitcnt lgkmcnt(8)
    ds_read_b64_tr_b16 a[168:169], v13 offset:16384
    v_cvt_pk_bf16_f32 v238, v92, v93
    v_mfma_f32_16x16x32_bf16 v[96:99], a[228:231], a[84:87], v[96:99]
    s_waitcnt lgkmcnt(7)
    s_add_u32 s38, s93, 163968
    ds_read_b64_tr_b16 a[170:171], v13 offset:20480
    v_cvt_pk_bf16_f32 v239, v94, v95
    v_mfma_f32_16x16x32_bf16 v[96:99], a[232:235], a[88:91], v[96:99]
    s_waitcnt lgkmcnt(6)
    s_add_u32 s49, s46, 74240
    buffer_store_dwordx4 v[236:239], v56, s[28:31], s38 offen sc1
    v_mfma_f32_16x16x32_bf16 v[96:99], a[236:239], a[92:95], v[96:99]
    s_add_u32 m0, s42, 49152
    ds_read_b64_tr_b16 a[172:173], v13 offset:24576
    ds_read_b64_tr_b16 a[174:175], v13 offset:28672
    v_mfma_f32_16x16x32_bf16 v[100:103], a[208:211], a[96:99], v[100:103]
    buffer_load_dwordx4 v46, s[20:23], s49 offen lds
    v_mfma_f32_16x16x32_bf16 v[100:103], a[212:215], a[100:103], v[100:103]
    ds_read_b64_tr_b16 a[176:177], v17 offset:0
    ds_read_b64_tr_b16 a[178:179], v17 offset:4096
    v_mfma_f32_16x16x32_bf16 v[100:103], a[216:219], a[104:107], v[100:103]
    buffer_load_dwordx4 v47, s[20:23], s49 offen offset:1024 lds
    v_mfma_f32_16x16x32_bf16 v[100:103], a[220:223], a[108:111], v[100:103]
    ds_read_b64_tr_b16 a[180:181], v17 offset:8192
    ds_read_b64_tr_b16 a[182:183], v17 offset:12288
    v_mfma_f32_16x16x32_bf16 v[100:103], a[224:227], a[112:115], v[100:103]
    ds_read_b64_tr_b16 a[184:185], v17 offset:16384
    v_cvt_pk_bf16_f32 v224, v96, v97
    v_mfma_f32_16x16x32_bf16 v[100:103], a[228:231], a[116:119], v[100:103]
    ds_read_b64_tr_b16 a[186:187], v17 offset:20480
    v_cvt_pk_bf16_f32 v225, v98, v99
    v_mfma_f32_16x16x32_bf16 v[100:103], a[232:235], a[120:123], v[100:103]
    ds_read_b64_tr_b16 a[188:189], v17 offset:24576
    v_mov_b32 v249, 0
    v_mfma_f32_16x16x32_bf16 v[100:103], a[236:239], a[124:127], v[100:103]
    s_waitcnt lgkmcnt(13)
    ds_read_b64_tr_b16 a[190:191], v17 offset:28672
    v_mov_b32 v252, 0
    v_mfma_f32_16x16x32_bf16 v[104:107], a[160:163], a[64:67], v[104:107]
    s_waitcnt lgkmcnt(12)
    buffer_load_dwordx4 v48, s[20:23], s49 offen offset:2048 lds
    v_mfma_f32_16x16x32_bf16 v[104:107], a[164:167], a[68:71], v[104:107]
    s_waitcnt lgkmcnt(10)
    ds_read_b64_tr_b16 a[208:209], v14 offset:0
    ds_read_b64_tr_b16 a[210:211], v14 offset:4096
    v_mfma_f32_16x16x32_bf16 v[104:107], a[168:171], a[72:75], v[104:107]
    s_waitcnt lgkmcnt(10)
    buffer_load_dwordx4 v49, s[20:23], s49 offen offset:3072 lds
    v_mfma_f32_16x16x32_bf16 v[104:107], a[172:175], a[76:79], v[104:107]
    s_waitcnt lgkmcnt(8)
    ds_read_b64_tr_b16 a[212:213], v14 offset:8192
    ds_read_b64_tr_b16 a[214:215], v14 offset:12288
    v_mfma_f32_16x16x32_bf16 v[104:107], a[176:179], a[80:83], v[104:107]
    s_waitcnt lgkmcnt(8)
    ds_read_b64_tr_b16 a[216:217], v14 offset:16384
    v_cvt_pk_bf16_f32 v228, v100, v101
    v_mfma_f32_16x16x32_bf16 v[104:107], a[180:183], a[84:87], v[104:107]
    s_waitcnt lgkmcnt(7)
    ds_read_b64_tr_b16 a[218:219], v14 offset:20480
    v_cvt_pk_bf16_f32 v229, v102, v103
    v_mfma_f32_16x16x32_bf16 v[104:107], a[184:187], a[88:91], v[104:107]
    s_waitcnt lgkmcnt(6)
    ds_read_b64_tr_b16 a[220:221], v14 offset:24576
    v_mov_b32 v253, 0
    v_mfma_f32_16x16x32_bf16 v[104:107], a[188:191], a[92:95], v[104:107]
    ds_read_b64_tr_b16 a[222:223], v14 offset:28672
    v_mfma_f32_16x16x32_bf16 v[108:111], a[160:163], a[96:99], v[108:111]
Ltour10:
    s_cbranch_execz Ltour14
    ds_read_b64_tr_b16 a[224:225], v18 offset:0
    v_mfma_f32_16x16x32_bf16 v[108:111], a[164:167], a[100:103], v[108:111]
    ds_read_b64_tr_b16 a[226:227], v18 offset:4096
    v_mfma_f32_16x16x32_bf16 v[108:111], a[168:171], a[104:107], v[108:111]
    ds_read_b64_tr_b16 a[228:229], v18 offset:8192
    v_mfma_f32_16x16x32_bf16 v[108:111], a[172:175], a[108:111], v[108:111]
    ds_read_b64_tr_b16 a[230:231], v18 offset:12288
    v_mfma_f32_16x16x32_bf16 v[108:111], a[176:179], a[112:115], v[108:111]
    ds_read_b64_tr_b16 a[232:233], v18 offset:16384
    v_cvt_pk_bf16_f32 v226, v104, v105
    v_mfma_f32_16x16x32_bf16 v[108:111], a[180:183], a[116:119], v[108:111]
    s_add_u32 s38, s93, 512
    ds_read_b64_tr_b16 a[234:235], v18 offset:20480
    v_cvt_pk_bf16_f32 v227, v106, v107
    v_mfma_f32_16x16x32_bf16 v[108:111], a[184:187], a[120:123], v[108:111]
    buffer_store_dwordx4 v[224:227], v56, s[28:31], s38 offen sc1
    v_mfma_f32_16x16x32_bf16 v[108:111], a[188:191], a[124:127], v[108:111]
    s_waitcnt lgkmcnt(12)
    ds_read_b64_tr_b16 a[236:237], v18 offset:24576
    ds_read_b64_tr_b16 a[238:239], v18 offset:28672
    v_mfma_f32_16x16x32_bf16 v[112:115], a[208:211], a[64:67], v[112:115]
    s_waitcnt lgkmcnt(12)
    ds_read_b64_tr_b16 a[160:161], v15 offset:0
    v_mfma_f32_16x16x32_bf16 v[112:115], a[212:215], a[68:71], v[112:115]
    s_waitcnt lgkmcnt(11)
    ds_read_b64_tr_b16 a[162:163], v15 offset:4096
    v_mfma_f32_16x16x32_bf16 v[112:115], a[216:219], a[72:75], v[112:115]
    s_waitcnt lgkmcnt(10)
    ds_read_b64_tr_b16 a[164:165], v15 offset:8192
    v_mfma_f32_16x16x32_bf16 v[112:115], a[220:223], a[76:79], v[112:115]
    s_waitcnt lgkmcnt(9)
    ds_read_b64_tr_b16 a[166:167], v15 offset:12288
    v_mfma_f32_16x16x32_bf16 v[112:115], a[224:227], a[80:83], v[112:115]
    s_waitcnt lgkmcnt(8)
    ds_read_b64_tr_b16 a[168:169], v15 offset:16384
    v_cvt_pk_bf16_f32 v230, v108, v109
    v_mfma_f32_16x16x32_bf16 v[112:115], a[228:231], a[84:87], v[112:115]
    s_waitcnt lgkmcnt(7)
    s_add_u32 s38, s93, 164352
    ds_read_b64_tr_b16 a[170:171], v15 offset:20480
    v_cvt_pk_bf16_f32 v231, v110, v111
    v_mfma_f32_16x16x32_bf16 v[112:115], a[232:235], a[88:91], v[112:115]
    s_waitcnt lgkmcnt(6)
    buffer_store_dwordx4 v[228:231], v56, s[28:31], s38 offen sc1
    v_mfma_f32_16x16x32_bf16 v[112:115], a[236:239], a[92:95], v[112:115]
    ds_read_b64_tr_b16 a[172:173], v15 offset:24576
    ds_read_b64_tr_b16 a[174:175], v15 offset:28672
    v_mfma_f32_16x16x32_bf16 v[116:119], a[208:211], a[96:99], v[116:119]
    ds_read_b64_tr_b16 a[176:177], v19 offset:0
    v_mfma_f32_16x16x32_bf16 v[116:119], a[212:215], a[100:103], v[116:119]
    ds_read_b64_tr_b16 a[178:179], v19 offset:4096
    v_mfma_f32_16x16x32_bf16 v[116:119], a[216:219], a[104:107], v[116:119]
    ds_read_b64_tr_b16 a[180:181], v19 offset:8192
    v_mfma_f32_16x16x32_bf16 v[116:119], a[220:223], a[108:111], v[116:119]
    ds_read_b64_tr_b16 a[182:183], v19 offset:12288
    v_mfma_f32_16x16x32_bf16 v[116:119], a[224:227], a[112:115], v[116:119]
    ds_read_b64_tr_b16 a[184:185], v19 offset:16384
    v_cvt_pk_bf16_f32 v232, v112, v113
    v_mfma_f32_16x16x32_bf16 v[116:119], a[228:231], a[116:119], v[116:119]
    ds_read_b64_tr_b16 a[186:187], v19 offset:20480
    v_cvt_pk_bf16_f32 v233, v114, v115
    v_mfma_f32_16x16x32_bf16 v[116:119], a[232:235], a[120:123], v[116:119]
    ds_read_b64_tr_b16 a[188:189], v19 offset:24576
    v_mfma_f32_16x16x32_bf16 v[116:119], a[236:239], a[124:127], v[116:119]
    s_waitcnt lgkmcnt(13)
    ds_read_b64_tr_b16 a[190:191], v19 offset:28672
    s_waitcnt vmcnt(17)
    s_barrier
    v_mfma_f32_16x16x32_bf16 v[120:123], a[160:163], a[64:67], v[120:123]
    s_waitcnt lgkmcnt(12)
    ds_read_b64_tr_b16 a[208:209], v20 offset:0
    v_mfma_f32_16x16x32_bf16 v[120:123], a[164:167], a[68:71], v[120:123]
    s_waitcnt lgkmcnt(11)
    ds_read_b64_tr_b16 a[210:211], v20 offset:4096
    v_mfma_f32_16x16x32_bf16 v[120:123], a[168:171], a[72:75], v[120:123]
    s_waitcnt lgkmcnt(10)
    ds_read_b64_tr_b16 a[212:213], v20 offset:8192
    v_mfma_f32_16x16x32_bf16 v[120:123], a[172:175], a[76:79], v[120:123]
    s_waitcnt lgkmcnt(9)
    ds_read_b64_tr_b16 a[214:215], v20 offset:12288
    v_mfma_f32_16x16x32_bf16 v[120:123], a[176:179], a[80:83], v[120:123]
    s_waitcnt lgkmcnt(8)
    ds_read_b64_tr_b16 a[216:217], v20 offset:16384
    v_cvt_pk_bf16_f32 v236, v116, v117
    v_mfma_f32_16x16x32_bf16 v[120:123], a[180:183], a[84:87], v[120:123]
    s_waitcnt lgkmcnt(7)
    ds_read_b64_tr_b16 a[218:219], v20 offset:20480
    v_cvt_pk_bf16_f32 v237, v118, v119
    v_mfma_f32_16x16x32_bf16 v[120:123], a[184:187], a[88:91], v[120:123]
    s_waitcnt lgkmcnt(6)
    s_add_u32 s49, s7, 768
    ds_read_b64_tr_b16 a[220:221], v20 offset:24576
    v_mfma_f32_16x16x32_bf16 v[120:123], a[188:191], a[92:95], v[120:123]
    s_add_u32 m0, s42, 98304
    ds_read_b64_tr_b16 a[222:223], v20 offset:28672
    v_mfma_f32_16x16x32_bf16 v[124:127], a[160:163], a[96:99], v[124:127]
    buffer_load_dwordx4 v46, s[20:23], s49 offen lds
    v_mfma_f32_16x16x32_bf16 v[124:127], a[164:167], a[100:103], v[124:127]
    ds_read_b64_tr_b16 a[224:225], v24 offset:0
    ds_read_b64_tr_b16 a[226:227], v24 offset:4096
    v_mfma_f32_16x16x32_bf16 v[124:127], a[168:171], a[104:107], v[124:127]
    buffer_load_dwordx4 v47, s[20:23], s49 offen offset:1024 lds
    v_mfma_f32_16x16x32_bf16 v[124:127], a[172:175], a[108:111], v[124:127]
    ds_read_b64_tr_b16 a[228:229], v24 offset:8192
    ds_read_b64_tr_b16 a[230:231], v24 offset:12288
    v_mfma_f32_16x16x32_bf16 v[124:127], a[176:179], a[112:115], v[124:127]
    ds_read_b64_tr_b16 a[232:233], v24 offset:16384
    v_cvt_pk_bf16_f32 v234, v120, v121
    v_mfma_f32_16x16x32_bf16 v[124:127], a[180:183], a[116:119], v[124:127]
    s_add_u32 s38, s93, 640
    ds_read_b64_tr_b16 a[234:235], v24 offset:20480
    v_cvt_pk_bf16_f32 v235, v122, v123
    v_mfma_f32_16x16x32_bf16 v[124:127], a[184:187], a[120:123], v[124:127]
    buffer_store_dwordx4 v[232:235], v56, s[28:31], s38 offen sc1
    v_mfma_f32_16x16x32_bf16 v[124:127], a[188:191], a[124:127], v[124:127]
    s_waitcnt lgkmcnt(12)
    ds_read_b64_tr_b16 a[236:237], v24 offset:24576
    ds_read_b64_tr_b16 a[238:239], v24 offset:28672
    v_mfma_f32_16x16x32_bf16 v[64:67], a[208:211], v[128:131], 0
    s_waitcnt lgkmcnt(12)
    buffer_load_dwordx4 v48, s[20:23], s49 offen offset:2048 lds
    v_mfma_f32_16x16x32_bf16 v[64:67], a[212:215], v[144:147], v[64:67]
    s_waitcnt lgkmcnt(10)
    ds_read_b64_tr_b16 a[160:161], v21 offset:0
    ds_read_b64_tr_b16 a[162:163], v21 offset:4096
    v_mfma_f32_16x16x32_bf16 v[64:67], a[216:219], v[192:195], v[64:67]
    s_waitcnt lgkmcnt(10)
    buffer_load_dwordx4 v49, s[20:23], s49 offen offset:3072 lds
    v_mfma_f32_16x16x32_bf16 v[64:67], a[220:223], v[176:179], v[64:67]
    s_waitcnt lgkmcnt(8)
    ds_read_b64_tr_b16 a[164:165], v21 offset:8192
    ds_read_b64_tr_b16 a[166:167], v21 offset:12288
    v_mfma_f32_16x16x32_bf16 v[64:67], a[224:227], v[136:139], v[64:67]
    s_waitcnt lgkmcnt(8)
    ds_read_b64_tr_b16 a[168:169], v21 offset:16384
    v_cvt_pk_bf16_f32 v238, v124, v125
    v_mfma_f32_16x16x32_bf16 v[64:67], a[228:231], v[152:155], v[64:67]
    s_waitcnt lgkmcnt(7)
    s_add_u32 s38, s93, 164480
    ds_read_b64_tr_b16 a[170:171], v21 offset:20480
    v_cvt_pk_bf16_f32 v239, v126, v127
    v_mfma_f32_16x16x32_bf16 v[64:67], a[232:235], v[200:203], v[64:67]
    s_waitcnt lgkmcnt(6)
    s_add_u32 s49, s7, 74496
    buffer_store_dwordx4 v[236:239], v56, s[28:31], s38 offen sc1
    v_mfma_f32_16x16x32_bf16 v[64:67], a[236:239], v[184:187], v[64:67]
    s_add_u32 m0, s42, 114688
    ds_read_b64_tr_b16 a[172:173], v21 offset:24576
    ds_read_b64_tr_b16 a[174:175], v21 offset:28672
    v_mfma_f32_16x16x32_bf16 v[68:71], a[208:211], v[132:135], 0
    buffer_load_dwordx4 v46, s[20:23], s49 offen lds
    v_mfma_f32_16x16x32_bf16 v[68:71], a[212:215], v[148:151], v[68:71]
    ds_read_b64_tr_b16 a[176:177], v25 offset:0
    ds_read_b64_tr_b16 a[178:179], v25 offset:4096
    v_mfma_f32_16x16x32_bf16 v[68:71], a[216:219], v[196:199], v[68:71]
    buffer_load_dwordx4 v47, s[20:23], s49 offen offset:1024 lds
    v_mfma_f32_16x16x32_bf16 v[68:71], a[220:223], v[180:183], v[68:71]
    ds_read_b64_tr_b16 a[180:181], v25 offset:8192
    ds_read_b64_tr_b16 a[182:183], v25 offset:12288
    v_mfma_f32_16x16x32_bf16 v[68:71], a[224:227], v[140:143], v[68:71]
    ds_read_b64_tr_b16 a[184:185], v25 offset:16384
    v_mfma_f32_16x16x32_bf16 v[68:71], a[228:231], v[156:159], v[68:71]
    ds_read_b64_tr_b16 a[186:187], v25 offset:20480
    v_mfma_f32_16x16x32_bf16 v[68:71], a[232:235], v[204:207], v[68:71]
    ds_read_b64_tr_b16 a[188:189], v25 offset:24576
    v_mfma_f32_16x16x32_bf16 v[68:71], a[236:239], v[188:191], v[68:71]
    s_waitcnt lgkmcnt(13)
    ds_read_b64_tr_b16 a[190:191], v25 offset:28672
    v_mfma_f32_16x16x32_bf16 v[72:75], a[160:163], v[128:131], 0
    s_waitcnt lgkmcnt(12)
    buffer_load_dwordx4 v48, s[20:23], s49 offen offset:2048 lds
    v_mfma_f32_16x16x32_bf16 v[72:75], a[164:167], v[144:147], v[72:75]
    s_waitcnt lgkmcnt(10)
    ds_read_b64_tr_b16 a[208:209], v22 offset:0
    ds_read_b64_tr_b16 a[210:211], v22 offset:4096
    v_mfma_f32_16x16x32_bf16 v[72:75], a[168:171], v[192:195], v[72:75]
    s_waitcnt lgkmcnt(10)
    buffer_load_dwordx4 v49, s[20:23], s49 offen offset:3072 lds
    v_mfma_f32_16x16x32_bf16 v[72:75], a[172:175], v[176:179], v[72:75]
    s_waitcnt lgkmcnt(8)
    ds_read_b64_tr_b16 a[212:213], v22 offset:8192
    ds_read_b64_tr_b16 a[214:215], v22 offset:12288
    v_mfma_f32_16x16x32_bf16 v[72:75], a[176:179], v[136:139], v[72:75]
    s_waitcnt lgkmcnt(8)
    ds_read_b64_tr_b16 a[216:217], v22 offset:16384
    v_mfma_f32_16x16x32_bf16 v[72:75], a[180:183], v[152:155], v[72:75]
    s_waitcnt lgkmcnt(7)
    ds_read_b64_tr_b16 a[218:219], v22 offset:20480
    v_mfma_f32_16x16x32_bf16 v[72:75], a[184:187], v[200:203], v[72:75]
    s_waitcnt lgkmcnt(6)
    ds_read_b64_tr_b16 a[220:221], v22 offset:24576
    v_mfma_f32_16x16x32_bf16 v[72:75], a[188:191], v[184:187], v[72:75]
    ds_read_b64_tr_b16 a[222:223], v22 offset:28672
    v_mfma_f32_16x16x32_bf16 v[76:79], a[160:163], v[132:135], 0
    ds_read_b64_tr_b16 a[224:225], v26 offset:0
    v_mfma_f32_16x16x32_bf16 v[76:79], a[164:167], v[148:151], v[76:79]
    ds_read_b64_tr_b16 a[226:227], v26 offset:4096
    v_mfma_f32_16x16x32_bf16 v[76:79], a[168:171], v[196:199], v[76:79]
    ds_read_b64_tr_b16 a[228:229], v26 offset:8192
    v_mfma_f32_16x16x32_bf16 v[76:79], a[172:175], v[180:183], v[76:79]
    ds_read_b64_tr_b16 a[230:231], v26 offset:12288
    v_mfma_f32_16x16x32_bf16 v[76:79], a[176:179], v[140:143], v[76:79]
    ds_read_b64_tr_b16 a[232:233], v26 offset:16384
    v_mfma_f32_16x16x32_bf16 v[76:79], a[180:183], v[156:159], v[76:79]
    ds_read_b64_tr_b16 a[234:235], v26 offset:20480
    v_mfma_f32_16x16x32_bf16 v[76:79], a[184:187], v[204:207], v[76:79]
    buffer_load_dword v63, v63, s[88:91], 0 offen sc1
    v_mfma_f32_16x16x32_bf16 v[76:79], a[188:191], v[188:191], v[76:79]
    s_waitcnt lgkmcnt(12)
    ds_read_b64_tr_b16 a[236:237], v26 offset:24576
    ds_read_b64_tr_b16 a[238:239], v26 offset:28672
    v_mfma_f32_16x16x32_bf16 v[80:83], a[208:211], v[128:131], 0
    s_waitcnt lgkmcnt(12)
    ds_read_b64_tr_b16 a[160:161], v23 offset:0
    v_mfma_f32_16x16x32_bf16 v[80:83], a[212:215], v[144:147], v[80:83]
    s_waitcnt lgkmcnt(11)
    ds_read_b64_tr_b16 a[162:163], v23 offset:4096
    v_mfma_f32_16x16x32_bf16 v[80:83], a[216:219], v[192:195], v[80:83]
    s_waitcnt lgkmcnt(10)
    ds_read_b64_tr_b16 a[164:165], v23 offset:8192
    v_mfma_f32_16x16x32_bf16 v[80:83], a[220:223], v[176:179], v[80:83]
    s_waitcnt lgkmcnt(9)
    ds_read_b64_tr_b16 a[166:167], v23 offset:12288
    v_mfma_f32_16x16x32_bf16 v[80:83], a[224:227], v[136:139], v[80:83]
    s_waitcnt lgkmcnt(8)
    ds_read_b64_tr_b16 a[168:169], v23 offset:16384
    v_mfma_f32_16x16x32_bf16 v[80:83], a[228:231], v[152:155], v[80:83]
    s_waitcnt lgkmcnt(7)
    ds_read_b64_tr_b16 a[170:171], v23 offset:20480
    v_mfma_f32_16x16x32_bf16 v[80:83], a[232:235], v[200:203], v[80:83]
    s_waitcnt lgkmcnt(6)
    ds_read_b64_tr_b16 a[172:173], v23 offset:24576
    v_mfma_f32_16x16x32_bf16 v[80:83], a[236:239], v[184:187], v[80:83]
    ds_read_b64_tr_b16 a[174:175], v23 offset:28672
    v_mfma_f32_16x16x32_bf16 v[84:87], a[208:211], v[132:135], 0
    ds_read_b64_tr_b16 a[176:177], v27 offset:0
    v_mfma_f32_16x16x32_bf16 v[84:87], a[212:215], v[148:151], v[84:87]
    ds_read_b64_tr_b16 a[178:179], v27 offset:4096
    v_mfma_f32_16x16x32_bf16 v[84:87], a[216:219], v[196:199], v[84:87]
    ds_read_b64_tr_b16 a[180:181], v27 offset:8192
    v_mfma_f32_16x16x32_bf16 v[84:87], a[220:223], v[180:183], v[84:87]
    ds_read_b64_tr_b16 a[182:183], v27 offset:12288
    v_mfma_f32_16x16x32_bf16 v[84:87], a[224:227], v[140:143], v[84:87]
    ds_read_b64_tr_b16 a[184:185], v27 offset:16384
    v_mfma_f32_16x16x32_bf16 v[84:87], a[228:231], v[156:159], v[84:87]
    ds_read_b64_tr_b16 a[186:187], v27 offset:20480
    v_mfma_f32_16x16x32_bf16 v[84:87], a[232:235], v[204:207], v[84:87]
    ds_read_b64_tr_b16 a[188:189], v27 offset:24576
    v_mfma_f32_16x16x32_bf16 v[84:87], a[236:239], v[188:191], v[84:87]
    s_waitcnt lgkmcnt(13)
    ds_read_b64_tr_b16 a[190:191], v27 offset:28672
    s_waitcnt vmcnt(13)
    s_barrier
    v_mfma_f32_16x16x32_bf16 v[88:91], a[160:163], v[128:131], 0
    s_waitcnt lgkmcnt(12)
    ds_read_b64_tr_b16 a[208:209], v12 offset:32768
    v_mfma_f32_16x16x32_bf16 v[88:91], a[164:167], v[144:147], v[88:91]
    s_waitcnt lgkmcnt(11)
    ds_read_b64_tr_b16 a[210:211], v12 offset:36864
    v_mfma_f32_16x16x32_bf16 v[88:91], a[168:171], v[192:195], v[88:91]
    s_waitcnt lgkmcnt(10)
    ds_read_b64_tr_b16 a[212:213], v12 offset:40960
    v_mfma_f32_16x16x32_bf16 v[88:91], a[172:175], v[176:179], v[88:91]
    s_waitcnt lgkmcnt(9)
    ds_read_b64_tr_b16 a[214:215], v12 offset:45056
    v_mfma_f32_16x16x32_bf16 v[88:91], a[176:179], v[136:139], v[88:91]
    s_waitcnt lgkmcnt(8)
    ds_read_b64_tr_b16 a[216:217], v12 offset:49152
    v_mfma_f32_16x16x32_bf16 v[88:91], a[180:183], v[152:155], v[88:91]
    s_waitcnt lgkmcnt(7)
    ds_read_b64_tr_b16 a[218:219], v12 offset:53248
    v_mfma_f32_16x16x32_bf16 v[88:91], a[184:187], v[200:203], v[88:91]
    s_waitcnt lgkmcnt(6)
    s_add_u32 s49, s46, 768
    ds_read_b64_tr_b16 a[220:221], v12 offset:57344
    v_mfma_f32_16x16x32_bf16 v[88:91], a[188:191], v[184:187], v[88:91]
    s_add_u32 m0, s42, 0
    ds_read_b64_tr_b16 a[222:223], v12 offset:61440
    v_mfma_f32_16x16x32_bf16 v[92:95], a[160:163], v[132:135], 0
    buffer_load_dwordx4 v46, s[20:23], s49 offen lds
    v_mfma_f32_16x16x32_bf16 v[92:95], a[164:167], v[148:151], v[92:95]
    ds_read_b64_tr_b16 a[224:225], v16 offset:32768
    ds_read_b64_tr_b16 a[226:227], v16 offset:36864
    v_mfma_f32_16x16x32_bf16 v[92:95], a[168:171], v[196:199], v[92:95]
    buffer_load_dwordx4 v47, s[20:23], s49 offen offset:1024 lds
    v_mfma_f32_16x16x32_bf16 v[92:95], a[172:175], v[180:183], v[92:95]
    ds_read_b64_tr_b16 a[228:229], v16 offset:40960
    ds_read_b64_tr_b16 a[230:231], v16 offset:45056
    v_mfma_f32_16x16x32_bf16 v[92:95], a[176:179], v[140:143], v[92:95]
    ds_read_b64_tr_b16 a[232:233], v16 offset:49152
    v_mfma_f32_16x16x32_bf16 v[92:95], a[180:183], v[156:159], v[92:95]
    ds_read_b64_tr_b16 a[234:235], v16 offset:53248
    v_mfma_f32_16x16x32_bf16 v[92:95], a[184:187], v[204:207], v[92:95]
    ds_read_b64_tr_b16 a[236:237], v16 offset:57344
    v_mfma_f32_16x16x32_bf16 v[92:95], a[188:191], v[188:191], v[92:95]
    s_waitcnt lgkmcnt(13)
    ds_read_b64_tr_b16 a[238:239], v16 offset:61440
    v_mfma_f32_16x16x32_bf16 v[64:67], a[208:211], a[64:67], v[64:67]
    s_waitcnt lgkmcnt(12)
    buffer_load_dwordx4 v48, s[20:23], s49 offen offset:2048 lds
    v_mfma_f32_16x16x32_bf16 v[64:67], a[212:215], a[68:71], v[64:67]
    s_waitcnt lgkmcnt(10)
    ds_read_b64_tr_b16 a[160:161], v13 offset:32768
    ds_read_b64_tr_b16 a[162:163], v13 offset:36864
    v_mfma_f32_16x16x32_bf16 v[64:67], a[216:219], a[72:75], v[64:67]
    s_waitcnt lgkmcnt(10)
    s_add_u32 s92, s92, 16
    buffer_load_dwordx4 v49, s[20:23], s49 offen offset:3072 lds
    v_mfma_f32_16x16x32_bf16 v[64:67], a[220:223], a[76:79], v[64:67]
    s_waitcnt lgkmcnt(8)
    s_waitcnt vmcnt(9)
    ds_read_b64_tr_b16 a[164:165], v13 offset:40960
    ds_read_b64_tr_b16 a[166:167], v13 offset:45056
    v_mfma_f32_16x16x32_bf16 v[64:67], a[224:227], a[80:83], v[64:67]
    s_waitcnt lgkmcnt(8)
    buffer_store_dword v10, v8, s[24:27], s92 offen sc1
    v_mfma_f32_16x16x32_bf16 v[64:67], a[228:231], a[84:87], v[64:67]
    s_waitcnt lgkmcnt(6)
    ds_read_b64_tr_b16 a[168:169], v13 offset:49152
    ds_read_b64_tr_b16 a[170:171], v13 offset:53248
    v_mfma_f32_16x16x32_bf16 v[64:67], a[232:235], a[88:91], v[64:67]
    s_waitcnt lgkmcnt(6)
    s_add_u32 s49, s46, 74496
    ds_read_b64_tr_b16 a[172:173], v13 offset:57344
    v_mfma_f32_16x16x32_bf16 v[64:67], a[236:239], a[92:95], v[64:67]
    s_add_u32 m0, s42, 16384
    ds_read_b64_tr_b16 a[174:175], v13 offset:61440
    v_mfma_f32_16x16x32_bf16 v[68:71], a[208:211], a[96:99], v[68:71]
    buffer_load_dwordx4 v46, s[20:23], s49 offen lds
    v_mfma_f32_16x16x32_bf16 v[68:71], a[212:215], a[100:103], v[68:71]
    ds_read_b64_tr_b16 a[176:177], v17 offset:32768
    ds_read_b64_tr_b16 a[178:179], v17 offset:36864
    v_mfma_f32_16x16x32_bf16 v[68:71], a[216:219], a[104:107], v[68:71]
    buffer_load_dwordx4 v47, s[20:23], s49 offen offset:1024 lds
    v_mfma_f32_16x16x32_bf16 v[68:71], a[220:223], a[108:111], v[68:71]
    ds_read_b64_tr_b16 a[180:181], v17 offset:40960
    ds_read_b64_tr_b16 a[182:183], v17 offset:45056
    v_mfma_f32_16x16x32_bf16 v[68:71], a[224:227], a[112:115], v[68:71]
    ds_read_b64_tr_b16 a[184:185], v17 offset:49152
    v_cvt_pk_bf16_f32 v224, v64, v65
    v_mfma_f32_16x16x32_bf16 v[68:71], a[228:231], a[116:119], v[68:71]
    ds_read_b64_tr_b16 a[186:187], v17 offset:53248
    v_cvt_pk_bf16_f32 v225, v66, v67
    v_mfma_f32_16x16x32_bf16 v[68:71], a[232:235], a[120:123], v[68:71]
    ds_read_b64_tr_b16 a[188:189], v17 offset:57344
    v_mfma_f32_16x16x32_bf16 v[68:71], a[236:239], a[124:127], v[68:71]
    s_waitcnt lgkmcnt(13)
    ds_read_b64_tr_b16 a[190:191], v17 offset:61440
    v_mfma_f32_16x16x32_bf16 v[72:75], a[160:163], a[64:67], v[72:75]
    s_waitcnt lgkmcnt(12)
    buffer_load_dwordx4 v48, s[20:23], s49 offen offset:2048 lds
    v_mfma_f32_16x16x32_bf16 v[72:75], a[164:167], a[68:71], v[72:75]
    s_waitcnt lgkmcnt(10)
    ds_read_b64_tr_b16 a[208:209], v14 offset:32768
    ds_read_b64_tr_b16 a[210:211], v14 offset:36864
    v_mfma_f32_16x16x32_bf16 v[72:75], a[168:171], a[72:75], v[72:75]
    s_waitcnt lgkmcnt(10)
    buffer_load_dwordx4 v49, s[20:23], s49 offen offset:3072 lds
    v_mfma_f32_16x16x32_bf16 v[72:75], a[172:175], a[76:79], v[72:75]
    s_waitcnt lgkmcnt(8)
    ds_read_b64_tr_b16 a[212:213], v14 offset:40960
    ds_read_b64_tr_b16 a[214:215], v14 offset:45056
    v_mfma_f32_16x16x32_bf16 v[72:75], a[176:179], a[80:83], v[72:75]
    s_waitcnt lgkmcnt(8)
    ds_read_b64_tr_b16 a[216:217], v14 offset:49152
    v_cvt_pk_bf16_f32 v228, v68, v69
    v_mfma_f32_16x16x32_bf16 v[72:75], a[180:183], a[84:87], v[72:75]
    s_waitcnt lgkmcnt(7)
    ds_read_b64_tr_b16 a[218:219], v14 offset:53248
    v_cvt_pk_bf16_f32 v229, v70, v71
    v_mfma_f32_16x16x32_bf16 v[72:75], a[184:187], a[88:91], v[72:75]
    s_waitcnt lgkmcnt(6)
    s_and_b32 s42, s2, 7
    ds_read_b64_tr_b16 a[220:221], v14 offset:57344
    v_mfma_f32_16x16x32_bf16 v[72:75], a[188:191], a[92:95], v[72:75]
    s_mov_b64 s[20:21], s[52:53]
    ds_read_b64_tr_b16 a[222:223], v14 offset:61440
    v_mfma_f32_16x16x32_bf16 v[76:79], a[160:163], a[96:99], v[76:79]
    ds_read_b64_tr_b16 a[224:225], v18 offset:32768
    s_waitcnt vmcnt(9)
    v_readfirstlane_b32 s37, v63
    v_mfma_f32_16x16x32_bf16 v[76:79], a[164:167], a[100:103], v[76:79]
    s_mov_b32 s22, 1152
    ds_read_b64_tr_b16 a[226:227], v18 offset:36864
    v_mfma_f32_16x16x32_bf16 v[76:79], a[168:171], a[104:107], v[76:79]
    s_mov_b32 s23, 0x20000
    ds_read_b64_tr_b16 a[228:229], v18 offset:40960
    s_cmp_lt_u32 s37, 256
    s_cbranch_scc1 Lattn_armwait
Lattn_armed:
    v_mfma_f32_16x16x32_bf16 v[76:79], a[172:175], a[108:111], v[76:79]
    ds_read_b64_tr_b16 a[230:231], v18 offset:45056
    v_mfma_f32_16x16x32_bf16 v[76:79], a[176:179], a[112:115], v[76:79]
    ds_read_b64_tr_b16 a[232:233], v18 offset:49152
    v_cvt_pk_bf16_f32 v226, v72, v73
    v_mfma_f32_16x16x32_bf16 v[76:79], a[180:183], a[116:119], v[76:79]
    s_add_u32 s38, s93, 1024
    ds_read_b64_tr_b16 a[234:235], v18 offset:53248
    v_cvt_pk_bf16_f32 v227, v74, v75
    v_mfma_f32_16x16x32_bf16 v[76:79], a[184:187], a[120:123], v[76:79]
    buffer_store_dwordx4 v[224:227], v56, s[28:31], s38 offen sc1
    v_mfma_f32_16x16x32_bf16 v[76:79], a[188:191], a[124:127], v[76:79]
    s_waitcnt lgkmcnt(12)
    s_mov_b32 s45, 18688
    ds_read_b64_tr_b16 a[236:237], v18 offset:57344
    ds_read_b64_tr_b16 a[238:239], v18 offset:61440
    v_mfma_f32_16x16x32_bf16 v[80:83], a[208:211], a[64:67], v[80:83]
    s_waitcnt lgkmcnt(12)
    buffer_load_dwordx4 v[160:163], v5, s[24:27], s45 offen offset:0 sc1
    v_mfma_f32_16x16x32_bf16 v[80:83], a[212:215], a[68:71], v[80:83]
    s_waitcnt lgkmcnt(10)
    ds_read_b64_tr_b16 a[160:161], v15 offset:32768
    ds_read_b64_tr_b16 a[162:163], v15 offset:36864
    v_mfma_f32_16x16x32_bf16 v[80:83], a[216:219], a[72:75], v[80:83]
    s_waitcnt lgkmcnt(10)
    ds_read_b64_tr_b16 a[164:165], v15 offset:40960
    v_mfma_f32_16x16x32_bf16 v[80:83], a[220:223], a[76:79], v[80:83]
    s_waitcnt lgkmcnt(9)
    ds_read_b64_tr_b16 a[166:167], v15 offset:45056
    v_mfma_f32_16x16x32_bf16 v[80:83], a[224:227], a[80:83], v[80:83]
    s_waitcnt lgkmcnt(8)
    ds_read_b64_tr_b16 a[168:169], v15 offset:49152
    v_cvt_pk_bf16_f32 v230, v76, v77
    v_mfma_f32_16x16x32_bf16 v[80:83], a[228:231], a[84:87], v[80:83]
    s_waitcnt lgkmcnt(7)
    s_add_u32 s38, s93, 164864
    ds_read_b64_tr_b16 a[170:171], v15 offset:53248
    v_cvt_pk_bf16_f32 v231, v78, v79
    v_mfma_f32_16x16x32_bf16 v[80:83], a[232:235], a[88:91], v[80:83]
    s_waitcnt lgkmcnt(6)
    buffer_store_dwordx4 v[228:231], v56, s[28:31], s38 offen sc1
    v_mfma_f32_16x16x32_bf16 v[80:83], a[236:239], a[92:95], v[80:83]
    ds_read_b64_tr_b16 a[172:173], v15 offset:57344
    ds_read_b64_tr_b16 a[174:175], v15 offset:61440
    v_mfma_f32_16x16x32_bf16 v[84:87], a[208:211], a[96:99], v[84:87]
    buffer_load_dwordx4 v[164:167], v5, s[24:27], s45 offen offset:512 sc1
    v_mfma_f32_16x16x32_bf16 v[84:87], a[212:215], a[100:103], v[84:87]
    ds_read_b64_tr_b16 a[176:177], v19 offset:32768
    ds_read_b64_tr_b16 a[178:179], v19 offset:36864
    v_mfma_f32_16x16x32_bf16 v[84:87], a[216:219], a[104:107], v[84:87]
    ds_read_b64_tr_b16 a[180:181], v19 offset:40960
    v_mfma_f32_16x16x32_bf16 v[84:87], a[220:223], a[108:111], v[84:87]
    ds_read_b64_tr_b16 a[182:183], v19 offset:45056
    v_mfma_f32_16x16x32_bf16 v[84:87], a[224:227], a[112:115], v[84:87]
    ds_read_b64_tr_b16 a[184:185], v19 offset:49152
    v_cvt_pk_bf16_f32 v232, v80, v81
    v_mfma_f32_16x16x32_bf16 v[84:87], a[228:231], a[116:119], v[84:87]
    ds_read_b64_tr_b16 a[186:187], v19 offset:53248
    v_cvt_pk_bf16_f32 v233, v82, v83
    v_mfma_f32_16x16x32_bf16 v[84:87], a[232:235], a[120:123], v[84:87]
    buffer_load_dwordx4 v[168:171], v59, s[24:27], s45 offen offset:1024 sc1
    v_mfma_f32_16x16x32_bf16 v[84:87], a[236:239], a[124:127], v[84:87]
    s_waitcnt lgkmcnt(12)
    ds_read_b64_tr_b16 a[188:189], v19 offset:57344
    ds_read_b64_tr_b16 a[190:191], v19 offset:61440
    s_barrier
    v_mfma_f32_16x16x32_bf16 v[88:91], a[160:163], a[64:67], v[88:91]
    s_waitcnt lgkmcnt(12)
    ds_read_b64_tr_b16 a[208:209], v20 offset:32768
    v_mfma_f32_16x16x32_bf16 v[88:91], a[164:167], a[68:71], v[88:91]
    s_waitcnt lgkmcnt(11)
    s_mov_b32 s45, 20992
    ds_read_b64_tr_b16 a[210:211], v20 offset:36864
    v_mfma_f32_16x16x32_bf16 v[88:91], a[168:171], a[72:75], v[88:91]
    s_waitcnt lgkmcnt(10)
    buffer_load_dwordx4 v[172:175], v5, s[24:27], s45 offen offset:0 sc1
    v_mfma_f32_16x16x32_bf16 v[88:91], a[172:175], a[76:79], v[88:91]
    s_waitcnt lgkmcnt(8)
    ds_read_b64_tr_b16 a[212:213], v20 offset:40960
    ds_read_b64_tr_b16 a[214:215], v20 offset:45056
    v_mfma_f32_16x16x32_bf16 v[88:91], a[176:179], a[80:83], v[88:91]
    s_waitcnt lgkmcnt(8)
    ds_read_b64_tr_b16 a[216:217], v20 offset:49152
    v_cvt_pk_bf16_f32 v236, v84, v85
    v_mfma_f32_16x16x32_bf16 v[88:91], a[180:183], a[84:87], v[88:91]
    s_waitcnt lgkmcnt(7)
    ds_read_b64_tr_b16 a[218:219], v20 offset:53248
    v_cvt_pk_bf16_f32 v237, v86, v87
    v_mfma_f32_16x16x32_bf16 v[88:91], a[184:187], a[88:91], v[88:91]
    s_waitcnt lgkmcnt(6)
    ds_read_b64_tr_b16 a[220:221], v20 offset:57344
    v_mfma_f32_16x16x32_bf16 v[88:91], a[188:191], a[92:95], v[88:91]
    ds_read_b64_tr_b16 a[222:223], v20 offset:61440
    v_mfma_f32_16x16x32_bf16 v[92:95], a[160:163], a[96:99], v[92:95]
    buffer_load_dwordx4 v[208:211], v5, s[24:27], s45 offen offset:512 sc1
    v_mfma_f32_16x16x32_bf16 v[92:95], a[164:167], a[100:103], v[92:95]
    ds_read_b64_tr_b16 a[224:225], v24 offset:32768
    ds_read_b64_tr_b16 a[226:227], v24 offset:36864
    v_mfma_f32_16x16x32_bf16 v[92:95], a[168:171], a[104:107], v[92:95]
    ds_read_b64_tr_b16 a[228:229], v24 offset:40960
    v_mfma_f32_16x16x32_bf16 v[92:95], a[172:175], a[108:111], v[92:95]
    ds_read_b64_tr_b16 a[230:231], v24 offset:45056
    v_mfma_f32_16x16x32_bf16 v[92:95], a[176:179], a[112:115], v[92:95]
    ds_read_b64_tr_b16 a[232:233], v24 offset:49152
    v_cvt_pk_bf16_f32 v234, v88, v89
    v_mfma_f32_16x16x32_bf16 v[92:95], a[180:183], a[116:119], v[92:95]
    s_add_u32 s38, s93, 1152
    ds_read_b64_tr_b16 a[234:235], v24 offset:53248
    v_cvt_pk_bf16_f32 v235, v90, v91
    v_mfma_f32_16x16x32_bf16 v[92:95], a[184:187], a[120:123], v[92:95]
    buffer_store_dwordx4 v[232:235], v56, s[28:31], s38 offen sc1
    v_mfma_f32_16x16x32_bf16 v[92:95], a[188:191], a[124:127], v[92:95]
    s_waitcnt lgkmcnt(12)
    ds_read_b64_tr_b16 a[236:237], v24 offset:57344
    ds_read_b64_tr_b16 a[238:239], v24 offset:61440
    v_mfma_f32_16x16x32_bf16 v[96:99], a[208:211], v[128:131], 0
    s_waitcnt lgkmcnt(12)
    buffer_load_dwordx4 v[212:215], v59, s[24:27], s45 offen offset:1024 sc1
    v_mfma_f32_16x16x32_bf16 v[96:99], a[212:215], v[144:147], v[96:99]
    s_waitcnt lgkmcnt(10)
    ds_read_b64_tr_b16 a[160:161], v21 offset:32768
    ds_read_b64_tr_b16 a[162:163], v21 offset:36864
    v_mfma_f32_16x16x32_bf16 v[96:99], a[216:219], v[192:195], v[96:99]
    s_waitcnt lgkmcnt(10)
    ds_read_b64_tr_b16 a[164:165], v21 offset:40960
    v_mfma_f32_16x16x32_bf16 v[96:99], a[220:223], v[176:179], v[96:99]
    s_waitcnt lgkmcnt(9)
    ds_read_b64_tr_b16 a[166:167], v21 offset:45056
    v_mfma_f32_16x16x32_bf16 v[96:99], a[224:227], v[136:139], v[96:99]
    s_waitcnt lgkmcnt(8)
    ds_read_b64_tr_b16 a[168:169], v21 offset:49152
    v_cvt_pk_bf16_f32 v238, v92, v93
    v_mfma_f32_16x16x32_bf16 v[96:99], a[228:231], v[152:155], v[96:99]
    s_waitcnt lgkmcnt(7)
    s_add_u32 s38, s93, 164992
    ds_read_b64_tr_b16 a[170:171], v21 offset:53248
    v_cvt_pk_bf16_f32 v239, v94, v95
    v_mfma_f32_16x16x32_bf16 v[96:99], a[232:235], v[200:203], v[96:99]
    s_waitcnt lgkmcnt(6)
    buffer_store_dwordx4 v[236:239], v56, s[28:31], s38 offen sc1
    v_mfma_f32_16x16x32_bf16 v[96:99], a[236:239], v[184:187], v[96:99]
    ds_read_b64_tr_b16 a[172:173], v21 offset:57344
    ds_read_b64_tr_b16 a[174:175], v21 offset:61440
    v_mfma_f32_16x16x32_bf16 v[100:103], a[208:211], v[132:135], 0
    buffer_load_dwordx2 v[92:93], v58, s[12:15], 0 offen offset:1024
    v_mfma_f32_16x16x32_bf16 v[100:103], a[212:215], v[148:151], v[100:103]
    ds_read_b64_tr_b16 a[176:177], v25 offset:32768
    ds_read_b64_tr_b16 a[178:179], v25 offset:36864
    v_mfma_f32_16x16x32_bf16 v[100:103], a[216:219], v[196:199], v[100:103]
    ds_read_b64_tr_b16 a[180:181], v25 offset:40960
    v_mfma_f32_16x16x32_bf16 v[100:103], a[220:223], v[180:183], v[100:103]
    ds_read_b64_tr_b16 a[182:183], v25 offset:45056
    v_mfma_f32_16x16x32_bf16 v[100:103], a[224:227], v[140:143], v[100:103]
    buffer_load_dwordx2 v[94:95], v58, s[12:15], 0 offen offset:1056
    v_mfma_f32_16x16x32_bf16 v[100:103], a[228:231], v[156:159], v[100:103]
    ds_read_b64_tr_b16 a[184:185], v25 offset:49152
    ds_read_b64_tr_b16 a[186:187], v25 offset:53248
    v_mfma_f32_16x16x32_bf16 v[100:103], a[232:235], v[204:207], v[100:103]
    ds_read_b64_tr_b16 a[188:189], v25 offset:57344
    v_mfma_f32_16x16x32_bf16 v[100:103], a[236:239], v[188:191], v[100:103]
    s_waitcnt lgkmcnt(13)
    ds_read_b64_tr_b16 a[190:191], v25 offset:61440
    v_mfma_f32_16x16x32_bf16 v[104:107], a[160:163], v[128:131], 0
    s_waitcnt lgkmcnt(12)
    ds_read_b64_tr_b16 a[208:209], v22 offset:32768
    v_mfma_f32_16x16x32_bf16 v[104:107], a[164:167], v[144:147], v[104:107]
    s_waitcnt lgkmcnt(11)
    s_mov_b32 s45, 19840
    ds_read_b64_tr_b16 a[210:211], v22 offset:36864
    v_mfma_f32_16x16x32_bf16 v[104:107], a[168:171], v[192:195], v[104:107]
    s_waitcnt lgkmcnt(10)
    buffer_load_dwordx4 v[64:67], v5, s[24:27], s45 offen offset:0 sc1
    v_mfma_f32_16x16x32_bf16 v[104:107], a[172:175], v[176:179], v[104:107]
    s_waitcnt lgkmcnt(8)
    ds_read_b64_tr_b16 a[212:213], v22 offset:40960
    ds_read_b64_tr_b16 a[214:215], v22 offset:45056
    v_mfma_f32_16x16x32_bf16 v[104:107], a[176:179], v[136:139], v[104:107]
    s_waitcnt lgkmcnt(8)
    ds_read_b64_tr_b16 a[216:217], v22 offset:49152
    v_mfma_f32_16x16x32_bf16 v[104:107], a[180:183], v[152:155], v[104:107]
Ltour11:
    s_cbranch_execz Ltour15
    s_waitcnt lgkmcnt(7)
    ds_read_b64_tr_b16 a[218:219], v22 offset:53248
    v_mfma_f32_16x16x32_bf16 v[104:107], a[184:187], v[200:203], v[104:107]
    s_waitcnt lgkmcnt(6)
    buffer_load_dwordx4 v[68:71], v5, s[24:27], s45 offen offset:512 sc1
    v_mfma_f32_16x16x32_bf16 v[104:107], a[188:191], v[184:187], v[104:107]
    ds_read_b64_tr_b16 a[220:221], v22 offset:57344
    ds_read_b64_tr_b16 a[222:223], v22 offset:61440
    v_mfma_f32_16x16x32_bf16 v[108:111], a[160:163], v[132:135], 0
    ds_read_b64_tr_b16 a[224:225], v26 offset:32768
    v_mfma_f32_16x16x32_bf16 v[108:111], a[164:167], v[148:151], v[108:111]
    ds_read_b64_tr_b16 a[226:227], v26 offset:36864
    v_mfma_f32_16x16x32_bf16 v[108:111], a[168:171], v[196:199], v[108:111]
    ds_read_b64_tr_b16 a[228:229], v26 offset:40960
    v_mfma_f32_16x16x32_bf16 v[108:111], a[172:175], v[180:183], v[108:111]
    ds_read_b64_tr_b16 a[230:231], v26 offset:45056
    v_mfma_f32_16x16x32_bf16 v[108:111], a[176:179], v[140:143], v[108:111]
    buffer_load_dwordx4 v[72:75], v59, s[24:27], s45 offen offset:1024 sc1
    v_mfma_f32_16x16x32_bf16 v[108:111], a[180:183], v[156:159], v[108:111]
    ds_read_b64_tr_b16 a[232:233], v26 offset:49152
    ds_read_b64_tr_b16 a[234:235], v26 offset:53248
    v_mfma_f32_16x16x32_bf16 v[108:111], a[184:187], v[204:207], v[108:111]
    ds_read_b64_tr_b16 a[236:237], v26 offset:57344
    v_mfma_f32_16x16x32_bf16 v[108:111], a[188:191], v[188:191], v[108:111]
    s_waitcnt lgkmcnt(13)
    ds_read_b64_tr_b16 a[238:239], v26 offset:61440
    v_mfma_f32_16x16x32_bf16 v[112:115], a[208:211], v[128:131], 0
    s_waitcnt lgkmcnt(12)
    ds_read_b64_tr_b16 a[160:161], v23 offset:32768
    v_mfma_f32_16x16x32_bf16 v[112:115], a[212:215], v[144:147], v[112:115]
    s_waitcnt lgkmcnt(11)
    ds_read_b64_tr_b16 a[162:163], v23 offset:36864
    v_mfma_f32_16x16x32_bf16 v[112:115], a[216:219], v[192:195], v[112:115]
    s_waitcnt lgkmcnt(10)
    buffer_load_dwordx2 v[76:77], v3, s[20:23], 0 offen offset:0
    v_mfma_f32_16x16x32_bf16 v[112:115], a[220:223], v[176:179], v[112:115]
    s_waitcnt lgkmcnt(8)
    ds_read_b64_tr_b16 a[164:165], v23 offset:40960
    ds_read_b64_tr_b16 a[166:167], v23 offset:45056
    v_mfma_f32_16x16x32_bf16 v[112:115], a[224:227], v[136:139], v[112:115]
    s_waitcnt lgkmcnt(8)
    ds_read_b64_tr_b16 a[168:169], v23 offset:49152
    v_mfma_f32_16x16x32_bf16 v[112:115], a[228:231], v[152:155], v[112:115]
    s_waitcnt lgkmcnt(7)
    ds_read_b64_tr_b16 a[170:171], v23 offset:53248
    v_mfma_f32_16x16x32_bf16 v[112:115], a[232:235], v[200:203], v[112:115]
    s_waitcnt lgkmcnt(6)
    buffer_load_dwordx2 v[78:79], v3, s[20:23], 0 offen offset:32
    v_mfma_f32_16x16x32_bf16 v[112:115], a[236:239], v[184:187], v[112:115]
    ds_read_b64_tr_b16 a[172:173], v23 offset:57344
    ds_read_b64_tr_b16 a[174:175], v23 offset:61440
    v_mfma_f32_16x16x32_bf16 v[116:119], a[208:211], v[132:135], 0
    ds_read_b64_tr_b16 a[176:177], v27 offset:32768
    v_mfma_f32_16x16x32_bf16 v[116:119], a[212:215], v[148:151], v[116:119]
    ds_read_b64_tr_b16 a[178:179], v27 offset:36864
    v_mfma_f32_16x16x32_bf16 v[116:119], a[216:219], v[196:199], v[116:119]
    ds_read_b64_tr_b16 a[180:181], v27 offset:40960
    v_mfma_f32_16x16x32_bf16 v[116:119], a[220:223], v[180:183], v[116:119]
    ds_read_b64_tr_b16 a[182:183], v27 offset:45056
    v_mfma_f32_16x16x32_bf16 v[116:119], a[224:227], v[140:143], v[116:119]
    buffer_load_dwordx2 v[80:81], v3, s[20:23], 0 offen offset:512
    v_mfma_f32_16x16x32_bf16 v[116:119], a[228:231], v[156:159], v[116:119]
    ds_read_b64_tr_b16 a[184:185], v27 offset:49152
    ds_read_b64_tr_b16 a[186:187], v27 offset:53248
    v_mfma_f32_16x16x32_bf16 v[116:119], a[232:235], v[204:207], v[116:119]
    ds_read_b64_tr_b16 a[188:189], v27 offset:57344
    v_mfma_f32_16x16x32_bf16 v[116:119], a[236:239], v[188:191], v[116:119]
    ds_read_b64_tr_b16 a[190:191], v27 offset:61440
    s_waitcnt vmcnt(18)
    s_waitcnt lgkmcnt(0)
    s_barrier
    v_mfma_f32_16x16x32_bf16 v[120:123], a[160:163], v[128:131], 0
    ds_read_b64_tr_b16 a[208:209], v12 offset:0
    v_mfma_f32_16x16x32_bf16 v[120:123], a[164:167], v[144:147], v[120:123]
    ds_read_b64_tr_b16 a[210:211], v12 offset:4096
    v_mfma_f32_16x16x32_bf16 v[120:123], a[168:171], v[192:195], v[120:123]
    buffer_load_dwordx2 v[82:83], v3, s[20:23], 0 offen offset:544
    v_mfma_f32_16x16x32_bf16 v[120:123], a[172:175], v[176:179], v[120:123]
    s_add_u32 s39, s39, 16
    ds_read_b64_tr_b16 a[212:213], v12 offset:8192
    ds_read_b64_tr_b16 a[214:215], v12 offset:12288
    v_mfma_f32_16x16x32_bf16 v[120:123], a[176:179], v[136:139], v[120:123]
    buffer_load_dword v11, v9, s[24:27], s39 offen sc1
    v_mfma_f32_16x16x32_bf16 v[120:123], a[180:183], v[152:155], v[120:123]
    ds_read_b64_tr_b16 a[216:217], v12 offset:16384
    ds_read_b64_tr_b16 a[218:219], v12 offset:20480
    v_mfma_f32_16x16x32_bf16 v[120:123], a[184:187], v[200:203], v[120:123]
    ds_read_b64_tr_b16 a[220:221], v12 offset:24576
    v_mfma_f32_16x16x32_bf16 v[120:123], a[188:191], v[184:187], v[120:123]
    ds_read_b64_tr_b16 a[222:223], v12 offset:28672
    v_mfma_f32_16x16x32_bf16 v[124:127], a[160:163], v[132:135], 0
    buffer_load_dwordx2 v[84:85], v55, s[20:23], 0 offen offset:1024
    v_mfma_f32_16x16x32_bf16 v[124:127], a[164:167], v[148:151], v[124:127]
    ds_read_b64_tr_b16 a[224:225], v16 offset:0
    ds_read_b64_tr_b16 a[226:227], v16 offset:4096
    v_mfma_f32_16x16x32_bf16 v[124:127], a[168:171], v[196:199], v[124:127]
    ds_read_b64_tr_b16 a[228:229], v16 offset:8192
    v_mfma_f32_16x16x32_bf16 v[124:127], a[172:175], v[180:183], v[124:127]
    ds_read_b64_tr_b16 a[230:231], v16 offset:12288
    v_mfma_f32_16x16x32_bf16 v[124:127], a[176:179], v[140:143], v[124:127]
    ds_read_b64_tr_b16 a[232:233], v16 offset:16384
    v_mfma_f32_16x16x32_bf16 v[124:127], a[180:183], v[156:159], v[124:127]
    ds_read_b64_tr_b16 a[234:235], v16 offset:20480
    v_mfma_f32_16x16x32_bf16 v[124:127], a[184:187], v[204:207], v[124:127]
    buffer_load_dwordx2 v[86:87], v55, s[20:23], 0 offen offset:1056
    v_mfma_f32_16x16x32_bf16 v[124:127], a[188:191], v[188:191], v[124:127]
    s_waitcnt lgkmcnt(12)
    ds_read_b64_tr_b16 a[236:237], v16 offset:24576
    ds_read_b64_tr_b16 a[238:239], v16 offset:28672
    v_mfma_f32_16x16x32_bf16 v[96:99], a[208:211], a[64:67], v[96:99]
    s_waitcnt lgkmcnt(12)
    ds_read_b64_tr_b16 a[160:161], v13 offset:0
    v_mfma_f32_16x16x32_bf16 v[96:99], a[212:215], a[68:71], v[96:99]
    s_waitcnt lgkmcnt(11)
    ds_read_b64_tr_b16 a[162:163], v13 offset:4096
    v_mfma_f32_16x16x32_bf16 v[96:99], a[216:219], a[72:75], v[96:99]
    s_waitcnt lgkmcnt(10)
    ds_read_b64_tr_b16 a[164:165], v13 offset:8192
    v_mfma_f32_16x16x32_bf16 v[96:99], a[220:223], a[76:79], v[96:99]
    s_waitcnt lgkmcnt(9)
    s_mov_b32 s45, 22144
    ds_read_b64_tr_b16 a[166:167], v13 offset:12288
    v_mfma_f32_16x16x32_bf16 v[96:99], a[224:227], a[80:83], v[96:99]
    s_waitcnt lgkmcnt(8)
    buffer_load_dwordx4 v[216:219], v5, s[24:27], s45 offen offset:0 sc1
    v_mfma_f32_16x16x32_bf16 v[96:99], a[228:231], a[84:87], v[96:99]
    s_waitcnt lgkmcnt(6)
    ds_read_b64_tr_b16 a[168:169], v13 offset:16384
    ds_read_b64_tr_b16 a[170:171], v13 offset:20480
    v_mfma_f32_16x16x32_bf16 v[96:99], a[232:235], a[88:91], v[96:99]
    s_waitcnt lgkmcnt(6)
    ds_read_b64_tr_b16 a[172:173], v13 offset:24576
    v_mfma_f32_16x16x32_bf16 v[96:99], a[236:239], a[92:95], v[96:99]
    ds_read_b64_tr_b16 a[174:175], v13 offset:28672
    v_mfma_f32_16x16x32_bf16 v[100:103], a[208:211], a[96:99], v[100:103]
    buffer_load_dwordx4 v[220:223], v5, s[24:27], s45 offen offset:512 sc1
    v_mfma_f32_16x16x32_bf16 v[100:103], a[212:215], a[100:103], v[100:103]
    ds_read_b64_tr_b16 a[176:177], v17 offset:0
    ds_read_b64_tr_b16 a[178:179], v17 offset:4096
    v_mfma_f32_16x16x32_bf16 v[100:103], a[216:219], a[104:107], v[100:103]
    ds_read_b64_tr_b16 a[180:181], v17 offset:8192
    v_mfma_f32_16x16x32_bf16 v[100:103], a[220:223], a[108:111], v[100:103]
    ds_read_b64_tr_b16 a[182:183], v17 offset:12288
    v_mfma_f32_16x16x32_bf16 v[100:103], a[224:227], a[112:115], v[100:103]
    ds_read_b64_tr_b16 a[184:185], v17 offset:16384
    v_cvt_pk_bf16_f32 v224, v96, v97
    v_mfma_f32_16x16x32_bf16 v[100:103], a[228:231], a[116:119], v[100:103]
    ds_read_b64_tr_b16 a[186:187], v17 offset:20480
    v_cvt_pk_bf16_f32 v225, v98, v99
    v_mfma_f32_16x16x32_bf16 v[100:103], a[232:235], a[120:123], v[100:103]
    ds_read_b64_tr_b16 a[188:189], v17 offset:24576
    v_mfma_f32_16x16x32_bf16 v[100:103], a[236:239], a[124:127], v[100:103]
    s_waitcnt lgkmcnt(13)
    ds_read_b64_tr_b16 a[190:191], v17 offset:28672
    v_mfma_f32_16x16x32_bf16 v[104:107], a[160:163], a[64:67], v[104:107]
    s_waitcnt lgkmcnt(12)
    buffer_load_dwordx4 v[88:91], v59, s[24:27], s45 offen offset:1024 sc1
    v_mfma_f32_16x16x32_bf16 v[104:107], a[164:167], a[68:71], v[104:107]
    s_waitcnt lgkmcnt(10)
    ds_read_b64_tr_b16 a[208:209], v14 offset:0
    ds_read_b64_tr_b16 a[210:211], v14 offset:4096
    v_mfma_f32_16x16x32_bf16 v[104:107], a[168:171], a[72:75], v[104:107]
    s_waitcnt lgkmcnt(10)
    ds_read_b64_tr_b16 a[212:213], v14 offset:8192
    v_mfma_f32_16x16x32_bf16 v[104:107], a[172:175], a[76:79], v[104:107]
    s_waitcnt lgkmcnt(9)
    ds_read_b64_tr_b16 a[214:215], v14 offset:12288
    v_mfma_f32_16x16x32_bf16 v[104:107], a[176:179], a[80:83], v[104:107]
    s_waitcnt lgkmcnt(8)
    ds_read_b64_tr_b16 a[216:217], v14 offset:16384
    v_cvt_pk_bf16_f32 v228, v100, v101
    v_mfma_f32_16x16x32_bf16 v[104:107], a[180:183], a[84:87], v[104:107]
    s_waitcnt lgkmcnt(7)
    ds_read_b64_tr_b16 a[218:219], v14 offset:20480
    v_cvt_pk_bf16_f32 v229, v102, v103
    v_mfma_f32_16x16x32_bf16 v[104:107], a[184:187], a[88:91], v[104:107]
    s_waitcnt lgkmcnt(6)
    ds_read_b64_tr_b16 a[220:221], v14 offset:24576
    v_mfma_f32_16x16x32_bf16 v[104:107], a[188:191], a[92:95], v[104:107]
    ds_read_b64_tr_b16 a[222:223], v14 offset:28672
    v_mfma_f32_16x16x32_bf16 v[108:111], a[160:163], a[96:99], v[108:111]
    ds_read_b64_tr_b16 a[224:225], v18 offset:0
    v_mfma_f32_16x16x32_bf16 v[108:111], a[164:167], a[100:103], v[108:111]
    ds_read_b64_tr_b16 a[226:227], v18 offset:4096
    v_mfma_f32_16x16x32_bf16 v[108:111], a[168:171], a[104:107], v[108:111]
    ds_read_b64_tr_b16 a[228:229], v18 offset:8192
    v_mfma_f32_16x16x32_bf16 v[108:111], a[172:175], a[108:111], v[108:111]
    ds_read_b64_tr_b16 a[230:231], v18 offset:12288
    v_mfma_f32_16x16x32_bf16 v[108:111], a[176:179], a[112:115], v[108:111]
    ds_read_b64_tr_b16 a[232:233], v18 offset:16384
    v_cvt_pk_bf16_f32 v226, v104, v105
    v_mfma_f32_16x16x32_bf16 v[108:111], a[180:183], a[116:119], v[108:111]
    s_add_u32 s38, s93, 1536
    ds_read_b64_tr_b16 a[234:235], v18 offset:20480
    v_cvt_pk_bf16_f32 v227, v106, v107
    v_mfma_f32_16x16x32_bf16 v[108:111], a[184:187], a[120:123], v[108:111]
    buffer_store_dwordx4 v[224:227], v56, s[28:31], s38 offen sc1
    v_mfma_f32_16x16x32_bf16 v[108:111], a[188:191], a[124:127], v[108:111]
    s_waitcnt lgkmcnt(12)
    ds_read_b64_tr_b16 a[236:237], v18 offset:24576
    ds_read_b64_tr_b16 a[238:239], v18 offset:28672
    v_mfma_f32_16x16x32_bf16 v[112:115], a[208:211], a[64:67], v[112:115]
    s_waitcnt lgkmcnt(12)
    ds_read_b64_tr_b16 a[160:161], v15 offset:0
    v_mfma_f32_16x16x32_bf16 v[112:115], a[212:215], a[68:71], v[112:115]
    s_waitcnt lgkmcnt(11)
    ds_read_b64_tr_b16 a[162:163], v15 offset:4096
    v_mfma_f32_16x16x32_bf16 v[112:115], a[216:219], a[72:75], v[112:115]
    s_waitcnt lgkmcnt(10)
    ds_read_b64_tr_b16 a[164:165], v15 offset:8192
    v_mfma_f32_16x16x32_bf16 v[112:115], a[220:223], a[76:79], v[112:115]
    s_waitcnt lgkmcnt(9)
    ds_read_b64_tr_b16 a[166:167], v15 offset:12288
    v_mfma_f32_16x16x32_bf16 v[112:115], a[224:227], a[80:83], v[112:115]
    s_waitcnt lgkmcnt(8)
    ds_read_b64_tr_b16 a[168:169], v15 offset:16384
    v_cvt_pk_bf16_f32 v230, v108, v109
    v_mfma_f32_16x16x32_bf16 v[112:115], a[228:231], a[84:87], v[112:115]
    s_waitcnt lgkmcnt(7)
    s_add_u32 s38, s93, 165376
    ds_read_b64_tr_b16 a[170:171], v15 offset:20480
    v_cvt_pk_bf16_f32 v231, v110, v111
    v_mfma_f32_16x16x32_bf16 v[112:115], a[232:235], a[88:91], v[112:115]
    s_waitcnt lgkmcnt(6)
    buffer_store_dwordx4 v[228:231], v56, s[28:31], s38 offen sc1
    v_mfma_f32_16x16x32_bf16 v[112:115], a[236:239], a[92:95], v[112:115]
    ds_read_b64_tr_b16 a[172:173], v15 offset:24576
    ds_read_b64_tr_b16 a[174:175], v15 offset:28672
    v_mfma_f32_16x16x32_bf16 v[116:119], a[208:211], a[96:99], v[116:119]
    ds_read_b64_tr_b16 a[176:177], v19 offset:0
    v_mfma_f32_16x16x32_bf16 v[116:119], a[212:215], a[100:103], v[116:119]
    ds_read_b64_tr_b16 a[178:179], v19 offset:4096
    v_mfma_f32_16x16x32_bf16 v[116:119], a[216:219], a[104:107], v[116:119]
    ds_read_b64_tr_b16 a[180:181], v19 offset:8192
    v_mfma_f32_16x16x32_bf16 v[116:119], a[220:223], a[108:111], v[116:119]
    ds_read_b64_tr_b16 a[182:183], v19 offset:12288
    v_mfma_f32_16x16x32_bf16 v[116:119], a[224:227], a[112:115], v[116:119]
    ds_read_b64_tr_b16 a[184:185], v19 offset:16384
    v_cvt_pk_bf16_f32 v232, v112, v113
    v_mfma_f32_16x16x32_bf16 v[116:119], a[228:231], a[116:119], v[116:119]
    ds_read_b64_tr_b16 a[186:187], v19 offset:20480
    v_cvt_pk_bf16_f32 v233, v114, v115
    v_mfma_f32_16x16x32_bf16 v[116:119], a[232:235], a[120:123], v[116:119]
    ds_read_b64_tr_b16 a[188:189], v19 offset:24576
    v_mfma_f32_16x16x32_bf16 v[116:119], a[236:239], a[124:127], v[116:119]
    s_waitcnt lgkmcnt(13)
    ds_read_b64_tr_b16 a[190:191], v19 offset:28672
    v_mfma_f32_16x16x32_bf16 v[120:123], a[160:163], a[64:67], v[120:123]
    s_waitcnt lgkmcnt(12)
    v_mfma_f32_16x16x32_bf16 v[120:123], a[164:167], a[68:71], v[120:123]
    s_waitcnt lgkmcnt(10)
    v_mfma_f32_16x16x32_bf16 v[120:123], a[168:171], a[72:75], v[120:123]
    s_waitcnt lgkmcnt(8)
    v_mfma_f32_16x16x32_bf16 v[120:123], a[172:175], a[76:79], v[120:123]
    s_waitcnt lgkmcnt(6)
    v_mfma_f32_16x16x32_bf16 v[120:123], a[176:179], a[80:83], v[120:123]
    s_waitcnt lgkmcnt(4)
    v_cvt_pk_bf16_f32 v236, v116, v117
    v_mfma_f32_16x16x32_bf16 v[120:123], a[180:183], a[84:87], v[120:123]
    s_waitcnt lgkmcnt(2)
    v_cvt_pk_bf16_f32 v237, v118, v119
    v_mfma_f32_16x16x32_bf16 v[120:123], a[184:187], a[88:91], v[120:123]
    s_waitcnt lgkmcnt(0)
    v_mfma_f32_16x16x32_bf16 v[120:123], a[188:191], a[92:95], v[120:123]
    v_mfma_f32_16x16x32_bf16 v[124:127], a[160:163], a[96:99], v[124:127]
    v_mfma_f32_16x16x32_bf16 v[124:127], a[164:167], a[100:103], v[124:127]
    v_mfma_f32_16x16x32_bf16 v[124:127], a[168:171], a[104:107], v[124:127]
    v_mfma_f32_16x16x32_bf16 v[124:127], a[172:175], a[108:111], v[124:127]
    v_mfma_f32_16x16x32_bf16 v[124:127], a[176:179], a[112:115], v[124:127]
    s_nop 2
    v_cvt_pk_bf16_f32 v234, v120, v121
    v_mfma_f32_16x16x32_bf16 v[124:127], a[180:183], a[116:119], v[124:127]
    s_add_u32 s38, s93, 1664
    v_cvt_pk_bf16_f32 v235, v122, v123
    v_mfma_f32_16x16x32_bf16 v[124:127], a[184:187], a[120:123], v[124:127]
    buffer_store_dwordx4 v[232:235], v56, s[28:31], s38 offen sc1
    v_mfma_f32_16x16x32_bf16 v[124:127], a[188:191], a[124:127], v[124:127]
    s_nop 7
    v_cvt_pk_bf16_f32 v238, v124, v125
    s_add_u32 s38, s93, 165504
    v_cvt_pk_bf16_f32 v239, v126, v127
    buffer_store_dwordx4 v[236:239], v56, s[28:31], s38 offen sc1
    s_add_u32 s92, s92, 16
    s_waitcnt vmcnt(27)
    v_lshlrev_b32 v96, 16, v160
    v_and_b32 v97, 0xffff0000, v160
    v_lshlrev_b32 v98, 16, v161
    v_and_b32 v99, 0xffff0000, v161
    v_lshlrev_b32 v100, 16, v162
    v_and_b32 v101, 0xffff0000, v162
    v_lshlrev_b32 v102, 16, v163
    v_and_b32 v103, 0xffff0000, v163
    s_waitcnt vmcnt(25)
    v_lshlrev_b32 v104, 16, v164
    v_and_b32 v105, 0xffff0000, v164
    v_lshlrev_b32 v106, 16, v165
    v_and_b32 v107, 0xffff0000, v165
    v_lshlrev_b32 v108, 16, v166
    v_and_b32 v109, 0xffff0000, v166
    v_lshlrev_b32 v110, 16, v167
    v_and_b32 v111, 0xffff0000, v167
    s_waitcnt vmcnt(24)
    v_lshlrev_b32 v112, 16, v168
    v_and_b32 v113, 0xffff0000, v168
    v_lshlrev_b32 v114, 16, v169
    v_and_b32 v115, 0xffff0000, v169
    v_lshlrev_b32 v116, 16, v170
    v_and_b32 v117, 0xffff0000, v170
    v_lshlrev_b32 v118, 16, v171
    v_and_b32 v119, 0xffff0000, v171
    s_waitcnt vmcnt(23)
    v_lshlrev_b32 v120, 16, v172
    v_and_b32 v121, 0xffff0000, v172
    v_lshlrev_b32 v122, 16, v173
    v_and_b32 v123, 0xffff0000, v173
    v_lshlrev_b32 v124, 16, v174
    v_and_b32 v125, 0xffff0000, v174
    v_lshlrev_b32 v126, 16, v175
    v_and_b32 v127, 0xffff0000, v175
    s_waitcnt vmcnt(22)
    v_lshlrev_b32 v128, 16, v208
    v_and_b32 v129, 0xffff0000, v208
    v_lshlrev_b32 v130, 16, v209
    v_and_b32 v131, 0xffff0000, v209
    v_lshlrev_b32 v132, 16, v210
    v_and_b32 v133, 0xffff0000, v210
    v_lshlrev_b32 v134, 16, v211
    v_and_b32 v135, 0xffff0000, v211
    s_waitcnt vmcnt(20)
    v_lshlrev_b32 v136, 16, v212
    v_and_b32 v137, 0xffff0000, v212
    v_lshlrev_b32 v138, 16, v213
    v_and_b32 v139, 0xffff0000, v213
    v_lshlrev_b32 v140, 16, v214
    v_and_b32 v141, 0xffff0000, v214
    v_lshlrev_b32 v142, 16, v215
    v_and_b32 v143, 0xffff0000, v215
    s_waitcnt vmcnt(16)
    v_lshlrev_b32 v144, 16, v64
    v_and_b32 v145, 0xffff0000, v64
    v_lshlrev_b32 v146, 16, v65
    v_and_b32 v147, 0xffff0000, v65
    v_lshlrev_b32 v148, 16, v66
    v_and_b32 v149, 0xffff0000, v66
    v_lshlrev_b32 v150, 16, v67
    v_and_b32 v151, 0xffff0000, v67
    s_waitcnt vmcnt(15)
    v_lshlrev_b32 v152, 16, v68
    v_and_b32 v153, 0xffff0000, v68
    v_lshlrev_b32 v154, 16, v69
    v_and_b32 v155, 0xffff0000, v69
    v_lshlrev_b32 v156, 16, v70
    v_and_b32 v157, 0xffff0000, v70
    v_lshlrev_b32 v158, 16, v71
    v_and_b32 v159, 0xffff0000, v71
    s_waitcnt vmcnt(14)
    v_lshlrev_b32 v160, 16, v72
    v_and_b32 v161, 0xffff0000, v72
    v_lshlrev_b32 v162, 16, v73
    v_and_b32 v163, 0xffff0000, v73
    v_lshlrev_b32 v164, 16, v74
    v_and_b32 v165, 0xffff0000, v74
    v_lshlrev_b32 v166, 16, v75
    v_and_b32 v167, 0xffff0000, v75
    s_waitcnt vmcnt(13)
    v_lshlrev_b32 v168, 16, v76
    v_and_b32 v169, 0xffff0000, v76
    v_lshlrev_b32 v170, 16, v77
    v_and_b32 v171, 0xffff0000, v77
    s_waitcnt vmcnt(12)
    v_lshlrev_b32 v172, 16, v78
    v_and_b32 v173, 0xffff0000, v78
    v_lshlrev_b32 v174, 16, v79
    v_and_b32 v175, 0xffff0000, v79
    s_waitcnt vmcnt(11)
    v_lshlrev_b32 v176, 16, v80
    v_and_b32 v177, 0xffff0000, v80
    v_lshlrev_b32 v178, 16, v81
    v_and_b32 v179, 0xffff0000, v81
    s_waitcnt vmcnt(10)
    v_lshlrev_b32 v180, 16, v82
    v_and_b32 v181, 0xffff0000, v82
    v_lshlrev_b32 v182, 16, v83
    v_and_b32 v183, 0xffff0000, v83
    s_waitcnt vmcnt(8)
    v_lshlrev_b32 v184, 16, v84
    v_and_b32 v185, 0xffff0000, v84
    v_lshlrev_b32 v186, 16, v85
    v_and_b32 v187, 0xffff0000, v85
    s_waitcnt vmcnt(7)
    v_lshlrev_b32 v188, 16, v86
    v_and_b32 v189, 0xffff0000, v86
    v_lshlrev_b32 v190, 16, v87
    v_and_b32 v191, 0xffff0000, v87
    s_waitcnt vmcnt(0)
    buffer_store_dword v10, v8, s[24:27], s92 offen sc1
    v_cmp_ne_u32 s[54:55], s95, v11
    s_cmp_lg_u64 s[54:55], 0
    s_cbranch_scc1 Ltail_spin1
Ltail_got1:
    s_add_u32 s56, s44, 16384
    buffer_load_dwordx4 a[0:3], v54, s[28:31], s56 offen offset:0 sc1
    buffer_load_dwordx4 a[4:7], v54, s[28:31], s56 offen offset:1024 sc1
    buffer_load_dwordx4 a[8:11], v54, s[28:31], s56 offen offset:2048 sc1
    buffer_load_dwordx4 a[12:15], v54, s[28:31], s56 offen offset:3072 sc1
    s_add_u32 s56, s44, 0
    buffer_load_dwordx4 a[16:19], v2, s[28:31], s56 offen offset:0 sc1
    s_add_u32 s56, s44, 4096
    buffer_load_dwordx4 a[20:23], v2, s[28:31], s56 offen offset:0 sc1
    s_add_u32 s56, s44, 8192
    buffer_load_dwordx4 a[24:27], v2, s[28:31], s56 offen offset:0 sc1
    s_add_u32 s56, s44, 12288
    buffer_load_dwordx4 a[28:31], v2, s[28:31], s56 offen offset:0 sc1
    ds_write_b128 v51, a[128:131] offset:0
    ds_write_b128 v51, a[132:135] offset:4096
    ds_write_b128 v51, a[136:139] offset:8192
    ds_write_b128 v51, a[140:143] offset:12288
    ds_write_b128 v51, a[144:147] offset:16384
    ds_write_b128 v51, a[148:151] offset:20480
    ds_write_b128 v51, a[152:155] offset:24576
    ds_write_b128 v51, a[156:159] offset:28672
    ds_write_b128 v51, a[240:243] offset:32768
    ds_write_b128 v255, a[244:247] offset:40960
    ds_write_b128 v255, a[248:251] offset:45056
    ds_write_b128 v255, a[252:255] offset:49152
    v_lshlrev_b32 v12, 16, v36
    v_and_b32 v13, 0xffff0000, v36
    v_lshlrev_b32 v14, 16, v37
    v_and_b32 v15, 0xffff0000, v37
    v_lshlrev_b32 v16, 16, v38
    v_and_b32 v17, 0xffff0000, v38
    v_lshlrev_b32 v18, 16, v39
    v_and_b32 v19, 0xffff0000, v39
    v_lshlrev_b32 v20, 16, v40
    v_and_b32 v21, 0xffff0000, v40
    v_lshlrev_b32 v22, 16, v41
    v_and_b32 v23, 0xffff0000, v41
    v_lshlrev_b32 v24, 16, v42
    v_and_b32 v25, 0xffff0000, v42
    v_lshlrev_b32 v26, 16, v43
    v_and_b32 v27, 0xffff0000, v43
    v_lshlrev_b32 v28, 16, v92
    v_and_b32 v29, 0xffff0000, v92
    v_lshlrev_b32 v30, 16, v93
    v_and_b32 v31, 0xffff0000, v93
    v_lshlrev_b32 v32, 16, v94
    v_and_b32 v33, 0xffff0000, v94
    v_lshlrev_b32 v34, 16, v95
    v_and_b32 v35, 0xffff0000, v95
    v_lshlrev_b32 v192, 16, v216
    v_and_b32 v193, 0xffff0000, v216
    v_lshlrev_b32 v194, 16, v217
    v_and_b32 v195, 0xffff0000, v217
    v_lshlrev_b32 v196, 16, v218
    v_and_b32 v197, 0xffff0000, v218
    v_lshlrev_b32 v198, 16, v219
    v_and_b32 v199, 0xffff0000, v219
    v_lshlrev_b32 v200, 16, v220
    v_and_b32 v201, 0xffff0000, v220
    v_lshlrev_b32 v202, 16, v221
    v_and_b32 v203, 0xffff0000, v221
    v_lshlrev_b32 v204, 16, v222
    v_and_b32 v205, 0xffff0000, v222
    v_lshlrev_b32 v206, 16, v223
    v_and_b32 v207, 0xffff0000, v223
    v_lshlrev_b32 v208, 16, v88
    v_and_b32 v209, 0xffff0000, v88
    v_lshlrev_b32 v210, 16, v89
    v_and_b32 v211, 0xffff0000, v89
    v_lshlrev_b32 v212, 16, v90
    v_and_b32 v213, 0xffff0000, v90
    v_lshlrev_b32 v214, 16, v91
    v_and_b32 v215, 0xffff0000, v91
    s_add_u32 s39, s39, 16
    buffer_load_dword v11, v9, s[24:27], s39 offen sc1
    s_add_u32 s56, s44, 0
    buffer_load_dwordx4 a[32:35], v2, s[28:31], s56 offen offset:512 sc1
    s_add_u32 s56, s44, 4096
    buffer_load_dwordx4 a[36:39], v2, s[28:31], s56 offen offset:512 sc1
    s_add_u32 s56, s44, 8192
    buffer_load_dwordx4 a[40:43], v2, s[28:31], s56 offen offset:512 sc1
    s_add_u32 s56, s44, 12288
    buffer_load_dwordx4 a[44:47], v2, s[28:31], s56 offen offset:512 sc1
    s_waitcnt vmcnt(4)
    v_cmp_ne_u32 s[54:55], s95, v11
    s_cmp_lg_u64 s[54:55], 0
    s_cbranch_scc1 Ltail_spin2
Ltail_got2:
    s_add_u32 s56, s44, 0
    buffer_load_dwordx4 a[48:51], v2, s[28:31], s56 offen offset:1024 sc1
    s_add_u32 s56, s44, 4096
    buffer_load_dwordx4 a[52:55], v2, s[28:31], s56 offen offset:1024 sc1
    s_add_u32 s56, s44, 8192
    buffer_load_dwordx4 a[56:59], v2, s[28:31], s56 offen offset:1024 sc1
    s_add_u32 s56, s44, 12288
    buffer_load_dwordx4 a[60:63], v2, s[28:31], s56 offen offset:1024 sc1
    s_add_u32 s56, s44, 0
    buffer_load_dwordx4 a[64:67], v2, s[28:31], s56 offen offset:1536 sc1
    s_add_u32 s56, s44, 4096
    buffer_load_dwordx4 a[68:71], v2, s[28:31], s56 offen offset:1536 sc1
    s_add_u32 s56, s44, 8192
    buffer_load_dwordx4 a[72:75], v2, s[28:31], s56 offen offset:1536 sc1
    s_add_u32 s56, s44, 12288
    buffer_load_dwordx4 a[76:79], v2, s[28:31], s56 offen offset:1536 sc1
    v_mfma_f32_16x16x32_bf16 v[80:83], v[242:245], a[0:3], 0
    v_mfma_f32_16x16x32_bf16 v[84:87], v[240:243], a[0:3], 0
    v_mfma_f32_16x16x32_bf16 v[80:83], v[242:245], a[4:7], v[80:83]
    v_mfma_f32_16x16x32_bf16 v[84:87], v[240:243], a[4:7], v[84:87]
    v_mfma_f32_16x16x32_bf16 v[80:83], v[242:245], a[8:11], v[80:83]
    v_mfma_f32_16x16x32_bf16 v[84:87], v[240:243], a[8:11], v[84:87]
    v_mfma_f32_16x16x32_bf16 v[80:83], v[242:245], a[12:15], v[80:83]
    v_mfma_f32_16x16x32_bf16 v[84:87], v[240:243], a[12:15], v[84:87]
    s_nop 6
    v_mov_b32_dpp v80, v80 row_ror:8 row_mask:0x4 bank_mask:0xf
    v_mov_b32_dpp v81, v81 row_ror:8 row_mask:0x4 bank_mask:0xf
    v_mov_b32_dpp v82, v82 row_ror:8 row_mask:0x4 bank_mask:0xf
    v_mov_b32_dpp v83, v83 row_ror:8 row_mask:0x4 bank_mask:0xf
    v_mov_b32_dpp v84, v84 row_ror:8 row_mask:0x4 bank_mask:0xf
    v_mov_b32_dpp v85, v85 row_ror:8 row_mask:0x4 bank_mask:0xf
    v_mov_b32_dpp v86, v86 row_ror:8 row_mask:0x4 bank_mask:0xf
    v_mov_b32_dpp v87, v87 row_ror:8 row_mask:0x4 bank_mask:0xf
    v_pk_fma_f32 v[28:29], v[112:113], v[80:81], v[28:29]
    v_pk_fma_f32 v[30:31], v[114:115], v[82:83], v[30:31]
    v_pk_fma_f32 v[32:33], v[116:117], v[84:85], v[32:33]
    v_pk_fma_f32 v[34:35], v[118:119], v[86:87], v[34:35]
    v_cvt_pk_bf16_f32 v44, v28, v29
    v_cvt_pk_bf16_f32 v45, v30, v31
    v_cvt_pk_bf16_f32 v46, v32, v33
    v_cvt_pk_bf16_f32 v47, v34, v35
    v_lshlrev_b32 v28, 16, v44
    v_and_b32 v29, 0xffff0000, v44
    v_lshlrev_b32 v30, 16, v45
    v_and_b32 v31, 0xffff0000, v45
    v_lshlrev_b32 v32, 16, v46
    v_and_b32 v33, 0xffff0000, v46
    v_lshlrev_b32 v34, 16, v47
    v_and_b32 v35, 0xffff0000, v47
    v_pk_add_f32 v[48:49], v[28:29], v[30:31]
    v_pk_add_f32 v[50:51], v[32:33], v[34:35]
    v_mfma_f32_16x16x32_bf16 v[64:67], v[246:249], a[16:19], 0
    v_mfma_f32_16x16x32_bf16 v[68:71], v[244:247], a[16:19], 0
    v_mfma_f32_16x16x32_bf16 v[64:67], v[246:249], a[20:23], v[64:67]
    v_mfma_f32_16x16x32_bf16 v[68:71], v[244:247], a[20:23], v[68:71]
    v_mfma_f32_16x16x32_bf16 v[64:67], v[246:249], a[24:27], v[64:67]
    v_mfma_f32_16x16x32_bf16 v[68:71], v[244:247], a[24:27], v[68:71]
    v_mfma_f32_16x16x32_bf16 v[64:67], v[246:249], a[28:31], v[64:67]
    v_mfma_f32_16x16x32_bf16 v[68:71], v[244:247], a[28:31], v[68:71]
    s_waitcnt vmcnt(11)
    v_mfma_f32_16x16x32_bf16 v[64:67], v[250:253], a[32:35], v[64:67]
    v_mfma_f32_16x16x32_bf16 v[68:71], v[248:251], a[32:35], v[68:71]
    s_waitcnt vmcnt(10)
    v_mfma_f32_16x16x32_bf16 v[64:67], v[250:253], a[36:39], v[64:67]
    v_mfma_f32_16x16x32_bf16 v[68:71], v[248:251], a[36:39], v[68:71]
    s_waitcnt vmcnt(9)
    v_mfma_f32_16x16x32_bf16 v[64:67], v[250:253], a[40:43], v[64:67]
    v_mfma_f32_16x16x32_bf16 v[68:71], v[248:251], a[40:43], v[68:71]
    s_waitcnt vmcnt(8)
    v_mfma_f32_16x16x32_bf16 v[64:67], v[250:253], a[44:47], v[64:67]
    v_mfma_f32_16x16x32_bf16 v[68:71], v[248:251], a[44:47], v[68:71]
    s_waitcnt vmcnt(7)
    s_nop 5
    v_pk_fma_f32 v[12:13], v[96:97], v[64:65], v[12:13]
    v_pk_fma_f32 v[14:15], v[98:99], v[66:67], v[14:15]
    v_pk_fma_f32 v[16:17], v[100:101], v[68:69], v[16:17]
    v_pk_fma_f32 v[18:19], v[102:103], v[70:71], v[18:19]
    v_cvt_pk_bf16_f32 v36, v12, v13
    v_cvt_pk_bf16_f32 v37, v14, v15
    v_cvt_pk_bf16_f32 v38, v16, v17
    v_cvt_pk_bf16_f32 v39, v18, v19
    v_lshlrev_b32 v12, 16, v36
    v_and_b32 v13, 0xffff0000, v36
    v_lshlrev_b32 v14, 16, v37
    v_and_b32 v15, 0xffff0000, v37
    v_lshlrev_b32 v16, 16, v38
    v_and_b32 v17, 0xffff0000, v38
    v_lshlrev_b32 v18, 16, v39
    v_and_b32 v19, 0xffff0000, v39
    v_pk_add_f32 v[48:49], v[48:49], v[12:13]
    v_pk_add_f32 v[50:51], v[50:51], v[14:15]
    v_pk_add_f32 v[48:49], v[48:49], v[16:17]
    v_pk_add_f32 v[50:51], v[50:51], v[18:19]
    v_mfma_f32_16x16x32_bf16 v[72:75], v[246:249], a[48:51], 0
    v_mfma_f32_16x16x32_bf16 v[76:79], v[244:247], a[48:51], 0
    s_waitcnt vmcnt(6)
    v_mfma_f32_16x16x32_bf16 v[72:75], v[246:249], a[52:55], v[72:75]
    v_mfma_f32_16x16x32_bf16 v[76:79], v[244:247], a[52:55], v[76:79]
    s_waitcnt vmcnt(5)
    v_mfma_f32_16x16x32_bf16 v[72:75], v[246:249], a[56:59], v[72:75]
    v_mfma_f32_16x16x32_bf16 v[76:79], v[244:247], a[56:59], v[76:79]
    s_waitcnt vmcnt(4)
    v_mfma_f32_16x16x32_bf16 v[72:75], v[246:249], a[60:63], v[72:75]
Ltour12:
    s_cbranch_execz Ltour16
    v_mfma_f32_16x16x32_bf16 v[76:79], v[244:247], a[60:63], v[76:79]
    s_waitcnt vmcnt(3)
    v_mfma_f32_16x16x32_bf16 v[72:75], v[250:253], a[64:67], v[72:75]
    v_mfma_f32_16x16x32_bf16 v[76:79], v[248:251], a[64:67], v[76:79]
    s_waitcnt vmcnt(2)
    v_mfma_f32_16x16x32_bf16 v[72:75], v[250:253], a[68:71], v[72:75]
    v_mfma_f32_16x16x32_bf16 v[76:79], v[248:251], a[68:71], v[76:79]
    s_waitcnt vmcnt(1)
    v_mfma_f32_16x16x32_bf16 v[72:75], v[250:253], a[72:75], v[72:75]
    v_mfma_f32_16x16x32_bf16 v[76:79], v[248:251], a[72:75], v[76:79]
    s_waitcnt vmcnt(0)
    v_mfma_f32_16x16x32_bf16 v[72:75], v[250:253], a[76:79], v[72:75]
    v_mfma_f32_16x16x32_bf16 v[76:79], v[248:251], a[76:79], v[76:79]
    s_nop 6
    v_pk_fma_f32 v[20:21], v[104:105], v[72:73], v[20:21]
    v_pk_fma_f32 v[22:23], v[106:107], v[74:75], v[22:23]
    v_pk_fma_f32 v[24:25], v[108:109], v[76:77], v[24:25]
    v_pk_fma_f32 v[26:27], v[110:111], v[78:79], v[26:27]
    v_cvt_pk_bf16_f32 v40, v20, v21
    v_cvt_pk_bf16_f32 v41, v22, v23
    v_cvt_pk_bf16_f32 v42, v24, v25
    v_cvt_pk_bf16_f32 v43, v26, v27
    v_lshlrev_b32 v20, 16, v40
    v_and_b32 v21, 0xffff0000, v40
    v_lshlrev_b32 v22, 16, v41
    v_and_b32 v23, 0xffff0000, v41
    v_lshlrev_b32 v24, 16, v42
    v_and_b32 v25, 0xffff0000, v42
    v_lshlrev_b32 v26, 16, v43
    v_and_b32 v27, 0xffff0000, v43
    v_pk_add_f32 v[48:49], v[48:49], v[20:21]
    v_pk_add_f32 v[50:51], v[50:51], v[22:23]
    v_pk_add_f32 v[48:49], v[48:49], v[24:25]
    v_pk_add_f32 v[50:51], v[50:51], v[26:27]
    v_pk_add_f32 v[48:49], v[48:49], v[50:51]
    v_add_f32 v48, v48, v49
    s_nop 1
    v_add_f32_dpp v48, v48, v48 row_ror:1 row_mask:0xf bank_mask:0xf
    s_nop 1
    v_add_f32_dpp v48, v48, v48 row_ror:2 row_mask:0xf bank_mask:0xf
    s_nop 1
    v_add_f32_dpp v48, v48, v48 row_ror:4 row_mask:0xf bank_mask:0xf
    s_nop 1
    v_add_f32_dpp v48, v48, v48 row_ror:8 row_mask:0xf bank_mask:0xf
    v_mov_b32 v52, v48
    s_nop 1
    v_permlane16_swap_b32 v48, v52
    s_nop 0
    v_add_f32 v48, v48, v52
    v_mul_f32 v48, 0x3ae38e39, v48
    v_pk_add_f32 v[216:217], v[12:13], v[48:49] op_sel_hi:[1,0] neg_lo:[0,1] neg_hi:[0,1]
    v_pk_add_f32 v[218:219], v[14:15], v[48:49] op_sel_hi:[1,0] neg_lo:[0,1] neg_hi:[0,1]
    v_pk_add_f32 v[220:221], v[16:17], v[48:49] op_sel_hi:[1,0] neg_lo:[0,1] neg_hi:[0,1]
    v_pk_add_f32 v[222:223], v[18:19], v[48:49] op_sel_hi:[1,0] neg_lo:[0,1] neg_hi:[0,1]
    v_pk_add_f32 v[224:225], v[20:21], v[48:49] op_sel_hi:[1,0] neg_lo:[0,1] neg_hi:[0,1]
    v_pk_add_f32 v[226:227], v[22:23], v[48:49] op_sel_hi:[1,0] neg_lo:[0,1] neg_hi:[0,1]
    v_pk_add_f32 v[228:229], v[24:25], v[48:49] op_sel_hi:[1,0] neg_lo:[0,1] neg_hi:[0,1]
    v_pk_add_f32 v[230:231], v[26:27], v[48:49] op_sel_hi:[1,0] neg_lo:[0,1] neg_hi:[0,1]
    v_pk_add_f32 v[232:233], v[28:29], v[48:49] op_sel_hi:[1,0] neg_lo:[0,1] neg_hi:[0,1]
    v_pk_add_f32 v[234:235], v[30:31], v[48:49] op_sel_hi:[1,0] neg_lo:[0,1] neg_hi:[0,1]
    v_pk_add_f32 v[236:237], v[32:33], v[48:49] op_sel_hi:[1,0] neg_lo:[0,1] neg_hi:[0,1]
    v_pk_add_f32 v[238:239], v[34:35], v[48:49] op_sel_hi:[1,0] neg_lo:[0,1] neg_hi:[0,1]
    v_pk_mul_f32 v[50:51], v[216:217], v[216:217]
    v_pk_mul_f32 v[52:53], v[224:225], v[224:225]
    v_pk_mul_f32 v[62:63], v[232:233], v[232:233]
    v_pk_fma_f32 v[50:51], v[218:219], v[218:219], v[50:51]
    v_pk_fma_f32 v[52:53], v[226:227], v[226:227], v[52:53]
    v_pk_fma_f32 v[62:63], v[234:235], v[234:235], v[62:63]
    v_pk_fma_f32 v[50:51], v[220:221], v[220:221], v[50:51]
    v_pk_fma_f32 v[52:53], v[228:229], v[228:229], v[52:53]
    v_pk_fma_f32 v[62:63], v[236:237], v[236:237], v[62:63]
    v_pk_fma_f32 v[50:51], v[222:223], v[222:223], v[50:51]
    v_pk_fma_f32 v[52:53], v[230:231], v[230:231], v[52:53]
    v_pk_fma_f32 v[62:63], v[238:239], v[238:239], v[62:63]
    v_pk_add_f32 v[50:51], v[50:51], v[52:53]
    v_add_f32 v62, v62, v63
    v_add_f32 v50, v50, v51
    v_cndmask_b32 v62, 0, v62, vcc
    v_add_f32 v50, v50, v62
    s_nop 1
    v_add_f32_dpp v50, v50, v50 row_ror:1 row_mask:0xf bank_mask:0xf
    s_nop 1
    v_add_f32_dpp v50, v50, v50 row_ror:2 row_mask:0xf bank_mask:0xf
    s_nop 1
    v_add_f32_dpp v50, v50, v50 row_ror:4 row_mask:0xf bank_mask:0xf
    s_nop 1
    v_add_f32_dpp v50, v50, v50 row_ror:8 row_mask:0xf bank_mask:0xf
    v_mov_b32 v52, v50
    s_nop 1
    v_permlane16_swap_b32 v50, v52
    s_nop 0
    v_add_f32 v50, v50, v52
    v_mul_f32 v50, 0x3ae38e39, v50
    v_cvt_pk_bf16_f32 v52, v48, v50
    v_and_b32 v50, 0xffff0000, v52
    v_lshlrev_b32 v52, 16, v52
    v_add_f32 v50, 0x3727c5ac, v50
    v_sub_f32 v48, v48, v52
    v_cvt_pk_bf16_f32 v50, v50, v50
    v_and_b32 v50, 0xffff0000, v50
    v_sqrt_f32 v50, v50
    s_nop 0
    v_cvt_pk_bf16_f32 v50, v50, v50
    v_and_b32 v50, 0xffff0000, v50
    v_rcp_f32 v50, v50
    s_mov_b32 s45, 2621440
    v_mul_f32 v48, v48, v50
    v_pk_fma_f32 v[216:217], v[216:217], v[50:51], v[48:49] op_sel_hi:[1,0,0]
    v_pk_fma_f32 v[218:219], v[218:219], v[50:51], v[48:49] op_sel_hi:[1,0,0]
    v_pk_fma_f32 v[220:221], v[220:221], v[50:51], v[48:49] op_sel_hi:[1,0,0]
    v_pk_fma_f32 v[222:223], v[222:223], v[50:51], v[48:49] op_sel_hi:[1,0,0]
    v_pk_fma_f32 v[224:225], v[224:225], v[50:51], v[48:49] op_sel_hi:[1,0,0]
    v_pk_fma_f32 v[226:227], v[226:227], v[50:51], v[48:49] op_sel_hi:[1,0,0]
    v_pk_fma_f32 v[228:229], v[228:229], v[50:51], v[48:49] op_sel_hi:[1,0,0]
    v_pk_fma_f32 v[230:231], v[230:231], v[50:51], v[48:49] op_sel_hi:[1,0,0]
    v_pk_fma_f32 v[232:233], v[232:233], v[50:51], v[48:49] op_sel_hi:[1,0,0]
    v_pk_fma_f32 v[234:235], v[234:235], v[50:51], v[48:49] op_sel_hi:[1,0,0]
    v_pk_fma_f32 v[236:237], v[236:237], v[50:51], v[48:49] op_sel_hi:[1,0,0]
    v_pk_fma_f32 v[238:239], v[238:239], v[50:51], v[48:49] op_sel_hi:[1,0,0]
    v_pk_fma_f32 v[216:217], v[216:217], v[120:121], v[144:145]
    v_pk_fma_f32 v[218:219], v[218:219], v[122:123], v[146:147]
    v_pk_fma_f32 v[220:221], v[220:221], v[124:125], v[148:149]
    v_pk_fma_f32 v[222:223], v[222:223], v[126:127], v[150:151]
    v_pk_fma_f32 v[224:225], v[224:225], v[128:129], v[152:153]
    v_pk_fma_f32 v[226:227], v[226:227], v[130:131], v[154:155]
    v_pk_fma_f32 v[228:229], v[228:229], v[132:133], v[156:157]
    v_pk_fma_f32 v[230:231], v[230:231], v[134:135], v[158:159]
    v_pk_fma_f32 v[232:233], v[232:233], v[136:137], v[160:161]
    v_pk_fma_f32 v[234:235], v[234:235], v[138:139], v[162:163]
    v_pk_fma_f32 v[236:237], v[236:237], v[140:141], v[164:165]
    v_pk_fma_f32 v[238:239], v[238:239], v[142:143], v[166:167]
    v_cvt_pk_bf16_f32 v64, v216, v217
    v_cvt_pk_bf16_f32 v65, v218, v219
    v_cvt_pk_bf16_f32 v66, v220, v221
    v_cvt_pk_bf16_f32 v67, v222, v223
    v_cvt_pk_bf16_f32 v68, v224, v225
    v_cvt_pk_bf16_f32 v69, v226, v227
    v_cvt_pk_bf16_f32 v70, v228, v229
    v_cvt_pk_bf16_f32 v71, v230, v231
    v_cvt_pk_bf16_f32 v72, v232, v233
    v_cvt_pk_bf16_f32 v73, v234, v235
    v_cvt_pk_bf16_f32 v74, v236, v237
    v_cvt_pk_bf16_f32 v75, v238, v239
    v_lshlrev_b32 v216, 16, v64
    v_and_b32 v217, 0xffff0000, v64
    v_lshlrev_b32 v218, 16, v65
    v_and_b32 v219, 0xffff0000, v65
    v_lshlrev_b32 v220, 16, v66
    v_and_b32 v221, 0xffff0000, v66
    v_lshlrev_b32 v222, 16, v67
    v_and_b32 v223, 0xffff0000, v67
    v_lshlrev_b32 v224, 16, v68
    v_and_b32 v225, 0xffff0000, v68
    v_lshlrev_b32 v226, 16, v69
    v_and_b32 v227, 0xffff0000, v69
    v_lshlrev_b32 v228, 16, v70
    v_and_b32 v229, 0xffff0000, v70
    v_lshlrev_b32 v230, 16, v71
    v_and_b32 v231, 0xffff0000, v71
    v_lshlrev_b32 v232, 16, v72
    v_and_b32 v233, 0xffff0000, v72
    v_lshlrev_b32 v234, 16, v73
    v_and_b32 v235, 0xffff0000, v73
    v_lshlrev_b32 v236, 16, v74
    v_and_b32 v237, 0xffff0000, v74
    v_lshlrev_b32 v238, 16, v75
    v_and_b32 v239, 0xffff0000, v75
    v_pk_mul_f32 v[50:51], v[216:217], v[168:169]
    v_pk_mul_f32 v[52:53], v[224:225], v[176:177]
    v_pk_mul_f32 v[62:63], v[232:233], v[184:185]
    v_pk_fma_f32 v[50:51], v[218:219], v[170:171], v[50:51]
    v_pk_fma_f32 v[52:53], v[226:227], v[178:179], v[52:53]
    v_pk_fma_f32 v[62:63], v[234:235], v[186:187], v[62:63]
    v_pk_fma_f32 v[50:51], v[220:221], v[172:173], v[50:51]
    v_pk_fma_f32 v[52:53], v[228:229], v[180:181], v[52:53]
    v_pk_fma_f32 v[62:63], v[236:237], v[188:189], v[62:63]
    v_pk_fma_f32 v[50:51], v[222:223], v[174:175], v[50:51]
    v_pk_fma_f32 v[52:53], v[230:231], v[182:183], v[52:53]
    v_pk_fma_f32 v[62:63], v[238:239], v[190:191], v[62:63]
    v_pk_add_f32 v[50:51], v[50:51], v[52:53]
    v_add_f32 v62, v62, v63
    v_add_f32 v50, v50, v51
    v_add_f32 v50, v50, v62
    v_lshlrev_b32 v48, 2, v7
    v_and_b32 v48, 28, v48
    v_sub_u32 v49, 2047, v7
    v_add_f32_dpp v50, v50, v50 row_ror:1 row_mask:0xf bank_mask:0xf
    s_nop 1
    v_add_f32_dpp v50, v50, v50 row_ror:2 row_mask:0xf bank_mask:0xf
    s_nop 1
    v_add_f32_dpp v50, v50, v50 row_ror:4 row_mask:0xf bank_mask:0xf
    s_nop 1
    v_add_f32_dpp v50, v50, v50 row_ror:8 row_mask:0xf bank_mask:0xf
    v_mov_b32 v52, v50
    s_nop 1
    v_permlane16_swap_b32 v50, v52
    s_nop 0
    v_add_f32 v50, v50, v52
    v_ashrrev_i32 v52, 31, v50
    v_or_b32 v52, 0x80000000, v52
    v_xor_b32 v52, v52, v50
    v_and_b32 v52, 0xfffff800, v52
    v_min_u32 v52, 0xfffff000, v52
    v_or_b32 v52, v52, v49
    s_mov_b32 exec_lo, 1
    s_mov_b32 exec_hi, 1
    ds_write_b32 v48, v52 offset:36864
    s_mov_b64 exec, -1
    s_waitcnt lgkmcnt(0)
    s_barrier
    v_mov_b32 v141, 36864
    ds_read_b128 v[128:131], v141
    ds_read_b128 v[132:135], v141 offset:16
    s_lshl_b32 s45, s2, 7
    s_add_u32 s45, s45, 9306112
    s_cmp_eq_u32 s3, 0
    s_cselect_b32 s45, s45, 2147483648
    s_waitcnt lgkmcnt(1)
    v_max_u32 v136, v128, v129
    v_min_u32 v137, v128, v129
    v_med3_u32 v137, v136, v137, v130
    v_max_u32 v136, v136, v130
    v_med3_u32 v137, v136, v137, v131
    v_max_u32 v136, v136, v131
    s_waitcnt lgkmcnt(0)
    v_med3_u32 v137, v136, v137, v132
    v_max_u32 v136, v136, v132
    v_med3_u32 v137, v136, v137, v133
    v_max_u32 v136, v136, v133
    v_med3_u32 v137, v136, v137, v134
    v_max_u32 v136, v136, v134
    v_med3_u32 v137, v136, v137, v135
    v_max_u32 v136, v136, v135
    buffer_store_dwordx2 v[136:137], v8, s[24:27], s45 offen sc1
    v_and_b32 v138, 0x7ff, v136
    v_and_b32 v139, 0x7ff, v137
    v_cmp_eq_u32 vcc, v138, v49
    v_cmp_eq_u32 s[36:37], v139, v49
    v_mov_b32 v138, 2147483648
    s_or_b64 vcc, vcc, s[36:37]
    s_mov_b32 s45, 2621440
    s_nop 0
    v_cndmask_b32 v6, v138, v6, vcc
    v_cndmask_b32 v60, v138, v60, vcc
    buffer_store_dwordx4 v[64:67], v6, s[24:27], s45 offen offset:0 sc1
    buffer_store_dwordx4 v[68:71], v6, s[24:27], s45 offen offset:512 sc1
    buffer_store_dwordx4 v[72:75], v60, s[24:27], s45 offen offset:1024 sc1
    v_pk_mul_f32 v[192:193], v[192:193], v[216:217]
    v_pk_mul_f32 v[194:195], v[194:195], v[218:219]
    v_pk_mul_f32 v[196:197], v[196:197], v[220:221]
    v_pk_mul_f32 v[198:199], v[198:199], v[222:223]
    v_pk_mul_f32 v[200:201], v[200:201], v[224:225]
    v_pk_mul_f32 v[202:203], v[202:203], v[226:227]
    v_pk_mul_f32 v[204:205], v[204:205], v[228:229]
    v_pk_mul_f32 v[206:207], v[206:207], v[230:231]
    v_pk_mul_f32 v[208:209], v[208:209], v[232:233]
    v_pk_mul_f32 v[210:211], v[210:211], v[234:235]
    v_pk_mul_f32 v[212:213], v[212:213], v[236:237]
    v_pk_mul_f32 v[214:215], v[214:215], v[238:239]
    v_cvt_pk_bf16_f32 v144, v192, v193
    v_cvt_pk_bf16_f32 v145, v194, v195
    v_cvt_pk_bf16_f32 v146, v196, v197
    v_cvt_pk_bf16_f32 v147, v198, v199
    v_cvt_pk_bf16_f32 v148, v200, v201
    v_cvt_pk_bf16_f32 v149, v202, v203
    v_cvt_pk_bf16_f32 v150, v204, v205
    v_cvt_pk_bf16_f32 v151, v206, v207
    v_cvt_pk_bf16_f32 v152, v208, v209
    v_cvt_pk_bf16_f32 v153, v210, v211
    v_cvt_pk_bf16_f32 v154, v212, v213
    v_cvt_pk_bf16_f32 v155, v214, v215
    v_lshlrev_b32 v192, 16, v144
    v_and_b32 v193, 0xffff0000, v144
    v_lshlrev_b32 v194, 16, v145
    v_and_b32 v195, 0xffff0000, v145
    v_lshlrev_b32 v196, 16, v146
    v_and_b32 v197, 0xffff0000, v146
    v_lshlrev_b32 v198, 16, v147
    v_and_b32 v199, 0xffff0000, v147
    v_lshlrev_b32 v200, 16, v148
    v_and_b32 v201, 0xffff0000, v148
    v_lshlrev_b32 v202, 16, v149
    v_and_b32 v203, 0xffff0000, v149
    v_lshlrev_b32 v204, 16, v150
    v_and_b32 v205, 0xffff0000, v150
    v_lshlrev_b32 v206, 16, v151
    v_and_b32 v207, 0xffff0000, v151
    v_lshlrev_b32 v208, 16, v152
    v_and_b32 v209, 0xffff0000, v152
    v_lshlrev_b32 v210, 16, v153
    v_and_b32 v211, 0xffff0000, v153
    v_lshlrev_b32 v212, 16, v154
    v_and_b32 v213, 0xffff0000, v154
    v_lshlrev_b32 v214, 16, v155
    v_and_b32 v215, 0xffff0000, v155
    v_pk_add_f32 v[192:193], v[192:193], v[12:13]
    v_pk_add_f32 v[194:195], v[194:195], v[14:15]
    v_pk_add_f32 v[196:197], v[196:197], v[16:17]
    v_pk_add_f32 v[198:199], v[198:199], v[18:19]
    v_pk_add_f32 v[200:201], v[200:201], v[20:21]
    v_pk_add_f32 v[202:203], v[202:203], v[22:23]
    v_pk_add_f32 v[204:205], v[204:205], v[24:25]
    v_pk_add_f32 v[206:207], v[206:207], v[26:27]
    v_pk_add_f32 v[208:209], v[208:209], v[28:29]
    v_pk_add_f32 v[210:211], v[210:211], v[30:31]
    v_pk_add_f32 v[212:213], v[212:213], v[32:33]
    v_pk_add_f32 v[214:215], v[214:215], v[34:35]
    v_cvt_pk_bf16_f32 v156, v192, v193
    v_cvt_pk_bf16_f32 v157, v194, v195
    v_cvt_pk_bf16_f32 v158, v196, v197
    v_cvt_pk_bf16_f32 v159, v198, v199
    v_cvt_pk_bf16_f32 v160, v200, v201
    v_cvt_pk_bf16_f32 v161, v202, v203
    v_cvt_pk_bf16_f32 v162, v204, v205
    v_cvt_pk_bf16_f32 v163, v206, v207
    v_cvt_pk_bf16_f32 v164, v208, v209
    v_cvt_pk_bf16_f32 v165, v210, v211
    v_cvt_pk_bf16_f32 v166, v212, v213
    v_cvt_pk_bf16_f32 v167, v214, v215
    v_and_b32 v30, 2, v1
    v_cmp_ne_u32 vcc, 0, v30
    v_mul_u32_u24 v30, 1152, v7
    v_add_u32 v4, v30, v5
    v_add_u32 v58, v30, v59
    v_mov_b32_dpp v192, v158 quad_perm:[0,2,0,2] row_mask:0xf bank_mask:0xf
    v_mov_b32_dpp v193, v159 quad_perm:[0,2,0,2] row_mask:0xf bank_mask:0xf
    v_mov_b32_dpp v194, v158 quad_perm:[1,3,1,3] row_mask:0xf bank_mask:0xf
    v_mov_b32_dpp v195, v159 quad_perm:[1,3,1,3] row_mask:0xf bank_mask:0xf
    v_mov_b32_dpp v196, v162 quad_perm:[0,2,0,2] row_mask:0xf bank_mask:0xf
    v_mov_b32_dpp v197, v163 quad_perm:[0,2,0,2] row_mask:0xf bank_mask:0xf
    v_mov_b32_dpp v198, v162 quad_perm:[1,3,1,3] row_mask:0xf bank_mask:0xf
    v_mov_b32_dpp v199, v163 quad_perm:[1,3,1,3] row_mask:0xf bank_mask:0xf
    v_mov_b32_dpp v200, v166 quad_perm:[0,2,0,2] row_mask:0xf bank_mask:0xf
    v_mov_b32_dpp v201, v167 quad_perm:[0,2,0,2] row_mask:0xf bank_mask:0xf
    v_mov_b32_dpp v202, v166 quad_perm:[1,3,1,3] row_mask:0xf bank_mask:0xf
    v_mov_b32_dpp v203, v167 quad_perm:[1,3,1,3] row_mask:0xf bank_mask:0xf
    v_cndmask_b32_dpp v144, v156, v192, vcc quad_perm:[0,2,0,2] row_mask:0xf bank_mask:0xf
    v_cndmask_b32_dpp v145, v157, v193, vcc quad_perm:[0,2,0,2] row_mask:0xf bank_mask:0xf
    v_cndmask_b32_dpp v146, v156, v194, vcc quad_perm:[1,3,1,3] row_mask:0xf bank_mask:0xf
    v_cndmask_b32_dpp v147, v157, v195, vcc quad_perm:[1,3,1,3] row_mask:0xf bank_mask:0xf
    v_cndmask_b32_dpp v148, v160, v196, vcc quad_perm:[0,2,0,2] row_mask:0xf bank_mask:0xf
    v_cndmask_b32_dpp v149, v161, v197, vcc quad_perm:[0,2,0,2] row_mask:0xf bank_mask:0xf
    v_cndmask_b32_dpp v150, v160, v198, vcc quad_perm:[1,3,1,3] row_mask:0xf bank_mask:0xf
    v_cndmask_b32_dpp v151, v161, v199, vcc quad_perm:[1,3,1,3] row_mask:0xf bank_mask:0xf
    v_cndmask_b32_dpp v152, v164, v200, vcc quad_perm:[0,2,0,2] row_mask:0xf bank_mask:0xf
    v_cndmask_b32_dpp v153, v165, v201, vcc quad_perm:[0,2,0,2] row_mask:0xf bank_mask:0xf
    v_cndmask_b32_dpp v154, v164, v202, vcc quad_perm:[1,3,1,3] row_mask:0xf bank_mask:0xf
    v_cndmask_b32_dpp v155, v165, v203, vcc quad_perm:[1,3,1,3] row_mask:0xf bank_mask:0xf
    buffer_store_dwordx4 v[144:147], v4, s[16:19], 0 offen offset:0 sc1
    buffer_store_dwordx4 v[148:151], v4, s[16:19], 0 offen offset:512 sc1
    buffer_store_dwordx4 v[152:155], v58, s[16:19], 0 offen offset:1024 sc1
    s_cmp_ge_u32 s41, 18
    s_cbranch_scc1 Ltail_idle
    s_add_u32 s57, s59, 4096
    s_add_u32 m0, s6, -110592
    s_nop 0
    buffer_load_dwordx4 v255, s[84:87], s57 offen lds
    s_add_u32 s57, s59, 8192
    s_add_u32 m0, s6, -106496
    s_nop 0
    buffer_load_dwordx4 v255, s[84:87], s57 offen lds
    s_add_u32 s57, s59, 12288
    s_add_u32 m0, s6, -102400
    s_nop 0
    buffer_load_dwordx4 v255, s[84:87], s57 offen lds
    s_add_u32 s57, s59, 16384
    s_add_u32 m0, s6, -98304
    s_nop 0
    buffer_load_dwordx4 v255, s[84:87], s57 offen lds
    s_add_u32 s57, s59, 20480
    s_add_u32 m0, s6, -94208
    s_nop 0
    buffer_load_dwordx4 v255, s[84:87], s57 offen lds
    s_add_u32 s57, s59, 24576
    s_add_u32 m0, s6, -90112
    s_nop 0
    buffer_load_dwordx4 v255, s[84:87], s57 offen lds
    s_add_u32 s57, s59, 28672
    s_add_u32 m0, s6, -86016
    s_nop 0
    buffer_load_dwordx4 v255, s[84:87], s57 offen lds
    s_add_u32 s57, s59, 32768
    s_add_u32 m0, s6, -81920
    s_nop 0
    buffer_load_dwordx4 v255, s[84:87], s57 offen lds
    s_mov_b32 s38, 135168
    s_mov_b32 s39, 12288
    v_lshrrev_b32 v9, 2, v1
    v_and_b32 v10, 3, v1
    v_lshlrev_b32 v10, 3, v10
    s_and_b32 s45, s3, 1
    s_lshl_b32 s45, s45, 5
    v_lshl_add_u32 v11, v9, 6, v10
    v_add_u32 v11, s45, v11
    s_cmp_lt_u32 s3, 2
    s_cselect_b32 s44, 98304, s38
    s_cselect_b32 s45, 98304, s39
    v_add_u32 v12, s45, v11
    v_add_u32 v11, s44, v11
    ds_read_b64_tr_b16 a[0:1], v11 offset:0
    ds_read_b64_tr_b16 a[2:3], v11 offset:1024
    ds_read_b64_tr_b16 a[4:5], v11 offset:2048
    ds_read_b64_tr_b16 a[6:7], v11 offset:3072
    ds_read_b64_tr_b16 a[8:9], v11 offset:4096
    ds_read_b64_tr_b16 a[10:11], v11 offset:5120
    ds_read_b64_tr_b16 a[12:13], v11 offset:6144
    ds_read_b64_tr_b16 a[14:15], v11 offset:7168
    ds_read_b64_tr_b16 a[16:17], v11 offset:8192
    ds_read_b64_tr_b16 a[18:19], v11 offset:9216
    ds_read_b64_tr_b16 a[20:21], v11 offset:10240
    ds_read_b64_tr_b16 a[22:23], v11 offset:11264
    ds_read_b64_tr_b16 a[24:25], v11 offset:12288
    ds_read_b64_tr_b16 a[26:27], v11 offset:13312
    ds_read_b64_tr_b16 a[28:29], v11 offset:14336
    ds_read_b64_tr_b16 a[30:31], v11 offset:15360
    ds_read_b64_tr_b16 a[32:33], v11 offset:16384
    ds_read_b64_tr_b16 a[34:35], v11 offset:17408
    ds_read_b64_tr_b16 a[36:37], v11 offset:18432
    ds_read_b64_tr_b16 a[38:39], v11 offset:19456
    ds_read_b64_tr_b16 a[40:41], v11 offset:20480
    ds_read_b64_tr_b16 a[42:43], v11 offset:21504
    ds_read_b64_tr_b16 a[44:45], v11 offset:22528
    ds_read_b64_tr_b16 a[46:47], v11 offset:23552
    ds_read_b64_tr_b16 a[48:49], v11 offset:24576
    ds_read_b64_tr_b16 a[50:51], v11 offset:25600
    ds_read_b64_tr_b16 a[52:53], v11 offset:26624
    ds_read_b64_tr_b16 a[54:55], v11 offset:27648
    ds_read_b64_tr_b16 a[56:57], v12 offset:28672
    ds_read_b64_tr_b16 a[58:59], v12 offset:29696
    ds_read_b64_tr_b16 a[60:61], v12 offset:30720
    ds_read_b64_tr_b16 a[62:63], v12 offset:31744
    ds_read_b64_tr_b16 a[64:65], v12 offset:32768
    ds_read_b64_tr_b16 a[66:67], v12 offset:33792
    ds_read_b64_tr_b16 a[68:69], v12 offset:34816
    ds_read_b64_tr_b16 a[70:71], v12 offset:35840
    v_mul_u32_u24 v12, 1152, v9
    s_lshl_b32 s44, s3, 7
    s_add_u32 s44, s44, 49152
    v_add3_u32 v12, v12, v10, s44
    v_lshlrev_b32 v13, 4, v1
    v_add_u32 v13, 32768, v13
    s_lshl_b32 s44, s3, 10
    v_add_u32 v14, s44, v13
    v_and_b32 v13, 0xffffff1f, v13
    v_bfe_u32 v15, v1, 2, 2
    v_cmp_eq_u32 s[52:53], 0, v15
    v_cmp_eq_u32 s[54:55], 1, v15
    v_cmp_eq_u32 s[56:57], 2, v15
    v_cmp_eq_u32 s[58:59], 3, v15
    s_mul_i32 s43, s42, 18
    s_add_u32 s43, s43, s41
    s_lshl_b32 s43, s43, 9
    s_mul_i32 s44, s3, 73728
    s_add_u32 s43, s43, s44
    v_lshlrev_b32 v15, 3, v1
    v_lshlrev_b32 v140, 7, v0
    s_mov_b32 s45, 9306112
    s_lshl_b32 s36, s3, 3
    v_mov_b32 v141, s36
    s_mov_b32 s48, 16384
Ltail_pollk:
    buffer_load_dwordx2 v[136:137], v140, s[24:27], s45 offen sc1
    s_sub_u32 s48, s48, 1
    s_cbranch_scc1 Ltail_gotk
    s_waitcnt vmcnt(0)
    v_max_u32 v138, v136, v137
    v_cmp_eq_u32 vcc, -1, v138
    s_cbranch_vccnz Ltail_pollk
Ltail_gotk:
    s_waitcnt vmcnt(0)
    s_mov_b32 s36, 2622592
    buffer_store_dwordx4 v[36:39], v6, s[24:27], s36 offen offset:0 sc1
    buffer_store_dwordx4 v[40:43], v6, s[24:27], s36 offen offset:512 sc1
    buffer_store_dwordx4 v[44:47], v60, s[24:27], s36 offen offset:1024 sc1
    v_mov_b32_dpp v138, v136 row_ror:1 row_mask:0xf bank_mask:0xf
    v_mov_b32_dpp v139, v137 row_ror:1 row_mask:0xf bank_mask:0xf
    v_min_u32 v142, v136, v138
    v_max_u32 v136, v136, v138
    v_max3_u32 v137, v142, v137, v139
    s_nop 0
    v_mov_b32_dpp v138, v136 row_ror:2 row_mask:0xf bank_mask:0xf
    v_mov_b32_dpp v139, v137 row_ror:2 row_mask:0xf bank_mask:0xf
    v_min_u32 v142, v136, v138
    v_max_u32 v136, v136, v138
    v_max3_u32 v137, v142, v137, v139
    s_nop 0
    v_mov_b32_dpp v138, v136 row_ror:4 row_mask:0xf bank_mask:0xf
    v_mov_b32_dpp v139, v137 row_ror:4 row_mask:0xf bank_mask:0xf
    v_min_u32 v142, v136, v138
    v_max_u32 v136, v136, v138
    v_max3_u32 v137, v142, v137, v139
    s_nop 0
    v_mov_b32_dpp v138, v136 row_ror:8 row_mask:0xf bank_mask:0xf
    v_mov_b32_dpp v139, v137 row_ror:8 row_mask:0xf bank_mask:0xf
    v_min_u32 v142, v136, v138
    v_max_u32 v136, v136, v138
    v_max3_u32 v137, v142, v137, v139
    v_mov_b32 v138, v136
    v_mov_b32 v139, v137
    s_nop 0
    v_permlane16_swap_b32 v136, v138
    v_permlane16_swap_b32 v137, v139
    v_min_u32 v142, v136, v138
    v_max_u32 v136, v136, v138
    v_max3_u32 v137, v142, v137, v139
    v_mov_b32 v138, v136
    v_mov_b32 v139, v137
    s_nop 0
    v_permlane32_swap_b32 v136, v138
    v_permlane32_swap_b32 v137, v139
    v_min_u32 v142, v136, v138
    v_max_u32 v136, v136, v138
    v_max3_u32 v137, v142, v137, v139
    ds_write_b64 v141, v[136:137] offset:36928
    v_mov_b32 v141, 36928
    s_waitcnt lgkmcnt(0)
    s_barrier
    ds_read_b128 v[128:131], v141
    ds_read_b128 v[132:135], v141 offset:16
    s_or_b32 s36, s2, s3
    s_cselect_b32 s45, -4, 24576
    s_add_u32 s36, s94, 1
    v_mov_b32 v138, s36
    buffer_store_dword v138, v8, s[24:27], s45 offen sc1
    s_waitcnt lgkmcnt(1)
    v_max_u32 v136, v128, v129
    v_min_u32 v137, v128, v129
    v_med3_u32 v137, v136, v137, v130
    v_max_u32 v136, v136, v130
    v_med3_u32 v137, v136, v137, v131
    v_max_u32 v136, v136, v131
    s_waitcnt lgkmcnt(0)
    v_med3_u32 v137, v136, v137, v132
    v_max_u32 v136, v136, v132
    v_med3_u32 v137, v136, v137, v133
    v_max_u32 v136, v136, v133
    v_med3_u32 v137, v136, v137, v134
    v_max_u32 v136, v136, v134
    v_med3_u32 v137, v136, v137, v135
    v_max_u32 v136, v136, v135
    s_nop 0
    v_readfirstlane_b32 s92, v136
    v_readfirstlane_b32 s93, v137
    s_andn2_b32 s46, 0x7ff, s92
    s_andn2_b32 s47, 0x7ff, s93
    s_cmp_ge_u32 s41, 18
    s_cbranch_scc1 Ltail_noffn
    s_mul_i32 s44, s46, 2304
    s_mul_i32 s45, s47, 2304
    s_sub_u32 s45, s45, s44
    v_and_b32 v8, 1, v1
    v_mul_lo_u32 v8, v8, s45
    v_and_b32 v9, 48, v1
    v_add3_u32 v8, v8, v9, s44
    s_mov_b32 s45, 2621440
    s_mov_b32 s48, 16384
Ltail_pollh:
    s_mov_b32 exec_lo, 0x30003
    s_mov_b32 exec_hi, 0x30003
    buffer_load_dwordx4 a[120:123], v8, s[24:27], s45 offen offset:0 sc1
    buffer_load_dwordx4 a[124:127], v8, s[24:27], s45 offen offset:64 sc1
    buffer_load_dwordx4 a[128:131], v8, s[24:27], s45 offen offset:128 sc1
    buffer_load_dwordx4 a[132:135], v8, s[24:27], s45 offen offset:192 sc1
    buffer_load_dwordx4 a[136:139], v8, s[24:27], s45 offen offset:256 sc1
    buffer_load_dwordx4 a[140:143], v8, s[24:27], s45 offen offset:320 sc1
    buffer_load_dwordx4 a[144:147], v8, s[24:27], s45 offen offset:384 sc1
    buffer_load_dwordx4 a[148:151], v8, s[24:27], s45 offen offset:448 sc1
    buffer_load_dwordx4 a[152:155], v8, s[24:27], s45 offen offset:512 sc1
    buffer_load_dwordx4 a[156:159], v8, s[24:27], s45 offen offset:576 sc1
    buffer_load_dwordx4 a[160:163], v8, s[24:27], s45 offen offset:640 sc1
    buffer_load_dwordx4 a[164:167], v8, s[24:27], s45 offen offset:704 sc1
    buffer_load_dwordx4 a[168:171], v8, s[24:27], s45 offen offset:768 sc1
    buffer_load_dwordx4 a[172:175], v8, s[24:27], s45 offen offset:832 sc1
    buffer_load_dwordx4 a[176:179], v8, s[24:27], s45 offen offset:896 sc1
    buffer_load_dwordx4 a[180:183], v8, s[24:27], s45 offen offset:960 sc1
    buffer_load_dwordx4 a[184:187], v8, s[24:27], s45 offen offset:1024 sc1
    buffer_load_dwordx4 a[188:191], v8, s[24:27], s45 offen offset:1088 sc1
    s_mov_b64 exec, -1
    ds_read_b64_tr_b16 a[72:73], v12 offset:0
    ds_read_b64_tr_b16 a[74:75], v12 offset:18432
    ds_read_b64_tr_b16 a[76:77], v12 offset:32
    ds_read_b64_tr_b16 a[78:79], v12 offset:18464
    ds_read_b64_tr_b16 a[80:81], v12 offset:64
    ds_read_b64_tr_b16 a[82:83], v12 offset:18496
    ds_read_b64_tr_b16 a[84:85], v12 offset:96
    ds_read_b64_tr_b16 a[86:87], v12 offset:18528
    ds_read_b64_tr_b16 a[88:89], v12 offset:512
    ds_read_b64_tr_b16 a[90:91], v12 offset:18944
    ds_read_b64_tr_b16 a[92:93], v12 offset:544
    ds_read_b64_tr_b16 a[94:95], v12 offset:18976
    ds_read_b64_tr_b16 a[96:97], v12 offset:576
    ds_read_b64_tr_b16 a[98:99], v12 offset:19008
    ds_read_b64_tr_b16 a[100:101], v12 offset:608
    ds_read_b64_tr_b16 a[102:103], v12 offset:19040
    ds_read_b64_tr_b16 a[104:105], v12 offset:1024
    ds_read_b64_tr_b16 a[106:107], v12 offset:19456
    ds_read_b64_tr_b16 a[108:109], v12 offset:1056
    ds_read_b64_tr_b16 a[110:111], v12 offset:19488
    ds_read_b64_tr_b16 a[112:113], v12 offset:1088
    ds_read_b64_tr_b16 a[114:115], v12 offset:19520
    ds_read_b64_tr_b16 a[116:117], v12 offset:1120
    ds_read_b64_tr_b16 a[118:119], v12 offset:19552
    s_waitcnt vmcnt(17)
    v_mfma_f32_16x16x32_bf16 v[16:19], a[0:3], a[120:123], 0
    s_waitcnt vmcnt(16)
    v_mfma_f32_16x16x32_bf16 v[20:23], a[4:7], a[124:127], 0
    s_waitcnt vmcnt(15)
    v_mfma_f32_16x16x32_bf16 v[16:19], a[8:11], a[128:131], v[16:19]
    s_waitcnt vmcnt(14)
    v_mfma_f32_16x16x32_bf16 v[20:23], a[12:15], a[132:135], v[20:23]
    s_waitcnt vmcnt(13)
    v_mfma_f32_16x16x32_bf16 v[16:19], a[16:19], a[136:139], v[16:19]
    s_waitcnt vmcnt(12)
    v_mfma_f32_16x16x32_bf16 v[20:23], a[20:23], a[140:143], v[20:23]
    s_waitcnt vmcnt(11)
    v_mfma_f32_16x16x32_bf16 v[16:19], a[24:27], a[144:147], v[16:19]
    s_waitcnt vmcnt(10)
    v_mfma_f32_16x16x32_bf16 v[20:23], a[28:31], a[148:151], v[20:23]
    s_waitcnt vmcnt(9)
    v_mfma_f32_16x16x32_bf16 v[16:19], a[32:35], a[152:155], v[16:19]
Ltour13:
    s_cbranch_execz Ltour17
    s_waitcnt vmcnt(8)
    v_mfma_f32_16x16x32_bf16 v[20:23], a[36:39], a[156:159], v[20:23]
    s_waitcnt vmcnt(7)
    v_mfma_f32_16x16x32_bf16 v[16:19], a[40:43], a[160:163], v[16:19]
    s_waitcnt vmcnt(6)
    v_mfma_f32_16x16x32_bf16 v[20:23], a[44:47], a[164:167], v[20:23]
    s_waitcnt vmcnt(5)
    v_mfma_f32_16x16x32_bf16 v[16:19], a[48:51], a[168:171], v[16:19]
    s_waitcnt vmcnt(4)
    v_mfma_f32_16x16x32_bf16 v[20:23], a[52:55], a[172:175], v[20:23]
    s_waitcnt vmcnt(3)
    v_mfma_f32_16x16x32_bf16 v[16:19], a[56:59], a[176:179], v[16:19]
    s_waitcnt vmcnt(2)
    v_mfma_f32_16x16x32_bf16 v[20:23], a[60:63], a[180:183], v[20:23]
    s_waitcnt vmcnt(1)
    v_mfma_f32_16x16x32_bf16 v[16:19], a[64:67], a[184:187], v[16:19]
    s_waitcnt vmcnt(0)
    v_mfma_f32_16x16x32_bf16 v[20:23], a[68:71], a[188:191], v[20:23]
    s_sub_u32 s48, s48, 1
    s_nop 6
    v_pk_add_f32 v[16:17], v[16:17], v[20:21]
    v_pk_add_f32 v[18:19], v[18:19], v[22:23]
    s_cbranch_scc1 Ltail_goth
    v_cmp_u_f32 vcc, v16, v16
    s_and_b32 s36, vcc_lo, 3
    s_cbranch_scc1 Ltail_pollh
Ltail_goth:
    ds_write_b128 v14, v[16:19]
    s_waitcnt lgkmcnt(0)
    s_barrier
    ds_read_b128 v[16:19], v13 offset:0
    ds_read_b128 v[20:23], v13 offset:1024
    ds_read_b128 v[24:27], v13 offset:2048
    ds_read_b128 v[28:31], v13 offset:3072
    s_mov_b32 s36, 0xbfb8aa3b
    s_mov_b32 s37, 0xbfb8aa3b
    s_waitcnt lgkmcnt(3)
    v_cvt_pk_bf16_f32 v32, v16, v17
    v_cvt_pk_bf16_f32 v33, v18, v19
    s_waitcnt lgkmcnt(2)
    v_cvt_pk_bf16_f32 v34, v20, v21
    v_cvt_pk_bf16_f32 v35, v22, v23
    v_lshlrev_b32 v16, 16, v32
    v_and_b32 v17, 0xffff0000, v32
    v_lshlrev_b32 v18, 16, v33
    v_and_b32 v19, 0xffff0000, v33
    v_lshlrev_b32 v20, 16, v34
    v_and_b32 v21, 0xffff0000, v34
    v_lshlrev_b32 v22, 16, v35
    v_and_b32 v23, 0xffff0000, v35
    v_pk_mul_f32 v[32:33], v[16:17], s[36:37]
    v_pk_mul_f32 v[34:35], v[18:19], s[36:37]
    v_pk_mul_f32 v[36:37], v[20:21], s[36:37]
    v_pk_mul_f32 v[38:39], v[22:23], s[36:37]
    v_exp_f32 v32, v32
    v_exp_f32 v33, v33
    v_exp_f32 v34, v34
    v_exp_f32 v35, v35
    v_exp_f32 v36, v36
    v_exp_f32 v37, v37
    v_exp_f32 v38, v38
    v_exp_f32 v39, v39
    s_waitcnt lgkmcnt(1)
    v_cvt_pk_bf16_f32 v60, v24, v25
    v_cvt_pk_bf16_f32 v61, v26, v27
    s_waitcnt lgkmcnt(0)
    v_cvt_pk_bf16_f32 v62, v28, v29
    v_cvt_pk_bf16_f32 v63, v30, v31
    v_pk_add_f32 v[32:33], v[32:33], 1.0 op_sel_hi:[1,0]
    v_pk_add_f32 v[34:35], v[34:35], 1.0 op_sel_hi:[1,0]
    v_pk_add_f32 v[36:37], v[36:37], 1.0 op_sel_hi:[1,0]
    v_pk_add_f32 v[38:39], v[38:39], 1.0 op_sel_hi:[1,0]
    v_rcp_f32 v32, v32
    v_rcp_f32 v33, v33
    v_rcp_f32 v34, v34
    v_rcp_f32 v35, v35
    v_rcp_f32 v36, v36
    v_rcp_f32 v37, v37
    v_rcp_f32 v38, v38
    v_rcp_f32 v39, v39
    v_lshlrev_b32 v24, 16, v60
    v_and_b32 v25, 0xffff0000, v60
    v_lshlrev_b32 v26, 16, v61
    v_and_b32 v27, 0xffff0000, v61
    v_lshlrev_b32 v28, 16, v62
    v_and_b32 v29, 0xffff0000, v62
    v_lshlrev_b32 v30, 16, v63
    v_and_b32 v31, 0xffff0000, v63
    v_pk_mul_f32 v[16:17], v[16:17], v[32:33]
    v_pk_mul_f32 v[18:19], v[18:19], v[34:35]
    v_pk_mul_f32 v[20:21], v[20:21], v[36:37]
    v_pk_mul_f32 v[22:23], v[22:23], v[38:39]
    v_cvt_pk_bf16_f32 v32, v16, v17
    v_cvt_pk_bf16_f32 v33, v18, v19
    v_cvt_pk_bf16_f32 v34, v20, v21
    v_cvt_pk_bf16_f32 v35, v22, v23
    v_lshlrev_b32 v16, 16, v32
    v_and_b32 v17, 0xffff0000, v32
    v_lshlrev_b32 v18, 16, v33
    v_and_b32 v19, 0xffff0000, v33
    v_lshlrev_b32 v20, 16, v34
    v_and_b32 v21, 0xffff0000, v34
    v_lshlrev_b32 v22, 16, v35
    v_and_b32 v23, 0xffff0000, v35
    v_pk_mul_f32 v[16:17], v[16:17], v[24:25]
    v_pk_mul_f32 v[18:19], v[18:19], v[26:27]
    v_pk_mul_f32 v[20:21], v[20:21], v[28:29]
    v_pk_mul_f32 v[22:23], v[22:23], v[30:31]
    v_cvt_pk_bf16_f32 v32, v16, v17
    v_cvt_pk_bf16_f32 v33, v18, v19
    v_cvt_pk_bf16_f32 v34, v20, v21
    v_cvt_pk_bf16_f32 v35, v22, v23
    v_cndmask_b32 v64, 0, v32, s[52:53]
    v_cndmask_b32 v65, 0, v33, s[52:53]
    v_cndmask_b32 v66, 0, v34, s[52:53]
    v_cndmask_b32 v67, 0, v35, s[52:53]
    v_cndmask_b32 v68, 0, v32, s[54:55]
    v_cndmask_b32 v69, 0, v33, s[54:55]
    v_cndmask_b32 v70, 0, v34, s[54:55]
    v_cndmask_b32 v71, 0, v35, s[54:55]
    v_cndmask_b32 v72, 0, v32, s[56:57]
    v_cndmask_b32 v73, 0, v33, s[56:57]
    v_cndmask_b32 v74, 0, v34, s[56:57]
    v_cndmask_b32 v75, 0, v35, s[56:57]
    v_cndmask_b32 v76, 0, v32, s[58:59]
    v_cndmask_b32 v77, 0, v33, s[58:59]
    v_cndmask_b32 v78, 0, v34, s[58:59]
    v_cndmask_b32 v79, 0, v35, s[58:59]
    v_mfma_f32_16x16x32_bf16 v[16:19], v[64:67], a[72:75], 0
    v_mfma_f32_16x16x32_bf16 v[16:19], v[68:71], a[76:79], v[16:19]
    v_mfma_f32_16x16x32_bf16 v[16:19], v[72:75], a[80:83], v[16:19]
    v_mfma_f32_16x16x32_bf16 v[16:19], v[76:79], a[84:87], v[16:19]
    v_mfma_f32_16x16x32_bf16 v[20:23], v[64:67], a[88:91], 0
    v_mfma_f32_16x16x32_bf16 v[20:23], v[68:71], a[92:95], v[20:23]
    v_mfma_f32_16x16x32_bf16 v[20:23], v[72:75], a[96:99], v[20:23]
    v_mfma_f32_16x16x32_bf16 v[20:23], v[76:79], a[100:103], v[20:23]
    v_mfma_f32_16x16x32_bf16 v[24:27], v[64:67], a[104:107], 0
    v_mfma_f32_16x16x32_bf16 v[24:27], v[68:71], a[108:111], v[24:27]
    v_mfma_f32_16x16x32_bf16 v[24:27], v[72:75], a[112:115], v[24:27]
    v_mfma_f32_16x16x32_bf16 v[24:27], v[76:79], a[116:119], v[24:27]
    v_min_u32 v16, -2, v16
    v_min_u32 v17, -2, v17
    buffer_store_dwordx2 v[16:17], v15, s[8:11], s43 offen sc1
    s_add_u32 s43, s43, 294912
    v_min_u32 v20, -2, v20
    v_min_u32 v21, -2, v21
    buffer_store_dwordx2 v[20:21], v15, s[8:11], s43 offen sc1
    s_add_u32 s43, s43, 294912
    v_min_u32 v24, -2, v24
    v_min_u32 v25, -2, v25
    buffer_store_dwordx2 v[24:25], v15, s[8:11], s43 offen sc1
    s_cmp_lt_u32 s41, 9
    s_cselect_b32 s36, s3, 0
    s_cmp_eq_u32 s36, 3
    s_cbranch_scc1 Ltail_final
Ltail_noffn:
    s_branch Ltail_done
Ltail_idle:
    s_waitcnt vmcnt(0)
    s_mov_b32 s36, 2622592
    buffer_store_dwordx4 v[36:39], v6, s[24:27], s36 offen offset:0 sc1
    buffer_store_dwordx4 v[40:43], v6, s[24:27], s36 offen offset:512 sc1
    buffer_store_dwordx4 v[44:47], v60, s[24:27], s36 offen offset:1024 sc1
    s_branch Ltail_done
Ltail_final:
Ltour14:
    s_cbranch_execz Lmain
    s_mul_i32 s43, s42, 9
    s_add_u32 s43, s43, s41
    v_bfe_u32 v8, v1, 2, 1
    v_cmp_eq_u32 vcc, 1, v8
    v_mov_b32 v9, s46
    v_mov_b32 v10, s47
    v_and_b32 v11, 3, v1
    v_cndmask_b32 v9, v9, v10, vcc
    s_lshr_b32 s44, s43, 2
    s_lshl_b32 s44, s44, 6
    s_and_b32 s45, s43, 1
    s_lshl_b32 s45, s45, 5
    s_add_u32 s44, s44, s45
    s_and_b32 s45, s43, 2
    s_lshl_b32 s45, s45, 2
    s_add_u32 s44, s44, s45
    v_lshrrev_b32 v12, 1, v11
    v_lshl_add_u32 v12, v12, 4, s44
    v_and_b32 v13, 1, v11
    v_lshl_add_u32 v12, v13, 2, v12
    v_mul_u32_u24 v13, 1152, v9
    v_lshl_add_u32 v14, v13, 1, v12
    v_add_u32 v15, 2621440, v14
    s_mov_b32 s45, 22144
    buffer_load_dword v18, v12, s[24:27], s45 offen sc1
    v_mov_b32 v19, s92
    v_mov_b32 v10, s93
    v_cndmask_b32 v19, v19, v10, vcc
    v_and_b32 v19, 0xfffff800, v19
    v_or_b32 v19, 0x400, v19
    v_ashrrev_i32 v10, 31, v19
    v_not_b32 v10, v10
    v_or_b32 v10, 0x80000000, v10
    v_xor_b32 v19, v19, v10
    s_lshl_b32 s45, s43, 4
    v_lshl_add_u32 v13, v11, 2, v13
    v_add_u32 v13, s45, v13
    v_lshrrev_b32 v14, 2, v1
    v_lshlrev_b32 v14, 9, v14
    v_lshl_add_u32 v14, v11, 4, v14
    s_lshr_b32 s44, s43, 3
    s_mul_i32 s44, s44, 73728
    s_and_b32 s45, s43, 7
    s_lshl_b32 s45, s45, 6
    s_add_u32 s44, s44, s45
    v_cmp_eq_u32 s[38:39], 1, v8
    v_cvt_pk_bf16_f32 v19, v19, v19
    v_and_b32 v19, 0xffff0000, v19
    v_mul_f32 v19, 0xbfb8aa3b, v19
    v_exp_f32 v19, v19
    s_waitcnt vmcnt(0)
    v_lshlrev_b32 v24, 16, v18
    v_and_b32 v25, 0xffff0000, v18
    v_add_f32 v19, 1.0, v19
    v_rcp_f32 v19, v19
    s_mov_b32 s48, 16384
    v_cvt_pk_bf16_f32 v19, v19, v19
    v_and_b32 v19, 0xffff0000, v19
Ltail_polly:
    s_add_u32 s45, s44, 0
    buffer_load_dwordx4 v[64:67], v14, s[8:11], s45 offen sc1
    s_add_u32 s45, s44, 8192
    buffer_load_dwordx4 v[68:71], v14, s[8:11], s45 offen sc1
    s_add_u32 s45, s44, 16384
    buffer_load_dwordx4 v[72:75], v14, s[8:11], s45 offen sc1
    s_add_u32 s45, s44, 24576
    buffer_load_dwordx4 v[76:79], v14, s[8:11], s45 offen sc1
    s_add_u32 s45, s44, 32768
    buffer_load_dwordx4 v[80:83], v14, s[8:11], s45 offen sc1
    s_add_u32 s45, s44, 40960
    buffer_load_dwordx4 v[84:87], v14, s[8:11], s45 offen sc1
    s_add_u32 s45, s44, 49152
    buffer_load_dwordx4 v[88:91], v14, s[8:11], s45 offen sc1
    s_add_u32 s45, s44, 57344
    buffer_load_dwordx4 v[92:95], v14, s[8:11], s45 offen sc1
    s_add_u32 s45, s44, 65536
    buffer_load_dwordx4 v[96:99], v14, s[8:11], s45 offen sc1
    s_mov_b32 s45, 1152
    buffer_load_dword v16, v15, s[24:27], s45 offen sc1
    buffer_load_dword v17, v15, s[24:27], 0 offen sc1
    s_sub_u32 s48, s48, 1
    s_cbranch_scc1 Ltail_goty
    s_waitcnt vmcnt(10)
    v_max3_u32 v26, v64, v65, v66
    s_waitcnt vmcnt(9)
    v_max3_u32 v26, v26, v67, v68
    v_max3_u32 v26, v26, v69, v70
    s_waitcnt vmcnt(8)
    v_max3_u32 v26, v26, v71, v72
    v_max3_u32 v26, v26, v73, v74
    s_waitcnt vmcnt(7)
    v_max3_u32 v26, v26, v75, v76
    v_max3_u32 v26, v26, v77, v78
    s_waitcnt vmcnt(6)
    v_max3_u32 v26, v26, v79, v80
    v_max3_u32 v26, v26, v81, v82
    s_waitcnt vmcnt(5)
    v_max3_u32 v26, v26, v83, v84
    v_max3_u32 v26, v26, v85, v86
    s_waitcnt vmcnt(4)
    v_max3_u32 v26, v26, v87, v88
    v_max3_u32 v26, v26, v89, v90
    s_waitcnt vmcnt(3)
    v_max3_u32 v26, v26, v91, v92
    v_max3_u32 v26, v26, v93, v94
    s_waitcnt vmcnt(2)
    v_max3_u32 v26, v26, v95, v96
    v_max3_u32 v26, v26, v97, v98
    v_max_u32 v26, v26, v99
    s_waitcnt vmcnt(0)
    v_max3_u32 v26, v26, v16, v17
    v_cmp_eq_u32 vcc, -1, v26
    s_cbranch_vccnz Ltail_polly
Ltail_goty:
    s_waitcnt vmcnt(0) lgkmcnt(0)
    v_lshlrev_b32 v20, 16, v16
    v_and_b32 v21, 0xffff0000, v16
    v_lshlrev_b32 v22, 16, v17
    v_and_b32 v23, 0xffff0000, v17
    v_pk_add_f32 v[64:65], v[64:65], v[68:69]
    v_pk_add_f32 v[66:67], v[66:67], v[70:71]
    v_pk_add_f32 v[64:65], v[64:65], v[72:73]
    v_pk_add_f32 v[66:67], v[66:67], v[74:75]
    v_pk_add_f32 v[64:65], v[64:65], v[76:77]
    v_pk_add_f32 v[66:67], v[66:67], v[78:79]
    v_pk_add_f32 v[64:65], v[64:65], v[80:81]
    v_pk_add_f32 v[66:67], v[66:67], v[82:83]
    v_pk_add_f32 v[64:65], v[64:65], v[84:85]
    v_pk_add_f32 v[66:67], v[66:67], v[86:87]
    v_pk_add_f32 v[64:65], v[64:65], v[88:89]
    v_pk_add_f32 v[66:67], v[66:67], v[90:91]
    v_pk_add_f32 v[64:65], v[64:65], v[92:93]
    v_pk_add_f32 v[66:67], v[66:67], v[94:95]
    v_pk_add_f32 v[64:65], v[64:65], v[96:97]
    v_pk_add_f32 v[66:67], v[66:67], v[98:99]
    s_nop 0
    v_add_f32_dpp v64, v64, v64 row_ror:4 row_mask:0xf bank_mask:0xf
    v_add_f32_dpp v65, v65, v65 row_ror:4 row_mask:0xf bank_mask:0xf
    v_add_f32_dpp v66, v66, v66 row_ror:4 row_mask:0xf bank_mask:0xf
    v_add_f32_dpp v67, v67, v67 row_ror:4 row_mask:0xf bank_mask:0xf
    v_add_f32_dpp v64, v64, v64 row_ror:8 row_mask:0xf bank_mask:0xf
    v_add_f32_dpp v65, v65, v65 row_ror:8 row_mask:0xf bank_mask:0xf
    v_add_f32_dpp v66, v66, v66 row_ror:8 row_mask:0xf bank_mask:0xf
    v_add_f32_dpp v67, v67, v67 row_ror:8 row_mask:0xf bank_mask:0xf
    v_mov_b32 v68, v64
    v_mov_b32 v69, v65
    v_mov_b32 v70, v66
    v_mov_b32 v71, v67
    v_permlane16_swap_b32 v64, v68
    v_permlane16_swap_b32 v65, v69
    v_permlane16_swap_b32 v66, v70
    v_permlane16_swap_b32 v67, v71
    v_add_f32 v64, v64, v68
    v_add_f32 v65, v65, v69
    v_add_f32 v66, v66, v70
    v_add_f32 v67, v67, v71
    v_mov_b32 v68, v64
    v_mov_b32 v69, v65
    v_mov_b32 v70, v66
    v_mov_b32 v71, v67
    v_permlane32_swap_b32 v64, v68
    v_permlane32_swap_b32 v65, v69
    v_permlane32_swap_b32 v66, v70
    v_permlane32_swap_b32 v67, v71
    v_add_f32 v64, v64, v68
    v_add_f32 v65, v65, v69
    v_add_f32 v66, v66, v70
    v_add_f32 v67, v67, v71
    v_cndmask_b32 v26, v64, v65, s[38:39]
    v_cndmask_b32 v27, v66, v67, s[38:39]
    v_cvt_pk_bf16_f32 v28, v26, v27
    v_lshlrev_b32 v26, 16, v28
    v_and_b32 v27, 0xffff0000, v28
    v_mul_f32 v26, v26, v19
    v_mul_f32 v27, v27, v19
    v_cvt_pk_bf16_f32 v28, v26, v27
    v_lshlrev_b32 v26, 16, v28
    v_and_b32 v27, 0xffff0000, v28
    v_pk_add_f32 v[26:27], v[26:27], v[22:23]
    v_cvt_pk_bf16_f32 v28, v26, v27
    v_lshlrev_b32 v26, 16, v28
    v_and_b32 v27, 0xffff0000, v28
    v_pk_mul_f32 v[26:27], v[26:27], v[24:25]
    v_cvt_pk_bf16_f32 v28, v26, v27
    v_lshlrev_b32 v26, 16, v28
    v_and_b32 v27, 0xffff0000, v28
    v_pk_add_f32 v[26:27], v[26:27], v[20:21]
    v_cvt_pk_bf16_f32 v28, v26, v27
    s_mov_b64 exec, 0xff
    buffer_store_dword v28, v13, s[16:19], 0 offen nt
Ltail_done:
    s_endpgm
Lattn_wb:
    buffer_wbl2 sc1
    s_waitcnt vmcnt(0)
    s_branch Lattn_wbdone
Lattn_xspin:
Ltour15:
    s_cbranch_execz Lmain
    s_mov_b32 s37, 16384
Lattn_xloop:
    buffer_load_dword v11, v8, s[24:27], s54 offen offset:8 sc1
    s_waitcnt vmcnt(0)
    v_readfirstlane_b32 s36, v11
    s_sub_u32 s37, s37, 1
    s_cbranch_scc1 Lattn_xgot
    s_cmp_lg_u32 s36, s95
    s_cbranch_scc1 Lattn_xloop
    s_branch Lattn_xgot
Ltail_spin1:
Ltour16:
    s_cbranch_execz Lmain
    s_mov_b32 s48, 16384
Ltail_spinl1:
    buffer_load_dword v11, v9, s[24:27], s39 offen sc1
    s_waitcnt vmcnt(0)
    v_cmp_ne_u32 s[54:55], s95, v11
    s_sub_u32 s48, s48, 1
    s_cbranch_scc1 Ltail_got1
    s_cmp_lg_u64 s[54:55], 0
    s_cbranch_scc1 Ltail_spinl1
    s_branch Ltail_got1
Ltail_spin2:
Ltour17:
    s_cbranch_execz Lmain
    s_mov_b32 s48, 16384
Ltail_spinl2:
    buffer_load_dword v11, v9, s[24:27], s39 offen sc1
    s_waitcnt vmcnt(0)
    v_cmp_ne_u32 s[54:55], s95, v11
    s_sub_u32 s48, s48, 1
    s_cbranch_scc1 Ltail_got2
    s_cmp_lg_u64 s[54:55], 0
    s_cbranch_scc1 Ltail_spinl2
    s_branch Ltail_got2
Lattn_redo:
    v_xor_b32 v8, 64, v9
    v_xor_b32 v10, 64, v11
    s_waitcnt vmcnt(0) lgkmcnt(0)
    s_barrier
    v_mov_b32 v232, 0xff800000
    v_mov_b32 v233, 0xff800000
    v_mov_b32 v234, 0xff800000
    v_mov_b32 v235, 0xff800000
    s_mov_b32 s40, 0
    s_mov_b32 s48, -1
Lattn_redo_loop:
    s_add_u32 m0, s42, 0
    s_nop 0
    buffer_load_dwordx4 v36, s[8:11], s40 offen lds
    buffer_load_dwordx4 v37, s[8:11], s40 offen offset:1024 lds
    buffer_load_dwordx4 v38, s[8:11], s40 offen offset:2048 lds
    buffer_load_dwordx4 v39, s[8:11], s40 offen offset:3072 lds
    s_add_u32 s40, s40, 16384
    s_waitcnt vmcnt(0) lgkmcnt(0)
    s_barrier
    ds_read_b128 a[208:211], v8 offset:0
    ds_read_b128 a[212:215], v9 offset:0
    ds_read_b128 a[216:219], v10 offset:0
    ds_read_b128 a[220:223], v11 offset:0
    s_waitcnt lgkmcnt(3)
    v_mfma_f32_16x16x32_bf16 v[216:219], a[208:211], v[64:67], 0
    s_waitcnt lgkmcnt(2)
    v_mfma_f32_16x16x32_bf16 v[216:219], a[212:215], v[68:71], v[216:219]
    s_waitcnt lgkmcnt(1)
    v_mfma_f32_16x16x32_bf16 v[216:219], a[216:219], v[72:75], v[216:219]
    s_waitcnt lgkmcnt(0)
    v_mfma_f32_16x16x32_bf16 v[216:219], a[220:223], v[76:79], v[216:219]
    v_mfma_f32_16x16x32_bf16 v[220:223], a[208:211], v[80:83], 0
    v_mfma_f32_16x16x32_bf16 v[220:223], a[212:215], v[84:87], v[220:223]
    v_mfma_f32_16x16x32_bf16 v[220:223], a[216:219], v[88:91], v[220:223]
    v_mfma_f32_16x16x32_bf16 v[220:223], a[220:223], v[92:95], v[220:223]
    v_mfma_f32_16x16x32_bf16 v[224:227], a[208:211], v[96:99], 0
    v_mfma_f32_16x16x32_bf16 v[224:227], a[212:215], v[100:103], v[224:227]
    v_mfma_f32_16x16x32_bf16 v[224:227], a[216:219], v[104:107], v[224:227]
    v_mfma_f32_16x16x32_bf16 v[224:227], a[220:223], v[108:111], v[224:227]
    v_mfma_f32_16x16x32_bf16 v[228:231], a[208:211], v[112:115], 0
    v_mfma_f32_16x16x32_bf16 v[228:231], a[212:215], v[116:119], v[228:231]
    v_mfma_f32_16x16x32_bf16 v[228:231], a[216:219], v[120:123], v[228:231]
    v_mfma_f32_16x16x32_bf16 v[228:231], a[220:223], v[124:127], v[228:231]
    v_max3_f32 v232, v232, v216, v217
    v_max3_f32 v232, v232, v218, v219
    v_max3_f32 v233, v233, v220, v221
    v_max3_f32 v233, v233, v222, v223
    v_max3_f32 v234, v234, v224, v225
    v_max3_f32 v234, v234, v226, v227
    s_nop 1
    v_max3_f32 v235, v235, v228, v229
    v_max3_f32 v235, v235, v230, v231
    ds_read_b128 a[224:227], v8 offset:4096
    ds_read_b128 a[228:231], v9 offset:4096
    ds_read_b128 a[232:235], v10 offset:4096
    ds_read_b128 a[236:239], v11 offset:4096
    s_waitcnt lgkmcnt(3)
    v_mfma_f32_16x16x32_bf16 v[216:219], a[224:227], v[64:67], 0
    s_waitcnt lgkmcnt(2)
    v_mfma_f32_16x16x32_bf16 v[216:219], a[228:231], v[68:71], v[216:219]
    s_waitcnt lgkmcnt(1)
    v_mfma_f32_16x16x32_bf16 v[216:219], a[232:235], v[72:75], v[216:219]
    s_waitcnt lgkmcnt(0)
    v_mfma_f32_16x16x32_bf16 v[216:219], a[236:239], v[76:79], v[216:219]
    v_mfma_f32_16x16x32_bf16 v[220:223], a[224:227], v[80:83], 0
    v_mfma_f32_16x16x32_bf16 v[220:223], a[228:231], v[84:87], v[220:223]
    v_mfma_f32_16x16x32_bf16 v[220:223], a[232:235], v[88:91], v[220:223]
    v_mfma_f32_16x16x32_bf16 v[220:223], a[236:239], v[92:95], v[220:223]
    v_mfma_f32_16x16x32_bf16 v[224:227], a[224:227], v[96:99], 0
    v_mfma_f32_16x16x32_bf16 v[224:227], a[228:231], v[100:103], v[224:227]
    v_mfma_f32_16x16x32_bf16 v[224:227], a[232:235], v[104:107], v[224:227]
    v_mfma_f32_16x16x32_bf16 v[224:227], a[236:239], v[108:111], v[224:227]
    v_mfma_f32_16x16x32_bf16 v[228:231], a[224:227], v[112:115], 0
    v_mfma_f32_16x16x32_bf16 v[228:231], a[228:231], v[116:119], v[228:231]
    v_mfma_f32_16x16x32_bf16 v[228:231], a[232:235], v[120:123], v[228:231]
    v_mfma_f32_16x16x32_bf16 v[228:231], a[236:239], v[124:127], v[228:231]
    v_max3_f32 v232, v232, v216, v217
    v_max3_f32 v232, v232, v218, v219
    v_max3_f32 v233, v233, v220, v221
    v_max3_f32 v233, v233, v222, v223
    v_max3_f32 v234, v234, v224, v225
    v_max3_f32 v234, v234, v226, v227
    s_nop 1
    v_max3_f32 v235, v235, v228, v229
    v_max3_f32 v235, v235, v230, v231
    ds_read_b128 a[208:211], v8 offset:8192
    ds_read_b128 a[212:215], v9 offset:8192
    ds_read_b128 a[216:219], v10 offset:8192
    ds_read_b128 a[220:223], v11 offset:8192
    s_waitcnt lgkmcnt(3)
    v_mfma_f32_16x16x32_bf16 v[216:219], a[208:211], v[64:67], 0
    s_waitcnt lgkmcnt(2)
    v_mfma_f32_16x16x32_bf16 v[216:219], a[212:215], v[68:71], v[216:219]
    s_waitcnt lgkmcnt(1)
    v_mfma_f32_16x16x32_bf16 v[216:219], a[216:219], v[72:75], v[216:219]
    s_waitcnt lgkmcnt(0)
    v_mfma_f32_16x16x32_bf16 v[216:219], a[220:223], v[76:79], v[216:219]
    v_mfma_f32_16x16x32_bf16 v[220:223], a[208:211], v[80:83], 0
    v_mfma_f32_16x16x32_bf16 v[220:223], a[212:215], v[84:87], v[220:223]
    v_mfma_f32_16x16x32_bf16 v[220:223], a[216:219], v[88:91], v[220:223]
    v_mfma_f32_16x16x32_bf16 v[220:223], a[220:223], v[92:95], v[220:223]
    v_mfma_f32_16x16x32_bf16 v[224:227], a[208:211], v[96:99], 0
    v_mfma_f32_16x16x32_bf16 v[224:227], a[212:215], v[100:103], v[224:227]
    v_mfma_f32_16x16x32_bf16 v[224:227], a[216:219], v[104:107], v[224:227]
    v_mfma_f32_16x16x32_bf16 v[224:227], a[220:223], v[108:111], v[224:227]
    v_mfma_f32_16x16x32_bf16 v[228:231], a[208:211], v[112:115], 0
    v_mfma_f32_16x16x32_bf16 v[228:231], a[212:215], v[116:119], v[228:231]
    v_mfma_f32_16x16x32_bf16 v[228:231], a[216:219], v[120:123], v[228:231]
    v_mfma_f32_16x16x32_bf16 v[228:231], a[220:223], v[124:127], v[228:231]
    v_max3_f32 v232, v232, v216, v217
    v_max3_f32 v232, v232, v218, v219
    v_max3_f32 v233, v233, v220, v221
    v_max3_f32 v233, v233, v222, v223
    v_max3_f32 v234, v234, v224, v225
    v_max3_f32 v234, v234, v226, v227
    s_nop 1
    v_max3_f32 v235, v235, v228, v229
    v_max3_f32 v235, v235, v230, v231
    ds_read_b128 a[224:227], v8 offset:12288
    ds_read_b128 a[228:231], v9 offset:12288
    ds_read_b128 a[232:235], v10 offset:12288
    ds_read_b128 a[236:239], v11 offset:12288
    s_waitcnt lgkmcnt(3)
    v_mfma_f32_16x16x32_bf16 v[216:219], a[224:227], v[64:67], 0
    s_waitcnt lgkmcnt(2)
    v_mfma_f32_16x16x32_bf16 v[216:219], a[228:231], v[68:71], v[216:219]
    s_waitcnt lgkmcnt(1)
    v_mfma_f32_16x16x32_bf16 v[216:219], a[232:235], v[72:75], v[216:219]
    s_waitcnt lgkmcnt(0)
    v_mfma_f32_16x16x32_bf16 v[216:219], a[236:239], v[76:79], v[216:219]
    v_mfma_f32_16x16x32_bf16 v[220:223], a[224:227], v[80:83], 0
    v_mfma_f32_16x16x32_bf16 v[220:223], a[228:231], v[84:87], v[220:223]
    v_mfma_f32_16x16x32_bf16 v[220:223], a[232:235], v[88:91], v[220:223]
    v_mfma_f32_16x16x32_bf16 v[220:223], a[236:239], v[92:95], v[220:223]
    v_mfma_f32_16x16x32_bf16 v[224:227], a[224:227], v[96:99], 0
    v_mfma_f32_16x16x32_bf16 v[224:227], a[228:231], v[100:103], v[224:227]
    v_mfma_f32_16x16x32_bf16 v[224:227], a[232:235], v[104:107], v[224:227]
    v_mfma_f32_16x16x32_bf16 v[224:227], a[236:239], v[108:111], v[224:227]
    v_mfma_f32_16x16x32_bf16 v[228:231], a[224:227], v[112:115], 0
    v_mfma_f32_16x16x32_bf16 v[228:231], a[228:231], v[116:119], v[228:231]
    v_mfma_f32_16x16x32_bf16 v[228:231], a[232:235], v[120:123], v[228:231]
    v_mfma_f32_16x16x32_bf16 v[228:231], a[236:239], v[124:127], v[228:231]
    v_max3_f32 v232, v232, v216, v217
    v_max3_f32 v232, v232, v218, v219
    v_max3_f32 v233, v233, v220, v221
    v_max3_f32 v233, v233, v222, v223
    v_max3_f32 v234, v234, v224, v225
    v_max3_f32 v234, v234, v226, v227
    s_nop 1
    v_max3_f32 v235, v235, v228, v229
    v_max3_f32 v235, v235, v230, v231
    s_barrier
    s_cmp_lt_u32 s40, 524288
    s_cbranch_scc1 Lattn_redo_loop
    v_mov_b32 v236, v232
    v_mov_b32 v237, v233
    v_mov_b32 v238, v234
    v_mov_b32 v239, v235
    v_permlane16_swap_b32 v232, v236
    v_permlane16_swap_b32 v233, v237
    v_permlane16_swap_b32 v234, v238
    v_permlane16_swap_b32 v235, v239
    v_max_f32 v232, v232, v236
    v_max_f32 v233, v233, v237
    v_max_f32 v234, v234, v238
    v_max_f32 v235, v235, v239
    v_mov_b32 v236, v232
    v_mov_b32 v237, v233
    v_mov_b32 v238, v234
    v_mov_b32 v239, v235
    v_permlane32_swap_b32 v232, v236
    v_permlane32_swap_b32 v233, v237
    v_permlane32_swap_b32 v234, v238
    v_permlane32_swap_b32 v235, v239
    v_max_f32 v232, v232, v236
    v_max_f32 v233, v233, v237
    v_max_f32 v234, v234, v238
    v_max_f32 v235, v235, v239
    v_sub_f32 v192, 0, v232
    v_sub_f32 v193, 0, v232
    v_sub_f32 v194, 0, v232
    v_sub_f32 v195, 0, v232
    v_sub_f32 v196, 0, v233
    v_sub_f32 v197, 0, v233
    v_sub_f32 v198, 0, v233
    v_sub_f32 v199, 0, v233
    v_sub_f32 v200, 0, v234
    v_sub_f32 v201, 0, v234
    v_sub_f32 v202, 0, v234
    v_sub_f32 v203, 0, v234
    v_sub_f32 v204, 0, v235
    v_sub_f32 v205, 0, v235
    v_sub_f32 v206, 0, v235
    v_sub_f32 v207, 0, v235
    s_mov_b32 s40, 0
    s_mov_b32 s41, 0
    s_add_u32 m0, s42, 0
    s_nop 0
    buffer_load_dwordx4 v36, s[8:11], s40 offen lds
    buffer_load_dwordx4 v37, s[8:11], s40 offen offset:1024 lds
    buffer_load_dwordx4 v38, s[8:11], s40 offen offset:2048 lds
    buffer_load_dwordx4 v39, s[8:11], s40 offen offset:3072 lds
    s_add_u32 s40, s40, 16384
    s_add_u32 m0, s42, 16384
    s_nop 0
    buffer_load_dwordx4 v36, s[8:11], s40 offen lds
    buffer_load_dwordx4 v37, s[8:11], s40 offen offset:1024 lds
    buffer_load_dwordx4 v38, s[8:11], s40 offen offset:2048 lds
    buffer_load_dwordx4 v39, s[8:11], s40 offen offset:3072 lds
    s_add_u32 s40, s40, 16384
    s_add_u32 m0, s42, 32768
    s_nop 0
    buffer_load_dwordx4 v36, s[8:11], s40 offen lds
    buffer_load_dwordx4 v37, s[8:11], s40 offen offset:1024 lds
    buffer_load_dwordx4 v38, s[8:11], s40 offen offset:2048 lds
    buffer_load_dwordx4 v39, s[8:11], s40 offen offset:3072 lds
    s_add_u32 s40, s40, 16384
    s_add_u32 m0, s42, 65536
    s_nop 0
    buffer_load_dwordx4 v40, s[12:15], s41 offen lds
    buffer_load_dwordx4 v41, s[12:15], s41 offen offset:1024 lds
    buffer_load_dwordx4 v40, s[12:15], s41 offen offset:2048 lds
    buffer_load_dwordx4 v41, s[12:15], s41 offen offset:3072 lds
    s_add_u32 s41, s41, 16384
    s_add_u32 m0, s42, 81920
    s_nop 0
    buffer_load_dwordx4 v40, s[12:15], s41 offen lds
    buffer_load_dwordx4 v41, s[12:15], s41 offen offset:1024 lds
    buffer_load_dwordx4 v40, s[12:15], s41 offen offset:2048 lds
    buffer_load_dwordx4 v41, s[12:15], s41 offen offset:3072 lds
    s_add_u32 s41, s41, 16384
    v_accvgpr_write_b32 a0, 0
    v_accvgpr_write_b32 a1, 0
    v_accvgpr_write_b32 a2, 0
    v_accvgpr_write_b32 a3, 0
    v_accvgpr_write_b32 a4, 0
    v_accvgpr_write_b32 a5, 0
    v_accvgpr_write_b32 a6, 0
    v_accvgpr_write_b32 a7, 0
    v_accvgpr_write_b32 a8, 0
    v_accvgpr_write_b32 a9, 0
    v_accvgpr_write_b32 a10, 0
    v_accvgpr_write_b32 a11, 0
    v_accvgpr_write_b32 a12, 0
    v_accvgpr_write_b32 a13, 0
    v_accvgpr_write_b32 a14, 0
    v_accvgpr_write_b32 a15, 0
    v_accvgpr_write_b32 a16, 0
    v_accvgpr_write_b32 a17, 0
    v_accvgpr_write_b32 a18, 0
    v_accvgpr_write_b32 a19, 0
    v_accvgpr_write_b32 a20, 0
    v_accvgpr_write_b32 a21, 0
    v_accvgpr_write_b32 a22, 0
    v_accvgpr_write_b32 a23, 0
    v_accvgpr_write_b32 a24, 0
    v_accvgpr_write_b32 a25, 0
    v_accvgpr_write_b32 a26, 0
    v_accvgpr_write_b32 a27, 0
    v_accvgpr_write_b32 a28, 0
    v_accvgpr_write_b32 a29, 0
    v_accvgpr_write_b32 a30, 0
    v_accvgpr_write_b32 a31, 0
    v_accvgpr_write_b32 a32, 0
    v_accvgpr_write_b32 a33, 0
    v_accvgpr_write_b32 a34, 0
    v_accvgpr_write_b32 a35, 0
    v_accvgpr_write_b32 a36, 0
    v_accvgpr_write_b32 a37, 0
    v_accvgpr_write_b32 a38, 0
    v_accvgpr_write_b32 a39, 0
    v_accvgpr_write_b32 a40, 0
    v_accvgpr_write_b32 a41, 0
    v_accvgpr_write_b32 a42, 0
    v_accvgpr_write_b32 a43, 0
    v_accvgpr_write_b32 a44, 0
    v_accvgpr_write_b32 a45, 0
    v_accvgpr_write_b32 a46, 0
    v_accvgpr_write_b32 a47, 0
    v_accvgpr_write_b32 a48, 0
    v_accvgpr_write_b32 a49, 0
    v_accvgpr_write_b32 a50, 0
    v_accvgpr_write_b32 a51, 0
    v_accvgpr_write_b32 a52, 0
    v_accvgpr_write_b32 a53, 0
    v_accvgpr_write_b32 a54, 0
    v_accvgpr_write_b32 a55, 0
    v_accvgpr_write_b32 a56, 0
    v_accvgpr_write_b32 a57, 0
    v_accvgpr_write_b32 a58, 0
    v_accvgpr_write_b32 a59, 0
    v_accvgpr_write_b32 a60, 0
    v_accvgpr_write_b32 a61, 0
    v_accvgpr_write_b32 a62, 0
    v_accvgpr_write_b32 a63, 0
    v_accvgpr_write_b32 a64, 0
    v_accvgpr_write_b32 a65, 0
    v_accvgpr_write_b32 a66, 0
    v_accvgpr_write_b32 a67, 0
    v_accvgpr_write_b32 a68, 0
    v_accvgpr_write_b32 a69, 0
    v_accvgpr_write_b32 a70, 0
    v_accvgpr_write_b32 a71, 0
    v_accvgpr_write_b32 a72, 0
    v_accvgpr_write_b32 a73, 0
    v_accvgpr_write_b32 a74, 0
    v_accvgpr_write_b32 a75, 0
    v_accvgpr_write_b32 a76, 0
    v_accvgpr_write_b32 a77, 0
    v_accvgpr_write_b32 a78, 0
    v_accvgpr_write_b32 a79, 0
    v_accvgpr_write_b32 a80, 0
    v_accvgpr_write_b32 a81, 0
    v_accvgpr_write_b32 a82, 0
    v_accvgpr_write_b32 a83, 0
    v_accvgpr_write_b32 a84, 0
    v_accvgpr_write_b32 a85, 0
    v_accvgpr_write_b32 a86, 0
    v_accvgpr_write_b32 a87, 0
    v_accvgpr_write_b32 a88, 0
    v_accvgpr_write_b32 a89, 0
    v_accvgpr_write_b32 a90, 0
    v_accvgpr_write_b32 a91, 0
    v_accvgpr_write_b32 a92, 0
    v_accvgpr_write_b32 a93, 0
    v_accvgpr_write_b32 a94, 0
    v_accvgpr_write_b32 a95, 0
    v_accvgpr_write_b32 a96, 0
    v_accvgpr_write_b32 a97, 0
    v_accvgpr_write_b32 a98, 0
    v_accvgpr_write_b32 a99, 0
    v_accvgpr_write_b32 a100, 0
    v_accvgpr_write_b32 a101, 0
    v_accvgpr_write_b32 a102, 0
    v_accvgpr_write_b32 a103, 0
    v_accvgpr_write_b32 a104, 0
    v_accvgpr_write_b32 a105, 0
    v_accvgpr_write_b32 a106, 0
    v_accvgpr_write_b32 a107, 0
    v_accvgpr_write_b32 a108, 0
    v_accvgpr_write_b32 a109, 0
    v_accvgpr_write_b32 a110, 0
    v_accvgpr_write_b32 a111, 0
    v_accvgpr_write_b32 a112, 0
    v_accvgpr_write_b32 a113, 0
    v_accvgpr_write_b32 a114, 0
    v_accvgpr_write_b32 a115, 0
    v_accvgpr_write_b32 a116, 0
    v_accvgpr_write_b32 a117, 0
    v_accvgpr_write_b32 a118, 0
    v_accvgpr_write_b32 a119, 0
    v_accvgpr_write_b32 a120, 0
    v_accvgpr_write_b32 a121, 0
    v_accvgpr_write_b32 a122, 0
    v_accvgpr_write_b32 a123, 0
    v_accvgpr_write_b32 a124, 0
    v_accvgpr_write_b32 a125, 0
    v_accvgpr_write_b32 a126, 0
    v_accvgpr_write_b32 a127, 0
    v_accvgpr_write_b32 a192, 0
    v_accvgpr_write_b32 a193, 0
    v_accvgpr_write_b32 a194, 0
    v_accvgpr_write_b32 a195, 0
    v_accvgpr_write_b32 a196, 0
    v_accvgpr_write_b32 a197, 0
    v_accvgpr_write_b32 a198, 0
    v_accvgpr_write_b32 a199, 0
    v_accvgpr_write_b32 a200, 0
    v_accvgpr_write_b32 a201, 0
    v_accvgpr_write_b32 a202, 0
    v_accvgpr_write_b32 a203, 0
    v_accvgpr_write_b32 a204, 0
    v_accvgpr_write_b32 a205, 0
    v_accvgpr_write_b32 a206, 0
    v_accvgpr_write_b32 a207, 0
    s_waitcnt vmcnt(0) lgkmcnt(0)
    s_barrier
    ds_read_b128 a[208:211], v8 offset:0
    ds_read_b128 a[212:215], v9 offset:0
    ds_read_b128 a[216:219], v10 offset:0
    ds_read_b128 a[220:223], v11 offset:0
    ds_read_b128 a[224:227], v8 offset:4096
    s_waitcnt vmcnt(0) lgkmcnt(0)
    s_branch Lattn_stage0
Lattn_armwait:
    s_mov_b32 s36, 16384
Lattn_armloop:
    v_mov_b32 v63, 0
    buffer_load_dword v63, v63, s[88:91], 0 offen sc1
    s_waitcnt vmcnt(0)
    v_readfirstlane_b32 s37, v63
    s_sub_u32 s36, s36, 1
    s_cbranch_scc1 Lattn_armed
    s_cmp_lt_u32 s37, 256
    s_cbranch_scc1 Lattn_armloop
    s_branch Lattn_armed
Lattn_end:
    s_endpgm
.section .rodata,"a"
.p2align 6
.amdhsa_kernel adaLN_cond__gqa_block_cached__moe_arch_mod__prompt_kernel
  .amdhsa_next_free_vgpr 512
  .amdhsa_next_free_sgpr 102
  .amdhsa_accum_offset 256
  .amdhsa_group_segment_fixed_size 0
  .amdhsa_kernarg_size 120
  .amdhsa_user_sgpr_count 2
  .amdhsa_user_sgpr_kernarg_segment_ptr 1
  .amdhsa_system_sgpr_workgroup_id_x 1
  .amdhsa_float_denorm_mode_32 3
.end_amdhsa_kernel
```

```asm
; @launch grid=(256,1,1) block=(256,1,1) lds=163840
.amdgcn_target "amdgcn-amd-amdhsa--gfx950"
.text
.globl adaLN_cond__gqa_block_cached__moe_arch_mod__prompt_kernel
.p2align 8
.type adaLN_cond__gqa_block_cached__moe_arch_mod__prompt_kernel,@function
adaLN_cond__gqa_block_cached__moe_arch_mod__prompt_kernel:
    s_cmp_ge_u32 s2, 256
    s_cbranch_scc1 Lattn_end
    s_load_dwordx2 s[8:9], s[0:1], 80
    s_load_dwordx2 s[12:13], s[0:1], 88
    s_load_dwordx2 s[20:21], s[0:1], 0
    s_load_dwordx2 s[50:51], s[0:1], 112
    s_load_dwordx8 s[52:59], s[0:1], 8
    s_load_dwordx4 s[80:83], s[0:1], 56
    s_load_dwordx2 s[84:85], s[0:1], 72
    s_load_dwordx2 s[88:89], s[0:1], 104
    s_load_dwordx2 s[28:29], s[0:1], 48
    s_getpc_b64 s[32:33]
Lattn_pc:
    s_mov_b32 s34, Lattn_end-Lattn_pc
    s_mov_b32 s35, 0x20000
    s_lshr_b32 s6, s2, 3
    s_lshl_b32 s7, s6, 6
    v_lshrrev_b32 v3, 6, v0
    v_and_b32 v1, 63, v0
    v_lshrrev_b32 v2, 2, v0
    v_lshlrev_b32 v2, 11, v2
    v_readfirstlane_b32 s3, v3
    buffer_load_dword v240, v2, s[32:35], s7 offen
    s_and_b32 s7, s2, 7
    s_lshl_b32 s4, s7, 1
    s_and_b32 s5, s6, 1
    s_add_u32 s4, s4, s5
    s_lshr_b32 s5, s2, 4
    s_lshr_b32 s38, s6, 2
    s_lshl_b32 s38, s38, 3
    s_add_u32 s38, s38, s7
    s_cmp_lt_u32 s38, 18
    s_cselect_b32 s39, 0, 2147483648
    s_lshl_b32 s38, s38, 2
    s_and_b32 s36, s6, 3
    s_add_u32 s38, s38, s36
    s_mov_b32 s14, 3981312
    s_mul_i32 s92, s6, 124416
    s_lshl_b32 s36, s7, 7
    s_add_u32 s92, s92, s36
    s_cmp_lt_u32 s7, 2
    s_cselect_b32 s36, 53, 35
    v_lshrrev_b32 v2, 2, v0
    v_min_u32 v2, s36, v2
    v_mul_u32_u24 v3, 57, v2
    v_lshrrev_b32 v3, 10, v3
    v_mul_i32_i24 v3, -123392, v3
    v_mul_u32_u24 v2, 6912, v2
    v_add_u32 v72, v2, v3
    s_mov_b32 s15, 0x20000
    s_mov_b32 s10, 1152
    s_mov_b32 s11, 0x20000
    s_mov_b32 s22, 2359296
    s_mov_b32 s23, 0x20000
    v_and_b32 v64, 0xfe, v0
    v_mul_u32_u24 v65, 3456, v64
    v_and_b32 v2, 1, v0
    v_lshl_add_u32 v65, v2, 4, v65
    s_lshl_b32 s36, s38, 5
    s_or_b32 s36, s36, s39
    v_and_b32 v4, 31, v1
    v_lshrrev_b32 v5, 5, v1
    v_cmp_gt_u32 vcc, 24, v4
    v_mov_b32 v6, 2147483648
    s_lshl_b32 s7, s5, 4
    s_add_u32 s7, s7, s4
    s_lshl_b32 s7, s7, 2
    s_add_u32 s7, s7, s3
    v_cndmask_b32 v6, v6, 0, vcc
    s_mul_i32 s49, s7, 2304
    v_lshrrev_b32 v7, 2, v4
    v_lshl_add_u32 v7, v7, 6, v6
    v_and_b32 v2, 3, v4
    v_lshl_add_u32 v7, v2, 3, v7
    v_mul_u32_u24 v2, 1152, v5
    v_add_u32 v66, v7, v2
    s_waitcnt lgkmcnt(0)
    s_load_dword s94, s[50:51], 24576
    buffer_load_dword v241, v72, s[12:15], s92 offen
    buffer_load_ushort v80, v64, s[8:11], 0 offen offset:0
    buffer_load_ushort v81, v64, s[8:11], 0 offen offset:256
    buffer_load_ushort v82, v64, s[8:11], 0 offen offset:512
    buffer_load_ushort v83, v64, s[8:11], 0 offen offset:768
    buffer_load_ushort v84, v64, s[8:11], 0 offen offset:1024
    buffer_load_dwordx4 v[88:91], v65, s[12:15], s36 offen
    s_add_u32 s36, s36, 884736
    buffer_load_dwordx4 v[92:95], v65, s[12:15], s36 offen
    s_add_u32 s36, s36, 884736
    buffer_load_dwordx4 v[96:99], v65, s[12:15], s36 offen
    s_add_u32 s36, s36, 884736
    buffer_load_dwordx4 v[100:103], v65, s[12:15], s36 offen
    s_add_u32 s36, s36, 884736
    buffer_load_dwordx4 v[104:107], v65, s[12:15], s36 offen
    s_mov_b32 s16, s56
    s_mov_b32 s17, s57
    s_mov_b32 s18, 4718592
    s_mov_b32 s19, 0x20000
    s_lshl_b32 s44, s4, 9
    s_mul_i32 s36, s5, 98304
    s_add_u32 s36, s36, 0
    v_lshrrev_b32 v2, 2, v0
    v_min_u32 v2, 47, v2
    v_lshrrev_b32 v3, 2, v2
    v_and_b32 v2, 3, v2
    v_lshl_add_u32 v2, v2, 7, s36
    v_lshl_add_u32 v71, v3, 13, v2
    s_mul_i32 s36, s5, 196608
    s_add_u32 s36, s36, 1572864
    v_lshrrev_b32 v2, 1, v0
    v_min_u32 v2, 95, v2
    v_lshrrev_b32 v3, 2, v2
    v_and_b32 v2, 3, v2
    v_lshl_add_u32 v2, v2, 7, s36
    v_lshl_add_u32 v70, v3, 13, v2
    s_add_u32 s92, s49, 65536
    v_lshl_add_u32 v7, v5, 4, v6
    v_lshl_add_u32 v67, v4, 5, v7
    v_min_u32 v4, 23, v4
    v_lshlrev_b32 v68, 4, v4
    s_mov_b32 s24, s50
    s_mov_b32 s25, s51
    s_mov_b32 s26, 10485760
    s_mov_b32 s27, 0x20000
    s_mov_b32 s90, 256
    s_mov_b32 s91, 0x20000
    s_cmp_ge_u32 s38, 36
    s_cselect_b32 s93, 1.0, 0
    s_lshl_b32 s36, s38, 7
    v_lshl_add_u32 v69, v0, 3, s36
    v_cmp_gt_u32 s[36:37], 16, v0
    v_mov_b32 v2, 2147483648
    v_mov_b32 v3, s39
    v_cndmask_b32 v2, v2, v3, s[36:37]
    v_or_b32 v69, v69, v2
    s_mul_i32 s36, s5, 3072
    s_lshl_b32 s37, s5, 11
    v_lshrrev_b32 v120, 3, v0
    v_min_u32 v120, 23, v120
    v_lshl_add_u32 v120, v120, 7, s36
    v_lshrrev_b32 v121, 4, v0
    v_lshl_add_u32 v121, v121, 7, s37
    s_lshl_b32 s42, s3, 12
    v_lshrrev_b32 v2, 4, v1
    v_and_b32 v3, 15, v1
    v_lshrrev_b32 v5, 1, v3
    v_mul_u32_u24 v5, 2304, v5
    v_lshl_add_u32 v5, v2, 5, v5
    v_and_b32 v6, 1, v3
    v_lshl_add_u32 v51, v6, 4, v5
    s_lshl_b32 s6, s5, 2
    s_add_u32 s6, s6, s3
    s_mul_i32 s46, s6, 36864
    s_add_u32 s46, s46, 65536
    s_add_u32 s43, s46, 18432
    s_mul_i32 s45, s4, 294912
    s_lshl_b32 s7, s3, 4
    v_add_u32 v4, s7, v2
    v_lshlrev_b32 v5, 1, v2
    v_xor_b32 v5, v5, v3
    v_xor_b32 v6, 8, v5
    v_lshlrev_b32 v7, 13, v4
    v_lshl_add_u32 v42, v5, 4, v7
    v_lshl_add_u32 v43, v6, 4, v7
    v_add_u32 v44, 63488, v42
    v_add_u32 v45, 95232, v43
    v_add_u32 v43, 31744, v43
    s_lshl_b32 s7, s4, 19
    s_add_u32 s8, s52, s7
    s_addc_u32 s9, s53, 0
    s_mov_b32 s10, 524288
    s_mov_b32 s11, 0x20000
    s_add_u32 s12, s54, s7
    s_addc_u32 s13, s55, 0
    s_mov_b32 s14, 524288
    s_mov_b32 s15, 0x20000
    s_add_u32 s28, s50, 10485760
    s_addc_u32 s29, s51, 0
    s_mov_b32 s30, 37748736
    s_mov_b32 s31, 0x20000
    v_lshlrev_b32 v7, 8, v4
    v_lshl_add_u32 v40, v5, 4, v7
    v_lshl_add_u32 v41, v6, 4, v7
    v_xor_b32 v224, v3, v2
    v_lshl_add_u32 v36, v224, 4, v7
    v_xor_b32 v37, 64, v36
    v_xor_b32 v38, 128, v36
    v_xor_b32 v39, 192, v36
    v_lshrrev_b32 v7, 3, v5
    v_lshl_add_u32 v7, v7, 7, v4
    v_mul_u32_u24 v7, 1152, v7
    v_and_b32 v225, 7, v5
    v_lshl_add_u32 v46, v225, 4, v7
    v_lshrrev_b32 v7, 3, v6
    v_lshl_add_u32 v7, v7, 7, v4
    v_mul_u32_u24 v7, 1152, v7
    v_and_b32 v225, 7, v6
    v_lshl_add_u32 v47, v225, 4, v7
    v_add_u32 v48, 7168, v46
    v_add_u32 v49, 10752, v47
    v_add_u32 v47, 3584, v47
    v_lshlrev_b32 v7, 8, v3
    v_lshl_add_u32 v8, v224, 4, v7
    v_xor_b32 v9, 64, v8
    v_xor_b32 v10, 128, v8
    v_xor_b32 v11, 192, v8
    v_lshrrev_b32 v5, 2, v1
    v_and_b32 v6, 7, v5
    v_lshlrev_b32 v6, 5, v6
    v_lshl_add_u32 v6, v5, 8, v6
    v_and_b32 v7, 3, v1
    v_lshl_add_u32 v12, v7, 3, v6
    v_xor_b32 v13, 32, v12
    v_xor_b32 v14, 64, v12
    v_xor_b32 v15, 96, v12
    v_xor_b32 v16, 128, v12
    v_xor_b32 v17, 160, v12
    v_xor_b32 v18, 192, v12
    v_xor_b32 v19, 224, v12
    v_add_u32 v20, 65536, v12
    v_add_u32 v21, 65536, v13
    v_add_u32 v22, 65536, v14
    v_add_u32 v23, 65536, v15
    v_add_u32 v24, 65536, v16
    v_add_u32 v25, 65536, v17
    v_add_u32 v26, 65536, v18
    v_add_u32 v27, 65536, v19
    v_add_u32 v28, 131072, v12
    v_add_u32 v29, 131072, v13
    v_add_u32 v30, 131072, v14
    v_add_u32 v31, 131072, v15
    v_add_u32 v32, 131072, v16
    v_add_u32 v33, 131072, v17
    v_add_u32 v34, 131072, v18
    v_add_u32 v35, 131072, v19
    v_mov_b32 v52, 0x3f803f80
    v_mov_b32 v53, 0x3f803f80
    v_mov_b32 v54, 0x3f803f80
    v_mov_b32 v55, 0x3f803f80
    v_and_b32 v5, 1, v1
    v_mul_u32_u24 v5, 0xaaaa, v5
    v_add_u32 v5, 0x4444, v5
    v_lshl_add_u32 v50, v5, 16, v5
    v_lshrrev_b32 v5, 1, v3
    v_mul_u32_u24 v5, 20480, v5
    v_lshl_add_u32 v5, v2, 5, v5
    v_and_b32 v6, 1, v3
    v_lshl_add_u32 v56, v6, 4, v5
    s_mul_i32 s47, s6, 327680
    s_mov_b32 s32, s82
    s_mov_b32 s33, s83
    s_mov_b32 s34, 5308416
    s_mov_b32 s35, 0x20000
    s_mov_b32 s82, 5308416
    s_mov_b32 s83, 0x20000
    s_mov_b32 s86, 5308416
    s_mov_b32 s87, 0x20000
    s_lshr_b32 s7, s2, 3
    s_mul_i32 s7, s7, 18
    s_add_u32 s7, s7, s3
    s_and_b32 s36, s2, 7
    s_mul_i32 s37, s36, 576
    s_add_u32 s37, s37, s7
    s_mul_i32 s37, s37, 1152
    s_mul_i32 s7, s7, 9216
    s_mul_i32 s36, s36, 1152
    s_add_u32 s7, s7, s36
    v_min_u32 v5, 17, v1
    v_lshl_add_u32 v57, v5, 6, s7
    v_lshl_add_u32 v62, v5, 6, s37
    s_mov_b32 s40, 0
    s_mov_b32 s41, 0
    s_mov_b32 s48, 0
    s_waitcnt vmcnt(9)
    v_lshlrev_b32 v80, 16, v80
    s_waitcnt vmcnt(8)
    v_lshlrev_b32 v81, 16, v81
    s_waitcnt vmcnt(7)
    v_lshlrev_b32 v82, 16, v82
    s_waitcnt vmcnt(6)
    v_lshlrev_b32 v83, 16, v83
    s_waitcnt vmcnt(5)
    v_lshlrev_b32 v84, 16, v84
    v_mul_f32 v144, 0xbfb8aa3b, v80
    v_mul_f32 v148, 0xbfb8aa3b, v81
    v_mul_f32 v152, 0xbfb8aa3b, v82
    v_mul_f32 v156, 0xbfb8aa3b, v83
    v_mul_f32 v160, 0xbfb8aa3b, v84
    v_min_f32 v144, 0x42fc0000, v144
    v_min_f32 v148, 0x42fc0000, v148
    v_min_f32 v152, 0x42fc0000, v152
    v_min_f32 v156, 0x42fc0000, v156
    v_min_f32 v160, 0x42fc0000, v160
    v_exp_f32 v144, v144
    v_exp_f32 v148, v148
    v_exp_f32 v152, v152
    v_exp_f32 v156, v156
    v_exp_f32 v160, v160
    v_add_f32 v144, 1.0, v144
    v_add_f32 v148, 1.0, v148
    v_add_f32 v152, 1.0, v152
    v_add_f32 v156, 1.0, v156
    v_add_f32 v160, 1.0, v160
    v_rcp_f32 v145, v144
    v_rcp_f32 v149, v148
    v_rcp_f32 v153, v152
    v_rcp_f32 v157, v156
    v_rcp_f32 v161, v160
    v_mul_f32 v146, v80, v145
    v_mul_f32 v150, v81, v149
    v_mul_f32 v154, v82, v153
    v_mul_f32 v158, v83, v157
    v_mul_f32 v162, v84, v161
    v_fma_f32 v144, -v146, v144, v80
    v_fma_f32 v148, -v150, v148, v81
    v_fma_f32 v152, -v154, v152, v82
    v_fma_f32 v156, -v158, v156, v83
    v_fma_f32 v160, -v162, v160, v84
    v_fma_f32 v80, v144, v145, v146
    v_fma_f32 v81, v148, v149, v150
    v_fma_f32 v82, v152, v153, v154
    v_fma_f32 v83, v156, v157, v158
    v_fma_f32 v84, v160, v161, v162
    v_cvt_pk_bf16_f32 v80, v80, v80
    v_cvt_pk_bf16_f32 v81, v81, v81
    v_cvt_pk_bf16_f32 v82, v82, v82
    v_cvt_pk_bf16_f32 v83, v83, v83
    v_cvt_pk_bf16_f32 v84, v84, v84
    v_and_b32 v80, 0xffff0000, v80
    v_and_b32 v81, 0xffff0000, v81
    v_and_b32 v82, 0xffff0000, v82
    v_and_b32 v83, 0xffff0000, v83
    v_and_b32 v84, 0xffff0000, v84
    buffer_load_dwordx2 v[108:109], v66, s[20:23], s49 offen offset:0
    buffer_load_dwordx2 v[110:111], v66, s[20:23], s49 offen offset:32
    buffer_load_dwordx2 v[112:113], v66, s[20:23], s49 offen offset:384
    buffer_load_dwordx2 v[114:115], v66, s[20:23], s49 offen offset:416
    buffer_load_dwordx2 v[116:117], v66, s[20:23], s49 offen offset:768
    buffer_load_dwordx2 v[118:119], v66, s[20:23], s49 offen offset:800
    s_mov_b32 s20, s58
    s_mov_b32 s21, s59
    s_mov_b32 s22, 4718592
    s_mov_b32 s23, 0x20000
    s_waitcnt vmcnt(10)
    v_lshlrev_b32 v136, 16, v88
    v_and_b32 v137, 0xffff0000, v88
    v_lshlrev_b32 v138, 16, v89
    v_and_b32 v139, 0xffff0000, v89
    v_lshlrev_b32 v140, 16, v90
    v_and_b32 v141, 0xffff0000, v90
    v_lshlrev_b32 v142, 16, v91
    v_and_b32 v143, 0xffff0000, v91
    v_pk_mul_f32 v[128:129], v[136:137], v[80:81] op_sel:[0,0] op_sel_hi:[1,0]
    v_pk_mul_f32 v[130:131], v[138:139], v[80:81] op_sel:[0,0] op_sel_hi:[1,0]
    v_pk_mul_f32 v[132:133], v[140:141], v[80:81] op_sel:[0,0] op_sel_hi:[1,0]
    v_pk_mul_f32 v[134:135], v[142:143], v[80:81] op_sel:[0,0] op_sel_hi:[1,0]
    s_waitcnt vmcnt(9)
    v_lshlrev_b32 v136, 16, v92
    v_and_b32 v137, 0xffff0000, v92
    v_lshlrev_b32 v138, 16, v93
    v_and_b32 v139, 0xffff0000, v93
    v_lshlrev_b32 v140, 16, v94
    v_and_b32 v141, 0xffff0000, v94
    v_lshlrev_b32 v142, 16, v95
    v_and_b32 v143, 0xffff0000, v95
    v_pk_fma_f32 v[128:129], v[136:137], v[80:81], v[128:129] op_sel:[0,1,0] op_sel_hi:[1,1,1]
    v_pk_fma_f32 v[130:131], v[138:139], v[80:81], v[130:131] op_sel:[0,1,0] op_sel_hi:[1,1,1]
    v_pk_fma_f32 v[132:133], v[140:141], v[80:81], v[132:133] op_sel:[0,1,0] op_sel_hi:[1,1,1]
    v_pk_fma_f32 v[134:135], v[142:143], v[80:81], v[134:135] op_sel:[0,1,0] op_sel_hi:[1,1,1]
    s_waitcnt vmcnt(8)
    v_lshlrev_b32 v136, 16, v96
    v_and_b32 v137, 0xffff0000, v96
    v_lshlrev_b32 v138, 16, v97
    v_and_b32 v139, 0xffff0000, v97
    v_lshlrev_b32 v140, 16, v98
    v_and_b32 v141, 0xffff0000, v98
    v_lshlrev_b32 v142, 16, v99
    v_and_b32 v143, 0xffff0000, v99
    v_pk_fma_f32 v[128:129], v[136:137], v[82:83], v[128:129] op_sel:[0,0,0] op_sel_hi:[1,0,1]
    v_pk_fma_f32 v[130:131], v[138:139], v[82:83], v[130:131] op_sel:[0,0,0] op_sel_hi:[1,0,1]
    v_pk_fma_f32 v[132:133], v[140:141], v[82:83], v[132:133] op_sel:[0,0,0] op_sel_hi:[1,0,1]
    v_pk_fma_f32 v[134:135], v[142:143], v[82:83], v[134:135] op_sel:[0,0,0] op_sel_hi:[1,0,1]
    s_waitcnt vmcnt(7)
    v_lshlrev_b32 v136, 16, v100
    v_and_b32 v137, 0xffff0000, v100
    v_lshlrev_b32 v138, 16, v101
    v_and_b32 v139, 0xffff0000, v101
    v_lshlrev_b32 v140, 16, v102
    v_and_b32 v141, 0xffff0000, v102
    v_lshlrev_b32 v142, 16, v103
    v_and_b32 v143, 0xffff0000, v103
    v_pk_fma_f32 v[128:129], v[136:137], v[82:83], v[128:129] op_sel:[0,1,0] op_sel_hi:[1,1,1]
    v_pk_fma_f32 v[130:131], v[138:139], v[82:83], v[130:131] op_sel:[0,1,0] op_sel_hi:[1,1,1]
    v_pk_fma_f32 v[132:133], v[140:141], v[82:83], v[132:133] op_sel:[0,1,0] op_sel_hi:[1,1,1]
    v_pk_fma_f32 v[134:135], v[142:143], v[82:83], v[134:135] op_sel:[0,1,0] op_sel_hi:[1,1,1]
    s_waitcnt vmcnt(6)
    v_lshlrev_b32 v136, 16, v104
    v_and_b32 v137, 0xffff0000, v104
    v_lshlrev_b32 v138, 16, v105
    v_and_b32 v139, 0xffff0000, v105
    v_lshlrev_b32 v140, 16, v106
    v_and_b32 v141, 0xffff0000, v106
    v_lshlrev_b32 v142, 16, v107
    v_and_b32 v143, 0xffff0000, v107
    v_pk_fma_f32 v[128:129], v[136:137], v[84:85], v[128:129] op_sel:[0,0,0] op_sel_hi:[1,0,1]
    v_pk_fma_f32 v[130:131], v[138:139], v[84:85], v[130:131] op_sel:[0,0,0] op_sel_hi:[1,0,1]
    v_pk_fma_f32 v[132:133], v[140:141], v[84:85], v[132:133] op_sel:[0,0,0] op_sel_hi:[1,0,1]
    v_pk_fma_f32 v[134:135], v[142:143], v[84:85], v[134:135] op_sel:[0,0,0] op_sel_hi:[1,0,1]
    s_nop 0
    v_permlane32_swap_b32 v128, v132
    v_permlane32_swap_b32 v129, v133
    v_permlane32_swap_b32 v130, v134
    v_permlane32_swap_b32 v131, v135
    v_and_b32 v72, 1, v1
    v_pk_add_f32 v[128:129], v[128:129], v[132:133]
    v_pk_add_f32 v[130:131], v[130:131], v[134:135]
    v_lshlrev_b32 v72, 5, v72
    v_lshrrev_b32 v73, 4, v1
    v_permlane16_swap_b32 v128, v130
    v_permlane16_swap_b32 v129, v131
    v_lshl_add_u32 v72, v73, 3, v72
    v_pk_add_f32 v[128:129], v[128:129], v[130:131]
    s_lshl_b32 s36, s3, 6
    v_add_u32 v72, s36, v72
    v_add_f32_dpp v128, v128, v128 row_ror:2 row_mask:0xf bank_mask:0xf
    v_add_f32_dpp v129, v129, v129 row_ror:2 row_mask:0xf bank_mask:0xf
    s_nop 0
    v_add_f32_dpp v128, v128, v128 row_ror:4 row_mask:0xf bank_mask:0xf
    v_add_f32_dpp v129, v129, v129 row_ror:4 row_mask:0xf bank_mask:0xf
    s_nop 0
    v_add_f32_dpp v128, v128, v128 row_ror:8 row_mask:0xf bank_mask:0xf
    v_add_f32_dpp v129, v129, v129 row_ror:8 row_mask:0xf bank_mask:0xf
    ds_write_b64 v72, v[128:129] offset:0
    v_and_b32 v73, 7, v1
    v_lshlrev_b32 v73, 3, v73
    s_waitcnt lgkmcnt(0)
    s_barrier
    ds_read_b64 v[128:129], v73 offset:0
    ds_read_b64 v[130:131], v73 offset:64
    ds_read_b64 v[132:133], v73 offset:128
    ds_read_b64 v[134:135], v73 offset:192
    s_add_u32 s95, s94, 0x9e3779b9
    v_mov_b32 v137, s95
    s_mov_b32 s37, 32768
    s_waitcnt lgkmcnt(2)
    v_pk_add_f32 v[128:129], v[128:129], v[130:131]
    s_waitcnt lgkmcnt(0)
    v_pk_add_f32 v[132:133], v[132:133], v[134:135]
    v_pk_add_f32 v[128:129], v[128:129], v[132:133]
    v_cvt_pk_bf16_f32 v136, v128, v129
    v_lshlrev_b32 v128, 16, v136
    v_and_b32 v129, 0xffff0000, v136
    v_add_f32 v128, s93, v128
    v_add_f32 v129, s93, v129
    v_cvt_pk_bf16_f32 v136, v128, v129
    buffer_store_dwordx2 v[136:137], v69, s[24:27], s37 offen sc1
    s_mul_i32 s36, s3, 72
    v_add_u32 v122, s36, v1
    v_and_b32 v123, 7, v1
    s_add_u32 s36, s36, 64
    v_add_u32 v123, s36, v123
    s_movk_i32 s36, 1024
    v_and_b32 v76, 3, v122
    v_lshlrev_b32 v76, 4, v76
    v_lshrrev_b32 v122, 2, v122
    v_lshl_add_u32 v124, v122, 7, v76
    v_and_b32 v77, 1, v122
    v_lshl_add_u32 v76, v77, 3, v76
    v_lshrrev_b32 v122, 1, v122
    v_lshl_add_u32 v122, v122, 6, v76
    v_add_u32 v122, s36, v122
    v_and_b32 v76, 3, v123
    v_lshlrev_b32 v76, 4, v76
    v_lshrrev_b32 v123, 2, v123
    v_lshl_add_u32 v125, v123, 7, v76
    v_and_b32 v77, 1, v123
    v_lshl_add_u32 v76, v77, 3, v76
    v_lshrrev_b32 v123, 1, v123
    v_lshl_add_u32 v123, v123, 6, v76
    v_add_u32 v123, s36, v123
    s_mov_b64 exec, 0
    s_cmp_eq_u32 s3, 0
    s_cbranch_scc1 Ltour0
    s_cmp_eq_u32 s3, 1
    s_cbranch_scc1 Ltour1
    s_cmp_eq_u32 s3, 2
    s_cbranch_scc1 Ltour2
    s_branch Ltour3
.p2align 12
Lmain:
    s_mov_b64 exec, -1
    s_waitcnt vmcnt(6)
    v_lshlrev_b32 v144, 16, v108
    v_and_b32 v145, 0xffff0000, v108
    v_lshlrev_b32 v146, 16, v109
    v_and_b32 v147, 0xffff0000, v109
    s_waitcnt vmcnt(5)
    v_lshlrev_b32 v148, 16, v110
    v_and_b32 v149, 0xffff0000, v110
    v_lshlrev_b32 v150, 16, v111
    v_and_b32 v151, 0xffff0000, v111
    s_waitcnt vmcnt(4)
    v_lshlrev_b32 v152, 16, v112
    v_and_b32 v153, 0xffff0000, v112
    v_lshlrev_b32 v154, 16, v113
    v_and_b32 v155, 0xffff0000, v113
    s_waitcnt vmcnt(3)
    v_lshlrev_b32 v156, 16, v114
    v_and_b32 v157, 0xffff0000, v114
    v_lshlrev_b32 v158, 16, v115
    v_and_b32 v159, 0xffff0000, v115
    s_waitcnt vmcnt(2)
    v_lshlrev_b32 v160, 16, v116
    v_and_b32 v161, 0xffff0000, v116
    v_lshlrev_b32 v162, 16, v117
    v_and_b32 v163, 0xffff0000, v117
    s_waitcnt vmcnt(1)
    v_lshlrev_b32 v164, 16, v118
    v_and_b32 v165, 0xffff0000, v118
    v_lshlrev_b32 v166, 16, v119
    v_and_b32 v167, 0xffff0000, v119
    buffer_load_dwordx4 v[88:91], v124, s[24:27], s37 offen sc1
    buffer_load_dwordx4 v[92:95], v125, s[24:27], s37 offen sc1
    buffer_load_dword v242, v71, s[16:19], s44 offen
    v_pk_add_f32 v[72:73], v[144:145], v[148:149]
    v_pk_add_f32 v[76:77], v[146:147], v[150:151]
    v_pk_add_f32 v[72:73], v[72:73], v[152:153]
    v_pk_add_f32 v[76:77], v[76:77], v[154:155]
    v_pk_add_f32 v[72:73], v[72:73], v[156:157]
    v_pk_add_f32 v[76:77], v[76:77], v[158:159]
    v_pk_add_f32 v[72:73], v[72:73], v[160:161]
    v_pk_add_f32 v[76:77], v[76:77], v[162:163]
    v_pk_add_f32 v[72:73], v[72:73], v[164:165]
    v_pk_add_f32 v[76:77], v[76:77], v[166:167]
    v_pk_add_f32 v[72:73], v[72:73], v[76:77]
    v_add_f32 v72, v72, v73
    s_nop 1
    v_add_f32_dpp v72, v72, v72 row_ror:8 row_mask:0xf bank_mask:0xf
    s_nop 1
    v_add_f32_dpp v72, v72, v72 row_ror:4 row_mask:0xf bank_mask:0xf
    s_nop 1
    v_add_f32_dpp v72, v72, v72 row_ror:2 row_mask:0xf bank_mask:0xf
    s_nop 1
    v_add_f32_dpp v72, v72, v72 row_ror:1 row_mask:0xf bank_mask:0xf
    v_mov_b32 v76, v72
    s_nop 1
    v_permlane16_swap_b32 v72, v76
    s_nop 0
    v_add_f32 v72, v72, v76
    v_mul_f32 v72, 0x3ae38e39, v72
    v_pk_add_f32 v[168:169], v[144:145], v[72:73] op_sel_hi:[1,0] neg_lo:[0,1] neg_hi:[0,1]
    v_pk_add_f32 v[170:171], v[146:147], v[72:73] op_sel_hi:[1,0] neg_lo:[0,1] neg_hi:[0,1]
    v_pk_add_f32 v[172:173], v[148:149], v[72:73] op_sel_hi:[1,0] neg_lo:[0,1] neg_hi:[0,1]
    v_pk_add_f32 v[174:175], v[150:151], v[72:73] op_sel_hi:[1,0] neg_lo:[0,1] neg_hi:[0,1]
    v_pk_add_f32 v[176:177], v[152:153], v[72:73] op_sel_hi:[1,0] neg_lo:[0,1] neg_hi:[0,1]
    v_pk_add_f32 v[178:179], v[154:155], v[72:73] op_sel_hi:[1,0] neg_lo:[0,1] neg_hi:[0,1]
    v_pk_add_f32 v[180:181], v[156:157], v[72:73] op_sel_hi:[1,0] neg_lo:[0,1] neg_hi:[0,1]
    v_pk_add_f32 v[182:183], v[158:159], v[72:73] op_sel_hi:[1,0] neg_lo:[0,1] neg_hi:[0,1]
    v_pk_add_f32 v[184:185], v[160:161], v[72:73] op_sel_hi:[1,0] neg_lo:[0,1] neg_hi:[0,1]
    v_pk_add_f32 v[186:187], v[162:163], v[72:73] op_sel_hi:[1,0] neg_lo:[0,1] neg_hi:[0,1]
    v_pk_add_f32 v[188:189], v[164:165], v[72:73] op_sel_hi:[1,0] neg_lo:[0,1] neg_hi:[0,1]
    v_pk_add_f32 v[190:191], v[166:167], v[72:73] op_sel_hi:[1,0] neg_lo:[0,1] neg_hi:[0,1]
    v_pk_mul_f32 v[74:75], v[168:169], v[168:169]
    v_pk_mul_f32 v[76:77], v[170:171], v[170:171]
    v_pk_fma_f32 v[74:75], v[172:173], v[172:173], v[74:75]
    v_pk_fma_f32 v[76:77], v[174:175], v[174:175], v[76:77]
    v_pk_fma_f32 v[74:75], v[176:177], v[176:177], v[74:75]
    v_pk_fma_f32 v[76:77], v[178:179], v[178:179], v[76:77]
    v_pk_fma_f32 v[74:75], v[180:181], v[180:181], v[74:75]
    v_pk_fma_f32 v[76:77], v[182:183], v[182:183], v[76:77]
    v_pk_fma_f32 v[74:75], v[184:185], v[184:185], v[74:75]
    v_pk_fma_f32 v[76:77], v[186:187], v[186:187], v[76:77]
    v_pk_fma_f32 v[74:75], v[188:189], v[188:189], v[74:75]
    v_pk_fma_f32 v[76:77], v[190:191], v[190:191], v[76:77]
    v_pk_add_f32 v[74:75], v[74:75], v[76:77]
    v_add_f32 v74, v74, v75
    v_cndmask_b32 v74, 0, v74, vcc
    s_nop 1
    v_add_f32_dpp v74, v74, v74 row_ror:8 row_mask:0xf bank_mask:0xf
    s_nop 1
    v_add_f32_dpp v74, v74, v74 row_ror:4 row_mask:0xf bank_mask:0xf
    s_nop 1
    v_add_f32_dpp v74, v74, v74 row_ror:2 row_mask:0xf bank_mask:0xf
    s_nop 1
    v_add_f32_dpp v74, v74, v74 row_ror:1 row_mask:0xf bank_mask:0xf
    v_mov_b32 v76, v74
    s_nop 1
    v_permlane16_swap_b32 v74, v76
    s_nop 0
    v_add_f32 v74, v74, v76
    v_mul_f32 v74, 0x3ae38e39, v74
    v_cvt_pk_bf16_f32 v76, v72, v74
    v_and_b32 v74, 0xffff0000, v76
    v_lshlrev_b32 v72, 16, v76
    v_add_f32 v74, 0x3727c5ac, v74
    v_cvt_pk_bf16_f32 v74, v74, v74
    v_and_b32 v74, 0xffff0000, v74
    v_sqrt_f32 v74, v74
    v_pk_add_f32 v[168:169], v[144:145], v[72:73] op_sel_hi:[1,0] neg_lo:[0,1] neg_hi:[0,1]
    v_pk_add_f32 v[170:171], v[146:147], v[72:73] op_sel_hi:[1,0] neg_lo:[0,1] neg_hi:[0,1]
    v_pk_add_f32 v[172:173], v[148:149], v[72:73] op_sel_hi:[1,0] neg_lo:[0,1] neg_hi:[0,1]
    v_pk_add_f32 v[174:175], v[150:151], v[72:73] op_sel_hi:[1,0] neg_lo:[0,1] neg_hi:[0,1]
    v_pk_add_f32 v[176:177], v[152:153], v[72:73] op_sel_hi:[1,0] neg_lo:[0,1] neg_hi:[0,1]
    v_pk_add_f32 v[178:179], v[154:155], v[72:73] op_sel_hi:[1,0] neg_lo:[0,1] neg_hi:[0,1]
    v_pk_add_f32 v[180:181], v[156:157], v[72:73] op_sel_hi:[1,0] neg_lo:[0,1] neg_hi:[0,1]
    v_pk_add_f32 v[182:183], v[158:159], v[72:73] op_sel_hi:[1,0] neg_lo:[0,1] neg_hi:[0,1]
    v_pk_add_f32 v[184:185], v[160:161], v[72:73] op_sel_hi:[1,0] neg_lo:[0,1] neg_hi:[0,1]
    v_pk_add_f32 v[186:187], v[162:163], v[72:73] op_sel_hi:[1,0] neg_lo:[0,1] neg_hi:[0,1]
    v_pk_add_f32 v[188:189], v[164:165], v[72:73] op_sel_hi:[1,0] neg_lo:[0,1] neg_hi:[0,1]
    v_pk_add_f32 v[190:191], v[166:167], v[72:73] op_sel_hi:[1,0] neg_lo:[0,1] neg_hi:[0,1]
    v_cvt_pk_bf16_f32 v74, v74, v74
    v_and_b32 v74, 0xffff0000, v74
    v_rcp_f32 v74, v74
    v_cvt_pk_bf16_f32 v108, v168, v169
    v_cvt_pk_bf16_f32 v109, v170, v171
    v_cvt_pk_bf16_f32 v110, v172, v173
    v_cvt_pk_bf16_f32 v111, v174, v175
    v_cvt_pk_bf16_f32 v112, v176, v177
    v_cvt_pk_bf16_f32 v113, v178, v179
    v_cvt_pk_bf16_f32 v114, v180, v181
    v_cvt_pk_bf16_f32 v115, v182, v183
    v_cvt_pk_bf16_f32 v116, v184, v185
    v_cvt_pk_bf16_f32 v117, v186, v187
    v_cvt_pk_bf16_f32 v118, v188, v189
    v_cvt_pk_bf16_f32 v119, v190, v191
    v_lshlrev_b32 v168, 16, v108
    v_and_b32 v169, 0xffff0000, v108
    v_lshlrev_b32 v170, 16, v109
    v_and_b32 v171, 0xffff0000, v109
    v_lshlrev_b32 v172, 16, v110
    v_and_b32 v173, 0xffff0000, v110
    v_lshlrev_b32 v174, 16, v111
    v_and_b32 v175, 0xffff0000, v111
    v_lshlrev_b32 v176, 16, v112
    v_and_b32 v177, 0xffff0000, v112
    v_lshlrev_b32 v178, 16, v113
    v_and_b32 v179, 0xffff0000, v113
    v_lshlrev_b32 v180, 16, v114
    v_and_b32 v181, 0xffff0000, v114
    v_lshlrev_b32 v182, 16, v115
    v_and_b32 v183, 0xffff0000, v115
    v_lshlrev_b32 v184, 16, v116
    v_and_b32 v185, 0xffff0000, v116
    v_lshlrev_b32 v186, 16, v117
    v_and_b32 v187, 0xffff0000, v117
    v_lshlrev_b32 v188, 16, v118
    v_and_b32 v189, 0xffff0000, v118
    v_lshlrev_b32 v190, 16, v119
    v_and_b32 v191, 0xffff0000, v119
    v_pk_mul_f32 v[168:169], v[168:169], v[74:75] op_sel_hi:[1,0]
    v_pk_mul_f32 v[170:171], v[170:171], v[74:75] op_sel_hi:[1,0]
    v_pk_mul_f32 v[172:173], v[172:173], v[74:75] op_sel_hi:[1,0]
    v_pk_mul_f32 v[174:175], v[174:175], v[74:75] op_sel_hi:[1,0]
    v_pk_mul_f32 v[176:177], v[176:177], v[74:75] op_sel_hi:[1,0]
    v_pk_mul_f32 v[178:179], v[178:179], v[74:75] op_sel_hi:[1,0]
    v_pk_mul_f32 v[180:181], v[180:181], v[74:75] op_sel_hi:[1,0]
    v_pk_mul_f32 v[182:183], v[182:183], v[74:75] op_sel_hi:[1,0]
    v_pk_mul_f32 v[184:185], v[184:185], v[74:75] op_sel_hi:[1,0]
    v_pk_mul_f32 v[186:187], v[186:187], v[74:75] op_sel_hi:[1,0]
    v_pk_mul_f32 v[188:189], v[188:189], v[74:75] op_sel_hi:[1,0]
    v_pk_mul_f32 v[190:191], v[190:191], v[74:75] op_sel_hi:[1,0]
    v_cvt_pk_bf16_f32 v108, v168, v169
    v_cvt_pk_bf16_f32 v109, v170, v171
    v_cvt_pk_bf16_f32 v110, v172, v173
    v_cvt_pk_bf16_f32 v111, v174, v175
    v_cvt_pk_bf16_f32 v112, v176, v177
    v_cvt_pk_bf16_f32 v113, v178, v179
    v_cvt_pk_bf16_f32 v114, v180, v181
    v_cvt_pk_bf16_f32 v115, v182, v183
    v_cvt_pk_bf16_f32 v116, v184, v185
    v_cvt_pk_bf16_f32 v117, v186, v187
    v_cvt_pk_bf16_f32 v118, v188, v189
    v_cvt_pk_bf16_f32 v119, v190, v191
    v_lshlrev_b32 v168, 16, v108
    v_and_b32 v169, 0xffff0000, v108
    v_lshlrev_b32 v170, 16, v109
    v_and_b32 v171, 0xffff0000, v109
    v_lshlrev_b32 v172, 16, v110
    v_and_b32 v173, 0xffff0000, v110
    v_lshlrev_b32 v174, 16, v111
    v_and_b32 v175, 0xffff0000, v111
    v_lshlrev_b32 v176, 16, v112
    v_and_b32 v177, 0xffff0000, v112
    v_lshlrev_b32 v178, 16, v113
    v_and_b32 v179, 0xffff0000, v113
    v_lshlrev_b32 v180, 16, v114
    v_and_b32 v181, 0xffff0000, v114
    v_lshlrev_b32 v182, 16, v115
    v_and_b32 v183, 0xffff0000, v115
    v_lshlrev_b32 v184, 16, v116
    v_and_b32 v185, 0xffff0000, v116
    v_lshlrev_b32 v186, 16, v117
    v_and_b32 v187, 0xffff0000, v117
    v_lshlrev_b32 v188, 16, v118
    v_and_b32 v189, 0xffff0000, v118
    v_lshlrev_b32 v190, 16, v119
    v_and_b32 v191, 0xffff0000, v119
    s_mov_b32 s38, 16384
    s_waitcnt vmcnt(2)
    v_xor_b32 v89, s95, v89
    v_xor_b32 v91, s95, v91
    s_waitcnt vmcnt(1)
    v_xor_b32 v93, s95, v93
    v_xor_b32 v95, s95, v95
    v_or3_b32 v89, v89, v91, v93
    v_or_b32 v89, v89, v95
    v_cmp_ne_u32 vcc, 0, v89
    s_cbranch_vccz Lhead_gotm
Lhead_pollm:
    buffer_load_dwordx4 v[88:91], v124, s[24:27], s37 offen sc1
    buffer_load_dwordx4 v[92:95], v125, s[24:27], s37 offen sc1
    s_waitcnt vmcnt(0)
    s_sub_u32 s38, s38, 1
    s_cbranch_scc1 Lhead_gotm
    v_xor_b32 v89, s95, v89
    v_xor_b32 v91, s95, v91
    v_xor_b32 v93, s95, v93
    v_xor_b32 v95, s95, v95
    v_or3_b32 v89, v89, v91, v93
    v_or_b32 v89, v89, v95
    v_cmp_ne_u32 vcc, 0, v89
    s_cbranch_vccnz Lhead_pollm
Lhead_gotm:
    ds_write2_b32 v122, v88, v90 offset0:0 offset1:1
    ds_write2_b32 v123, v92, v94 offset0:0 offset1:1
    s_waitcnt lgkmcnt(0)
    s_barrier
    ds_read_b128 v[144:147], v68 offset:2176
    ds_read_b128 v[148:151], v68 offset:2560
    ds_read_b128 v[152:155], v68 offset:2944
    ds_read_b128 v[156:159], v68 offset:1024
    ds_read_b128 v[160:163], v68 offset:1408
    ds_read_b128 v[164:167], v68 offset:1792
    s_waitcnt lgkmcnt(5)
    v_lshlrev_b32 v192, 16, v144
    v_and_b32 v193, 0xffff0000, v144
    v_lshlrev_b32 v194, 16, v145
    v_and_b32 v195, 0xffff0000, v145
    v_lshlrev_b32 v196, 16, v146
    v_and_b32 v197, 0xffff0000, v146
    v_lshlrev_b32 v198, 16, v147
    v_and_b32 v199, 0xffff0000, v147
    s_waitcnt lgkmcnt(4)
    v_lshlrev_b32 v200, 16, v148
    v_and_b32 v201, 0xffff0000, v148
    v_lshlrev_b32 v202, 16, v149
    v_and_b32 v203, 0xffff0000, v149
    v_lshlrev_b32 v204, 16, v150
    v_and_b32 v205, 0xffff0000, v150
    v_lshlrev_b32 v206, 16, v151
    v_and_b32 v207, 0xffff0000, v151
    s_waitcnt lgkmcnt(3)
    v_lshlrev_b32 v208, 16, v152
    v_and_b32 v209, 0xffff0000, v152
    v_lshlrev_b32 v210, 16, v153
    v_and_b32 v211, 0xffff0000, v153
    v_lshlrev_b32 v212, 16, v154
    v_and_b32 v213, 0xffff0000, v154
    v_lshlrev_b32 v214, 16, v155
    v_and_b32 v215, 0xffff0000, v155
    v_pk_mul_f32 v[168:169], v[168:169], v[192:193]
    v_pk_mul_f32 v[170:171], v[170:171], v[194:195]
    v_pk_mul_f32 v[172:173], v[172:173], v[196:197]
    v_pk_mul_f32 v[174:175], v[174:175], v[198:199]
    v_pk_mul_f32 v[176:177], v[176:177], v[200:201]
    v_pk_mul_f32 v[178:179], v[178:179], v[202:203]
    v_pk_mul_f32 v[180:181], v[180:181], v[204:205]
    v_pk_mul_f32 v[182:183], v[182:183], v[206:207]
    v_pk_mul_f32 v[184:185], v[184:185], v[208:209]
    v_pk_mul_f32 v[186:187], v[186:187], v[210:211]
    v_pk_mul_f32 v[188:189], v[188:189], v[212:213]
    v_pk_mul_f32 v[190:191], v[190:191], v[214:215]
    v_cvt_pk_bf16_f32 v108, v168, v169
    v_cvt_pk_bf16_f32 v109, v170, v171
    v_cvt_pk_bf16_f32 v110, v172, v173
    v_cvt_pk_bf16_f32 v111, v174, v175
    v_cvt_pk_bf16_f32 v112, v176, v177
    v_cvt_pk_bf16_f32 v113, v178, v179
    v_cvt_pk_bf16_f32 v114, v180, v181
    v_cvt_pk_bf16_f32 v115, v182, v183
    v_cvt_pk_bf16_f32 v116, v184, v185
    v_cvt_pk_bf16_f32 v117, v186, v187
    v_cvt_pk_bf16_f32 v118, v188, v189
    v_cvt_pk_bf16_f32 v119, v190, v191
    s_waitcnt lgkmcnt(2)
    v_lshlrev_b32 v216, 16, v156
    v_and_b32 v217, 0xffff0000, v156
    v_lshlrev_b32 v218, 16, v157
    v_and_b32 v219, 0xffff0000, v157
    v_lshlrev_b32 v220, 16, v158
    v_and_b32 v221, 0xffff0000, v158
    v_lshlrev_b32 v222, 16, v159
    v_and_b32 v223, 0xffff0000, v159
    s_waitcnt lgkmcnt(1)
    v_lshlrev_b32 v224, 16, v160
    v_and_b32 v225, 0xffff0000, v160
    v_lshlrev_b32 v226, 16, v161
    v_and_b32 v227, 0xffff0000, v161
    v_lshlrev_b32 v228, 16, v162
    v_and_b32 v229, 0xffff0000, v162
    v_lshlrev_b32 v230, 16, v163
    v_and_b32 v231, 0xffff0000, v163
    s_waitcnt lgkmcnt(0)
    v_lshlrev_b32 v232, 16, v164
    v_and_b32 v233, 0xffff0000, v164
    v_lshlrev_b32 v234, 16, v165
    v_and_b32 v235, 0xffff0000, v165
    v_lshlrev_b32 v236, 16, v166
    v_and_b32 v237, 0xffff0000, v166
    v_lshlrev_b32 v238, 16, v167
    v_and_b32 v239, 0xffff0000, v167
    v_lshlrev_b32 v168, 16, v108
    v_and_b32 v169, 0xffff0000, v108
    v_lshlrev_b32 v170, 16, v109
    v_and_b32 v171, 0xffff0000, v109
    v_lshlrev_b32 v172, 16, v110
    v_and_b32 v173, 0xffff0000, v110
    v_lshlrev_b32 v174, 16, v111
    v_and_b32 v175, 0xffff0000, v111
    v_lshlrev_b32 v176, 16, v112
    v_and_b32 v177, 0xffff0000, v112
    v_lshlrev_b32 v178, 16, v113
    v_and_b32 v179, 0xffff0000, v113
    v_lshlrev_b32 v180, 16, v114
    v_and_b32 v181, 0xffff0000, v114
    v_lshlrev_b32 v182, 16, v115
    v_and_b32 v183, 0xffff0000, v115
    v_lshlrev_b32 v184, 16, v116
    v_and_b32 v185, 0xffff0000, v116
    v_lshlrev_b32 v186, 16, v117
    v_and_b32 v187, 0xffff0000, v117
    v_lshlrev_b32 v188, 16, v118
    v_and_b32 v189, 0xffff0000, v118
    v_lshlrev_b32 v190, 16, v119
    v_and_b32 v191, 0xffff0000, v119
    v_pk_add_f32 v[168:169], v[168:169], v[216:217]
    v_pk_add_f32 v[170:171], v[170:171], v[218:219]
    v_pk_add_f32 v[172:173], v[172:173], v[220:221]
    v_pk_add_f32 v[174:175], v[174:175], v[222:223]
    v_cvt_pk_bf16_f32 v108, v168, v169
    v_cvt_pk_bf16_f32 v109, v170, v171
    v_cvt_pk_bf16_f32 v110, v172, v173
    v_cvt_pk_bf16_f32 v111, v174, v175
    buffer_store_dwordx4 v[108:111], v67, s[24:27], s92 offen offset:0 sc1
    v_pk_add_f32 v[176:177], v[176:177], v[224:225]
    v_pk_add_f32 v[178:179], v[178:179], v[226:227]
    v_pk_add_f32 v[180:181], v[180:181], v[228:229]
    v_pk_add_f32 v[182:183], v[182:183], v[230:231]
    v_cvt_pk_bf16_f32 v112, v176, v177
    v_cvt_pk_bf16_f32 v113, v178, v179
    v_cvt_pk_bf16_f32 v114, v180, v181
    v_cvt_pk_bf16_f32 v115, v182, v183
    buffer_store_dwordx4 v[112:115], v67, s[24:27], s92 offen offset:768 sc1
    v_pk_add_f32 v[184:185], v[184:185], v[232:233]
    v_pk_add_f32 v[186:187], v[186:187], v[234:235]
    v_pk_add_f32 v[188:189], v[188:189], v[236:237]
    v_pk_add_f32 v[190:191], v[190:191], v[238:239]
    v_cvt_pk_bf16_f32 v116, v184, v185
    v_cvt_pk_bf16_f32 v117, v186, v187
    v_cvt_pk_bf16_f32 v118, v188, v189
    v_cvt_pk_bf16_f32 v119, v190, v191
    buffer_store_dwordx4 v[116:119], v67, s[24:27], s92 offen offset:1536 sc1
    s_lshl_b32 s36, s5, 13
    s_add_u32 s36, s36, 8650752
    s_lshl_b32 s37, s4, 9
    s_add_u32 s37, s37, s36
    s_lshl_b32 s38, s3, 7
    s_add_u32 s37, s37, s38
    s_lshl_b32 s38, s3, 11
    s_add_u32 s36, s36, s38
    v_min_u32 v72, 1, v1
    v_lshlrev_b32 v72, 31, v72
    v_and_b32 v73, 15, v1
    v_lshlrev_b32 v73, 7, v73
    v_cmp_gt_u32 vcc, 162, v0
    v_mov_b32 v88, -1
    v_mov_b32 v89, -1
    v_mov_b32 v90, -1
    v_mov_b32 v91, -1
    s_mul_i32 s39, s2, 2592
    s_add_u32 s39, s39, 7864320
    v_lshl_add_u32 v74, v0, 4, s39
    s_lshl_b32 s39, s2, 7
    s_add_u32 s39, s39, 9306112
    v_mov_b32 v75, s39
    v_cndmask_b32 v74, v75, v74, vcc
    s_lshl_b32 s92, s5, 13
    s_add_u32 s92, s92, 8781824
    s_add_u32 s92, s92, s38
    s_lshl_b32 s38, s4, 7
    s_add_u32 s92, s92, s38
    s_getreg_b32 s38, hwreg(HW_REG_XCC_ID, 0, 4)
    s_add_u32 s38, s38, s95
    v_mov_b32 v76, s38
    v_mov_b32 v2, v80
    v_mov_b32 v3, v81
    v_mov_b32 v4, v82
    v_mov_b32 v5, v83
    v_mov_b32 v6, v84
    v_mov_b32 v7, v65
    v_and_b32 v126, 31, v1
    v_lshlrev_b32 v126, 2, v126
    s_waitcnt vmcnt(0)
    buffer_store_dword v137, v126, s[24:27], s37 offen sc1
    s_add_u32 s49, s44, 0
    s_add_u32 m0, s42, 32768
    s_nop 0
    buffer_load_dwordx4 v42, s[16:19], s49 offen lds
    buffer_load_dwordx4 v43, s[16:19], s49 offen offset:1024 lds
    buffer_load_dwordx4 v44, s[16:19], s49 offen offset:2048 lds
    buffer_load_dwordx4 v45, s[16:19], s49 offen offset:3072 lds
    s_add_u32 s49, s44, 256
    s_add_u32 m0, s42, 49152
    s_nop 0
    buffer_load_dwordx4 v42, s[16:19], s49 offen lds
    buffer_load_dwordx4 v43, s[16:19], s49 offen offset:1024 lds
    buffer_load_dwordx4 v44, s[16:19], s49 offen offset:2048 lds
    buffer_load_dwordx4 v45, s[16:19], s49 offen offset:3072 lds
    s_add_u32 s49, s44, 524288
    s_add_u32 m0, s42, 65536
    s_nop 0
    buffer_load_dwordx4 v42, s[16:19], s49 offen lds
    buffer_load_dwordx4 v43, s[16:19], s49 offen offset:1024 lds
    buffer_load_dwordx4 v44, s[16:19], s49 offen offset:2048 lds
    buffer_load_dwordx4 v45, s[16:19], s49 offen offset:3072 lds
    s_add_u32 s49, s44, 524544
    s_add_u32 m0, s42, 81920
    s_nop 0
    buffer_load_dwordx4 v42, s[16:19], s49 offen lds
    buffer_load_dwordx4 v43, s[16:19], s49 offen offset:1024 lds
    buffer_load_dwordx4 v44, s[16:19], s49 offen offset:2048 lds
    buffer_load_dwordx4 v45, s[16:19], s49 offen offset:3072 lds
    s_add_u32 s49, s44, 1048576
    s_add_u32 m0, s42, 98304
    s_nop 0
    buffer_load_dwordx4 v42, s[16:19], s49 offen lds
    buffer_load_dwordx4 v43, s[16:19], s49 offen offset:1024 lds
    buffer_load_dwordx4 v44, s[16:19], s49 offen offset:2048 lds
    buffer_load_dwordx4 v45, s[16:19], s49 offen offset:3072 lds
    s_add_u32 s49, s44, 1048832
    s_add_u32 m0, s42, 114688
    s_nop 0
    buffer_load_dwordx4 v42, s[16:19], s49 offen lds
    buffer_load_dwordx4 v43, s[16:19], s49 offen offset:1024 lds
    buffer_load_dwordx4 v44, s[16:19], s49 offen offset:2048 lds
    buffer_load_dwordx4 v45, s[16:19], s49 offen offset:3072 lds
    s_mov_b32 s38, 16384
Lhead_pollh:
    buffer_load_dword v75, v73, s[24:27], s36 offen sc1
    s_sub_u32 s38, s38, 1
    s_cbranch_scc1 Lhead_goth
    s_waitcnt vmcnt(0) lgkmcnt(0)
    v_cmp_ne_u32 vcc, s95, v75
    s_cbranch_vccnz Lhead_pollh
Lhead_goth:
    s_waitcnt vmcnt(0) lgkmcnt(0)
    buffer_load_dwordx4 a[0:3], v51, s[24:27], s46 offen offset:0 sc1
    buffer_load_dwordx4 a[8:11], v51, s[24:27], s46 offen offset:128 sc1
    buffer_load_dwordx4 a[4:7], v51, s[24:27], s43 offen offset:0 sc1
    buffer_load_dwordx4 a[12:15], v51, s[24:27], s43 offen offset:128 sc1
    s_barrier
    ds_read_b64_tr_b16 a[160:161], v12 offset:32768
    ds_read_b64_tr_b16 a[162:163], v12 offset:36864
    ds_read_b64_tr_b16 a[164:165], v12 offset:40960
    ds_read_b64_tr_b16 a[166:167], v12 offset:45056
    ds_read_b64_tr_b16 a[168:169], v13 offset:32768
    ds_read_b64_tr_b16 a[170:171], v13 offset:36864
    ds_read_b64_tr_b16 a[172:173], v13 offset:40960
    ds_read_b64_tr_b16 a[174:175], v13 offset:45056
    ds_read_b64_tr_b16 a[176:177], v14 offset:32768
    ds_read_b64_tr_b16 a[178:179], v14 offset:36864
    ds_read_b64_tr_b16 a[180:181], v14 offset:40960
    ds_read_b64_tr_b16 a[182:183], v14 offset:45056
    buffer_load_dwordx4 a[16:19], v51, s[24:27], s46 offen offset:256 sc1
    buffer_load_dwordx4 a[24:27], v51, s[24:27], s46 offen offset:384 sc1
    buffer_load_dwordx4 a[20:23], v51, s[24:27], s43 offen offset:256 sc1
    buffer_load_dwordx4 a[28:31], v51, s[24:27], s43 offen offset:384 sc1
    s_waitcnt lgkmcnt(10)
    s_waitcnt vmcnt(7)
    v_mfma_f32_16x16x32_bf16 v[128:131], a[160:163], a[0:3], 0
    s_waitcnt vmcnt(6)
    s_waitcnt lgkmcnt(8)
    ds_read_b64_tr_b16 a[184:185], v15 offset:32768
    v_mfma_f32_16x16x32_bf16 v[128:131], a[164:167], a[8:11], v[128:131]
    s_waitcnt vmcnt(5)
    ds_read_b64_tr_b16 a[186:187], v15 offset:36864
    v_mfma_f32_16x16x32_bf16 v[132:135], a[160:163], a[4:7], 0
    s_waitcnt vmcnt(4)
    ds_read_b64_tr_b16 a[188:189], v15 offset:40960
    v_mfma_f32_16x16x32_bf16 v[132:135], a[164:167], a[12:15], v[132:135]
    s_waitcnt lgkmcnt(9)
    buffer_load_dwordx4 a[32:35], v51, s[24:27], s46 offen offset:512 sc1
    v_mfma_f32_16x16x32_bf16 v[136:139], a[168:171], a[0:3], 0
    s_waitcnt lgkmcnt(7)
    ds_read_b64_tr_b16 a[190:191], v15 offset:45056
    ds_read_b64_tr_b16 a[160:161], v16 offset:32768
    v_mfma_f32_16x16x32_bf16 v[136:139], a[172:175], a[8:11], v[136:139]
    ds_read_b64_tr_b16 a[162:163], v16 offset:36864
    v_mfma_f32_16x16x32_bf16 v[140:143], a[168:171], a[4:7], 0
    ds_read_b64_tr_b16 a[164:165], v16 offset:40960
    v_mfma_f32_16x16x32_bf16 v[140:143], a[172:175], a[12:15], v[140:143]
    s_waitcnt lgkmcnt(9)
    buffer_load_dwordx4 a[40:43], v51, s[24:27], s46 offen offset:640 sc1
    v_mfma_f32_16x16x32_bf16 v[144:147], a[176:179], a[0:3], 0
    s_waitcnt lgkmcnt(7)
    ds_read_b64_tr_b16 a[166:167], v16 offset:45056
    ds_read_b64_tr_b16 a[168:169], v17 offset:32768
    v_mfma_f32_16x16x32_bf16 v[144:147], a[180:183], a[8:11], v[144:147]
    ds_read_b64_tr_b16 a[170:171], v17 offset:36864
    v_mfma_f32_16x16x32_bf16 v[148:151], a[176:179], a[4:7], 0
    ds_read_b64_tr_b16 a[172:173], v17 offset:40960
    v_mfma_f32_16x16x32_bf16 v[148:151], a[180:183], a[12:15], v[148:151]
    s_waitcnt lgkmcnt(9)
    buffer_load_dwordx4 a[36:39], v51, s[24:27], s43 offen offset:512 sc1
    v_mfma_f32_16x16x32_bf16 v[152:155], a[184:187], a[0:3], 0
    s_waitcnt lgkmcnt(7)
    ds_read_b64_tr_b16 a[174:175], v17 offset:45056
    ds_read_b64_tr_b16 a[176:177], v18 offset:32768
    v_mfma_f32_16x16x32_bf16 v[152:155], a[188:191], a[8:11], v[152:155]
    ds_read_b64_tr_b16 a[178:179], v18 offset:36864
    v_mfma_f32_16x16x32_bf16 v[156:159], a[184:187], a[4:7], 0
    ds_read_b64_tr_b16 a[180:181], v18 offset:40960
    v_mfma_f32_16x16x32_bf16 v[156:159], a[188:191], a[12:15], v[156:159]
    s_waitcnt lgkmcnt(9)
    buffer_load_dwordx4 a[44:47], v51, s[24:27], s43 offen offset:640 sc1
    v_mfma_f32_16x16x32_bf16 v[160:163], a[160:163], a[0:3], 0
    s_waitcnt lgkmcnt(7)
    ds_read_b64_tr_b16 a[182:183], v18 offset:45056
    ds_read_b64_tr_b16 a[184:185], v19 offset:32768
    v_mfma_f32_16x16x32_bf16 v[160:163], a[164:167], a[8:11], v[160:163]
    ds_read_b64_tr_b16 a[186:187], v19 offset:36864
    v_mfma_f32_16x16x32_bf16 v[164:167], a[160:163], a[4:7], 0
    ds_read_b64_tr_b16 a[188:189], v19 offset:40960
    v_mfma_f32_16x16x32_bf16 v[164:167], a[164:167], a[12:15], v[164:167]
    s_waitcnt lgkmcnt(9)
    buffer_load_dword v77, v70, s[16:19], s44 offen
    v_mfma_f32_16x16x32_bf16 v[168:171], a[168:171], a[0:3], 0
    s_waitcnt lgkmcnt(7)
    ds_read_b64_tr_b16 a[190:191], v19 offset:45056
    ds_read_b64_tr_b16 a[160:161], v12 offset:49152
    v_mfma_f32_16x16x32_bf16 v[168:171], a[172:175], a[8:11], v[168:171]
    ds_read_b64_tr_b16 a[162:163], v12 offset:53248
    v_mfma_f32_16x16x32_bf16 v[172:175], a[168:171], a[4:7], 0
    ds_read_b64_tr_b16 a[164:165], v12 offset:57344
    v_mfma_f32_16x16x32_bf16 v[172:175], a[172:175], a[12:15], v[172:175]
    s_waitcnt lgkmcnt(9)
    ds_read_b64_tr_b16 a[166:167], v12 offset:61440
    v_mfma_f32_16x16x32_bf16 v[176:179], a[176:179], a[0:3], 0
    s_waitcnt lgkmcnt(8)
    ds_read_b64_tr_b16 a[168:169], v13 offset:49152
    v_mfma_f32_16x16x32_bf16 v[176:179], a[180:183], a[8:11], v[176:179]
    ds_read_b64_tr_b16 a[170:171], v13 offset:53248
    v_mfma_f32_16x16x32_bf16 v[180:183], a[176:179], a[4:7], 0
    ds_read_b64_tr_b16 a[172:173], v13 offset:57344
    v_mfma_f32_16x16x32_bf16 v[180:183], a[180:183], a[12:15], v[180:183]
    s_waitcnt lgkmcnt(9)
    ds_read_b64_tr_b16 a[174:175], v13 offset:61440
    v_mfma_f32_16x16x32_bf16 v[184:187], a[184:187], a[0:3], 0
    s_waitcnt lgkmcnt(8)
    ds_read_b64_tr_b16 a[176:177], v14 offset:49152
    v_mfma_f32_16x16x32_bf16 v[184:187], a[188:191], a[8:11], v[184:187]
    ds_read_b64_tr_b16 a[178:179], v14 offset:53248
    v_mfma_f32_16x16x32_bf16 v[188:191], a[184:187], a[4:7], 0
    ds_read_b64_tr_b16 a[180:181], v14 offset:57344
    v_mfma_f32_16x16x32_bf16 v[188:191], a[188:191], a[12:15], v[188:191]
    s_waitcnt lgkmcnt(9)
    ds_read_b64_tr_b16 a[182:183], v14 offset:61440
    v_mfma_f32_16x16x32_bf16 v[192:195], a[160:163], a[0:3], 0
    s_waitcnt lgkmcnt(8)
    ds_read_b64_tr_b16 a[184:185], v15 offset:49152
    v_mfma_f32_16x16x32_bf16 v[192:195], a[164:167], a[8:11], v[192:195]
    ds_read_b64_tr_b16 a[186:187], v15 offset:53248
    v_mfma_f32_16x16x32_bf16 v[196:199], a[160:163], a[4:7], 0
    ds_read_b64_tr_b16 a[188:189], v15 offset:57344
    v_mfma_f32_16x16x32_bf16 v[196:199], a[164:167], a[12:15], v[196:199]
    s_waitcnt lgkmcnt(9)
    ds_read_b64_tr_b16 a[190:191], v15 offset:61440
    v_mfma_f32_16x16x32_bf16 v[200:203], a[168:171], a[0:3], 0
    s_waitcnt lgkmcnt(8)
    ds_read_b64_tr_b16 a[160:161], v16 offset:49152
    v_mfma_f32_16x16x32_bf16 v[200:203], a[172:175], a[8:11], v[200:203]
    ds_read_b64_tr_b16 a[162:163], v16 offset:53248
    v_mfma_f32_16x16x32_bf16 v[204:207], a[168:171], a[4:7], 0
    ds_read_b64_tr_b16 a[164:165], v16 offset:57344
    v_mfma_f32_16x16x32_bf16 v[204:207], a[172:175], a[12:15], v[204:207]
    s_waitcnt lgkmcnt(9)
    ds_read_b64_tr_b16 a[166:167], v16 offset:61440
    v_mfma_f32_16x16x32_bf16 v[208:211], a[176:179], a[0:3], 0
    s_waitcnt lgkmcnt(8)
    ds_read_b64_tr_b16 a[168:169], v17 offset:49152
    v_mfma_f32_16x16x32_bf16 v[208:211], a[180:183], a[8:11], v[208:211]
    ds_read_b64_tr_b16 a[170:171], v17 offset:53248
    v_mfma_f32_16x16x32_bf16 v[212:215], a[176:179], a[4:7], 0
    ds_read_b64_tr_b16 a[172:173], v17 offset:57344
    v_mfma_f32_16x16x32_bf16 v[212:215], a[180:183], a[12:15], v[212:215]
    s_waitcnt lgkmcnt(9)
    ds_read_b64_tr_b16 a[174:175], v17 offset:61440
    v_mfma_f32_16x16x32_bf16 v[216:219], a[184:187], a[0:3], 0
    s_waitcnt lgkmcnt(8)
    ds_read_b64_tr_b16 a[176:177], v18 offset:49152
    v_mfma_f32_16x16x32_bf16 v[216:219], a[188:191], a[8:11], v[216:219]
    ds_read_b64_tr_b16 a[178:179], v18 offset:53248
    v_mfma_f32_16x16x32_bf16 v[220:223], a[184:187], a[4:7], 0
    ds_read_b64_tr_b16 a[180:181], v18 offset:57344
    v_mfma_f32_16x16x32_bf16 v[220:223], a[188:191], a[12:15], v[220:223]
    s_waitcnt lgkmcnt(9)
    ds_read_b64_tr_b16 a[182:183], v18 offset:61440
    v_mfma_f32_16x16x32_bf16 v[224:227], a[160:163], a[0:3], 0
    s_waitcnt lgkmcnt(8)
    ds_read_b64_tr_b16 a[184:185], v19 offset:49152
    v_mfma_f32_16x16x32_bf16 v[224:227], a[164:167], a[8:11], v[224:227]
Ltour0:
    s_cbranch_execz Ltour4
    ds_read_b64_tr_b16 a[186:187], v19 offset:53248
    v_mfma_f32_16x16x32_bf16 v[228:231], a[160:163], a[4:7], 0
    ds_read_b64_tr_b16 a[188:189], v19 offset:57344
    v_mfma_f32_16x16x32_bf16 v[228:231], a[164:167], a[12:15], v[228:231]
    s_waitcnt lgkmcnt(9)
    ds_read_b64_tr_b16 a[190:191], v19 offset:61440
    s_barrier
    v_mfma_f32_16x16x32_bf16 v[232:235], a[168:171], a[0:3], 0
    s_waitcnt lgkmcnt(8)
    ds_read_b64_tr_b16 a[160:161], v20 offset:0
    v_mfma_f32_16x16x32_bf16 v[232:235], a[172:175], a[8:11], v[232:235]
    s_add_u32 s49, s44, 1572864
    ds_read_b64_tr_b16 a[162:163], v20 offset:4096
    v_mfma_f32_16x16x32_bf16 v[236:239], a[168:171], a[4:7], 0
    s_add_u32 m0, s42, 131072
    ds_read_b64_tr_b16 a[164:165], v20 offset:8192
    v_mfma_f32_16x16x32_bf16 v[236:239], a[172:175], a[12:15], v[236:239]
    s_waitcnt lgkmcnt(9)
    buffer_load_dwordx4 v42, s[16:19], s49 offen lds
    v_mfma_f32_16x16x32_bf16 v[240:243], a[176:179], a[0:3], 0
    s_waitcnt lgkmcnt(7)
    ds_read_b64_tr_b16 a[166:167], v20 offset:12288
    ds_read_b64_tr_b16 a[168:169], v21 offset:0
    v_mfma_f32_16x16x32_bf16 v[240:243], a[180:183], a[8:11], v[240:243]
    ds_read_b64_tr_b16 a[170:171], v21 offset:4096
    v_mfma_f32_16x16x32_bf16 v[244:247], a[176:179], a[4:7], 0
    ds_read_b64_tr_b16 a[172:173], v21 offset:8192
    v_mfma_f32_16x16x32_bf16 v[244:247], a[180:183], a[12:15], v[244:247]
    s_waitcnt lgkmcnt(9)
    buffer_load_dwordx4 v43, s[16:19], s49 offen offset:1024 lds
    v_mfma_f32_16x16x32_bf16 v[248:251], a[184:187], a[0:3], 0
    s_waitcnt lgkmcnt(7)
    ds_read_b64_tr_b16 a[174:175], v21 offset:12288
    ds_read_b64_tr_b16 a[176:177], v22 offset:0
    v_mfma_f32_16x16x32_bf16 v[248:251], a[188:191], a[8:11], v[248:251]
    ds_read_b64_tr_b16 a[178:179], v22 offset:4096
    v_mfma_f32_16x16x32_bf16 v[252:255], a[184:187], a[4:7], 0
    ds_read_b64_tr_b16 a[180:181], v22 offset:8192
    v_mfma_f32_16x16x32_bf16 v[252:255], a[188:191], a[12:15], v[252:255]
    s_waitcnt vmcnt(10)
    s_waitcnt lgkmcnt(9)
    buffer_load_dwordx4 v44, s[16:19], s49 offen offset:2048 lds
    v_mfma_f32_16x16x32_bf16 v[128:131], a[160:163], a[16:19], v[128:131]
    s_waitcnt vmcnt(10)
    s_waitcnt lgkmcnt(7)
    ds_read_b64_tr_b16 a[182:183], v22 offset:12288
    ds_read_b64_tr_b16 a[184:185], v23 offset:0
    v_mfma_f32_16x16x32_bf16 v[128:131], a[164:167], a[24:27], v[128:131]
    s_waitcnt vmcnt(9)
    ds_read_b64_tr_b16 a[186:187], v23 offset:4096
    v_mfma_f32_16x16x32_bf16 v[132:135], a[160:163], a[20:23], v[132:135]
    s_waitcnt vmcnt(8)
    ds_read_b64_tr_b16 a[188:189], v23 offset:8192
    v_mfma_f32_16x16x32_bf16 v[132:135], a[164:167], a[28:31], v[132:135]
    s_waitcnt lgkmcnt(9)
    buffer_load_dwordx4 v45, s[16:19], s49 offen offset:3072 lds
    v_mfma_f32_16x16x32_bf16 v[136:139], a[168:171], a[16:19], v[136:139]
    s_waitcnt lgkmcnt(7)
    ds_read_b64_tr_b16 a[190:191], v23 offset:12288
    ds_read_b64_tr_b16 a[160:161], v24 offset:0
    v_mfma_f32_16x16x32_bf16 v[136:139], a[172:175], a[24:27], v[136:139]
    s_add_u32 s49, s44, 1573120
    ds_read_b64_tr_b16 a[162:163], v24 offset:4096
    v_mfma_f32_16x16x32_bf16 v[140:143], a[168:171], a[20:23], v[140:143]
    s_add_u32 m0, s42, 147456
    ds_read_b64_tr_b16 a[164:165], v24 offset:8192
    v_mfma_f32_16x16x32_bf16 v[140:143], a[172:175], a[28:31], v[140:143]
    s_waitcnt lgkmcnt(9)
    buffer_load_dwordx4 v42, s[16:19], s49 offen lds
    v_mfma_f32_16x16x32_bf16 v[144:147], a[176:179], a[16:19], v[144:147]
    s_waitcnt lgkmcnt(7)
    ds_read_b64_tr_b16 a[166:167], v24 offset:12288
    ds_read_b64_tr_b16 a[168:169], v25 offset:0
    v_mfma_f32_16x16x32_bf16 v[144:147], a[180:183], a[24:27], v[144:147]
    ds_read_b64_tr_b16 a[170:171], v25 offset:4096
    v_mfma_f32_16x16x32_bf16 v[148:151], a[176:179], a[20:23], v[148:151]
    ds_read_b64_tr_b16 a[172:173], v25 offset:8192
    v_mfma_f32_16x16x32_bf16 v[148:151], a[180:183], a[28:31], v[148:151]
    s_waitcnt lgkmcnt(9)
    buffer_load_dwordx4 v43, s[16:19], s49 offen offset:1024 lds
    v_mfma_f32_16x16x32_bf16 v[152:155], a[184:187], a[16:19], v[152:155]
    s_waitcnt lgkmcnt(7)
    ds_read_b64_tr_b16 a[174:175], v25 offset:12288
    ds_read_b64_tr_b16 a[176:177], v26 offset:0
    v_mfma_f32_16x16x32_bf16 v[152:155], a[188:191], a[24:27], v[152:155]
    ds_read_b64_tr_b16 a[178:179], v26 offset:4096
    v_mfma_f32_16x16x32_bf16 v[156:159], a[184:187], a[20:23], v[156:159]
    ds_read_b64_tr_b16 a[180:181], v26 offset:8192
    v_mfma_f32_16x16x32_bf16 v[156:159], a[188:191], a[28:31], v[156:159]
    s_waitcnt lgkmcnt(9)
    buffer_load_dwordx4 v44, s[16:19], s49 offen offset:2048 lds
    v_mfma_f32_16x16x32_bf16 v[160:163], a[160:163], a[16:19], v[160:163]
    s_waitcnt lgkmcnt(7)
    ds_read_b64_tr_b16 a[182:183], v26 offset:12288
    ds_read_b64_tr_b16 a[184:185], v27 offset:0
    v_mfma_f32_16x16x32_bf16 v[160:163], a[164:167], a[24:27], v[160:163]
    ds_read_b64_tr_b16 a[186:187], v27 offset:4096
    v_mfma_f32_16x16x32_bf16 v[164:167], a[160:163], a[20:23], v[164:167]
    ds_read_b64_tr_b16 a[188:189], v27 offset:8192
    v_mfma_f32_16x16x32_bf16 v[164:167], a[164:167], a[28:31], v[164:167]
    s_waitcnt lgkmcnt(9)
    buffer_load_dwordx4 v45, s[16:19], s49 offen offset:3072 lds
    v_mfma_f32_16x16x32_bf16 v[168:171], a[168:171], a[16:19], v[168:171]
    s_waitcnt lgkmcnt(7)
    ds_read_b64_tr_b16 a[190:191], v27 offset:12288
    ds_read_b64_tr_b16 a[160:161], v20 offset:16384
    v_mfma_f32_16x16x32_bf16 v[168:171], a[172:175], a[24:27], v[168:171]
    ds_read_b64_tr_b16 a[162:163], v20 offset:20480
    v_mfma_f32_16x16x32_bf16 v[172:175], a[168:171], a[20:23], v[172:175]
    ds_read_b64_tr_b16 a[164:165], v20 offset:24576
    v_mfma_f32_16x16x32_bf16 v[172:175], a[172:175], a[28:31], v[172:175]
    s_waitcnt lgkmcnt(9)
    buffer_load_dwordx4 a[48:51], v51, s[24:27], s46 offen offset:768 sc1
    v_mfma_f32_16x16x32_bf16 v[176:179], a[176:179], a[16:19], v[176:179]
    s_waitcnt lgkmcnt(7)
    ds_read_b64_tr_b16 a[166:167], v20 offset:28672
    ds_read_b64_tr_b16 a[168:169], v21 offset:16384
    v_mfma_f32_16x16x32_bf16 v[176:179], a[180:183], a[24:27], v[176:179]
    ds_read_b64_tr_b16 a[170:171], v21 offset:20480
    v_mfma_f32_16x16x32_bf16 v[180:183], a[176:179], a[20:23], v[180:183]
    ds_read_b64_tr_b16 a[172:173], v21 offset:24576
    v_mfma_f32_16x16x32_bf16 v[180:183], a[180:183], a[28:31], v[180:183]
    s_waitcnt lgkmcnt(9)
    buffer_load_dwordx4 a[56:59], v51, s[24:27], s46 offen offset:896 sc1
    v_mfma_f32_16x16x32_bf16 v[184:187], a[184:187], a[16:19], v[184:187]
    s_waitcnt lgkmcnt(7)
    ds_read_b64_tr_b16 a[174:175], v21 offset:28672
    ds_read_b64_tr_b16 a[176:177], v22 offset:16384
    v_mfma_f32_16x16x32_bf16 v[184:187], a[188:191], a[24:27], v[184:187]
    ds_read_b64_tr_b16 a[178:179], v22 offset:20480
    v_mfma_f32_16x16x32_bf16 v[188:191], a[184:187], a[20:23], v[188:191]
    ds_read_b64_tr_b16 a[180:181], v22 offset:24576
    v_mfma_f32_16x16x32_bf16 v[188:191], a[188:191], a[28:31], v[188:191]
    s_waitcnt lgkmcnt(9)
    buffer_load_dwordx4 a[52:55], v51, s[24:27], s43 offen offset:768 sc1
    v_mfma_f32_16x16x32_bf16 v[192:195], a[160:163], a[16:19], v[192:195]
    s_waitcnt lgkmcnt(7)
    ds_read_b64_tr_b16 a[182:183], v22 offset:28672
    ds_read_b64_tr_b16 a[184:185], v23 offset:16384
    v_mfma_f32_16x16x32_bf16 v[192:195], a[164:167], a[24:27], v[192:195]
    ds_read_b64_tr_b16 a[186:187], v23 offset:20480
    v_mfma_f32_16x16x32_bf16 v[196:199], a[160:163], a[20:23], v[196:199]
    ds_read_b64_tr_b16 a[188:189], v23 offset:24576
    v_mfma_f32_16x16x32_bf16 v[196:199], a[164:167], a[28:31], v[196:199]
    s_waitcnt lgkmcnt(9)
    buffer_load_dwordx4 a[60:63], v51, s[24:27], s43 offen offset:896 sc1
    v_mfma_f32_16x16x32_bf16 v[200:203], a[168:171], a[16:19], v[200:203]
    s_waitcnt lgkmcnt(7)
    ds_read_b64_tr_b16 a[190:191], v23 offset:28672
    ds_read_b64_tr_b16 a[160:161], v24 offset:16384
    v_mfma_f32_16x16x32_bf16 v[200:203], a[172:175], a[24:27], v[200:203]
    ds_read_b64_tr_b16 a[162:163], v24 offset:20480
    v_mfma_f32_16x16x32_bf16 v[204:207], a[168:171], a[20:23], v[204:207]
    ds_read_b64_tr_b16 a[164:165], v24 offset:24576
    v_mfma_f32_16x16x32_bf16 v[204:207], a[172:175], a[28:31], v[204:207]
    s_waitcnt lgkmcnt(9)
    ds_read_b64_tr_b16 a[166:167], v24 offset:28672
    v_mfma_f32_16x16x32_bf16 v[208:211], a[176:179], a[16:19], v[208:211]
    s_waitcnt lgkmcnt(8)
    ds_read_b64_tr_b16 a[168:169], v25 offset:16384
    v_mfma_f32_16x16x32_bf16 v[208:211], a[180:183], a[24:27], v[208:211]
    ds_read_b64_tr_b16 a[170:171], v25 offset:20480
    v_mfma_f32_16x16x32_bf16 v[212:215], a[176:179], a[20:23], v[212:215]
    ds_read_b64_tr_b16 a[172:173], v25 offset:24576
    v_mfma_f32_16x16x32_bf16 v[212:215], a[180:183], a[28:31], v[212:215]
    s_waitcnt lgkmcnt(9)
    ds_read_b64_tr_b16 a[174:175], v25 offset:28672
    v_mfma_f32_16x16x32_bf16 v[216:219], a[184:187], a[16:19], v[216:219]
    s_waitcnt lgkmcnt(8)
    ds_read_b64_tr_b16 a[176:177], v26 offset:16384
    v_mfma_f32_16x16x32_bf16 v[216:219], a[188:191], a[24:27], v[216:219]
    ds_read_b64_tr_b16 a[178:179], v26 offset:20480
    v_mfma_f32_16x16x32_bf16 v[220:223], a[184:187], a[20:23], v[220:223]
    ds_read_b64_tr_b16 a[180:181], v26 offset:24576
    v_mfma_f32_16x16x32_bf16 v[220:223], a[188:191], a[28:31], v[220:223]
    s_waitcnt lgkmcnt(9)
    ds_read_b64_tr_b16 a[182:183], v26 offset:28672
    v_mfma_f32_16x16x32_bf16 v[224:227], a[160:163], a[16:19], v[224:227]
    s_waitcnt lgkmcnt(8)
    ds_read_b64_tr_b16 a[184:185], v27 offset:16384
    v_mfma_f32_16x16x32_bf16 v[224:227], a[164:167], a[24:27], v[224:227]
    ds_read_b64_tr_b16 a[186:187], v27 offset:20480
    v_mfma_f32_16x16x32_bf16 v[228:231], a[160:163], a[20:23], v[228:231]
    ds_read_b64_tr_b16 a[188:189], v27 offset:24576
    v_mfma_f32_16x16x32_bf16 v[228:231], a[164:167], a[28:31], v[228:231]
    s_waitcnt lgkmcnt(9)
    ds_read_b64_tr_b16 a[190:191], v27 offset:28672
    s_barrier
    v_mfma_f32_16x16x32_bf16 v[232:235], a[168:171], a[16:19], v[232:235]
    s_waitcnt lgkmcnt(8)
    ds_read_b64_tr_b16 a[160:161], v20 offset:32768
    v_mfma_f32_16x16x32_bf16 v[232:235], a[172:175], a[24:27], v[232:235]
    s_add_u32 s49, s44, 2097152
    ds_read_b64_tr_b16 a[162:163], v20 offset:36864
    v_mfma_f32_16x16x32_bf16 v[236:239], a[168:171], a[20:23], v[236:239]
    s_add_u32 m0, s42, 0
    ds_read_b64_tr_b16 a[164:165], v20 offset:40960
    v_mfma_f32_16x16x32_bf16 v[236:239], a[172:175], a[28:31], v[236:239]
    s_waitcnt lgkmcnt(9)
    buffer_load_dwordx4 v42, s[16:19], s49 offen lds
    v_mfma_f32_16x16x32_bf16 v[240:243], a[176:179], a[16:19], v[240:243]
    s_waitcnt lgkmcnt(7)
    ds_read_b64_tr_b16 a[166:167], v20 offset:45056
    ds_read_b64_tr_b16 a[168:169], v21 offset:32768
    v_mfma_f32_16x16x32_bf16 v[240:243], a[180:183], a[24:27], v[240:243]
    ds_read_b64_tr_b16 a[170:171], v21 offset:36864
    v_mfma_f32_16x16x32_bf16 v[244:247], a[176:179], a[20:23], v[244:247]
    ds_read_b64_tr_b16 a[172:173], v21 offset:40960
    v_mfma_f32_16x16x32_bf16 v[244:247], a[180:183], a[28:31], v[244:247]
    s_waitcnt lgkmcnt(9)
    buffer_load_dwordx4 v43, s[16:19], s49 offen offset:1024 lds
    v_mfma_f32_16x16x32_bf16 v[248:251], a[184:187], a[16:19], v[248:251]
    s_waitcnt lgkmcnt(7)
    ds_read_b64_tr_b16 a[174:175], v21 offset:45056
    ds_read_b64_tr_b16 a[176:177], v22 offset:32768
    v_mfma_f32_16x16x32_bf16 v[248:251], a[188:191], a[24:27], v[248:251]
    ds_read_b64_tr_b16 a[178:179], v22 offset:36864
    v_mfma_f32_16x16x32_bf16 v[252:255], a[184:187], a[20:23], v[252:255]
    ds_read_b64_tr_b16 a[180:181], v22 offset:40960
    v_mfma_f32_16x16x32_bf16 v[252:255], a[188:191], a[28:31], v[252:255]
    s_waitcnt vmcnt(18)
    s_waitcnt lgkmcnt(9)
    buffer_load_dwordx4 v44, s[16:19], s49 offen offset:2048 lds
    v_mfma_f32_16x16x32_bf16 v[128:131], a[160:163], a[32:35], v[128:131]
    s_waitcnt vmcnt(18)
    s_waitcnt lgkmcnt(7)
    ds_read_b64_tr_b16 a[182:183], v22 offset:45056
    ds_read_b64_tr_b16 a[184:185], v23 offset:32768
    v_mfma_f32_16x16x32_bf16 v[128:131], a[164:167], a[40:43], v[128:131]
    s_waitcnt vmcnt(17)
    ds_read_b64_tr_b16 a[186:187], v23 offset:36864
    v_mfma_f32_16x16x32_bf16 v[132:135], a[160:163], a[36:39], v[132:135]
    s_waitcnt vmcnt(16)
    ds_read_b64_tr_b16 a[188:189], v23 offset:40960
    v_mfma_f32_16x16x32_bf16 v[132:135], a[164:167], a[44:47], v[132:135]
    s_waitcnt lgkmcnt(9)
    buffer_load_dwordx4 v45, s[16:19], s49 offen offset:3072 lds
    v_mfma_f32_16x16x32_bf16 v[136:139], a[168:171], a[32:35], v[136:139]
    s_waitcnt lgkmcnt(7)
    ds_read_b64_tr_b16 a[190:191], v23 offset:45056
    ds_read_b64_tr_b16 a[160:161], v24 offset:32768
    v_mfma_f32_16x16x32_bf16 v[136:139], a[172:175], a[40:43], v[136:139]
    s_add_u32 s49, s44, 2097408
    ds_read_b64_tr_b16 a[162:163], v24 offset:36864
    v_mfma_f32_16x16x32_bf16 v[140:143], a[168:171], a[36:39], v[140:143]
    s_add_u32 m0, s42, 16384
    ds_read_b64_tr_b16 a[164:165], v24 offset:40960
    v_mfma_f32_16x16x32_bf16 v[140:143], a[172:175], a[44:47], v[140:143]
    s_waitcnt lgkmcnt(9)
    buffer_load_dwordx4 v42, s[16:19], s49 offen lds
    v_mfma_f32_16x16x32_bf16 v[144:147], a[176:179], a[32:35], v[144:147]
    s_waitcnt lgkmcnt(7)
    ds_read_b64_tr_b16 a[166:167], v24 offset:45056
    ds_read_b64_tr_b16 a[168:169], v25 offset:32768
    v_mfma_f32_16x16x32_bf16 v[144:147], a[180:183], a[40:43], v[144:147]
    ds_read_b64_tr_b16 a[170:171], v25 offset:36864
    v_mfma_f32_16x16x32_bf16 v[148:151], a[176:179], a[36:39], v[148:151]
    ds_read_b64_tr_b16 a[172:173], v25 offset:40960
    v_mfma_f32_16x16x32_bf16 v[148:151], a[180:183], a[44:47], v[148:151]
    s_waitcnt lgkmcnt(9)
    buffer_load_dwordx4 v43, s[16:19], s49 offen offset:1024 lds
    v_mfma_f32_16x16x32_bf16 v[152:155], a[184:187], a[32:35], v[152:155]
    s_waitcnt lgkmcnt(7)
    ds_read_b64_tr_b16 a[174:175], v25 offset:45056
    ds_read_b64_tr_b16 a[176:177], v26 offset:32768
    v_mfma_f32_16x16x32_bf16 v[152:155], a[188:191], a[40:43], v[152:155]
    ds_read_b64_tr_b16 a[178:179], v26 offset:36864
    v_mfma_f32_16x16x32_bf16 v[156:159], a[184:187], a[36:39], v[156:159]
    ds_read_b64_tr_b16 a[180:181], v26 offset:40960
    v_mfma_f32_16x16x32_bf16 v[156:159], a[188:191], a[44:47], v[156:159]
    s_waitcnt lgkmcnt(9)
    buffer_load_dwordx4 v44, s[16:19], s49 offen offset:2048 lds
    v_mfma_f32_16x16x32_bf16 v[160:163], a[160:163], a[32:35], v[160:163]
    s_waitcnt lgkmcnt(7)
    ds_read_b64_tr_b16 a[182:183], v26 offset:45056
    ds_read_b64_tr_b16 a[184:185], v27 offset:32768
    v_mfma_f32_16x16x32_bf16 v[160:163], a[164:167], a[40:43], v[160:163]
    ds_read_b64_tr_b16 a[186:187], v27 offset:36864
    v_mfma_f32_16x16x32_bf16 v[164:167], a[160:163], a[36:39], v[164:167]
    ds_read_b64_tr_b16 a[188:189], v27 offset:40960
    v_mfma_f32_16x16x32_bf16 v[164:167], a[164:167], a[44:47], v[164:167]
    s_waitcnt lgkmcnt(9)
    buffer_load_dwordx4 v45, s[16:19], s49 offen offset:3072 lds
    v_mfma_f32_16x16x32_bf16 v[168:171], a[168:171], a[32:35], v[168:171]
    s_waitcnt lgkmcnt(7)
    ds_read_b64_tr_b16 a[190:191], v27 offset:45056
    ds_read_b64_tr_b16 a[160:161], v20 offset:49152
    v_mfma_f32_16x16x32_bf16 v[168:171], a[172:175], a[40:43], v[168:171]
    ds_read_b64_tr_b16 a[162:163], v20 offset:53248
    v_mfma_f32_16x16x32_bf16 v[172:175], a[168:171], a[36:39], v[172:175]
    ds_read_b64_tr_b16 a[164:165], v20 offset:57344
    v_mfma_f32_16x16x32_bf16 v[172:175], a[172:175], a[44:47], v[172:175]
    s_waitcnt lgkmcnt(9)
    buffer_load_dwordx4 a[64:67], v51, s[24:27], s46 offen offset:1024 sc1
    v_mfma_f32_16x16x32_bf16 v[176:179], a[176:179], a[32:35], v[176:179]
    s_waitcnt lgkmcnt(7)
    ds_read_b64_tr_b16 a[166:167], v20 offset:61440
    ds_read_b64_tr_b16 a[168:169], v21 offset:49152
    v_mfma_f32_16x16x32_bf16 v[176:179], a[180:183], a[40:43], v[176:179]
    ds_read_b64_tr_b16 a[170:171], v21 offset:53248
    v_mfma_f32_16x16x32_bf16 v[180:183], a[176:179], a[36:39], v[180:183]
    ds_read_b64_tr_b16 a[172:173], v21 offset:57344
    v_mfma_f32_16x16x32_bf16 v[180:183], a[180:183], a[44:47], v[180:183]
    s_waitcnt lgkmcnt(9)
    buffer_load_dwordx4 a[72:75], v51, s[24:27], s46 offen offset:1152 sc1
    v_mfma_f32_16x16x32_bf16 v[184:187], a[184:187], a[32:35], v[184:187]
    s_waitcnt lgkmcnt(7)
    ds_read_b64_tr_b16 a[174:175], v21 offset:61440
    ds_read_b64_tr_b16 a[176:177], v22 offset:49152
    v_mfma_f32_16x16x32_bf16 v[184:187], a[188:191], a[40:43], v[184:187]
    ds_read_b64_tr_b16 a[178:179], v22 offset:53248
    v_mfma_f32_16x16x32_bf16 v[188:191], a[184:187], a[36:39], v[188:191]
    ds_read_b64_tr_b16 a[180:181], v22 offset:57344
    v_mfma_f32_16x16x32_bf16 v[188:191], a[188:191], a[44:47], v[188:191]
    s_waitcnt lgkmcnt(9)
    buffer_load_dwordx4 a[68:71], v51, s[24:27], s43 offen offset:1024 sc1
    v_mfma_f32_16x16x32_bf16 v[192:195], a[160:163], a[32:35], v[192:195]
    s_waitcnt lgkmcnt(7)
    ds_read_b64_tr_b16 a[182:183], v22 offset:61440
    ds_read_b64_tr_b16 a[184:185], v23 offset:49152
    v_mfma_f32_16x16x32_bf16 v[192:195], a[164:167], a[40:43], v[192:195]
    ds_read_b64_tr_b16 a[186:187], v23 offset:53248
    v_mfma_f32_16x16x32_bf16 v[196:199], a[160:163], a[36:39], v[196:199]
    ds_read_b64_tr_b16 a[188:189], v23 offset:57344
    v_mfma_f32_16x16x32_bf16 v[196:199], a[164:167], a[44:47], v[196:199]
    s_waitcnt lgkmcnt(9)
    buffer_load_dwordx4 a[76:79], v51, s[24:27], s43 offen offset:1152 sc1
    v_mfma_f32_16x16x32_bf16 v[200:203], a[168:171], a[32:35], v[200:203]
    s_waitcnt lgkmcnt(7)
    ds_read_b64_tr_b16 a[190:191], v23 offset:61440
    ds_read_b64_tr_b16 a[160:161], v24 offset:49152
    v_mfma_f32_16x16x32_bf16 v[200:203], a[172:175], a[40:43], v[200:203]
    ds_read_b64_tr_b16 a[162:163], v24 offset:53248
    v_mfma_f32_16x16x32_bf16 v[204:207], a[168:171], a[36:39], v[204:207]
    ds_read_b64_tr_b16 a[164:165], v24 offset:57344
    v_mfma_f32_16x16x32_bf16 v[204:207], a[172:175], a[44:47], v[204:207]
    s_waitcnt lgkmcnt(9)
    ds_read_b64_tr_b16 a[166:167], v24 offset:61440
    v_mfma_f32_16x16x32_bf16 v[208:211], a[176:179], a[32:35], v[208:211]
    s_waitcnt lgkmcnt(8)
    ds_read_b64_tr_b16 a[168:169], v25 offset:49152
    v_mfma_f32_16x16x32_bf16 v[208:211], a[180:183], a[40:43], v[208:211]
    ds_read_b64_tr_b16 a[170:171], v25 offset:53248
    v_mfma_f32_16x16x32_bf16 v[212:215], a[176:179], a[36:39], v[212:215]
    ds_read_b64_tr_b16 a[172:173], v25 offset:57344
    v_mfma_f32_16x16x32_bf16 v[212:215], a[180:183], a[44:47], v[212:215]
    s_waitcnt lgkmcnt(9)
    ds_read_b64_tr_b16 a[174:175], v25 offset:61440
    v_mfma_f32_16x16x32_bf16 v[216:219], a[184:187], a[32:35], v[216:219]
    s_waitcnt lgkmcnt(8)
    ds_read_b64_tr_b16 a[176:177], v26 offset:49152
    v_mfma_f32_16x16x32_bf16 v[216:219], a[188:191], a[40:43], v[216:219]
    ds_read_b64_tr_b16 a[178:179], v26 offset:53248
    v_mfma_f32_16x16x32_bf16 v[220:223], a[184:187], a[36:39], v[220:223]
    ds_read_b64_tr_b16 a[180:181], v26 offset:57344
    v_mfma_f32_16x16x32_bf16 v[220:223], a[188:191], a[44:47], v[220:223]
    s_waitcnt lgkmcnt(9)
    ds_read_b64_tr_b16 a[182:183], v26 offset:61440
    v_mfma_f32_16x16x32_bf16 v[224:227], a[160:163], a[32:35], v[224:227]
    s_waitcnt lgkmcnt(8)
    ds_read_b64_tr_b16 a[184:185], v27 offset:49152
    v_mfma_f32_16x16x32_bf16 v[224:227], a[164:167], a[40:43], v[224:227]
    ds_read_b64_tr_b16 a[186:187], v27 offset:53248
    v_mfma_f32_16x16x32_bf16 v[228:231], a[160:163], a[36:39], v[228:231]
    ds_read_b64_tr_b16 a[188:189], v27 offset:57344
    v_mfma_f32_16x16x32_bf16 v[228:231], a[164:167], a[44:47], v[228:231]
    s_waitcnt lgkmcnt(9)
    ds_read_b64_tr_b16 a[190:191], v27 offset:61440
    s_waitcnt vmcnt(16)
    s_barrier
    v_mfma_f32_16x16x32_bf16 v[232:235], a[168:171], a[32:35], v[232:235]
    s_waitcnt lgkmcnt(8)
    ds_read_b64_tr_b16 a[160:161], v28 offset:0
    v_mfma_f32_16x16x32_bf16 v[232:235], a[172:175], a[40:43], v[232:235]
    s_add_u32 s49, s44, 2621440
    ds_read_b64_tr_b16 a[162:163], v28 offset:4096
    v_mfma_f32_16x16x32_bf16 v[236:239], a[168:171], a[36:39], v[236:239]
    s_add_u32 m0, s42, 32768
    ds_read_b64_tr_b16 a[164:165], v28 offset:8192
    v_mfma_f32_16x16x32_bf16 v[236:239], a[172:175], a[44:47], v[236:239]
    s_waitcnt lgkmcnt(9)
    buffer_load_dwordx4 v42, s[16:19], s49 offen lds
    v_mfma_f32_16x16x32_bf16 v[240:243], a[176:179], a[32:35], v[240:243]
    s_waitcnt lgkmcnt(7)
    ds_read_b64_tr_b16 a[166:167], v28 offset:12288
    ds_read_b64_tr_b16 a[168:169], v29 offset:0
    v_mfma_f32_16x16x32_bf16 v[240:243], a[180:183], a[40:43], v[240:243]
    ds_read_b64_tr_b16 a[170:171], v29 offset:4096
    v_mfma_f32_16x16x32_bf16 v[244:247], a[176:179], a[36:39], v[244:247]
    ds_read_b64_tr_b16 a[172:173], v29 offset:8192
    v_mfma_f32_16x16x32_bf16 v[244:247], a[180:183], a[44:47], v[244:247]
    s_waitcnt lgkmcnt(9)
    buffer_load_dwordx4 v43, s[16:19], s49 offen offset:1024 lds
    v_mfma_f32_16x16x32_bf16 v[248:251], a[184:187], a[32:35], v[248:251]
    s_waitcnt lgkmcnt(7)
    ds_read_b64_tr_b16 a[174:175], v29 offset:12288
    ds_read_b64_tr_b16 a[176:177], v30 offset:0
    v_mfma_f32_16x16x32_bf16 v[248:251], a[188:191], a[40:43], v[248:251]
    ds_read_b64_tr_b16 a[178:179], v30 offset:4096
    v_mfma_f32_16x16x32_bf16 v[252:255], a[184:187], a[36:39], v[252:255]
    ds_read_b64_tr_b16 a[180:181], v30 offset:8192
    v_mfma_f32_16x16x32_bf16 v[252:255], a[188:191], a[44:47], v[252:255]
    s_waitcnt vmcnt(17)
    s_waitcnt lgkmcnt(9)
    buffer_load_dwordx4 v44, s[16:19], s49 offen offset:2048 lds
    v_mfma_f32_16x16x32_bf16 v[128:131], a[160:163], a[48:51], v[128:131]
    s_waitcnt vmcnt(17)
    s_waitcnt lgkmcnt(7)
    ds_read_b64_tr_b16 a[182:183], v30 offset:12288
    ds_read_b64_tr_b16 a[184:185], v31 offset:0
    v_mfma_f32_16x16x32_bf16 v[128:131], a[164:167], a[56:59], v[128:131]
    s_waitcnt vmcnt(16)
    ds_read_b64_tr_b16 a[186:187], v31 offset:4096
    v_mfma_f32_16x16x32_bf16 v[132:135], a[160:163], a[52:55], v[132:135]
    s_waitcnt vmcnt(15)
    ds_read_b64_tr_b16 a[188:189], v31 offset:8192
    v_mfma_f32_16x16x32_bf16 v[132:135], a[164:167], a[60:63], v[132:135]
    s_waitcnt lgkmcnt(9)
    buffer_load_dwordx4 v45, s[16:19], s49 offen offset:3072 lds
    v_mfma_f32_16x16x32_bf16 v[136:139], a[168:171], a[48:51], v[136:139]
    s_waitcnt lgkmcnt(7)
    ds_read_b64_tr_b16 a[190:191], v31 offset:12288
    ds_read_b64_tr_b16 a[160:161], v32 offset:0
    v_mfma_f32_16x16x32_bf16 v[136:139], a[172:175], a[56:59], v[136:139]
    s_add_u32 s49, s44, 2621696
    ds_read_b64_tr_b16 a[162:163], v32 offset:4096
    v_mfma_f32_16x16x32_bf16 v[140:143], a[168:171], a[52:55], v[140:143]
    s_add_u32 m0, s42, 49152
    ds_read_b64_tr_b16 a[164:165], v32 offset:8192
    v_mfma_f32_16x16x32_bf16 v[140:143], a[172:175], a[60:63], v[140:143]
    s_waitcnt lgkmcnt(9)
    buffer_load_dwordx4 v42, s[16:19], s49 offen lds
    v_mfma_f32_16x16x32_bf16 v[144:147], a[176:179], a[48:51], v[144:147]
    s_waitcnt lgkmcnt(7)
    ds_read_b64_tr_b16 a[166:167], v32 offset:12288
    ds_read_b64_tr_b16 a[168:169], v33 offset:0
    v_mfma_f32_16x16x32_bf16 v[144:147], a[180:183], a[56:59], v[144:147]
    ds_read_b64_tr_b16 a[170:171], v33 offset:4096
    v_mfma_f32_16x16x32_bf16 v[148:151], a[176:179], a[52:55], v[148:151]
    ds_read_b64_tr_b16 a[172:173], v33 offset:8192
    v_mfma_f32_16x16x32_bf16 v[148:151], a[180:183], a[60:63], v[148:151]
    s_waitcnt lgkmcnt(9)
    buffer_load_dwordx4 v43, s[16:19], s49 offen offset:1024 lds
    v_mfma_f32_16x16x32_bf16 v[152:155], a[184:187], a[48:51], v[152:155]
    s_waitcnt lgkmcnt(7)
    ds_read_b64_tr_b16 a[174:175], v33 offset:12288
    ds_read_b64_tr_b16 a[176:177], v34 offset:0
    v_mfma_f32_16x16x32_bf16 v[152:155], a[188:191], a[56:59], v[152:155]
    ds_read_b64_tr_b16 a[178:179], v34 offset:4096
    v_mfma_f32_16x16x32_bf16 v[156:159], a[184:187], a[52:55], v[156:159]
    ds_read_b64_tr_b16 a[180:181], v34 offset:8192
    v_mfma_f32_16x16x32_bf16 v[156:159], a[188:191], a[60:63], v[156:159]
    s_waitcnt lgkmcnt(9)
    buffer_load_dwordx4 v44, s[16:19], s49 offen offset:2048 lds
    v_mfma_f32_16x16x32_bf16 v[160:163], a[160:163], a[48:51], v[160:163]
    s_waitcnt lgkmcnt(7)
    ds_read_b64_tr_b16 a[182:183], v34 offset:12288
    ds_read_b64_tr_b16 a[184:185], v35 offset:0
    v_mfma_f32_16x16x32_bf16 v[160:163], a[164:167], a[56:59], v[160:163]
    ds_read_b64_tr_b16 a[186:187], v35 offset:4096
    v_mfma_f32_16x16x32_bf16 v[164:167], a[160:163], a[52:55], v[164:167]
    ds_read_b64_tr_b16 a[188:189], v35 offset:8192
    v_mfma_f32_16x16x32_bf16 v[164:167], a[164:167], a[60:63], v[164:167]
    s_waitcnt lgkmcnt(9)
    buffer_load_dwordx4 v45, s[16:19], s49 offen offset:3072 lds
    v_mfma_f32_16x16x32_bf16 v[168:171], a[168:171], a[48:51], v[168:171]
    s_waitcnt lgkmcnt(7)
    ds_read_b64_tr_b16 a[190:191], v35 offset:12288
    ds_read_b64_tr_b16 a[160:161], v28 offset:16384
    v_mfma_f32_16x16x32_bf16 v[168:171], a[172:175], a[56:59], v[168:171]
    ds_read_b64_tr_b16 a[162:163], v28 offset:20480
    v_mfma_f32_16x16x32_bf16 v[172:175], a[168:171], a[52:55], v[172:175]
    ds_read_b64_tr_b16 a[164:165], v28 offset:24576
    v_mfma_f32_16x16x32_bf16 v[172:175], a[172:175], a[60:63], v[172:175]
    s_waitcnt lgkmcnt(9)
    buffer_load_dwordx4 a[80:83], v51, s[24:27], s46 offen offset:1280 sc1
    v_mfma_f32_16x16x32_bf16 v[176:179], a[176:179], a[48:51], v[176:179]
    s_waitcnt lgkmcnt(7)
    ds_read_b64_tr_b16 a[166:167], v28 offset:28672
    ds_read_b64_tr_b16 a[168:169], v29 offset:16384
    v_mfma_f32_16x16x32_bf16 v[176:179], a[180:183], a[56:59], v[176:179]
    ds_read_b64_tr_b16 a[170:171], v29 offset:20480
    v_mfma_f32_16x16x32_bf16 v[180:183], a[176:179], a[52:55], v[180:183]
    ds_read_b64_tr_b16 a[172:173], v29 offset:24576
    v_mfma_f32_16x16x32_bf16 v[180:183], a[180:183], a[60:63], v[180:183]
    s_waitcnt lgkmcnt(9)
    buffer_load_dwordx4 a[88:91], v51, s[24:27], s46 offen offset:1408 sc1
    v_mfma_f32_16x16x32_bf16 v[184:187], a[184:187], a[48:51], v[184:187]
    s_waitcnt lgkmcnt(7)
    ds_read_b64_tr_b16 a[174:175], v29 offset:28672
    ds_read_b64_tr_b16 a[176:177], v30 offset:16384
    v_mfma_f32_16x16x32_bf16 v[184:187], a[188:191], a[56:59], v[184:187]
    ds_read_b64_tr_b16 a[178:179], v30 offset:20480
    v_mfma_f32_16x16x32_bf16 v[188:191], a[184:187], a[52:55], v[188:191]
    ds_read_b64_tr_b16 a[180:181], v30 offset:24576
    v_mfma_f32_16x16x32_bf16 v[188:191], a[188:191], a[60:63], v[188:191]
    s_waitcnt lgkmcnt(9)
    buffer_load_dwordx4 a[84:87], v51, s[24:27], s43 offen offset:1280 sc1
    v_mfma_f32_16x16x32_bf16 v[192:195], a[160:163], a[48:51], v[192:195]
    s_waitcnt lgkmcnt(7)
    ds_read_b64_tr_b16 a[182:183], v30 offset:28672
    ds_read_b64_tr_b16 a[184:185], v31 offset:16384
    v_mfma_f32_16x16x32_bf16 v[192:195], a[164:167], a[56:59], v[192:195]
    ds_read_b64_tr_b16 a[186:187], v31 offset:20480
    v_mfma_f32_16x16x32_bf16 v[196:199], a[160:163], a[52:55], v[196:199]
    ds_read_b64_tr_b16 a[188:189], v31 offset:24576
    v_mfma_f32_16x16x32_bf16 v[196:199], a[164:167], a[60:63], v[196:199]
    s_waitcnt lgkmcnt(9)
    buffer_load_dwordx4 a[92:95], v51, s[24:27], s43 offen offset:1408 sc1
    v_mfma_f32_16x16x32_bf16 v[200:203], a[168:171], a[48:51], v[200:203]
    s_waitcnt lgkmcnt(7)
    ds_read_b64_tr_b16 a[190:191], v31 offset:28672
    ds_read_b64_tr_b16 a[160:161], v32 offset:16384
    v_mfma_f32_16x16x32_bf16 v[200:203], a[172:175], a[56:59], v[200:203]
    ds_read_b64_tr_b16 a[162:163], v32 offset:20480
    v_mfma_f32_16x16x32_bf16 v[204:207], a[168:171], a[52:55], v[204:207]
    ds_read_b64_tr_b16 a[164:165], v32 offset:24576
    v_mfma_f32_16x16x32_bf16 v[204:207], a[172:175], a[60:63], v[204:207]
    s_waitcnt lgkmcnt(9)
    buffer_load_dword v78, v120, s[8:11], 0 offen
    v_mfma_f32_16x16x32_bf16 v[208:211], a[176:179], a[48:51], v[208:211]
    s_waitcnt lgkmcnt(7)
    ds_read_b64_tr_b16 a[166:167], v32 offset:28672
    ds_read_b64_tr_b16 a[168:169], v33 offset:16384
    v_mfma_f32_16x16x32_bf16 v[208:211], a[180:183], a[56:59], v[208:211]
    ds_read_b64_tr_b16 a[170:171], v33 offset:20480
    v_mfma_f32_16x16x32_bf16 v[212:215], a[176:179], a[52:55], v[212:215]
    ds_read_b64_tr_b16 a[172:173], v33 offset:24576
    v_mfma_f32_16x16x32_bf16 v[212:215], a[180:183], a[60:63], v[212:215]
    s_waitcnt lgkmcnt(9)
    buffer_load_dword v79, v121, s[12:15], 0 offen
    v_mfma_f32_16x16x32_bf16 v[216:219], a[184:187], a[48:51], v[216:219]
    s_waitcnt lgkmcnt(7)
    ds_read_b64_tr_b16 a[174:175], v33 offset:28672
    ds_read_b64_tr_b16 a[176:177], v34 offset:16384
    v_mfma_f32_16x16x32_bf16 v[216:219], a[188:191], a[56:59], v[216:219]
    ds_read_b64_tr_b16 a[178:179], v34 offset:20480
    v_mfma_f32_16x16x32_bf16 v[220:223], a[184:187], a[52:55], v[220:223]
    ds_read_b64_tr_b16 a[180:181], v34 offset:24576
    v_mfma_f32_16x16x32_bf16 v[220:223], a[188:191], a[60:63], v[220:223]
    s_waitcnt lgkmcnt(9)
    ds_read_b64_tr_b16 a[182:183], v34 offset:28672
    v_mfma_f32_16x16x32_bf16 v[224:227], a[160:163], a[48:51], v[224:227]
    s_waitcnt lgkmcnt(8)
    ds_read_b64_tr_b16 a[184:185], v35 offset:16384
    v_mfma_f32_16x16x32_bf16 v[224:227], a[164:167], a[56:59], v[224:227]
    ds_read_b64_tr_b16 a[186:187], v35 offset:20480
    v_mfma_f32_16x16x32_bf16 v[228:231], a[160:163], a[52:55], v[228:231]
    ds_read_b64_tr_b16 a[188:189], v35 offset:24576
    v_mfma_f32_16x16x32_bf16 v[228:231], a[164:167], a[60:63], v[228:231]
    s_waitcnt lgkmcnt(9)
    ds_read_b64_tr_b16 a[190:191], v35 offset:28672
    s_waitcnt vmcnt(18)
    s_barrier
    v_mfma_f32_16x16x32_bf16 v[232:235], a[168:171], a[48:51], v[232:235]
    s_waitcnt lgkmcnt(8)
    ds_read_b64_tr_b16 a[160:161], v12 offset:0
    v_mfma_f32_16x16x32_bf16 v[232:235], a[172:175], a[56:59], v[232:235]
    s_add_u32 s49, s44, 3145728
    ds_read_b64_tr_b16 a[162:163], v12 offset:4096
    v_mfma_f32_16x16x32_bf16 v[236:239], a[168:171], a[52:55], v[236:239]
    s_add_u32 m0, s42, 65536
    ds_read_b64_tr_b16 a[164:165], v12 offset:8192
    v_mfma_f32_16x16x32_bf16 v[236:239], a[172:175], a[60:63], v[236:239]
    s_waitcnt lgkmcnt(9)
    buffer_load_dwordx4 v42, s[16:19], s49 offen lds
    v_mfma_f32_16x16x32_bf16 v[240:243], a[176:179], a[48:51], v[240:243]
    s_waitcnt lgkmcnt(7)
    ds_read_b64_tr_b16 a[166:167], v12 offset:12288
    ds_read_b64_tr_b16 a[168:169], v13 offset:0
    v_mfma_f32_16x16x32_bf16 v[240:243], a[180:183], a[56:59], v[240:243]
Ltour1:
    s_cbranch_execz Ltour5
    ds_read_b64_tr_b16 a[170:171], v13 offset:4096
    v_mfma_f32_16x16x32_bf16 v[244:247], a[176:179], a[52:55], v[244:247]
    ds_read_b64_tr_b16 a[172:173], v13 offset:8192
    v_mfma_f32_16x16x32_bf16 v[244:247], a[180:183], a[60:63], v[244:247]
    s_waitcnt lgkmcnt(9)
    buffer_load_dwordx4 v43, s[16:19], s49 offen offset:1024 lds
    v_mfma_f32_16x16x32_bf16 v[248:251], a[184:187], a[48:51], v[248:251]
    s_waitcnt lgkmcnt(7)
    ds_read_b64_tr_b16 a[174:175], v13 offset:12288
    ds_read_b64_tr_b16 a[176:177], v14 offset:0
    v_mfma_f32_16x16x32_bf16 v[248:251], a[188:191], a[56:59], v[248:251]
    ds_read_b64_tr_b16 a[178:179], v14 offset:4096
    v_mfma_f32_16x16x32_bf16 v[252:255], a[184:187], a[52:55], v[252:255]
    ds_read_b64_tr_b16 a[180:181], v14 offset:8192
    v_mfma_f32_16x16x32_bf16 v[252:255], a[188:191], a[60:63], v[252:255]
    s_waitcnt vmcnt(19)
    s_waitcnt lgkmcnt(9)
    buffer_load_dwordx4 v44, s[16:19], s49 offen offset:2048 lds
    v_mfma_f32_16x16x32_bf16 v[128:131], a[160:163], a[64:67], v[128:131]
    s_waitcnt vmcnt(19)
    s_waitcnt lgkmcnt(7)
    ds_read_b64_tr_b16 a[182:183], v14 offset:12288
    ds_read_b64_tr_b16 a[184:185], v15 offset:0
    v_mfma_f32_16x16x32_bf16 v[128:131], a[164:167], a[72:75], v[128:131]
    s_waitcnt vmcnt(18)
    ds_read_b64_tr_b16 a[186:187], v15 offset:4096
    v_mfma_f32_16x16x32_bf16 v[132:135], a[160:163], a[68:71], v[132:135]
    s_waitcnt vmcnt(17)
    ds_read_b64_tr_b16 a[188:189], v15 offset:8192
    v_mfma_f32_16x16x32_bf16 v[132:135], a[164:167], a[76:79], v[132:135]
    s_waitcnt lgkmcnt(9)
    buffer_load_dwordx4 v45, s[16:19], s49 offen offset:3072 lds
    v_mfma_f32_16x16x32_bf16 v[136:139], a[168:171], a[64:67], v[136:139]
    s_waitcnt lgkmcnt(7)
    ds_read_b64_tr_b16 a[190:191], v15 offset:12288
    ds_read_b64_tr_b16 a[160:161], v16 offset:0
    v_mfma_f32_16x16x32_bf16 v[136:139], a[172:175], a[72:75], v[136:139]
    s_add_u32 s49, s44, 3145984
    ds_read_b64_tr_b16 a[162:163], v16 offset:4096
    v_mfma_f32_16x16x32_bf16 v[140:143], a[168:171], a[68:71], v[140:143]
    s_add_u32 m0, s42, 81920
    ds_read_b64_tr_b16 a[164:165], v16 offset:8192
    v_mfma_f32_16x16x32_bf16 v[140:143], a[172:175], a[76:79], v[140:143]
    s_waitcnt lgkmcnt(9)
    buffer_load_dwordx4 v42, s[16:19], s49 offen lds
    v_mfma_f32_16x16x32_bf16 v[144:147], a[176:179], a[64:67], v[144:147]
    s_waitcnt lgkmcnt(7)
    ds_read_b64_tr_b16 a[166:167], v16 offset:12288
    ds_read_b64_tr_b16 a[168:169], v17 offset:0
    v_mfma_f32_16x16x32_bf16 v[144:147], a[180:183], a[72:75], v[144:147]
    ds_read_b64_tr_b16 a[170:171], v17 offset:4096
    v_mfma_f32_16x16x32_bf16 v[148:151], a[176:179], a[68:71], v[148:151]
    ds_read_b64_tr_b16 a[172:173], v17 offset:8192
    v_mfma_f32_16x16x32_bf16 v[148:151], a[180:183], a[76:79], v[148:151]
    s_waitcnt lgkmcnt(9)
    buffer_load_dwordx4 v43, s[16:19], s49 offen offset:1024 lds
    v_mfma_f32_16x16x32_bf16 v[152:155], a[184:187], a[64:67], v[152:155]
    s_waitcnt lgkmcnt(7)
    ds_read_b64_tr_b16 a[174:175], v17 offset:12288
    ds_read_b64_tr_b16 a[176:177], v18 offset:0
    v_mfma_f32_16x16x32_bf16 v[152:155], a[188:191], a[72:75], v[152:155]
    ds_read_b64_tr_b16 a[178:179], v18 offset:4096
    v_mfma_f32_16x16x32_bf16 v[156:159], a[184:187], a[68:71], v[156:159]
    ds_read_b64_tr_b16 a[180:181], v18 offset:8192
    v_mfma_f32_16x16x32_bf16 v[156:159], a[188:191], a[76:79], v[156:159]
    s_waitcnt lgkmcnt(9)
    buffer_load_dwordx4 v44, s[16:19], s49 offen offset:2048 lds
    v_mfma_f32_16x16x32_bf16 v[160:163], a[160:163], a[64:67], v[160:163]
    s_waitcnt lgkmcnt(7)
    ds_read_b64_tr_b16 a[182:183], v18 offset:12288
    ds_read_b64_tr_b16 a[184:185], v19 offset:0
    v_mfma_f32_16x16x32_bf16 v[160:163], a[164:167], a[72:75], v[160:163]
    ds_read_b64_tr_b16 a[186:187], v19 offset:4096
    v_mfma_f32_16x16x32_bf16 v[164:167], a[160:163], a[68:71], v[164:167]
    ds_read_b64_tr_b16 a[188:189], v19 offset:8192
    v_mfma_f32_16x16x32_bf16 v[164:167], a[164:167], a[76:79], v[164:167]
    s_waitcnt lgkmcnt(9)
    buffer_load_dwordx4 v45, s[16:19], s49 offen offset:3072 lds
    v_mfma_f32_16x16x32_bf16 v[168:171], a[168:171], a[64:67], v[168:171]
    s_waitcnt lgkmcnt(7)
    ds_read_b64_tr_b16 a[190:191], v19 offset:12288
    ds_read_b64_tr_b16 a[160:161], v12 offset:16384
    v_mfma_f32_16x16x32_bf16 v[168:171], a[172:175], a[72:75], v[168:171]
    ds_read_b64_tr_b16 a[162:163], v12 offset:20480
    v_mfma_f32_16x16x32_bf16 v[172:175], a[168:171], a[68:71], v[172:175]
    ds_read_b64_tr_b16 a[164:165], v12 offset:24576
    v_mfma_f32_16x16x32_bf16 v[172:175], a[172:175], a[76:79], v[172:175]
    s_waitcnt lgkmcnt(9)
    buffer_load_dwordx4 a[96:99], v51, s[24:27], s46 offen offset:1536 sc1
    v_mfma_f32_16x16x32_bf16 v[176:179], a[176:179], a[64:67], v[176:179]
    s_waitcnt lgkmcnt(7)
    ds_read_b64_tr_b16 a[166:167], v12 offset:28672
    ds_read_b64_tr_b16 a[168:169], v13 offset:16384
    v_mfma_f32_16x16x32_bf16 v[176:179], a[180:183], a[72:75], v[176:179]
    ds_read_b64_tr_b16 a[170:171], v13 offset:20480
    v_mfma_f32_16x16x32_bf16 v[180:183], a[176:179], a[68:71], v[180:183]
    ds_read_b64_tr_b16 a[172:173], v13 offset:24576
    v_mfma_f32_16x16x32_bf16 v[180:183], a[180:183], a[76:79], v[180:183]
    s_waitcnt lgkmcnt(9)
    buffer_load_dwordx4 a[104:107], v51, s[24:27], s46 offen offset:1664 sc1
    v_mfma_f32_16x16x32_bf16 v[184:187], a[184:187], a[64:67], v[184:187]
    s_waitcnt lgkmcnt(7)
    ds_read_b64_tr_b16 a[174:175], v13 offset:28672
    ds_read_b64_tr_b16 a[176:177], v14 offset:16384
    v_mfma_f32_16x16x32_bf16 v[184:187], a[188:191], a[72:75], v[184:187]
    ds_read_b64_tr_b16 a[178:179], v14 offset:20480
    v_mfma_f32_16x16x32_bf16 v[188:191], a[184:187], a[68:71], v[188:191]
    ds_read_b64_tr_b16 a[180:181], v14 offset:24576
    v_mfma_f32_16x16x32_bf16 v[188:191], a[188:191], a[76:79], v[188:191]
    s_waitcnt lgkmcnt(9)
    buffer_load_dwordx4 a[100:103], v51, s[24:27], s43 offen offset:1536 sc1
    v_mfma_f32_16x16x32_bf16 v[192:195], a[160:163], a[64:67], v[192:195]
    s_waitcnt lgkmcnt(7)
    ds_read_b64_tr_b16 a[182:183], v14 offset:28672
    ds_read_b64_tr_b16 a[184:185], v15 offset:16384
    v_mfma_f32_16x16x32_bf16 v[192:195], a[164:167], a[72:75], v[192:195]
    ds_read_b64_tr_b16 a[186:187], v15 offset:20480
    v_mfma_f32_16x16x32_bf16 v[196:199], a[160:163], a[68:71], v[196:199]
    ds_read_b64_tr_b16 a[188:189], v15 offset:24576
    v_mfma_f32_16x16x32_bf16 v[196:199], a[164:167], a[76:79], v[196:199]
    s_waitcnt lgkmcnt(9)
    buffer_load_dwordx4 a[108:111], v51, s[24:27], s43 offen offset:1664 sc1
    v_mfma_f32_16x16x32_bf16 v[200:203], a[168:171], a[64:67], v[200:203]
    s_waitcnt lgkmcnt(7)
    ds_read_b64_tr_b16 a[190:191], v15 offset:28672
    ds_read_b64_tr_b16 a[160:161], v16 offset:16384
    v_mfma_f32_16x16x32_bf16 v[200:203], a[172:175], a[72:75], v[200:203]
    ds_read_b64_tr_b16 a[162:163], v16 offset:20480
    v_mfma_f32_16x16x32_bf16 v[204:207], a[168:171], a[68:71], v[204:207]
    ds_read_b64_tr_b16 a[164:165], v16 offset:24576
    v_mfma_f32_16x16x32_bf16 v[204:207], a[172:175], a[76:79], v[204:207]
    s_waitcnt lgkmcnt(9)
    ds_read_b64_tr_b16 a[166:167], v16 offset:28672
    v_mfma_f32_16x16x32_bf16 v[208:211], a[176:179], a[64:67], v[208:211]
    s_waitcnt lgkmcnt(8)
    ds_read_b64_tr_b16 a[168:169], v17 offset:16384
    v_mfma_f32_16x16x32_bf16 v[208:211], a[180:183], a[72:75], v[208:211]
    ds_read_b64_tr_b16 a[170:171], v17 offset:20480
    v_mfma_f32_16x16x32_bf16 v[212:215], a[176:179], a[68:71], v[212:215]
    ds_read_b64_tr_b16 a[172:173], v17 offset:24576
    v_mfma_f32_16x16x32_bf16 v[212:215], a[180:183], a[76:79], v[212:215]
    s_waitcnt lgkmcnt(9)
    ds_read_b64_tr_b16 a[174:175], v17 offset:28672
    v_mfma_f32_16x16x32_bf16 v[216:219], a[184:187], a[64:67], v[216:219]
    s_waitcnt lgkmcnt(8)
    ds_read_b64_tr_b16 a[176:177], v18 offset:16384
    v_mfma_f32_16x16x32_bf16 v[216:219], a[188:191], a[72:75], v[216:219]
    ds_read_b64_tr_b16 a[178:179], v18 offset:20480
    v_mfma_f32_16x16x32_bf16 v[220:223], a[184:187], a[68:71], v[220:223]
    ds_read_b64_tr_b16 a[180:181], v18 offset:24576
    v_mfma_f32_16x16x32_bf16 v[220:223], a[188:191], a[76:79], v[220:223]
    s_waitcnt lgkmcnt(9)
    ds_read_b64_tr_b16 a[182:183], v18 offset:28672
    v_mfma_f32_16x16x32_bf16 v[224:227], a[160:163], a[64:67], v[224:227]
    s_waitcnt lgkmcnt(8)
    ds_read_b64_tr_b16 a[184:185], v19 offset:16384
    v_mfma_f32_16x16x32_bf16 v[224:227], a[164:167], a[72:75], v[224:227]
    ds_read_b64_tr_b16 a[186:187], v19 offset:20480
    v_mfma_f32_16x16x32_bf16 v[228:231], a[160:163], a[68:71], v[228:231]
    ds_read_b64_tr_b16 a[188:189], v19 offset:24576
    v_mfma_f32_16x16x32_bf16 v[228:231], a[164:167], a[76:79], v[228:231]
    s_waitcnt lgkmcnt(9)
    ds_read_b64_tr_b16 a[190:191], v19 offset:28672
    s_waitcnt vmcnt(18)
    s_barrier
    v_mfma_f32_16x16x32_bf16 v[232:235], a[168:171], a[64:67], v[232:235]
    s_waitcnt lgkmcnt(8)
    ds_read_b64_tr_b16 a[160:161], v12 offset:32768
    v_mfma_f32_16x16x32_bf16 v[232:235], a[172:175], a[72:75], v[232:235]
    s_add_u32 s49, s44, 3670016
    ds_read_b64_tr_b16 a[162:163], v12 offset:36864
    v_mfma_f32_16x16x32_bf16 v[236:239], a[168:171], a[68:71], v[236:239]
    s_add_u32 m0, s42, 98304
    ds_read_b64_tr_b16 a[164:165], v12 offset:40960
    v_mfma_f32_16x16x32_bf16 v[236:239], a[172:175], a[76:79], v[236:239]
    s_waitcnt lgkmcnt(9)
    buffer_load_dwordx4 v42, s[16:19], s49 offen lds
    v_mfma_f32_16x16x32_bf16 v[240:243], a[176:179], a[64:67], v[240:243]
    s_waitcnt lgkmcnt(7)
    ds_read_b64_tr_b16 a[166:167], v12 offset:45056
    ds_read_b64_tr_b16 a[168:169], v13 offset:32768
    v_mfma_f32_16x16x32_bf16 v[240:243], a[180:183], a[72:75], v[240:243]
    ds_read_b64_tr_b16 a[170:171], v13 offset:36864
    v_mfma_f32_16x16x32_bf16 v[244:247], a[176:179], a[68:71], v[244:247]
    ds_read_b64_tr_b16 a[172:173], v13 offset:40960
    v_mfma_f32_16x16x32_bf16 v[244:247], a[180:183], a[76:79], v[244:247]
    s_waitcnt lgkmcnt(9)
    buffer_load_dwordx4 v43, s[16:19], s49 offen offset:1024 lds
    v_mfma_f32_16x16x32_bf16 v[248:251], a[184:187], a[64:67], v[248:251]
    s_waitcnt lgkmcnt(7)
    ds_read_b64_tr_b16 a[174:175], v13 offset:45056
    ds_read_b64_tr_b16 a[176:177], v14 offset:32768
    v_mfma_f32_16x16x32_bf16 v[248:251], a[188:191], a[72:75], v[248:251]
    ds_read_b64_tr_b16 a[178:179], v14 offset:36864
    v_mfma_f32_16x16x32_bf16 v[252:255], a[184:187], a[68:71], v[252:255]
    ds_read_b64_tr_b16 a[180:181], v14 offset:40960
    v_mfma_f32_16x16x32_bf16 v[252:255], a[188:191], a[76:79], v[252:255]
    s_waitcnt vmcnt(19)
    s_waitcnt lgkmcnt(9)
    buffer_load_dwordx4 v44, s[16:19], s49 offen offset:2048 lds
    v_mfma_f32_16x16x32_bf16 v[128:131], a[160:163], a[80:83], v[128:131]
    s_waitcnt vmcnt(19)
    s_waitcnt lgkmcnt(7)
    ds_read_b64_tr_b16 a[182:183], v14 offset:45056
    ds_read_b64_tr_b16 a[184:185], v15 offset:32768
    v_mfma_f32_16x16x32_bf16 v[128:131], a[164:167], a[88:91], v[128:131]
    s_waitcnt vmcnt(18)
    ds_read_b64_tr_b16 a[186:187], v15 offset:36864
    v_accvgpr_write_b32 a0, 0
    v_mfma_f32_16x16x32_bf16 v[132:135], a[160:163], a[84:87], v[132:135]
    s_waitcnt vmcnt(17)
    ds_read_b64_tr_b16 a[188:189], v15 offset:40960
    v_accvgpr_write_b32 a1, 0
    v_mfma_f32_16x16x32_bf16 v[132:135], a[164:167], a[92:95], v[132:135]
    s_waitcnt lgkmcnt(9)
    buffer_load_dwordx4 v45, s[16:19], s49 offen offset:3072 lds
    v_mfma_f32_16x16x32_bf16 v[136:139], a[168:171], a[80:83], v[136:139]
    s_waitcnt lgkmcnt(7)
    ds_read_b64_tr_b16 a[190:191], v15 offset:45056
    ds_read_b64_tr_b16 a[160:161], v16 offset:32768
    v_mfma_f32_16x16x32_bf16 v[136:139], a[172:175], a[88:91], v[136:139]
    s_add_u32 s49, s44, 3670272
    ds_read_b64_tr_b16 a[162:163], v16 offset:36864
    v_accvgpr_write_b32 a2, 0
    v_mfma_f32_16x16x32_bf16 v[140:143], a[168:171], a[84:87], v[140:143]
    s_add_u32 m0, s42, 114688
    ds_read_b64_tr_b16 a[164:165], v16 offset:40960
    v_accvgpr_write_b32 a3, 0
    v_mfma_f32_16x16x32_bf16 v[140:143], a[172:175], a[92:95], v[140:143]
    s_waitcnt lgkmcnt(9)
    buffer_load_dwordx4 v42, s[16:19], s49 offen lds
    v_mfma_f32_16x16x32_bf16 v[144:147], a[176:179], a[80:83], v[144:147]
    s_waitcnt lgkmcnt(7)
    ds_read_b64_tr_b16 a[166:167], v16 offset:45056
    ds_read_b64_tr_b16 a[168:169], v17 offset:32768
    v_mfma_f32_16x16x32_bf16 v[144:147], a[180:183], a[88:91], v[144:147]
    ds_read_b64_tr_b16 a[170:171], v17 offset:36864
    v_accvgpr_write_b32 a4, 0
    v_mfma_f32_16x16x32_bf16 v[148:151], a[176:179], a[84:87], v[148:151]
    ds_read_b64_tr_b16 a[172:173], v17 offset:40960
    v_accvgpr_write_b32 a5, 0
    v_mfma_f32_16x16x32_bf16 v[148:151], a[180:183], a[92:95], v[148:151]
    s_waitcnt lgkmcnt(9)
    buffer_load_dwordx4 v43, s[16:19], s49 offen offset:1024 lds
    v_mfma_f32_16x16x32_bf16 v[152:155], a[184:187], a[80:83], v[152:155]
    s_waitcnt lgkmcnt(7)
    ds_read_b64_tr_b16 a[174:175], v17 offset:45056
    ds_read_b64_tr_b16 a[176:177], v18 offset:32768
    v_mfma_f32_16x16x32_bf16 v[152:155], a[188:191], a[88:91], v[152:155]
    ds_read_b64_tr_b16 a[178:179], v18 offset:36864
    v_accvgpr_write_b32 a6, 0
    v_mfma_f32_16x16x32_bf16 v[156:159], a[184:187], a[84:87], v[156:159]
    ds_read_b64_tr_b16 a[180:181], v18 offset:40960
    v_accvgpr_write_b32 a7, 0
    v_mfma_f32_16x16x32_bf16 v[156:159], a[188:191], a[92:95], v[156:159]
    s_waitcnt lgkmcnt(9)
    buffer_load_dwordx4 v44, s[16:19], s49 offen offset:2048 lds
    v_mfma_f32_16x16x32_bf16 v[160:163], a[160:163], a[80:83], v[160:163]
    s_waitcnt lgkmcnt(7)
    ds_read_b64_tr_b16 a[182:183], v18 offset:45056
    ds_read_b64_tr_b16 a[184:185], v19 offset:32768
    v_mfma_f32_16x16x32_bf16 v[160:163], a[164:167], a[88:91], v[160:163]
    ds_read_b64_tr_b16 a[186:187], v19 offset:36864
    v_accvgpr_write_b32 a8, 0
    v_mfma_f32_16x16x32_bf16 v[164:167], a[160:163], a[84:87], v[164:167]
    ds_read_b64_tr_b16 a[188:189], v19 offset:40960
    v_accvgpr_write_b32 a9, 0
    v_mfma_f32_16x16x32_bf16 v[164:167], a[164:167], a[92:95], v[164:167]
    s_waitcnt lgkmcnt(9)
    buffer_load_dwordx4 v45, s[16:19], s49 offen offset:3072 lds
    v_mfma_f32_16x16x32_bf16 v[168:171], a[168:171], a[80:83], v[168:171]
    s_waitcnt lgkmcnt(7)
    ds_read_b64_tr_b16 a[190:191], v19 offset:45056
    ds_read_b64_tr_b16 a[160:161], v12 offset:49152
    v_mfma_f32_16x16x32_bf16 v[168:171], a[172:175], a[88:91], v[168:171]
    ds_read_b64_tr_b16 a[162:163], v12 offset:53248
    v_accvgpr_write_b32 a10, 0
    v_mfma_f32_16x16x32_bf16 v[172:175], a[168:171], a[84:87], v[172:175]
    ds_read_b64_tr_b16 a[164:165], v12 offset:57344
    v_accvgpr_write_b32 a11, 0
    v_mfma_f32_16x16x32_bf16 v[172:175], a[172:175], a[92:95], v[172:175]
    s_waitcnt lgkmcnt(9)
    buffer_load_dwordx4 a[112:115], v51, s[24:27], s46 offen offset:1792 sc1
    v_mfma_f32_16x16x32_bf16 v[176:179], a[176:179], a[80:83], v[176:179]
    s_waitcnt lgkmcnt(7)
    ds_read_b64_tr_b16 a[166:167], v12 offset:61440
    ds_read_b64_tr_b16 a[168:169], v13 offset:49152
    v_mfma_f32_16x16x32_bf16 v[176:179], a[180:183], a[88:91], v[176:179]
    ds_read_b64_tr_b16 a[170:171], v13 offset:53248
    v_accvgpr_write_b32 a12, 0
    v_mfma_f32_16x16x32_bf16 v[180:183], a[176:179], a[84:87], v[180:183]
    ds_read_b64_tr_b16 a[172:173], v13 offset:57344
    v_accvgpr_write_b32 a13, 0
    v_mfma_f32_16x16x32_bf16 v[180:183], a[180:183], a[92:95], v[180:183]
    s_waitcnt lgkmcnt(9)
    buffer_load_dwordx4 a[120:123], v51, s[24:27], s46 offen offset:1920 sc1
    v_mfma_f32_16x16x32_bf16 v[184:187], a[184:187], a[80:83], v[184:187]
    s_waitcnt lgkmcnt(7)
    ds_read_b64_tr_b16 a[174:175], v13 offset:61440
    ds_read_b64_tr_b16 a[176:177], v14 offset:49152
    v_mfma_f32_16x16x32_bf16 v[184:187], a[188:191], a[88:91], v[184:187]
    ds_read_b64_tr_b16 a[178:179], v14 offset:53248
    v_accvgpr_write_b32 a14, 0
    v_mfma_f32_16x16x32_bf16 v[188:191], a[184:187], a[84:87], v[188:191]
    ds_read_b64_tr_b16 a[180:181], v14 offset:57344
    v_accvgpr_write_b32 a15, 0
    v_mfma_f32_16x16x32_bf16 v[188:191], a[188:191], a[92:95], v[188:191]
    s_waitcnt lgkmcnt(9)
    buffer_load_dwordx4 a[116:119], v51, s[24:27], s43 offen offset:1792 sc1
    v_mfma_f32_16x16x32_bf16 v[192:195], a[160:163], a[80:83], v[192:195]
    s_waitcnt lgkmcnt(7)
    ds_read_b64_tr_b16 a[182:183], v14 offset:61440
    ds_read_b64_tr_b16 a[184:185], v15 offset:49152
    v_mfma_f32_16x16x32_bf16 v[192:195], a[164:167], a[88:91], v[192:195]
    ds_read_b64_tr_b16 a[186:187], v15 offset:53248
    v_accvgpr_write_b32 a16, 0
    v_mfma_f32_16x16x32_bf16 v[196:199], a[160:163], a[84:87], v[196:199]
    ds_read_b64_tr_b16 a[188:189], v15 offset:57344
    v_accvgpr_write_b32 a17, 0
    v_mfma_f32_16x16x32_bf16 v[196:199], a[164:167], a[92:95], v[196:199]
    s_waitcnt lgkmcnt(9)
    buffer_load_dwordx4 a[124:127], v51, s[24:27], s43 offen offset:1920 sc1
    v_mfma_f32_16x16x32_bf16 v[200:203], a[168:171], a[80:83], v[200:203]
    s_waitcnt lgkmcnt(7)
    ds_read_b64_tr_b16 a[190:191], v15 offset:61440
    ds_read_b64_tr_b16 a[160:161], v16 offset:49152
    v_mfma_f32_16x16x32_bf16 v[200:203], a[172:175], a[88:91], v[200:203]
    ds_read_b64_tr_b16 a[162:163], v16 offset:53248
    v_accvgpr_write_b32 a18, 0
    v_mfma_f32_16x16x32_bf16 v[204:207], a[168:171], a[84:87], v[204:207]
    ds_read_b64_tr_b16 a[164:165], v16 offset:57344
    v_accvgpr_write_b32 a19, 0
    v_mfma_f32_16x16x32_bf16 v[204:207], a[172:175], a[92:95], v[204:207]
    s_waitcnt lgkmcnt(9)
    ds_read_b64_tr_b16 a[166:167], v16 offset:61440
    v_accvgpr_write_b32 a20, 0
    v_mfma_f32_16x16x32_bf16 v[208:211], a[176:179], a[80:83], v[208:211]
    s_waitcnt lgkmcnt(8)
    ds_read_b64_tr_b16 a[168:169], v17 offset:49152
    v_accvgpr_write_b32 a21, 0
    v_mfma_f32_16x16x32_bf16 v[208:211], a[180:183], a[88:91], v[208:211]
    ds_read_b64_tr_b16 a[170:171], v17 offset:53248
    v_accvgpr_write_b32 a22, 0
    v_mfma_f32_16x16x32_bf16 v[212:215], a[176:179], a[84:87], v[212:215]
    ds_read_b64_tr_b16 a[172:173], v17 offset:57344
    v_accvgpr_write_b32 a23, 0
    v_mfma_f32_16x16x32_bf16 v[212:215], a[180:183], a[92:95], v[212:215]
    s_waitcnt lgkmcnt(9)
    ds_read_b64_tr_b16 a[174:175], v17 offset:61440
    v_accvgpr_write_b32 a24, 0
    v_mfma_f32_16x16x32_bf16 v[216:219], a[184:187], a[80:83], v[216:219]
    s_waitcnt lgkmcnt(8)
    ds_read_b64_tr_b16 a[176:177], v18 offset:49152
    v_accvgpr_write_b32 a25, 0
    v_mfma_f32_16x16x32_bf16 v[216:219], a[188:191], a[88:91], v[216:219]
    ds_read_b64_tr_b16 a[178:179], v18 offset:53248
    v_accvgpr_write_b32 a26, 0
    v_mfma_f32_16x16x32_bf16 v[220:223], a[184:187], a[84:87], v[220:223]
    ds_read_b64_tr_b16 a[180:181], v18 offset:57344
    v_accvgpr_write_b32 a27, 0
    v_mfma_f32_16x16x32_bf16 v[220:223], a[188:191], a[92:95], v[220:223]
    s_waitcnt lgkmcnt(9)
    ds_read_b64_tr_b16 a[182:183], v18 offset:61440
    v_accvgpr_write_b32 a28, 0
    v_mfma_f32_16x16x32_bf16 v[224:227], a[160:163], a[80:83], v[224:227]
    s_waitcnt lgkmcnt(8)
    ds_read_b64_tr_b16 a[184:185], v19 offset:49152
    v_accvgpr_write_b32 a29, 0
    v_mfma_f32_16x16x32_bf16 v[224:227], a[164:167], a[88:91], v[224:227]
    ds_read_b64_tr_b16 a[186:187], v19 offset:53248
    v_accvgpr_write_b32 a30, 0
    v_mfma_f32_16x16x32_bf16 v[228:231], a[160:163], a[84:87], v[228:231]
    ds_read_b64_tr_b16 a[188:189], v19 offset:57344
    v_accvgpr_write_b32 a31, 0
    v_mfma_f32_16x16x32_bf16 v[228:231], a[164:167], a[92:95], v[228:231]
    s_waitcnt lgkmcnt(9)
    ds_read_b64_tr_b16 a[190:191], v19 offset:61440
    v_accvgpr_write_b32 a32, 0
    s_waitcnt vmcnt(16)
    s_barrier
    v_mfma_f32_16x16x32_bf16 v[232:235], a[168:171], a[80:83], v[232:235]
    s_waitcnt lgkmcnt(8)
    ds_read_b64_tr_b16 a[160:161], v20 offset:0
    v_accvgpr_write_b32 a33, 0
    v_mfma_f32_16x16x32_bf16 v[232:235], a[172:175], a[88:91], v[232:235]
    s_add_u32 s49, s44, 4194304
    ds_read_b64_tr_b16 a[162:163], v20 offset:4096
    v_accvgpr_write_b32 a34, 0
    v_mfma_f32_16x16x32_bf16 v[236:239], a[168:171], a[84:87], v[236:239]
    s_add_u32 m0, s42, 131072
    ds_read_b64_tr_b16 a[164:165], v20 offset:8192
    v_accvgpr_write_b32 a35, 0
    v_mfma_f32_16x16x32_bf16 v[236:239], a[172:175], a[92:95], v[236:239]
    s_waitcnt lgkmcnt(9)
    buffer_load_dwordx4 v42, s[16:19], s49 offen lds
    v_mfma_f32_16x16x32_bf16 v[240:243], a[176:179], a[80:83], v[240:243]
    s_waitcnt lgkmcnt(7)
    ds_read_b64_tr_b16 a[166:167], v20 offset:12288
    ds_read_b64_tr_b16 a[168:169], v21 offset:0
    v_mfma_f32_16x16x32_bf16 v[240:243], a[180:183], a[88:91], v[240:243]
    ds_read_b64_tr_b16 a[170:171], v21 offset:4096
    v_accvgpr_write_b32 a36, 0
    v_mfma_f32_16x16x32_bf16 v[244:247], a[176:179], a[84:87], v[244:247]
    ds_read_b64_tr_b16 a[172:173], v21 offset:8192
    v_accvgpr_write_b32 a37, 0
    v_mfma_f32_16x16x32_bf16 v[244:247], a[180:183], a[92:95], v[244:247]
    s_waitcnt lgkmcnt(9)
    buffer_load_dwordx4 v43, s[16:19], s49 offen offset:1024 lds
    v_mfma_f32_16x16x32_bf16 v[248:251], a[184:187], a[80:83], v[248:251]
    s_waitcnt lgkmcnt(7)
    ds_read_b64_tr_b16 a[174:175], v21 offset:12288
    ds_read_b64_tr_b16 a[176:177], v22 offset:0
    v_mfma_f32_16x16x32_bf16 v[248:251], a[188:191], a[88:91], v[248:251]
    ds_read_b64_tr_b16 a[178:179], v22 offset:4096
    v_accvgpr_write_b32 a38, 0
    v_mfma_f32_16x16x32_bf16 v[252:255], a[184:187], a[84:87], v[252:255]
    ds_read_b64_tr_b16 a[180:181], v22 offset:8192
    v_accvgpr_write_b32 a39, 0
    v_mfma_f32_16x16x32_bf16 v[252:255], a[188:191], a[92:95], v[252:255]
    s_waitcnt vmcnt(17)
    s_waitcnt lgkmcnt(9)
    buffer_load_dwordx4 v44, s[16:19], s49 offen offset:2048 lds
    v_mfma_f32_16x16x32_bf16 v[128:131], a[160:163], a[96:99], v[128:131]
    s_waitcnt vmcnt(17)
    s_waitcnt lgkmcnt(7)
    ds_read_b64_tr_b16 a[182:183], v22 offset:12288
    ds_read_b64_tr_b16 a[184:185], v23 offset:0
    v_mfma_f32_16x16x32_bf16 v[128:131], a[164:167], a[104:107], v[128:131]
    s_waitcnt vmcnt(16)
    ds_read_b64_tr_b16 a[186:187], v23 offset:4096
    v_accvgpr_write_b32 a40, 0
    v_mfma_f32_16x16x32_bf16 v[132:135], a[160:163], a[100:103], v[132:135]
    s_waitcnt vmcnt(15)
    ds_read_b64_tr_b16 a[188:189], v23 offset:8192
    v_accvgpr_write_b32 a41, 0
    v_mfma_f32_16x16x32_bf16 v[132:135], a[164:167], a[108:111], v[132:135]
    s_waitcnt lgkmcnt(9)
    buffer_load_dwordx4 v45, s[16:19], s49 offen offset:3072 lds
    v_mfma_f32_16x16x32_bf16 v[136:139], a[168:171], a[96:99], v[136:139]
    s_waitcnt lgkmcnt(7)
    ds_read_b64_tr_b16 a[190:191], v23 offset:12288
    ds_read_b64_tr_b16 a[160:161], v24 offset:0
    v_mfma_f32_16x16x32_bf16 v[136:139], a[172:175], a[104:107], v[136:139]
    s_add_u32 s49, s44, 4194560
    ds_read_b64_tr_b16 a[162:163], v24 offset:4096
    v_accvgpr_write_b32 a42, 0
    v_mfma_f32_16x16x32_bf16 v[140:143], a[168:171], a[100:103], v[140:143]
    s_add_u32 m0, s42, 147456
    ds_read_b64_tr_b16 a[164:165], v24 offset:8192
    v_accvgpr_write_b32 a43, 0
    v_mfma_f32_16x16x32_bf16 v[140:143], a[172:175], a[108:111], v[140:143]
    s_waitcnt lgkmcnt(9)
    buffer_load_dwordx4 v42, s[16:19], s49 offen lds
    v_mfma_f32_16x16x32_bf16 v[144:147], a[176:179], a[96:99], v[144:147]
    s_waitcnt lgkmcnt(7)
    ds_read_b64_tr_b16 a[166:167], v24 offset:12288
    ds_read_b64_tr_b16 a[168:169], v25 offset:0
    v_mfma_f32_16x16x32_bf16 v[144:147], a[180:183], a[104:107], v[144:147]
    ds_read_b64_tr_b16 a[170:171], v25 offset:4096
    v_accvgpr_write_b32 a44, 0
    v_mfma_f32_16x16x32_bf16 v[148:151], a[176:179], a[100:103], v[148:151]
    ds_read_b64_tr_b16 a[172:173], v25 offset:8192
    v_accvgpr_write_b32 a45, 0
    v_mfma_f32_16x16x32_bf16 v[148:151], a[180:183], a[108:111], v[148:151]
    s_waitcnt lgkmcnt(9)
    buffer_load_dwordx4 v43, s[16:19], s49 offen offset:1024 lds
    v_mfma_f32_16x16x32_bf16 v[152:155], a[184:187], a[96:99], v[152:155]
    s_waitcnt lgkmcnt(7)
    ds_read_b64_tr_b16 a[174:175], v25 offset:12288
    ds_read_b64_tr_b16 a[176:177], v26 offset:0
    v_mfma_f32_16x16x32_bf16 v[152:155], a[188:191], a[104:107], v[152:155]
    ds_read_b64_tr_b16 a[178:179], v26 offset:4096
    v_accvgpr_write_b32 a46, 0
    v_mfma_f32_16x16x32_bf16 v[156:159], a[184:187], a[100:103], v[156:159]
    ds_read_b64_tr_b16 a[180:181], v26 offset:8192
    v_accvgpr_write_b32 a47, 0
    v_mfma_f32_16x16x32_bf16 v[156:159], a[188:191], a[108:111], v[156:159]
    s_waitcnt lgkmcnt(9)
    buffer_load_dwordx4 v44, s[16:19], s49 offen offset:2048 lds
    v_mfma_f32_16x16x32_bf16 v[160:163], a[160:163], a[96:99], v[160:163]
    s_waitcnt lgkmcnt(7)
    ds_read_b64_tr_b16 a[182:183], v26 offset:12288
    ds_read_b64_tr_b16 a[184:185], v27 offset:0
    v_mfma_f32_16x16x32_bf16 v[160:163], a[164:167], a[104:107], v[160:163]
    ds_read_b64_tr_b16 a[186:187], v27 offset:4096
    v_accvgpr_write_b32 a48, 0
    v_mfma_f32_16x16x32_bf16 v[164:167], a[160:163], a[100:103], v[164:167]
    ds_read_b64_tr_b16 a[188:189], v27 offset:8192
    v_accvgpr_write_b32 a49, 0
    v_mfma_f32_16x16x32_bf16 v[164:167], a[164:167], a[108:111], v[164:167]
    s_waitcnt lgkmcnt(9)
    buffer_load_dwordx4 v45, s[16:19], s49 offen offset:3072 lds
    v_mfma_f32_16x16x32_bf16 v[168:171], a[168:171], a[96:99], v[168:171]
    s_waitcnt lgkmcnt(7)
    ds_read_b64_tr_b16 a[190:191], v27 offset:12288
    ds_read_b64_tr_b16 a[160:161], v20 offset:16384
    v_mfma_f32_16x16x32_bf16 v[168:171], a[172:175], a[104:107], v[168:171]
    ds_read_b64_tr_b16 a[162:163], v20 offset:20480
    v_accvgpr_write_b32 a50, 0
    v_mfma_f32_16x16x32_bf16 v[172:175], a[168:171], a[100:103], v[172:175]
    ds_read_b64_tr_b16 a[164:165], v20 offset:24576
    v_accvgpr_write_b32 a51, 0
    v_mfma_f32_16x16x32_bf16 v[172:175], a[172:175], a[108:111], v[172:175]
    s_waitcnt lgkmcnt(9)
    buffer_load_dwordx4 a[128:131], v51, s[24:27], s46 offen offset:2048 sc1
    v_mfma_f32_16x16x32_bf16 v[176:179], a[176:179], a[96:99], v[176:179]
    s_waitcnt lgkmcnt(7)
    ds_read_b64_tr_b16 a[166:167], v20 offset:28672
    ds_read_b64_tr_b16 a[168:169], v21 offset:16384
    v_mfma_f32_16x16x32_bf16 v[176:179], a[180:183], a[104:107], v[176:179]
    ds_read_b64_tr_b16 a[170:171], v21 offset:20480
    v_accvgpr_write_b32 a52, 0
    v_mfma_f32_16x16x32_bf16 v[180:183], a[176:179], a[100:103], v[180:183]
    ds_read_b64_tr_b16 a[172:173], v21 offset:24576
    v_accvgpr_write_b32 a53, 0
    v_mfma_f32_16x16x32_bf16 v[180:183], a[180:183], a[108:111], v[180:183]
    s_waitcnt lgkmcnt(9)
    buffer_load_dwordx4 a[136:139], v51, s[24:27], s46 offen offset:2176 sc1
    v_mfma_f32_16x16x32_bf16 v[184:187], a[184:187], a[96:99], v[184:187]
    s_waitcnt lgkmcnt(7)
    ds_read_b64_tr_b16 a[174:175], v21 offset:28672
    ds_read_b64_tr_b16 a[176:177], v22 offset:16384
    v_mfma_f32_16x16x32_bf16 v[184:187], a[188:191], a[104:107], v[184:187]
    ds_read_b64_tr_b16 a[178:179], v22 offset:20480
    v_accvgpr_write_b32 a54, 0
    v_mfma_f32_16x16x32_bf16 v[188:191], a[184:187], a[100:103], v[188:191]
    ds_read_b64_tr_b16 a[180:181], v22 offset:24576
    v_accvgpr_write_b32 a55, 0
    v_mfma_f32_16x16x32_bf16 v[188:191], a[188:191], a[108:111], v[188:191]
    s_waitcnt lgkmcnt(9)
    buffer_load_dwordx4 a[132:135], v51, s[24:27], s43 offen offset:2048 sc1
    v_mfma_f32_16x16x32_bf16 v[192:195], a[160:163], a[96:99], v[192:195]
    s_waitcnt lgkmcnt(7)
    ds_read_b64_tr_b16 a[182:183], v22 offset:28672
    ds_read_b64_tr_b16 a[184:185], v23 offset:16384
    v_mfma_f32_16x16x32_bf16 v[192:195], a[164:167], a[104:107], v[192:195]
    ds_read_b64_tr_b16 a[186:187], v23 offset:20480
    v_accvgpr_write_b32 a56, 0
    v_mfma_f32_16x16x32_bf16 v[196:199], a[160:163], a[100:103], v[196:199]
    ds_read_b64_tr_b16 a[188:189], v23 offset:24576
    v_accvgpr_write_b32 a57, 0
    v_mfma_f32_16x16x32_bf16 v[196:199], a[164:167], a[108:111], v[196:199]
    s_waitcnt lgkmcnt(9)
    buffer_load_dwordx4 a[140:143], v51, s[24:27], s43 offen offset:2176 sc1
    v_mfma_f32_16x16x32_bf16 v[200:203], a[168:171], a[96:99], v[200:203]
    s_waitcnt lgkmcnt(7)
    ds_read_b64_tr_b16 a[190:191], v23 offset:28672
    ds_read_b64_tr_b16 a[160:161], v24 offset:16384
    v_mfma_f32_16x16x32_bf16 v[200:203], a[172:175], a[104:107], v[200:203]
    ds_read_b64_tr_b16 a[162:163], v24 offset:20480
    v_accvgpr_write_b32 a58, 0
    v_mfma_f32_16x16x32_bf16 v[204:207], a[168:171], a[100:103], v[204:207]
    ds_read_b64_tr_b16 a[164:165], v24 offset:24576
    v_accvgpr_write_b32 a59, 0
    v_mfma_f32_16x16x32_bf16 v[204:207], a[172:175], a[108:111], v[204:207]
    s_waitcnt lgkmcnt(9)
    ds_read_b64_tr_b16 a[166:167], v24 offset:28672
    v_accvgpr_write_b32 a60, 0
    v_mfma_f32_16x16x32_bf16 v[208:211], a[176:179], a[96:99], v[208:211]
    s_waitcnt lgkmcnt(8)
    ds_read_b64_tr_b16 a[168:169], v25 offset:16384
    v_accvgpr_write_b32 a61, 0
    v_mfma_f32_16x16x32_bf16 v[208:211], a[180:183], a[104:107], v[208:211]
Ltour2:
    s_cbranch_execz Ltour6
    ds_read_b64_tr_b16 a[170:171], v25 offset:20480
    v_accvgpr_write_b32 a62, 0
    v_mfma_f32_16x16x32_bf16 v[212:215], a[176:179], a[100:103], v[212:215]
    ds_read_b64_tr_b16 a[172:173], v25 offset:24576
    v_accvgpr_write_b32 a63, 0
    v_mfma_f32_16x16x32_bf16 v[212:215], a[180:183], a[108:111], v[212:215]
    s_waitcnt lgkmcnt(9)
    ds_read_b64_tr_b16 a[174:175], v25 offset:28672
    v_accvgpr_write_b32 a64, 0
    v_mfma_f32_16x16x32_bf16 v[216:219], a[184:187], a[96:99], v[216:219]
    s_waitcnt lgkmcnt(8)
    ds_read_b64_tr_b16 a[176:177], v26 offset:16384
    v_accvgpr_write_b32 a65, 0
    v_mfma_f32_16x16x32_bf16 v[216:219], a[188:191], a[104:107], v[216:219]
    ds_read_b64_tr_b16 a[178:179], v26 offset:20480
    v_accvgpr_write_b32 a66, 0
    v_mfma_f32_16x16x32_bf16 v[220:223], a[184:187], a[100:103], v[220:223]
    ds_read_b64_tr_b16 a[180:181], v26 offset:24576
    v_accvgpr_write_b32 a67, 0
    v_mfma_f32_16x16x32_bf16 v[220:223], a[188:191], a[108:111], v[220:223]
    s_waitcnt lgkmcnt(9)
    ds_read_b64_tr_b16 a[182:183], v26 offset:28672
    v_accvgpr_write_b32 a68, 0
    v_mfma_f32_16x16x32_bf16 v[224:227], a[160:163], a[96:99], v[224:227]
    s_waitcnt lgkmcnt(8)
    ds_read_b64_tr_b16 a[184:185], v27 offset:16384
    v_accvgpr_write_b32 a69, 0
    v_mfma_f32_16x16x32_bf16 v[224:227], a[164:167], a[104:107], v[224:227]
    ds_read_b64_tr_b16 a[186:187], v27 offset:20480
    v_accvgpr_write_b32 a70, 0
    v_mfma_f32_16x16x32_bf16 v[228:231], a[160:163], a[100:103], v[228:231]
    ds_read_b64_tr_b16 a[188:189], v27 offset:24576
    v_accvgpr_write_b32 a71, 0
    v_mfma_f32_16x16x32_bf16 v[228:231], a[164:167], a[108:111], v[228:231]
    s_waitcnt lgkmcnt(9)
    ds_read_b64_tr_b16 a[190:191], v27 offset:28672
    v_accvgpr_write_b32 a72, 0
    s_waitcnt vmcnt(16)
    s_barrier
    v_mfma_f32_16x16x32_bf16 v[232:235], a[168:171], a[96:99], v[232:235]
    s_waitcnt lgkmcnt(8)
    ds_read_b64_tr_b16 a[160:161], v20 offset:32768
    v_accvgpr_write_b32 a73, 0
    v_mfma_f32_16x16x32_bf16 v[232:235], a[172:175], a[104:107], v[232:235]
    ds_read_b64_tr_b16 a[162:163], v20 offset:36864
    v_accvgpr_write_b32 a74, 0
    v_mfma_f32_16x16x32_bf16 v[236:239], a[168:171], a[100:103], v[236:239]
    s_add_u32 m0, s42, 0
    ds_read_b64_tr_b16 a[164:165], v20 offset:40960
    v_accvgpr_write_b32 a75, 0
    v_mfma_f32_16x16x32_bf16 v[236:239], a[172:175], a[108:111], v[236:239]
    s_waitcnt lgkmcnt(9)
    buffer_load_dwordx4 v36, s[8:11], s40 offen lds
    v_mfma_f32_16x16x32_bf16 v[240:243], a[176:179], a[96:99], v[240:243]
    s_waitcnt lgkmcnt(7)
    ds_read_b64_tr_b16 a[166:167], v20 offset:45056
    ds_read_b64_tr_b16 a[168:169], v21 offset:32768
    v_mfma_f32_16x16x32_bf16 v[240:243], a[180:183], a[104:107], v[240:243]
    ds_read_b64_tr_b16 a[170:171], v21 offset:36864
    v_accvgpr_write_b32 a76, 0
    v_mfma_f32_16x16x32_bf16 v[244:247], a[176:179], a[100:103], v[244:247]
    ds_read_b64_tr_b16 a[172:173], v21 offset:40960
    v_accvgpr_write_b32 a77, 0
    v_mfma_f32_16x16x32_bf16 v[244:247], a[180:183], a[108:111], v[244:247]
    s_waitcnt lgkmcnt(9)
    buffer_load_dwordx4 v37, s[8:11], s40 offen offset:1024 lds
    v_mfma_f32_16x16x32_bf16 v[248:251], a[184:187], a[96:99], v[248:251]
    s_waitcnt lgkmcnt(7)
    ds_read_b64_tr_b16 a[174:175], v21 offset:45056
    ds_read_b64_tr_b16 a[176:177], v22 offset:32768
    v_mfma_f32_16x16x32_bf16 v[248:251], a[188:191], a[104:107], v[248:251]
    ds_read_b64_tr_b16 a[178:179], v22 offset:36864
    v_accvgpr_write_b32 a78, 0
    v_mfma_f32_16x16x32_bf16 v[252:255], a[184:187], a[100:103], v[252:255]
    ds_read_b64_tr_b16 a[180:181], v22 offset:40960
    v_accvgpr_write_b32 a79, 0
    v_mfma_f32_16x16x32_bf16 v[252:255], a[188:191], a[108:111], v[252:255]
    s_waitcnt vmcnt(17)
    s_waitcnt lgkmcnt(9)
    buffer_load_dwordx4 v38, s[8:11], s40 offen offset:2048 lds
    v_mfma_f32_16x16x32_bf16 v[128:131], a[160:163], a[112:115], v[128:131]
    s_waitcnt vmcnt(17)
    s_waitcnt lgkmcnt(7)
    ds_read_b64_tr_b16 a[182:183], v22 offset:45056
    ds_read_b64_tr_b16 a[184:185], v23 offset:32768
    v_mfma_f32_16x16x32_bf16 v[128:131], a[164:167], a[120:123], v[128:131]
    s_waitcnt vmcnt(16)
    ds_read_b64_tr_b16 a[186:187], v23 offset:36864
    v_accvgpr_write_b32 a80, 0
    v_mfma_f32_16x16x32_bf16 v[132:135], a[160:163], a[116:119], v[132:135]
    s_waitcnt vmcnt(15)
    ds_read_b64_tr_b16 a[188:189], v23 offset:40960
    v_accvgpr_write_b32 a81, 0
    v_mfma_f32_16x16x32_bf16 v[132:135], a[164:167], a[124:127], v[132:135]
    s_waitcnt lgkmcnt(9)
    buffer_load_dwordx4 v39, s[8:11], s40 offen offset:3072 lds
    v_mfma_f32_16x16x32_bf16 v[136:139], a[168:171], a[112:115], v[136:139]
    s_waitcnt lgkmcnt(7)
    s_add_u32 s40, s40, 16384
    ds_read_b64_tr_b16 a[190:191], v23 offset:45056
    ds_read_b64_tr_b16 a[160:161], v24 offset:32768
    v_mfma_f32_16x16x32_bf16 v[136:139], a[172:175], a[120:123], v[136:139]
    ds_read_b64_tr_b16 a[162:163], v24 offset:36864
    v_accvgpr_write_b32 a82, 0
    v_mfma_f32_16x16x32_bf16 v[140:143], a[168:171], a[116:119], v[140:143]
    s_add_u32 m0, s42, 16384
    ds_read_b64_tr_b16 a[164:165], v24 offset:40960
    v_accvgpr_write_b32 a83, 0
    v_mfma_f32_16x16x32_bf16 v[140:143], a[172:175], a[124:127], v[140:143]
    s_waitcnt lgkmcnt(9)
    buffer_load_dwordx4 v36, s[8:11], s40 offen lds
    v_mfma_f32_16x16x32_bf16 v[144:147], a[176:179], a[112:115], v[144:147]
    s_waitcnt lgkmcnt(7)
    ds_read_b64_tr_b16 a[166:167], v24 offset:45056
    ds_read_b64_tr_b16 a[168:169], v25 offset:32768
    v_mfma_f32_16x16x32_bf16 v[144:147], a[180:183], a[120:123], v[144:147]
    ds_read_b64_tr_b16 a[170:171], v25 offset:36864
    v_accvgpr_write_b32 a84, 0
    v_mfma_f32_16x16x32_bf16 v[148:151], a[176:179], a[116:119], v[148:151]
    ds_read_b64_tr_b16 a[172:173], v25 offset:40960
    v_accvgpr_write_b32 a85, 0
    v_mfma_f32_16x16x32_bf16 v[148:151], a[180:183], a[124:127], v[148:151]
    s_waitcnt lgkmcnt(9)
    buffer_load_dwordx4 v37, s[8:11], s40 offen offset:1024 lds
    v_mfma_f32_16x16x32_bf16 v[152:155], a[184:187], a[112:115], v[152:155]
    s_waitcnt lgkmcnt(7)
    ds_read_b64_tr_b16 a[174:175], v25 offset:45056
    ds_read_b64_tr_b16 a[176:177], v26 offset:32768
    v_mfma_f32_16x16x32_bf16 v[152:155], a[188:191], a[120:123], v[152:155]
    ds_read_b64_tr_b16 a[178:179], v26 offset:36864
    v_accvgpr_write_b32 a86, 0
    v_mfma_f32_16x16x32_bf16 v[156:159], a[184:187], a[116:119], v[156:159]
    ds_read_b64_tr_b16 a[180:181], v26 offset:40960
    v_accvgpr_write_b32 a87, 0
    v_mfma_f32_16x16x32_bf16 v[156:159], a[188:191], a[124:127], v[156:159]
    s_waitcnt lgkmcnt(9)
    buffer_load_dwordx4 v38, s[8:11], s40 offen offset:2048 lds
    v_mfma_f32_16x16x32_bf16 v[160:163], a[160:163], a[112:115], v[160:163]
    s_waitcnt lgkmcnt(7)
    ds_read_b64_tr_b16 a[182:183], v26 offset:45056
    ds_read_b64_tr_b16 a[184:185], v27 offset:32768
    v_mfma_f32_16x16x32_bf16 v[160:163], a[164:167], a[120:123], v[160:163]
    ds_read_b64_tr_b16 a[186:187], v27 offset:36864
    v_accvgpr_write_b32 a88, 0
    v_mfma_f32_16x16x32_bf16 v[164:167], a[160:163], a[116:119], v[164:167]
    ds_read_b64_tr_b16 a[188:189], v27 offset:40960
    v_accvgpr_write_b32 a89, 0
    v_mfma_f32_16x16x32_bf16 v[164:167], a[164:167], a[124:127], v[164:167]
    s_waitcnt lgkmcnt(9)
    buffer_load_dwordx4 v39, s[8:11], s40 offen offset:3072 lds
    v_mfma_f32_16x16x32_bf16 v[168:171], a[168:171], a[112:115], v[168:171]
    s_waitcnt lgkmcnt(7)
    s_add_u32 s40, s40, 16384
    ds_read_b64_tr_b16 a[190:191], v27 offset:45056
    ds_read_b64_tr_b16 a[160:161], v20 offset:49152
    v_mfma_f32_16x16x32_bf16 v[168:171], a[172:175], a[120:123], v[168:171]
    ds_read_b64_tr_b16 a[162:163], v20 offset:53248
    v_accvgpr_write_b32 a90, 0
    v_mfma_f32_16x16x32_bf16 v[172:175], a[168:171], a[116:119], v[172:175]
    ds_read_b64_tr_b16 a[164:165], v20 offset:57344
    v_accvgpr_write_b32 a91, 0
    v_mfma_f32_16x16x32_bf16 v[172:175], a[172:175], a[124:127], v[172:175]
    s_waitcnt lgkmcnt(9)
    buffer_store_dword v76, v72, s[24:27], s92 offen offset:12 sc1
    v_mfma_f32_16x16x32_bf16 v[176:179], a[176:179], a[112:115], v[176:179]
    s_waitcnt lgkmcnt(7)
    ds_read_b64_tr_b16 a[166:167], v20 offset:61440
    ds_read_b64_tr_b16 a[168:169], v21 offset:49152
    v_mfma_f32_16x16x32_bf16 v[176:179], a[180:183], a[120:123], v[176:179]
    ds_read_b64_tr_b16 a[170:171], v21 offset:53248
    v_accvgpr_write_b32 a92, 0
    v_mfma_f32_16x16x32_bf16 v[180:183], a[176:179], a[116:119], v[180:183]
    ds_read_b64_tr_b16 a[172:173], v21 offset:57344
    v_accvgpr_write_b32 a93, 0
    v_mfma_f32_16x16x32_bf16 v[180:183], a[180:183], a[124:127], v[180:183]
    s_waitcnt lgkmcnt(9)
    buffer_store_dwordx4 v[88:91], v74, s[24:27], 0 offen sc1
    v_mfma_f32_16x16x32_bf16 v[184:187], a[184:187], a[112:115], v[184:187]
    s_waitcnt lgkmcnt(7)
    ds_read_b64_tr_b16 a[174:175], v21 offset:61440
    ds_read_b64_tr_b16 a[176:177], v22 offset:49152
    v_mfma_f32_16x16x32_bf16 v[184:187], a[188:191], a[120:123], v[184:187]
    ds_read_b64_tr_b16 a[178:179], v22 offset:53248
    v_accvgpr_write_b32 a94, 0
    v_mfma_f32_16x16x32_bf16 v[188:191], a[184:187], a[116:119], v[188:191]
    ds_read_b64_tr_b16 a[180:181], v22 offset:57344
    v_accvgpr_write_b32 a95, 0
    v_mfma_f32_16x16x32_bf16 v[188:191], a[188:191], a[124:127], v[188:191]
    s_waitcnt lgkmcnt(9)
    ds_read_b64_tr_b16 a[182:183], v22 offset:61440
    v_accvgpr_write_b32 a96, 0
    v_mfma_f32_16x16x32_bf16 v[192:195], a[160:163], a[112:115], v[192:195]
    s_waitcnt lgkmcnt(8)
    ds_read_b64_tr_b16 a[184:185], v23 offset:49152
    v_accvgpr_write_b32 a97, 0
    v_mfma_f32_16x16x32_bf16 v[192:195], a[164:167], a[120:123], v[192:195]
    ds_read_b64_tr_b16 a[186:187], v23 offset:53248
    v_accvgpr_write_b32 a98, 0
    v_mfma_f32_16x16x32_bf16 v[196:199], a[160:163], a[116:119], v[196:199]
    ds_read_b64_tr_b16 a[188:189], v23 offset:57344
    v_accvgpr_write_b32 a99, 0
    v_mfma_f32_16x16x32_bf16 v[196:199], a[164:167], a[124:127], v[196:199]
    s_waitcnt lgkmcnt(9)
    ds_read_b64_tr_b16 a[190:191], v23 offset:61440
    v_accvgpr_write_b32 a100, 0
    v_mfma_f32_16x16x32_bf16 v[200:203], a[168:171], a[112:115], v[200:203]
    s_waitcnt lgkmcnt(8)
    ds_read_b64_tr_b16 a[160:161], v24 offset:49152
    v_accvgpr_write_b32 a101, 0
    v_mfma_f32_16x16x32_bf16 v[200:203], a[172:175], a[120:123], v[200:203]
    ds_read_b64_tr_b16 a[162:163], v24 offset:53248
    v_accvgpr_write_b32 a102, 0
    v_mfma_f32_16x16x32_bf16 v[204:207], a[168:171], a[116:119], v[204:207]
    ds_read_b64_tr_b16 a[164:165], v24 offset:57344
    v_accvgpr_write_b32 a103, 0
    v_mfma_f32_16x16x32_bf16 v[204:207], a[172:175], a[124:127], v[204:207]
    s_waitcnt lgkmcnt(9)
    ds_read_b64_tr_b16 a[166:167], v24 offset:61440
    v_accvgpr_write_b32 a104, 0
    v_mfma_f32_16x16x32_bf16 v[208:211], a[176:179], a[112:115], v[208:211]
    s_waitcnt lgkmcnt(8)
    ds_read_b64_tr_b16 a[168:169], v25 offset:49152
    v_accvgpr_write_b32 a105, 0
    v_mfma_f32_16x16x32_bf16 v[208:211], a[180:183], a[120:123], v[208:211]
    ds_read_b64_tr_b16 a[170:171], v25 offset:53248
    v_accvgpr_write_b32 a106, 0
    v_mfma_f32_16x16x32_bf16 v[212:215], a[176:179], a[116:119], v[212:215]
    ds_read_b64_tr_b16 a[172:173], v25 offset:57344
    v_accvgpr_write_b32 a107, 0
    v_mfma_f32_16x16x32_bf16 v[212:215], a[180:183], a[124:127], v[212:215]
    s_waitcnt lgkmcnt(9)
    ds_read_b64_tr_b16 a[174:175], v25 offset:61440
    v_accvgpr_write_b32 a108, 0
    v_mfma_f32_16x16x32_bf16 v[216:219], a[184:187], a[112:115], v[216:219]
    s_waitcnt lgkmcnt(8)
    ds_read_b64_tr_b16 a[176:177], v26 offset:49152
    v_accvgpr_write_b32 a109, 0
    v_mfma_f32_16x16x32_bf16 v[216:219], a[188:191], a[120:123], v[216:219]
    ds_read_b64_tr_b16 a[178:179], v26 offset:53248
    v_accvgpr_write_b32 a110, 0
    v_mfma_f32_16x16x32_bf16 v[220:223], a[184:187], a[116:119], v[220:223]
    ds_read_b64_tr_b16 a[180:181], v26 offset:57344
    v_accvgpr_write_b32 a111, 0
    v_mfma_f32_16x16x32_bf16 v[220:223], a[188:191], a[124:127], v[220:223]
    s_waitcnt lgkmcnt(9)
    ds_read_b64_tr_b16 a[182:183], v26 offset:61440
    v_accvgpr_write_b32 a192, 0
    v_mfma_f32_16x16x32_bf16 v[224:227], a[160:163], a[112:115], v[224:227]
    s_waitcnt lgkmcnt(8)
    ds_read_b64_tr_b16 a[184:185], v27 offset:49152
    v_accvgpr_write_b32 a193, 0
    v_mfma_f32_16x16x32_bf16 v[224:227], a[164:167], a[120:123], v[224:227]
    ds_read_b64_tr_b16 a[186:187], v27 offset:53248
    v_accvgpr_write_b32 a194, 0
    v_mfma_f32_16x16x32_bf16 v[228:231], a[160:163], a[116:119], v[228:231]
    ds_read_b64_tr_b16 a[188:189], v27 offset:57344
    v_accvgpr_write_b32 a195, 0
    v_mfma_f32_16x16x32_bf16 v[228:231], a[164:167], a[124:127], v[228:231]
    s_waitcnt lgkmcnt(9)
    ds_read_b64_tr_b16 a[190:191], v27 offset:61440
    v_accvgpr_write_b32 a196, 0
    s_waitcnt vmcnt(14)
    s_barrier
    v_mfma_f32_16x16x32_bf16 v[232:235], a[168:171], a[112:115], v[232:235]
    s_waitcnt lgkmcnt(8)
    ds_read_b64_tr_b16 a[160:161], v28 offset:0
    v_accvgpr_write_b32 a197, 0
    v_mfma_f32_16x16x32_bf16 v[232:235], a[172:175], a[120:123], v[232:235]
    ds_read_b64_tr_b16 a[162:163], v28 offset:4096
    v_accvgpr_write_b32 a198, 0
    v_mfma_f32_16x16x32_bf16 v[236:239], a[168:171], a[116:119], v[236:239]
    s_add_u32 m0, s42, 32768
    ds_read_b64_tr_b16 a[164:165], v28 offset:8192
    v_accvgpr_write_b32 a199, 0
    v_mfma_f32_16x16x32_bf16 v[236:239], a[172:175], a[124:127], v[236:239]
    s_waitcnt lgkmcnt(9)
    buffer_load_dwordx4 v36, s[8:11], s40 offen lds
    v_mfma_f32_16x16x32_bf16 v[240:243], a[176:179], a[112:115], v[240:243]
    s_waitcnt lgkmcnt(7)
    ds_read_b64_tr_b16 a[166:167], v28 offset:12288
    ds_read_b64_tr_b16 a[168:169], v29 offset:0
    v_mfma_f32_16x16x32_bf16 v[240:243], a[180:183], a[120:123], v[240:243]
    ds_read_b64_tr_b16 a[170:171], v29 offset:4096
    v_accvgpr_write_b32 a200, 0
    v_mfma_f32_16x16x32_bf16 v[244:247], a[176:179], a[116:119], v[244:247]
    ds_read_b64_tr_b16 a[172:173], v29 offset:8192
    v_accvgpr_write_b32 a201, 0
    v_mfma_f32_16x16x32_bf16 v[244:247], a[180:183], a[124:127], v[244:247]
    s_waitcnt lgkmcnt(9)
    buffer_load_dwordx4 v37, s[8:11], s40 offen offset:1024 lds
    v_mfma_f32_16x16x32_bf16 v[248:251], a[184:187], a[112:115], v[248:251]
    s_waitcnt lgkmcnt(7)
    ds_read_b64_tr_b16 a[174:175], v29 offset:12288
    ds_read_b64_tr_b16 a[176:177], v30 offset:0
    v_mfma_f32_16x16x32_bf16 v[248:251], a[188:191], a[120:123], v[248:251]
    ds_read_b64_tr_b16 a[178:179], v30 offset:4096
    v_accvgpr_write_b32 a202, 0
    v_mfma_f32_16x16x32_bf16 v[252:255], a[184:187], a[116:119], v[252:255]
    ds_read_b64_tr_b16 a[180:181], v30 offset:8192
    v_accvgpr_write_b32 a203, 0
    v_mfma_f32_16x16x32_bf16 v[252:255], a[188:191], a[124:127], v[252:255]
    s_waitcnt vmcnt(15)
    s_waitcnt lgkmcnt(9)
    buffer_load_dwordx4 v38, s[8:11], s40 offen offset:2048 lds
    v_mfma_f32_16x16x32_bf16 v[128:131], a[160:163], a[128:131], v[128:131]
    s_waitcnt vmcnt(15)
    s_waitcnt lgkmcnt(7)
    ds_read_b64_tr_b16 a[182:183], v30 offset:12288
    ds_read_b64_tr_b16 a[184:185], v31 offset:0
    v_mfma_f32_16x16x32_bf16 v[128:131], a[164:167], a[136:139], v[128:131]
    s_waitcnt vmcnt(14)
    ds_read_b64_tr_b16 a[186:187], v31 offset:4096
    v_accvgpr_write_b32 a204, 0
    v_mfma_f32_16x16x32_bf16 v[132:135], a[160:163], a[132:135], v[132:135]
    s_waitcnt vmcnt(13)
    ds_read_b64_tr_b16 a[188:189], v31 offset:8192
    v_accvgpr_write_b32 a205, 0
    v_mfma_f32_16x16x32_bf16 v[132:135], a[164:167], a[140:143], v[132:135]
    s_waitcnt lgkmcnt(9)
    buffer_load_dwordx4 v39, s[8:11], s40 offen offset:3072 lds
    v_mfma_f32_16x16x32_bf16 v[136:139], a[168:171], a[128:131], v[136:139]
    s_waitcnt lgkmcnt(7)
    s_add_u32 s40, s40, 16384
    ds_read_b64_tr_b16 a[190:191], v31 offset:12288
    ds_read_b64_tr_b16 a[160:161], v32 offset:0
    v_mfma_f32_16x16x32_bf16 v[136:139], a[172:175], a[136:139], v[136:139]
    ds_read_b64_tr_b16 a[162:163], v32 offset:4096
    v_accvgpr_write_b32 a206, 0
    v_mfma_f32_16x16x32_bf16 v[140:143], a[168:171], a[132:135], v[140:143]
    s_add_u32 m0, s42, 65536
    ds_read_b64_tr_b16 a[164:165], v32 offset:8192
    v_accvgpr_write_b32 a207, 0
    v_mfma_f32_16x16x32_bf16 v[140:143], a[172:175], a[140:143], v[140:143]
    s_waitcnt lgkmcnt(9)
    buffer_load_dwordx4 v40, s[12:15], s41 offen lds
    v_mfma_f32_16x16x32_bf16 v[144:147], a[176:179], a[128:131], v[144:147]
    s_waitcnt lgkmcnt(7)
    ds_read_b64_tr_b16 a[166:167], v32 offset:12288
    ds_read_b64_tr_b16 a[168:169], v33 offset:0
    v_mfma_f32_16x16x32_bf16 v[144:147], a[180:183], a[136:139], v[144:147]
    ds_read_b64_tr_b16 a[170:171], v33 offset:4096
    v_accvgpr_write_b32 a112, 0
    v_mfma_f32_16x16x32_bf16 v[148:151], a[176:179], a[132:135], v[148:151]
    ds_read_b64_tr_b16 a[172:173], v33 offset:8192
    v_accvgpr_write_b32 a113, 0
    v_mfma_f32_16x16x32_bf16 v[148:151], a[180:183], a[140:143], v[148:151]
    s_waitcnt lgkmcnt(9)
    buffer_load_dwordx4 v41, s[12:15], s41 offen offset:1024 lds
    v_mfma_f32_16x16x32_bf16 v[152:155], a[184:187], a[128:131], v[152:155]
    s_waitcnt lgkmcnt(7)
    ds_read_b64_tr_b16 a[174:175], v33 offset:12288
    ds_read_b64_tr_b16 a[176:177], v34 offset:0
    v_mfma_f32_16x16x32_bf16 v[152:155], a[188:191], a[136:139], v[152:155]
    ds_read_b64_tr_b16 a[178:179], v34 offset:4096
    v_accvgpr_write_b32 a114, 0
    v_mfma_f32_16x16x32_bf16 v[156:159], a[184:187], a[132:135], v[156:159]
    ds_read_b64_tr_b16 a[180:181], v34 offset:8192
    v_accvgpr_write_b32 a115, 0
    v_mfma_f32_16x16x32_bf16 v[156:159], a[188:191], a[140:143], v[156:159]
    s_waitcnt lgkmcnt(9)
    buffer_load_dwordx4 v40, s[12:15], s41 offen offset:2048 lds
    v_mfma_f32_16x16x32_bf16 v[160:163], a[160:163], a[128:131], v[160:163]
    s_waitcnt lgkmcnt(7)
    ds_read_b64_tr_b16 a[182:183], v34 offset:12288
    ds_read_b64_tr_b16 a[184:185], v35 offset:0
    v_mfma_f32_16x16x32_bf16 v[160:163], a[164:167], a[136:139], v[160:163]
    ds_read_b64_tr_b16 a[186:187], v35 offset:4096
    v_accvgpr_write_b32 a116, 0
    v_mfma_f32_16x16x32_bf16 v[164:167], a[160:163], a[132:135], v[164:167]
    ds_read_b64_tr_b16 a[188:189], v35 offset:8192
    v_accvgpr_write_b32 a117, 0
    v_mfma_f32_16x16x32_bf16 v[164:167], a[164:167], a[140:143], v[164:167]
    s_waitcnt lgkmcnt(9)
    buffer_load_dwordx4 v41, s[12:15], s41 offen offset:3072 lds
    v_mfma_f32_16x16x32_bf16 v[168:171], a[168:171], a[128:131], v[168:171]
    s_waitcnt lgkmcnt(7)
    s_add_u32 s41, s41, 16384
    ds_read_b64_tr_b16 a[190:191], v35 offset:12288
    ds_read_b64_tr_b16 a[160:161], v28 offset:16384
    v_mfma_f32_16x16x32_bf16 v[168:171], a[172:175], a[136:139], v[168:171]
    ds_read_b64_tr_b16 a[162:163], v28 offset:20480
    v_accvgpr_write_b32 a118, 0
    v_mfma_f32_16x16x32_bf16 v[172:175], a[168:171], a[132:135], v[172:175]
    s_add_u32 m0, s42, 81920
    ds_read_b64_tr_b16 a[164:165], v28 offset:24576
    v_accvgpr_write_b32 a119, 0
    v_mfma_f32_16x16x32_bf16 v[172:175], a[172:175], a[140:143], v[172:175]
    s_waitcnt lgkmcnt(9)
    buffer_load_dwordx4 v40, s[12:15], s41 offen lds
    v_mfma_f32_16x16x32_bf16 v[176:179], a[176:179], a[128:131], v[176:179]
    s_waitcnt lgkmcnt(7)
    ds_read_b64_tr_b16 a[166:167], v28 offset:28672
    ds_read_b64_tr_b16 a[168:169], v29 offset:16384
    v_mfma_f32_16x16x32_bf16 v[176:179], a[180:183], a[136:139], v[176:179]
    ds_read_b64_tr_b16 a[170:171], v29 offset:20480
    v_accvgpr_write_b32 a120, 0
    v_mfma_f32_16x16x32_bf16 v[180:183], a[176:179], a[132:135], v[180:183]
    ds_read_b64_tr_b16 a[172:173], v29 offset:24576
    v_accvgpr_write_b32 a121, 0
    v_mfma_f32_16x16x32_bf16 v[180:183], a[180:183], a[140:143], v[180:183]
    s_waitcnt lgkmcnt(9)
    buffer_load_dwordx4 v41, s[12:15], s41 offen offset:1024 lds
    v_mfma_f32_16x16x32_bf16 v[184:187], a[184:187], a[128:131], v[184:187]
    s_waitcnt lgkmcnt(7)
    ds_read_b64_tr_b16 a[174:175], v29 offset:28672
    ds_read_b64_tr_b16 a[176:177], v30 offset:16384
    v_mfma_f32_16x16x32_bf16 v[184:187], a[188:191], a[136:139], v[184:187]
    ds_read_b64_tr_b16 a[178:179], v30 offset:20480
    v_accvgpr_write_b32 a122, 0
    v_mfma_f32_16x16x32_bf16 v[188:191], a[184:187], a[132:135], v[188:191]
    ds_read_b64_tr_b16 a[180:181], v30 offset:24576
    v_accvgpr_write_b32 a123, 0
    v_mfma_f32_16x16x32_bf16 v[188:191], a[188:191], a[140:143], v[188:191]
    s_waitcnt lgkmcnt(9)
    buffer_load_dwordx4 v40, s[12:15], s41 offen offset:2048 lds
    v_mfma_f32_16x16x32_bf16 v[192:195], a[160:163], a[128:131], v[192:195]
    s_waitcnt lgkmcnt(7)
    ds_read_b64_tr_b16 a[182:183], v30 offset:28672
    ds_read_b64_tr_b16 a[184:185], v31 offset:16384
    v_mfma_f32_16x16x32_bf16 v[192:195], a[164:167], a[136:139], v[192:195]
    ds_read_b64_tr_b16 a[186:187], v31 offset:20480
    v_accvgpr_write_b32 a124, 0
    v_mfma_f32_16x16x32_bf16 v[196:199], a[160:163], a[132:135], v[196:199]
    ds_read_b64_tr_b16 a[188:189], v31 offset:24576
    v_accvgpr_write_b32 a125, 0
    v_mfma_f32_16x16x32_bf16 v[196:199], a[164:167], a[140:143], v[196:199]
    s_waitcnt lgkmcnt(9)
    buffer_load_dwordx4 v41, s[12:15], s41 offen offset:3072 lds
    v_mfma_f32_16x16x32_bf16 v[200:203], a[168:171], a[128:131], v[200:203]
    s_waitcnt lgkmcnt(7)
    s_add_u32 s41, s41, 16384
    ds_read_b64_tr_b16 a[190:191], v31 offset:28672
    ds_read_b64_tr_b16 a[160:161], v32 offset:16384
    v_mfma_f32_16x16x32_bf16 v[200:203], a[172:175], a[136:139], v[200:203]
    ds_read_b64_tr_b16 a[162:163], v32 offset:20480
    v_accvgpr_write_b32 a126, 0
    v_mfma_f32_16x16x32_bf16 v[204:207], a[168:171], a[132:135], v[204:207]
    ds_read_b64_tr_b16 a[164:165], v32 offset:24576
    v_accvgpr_write_b32 a127, 0
    v_mfma_f32_16x16x32_bf16 v[204:207], a[172:175], a[140:143], v[204:207]
    s_waitcnt lgkmcnt(9)
    ds_read_b64_tr_b16 a[166:167], v32 offset:28672
    v_mfma_f32_16x16x32_bf16 v[208:211], a[176:179], a[128:131], v[208:211]
    s_waitcnt lgkmcnt(8)
    ds_read_b64_tr_b16 a[168:169], v33 offset:16384
    v_mfma_f32_16x16x32_bf16 v[208:211], a[180:183], a[136:139], v[208:211]
    ds_read_b64_tr_b16 a[170:171], v33 offset:20480
    v_mfma_f32_16x16x32_bf16 v[212:215], a[176:179], a[132:135], v[212:215]
    ds_read_b64_tr_b16 a[172:173], v33 offset:24576
    v_mfma_f32_16x16x32_bf16 v[212:215], a[180:183], a[140:143], v[212:215]
    s_waitcnt lgkmcnt(9)
    ds_read_b64_tr_b16 a[174:175], v33 offset:28672
    v_mfma_f32_16x16x32_bf16 v[216:219], a[184:187], a[128:131], v[216:219]
    s_waitcnt lgkmcnt(8)
    ds_read_b64_tr_b16 a[176:177], v34 offset:16384
    v_mfma_f32_16x16x32_bf16 v[216:219], a[188:191], a[136:139], v[216:219]
    ds_read_b64_tr_b16 a[178:179], v34 offset:20480
    v_mfma_f32_16x16x32_bf16 v[220:223], a[184:187], a[132:135], v[220:223]
    ds_read_b64_tr_b16 a[180:181], v34 offset:24576
    v_mfma_f32_16x16x32_bf16 v[220:223], a[188:191], a[140:143], v[220:223]
    s_waitcnt lgkmcnt(9)
    ds_read_b64_tr_b16 a[182:183], v34 offset:28672
    v_mfma_f32_16x16x32_bf16 v[224:227], a[160:163], a[128:131], v[224:227]
    s_waitcnt lgkmcnt(8)
    ds_read_b64_tr_b16 a[184:185], v35 offset:16384
    v_mfma_f32_16x16x32_bf16 v[224:227], a[164:167], a[136:139], v[224:227]
    ds_read_b64_tr_b16 a[186:187], v35 offset:20480
    v_mfma_f32_16x16x32_bf16 v[228:231], a[160:163], a[132:135], v[228:231]
    ds_read_b64_tr_b16 a[188:189], v35 offset:24576
    v_mfma_f32_16x16x32_bf16 v[228:231], a[164:167], a[140:143], v[228:231]
    s_waitcnt lgkmcnt(9)
    ds_read_b64_tr_b16 a[190:191], v35 offset:28672
    v_mfma_f32_16x16x32_bf16 v[232:235], a[168:171], a[128:131], v[232:235]
    s_waitcnt lgkmcnt(8)
    v_mfma_f32_16x16x32_bf16 v[232:235], a[172:175], a[136:139], v[232:235]
    v_mfma_f32_16x16x32_bf16 v[236:239], a[168:171], a[132:135], v[236:239]
    v_mfma_f32_16x16x32_bf16 v[236:239], a[172:175], a[140:143], v[236:239]
    s_waitcnt lgkmcnt(6)
    s_waitcnt vmcnt(18)
    s_barrier
    v_mfma_f32_16x16x32_bf16 v[240:243], a[176:179], a[128:131], v[240:243]
    s_waitcnt lgkmcnt(4)
    ds_read_b128 a[208:211], v8 offset:0
    v_mfma_f32_16x16x32_bf16 v[240:243], a[180:183], a[136:139], v[240:243]
    ds_read_b128 a[212:215], v9 offset:0
    v_mfma_f32_16x16x32_bf16 v[244:247], a[176:179], a[132:135], v[244:247]
    ds_read_b128 a[216:219], v10 offset:0
    v_mfma_f32_16x16x32_bf16 v[244:247], a[180:183], a[140:143], v[244:247]
    s_waitcnt lgkmcnt(5)
    ds_read_b128 a[220:223], v11 offset:0
    v_mfma_f32_16x16x32_bf16 v[248:251], a[184:187], a[128:131], v[248:251]
    s_waitcnt lgkmcnt(4)
    ds_read_b128 a[224:227], v8 offset:4096
    v_mfma_f32_16x16x32_bf16 v[248:251], a[188:191], a[136:139], v[248:251]
    v_mfma_f32_16x16x32_bf16 v[252:255], a[184:187], a[132:135], v[252:255]
    s_load_dwordx2 s[16:17], s[0:1], 88
    v_mfma_f32_16x16x32_bf16 v[252:255], a[188:191], a[140:143], v[252:255]
    s_mov_b32 s36, 1040356334
    s_mov_b32 s37, 1040356334
    v_pk_mul_f32 v[128:129], v[128:129], s[36:37]
    v_pk_mul_f32 v[130:131], v[130:131], s[36:37]
    v_pk_mul_f32 v[136:137], v[136:137], s[36:37]
    v_pk_mul_f32 v[138:139], v[138:139], s[36:37]
    v_cvt_pk_bf16_f32 v64, v128, v129
    v_cvt_pk_bf16_f32 v65, v130, v131
    v_cvt_pk_bf16_f32 v66, v136, v137
    v_cvt_pk_bf16_f32 v67, v138, v139
    v_pk_mul_f32 v[132:133], v[132:133], s[36:37]
    v_pk_mul_f32 v[134:135], v[134:135], s[36:37]
    v_pk_mul_f32 v[140:141], v[140:141], s[36:37]
    v_pk_mul_f32 v[142:143], v[142:143], s[36:37]
    v_cvt_pk_bf16_f32 v80, v132, v133
    v_cvt_pk_bf16_f32 v81, v134, v135
    v_cvt_pk_bf16_f32 v82, v140, v141
    v_cvt_pk_bf16_f32 v83, v142, v143
    v_permlane32_swap_b32 v64, v66
    v_permlane32_swap_b32 v65, v67
    v_permlane32_swap_b32 v80, v82
    v_permlane32_swap_b32 v81, v83
    v_permlane16_swap_b32 v64, v66
    v_permlane16_swap_b32 v65, v67
    v_permlane16_swap_b32 v80, v82
    v_permlane16_swap_b32 v81, v83
    v_pk_mul_f32 v[144:145], v[144:145], s[36:37]
    v_pk_mul_f32 v[146:147], v[146:147], s[36:37]
    v_pk_mul_f32 v[152:153], v[152:153], s[36:37]
    v_pk_mul_f32 v[154:155], v[154:155], s[36:37]
    v_cvt_pk_bf16_f32 v68, v144, v145
    v_cvt_pk_bf16_f32 v69, v146, v147
    v_cvt_pk_bf16_f32 v70, v152, v153
    v_cvt_pk_bf16_f32 v71, v154, v155
    v_pk_mul_f32 v[148:149], v[148:149], s[36:37]
    v_pk_mul_f32 v[150:151], v[150:151], s[36:37]
    v_pk_mul_f32 v[156:157], v[156:157], s[36:37]
    v_pk_mul_f32 v[158:159], v[158:159], s[36:37]
    v_cvt_pk_bf16_f32 v84, v148, v149
    v_cvt_pk_bf16_f32 v85, v150, v151
    v_cvt_pk_bf16_f32 v86, v156, v157
    v_cvt_pk_bf16_f32 v87, v158, v159
    v_permlane32_swap_b32 v68, v70
    v_permlane32_swap_b32 v69, v71
    v_permlane32_swap_b32 v84, v86
    v_permlane32_swap_b32 v85, v87
    v_permlane16_swap_b32 v68, v70
    v_permlane16_swap_b32 v69, v71
    v_permlane16_swap_b32 v84, v86
    v_permlane16_swap_b32 v85, v87
    v_pk_mul_f32 v[160:161], v[160:161], s[36:37]
    v_pk_mul_f32 v[162:163], v[162:163], s[36:37]
    v_pk_mul_f32 v[168:169], v[168:169], s[36:37]
    v_pk_mul_f32 v[170:171], v[170:171], s[36:37]
    v_cvt_pk_bf16_f32 v72, v160, v161
    v_cvt_pk_bf16_f32 v73, v162, v163
    v_cvt_pk_bf16_f32 v74, v168, v169
    v_cvt_pk_bf16_f32 v75, v170, v171
    v_pk_mul_f32 v[164:165], v[164:165], s[36:37]
    v_pk_mul_f32 v[166:167], v[166:167], s[36:37]
    v_pk_mul_f32 v[172:173], v[172:173], s[36:37]
    v_pk_mul_f32 v[174:175], v[174:175], s[36:37]
    v_cvt_pk_bf16_f32 v88, v164, v165
    v_cvt_pk_bf16_f32 v89, v166, v167
    v_cvt_pk_bf16_f32 v90, v172, v173
    v_cvt_pk_bf16_f32 v91, v174, v175
    v_permlane32_swap_b32 v72, v74
    v_permlane32_swap_b32 v73, v75
    v_permlane32_swap_b32 v88, v90
    v_permlane32_swap_b32 v89, v91
    v_permlane16_swap_b32 v72, v74
    v_permlane16_swap_b32 v73, v75
    v_permlane16_swap_b32 v88, v90
    v_permlane16_swap_b32 v89, v91
    v_pk_mul_f32 v[176:177], v[176:177], s[36:37]
    v_pk_mul_f32 v[178:179], v[178:179], s[36:37]
Ltour3:
    s_cbranch_execz Ltour7
    v_pk_mul_f32 v[184:185], v[184:185], s[36:37]
    v_pk_mul_f32 v[186:187], v[186:187], s[36:37]
    v_cvt_pk_bf16_f32 v76, v176, v177
    v_cvt_pk_bf16_f32 v77, v178, v179
    v_cvt_pk_bf16_f32 v78, v184, v185
    v_cvt_pk_bf16_f32 v79, v186, v187
    v_pk_mul_f32 v[180:181], v[180:181], s[36:37]
    v_pk_mul_f32 v[182:183], v[182:183], s[36:37]
    v_pk_mul_f32 v[188:189], v[188:189], s[36:37]
    v_pk_mul_f32 v[190:191], v[190:191], s[36:37]
    v_cvt_pk_bf16_f32 v92, v180, v181
    v_cvt_pk_bf16_f32 v93, v182, v183
    v_cvt_pk_bf16_f32 v94, v188, v189
    v_cvt_pk_bf16_f32 v95, v190, v191
    v_permlane32_swap_b32 v76, v78
    v_permlane32_swap_b32 v77, v79
    v_permlane32_swap_b32 v92, v94
    v_permlane32_swap_b32 v93, v95
    v_permlane16_swap_b32 v76, v78
    v_permlane16_swap_b32 v77, v79
    v_permlane16_swap_b32 v92, v94
    v_permlane16_swap_b32 v93, v95
    v_pk_mul_f32 v[192:193], v[192:193], s[36:37]
    v_pk_mul_f32 v[194:195], v[194:195], s[36:37]
    v_pk_mul_f32 v[200:201], v[200:201], s[36:37]
    v_pk_mul_f32 v[202:203], v[202:203], s[36:37]
    v_cvt_pk_bf16_f32 v96, v192, v193
    v_cvt_pk_bf16_f32 v97, v194, v195
    v_cvt_pk_bf16_f32 v98, v200, v201
    v_cvt_pk_bf16_f32 v99, v202, v203
    v_pk_mul_f32 v[196:197], v[196:197], s[36:37]
    v_pk_mul_f32 v[198:199], v[198:199], s[36:37]
    v_pk_mul_f32 v[204:205], v[204:205], s[36:37]
    v_pk_mul_f32 v[206:207], v[206:207], s[36:37]
    v_cvt_pk_bf16_f32 v112, v196, v197
    v_cvt_pk_bf16_f32 v113, v198, v199
    v_cvt_pk_bf16_f32 v114, v204, v205
    v_cvt_pk_bf16_f32 v115, v206, v207
    v_permlane32_swap_b32 v96, v98
    v_permlane32_swap_b32 v97, v99
    v_permlane32_swap_b32 v112, v114
    v_permlane32_swap_b32 v113, v115
    v_permlane16_swap_b32 v96, v98
    v_permlane16_swap_b32 v97, v99
    v_permlane16_swap_b32 v112, v114
    v_permlane16_swap_b32 v113, v115
    v_pk_mul_f32 v[208:209], v[208:209], s[36:37]
    v_pk_mul_f32 v[210:211], v[210:211], s[36:37]
    v_pk_mul_f32 v[216:217], v[216:217], s[36:37]
    v_pk_mul_f32 v[218:219], v[218:219], s[36:37]
    v_cvt_pk_bf16_f32 v100, v208, v209
    v_cvt_pk_bf16_f32 v101, v210, v211
    v_cvt_pk_bf16_f32 v102, v216, v217
    v_cvt_pk_bf16_f32 v103, v218, v219
    v_pk_mul_f32 v[212:213], v[212:213], s[36:37]
    v_pk_mul_f32 v[214:215], v[214:215], s[36:37]
    v_pk_mul_f32 v[220:221], v[220:221], s[36:37]
    v_pk_mul_f32 v[222:223], v[222:223], s[36:37]
    v_cvt_pk_bf16_f32 v116, v212, v213
    v_cvt_pk_bf16_f32 v117, v214, v215
    v_cvt_pk_bf16_f32 v118, v220, v221
    v_cvt_pk_bf16_f32 v119, v222, v223
    v_permlane32_swap_b32 v100, v102
    v_permlane32_swap_b32 v101, v103
    v_permlane32_swap_b32 v116, v118
    v_permlane32_swap_b32 v117, v119
    v_permlane16_swap_b32 v100, v102
    v_permlane16_swap_b32 v101, v103
    v_permlane16_swap_b32 v116, v118
    v_permlane16_swap_b32 v117, v119
    v_pk_mul_f32 v[224:225], v[224:225], s[36:37]
    v_pk_mul_f32 v[226:227], v[226:227], s[36:37]
    v_pk_mul_f32 v[232:233], v[232:233], s[36:37]
    v_pk_mul_f32 v[234:235], v[234:235], s[36:37]
    v_cvt_pk_bf16_f32 v104, v224, v225
    v_cvt_pk_bf16_f32 v105, v226, v227
    v_cvt_pk_bf16_f32 v106, v232, v233
    v_cvt_pk_bf16_f32 v107, v234, v235
    v_pk_mul_f32 v[228:229], v[228:229], s[36:37]
    v_pk_mul_f32 v[230:231], v[230:231], s[36:37]
    v_pk_mul_f32 v[236:237], v[236:237], s[36:37]
    v_pk_mul_f32 v[238:239], v[238:239], s[36:37]
    v_cvt_pk_bf16_f32 v120, v228, v229
    v_cvt_pk_bf16_f32 v121, v230, v231
    v_cvt_pk_bf16_f32 v122, v236, v237
    v_cvt_pk_bf16_f32 v123, v238, v239
    v_permlane32_swap_b32 v104, v106
    v_permlane32_swap_b32 v105, v107
    v_permlane32_swap_b32 v120, v122
    v_permlane32_swap_b32 v121, v123
    v_permlane16_swap_b32 v104, v106
    v_permlane16_swap_b32 v105, v107
    v_permlane16_swap_b32 v120, v122
    v_permlane16_swap_b32 v121, v123
    v_pk_mul_f32 v[240:241], v[240:241], s[36:37]
    v_pk_mul_f32 v[242:243], v[242:243], s[36:37]
    v_pk_mul_f32 v[248:249], v[248:249], s[36:37]
    v_pk_mul_f32 v[250:251], v[250:251], s[36:37]
    v_cvt_pk_bf16_f32 v108, v240, v241
    v_cvt_pk_bf16_f32 v109, v242, v243
    v_cvt_pk_bf16_f32 v110, v248, v249
    v_cvt_pk_bf16_f32 v111, v250, v251
    v_pk_mul_f32 v[244:245], v[244:245], s[36:37]
    v_pk_mul_f32 v[246:247], v[246:247], s[36:37]
    v_pk_mul_f32 v[252:253], v[252:253], s[36:37]
    v_pk_mul_f32 v[254:255], v[254:255], s[36:37]
    v_cvt_pk_bf16_f32 v124, v244, v245
    v_cvt_pk_bf16_f32 v125, v246, v247
    v_cvt_pk_bf16_f32 v126, v252, v253
    v_cvt_pk_bf16_f32 v127, v254, v255
    v_permlane32_swap_b32 v108, v110
    v_permlane32_swap_b32 v109, v111
    v_permlane32_swap_b32 v124, v126
    v_permlane32_swap_b32 v125, v127
    v_permlane16_swap_b32 v108, v110
    v_permlane16_swap_b32 v109, v111
    v_permlane16_swap_b32 v124, v126
    v_permlane16_swap_b32 v125, v127
    s_waitcnt lgkmcnt(0)
    v_mfma_f32_16x16x32_bf16 v[216:219], a[208:211], v[64:67], 0
    v_mfma_f32_16x16x32_bf16 v[216:219], a[212:215], v[68:71], v[216:219]
    v_mfma_f32_16x16x32_bf16 v[216:219], a[216:219], v[72:75], v[216:219]
    v_mfma_f32_16x16x32_bf16 v[216:219], a[220:223], v[76:79], v[216:219]
    v_mfma_f32_16x16x32_bf16 v[220:223], a[208:211], v[80:83], 0
    v_mfma_f32_16x16x32_bf16 v[220:223], a[212:215], v[84:87], v[220:223]
    v_mfma_f32_16x16x32_bf16 v[220:223], a[216:219], v[88:91], v[220:223]
    v_mfma_f32_16x16x32_bf16 v[220:223], a[220:223], v[92:95], v[220:223]
    v_mfma_f32_16x16x32_bf16 v[224:227], a[208:211], v[96:99], 0
    v_mfma_f32_16x16x32_bf16 v[224:227], a[212:215], v[100:103], v[224:227]
    v_mfma_f32_16x16x32_bf16 v[224:227], a[216:219], v[104:107], v[224:227]
    v_mfma_f32_16x16x32_bf16 v[224:227], a[220:223], v[108:111], v[224:227]
    v_mfma_f32_16x16x32_bf16 v[228:231], a[208:211], v[112:115], 0
    v_mfma_f32_16x16x32_bf16 v[228:231], a[212:215], v[116:119], v[228:231]
    v_mfma_f32_16x16x32_bf16 v[228:231], a[216:219], v[120:123], v[228:231]
    v_mfma_f32_16x16x32_bf16 v[228:231], a[220:223], v[124:127], v[228:231]
    v_max3_f32 v232, v216, v217, v218
    v_max_f32 v232, v232, v219
    v_max3_f32 v233, v220, v221, v222
    v_max_f32 v233, v233, v223
    v_max3_f32 v234, v224, v225, v226
    v_max_f32 v234, v234, v227
    s_nop 1
    v_max3_f32 v235, v228, v229, v230
    v_max_f32 v235, v235, v231
    v_mov_b32 v236, v232
    v_mov_b32 v237, v233
    v_mov_b32 v238, v234
    v_mov_b32 v239, v235
    v_permlane16_swap_b32 v232, v236
    v_permlane16_swap_b32 v233, v237
    v_permlane16_swap_b32 v234, v238
    v_permlane16_swap_b32 v235, v239
    v_max_f32 v232, v232, v236
    v_max_f32 v233, v233, v237
    v_max_f32 v234, v234, v238
    v_max_f32 v235, v235, v239
    v_mov_b32 v236, v232
    v_mov_b32 v237, v233
    v_mov_b32 v238, v234
    v_mov_b32 v239, v235
    v_permlane32_swap_b32 v232, v236
    v_permlane32_swap_b32 v233, v237
    v_permlane32_swap_b32 v234, v238
    v_permlane32_swap_b32 v235, v239
    v_max_f32 v232, v232, v236
    v_max_f32 v233, v233, v237
    v_max_f32 v234, v234, v238
    v_max_f32 v235, v235, v239
    v_sub_f32 v192, 3250585600, v232
    v_sub_f32 v193, 3250585600, v232
    v_sub_f32 v194, 3250585600, v232
    v_sub_f32 v195, 3250585600, v232
    v_sub_f32 v196, 3250585600, v233
    v_sub_f32 v197, 3250585600, v233
    v_sub_f32 v198, 3250585600, v233
    v_sub_f32 v199, 3250585600, v233
    v_sub_f32 v200, 3250585600, v234
    v_sub_f32 v201, 3250585600, v234
    v_sub_f32 v202, 3250585600, v234
    v_sub_f32 v203, 3250585600, v234
    v_sub_f32 v204, 3250585600, v235
    v_sub_f32 v205, 3250585600, v235
    v_sub_f32 v206, 3250585600, v235
    v_sub_f32 v207, 3250585600, v235
Lattn_stage0:
    s_mov_b32 s43, 7
    v_mfma_f32_16x16x32_bf16 v[208:211], a[208:211], v[64:67], v[192:195]
    s_lshl_b32 s53, s5, 4
    v_mfma_f32_16x16x32_bf16 v[208:211], a[212:215], v[68:71], v[208:211]
    s_add_u32 s53, s53, s4
    v_mfma_f32_16x16x32_bf16 v[208:211], a[216:219], v[72:75], v[208:211]
    s_lshl_b32 s53, s53, 2
    v_mfma_f32_16x16x32_bf16 v[208:211], a[220:223], v[76:79], v[208:211]
    s_add_u32 s53, s53, s3
    ds_read_b128 a[228:231], v9 offset:4096
    v_mfma_f32_16x16x32_bf16 v[212:215], a[208:211], v[80:83], v[196:199]
    s_mul_i32 s53, s53, 4608
    s_nop 3
    v_exp_f32 v208, v208
    v_mfma_f32_16x16x32_bf16 v[212:215], a[212:215], v[84:87], v[212:215]
    s_add_u32 s53, s53, 2621440
    v_exp_f32 v209, v209
    v_mfma_f32_16x16x32_bf16 v[212:215], a[216:219], v[88:91], v[212:215]
    s_lshr_b32 s44, s2, 5
    v_exp_f32 v210, v210
    v_mfma_f32_16x16x32_bf16 v[212:215], a[220:223], v[92:95], v[212:215]
    s_lshl_b32 s44, s44, 3
    v_exp_f32 v211, v211
    v_cvt_pk_bf16_f32 v128, v208, v209
    ds_read_b128 a[232:235], v10 offset:4096
    v_cvt_pk_bf16_f32 v129, v210, v211
    v_mfma_f32_16x16x32_bf16 v[208:211], a[208:211], v[96:99], v[200:203]
    s_and_b32 s37, s2, 7
    s_nop 0
    v_exp_f32 v212, v212
    v_mfma_f32_16x16x32_bf16 v[208:211], a[212:215], v[100:103], v[208:211]
    s_add_u32 s44, s44, s37
    v_exp_f32 v213, v213
    v_mfma_f32_16x16x32_bf16 v[208:211], a[216:219], v[104:107], v[208:211]
    s_lshl_b32 s44, s44, 2
    v_exp_f32 v214, v214
    v_mfma_f32_16x16x32_bf16 v[208:211], a[220:223], v[108:111], v[208:211]
    s_bfe_u32 s37, s2, 0x20003
    v_exp_f32 v215, v215
    v_cvt_pk_bf16_f32 v136, v212, v213
    ds_read_b128 a[236:239], v11 offset:4096
    v_cvt_pk_bf16_f32 v137, v214, v215
    v_mfma_f32_16x16x32_bf16 v[212:215], a[208:211], v[112:115], v[204:207]
    s_add_u32 s44, s44, s37
    s_nop 0
    v_exp_f32 v208, v208
    v_mfma_f32_16x16x32_bf16 v[212:215], a[212:215], v[116:119], v[212:215]
    s_add_u32 s44, s44, 72
    v_exp_f32 v209, v209
    v_mfma_f32_16x16x32_bf16 v[212:215], a[216:219], v[120:123], v[212:215]
    s_cmp_lt_u32 s44, 216
    s_cselect_b32 s37, 0, 2147483648
    v_exp_f32 v210, v210
    v_mfma_f32_16x16x32_bf16 v[212:215], a[220:223], v[124:127], v[212:215]
    s_lshl_b32 s44, s44, 5
    v_exp_f32 v211, v211
    v_cvt_pk_bf16_f32 v144, v208, v209
    ds_read_b128 a[208:211], v8 offset:8192
    v_cvt_pk_bf16_f32 v145, v210, v211
    v_mfma_f32_16x16x32_bf16 v[208:211], a[224:227], v[64:67], v[192:195]
    s_waitcnt lgkmcnt(3)
    s_or_b32 s44, s44, s37
    v_exp_f32 v212, v212
    v_mfma_f32_16x16x32_bf16 v[208:211], a[228:231], v[68:71], v[208:211]
    s_waitcnt lgkmcnt(2)
    s_mov_b32 s18, 3981312
    v_exp_f32 v213, v213
    v_mfma_f32_16x16x32_bf16 v[208:211], a[232:235], v[72:75], v[208:211]
    s_waitcnt lgkmcnt(1)
    s_lshr_b32 s6, s2, 3
    v_exp_f32 v214, v214
    v_mfma_f32_16x16x32_bf16 v[208:211], a[236:239], v[76:79], v[208:211]
    s_and_b32 s7, s2, 7
    v_exp_f32 v215, v215
    v_cvt_pk_bf16_f32 v152, v212, v213
    ds_read_b128 a[212:215], v9 offset:8192
    v_cvt_pk_bf16_f32 v153, v214, v215
    v_mfma_f32_16x16x32_bf16 v[212:215], a[224:227], v[80:83], v[196:199]
    s_mul_i32 s7, s7, 18
    s_nop 0
    v_exp_f32 v208, v208
    v_mfma_f32_16x16x32_bf16 v[212:215], a[228:231], v[84:87], v[212:215]
    s_add_u32 s7, s7, s6
    v_exp_f32 v209, v209
    v_mfma_f32_16x16x32_bf16 v[212:215], a[232:235], v[88:91], v[212:215]
    s_lshl_b32 s58, s7, 6
    v_exp_f32 v210, v210
    v_mfma_f32_16x16x32_bf16 v[212:215], a[236:239], v[92:95], v[212:215]
    s_mul_i32 s59, s7, 36864
    v_exp_f32 v211, v211
    v_cvt_pk_bf16_f32 v130, v208, v209
    ds_read_b128 a[216:219], v10 offset:8192
    v_cvt_pk_bf16_f32 v131, v210, v211
    v_mfma_f32_16x16x32_bf16 v[208:211], a[224:227], v[96:99], v[200:203]
    s_cmp_lt_u32 s6, 18
    s_cselect_b32 s7, 0, 2147483648
    v_exp_f32 v212, v212
    v_mfma_f32_16x16x32_bf16 v[208:211], a[228:231], v[100:103], v[208:211]
    s_or_b32 s58, s58, s7
    v_exp_f32 v213, v213
    v_mfma_f32_16x16x32_bf16 v[208:211], a[232:235], v[104:107], v[208:211]
    s_or_b32 s59, s59, s7
    v_exp_f32 v214, v214
    v_mfma_f32_16x16x32_bf16 v[208:211], a[236:239], v[108:111], v[208:211]
    s_and_b32 s7, s4, 1
    v_exp_f32 v215, v215
    v_cvt_pk_bf16_f32 v138, v212, v213
    ds_read_b128 a[220:223], v11 offset:8192
    v_cvt_pk_bf16_f32 v139, v214, v215
    s_mov_b32 s39, 221184
    s_mov_b32 s38, 27648
    v_mfma_f32_16x16x32_bf16 v[212:215], a[224:227], v[112:115], v[204:207]
    s_lshl_b32 s6, s7, 7
    v_exp_f32 v208, v208
    v_mfma_f32_16x16x32_bf16 v[212:215], a[228:231], v[116:119], v[212:215]
    s_xor_b32 s36, s4, 1
    v_exp_f32 v209, v209
    v_mfma_f32_16x16x32_bf16 v[212:215], a[232:235], v[120:123], v[212:215]
    s_mul_i32 s36, s36, 294912
    v_exp_f32 v210, v210
    v_mfma_f32_16x16x32_bf16 v[212:215], a[236:239], v[124:127], v[212:215]
    s_waitcnt lgkmcnt(3)
    s_add_u32 s46, s36, s6
    v_exp_f32 v211, v211
    v_cvt_pk_bf16_f32 v146, v208, v209
    ds_read_b128 a[224:227], v8 offset:12288
    v_cvt_pk_bf16_f32 v147, v210, v211
    v_mfma_f32_16x16x32_bf16 v[208:211], a[208:211], v[64:67], v[192:195]
    s_waitcnt lgkmcnt(3)
    s_lshl_b32 s36, s4, 8
    v_exp_f32 v212, v212
    v_mfma_f32_16x16x32_bf16 v[208:211], a[212:215], v[68:71], v[208:211]
    s_waitcnt lgkmcnt(2)
    s_add_u32 s56, s47, s36
    v_exp_f32 v213, v213
    v_mfma_f32_16x16x32_bf16 v[208:211], a[216:219], v[72:75], v[208:211]
    s_waitcnt lgkmcnt(1)
    s_lshr_b32 s36, s4, 1
    v_exp_f32 v214, v214
    v_mfma_f32_16x16x32_bf16 v[208:211], a[220:223], v[76:79], v[208:211]
    s_lshl_b32 s36, s36, 11
    v_exp_f32 v215, v215
    v_cvt_pk_bf16_f32 v154, v212, v213
    ds_read_b128 a[228:231], v9 offset:12288
    v_cvt_pk_bf16_f32 v155, v214, v215
    v_mfma_f32_16x16x32_bf16 v[212:215], a[208:211], v[80:83], v[196:199]
    s_lshl_b32 s7, s7, 8
    s_nop 0
    v_exp_f32 v208, v208
    v_mfma_f32_16x16x32_bf16 v[212:215], a[212:215], v[84:87], v[212:215]
    s_add_u32 s36, s36, s7
    v_exp_f32 v209, v209
    v_mfma_f32_16x16x32_bf16 v[212:215], a[216:219], v[88:91], v[212:215]
    s_add_u32 s93, s47, s36
    v_exp_f32 v210, v210
    v_mfma_f32_16x16x32_bf16 v[212:215], a[220:223], v[92:95], v[212:215]
    s_lshr_b32 s36, s4, 1
    v_exp_f32 v211, v211
    v_cvt_pk_bf16_f32 v132, v208, v209
    ds_read_b128 a[232:235], v10 offset:12288
    v_cvt_pk_bf16_f32 v133, v210, v211
    v_mfma_f32_16x16x32_bf16 v[208:211], a[208:211], v[96:99], v[200:203]
    s_lshl_b32 s36, s36, 4
    s_nop 0
    v_exp_f32 v212, v212
    v_mfma_f32_16x16x32_bf16 v[208:211], a[212:215], v[100:103], v[208:211]
    s_add_u32 s36, s36, s5
    v_exp_f32 v213, v213
    v_mfma_f32_16x16x32_bf16 v[208:211], a[216:219], v[104:107], v[208:211]
    s_lshl_b32 s36, s36, 9
    v_exp_f32 v214, v214
    v_mfma_f32_16x16x32_bf16 v[208:211], a[220:223], v[108:111], v[208:211]
    s_add_u32 s36, s36, s7
    v_exp_f32 v215, v215
    v_cvt_pk_bf16_f32 v140, v212, v213
    ds_read_b128 a[236:239], v11 offset:12288
    v_cvt_pk_bf16_f32 v141, v214, v215
    s_waitcnt vmcnt(4)
    s_barrier
    v_mfma_f32_16x16x32_bf16 v[212:215], a[208:211], v[112:115], v[204:207]
    s_lshl_b32 s36, s36, 8
    v_exp_f32 v208, v208
    v_mfma_f32_16x16x32_bf16 v[212:215], a[212:215], v[116:119], v[212:215]
    s_add_u32 m0, s42, 49152
    s_add_u32 s55, s36, 20971520
    v_exp_f32 v209, v209
    v_mfma_f32_16x16x32_bf16 v[212:215], a[216:219], v[120:123], v[212:215]
    s_add_u32 s7, s45, s6
    v_exp_f32 v210, v210
    v_mfma_f32_16x16x32_bf16 v[212:215], a[220:223], v[124:127], v[212:215]
    s_waitcnt lgkmcnt(3)
    s_xor_b32 s54, s92, 128
    v_exp_f32 v211, v211
    v_cvt_pk_bf16_f32 v148, v208, v209
    ds_read_b128 a[208:211], v8 offset:16384
    v_cvt_pk_bf16_f32 v149, v210, v211
    buffer_load_dwordx4 v36, s[8:11], s40 offen lds
    v_mfma_f32_16x16x32_bf16 v[208:211], a[224:227], v[64:67], v[192:195]
    s_waitcnt lgkmcnt(3)
    s_lshl_b32 s36, s3, 14
    v_exp_f32 v212, v212
    v_mfma_f32_16x16x32_bf16 v[208:211], a[228:231], v[68:71], v[208:211]
    s_waitcnt lgkmcnt(2)
    v_exp_f32 v213, v213
    v_mfma_f32_16x16x32_bf16 v[208:211], a[232:235], v[72:75], v[208:211]
    s_waitcnt lgkmcnt(1)
    v_exp_f32 v214, v214
    v_mfma_f32_16x16x32_bf16 v[208:211], a[236:239], v[76:79], v[208:211]
    v_exp_f32 v215, v215
    v_cvt_pk_bf16_f32 v156, v212, v213
    ds_read_b128 a[212:215], v9 offset:16384
    v_cvt_pk_bf16_f32 v157, v214, v215
    v_mfma_f32_16x16x32_bf16 v[212:215], a[224:227], v[80:83], v[196:199]
    s_nop 2
    v_exp_f32 v208, v208
    v_mfma_f32_16x16x32_bf16 v[212:215], a[228:231], v[84:87], v[212:215]
    v_exp_f32 v209, v209
    v_mfma_f32_16x16x32_bf16 v[212:215], a[232:235], v[88:91], v[212:215]
    v_exp_f32 v210, v210
    v_mfma_f32_16x16x32_bf16 v[212:215], a[236:239], v[92:95], v[212:215]
    v_exp_f32 v211, v211
    ds_read_b64_tr_b16 a[160:161], v20 offset:0
    v_cvt_pk_bf16_f32 v134, v208, v209
    v_lshrrev_b32 v51, 2, v0
    v_mul_u32_u24 v51, 9216, v51
    v_and_b32 v254, 3, v0
    v_lshl_add_u32 v254, v254, 4, v51
    v_lshlrev_b32 v255, 4, v0
    v_add_u32 v51, 98304, v255
    v_lshl_add_u32 v252, v1, 4, s36
    v_mov_b32 v224, 0
    v_mov_b32 v225, 0
    v_mov_b32 v226, 0
    v_mov_b32 v227, 0
    v_mov_b32 v228, 0
    v_mov_b32 v229, 0
    v_mov_b32 v230, 0
    v_mov_b32 v231, 0
    v_mov_b32 v248, -1
    v_mov_b32 v249, -1
    v_mov_b32 v250, -1
    v_mov_b32 v251, -1
    v_min_u32 v232, 41, v1
    v_lshlrev_b32 v232, 4, v232
    s_mov_b32 s57, s58
    s_lshl_b32 s6, s3, 10
    s_add_u32 s6, s6, 135168
    s_lshr_b32 s37, s2, 3
    s_mul_i32 s37, s37, -129024
    s_add_u32 s37, s37, 4128768
    ds_read_b64_tr_b16 a[162:163], v20 offset:4096
    ds_read_b128 a[216:219], v10 offset:16384
    v_cvt_pk_bf16_f32 v135, v210, v211
    buffer_load_dwordx4 v37, s[8:11], s40 offen offset:1024 lds
    v_mfma_f32_16x16x32_bf16 v[208:211], a[224:227], v[96:99], v[200:203]
    v_exp_f32 v212, v212
    v_mfma_f32_16x16x32_bf16 v[208:211], a[228:231], v[100:103], v[208:211]
    v_exp_f32 v213, v213
    v_mfma_f32_16x16x32_bf16 v[208:211], a[232:235], v[104:107], v[208:211]
    v_exp_f32 v214, v214
    v_mfma_f32_16x16x32_bf16 v[208:211], a[236:239], v[108:111], v[208:211]
    s_mov_b32 s52, s55
    v_exp_f32 v215, v215
    ds_read_b64_tr_b16 a[164:165], v20 offset:8192
    v_cvt_pk_bf16_f32 v142, v212, v213
    ds_read_b64_tr_b16 a[166:167], v20 offset:12288
    v_min_u32 v237, 19, v1
    v_lshl_add_u32 v237, v237, 7, s36
    v_lshl_add_u32 v238, v1, 7, s36
    ds_read_b128 a[220:223], v11 offset:16384
    v_cvt_pk_bf16_f32 v143, v214, v215
    buffer_load_dword v217, v57, s[32:35], s37 offen
    v_mfma_f32_16x16x32_bf16 v[212:215], a[224:227], v[112:115], v[204:207]
    v_exp_f32 v208, v208
    v_mfma_f32_16x16x32_bf16 v[212:215], a[228:231], v[116:119], v[212:215]
    v_exp_f32 v209, v209
    v_mfma_f32_16x16x32_bf16 v[212:215], a[232:235], v[120:123], v[212:215]
    s_mul_i32 s37, s5, 18432
    v_exp_f32 v210, v210
    v_mfma_f32_16x16x32_bf16 v[212:215], a[236:239], v[124:127], v[212:215]
    s_add_u32 s37, s37, s45
    v_exp_f32 v211, v211
    ds_read_b64_tr_b16 a[168:169], v21 offset:0
    v_cvt_pk_bf16_f32 v150, v208, v209
    ds_read_b64_tr_b16 a[170:171], v21 offset:4096
    v_min_u32 v236, 143, v0
    v_lshl_add_u32 v236, v236, 7, s37
    v_mul_u32_u24 v235, 24, v0
    v_lshrrev_b32 v235, 8, v235
    v_lshl_add_u32 v235, v235, 7, s37
    ds_read_b128 a[224:227], v8 offset:20480
    v_cvt_pk_bf16_f32 v151, v210, v211
    s_waitcnt lgkmcnt(3)
    buffer_load_dwordx4 v38, s[8:11], s40 offen offset:2048 lds
Lattn_loop:
    v_mfma_f32_16x16x32_bf16 v[208:211], a[208:211], v[64:67], v[192:195]
    v_exp_f32 v212, v212
    v_mfma_f32_16x16x32_bf16 v[208:211], a[212:215], v[68:71], v[208:211]
    v_exp_f32 v213, v213
    v_mfma_f32_16x16x32_bf16 v[208:211], a[216:219], v[72:75], v[208:211]
    v_exp_f32 v214, v214
    v_mfma_f32_16x16x32_bf16 v[208:211], a[220:223], v[76:79], v[208:211]
    v_exp_f32 v215, v215
    v_mfma_f32_16x16x32_bf16 a[0:3], a[160:163], v[128:131], a[0:3]
    ds_read_b64_tr_b16 a[172:173], v21 offset:8192
    v_cvt_pk_bf16_f32 v158, v212, v213
    v_mfma_f32_16x16x32_bf16 a[0:3], a[164:167], v[132:135], a[0:3]
    ds_read_b64_tr_b16 a[174:175], v21 offset:12288
    v_mfma_f32_16x16x32_bf16 a[4:7], a[160:163], v[136:139], a[4:7]
    ds_read_b128 a[228:231], v9 offset:20480
    v_cvt_pk_bf16_f32 v159, v214, v215
    v_mfma_f32_16x16x32_bf16 a[4:7], a[164:167], v[140:143], a[4:7]
    v_mfma_f32_16x16x32_bf16 v[212:215], a[208:211], v[80:83], v[196:199]
    v_exp_f32 v208, v208
    v_mfma_f32_16x16x32_bf16 v[212:215], a[212:215], v[84:87], v[212:215]
    v_exp_f32 v209, v209
    v_mfma_f32_16x16x32_bf16 v[212:215], a[216:219], v[88:91], v[212:215]
    v_exp_f32 v210, v210
    v_mfma_f32_16x16x32_bf16 v[212:215], a[220:223], v[92:95], v[212:215]
    v_exp_f32 v211, v211
    v_mfma_f32_16x16x32_bf16 a[8:11], a[160:163], v[144:147], a[8:11]
    ds_read_b64_tr_b16 a[176:177], v22 offset:0
    v_cvt_pk_bf16_f32 v160, v208, v209
    v_mfma_f32_16x16x32_bf16 a[8:11], a[164:167], v[148:151], a[8:11]
    ds_read_b64_tr_b16 a[178:179], v22 offset:4096
    v_mfma_f32_16x16x32_bf16 a[12:15], a[160:163], v[152:155], a[12:15]
    ds_read_b128 a[232:235], v10 offset:20480
    v_cvt_pk_bf16_f32 v161, v210, v211
    v_mfma_f32_16x16x32_bf16 a[12:15], a[164:167], v[156:159], a[12:15]
    s_waitcnt lgkmcnt(3)
    buffer_load_dwordx4 v39, s[8:11], s40 offen offset:3072 lds
    v_mfma_f32_16x16x32_bf16 v[208:211], a[208:211], v[96:99], v[200:203]
    v_exp_f32 v212, v212
    v_mfma_f32_16x16x32_bf16 v[208:211], a[212:215], v[100:103], v[208:211]
    s_add_u32 s40, s40, 16384
    v_exp_f32 v213, v213
    v_mfma_f32_16x16x32_bf16 v[208:211], a[216:219], v[104:107], v[208:211]
    s_mov_b32 m0, s6
    v_exp_f32 v214, v214
    v_mfma_f32_16x16x32_bf16 v[208:211], a[220:223], v[108:111], v[208:211]
    v_exp_f32 v215, v215
    v_mfma_f32_16x16x32_bf16 a[16:19], a[168:171], v[128:131], a[16:19]
    ds_read_b64_tr_b16 a[180:181], v22 offset:8192
    v_cvt_pk_bf16_f32 v168, v212, v213
    v_mfma_f32_16x16x32_bf16 a[16:19], a[172:175], v[132:135], a[16:19]
    ds_read_b64_tr_b16 a[182:183], v22 offset:12288
    v_mfma_f32_16x16x32_bf16 a[20:23], a[168:171], v[136:139], a[20:23]
    ds_read_b128 a[236:239], v11 offset:20480
    v_cvt_pk_bf16_f32 v169, v214, v215
    v_mfma_f32_16x16x32_bf16 a[20:23], a[172:175], v[140:143], a[20:23]
    buffer_load_dwordx4 v254, s[32:35], s57 offen  lds
    v_smfmac_f32_16x16x64_bf16 a[192:195], v[52:55], v[128:135], v50
    v_mfma_f32_16x16x32_bf16 v[212:215], a[208:211], v[112:115], v[204:207]
    v_exp_f32 v208, v208
    v_mfma_f32_16x16x32_bf16 v[212:215], a[212:215], v[116:119], v[212:215]
    s_add_u32 m0, s42, 98304
    v_exp_f32 v209, v209
    v_mfma_f32_16x16x32_bf16 v[212:215], a[216:219], v[120:123], v[212:215]
    v_exp_f32 v210, v210
    v_mfma_f32_16x16x32_bf16 v[212:215], a[220:223], v[124:127], v[212:215]
    v_exp_f32 v211, v211
    v_mfma_f32_16x16x32_bf16 a[24:27], a[168:171], v[144:147], a[24:27]
    ds_read_b64_tr_b16 a[184:185], v23 offset:0
    v_cvt_pk_bf16_f32 v176, v208, v209
    v_mfma_f32_16x16x32_bf16 a[24:27], a[172:175], v[148:151], a[24:27]
    ds_read_b64_tr_b16 a[186:187], v23 offset:4096
    v_mfma_f32_16x16x32_bf16 a[28:31], a[168:171], v[152:155], a[28:31]
    ds_read_b128 a[208:211], v8 offset:24576
    v_cvt_pk_bf16_f32 v177, v210, v211
    v_mfma_f32_16x16x32_bf16 a[28:31], a[172:175], v[156:159], a[28:31]
    s_waitcnt lgkmcnt(3)
    buffer_load_dwordx4 v40, s[12:15], s41 offen lds
    v_mfma_f32_16x16x32_bf16 v[208:211], a[224:227], v[64:67], v[192:195]
    v_exp_f32 v212, v212
    v_mfma_f32_16x16x32_bf16 v[208:211], a[228:231], v[68:71], v[208:211]
    s_add_u32 s6, s6, 4096
    v_exp_f32 v213, v213
    v_mfma_f32_16x16x32_bf16 v[208:211], a[232:235], v[72:75], v[208:211]
    s_add_u32 s57, s57, 589824
    v_exp_f32 v214, v214
    v_mfma_f32_16x16x32_bf16 v[208:211], a[236:239], v[76:79], v[208:211]
    v_exp_f32 v215, v215
    v_mfma_f32_16x16x32_bf16 a[32:35], a[176:179], v[128:131], a[32:35]
    ds_read_b64_tr_b16 a[188:189], v23 offset:8192
    v_cvt_pk_bf16_f32 v184, v212, v213
    v_mfma_f32_16x16x32_bf16 a[32:35], a[180:183], v[132:135], a[32:35]
    ds_read_b64_tr_b16 a[190:191], v23 offset:12288
    v_mfma_f32_16x16x32_bf16 a[36:39], a[176:179], v[136:139], a[36:39]
    ds_read_b128 a[212:215], v9 offset:24576
    v_cvt_pk_bf16_f32 v185, v214, v215
    v_mfma_f32_16x16x32_bf16 a[36:39], a[180:183], v[140:143], a[36:39]
    v_smfmac_f32_16x16x64_bf16 a[196:199], v[52:55], v[136:143], v50
    v_mfma_f32_16x16x32_bf16 v[212:215], a[224:227], v[80:83], v[196:199]
    v_exp_f32 v208, v208
    v_mfma_f32_16x16x32_bf16 v[212:215], a[228:231], v[84:87], v[212:215]
    v_exp_f32 v209, v209
    v_mfma_f32_16x16x32_bf16 v[212:215], a[232:235], v[88:91], v[212:215]
    v_exp_f32 v210, v210
    v_mfma_f32_16x16x32_bf16 v[212:215], a[236:239], v[92:95], v[212:215]
    v_exp_f32 v211, v211
    v_mfma_f32_16x16x32_bf16 a[40:43], a[176:179], v[144:147], a[40:43]
    ds_read_b64_tr_b16 a[160:161], v24 offset:0
    v_cvt_pk_bf16_f32 v162, v208, v209
    v_mfma_f32_16x16x32_bf16 a[40:43], a[180:183], v[148:151], a[40:43]
    ds_read_b64_tr_b16 a[162:163], v24 offset:4096
    v_mfma_f32_16x16x32_bf16 a[44:47], a[176:179], v[152:155], a[44:47]
    ds_read_b128 a[216:219], v10 offset:24576
    v_cvt_pk_bf16_f32 v163, v210, v211
    v_mfma_f32_16x16x32_bf16 a[44:47], a[180:183], v[156:159], a[44:47]
    s_waitcnt lgkmcnt(3)
    buffer_load_dwordx4 v41, s[12:15], s41 offen offset:1024 lds
    v_mfma_f32_16x16x32_bf16 v[208:211], a[224:227], v[96:99], v[200:203]
    v_exp_f32 v212, v212
    v_mfma_f32_16x16x32_bf16 v[208:211], a[228:231], v[100:103], v[208:211]
    v_exp_f32 v213, v213
    v_mfma_f32_16x16x32_bf16 v[208:211], a[232:235], v[104:107], v[208:211]
    v_exp_f32 v214, v214
    v_mfma_f32_16x16x32_bf16 v[208:211], a[236:239], v[108:111], v[208:211]
    v_exp_f32 v215, v215
    v_mfma_f32_16x16x32_bf16 a[48:51], a[184:187], v[128:131], a[48:51]
    ds_read_b64_tr_b16 a[164:165], v24 offset:8192
    v_cvt_pk_bf16_f32 v170, v212, v213
    v_mfma_f32_16x16x32_bf16 a[48:51], a[188:191], v[132:135], a[48:51]
    ds_read_b64_tr_b16 a[166:167], v24 offset:12288
    v_mfma_f32_16x16x32_bf16 a[52:55], a[184:187], v[136:139], a[52:55]
    ds_read_b128 a[220:223], v11 offset:24576
    v_cvt_pk_bf16_f32 v171, v214, v215
    v_mfma_f32_16x16x32_bf16 a[52:55], a[188:191], v[140:143], a[52:55]
    v_smfmac_f32_16x16x64_bf16 a[200:203], v[52:55], v[144:151], v50
    v_mfma_f32_16x16x32_bf16 v[212:215], a[224:227], v[112:115], v[204:207]
    v_exp_f32 v208, v208
    v_mfma_f32_16x16x32_bf16 v[212:215], a[228:231], v[116:119], v[212:215]
    v_exp_f32 v209, v209
    v_mfma_f32_16x16x32_bf16 v[212:215], a[232:235], v[120:123], v[212:215]
    v_exp_f32 v210, v210
    v_mfma_f32_16x16x32_bf16 v[212:215], a[236:239], v[124:127], v[212:215]
    v_exp_f32 v211, v211
    v_mfma_f32_16x16x32_bf16 a[56:59], a[184:187], v[144:147], a[56:59]
    ds_read_b64_tr_b16 a[168:169], v25 offset:0
    v_cvt_pk_bf16_f32 v178, v208, v209
    v_mfma_f32_16x16x32_bf16 a[56:59], a[188:191], v[148:151], a[56:59]
    ds_read_b64_tr_b16 a[170:171], v25 offset:4096
    v_mfma_f32_16x16x32_bf16 a[60:63], a[184:187], v[152:155], a[60:63]
    ds_read_b128 a[224:227], v8 offset:28672
    v_cvt_pk_bf16_f32 v179, v210, v211
    v_mfma_f32_16x16x32_bf16 a[60:63], a[188:191], v[156:159], a[60:63]
    s_waitcnt lgkmcnt(3)
    buffer_load_dwordx4 v40, s[12:15], s41 offen offset:2048 lds
    v_mfma_f32_16x16x32_bf16 v[208:211], a[208:211], v[64:67], v[192:195]
    v_exp_f32 v212, v212
    v_mfma_f32_16x16x32_bf16 v[208:211], a[212:215], v[68:71], v[208:211]
Ltour4:
    s_cbranch_execz Ltour8
    v_exp_f32 v213, v213
    v_mfma_f32_16x16x32_bf16 v[208:211], a[216:219], v[72:75], v[208:211]
    v_exp_f32 v214, v214
    v_mfma_f32_16x16x32_bf16 v[208:211], a[220:223], v[76:79], v[208:211]
    v_exp_f32 v215, v215
    v_mfma_f32_16x16x32_bf16 a[64:67], a[160:163], v[128:131], a[64:67]
    ds_read_b64_tr_b16 a[172:173], v25 offset:8192
    v_cvt_pk_bf16_f32 v186, v212, v213
    v_mfma_f32_16x16x32_bf16 a[64:67], a[164:167], v[132:135], a[64:67]
    ds_read_b64_tr_b16 a[174:175], v25 offset:12288
    v_mfma_f32_16x16x32_bf16 a[68:71], a[160:163], v[136:139], a[68:71]
    ds_read_b128 a[228:231], v9 offset:28672
    v_cvt_pk_bf16_f32 v187, v214, v215
    v_mfma_f32_16x16x32_bf16 a[68:71], a[164:167], v[140:143], a[68:71]
    v_smfmac_f32_16x16x64_bf16 a[204:207], v[52:55], v[152:159], v50
    v_mfma_f32_16x16x32_bf16 v[212:215], a[208:211], v[80:83], v[196:199]
    v_exp_f32 v208, v208
    v_mfma_f32_16x16x32_bf16 v[212:215], a[212:215], v[84:87], v[212:215]
    v_exp_f32 v209, v209
    v_mfma_f32_16x16x32_bf16 v[212:215], a[216:219], v[88:91], v[212:215]
    v_exp_f32 v210, v210
    v_mfma_f32_16x16x32_bf16 v[212:215], a[220:223], v[92:95], v[212:215]
    v_exp_f32 v211, v211
    v_mfma_f32_16x16x32_bf16 a[72:75], a[160:163], v[144:147], a[72:75]
    ds_read_b64_tr_b16 a[176:177], v26 offset:0
    v_cvt_pk_bf16_f32 v164, v208, v209
    v_mfma_f32_16x16x32_bf16 a[72:75], a[164:167], v[148:151], a[72:75]
    ds_read_b64_tr_b16 a[178:179], v26 offset:4096
    v_mfma_f32_16x16x32_bf16 a[76:79], a[160:163], v[152:155], a[76:79]
    ds_read_b128 a[232:235], v10 offset:28672
    v_cvt_pk_bf16_f32 v165, v210, v211
    v_mfma_f32_16x16x32_bf16 a[76:79], a[164:167], v[156:159], a[76:79]
    s_waitcnt lgkmcnt(3)
    buffer_load_dwordx4 v41, s[12:15], s41 offen offset:3072 lds
    v_mfma_f32_16x16x32_bf16 v[208:211], a[208:211], v[96:99], v[200:203]
    v_exp_f32 v212, v212
    v_mfma_f32_16x16x32_bf16 v[208:211], a[212:215], v[100:103], v[208:211]
    s_add_u32 s41, s41, 16384
    v_exp_f32 v213, v213
    v_mfma_f32_16x16x32_bf16 v[208:211], a[216:219], v[104:107], v[208:211]
    v_exp_f32 v214, v214
    v_mfma_f32_16x16x32_bf16 v[208:211], a[220:223], v[108:111], v[208:211]
    v_exp_f32 v215, v215
    v_mfma_f32_16x16x32_bf16 a[80:83], a[168:171], v[128:131], a[80:83]
    ds_read_b64_tr_b16 a[180:181], v26 offset:8192
    v_cvt_pk_bf16_f32 v172, v212, v213
    v_mfma_f32_16x16x32_bf16 a[80:83], a[172:175], v[132:135], a[80:83]
    ds_read_b64_tr_b16 a[182:183], v26 offset:12288
    v_mfma_f32_16x16x32_bf16 a[84:87], a[168:171], v[136:139], a[84:87]
    ds_read_b128 a[236:239], v11 offset:28672
    v_cvt_pk_bf16_f32 v173, v214, v215
    v_mfma_f32_16x16x32_bf16 a[84:87], a[172:175], v[140:143], a[84:87]
    s_waitcnt vmcnt(10)
    s_barrier
    v_mfma_f32_16x16x32_bf16 v[212:215], a[208:211], v[112:115], v[204:207]
    v_exp_f32 v208, v208
    v_mfma_f32_16x16x32_bf16 v[212:215], a[212:215], v[116:119], v[212:215]
    s_add_u32 m0, s42, 0
    v_exp_f32 v209, v209
    v_mfma_f32_16x16x32_bf16 v[212:215], a[216:219], v[120:123], v[212:215]
    v_exp_f32 v210, v210
    v_mfma_f32_16x16x32_bf16 v[212:215], a[220:223], v[124:127], v[212:215]
    v_exp_f32 v211, v211
    v_mfma_f32_16x16x32_bf16 a[88:91], a[168:171], v[144:147], a[88:91]
    ds_read_b64_tr_b16 a[184:185], v27 offset:0
    v_cvt_pk_bf16_f32 v180, v208, v209
    v_mfma_f32_16x16x32_bf16 a[88:91], a[172:175], v[148:151], a[88:91]
    ds_read_b64_tr_b16 a[186:187], v27 offset:4096
    v_mfma_f32_16x16x32_bf16 a[92:95], a[168:171], v[152:155], a[92:95]
    ds_read_b128 a[208:211], v8 offset:32768
    v_cvt_pk_bf16_f32 v181, v210, v211
    v_mfma_f32_16x16x32_bf16 a[92:95], a[172:175], v[156:159], a[92:95]
    s_waitcnt lgkmcnt(3)
    buffer_load_dwordx4 v36, s[8:11], s40 offen lds
    v_mfma_f32_16x16x32_bf16 v[208:211], a[224:227], v[64:67], v[192:195]
    v_exp_f32 v212, v212
    v_mfma_f32_16x16x32_bf16 v[208:211], a[228:231], v[68:71], v[208:211]
    v_exp_f32 v213, v213
    v_mfma_f32_16x16x32_bf16 v[208:211], a[232:235], v[72:75], v[208:211]
    v_exp_f32 v214, v214
    v_mfma_f32_16x16x32_bf16 v[208:211], a[236:239], v[76:79], v[208:211]
    v_exp_f32 v215, v215
    v_mfma_f32_16x16x32_bf16 a[96:99], a[176:179], v[128:131], a[96:99]
    ds_read_b64_tr_b16 a[188:189], v27 offset:8192
    v_cvt_pk_bf16_f32 v188, v212, v213
    v_mfma_f32_16x16x32_bf16 a[96:99], a[180:183], v[132:135], a[96:99]
    ds_read_b64_tr_b16 a[190:191], v27 offset:12288
    v_mfma_f32_16x16x32_bf16 a[100:103], a[176:179], v[136:139], a[100:103]
    ds_read_b128 a[212:215], v9 offset:32768
    v_cvt_pk_bf16_f32 v189, v214, v215
    v_mfma_f32_16x16x32_bf16 a[100:103], a[180:183], v[140:143], a[100:103]
    v_mfma_f32_16x16x32_bf16 v[212:215], a[224:227], v[80:83], v[196:199]
    v_exp_f32 v208, v208
    v_mfma_f32_16x16x32_bf16 v[212:215], a[228:231], v[84:87], v[212:215]
    v_exp_f32 v209, v209
    v_mfma_f32_16x16x32_bf16 v[212:215], a[232:235], v[88:91], v[212:215]
    v_exp_f32 v210, v210
    v_mfma_f32_16x16x32_bf16 v[212:215], a[236:239], v[92:95], v[212:215]
    v_exp_f32 v211, v211
    v_mfma_f32_16x16x32_bf16 a[104:107], a[176:179], v[144:147], a[104:107]
    ds_read_b64_tr_b16 a[160:161], v20 offset:16384
    v_cvt_pk_bf16_f32 v166, v208, v209
    v_mfma_f32_16x16x32_bf16 a[104:107], a[180:183], v[148:151], a[104:107]
    ds_read_b64_tr_b16 a[162:163], v20 offset:20480
    v_mfma_f32_16x16x32_bf16 a[108:111], a[176:179], v[152:155], a[108:111]
    ds_read_b128 a[216:219], v10 offset:32768
    v_cvt_pk_bf16_f32 v167, v210, v211
    v_mfma_f32_16x16x32_bf16 a[108:111], a[180:183], v[156:159], a[108:111]
    s_waitcnt lgkmcnt(3)
    buffer_load_dwordx4 v37, s[8:11], s40 offen offset:1024 lds
    v_mfma_f32_16x16x32_bf16 v[208:211], a[224:227], v[96:99], v[200:203]
    v_exp_f32 v212, v212
    v_mfma_f32_16x16x32_bf16 v[208:211], a[228:231], v[100:103], v[208:211]
    v_exp_f32 v213, v213
    v_mfma_f32_16x16x32_bf16 v[208:211], a[232:235], v[104:107], v[208:211]
    v_exp_f32 v214, v214
    v_mfma_f32_16x16x32_bf16 v[208:211], a[236:239], v[108:111], v[208:211]
    v_exp_f32 v215, v215
    v_mfma_f32_16x16x32_bf16 a[112:115], a[184:187], v[128:131], a[112:115]
    ds_read_b64_tr_b16 a[164:165], v20 offset:24576
    v_cvt_pk_bf16_f32 v174, v212, v213
    v_mfma_f32_16x16x32_bf16 a[112:115], a[188:191], v[132:135], a[112:115]
    ds_read_b64_tr_b16 a[166:167], v20 offset:28672
    v_mfma_f32_16x16x32_bf16 a[116:119], a[184:187], v[136:139], a[116:119]
    ds_read_b128 a[220:223], v11 offset:32768
    v_cvt_pk_bf16_f32 v175, v214, v215
    v_mfma_f32_16x16x32_bf16 a[116:119], a[188:191], v[140:143], a[116:119]
    buffer_load_dwordx4 v[240:243], v7, s[16:19], s44 offen
    v_mfma_f32_16x16x32_bf16 v[212:215], a[224:227], v[112:115], v[204:207]
    v_exp_f32 v208, v208
    v_mfma_f32_16x16x32_bf16 v[212:215], a[228:231], v[116:119], v[212:215]
    v_exp_f32 v209, v209
    v_mfma_f32_16x16x32_bf16 v[212:215], a[232:235], v[120:123], v[212:215]
    v_exp_f32 v210, v210
    v_mfma_f32_16x16x32_bf16 v[212:215], a[236:239], v[124:127], v[212:215]
    s_add_u32 s44, s44, 884736
    v_exp_f32 v211, v211
    v_mfma_f32_16x16x32_bf16 a[120:123], a[184:187], v[144:147], a[120:123]
    ds_read_b64_tr_b16 a[168:169], v21 offset:16384
    v_cvt_pk_bf16_f32 v182, v208, v209
    v_mfma_f32_16x16x32_bf16 a[120:123], a[188:191], v[148:151], a[120:123]
    ds_read_b64_tr_b16 a[170:171], v21 offset:20480
    v_mfma_f32_16x16x32_bf16 a[124:127], a[184:187], v[152:155], a[124:127]
    ds_read_b128 a[224:227], v8 offset:36864
    v_cvt_pk_bf16_f32 v183, v210, v211
    v_mfma_f32_16x16x32_bf16 a[124:127], a[188:191], v[156:159], a[124:127]
    s_waitcnt lgkmcnt(3)
    buffer_load_dwordx4 v38, s[8:11], s40 offen offset:2048 lds
    v_mfma_f32_16x16x32_bf16 v[208:211], a[208:211], v[64:67], v[192:195]
    v_exp_f32 v212, v212
    v_mfma_f32_16x16x32_bf16 v[208:211], a[212:215], v[68:71], v[208:211]
    v_exp_f32 v213, v213
    v_mfma_f32_16x16x32_bf16 v[208:211], a[216:219], v[72:75], v[208:211]
    v_exp_f32 v214, v214
    v_mfma_f32_16x16x32_bf16 v[208:211], a[220:223], v[76:79], v[208:211]
    v_exp_f32 v215, v215
    v_mfma_f32_16x16x32_bf16 a[0:3], a[160:163], v[160:163], a[0:3]
    ds_read_b64_tr_b16 a[172:173], v21 offset:24576
    v_cvt_pk_bf16_f32 v190, v212, v213
    v_mfma_f32_16x16x32_bf16 a[0:3], a[164:167], v[164:167], a[0:3]
    ds_read_b64_tr_b16 a[174:175], v21 offset:28672
    v_mfma_f32_16x16x32_bf16 a[4:7], a[160:163], v[168:171], a[4:7]
    ds_read_b128 a[228:231], v9 offset:36864
    v_cvt_pk_bf16_f32 v191, v214, v215
    v_mfma_f32_16x16x32_bf16 a[4:7], a[164:167], v[172:175], a[4:7]
    v_mfma_f32_16x16x32_bf16 v[212:215], a[208:211], v[80:83], v[196:199]
    v_exp_f32 v208, v208
    v_mfma_f32_16x16x32_bf16 v[212:215], a[212:215], v[84:87], v[212:215]
    v_exp_f32 v209, v209
    v_mfma_f32_16x16x32_bf16 v[212:215], a[216:219], v[88:91], v[212:215]
    v_exp_f32 v210, v210
    v_mfma_f32_16x16x32_bf16 v[212:215], a[220:223], v[92:95], v[212:215]
    v_exp_f32 v211, v211
    v_mfma_f32_16x16x32_bf16 a[8:11], a[160:163], v[176:179], a[8:11]
    ds_read_b64_tr_b16 a[176:177], v22 offset:16384
    v_cvt_pk_bf16_f32 v128, v208, v209
    v_mfma_f32_16x16x32_bf16 a[8:11], a[164:167], v[180:183], a[8:11]
    ds_read_b64_tr_b16 a[178:179], v22 offset:20480
    v_mfma_f32_16x16x32_bf16 a[12:15], a[160:163], v[184:187], a[12:15]
    ds_read_b128 a[232:235], v10 offset:36864
    v_cvt_pk_bf16_f32 v129, v210, v211
    v_mfma_f32_16x16x32_bf16 a[12:15], a[164:167], v[188:191], a[12:15]
    s_waitcnt lgkmcnt(3)
    buffer_load_dwordx4 v39, s[8:11], s40 offen offset:3072 lds
    v_mfma_f32_16x16x32_bf16 v[208:211], a[208:211], v[96:99], v[200:203]
    v_exp_f32 v212, v212
    v_mfma_f32_16x16x32_bf16 v[208:211], a[212:215], v[100:103], v[208:211]
    s_add_u32 s40, s40, 16384
    v_exp_f32 v213, v213
    v_mfma_f32_16x16x32_bf16 v[208:211], a[216:219], v[104:107], v[208:211]
    v_exp_f32 v214, v214
    v_mfma_f32_16x16x32_bf16 v[208:211], a[220:223], v[108:111], v[208:211]
    v_exp_f32 v215, v215
    v_mfma_f32_16x16x32_bf16 a[16:19], a[168:171], v[160:163], a[16:19]
    ds_read_b64_tr_b16 a[180:181], v22 offset:24576
    v_cvt_pk_bf16_f32 v136, v212, v213
    v_mfma_f32_16x16x32_bf16 a[16:19], a[172:175], v[164:167], a[16:19]
    ds_read_b64_tr_b16 a[182:183], v22 offset:28672
    v_mfma_f32_16x16x32_bf16 a[20:23], a[168:171], v[168:171], a[20:23]
    ds_read_b128 a[236:239], v11 offset:36864
    v_cvt_pk_bf16_f32 v137, v214, v215
    v_mfma_f32_16x16x32_bf16 a[20:23], a[172:175], v[172:175], a[20:23]
    v_smfmac_f32_16x16x64_bf16 a[192:195], v[52:55], v[160:167], v50
    v_mfma_f32_16x16x32_bf16 v[212:215], a[208:211], v[112:115], v[204:207]
    v_exp_f32 v208, v208
    v_mfma_f32_16x16x32_bf16 v[212:215], a[212:215], v[116:119], v[212:215]
    s_add_u32 m0, s42, 114688
    v_exp_f32 v209, v209
    v_mfma_f32_16x16x32_bf16 v[212:215], a[216:219], v[120:123], v[212:215]
    v_exp_f32 v210, v210
    v_mfma_f32_16x16x32_bf16 v[212:215], a[220:223], v[124:127], v[212:215]
    v_exp_f32 v211, v211
    v_mfma_f32_16x16x32_bf16 a[24:27], a[168:171], v[176:179], a[24:27]
    ds_read_b64_tr_b16 a[184:185], v23 offset:16384
    v_cvt_pk_bf16_f32 v144, v208, v209
    v_mfma_f32_16x16x32_bf16 a[24:27], a[172:175], v[180:183], a[24:27]
    ds_read_b64_tr_b16 a[186:187], v23 offset:20480
    v_mfma_f32_16x16x32_bf16 a[28:31], a[168:171], v[184:187], a[28:31]
    ds_read_b128 a[208:211], v8 offset:40960
    v_cvt_pk_bf16_f32 v145, v210, v211
    v_mfma_f32_16x16x32_bf16 a[28:31], a[172:175], v[188:191], a[28:31]
    s_waitcnt lgkmcnt(3)
    buffer_load_dwordx4 v40, s[12:15], s41 offen lds
    v_mfma_f32_16x16x32_bf16 v[208:211], a[224:227], v[64:67], v[192:195]
    v_exp_f32 v212, v212
    v_mfma_f32_16x16x32_bf16 v[208:211], a[228:231], v[68:71], v[208:211]
    v_exp_f32 v213, v213
    v_mfma_f32_16x16x32_bf16 v[208:211], a[232:235], v[72:75], v[208:211]
    v_exp_f32 v214, v214
    v_mfma_f32_16x16x32_bf16 v[208:211], a[236:239], v[76:79], v[208:211]
    v_exp_f32 v215, v215
    v_mfma_f32_16x16x32_bf16 a[32:35], a[176:179], v[160:163], a[32:35]
    ds_read_b64_tr_b16 a[188:189], v23 offset:24576
    v_cvt_pk_bf16_f32 v152, v212, v213
    v_mfma_f32_16x16x32_bf16 a[32:35], a[180:183], v[164:167], a[32:35]
    ds_read_b64_tr_b16 a[190:191], v23 offset:28672
    v_mfma_f32_16x16x32_bf16 a[36:39], a[176:179], v[168:171], a[36:39]
    ds_read_b128 a[212:215], v9 offset:40960
    v_cvt_pk_bf16_f32 v153, v214, v215
    v_mfma_f32_16x16x32_bf16 a[36:39], a[180:183], v[172:175], a[36:39]
    v_smfmac_f32_16x16x64_bf16 a[196:199], v[52:55], v[168:175], v50
    v_mfma_f32_16x16x32_bf16 v[212:215], a[224:227], v[80:83], v[196:199]
    v_exp_f32 v208, v208
    v_mfma_f32_16x16x32_bf16 v[212:215], a[228:231], v[84:87], v[212:215]
    v_exp_f32 v209, v209
    v_mfma_f32_16x16x32_bf16 v[212:215], a[232:235], v[88:91], v[212:215]
    v_exp_f32 v210, v210
    v_mfma_f32_16x16x32_bf16 v[212:215], a[236:239], v[92:95], v[212:215]
    v_exp_f32 v211, v211
    v_mfma_f32_16x16x32_bf16 a[40:43], a[176:179], v[176:179], a[40:43]
    ds_read_b64_tr_b16 a[160:161], v24 offset:16384
    v_cvt_pk_bf16_f32 v130, v208, v209
    v_mfma_f32_16x16x32_bf16 a[40:43], a[180:183], v[180:183], a[40:43]
    ds_read_b64_tr_b16 a[162:163], v24 offset:20480
    v_mfma_f32_16x16x32_bf16 a[44:47], a[176:179], v[184:187], a[44:47]
    ds_read_b128 a[216:219], v10 offset:40960
    v_cvt_pk_bf16_f32 v131, v210, v211
    v_mfma_f32_16x16x32_bf16 a[44:47], a[180:183], v[188:191], a[44:47]
    s_waitcnt lgkmcnt(3)
    buffer_load_dwordx4 v41, s[12:15], s41 offen offset:1024 lds
    v_mfma_f32_16x16x32_bf16 v[208:211], a[224:227], v[96:99], v[200:203]
    v_exp_f32 v212, v212
    v_mfma_f32_16x16x32_bf16 v[208:211], a[228:231], v[100:103], v[208:211]
    v_exp_f32 v213, v213
    v_mfma_f32_16x16x32_bf16 v[208:211], a[232:235], v[104:107], v[208:211]
    v_exp_f32 v214, v214
    v_mfma_f32_16x16x32_bf16 v[208:211], a[236:239], v[108:111], v[208:211]
    v_exp_f32 v215, v215
    v_mfma_f32_16x16x32_bf16 a[48:51], a[184:187], v[160:163], a[48:51]
    ds_read_b64_tr_b16 a[164:165], v24 offset:24576
    v_cvt_pk_bf16_f32 v138, v212, v213
    v_mfma_f32_16x16x32_bf16 a[48:51], a[188:191], v[164:167], a[48:51]
    ds_read_b64_tr_b16 a[166:167], v24 offset:28672
    v_mfma_f32_16x16x32_bf16 a[52:55], a[184:187], v[168:171], a[52:55]
    ds_read_b128 a[220:223], v11 offset:40960
    v_cvt_pk_bf16_f32 v139, v214, v215
    v_mfma_f32_16x16x32_bf16 a[52:55], a[188:191], v[172:175], a[52:55]
    v_smfmac_f32_16x16x64_bf16 a[200:203], v[52:55], v[176:183], v50
    v_mfma_f32_16x16x32_bf16 v[212:215], a[224:227], v[112:115], v[204:207]
    v_exp_f32 v208, v208
    v_mfma_f32_16x16x32_bf16 v[212:215], a[228:231], v[116:119], v[212:215]
    v_exp_f32 v209, v209
    v_mfma_f32_16x16x32_bf16 v[212:215], a[232:235], v[120:123], v[212:215]
    v_exp_f32 v210, v210
    v_mfma_f32_16x16x32_bf16 v[212:215], a[236:239], v[124:127], v[212:215]
    v_exp_f32 v211, v211
    v_mfma_f32_16x16x32_bf16 a[56:59], a[184:187], v[176:179], a[56:59]
    ds_read_b64_tr_b16 a[168:169], v25 offset:16384
    v_cvt_pk_bf16_f32 v146, v208, v209
    v_mfma_f32_16x16x32_bf16 a[56:59], a[188:191], v[180:183], a[56:59]
    ds_read_b64_tr_b16 a[170:171], v25 offset:20480
    v_mfma_f32_16x16x32_bf16 a[60:63], a[184:187], v[184:187], a[60:63]
    ds_read_b128 a[224:227], v8 offset:45056
    v_cvt_pk_bf16_f32 v147, v210, v211
    v_mfma_f32_16x16x32_bf16 a[60:63], a[188:191], v[188:191], a[60:63]
    s_waitcnt lgkmcnt(3)
    buffer_load_dwordx4 v40, s[12:15], s41 offen offset:2048 lds
    v_mfma_f32_16x16x32_bf16 v[208:211], a[208:211], v[64:67], v[192:195]
    v_exp_f32 v212, v212
    v_mfma_f32_16x16x32_bf16 v[208:211], a[212:215], v[68:71], v[208:211]
    v_exp_f32 v213, v213
    v_mfma_f32_16x16x32_bf16 v[208:211], a[216:219], v[72:75], v[208:211]
    v_exp_f32 v214, v214
    v_mfma_f32_16x16x32_bf16 v[208:211], a[220:223], v[76:79], v[208:211]
    v_exp_f32 v215, v215
    v_mfma_f32_16x16x32_bf16 a[64:67], a[160:163], v[160:163], a[64:67]
    ds_read_b64_tr_b16 a[172:173], v25 offset:24576
    v_cvt_pk_bf16_f32 v154, v212, v213
    v_mfma_f32_16x16x32_bf16 a[64:67], a[164:167], v[164:167], a[64:67]
    ds_read_b64_tr_b16 a[174:175], v25 offset:28672
    v_mfma_f32_16x16x32_bf16 a[68:71], a[160:163], v[168:171], a[68:71]
    ds_read_b128 a[228:231], v9 offset:45056
    v_cvt_pk_bf16_f32 v155, v214, v215
    v_mfma_f32_16x16x32_bf16 a[68:71], a[164:167], v[172:175], a[68:71]
    v_smfmac_f32_16x16x64_bf16 a[204:207], v[52:55], v[184:191], v50
    v_mfma_f32_16x16x32_bf16 v[212:215], a[208:211], v[80:83], v[196:199]
    v_exp_f32 v208, v208
    v_mfma_f32_16x16x32_bf16 v[212:215], a[212:215], v[84:87], v[212:215]
    v_exp_f32 v209, v209
    v_mfma_f32_16x16x32_bf16 v[212:215], a[216:219], v[88:91], v[212:215]
    v_exp_f32 v210, v210
    v_mfma_f32_16x16x32_bf16 v[212:215], a[220:223], v[92:95], v[212:215]
    v_exp_f32 v211, v211
    v_mfma_f32_16x16x32_bf16 a[72:75], a[160:163], v[176:179], a[72:75]
    ds_read_b64_tr_b16 a[176:177], v26 offset:16384
    v_cvt_pk_bf16_f32 v132, v208, v209
    v_mfma_f32_16x16x32_bf16 a[72:75], a[164:167], v[180:183], a[72:75]
    ds_read_b64_tr_b16 a[178:179], v26 offset:20480
    v_mfma_f32_16x16x32_bf16 a[76:79], a[160:163], v[184:187], a[76:79]
    ds_read_b128 a[232:235], v10 offset:45056
    v_cvt_pk_bf16_f32 v133, v210, v211
    v_mfma_f32_16x16x32_bf16 a[76:79], a[164:167], v[188:191], a[76:79]
    s_waitcnt lgkmcnt(3)
    buffer_load_dwordx4 v41, s[12:15], s41 offen offset:3072 lds
    v_mfma_f32_16x16x32_bf16 v[208:211], a[208:211], v[96:99], v[200:203]
    v_exp_f32 v212, v212
    v_mfma_f32_16x16x32_bf16 v[208:211], a[212:215], v[100:103], v[208:211]
    s_add_u32 s41, s41, 16384
    v_exp_f32 v213, v213
    v_mfma_f32_16x16x32_bf16 v[208:211], a[216:219], v[104:107], v[208:211]
    v_exp_f32 v214, v214
    v_mfma_f32_16x16x32_bf16 v[208:211], a[220:223], v[108:111], v[208:211]
    v_exp_f32 v215, v215
    v_mfma_f32_16x16x32_bf16 a[80:83], a[168:171], v[160:163], a[80:83]
    ds_read_b64_tr_b16 a[180:181], v26 offset:24576
    v_cvt_pk_bf16_f32 v140, v212, v213
    v_mfma_f32_16x16x32_bf16 a[80:83], a[172:175], v[164:167], a[80:83]
    ds_read_b64_tr_b16 a[182:183], v26 offset:28672
    v_mfma_f32_16x16x32_bf16 a[84:87], a[168:171], v[168:171], a[84:87]
    ds_read_b128 a[236:239], v11 offset:45056
    v_cvt_pk_bf16_f32 v141, v214, v215
    v_mfma_f32_16x16x32_bf16 a[84:87], a[172:175], v[172:175], a[84:87]
    s_waitcnt vmcnt(9)
    s_barrier
    v_mfma_f32_16x16x32_bf16 v[212:215], a[208:211], v[112:115], v[204:207]
    v_exp_f32 v208, v208
    v_mfma_f32_16x16x32_bf16 v[212:215], a[212:215], v[116:119], v[212:215]
    s_add_u32 m0, s42, 16384
    v_exp_f32 v209, v209
    v_mfma_f32_16x16x32_bf16 v[212:215], a[216:219], v[120:123], v[212:215]
    v_exp_f32 v210, v210
    v_mfma_f32_16x16x32_bf16 v[212:215], a[220:223], v[124:127], v[212:215]
    v_exp_f32 v211, v211
    v_mfma_f32_16x16x32_bf16 a[88:91], a[168:171], v[176:179], a[88:91]
    ds_read_b64_tr_b16 a[184:185], v27 offset:16384
    v_cvt_pk_bf16_f32 v148, v208, v209
    v_mfma_f32_16x16x32_bf16 a[88:91], a[172:175], v[180:183], a[88:91]
    ds_read_b64_tr_b16 a[186:187], v27 offset:20480
    v_mfma_f32_16x16x32_bf16 a[92:95], a[168:171], v[184:187], a[92:95]
    ds_read_b128 a[208:211], v8 offset:49152
    v_cvt_pk_bf16_f32 v149, v210, v211
    v_mfma_f32_16x16x32_bf16 a[92:95], a[172:175], v[188:191], a[92:95]
    s_waitcnt lgkmcnt(3)
    buffer_load_dwordx4 v36, s[8:11], s40 offen lds
    v_mfma_f32_16x16x32_bf16 v[208:211], a[224:227], v[64:67], v[192:195]
    v_exp_f32 v212, v212
    v_mfma_f32_16x16x32_bf16 v[208:211], a[228:231], v[68:71], v[208:211]
    v_exp_f32 v213, v213
    v_mfma_f32_16x16x32_bf16 v[208:211], a[232:235], v[72:75], v[208:211]
    v_exp_f32 v214, v214
    v_mfma_f32_16x16x32_bf16 v[208:211], a[236:239], v[76:79], v[208:211]
    v_exp_f32 v215, v215
    v_mfma_f32_16x16x32_bf16 a[96:99], a[176:179], v[160:163], a[96:99]
    ds_read_b64_tr_b16 a[188:189], v27 offset:24576
    v_cvt_pk_bf16_f32 v156, v212, v213
    v_mfma_f32_16x16x32_bf16 a[96:99], a[180:183], v[164:167], a[96:99]
    ds_read_b64_tr_b16 a[190:191], v27 offset:28672
    v_mfma_f32_16x16x32_bf16 a[100:103], a[176:179], v[168:171], a[100:103]
    ds_read_b128 a[212:215], v9 offset:49152
    v_cvt_pk_bf16_f32 v157, v214, v215
    v_mfma_f32_16x16x32_bf16 a[100:103], a[180:183], v[172:175], a[100:103]
    buffer_load_dword v218, v57, s[80:83], s39 offen
    v_mfma_f32_16x16x32_bf16 v[212:215], a[224:227], v[80:83], v[196:199]
    v_exp_f32 v208, v208
    v_mfma_f32_16x16x32_bf16 v[212:215], a[228:231], v[84:87], v[212:215]
    v_exp_f32 v209, v209
    v_mfma_f32_16x16x32_bf16 v[212:215], a[232:235], v[88:91], v[212:215]
    v_exp_f32 v210, v210
    v_mfma_f32_16x16x32_bf16 v[212:215], a[236:239], v[92:95], v[212:215]
    v_exp_f32 v211, v211
    v_mfma_f32_16x16x32_bf16 a[104:107], a[176:179], v[176:179], a[104:107]
    ds_read_b64_tr_b16 a[160:161], v20 offset:32768
    v_cvt_pk_bf16_f32 v134, v208, v209
    v_mfma_f32_16x16x32_bf16 a[104:107], a[180:183], v[180:183], a[104:107]
    ds_read_b64_tr_b16 a[162:163], v20 offset:36864
    v_mfma_f32_16x16x32_bf16 a[108:111], a[176:179], v[184:187], a[108:111]
    ds_read_b128 a[216:219], v10 offset:49152
    v_cvt_pk_bf16_f32 v135, v210, v211
    v_mfma_f32_16x16x32_bf16 a[108:111], a[180:183], v[188:191], a[108:111]
    s_waitcnt lgkmcnt(3)
    buffer_load_dwordx4 v37, s[8:11], s40 offen offset:1024 lds
    v_mfma_f32_16x16x32_bf16 v[208:211], a[224:227], v[96:99], v[200:203]
    v_exp_f32 v212, v212
    v_mfma_f32_16x16x32_bf16 v[208:211], a[228:231], v[100:103], v[208:211]
    v_exp_f32 v213, v213
    v_mfma_f32_16x16x32_bf16 v[208:211], a[232:235], v[104:107], v[208:211]
    v_exp_f32 v214, v214
    v_mfma_f32_16x16x32_bf16 v[208:211], a[236:239], v[108:111], v[208:211]
    v_exp_f32 v215, v215
    v_mfma_f32_16x16x32_bf16 a[112:115], a[184:187], v[160:163], a[112:115]
    ds_read_b64_tr_b16 a[164:165], v20 offset:40960
    v_cvt_pk_bf16_f32 v142, v212, v213
    v_mfma_f32_16x16x32_bf16 a[112:115], a[188:191], v[164:167], a[112:115]
    ds_read_b64_tr_b16 a[166:167], v20 offset:45056
    v_mfma_f32_16x16x32_bf16 a[116:119], a[184:187], v[168:171], a[116:119]
    ds_read_b128 a[220:223], v11 offset:49152
    v_cvt_pk_bf16_f32 v143, v214, v215
    v_mfma_f32_16x16x32_bf16 a[116:119], a[188:191], v[172:175], a[116:119]
    buffer_store_dwordx4 v[248:251], v232, s[24:27], s53 offen sc1
    v_mfma_f32_16x16x32_bf16 v[212:215], a[224:227], v[112:115], v[204:207]
    v_exp_f32 v208, v208
    v_mfma_f32_16x16x32_bf16 v[212:215], a[228:231], v[116:119], v[212:215]
    v_exp_f32 v209, v209
    v_mfma_f32_16x16x32_bf16 v[212:215], a[232:235], v[120:123], v[212:215]
    v_exp_f32 v210, v210
    v_mfma_f32_16x16x32_bf16 v[212:215], a[236:239], v[124:127], v[212:215]
    s_add_u32 s53, s53, 656
    v_exp_f32 v211, v211
    v_mfma_f32_16x16x32_bf16 a[120:123], a[184:187], v[176:179], a[120:123]
    ds_read_b64_tr_b16 a[168:169], v21 offset:32768
    v_cvt_pk_bf16_f32 v150, v208, v209
    v_mfma_f32_16x16x32_bf16 a[120:123], a[188:191], v[180:183], a[120:123]
    ds_read_b64_tr_b16 a[170:171], v21 offset:36864
    v_mfma_f32_16x16x32_bf16 a[124:127], a[184:187], v[184:187], a[124:127]
    ds_read_b128 a[224:227], v8 offset:53248
    v_cvt_pk_bf16_f32 v151, v210, v211
    v_mfma_f32_16x16x32_bf16 a[124:127], a[188:191], v[188:191], a[124:127]
    s_waitcnt lgkmcnt(3)
    buffer_load_dwordx4 v38, s[8:11], s40 offen offset:2048 lds
    v_mfma_f32_16x16x32_bf16 v[208:211], a[208:211], v[64:67], v[192:195]
    v_exp_f32 v212, v212
    v_mfma_f32_16x16x32_bf16 v[208:211], a[212:215], v[68:71], v[208:211]
    v_exp_f32 v213, v213
    v_mfma_f32_16x16x32_bf16 v[208:211], a[216:219], v[72:75], v[208:211]
    v_exp_f32 v214, v214
    v_mfma_f32_16x16x32_bf16 v[208:211], a[220:223], v[76:79], v[208:211]
    v_exp_f32 v215, v215
    v_mfma_f32_16x16x32_bf16 a[0:3], a[160:163], v[128:131], a[0:3]
    ds_read_b64_tr_b16 a[172:173], v21 offset:40960
    v_cvt_pk_bf16_f32 v158, v212, v213
    v_mfma_f32_16x16x32_bf16 a[0:3], a[164:167], v[132:135], a[0:3]
    ds_read_b64_tr_b16 a[174:175], v21 offset:45056
    v_mfma_f32_16x16x32_bf16 a[4:7], a[160:163], v[136:139], a[4:7]
    ds_read_b128 a[228:231], v9 offset:53248
    v_cvt_pk_bf16_f32 v159, v214, v215
    v_mfma_f32_16x16x32_bf16 a[4:7], a[164:167], v[140:143], a[4:7]
    v_mfma_f32_16x16x32_bf16 v[212:215], a[208:211], v[80:83], v[196:199]
    v_exp_f32 v208, v208
    v_mfma_f32_16x16x32_bf16 v[212:215], a[212:215], v[84:87], v[212:215]
    v_exp_f32 v209, v209
    v_mfma_f32_16x16x32_bf16 v[212:215], a[216:219], v[88:91], v[212:215]
    v_exp_f32 v210, v210
    v_mfma_f32_16x16x32_bf16 v[212:215], a[220:223], v[92:95], v[212:215]
    v_exp_f32 v211, v211
    v_mfma_f32_16x16x32_bf16 a[8:11], a[160:163], v[144:147], a[8:11]
    ds_read_b64_tr_b16 a[176:177], v22 offset:32768
    v_cvt_pk_bf16_f32 v160, v208, v209
    v_mfma_f32_16x16x32_bf16 a[8:11], a[164:167], v[148:151], a[8:11]
    ds_read_b64_tr_b16 a[178:179], v22 offset:36864
    v_mfma_f32_16x16x32_bf16 a[12:15], a[160:163], v[152:155], a[12:15]
    ds_read_b128 a[232:235], v10 offset:53248
    v_cvt_pk_bf16_f32 v161, v210, v211
    v_mfma_f32_16x16x32_bf16 a[12:15], a[164:167], v[156:159], a[12:15]
    s_waitcnt lgkmcnt(3)
    buffer_load_dwordx4 v39, s[8:11], s40 offen offset:3072 lds
    v_mfma_f32_16x16x32_bf16 v[208:211], a[208:211], v[96:99], v[200:203]
    v_exp_f32 v212, v212
    v_mfma_f32_16x16x32_bf16 v[208:211], a[212:215], v[100:103], v[208:211]
    s_add_u32 s40, s40, 16384
    v_exp_f32 v213, v213
    v_mfma_f32_16x16x32_bf16 v[208:211], a[216:219], v[104:107], v[208:211]
    v_exp_f32 v214, v214
    v_mfma_f32_16x16x32_bf16 v[208:211], a[220:223], v[108:111], v[208:211]
    v_exp_f32 v215, v215
    v_mfma_f32_16x16x32_bf16 a[16:19], a[168:171], v[128:131], a[16:19]
    ds_read_b64_tr_b16 a[180:181], v22 offset:40960
    v_cvt_pk_bf16_f32 v168, v212, v213
    v_mfma_f32_16x16x32_bf16 a[16:19], a[172:175], v[132:135], a[16:19]
    ds_read_b64_tr_b16 a[182:183], v22 offset:45056
    v_mfma_f32_16x16x32_bf16 a[20:23], a[168:171], v[136:139], a[20:23]
    ds_read_b128 a[236:239], v11 offset:53248
    v_cvt_pk_bf16_f32 v169, v214, v215
    v_mfma_f32_16x16x32_bf16 a[20:23], a[172:175], v[140:143], a[20:23]
    v_smfmac_f32_16x16x64_bf16 a[192:195], v[52:55], v[128:135], v50
    v_mfma_f32_16x16x32_bf16 v[212:215], a[208:211], v[112:115], v[204:207]
    v_exp_f32 v208, v208
    v_mfma_f32_16x16x32_bf16 v[212:215], a[212:215], v[116:119], v[212:215]
    s_add_u32 m0, s42, 65536
    v_exp_f32 v209, v209
    v_mfma_f32_16x16x32_bf16 v[212:215], a[216:219], v[120:123], v[212:215]
    v_exp_f32 v210, v210
    v_mfma_f32_16x16x32_bf16 v[212:215], a[220:223], v[124:127], v[212:215]
    v_exp_f32 v211, v211
    v_mfma_f32_16x16x32_bf16 a[24:27], a[168:171], v[144:147], a[24:27]
    ds_read_b64_tr_b16 a[184:185], v23 offset:32768
    v_cvt_pk_bf16_f32 v176, v208, v209
    v_mfma_f32_16x16x32_bf16 a[24:27], a[172:175], v[148:151], a[24:27]
    ds_read_b64_tr_b16 a[186:187], v23 offset:36864
    v_mfma_f32_16x16x32_bf16 a[28:31], a[168:171], v[152:155], a[28:31]
    ds_read_b128 a[208:211], v8 offset:57344
    v_cvt_pk_bf16_f32 v177, v210, v211
    v_mfma_f32_16x16x32_bf16 a[28:31], a[172:175], v[156:159], a[28:31]
    s_waitcnt lgkmcnt(3)
    buffer_load_dwordx4 v40, s[12:15], s41 offen lds
    v_mfma_f32_16x16x32_bf16 v[208:211], a[224:227], v[64:67], v[192:195]
    v_exp_f32 v212, v212
    v_mfma_f32_16x16x32_bf16 v[208:211], a[228:231], v[68:71], v[208:211]
    v_exp_f32 v213, v213
    v_mfma_f32_16x16x32_bf16 v[208:211], a[232:235], v[72:75], v[208:211]
    v_exp_f32 v214, v214
    v_mfma_f32_16x16x32_bf16 v[208:211], a[236:239], v[76:79], v[208:211]
    v_exp_f32 v215, v215
    v_mfma_f32_16x16x32_bf16 a[32:35], a[176:179], v[128:131], a[32:35]
    ds_read_b64_tr_b16 a[188:189], v23 offset:40960
    v_cvt_pk_bf16_f32 v184, v212, v213
    v_mfma_f32_16x16x32_bf16 a[32:35], a[180:183], v[132:135], a[32:35]
    ds_read_b64_tr_b16 a[190:191], v23 offset:45056
    v_mfma_f32_16x16x32_bf16 a[36:39], a[176:179], v[136:139], a[36:39]
    ds_read_b128 a[212:215], v9 offset:57344
    v_cvt_pk_bf16_f32 v185, v214, v215
    v_mfma_f32_16x16x32_bf16 a[36:39], a[180:183], v[140:143], a[36:39]
    v_smfmac_f32_16x16x64_bf16 a[196:199], v[52:55], v[136:143], v50
    v_mfma_f32_16x16x32_bf16 v[212:215], a[224:227], v[80:83], v[196:199]
    v_exp_f32 v208, v208
    v_mfma_f32_16x16x32_bf16 v[212:215], a[228:231], v[84:87], v[212:215]
    v_exp_f32 v209, v209
    v_mfma_f32_16x16x32_bf16 v[212:215], a[232:235], v[88:91], v[212:215]
    v_exp_f32 v210, v210
    v_mfma_f32_16x16x32_bf16 v[212:215], a[236:239], v[92:95], v[212:215]
    v_exp_f32 v211, v211
    v_mfma_f32_16x16x32_bf16 a[40:43], a[176:179], v[144:147], a[40:43]
    ds_read_b64_tr_b16 a[160:161], v24 offset:32768
    v_cvt_pk_bf16_f32 v162, v208, v209
    v_mfma_f32_16x16x32_bf16 a[40:43], a[180:183], v[148:151], a[40:43]
    ds_read_b64_tr_b16 a[162:163], v24 offset:36864
    v_mfma_f32_16x16x32_bf16 a[44:47], a[176:179], v[152:155], a[44:47]
    ds_read_b128 a[216:219], v10 offset:57344
    v_cvt_pk_bf16_f32 v163, v210, v211
    v_mfma_f32_16x16x32_bf16 a[44:47], a[180:183], v[156:159], a[44:47]
    s_waitcnt lgkmcnt(3)
    buffer_load_dwordx4 v41, s[12:15], s41 offen offset:1024 lds
    v_mfma_f32_16x16x32_bf16 v[208:211], a[224:227], v[96:99], v[200:203]
    v_exp_f32 v212, v212
    v_mfma_f32_16x16x32_bf16 v[208:211], a[228:231], v[100:103], v[208:211]
    v_exp_f32 v213, v213
    v_mfma_f32_16x16x32_bf16 v[208:211], a[232:235], v[104:107], v[208:211]
    v_exp_f32 v214, v214
    v_mfma_f32_16x16x32_bf16 v[208:211], a[236:239], v[108:111], v[208:211]
    v_exp_f32 v215, v215
    v_mfma_f32_16x16x32_bf16 a[48:51], a[184:187], v[128:131], a[48:51]
    ds_read_b64_tr_b16 a[164:165], v24 offset:40960
    v_cvt_pk_bf16_f32 v170, v212, v213
    v_mfma_f32_16x16x32_bf16 a[48:51], a[188:191], v[132:135], a[48:51]
    ds_read_b64_tr_b16 a[166:167], v24 offset:45056
    v_mfma_f32_16x16x32_bf16 a[52:55], a[184:187], v[136:139], a[52:55]
    ds_read_b128 a[220:223], v11 offset:57344
    v_cvt_pk_bf16_f32 v171, v214, v215
    v_mfma_f32_16x16x32_bf16 a[52:55], a[188:191], v[140:143], a[52:55]
    v_smfmac_f32_16x16x64_bf16 a[200:203], v[52:55], v[144:151], v50
    v_mfma_f32_16x16x32_bf16 v[212:215], a[224:227], v[112:115], v[204:207]
    v_exp_f32 v208, v208
    v_mfma_f32_16x16x32_bf16 v[212:215], a[228:231], v[116:119], v[212:215]
    v_exp_f32 v209, v209
    v_mfma_f32_16x16x32_bf16 v[212:215], a[232:235], v[120:123], v[212:215]
Ltour5:
    s_cbranch_execz Ltour9
    v_exp_f32 v210, v210
    v_mfma_f32_16x16x32_bf16 v[212:215], a[236:239], v[124:127], v[212:215]
    v_exp_f32 v211, v211
    v_mfma_f32_16x16x32_bf16 a[56:59], a[184:187], v[144:147], a[56:59]
    ds_read_b64_tr_b16 a[168:169], v25 offset:32768
    v_cvt_pk_bf16_f32 v178, v208, v209
    v_mfma_f32_16x16x32_bf16 a[56:59], a[188:191], v[148:151], a[56:59]
    ds_read_b64_tr_b16 a[170:171], v25 offset:36864
    v_mfma_f32_16x16x32_bf16 a[60:63], a[184:187], v[152:155], a[60:63]
    ds_read_b128 a[224:227], v8 offset:61440
    v_cvt_pk_bf16_f32 v179, v210, v211
    v_mfma_f32_16x16x32_bf16 a[60:63], a[188:191], v[156:159], a[60:63]
    s_waitcnt lgkmcnt(3)
    buffer_load_dwordx4 v40, s[12:15], s41 offen offset:2048 lds
    v_mfma_f32_16x16x32_bf16 v[208:211], a[208:211], v[64:67], v[192:195]
    v_exp_f32 v212, v212
    v_mfma_f32_16x16x32_bf16 v[208:211], a[212:215], v[68:71], v[208:211]
    v_exp_f32 v213, v213
    v_mfma_f32_16x16x32_bf16 v[208:211], a[216:219], v[72:75], v[208:211]
    v_exp_f32 v214, v214
    v_mfma_f32_16x16x32_bf16 v[208:211], a[220:223], v[76:79], v[208:211]
    v_exp_f32 v215, v215
    v_mfma_f32_16x16x32_bf16 a[64:67], a[160:163], v[128:131], a[64:67]
    ds_read_b64_tr_b16 a[172:173], v25 offset:40960
    v_cvt_pk_bf16_f32 v186, v212, v213
    v_mfma_f32_16x16x32_bf16 a[64:67], a[164:167], v[132:135], a[64:67]
    ds_read_b64_tr_b16 a[174:175], v25 offset:45056
    v_mfma_f32_16x16x32_bf16 a[68:71], a[160:163], v[136:139], a[68:71]
    ds_read_b128 a[228:231], v9 offset:61440
    v_cvt_pk_bf16_f32 v187, v214, v215
    v_mfma_f32_16x16x32_bf16 a[68:71], a[164:167], v[140:143], a[68:71]
    v_smfmac_f32_16x16x64_bf16 a[204:207], v[52:55], v[152:159], v50
    v_mfma_f32_16x16x32_bf16 v[212:215], a[208:211], v[80:83], v[196:199]
    v_exp_f32 v208, v208
    v_mfma_f32_16x16x32_bf16 v[212:215], a[212:215], v[84:87], v[212:215]
    v_exp_f32 v209, v209
    v_mfma_f32_16x16x32_bf16 v[212:215], a[216:219], v[88:91], v[212:215]
    v_exp_f32 v210, v210
    v_mfma_f32_16x16x32_bf16 v[212:215], a[220:223], v[92:95], v[212:215]
    v_exp_f32 v211, v211
    v_mfma_f32_16x16x32_bf16 a[72:75], a[160:163], v[144:147], a[72:75]
    ds_read_b64_tr_b16 a[176:177], v26 offset:32768
    v_cvt_pk_bf16_f32 v164, v208, v209
    v_mfma_f32_16x16x32_bf16 a[72:75], a[164:167], v[148:151], a[72:75]
    ds_read_b64_tr_b16 a[178:179], v26 offset:36864
    v_mfma_f32_16x16x32_bf16 a[76:79], a[160:163], v[152:155], a[76:79]
    ds_read_b128 a[232:235], v10 offset:61440
    v_cvt_pk_bf16_f32 v165, v210, v211
    v_mfma_f32_16x16x32_bf16 a[76:79], a[164:167], v[156:159], a[76:79]
    s_waitcnt lgkmcnt(3)
    buffer_load_dwordx4 v41, s[12:15], s41 offen offset:3072 lds
    v_mfma_f32_16x16x32_bf16 v[208:211], a[208:211], v[96:99], v[200:203]
    v_exp_f32 v212, v212
    v_mfma_f32_16x16x32_bf16 v[208:211], a[212:215], v[100:103], v[208:211]
    s_add_u32 s41, s41, 16384
    v_exp_f32 v213, v213
    v_mfma_f32_16x16x32_bf16 v[208:211], a[216:219], v[104:107], v[208:211]
    v_exp_f32 v214, v214
    v_mfma_f32_16x16x32_bf16 v[208:211], a[220:223], v[108:111], v[208:211]
    v_exp_f32 v215, v215
    v_mfma_f32_16x16x32_bf16 a[80:83], a[168:171], v[128:131], a[80:83]
    ds_read_b64_tr_b16 a[180:181], v26 offset:40960
    v_cvt_pk_bf16_f32 v172, v212, v213
    v_mfma_f32_16x16x32_bf16 a[80:83], a[172:175], v[132:135], a[80:83]
    ds_read_b64_tr_b16 a[182:183], v26 offset:45056
    v_mfma_f32_16x16x32_bf16 a[84:87], a[168:171], v[136:139], a[84:87]
    ds_read_b128 a[236:239], v11 offset:61440
    v_cvt_pk_bf16_f32 v173, v214, v215
    v_mfma_f32_16x16x32_bf16 a[84:87], a[172:175], v[140:143], a[84:87]
    s_waitcnt vmcnt(10)
    s_barrier
    v_mfma_f32_16x16x32_bf16 v[212:215], a[208:211], v[112:115], v[204:207]
    v_exp_f32 v208, v208
    v_mfma_f32_16x16x32_bf16 v[212:215], a[212:215], v[116:119], v[212:215]
    s_add_u32 m0, s42, 32768
    v_exp_f32 v209, v209
    v_mfma_f32_16x16x32_bf16 v[212:215], a[216:219], v[120:123], v[212:215]
    v_exp_f32 v210, v210
    v_mfma_f32_16x16x32_bf16 v[212:215], a[220:223], v[124:127], v[212:215]
    v_exp_f32 v211, v211
    v_mfma_f32_16x16x32_bf16 a[88:91], a[168:171], v[144:147], a[88:91]
    ds_read_b64_tr_b16 a[184:185], v27 offset:32768
    v_cvt_pk_bf16_f32 v180, v208, v209
    v_mfma_f32_16x16x32_bf16 a[88:91], a[172:175], v[148:151], a[88:91]
    ds_read_b64_tr_b16 a[186:187], v27 offset:36864
    v_mfma_f32_16x16x32_bf16 a[92:95], a[168:171], v[152:155], a[92:95]
    ds_read_b128 a[208:211], v8 offset:0
    v_cvt_pk_bf16_f32 v181, v210, v211
    v_mfma_f32_16x16x32_bf16 a[92:95], a[172:175], v[156:159], a[92:95]
    s_waitcnt lgkmcnt(3)
    buffer_load_dwordx4 v36, s[8:11], s40 offen lds
    v_mfma_f32_16x16x32_bf16 v[208:211], a[224:227], v[64:67], v[192:195]
    v_exp_f32 v212, v212
    v_mfma_f32_16x16x32_bf16 v[208:211], a[228:231], v[68:71], v[208:211]
    v_exp_f32 v213, v213
    v_mfma_f32_16x16x32_bf16 v[208:211], a[232:235], v[72:75], v[208:211]
    v_exp_f32 v214, v214
    v_mfma_f32_16x16x32_bf16 v[208:211], a[236:239], v[76:79], v[208:211]
    v_exp_f32 v215, v215
    v_mfma_f32_16x16x32_bf16 a[96:99], a[176:179], v[128:131], a[96:99]
    ds_read_b64_tr_b16 a[188:189], v27 offset:40960
    v_cvt_pk_bf16_f32 v188, v212, v213
    v_mfma_f32_16x16x32_bf16 a[96:99], a[180:183], v[132:135], a[96:99]
    ds_read_b64_tr_b16 a[190:191], v27 offset:45056
    v_mfma_f32_16x16x32_bf16 a[100:103], a[176:179], v[136:139], a[100:103]
    ds_read_b128 a[212:215], v9 offset:0
    v_cvt_pk_bf16_f32 v189, v214, v215
    v_mfma_f32_16x16x32_bf16 a[100:103], a[180:183], v[140:143], a[100:103]
    buffer_load_dword v219, v62, s[84:87], s38 offen
    v_mfma_f32_16x16x32_bf16 v[212:215], a[224:227], v[80:83], v[196:199]
    v_exp_f32 v208, v208
    v_mfma_f32_16x16x32_bf16 v[212:215], a[228:231], v[84:87], v[212:215]
    v_exp_f32 v209, v209
    v_mfma_f32_16x16x32_bf16 v[212:215], a[232:235], v[88:91], v[212:215]
    v_exp_f32 v210, v210
    v_mfma_f32_16x16x32_bf16 v[212:215], a[236:239], v[92:95], v[212:215]
    v_exp_f32 v211, v211
    v_mfma_f32_16x16x32_bf16 a[104:107], a[176:179], v[144:147], a[104:107]
    ds_read_b64_tr_b16 a[160:161], v20 offset:49152
    v_cvt_pk_bf16_f32 v166, v208, v209
    v_mfma_f32_16x16x32_bf16 a[104:107], a[180:183], v[148:151], a[104:107]
    ds_read_b64_tr_b16 a[162:163], v20 offset:53248
    v_mfma_f32_16x16x32_bf16 a[108:111], a[176:179], v[152:155], a[108:111]
    ds_read_b128 a[216:219], v10 offset:0
    v_cvt_pk_bf16_f32 v167, v210, v211
    v_mfma_f32_16x16x32_bf16 a[108:111], a[180:183], v[156:159], a[108:111]
    s_waitcnt lgkmcnt(3)
    buffer_load_dwordx4 v37, s[8:11], s40 offen offset:1024 lds
    v_mfma_f32_16x16x32_bf16 v[208:211], a[224:227], v[96:99], v[200:203]
    v_exp_f32 v212, v212
    v_mfma_f32_16x16x32_bf16 v[208:211], a[228:231], v[100:103], v[208:211]
    v_exp_f32 v213, v213
    v_mfma_f32_16x16x32_bf16 v[208:211], a[232:235], v[104:107], v[208:211]
    v_exp_f32 v214, v214
    v_mfma_f32_16x16x32_bf16 v[208:211], a[236:239], v[108:111], v[208:211]
    v_exp_f32 v215, v215
    v_mfma_f32_16x16x32_bf16 a[112:115], a[184:187], v[128:131], a[112:115]
    ds_read_b64_tr_b16 a[164:165], v20 offset:57344
    v_cvt_pk_bf16_f32 v174, v212, v213
    v_mfma_f32_16x16x32_bf16 a[112:115], a[188:191], v[132:135], a[112:115]
    ds_read_b64_tr_b16 a[166:167], v20 offset:61440
    v_mfma_f32_16x16x32_bf16 a[116:119], a[184:187], v[136:139], a[116:119]
    ds_read_b128 a[220:223], v11 offset:0
    v_cvt_pk_bf16_f32 v175, v214, v215
    v_mfma_f32_16x16x32_bf16 a[116:119], a[188:191], v[140:143], a[116:119]
    buffer_load_dword v221, v235, s[20:23], 0 offen
    v_mfma_f32_16x16x32_bf16 v[212:215], a[224:227], v[112:115], v[204:207]
    v_exp_f32 v208, v208
    v_mfma_f32_16x16x32_bf16 v[212:215], a[228:231], v[116:119], v[212:215]
    v_exp_f32 v209, v209
    v_mfma_f32_16x16x32_bf16 v[212:215], a[232:235], v[120:123], v[212:215]
    v_exp_f32 v210, v210
    v_mfma_f32_16x16x32_bf16 v[212:215], a[236:239], v[124:127], v[212:215]
    v_exp_f32 v211, v211
    v_mfma_f32_16x16x32_bf16 a[120:123], a[184:187], v[144:147], a[120:123]
    ds_read_b64_tr_b16 a[168:169], v21 offset:49152
    v_cvt_pk_bf16_f32 v182, v208, v209
    v_mfma_f32_16x16x32_bf16 a[120:123], a[188:191], v[148:151], a[120:123]
    ds_read_b64_tr_b16 a[170:171], v21 offset:53248
    v_add_u32 v235, 2560, v235
    v_mfma_f32_16x16x32_bf16 a[124:127], a[184:187], v[152:155], a[124:127]
    ds_read_b128 a[224:227], v8 offset:4096
    v_cvt_pk_bf16_f32 v183, v210, v211
    v_mfma_f32_16x16x32_bf16 a[124:127], a[188:191], v[156:159], a[124:127]
    s_waitcnt lgkmcnt(3)
    buffer_load_dwordx4 v38, s[8:11], s40 offen offset:2048 lds
    v_mfma_f32_16x16x32_bf16 v[208:211], a[208:211], v[64:67], v[192:195]
    v_exp_f32 v212, v212
    v_mfma_f32_16x16x32_bf16 v[208:211], a[212:215], v[68:71], v[208:211]
    v_exp_f32 v213, v213
    v_mfma_f32_16x16x32_bf16 v[208:211], a[216:219], v[72:75], v[208:211]
    v_exp_f32 v214, v214
    v_mfma_f32_16x16x32_bf16 v[208:211], a[220:223], v[76:79], v[208:211]
    v_exp_f32 v215, v215
    v_mfma_f32_16x16x32_bf16 a[0:3], a[160:163], v[160:163], a[0:3]
    ds_read_b64_tr_b16 a[172:173], v21 offset:57344
    v_cvt_pk_bf16_f32 v190, v212, v213
    v_mfma_f32_16x16x32_bf16 a[0:3], a[164:167], v[164:167], a[0:3]
    ds_read_b64_tr_b16 a[174:175], v21 offset:61440
    v_lshlrev_b32 v244, 16, v240
    v_mfma_f32_16x16x32_bf16 a[4:7], a[160:163], v[168:171], a[4:7]
    ds_read_b128 a[228:231], v9 offset:4096
    v_cvt_pk_bf16_f32 v191, v214, v215
    v_mfma_f32_16x16x32_bf16 a[4:7], a[164:167], v[172:175], a[4:7]
    v_and_b32 v245, 0xffff0000, v240
    v_fmac_f32 v224, v2, v244
    v_mfma_f32_16x16x32_bf16 v[212:215], a[208:211], v[80:83], v[196:199]
    v_exp_f32 v208, v208
    v_mfma_f32_16x16x32_bf16 v[212:215], a[212:215], v[84:87], v[212:215]
    v_exp_f32 v209, v209
    v_mfma_f32_16x16x32_bf16 v[212:215], a[216:219], v[88:91], v[212:215]
    v_exp_f32 v210, v210
    v_mfma_f32_16x16x32_bf16 v[212:215], a[220:223], v[92:95], v[212:215]
    v_exp_f32 v211, v211
    v_mfma_f32_16x16x32_bf16 a[8:11], a[160:163], v[176:179], a[8:11]
    ds_read_b64_tr_b16 a[176:177], v22 offset:49152
    v_cvt_pk_bf16_f32 v128, v208, v209
    v_mfma_f32_16x16x32_bf16 a[8:11], a[164:167], v[180:183], a[8:11]
    ds_read_b64_tr_b16 a[178:179], v22 offset:53248
    v_fmac_f32 v225, v2, v245
    v_mfma_f32_16x16x32_bf16 a[12:15], a[160:163], v[184:187], a[12:15]
    ds_read_b128 a[232:235], v10 offset:4096
    v_cvt_pk_bf16_f32 v129, v210, v211
    v_mfma_f32_16x16x32_bf16 a[12:15], a[164:167], v[188:191], a[12:15]
    s_waitcnt lgkmcnt(3)
    buffer_load_dwordx4 v39, s[8:11], s40 offen offset:3072 lds
    v_mfma_f32_16x16x32_bf16 v[208:211], a[208:211], v[96:99], v[200:203]
    v_exp_f32 v212, v212
    v_mfma_f32_16x16x32_bf16 v[208:211], a[212:215], v[100:103], v[208:211]
    s_add_u32 s40, s40, 16384
    v_exp_f32 v213, v213
    v_mfma_f32_16x16x32_bf16 v[208:211], a[216:219], v[104:107], v[208:211]
    v_exp_f32 v214, v214
    v_mfma_f32_16x16x32_bf16 v[208:211], a[220:223], v[108:111], v[208:211]
    v_exp_f32 v215, v215
    v_mfma_f32_16x16x32_bf16 a[16:19], a[168:171], v[160:163], a[16:19]
    ds_read_b64_tr_b16 a[180:181], v22 offset:57344
    v_cvt_pk_bf16_f32 v136, v212, v213
    v_mfma_f32_16x16x32_bf16 a[16:19], a[172:175], v[164:167], a[16:19]
    ds_read_b64_tr_b16 a[182:183], v22 offset:61440
    v_lshlrev_b32 v246, 16, v241
    v_mfma_f32_16x16x32_bf16 a[20:23], a[168:171], v[168:171], a[20:23]
    ds_read_b128 a[236:239], v11 offset:4096
    v_cvt_pk_bf16_f32 v137, v214, v215
    v_mfma_f32_16x16x32_bf16 a[20:23], a[172:175], v[172:175], a[20:23]
    v_and_b32 v247, 0xffff0000, v241
    v_fmac_f32 v226, v2, v246
    v_smfmac_f32_16x16x64_bf16 a[192:195], v[52:55], v[160:167], v50
    v_mfma_f32_16x16x32_bf16 v[212:215], a[208:211], v[112:115], v[204:207]
    v_exp_f32 v208, v208
    v_mfma_f32_16x16x32_bf16 v[212:215], a[212:215], v[116:119], v[212:215]
    s_add_u32 m0, s42, 81920
    v_exp_f32 v209, v209
    v_mfma_f32_16x16x32_bf16 v[212:215], a[216:219], v[120:123], v[212:215]
    v_exp_f32 v210, v210
    v_mfma_f32_16x16x32_bf16 v[212:215], a[220:223], v[124:127], v[212:215]
    v_exp_f32 v211, v211
    v_mfma_f32_16x16x32_bf16 a[24:27], a[168:171], v[176:179], a[24:27]
    ds_read_b64_tr_b16 a[184:185], v23 offset:49152
    v_cvt_pk_bf16_f32 v144, v208, v209
    v_mfma_f32_16x16x32_bf16 a[24:27], a[172:175], v[180:183], a[24:27]
    ds_read_b64_tr_b16 a[186:187], v23 offset:53248
    v_fmac_f32 v227, v2, v247
    v_mfma_f32_16x16x32_bf16 a[28:31], a[168:171], v[184:187], a[28:31]
    ds_read_b128 a[208:211], v8 offset:8192
    v_cvt_pk_bf16_f32 v145, v210, v211
    v_mfma_f32_16x16x32_bf16 a[28:31], a[172:175], v[188:191], a[28:31]
    s_waitcnt lgkmcnt(3)
    buffer_load_dwordx4 v40, s[12:15], s41 offen lds
    v_mfma_f32_16x16x32_bf16 v[208:211], a[224:227], v[64:67], v[192:195]
    v_exp_f32 v212, v212
    v_mfma_f32_16x16x32_bf16 v[208:211], a[228:231], v[68:71], v[208:211]
    v_exp_f32 v213, v213
    v_mfma_f32_16x16x32_bf16 v[208:211], a[232:235], v[72:75], v[208:211]
    v_exp_f32 v214, v214
    v_mfma_f32_16x16x32_bf16 v[208:211], a[236:239], v[76:79], v[208:211]
    v_exp_f32 v215, v215
    v_mfma_f32_16x16x32_bf16 a[32:35], a[176:179], v[160:163], a[32:35]
    ds_read_b64_tr_b16 a[188:189], v23 offset:57344
    v_cvt_pk_bf16_f32 v152, v212, v213
    v_mfma_f32_16x16x32_bf16 a[32:35], a[180:183], v[164:167], a[32:35]
    ds_read_b64_tr_b16 a[190:191], v23 offset:61440
    v_lshlrev_b32 v244, 16, v242
    v_mfma_f32_16x16x32_bf16 a[36:39], a[176:179], v[168:171], a[36:39]
    ds_read_b128 a[212:215], v9 offset:8192
    v_cvt_pk_bf16_f32 v153, v214, v215
    v_mfma_f32_16x16x32_bf16 a[36:39], a[180:183], v[172:175], a[36:39]
    v_and_b32 v245, 0xffff0000, v242
    v_fmac_f32 v228, v2, v244
    v_smfmac_f32_16x16x64_bf16 a[196:199], v[52:55], v[168:175], v50
    v_mfma_f32_16x16x32_bf16 v[212:215], a[224:227], v[80:83], v[196:199]
    v_exp_f32 v208, v208
    v_mfma_f32_16x16x32_bf16 v[212:215], a[228:231], v[84:87], v[212:215]
    v_exp_f32 v209, v209
    v_mfma_f32_16x16x32_bf16 v[212:215], a[232:235], v[88:91], v[212:215]
    v_exp_f32 v210, v210
    v_mfma_f32_16x16x32_bf16 v[212:215], a[236:239], v[92:95], v[212:215]
    v_exp_f32 v211, v211
    v_mfma_f32_16x16x32_bf16 a[40:43], a[176:179], v[176:179], a[40:43]
    ds_read_b64_tr_b16 a[160:161], v24 offset:49152
    v_cvt_pk_bf16_f32 v130, v208, v209
    v_mfma_f32_16x16x32_bf16 a[40:43], a[180:183], v[180:183], a[40:43]
    ds_read_b64_tr_b16 a[162:163], v24 offset:53248
    v_fmac_f32 v229, v2, v245
    v_mfma_f32_16x16x32_bf16 a[44:47], a[176:179], v[184:187], a[44:47]
    ds_read_b128 a[216:219], v10 offset:8192
    v_cvt_pk_bf16_f32 v131, v210, v211
    v_mfma_f32_16x16x32_bf16 a[44:47], a[180:183], v[188:191], a[44:47]
    s_waitcnt lgkmcnt(3)
    buffer_load_dwordx4 v41, s[12:15], s41 offen offset:1024 lds
    v_mfma_f32_16x16x32_bf16 v[208:211], a[224:227], v[96:99], v[200:203]
    v_exp_f32 v212, v212
    v_mfma_f32_16x16x32_bf16 v[208:211], a[228:231], v[100:103], v[208:211]
    v_exp_f32 v213, v213
    v_mfma_f32_16x16x32_bf16 v[208:211], a[232:235], v[104:107], v[208:211]
    v_exp_f32 v214, v214
    v_mfma_f32_16x16x32_bf16 v[208:211], a[236:239], v[108:111], v[208:211]
    v_exp_f32 v215, v215
    v_mfma_f32_16x16x32_bf16 a[48:51], a[184:187], v[160:163], a[48:51]
    ds_read_b64_tr_b16 a[164:165], v24 offset:57344
    v_cvt_pk_bf16_f32 v138, v212, v213
    v_mfma_f32_16x16x32_bf16 a[48:51], a[188:191], v[164:167], a[48:51]
    ds_read_b64_tr_b16 a[166:167], v24 offset:61440
    v_lshlrev_b32 v246, 16, v243
    v_mfma_f32_16x16x32_bf16 a[52:55], a[184:187], v[168:171], a[52:55]
    ds_read_b128 a[220:223], v11 offset:8192
    v_cvt_pk_bf16_f32 v139, v214, v215
    v_mfma_f32_16x16x32_bf16 a[52:55], a[188:191], v[172:175], a[52:55]
    v_and_b32 v247, 0xffff0000, v243
    v_fmac_f32 v230, v2, v246
    v_smfmac_f32_16x16x64_bf16 a[200:203], v[52:55], v[176:183], v50
    v_mfma_f32_16x16x32_bf16 v[212:215], a[224:227], v[112:115], v[204:207]
    v_exp_f32 v208, v208
    v_mfma_f32_16x16x32_bf16 v[212:215], a[228:231], v[116:119], v[212:215]
    v_exp_f32 v209, v209
    v_mfma_f32_16x16x32_bf16 v[212:215], a[232:235], v[120:123], v[212:215]
    v_exp_f32 v210, v210
    v_mfma_f32_16x16x32_bf16 v[212:215], a[236:239], v[124:127], v[212:215]
    v_exp_f32 v211, v211
    v_mfma_f32_16x16x32_bf16 a[56:59], a[184:187], v[176:179], a[56:59]
    ds_read_b64_tr_b16 a[168:169], v25 offset:49152
    v_cvt_pk_bf16_f32 v146, v208, v209
    v_mfma_f32_16x16x32_bf16 a[56:59], a[188:191], v[180:183], a[56:59]
    ds_read_b64_tr_b16 a[170:171], v25 offset:53248
    v_fmac_f32 v231, v2, v247
    v_mfma_f32_16x16x32_bf16 a[60:63], a[184:187], v[184:187], a[60:63]
    ds_read_b128 a[224:227], v8 offset:12288
    v_cvt_pk_bf16_f32 v147, v210, v211
    v_mfma_f32_16x16x32_bf16 a[60:63], a[188:191], v[188:191], a[60:63]
    s_waitcnt lgkmcnt(3)
    buffer_load_dwordx4 v40, s[12:15], s41 offen offset:2048 lds
    v_mfma_f32_16x16x32_bf16 v[208:211], a[208:211], v[64:67], v[192:195]
    v_exp_f32 v212, v212
    v_mfma_f32_16x16x32_bf16 v[208:211], a[212:215], v[68:71], v[208:211]
    v_exp_f32 v213, v213
    v_mfma_f32_16x16x32_bf16 v[208:211], a[216:219], v[72:75], v[208:211]
    v_exp_f32 v214, v214
    v_mfma_f32_16x16x32_bf16 v[208:211], a[220:223], v[76:79], v[208:211]
    v_exp_f32 v215, v215
    v_mfma_f32_16x16x32_bf16 a[64:67], a[160:163], v[160:163], a[64:67]
    ds_read_b64_tr_b16 a[172:173], v25 offset:57344
    v_cvt_pk_bf16_f32 v154, v212, v213
    v_mfma_f32_16x16x32_bf16 a[64:67], a[164:167], v[164:167], a[64:67]
    ds_read_b64_tr_b16 a[174:175], v25 offset:61440
    v_mov_b32 v2, v3
    v_mfma_f32_16x16x32_bf16 a[68:71], a[160:163], v[168:171], a[68:71]
    ds_read_b128 a[228:231], v9 offset:12288
    v_cvt_pk_bf16_f32 v155, v214, v215
    v_mfma_f32_16x16x32_bf16 a[68:71], a[164:167], v[172:175], a[68:71]
    v_mov_b32 v3, v4
    v_mov_b32 v4, v5
    v_smfmac_f32_16x16x64_bf16 a[204:207], v[52:55], v[184:191], v50
    v_mfma_f32_16x16x32_bf16 v[212:215], a[208:211], v[80:83], v[196:199]
    v_exp_f32 v208, v208
    v_mfma_f32_16x16x32_bf16 v[212:215], a[212:215], v[84:87], v[212:215]
    v_exp_f32 v209, v209
    v_mfma_f32_16x16x32_bf16 v[212:215], a[216:219], v[88:91], v[212:215]
    v_exp_f32 v210, v210
    v_mfma_f32_16x16x32_bf16 v[212:215], a[220:223], v[92:95], v[212:215]
    v_exp_f32 v211, v211
    v_mfma_f32_16x16x32_bf16 a[72:75], a[160:163], v[176:179], a[72:75]
    ds_read_b64_tr_b16 a[176:177], v26 offset:49152
    v_cvt_pk_bf16_f32 v132, v208, v209
    v_mfma_f32_16x16x32_bf16 a[72:75], a[164:167], v[180:183], a[72:75]
    ds_read_b64_tr_b16 a[178:179], v26 offset:53248
    v_mov_b32 v5, v6
    v_mfma_f32_16x16x32_bf16 a[76:79], a[160:163], v[184:187], a[76:79]
    ds_read_b128 a[232:235], v10 offset:12288
    v_cvt_pk_bf16_f32 v133, v210, v211
    v_mfma_f32_16x16x32_bf16 a[76:79], a[164:167], v[188:191], a[76:79]
    s_waitcnt lgkmcnt(3)
    buffer_load_dwordx4 v41, s[12:15], s41 offen offset:3072 lds
    v_mfma_f32_16x16x32_bf16 v[208:211], a[208:211], v[96:99], v[200:203]
    v_exp_f32 v212, v212
    v_mfma_f32_16x16x32_bf16 v[208:211], a[212:215], v[100:103], v[208:211]
    s_add_u32 s41, s41, 16384
    v_exp_f32 v213, v213
    v_mfma_f32_16x16x32_bf16 v[208:211], a[216:219], v[104:107], v[208:211]
    v_exp_f32 v214, v214
    v_mfma_f32_16x16x32_bf16 v[208:211], a[220:223], v[108:111], v[208:211]
    v_exp_f32 v215, v215
    v_mfma_f32_16x16x32_bf16 a[80:83], a[168:171], v[160:163], a[80:83]
    ds_read_b64_tr_b16 a[180:181], v26 offset:57344
    v_cvt_pk_bf16_f32 v140, v212, v213
    v_mfma_f32_16x16x32_bf16 a[80:83], a[172:175], v[164:167], a[80:83]
    ds_read_b64_tr_b16 a[182:183], v26 offset:61440
    v_mfma_f32_16x16x32_bf16 a[84:87], a[168:171], v[168:171], a[84:87]
    ds_read_b128 a[236:239], v11 offset:12288
    v_cvt_pk_bf16_f32 v141, v214, v215
    v_mfma_f32_16x16x32_bf16 a[84:87], a[172:175], v[172:175], a[84:87]
    s_waitcnt vmcnt(10)
    s_barrier
    v_mfma_f32_16x16x32_bf16 v[212:215], a[208:211], v[112:115], v[204:207]
    v_exp_f32 v208, v208
    v_mfma_f32_16x16x32_bf16 v[212:215], a[212:215], v[116:119], v[212:215]
    s_add_u32 m0, s42, 49152
    v_exp_f32 v209, v209
    v_mfma_f32_16x16x32_bf16 v[212:215], a[216:219], v[120:123], v[212:215]
    v_exp_f32 v210, v210
    v_mfma_f32_16x16x32_bf16 v[212:215], a[220:223], v[124:127], v[212:215]
    v_exp_f32 v211, v211
    v_mfma_f32_16x16x32_bf16 a[88:91], a[168:171], v[176:179], a[88:91]
    ds_read_b64_tr_b16 a[184:185], v27 offset:49152
    v_cvt_pk_bf16_f32 v148, v208, v209
    v_mfma_f32_16x16x32_bf16 a[88:91], a[172:175], v[180:183], a[88:91]
    ds_read_b64_tr_b16 a[186:187], v27 offset:53248
    v_mfma_f32_16x16x32_bf16 a[92:95], a[168:171], v[184:187], a[92:95]
    ds_read_b128 a[208:211], v8 offset:16384
    v_cvt_pk_bf16_f32 v149, v210, v211
    v_mfma_f32_16x16x32_bf16 a[92:95], a[172:175], v[188:191], a[92:95]
    s_waitcnt lgkmcnt(3)
    buffer_load_dwordx4 v36, s[8:11], s40 offen lds
    v_mfma_f32_16x16x32_bf16 v[208:211], a[224:227], v[64:67], v[192:195]
    v_exp_f32 v212, v212
    v_mfma_f32_16x16x32_bf16 v[208:211], a[228:231], v[68:71], v[208:211]
    v_exp_f32 v213, v213
    v_mfma_f32_16x16x32_bf16 v[208:211], a[232:235], v[72:75], v[208:211]
    v_exp_f32 v214, v214
    v_mfma_f32_16x16x32_bf16 v[208:211], a[236:239], v[76:79], v[208:211]
    v_exp_f32 v215, v215
    v_mfma_f32_16x16x32_bf16 a[96:99], a[176:179], v[160:163], a[96:99]
    ds_read_b64_tr_b16 a[188:189], v27 offset:57344
    v_cvt_pk_bf16_f32 v156, v212, v213
    v_mfma_f32_16x16x32_bf16 a[96:99], a[180:183], v[164:167], a[96:99]
    ds_read_b64_tr_b16 a[190:191], v27 offset:61440
    v_mfma_f32_16x16x32_bf16 a[100:103], a[176:179], v[168:171], a[100:103]
    ds_read_b128 a[212:215], v9 offset:16384
    v_cvt_pk_bf16_f32 v157, v214, v215
    v_mfma_f32_16x16x32_bf16 a[100:103], a[180:183], v[172:175], a[100:103]
    buffer_load_dword v216, v237, s[28:31], s52 offen
    v_mfma_f32_16x16x32_bf16 v[212:215], a[224:227], v[80:83], v[196:199]
    v_exp_f32 v208, v208
    v_mfma_f32_16x16x32_bf16 v[212:215], a[228:231], v[84:87], v[212:215]
    s_sub_u32 s39, s39, 36864
    v_exp_f32 v209, v209
    v_mfma_f32_16x16x32_bf16 v[212:215], a[232:235], v[88:91], v[212:215]
    s_sub_u32 s38, s38, 4608
    v_exp_f32 v210, v210
    v_mfma_f32_16x16x32_bf16 v[212:215], a[236:239], v[92:95], v[212:215]
    s_add_u32 s52, s52, 2304
    v_exp_f32 v211, v211
    v_mfma_f32_16x16x32_bf16 a[104:107], a[176:179], v[176:179], a[104:107]
    ds_read_b64_tr_b16 a[160:161], v20 offset:0
    v_cvt_pk_bf16_f32 v134, v208, v209
    v_mfma_f32_16x16x32_bf16 a[104:107], a[180:183], v[180:183], a[104:107]
    ds_read_b64_tr_b16 a[162:163], v20 offset:4096
    v_mfma_f32_16x16x32_bf16 a[108:111], a[176:179], v[184:187], a[108:111]
    ds_read_b128 a[216:219], v10 offset:16384
    v_cvt_pk_bf16_f32 v135, v210, v211
    v_mfma_f32_16x16x32_bf16 a[108:111], a[180:183], v[188:191], a[108:111]
    s_waitcnt lgkmcnt(3)
    buffer_load_dwordx4 v37, s[8:11], s40 offen offset:1024 lds
    v_mfma_f32_16x16x32_bf16 v[208:211], a[224:227], v[96:99], v[200:203]
    v_exp_f32 v212, v212
    v_mfma_f32_16x16x32_bf16 v[208:211], a[228:231], v[100:103], v[208:211]
    v_exp_f32 v213, v213
    v_mfma_f32_16x16x32_bf16 v[208:211], a[232:235], v[104:107], v[208:211]
    v_exp_f32 v214, v214
    v_mfma_f32_16x16x32_bf16 v[208:211], a[236:239], v[108:111], v[208:211]
    v_exp_f32 v215, v215
    v_mfma_f32_16x16x32_bf16 a[112:115], a[184:187], v[160:163], a[112:115]
    ds_read_b64_tr_b16 a[164:165], v20 offset:8192
    v_cvt_pk_bf16_f32 v142, v212, v213
    v_mfma_f32_16x16x32_bf16 a[112:115], a[188:191], v[164:167], a[112:115]
    ds_read_b64_tr_b16 a[166:167], v20 offset:12288
    v_mfma_f32_16x16x32_bf16 a[116:119], a[184:187], v[168:171], a[116:119]
    ds_read_b128 a[220:223], v11 offset:16384
    v_cvt_pk_bf16_f32 v143, v214, v215
    v_mfma_f32_16x16x32_bf16 a[116:119], a[188:191], v[172:175], a[116:119]
    v_mfma_f32_16x16x32_bf16 v[212:215], a[224:227], v[112:115], v[204:207]
    v_exp_f32 v208, v208
    v_mfma_f32_16x16x32_bf16 v[212:215], a[228:231], v[116:119], v[212:215]
    v_exp_f32 v209, v209
    v_mfma_f32_16x16x32_bf16 v[212:215], a[232:235], v[120:123], v[212:215]
    v_exp_f32 v210, v210
    v_mfma_f32_16x16x32_bf16 v[212:215], a[236:239], v[124:127], v[212:215]
    v_exp_f32 v211, v211
    v_mfma_f32_16x16x32_bf16 a[120:123], a[184:187], v[176:179], a[120:123]
    ds_read_b64_tr_b16 a[168:169], v21 offset:0
    v_cvt_pk_bf16_f32 v150, v208, v209
    v_mfma_f32_16x16x32_bf16 a[120:123], a[188:191], v[180:183], a[120:123]
    ds_read_b64_tr_b16 a[170:171], v21 offset:4096
    v_mfma_f32_16x16x32_bf16 a[124:127], a[184:187], v[184:187], a[124:127]
    ds_read_b128 a[224:227], v8 offset:20480
    v_cvt_pk_bf16_f32 v151, v210, v211
    v_mfma_f32_16x16x32_bf16 a[124:127], a[188:191], v[188:191], a[124:127]
    s_waitcnt lgkmcnt(3)
    buffer_load_dwordx4 v38, s[8:11], s40 offen offset:2048 lds
    s_sub_u32 s43, s43, 1
    s_cmp_lg_u32 s43, 0
    s_cbranch_scc1 Lattn_loop
    v_mfma_f32_16x16x32_bf16 v[208:211], a[208:211], v[64:67], v[192:195]
    s_lshl_b32 s38, s3, 6
    v_exp_f32 v212, v212
    v_mfma_f32_16x16x32_bf16 v[208:211], a[212:215], v[68:71], v[208:211]
    s_add_u32 s38, s38, 131136
    v_exp_f32 v213, v213
    v_mfma_f32_16x16x32_bf16 v[208:211], a[216:219], v[72:75], v[208:211]
    v_exp_f32 v214, v214
    v_mfma_f32_16x16x32_bf16 v[208:211], a[220:223], v[76:79], v[208:211]
    s_add_u32 s57, s58, 0
    v_exp_f32 v215, v215
    v_mfma_f32_16x16x32_bf16 a[0:3], a[160:163], v[128:131], a[0:3]
    ds_read_b64_tr_b16 a[172:173], v21 offset:8192
    v_cvt_pk_bf16_f32 v158, v212, v213
    v_mfma_f32_16x16x32_bf16 a[0:3], a[164:167], v[132:135], a[0:3]
    ds_read_b64_tr_b16 a[174:175], v21 offset:12288
    v_permlane32_swap_b32 v224, v228
    v_mfma_f32_16x16x32_bf16 a[4:7], a[160:163], v[136:139], a[4:7]
    ds_read_b128 a[228:231], v9 offset:20480
    v_cvt_pk_bf16_f32 v159, v214, v215
    v_mfma_f32_16x16x32_bf16 a[4:7], a[164:167], v[140:143], a[4:7]
    buffer_load_dwordx4 a[128:131], v254, s[80:83], s57 offen
    v_mfma_f32_16x16x32_bf16 v[212:215], a[208:211], v[80:83], v[196:199]
    v_exp_f32 v208, v208
    v_mfma_f32_16x16x32_bf16 v[212:215], a[212:215], v[84:87], v[212:215]
    v_exp_f32 v209, v209
    v_mfma_f32_16x16x32_bf16 v[212:215], a[216:219], v[88:91], v[212:215]
    v_exp_f32 v210, v210
    v_mfma_f32_16x16x32_bf16 v[212:215], a[220:223], v[92:95], v[212:215]
    v_exp_f32 v211, v211
    v_mfma_f32_16x16x32_bf16 a[8:11], a[160:163], v[144:147], a[8:11]
    ds_read_b64_tr_b16 a[176:177], v22 offset:0
    v_cvt_pk_bf16_f32 v160, v208, v209
    v_mfma_f32_16x16x32_bf16 a[8:11], a[164:167], v[148:151], a[8:11]
    ds_read_b64_tr_b16 a[178:179], v22 offset:4096
    v_permlane32_swap_b32 v225, v229
    v_mfma_f32_16x16x32_bf16 a[12:15], a[160:163], v[152:155], a[12:15]
    ds_read_b128 a[232:235], v10 offset:20480
    v_cvt_pk_bf16_f32 v161, v210, v211
    v_mfma_f32_16x16x32_bf16 a[12:15], a[164:167], v[156:159], a[12:15]
    s_waitcnt lgkmcnt(3)
    buffer_load_dwordx4 v39, s[8:11], s40 offen offset:3072 lds
    v_mfma_f32_16x16x32_bf16 v[208:211], a[208:211], v[96:99], v[200:203]
    v_exp_f32 v212, v212
    v_mfma_f32_16x16x32_bf16 v[208:211], a[212:215], v[100:103], v[208:211]
    s_add_u32 s40, s40, 16384
    v_exp_f32 v213, v213
    v_mfma_f32_16x16x32_bf16 v[208:211], a[216:219], v[104:107], v[208:211]
    v_exp_f32 v214, v214
    v_mfma_f32_16x16x32_bf16 v[208:211], a[220:223], v[108:111], v[208:211]
    v_exp_f32 v215, v215
    v_mfma_f32_16x16x32_bf16 a[16:19], a[168:171], v[128:131], a[16:19]
    ds_read_b64_tr_b16 a[180:181], v22 offset:8192
    v_cvt_pk_bf16_f32 v168, v212, v213
    v_mfma_f32_16x16x32_bf16 a[16:19], a[172:175], v[132:135], a[16:19]
    ds_read_b64_tr_b16 a[182:183], v22 offset:12288
    v_permlane32_swap_b32 v226, v230
    v_mfma_f32_16x16x32_bf16 a[20:23], a[168:171], v[136:139], a[20:23]
    ds_read_b128 a[236:239], v11 offset:20480
    v_cvt_pk_bf16_f32 v169, v214, v215
    v_mfma_f32_16x16x32_bf16 a[20:23], a[172:175], v[140:143], a[20:23]
    v_permlane32_swap_b32 v227, v231
    v_add_f32 v224, v224, v228
    v_smfmac_f32_16x16x64_bf16 a[192:195], v[52:55], v[128:135], v50
    v_mfma_f32_16x16x32_bf16 v[212:215], a[208:211], v[112:115], v[204:207]
    v_exp_f32 v208, v208
    v_mfma_f32_16x16x32_bf16 v[212:215], a[212:215], v[116:119], v[212:215]
    s_add_u32 m0, s42, 98304
    v_exp_f32 v209, v209
    v_mfma_f32_16x16x32_bf16 v[212:215], a[216:219], v[120:123], v[212:215]
    v_exp_f32 v210, v210
    v_mfma_f32_16x16x32_bf16 v[212:215], a[220:223], v[124:127], v[212:215]
    v_exp_f32 v211, v211
    v_mfma_f32_16x16x32_bf16 a[24:27], a[168:171], v[144:147], a[24:27]
    ds_read_b64_tr_b16 a[184:185], v23 offset:0
    v_cvt_pk_bf16_f32 v176, v208, v209
    v_mfma_f32_16x16x32_bf16 a[24:27], a[172:175], v[148:151], a[24:27]
    ds_read_b64_tr_b16 a[186:187], v23 offset:4096
    v_add_f32 v225, v225, v229
    v_mfma_f32_16x16x32_bf16 a[28:31], a[168:171], v[152:155], a[28:31]
    ds_read_b128 a[208:211], v8 offset:24576
    v_cvt_pk_bf16_f32 v177, v210, v211
    v_mfma_f32_16x16x32_bf16 a[28:31], a[172:175], v[156:159], a[28:31]
    s_waitcnt lgkmcnt(3)
    buffer_load_dwordx4 v40, s[12:15], s41 offen lds
    v_mfma_f32_16x16x32_bf16 v[208:211], a[224:227], v[64:67], v[192:195]
    v_exp_f32 v212, v212
    v_mfma_f32_16x16x32_bf16 v[208:211], a[228:231], v[68:71], v[208:211]
    v_exp_f32 v213, v213
    v_mfma_f32_16x16x32_bf16 v[208:211], a[232:235], v[72:75], v[208:211]
    v_exp_f32 v214, v214
    v_mfma_f32_16x16x32_bf16 v[208:211], a[236:239], v[76:79], v[208:211]
    s_add_u32 s57, s58, 589824
    v_exp_f32 v215, v215
    v_mfma_f32_16x16x32_bf16 a[32:35], a[176:179], v[128:131], a[32:35]
    ds_read_b64_tr_b16 a[188:189], v23 offset:8192
    v_cvt_pk_bf16_f32 v184, v212, v213
    v_mfma_f32_16x16x32_bf16 a[32:35], a[180:183], v[132:135], a[32:35]
    ds_read_b64_tr_b16 a[190:191], v23 offset:12288
    v_add_f32 v226, v226, v230
    v_mfma_f32_16x16x32_bf16 a[36:39], a[176:179], v[136:139], a[36:39]
    ds_read_b128 a[212:215], v9 offset:24576
    v_cvt_pk_bf16_f32 v185, v214, v215
    v_mfma_f32_16x16x32_bf16 a[36:39], a[180:183], v[140:143], a[36:39]
Ltour6:
    s_cbranch_execz Ltour10
    buffer_load_dwordx4 a[132:135], v254, s[80:83], s57 offen
    v_smfmac_f32_16x16x64_bf16 a[196:199], v[52:55], v[136:143], v50
    v_mfma_f32_16x16x32_bf16 v[212:215], a[224:227], v[80:83], v[196:199]
    v_exp_f32 v208, v208
    v_mfma_f32_16x16x32_bf16 v[212:215], a[228:231], v[84:87], v[212:215]
    v_exp_f32 v209, v209
    v_mfma_f32_16x16x32_bf16 v[212:215], a[232:235], v[88:91], v[212:215]
    v_exp_f32 v210, v210
    v_mfma_f32_16x16x32_bf16 v[212:215], a[236:239], v[92:95], v[212:215]
    v_exp_f32 v211, v211
    v_mfma_f32_16x16x32_bf16 a[40:43], a[176:179], v[144:147], a[40:43]
    ds_read_b64_tr_b16 a[160:161], v24 offset:0
    v_cvt_pk_bf16_f32 v162, v208, v209
    v_mfma_f32_16x16x32_bf16 a[40:43], a[180:183], v[148:151], a[40:43]
    ds_read_b64_tr_b16 a[162:163], v24 offset:4096
    v_add_f32 v227, v227, v231
    v_mfma_f32_16x16x32_bf16 a[44:47], a[176:179], v[152:155], a[44:47]
    ds_read_b128 a[216:219], v10 offset:24576
    v_cvt_pk_bf16_f32 v163, v210, v211
    v_mfma_f32_16x16x32_bf16 a[44:47], a[180:183], v[156:159], a[44:47]
    s_waitcnt lgkmcnt(3)
    buffer_load_dwordx4 v41, s[12:15], s41 offen offset:1024 lds
    v_mfma_f32_16x16x32_bf16 v[208:211], a[224:227], v[96:99], v[200:203]
    v_exp_f32 v212, v212
    v_mfma_f32_16x16x32_bf16 v[208:211], a[228:231], v[100:103], v[208:211]
    v_exp_f32 v213, v213
    v_mfma_f32_16x16x32_bf16 v[208:211], a[232:235], v[104:107], v[208:211]
    v_exp_f32 v214, v214
    v_mfma_f32_16x16x32_bf16 v[208:211], a[236:239], v[108:111], v[208:211]
    v_exp_f32 v215, v215
    v_mfma_f32_16x16x32_bf16 a[48:51], a[184:187], v[128:131], a[48:51]
    ds_read_b64_tr_b16 a[164:165], v24 offset:8192
    v_cvt_pk_bf16_f32 v170, v212, v213
    v_mfma_f32_16x16x32_bf16 a[48:51], a[188:191], v[132:135], a[48:51]
    ds_read_b64_tr_b16 a[166:167], v24 offset:12288
    v_and_b32 v244, 1, v1
    v_mfma_f32_16x16x32_bf16 a[52:55], a[184:187], v[136:139], a[52:55]
    ds_read_b128 a[220:223], v11 offset:24576
    v_cvt_pk_bf16_f32 v171, v214, v215
    v_mfma_f32_16x16x32_bf16 a[52:55], a[188:191], v[140:143], a[52:55]
    s_waitcnt vmcnt(15)
    buffer_load_dword v221, v236, s[20:23], 0 offen
    v_smfmac_f32_16x16x64_bf16 a[200:203], v[52:55], v[144:151], v50
    v_mfma_f32_16x16x32_bf16 v[212:215], a[224:227], v[112:115], v[204:207]
    v_exp_f32 v208, v208
    v_mfma_f32_16x16x32_bf16 v[212:215], a[228:231], v[116:119], v[212:215]
    v_exp_f32 v209, v209
    v_mfma_f32_16x16x32_bf16 v[212:215], a[232:235], v[120:123], v[212:215]
    v_exp_f32 v210, v210
    v_mfma_f32_16x16x32_bf16 v[212:215], a[236:239], v[124:127], v[212:215]
    v_exp_f32 v211, v211
    v_mfma_f32_16x16x32_bf16 a[56:59], a[184:187], v[144:147], a[56:59]
    ds_read_b64_tr_b16 a[168:169], v25 offset:0
    v_cvt_pk_bf16_f32 v178, v208, v209
    v_mfma_f32_16x16x32_bf16 a[56:59], a[188:191], v[148:151], a[56:59]
    ds_read_b64_tr_b16 a[170:171], v25 offset:4096
    v_permlane16_swap_b32 v224, v226
    v_mfma_f32_16x16x32_bf16 a[60:63], a[184:187], v[152:155], a[60:63]
    ds_read_b128 a[224:227], v8 offset:28672
    v_cvt_pk_bf16_f32 v179, v210, v211
    v_mfma_f32_16x16x32_bf16 a[60:63], a[188:191], v[156:159], a[60:63]
    s_waitcnt lgkmcnt(3)
    buffer_load_dwordx4 v40, s[12:15], s41 offen offset:2048 lds
    v_mfma_f32_16x16x32_bf16 v[208:211], a[208:211], v[64:67], v[192:195]
    v_exp_f32 v212, v212
    v_mfma_f32_16x16x32_bf16 v[208:211], a[212:215], v[68:71], v[208:211]
    v_exp_f32 v213, v213
    v_mfma_f32_16x16x32_bf16 v[208:211], a[216:219], v[72:75], v[208:211]
    v_exp_f32 v214, v214
    v_mfma_f32_16x16x32_bf16 v[208:211], a[220:223], v[76:79], v[208:211]
    s_add_u32 s57, s58, 1179648
    v_exp_f32 v215, v215
    v_mfma_f32_16x16x32_bf16 a[64:67], a[160:163], v[128:131], a[64:67]
    ds_read_b64_tr_b16 a[172:173], v25 offset:8192
    v_cvt_pk_bf16_f32 v186, v212, v213
    v_mfma_f32_16x16x32_bf16 a[64:67], a[164:167], v[132:135], a[64:67]
    ds_read_b64_tr_b16 a[174:175], v25 offset:12288
    v_permlane16_swap_b32 v225, v227
    v_mfma_f32_16x16x32_bf16 a[68:71], a[160:163], v[136:139], a[68:71]
    ds_read_b128 a[228:231], v9 offset:28672
    v_cvt_pk_bf16_f32 v187, v214, v215
    v_mfma_f32_16x16x32_bf16 a[68:71], a[164:167], v[140:143], a[68:71]
    buffer_load_dwordx4 a[136:139], v254, s[80:83], s57 offen
    v_smfmac_f32_16x16x64_bf16 a[204:207], v[52:55], v[152:159], v50
    v_mfma_f32_16x16x32_bf16 v[212:215], a[208:211], v[80:83], v[196:199]
    v_exp_f32 v208, v208
    v_mfma_f32_16x16x32_bf16 v[212:215], a[212:215], v[84:87], v[212:215]
    v_exp_f32 v209, v209
    v_mfma_f32_16x16x32_bf16 v[212:215], a[216:219], v[88:91], v[212:215]
    v_exp_f32 v210, v210
    v_mfma_f32_16x16x32_bf16 v[212:215], a[220:223], v[92:95], v[212:215]
    v_exp_f32 v211, v211
    v_mfma_f32_16x16x32_bf16 a[72:75], a[160:163], v[144:147], a[72:75]
    ds_read_b64_tr_b16 a[176:177], v26 offset:0
    v_cvt_pk_bf16_f32 v164, v208, v209
    v_mfma_f32_16x16x32_bf16 a[72:75], a[164:167], v[148:151], a[72:75]
    ds_read_b64_tr_b16 a[178:179], v26 offset:4096
    v_lshlrev_b32 v244, 5, v244
    v_mfma_f32_16x16x32_bf16 a[76:79], a[160:163], v[152:155], a[76:79]
    ds_read_b128 a[232:235], v10 offset:28672
    v_cvt_pk_bf16_f32 v165, v210, v211
    v_mfma_f32_16x16x32_bf16 a[76:79], a[164:167], v[156:159], a[76:79]
    s_waitcnt lgkmcnt(3)
    buffer_load_dwordx4 v41, s[12:15], s41 offen offset:3072 lds
    v_mfma_f32_16x16x32_bf16 v[208:211], a[208:211], v[96:99], v[200:203]
    v_exp_f32 v212, v212
    v_mfma_f32_16x16x32_bf16 v[208:211], a[212:215], v[100:103], v[208:211]
    s_add_u32 s41, s41, 16384
    v_exp_f32 v213, v213
    v_mfma_f32_16x16x32_bf16 v[208:211], a[216:219], v[104:107], v[208:211]
    v_exp_f32 v214, v214
    v_mfma_f32_16x16x32_bf16 v[208:211], a[220:223], v[108:111], v[208:211]
    v_exp_f32 v215, v215
    v_mfma_f32_16x16x32_bf16 a[80:83], a[168:171], v[128:131], a[80:83]
    ds_read_b64_tr_b16 a[180:181], v26 offset:8192
    v_cvt_pk_bf16_f32 v172, v212, v213
    v_mfma_f32_16x16x32_bf16 a[80:83], a[172:175], v[132:135], a[80:83]
    ds_read_b64_tr_b16 a[182:183], v26 offset:12288
    v_add_f32 v224, v224, v226
    v_mfma_f32_16x16x32_bf16 a[84:87], a[168:171], v[136:139], a[84:87]
    ds_read_b128 a[236:239], v11 offset:28672
    v_cvt_pk_bf16_f32 v173, v214, v215
    v_mfma_f32_16x16x32_bf16 a[84:87], a[172:175], v[140:143], a[84:87]
    s_waitcnt vmcnt(13)
    s_barrier
    v_mfma_f32_16x16x32_bf16 v[212:215], a[208:211], v[112:115], v[204:207]
    v_exp_f32 v208, v208
    v_mfma_f32_16x16x32_bf16 v[212:215], a[212:215], v[116:119], v[212:215]
    s_add_u32 s49, s45, 1024
    v_exp_f32 v209, v209
    v_mfma_f32_16x16x32_bf16 v[212:215], a[216:219], v[120:123], v[212:215]
    s_add_u32 m0, s42, 0
    v_exp_f32 v210, v210
    v_mfma_f32_16x16x32_bf16 v[212:215], a[220:223], v[124:127], v[212:215]
    v_exp_f32 v211, v211
    v_mfma_f32_16x16x32_bf16 a[88:91], a[168:171], v[144:147], a[88:91]
    ds_read_b64_tr_b16 a[184:185], v27 offset:0
    v_cvt_pk_bf16_f32 v180, v208, v209
    v_mfma_f32_16x16x32_bf16 a[88:91], a[172:175], v[148:151], a[88:91]
    ds_read_b64_tr_b16 a[186:187], v27 offset:4096
    v_add_f32 v225, v225, v227
    v_mfma_f32_16x16x32_bf16 a[92:95], a[168:171], v[152:155], a[92:95]
    ds_read_b128 a[208:211], v8 offset:32768
    v_cvt_pk_bf16_f32 v181, v210, v211
    v_mfma_f32_16x16x32_bf16 a[92:95], a[172:175], v[156:159], a[92:95]
    s_waitcnt lgkmcnt(3)
    buffer_load_dwordx4 v46, s[20:23], s49 offen lds
    v_mfma_f32_16x16x32_bf16 v[208:211], a[224:227], v[64:67], v[192:195]
    v_exp_f32 v212, v212
    v_mfma_f32_16x16x32_bf16 v[208:211], a[228:231], v[68:71], v[208:211]
    v_exp_f32 v213, v213
    v_mfma_f32_16x16x32_bf16 v[208:211], a[232:235], v[72:75], v[208:211]
    v_exp_f32 v214, v214
    v_mfma_f32_16x16x32_bf16 v[208:211], a[236:239], v[76:79], v[208:211]
    s_add_u32 s37, s55, 0
    v_exp_f32 v215, v215
    v_mfma_f32_16x16x32_bf16 a[96:99], a[176:179], v[128:131], a[96:99]
    ds_read_b64_tr_b16 a[188:189], v27 offset:8192
    v_cvt_pk_bf16_f32 v188, v212, v213
    v_mfma_f32_16x16x32_bf16 a[96:99], a[180:183], v[132:135], a[96:99]
    ds_read_b64_tr_b16 a[190:191], v27 offset:12288
    v_lshrrev_b32 v245, 4, v1
    v_mfma_f32_16x16x32_bf16 a[100:103], a[176:179], v[136:139], a[100:103]
    ds_read_b128 a[212:215], v9 offset:32768
    v_cvt_pk_bf16_f32 v189, v214, v215
    v_mfma_f32_16x16x32_bf16 a[100:103], a[180:183], v[140:143], a[100:103]
    buffer_load_dword v239, v238, s[28:31], s37 offen
    v_mfma_f32_16x16x32_bf16 v[212:215], a[224:227], v[80:83], v[196:199]
    v_exp_f32 v208, v208
    v_mfma_f32_16x16x32_bf16 v[212:215], a[228:231], v[84:87], v[212:215]
    v_exp_f32 v209, v209
    v_mfma_f32_16x16x32_bf16 v[212:215], a[232:235], v[88:91], v[212:215]
    v_exp_f32 v210, v210
    v_mfma_f32_16x16x32_bf16 v[212:215], a[236:239], v[92:95], v[212:215]
    v_exp_f32 v211, v211
    v_mfma_f32_16x16x32_bf16 a[104:107], a[176:179], v[144:147], a[104:107]
    ds_read_b64_tr_b16 a[160:161], v20 offset:16384
    v_cvt_pk_bf16_f32 v166, v208, v209
    v_mfma_f32_16x16x32_bf16 a[104:107], a[180:183], v[148:151], a[104:107]
    ds_read_b64_tr_b16 a[162:163], v20 offset:20480
    v_lshl_add_u32 v244, v245, 3, v244
    v_mfma_f32_16x16x32_bf16 a[108:111], a[176:179], v[152:155], a[108:111]
    ds_read_b128 a[216:219], v10 offset:32768
    v_cvt_pk_bf16_f32 v167, v210, v211
    v_mfma_f32_16x16x32_bf16 a[108:111], a[180:183], v[156:159], a[108:111]
    s_waitcnt lgkmcnt(3)
    buffer_load_dwordx4 v47, s[20:23], s49 offen offset:1024 lds
    v_mfma_f32_16x16x32_bf16 v[208:211], a[224:227], v[96:99], v[200:203]
    v_exp_f32 v212, v212
    v_mfma_f32_16x16x32_bf16 v[208:211], a[228:231], v[100:103], v[208:211]
    v_exp_f32 v213, v213
    v_mfma_f32_16x16x32_bf16 v[208:211], a[232:235], v[104:107], v[208:211]
    v_exp_f32 v214, v214
    v_mfma_f32_16x16x32_bf16 v[208:211], a[236:239], v[108:111], v[208:211]
    s_add_u32 s57, s58, 1769472
    v_exp_f32 v215, v215
    v_mfma_f32_16x16x32_bf16 a[112:115], a[184:187], v[128:131], a[112:115]
    ds_read_b64_tr_b16 a[164:165], v20 offset:24576
    v_cvt_pk_bf16_f32 v174, v212, v213
    v_mfma_f32_16x16x32_bf16 a[112:115], a[188:191], v[132:135], a[112:115]
    ds_read_b64_tr_b16 a[166:167], v20 offset:28672
    v_mfma_f32_16x16x32_bf16 a[116:119], a[184:187], v[136:139], a[116:119]
    ds_read_b128 a[220:223], v11 offset:32768
    v_cvt_pk_bf16_f32 v175, v214, v215
    v_mfma_f32_16x16x32_bf16 a[116:119], a[188:191], v[140:143], a[116:119]
    buffer_load_dwordx4 a[140:143], v254, s[80:83], s57 offen
    v_mfma_f32_16x16x32_bf16 v[212:215], a[224:227], v[112:115], v[204:207]
    v_exp_f32 v208, v208
    v_mfma_f32_16x16x32_bf16 v[212:215], a[228:231], v[116:119], v[212:215]
    v_exp_f32 v209, v209
    v_mfma_f32_16x16x32_bf16 v[212:215], a[232:235], v[120:123], v[212:215]
    v_exp_f32 v210, v210
    v_mfma_f32_16x16x32_bf16 v[212:215], a[236:239], v[124:127], v[212:215]
    v_exp_f32 v211, v211
    v_mfma_f32_16x16x32_bf16 a[120:123], a[184:187], v[144:147], a[120:123]
    ds_read_b64_tr_b16 a[168:169], v21 offset:16384
    v_cvt_pk_bf16_f32 v182, v208, v209
    v_mfma_f32_16x16x32_bf16 a[120:123], a[188:191], v[148:151], a[120:123]
    ds_read_b64_tr_b16 a[170:171], v21 offset:20480
    v_mfma_f32_16x16x32_bf16 a[124:127], a[184:187], v[152:155], a[124:127]
    ds_read_b128 a[224:227], v8 offset:36864
    v_cvt_pk_bf16_f32 v183, v210, v211
    v_mfma_f32_16x16x32_bf16 a[124:127], a[188:191], v[156:159], a[124:127]
    s_waitcnt lgkmcnt(3)
    buffer_load_dwordx4 v48, s[20:23], s49 offen offset:2048 lds
    v_mfma_f32_16x16x32_bf16 v[208:211], a[208:211], v[64:67], v[192:195]
    v_exp_f32 v212, v212
    v_mfma_f32_16x16x32_bf16 v[208:211], a[212:215], v[68:71], v[208:211]
    v_exp_f32 v213, v213
    v_mfma_f32_16x16x32_bf16 v[208:211], a[216:219], v[72:75], v[208:211]
    v_exp_f32 v214, v214
    v_mfma_f32_16x16x32_bf16 v[208:211], a[220:223], v[76:79], v[208:211]
    s_add_u32 s57, s58, 2359296
    v_exp_f32 v215, v215
    v_mfma_f32_16x16x32_bf16 a[0:3], a[160:163], v[160:163], a[0:3]
    ds_read_b64_tr_b16 a[172:173], v21 offset:24576
    v_cvt_pk_bf16_f32 v190, v212, v213
    v_mfma_f32_16x16x32_bf16 a[0:3], a[164:167], v[164:167], a[0:3]
    ds_read_b64_tr_b16 a[174:175], v21 offset:28672
    v_mov_b32 v63, 0
    v_mfma_f32_16x16x32_bf16 a[4:7], a[160:163], v[168:171], a[4:7]
    ds_read_b128 a[228:231], v9 offset:36864
    v_cvt_pk_bf16_f32 v191, v214, v215
    v_mfma_f32_16x16x32_bf16 a[4:7], a[164:167], v[172:175], a[4:7]
    buffer_load_dwordx4 a[144:147], v254, s[80:83], s57 offen
    v_mfma_f32_16x16x32_bf16 v[212:215], a[208:211], v[80:83], v[196:199]
    v_exp_f32 v208, v208
    v_mfma_f32_16x16x32_bf16 v[212:215], a[212:215], v[84:87], v[212:215]
    v_exp_f32 v209, v209
    v_mfma_f32_16x16x32_bf16 v[212:215], a[216:219], v[88:91], v[212:215]
    v_exp_f32 v210, v210
    v_mfma_f32_16x16x32_bf16 v[212:215], a[220:223], v[92:95], v[212:215]
    v_exp_f32 v211, v211
    v_mfma_f32_16x16x32_bf16 a[8:11], a[160:163], v[176:179], a[8:11]
    ds_read_b64_tr_b16 a[176:177], v22 offset:16384
    v_cvt_pk_bf16_f32 v128, v208, v209
    v_mfma_f32_16x16x32_bf16 a[8:11], a[164:167], v[180:183], a[8:11]
    ds_read_b64_tr_b16 a[178:179], v22 offset:20480
    v_add_f32_dpp v224, v224, v224 row_ror:2 row_mask:0xf bank_mask:0xf
    v_mfma_f32_16x16x32_bf16 a[12:15], a[160:163], v[184:187], a[12:15]
    ds_read_b128 a[232:235], v10 offset:36864
    v_cvt_pk_bf16_f32 v129, v210, v211
    v_mfma_f32_16x16x32_bf16 a[12:15], a[164:167], v[188:191], a[12:15]
    s_waitcnt lgkmcnt(3)
    buffer_load_dwordx4 v49, s[20:23], s49 offen offset:3072 lds
    v_mfma_f32_16x16x32_bf16 v[208:211], a[208:211], v[96:99], v[200:203]
    s_lshr_b32 s39, s2, 5
    v_exp_f32 v212, v212
    v_mfma_f32_16x16x32_bf16 v[208:211], a[212:215], v[100:103], v[208:211]
    s_lshl_b32 s39, s39, 3
    v_exp_f32 v213, v213
    v_mfma_f32_16x16x32_bf16 v[208:211], a[216:219], v[104:107], v[208:211]
    s_and_b32 s43, s2, 7
    v_exp_f32 v214, v214
    v_mfma_f32_16x16x32_bf16 v[208:211], a[220:223], v[108:111], v[208:211]
    s_add_u32 s39, s39, s43
    v_exp_f32 v215, v215
    v_mfma_f32_16x16x32_bf16 a[16:19], a[168:171], v[160:163], a[16:19]
    ds_read_b64_tr_b16 a[180:181], v22 offset:24576
    v_cvt_pk_bf16_f32 v136, v212, v213
    v_mfma_f32_16x16x32_bf16 a[16:19], a[172:175], v[164:167], a[16:19]
    ds_read_b64_tr_b16 a[182:183], v22 offset:28672
    v_add_f32_dpp v225, v225, v225 row_ror:2 row_mask:0xf bank_mask:0xf
    v_mfma_f32_16x16x32_bf16 a[20:23], a[168:171], v[168:171], a[20:23]
    ds_read_b128 a[236:239], v11 offset:36864
    v_cvt_pk_bf16_f32 v137, v214, v215
    v_mfma_f32_16x16x32_bf16 a[20:23], a[172:175], v[172:175], a[20:23]
    buffer_load_dword v253, v63, s[24:27], s54 offen offset:12 sc1
    v_smfmac_f32_16x16x64_bf16 a[192:195], v[52:55], v[160:167], v50
    v_mfma_f32_16x16x32_bf16 v[212:215], a[208:211], v[112:115], v[204:207]
    s_lshl_b32 s39, s39, 2
    v_exp_f32 v208, v208
    v_mfma_f32_16x16x32_bf16 v[212:215], a[212:215], v[116:119], v[212:215]
    s_add_u32 m0, s42, 114688
    v_exp_f32 v209, v209
    v_mfma_f32_16x16x32_bf16 v[212:215], a[216:219], v[120:123], v[212:215]
    s_bfe_u32 s43, s2, 0x20003
    v_exp_f32 v210, v210
    v_mfma_f32_16x16x32_bf16 v[212:215], a[220:223], v[124:127], v[212:215]
    s_add_u32 s39, s39, s43
    v_exp_f32 v211, v211
    v_mfma_f32_16x16x32_bf16 a[24:27], a[168:171], v[176:179], a[24:27]
    ds_read_b64_tr_b16 a[184:185], v23 offset:16384
    v_cvt_pk_bf16_f32 v144, v208, v209
    v_mfma_f32_16x16x32_bf16 a[24:27], a[172:175], v[180:183], a[24:27]
    ds_read_b64_tr_b16 a[186:187], v23 offset:20480
    v_add_f32_dpp v224, v224, v224 row_ror:4 row_mask:0xf bank_mask:0xf
    v_mfma_f32_16x16x32_bf16 a[28:31], a[168:171], v[184:187], a[28:31]
    ds_read_b128 a[208:211], v8 offset:40960
    v_cvt_pk_bf16_f32 v145, v210, v211
    v_mfma_f32_16x16x32_bf16 a[28:31], a[172:175], v[188:191], a[28:31]
    s_waitcnt lgkmcnt(3)
    buffer_load_dwordx4 v40, s[12:15], s41 offen lds
    v_mfma_f32_16x16x32_bf16 v[208:211], a[224:227], v[64:67], v[192:195]
    s_add_u32 s39, s39, 72
    v_exp_f32 v212, v212
    v_mfma_f32_16x16x32_bf16 v[208:211], a[228:231], v[68:71], v[208:211]
    s_cmp_lt_u32 s39, 216
    s_cselect_b32 s43, 0, 2147483648
    v_exp_f32 v213, v213
    v_mfma_f32_16x16x32_bf16 v[208:211], a[232:235], v[72:75], v[208:211]
    s_or_b32 s43, s43, s48
    v_exp_f32 v214, v214
    v_mfma_f32_16x16x32_bf16 v[208:211], a[236:239], v[76:79], v[208:211]
    s_add_u32 s57, s58, 2949120
    v_exp_f32 v215, v215
    v_mfma_f32_16x16x32_bf16 a[32:35], a[176:179], v[160:163], a[32:35]
    ds_read_b64_tr_b16 a[188:189], v23 offset:24576
    v_cvt_pk_bf16_f32 v152, v212, v213
    v_mfma_f32_16x16x32_bf16 a[32:35], a[180:183], v[164:167], a[32:35]
    ds_read_b64_tr_b16 a[190:191], v23 offset:28672
    v_add_f32_dpp v225, v225, v225 row_ror:4 row_mask:0xf bank_mask:0xf
    v_mfma_f32_16x16x32_bf16 a[36:39], a[176:179], v[168:171], a[36:39]
    ds_read_b128 a[212:215], v9 offset:40960
    v_cvt_pk_bf16_f32 v153, v214, v215
    v_mfma_f32_16x16x32_bf16 a[36:39], a[180:183], v[172:175], a[36:39]
    buffer_load_dwordx4 a[148:151], v254, s[80:83], s57 offen
    v_smfmac_f32_16x16x64_bf16 a[196:199], v[52:55], v[168:175], v50
    v_mfma_f32_16x16x32_bf16 v[212:215], a[224:227], v[80:83], v[196:199]
    s_and_b32 s43, s43, 2147483648
    v_exp_f32 v208, v208
    v_mfma_f32_16x16x32_bf16 v[212:215], a[228:231], v[84:87], v[212:215]
    s_sub_u32 s36, s39, 144
    v_exp_f32 v209, v209
    v_mfma_f32_16x16x32_bf16 v[212:215], a[232:235], v[88:91], v[212:215]
    s_cmp_lt_u32 s36, 36
    s_cselect_b32 s36, 1.0, 0
    v_exp_f32 v210, v210
    v_mfma_f32_16x16x32_bf16 v[212:215], a[236:239], v[92:95], v[212:215]
    s_lshr_b32 s44, s39, 1
    v_exp_f32 v211, v211
    v_mfma_f32_16x16x32_bf16 a[40:43], a[176:179], v[176:179], a[40:43]
    ds_read_b64_tr_b16 a[160:161], v24 offset:16384
    v_cvt_pk_bf16_f32 v130, v208, v209
    v_mfma_f32_16x16x32_bf16 a[40:43], a[180:183], v[180:183], a[40:43]
    ds_read_b64_tr_b16 a[162:163], v24 offset:20480
    v_add_f32_dpp v224, v224, v224 row_ror:8 row_mask:0xf bank_mask:0xf
    v_mfma_f32_16x16x32_bf16 a[44:47], a[176:179], v[184:187], a[44:47]
    ds_read_b128 a[216:219], v10 offset:40960
    v_cvt_pk_bf16_f32 v131, v210, v211
    v_mfma_f32_16x16x32_bf16 a[44:47], a[180:183], v[188:191], a[44:47]
    s_waitcnt lgkmcnt(3)
    buffer_load_dwordx4 v41, s[12:15], s41 offen offset:1024 lds
    v_mfma_f32_16x16x32_bf16 v[208:211], a[224:227], v[96:99], v[200:203]
    s_lshl_b32 s44, s44, 6
    v_exp_f32 v212, v212
    v_mfma_f32_16x16x32_bf16 v[208:211], a[228:231], v[100:103], v[208:211]
    s_and_b32 s39, s39, 1
    v_exp_f32 v213, v213
    v_mfma_f32_16x16x32_bf16 v[208:211], a[232:235], v[104:107], v[208:211]
    s_lshl_b32 s39, s39, 3
    v_exp_f32 v214, v214
    v_mfma_f32_16x16x32_bf16 v[208:211], a[236:239], v[108:111], v[208:211]
    s_add_u32 s39, s39, s44
    v_exp_f32 v215, v215
    v_mfma_f32_16x16x32_bf16 a[48:51], a[184:187], v[160:163], a[48:51]
    ds_read_b64_tr_b16 a[164:165], v24 offset:24576
    v_cvt_pk_bf16_f32 v138, v212, v213
    v_mfma_f32_16x16x32_bf16 a[48:51], a[188:191], v[164:167], a[48:51]
    ds_read_b64_tr_b16 a[166:167], v24 offset:28672
    v_add_f32_dpp v225, v225, v225 row_ror:8 row_mask:0xf bank_mask:0xf
    v_mfma_f32_16x16x32_bf16 a[52:55], a[184:187], v[168:171], a[52:55]
    ds_read_b128 a[220:223], v11 offset:40960
    v_cvt_pk_bf16_f32 v139, v214, v215
    v_mfma_f32_16x16x32_bf16 a[52:55], a[188:191], v[172:175], a[52:55]
    v_add_u32 v244, s38, v244
    v_and_b32 v245, 7, v1
    v_smfmac_f32_16x16x64_bf16 a[200:203], v[52:55], v[176:183], v50
    v_mfma_f32_16x16x32_bf16 v[212:215], a[224:227], v[112:115], v[204:207]
    s_add_u32 s39, s39, 16384
    v_exp_f32 v208, v208
    v_mfma_f32_16x16x32_bf16 v[212:215], a[228:231], v[116:119], v[212:215]
    s_or_b32 s39, s39, s43
    v_exp_f32 v209, v209
    v_mfma_f32_16x16x32_bf16 v[212:215], a[232:235], v[120:123], v[212:215]
    v_exp_f32 v210, v210
    v_mfma_f32_16x16x32_bf16 v[212:215], a[236:239], v[124:127], v[212:215]
    v_exp_f32 v211, v211
    v_mfma_f32_16x16x32_bf16 a[56:59], a[184:187], v[176:179], a[56:59]
    ds_read_b64_tr_b16 a[168:169], v25 offset:16384
    v_cvt_pk_bf16_f32 v146, v208, v209
    v_mfma_f32_16x16x32_bf16 a[56:59], a[188:191], v[180:183], a[56:59]
    ds_read_b64_tr_b16 a[170:171], v25 offset:20480
    v_mfma_f32_16x16x32_bf16 a[60:63], a[184:187], v[184:187], a[60:63]
    ds_read_b128 a[224:227], v8 offset:45056
    v_cvt_pk_bf16_f32 v147, v210, v211
    v_mfma_f32_16x16x32_bf16 a[60:63], a[188:191], v[188:191], a[60:63]
    s_waitcnt lgkmcnt(3)
    buffer_load_dwordx4 v40, s[12:15], s41 offen offset:2048 lds
    v_mfma_f32_16x16x32_bf16 v[208:211], a[208:211], v[64:67], v[192:195]
    v_exp_f32 v212, v212
    v_mfma_f32_16x16x32_bf16 v[208:211], a[212:215], v[68:71], v[208:211]
    v_exp_f32 v213, v213
    v_mfma_f32_16x16x32_bf16 v[208:211], a[216:219], v[72:75], v[208:211]
    v_exp_f32 v214, v214
    v_mfma_f32_16x16x32_bf16 v[208:211], a[220:223], v[76:79], v[208:211]
    s_add_u32 s57, s58, 3538944
    v_exp_f32 v215, v215
    v_mfma_f32_16x16x32_bf16 a[64:67], a[160:163], v[160:163], a[64:67]
    ds_read_b64_tr_b16 a[172:173], v25 offset:24576
    v_cvt_pk_bf16_f32 v154, v212, v213
    v_mfma_f32_16x16x32_bf16 a[64:67], a[164:167], v[164:167], a[64:67]
    ds_read_b64_tr_b16 a[174:175], v25 offset:28672
    v_lshlrev_b32 v245, 3, v245
    v_mfma_f32_16x16x32_bf16 a[68:71], a[160:163], v[168:171], a[68:71]
    ds_read_b128 a[228:231], v9 offset:45056
    v_cvt_pk_bf16_f32 v155, v214, v215
    v_mfma_f32_16x16x32_bf16 a[68:71], a[164:167], v[172:175], a[68:71]
    buffer_load_dwordx4 a[152:155], v254, s[80:83], s57 offen
    v_smfmac_f32_16x16x64_bf16 a[204:207], v[52:55], v[184:191], v50
    ds_write_b64 v244, v[224:225]
    v_mfma_f32_16x16x32_bf16 v[212:215], a[208:211], v[80:83], v[196:199]
    v_exp_f32 v208, v208
    v_mfma_f32_16x16x32_bf16 v[212:215], a[212:215], v[84:87], v[212:215]
    v_exp_f32 v209, v209
    v_mfma_f32_16x16x32_bf16 v[212:215], a[216:219], v[88:91], v[212:215]
    v_exp_f32 v210, v210
    v_mfma_f32_16x16x32_bf16 v[212:215], a[220:223], v[92:95], v[212:215]
    v_exp_f32 v211, v211
    v_mfma_f32_16x16x32_bf16 a[72:75], a[160:163], v[176:179], a[72:75]
    ds_read_b64_tr_b16 a[176:177], v26 offset:16384
    v_cvt_pk_bf16_f32 v132, v208, v209
    v_mfma_f32_16x16x32_bf16 a[72:75], a[164:167], v[180:183], a[72:75]
    ds_read_b64_tr_b16 a[178:179], v26 offset:20480
    v_add_u32 v245, 131136, v245
    v_mfma_f32_16x16x32_bf16 a[76:79], a[160:163], v[184:187], a[76:79]
    ds_read_b128 a[232:235], v10 offset:45056
    v_cvt_pk_bf16_f32 v133, v210, v211
    v_mfma_f32_16x16x32_bf16 a[76:79], a[164:167], v[188:191], a[76:79]
    s_waitcnt lgkmcnt(3)
    buffer_load_dwordx4 v41, s[12:15], s41 offen offset:3072 lds
    v_mfma_f32_16x16x32_bf16 v[208:211], a[208:211], v[96:99], v[200:203]
    v_exp_f32 v212, v212
    v_mfma_f32_16x16x32_bf16 v[208:211], a[212:215], v[100:103], v[208:211]
    s_add_u32 s41, s41, 16384
    v_exp_f32 v213, v213
    v_mfma_f32_16x16x32_bf16 v[208:211], a[216:219], v[104:107], v[208:211]
    v_exp_f32 v214, v214
    v_mfma_f32_16x16x32_bf16 v[208:211], a[220:223], v[108:111], v[208:211]
    v_exp_f32 v215, v215
    v_mfma_f32_16x16x32_bf16 a[80:83], a[168:171], v[160:163], a[80:83]
    ds_read_b64_tr_b16 a[180:181], v26 offset:24576
    v_cvt_pk_bf16_f32 v140, v212, v213
    v_mfma_f32_16x16x32_bf16 a[80:83], a[172:175], v[164:167], a[80:83]
    ds_read_b64_tr_b16 a[182:183], v26 offset:28672
    v_mfma_f32_16x16x32_bf16 a[84:87], a[168:171], v[168:171], a[84:87]
    ds_read_b128 a[236:239], v11 offset:45056
    v_cvt_pk_bf16_f32 v141, v214, v215
    v_mfma_f32_16x16x32_bf16 a[84:87], a[172:175], v[172:175], a[84:87]
    s_waitcnt vmcnt(14)
    s_barrier
    v_mfma_f32_16x16x32_bf16 v[212:215], a[208:211], v[112:115], v[204:207]
    v_exp_f32 v208, v208
    v_mfma_f32_16x16x32_bf16 v[212:215], a[212:215], v[116:119], v[212:215]
    s_add_u32 s49, s45, 74752
    v_exp_f32 v209, v209
    v_mfma_f32_16x16x32_bf16 v[212:215], a[216:219], v[120:123], v[212:215]
    s_add_u32 m0, s42, 16384
    v_exp_f32 v210, v210
    v_mfma_f32_16x16x32_bf16 v[212:215], a[220:223], v[124:127], v[212:215]
    v_exp_f32 v211, v211
    v_mfma_f32_16x16x32_bf16 a[88:91], a[168:171], v[176:179], a[88:91]
    ds_read_b64_tr_b16 a[184:185], v27 offset:16384
    v_cvt_pk_bf16_f32 v148, v208, v209
    v_mfma_f32_16x16x32_bf16 a[88:91], a[172:175], v[180:183], a[88:91]
    ds_read_b64_tr_b16 a[186:187], v27 offset:20480
    ds_read_b64 v[224:225], v245 offset:0
    v_mfma_f32_16x16x32_bf16 a[92:95], a[168:171], v[184:187], a[92:95]
    ds_read_b128 a[208:211], v8 offset:49152
    v_cvt_pk_bf16_f32 v149, v210, v211
    v_mfma_f32_16x16x32_bf16 a[92:95], a[172:175], v[188:191], a[92:95]
    s_waitcnt lgkmcnt(3)
    buffer_load_dwordx4 v46, s[20:23], s49 offen lds
    v_mfma_f32_16x16x32_bf16 v[208:211], a[224:227], v[64:67], v[192:195]
    v_exp_f32 v212, v212
    v_mfma_f32_16x16x32_bf16 v[208:211], a[228:231], v[68:71], v[208:211]
    v_exp_f32 v213, v213
    v_mfma_f32_16x16x32_bf16 v[208:211], a[232:235], v[72:75], v[208:211]
    v_exp_f32 v214, v214
    v_mfma_f32_16x16x32_bf16 v[208:211], a[236:239], v[76:79], v[208:211]
    s_add_u32 s37, s55, 8192
    v_exp_f32 v215, v215
    v_mfma_f32_16x16x32_bf16 a[96:99], a[176:179], v[160:163], a[96:99]
    ds_read_b64_tr_b16 a[188:189], v27 offset:24576
    v_cvt_pk_bf16_f32 v156, v212, v213
    v_mfma_f32_16x16x32_bf16 a[96:99], a[180:183], v[164:167], a[96:99]
    ds_read_b64_tr_b16 a[190:191], v27 offset:28672
    ds_read_b64 v[226:227], v245 offset:64
    v_mfma_f32_16x16x32_bf16 a[100:103], a[176:179], v[168:171], a[100:103]
    ds_read_b128 a[212:215], v9 offset:49152
    v_cvt_pk_bf16_f32 v157, v214, v215
    v_mfma_f32_16x16x32_bf16 a[100:103], a[180:183], v[172:175], a[100:103]
    buffer_load_dword v234, v238, s[28:31], s37 offen
    v_mfma_f32_16x16x32_bf16 v[212:215], a[224:227], v[80:83], v[196:199]
    v_exp_f32 v208, v208
    v_mfma_f32_16x16x32_bf16 v[212:215], a[228:231], v[84:87], v[212:215]
    v_exp_f32 v209, v209
    v_mfma_f32_16x16x32_bf16 v[212:215], a[232:235], v[88:91], v[212:215]
    v_exp_f32 v210, v210
    v_mfma_f32_16x16x32_bf16 v[212:215], a[236:239], v[92:95], v[212:215]
    v_exp_f32 v211, v211
    v_mfma_f32_16x16x32_bf16 a[104:107], a[176:179], v[176:179], a[104:107]
    ds_read_b64_tr_b16 a[160:161], v20 offset:32768
    v_cvt_pk_bf16_f32 v134, v208, v209
    v_mfma_f32_16x16x32_bf16 a[104:107], a[180:183], v[180:183], a[104:107]
    ds_read_b64_tr_b16 a[162:163], v20 offset:36864
    ds_read_b64 v[228:229], v245 offset:128
    v_mfma_f32_16x16x32_bf16 a[108:111], a[176:179], v[184:187], a[108:111]
    ds_read_b128 a[216:219], v10 offset:49152
    v_cvt_pk_bf16_f32 v135, v210, v211
    v_mfma_f32_16x16x32_bf16 a[108:111], a[180:183], v[188:191], a[108:111]
    s_waitcnt lgkmcnt(3)
    buffer_load_dwordx4 v47, s[20:23], s49 offen offset:1024 lds
    v_mfma_f32_16x16x32_bf16 v[208:211], a[224:227], v[96:99], v[200:203]
    v_exp_f32 v212, v212
    v_mfma_f32_16x16x32_bf16 v[208:211], a[228:231], v[100:103], v[208:211]
    v_exp_f32 v213, v213
    v_mfma_f32_16x16x32_bf16 v[208:211], a[232:235], v[104:107], v[208:211]
    v_exp_f32 v214, v214
    v_mfma_f32_16x16x32_bf16 v[208:211], a[236:239], v[108:111], v[208:211]
    s_add_u32 s57, s58, 4128768
    v_exp_f32 v215, v215
    v_mfma_f32_16x16x32_bf16 a[112:115], a[184:187], v[160:163], a[112:115]
    ds_read_b64_tr_b16 a[164:165], v20 offset:40960
    v_cvt_pk_bf16_f32 v142, v212, v213
    v_mfma_f32_16x16x32_bf16 a[112:115], a[188:191], v[164:167], a[112:115]
    ds_read_b64_tr_b16 a[166:167], v20 offset:45056
    ds_read_b64 v[230:231], v245 offset:192
    v_mfma_f32_16x16x32_bf16 a[116:119], a[184:187], v[168:171], a[116:119]
    ds_read_b128 a[220:223], v11 offset:49152
    v_cvt_pk_bf16_f32 v143, v214, v215
    v_mfma_f32_16x16x32_bf16 a[116:119], a[188:191], v[172:175], a[116:119]
    buffer_load_dwordx4 a[156:159], v254, s[80:83], s57 offen
    v_mfma_f32_16x16x32_bf16 v[212:215], a[224:227], v[112:115], v[204:207]
    v_exp_f32 v208, v208
    v_mfma_f32_16x16x32_bf16 v[212:215], a[228:231], v[116:119], v[212:215]
    v_exp_f32 v209, v209
    v_mfma_f32_16x16x32_bf16 v[212:215], a[232:235], v[120:123], v[212:215]
    v_exp_f32 v210, v210
    v_mfma_f32_16x16x32_bf16 v[212:215], a[236:239], v[124:127], v[212:215]
    v_exp_f32 v211, v211
    v_mfma_f32_16x16x32_bf16 a[120:123], a[184:187], v[176:179], a[120:123]
    ds_read_b64_tr_b16 a[168:169], v21 offset:32768
    v_cvt_pk_bf16_f32 v150, v208, v209
    v_mfma_f32_16x16x32_bf16 a[120:123], a[188:191], v[180:183], a[120:123]
    ds_read_b64_tr_b16 a[170:171], v21 offset:36864
    v_mfma_f32_16x16x32_bf16 a[124:127], a[184:187], v[184:187], a[124:127]
    ds_read_b128 a[224:227], v8 offset:53248
    v_cvt_pk_bf16_f32 v151, v210, v211
    v_mfma_f32_16x16x32_bf16 a[124:127], a[188:191], v[188:191], a[124:127]
    s_waitcnt lgkmcnt(3)
    buffer_load_dwordx4 v48, s[20:23], s49 offen offset:2048 lds
    v_mfma_f32_16x16x32_bf16 v[208:211], a[208:211], v[64:67], v[192:195]
    v_exp_f32 v212, v212
    v_mfma_f32_16x16x32_bf16 v[208:211], a[212:215], v[68:71], v[208:211]
    v_exp_f32 v213, v213
    v_mfma_f32_16x16x32_bf16 v[208:211], a[216:219], v[72:75], v[208:211]
    v_exp_f32 v214, v214
    v_mfma_f32_16x16x32_bf16 v[208:211], a[220:223], v[76:79], v[208:211]
    s_add_u32 s57, s58, 4718592
    v_exp_f32 v215, v215
    v_mfma_f32_16x16x32_bf16 a[0:3], a[160:163], v[128:131], a[0:3]
    ds_read_b64_tr_b16 a[172:173], v21 offset:40960
    v_cvt_pk_bf16_f32 v158, v212, v213
    v_mfma_f32_16x16x32_bf16 a[0:3], a[164:167], v[132:135], a[0:3]
    ds_read_b64_tr_b16 a[174:175], v21 offset:45056
    v_add_f32 v224, v224, v228
    v_mfma_f32_16x16x32_bf16 a[4:7], a[160:163], v[136:139], a[4:7]
    ds_read_b128 a[228:231], v9 offset:53248
    v_cvt_pk_bf16_f32 v159, v214, v215
    v_mfma_f32_16x16x32_bf16 a[4:7], a[164:167], v[140:143], a[4:7]
Ltour7:
    s_cbranch_execz Ltour11
    buffer_load_dwordx4 a[240:243], v254, s[80:83], s57 offen
    v_mfma_f32_16x16x32_bf16 v[212:215], a[208:211], v[80:83], v[196:199]
    v_exp_f32 v208, v208
    v_mfma_f32_16x16x32_bf16 v[212:215], a[212:215], v[84:87], v[212:215]
    v_exp_f32 v209, v209
    v_mfma_f32_16x16x32_bf16 v[212:215], a[216:219], v[88:91], v[212:215]
    v_exp_f32 v210, v210
    v_mfma_f32_16x16x32_bf16 v[212:215], a[220:223], v[92:95], v[212:215]
    v_exp_f32 v211, v211
    v_mfma_f32_16x16x32_bf16 a[8:11], a[160:163], v[144:147], a[8:11]
    ds_read_b64_tr_b16 a[176:177], v22 offset:32768
    v_cvt_pk_bf16_f32 v160, v208, v209
    v_mfma_f32_16x16x32_bf16 a[8:11], a[164:167], v[148:151], a[8:11]
    ds_read_b64_tr_b16 a[178:179], v22 offset:36864
    v_add_f32 v225, v225, v229
    v_mfma_f32_16x16x32_bf16 a[12:15], a[160:163], v[152:155], a[12:15]
    ds_read_b128 a[232:235], v10 offset:53248
    v_cvt_pk_bf16_f32 v161, v210, v211
    v_mfma_f32_16x16x32_bf16 a[12:15], a[164:167], v[156:159], a[12:15]
    s_waitcnt lgkmcnt(3)
    buffer_load_dwordx4 v49, s[20:23], s49 offen offset:3072 lds
    v_mfma_f32_16x16x32_bf16 v[208:211], a[208:211], v[96:99], v[200:203]
    v_exp_f32 v212, v212
    v_mfma_f32_16x16x32_bf16 v[208:211], a[212:215], v[100:103], v[208:211]
    v_exp_f32 v213, v213
    v_mfma_f32_16x16x32_bf16 v[208:211], a[216:219], v[104:107], v[208:211]
    v_exp_f32 v214, v214
    v_mfma_f32_16x16x32_bf16 v[208:211], a[220:223], v[108:111], v[208:211]
    v_exp_f32 v215, v215
    v_mfma_f32_16x16x32_bf16 a[16:19], a[168:171], v[128:131], a[16:19]
    ds_read_b64_tr_b16 a[180:181], v22 offset:40960
    v_cvt_pk_bf16_f32 v168, v212, v213
    v_mfma_f32_16x16x32_bf16 a[16:19], a[172:175], v[132:135], a[16:19]
    ds_read_b64_tr_b16 a[182:183], v22 offset:45056
    v_add_f32 v226, v226, v230
    v_mfma_f32_16x16x32_bf16 a[20:23], a[168:171], v[136:139], a[20:23]
    ds_read_b128 a[236:239], v11 offset:53248
    v_cvt_pk_bf16_f32 v169, v214, v215
    v_mfma_f32_16x16x32_bf16 a[20:23], a[172:175], v[140:143], a[20:23]
    v_add_f32 v227, v227, v231
    v_add_f32 v224, v224, v226
    v_smfmac_f32_16x16x64_bf16 a[192:195], v[52:55], v[128:135], v50
    v_mfma_f32_16x16x32_bf16 v[212:215], a[208:211], v[112:115], v[204:207]
    v_exp_f32 v208, v208
    v_mfma_f32_16x16x32_bf16 v[212:215], a[212:215], v[116:119], v[212:215]
    s_add_u32 s49, s7, 0
    v_exp_f32 v209, v209
    v_mfma_f32_16x16x32_bf16 v[212:215], a[216:219], v[120:123], v[212:215]
    s_add_u32 m0, s42, 65536
    v_exp_f32 v210, v210
    v_mfma_f32_16x16x32_bf16 v[212:215], a[220:223], v[124:127], v[212:215]
    v_exp_f32 v211, v211
    v_mfma_f32_16x16x32_bf16 a[24:27], a[168:171], v[144:147], a[24:27]
    ds_read_b64_tr_b16 a[184:185], v23 offset:32768
    v_cvt_pk_bf16_f32 v176, v208, v209
    v_mfma_f32_16x16x32_bf16 a[24:27], a[172:175], v[148:151], a[24:27]
    ds_read_b64_tr_b16 a[186:187], v23 offset:36864
    v_add_f32 v225, v225, v227
    v_mfma_f32_16x16x32_bf16 a[28:31], a[168:171], v[152:155], a[28:31]
    ds_read_b128 a[208:211], v8 offset:57344
    v_cvt_pk_bf16_f32 v177, v210, v211
    v_mfma_f32_16x16x32_bf16 a[28:31], a[172:175], v[156:159], a[28:31]
    s_waitcnt lgkmcnt(3)
    buffer_load_dwordx4 v46, s[20:23], s49 offen lds
    v_mfma_f32_16x16x32_bf16 v[208:211], a[224:227], v[64:67], v[192:195]
    v_exp_f32 v212, v212
    v_mfma_f32_16x16x32_bf16 v[208:211], a[228:231], v[68:71], v[208:211]
    v_exp_f32 v213, v213
    v_mfma_f32_16x16x32_bf16 v[208:211], a[232:235], v[72:75], v[208:211]
    v_exp_f32 v214, v214
    v_mfma_f32_16x16x32_bf16 v[208:211], a[236:239], v[76:79], v[208:211]
    s_add_u32 s57, s58, 4128768
    v_exp_f32 v215, v215
    v_mfma_f32_16x16x32_bf16 a[32:35], a[176:179], v[128:131], a[32:35]
    ds_read_b64_tr_b16 a[188:189], v23 offset:40960
    v_cvt_pk_bf16_f32 v184, v212, v213
    v_mfma_f32_16x16x32_bf16 a[32:35], a[180:183], v[132:135], a[32:35]
    ds_read_b64_tr_b16 a[190:191], v23 offset:45056
    v_cvt_pk_bf16_f32 v246, v224, v225
    v_mfma_f32_16x16x32_bf16 a[36:39], a[176:179], v[136:139], a[36:39]
    ds_read_b128 a[212:215], v9 offset:57344
    v_cvt_pk_bf16_f32 v185, v214, v215
    v_mfma_f32_16x16x32_bf16 a[36:39], a[180:183], v[140:143], a[36:39]
    buffer_load_dwordx4 a[244:247], v254, s[32:35], s57 offen
    v_smfmac_f32_16x16x64_bf16 a[196:199], v[52:55], v[136:143], v50
    v_mfma_f32_16x16x32_bf16 v[212:215], a[224:227], v[80:83], v[196:199]
    v_exp_f32 v208, v208
    v_mfma_f32_16x16x32_bf16 v[212:215], a[228:231], v[84:87], v[212:215]
    v_exp_f32 v209, v209
    v_mfma_f32_16x16x32_bf16 v[212:215], a[232:235], v[88:91], v[212:215]
    v_exp_f32 v210, v210
    v_mfma_f32_16x16x32_bf16 v[212:215], a[236:239], v[92:95], v[212:215]
    v_exp_f32 v211, v211
    v_mfma_f32_16x16x32_bf16 a[40:43], a[176:179], v[144:147], a[40:43]
    ds_read_b64_tr_b16 a[160:161], v24 offset:32768
    v_cvt_pk_bf16_f32 v162, v208, v209
    v_mfma_f32_16x16x32_bf16 a[40:43], a[180:183], v[148:151], a[40:43]
    ds_read_b64_tr_b16 a[162:163], v24 offset:36864
    v_lshlrev_b32 v224, 16, v246
    v_mfma_f32_16x16x32_bf16 a[44:47], a[176:179], v[152:155], a[44:47]
    ds_read_b128 a[216:219], v10 offset:57344
    v_cvt_pk_bf16_f32 v163, v210, v211
    v_mfma_f32_16x16x32_bf16 a[44:47], a[180:183], v[156:159], a[44:47]
    s_waitcnt lgkmcnt(3)
    buffer_load_dwordx4 v47, s[20:23], s49 offen offset:1024 lds
    v_mfma_f32_16x16x32_bf16 v[208:211], a[224:227], v[96:99], v[200:203]
    v_exp_f32 v212, v212
    v_mfma_f32_16x16x32_bf16 v[208:211], a[228:231], v[100:103], v[208:211]
    v_exp_f32 v213, v213
    v_mfma_f32_16x16x32_bf16 v[208:211], a[232:235], v[104:107], v[208:211]
    v_exp_f32 v214, v214
    v_mfma_f32_16x16x32_bf16 v[208:211], a[236:239], v[108:111], v[208:211]
    v_exp_f32 v215, v215
    v_mfma_f32_16x16x32_bf16 a[48:51], a[184:187], v[128:131], a[48:51]
    ds_read_b64_tr_b16 a[164:165], v24 offset:40960
    v_cvt_pk_bf16_f32 v170, v212, v213
    v_mfma_f32_16x16x32_bf16 a[48:51], a[188:191], v[132:135], a[48:51]
    ds_read_b64_tr_b16 a[166:167], v24 offset:45056
    v_and_b32 v225, 0xffff0000, v246
    v_mfma_f32_16x16x32_bf16 a[52:55], a[184:187], v[136:139], a[52:55]
    ds_read_b128 a[220:223], v11 offset:57344
    v_cvt_pk_bf16_f32 v171, v214, v215
    v_mfma_f32_16x16x32_bf16 a[52:55], a[188:191], v[140:143], a[52:55]
    v_add_f32 v224, s36, v224
    v_add_f32 v225, s36, v225
    v_smfmac_f32_16x16x64_bf16 a[200:203], v[52:55], v[144:151], v50
    v_mfma_f32_16x16x32_bf16 v[212:215], a[224:227], v[112:115], v[204:207]
    v_exp_f32 v208, v208
    v_mfma_f32_16x16x32_bf16 v[212:215], a[228:231], v[116:119], v[212:215]
    v_exp_f32 v209, v209
    v_mfma_f32_16x16x32_bf16 v[212:215], a[232:235], v[120:123], v[212:215]
    v_exp_f32 v210, v210
    v_mfma_f32_16x16x32_bf16 v[212:215], a[236:239], v[124:127], v[212:215]
    v_exp_f32 v211, v211
    v_mfma_f32_16x16x32_bf16 a[56:59], a[184:187], v[144:147], a[56:59]
    ds_read_b64_tr_b16 a[168:169], v25 offset:32768
    v_cvt_pk_bf16_f32 v178, v208, v209
    v_mfma_f32_16x16x32_bf16 a[56:59], a[188:191], v[148:151], a[56:59]
    ds_read_b64_tr_b16 a[170:171], v25 offset:36864
    v_cvt_pk_bf16_f32 v246, v224, v225
    v_mfma_f32_16x16x32_bf16 a[60:63], a[184:187], v[152:155], a[60:63]
    ds_read_b128 a[224:227], v8 offset:61440
    v_cvt_pk_bf16_f32 v179, v210, v211
    v_mfma_f32_16x16x32_bf16 a[60:63], a[188:191], v[156:159], a[60:63]
    s_waitcnt lgkmcnt(3)
    buffer_load_dwordx4 v48, s[20:23], s49 offen offset:2048 lds
    v_mfma_f32_16x16x32_bf16 v[208:211], a[208:211], v[64:67], v[192:195]
    v_exp_f32 v212, v212
    v_mfma_f32_16x16x32_bf16 v[208:211], a[212:215], v[68:71], v[208:211]
    v_exp_f32 v213, v213
    v_mfma_f32_16x16x32_bf16 v[208:211], a[216:219], v[72:75], v[208:211]
    v_exp_f32 v214, v214
    v_mfma_f32_16x16x32_bf16 v[208:211], a[220:223], v[76:79], v[208:211]
    s_add_u32 s57, s58, 4718592
    v_exp_f32 v215, v215
    v_mfma_f32_16x16x32_bf16 a[64:67], a[160:163], v[128:131], a[64:67]
    ds_read_b64_tr_b16 a[172:173], v25 offset:40960
    v_cvt_pk_bf16_f32 v186, v212, v213
    v_mfma_f32_16x16x32_bf16 a[64:67], a[164:167], v[132:135], a[64:67]
    ds_read_b64_tr_b16 a[174:175], v25 offset:45056
    v_lshrrev_b32 v244, 1, v0
    v_mfma_f32_16x16x32_bf16 a[68:71], a[160:163], v[136:139], a[68:71]
    ds_read_b128 a[228:231], v9 offset:61440
    v_cvt_pk_bf16_f32 v187, v214, v215
    v_mfma_f32_16x16x32_bf16 a[68:71], a[164:167], v[140:143], a[68:71]
    buffer_load_dwordx4 a[248:251], v254, s[32:35], s57 offen
    v_smfmac_f32_16x16x64_bf16 a[204:207], v[52:55], v[152:159], v50
    v_mfma_f32_16x16x32_bf16 v[212:215], a[208:211], v[80:83], v[196:199]
    v_exp_f32 v208, v208
    v_mfma_f32_16x16x32_bf16 v[212:215], a[212:215], v[84:87], v[212:215]
    v_exp_f32 v209, v209
    v_mfma_f32_16x16x32_bf16 v[212:215], a[216:219], v[88:91], v[212:215]
    v_exp_f32 v210, v210
    v_mfma_f32_16x16x32_bf16 v[212:215], a[220:223], v[92:95], v[212:215]
    v_exp_f32 v211, v211
    v_mfma_f32_16x16x32_bf16 a[72:75], a[160:163], v[144:147], a[72:75]
    ds_read_b64_tr_b16 a[176:177], v26 offset:32768
    v_cvt_pk_bf16_f32 v164, v208, v209
    v_mfma_f32_16x16x32_bf16 a[72:75], a[164:167], v[148:151], a[72:75]
    ds_read_b64_tr_b16 a[178:179], v26 offset:36864
    v_lshlrev_b32 v244, 4, v244
    v_mfma_f32_16x16x32_bf16 a[76:79], a[160:163], v[152:155], a[76:79]
    ds_read_b128 a[232:235], v10 offset:61440
    v_cvt_pk_bf16_f32 v165, v210, v211
    v_mfma_f32_16x16x32_bf16 a[76:79], a[164:167], v[156:159], a[76:79]
    s_waitcnt lgkmcnt(3)
    buffer_load_dwordx4 v49, s[20:23], s49 offen offset:3072 lds
    v_mfma_f32_16x16x32_bf16 v[208:211], a[208:211], v[96:99], v[200:203]
    v_exp_f32 v212, v212
    v_mfma_f32_16x16x32_bf16 v[208:211], a[212:215], v[100:103], v[208:211]
    v_exp_f32 v213, v213
    v_mfma_f32_16x16x32_bf16 v[208:211], a[216:219], v[104:107], v[208:211]
    v_exp_f32 v214, v214
    v_mfma_f32_16x16x32_bf16 v[208:211], a[220:223], v[108:111], v[208:211]
    v_exp_f32 v215, v215
    v_mfma_f32_16x16x32_bf16 a[80:83], a[168:171], v[128:131], a[80:83]
    ds_read_b64_tr_b16 a[180:181], v26 offset:40960
    v_cvt_pk_bf16_f32 v172, v212, v213
    v_mfma_f32_16x16x32_bf16 a[80:83], a[172:175], v[132:135], a[80:83]
    ds_read_b64_tr_b16 a[182:183], v26 offset:45056
    v_and_b32 v245, 1, v0
    v_mfma_f32_16x16x32_bf16 a[84:87], a[168:171], v[136:139], a[84:87]
    ds_read_b128 a[236:239], v11 offset:61440
    v_cvt_pk_bf16_f32 v173, v214, v215
    v_mfma_f32_16x16x32_bf16 a[84:87], a[172:175], v[140:143], a[84:87]
    s_waitcnt vmcnt(13)
    s_barrier
    v_mfma_f32_16x16x32_bf16 v[212:215], a[208:211], v[112:115], v[204:207]
    v_exp_f32 v208, v208
    v_mfma_f32_16x16x32_bf16 v[212:215], a[212:215], v[116:119], v[212:215]
    s_add_u32 s49, s7, 73728
    v_exp_f32 v209, v209
    v_mfma_f32_16x16x32_bf16 v[212:215], a[216:219], v[120:123], v[212:215]
    s_add_u32 m0, s42, 81920
    v_exp_f32 v210, v210
    v_mfma_f32_16x16x32_bf16 v[212:215], a[220:223], v[124:127], v[212:215]
    v_exp_f32 v211, v211
    v_mfma_f32_16x16x32_bf16 a[88:91], a[168:171], v[144:147], a[88:91]
    ds_read_b64_tr_b16 a[184:185], v27 offset:32768
    v_cvt_pk_bf16_f32 v180, v208, v209
    v_mfma_f32_16x16x32_bf16 a[88:91], a[172:175], v[148:151], a[88:91]
    ds_read_b64_tr_b16 a[186:187], v27 offset:36864
    v_lshl_add_u32 v244, v245, 2, v244
    v_mfma_f32_16x16x32_bf16 a[92:95], a[168:171], v[152:155], a[92:95]
    v_cvt_pk_bf16_f32 v181, v210, v211
    v_mfma_f32_16x16x32_bf16 a[92:95], a[172:175], v[156:159], a[92:95]
    s_waitcnt lgkmcnt(3)
    buffer_load_dwordx4 v46, s[20:23], s49 offen lds
    v_mfma_f32_16x16x32_bf16 v[208:211], a[224:227], v[64:67], v[192:195]
    v_exp_f32 v212, v212
    v_mfma_f32_16x16x32_bf16 v[208:211], a[228:231], v[68:71], v[208:211]
    v_exp_f32 v213, v213
    v_mfma_f32_16x16x32_bf16 v[208:211], a[232:235], v[72:75], v[208:211]
    s_waitcnt lgkmcnt(2)
    v_exp_f32 v214, v214
    v_mfma_f32_16x16x32_bf16 v[208:211], a[236:239], v[76:79], v[208:211]
    v_exp_f32 v215, v215
    v_mfma_f32_16x16x32_bf16 a[96:99], a[176:179], v[128:131], a[96:99]
    ds_read_b64_tr_b16 a[188:189], v27 offset:40960
    v_cvt_pk_bf16_f32 v188, v212, v213
    v_mfma_f32_16x16x32_bf16 a[96:99], a[180:183], v[132:135], a[96:99]
    ds_read_b64_tr_b16 a[190:191], v27 offset:45056
    v_lshrrev_b32 v245, 3, v0
    v_mfma_f32_16x16x32_bf16 a[100:103], a[176:179], v[136:139], a[100:103]
    v_cvt_pk_bf16_f32 v189, v214, v215
    v_mfma_f32_16x16x32_bf16 a[100:103], a[180:183], v[140:143], a[100:103]
    v_min_u32 v245, 1, v245
    v_lshl_or_b32 v244, v245, 31, v244
    v_mfma_f32_16x16x32_bf16 v[212:215], a[224:227], v[80:83], v[196:199]
    v_exp_f32 v208, v208
    v_mfma_f32_16x16x32_bf16 v[212:215], a[228:231], v[84:87], v[212:215]
    v_exp_f32 v209, v209
    v_mfma_f32_16x16x32_bf16 v[212:215], a[232:235], v[88:91], v[212:215]
    v_exp_f32 v210, v210
    v_mfma_f32_16x16x32_bf16 v[212:215], a[236:239], v[92:95], v[212:215]
    v_exp_f32 v211, v211
    v_mfma_f32_16x16x32_bf16 a[104:107], a[176:179], v[144:147], a[104:107]
    ds_read_b64_tr_b16 a[160:161], v20 offset:49152
    v_cvt_pk_bf16_f32 v166, v208, v209
    v_mfma_f32_16x16x32_bf16 a[104:107], a[180:183], v[148:151], a[104:107]
    ds_read_b64_tr_b16 a[162:163], v20 offset:53248
    v_mfma_f32_16x16x32_bf16 a[108:111], a[176:179], v[152:155], a[108:111]
    v_cvt_pk_bf16_f32 v167, v210, v211
    v_mfma_f32_16x16x32_bf16 a[108:111], a[180:183], v[156:159], a[108:111]
    s_waitcnt lgkmcnt(3)
    buffer_load_dwordx4 v47, s[20:23], s49 offen offset:1024 lds
    v_mfma_f32_16x16x32_bf16 v[208:211], a[224:227], v[96:99], v[200:203]
    v_exp_f32 v212, v212
    v_mfma_f32_16x16x32_bf16 v[208:211], a[228:231], v[100:103], v[208:211]
    v_exp_f32 v213, v213
    v_mfma_f32_16x16x32_bf16 v[208:211], a[232:235], v[104:107], v[208:211]
    v_exp_f32 v214, v214
    v_mfma_f32_16x16x32_bf16 v[208:211], a[236:239], v[108:111], v[208:211]
    s_add_u32 s57, s59, 0
    v_exp_f32 v215, v215
    v_mfma_f32_16x16x32_bf16 a[112:115], a[184:187], v[128:131], a[112:115]
    s_waitcnt lgkmcnt(2)
    ds_read_b64_tr_b16 a[164:165], v20 offset:57344
    v_cvt_pk_bf16_f32 v174, v212, v213
    v_mfma_f32_16x16x32_bf16 a[112:115], a[188:191], v[132:135], a[112:115]
    ds_read_b64_tr_b16 a[166:167], v20 offset:61440
    v_mfma_f32_16x16x32_bf16 a[116:119], a[184:187], v[136:139], a[116:119]
    v_cvt_pk_bf16_f32 v175, v214, v215
    v_mfma_f32_16x16x32_bf16 a[116:119], a[188:191], v[140:143], a[116:119]
    buffer_load_dwordx4 a[252:255], v255, s[84:87], s57 offen
    v_mfma_f32_16x16x32_bf16 v[212:215], a[224:227], v[112:115], v[204:207]
    v_exp_f32 v208, v208
    v_mfma_f32_16x16x32_bf16 v[212:215], a[228:231], v[116:119], v[212:215]
    v_exp_f32 v209, v209
    v_mfma_f32_16x16x32_bf16 v[212:215], a[232:235], v[120:123], v[212:215]
    v_exp_f32 v210, v210
    v_mfma_f32_16x16x32_bf16 v[212:215], a[236:239], v[124:127], v[212:215]
    v_exp_f32 v211, v211
    v_mfma_f32_16x16x32_bf16 a[120:123], a[184:187], v[144:147], a[120:123]
    ds_read_b64_tr_b16 a[168:169], v21 offset:49152
    v_cvt_pk_bf16_f32 v182, v208, v209
    v_mfma_f32_16x16x32_bf16 a[120:123], a[188:191], v[148:151], a[120:123]
    ds_read_b64_tr_b16 a[170:171], v21 offset:53248
    v_mfma_f32_16x16x32_bf16 a[124:127], a[184:187], v[152:155], a[124:127]
    v_cvt_pk_bf16_f32 v183, v210, v211
    v_mfma_f32_16x16x32_bf16 a[124:127], a[188:191], v[156:159], a[124:127]
    s_waitcnt lgkmcnt(3)
    buffer_load_dwordx4 v48, s[20:23], s49 offen offset:2048 lds
    v_smfmac_f32_16x16x64_bf16 a[192:195], v[52:55], v[160:167], v50
    v_exp_f32 v212, v212
    v_smfmac_f32_16x16x64_bf16 a[196:199], v[52:55], v[168:175], v50
    v_exp_f32 v213, v213
    v_smfmac_f32_16x16x64_bf16 a[200:203], v[52:55], v[176:183], v50
    v_exp_f32 v214, v214
    v_exp_f32 v215, v215
    v_mfma_f32_16x16x32_bf16 a[0:3], a[160:163], v[160:163], a[0:3]
    s_waitcnt lgkmcnt(2)
    ds_read_b64_tr_b16 a[172:173], v21 offset:57344
    v_cvt_pk_bf16_f32 v190, v212, v213
    v_mfma_f32_16x16x32_bf16 a[0:3], a[164:167], v[164:167], a[0:3]
    ds_read_b64_tr_b16 a[174:175], v21 offset:61440
    v_mfma_f32_16x16x32_bf16 a[4:7], a[160:163], v[168:171], a[4:7]
    v_cvt_pk_bf16_f32 v191, v214, v215
    v_mfma_f32_16x16x32_bf16 a[4:7], a[164:167], v[172:175], a[4:7]
    buffer_store_dword v246, v244, s[24:27], s39 offen sc1
    v_smfmac_f32_16x16x64_bf16 a[204:207], v[52:55], v[184:191], v50
    v_mfma_f32_16x16x32_bf16 a[8:11], a[160:163], v[176:179], a[8:11]
    ds_read_b64_tr_b16 a[176:177], v22 offset:49152
    v_mfma_f32_16x16x32_bf16 a[8:11], a[164:167], v[180:183], a[8:11]
    ds_read_b64_tr_b16 a[178:179], v22 offset:53248
    v_accvgpr_read_b32 v216, a192
    v_accvgpr_read_b32 v217, a193
    v_mfma_f32_16x16x32_bf16 a[12:15], a[160:163], v[184:187], a[12:15]
    v_accvgpr_read_b32 v218, a196
    v_accvgpr_read_b32 v219, a197
    v_mfma_f32_16x16x32_bf16 a[12:15], a[164:167], v[188:191], a[12:15]
    s_waitcnt lgkmcnt(4)
    buffer_load_dwordx4 v49, s[20:23], s49 offen offset:3072 lds
    v_accvgpr_read_b32 v220, a200
    v_accvgpr_read_b32 v221, a201
    v_mfma_f32_16x16x32_bf16 a[16:19], a[168:171], v[160:163], a[16:19]
    s_waitcnt lgkmcnt(2)
    ds_read_b64_tr_b16 a[180:181], v22 offset:57344
    v_accvgpr_read_b32 v222, a204
    v_mfma_f32_16x16x32_bf16 a[16:19], a[172:175], v[164:167], a[16:19]
    ds_read_b64_tr_b16 a[182:183], v22 offset:61440
    v_accvgpr_read_b32 v223, a205
    v_add_f32 v58, v216, v217
    v_mfma_f32_16x16x32_bf16 a[20:23], a[168:171], v[168:171], a[20:23]
    v_add_f32 v59, v218, v219
    v_add_f32 v60, v220, v221
    v_mfma_f32_16x16x32_bf16 a[20:23], a[172:175], v[172:175], a[20:23]
    v_add_f32 v61, v222, v223
    v_add_f32 v216, v58, v59
    s_add_u32 s49, s7, 256
    s_add_u32 m0, s42, 32768
    v_mfma_f32_16x16x32_bf16 a[24:27], a[168:171], v[176:179], a[24:27]
    ds_read_b64_tr_b16 a[184:185], v23 offset:49152
    v_add_f32 v217, v60, v61
    v_mfma_f32_16x16x32_bf16 a[24:27], a[172:175], v[180:183], a[24:27]
    ds_read_b64_tr_b16 a[186:187], v23 offset:53248
    v_add_f32 v216, v216, v217
    v_cmp_ngt_f32 vcc, 1669332992, v216
    v_mfma_f32_16x16x32_bf16 a[28:31], a[168:171], v[184:187], a[28:31]
    v_rcp_f32 v58, v58
    v_rcp_f32 v59, v59
    v_mfma_f32_16x16x32_bf16 a[28:31], a[172:175], v[188:191], a[28:31]
    s_waitcnt lgkmcnt(4)
    buffer_load_dwordx4 v46, s[20:23], s49 offen lds
    v_rcp_f32 v60, v60
    v_rcp_f32 v61, v61
    v_mfma_f32_16x16x32_bf16 a[32:35], a[176:179], v[160:163], a[32:35]
    s_waitcnt lgkmcnt(2)
    ds_read_b64_tr_b16 a[188:189], v23 offset:57344
    v_mov_b32 v228, 131072
    v_mfma_f32_16x16x32_bf16 a[32:35], a[180:183], v[164:167], a[32:35]
    ds_read_b64_tr_b16 a[190:191], v23 offset:61440
    s_or_b32 s36, vcc_lo, vcc_hi
    v_mfma_f32_16x16x32_bf16 a[36:39], a[176:179], v[168:171], a[36:39]
    v_accvgpr_read_b32 v208, a0
    v_accvgpr_read_b32 v209, a1
    v_accvgpr_read_b32 v210, a2
    v_accvgpr_read_b32 v211, a3
    v_pk_mul_f32 v[208:209], v[208:209], v[58:59] op_sel:[0,0] op_sel_hi:[1,0]
    v_pk_mul_f32 v[210:211], v[210:211], v[58:59] op_sel:[0,0] op_sel_hi:[1,0]
    v_cvt_pk_bf16_f32 v128, v208, v209
    v_cvt_pk_bf16_f32 v129, v210, v211
    v_mfma_f32_16x16x32_bf16 a[36:39], a[180:183], v[172:175], a[36:39]
    v_accvgpr_read_b32 v212, a4
    v_accvgpr_read_b32 v213, a5
    v_accvgpr_read_b32 v214, a6
    v_accvgpr_read_b32 v215, a7
    v_pk_mul_f32 v[212:213], v[212:213], v[58:59] op_sel:[0,1] op_sel_hi:[1,1]
    v_pk_mul_f32 v[214:215], v[214:215], v[58:59] op_sel:[0,1] op_sel_hi:[1,1]
    v_cvt_pk_bf16_f32 v132, v212, v213
    v_cvt_pk_bf16_f32 v133, v214, v215
    v_mfma_f32_16x16x32_bf16 a[40:43], a[176:179], v[176:179], a[40:43]
    ds_read_b64_tr_b16 a[160:161], v24 offset:49152
    v_mov_b32 v218, s36
    v_mfma_f32_16x16x32_bf16 a[40:43], a[180:183], v[180:183], a[40:43]
    ds_read_b64_tr_b16 a[162:163], v24 offset:53248
    s_lshl_b32 s38, s3, 2
    v_mfma_f32_16x16x32_bf16 a[44:47], a[176:179], v[184:187], a[44:47]
    v_accvgpr_read_b32 v208, a8
    v_accvgpr_read_b32 v209, a9
    v_accvgpr_read_b32 v210, a10
    v_accvgpr_read_b32 v211, a11
    v_pk_mul_f32 v[208:209], v[208:209], v[60:61] op_sel:[0,0] op_sel_hi:[1,0]
    v_pk_mul_f32 v[210:211], v[210:211], v[60:61] op_sel:[0,0] op_sel_hi:[1,0]
    v_cvt_pk_bf16_f32 v136, v208, v209
    v_cvt_pk_bf16_f32 v137, v210, v211
    v_mfma_f32_16x16x32_bf16 a[44:47], a[180:183], v[188:191], a[44:47]
    s_waitcnt lgkmcnt(4)
    buffer_load_dwordx4 v47, s[20:23], s49 offen offset:1024 lds
    v_accvgpr_read_b32 v212, a12
    v_accvgpr_read_b32 v213, a13
    v_accvgpr_read_b32 v214, a14
    v_accvgpr_read_b32 v215, a15
    v_pk_mul_f32 v[212:213], v[212:213], v[60:61] op_sel:[0,1] op_sel_hi:[1,1]
    v_pk_mul_f32 v[214:215], v[214:215], v[60:61] op_sel:[0,1] op_sel_hi:[1,1]
    v_cvt_pk_bf16_f32 v140, v212, v213
    v_cvt_pk_bf16_f32 v141, v214, v215
    v_mfma_f32_16x16x32_bf16 a[48:51], a[184:187], v[160:163], a[48:51]
    s_waitcnt lgkmcnt(2)
    ds_read_b64_tr_b16 a[164:165], v24 offset:57344
    v_add_u32 v219, s38, v228
    v_mfma_f32_16x16x32_bf16 a[48:51], a[188:191], v[164:167], a[48:51]
    ds_read_b64_tr_b16 a[166:167], v24 offset:61440
    ds_write_b32 v219, v218
    v_mfma_f32_16x16x32_bf16 a[52:55], a[184:187], v[168:171], a[52:55]
    v_accvgpr_read_b32 v208, a16
    v_accvgpr_read_b32 v209, a17
    v_accvgpr_read_b32 v210, a18
    v_accvgpr_read_b32 v211, a19
    v_pk_mul_f32 v[208:209], v[208:209], v[58:59] op_sel:[0,0] op_sel_hi:[1,0]
    v_pk_mul_f32 v[210:211], v[210:211], v[58:59] op_sel:[0,0] op_sel_hi:[1,0]
    v_cvt_pk_bf16_f32 v130, v208, v209
    v_cvt_pk_bf16_f32 v131, v210, v211
    s_add_u32 s37, s55, 0
    buffer_store_dwordx4 v[128:131], v252, s[28:31], s37 offen offset:0
    v_mfma_f32_16x16x32_bf16 a[52:55], a[188:191], v[172:175], a[52:55]
    v_accvgpr_read_b32 v212, a20
    v_accvgpr_read_b32 v213, a21
    v_accvgpr_read_b32 v214, a22
    v_accvgpr_read_b32 v215, a23
    v_pk_mul_f32 v[212:213], v[212:213], v[58:59] op_sel:[0,1] op_sel_hi:[1,1]
    v_pk_mul_f32 v[214:215], v[214:215], v[58:59] op_sel:[0,1] op_sel_hi:[1,1]
    v_cvt_pk_bf16_f32 v134, v212, v213
    v_cvt_pk_bf16_f32 v135, v214, v215
    s_add_u32 s37, s55, 8192
    buffer_store_dwordx4 v[132:135], v252, s[28:31], s37 offen offset:0
    v_mfma_f32_16x16x32_bf16 a[56:59], a[184:187], v[176:179], a[56:59]
    ds_read_b64_tr_b16 a[168:169], v25 offset:49152
    v_min_u32 v240, 1, v0
    v_mfma_f32_16x16x32_bf16 a[56:59], a[188:191], v[180:183], a[56:59]
    ds_read_b64_tr_b16 a[170:171], v25 offset:53248
    v_mfma_f32_16x16x32_bf16 a[60:63], a[184:187], v[184:187], a[60:63]
    v_accvgpr_read_b32 v208, a24
    v_accvgpr_read_b32 v209, a25
    v_accvgpr_read_b32 v210, a26
    v_accvgpr_read_b32 v211, a27
    v_pk_mul_f32 v[208:209], v[208:209], v[60:61] op_sel:[0,0] op_sel_hi:[1,0]
    v_pk_mul_f32 v[210:211], v[210:211], v[60:61] op_sel:[0,0] op_sel_hi:[1,0]
    v_cvt_pk_bf16_f32 v138, v208, v209
    v_cvt_pk_bf16_f32 v139, v210, v211
    s_add_u32 s37, s55, 4096
    buffer_store_dwordx4 v[136:139], v252, s[28:31], s37 offen offset:0
    v_mfma_f32_16x16x32_bf16 a[60:63], a[188:191], v[188:191], a[60:63]
    s_waitcnt lgkmcnt(5)
    buffer_load_dwordx4 v48, s[20:23], s49 offen offset:2048 lds
    v_accvgpr_read_b32 v212, a28
    v_accvgpr_read_b32 v213, a29
    v_accvgpr_read_b32 v214, a30
    v_accvgpr_read_b32 v215, a31
    v_pk_mul_f32 v[212:213], v[212:213], v[60:61] op_sel:[0,1] op_sel_hi:[1,1]
    v_pk_mul_f32 v[214:215], v[214:215], v[60:61] op_sel:[0,1] op_sel_hi:[1,1]
    v_cvt_pk_bf16_f32 v142, v212, v213
    v_cvt_pk_bf16_f32 v143, v214, v215
    s_add_u32 s37, s55, 12288
    buffer_store_dwordx4 v[140:143], v252, s[28:31], s37 offen offset:0
    v_mfma_f32_16x16x32_bf16 a[64:67], a[160:163], v[160:163], a[64:67]
    s_waitcnt lgkmcnt(3)
    ds_read_b64_tr_b16 a[172:173], v25 offset:57344
    v_lshlrev_b32 v240, 31, v240
    v_mfma_f32_16x16x32_bf16 a[64:67], a[164:167], v[164:167], a[64:67]
    ds_read_b64_tr_b16 a[174:175], v25 offset:61440
    v_mfma_f32_16x16x32_bf16 a[68:71], a[160:163], v[168:171], a[68:71]
    v_accvgpr_read_b32 v208, a32
    v_accvgpr_read_b32 v209, a33
    v_accvgpr_read_b32 v210, a34
    v_accvgpr_read_b32 v211, a35
    v_pk_mul_f32 v[208:209], v[208:209], v[58:59] op_sel:[0,0] op_sel_hi:[1,0]
    v_pk_mul_f32 v[210:211], v[210:211], v[58:59] op_sel:[0,0] op_sel_hi:[1,0]
    v_cvt_pk_bf16_f32 v144, v208, v209
    v_cvt_pk_bf16_f32 v145, v210, v211
    v_mfma_f32_16x16x32_bf16 a[68:71], a[164:167], v[172:175], a[68:71]
    v_accvgpr_read_b32 v212, a36
    v_accvgpr_read_b32 v213, a37
    v_accvgpr_read_b32 v214, a38
    v_accvgpr_read_b32 v215, a39
    v_pk_mul_f32 v[212:213], v[212:213], v[58:59] op_sel:[0,1] op_sel_hi:[1,1]
    v_pk_mul_f32 v[214:215], v[214:215], v[58:59] op_sel:[0,1] op_sel_hi:[1,1]
    v_cvt_pk_bf16_f32 v148, v212, v213
    v_cvt_pk_bf16_f32 v149, v214, v215
    v_mfma_f32_16x16x32_bf16 a[72:75], a[160:163], v[176:179], a[72:75]
    ds_read_b64_tr_b16 a[176:177], v26 offset:49152
    v_mov_b32 v241, 1
    v_mfma_f32_16x16x32_bf16 a[72:75], a[164:167], v[180:183], a[72:75]
    ds_read_b64_tr_b16 a[178:179], v26 offset:53248
    v_mfma_f32_16x16x32_bf16 a[76:79], a[160:163], v[184:187], a[76:79]
    v_accvgpr_read_b32 v208, a40
    v_accvgpr_read_b32 v209, a41
    v_accvgpr_read_b32 v210, a42
    v_accvgpr_read_b32 v211, a43
    v_pk_mul_f32 v[208:209], v[208:209], v[60:61] op_sel:[0,0] op_sel_hi:[1,0]
    v_pk_mul_f32 v[210:211], v[210:211], v[60:61] op_sel:[0,0] op_sel_hi:[1,0]
    v_cvt_pk_bf16_f32 v152, v208, v209
    v_cvt_pk_bf16_f32 v153, v210, v211
    v_mfma_f32_16x16x32_bf16 a[76:79], a[164:167], v[188:191], a[76:79]
    s_waitcnt lgkmcnt(4)
    buffer_load_dwordx4 v49, s[20:23], s49 offen offset:3072 lds
    v_accvgpr_read_b32 v212, a44
    v_accvgpr_read_b32 v213, a45
    v_accvgpr_read_b32 v214, a46
    v_accvgpr_read_b32 v215, a47
    v_pk_mul_f32 v[212:213], v[212:213], v[60:61] op_sel:[0,1] op_sel_hi:[1,1]
    v_pk_mul_f32 v[214:215], v[214:215], v[60:61] op_sel:[0,1] op_sel_hi:[1,1]
    v_cvt_pk_bf16_f32 v156, v212, v213
    v_cvt_pk_bf16_f32 v157, v214, v215
    v_mfma_f32_16x16x32_bf16 a[80:83], a[168:171], v[160:163], a[80:83]
    s_waitcnt lgkmcnt(2)
    ds_read_b64_tr_b16 a[180:181], v26 offset:57344
    v_mfma_f32_16x16x32_bf16 a[80:83], a[172:175], v[164:167], a[80:83]
    ds_read_b64_tr_b16 a[182:183], v26 offset:61440
    v_mfma_f32_16x16x32_bf16 a[84:87], a[168:171], v[168:171], a[84:87]
    v_accvgpr_read_b32 v208, a48
    v_accvgpr_read_b32 v209, a49
    v_accvgpr_read_b32 v210, a50
    v_accvgpr_read_b32 v211, a51
    v_pk_mul_f32 v[208:209], v[208:209], v[58:59] op_sel:[0,0] op_sel_hi:[1,0]
    v_pk_mul_f32 v[210:211], v[210:211], v[58:59] op_sel:[0,0] op_sel_hi:[1,0]
    v_cvt_pk_bf16_f32 v146, v208, v209
    v_cvt_pk_bf16_f32 v147, v210, v211
    s_add_u32 s37, s55, 0
    buffer_store_dwordx4 v[144:147], v252, s[28:31], s37 offen offset:1024
    v_mfma_f32_16x16x32_bf16 a[84:87], a[172:175], v[172:175], a[84:87]
    v_accvgpr_read_b32 v212, a52
    v_accvgpr_read_b32 v213, a53
    v_accvgpr_read_b32 v214, a54
    v_accvgpr_read_b32 v215, a55
    v_pk_mul_f32 v[212:213], v[212:213], v[58:59] op_sel:[0,1] op_sel_hi:[1,1]
    v_pk_mul_f32 v[214:215], v[214:215], v[58:59] op_sel:[0,1] op_sel_hi:[1,1]
    v_cvt_pk_bf16_f32 v150, v212, v213
    v_cvt_pk_bf16_f32 v151, v214, v215
    s_add_u32 s37, s55, 8192
    buffer_store_dwordx4 v[148:151], v252, s[28:31], s37 offen offset:1024
    s_waitcnt vmcnt(22)
    s_barrier
    v_mfma_f32_16x16x32_bf16 a[88:91], a[168:171], v[176:179], a[88:91]
    ds_read_b64_tr_b16 a[184:185], v27 offset:49152
    v_mfma_f32_16x16x32_bf16 a[88:91], a[172:175], v[180:183], a[88:91]
    ds_read_b64_tr_b16 a[186:187], v27 offset:53248
    v_mfma_f32_16x16x32_bf16 a[92:95], a[168:171], v[184:187], a[92:95]
    ds_read_b128 v[224:227], v228
    v_accvgpr_read_b32 v208, a56
    v_accvgpr_read_b32 v209, a57
    v_accvgpr_read_b32 v210, a58
    v_accvgpr_read_b32 v211, a59
    v_pk_mul_f32 v[208:209], v[208:209], v[60:61] op_sel:[0,0] op_sel_hi:[1,0]
    v_pk_mul_f32 v[210:211], v[210:211], v[60:61] op_sel:[0,0] op_sel_hi:[1,0]
    v_cvt_pk_bf16_f32 v154, v208, v209
    v_cvt_pk_bf16_f32 v155, v210, v211
    s_add_u32 s37, s55, 4096
    buffer_store_dwordx4 v[152:155], v252, s[28:31], s37 offen offset:1024
    v_mfma_f32_16x16x32_bf16 a[92:95], a[172:175], v[188:191], a[92:95]
    s_waitcnt lgkmcnt(5)
    v_accvgpr_read_b32 v212, a60
    v_accvgpr_read_b32 v213, a61
    v_accvgpr_read_b32 v214, a62
    v_accvgpr_read_b32 v215, a63
    v_pk_mul_f32 v[212:213], v[212:213], v[60:61] op_sel:[0,1] op_sel_hi:[1,1]
    v_pk_mul_f32 v[214:215], v[214:215], v[60:61] op_sel:[0,1] op_sel_hi:[1,1]
    v_cvt_pk_bf16_f32 v158, v212, v213
Ltour8:
    s_cbranch_execz Ltour12
    v_cvt_pk_bf16_f32 v159, v214, v215
    s_add_u32 s37, s55, 12288
    buffer_store_dwordx4 v[156:159], v252, s[28:31], s37 offen offset:1024
    s_add_u32 s49, s7, 73984
    v_mfma_f32_16x16x32_bf16 a[96:99], a[176:179], v[160:163], a[96:99]
    s_waitcnt lgkmcnt(3)
    s_add_u32 m0, s42, 49152
    ds_read_b64_tr_b16 a[188:189], v27 offset:57344
    v_mfma_f32_16x16x32_bf16 a[96:99], a[180:183], v[164:167], a[96:99]
    buffer_load_dwordx4 v46, s[20:23], s49 offen lds
    v_mfma_f32_16x16x32_bf16 a[100:103], a[176:179], v[168:171], a[100:103]
    ds_read_b64_tr_b16 a[190:191], v27 offset:61440
    v_accvgpr_read_b32 v208, a64
    v_accvgpr_read_b32 v209, a65
    v_accvgpr_read_b32 v210, a66
    v_accvgpr_read_b32 v211, a67
    v_pk_mul_f32 v[208:209], v[208:209], v[58:59] op_sel:[0,0] op_sel_hi:[1,0]
    v_pk_mul_f32 v[210:211], v[210:211], v[58:59] op_sel:[0,0] op_sel_hi:[1,0]
    v_cvt_pk_bf16_f32 v192, v208, v209
    v_cvt_pk_bf16_f32 v193, v210, v211
    v_mfma_f32_16x16x32_bf16 a[100:103], a[180:183], v[172:175], a[100:103]
    buffer_load_dwordx4 v47, s[20:23], s49 offen offset:1024 lds
    v_accvgpr_read_b32 v212, a68
    v_accvgpr_read_b32 v213, a69
    v_accvgpr_read_b32 v214, a70
    v_accvgpr_read_b32 v215, a71
    v_pk_mul_f32 v[212:213], v[212:213], v[58:59] op_sel:[0,1] op_sel_hi:[1,1]
    v_pk_mul_f32 v[214:215], v[214:215], v[58:59] op_sel:[0,1] op_sel_hi:[1,1]
    v_cvt_pk_bf16_f32 v196, v212, v213
    v_cvt_pk_bf16_f32 v197, v214, v215
    v_mfma_f32_16x16x32_bf16 a[104:107], a[176:179], v[176:179], a[104:107]
    v_mfma_f32_16x16x32_bf16 a[104:107], a[180:183], v[180:183], a[104:107]
    buffer_load_dwordx4 v48, s[20:23], s49 offen offset:2048 lds
    v_mfma_f32_16x16x32_bf16 a[108:111], a[176:179], v[184:187], a[108:111]
    v_accvgpr_read_b32 v208, a72
    v_accvgpr_read_b32 v209, a73
    v_accvgpr_read_b32 v210, a74
    v_accvgpr_read_b32 v211, a75
    v_pk_mul_f32 v[208:209], v[208:209], v[60:61] op_sel:[0,0] op_sel_hi:[1,0]
    v_pk_mul_f32 v[210:211], v[210:211], v[60:61] op_sel:[0,0] op_sel_hi:[1,0]
    v_cvt_pk_bf16_f32 v200, v208, v209
    v_cvt_pk_bf16_f32 v201, v210, v211
    v_mfma_f32_16x16x32_bf16 a[108:111], a[180:183], v[188:191], a[108:111]
    s_waitcnt lgkmcnt(3)
    buffer_load_dwordx4 v49, s[20:23], s49 offen offset:3072 lds
    v_accvgpr_read_b32 v212, a76
    v_accvgpr_read_b32 v213, a77
    v_accvgpr_read_b32 v214, a78
    v_accvgpr_read_b32 v215, a79
    v_pk_mul_f32 v[212:213], v[212:213], v[60:61] op_sel:[0,1] op_sel_hi:[1,1]
    v_pk_mul_f32 v[214:215], v[214:215], v[60:61] op_sel:[0,1] op_sel_hi:[1,1]
    v_cvt_pk_bf16_f32 v204, v212, v213
    v_cvt_pk_bf16_f32 v205, v214, v215
    s_add_u32 s49, s46, 0
    v_mfma_f32_16x16x32_bf16 a[112:115], a[184:187], v[160:163], a[112:115]
    s_waitcnt lgkmcnt(0)
    s_add_u32 m0, s42, 98304
    v_mfma_f32_16x16x32_bf16 a[112:115], a[188:191], v[164:167], a[112:115]
    buffer_load_dwordx4 v46, s[20:23], s49 offen lds
    v_mfma_f32_16x16x32_bf16 a[116:119], a[184:187], v[168:171], a[116:119]
    v_accvgpr_read_b32 v208, a80
    v_accvgpr_read_b32 v209, a81
    v_accvgpr_read_b32 v210, a82
    v_accvgpr_read_b32 v211, a83
    v_pk_mul_f32 v[208:209], v[208:209], v[58:59] op_sel:[0,0] op_sel_hi:[1,0]
    v_pk_mul_f32 v[210:211], v[210:211], v[58:59] op_sel:[0,0] op_sel_hi:[1,0]
    v_cvt_pk_bf16_f32 v194, v208, v209
    v_cvt_pk_bf16_f32 v195, v210, v211
    s_add_u32 s37, s55, 0
    buffer_store_dwordx4 v[192:195], v252, s[28:31], s37 offen offset:2048
    v_mfma_f32_16x16x32_bf16 a[116:119], a[188:191], v[172:175], a[116:119]
    buffer_load_dwordx4 v47, s[20:23], s49 offen offset:1024 lds
    v_accvgpr_read_b32 v212, a84
    v_accvgpr_read_b32 v213, a85
    v_accvgpr_read_b32 v214, a86
    v_accvgpr_read_b32 v215, a87
    v_pk_mul_f32 v[212:213], v[212:213], v[58:59] op_sel:[0,1] op_sel_hi:[1,1]
    v_pk_mul_f32 v[214:215], v[214:215], v[58:59] op_sel:[0,1] op_sel_hi:[1,1]
    v_cvt_pk_bf16_f32 v198, v212, v213
    v_cvt_pk_bf16_f32 v199, v214, v215
    s_add_u32 s37, s55, 8192
    buffer_store_dwordx4 v[196:199], v252, s[28:31], s37 offen offset:2048
    v_mfma_f32_16x16x32_bf16 a[120:123], a[184:187], v[176:179], a[120:123]
    v_mfma_f32_16x16x32_bf16 a[120:123], a[188:191], v[180:183], a[120:123]
    buffer_load_dwordx4 v48, s[20:23], s49 offen offset:2048 lds
    v_mfma_f32_16x16x32_bf16 a[124:127], a[184:187], v[184:187], a[124:127]
    v_accvgpr_read_b32 v208, a88
    v_accvgpr_read_b32 v209, a89
    v_accvgpr_read_b32 v210, a90
    v_accvgpr_read_b32 v211, a91
    v_pk_mul_f32 v[208:209], v[208:209], v[60:61] op_sel:[0,0] op_sel_hi:[1,0]
    v_pk_mul_f32 v[210:211], v[210:211], v[60:61] op_sel:[0,0] op_sel_hi:[1,0]
    v_cvt_pk_bf16_f32 v202, v208, v209
    v_cvt_pk_bf16_f32 v203, v210, v211
    s_add_u32 s37, s55, 4096
    buffer_store_dwordx4 v[200:203], v252, s[28:31], s37 offen offset:2048
    v_mfma_f32_16x16x32_bf16 a[124:127], a[188:191], v[188:191], a[124:127]
    buffer_load_dwordx4 v49, s[20:23], s49 offen offset:3072 lds
    v_accvgpr_read_b32 v212, a92
    v_accvgpr_read_b32 v213, a93
    v_accvgpr_read_b32 v214, a94
    v_accvgpr_read_b32 v215, a95
    v_pk_mul_f32 v[212:213], v[212:213], v[60:61] op_sel:[0,1] op_sel_hi:[1,1]
    v_pk_mul_f32 v[214:215], v[214:215], v[60:61] op_sel:[0,1] op_sel_hi:[1,1]
    v_cvt_pk_bf16_f32 v206, v212, v213
    v_cvt_pk_bf16_f32 v207, v214, v215
    s_add_u32 s37, s55, 12288
    buffer_store_dwordx4 v[204:207], v252, s[28:31], s37 offen offset:2048
    v_or3_b32 v224, v224, v225, v226
    v_or_b32 v224, v224, v227
    s_nop 0
    v_readfirstlane_b32 s36, v224
    v_readfirstlane_b32 s38, v253
    v_min_u32 v8, 1, v1
    v_lshlrev_b32 v8, 31, v8
    v_mov_b32 v10, s95
    s_getreg_b32 s39, hwreg(HW_REG_XCC_ID, 0, 4)
    s_add_u32 s39, s39, s95
    s_cmp_eq_u32 s38, s39
    s_cselect_b32 s53, 1, 0
    ds_read_b64_tr_b16 a[208:209], v12 offset:0
    ds_read_b64_tr_b16 a[210:211], v12 offset:4096
    ds_read_b64_tr_b16 a[212:213], v12 offset:8192
    ds_read_b64_tr_b16 a[214:215], v12 offset:12288
    ds_read_b64_tr_b16 a[216:217], v12 offset:16384
    ds_read_b64_tr_b16 a[218:219], v12 offset:20480
    ds_read_b64_tr_b16 a[220:221], v12 offset:24576
    ds_read_b64_tr_b16 a[222:223], v12 offset:28672
    ds_read_b64_tr_b16 a[224:225], v16 offset:0
    ds_read_b64_tr_b16 a[226:227], v16 offset:4096
    ds_read_b64_tr_b16 a[228:229], v16 offset:8192
    ds_read_b64_tr_b16 a[230:231], v16 offset:12288
    ds_read_b64_tr_b16 a[232:233], v16 offset:16384
    ds_read_b64_tr_b16 a[234:235], v16 offset:20480
    ds_read_b64_tr_b16 a[236:237], v16 offset:24576
    ds_read_b64_tr_b16 a[238:239], v16 offset:28672
    s_andn2_b32 s36, s36, s48
    s_cbranch_scc1 Lattn_redo
    v_accvgpr_read_b32 v208, a96
    v_accvgpr_read_b32 v209, a97
    v_accvgpr_read_b32 v210, a98
    v_accvgpr_read_b32 v211, a99
    v_pk_mul_f32 v[208:209], v[208:209], v[58:59] op_sel:[0,0] op_sel_hi:[1,0]
    v_pk_mul_f32 v[210:211], v[210:211], v[58:59] op_sel:[0,0] op_sel_hi:[1,0]
    v_cvt_pk_bf16_f32 v176, v208, v209
    v_cvt_pk_bf16_f32 v177, v210, v211
    v_accvgpr_read_b32 v212, a100
    v_accvgpr_read_b32 v213, a101
    v_accvgpr_read_b32 v214, a102
    v_accvgpr_read_b32 v215, a103
    v_pk_mul_f32 v[212:213], v[212:213], v[58:59] op_sel:[0,1] op_sel_hi:[1,1]
    v_pk_mul_f32 v[214:215], v[214:215], v[58:59] op_sel:[0,1] op_sel_hi:[1,1]
    v_cvt_pk_bf16_f32 v180, v212, v213
    v_cvt_pk_bf16_f32 v181, v214, v215
    v_accvgpr_read_b32 v208, a104
    v_accvgpr_read_b32 v209, a105
    v_accvgpr_read_b32 v210, a106
    v_accvgpr_read_b32 v211, a107
    v_pk_mul_f32 v[208:209], v[208:209], v[60:61] op_sel:[0,0] op_sel_hi:[1,0]
    v_pk_mul_f32 v[210:211], v[210:211], v[60:61] op_sel:[0,0] op_sel_hi:[1,0]
    v_cvt_pk_bf16_f32 v184, v208, v209
    v_cvt_pk_bf16_f32 v185, v210, v211
    v_accvgpr_read_b32 v212, a108
    v_accvgpr_read_b32 v213, a109
    v_accvgpr_read_b32 v214, a110
    v_accvgpr_read_b32 v215, a111
    v_pk_mul_f32 v[212:213], v[212:213], v[60:61] op_sel:[0,1] op_sel_hi:[1,1]
    v_pk_mul_f32 v[214:215], v[214:215], v[60:61] op_sel:[0,1] op_sel_hi:[1,1]
    v_cvt_pk_bf16_f32 v188, v212, v213
    v_cvt_pk_bf16_f32 v189, v214, v215
    v_accvgpr_read_b32 v208, a112
    v_accvgpr_read_b32 v209, a113
    v_accvgpr_read_b32 v210, a114
    v_accvgpr_read_b32 v211, a115
    v_pk_mul_f32 v[208:209], v[208:209], v[58:59] op_sel:[0,0] op_sel_hi:[1,0]
    v_pk_mul_f32 v[210:211], v[210:211], v[58:59] op_sel:[0,0] op_sel_hi:[1,0]
    v_cvt_pk_bf16_f32 v178, v208, v209
    v_cvt_pk_bf16_f32 v179, v210, v211
    s_add_u32 s37, s55, 0
    buffer_store_dwordx4 v[176:179], v252, s[28:31], s37 offen offset:3072
    v_accvgpr_read_b32 v212, a116
    v_accvgpr_read_b32 v213, a117
    v_accvgpr_read_b32 v214, a118
    v_accvgpr_read_b32 v215, a119
    v_pk_mul_f32 v[212:213], v[212:213], v[58:59] op_sel:[0,1] op_sel_hi:[1,1]
    v_pk_mul_f32 v[214:215], v[214:215], v[58:59] op_sel:[0,1] op_sel_hi:[1,1]
    v_cvt_pk_bf16_f32 v182, v212, v213
    v_cvt_pk_bf16_f32 v183, v214, v215
    s_add_u32 s37, s55, 8192
    buffer_store_dwordx4 v[180:183], v252, s[28:31], s37 offen offset:3072
    v_accvgpr_read_b32 v208, a120
    v_accvgpr_read_b32 v209, a121
    v_accvgpr_read_b32 v210, a122
    v_accvgpr_read_b32 v211, a123
    v_pk_mul_f32 v[208:209], v[208:209], v[60:61] op_sel:[0,0] op_sel_hi:[1,0]
    v_pk_mul_f32 v[210:211], v[210:211], v[60:61] op_sel:[0,0] op_sel_hi:[1,0]
    v_cvt_pk_bf16_f32 v186, v208, v209
    v_cvt_pk_bf16_f32 v187, v210, v211
    s_add_u32 s37, s55, 4096
    buffer_store_dwordx4 v[184:187], v252, s[28:31], s37 offen offset:3072
    v_accvgpr_read_b32 v212, a124
    v_accvgpr_read_b32 v213, a125
    v_accvgpr_read_b32 v214, a126
    v_accvgpr_read_b32 v215, a127
    v_pk_mul_f32 v[212:213], v[212:213], v[60:61] op_sel:[0,1] op_sel_hi:[1,1]
    v_pk_mul_f32 v[214:215], v[214:215], v[60:61] op_sel:[0,1] op_sel_hi:[1,1]
    v_cvt_pk_bf16_f32 v190, v212, v213
    v_cvt_pk_bf16_f32 v191, v214, v215
    s_add_u32 s37, s55, 12288
    buffer_store_dwordx4 v[188:191], v252, s[28:31], s37 offen offset:3072
    s_waitcnt lgkmcnt(14)
    v_mfma_f32_16x16x32_bf16 v[96:99], a[208:211], v[128:131], 0
    s_waitcnt lgkmcnt(12)
    ds_read_b64_tr_b16 a[160:161], v13 offset:0
    v_mfma_f32_16x16x32_bf16 v[96:99], a[212:215], v[144:147], v[96:99]
    s_waitcnt lgkmcnt(11)
    ds_read_b64_tr_b16 a[162:163], v13 offset:4096
    v_mfma_f32_16x16x32_bf16 v[96:99], a[216:219], v[192:195], v[96:99]
    s_waitcnt lgkmcnt(10)
    ds_read_b64_tr_b16 a[164:165], v13 offset:8192
    v_mfma_f32_16x16x32_bf16 v[96:99], a[220:223], v[176:179], v[96:99]
    s_waitcnt lgkmcnt(9)
    ds_read_b64_tr_b16 a[166:167], v13 offset:12288
    v_mfma_f32_16x16x32_bf16 v[96:99], a[224:227], v[136:139], v[96:99]
    s_waitcnt lgkmcnt(8)
    ds_read_b64_tr_b16 a[168:169], v13 offset:16384
    v_mfma_f32_16x16x32_bf16 v[96:99], a[228:231], v[152:155], v[96:99]
    s_waitcnt lgkmcnt(7)
    ds_read_b64_tr_b16 a[170:171], v13 offset:20480
    v_mfma_f32_16x16x32_bf16 v[96:99], a[232:235], v[200:203], v[96:99]
    s_waitcnt lgkmcnt(6)
    ds_read_b64_tr_b16 a[172:173], v13 offset:24576
    v_mfma_f32_16x16x32_bf16 v[96:99], a[236:239], v[184:187], v[96:99]
    ds_read_b64_tr_b16 a[174:175], v13 offset:28672
    v_mfma_f32_16x16x32_bf16 v[100:103], a[208:211], v[132:135], 0
    ds_read_b64_tr_b16 a[176:177], v17 offset:0
    v_mfma_f32_16x16x32_bf16 v[100:103], a[212:215], v[148:151], v[100:103]
    ds_read_b64_tr_b16 a[178:179], v17 offset:4096
    v_mfma_f32_16x16x32_bf16 v[100:103], a[216:219], v[196:199], v[100:103]
    ds_read_b64_tr_b16 a[180:181], v17 offset:8192
    v_mfma_f32_16x16x32_bf16 v[100:103], a[220:223], v[180:183], v[100:103]
    ds_read_b64_tr_b16 a[182:183], v17 offset:12288
    v_mfma_f32_16x16x32_bf16 v[100:103], a[224:227], v[140:143], v[100:103]
    ds_read_b64_tr_b16 a[184:185], v17 offset:16384
    v_cvt_pk_bf16_f32 v224, v96, v97
    v_mfma_f32_16x16x32_bf16 v[100:103], a[228:231], v[156:159], v[100:103]
    ds_read_b64_tr_b16 a[186:187], v17 offset:20480
    v_cvt_pk_bf16_f32 v225, v98, v99
    v_mfma_f32_16x16x32_bf16 v[100:103], a[232:235], v[204:207], v[100:103]
    ds_read_b64_tr_b16 a[188:189], v17 offset:24576
    v_mfma_f32_16x16x32_bf16 v[100:103], a[236:239], v[188:191], v[100:103]
    s_waitcnt lgkmcnt(13)
    ds_read_b64_tr_b16 a[190:191], v17 offset:28672
    v_mfma_f32_16x16x32_bf16 v[104:107], a[160:163], v[128:131], 0
    s_waitcnt lgkmcnt(12)
    ds_read_b64_tr_b16 a[208:209], v14 offset:0
    v_mfma_f32_16x16x32_bf16 v[104:107], a[164:167], v[144:147], v[104:107]
    s_waitcnt lgkmcnt(11)
    ds_read_b64_tr_b16 a[210:211], v14 offset:4096
    v_mfma_f32_16x16x32_bf16 v[104:107], a[168:171], v[192:195], v[104:107]
    s_waitcnt lgkmcnt(10)
    ds_read_b64_tr_b16 a[212:213], v14 offset:8192
    v_mfma_f32_16x16x32_bf16 v[104:107], a[172:175], v[176:179], v[104:107]
    s_waitcnt lgkmcnt(9)
    ds_read_b64_tr_b16 a[214:215], v14 offset:12288
    v_mfma_f32_16x16x32_bf16 v[104:107], a[176:179], v[136:139], v[104:107]
    s_waitcnt lgkmcnt(8)
    ds_read_b64_tr_b16 a[216:217], v14 offset:16384
    v_cvt_pk_bf16_f32 v228, v100, v101
    v_mfma_f32_16x16x32_bf16 v[104:107], a[180:183], v[152:155], v[104:107]
    s_waitcnt lgkmcnt(7)
    ds_read_b64_tr_b16 a[218:219], v14 offset:20480
    v_cvt_pk_bf16_f32 v229, v102, v103
    v_mfma_f32_16x16x32_bf16 v[104:107], a[184:187], v[200:203], v[104:107]
    s_waitcnt lgkmcnt(6)
    ds_read_b64_tr_b16 a[220:221], v14 offset:24576
    v_mfma_f32_16x16x32_bf16 v[104:107], a[188:191], v[184:187], v[104:107]
    ds_read_b64_tr_b16 a[222:223], v14 offset:28672
    s_waitcnt vmcnt(0)
    s_cmp_eq_u32 s53, 0
    s_cbranch_scc1 Lattn_wb
Lattn_wbdone:
    v_mfma_f32_16x16x32_bf16 v[108:111], a[160:163], v[132:135], 0
    buffer_store_dword v10, v8, s[24:27], s92 offen offset:8 sc1
    v_mfma_f32_16x16x32_bf16 v[108:111], a[164:167], v[148:151], v[108:111]
    s_xor_b32 s55, s55, 65536
    ds_read_b64_tr_b16 a[224:225], v18 offset:0
    ds_read_b64_tr_b16 a[226:227], v18 offset:4096
    v_mfma_f32_16x16x32_bf16 v[108:111], a[168:171], v[196:199], v[108:111]
    buffer_atomic_add v241, v240, s[88:91], 0 offen sc1
    v_mfma_f32_16x16x32_bf16 v[108:111], a[172:175], v[180:183], v[108:111]
    ds_read_b64_tr_b16 a[228:229], v18 offset:8192
    ds_read_b64_tr_b16 a[230:231], v18 offset:12288
    s_load_dwordx2 s[12:13], s[0:1], 0
    v_mfma_f32_16x16x32_bf16 v[108:111], a[176:179], v[140:143], v[108:111]
    ds_read_b64_tr_b16 a[232:233], v18 offset:16384
    v_cvt_pk_bf16_f32 v226, v104, v105
    v_mfma_f32_16x16x32_bf16 v[108:111], a[180:183], v[156:159], v[108:111]
    s_add_u32 s38, s56, 16384
    ds_read_b64_tr_b16 a[234:235], v18 offset:20480
    v_cvt_pk_bf16_f32 v227, v106, v107
    s_load_dwordx2 s[16:17], s[0:1], 96
    v_mfma_f32_16x16x32_bf16 v[108:111], a[184:187], v[204:207], v[108:111]
    buffer_store_dwordx4 v[224:227], v56, s[28:31], s38 offen sc1
    v_mfma_f32_16x16x32_bf16 v[108:111], a[188:191], v[188:191], v[108:111]
    s_waitcnt lgkmcnt(12)
    ds_read_b64_tr_b16 a[236:237], v18 offset:24576
    ds_read_b64_tr_b16 a[238:239], v18 offset:28672
    s_load_dwordx2 s[52:53], s[0:1], 48
    v_mfma_f32_16x16x32_bf16 v[112:115], a[208:211], v[128:131], 0
    s_waitcnt lgkmcnt(12)
    ds_read_b64_tr_b16 a[160:161], v15 offset:0
    v_mfma_f32_16x16x32_bf16 v[112:115], a[212:215], v[144:147], v[112:115]
    s_waitcnt lgkmcnt(11)
    ds_read_b64_tr_b16 a[162:163], v15 offset:4096
    v_mfma_f32_16x16x32_bf16 v[112:115], a[216:219], v[192:195], v[112:115]
    s_waitcnt lgkmcnt(10)
    ds_read_b64_tr_b16 a[164:165], v15 offset:8192
    v_mfma_f32_16x16x32_bf16 v[112:115], a[220:223], v[176:179], v[112:115]
    s_waitcnt lgkmcnt(9)
    ds_read_b64_tr_b16 a[166:167], v15 offset:12288
    v_mfma_f32_16x16x32_bf16 v[112:115], a[224:227], v[136:139], v[112:115]
    s_waitcnt lgkmcnt(8)
    ds_read_b64_tr_b16 a[168:169], v15 offset:16384
    v_cvt_pk_bf16_f32 v230, v108, v109
    v_mfma_f32_16x16x32_bf16 v[112:115], a[228:231], v[152:155], v[112:115]
    s_waitcnt lgkmcnt(7)
    s_add_u32 s38, s56, 180224
    ds_read_b64_tr_b16 a[170:171], v15 offset:20480
    v_cvt_pk_bf16_f32 v231, v110, v111
    v_mfma_f32_16x16x32_bf16 v[112:115], a[232:235], v[200:203], v[112:115]
    s_waitcnt lgkmcnt(6)
    buffer_store_dwordx4 v[228:231], v56, s[28:31], s38 offen sc1
    v_mfma_f32_16x16x32_bf16 v[112:115], a[236:239], v[184:187], v[112:115]
    ds_read_b64_tr_b16 a[172:173], v15 offset:24576
    ds_read_b64_tr_b16 a[174:175], v15 offset:28672
    v_mfma_f32_16x16x32_bf16 v[116:119], a[208:211], v[132:135], 0
    ds_read_b64_tr_b16 a[176:177], v19 offset:0
    v_mfma_f32_16x16x32_bf16 v[116:119], a[212:215], v[148:151], v[116:119]
    ds_read_b64_tr_b16 a[178:179], v19 offset:4096
    v_mfma_f32_16x16x32_bf16 v[116:119], a[216:219], v[196:199], v[116:119]
    ds_read_b64_tr_b16 a[180:181], v19 offset:8192
    v_mfma_f32_16x16x32_bf16 v[116:119], a[220:223], v[180:183], v[116:119]
    ds_read_b64_tr_b16 a[182:183], v19 offset:12288
    v_mfma_f32_16x16x32_bf16 v[116:119], a[224:227], v[140:143], v[116:119]
    ds_read_b64_tr_b16 a[184:185], v19 offset:16384
    v_cvt_pk_bf16_f32 v232, v112, v113
    v_mfma_f32_16x16x32_bf16 v[116:119], a[228:231], v[156:159], v[116:119]
    ds_read_b64_tr_b16 a[186:187], v19 offset:20480
    v_cvt_pk_bf16_f32 v233, v114, v115
    v_mfma_f32_16x16x32_bf16 v[116:119], a[232:235], v[204:207], v[116:119]
    ds_read_b64_tr_b16 a[188:189], v19 offset:24576
    v_mfma_f32_16x16x32_bf16 v[116:119], a[236:239], v[188:191], v[116:119]
    s_waitcnt lgkmcnt(13)
    ds_read_b64_tr_b16 a[190:191], v19 offset:28672
    s_barrier
    v_mfma_f32_16x16x32_bf16 v[120:123], a[160:163], v[128:131], 0
    s_waitcnt lgkmcnt(12)
    buffer_load_dword v11, v8, s[24:27], s54 offen offset:8 sc1
    v_mfma_f32_16x16x32_bf16 v[120:123], a[164:167], v[144:147], v[120:123]
    s_waitcnt lgkmcnt(10)
    ds_read_b64_tr_b16 a[208:209], v20 offset:0
    ds_read_b64_tr_b16 a[210:211], v20 offset:4096
    v_mfma_f32_16x16x32_bf16 v[120:123], a[168:171], v[192:195], v[120:123]
    s_waitcnt lgkmcnt(10)
    ds_read_b64_tr_b16 a[212:213], v20 offset:8192
    v_mfma_f32_16x16x32_bf16 v[120:123], a[172:175], v[176:179], v[120:123]
    s_waitcnt lgkmcnt(9)
    ds_read_b64_tr_b16 a[214:215], v20 offset:12288
    v_mfma_f32_16x16x32_bf16 v[120:123], a[176:179], v[136:139], v[120:123]
    s_waitcnt lgkmcnt(8)
    ds_read_b64_tr_b16 a[216:217], v20 offset:16384
    v_cvt_pk_bf16_f32 v236, v116, v117
    v_mfma_f32_16x16x32_bf16 v[120:123], a[180:183], v[152:155], v[120:123]
    s_waitcnt lgkmcnt(7)
    ds_read_b64_tr_b16 a[218:219], v20 offset:20480
    v_cvt_pk_bf16_f32 v237, v118, v119
    v_mfma_f32_16x16x32_bf16 v[120:123], a[184:187], v[200:203], v[120:123]
    s_waitcnt lgkmcnt(6)
    s_add_u32 s49, s46, 73728
    ds_read_b64_tr_b16 a[220:221], v20 offset:24576
    v_mfma_f32_16x16x32_bf16 v[120:123], a[188:191], v[184:187], v[120:123]
    s_add_u32 m0, s42, 114688
    ds_read_b64_tr_b16 a[222:223], v20 offset:28672
    v_mfma_f32_16x16x32_bf16 v[124:127], a[160:163], v[132:135], 0
    buffer_load_dwordx4 v46, s[20:23], s49 offen lds
    v_mfma_f32_16x16x32_bf16 v[124:127], a[164:167], v[148:151], v[124:127]
    ds_read_b64_tr_b16 a[224:225], v24 offset:0
    ds_read_b64_tr_b16 a[226:227], v24 offset:4096
    v_mfma_f32_16x16x32_bf16 v[124:127], a[168:171], v[196:199], v[124:127]
    buffer_load_dwordx4 v47, s[20:23], s49 offen offset:1024 lds
    v_mfma_f32_16x16x32_bf16 v[124:127], a[172:175], v[180:183], v[124:127]
    ds_read_b64_tr_b16 a[228:229], v24 offset:8192
    ds_read_b64_tr_b16 a[230:231], v24 offset:12288
    v_mfma_f32_16x16x32_bf16 v[124:127], a[176:179], v[140:143], v[124:127]
    ds_read_b64_tr_b16 a[232:233], v24 offset:16384
    v_cvt_pk_bf16_f32 v234, v120, v121
    v_mfma_f32_16x16x32_bf16 v[124:127], a[180:183], v[156:159], v[124:127]
    s_add_u32 s38, s56, 16512
    ds_read_b64_tr_b16 a[234:235], v24 offset:20480
    v_cvt_pk_bf16_f32 v235, v122, v123
    v_mfma_f32_16x16x32_bf16 v[124:127], a[184:187], v[204:207], v[124:127]
    buffer_store_dwordx4 v[232:235], v56, s[28:31], s38 offen sc1
    v_mfma_f32_16x16x32_bf16 v[124:127], a[188:191], v[188:191], v[124:127]
    s_waitcnt lgkmcnt(12)
    ds_read_b64_tr_b16 a[236:237], v24 offset:24576
    ds_read_b64_tr_b16 a[238:239], v24 offset:28672
    v_mfma_f32_16x16x32_bf16 v[64:67], a[208:211], v[128:131], 0
    s_waitcnt lgkmcnt(12)
    buffer_load_dwordx4 v48, s[20:23], s49 offen offset:2048 lds
    v_mfma_f32_16x16x32_bf16 v[64:67], a[212:215], v[144:147], v[64:67]
    s_waitcnt lgkmcnt(10)
    ds_read_b64_tr_b16 a[160:161], v21 offset:0
    ds_read_b64_tr_b16 a[162:163], v21 offset:4096
    v_mfma_f32_16x16x32_bf16 v[64:67], a[216:219], v[192:195], v[64:67]
    s_waitcnt lgkmcnt(10)
    buffer_load_dwordx4 v49, s[20:23], s49 offen offset:3072 lds
    v_mfma_f32_16x16x32_bf16 v[64:67], a[220:223], v[176:179], v[64:67]
    s_waitcnt lgkmcnt(8)
    ds_read_b64_tr_b16 a[164:165], v21 offset:8192
    ds_read_b64_tr_b16 a[166:167], v21 offset:12288
    v_mfma_f32_16x16x32_bf16 v[64:67], a[224:227], v[136:139], v[64:67]
    s_waitcnt lgkmcnt(8)
    ds_read_b64_tr_b16 a[168:169], v21 offset:16384
    v_cvt_pk_bf16_f32 v238, v124, v125
    v_mfma_f32_16x16x32_bf16 v[64:67], a[228:231], v[152:155], v[64:67]
    s_waitcnt lgkmcnt(7)
    s_add_u32 s38, s56, 180352
    ds_read_b64_tr_b16 a[170:171], v21 offset:20480
    v_cvt_pk_bf16_f32 v239, v126, v127
    v_mfma_f32_16x16x32_bf16 v[64:67], a[232:235], v[200:203], v[64:67]
    s_waitcnt lgkmcnt(6)
    buffer_store_dwordx4 v[236:239], v56, s[28:31], s38 offen sc1
    v_mfma_f32_16x16x32_bf16 v[64:67], a[236:239], v[184:187], v[64:67]
    ds_read_b64_tr_b16 a[172:173], v21 offset:24576
    ds_read_b64_tr_b16 a[174:175], v21 offset:28672
    v_mfma_f32_16x16x32_bf16 v[68:71], a[208:211], v[132:135], 0
    s_lshl_b32 s40, s5, 4
    ds_read_b64_tr_b16 a[176:177], v25 offset:0
    v_mfma_f32_16x16x32_bf16 v[68:71], a[212:215], v[148:151], v[68:71]
    s_add_u32 s40, s40, s4
    ds_read_b64_tr_b16 a[178:179], v25 offset:4096
    v_and_b32 v240, 31, v1
    v_mfma_f32_16x16x32_bf16 v[68:71], a[216:219], v[196:199], v[68:71]
    ds_read_b64_tr_b16 a[180:181], v25 offset:8192
    v_lshrrev_b32 v241, 5, v1
    v_mfma_f32_16x16x32_bf16 v[68:71], a[220:223], v[180:183], v[68:71]
    ds_read_b64_tr_b16 a[182:183], v25 offset:12288
    v_cmp_gt_u32 vcc, 8, v240
    v_mfma_f32_16x16x32_bf16 v[68:71], a[224:227], v[140:143], v[68:71]
    ds_read_b64_tr_b16 a[184:185], v25 offset:16384
    v_mov_b32 v242, 2147483648
    v_mfma_f32_16x16x32_bf16 v[68:71], a[228:231], v[156:159], v[68:71]
    s_lshl_b32 s43, s40, 3
    ds_read_b64_tr_b16 a[186:187], v25 offset:20480
    v_mfma_f32_16x16x32_bf16 v[68:71], a[232:235], v[204:207], v[68:71]
    s_lshl_b32 s44, s3, 1
    ds_read_b64_tr_b16 a[188:189], v25 offset:24576
    v_mfma_f32_16x16x32_bf16 v[68:71], a[236:239], v[188:191], v[68:71]
    s_waitcnt lgkmcnt(13)
    s_add_u32 s43, s43, s44
    ds_read_b64_tr_b16 a[190:191], v25 offset:28672
    v_cndmask_b32 v242, v242, 0, vcc
    v_mfma_f32_16x16x32_bf16 v[72:75], a[160:163], v[128:131], 0
    s_waitcnt lgkmcnt(12)
    ds_read_b64_tr_b16 a[208:209], v22 offset:0
    v_add_u32 v7, s43, v241
    v_mfma_f32_16x16x32_bf16 v[72:75], a[164:167], v[144:147], v[72:75]
    s_waitcnt lgkmcnt(11)
    ds_read_b64_tr_b16 a[210:211], v22 offset:4096
    v_lshlrev_b32 v5, 4, v240
    v_mfma_f32_16x16x32_bf16 v[72:75], a[168:171], v[192:195], v[72:75]
    s_waitcnt lgkmcnt(10)
    ds_read_b64_tr_b16 a[212:213], v22 offset:8192
    v_lshlrev_b32 v243, 4, v241
    v_mfma_f32_16x16x32_bf16 v[72:75], a[172:175], v[176:179], v[72:75]
    s_waitcnt lgkmcnt(9)
    ds_read_b64_tr_b16 a[214:215], v22 offset:12288
    v_lshl_add_u32 v2, v240, 5, v243
    v_mfma_f32_16x16x32_bf16 v[72:75], a[176:179], v[136:139], v[72:75]
    s_waitcnt lgkmcnt(8)
    ds_read_b64_tr_b16 a[216:217], v22 offset:16384
    v_lshrrev_b32 v243, 4, v240
    v_mfma_f32_16x16x32_bf16 v[72:75], a[180:183], v[152:155], v[72:75]
    s_waitcnt lgkmcnt(7)
    ds_read_b64_tr_b16 a[218:219], v22 offset:20480
    v_mul_u32_u24 v243, 1536, v243
    v_mfma_f32_16x16x32_bf16 v[72:75], a[184:187], v[200:203], v[72:75]
    s_waitcnt lgkmcnt(6)
    ds_read_b64_tr_b16 a[220:221], v22 offset:24576
    v_add_u32 v2, v2, v243
    v_mfma_f32_16x16x32_bf16 v[72:75], a[188:191], v[184:187], v[72:75]
    s_mul_i32 s44, s43, 10240
    ds_read_b64_tr_b16 a[222:223], v22 offset:28672
    v_lshrrev_b32 v243, 2, v240
    v_mfma_f32_16x16x32_bf16 v[76:79], a[160:163], v[132:135], 0
    ds_read_b64_tr_b16 a[224:225], v26 offset:0
    v_lshlrev_b32 v243, 6, v243
    v_mfma_f32_16x16x32_bf16 v[76:79], a[164:167], v[148:151], v[76:79]
    ds_read_b64_tr_b16 a[226:227], v26 offset:4096
    v_and_b32 v241, 3, v240
    v_mfma_f32_16x16x32_bf16 v[76:79], a[168:171], v[196:199], v[76:79]
    ds_read_b64_tr_b16 a[228:229], v26 offset:8192
    v_lshl_add_u32 v3, v241, 3, v243
    v_mfma_f32_16x16x32_bf16 v[76:79], a[172:175], v[180:183], v[76:79]
    ds_read_b64_tr_b16 a[230:231], v26 offset:12288
    v_mul_u32_u24 v243, 1152, v7
    v_mfma_f32_16x16x32_bf16 v[76:79], a[176:179], v[140:143], v[76:79]
    ds_read_b64_tr_b16 a[232:233], v26 offset:16384
    v_add_u32 v4, v243, v3
    v_mfma_f32_16x16x32_bf16 v[76:79], a[180:183], v[156:159], v[76:79]
    ds_read_b64_tr_b16 a[234:235], v26 offset:20480
    v_lshl_add_u32 v6, v243, 1, v5
    v_mfma_f32_16x16x32_bf16 v[76:79], a[184:187], v[204:207], v[76:79]
    ds_read_b64_tr_b16 a[236:237], v26 offset:24576
    v_or_b32 v55, v3, v242
    v_mfma_f32_16x16x32_bf16 v[76:79], a[188:191], v[188:191], v[76:79]
    s_waitcnt lgkmcnt(13)
    ds_read_b64_tr_b16 a[238:239], v26 offset:28672
    v_or_b32 v58, v4, v242
    v_mfma_f32_16x16x32_bf16 v[80:83], a[208:211], v[128:131], 0
    s_waitcnt lgkmcnt(12)
    ds_read_b64_tr_b16 a[160:161], v23 offset:0
    v_or_b32 v59, v5, v242
    v_mfma_f32_16x16x32_bf16 v[80:83], a[212:215], v[144:147], v[80:83]
    s_waitcnt lgkmcnt(11)
    ds_read_b64_tr_b16 a[162:163], v23 offset:4096
    v_or_b32 v60, v6, v242
    v_mfma_f32_16x16x32_bf16 v[80:83], a[216:219], v[192:195], v[80:83]
    s_waitcnt lgkmcnt(10)
    ds_read_b64_tr_b16 a[164:165], v23 offset:8192
    s_waitcnt vmcnt(6)
    v_readfirstlane_b32 s36, v11
    v_mfma_f32_16x16x32_bf16 v[80:83], a[220:223], v[176:179], v[80:83]
    s_waitcnt lgkmcnt(9)
    ds_read_b64_tr_b16 a[166:167], v23 offset:12288
    v_lshrrev_b32 v243, 4, v1
    v_mfma_f32_16x16x32_bf16 v[80:83], a[224:227], v[136:139], v[80:83]
    ds_read_b64_tr_b16 a[168:169], v23 offset:16384
    v_lshlrev_b32 v243, 8, v243
    s_cmp_lg_u32 s36, s95
    s_cbranch_scc1 Lattn_xspin
Lattn_xgot:
    s_waitcnt lgkmcnt(9)
    v_mfma_f32_16x16x32_bf16 v[80:83], a[228:231], v[152:155], v[80:83]
    s_waitcnt lgkmcnt(7)
    ds_read_b64_tr_b16 a[170:171], v23 offset:20480
    v_and_b32 v241, 7, v1
    v_mfma_f32_16x16x32_bf16 v[80:83], a[232:235], v[200:203], v[80:83]
    s_waitcnt lgkmcnt(6)
    ds_read_b64_tr_b16 a[172:173], v23 offset:24576
    v_lshl_add_u32 v243, v241, 5, v243
    v_mfma_f32_16x16x32_bf16 v[80:83], a[236:239], v[184:187], v[80:83]
    s_add_u32 s37, s55, 0
    ds_read_b64_tr_b16 a[174:175], v23 offset:28672
    v_and_b32 v241, 8, v1
    v_mfma_f32_16x16x32_bf16 v[84:87], a[208:211], v[132:135], 0
    buffer_load_dwordx4 a[64:67], v252, s[28:31], s37 offen offset:0 sc1
    v_mfma_f32_16x16x32_bf16 v[84:87], a[212:215], v[148:151], v[84:87]
    ds_read_b64_tr_b16 a[176:177], v27 offset:0
    ds_read_b64_tr_b16 a[178:179], v27 offset:4096
    v_mfma_f32_16x16x32_bf16 v[84:87], a[216:219], v[196:199], v[84:87]
    buffer_load_dwordx4 a[68:71], v252, s[28:31], s37 offen offset:1024 sc1
    v_mfma_f32_16x16x32_bf16 v[84:87], a[220:223], v[180:183], v[84:87]
Ltour9:
    s_cbranch_execz Ltour13
    ds_read_b64_tr_b16 a[180:181], v27 offset:8192
    ds_read_b64_tr_b16 a[182:183], v27 offset:12288
    v_mfma_f32_16x16x32_bf16 v[84:87], a[224:227], v[140:143], v[84:87]
    ds_read_b64_tr_b16 a[184:185], v27 offset:16384
    v_lshl_add_u32 v54, v241, 1, v243
    v_mfma_f32_16x16x32_bf16 v[84:87], a[228:231], v[156:159], v[84:87]
    s_lshr_b32 s41, s2, 3
    ds_read_b64_tr_b16 a[186:187], v27 offset:20480
    v_mfma_f32_16x16x32_bf16 v[84:87], a[232:235], v[204:207], v[84:87]
    buffer_load_dwordx4 a[72:75], v252, s[28:31], s37 offen offset:2048 sc1
    v_mfma_f32_16x16x32_bf16 v[84:87], a[236:239], v[188:191], v[84:87]
    s_waitcnt lgkmcnt(12)
    s_mov_b32 s14, 2359296
    ds_read_b64_tr_b16 a[188:189], v27 offset:24576
    ds_read_b64_tr_b16 a[190:191], v27 offset:28672
    s_barrier
    v_mfma_f32_16x16x32_bf16 v[88:91], a[160:163], v[128:131], 0
    s_waitcnt lgkmcnt(12)
    s_mov_b32 s15, 0x20000
    ds_read_b64_tr_b16 a[208:209], v12 offset:32768
    v_mfma_f32_16x16x32_bf16 v[88:91], a[164:167], v[144:147], v[88:91]
    s_waitcnt lgkmcnt(11)
    s_mov_b32 s18, 2359296
    ds_read_b64_tr_b16 a[210:211], v12 offset:36864
    v_mfma_f32_16x16x32_bf16 v[88:91], a[168:171], v[192:195], v[88:91]
    s_waitcnt lgkmcnt(10)
    buffer_load_dwordx4 a[76:79], v252, s[28:31], s37 offen offset:3072 sc1
    v_mfma_f32_16x16x32_bf16 v[88:91], a[172:175], v[176:179], v[88:91]
    s_waitcnt lgkmcnt(8)
    s_mov_b32 s19, 0x20000
    ds_read_b64_tr_b16 a[212:213], v12 offset:40960
    ds_read_b64_tr_b16 a[214:215], v12 offset:45056
    v_mfma_f32_16x16x32_bf16 v[88:91], a[176:179], v[136:139], v[88:91]
    s_waitcnt lgkmcnt(8)
    s_add_u32 s8, s50, 7864320
    s_addc_u32 s9, s51, 0
    ds_read_b64_tr_b16 a[216:217], v12 offset:49152
    v_mfma_f32_16x16x32_bf16 v[88:91], a[180:183], v[152:155], v[88:91]
    s_waitcnt lgkmcnt(7)
    s_add_u32 s37, s55, 4096
    ds_read_b64_tr_b16 a[218:219], v12 offset:53248
    v_mfma_f32_16x16x32_bf16 v[88:91], a[184:187], v[200:203], v[88:91]
    s_waitcnt lgkmcnt(6)
    s_add_u32 s49, s46, 256
    buffer_load_dwordx4 a[80:83], v252, s[28:31], s37 offen offset:0 sc1
    v_mfma_f32_16x16x32_bf16 v[88:91], a[188:191], v[184:187], v[88:91]
    s_add_u32 m0, s42, 0
    ds_read_b64_tr_b16 a[220:221], v12 offset:57344
    ds_read_b64_tr_b16 a[222:223], v12 offset:61440
    v_mfma_f32_16x16x32_bf16 v[92:95], a[160:163], v[132:135], 0
    buffer_load_dwordx4 v46, s[20:23], s49 offen lds
    v_mfma_f32_16x16x32_bf16 v[92:95], a[164:167], v[148:151], v[92:95]
    s_mov_b32 s10, 663552
    ds_read_b64_tr_b16 a[224:225], v16 offset:32768
    ds_read_b64_tr_b16 a[226:227], v16 offset:36864
    v_mfma_f32_16x16x32_bf16 v[92:95], a[168:171], v[196:199], v[92:95]
    buffer_load_dwordx4 v47, s[20:23], s49 offen offset:1024 lds
    v_mfma_f32_16x16x32_bf16 v[92:95], a[172:175], v[180:183], v[92:95]
    s_mov_b32 s11, 0x20000
    ds_read_b64_tr_b16 a[228:229], v16 offset:40960
    ds_read_b64_tr_b16 a[230:231], v16 offset:45056
    v_mfma_f32_16x16x32_bf16 v[92:95], a[176:179], v[140:143], v[92:95]
    buffer_load_dwordx4 a[84:87], v252, s[28:31], s37 offen offset:1024 sc1
    v_mfma_f32_16x16x32_bf16 v[92:95], a[180:183], v[156:159], v[92:95]
    s_lshl_b32 s39, s5, 13
    ds_read_b64_tr_b16 a[232:233], v16 offset:49152
    ds_read_b64_tr_b16 a[234:235], v16 offset:53248
    v_mfma_f32_16x16x32_bf16 v[92:95], a[184:187], v[204:207], v[92:95]
    s_add_u32 s39, s39, 8781824
    ds_read_b64_tr_b16 a[236:237], v16 offset:57344
    v_mfma_f32_16x16x32_bf16 v[92:95], a[188:191], v[188:191], v[92:95]
    s_waitcnt lgkmcnt(13)
    s_lshr_b32 s45, s4, 2
    ds_read_b64_tr_b16 a[238:239], v16 offset:61440
    v_mfma_f32_16x16x32_bf16 v[96:99], a[208:211], v[128:131], 0
    s_waitcnt lgkmcnt(12)
    buffer_load_dwordx4 v48, s[20:23], s49 offen offset:2048 lds
    v_mfma_f32_16x16x32_bf16 v[96:99], a[212:215], v[144:147], v[96:99]
    s_waitcnt lgkmcnt(10)
    s_lshl_b32 s45, s45, 11
    ds_read_b64_tr_b16 a[160:161], v13 offset:32768
    ds_read_b64_tr_b16 a[162:163], v13 offset:36864
    v_mfma_f32_16x16x32_bf16 v[96:99], a[216:219], v[192:195], v[96:99]
    s_waitcnt lgkmcnt(10)
    buffer_load_dwordx4 v49, s[20:23], s49 offen offset:3072 lds
    v_mfma_f32_16x16x32_bf16 v[96:99], a[220:223], v[176:179], v[96:99]
    s_waitcnt lgkmcnt(8)
    s_add_u32 s39, s39, s45
    ds_read_b64_tr_b16 a[164:165], v13 offset:40960
    ds_read_b64_tr_b16 a[166:167], v13 offset:45056
    v_mfma_f32_16x16x32_bf16 v[96:99], a[224:227], v[136:139], v[96:99]
    s_waitcnt lgkmcnt(8)
    buffer_load_dwordx4 a[88:91], v252, s[28:31], s37 offen offset:2048 sc1
    v_mfma_f32_16x16x32_bf16 v[96:99], a[228:231], v[152:155], v[96:99]
    s_waitcnt lgkmcnt(6)
    ds_read_b64_tr_b16 a[168:169], v13 offset:49152
    ds_read_b64_tr_b16 a[170:171], v13 offset:53248
    v_mfma_f32_16x16x32_bf16 v[96:99], a[232:235], v[200:203], v[96:99]
    s_waitcnt lgkmcnt(6)
    s_add_u32 s49, s46, 73984
    ds_read_b64_tr_b16 a[172:173], v13 offset:57344
    v_and_b32 v9, 15, v1
    v_mfma_f32_16x16x32_bf16 v[96:99], a[236:239], v[184:187], v[96:99]
    s_add_u32 m0, s42, 16384
    ds_read_b64_tr_b16 a[174:175], v13 offset:61440
    v_lshlrev_b32 v9, 7, v9
    v_mfma_f32_16x16x32_bf16 v[100:103], a[208:211], v[132:135], 0
    buffer_load_dwordx4 v46, s[20:23], s49 offen lds
    v_mfma_f32_16x16x32_bf16 v[100:103], a[212:215], v[148:151], v[100:103]
    ds_read_b64_tr_b16 a[176:177], v17 offset:32768
    ds_read_b64_tr_b16 a[178:179], v17 offset:36864
    v_mfma_f32_16x16x32_bf16 v[100:103], a[216:219], v[196:199], v[100:103]
    buffer_load_dwordx4 v47, s[20:23], s49 offen offset:1024 lds
    v_mfma_f32_16x16x32_bf16 v[100:103], a[220:223], v[180:183], v[100:103]
    ds_read_b64_tr_b16 a[180:181], v17 offset:40960
    ds_read_b64_tr_b16 a[182:183], v17 offset:45056
    v_mfma_f32_16x16x32_bf16 v[100:103], a[224:227], v[140:143], v[100:103]
    buffer_load_dwordx4 a[92:95], v252, s[28:31], s37 offen offset:3072 sc1
    v_mfma_f32_16x16x32_bf16 v[100:103], a[228:231], v[156:159], v[100:103]
    ds_read_b64_tr_b16 a[184:185], v17 offset:49152
    ds_read_b64_tr_b16 a[186:187], v17 offset:53248
    v_mfma_f32_16x16x32_bf16 v[100:103], a[232:235], v[204:207], v[100:103]
    ds_read_b64_tr_b16 a[188:189], v17 offset:57344
    v_mfma_f32_16x16x32_bf16 v[100:103], a[236:239], v[188:191], v[100:103]
    s_waitcnt lgkmcnt(13)
    ds_read_b64_tr_b16 a[190:191], v17 offset:61440
    v_mfma_f32_16x16x32_bf16 v[104:107], a[160:163], v[128:131], 0
    s_waitcnt lgkmcnt(12)
    buffer_load_dwordx4 v48, s[20:23], s49 offen offset:2048 lds
    v_mfma_f32_16x16x32_bf16 v[104:107], a[164:167], v[144:147], v[104:107]
    s_waitcnt lgkmcnt(10)
    ds_read_b64_tr_b16 a[208:209], v14 offset:32768
    ds_read_b64_tr_b16 a[210:211], v14 offset:36864
    v_mfma_f32_16x16x32_bf16 v[104:107], a[168:171], v[192:195], v[104:107]
    s_waitcnt lgkmcnt(10)
    buffer_load_dwordx4 v49, s[20:23], s49 offen offset:3072 lds
    v_mfma_f32_16x16x32_bf16 v[104:107], a[172:175], v[176:179], v[104:107]
    s_waitcnt lgkmcnt(8)
    s_add_u32 s37, s55, 8192
    ds_read_b64_tr_b16 a[212:213], v14 offset:40960
    ds_read_b64_tr_b16 a[214:215], v14 offset:45056
    v_mfma_f32_16x16x32_bf16 v[104:107], a[176:179], v[136:139], v[104:107]
    s_waitcnt lgkmcnt(8)
    buffer_load_dwordx4 a[96:99], v252, s[28:31], s37 offen offset:0 sc1
    v_mfma_f32_16x16x32_bf16 v[104:107], a[180:183], v[152:155], v[104:107]
    s_waitcnt lgkmcnt(6)
    ds_read_b64_tr_b16 a[216:217], v14 offset:49152
    ds_read_b64_tr_b16 a[218:219], v14 offset:53248
    v_mfma_f32_16x16x32_bf16 v[104:107], a[184:187], v[200:203], v[104:107]
    s_waitcnt lgkmcnt(6)
    buffer_load_dwordx4 a[100:103], v252, s[28:31], s37 offen offset:1024 sc1
    v_mfma_f32_16x16x32_bf16 v[104:107], a[188:191], v[184:187], v[104:107]
    ds_read_b64_tr_b16 a[220:221], v14 offset:57344
    ds_read_b64_tr_b16 a[222:223], v14 offset:61440
    v_mfma_f32_16x16x32_bf16 v[108:111], a[160:163], v[132:135], 0
    ds_read_b64_tr_b16 a[224:225], v18 offset:32768
    v_mfma_f32_16x16x32_bf16 v[108:111], a[164:167], v[148:151], v[108:111]
    ds_read_b64_tr_b16 a[226:227], v18 offset:36864
    v_mfma_f32_16x16x32_bf16 v[108:111], a[168:171], v[196:199], v[108:111]
    buffer_load_dwordx4 a[104:107], v252, s[28:31], s37 offen offset:2048 sc1
    v_mfma_f32_16x16x32_bf16 v[108:111], a[172:175], v[180:183], v[108:111]
    ds_read_b64_tr_b16 a[228:229], v18 offset:40960
    ds_read_b64_tr_b16 a[230:231], v18 offset:45056
    v_mfma_f32_16x16x32_bf16 v[108:111], a[176:179], v[140:143], v[108:111]
    ds_read_b64_tr_b16 a[232:233], v18 offset:49152
    v_mfma_f32_16x16x32_bf16 v[108:111], a[180:183], v[156:159], v[108:111]
    ds_read_b64_tr_b16 a[234:235], v18 offset:53248
    v_mfma_f32_16x16x32_bf16 v[108:111], a[184:187], v[204:207], v[108:111]
    buffer_load_dwordx4 a[108:111], v252, s[28:31], s37 offen offset:3072 sc1
    v_mfma_f32_16x16x32_bf16 v[108:111], a[188:191], v[188:191], v[108:111]
    s_waitcnt lgkmcnt(12)
    ds_read_b64_tr_b16 a[236:237], v18 offset:57344
    ds_read_b64_tr_b16 a[238:239], v18 offset:61440
    v_mfma_f32_16x16x32_bf16 v[112:115], a[208:211], v[128:131], 0
    s_waitcnt lgkmcnt(12)
    ds_read_b64_tr_b16 a[160:161], v15 offset:32768
    v_mfma_f32_16x16x32_bf16 v[112:115], a[212:215], v[144:147], v[112:115]
    s_waitcnt lgkmcnt(11)
    s_add_u32 s37, s55, 12288
    ds_read_b64_tr_b16 a[162:163], v15 offset:36864
    v_mfma_f32_16x16x32_bf16 v[112:115], a[216:219], v[192:195], v[112:115]
    s_waitcnt lgkmcnt(10)
    buffer_load_dwordx4 a[112:115], v252, s[28:31], s37 offen offset:0 sc1
    v_mfma_f32_16x16x32_bf16 v[112:115], a[220:223], v[176:179], v[112:115]
    s_waitcnt lgkmcnt(8)
    ds_read_b64_tr_b16 a[164:165], v15 offset:40960
    ds_read_b64_tr_b16 a[166:167], v15 offset:45056
    v_mfma_f32_16x16x32_bf16 v[112:115], a[224:227], v[136:139], v[112:115]
    s_waitcnt lgkmcnt(8)
    buffer_load_dwordx4 a[116:119], v252, s[28:31], s37 offen offset:1024 sc1
    v_mfma_f32_16x16x32_bf16 v[112:115], a[228:231], v[152:155], v[112:115]
    s_waitcnt lgkmcnt(6)
    ds_read_b64_tr_b16 a[168:169], v15 offset:49152
    ds_read_b64_tr_b16 a[170:171], v15 offset:53248
    v_mfma_f32_16x16x32_bf16 v[112:115], a[232:235], v[200:203], v[112:115]
    s_waitcnt lgkmcnt(6)
    ds_read_b64_tr_b16 a[172:173], v15 offset:57344
    v_mfma_f32_16x16x32_bf16 v[112:115], a[236:239], v[184:187], v[112:115]
    ds_read_b64_tr_b16 a[174:175], v15 offset:61440
    v_mfma_f32_16x16x32_bf16 v[116:119], a[208:211], v[132:135], 0
    buffer_load_dwordx4 a[120:123], v252, s[28:31], s37 offen offset:2048 sc1
    v_mfma_f32_16x16x32_bf16 v[116:119], a[212:215], v[148:151], v[116:119]
    ds_read_b64_tr_b16 a[176:177], v19 offset:32768
    ds_read_b64_tr_b16 a[178:179], v19 offset:36864
    v_mfma_f32_16x16x32_bf16 v[116:119], a[216:219], v[196:199], v[116:119]
    ds_read_b64_tr_b16 a[180:181], v19 offset:40960
    v_mfma_f32_16x16x32_bf16 v[116:119], a[220:223], v[180:183], v[116:119]
    ds_read_b64_tr_b16 a[182:183], v19 offset:45056
    v_mfma_f32_16x16x32_bf16 v[116:119], a[224:227], v[140:143], v[116:119]
    buffer_load_dwordx4 a[124:127], v252, s[28:31], s37 offen offset:3072 sc1
    v_mfma_f32_16x16x32_bf16 v[116:119], a[228:231], v[156:159], v[116:119]
    ds_read_b64_tr_b16 a[184:185], v19 offset:49152
    ds_read_b64_tr_b16 a[186:187], v19 offset:53248
    v_mfma_f32_16x16x32_bf16 v[116:119], a[232:235], v[204:207], v[116:119]
    ds_read_b64_tr_b16 a[188:189], v19 offset:57344
    v_mfma_f32_16x16x32_bf16 v[116:119], a[236:239], v[188:191], v[116:119]
    ds_read_b64_tr_b16 a[190:191], v19 offset:61440
    s_waitcnt vmcnt(25)
    s_waitcnt lgkmcnt(0)
    s_barrier
    v_mfma_f32_16x16x32_bf16 v[120:123], a[160:163], v[128:131], 0
    ds_read_b64_tr_b16 a[208:209], v20 offset:32768
    v_mfma_f32_16x16x32_bf16 v[120:123], a[164:167], v[144:147], v[120:123]
    ds_read_b64_tr_b16 a[210:211], v20 offset:36864
    v_mfma_f32_16x16x32_bf16 v[120:123], a[168:171], v[192:195], v[120:123]
    ds_read_b64_tr_b16 a[212:213], v20 offset:40960
    v_mfma_f32_16x16x32_bf16 v[120:123], a[172:175], v[176:179], v[120:123]
    ds_read_b64_tr_b16 a[214:215], v20 offset:45056
    v_mfma_f32_16x16x32_bf16 v[120:123], a[176:179], v[136:139], v[120:123]
    ds_read_b64_tr_b16 a[216:217], v20 offset:49152
    v_mfma_f32_16x16x32_bf16 v[120:123], a[180:183], v[152:155], v[120:123]
    ds_read_b64_tr_b16 a[218:219], v20 offset:53248
    v_mfma_f32_16x16x32_bf16 v[120:123], a[184:187], v[200:203], v[120:123]
    s_add_u32 s49, s7, 512
    ds_read_b64_tr_b16 a[220:221], v20 offset:57344
    v_mfma_f32_16x16x32_bf16 v[120:123], a[188:191], v[184:187], v[120:123]
    s_add_u32 m0, s42, 65536
    ds_read_b64_tr_b16 a[222:223], v20 offset:61440
    v_mfma_f32_16x16x32_bf16 v[124:127], a[160:163], v[132:135], 0
    buffer_load_dwordx4 v46, s[20:23], s49 offen lds
    v_mfma_f32_16x16x32_bf16 v[124:127], a[164:167], v[148:151], v[124:127]
    ds_read_b64_tr_b16 a[224:225], v24 offset:32768
    ds_read_b64_tr_b16 a[226:227], v24 offset:36864
    v_mfma_f32_16x16x32_bf16 v[124:127], a[168:171], v[196:199], v[124:127]
    buffer_load_dwordx4 v47, s[20:23], s49 offen offset:1024 lds
    v_mfma_f32_16x16x32_bf16 v[124:127], a[172:175], v[180:183], v[124:127]
    ds_read_b64_tr_b16 a[228:229], v24 offset:40960
    ds_read_b64_tr_b16 a[230:231], v24 offset:45056
    v_mfma_f32_16x16x32_bf16 v[124:127], a[176:179], v[140:143], v[124:127]
    ds_read_b64_tr_b16 a[232:233], v24 offset:49152
    v_mfma_f32_16x16x32_bf16 v[124:127], a[180:183], v[156:159], v[124:127]
    ds_read_b64_tr_b16 a[234:235], v24 offset:53248
    v_mfma_f32_16x16x32_bf16 v[124:127], a[184:187], v[204:207], v[124:127]
    ds_read_b64_tr_b16 a[236:237], v24 offset:57344
    v_lshrrev_b32 v240, 4, v1
    v_mfma_f32_16x16x32_bf16 v[124:127], a[188:191], v[188:191], v[124:127]
    s_waitcnt vmcnt(25)
    s_waitcnt lgkmcnt(13)
    ds_read_b64_tr_b16 a[238:239], v24 offset:61440
    v_and_b32 v240, 2, v240
    v_mfma_f32_16x16x32_bf16 v[64:67], a[208:211], a[64:67], v[64:67]
    s_waitcnt vmcnt(24)
    s_waitcnt lgkmcnt(12)
    buffer_load_dwordx4 v48, s[20:23], s49 offen offset:2048 lds
    v_mfma_f32_16x16x32_bf16 v[64:67], a[212:215], a[68:71], v[64:67]
    s_waitcnt vmcnt(24)
    s_waitcnt lgkmcnt(10)
    ds_read_b64_tr_b16 a[160:161], v21 offset:32768
    ds_read_b64_tr_b16 a[162:163], v21 offset:36864
    v_mfma_f32_16x16x32_bf16 v[64:67], a[216:219], a[72:75], v[64:67]
    s_waitcnt vmcnt(23)
    s_waitcnt lgkmcnt(10)
    buffer_load_dwordx4 v49, s[20:23], s49 offen offset:3072 lds
    v_mfma_f32_16x16x32_bf16 v[64:67], a[220:223], a[76:79], v[64:67]
    s_waitcnt vmcnt(23)
    s_waitcnt lgkmcnt(8)
    ds_read_b64_tr_b16 a[164:165], v21 offset:40960
    ds_read_b64_tr_b16 a[166:167], v21 offset:45056
    v_mfma_f32_16x16x32_bf16 v[64:67], a[224:227], a[80:83], v[64:67]
    s_waitcnt vmcnt(20)
    s_waitcnt lgkmcnt(8)
    ds_read_b64_tr_b16 a[168:169], v21 offset:49152
    v_bfe_u32 v241, v1, 2, 2
    v_mfma_f32_16x16x32_bf16 v[64:67], a[228:231], a[84:87], v[64:67]
    s_waitcnt vmcnt(17)
    s_waitcnt lgkmcnt(7)
    ds_read_b64_tr_b16 a[170:171], v21 offset:53248
    v_cmp_eq_u32 s[54:55], v240, v241
    v_mfma_f32_16x16x32_bf16 v[64:67], a[232:235], a[88:91], v[64:67]
    s_waitcnt vmcnt(14)
    s_waitcnt lgkmcnt(6)
    s_add_u32 s49, s7, 74240
    ds_read_b64_tr_b16 a[172:173], v21 offset:57344
    v_or_b32 v240, 1, v240
    v_mfma_f32_16x16x32_bf16 v[64:67], a[236:239], a[92:95], v[64:67]
    s_waitcnt vmcnt(11)
    s_add_u32 m0, s42, 81920
    ds_read_b64_tr_b16 a[174:175], v21 offset:61440
    v_cmp_eq_u32 s[36:37], v240, v241
    v_mfma_f32_16x16x32_bf16 v[68:71], a[208:211], a[96:99], v[68:71]
    s_waitcnt vmcnt(10)
    buffer_load_dwordx4 v46, s[20:23], s49 offen lds
    v_mfma_f32_16x16x32_bf16 v[68:71], a[212:215], a[100:103], v[68:71]
    s_waitcnt vmcnt(10)
    ds_read_b64_tr_b16 a[176:177], v25 offset:32768
    ds_read_b64_tr_b16 a[178:179], v25 offset:36864
    v_mfma_f32_16x16x32_bf16 v[68:71], a[216:219], a[104:107], v[68:71]
    s_waitcnt vmcnt(9)
    buffer_load_dwordx4 v47, s[20:23], s49 offen offset:1024 lds
    v_mfma_f32_16x16x32_bf16 v[68:71], a[220:223], a[108:111], v[68:71]
    s_waitcnt vmcnt(9)
    ds_read_b64_tr_b16 a[180:181], v25 offset:40960
    ds_read_b64_tr_b16 a[182:183], v25 offset:45056
    v_mfma_f32_16x16x32_bf16 v[68:71], a[224:227], a[112:115], v[68:71]
    s_waitcnt vmcnt(8)
    ds_read_b64_tr_b16 a[184:185], v25 offset:49152
    v_cvt_pk_bf16_f32 v224, v64, v65
    v_mfma_f32_16x16x32_bf16 v[68:71], a[228:231], a[116:119], v[68:71]
    s_waitcnt vmcnt(7)
    ds_read_b64_tr_b16 a[186:187], v25 offset:53248
    v_cvt_pk_bf16_f32 v225, v66, v67
    v_mfma_f32_16x16x32_bf16 v[68:71], a[232:235], a[120:123], v[68:71]
    s_waitcnt vmcnt(6)
    buffer_load_dwordx2 v[36:37], v4, s[12:15], 0 offen offset:0
    v_mfma_f32_16x16x32_bf16 v[68:71], a[236:239], a[124:127], v[68:71]
    s_waitcnt lgkmcnt(12)
    ds_read_b64_tr_b16 a[188:189], v25 offset:57344
    ds_read_b64_tr_b16 a[190:191], v25 offset:61440
    v_mfma_f32_16x16x32_bf16 v[72:75], a[160:163], a[64:67], v[72:75]
    s_waitcnt lgkmcnt(12)
    buffer_load_dwordx4 v48, s[20:23], s49 offen offset:2048 lds
    v_mfma_f32_16x16x32_bf16 v[72:75], a[164:167], a[68:71], v[72:75]
    s_waitcnt lgkmcnt(10)
    ds_read_b64_tr_b16 a[208:209], v22 offset:32768
    ds_read_b64_tr_b16 a[210:211], v22 offset:36864
    v_mfma_f32_16x16x32_bf16 v[72:75], a[168:171], a[72:75], v[72:75]
    s_waitcnt lgkmcnt(10)
    buffer_load_dwordx4 v49, s[20:23], s49 offen offset:3072 lds
    v_mfma_f32_16x16x32_bf16 v[72:75], a[172:175], a[76:79], v[72:75]
    s_waitcnt lgkmcnt(8)
    ds_read_b64_tr_b16 a[212:213], v22 offset:40960
    ds_read_b64_tr_b16 a[214:215], v22 offset:45056
    v_mfma_f32_16x16x32_bf16 v[72:75], a[176:179], a[80:83], v[72:75]
    s_waitcnt lgkmcnt(8)
    ds_read_b64_tr_b16 a[216:217], v22 offset:49152
    v_cvt_pk_bf16_f32 v228, v68, v69
    v_mfma_f32_16x16x32_bf16 v[72:75], a[180:183], a[84:87], v[72:75]
    s_waitcnt lgkmcnt(7)
    ds_read_b64_tr_b16 a[218:219], v22 offset:53248
    v_cvt_pk_bf16_f32 v229, v70, v71
    v_mfma_f32_16x16x32_bf16 v[72:75], a[184:187], a[88:91], v[72:75]
    s_waitcnt lgkmcnt(6)
    ds_read_b64_tr_b16 a[220:221], v22 offset:57344
    v_and_b32 v240, 1, v1
    v_mfma_f32_16x16x32_bf16 v[72:75], a[188:191], a[92:95], v[72:75]
    ds_read_b64_tr_b16 a[222:223], v22 offset:61440
    v_lshlrev_b32 v240, 4, v240
    v_mfma_f32_16x16x32_bf16 v[76:79], a[160:163], a[96:99], v[76:79]
    buffer_load_dwordx2 v[38:39], v4, s[12:15], 0 offen offset:32
    v_mfma_f32_16x16x32_bf16 v[76:79], a[164:167], a[100:103], v[76:79]
    ds_read_b64_tr_b16 a[224:225], v26 offset:32768
    ds_read_b64_tr_b16 a[226:227], v26 offset:36864
    v_mfma_f32_16x16x32_bf16 v[76:79], a[168:171], a[104:107], v[76:79]
    ds_read_b64_tr_b16 a[228:229], v26 offset:40960
    v_mov_b32 v241, 0x3f80
    v_mfma_f32_16x16x32_bf16 v[76:79], a[172:175], a[108:111], v[76:79]
    ds_read_b64_tr_b16 a[230:231], v26 offset:45056
    v_lshlrev_b32 v240, v240, v241
    v_mfma_f32_16x16x32_bf16 v[76:79], a[176:179], a[112:115], v[76:79]
    ds_read_b64_tr_b16 a[232:233], v26 offset:49152
    v_cvt_pk_bf16_f32 v226, v72, v73
    v_mfma_f32_16x16x32_bf16 v[76:79], a[180:183], a[116:119], v[76:79]
    s_add_u32 s38, s93, 0
    ds_read_b64_tr_b16 a[234:235], v26 offset:53248
    v_cvt_pk_bf16_f32 v227, v74, v75
    v_mfma_f32_16x16x32_bf16 v[76:79], a[184:187], a[120:123], v[76:79]
    buffer_store_dwordx4 v[224:227], v56, s[28:31], s38 offen sc1
    v_mfma_f32_16x16x32_bf16 v[76:79], a[188:191], a[124:127], v[76:79]
    s_waitcnt lgkmcnt(12)
    ds_read_b64_tr_b16 a[236:237], v26 offset:57344
    ds_read_b64_tr_b16 a[238:239], v26 offset:61440
    v_mfma_f32_16x16x32_bf16 v[80:83], a[208:211], a[64:67], v[80:83]
    s_waitcnt lgkmcnt(12)
    ds_read_b64_tr_b16 a[160:161], v23 offset:32768
    v_bfe_i32 v241, v1, 1, 1
    v_mfma_f32_16x16x32_bf16 v[80:83], a[212:215], a[68:71], v[80:83]
    s_waitcnt lgkmcnt(11)
    ds_read_b64_tr_b16 a[162:163], v23 offset:36864
    v_and_b32 v243, v240, v241
    v_mfma_f32_16x16x32_bf16 v[80:83], a[216:219], a[72:75], v[80:83]
    s_waitcnt lgkmcnt(10)
    buffer_load_dwordx2 v[40:41], v4, s[12:15], 0 offen offset:512
    v_mfma_f32_16x16x32_bf16 v[80:83], a[220:223], a[76:79], v[80:83]
    s_waitcnt lgkmcnt(8)
    ds_read_b64_tr_b16 a[164:165], v23 offset:40960
    ds_read_b64_tr_b16 a[166:167], v23 offset:45056
    v_mfma_f32_16x16x32_bf16 v[80:83], a[224:227], a[80:83], v[80:83]
    s_waitcnt lgkmcnt(8)
    ds_read_b64_tr_b16 a[168:169], v23 offset:49152
    v_cvt_pk_bf16_f32 v230, v76, v77
    v_mfma_f32_16x16x32_bf16 v[80:83], a[228:231], a[84:87], v[80:83]
    s_waitcnt lgkmcnt(7)
    s_add_u32 s38, s93, 163840
    ds_read_b64_tr_b16 a[170:171], v23 offset:53248
    v_cvt_pk_bf16_f32 v231, v78, v79
    v_mfma_f32_16x16x32_bf16 v[80:83], a[232:235], a[88:91], v[80:83]
    s_waitcnt lgkmcnt(6)
    buffer_store_dwordx4 v[228:231], v56, s[28:31], s38 offen sc1
    v_mfma_f32_16x16x32_bf16 v[80:83], a[236:239], a[92:95], v[80:83]
    ds_read_b64_tr_b16 a[172:173], v23 offset:57344
    ds_read_b64_tr_b16 a[174:175], v23 offset:61440
    v_mfma_f32_16x16x32_bf16 v[84:87], a[208:211], a[96:99], v[84:87]
    ds_read_b64_tr_b16 a[176:177], v27 offset:32768
    v_xor_b32 v242, v240, v243
    v_mfma_f32_16x16x32_bf16 v[84:87], a[212:215], a[100:103], v[84:87]
    ds_read_b64_tr_b16 a[178:179], v27 offset:36864
    v_cndmask_b32 v246, 0, v242, s[54:55]
    v_mfma_f32_16x16x32_bf16 v[84:87], a[216:219], a[104:107], v[84:87]
    ds_read_b64_tr_b16 a[180:181], v27 offset:40960
    v_cndmask_b32 v247, 0, v243, s[54:55]
    v_mfma_f32_16x16x32_bf16 v[84:87], a[220:223], a[108:111], v[84:87]
    ds_read_b64_tr_b16 a[182:183], v27 offset:45056
    v_cndmask_b32 v250, 0, v242, s[36:37]
    v_mfma_f32_16x16x32_bf16 v[84:87], a[224:227], a[112:115], v[84:87]
    ds_read_b64_tr_b16 a[184:185], v27 offset:49152
    v_cvt_pk_bf16_f32 v232, v80, v81
    v_mfma_f32_16x16x32_bf16 v[84:87], a[228:231], a[116:119], v[84:87]
    ds_read_b64_tr_b16 a[186:187], v27 offset:53248
    v_cvt_pk_bf16_f32 v233, v82, v83
    v_mfma_f32_16x16x32_bf16 v[84:87], a[232:235], a[120:123], v[84:87]
    buffer_load_dwordx2 v[42:43], v4, s[12:15], 0 offen offset:544
    v_mfma_f32_16x16x32_bf16 v[84:87], a[236:239], a[124:127], v[84:87]
    s_waitcnt lgkmcnt(12)
    ds_read_b64_tr_b16 a[188:189], v27 offset:57344
    ds_read_b64_tr_b16 a[190:191], v27 offset:61440
    s_barrier
    v_mfma_f32_16x16x32_bf16 v[88:91], a[160:163], a[64:67], v[88:91]
    s_waitcnt lgkmcnt(12)
    ds_read_b64_tr_b16 a[208:209], v12 offset:0
    v_cndmask_b32 v251, 0, v243, s[36:37]
    v_mfma_f32_16x16x32_bf16 v[88:91], a[164:167], a[68:71], v[88:91]
    s_waitcnt lgkmcnt(11)
    ds_read_b64_tr_b16 a[210:211], v12 offset:4096
    v_mov_b32 v240, 0
    v_mfma_f32_16x16x32_bf16 v[88:91], a[168:171], a[72:75], v[88:91]
    s_waitcnt lgkmcnt(10)
    ds_read_b64_tr_b16 a[212:213], v12 offset:8192
    v_mov_b32 v241, 0
    v_mfma_f32_16x16x32_bf16 v[88:91], a[172:175], a[76:79], v[88:91]
    s_waitcnt lgkmcnt(9)
    ds_read_b64_tr_b16 a[214:215], v12 offset:12288
    v_mov_b32 v244, 0
    v_mfma_f32_16x16x32_bf16 v[88:91], a[176:179], a[80:83], v[88:91]
    s_waitcnt lgkmcnt(8)
    ds_read_b64_tr_b16 a[216:217], v12 offset:16384
    v_cvt_pk_bf16_f32 v236, v84, v85
    v_mfma_f32_16x16x32_bf16 v[88:91], a[180:183], a[84:87], v[88:91]
    s_waitcnt lgkmcnt(7)
    ds_read_b64_tr_b16 a[218:219], v12 offset:20480
    v_cvt_pk_bf16_f32 v237, v86, v87
    v_mfma_f32_16x16x32_bf16 v[88:91], a[184:187], a[88:91], v[88:91]
    s_waitcnt lgkmcnt(6)
    s_add_u32 s49, s46, 512
    ds_read_b64_tr_b16 a[220:221], v12 offset:24576
    v_mov_b32 v245, 0
    v_mfma_f32_16x16x32_bf16 v[88:91], a[188:191], a[92:95], v[88:91]
    s_add_u32 m0, s42, 32768
    ds_read_b64_tr_b16 a[222:223], v12 offset:28672
    v_mov_b32 v248, 0
    v_mfma_f32_16x16x32_bf16 v[92:95], a[160:163], a[96:99], v[92:95]
    buffer_load_dwordx4 v46, s[20:23], s49 offen lds
    v_mfma_f32_16x16x32_bf16 v[92:95], a[164:167], a[100:103], v[92:95]
    ds_read_b64_tr_b16 a[224:225], v16 offset:0
    ds_read_b64_tr_b16 a[226:227], v16 offset:4096
    v_mfma_f32_16x16x32_bf16 v[92:95], a[168:171], a[104:107], v[92:95]
    buffer_load_dwordx4 v47, s[20:23], s49 offen offset:1024 lds
    v_mfma_f32_16x16x32_bf16 v[92:95], a[172:175], a[108:111], v[92:95]
    ds_read_b64_tr_b16 a[228:229], v16 offset:8192
    ds_read_b64_tr_b16 a[230:231], v16 offset:12288
    v_mfma_f32_16x16x32_bf16 v[92:95], a[176:179], a[112:115], v[92:95]
    ds_read_b64_tr_b16 a[232:233], v16 offset:16384
    v_cvt_pk_bf16_f32 v234, v88, v89
    v_mfma_f32_16x16x32_bf16 v[92:95], a[180:183], a[116:119], v[92:95]
    s_add_u32 s38, s93, 128
    ds_read_b64_tr_b16 a[234:235], v16 offset:20480
    v_cvt_pk_bf16_f32 v235, v90, v91
    v_mfma_f32_16x16x32_bf16 v[92:95], a[184:187], a[120:123], v[92:95]
    buffer_store_dwordx4 v[232:235], v56, s[28:31], s38 offen sc1
    v_mfma_f32_16x16x32_bf16 v[92:95], a[188:191], a[124:127], v[92:95]
    s_waitcnt lgkmcnt(12)
    ds_read_b64_tr_b16 a[236:237], v16 offset:24576
    ds_read_b64_tr_b16 a[238:239], v16 offset:28672
    v_mfma_f32_16x16x32_bf16 v[96:99], a[208:211], a[64:67], v[96:99]
    s_waitcnt lgkmcnt(12)
    buffer_load_dwordx4 v48, s[20:23], s49 offen offset:2048 lds
    v_mfma_f32_16x16x32_bf16 v[96:99], a[212:215], a[68:71], v[96:99]
    s_waitcnt lgkmcnt(10)
    ds_read_b64_tr_b16 a[160:161], v13 offset:0
    ds_read_b64_tr_b16 a[162:163], v13 offset:4096
    v_mfma_f32_16x16x32_bf16 v[96:99], a[216:219], a[72:75], v[96:99]
    s_waitcnt lgkmcnt(10)
    buffer_load_dwordx4 v49, s[20:23], s49 offen offset:3072 lds
    v_mfma_f32_16x16x32_bf16 v[96:99], a[220:223], a[76:79], v[96:99]
    s_waitcnt lgkmcnt(8)
    ds_read_b64_tr_b16 a[164:165], v13 offset:8192
    ds_read_b64_tr_b16 a[166:167], v13 offset:12288
    v_mfma_f32_16x16x32_bf16 v[96:99], a[224:227], a[80:83], v[96:99]
    s_waitcnt lgkmcnt(8)
    ds_read_b64_tr_b16 a[168:169], v13 offset:16384
    v_cvt_pk_bf16_f32 v238, v92, v93
    v_mfma_f32_16x16x32_bf16 v[96:99], a[228:231], a[84:87], v[96:99]
    s_waitcnt lgkmcnt(7)
    s_add_u32 s38, s93, 163968
    ds_read_b64_tr_b16 a[170:171], v13 offset:20480
    v_cvt_pk_bf16_f32 v239, v94, v95
    v_mfma_f32_16x16x32_bf16 v[96:99], a[232:235], a[88:91], v[96:99]
    s_waitcnt lgkmcnt(6)
    s_add_u32 s49, s46, 74240
    buffer_store_dwordx4 v[236:239], v56, s[28:31], s38 offen sc1
    v_mfma_f32_16x16x32_bf16 v[96:99], a[236:239], a[92:95], v[96:99]
    s_add_u32 m0, s42, 49152
    ds_read_b64_tr_b16 a[172:173], v13 offset:24576
    ds_read_b64_tr_b16 a[174:175], v13 offset:28672
    v_mfma_f32_16x16x32_bf16 v[100:103], a[208:211], a[96:99], v[100:103]
    buffer_load_dwordx4 v46, s[20:23], s49 offen lds
    v_mfma_f32_16x16x32_bf16 v[100:103], a[212:215], a[100:103], v[100:103]
    ds_read_b64_tr_b16 a[176:177], v17 offset:0
    ds_read_b64_tr_b16 a[178:179], v17 offset:4096
    v_mfma_f32_16x16x32_bf16 v[100:103], a[216:219], a[104:107], v[100:103]
    buffer_load_dwordx4 v47, s[20:23], s49 offen offset:1024 lds
    v_mfma_f32_16x16x32_bf16 v[100:103], a[220:223], a[108:111], v[100:103]
    ds_read_b64_tr_b16 a[180:181], v17 offset:8192
    ds_read_b64_tr_b16 a[182:183], v17 offset:12288
    v_mfma_f32_16x16x32_bf16 v[100:103], a[224:227], a[112:115], v[100:103]
    ds_read_b64_tr_b16 a[184:185], v17 offset:16384
    v_cvt_pk_bf16_f32 v224, v96, v97
    v_mfma_f32_16x16x32_bf16 v[100:103], a[228:231], a[116:119], v[100:103]
    ds_read_b64_tr_b16 a[186:187], v17 offset:20480
    v_cvt_pk_bf16_f32 v225, v98, v99
    v_mfma_f32_16x16x32_bf16 v[100:103], a[232:235], a[120:123], v[100:103]
    ds_read_b64_tr_b16 a[188:189], v17 offset:24576
    v_mov_b32 v249, 0
    v_mfma_f32_16x16x32_bf16 v[100:103], a[236:239], a[124:127], v[100:103]
    s_waitcnt lgkmcnt(13)
    ds_read_b64_tr_b16 a[190:191], v17 offset:28672
    v_mov_b32 v252, 0
    v_mfma_f32_16x16x32_bf16 v[104:107], a[160:163], a[64:67], v[104:107]
    s_waitcnt lgkmcnt(12)
    buffer_load_dwordx4 v48, s[20:23], s49 offen offset:2048 lds
    v_mfma_f32_16x16x32_bf16 v[104:107], a[164:167], a[68:71], v[104:107]
    s_waitcnt lgkmcnt(10)
    ds_read_b64_tr_b16 a[208:209], v14 offset:0
    ds_read_b64_tr_b16 a[210:211], v14 offset:4096
    v_mfma_f32_16x16x32_bf16 v[104:107], a[168:171], a[72:75], v[104:107]
    s_waitcnt lgkmcnt(10)
    buffer_load_dwordx4 v49, s[20:23], s49 offen offset:3072 lds
    v_mfma_f32_16x16x32_bf16 v[104:107], a[172:175], a[76:79], v[104:107]
    s_waitcnt lgkmcnt(8)
    ds_read_b64_tr_b16 a[212:213], v14 offset:8192
    ds_read_b64_tr_b16 a[214:215], v14 offset:12288
    v_mfma_f32_16x16x32_bf16 v[104:107], a[176:179], a[80:83], v[104:107]
    s_waitcnt lgkmcnt(8)
    ds_read_b64_tr_b16 a[216:217], v14 offset:16384
    v_cvt_pk_bf16_f32 v228, v100, v101
    v_mfma_f32_16x16x32_bf16 v[104:107], a[180:183], a[84:87], v[104:107]
    s_waitcnt lgkmcnt(7)
    ds_read_b64_tr_b16 a[218:219], v14 offset:20480
    v_cvt_pk_bf16_f32 v229, v102, v103
    v_mfma_f32_16x16x32_bf16 v[104:107], a[184:187], a[88:91], v[104:107]
    s_waitcnt lgkmcnt(6)
    ds_read_b64_tr_b16 a[220:221], v14 offset:24576
    v_mov_b32 v253, 0
    v_mfma_f32_16x16x32_bf16 v[104:107], a[188:191], a[92:95], v[104:107]
    ds_read_b64_tr_b16 a[222:223], v14 offset:28672
    v_mfma_f32_16x16x32_bf16 v[108:111], a[160:163], a[96:99], v[108:111]
Ltour10:
    s_cbranch_execz Ltour14
    ds_read_b64_tr_b16 a[224:225], v18 offset:0
    v_mfma_f32_16x16x32_bf16 v[108:111], a[164:167], a[100:103], v[108:111]
    ds_read_b64_tr_b16 a[226:227], v18 offset:4096
    v_mfma_f32_16x16x32_bf16 v[108:111], a[168:171], a[104:107], v[108:111]
    ds_read_b64_tr_b16 a[228:229], v18 offset:8192
    v_mfma_f32_16x16x32_bf16 v[108:111], a[172:175], a[108:111], v[108:111]
    ds_read_b64_tr_b16 a[230:231], v18 offset:12288
    v_mfma_f32_16x16x32_bf16 v[108:111], a[176:179], a[112:115], v[108:111]
    ds_read_b64_tr_b16 a[232:233], v18 offset:16384
    v_cvt_pk_bf16_f32 v226, v104, v105
    v_mfma_f32_16x16x32_bf16 v[108:111], a[180:183], a[116:119], v[108:111]
    s_add_u32 s38, s93, 512
    ds_read_b64_tr_b16 a[234:235], v18 offset:20480
    v_cvt_pk_bf16_f32 v227, v106, v107
    v_mfma_f32_16x16x32_bf16 v[108:111], a[184:187], a[120:123], v[108:111]
    buffer_store_dwordx4 v[224:227], v56, s[28:31], s38 offen sc1
    v_mfma_f32_16x16x32_bf16 v[108:111], a[188:191], a[124:127], v[108:111]
    s_waitcnt lgkmcnt(12)
    ds_read_b64_tr_b16 a[236:237], v18 offset:24576
    ds_read_b64_tr_b16 a[238:239], v18 offset:28672
    v_mfma_f32_16x16x32_bf16 v[112:115], a[208:211], a[64:67], v[112:115]
    s_waitcnt lgkmcnt(12)
    ds_read_b64_tr_b16 a[160:161], v15 offset:0
    v_mfma_f32_16x16x32_bf16 v[112:115], a[212:215], a[68:71], v[112:115]
    s_waitcnt lgkmcnt(11)
    ds_read_b64_tr_b16 a[162:163], v15 offset:4096
    v_mfma_f32_16x16x32_bf16 v[112:115], a[216:219], a[72:75], v[112:115]
    s_waitcnt lgkmcnt(10)
    ds_read_b64_tr_b16 a[164:165], v15 offset:8192
    v_mfma_f32_16x16x32_bf16 v[112:115], a[220:223], a[76:79], v[112:115]
    s_waitcnt lgkmcnt(9)
    ds_read_b64_tr_b16 a[166:167], v15 offset:12288
    v_mfma_f32_16x16x32_bf16 v[112:115], a[224:227], a[80:83], v[112:115]
    s_waitcnt lgkmcnt(8)
    ds_read_b64_tr_b16 a[168:169], v15 offset:16384
    v_cvt_pk_bf16_f32 v230, v108, v109
    v_mfma_f32_16x16x32_bf16 v[112:115], a[228:231], a[84:87], v[112:115]
    s_waitcnt lgkmcnt(7)
    s_add_u32 s38, s93, 164352
    ds_read_b64_tr_b16 a[170:171], v15 offset:20480
    v_cvt_pk_bf16_f32 v231, v110, v111
    v_mfma_f32_16x16x32_bf16 v[112:115], a[232:235], a[88:91], v[112:115]
    s_waitcnt lgkmcnt(6)
    buffer_store_dwordx4 v[228:231], v56, s[28:31], s38 offen sc1
    v_mfma_f32_16x16x32_bf16 v[112:115], a[236:239], a[92:95], v[112:115]
    ds_read_b64_tr_b16 a[172:173], v15 offset:24576
    ds_read_b64_tr_b16 a[174:175], v15 offset:28672
    v_mfma_f32_16x16x32_bf16 v[116:119], a[208:211], a[96:99], v[116:119]
    ds_read_b64_tr_b16 a[176:177], v19 offset:0
    v_mfma_f32_16x16x32_bf16 v[116:119], a[212:215], a[100:103], v[116:119]
    ds_read_b64_tr_b16 a[178:179], v19 offset:4096
    v_mfma_f32_16x16x32_bf16 v[116:119], a[216:219], a[104:107], v[116:119]
    ds_read_b64_tr_b16 a[180:181], v19 offset:8192
    v_mfma_f32_16x16x32_bf16 v[116:119], a[220:223], a[108:111], v[116:119]
    ds_read_b64_tr_b16 a[182:183], v19 offset:12288
    v_mfma_f32_16x16x32_bf16 v[116:119], a[224:227], a[112:115], v[116:119]
    ds_read_b64_tr_b16 a[184:185], v19 offset:16384
    v_cvt_pk_bf16_f32 v232, v112, v113
    v_mfma_f32_16x16x32_bf16 v[116:119], a[228:231], a[116:119], v[116:119]
    ds_read_b64_tr_b16 a[186:187], v19 offset:20480
    v_cvt_pk_bf16_f32 v233, v114, v115
    v_mfma_f32_16x16x32_bf16 v[116:119], a[232:235], a[120:123], v[116:119]
    ds_read_b64_tr_b16 a[188:189], v19 offset:24576
    v_mfma_f32_16x16x32_bf16 v[116:119], a[236:239], a[124:127], v[116:119]
    s_waitcnt lgkmcnt(13)
    ds_read_b64_tr_b16 a[190:191], v19 offset:28672
    s_waitcnt vmcnt(17)
    s_barrier
    v_mfma_f32_16x16x32_bf16 v[120:123], a[160:163], a[64:67], v[120:123]
    s_waitcnt lgkmcnt(12)
    ds_read_b64_tr_b16 a[208:209], v20 offset:0
    v_mfma_f32_16x16x32_bf16 v[120:123], a[164:167], a[68:71], v[120:123]
    s_waitcnt lgkmcnt(11)
    ds_read_b64_tr_b16 a[210:211], v20 offset:4096
    v_mfma_f32_16x16x32_bf16 v[120:123], a[168:171], a[72:75], v[120:123]
    s_waitcnt lgkmcnt(10)
    ds_read_b64_tr_b16 a[212:213], v20 offset:8192
    v_mfma_f32_16x16x32_bf16 v[120:123], a[172:175], a[76:79], v[120:123]
    s_waitcnt lgkmcnt(9)
    ds_read_b64_tr_b16 a[214:215], v20 offset:12288
    v_mfma_f32_16x16x32_bf16 v[120:123], a[176:179], a[80:83], v[120:123]
    s_waitcnt lgkmcnt(8)
    ds_read_b64_tr_b16 a[216:217], v20 offset:16384
    v_cvt_pk_bf16_f32 v236, v116, v117
    v_mfma_f32_16x16x32_bf16 v[120:123], a[180:183], a[84:87], v[120:123]
    s_waitcnt lgkmcnt(7)
    ds_read_b64_tr_b16 a[218:219], v20 offset:20480
    v_cvt_pk_bf16_f32 v237, v118, v119
    v_mfma_f32_16x16x32_bf16 v[120:123], a[184:187], a[88:91], v[120:123]
    s_waitcnt lgkmcnt(6)
    s_add_u32 s49, s7, 768
    ds_read_b64_tr_b16 a[220:221], v20 offset:24576
    v_mfma_f32_16x16x32_bf16 v[120:123], a[188:191], a[92:95], v[120:123]
    s_add_u32 m0, s42, 98304
    ds_read_b64_tr_b16 a[222:223], v20 offset:28672
    v_mfma_f32_16x16x32_bf16 v[124:127], a[160:163], a[96:99], v[124:127]
    buffer_load_dwordx4 v46, s[20:23], s49 offen lds
    v_mfma_f32_16x16x32_bf16 v[124:127], a[164:167], a[100:103], v[124:127]
    ds_read_b64_tr_b16 a[224:225], v24 offset:0
    ds_read_b64_tr_b16 a[226:227], v24 offset:4096
    v_mfma_f32_16x16x32_bf16 v[124:127], a[168:171], a[104:107], v[124:127]
    buffer_load_dwordx4 v47, s[20:23], s49 offen offset:1024 lds
    v_mfma_f32_16x16x32_bf16 v[124:127], a[172:175], a[108:111], v[124:127]
    ds_read_b64_tr_b16 a[228:229], v24 offset:8192
    ds_read_b64_tr_b16 a[230:231], v24 offset:12288
    v_mfma_f32_16x16x32_bf16 v[124:127], a[176:179], a[112:115], v[124:127]
    ds_read_b64_tr_b16 a[232:233], v24 offset:16384
    v_cvt_pk_bf16_f32 v234, v120, v121
    v_mfma_f32_16x16x32_bf16 v[124:127], a[180:183], a[116:119], v[124:127]
    s_add_u32 s38, s93, 640
    ds_read_b64_tr_b16 a[234:235], v24 offset:20480
    v_cvt_pk_bf16_f32 v235, v122, v123
    v_mfma_f32_16x16x32_bf16 v[124:127], a[184:187], a[120:123], v[124:127]
    buffer_store_dwordx4 v[232:235], v56, s[28:31], s38 offen sc1
    v_mfma_f32_16x16x32_bf16 v[124:127], a[188:191], a[124:127], v[124:127]
    s_waitcnt lgkmcnt(12)
    ds_read_b64_tr_b16 a[236:237], v24 offset:24576
    ds_read_b64_tr_b16 a[238:239], v24 offset:28672
    v_mfma_f32_16x16x32_bf16 v[64:67], a[208:211], v[128:131], 0
    s_waitcnt lgkmcnt(12)
    buffer_load_dwordx4 v48, s[20:23], s49 offen offset:2048 lds
    v_mfma_f32_16x16x32_bf16 v[64:67], a[212:215], v[144:147], v[64:67]
    s_waitcnt lgkmcnt(10)
    ds_read_b64_tr_b16 a[160:161], v21 offset:0
    ds_read_b64_tr_b16 a[162:163], v21 offset:4096
    v_mfma_f32_16x16x32_bf16 v[64:67], a[216:219], v[192:195], v[64:67]
    s_waitcnt lgkmcnt(10)
    buffer_load_dwordx4 v49, s[20:23], s49 offen offset:3072 lds
    v_mfma_f32_16x16x32_bf16 v[64:67], a[220:223], v[176:179], v[64:67]
    s_waitcnt lgkmcnt(8)
    ds_read_b64_tr_b16 a[164:165], v21 offset:8192
    ds_read_b64_tr_b16 a[166:167], v21 offset:12288
    v_mfma_f32_16x16x32_bf16 v[64:67], a[224:227], v[136:139], v[64:67]
    s_waitcnt lgkmcnt(8)
    ds_read_b64_tr_b16 a[168:169], v21 offset:16384
    v_cvt_pk_bf16_f32 v238, v124, v125
    v_mfma_f32_16x16x32_bf16 v[64:67], a[228:231], v[152:155], v[64:67]
    s_waitcnt lgkmcnt(7)
    s_add_u32 s38, s93, 164480
    ds_read_b64_tr_b16 a[170:171], v21 offset:20480
    v_cvt_pk_bf16_f32 v239, v126, v127
    v_mfma_f32_16x16x32_bf16 v[64:67], a[232:235], v[200:203], v[64:67]
    s_waitcnt lgkmcnt(6)
    s_add_u32 s49, s7, 74496
    buffer_store_dwordx4 v[236:239], v56, s[28:31], s38 offen sc1
    v_mfma_f32_16x16x32_bf16 v[64:67], a[236:239], v[184:187], v[64:67]
    s_add_u32 m0, s42, 114688
    ds_read_b64_tr_b16 a[172:173], v21 offset:24576
    ds_read_b64_tr_b16 a[174:175], v21 offset:28672
    v_mfma_f32_16x16x32_bf16 v[68:71], a[208:211], v[132:135], 0
    buffer_load_dwordx4 v46, s[20:23], s49 offen lds
    v_mfma_f32_16x16x32_bf16 v[68:71], a[212:215], v[148:151], v[68:71]
    ds_read_b64_tr_b16 a[176:177], v25 offset:0
    ds_read_b64_tr_b16 a[178:179], v25 offset:4096
    v_mfma_f32_16x16x32_bf16 v[68:71], a[216:219], v[196:199], v[68:71]
    buffer_load_dwordx4 v47, s[20:23], s49 offen offset:1024 lds
    v_mfma_f32_16x16x32_bf16 v[68:71], a[220:223], v[180:183], v[68:71]
    ds_read_b64_tr_b16 a[180:181], v25 offset:8192
    ds_read_b64_tr_b16 a[182:183], v25 offset:12288
    v_mfma_f32_16x16x32_bf16 v[68:71], a[224:227], v[140:143], v[68:71]
    ds_read_b64_tr_b16 a[184:185], v25 offset:16384
    v_mfma_f32_16x16x32_bf16 v[68:71], a[228:231], v[156:159], v[68:71]
    ds_read_b64_tr_b16 a[186:187], v25 offset:20480
    v_mfma_f32_16x16x32_bf16 v[68:71], a[232:235], v[204:207], v[68:71]
    ds_read_b64_tr_b16 a[188:189], v25 offset:24576
    v_mfma_f32_16x16x32_bf16 v[68:71], a[236:239], v[188:191], v[68:71]
    s_waitcnt lgkmcnt(13)
    ds_read_b64_tr_b16 a[190:191], v25 offset:28672
    v_mfma_f32_16x16x32_bf16 v[72:75], a[160:163], v[128:131], 0
    s_waitcnt lgkmcnt(12)
    buffer_load_dwordx4 v48, s[20:23], s49 offen offset:2048 lds
    v_mfma_f32_16x16x32_bf16 v[72:75], a[164:167], v[144:147], v[72:75]
    s_waitcnt lgkmcnt(10)
    ds_read_b64_tr_b16 a[208:209], v22 offset:0
    ds_read_b64_tr_b16 a[210:211], v22 offset:4096
    v_mfma_f32_16x16x32_bf16 v[72:75], a[168:171], v[192:195], v[72:75]
    s_waitcnt lgkmcnt(10)
    buffer_load_dwordx4 v49, s[20:23], s49 offen offset:3072 lds
    v_mfma_f32_16x16x32_bf16 v[72:75], a[172:175], v[176:179], v[72:75]
    s_waitcnt lgkmcnt(8)
    ds_read_b64_tr_b16 a[212:213], v22 offset:8192
    ds_read_b64_tr_b16 a[214:215], v22 offset:12288
    v_mfma_f32_16x16x32_bf16 v[72:75], a[176:179], v[136:139], v[72:75]
    s_waitcnt lgkmcnt(8)
    ds_read_b64_tr_b16 a[216:217], v22 offset:16384
    v_mfma_f32_16x16x32_bf16 v[72:75], a[180:183], v[152:155], v[72:75]
    s_waitcnt lgkmcnt(7)
    ds_read_b64_tr_b16 a[218:219], v22 offset:20480
    v_mfma_f32_16x16x32_bf16 v[72:75], a[184:187], v[200:203], v[72:75]
    s_waitcnt lgkmcnt(6)
    ds_read_b64_tr_b16 a[220:221], v22 offset:24576
    v_mfma_f32_16x16x32_bf16 v[72:75], a[188:191], v[184:187], v[72:75]
    ds_read_b64_tr_b16 a[222:223], v22 offset:28672
    v_mfma_f32_16x16x32_bf16 v[76:79], a[160:163], v[132:135], 0
    ds_read_b64_tr_b16 a[224:225], v26 offset:0
    v_mfma_f32_16x16x32_bf16 v[76:79], a[164:167], v[148:151], v[76:79]
    ds_read_b64_tr_b16 a[226:227], v26 offset:4096
    v_mfma_f32_16x16x32_bf16 v[76:79], a[168:171], v[196:199], v[76:79]
    ds_read_b64_tr_b16 a[228:229], v26 offset:8192
    v_mfma_f32_16x16x32_bf16 v[76:79], a[172:175], v[180:183], v[76:79]
    ds_read_b64_tr_b16 a[230:231], v26 offset:12288
    v_mfma_f32_16x16x32_bf16 v[76:79], a[176:179], v[140:143], v[76:79]
    ds_read_b64_tr_b16 a[232:233], v26 offset:16384
    v_mfma_f32_16x16x32_bf16 v[76:79], a[180:183], v[156:159], v[76:79]
    ds_read_b64_tr_b16 a[234:235], v26 offset:20480
    v_mfma_f32_16x16x32_bf16 v[76:79], a[184:187], v[204:207], v[76:79]
    buffer_load_dword v63, v63, s[88:91], 0 offen sc1
    v_mfma_f32_16x16x32_bf16 v[76:79], a[188:191], v[188:191], v[76:79]
    s_waitcnt lgkmcnt(12)
    ds_read_b64_tr_b16 a[236:237], v26 offset:24576
    ds_read_b64_tr_b16 a[238:239], v26 offset:28672
    v_mfma_f32_16x16x32_bf16 v[80:83], a[208:211], v[128:131], 0
    s_waitcnt lgkmcnt(12)
    ds_read_b64_tr_b16 a[160:161], v23 offset:0
    v_mfma_f32_16x16x32_bf16 v[80:83], a[212:215], v[144:147], v[80:83]
    s_waitcnt lgkmcnt(11)
    ds_read_b64_tr_b16 a[162:163], v23 offset:4096
    v_mfma_f32_16x16x32_bf16 v[80:83], a[216:219], v[192:195], v[80:83]
    s_waitcnt lgkmcnt(10)
    ds_read_b64_tr_b16 a[164:165], v23 offset:8192
    v_mfma_f32_16x16x32_bf16 v[80:83], a[220:223], v[176:179], v[80:83]
    s_waitcnt lgkmcnt(9)
    ds_read_b64_tr_b16 a[166:167], v23 offset:12288
    v_mfma_f32_16x16x32_bf16 v[80:83], a[224:227], v[136:139], v[80:83]
    s_waitcnt lgkmcnt(8)
    ds_read_b64_tr_b16 a[168:169], v23 offset:16384
    v_mfma_f32_16x16x32_bf16 v[80:83], a[228:231], v[152:155], v[80:83]
    s_waitcnt lgkmcnt(7)
    ds_read_b64_tr_b16 a[170:171], v23 offset:20480
    v_mfma_f32_16x16x32_bf16 v[80:83], a[232:235], v[200:203], v[80:83]
    s_waitcnt lgkmcnt(6)
    ds_read_b64_tr_b16 a[172:173], v23 offset:24576
    v_mfma_f32_16x16x32_bf16 v[80:83], a[236:239], v[184:187], v[80:83]
    ds_read_b64_tr_b16 a[174:175], v23 offset:28672
    v_mfma_f32_16x16x32_bf16 v[84:87], a[208:211], v[132:135], 0
    ds_read_b64_tr_b16 a[176:177], v27 offset:0
    v_mfma_f32_16x16x32_bf16 v[84:87], a[212:215], v[148:151], v[84:87]
    ds_read_b64_tr_b16 a[178:179], v27 offset:4096
    v_mfma_f32_16x16x32_bf16 v[84:87], a[216:219], v[196:199], v[84:87]
    ds_read_b64_tr_b16 a[180:181], v27 offset:8192
    v_mfma_f32_16x16x32_bf16 v[84:87], a[220:223], v[180:183], v[84:87]
    ds_read_b64_tr_b16 a[182:183], v27 offset:12288
    v_mfma_f32_16x16x32_bf16 v[84:87], a[224:227], v[140:143], v[84:87]
    ds_read_b64_tr_b16 a[184:185], v27 offset:16384
    v_mfma_f32_16x16x32_bf16 v[84:87], a[228:231], v[156:159], v[84:87]
    ds_read_b64_tr_b16 a[186:187], v27 offset:20480
    v_mfma_f32_16x16x32_bf16 v[84:87], a[232:235], v[204:207], v[84:87]
    ds_read_b64_tr_b16 a[188:189], v27 offset:24576
    v_mfma_f32_16x16x32_bf16 v[84:87], a[236:239], v[188:191], v[84:87]
    s_waitcnt lgkmcnt(13)
    ds_read_b64_tr_b16 a[190:191], v27 offset:28672
    s_waitcnt vmcnt(13)
    s_barrier
    v_mfma_f32_16x16x32_bf16 v[88:91], a[160:163], v[128:131], 0
    s_waitcnt lgkmcnt(12)
    ds_read_b64_tr_b16 a[208:209], v12 offset:32768
    v_mfma_f32_16x16x32_bf16 v[88:91], a[164:167], v[144:147], v[88:91]
    s_waitcnt lgkmcnt(11)
    ds_read_b64_tr_b16 a[210:211], v12 offset:36864
    v_mfma_f32_16x16x32_bf16 v[88:91], a[168:171], v[192:195], v[88:91]
    s_waitcnt lgkmcnt(10)
    ds_read_b64_tr_b16 a[212:213], v12 offset:40960
    v_mfma_f32_16x16x32_bf16 v[88:91], a[172:175], v[176:179], v[88:91]
    s_waitcnt lgkmcnt(9)
    ds_read_b64_tr_b16 a[214:215], v12 offset:45056
    v_mfma_f32_16x16x32_bf16 v[88:91], a[176:179], v[136:139], v[88:91]
    s_waitcnt lgkmcnt(8)
    ds_read_b64_tr_b16 a[216:217], v12 offset:49152
    v_mfma_f32_16x16x32_bf16 v[88:91], a[180:183], v[152:155], v[88:91]
    s_waitcnt lgkmcnt(7)
    ds_read_b64_tr_b16 a[218:219], v12 offset:53248
    v_mfma_f32_16x16x32_bf16 v[88:91], a[184:187], v[200:203], v[88:91]
    s_waitcnt lgkmcnt(6)
    s_add_u32 s49, s46, 768
    ds_read_b64_tr_b16 a[220:221], v12 offset:57344
    v_mfma_f32_16x16x32_bf16 v[88:91], a[188:191], v[184:187], v[88:91]
    s_add_u32 m0, s42, 0
    ds_read_b64_tr_b16 a[222:223], v12 offset:61440
    v_mfma_f32_16x16x32_bf16 v[92:95], a[160:163], v[132:135], 0
    buffer_load_dwordx4 v46, s[20:23], s49 offen lds
    v_mfma_f32_16x16x32_bf16 v[92:95], a[164:167], v[148:151], v[92:95]
    ds_read_b64_tr_b16 a[224:225], v16 offset:32768
    ds_read_b64_tr_b16 a[226:227], v16 offset:36864
    v_mfma_f32_16x16x32_bf16 v[92:95], a[168:171], v[196:199], v[92:95]
    buffer_load_dwordx4 v47, s[20:23], s49 offen offset:1024 lds
    v_mfma_f32_16x16x32_bf16 v[92:95], a[172:175], v[180:183], v[92:95]
    ds_read_b64_tr_b16 a[228:229], v16 offset:40960
    ds_read_b64_tr_b16 a[230:231], v16 offset:45056
    v_mfma_f32_16x16x32_bf16 v[92:95], a[176:179], v[140:143], v[92:95]
    ds_read_b64_tr_b16 a[232:233], v16 offset:49152
    v_mfma_f32_16x16x32_bf16 v[92:95], a[180:183], v[156:159], v[92:95]
    ds_read_b64_tr_b16 a[234:235], v16 offset:53248
    v_mfma_f32_16x16x32_bf16 v[92:95], a[184:187], v[204:207], v[92:95]
    ds_read_b64_tr_b16 a[236:237], v16 offset:57344
    v_mfma_f32_16x16x32_bf16 v[92:95], a[188:191], v[188:191], v[92:95]
    s_waitcnt lgkmcnt(13)
    ds_read_b64_tr_b16 a[238:239], v16 offset:61440
    v_mfma_f32_16x16x32_bf16 v[64:67], a[208:211], a[64:67], v[64:67]
    s_waitcnt lgkmcnt(12)
    buffer_load_dwordx4 v48, s[20:23], s49 offen offset:2048 lds
    v_mfma_f32_16x16x32_bf16 v[64:67], a[212:215], a[68:71], v[64:67]
    s_waitcnt lgkmcnt(10)
    ds_read_b64_tr_b16 a[160:161], v13 offset:32768
    ds_read_b64_tr_b16 a[162:163], v13 offset:36864
    v_mfma_f32_16x16x32_bf16 v[64:67], a[216:219], a[72:75], v[64:67]
    s_waitcnt lgkmcnt(10)
    s_add_u32 s92, s92, 16
    buffer_load_dwordx4 v49, s[20:23], s49 offen offset:3072 lds
    v_mfma_f32_16x16x32_bf16 v[64:67], a[220:223], a[76:79], v[64:67]
    s_waitcnt lgkmcnt(8)
    s_waitcnt vmcnt(9)
    ds_read_b64_tr_b16 a[164:165], v13 offset:40960
    ds_read_b64_tr_b16 a[166:167], v13 offset:45056
    v_mfma_f32_16x16x32_bf16 v[64:67], a[224:227], a[80:83], v[64:67]
    s_waitcnt lgkmcnt(8)
    buffer_store_dword v10, v8, s[24:27], s92 offen sc1
    v_mfma_f32_16x16x32_bf16 v[64:67], a[228:231], a[84:87], v[64:67]
    s_waitcnt lgkmcnt(6)
    ds_read_b64_tr_b16 a[168:169], v13 offset:49152
    ds_read_b64_tr_b16 a[170:171], v13 offset:53248
    v_mfma_f32_16x16x32_bf16 v[64:67], a[232:235], a[88:91], v[64:67]
    s_waitcnt lgkmcnt(6)
    s_add_u32 s49, s46, 74496
    ds_read_b64_tr_b16 a[172:173], v13 offset:57344
    v_mfma_f32_16x16x32_bf16 v[64:67], a[236:239], a[92:95], v[64:67]
    s_add_u32 m0, s42, 16384
    ds_read_b64_tr_b16 a[174:175], v13 offset:61440
    v_mfma_f32_16x16x32_bf16 v[68:71], a[208:211], a[96:99], v[68:71]
    buffer_load_dwordx4 v46, s[20:23], s49 offen lds
    v_mfma_f32_16x16x32_bf16 v[68:71], a[212:215], a[100:103], v[68:71]
    ds_read_b64_tr_b16 a[176:177], v17 offset:32768
    ds_read_b64_tr_b16 a[178:179], v17 offset:36864
    v_mfma_f32_16x16x32_bf16 v[68:71], a[216:219], a[104:107], v[68:71]
    buffer_load_dwordx4 v47, s[20:23], s49 offen offset:1024 lds
    v_mfma_f32_16x16x32_bf16 v[68:71], a[220:223], a[108:111], v[68:71]
    ds_read_b64_tr_b16 a[180:181], v17 offset:40960
    ds_read_b64_tr_b16 a[182:183], v17 offset:45056
    v_mfma_f32_16x16x32_bf16 v[68:71], a[224:227], a[112:115], v[68:71]
    ds_read_b64_tr_b16 a[184:185], v17 offset:49152
    v_cvt_pk_bf16_f32 v224, v64, v65
    v_mfma_f32_16x16x32_bf16 v[68:71], a[228:231], a[116:119], v[68:71]
    ds_read_b64_tr_b16 a[186:187], v17 offset:53248
    v_cvt_pk_bf16_f32 v225, v66, v67
    v_mfma_f32_16x16x32_bf16 v[68:71], a[232:235], a[120:123], v[68:71]
    ds_read_b64_tr_b16 a[188:189], v17 offset:57344
    v_mfma_f32_16x16x32_bf16 v[68:71], a[236:239], a[124:127], v[68:71]
    s_waitcnt lgkmcnt(13)
    ds_read_b64_tr_b16 a[190:191], v17 offset:61440
    v_mfma_f32_16x16x32_bf16 v[72:75], a[160:163], a[64:67], v[72:75]
    s_waitcnt lgkmcnt(12)
    buffer_load_dwordx4 v48, s[20:23], s49 offen offset:2048 lds
    v_mfma_f32_16x16x32_bf16 v[72:75], a[164:167], a[68:71], v[72:75]
    s_waitcnt lgkmcnt(10)
    ds_read_b64_tr_b16 a[208:209], v14 offset:32768
    ds_read_b64_tr_b16 a[210:211], v14 offset:36864
    v_mfma_f32_16x16x32_bf16 v[72:75], a[168:171], a[72:75], v[72:75]
    s_waitcnt lgkmcnt(10)
    buffer_load_dwordx4 v49, s[20:23], s49 offen offset:3072 lds
    v_mfma_f32_16x16x32_bf16 v[72:75], a[172:175], a[76:79], v[72:75]
    s_waitcnt lgkmcnt(8)
    ds_read_b64_tr_b16 a[212:213], v14 offset:40960
    ds_read_b64_tr_b16 a[214:215], v14 offset:45056
    v_mfma_f32_16x16x32_bf16 v[72:75], a[176:179], a[80:83], v[72:75]
    s_waitcnt lgkmcnt(8)
    ds_read_b64_tr_b16 a[216:217], v14 offset:49152
    v_cvt_pk_bf16_f32 v228, v68, v69
    v_mfma_f32_16x16x32_bf16 v[72:75], a[180:183], a[84:87], v[72:75]
    s_waitcnt lgkmcnt(7)
    ds_read_b64_tr_b16 a[218:219], v14 offset:53248
    v_cvt_pk_bf16_f32 v229, v70, v71
    v_mfma_f32_16x16x32_bf16 v[72:75], a[184:187], a[88:91], v[72:75]
    s_waitcnt lgkmcnt(6)
    s_and_b32 s42, s2, 7
    ds_read_b64_tr_b16 a[220:221], v14 offset:57344
    v_mfma_f32_16x16x32_bf16 v[72:75], a[188:191], a[92:95], v[72:75]
    s_mov_b64 s[20:21], s[52:53]
    ds_read_b64_tr_b16 a[222:223], v14 offset:61440
    v_mfma_f32_16x16x32_bf16 v[76:79], a[160:163], a[96:99], v[76:79]
    ds_read_b64_tr_b16 a[224:225], v18 offset:32768
    s_waitcnt vmcnt(9)
    v_readfirstlane_b32 s37, v63
    v_mfma_f32_16x16x32_bf16 v[76:79], a[164:167], a[100:103], v[76:79]
    s_mov_b32 s22, 1152
    ds_read_b64_tr_b16 a[226:227], v18 offset:36864
    v_mfma_f32_16x16x32_bf16 v[76:79], a[168:171], a[104:107], v[76:79]
    s_mov_b32 s23, 0x20000
    ds_read_b64_tr_b16 a[228:229], v18 offset:40960
    s_cmp_lt_u32 s37, 256
    s_cbranch_scc1 Lattn_armwait
Lattn_armed:
    v_mfma_f32_16x16x32_bf16 v[76:79], a[172:175], a[108:111], v[76:79]
    ds_read_b64_tr_b16 a[230:231], v18 offset:45056
    v_mfma_f32_16x16x32_bf16 v[76:79], a[176:179], a[112:115], v[76:79]
    ds_read_b64_tr_b16 a[232:233], v18 offset:49152
    v_cvt_pk_bf16_f32 v226, v72, v73
    v_mfma_f32_16x16x32_bf16 v[76:79], a[180:183], a[116:119], v[76:79]
    s_add_u32 s38, s93, 1024
    ds_read_b64_tr_b16 a[234:235], v18 offset:53248
    v_cvt_pk_bf16_f32 v227, v74, v75
    v_mfma_f32_16x16x32_bf16 v[76:79], a[184:187], a[120:123], v[76:79]
    buffer_store_dwordx4 v[224:227], v56, s[28:31], s38 offen sc1
    v_mfma_f32_16x16x32_bf16 v[76:79], a[188:191], a[124:127], v[76:79]
    s_waitcnt lgkmcnt(12)
    s_mov_b32 s45, 18688
    ds_read_b64_tr_b16 a[236:237], v18 offset:57344
    ds_read_b64_tr_b16 a[238:239], v18 offset:61440
    v_mfma_f32_16x16x32_bf16 v[80:83], a[208:211], a[64:67], v[80:83]
    s_waitcnt lgkmcnt(12)
    buffer_load_dwordx4 v[160:163], v5, s[24:27], s45 offen offset:0 sc1
    v_mfma_f32_16x16x32_bf16 v[80:83], a[212:215], a[68:71], v[80:83]
    s_waitcnt lgkmcnt(10)
    ds_read_b64_tr_b16 a[160:161], v15 offset:32768
    ds_read_b64_tr_b16 a[162:163], v15 offset:36864
    v_mfma_f32_16x16x32_bf16 v[80:83], a[216:219], a[72:75], v[80:83]
    s_waitcnt lgkmcnt(10)
    ds_read_b64_tr_b16 a[164:165], v15 offset:40960
    v_mfma_f32_16x16x32_bf16 v[80:83], a[220:223], a[76:79], v[80:83]
    s_waitcnt lgkmcnt(9)
    ds_read_b64_tr_b16 a[166:167], v15 offset:45056
    v_mfma_f32_16x16x32_bf16 v[80:83], a[224:227], a[80:83], v[80:83]
    s_waitcnt lgkmcnt(8)
    ds_read_b64_tr_b16 a[168:169], v15 offset:49152
    v_cvt_pk_bf16_f32 v230, v76, v77
    v_mfma_f32_16x16x32_bf16 v[80:83], a[228:231], a[84:87], v[80:83]
    s_waitcnt lgkmcnt(7)
    s_add_u32 s38, s93, 164864
    ds_read_b64_tr_b16 a[170:171], v15 offset:53248
    v_cvt_pk_bf16_f32 v231, v78, v79
    v_mfma_f32_16x16x32_bf16 v[80:83], a[232:235], a[88:91], v[80:83]
    s_waitcnt lgkmcnt(6)
    buffer_store_dwordx4 v[228:231], v56, s[28:31], s38 offen sc1
    v_mfma_f32_16x16x32_bf16 v[80:83], a[236:239], a[92:95], v[80:83]
    ds_read_b64_tr_b16 a[172:173], v15 offset:57344
    ds_read_b64_tr_b16 a[174:175], v15 offset:61440
    v_mfma_f32_16x16x32_bf16 v[84:87], a[208:211], a[96:99], v[84:87]
    buffer_load_dwordx4 v[164:167], v5, s[24:27], s45 offen offset:512 sc1
    v_mfma_f32_16x16x32_bf16 v[84:87], a[212:215], a[100:103], v[84:87]
    ds_read_b64_tr_b16 a[176:177], v19 offset:32768
    ds_read_b64_tr_b16 a[178:179], v19 offset:36864
    v_mfma_f32_16x16x32_bf16 v[84:87], a[216:219], a[104:107], v[84:87]
    ds_read_b64_tr_b16 a[180:181], v19 offset:40960
    v_mfma_f32_16x16x32_bf16 v[84:87], a[220:223], a[108:111], v[84:87]
    ds_read_b64_tr_b16 a[182:183], v19 offset:45056
    v_mfma_f32_16x16x32_bf16 v[84:87], a[224:227], a[112:115], v[84:87]
    ds_read_b64_tr_b16 a[184:185], v19 offset:49152
    v_cvt_pk_bf16_f32 v232, v80, v81
    v_mfma_f32_16x16x32_bf16 v[84:87], a[228:231], a[116:119], v[84:87]
    ds_read_b64_tr_b16 a[186:187], v19 offset:53248
    v_cvt_pk_bf16_f32 v233, v82, v83
    v_mfma_f32_16x16x32_bf16 v[84:87], a[232:235], a[120:123], v[84:87]
    buffer_load_dwordx4 v[168:171], v59, s[24:27], s45 offen offset:1024 sc1
    v_mfma_f32_16x16x32_bf16 v[84:87], a[236:239], a[124:127], v[84:87]
    s_waitcnt lgkmcnt(12)
    ds_read_b64_tr_b16 a[188:189], v19 offset:57344
    ds_read_b64_tr_b16 a[190:191], v19 offset:61440
    s_barrier
    v_mfma_f32_16x16x32_bf16 v[88:91], a[160:163], a[64:67], v[88:91]
    s_waitcnt lgkmcnt(12)
    ds_read_b64_tr_b16 a[208:209], v20 offset:32768
    v_mfma_f32_16x16x32_bf16 v[88:91], a[164:167], a[68:71], v[88:91]
    s_waitcnt lgkmcnt(11)
    s_mov_b32 s45, 20992
    ds_read_b64_tr_b16 a[210:211], v20 offset:36864
    v_mfma_f32_16x16x32_bf16 v[88:91], a[168:171], a[72:75], v[88:91]
    s_waitcnt lgkmcnt(10)
    buffer_load_dwordx4 v[172:175], v5, s[24:27], s45 offen offset:0 sc1
    v_mfma_f32_16x16x32_bf16 v[88:91], a[172:175], a[76:79], v[88:91]
    s_waitcnt lgkmcnt(8)
    ds_read_b64_tr_b16 a[212:213], v20 offset:40960
    ds_read_b64_tr_b16 a[214:215], v20 offset:45056
    v_mfma_f32_16x16x32_bf16 v[88:91], a[176:179], a[80:83], v[88:91]
    s_waitcnt lgkmcnt(8)
    ds_read_b64_tr_b16 a[216:217], v20 offset:49152
    v_cvt_pk_bf16_f32 v236, v84, v85
    v_mfma_f32_16x16x32_bf16 v[88:91], a[180:183], a[84:87], v[88:91]
    s_waitcnt lgkmcnt(7)
    ds_read_b64_tr_b16 a[218:219], v20 offset:53248
    v_cvt_pk_bf16_f32 v237, v86, v87
    v_mfma_f32_16x16x32_bf16 v[88:91], a[184:187], a[88:91], v[88:91]
    s_waitcnt lgkmcnt(6)
    ds_read_b64_tr_b16 a[220:221], v20 offset:57344
    v_mfma_f32_16x16x32_bf16 v[88:91], a[188:191], a[92:95], v[88:91]
    ds_read_b64_tr_b16 a[222:223], v20 offset:61440
    v_mfma_f32_16x16x32_bf16 v[92:95], a[160:163], a[96:99], v[92:95]
    buffer_load_dwordx4 v[208:211], v5, s[24:27], s45 offen offset:512 sc1
    v_mfma_f32_16x16x32_bf16 v[92:95], a[164:167], a[100:103], v[92:95]
    ds_read_b64_tr_b16 a[224:225], v24 offset:32768
    ds_read_b64_tr_b16 a[226:227], v24 offset:36864
    v_mfma_f32_16x16x32_bf16 v[92:95], a[168:171], a[104:107], v[92:95]
    ds_read_b64_tr_b16 a[228:229], v24 offset:40960
    v_mfma_f32_16x16x32_bf16 v[92:95], a[172:175], a[108:111], v[92:95]
    ds_read_b64_tr_b16 a[230:231], v24 offset:45056
    v_mfma_f32_16x16x32_bf16 v[92:95], a[176:179], a[112:115], v[92:95]
    ds_read_b64_tr_b16 a[232:233], v24 offset:49152
    v_cvt_pk_bf16_f32 v234, v88, v89
    v_mfma_f32_16x16x32_bf16 v[92:95], a[180:183], a[116:119], v[92:95]
    s_add_u32 s38, s93, 1152
    ds_read_b64_tr_b16 a[234:235], v24 offset:53248
    v_cvt_pk_bf16_f32 v235, v90, v91
    v_mfma_f32_16x16x32_bf16 v[92:95], a[184:187], a[120:123], v[92:95]
    buffer_store_dwordx4 v[232:235], v56, s[28:31], s38 offen sc1
    v_mfma_f32_16x16x32_bf16 v[92:95], a[188:191], a[124:127], v[92:95]
    s_waitcnt lgkmcnt(12)
    ds_read_b64_tr_b16 a[236:237], v24 offset:57344
    ds_read_b64_tr_b16 a[238:239], v24 offset:61440
    v_mfma_f32_16x16x32_bf16 v[96:99], a[208:211], v[128:131], 0
    s_waitcnt lgkmcnt(12)
    buffer_load_dwordx4 v[212:215], v59, s[24:27], s45 offen offset:1024 sc1
    v_mfma_f32_16x16x32_bf16 v[96:99], a[212:215], v[144:147], v[96:99]
    s_waitcnt lgkmcnt(10)
    ds_read_b64_tr_b16 a[160:161], v21 offset:32768
    ds_read_b64_tr_b16 a[162:163], v21 offset:36864
    v_mfma_f32_16x16x32_bf16 v[96:99], a[216:219], v[192:195], v[96:99]
    s_waitcnt lgkmcnt(10)
    ds_read_b64_tr_b16 a[164:165], v21 offset:40960
    v_mfma_f32_16x16x32_bf16 v[96:99], a[220:223], v[176:179], v[96:99]
    s_waitcnt lgkmcnt(9)
    ds_read_b64_tr_b16 a[166:167], v21 offset:45056
    v_mfma_f32_16x16x32_bf16 v[96:99], a[224:227], v[136:139], v[96:99]
    s_waitcnt lgkmcnt(8)
    ds_read_b64_tr_b16 a[168:169], v21 offset:49152
    v_cvt_pk_bf16_f32 v238, v92, v93
    v_mfma_f32_16x16x32_bf16 v[96:99], a[228:231], v[152:155], v[96:99]
    s_waitcnt lgkmcnt(7)
    s_add_u32 s38, s93, 164992
    ds_read_b64_tr_b16 a[170:171], v21 offset:53248
    v_cvt_pk_bf16_f32 v239, v94, v95
    v_mfma_f32_16x16x32_bf16 v[96:99], a[232:235], v[200:203], v[96:99]
    s_waitcnt lgkmcnt(6)
    buffer_store_dwordx4 v[236:239], v56, s[28:31], s38 offen sc1
    v_mfma_f32_16x16x32_bf16 v[96:99], a[236:239], v[184:187], v[96:99]
    ds_read_b64_tr_b16 a[172:173], v21 offset:57344
    ds_read_b64_tr_b16 a[174:175], v21 offset:61440
    v_mfma_f32_16x16x32_bf16 v[100:103], a[208:211], v[132:135], 0
    buffer_load_dwordx2 v[92:93], v58, s[12:15], 0 offen offset:1024
    v_mfma_f32_16x16x32_bf16 v[100:103], a[212:215], v[148:151], v[100:103]
    ds_read_b64_tr_b16 a[176:177], v25 offset:32768
    ds_read_b64_tr_b16 a[178:179], v25 offset:36864
    v_mfma_f32_16x16x32_bf16 v[100:103], a[216:219], v[196:199], v[100:103]
    ds_read_b64_tr_b16 a[180:181], v25 offset:40960
    v_mfma_f32_16x16x32_bf16 v[100:103], a[220:223], v[180:183], v[100:103]
    ds_read_b64_tr_b16 a[182:183], v25 offset:45056
    v_mfma_f32_16x16x32_bf16 v[100:103], a[224:227], v[140:143], v[100:103]
    buffer_load_dwordx2 v[94:95], v58, s[12:15], 0 offen offset:1056
    v_mfma_f32_16x16x32_bf16 v[100:103], a[228:231], v[156:159], v[100:103]
    ds_read_b64_tr_b16 a[184:185], v25 offset:49152
    ds_read_b64_tr_b16 a[186:187], v25 offset:53248
    v_mfma_f32_16x16x32_bf16 v[100:103], a[232:235], v[204:207], v[100:103]
    ds_read_b64_tr_b16 a[188:189], v25 offset:57344
    v_mfma_f32_16x16x32_bf16 v[100:103], a[236:239], v[188:191], v[100:103]
    s_waitcnt lgkmcnt(13)
    ds_read_b64_tr_b16 a[190:191], v25 offset:61440
    v_mfma_f32_16x16x32_bf16 v[104:107], a[160:163], v[128:131], 0
    s_waitcnt lgkmcnt(12)
    ds_read_b64_tr_b16 a[208:209], v22 offset:32768
    v_mfma_f32_16x16x32_bf16 v[104:107], a[164:167], v[144:147], v[104:107]
    s_waitcnt lgkmcnt(11)
    s_mov_b32 s45, 19840
    ds_read_b64_tr_b16 a[210:211], v22 offset:36864
    v_mfma_f32_16x16x32_bf16 v[104:107], a[168:171], v[192:195], v[104:107]
    s_waitcnt lgkmcnt(10)
    buffer_load_dwordx4 v[64:67], v5, s[24:27], s45 offen offset:0 sc1
    v_mfma_f32_16x16x32_bf16 v[104:107], a[172:175], v[176:179], v[104:107]
    s_waitcnt lgkmcnt(8)
    ds_read_b64_tr_b16 a[212:213], v22 offset:40960
    ds_read_b64_tr_b16 a[214:215], v22 offset:45056
    v_mfma_f32_16x16x32_bf16 v[104:107], a[176:179], v[136:139], v[104:107]
    s_waitcnt lgkmcnt(8)
    ds_read_b64_tr_b16 a[216:217], v22 offset:49152
    v_mfma_f32_16x16x32_bf16 v[104:107], a[180:183], v[152:155], v[104:107]
Ltour11:
    s_cbranch_execz Ltour15
    s_waitcnt lgkmcnt(7)
    ds_read_b64_tr_b16 a[218:219], v22 offset:53248
    v_mfma_f32_16x16x32_bf16 v[104:107], a[184:187], v[200:203], v[104:107]
    s_waitcnt lgkmcnt(6)
    buffer_load_dwordx4 v[68:71], v5, s[24:27], s45 offen offset:512 sc1
    v_mfma_f32_16x16x32_bf16 v[104:107], a[188:191], v[184:187], v[104:107]
    ds_read_b64_tr_b16 a[220:221], v22 offset:57344
    ds_read_b64_tr_b16 a[222:223], v22 offset:61440
    v_mfma_f32_16x16x32_bf16 v[108:111], a[160:163], v[132:135], 0
    ds_read_b64_tr_b16 a[224:225], v26 offset:32768
    v_mfma_f32_16x16x32_bf16 v[108:111], a[164:167], v[148:151], v[108:111]
    ds_read_b64_tr_b16 a[226:227], v26 offset:36864
    v_mfma_f32_16x16x32_bf16 v[108:111], a[168:171], v[196:199], v[108:111]
    ds_read_b64_tr_b16 a[228:229], v26 offset:40960
    v_mfma_f32_16x16x32_bf16 v[108:111], a[172:175], v[180:183], v[108:111]
    ds_read_b64_tr_b16 a[230:231], v26 offset:45056
    v_mfma_f32_16x16x32_bf16 v[108:111], a[176:179], v[140:143], v[108:111]
    buffer_load_dwordx4 v[72:75], v59, s[24:27], s45 offen offset:1024 sc1
    v_mfma_f32_16x16x32_bf16 v[108:111], a[180:183], v[156:159], v[108:111]
    ds_read_b64_tr_b16 a[232:233], v26 offset:49152
    ds_read_b64_tr_b16 a[234:235], v26 offset:53248
    v_mfma_f32_16x16x32_bf16 v[108:111], a[184:187], v[204:207], v[108:111]
    ds_read_b64_tr_b16 a[236:237], v26 offset:57344
    v_mfma_f32_16x16x32_bf16 v[108:111], a[188:191], v[188:191], v[108:111]
    s_waitcnt lgkmcnt(13)
    ds_read_b64_tr_b16 a[238:239], v26 offset:61440
    v_mfma_f32_16x16x32_bf16 v[112:115], a[208:211], v[128:131], 0
    s_waitcnt lgkmcnt(12)
    ds_read_b64_tr_b16 a[160:161], v23 offset:32768
    v_mfma_f32_16x16x32_bf16 v[112:115], a[212:215], v[144:147], v[112:115]
    s_waitcnt lgkmcnt(11)
    ds_read_b64_tr_b16 a[162:163], v23 offset:36864
    v_mfma_f32_16x16x32_bf16 v[112:115], a[216:219], v[192:195], v[112:115]
    s_waitcnt lgkmcnt(10)
    buffer_load_dwordx2 v[76:77], v3, s[20:23], 0 offen offset:0
    v_mfma_f32_16x16x32_bf16 v[112:115], a[220:223], v[176:179], v[112:115]
    s_waitcnt lgkmcnt(8)
    ds_read_b64_tr_b16 a[164:165], v23 offset:40960
    ds_read_b64_tr_b16 a[166:167], v23 offset:45056
    v_mfma_f32_16x16x32_bf16 v[112:115], a[224:227], v[136:139], v[112:115]
    s_waitcnt lgkmcnt(8)
    ds_read_b64_tr_b16 a[168:169], v23 offset:49152
    v_mfma_f32_16x16x32_bf16 v[112:115], a[228:231], v[152:155], v[112:115]
    s_waitcnt lgkmcnt(7)
    ds_read_b64_tr_b16 a[170:171], v23 offset:53248
    v_mfma_f32_16x16x32_bf16 v[112:115], a[232:235], v[200:203], v[112:115]
    s_waitcnt lgkmcnt(6)
    buffer_load_dwordx2 v[78:79], v3, s[20:23], 0 offen offset:32
    v_mfma_f32_16x16x32_bf16 v[112:115], a[236:239], v[184:187], v[112:115]
    ds_read_b64_tr_b16 a[172:173], v23 offset:57344
    ds_read_b64_tr_b16 a[174:175], v23 offset:61440
    v_mfma_f32_16x16x32_bf16 v[116:119], a[208:211], v[132:135], 0
    ds_read_b64_tr_b16 a[176:177], v27 offset:32768
    v_mfma_f32_16x16x32_bf16 v[116:119], a[212:215], v[148:151], v[116:119]
    ds_read_b64_tr_b16 a[178:179], v27 offset:36864
    v_mfma_f32_16x16x32_bf16 v[116:119], a[216:219], v[196:199], v[116:119]
    ds_read_b64_tr_b16 a[180:181], v27 offset:40960
    v_mfma_f32_16x16x32_bf16 v[116:119], a[220:223], v[180:183], v[116:119]
    ds_read_b64_tr_b16 a[182:183], v27 offset:45056
    v_mfma_f32_16x16x32_bf16 v[116:119], a[224:227], v[140:143], v[116:119]
    buffer_load_dwordx2 v[80:81], v3, s[20:23], 0 offen offset:512
    v_mfma_f32_16x16x32_bf16 v[116:119], a[228:231], v[156:159], v[116:119]
    ds_read_b64_tr_b16 a[184:185], v27 offset:49152
    ds_read_b64_tr_b16 a[186:187], v27 offset:53248
    v_mfma_f32_16x16x32_bf16 v[116:119], a[232:235], v[204:207], v[116:119]
    ds_read_b64_tr_b16 a[188:189], v27 offset:57344
    v_mfma_f32_16x16x32_bf16 v[116:119], a[236:239], v[188:191], v[116:119]
    ds_read_b64_tr_b16 a[190:191], v27 offset:61440
    s_waitcnt vmcnt(18)
    s_waitcnt lgkmcnt(0)
    s_barrier
    v_mfma_f32_16x16x32_bf16 v[120:123], a[160:163], v[128:131], 0
    ds_read_b64_tr_b16 a[208:209], v12 offset:0
    v_mfma_f32_16x16x32_bf16 v[120:123], a[164:167], v[144:147], v[120:123]
    ds_read_b64_tr_b16 a[210:211], v12 offset:4096
    v_mfma_f32_16x16x32_bf16 v[120:123], a[168:171], v[192:195], v[120:123]
    buffer_load_dwordx2 v[82:83], v3, s[20:23], 0 offen offset:544
    v_mfma_f32_16x16x32_bf16 v[120:123], a[172:175], v[176:179], v[120:123]
    s_add_u32 s39, s39, 16
    ds_read_b64_tr_b16 a[212:213], v12 offset:8192
    ds_read_b64_tr_b16 a[214:215], v12 offset:12288
    v_mfma_f32_16x16x32_bf16 v[120:123], a[176:179], v[136:139], v[120:123]
    buffer_load_dword v11, v9, s[24:27], s39 offen sc1
    v_mfma_f32_16x16x32_bf16 v[120:123], a[180:183], v[152:155], v[120:123]
    ds_read_b64_tr_b16 a[216:217], v12 offset:16384
    ds_read_b64_tr_b16 a[218:219], v12 offset:20480
    v_mfma_f32_16x16x32_bf16 v[120:123], a[184:187], v[200:203], v[120:123]
    ds_read_b64_tr_b16 a[220:221], v12 offset:24576
    v_mfma_f32_16x16x32_bf16 v[120:123], a[188:191], v[184:187], v[120:123]
    ds_read_b64_tr_b16 a[222:223], v12 offset:28672
    v_mfma_f32_16x16x32_bf16 v[124:127], a[160:163], v[132:135], 0
    buffer_load_dwordx2 v[84:85], v55, s[20:23], 0 offen offset:1024
    v_mfma_f32_16x16x32_bf16 v[124:127], a[164:167], v[148:151], v[124:127]
    ds_read_b64_tr_b16 a[224:225], v16 offset:0
    ds_read_b64_tr_b16 a[226:227], v16 offset:4096
    v_mfma_f32_16x16x32_bf16 v[124:127], a[168:171], v[196:199], v[124:127]
    ds_read_b64_tr_b16 a[228:229], v16 offset:8192
    v_mfma_f32_16x16x32_bf16 v[124:127], a[172:175], v[180:183], v[124:127]
    ds_read_b64_tr_b16 a[230:231], v16 offset:12288
    v_mfma_f32_16x16x32_bf16 v[124:127], a[176:179], v[140:143], v[124:127]
    ds_read_b64_tr_b16 a[232:233], v16 offset:16384
    v_mfma_f32_16x16x32_bf16 v[124:127], a[180:183], v[156:159], v[124:127]
    ds_read_b64_tr_b16 a[234:235], v16 offset:20480
    v_mfma_f32_16x16x32_bf16 v[124:127], a[184:187], v[204:207], v[124:127]
    buffer_load_dwordx2 v[86:87], v55, s[20:23], 0 offen offset:1056
    v_mfma_f32_16x16x32_bf16 v[124:127], a[188:191], v[188:191], v[124:127]
    s_waitcnt lgkmcnt(12)
    ds_read_b64_tr_b16 a[236:237], v16 offset:24576
    ds_read_b64_tr_b16 a[238:239], v16 offset:28672
    v_mfma_f32_16x16x32_bf16 v[96:99], a[208:211], a[64:67], v[96:99]
    s_waitcnt lgkmcnt(12)
    ds_read_b64_tr_b16 a[160:161], v13 offset:0
    v_mfma_f32_16x16x32_bf16 v[96:99], a[212:215], a[68:71], v[96:99]
    s_waitcnt lgkmcnt(11)
    ds_read_b64_tr_b16 a[162:163], v13 offset:4096
    v_mfma_f32_16x16x32_bf16 v[96:99], a[216:219], a[72:75], v[96:99]
    s_waitcnt lgkmcnt(10)
    ds_read_b64_tr_b16 a[164:165], v13 offset:8192
    v_mfma_f32_16x16x32_bf16 v[96:99], a[220:223], a[76:79], v[96:99]
    s_waitcnt lgkmcnt(9)
    s_mov_b32 s45, 22144
    ds_read_b64_tr_b16 a[166:167], v13 offset:12288
    v_mfma_f32_16x16x32_bf16 v[96:99], a[224:227], a[80:83], v[96:99]
    s_waitcnt lgkmcnt(8)
    buffer_load_dwordx4 v[216:219], v5, s[24:27], s45 offen offset:0 sc1
    v_mfma_f32_16x16x32_bf16 v[96:99], a[228:231], a[84:87], v[96:99]
    s_waitcnt lgkmcnt(6)
    ds_read_b64_tr_b16 a[168:169], v13 offset:16384
    ds_read_b64_tr_b16 a[170:171], v13 offset:20480
    v_mfma_f32_16x16x32_bf16 v[96:99], a[232:235], a[88:91], v[96:99]
    s_waitcnt lgkmcnt(6)
    ds_read_b64_tr_b16 a[172:173], v13 offset:24576
    v_mfma_f32_16x16x32_bf16 v[96:99], a[236:239], a[92:95], v[96:99]
    ds_read_b64_tr_b16 a[174:175], v13 offset:28672
    v_mfma_f32_16x16x32_bf16 v[100:103], a[208:211], a[96:99], v[100:103]
    buffer_load_dwordx4 v[220:223], v5, s[24:27], s45 offen offset:512 sc1
    v_mfma_f32_16x16x32_bf16 v[100:103], a[212:215], a[100:103], v[100:103]
    ds_read_b64_tr_b16 a[176:177], v17 offset:0
    ds_read_b64_tr_b16 a[178:179], v17 offset:4096
    v_mfma_f32_16x16x32_bf16 v[100:103], a[216:219], a[104:107], v[100:103]
    ds_read_b64_tr_b16 a[180:181], v17 offset:8192
    v_mfma_f32_16x16x32_bf16 v[100:103], a[220:223], a[108:111], v[100:103]
    ds_read_b64_tr_b16 a[182:183], v17 offset:12288
    v_mfma_f32_16x16x32_bf16 v[100:103], a[224:227], a[112:115], v[100:103]
    ds_read_b64_tr_b16 a[184:185], v17 offset:16384
    v_cvt_pk_bf16_f32 v224, v96, v97
    v_mfma_f32_16x16x32_bf16 v[100:103], a[228:231], a[116:119], v[100:103]
    ds_read_b64_tr_b16 a[186:187], v17 offset:20480
    v_cvt_pk_bf16_f32 v225, v98, v99
    v_mfma_f32_16x16x32_bf16 v[100:103], a[232:235], a[120:123], v[100:103]
    ds_read_b64_tr_b16 a[188:189], v17 offset:24576
    v_mfma_f32_16x16x32_bf16 v[100:103], a[236:239], a[124:127], v[100:103]
    s_waitcnt lgkmcnt(13)
    ds_read_b64_tr_b16 a[190:191], v17 offset:28672
    v_mfma_f32_16x16x32_bf16 v[104:107], a[160:163], a[64:67], v[104:107]
    s_waitcnt lgkmcnt(12)
    buffer_load_dwordx4 v[88:91], v59, s[24:27], s45 offen offset:1024 sc1
    v_mfma_f32_16x16x32_bf16 v[104:107], a[164:167], a[68:71], v[104:107]
    s_waitcnt lgkmcnt(10)
    ds_read_b64_tr_b16 a[208:209], v14 offset:0
    ds_read_b64_tr_b16 a[210:211], v14 offset:4096
    v_mfma_f32_16x16x32_bf16 v[104:107], a[168:171], a[72:75], v[104:107]
    s_waitcnt lgkmcnt(10)
    ds_read_b64_tr_b16 a[212:213], v14 offset:8192
    v_mfma_f32_16x16x32_bf16 v[104:107], a[172:175], a[76:79], v[104:107]
    s_waitcnt lgkmcnt(9)
    ds_read_b64_tr_b16 a[214:215], v14 offset:12288
    v_mfma_f32_16x16x32_bf16 v[104:107], a[176:179], a[80:83], v[104:107]
    s_waitcnt lgkmcnt(8)
    ds_read_b64_tr_b16 a[216:217], v14 offset:16384
    v_cvt_pk_bf16_f32 v228, v100, v101
    v_mfma_f32_16x16x32_bf16 v[104:107], a[180:183], a[84:87], v[104:107]
    s_waitcnt lgkmcnt(7)
    ds_read_b64_tr_b16 a[218:219], v14 offset:20480
    v_cvt_pk_bf16_f32 v229, v102, v103
    v_mfma_f32_16x16x32_bf16 v[104:107], a[184:187], a[88:91], v[104:107]
    s_waitcnt lgkmcnt(6)
    ds_read_b64_tr_b16 a[220:221], v14 offset:24576
    v_mfma_f32_16x16x32_bf16 v[104:107], a[188:191], a[92:95], v[104:107]
    ds_read_b64_tr_b16 a[222:223], v14 offset:28672
    v_mfma_f32_16x16x32_bf16 v[108:111], a[160:163], a[96:99], v[108:111]
    ds_read_b64_tr_b16 a[224:225], v18 offset:0
    v_mfma_f32_16x16x32_bf16 v[108:111], a[164:167], a[100:103], v[108:111]
    ds_read_b64_tr_b16 a[226:227], v18 offset:4096
    v_mfma_f32_16x16x32_bf16 v[108:111], a[168:171], a[104:107], v[108:111]
    ds_read_b64_tr_b16 a[228:229], v18 offset:8192
    v_mfma_f32_16x16x32_bf16 v[108:111], a[172:175], a[108:111], v[108:111]
    ds_read_b64_tr_b16 a[230:231], v18 offset:12288
    v_mfma_f32_16x16x32_bf16 v[108:111], a[176:179], a[112:115], v[108:111]
    ds_read_b64_tr_b16 a[232:233], v18 offset:16384
    v_cvt_pk_bf16_f32 v226, v104, v105
    v_mfma_f32_16x16x32_bf16 v[108:111], a[180:183], a[116:119], v[108:111]
    s_add_u32 s38, s93, 1536
    ds_read_b64_tr_b16 a[234:235], v18 offset:20480
    v_cvt_pk_bf16_f32 v227, v106, v107
    v_mfma_f32_16x16x32_bf16 v[108:111], a[184:187], a[120:123], v[108:111]
    buffer_store_dwordx4 v[224:227], v56, s[28:31], s38 offen sc1
    v_mfma_f32_16x16x32_bf16 v[108:111], a[188:191], a[124:127], v[108:111]
    s_waitcnt lgkmcnt(12)
    ds_read_b64_tr_b16 a[236:237], v18 offset:24576
    ds_read_b64_tr_b16 a[238:239], v18 offset:28672
    v_mfma_f32_16x16x32_bf16 v[112:115], a[208:211], a[64:67], v[112:115]
    s_waitcnt lgkmcnt(12)
    ds_read_b64_tr_b16 a[160:161], v15 offset:0
    v_mfma_f32_16x16x32_bf16 v[112:115], a[212:215], a[68:71], v[112:115]
    s_waitcnt lgkmcnt(11)
    ds_read_b64_tr_b16 a[162:163], v15 offset:4096
    v_mfma_f32_16x16x32_bf16 v[112:115], a[216:219], a[72:75], v[112:115]
    s_waitcnt lgkmcnt(10)
    ds_read_b64_tr_b16 a[164:165], v15 offset:8192
    v_mfma_f32_16x16x32_bf16 v[112:115], a[220:223], a[76:79], v[112:115]
    s_waitcnt lgkmcnt(9)
    ds_read_b64_tr_b16 a[166:167], v15 offset:12288
    v_mfma_f32_16x16x32_bf16 v[112:115], a[224:227], a[80:83], v[112:115]
    s_waitcnt lgkmcnt(8)
    ds_read_b64_tr_b16 a[168:169], v15 offset:16384
    v_cvt_pk_bf16_f32 v230, v108, v109
    v_mfma_f32_16x16x32_bf16 v[112:115], a[228:231], a[84:87], v[112:115]
    s_waitcnt lgkmcnt(7)
    s_add_u32 s38, s93, 165376
    ds_read_b64_tr_b16 a[170:171], v15 offset:20480
    v_cvt_pk_bf16_f32 v231, v110, v111
    v_mfma_f32_16x16x32_bf16 v[112:115], a[232:235], a[88:91], v[112:115]
    s_waitcnt lgkmcnt(6)
    buffer_store_dwordx4 v[228:231], v56, s[28:31], s38 offen sc1
    v_mfma_f32_16x16x32_bf16 v[112:115], a[236:239], a[92:95], v[112:115]
    ds_read_b64_tr_b16 a[172:173], v15 offset:24576
    ds_read_b64_tr_b16 a[174:175], v15 offset:28672
    v_mfma_f32_16x16x32_bf16 v[116:119], a[208:211], a[96:99], v[116:119]
    ds_read_b64_tr_b16 a[176:177], v19 offset:0
    v_mfma_f32_16x16x32_bf16 v[116:119], a[212:215], a[100:103], v[116:119]
    ds_read_b64_tr_b16 a[178:179], v19 offset:4096
    v_mfma_f32_16x16x32_bf16 v[116:119], a[216:219], a[104:107], v[116:119]
    ds_read_b64_tr_b16 a[180:181], v19 offset:8192
    v_mfma_f32_16x16x32_bf16 v[116:119], a[220:223], a[108:111], v[116:119]
    ds_read_b64_tr_b16 a[182:183], v19 offset:12288
    v_mfma_f32_16x16x32_bf16 v[116:119], a[224:227], a[112:115], v[116:119]
    ds_read_b64_tr_b16 a[184:185], v19 offset:16384
    v_cvt_pk_bf16_f32 v232, v112, v113
    v_mfma_f32_16x16x32_bf16 v[116:119], a[228:231], a[116:119], v[116:119]
    ds_read_b64_tr_b16 a[186:187], v19 offset:20480
    v_cvt_pk_bf16_f32 v233, v114, v115
    v_mfma_f32_16x16x32_bf16 v[116:119], a[232:235], a[120:123], v[116:119]
    ds_read_b64_tr_b16 a[188:189], v19 offset:24576
    v_mfma_f32_16x16x32_bf16 v[116:119], a[236:239], a[124:127], v[116:119]
    s_waitcnt lgkmcnt(13)
    ds_read_b64_tr_b16 a[190:191], v19 offset:28672
    v_mfma_f32_16x16x32_bf16 v[120:123], a[160:163], a[64:67], v[120:123]
    s_waitcnt lgkmcnt(12)
    v_mfma_f32_16x16x32_bf16 v[120:123], a[164:167], a[68:71], v[120:123]
    s_waitcnt lgkmcnt(10)
    v_mfma_f32_16x16x32_bf16 v[120:123], a[168:171], a[72:75], v[120:123]
    s_waitcnt lgkmcnt(8)
    v_mfma_f32_16x16x32_bf16 v[120:123], a[172:175], a[76:79], v[120:123]
    s_waitcnt lgkmcnt(6)
    v_mfma_f32_16x16x32_bf16 v[120:123], a[176:179], a[80:83], v[120:123]
    s_waitcnt lgkmcnt(4)
    v_cvt_pk_bf16_f32 v236, v116, v117
    v_mfma_f32_16x16x32_bf16 v[120:123], a[180:183], a[84:87], v[120:123]
    s_waitcnt lgkmcnt(2)
    v_cvt_pk_bf16_f32 v237, v118, v119
    v_mfma_f32_16x16x32_bf16 v[120:123], a[184:187], a[88:91], v[120:123]
    s_waitcnt lgkmcnt(0)
    v_mfma_f32_16x16x32_bf16 v[120:123], a[188:191], a[92:95], v[120:123]
    v_mfma_f32_16x16x32_bf16 v[124:127], a[160:163], a[96:99], v[124:127]
    v_mfma_f32_16x16x32_bf16 v[124:127], a[164:167], a[100:103], v[124:127]
    v_mfma_f32_16x16x32_bf16 v[124:127], a[168:171], a[104:107], v[124:127]
    v_mfma_f32_16x16x32_bf16 v[124:127], a[172:175], a[108:111], v[124:127]
    v_mfma_f32_16x16x32_bf16 v[124:127], a[176:179], a[112:115], v[124:127]
    s_nop 2
    v_cvt_pk_bf16_f32 v234, v120, v121
    v_mfma_f32_16x16x32_bf16 v[124:127], a[180:183], a[116:119], v[124:127]
    s_add_u32 s38, s93, 1664
    v_cvt_pk_bf16_f32 v235, v122, v123
    v_mfma_f32_16x16x32_bf16 v[124:127], a[184:187], a[120:123], v[124:127]
    buffer_store_dwordx4 v[232:235], v56, s[28:31], s38 offen sc1
    v_mfma_f32_16x16x32_bf16 v[124:127], a[188:191], a[124:127], v[124:127]
    s_nop 7
    v_cvt_pk_bf16_f32 v238, v124, v125
    s_add_u32 s38, s93, 165504
    v_cvt_pk_bf16_f32 v239, v126, v127
    buffer_store_dwordx4 v[236:239], v56, s[28:31], s38 offen sc1
    s_add_u32 s92, s92, 16
    s_waitcnt vmcnt(27)
    v_lshlrev_b32 v96, 16, v160
    v_and_b32 v97, 0xffff0000, v160
    v_lshlrev_b32 v98, 16, v161
    v_and_b32 v99, 0xffff0000, v161
    v_lshlrev_b32 v100, 16, v162
    v_and_b32 v101, 0xffff0000, v162
    v_lshlrev_b32 v102, 16, v163
    v_and_b32 v103, 0xffff0000, v163
    s_waitcnt vmcnt(25)
    v_lshlrev_b32 v104, 16, v164
    v_and_b32 v105, 0xffff0000, v164
    v_lshlrev_b32 v106, 16, v165
    v_and_b32 v107, 0xffff0000, v165
    v_lshlrev_b32 v108, 16, v166
    v_and_b32 v109, 0xffff0000, v166
    v_lshlrev_b32 v110, 16, v167
    v_and_b32 v111, 0xffff0000, v167
    s_waitcnt vmcnt(24)
    v_lshlrev_b32 v112, 16, v168
    v_and_b32 v113, 0xffff0000, v168
    v_lshlrev_b32 v114, 16, v169
    v_and_b32 v115, 0xffff0000, v169
    v_lshlrev_b32 v116, 16, v170
    v_and_b32 v117, 0xffff0000, v170
    v_lshlrev_b32 v118, 16, v171
    v_and_b32 v119, 0xffff0000, v171
    s_waitcnt vmcnt(23)
    v_lshlrev_b32 v120, 16, v172
    v_and_b32 v121, 0xffff0000, v172
    v_lshlrev_b32 v122, 16, v173
    v_and_b32 v123, 0xffff0000, v173
    v_lshlrev_b32 v124, 16, v174
    v_and_b32 v125, 0xffff0000, v174
    v_lshlrev_b32 v126, 16, v175
    v_and_b32 v127, 0xffff0000, v175
    s_waitcnt vmcnt(22)
    v_lshlrev_b32 v128, 16, v208
    v_and_b32 v129, 0xffff0000, v208
    v_lshlrev_b32 v130, 16, v209
    v_and_b32 v131, 0xffff0000, v209
    v_lshlrev_b32 v132, 16, v210
    v_and_b32 v133, 0xffff0000, v210
    v_lshlrev_b32 v134, 16, v211
    v_and_b32 v135, 0xffff0000, v211
    s_waitcnt vmcnt(20)
    v_lshlrev_b32 v136, 16, v212
    v_and_b32 v137, 0xffff0000, v212
    v_lshlrev_b32 v138, 16, v213
    v_and_b32 v139, 0xffff0000, v213
    v_lshlrev_b32 v140, 16, v214
    v_and_b32 v141, 0xffff0000, v214
    v_lshlrev_b32 v142, 16, v215
    v_and_b32 v143, 0xffff0000, v215
    s_waitcnt vmcnt(16)
    v_lshlrev_b32 v144, 16, v64
    v_and_b32 v145, 0xffff0000, v64
    v_lshlrev_b32 v146, 16, v65
    v_and_b32 v147, 0xffff0000, v65
    v_lshlrev_b32 v148, 16, v66
    v_and_b32 v149, 0xffff0000, v66
    v_lshlrev_b32 v150, 16, v67
    v_and_b32 v151, 0xffff0000, v67
    s_waitcnt vmcnt(15)
    v_lshlrev_b32 v152, 16, v68
    v_and_b32 v153, 0xffff0000, v68
    v_lshlrev_b32 v154, 16, v69
    v_and_b32 v155, 0xffff0000, v69
    v_lshlrev_b32 v156, 16, v70
    v_and_b32 v157, 0xffff0000, v70
    v_lshlrev_b32 v158, 16, v71
    v_and_b32 v159, 0xffff0000, v71
    s_waitcnt vmcnt(14)
    v_lshlrev_b32 v160, 16, v72
    v_and_b32 v161, 0xffff0000, v72
    v_lshlrev_b32 v162, 16, v73
    v_and_b32 v163, 0xffff0000, v73
    v_lshlrev_b32 v164, 16, v74
    v_and_b32 v165, 0xffff0000, v74
    v_lshlrev_b32 v166, 16, v75
    v_and_b32 v167, 0xffff0000, v75
    s_waitcnt vmcnt(13)
    v_lshlrev_b32 v168, 16, v76
    v_and_b32 v169, 0xffff0000, v76
    v_lshlrev_b32 v170, 16, v77
    v_and_b32 v171, 0xffff0000, v77
    s_waitcnt vmcnt(12)
    v_lshlrev_b32 v172, 16, v78
    v_and_b32 v173, 0xffff0000, v78
    v_lshlrev_b32 v174, 16, v79
    v_and_b32 v175, 0xffff0000, v79
    s_waitcnt vmcnt(11)
    v_lshlrev_b32 v176, 16, v80
    v_and_b32 v177, 0xffff0000, v80
    v_lshlrev_b32 v178, 16, v81
    v_and_b32 v179, 0xffff0000, v81
    s_waitcnt vmcnt(10)
    v_lshlrev_b32 v180, 16, v82
    v_and_b32 v181, 0xffff0000, v82
    v_lshlrev_b32 v182, 16, v83
    v_and_b32 v183, 0xffff0000, v83
    s_waitcnt vmcnt(8)
    v_lshlrev_b32 v184, 16, v84
    v_and_b32 v185, 0xffff0000, v84
    v_lshlrev_b32 v186, 16, v85
    v_and_b32 v187, 0xffff0000, v85
    s_waitcnt vmcnt(7)
    v_lshlrev_b32 v188, 16, v86
    v_and_b32 v189, 0xffff0000, v86
    v_lshlrev_b32 v190, 16, v87
    v_and_b32 v191, 0xffff0000, v87
    s_waitcnt vmcnt(0)
    buffer_store_dword v10, v8, s[24:27], s92 offen sc1
    v_cmp_ne_u32 s[54:55], s95, v11
    s_cmp_lg_u64 s[54:55], 0
    s_cbranch_scc1 Ltail_spin1
Ltail_got1:
    s_add_u32 s56, s44, 16384
    buffer_load_dwordx4 a[0:3], v54, s[28:31], s56 offen offset:0 sc1
    buffer_load_dwordx4 a[4:7], v54, s[28:31], s56 offen offset:1024 sc1
    buffer_load_dwordx4 a[8:11], v54, s[28:31], s56 offen offset:2048 sc1
    buffer_load_dwordx4 a[12:15], v54, s[28:31], s56 offen offset:3072 sc1
    s_add_u32 s56, s44, 0
    buffer_load_dwordx4 a[16:19], v2, s[28:31], s56 offen offset:0 sc1
    s_add_u32 s56, s44, 4096
    buffer_load_dwordx4 a[20:23], v2, s[28:31], s56 offen offset:0 sc1
    s_add_u32 s56, s44, 8192
    buffer_load_dwordx4 a[24:27], v2, s[28:31], s56 offen offset:0 sc1
    s_add_u32 s56, s44, 12288
    buffer_load_dwordx4 a[28:31], v2, s[28:31], s56 offen offset:0 sc1
    ds_write_b128 v51, a[128:131] offset:0
    ds_write_b128 v51, a[132:135] offset:4096
    ds_write_b128 v51, a[136:139] offset:8192
    ds_write_b128 v51, a[140:143] offset:12288
    ds_write_b128 v51, a[144:147] offset:16384
    ds_write_b128 v51, a[148:151] offset:20480
    ds_write_b128 v51, a[152:155] offset:24576
    ds_write_b128 v51, a[156:159] offset:28672
    ds_write_b128 v51, a[240:243] offset:32768
    ds_write_b128 v255, a[244:247] offset:40960
    ds_write_b128 v255, a[248:251] offset:45056
    ds_write_b128 v255, a[252:255] offset:49152
    v_lshlrev_b32 v12, 16, v36
    v_and_b32 v13, 0xffff0000, v36
    v_lshlrev_b32 v14, 16, v37
    v_and_b32 v15, 0xffff0000, v37
    v_lshlrev_b32 v16, 16, v38
    v_and_b32 v17, 0xffff0000, v38
    v_lshlrev_b32 v18, 16, v39
    v_and_b32 v19, 0xffff0000, v39
    v_lshlrev_b32 v20, 16, v40
    v_and_b32 v21, 0xffff0000, v40
    v_lshlrev_b32 v22, 16, v41
    v_and_b32 v23, 0xffff0000, v41
    v_lshlrev_b32 v24, 16, v42
    v_and_b32 v25, 0xffff0000, v42
    v_lshlrev_b32 v26, 16, v43
    v_and_b32 v27, 0xffff0000, v43
    v_lshlrev_b32 v28, 16, v92
    v_and_b32 v29, 0xffff0000, v92
    v_lshlrev_b32 v30, 16, v93
    v_and_b32 v31, 0xffff0000, v93
    v_lshlrev_b32 v32, 16, v94
    v_and_b32 v33, 0xffff0000, v94
    v_lshlrev_b32 v34, 16, v95
    v_and_b32 v35, 0xffff0000, v95
    v_lshlrev_b32 v192, 16, v216
    v_and_b32 v193, 0xffff0000, v216
    v_lshlrev_b32 v194, 16, v217
    v_and_b32 v195, 0xffff0000, v217
    v_lshlrev_b32 v196, 16, v218
    v_and_b32 v197, 0xffff0000, v218
    v_lshlrev_b32 v198, 16, v219
    v_and_b32 v199, 0xffff0000, v219
    v_lshlrev_b32 v200, 16, v220
    v_and_b32 v201, 0xffff0000, v220
    v_lshlrev_b32 v202, 16, v221
    v_and_b32 v203, 0xffff0000, v221
    v_lshlrev_b32 v204, 16, v222
    v_and_b32 v205, 0xffff0000, v222
    v_lshlrev_b32 v206, 16, v223
    v_and_b32 v207, 0xffff0000, v223
    v_lshlrev_b32 v208, 16, v88
    v_and_b32 v209, 0xffff0000, v88
    v_lshlrev_b32 v210, 16, v89
    v_and_b32 v211, 0xffff0000, v89
    v_lshlrev_b32 v212, 16, v90
    v_and_b32 v213, 0xffff0000, v90
    v_lshlrev_b32 v214, 16, v91
    v_and_b32 v215, 0xffff0000, v91
    s_add_u32 s39, s39, 16
    buffer_load_dword v11, v9, s[24:27], s39 offen sc1
    s_add_u32 s56, s44, 0
    buffer_load_dwordx4 a[32:35], v2, s[28:31], s56 offen offset:512 sc1
    s_add_u32 s56, s44, 4096
    buffer_load_dwordx4 a[36:39], v2, s[28:31], s56 offen offset:512 sc1
    s_add_u32 s56, s44, 8192
    buffer_load_dwordx4 a[40:43], v2, s[28:31], s56 offen offset:512 sc1
    s_add_u32 s56, s44, 12288
    buffer_load_dwordx4 a[44:47], v2, s[28:31], s56 offen offset:512 sc1
    v_pk_mul_f32 v[62:63], v[144:145], v[168:169]
    v_pk_mul_f32 v[168:169], v[168:169], v[120:121]
    v_pk_fma_f32 v[62:63], v[146:147], v[170:171], v[62:63]
    v_pk_mul_f32 v[170:171], v[170:171], v[122:123]
    v_pk_add_f32 v[88:89], v[168:169], v[170:171]
    v_pk_fma_f32 v[62:63], v[148:149], v[172:173], v[62:63]
    v_pk_mul_f32 v[172:173], v[172:173], v[124:125]
    v_pk_add_f32 v[88:89], v[88:89], v[172:173]
    v_pk_fma_f32 v[62:63], v[150:151], v[174:175], v[62:63]
    v_pk_mul_f32 v[174:175], v[174:175], v[126:127]
    v_pk_add_f32 v[88:89], v[88:89], v[174:175]
    v_pk_fma_f32 v[62:63], v[152:153], v[176:177], v[62:63]
    v_pk_mul_f32 v[176:177], v[176:177], v[128:129]
    v_pk_add_f32 v[88:89], v[88:89], v[176:177]
    v_pk_fma_f32 v[62:63], v[154:155], v[178:179], v[62:63]
    v_pk_mul_f32 v[178:179], v[178:179], v[130:131]
    v_pk_add_f32 v[88:89], v[88:89], v[178:179]
    v_pk_fma_f32 v[62:63], v[156:157], v[180:181], v[62:63]
    v_pk_mul_f32 v[180:181], v[180:181], v[132:133]
    v_pk_add_f32 v[88:89], v[88:89], v[180:181]
    v_pk_fma_f32 v[62:63], v[158:159], v[182:183], v[62:63]
    v_pk_mul_f32 v[182:183], v[182:183], v[134:135]
    v_pk_add_f32 v[88:89], v[88:89], v[182:183]
    v_pk_fma_f32 v[62:63], v[160:161], v[184:185], v[62:63]
    v_pk_mul_f32 v[184:185], v[184:185], v[136:137]
    v_pk_add_f32 v[88:89], v[88:89], v[184:185]
    v_pk_fma_f32 v[62:63], v[162:163], v[186:187], v[62:63]
    v_pk_mul_f32 v[186:187], v[186:187], v[138:139]
    v_pk_add_f32 v[88:89], v[88:89], v[186:187]
    v_pk_fma_f32 v[62:63], v[164:165], v[188:189], v[62:63]
    v_pk_mul_f32 v[188:189], v[188:189], v[140:141]
    v_pk_add_f32 v[88:89], v[88:89], v[188:189]
    v_pk_fma_f32 v[62:63], v[166:167], v[190:191], v[62:63]
    v_pk_mul_f32 v[190:191], v[190:191], v[142:143]
    v_pk_add_f32 v[88:89], v[88:89], v[190:191]
    v_add_f32 v91, v62, v63
    v_add_f32 v90, v88, v89
    s_nop 1
    v_add_f32_dpp v90, v90, v90 row_ror:8 row_mask:0xf bank_mask:0xf
    v_add_f32_dpp v91, v91, v91 row_ror:8 row_mask:0xf bank_mask:0xf
    s_nop 0
    v_add_f32_dpp v90, v90, v90 row_ror:4 row_mask:0xf bank_mask:0xf
    v_add_f32_dpp v91, v91, v91 row_ror:4 row_mask:0xf bank_mask:0xf
    s_nop 0
    v_add_f32_dpp v90, v90, v90 row_ror:2 row_mask:0xf bank_mask:0xf
    v_add_f32_dpp v91, v91, v91 row_ror:2 row_mask:0xf bank_mask:0xf
    s_nop 0
    v_add_f32_dpp v90, v90, v90 row_ror:1 row_mask:0xf bank_mask:0xf
    v_add_f32_dpp v91, v91, v91 row_ror:1 row_mask:0xf bank_mask:0xf
    v_mov_b32 v62, v90
    v_mov_b32 v63, v91
    s_nop 0
    v_permlane16_swap_b32 v90, v62
    v_permlane16_swap_b32 v91, v63
    v_add_f32 v90, v90, v62
    v_add_f32 v91, v91, v63
    v_lshlrev_b32 v92, 2, v7
    v_and_b32 v92, 28, v92
    v_sub_u32 v93, 2047, v7
    s_waitcnt vmcnt(4)
    v_cmp_ne_u32 s[54:55], s95, v11
    s_cmp_lg_u64 s[54:55], 0
    s_cbranch_scc1 Ltail_spin2
Ltail_got2:
    s_add_u32 s56, s44, 0
    buffer_load_dwordx4 a[48:51], v2, s[28:31], s56 offen offset:1024 sc1
    s_add_u32 s56, s44, 4096
    buffer_load_dwordx4 a[52:55], v2, s[28:31], s56 offen offset:1024 sc1
    s_add_u32 s56, s44, 8192
    buffer_load_dwordx4 a[56:59], v2, s[28:31], s56 offen offset:1024 sc1
    s_add_u32 s56, s44, 12288
    buffer_load_dwordx4 a[60:63], v2, s[28:31], s56 offen offset:1024 sc1
    s_add_u32 s56, s44, 0
    buffer_load_dwordx4 a[64:67], v2, s[28:31], s56 offen offset:1536 sc1
    s_add_u32 s56, s44, 4096
    buffer_load_dwordx4 a[68:71], v2, s[28:31], s56 offen offset:1536 sc1
    s_add_u32 s56, s44, 8192
    buffer_load_dwordx4 a[72:75], v2, s[28:31], s56 offen offset:1536 sc1
    s_add_u32 s56, s44, 12288
    buffer_load_dwordx4 a[76:79], v2, s[28:31], s56 offen offset:1536 sc1
    s_movk_i32 s48, 0x7ff
    v_mfma_f32_16x16x32_bf16 v[80:83], v[242:245], a[0:3], 0
    v_mfma_f32_16x16x32_bf16 v[84:87], v[240:243], a[0:3], 0
    v_mfma_f32_16x16x32_bf16 v[80:83], v[242:245], a[4:7], v[80:83]
    v_mfma_f32_16x16x32_bf16 v[84:87], v[240:243], a[4:7], v[84:87]
    v_mfma_f32_16x16x32_bf16 v[80:83], v[242:245], a[8:11], v[80:83]
    v_mfma_f32_16x16x32_bf16 v[84:87], v[240:243], a[8:11], v[84:87]
    v_mfma_f32_16x16x32_bf16 v[80:83], v[242:245], a[12:15], v[80:83]
    v_mfma_f32_16x16x32_bf16 v[84:87], v[240:243], a[12:15], v[84:87]
    s_nop 6
    v_mov_b32_dpp v80, v80 row_ror:8 row_mask:0x4 bank_mask:0xf
    v_mov_b32_dpp v81, v81 row_ror:8 row_mask:0x4 bank_mask:0xf
    v_mov_b32_dpp v82, v82 row_ror:8 row_mask:0x4 bank_mask:0xf
    v_mov_b32_dpp v83, v83 row_ror:8 row_mask:0x4 bank_mask:0xf
    v_mov_b32_dpp v84, v84 row_ror:8 row_mask:0x4 bank_mask:0xf
    v_mov_b32_dpp v85, v85 row_ror:8 row_mask:0x4 bank_mask:0xf
    v_mov_b32_dpp v86, v86 row_ror:8 row_mask:0x4 bank_mask:0xf
    v_mov_b32_dpp v87, v87 row_ror:8 row_mask:0x4 bank_mask:0xf
    v_pk_fma_f32 v[28:29], v[112:113], v[80:81], v[28:29]
    v_pk_fma_f32 v[30:31], v[114:115], v[82:83], v[30:31]
    v_pk_fma_f32 v[32:33], v[116:117], v[84:85], v[32:33]
    v_pk_fma_f32 v[34:35], v[118:119], v[86:87], v[34:35]
    v_cvt_pk_bf16_f32 v44, v28, v29
    v_cvt_pk_bf16_f32 v45, v30, v31
    v_cvt_pk_bf16_f32 v46, v32, v33
    v_cvt_pk_bf16_f32 v47, v34, v35
    v_lshlrev_b32 v28, 16, v44
    v_and_b32 v29, 0xffff0000, v44
    v_lshlrev_b32 v30, 16, v45
    v_and_b32 v31, 0xffff0000, v45
    v_lshlrev_b32 v32, 16, v46
    v_and_b32 v33, 0xffff0000, v46
    v_lshlrev_b32 v34, 16, v47
    v_and_b32 v35, 0xffff0000, v47
    v_mfma_f32_16x16x32_bf16 v[64:67], v[246:249], a[16:19], 0
Ltour12:
    s_cbranch_execz Ltour16
    v_mfma_f32_16x16x32_bf16 v[68:71], v[244:247], a[16:19], 0
    v_mfma_f32_16x16x32_bf16 v[64:67], v[246:249], a[20:23], v[64:67]
    v_mfma_f32_16x16x32_bf16 v[68:71], v[244:247], a[20:23], v[68:71]
    v_mfma_f32_16x16x32_bf16 v[64:67], v[246:249], a[24:27], v[64:67]
    v_mfma_f32_16x16x32_bf16 v[68:71], v[244:247], a[24:27], v[68:71]
    v_mfma_f32_16x16x32_bf16 v[64:67], v[246:249], a[28:31], v[64:67]
    v_mfma_f32_16x16x32_bf16 v[68:71], v[244:247], a[28:31], v[68:71]
    s_waitcnt vmcnt(11)
    v_mfma_f32_16x16x32_bf16 v[64:67], v[250:253], a[32:35], v[64:67]
    v_mfma_f32_16x16x32_bf16 v[68:71], v[248:251], a[32:35], v[68:71]
    s_waitcnt vmcnt(10)
    v_mfma_f32_16x16x32_bf16 v[64:67], v[250:253], a[36:39], v[64:67]
    v_mfma_f32_16x16x32_bf16 v[68:71], v[248:251], a[36:39], v[68:71]
    s_waitcnt vmcnt(9)
    v_mfma_f32_16x16x32_bf16 v[64:67], v[250:253], a[40:43], v[64:67]
    v_mfma_f32_16x16x32_bf16 v[68:71], v[248:251], a[40:43], v[68:71]
    s_waitcnt vmcnt(8)
    v_mfma_f32_16x16x32_bf16 v[64:67], v[250:253], a[44:47], v[64:67]
    v_mfma_f32_16x16x32_bf16 v[68:71], v[248:251], a[44:47], v[68:71]
    s_waitcnt vmcnt(7)
    s_nop 5
    v_pk_fma_f32 v[12:13], v[96:97], v[64:65], v[12:13]
    v_pk_fma_f32 v[14:15], v[98:99], v[66:67], v[14:15]
    v_pk_fma_f32 v[16:17], v[100:101], v[68:69], v[16:17]
    v_pk_fma_f32 v[18:19], v[102:103], v[70:71], v[18:19]
    v_cvt_pk_bf16_f32 v36, v12, v13
    v_cvt_pk_bf16_f32 v37, v14, v15
    v_cvt_pk_bf16_f32 v38, v16, v17
    v_cvt_pk_bf16_f32 v39, v18, v19
    v_lshlrev_b32 v12, 16, v36
    v_and_b32 v13, 0xffff0000, v36
    v_lshlrev_b32 v14, 16, v37
    v_and_b32 v15, 0xffff0000, v37
    v_lshlrev_b32 v16, 16, v38
    v_and_b32 v17, 0xffff0000, v38
    v_lshlrev_b32 v18, 16, v39
    v_and_b32 v19, 0xffff0000, v39
    v_pk_add_f32 v[88:89], v[12:13], v[14:15]
    v_pk_add_f32 v[62:63], v[16:17], v[18:19]
    v_pk_add_f32 v[88:89], v[88:89], v[62:63]
    v_add_f32 v88, v88, v89
    s_nop 1
    v_add_f32_dpp v88, v88, v88 row_ror:8 row_mask:0xf bank_mask:0xf
    s_nop 1
    v_add_f32_dpp v88, v88, v88 row_ror:4 row_mask:0xf bank_mask:0xf
    s_nop 1
    v_add_f32_dpp v88, v88, v88 row_ror:2 row_mask:0xf bank_mask:0xf
    s_nop 1
    v_add_f32_dpp v88, v88, v88 row_ror:1 row_mask:0xf bank_mask:0xf
    v_mov_b32 v62, v88
    s_nop 1
    v_permlane16_swap_b32 v88, v62
    s_nop 0
    v_add_f32 v88, v88, v62
    v_mul_f32 v88, 0x3b800000, v88
    v_pk_add_f32 v[232:233], v[28:29], v[88:89] op_sel_hi:[1,0] neg_lo:[0,1] neg_hi:[0,1]
    v_pk_add_f32 v[234:235], v[30:31], v[88:89] op_sel_hi:[1,0] neg_lo:[0,1] neg_hi:[0,1]
    v_pk_add_f32 v[236:237], v[32:33], v[88:89] op_sel_hi:[1,0] neg_lo:[0,1] neg_hi:[0,1]
    v_pk_add_f32 v[238:239], v[34:35], v[88:89] op_sel_hi:[1,0] neg_lo:[0,1] neg_hi:[0,1]
    v_pk_add_f32 v[48:49], v[232:233], v[234:235]
    v_pk_mul_f32 v[50:51], v[232:233], v[232:233]
    v_pk_mul_f32 v[52:53], v[232:233], v[184:185]
    v_pk_fma_f32 v[50:51], v[234:235], v[234:235], v[50:51]
    v_pk_fma_f32 v[52:53], v[234:235], v[186:187], v[52:53]
    v_pk_add_f32 v[48:49], v[48:49], v[236:237]
    v_pk_fma_f32 v[50:51], v[236:237], v[236:237], v[50:51]
    v_pk_fma_f32 v[52:53], v[236:237], v[188:189], v[52:53]
    v_pk_add_f32 v[48:49], v[48:49], v[238:239]
    v_pk_fma_f32 v[50:51], v[238:239], v[238:239], v[50:51]
    v_pk_fma_f32 v[52:53], v[238:239], v[190:191], v[52:53]
    v_cndmask_b32 v48, 0, v48, vcc
    v_cndmask_b32 v49, 0, v49, vcc
    v_cndmask_b32 v50, 0, v50, vcc
    v_cndmask_b32 v51, 0, v51, vcc
    v_pk_add_f32 v[216:217], v[12:13], v[88:89] op_sel_hi:[1,0] neg_lo:[0,1] neg_hi:[0,1]
    v_pk_add_f32 v[218:219], v[14:15], v[88:89] op_sel_hi:[1,0] neg_lo:[0,1] neg_hi:[0,1]
    v_pk_add_f32 v[220:221], v[16:17], v[88:89] op_sel_hi:[1,0] neg_lo:[0,1] neg_hi:[0,1]
    v_pk_add_f32 v[222:223], v[18:19], v[88:89] op_sel_hi:[1,0] neg_lo:[0,1] neg_hi:[0,1]
    v_pk_add_f32 v[48:49], v[48:49], v[216:217]
    v_pk_fma_f32 v[50:51], v[216:217], v[216:217], v[50:51]
    v_pk_fma_f32 v[52:53], v[216:217], v[168:169], v[52:53]
    v_pk_add_f32 v[48:49], v[48:49], v[218:219]
    v_pk_fma_f32 v[50:51], v[218:219], v[218:219], v[50:51]
    v_pk_fma_f32 v[52:53], v[218:219], v[170:171], v[52:53]
    v_pk_add_f32 v[48:49], v[48:49], v[220:221]
    v_pk_fma_f32 v[50:51], v[220:221], v[220:221], v[50:51]
    v_pk_fma_f32 v[52:53], v[220:221], v[172:173], v[52:53]
    v_pk_add_f32 v[48:49], v[48:49], v[222:223]
    v_pk_fma_f32 v[50:51], v[222:223], v[222:223], v[50:51]
    v_pk_fma_f32 v[52:53], v[222:223], v[174:175], v[52:53]
    v_mfma_f32_16x16x32_bf16 v[72:75], v[246:249], a[48:51], 0
    v_mfma_f32_16x16x32_bf16 v[76:79], v[244:247], a[48:51], 0
    s_waitcnt vmcnt(6)
    v_mfma_f32_16x16x32_bf16 v[72:75], v[246:249], a[52:55], v[72:75]
    v_mfma_f32_16x16x32_bf16 v[76:79], v[244:247], a[52:55], v[76:79]
    s_waitcnt vmcnt(5)
    v_mfma_f32_16x16x32_bf16 v[72:75], v[246:249], a[56:59], v[72:75]
    v_mfma_f32_16x16x32_bf16 v[76:79], v[244:247], a[56:59], v[76:79]
    s_waitcnt vmcnt(4)
    v_mfma_f32_16x16x32_bf16 v[72:75], v[246:249], a[60:63], v[72:75]
    v_mfma_f32_16x16x32_bf16 v[76:79], v[244:247], a[60:63], v[76:79]
    s_waitcnt vmcnt(3)
    v_mfma_f32_16x16x32_bf16 v[72:75], v[250:253], a[64:67], v[72:75]
    v_mfma_f32_16x16x32_bf16 v[76:79], v[248:251], a[64:67], v[76:79]
    s_waitcnt vmcnt(2)
    v_mfma_f32_16x16x32_bf16 v[72:75], v[250:253], a[68:71], v[72:75]
    v_mfma_f32_16x16x32_bf16 v[76:79], v[248:251], a[68:71], v[76:79]
    s_waitcnt vmcnt(1)
    v_mfma_f32_16x16x32_bf16 v[72:75], v[250:253], a[72:75], v[72:75]
    v_mfma_f32_16x16x32_bf16 v[76:79], v[248:251], a[72:75], v[76:79]
    s_waitcnt vmcnt(0)
    v_mfma_f32_16x16x32_bf16 v[72:75], v[250:253], a[76:79], v[72:75]
    v_mfma_f32_16x16x32_bf16 v[76:79], v[248:251], a[76:79], v[76:79]
    s_nop 6
    v_pk_fma_f32 v[20:21], v[104:105], v[72:73], v[20:21]
    v_pk_fma_f32 v[22:23], v[106:107], v[74:75], v[22:23]
    v_pk_fma_f32 v[24:25], v[108:109], v[76:77], v[24:25]
    v_pk_fma_f32 v[26:27], v[110:111], v[78:79], v[26:27]
    v_cvt_pk_bf16_f32 v40, v20, v21
    v_cvt_pk_bf16_f32 v41, v22, v23
    v_cvt_pk_bf16_f32 v42, v24, v25
    v_cvt_pk_bf16_f32 v43, v26, v27
    v_lshlrev_b32 v20, 16, v40
    v_and_b32 v21, 0xffff0000, v40
    v_lshlrev_b32 v22, 16, v41
    v_and_b32 v23, 0xffff0000, v41
    v_lshlrev_b32 v24, 16, v42
    v_and_b32 v25, 0xffff0000, v42
    v_lshlrev_b32 v26, 16, v43
    v_and_b32 v27, 0xffff0000, v43
    v_pk_add_f32 v[224:225], v[20:21], v[88:89] op_sel_hi:[1,0] neg_lo:[0,1] neg_hi:[0,1]
    v_pk_add_f32 v[226:227], v[22:23], v[88:89] op_sel_hi:[1,0] neg_lo:[0,1] neg_hi:[0,1]
    v_pk_add_f32 v[228:229], v[24:25], v[88:89] op_sel_hi:[1,0] neg_lo:[0,1] neg_hi:[0,1]
    v_pk_add_f32 v[230:231], v[26:27], v[88:89] op_sel_hi:[1,0] neg_lo:[0,1] neg_hi:[0,1]
    v_pk_add_f32 v[48:49], v[48:49], v[224:225]
    v_pk_fma_f32 v[50:51], v[224:225], v[224:225], v[50:51]
    v_pk_fma_f32 v[52:53], v[224:225], v[176:177], v[52:53]
    v_pk_add_f32 v[48:49], v[48:49], v[226:227]
    v_pk_fma_f32 v[50:51], v[226:227], v[226:227], v[50:51]
    v_pk_fma_f32 v[52:53], v[226:227], v[178:179], v[52:53]
    v_pk_add_f32 v[48:49], v[48:49], v[228:229]
    v_pk_fma_f32 v[50:51], v[228:229], v[228:229], v[50:51]
    v_pk_fma_f32 v[52:53], v[228:229], v[180:181], v[52:53]
    v_pk_add_f32 v[48:49], v[48:49], v[230:231]
    v_pk_fma_f32 v[50:51], v[230:231], v[230:231], v[50:51]
    v_pk_fma_f32 v[52:53], v[230:231], v[182:183], v[52:53]
    v_add_f32 v48, v48, v49
    v_add_f32 v50, v50, v51
    v_add_f32 v52, v52, v53
    v_add_f32_dpp v48, v48, v48 row_ror:8 row_mask:0xf bank_mask:0xf
    v_add_f32_dpp v50, v50, v50 row_ror:8 row_mask:0xf bank_mask:0xf
    v_add_f32_dpp v52, v52, v52 row_ror:8 row_mask:0xf bank_mask:0xf
    v_add_f32_dpp v48, v48, v48 row_ror:4 row_mask:0xf bank_mask:0xf
    v_add_f32_dpp v50, v50, v50 row_ror:4 row_mask:0xf bank_mask:0xf
    v_add_f32_dpp v52, v52, v52 row_ror:4 row_mask:0xf bank_mask:0xf
    v_add_f32_dpp v48, v48, v48 row_ror:2 row_mask:0xf bank_mask:0xf
    v_add_f32_dpp v50, v50, v50 row_ror:2 row_mask:0xf bank_mask:0xf
    v_add_f32_dpp v52, v52, v52 row_ror:2 row_mask:0xf bank_mask:0xf
    v_add_f32_dpp v48, v48, v48 row_ror:1 row_mask:0xf bank_mask:0xf
    v_add_f32_dpp v50, v50, v50 row_ror:1 row_mask:0xf bank_mask:0xf
    v_add_f32_dpp v52, v52, v52 row_ror:1 row_mask:0xf bank_mask:0xf
    v_mov_b32 v49, v48
    v_mov_b32 v51, v50
    v_mov_b32 v53, v52
    v_permlane16_swap_b32 v48, v49
    v_permlane16_swap_b32 v50, v51
    v_permlane16_swap_b32 v52, v53
    v_add_f32 v48, v48, v49
    v_add_f32 v50, v50, v51
    v_add_f32 v52, v52, v53
    v_mul_f32 v48, 0x3ae38e39, v48
    v_mul_f32 v50, 0x3ae38e39, v50
    v_fma_f32 v50, -v48, v48, v50
    v_add_f32 v48, v48, v88
    v_max_f32 v50, 0, v50
    v_cvt_pk_bf16_f32 v48, v48, v50
    v_and_b32 v50, 0xffff0000, v48
    v_lshlrev_b32 v48, 16, v48
    v_add_f32 v50, 0x3727c5ac, v50
    v_sub_f32 v48, v88, v48
    v_cvt_pk_bf16_f32 v50, v50, v50
    v_and_b32 v50, 0xffff0000, v50
    v_sqrt_f32 v50, v50
    v_fmac_f32 v52, v48, v90
    v_cvt_pk_bf16_f32 v50, v50, v50
    v_and_b32 v50, 0xffff0000, v50
    v_rcp_f32 v50, v50
    s_mov_b32 exec_lo, 1
    s_mov_b32 exec_hi, 1
    v_fma_f32 v52, v52, v50, v91
    v_ashrrev_i32 v62, 31, v52
    v_or_b32 v62, 0x80000000, v62
    v_xor_b32 v52, v62, v52
    v_min_u32 v52, 0xfffff000, v52
    v_bfi_b32 v52, s48, v93, v52
    ds_write_b32 v92, v52 offset:36864
    s_mov_b64 exec, -1
    v_mul_f32 v48, v48, v50
    s_waitcnt lgkmcnt(0)
    s_barrier
    v_mov_b32 v109, 36864
    ds_read_b128 v[96:99], v109
    ds_read_b128 v[100:103], v109 offset:16
    s_lshl_b32 s45, s2, 7
    s_add_u32 s45, s45, 9306112
    s_cmp_eq_u32 s3, 0
    s_cselect_b32 s45, s45, 2147483648
    s_waitcnt lgkmcnt(1)
    v_max_u32 v104, v96, v97
    v_min_u32 v105, v96, v97
    v_med3_u32 v105, v104, v105, v98
    v_max_u32 v104, v104, v98
    v_med3_u32 v105, v104, v105, v99
    v_max_u32 v104, v104, v99
    s_waitcnt lgkmcnt(0)
    v_med3_u32 v105, v104, v105, v100
    v_max_u32 v104, v104, v100
    v_med3_u32 v105, v104, v105, v101
    v_max_u32 v104, v104, v101
    v_med3_u32 v105, v104, v105, v102
    v_max_u32 v104, v104, v102
    v_med3_u32 v105, v104, v105, v103
    v_max_u32 v104, v104, v103
    buffer_store_dwordx2 v[104:105], v8, s[24:27], s45 offen sc1
    v_pk_fma_f32 v[216:217], v[216:217], v[50:51], v[48:49] op_sel_hi:[1,0,0]
    v_pk_fma_f32 v[218:219], v[218:219], v[50:51], v[48:49] op_sel_hi:[1,0,0]
    v_pk_fma_f32 v[220:221], v[220:221], v[50:51], v[48:49] op_sel_hi:[1,0,0]
    v_pk_fma_f32 v[222:223], v[222:223], v[50:51], v[48:49] op_sel_hi:[1,0,0]
    v_pk_fma_f32 v[224:225], v[224:225], v[50:51], v[48:49] op_sel_hi:[1,0,0]
    v_pk_fma_f32 v[226:227], v[226:227], v[50:51], v[48:49] op_sel_hi:[1,0,0]
    v_pk_fma_f32 v[228:229], v[228:229], v[50:51], v[48:49] op_sel_hi:[1,0,0]
    v_pk_fma_f32 v[230:231], v[230:231], v[50:51], v[48:49] op_sel_hi:[1,0,0]
    v_pk_fma_f32 v[232:233], v[232:233], v[50:51], v[48:49] op_sel_hi:[1,0,0]
    v_pk_fma_f32 v[234:235], v[234:235], v[50:51], v[48:49] op_sel_hi:[1,0,0]
    v_pk_fma_f32 v[236:237], v[236:237], v[50:51], v[48:49] op_sel_hi:[1,0,0]
    v_pk_fma_f32 v[238:239], v[238:239], v[50:51], v[48:49] op_sel_hi:[1,0,0]
    v_pk_fma_f32 v[216:217], v[216:217], v[120:121], v[144:145]
    v_pk_fma_f32 v[218:219], v[218:219], v[122:123], v[146:147]
    v_pk_fma_f32 v[220:221], v[220:221], v[124:125], v[148:149]
    v_pk_fma_f32 v[222:223], v[222:223], v[126:127], v[150:151]
    v_pk_fma_f32 v[224:225], v[224:225], v[128:129], v[152:153]
    v_pk_fma_f32 v[226:227], v[226:227], v[130:131], v[154:155]
    v_pk_fma_f32 v[228:229], v[228:229], v[132:133], v[156:157]
    v_pk_fma_f32 v[230:231], v[230:231], v[134:135], v[158:159]
    v_pk_fma_f32 v[232:233], v[232:233], v[136:137], v[160:161]
    v_pk_fma_f32 v[234:235], v[234:235], v[138:139], v[162:163]
    v_pk_fma_f32 v[236:237], v[236:237], v[140:141], v[164:165]
    v_pk_fma_f32 v[238:239], v[238:239], v[142:143], v[166:167]
    v_cvt_pk_bf16_f32 v64, v216, v217
    v_cvt_pk_bf16_f32 v65, v218, v219
    v_cvt_pk_bf16_f32 v66, v220, v221
    v_cvt_pk_bf16_f32 v67, v222, v223
    v_cvt_pk_bf16_f32 v68, v224, v225
    v_cvt_pk_bf16_f32 v69, v226, v227
    v_cvt_pk_bf16_f32 v70, v228, v229
    v_cvt_pk_bf16_f32 v71, v230, v231
    v_cvt_pk_bf16_f32 v72, v232, v233
    v_cvt_pk_bf16_f32 v73, v234, v235
    v_cvt_pk_bf16_f32 v74, v236, v237
    v_cvt_pk_bf16_f32 v75, v238, v239
    v_and_b32 v106, 0x7ff, v104
    v_and_b32 v107, 0x7ff, v105
    v_cmp_eq_u32 vcc, v106, v93
    v_cmp_eq_u32 s[36:37], v107, v93
    v_mov_b32 v106, 2147483648
    s_or_b64 vcc, vcc, s[36:37]
    s_mov_b32 s45, 2621440
    s_nop 0
    v_cndmask_b32 v6, v106, v6, vcc
    v_cndmask_b32 v60, v106, v60, vcc
    buffer_store_dwordx4 v[64:67], v6, s[24:27], s45 offen offset:0 sc1
    buffer_store_dwordx4 v[68:71], v6, s[24:27], s45 offen offset:512 sc1
    buffer_store_dwordx4 v[72:75], v60, s[24:27], s45 offen offset:1024 sc1
    s_cmp_ge_u32 s41, 18
    s_cbranch_scc1 Ltail_idle
    s_mov_b32 s36, 2622592
    buffer_store_dwordx4 v[36:39], v6, s[24:27], s36 offen offset:0 sc1
    buffer_store_dwordx4 v[40:43], v6, s[24:27], s36 offen offset:512 sc1
    buffer_store_dwordx4 v[44:47], v60, s[24:27], s36 offen offset:1024 sc1
    s_add_u32 s57, s59, 4096
    s_add_u32 m0, s6, -110592
    s_nop 0
    buffer_load_dwordx4 v255, s[84:87], s57 offen lds
    s_add_u32 s57, s59, 8192
    s_add_u32 m0, s6, -106496
    s_nop 0
    buffer_load_dwordx4 v255, s[84:87], s57 offen lds
    s_add_u32 s57, s59, 12288
    s_add_u32 m0, s6, -102400
    s_nop 0
    buffer_load_dwordx4 v255, s[84:87], s57 offen lds
    s_add_u32 s57, s59, 16384
    s_add_u32 m0, s6, -98304
    s_nop 0
    buffer_load_dwordx4 v255, s[84:87], s57 offen lds
    s_add_u32 s57, s59, 20480
    s_add_u32 m0, s6, -94208
    s_nop 0
    buffer_load_dwordx4 v255, s[84:87], s57 offen lds
    s_add_u32 s57, s59, 24576
    s_add_u32 m0, s6, -90112
    s_nop 0
    buffer_load_dwordx4 v255, s[84:87], s57 offen lds
    s_add_u32 s57, s59, 28672
    s_add_u32 m0, s6, -86016
    s_nop 0
    buffer_load_dwordx4 v255, s[84:87], s57 offen lds
    s_add_u32 s57, s59, 32768
    s_add_u32 m0, s6, -81920
    s_nop 0
    buffer_load_dwordx4 v255, s[84:87], s57 offen lds
    v_lshlrev_b32 v216, 16, v64
    v_and_b32 v217, 0xffff0000, v64
    v_lshlrev_b32 v218, 16, v65
    v_and_b32 v219, 0xffff0000, v65
    v_lshlrev_b32 v220, 16, v66
    v_and_b32 v221, 0xffff0000, v66
    v_lshlrev_b32 v222, 16, v67
    v_and_b32 v223, 0xffff0000, v67
    v_lshlrev_b32 v224, 16, v68
    v_and_b32 v225, 0xffff0000, v68
    v_lshlrev_b32 v226, 16, v69
    v_and_b32 v227, 0xffff0000, v69
    v_lshlrev_b32 v228, 16, v70
    v_and_b32 v229, 0xffff0000, v70
    v_lshlrev_b32 v230, 16, v71
    v_and_b32 v231, 0xffff0000, v71
    v_lshlrev_b32 v232, 16, v72
    v_and_b32 v233, 0xffff0000, v72
    v_lshlrev_b32 v234, 16, v73
    v_and_b32 v235, 0xffff0000, v73
    v_lshlrev_b32 v236, 16, v74
    v_and_b32 v237, 0xffff0000, v74
    v_lshlrev_b32 v238, 16, v75
    v_and_b32 v239, 0xffff0000, v75
    v_pk_mul_f32 v[192:193], v[192:193], v[216:217]
    v_pk_mul_f32 v[194:195], v[194:195], v[218:219]
    v_pk_mul_f32 v[196:197], v[196:197], v[220:221]
    v_pk_mul_f32 v[198:199], v[198:199], v[222:223]
    v_pk_mul_f32 v[200:201], v[200:201], v[224:225]
    v_pk_mul_f32 v[202:203], v[202:203], v[226:227]
    v_pk_mul_f32 v[204:205], v[204:205], v[228:229]
    v_pk_mul_f32 v[206:207], v[206:207], v[230:231]
    v_pk_mul_f32 v[208:209], v[208:209], v[232:233]
    v_pk_mul_f32 v[210:211], v[210:211], v[234:235]
    v_pk_mul_f32 v[212:213], v[212:213], v[236:237]
    v_pk_mul_f32 v[214:215], v[214:215], v[238:239]
    v_cvt_pk_bf16_f32 v144, v192, v193
    v_cvt_pk_bf16_f32 v145, v194, v195
    v_cvt_pk_bf16_f32 v146, v196, v197
    v_cvt_pk_bf16_f32 v147, v198, v199
    v_cvt_pk_bf16_f32 v148, v200, v201
    v_cvt_pk_bf16_f32 v149, v202, v203
    v_cvt_pk_bf16_f32 v150, v204, v205
    v_cvt_pk_bf16_f32 v151, v206, v207
    v_cvt_pk_bf16_f32 v152, v208, v209
    v_cvt_pk_bf16_f32 v153, v210, v211
    v_cvt_pk_bf16_f32 v154, v212, v213
    v_cvt_pk_bf16_f32 v155, v214, v215
    v_lshlrev_b32 v192, 16, v144
    v_and_b32 v193, 0xffff0000, v144
    v_lshlrev_b32 v194, 16, v145
    v_and_b32 v195, 0xffff0000, v145
    v_lshlrev_b32 v196, 16, v146
    v_and_b32 v197, 0xffff0000, v146
    v_lshlrev_b32 v198, 16, v147
    v_and_b32 v199, 0xffff0000, v147
    v_lshlrev_b32 v200, 16, v148
    v_and_b32 v201, 0xffff0000, v148
    v_lshlrev_b32 v202, 16, v149
    v_and_b32 v203, 0xffff0000, v149
    v_lshlrev_b32 v204, 16, v150
    v_and_b32 v205, 0xffff0000, v150
    v_lshlrev_b32 v206, 16, v151
    v_and_b32 v207, 0xffff0000, v151
    v_lshlrev_b32 v208, 16, v152
    v_and_b32 v209, 0xffff0000, v152
    v_lshlrev_b32 v210, 16, v153
    v_and_b32 v211, 0xffff0000, v153
    v_lshlrev_b32 v212, 16, v154
    v_and_b32 v213, 0xffff0000, v154
    v_lshlrev_b32 v214, 16, v155
    v_and_b32 v215, 0xffff0000, v155
    v_pk_add_f32 v[192:193], v[192:193], v[12:13]
    v_pk_add_f32 v[194:195], v[194:195], v[14:15]
    v_pk_add_f32 v[196:197], v[196:197], v[16:17]
    v_pk_add_f32 v[198:199], v[198:199], v[18:19]
    v_pk_add_f32 v[200:201], v[200:201], v[20:21]
    v_pk_add_f32 v[202:203], v[202:203], v[22:23]
    v_pk_add_f32 v[204:205], v[204:205], v[24:25]
    v_pk_add_f32 v[206:207], v[206:207], v[26:27]
    v_pk_add_f32 v[208:209], v[208:209], v[28:29]
    v_pk_add_f32 v[210:211], v[210:211], v[30:31]
    v_pk_add_f32 v[212:213], v[212:213], v[32:33]
    v_pk_add_f32 v[214:215], v[214:215], v[34:35]
    v_cvt_pk_bf16_f32 v156, v192, v193
    v_cvt_pk_bf16_f32 v157, v194, v195
    v_cvt_pk_bf16_f32 v158, v196, v197
    v_cvt_pk_bf16_f32 v159, v198, v199
    v_cvt_pk_bf16_f32 v160, v200, v201
    v_cvt_pk_bf16_f32 v161, v202, v203
    v_cvt_pk_bf16_f32 v162, v204, v205
    v_cvt_pk_bf16_f32 v163, v206, v207
    v_cvt_pk_bf16_f32 v164, v208, v209
    v_cvt_pk_bf16_f32 v165, v210, v211
    v_cvt_pk_bf16_f32 v166, v212, v213
    v_cvt_pk_bf16_f32 v167, v214, v215
    v_and_b32 v30, 2, v1
    v_cmp_ne_u32 vcc, 0, v30
    v_mul_u32_u24 v30, 1152, v7
    v_add_u32 v4, v30, v5
    v_add_u32 v58, v30, v59
    v_mov_b32_dpp v192, v158 quad_perm:[0,2,0,2] row_mask:0xf bank_mask:0xf
    v_mov_b32_dpp v193, v159 quad_perm:[0,2,0,2] row_mask:0xf bank_mask:0xf
    v_mov_b32_dpp v194, v158 quad_perm:[1,3,1,3] row_mask:0xf bank_mask:0xf
    v_mov_b32_dpp v195, v159 quad_perm:[1,3,1,3] row_mask:0xf bank_mask:0xf
    v_mov_b32_dpp v196, v162 quad_perm:[0,2,0,2] row_mask:0xf bank_mask:0xf
    v_mov_b32_dpp v197, v163 quad_perm:[0,2,0,2] row_mask:0xf bank_mask:0xf
    v_mov_b32_dpp v198, v162 quad_perm:[1,3,1,3] row_mask:0xf bank_mask:0xf
    v_mov_b32_dpp v199, v163 quad_perm:[1,3,1,3] row_mask:0xf bank_mask:0xf
    v_mov_b32_dpp v200, v166 quad_perm:[0,2,0,2] row_mask:0xf bank_mask:0xf
    v_mov_b32_dpp v201, v167 quad_perm:[0,2,0,2] row_mask:0xf bank_mask:0xf
    v_mov_b32_dpp v202, v166 quad_perm:[1,3,1,3] row_mask:0xf bank_mask:0xf
    v_mov_b32_dpp v203, v167 quad_perm:[1,3,1,3] row_mask:0xf bank_mask:0xf
    v_cndmask_b32_dpp v144, v156, v192, vcc quad_perm:[0,2,0,2] row_mask:0xf bank_mask:0xf
    v_cndmask_b32_dpp v145, v157, v193, vcc quad_perm:[0,2,0,2] row_mask:0xf bank_mask:0xf
    v_cndmask_b32_dpp v146, v156, v194, vcc quad_perm:[1,3,1,3] row_mask:0xf bank_mask:0xf
    v_cndmask_b32_dpp v147, v157, v195, vcc quad_perm:[1,3,1,3] row_mask:0xf bank_mask:0xf
    v_cndmask_b32_dpp v148, v160, v196, vcc quad_perm:[0,2,0,2] row_mask:0xf bank_mask:0xf
    v_cndmask_b32_dpp v149, v161, v197, vcc quad_perm:[0,2,0,2] row_mask:0xf bank_mask:0xf
    v_cndmask_b32_dpp v150, v160, v198, vcc quad_perm:[1,3,1,3] row_mask:0xf bank_mask:0xf
    v_cndmask_b32_dpp v151, v161, v199, vcc quad_perm:[1,3,1,3] row_mask:0xf bank_mask:0xf
    v_cndmask_b32_dpp v152, v164, v200, vcc quad_perm:[0,2,0,2] row_mask:0xf bank_mask:0xf
    v_cndmask_b32_dpp v153, v165, v201, vcc quad_perm:[0,2,0,2] row_mask:0xf bank_mask:0xf
    v_cndmask_b32_dpp v154, v164, v202, vcc quad_perm:[1,3,1,3] row_mask:0xf bank_mask:0xf
    v_cndmask_b32_dpp v155, v165, v203, vcc quad_perm:[1,3,1,3] row_mask:0xf bank_mask:0xf
    s_mov_b32 s38, 135168
    s_mov_b32 s39, 12288
    v_lshrrev_b32 v9, 2, v1
    v_and_b32 v10, 3, v1
    v_lshlrev_b32 v10, 3, v10
    s_and_b32 s45, s3, 1
    s_lshl_b32 s45, s45, 5
    v_lshl_add_u32 v11, v9, 6, v10
    v_add_u32 v11, s45, v11
    s_cmp_lt_u32 s3, 2
    s_cselect_b32 s44, 98304, s38
    s_cselect_b32 s45, 98304, s39
    v_add_u32 v12, s45, v11
    v_add_u32 v11, s44, v11
    ds_read_b64_tr_b16 a[0:1], v11 offset:0
    ds_read_b64_tr_b16 a[2:3], v11 offset:1024
    ds_read_b64_tr_b16 a[4:5], v11 offset:2048
    ds_read_b64_tr_b16 a[6:7], v11 offset:3072
    ds_read_b64_tr_b16 a[8:9], v11 offset:4096
    ds_read_b64_tr_b16 a[10:11], v11 offset:5120
    ds_read_b64_tr_b16 a[12:13], v11 offset:6144
    ds_read_b64_tr_b16 a[14:15], v11 offset:7168
    ds_read_b64_tr_b16 a[16:17], v11 offset:8192
    ds_read_b64_tr_b16 a[18:19], v11 offset:9216
    ds_read_b64_tr_b16 a[20:21], v11 offset:10240
    ds_read_b64_tr_b16 a[22:23], v11 offset:11264
    ds_read_b64_tr_b16 a[24:25], v11 offset:12288
    ds_read_b64_tr_b16 a[26:27], v11 offset:13312
    ds_read_b64_tr_b16 a[28:29], v11 offset:14336
    ds_read_b64_tr_b16 a[30:31], v11 offset:15360
    ds_read_b64_tr_b16 a[32:33], v11 offset:16384
    ds_read_b64_tr_b16 a[34:35], v11 offset:17408
    ds_read_b64_tr_b16 a[36:37], v11 offset:18432
    ds_read_b64_tr_b16 a[38:39], v11 offset:19456
    ds_read_b64_tr_b16 a[40:41], v11 offset:20480
    ds_read_b64_tr_b16 a[42:43], v11 offset:21504
    ds_read_b64_tr_b16 a[44:45], v11 offset:22528
    ds_read_b64_tr_b16 a[46:47], v11 offset:23552
    ds_read_b64_tr_b16 a[48:49], v11 offset:24576
    ds_read_b64_tr_b16 a[50:51], v11 offset:25600
    ds_read_b64_tr_b16 a[52:53], v11 offset:26624
    ds_read_b64_tr_b16 a[54:55], v11 offset:27648
    ds_read_b64_tr_b16 a[56:57], v12 offset:28672
    ds_read_b64_tr_b16 a[58:59], v12 offset:29696
    ds_read_b64_tr_b16 a[60:61], v12 offset:30720
    ds_read_b64_tr_b16 a[62:63], v12 offset:31744
    ds_read_b64_tr_b16 a[64:65], v12 offset:32768
    ds_read_b64_tr_b16 a[66:67], v12 offset:33792
    ds_read_b64_tr_b16 a[68:69], v12 offset:34816
    ds_read_b64_tr_b16 a[70:71], v12 offset:35840
    v_mul_u32_u24 v12, 1152, v9
    s_lshl_b32 s44, s3, 7
    s_add_u32 s44, s44, 49152
    v_add3_u32 v12, v12, v10, s44
    v_lshlrev_b32 v13, 4, v1
    v_add_u32 v13, 32768, v13
    s_lshl_b32 s44, s3, 10
    v_add_u32 v14, s44, v13
    v_and_b32 v13, 0xffffff1f, v13
    v_bfe_u32 v15, v1, 2, 2
    v_cmp_eq_u32 s[52:53], 0, v15
    v_cmp_eq_u32 s[54:55], 1, v15
    v_cmp_eq_u32 s[56:57], 2, v15
    v_cmp_eq_u32 s[58:59], 3, v15
    s_mul_i32 s43, s42, 18
    s_add_u32 s43, s43, s41
    s_lshl_b32 s43, s43, 9
    s_mul_i32 s44, s3, 73728
    s_add_u32 s43, s43, s44
    v_lshlrev_b32 v15, 3, v1
    v_and_b32 v10, 1, v1
    v_and_b32 v9, 48, v1
    v_lshlrev_b32 v108, 7, v0
    s_mov_b32 s45, 9306112
    s_lshl_b32 s36, s3, 3
    v_mov_b32 v109, s36
    s_mov_b32 s48, 16384
Ltail_pollk:
    buffer_load_dwordx2 v[104:105], v108, s[24:27], s45 offen sc1
    s_sub_u32 s48, s48, 1
    s_cbranch_scc1 Ltail_gotk
    s_waitcnt vmcnt(0)
    v_max_u32 v106, v104, v105
    v_cmp_eq_u32 vcc, -1, v106
    s_cbranch_vccnz Ltail_pollk
Ltail_gotk:
    s_waitcnt vmcnt(0)
    v_mov_b32_dpp v106, v104 row_ror:1 row_mask:0xf bank_mask:0xf
    v_mov_b32_dpp v107, v105 row_ror:1 row_mask:0xf bank_mask:0xf
    v_min_u32 v110, v104, v106
    v_max_u32 v104, v104, v106
    v_max3_u32 v105, v110, v105, v107
    s_nop 0
    v_mov_b32_dpp v106, v104 row_ror:2 row_mask:0xf bank_mask:0xf
    v_mov_b32_dpp v107, v105 row_ror:2 row_mask:0xf bank_mask:0xf
    v_min_u32 v110, v104, v106
    v_max_u32 v104, v104, v106
    v_max3_u32 v105, v110, v105, v107
    s_nop 0
    v_mov_b32_dpp v106, v104 row_ror:4 row_mask:0xf bank_mask:0xf
    v_mov_b32_dpp v107, v105 row_ror:4 row_mask:0xf bank_mask:0xf
    v_min_u32 v110, v104, v106
    v_max_u32 v104, v104, v106
    v_max3_u32 v105, v110, v105, v107
    s_nop 0
    v_mov_b32_dpp v106, v104 row_ror:8 row_mask:0xf bank_mask:0xf
    v_mov_b32_dpp v107, v105 row_ror:8 row_mask:0xf bank_mask:0xf
    v_min_u32 v110, v104, v106
    v_max_u32 v104, v104, v106
    v_max3_u32 v105, v110, v105, v107
    v_mov_b32 v106, v104
    v_mov_b32 v107, v105
    s_nop 0
    v_permlane16_swap_b32 v104, v106
    v_permlane16_swap_b32 v105, v107
    v_min_u32 v110, v104, v106
    v_max_u32 v104, v104, v106
    v_max3_u32 v105, v110, v105, v107
    v_mov_b32 v106, v104
    v_mov_b32 v107, v105
    s_nop 0
    v_permlane32_swap_b32 v104, v106
    v_permlane32_swap_b32 v105, v107
    v_min_u32 v110, v104, v106
    v_max_u32 v104, v104, v106
    v_max3_u32 v105, v110, v105, v107
    ds_write_b64 v109, v[104:105] offset:36928
    v_mov_b32 v109, 36928
    s_waitcnt lgkmcnt(0)
    s_barrier
    ds_read_b128 v[96:99], v109
    ds_read_b128 v[100:103], v109 offset:16
    s_waitcnt lgkmcnt(1)
    v_max_u32 v104, v96, v97
    v_min_u32 v105, v96, v97
    v_med3_u32 v105, v104, v105, v98
    v_max_u32 v104, v104, v98
    v_med3_u32 v105, v104, v105, v99
    v_max_u32 v104, v104, v99
    s_waitcnt lgkmcnt(0)
    v_med3_u32 v105, v104, v105, v100
    v_max_u32 v104, v104, v100
    v_med3_u32 v105, v104, v105, v101
    v_max_u32 v104, v104, v101
    v_med3_u32 v105, v104, v105, v102
    v_max_u32 v104, v104, v102
    v_med3_u32 v105, v104, v105, v103
    v_max_u32 v104, v104, v103
    s_nop 0
    v_readfirstlane_b32 s92, v104
    v_readfirstlane_b32 s93, v105
    s_andn2_b32 s46, 0x7ff, s92
    s_andn2_b32 s47, 0x7ff, s93
    s_mul_i32 s44, s46, 2304
    s_mul_i32 s45, s47, 2304
    s_sub_u32 s45, s45, s44
    v_mad_i32_i24 v10, v10, s45, v9
    v_add_u32 v10, s44, v10
    s_mov_b32 s45, 2621440
    s_mov_b32 s48, 16384
Ltail_pollh:
    s_mov_b32 exec_lo, 0x30003
    s_mov_b32 exec_hi, 0x30003
    buffer_load_dwordx4 a[120:123], v10, s[24:27], s45 offen offset:0 sc1
    buffer_load_dwordx4 a[124:127], v10, s[24:27], s45 offen offset:64 sc1
    buffer_load_dwordx4 a[128:131], v10, s[24:27], s45 offen offset:128 sc1
    buffer_load_dwordx4 a[132:135], v10, s[24:27], s45 offen offset:192 sc1
    buffer_load_dwordx4 a[136:139], v10, s[24:27], s45 offen offset:256 sc1
    buffer_load_dwordx4 a[140:143], v10, s[24:27], s45 offen offset:320 sc1
    buffer_load_dwordx4 a[144:147], v10, s[24:27], s45 offen offset:384 sc1
    buffer_load_dwordx4 a[148:151], v10, s[24:27], s45 offen offset:448 sc1
    buffer_load_dwordx4 a[152:155], v10, s[24:27], s45 offen offset:512 sc1
    buffer_load_dwordx4 a[156:159], v10, s[24:27], s45 offen offset:576 sc1
Ltour13:
    s_cbranch_execz Ltour17
    buffer_load_dwordx4 a[160:163], v10, s[24:27], s45 offen offset:640 sc1
    buffer_load_dwordx4 a[164:167], v10, s[24:27], s45 offen offset:704 sc1
    buffer_load_dwordx4 a[168:171], v10, s[24:27], s45 offen offset:768 sc1
    buffer_load_dwordx4 a[172:175], v10, s[24:27], s45 offen offset:832 sc1
    buffer_load_dwordx4 a[176:179], v10, s[24:27], s45 offen offset:896 sc1
    buffer_load_dwordx4 a[180:183], v10, s[24:27], s45 offen offset:960 sc1
    buffer_load_dwordx4 a[184:187], v10, s[24:27], s45 offen offset:1024 sc1
    buffer_load_dwordx4 a[188:191], v10, s[24:27], s45 offen offset:1088 sc1
    s_mov_b64 exec, -1
    ds_read_b64_tr_b16 a[72:73], v12 offset:0
    ds_read_b64_tr_b16 a[74:75], v12 offset:18432
    ds_read_b64_tr_b16 a[76:77], v12 offset:32
    ds_read_b64_tr_b16 a[78:79], v12 offset:18464
    ds_read_b64_tr_b16 a[80:81], v12 offset:64
    ds_read_b64_tr_b16 a[82:83], v12 offset:18496
    ds_read_b64_tr_b16 a[84:85], v12 offset:96
    ds_read_b64_tr_b16 a[86:87], v12 offset:18528
    ds_read_b64_tr_b16 a[88:89], v12 offset:512
    ds_read_b64_tr_b16 a[90:91], v12 offset:18944
    ds_read_b64_tr_b16 a[92:93], v12 offset:544
    ds_read_b64_tr_b16 a[94:95], v12 offset:18976
    ds_read_b64_tr_b16 a[96:97], v12 offset:576
    ds_read_b64_tr_b16 a[98:99], v12 offset:19008
    ds_read_b64_tr_b16 a[100:101], v12 offset:608
    ds_read_b64_tr_b16 a[102:103], v12 offset:19040
    ds_read_b64_tr_b16 a[104:105], v12 offset:1024
    ds_read_b64_tr_b16 a[106:107], v12 offset:19456
    ds_read_b64_tr_b16 a[108:109], v12 offset:1056
    ds_read_b64_tr_b16 a[110:111], v12 offset:19488
    ds_read_b64_tr_b16 a[112:113], v12 offset:1088
    ds_read_b64_tr_b16 a[114:115], v12 offset:19520
    ds_read_b64_tr_b16 a[116:117], v12 offset:1120
    ds_read_b64_tr_b16 a[118:119], v12 offset:19552
    s_waitcnt vmcnt(17)
    v_mfma_f32_16x16x32_bf16 v[16:19], a[0:3], a[120:123], 0
    s_waitcnt vmcnt(16)
    v_mfma_f32_16x16x32_bf16 v[20:23], a[4:7], a[124:127], 0
    s_waitcnt vmcnt(15)
    v_mfma_f32_16x16x32_bf16 v[16:19], a[8:11], a[128:131], v[16:19]
    s_waitcnt vmcnt(14)
    v_mfma_f32_16x16x32_bf16 v[20:23], a[12:15], a[132:135], v[20:23]
    s_waitcnt vmcnt(13)
    v_mfma_f32_16x16x32_bf16 v[16:19], a[16:19], a[136:139], v[16:19]
    s_waitcnt vmcnt(12)
    v_mfma_f32_16x16x32_bf16 v[20:23], a[20:23], a[140:143], v[20:23]
    s_waitcnt vmcnt(11)
    v_mfma_f32_16x16x32_bf16 v[16:19], a[24:27], a[144:147], v[16:19]
    s_waitcnt vmcnt(10)
    v_mfma_f32_16x16x32_bf16 v[20:23], a[28:31], a[148:151], v[20:23]
    s_waitcnt vmcnt(9)
    v_mfma_f32_16x16x32_bf16 v[16:19], a[32:35], a[152:155], v[16:19]
    s_waitcnt vmcnt(8)
    v_mfma_f32_16x16x32_bf16 v[20:23], a[36:39], a[156:159], v[20:23]
    s_waitcnt vmcnt(7)
    v_mfma_f32_16x16x32_bf16 v[16:19], a[40:43], a[160:163], v[16:19]
    s_waitcnt vmcnt(6)
    v_mfma_f32_16x16x32_bf16 v[20:23], a[44:47], a[164:167], v[20:23]
    s_waitcnt vmcnt(5)
    v_mfma_f32_16x16x32_bf16 v[16:19], a[48:51], a[168:171], v[16:19]
    s_waitcnt vmcnt(4)
    v_mfma_f32_16x16x32_bf16 v[20:23], a[52:55], a[172:175], v[20:23]
    s_waitcnt vmcnt(3)
    v_mfma_f32_16x16x32_bf16 v[16:19], a[56:59], a[176:179], v[16:19]
    s_waitcnt vmcnt(2)
    v_mfma_f32_16x16x32_bf16 v[20:23], a[60:63], a[180:183], v[20:23]
    s_waitcnt vmcnt(1)
    v_mfma_f32_16x16x32_bf16 v[16:19], a[64:67], a[184:187], v[16:19]
    s_waitcnt vmcnt(0)
    v_mfma_f32_16x16x32_bf16 v[20:23], a[68:71], a[188:191], v[20:23]
    s_sub_u32 s48, s48, 1
    s_nop 6
    v_pk_add_f32 v[16:17], v[16:17], v[20:21]
    v_pk_add_f32 v[18:19], v[18:19], v[22:23]
    s_cbranch_scc1 Ltail_goth
    v_cmp_u_f32 vcc, v16, v16
    s_and_b32 s36, vcc_lo, 3
    s_cbranch_scc1 Ltail_pollh
Ltail_goth:
    ds_write_b128 v14, v[16:19]
    s_waitcnt lgkmcnt(0)
    s_barrier
    ds_read_b128 v[16:19], v13 offset:0
    ds_read_b128 v[20:23], v13 offset:1024
    ds_read_b128 v[24:27], v13 offset:2048
    ds_read_b128 v[28:31], v13 offset:3072
    s_mov_b32 s36, 0xbfb8aa3b
    s_mov_b32 s37, 0xbfb8aa3b
    s_waitcnt lgkmcnt(3)
    v_cvt_pk_bf16_f32 v32, v16, v17
    v_cvt_pk_bf16_f32 v33, v18, v19
    s_waitcnt lgkmcnt(2)
    v_cvt_pk_bf16_f32 v34, v20, v21
    v_cvt_pk_bf16_f32 v35, v22, v23
    v_lshlrev_b32 v16, 16, v32
    v_and_b32 v17, 0xffff0000, v32
    v_lshlrev_b32 v18, 16, v33
    v_and_b32 v19, 0xffff0000, v33
    v_lshlrev_b32 v20, 16, v34
    v_and_b32 v21, 0xffff0000, v34
    v_lshlrev_b32 v22, 16, v35
    v_and_b32 v23, 0xffff0000, v35
    v_pk_mul_f32 v[32:33], v[16:17], s[36:37]
    v_pk_mul_f32 v[34:35], v[18:19], s[36:37]
    v_pk_mul_f32 v[36:37], v[20:21], s[36:37]
    v_pk_mul_f32 v[38:39], v[22:23], s[36:37]
    v_exp_f32 v32, v32
    v_exp_f32 v33, v33
    v_exp_f32 v34, v34
    v_exp_f32 v35, v35
    v_exp_f32 v36, v36
    v_exp_f32 v37, v37
    v_exp_f32 v38, v38
    v_exp_f32 v39, v39
    s_waitcnt lgkmcnt(1)
    v_cvt_pk_bf16_f32 v60, v24, v25
    v_cvt_pk_bf16_f32 v61, v26, v27
    s_waitcnt lgkmcnt(0)
    v_cvt_pk_bf16_f32 v62, v28, v29
    v_cvt_pk_bf16_f32 v63, v30, v31
    v_pk_add_f32 v[32:33], v[32:33], 1.0 op_sel_hi:[1,0]
    v_pk_add_f32 v[34:35], v[34:35], 1.0 op_sel_hi:[1,0]
    v_pk_add_f32 v[36:37], v[36:37], 1.0 op_sel_hi:[1,0]
    v_pk_add_f32 v[38:39], v[38:39], 1.0 op_sel_hi:[1,0]
    v_rcp_f32 v32, v32
    v_rcp_f32 v33, v33
    v_rcp_f32 v34, v34
    v_rcp_f32 v35, v35
    v_rcp_f32 v36, v36
    v_rcp_f32 v37, v37
    v_rcp_f32 v38, v38
    v_rcp_f32 v39, v39
    v_lshlrev_b32 v24, 16, v60
    v_and_b32 v25, 0xffff0000, v60
    v_lshlrev_b32 v26, 16, v61
    v_and_b32 v27, 0xffff0000, v61
    v_lshlrev_b32 v28, 16, v62
    v_and_b32 v29, 0xffff0000, v62
    v_lshlrev_b32 v30, 16, v63
    v_and_b32 v31, 0xffff0000, v63
    v_pk_mul_f32 v[16:17], v[16:17], v[32:33]
    v_pk_mul_f32 v[18:19], v[18:19], v[34:35]
    v_pk_mul_f32 v[20:21], v[20:21], v[36:37]
    v_pk_mul_f32 v[22:23], v[22:23], v[38:39]
    v_cvt_pk_bf16_f32 v32, v16, v17
    v_cvt_pk_bf16_f32 v33, v18, v19
    v_cvt_pk_bf16_f32 v34, v20, v21
    v_cvt_pk_bf16_f32 v35, v22, v23
    v_lshlrev_b32 v16, 16, v32
    v_and_b32 v17, 0xffff0000, v32
    v_lshlrev_b32 v18, 16, v33
    v_and_b32 v19, 0xffff0000, v33
    v_lshlrev_b32 v20, 16, v34
    v_and_b32 v21, 0xffff0000, v34
    v_lshlrev_b32 v22, 16, v35
    v_and_b32 v23, 0xffff0000, v35
    v_pk_mul_f32 v[16:17], v[16:17], v[24:25]
    v_pk_mul_f32 v[18:19], v[18:19], v[26:27]
    v_pk_mul_f32 v[20:21], v[20:21], v[28:29]
    v_pk_mul_f32 v[22:23], v[22:23], v[30:31]
    v_cvt_pk_bf16_f32 v32, v16, v17
    v_cvt_pk_bf16_f32 v33, v18, v19
    v_cvt_pk_bf16_f32 v34, v20, v21
    v_cvt_pk_bf16_f32 v35, v22, v23
    v_cndmask_b32 v64, 0, v32, s[52:53]
    v_cndmask_b32 v65, 0, v33, s[52:53]
    v_cndmask_b32 v66, 0, v34, s[52:53]
    v_cndmask_b32 v67, 0, v35, s[52:53]
    v_cndmask_b32 v68, 0, v32, s[54:55]
    v_cndmask_b32 v69, 0, v33, s[54:55]
    v_cndmask_b32 v70, 0, v34, s[54:55]
    v_cndmask_b32 v71, 0, v35, s[54:55]
    v_cndmask_b32 v72, 0, v32, s[56:57]
    v_cndmask_b32 v73, 0, v33, s[56:57]
    v_cndmask_b32 v74, 0, v34, s[56:57]
    v_cndmask_b32 v75, 0, v35, s[56:57]
    v_cndmask_b32 v76, 0, v32, s[58:59]
    v_cndmask_b32 v77, 0, v33, s[58:59]
    v_cndmask_b32 v78, 0, v34, s[58:59]
    v_cndmask_b32 v79, 0, v35, s[58:59]
    v_mfma_f32_16x16x32_bf16 v[16:19], v[64:67], a[72:75], 0
    v_mfma_f32_16x16x32_bf16 v[16:19], v[68:71], a[76:79], v[16:19]
    v_mfma_f32_16x16x32_bf16 v[16:19], v[72:75], a[80:83], v[16:19]
    v_mfma_f32_16x16x32_bf16 v[16:19], v[76:79], a[84:87], v[16:19]
    v_mfma_f32_16x16x32_bf16 v[20:23], v[64:67], a[88:91], 0
    v_mfma_f32_16x16x32_bf16 v[20:23], v[68:71], a[92:95], v[20:23]
    v_mfma_f32_16x16x32_bf16 v[20:23], v[72:75], a[96:99], v[20:23]
    v_mfma_f32_16x16x32_bf16 v[20:23], v[76:79], a[100:103], v[20:23]
    v_mfma_f32_16x16x32_bf16 v[24:27], v[64:67], a[104:107], 0
    v_mfma_f32_16x16x32_bf16 v[24:27], v[68:71], a[108:111], v[24:27]
    v_mfma_f32_16x16x32_bf16 v[24:27], v[72:75], a[112:115], v[24:27]
    v_mfma_f32_16x16x32_bf16 v[24:27], v[76:79], a[116:119], v[24:27]
    v_min_u32 v16, -2, v16
    v_min_u32 v17, -2, v17
    buffer_store_dwordx2 v[16:17], v15, s[8:11], s43 offen sc1
    s_add_u32 s43, s43, 294912
    v_min_u32 v20, -2, v20
    v_min_u32 v21, -2, v21
    buffer_store_dwordx2 v[20:21], v15, s[8:11], s43 offen sc1
    s_add_u32 s43, s43, 294912
    v_min_u32 v24, -2, v24
    v_min_u32 v25, -2, v25
    buffer_store_dwordx2 v[24:25], v15, s[8:11], s43 offen sc1
    s_or_b32 s36, s2, s3
    s_cselect_b32 s37, -4, 24576
    s_add_u32 s36, s94, 1
    v_mov_b32 v106, s36
    buffer_store_dword v106, v8, s[24:27], s37 offen sc1
    v_cmp_ne_u32 vcc, s46, v7
    v_cmp_ne_u32 s[36:37], s47, v7
    v_mov_b32 v31, 2147483648
    s_and_b64 vcc, vcc, s[36:37]
    s_nop 1
    v_cndmask_b32 v30, v31, v58, vcc
    v_cndmask_b32 v31, v31, v4, vcc
    buffer_store_dwordx4 v[144:147], v31, s[16:19], 0 offen offset:0 nt
    buffer_store_dwordx4 v[148:151], v31, s[16:19], 0 offen offset:512 nt
    buffer_store_dwordx4 v[152:155], v30, s[16:19], 0 offen offset:1024 nt
    s_cmp_lt_u32 s41, 9
    s_cselect_b32 s36, s3, 0
    s_cmp_lg_u32 s36, 3
    s_cbranch_scc1 Ltail_done
    s_mul_i32 s43, s42, 9
    s_add_u32 s43, s43, s41
    v_bfe_u32 v8, v1, 2, 1
    v_cmp_eq_u32 vcc, 1, v8
    v_mov_b32 v9, s46
    v_mov_b32 v10, s47
    v_and_b32 v11, 3, v1
    v_cndmask_b32 v9, v9, v10, vcc
    s_lshr_b32 s44, s43, 2
    s_lshl_b32 s44, s44, 6
    s_and_b32 s45, s43, 1
    s_lshl_b32 s45, s45, 5
    s_add_u32 s44, s44, s45
    s_and_b32 s45, s43, 2
    s_lshl_b32 s45, s45, 2
    s_add_u32 s44, s44, s45
    v_lshrrev_b32 v12, 1, v11
    v_lshl_add_u32 v12, v12, 4, s44
    v_and_b32 v13, 1, v11
    v_lshl_add_u32 v12, v13, 2, v12
    v_mul_u32_u24 v13, 1152, v9
    v_lshl_add_u32 v14, v13, 1, v12
    v_add_u32 v15, 2621440, v14
    s_mov_b32 s45, 22144
    buffer_load_dword v18, v12, s[24:27], s45 offen sc1
    v_mov_b32 v19, s92
    v_mov_b32 v10, s93
    v_cndmask_b32 v19, v19, v10, vcc
    v_and_b32 v19, 0xfffff800, v19
    v_or_b32 v19, 0x400, v19
    v_ashrrev_i32 v10, 31, v19
    v_not_b32 v10, v10
    v_or_b32 v10, 0x80000000, v10
    v_xor_b32 v19, v19, v10
    s_lshl_b32 s45, s43, 4
    v_lshl_add_u32 v13, v11, 2, v13
    v_add_u32 v13, s45, v13
    v_lshrrev_b32 v14, 2, v1
    v_lshlrev_b32 v14, 9, v14
    v_lshl_add_u32 v14, v11, 4, v14
    s_lshr_b32 s44, s43, 3
    s_mul_i32 s44, s44, 73728
    s_and_b32 s45, s43, 7
    s_lshl_b32 s45, s45, 6
    s_add_u32 s44, s44, s45
    v_cmp_eq_u32 s[38:39], 1, v8
    v_cvt_pk_bf16_f32 v19, v19, v19
    v_and_b32 v19, 0xffff0000, v19
    v_mul_f32 v19, 0xbfb8aa3b, v19
    v_exp_f32 v19, v19
    s_waitcnt vmcnt(0)
    v_lshlrev_b32 v24, 16, v18
    v_and_b32 v25, 0xffff0000, v18
    v_add_f32 v19, 1.0, v19
    v_rcp_f32 v19, v19
    s_mov_b32 s48, 16384
    v_cvt_pk_bf16_f32 v19, v19, v19
    v_and_b32 v19, 0xffff0000, v19
Ltail_polly:
    s_add_u32 s45, s44, 0
    buffer_load_dwordx4 v[64:67], v14, s[8:11], s45 offen sc1
    s_add_u32 s45, s44, 8192
    buffer_load_dwordx4 v[68:71], v14, s[8:11], s45 offen sc1
    s_add_u32 s45, s44, 16384
    buffer_load_dwordx4 v[72:75], v14, s[8:11], s45 offen sc1
    s_add_u32 s45, s44, 24576
    buffer_load_dwordx4 v[76:79], v14, s[8:11], s45 offen sc1
    s_add_u32 s45, s44, 32768
    buffer_load_dwordx4 v[80:83], v14, s[8:11], s45 offen sc1
    s_add_u32 s45, s44, 40960
    buffer_load_dwordx4 v[84:87], v14, s[8:11], s45 offen sc1
    s_add_u32 s45, s44, 49152
    buffer_load_dwordx4 v[88:91], v14, s[8:11], s45 offen sc1
    s_add_u32 s45, s44, 57344
    buffer_load_dwordx4 v[92:95], v14, s[8:11], s45 offen sc1
    s_add_u32 s45, s44, 65536
    buffer_load_dwordx4 v[96:99], v14, s[8:11], s45 offen sc1
    s_mov_b32 s45, 1152
    buffer_load_dword v16, v15, s[24:27], s45 offen sc1
    buffer_load_dword v17, v15, s[24:27], 0 offen sc1
    s_sub_u32 s48, s48, 1
    s_cbranch_scc1 Ltail_goty
    s_waitcnt vmcnt(10)
    v_max3_u32 v26, v64, v65, v66
    s_waitcnt vmcnt(9)
    v_max3_u32 v26, v26, v67, v68
    v_max3_u32 v26, v26, v69, v70
    s_waitcnt vmcnt(8)
    v_max3_u32 v26, v26, v71, v72
    v_max3_u32 v26, v26, v73, v74
    s_waitcnt vmcnt(7)
    v_max3_u32 v26, v26, v75, v76
    v_max3_u32 v26, v26, v77, v78
    s_waitcnt vmcnt(6)
    v_max3_u32 v26, v26, v79, v80
    v_max3_u32 v26, v26, v81, v82
    s_waitcnt vmcnt(5)
    v_max3_u32 v26, v26, v83, v84
    v_max3_u32 v26, v26, v85, v86
    s_waitcnt vmcnt(4)
    v_max3_u32 v26, v26, v87, v88
    v_max3_u32 v26, v26, v89, v90
    s_waitcnt vmcnt(3)
    v_max3_u32 v26, v26, v91, v92
    v_max3_u32 v26, v26, v93, v94
    s_waitcnt vmcnt(2)
    v_max3_u32 v26, v26, v95, v96
    v_max3_u32 v26, v26, v97, v98
    v_max_u32 v26, v26, v99
    s_waitcnt vmcnt(0)
    v_max3_u32 v26, v26, v16, v17
    v_cmp_eq_u32 vcc, -1, v26
    s_cbranch_vccnz Ltail_polly
Ltail_goty:
    s_waitcnt vmcnt(0) lgkmcnt(0)
    v_lshlrev_b32 v20, 16, v16
    v_and_b32 v21, 0xffff0000, v16
    v_lshlrev_b32 v22, 16, v17
    v_and_b32 v23, 0xffff0000, v17
    v_pk_add_f32 v[64:65], v[64:65], v[68:69]
    v_pk_add_f32 v[66:67], v[66:67], v[70:71]
    v_pk_add_f32 v[64:65], v[64:65], v[72:73]
    v_pk_add_f32 v[66:67], v[66:67], v[74:75]
    v_pk_add_f32 v[64:65], v[64:65], v[76:77]
    v_pk_add_f32 v[66:67], v[66:67], v[78:79]
    v_pk_add_f32 v[64:65], v[64:65], v[80:81]
    v_pk_add_f32 v[66:67], v[66:67], v[82:83]
    v_pk_add_f32 v[64:65], v[64:65], v[84:85]
    v_pk_add_f32 v[66:67], v[66:67], v[86:87]
    v_pk_add_f32 v[64:65], v[64:65], v[88:89]
    v_pk_add_f32 v[66:67], v[66:67], v[90:91]
    v_pk_add_f32 v[64:65], v[64:65], v[92:93]
    v_pk_add_f32 v[66:67], v[66:67], v[94:95]
    v_pk_add_f32 v[64:65], v[64:65], v[96:97]
    v_pk_add_f32 v[66:67], v[66:67], v[98:99]
    s_nop 0
    v_add_f32_dpp v64, v64, v64 row_ror:4 row_mask:0xf bank_mask:0xf
    v_add_f32_dpp v65, v65, v65 row_ror:4 row_mask:0xf bank_mask:0xf
    v_add_f32_dpp v66, v66, v66 row_ror:4 row_mask:0xf bank_mask:0xf
    v_add_f32_dpp v67, v67, v67 row_ror:4 row_mask:0xf bank_mask:0xf
    v_add_f32_dpp v64, v64, v64 row_ror:8 row_mask:0xf bank_mask:0xf
    v_add_f32_dpp v65, v65, v65 row_ror:8 row_mask:0xf bank_mask:0xf
    v_add_f32_dpp v66, v66, v66 row_ror:8 row_mask:0xf bank_mask:0xf
    v_add_f32_dpp v67, v67, v67 row_ror:8 row_mask:0xf bank_mask:0xf
    v_mov_b32 v68, v64
    v_mov_b32 v69, v65
    v_mov_b32 v70, v66
    v_mov_b32 v71, v67
    v_permlane16_swap_b32 v64, v68
    v_permlane16_swap_b32 v65, v69
    v_permlane16_swap_b32 v66, v70
    v_permlane16_swap_b32 v67, v71
    v_add_f32 v64, v64, v68
    v_add_f32 v65, v65, v69
    v_add_f32 v66, v66, v70
    v_add_f32 v67, v67, v71
    v_mov_b32 v68, v64
    v_mov_b32 v69, v65
    v_mov_b32 v70, v66
    v_mov_b32 v71, v67
    v_permlane32_swap_b32 v64, v68
    v_permlane32_swap_b32 v65, v69
    v_permlane32_swap_b32 v66, v70
    v_permlane32_swap_b32 v67, v71
    v_add_f32 v64, v64, v68
    v_add_f32 v65, v65, v69
    v_add_f32 v66, v66, v70
    v_add_f32 v67, v67, v71
    v_cndmask_b32 v26, v64, v65, s[38:39]
    v_cndmask_b32 v27, v66, v67, s[38:39]
    v_cvt_pk_bf16_f32 v28, v26, v27
    v_lshlrev_b32 v26, 16, v28
    v_and_b32 v27, 0xffff0000, v28
    v_mul_f32 v26, v26, v19
    v_mul_f32 v27, v27, v19
    v_cvt_pk_bf16_f32 v28, v26, v27
    v_lshlrev_b32 v26, 16, v28
    v_and_b32 v27, 0xffff0000, v28
    v_pk_add_f32 v[26:27], v[26:27], v[22:23]
    v_cvt_pk_bf16_f32 v28, v26, v27
    v_lshlrev_b32 v26, 16, v28
    v_and_b32 v27, 0xffff0000, v28
    v_pk_mul_f32 v[26:27], v[26:27], v[24:25]
    v_cvt_pk_bf16_f32 v28, v26, v27
    v_lshlrev_b32 v26, 16, v28
    v_and_b32 v27, 0xffff0000, v28
    v_pk_add_f32 v[26:27], v[26:27], v[20:21]
    v_cvt_pk_bf16_f32 v28, v26, v27
    s_mov_b64 exec, 0xff
    buffer_store_dword v28, v13, s[16:19], 0 offen nt
    s_branch Ltail_done
Ltail_idle:
Ltour14:
    s_cbranch_execz Lmain
    v_lshlrev_b32 v216, 16, v64
    v_and_b32 v217, 0xffff0000, v64
    v_lshlrev_b32 v218, 16, v65
    v_and_b32 v219, 0xffff0000, v65
    v_lshlrev_b32 v220, 16, v66
    v_and_b32 v221, 0xffff0000, v66
    v_lshlrev_b32 v222, 16, v67
    v_and_b32 v223, 0xffff0000, v67
    v_lshlrev_b32 v224, 16, v68
    v_and_b32 v225, 0xffff0000, v68
    v_lshlrev_b32 v226, 16, v69
    v_and_b32 v227, 0xffff0000, v69
    v_lshlrev_b32 v228, 16, v70
    v_and_b32 v229, 0xffff0000, v70
    v_lshlrev_b32 v230, 16, v71
    v_and_b32 v231, 0xffff0000, v71
    v_lshlrev_b32 v232, 16, v72
    v_and_b32 v233, 0xffff0000, v72
    v_lshlrev_b32 v234, 16, v73
    v_and_b32 v235, 0xffff0000, v73
    v_lshlrev_b32 v236, 16, v74
    v_and_b32 v237, 0xffff0000, v74
    v_lshlrev_b32 v238, 16, v75
    v_and_b32 v239, 0xffff0000, v75
    v_pk_mul_f32 v[192:193], v[192:193], v[216:217]
    v_pk_mul_f32 v[194:195], v[194:195], v[218:219]
    v_pk_mul_f32 v[196:197], v[196:197], v[220:221]
    v_pk_mul_f32 v[198:199], v[198:199], v[222:223]
    v_pk_mul_f32 v[200:201], v[200:201], v[224:225]
    v_pk_mul_f32 v[202:203], v[202:203], v[226:227]
    v_pk_mul_f32 v[204:205], v[204:205], v[228:229]
    v_pk_mul_f32 v[206:207], v[206:207], v[230:231]
    v_pk_mul_f32 v[208:209], v[208:209], v[232:233]
    v_pk_mul_f32 v[210:211], v[210:211], v[234:235]
    v_pk_mul_f32 v[212:213], v[212:213], v[236:237]
    v_pk_mul_f32 v[214:215], v[214:215], v[238:239]
    v_cvt_pk_bf16_f32 v144, v192, v193
    v_cvt_pk_bf16_f32 v145, v194, v195
    v_cvt_pk_bf16_f32 v146, v196, v197
    v_cvt_pk_bf16_f32 v147, v198, v199
    v_cvt_pk_bf16_f32 v148, v200, v201
    v_cvt_pk_bf16_f32 v149, v202, v203
    v_cvt_pk_bf16_f32 v150, v204, v205
    v_cvt_pk_bf16_f32 v151, v206, v207
    v_cvt_pk_bf16_f32 v152, v208, v209
    v_cvt_pk_bf16_f32 v153, v210, v211
    v_cvt_pk_bf16_f32 v154, v212, v213
    v_cvt_pk_bf16_f32 v155, v214, v215
    v_lshlrev_b32 v192, 16, v144
    v_and_b32 v193, 0xffff0000, v144
    v_lshlrev_b32 v194, 16, v145
    v_and_b32 v195, 0xffff0000, v145
    v_lshlrev_b32 v196, 16, v146
    v_and_b32 v197, 0xffff0000, v146
    v_lshlrev_b32 v198, 16, v147
    v_and_b32 v199, 0xffff0000, v147
    v_lshlrev_b32 v200, 16, v148
    v_and_b32 v201, 0xffff0000, v148
    v_lshlrev_b32 v202, 16, v149
    v_and_b32 v203, 0xffff0000, v149
    v_lshlrev_b32 v204, 16, v150
    v_and_b32 v205, 0xffff0000, v150
    v_lshlrev_b32 v206, 16, v151
    v_and_b32 v207, 0xffff0000, v151
    v_lshlrev_b32 v208, 16, v152
    v_and_b32 v209, 0xffff0000, v152
    v_lshlrev_b32 v210, 16, v153
    v_and_b32 v211, 0xffff0000, v153
    v_lshlrev_b32 v212, 16, v154
    v_and_b32 v213, 0xffff0000, v154
    v_lshlrev_b32 v214, 16, v155
    v_and_b32 v215, 0xffff0000, v155
    v_pk_add_f32 v[192:193], v[192:193], v[12:13]
    v_pk_add_f32 v[194:195], v[194:195], v[14:15]
    v_pk_add_f32 v[196:197], v[196:197], v[16:17]
    v_pk_add_f32 v[198:199], v[198:199], v[18:19]
    v_pk_add_f32 v[200:201], v[200:201], v[20:21]
    v_pk_add_f32 v[202:203], v[202:203], v[22:23]
    v_pk_add_f32 v[204:205], v[204:205], v[24:25]
    v_pk_add_f32 v[206:207], v[206:207], v[26:27]
    v_pk_add_f32 v[208:209], v[208:209], v[28:29]
    v_pk_add_f32 v[210:211], v[210:211], v[30:31]
    v_pk_add_f32 v[212:213], v[212:213], v[32:33]
    v_pk_add_f32 v[214:215], v[214:215], v[34:35]
    v_cvt_pk_bf16_f32 v156, v192, v193
    v_cvt_pk_bf16_f32 v157, v194, v195
    v_cvt_pk_bf16_f32 v158, v196, v197
    v_cvt_pk_bf16_f32 v159, v198, v199
    v_cvt_pk_bf16_f32 v160, v200, v201
    v_cvt_pk_bf16_f32 v161, v202, v203
    v_cvt_pk_bf16_f32 v162, v204, v205
    v_cvt_pk_bf16_f32 v163, v206, v207
    v_cvt_pk_bf16_f32 v164, v208, v209
    v_cvt_pk_bf16_f32 v165, v210, v211
    v_cvt_pk_bf16_f32 v166, v212, v213
    v_cvt_pk_bf16_f32 v167, v214, v215
    v_and_b32 v30, 2, v1
    v_cmp_ne_u32 vcc, 0, v30
    v_mul_u32_u24 v30, 1152, v7
    v_add_u32 v4, v30, v5
    v_add_u32 v58, v30, v59
    v_mov_b32_dpp v192, v158 quad_perm:[0,2,0,2] row_mask:0xf bank_mask:0xf
    v_mov_b32_dpp v193, v159 quad_perm:[0,2,0,2] row_mask:0xf bank_mask:0xf
    v_mov_b32_dpp v194, v158 quad_perm:[1,3,1,3] row_mask:0xf bank_mask:0xf
    v_mov_b32_dpp v195, v159 quad_perm:[1,3,1,3] row_mask:0xf bank_mask:0xf
    v_mov_b32_dpp v196, v162 quad_perm:[0,2,0,2] row_mask:0xf bank_mask:0xf
    v_mov_b32_dpp v197, v163 quad_perm:[0,2,0,2] row_mask:0xf bank_mask:0xf
    v_mov_b32_dpp v198, v162 quad_perm:[1,3,1,3] row_mask:0xf bank_mask:0xf
    v_mov_b32_dpp v199, v163 quad_perm:[1,3,1,3] row_mask:0xf bank_mask:0xf
    v_mov_b32_dpp v200, v166 quad_perm:[0,2,0,2] row_mask:0xf bank_mask:0xf
    v_mov_b32_dpp v201, v167 quad_perm:[0,2,0,2] row_mask:0xf bank_mask:0xf
    v_mov_b32_dpp v202, v166 quad_perm:[1,3,1,3] row_mask:0xf bank_mask:0xf
    v_mov_b32_dpp v203, v167 quad_perm:[1,3,1,3] row_mask:0xf bank_mask:0xf
    v_cndmask_b32_dpp v144, v156, v192, vcc quad_perm:[0,2,0,2] row_mask:0xf bank_mask:0xf
    v_cndmask_b32_dpp v145, v157, v193, vcc quad_perm:[0,2,0,2] row_mask:0xf bank_mask:0xf
    v_cndmask_b32_dpp v146, v156, v194, vcc quad_perm:[1,3,1,3] row_mask:0xf bank_mask:0xf
    v_cndmask_b32_dpp v147, v157, v195, vcc quad_perm:[1,3,1,3] row_mask:0xf bank_mask:0xf
    v_cndmask_b32_dpp v148, v160, v196, vcc quad_perm:[0,2,0,2] row_mask:0xf bank_mask:0xf
    v_cndmask_b32_dpp v149, v161, v197, vcc quad_perm:[0,2,0,2] row_mask:0xf bank_mask:0xf
    v_cndmask_b32_dpp v150, v160, v198, vcc quad_perm:[1,3,1,3] row_mask:0xf bank_mask:0xf
    v_cndmask_b32_dpp v151, v161, v199, vcc quad_perm:[1,3,1,3] row_mask:0xf bank_mask:0xf
    v_cndmask_b32_dpp v152, v164, v200, vcc quad_perm:[0,2,0,2] row_mask:0xf bank_mask:0xf
    v_cndmask_b32_dpp v153, v165, v201, vcc quad_perm:[0,2,0,2] row_mask:0xf bank_mask:0xf
    v_cndmask_b32_dpp v154, v164, v202, vcc quad_perm:[1,3,1,3] row_mask:0xf bank_mask:0xf
    v_cndmask_b32_dpp v155, v165, v203, vcc quad_perm:[1,3,1,3] row_mask:0xf bank_mask:0xf
    buffer_store_dwordx4 v[144:147], v4, s[16:19], 0 offen offset:0 sc1
    buffer_store_dwordx4 v[148:151], v4, s[16:19], 0 offen offset:512 sc1
    buffer_store_dwordx4 v[152:155], v58, s[16:19], 0 offen offset:1024 sc1
    s_waitcnt vmcnt(0)
    s_mov_b32 s36, 2622592
    buffer_store_dwordx4 v[36:39], v6, s[24:27], s36 offen offset:0 sc1
    buffer_store_dwordx4 v[40:43], v6, s[24:27], s36 offen offset:512 sc1
    buffer_store_dwordx4 v[44:47], v60, s[24:27], s36 offen offset:1024 sc1
Ltail_done:
    s_endpgm
Lattn_wb:
    buffer_wbl2 sc1
    s_waitcnt vmcnt(0)
    s_branch Lattn_wbdone
Lattn_xspin:
Ltour15:
    s_cbranch_execz Lmain
    s_mov_b32 s37, 16384
Lattn_xloop:
    buffer_load_dword v11, v8, s[24:27], s54 offen offset:8 sc1
    s_waitcnt vmcnt(0)
    v_readfirstlane_b32 s36, v11
    s_sub_u32 s37, s37, 1
    s_cbranch_scc1 Lattn_xgot
    s_cmp_lg_u32 s36, s95
    s_cbranch_scc1 Lattn_xloop
    s_branch Lattn_xgot
Ltail_spin1:
Ltour16:
    s_cbranch_execz Lmain
    s_mov_b32 s48, 16384
Ltail_spinl1:
    buffer_load_dword v11, v9, s[24:27], s39 offen sc1
    s_waitcnt vmcnt(0)
    v_cmp_ne_u32 s[54:55], s95, v11
    s_sub_u32 s48, s48, 1
    s_cbranch_scc1 Ltail_got1
    s_cmp_lg_u64 s[54:55], 0
    s_cbranch_scc1 Ltail_spinl1
    s_branch Ltail_got1
Ltail_spin2:
Ltour17:
    s_cbranch_execz Lmain
    s_mov_b32 s48, 16384
Ltail_spinl2:
    buffer_load_dword v11, v9, s[24:27], s39 offen sc1
    s_waitcnt vmcnt(0)
    v_cmp_ne_u32 s[54:55], s95, v11
    s_sub_u32 s48, s48, 1
    s_cbranch_scc1 Ltail_got2
    s_cmp_lg_u64 s[54:55], 0
    s_cbranch_scc1 Ltail_spinl2
    s_branch Ltail_got2
Lattn_redo:
    v_xor_b32 v8, 64, v9
    v_xor_b32 v10, 64, v11
    s_waitcnt vmcnt(0) lgkmcnt(0)
    s_barrier
    v_mov_b32 v232, 0xff800000
    v_mov_b32 v233, 0xff800000
    v_mov_b32 v234, 0xff800000
    v_mov_b32 v235, 0xff800000
    s_mov_b32 s40, 0
    s_mov_b32 s48, -1
Lattn_redo_loop:
    s_add_u32 m0, s42, 0
    s_nop 0
    buffer_load_dwordx4 v36, s[8:11], s40 offen lds
    buffer_load_dwordx4 v37, s[8:11], s40 offen offset:1024 lds
    buffer_load_dwordx4 v38, s[8:11], s40 offen offset:2048 lds
    buffer_load_dwordx4 v39, s[8:11], s40 offen offset:3072 lds
    s_add_u32 s40, s40, 16384
    s_waitcnt vmcnt(0) lgkmcnt(0)
    s_barrier
    ds_read_b128 a[208:211], v8 offset:0
    ds_read_b128 a[212:215], v9 offset:0
    ds_read_b128 a[216:219], v10 offset:0
    ds_read_b128 a[220:223], v11 offset:0
    s_waitcnt lgkmcnt(3)
    v_mfma_f32_16x16x32_bf16 v[216:219], a[208:211], v[64:67], 0
    s_waitcnt lgkmcnt(2)
    v_mfma_f32_16x16x32_bf16 v[216:219], a[212:215], v[68:71], v[216:219]
    s_waitcnt lgkmcnt(1)
    v_mfma_f32_16x16x32_bf16 v[216:219], a[216:219], v[72:75], v[216:219]
    s_waitcnt lgkmcnt(0)
    v_mfma_f32_16x16x32_bf16 v[216:219], a[220:223], v[76:79], v[216:219]
    v_mfma_f32_16x16x32_bf16 v[220:223], a[208:211], v[80:83], 0
    v_mfma_f32_16x16x32_bf16 v[220:223], a[212:215], v[84:87], v[220:223]
    v_mfma_f32_16x16x32_bf16 v[220:223], a[216:219], v[88:91], v[220:223]
    v_mfma_f32_16x16x32_bf16 v[220:223], a[220:223], v[92:95], v[220:223]
    v_mfma_f32_16x16x32_bf16 v[224:227], a[208:211], v[96:99], 0
    v_mfma_f32_16x16x32_bf16 v[224:227], a[212:215], v[100:103], v[224:227]
    v_mfma_f32_16x16x32_bf16 v[224:227], a[216:219], v[104:107], v[224:227]
    v_mfma_f32_16x16x32_bf16 v[224:227], a[220:223], v[108:111], v[224:227]
    v_mfma_f32_16x16x32_bf16 v[228:231], a[208:211], v[112:115], 0
    v_mfma_f32_16x16x32_bf16 v[228:231], a[212:215], v[116:119], v[228:231]
    v_mfma_f32_16x16x32_bf16 v[228:231], a[216:219], v[120:123], v[228:231]
    v_mfma_f32_16x16x32_bf16 v[228:231], a[220:223], v[124:127], v[228:231]
    v_max3_f32 v232, v232, v216, v217
    v_max3_f32 v232, v232, v218, v219
    v_max3_f32 v233, v233, v220, v221
    v_max3_f32 v233, v233, v222, v223
    v_max3_f32 v234, v234, v224, v225
    v_max3_f32 v234, v234, v226, v227
    s_nop 1
    v_max3_f32 v235, v235, v228, v229
    v_max3_f32 v235, v235, v230, v231
    ds_read_b128 a[224:227], v8 offset:4096
    ds_read_b128 a[228:231], v9 offset:4096
    ds_read_b128 a[232:235], v10 offset:4096
    ds_read_b128 a[236:239], v11 offset:4096
    s_waitcnt lgkmcnt(3)
    v_mfma_f32_16x16x32_bf16 v[216:219], a[224:227], v[64:67], 0
    s_waitcnt lgkmcnt(2)
    v_mfma_f32_16x16x32_bf16 v[216:219], a[228:231], v[68:71], v[216:219]
    s_waitcnt lgkmcnt(1)
    v_mfma_f32_16x16x32_bf16 v[216:219], a[232:235], v[72:75], v[216:219]
    s_waitcnt lgkmcnt(0)
    v_mfma_f32_16x16x32_bf16 v[216:219], a[236:239], v[76:79], v[216:219]
    v_mfma_f32_16x16x32_bf16 v[220:223], a[224:227], v[80:83], 0
    v_mfma_f32_16x16x32_bf16 v[220:223], a[228:231], v[84:87], v[220:223]
    v_mfma_f32_16x16x32_bf16 v[220:223], a[232:235], v[88:91], v[220:223]
    v_mfma_f32_16x16x32_bf16 v[220:223], a[236:239], v[92:95], v[220:223]
    v_mfma_f32_16x16x32_bf16 v[224:227], a[224:227], v[96:99], 0
    v_mfma_f32_16x16x32_bf16 v[224:227], a[228:231], v[100:103], v[224:227]
    v_mfma_f32_16x16x32_bf16 v[224:227], a[232:235], v[104:107], v[224:227]
    v_mfma_f32_16x16x32_bf16 v[224:227], a[236:239], v[108:111], v[224:227]
    v_mfma_f32_16x16x32_bf16 v[228:231], a[224:227], v[112:115], 0
    v_mfma_f32_16x16x32_bf16 v[228:231], a[228:231], v[116:119], v[228:231]
    v_mfma_f32_16x16x32_bf16 v[228:231], a[232:235], v[120:123], v[228:231]
    v_mfma_f32_16x16x32_bf16 v[228:231], a[236:239], v[124:127], v[228:231]
    v_max3_f32 v232, v232, v216, v217
    v_max3_f32 v232, v232, v218, v219
    v_max3_f32 v233, v233, v220, v221
    v_max3_f32 v233, v233, v222, v223
    v_max3_f32 v234, v234, v224, v225
    v_max3_f32 v234, v234, v226, v227
    s_nop 1
    v_max3_f32 v235, v235, v228, v229
    v_max3_f32 v235, v235, v230, v231
    ds_read_b128 a[208:211], v8 offset:8192
    ds_read_b128 a[212:215], v9 offset:8192
    ds_read_b128 a[216:219], v10 offset:8192
    ds_read_b128 a[220:223], v11 offset:8192
    s_waitcnt lgkmcnt(3)
    v_mfma_f32_16x16x32_bf16 v[216:219], a[208:211], v[64:67], 0
    s_waitcnt lgkmcnt(2)
    v_mfma_f32_16x16x32_bf16 v[216:219], a[212:215], v[68:71], v[216:219]
    s_waitcnt lgkmcnt(1)
    v_mfma_f32_16x16x32_bf16 v[216:219], a[216:219], v[72:75], v[216:219]
    s_waitcnt lgkmcnt(0)
    v_mfma_f32_16x16x32_bf16 v[216:219], a[220:223], v[76:79], v[216:219]
    v_mfma_f32_16x16x32_bf16 v[220:223], a[208:211], v[80:83], 0
    v_mfma_f32_16x16x32_bf16 v[220:223], a[212:215], v[84:87], v[220:223]
    v_mfma_f32_16x16x32_bf16 v[220:223], a[216:219], v[88:91], v[220:223]
    v_mfma_f32_16x16x32_bf16 v[220:223], a[220:223], v[92:95], v[220:223]
    v_mfma_f32_16x16x32_bf16 v[224:227], a[208:211], v[96:99], 0
    v_mfma_f32_16x16x32_bf16 v[224:227], a[212:215], v[100:103], v[224:227]
    v_mfma_f32_16x16x32_bf16 v[224:227], a[216:219], v[104:107], v[224:227]
    v_mfma_f32_16x16x32_bf16 v[224:227], a[220:223], v[108:111], v[224:227]
    v_mfma_f32_16x16x32_bf16 v[228:231], a[208:211], v[112:115], 0
    v_mfma_f32_16x16x32_bf16 v[228:231], a[212:215], v[116:119], v[228:231]
    v_mfma_f32_16x16x32_bf16 v[228:231], a[216:219], v[120:123], v[228:231]
    v_mfma_f32_16x16x32_bf16 v[228:231], a[220:223], v[124:127], v[228:231]
    v_max3_f32 v232, v232, v216, v217
    v_max3_f32 v232, v232, v218, v219
    v_max3_f32 v233, v233, v220, v221
    v_max3_f32 v233, v233, v222, v223
    v_max3_f32 v234, v234, v224, v225
    v_max3_f32 v234, v234, v226, v227
    s_nop 1
    v_max3_f32 v235, v235, v228, v229
    v_max3_f32 v235, v235, v230, v231
    ds_read_b128 a[224:227], v8 offset:12288
    ds_read_b128 a[228:231], v9 offset:12288
    ds_read_b128 a[232:235], v10 offset:12288
    ds_read_b128 a[236:239], v11 offset:12288
    s_waitcnt lgkmcnt(3)
    v_mfma_f32_16x16x32_bf16 v[216:219], a[224:227], v[64:67], 0
    s_waitcnt lgkmcnt(2)
    v_mfma_f32_16x16x32_bf16 v[216:219], a[228:231], v[68:71], v[216:219]
    s_waitcnt lgkmcnt(1)
    v_mfma_f32_16x16x32_bf16 v[216:219], a[232:235], v[72:75], v[216:219]
    s_waitcnt lgkmcnt(0)
    v_mfma_f32_16x16x32_bf16 v[216:219], a[236:239], v[76:79], v[216:219]
    v_mfma_f32_16x16x32_bf16 v[220:223], a[224:227], v[80:83], 0
    v_mfma_f32_16x16x32_bf16 v[220:223], a[228:231], v[84:87], v[220:223]
    v_mfma_f32_16x16x32_bf16 v[220:223], a[232:235], v[88:91], v[220:223]
    v_mfma_f32_16x16x32_bf16 v[220:223], a[236:239], v[92:95], v[220:223]
    v_mfma_f32_16x16x32_bf16 v[224:227], a[224:227], v[96:99], 0
    v_mfma_f32_16x16x32_bf16 v[224:227], a[228:231], v[100:103], v[224:227]
    v_mfma_f32_16x16x32_bf16 v[224:227], a[232:235], v[104:107], v[224:227]
    v_mfma_f32_16x16x32_bf16 v[224:227], a[236:239], v[108:111], v[224:227]
    v_mfma_f32_16x16x32_bf16 v[228:231], a[224:227], v[112:115], 0
    v_mfma_f32_16x16x32_bf16 v[228:231], a[228:231], v[116:119], v[228:231]
    v_mfma_f32_16x16x32_bf16 v[228:231], a[232:235], v[120:123], v[228:231]
    v_mfma_f32_16x16x32_bf16 v[228:231], a[236:239], v[124:127], v[228:231]
    v_max3_f32 v232, v232, v216, v217
    v_max3_f32 v232, v232, v218, v219
    v_max3_f32 v233, v233, v220, v221
    v_max3_f32 v233, v233, v222, v223
    v_max3_f32 v234, v234, v224, v225
    v_max3_f32 v234, v234, v226, v227
    s_nop 1
    v_max3_f32 v235, v235, v228, v229
    v_max3_f32 v235, v235, v230, v231
    s_barrier
    s_cmp_lt_u32 s40, 524288
    s_cbranch_scc1 Lattn_redo_loop
    v_mov_b32 v236, v232
    v_mov_b32 v237, v233
    v_mov_b32 v238, v234
    v_mov_b32 v239, v235
    v_permlane16_swap_b32 v232, v236
    v_permlane16_swap_b32 v233, v237
    v_permlane16_swap_b32 v234, v238
    v_permlane16_swap_b32 v235, v239
    v_max_f32 v232, v232, v236
    v_max_f32 v233, v233, v237
    v_max_f32 v234, v234, v238
    v_max_f32 v235, v235, v239
    v_mov_b32 v236, v232
    v_mov_b32 v237, v233
    v_mov_b32 v238, v234
    v_mov_b32 v239, v235
    v_permlane32_swap_b32 v232, v236
    v_permlane32_swap_b32 v233, v237
    v_permlane32_swap_b32 v234, v238
    v_permlane32_swap_b32 v235, v239
    v_max_f32 v232, v232, v236
    v_max_f32 v233, v233, v237
    v_max_f32 v234, v234, v238
    v_max_f32 v235, v235, v239
    v_sub_f32 v192, 0, v232
    v_sub_f32 v193, 0, v232
    v_sub_f32 v194, 0, v232
    v_sub_f32 v195, 0, v232
    v_sub_f32 v196, 0, v233
    v_sub_f32 v197, 0, v233
    v_sub_f32 v198, 0, v233
    v_sub_f32 v199, 0, v233
    v_sub_f32 v200, 0, v234
    v_sub_f32 v201, 0, v234
    v_sub_f32 v202, 0, v234
    v_sub_f32 v203, 0, v234
    v_sub_f32 v204, 0, v235
    v_sub_f32 v205, 0, v235
    v_sub_f32 v206, 0, v235
    v_sub_f32 v207, 0, v235
    s_mov_b32 s40, 0
    s_mov_b32 s41, 0
    s_add_u32 m0, s42, 0
    s_nop 0
    buffer_load_dwordx4 v36, s[8:11], s40 offen lds
    buffer_load_dwordx4 v37, s[8:11], s40 offen offset:1024 lds
    buffer_load_dwordx4 v38, s[8:11], s40 offen offset:2048 lds
    buffer_load_dwordx4 v39, s[8:11], s40 offen offset:3072 lds
    s_add_u32 s40, s40, 16384
    s_add_u32 m0, s42, 16384
    s_nop 0
    buffer_load_dwordx4 v36, s[8:11], s40 offen lds
    buffer_load_dwordx4 v37, s[8:11], s40 offen offset:1024 lds
    buffer_load_dwordx4 v38, s[8:11], s40 offen offset:2048 lds
    buffer_load_dwordx4 v39, s[8:11], s40 offen offset:3072 lds
    s_add_u32 s40, s40, 16384
    s_add_u32 m0, s42, 32768
    s_nop 0
    buffer_load_dwordx4 v36, s[8:11], s40 offen lds
    buffer_load_dwordx4 v37, s[8:11], s40 offen offset:1024 lds
    buffer_load_dwordx4 v38, s[8:11], s40 offen offset:2048 lds
    buffer_load_dwordx4 v39, s[8:11], s40 offen offset:3072 lds
    s_add_u32 s40, s40, 16384
    s_add_u32 m0, s42, 65536
    s_nop 0
    buffer_load_dwordx4 v40, s[12:15], s41 offen lds
    buffer_load_dwordx4 v41, s[12:15], s41 offen offset:1024 lds
    buffer_load_dwordx4 v40, s[12:15], s41 offen offset:2048 lds
    buffer_load_dwordx4 v41, s[12:15], s41 offen offset:3072 lds
    s_add_u32 s41, s41, 16384
    s_add_u32 m0, s42, 81920
    s_nop 0
    buffer_load_dwordx4 v40, s[12:15], s41 offen lds
    buffer_load_dwordx4 v41, s[12:15], s41 offen offset:1024 lds
    buffer_load_dwordx4 v40, s[12:15], s41 offen offset:2048 lds
    buffer_load_dwordx4 v41, s[12:15], s41 offen offset:3072 lds
    s_add_u32 s41, s41, 16384
    v_accvgpr_write_b32 a0, 0
    v_accvgpr_write_b32 a1, 0
    v_accvgpr_write_b32 a2, 0
    v_accvgpr_write_b32 a3, 0
    v_accvgpr_write_b32 a4, 0
    v_accvgpr_write_b32 a5, 0
    v_accvgpr_write_b32 a6, 0
    v_accvgpr_write_b32 a7, 0
    v_accvgpr_write_b32 a8, 0
    v_accvgpr_write_b32 a9, 0
    v_accvgpr_write_b32 a10, 0
    v_accvgpr_write_b32 a11, 0
    v_accvgpr_write_b32 a12, 0
    v_accvgpr_write_b32 a13, 0
    v_accvgpr_write_b32 a14, 0
    v_accvgpr_write_b32 a15, 0
    v_accvgpr_write_b32 a16, 0
    v_accvgpr_write_b32 a17, 0
    v_accvgpr_write_b32 a18, 0
    v_accvgpr_write_b32 a19, 0
    v_accvgpr_write_b32 a20, 0
    v_accvgpr_write_b32 a21, 0
    v_accvgpr_write_b32 a22, 0
    v_accvgpr_write_b32 a23, 0
    v_accvgpr_write_b32 a24, 0
    v_accvgpr_write_b32 a25, 0
    v_accvgpr_write_b32 a26, 0
    v_accvgpr_write_b32 a27, 0
    v_accvgpr_write_b32 a28, 0
    v_accvgpr_write_b32 a29, 0
    v_accvgpr_write_b32 a30, 0
    v_accvgpr_write_b32 a31, 0
    v_accvgpr_write_b32 a32, 0
    v_accvgpr_write_b32 a33, 0
    v_accvgpr_write_b32 a34, 0
    v_accvgpr_write_b32 a35, 0
    v_accvgpr_write_b32 a36, 0
    v_accvgpr_write_b32 a37, 0
    v_accvgpr_write_b32 a38, 0
    v_accvgpr_write_b32 a39, 0
    v_accvgpr_write_b32 a40, 0
    v_accvgpr_write_b32 a41, 0
    v_accvgpr_write_b32 a42, 0
    v_accvgpr_write_b32 a43, 0
    v_accvgpr_write_b32 a44, 0
    v_accvgpr_write_b32 a45, 0
    v_accvgpr_write_b32 a46, 0
    v_accvgpr_write_b32 a47, 0
    v_accvgpr_write_b32 a48, 0
    v_accvgpr_write_b32 a49, 0
    v_accvgpr_write_b32 a50, 0
    v_accvgpr_write_b32 a51, 0
    v_accvgpr_write_b32 a52, 0
    v_accvgpr_write_b32 a53, 0
    v_accvgpr_write_b32 a54, 0
    v_accvgpr_write_b32 a55, 0
    v_accvgpr_write_b32 a56, 0
    v_accvgpr_write_b32 a57, 0
    v_accvgpr_write_b32 a58, 0
    v_accvgpr_write_b32 a59, 0
    v_accvgpr_write_b32 a60, 0
    v_accvgpr_write_b32 a61, 0
    v_accvgpr_write_b32 a62, 0
    v_accvgpr_write_b32 a63, 0
    v_accvgpr_write_b32 a64, 0
    v_accvgpr_write_b32 a65, 0
    v_accvgpr_write_b32 a66, 0
    v_accvgpr_write_b32 a67, 0
    v_accvgpr_write_b32 a68, 0
    v_accvgpr_write_b32 a69, 0
    v_accvgpr_write_b32 a70, 0
    v_accvgpr_write_b32 a71, 0
    v_accvgpr_write_b32 a72, 0
    v_accvgpr_write_b32 a73, 0
    v_accvgpr_write_b32 a74, 0
    v_accvgpr_write_b32 a75, 0
    v_accvgpr_write_b32 a76, 0
    v_accvgpr_write_b32 a77, 0
    v_accvgpr_write_b32 a78, 0
    v_accvgpr_write_b32 a79, 0
    v_accvgpr_write_b32 a80, 0
    v_accvgpr_write_b32 a81, 0
    v_accvgpr_write_b32 a82, 0
    v_accvgpr_write_b32 a83, 0
    v_accvgpr_write_b32 a84, 0
    v_accvgpr_write_b32 a85, 0
    v_accvgpr_write_b32 a86, 0
    v_accvgpr_write_b32 a87, 0
    v_accvgpr_write_b32 a88, 0
    v_accvgpr_write_b32 a89, 0
    v_accvgpr_write_b32 a90, 0
    v_accvgpr_write_b32 a91, 0
    v_accvgpr_write_b32 a92, 0
    v_accvgpr_write_b32 a93, 0
    v_accvgpr_write_b32 a94, 0
    v_accvgpr_write_b32 a95, 0
    v_accvgpr_write_b32 a96, 0
    v_accvgpr_write_b32 a97, 0
    v_accvgpr_write_b32 a98, 0
    v_accvgpr_write_b32 a99, 0
    v_accvgpr_write_b32 a100, 0
    v_accvgpr_write_b32 a101, 0
    v_accvgpr_write_b32 a102, 0
    v_accvgpr_write_b32 a103, 0
    v_accvgpr_write_b32 a104, 0
    v_accvgpr_write_b32 a105, 0
    v_accvgpr_write_b32 a106, 0
    v_accvgpr_write_b32 a107, 0
    v_accvgpr_write_b32 a108, 0
    v_accvgpr_write_b32 a109, 0
    v_accvgpr_write_b32 a110, 0
    v_accvgpr_write_b32 a111, 0
    v_accvgpr_write_b32 a112, 0
    v_accvgpr_write_b32 a113, 0
    v_accvgpr_write_b32 a114, 0
    v_accvgpr_write_b32 a115, 0
    v_accvgpr_write_b32 a116, 0
    v_accvgpr_write_b32 a117, 0
    v_accvgpr_write_b32 a118, 0
    v_accvgpr_write_b32 a119, 0
    v_accvgpr_write_b32 a120, 0
    v_accvgpr_write_b32 a121, 0
    v_accvgpr_write_b32 a122, 0
    v_accvgpr_write_b32 a123, 0
    v_accvgpr_write_b32 a124, 0
    v_accvgpr_write_b32 a125, 0
    v_accvgpr_write_b32 a126, 0
    v_accvgpr_write_b32 a127, 0
    v_accvgpr_write_b32 a192, 0
    v_accvgpr_write_b32 a193, 0
    v_accvgpr_write_b32 a194, 0
    v_accvgpr_write_b32 a195, 0
    v_accvgpr_write_b32 a196, 0
    v_accvgpr_write_b32 a197, 0
    v_accvgpr_write_b32 a198, 0
    v_accvgpr_write_b32 a199, 0
    v_accvgpr_write_b32 a200, 0
    v_accvgpr_write_b32 a201, 0
    v_accvgpr_write_b32 a202, 0
    v_accvgpr_write_b32 a203, 0
    v_accvgpr_write_b32 a204, 0
    v_accvgpr_write_b32 a205, 0
    v_accvgpr_write_b32 a206, 0
    v_accvgpr_write_b32 a207, 0
    s_waitcnt vmcnt(0) lgkmcnt(0)
    s_barrier
    ds_read_b128 a[208:211], v8 offset:0
    ds_read_b128 a[212:215], v9 offset:0
    ds_read_b128 a[216:219], v10 offset:0
    ds_read_b128 a[220:223], v11 offset:0
    ds_read_b128 a[224:227], v8 offset:4096
    s_waitcnt vmcnt(0) lgkmcnt(0)
    s_branch Lattn_stage0
Lattn_armwait:
    s_mov_b32 s36, 16384
Lattn_armloop:
    v_mov_b32 v63, 0
    buffer_load_dword v63, v63, s[88:91], 0 offen sc1
    s_waitcnt vmcnt(0)
    v_readfirstlane_b32 s37, v63
    s_sub_u32 s36, s36, 1
    s_cbranch_scc1 Lattn_armed
    s_cmp_lt_u32 s37, 256
    s_cbranch_scc1 Lattn_armloop
    s_branch Lattn_armed
Lattn_end:
    s_endpgm
.section .rodata,"a"
.p2align 6
.amdhsa_kernel adaLN_cond__gqa_block_cached__moe_arch_mod__prompt_kernel
  .amdhsa_next_free_vgpr 512
  .amdhsa_next_free_sgpr 102
  .amdhsa_accum_offset 256
  .amdhsa_group_segment_fixed_size 0
  .amdhsa_kernarg_size 120
  .amdhsa_user_sgpr_count 2
  .amdhsa_user_sgpr_kernarg_segment_ptr 1
  .amdhsa_system_sgpr_workgroup_id_x 1
  .amdhsa_float_denorm_mode_32 3
.end_amdhsa_kernel
```

```asm
; @launch grid=(256,1,1) block=(256,1,1) lds=163840
.amdgcn_target "amdgcn-amd-amdhsa--gfx950"
.text
.globl adaLN_cond__gqa_block_cached__moe_arch_mod__prompt_kernel
.p2align 8
.type adaLN_cond__gqa_block_cached__moe_arch_mod__prompt_kernel,@function
adaLN_cond__gqa_block_cached__moe_arch_mod__prompt_kernel:
    s_cmp_ge_u32 s2, 256
    s_cbranch_scc1 Lattn_end
    s_load_dwordx2 s[8:9], s[0:1], 80
    s_load_dwordx2 s[12:13], s[0:1], 88
    s_load_dwordx2 s[20:21], s[0:1], 0
    s_load_dwordx2 s[50:51], s[0:1], 112
    s_load_dwordx8 s[52:59], s[0:1], 8
    s_load_dwordx4 s[80:83], s[0:1], 56
    s_load_dwordx2 s[84:85], s[0:1], 72
    s_load_dwordx2 s[88:89], s[0:1], 104
    s_load_dwordx2 s[28:29], s[0:1], 48
    s_getpc_b64 s[32:33]
Lattn_pc:
    s_mov_b32 s34, Lattn_end-Lattn_pc
    s_mov_b32 s35, 0x20000
    s_lshr_b32 s6, s2, 3
    s_lshl_b32 s7, s6, 6
    v_lshrrev_b32 v3, 6, v0
    v_and_b32 v1, 63, v0
    v_lshrrev_b32 v2, 2, v0
    v_lshlrev_b32 v2, 11, v2
    v_readfirstlane_b32 s3, v3
    buffer_load_dword v240, v2, s[32:35], s7 offen
    s_and_b32 s7, s2, 7
    s_lshl_b32 s4, s7, 1
    s_and_b32 s5, s6, 1
    s_add_u32 s4, s4, s5
    s_lshr_b32 s5, s2, 4
    s_lshr_b32 s38, s6, 2
    s_lshl_b32 s38, s38, 3
    s_add_u32 s38, s38, s7
    s_cmp_lt_u32 s38, 18
    s_cselect_b32 s39, 0, 2147483648
    s_lshl_b32 s38, s38, 2
    s_and_b32 s36, s6, 3
    s_add_u32 s38, s38, s36
    s_mov_b32 s14, 3981312
    s_mul_i32 s92, s6, 124416
    s_lshl_b32 s36, s7, 7
    s_add_u32 s92, s92, s36
    s_cmp_lt_u32 s7, 2
    s_cselect_b32 s36, 53, 35
    v_lshrrev_b32 v2, 2, v0
    v_min_u32 v2, s36, v2
    v_mul_u32_u24 v3, 57, v2
    v_lshrrev_b32 v3, 10, v3
    v_mul_i32_i24 v3, -123392, v3
    v_mul_u32_u24 v2, 6912, v2
    v_add_u32 v72, v2, v3
    s_mov_b32 s15, 0x20000
    s_mov_b32 s10, 1152
    s_mov_b32 s11, 0x20000
    s_mov_b32 s22, 2359296
    s_mov_b32 s23, 0x20000
    v_and_b32 v64, 0xfe, v0
    v_mul_u32_u24 v65, 3456, v64
    v_and_b32 v2, 1, v0
    v_lshl_add_u32 v65, v2, 4, v65
    s_lshl_b32 s36, s38, 5
    s_or_b32 s36, s36, s39
    v_and_b32 v4, 31, v1
    v_lshrrev_b32 v5, 5, v1
    v_cmp_gt_u32 vcc, 24, v4
    v_mov_b32 v6, 2147483648
    s_lshl_b32 s7, s5, 4
    s_add_u32 s7, s7, s4
    s_lshl_b32 s7, s7, 2
    s_add_u32 s7, s7, s3
    v_cndmask_b32 v6, v6, 0, vcc
    s_mul_i32 s49, s7, 2304
    v_lshrrev_b32 v7, 2, v4
    v_lshl_add_u32 v7, v7, 6, v6
    v_and_b32 v2, 3, v4
    v_lshl_add_u32 v7, v2, 3, v7
    v_mul_u32_u24 v2, 1152, v5
    v_add_u32 v66, v7, v2
    s_waitcnt lgkmcnt(0)
    s_load_dword s94, s[50:51], 24576
    buffer_load_dword v241, v72, s[12:15], s92 offen
    buffer_load_ushort v80, v64, s[8:11], 0 offen offset:0
    buffer_load_ushort v81, v64, s[8:11], 0 offen offset:256
    buffer_load_ushort v82, v64, s[8:11], 0 offen offset:512
    buffer_load_ushort v83, v64, s[8:11], 0 offen offset:768
    buffer_load_ushort v84, v64, s[8:11], 0 offen offset:1024
    buffer_load_dwordx4 v[88:91], v65, s[12:15], s36 offen
    s_add_u32 s36, s36, 884736
    buffer_load_dwordx4 v[92:95], v65, s[12:15], s36 offen
    s_add_u32 s36, s36, 884736
    buffer_load_dwordx4 v[96:99], v65, s[12:15], s36 offen
    s_add_u32 s36, s36, 884736
    buffer_load_dwordx4 v[100:103], v65, s[12:15], s36 offen
    s_add_u32 s36, s36, 884736
    buffer_load_dwordx4 v[104:107], v65, s[12:15], s36 offen
    s_mov_b32 s16, s56
    s_mov_b32 s17, s57
    s_mov_b32 s18, 4718592
    s_mov_b32 s19, 0x20000
    s_lshl_b32 s44, s4, 9
    s_mul_i32 s36, s5, 98304
    s_add_u32 s36, s36, 0
    v_lshrrev_b32 v2, 2, v0
    v_min_u32 v2, 47, v2
    v_lshrrev_b32 v3, 2, v2
    v_and_b32 v2, 3, v2
    v_lshl_add_u32 v2, v2, 7, s36
    v_lshl_add_u32 v71, v3, 13, v2
    s_mul_i32 s36, s5, 196608
    s_add_u32 s36, s36, 1572864
    v_lshrrev_b32 v2, 1, v0
    v_min_u32 v2, 95, v2
    v_lshrrev_b32 v3, 2, v2
    v_and_b32 v2, 3, v2
    v_lshl_add_u32 v2, v2, 7, s36
    v_lshl_add_u32 v70, v3, 13, v2
    s_add_u32 s92, s49, 65536
    v_lshl_add_u32 v7, v5, 4, v6
    v_lshl_add_u32 v67, v4, 5, v7
    v_min_u32 v4, 23, v4
    v_lshlrev_b32 v68, 4, v4
    s_mov_b32 s24, s50
    s_mov_b32 s25, s51
    s_mov_b32 s26, 10485760
    s_mov_b32 s27, 0x20000
    s_mov_b32 s90, 256
    s_mov_b32 s91, 0x20000
    s_cmp_ge_u32 s38, 36
    s_cselect_b32 s93, 1.0, 0
    s_lshl_b32 s36, s38, 7
    v_lshl_add_u32 v69, v0, 3, s36
    v_cmp_gt_u32 s[36:37], 16, v0
    v_mov_b32 v2, 2147483648
    v_mov_b32 v3, s39
    v_cndmask_b32 v2, v2, v3, s[36:37]
    v_or_b32 v69, v69, v2
    s_mul_i32 s36, s5, 3072
    s_lshl_b32 s37, s5, 11
    v_lshrrev_b32 v120, 3, v0
    v_min_u32 v120, 23, v120
    v_lshl_add_u32 v120, v120, 7, s36
    v_lshrrev_b32 v121, 4, v0
    v_lshl_add_u32 v121, v121, 7, s37
    s_lshl_b32 s42, s3, 12
    v_lshrrev_b32 v2, 4, v1
    v_and_b32 v3, 15, v1
    v_lshrrev_b32 v5, 1, v3
    v_mul_u32_u24 v5, 2304, v5
    v_lshl_add_u32 v5, v2, 5, v5
    v_and_b32 v6, 1, v3
    v_lshl_add_u32 v51, v6, 4, v5
    s_lshl_b32 s6, s5, 2
    s_add_u32 s6, s6, s3
    s_mul_i32 s46, s6, 36864
    s_add_u32 s46, s46, 65536
    s_add_u32 s43, s46, 18432
    s_mul_i32 s45, s4, 294912
    s_lshl_b32 s7, s3, 4
    v_add_u32 v4, s7, v2
    v_lshlrev_b32 v5, 1, v2
    v_xor_b32 v5, v5, v3
    v_xor_b32 v6, 8, v5
    v_lshlrev_b32 v7, 13, v4
    v_lshl_add_u32 v42, v5, 4, v7
    v_lshl_add_u32 v43, v6, 4, v7
    v_add_u32 v44, 63488, v42
    v_add_u32 v45, 95232, v43
    v_add_u32 v43, 31744, v43
    s_lshl_b32 s7, s4, 19
    s_add_u32 s8, s52, s7
    s_addc_u32 s9, s53, 0
    s_mov_b32 s10, 524288
    s_mov_b32 s11, 0x20000
    s_add_u32 s12, s54, s7
    s_addc_u32 s13, s55, 0
    s_mov_b32 s14, 524288
    s_mov_b32 s15, 0x20000
    s_add_u32 s28, s50, 10485760
    s_addc_u32 s29, s51, 0
    s_mov_b32 s30, 37748736
    s_mov_b32 s31, 0x20000
    v_lshlrev_b32 v7, 8, v4
    v_lshl_add_u32 v40, v5, 4, v7
    v_lshl_add_u32 v41, v6, 4, v7
    v_xor_b32 v224, v3, v2
    v_lshl_add_u32 v36, v224, 4, v7
    v_xor_b32 v37, 64, v36
    v_xor_b32 v38, 128, v36
    v_xor_b32 v39, 192, v36
    v_lshrrev_b32 v7, 3, v5
    v_lshl_add_u32 v7, v7, 7, v4
    v_mul_u32_u24 v7, 1152, v7
    v_and_b32 v225, 7, v5
    v_lshl_add_u32 v46, v225, 4, v7
    v_lshrrev_b32 v7, 3, v6
    v_lshl_add_u32 v7, v7, 7, v4
    v_mul_u32_u24 v7, 1152, v7
    v_and_b32 v225, 7, v6
    v_lshl_add_u32 v47, v225, 4, v7
    v_add_u32 v48, 7168, v46
    v_add_u32 v49, 10752, v47
    v_add_u32 v47, 3584, v47
    v_lshlrev_b32 v7, 8, v3
    v_lshl_add_u32 v8, v224, 4, v7
    v_xor_b32 v9, 64, v8
    v_xor_b32 v10, 128, v8
    v_xor_b32 v11, 192, v8
    v_lshrrev_b32 v5, 2, v1
    v_and_b32 v6, 7, v5
    v_lshlrev_b32 v6, 5, v6
    v_lshl_add_u32 v6, v5, 8, v6
    v_and_b32 v7, 3, v1
    v_lshl_add_u32 v12, v7, 3, v6
    v_xor_b32 v13, 32, v12
    v_xor_b32 v14, 64, v12
    v_xor_b32 v15, 96, v12
    v_xor_b32 v16, 128, v12
    v_xor_b32 v17, 160, v12
    v_xor_b32 v18, 192, v12
    v_xor_b32 v19, 224, v12
    v_add_u32 v20, 65536, v12
    v_add_u32 v21, 65536, v13
    v_add_u32 v22, 65536, v14
    v_add_u32 v23, 65536, v15
    v_add_u32 v24, 65536, v16
    v_add_u32 v25, 65536, v17
    v_add_u32 v26, 65536, v18
    v_add_u32 v27, 65536, v19
    v_add_u32 v28, 131072, v12
    v_add_u32 v29, 131072, v13
    v_add_u32 v30, 131072, v14
    v_add_u32 v31, 131072, v15
    v_add_u32 v32, 131072, v16
    v_add_u32 v33, 131072, v17
    v_add_u32 v34, 131072, v18
    v_add_u32 v35, 131072, v19
    v_mov_b32 v52, 0x3f803f80
    v_mov_b32 v53, 0x3f803f80
    v_mov_b32 v54, 0x3f803f80
    v_mov_b32 v55, 0x3f803f80
    v_and_b32 v5, 1, v1
    v_mul_u32_u24 v5, 0xaaaa, v5
    v_add_u32 v5, 0x4444, v5
    v_lshl_add_u32 v50, v5, 16, v5
    v_lshrrev_b32 v5, 1, v3
    v_mul_u32_u24 v5, 20480, v5
    v_lshl_add_u32 v5, v2, 5, v5
    v_and_b32 v6, 1, v3
    v_lshl_add_u32 v56, v6, 4, v5
    s_mul_i32 s47, s6, 327680
    s_mov_b32 s32, s82
    s_mov_b32 s33, s83
    s_mov_b32 s34, 5308416
    s_mov_b32 s35, 0x20000
    s_mov_b32 s82, 5308416
    s_mov_b32 s83, 0x20000
    s_mov_b32 s86, 5308416
    s_mov_b32 s87, 0x20000
    s_lshr_b32 s7, s2, 3
    s_mul_i32 s7, s7, 18
    s_add_u32 s7, s7, s3
    s_and_b32 s36, s2, 7
    s_mul_i32 s37, s36, 576
    s_add_u32 s37, s37, s7
    s_mul_i32 s37, s37, 1152
    s_mul_i32 s7, s7, 9216
    s_mul_i32 s36, s36, 1152
    s_add_u32 s7, s7, s36
    v_min_u32 v5, 17, v1
    v_lshl_add_u32 v57, v5, 6, s7
    v_lshl_add_u32 v62, v5, 6, s37
    s_mov_b32 s40, 0
    s_mov_b32 s41, 0
    s_mov_b32 s48, 0
    s_waitcnt vmcnt(9)
    v_lshlrev_b32 v80, 16, v80
    s_waitcnt vmcnt(8)
    v_lshlrev_b32 v81, 16, v81
    s_waitcnt vmcnt(7)
    v_lshlrev_b32 v82, 16, v82
    s_waitcnt vmcnt(6)
    v_lshlrev_b32 v83, 16, v83
    s_waitcnt vmcnt(5)
    v_lshlrev_b32 v84, 16, v84
    v_mul_f32 v144, 0xbfb8aa3b, v80
    v_mul_f32 v148, 0xbfb8aa3b, v81
    v_mul_f32 v152, 0xbfb8aa3b, v82
    v_mul_f32 v156, 0xbfb8aa3b, v83
    v_mul_f32 v160, 0xbfb8aa3b, v84
    v_min_f32 v144, 0x42fc0000, v144
    v_min_f32 v148, 0x42fc0000, v148
    v_min_f32 v152, 0x42fc0000, v152
    v_min_f32 v156, 0x42fc0000, v156
    v_min_f32 v160, 0x42fc0000, v160
    v_exp_f32 v144, v144
    v_exp_f32 v148, v148
    v_exp_f32 v152, v152
    v_exp_f32 v156, v156
    v_exp_f32 v160, v160
    v_add_f32 v144, 1.0, v144
    v_add_f32 v148, 1.0, v148
    v_add_f32 v152, 1.0, v152
    v_add_f32 v156, 1.0, v156
    v_add_f32 v160, 1.0, v160
    v_rcp_f32 v145, v144
    v_rcp_f32 v149, v148
    v_rcp_f32 v153, v152
    v_rcp_f32 v157, v156
    v_rcp_f32 v161, v160
    v_mul_f32 v146, v80, v145
    v_mul_f32 v150, v81, v149
    v_mul_f32 v154, v82, v153
    v_mul_f32 v158, v83, v157
    v_mul_f32 v162, v84, v161
    v_fma_f32 v144, -v146, v144, v80
    v_fma_f32 v148, -v150, v148, v81
    v_fma_f32 v152, -v154, v152, v82
    v_fma_f32 v156, -v158, v156, v83
    v_fma_f32 v160, -v162, v160, v84
    v_fma_f32 v80, v144, v145, v146
    v_fma_f32 v81, v148, v149, v150
    v_fma_f32 v82, v152, v153, v154
    v_fma_f32 v83, v156, v157, v158
    v_fma_f32 v84, v160, v161, v162
    v_cvt_pk_bf16_f32 v80, v80, v80
    v_cvt_pk_bf16_f32 v81, v81, v81
    v_cvt_pk_bf16_f32 v82, v82, v82
    v_cvt_pk_bf16_f32 v83, v83, v83
    v_cvt_pk_bf16_f32 v84, v84, v84
    v_and_b32 v80, 0xffff0000, v80
    v_and_b32 v81, 0xffff0000, v81
    v_and_b32 v82, 0xffff0000, v82
    v_and_b32 v83, 0xffff0000, v83
    v_and_b32 v84, 0xffff0000, v84
    buffer_load_dwordx2 v[108:109], v66, s[20:23], s49 offen offset:0
    buffer_load_dwordx2 v[110:111], v66, s[20:23], s49 offen offset:32
    buffer_load_dwordx2 v[112:113], v66, s[20:23], s49 offen offset:384
    buffer_load_dwordx2 v[114:115], v66, s[20:23], s49 offen offset:416
    buffer_load_dwordx2 v[116:117], v66, s[20:23], s49 offen offset:768
    buffer_load_dwordx2 v[118:119], v66, s[20:23], s49 offen offset:800
    s_mov_b32 s20, s58
    s_mov_b32 s21, s59
    s_mov_b32 s22, 4718592
    s_mov_b32 s23, 0x20000
    s_waitcnt vmcnt(10)
    v_lshlrev_b32 v136, 16, v88
    v_and_b32 v137, 0xffff0000, v88
    v_lshlrev_b32 v138, 16, v89
    v_and_b32 v139, 0xffff0000, v89
    v_lshlrev_b32 v140, 16, v90
    v_and_b32 v141, 0xffff0000, v90
    v_lshlrev_b32 v142, 16, v91
    v_and_b32 v143, 0xffff0000, v91
    v_pk_mul_f32 v[128:129], v[136:137], v[80:81] op_sel:[0,0] op_sel_hi:[1,0]
    v_pk_mul_f32 v[130:131], v[138:139], v[80:81] op_sel:[0,0] op_sel_hi:[1,0]
    v_pk_mul_f32 v[132:133], v[140:141], v[80:81] op_sel:[0,0] op_sel_hi:[1,0]
    v_pk_mul_f32 v[134:135], v[142:143], v[80:81] op_sel:[0,0] op_sel_hi:[1,0]
    s_waitcnt vmcnt(9)
    v_lshlrev_b32 v136, 16, v92
    v_and_b32 v137, 0xffff0000, v92
    v_lshlrev_b32 v138, 16, v93
    v_and_b32 v139, 0xffff0000, v93
    v_lshlrev_b32 v140, 16, v94
    v_and_b32 v141, 0xffff0000, v94
    v_lshlrev_b32 v142, 16, v95
    v_and_b32 v143, 0xffff0000, v95
    v_pk_fma_f32 v[128:129], v[136:137], v[80:81], v[128:129] op_sel:[0,1,0] op_sel_hi:[1,1,1]
    v_pk_fma_f32 v[130:131], v[138:139], v[80:81], v[130:131] op_sel:[0,1,0] op_sel_hi:[1,1,1]
    v_pk_fma_f32 v[132:133], v[140:141], v[80:81], v[132:133] op_sel:[0,1,0] op_sel_hi:[1,1,1]
    v_pk_fma_f32 v[134:135], v[142:143], v[80:81], v[134:135] op_sel:[0,1,0] op_sel_hi:[1,1,1]
    s_waitcnt vmcnt(8)
    v_lshlrev_b32 v136, 16, v96
    v_and_b32 v137, 0xffff0000, v96
    v_lshlrev_b32 v138, 16, v97
    v_and_b32 v139, 0xffff0000, v97
    v_lshlrev_b32 v140, 16, v98
    v_and_b32 v141, 0xffff0000, v98
    v_lshlrev_b32 v142, 16, v99
    v_and_b32 v143, 0xffff0000, v99
    v_pk_fma_f32 v[128:129], v[136:137], v[82:83], v[128:129] op_sel:[0,0,0] op_sel_hi:[1,0,1]
    v_pk_fma_f32 v[130:131], v[138:139], v[82:83], v[130:131] op_sel:[0,0,0] op_sel_hi:[1,0,1]
    v_pk_fma_f32 v[132:133], v[140:141], v[82:83], v[132:133] op_sel:[0,0,0] op_sel_hi:[1,0,1]
    v_pk_fma_f32 v[134:135], v[142:143], v[82:83], v[134:135] op_sel:[0,0,0] op_sel_hi:[1,0,1]
    s_waitcnt vmcnt(7)
    v_lshlrev_b32 v136, 16, v100
    v_and_b32 v137, 0xffff0000, v100
    v_lshlrev_b32 v138, 16, v101
    v_and_b32 v139, 0xffff0000, v101
    v_lshlrev_b32 v140, 16, v102
    v_and_b32 v141, 0xffff0000, v102
    v_lshlrev_b32 v142, 16, v103
    v_and_b32 v143, 0xffff0000, v103
    v_pk_fma_f32 v[128:129], v[136:137], v[82:83], v[128:129] op_sel:[0,1,0] op_sel_hi:[1,1,1]
    v_pk_fma_f32 v[130:131], v[138:139], v[82:83], v[130:131] op_sel:[0,1,0] op_sel_hi:[1,1,1]
    v_pk_fma_f32 v[132:133], v[140:141], v[82:83], v[132:133] op_sel:[0,1,0] op_sel_hi:[1,1,1]
    v_pk_fma_f32 v[134:135], v[142:143], v[82:83], v[134:135] op_sel:[0,1,0] op_sel_hi:[1,1,1]
    s_waitcnt vmcnt(6)
    v_lshlrev_b32 v136, 16, v104
    v_and_b32 v137, 0xffff0000, v104
    v_lshlrev_b32 v138, 16, v105
    v_and_b32 v139, 0xffff0000, v105
    v_lshlrev_b32 v140, 16, v106
    v_and_b32 v141, 0xffff0000, v106
    v_lshlrev_b32 v142, 16, v107
    v_and_b32 v143, 0xffff0000, v107
    v_pk_fma_f32 v[128:129], v[136:137], v[84:85], v[128:129] op_sel:[0,0,0] op_sel_hi:[1,0,1]
    v_pk_fma_f32 v[130:131], v[138:139], v[84:85], v[130:131] op_sel:[0,0,0] op_sel_hi:[1,0,1]
    v_pk_fma_f32 v[132:133], v[140:141], v[84:85], v[132:133] op_sel:[0,0,0] op_sel_hi:[1,0,1]
    v_pk_fma_f32 v[134:135], v[142:143], v[84:85], v[134:135] op_sel:[0,0,0] op_sel_hi:[1,0,1]
    s_nop 0
    v_permlane32_swap_b32 v128, v132
    v_permlane32_swap_b32 v129, v133
    v_permlane32_swap_b32 v130, v134
    v_permlane32_swap_b32 v131, v135
    v_and_b32 v72, 1, v1
    v_pk_add_f32 v[128:129], v[128:129], v[132:133]
    v_pk_add_f32 v[130:131], v[130:131], v[134:135]
    v_lshlrev_b32 v72, 5, v72
    v_lshrrev_b32 v73, 4, v1
    v_permlane16_swap_b32 v128, v130
    v_permlane16_swap_b32 v129, v131
    v_lshl_add_u32 v72, v73, 3, v72
    v_pk_add_f32 v[128:129], v[128:129], v[130:131]
    s_lshl_b32 s36, s3, 6
    v_add_u32 v72, s36, v72
    v_add_f32_dpp v128, v128, v128 row_ror:2 row_mask:0xf bank_mask:0xf
    v_add_f32_dpp v129, v129, v129 row_ror:2 row_mask:0xf bank_mask:0xf
    s_nop 0
    v_add_f32_dpp v128, v128, v128 row_ror:4 row_mask:0xf bank_mask:0xf
    v_add_f32_dpp v129, v129, v129 row_ror:4 row_mask:0xf bank_mask:0xf
    s_nop 0
    v_add_f32_dpp v128, v128, v128 row_ror:8 row_mask:0xf bank_mask:0xf
    v_add_f32_dpp v129, v129, v129 row_ror:8 row_mask:0xf bank_mask:0xf
    ds_write_b64 v72, v[128:129] offset:0
    v_and_b32 v73, 7, v1
    v_lshlrev_b32 v73, 3, v73
    s_waitcnt lgkmcnt(0)
    s_barrier
    ds_read_b64 v[128:129], v73 offset:0
    ds_read_b64 v[130:131], v73 offset:64
    ds_read_b64 v[132:133], v73 offset:128
    ds_read_b64 v[134:135], v73 offset:192
    s_add_u32 s95, s94, 0x9e3779b9
    v_mov_b32 v137, s95
    s_mov_b32 s37, 32768
    s_waitcnt lgkmcnt(2)
    v_pk_add_f32 v[128:129], v[128:129], v[130:131]
    s_waitcnt lgkmcnt(0)
    v_pk_add_f32 v[132:133], v[132:133], v[134:135]
    v_pk_add_f32 v[128:129], v[128:129], v[132:133]
    v_cvt_pk_bf16_f32 v136, v128, v129
    v_lshlrev_b32 v128, 16, v136
    v_and_b32 v129, 0xffff0000, v136
    v_add_f32 v128, s93, v128
    v_add_f32 v129, s93, v129
    v_cvt_pk_bf16_f32 v136, v128, v129
    buffer_store_dwordx2 v[136:137], v69, s[24:27], s37 offen sc1
    s_mul_i32 s36, s3, 72
    v_add_u32 v122, s36, v1
    v_and_b32 v123, 7, v1
    s_add_u32 s36, s36, 64
    v_add_u32 v123, s36, v123
    s_movk_i32 s36, 1024
    v_and_b32 v76, 3, v122
    v_lshlrev_b32 v76, 4, v76
    v_lshrrev_b32 v122, 2, v122
    v_lshl_add_u32 v124, v122, 7, v76
    v_and_b32 v77, 1, v122
    v_lshl_add_u32 v76, v77, 3, v76
    v_lshrrev_b32 v122, 1, v122
    v_lshl_add_u32 v122, v122, 6, v76
    v_add_u32 v122, s36, v122
    v_and_b32 v76, 3, v123
    v_lshlrev_b32 v76, 4, v76
    v_lshrrev_b32 v123, 2, v123
    v_lshl_add_u32 v125, v123, 7, v76
    v_and_b32 v77, 1, v123
    v_lshl_add_u32 v76, v77, 3, v76
    v_lshrrev_b32 v123, 1, v123
    v_lshl_add_u32 v123, v123, 6, v76
    v_add_u32 v123, s36, v123
    s_mov_b64 exec, 0
    s_cmp_eq_u32 s3, 0
    s_cbranch_scc1 Ltour0
    s_cmp_eq_u32 s3, 1
    s_cbranch_scc1 Ltour1
    s_cmp_eq_u32 s3, 2
    s_cbranch_scc1 Ltour2
    s_branch Ltour3
.p2align 12
Lmain:
    s_mov_b64 exec, -1
    s_waitcnt vmcnt(6)
    v_lshlrev_b32 v144, 16, v108
    v_and_b32 v145, 0xffff0000, v108
    v_lshlrev_b32 v146, 16, v109
    v_and_b32 v147, 0xffff0000, v109
    s_waitcnt vmcnt(5)
    v_lshlrev_b32 v148, 16, v110
    v_and_b32 v149, 0xffff0000, v110
    v_lshlrev_b32 v150, 16, v111
    v_and_b32 v151, 0xffff0000, v111
    s_waitcnt vmcnt(4)
    v_lshlrev_b32 v152, 16, v112
    v_and_b32 v153, 0xffff0000, v112
    v_lshlrev_b32 v154, 16, v113
    v_and_b32 v155, 0xffff0000, v113
    s_waitcnt vmcnt(3)
    v_lshlrev_b32 v156, 16, v114
    v_and_b32 v157, 0xffff0000, v114
    v_lshlrev_b32 v158, 16, v115
    v_and_b32 v159, 0xffff0000, v115
    s_waitcnt vmcnt(2)
    v_lshlrev_b32 v160, 16, v116
    v_and_b32 v161, 0xffff0000, v116
    v_lshlrev_b32 v162, 16, v117
    v_and_b32 v163, 0xffff0000, v117
    s_waitcnt vmcnt(1)
    v_lshlrev_b32 v164, 16, v118
    v_and_b32 v165, 0xffff0000, v118
    v_lshlrev_b32 v166, 16, v119
    v_and_b32 v167, 0xffff0000, v119
    buffer_load_dwordx4 v[88:91], v124, s[24:27], s37 offen sc1
    buffer_load_dwordx4 v[92:95], v125, s[24:27], s37 offen sc1
    buffer_load_dword v242, v71, s[16:19], s44 offen
    v_pk_add_f32 v[72:73], v[144:145], v[148:149]
    v_pk_add_f32 v[76:77], v[146:147], v[150:151]
    v_pk_add_f32 v[72:73], v[72:73], v[152:153]
    v_pk_add_f32 v[76:77], v[76:77], v[154:155]
    v_pk_add_f32 v[72:73], v[72:73], v[156:157]
    v_pk_add_f32 v[76:77], v[76:77], v[158:159]
    v_pk_add_f32 v[72:73], v[72:73], v[160:161]
    v_pk_add_f32 v[76:77], v[76:77], v[162:163]
    v_pk_add_f32 v[72:73], v[72:73], v[164:165]
    v_pk_add_f32 v[76:77], v[76:77], v[166:167]
    v_pk_add_f32 v[72:73], v[72:73], v[76:77]
    v_add_f32 v72, v72, v73
    s_nop 1
    v_add_f32_dpp v72, v72, v72 row_ror:8 row_mask:0xf bank_mask:0xf
    s_nop 1
    v_add_f32_dpp v72, v72, v72 row_ror:4 row_mask:0xf bank_mask:0xf
    s_nop 1
    v_add_f32_dpp v72, v72, v72 row_ror:2 row_mask:0xf bank_mask:0xf
    s_nop 1
    v_add_f32_dpp v72, v72, v72 row_ror:1 row_mask:0xf bank_mask:0xf
    v_mov_b32 v76, v72
    s_nop 1
    v_permlane16_swap_b32 v72, v76
    s_nop 0
    v_add_f32 v72, v72, v76
    v_mul_f32 v72, 0x3ae38e39, v72
    v_pk_add_f32 v[168:169], v[144:145], v[72:73] op_sel_hi:[1,0] neg_lo:[0,1] neg_hi:[0,1]
    v_pk_add_f32 v[170:171], v[146:147], v[72:73] op_sel_hi:[1,0] neg_lo:[0,1] neg_hi:[0,1]
    v_pk_add_f32 v[172:173], v[148:149], v[72:73] op_sel_hi:[1,0] neg_lo:[0,1] neg_hi:[0,1]
    v_pk_add_f32 v[174:175], v[150:151], v[72:73] op_sel_hi:[1,0] neg_lo:[0,1] neg_hi:[0,1]
    v_pk_add_f32 v[176:177], v[152:153], v[72:73] op_sel_hi:[1,0] neg_lo:[0,1] neg_hi:[0,1]
    v_pk_add_f32 v[178:179], v[154:155], v[72:73] op_sel_hi:[1,0] neg_lo:[0,1] neg_hi:[0,1]
    v_pk_add_f32 v[180:181], v[156:157], v[72:73] op_sel_hi:[1,0] neg_lo:[0,1] neg_hi:[0,1]
    v_pk_add_f32 v[182:183], v[158:159], v[72:73] op_sel_hi:[1,0] neg_lo:[0,1] neg_hi:[0,1]
    v_pk_add_f32 v[184:185], v[160:161], v[72:73] op_sel_hi:[1,0] neg_lo:[0,1] neg_hi:[0,1]
    v_pk_add_f32 v[186:187], v[162:163], v[72:73] op_sel_hi:[1,0] neg_lo:[0,1] neg_hi:[0,1]
    v_pk_add_f32 v[188:189], v[164:165], v[72:73] op_sel_hi:[1,0] neg_lo:[0,1] neg_hi:[0,1]
    v_pk_add_f32 v[190:191], v[166:167], v[72:73] op_sel_hi:[1,0] neg_lo:[0,1] neg_hi:[0,1]
    v_pk_mul_f32 v[74:75], v[168:169], v[168:169]
    v_pk_mul_f32 v[76:77], v[170:171], v[170:171]
    v_pk_fma_f32 v[74:75], v[172:173], v[172:173], v[74:75]
    v_pk_fma_f32 v[76:77], v[174:175], v[174:175], v[76:77]
    v_pk_fma_f32 v[74:75], v[176:177], v[176:177], v[74:75]
    v_pk_fma_f32 v[76:77], v[178:179], v[178:179], v[76:77]
    v_pk_fma_f32 v[74:75], v[180:181], v[180:181], v[74:75]
    v_pk_fma_f32 v[76:77], v[182:183], v[182:183], v[76:77]
    v_pk_fma_f32 v[74:75], v[184:185], v[184:185], v[74:75]
    v_pk_fma_f32 v[76:77], v[186:187], v[186:187], v[76:77]
    v_pk_fma_f32 v[74:75], v[188:189], v[188:189], v[74:75]
    v_pk_fma_f32 v[76:77], v[190:191], v[190:191], v[76:77]
    v_pk_add_f32 v[74:75], v[74:75], v[76:77]
    v_add_f32 v74, v74, v75
    v_cndmask_b32 v74, 0, v74, vcc
    s_nop 1
    v_add_f32_dpp v74, v74, v74 row_ror:8 row_mask:0xf bank_mask:0xf
    s_nop 1
    v_add_f32_dpp v74, v74, v74 row_ror:4 row_mask:0xf bank_mask:0xf
    s_nop 1
    v_add_f32_dpp v74, v74, v74 row_ror:2 row_mask:0xf bank_mask:0xf
    s_nop 1
    v_add_f32_dpp v74, v74, v74 row_ror:1 row_mask:0xf bank_mask:0xf
    v_mov_b32 v76, v74
    s_nop 1
    v_permlane16_swap_b32 v74, v76
    s_nop 0
    v_add_f32 v74, v74, v76
    v_mul_f32 v74, 0x3ae38e39, v74
    v_cvt_pk_bf16_f32 v76, v72, v74
    v_and_b32 v74, 0xffff0000, v76
    v_lshlrev_b32 v72, 16, v76
    v_add_f32 v74, 0x3727c5ac, v74
    v_cvt_pk_bf16_f32 v74, v74, v74
    v_and_b32 v74, 0xffff0000, v74
    v_sqrt_f32 v74, v74
    v_pk_add_f32 v[168:169], v[144:145], v[72:73] op_sel_hi:[1,0] neg_lo:[0,1] neg_hi:[0,1]
    v_pk_add_f32 v[170:171], v[146:147], v[72:73] op_sel_hi:[1,0] neg_lo:[0,1] neg_hi:[0,1]
    v_pk_add_f32 v[172:173], v[148:149], v[72:73] op_sel_hi:[1,0] neg_lo:[0,1] neg_hi:[0,1]
    v_pk_add_f32 v[174:175], v[150:151], v[72:73] op_sel_hi:[1,0] neg_lo:[0,1] neg_hi:[0,1]
    v_pk_add_f32 v[176:177], v[152:153], v[72:73] op_sel_hi:[1,0] neg_lo:[0,1] neg_hi:[0,1]
    v_pk_add_f32 v[178:179], v[154:155], v[72:73] op_sel_hi:[1,0] neg_lo:[0,1] neg_hi:[0,1]
    v_pk_add_f32 v[180:181], v[156:157], v[72:73] op_sel_hi:[1,0] neg_lo:[0,1] neg_hi:[0,1]
    v_pk_add_f32 v[182:183], v[158:159], v[72:73] op_sel_hi:[1,0] neg_lo:[0,1] neg_hi:[0,1]
    v_pk_add_f32 v[184:185], v[160:161], v[72:73] op_sel_hi:[1,0] neg_lo:[0,1] neg_hi:[0,1]
    v_pk_add_f32 v[186:187], v[162:163], v[72:73] op_sel_hi:[1,0] neg_lo:[0,1] neg_hi:[0,1]
    v_pk_add_f32 v[188:189], v[164:165], v[72:73] op_sel_hi:[1,0] neg_lo:[0,1] neg_hi:[0,1]
    v_pk_add_f32 v[190:191], v[166:167], v[72:73] op_sel_hi:[1,0] neg_lo:[0,1] neg_hi:[0,1]
    v_cvt_pk_bf16_f32 v74, v74, v74
    v_and_b32 v74, 0xffff0000, v74
    v_rcp_f32 v74, v74
    v_cvt_pk_bf16_f32 v108, v168, v169
    v_cvt_pk_bf16_f32 v109, v170, v171
    v_cvt_pk_bf16_f32 v110, v172, v173
    v_cvt_pk_bf16_f32 v111, v174, v175
    v_cvt_pk_bf16_f32 v112, v176, v177
    v_cvt_pk_bf16_f32 v113, v178, v179
    v_cvt_pk_bf16_f32 v114, v180, v181
    v_cvt_pk_bf16_f32 v115, v182, v183
    v_cvt_pk_bf16_f32 v116, v184, v185
    v_cvt_pk_bf16_f32 v117, v186, v187
    v_cvt_pk_bf16_f32 v118, v188, v189
    v_cvt_pk_bf16_f32 v119, v190, v191
    v_lshlrev_b32 v168, 16, v108
    v_and_b32 v169, 0xffff0000, v108
    v_lshlrev_b32 v170, 16, v109
    v_and_b32 v171, 0xffff0000, v109
    v_lshlrev_b32 v172, 16, v110
    v_and_b32 v173, 0xffff0000, v110
    v_lshlrev_b32 v174, 16, v111
    v_and_b32 v175, 0xffff0000, v111
    v_lshlrev_b32 v176, 16, v112
    v_and_b32 v177, 0xffff0000, v112
    v_lshlrev_b32 v178, 16, v113
    v_and_b32 v179, 0xffff0000, v113
    v_lshlrev_b32 v180, 16, v114
    v_and_b32 v181, 0xffff0000, v114
    v_lshlrev_b32 v182, 16, v115
    v_and_b32 v183, 0xffff0000, v115
    v_lshlrev_b32 v184, 16, v116
    v_and_b32 v185, 0xffff0000, v116
    v_lshlrev_b32 v186, 16, v117
    v_and_b32 v187, 0xffff0000, v117
    v_lshlrev_b32 v188, 16, v118
    v_and_b32 v189, 0xffff0000, v118
    v_lshlrev_b32 v190, 16, v119
    v_and_b32 v191, 0xffff0000, v119
    v_pk_mul_f32 v[168:169], v[168:169], v[74:75] op_sel_hi:[1,0]
    v_pk_mul_f32 v[170:171], v[170:171], v[74:75] op_sel_hi:[1,0]
    v_pk_mul_f32 v[172:173], v[172:173], v[74:75] op_sel_hi:[1,0]
    v_pk_mul_f32 v[174:175], v[174:175], v[74:75] op_sel_hi:[1,0]
    v_pk_mul_f32 v[176:177], v[176:177], v[74:75] op_sel_hi:[1,0]
    v_pk_mul_f32 v[178:179], v[178:179], v[74:75] op_sel_hi:[1,0]
    v_pk_mul_f32 v[180:181], v[180:181], v[74:75] op_sel_hi:[1,0]
    v_pk_mul_f32 v[182:183], v[182:183], v[74:75] op_sel_hi:[1,0]
    v_pk_mul_f32 v[184:185], v[184:185], v[74:75] op_sel_hi:[1,0]
    v_pk_mul_f32 v[186:187], v[186:187], v[74:75] op_sel_hi:[1,0]
    v_pk_mul_f32 v[188:189], v[188:189], v[74:75] op_sel_hi:[1,0]
    v_pk_mul_f32 v[190:191], v[190:191], v[74:75] op_sel_hi:[1,0]
    v_cvt_pk_bf16_f32 v108, v168, v169
    v_cvt_pk_bf16_f32 v109, v170, v171
    v_cvt_pk_bf16_f32 v110, v172, v173
    v_cvt_pk_bf16_f32 v111, v174, v175
    v_cvt_pk_bf16_f32 v112, v176, v177
    v_cvt_pk_bf16_f32 v113, v178, v179
    v_cvt_pk_bf16_f32 v114, v180, v181
    v_cvt_pk_bf16_f32 v115, v182, v183
    v_cvt_pk_bf16_f32 v116, v184, v185
    v_cvt_pk_bf16_f32 v117, v186, v187
    v_cvt_pk_bf16_f32 v118, v188, v189
    v_cvt_pk_bf16_f32 v119, v190, v191
    v_lshlrev_b32 v168, 16, v108
    v_and_b32 v169, 0xffff0000, v108
    v_lshlrev_b32 v170, 16, v109
    v_and_b32 v171, 0xffff0000, v109
    v_lshlrev_b32 v172, 16, v110
    v_and_b32 v173, 0xffff0000, v110
    v_lshlrev_b32 v174, 16, v111
    v_and_b32 v175, 0xffff0000, v111
    v_lshlrev_b32 v176, 16, v112
    v_and_b32 v177, 0xffff0000, v112
    v_lshlrev_b32 v178, 16, v113
    v_and_b32 v179, 0xffff0000, v113
    v_lshlrev_b32 v180, 16, v114
    v_and_b32 v181, 0xffff0000, v114
    v_lshlrev_b32 v182, 16, v115
    v_and_b32 v183, 0xffff0000, v115
    v_lshlrev_b32 v184, 16, v116
    v_and_b32 v185, 0xffff0000, v116
    v_lshlrev_b32 v186, 16, v117
    v_and_b32 v187, 0xffff0000, v117
    v_lshlrev_b32 v188, 16, v118
    v_and_b32 v189, 0xffff0000, v118
    v_lshlrev_b32 v190, 16, v119
    v_and_b32 v191, 0xffff0000, v119
    s_mov_b32 s38, 16384
    s_waitcnt vmcnt(2)
    v_xor_b32 v89, s95, v89
    v_xor_b32 v91, s95, v91
    s_waitcnt vmcnt(1)
    v_xor_b32 v93, s95, v93
    v_xor_b32 v95, s95, v95
    v_or3_b32 v89, v89, v91, v93
    v_or_b32 v89, v89, v95
    v_cmp_ne_u32 vcc, 0, v89
    s_cbranch_vccz Lhead_gotm
Lhead_pollm:
    buffer_load_dwordx4 v[88:91], v124, s[24:27], s37 offen sc1
    buffer_load_dwordx4 v[92:95], v125, s[24:27], s37 offen sc1
    s_waitcnt vmcnt(0)
    s_sub_u32 s38, s38, 1
    s_cbranch_scc1 Lhead_gotm
    v_xor_b32 v89, s95, v89
    v_xor_b32 v91, s95, v91
    v_xor_b32 v93, s95, v93
    v_xor_b32 v95, s95, v95
    v_or3_b32 v89, v89, v91, v93
    v_or_b32 v89, v89, v95
    v_cmp_ne_u32 vcc, 0, v89
    s_cbranch_vccnz Lhead_pollm
Lhead_gotm:
    ds_write2_b32 v122, v88, v90 offset0:0 offset1:1
    ds_write2_b32 v123, v92, v94 offset0:0 offset1:1
    s_waitcnt lgkmcnt(0)
    s_barrier
    ds_read_b128 v[144:147], v68 offset:2176
    ds_read_b128 v[148:151], v68 offset:2560
    ds_read_b128 v[152:155], v68 offset:2944
    ds_read_b128 v[156:159], v68 offset:1024
    ds_read_b128 v[160:163], v68 offset:1408
    ds_read_b128 v[164:167], v68 offset:1792
    s_waitcnt lgkmcnt(5)
    v_lshlrev_b32 v192, 16, v144
    v_and_b32 v193, 0xffff0000, v144
    v_lshlrev_b32 v194, 16, v145
    v_and_b32 v195, 0xffff0000, v145
    v_lshlrev_b32 v196, 16, v146
    v_and_b32 v197, 0xffff0000, v146
    v_lshlrev_b32 v198, 16, v147
    v_and_b32 v199, 0xffff0000, v147
    s_waitcnt lgkmcnt(4)
    v_lshlrev_b32 v200, 16, v148
    v_and_b32 v201, 0xffff0000, v148
    v_lshlrev_b32 v202, 16, v149
    v_and_b32 v203, 0xffff0000, v149
    v_lshlrev_b32 v204, 16, v150
    v_and_b32 v205, 0xffff0000, v150
    v_lshlrev_b32 v206, 16, v151
    v_and_b32 v207, 0xffff0000, v151
    s_waitcnt lgkmcnt(3)
    v_lshlrev_b32 v208, 16, v152
    v_and_b32 v209, 0xffff0000, v152
    v_lshlrev_b32 v210, 16, v153
    v_and_b32 v211, 0xffff0000, v153
    v_lshlrev_b32 v212, 16, v154
    v_and_b32 v213, 0xffff0000, v154
    v_lshlrev_b32 v214, 16, v155
    v_and_b32 v215, 0xffff0000, v155
    v_pk_mul_f32 v[168:169], v[168:169], v[192:193]
    v_pk_mul_f32 v[170:171], v[170:171], v[194:195]
    v_pk_mul_f32 v[172:173], v[172:173], v[196:197]
    v_pk_mul_f32 v[174:175], v[174:175], v[198:199]
    v_pk_mul_f32 v[176:177], v[176:177], v[200:201]
    v_pk_mul_f32 v[178:179], v[178:179], v[202:203]
    v_pk_mul_f32 v[180:181], v[180:181], v[204:205]
    v_pk_mul_f32 v[182:183], v[182:183], v[206:207]
    v_pk_mul_f32 v[184:185], v[184:185], v[208:209]
    v_pk_mul_f32 v[186:187], v[186:187], v[210:211]
    v_pk_mul_f32 v[188:189], v[188:189], v[212:213]
    v_pk_mul_f32 v[190:191], v[190:191], v[214:215]
    v_cvt_pk_bf16_f32 v108, v168, v169
    v_cvt_pk_bf16_f32 v109, v170, v171
    v_cvt_pk_bf16_f32 v110, v172, v173
    v_cvt_pk_bf16_f32 v111, v174, v175
    v_cvt_pk_bf16_f32 v112, v176, v177
    v_cvt_pk_bf16_f32 v113, v178, v179
    v_cvt_pk_bf16_f32 v114, v180, v181
    v_cvt_pk_bf16_f32 v115, v182, v183
    v_cvt_pk_bf16_f32 v116, v184, v185
    v_cvt_pk_bf16_f32 v117, v186, v187
    v_cvt_pk_bf16_f32 v118, v188, v189
    v_cvt_pk_bf16_f32 v119, v190, v191
    s_waitcnt lgkmcnt(2)
    v_lshlrev_b32 v216, 16, v156
    v_and_b32 v217, 0xffff0000, v156
    v_lshlrev_b32 v218, 16, v157
    v_and_b32 v219, 0xffff0000, v157
    v_lshlrev_b32 v220, 16, v158
    v_and_b32 v221, 0xffff0000, v158
    v_lshlrev_b32 v222, 16, v159
    v_and_b32 v223, 0xffff0000, v159
    s_waitcnt lgkmcnt(1)
    v_lshlrev_b32 v224, 16, v160
    v_and_b32 v225, 0xffff0000, v160
    v_lshlrev_b32 v226, 16, v161
    v_and_b32 v227, 0xffff0000, v161
    v_lshlrev_b32 v228, 16, v162
    v_and_b32 v229, 0xffff0000, v162
    v_lshlrev_b32 v230, 16, v163
    v_and_b32 v231, 0xffff0000, v163
    s_waitcnt lgkmcnt(0)
    v_lshlrev_b32 v232, 16, v164
    v_and_b32 v233, 0xffff0000, v164
    v_lshlrev_b32 v234, 16, v165
    v_and_b32 v235, 0xffff0000, v165
    v_lshlrev_b32 v236, 16, v166
    v_and_b32 v237, 0xffff0000, v166
    v_lshlrev_b32 v238, 16, v167
    v_and_b32 v239, 0xffff0000, v167
    v_lshlrev_b32 v168, 16, v108
    v_and_b32 v169, 0xffff0000, v108
    v_lshlrev_b32 v170, 16, v109
    v_and_b32 v171, 0xffff0000, v109
    v_lshlrev_b32 v172, 16, v110
    v_and_b32 v173, 0xffff0000, v110
    v_lshlrev_b32 v174, 16, v111
    v_and_b32 v175, 0xffff0000, v111
    v_lshlrev_b32 v176, 16, v112
    v_and_b32 v177, 0xffff0000, v112
    v_lshlrev_b32 v178, 16, v113
    v_and_b32 v179, 0xffff0000, v113
    v_lshlrev_b32 v180, 16, v114
    v_and_b32 v181, 0xffff0000, v114
    v_lshlrev_b32 v182, 16, v115
    v_and_b32 v183, 0xffff0000, v115
    v_lshlrev_b32 v184, 16, v116
    v_and_b32 v185, 0xffff0000, v116
    v_lshlrev_b32 v186, 16, v117
    v_and_b32 v187, 0xffff0000, v117
    v_lshlrev_b32 v188, 16, v118
    v_and_b32 v189, 0xffff0000, v118
    v_lshlrev_b32 v190, 16, v119
    v_and_b32 v191, 0xffff0000, v119
    v_pk_add_f32 v[168:169], v[168:169], v[216:217]
    v_pk_add_f32 v[170:171], v[170:171], v[218:219]
    v_pk_add_f32 v[172:173], v[172:173], v[220:221]
    v_pk_add_f32 v[174:175], v[174:175], v[222:223]
    v_cvt_pk_bf16_f32 v108, v168, v169
    v_cvt_pk_bf16_f32 v109, v170, v171
    v_cvt_pk_bf16_f32 v110, v172, v173
    v_cvt_pk_bf16_f32 v111, v174, v175
    buffer_store_dwordx4 v[108:111], v67, s[24:27], s92 offen offset:0 sc1
    v_pk_add_f32 v[176:177], v[176:177], v[224:225]
    v_pk_add_f32 v[178:179], v[178:179], v[226:227]
    v_pk_add_f32 v[180:181], v[180:181], v[228:229]
    v_pk_add_f32 v[182:183], v[182:183], v[230:231]
    v_cvt_pk_bf16_f32 v112, v176, v177
    v_cvt_pk_bf16_f32 v113, v178, v179
    v_cvt_pk_bf16_f32 v114, v180, v181
    v_cvt_pk_bf16_f32 v115, v182, v183
    buffer_store_dwordx4 v[112:115], v67, s[24:27], s92 offen offset:768 sc1
    v_pk_add_f32 v[184:185], v[184:185], v[232:233]
    v_pk_add_f32 v[186:187], v[186:187], v[234:235]
    v_pk_add_f32 v[188:189], v[188:189], v[236:237]
    v_pk_add_f32 v[190:191], v[190:191], v[238:239]
    v_cvt_pk_bf16_f32 v116, v184, v185
    v_cvt_pk_bf16_f32 v117, v186, v187
    v_cvt_pk_bf16_f32 v118, v188, v189
    v_cvt_pk_bf16_f32 v119, v190, v191
    buffer_store_dwordx4 v[116:119], v67, s[24:27], s92 offen offset:1536 sc1
    s_lshl_b32 s36, s5, 13
    s_add_u32 s36, s36, 8650752
    s_lshl_b32 s37, s4, 9
    s_add_u32 s37, s37, s36
    s_lshl_b32 s38, s3, 7
    s_add_u32 s37, s37, s38
    s_lshl_b32 s38, s3, 11
    s_add_u32 s36, s36, s38
    v_min_u32 v72, 1, v1
    v_lshlrev_b32 v72, 31, v72
    v_and_b32 v73, 15, v1
    v_lshlrev_b32 v73, 7, v73
    v_cmp_gt_u32 vcc, 162, v0
    v_mov_b32 v88, -1
    v_mov_b32 v89, -1
    v_mov_b32 v90, -1
    v_mov_b32 v91, -1
    s_mul_i32 s39, s2, 2592
    s_add_u32 s39, s39, 7864320
    v_lshl_add_u32 v74, v0, 4, s39
    s_lshl_b32 s39, s2, 7
    s_add_u32 s39, s39, 9306112
    v_mov_b32 v75, s39
    v_cndmask_b32 v74, v75, v74, vcc
    s_lshl_b32 s92, s5, 13
    s_add_u32 s92, s92, 8781824
    s_add_u32 s92, s92, s38
    s_lshl_b32 s38, s4, 7
    s_add_u32 s92, s92, s38
    s_getreg_b32 s38, hwreg(HW_REG_XCC_ID, 0, 4)
    s_add_u32 s38, s38, s95
    v_mov_b32 v76, s38
    v_mov_b32 v2, v80
    v_mov_b32 v3, v81
    v_mov_b32 v4, v82
    v_mov_b32 v5, v83
    v_mov_b32 v6, v84
    v_mov_b32 v7, v65
    v_and_b32 v126, 31, v1
    v_lshlrev_b32 v126, 2, v126
    s_waitcnt vmcnt(0)
    buffer_store_dword v137, v126, s[24:27], s37 offen sc1
    s_add_u32 s49, s44, 0
    s_add_u32 m0, s42, 32768
    s_nop 0
    buffer_load_dwordx4 v42, s[16:19], s49 offen lds
    buffer_load_dwordx4 v43, s[16:19], s49 offen offset:1024 lds
    buffer_load_dwordx4 v44, s[16:19], s49 offen offset:2048 lds
    buffer_load_dwordx4 v45, s[16:19], s49 offen offset:3072 lds
    s_add_u32 s49, s44, 256
    s_add_u32 m0, s42, 49152
    s_nop 0
    buffer_load_dwordx4 v42, s[16:19], s49 offen lds
    buffer_load_dwordx4 v43, s[16:19], s49 offen offset:1024 lds
    buffer_load_dwordx4 v44, s[16:19], s49 offen offset:2048 lds
    buffer_load_dwordx4 v45, s[16:19], s49 offen offset:3072 lds
    s_add_u32 s49, s44, 524288
    s_add_u32 m0, s42, 65536
    s_nop 0
    buffer_load_dwordx4 v42, s[16:19], s49 offen lds
    buffer_load_dwordx4 v43, s[16:19], s49 offen offset:1024 lds
    buffer_load_dwordx4 v44, s[16:19], s49 offen offset:2048 lds
    buffer_load_dwordx4 v45, s[16:19], s49 offen offset:3072 lds
    s_add_u32 s49, s44, 524544
    s_add_u32 m0, s42, 81920
    s_nop 0
    buffer_load_dwordx4 v42, s[16:19], s49 offen lds
    buffer_load_dwordx4 v43, s[16:19], s49 offen offset:1024 lds
    buffer_load_dwordx4 v44, s[16:19], s49 offen offset:2048 lds
    buffer_load_dwordx4 v45, s[16:19], s49 offen offset:3072 lds
    s_add_u32 s49, s44, 1048576
    s_add_u32 m0, s42, 98304
    s_nop 0
    buffer_load_dwordx4 v42, s[16:19], s49 offen lds
    buffer_load_dwordx4 v43, s[16:19], s49 offen offset:1024 lds
    buffer_load_dwordx4 v44, s[16:19], s49 offen offset:2048 lds
    buffer_load_dwordx4 v45, s[16:19], s49 offen offset:3072 lds
    s_add_u32 s49, s44, 1048832
    s_add_u32 m0, s42, 114688
    s_nop 0
    buffer_load_dwordx4 v42, s[16:19], s49 offen lds
    buffer_load_dwordx4 v43, s[16:19], s49 offen offset:1024 lds
    buffer_load_dwordx4 v44, s[16:19], s49 offen offset:2048 lds
    buffer_load_dwordx4 v45, s[16:19], s49 offen offset:3072 lds
    s_mov_b32 s38, 16384
Lhead_pollh:
    buffer_load_dword v75, v73, s[24:27], s36 offen sc1
    s_sub_u32 s38, s38, 1
    s_cbranch_scc1 Lhead_goth
    s_waitcnt vmcnt(0) lgkmcnt(0)
    v_cmp_ne_u32 vcc, s95, v75
    s_cbranch_vccnz Lhead_pollh
Lhead_goth:
    s_waitcnt vmcnt(0) lgkmcnt(0)
    buffer_load_dwordx4 a[0:3], v51, s[24:27], s46 offen offset:0 sc1
    buffer_load_dwordx4 a[8:11], v51, s[24:27], s46 offen offset:128 sc1
    buffer_load_dwordx4 a[4:7], v51, s[24:27], s43 offen offset:0 sc1
    buffer_load_dwordx4 a[12:15], v51, s[24:27], s43 offen offset:128 sc1
    s_barrier
    ds_read_b64_tr_b16 a[160:161], v12 offset:32768
    ds_read_b64_tr_b16 a[162:163], v12 offset:36864
    ds_read_b64_tr_b16 a[164:165], v12 offset:40960
    ds_read_b64_tr_b16 a[166:167], v12 offset:45056
    ds_read_b64_tr_b16 a[168:169], v13 offset:32768
    ds_read_b64_tr_b16 a[170:171], v13 offset:36864
    ds_read_b64_tr_b16 a[172:173], v13 offset:40960
    ds_read_b64_tr_b16 a[174:175], v13 offset:45056
    ds_read_b64_tr_b16 a[176:177], v14 offset:32768
    ds_read_b64_tr_b16 a[178:179], v14 offset:36864
    ds_read_b64_tr_b16 a[180:181], v14 offset:40960
    ds_read_b64_tr_b16 a[182:183], v14 offset:45056
    buffer_load_dwordx4 a[16:19], v51, s[24:27], s46 offen offset:256 sc1
    buffer_load_dwordx4 a[24:27], v51, s[24:27], s46 offen offset:384 sc1
    buffer_load_dwordx4 a[20:23], v51, s[24:27], s43 offen offset:256 sc1
    buffer_load_dwordx4 a[28:31], v51, s[24:27], s43 offen offset:384 sc1
    s_waitcnt lgkmcnt(10)
    s_waitcnt vmcnt(7)
    v_mfma_f32_16x16x32_bf16 v[128:131], a[160:163], a[0:3], 0
    s_waitcnt vmcnt(6)
    s_waitcnt lgkmcnt(8)
    ds_read_b64_tr_b16 a[184:185], v15 offset:32768
    v_mfma_f32_16x16x32_bf16 v[128:131], a[164:167], a[8:11], v[128:131]
    s_waitcnt vmcnt(5)
    ds_read_b64_tr_b16 a[186:187], v15 offset:36864
    v_mfma_f32_16x16x32_bf16 v[132:135], a[160:163], a[4:7], 0
    s_waitcnt vmcnt(4)
    ds_read_b64_tr_b16 a[188:189], v15 offset:40960
    v_mfma_f32_16x16x32_bf16 v[132:135], a[164:167], a[12:15], v[132:135]
    s_waitcnt lgkmcnt(9)
    buffer_load_dwordx4 a[32:35], v51, s[24:27], s46 offen offset:512 sc1
    v_mfma_f32_16x16x32_bf16 v[136:139], a[168:171], a[0:3], 0
    s_waitcnt lgkmcnt(7)
    ds_read_b64_tr_b16 a[190:191], v15 offset:45056
    ds_read_b64_tr_b16 a[160:161], v16 offset:32768
    v_mfma_f32_16x16x32_bf16 v[136:139], a[172:175], a[8:11], v[136:139]
    ds_read_b64_tr_b16 a[162:163], v16 offset:36864
    v_mfma_f32_16x16x32_bf16 v[140:143], a[168:171], a[4:7], 0
    ds_read_b64_tr_b16 a[164:165], v16 offset:40960
    v_mfma_f32_16x16x32_bf16 v[140:143], a[172:175], a[12:15], v[140:143]
    s_waitcnt lgkmcnt(9)
    buffer_load_dwordx4 a[40:43], v51, s[24:27], s46 offen offset:640 sc1
    v_mfma_f32_16x16x32_bf16 v[144:147], a[176:179], a[0:3], 0
    s_waitcnt lgkmcnt(7)
    ds_read_b64_tr_b16 a[166:167], v16 offset:45056
    ds_read_b64_tr_b16 a[168:169], v17 offset:32768
    v_mfma_f32_16x16x32_bf16 v[144:147], a[180:183], a[8:11], v[144:147]
    ds_read_b64_tr_b16 a[170:171], v17 offset:36864
    v_mfma_f32_16x16x32_bf16 v[148:151], a[176:179], a[4:7], 0
    ds_read_b64_tr_b16 a[172:173], v17 offset:40960
    v_mfma_f32_16x16x32_bf16 v[148:151], a[180:183], a[12:15], v[148:151]
    s_waitcnt lgkmcnt(9)
    buffer_load_dwordx4 a[36:39], v51, s[24:27], s43 offen offset:512 sc1
    v_mfma_f32_16x16x32_bf16 v[152:155], a[184:187], a[0:3], 0
    s_waitcnt lgkmcnt(7)
    ds_read_b64_tr_b16 a[174:175], v17 offset:45056
    ds_read_b64_tr_b16 a[176:177], v18 offset:32768
    v_mfma_f32_16x16x32_bf16 v[152:155], a[188:191], a[8:11], v[152:155]
    ds_read_b64_tr_b16 a[178:179], v18 offset:36864
    v_mfma_f32_16x16x32_bf16 v[156:159], a[184:187], a[4:7], 0
    ds_read_b64_tr_b16 a[180:181], v18 offset:40960
    v_mfma_f32_16x16x32_bf16 v[156:159], a[188:191], a[12:15], v[156:159]
    s_waitcnt lgkmcnt(9)
    buffer_load_dwordx4 a[44:47], v51, s[24:27], s43 offen offset:640 sc1
    v_mfma_f32_16x16x32_bf16 v[160:163], a[160:163], a[0:3], 0
    s_waitcnt lgkmcnt(7)
    ds_read_b64_tr_b16 a[182:183], v18 offset:45056
    ds_read_b64_tr_b16 a[184:185], v19 offset:32768
    v_mfma_f32_16x16x32_bf16 v[160:163], a[164:167], a[8:11], v[160:163]
    ds_read_b64_tr_b16 a[186:187], v19 offset:36864
    v_mfma_f32_16x16x32_bf16 v[164:167], a[160:163], a[4:7], 0
    ds_read_b64_tr_b16 a[188:189], v19 offset:40960
    v_mfma_f32_16x16x32_bf16 v[164:167], a[164:167], a[12:15], v[164:167]
    s_waitcnt lgkmcnt(9)
    buffer_load_dword v77, v70, s[16:19], s44 offen
    v_mfma_f32_16x16x32_bf16 v[168:171], a[168:171], a[0:3], 0
    s_waitcnt lgkmcnt(7)
    ds_read_b64_tr_b16 a[190:191], v19 offset:45056
    ds_read_b64_tr_b16 a[160:161], v12 offset:49152
    v_mfma_f32_16x16x32_bf16 v[168:171], a[172:175], a[8:11], v[168:171]
    ds_read_b64_tr_b16 a[162:163], v12 offset:53248
    v_mfma_f32_16x16x32_bf16 v[172:175], a[168:171], a[4:7], 0
    ds_read_b64_tr_b16 a[164:165], v12 offset:57344
    v_mfma_f32_16x16x32_bf16 v[172:175], a[172:175], a[12:15], v[172:175]
    s_waitcnt lgkmcnt(9)
    ds_read_b64_tr_b16 a[166:167], v12 offset:61440
    v_mfma_f32_16x16x32_bf16 v[176:179], a[176:179], a[0:3], 0
    s_waitcnt lgkmcnt(8)
    ds_read_b64_tr_b16 a[168:169], v13 offset:49152
    v_mfma_f32_16x16x32_bf16 v[176:179], a[180:183], a[8:11], v[176:179]
    ds_read_b64_tr_b16 a[170:171], v13 offset:53248
    v_mfma_f32_16x16x32_bf16 v[180:183], a[176:179], a[4:7], 0
    ds_read_b64_tr_b16 a[172:173], v13 offset:57344
    v_mfma_f32_16x16x32_bf16 v[180:183], a[180:183], a[12:15], v[180:183]
    s_waitcnt lgkmcnt(9)
    ds_read_b64_tr_b16 a[174:175], v13 offset:61440
    v_mfma_f32_16x16x32_bf16 v[184:187], a[184:187], a[0:3], 0
    s_waitcnt lgkmcnt(8)
    ds_read_b64_tr_b16 a[176:177], v14 offset:49152
    v_mfma_f32_16x16x32_bf16 v[184:187], a[188:191], a[8:11], v[184:187]
    ds_read_b64_tr_b16 a[178:179], v14 offset:53248
    v_mfma_f32_16x16x32_bf16 v[188:191], a[184:187], a[4:7], 0
    ds_read_b64_tr_b16 a[180:181], v14 offset:57344
    v_mfma_f32_16x16x32_bf16 v[188:191], a[188:191], a[12:15], v[188:191]
    s_waitcnt lgkmcnt(9)
    ds_read_b64_tr_b16 a[182:183], v14 offset:61440
    v_mfma_f32_16x16x32_bf16 v[192:195], a[160:163], a[0:3], 0
    s_waitcnt lgkmcnt(8)
    ds_read_b64_tr_b16 a[184:185], v15 offset:49152
    v_mfma_f32_16x16x32_bf16 v[192:195], a[164:167], a[8:11], v[192:195]
    ds_read_b64_tr_b16 a[186:187], v15 offset:53248
    v_mfma_f32_16x16x32_bf16 v[196:199], a[160:163], a[4:7], 0
    ds_read_b64_tr_b16 a[188:189], v15 offset:57344
    v_mfma_f32_16x16x32_bf16 v[196:199], a[164:167], a[12:15], v[196:199]
    s_waitcnt lgkmcnt(9)
    ds_read_b64_tr_b16 a[190:191], v15 offset:61440
    v_mfma_f32_16x16x32_bf16 v[200:203], a[168:171], a[0:3], 0
    s_waitcnt lgkmcnt(8)
    ds_read_b64_tr_b16 a[160:161], v16 offset:49152
    v_mfma_f32_16x16x32_bf16 v[200:203], a[172:175], a[8:11], v[200:203]
    ds_read_b64_tr_b16 a[162:163], v16 offset:53248
    v_mfma_f32_16x16x32_bf16 v[204:207], a[168:171], a[4:7], 0
    ds_read_b64_tr_b16 a[164:165], v16 offset:57344
    v_mfma_f32_16x16x32_bf16 v[204:207], a[172:175], a[12:15], v[204:207]
    s_waitcnt lgkmcnt(9)
    ds_read_b64_tr_b16 a[166:167], v16 offset:61440
    v_mfma_f32_16x16x32_bf16 v[208:211], a[176:179], a[0:3], 0
    s_waitcnt lgkmcnt(8)
    ds_read_b64_tr_b16 a[168:169], v17 offset:49152
    v_mfma_f32_16x16x32_bf16 v[208:211], a[180:183], a[8:11], v[208:211]
    ds_read_b64_tr_b16 a[170:171], v17 offset:53248
    v_mfma_f32_16x16x32_bf16 v[212:215], a[176:179], a[4:7], 0
    ds_read_b64_tr_b16 a[172:173], v17 offset:57344
    v_mfma_f32_16x16x32_bf16 v[212:215], a[180:183], a[12:15], v[212:215]
    s_waitcnt lgkmcnt(9)
    ds_read_b64_tr_b16 a[174:175], v17 offset:61440
    v_mfma_f32_16x16x32_bf16 v[216:219], a[184:187], a[0:3], 0
    s_waitcnt lgkmcnt(8)
    ds_read_b64_tr_b16 a[176:177], v18 offset:49152
    v_mfma_f32_16x16x32_bf16 v[216:219], a[188:191], a[8:11], v[216:219]
    ds_read_b64_tr_b16 a[178:179], v18 offset:53248
    v_mfma_f32_16x16x32_bf16 v[220:223], a[184:187], a[4:7], 0
    ds_read_b64_tr_b16 a[180:181], v18 offset:57344
    v_mfma_f32_16x16x32_bf16 v[220:223], a[188:191], a[12:15], v[220:223]
    s_waitcnt lgkmcnt(9)
    ds_read_b64_tr_b16 a[182:183], v18 offset:61440
    v_mfma_f32_16x16x32_bf16 v[224:227], a[160:163], a[0:3], 0
    s_waitcnt lgkmcnt(8)
    ds_read_b64_tr_b16 a[184:185], v19 offset:49152
    v_mfma_f32_16x16x32_bf16 v[224:227], a[164:167], a[8:11], v[224:227]
Ltour0:
    s_cbranch_execz Ltour4
    ds_read_b64_tr_b16 a[186:187], v19 offset:53248
    v_mfma_f32_16x16x32_bf16 v[228:231], a[160:163], a[4:7], 0
    ds_read_b64_tr_b16 a[188:189], v19 offset:57344
    v_mfma_f32_16x16x32_bf16 v[228:231], a[164:167], a[12:15], v[228:231]
    s_waitcnt lgkmcnt(9)
    ds_read_b64_tr_b16 a[190:191], v19 offset:61440
    s_barrier
    v_mfma_f32_16x16x32_bf16 v[232:235], a[168:171], a[0:3], 0
    s_waitcnt lgkmcnt(8)
    ds_read_b64_tr_b16 a[160:161], v20 offset:0
    v_mfma_f32_16x16x32_bf16 v[232:235], a[172:175], a[8:11], v[232:235]
    s_add_u32 s49, s44, 1572864
    ds_read_b64_tr_b16 a[162:163], v20 offset:4096
    v_mfma_f32_16x16x32_bf16 v[236:239], a[168:171], a[4:7], 0
    s_add_u32 m0, s42, 131072
    ds_read_b64_tr_b16 a[164:165], v20 offset:8192
    v_mfma_f32_16x16x32_bf16 v[236:239], a[172:175], a[12:15], v[236:239]
    s_waitcnt lgkmcnt(9)
    buffer_load_dwordx4 v42, s[16:19], s49 offen lds
    v_mfma_f32_16x16x32_bf16 v[240:243], a[176:179], a[0:3], 0
    s_waitcnt lgkmcnt(7)
    ds_read_b64_tr_b16 a[166:167], v20 offset:12288
    ds_read_b64_tr_b16 a[168:169], v21 offset:0
    v_mfma_f32_16x16x32_bf16 v[240:243], a[180:183], a[8:11], v[240:243]
    ds_read_b64_tr_b16 a[170:171], v21 offset:4096
    v_mfma_f32_16x16x32_bf16 v[244:247], a[176:179], a[4:7], 0
    ds_read_b64_tr_b16 a[172:173], v21 offset:8192
    v_mfma_f32_16x16x32_bf16 v[244:247], a[180:183], a[12:15], v[244:247]
    s_waitcnt lgkmcnt(9)
    buffer_load_dwordx4 v43, s[16:19], s49 offen offset:1024 lds
    v_mfma_f32_16x16x32_bf16 v[248:251], a[184:187], a[0:3], 0
    s_waitcnt lgkmcnt(7)
    ds_read_b64_tr_b16 a[174:175], v21 offset:12288
    ds_read_b64_tr_b16 a[176:177], v22 offset:0
    v_mfma_f32_16x16x32_bf16 v[248:251], a[188:191], a[8:11], v[248:251]
    ds_read_b64_tr_b16 a[178:179], v22 offset:4096
    v_mfma_f32_16x16x32_bf16 v[252:255], a[184:187], a[4:7], 0
    ds_read_b64_tr_b16 a[180:181], v22 offset:8192
    v_mfma_f32_16x16x32_bf16 v[252:255], a[188:191], a[12:15], v[252:255]
    s_waitcnt vmcnt(10)
    s_waitcnt lgkmcnt(9)
    buffer_load_dwordx4 v44, s[16:19], s49 offen offset:2048 lds
    v_mfma_f32_16x16x32_bf16 v[128:131], a[160:163], a[16:19], v[128:131]
    s_waitcnt vmcnt(10)
    s_waitcnt lgkmcnt(7)
    ds_read_b64_tr_b16 a[182:183], v22 offset:12288
    ds_read_b64_tr_b16 a[184:185], v23 offset:0
    v_mfma_f32_16x16x32_bf16 v[128:131], a[164:167], a[24:27], v[128:131]
    s_waitcnt vmcnt(9)
    ds_read_b64_tr_b16 a[186:187], v23 offset:4096
    v_mfma_f32_16x16x32_bf16 v[132:135], a[160:163], a[20:23], v[132:135]
    s_waitcnt vmcnt(8)
    ds_read_b64_tr_b16 a[188:189], v23 offset:8192
    v_mfma_f32_16x16x32_bf16 v[132:135], a[164:167], a[28:31], v[132:135]
    s_waitcnt lgkmcnt(9)
    buffer_load_dwordx4 v45, s[16:19], s49 offen offset:3072 lds
    v_mfma_f32_16x16x32_bf16 v[136:139], a[168:171], a[16:19], v[136:139]
    s_waitcnt lgkmcnt(7)
    ds_read_b64_tr_b16 a[190:191], v23 offset:12288
    ds_read_b64_tr_b16 a[160:161], v24 offset:0
    v_mfma_f32_16x16x32_bf16 v[136:139], a[172:175], a[24:27], v[136:139]
    s_add_u32 s49, s44, 1573120
    ds_read_b64_tr_b16 a[162:163], v24 offset:4096
    v_mfma_f32_16x16x32_bf16 v[140:143], a[168:171], a[20:23], v[140:143]
    s_add_u32 m0, s42, 147456
    ds_read_b64_tr_b16 a[164:165], v24 offset:8192
    v_mfma_f32_16x16x32_bf16 v[140:143], a[172:175], a[28:31], v[140:143]
    s_waitcnt lgkmcnt(9)
    buffer_load_dwordx4 v42, s[16:19], s49 offen lds
    v_mfma_f32_16x16x32_bf16 v[144:147], a[176:179], a[16:19], v[144:147]
    s_waitcnt lgkmcnt(7)
    ds_read_b64_tr_b16 a[166:167], v24 offset:12288
    ds_read_b64_tr_b16 a[168:169], v25 offset:0
    v_mfma_f32_16x16x32_bf16 v[144:147], a[180:183], a[24:27], v[144:147]
    ds_read_b64_tr_b16 a[170:171], v25 offset:4096
    v_mfma_f32_16x16x32_bf16 v[148:151], a[176:179], a[20:23], v[148:151]
    ds_read_b64_tr_b16 a[172:173], v25 offset:8192
    v_mfma_f32_16x16x32_bf16 v[148:151], a[180:183], a[28:31], v[148:151]
    s_waitcnt lgkmcnt(9)
    buffer_load_dwordx4 v43, s[16:19], s49 offen offset:1024 lds
    v_mfma_f32_16x16x32_bf16 v[152:155], a[184:187], a[16:19], v[152:155]
    s_waitcnt lgkmcnt(7)
    ds_read_b64_tr_b16 a[174:175], v25 offset:12288
    ds_read_b64_tr_b16 a[176:177], v26 offset:0
    v_mfma_f32_16x16x32_bf16 v[152:155], a[188:191], a[24:27], v[152:155]
    ds_read_b64_tr_b16 a[178:179], v26 offset:4096
    v_mfma_f32_16x16x32_bf16 v[156:159], a[184:187], a[20:23], v[156:159]
    ds_read_b64_tr_b16 a[180:181], v26 offset:8192
    v_mfma_f32_16x16x32_bf16 v[156:159], a[188:191], a[28:31], v[156:159]
    s_waitcnt lgkmcnt(9)
    buffer_load_dwordx4 v44, s[16:19], s49 offen offset:2048 lds
    v_mfma_f32_16x16x32_bf16 v[160:163], a[160:163], a[16:19], v[160:163]
    s_waitcnt lgkmcnt(7)
    ds_read_b64_tr_b16 a[182:183], v26 offset:12288
    ds_read_b64_tr_b16 a[184:185], v27 offset:0
    v_mfma_f32_16x16x32_bf16 v[160:163], a[164:167], a[24:27], v[160:163]
    ds_read_b64_tr_b16 a[186:187], v27 offset:4096
    v_mfma_f32_16x16x32_bf16 v[164:167], a[160:163], a[20:23], v[164:167]
    ds_read_b64_tr_b16 a[188:189], v27 offset:8192
    v_mfma_f32_16x16x32_bf16 v[164:167], a[164:167], a[28:31], v[164:167]
    s_waitcnt lgkmcnt(9)
    buffer_load_dwordx4 v45, s[16:19], s49 offen offset:3072 lds
    v_mfma_f32_16x16x32_bf16 v[168:171], a[168:171], a[16:19], v[168:171]
    s_waitcnt lgkmcnt(7)
    ds_read_b64_tr_b16 a[190:191], v27 offset:12288
    ds_read_b64_tr_b16 a[160:161], v20 offset:16384
    v_mfma_f32_16x16x32_bf16 v[168:171], a[172:175], a[24:27], v[168:171]
    ds_read_b64_tr_b16 a[162:163], v20 offset:20480
    v_mfma_f32_16x16x32_bf16 v[172:175], a[168:171], a[20:23], v[172:175]
    ds_read_b64_tr_b16 a[164:165], v20 offset:24576
    v_mfma_f32_16x16x32_bf16 v[172:175], a[172:175], a[28:31], v[172:175]
    s_waitcnt lgkmcnt(9)
    buffer_load_dwordx4 a[48:51], v51, s[24:27], s46 offen offset:768 sc1
    v_mfma_f32_16x16x32_bf16 v[176:179], a[176:179], a[16:19], v[176:179]
    s_waitcnt lgkmcnt(7)
    ds_read_b64_tr_b16 a[166:167], v20 offset:28672
    ds_read_b64_tr_b16 a[168:169], v21 offset:16384
    v_mfma_f32_16x16x32_bf16 v[176:179], a[180:183], a[24:27], v[176:179]
    ds_read_b64_tr_b16 a[170:171], v21 offset:20480
    v_mfma_f32_16x16x32_bf16 v[180:183], a[176:179], a[20:23], v[180:183]
    ds_read_b64_tr_b16 a[172:173], v21 offset:24576
    v_mfma_f32_16x16x32_bf16 v[180:183], a[180:183], a[28:31], v[180:183]
    s_waitcnt lgkmcnt(9)
    buffer_load_dwordx4 a[56:59], v51, s[24:27], s46 offen offset:896 sc1
    v_mfma_f32_16x16x32_bf16 v[184:187], a[184:187], a[16:19], v[184:187]
    s_waitcnt lgkmcnt(7)
    ds_read_b64_tr_b16 a[174:175], v21 offset:28672
    ds_read_b64_tr_b16 a[176:177], v22 offset:16384
    v_mfma_f32_16x16x32_bf16 v[184:187], a[188:191], a[24:27], v[184:187]
    ds_read_b64_tr_b16 a[178:179], v22 offset:20480
    v_mfma_f32_16x16x32_bf16 v[188:191], a[184:187], a[20:23], v[188:191]
    ds_read_b64_tr_b16 a[180:181], v22 offset:24576
    v_mfma_f32_16x16x32_bf16 v[188:191], a[188:191], a[28:31], v[188:191]
    s_waitcnt lgkmcnt(9)
    buffer_load_dwordx4 a[52:55], v51, s[24:27], s43 offen offset:768 sc1
    v_mfma_f32_16x16x32_bf16 v[192:195], a[160:163], a[16:19], v[192:195]
    s_waitcnt lgkmcnt(7)
    ds_read_b64_tr_b16 a[182:183], v22 offset:28672
    ds_read_b64_tr_b16 a[184:185], v23 offset:16384
    v_mfma_f32_16x16x32_bf16 v[192:195], a[164:167], a[24:27], v[192:195]
    ds_read_b64_tr_b16 a[186:187], v23 offset:20480
    v_mfma_f32_16x16x32_bf16 v[196:199], a[160:163], a[20:23], v[196:199]
    ds_read_b64_tr_b16 a[188:189], v23 offset:24576
    v_mfma_f32_16x16x32_bf16 v[196:199], a[164:167], a[28:31], v[196:199]
    s_waitcnt lgkmcnt(9)
    buffer_load_dwordx4 a[60:63], v51, s[24:27], s43 offen offset:896 sc1
    v_mfma_f32_16x16x32_bf16 v[200:203], a[168:171], a[16:19], v[200:203]
    s_waitcnt lgkmcnt(7)
    ds_read_b64_tr_b16 a[190:191], v23 offset:28672
    ds_read_b64_tr_b16 a[160:161], v24 offset:16384
    v_mfma_f32_16x16x32_bf16 v[200:203], a[172:175], a[24:27], v[200:203]
    ds_read_b64_tr_b16 a[162:163], v24 offset:20480
    v_mfma_f32_16x16x32_bf16 v[204:207], a[168:171], a[20:23], v[204:207]
    ds_read_b64_tr_b16 a[164:165], v24 offset:24576
    v_mfma_f32_16x16x32_bf16 v[204:207], a[172:175], a[28:31], v[204:207]
    s_waitcnt lgkmcnt(9)
    ds_read_b64_tr_b16 a[166:167], v24 offset:28672
    v_mfma_f32_16x16x32_bf16 v[208:211], a[176:179], a[16:19], v[208:211]
    s_waitcnt lgkmcnt(8)
    ds_read_b64_tr_b16 a[168:169], v25 offset:16384
    v_mfma_f32_16x16x32_bf16 v[208:211], a[180:183], a[24:27], v[208:211]
    ds_read_b64_tr_b16 a[170:171], v25 offset:20480
    v_mfma_f32_16x16x32_bf16 v[212:215], a[176:179], a[20:23], v[212:215]
    ds_read_b64_tr_b16 a[172:173], v25 offset:24576
    v_mfma_f32_16x16x32_bf16 v[212:215], a[180:183], a[28:31], v[212:215]
    s_waitcnt lgkmcnt(9)
    ds_read_b64_tr_b16 a[174:175], v25 offset:28672
    v_mfma_f32_16x16x32_bf16 v[216:219], a[184:187], a[16:19], v[216:219]
    s_waitcnt lgkmcnt(8)
    ds_read_b64_tr_b16 a[176:177], v26 offset:16384
    v_mfma_f32_16x16x32_bf16 v[216:219], a[188:191], a[24:27], v[216:219]
    ds_read_b64_tr_b16 a[178:179], v26 offset:20480
    v_mfma_f32_16x16x32_bf16 v[220:223], a[184:187], a[20:23], v[220:223]
    ds_read_b64_tr_b16 a[180:181], v26 offset:24576
    v_mfma_f32_16x16x32_bf16 v[220:223], a[188:191], a[28:31], v[220:223]
    s_waitcnt lgkmcnt(9)
    ds_read_b64_tr_b16 a[182:183], v26 offset:28672
    v_mfma_f32_16x16x32_bf16 v[224:227], a[160:163], a[16:19], v[224:227]
    s_waitcnt lgkmcnt(8)
    ds_read_b64_tr_b16 a[184:185], v27 offset:16384
    v_mfma_f32_16x16x32_bf16 v[224:227], a[164:167], a[24:27], v[224:227]
    ds_read_b64_tr_b16 a[186:187], v27 offset:20480
    v_mfma_f32_16x16x32_bf16 v[228:231], a[160:163], a[20:23], v[228:231]
    ds_read_b64_tr_b16 a[188:189], v27 offset:24576
    v_mfma_f32_16x16x32_bf16 v[228:231], a[164:167], a[28:31], v[228:231]
    s_waitcnt lgkmcnt(9)
    ds_read_b64_tr_b16 a[190:191], v27 offset:28672
    s_barrier
    v_mfma_f32_16x16x32_bf16 v[232:235], a[168:171], a[16:19], v[232:235]
    s_waitcnt lgkmcnt(8)
    ds_read_b64_tr_b16 a[160:161], v20 offset:32768
    v_mfma_f32_16x16x32_bf16 v[232:235], a[172:175], a[24:27], v[232:235]
    s_add_u32 s49, s44, 2097152
    ds_read_b64_tr_b16 a[162:163], v20 offset:36864
    v_mfma_f32_16x16x32_bf16 v[236:239], a[168:171], a[20:23], v[236:239]
    s_add_u32 m0, s42, 0
    ds_read_b64_tr_b16 a[164:165], v20 offset:40960
    v_mfma_f32_16x16x32_bf16 v[236:239], a[172:175], a[28:31], v[236:239]
    s_waitcnt lgkmcnt(9)
    buffer_load_dwordx4 v42, s[16:19], s49 offen lds
    v_mfma_f32_16x16x32_bf16 v[240:243], a[176:179], a[16:19], v[240:243]
    s_waitcnt lgkmcnt(7)
    ds_read_b64_tr_b16 a[166:167], v20 offset:45056
    ds_read_b64_tr_b16 a[168:169], v21 offset:32768
    v_mfma_f32_16x16x32_bf16 v[240:243], a[180:183], a[24:27], v[240:243]
    ds_read_b64_tr_b16 a[170:171], v21 offset:36864
    v_mfma_f32_16x16x32_bf16 v[244:247], a[176:179], a[20:23], v[244:247]
    ds_read_b64_tr_b16 a[172:173], v21 offset:40960
    v_mfma_f32_16x16x32_bf16 v[244:247], a[180:183], a[28:31], v[244:247]
    s_waitcnt lgkmcnt(9)
    buffer_load_dwordx4 v43, s[16:19], s49 offen offset:1024 lds
    v_mfma_f32_16x16x32_bf16 v[248:251], a[184:187], a[16:19], v[248:251]
    s_waitcnt lgkmcnt(7)
    ds_read_b64_tr_b16 a[174:175], v21 offset:45056
    ds_read_b64_tr_b16 a[176:177], v22 offset:32768
    v_mfma_f32_16x16x32_bf16 v[248:251], a[188:191], a[24:27], v[248:251]
    ds_read_b64_tr_b16 a[178:179], v22 offset:36864
    v_mfma_f32_16x16x32_bf16 v[252:255], a[184:187], a[20:23], v[252:255]
    ds_read_b64_tr_b16 a[180:181], v22 offset:40960
    v_mfma_f32_16x16x32_bf16 v[252:255], a[188:191], a[28:31], v[252:255]
    s_waitcnt vmcnt(18)
    s_waitcnt lgkmcnt(9)
    buffer_load_dwordx4 v44, s[16:19], s49 offen offset:2048 lds
    v_mfma_f32_16x16x32_bf16 v[128:131], a[160:163], a[32:35], v[128:131]
    s_waitcnt vmcnt(18)
    s_waitcnt lgkmcnt(7)
    ds_read_b64_tr_b16 a[182:183], v22 offset:45056
    ds_read_b64_tr_b16 a[184:185], v23 offset:32768
    v_mfma_f32_16x16x32_bf16 v[128:131], a[164:167], a[40:43], v[128:131]
    s_waitcnt vmcnt(17)
    ds_read_b64_tr_b16 a[186:187], v23 offset:36864
    v_mfma_f32_16x16x32_bf16 v[132:135], a[160:163], a[36:39], v[132:135]
    s_waitcnt vmcnt(16)
    ds_read_b64_tr_b16 a[188:189], v23 offset:40960
    v_mfma_f32_16x16x32_bf16 v[132:135], a[164:167], a[44:47], v[132:135]
    s_waitcnt lgkmcnt(9)
    buffer_load_dwordx4 v45, s[16:19], s49 offen offset:3072 lds
    v_mfma_f32_16x16x32_bf16 v[136:139], a[168:171], a[32:35], v[136:139]
    s_waitcnt lgkmcnt(7)
    ds_read_b64_tr_b16 a[190:191], v23 offset:45056
    ds_read_b64_tr_b16 a[160:161], v24 offset:32768
    v_mfma_f32_16x16x32_bf16 v[136:139], a[172:175], a[40:43], v[136:139]
    s_add_u32 s49, s44, 2097408
    ds_read_b64_tr_b16 a[162:163], v24 offset:36864
    v_mfma_f32_16x16x32_bf16 v[140:143], a[168:171], a[36:39], v[140:143]
    s_add_u32 m0, s42, 16384
    ds_read_b64_tr_b16 a[164:165], v24 offset:40960
    v_mfma_f32_16x16x32_bf16 v[140:143], a[172:175], a[44:47], v[140:143]
    s_waitcnt lgkmcnt(9)
    buffer_load_dwordx4 v42, s[16:19], s49 offen lds
    v_mfma_f32_16x16x32_bf16 v[144:147], a[176:179], a[32:35], v[144:147]
    s_waitcnt lgkmcnt(7)
    ds_read_b64_tr_b16 a[166:167], v24 offset:45056
    ds_read_b64_tr_b16 a[168:169], v25 offset:32768
    v_mfma_f32_16x16x32_bf16 v[144:147], a[180:183], a[40:43], v[144:147]
    ds_read_b64_tr_b16 a[170:171], v25 offset:36864
    v_mfma_f32_16x16x32_bf16 v[148:151], a[176:179], a[36:39], v[148:151]
    ds_read_b64_tr_b16 a[172:173], v25 offset:40960
    v_mfma_f32_16x16x32_bf16 v[148:151], a[180:183], a[44:47], v[148:151]
    s_waitcnt lgkmcnt(9)
    buffer_load_dwordx4 v43, s[16:19], s49 offen offset:1024 lds
    v_mfma_f32_16x16x32_bf16 v[152:155], a[184:187], a[32:35], v[152:155]
    s_waitcnt lgkmcnt(7)
    ds_read_b64_tr_b16 a[174:175], v25 offset:45056
    ds_read_b64_tr_b16 a[176:177], v26 offset:32768
    v_mfma_f32_16x16x32_bf16 v[152:155], a[188:191], a[40:43], v[152:155]
    ds_read_b64_tr_b16 a[178:179], v26 offset:36864
    v_mfma_f32_16x16x32_bf16 v[156:159], a[184:187], a[36:39], v[156:159]
    ds_read_b64_tr_b16 a[180:181], v26 offset:40960
    v_mfma_f32_16x16x32_bf16 v[156:159], a[188:191], a[44:47], v[156:159]
    s_waitcnt lgkmcnt(9)
    buffer_load_dwordx4 v44, s[16:19], s49 offen offset:2048 lds
    v_mfma_f32_16x16x32_bf16 v[160:163], a[160:163], a[32:35], v[160:163]
    s_waitcnt lgkmcnt(7)
    ds_read_b64_tr_b16 a[182:183], v26 offset:45056
    ds_read_b64_tr_b16 a[184:185], v27 offset:32768
    v_mfma_f32_16x16x32_bf16 v[160:163], a[164:167], a[40:43], v[160:163]
    ds_read_b64_tr_b16 a[186:187], v27 offset:36864
    v_mfma_f32_16x16x32_bf16 v[164:167], a[160:163], a[36:39], v[164:167]
    ds_read_b64_tr_b16 a[188:189], v27 offset:40960
    v_mfma_f32_16x16x32_bf16 v[164:167], a[164:167], a[44:47], v[164:167]
    s_waitcnt lgkmcnt(9)
    buffer_load_dwordx4 v45, s[16:19], s49 offen offset:3072 lds
    v_mfma_f32_16x16x32_bf16 v[168:171], a[168:171], a[32:35], v[168:171]
    s_waitcnt lgkmcnt(7)
    ds_read_b64_tr_b16 a[190:191], v27 offset:45056
    ds_read_b64_tr_b16 a[160:161], v20 offset:49152
    v_mfma_f32_16x16x32_bf16 v[168:171], a[172:175], a[40:43], v[168:171]
    ds_read_b64_tr_b16 a[162:163], v20 offset:53248
    v_mfma_f32_16x16x32_bf16 v[172:175], a[168:171], a[36:39], v[172:175]
    ds_read_b64_tr_b16 a[164:165], v20 offset:57344
    v_mfma_f32_16x16x32_bf16 v[172:175], a[172:175], a[44:47], v[172:175]
    s_waitcnt lgkmcnt(9)
    buffer_load_dwordx4 a[64:67], v51, s[24:27], s46 offen offset:1024 sc1
    v_mfma_f32_16x16x32_bf16 v[176:179], a[176:179], a[32:35], v[176:179]
    s_waitcnt lgkmcnt(7)
    ds_read_b64_tr_b16 a[166:167], v20 offset:61440
    ds_read_b64_tr_b16 a[168:169], v21 offset:49152
    v_mfma_f32_16x16x32_bf16 v[176:179], a[180:183], a[40:43], v[176:179]
    ds_read_b64_tr_b16 a[170:171], v21 offset:53248
    v_mfma_f32_16x16x32_bf16 v[180:183], a[176:179], a[36:39], v[180:183]
    ds_read_b64_tr_b16 a[172:173], v21 offset:57344
    v_mfma_f32_16x16x32_bf16 v[180:183], a[180:183], a[44:47], v[180:183]
    s_waitcnt lgkmcnt(9)
    buffer_load_dwordx4 a[72:75], v51, s[24:27], s46 offen offset:1152 sc1
    v_mfma_f32_16x16x32_bf16 v[184:187], a[184:187], a[32:35], v[184:187]
    s_waitcnt lgkmcnt(7)
    ds_read_b64_tr_b16 a[174:175], v21 offset:61440
    ds_read_b64_tr_b16 a[176:177], v22 offset:49152
    v_mfma_f32_16x16x32_bf16 v[184:187], a[188:191], a[40:43], v[184:187]
    ds_read_b64_tr_b16 a[178:179], v22 offset:53248
    v_mfma_f32_16x16x32_bf16 v[188:191], a[184:187], a[36:39], v[188:191]
    ds_read_b64_tr_b16 a[180:181], v22 offset:57344
    v_mfma_f32_16x16x32_bf16 v[188:191], a[188:191], a[44:47], v[188:191]
    s_waitcnt lgkmcnt(9)
    buffer_load_dwordx4 a[68:71], v51, s[24:27], s43 offen offset:1024 sc1
    v_mfma_f32_16x16x32_bf16 v[192:195], a[160:163], a[32:35], v[192:195]
    s_waitcnt lgkmcnt(7)
    ds_read_b64_tr_b16 a[182:183], v22 offset:61440
    ds_read_b64_tr_b16 a[184:185], v23 offset:49152
    v_mfma_f32_16x16x32_bf16 v[192:195], a[164:167], a[40:43], v[192:195]
    ds_read_b64_tr_b16 a[186:187], v23 offset:53248
    v_mfma_f32_16x16x32_bf16 v[196:199], a[160:163], a[36:39], v[196:199]
    ds_read_b64_tr_b16 a[188:189], v23 offset:57344
    v_mfma_f32_16x16x32_bf16 v[196:199], a[164:167], a[44:47], v[196:199]
    s_waitcnt lgkmcnt(9)
    buffer_load_dwordx4 a[76:79], v51, s[24:27], s43 offen offset:1152 sc1
    v_mfma_f32_16x16x32_bf16 v[200:203], a[168:171], a[32:35], v[200:203]
    s_waitcnt lgkmcnt(7)
    ds_read_b64_tr_b16 a[190:191], v23 offset:61440
    ds_read_b64_tr_b16 a[160:161], v24 offset:49152
    v_mfma_f32_16x16x32_bf16 v[200:203], a[172:175], a[40:43], v[200:203]
    ds_read_b64_tr_b16 a[162:163], v24 offset:53248
    v_mfma_f32_16x16x32_bf16 v[204:207], a[168:171], a[36:39], v[204:207]
    ds_read_b64_tr_b16 a[164:165], v24 offset:57344
    v_mfma_f32_16x16x32_bf16 v[204:207], a[172:175], a[44:47], v[204:207]
    s_waitcnt lgkmcnt(9)
    buffer_load_dwordx4 a[80:83], v51, s[24:27], s46 offen offset:1280 sc1
    v_mfma_f32_16x16x32_bf16 v[208:211], a[176:179], a[32:35], v[208:211]
    s_waitcnt lgkmcnt(7)
    ds_read_b64_tr_b16 a[166:167], v24 offset:61440
    ds_read_b64_tr_b16 a[168:169], v25 offset:49152
    v_mfma_f32_16x16x32_bf16 v[208:211], a[180:183], a[40:43], v[208:211]
    ds_read_b64_tr_b16 a[170:171], v25 offset:53248
    v_mfma_f32_16x16x32_bf16 v[212:215], a[176:179], a[36:39], v[212:215]
    ds_read_b64_tr_b16 a[172:173], v25 offset:57344
    v_mfma_f32_16x16x32_bf16 v[212:215], a[180:183], a[44:47], v[212:215]
    s_waitcnt lgkmcnt(9)
    buffer_load_dwordx4 a[88:91], v51, s[24:27], s46 offen offset:1408 sc1
    v_mfma_f32_16x16x32_bf16 v[216:219], a[184:187], a[32:35], v[216:219]
    s_waitcnt lgkmcnt(7)
    ds_read_b64_tr_b16 a[174:175], v25 offset:61440
    ds_read_b64_tr_b16 a[176:177], v26 offset:49152
    v_mfma_f32_16x16x32_bf16 v[216:219], a[188:191], a[40:43], v[216:219]
    ds_read_b64_tr_b16 a[178:179], v26 offset:53248
    v_mfma_f32_16x16x32_bf16 v[220:223], a[184:187], a[36:39], v[220:223]
    ds_read_b64_tr_b16 a[180:181], v26 offset:57344
    v_mfma_f32_16x16x32_bf16 v[220:223], a[188:191], a[44:47], v[220:223]
    s_waitcnt lgkmcnt(9)
    ds_read_b64_tr_b16 a[182:183], v26 offset:61440
    v_mfma_f32_16x16x32_bf16 v[224:227], a[160:163], a[32:35], v[224:227]
    s_waitcnt lgkmcnt(8)
    ds_read_b64_tr_b16 a[184:185], v27 offset:49152
    v_mfma_f32_16x16x32_bf16 v[224:227], a[164:167], a[40:43], v[224:227]
    ds_read_b64_tr_b16 a[186:187], v27 offset:53248
    v_mfma_f32_16x16x32_bf16 v[228:231], a[160:163], a[36:39], v[228:231]
    ds_read_b64_tr_b16 a[188:189], v27 offset:57344
    v_mfma_f32_16x16x32_bf16 v[228:231], a[164:167], a[44:47], v[228:231]
    s_waitcnt lgkmcnt(9)
    ds_read_b64_tr_b16 a[190:191], v27 offset:61440
    s_waitcnt vmcnt(18)
    s_barrier
    v_mfma_f32_16x16x32_bf16 v[232:235], a[168:171], a[32:35], v[232:235]
    s_waitcnt lgkmcnt(8)
    ds_read_b64_tr_b16 a[160:161], v28 offset:0
    v_mfma_f32_16x16x32_bf16 v[232:235], a[172:175], a[40:43], v[232:235]
    s_add_u32 s49, s44, 2621440
    ds_read_b64_tr_b16 a[162:163], v28 offset:4096
    v_mfma_f32_16x16x32_bf16 v[236:239], a[168:171], a[36:39], v[236:239]
    s_add_u32 m0, s42, 32768
    ds_read_b64_tr_b16 a[164:165], v28 offset:8192
    v_mfma_f32_16x16x32_bf16 v[236:239], a[172:175], a[44:47], v[236:239]
    s_waitcnt lgkmcnt(9)
    buffer_load_dwordx4 v42, s[16:19], s49 offen lds
    v_mfma_f32_16x16x32_bf16 v[240:243], a[176:179], a[32:35], v[240:243]
    s_waitcnt lgkmcnt(7)
    ds_read_b64_tr_b16 a[166:167], v28 offset:12288
    ds_read_b64_tr_b16 a[168:169], v29 offset:0
    v_mfma_f32_16x16x32_bf16 v[240:243], a[180:183], a[40:43], v[240:243]
    ds_read_b64_tr_b16 a[170:171], v29 offset:4096
    v_mfma_f32_16x16x32_bf16 v[244:247], a[176:179], a[36:39], v[244:247]
    ds_read_b64_tr_b16 a[172:173], v29 offset:8192
    v_mfma_f32_16x16x32_bf16 v[244:247], a[180:183], a[44:47], v[244:247]
    s_waitcnt lgkmcnt(9)
    buffer_load_dwordx4 v43, s[16:19], s49 offen offset:1024 lds
    v_mfma_f32_16x16x32_bf16 v[248:251], a[184:187], a[32:35], v[248:251]
    s_waitcnt lgkmcnt(7)
    ds_read_b64_tr_b16 a[174:175], v29 offset:12288
    ds_read_b64_tr_b16 a[176:177], v30 offset:0
    v_mfma_f32_16x16x32_bf16 v[248:251], a[188:191], a[40:43], v[248:251]
    ds_read_b64_tr_b16 a[178:179], v30 offset:4096
    v_mfma_f32_16x16x32_bf16 v[252:255], a[184:187], a[36:39], v[252:255]
    ds_read_b64_tr_b16 a[180:181], v30 offset:8192
    v_mfma_f32_16x16x32_bf16 v[252:255], a[188:191], a[44:47], v[252:255]
    s_waitcnt vmcnt(19)
    s_waitcnt lgkmcnt(9)
    buffer_load_dwordx4 v44, s[16:19], s49 offen offset:2048 lds
    v_mfma_f32_16x16x32_bf16 v[128:131], a[160:163], a[48:51], v[128:131]
    s_waitcnt vmcnt(19)
    s_waitcnt lgkmcnt(7)
    ds_read_b64_tr_b16 a[182:183], v30 offset:12288
    ds_read_b64_tr_b16 a[184:185], v31 offset:0
    v_mfma_f32_16x16x32_bf16 v[128:131], a[164:167], a[56:59], v[128:131]
    s_waitcnt vmcnt(18)
    ds_read_b64_tr_b16 a[186:187], v31 offset:4096
    v_mfma_f32_16x16x32_bf16 v[132:135], a[160:163], a[52:55], v[132:135]
    s_waitcnt vmcnt(17)
    ds_read_b64_tr_b16 a[188:189], v31 offset:8192
    v_mfma_f32_16x16x32_bf16 v[132:135], a[164:167], a[60:63], v[132:135]
    s_waitcnt lgkmcnt(9)
    buffer_load_dwordx4 v45, s[16:19], s49 offen offset:3072 lds
    v_mfma_f32_16x16x32_bf16 v[136:139], a[168:171], a[48:51], v[136:139]
    s_waitcnt lgkmcnt(7)
    ds_read_b64_tr_b16 a[190:191], v31 offset:12288
    ds_read_b64_tr_b16 a[160:161], v32 offset:0
    v_mfma_f32_16x16x32_bf16 v[136:139], a[172:175], a[56:59], v[136:139]
    s_add_u32 s49, s44, 3145728
    ds_read_b64_tr_b16 a[162:163], v32 offset:4096
    v_mfma_f32_16x16x32_bf16 v[140:143], a[168:171], a[52:55], v[140:143]
    s_add_u32 m0, s42, 49152
    ds_read_b64_tr_b16 a[164:165], v32 offset:8192
    v_mfma_f32_16x16x32_bf16 v[140:143], a[172:175], a[60:63], v[140:143]
    s_waitcnt lgkmcnt(9)
    buffer_load_dwordx4 v42, s[16:19], s49 offen lds
    v_mfma_f32_16x16x32_bf16 v[144:147], a[176:179], a[48:51], v[144:147]
    s_waitcnt lgkmcnt(7)
    ds_read_b64_tr_b16 a[166:167], v32 offset:12288
    ds_read_b64_tr_b16 a[168:169], v33 offset:0
    v_mfma_f32_16x16x32_bf16 v[144:147], a[180:183], a[56:59], v[144:147]
    ds_read_b64_tr_b16 a[170:171], v33 offset:4096
    v_mfma_f32_16x16x32_bf16 v[148:151], a[176:179], a[52:55], v[148:151]
    ds_read_b64_tr_b16 a[172:173], v33 offset:8192
    v_mfma_f32_16x16x32_bf16 v[148:151], a[180:183], a[60:63], v[148:151]
    s_waitcnt lgkmcnt(9)
    buffer_load_dwordx4 v43, s[16:19], s49 offen offset:1024 lds
    v_mfma_f32_16x16x32_bf16 v[152:155], a[184:187], a[48:51], v[152:155]
    s_waitcnt lgkmcnt(7)
    ds_read_b64_tr_b16 a[174:175], v33 offset:12288
    ds_read_b64_tr_b16 a[176:177], v34 offset:0
    v_mfma_f32_16x16x32_bf16 v[152:155], a[188:191], a[56:59], v[152:155]
    ds_read_b64_tr_b16 a[178:179], v34 offset:4096
    v_mfma_f32_16x16x32_bf16 v[156:159], a[184:187], a[52:55], v[156:159]
    ds_read_b64_tr_b16 a[180:181], v34 offset:8192
    v_mfma_f32_16x16x32_bf16 v[156:159], a[188:191], a[60:63], v[156:159]
    s_waitcnt lgkmcnt(9)
    buffer_load_dwordx4 v44, s[16:19], s49 offen offset:2048 lds
    v_mfma_f32_16x16x32_bf16 v[160:163], a[160:163], a[48:51], v[160:163]
    s_waitcnt lgkmcnt(7)
    ds_read_b64_tr_b16 a[182:183], v34 offset:12288
    ds_read_b64_tr_b16 a[184:185], v35 offset:0
    v_mfma_f32_16x16x32_bf16 v[160:163], a[164:167], a[56:59], v[160:163]
    ds_read_b64_tr_b16 a[186:187], v35 offset:4096
    v_mfma_f32_16x16x32_bf16 v[164:167], a[160:163], a[52:55], v[164:167]
    ds_read_b64_tr_b16 a[188:189], v35 offset:8192
    v_mfma_f32_16x16x32_bf16 v[164:167], a[164:167], a[60:63], v[164:167]
    s_waitcnt lgkmcnt(9)
    buffer_load_dwordx4 v45, s[16:19], s49 offen offset:3072 lds
    v_mfma_f32_16x16x32_bf16 v[168:171], a[168:171], a[48:51], v[168:171]
    s_waitcnt lgkmcnt(7)
    ds_read_b64_tr_b16 a[190:191], v35 offset:12288
    ds_read_b64_tr_b16 a[160:161], v28 offset:16384
    v_mfma_f32_16x16x32_bf16 v[168:171], a[172:175], a[56:59], v[168:171]
    ds_read_b64_tr_b16 a[162:163], v28 offset:20480
    v_mfma_f32_16x16x32_bf16 v[172:175], a[168:171], a[52:55], v[172:175]
    ds_read_b64_tr_b16 a[164:165], v28 offset:24576
    v_mfma_f32_16x16x32_bf16 v[172:175], a[172:175], a[60:63], v[172:175]
    s_waitcnt lgkmcnt(9)
    buffer_load_dwordx4 a[84:87], v51, s[24:27], s43 offen offset:1280 sc1
    v_mfma_f32_16x16x32_bf16 v[176:179], a[176:179], a[48:51], v[176:179]
    s_waitcnt lgkmcnt(7)
    ds_read_b64_tr_b16 a[166:167], v28 offset:28672
    ds_read_b64_tr_b16 a[168:169], v29 offset:16384
    v_mfma_f32_16x16x32_bf16 v[176:179], a[180:183], a[56:59], v[176:179]
    ds_read_b64_tr_b16 a[170:171], v29 offset:20480
    v_mfma_f32_16x16x32_bf16 v[180:183], a[176:179], a[52:55], v[180:183]
    ds_read_b64_tr_b16 a[172:173], v29 offset:24576
    v_mfma_f32_16x16x32_bf16 v[180:183], a[180:183], a[60:63], v[180:183]
    s_waitcnt lgkmcnt(9)
    buffer_load_dwordx4 a[92:95], v51, s[24:27], s43 offen offset:1408 sc1
    v_mfma_f32_16x16x32_bf16 v[184:187], a[184:187], a[48:51], v[184:187]
    s_waitcnt lgkmcnt(7)
    ds_read_b64_tr_b16 a[174:175], v29 offset:28672
    ds_read_b64_tr_b16 a[176:177], v30 offset:16384
    v_mfma_f32_16x16x32_bf16 v[184:187], a[188:191], a[56:59], v[184:187]
    ds_read_b64_tr_b16 a[178:179], v30 offset:20480
    v_mfma_f32_16x16x32_bf16 v[188:191], a[184:187], a[52:55], v[188:191]
    ds_read_b64_tr_b16 a[180:181], v30 offset:24576
    v_mfma_f32_16x16x32_bf16 v[188:191], a[188:191], a[60:63], v[188:191]
    s_waitcnt lgkmcnt(9)
    buffer_load_dwordx4 a[96:99], v51, s[24:27], s46 offen offset:1536 sc1
    v_mfma_f32_16x16x32_bf16 v[192:195], a[160:163], a[48:51], v[192:195]
    s_waitcnt lgkmcnt(7)
    ds_read_b64_tr_b16 a[182:183], v30 offset:28672
    ds_read_b64_tr_b16 a[184:185], v31 offset:16384
    v_mfma_f32_16x16x32_bf16 v[192:195], a[164:167], a[56:59], v[192:195]
    ds_read_b64_tr_b16 a[186:187], v31 offset:20480
    v_mfma_f32_16x16x32_bf16 v[196:199], a[160:163], a[52:55], v[196:199]
    ds_read_b64_tr_b16 a[188:189], v31 offset:24576
    v_mfma_f32_16x16x32_bf16 v[196:199], a[164:167], a[60:63], v[196:199]
    s_waitcnt lgkmcnt(9)
    buffer_load_dwordx4 a[104:107], v51, s[24:27], s46 offen offset:1664 sc1
    v_mfma_f32_16x16x32_bf16 v[200:203], a[168:171], a[48:51], v[200:203]
    s_waitcnt lgkmcnt(7)
    ds_read_b64_tr_b16 a[190:191], v31 offset:28672
    ds_read_b64_tr_b16 a[160:161], v32 offset:16384
    v_mfma_f32_16x16x32_bf16 v[200:203], a[172:175], a[56:59], v[200:203]
    ds_read_b64_tr_b16 a[162:163], v32 offset:20480
    v_mfma_f32_16x16x32_bf16 v[204:207], a[168:171], a[52:55], v[204:207]
    ds_read_b64_tr_b16 a[164:165], v32 offset:24576
    v_mfma_f32_16x16x32_bf16 v[204:207], a[172:175], a[60:63], v[204:207]
    s_waitcnt lgkmcnt(9)
    buffer_load_dwordx4 a[100:103], v51, s[24:27], s43 offen offset:1536 sc1
    v_mfma_f32_16x16x32_bf16 v[208:211], a[176:179], a[48:51], v[208:211]
    s_waitcnt lgkmcnt(7)
    ds_read_b64_tr_b16 a[166:167], v32 offset:28672
    ds_read_b64_tr_b16 a[168:169], v33 offset:16384
    v_mfma_f32_16x16x32_bf16 v[208:211], a[180:183], a[56:59], v[208:211]
    ds_read_b64_tr_b16 a[170:171], v33 offset:20480
    v_mfma_f32_16x16x32_bf16 v[212:215], a[176:179], a[52:55], v[212:215]
    ds_read_b64_tr_b16 a[172:173], v33 offset:24576
    v_mfma_f32_16x16x32_bf16 v[212:215], a[180:183], a[60:63], v[212:215]
    s_waitcnt lgkmcnt(9)
    buffer_load_dwordx4 a[108:111], v51, s[24:27], s43 offen offset:1664 sc1
    v_mfma_f32_16x16x32_bf16 v[216:219], a[184:187], a[48:51], v[216:219]
    s_waitcnt lgkmcnt(7)
    ds_read_b64_tr_b16 a[174:175], v33 offset:28672
    ds_read_b64_tr_b16 a[176:177], v34 offset:16384
    v_mfma_f32_16x16x32_bf16 v[216:219], a[188:191], a[56:59], v[216:219]
    ds_read_b64_tr_b16 a[178:179], v34 offset:20480
    v_mfma_f32_16x16x32_bf16 v[220:223], a[184:187], a[52:55], v[220:223]
    ds_read_b64_tr_b16 a[180:181], v34 offset:24576
    v_mfma_f32_16x16x32_bf16 v[220:223], a[188:191], a[60:63], v[220:223]
    s_waitcnt lgkmcnt(9)
    ds_read_b64_tr_b16 a[182:183], v34 offset:28672
    v_mfma_f32_16x16x32_bf16 v[224:227], a[160:163], a[48:51], v[224:227]
    s_waitcnt lgkmcnt(8)
    ds_read_b64_tr_b16 a[184:185], v35 offset:16384
    v_mfma_f32_16x16x32_bf16 v[224:227], a[164:167], a[56:59], v[224:227]
    ds_read_b64_tr_b16 a[186:187], v35 offset:20480
    v_mfma_f32_16x16x32_bf16 v[228:231], a[160:163], a[52:55], v[228:231]
    ds_read_b64_tr_b16 a[188:189], v35 offset:24576
    v_mfma_f32_16x16x32_bf16 v[228:231], a[164:167], a[60:63], v[228:231]
    s_waitcnt lgkmcnt(9)
    ds_read_b64_tr_b16 a[190:191], v35 offset:28672
    s_waitcnt vmcnt(20)
    s_barrier
    v_mfma_f32_16x16x32_bf16 v[232:235], a[168:171], a[48:51], v[232:235]
    s_waitcnt lgkmcnt(8)
    ds_read_b64_tr_b16 a[160:161], v12 offset:0
    v_mfma_f32_16x16x32_bf16 v[232:235], a[172:175], a[56:59], v[232:235]
    s_add_u32 s49, s44, 3670016
    ds_read_b64_tr_b16 a[162:163], v12 offset:4096
    v_mfma_f32_16x16x32_bf16 v[236:239], a[168:171], a[52:55], v[236:239]
    s_add_u32 m0, s42, 65536
    ds_read_b64_tr_b16 a[164:165], v12 offset:8192
    v_mfma_f32_16x16x32_bf16 v[236:239], a[172:175], a[60:63], v[236:239]
    s_waitcnt lgkmcnt(9)
    buffer_load_dwordx4 v42, s[16:19], s49 offen lds
    v_mfma_f32_16x16x32_bf16 v[240:243], a[176:179], a[48:51], v[240:243]
    s_waitcnt lgkmcnt(7)
    ds_read_b64_tr_b16 a[166:167], v12 offset:12288
    ds_read_b64_tr_b16 a[168:169], v13 offset:0
    v_mfma_f32_16x16x32_bf16 v[240:243], a[180:183], a[56:59], v[240:243]
Ltour1:
    s_cbranch_execz Ltour5
    ds_read_b64_tr_b16 a[170:171], v13 offset:4096
    v_mfma_f32_16x16x32_bf16 v[244:247], a[176:179], a[52:55], v[244:247]
    ds_read_b64_tr_b16 a[172:173], v13 offset:8192
    v_mfma_f32_16x16x32_bf16 v[244:247], a[180:183], a[60:63], v[244:247]
    s_waitcnt lgkmcnt(9)
    buffer_load_dwordx4 v43, s[16:19], s49 offen offset:1024 lds
    v_mfma_f32_16x16x32_bf16 v[248:251], a[184:187], a[48:51], v[248:251]
    s_waitcnt lgkmcnt(7)
    ds_read_b64_tr_b16 a[174:175], v13 offset:12288
    ds_read_b64_tr_b16 a[176:177], v14 offset:0
    v_mfma_f32_16x16x32_bf16 v[248:251], a[188:191], a[56:59], v[248:251]
    ds_read_b64_tr_b16 a[178:179], v14 offset:4096
    v_mfma_f32_16x16x32_bf16 v[252:255], a[184:187], a[52:55], v[252:255]
    ds_read_b64_tr_b16 a[180:181], v14 offset:8192
    v_mfma_f32_16x16x32_bf16 v[252:255], a[188:191], a[60:63], v[252:255]
    s_waitcnt vmcnt(21)
    s_waitcnt lgkmcnt(9)
    buffer_load_dwordx4 v44, s[16:19], s49 offen offset:2048 lds
    v_mfma_f32_16x16x32_bf16 v[128:131], a[160:163], a[64:67], v[128:131]
    s_waitcnt vmcnt(21)
    s_waitcnt lgkmcnt(7)
    ds_read_b64_tr_b16 a[182:183], v14 offset:12288
    ds_read_b64_tr_b16 a[184:185], v15 offset:0
    v_mfma_f32_16x16x32_bf16 v[128:131], a[164:167], a[72:75], v[128:131]
    s_waitcnt vmcnt(20)
    ds_read_b64_tr_b16 a[186:187], v15 offset:4096
    v_mfma_f32_16x16x32_bf16 v[132:135], a[160:163], a[68:71], v[132:135]
    s_waitcnt vmcnt(19)
    ds_read_b64_tr_b16 a[188:189], v15 offset:8192
    v_mfma_f32_16x16x32_bf16 v[132:135], a[164:167], a[76:79], v[132:135]
    s_waitcnt lgkmcnt(9)
    buffer_load_dwordx4 v45, s[16:19], s49 offen offset:3072 lds
    v_mfma_f32_16x16x32_bf16 v[136:139], a[168:171], a[64:67], v[136:139]
    s_waitcnt lgkmcnt(7)
    ds_read_b64_tr_b16 a[190:191], v15 offset:12288
    ds_read_b64_tr_b16 a[160:161], v16 offset:0
    v_mfma_f32_16x16x32_bf16 v[136:139], a[172:175], a[72:75], v[136:139]
    s_add_u32 s49, s44, 4194304
    ds_read_b64_tr_b16 a[162:163], v16 offset:4096
    v_mfma_f32_16x16x32_bf16 v[140:143], a[168:171], a[68:71], v[140:143]
    s_add_u32 m0, s42, 81920
    ds_read_b64_tr_b16 a[164:165], v16 offset:8192
    v_mfma_f32_16x16x32_bf16 v[140:143], a[172:175], a[76:79], v[140:143]
    s_waitcnt lgkmcnt(9)
    buffer_load_dwordx4 v42, s[16:19], s49 offen lds
    v_mfma_f32_16x16x32_bf16 v[144:147], a[176:179], a[64:67], v[144:147]
    s_waitcnt lgkmcnt(7)
    ds_read_b64_tr_b16 a[166:167], v16 offset:12288
    ds_read_b64_tr_b16 a[168:169], v17 offset:0
    v_mfma_f32_16x16x32_bf16 v[144:147], a[180:183], a[72:75], v[144:147]
    ds_read_b64_tr_b16 a[170:171], v17 offset:4096
    v_mfma_f32_16x16x32_bf16 v[148:151], a[176:179], a[68:71], v[148:151]
    ds_read_b64_tr_b16 a[172:173], v17 offset:8192
    v_mfma_f32_16x16x32_bf16 v[148:151], a[180:183], a[76:79], v[148:151]
    s_waitcnt lgkmcnt(9)
    buffer_load_dwordx4 v43, s[16:19], s49 offen offset:1024 lds
    v_mfma_f32_16x16x32_bf16 v[152:155], a[184:187], a[64:67], v[152:155]
    s_waitcnt lgkmcnt(7)
    ds_read_b64_tr_b16 a[174:175], v17 offset:12288
    ds_read_b64_tr_b16 a[176:177], v18 offset:0
    v_mfma_f32_16x16x32_bf16 v[152:155], a[188:191], a[72:75], v[152:155]
    ds_read_b64_tr_b16 a[178:179], v18 offset:4096
    v_mfma_f32_16x16x32_bf16 v[156:159], a[184:187], a[68:71], v[156:159]
    ds_read_b64_tr_b16 a[180:181], v18 offset:8192
    v_mfma_f32_16x16x32_bf16 v[156:159], a[188:191], a[76:79], v[156:159]
    s_waitcnt lgkmcnt(9)
    buffer_load_dwordx4 v44, s[16:19], s49 offen offset:2048 lds
    v_mfma_f32_16x16x32_bf16 v[160:163], a[160:163], a[64:67], v[160:163]
    s_waitcnt lgkmcnt(7)
    ds_read_b64_tr_b16 a[182:183], v18 offset:12288
    ds_read_b64_tr_b16 a[184:185], v19 offset:0
    v_mfma_f32_16x16x32_bf16 v[160:163], a[164:167], a[72:75], v[160:163]
    ds_read_b64_tr_b16 a[186:187], v19 offset:4096
    v_mfma_f32_16x16x32_bf16 v[164:167], a[160:163], a[68:71], v[164:167]
    ds_read_b64_tr_b16 a[188:189], v19 offset:8192
    v_mfma_f32_16x16x32_bf16 v[164:167], a[164:167], a[76:79], v[164:167]
    s_waitcnt lgkmcnt(9)
    buffer_load_dwordx4 v45, s[16:19], s49 offen offset:3072 lds
    v_mfma_f32_16x16x32_bf16 v[168:171], a[168:171], a[64:67], v[168:171]
    s_waitcnt lgkmcnt(7)
    ds_read_b64_tr_b16 a[190:191], v19 offset:12288
    ds_read_b64_tr_b16 a[160:161], v12 offset:16384
    v_mfma_f32_16x16x32_bf16 v[168:171], a[172:175], a[72:75], v[168:171]
    ds_read_b64_tr_b16 a[162:163], v12 offset:20480
    v_mfma_f32_16x16x32_bf16 v[172:175], a[168:171], a[68:71], v[172:175]
    ds_read_b64_tr_b16 a[164:165], v12 offset:24576
    v_mfma_f32_16x16x32_bf16 v[172:175], a[172:175], a[76:79], v[172:175]
    s_waitcnt lgkmcnt(9)
    buffer_load_dwordx4 a[112:115], v51, s[24:27], s46 offen offset:1792 sc1
    v_mfma_f32_16x16x32_bf16 v[176:179], a[176:179], a[64:67], v[176:179]
    s_waitcnt lgkmcnt(7)
    ds_read_b64_tr_b16 a[166:167], v12 offset:28672
    ds_read_b64_tr_b16 a[168:169], v13 offset:16384
    v_mfma_f32_16x16x32_bf16 v[176:179], a[180:183], a[72:75], v[176:179]
    ds_read_b64_tr_b16 a[170:171], v13 offset:20480
    v_mfma_f32_16x16x32_bf16 v[180:183], a[176:179], a[68:71], v[180:183]
    ds_read_b64_tr_b16 a[172:173], v13 offset:24576
    v_mfma_f32_16x16x32_bf16 v[180:183], a[180:183], a[76:79], v[180:183]
    s_waitcnt lgkmcnt(9)
    buffer_load_dwordx4 a[120:123], v51, s[24:27], s46 offen offset:1920 sc1
    v_mfma_f32_16x16x32_bf16 v[184:187], a[184:187], a[64:67], v[184:187]
    s_waitcnt lgkmcnt(7)
    ds_read_b64_tr_b16 a[174:175], v13 offset:28672
    ds_read_b64_tr_b16 a[176:177], v14 offset:16384
    v_mfma_f32_16x16x32_bf16 v[184:187], a[188:191], a[72:75], v[184:187]
    ds_read_b64_tr_b16 a[178:179], v14 offset:20480
    v_mfma_f32_16x16x32_bf16 v[188:191], a[184:187], a[68:71], v[188:191]
    ds_read_b64_tr_b16 a[180:181], v14 offset:24576
    v_mfma_f32_16x16x32_bf16 v[188:191], a[188:191], a[76:79], v[188:191]
    s_waitcnt lgkmcnt(9)
    buffer_load_dwordx4 a[116:119], v51, s[24:27], s43 offen offset:1792 sc1
    v_mfma_f32_16x16x32_bf16 v[192:195], a[160:163], a[64:67], v[192:195]
    s_waitcnt lgkmcnt(7)
    ds_read_b64_tr_b16 a[182:183], v14 offset:28672
    ds_read_b64_tr_b16 a[184:185], v15 offset:16384
    v_mfma_f32_16x16x32_bf16 v[192:195], a[164:167], a[72:75], v[192:195]
    ds_read_b64_tr_b16 a[186:187], v15 offset:20480
    v_mfma_f32_16x16x32_bf16 v[196:199], a[160:163], a[68:71], v[196:199]
    ds_read_b64_tr_b16 a[188:189], v15 offset:24576
    v_mfma_f32_16x16x32_bf16 v[196:199], a[164:167], a[76:79], v[196:199]
    s_waitcnt lgkmcnt(9)
    buffer_load_dwordx4 a[124:127], v51, s[24:27], s43 offen offset:1920 sc1
    v_mfma_f32_16x16x32_bf16 v[200:203], a[168:171], a[64:67], v[200:203]
    s_waitcnt lgkmcnt(7)
    ds_read_b64_tr_b16 a[190:191], v15 offset:28672
    ds_read_b64_tr_b16 a[160:161], v16 offset:16384
    v_mfma_f32_16x16x32_bf16 v[200:203], a[172:175], a[72:75], v[200:203]
    ds_read_b64_tr_b16 a[162:163], v16 offset:20480
    v_mfma_f32_16x16x32_bf16 v[204:207], a[168:171], a[68:71], v[204:207]
    ds_read_b64_tr_b16 a[164:165], v16 offset:24576
    v_mfma_f32_16x16x32_bf16 v[204:207], a[172:175], a[76:79], v[204:207]
    s_waitcnt lgkmcnt(9)
    buffer_load_dwordx4 a[128:131], v51, s[24:27], s46 offen offset:2048 sc1
    v_mfma_f32_16x16x32_bf16 v[208:211], a[176:179], a[64:67], v[208:211]
    s_waitcnt lgkmcnt(7)
    ds_read_b64_tr_b16 a[166:167], v16 offset:28672
    ds_read_b64_tr_b16 a[168:169], v17 offset:16384
    v_mfma_f32_16x16x32_bf16 v[208:211], a[180:183], a[72:75], v[208:211]
    ds_read_b64_tr_b16 a[170:171], v17 offset:20480
    v_mfma_f32_16x16x32_bf16 v[212:215], a[176:179], a[68:71], v[212:215]
    ds_read_b64_tr_b16 a[172:173], v17 offset:24576
    v_mfma_f32_16x16x32_bf16 v[212:215], a[180:183], a[76:79], v[212:215]
    s_waitcnt lgkmcnt(9)
    buffer_load_dwordx4 a[136:139], v51, s[24:27], s46 offen offset:2176 sc1
    v_mfma_f32_16x16x32_bf16 v[216:219], a[184:187], a[64:67], v[216:219]
    s_waitcnt lgkmcnt(7)
    ds_read_b64_tr_b16 a[174:175], v17 offset:28672
    ds_read_b64_tr_b16 a[176:177], v18 offset:16384
    v_mfma_f32_16x16x32_bf16 v[216:219], a[188:191], a[72:75], v[216:219]
    ds_read_b64_tr_b16 a[178:179], v18 offset:20480
    v_mfma_f32_16x16x32_bf16 v[220:223], a[184:187], a[68:71], v[220:223]
    ds_read_b64_tr_b16 a[180:181], v18 offset:24576
    v_mfma_f32_16x16x32_bf16 v[220:223], a[188:191], a[76:79], v[220:223]
    s_waitcnt lgkmcnt(9)
    ds_read_b64_tr_b16 a[182:183], v18 offset:28672
    v_mfma_f32_16x16x32_bf16 v[224:227], a[160:163], a[64:67], v[224:227]
    s_waitcnt lgkmcnt(8)
    ds_read_b64_tr_b16 a[184:185], v19 offset:16384
    v_mfma_f32_16x16x32_bf16 v[224:227], a[164:167], a[72:75], v[224:227]
    ds_read_b64_tr_b16 a[186:187], v19 offset:20480
    v_mfma_f32_16x16x32_bf16 v[228:231], a[160:163], a[68:71], v[228:231]
    ds_read_b64_tr_b16 a[188:189], v19 offset:24576
    v_mfma_f32_16x16x32_bf16 v[228:231], a[164:167], a[76:79], v[228:231]
    s_waitcnt lgkmcnt(9)
    ds_read_b64_tr_b16 a[190:191], v19 offset:28672
    s_waitcnt vmcnt(20)
    s_barrier
    v_mfma_f32_16x16x32_bf16 v[232:235], a[168:171], a[64:67], v[232:235]
    s_waitcnt lgkmcnt(8)
    ds_read_b64_tr_b16 a[160:161], v12 offset:32768
    v_mfma_f32_16x16x32_bf16 v[232:235], a[172:175], a[72:75], v[232:235]
    s_add_u32 s49, s44, 2621696
    ds_read_b64_tr_b16 a[162:163], v12 offset:36864
    v_mfma_f32_16x16x32_bf16 v[236:239], a[168:171], a[68:71], v[236:239]
    s_add_u32 m0, s42, 98304
    ds_read_b64_tr_b16 a[164:165], v12 offset:40960
    v_mfma_f32_16x16x32_bf16 v[236:239], a[172:175], a[76:79], v[236:239]
    s_waitcnt lgkmcnt(9)
    buffer_load_dwordx4 v42, s[16:19], s49 offen lds
    v_mfma_f32_16x16x32_bf16 v[240:243], a[176:179], a[64:67], v[240:243]
    s_waitcnt lgkmcnt(7)
    ds_read_b64_tr_b16 a[166:167], v12 offset:45056
    ds_read_b64_tr_b16 a[168:169], v13 offset:32768
    v_mfma_f32_16x16x32_bf16 v[240:243], a[180:183], a[72:75], v[240:243]
    ds_read_b64_tr_b16 a[170:171], v13 offset:36864
    v_mfma_f32_16x16x32_bf16 v[244:247], a[176:179], a[68:71], v[244:247]
    ds_read_b64_tr_b16 a[172:173], v13 offset:40960
    v_mfma_f32_16x16x32_bf16 v[244:247], a[180:183], a[76:79], v[244:247]
    s_waitcnt lgkmcnt(9)
    buffer_load_dwordx4 v43, s[16:19], s49 offen offset:1024 lds
    v_mfma_f32_16x16x32_bf16 v[248:251], a[184:187], a[64:67], v[248:251]
    s_waitcnt lgkmcnt(7)
    ds_read_b64_tr_b16 a[174:175], v13 offset:45056
    ds_read_b64_tr_b16 a[176:177], v14 offset:32768
    v_mfma_f32_16x16x32_bf16 v[248:251], a[188:191], a[72:75], v[248:251]
    ds_read_b64_tr_b16 a[178:179], v14 offset:36864
    v_mfma_f32_16x16x32_bf16 v[252:255], a[184:187], a[68:71], v[252:255]
    ds_read_b64_tr_b16 a[180:181], v14 offset:40960
    v_mfma_f32_16x16x32_bf16 v[252:255], a[188:191], a[76:79], v[252:255]
    s_waitcnt lgkmcnt(9)
    buffer_load_dwordx4 v44, s[16:19], s49 offen offset:2048 lds
    v_mfma_f32_16x16x32_bf16 v[128:131], a[160:163], a[80:83], v[128:131]
    s_waitcnt lgkmcnt(7)
    ds_read_b64_tr_b16 a[182:183], v14 offset:45056
    ds_read_b64_tr_b16 a[184:185], v15 offset:32768
    v_mfma_f32_16x16x32_bf16 v[128:131], a[164:167], a[88:91], v[128:131]
    s_waitcnt vmcnt(22)
    ds_read_b64_tr_b16 a[186:187], v15 offset:36864
    v_mfma_f32_16x16x32_bf16 v[132:135], a[160:163], a[84:87], v[132:135]
    s_waitcnt vmcnt(21)
    ds_read_b64_tr_b16 a[188:189], v15 offset:40960
    v_mfma_f32_16x16x32_bf16 v[132:135], a[164:167], a[92:95], v[132:135]
    s_waitcnt lgkmcnt(9)
    buffer_load_dwordx4 v45, s[16:19], s49 offen offset:3072 lds
    v_mfma_f32_16x16x32_bf16 v[136:139], a[168:171], a[80:83], v[136:139]
    s_waitcnt lgkmcnt(7)
    ds_read_b64_tr_b16 a[190:191], v15 offset:45056
    ds_read_b64_tr_b16 a[160:161], v16 offset:32768
    v_mfma_f32_16x16x32_bf16 v[136:139], a[172:175], a[88:91], v[136:139]
    s_add_u32 s49, s44, 3145984
    ds_read_b64_tr_b16 a[162:163], v16 offset:36864
    v_mfma_f32_16x16x32_bf16 v[140:143], a[168:171], a[84:87], v[140:143]
    s_add_u32 m0, s42, 114688
    ds_read_b64_tr_b16 a[164:165], v16 offset:40960
    v_mfma_f32_16x16x32_bf16 v[140:143], a[172:175], a[92:95], v[140:143]
    s_waitcnt lgkmcnt(9)
    buffer_load_dwordx4 v42, s[16:19], s49 offen lds
    v_mfma_f32_16x16x32_bf16 v[144:147], a[176:179], a[80:83], v[144:147]
    s_waitcnt lgkmcnt(7)
    ds_read_b64_tr_b16 a[166:167], v16 offset:45056
    ds_read_b64_tr_b16 a[168:169], v17 offset:32768
    v_mfma_f32_16x16x32_bf16 v[144:147], a[180:183], a[88:91], v[144:147]
    ds_read_b64_tr_b16 a[170:171], v17 offset:36864
    v_mfma_f32_16x16x32_bf16 v[148:151], a[176:179], a[84:87], v[148:151]
    ds_read_b64_tr_b16 a[172:173], v17 offset:40960
    v_mfma_f32_16x16x32_bf16 v[148:151], a[180:183], a[92:95], v[148:151]
    s_waitcnt lgkmcnt(9)
    buffer_load_dwordx4 v43, s[16:19], s49 offen offset:1024 lds
    v_mfma_f32_16x16x32_bf16 v[152:155], a[184:187], a[80:83], v[152:155]
    s_waitcnt lgkmcnt(7)
    ds_read_b64_tr_b16 a[174:175], v17 offset:45056
    ds_read_b64_tr_b16 a[176:177], v18 offset:32768
    v_mfma_f32_16x16x32_bf16 v[152:155], a[188:191], a[88:91], v[152:155]
    ds_read_b64_tr_b16 a[178:179], v18 offset:36864
    v_mfma_f32_16x16x32_bf16 v[156:159], a[184:187], a[84:87], v[156:159]
    ds_read_b64_tr_b16 a[180:181], v18 offset:40960
    v_mfma_f32_16x16x32_bf16 v[156:159], a[188:191], a[92:95], v[156:159]
    s_waitcnt lgkmcnt(9)
    buffer_load_dwordx4 v44, s[16:19], s49 offen offset:2048 lds
    v_mfma_f32_16x16x32_bf16 v[160:163], a[160:163], a[80:83], v[160:163]
    s_waitcnt lgkmcnt(7)
    ds_read_b64_tr_b16 a[182:183], v18 offset:45056
    ds_read_b64_tr_b16 a[184:185], v19 offset:32768
    v_mfma_f32_16x16x32_bf16 v[160:163], a[164:167], a[88:91], v[160:163]
    ds_read_b64_tr_b16 a[186:187], v19 offset:36864
    v_mfma_f32_16x16x32_bf16 v[164:167], a[160:163], a[84:87], v[164:167]
    ds_read_b64_tr_b16 a[188:189], v19 offset:40960
    v_mfma_f32_16x16x32_bf16 v[164:167], a[164:167], a[92:95], v[164:167]
    s_waitcnt lgkmcnt(9)
    buffer_load_dwordx4 v45, s[16:19], s49 offen offset:3072 lds
    v_mfma_f32_16x16x32_bf16 v[168:171], a[168:171], a[80:83], v[168:171]
    s_waitcnt lgkmcnt(7)
    ds_read_b64_tr_b16 a[190:191], v19 offset:45056
    ds_read_b64_tr_b16 a[160:161], v12 offset:49152
    v_mfma_f32_16x16x32_bf16 v[168:171], a[172:175], a[88:91], v[168:171]
    ds_read_b64_tr_b16 a[162:163], v12 offset:53248
    v_mfma_f32_16x16x32_bf16 v[172:175], a[168:171], a[84:87], v[172:175]
    ds_read_b64_tr_b16 a[164:165], v12 offset:57344
    v_mfma_f32_16x16x32_bf16 v[172:175], a[172:175], a[92:95], v[172:175]
    s_waitcnt lgkmcnt(9)
    buffer_load_dwordx4 a[132:135], v51, s[24:27], s43 offen offset:2048 sc1
    v_mfma_f32_16x16x32_bf16 v[176:179], a[176:179], a[80:83], v[176:179]
    s_waitcnt lgkmcnt(7)
    ds_read_b64_tr_b16 a[166:167], v12 offset:61440
    ds_read_b64_tr_b16 a[168:169], v13 offset:49152
    v_mfma_f32_16x16x32_bf16 v[176:179], a[180:183], a[88:91], v[176:179]
    ds_read_b64_tr_b16 a[170:171], v13 offset:53248
    v_mfma_f32_16x16x32_bf16 v[180:183], a[176:179], a[84:87], v[180:183]
    ds_read_b64_tr_b16 a[172:173], v13 offset:57344
    v_mfma_f32_16x16x32_bf16 v[180:183], a[180:183], a[92:95], v[180:183]
    s_waitcnt lgkmcnt(9)
    buffer_load_dwordx4 a[140:143], v51, s[24:27], s43 offen offset:2176 sc1
    v_mfma_f32_16x16x32_bf16 v[184:187], a[184:187], a[80:83], v[184:187]
    s_waitcnt lgkmcnt(7)
    ds_read_b64_tr_b16 a[174:175], v13 offset:61440
    ds_read_b64_tr_b16 a[176:177], v14 offset:49152
    v_mfma_f32_16x16x32_bf16 v[184:187], a[188:191], a[88:91], v[184:187]
    ds_read_b64_tr_b16 a[178:179], v14 offset:53248
    v_mfma_f32_16x16x32_bf16 v[188:191], a[184:187], a[84:87], v[188:191]
    ds_read_b64_tr_b16 a[180:181], v14 offset:57344
    v_mfma_f32_16x16x32_bf16 v[188:191], a[188:191], a[92:95], v[188:191]
    s_waitcnt vmcnt(27)
    s_waitcnt lgkmcnt(9)
    ds_read_b64_tr_b16 a[182:183], v14 offset:61440
    v_mfma_f32_16x16x32_bf16 v[128:131], a[160:163], a[96:99], v[128:131]
    s_waitcnt vmcnt(26)
    s_waitcnt lgkmcnt(8)
    ds_read_b64_tr_b16 a[184:185], v15 offset:49152
    v_mfma_f32_16x16x32_bf16 v[128:131], a[164:167], a[104:107], v[128:131]
    s_waitcnt vmcnt(25)
    ds_read_b64_tr_b16 a[186:187], v15 offset:53248
    v_mfma_f32_16x16x32_bf16 v[132:135], a[160:163], a[100:103], v[132:135]
    s_waitcnt vmcnt(24)
    ds_read_b64_tr_b16 a[188:189], v15 offset:57344
    v_mfma_f32_16x16x32_bf16 v[132:135], a[164:167], a[108:111], v[132:135]
    s_waitcnt lgkmcnt(9)
    ds_read_b64_tr_b16 a[190:191], v15 offset:61440
    v_mfma_f32_16x16x32_bf16 v[136:139], a[168:171], a[96:99], v[136:139]
    s_waitcnt lgkmcnt(8)
    ds_read_b64_tr_b16 a[160:161], v16 offset:49152
    v_mfma_f32_16x16x32_bf16 v[136:139], a[172:175], a[104:107], v[136:139]
    ds_read_b64_tr_b16 a[162:163], v16 offset:53248
    v_mfma_f32_16x16x32_bf16 v[140:143], a[168:171], a[100:103], v[140:143]
    ds_read_b64_tr_b16 a[164:165], v16 offset:57344
    v_mfma_f32_16x16x32_bf16 v[140:143], a[172:175], a[108:111], v[140:143]
    s_waitcnt lgkmcnt(9)
    ds_read_b64_tr_b16 a[166:167], v16 offset:61440
    v_mfma_f32_16x16x32_bf16 v[144:147], a[176:179], a[96:99], v[144:147]
    s_waitcnt lgkmcnt(8)
    ds_read_b64_tr_b16 a[168:169], v17 offset:49152
    v_mfma_f32_16x16x32_bf16 v[144:147], a[180:183], a[104:107], v[144:147]
    ds_read_b64_tr_b16 a[170:171], v17 offset:53248
    v_mfma_f32_16x16x32_bf16 v[148:151], a[176:179], a[100:103], v[148:151]
    ds_read_b64_tr_b16 a[172:173], v17 offset:57344
    v_mfma_f32_16x16x32_bf16 v[148:151], a[180:183], a[108:111], v[148:151]
    s_waitcnt lgkmcnt(9)
    ds_read_b64_tr_b16 a[174:175], v17 offset:61440
    v_mfma_f32_16x16x32_bf16 v[152:155], a[184:187], a[96:99], v[152:155]
    s_waitcnt lgkmcnt(8)
    ds_read_b64_tr_b16 a[176:177], v18 offset:49152
    v_mfma_f32_16x16x32_bf16 v[152:155], a[188:191], a[104:107], v[152:155]
    ds_read_b64_tr_b16 a[178:179], v18 offset:53248
    v_mfma_f32_16x16x32_bf16 v[156:159], a[184:187], a[100:103], v[156:159]
    ds_read_b64_tr_b16 a[180:181], v18 offset:57344
    v_mfma_f32_16x16x32_bf16 v[156:159], a[188:191], a[108:111], v[156:159]
    s_waitcnt lgkmcnt(9)
    ds_read_b64_tr_b16 a[182:183], v18 offset:61440
    v_mfma_f32_16x16x32_bf16 v[160:163], a[160:163], a[96:99], v[160:163]
    s_waitcnt lgkmcnt(8)
    ds_read_b64_tr_b16 a[184:185], v19 offset:49152
    v_mfma_f32_16x16x32_bf16 v[160:163], a[164:167], a[104:107], v[160:163]
    ds_read_b64_tr_b16 a[186:187], v19 offset:53248
    v_mfma_f32_16x16x32_bf16 v[164:167], a[160:163], a[100:103], v[164:167]
    ds_read_b64_tr_b16 a[188:189], v19 offset:57344
    v_mfma_f32_16x16x32_bf16 v[164:167], a[164:167], a[108:111], v[164:167]
    s_waitcnt lgkmcnt(9)
    ds_read_b64_tr_b16 a[190:191], v19 offset:61440
    s_waitcnt vmcnt(16)
    s_barrier
    v_mfma_f32_16x16x32_bf16 v[168:171], a[168:171], a[96:99], v[168:171]
    s_waitcnt lgkmcnt(8)
    ds_read_b64_tr_b16 a[160:161], v20 offset:0
    v_mfma_f32_16x16x32_bf16 v[168:171], a[172:175], a[104:107], v[168:171]
    s_add_u32 s49, s44, 3670272
    ds_read_b64_tr_b16 a[162:163], v20 offset:4096
    v_mfma_f32_16x16x32_bf16 v[172:175], a[168:171], a[100:103], v[172:175]
    s_add_u32 m0, s42, 131072
    ds_read_b64_tr_b16 a[164:165], v20 offset:8192
    v_mfma_f32_16x16x32_bf16 v[172:175], a[172:175], a[108:111], v[172:175]
    s_waitcnt lgkmcnt(9)
    buffer_load_dwordx4 v42, s[16:19], s49 offen lds
    v_mfma_f32_16x16x32_bf16 v[176:179], a[176:179], a[96:99], v[176:179]
    s_waitcnt lgkmcnt(7)
    ds_read_b64_tr_b16 a[166:167], v20 offset:12288
    ds_read_b64_tr_b16 a[168:169], v21 offset:0
    v_mfma_f32_16x16x32_bf16 v[176:179], a[180:183], a[104:107], v[176:179]
    ds_read_b64_tr_b16 a[170:171], v21 offset:4096
    v_mfma_f32_16x16x32_bf16 v[180:183], a[176:179], a[100:103], v[180:183]
    ds_read_b64_tr_b16 a[172:173], v21 offset:8192
    v_mfma_f32_16x16x32_bf16 v[180:183], a[180:183], a[108:111], v[180:183]
    s_waitcnt lgkmcnt(9)
    buffer_load_dwordx4 v43, s[16:19], s49 offen offset:1024 lds
    v_mfma_f32_16x16x32_bf16 v[184:187], a[184:187], a[96:99], v[184:187]
    s_waitcnt lgkmcnt(7)
    ds_read_b64_tr_b16 a[174:175], v21 offset:12288
    ds_read_b64_tr_b16 a[176:177], v22 offset:0
    v_mfma_f32_16x16x32_bf16 v[184:187], a[188:191], a[104:107], v[184:187]
    ds_read_b64_tr_b16 a[178:179], v22 offset:4096
    v_mfma_f32_16x16x32_bf16 v[188:191], a[184:187], a[100:103], v[188:191]
    ds_read_b64_tr_b16 a[180:181], v22 offset:8192
    v_mfma_f32_16x16x32_bf16 v[188:191], a[188:191], a[108:111], v[188:191]
    s_waitcnt vmcnt(17)
    s_waitcnt lgkmcnt(9)
    buffer_load_dwordx4 v44, s[16:19], s49 offen offset:2048 lds
    v_mfma_f32_16x16x32_bf16 v[128:131], a[160:163], a[112:115], v[128:131]
    s_waitcnt vmcnt(17)
    s_waitcnt lgkmcnt(7)
    ds_read_b64_tr_b16 a[182:183], v22 offset:12288
    ds_read_b64_tr_b16 a[184:185], v23 offset:0
    v_mfma_f32_16x16x32_bf16 v[128:131], a[164:167], a[120:123], v[128:131]
    s_waitcnt vmcnt(16)
    ds_read_b64_tr_b16 a[186:187], v23 offset:4096
    v_mfma_f32_16x16x32_bf16 v[132:135], a[160:163], a[116:119], v[132:135]
    s_waitcnt vmcnt(15)
    ds_read_b64_tr_b16 a[188:189], v23 offset:8192
    v_mfma_f32_16x16x32_bf16 v[132:135], a[164:167], a[124:127], v[132:135]
    s_waitcnt lgkmcnt(9)
    buffer_load_dwordx4 v45, s[16:19], s49 offen offset:3072 lds
    v_mfma_f32_16x16x32_bf16 v[136:139], a[168:171], a[112:115], v[136:139]
    s_waitcnt lgkmcnt(7)
    ds_read_b64_tr_b16 a[190:191], v23 offset:12288
    ds_read_b64_tr_b16 a[160:161], v24 offset:0
    v_mfma_f32_16x16x32_bf16 v[136:139], a[172:175], a[120:123], v[136:139]
    s_add_u32 s49, s44, 4194560
    ds_read_b64_tr_b16 a[162:163], v24 offset:4096
    v_mfma_f32_16x16x32_bf16 v[140:143], a[168:171], a[116:119], v[140:143]
    s_add_u32 m0, s42, 147456
    ds_read_b64_tr_b16 a[164:165], v24 offset:8192
    v_mfma_f32_16x16x32_bf16 v[140:143], a[172:175], a[124:127], v[140:143]
    s_waitcnt lgkmcnt(9)
    buffer_load_dwordx4 v42, s[16:19], s49 offen lds
    v_mfma_f32_16x16x32_bf16 v[144:147], a[176:179], a[112:115], v[144:147]
    s_waitcnt lgkmcnt(7)
    ds_read_b64_tr_b16 a[166:167], v24 offset:12288
    ds_read_b64_tr_b16 a[168:169], v25 offset:0
    v_mfma_f32_16x16x32_bf16 v[144:147], a[180:183], a[120:123], v[144:147]
    ds_read_b64_tr_b16 a[170:171], v25 offset:4096
    v_mfma_f32_16x16x32_bf16 v[148:151], a[176:179], a[116:119], v[148:151]
    ds_read_b64_tr_b16 a[172:173], v25 offset:8192
    v_mfma_f32_16x16x32_bf16 v[148:151], a[180:183], a[124:127], v[148:151]
    s_waitcnt lgkmcnt(9)
    buffer_load_dwordx4 v43, s[16:19], s49 offen offset:1024 lds
    v_mfma_f32_16x16x32_bf16 v[152:155], a[184:187], a[112:115], v[152:155]
    s_waitcnt lgkmcnt(7)
    ds_read_b64_tr_b16 a[174:175], v25 offset:12288
    ds_read_b64_tr_b16 a[176:177], v26 offset:0
    v_mfma_f32_16x16x32_bf16 v[152:155], a[188:191], a[120:123], v[152:155]
    ds_read_b64_tr_b16 a[178:179], v26 offset:4096
    v_mfma_f32_16x16x32_bf16 v[156:159], a[184:187], a[116:119], v[156:159]
    ds_read_b64_tr_b16 a[180:181], v26 offset:8192
    v_mfma_f32_16x16x32_bf16 v[156:159], a[188:191], a[124:127], v[156:159]
    s_waitcnt lgkmcnt(9)
    buffer_load_dwordx4 v44, s[16:19], s49 offen offset:2048 lds
    v_mfma_f32_16x16x32_bf16 v[160:163], a[160:163], a[112:115], v[160:163]
    s_waitcnt lgkmcnt(7)
    ds_read_b64_tr_b16 a[182:183], v26 offset:12288
    ds_read_b64_tr_b16 a[184:185], v27 offset:0
    v_mfma_f32_16x16x32_bf16 v[160:163], a[164:167], a[120:123], v[160:163]
    ds_read_b64_tr_b16 a[186:187], v27 offset:4096
    v_mfma_f32_16x16x32_bf16 v[164:167], a[160:163], a[116:119], v[164:167]
    ds_read_b64_tr_b16 a[188:189], v27 offset:8192
    v_mfma_f32_16x16x32_bf16 v[164:167], a[164:167], a[124:127], v[164:167]
    s_waitcnt lgkmcnt(9)
    buffer_load_dwordx4 v45, s[16:19], s49 offen offset:3072 lds
    v_mfma_f32_16x16x32_bf16 v[168:171], a[168:171], a[112:115], v[168:171]
    s_waitcnt lgkmcnt(7)
    ds_read_b64_tr_b16 a[190:191], v27 offset:12288
    ds_read_b64_tr_b16 a[160:161], v20 offset:16384
    v_mfma_f32_16x16x32_bf16 v[168:171], a[172:175], a[120:123], v[168:171]
    ds_read_b64_tr_b16 a[162:163], v20 offset:20480
    v_mfma_f32_16x16x32_bf16 v[172:175], a[168:171], a[116:119], v[172:175]
    ds_read_b64_tr_b16 a[164:165], v20 offset:24576
    v_mfma_f32_16x16x32_bf16 v[172:175], a[172:175], a[124:127], v[172:175]
    s_waitcnt lgkmcnt(9)
    buffer_load_dword v78, v120, s[8:11], 0 offen
    v_mfma_f32_16x16x32_bf16 v[176:179], a[176:179], a[112:115], v[176:179]
    s_waitcnt lgkmcnt(7)
    ds_read_b64_tr_b16 a[166:167], v20 offset:28672
    ds_read_b64_tr_b16 a[168:169], v21 offset:16384
    v_mfma_f32_16x16x32_bf16 v[176:179], a[180:183], a[120:123], v[176:179]
    ds_read_b64_tr_b16 a[170:171], v21 offset:20480
    v_mfma_f32_16x16x32_bf16 v[180:183], a[176:179], a[116:119], v[180:183]
    ds_read_b64_tr_b16 a[172:173], v21 offset:24576
    v_mfma_f32_16x16x32_bf16 v[180:183], a[180:183], a[124:127], v[180:183]
    s_waitcnt lgkmcnt(9)
    buffer_load_dword v79, v121, s[12:15], 0 offen
    v_mfma_f32_16x16x32_bf16 v[184:187], a[184:187], a[112:115], v[184:187]
    s_waitcnt lgkmcnt(7)
    ds_read_b64_tr_b16 a[174:175], v21 offset:28672
    ds_read_b64_tr_b16 a[176:177], v22 offset:16384
    v_mfma_f32_16x16x32_bf16 v[184:187], a[188:191], a[120:123], v[184:187]
    ds_read_b64_tr_b16 a[178:179], v22 offset:20480
    v_mfma_f32_16x16x32_bf16 v[188:191], a[184:187], a[116:119], v[188:191]
    s_mov_b32 s36, 1040356334
    ds_read_b64_tr_b16 a[180:181], v22 offset:24576
    v_mfma_f32_16x16x32_bf16 v[188:191], a[188:191], a[124:127], v[188:191]
    s_waitcnt vmcnt(21)
    s_waitcnt lgkmcnt(9)
    buffer_store_dword v76, v72, s[24:27], s92 offen offset:12 sc1
    v_mfma_f32_16x16x32_bf16 v[128:131], a[160:163], a[128:131], v[128:131]
    s_waitcnt vmcnt(21)
    s_waitcnt lgkmcnt(7)
    ds_read_b64_tr_b16 a[182:183], v22 offset:28672
    ds_read_b64_tr_b16 a[184:185], v23 offset:16384
    v_mfma_f32_16x16x32_bf16 v[128:131], a[164:167], a[136:139], v[128:131]
    s_waitcnt vmcnt(12)
    ds_read_b64_tr_b16 a[186:187], v23 offset:20480
    v_mfma_f32_16x16x32_bf16 v[132:135], a[160:163], a[132:135], v[132:135]
    s_waitcnt vmcnt(11)
    ds_read_b64_tr_b16 a[188:189], v23 offset:24576
    v_mfma_f32_16x16x32_bf16 v[132:135], a[164:167], a[140:143], v[132:135]
    s_waitcnt lgkmcnt(9)
    buffer_store_dwordx4 v[88:91], v74, s[24:27], 0 offen sc1
    v_mfma_f32_16x16x32_bf16 v[136:139], a[168:171], a[128:131], v[136:139]
    s_waitcnt lgkmcnt(7)
    ds_read_b64_tr_b16 a[190:191], v23 offset:28672
    ds_read_b64_tr_b16 a[160:161], v24 offset:16384
    v_mfma_f32_16x16x32_bf16 v[136:139], a[172:175], a[136:139], v[136:139]
    ds_read_b64_tr_b16 a[162:163], v24 offset:20480
    v_mfma_f32_16x16x32_bf16 v[140:143], a[168:171], a[132:135], v[140:143]
    ds_read_b64_tr_b16 a[164:165], v24 offset:24576
    v_mfma_f32_16x16x32_bf16 v[140:143], a[172:175], a[140:143], v[140:143]
    s_waitcnt lgkmcnt(9)
    ds_read_b64_tr_b16 a[166:167], v24 offset:28672
    v_mfma_f32_16x16x32_bf16 v[144:147], a[176:179], a[128:131], v[144:147]
    s_waitcnt lgkmcnt(8)
    ds_read_b64_tr_b16 a[168:169], v25 offset:16384
    v_mfma_f32_16x16x32_bf16 v[144:147], a[180:183], a[136:139], v[144:147]
    ds_read_b64_tr_b16 a[170:171], v25 offset:20480
    v_mfma_f32_16x16x32_bf16 v[148:151], a[176:179], a[132:135], v[148:151]
    ds_read_b64_tr_b16 a[172:173], v25 offset:24576
    v_mfma_f32_16x16x32_bf16 v[148:151], a[180:183], a[140:143], v[148:151]
    s_waitcnt lgkmcnt(9)
    ds_read_b64_tr_b16 a[174:175], v25 offset:28672
    v_mul_f32 v128, s36, v128
    v_mfma_f32_16x16x32_bf16 v[152:155], a[184:187], a[128:131], v[152:155]
    s_waitcnt lgkmcnt(8)
    ds_read_b64_tr_b16 a[176:177], v26 offset:16384
    v_mul_f32 v129, s36, v129
    v_mfma_f32_16x16x32_bf16 v[152:155], a[188:191], a[136:139], v[152:155]
    ds_read_b64_tr_b16 a[178:179], v26 offset:20480
    v_mul_f32 v130, s36, v130
    v_mfma_f32_16x16x32_bf16 v[156:159], a[184:187], a[132:135], v[156:159]
    ds_read_b64_tr_b16 a[180:181], v26 offset:24576
    v_mul_f32 v131, s36, v131
    v_mfma_f32_16x16x32_bf16 v[156:159], a[188:191], a[140:143], v[156:159]
    s_waitcnt lgkmcnt(9)
    ds_read_b64_tr_b16 a[182:183], v26 offset:28672
    v_mul_f32 v136, s36, v136
    v_mfma_f32_16x16x32_bf16 v[160:163], a[160:163], a[128:131], v[160:163]
    s_waitcnt lgkmcnt(8)
    ds_read_b64_tr_b16 a[184:185], v27 offset:16384
    v_mul_f32 v137, s36, v137
    v_mfma_f32_16x16x32_bf16 v[160:163], a[164:167], a[136:139], v[160:163]
    ds_read_b64_tr_b16 a[186:187], v27 offset:20480
    v_mul_f32 v138, s36, v138
    v_mfma_f32_16x16x32_bf16 v[164:167], a[160:163], a[132:135], v[164:167]
    ds_read_b64_tr_b16 a[188:189], v27 offset:24576
    v_mul_f32 v139, s36, v139
    v_mfma_f32_16x16x32_bf16 v[164:167], a[164:167], a[140:143], v[164:167]
    s_waitcnt lgkmcnt(9)
    ds_read_b64_tr_b16 a[190:191], v27 offset:28672
    v_mul_f32 v132, s36, v132
    s_barrier
    v_mfma_f32_16x16x32_bf16 v[168:171], a[168:171], a[128:131], v[168:171]
    s_waitcnt lgkmcnt(8)
    ds_read_b64_tr_b16 a[160:161], v20 offset:32768
    v_mul_f32 v133, s36, v133
    v_mfma_f32_16x16x32_bf16 v[168:171], a[172:175], a[136:139], v[168:171]
    ds_read_b64_tr_b16 a[162:163], v20 offset:36864
    v_mul_f32 v134, s36, v134
    v_mfma_f32_16x16x32_bf16 v[172:175], a[168:171], a[132:135], v[172:175]
    s_add_u32 m0, s42, 0
    ds_read_b64_tr_b16 a[164:165], v20 offset:40960
    v_mul_f32 v135, s36, v135
    v_mfma_f32_16x16x32_bf16 v[172:175], a[172:175], a[140:143], v[172:175]
    s_waitcnt lgkmcnt(9)
    buffer_load_dwordx4 v36, s[8:11], s40 offen lds
    v_mfma_f32_16x16x32_bf16 v[176:179], a[176:179], a[128:131], v[176:179]
    s_waitcnt lgkmcnt(7)
    ds_read_b64_tr_b16 a[166:167], v20 offset:45056
    ds_read_b64_tr_b16 a[168:169], v21 offset:32768
    v_mfma_f32_16x16x32_bf16 v[176:179], a[180:183], a[136:139], v[176:179]
    ds_read_b64_tr_b16 a[170:171], v21 offset:36864
    v_mul_f32 v140, s36, v140
    v_mfma_f32_16x16x32_bf16 v[180:183], a[176:179], a[132:135], v[180:183]
    ds_read_b64_tr_b16 a[172:173], v21 offset:40960
    v_mul_f32 v141, s36, v141
    v_mfma_f32_16x16x32_bf16 v[180:183], a[180:183], a[140:143], v[180:183]
    s_waitcnt lgkmcnt(9)
    buffer_load_dwordx4 v37, s[8:11], s40 offen offset:1024 lds
    v_mfma_f32_16x16x32_bf16 v[184:187], a[184:187], a[128:131], v[184:187]
    s_waitcnt lgkmcnt(7)
    ds_read_b64_tr_b16 a[174:175], v21 offset:45056
    ds_read_b64_tr_b16 a[176:177], v22 offset:32768
    v_mfma_f32_16x16x32_bf16 v[184:187], a[188:191], a[136:139], v[184:187]
    ds_read_b64_tr_b16 a[178:179], v22 offset:36864
    v_mul_f32 v142, s36, v142
    v_mfma_f32_16x16x32_bf16 v[188:191], a[184:187], a[132:135], v[188:191]
Ltour2:
    s_cbranch_execz Ltour6
    ds_read_b64_tr_b16 a[180:181], v22 offset:40960
    v_mul_f32 v143, s36, v143
    v_mfma_f32_16x16x32_bf16 v[188:191], a[188:191], a[140:143], v[188:191]
    s_waitcnt lgkmcnt(9)
    buffer_load_dwordx4 v38, s[8:11], s40 offen offset:2048 lds
    v_mfma_f32_16x16x32_bf16 v[192:195], a[160:163], a[80:83], v[192:195]
    s_waitcnt lgkmcnt(7)
    ds_read_b64_tr_b16 a[182:183], v22 offset:45056
    ds_read_b64_tr_b16 a[184:185], v23 offset:32768
    v_mfma_f32_16x16x32_bf16 v[192:195], a[164:167], a[88:91], v[192:195]
    ds_read_b64_tr_b16 a[186:187], v23 offset:36864
    v_cvt_pk_bf16_f32 v64, v128, v129
    v_mfma_f32_16x16x32_bf16 v[196:199], a[160:163], a[84:87], v[196:199]
    ds_read_b64_tr_b16 a[188:189], v23 offset:40960
    v_cvt_pk_bf16_f32 v65, v130, v131
    v_mfma_f32_16x16x32_bf16 v[196:199], a[164:167], a[92:95], v[196:199]
    s_waitcnt lgkmcnt(9)
    buffer_load_dwordx4 v39, s[8:11], s40 offen offset:3072 lds
    v_mfma_f32_16x16x32_bf16 v[200:203], a[168:171], a[80:83], v[200:203]
    s_waitcnt lgkmcnt(7)
    s_add_u32 s40, s40, 16384
    ds_read_b64_tr_b16 a[190:191], v23 offset:45056
    ds_read_b64_tr_b16 a[160:161], v24 offset:32768
    v_mfma_f32_16x16x32_bf16 v[200:203], a[172:175], a[88:91], v[200:203]
    ds_read_b64_tr_b16 a[162:163], v24 offset:36864
    v_cvt_pk_bf16_f32 v66, v136, v137
    v_mfma_f32_16x16x32_bf16 v[204:207], a[168:171], a[84:87], v[204:207]
    s_add_u32 m0, s42, 16384
    ds_read_b64_tr_b16 a[164:165], v24 offset:40960
    v_cvt_pk_bf16_f32 v67, v138, v139
    v_mfma_f32_16x16x32_bf16 v[204:207], a[172:175], a[92:95], v[204:207]
    s_waitcnt lgkmcnt(9)
    buffer_load_dwordx4 v36, s[8:11], s40 offen lds
    v_mfma_f32_16x16x32_bf16 v[208:211], a[176:179], a[80:83], v[208:211]
    s_waitcnt lgkmcnt(7)
    ds_read_b64_tr_b16 a[166:167], v24 offset:45056
    ds_read_b64_tr_b16 a[168:169], v25 offset:32768
    v_mfma_f32_16x16x32_bf16 v[208:211], a[180:183], a[88:91], v[208:211]
    ds_read_b64_tr_b16 a[170:171], v25 offset:36864
    v_cvt_pk_bf16_f32 v80, v132, v133
    v_mfma_f32_16x16x32_bf16 v[212:215], a[176:179], a[84:87], v[212:215]
    ds_read_b64_tr_b16 a[172:173], v25 offset:40960
    v_cvt_pk_bf16_f32 v81, v134, v135
    v_mfma_f32_16x16x32_bf16 v[212:215], a[180:183], a[92:95], v[212:215]
    s_waitcnt lgkmcnt(9)
    buffer_load_dwordx4 v37, s[8:11], s40 offen offset:1024 lds
    v_mfma_f32_16x16x32_bf16 v[216:219], a[184:187], a[80:83], v[216:219]
    s_waitcnt lgkmcnt(7)
    ds_read_b64_tr_b16 a[174:175], v25 offset:45056
    ds_read_b64_tr_b16 a[176:177], v26 offset:32768
    v_mfma_f32_16x16x32_bf16 v[216:219], a[188:191], a[88:91], v[216:219]
    ds_read_b64_tr_b16 a[178:179], v26 offset:36864
    v_cvt_pk_bf16_f32 v82, v140, v141
    v_mfma_f32_16x16x32_bf16 v[220:223], a[184:187], a[84:87], v[220:223]
    ds_read_b64_tr_b16 a[180:181], v26 offset:40960
    v_cvt_pk_bf16_f32 v83, v142, v143
    v_mfma_f32_16x16x32_bf16 v[220:223], a[188:191], a[92:95], v[220:223]
    s_waitcnt lgkmcnt(9)
    buffer_load_dwordx4 v38, s[8:11], s40 offen offset:2048 lds
    v_mfma_f32_16x16x32_bf16 v[224:227], a[160:163], a[80:83], v[224:227]
    s_waitcnt lgkmcnt(7)
    ds_read_b64_tr_b16 a[182:183], v26 offset:45056
    ds_read_b64_tr_b16 a[184:185], v27 offset:32768
    v_mfma_f32_16x16x32_bf16 v[224:227], a[164:167], a[88:91], v[224:227]
    ds_read_b64_tr_b16 a[186:187], v27 offset:36864
    v_permlane32_swap_b32 v64, v66
    v_mfma_f32_16x16x32_bf16 v[228:231], a[160:163], a[84:87], v[228:231]
    ds_read_b64_tr_b16 a[188:189], v27 offset:40960
    v_permlane32_swap_b32 v65, v67
    v_mfma_f32_16x16x32_bf16 v[228:231], a[164:167], a[92:95], v[228:231]
    s_waitcnt lgkmcnt(9)
    buffer_load_dwordx4 v39, s[8:11], s40 offen offset:3072 lds
    v_mfma_f32_16x16x32_bf16 v[232:235], a[168:171], a[80:83], v[232:235]
    s_waitcnt lgkmcnt(7)
    s_add_u32 s40, s40, 16384
    ds_read_b64_tr_b16 a[190:191], v27 offset:45056
    ds_read_b64_tr_b16 a[160:161], v20 offset:49152
    v_mfma_f32_16x16x32_bf16 v[232:235], a[172:175], a[88:91], v[232:235]
    ds_read_b64_tr_b16 a[162:163], v20 offset:53248
    v_permlane32_swap_b32 v80, v82
    v_mfma_f32_16x16x32_bf16 v[236:239], a[168:171], a[84:87], v[236:239]
    ds_read_b64_tr_b16 a[164:165], v20 offset:57344
    v_permlane32_swap_b32 v81, v83
    v_mfma_f32_16x16x32_bf16 v[236:239], a[172:175], a[92:95], v[236:239]
    s_waitcnt lgkmcnt(9)
    ds_read_b64_tr_b16 a[166:167], v20 offset:61440
    v_permlane16_swap_b32 v64, v66
    v_mfma_f32_16x16x32_bf16 v[240:243], a[176:179], a[80:83], v[240:243]
    s_waitcnt lgkmcnt(8)
    ds_read_b64_tr_b16 a[168:169], v21 offset:49152
    v_permlane16_swap_b32 v65, v67
    v_mfma_f32_16x16x32_bf16 v[240:243], a[180:183], a[88:91], v[240:243]
    ds_read_b64_tr_b16 a[170:171], v21 offset:53248
    v_permlane16_swap_b32 v80, v82
    v_mfma_f32_16x16x32_bf16 v[244:247], a[176:179], a[84:87], v[244:247]
    ds_read_b64_tr_b16 a[172:173], v21 offset:57344
    v_permlane16_swap_b32 v81, v83
    v_mfma_f32_16x16x32_bf16 v[244:247], a[180:183], a[92:95], v[244:247]
    s_waitcnt lgkmcnt(9)
    ds_read_b64_tr_b16 a[174:175], v21 offset:61440
    v_mul_f32 v144, s36, v144
    v_mfma_f32_16x16x32_bf16 v[248:251], a[184:187], a[80:83], v[248:251]
    s_waitcnt lgkmcnt(8)
    ds_read_b64_tr_b16 a[176:177], v22 offset:49152
    v_mul_f32 v145, s36, v145
    v_mfma_f32_16x16x32_bf16 v[248:251], a[188:191], a[88:91], v[248:251]
    ds_read_b64_tr_b16 a[178:179], v22 offset:53248
    v_mul_f32 v146, s36, v146
    v_mfma_f32_16x16x32_bf16 v[252:255], a[184:187], a[84:87], v[252:255]
    ds_read_b64_tr_b16 a[180:181], v22 offset:57344
    v_mul_f32 v147, s36, v147
    v_mfma_f32_16x16x32_bf16 v[252:255], a[188:191], a[92:95], v[252:255]
    s_waitcnt lgkmcnt(9)
    ds_read_b64_tr_b16 a[182:183], v22 offset:61440
    v_mul_f32 v152, s36, v152
    v_mfma_f32_16x16x32_bf16 v[192:195], a[160:163], a[96:99], v[192:195]
    s_waitcnt lgkmcnt(8)
    ds_read_b64_tr_b16 a[184:185], v23 offset:49152
    v_mul_f32 v153, s36, v153
    v_mfma_f32_16x16x32_bf16 v[192:195], a[164:167], a[104:107], v[192:195]
    ds_read_b64_tr_b16 a[186:187], v23 offset:53248
    v_mul_f32 v154, s36, v154
    v_mfma_f32_16x16x32_bf16 v[196:199], a[160:163], a[100:103], v[196:199]
    ds_read_b64_tr_b16 a[188:189], v23 offset:57344
    v_mul_f32 v155, s36, v155
    v_mfma_f32_16x16x32_bf16 v[196:199], a[164:167], a[108:111], v[196:199]
    s_waitcnt lgkmcnt(9)
    ds_read_b64_tr_b16 a[190:191], v23 offset:61440
    v_mul_f32 v148, s36, v148
    v_mfma_f32_16x16x32_bf16 v[200:203], a[168:171], a[96:99], v[200:203]
    s_waitcnt lgkmcnt(8)
    ds_read_b64_tr_b16 a[160:161], v24 offset:49152
    v_mul_f32 v149, s36, v149
    v_mfma_f32_16x16x32_bf16 v[200:203], a[172:175], a[104:107], v[200:203]
    ds_read_b64_tr_b16 a[162:163], v24 offset:53248
    v_mul_f32 v150, s36, v150
    v_mfma_f32_16x16x32_bf16 v[204:207], a[168:171], a[100:103], v[204:207]
    ds_read_b64_tr_b16 a[164:165], v24 offset:57344
    v_mul_f32 v151, s36, v151
    v_mfma_f32_16x16x32_bf16 v[204:207], a[172:175], a[108:111], v[204:207]
    s_waitcnt lgkmcnt(9)
    ds_read_b64_tr_b16 a[166:167], v24 offset:61440
    v_mul_f32 v156, s36, v156
    v_mfma_f32_16x16x32_bf16 v[208:211], a[176:179], a[96:99], v[208:211]
    s_waitcnt lgkmcnt(8)
    ds_read_b64_tr_b16 a[168:169], v25 offset:49152
    v_mul_f32 v157, s36, v157
    v_mfma_f32_16x16x32_bf16 v[208:211], a[180:183], a[104:107], v[208:211]
    ds_read_b64_tr_b16 a[170:171], v25 offset:53248
    v_mul_f32 v158, s36, v158
    v_mfma_f32_16x16x32_bf16 v[212:215], a[176:179], a[100:103], v[212:215]
    ds_read_b64_tr_b16 a[172:173], v25 offset:57344
    v_mul_f32 v159, s36, v159
    v_mfma_f32_16x16x32_bf16 v[212:215], a[180:183], a[108:111], v[212:215]
    s_waitcnt lgkmcnt(9)
    ds_read_b64_tr_b16 a[174:175], v25 offset:61440
    v_cvt_pk_bf16_f32 v68, v144, v145
    v_mfma_f32_16x16x32_bf16 v[216:219], a[184:187], a[96:99], v[216:219]
    s_waitcnt lgkmcnt(8)
    ds_read_b64_tr_b16 a[176:177], v26 offset:49152
    v_cvt_pk_bf16_f32 v69, v146, v147
    v_mfma_f32_16x16x32_bf16 v[216:219], a[188:191], a[104:107], v[216:219]
    ds_read_b64_tr_b16 a[178:179], v26 offset:53248
    v_cvt_pk_bf16_f32 v70, v152, v153
    v_mfma_f32_16x16x32_bf16 v[220:223], a[184:187], a[100:103], v[220:223]
    ds_read_b64_tr_b16 a[180:181], v26 offset:57344
    v_cvt_pk_bf16_f32 v71, v154, v155
    v_mfma_f32_16x16x32_bf16 v[220:223], a[188:191], a[108:111], v[220:223]
    s_waitcnt lgkmcnt(9)
    ds_read_b64_tr_b16 a[182:183], v26 offset:61440
    v_cvt_pk_bf16_f32 v84, v148, v149
    v_mfma_f32_16x16x32_bf16 v[224:227], a[160:163], a[96:99], v[224:227]
    s_waitcnt lgkmcnt(8)
    ds_read_b64_tr_b16 a[184:185], v27 offset:49152
    v_cvt_pk_bf16_f32 v85, v150, v151
    v_mfma_f32_16x16x32_bf16 v[224:227], a[164:167], a[104:107], v[224:227]
    ds_read_b64_tr_b16 a[186:187], v27 offset:53248
    v_cvt_pk_bf16_f32 v86, v156, v157
    v_mfma_f32_16x16x32_bf16 v[228:231], a[160:163], a[100:103], v[228:231]
    ds_read_b64_tr_b16 a[188:189], v27 offset:57344
    v_cvt_pk_bf16_f32 v87, v158, v159
    v_mfma_f32_16x16x32_bf16 v[228:231], a[164:167], a[108:111], v[228:231]
    s_waitcnt lgkmcnt(9)
    ds_read_b64_tr_b16 a[190:191], v27 offset:61440
    v_permlane32_swap_b32 v68, v70
    s_waitcnt vmcnt(12)
    s_barrier
    v_mfma_f32_16x16x32_bf16 v[232:235], a[168:171], a[96:99], v[232:235]
    s_waitcnt lgkmcnt(8)
    ds_read_b64_tr_b16 a[160:161], v28 offset:0
    v_permlane32_swap_b32 v69, v71
    v_mfma_f32_16x16x32_bf16 v[232:235], a[172:175], a[104:107], v[232:235]
    ds_read_b64_tr_b16 a[162:163], v28 offset:4096
    v_permlane32_swap_b32 v84, v86
    v_mfma_f32_16x16x32_bf16 v[236:239], a[168:171], a[100:103], v[236:239]
    s_add_u32 m0, s42, 32768
    ds_read_b64_tr_b16 a[164:165], v28 offset:8192
    v_permlane32_swap_b32 v85, v87
    v_mfma_f32_16x16x32_bf16 v[236:239], a[172:175], a[108:111], v[236:239]
    s_waitcnt lgkmcnt(9)
    buffer_load_dwordx4 v36, s[8:11], s40 offen lds
    v_mfma_f32_16x16x32_bf16 v[240:243], a[176:179], a[96:99], v[240:243]
    s_waitcnt lgkmcnt(7)
    ds_read_b64_tr_b16 a[166:167], v28 offset:12288
    ds_read_b64_tr_b16 a[168:169], v29 offset:0
    v_mfma_f32_16x16x32_bf16 v[240:243], a[180:183], a[104:107], v[240:243]
    ds_read_b64_tr_b16 a[170:171], v29 offset:4096
    v_permlane16_swap_b32 v68, v70
    v_mfma_f32_16x16x32_bf16 v[244:247], a[176:179], a[100:103], v[244:247]
    ds_read_b64_tr_b16 a[172:173], v29 offset:8192
    v_permlane16_swap_b32 v69, v71
    v_mfma_f32_16x16x32_bf16 v[244:247], a[180:183], a[108:111], v[244:247]
    s_waitcnt lgkmcnt(9)
    buffer_load_dwordx4 v37, s[8:11], s40 offen offset:1024 lds
    v_mfma_f32_16x16x32_bf16 v[248:251], a[184:187], a[96:99], v[248:251]
    s_waitcnt lgkmcnt(7)
    ds_read_b64_tr_b16 a[174:175], v29 offset:12288
    ds_read_b64_tr_b16 a[176:177], v30 offset:0
    v_mfma_f32_16x16x32_bf16 v[248:251], a[188:191], a[104:107], v[248:251]
    ds_read_b64_tr_b16 a[178:179], v30 offset:4096
    v_permlane16_swap_b32 v84, v86
    v_mfma_f32_16x16x32_bf16 v[252:255], a[184:187], a[100:103], v[252:255]
    ds_read_b64_tr_b16 a[180:181], v30 offset:8192
    v_permlane16_swap_b32 v85, v87
    v_mfma_f32_16x16x32_bf16 v[252:255], a[188:191], a[108:111], v[252:255]
    s_waitcnt lgkmcnt(9)
    buffer_load_dwordx4 v38, s[8:11], s40 offen offset:2048 lds
    v_mfma_f32_16x16x32_bf16 v[192:195], a[160:163], a[112:115], v[192:195]
    s_waitcnt lgkmcnt(7)
    ds_read_b64_tr_b16 a[182:183], v30 offset:12288
    ds_read_b64_tr_b16 a[184:185], v31 offset:0
    v_mfma_f32_16x16x32_bf16 v[192:195], a[164:167], a[120:123], v[192:195]
    ds_read_b64_tr_b16 a[186:187], v31 offset:4096
    v_mul_f32 v160, s36, v160
    v_mfma_f32_16x16x32_bf16 v[196:199], a[160:163], a[116:119], v[196:199]
    ds_read_b64_tr_b16 a[188:189], v31 offset:8192
    v_mul_f32 v161, s36, v161
    v_mfma_f32_16x16x32_bf16 v[196:199], a[164:167], a[124:127], v[196:199]
    s_waitcnt lgkmcnt(9)
    buffer_load_dwordx4 v39, s[8:11], s40 offen offset:3072 lds
    v_mfma_f32_16x16x32_bf16 v[200:203], a[168:171], a[112:115], v[200:203]
    s_waitcnt lgkmcnt(7)
    s_add_u32 s40, s40, 16384
    ds_read_b64_tr_b16 a[190:191], v31 offset:12288
    ds_read_b64_tr_b16 a[160:161], v32 offset:0
    v_mfma_f32_16x16x32_bf16 v[200:203], a[172:175], a[120:123], v[200:203]
    ds_read_b64_tr_b16 a[162:163], v32 offset:4096
    v_mul_f32 v162, s36, v162
    v_mfma_f32_16x16x32_bf16 v[204:207], a[168:171], a[116:119], v[204:207]
    s_add_u32 m0, s42, 65536
    ds_read_b64_tr_b16 a[164:165], v32 offset:8192
    v_mul_f32 v163, s36, v163
    v_mfma_f32_16x16x32_bf16 v[204:207], a[172:175], a[124:127], v[204:207]
    s_waitcnt lgkmcnt(9)
    buffer_load_dwordx4 v40, s[12:15], s41 offen lds
    v_mfma_f32_16x16x32_bf16 v[208:211], a[176:179], a[112:115], v[208:211]
    s_waitcnt lgkmcnt(7)
    ds_read_b64_tr_b16 a[166:167], v32 offset:12288
    ds_read_b64_tr_b16 a[168:169], v33 offset:0
    v_mfma_f32_16x16x32_bf16 v[208:211], a[180:183], a[120:123], v[208:211]
    ds_read_b64_tr_b16 a[170:171], v33 offset:4096
    v_mul_f32 v168, s36, v168
    v_mfma_f32_16x16x32_bf16 v[212:215], a[176:179], a[116:119], v[212:215]
    ds_read_b64_tr_b16 a[172:173], v33 offset:8192
    v_mul_f32 v169, s36, v169
    v_mfma_f32_16x16x32_bf16 v[212:215], a[180:183], a[124:127], v[212:215]
    s_waitcnt lgkmcnt(9)
    buffer_load_dwordx4 v41, s[12:15], s41 offen offset:1024 lds
    v_mfma_f32_16x16x32_bf16 v[216:219], a[184:187], a[112:115], v[216:219]
    s_waitcnt lgkmcnt(7)
    ds_read_b64_tr_b16 a[174:175], v33 offset:12288
    ds_read_b64_tr_b16 a[176:177], v34 offset:0
    v_mfma_f32_16x16x32_bf16 v[216:219], a[188:191], a[120:123], v[216:219]
    ds_read_b64_tr_b16 a[178:179], v34 offset:4096
    v_mul_f32 v170, s36, v170
    v_mfma_f32_16x16x32_bf16 v[220:223], a[184:187], a[116:119], v[220:223]
    ds_read_b64_tr_b16 a[180:181], v34 offset:8192
    v_mul_f32 v171, s36, v171
    v_mfma_f32_16x16x32_bf16 v[220:223], a[188:191], a[124:127], v[220:223]
    s_waitcnt lgkmcnt(9)
    buffer_load_dwordx4 v40, s[12:15], s41 offen offset:2048 lds
    v_mfma_f32_16x16x32_bf16 v[224:227], a[160:163], a[112:115], v[224:227]
    s_waitcnt lgkmcnt(7)
    ds_read_b64_tr_b16 a[182:183], v34 offset:12288
    ds_read_b64_tr_b16 a[184:185], v35 offset:0
    v_mfma_f32_16x16x32_bf16 v[224:227], a[164:167], a[120:123], v[224:227]
    ds_read_b64_tr_b16 a[186:187], v35 offset:4096
    v_mul_f32 v164, s36, v164
    v_mfma_f32_16x16x32_bf16 v[228:231], a[160:163], a[116:119], v[228:231]
    ds_read_b64_tr_b16 a[188:189], v35 offset:8192
    v_mul_f32 v165, s36, v165
    v_mfma_f32_16x16x32_bf16 v[228:231], a[164:167], a[124:127], v[228:231]
    s_waitcnt lgkmcnt(9)
    buffer_load_dwordx4 v41, s[12:15], s41 offen offset:3072 lds
    v_mfma_f32_16x16x32_bf16 v[232:235], a[168:171], a[112:115], v[232:235]
    s_waitcnt lgkmcnt(7)
    s_add_u32 s41, s41, 16384
    ds_read_b64_tr_b16 a[190:191], v35 offset:12288
    ds_read_b64_tr_b16 a[160:161], v28 offset:16384
    v_mfma_f32_16x16x32_bf16 v[232:235], a[172:175], a[120:123], v[232:235]
    ds_read_b64_tr_b16 a[162:163], v28 offset:20480
    v_mul_f32 v166, s36, v166
    v_mfma_f32_16x16x32_bf16 v[236:239], a[168:171], a[116:119], v[236:239]
    s_add_u32 m0, s42, 81920
    ds_read_b64_tr_b16 a[164:165], v28 offset:24576
    v_mul_f32 v167, s36, v167
    v_mfma_f32_16x16x32_bf16 v[236:239], a[172:175], a[124:127], v[236:239]
    s_waitcnt lgkmcnt(9)
    buffer_load_dwordx4 v40, s[12:15], s41 offen lds
    v_mfma_f32_16x16x32_bf16 v[240:243], a[176:179], a[112:115], v[240:243]
    s_waitcnt lgkmcnt(7)
    ds_read_b64_tr_b16 a[166:167], v28 offset:28672
    ds_read_b64_tr_b16 a[168:169], v29 offset:16384
    v_mfma_f32_16x16x32_bf16 v[240:243], a[180:183], a[120:123], v[240:243]
    ds_read_b64_tr_b16 a[170:171], v29 offset:20480
    v_mul_f32 v172, s36, v172
    v_mfma_f32_16x16x32_bf16 v[244:247], a[176:179], a[116:119], v[244:247]
    ds_read_b64_tr_b16 a[172:173], v29 offset:24576
    v_mul_f32 v173, s36, v173
    v_mfma_f32_16x16x32_bf16 v[244:247], a[180:183], a[124:127], v[244:247]
    s_waitcnt lgkmcnt(9)
    buffer_load_dwordx4 v41, s[12:15], s41 offen offset:1024 lds
    v_mfma_f32_16x16x32_bf16 v[248:251], a[184:187], a[112:115], v[248:251]
    s_waitcnt lgkmcnt(7)
    ds_read_b64_tr_b16 a[174:175], v29 offset:28672
    ds_read_b64_tr_b16 a[176:177], v30 offset:16384
    v_mfma_f32_16x16x32_bf16 v[248:251], a[188:191], a[120:123], v[248:251]
    ds_read_b64_tr_b16 a[178:179], v30 offset:20480
    v_mul_f32 v174, s36, v174
    v_mfma_f32_16x16x32_bf16 v[252:255], a[184:187], a[116:119], v[252:255]
    ds_read_b64_tr_b16 a[180:181], v30 offset:24576
    v_mul_f32 v175, s36, v175
    v_mfma_f32_16x16x32_bf16 v[252:255], a[188:191], a[124:127], v[252:255]
    s_waitcnt lgkmcnt(9)
    buffer_load_dwordx4 v40, s[12:15], s41 offen offset:2048 lds
    v_mfma_f32_16x16x32_bf16 v[192:195], a[160:163], a[128:131], v[192:195]
    s_waitcnt lgkmcnt(7)
    ds_read_b64_tr_b16 a[182:183], v30 offset:28672
    ds_read_b64_tr_b16 a[184:185], v31 offset:16384
    v_mfma_f32_16x16x32_bf16 v[192:195], a[164:167], a[136:139], v[192:195]
    ds_read_b64_tr_b16 a[186:187], v31 offset:20480
    v_cvt_pk_bf16_f32 v72, v160, v161
    v_mfma_f32_16x16x32_bf16 v[196:199], a[160:163], a[132:135], v[196:199]
    ds_read_b64_tr_b16 a[188:189], v31 offset:24576
    v_cvt_pk_bf16_f32 v73, v162, v163
    v_mfma_f32_16x16x32_bf16 v[196:199], a[164:167], a[140:143], v[196:199]
    s_waitcnt lgkmcnt(9)
    buffer_load_dwordx4 v41, s[12:15], s41 offen offset:3072 lds
    v_mfma_f32_16x16x32_bf16 v[200:203], a[168:171], a[128:131], v[200:203]
    s_waitcnt lgkmcnt(7)
    s_add_u32 s41, s41, 16384
    ds_read_b64_tr_b16 a[190:191], v31 offset:28672
    ds_read_b64_tr_b16 a[160:161], v32 offset:16384
    v_mfma_f32_16x16x32_bf16 v[200:203], a[172:175], a[136:139], v[200:203]
    ds_read_b64_tr_b16 a[162:163], v32 offset:20480
    v_cvt_pk_bf16_f32 v74, v168, v169
    v_mfma_f32_16x16x32_bf16 v[204:207], a[168:171], a[132:135], v[204:207]
    ds_read_b64_tr_b16 a[164:165], v32 offset:24576
    v_cvt_pk_bf16_f32 v75, v170, v171
    v_mfma_f32_16x16x32_bf16 v[204:207], a[172:175], a[140:143], v[204:207]
    s_waitcnt lgkmcnt(9)
    ds_read_b64_tr_b16 a[166:167], v32 offset:28672
    v_cvt_pk_bf16_f32 v88, v164, v165
    v_mfma_f32_16x16x32_bf16 v[208:211], a[176:179], a[128:131], v[208:211]
    s_waitcnt lgkmcnt(8)
    ds_read_b64_tr_b16 a[168:169], v33 offset:16384
    v_cvt_pk_bf16_f32 v89, v166, v167
    v_mfma_f32_16x16x32_bf16 v[208:211], a[180:183], a[136:139], v[208:211]
    ds_read_b64_tr_b16 a[170:171], v33 offset:20480
    v_cvt_pk_bf16_f32 v90, v172, v173
    v_mfma_f32_16x16x32_bf16 v[212:215], a[176:179], a[132:135], v[212:215]
    ds_read_b64_tr_b16 a[172:173], v33 offset:24576
    v_cvt_pk_bf16_f32 v91, v174, v175
    v_mfma_f32_16x16x32_bf16 v[212:215], a[180:183], a[140:143], v[212:215]
    s_waitcnt lgkmcnt(9)
    ds_read_b64_tr_b16 a[174:175], v33 offset:28672
    v_permlane32_swap_b32 v72, v74
    v_mfma_f32_16x16x32_bf16 v[216:219], a[184:187], a[128:131], v[216:219]
    s_waitcnt lgkmcnt(8)
    ds_read_b64_tr_b16 a[176:177], v34 offset:16384
    v_permlane32_swap_b32 v73, v75
    v_mfma_f32_16x16x32_bf16 v[216:219], a[188:191], a[136:139], v[216:219]
    ds_read_b64_tr_b16 a[178:179], v34 offset:20480
    v_permlane32_swap_b32 v88, v90
    v_mfma_f32_16x16x32_bf16 v[220:223], a[184:187], a[132:135], v[220:223]
    ds_read_b64_tr_b16 a[180:181], v34 offset:24576
    v_permlane32_swap_b32 v89, v91
    v_mfma_f32_16x16x32_bf16 v[220:223], a[188:191], a[140:143], v[220:223]
    s_waitcnt lgkmcnt(9)
    ds_read_b64_tr_b16 a[182:183], v34 offset:28672
    v_permlane16_swap_b32 v72, v74
    v_mfma_f32_16x16x32_bf16 v[224:227], a[160:163], a[128:131], v[224:227]
    s_waitcnt lgkmcnt(8)
    ds_read_b64_tr_b16 a[184:185], v35 offset:16384
    v_permlane16_swap_b32 v73, v75
    v_mfma_f32_16x16x32_bf16 v[224:227], a[164:167], a[136:139], v[224:227]
    ds_read_b64_tr_b16 a[186:187], v35 offset:20480
    v_permlane16_swap_b32 v88, v90
    v_mfma_f32_16x16x32_bf16 v[228:231], a[160:163], a[132:135], v[228:231]
    ds_read_b64_tr_b16 a[188:189], v35 offset:24576
    v_permlane16_swap_b32 v89, v91
    v_mfma_f32_16x16x32_bf16 v[228:231], a[164:167], a[140:143], v[228:231]
    s_waitcnt lgkmcnt(9)
    ds_read_b64_tr_b16 a[190:191], v35 offset:28672
    v_mul_f32 v176, s36, v176
    v_mfma_f32_16x16x32_bf16 v[232:235], a[168:171], a[128:131], v[232:235]
    s_waitcnt lgkmcnt(8)
    v_mul_f32 v177, s36, v177
    v_mul_f32 v178, s36, v178
    v_mfma_f32_16x16x32_bf16 v[232:235], a[172:175], a[136:139], v[232:235]
    v_mul_f32 v179, s36, v179
    v_mul_f32 v184, s36, v184
    v_mfma_f32_16x16x32_bf16 v[236:239], a[168:171], a[132:135], v[236:239]
    v_mul_f32 v185, s36, v185
    v_mul_f32 v186, s36, v186
    v_mfma_f32_16x16x32_bf16 v[236:239], a[172:175], a[140:143], v[236:239]
    s_waitcnt lgkmcnt(6)
    v_mul_f32 v187, s36, v187
    v_mul_f32 v180, s36, v180
    s_waitcnt vmcnt(16)
    s_barrier
    v_mfma_f32_16x16x32_bf16 v[240:243], a[176:179], a[128:131], v[240:243]
    s_waitcnt lgkmcnt(4)
    ds_read_b128 a[208:211], v8 offset:0
    v_mul_f32 v181, s36, v181
    v_mfma_f32_16x16x32_bf16 v[240:243], a[180:183], a[136:139], v[240:243]
    ds_read_b128 a[212:215], v9 offset:0
    v_mul_f32 v182, s36, v182
    v_mfma_f32_16x16x32_bf16 v[244:247], a[176:179], a[132:135], v[244:247]
    ds_read_b128 a[216:219], v10 offset:0
    v_mul_f32 v183, s36, v183
    v_mfma_f32_16x16x32_bf16 v[244:247], a[180:183], a[140:143], v[244:247]
    s_waitcnt lgkmcnt(5)
    ds_read_b128 a[220:223], v11 offset:0
    v_mul_f32 v188, s36, v188
    v_mfma_f32_16x16x32_bf16 v[248:251], a[184:187], a[128:131], v[248:251]
    s_waitcnt lgkmcnt(4)
    ds_read_b128 a[224:227], v8 offset:4096
    v_mul_f32 v189, s36, v189
    v_mfma_f32_16x16x32_bf16 v[248:251], a[188:191], a[136:139], v[248:251]
    v_mul_f32 v190, s36, v190
    v_mul_f32 v191, s36, v191
    v_mfma_f32_16x16x32_bf16 v[252:255], a[184:187], a[132:135], v[252:255]
    s_load_dwordx2 s[16:17], s[0:1], 88
    v_cvt_pk_bf16_f32 v76, v176, v177
    v_cvt_pk_bf16_f32 v77, v178, v179
    v_mfma_f32_16x16x32_bf16 v[252:255], a[188:191], a[140:143], v[252:255]
    v_cvt_pk_bf16_f32 v78, v184, v185
    v_cvt_pk_bf16_f32 v79, v186, v187
    v_cvt_pk_bf16_f32 v92, v180, v181
    v_cvt_pk_bf16_f32 v93, v182, v183
    v_cvt_pk_bf16_f32 v94, v188, v189
    v_cvt_pk_bf16_f32 v95, v190, v191
    v_permlane32_swap_b32 v76, v78
    v_permlane32_swap_b32 v77, v79
    v_permlane32_swap_b32 v92, v94
    v_permlane32_swap_b32 v93, v95
    v_permlane16_swap_b32 v76, v78
    v_permlane16_swap_b32 v77, v79
    v_permlane16_swap_b32 v92, v94
    v_permlane16_swap_b32 v93, v95
    s_mov_b32 s36, 1040356334
    s_mov_b32 s37, 1040356334
    v_mov_b32 v58, 0
    v_mov_b32 v59, 0
    v_mov_b32 v60, 0
    v_mov_b32 v61, 0
    v_pk_mul_f32 v[192:193], v[192:193], s[36:37]
    v_pk_mul_f32 v[194:195], v[194:195], s[36:37]
    v_pk_mul_f32 v[200:201], v[200:201], s[36:37]
    v_pk_mul_f32 v[202:203], v[202:203], s[36:37]
    v_pk_mul_f32 v[196:197], v[196:197], s[36:37]
    v_pk_mul_f32 v[198:199], v[198:199], s[36:37]
    v_pk_mul_f32 v[204:205], v[204:205], s[36:37]
    v_pk_mul_f32 v[206:207], v[206:207], s[36:37]
    v_mfma_f32_32x32x16_bf16 a[0:15], v[58:61], v[58:61], 0
    v_cvt_pk_bf16_f32 v96, v192, v193
    v_cvt_pk_bf16_f32 v97, v194, v195
    v_cvt_pk_bf16_f32 v98, v200, v201
    v_cvt_pk_bf16_f32 v99, v202, v203
    v_cvt_pk_bf16_f32 v112, v196, v197
    v_cvt_pk_bf16_f32 v113, v198, v199
    v_cvt_pk_bf16_f32 v114, v204, v205
    v_cvt_pk_bf16_f32 v115, v206, v207
    v_mfma_f32_32x32x16_bf16 a[16:31], v[58:61], v[58:61], 0
    v_permlane32_swap_b32 v96, v98
    v_permlane32_swap_b32 v97, v99
    v_permlane32_swap_b32 v112, v114
    v_permlane32_swap_b32 v113, v115
    v_permlane16_swap_b32 v96, v98
    v_permlane16_swap_b32 v97, v99
    v_permlane16_swap_b32 v112, v114
    v_permlane16_swap_b32 v113, v115
    v_pk_mul_f32 v[208:209], v[208:209], s[36:37]
    v_pk_mul_f32 v[210:211], v[210:211], s[36:37]
    v_pk_mul_f32 v[216:217], v[216:217], s[36:37]
    v_pk_mul_f32 v[218:219], v[218:219], s[36:37]
    v_pk_mul_f32 v[212:213], v[212:213], s[36:37]
    v_pk_mul_f32 v[214:215], v[214:215], s[36:37]
    v_pk_mul_f32 v[220:221], v[220:221], s[36:37]
    v_pk_mul_f32 v[222:223], v[222:223], s[36:37]
    v_mfma_f32_32x32x16_bf16 a[32:47], v[58:61], v[58:61], 0
    v_cvt_pk_bf16_f32 v100, v208, v209
    v_cvt_pk_bf16_f32 v101, v210, v211
    v_cvt_pk_bf16_f32 v102, v216, v217
    v_cvt_pk_bf16_f32 v103, v218, v219
    v_cvt_pk_bf16_f32 v116, v212, v213
    v_cvt_pk_bf16_f32 v117, v214, v215
    v_cvt_pk_bf16_f32 v118, v220, v221
    v_cvt_pk_bf16_f32 v119, v222, v223
    v_mfma_f32_32x32x16_bf16 a[48:63], v[58:61], v[58:61], 0
    v_permlane32_swap_b32 v100, v102
    v_permlane32_swap_b32 v101, v103
    v_permlane32_swap_b32 v116, v118
    v_permlane32_swap_b32 v117, v119
    v_permlane16_swap_b32 v100, v102
    v_permlane16_swap_b32 v101, v103
    v_permlane16_swap_b32 v116, v118
    v_permlane16_swap_b32 v117, v119
    v_pk_mul_f32 v[224:225], v[224:225], s[36:37]
    v_pk_mul_f32 v[226:227], v[226:227], s[36:37]
    v_pk_mul_f32 v[232:233], v[232:233], s[36:37]
    v_pk_mul_f32 v[234:235], v[234:235], s[36:37]
    v_pk_mul_f32 v[228:229], v[228:229], s[36:37]
    v_pk_mul_f32 v[230:231], v[230:231], s[36:37]
    v_pk_mul_f32 v[236:237], v[236:237], s[36:37]
    v_pk_mul_f32 v[238:239], v[238:239], s[36:37]
    v_mfma_f32_32x32x16_bf16 a[64:79], v[58:61], v[58:61], 0
    v_cvt_pk_bf16_f32 v104, v224, v225
    v_cvt_pk_bf16_f32 v105, v226, v227
    v_cvt_pk_bf16_f32 v106, v232, v233
    v_cvt_pk_bf16_f32 v107, v234, v235
    v_cvt_pk_bf16_f32 v120, v228, v229
    v_cvt_pk_bf16_f32 v121, v230, v231
    v_cvt_pk_bf16_f32 v122, v236, v237
    v_cvt_pk_bf16_f32 v123, v238, v239
    v_mfma_f32_32x32x16_bf16 a[80:95], v[58:61], v[58:61], 0
    v_permlane32_swap_b32 v104, v106
    v_permlane32_swap_b32 v105, v107
    v_permlane32_swap_b32 v120, v122
    v_permlane32_swap_b32 v121, v123
    v_permlane16_swap_b32 v104, v106
    v_permlane16_swap_b32 v105, v107
    v_permlane16_swap_b32 v120, v122
    v_permlane16_swap_b32 v121, v123
    v_pk_mul_f32 v[240:241], v[240:241], s[36:37]
    v_pk_mul_f32 v[242:243], v[242:243], s[36:37]
    v_pk_mul_f32 v[248:249], v[248:249], s[36:37]
    v_pk_mul_f32 v[250:251], v[250:251], s[36:37]
    v_pk_mul_f32 v[244:245], v[244:245], s[36:37]
    v_pk_mul_f32 v[246:247], v[246:247], s[36:37]
    v_pk_mul_f32 v[252:253], v[252:253], s[36:37]
    v_pk_mul_f32 v[254:255], v[254:255], s[36:37]
    v_mfma_f32_32x32x16_bf16 a[96:111], v[58:61], v[58:61], 0
    v_cvt_pk_bf16_f32 v108, v240, v241
    v_cvt_pk_bf16_f32 v109, v242, v243
    v_cvt_pk_bf16_f32 v110, v248, v249
    v_cvt_pk_bf16_f32 v111, v250, v251
    v_cvt_pk_bf16_f32 v124, v244, v245
    v_cvt_pk_bf16_f32 v125, v246, v247
    v_cvt_pk_bf16_f32 v126, v252, v253
    v_cvt_pk_bf16_f32 v127, v254, v255
    v_mfma_f32_32x32x16_bf16 a[112:127], v[58:61], v[58:61], 0
    v_permlane32_swap_b32 v108, v110
    v_permlane32_swap_b32 v109, v111
    v_permlane32_swap_b32 v124, v126
    v_permlane32_swap_b32 v125, v127
    v_permlane16_swap_b32 v108, v110
    v_permlane16_swap_b32 v109, v111
    v_permlane16_swap_b32 v124, v126
    v_permlane16_swap_b32 v125, v127
    s_waitcnt lgkmcnt(0)
    v_mfma_f32_16x16x32_bf16 v[216:219], a[208:211], v[64:67], 0
    v_mfma_f32_16x16x32_bf16 v[216:219], a[212:215], v[68:71], v[216:219]
    v_mfma_f32_16x16x32_bf16 v[216:219], a[216:219], v[72:75], v[216:219]
    v_mfma_f32_16x16x32_bf16 v[216:219], a[220:223], v[76:79], v[216:219]
    v_mfma_f32_16x16x32_bf16 v[220:223], a[208:211], v[80:83], 0
    v_mfma_f32_16x16x32_bf16 v[220:223], a[212:215], v[84:87], v[220:223]
    v_mfma_f32_16x16x32_bf16 v[220:223], a[216:219], v[88:91], v[220:223]
    v_mfma_f32_16x16x32_bf16 v[220:223], a[220:223], v[92:95], v[220:223]
    v_mfma_f32_16x16x32_bf16 v[224:227], a[208:211], v[96:99], 0
    v_mfma_f32_16x16x32_bf16 v[224:227], a[212:215], v[100:103], v[224:227]
    v_mfma_f32_16x16x32_bf16 v[224:227], a[216:219], v[104:107], v[224:227]
    v_mfma_f32_16x16x32_bf16 v[224:227], a[220:223], v[108:111], v[224:227]
    v_mfma_f32_16x16x32_bf16 v[228:231], a[208:211], v[112:115], 0
    v_mfma_f32_16x16x32_bf16 v[228:231], a[212:215], v[116:119], v[228:231]
    v_mfma_f32_16x16x32_bf16 v[228:231], a[216:219], v[120:123], v[228:231]
    v_mfma_f32_16x16x32_bf16 v[228:231], a[220:223], v[124:127], v[228:231]
    v_mfma_f32_32x32x16_bf16 a[192:207], v[58:61], v[58:61], 0
    v_max3_f32 v232, v216, v217, v218
    v_max_f32 v232, v232, v219
    v_max3_f32 v233, v220, v221, v222
    v_max_f32 v233, v233, v223
    v_max3_f32 v234, v224, v225, v226
    v_max_f32 v234, v234, v227
    s_nop 0
    v_max3_f32 v235, v228, v229, v230
    v_max_f32 v235, v235, v231
    v_mov_b32 v236, v232
    v_mov_b32 v237, v233
    v_mov_b32 v238, v234
    v_mov_b32 v239, v235
    v_permlane16_swap_b32 v232, v236
    v_permlane16_swap_b32 v233, v237
    v_permlane16_swap_b32 v234, v238
    v_permlane16_swap_b32 v235, v239
    v_max_f32 v232, v232, v236
    v_max_f32 v233, v233, v237
    v_max_f32 v234, v234, v238
    v_max_f32 v235, v235, v239
    v_mov_b32 v236, v232
    v_mov_b32 v237, v233
    v_mov_b32 v238, v234
    v_mov_b32 v239, v235
    v_permlane32_swap_b32 v232, v236
    v_permlane32_swap_b32 v233, v237
    v_permlane32_swap_b32 v234, v238
    v_permlane32_swap_b32 v235, v239
    v_max_f32 v232, v232, v236
    v_max_f32 v233, v233, v237
    v_max_f32 v234, v234, v238
    v_max_f32 v235, v235, v239
Ltour3:
    s_cbranch_execz Ltour7
    v_sub_f32 v192, 3250585600, v232
    v_sub_f32 v193, 3250585600, v232
    v_sub_f32 v194, 3250585600, v232
    v_sub_f32 v195, 3250585600, v232
    v_sub_f32 v196, 3250585600, v233
    v_sub_f32 v197, 3250585600, v233
    v_sub_f32 v198, 3250585600, v233
    v_sub_f32 v199, 3250585600, v233
    v_sub_f32 v200, 3250585600, v234
    v_sub_f32 v201, 3250585600, v234
    v_sub_f32 v202, 3250585600, v234
    v_sub_f32 v203, 3250585600, v234
    v_sub_f32 v204, 3250585600, v235
    v_sub_f32 v205, 3250585600, v235
    v_sub_f32 v206, 3250585600, v235
    v_sub_f32 v207, 3250585600, v235
Lattn_stage0:
    s_mov_b32 s43, 7
    v_mfma_f32_16x16x32_bf16 v[208:211], a[208:211], v[64:67], v[192:195]
    s_lshl_b32 s53, s5, 4
    v_mfma_f32_16x16x32_bf16 v[208:211], a[212:215], v[68:71], v[208:211]
    s_add_u32 s53, s53, s4
    v_mfma_f32_16x16x32_bf16 v[208:211], a[216:219], v[72:75], v[208:211]
    s_lshl_b32 s53, s53, 2
    v_mfma_f32_16x16x32_bf16 v[208:211], a[220:223], v[76:79], v[208:211]
    s_add_u32 s53, s53, s3
    ds_read_b128 a[228:231], v9 offset:4096
    v_mfma_f32_16x16x32_bf16 v[212:215], a[208:211], v[80:83], v[196:199]
    s_mul_i32 s53, s53, 4608
    s_nop 3
    v_exp_f32 v208, v208
    v_mfma_f32_16x16x32_bf16 v[212:215], a[212:215], v[84:87], v[212:215]
    s_add_u32 s53, s53, 2621440
    v_exp_f32 v209, v209
    v_mfma_f32_16x16x32_bf16 v[212:215], a[216:219], v[88:91], v[212:215]
    s_lshr_b32 s44, s2, 5
    v_exp_f32 v210, v210
    v_mfma_f32_16x16x32_bf16 v[212:215], a[220:223], v[92:95], v[212:215]
    s_lshl_b32 s44, s44, 3
    v_exp_f32 v211, v211
    v_cvt_pk_bf16_f32 v128, v208, v209
    ds_read_b128 a[232:235], v10 offset:4096
    v_cvt_pk_bf16_f32 v129, v210, v211
    v_mfma_f32_16x16x32_bf16 v[208:211], a[208:211], v[96:99], v[200:203]
    s_and_b32 s37, s2, 7
    s_nop 0
    v_exp_f32 v212, v212
    v_mfma_f32_16x16x32_bf16 v[208:211], a[212:215], v[100:103], v[208:211]
    s_add_u32 s44, s44, s37
    v_exp_f32 v213, v213
    v_mfma_f32_16x16x32_bf16 v[208:211], a[216:219], v[104:107], v[208:211]
    s_lshl_b32 s44, s44, 2
    v_exp_f32 v214, v214
    v_mfma_f32_16x16x32_bf16 v[208:211], a[220:223], v[108:111], v[208:211]
    s_bfe_u32 s37, s2, 0x20003
    v_exp_f32 v215, v215
    v_cvt_pk_bf16_f32 v136, v212, v213
    ds_read_b128 a[236:239], v11 offset:4096
    v_cvt_pk_bf16_f32 v137, v214, v215
    v_mfma_f32_16x16x32_bf16 v[212:215], a[208:211], v[112:115], v[204:207]
    s_add_u32 s44, s44, s37
    s_nop 0
    v_exp_f32 v208, v208
    v_mfma_f32_16x16x32_bf16 v[212:215], a[212:215], v[116:119], v[212:215]
    s_add_u32 s44, s44, 72
    v_exp_f32 v209, v209
    v_mfma_f32_16x16x32_bf16 v[212:215], a[216:219], v[120:123], v[212:215]
    s_cmp_lt_u32 s44, 216
    s_cselect_b32 s37, 0, 2147483648
    v_exp_f32 v210, v210
    v_mfma_f32_16x16x32_bf16 v[212:215], a[220:223], v[124:127], v[212:215]
    s_lshl_b32 s44, s44, 5
    v_exp_f32 v211, v211
    v_cvt_pk_bf16_f32 v144, v208, v209
    ds_read_b128 a[208:211], v8 offset:8192
    v_cvt_pk_bf16_f32 v145, v210, v211
    v_mfma_f32_16x16x32_bf16 v[208:211], a[224:227], v[64:67], v[192:195]
    s_waitcnt lgkmcnt(3)
    s_or_b32 s44, s44, s37
    v_exp_f32 v212, v212
    v_mfma_f32_16x16x32_bf16 v[208:211], a[228:231], v[68:71], v[208:211]
    s_waitcnt lgkmcnt(2)
    s_mov_b32 s18, 3981312
    v_exp_f32 v213, v213
    v_mfma_f32_16x16x32_bf16 v[208:211], a[232:235], v[72:75], v[208:211]
    s_waitcnt lgkmcnt(1)
    s_lshr_b32 s6, s2, 3
    v_exp_f32 v214, v214
    v_mfma_f32_16x16x32_bf16 v[208:211], a[236:239], v[76:79], v[208:211]
    s_and_b32 s7, s2, 7
    v_exp_f32 v215, v215
    v_cvt_pk_bf16_f32 v152, v212, v213
    ds_read_b128 a[212:215], v9 offset:8192
    v_cvt_pk_bf16_f32 v153, v214, v215
    v_mfma_f32_16x16x32_bf16 v[212:215], a[224:227], v[80:83], v[196:199]
    s_mul_i32 s7, s7, 18
    s_nop 0
    v_exp_f32 v208, v208
    v_mfma_f32_16x16x32_bf16 v[212:215], a[228:231], v[84:87], v[212:215]
    s_add_u32 s7, s7, s6
    v_exp_f32 v209, v209
    v_mfma_f32_16x16x32_bf16 v[212:215], a[232:235], v[88:91], v[212:215]
    s_lshl_b32 s58, s7, 6
    v_exp_f32 v210, v210
    v_mfma_f32_16x16x32_bf16 v[212:215], a[236:239], v[92:95], v[212:215]
    s_mul_i32 s59, s7, 36864
    v_exp_f32 v211, v211
    v_cvt_pk_bf16_f32 v130, v208, v209
    ds_read_b128 a[216:219], v10 offset:8192
    v_cvt_pk_bf16_f32 v131, v210, v211
    v_mfma_f32_16x16x32_bf16 v[208:211], a[224:227], v[96:99], v[200:203]
    s_cmp_lt_u32 s6, 18
    s_cselect_b32 s7, 0, 2147483648
    v_exp_f32 v212, v212
    v_mfma_f32_16x16x32_bf16 v[208:211], a[228:231], v[100:103], v[208:211]
    s_or_b32 s58, s58, s7
    v_exp_f32 v213, v213
    v_mfma_f32_16x16x32_bf16 v[208:211], a[232:235], v[104:107], v[208:211]
    s_or_b32 s59, s59, s7
    v_exp_f32 v214, v214
    v_mfma_f32_16x16x32_bf16 v[208:211], a[236:239], v[108:111], v[208:211]
    s_and_b32 s7, s4, 1
    v_exp_f32 v215, v215
    v_cvt_pk_bf16_f32 v138, v212, v213
    ds_read_b128 a[220:223], v11 offset:8192
    v_cvt_pk_bf16_f32 v139, v214, v215
    s_mov_b32 s39, 221184
    s_mov_b32 s38, 27648
    v_mfma_f32_16x16x32_bf16 v[212:215], a[224:227], v[112:115], v[204:207]
    s_lshl_b32 s6, s7, 7
    v_exp_f32 v208, v208
    v_mfma_f32_16x16x32_bf16 v[212:215], a[228:231], v[116:119], v[212:215]
    s_xor_b32 s36, s4, 1
    v_exp_f32 v209, v209
    v_mfma_f32_16x16x32_bf16 v[212:215], a[232:235], v[120:123], v[212:215]
    s_mul_i32 s36, s36, 294912
    v_exp_f32 v210, v210
    v_mfma_f32_16x16x32_bf16 v[212:215], a[236:239], v[124:127], v[212:215]
    s_waitcnt lgkmcnt(3)
    s_add_u32 s46, s36, s6
    v_exp_f32 v211, v211
    v_cvt_pk_bf16_f32 v146, v208, v209
    ds_read_b128 a[224:227], v8 offset:12288
    v_cvt_pk_bf16_f32 v147, v210, v211
    v_mfma_f32_16x16x32_bf16 v[208:211], a[208:211], v[64:67], v[192:195]
    s_waitcnt lgkmcnt(3)
    s_lshl_b32 s36, s4, 8
    v_exp_f32 v212, v212
    v_mfma_f32_16x16x32_bf16 v[208:211], a[212:215], v[68:71], v[208:211]
    s_waitcnt lgkmcnt(2)
    s_add_u32 s56, s47, s36
    v_exp_f32 v213, v213
    v_mfma_f32_16x16x32_bf16 v[208:211], a[216:219], v[72:75], v[208:211]
    s_waitcnt lgkmcnt(1)
    s_lshr_b32 s36, s4, 1
    v_exp_f32 v214, v214
    v_mfma_f32_16x16x32_bf16 v[208:211], a[220:223], v[76:79], v[208:211]
    s_lshl_b32 s36, s36, 11
    v_exp_f32 v215, v215
    v_cvt_pk_bf16_f32 v154, v212, v213
    ds_read_b128 a[228:231], v9 offset:12288
    v_cvt_pk_bf16_f32 v155, v214, v215
    v_mfma_f32_16x16x32_bf16 v[212:215], a[208:211], v[80:83], v[196:199]
    s_lshl_b32 s7, s7, 8
    s_nop 0
    v_exp_f32 v208, v208
    v_mfma_f32_16x16x32_bf16 v[212:215], a[212:215], v[84:87], v[212:215]
    s_add_u32 s36, s36, s7
    v_exp_f32 v209, v209
    v_mfma_f32_16x16x32_bf16 v[212:215], a[216:219], v[88:91], v[212:215]
    s_add_u32 s93, s47, s36
    v_exp_f32 v210, v210
    v_mfma_f32_16x16x32_bf16 v[212:215], a[220:223], v[92:95], v[212:215]
    s_lshr_b32 s36, s4, 1
    v_exp_f32 v211, v211
    v_cvt_pk_bf16_f32 v132, v208, v209
    ds_read_b128 a[232:235], v10 offset:12288
    v_cvt_pk_bf16_f32 v133, v210, v211
    v_mfma_f32_16x16x32_bf16 v[208:211], a[208:211], v[96:99], v[200:203]
    s_lshl_b32 s36, s36, 4
    s_nop 0
    v_exp_f32 v212, v212
    v_mfma_f32_16x16x32_bf16 v[208:211], a[212:215], v[100:103], v[208:211]
    s_add_u32 s36, s36, s5
    v_exp_f32 v213, v213
    v_mfma_f32_16x16x32_bf16 v[208:211], a[216:219], v[104:107], v[208:211]
    s_lshl_b32 s36, s36, 9
    v_exp_f32 v214, v214
    v_mfma_f32_16x16x32_bf16 v[208:211], a[220:223], v[108:111], v[208:211]
    s_add_u32 s36, s36, s7
    v_exp_f32 v215, v215
    v_cvt_pk_bf16_f32 v140, v212, v213
    ds_read_b128 a[236:239], v11 offset:12288
    v_cvt_pk_bf16_f32 v141, v214, v215
    s_waitcnt vmcnt(4)
    s_barrier
    v_mfma_f32_16x16x32_bf16 v[212:215], a[208:211], v[112:115], v[204:207]
    s_lshl_b32 s36, s36, 8
    v_exp_f32 v208, v208
    v_mfma_f32_16x16x32_bf16 v[212:215], a[212:215], v[116:119], v[212:215]
    s_add_u32 m0, s42, 49152
    s_add_u32 s55, s36, 20971520
    v_exp_f32 v209, v209
    v_mfma_f32_16x16x32_bf16 v[212:215], a[216:219], v[120:123], v[212:215]
    s_add_u32 s7, s45, s6
    v_exp_f32 v210, v210
    v_mfma_f32_16x16x32_bf16 v[212:215], a[220:223], v[124:127], v[212:215]
    s_waitcnt lgkmcnt(3)
    s_xor_b32 s54, s92, 128
    v_exp_f32 v211, v211
    v_cvt_pk_bf16_f32 v148, v208, v209
    ds_read_b128 a[208:211], v8 offset:16384
    v_cvt_pk_bf16_f32 v149, v210, v211
    buffer_load_dwordx4 v36, s[8:11], s40 offen lds
    v_mfma_f32_16x16x32_bf16 v[208:211], a[224:227], v[64:67], v[192:195]
    s_waitcnt lgkmcnt(3)
    s_lshl_b32 s36, s3, 14
    v_exp_f32 v212, v212
    v_mfma_f32_16x16x32_bf16 v[208:211], a[228:231], v[68:71], v[208:211]
    s_waitcnt lgkmcnt(2)
    v_exp_f32 v213, v213
    v_mfma_f32_16x16x32_bf16 v[208:211], a[232:235], v[72:75], v[208:211]
    s_waitcnt lgkmcnt(1)
    v_exp_f32 v214, v214
    v_mfma_f32_16x16x32_bf16 v[208:211], a[236:239], v[76:79], v[208:211]
    v_exp_f32 v215, v215
    v_cvt_pk_bf16_f32 v156, v212, v213
    ds_read_b128 a[212:215], v9 offset:16384
    v_cvt_pk_bf16_f32 v157, v214, v215
    v_mfma_f32_16x16x32_bf16 v[212:215], a[224:227], v[80:83], v[196:199]
    s_nop 2
    v_exp_f32 v208, v208
    v_mfma_f32_16x16x32_bf16 v[212:215], a[228:231], v[84:87], v[212:215]
    v_exp_f32 v209, v209
    v_mfma_f32_16x16x32_bf16 v[212:215], a[232:235], v[88:91], v[212:215]
    v_exp_f32 v210, v210
    v_mfma_f32_16x16x32_bf16 v[212:215], a[236:239], v[92:95], v[212:215]
    v_exp_f32 v211, v211
    ds_read_b64_tr_b16 a[160:161], v20 offset:0
    v_cvt_pk_bf16_f32 v134, v208, v209
    v_lshrrev_b32 v51, 2, v0
    v_mul_u32_u24 v51, 9216, v51
    v_and_b32 v254, 3, v0
    v_lshl_add_u32 v254, v254, 4, v51
    v_lshlrev_b32 v255, 4, v0
    v_add_u32 v51, 98304, v255
    v_lshl_add_u32 v252, v1, 4, s36
    v_mov_b32 v224, 0
    v_mov_b32 v225, 0
    v_mov_b32 v226, 0
    v_mov_b32 v227, 0
    v_mov_b32 v228, 0
    v_mov_b32 v229, 0
    v_mov_b32 v230, 0
    v_mov_b32 v231, 0
    v_mov_b32 v248, -1
    v_mov_b32 v249, -1
    v_mov_b32 v250, -1
    v_mov_b32 v251, -1
    v_min_u32 v232, 41, v1
    v_lshlrev_b32 v232, 4, v232
    s_mov_b32 s57, s58
    s_lshl_b32 s6, s3, 10
    s_add_u32 s6, s6, 135168
    s_lshr_b32 s37, s2, 3
    s_mul_i32 s37, s37, -129024
    s_add_u32 s37, s37, 4128768
    ds_read_b64_tr_b16 a[162:163], v20 offset:4096
    ds_read_b128 a[216:219], v10 offset:16384
    v_cvt_pk_bf16_f32 v135, v210, v211
    buffer_load_dwordx4 v37, s[8:11], s40 offen offset:1024 lds
    v_mfma_f32_16x16x32_bf16 v[208:211], a[224:227], v[96:99], v[200:203]
    v_exp_f32 v212, v212
    v_mfma_f32_16x16x32_bf16 v[208:211], a[228:231], v[100:103], v[208:211]
    v_exp_f32 v213, v213
    v_mfma_f32_16x16x32_bf16 v[208:211], a[232:235], v[104:107], v[208:211]
    v_exp_f32 v214, v214
    v_mfma_f32_16x16x32_bf16 v[208:211], a[236:239], v[108:111], v[208:211]
    s_mov_b32 s52, s55
    v_exp_f32 v215, v215
    ds_read_b64_tr_b16 a[164:165], v20 offset:8192
    v_cvt_pk_bf16_f32 v142, v212, v213
    ds_read_b64_tr_b16 a[166:167], v20 offset:12288
    v_min_u32 v237, 19, v1
    v_lshl_add_u32 v237, v237, 7, s36
    v_lshl_add_u32 v238, v1, 7, s36
    ds_read_b128 a[220:223], v11 offset:16384
    v_cvt_pk_bf16_f32 v143, v214, v215
    buffer_load_dword v217, v57, s[32:35], s37 offen
    v_mfma_f32_16x16x32_bf16 v[212:215], a[224:227], v[112:115], v[204:207]
    v_exp_f32 v208, v208
    v_mfma_f32_16x16x32_bf16 v[212:215], a[228:231], v[116:119], v[212:215]
    v_exp_f32 v209, v209
    v_mfma_f32_16x16x32_bf16 v[212:215], a[232:235], v[120:123], v[212:215]
    s_mul_i32 s37, s5, 18432
    v_exp_f32 v210, v210
    v_mfma_f32_16x16x32_bf16 v[212:215], a[236:239], v[124:127], v[212:215]
    s_add_u32 s37, s37, s45
    v_exp_f32 v211, v211
    ds_read_b64_tr_b16 a[168:169], v21 offset:0
    v_cvt_pk_bf16_f32 v150, v208, v209
    ds_read_b64_tr_b16 a[170:171], v21 offset:4096
    v_min_u32 v236, 143, v0
    v_lshl_add_u32 v236, v236, 7, s37
    v_mul_u32_u24 v235, 24, v0
    v_lshrrev_b32 v235, 8, v235
    v_lshl_add_u32 v235, v235, 7, s37
    ds_read_b128 a[224:227], v8 offset:20480
    v_cvt_pk_bf16_f32 v151, v210, v211
    s_waitcnt lgkmcnt(3)
    buffer_load_dwordx4 v38, s[8:11], s40 offen offset:2048 lds
    s_nop 0
    s_nop 0
    s_nop 0
    s_nop 0
    s_nop 0
Lattn_loop:
    v_mfma_f32_16x16x32_bf16 v[208:211], a[208:211], v[64:67], v[192:195]
    v_exp_f32 v212, v212
    v_mfma_f32_16x16x32_bf16 v[208:211], a[212:215], v[68:71], v[208:211]
    v_exp_f32 v213, v213
    v_mfma_f32_16x16x32_bf16 v[208:211], a[216:219], v[72:75], v[208:211]
    v_exp_f32 v214, v214
    v_mfma_f32_16x16x32_bf16 v[208:211], a[220:223], v[76:79], v[208:211]
    v_exp_f32 v215, v215
    v_mfma_f32_16x16x32_bf16 a[0:3], a[160:163], v[128:131], a[0:3]
    ds_read_b64_tr_b16 a[172:173], v21 offset:8192
    v_cvt_pk_bf16_f32 v158, v212, v213
    v_mfma_f32_16x16x32_bf16 a[0:3], a[164:167], v[132:135], a[0:3]
    ds_read_b64_tr_b16 a[174:175], v21 offset:12288
    v_mfma_f32_16x16x32_bf16 a[4:7], a[160:163], v[136:139], a[4:7]
    ds_read_b128 a[228:231], v9 offset:20480
    v_cvt_pk_bf16_f32 v159, v214, v215
    v_mfma_f32_16x16x32_bf16 a[4:7], a[164:167], v[140:143], a[4:7]
    v_mfma_f32_16x16x32_bf16 v[212:215], a[208:211], v[80:83], v[196:199]
    v_exp_f32 v208, v208
    v_mfma_f32_16x16x32_bf16 v[212:215], a[212:215], v[84:87], v[212:215]
    v_exp_f32 v209, v209
    v_mfma_f32_16x16x32_bf16 v[212:215], a[216:219], v[88:91], v[212:215]
    v_exp_f32 v210, v210
    v_mfma_f32_16x16x32_bf16 v[212:215], a[220:223], v[92:95], v[212:215]
    v_exp_f32 v211, v211
    v_mfma_f32_16x16x32_bf16 a[8:11], a[160:163], v[144:147], a[8:11]
    ds_read_b64_tr_b16 a[176:177], v22 offset:0
    v_cvt_pk_bf16_f32 v160, v208, v209
    v_mfma_f32_16x16x32_bf16 a[8:11], a[164:167], v[148:151], a[8:11]
    ds_read_b64_tr_b16 a[178:179], v22 offset:4096
    v_mfma_f32_16x16x32_bf16 a[12:15], a[160:163], v[152:155], a[12:15]
    ds_read_b128 a[232:235], v10 offset:20480
    v_cvt_pk_bf16_f32 v161, v210, v211
    v_mfma_f32_16x16x32_bf16 a[12:15], a[164:167], v[156:159], a[12:15]
    s_waitcnt lgkmcnt(3)
    buffer_load_dwordx4 v39, s[8:11], s40 offen offset:3072 lds
    v_mfma_f32_16x16x32_bf16 v[208:211], a[208:211], v[96:99], v[200:203]
    v_exp_f32 v212, v212
    v_mfma_f32_16x16x32_bf16 v[208:211], a[212:215], v[100:103], v[208:211]
    s_add_u32 s40, s40, 16384
    v_exp_f32 v213, v213
    v_mfma_f32_16x16x32_bf16 v[208:211], a[216:219], v[104:107], v[208:211]
    s_mov_b32 m0, s6
    v_exp_f32 v214, v214
    v_mfma_f32_16x16x32_bf16 v[208:211], a[220:223], v[108:111], v[208:211]
    v_exp_f32 v215, v215
    v_mfma_f32_16x16x32_bf16 a[16:19], a[168:171], v[128:131], a[16:19]
    ds_read_b64_tr_b16 a[180:181], v22 offset:8192
    v_cvt_pk_bf16_f32 v168, v212, v213
    v_mfma_f32_16x16x32_bf16 a[16:19], a[172:175], v[132:135], a[16:19]
    ds_read_b64_tr_b16 a[182:183], v22 offset:12288
    v_mfma_f32_16x16x32_bf16 a[20:23], a[168:171], v[136:139], a[20:23]
    ds_read_b128 a[236:239], v11 offset:20480
    v_cvt_pk_bf16_f32 v169, v214, v215
    v_mfma_f32_16x16x32_bf16 a[20:23], a[172:175], v[140:143], a[20:23]
    buffer_load_dwordx4 v254, s[32:35], s57 offen  lds
    v_smfmac_f32_16x16x64_bf16 a[192:195], v[52:55], v[128:135], v50
    v_mfma_f32_16x16x32_bf16 v[212:215], a[208:211], v[112:115], v[204:207]
    v_exp_f32 v208, v208
    v_mfma_f32_16x16x32_bf16 v[212:215], a[212:215], v[116:119], v[212:215]
    s_add_u32 m0, s42, 98304
    v_exp_f32 v209, v209
    v_mfma_f32_16x16x32_bf16 v[212:215], a[216:219], v[120:123], v[212:215]
    v_exp_f32 v210, v210
    v_mfma_f32_16x16x32_bf16 v[212:215], a[220:223], v[124:127], v[212:215]
    v_exp_f32 v211, v211
    v_mfma_f32_16x16x32_bf16 a[24:27], a[168:171], v[144:147], a[24:27]
    ds_read_b64_tr_b16 a[184:185], v23 offset:0
    v_cvt_pk_bf16_f32 v176, v208, v209
    v_mfma_f32_16x16x32_bf16 a[24:27], a[172:175], v[148:151], a[24:27]
    ds_read_b64_tr_b16 a[186:187], v23 offset:4096
    v_mfma_f32_16x16x32_bf16 a[28:31], a[168:171], v[152:155], a[28:31]
    ds_read_b128 a[208:211], v8 offset:24576
    v_cvt_pk_bf16_f32 v177, v210, v211
    v_mfma_f32_16x16x32_bf16 a[28:31], a[172:175], v[156:159], a[28:31]
    s_waitcnt lgkmcnt(3)
    buffer_load_dwordx4 v40, s[12:15], s41 offen lds
    v_mfma_f32_16x16x32_bf16 v[208:211], a[224:227], v[64:67], v[192:195]
    v_exp_f32 v212, v212
    v_mfma_f32_16x16x32_bf16 v[208:211], a[228:231], v[68:71], v[208:211]
    s_add_u32 s6, s6, 4096
    v_exp_f32 v213, v213
    v_mfma_f32_16x16x32_bf16 v[208:211], a[232:235], v[72:75], v[208:211]
    s_add_u32 s57, s57, 589824
    v_exp_f32 v214, v214
    v_mfma_f32_16x16x32_bf16 v[208:211], a[236:239], v[76:79], v[208:211]
    v_exp_f32 v215, v215
    v_mfma_f32_16x16x32_bf16 a[32:35], a[176:179], v[128:131], a[32:35]
    ds_read_b64_tr_b16 a[188:189], v23 offset:8192
    v_cvt_pk_bf16_f32 v184, v212, v213
    v_mfma_f32_16x16x32_bf16 a[32:35], a[180:183], v[132:135], a[32:35]
    ds_read_b64_tr_b16 a[190:191], v23 offset:12288
    v_mfma_f32_16x16x32_bf16 a[36:39], a[176:179], v[136:139], a[36:39]
    ds_read_b128 a[212:215], v9 offset:24576
    v_cvt_pk_bf16_f32 v185, v214, v215
    v_mfma_f32_16x16x32_bf16 a[36:39], a[180:183], v[140:143], a[36:39]
    v_smfmac_f32_16x16x64_bf16 a[196:199], v[52:55], v[136:143], v50
    v_mfma_f32_16x16x32_bf16 v[212:215], a[224:227], v[80:83], v[196:199]
    v_exp_f32 v208, v208
    v_mfma_f32_16x16x32_bf16 v[212:215], a[228:231], v[84:87], v[212:215]
    v_exp_f32 v209, v209
    v_mfma_f32_16x16x32_bf16 v[212:215], a[232:235], v[88:91], v[212:215]
    v_exp_f32 v210, v210
    v_mfma_f32_16x16x32_bf16 v[212:215], a[236:239], v[92:95], v[212:215]
    v_exp_f32 v211, v211
    v_mfma_f32_16x16x32_bf16 a[40:43], a[176:179], v[144:147], a[40:43]
    ds_read_b64_tr_b16 a[160:161], v24 offset:0
    v_cvt_pk_bf16_f32 v162, v208, v209
    v_mfma_f32_16x16x32_bf16 a[40:43], a[180:183], v[148:151], a[40:43]
    ds_read_b64_tr_b16 a[162:163], v24 offset:4096
    v_mfma_f32_16x16x32_bf16 a[44:47], a[176:179], v[152:155], a[44:47]
    ds_read_b128 a[216:219], v10 offset:24576
    v_cvt_pk_bf16_f32 v163, v210, v211
    v_mfma_f32_16x16x32_bf16 a[44:47], a[180:183], v[156:159], a[44:47]
    s_waitcnt lgkmcnt(3)
    buffer_load_dwordx4 v41, s[12:15], s41 offen offset:1024 lds
    v_mfma_f32_16x16x32_bf16 v[208:211], a[224:227], v[96:99], v[200:203]
    v_exp_f32 v212, v212
    v_mfma_f32_16x16x32_bf16 v[208:211], a[228:231], v[100:103], v[208:211]
    v_exp_f32 v213, v213
    v_mfma_f32_16x16x32_bf16 v[208:211], a[232:235], v[104:107], v[208:211]
    v_exp_f32 v214, v214
    v_mfma_f32_16x16x32_bf16 v[208:211], a[236:239], v[108:111], v[208:211]
    v_exp_f32 v215, v215
    v_mfma_f32_16x16x32_bf16 a[48:51], a[184:187], v[128:131], a[48:51]
    ds_read_b64_tr_b16 a[164:165], v24 offset:8192
    v_cvt_pk_bf16_f32 v170, v212, v213
    v_mfma_f32_16x16x32_bf16 a[48:51], a[188:191], v[132:135], a[48:51]
    ds_read_b64_tr_b16 a[166:167], v24 offset:12288
    v_mfma_f32_16x16x32_bf16 a[52:55], a[184:187], v[136:139], a[52:55]
    ds_read_b128 a[220:223], v11 offset:24576
    v_cvt_pk_bf16_f32 v171, v214, v215
    v_mfma_f32_16x16x32_bf16 a[52:55], a[188:191], v[140:143], a[52:55]
    v_smfmac_f32_16x16x64_bf16 a[200:203], v[52:55], v[144:151], v50
    v_mfma_f32_16x16x32_bf16 v[212:215], a[224:227], v[112:115], v[204:207]
    v_exp_f32 v208, v208
    v_mfma_f32_16x16x32_bf16 v[212:215], a[228:231], v[116:119], v[212:215]
    v_exp_f32 v209, v209
    v_mfma_f32_16x16x32_bf16 v[212:215], a[232:235], v[120:123], v[212:215]
    v_exp_f32 v210, v210
    v_mfma_f32_16x16x32_bf16 v[212:215], a[236:239], v[124:127], v[212:215]
    v_exp_f32 v211, v211
    v_mfma_f32_16x16x32_bf16 a[56:59], a[184:187], v[144:147], a[56:59]
    ds_read_b64_tr_b16 a[168:169], v25 offset:0
    v_cvt_pk_bf16_f32 v178, v208, v209
    v_mfma_f32_16x16x32_bf16 a[56:59], a[188:191], v[148:151], a[56:59]
    ds_read_b64_tr_b16 a[170:171], v25 offset:4096
    v_mfma_f32_16x16x32_bf16 a[60:63], a[184:187], v[152:155], a[60:63]
    ds_read_b128 a[224:227], v8 offset:28672
    v_cvt_pk_bf16_f32 v179, v210, v211
    v_mfma_f32_16x16x32_bf16 a[60:63], a[188:191], v[156:159], a[60:63]
    s_waitcnt lgkmcnt(3)
    buffer_load_dwordx4 v40, s[12:15], s41 offen offset:2048 lds
    v_mfma_f32_16x16x32_bf16 v[208:211], a[208:211], v[64:67], v[192:195]
    v_exp_f32 v212, v212
    v_mfma_f32_16x16x32_bf16 v[208:211], a[212:215], v[68:71], v[208:211]
    v_exp_f32 v213, v213
    v_mfma_f32_16x16x32_bf16 v[208:211], a[216:219], v[72:75], v[208:211]
    v_exp_f32 v214, v214
    v_mfma_f32_16x16x32_bf16 v[208:211], a[220:223], v[76:79], v[208:211]
    v_exp_f32 v215, v215
    v_mfma_f32_16x16x32_bf16 a[64:67], a[160:163], v[128:131], a[64:67]
    ds_read_b64_tr_b16 a[172:173], v25 offset:8192
    v_cvt_pk_bf16_f32 v186, v212, v213
    v_mfma_f32_16x16x32_bf16 a[64:67], a[164:167], v[132:135], a[64:67]
    ds_read_b64_tr_b16 a[174:175], v25 offset:12288
    v_mfma_f32_16x16x32_bf16 a[68:71], a[160:163], v[136:139], a[68:71]
    ds_read_b128 a[228:231], v9 offset:28672
    v_cvt_pk_bf16_f32 v187, v214, v215
    v_mfma_f32_16x16x32_bf16 a[68:71], a[164:167], v[140:143], a[68:71]
    v_smfmac_f32_16x16x64_bf16 a[204:207], v[52:55], v[152:159], v50
    v_mfma_f32_16x16x32_bf16 v[212:215], a[208:211], v[80:83], v[196:199]
    v_exp_f32 v208, v208
    v_mfma_f32_16x16x32_bf16 v[212:215], a[212:215], v[84:87], v[212:215]
    v_exp_f32 v209, v209
    v_mfma_f32_16x16x32_bf16 v[212:215], a[216:219], v[88:91], v[212:215]
    v_exp_f32 v210, v210
    v_mfma_f32_16x16x32_bf16 v[212:215], a[220:223], v[92:95], v[212:215]
    v_exp_f32 v211, v211
    v_mfma_f32_16x16x32_bf16 a[72:75], a[160:163], v[144:147], a[72:75]
    ds_read_b64_tr_b16 a[176:177], v26 offset:0
    v_cvt_pk_bf16_f32 v164, v208, v209
    v_mfma_f32_16x16x32_bf16 a[72:75], a[164:167], v[148:151], a[72:75]
    ds_read_b64_tr_b16 a[178:179], v26 offset:4096
    v_mfma_f32_16x16x32_bf16 a[76:79], a[160:163], v[152:155], a[76:79]
    ds_read_b128 a[232:235], v10 offset:28672
    v_cvt_pk_bf16_f32 v165, v210, v211
    v_mfma_f32_16x16x32_bf16 a[76:79], a[164:167], v[156:159], a[76:79]
    s_waitcnt lgkmcnt(3)
    buffer_load_dwordx4 v41, s[12:15], s41 offen offset:3072 lds
    v_mfma_f32_16x16x32_bf16 v[208:211], a[208:211], v[96:99], v[200:203]
    v_exp_f32 v212, v212
    v_mfma_f32_16x16x32_bf16 v[208:211], a[212:215], v[100:103], v[208:211]
    s_add_u32 s41, s41, 16384
    v_exp_f32 v213, v213
    v_mfma_f32_16x16x32_bf16 v[208:211], a[216:219], v[104:107], v[208:211]
    v_exp_f32 v214, v214
    v_mfma_f32_16x16x32_bf16 v[208:211], a[220:223], v[108:111], v[208:211]
    v_exp_f32 v215, v215
    v_mfma_f32_16x16x32_bf16 a[80:83], a[168:171], v[128:131], a[80:83]
    ds_read_b64_tr_b16 a[180:181], v26 offset:8192
    v_cvt_pk_bf16_f32 v172, v212, v213
    v_mfma_f32_16x16x32_bf16 a[80:83], a[172:175], v[132:135], a[80:83]
    ds_read_b64_tr_b16 a[182:183], v26 offset:12288
    v_mfma_f32_16x16x32_bf16 a[84:87], a[168:171], v[136:139], a[84:87]
    ds_read_b128 a[236:239], v11 offset:28672
    v_cvt_pk_bf16_f32 v173, v214, v215
    v_mfma_f32_16x16x32_bf16 a[84:87], a[172:175], v[140:143], a[84:87]
    s_waitcnt vmcnt(10)
    s_barrier
    v_mfma_f32_16x16x32_bf16 v[212:215], a[208:211], v[112:115], v[204:207]
    v_exp_f32 v208, v208
    v_mfma_f32_16x16x32_bf16 v[212:215], a[212:215], v[116:119], v[212:215]
    s_add_u32 m0, s42, 0
    v_exp_f32 v209, v209
    v_mfma_f32_16x16x32_bf16 v[212:215], a[216:219], v[120:123], v[212:215]
    v_exp_f32 v210, v210
    v_mfma_f32_16x16x32_bf16 v[212:215], a[220:223], v[124:127], v[212:215]
    v_exp_f32 v211, v211
    v_mfma_f32_16x16x32_bf16 a[88:91], a[168:171], v[144:147], a[88:91]
    ds_read_b64_tr_b16 a[184:185], v27 offset:0
    v_cvt_pk_bf16_f32 v180, v208, v209
    v_mfma_f32_16x16x32_bf16 a[88:91], a[172:175], v[148:151], a[88:91]
    ds_read_b64_tr_b16 a[186:187], v27 offset:4096
    v_mfma_f32_16x16x32_bf16 a[92:95], a[168:171], v[152:155], a[92:95]
    ds_read_b128 a[208:211], v8 offset:32768
    v_cvt_pk_bf16_f32 v181, v210, v211
    v_mfma_f32_16x16x32_bf16 a[92:95], a[172:175], v[156:159], a[92:95]
    s_waitcnt lgkmcnt(3)
    buffer_load_dwordx4 v36, s[8:11], s40 offen lds
    v_mfma_f32_16x16x32_bf16 v[208:211], a[224:227], v[64:67], v[192:195]
    v_exp_f32 v212, v212
    v_mfma_f32_16x16x32_bf16 v[208:211], a[228:231], v[68:71], v[208:211]
    v_exp_f32 v213, v213
    v_mfma_f32_16x16x32_bf16 v[208:211], a[232:235], v[72:75], v[208:211]
    v_exp_f32 v214, v214
    v_mfma_f32_16x16x32_bf16 v[208:211], a[236:239], v[76:79], v[208:211]
    v_exp_f32 v215, v215
    v_mfma_f32_16x16x32_bf16 a[96:99], a[176:179], v[128:131], a[96:99]
    ds_read_b64_tr_b16 a[188:189], v27 offset:8192
    v_cvt_pk_bf16_f32 v188, v212, v213
    v_mfma_f32_16x16x32_bf16 a[96:99], a[180:183], v[132:135], a[96:99]
    ds_read_b64_tr_b16 a[190:191], v27 offset:12288
    v_mfma_f32_16x16x32_bf16 a[100:103], a[176:179], v[136:139], a[100:103]
    ds_read_b128 a[212:215], v9 offset:32768
    v_cvt_pk_bf16_f32 v189, v214, v215
    v_mfma_f32_16x16x32_bf16 a[100:103], a[180:183], v[140:143], a[100:103]
    v_mfma_f32_16x16x32_bf16 v[212:215], a[224:227], v[80:83], v[196:199]
    v_exp_f32 v208, v208
    v_mfma_f32_16x16x32_bf16 v[212:215], a[228:231], v[84:87], v[212:215]
    v_exp_f32 v209, v209
    v_mfma_f32_16x16x32_bf16 v[212:215], a[232:235], v[88:91], v[212:215]
    v_exp_f32 v210, v210
    v_mfma_f32_16x16x32_bf16 v[212:215], a[236:239], v[92:95], v[212:215]
    v_exp_f32 v211, v211
    v_mfma_f32_16x16x32_bf16 a[104:107], a[176:179], v[144:147], a[104:107]
    ds_read_b64_tr_b16 a[160:161], v20 offset:16384
    v_cvt_pk_bf16_f32 v166, v208, v209
    v_mfma_f32_16x16x32_bf16 a[104:107], a[180:183], v[148:151], a[104:107]
    ds_read_b64_tr_b16 a[162:163], v20 offset:20480
    v_mfma_f32_16x16x32_bf16 a[108:111], a[176:179], v[152:155], a[108:111]
    ds_read_b128 a[216:219], v10 offset:32768
    v_cvt_pk_bf16_f32 v167, v210, v211
    v_mfma_f32_16x16x32_bf16 a[108:111], a[180:183], v[156:159], a[108:111]
    s_waitcnt lgkmcnt(3)
    buffer_load_dwordx4 v37, s[8:11], s40 offen offset:1024 lds
    v_mfma_f32_16x16x32_bf16 v[208:211], a[224:227], v[96:99], v[200:203]
    v_exp_f32 v212, v212
    v_mfma_f32_16x16x32_bf16 v[208:211], a[228:231], v[100:103], v[208:211]
    v_exp_f32 v213, v213
    v_mfma_f32_16x16x32_bf16 v[208:211], a[232:235], v[104:107], v[208:211]
    v_exp_f32 v214, v214
    v_mfma_f32_16x16x32_bf16 v[208:211], a[236:239], v[108:111], v[208:211]
    v_exp_f32 v215, v215
    v_mfma_f32_16x16x32_bf16 a[112:115], a[184:187], v[128:131], a[112:115]
    ds_read_b64_tr_b16 a[164:165], v20 offset:24576
    v_cvt_pk_bf16_f32 v174, v212, v213
    v_mfma_f32_16x16x32_bf16 a[112:115], a[188:191], v[132:135], a[112:115]
    ds_read_b64_tr_b16 a[166:167], v20 offset:28672
    v_mfma_f32_16x16x32_bf16 a[116:119], a[184:187], v[136:139], a[116:119]
    ds_read_b128 a[220:223], v11 offset:32768
    v_cvt_pk_bf16_f32 v175, v214, v215
    v_mfma_f32_16x16x32_bf16 a[116:119], a[188:191], v[140:143], a[116:119]
    buffer_load_dwordx4 v[240:243], v7, s[16:19], s44 offen
    v_mfma_f32_16x16x32_bf16 v[212:215], a[224:227], v[112:115], v[204:207]
    v_exp_f32 v208, v208
    v_mfma_f32_16x16x32_bf16 v[212:215], a[228:231], v[116:119], v[212:215]
    v_exp_f32 v209, v209
    v_mfma_f32_16x16x32_bf16 v[212:215], a[232:235], v[120:123], v[212:215]
    v_exp_f32 v210, v210
    v_mfma_f32_16x16x32_bf16 v[212:215], a[236:239], v[124:127], v[212:215]
    s_add_u32 s44, s44, 884736
    v_exp_f32 v211, v211
    v_mfma_f32_16x16x32_bf16 a[120:123], a[184:187], v[144:147], a[120:123]
    ds_read_b64_tr_b16 a[168:169], v21 offset:16384
    v_cvt_pk_bf16_f32 v182, v208, v209
    v_mfma_f32_16x16x32_bf16 a[120:123], a[188:191], v[148:151], a[120:123]
    ds_read_b64_tr_b16 a[170:171], v21 offset:20480
    v_mfma_f32_16x16x32_bf16 a[124:127], a[184:187], v[152:155], a[124:127]
    ds_read_b128 a[224:227], v8 offset:36864
    v_cvt_pk_bf16_f32 v183, v210, v211
    v_mfma_f32_16x16x32_bf16 a[124:127], a[188:191], v[156:159], a[124:127]
    s_waitcnt lgkmcnt(3)
    buffer_load_dwordx4 v38, s[8:11], s40 offen offset:2048 lds
    v_mfma_f32_16x16x32_bf16 v[208:211], a[208:211], v[64:67], v[192:195]
Ltour4:
    s_cbranch_execz Ltour8
    v_exp_f32 v212, v212
    v_mfma_f32_16x16x32_bf16 v[208:211], a[212:215], v[68:71], v[208:211]
    v_exp_f32 v213, v213
    v_mfma_f32_16x16x32_bf16 v[208:211], a[216:219], v[72:75], v[208:211]
    v_exp_f32 v214, v214
    v_mfma_f32_16x16x32_bf16 v[208:211], a[220:223], v[76:79], v[208:211]
    v_exp_f32 v215, v215
    v_mfma_f32_16x16x32_bf16 a[0:3], a[160:163], v[160:163], a[0:3]
    ds_read_b64_tr_b16 a[172:173], v21 offset:24576
    v_cvt_pk_bf16_f32 v190, v212, v213
    v_mfma_f32_16x16x32_bf16 a[0:3], a[164:167], v[164:167], a[0:3]
    ds_read_b64_tr_b16 a[174:175], v21 offset:28672
    v_mfma_f32_16x16x32_bf16 a[4:7], a[160:163], v[168:171], a[4:7]
    ds_read_b128 a[228:231], v9 offset:36864
    v_cvt_pk_bf16_f32 v191, v214, v215
    v_mfma_f32_16x16x32_bf16 a[4:7], a[164:167], v[172:175], a[4:7]
    v_mfma_f32_16x16x32_bf16 v[212:215], a[208:211], v[80:83], v[196:199]
    v_exp_f32 v208, v208
    v_mfma_f32_16x16x32_bf16 v[212:215], a[212:215], v[84:87], v[212:215]
    v_exp_f32 v209, v209
    v_mfma_f32_16x16x32_bf16 v[212:215], a[216:219], v[88:91], v[212:215]
    v_exp_f32 v210, v210
    v_mfma_f32_16x16x32_bf16 v[212:215], a[220:223], v[92:95], v[212:215]
    v_exp_f32 v211, v211
    v_mfma_f32_16x16x32_bf16 a[8:11], a[160:163], v[176:179], a[8:11]
    ds_read_b64_tr_b16 a[176:177], v22 offset:16384
    v_cvt_pk_bf16_f32 v128, v208, v209
    v_mfma_f32_16x16x32_bf16 a[8:11], a[164:167], v[180:183], a[8:11]
    ds_read_b64_tr_b16 a[178:179], v22 offset:20480
    v_mfma_f32_16x16x32_bf16 a[12:15], a[160:163], v[184:187], a[12:15]
    ds_read_b128 a[232:235], v10 offset:36864
    v_cvt_pk_bf16_f32 v129, v210, v211
    v_mfma_f32_16x16x32_bf16 a[12:15], a[164:167], v[188:191], a[12:15]
    s_waitcnt lgkmcnt(3)
    buffer_load_dwordx4 v39, s[8:11], s40 offen offset:3072 lds
    v_mfma_f32_16x16x32_bf16 v[208:211], a[208:211], v[96:99], v[200:203]
    v_exp_f32 v212, v212
    v_mfma_f32_16x16x32_bf16 v[208:211], a[212:215], v[100:103], v[208:211]
    s_add_u32 s40, s40, 16384
    v_exp_f32 v213, v213
    v_mfma_f32_16x16x32_bf16 v[208:211], a[216:219], v[104:107], v[208:211]
    v_exp_f32 v214, v214
    v_mfma_f32_16x16x32_bf16 v[208:211], a[220:223], v[108:111], v[208:211]
    v_exp_f32 v215, v215
    v_mfma_f32_16x16x32_bf16 a[16:19], a[168:171], v[160:163], a[16:19]
    ds_read_b64_tr_b16 a[180:181], v22 offset:24576
    v_cvt_pk_bf16_f32 v136, v212, v213
    v_mfma_f32_16x16x32_bf16 a[16:19], a[172:175], v[164:167], a[16:19]
    ds_read_b64_tr_b16 a[182:183], v22 offset:28672
    v_mfma_f32_16x16x32_bf16 a[20:23], a[168:171], v[168:171], a[20:23]
    ds_read_b128 a[236:239], v11 offset:36864
    v_cvt_pk_bf16_f32 v137, v214, v215
    v_mfma_f32_16x16x32_bf16 a[20:23], a[172:175], v[172:175], a[20:23]
    v_smfmac_f32_16x16x64_bf16 a[192:195], v[52:55], v[160:167], v50
    v_mfma_f32_16x16x32_bf16 v[212:215], a[208:211], v[112:115], v[204:207]
    v_exp_f32 v208, v208
    v_mfma_f32_16x16x32_bf16 v[212:215], a[212:215], v[116:119], v[212:215]
    s_add_u32 m0, s42, 114688
    v_exp_f32 v209, v209
    v_mfma_f32_16x16x32_bf16 v[212:215], a[216:219], v[120:123], v[212:215]
    v_exp_f32 v210, v210
    v_mfma_f32_16x16x32_bf16 v[212:215], a[220:223], v[124:127], v[212:215]
    v_exp_f32 v211, v211
    v_mfma_f32_16x16x32_bf16 a[24:27], a[168:171], v[176:179], a[24:27]
    ds_read_b64_tr_b16 a[184:185], v23 offset:16384
    v_cvt_pk_bf16_f32 v144, v208, v209
    v_mfma_f32_16x16x32_bf16 a[24:27], a[172:175], v[180:183], a[24:27]
    ds_read_b64_tr_b16 a[186:187], v23 offset:20480
    v_mfma_f32_16x16x32_bf16 a[28:31], a[168:171], v[184:187], a[28:31]
    ds_read_b128 a[208:211], v8 offset:40960
    v_cvt_pk_bf16_f32 v145, v210, v211
    v_mfma_f32_16x16x32_bf16 a[28:31], a[172:175], v[188:191], a[28:31]
    s_waitcnt lgkmcnt(3)
    buffer_load_dwordx4 v40, s[12:15], s41 offen lds
    v_mfma_f32_16x16x32_bf16 v[208:211], a[224:227], v[64:67], v[192:195]
    v_exp_f32 v212, v212
    v_mfma_f32_16x16x32_bf16 v[208:211], a[228:231], v[68:71], v[208:211]
    v_exp_f32 v213, v213
    v_mfma_f32_16x16x32_bf16 v[208:211], a[232:235], v[72:75], v[208:211]
    v_exp_f32 v214, v214
    v_mfma_f32_16x16x32_bf16 v[208:211], a[236:239], v[76:79], v[208:211]
    v_exp_f32 v215, v215
    v_mfma_f32_16x16x32_bf16 a[32:35], a[176:179], v[160:163], a[32:35]
    ds_read_b64_tr_b16 a[188:189], v23 offset:24576
    v_cvt_pk_bf16_f32 v152, v212, v213
    v_mfma_f32_16x16x32_bf16 a[32:35], a[180:183], v[164:167], a[32:35]
    ds_read_b64_tr_b16 a[190:191], v23 offset:28672
    v_mfma_f32_16x16x32_bf16 a[36:39], a[176:179], v[168:171], a[36:39]
    ds_read_b128 a[212:215], v9 offset:40960
    v_cvt_pk_bf16_f32 v153, v214, v215
    v_mfma_f32_16x16x32_bf16 a[36:39], a[180:183], v[172:175], a[36:39]
    v_smfmac_f32_16x16x64_bf16 a[196:199], v[52:55], v[168:175], v50
    v_mfma_f32_16x16x32_bf16 v[212:215], a[224:227], v[80:83], v[196:199]
    v_exp_f32 v208, v208
    v_mfma_f32_16x16x32_bf16 v[212:215], a[228:231], v[84:87], v[212:215]
    v_exp_f32 v209, v209
    v_mfma_f32_16x16x32_bf16 v[212:215], a[232:235], v[88:91], v[212:215]
    v_exp_f32 v210, v210
    v_mfma_f32_16x16x32_bf16 v[212:215], a[236:239], v[92:95], v[212:215]
    v_exp_f32 v211, v211
    v_mfma_f32_16x16x32_bf16 a[40:43], a[176:179], v[176:179], a[40:43]
    ds_read_b64_tr_b16 a[160:161], v24 offset:16384
    v_cvt_pk_bf16_f32 v130, v208, v209
    v_mfma_f32_16x16x32_bf16 a[40:43], a[180:183], v[180:183], a[40:43]
    ds_read_b64_tr_b16 a[162:163], v24 offset:20480
    v_mfma_f32_16x16x32_bf16 a[44:47], a[176:179], v[184:187], a[44:47]
    ds_read_b128 a[216:219], v10 offset:40960
    v_cvt_pk_bf16_f32 v131, v210, v211
    v_mfma_f32_16x16x32_bf16 a[44:47], a[180:183], v[188:191], a[44:47]
    s_waitcnt lgkmcnt(3)
    buffer_load_dwordx4 v41, s[12:15], s41 offen offset:1024 lds
    v_mfma_f32_16x16x32_bf16 v[208:211], a[224:227], v[96:99], v[200:203]
    v_exp_f32 v212, v212
    v_mfma_f32_16x16x32_bf16 v[208:211], a[228:231], v[100:103], v[208:211]
    v_exp_f32 v213, v213
    v_mfma_f32_16x16x32_bf16 v[208:211], a[232:235], v[104:107], v[208:211]
    v_exp_f32 v214, v214
    v_mfma_f32_16x16x32_bf16 v[208:211], a[236:239], v[108:111], v[208:211]
    v_exp_f32 v215, v215
    v_mfma_f32_16x16x32_bf16 a[48:51], a[184:187], v[160:163], a[48:51]
    ds_read_b64_tr_b16 a[164:165], v24 offset:24576
    v_cvt_pk_bf16_f32 v138, v212, v213
    v_mfma_f32_16x16x32_bf16 a[48:51], a[188:191], v[164:167], a[48:51]
    ds_read_b64_tr_b16 a[166:167], v24 offset:28672
    v_mfma_f32_16x16x32_bf16 a[52:55], a[184:187], v[168:171], a[52:55]
    ds_read_b128 a[220:223], v11 offset:40960
    v_cvt_pk_bf16_f32 v139, v214, v215
    v_mfma_f32_16x16x32_bf16 a[52:55], a[188:191], v[172:175], a[52:55]
    v_smfmac_f32_16x16x64_bf16 a[200:203], v[52:55], v[176:183], v50
    v_mfma_f32_16x16x32_bf16 v[212:215], a[224:227], v[112:115], v[204:207]
    v_exp_f32 v208, v208
    v_mfma_f32_16x16x32_bf16 v[212:215], a[228:231], v[116:119], v[212:215]
    v_exp_f32 v209, v209
    v_mfma_f32_16x16x32_bf16 v[212:215], a[232:235], v[120:123], v[212:215]
    v_exp_f32 v210, v210
    v_mfma_f32_16x16x32_bf16 v[212:215], a[236:239], v[124:127], v[212:215]
    v_exp_f32 v211, v211
    v_mfma_f32_16x16x32_bf16 a[56:59], a[184:187], v[176:179], a[56:59]
    ds_read_b64_tr_b16 a[168:169], v25 offset:16384
    v_cvt_pk_bf16_f32 v146, v208, v209
    v_mfma_f32_16x16x32_bf16 a[56:59], a[188:191], v[180:183], a[56:59]
    ds_read_b64_tr_b16 a[170:171], v25 offset:20480
    v_mfma_f32_16x16x32_bf16 a[60:63], a[184:187], v[184:187], a[60:63]
    ds_read_b128 a[224:227], v8 offset:45056
    v_cvt_pk_bf16_f32 v147, v210, v211
    v_mfma_f32_16x16x32_bf16 a[60:63], a[188:191], v[188:191], a[60:63]
    s_waitcnt lgkmcnt(3)
    buffer_load_dwordx4 v40, s[12:15], s41 offen offset:2048 lds
    v_mfma_f32_16x16x32_bf16 v[208:211], a[208:211], v[64:67], v[192:195]
    v_exp_f32 v212, v212
    v_mfma_f32_16x16x32_bf16 v[208:211], a[212:215], v[68:71], v[208:211]
    v_exp_f32 v213, v213
    v_mfma_f32_16x16x32_bf16 v[208:211], a[216:219], v[72:75], v[208:211]
    v_exp_f32 v214, v214
    v_mfma_f32_16x16x32_bf16 v[208:211], a[220:223], v[76:79], v[208:211]
    v_exp_f32 v215, v215
    v_mfma_f32_16x16x32_bf16 a[64:67], a[160:163], v[160:163], a[64:67]
    ds_read_b64_tr_b16 a[172:173], v25 offset:24576
    v_cvt_pk_bf16_f32 v154, v212, v213
    v_mfma_f32_16x16x32_bf16 a[64:67], a[164:167], v[164:167], a[64:67]
    ds_read_b64_tr_b16 a[174:175], v25 offset:28672
    v_mfma_f32_16x16x32_bf16 a[68:71], a[160:163], v[168:171], a[68:71]
    ds_read_b128 a[228:231], v9 offset:45056
    v_cvt_pk_bf16_f32 v155, v214, v215
    v_mfma_f32_16x16x32_bf16 a[68:71], a[164:167], v[172:175], a[68:71]
    v_smfmac_f32_16x16x64_bf16 a[204:207], v[52:55], v[184:191], v50
    v_mfma_f32_16x16x32_bf16 v[212:215], a[208:211], v[80:83], v[196:199]
    v_exp_f32 v208, v208
    v_mfma_f32_16x16x32_bf16 v[212:215], a[212:215], v[84:87], v[212:215]
    v_exp_f32 v209, v209
    v_mfma_f32_16x16x32_bf16 v[212:215], a[216:219], v[88:91], v[212:215]
    v_exp_f32 v210, v210
    v_mfma_f32_16x16x32_bf16 v[212:215], a[220:223], v[92:95], v[212:215]
    v_exp_f32 v211, v211
    v_mfma_f32_16x16x32_bf16 a[72:75], a[160:163], v[176:179], a[72:75]
    ds_read_b64_tr_b16 a[176:177], v26 offset:16384
    v_cvt_pk_bf16_f32 v132, v208, v209
    v_mfma_f32_16x16x32_bf16 a[72:75], a[164:167], v[180:183], a[72:75]
    ds_read_b64_tr_b16 a[178:179], v26 offset:20480
    v_mfma_f32_16x16x32_bf16 a[76:79], a[160:163], v[184:187], a[76:79]
    ds_read_b128 a[232:235], v10 offset:45056
    v_cvt_pk_bf16_f32 v133, v210, v211
    v_mfma_f32_16x16x32_bf16 a[76:79], a[164:167], v[188:191], a[76:79]
    s_waitcnt lgkmcnt(3)
    buffer_load_dwordx4 v41, s[12:15], s41 offen offset:3072 lds
    v_mfma_f32_16x16x32_bf16 v[208:211], a[208:211], v[96:99], v[200:203]
    v_exp_f32 v212, v212
    v_mfma_f32_16x16x32_bf16 v[208:211], a[212:215], v[100:103], v[208:211]
    s_add_u32 s41, s41, 16384
    v_exp_f32 v213, v213
    v_mfma_f32_16x16x32_bf16 v[208:211], a[216:219], v[104:107], v[208:211]
    v_exp_f32 v214, v214
    v_mfma_f32_16x16x32_bf16 v[208:211], a[220:223], v[108:111], v[208:211]
    v_exp_f32 v215, v215
    v_mfma_f32_16x16x32_bf16 a[80:83], a[168:171], v[160:163], a[80:83]
    ds_read_b64_tr_b16 a[180:181], v26 offset:24576
    v_cvt_pk_bf16_f32 v140, v212, v213
    v_mfma_f32_16x16x32_bf16 a[80:83], a[172:175], v[164:167], a[80:83]
    ds_read_b64_tr_b16 a[182:183], v26 offset:28672
    v_mfma_f32_16x16x32_bf16 a[84:87], a[168:171], v[168:171], a[84:87]
    ds_read_b128 a[236:239], v11 offset:45056
    v_cvt_pk_bf16_f32 v141, v214, v215
    v_mfma_f32_16x16x32_bf16 a[84:87], a[172:175], v[172:175], a[84:87]
    s_waitcnt vmcnt(9)
    s_barrier
    v_mfma_f32_16x16x32_bf16 v[212:215], a[208:211], v[112:115], v[204:207]
    v_exp_f32 v208, v208
    v_mfma_f32_16x16x32_bf16 v[212:215], a[212:215], v[116:119], v[212:215]
    s_add_u32 m0, s42, 16384
    v_exp_f32 v209, v209
    v_mfma_f32_16x16x32_bf16 v[212:215], a[216:219], v[120:123], v[212:215]
    v_exp_f32 v210, v210
    v_mfma_f32_16x16x32_bf16 v[212:215], a[220:223], v[124:127], v[212:215]
    v_exp_f32 v211, v211
    v_mfma_f32_16x16x32_bf16 a[88:91], a[168:171], v[176:179], a[88:91]
    ds_read_b64_tr_b16 a[184:185], v27 offset:16384
    v_cvt_pk_bf16_f32 v148, v208, v209
    v_mfma_f32_16x16x32_bf16 a[88:91], a[172:175], v[180:183], a[88:91]
    ds_read_b64_tr_b16 a[186:187], v27 offset:20480
    v_mfma_f32_16x16x32_bf16 a[92:95], a[168:171], v[184:187], a[92:95]
    ds_read_b128 a[208:211], v8 offset:49152
    v_cvt_pk_bf16_f32 v149, v210, v211
    v_mfma_f32_16x16x32_bf16 a[92:95], a[172:175], v[188:191], a[92:95]
    s_waitcnt lgkmcnt(3)
    buffer_load_dwordx4 v36, s[8:11], s40 offen lds
    v_mfma_f32_16x16x32_bf16 v[208:211], a[224:227], v[64:67], v[192:195]
    v_exp_f32 v212, v212
    v_mfma_f32_16x16x32_bf16 v[208:211], a[228:231], v[68:71], v[208:211]
    v_exp_f32 v213, v213
    v_mfma_f32_16x16x32_bf16 v[208:211], a[232:235], v[72:75], v[208:211]
    v_exp_f32 v214, v214
    v_mfma_f32_16x16x32_bf16 v[208:211], a[236:239], v[76:79], v[208:211]
    v_exp_f32 v215, v215
    v_mfma_f32_16x16x32_bf16 a[96:99], a[176:179], v[160:163], a[96:99]
    ds_read_b64_tr_b16 a[188:189], v27 offset:24576
    v_cvt_pk_bf16_f32 v156, v212, v213
    v_mfma_f32_16x16x32_bf16 a[96:99], a[180:183], v[164:167], a[96:99]
    ds_read_b64_tr_b16 a[190:191], v27 offset:28672
    v_mfma_f32_16x16x32_bf16 a[100:103], a[176:179], v[168:171], a[100:103]
    ds_read_b128 a[212:215], v9 offset:49152
    v_cvt_pk_bf16_f32 v157, v214, v215
    v_mfma_f32_16x16x32_bf16 a[100:103], a[180:183], v[172:175], a[100:103]
    buffer_load_dword v218, v57, s[80:83], s39 offen
    v_mfma_f32_16x16x32_bf16 v[212:215], a[224:227], v[80:83], v[196:199]
    v_exp_f32 v208, v208
    v_mfma_f32_16x16x32_bf16 v[212:215], a[228:231], v[84:87], v[212:215]
    v_exp_f32 v209, v209
    v_mfma_f32_16x16x32_bf16 v[212:215], a[232:235], v[88:91], v[212:215]
    v_exp_f32 v210, v210
    v_mfma_f32_16x16x32_bf16 v[212:215], a[236:239], v[92:95], v[212:215]
    v_exp_f32 v211, v211
    v_mfma_f32_16x16x32_bf16 a[104:107], a[176:179], v[176:179], a[104:107]
    ds_read_b64_tr_b16 a[160:161], v20 offset:32768
    v_cvt_pk_bf16_f32 v134, v208, v209
    v_mfma_f32_16x16x32_bf16 a[104:107], a[180:183], v[180:183], a[104:107]
    ds_read_b64_tr_b16 a[162:163], v20 offset:36864
    v_mfma_f32_16x16x32_bf16 a[108:111], a[176:179], v[184:187], a[108:111]
    ds_read_b128 a[216:219], v10 offset:49152
    v_cvt_pk_bf16_f32 v135, v210, v211
    v_mfma_f32_16x16x32_bf16 a[108:111], a[180:183], v[188:191], a[108:111]
    s_waitcnt lgkmcnt(3)
    buffer_load_dwordx4 v37, s[8:11], s40 offen offset:1024 lds
    v_mfma_f32_16x16x32_bf16 v[208:211], a[224:227], v[96:99], v[200:203]
    v_exp_f32 v212, v212
    v_mfma_f32_16x16x32_bf16 v[208:211], a[228:231], v[100:103], v[208:211]
    v_exp_f32 v213, v213
    v_mfma_f32_16x16x32_bf16 v[208:211], a[232:235], v[104:107], v[208:211]
    v_exp_f32 v214, v214
    v_mfma_f32_16x16x32_bf16 v[208:211], a[236:239], v[108:111], v[208:211]
    v_exp_f32 v215, v215
    v_mfma_f32_16x16x32_bf16 a[112:115], a[184:187], v[160:163], a[112:115]
    ds_read_b64_tr_b16 a[164:165], v20 offset:40960
    v_cvt_pk_bf16_f32 v142, v212, v213
    v_mfma_f32_16x16x32_bf16 a[112:115], a[188:191], v[164:167], a[112:115]
    ds_read_b64_tr_b16 a[166:167], v20 offset:45056
    v_mfma_f32_16x16x32_bf16 a[116:119], a[184:187], v[168:171], a[116:119]
    ds_read_b128 a[220:223], v11 offset:49152
    v_cvt_pk_bf16_f32 v143, v214, v215
    v_mfma_f32_16x16x32_bf16 a[116:119], a[188:191], v[172:175], a[116:119]
    buffer_store_dwordx4 v[248:251], v232, s[24:27], s53 offen sc1
    v_mfma_f32_16x16x32_bf16 v[212:215], a[224:227], v[112:115], v[204:207]
    v_exp_f32 v208, v208
    v_mfma_f32_16x16x32_bf16 v[212:215], a[228:231], v[116:119], v[212:215]
    v_exp_f32 v209, v209
    v_mfma_f32_16x16x32_bf16 v[212:215], a[232:235], v[120:123], v[212:215]
    v_exp_f32 v210, v210
    v_mfma_f32_16x16x32_bf16 v[212:215], a[236:239], v[124:127], v[212:215]
    s_add_u32 s53, s53, 656
    v_exp_f32 v211, v211
    v_mfma_f32_16x16x32_bf16 a[120:123], a[184:187], v[176:179], a[120:123]
    ds_read_b64_tr_b16 a[168:169], v21 offset:32768
    v_cvt_pk_bf16_f32 v150, v208, v209
    v_mfma_f32_16x16x32_bf16 a[120:123], a[188:191], v[180:183], a[120:123]
    ds_read_b64_tr_b16 a[170:171], v21 offset:36864
    v_mfma_f32_16x16x32_bf16 a[124:127], a[184:187], v[184:187], a[124:127]
    ds_read_b128 a[224:227], v8 offset:53248
    v_cvt_pk_bf16_f32 v151, v210, v211
    v_mfma_f32_16x16x32_bf16 a[124:127], a[188:191], v[188:191], a[124:127]
    s_waitcnt lgkmcnt(3)
    buffer_load_dwordx4 v38, s[8:11], s40 offen offset:2048 lds
    v_mfma_f32_16x16x32_bf16 v[208:211], a[208:211], v[64:67], v[192:195]
    v_exp_f32 v212, v212
    v_mfma_f32_16x16x32_bf16 v[208:211], a[212:215], v[68:71], v[208:211]
    v_exp_f32 v213, v213
    v_mfma_f32_16x16x32_bf16 v[208:211], a[216:219], v[72:75], v[208:211]
    v_exp_f32 v214, v214
    v_mfma_f32_16x16x32_bf16 v[208:211], a[220:223], v[76:79], v[208:211]
    v_exp_f32 v215, v215
    v_mfma_f32_16x16x32_bf16 a[0:3], a[160:163], v[128:131], a[0:3]
    ds_read_b64_tr_b16 a[172:173], v21 offset:40960
    v_cvt_pk_bf16_f32 v158, v212, v213
    v_mfma_f32_16x16x32_bf16 a[0:3], a[164:167], v[132:135], a[0:3]
    ds_read_b64_tr_b16 a[174:175], v21 offset:45056
    v_mfma_f32_16x16x32_bf16 a[4:7], a[160:163], v[136:139], a[4:7]
    ds_read_b128 a[228:231], v9 offset:53248
    v_cvt_pk_bf16_f32 v159, v214, v215
    v_mfma_f32_16x16x32_bf16 a[4:7], a[164:167], v[140:143], a[4:7]
    v_mfma_f32_16x16x32_bf16 v[212:215], a[208:211], v[80:83], v[196:199]
    v_exp_f32 v208, v208
    v_mfma_f32_16x16x32_bf16 v[212:215], a[212:215], v[84:87], v[212:215]
    v_exp_f32 v209, v209
    v_mfma_f32_16x16x32_bf16 v[212:215], a[216:219], v[88:91], v[212:215]
    v_exp_f32 v210, v210
    v_mfma_f32_16x16x32_bf16 v[212:215], a[220:223], v[92:95], v[212:215]
    v_exp_f32 v211, v211
    v_mfma_f32_16x16x32_bf16 a[8:11], a[160:163], v[144:147], a[8:11]
    ds_read_b64_tr_b16 a[176:177], v22 offset:32768
    v_cvt_pk_bf16_f32 v160, v208, v209
    v_mfma_f32_16x16x32_bf16 a[8:11], a[164:167], v[148:151], a[8:11]
    ds_read_b64_tr_b16 a[178:179], v22 offset:36864
    v_mfma_f32_16x16x32_bf16 a[12:15], a[160:163], v[152:155], a[12:15]
    ds_read_b128 a[232:235], v10 offset:53248
    v_cvt_pk_bf16_f32 v161, v210, v211
    v_mfma_f32_16x16x32_bf16 a[12:15], a[164:167], v[156:159], a[12:15]
    s_waitcnt lgkmcnt(3)
    buffer_load_dwordx4 v39, s[8:11], s40 offen offset:3072 lds
    v_mfma_f32_16x16x32_bf16 v[208:211], a[208:211], v[96:99], v[200:203]
    v_exp_f32 v212, v212
    v_mfma_f32_16x16x32_bf16 v[208:211], a[212:215], v[100:103], v[208:211]
    s_add_u32 s40, s40, 16384
    v_exp_f32 v213, v213
    v_mfma_f32_16x16x32_bf16 v[208:211], a[216:219], v[104:107], v[208:211]
    v_exp_f32 v214, v214
    v_mfma_f32_16x16x32_bf16 v[208:211], a[220:223], v[108:111], v[208:211]
    v_exp_f32 v215, v215
    v_mfma_f32_16x16x32_bf16 a[16:19], a[168:171], v[128:131], a[16:19]
    ds_read_b64_tr_b16 a[180:181], v22 offset:40960
    v_cvt_pk_bf16_f32 v168, v212, v213
    v_mfma_f32_16x16x32_bf16 a[16:19], a[172:175], v[132:135], a[16:19]
    ds_read_b64_tr_b16 a[182:183], v22 offset:45056
    v_mfma_f32_16x16x32_bf16 a[20:23], a[168:171], v[136:139], a[20:23]
    ds_read_b128 a[236:239], v11 offset:53248
    v_cvt_pk_bf16_f32 v169, v214, v215
    v_mfma_f32_16x16x32_bf16 a[20:23], a[172:175], v[140:143], a[20:23]
    v_smfmac_f32_16x16x64_bf16 a[192:195], v[52:55], v[128:135], v50
    v_mfma_f32_16x16x32_bf16 v[212:215], a[208:211], v[112:115], v[204:207]
    v_exp_f32 v208, v208
    v_mfma_f32_16x16x32_bf16 v[212:215], a[212:215], v[116:119], v[212:215]
    s_add_u32 m0, s42, 65536
    v_exp_f32 v209, v209
    v_mfma_f32_16x16x32_bf16 v[212:215], a[216:219], v[120:123], v[212:215]
    v_exp_f32 v210, v210
    v_mfma_f32_16x16x32_bf16 v[212:215], a[220:223], v[124:127], v[212:215]
    v_exp_f32 v211, v211
    v_mfma_f32_16x16x32_bf16 a[24:27], a[168:171], v[144:147], a[24:27]
    ds_read_b64_tr_b16 a[184:185], v23 offset:32768
    v_cvt_pk_bf16_f32 v176, v208, v209
    v_mfma_f32_16x16x32_bf16 a[24:27], a[172:175], v[148:151], a[24:27]
    ds_read_b64_tr_b16 a[186:187], v23 offset:36864
    v_mfma_f32_16x16x32_bf16 a[28:31], a[168:171], v[152:155], a[28:31]
    ds_read_b128 a[208:211], v8 offset:57344
    v_cvt_pk_bf16_f32 v177, v210, v211
    v_mfma_f32_16x16x32_bf16 a[28:31], a[172:175], v[156:159], a[28:31]
    s_waitcnt lgkmcnt(3)
    buffer_load_dwordx4 v40, s[12:15], s41 offen lds
    v_mfma_f32_16x16x32_bf16 v[208:211], a[224:227], v[64:67], v[192:195]
    v_exp_f32 v212, v212
    v_mfma_f32_16x16x32_bf16 v[208:211], a[228:231], v[68:71], v[208:211]
    v_exp_f32 v213, v213
    v_mfma_f32_16x16x32_bf16 v[208:211], a[232:235], v[72:75], v[208:211]
    v_exp_f32 v214, v214
    v_mfma_f32_16x16x32_bf16 v[208:211], a[236:239], v[76:79], v[208:211]
    v_exp_f32 v215, v215
    v_mfma_f32_16x16x32_bf16 a[32:35], a[176:179], v[128:131], a[32:35]
    ds_read_b64_tr_b16 a[188:189], v23 offset:40960
    v_cvt_pk_bf16_f32 v184, v212, v213
    v_mfma_f32_16x16x32_bf16 a[32:35], a[180:183], v[132:135], a[32:35]
    ds_read_b64_tr_b16 a[190:191], v23 offset:45056
    v_mfma_f32_16x16x32_bf16 a[36:39], a[176:179], v[136:139], a[36:39]
    ds_read_b128 a[212:215], v9 offset:57344
    v_cvt_pk_bf16_f32 v185, v214, v215
    v_mfma_f32_16x16x32_bf16 a[36:39], a[180:183], v[140:143], a[36:39]
    v_smfmac_f32_16x16x64_bf16 a[196:199], v[52:55], v[136:143], v50
    v_mfma_f32_16x16x32_bf16 v[212:215], a[224:227], v[80:83], v[196:199]
    v_exp_f32 v208, v208
    v_mfma_f32_16x16x32_bf16 v[212:215], a[228:231], v[84:87], v[212:215]
    v_exp_f32 v209, v209
    v_mfma_f32_16x16x32_bf16 v[212:215], a[232:235], v[88:91], v[212:215]
    v_exp_f32 v210, v210
    v_mfma_f32_16x16x32_bf16 v[212:215], a[236:239], v[92:95], v[212:215]
    v_exp_f32 v211, v211
    v_mfma_f32_16x16x32_bf16 a[40:43], a[176:179], v[144:147], a[40:43]
    ds_read_b64_tr_b16 a[160:161], v24 offset:32768
    v_cvt_pk_bf16_f32 v162, v208, v209
    v_mfma_f32_16x16x32_bf16 a[40:43], a[180:183], v[148:151], a[40:43]
    ds_read_b64_tr_b16 a[162:163], v24 offset:36864
    v_mfma_f32_16x16x32_bf16 a[44:47], a[176:179], v[152:155], a[44:47]
    ds_read_b128 a[216:219], v10 offset:57344
    v_cvt_pk_bf16_f32 v163, v210, v211
    v_mfma_f32_16x16x32_bf16 a[44:47], a[180:183], v[156:159], a[44:47]
    s_waitcnt lgkmcnt(3)
    buffer_load_dwordx4 v41, s[12:15], s41 offen offset:1024 lds
    v_mfma_f32_16x16x32_bf16 v[208:211], a[224:227], v[96:99], v[200:203]
    v_exp_f32 v212, v212
    v_mfma_f32_16x16x32_bf16 v[208:211], a[228:231], v[100:103], v[208:211]
    v_exp_f32 v213, v213
    v_mfma_f32_16x16x32_bf16 v[208:211], a[232:235], v[104:107], v[208:211]
    v_exp_f32 v214, v214
    v_mfma_f32_16x16x32_bf16 v[208:211], a[236:239], v[108:111], v[208:211]
    v_exp_f32 v215, v215
    v_mfma_f32_16x16x32_bf16 a[48:51], a[184:187], v[128:131], a[48:51]
    ds_read_b64_tr_b16 a[164:165], v24 offset:40960
    v_cvt_pk_bf16_f32 v170, v212, v213
    v_mfma_f32_16x16x32_bf16 a[48:51], a[188:191], v[132:135], a[48:51]
    ds_read_b64_tr_b16 a[166:167], v24 offset:45056
    v_mfma_f32_16x16x32_bf16 a[52:55], a[184:187], v[136:139], a[52:55]
    ds_read_b128 a[220:223], v11 offset:57344
    v_cvt_pk_bf16_f32 v171, v214, v215
    v_mfma_f32_16x16x32_bf16 a[52:55], a[188:191], v[140:143], a[52:55]
    v_smfmac_f32_16x16x64_bf16 a[200:203], v[52:55], v[144:151], v50
    v_mfma_f32_16x16x32_bf16 v[212:215], a[224:227], v[112:115], v[204:207]
    v_exp_f32 v208, v208
    v_mfma_f32_16x16x32_bf16 v[212:215], a[228:231], v[116:119], v[212:215]
    v_exp_f32 v209, v209
    v_mfma_f32_16x16x32_bf16 v[212:215], a[232:235], v[120:123], v[212:215]
    v_exp_f32 v210, v210
    v_mfma_f32_16x16x32_bf16 v[212:215], a[236:239], v[124:127], v[212:215]
    v_exp_f32 v211, v211
    v_mfma_f32_16x16x32_bf16 a[56:59], a[184:187], v[144:147], a[56:59]
    ds_read_b64_tr_b16 a[168:169], v25 offset:32768
    v_cvt_pk_bf16_f32 v178, v208, v209
    v_mfma_f32_16x16x32_bf16 a[56:59], a[188:191], v[148:151], a[56:59]
    ds_read_b64_tr_b16 a[170:171], v25 offset:36864
    v_mfma_f32_16x16x32_bf16 a[60:63], a[184:187], v[152:155], a[60:63]
    ds_read_b128 a[224:227], v8 offset:61440
    v_cvt_pk_bf16_f32 v179, v210, v211
    v_mfma_f32_16x16x32_bf16 a[60:63], a[188:191], v[156:159], a[60:63]
    s_waitcnt lgkmcnt(3)
    buffer_load_dwordx4 v40, s[12:15], s41 offen offset:2048 lds
    v_mfma_f32_16x16x32_bf16 v[208:211], a[208:211], v[64:67], v[192:195]
    v_exp_f32 v212, v212
    v_mfma_f32_16x16x32_bf16 v[208:211], a[212:215], v[68:71], v[208:211]
    v_exp_f32 v213, v213
    v_mfma_f32_16x16x32_bf16 v[208:211], a[216:219], v[72:75], v[208:211]
    v_exp_f32 v214, v214
    v_mfma_f32_16x16x32_bf16 v[208:211], a[220:223], v[76:79], v[208:211]
    v_exp_f32 v215, v215
    v_mfma_f32_16x16x32_bf16 a[64:67], a[160:163], v[128:131], a[64:67]
    ds_read_b64_tr_b16 a[172:173], v25 offset:40960
    v_cvt_pk_bf16_f32 v186, v212, v213
    v_mfma_f32_16x16x32_bf16 a[64:67], a[164:167], v[132:135], a[64:67]
    ds_read_b64_tr_b16 a[174:175], v25 offset:45056
    v_mfma_f32_16x16x32_bf16 a[68:71], a[160:163], v[136:139], a[68:71]
    ds_read_b128 a[228:231], v9 offset:61440
    v_cvt_pk_bf16_f32 v187, v214, v215
    v_mfma_f32_16x16x32_bf16 a[68:71], a[164:167], v[140:143], a[68:71]
    v_smfmac_f32_16x16x64_bf16 a[204:207], v[52:55], v[152:159], v50
    v_mfma_f32_16x16x32_bf16 v[212:215], a[208:211], v[80:83], v[196:199]
    v_exp_f32 v208, v208
    v_mfma_f32_16x16x32_bf16 v[212:215], a[212:215], v[84:87], v[212:215]
    v_exp_f32 v209, v209
    v_mfma_f32_16x16x32_bf16 v[212:215], a[216:219], v[88:91], v[212:215]
    v_exp_f32 v210, v210
    v_mfma_f32_16x16x32_bf16 v[212:215], a[220:223], v[92:95], v[212:215]
    v_exp_f32 v211, v211
    v_mfma_f32_16x16x32_bf16 a[72:75], a[160:163], v[144:147], a[72:75]
    ds_read_b64_tr_b16 a[176:177], v26 offset:32768
    v_cvt_pk_bf16_f32 v164, v208, v209
    v_mfma_f32_16x16x32_bf16 a[72:75], a[164:167], v[148:151], a[72:75]
    ds_read_b64_tr_b16 a[178:179], v26 offset:36864
    v_mfma_f32_16x16x32_bf16 a[76:79], a[160:163], v[152:155], a[76:79]
    ds_read_b128 a[232:235], v10 offset:61440
    v_cvt_pk_bf16_f32 v165, v210, v211
    v_mfma_f32_16x16x32_bf16 a[76:79], a[164:167], v[156:159], a[76:79]
    s_waitcnt lgkmcnt(3)
    buffer_load_dwordx4 v41, s[12:15], s41 offen offset:3072 lds
    v_mfma_f32_16x16x32_bf16 v[208:211], a[208:211], v[96:99], v[200:203]
    v_exp_f32 v212, v212
    v_mfma_f32_16x16x32_bf16 v[208:211], a[212:215], v[100:103], v[208:211]
    s_add_u32 s41, s41, 16384
    v_exp_f32 v213, v213
    v_mfma_f32_16x16x32_bf16 v[208:211], a[216:219], v[104:107], v[208:211]
    v_exp_f32 v214, v214
    v_mfma_f32_16x16x32_bf16 v[208:211], a[220:223], v[108:111], v[208:211]
    v_exp_f32 v215, v215
    v_mfma_f32_16x16x32_bf16 a[80:83], a[168:171], v[128:131], a[80:83]
    ds_read_b64_tr_b16 a[180:181], v26 offset:40960
    v_cvt_pk_bf16_f32 v172, v212, v213
    v_mfma_f32_16x16x32_bf16 a[80:83], a[172:175], v[132:135], a[80:83]
    ds_read_b64_tr_b16 a[182:183], v26 offset:45056
    v_mfma_f32_16x16x32_bf16 a[84:87], a[168:171], v[136:139], a[84:87]
    ds_read_b128 a[236:239], v11 offset:61440
    v_cvt_pk_bf16_f32 v173, v214, v215
    v_mfma_f32_16x16x32_bf16 a[84:87], a[172:175], v[140:143], a[84:87]
    s_waitcnt vmcnt(10)
    s_barrier
    v_mfma_f32_16x16x32_bf16 v[212:215], a[208:211], v[112:115], v[204:207]
    v_exp_f32 v208, v208
    v_mfma_f32_16x16x32_bf16 v[212:215], a[212:215], v[116:119], v[212:215]
    s_add_u32 m0, s42, 32768
    v_exp_f32 v209, v209
    v_mfma_f32_16x16x32_bf16 v[212:215], a[216:219], v[120:123], v[212:215]
    v_exp_f32 v210, v210
    v_mfma_f32_16x16x32_bf16 v[212:215], a[220:223], v[124:127], v[212:215]
    v_exp_f32 v211, v211
    v_mfma_f32_16x16x32_bf16 a[88:91], a[168:171], v[144:147], a[88:91]
    ds_read_b64_tr_b16 a[184:185], v27 offset:32768
    v_cvt_pk_bf16_f32 v180, v208, v209
    v_mfma_f32_16x16x32_bf16 a[88:91], a[172:175], v[148:151], a[88:91]
    ds_read_b64_tr_b16 a[186:187], v27 offset:36864
    v_mfma_f32_16x16x32_bf16 a[92:95], a[168:171], v[152:155], a[92:95]
    ds_read_b128 a[208:211], v8 offset:0
    v_cvt_pk_bf16_f32 v181, v210, v211
    v_mfma_f32_16x16x32_bf16 a[92:95], a[172:175], v[156:159], a[92:95]
    s_waitcnt lgkmcnt(3)
    buffer_load_dwordx4 v36, s[8:11], s40 offen lds
    v_mfma_f32_16x16x32_bf16 v[208:211], a[224:227], v[64:67], v[192:195]
    v_exp_f32 v212, v212
    v_mfma_f32_16x16x32_bf16 v[208:211], a[228:231], v[68:71], v[208:211]
    v_exp_f32 v213, v213
    v_mfma_f32_16x16x32_bf16 v[208:211], a[232:235], v[72:75], v[208:211]
    v_exp_f32 v214, v214
    v_mfma_f32_16x16x32_bf16 v[208:211], a[236:239], v[76:79], v[208:211]
    v_exp_f32 v215, v215
    v_mfma_f32_16x16x32_bf16 a[96:99], a[176:179], v[128:131], a[96:99]
    ds_read_b64_tr_b16 a[188:189], v27 offset:40960
    v_cvt_pk_bf16_f32 v188, v212, v213
    v_mfma_f32_16x16x32_bf16 a[96:99], a[180:183], v[132:135], a[96:99]
    ds_read_b64_tr_b16 a[190:191], v27 offset:45056
    v_mfma_f32_16x16x32_bf16 a[100:103], a[176:179], v[136:139], a[100:103]
    ds_read_b128 a[212:215], v9 offset:0
    v_cvt_pk_bf16_f32 v189, v214, v215
    v_mfma_f32_16x16x32_bf16 a[100:103], a[180:183], v[140:143], a[100:103]
    buffer_load_dword v219, v62, s[84:87], s38 offen
    v_mfma_f32_16x16x32_bf16 v[212:215], a[224:227], v[80:83], v[196:199]
    v_exp_f32 v208, v208
    v_mfma_f32_16x16x32_bf16 v[212:215], a[228:231], v[84:87], v[212:215]
    v_exp_f32 v209, v209
    v_mfma_f32_16x16x32_bf16 v[212:215], a[232:235], v[88:91], v[212:215]
    v_exp_f32 v210, v210
    v_mfma_f32_16x16x32_bf16 v[212:215], a[236:239], v[92:95], v[212:215]
    v_exp_f32 v211, v211
    v_mfma_f32_16x16x32_bf16 a[104:107], a[176:179], v[144:147], a[104:107]
    ds_read_b64_tr_b16 a[160:161], v20 offset:49152
    v_cvt_pk_bf16_f32 v166, v208, v209
    v_mfma_f32_16x16x32_bf16 a[104:107], a[180:183], v[148:151], a[104:107]
    ds_read_b64_tr_b16 a[162:163], v20 offset:53248
    v_mfma_f32_16x16x32_bf16 a[108:111], a[176:179], v[152:155], a[108:111]
    ds_read_b128 a[216:219], v10 offset:0
    v_cvt_pk_bf16_f32 v167, v210, v211
    v_mfma_f32_16x16x32_bf16 a[108:111], a[180:183], v[156:159], a[108:111]
    s_waitcnt lgkmcnt(3)
    buffer_load_dwordx4 v37, s[8:11], s40 offen offset:1024 lds
    v_mfma_f32_16x16x32_bf16 v[208:211], a[224:227], v[96:99], v[200:203]
    v_exp_f32 v212, v212
    v_mfma_f32_16x16x32_bf16 v[208:211], a[228:231], v[100:103], v[208:211]
    v_exp_f32 v213, v213
    v_mfma_f32_16x16x32_bf16 v[208:211], a[232:235], v[104:107], v[208:211]
    v_exp_f32 v214, v214
    v_mfma_f32_16x16x32_bf16 v[208:211], a[236:239], v[108:111], v[208:211]
    v_exp_f32 v215, v215
    v_mfma_f32_16x16x32_bf16 a[112:115], a[184:187], v[128:131], a[112:115]
    ds_read_b64_tr_b16 a[164:165], v20 offset:57344
    v_cvt_pk_bf16_f32 v174, v212, v213
    v_mfma_f32_16x16x32_bf16 a[112:115], a[188:191], v[132:135], a[112:115]
    ds_read_b64_tr_b16 a[166:167], v20 offset:61440
    v_mfma_f32_16x16x32_bf16 a[116:119], a[184:187], v[136:139], a[116:119]
    ds_read_b128 a[220:223], v11 offset:0
    v_cvt_pk_bf16_f32 v175, v214, v215
    v_mfma_f32_16x16x32_bf16 a[116:119], a[188:191], v[140:143], a[116:119]
    buffer_load_dword v221, v235, s[20:23], 0 offen
    v_mfma_f32_16x16x32_bf16 v[212:215], a[224:227], v[112:115], v[204:207]
    v_exp_f32 v208, v208
    v_mfma_f32_16x16x32_bf16 v[212:215], a[228:231], v[116:119], v[212:215]
Ltour5:
    s_cbranch_execz Ltour9
    v_exp_f32 v209, v209
    v_mfma_f32_16x16x32_bf16 v[212:215], a[232:235], v[120:123], v[212:215]
    v_exp_f32 v210, v210
    v_mfma_f32_16x16x32_bf16 v[212:215], a[236:239], v[124:127], v[212:215]
    v_exp_f32 v211, v211
    v_mfma_f32_16x16x32_bf16 a[120:123], a[184:187], v[144:147], a[120:123]
    ds_read_b64_tr_b16 a[168:169], v21 offset:49152
    v_cvt_pk_bf16_f32 v182, v208, v209
    v_mfma_f32_16x16x32_bf16 a[120:123], a[188:191], v[148:151], a[120:123]
    ds_read_b64_tr_b16 a[170:171], v21 offset:53248
    v_add_u32 v235, 2560, v235
    v_mfma_f32_16x16x32_bf16 a[124:127], a[184:187], v[152:155], a[124:127]
    ds_read_b128 a[224:227], v8 offset:4096
    v_cvt_pk_bf16_f32 v183, v210, v211
    v_mfma_f32_16x16x32_bf16 a[124:127], a[188:191], v[156:159], a[124:127]
    s_waitcnt lgkmcnt(3)
    buffer_load_dwordx4 v38, s[8:11], s40 offen offset:2048 lds
    v_mfma_f32_16x16x32_bf16 v[208:211], a[208:211], v[64:67], v[192:195]
    v_exp_f32 v212, v212
    v_mfma_f32_16x16x32_bf16 v[208:211], a[212:215], v[68:71], v[208:211]
    v_exp_f32 v213, v213
    v_mfma_f32_16x16x32_bf16 v[208:211], a[216:219], v[72:75], v[208:211]
    v_exp_f32 v214, v214
    v_mfma_f32_16x16x32_bf16 v[208:211], a[220:223], v[76:79], v[208:211]
    v_exp_f32 v215, v215
    v_mfma_f32_16x16x32_bf16 a[0:3], a[160:163], v[160:163], a[0:3]
    ds_read_b64_tr_b16 a[172:173], v21 offset:57344
    v_cvt_pk_bf16_f32 v190, v212, v213
    v_mfma_f32_16x16x32_bf16 a[0:3], a[164:167], v[164:167], a[0:3]
    ds_read_b64_tr_b16 a[174:175], v21 offset:61440
    v_lshlrev_b32 v244, 16, v240
    v_mfma_f32_16x16x32_bf16 a[4:7], a[160:163], v[168:171], a[4:7]
    ds_read_b128 a[228:231], v9 offset:4096
    v_cvt_pk_bf16_f32 v191, v214, v215
    v_mfma_f32_16x16x32_bf16 a[4:7], a[164:167], v[172:175], a[4:7]
    v_and_b32 v245, 0xffff0000, v240
    v_fmac_f32 v224, v2, v244
    v_mfma_f32_16x16x32_bf16 v[212:215], a[208:211], v[80:83], v[196:199]
    v_exp_f32 v208, v208
    v_mfma_f32_16x16x32_bf16 v[212:215], a[212:215], v[84:87], v[212:215]
    v_exp_f32 v209, v209
    v_mfma_f32_16x16x32_bf16 v[212:215], a[216:219], v[88:91], v[212:215]
    v_exp_f32 v210, v210
    v_mfma_f32_16x16x32_bf16 v[212:215], a[220:223], v[92:95], v[212:215]
    v_exp_f32 v211, v211
    v_mfma_f32_16x16x32_bf16 a[8:11], a[160:163], v[176:179], a[8:11]
    ds_read_b64_tr_b16 a[176:177], v22 offset:49152
    v_cvt_pk_bf16_f32 v128, v208, v209
    v_mfma_f32_16x16x32_bf16 a[8:11], a[164:167], v[180:183], a[8:11]
    ds_read_b64_tr_b16 a[178:179], v22 offset:53248
    v_fmac_f32 v225, v2, v245
    v_mfma_f32_16x16x32_bf16 a[12:15], a[160:163], v[184:187], a[12:15]
    ds_read_b128 a[232:235], v10 offset:4096
    v_cvt_pk_bf16_f32 v129, v210, v211
    v_mfma_f32_16x16x32_bf16 a[12:15], a[164:167], v[188:191], a[12:15]
    s_waitcnt lgkmcnt(3)
    buffer_load_dwordx4 v39, s[8:11], s40 offen offset:3072 lds
    v_mfma_f32_16x16x32_bf16 v[208:211], a[208:211], v[96:99], v[200:203]
    v_exp_f32 v212, v212
    v_mfma_f32_16x16x32_bf16 v[208:211], a[212:215], v[100:103], v[208:211]
    s_add_u32 s40, s40, 16384
    v_exp_f32 v213, v213
    v_mfma_f32_16x16x32_bf16 v[208:211], a[216:219], v[104:107], v[208:211]
    v_exp_f32 v214, v214
    v_mfma_f32_16x16x32_bf16 v[208:211], a[220:223], v[108:111], v[208:211]
    v_exp_f32 v215, v215
    v_mfma_f32_16x16x32_bf16 a[16:19], a[168:171], v[160:163], a[16:19]
    ds_read_b64_tr_b16 a[180:181], v22 offset:57344
    v_cvt_pk_bf16_f32 v136, v212, v213
    v_mfma_f32_16x16x32_bf16 a[16:19], a[172:175], v[164:167], a[16:19]
    ds_read_b64_tr_b16 a[182:183], v22 offset:61440
    v_lshlrev_b32 v246, 16, v241
    v_mfma_f32_16x16x32_bf16 a[20:23], a[168:171], v[168:171], a[20:23]
    ds_read_b128 a[236:239], v11 offset:4096
    v_cvt_pk_bf16_f32 v137, v214, v215
    v_mfma_f32_16x16x32_bf16 a[20:23], a[172:175], v[172:175], a[20:23]
    v_and_b32 v247, 0xffff0000, v241
    v_fmac_f32 v226, v2, v246
    v_smfmac_f32_16x16x64_bf16 a[192:195], v[52:55], v[160:167], v50
    v_mfma_f32_16x16x32_bf16 v[212:215], a[208:211], v[112:115], v[204:207]
    v_exp_f32 v208, v208
    v_mfma_f32_16x16x32_bf16 v[212:215], a[212:215], v[116:119], v[212:215]
    s_add_u32 m0, s42, 81920
    v_exp_f32 v209, v209
    v_mfma_f32_16x16x32_bf16 v[212:215], a[216:219], v[120:123], v[212:215]
    v_exp_f32 v210, v210
    v_mfma_f32_16x16x32_bf16 v[212:215], a[220:223], v[124:127], v[212:215]
    v_exp_f32 v211, v211
    v_mfma_f32_16x16x32_bf16 a[24:27], a[168:171], v[176:179], a[24:27]
    ds_read_b64_tr_b16 a[184:185], v23 offset:49152
    v_cvt_pk_bf16_f32 v144, v208, v209
    v_mfma_f32_16x16x32_bf16 a[24:27], a[172:175], v[180:183], a[24:27]
    ds_read_b64_tr_b16 a[186:187], v23 offset:53248
    v_fmac_f32 v227, v2, v247
    v_mfma_f32_16x16x32_bf16 a[28:31], a[168:171], v[184:187], a[28:31]
    ds_read_b128 a[208:211], v8 offset:8192
    v_cvt_pk_bf16_f32 v145, v210, v211
    v_mfma_f32_16x16x32_bf16 a[28:31], a[172:175], v[188:191], a[28:31]
    s_waitcnt lgkmcnt(3)
    buffer_load_dwordx4 v40, s[12:15], s41 offen lds
    v_mfma_f32_16x16x32_bf16 v[208:211], a[224:227], v[64:67], v[192:195]
    v_exp_f32 v212, v212
    v_mfma_f32_16x16x32_bf16 v[208:211], a[228:231], v[68:71], v[208:211]
    v_exp_f32 v213, v213
    v_mfma_f32_16x16x32_bf16 v[208:211], a[232:235], v[72:75], v[208:211]
    v_exp_f32 v214, v214
    v_mfma_f32_16x16x32_bf16 v[208:211], a[236:239], v[76:79], v[208:211]
    v_exp_f32 v215, v215
    v_mfma_f32_16x16x32_bf16 a[32:35], a[176:179], v[160:163], a[32:35]
    ds_read_b64_tr_b16 a[188:189], v23 offset:57344
    v_cvt_pk_bf16_f32 v152, v212, v213
    v_mfma_f32_16x16x32_bf16 a[32:35], a[180:183], v[164:167], a[32:35]
    ds_read_b64_tr_b16 a[190:191], v23 offset:61440
    v_lshlrev_b32 v244, 16, v242
    v_mfma_f32_16x16x32_bf16 a[36:39], a[176:179], v[168:171], a[36:39]
    ds_read_b128 a[212:215], v9 offset:8192
    v_cvt_pk_bf16_f32 v153, v214, v215
    v_mfma_f32_16x16x32_bf16 a[36:39], a[180:183], v[172:175], a[36:39]
    v_and_b32 v245, 0xffff0000, v242
    v_fmac_f32 v228, v2, v244
    v_smfmac_f32_16x16x64_bf16 a[196:199], v[52:55], v[168:175], v50
    v_mfma_f32_16x16x32_bf16 v[212:215], a[224:227], v[80:83], v[196:199]
    v_exp_f32 v208, v208
    v_mfma_f32_16x16x32_bf16 v[212:215], a[228:231], v[84:87], v[212:215]
    v_exp_f32 v209, v209
    v_mfma_f32_16x16x32_bf16 v[212:215], a[232:235], v[88:91], v[212:215]
    v_exp_f32 v210, v210
    v_mfma_f32_16x16x32_bf16 v[212:215], a[236:239], v[92:95], v[212:215]
    v_exp_f32 v211, v211
    v_mfma_f32_16x16x32_bf16 a[40:43], a[176:179], v[176:179], a[40:43]
    ds_read_b64_tr_b16 a[160:161], v24 offset:49152
    v_cvt_pk_bf16_f32 v130, v208, v209
    v_mfma_f32_16x16x32_bf16 a[40:43], a[180:183], v[180:183], a[40:43]
    ds_read_b64_tr_b16 a[162:163], v24 offset:53248
    v_fmac_f32 v229, v2, v245
    v_mfma_f32_16x16x32_bf16 a[44:47], a[176:179], v[184:187], a[44:47]
    ds_read_b128 a[216:219], v10 offset:8192
    v_cvt_pk_bf16_f32 v131, v210, v211
    v_mfma_f32_16x16x32_bf16 a[44:47], a[180:183], v[188:191], a[44:47]
    s_waitcnt lgkmcnt(3)
    buffer_load_dwordx4 v41, s[12:15], s41 offen offset:1024 lds
    v_mfma_f32_16x16x32_bf16 v[208:211], a[224:227], v[96:99], v[200:203]
    v_exp_f32 v212, v212
    v_mfma_f32_16x16x32_bf16 v[208:211], a[228:231], v[100:103], v[208:211]
    v_exp_f32 v213, v213
    v_mfma_f32_16x16x32_bf16 v[208:211], a[232:235], v[104:107], v[208:211]
    v_exp_f32 v214, v214
    v_mfma_f32_16x16x32_bf16 v[208:211], a[236:239], v[108:111], v[208:211]
    v_exp_f32 v215, v215
    v_mfma_f32_16x16x32_bf16 a[48:51], a[184:187], v[160:163], a[48:51]
    ds_read_b64_tr_b16 a[164:165], v24 offset:57344
    v_cvt_pk_bf16_f32 v138, v212, v213
    v_mfma_f32_16x16x32_bf16 a[48:51], a[188:191], v[164:167], a[48:51]
    ds_read_b64_tr_b16 a[166:167], v24 offset:61440
    v_lshlrev_b32 v246, 16, v243
    v_mfma_f32_16x16x32_bf16 a[52:55], a[184:187], v[168:171], a[52:55]
    ds_read_b128 a[220:223], v11 offset:8192
    v_cvt_pk_bf16_f32 v139, v214, v215
    v_mfma_f32_16x16x32_bf16 a[52:55], a[188:191], v[172:175], a[52:55]
    v_and_b32 v247, 0xffff0000, v243
    v_fmac_f32 v230, v2, v246
    v_smfmac_f32_16x16x64_bf16 a[200:203], v[52:55], v[176:183], v50
    v_mfma_f32_16x16x32_bf16 v[212:215], a[224:227], v[112:115], v[204:207]
    v_exp_f32 v208, v208
    v_mfma_f32_16x16x32_bf16 v[212:215], a[228:231], v[116:119], v[212:215]
    v_exp_f32 v209, v209
    v_mfma_f32_16x16x32_bf16 v[212:215], a[232:235], v[120:123], v[212:215]
    v_exp_f32 v210, v210
    v_mfma_f32_16x16x32_bf16 v[212:215], a[236:239], v[124:127], v[212:215]
    v_exp_f32 v211, v211
    v_mfma_f32_16x16x32_bf16 a[56:59], a[184:187], v[176:179], a[56:59]
    ds_read_b64_tr_b16 a[168:169], v25 offset:49152
    v_cvt_pk_bf16_f32 v146, v208, v209
    v_mfma_f32_16x16x32_bf16 a[56:59], a[188:191], v[180:183], a[56:59]
    ds_read_b64_tr_b16 a[170:171], v25 offset:53248
    v_fmac_f32 v231, v2, v247
    v_mfma_f32_16x16x32_bf16 a[60:63], a[184:187], v[184:187], a[60:63]
    ds_read_b128 a[224:227], v8 offset:12288
    v_cvt_pk_bf16_f32 v147, v210, v211
    v_mfma_f32_16x16x32_bf16 a[60:63], a[188:191], v[188:191], a[60:63]
    s_waitcnt lgkmcnt(3)
    buffer_load_dwordx4 v40, s[12:15], s41 offen offset:2048 lds
    v_mfma_f32_16x16x32_bf16 v[208:211], a[208:211], v[64:67], v[192:195]
    v_exp_f32 v212, v212
    v_mfma_f32_16x16x32_bf16 v[208:211], a[212:215], v[68:71], v[208:211]
    v_exp_f32 v213, v213
    v_mfma_f32_16x16x32_bf16 v[208:211], a[216:219], v[72:75], v[208:211]
    v_exp_f32 v214, v214
    v_mfma_f32_16x16x32_bf16 v[208:211], a[220:223], v[76:79], v[208:211]
    v_exp_f32 v215, v215
    v_mfma_f32_16x16x32_bf16 a[64:67], a[160:163], v[160:163], a[64:67]
    ds_read_b64_tr_b16 a[172:173], v25 offset:57344
    v_cvt_pk_bf16_f32 v154, v212, v213
    v_mfma_f32_16x16x32_bf16 a[64:67], a[164:167], v[164:167], a[64:67]
    ds_read_b64_tr_b16 a[174:175], v25 offset:61440
    v_mov_b32 v2, v3
    v_mfma_f32_16x16x32_bf16 a[68:71], a[160:163], v[168:171], a[68:71]
    ds_read_b128 a[228:231], v9 offset:12288
    v_cvt_pk_bf16_f32 v155, v214, v215
    v_mfma_f32_16x16x32_bf16 a[68:71], a[164:167], v[172:175], a[68:71]
    v_mov_b32 v3, v4
    v_mov_b32 v4, v5
    v_smfmac_f32_16x16x64_bf16 a[204:207], v[52:55], v[184:191], v50
    v_mfma_f32_16x16x32_bf16 v[212:215], a[208:211], v[80:83], v[196:199]
    v_exp_f32 v208, v208
    v_mfma_f32_16x16x32_bf16 v[212:215], a[212:215], v[84:87], v[212:215]
    v_exp_f32 v209, v209
    v_mfma_f32_16x16x32_bf16 v[212:215], a[216:219], v[88:91], v[212:215]
    v_exp_f32 v210, v210
    v_mfma_f32_16x16x32_bf16 v[212:215], a[220:223], v[92:95], v[212:215]
    v_exp_f32 v211, v211
    v_mfma_f32_16x16x32_bf16 a[72:75], a[160:163], v[176:179], a[72:75]
    ds_read_b64_tr_b16 a[176:177], v26 offset:49152
    v_cvt_pk_bf16_f32 v132, v208, v209
    v_mfma_f32_16x16x32_bf16 a[72:75], a[164:167], v[180:183], a[72:75]
    ds_read_b64_tr_b16 a[178:179], v26 offset:53248
    v_mov_b32 v5, v6
    v_mfma_f32_16x16x32_bf16 a[76:79], a[160:163], v[184:187], a[76:79]
    ds_read_b128 a[232:235], v10 offset:12288
    v_cvt_pk_bf16_f32 v133, v210, v211
    v_mfma_f32_16x16x32_bf16 a[76:79], a[164:167], v[188:191], a[76:79]
    s_waitcnt lgkmcnt(3)
    buffer_load_dwordx4 v41, s[12:15], s41 offen offset:3072 lds
    v_mfma_f32_16x16x32_bf16 v[208:211], a[208:211], v[96:99], v[200:203]
    v_exp_f32 v212, v212
    v_mfma_f32_16x16x32_bf16 v[208:211], a[212:215], v[100:103], v[208:211]
    s_add_u32 s41, s41, 16384
    v_exp_f32 v213, v213
    v_mfma_f32_16x16x32_bf16 v[208:211], a[216:219], v[104:107], v[208:211]
    v_exp_f32 v214, v214
    v_mfma_f32_16x16x32_bf16 v[208:211], a[220:223], v[108:111], v[208:211]
    v_exp_f32 v215, v215
    v_mfma_f32_16x16x32_bf16 a[80:83], a[168:171], v[160:163], a[80:83]
    ds_read_b64_tr_b16 a[180:181], v26 offset:57344
    v_cvt_pk_bf16_f32 v140, v212, v213
    v_mfma_f32_16x16x32_bf16 a[80:83], a[172:175], v[164:167], a[80:83]
    ds_read_b64_tr_b16 a[182:183], v26 offset:61440
    v_mfma_f32_16x16x32_bf16 a[84:87], a[168:171], v[168:171], a[84:87]
    ds_read_b128 a[236:239], v11 offset:12288
    v_cvt_pk_bf16_f32 v141, v214, v215
    v_mfma_f32_16x16x32_bf16 a[84:87], a[172:175], v[172:175], a[84:87]
    s_waitcnt vmcnt(10)
    s_barrier
    v_mfma_f32_16x16x32_bf16 v[212:215], a[208:211], v[112:115], v[204:207]
    v_exp_f32 v208, v208
    v_mfma_f32_16x16x32_bf16 v[212:215], a[212:215], v[116:119], v[212:215]
    s_add_u32 m0, s42, 49152
    v_exp_f32 v209, v209
    v_mfma_f32_16x16x32_bf16 v[212:215], a[216:219], v[120:123], v[212:215]
    v_exp_f32 v210, v210
    v_mfma_f32_16x16x32_bf16 v[212:215], a[220:223], v[124:127], v[212:215]
    v_exp_f32 v211, v211
    v_mfma_f32_16x16x32_bf16 a[88:91], a[168:171], v[176:179], a[88:91]
    ds_read_b64_tr_b16 a[184:185], v27 offset:49152
    v_cvt_pk_bf16_f32 v148, v208, v209
    v_mfma_f32_16x16x32_bf16 a[88:91], a[172:175], v[180:183], a[88:91]
    ds_read_b64_tr_b16 a[186:187], v27 offset:53248
    v_mfma_f32_16x16x32_bf16 a[92:95], a[168:171], v[184:187], a[92:95]
    ds_read_b128 a[208:211], v8 offset:16384
    v_cvt_pk_bf16_f32 v149, v210, v211
    v_mfma_f32_16x16x32_bf16 a[92:95], a[172:175], v[188:191], a[92:95]
    s_waitcnt lgkmcnt(3)
    buffer_load_dwordx4 v36, s[8:11], s40 offen lds
    v_mfma_f32_16x16x32_bf16 v[208:211], a[224:227], v[64:67], v[192:195]
    v_exp_f32 v212, v212
    v_mfma_f32_16x16x32_bf16 v[208:211], a[228:231], v[68:71], v[208:211]
    v_exp_f32 v213, v213
    v_mfma_f32_16x16x32_bf16 v[208:211], a[232:235], v[72:75], v[208:211]
    v_exp_f32 v214, v214
    v_mfma_f32_16x16x32_bf16 v[208:211], a[236:239], v[76:79], v[208:211]
    v_exp_f32 v215, v215
    v_mfma_f32_16x16x32_bf16 a[96:99], a[176:179], v[160:163], a[96:99]
    ds_read_b64_tr_b16 a[188:189], v27 offset:57344
    v_cvt_pk_bf16_f32 v156, v212, v213
    v_mfma_f32_16x16x32_bf16 a[96:99], a[180:183], v[164:167], a[96:99]
    ds_read_b64_tr_b16 a[190:191], v27 offset:61440
    v_mfma_f32_16x16x32_bf16 a[100:103], a[176:179], v[168:171], a[100:103]
    ds_read_b128 a[212:215], v9 offset:16384
    v_cvt_pk_bf16_f32 v157, v214, v215
    v_mfma_f32_16x16x32_bf16 a[100:103], a[180:183], v[172:175], a[100:103]
    buffer_load_dword v216, v237, s[28:31], s52 offen
    v_mfma_f32_16x16x32_bf16 v[212:215], a[224:227], v[80:83], v[196:199]
    v_exp_f32 v208, v208
    v_mfma_f32_16x16x32_bf16 v[212:215], a[228:231], v[84:87], v[212:215]
    s_sub_u32 s39, s39, 36864
    v_exp_f32 v209, v209
    v_mfma_f32_16x16x32_bf16 v[212:215], a[232:235], v[88:91], v[212:215]
    s_sub_u32 s38, s38, 4608
    v_exp_f32 v210, v210
    v_mfma_f32_16x16x32_bf16 v[212:215], a[236:239], v[92:95], v[212:215]
    s_add_u32 s52, s52, 2304
    v_exp_f32 v211, v211
    v_mfma_f32_16x16x32_bf16 a[104:107], a[176:179], v[176:179], a[104:107]
    ds_read_b64_tr_b16 a[160:161], v20 offset:0
    v_cvt_pk_bf16_f32 v134, v208, v209
    v_mfma_f32_16x16x32_bf16 a[104:107], a[180:183], v[180:183], a[104:107]
    ds_read_b64_tr_b16 a[162:163], v20 offset:4096
    v_mfma_f32_16x16x32_bf16 a[108:111], a[176:179], v[184:187], a[108:111]
    ds_read_b128 a[216:219], v10 offset:16384
    v_cvt_pk_bf16_f32 v135, v210, v211
    v_mfma_f32_16x16x32_bf16 a[108:111], a[180:183], v[188:191], a[108:111]
    s_waitcnt lgkmcnt(3)
    buffer_load_dwordx4 v37, s[8:11], s40 offen offset:1024 lds
    v_mfma_f32_16x16x32_bf16 v[208:211], a[224:227], v[96:99], v[200:203]
    v_exp_f32 v212, v212
    v_mfma_f32_16x16x32_bf16 v[208:211], a[228:231], v[100:103], v[208:211]
    v_exp_f32 v213, v213
    v_mfma_f32_16x16x32_bf16 v[208:211], a[232:235], v[104:107], v[208:211]
    v_exp_f32 v214, v214
    v_mfma_f32_16x16x32_bf16 v[208:211], a[236:239], v[108:111], v[208:211]
    v_exp_f32 v215, v215
    v_mfma_f32_16x16x32_bf16 a[112:115], a[184:187], v[160:163], a[112:115]
    ds_read_b64_tr_b16 a[164:165], v20 offset:8192
    v_cvt_pk_bf16_f32 v142, v212, v213
    v_mfma_f32_16x16x32_bf16 a[112:115], a[188:191], v[164:167], a[112:115]
    ds_read_b64_tr_b16 a[166:167], v20 offset:12288
    v_mfma_f32_16x16x32_bf16 a[116:119], a[184:187], v[168:171], a[116:119]
    ds_read_b128 a[220:223], v11 offset:16384
    v_cvt_pk_bf16_f32 v143, v214, v215
    v_mfma_f32_16x16x32_bf16 a[116:119], a[188:191], v[172:175], a[116:119]
    v_mfma_f32_16x16x32_bf16 v[212:215], a[224:227], v[112:115], v[204:207]
    v_exp_f32 v208, v208
    v_mfma_f32_16x16x32_bf16 v[212:215], a[228:231], v[116:119], v[212:215]
    v_exp_f32 v209, v209
    v_mfma_f32_16x16x32_bf16 v[212:215], a[232:235], v[120:123], v[212:215]
    v_exp_f32 v210, v210
    v_mfma_f32_16x16x32_bf16 v[212:215], a[236:239], v[124:127], v[212:215]
    v_exp_f32 v211, v211
    v_mfma_f32_16x16x32_bf16 a[120:123], a[184:187], v[176:179], a[120:123]
    ds_read_b64_tr_b16 a[168:169], v21 offset:0
    v_cvt_pk_bf16_f32 v150, v208, v209
    v_mfma_f32_16x16x32_bf16 a[120:123], a[188:191], v[180:183], a[120:123]
    ds_read_b64_tr_b16 a[170:171], v21 offset:4096
    v_mfma_f32_16x16x32_bf16 a[124:127], a[184:187], v[184:187], a[124:127]
    ds_read_b128 a[224:227], v8 offset:20480
    v_cvt_pk_bf16_f32 v151, v210, v211
    v_mfma_f32_16x16x32_bf16 a[124:127], a[188:191], v[188:191], a[124:127]
    s_waitcnt lgkmcnt(3)
    buffer_load_dwordx4 v38, s[8:11], s40 offen offset:2048 lds
    s_sub_u32 s43, s43, 1
    s_cmp_lg_u32 s43, 0
    s_cbranch_scc1 Lattn_loop
    v_mfma_f32_16x16x32_bf16 v[208:211], a[208:211], v[64:67], v[192:195]
    s_lshl_b32 s38, s3, 6
    v_exp_f32 v212, v212
    v_mfma_f32_16x16x32_bf16 v[208:211], a[212:215], v[68:71], v[208:211]
    s_add_u32 s38, s38, 131136
    v_exp_f32 v213, v213
    v_mfma_f32_16x16x32_bf16 v[208:211], a[216:219], v[72:75], v[208:211]
    v_exp_f32 v214, v214
    v_mfma_f32_16x16x32_bf16 v[208:211], a[220:223], v[76:79], v[208:211]
    s_add_u32 s57, s58, 0
    v_exp_f32 v215, v215
    v_mfma_f32_16x16x32_bf16 a[0:3], a[160:163], v[128:131], a[0:3]
    ds_read_b64_tr_b16 a[172:173], v21 offset:8192
    v_cvt_pk_bf16_f32 v158, v212, v213
    v_mfma_f32_16x16x32_bf16 a[0:3], a[164:167], v[132:135], a[0:3]
    ds_read_b64_tr_b16 a[174:175], v21 offset:12288
    v_permlane32_swap_b32 v224, v228
    v_mfma_f32_16x16x32_bf16 a[4:7], a[160:163], v[136:139], a[4:7]
    ds_read_b128 a[228:231], v9 offset:20480
    v_cvt_pk_bf16_f32 v159, v214, v215
    v_mfma_f32_16x16x32_bf16 a[4:7], a[164:167], v[140:143], a[4:7]
    buffer_load_dwordx4 a[128:131], v254, s[80:83], s57 offen
    v_mfma_f32_16x16x32_bf16 v[212:215], a[208:211], v[80:83], v[196:199]
    v_exp_f32 v208, v208
    v_mfma_f32_16x16x32_bf16 v[212:215], a[212:215], v[84:87], v[212:215]
    v_exp_f32 v209, v209
    v_mfma_f32_16x16x32_bf16 v[212:215], a[216:219], v[88:91], v[212:215]
    v_exp_f32 v210, v210
    v_mfma_f32_16x16x32_bf16 v[212:215], a[220:223], v[92:95], v[212:215]
    v_exp_f32 v211, v211
    v_mfma_f32_16x16x32_bf16 a[8:11], a[160:163], v[144:147], a[8:11]
    ds_read_b64_tr_b16 a[176:177], v22 offset:0
    v_cvt_pk_bf16_f32 v160, v208, v209
    v_mfma_f32_16x16x32_bf16 a[8:11], a[164:167], v[148:151], a[8:11]
    ds_read_b64_tr_b16 a[178:179], v22 offset:4096
    v_permlane32_swap_b32 v225, v229
    v_mfma_f32_16x16x32_bf16 a[12:15], a[160:163], v[152:155], a[12:15]
    ds_read_b128 a[232:235], v10 offset:20480
    v_cvt_pk_bf16_f32 v161, v210, v211
    v_mfma_f32_16x16x32_bf16 a[12:15], a[164:167], v[156:159], a[12:15]
    s_waitcnt lgkmcnt(3)
    buffer_load_dwordx4 v39, s[8:11], s40 offen offset:3072 lds
    v_mfma_f32_16x16x32_bf16 v[208:211], a[208:211], v[96:99], v[200:203]
    v_exp_f32 v212, v212
    v_mfma_f32_16x16x32_bf16 v[208:211], a[212:215], v[100:103], v[208:211]
    s_add_u32 s40, s40, 16384
    v_exp_f32 v213, v213
    v_mfma_f32_16x16x32_bf16 v[208:211], a[216:219], v[104:107], v[208:211]
    v_exp_f32 v214, v214
    v_mfma_f32_16x16x32_bf16 v[208:211], a[220:223], v[108:111], v[208:211]
    v_exp_f32 v215, v215
    v_mfma_f32_16x16x32_bf16 a[16:19], a[168:171], v[128:131], a[16:19]
    ds_read_b64_tr_b16 a[180:181], v22 offset:8192
    v_cvt_pk_bf16_f32 v168, v212, v213
    v_mfma_f32_16x16x32_bf16 a[16:19], a[172:175], v[132:135], a[16:19]
    ds_read_b64_tr_b16 a[182:183], v22 offset:12288
    v_permlane32_swap_b32 v226, v230
    v_mfma_f32_16x16x32_bf16 a[20:23], a[168:171], v[136:139], a[20:23]
    ds_read_b128 a[236:239], v11 offset:20480
    v_cvt_pk_bf16_f32 v169, v214, v215
    v_mfma_f32_16x16x32_bf16 a[20:23], a[172:175], v[140:143], a[20:23]
    v_permlane32_swap_b32 v227, v231
    v_add_f32 v224, v224, v228
    v_smfmac_f32_16x16x64_bf16 a[192:195], v[52:55], v[128:135], v50
    v_mfma_f32_16x16x32_bf16 v[212:215], a[208:211], v[112:115], v[204:207]
    v_exp_f32 v208, v208
    v_mfma_f32_16x16x32_bf16 v[212:215], a[212:215], v[116:119], v[212:215]
    s_add_u32 m0, s42, 98304
    v_exp_f32 v209, v209
    v_mfma_f32_16x16x32_bf16 v[212:215], a[216:219], v[120:123], v[212:215]
    v_exp_f32 v210, v210
    v_mfma_f32_16x16x32_bf16 v[212:215], a[220:223], v[124:127], v[212:215]
    v_exp_f32 v211, v211
    v_mfma_f32_16x16x32_bf16 a[24:27], a[168:171], v[144:147], a[24:27]
    ds_read_b64_tr_b16 a[184:185], v23 offset:0
    v_cvt_pk_bf16_f32 v176, v208, v209
    v_mfma_f32_16x16x32_bf16 a[24:27], a[172:175], v[148:151], a[24:27]
    ds_read_b64_tr_b16 a[186:187], v23 offset:4096
    v_add_f32 v225, v225, v229
    v_mfma_f32_16x16x32_bf16 a[28:31], a[168:171], v[152:155], a[28:31]
    ds_read_b128 a[208:211], v8 offset:24576
    v_cvt_pk_bf16_f32 v177, v210, v211
    v_mfma_f32_16x16x32_bf16 a[28:31], a[172:175], v[156:159], a[28:31]
    s_waitcnt lgkmcnt(3)
    buffer_load_dwordx4 v40, s[12:15], s41 offen lds
    v_mfma_f32_16x16x32_bf16 v[208:211], a[224:227], v[64:67], v[192:195]
    v_exp_f32 v212, v212
    v_mfma_f32_16x16x32_bf16 v[208:211], a[228:231], v[68:71], v[208:211]
    v_exp_f32 v213, v213
    v_mfma_f32_16x16x32_bf16 v[208:211], a[232:235], v[72:75], v[208:211]
    v_exp_f32 v214, v214
    v_mfma_f32_16x16x32_bf16 v[208:211], a[236:239], v[76:79], v[208:211]
    s_add_u32 s57, s58, 589824
    v_exp_f32 v215, v215
    v_mfma_f32_16x16x32_bf16 a[32:35], a[176:179], v[128:131], a[32:35]
    ds_read_b64_tr_b16 a[188:189], v23 offset:8192
    v_cvt_pk_bf16_f32 v184, v212, v213
    v_mfma_f32_16x16x32_bf16 a[32:35], a[180:183], v[132:135], a[32:35]
    ds_read_b64_tr_b16 a[190:191], v23 offset:12288
    v_add_f32 v226, v226, v230
    v_mfma_f32_16x16x32_bf16 a[36:39], a[176:179], v[136:139], a[36:39]
    ds_read_b128 a[212:215], v9 offset:24576
    v_cvt_pk_bf16_f32 v185, v214, v215
    v_mfma_f32_16x16x32_bf16 a[36:39], a[180:183], v[140:143], a[36:39]
    buffer_load_dwordx4 a[132:135], v254, s[80:83], s57 offen
    v_smfmac_f32_16x16x64_bf16 a[196:199], v[52:55], v[136:143], v50
    v_mfma_f32_16x16x32_bf16 v[212:215], a[224:227], v[80:83], v[196:199]
    v_exp_f32 v208, v208
    v_mfma_f32_16x16x32_bf16 v[212:215], a[228:231], v[84:87], v[212:215]
    v_exp_f32 v209, v209
    v_mfma_f32_16x16x32_bf16 v[212:215], a[232:235], v[88:91], v[212:215]
    v_exp_f32 v210, v210
    v_mfma_f32_16x16x32_bf16 v[212:215], a[236:239], v[92:95], v[212:215]
    v_exp_f32 v211, v211
    v_mfma_f32_16x16x32_bf16 a[40:43], a[176:179], v[144:147], a[40:43]
    ds_read_b64_tr_b16 a[160:161], v24 offset:0
    v_cvt_pk_bf16_f32 v162, v208, v209
    v_mfma_f32_16x16x32_bf16 a[40:43], a[180:183], v[148:151], a[40:43]
    ds_read_b64_tr_b16 a[162:163], v24 offset:4096
    v_add_f32 v227, v227, v231
    v_mfma_f32_16x16x32_bf16 a[44:47], a[176:179], v[152:155], a[44:47]
    ds_read_b128 a[216:219], v10 offset:24576
    v_cvt_pk_bf16_f32 v163, v210, v211
    v_mfma_f32_16x16x32_bf16 a[44:47], a[180:183], v[156:159], a[44:47]
    s_waitcnt lgkmcnt(3)
    buffer_load_dwordx4 v41, s[12:15], s41 offen offset:1024 lds
    v_mfma_f32_16x16x32_bf16 v[208:211], a[224:227], v[96:99], v[200:203]
    v_exp_f32 v212, v212
    v_mfma_f32_16x16x32_bf16 v[208:211], a[228:231], v[100:103], v[208:211]
    v_exp_f32 v213, v213
    v_mfma_f32_16x16x32_bf16 v[208:211], a[232:235], v[104:107], v[208:211]
    v_exp_f32 v214, v214
    v_mfma_f32_16x16x32_bf16 v[208:211], a[236:239], v[108:111], v[208:211]
    v_exp_f32 v215, v215
    v_mfma_f32_16x16x32_bf16 a[48:51], a[184:187], v[128:131], a[48:51]
    ds_read_b64_tr_b16 a[164:165], v24 offset:8192
    v_cvt_pk_bf16_f32 v170, v212, v213
    v_mfma_f32_16x16x32_bf16 a[48:51], a[188:191], v[132:135], a[48:51]
    ds_read_b64_tr_b16 a[166:167], v24 offset:12288
    v_and_b32 v244, 1, v1
    v_mfma_f32_16x16x32_bf16 a[52:55], a[184:187], v[136:139], a[52:55]
    ds_read_b128 a[220:223], v11 offset:24576
    v_cvt_pk_bf16_f32 v171, v214, v215
    v_mfma_f32_16x16x32_bf16 a[52:55], a[188:191], v[140:143], a[52:55]
    s_waitcnt vmcnt(15)
    buffer_load_dword v221, v236, s[20:23], 0 offen
    v_smfmac_f32_16x16x64_bf16 a[200:203], v[52:55], v[144:151], v50
    v_mfma_f32_16x16x32_bf16 v[212:215], a[224:227], v[112:115], v[204:207]
    v_exp_f32 v208, v208
    v_mfma_f32_16x16x32_bf16 v[212:215], a[228:231], v[116:119], v[212:215]
    v_exp_f32 v209, v209
    v_mfma_f32_16x16x32_bf16 v[212:215], a[232:235], v[120:123], v[212:215]
    v_exp_f32 v210, v210
    v_mfma_f32_16x16x32_bf16 v[212:215], a[236:239], v[124:127], v[212:215]
    v_exp_f32 v211, v211
    v_mfma_f32_16x16x32_bf16 a[56:59], a[184:187], v[144:147], a[56:59]
    ds_read_b64_tr_b16 a[168:169], v25 offset:0
    v_cvt_pk_bf16_f32 v178, v208, v209
    v_mfma_f32_16x16x32_bf16 a[56:59], a[188:191], v[148:151], a[56:59]
    ds_read_b64_tr_b16 a[170:171], v25 offset:4096
    v_permlane16_swap_b32 v224, v226
    v_mfma_f32_16x16x32_bf16 a[60:63], a[184:187], v[152:155], a[60:63]
    ds_read_b128 a[224:227], v8 offset:28672
    v_cvt_pk_bf16_f32 v179, v210, v211
    v_mfma_f32_16x16x32_bf16 a[60:63], a[188:191], v[156:159], a[60:63]
    s_waitcnt lgkmcnt(3)
    buffer_load_dwordx4 v40, s[12:15], s41 offen offset:2048 lds
    v_mfma_f32_16x16x32_bf16 v[208:211], a[208:211], v[64:67], v[192:195]
    v_exp_f32 v212, v212
    v_mfma_f32_16x16x32_bf16 v[208:211], a[212:215], v[68:71], v[208:211]
    v_exp_f32 v213, v213
    v_mfma_f32_16x16x32_bf16 v[208:211], a[216:219], v[72:75], v[208:211]
    v_exp_f32 v214, v214
    v_mfma_f32_16x16x32_bf16 v[208:211], a[220:223], v[76:79], v[208:211]
    s_add_u32 s57, s58, 1179648
    v_exp_f32 v215, v215
    v_mfma_f32_16x16x32_bf16 a[64:67], a[160:163], v[128:131], a[64:67]
    ds_read_b64_tr_b16 a[172:173], v25 offset:8192
    v_cvt_pk_bf16_f32 v186, v212, v213
    v_mfma_f32_16x16x32_bf16 a[64:67], a[164:167], v[132:135], a[64:67]
    ds_read_b64_tr_b16 a[174:175], v25 offset:12288
    v_permlane16_swap_b32 v225, v227
    v_mfma_f32_16x16x32_bf16 a[68:71], a[160:163], v[136:139], a[68:71]
    ds_read_b128 a[228:231], v9 offset:28672
    v_cvt_pk_bf16_f32 v187, v214, v215
    v_mfma_f32_16x16x32_bf16 a[68:71], a[164:167], v[140:143], a[68:71]
    buffer_load_dwordx4 a[136:139], v254, s[80:83], s57 offen
    v_smfmac_f32_16x16x64_bf16 a[204:207], v[52:55], v[152:159], v50
    v_mfma_f32_16x16x32_bf16 v[212:215], a[208:211], v[80:83], v[196:199]
    v_exp_f32 v208, v208
    v_mfma_f32_16x16x32_bf16 v[212:215], a[212:215], v[84:87], v[212:215]
    v_exp_f32 v209, v209
    v_mfma_f32_16x16x32_bf16 v[212:215], a[216:219], v[88:91], v[212:215]
    v_exp_f32 v210, v210
    v_mfma_f32_16x16x32_bf16 v[212:215], a[220:223], v[92:95], v[212:215]
    v_exp_f32 v211, v211
    v_mfma_f32_16x16x32_bf16 a[72:75], a[160:163], v[144:147], a[72:75]
    ds_read_b64_tr_b16 a[176:177], v26 offset:0
    v_cvt_pk_bf16_f32 v164, v208, v209
    v_mfma_f32_16x16x32_bf16 a[72:75], a[164:167], v[148:151], a[72:75]
    ds_read_b64_tr_b16 a[178:179], v26 offset:4096
    v_lshlrev_b32 v244, 5, v244
    v_mfma_f32_16x16x32_bf16 a[76:79], a[160:163], v[152:155], a[76:79]
    ds_read_b128 a[232:235], v10 offset:28672
    v_cvt_pk_bf16_f32 v165, v210, v211
    v_mfma_f32_16x16x32_bf16 a[76:79], a[164:167], v[156:159], a[76:79]
    s_waitcnt lgkmcnt(3)
    buffer_load_dwordx4 v41, s[12:15], s41 offen offset:3072 lds
    v_mfma_f32_16x16x32_bf16 v[208:211], a[208:211], v[96:99], v[200:203]
    v_exp_f32 v212, v212
    v_mfma_f32_16x16x32_bf16 v[208:211], a[212:215], v[100:103], v[208:211]
    s_add_u32 s41, s41, 16384
    v_exp_f32 v213, v213
    v_mfma_f32_16x16x32_bf16 v[208:211], a[216:219], v[104:107], v[208:211]
    v_exp_f32 v214, v214
    v_mfma_f32_16x16x32_bf16 v[208:211], a[220:223], v[108:111], v[208:211]
    v_exp_f32 v215, v215
    v_mfma_f32_16x16x32_bf16 a[80:83], a[168:171], v[128:131], a[80:83]
    ds_read_b64_tr_b16 a[180:181], v26 offset:8192
    v_cvt_pk_bf16_f32 v172, v212, v213
    v_mfma_f32_16x16x32_bf16 a[80:83], a[172:175], v[132:135], a[80:83]
    ds_read_b64_tr_b16 a[182:183], v26 offset:12288
    v_add_f32 v224, v224, v226
    v_mfma_f32_16x16x32_bf16 a[84:87], a[168:171], v[136:139], a[84:87]
    ds_read_b128 a[236:239], v11 offset:28672
    v_cvt_pk_bf16_f32 v173, v214, v215
    v_mfma_f32_16x16x32_bf16 a[84:87], a[172:175], v[140:143], a[84:87]
    s_waitcnt vmcnt(13)
    s_barrier
    v_mfma_f32_16x16x32_bf16 v[212:215], a[208:211], v[112:115], v[204:207]
    v_exp_f32 v208, v208
    v_mfma_f32_16x16x32_bf16 v[212:215], a[212:215], v[116:119], v[212:215]
    s_add_u32 s49, s45, 1024
    v_exp_f32 v209, v209
    v_mfma_f32_16x16x32_bf16 v[212:215], a[216:219], v[120:123], v[212:215]
    s_add_u32 m0, s42, 0
    v_exp_f32 v210, v210
    v_mfma_f32_16x16x32_bf16 v[212:215], a[220:223], v[124:127], v[212:215]
    v_exp_f32 v211, v211
    v_mfma_f32_16x16x32_bf16 a[88:91], a[168:171], v[144:147], a[88:91]
    ds_read_b64_tr_b16 a[184:185], v27 offset:0
    v_cvt_pk_bf16_f32 v180, v208, v209
    v_mfma_f32_16x16x32_bf16 a[88:91], a[172:175], v[148:151], a[88:91]
    ds_read_b64_tr_b16 a[186:187], v27 offset:4096
    v_add_f32 v225, v225, v227
    v_mfma_f32_16x16x32_bf16 a[92:95], a[168:171], v[152:155], a[92:95]
    ds_read_b128 a[208:211], v8 offset:32768
    v_cvt_pk_bf16_f32 v181, v210, v211
    v_mfma_f32_16x16x32_bf16 a[92:95], a[172:175], v[156:159], a[92:95]
    s_waitcnt lgkmcnt(3)
    buffer_load_dwordx4 v46, s[20:23], s49 offen lds
    v_mfma_f32_16x16x32_bf16 v[208:211], a[224:227], v[64:67], v[192:195]
    v_exp_f32 v212, v212
    v_mfma_f32_16x16x32_bf16 v[208:211], a[228:231], v[68:71], v[208:211]
    v_exp_f32 v213, v213
    v_mfma_f32_16x16x32_bf16 v[208:211], a[232:235], v[72:75], v[208:211]
Ltour6:
    s_cbranch_execz Ltour10
    v_exp_f32 v214, v214
    v_mfma_f32_16x16x32_bf16 v[208:211], a[236:239], v[76:79], v[208:211]
    s_add_u32 s37, s55, 0
    v_exp_f32 v215, v215
    v_mfma_f32_16x16x32_bf16 a[96:99], a[176:179], v[128:131], a[96:99]
    ds_read_b64_tr_b16 a[188:189], v27 offset:8192
    v_cvt_pk_bf16_f32 v188, v212, v213
    v_mfma_f32_16x16x32_bf16 a[96:99], a[180:183], v[132:135], a[96:99]
    ds_read_b64_tr_b16 a[190:191], v27 offset:12288
    v_lshrrev_b32 v245, 4, v1
    v_mfma_f32_16x16x32_bf16 a[100:103], a[176:179], v[136:139], a[100:103]
    ds_read_b128 a[212:215], v9 offset:32768
    v_cvt_pk_bf16_f32 v189, v214, v215
    v_mfma_f32_16x16x32_bf16 a[100:103], a[180:183], v[140:143], a[100:103]
    buffer_load_dword v239, v238, s[28:31], s37 offen
    v_mfma_f32_16x16x32_bf16 v[212:215], a[224:227], v[80:83], v[196:199]
    v_exp_f32 v208, v208
    v_mfma_f32_16x16x32_bf16 v[212:215], a[228:231], v[84:87], v[212:215]
    v_exp_f32 v209, v209
    v_mfma_f32_16x16x32_bf16 v[212:215], a[232:235], v[88:91], v[212:215]
    v_exp_f32 v210, v210
    v_mfma_f32_16x16x32_bf16 v[212:215], a[236:239], v[92:95], v[212:215]
    v_exp_f32 v211, v211
    v_mfma_f32_16x16x32_bf16 a[104:107], a[176:179], v[144:147], a[104:107]
    ds_read_b64_tr_b16 a[160:161], v20 offset:16384
    v_cvt_pk_bf16_f32 v166, v208, v209
    v_mfma_f32_16x16x32_bf16 a[104:107], a[180:183], v[148:151], a[104:107]
    ds_read_b64_tr_b16 a[162:163], v20 offset:20480
    v_lshl_add_u32 v244, v245, 3, v244
    v_mfma_f32_16x16x32_bf16 a[108:111], a[176:179], v[152:155], a[108:111]
    ds_read_b128 a[216:219], v10 offset:32768
    v_cvt_pk_bf16_f32 v167, v210, v211
    v_mfma_f32_16x16x32_bf16 a[108:111], a[180:183], v[156:159], a[108:111]
    s_waitcnt lgkmcnt(3)
    buffer_load_dwordx4 v47, s[20:23], s49 offen offset:1024 lds
    v_mfma_f32_16x16x32_bf16 v[208:211], a[224:227], v[96:99], v[200:203]
    v_exp_f32 v212, v212
    v_mfma_f32_16x16x32_bf16 v[208:211], a[228:231], v[100:103], v[208:211]
    v_exp_f32 v213, v213
    v_mfma_f32_16x16x32_bf16 v[208:211], a[232:235], v[104:107], v[208:211]
    v_exp_f32 v214, v214
    v_mfma_f32_16x16x32_bf16 v[208:211], a[236:239], v[108:111], v[208:211]
    s_add_u32 s57, s58, 1769472
    v_exp_f32 v215, v215
    v_mfma_f32_16x16x32_bf16 a[112:115], a[184:187], v[128:131], a[112:115]
    ds_read_b64_tr_b16 a[164:165], v20 offset:24576
    v_cvt_pk_bf16_f32 v174, v212, v213
    v_mfma_f32_16x16x32_bf16 a[112:115], a[188:191], v[132:135], a[112:115]
    ds_read_b64_tr_b16 a[166:167], v20 offset:28672
    v_mfma_f32_16x16x32_bf16 a[116:119], a[184:187], v[136:139], a[116:119]
    ds_read_b128 a[220:223], v11 offset:32768
    v_cvt_pk_bf16_f32 v175, v214, v215
    v_mfma_f32_16x16x32_bf16 a[116:119], a[188:191], v[140:143], a[116:119]
    buffer_load_dwordx4 a[140:143], v254, s[80:83], s57 offen
    v_mfma_f32_16x16x32_bf16 v[212:215], a[224:227], v[112:115], v[204:207]
    v_exp_f32 v208, v208
    v_mfma_f32_16x16x32_bf16 v[212:215], a[228:231], v[116:119], v[212:215]
    v_exp_f32 v209, v209
    v_mfma_f32_16x16x32_bf16 v[212:215], a[232:235], v[120:123], v[212:215]
    v_exp_f32 v210, v210
    v_mfma_f32_16x16x32_bf16 v[212:215], a[236:239], v[124:127], v[212:215]
    v_exp_f32 v211, v211
    v_mfma_f32_16x16x32_bf16 a[120:123], a[184:187], v[144:147], a[120:123]
    ds_read_b64_tr_b16 a[168:169], v21 offset:16384
    v_cvt_pk_bf16_f32 v182, v208, v209
    v_mfma_f32_16x16x32_bf16 a[120:123], a[188:191], v[148:151], a[120:123]
    ds_read_b64_tr_b16 a[170:171], v21 offset:20480
    v_mfma_f32_16x16x32_bf16 a[124:127], a[184:187], v[152:155], a[124:127]
    ds_read_b128 a[224:227], v8 offset:36864
    v_cvt_pk_bf16_f32 v183, v210, v211
    v_mfma_f32_16x16x32_bf16 a[124:127], a[188:191], v[156:159], a[124:127]
    s_waitcnt lgkmcnt(3)
    buffer_load_dwordx4 v48, s[20:23], s49 offen offset:2048 lds
    v_mfma_f32_16x16x32_bf16 v[208:211], a[208:211], v[64:67], v[192:195]
    v_exp_f32 v212, v212
    v_mfma_f32_16x16x32_bf16 v[208:211], a[212:215], v[68:71], v[208:211]
    v_exp_f32 v213, v213
    v_mfma_f32_16x16x32_bf16 v[208:211], a[216:219], v[72:75], v[208:211]
    v_exp_f32 v214, v214
    v_mfma_f32_16x16x32_bf16 v[208:211], a[220:223], v[76:79], v[208:211]
    s_add_u32 s57, s58, 2359296
    v_exp_f32 v215, v215
    v_mfma_f32_16x16x32_bf16 a[0:3], a[160:163], v[160:163], a[0:3]
    ds_read_b64_tr_b16 a[172:173], v21 offset:24576
    v_cvt_pk_bf16_f32 v190, v212, v213
    v_mfma_f32_16x16x32_bf16 a[0:3], a[164:167], v[164:167], a[0:3]
    ds_read_b64_tr_b16 a[174:175], v21 offset:28672
    v_mov_b32 v63, 0
    v_mfma_f32_16x16x32_bf16 a[4:7], a[160:163], v[168:171], a[4:7]
    ds_read_b128 a[228:231], v9 offset:36864
    v_cvt_pk_bf16_f32 v191, v214, v215
    v_mfma_f32_16x16x32_bf16 a[4:7], a[164:167], v[172:175], a[4:7]
    buffer_load_dwordx4 a[144:147], v254, s[80:83], s57 offen
    v_mfma_f32_16x16x32_bf16 v[212:215], a[208:211], v[80:83], v[196:199]
    v_exp_f32 v208, v208
    v_mfma_f32_16x16x32_bf16 v[212:215], a[212:215], v[84:87], v[212:215]
    v_exp_f32 v209, v209
    v_mfma_f32_16x16x32_bf16 v[212:215], a[216:219], v[88:91], v[212:215]
    v_exp_f32 v210, v210
    v_mfma_f32_16x16x32_bf16 v[212:215], a[220:223], v[92:95], v[212:215]
    v_exp_f32 v211, v211
    v_mfma_f32_16x16x32_bf16 a[8:11], a[160:163], v[176:179], a[8:11]
    ds_read_b64_tr_b16 a[176:177], v22 offset:16384
    v_cvt_pk_bf16_f32 v128, v208, v209
    v_mfma_f32_16x16x32_bf16 a[8:11], a[164:167], v[180:183], a[8:11]
    ds_read_b64_tr_b16 a[178:179], v22 offset:20480
    v_add_f32_dpp v224, v224, v224 row_ror:2 row_mask:0xf bank_mask:0xf
    v_mfma_f32_16x16x32_bf16 a[12:15], a[160:163], v[184:187], a[12:15]
    ds_read_b128 a[232:235], v10 offset:36864
    v_cvt_pk_bf16_f32 v129, v210, v211
    v_mfma_f32_16x16x32_bf16 a[12:15], a[164:167], v[188:191], a[12:15]
    s_waitcnt lgkmcnt(3)
    buffer_load_dwordx4 v49, s[20:23], s49 offen offset:3072 lds
    v_mfma_f32_16x16x32_bf16 v[208:211], a[208:211], v[96:99], v[200:203]
    s_lshr_b32 s39, s2, 5
    v_exp_f32 v212, v212
    v_mfma_f32_16x16x32_bf16 v[208:211], a[212:215], v[100:103], v[208:211]
    s_lshl_b32 s39, s39, 3
    v_exp_f32 v213, v213
    v_mfma_f32_16x16x32_bf16 v[208:211], a[216:219], v[104:107], v[208:211]
    s_and_b32 s43, s2, 7
    v_exp_f32 v214, v214
    v_mfma_f32_16x16x32_bf16 v[208:211], a[220:223], v[108:111], v[208:211]
    s_add_u32 s39, s39, s43
    v_exp_f32 v215, v215
    v_mfma_f32_16x16x32_bf16 a[16:19], a[168:171], v[160:163], a[16:19]
    ds_read_b64_tr_b16 a[180:181], v22 offset:24576
    v_cvt_pk_bf16_f32 v136, v212, v213
    v_mfma_f32_16x16x32_bf16 a[16:19], a[172:175], v[164:167], a[16:19]
    ds_read_b64_tr_b16 a[182:183], v22 offset:28672
    v_add_f32_dpp v225, v225, v225 row_ror:2 row_mask:0xf bank_mask:0xf
    v_mfma_f32_16x16x32_bf16 a[20:23], a[168:171], v[168:171], a[20:23]
    ds_read_b128 a[236:239], v11 offset:36864
    v_cvt_pk_bf16_f32 v137, v214, v215
    v_mfma_f32_16x16x32_bf16 a[20:23], a[172:175], v[172:175], a[20:23]
    buffer_load_dword v253, v63, s[24:27], s54 offen offset:12 sc1
    v_smfmac_f32_16x16x64_bf16 a[192:195], v[52:55], v[160:167], v50
    v_mfma_f32_16x16x32_bf16 v[212:215], a[208:211], v[112:115], v[204:207]
    s_lshl_b32 s39, s39, 2
    v_exp_f32 v208, v208
    v_mfma_f32_16x16x32_bf16 v[212:215], a[212:215], v[116:119], v[212:215]
    s_add_u32 m0, s42, 114688
    v_exp_f32 v209, v209
    v_mfma_f32_16x16x32_bf16 v[212:215], a[216:219], v[120:123], v[212:215]
    s_bfe_u32 s43, s2, 0x20003
    v_exp_f32 v210, v210
    v_mfma_f32_16x16x32_bf16 v[212:215], a[220:223], v[124:127], v[212:215]
    s_add_u32 s39, s39, s43
    v_exp_f32 v211, v211
    v_mfma_f32_16x16x32_bf16 a[24:27], a[168:171], v[176:179], a[24:27]
    ds_read_b64_tr_b16 a[184:185], v23 offset:16384
    v_cvt_pk_bf16_f32 v144, v208, v209
    v_mfma_f32_16x16x32_bf16 a[24:27], a[172:175], v[180:183], a[24:27]
    ds_read_b64_tr_b16 a[186:187], v23 offset:20480
    v_add_f32_dpp v224, v224, v224 row_ror:4 row_mask:0xf bank_mask:0xf
    v_mfma_f32_16x16x32_bf16 a[28:31], a[168:171], v[184:187], a[28:31]
    ds_read_b128 a[208:211], v8 offset:40960
    v_cvt_pk_bf16_f32 v145, v210, v211
    v_mfma_f32_16x16x32_bf16 a[28:31], a[172:175], v[188:191], a[28:31]
    s_waitcnt lgkmcnt(3)
    buffer_load_dwordx4 v40, s[12:15], s41 offen lds
    v_mfma_f32_16x16x32_bf16 v[208:211], a[224:227], v[64:67], v[192:195]
    s_add_u32 s39, s39, 72
    v_exp_f32 v212, v212
    v_mfma_f32_16x16x32_bf16 v[208:211], a[228:231], v[68:71], v[208:211]
    s_cmp_lt_u32 s39, 216
    s_cselect_b32 s43, 0, 2147483648
    v_exp_f32 v213, v213
    v_mfma_f32_16x16x32_bf16 v[208:211], a[232:235], v[72:75], v[208:211]
    s_or_b32 s43, s43, s48
    v_exp_f32 v214, v214
    v_mfma_f32_16x16x32_bf16 v[208:211], a[236:239], v[76:79], v[208:211]
    s_add_u32 s57, s58, 2949120
    v_exp_f32 v215, v215
    v_mfma_f32_16x16x32_bf16 a[32:35], a[176:179], v[160:163], a[32:35]
    ds_read_b64_tr_b16 a[188:189], v23 offset:24576
    v_cvt_pk_bf16_f32 v152, v212, v213
    v_mfma_f32_16x16x32_bf16 a[32:35], a[180:183], v[164:167], a[32:35]
    ds_read_b64_tr_b16 a[190:191], v23 offset:28672
    v_add_f32_dpp v225, v225, v225 row_ror:4 row_mask:0xf bank_mask:0xf
    v_mfma_f32_16x16x32_bf16 a[36:39], a[176:179], v[168:171], a[36:39]
    ds_read_b128 a[212:215], v9 offset:40960
    v_cvt_pk_bf16_f32 v153, v214, v215
    v_mfma_f32_16x16x32_bf16 a[36:39], a[180:183], v[172:175], a[36:39]
    buffer_load_dwordx4 a[148:151], v254, s[80:83], s57 offen
    v_smfmac_f32_16x16x64_bf16 a[196:199], v[52:55], v[168:175], v50
    v_mfma_f32_16x16x32_bf16 v[212:215], a[224:227], v[80:83], v[196:199]
    s_and_b32 s43, s43, 2147483648
    v_exp_f32 v208, v208
    v_mfma_f32_16x16x32_bf16 v[212:215], a[228:231], v[84:87], v[212:215]
    s_sub_u32 s36, s39, 144
    v_exp_f32 v209, v209
    v_mfma_f32_16x16x32_bf16 v[212:215], a[232:235], v[88:91], v[212:215]
    s_cmp_lt_u32 s36, 36
    s_cselect_b32 s36, 1.0, 0
    v_exp_f32 v210, v210
    v_mfma_f32_16x16x32_bf16 v[212:215], a[236:239], v[92:95], v[212:215]
    s_lshr_b32 s44, s39, 1
    v_exp_f32 v211, v211
    v_mfma_f32_16x16x32_bf16 a[40:43], a[176:179], v[176:179], a[40:43]
    ds_read_b64_tr_b16 a[160:161], v24 offset:16384
    v_cvt_pk_bf16_f32 v130, v208, v209
    v_mfma_f32_16x16x32_bf16 a[40:43], a[180:183], v[180:183], a[40:43]
    ds_read_b64_tr_b16 a[162:163], v24 offset:20480
    v_add_f32_dpp v224, v224, v224 row_ror:8 row_mask:0xf bank_mask:0xf
    v_mfma_f32_16x16x32_bf16 a[44:47], a[176:179], v[184:187], a[44:47]
    ds_read_b128 a[216:219], v10 offset:40960
    v_cvt_pk_bf16_f32 v131, v210, v211
    v_mfma_f32_16x16x32_bf16 a[44:47], a[180:183], v[188:191], a[44:47]
    s_waitcnt lgkmcnt(3)
    buffer_load_dwordx4 v41, s[12:15], s41 offen offset:1024 lds
    v_mfma_f32_16x16x32_bf16 v[208:211], a[224:227], v[96:99], v[200:203]
    s_lshl_b32 s44, s44, 6
    v_exp_f32 v212, v212
    v_mfma_f32_16x16x32_bf16 v[208:211], a[228:231], v[100:103], v[208:211]
    s_and_b32 s39, s39, 1
    v_exp_f32 v213, v213
    v_mfma_f32_16x16x32_bf16 v[208:211], a[232:235], v[104:107], v[208:211]
    s_lshl_b32 s39, s39, 3
    v_exp_f32 v214, v214
    v_mfma_f32_16x16x32_bf16 v[208:211], a[236:239], v[108:111], v[208:211]
    s_add_u32 s39, s39, s44
    v_exp_f32 v215, v215
    v_mfma_f32_16x16x32_bf16 a[48:51], a[184:187], v[160:163], a[48:51]
    ds_read_b64_tr_b16 a[164:165], v24 offset:24576
    v_cvt_pk_bf16_f32 v138, v212, v213
    v_mfma_f32_16x16x32_bf16 a[48:51], a[188:191], v[164:167], a[48:51]
    ds_read_b64_tr_b16 a[166:167], v24 offset:28672
    v_add_f32_dpp v225, v225, v225 row_ror:8 row_mask:0xf bank_mask:0xf
    v_mfma_f32_16x16x32_bf16 a[52:55], a[184:187], v[168:171], a[52:55]
    ds_read_b128 a[220:223], v11 offset:40960
    v_cvt_pk_bf16_f32 v139, v214, v215
    v_mfma_f32_16x16x32_bf16 a[52:55], a[188:191], v[172:175], a[52:55]
    v_add_u32 v244, s38, v244
    v_and_b32 v245, 7, v1
    v_smfmac_f32_16x16x64_bf16 a[200:203], v[52:55], v[176:183], v50
    v_mfma_f32_16x16x32_bf16 v[212:215], a[224:227], v[112:115], v[204:207]
    s_add_u32 s39, s39, 16384
    v_exp_f32 v208, v208
    v_mfma_f32_16x16x32_bf16 v[212:215], a[228:231], v[116:119], v[212:215]
    s_or_b32 s39, s39, s43
    v_exp_f32 v209, v209
    v_mfma_f32_16x16x32_bf16 v[212:215], a[232:235], v[120:123], v[212:215]
    v_exp_f32 v210, v210
    v_mfma_f32_16x16x32_bf16 v[212:215], a[236:239], v[124:127], v[212:215]
    v_exp_f32 v211, v211
    v_mfma_f32_16x16x32_bf16 a[56:59], a[184:187], v[176:179], a[56:59]
    ds_read_b64_tr_b16 a[168:169], v25 offset:16384
    v_cvt_pk_bf16_f32 v146, v208, v209
    v_mfma_f32_16x16x32_bf16 a[56:59], a[188:191], v[180:183], a[56:59]
    ds_read_b64_tr_b16 a[170:171], v25 offset:20480
    v_mfma_f32_16x16x32_bf16 a[60:63], a[184:187], v[184:187], a[60:63]
    ds_read_b128 a[224:227], v8 offset:45056
    v_cvt_pk_bf16_f32 v147, v210, v211
    v_mfma_f32_16x16x32_bf16 a[60:63], a[188:191], v[188:191], a[60:63]
    s_waitcnt lgkmcnt(3)
    buffer_load_dwordx4 v40, s[12:15], s41 offen offset:2048 lds
    v_mfma_f32_16x16x32_bf16 v[208:211], a[208:211], v[64:67], v[192:195]
    v_exp_f32 v212, v212
    v_mfma_f32_16x16x32_bf16 v[208:211], a[212:215], v[68:71], v[208:211]
    v_exp_f32 v213, v213
    v_mfma_f32_16x16x32_bf16 v[208:211], a[216:219], v[72:75], v[208:211]
    v_exp_f32 v214, v214
    v_mfma_f32_16x16x32_bf16 v[208:211], a[220:223], v[76:79], v[208:211]
    s_add_u32 s57, s58, 3538944
    v_exp_f32 v215, v215
    v_mfma_f32_16x16x32_bf16 a[64:67], a[160:163], v[160:163], a[64:67]
    ds_read_b64_tr_b16 a[172:173], v25 offset:24576
    v_cvt_pk_bf16_f32 v154, v212, v213
    v_mfma_f32_16x16x32_bf16 a[64:67], a[164:167], v[164:167], a[64:67]
    ds_read_b64_tr_b16 a[174:175], v25 offset:28672
    v_lshlrev_b32 v245, 3, v245
    v_mfma_f32_16x16x32_bf16 a[68:71], a[160:163], v[168:171], a[68:71]
    ds_read_b128 a[228:231], v9 offset:45056
    v_cvt_pk_bf16_f32 v155, v214, v215
    v_mfma_f32_16x16x32_bf16 a[68:71], a[164:167], v[172:175], a[68:71]
    buffer_load_dwordx4 a[152:155], v254, s[80:83], s57 offen
    v_smfmac_f32_16x16x64_bf16 a[204:207], v[52:55], v[184:191], v50
    ds_write_b64 v244, v[224:225]
    v_mfma_f32_16x16x32_bf16 v[212:215], a[208:211], v[80:83], v[196:199]
    v_exp_f32 v208, v208
    v_mfma_f32_16x16x32_bf16 v[212:215], a[212:215], v[84:87], v[212:215]
    v_exp_f32 v209, v209
    v_mfma_f32_16x16x32_bf16 v[212:215], a[216:219], v[88:91], v[212:215]
    v_exp_f32 v210, v210
    v_mfma_f32_16x16x32_bf16 v[212:215], a[220:223], v[92:95], v[212:215]
    v_exp_f32 v211, v211
    v_mfma_f32_16x16x32_bf16 a[72:75], a[160:163], v[176:179], a[72:75]
    ds_read_b64_tr_b16 a[176:177], v26 offset:16384
    v_cvt_pk_bf16_f32 v132, v208, v209
    v_mfma_f32_16x16x32_bf16 a[72:75], a[164:167], v[180:183], a[72:75]
    ds_read_b64_tr_b16 a[178:179], v26 offset:20480
    v_add_u32 v245, 131136, v245
    v_mfma_f32_16x16x32_bf16 a[76:79], a[160:163], v[184:187], a[76:79]
    ds_read_b128 a[232:235], v10 offset:45056
    v_cvt_pk_bf16_f32 v133, v210, v211
    v_mfma_f32_16x16x32_bf16 a[76:79], a[164:167], v[188:191], a[76:79]
    s_waitcnt lgkmcnt(3)
    buffer_load_dwordx4 v41, s[12:15], s41 offen offset:3072 lds
    v_mfma_f32_16x16x32_bf16 v[208:211], a[208:211], v[96:99], v[200:203]
    v_exp_f32 v212, v212
    v_mfma_f32_16x16x32_bf16 v[208:211], a[212:215], v[100:103], v[208:211]
    s_add_u32 s41, s41, 16384
    v_exp_f32 v213, v213
    v_mfma_f32_16x16x32_bf16 v[208:211], a[216:219], v[104:107], v[208:211]
    v_exp_f32 v214, v214
    v_mfma_f32_16x16x32_bf16 v[208:211], a[220:223], v[108:111], v[208:211]
    v_exp_f32 v215, v215
    v_mfma_f32_16x16x32_bf16 a[80:83], a[168:171], v[160:163], a[80:83]
    ds_read_b64_tr_b16 a[180:181], v26 offset:24576
    v_cvt_pk_bf16_f32 v140, v212, v213
    v_mfma_f32_16x16x32_bf16 a[80:83], a[172:175], v[164:167], a[80:83]
    ds_read_b64_tr_b16 a[182:183], v26 offset:28672
    v_mfma_f32_16x16x32_bf16 a[84:87], a[168:171], v[168:171], a[84:87]
    ds_read_b128 a[236:239], v11 offset:45056
    v_cvt_pk_bf16_f32 v141, v214, v215
    v_mfma_f32_16x16x32_bf16 a[84:87], a[172:175], v[172:175], a[84:87]
    s_waitcnt vmcnt(14)
    s_barrier
    v_mfma_f32_16x16x32_bf16 v[212:215], a[208:211], v[112:115], v[204:207]
    v_exp_f32 v208, v208
    v_mfma_f32_16x16x32_bf16 v[212:215], a[212:215], v[116:119], v[212:215]
    s_add_u32 s49, s45, 74752
    v_exp_f32 v209, v209
    v_mfma_f32_16x16x32_bf16 v[212:215], a[216:219], v[120:123], v[212:215]
    s_add_u32 m0, s42, 16384
    v_exp_f32 v210, v210
    v_mfma_f32_16x16x32_bf16 v[212:215], a[220:223], v[124:127], v[212:215]
    v_exp_f32 v211, v211
    v_mfma_f32_16x16x32_bf16 a[88:91], a[168:171], v[176:179], a[88:91]
    ds_read_b64_tr_b16 a[184:185], v27 offset:16384
    v_cvt_pk_bf16_f32 v148, v208, v209
    v_mfma_f32_16x16x32_bf16 a[88:91], a[172:175], v[180:183], a[88:91]
    ds_read_b64_tr_b16 a[186:187], v27 offset:20480
    ds_read_b64 v[224:225], v245 offset:0
    v_mfma_f32_16x16x32_bf16 a[92:95], a[168:171], v[184:187], a[92:95]
    ds_read_b128 a[208:211], v8 offset:49152
    v_cvt_pk_bf16_f32 v149, v210, v211
    v_mfma_f32_16x16x32_bf16 a[92:95], a[172:175], v[188:191], a[92:95]
    s_waitcnt lgkmcnt(3)
    buffer_load_dwordx4 v46, s[20:23], s49 offen lds
    v_mfma_f32_16x16x32_bf16 v[208:211], a[224:227], v[64:67], v[192:195]
    v_exp_f32 v212, v212
    v_mfma_f32_16x16x32_bf16 v[208:211], a[228:231], v[68:71], v[208:211]
    v_exp_f32 v213, v213
    v_mfma_f32_16x16x32_bf16 v[208:211], a[232:235], v[72:75], v[208:211]
    v_exp_f32 v214, v214
    v_mfma_f32_16x16x32_bf16 v[208:211], a[236:239], v[76:79], v[208:211]
    s_add_u32 s37, s55, 8192
    v_exp_f32 v215, v215
    v_mfma_f32_16x16x32_bf16 a[96:99], a[176:179], v[160:163], a[96:99]
    ds_read_b64_tr_b16 a[188:189], v27 offset:24576
    v_cvt_pk_bf16_f32 v156, v212, v213
    v_mfma_f32_16x16x32_bf16 a[96:99], a[180:183], v[164:167], a[96:99]
    ds_read_b64_tr_b16 a[190:191], v27 offset:28672
    ds_read_b64 v[226:227], v245 offset:64
    v_mfma_f32_16x16x32_bf16 a[100:103], a[176:179], v[168:171], a[100:103]
    ds_read_b128 a[212:215], v9 offset:49152
    v_cvt_pk_bf16_f32 v157, v214, v215
    v_mfma_f32_16x16x32_bf16 a[100:103], a[180:183], v[172:175], a[100:103]
    buffer_load_dword v234, v238, s[28:31], s37 offen
    v_mfma_f32_16x16x32_bf16 v[212:215], a[224:227], v[80:83], v[196:199]
    v_exp_f32 v208, v208
    v_mfma_f32_16x16x32_bf16 v[212:215], a[228:231], v[84:87], v[212:215]
    v_exp_f32 v209, v209
    v_mfma_f32_16x16x32_bf16 v[212:215], a[232:235], v[88:91], v[212:215]
    v_exp_f32 v210, v210
    v_mfma_f32_16x16x32_bf16 v[212:215], a[236:239], v[92:95], v[212:215]
    v_exp_f32 v211, v211
    v_mfma_f32_16x16x32_bf16 a[104:107], a[176:179], v[176:179], a[104:107]
    ds_read_b64_tr_b16 a[160:161], v20 offset:32768
    v_cvt_pk_bf16_f32 v134, v208, v209
    v_mfma_f32_16x16x32_bf16 a[104:107], a[180:183], v[180:183], a[104:107]
    ds_read_b64_tr_b16 a[162:163], v20 offset:36864
    ds_read_b64 v[228:229], v245 offset:128
    v_mfma_f32_16x16x32_bf16 a[108:111], a[176:179], v[184:187], a[108:111]
    ds_read_b128 a[216:219], v10 offset:49152
    v_cvt_pk_bf16_f32 v135, v210, v211
    v_mfma_f32_16x16x32_bf16 a[108:111], a[180:183], v[188:191], a[108:111]
    s_waitcnt lgkmcnt(3)
    buffer_load_dwordx4 v47, s[20:23], s49 offen offset:1024 lds
    v_mfma_f32_16x16x32_bf16 v[208:211], a[224:227], v[96:99], v[200:203]
    v_exp_f32 v212, v212
    v_mfma_f32_16x16x32_bf16 v[208:211], a[228:231], v[100:103], v[208:211]
    v_exp_f32 v213, v213
    v_mfma_f32_16x16x32_bf16 v[208:211], a[232:235], v[104:107], v[208:211]
    v_exp_f32 v214, v214
    v_mfma_f32_16x16x32_bf16 v[208:211], a[236:239], v[108:111], v[208:211]
    s_add_u32 s57, s58, 4128768
    v_exp_f32 v215, v215
    v_mfma_f32_16x16x32_bf16 a[112:115], a[184:187], v[160:163], a[112:115]
    ds_read_b64_tr_b16 a[164:165], v20 offset:40960
    v_cvt_pk_bf16_f32 v142, v212, v213
    v_mfma_f32_16x16x32_bf16 a[112:115], a[188:191], v[164:167], a[112:115]
    ds_read_b64_tr_b16 a[166:167], v20 offset:45056
    ds_read_b64 v[230:231], v245 offset:192
    v_mfma_f32_16x16x32_bf16 a[116:119], a[184:187], v[168:171], a[116:119]
    ds_read_b128 a[220:223], v11 offset:49152
    v_cvt_pk_bf16_f32 v143, v214, v215
    v_mfma_f32_16x16x32_bf16 a[116:119], a[188:191], v[172:175], a[116:119]
    buffer_load_dwordx4 a[156:159], v254, s[80:83], s57 offen
    v_mfma_f32_16x16x32_bf16 v[212:215], a[224:227], v[112:115], v[204:207]
    v_exp_f32 v208, v208
    v_mfma_f32_16x16x32_bf16 v[212:215], a[228:231], v[116:119], v[212:215]
    v_exp_f32 v209, v209
    v_mfma_f32_16x16x32_bf16 v[212:215], a[232:235], v[120:123], v[212:215]
    v_exp_f32 v210, v210
    v_mfma_f32_16x16x32_bf16 v[212:215], a[236:239], v[124:127], v[212:215]
    v_exp_f32 v211, v211
    v_mfma_f32_16x16x32_bf16 a[120:123], a[184:187], v[176:179], a[120:123]
    ds_read_b64_tr_b16 a[168:169], v21 offset:32768
    v_cvt_pk_bf16_f32 v150, v208, v209
    v_mfma_f32_16x16x32_bf16 a[120:123], a[188:191], v[180:183], a[120:123]
    ds_read_b64_tr_b16 a[170:171], v21 offset:36864
    v_mfma_f32_16x16x32_bf16 a[124:127], a[184:187], v[184:187], a[124:127]
    ds_read_b128 a[224:227], v8 offset:53248
    v_cvt_pk_bf16_f32 v151, v210, v211
    v_mfma_f32_16x16x32_bf16 a[124:127], a[188:191], v[188:191], a[124:127]
    s_waitcnt lgkmcnt(3)
    buffer_load_dwordx4 v48, s[20:23], s49 offen offset:2048 lds
    v_mfma_f32_16x16x32_bf16 v[208:211], a[208:211], v[64:67], v[192:195]
    v_exp_f32 v212, v212
    v_mfma_f32_16x16x32_bf16 v[208:211], a[212:215], v[68:71], v[208:211]
    v_exp_f32 v213, v213
    v_mfma_f32_16x16x32_bf16 v[208:211], a[216:219], v[72:75], v[208:211]
    v_exp_f32 v214, v214
    v_mfma_f32_16x16x32_bf16 v[208:211], a[220:223], v[76:79], v[208:211]
    s_add_u32 s57, s58, 4718592
    v_exp_f32 v215, v215
    v_mfma_f32_16x16x32_bf16 a[0:3], a[160:163], v[128:131], a[0:3]
    ds_read_b64_tr_b16 a[172:173], v21 offset:40960
    v_cvt_pk_bf16_f32 v158, v212, v213
    v_mfma_f32_16x16x32_bf16 a[0:3], a[164:167], v[132:135], a[0:3]
    ds_read_b64_tr_b16 a[174:175], v21 offset:45056
    v_add_f32 v224, v224, v228
    v_mfma_f32_16x16x32_bf16 a[4:7], a[160:163], v[136:139], a[4:7]
    ds_read_b128 a[228:231], v9 offset:53248
    v_cvt_pk_bf16_f32 v159, v214, v215
    v_mfma_f32_16x16x32_bf16 a[4:7], a[164:167], v[140:143], a[4:7]
    buffer_load_dwordx4 a[240:243], v254, s[80:83], s57 offen
    v_mfma_f32_16x16x32_bf16 v[212:215], a[208:211], v[80:83], v[196:199]
    v_exp_f32 v208, v208
    v_mfma_f32_16x16x32_bf16 v[212:215], a[212:215], v[84:87], v[212:215]
    v_exp_f32 v209, v209
    v_mfma_f32_16x16x32_bf16 v[212:215], a[216:219], v[88:91], v[212:215]
    v_exp_f32 v210, v210
    v_mfma_f32_16x16x32_bf16 v[212:215], a[220:223], v[92:95], v[212:215]
    v_exp_f32 v211, v211
    v_mfma_f32_16x16x32_bf16 a[8:11], a[160:163], v[144:147], a[8:11]
    ds_read_b64_tr_b16 a[176:177], v22 offset:32768
    v_cvt_pk_bf16_f32 v160, v208, v209
    v_mfma_f32_16x16x32_bf16 a[8:11], a[164:167], v[148:151], a[8:11]
    ds_read_b64_tr_b16 a[178:179], v22 offset:36864
    v_add_f32 v225, v225, v229
    v_mfma_f32_16x16x32_bf16 a[12:15], a[160:163], v[152:155], a[12:15]
    ds_read_b128 a[232:235], v10 offset:53248
    v_cvt_pk_bf16_f32 v161, v210, v211
    v_mfma_f32_16x16x32_bf16 a[12:15], a[164:167], v[156:159], a[12:15]
    s_waitcnt lgkmcnt(3)
    buffer_load_dwordx4 v49, s[20:23], s49 offen offset:3072 lds
    v_mfma_f32_16x16x32_bf16 v[208:211], a[208:211], v[96:99], v[200:203]
    v_exp_f32 v212, v212
    v_mfma_f32_16x16x32_bf16 v[208:211], a[212:215], v[100:103], v[208:211]
    v_exp_f32 v213, v213
    v_mfma_f32_16x16x32_bf16 v[208:211], a[216:219], v[104:107], v[208:211]
    v_exp_f32 v214, v214
    v_mfma_f32_16x16x32_bf16 v[208:211], a[220:223], v[108:111], v[208:211]
    v_exp_f32 v215, v215
    v_mfma_f32_16x16x32_bf16 a[16:19], a[168:171], v[128:131], a[16:19]
    ds_read_b64_tr_b16 a[180:181], v22 offset:40960
    v_cvt_pk_bf16_f32 v168, v212, v213
    v_mfma_f32_16x16x32_bf16 a[16:19], a[172:175], v[132:135], a[16:19]
    ds_read_b64_tr_b16 a[182:183], v22 offset:45056
    v_add_f32 v226, v226, v230
    v_mfma_f32_16x16x32_bf16 a[20:23], a[168:171], v[136:139], a[20:23]
    ds_read_b128 a[236:239], v11 offset:53248
    v_cvt_pk_bf16_f32 v169, v214, v215
    v_mfma_f32_16x16x32_bf16 a[20:23], a[172:175], v[140:143], a[20:23]
    v_add_f32 v227, v227, v231
    v_add_f32 v224, v224, v226
    v_smfmac_f32_16x16x64_bf16 a[192:195], v[52:55], v[128:135], v50
    v_mfma_f32_16x16x32_bf16 v[212:215], a[208:211], v[112:115], v[204:207]
    v_exp_f32 v208, v208
    v_mfma_f32_16x16x32_bf16 v[212:215], a[212:215], v[116:119], v[212:215]
    s_add_u32 s49, s7, 0
    v_exp_f32 v209, v209
    v_mfma_f32_16x16x32_bf16 v[212:215], a[216:219], v[120:123], v[212:215]
    s_add_u32 m0, s42, 65536
    v_exp_f32 v210, v210
    v_mfma_f32_16x16x32_bf16 v[212:215], a[220:223], v[124:127], v[212:215]
    v_exp_f32 v211, v211
    v_mfma_f32_16x16x32_bf16 a[24:27], a[168:171], v[144:147], a[24:27]
    ds_read_b64_tr_b16 a[184:185], v23 offset:32768
    v_cvt_pk_bf16_f32 v176, v208, v209
    v_mfma_f32_16x16x32_bf16 a[24:27], a[172:175], v[148:151], a[24:27]
    ds_read_b64_tr_b16 a[186:187], v23 offset:36864
    v_add_f32 v225, v225, v227
    v_mfma_f32_16x16x32_bf16 a[28:31], a[168:171], v[152:155], a[28:31]
    ds_read_b128 a[208:211], v8 offset:57344
    v_cvt_pk_bf16_f32 v177, v210, v211
    v_mfma_f32_16x16x32_bf16 a[28:31], a[172:175], v[156:159], a[28:31]
    s_waitcnt lgkmcnt(3)
    buffer_load_dwordx4 v46, s[20:23], s49 offen lds
    v_mfma_f32_16x16x32_bf16 v[208:211], a[224:227], v[64:67], v[192:195]
    v_exp_f32 v212, v212
    v_mfma_f32_16x16x32_bf16 v[208:211], a[228:231], v[68:71], v[208:211]
    v_exp_f32 v213, v213
    v_mfma_f32_16x16x32_bf16 v[208:211], a[232:235], v[72:75], v[208:211]
    v_exp_f32 v214, v214
    v_mfma_f32_16x16x32_bf16 v[208:211], a[236:239], v[76:79], v[208:211]
    s_add_u32 s57, s58, 4128768
    v_exp_f32 v215, v215
    v_mfma_f32_16x16x32_bf16 a[32:35], a[176:179], v[128:131], a[32:35]
    ds_read_b64_tr_b16 a[188:189], v23 offset:40960
    v_cvt_pk_bf16_f32 v184, v212, v213
    v_mfma_f32_16x16x32_bf16 a[32:35], a[180:183], v[132:135], a[32:35]
    ds_read_b64_tr_b16 a[190:191], v23 offset:45056
    v_cvt_pk_bf16_f32 v246, v224, v225
    v_mfma_f32_16x16x32_bf16 a[36:39], a[176:179], v[136:139], a[36:39]
    ds_read_b128 a[212:215], v9 offset:57344
    v_cvt_pk_bf16_f32 v185, v214, v215
    v_mfma_f32_16x16x32_bf16 a[36:39], a[180:183], v[140:143], a[36:39]
    buffer_load_dwordx4 a[244:247], v254, s[32:35], s57 offen
    v_smfmac_f32_16x16x64_bf16 a[196:199], v[52:55], v[136:143], v50
    v_mfma_f32_16x16x32_bf16 v[212:215], a[224:227], v[80:83], v[196:199]
    v_exp_f32 v208, v208
    v_mfma_f32_16x16x32_bf16 v[212:215], a[228:231], v[84:87], v[212:215]
    v_exp_f32 v209, v209
    v_mfma_f32_16x16x32_bf16 v[212:215], a[232:235], v[88:91], v[212:215]
    v_exp_f32 v210, v210
    v_mfma_f32_16x16x32_bf16 v[212:215], a[236:239], v[92:95], v[212:215]
    v_exp_f32 v211, v211
    v_mfma_f32_16x16x32_bf16 a[40:43], a[176:179], v[144:147], a[40:43]
    ds_read_b64_tr_b16 a[160:161], v24 offset:32768
    v_cvt_pk_bf16_f32 v162, v208, v209
    v_mfma_f32_16x16x32_bf16 a[40:43], a[180:183], v[148:151], a[40:43]
    ds_read_b64_tr_b16 a[162:163], v24 offset:36864
    v_lshlrev_b32 v224, 16, v246
    v_mfma_f32_16x16x32_bf16 a[44:47], a[176:179], v[152:155], a[44:47]
    ds_read_b128 a[216:219], v10 offset:57344
    v_cvt_pk_bf16_f32 v163, v210, v211
    v_mfma_f32_16x16x32_bf16 a[44:47], a[180:183], v[156:159], a[44:47]
    s_waitcnt lgkmcnt(3)
    buffer_load_dwordx4 v47, s[20:23], s49 offen offset:1024 lds
    v_mfma_f32_16x16x32_bf16 v[208:211], a[224:227], v[96:99], v[200:203]
    v_exp_f32 v212, v212
    v_mfma_f32_16x16x32_bf16 v[208:211], a[228:231], v[100:103], v[208:211]
    v_exp_f32 v213, v213
    v_mfma_f32_16x16x32_bf16 v[208:211], a[232:235], v[104:107], v[208:211]
    v_exp_f32 v214, v214
    v_mfma_f32_16x16x32_bf16 v[208:211], a[236:239], v[108:111], v[208:211]
    v_exp_f32 v215, v215
    v_mfma_f32_16x16x32_bf16 a[48:51], a[184:187], v[128:131], a[48:51]
    ds_read_b64_tr_b16 a[164:165], v24 offset:40960
    v_cvt_pk_bf16_f32 v170, v212, v213
    v_mfma_f32_16x16x32_bf16 a[48:51], a[188:191], v[132:135], a[48:51]
    ds_read_b64_tr_b16 a[166:167], v24 offset:45056
    v_and_b32 v225, 0xffff0000, v246
    v_mfma_f32_16x16x32_bf16 a[52:55], a[184:187], v[136:139], a[52:55]
    ds_read_b128 a[220:223], v11 offset:57344
    v_cvt_pk_bf16_f32 v171, v214, v215
    v_mfma_f32_16x16x32_bf16 a[52:55], a[188:191], v[140:143], a[52:55]
    v_add_f32 v224, s36, v224
    v_add_f32 v225, s36, v225
    v_smfmac_f32_16x16x64_bf16 a[200:203], v[52:55], v[144:151], v50
    v_mfma_f32_16x16x32_bf16 v[212:215], a[224:227], v[112:115], v[204:207]
    v_exp_f32 v208, v208
    v_mfma_f32_16x16x32_bf16 v[212:215], a[228:231], v[116:119], v[212:215]
    v_exp_f32 v209, v209
    v_mfma_f32_16x16x32_bf16 v[212:215], a[232:235], v[120:123], v[212:215]
    v_exp_f32 v210, v210
    v_mfma_f32_16x16x32_bf16 v[212:215], a[236:239], v[124:127], v[212:215]
    v_exp_f32 v211, v211
    v_mfma_f32_16x16x32_bf16 a[56:59], a[184:187], v[144:147], a[56:59]
    ds_read_b64_tr_b16 a[168:169], v25 offset:32768
    v_cvt_pk_bf16_f32 v178, v208, v209
    v_mfma_f32_16x16x32_bf16 a[56:59], a[188:191], v[148:151], a[56:59]
    ds_read_b64_tr_b16 a[170:171], v25 offset:36864
    v_cvt_pk_bf16_f32 v246, v224, v225
    v_mfma_f32_16x16x32_bf16 a[60:63], a[184:187], v[152:155], a[60:63]
    ds_read_b128 a[224:227], v8 offset:61440
    v_cvt_pk_bf16_f32 v179, v210, v211
    v_mfma_f32_16x16x32_bf16 a[60:63], a[188:191], v[156:159], a[60:63]
    s_waitcnt lgkmcnt(3)
    buffer_load_dwordx4 v48, s[20:23], s49 offen offset:2048 lds
    v_mfma_f32_16x16x32_bf16 v[208:211], a[208:211], v[64:67], v[192:195]
    v_exp_f32 v212, v212
    v_mfma_f32_16x16x32_bf16 v[208:211], a[212:215], v[68:71], v[208:211]
    v_exp_f32 v213, v213
    v_mfma_f32_16x16x32_bf16 v[208:211], a[216:219], v[72:75], v[208:211]
    v_exp_f32 v214, v214
    v_mfma_f32_16x16x32_bf16 v[208:211], a[220:223], v[76:79], v[208:211]
    s_add_u32 s57, s58, 4718592
    v_exp_f32 v215, v215
    v_mfma_f32_16x16x32_bf16 a[64:67], a[160:163], v[128:131], a[64:67]
Ltour7:
    s_cbranch_execz Ltour11
    ds_read_b64_tr_b16 a[172:173], v25 offset:40960
    v_cvt_pk_bf16_f32 v186, v212, v213
    v_mfma_f32_16x16x32_bf16 a[64:67], a[164:167], v[132:135], a[64:67]
    ds_read_b64_tr_b16 a[174:175], v25 offset:45056
    v_lshrrev_b32 v244, 1, v0
    v_mfma_f32_16x16x32_bf16 a[68:71], a[160:163], v[136:139], a[68:71]
    ds_read_b128 a[228:231], v9 offset:61440
    v_cvt_pk_bf16_f32 v187, v214, v215
    v_mfma_f32_16x16x32_bf16 a[68:71], a[164:167], v[140:143], a[68:71]
    buffer_load_dwordx4 a[248:251], v254, s[32:35], s57 offen
    v_smfmac_f32_16x16x64_bf16 a[204:207], v[52:55], v[152:159], v50
    v_mfma_f32_16x16x32_bf16 v[212:215], a[208:211], v[80:83], v[196:199]
    v_exp_f32 v208, v208
    v_mfma_f32_16x16x32_bf16 v[212:215], a[212:215], v[84:87], v[212:215]
    v_exp_f32 v209, v209
    v_mfma_f32_16x16x32_bf16 v[212:215], a[216:219], v[88:91], v[212:215]
    v_exp_f32 v210, v210
    v_mfma_f32_16x16x32_bf16 v[212:215], a[220:223], v[92:95], v[212:215]
    v_exp_f32 v211, v211
    v_mfma_f32_16x16x32_bf16 a[72:75], a[160:163], v[144:147], a[72:75]
    ds_read_b64_tr_b16 a[176:177], v26 offset:32768
    v_cvt_pk_bf16_f32 v164, v208, v209
    v_mfma_f32_16x16x32_bf16 a[72:75], a[164:167], v[148:151], a[72:75]
    ds_read_b64_tr_b16 a[178:179], v26 offset:36864
    v_lshlrev_b32 v244, 4, v244
    v_mfma_f32_16x16x32_bf16 a[76:79], a[160:163], v[152:155], a[76:79]
    ds_read_b128 a[232:235], v10 offset:61440
    v_cvt_pk_bf16_f32 v165, v210, v211
    v_mfma_f32_16x16x32_bf16 a[76:79], a[164:167], v[156:159], a[76:79]
    s_waitcnt lgkmcnt(3)
    buffer_load_dwordx4 v49, s[20:23], s49 offen offset:3072 lds
    v_mfma_f32_16x16x32_bf16 v[208:211], a[208:211], v[96:99], v[200:203]
    v_exp_f32 v212, v212
    v_mfma_f32_16x16x32_bf16 v[208:211], a[212:215], v[100:103], v[208:211]
    v_exp_f32 v213, v213
    v_mfma_f32_16x16x32_bf16 v[208:211], a[216:219], v[104:107], v[208:211]
    v_exp_f32 v214, v214
    v_mfma_f32_16x16x32_bf16 v[208:211], a[220:223], v[108:111], v[208:211]
    v_exp_f32 v215, v215
    v_mfma_f32_16x16x32_bf16 a[80:83], a[168:171], v[128:131], a[80:83]
    ds_read_b64_tr_b16 a[180:181], v26 offset:40960
    v_cvt_pk_bf16_f32 v172, v212, v213
    v_mfma_f32_16x16x32_bf16 a[80:83], a[172:175], v[132:135], a[80:83]
    ds_read_b64_tr_b16 a[182:183], v26 offset:45056
    v_and_b32 v245, 1, v0
    v_mfma_f32_16x16x32_bf16 a[84:87], a[168:171], v[136:139], a[84:87]
    ds_read_b128 a[236:239], v11 offset:61440
    v_cvt_pk_bf16_f32 v173, v214, v215
    v_mfma_f32_16x16x32_bf16 a[84:87], a[172:175], v[140:143], a[84:87]
    s_waitcnt vmcnt(13)
    s_barrier
    v_mfma_f32_16x16x32_bf16 v[212:215], a[208:211], v[112:115], v[204:207]
    v_exp_f32 v208, v208
    v_mfma_f32_16x16x32_bf16 v[212:215], a[212:215], v[116:119], v[212:215]
    s_add_u32 s49, s7, 73728
    v_exp_f32 v209, v209
    v_mfma_f32_16x16x32_bf16 v[212:215], a[216:219], v[120:123], v[212:215]
    s_add_u32 m0, s42, 81920
    v_exp_f32 v210, v210
    v_mfma_f32_16x16x32_bf16 v[212:215], a[220:223], v[124:127], v[212:215]
    v_exp_f32 v211, v211
    v_mfma_f32_16x16x32_bf16 a[88:91], a[168:171], v[144:147], a[88:91]
    ds_read_b64_tr_b16 a[184:185], v27 offset:32768
    v_cvt_pk_bf16_f32 v180, v208, v209
    v_mfma_f32_16x16x32_bf16 a[88:91], a[172:175], v[148:151], a[88:91]
    ds_read_b64_tr_b16 a[186:187], v27 offset:36864
    v_lshl_add_u32 v244, v245, 2, v244
    v_mfma_f32_16x16x32_bf16 a[92:95], a[168:171], v[152:155], a[92:95]
    v_cvt_pk_bf16_f32 v181, v210, v211
    v_mfma_f32_16x16x32_bf16 a[92:95], a[172:175], v[156:159], a[92:95]
    s_waitcnt lgkmcnt(3)
    buffer_load_dwordx4 v46, s[20:23], s49 offen lds
    v_mfma_f32_16x16x32_bf16 v[208:211], a[224:227], v[64:67], v[192:195]
    v_exp_f32 v212, v212
    v_mfma_f32_16x16x32_bf16 v[208:211], a[228:231], v[68:71], v[208:211]
    v_exp_f32 v213, v213
    v_mfma_f32_16x16x32_bf16 v[208:211], a[232:235], v[72:75], v[208:211]
    s_waitcnt lgkmcnt(2)
    v_exp_f32 v214, v214
    v_mfma_f32_16x16x32_bf16 v[208:211], a[236:239], v[76:79], v[208:211]
    v_exp_f32 v215, v215
    v_mfma_f32_16x16x32_bf16 a[96:99], a[176:179], v[128:131], a[96:99]
    ds_read_b64_tr_b16 a[188:189], v27 offset:40960
    v_cvt_pk_bf16_f32 v188, v212, v213
    v_mfma_f32_16x16x32_bf16 a[96:99], a[180:183], v[132:135], a[96:99]
    ds_read_b64_tr_b16 a[190:191], v27 offset:45056
    v_lshrrev_b32 v245, 3, v0
    v_mfma_f32_16x16x32_bf16 a[100:103], a[176:179], v[136:139], a[100:103]
    v_cvt_pk_bf16_f32 v189, v214, v215
    v_mfma_f32_16x16x32_bf16 a[100:103], a[180:183], v[140:143], a[100:103]
    v_min_u32 v245, 1, v245
    v_lshl_or_b32 v244, v245, 31, v244
    v_mfma_f32_16x16x32_bf16 v[212:215], a[224:227], v[80:83], v[196:199]
    v_exp_f32 v208, v208
    v_mfma_f32_16x16x32_bf16 v[212:215], a[228:231], v[84:87], v[212:215]
    v_exp_f32 v209, v209
    v_mfma_f32_16x16x32_bf16 v[212:215], a[232:235], v[88:91], v[212:215]
    v_exp_f32 v210, v210
    v_mfma_f32_16x16x32_bf16 v[212:215], a[236:239], v[92:95], v[212:215]
    v_exp_f32 v211, v211
    v_mfma_f32_16x16x32_bf16 a[104:107], a[176:179], v[144:147], a[104:107]
    ds_read_b64_tr_b16 a[160:161], v20 offset:49152
    v_cvt_pk_bf16_f32 v166, v208, v209
    v_mfma_f32_16x16x32_bf16 a[104:107], a[180:183], v[148:151], a[104:107]
    ds_read_b64_tr_b16 a[162:163], v20 offset:53248
    v_mfma_f32_16x16x32_bf16 a[108:111], a[176:179], v[152:155], a[108:111]
    v_cvt_pk_bf16_f32 v167, v210, v211
    v_mfma_f32_16x16x32_bf16 a[108:111], a[180:183], v[156:159], a[108:111]
    s_waitcnt lgkmcnt(3)
    buffer_load_dwordx4 v47, s[20:23], s49 offen offset:1024 lds
    v_mfma_f32_16x16x32_bf16 v[208:211], a[224:227], v[96:99], v[200:203]
    v_exp_f32 v212, v212
    v_mfma_f32_16x16x32_bf16 v[208:211], a[228:231], v[100:103], v[208:211]
    v_exp_f32 v213, v213
    v_mfma_f32_16x16x32_bf16 v[208:211], a[232:235], v[104:107], v[208:211]
    v_exp_f32 v214, v214
    v_mfma_f32_16x16x32_bf16 v[208:211], a[236:239], v[108:111], v[208:211]
    s_add_u32 s57, s59, 0
    v_exp_f32 v215, v215
    v_mfma_f32_16x16x32_bf16 a[112:115], a[184:187], v[128:131], a[112:115]
    s_waitcnt lgkmcnt(2)
    ds_read_b64_tr_b16 a[164:165], v20 offset:57344
    v_cvt_pk_bf16_f32 v174, v212, v213
    v_mfma_f32_16x16x32_bf16 a[112:115], a[188:191], v[132:135], a[112:115]
    ds_read_b64_tr_b16 a[166:167], v20 offset:61440
    v_mfma_f32_16x16x32_bf16 a[116:119], a[184:187], v[136:139], a[116:119]
    v_cvt_pk_bf16_f32 v175, v214, v215
    v_mfma_f32_16x16x32_bf16 a[116:119], a[188:191], v[140:143], a[116:119]
    buffer_load_dwordx4 a[252:255], v255, s[84:87], s57 offen
    v_mfma_f32_16x16x32_bf16 v[212:215], a[224:227], v[112:115], v[204:207]
    v_exp_f32 v208, v208
    v_mfma_f32_16x16x32_bf16 v[212:215], a[228:231], v[116:119], v[212:215]
    v_exp_f32 v209, v209
    v_mfma_f32_16x16x32_bf16 v[212:215], a[232:235], v[120:123], v[212:215]
    v_exp_f32 v210, v210
    v_mfma_f32_16x16x32_bf16 v[212:215], a[236:239], v[124:127], v[212:215]
    v_exp_f32 v211, v211
    v_mfma_f32_16x16x32_bf16 a[120:123], a[184:187], v[144:147], a[120:123]
    ds_read_b64_tr_b16 a[168:169], v21 offset:49152
    v_cvt_pk_bf16_f32 v182, v208, v209
    v_mfma_f32_16x16x32_bf16 a[120:123], a[188:191], v[148:151], a[120:123]
    ds_read_b64_tr_b16 a[170:171], v21 offset:53248
    v_mfma_f32_16x16x32_bf16 a[124:127], a[184:187], v[152:155], a[124:127]
    v_cvt_pk_bf16_f32 v183, v210, v211
    v_mfma_f32_16x16x32_bf16 a[124:127], a[188:191], v[156:159], a[124:127]
    s_waitcnt lgkmcnt(3)
    buffer_load_dwordx4 v48, s[20:23], s49 offen offset:2048 lds
    v_smfmac_f32_16x16x64_bf16 a[192:195], v[52:55], v[160:167], v50
    v_exp_f32 v212, v212
    v_smfmac_f32_16x16x64_bf16 a[196:199], v[52:55], v[168:175], v50
    v_exp_f32 v213, v213
    v_smfmac_f32_16x16x64_bf16 a[200:203], v[52:55], v[176:183], v50
    v_exp_f32 v214, v214
    v_exp_f32 v215, v215
    v_mfma_f32_16x16x32_bf16 a[0:3], a[160:163], v[160:163], a[0:3]
    s_waitcnt lgkmcnt(2)
    ds_read_b64_tr_b16 a[172:173], v21 offset:57344
    v_cvt_pk_bf16_f32 v190, v212, v213
    v_mfma_f32_16x16x32_bf16 a[0:3], a[164:167], v[164:167], a[0:3]
    ds_read_b64_tr_b16 a[174:175], v21 offset:61440
    v_mfma_f32_16x16x32_bf16 a[4:7], a[160:163], v[168:171], a[4:7]
    v_cvt_pk_bf16_f32 v191, v214, v215
    v_mfma_f32_16x16x32_bf16 a[4:7], a[164:167], v[172:175], a[4:7]
    buffer_store_dword v246, v244, s[24:27], s39 offen sc1
    v_smfmac_f32_16x16x64_bf16 a[204:207], v[52:55], v[184:191], v50
    v_mfma_f32_16x16x32_bf16 a[8:11], a[160:163], v[176:179], a[8:11]
    ds_read_b64_tr_b16 a[176:177], v22 offset:49152
    v_mfma_f32_16x16x32_bf16 a[8:11], a[164:167], v[180:183], a[8:11]
    ds_read_b64_tr_b16 a[178:179], v22 offset:53248
    v_accvgpr_read_b32 v216, a192
    v_accvgpr_read_b32 v217, a193
    v_mfma_f32_16x16x32_bf16 a[12:15], a[160:163], v[184:187], a[12:15]
    v_accvgpr_read_b32 v218, a196
    v_accvgpr_read_b32 v219, a197
    v_mfma_f32_16x16x32_bf16 a[12:15], a[164:167], v[188:191], a[12:15]
    s_waitcnt lgkmcnt(4)
    buffer_load_dwordx4 v49, s[20:23], s49 offen offset:3072 lds
    v_accvgpr_read_b32 v220, a200
    v_accvgpr_read_b32 v221, a201
    v_mfma_f32_16x16x32_bf16 a[16:19], a[168:171], v[160:163], a[16:19]
    s_waitcnt lgkmcnt(2)
    ds_read_b64_tr_b16 a[180:181], v22 offset:57344
    v_accvgpr_read_b32 v222, a204
    v_mfma_f32_16x16x32_bf16 a[16:19], a[172:175], v[164:167], a[16:19]
    ds_read_b64_tr_b16 a[182:183], v22 offset:61440
    v_accvgpr_read_b32 v223, a205
    v_add_f32 v58, v216, v217
    v_mfma_f32_16x16x32_bf16 a[20:23], a[168:171], v[168:171], a[20:23]
    v_add_f32 v59, v218, v219
    v_add_f32 v60, v220, v221
    v_mfma_f32_16x16x32_bf16 a[20:23], a[172:175], v[172:175], a[20:23]
    v_add_f32 v61, v222, v223
    v_add_f32 v216, v58, v59
    s_add_u32 s49, s7, 256
    s_add_u32 m0, s42, 32768
    v_mfma_f32_16x16x32_bf16 a[24:27], a[168:171], v[176:179], a[24:27]
    ds_read_b64_tr_b16 a[184:185], v23 offset:49152
    v_add_f32 v217, v60, v61
    v_mfma_f32_16x16x32_bf16 a[24:27], a[172:175], v[180:183], a[24:27]
    ds_read_b64_tr_b16 a[186:187], v23 offset:53248
    v_add_f32 v216, v216, v217
    v_cmp_ngt_f32 vcc, 1669332992, v216
    v_mfma_f32_16x16x32_bf16 a[28:31], a[168:171], v[184:187], a[28:31]
    v_rcp_f32 v58, v58
    v_rcp_f32 v59, v59
    v_mfma_f32_16x16x32_bf16 a[28:31], a[172:175], v[188:191], a[28:31]
    s_waitcnt lgkmcnt(4)
    buffer_load_dwordx4 v46, s[20:23], s49 offen lds
    v_rcp_f32 v60, v60
    v_rcp_f32 v61, v61
    v_mfma_f32_16x16x32_bf16 a[32:35], a[176:179], v[160:163], a[32:35]
    s_waitcnt lgkmcnt(2)
    ds_read_b64_tr_b16 a[188:189], v23 offset:57344
    v_mov_b32 v228, 131072
    v_mfma_f32_16x16x32_bf16 a[32:35], a[180:183], v[164:167], a[32:35]
    ds_read_b64_tr_b16 a[190:191], v23 offset:61440
    s_or_b32 s36, vcc_lo, vcc_hi
    v_mfma_f32_16x16x32_bf16 a[36:39], a[176:179], v[168:171], a[36:39]
    v_accvgpr_read_b32 v208, a0
    v_accvgpr_read_b32 v209, a1
    v_accvgpr_read_b32 v210, a2
    v_accvgpr_read_b32 v211, a3
    v_pk_mul_f32 v[208:209], v[208:209], v[58:59] op_sel:[0,0] op_sel_hi:[1,0]
    v_pk_mul_f32 v[210:211], v[210:211], v[58:59] op_sel:[0,0] op_sel_hi:[1,0]
    v_cvt_pk_bf16_f32 v128, v208, v209
    v_cvt_pk_bf16_f32 v129, v210, v211
    v_mfma_f32_16x16x32_bf16 a[36:39], a[180:183], v[172:175], a[36:39]
    v_accvgpr_read_b32 v212, a4
    v_accvgpr_read_b32 v213, a5
    v_accvgpr_read_b32 v214, a6
    v_accvgpr_read_b32 v215, a7
    v_pk_mul_f32 v[212:213], v[212:213], v[58:59] op_sel:[0,1] op_sel_hi:[1,1]
    v_pk_mul_f32 v[214:215], v[214:215], v[58:59] op_sel:[0,1] op_sel_hi:[1,1]
    v_cvt_pk_bf16_f32 v132, v212, v213
    v_cvt_pk_bf16_f32 v133, v214, v215
    v_mfma_f32_16x16x32_bf16 a[40:43], a[176:179], v[176:179], a[40:43]
    ds_read_b64_tr_b16 a[160:161], v24 offset:49152
    v_mov_b32 v218, s36
    v_mfma_f32_16x16x32_bf16 a[40:43], a[180:183], v[180:183], a[40:43]
    ds_read_b64_tr_b16 a[162:163], v24 offset:53248
    s_lshl_b32 s38, s3, 2
    v_mfma_f32_16x16x32_bf16 a[44:47], a[176:179], v[184:187], a[44:47]
    v_accvgpr_read_b32 v208, a8
    v_accvgpr_read_b32 v209, a9
    v_accvgpr_read_b32 v210, a10
    v_accvgpr_read_b32 v211, a11
    v_pk_mul_f32 v[208:209], v[208:209], v[60:61] op_sel:[0,0] op_sel_hi:[1,0]
    v_pk_mul_f32 v[210:211], v[210:211], v[60:61] op_sel:[0,0] op_sel_hi:[1,0]
    v_cvt_pk_bf16_f32 v136, v208, v209
    v_cvt_pk_bf16_f32 v137, v210, v211
    v_mfma_f32_16x16x32_bf16 a[44:47], a[180:183], v[188:191], a[44:47]
    s_waitcnt lgkmcnt(4)
    buffer_load_dwordx4 v47, s[20:23], s49 offen offset:1024 lds
    v_accvgpr_read_b32 v212, a12
    v_accvgpr_read_b32 v213, a13
    v_accvgpr_read_b32 v214, a14
    v_accvgpr_read_b32 v215, a15
    v_pk_mul_f32 v[212:213], v[212:213], v[60:61] op_sel:[0,1] op_sel_hi:[1,1]
    v_pk_mul_f32 v[214:215], v[214:215], v[60:61] op_sel:[0,1] op_sel_hi:[1,1]
    v_cvt_pk_bf16_f32 v140, v212, v213
    v_cvt_pk_bf16_f32 v141, v214, v215
    v_mfma_f32_16x16x32_bf16 a[48:51], a[184:187], v[160:163], a[48:51]
    s_waitcnt lgkmcnt(2)
    ds_read_b64_tr_b16 a[164:165], v24 offset:57344
    v_add_u32 v219, s38, v228
    v_mfma_f32_16x16x32_bf16 a[48:51], a[188:191], v[164:167], a[48:51]
    ds_read_b64_tr_b16 a[166:167], v24 offset:61440
    ds_write_b32 v219, v218
    v_mfma_f32_16x16x32_bf16 a[52:55], a[184:187], v[168:171], a[52:55]
    v_accvgpr_read_b32 v208, a16
    v_accvgpr_read_b32 v209, a17
    v_accvgpr_read_b32 v210, a18
    v_accvgpr_read_b32 v211, a19
    v_pk_mul_f32 v[208:209], v[208:209], v[58:59] op_sel:[0,0] op_sel_hi:[1,0]
    v_pk_mul_f32 v[210:211], v[210:211], v[58:59] op_sel:[0,0] op_sel_hi:[1,0]
    v_cvt_pk_bf16_f32 v130, v208, v209
    v_cvt_pk_bf16_f32 v131, v210, v211
    s_add_u32 s37, s55, 0
    buffer_store_dwordx4 v[128:131], v252, s[28:31], s37 offen offset:0
    v_mfma_f32_16x16x32_bf16 a[52:55], a[188:191], v[172:175], a[52:55]
    v_accvgpr_read_b32 v212, a20
    v_accvgpr_read_b32 v213, a21
    v_accvgpr_read_b32 v214, a22
    v_accvgpr_read_b32 v215, a23
    v_pk_mul_f32 v[212:213], v[212:213], v[58:59] op_sel:[0,1] op_sel_hi:[1,1]
    v_pk_mul_f32 v[214:215], v[214:215], v[58:59] op_sel:[0,1] op_sel_hi:[1,1]
    v_cvt_pk_bf16_f32 v134, v212, v213
    v_cvt_pk_bf16_f32 v135, v214, v215
    s_add_u32 s37, s55, 8192
    buffer_store_dwordx4 v[132:135], v252, s[28:31], s37 offen offset:0
    v_mfma_f32_16x16x32_bf16 a[56:59], a[184:187], v[176:179], a[56:59]
    ds_read_b64_tr_b16 a[168:169], v25 offset:49152
    v_min_u32 v240, 1, v0
    v_mfma_f32_16x16x32_bf16 a[56:59], a[188:191], v[180:183], a[56:59]
    ds_read_b64_tr_b16 a[170:171], v25 offset:53248
    v_mfma_f32_16x16x32_bf16 a[60:63], a[184:187], v[184:187], a[60:63]
    v_accvgpr_read_b32 v208, a24
    v_accvgpr_read_b32 v209, a25
    v_accvgpr_read_b32 v210, a26
    v_accvgpr_read_b32 v211, a27
    v_pk_mul_f32 v[208:209], v[208:209], v[60:61] op_sel:[0,0] op_sel_hi:[1,0]
    v_pk_mul_f32 v[210:211], v[210:211], v[60:61] op_sel:[0,0] op_sel_hi:[1,0]
    v_cvt_pk_bf16_f32 v138, v208, v209
    v_cvt_pk_bf16_f32 v139, v210, v211
    s_add_u32 s37, s55, 4096
    buffer_store_dwordx4 v[136:139], v252, s[28:31], s37 offen offset:0
    v_mfma_f32_16x16x32_bf16 a[60:63], a[188:191], v[188:191], a[60:63]
    s_waitcnt lgkmcnt(5)
    buffer_load_dwordx4 v48, s[20:23], s49 offen offset:2048 lds
    v_accvgpr_read_b32 v212, a28
    v_accvgpr_read_b32 v213, a29
    v_accvgpr_read_b32 v214, a30
    v_accvgpr_read_b32 v215, a31
    v_pk_mul_f32 v[212:213], v[212:213], v[60:61] op_sel:[0,1] op_sel_hi:[1,1]
    v_pk_mul_f32 v[214:215], v[214:215], v[60:61] op_sel:[0,1] op_sel_hi:[1,1]
    v_cvt_pk_bf16_f32 v142, v212, v213
    v_cvt_pk_bf16_f32 v143, v214, v215
    s_add_u32 s37, s55, 12288
    buffer_store_dwordx4 v[140:143], v252, s[28:31], s37 offen offset:0
    v_mfma_f32_16x16x32_bf16 a[64:67], a[160:163], v[160:163], a[64:67]
    s_waitcnt lgkmcnt(3)
    ds_read_b64_tr_b16 a[172:173], v25 offset:57344
    v_lshlrev_b32 v240, 31, v240
    v_mfma_f32_16x16x32_bf16 a[64:67], a[164:167], v[164:167], a[64:67]
    ds_read_b64_tr_b16 a[174:175], v25 offset:61440
    v_mfma_f32_16x16x32_bf16 a[68:71], a[160:163], v[168:171], a[68:71]
    v_accvgpr_read_b32 v208, a32
    v_accvgpr_read_b32 v209, a33
    v_accvgpr_read_b32 v210, a34
    v_accvgpr_read_b32 v211, a35
    v_pk_mul_f32 v[208:209], v[208:209], v[58:59] op_sel:[0,0] op_sel_hi:[1,0]
    v_pk_mul_f32 v[210:211], v[210:211], v[58:59] op_sel:[0,0] op_sel_hi:[1,0]
    v_cvt_pk_bf16_f32 v144, v208, v209
    v_cvt_pk_bf16_f32 v145, v210, v211
    v_mfma_f32_16x16x32_bf16 a[68:71], a[164:167], v[172:175], a[68:71]
    v_accvgpr_read_b32 v212, a36
    v_accvgpr_read_b32 v213, a37
    v_accvgpr_read_b32 v214, a38
    v_accvgpr_read_b32 v215, a39
    v_pk_mul_f32 v[212:213], v[212:213], v[58:59] op_sel:[0,1] op_sel_hi:[1,1]
    v_pk_mul_f32 v[214:215], v[214:215], v[58:59] op_sel:[0,1] op_sel_hi:[1,1]
    v_cvt_pk_bf16_f32 v148, v212, v213
    v_cvt_pk_bf16_f32 v149, v214, v215
    v_mfma_f32_16x16x32_bf16 a[72:75], a[160:163], v[176:179], a[72:75]
    ds_read_b64_tr_b16 a[176:177], v26 offset:49152
    v_mov_b32 v241, 1
    v_mfma_f32_16x16x32_bf16 a[72:75], a[164:167], v[180:183], a[72:75]
    ds_read_b64_tr_b16 a[178:179], v26 offset:53248
    v_mfma_f32_16x16x32_bf16 a[76:79], a[160:163], v[184:187], a[76:79]
    v_accvgpr_read_b32 v208, a40
    v_accvgpr_read_b32 v209, a41
    v_accvgpr_read_b32 v210, a42
    v_accvgpr_read_b32 v211, a43
    v_pk_mul_f32 v[208:209], v[208:209], v[60:61] op_sel:[0,0] op_sel_hi:[1,0]
    v_pk_mul_f32 v[210:211], v[210:211], v[60:61] op_sel:[0,0] op_sel_hi:[1,0]
    v_cvt_pk_bf16_f32 v152, v208, v209
    v_cvt_pk_bf16_f32 v153, v210, v211
    v_mfma_f32_16x16x32_bf16 a[76:79], a[164:167], v[188:191], a[76:79]
    s_waitcnt lgkmcnt(4)
    buffer_load_dwordx4 v49, s[20:23], s49 offen offset:3072 lds
    v_accvgpr_read_b32 v212, a44
    v_accvgpr_read_b32 v213, a45
    v_accvgpr_read_b32 v214, a46
    v_accvgpr_read_b32 v215, a47
    v_pk_mul_f32 v[212:213], v[212:213], v[60:61] op_sel:[0,1] op_sel_hi:[1,1]
    v_pk_mul_f32 v[214:215], v[214:215], v[60:61] op_sel:[0,1] op_sel_hi:[1,1]
    v_cvt_pk_bf16_f32 v156, v212, v213
    v_cvt_pk_bf16_f32 v157, v214, v215
    v_mfma_f32_16x16x32_bf16 a[80:83], a[168:171], v[160:163], a[80:83]
    s_waitcnt lgkmcnt(2)
    ds_read_b64_tr_b16 a[180:181], v26 offset:57344
    v_mfma_f32_16x16x32_bf16 a[80:83], a[172:175], v[164:167], a[80:83]
    ds_read_b64_tr_b16 a[182:183], v26 offset:61440
    v_mfma_f32_16x16x32_bf16 a[84:87], a[168:171], v[168:171], a[84:87]
    v_accvgpr_read_b32 v208, a48
    v_accvgpr_read_b32 v209, a49
    v_accvgpr_read_b32 v210, a50
    v_accvgpr_read_b32 v211, a51
    v_pk_mul_f32 v[208:209], v[208:209], v[58:59] op_sel:[0,0] op_sel_hi:[1,0]
    v_pk_mul_f32 v[210:211], v[210:211], v[58:59] op_sel:[0,0] op_sel_hi:[1,0]
    v_cvt_pk_bf16_f32 v146, v208, v209
    v_cvt_pk_bf16_f32 v147, v210, v211
    s_add_u32 s37, s55, 0
    buffer_store_dwordx4 v[144:147], v252, s[28:31], s37 offen offset:1024
    v_mfma_f32_16x16x32_bf16 a[84:87], a[172:175], v[172:175], a[84:87]
    v_accvgpr_read_b32 v212, a52
    v_accvgpr_read_b32 v213, a53
    v_accvgpr_read_b32 v214, a54
    v_accvgpr_read_b32 v215, a55
    v_pk_mul_f32 v[212:213], v[212:213], v[58:59] op_sel:[0,1] op_sel_hi:[1,1]
    v_pk_mul_f32 v[214:215], v[214:215], v[58:59] op_sel:[0,1] op_sel_hi:[1,1]
    v_cvt_pk_bf16_f32 v150, v212, v213
    v_cvt_pk_bf16_f32 v151, v214, v215
    s_add_u32 s37, s55, 8192
    buffer_store_dwordx4 v[148:151], v252, s[28:31], s37 offen offset:1024
    s_waitcnt vmcnt(22)
    s_barrier
    v_mfma_f32_16x16x32_bf16 a[88:91], a[168:171], v[176:179], a[88:91]
    ds_read_b64_tr_b16 a[184:185], v27 offset:49152
    v_mfma_f32_16x16x32_bf16 a[88:91], a[172:175], v[180:183], a[88:91]
    ds_read_b64_tr_b16 a[186:187], v27 offset:53248
    v_mfma_f32_16x16x32_bf16 a[92:95], a[168:171], v[184:187], a[92:95]
    ds_read_b128 v[224:227], v228
    v_accvgpr_read_b32 v208, a56
    v_accvgpr_read_b32 v209, a57
    v_accvgpr_read_b32 v210, a58
    v_accvgpr_read_b32 v211, a59
    v_pk_mul_f32 v[208:209], v[208:209], v[60:61] op_sel:[0,0] op_sel_hi:[1,0]
    v_pk_mul_f32 v[210:211], v[210:211], v[60:61] op_sel:[0,0] op_sel_hi:[1,0]
    v_cvt_pk_bf16_f32 v154, v208, v209
    v_cvt_pk_bf16_f32 v155, v210, v211
    s_add_u32 s37, s55, 4096
    buffer_store_dwordx4 v[152:155], v252, s[28:31], s37 offen offset:1024
    v_mfma_f32_16x16x32_bf16 a[92:95], a[172:175], v[188:191], a[92:95]
    s_waitcnt lgkmcnt(5)
    v_accvgpr_read_b32 v212, a60
    v_accvgpr_read_b32 v213, a61
    v_accvgpr_read_b32 v214, a62
    v_accvgpr_read_b32 v215, a63
    v_pk_mul_f32 v[212:213], v[212:213], v[60:61] op_sel:[0,1] op_sel_hi:[1,1]
    v_pk_mul_f32 v[214:215], v[214:215], v[60:61] op_sel:[0,1] op_sel_hi:[1,1]
    v_cvt_pk_bf16_f32 v158, v212, v213
    v_cvt_pk_bf16_f32 v159, v214, v215
    s_add_u32 s37, s55, 12288
    buffer_store_dwordx4 v[156:159], v252, s[28:31], s37 offen offset:1024
    s_add_u32 s49, s7, 73984
    v_mfma_f32_16x16x32_bf16 a[96:99], a[176:179], v[160:163], a[96:99]
    s_waitcnt lgkmcnt(3)
    s_add_u32 m0, s42, 49152
    ds_read_b64_tr_b16 a[188:189], v27 offset:57344
    v_mfma_f32_16x16x32_bf16 a[96:99], a[180:183], v[164:167], a[96:99]
    buffer_load_dwordx4 v46, s[20:23], s49 offen lds
    v_mfma_f32_16x16x32_bf16 a[100:103], a[176:179], v[168:171], a[100:103]
    ds_read_b64_tr_b16 a[190:191], v27 offset:61440
    v_accvgpr_read_b32 v208, a64
    v_accvgpr_read_b32 v209, a65
    v_accvgpr_read_b32 v210, a66
    v_accvgpr_read_b32 v211, a67
    v_pk_mul_f32 v[208:209], v[208:209], v[58:59] op_sel:[0,0] op_sel_hi:[1,0]
    v_pk_mul_f32 v[210:211], v[210:211], v[58:59] op_sel:[0,0] op_sel_hi:[1,0]
    v_cvt_pk_bf16_f32 v192, v208, v209
    v_cvt_pk_bf16_f32 v193, v210, v211
    v_mfma_f32_16x16x32_bf16 a[100:103], a[180:183], v[172:175], a[100:103]
    buffer_load_dwordx4 v47, s[20:23], s49 offen offset:1024 lds
    v_accvgpr_read_b32 v212, a68
    v_accvgpr_read_b32 v213, a69
    v_accvgpr_read_b32 v214, a70
    v_accvgpr_read_b32 v215, a71
    v_pk_mul_f32 v[212:213], v[212:213], v[58:59] op_sel:[0,1] op_sel_hi:[1,1]
    v_pk_mul_f32 v[214:215], v[214:215], v[58:59] op_sel:[0,1] op_sel_hi:[1,1]
    v_cvt_pk_bf16_f32 v196, v212, v213
    v_cvt_pk_bf16_f32 v197, v214, v215
    v_mfma_f32_16x16x32_bf16 a[104:107], a[176:179], v[176:179], a[104:107]
    v_mfma_f32_16x16x32_bf16 a[104:107], a[180:183], v[180:183], a[104:107]
    buffer_load_dwordx4 v48, s[20:23], s49 offen offset:2048 lds
    v_mfma_f32_16x16x32_bf16 a[108:111], a[176:179], v[184:187], a[108:111]
    v_accvgpr_read_b32 v208, a72
    v_accvgpr_read_b32 v209, a73
    v_accvgpr_read_b32 v210, a74
    v_accvgpr_read_b32 v211, a75
    v_pk_mul_f32 v[208:209], v[208:209], v[60:61] op_sel:[0,0] op_sel_hi:[1,0]
    v_pk_mul_f32 v[210:211], v[210:211], v[60:61] op_sel:[0,0] op_sel_hi:[1,0]
    v_cvt_pk_bf16_f32 v200, v208, v209
    v_cvt_pk_bf16_f32 v201, v210, v211
    v_mfma_f32_16x16x32_bf16 a[108:111], a[180:183], v[188:191], a[108:111]
    s_waitcnt lgkmcnt(3)
    buffer_load_dwordx4 v49, s[20:23], s49 offen offset:3072 lds
    v_accvgpr_read_b32 v212, a76
    v_accvgpr_read_b32 v213, a77
    v_accvgpr_read_b32 v214, a78
    v_accvgpr_read_b32 v215, a79
    v_pk_mul_f32 v[212:213], v[212:213], v[60:61] op_sel:[0,1] op_sel_hi:[1,1]
    v_pk_mul_f32 v[214:215], v[214:215], v[60:61] op_sel:[0,1] op_sel_hi:[1,1]
    v_cvt_pk_bf16_f32 v204, v212, v213
    v_cvt_pk_bf16_f32 v205, v214, v215
    s_add_u32 s49, s46, 0
    v_mfma_f32_16x16x32_bf16 a[112:115], a[184:187], v[160:163], a[112:115]
    s_waitcnt lgkmcnt(0)
    s_add_u32 m0, s42, 98304
    v_mfma_f32_16x16x32_bf16 a[112:115], a[188:191], v[164:167], a[112:115]
    buffer_load_dwordx4 v46, s[20:23], s49 offen lds
    v_mfma_f32_16x16x32_bf16 a[116:119], a[184:187], v[168:171], a[116:119]
    v_accvgpr_read_b32 v208, a80
    v_accvgpr_read_b32 v209, a81
    v_accvgpr_read_b32 v210, a82
    v_accvgpr_read_b32 v211, a83
    v_pk_mul_f32 v[208:209], v[208:209], v[58:59] op_sel:[0,0] op_sel_hi:[1,0]
    v_pk_mul_f32 v[210:211], v[210:211], v[58:59] op_sel:[0,0] op_sel_hi:[1,0]
    v_cvt_pk_bf16_f32 v194, v208, v209
    v_cvt_pk_bf16_f32 v195, v210, v211
    s_add_u32 s37, s55, 0
    buffer_store_dwordx4 v[192:195], v252, s[28:31], s37 offen offset:2048
    v_mfma_f32_16x16x32_bf16 a[116:119], a[188:191], v[172:175], a[116:119]
    buffer_load_dwordx4 v47, s[20:23], s49 offen offset:1024 lds
    v_accvgpr_read_b32 v212, a84
    v_accvgpr_read_b32 v213, a85
    v_accvgpr_read_b32 v214, a86
    v_accvgpr_read_b32 v215, a87
    v_pk_mul_f32 v[212:213], v[212:213], v[58:59] op_sel:[0,1] op_sel_hi:[1,1]
    v_pk_mul_f32 v[214:215], v[214:215], v[58:59] op_sel:[0,1] op_sel_hi:[1,1]
    v_cvt_pk_bf16_f32 v198, v212, v213
    v_cvt_pk_bf16_f32 v199, v214, v215
    s_add_u32 s37, s55, 8192
    buffer_store_dwordx4 v[196:199], v252, s[28:31], s37 offen offset:2048
    v_mfma_f32_16x16x32_bf16 a[120:123], a[184:187], v[176:179], a[120:123]
    v_mfma_f32_16x16x32_bf16 a[120:123], a[188:191], v[180:183], a[120:123]
    buffer_load_dwordx4 v48, s[20:23], s49 offen offset:2048 lds
    v_mfma_f32_16x16x32_bf16 a[124:127], a[184:187], v[184:187], a[124:127]
    v_accvgpr_read_b32 v208, a88
    v_accvgpr_read_b32 v209, a89
    v_accvgpr_read_b32 v210, a90
    v_accvgpr_read_b32 v211, a91
    v_pk_mul_f32 v[208:209], v[208:209], v[60:61] op_sel:[0,0] op_sel_hi:[1,0]
    v_pk_mul_f32 v[210:211], v[210:211], v[60:61] op_sel:[0,0] op_sel_hi:[1,0]
    v_cvt_pk_bf16_f32 v202, v208, v209
    v_cvt_pk_bf16_f32 v203, v210, v211
    s_add_u32 s37, s55, 4096
    buffer_store_dwordx4 v[200:203], v252, s[28:31], s37 offen offset:2048
    v_mfma_f32_16x16x32_bf16 a[124:127], a[188:191], v[188:191], a[124:127]
    buffer_load_dwordx4 v49, s[20:23], s49 offen offset:3072 lds
    v_accvgpr_read_b32 v212, a92
    v_accvgpr_read_b32 v213, a93
    v_accvgpr_read_b32 v214, a94
    v_accvgpr_read_b32 v215, a95
    v_pk_mul_f32 v[212:213], v[212:213], v[60:61] op_sel:[0,1] op_sel_hi:[1,1]
    v_pk_mul_f32 v[214:215], v[214:215], v[60:61] op_sel:[0,1] op_sel_hi:[1,1]
    v_cvt_pk_bf16_f32 v206, v212, v213
    v_cvt_pk_bf16_f32 v207, v214, v215
    s_add_u32 s37, s55, 12288
    buffer_store_dwordx4 v[204:207], v252, s[28:31], s37 offen offset:2048
    v_or3_b32 v224, v224, v225, v226
    v_or_b32 v224, v224, v227
    s_nop 0
    v_readfirstlane_b32 s36, v224
    v_readfirstlane_b32 s38, v253
    v_min_u32 v8, 1, v1
    v_lshlrev_b32 v8, 31, v8
    v_mov_b32 v10, s95
    s_getreg_b32 s39, hwreg(HW_REG_XCC_ID, 0, 4)
    s_add_u32 s39, s39, s95
    s_cmp_eq_u32 s38, s39
    s_cselect_b32 s53, 1, 0
    ds_read_b64_tr_b16 a[208:209], v12 offset:0
    ds_read_b64_tr_b16 a[210:211], v12 offset:4096
    ds_read_b64_tr_b16 a[212:213], v12 offset:8192
    ds_read_b64_tr_b16 a[214:215], v12 offset:12288
    ds_read_b64_tr_b16 a[216:217], v12 offset:16384
    ds_read_b64_tr_b16 a[218:219], v12 offset:20480
    ds_read_b64_tr_b16 a[220:221], v12 offset:24576
    ds_read_b64_tr_b16 a[222:223], v12 offset:28672
    ds_read_b64_tr_b16 a[224:225], v16 offset:0
    ds_read_b64_tr_b16 a[226:227], v16 offset:4096
    ds_read_b64_tr_b16 a[228:229], v16 offset:8192
    ds_read_b64_tr_b16 a[230:231], v16 offset:12288
    ds_read_b64_tr_b16 a[232:233], v16 offset:16384
    ds_read_b64_tr_b16 a[234:235], v16 offset:20480
    ds_read_b64_tr_b16 a[236:237], v16 offset:24576
    ds_read_b64_tr_b16 a[238:239], v16 offset:28672
    s_andn2_b32 s36, s36, s48
    s_cbranch_scc1 Lattn_redo
    v_accvgpr_read_b32 v208, a96
    v_accvgpr_read_b32 v209, a97
Ltour8:
    s_cbranch_execz Ltour12
    v_accvgpr_read_b32 v210, a98
    v_accvgpr_read_b32 v211, a99
    v_pk_mul_f32 v[208:209], v[208:209], v[58:59] op_sel:[0,0] op_sel_hi:[1,0]
    v_pk_mul_f32 v[210:211], v[210:211], v[58:59] op_sel:[0,0] op_sel_hi:[1,0]
    v_cvt_pk_bf16_f32 v176, v208, v209
    v_cvt_pk_bf16_f32 v177, v210, v211
    v_accvgpr_read_b32 v212, a100
    v_accvgpr_read_b32 v213, a101
    v_accvgpr_read_b32 v214, a102
    v_accvgpr_read_b32 v215, a103
    v_pk_mul_f32 v[212:213], v[212:213], v[58:59] op_sel:[0,1] op_sel_hi:[1,1]
    v_pk_mul_f32 v[214:215], v[214:215], v[58:59] op_sel:[0,1] op_sel_hi:[1,1]
    v_cvt_pk_bf16_f32 v180, v212, v213
    v_cvt_pk_bf16_f32 v181, v214, v215
    v_accvgpr_read_b32 v208, a104
    v_accvgpr_read_b32 v209, a105
    v_accvgpr_read_b32 v210, a106
    v_accvgpr_read_b32 v211, a107
    v_pk_mul_f32 v[208:209], v[208:209], v[60:61] op_sel:[0,0] op_sel_hi:[1,0]
    v_pk_mul_f32 v[210:211], v[210:211], v[60:61] op_sel:[0,0] op_sel_hi:[1,0]
    v_cvt_pk_bf16_f32 v184, v208, v209
    v_cvt_pk_bf16_f32 v185, v210, v211
    v_accvgpr_read_b32 v212, a108
    v_accvgpr_read_b32 v213, a109
    v_accvgpr_read_b32 v214, a110
    v_accvgpr_read_b32 v215, a111
    v_pk_mul_f32 v[212:213], v[212:213], v[60:61] op_sel:[0,1] op_sel_hi:[1,1]
    v_pk_mul_f32 v[214:215], v[214:215], v[60:61] op_sel:[0,1] op_sel_hi:[1,1]
    v_cvt_pk_bf16_f32 v188, v212, v213
    v_cvt_pk_bf16_f32 v189, v214, v215
    v_accvgpr_read_b32 v208, a112
    v_accvgpr_read_b32 v209, a113
    v_accvgpr_read_b32 v210, a114
    v_accvgpr_read_b32 v211, a115
    v_pk_mul_f32 v[208:209], v[208:209], v[58:59] op_sel:[0,0] op_sel_hi:[1,0]
    v_pk_mul_f32 v[210:211], v[210:211], v[58:59] op_sel:[0,0] op_sel_hi:[1,0]
    v_cvt_pk_bf16_f32 v178, v208, v209
    v_cvt_pk_bf16_f32 v179, v210, v211
    s_add_u32 s37, s55, 0
    buffer_store_dwordx4 v[176:179], v252, s[28:31], s37 offen offset:3072
    v_accvgpr_read_b32 v212, a116
    v_accvgpr_read_b32 v213, a117
    v_accvgpr_read_b32 v214, a118
    v_accvgpr_read_b32 v215, a119
    v_pk_mul_f32 v[212:213], v[212:213], v[58:59] op_sel:[0,1] op_sel_hi:[1,1]
    v_pk_mul_f32 v[214:215], v[214:215], v[58:59] op_sel:[0,1] op_sel_hi:[1,1]
    v_cvt_pk_bf16_f32 v182, v212, v213
    v_cvt_pk_bf16_f32 v183, v214, v215
    s_add_u32 s37, s55, 8192
    buffer_store_dwordx4 v[180:183], v252, s[28:31], s37 offen offset:3072
    v_accvgpr_read_b32 v208, a120
    v_accvgpr_read_b32 v209, a121
    v_accvgpr_read_b32 v210, a122
    v_accvgpr_read_b32 v211, a123
    v_pk_mul_f32 v[208:209], v[208:209], v[60:61] op_sel:[0,0] op_sel_hi:[1,0]
    v_pk_mul_f32 v[210:211], v[210:211], v[60:61] op_sel:[0,0] op_sel_hi:[1,0]
    v_cvt_pk_bf16_f32 v186, v208, v209
    v_cvt_pk_bf16_f32 v187, v210, v211
    s_add_u32 s37, s55, 4096
    buffer_store_dwordx4 v[184:187], v252, s[28:31], s37 offen offset:3072
    v_accvgpr_read_b32 v212, a124
    v_accvgpr_read_b32 v213, a125
    v_accvgpr_read_b32 v214, a126
    v_accvgpr_read_b32 v215, a127
    v_pk_mul_f32 v[212:213], v[212:213], v[60:61] op_sel:[0,1] op_sel_hi:[1,1]
    v_pk_mul_f32 v[214:215], v[214:215], v[60:61] op_sel:[0,1] op_sel_hi:[1,1]
    v_cvt_pk_bf16_f32 v190, v212, v213
    v_cvt_pk_bf16_f32 v191, v214, v215
    s_add_u32 s37, s55, 12288
    buffer_store_dwordx4 v[188:191], v252, s[28:31], s37 offen offset:3072
    s_waitcnt lgkmcnt(14)
    v_mfma_f32_16x16x32_bf16 v[96:99], a[208:211], v[128:131], 0
    s_waitcnt lgkmcnt(12)
    ds_read_b64_tr_b16 a[160:161], v13 offset:0
    v_mfma_f32_16x16x32_bf16 v[96:99], a[212:215], v[144:147], v[96:99]
    s_waitcnt lgkmcnt(11)
    ds_read_b64_tr_b16 a[162:163], v13 offset:4096
    v_mfma_f32_16x16x32_bf16 v[96:99], a[216:219], v[192:195], v[96:99]
    s_waitcnt lgkmcnt(10)
    ds_read_b64_tr_b16 a[164:165], v13 offset:8192
    v_mfma_f32_16x16x32_bf16 v[96:99], a[220:223], v[176:179], v[96:99]
    s_waitcnt lgkmcnt(9)
    ds_read_b64_tr_b16 a[166:167], v13 offset:12288
    v_mfma_f32_16x16x32_bf16 v[96:99], a[224:227], v[136:139], v[96:99]
    s_waitcnt lgkmcnt(8)
    ds_read_b64_tr_b16 a[168:169], v13 offset:16384
    v_mfma_f32_16x16x32_bf16 v[96:99], a[228:231], v[152:155], v[96:99]
    s_waitcnt lgkmcnt(7)
    ds_read_b64_tr_b16 a[170:171], v13 offset:20480
    v_mfma_f32_16x16x32_bf16 v[96:99], a[232:235], v[200:203], v[96:99]
    s_waitcnt lgkmcnt(6)
    ds_read_b64_tr_b16 a[172:173], v13 offset:24576
    v_mfma_f32_16x16x32_bf16 v[96:99], a[236:239], v[184:187], v[96:99]
    ds_read_b64_tr_b16 a[174:175], v13 offset:28672
    v_mfma_f32_16x16x32_bf16 v[100:103], a[208:211], v[132:135], 0
    ds_read_b64_tr_b16 a[176:177], v17 offset:0
    v_mfma_f32_16x16x32_bf16 v[100:103], a[212:215], v[148:151], v[100:103]
    ds_read_b64_tr_b16 a[178:179], v17 offset:4096
    v_mfma_f32_16x16x32_bf16 v[100:103], a[216:219], v[196:199], v[100:103]
    ds_read_b64_tr_b16 a[180:181], v17 offset:8192
    v_mfma_f32_16x16x32_bf16 v[100:103], a[220:223], v[180:183], v[100:103]
    ds_read_b64_tr_b16 a[182:183], v17 offset:12288
    v_mfma_f32_16x16x32_bf16 v[100:103], a[224:227], v[140:143], v[100:103]
    ds_read_b64_tr_b16 a[184:185], v17 offset:16384
    v_cvt_pk_bf16_f32 v224, v96, v97
    v_mfma_f32_16x16x32_bf16 v[100:103], a[228:231], v[156:159], v[100:103]
    ds_read_b64_tr_b16 a[186:187], v17 offset:20480
    v_cvt_pk_bf16_f32 v225, v98, v99
    v_mfma_f32_16x16x32_bf16 v[100:103], a[232:235], v[204:207], v[100:103]
    ds_read_b64_tr_b16 a[188:189], v17 offset:24576
    v_mfma_f32_16x16x32_bf16 v[100:103], a[236:239], v[188:191], v[100:103]
    s_waitcnt lgkmcnt(13)
    ds_read_b64_tr_b16 a[190:191], v17 offset:28672
    v_mfma_f32_16x16x32_bf16 v[104:107], a[160:163], v[128:131], 0
    s_waitcnt lgkmcnt(12)
    ds_read_b64_tr_b16 a[208:209], v14 offset:0
    v_mfma_f32_16x16x32_bf16 v[104:107], a[164:167], v[144:147], v[104:107]
    s_waitcnt lgkmcnt(11)
    ds_read_b64_tr_b16 a[210:211], v14 offset:4096
    v_mfma_f32_16x16x32_bf16 v[104:107], a[168:171], v[192:195], v[104:107]
    s_waitcnt lgkmcnt(10)
    ds_read_b64_tr_b16 a[212:213], v14 offset:8192
    v_mfma_f32_16x16x32_bf16 v[104:107], a[172:175], v[176:179], v[104:107]
    s_waitcnt lgkmcnt(9)
    ds_read_b64_tr_b16 a[214:215], v14 offset:12288
    v_mfma_f32_16x16x32_bf16 v[104:107], a[176:179], v[136:139], v[104:107]
    s_waitcnt lgkmcnt(8)
    ds_read_b64_tr_b16 a[216:217], v14 offset:16384
    v_cvt_pk_bf16_f32 v228, v100, v101
    v_mfma_f32_16x16x32_bf16 v[104:107], a[180:183], v[152:155], v[104:107]
    s_waitcnt lgkmcnt(7)
    ds_read_b64_tr_b16 a[218:219], v14 offset:20480
    v_cvt_pk_bf16_f32 v229, v102, v103
    v_mfma_f32_16x16x32_bf16 v[104:107], a[184:187], v[200:203], v[104:107]
    s_waitcnt lgkmcnt(6)
    ds_read_b64_tr_b16 a[220:221], v14 offset:24576
    v_mfma_f32_16x16x32_bf16 v[104:107], a[188:191], v[184:187], v[104:107]
    ds_read_b64_tr_b16 a[222:223], v14 offset:28672
    s_waitcnt vmcnt(0)
    s_cmp_eq_u32 s53, 0
    s_cbranch_scc1 Lattn_wb
Lattn_wbdone:
    v_mfma_f32_16x16x32_bf16 v[108:111], a[160:163], v[132:135], 0
    buffer_store_dword v10, v8, s[24:27], s92 offen offset:8 sc1
    v_mfma_f32_16x16x32_bf16 v[108:111], a[164:167], v[148:151], v[108:111]
    s_xor_b32 s55, s55, 65536
    ds_read_b64_tr_b16 a[224:225], v18 offset:0
    ds_read_b64_tr_b16 a[226:227], v18 offset:4096
    v_mfma_f32_16x16x32_bf16 v[108:111], a[168:171], v[196:199], v[108:111]
    buffer_atomic_add v241, v240, s[88:91], 0 offen sc1
    v_mfma_f32_16x16x32_bf16 v[108:111], a[172:175], v[180:183], v[108:111]
    ds_read_b64_tr_b16 a[228:229], v18 offset:8192
    ds_read_b64_tr_b16 a[230:231], v18 offset:12288
    s_load_dwordx2 s[12:13], s[0:1], 0
    v_mfma_f32_16x16x32_bf16 v[108:111], a[176:179], v[140:143], v[108:111]
    ds_read_b64_tr_b16 a[232:233], v18 offset:16384
    v_cvt_pk_bf16_f32 v226, v104, v105
    v_mfma_f32_16x16x32_bf16 v[108:111], a[180:183], v[156:159], v[108:111]
    s_add_u32 s38, s56, 16384
    ds_read_b64_tr_b16 a[234:235], v18 offset:20480
    v_cvt_pk_bf16_f32 v227, v106, v107
    s_load_dwordx2 s[16:17], s[0:1], 96
    v_mfma_f32_16x16x32_bf16 v[108:111], a[184:187], v[204:207], v[108:111]
    buffer_store_dwordx4 v[224:227], v56, s[28:31], s38 offen sc1
    v_mfma_f32_16x16x32_bf16 v[108:111], a[188:191], v[188:191], v[108:111]
    s_waitcnt lgkmcnt(12)
    ds_read_b64_tr_b16 a[236:237], v18 offset:24576
    ds_read_b64_tr_b16 a[238:239], v18 offset:28672
    s_load_dwordx2 s[52:53], s[0:1], 48
    v_mfma_f32_16x16x32_bf16 v[112:115], a[208:211], v[128:131], 0
    s_waitcnt lgkmcnt(12)
    ds_read_b64_tr_b16 a[160:161], v15 offset:0
    v_mfma_f32_16x16x32_bf16 v[112:115], a[212:215], v[144:147], v[112:115]
    s_waitcnt lgkmcnt(11)
    ds_read_b64_tr_b16 a[162:163], v15 offset:4096
    v_mfma_f32_16x16x32_bf16 v[112:115], a[216:219], v[192:195], v[112:115]
    s_waitcnt lgkmcnt(10)
    ds_read_b64_tr_b16 a[164:165], v15 offset:8192
    v_mfma_f32_16x16x32_bf16 v[112:115], a[220:223], v[176:179], v[112:115]
    s_waitcnt lgkmcnt(9)
    ds_read_b64_tr_b16 a[166:167], v15 offset:12288
    v_mfma_f32_16x16x32_bf16 v[112:115], a[224:227], v[136:139], v[112:115]
    s_waitcnt lgkmcnt(8)
    ds_read_b64_tr_b16 a[168:169], v15 offset:16384
    v_cvt_pk_bf16_f32 v230, v108, v109
    v_mfma_f32_16x16x32_bf16 v[112:115], a[228:231], v[152:155], v[112:115]
    s_waitcnt lgkmcnt(7)
    s_add_u32 s38, s56, 180224
    ds_read_b64_tr_b16 a[170:171], v15 offset:20480
    v_cvt_pk_bf16_f32 v231, v110, v111
    v_mfma_f32_16x16x32_bf16 v[112:115], a[232:235], v[200:203], v[112:115]
    s_waitcnt lgkmcnt(6)
    buffer_store_dwordx4 v[228:231], v56, s[28:31], s38 offen sc1
    v_mfma_f32_16x16x32_bf16 v[112:115], a[236:239], v[184:187], v[112:115]
    ds_read_b64_tr_b16 a[172:173], v15 offset:24576
    ds_read_b64_tr_b16 a[174:175], v15 offset:28672
    v_mfma_f32_16x16x32_bf16 v[116:119], a[208:211], v[132:135], 0
    ds_read_b64_tr_b16 a[176:177], v19 offset:0
    v_mfma_f32_16x16x32_bf16 v[116:119], a[212:215], v[148:151], v[116:119]
    ds_read_b64_tr_b16 a[178:179], v19 offset:4096
    v_mfma_f32_16x16x32_bf16 v[116:119], a[216:219], v[196:199], v[116:119]
    ds_read_b64_tr_b16 a[180:181], v19 offset:8192
    v_mfma_f32_16x16x32_bf16 v[116:119], a[220:223], v[180:183], v[116:119]
    ds_read_b64_tr_b16 a[182:183], v19 offset:12288
    v_mfma_f32_16x16x32_bf16 v[116:119], a[224:227], v[140:143], v[116:119]
    ds_read_b64_tr_b16 a[184:185], v19 offset:16384
    v_cvt_pk_bf16_f32 v232, v112, v113
    v_mfma_f32_16x16x32_bf16 v[116:119], a[228:231], v[156:159], v[116:119]
    ds_read_b64_tr_b16 a[186:187], v19 offset:20480
    v_cvt_pk_bf16_f32 v233, v114, v115
    v_mfma_f32_16x16x32_bf16 v[116:119], a[232:235], v[204:207], v[116:119]
    ds_read_b64_tr_b16 a[188:189], v19 offset:24576
    v_mfma_f32_16x16x32_bf16 v[116:119], a[236:239], v[188:191], v[116:119]
    s_waitcnt lgkmcnt(13)
    ds_read_b64_tr_b16 a[190:191], v19 offset:28672
    s_barrier
    v_mfma_f32_16x16x32_bf16 v[120:123], a[160:163], v[128:131], 0
    s_waitcnt lgkmcnt(12)
    buffer_load_dword v11, v8, s[24:27], s54 offen offset:8 sc1
    v_mfma_f32_16x16x32_bf16 v[120:123], a[164:167], v[144:147], v[120:123]
    s_waitcnt lgkmcnt(10)
    ds_read_b64_tr_b16 a[208:209], v20 offset:0
    ds_read_b64_tr_b16 a[210:211], v20 offset:4096
    v_mfma_f32_16x16x32_bf16 v[120:123], a[168:171], v[192:195], v[120:123]
    s_waitcnt lgkmcnt(10)
    ds_read_b64_tr_b16 a[212:213], v20 offset:8192
    v_mfma_f32_16x16x32_bf16 v[120:123], a[172:175], v[176:179], v[120:123]
    s_waitcnt lgkmcnt(9)
    ds_read_b64_tr_b16 a[214:215], v20 offset:12288
    v_mfma_f32_16x16x32_bf16 v[120:123], a[176:179], v[136:139], v[120:123]
    s_waitcnt lgkmcnt(8)
    ds_read_b64_tr_b16 a[216:217], v20 offset:16384
    v_cvt_pk_bf16_f32 v236, v116, v117
    v_mfma_f32_16x16x32_bf16 v[120:123], a[180:183], v[152:155], v[120:123]
    s_waitcnt lgkmcnt(7)
    ds_read_b64_tr_b16 a[218:219], v20 offset:20480
    v_cvt_pk_bf16_f32 v237, v118, v119
    v_mfma_f32_16x16x32_bf16 v[120:123], a[184:187], v[200:203], v[120:123]
    s_waitcnt lgkmcnt(6)
    s_add_u32 s49, s46, 73728
    ds_read_b64_tr_b16 a[220:221], v20 offset:24576
    v_mfma_f32_16x16x32_bf16 v[120:123], a[188:191], v[184:187], v[120:123]
    s_add_u32 m0, s42, 114688
    ds_read_b64_tr_b16 a[222:223], v20 offset:28672
    v_mfma_f32_16x16x32_bf16 v[124:127], a[160:163], v[132:135], 0
    buffer_load_dwordx4 v46, s[20:23], s49 offen lds
    v_mfma_f32_16x16x32_bf16 v[124:127], a[164:167], v[148:151], v[124:127]
    ds_read_b64_tr_b16 a[224:225], v24 offset:0
    ds_read_b64_tr_b16 a[226:227], v24 offset:4096
    v_mfma_f32_16x16x32_bf16 v[124:127], a[168:171], v[196:199], v[124:127]
    buffer_load_dwordx4 v47, s[20:23], s49 offen offset:1024 lds
    v_mfma_f32_16x16x32_bf16 v[124:127], a[172:175], v[180:183], v[124:127]
    ds_read_b64_tr_b16 a[228:229], v24 offset:8192
    ds_read_b64_tr_b16 a[230:231], v24 offset:12288
    v_mfma_f32_16x16x32_bf16 v[124:127], a[176:179], v[140:143], v[124:127]
    ds_read_b64_tr_b16 a[232:233], v24 offset:16384
    v_cvt_pk_bf16_f32 v234, v120, v121
    v_mfma_f32_16x16x32_bf16 v[124:127], a[180:183], v[156:159], v[124:127]
    s_add_u32 s38, s56, 16512
    ds_read_b64_tr_b16 a[234:235], v24 offset:20480
    v_cvt_pk_bf16_f32 v235, v122, v123
    v_mfma_f32_16x16x32_bf16 v[124:127], a[184:187], v[204:207], v[124:127]
    buffer_store_dwordx4 v[232:235], v56, s[28:31], s38 offen sc1
    v_mfma_f32_16x16x32_bf16 v[124:127], a[188:191], v[188:191], v[124:127]
    s_waitcnt lgkmcnt(12)
    ds_read_b64_tr_b16 a[236:237], v24 offset:24576
    ds_read_b64_tr_b16 a[238:239], v24 offset:28672
    v_mfma_f32_16x16x32_bf16 v[64:67], a[208:211], v[128:131], 0
    s_waitcnt lgkmcnt(12)
    buffer_load_dwordx4 v48, s[20:23], s49 offen offset:2048 lds
    v_mfma_f32_16x16x32_bf16 v[64:67], a[212:215], v[144:147], v[64:67]
    s_waitcnt lgkmcnt(10)
    ds_read_b64_tr_b16 a[160:161], v21 offset:0
    ds_read_b64_tr_b16 a[162:163], v21 offset:4096
    v_mfma_f32_16x16x32_bf16 v[64:67], a[216:219], v[192:195], v[64:67]
    s_waitcnt lgkmcnt(10)
    buffer_load_dwordx4 v49, s[20:23], s49 offen offset:3072 lds
    v_mfma_f32_16x16x32_bf16 v[64:67], a[220:223], v[176:179], v[64:67]
    s_waitcnt lgkmcnt(8)
    ds_read_b64_tr_b16 a[164:165], v21 offset:8192
    ds_read_b64_tr_b16 a[166:167], v21 offset:12288
    v_mfma_f32_16x16x32_bf16 v[64:67], a[224:227], v[136:139], v[64:67]
    s_waitcnt lgkmcnt(8)
    ds_read_b64_tr_b16 a[168:169], v21 offset:16384
    v_cvt_pk_bf16_f32 v238, v124, v125
    v_mfma_f32_16x16x32_bf16 v[64:67], a[228:231], v[152:155], v[64:67]
    s_waitcnt lgkmcnt(7)
    s_add_u32 s38, s56, 180352
    ds_read_b64_tr_b16 a[170:171], v21 offset:20480
    v_cvt_pk_bf16_f32 v239, v126, v127
    v_mfma_f32_16x16x32_bf16 v[64:67], a[232:235], v[200:203], v[64:67]
    s_waitcnt lgkmcnt(6)
    buffer_store_dwordx4 v[236:239], v56, s[28:31], s38 offen sc1
    v_mfma_f32_16x16x32_bf16 v[64:67], a[236:239], v[184:187], v[64:67]
    ds_read_b64_tr_b16 a[172:173], v21 offset:24576
    ds_read_b64_tr_b16 a[174:175], v21 offset:28672
    v_mfma_f32_16x16x32_bf16 v[68:71], a[208:211], v[132:135], 0
    s_lshl_b32 s40, s5, 4
    ds_read_b64_tr_b16 a[176:177], v25 offset:0
    v_mfma_f32_16x16x32_bf16 v[68:71], a[212:215], v[148:151], v[68:71]
    s_add_u32 s40, s40, s4
    ds_read_b64_tr_b16 a[178:179], v25 offset:4096
    v_and_b32 v240, 31, v1
    v_mfma_f32_16x16x32_bf16 v[68:71], a[216:219], v[196:199], v[68:71]
    ds_read_b64_tr_b16 a[180:181], v25 offset:8192
    v_lshrrev_b32 v241, 5, v1
    v_mfma_f32_16x16x32_bf16 v[68:71], a[220:223], v[180:183], v[68:71]
    ds_read_b64_tr_b16 a[182:183], v25 offset:12288
    v_cmp_gt_u32 vcc, 8, v240
    v_mfma_f32_16x16x32_bf16 v[68:71], a[224:227], v[140:143], v[68:71]
    ds_read_b64_tr_b16 a[184:185], v25 offset:16384
    v_mov_b32 v242, 2147483648
    v_mfma_f32_16x16x32_bf16 v[68:71], a[228:231], v[156:159], v[68:71]
    s_lshl_b32 s43, s40, 3
    ds_read_b64_tr_b16 a[186:187], v25 offset:20480
    v_mfma_f32_16x16x32_bf16 v[68:71], a[232:235], v[204:207], v[68:71]
    s_lshl_b32 s44, s3, 1
    ds_read_b64_tr_b16 a[188:189], v25 offset:24576
    v_mfma_f32_16x16x32_bf16 v[68:71], a[236:239], v[188:191], v[68:71]
    s_waitcnt lgkmcnt(13)
    s_add_u32 s43, s43, s44
    ds_read_b64_tr_b16 a[190:191], v25 offset:28672
    v_cndmask_b32 v242, v242, 0, vcc
    v_mfma_f32_16x16x32_bf16 v[72:75], a[160:163], v[128:131], 0
    s_waitcnt lgkmcnt(12)
    ds_read_b64_tr_b16 a[208:209], v22 offset:0
    v_add_u32 v7, s43, v241
    v_mfma_f32_16x16x32_bf16 v[72:75], a[164:167], v[144:147], v[72:75]
    s_waitcnt lgkmcnt(11)
    ds_read_b64_tr_b16 a[210:211], v22 offset:4096
    v_lshlrev_b32 v5, 4, v240
    v_mfma_f32_16x16x32_bf16 v[72:75], a[168:171], v[192:195], v[72:75]
    s_waitcnt lgkmcnt(10)
    ds_read_b64_tr_b16 a[212:213], v22 offset:8192
    v_lshlrev_b32 v243, 4, v241
    v_mfma_f32_16x16x32_bf16 v[72:75], a[172:175], v[176:179], v[72:75]
    s_waitcnt lgkmcnt(9)
    ds_read_b64_tr_b16 a[214:215], v22 offset:12288
    v_lshl_add_u32 v2, v240, 5, v243
    v_mfma_f32_16x16x32_bf16 v[72:75], a[176:179], v[136:139], v[72:75]
    s_waitcnt lgkmcnt(8)
    ds_read_b64_tr_b16 a[216:217], v22 offset:16384
    v_lshrrev_b32 v243, 4, v240
    v_mfma_f32_16x16x32_bf16 v[72:75], a[180:183], v[152:155], v[72:75]
    s_waitcnt lgkmcnt(7)
    ds_read_b64_tr_b16 a[218:219], v22 offset:20480
    v_mul_u32_u24 v243, 1536, v243
    v_mfma_f32_16x16x32_bf16 v[72:75], a[184:187], v[200:203], v[72:75]
    s_waitcnt lgkmcnt(6)
    ds_read_b64_tr_b16 a[220:221], v22 offset:24576
    v_add_u32 v2, v2, v243
    v_mfma_f32_16x16x32_bf16 v[72:75], a[188:191], v[184:187], v[72:75]
    s_mul_i32 s44, s43, 10240
    ds_read_b64_tr_b16 a[222:223], v22 offset:28672
    v_lshrrev_b32 v243, 2, v240
    v_mfma_f32_16x16x32_bf16 v[76:79], a[160:163], v[132:135], 0
    ds_read_b64_tr_b16 a[224:225], v26 offset:0
    v_lshlrev_b32 v243, 6, v243
    v_mfma_f32_16x16x32_bf16 v[76:79], a[164:167], v[148:151], v[76:79]
    ds_read_b64_tr_b16 a[226:227], v26 offset:4096
    v_and_b32 v241, 3, v240
    v_mfma_f32_16x16x32_bf16 v[76:79], a[168:171], v[196:199], v[76:79]
    ds_read_b64_tr_b16 a[228:229], v26 offset:8192
    v_lshl_add_u32 v3, v241, 3, v243
    v_mfma_f32_16x16x32_bf16 v[76:79], a[172:175], v[180:183], v[76:79]
    ds_read_b64_tr_b16 a[230:231], v26 offset:12288
    v_mul_u32_u24 v243, 1152, v7
    v_mfma_f32_16x16x32_bf16 v[76:79], a[176:179], v[140:143], v[76:79]
    ds_read_b64_tr_b16 a[232:233], v26 offset:16384
    v_add_u32 v4, v243, v3
    v_mfma_f32_16x16x32_bf16 v[76:79], a[180:183], v[156:159], v[76:79]
    ds_read_b64_tr_b16 a[234:235], v26 offset:20480
    v_lshl_add_u32 v6, v243, 1, v5
    v_mfma_f32_16x16x32_bf16 v[76:79], a[184:187], v[204:207], v[76:79]
    ds_read_b64_tr_b16 a[236:237], v26 offset:24576
    v_or_b32 v55, v3, v242
    v_mfma_f32_16x16x32_bf16 v[76:79], a[188:191], v[188:191], v[76:79]
    s_waitcnt lgkmcnt(13)
    ds_read_b64_tr_b16 a[238:239], v26 offset:28672
    v_or_b32 v58, v4, v242
    v_mfma_f32_16x16x32_bf16 v[80:83], a[208:211], v[128:131], 0
    s_waitcnt lgkmcnt(12)
    ds_read_b64_tr_b16 a[160:161], v23 offset:0
    v_or_b32 v59, v5, v242
    v_mfma_f32_16x16x32_bf16 v[80:83], a[212:215], v[144:147], v[80:83]
    s_waitcnt lgkmcnt(11)
    ds_read_b64_tr_b16 a[162:163], v23 offset:4096
    v_or_b32 v60, v6, v242
    v_mfma_f32_16x16x32_bf16 v[80:83], a[216:219], v[192:195], v[80:83]
    s_waitcnt lgkmcnt(10)
    ds_read_b64_tr_b16 a[164:165], v23 offset:8192
    s_waitcnt vmcnt(6)
    v_readfirstlane_b32 s36, v11
    v_mfma_f32_16x16x32_bf16 v[80:83], a[220:223], v[176:179], v[80:83]
    s_waitcnt lgkmcnt(9)
    ds_read_b64_tr_b16 a[166:167], v23 offset:12288
    v_lshrrev_b32 v243, 4, v1
    v_mfma_f32_16x16x32_bf16 v[80:83], a[224:227], v[136:139], v[80:83]
    ds_read_b64_tr_b16 a[168:169], v23 offset:16384
    v_lshlrev_b32 v243, 8, v243
    s_cmp_lg_u32 s36, s95
    s_cbranch_scc1 Lattn_xspin
Lattn_xgot:
    s_waitcnt lgkmcnt(9)
    v_mfma_f32_16x16x32_bf16 v[80:83], a[228:231], v[152:155], v[80:83]
    s_waitcnt lgkmcnt(7)
    ds_read_b64_tr_b16 a[170:171], v23 offset:20480
    v_and_b32 v241, 7, v1
    v_mfma_f32_16x16x32_bf16 v[80:83], a[232:235], v[200:203], v[80:83]
    s_waitcnt lgkmcnt(6)
    ds_read_b64_tr_b16 a[172:173], v23 offset:24576
    v_lshl_add_u32 v243, v241, 5, v243
    v_mfma_f32_16x16x32_bf16 v[80:83], a[236:239], v[184:187], v[80:83]
    s_add_u32 s37, s55, 0
    ds_read_b64_tr_b16 a[174:175], v23 offset:28672
    v_and_b32 v241, 8, v1
    v_mfma_f32_16x16x32_bf16 v[84:87], a[208:211], v[132:135], 0
    buffer_load_dwordx4 a[64:67], v252, s[28:31], s37 offen offset:0 sc1
    v_mfma_f32_16x16x32_bf16 v[84:87], a[212:215], v[148:151], v[84:87]
    ds_read_b64_tr_b16 a[176:177], v27 offset:0
    ds_read_b64_tr_b16 a[178:179], v27 offset:4096
    v_mfma_f32_16x16x32_bf16 v[84:87], a[216:219], v[196:199], v[84:87]
    buffer_load_dwordx4 a[68:71], v252, s[28:31], s37 offen offset:1024 sc1
    v_mfma_f32_16x16x32_bf16 v[84:87], a[220:223], v[180:183], v[84:87]
    ds_read_b64_tr_b16 a[180:181], v27 offset:8192
    ds_read_b64_tr_b16 a[182:183], v27 offset:12288
    v_mfma_f32_16x16x32_bf16 v[84:87], a[224:227], v[140:143], v[84:87]
    ds_read_b64_tr_b16 a[184:185], v27 offset:16384
    v_lshl_add_u32 v54, v241, 1, v243
    v_mfma_f32_16x16x32_bf16 v[84:87], a[228:231], v[156:159], v[84:87]
    s_lshr_b32 s41, s2, 3
    ds_read_b64_tr_b16 a[186:187], v27 offset:20480
    v_mfma_f32_16x16x32_bf16 v[84:87], a[232:235], v[204:207], v[84:87]
    buffer_load_dwordx4 a[72:75], v252, s[28:31], s37 offen offset:2048 sc1
    v_mfma_f32_16x16x32_bf16 v[84:87], a[236:239], v[188:191], v[84:87]
    s_waitcnt lgkmcnt(12)
    s_mov_b32 s14, 2359296
    ds_read_b64_tr_b16 a[188:189], v27 offset:24576
    ds_read_b64_tr_b16 a[190:191], v27 offset:28672
    s_barrier
    v_mfma_f32_16x16x32_bf16 v[88:91], a[160:163], v[128:131], 0
    s_waitcnt lgkmcnt(12)
    s_mov_b32 s15, 0x20000
    ds_read_b64_tr_b16 a[208:209], v12 offset:32768
    v_mfma_f32_16x16x32_bf16 v[88:91], a[164:167], v[144:147], v[88:91]
    s_waitcnt lgkmcnt(11)
    s_mov_b32 s18, 2359296
    ds_read_b64_tr_b16 a[210:211], v12 offset:36864
    v_mfma_f32_16x16x32_bf16 v[88:91], a[168:171], v[192:195], v[88:91]
    s_waitcnt lgkmcnt(10)
    buffer_load_dwordx4 a[76:79], v252, s[28:31], s37 offen offset:3072 sc1
    v_mfma_f32_16x16x32_bf16 v[88:91], a[172:175], v[176:179], v[88:91]
    s_waitcnt lgkmcnt(8)
    s_mov_b32 s19, 0x20000
    ds_read_b64_tr_b16 a[212:213], v12 offset:40960
    ds_read_b64_tr_b16 a[214:215], v12 offset:45056
    v_mfma_f32_16x16x32_bf16 v[88:91], a[176:179], v[136:139], v[88:91]
    s_waitcnt lgkmcnt(8)
    s_add_u32 s8, s50, 7864320
    s_addc_u32 s9, s51, 0
    ds_read_b64_tr_b16 a[216:217], v12 offset:49152
    v_mfma_f32_16x16x32_bf16 v[88:91], a[180:183], v[152:155], v[88:91]
    s_waitcnt lgkmcnt(7)
    s_add_u32 s37, s55, 4096
    ds_read_b64_tr_b16 a[218:219], v12 offset:53248
    v_mfma_f32_16x16x32_bf16 v[88:91], a[184:187], v[200:203], v[88:91]
    s_waitcnt lgkmcnt(6)
    s_add_u32 s49, s46, 256
    buffer_load_dwordx4 a[80:83], v252, s[28:31], s37 offen offset:0 sc1
    v_mfma_f32_16x16x32_bf16 v[88:91], a[188:191], v[184:187], v[88:91]
    s_add_u32 m0, s42, 0
    ds_read_b64_tr_b16 a[220:221], v12 offset:57344
    ds_read_b64_tr_b16 a[222:223], v12 offset:61440
    v_mfma_f32_16x16x32_bf16 v[92:95], a[160:163], v[132:135], 0
    buffer_load_dwordx4 v46, s[20:23], s49 offen lds
    v_mfma_f32_16x16x32_bf16 v[92:95], a[164:167], v[148:151], v[92:95]
    s_mov_b32 s10, 663552
    ds_read_b64_tr_b16 a[224:225], v16 offset:32768
    ds_read_b64_tr_b16 a[226:227], v16 offset:36864
    v_mfma_f32_16x16x32_bf16 v[92:95], a[168:171], v[196:199], v[92:95]
    buffer_load_dwordx4 v47, s[20:23], s49 offen offset:1024 lds
    v_mfma_f32_16x16x32_bf16 v[92:95], a[172:175], v[180:183], v[92:95]
    s_mov_b32 s11, 0x20000
    ds_read_b64_tr_b16 a[228:229], v16 offset:40960
    ds_read_b64_tr_b16 a[230:231], v16 offset:45056
    v_mfma_f32_16x16x32_bf16 v[92:95], a[176:179], v[140:143], v[92:95]
    buffer_load_dwordx4 a[84:87], v252, s[28:31], s37 offen offset:1024 sc1
    v_mfma_f32_16x16x32_bf16 v[92:95], a[180:183], v[156:159], v[92:95]
    s_lshl_b32 s39, s5, 13
    ds_read_b64_tr_b16 a[232:233], v16 offset:49152
    ds_read_b64_tr_b16 a[234:235], v16 offset:53248
    v_mfma_f32_16x16x32_bf16 v[92:95], a[184:187], v[204:207], v[92:95]
    s_add_u32 s39, s39, 8781824
    ds_read_b64_tr_b16 a[236:237], v16 offset:57344
    v_mfma_f32_16x16x32_bf16 v[92:95], a[188:191], v[188:191], v[92:95]
    s_waitcnt lgkmcnt(13)
    s_lshr_b32 s45, s4, 2
    ds_read_b64_tr_b16 a[238:239], v16 offset:61440
    v_mfma_f32_16x16x32_bf16 v[96:99], a[208:211], v[128:131], 0
    s_waitcnt lgkmcnt(12)
    buffer_load_dwordx4 v48, s[20:23], s49 offen offset:2048 lds
    v_mfma_f32_16x16x32_bf16 v[96:99], a[212:215], v[144:147], v[96:99]
    s_waitcnt lgkmcnt(10)
    s_lshl_b32 s45, s45, 11
    ds_read_b64_tr_b16 a[160:161], v13 offset:32768
    ds_read_b64_tr_b16 a[162:163], v13 offset:36864
    v_mfma_f32_16x16x32_bf16 v[96:99], a[216:219], v[192:195], v[96:99]
    s_waitcnt lgkmcnt(10)
    buffer_load_dwordx4 v49, s[20:23], s49 offen offset:3072 lds
    v_mfma_f32_16x16x32_bf16 v[96:99], a[220:223], v[176:179], v[96:99]
    s_waitcnt lgkmcnt(8)
    s_add_u32 s39, s39, s45
    ds_read_b64_tr_b16 a[164:165], v13 offset:40960
    ds_read_b64_tr_b16 a[166:167], v13 offset:45056
    v_mfma_f32_16x16x32_bf16 v[96:99], a[224:227], v[136:139], v[96:99]
    s_waitcnt lgkmcnt(8)
    buffer_load_dwordx4 a[88:91], v252, s[28:31], s37 offen offset:2048 sc1
    v_mfma_f32_16x16x32_bf16 v[96:99], a[228:231], v[152:155], v[96:99]
    s_waitcnt lgkmcnt(6)
    ds_read_b64_tr_b16 a[168:169], v13 offset:49152
    ds_read_b64_tr_b16 a[170:171], v13 offset:53248
    v_mfma_f32_16x16x32_bf16 v[96:99], a[232:235], v[200:203], v[96:99]
    s_waitcnt lgkmcnt(6)
    s_add_u32 s49, s46, 73984
    ds_read_b64_tr_b16 a[172:173], v13 offset:57344
    v_and_b32 v9, 15, v1
    v_mfma_f32_16x16x32_bf16 v[96:99], a[236:239], v[184:187], v[96:99]
    s_add_u32 m0, s42, 16384
    ds_read_b64_tr_b16 a[174:175], v13 offset:61440
    v_lshlrev_b32 v9, 7, v9
    v_mfma_f32_16x16x32_bf16 v[100:103], a[208:211], v[132:135], 0
    buffer_load_dwordx4 v46, s[20:23], s49 offen lds
    v_mfma_f32_16x16x32_bf16 v[100:103], a[212:215], v[148:151], v[100:103]
    ds_read_b64_tr_b16 a[176:177], v17 offset:32768
    ds_read_b64_tr_b16 a[178:179], v17 offset:36864
    v_mfma_f32_16x16x32_bf16 v[100:103], a[216:219], v[196:199], v[100:103]
    buffer_load_dwordx4 v47, s[20:23], s49 offen offset:1024 lds
    v_mfma_f32_16x16x32_bf16 v[100:103], a[220:223], v[180:183], v[100:103]
    ds_read_b64_tr_b16 a[180:181], v17 offset:40960
    ds_read_b64_tr_b16 a[182:183], v17 offset:45056
    v_mfma_f32_16x16x32_bf16 v[100:103], a[224:227], v[140:143], v[100:103]
    buffer_load_dwordx4 a[92:95], v252, s[28:31], s37 offen offset:3072 sc1
    v_mfma_f32_16x16x32_bf16 v[100:103], a[228:231], v[156:159], v[100:103]
    ds_read_b64_tr_b16 a[184:185], v17 offset:49152
    ds_read_b64_tr_b16 a[186:187], v17 offset:53248
    v_mfma_f32_16x16x32_bf16 v[100:103], a[232:235], v[204:207], v[100:103]
    ds_read_b64_tr_b16 a[188:189], v17 offset:57344
    v_mfma_f32_16x16x32_bf16 v[100:103], a[236:239], v[188:191], v[100:103]
    s_waitcnt lgkmcnt(13)
    ds_read_b64_tr_b16 a[190:191], v17 offset:61440
    v_mfma_f32_16x16x32_bf16 v[104:107], a[160:163], v[128:131], 0
    s_waitcnt lgkmcnt(12)
    buffer_load_dwordx4 v48, s[20:23], s49 offen offset:2048 lds
    v_mfma_f32_16x16x32_bf16 v[104:107], a[164:167], v[144:147], v[104:107]
    s_waitcnt lgkmcnt(10)
    ds_read_b64_tr_b16 a[208:209], v14 offset:32768
    ds_read_b64_tr_b16 a[210:211], v14 offset:36864
    v_mfma_f32_16x16x32_bf16 v[104:107], a[168:171], v[192:195], v[104:107]
    s_waitcnt lgkmcnt(10)
    buffer_load_dwordx4 v49, s[20:23], s49 offen offset:3072 lds
    v_mfma_f32_16x16x32_bf16 v[104:107], a[172:175], v[176:179], v[104:107]
    s_waitcnt lgkmcnt(8)
    s_add_u32 s37, s55, 8192
    ds_read_b64_tr_b16 a[212:213], v14 offset:40960
    ds_read_b64_tr_b16 a[214:215], v14 offset:45056
    v_mfma_f32_16x16x32_bf16 v[104:107], a[176:179], v[136:139], v[104:107]
    s_waitcnt lgkmcnt(8)
    buffer_load_dwordx4 a[96:99], v252, s[28:31], s37 offen offset:0 sc1
    v_mfma_f32_16x16x32_bf16 v[104:107], a[180:183], v[152:155], v[104:107]
    s_waitcnt lgkmcnt(6)
    ds_read_b64_tr_b16 a[216:217], v14 offset:49152
    ds_read_b64_tr_b16 a[218:219], v14 offset:53248
    v_mfma_f32_16x16x32_bf16 v[104:107], a[184:187], v[200:203], v[104:107]
    s_waitcnt lgkmcnt(6)
    buffer_load_dwordx4 a[100:103], v252, s[28:31], s37 offen offset:1024 sc1
    v_mfma_f32_16x16x32_bf16 v[104:107], a[188:191], v[184:187], v[104:107]
Ltour9:
    s_cbranch_execz Ltour13
    ds_read_b64_tr_b16 a[220:221], v14 offset:57344
    ds_read_b64_tr_b16 a[222:223], v14 offset:61440
    v_mfma_f32_16x16x32_bf16 v[108:111], a[160:163], v[132:135], 0
    ds_read_b64_tr_b16 a[224:225], v18 offset:32768
    v_mfma_f32_16x16x32_bf16 v[108:111], a[164:167], v[148:151], v[108:111]
    ds_read_b64_tr_b16 a[226:227], v18 offset:36864
    v_mfma_f32_16x16x32_bf16 v[108:111], a[168:171], v[196:199], v[108:111]
    buffer_load_dwordx4 a[104:107], v252, s[28:31], s37 offen offset:2048 sc1
    v_mfma_f32_16x16x32_bf16 v[108:111], a[172:175], v[180:183], v[108:111]
    ds_read_b64_tr_b16 a[228:229], v18 offset:40960
    ds_read_b64_tr_b16 a[230:231], v18 offset:45056
    v_mfma_f32_16x16x32_bf16 v[108:111], a[176:179], v[140:143], v[108:111]
    ds_read_b64_tr_b16 a[232:233], v18 offset:49152
    v_mfma_f32_16x16x32_bf16 v[108:111], a[180:183], v[156:159], v[108:111]
    ds_read_b64_tr_b16 a[234:235], v18 offset:53248
    v_mfma_f32_16x16x32_bf16 v[108:111], a[184:187], v[204:207], v[108:111]
    buffer_load_dwordx4 a[108:111], v252, s[28:31], s37 offen offset:3072 sc1
    v_mfma_f32_16x16x32_bf16 v[108:111], a[188:191], v[188:191], v[108:111]
    s_waitcnt lgkmcnt(12)
    ds_read_b64_tr_b16 a[236:237], v18 offset:57344
    ds_read_b64_tr_b16 a[238:239], v18 offset:61440
    v_mfma_f32_16x16x32_bf16 v[112:115], a[208:211], v[128:131], 0
    s_waitcnt lgkmcnt(12)
    ds_read_b64_tr_b16 a[160:161], v15 offset:32768
    v_mfma_f32_16x16x32_bf16 v[112:115], a[212:215], v[144:147], v[112:115]
    s_waitcnt lgkmcnt(11)
    s_add_u32 s37, s55, 12288
    ds_read_b64_tr_b16 a[162:163], v15 offset:36864
    v_mfma_f32_16x16x32_bf16 v[112:115], a[216:219], v[192:195], v[112:115]
    s_waitcnt lgkmcnt(10)
    buffer_load_dwordx4 a[112:115], v252, s[28:31], s37 offen offset:0 sc1
    v_mfma_f32_16x16x32_bf16 v[112:115], a[220:223], v[176:179], v[112:115]
    s_waitcnt lgkmcnt(8)
    ds_read_b64_tr_b16 a[164:165], v15 offset:40960
    ds_read_b64_tr_b16 a[166:167], v15 offset:45056
    v_mfma_f32_16x16x32_bf16 v[112:115], a[224:227], v[136:139], v[112:115]
    s_waitcnt lgkmcnt(8)
    buffer_load_dwordx4 a[116:119], v252, s[28:31], s37 offen offset:1024 sc1
    v_mfma_f32_16x16x32_bf16 v[112:115], a[228:231], v[152:155], v[112:115]
    s_waitcnt lgkmcnt(6)
    ds_read_b64_tr_b16 a[168:169], v15 offset:49152
    ds_read_b64_tr_b16 a[170:171], v15 offset:53248
    v_mfma_f32_16x16x32_bf16 v[112:115], a[232:235], v[200:203], v[112:115]
    s_waitcnt lgkmcnt(6)
    ds_read_b64_tr_b16 a[172:173], v15 offset:57344
    v_mfma_f32_16x16x32_bf16 v[112:115], a[236:239], v[184:187], v[112:115]
    ds_read_b64_tr_b16 a[174:175], v15 offset:61440
    v_mfma_f32_16x16x32_bf16 v[116:119], a[208:211], v[132:135], 0
    buffer_load_dwordx4 a[120:123], v252, s[28:31], s37 offen offset:2048 sc1
    v_mfma_f32_16x16x32_bf16 v[116:119], a[212:215], v[148:151], v[116:119]
    ds_read_b64_tr_b16 a[176:177], v19 offset:32768
    ds_read_b64_tr_b16 a[178:179], v19 offset:36864
    v_mfma_f32_16x16x32_bf16 v[116:119], a[216:219], v[196:199], v[116:119]
    ds_read_b64_tr_b16 a[180:181], v19 offset:40960
    v_mfma_f32_16x16x32_bf16 v[116:119], a[220:223], v[180:183], v[116:119]
    ds_read_b64_tr_b16 a[182:183], v19 offset:45056
    v_mfma_f32_16x16x32_bf16 v[116:119], a[224:227], v[140:143], v[116:119]
    buffer_load_dwordx4 a[124:127], v252, s[28:31], s37 offen offset:3072 sc1
    v_mfma_f32_16x16x32_bf16 v[116:119], a[228:231], v[156:159], v[116:119]
    ds_read_b64_tr_b16 a[184:185], v19 offset:49152
    ds_read_b64_tr_b16 a[186:187], v19 offset:53248
    v_mfma_f32_16x16x32_bf16 v[116:119], a[232:235], v[204:207], v[116:119]
    ds_read_b64_tr_b16 a[188:189], v19 offset:57344
    v_mfma_f32_16x16x32_bf16 v[116:119], a[236:239], v[188:191], v[116:119]
    ds_read_b64_tr_b16 a[190:191], v19 offset:61440
    s_waitcnt vmcnt(25)
    s_waitcnt lgkmcnt(0)
    s_barrier
    v_mfma_f32_16x16x32_bf16 v[120:123], a[160:163], v[128:131], 0
    ds_read_b64_tr_b16 a[208:209], v20 offset:32768
    v_mfma_f32_16x16x32_bf16 v[120:123], a[164:167], v[144:147], v[120:123]
    ds_read_b64_tr_b16 a[210:211], v20 offset:36864
    v_mfma_f32_16x16x32_bf16 v[120:123], a[168:171], v[192:195], v[120:123]
    ds_read_b64_tr_b16 a[212:213], v20 offset:40960
    v_mfma_f32_16x16x32_bf16 v[120:123], a[172:175], v[176:179], v[120:123]
    ds_read_b64_tr_b16 a[214:215], v20 offset:45056
    v_mfma_f32_16x16x32_bf16 v[120:123], a[176:179], v[136:139], v[120:123]
    ds_read_b64_tr_b16 a[216:217], v20 offset:49152
    v_mfma_f32_16x16x32_bf16 v[120:123], a[180:183], v[152:155], v[120:123]
    ds_read_b64_tr_b16 a[218:219], v20 offset:53248
    v_mfma_f32_16x16x32_bf16 v[120:123], a[184:187], v[200:203], v[120:123]
    s_add_u32 s49, s7, 512
    ds_read_b64_tr_b16 a[220:221], v20 offset:57344
    v_mfma_f32_16x16x32_bf16 v[120:123], a[188:191], v[184:187], v[120:123]
    s_add_u32 m0, s42, 65536
    ds_read_b64_tr_b16 a[222:223], v20 offset:61440
    v_mfma_f32_16x16x32_bf16 v[124:127], a[160:163], v[132:135], 0
    buffer_load_dwordx4 v46, s[20:23], s49 offen lds
    v_mfma_f32_16x16x32_bf16 v[124:127], a[164:167], v[148:151], v[124:127]
    ds_read_b64_tr_b16 a[224:225], v24 offset:32768
    ds_read_b64_tr_b16 a[226:227], v24 offset:36864
    v_mfma_f32_16x16x32_bf16 v[124:127], a[168:171], v[196:199], v[124:127]
    buffer_load_dwordx4 v47, s[20:23], s49 offen offset:1024 lds
    v_mfma_f32_16x16x32_bf16 v[124:127], a[172:175], v[180:183], v[124:127]
    ds_read_b64_tr_b16 a[228:229], v24 offset:40960
    ds_read_b64_tr_b16 a[230:231], v24 offset:45056
    v_mfma_f32_16x16x32_bf16 v[124:127], a[176:179], v[140:143], v[124:127]
    ds_read_b64_tr_b16 a[232:233], v24 offset:49152
    v_mfma_f32_16x16x32_bf16 v[124:127], a[180:183], v[156:159], v[124:127]
    ds_read_b64_tr_b16 a[234:235], v24 offset:53248
    v_mfma_f32_16x16x32_bf16 v[124:127], a[184:187], v[204:207], v[124:127]
    ds_read_b64_tr_b16 a[236:237], v24 offset:57344
    v_lshrrev_b32 v240, 4, v1
    v_mfma_f32_16x16x32_bf16 v[124:127], a[188:191], v[188:191], v[124:127]
    s_waitcnt vmcnt(25)
    s_waitcnt lgkmcnt(13)
    ds_read_b64_tr_b16 a[238:239], v24 offset:61440
    v_and_b32 v240, 2, v240
    v_mfma_f32_16x16x32_bf16 v[64:67], a[208:211], a[64:67], v[64:67]
    s_waitcnt vmcnt(24)
    s_waitcnt lgkmcnt(12)
    buffer_load_dwordx4 v48, s[20:23], s49 offen offset:2048 lds
    v_mfma_f32_16x16x32_bf16 v[64:67], a[212:215], a[68:71], v[64:67]
    s_waitcnt vmcnt(24)
    s_waitcnt lgkmcnt(10)
    ds_read_b64_tr_b16 a[160:161], v21 offset:32768
    ds_read_b64_tr_b16 a[162:163], v21 offset:36864
    v_mfma_f32_16x16x32_bf16 v[64:67], a[216:219], a[72:75], v[64:67]
    s_waitcnt vmcnt(23)
    s_waitcnt lgkmcnt(10)
    buffer_load_dwordx4 v49, s[20:23], s49 offen offset:3072 lds
    v_mfma_f32_16x16x32_bf16 v[64:67], a[220:223], a[76:79], v[64:67]
    s_waitcnt vmcnt(23)
    s_waitcnt lgkmcnt(8)
    ds_read_b64_tr_b16 a[164:165], v21 offset:40960
    ds_read_b64_tr_b16 a[166:167], v21 offset:45056
    v_mfma_f32_16x16x32_bf16 v[64:67], a[224:227], a[80:83], v[64:67]
    s_waitcnt vmcnt(20)
    s_waitcnt lgkmcnt(8)
    ds_read_b64_tr_b16 a[168:169], v21 offset:49152
    v_bfe_u32 v241, v1, 2, 2
    v_mfma_f32_16x16x32_bf16 v[64:67], a[228:231], a[84:87], v[64:67]
    s_waitcnt vmcnt(17)
    s_waitcnt lgkmcnt(7)
    ds_read_b64_tr_b16 a[170:171], v21 offset:53248
    v_cmp_eq_u32 s[54:55], v240, v241
    v_mfma_f32_16x16x32_bf16 v[64:67], a[232:235], a[88:91], v[64:67]
    s_waitcnt vmcnt(14)
    s_waitcnt lgkmcnt(6)
    s_add_u32 s49, s7, 74240
    ds_read_b64_tr_b16 a[172:173], v21 offset:57344
    v_or_b32 v240, 1, v240
    v_mfma_f32_16x16x32_bf16 v[64:67], a[236:239], a[92:95], v[64:67]
    s_waitcnt vmcnt(11)
    s_add_u32 m0, s42, 81920
    ds_read_b64_tr_b16 a[174:175], v21 offset:61440
    v_cmp_eq_u32 s[36:37], v240, v241
    v_mfma_f32_16x16x32_bf16 v[68:71], a[208:211], a[96:99], v[68:71]
    s_waitcnt vmcnt(10)
    buffer_load_dwordx4 v46, s[20:23], s49 offen lds
    v_mfma_f32_16x16x32_bf16 v[68:71], a[212:215], a[100:103], v[68:71]
    s_waitcnt vmcnt(10)
    ds_read_b64_tr_b16 a[176:177], v25 offset:32768
    ds_read_b64_tr_b16 a[178:179], v25 offset:36864
    v_mfma_f32_16x16x32_bf16 v[68:71], a[216:219], a[104:107], v[68:71]
    s_waitcnt vmcnt(9)
    buffer_load_dwordx4 v47, s[20:23], s49 offen offset:1024 lds
    v_mfma_f32_16x16x32_bf16 v[68:71], a[220:223], a[108:111], v[68:71]
    s_waitcnt vmcnt(9)
    ds_read_b64_tr_b16 a[180:181], v25 offset:40960
    ds_read_b64_tr_b16 a[182:183], v25 offset:45056
    v_mfma_f32_16x16x32_bf16 v[68:71], a[224:227], a[112:115], v[68:71]
    s_waitcnt vmcnt(8)
    ds_read_b64_tr_b16 a[184:185], v25 offset:49152
    v_cvt_pk_bf16_f32 v224, v64, v65
    v_mfma_f32_16x16x32_bf16 v[68:71], a[228:231], a[116:119], v[68:71]
    s_waitcnt vmcnt(7)
    ds_read_b64_tr_b16 a[186:187], v25 offset:53248
    v_cvt_pk_bf16_f32 v225, v66, v67
    v_mfma_f32_16x16x32_bf16 v[68:71], a[232:235], a[120:123], v[68:71]
    s_waitcnt vmcnt(6)
    buffer_load_dwordx2 v[36:37], v4, s[12:15], 0 offen offset:0
    v_mfma_f32_16x16x32_bf16 v[68:71], a[236:239], a[124:127], v[68:71]
    s_waitcnt lgkmcnt(12)
    ds_read_b64_tr_b16 a[188:189], v25 offset:57344
    ds_read_b64_tr_b16 a[190:191], v25 offset:61440
    v_mfma_f32_16x16x32_bf16 v[72:75], a[160:163], a[64:67], v[72:75]
    s_waitcnt lgkmcnt(12)
    buffer_load_dwordx4 v48, s[20:23], s49 offen offset:2048 lds
    v_mfma_f32_16x16x32_bf16 v[72:75], a[164:167], a[68:71], v[72:75]
    s_waitcnt lgkmcnt(10)
    ds_read_b64_tr_b16 a[208:209], v22 offset:32768
    ds_read_b64_tr_b16 a[210:211], v22 offset:36864
    v_mfma_f32_16x16x32_bf16 v[72:75], a[168:171], a[72:75], v[72:75]
    s_waitcnt lgkmcnt(10)
    buffer_load_dwordx4 v49, s[20:23], s49 offen offset:3072 lds
    v_mfma_f32_16x16x32_bf16 v[72:75], a[172:175], a[76:79], v[72:75]
    s_waitcnt lgkmcnt(8)
    ds_read_b64_tr_b16 a[212:213], v22 offset:40960
    ds_read_b64_tr_b16 a[214:215], v22 offset:45056
    v_mfma_f32_16x16x32_bf16 v[72:75], a[176:179], a[80:83], v[72:75]
    s_waitcnt lgkmcnt(8)
    ds_read_b64_tr_b16 a[216:217], v22 offset:49152
    v_cvt_pk_bf16_f32 v228, v68, v69
    v_mfma_f32_16x16x32_bf16 v[72:75], a[180:183], a[84:87], v[72:75]
    s_waitcnt lgkmcnt(7)
    ds_read_b64_tr_b16 a[218:219], v22 offset:53248
    v_cvt_pk_bf16_f32 v229, v70, v71
    v_mfma_f32_16x16x32_bf16 v[72:75], a[184:187], a[88:91], v[72:75]
    s_waitcnt lgkmcnt(6)
    ds_read_b64_tr_b16 a[220:221], v22 offset:57344
    v_and_b32 v240, 1, v1
    v_mfma_f32_16x16x32_bf16 v[72:75], a[188:191], a[92:95], v[72:75]
    ds_read_b64_tr_b16 a[222:223], v22 offset:61440
    v_lshlrev_b32 v240, 4, v240
    v_mfma_f32_16x16x32_bf16 v[76:79], a[160:163], a[96:99], v[76:79]
    buffer_load_dwordx2 v[38:39], v4, s[12:15], 0 offen offset:32
    v_mfma_f32_16x16x32_bf16 v[76:79], a[164:167], a[100:103], v[76:79]
    ds_read_b64_tr_b16 a[224:225], v26 offset:32768
    ds_read_b64_tr_b16 a[226:227], v26 offset:36864
    v_mfma_f32_16x16x32_bf16 v[76:79], a[168:171], a[104:107], v[76:79]
    ds_read_b64_tr_b16 a[228:229], v26 offset:40960
    v_mov_b32 v241, 0x3f80
    v_mfma_f32_16x16x32_bf16 v[76:79], a[172:175], a[108:111], v[76:79]
    ds_read_b64_tr_b16 a[230:231], v26 offset:45056
    v_lshlrev_b32 v240, v240, v241
    v_mfma_f32_16x16x32_bf16 v[76:79], a[176:179], a[112:115], v[76:79]
    ds_read_b64_tr_b16 a[232:233], v26 offset:49152
    v_cvt_pk_bf16_f32 v226, v72, v73
    v_mfma_f32_16x16x32_bf16 v[76:79], a[180:183], a[116:119], v[76:79]
    s_add_u32 s38, s93, 0
    ds_read_b64_tr_b16 a[234:235], v26 offset:53248
    v_cvt_pk_bf16_f32 v227, v74, v75
    v_mfma_f32_16x16x32_bf16 v[76:79], a[184:187], a[120:123], v[76:79]
    buffer_store_dwordx4 v[224:227], v56, s[28:31], s38 offen sc1
    v_mfma_f32_16x16x32_bf16 v[76:79], a[188:191], a[124:127], v[76:79]
    s_waitcnt lgkmcnt(12)
    ds_read_b64_tr_b16 a[236:237], v26 offset:57344
    ds_read_b64_tr_b16 a[238:239], v26 offset:61440
    v_mfma_f32_16x16x32_bf16 v[80:83], a[208:211], a[64:67], v[80:83]
    s_waitcnt lgkmcnt(12)
    ds_read_b64_tr_b16 a[160:161], v23 offset:32768
    v_bfe_i32 v241, v1, 1, 1
    v_mfma_f32_16x16x32_bf16 v[80:83], a[212:215], a[68:71], v[80:83]
    s_waitcnt lgkmcnt(11)
    ds_read_b64_tr_b16 a[162:163], v23 offset:36864
    v_and_b32 v243, v240, v241
    v_mfma_f32_16x16x32_bf16 v[80:83], a[216:219], a[72:75], v[80:83]
    s_waitcnt lgkmcnt(10)
    buffer_load_dwordx2 v[40:41], v4, s[12:15], 0 offen offset:512
    v_mfma_f32_16x16x32_bf16 v[80:83], a[220:223], a[76:79], v[80:83]
    s_waitcnt lgkmcnt(8)
    ds_read_b64_tr_b16 a[164:165], v23 offset:40960
    ds_read_b64_tr_b16 a[166:167], v23 offset:45056
    v_mfma_f32_16x16x32_bf16 v[80:83], a[224:227], a[80:83], v[80:83]
    s_waitcnt lgkmcnt(8)
    ds_read_b64_tr_b16 a[168:169], v23 offset:49152
    v_cvt_pk_bf16_f32 v230, v76, v77
    v_mfma_f32_16x16x32_bf16 v[80:83], a[228:231], a[84:87], v[80:83]
    s_waitcnt lgkmcnt(7)
    s_add_u32 s38, s93, 163840
    ds_read_b64_tr_b16 a[170:171], v23 offset:53248
    v_cvt_pk_bf16_f32 v231, v78, v79
    v_mfma_f32_16x16x32_bf16 v[80:83], a[232:235], a[88:91], v[80:83]
    s_waitcnt lgkmcnt(6)
    buffer_store_dwordx4 v[228:231], v56, s[28:31], s38 offen sc1
    v_mfma_f32_16x16x32_bf16 v[80:83], a[236:239], a[92:95], v[80:83]
    ds_read_b64_tr_b16 a[172:173], v23 offset:57344
    ds_read_b64_tr_b16 a[174:175], v23 offset:61440
    v_mfma_f32_16x16x32_bf16 v[84:87], a[208:211], a[96:99], v[84:87]
    ds_read_b64_tr_b16 a[176:177], v27 offset:32768
    v_xor_b32 v242, v240, v243
    v_mfma_f32_16x16x32_bf16 v[84:87], a[212:215], a[100:103], v[84:87]
    ds_read_b64_tr_b16 a[178:179], v27 offset:36864
    v_cndmask_b32 v246, 0, v242, s[54:55]
    v_mfma_f32_16x16x32_bf16 v[84:87], a[216:219], a[104:107], v[84:87]
    ds_read_b64_tr_b16 a[180:181], v27 offset:40960
    v_cndmask_b32 v247, 0, v243, s[54:55]
    v_mfma_f32_16x16x32_bf16 v[84:87], a[220:223], a[108:111], v[84:87]
    ds_read_b64_tr_b16 a[182:183], v27 offset:45056
    v_cndmask_b32 v250, 0, v242, s[36:37]
    v_mfma_f32_16x16x32_bf16 v[84:87], a[224:227], a[112:115], v[84:87]
    ds_read_b64_tr_b16 a[184:185], v27 offset:49152
    v_cvt_pk_bf16_f32 v232, v80, v81
    v_mfma_f32_16x16x32_bf16 v[84:87], a[228:231], a[116:119], v[84:87]
    ds_read_b64_tr_b16 a[186:187], v27 offset:53248
    v_cvt_pk_bf16_f32 v233, v82, v83
    v_mfma_f32_16x16x32_bf16 v[84:87], a[232:235], a[120:123], v[84:87]
    buffer_load_dwordx2 v[42:43], v4, s[12:15], 0 offen offset:544
    v_mfma_f32_16x16x32_bf16 v[84:87], a[236:239], a[124:127], v[84:87]
    s_waitcnt lgkmcnt(12)
    ds_read_b64_tr_b16 a[188:189], v27 offset:57344
    ds_read_b64_tr_b16 a[190:191], v27 offset:61440
    s_barrier
    v_mfma_f32_16x16x32_bf16 v[88:91], a[160:163], a[64:67], v[88:91]
    s_waitcnt lgkmcnt(12)
    ds_read_b64_tr_b16 a[208:209], v12 offset:0
    v_cndmask_b32 v251, 0, v243, s[36:37]
    v_mfma_f32_16x16x32_bf16 v[88:91], a[164:167], a[68:71], v[88:91]
    s_waitcnt lgkmcnt(11)
    ds_read_b64_tr_b16 a[210:211], v12 offset:4096
    v_mov_b32 v240, 0
    v_mfma_f32_16x16x32_bf16 v[88:91], a[168:171], a[72:75], v[88:91]
    s_waitcnt lgkmcnt(10)
    ds_read_b64_tr_b16 a[212:213], v12 offset:8192
    v_mov_b32 v241, 0
    v_mfma_f32_16x16x32_bf16 v[88:91], a[172:175], a[76:79], v[88:91]
    s_waitcnt lgkmcnt(9)
    ds_read_b64_tr_b16 a[214:215], v12 offset:12288
    v_mov_b32 v244, 0
    v_mfma_f32_16x16x32_bf16 v[88:91], a[176:179], a[80:83], v[88:91]
    s_waitcnt lgkmcnt(8)
    ds_read_b64_tr_b16 a[216:217], v12 offset:16384
    v_cvt_pk_bf16_f32 v236, v84, v85
    v_mfma_f32_16x16x32_bf16 v[88:91], a[180:183], a[84:87], v[88:91]
    s_waitcnt lgkmcnt(7)
    ds_read_b64_tr_b16 a[218:219], v12 offset:20480
    v_cvt_pk_bf16_f32 v237, v86, v87
    v_mfma_f32_16x16x32_bf16 v[88:91], a[184:187], a[88:91], v[88:91]
    s_waitcnt lgkmcnt(6)
    s_add_u32 s49, s46, 512
    ds_read_b64_tr_b16 a[220:221], v12 offset:24576
    v_mov_b32 v245, 0
    v_mfma_f32_16x16x32_bf16 v[88:91], a[188:191], a[92:95], v[88:91]
    s_add_u32 m0, s42, 32768
    ds_read_b64_tr_b16 a[222:223], v12 offset:28672
    v_mov_b32 v248, 0
    v_mfma_f32_16x16x32_bf16 v[92:95], a[160:163], a[96:99], v[92:95]
    buffer_load_dwordx4 v46, s[20:23], s49 offen lds
    v_mfma_f32_16x16x32_bf16 v[92:95], a[164:167], a[100:103], v[92:95]
    ds_read_b64_tr_b16 a[224:225], v16 offset:0
    ds_read_b64_tr_b16 a[226:227], v16 offset:4096
    v_mfma_f32_16x16x32_bf16 v[92:95], a[168:171], a[104:107], v[92:95]
    buffer_load_dwordx4 v47, s[20:23], s49 offen offset:1024 lds
    v_mfma_f32_16x16x32_bf16 v[92:95], a[172:175], a[108:111], v[92:95]
    ds_read_b64_tr_b16 a[228:229], v16 offset:8192
    ds_read_b64_tr_b16 a[230:231], v16 offset:12288
    v_mfma_f32_16x16x32_bf16 v[92:95], a[176:179], a[112:115], v[92:95]
    ds_read_b64_tr_b16 a[232:233], v16 offset:16384
    v_cvt_pk_bf16_f32 v234, v88, v89
    v_mfma_f32_16x16x32_bf16 v[92:95], a[180:183], a[116:119], v[92:95]
    s_add_u32 s38, s93, 128
    ds_read_b64_tr_b16 a[234:235], v16 offset:20480
    v_cvt_pk_bf16_f32 v235, v90, v91
    v_mfma_f32_16x16x32_bf16 v[92:95], a[184:187], a[120:123], v[92:95]
    buffer_store_dwordx4 v[232:235], v56, s[28:31], s38 offen sc1
    v_mfma_f32_16x16x32_bf16 v[92:95], a[188:191], a[124:127], v[92:95]
    s_waitcnt lgkmcnt(12)
    ds_read_b64_tr_b16 a[236:237], v16 offset:24576
    ds_read_b64_tr_b16 a[238:239], v16 offset:28672
    v_mfma_f32_16x16x32_bf16 v[96:99], a[208:211], a[64:67], v[96:99]
    s_waitcnt lgkmcnt(12)
    buffer_load_dwordx4 v48, s[20:23], s49 offen offset:2048 lds
    v_mfma_f32_16x16x32_bf16 v[96:99], a[212:215], a[68:71], v[96:99]
    s_waitcnt lgkmcnt(10)
    ds_read_b64_tr_b16 a[160:161], v13 offset:0
    ds_read_b64_tr_b16 a[162:163], v13 offset:4096
    v_mfma_f32_16x16x32_bf16 v[96:99], a[216:219], a[72:75], v[96:99]
    s_waitcnt lgkmcnt(10)
    buffer_load_dwordx4 v49, s[20:23], s49 offen offset:3072 lds
    v_mfma_f32_16x16x32_bf16 v[96:99], a[220:223], a[76:79], v[96:99]
    s_waitcnt lgkmcnt(8)
    ds_read_b64_tr_b16 a[164:165], v13 offset:8192
    ds_read_b64_tr_b16 a[166:167], v13 offset:12288
    v_mfma_f32_16x16x32_bf16 v[96:99], a[224:227], a[80:83], v[96:99]
    s_waitcnt lgkmcnt(8)
    ds_read_b64_tr_b16 a[168:169], v13 offset:16384
    v_cvt_pk_bf16_f32 v238, v92, v93
    v_mfma_f32_16x16x32_bf16 v[96:99], a[228:231], a[84:87], v[96:99]
    s_waitcnt lgkmcnt(7)
    s_add_u32 s38, s93, 163968
    ds_read_b64_tr_b16 a[170:171], v13 offset:20480
    v_cvt_pk_bf16_f32 v239, v94, v95
    v_mfma_f32_16x16x32_bf16 v[96:99], a[232:235], a[88:91], v[96:99]
    s_waitcnt lgkmcnt(6)
    s_add_u32 s49, s46, 74240
    buffer_store_dwordx4 v[236:239], v56, s[28:31], s38 offen sc1
    v_mfma_f32_16x16x32_bf16 v[96:99], a[236:239], a[92:95], v[96:99]
    s_add_u32 m0, s42, 49152
    ds_read_b64_tr_b16 a[172:173], v13 offset:24576
    ds_read_b64_tr_b16 a[174:175], v13 offset:28672
    v_mfma_f32_16x16x32_bf16 v[100:103], a[208:211], a[96:99], v[100:103]
    buffer_load_dwordx4 v46, s[20:23], s49 offen lds
    v_mfma_f32_16x16x32_bf16 v[100:103], a[212:215], a[100:103], v[100:103]
    ds_read_b64_tr_b16 a[176:177], v17 offset:0
    ds_read_b64_tr_b16 a[178:179], v17 offset:4096
    v_mfma_f32_16x16x32_bf16 v[100:103], a[216:219], a[104:107], v[100:103]
    buffer_load_dwordx4 v47, s[20:23], s49 offen offset:1024 lds
    v_mfma_f32_16x16x32_bf16 v[100:103], a[220:223], a[108:111], v[100:103]
    ds_read_b64_tr_b16 a[180:181], v17 offset:8192
    ds_read_b64_tr_b16 a[182:183], v17 offset:12288
    v_mfma_f32_16x16x32_bf16 v[100:103], a[224:227], a[112:115], v[100:103]
    ds_read_b64_tr_b16 a[184:185], v17 offset:16384
    v_cvt_pk_bf16_f32 v224, v96, v97
    v_mfma_f32_16x16x32_bf16 v[100:103], a[228:231], a[116:119], v[100:103]
    ds_read_b64_tr_b16 a[186:187], v17 offset:20480
    v_cvt_pk_bf16_f32 v225, v98, v99
    v_mfma_f32_16x16x32_bf16 v[100:103], a[232:235], a[120:123], v[100:103]
    ds_read_b64_tr_b16 a[188:189], v17 offset:24576
    v_mov_b32 v249, 0
    v_mfma_f32_16x16x32_bf16 v[100:103], a[236:239], a[124:127], v[100:103]
    s_waitcnt lgkmcnt(13)
    ds_read_b64_tr_b16 a[190:191], v17 offset:28672
    v_mov_b32 v252, 0
    v_mfma_f32_16x16x32_bf16 v[104:107], a[160:163], a[64:67], v[104:107]
    s_waitcnt lgkmcnt(12)
    buffer_load_dwordx4 v48, s[20:23], s49 offen offset:2048 lds
    v_mfma_f32_16x16x32_bf16 v[104:107], a[164:167], a[68:71], v[104:107]
    s_waitcnt lgkmcnt(10)
    ds_read_b64_tr_b16 a[208:209], v14 offset:0
    ds_read_b64_tr_b16 a[210:211], v14 offset:4096
    v_mfma_f32_16x16x32_bf16 v[104:107], a[168:171], a[72:75], v[104:107]
    s_waitcnt lgkmcnt(10)
    buffer_load_dwordx4 v49, s[20:23], s49 offen offset:3072 lds
    v_mfma_f32_16x16x32_bf16 v[104:107], a[172:175], a[76:79], v[104:107]
    s_waitcnt lgkmcnt(8)
    ds_read_b64_tr_b16 a[212:213], v14 offset:8192
    ds_read_b64_tr_b16 a[214:215], v14 offset:12288
    v_mfma_f32_16x16x32_bf16 v[104:107], a[176:179], a[80:83], v[104:107]
    s_waitcnt lgkmcnt(8)
    ds_read_b64_tr_b16 a[216:217], v14 offset:16384
    v_cvt_pk_bf16_f32 v228, v100, v101
    v_mfma_f32_16x16x32_bf16 v[104:107], a[180:183], a[84:87], v[104:107]
    s_waitcnt lgkmcnt(7)
    ds_read_b64_tr_b16 a[218:219], v14 offset:20480
    v_cvt_pk_bf16_f32 v229, v102, v103
    v_mfma_f32_16x16x32_bf16 v[104:107], a[184:187], a[88:91], v[104:107]
    s_waitcnt lgkmcnt(6)
    ds_read_b64_tr_b16 a[220:221], v14 offset:24576
    v_mov_b32 v253, 0
    v_mfma_f32_16x16x32_bf16 v[104:107], a[188:191], a[92:95], v[104:107]
    ds_read_b64_tr_b16 a[222:223], v14 offset:28672
    v_mfma_f32_16x16x32_bf16 v[108:111], a[160:163], a[96:99], v[108:111]
    ds_read_b64_tr_b16 a[224:225], v18 offset:0
    v_mfma_f32_16x16x32_bf16 v[108:111], a[164:167], a[100:103], v[108:111]
    ds_read_b64_tr_b16 a[226:227], v18 offset:4096
    v_mfma_f32_16x16x32_bf16 v[108:111], a[168:171], a[104:107], v[108:111]
    ds_read_b64_tr_b16 a[228:229], v18 offset:8192
    v_mfma_f32_16x16x32_bf16 v[108:111], a[172:175], a[108:111], v[108:111]
    ds_read_b64_tr_b16 a[230:231], v18 offset:12288
    v_mfma_f32_16x16x32_bf16 v[108:111], a[176:179], a[112:115], v[108:111]
    ds_read_b64_tr_b16 a[232:233], v18 offset:16384
    v_cvt_pk_bf16_f32 v226, v104, v105
    v_mfma_f32_16x16x32_bf16 v[108:111], a[180:183], a[116:119], v[108:111]
    s_add_u32 s38, s93, 512
    ds_read_b64_tr_b16 a[234:235], v18 offset:20480
    v_cvt_pk_bf16_f32 v227, v106, v107
    v_mfma_f32_16x16x32_bf16 v[108:111], a[184:187], a[120:123], v[108:111]
    buffer_store_dwordx4 v[224:227], v56, s[28:31], s38 offen sc1
    v_mfma_f32_16x16x32_bf16 v[108:111], a[188:191], a[124:127], v[108:111]
    s_waitcnt lgkmcnt(12)
    ds_read_b64_tr_b16 a[236:237], v18 offset:24576
    ds_read_b64_tr_b16 a[238:239], v18 offset:28672
    v_mfma_f32_16x16x32_bf16 v[112:115], a[208:211], a[64:67], v[112:115]
    s_waitcnt lgkmcnt(12)
    ds_read_b64_tr_b16 a[160:161], v15 offset:0
    v_mfma_f32_16x16x32_bf16 v[112:115], a[212:215], a[68:71], v[112:115]
    s_waitcnt lgkmcnt(11)
    ds_read_b64_tr_b16 a[162:163], v15 offset:4096
    v_mfma_f32_16x16x32_bf16 v[112:115], a[216:219], a[72:75], v[112:115]
    s_waitcnt lgkmcnt(10)
    ds_read_b64_tr_b16 a[164:165], v15 offset:8192
    v_mfma_f32_16x16x32_bf16 v[112:115], a[220:223], a[76:79], v[112:115]
    s_waitcnt lgkmcnt(9)
    ds_read_b64_tr_b16 a[166:167], v15 offset:12288
    v_mfma_f32_16x16x32_bf16 v[112:115], a[224:227], a[80:83], v[112:115]
    s_waitcnt lgkmcnt(8)
    ds_read_b64_tr_b16 a[168:169], v15 offset:16384
    v_cvt_pk_bf16_f32 v230, v108, v109
    v_mfma_f32_16x16x32_bf16 v[112:115], a[228:231], a[84:87], v[112:115]
    s_waitcnt lgkmcnt(7)
    s_add_u32 s38, s93, 164352
    ds_read_b64_tr_b16 a[170:171], v15 offset:20480
    v_cvt_pk_bf16_f32 v231, v110, v111
    v_mfma_f32_16x16x32_bf16 v[112:115], a[232:235], a[88:91], v[112:115]
    s_waitcnt lgkmcnt(6)
    buffer_store_dwordx4 v[228:231], v56, s[28:31], s38 offen sc1
    v_mfma_f32_16x16x32_bf16 v[112:115], a[236:239], a[92:95], v[112:115]
    ds_read_b64_tr_b16 a[172:173], v15 offset:24576
    ds_read_b64_tr_b16 a[174:175], v15 offset:28672
    v_mfma_f32_16x16x32_bf16 v[116:119], a[208:211], a[96:99], v[116:119]
    ds_read_b64_tr_b16 a[176:177], v19 offset:0
    v_mfma_f32_16x16x32_bf16 v[116:119], a[212:215], a[100:103], v[116:119]
    ds_read_b64_tr_b16 a[178:179], v19 offset:4096
    v_mfma_f32_16x16x32_bf16 v[116:119], a[216:219], a[104:107], v[116:119]
    ds_read_b64_tr_b16 a[180:181], v19 offset:8192
    v_mfma_f32_16x16x32_bf16 v[116:119], a[220:223], a[108:111], v[116:119]
    ds_read_b64_tr_b16 a[182:183], v19 offset:12288
    v_mfma_f32_16x16x32_bf16 v[116:119], a[224:227], a[112:115], v[116:119]
    ds_read_b64_tr_b16 a[184:185], v19 offset:16384
    v_cvt_pk_bf16_f32 v232, v112, v113
    v_mfma_f32_16x16x32_bf16 v[116:119], a[228:231], a[116:119], v[116:119]
    ds_read_b64_tr_b16 a[186:187], v19 offset:20480
    v_cvt_pk_bf16_f32 v233, v114, v115
    v_mfma_f32_16x16x32_bf16 v[116:119], a[232:235], a[120:123], v[116:119]
    ds_read_b64_tr_b16 a[188:189], v19 offset:24576
    v_mfma_f32_16x16x32_bf16 v[116:119], a[236:239], a[124:127], v[116:119]
    s_waitcnt lgkmcnt(13)
    ds_read_b64_tr_b16 a[190:191], v19 offset:28672
    s_waitcnt vmcnt(17)
    s_barrier
    v_mfma_f32_16x16x32_bf16 v[120:123], a[160:163], a[64:67], v[120:123]
    s_waitcnt lgkmcnt(12)
    ds_read_b64_tr_b16 a[208:209], v20 offset:0
    v_mfma_f32_16x16x32_bf16 v[120:123], a[164:167], a[68:71], v[120:123]
    s_waitcnt lgkmcnt(11)
    ds_read_b64_tr_b16 a[210:211], v20 offset:4096
    v_mfma_f32_16x16x32_bf16 v[120:123], a[168:171], a[72:75], v[120:123]
    s_waitcnt lgkmcnt(10)
    ds_read_b64_tr_b16 a[212:213], v20 offset:8192
    v_mfma_f32_16x16x32_bf16 v[120:123], a[172:175], a[76:79], v[120:123]
    s_waitcnt lgkmcnt(9)
    ds_read_b64_tr_b16 a[214:215], v20 offset:12288
    v_mfma_f32_16x16x32_bf16 v[120:123], a[176:179], a[80:83], v[120:123]
    s_waitcnt lgkmcnt(8)
    ds_read_b64_tr_b16 a[216:217], v20 offset:16384
    v_cvt_pk_bf16_f32 v236, v116, v117
    v_mfma_f32_16x16x32_bf16 v[120:123], a[180:183], a[84:87], v[120:123]
    s_waitcnt lgkmcnt(7)
    ds_read_b64_tr_b16 a[218:219], v20 offset:20480
    v_cvt_pk_bf16_f32 v237, v118, v119
    v_mfma_f32_16x16x32_bf16 v[120:123], a[184:187], a[88:91], v[120:123]
    s_waitcnt lgkmcnt(6)
    s_add_u32 s49, s7, 768
    ds_read_b64_tr_b16 a[220:221], v20 offset:24576
    v_mfma_f32_16x16x32_bf16 v[120:123], a[188:191], a[92:95], v[120:123]
    s_add_u32 m0, s42, 98304
    ds_read_b64_tr_b16 a[222:223], v20 offset:28672
    v_mfma_f32_16x16x32_bf16 v[124:127], a[160:163], a[96:99], v[124:127]
    buffer_load_dwordx4 v46, s[20:23], s49 offen lds
    v_mfma_f32_16x16x32_bf16 v[124:127], a[164:167], a[100:103], v[124:127]
    ds_read_b64_tr_b16 a[224:225], v24 offset:0
    ds_read_b64_tr_b16 a[226:227], v24 offset:4096
    v_mfma_f32_16x16x32_bf16 v[124:127], a[168:171], a[104:107], v[124:127]
    buffer_load_dwordx4 v47, s[20:23], s49 offen offset:1024 lds
    v_mfma_f32_16x16x32_bf16 v[124:127], a[172:175], a[108:111], v[124:127]
    ds_read_b64_tr_b16 a[228:229], v24 offset:8192
    ds_read_b64_tr_b16 a[230:231], v24 offset:12288
    v_mfma_f32_16x16x32_bf16 v[124:127], a[176:179], a[112:115], v[124:127]
    ds_read_b64_tr_b16 a[232:233], v24 offset:16384
    v_cvt_pk_bf16_f32 v234, v120, v121
    v_mfma_f32_16x16x32_bf16 v[124:127], a[180:183], a[116:119], v[124:127]
    s_add_u32 s38, s93, 640
    ds_read_b64_tr_b16 a[234:235], v24 offset:20480
    v_cvt_pk_bf16_f32 v235, v122, v123
    v_mfma_f32_16x16x32_bf16 v[124:127], a[184:187], a[120:123], v[124:127]
    buffer_store_dwordx4 v[232:235], v56, s[28:31], s38 offen sc1
    v_mfma_f32_16x16x32_bf16 v[124:127], a[188:191], a[124:127], v[124:127]
    s_waitcnt lgkmcnt(12)
    ds_read_b64_tr_b16 a[236:237], v24 offset:24576
    ds_read_b64_tr_b16 a[238:239], v24 offset:28672
    v_mfma_f32_16x16x32_bf16 v[64:67], a[208:211], v[128:131], 0
    s_waitcnt lgkmcnt(12)
    buffer_load_dwordx4 v48, s[20:23], s49 offen offset:2048 lds
    v_mfma_f32_16x16x32_bf16 v[64:67], a[212:215], v[144:147], v[64:67]
    s_waitcnt lgkmcnt(10)
    ds_read_b64_tr_b16 a[160:161], v21 offset:0
    ds_read_b64_tr_b16 a[162:163], v21 offset:4096
    v_mfma_f32_16x16x32_bf16 v[64:67], a[216:219], v[192:195], v[64:67]
    s_waitcnt lgkmcnt(10)
    buffer_load_dwordx4 v49, s[20:23], s49 offen offset:3072 lds
    v_mfma_f32_16x16x32_bf16 v[64:67], a[220:223], v[176:179], v[64:67]
    s_waitcnt lgkmcnt(8)
    ds_read_b64_tr_b16 a[164:165], v21 offset:8192
    ds_read_b64_tr_b16 a[166:167], v21 offset:12288
    v_mfma_f32_16x16x32_bf16 v[64:67], a[224:227], v[136:139], v[64:67]
    s_waitcnt lgkmcnt(8)
    ds_read_b64_tr_b16 a[168:169], v21 offset:16384
    v_cvt_pk_bf16_f32 v238, v124, v125
    v_mfma_f32_16x16x32_bf16 v[64:67], a[228:231], v[152:155], v[64:67]
    s_waitcnt lgkmcnt(7)
    s_add_u32 s38, s93, 164480
    ds_read_b64_tr_b16 a[170:171], v21 offset:20480
    v_cvt_pk_bf16_f32 v239, v126, v127
    v_mfma_f32_16x16x32_bf16 v[64:67], a[232:235], v[200:203], v[64:67]
    s_waitcnt lgkmcnt(6)
    s_add_u32 s49, s7, 74496
    buffer_store_dwordx4 v[236:239], v56, s[28:31], s38 offen sc1
    v_mfma_f32_16x16x32_bf16 v[64:67], a[236:239], v[184:187], v[64:67]
    s_add_u32 m0, s42, 114688
    ds_read_b64_tr_b16 a[172:173], v21 offset:24576
Ltour10:
    s_cbranch_execz Ltour14
    ds_read_b64_tr_b16 a[174:175], v21 offset:28672
    v_mfma_f32_16x16x32_bf16 v[68:71], a[208:211], v[132:135], 0
    buffer_load_dwordx4 v46, s[20:23], s49 offen lds
    v_mfma_f32_16x16x32_bf16 v[68:71], a[212:215], v[148:151], v[68:71]
    ds_read_b64_tr_b16 a[176:177], v25 offset:0
    ds_read_b64_tr_b16 a[178:179], v25 offset:4096
    v_mfma_f32_16x16x32_bf16 v[68:71], a[216:219], v[196:199], v[68:71]
    buffer_load_dwordx4 v47, s[20:23], s49 offen offset:1024 lds
    v_mfma_f32_16x16x32_bf16 v[68:71], a[220:223], v[180:183], v[68:71]
    ds_read_b64_tr_b16 a[180:181], v25 offset:8192
    ds_read_b64_tr_b16 a[182:183], v25 offset:12288
    v_mfma_f32_16x16x32_bf16 v[68:71], a[224:227], v[140:143], v[68:71]
    ds_read_b64_tr_b16 a[184:185], v25 offset:16384
    v_mfma_f32_16x16x32_bf16 v[68:71], a[228:231], v[156:159], v[68:71]
    ds_read_b64_tr_b16 a[186:187], v25 offset:20480
    v_mfma_f32_16x16x32_bf16 v[68:71], a[232:235], v[204:207], v[68:71]
    ds_read_b64_tr_b16 a[188:189], v25 offset:24576
    v_mfma_f32_16x16x32_bf16 v[68:71], a[236:239], v[188:191], v[68:71]
    s_waitcnt lgkmcnt(13)
    ds_read_b64_tr_b16 a[190:191], v25 offset:28672
    v_mfma_f32_16x16x32_bf16 v[72:75], a[160:163], v[128:131], 0
    s_waitcnt lgkmcnt(12)
    buffer_load_dwordx4 v48, s[20:23], s49 offen offset:2048 lds
    v_mfma_f32_16x16x32_bf16 v[72:75], a[164:167], v[144:147], v[72:75]
    s_waitcnt lgkmcnt(10)
    ds_read_b64_tr_b16 a[208:209], v22 offset:0
    ds_read_b64_tr_b16 a[210:211], v22 offset:4096
    v_mfma_f32_16x16x32_bf16 v[72:75], a[168:171], v[192:195], v[72:75]
    s_waitcnt lgkmcnt(10)
    buffer_load_dwordx4 v49, s[20:23], s49 offen offset:3072 lds
    v_mfma_f32_16x16x32_bf16 v[72:75], a[172:175], v[176:179], v[72:75]
    s_waitcnt lgkmcnt(8)
    ds_read_b64_tr_b16 a[212:213], v22 offset:8192
    ds_read_b64_tr_b16 a[214:215], v22 offset:12288
    v_mfma_f32_16x16x32_bf16 v[72:75], a[176:179], v[136:139], v[72:75]
    s_waitcnt lgkmcnt(8)
    ds_read_b64_tr_b16 a[216:217], v22 offset:16384
    v_mfma_f32_16x16x32_bf16 v[72:75], a[180:183], v[152:155], v[72:75]
    s_waitcnt lgkmcnt(7)
    ds_read_b64_tr_b16 a[218:219], v22 offset:20480
    v_mfma_f32_16x16x32_bf16 v[72:75], a[184:187], v[200:203], v[72:75]
    s_waitcnt lgkmcnt(6)
    ds_read_b64_tr_b16 a[220:221], v22 offset:24576
    v_mfma_f32_16x16x32_bf16 v[72:75], a[188:191], v[184:187], v[72:75]
    ds_read_b64_tr_b16 a[222:223], v22 offset:28672
    v_mfma_f32_16x16x32_bf16 v[76:79], a[160:163], v[132:135], 0
    ds_read_b64_tr_b16 a[224:225], v26 offset:0
    v_mfma_f32_16x16x32_bf16 v[76:79], a[164:167], v[148:151], v[76:79]
    ds_read_b64_tr_b16 a[226:227], v26 offset:4096
    v_mfma_f32_16x16x32_bf16 v[76:79], a[168:171], v[196:199], v[76:79]
    ds_read_b64_tr_b16 a[228:229], v26 offset:8192
    v_mfma_f32_16x16x32_bf16 v[76:79], a[172:175], v[180:183], v[76:79]
    ds_read_b64_tr_b16 a[230:231], v26 offset:12288
    v_mfma_f32_16x16x32_bf16 v[76:79], a[176:179], v[140:143], v[76:79]
    ds_read_b64_tr_b16 a[232:233], v26 offset:16384
    v_mfma_f32_16x16x32_bf16 v[76:79], a[180:183], v[156:159], v[76:79]
    ds_read_b64_tr_b16 a[234:235], v26 offset:20480
    v_mfma_f32_16x16x32_bf16 v[76:79], a[184:187], v[204:207], v[76:79]
    buffer_load_dword v63, v63, s[88:91], 0 offen sc1
    v_mfma_f32_16x16x32_bf16 v[76:79], a[188:191], v[188:191], v[76:79]
    s_waitcnt lgkmcnt(12)
    ds_read_b64_tr_b16 a[236:237], v26 offset:24576
    ds_read_b64_tr_b16 a[238:239], v26 offset:28672
    v_mfma_f32_16x16x32_bf16 v[80:83], a[208:211], v[128:131], 0
    s_waitcnt lgkmcnt(12)
    ds_read_b64_tr_b16 a[160:161], v23 offset:0
    v_mfma_f32_16x16x32_bf16 v[80:83], a[212:215], v[144:147], v[80:83]
    s_waitcnt lgkmcnt(11)
    ds_read_b64_tr_b16 a[162:163], v23 offset:4096
    v_mfma_f32_16x16x32_bf16 v[80:83], a[216:219], v[192:195], v[80:83]
    s_waitcnt lgkmcnt(10)
    ds_read_b64_tr_b16 a[164:165], v23 offset:8192
    v_mfma_f32_16x16x32_bf16 v[80:83], a[220:223], v[176:179], v[80:83]
    s_waitcnt lgkmcnt(9)
    ds_read_b64_tr_b16 a[166:167], v23 offset:12288
    v_mfma_f32_16x16x32_bf16 v[80:83], a[224:227], v[136:139], v[80:83]
    s_waitcnt lgkmcnt(8)
    ds_read_b64_tr_b16 a[168:169], v23 offset:16384
    v_mfma_f32_16x16x32_bf16 v[80:83], a[228:231], v[152:155], v[80:83]
    s_waitcnt lgkmcnt(7)
    ds_read_b64_tr_b16 a[170:171], v23 offset:20480
    v_mfma_f32_16x16x32_bf16 v[80:83], a[232:235], v[200:203], v[80:83]
    s_waitcnt lgkmcnt(6)
    ds_read_b64_tr_b16 a[172:173], v23 offset:24576
    v_mfma_f32_16x16x32_bf16 v[80:83], a[236:239], v[184:187], v[80:83]
    ds_read_b64_tr_b16 a[174:175], v23 offset:28672
    v_mfma_f32_16x16x32_bf16 v[84:87], a[208:211], v[132:135], 0
    ds_read_b64_tr_b16 a[176:177], v27 offset:0
    v_mfma_f32_16x16x32_bf16 v[84:87], a[212:215], v[148:151], v[84:87]
    ds_read_b64_tr_b16 a[178:179], v27 offset:4096
    v_mfma_f32_16x16x32_bf16 v[84:87], a[216:219], v[196:199], v[84:87]
    ds_read_b64_tr_b16 a[180:181], v27 offset:8192
    v_mfma_f32_16x16x32_bf16 v[84:87], a[220:223], v[180:183], v[84:87]
    ds_read_b64_tr_b16 a[182:183], v27 offset:12288
    v_mfma_f32_16x16x32_bf16 v[84:87], a[224:227], v[140:143], v[84:87]
    ds_read_b64_tr_b16 a[184:185], v27 offset:16384
    v_mfma_f32_16x16x32_bf16 v[84:87], a[228:231], v[156:159], v[84:87]
    ds_read_b64_tr_b16 a[186:187], v27 offset:20480
    v_mfma_f32_16x16x32_bf16 v[84:87], a[232:235], v[204:207], v[84:87]
    ds_read_b64_tr_b16 a[188:189], v27 offset:24576
    v_mfma_f32_16x16x32_bf16 v[84:87], a[236:239], v[188:191], v[84:87]
    s_waitcnt lgkmcnt(13)
    ds_read_b64_tr_b16 a[190:191], v27 offset:28672
    s_waitcnt vmcnt(13)
    s_barrier
    v_mfma_f32_16x16x32_bf16 v[88:91], a[160:163], v[128:131], 0
    s_waitcnt lgkmcnt(12)
    ds_read_b64_tr_b16 a[208:209], v12 offset:32768
    v_mfma_f32_16x16x32_bf16 v[88:91], a[164:167], v[144:147], v[88:91]
    s_waitcnt lgkmcnt(11)
    ds_read_b64_tr_b16 a[210:211], v12 offset:36864
    v_mfma_f32_16x16x32_bf16 v[88:91], a[168:171], v[192:195], v[88:91]
    s_waitcnt lgkmcnt(10)
    ds_read_b64_tr_b16 a[212:213], v12 offset:40960
    v_mfma_f32_16x16x32_bf16 v[88:91], a[172:175], v[176:179], v[88:91]
    s_waitcnt lgkmcnt(9)
    ds_read_b64_tr_b16 a[214:215], v12 offset:45056
    v_mfma_f32_16x16x32_bf16 v[88:91], a[176:179], v[136:139], v[88:91]
    s_waitcnt lgkmcnt(8)
    ds_read_b64_tr_b16 a[216:217], v12 offset:49152
    v_mfma_f32_16x16x32_bf16 v[88:91], a[180:183], v[152:155], v[88:91]
    s_waitcnt lgkmcnt(7)
    ds_read_b64_tr_b16 a[218:219], v12 offset:53248
    v_mfma_f32_16x16x32_bf16 v[88:91], a[184:187], v[200:203], v[88:91]
    s_waitcnt lgkmcnt(6)
    s_add_u32 s49, s46, 768
    ds_read_b64_tr_b16 a[220:221], v12 offset:57344
    v_mfma_f32_16x16x32_bf16 v[88:91], a[188:191], v[184:187], v[88:91]
    s_add_u32 m0, s42, 0
    ds_read_b64_tr_b16 a[222:223], v12 offset:61440
    v_mfma_f32_16x16x32_bf16 v[92:95], a[160:163], v[132:135], 0
    buffer_load_dwordx4 v46, s[20:23], s49 offen lds
    v_mfma_f32_16x16x32_bf16 v[92:95], a[164:167], v[148:151], v[92:95]
    ds_read_b64_tr_b16 a[224:225], v16 offset:32768
    ds_read_b64_tr_b16 a[226:227], v16 offset:36864
    v_mfma_f32_16x16x32_bf16 v[92:95], a[168:171], v[196:199], v[92:95]
    buffer_load_dwordx4 v47, s[20:23], s49 offen offset:1024 lds
    v_mfma_f32_16x16x32_bf16 v[92:95], a[172:175], v[180:183], v[92:95]
    ds_read_b64_tr_b16 a[228:229], v16 offset:40960
    ds_read_b64_tr_b16 a[230:231], v16 offset:45056
    v_mfma_f32_16x16x32_bf16 v[92:95], a[176:179], v[140:143], v[92:95]
    ds_read_b64_tr_b16 a[232:233], v16 offset:49152
    v_mfma_f32_16x16x32_bf16 v[92:95], a[180:183], v[156:159], v[92:95]
    ds_read_b64_tr_b16 a[234:235], v16 offset:53248
    v_mfma_f32_16x16x32_bf16 v[92:95], a[184:187], v[204:207], v[92:95]
    ds_read_b64_tr_b16 a[236:237], v16 offset:57344
    v_mfma_f32_16x16x32_bf16 v[92:95], a[188:191], v[188:191], v[92:95]
    s_waitcnt lgkmcnt(13)
    ds_read_b64_tr_b16 a[238:239], v16 offset:61440
    v_mfma_f32_16x16x32_bf16 v[64:67], a[208:211], a[64:67], v[64:67]
    s_waitcnt lgkmcnt(12)
    buffer_load_dwordx4 v48, s[20:23], s49 offen offset:2048 lds
    v_mfma_f32_16x16x32_bf16 v[64:67], a[212:215], a[68:71], v[64:67]
    s_waitcnt lgkmcnt(10)
    ds_read_b64_tr_b16 a[160:161], v13 offset:32768
    ds_read_b64_tr_b16 a[162:163], v13 offset:36864
    v_mfma_f32_16x16x32_bf16 v[64:67], a[216:219], a[72:75], v[64:67]
    s_waitcnt lgkmcnt(10)
    s_add_u32 s92, s92, 16
    buffer_load_dwordx4 v49, s[20:23], s49 offen offset:3072 lds
    v_mfma_f32_16x16x32_bf16 v[64:67], a[220:223], a[76:79], v[64:67]
    s_waitcnt lgkmcnt(8)
    s_waitcnt vmcnt(9)
    ds_read_b64_tr_b16 a[164:165], v13 offset:40960
    ds_read_b64_tr_b16 a[166:167], v13 offset:45056
    v_mfma_f32_16x16x32_bf16 v[64:67], a[224:227], a[80:83], v[64:67]
    s_waitcnt lgkmcnt(8)
    buffer_store_dword v10, v8, s[24:27], s92 offen sc1
    v_mfma_f32_16x16x32_bf16 v[64:67], a[228:231], a[84:87], v[64:67]
    s_waitcnt lgkmcnt(6)
    ds_read_b64_tr_b16 a[168:169], v13 offset:49152
    ds_read_b64_tr_b16 a[170:171], v13 offset:53248
    v_mfma_f32_16x16x32_bf16 v[64:67], a[232:235], a[88:91], v[64:67]
    s_waitcnt lgkmcnt(6)
    s_add_u32 s49, s46, 74496
    ds_read_b64_tr_b16 a[172:173], v13 offset:57344
    v_mfma_f32_16x16x32_bf16 v[64:67], a[236:239], a[92:95], v[64:67]
    s_add_u32 m0, s42, 16384
    ds_read_b64_tr_b16 a[174:175], v13 offset:61440
    v_mfma_f32_16x16x32_bf16 v[68:71], a[208:211], a[96:99], v[68:71]
    buffer_load_dwordx4 v46, s[20:23], s49 offen lds
    v_mfma_f32_16x16x32_bf16 v[68:71], a[212:215], a[100:103], v[68:71]
    ds_read_b64_tr_b16 a[176:177], v17 offset:32768
    ds_read_b64_tr_b16 a[178:179], v17 offset:36864
    v_mfma_f32_16x16x32_bf16 v[68:71], a[216:219], a[104:107], v[68:71]
    buffer_load_dwordx4 v47, s[20:23], s49 offen offset:1024 lds
    v_mfma_f32_16x16x32_bf16 v[68:71], a[220:223], a[108:111], v[68:71]
    ds_read_b64_tr_b16 a[180:181], v17 offset:40960
    ds_read_b64_tr_b16 a[182:183], v17 offset:45056
    v_mfma_f32_16x16x32_bf16 v[68:71], a[224:227], a[112:115], v[68:71]
    ds_read_b64_tr_b16 a[184:185], v17 offset:49152
    v_cvt_pk_bf16_f32 v224, v64, v65
    v_mfma_f32_16x16x32_bf16 v[68:71], a[228:231], a[116:119], v[68:71]
    ds_read_b64_tr_b16 a[186:187], v17 offset:53248
    v_cvt_pk_bf16_f32 v225, v66, v67
    v_mfma_f32_16x16x32_bf16 v[68:71], a[232:235], a[120:123], v[68:71]
    ds_read_b64_tr_b16 a[188:189], v17 offset:57344
    v_mfma_f32_16x16x32_bf16 v[68:71], a[236:239], a[124:127], v[68:71]
    s_waitcnt lgkmcnt(13)
    ds_read_b64_tr_b16 a[190:191], v17 offset:61440
    v_mfma_f32_16x16x32_bf16 v[72:75], a[160:163], a[64:67], v[72:75]
    s_waitcnt lgkmcnt(12)
    buffer_load_dwordx4 v48, s[20:23], s49 offen offset:2048 lds
    v_mfma_f32_16x16x32_bf16 v[72:75], a[164:167], a[68:71], v[72:75]
    s_waitcnt lgkmcnt(10)
    ds_read_b64_tr_b16 a[208:209], v14 offset:32768
    ds_read_b64_tr_b16 a[210:211], v14 offset:36864
    v_mfma_f32_16x16x32_bf16 v[72:75], a[168:171], a[72:75], v[72:75]
    s_waitcnt lgkmcnt(10)
    buffer_load_dwordx4 v49, s[20:23], s49 offen offset:3072 lds
    v_mfma_f32_16x16x32_bf16 v[72:75], a[172:175], a[76:79], v[72:75]
    s_waitcnt lgkmcnt(8)
    ds_read_b64_tr_b16 a[212:213], v14 offset:40960
    ds_read_b64_tr_b16 a[214:215], v14 offset:45056
    v_mfma_f32_16x16x32_bf16 v[72:75], a[176:179], a[80:83], v[72:75]
    s_waitcnt lgkmcnt(8)
    ds_read_b64_tr_b16 a[216:217], v14 offset:49152
    v_cvt_pk_bf16_f32 v228, v68, v69
    v_mfma_f32_16x16x32_bf16 v[72:75], a[180:183], a[84:87], v[72:75]
    s_waitcnt lgkmcnt(7)
    ds_read_b64_tr_b16 a[218:219], v14 offset:53248
    v_cvt_pk_bf16_f32 v229, v70, v71
    v_mfma_f32_16x16x32_bf16 v[72:75], a[184:187], a[88:91], v[72:75]
    s_waitcnt lgkmcnt(6)
    s_and_b32 s42, s2, 7
    ds_read_b64_tr_b16 a[220:221], v14 offset:57344
    v_mfma_f32_16x16x32_bf16 v[72:75], a[188:191], a[92:95], v[72:75]
    s_mov_b64 s[20:21], s[52:53]
    ds_read_b64_tr_b16 a[222:223], v14 offset:61440
    v_mfma_f32_16x16x32_bf16 v[76:79], a[160:163], a[96:99], v[76:79]
    ds_read_b64_tr_b16 a[224:225], v18 offset:32768
    s_waitcnt vmcnt(9)
    v_readfirstlane_b32 s37, v63
    v_mfma_f32_16x16x32_bf16 v[76:79], a[164:167], a[100:103], v[76:79]
    s_mov_b32 s22, 1152
    ds_read_b64_tr_b16 a[226:227], v18 offset:36864
    v_mfma_f32_16x16x32_bf16 v[76:79], a[168:171], a[104:107], v[76:79]
    s_mov_b32 s23, 0x20000
    ds_read_b64_tr_b16 a[228:229], v18 offset:40960
    s_cmp_lt_u32 s37, 256
    s_cbranch_scc1 Lattn_armwait
Lattn_armed:
    v_mfma_f32_16x16x32_bf16 v[76:79], a[172:175], a[108:111], v[76:79]
    ds_read_b64_tr_b16 a[230:231], v18 offset:45056
    v_mfma_f32_16x16x32_bf16 v[76:79], a[176:179], a[112:115], v[76:79]
    ds_read_b64_tr_b16 a[232:233], v18 offset:49152
    v_cvt_pk_bf16_f32 v226, v72, v73
    v_mfma_f32_16x16x32_bf16 v[76:79], a[180:183], a[116:119], v[76:79]
    s_add_u32 s38, s93, 1024
    ds_read_b64_tr_b16 a[234:235], v18 offset:53248
    v_cvt_pk_bf16_f32 v227, v74, v75
    v_mfma_f32_16x16x32_bf16 v[76:79], a[184:187], a[120:123], v[76:79]
    buffer_store_dwordx4 v[224:227], v56, s[28:31], s38 offen sc1
    v_mfma_f32_16x16x32_bf16 v[76:79], a[188:191], a[124:127], v[76:79]
    s_waitcnt lgkmcnt(12)
    s_mov_b32 s45, 18688
    ds_read_b64_tr_b16 a[236:237], v18 offset:57344
    ds_read_b64_tr_b16 a[238:239], v18 offset:61440
    v_mfma_f32_16x16x32_bf16 v[80:83], a[208:211], a[64:67], v[80:83]
    s_waitcnt lgkmcnt(12)
    buffer_load_dwordx4 v[160:163], v5, s[24:27], s45 offen offset:0 sc1
    v_mfma_f32_16x16x32_bf16 v[80:83], a[212:215], a[68:71], v[80:83]
    s_waitcnt lgkmcnt(10)
    ds_read_b64_tr_b16 a[160:161], v15 offset:32768
    ds_read_b64_tr_b16 a[162:163], v15 offset:36864
    v_mfma_f32_16x16x32_bf16 v[80:83], a[216:219], a[72:75], v[80:83]
    s_waitcnt lgkmcnt(10)
    ds_read_b64_tr_b16 a[164:165], v15 offset:40960
    v_mfma_f32_16x16x32_bf16 v[80:83], a[220:223], a[76:79], v[80:83]
    s_waitcnt lgkmcnt(9)
    ds_read_b64_tr_b16 a[166:167], v15 offset:45056
    v_mfma_f32_16x16x32_bf16 v[80:83], a[224:227], a[80:83], v[80:83]
    s_waitcnt lgkmcnt(8)
    ds_read_b64_tr_b16 a[168:169], v15 offset:49152
    v_cvt_pk_bf16_f32 v230, v76, v77
    v_mfma_f32_16x16x32_bf16 v[80:83], a[228:231], a[84:87], v[80:83]
    s_waitcnt lgkmcnt(7)
    s_add_u32 s38, s93, 164864
    ds_read_b64_tr_b16 a[170:171], v15 offset:53248
    v_cvt_pk_bf16_f32 v231, v78, v79
    v_mfma_f32_16x16x32_bf16 v[80:83], a[232:235], a[88:91], v[80:83]
    s_waitcnt lgkmcnt(6)
    buffer_store_dwordx4 v[228:231], v56, s[28:31], s38 offen sc1
    v_mfma_f32_16x16x32_bf16 v[80:83], a[236:239], a[92:95], v[80:83]
    ds_read_b64_tr_b16 a[172:173], v15 offset:57344
    ds_read_b64_tr_b16 a[174:175], v15 offset:61440
    v_mfma_f32_16x16x32_bf16 v[84:87], a[208:211], a[96:99], v[84:87]
    buffer_load_dwordx4 v[164:167], v5, s[24:27], s45 offen offset:512 sc1
    v_mfma_f32_16x16x32_bf16 v[84:87], a[212:215], a[100:103], v[84:87]
    ds_read_b64_tr_b16 a[176:177], v19 offset:32768
    ds_read_b64_tr_b16 a[178:179], v19 offset:36864
    v_mfma_f32_16x16x32_bf16 v[84:87], a[216:219], a[104:107], v[84:87]
    ds_read_b64_tr_b16 a[180:181], v19 offset:40960
    v_mfma_f32_16x16x32_bf16 v[84:87], a[220:223], a[108:111], v[84:87]
    ds_read_b64_tr_b16 a[182:183], v19 offset:45056
    v_mfma_f32_16x16x32_bf16 v[84:87], a[224:227], a[112:115], v[84:87]
    ds_read_b64_tr_b16 a[184:185], v19 offset:49152
    v_cvt_pk_bf16_f32 v232, v80, v81
    v_mfma_f32_16x16x32_bf16 v[84:87], a[228:231], a[116:119], v[84:87]
    ds_read_b64_tr_b16 a[186:187], v19 offset:53248
    v_cvt_pk_bf16_f32 v233, v82, v83
    v_mfma_f32_16x16x32_bf16 v[84:87], a[232:235], a[120:123], v[84:87]
    buffer_load_dwordx4 v[168:171], v59, s[24:27], s45 offen offset:1024 sc1
    v_mfma_f32_16x16x32_bf16 v[84:87], a[236:239], a[124:127], v[84:87]
    s_waitcnt lgkmcnt(12)
    ds_read_b64_tr_b16 a[188:189], v19 offset:57344
    ds_read_b64_tr_b16 a[190:191], v19 offset:61440
    s_barrier
    v_mfma_f32_16x16x32_bf16 v[88:91], a[160:163], a[64:67], v[88:91]
    s_waitcnt lgkmcnt(12)
    ds_read_b64_tr_b16 a[208:209], v20 offset:32768
    v_mfma_f32_16x16x32_bf16 v[88:91], a[164:167], a[68:71], v[88:91]
    s_waitcnt lgkmcnt(11)
    s_mov_b32 s45, 20992
    ds_read_b64_tr_b16 a[210:211], v20 offset:36864
    v_mfma_f32_16x16x32_bf16 v[88:91], a[168:171], a[72:75], v[88:91]
    s_waitcnt lgkmcnt(10)
    buffer_load_dwordx4 v[172:175], v5, s[24:27], s45 offen offset:0 sc1
    v_mfma_f32_16x16x32_bf16 v[88:91], a[172:175], a[76:79], v[88:91]
    s_waitcnt lgkmcnt(8)
    ds_read_b64_tr_b16 a[212:213], v20 offset:40960
    ds_read_b64_tr_b16 a[214:215], v20 offset:45056
    v_mfma_f32_16x16x32_bf16 v[88:91], a[176:179], a[80:83], v[88:91]
    s_waitcnt lgkmcnt(8)
    ds_read_b64_tr_b16 a[216:217], v20 offset:49152
    v_cvt_pk_bf16_f32 v236, v84, v85
    v_mfma_f32_16x16x32_bf16 v[88:91], a[180:183], a[84:87], v[88:91]
    s_waitcnt lgkmcnt(7)
    ds_read_b64_tr_b16 a[218:219], v20 offset:53248
    v_cvt_pk_bf16_f32 v237, v86, v87
    v_mfma_f32_16x16x32_bf16 v[88:91], a[184:187], a[88:91], v[88:91]
    s_waitcnt lgkmcnt(6)
    ds_read_b64_tr_b16 a[220:221], v20 offset:57344
    v_mfma_f32_16x16x32_bf16 v[88:91], a[188:191], a[92:95], v[88:91]
    ds_read_b64_tr_b16 a[222:223], v20 offset:61440
    v_mfma_f32_16x16x32_bf16 v[92:95], a[160:163], a[96:99], v[92:95]
    buffer_load_dwordx4 v[208:211], v5, s[24:27], s45 offen offset:512 sc1
    v_mfma_f32_16x16x32_bf16 v[92:95], a[164:167], a[100:103], v[92:95]
    ds_read_b64_tr_b16 a[224:225], v24 offset:32768
    ds_read_b64_tr_b16 a[226:227], v24 offset:36864
    v_mfma_f32_16x16x32_bf16 v[92:95], a[168:171], a[104:107], v[92:95]
    ds_read_b64_tr_b16 a[228:229], v24 offset:40960
    v_mfma_f32_16x16x32_bf16 v[92:95], a[172:175], a[108:111], v[92:95]
    ds_read_b64_tr_b16 a[230:231], v24 offset:45056
    v_mfma_f32_16x16x32_bf16 v[92:95], a[176:179], a[112:115], v[92:95]
    ds_read_b64_tr_b16 a[232:233], v24 offset:49152
    v_cvt_pk_bf16_f32 v234, v88, v89
    v_mfma_f32_16x16x32_bf16 v[92:95], a[180:183], a[116:119], v[92:95]
    s_add_u32 s38, s93, 1152
    ds_read_b64_tr_b16 a[234:235], v24 offset:53248
    v_cvt_pk_bf16_f32 v235, v90, v91
    v_mfma_f32_16x16x32_bf16 v[92:95], a[184:187], a[120:123], v[92:95]
    buffer_store_dwordx4 v[232:235], v56, s[28:31], s38 offen sc1
    v_mfma_f32_16x16x32_bf16 v[92:95], a[188:191], a[124:127], v[92:95]
    s_waitcnt lgkmcnt(12)
    ds_read_b64_tr_b16 a[236:237], v24 offset:57344
    ds_read_b64_tr_b16 a[238:239], v24 offset:61440
    v_mfma_f32_16x16x32_bf16 v[96:99], a[208:211], v[128:131], 0
    s_waitcnt lgkmcnt(12)
    buffer_load_dwordx4 v[212:215], v59, s[24:27], s45 offen offset:1024 sc1
    v_mfma_f32_16x16x32_bf16 v[96:99], a[212:215], v[144:147], v[96:99]
    s_waitcnt lgkmcnt(10)
    ds_read_b64_tr_b16 a[160:161], v21 offset:32768
    ds_read_b64_tr_b16 a[162:163], v21 offset:36864
    v_mfma_f32_16x16x32_bf16 v[96:99], a[216:219], v[192:195], v[96:99]
    s_waitcnt lgkmcnt(10)
    ds_read_b64_tr_b16 a[164:165], v21 offset:40960
    v_mfma_f32_16x16x32_bf16 v[96:99], a[220:223], v[176:179], v[96:99]
    s_waitcnt lgkmcnt(9)
    ds_read_b64_tr_b16 a[166:167], v21 offset:45056
    v_mfma_f32_16x16x32_bf16 v[96:99], a[224:227], v[136:139], v[96:99]
    s_waitcnt lgkmcnt(8)
    ds_read_b64_tr_b16 a[168:169], v21 offset:49152
    v_cvt_pk_bf16_f32 v238, v92, v93
    v_mfma_f32_16x16x32_bf16 v[96:99], a[228:231], v[152:155], v[96:99]
    s_waitcnt lgkmcnt(7)
    s_add_u32 s38, s93, 164992
    ds_read_b64_tr_b16 a[170:171], v21 offset:53248
    v_cvt_pk_bf16_f32 v239, v94, v95
    v_mfma_f32_16x16x32_bf16 v[96:99], a[232:235], v[200:203], v[96:99]
    s_waitcnt lgkmcnt(6)
    buffer_store_dwordx4 v[236:239], v56, s[28:31], s38 offen sc1
    v_mfma_f32_16x16x32_bf16 v[96:99], a[236:239], v[184:187], v[96:99]
    ds_read_b64_tr_b16 a[172:173], v21 offset:57344
    ds_read_b64_tr_b16 a[174:175], v21 offset:61440
    v_mfma_f32_16x16x32_bf16 v[100:103], a[208:211], v[132:135], 0
    buffer_load_dwordx2 v[92:93], v58, s[12:15], 0 offen offset:1024
    v_mfma_f32_16x16x32_bf16 v[100:103], a[212:215], v[148:151], v[100:103]
    ds_read_b64_tr_b16 a[176:177], v25 offset:32768
    ds_read_b64_tr_b16 a[178:179], v25 offset:36864
    v_mfma_f32_16x16x32_bf16 v[100:103], a[216:219], v[196:199], v[100:103]
    ds_read_b64_tr_b16 a[180:181], v25 offset:40960
    v_mfma_f32_16x16x32_bf16 v[100:103], a[220:223], v[180:183], v[100:103]
    ds_read_b64_tr_b16 a[182:183], v25 offset:45056
    v_mfma_f32_16x16x32_bf16 v[100:103], a[224:227], v[140:143], v[100:103]
    buffer_load_dwordx2 v[94:95], v58, s[12:15], 0 offen offset:1056
    v_mfma_f32_16x16x32_bf16 v[100:103], a[228:231], v[156:159], v[100:103]
    ds_read_b64_tr_b16 a[184:185], v25 offset:49152
    ds_read_b64_tr_b16 a[186:187], v25 offset:53248
    v_mfma_f32_16x16x32_bf16 v[100:103], a[232:235], v[204:207], v[100:103]
    ds_read_b64_tr_b16 a[188:189], v25 offset:57344
    v_mfma_f32_16x16x32_bf16 v[100:103], a[236:239], v[188:191], v[100:103]
    s_waitcnt lgkmcnt(13)
    ds_read_b64_tr_b16 a[190:191], v25 offset:61440
    v_mfma_f32_16x16x32_bf16 v[104:107], a[160:163], v[128:131], 0
    s_waitcnt lgkmcnt(12)
    ds_read_b64_tr_b16 a[208:209], v22 offset:32768
    v_mfma_f32_16x16x32_bf16 v[104:107], a[164:167], v[144:147], v[104:107]
    s_waitcnt lgkmcnt(11)
    s_mov_b32 s45, 19840
    ds_read_b64_tr_b16 a[210:211], v22 offset:36864
    v_mfma_f32_16x16x32_bf16 v[104:107], a[168:171], v[192:195], v[104:107]
    s_waitcnt lgkmcnt(10)
    buffer_load_dwordx4 v[64:67], v5, s[24:27], s45 offen offset:0 sc1
    v_mfma_f32_16x16x32_bf16 v[104:107], a[172:175], v[176:179], v[104:107]
    s_waitcnt lgkmcnt(8)
    ds_read_b64_tr_b16 a[212:213], v22 offset:40960
    ds_read_b64_tr_b16 a[214:215], v22 offset:45056
    v_mfma_f32_16x16x32_bf16 v[104:107], a[176:179], v[136:139], v[104:107]
    s_waitcnt lgkmcnt(8)
    ds_read_b64_tr_b16 a[216:217], v22 offset:49152
    v_mfma_f32_16x16x32_bf16 v[104:107], a[180:183], v[152:155], v[104:107]
    s_waitcnt lgkmcnt(7)
    ds_read_b64_tr_b16 a[218:219], v22 offset:53248
    v_mfma_f32_16x16x32_bf16 v[104:107], a[184:187], v[200:203], v[104:107]
    s_waitcnt lgkmcnt(6)
    buffer_load_dwordx4 v[68:71], v5, s[24:27], s45 offen offset:512 sc1
    v_mfma_f32_16x16x32_bf16 v[104:107], a[188:191], v[184:187], v[104:107]
    ds_read_b64_tr_b16 a[220:221], v22 offset:57344
    ds_read_b64_tr_b16 a[222:223], v22 offset:61440
    v_mfma_f32_16x16x32_bf16 v[108:111], a[160:163], v[132:135], 0
    ds_read_b64_tr_b16 a[224:225], v26 offset:32768
    v_mfma_f32_16x16x32_bf16 v[108:111], a[164:167], v[148:151], v[108:111]
    ds_read_b64_tr_b16 a[226:227], v26 offset:36864
    v_mfma_f32_16x16x32_bf16 v[108:111], a[168:171], v[196:199], v[108:111]
    ds_read_b64_tr_b16 a[228:229], v26 offset:40960
    v_mfma_f32_16x16x32_bf16 v[108:111], a[172:175], v[180:183], v[108:111]
    ds_read_b64_tr_b16 a[230:231], v26 offset:45056
    v_mfma_f32_16x16x32_bf16 v[108:111], a[176:179], v[140:143], v[108:111]
    buffer_load_dwordx4 v[72:75], v59, s[24:27], s45 offen offset:1024 sc1
    v_mfma_f32_16x16x32_bf16 v[108:111], a[180:183], v[156:159], v[108:111]
    ds_read_b64_tr_b16 a[232:233], v26 offset:49152
    ds_read_b64_tr_b16 a[234:235], v26 offset:53248
    v_mfma_f32_16x16x32_bf16 v[108:111], a[184:187], v[204:207], v[108:111]
    ds_read_b64_tr_b16 a[236:237], v26 offset:57344
    v_mfma_f32_16x16x32_bf16 v[108:111], a[188:191], v[188:191], v[108:111]
    s_waitcnt lgkmcnt(13)
    ds_read_b64_tr_b16 a[238:239], v26 offset:61440
    v_mfma_f32_16x16x32_bf16 v[112:115], a[208:211], v[128:131], 0
    s_waitcnt lgkmcnt(12)
    ds_read_b64_tr_b16 a[160:161], v23 offset:32768
    v_mfma_f32_16x16x32_bf16 v[112:115], a[212:215], v[144:147], v[112:115]
    s_waitcnt lgkmcnt(11)
    ds_read_b64_tr_b16 a[162:163], v23 offset:36864
    v_mfma_f32_16x16x32_bf16 v[112:115], a[216:219], v[192:195], v[112:115]
    s_waitcnt lgkmcnt(10)
    buffer_load_dwordx2 v[76:77], v3, s[20:23], 0 offen offset:0
    v_mfma_f32_16x16x32_bf16 v[112:115], a[220:223], v[176:179], v[112:115]
    s_waitcnt lgkmcnt(8)
    ds_read_b64_tr_b16 a[164:165], v23 offset:40960
    ds_read_b64_tr_b16 a[166:167], v23 offset:45056
    v_mfma_f32_16x16x32_bf16 v[112:115], a[224:227], v[136:139], v[112:115]
    s_waitcnt lgkmcnt(8)
    ds_read_b64_tr_b16 a[168:169], v23 offset:49152
    v_mfma_f32_16x16x32_bf16 v[112:115], a[228:231], v[152:155], v[112:115]
    s_waitcnt lgkmcnt(7)
    ds_read_b64_tr_b16 a[170:171], v23 offset:53248
    v_mfma_f32_16x16x32_bf16 v[112:115], a[232:235], v[200:203], v[112:115]
    s_waitcnt lgkmcnt(6)
    buffer_load_dwordx2 v[78:79], v3, s[20:23], 0 offen offset:32
    v_mfma_f32_16x16x32_bf16 v[112:115], a[236:239], v[184:187], v[112:115]
    ds_read_b64_tr_b16 a[172:173], v23 offset:57344
    ds_read_b64_tr_b16 a[174:175], v23 offset:61440
    v_mfma_f32_16x16x32_bf16 v[116:119], a[208:211], v[132:135], 0
    ds_read_b64_tr_b16 a[176:177], v27 offset:32768
    v_mfma_f32_16x16x32_bf16 v[116:119], a[212:215], v[148:151], v[116:119]
    ds_read_b64_tr_b16 a[178:179], v27 offset:36864
    v_mfma_f32_16x16x32_bf16 v[116:119], a[216:219], v[196:199], v[116:119]
    ds_read_b64_tr_b16 a[180:181], v27 offset:40960
    v_mfma_f32_16x16x32_bf16 v[116:119], a[220:223], v[180:183], v[116:119]
    ds_read_b64_tr_b16 a[182:183], v27 offset:45056
    v_mfma_f32_16x16x32_bf16 v[116:119], a[224:227], v[140:143], v[116:119]
    buffer_load_dwordx2 v[80:81], v3, s[20:23], 0 offen offset:512
    v_mfma_f32_16x16x32_bf16 v[116:119], a[228:231], v[156:159], v[116:119]
    ds_read_b64_tr_b16 a[184:185], v27 offset:49152
    ds_read_b64_tr_b16 a[186:187], v27 offset:53248
    v_mfma_f32_16x16x32_bf16 v[116:119], a[232:235], v[204:207], v[116:119]
    ds_read_b64_tr_b16 a[188:189], v27 offset:57344
    v_mfma_f32_16x16x32_bf16 v[116:119], a[236:239], v[188:191], v[116:119]
    ds_read_b64_tr_b16 a[190:191], v27 offset:61440
    s_waitcnt vmcnt(18)
    s_waitcnt lgkmcnt(0)
    s_barrier
    v_mfma_f32_16x16x32_bf16 v[120:123], a[160:163], v[128:131], 0
    ds_read_b64_tr_b16 a[208:209], v12 offset:0
    v_mfma_f32_16x16x32_bf16 v[120:123], a[164:167], v[144:147], v[120:123]
    ds_read_b64_tr_b16 a[210:211], v12 offset:4096
    v_mfma_f32_16x16x32_bf16 v[120:123], a[168:171], v[192:195], v[120:123]
    buffer_load_dwordx2 v[82:83], v3, s[20:23], 0 offen offset:544
    v_mfma_f32_16x16x32_bf16 v[120:123], a[172:175], v[176:179], v[120:123]
    s_add_u32 s39, s39, 16
    ds_read_b64_tr_b16 a[212:213], v12 offset:8192
    ds_read_b64_tr_b16 a[214:215], v12 offset:12288
    v_mfma_f32_16x16x32_bf16 v[120:123], a[176:179], v[136:139], v[120:123]
    buffer_load_dword v11, v9, s[24:27], s39 offen sc1
    v_mfma_f32_16x16x32_bf16 v[120:123], a[180:183], v[152:155], v[120:123]
    ds_read_b64_tr_b16 a[216:217], v12 offset:16384
    ds_read_b64_tr_b16 a[218:219], v12 offset:20480
    v_mfma_f32_16x16x32_bf16 v[120:123], a[184:187], v[200:203], v[120:123]
    ds_read_b64_tr_b16 a[220:221], v12 offset:24576
    v_mfma_f32_16x16x32_bf16 v[120:123], a[188:191], v[184:187], v[120:123]
    ds_read_b64_tr_b16 a[222:223], v12 offset:28672
    v_mfma_f32_16x16x32_bf16 v[124:127], a[160:163], v[132:135], 0
    buffer_load_dwordx2 v[84:85], v55, s[20:23], 0 offen offset:1024
    v_mfma_f32_16x16x32_bf16 v[124:127], a[164:167], v[148:151], v[124:127]
    ds_read_b64_tr_b16 a[224:225], v16 offset:0
    ds_read_b64_tr_b16 a[226:227], v16 offset:4096
    v_mfma_f32_16x16x32_bf16 v[124:127], a[168:171], v[196:199], v[124:127]
    ds_read_b64_tr_b16 a[228:229], v16 offset:8192
    v_mfma_f32_16x16x32_bf16 v[124:127], a[172:175], v[180:183], v[124:127]
    ds_read_b64_tr_b16 a[230:231], v16 offset:12288
    v_mfma_f32_16x16x32_bf16 v[124:127], a[176:179], v[140:143], v[124:127]
    ds_read_b64_tr_b16 a[232:233], v16 offset:16384
    v_mfma_f32_16x16x32_bf16 v[124:127], a[180:183], v[156:159], v[124:127]
    ds_read_b64_tr_b16 a[234:235], v16 offset:20480
    v_mfma_f32_16x16x32_bf16 v[124:127], a[184:187], v[204:207], v[124:127]
    buffer_load_dwordx2 v[86:87], v55, s[20:23], 0 offen offset:1056
    v_mfma_f32_16x16x32_bf16 v[124:127], a[188:191], v[188:191], v[124:127]
    s_waitcnt lgkmcnt(12)
    ds_read_b64_tr_b16 a[236:237], v16 offset:24576
    ds_read_b64_tr_b16 a[238:239], v16 offset:28672
    v_mfma_f32_16x16x32_bf16 v[96:99], a[208:211], a[64:67], v[96:99]
    s_waitcnt lgkmcnt(12)
    ds_read_b64_tr_b16 a[160:161], v13 offset:0
    v_mfma_f32_16x16x32_bf16 v[96:99], a[212:215], a[68:71], v[96:99]
    s_waitcnt lgkmcnt(11)
    ds_read_b64_tr_b16 a[162:163], v13 offset:4096
    v_mfma_f32_16x16x32_bf16 v[96:99], a[216:219], a[72:75], v[96:99]
    s_waitcnt lgkmcnt(10)
    ds_read_b64_tr_b16 a[164:165], v13 offset:8192
    v_mfma_f32_16x16x32_bf16 v[96:99], a[220:223], a[76:79], v[96:99]
    s_waitcnt lgkmcnt(9)
    s_mov_b32 s45, 22144
    ds_read_b64_tr_b16 a[166:167], v13 offset:12288
    v_mfma_f32_16x16x32_bf16 v[96:99], a[224:227], a[80:83], v[96:99]
    s_waitcnt lgkmcnt(8)
    buffer_load_dwordx4 v[216:219], v5, s[24:27], s45 offen offset:0 sc1
    v_mfma_f32_16x16x32_bf16 v[96:99], a[228:231], a[84:87], v[96:99]
    s_waitcnt lgkmcnt(6)
    ds_read_b64_tr_b16 a[168:169], v13 offset:16384
    ds_read_b64_tr_b16 a[170:171], v13 offset:20480
    v_mfma_f32_16x16x32_bf16 v[96:99], a[232:235], a[88:91], v[96:99]
    s_waitcnt lgkmcnt(6)
    ds_read_b64_tr_b16 a[172:173], v13 offset:24576
    v_mfma_f32_16x16x32_bf16 v[96:99], a[236:239], a[92:95], v[96:99]
    ds_read_b64_tr_b16 a[174:175], v13 offset:28672
    v_mfma_f32_16x16x32_bf16 v[100:103], a[208:211], a[96:99], v[100:103]
    buffer_load_dwordx4 v[220:223], v5, s[24:27], s45 offen offset:512 sc1
    v_mfma_f32_16x16x32_bf16 v[100:103], a[212:215], a[100:103], v[100:103]
Ltour11:
    s_cbranch_execz Ltour15
    ds_read_b64_tr_b16 a[176:177], v17 offset:0
    ds_read_b64_tr_b16 a[178:179], v17 offset:4096
    v_mfma_f32_16x16x32_bf16 v[100:103], a[216:219], a[104:107], v[100:103]
    ds_read_b64_tr_b16 a[180:181], v17 offset:8192
    v_mfma_f32_16x16x32_bf16 v[100:103], a[220:223], a[108:111], v[100:103]
    ds_read_b64_tr_b16 a[182:183], v17 offset:12288
    v_mfma_f32_16x16x32_bf16 v[100:103], a[224:227], a[112:115], v[100:103]
    ds_read_b64_tr_b16 a[184:185], v17 offset:16384
    v_cvt_pk_bf16_f32 v224, v96, v97
    v_mfma_f32_16x16x32_bf16 v[100:103], a[228:231], a[116:119], v[100:103]
    ds_read_b64_tr_b16 a[186:187], v17 offset:20480
    v_cvt_pk_bf16_f32 v225, v98, v99
    v_mfma_f32_16x16x32_bf16 v[100:103], a[232:235], a[120:123], v[100:103]
    ds_read_b64_tr_b16 a[188:189], v17 offset:24576
    v_mfma_f32_16x16x32_bf16 v[100:103], a[236:239], a[124:127], v[100:103]
    s_waitcnt lgkmcnt(13)
    ds_read_b64_tr_b16 a[190:191], v17 offset:28672
    v_mfma_f32_16x16x32_bf16 v[104:107], a[160:163], a[64:67], v[104:107]
    s_waitcnt lgkmcnt(12)
    buffer_load_dwordx4 v[88:91], v59, s[24:27], s45 offen offset:1024 sc1
    v_mfma_f32_16x16x32_bf16 v[104:107], a[164:167], a[68:71], v[104:107]
    s_waitcnt lgkmcnt(10)
    ds_read_b64_tr_b16 a[208:209], v14 offset:0
    ds_read_b64_tr_b16 a[210:211], v14 offset:4096
    v_mfma_f32_16x16x32_bf16 v[104:107], a[168:171], a[72:75], v[104:107]
    s_waitcnt lgkmcnt(10)
    ds_read_b64_tr_b16 a[212:213], v14 offset:8192
    v_mfma_f32_16x16x32_bf16 v[104:107], a[172:175], a[76:79], v[104:107]
    s_waitcnt lgkmcnt(9)
    ds_read_b64_tr_b16 a[214:215], v14 offset:12288
    v_mfma_f32_16x16x32_bf16 v[104:107], a[176:179], a[80:83], v[104:107]
    s_waitcnt lgkmcnt(8)
    ds_read_b64_tr_b16 a[216:217], v14 offset:16384
    v_cvt_pk_bf16_f32 v228, v100, v101
    v_mfma_f32_16x16x32_bf16 v[104:107], a[180:183], a[84:87], v[104:107]
    s_waitcnt lgkmcnt(7)
    ds_read_b64_tr_b16 a[218:219], v14 offset:20480
    v_cvt_pk_bf16_f32 v229, v102, v103
    v_mfma_f32_16x16x32_bf16 v[104:107], a[184:187], a[88:91], v[104:107]
    s_waitcnt lgkmcnt(6)
    ds_read_b64_tr_b16 a[220:221], v14 offset:24576
    v_mfma_f32_16x16x32_bf16 v[104:107], a[188:191], a[92:95], v[104:107]
    ds_read_b64_tr_b16 a[222:223], v14 offset:28672
    v_mfma_f32_16x16x32_bf16 v[108:111], a[160:163], a[96:99], v[108:111]
    ds_read_b64_tr_b16 a[224:225], v18 offset:0
    v_mfma_f32_16x16x32_bf16 v[108:111], a[164:167], a[100:103], v[108:111]
    ds_read_b64_tr_b16 a[226:227], v18 offset:4096
    v_mfma_f32_16x16x32_bf16 v[108:111], a[168:171], a[104:107], v[108:111]
    ds_read_b64_tr_b16 a[228:229], v18 offset:8192
    v_mfma_f32_16x16x32_bf16 v[108:111], a[172:175], a[108:111], v[108:111]
    ds_read_b64_tr_b16 a[230:231], v18 offset:12288
    v_mfma_f32_16x16x32_bf16 v[108:111], a[176:179], a[112:115], v[108:111]
    ds_read_b64_tr_b16 a[232:233], v18 offset:16384
    v_cvt_pk_bf16_f32 v226, v104, v105
    v_mfma_f32_16x16x32_bf16 v[108:111], a[180:183], a[116:119], v[108:111]
    s_add_u32 s38, s93, 1536
    ds_read_b64_tr_b16 a[234:235], v18 offset:20480
    v_cvt_pk_bf16_f32 v227, v106, v107
    v_mfma_f32_16x16x32_bf16 v[108:111], a[184:187], a[120:123], v[108:111]
    buffer_store_dwordx4 v[224:227], v56, s[28:31], s38 offen sc1
    v_mfma_f32_16x16x32_bf16 v[108:111], a[188:191], a[124:127], v[108:111]
    s_waitcnt lgkmcnt(12)
    ds_read_b64_tr_b16 a[236:237], v18 offset:24576
    ds_read_b64_tr_b16 a[238:239], v18 offset:28672
    v_mfma_f32_16x16x32_bf16 v[112:115], a[208:211], a[64:67], v[112:115]
    s_waitcnt lgkmcnt(12)
    ds_read_b64_tr_b16 a[160:161], v15 offset:0
    v_mfma_f32_16x16x32_bf16 v[112:115], a[212:215], a[68:71], v[112:115]
    s_waitcnt lgkmcnt(11)
    ds_read_b64_tr_b16 a[162:163], v15 offset:4096
    v_mfma_f32_16x16x32_bf16 v[112:115], a[216:219], a[72:75], v[112:115]
    s_waitcnt lgkmcnt(10)
    ds_read_b64_tr_b16 a[164:165], v15 offset:8192
    v_mfma_f32_16x16x32_bf16 v[112:115], a[220:223], a[76:79], v[112:115]
    s_waitcnt lgkmcnt(9)
    ds_read_b64_tr_b16 a[166:167], v15 offset:12288
    v_mfma_f32_16x16x32_bf16 v[112:115], a[224:227], a[80:83], v[112:115]
    s_waitcnt lgkmcnt(8)
    ds_read_b64_tr_b16 a[168:169], v15 offset:16384
    v_cvt_pk_bf16_f32 v230, v108, v109
    v_mfma_f32_16x16x32_bf16 v[112:115], a[228:231], a[84:87], v[112:115]
    s_waitcnt lgkmcnt(7)
    s_add_u32 s38, s93, 165376
    ds_read_b64_tr_b16 a[170:171], v15 offset:20480
    v_cvt_pk_bf16_f32 v231, v110, v111
    v_mfma_f32_16x16x32_bf16 v[112:115], a[232:235], a[88:91], v[112:115]
    s_waitcnt lgkmcnt(6)
    buffer_store_dwordx4 v[228:231], v56, s[28:31], s38 offen sc1
    v_mfma_f32_16x16x32_bf16 v[112:115], a[236:239], a[92:95], v[112:115]
    ds_read_b64_tr_b16 a[172:173], v15 offset:24576
    ds_read_b64_tr_b16 a[174:175], v15 offset:28672
    v_mfma_f32_16x16x32_bf16 v[116:119], a[208:211], a[96:99], v[116:119]
    ds_read_b64_tr_b16 a[176:177], v19 offset:0
    v_mfma_f32_16x16x32_bf16 v[116:119], a[212:215], a[100:103], v[116:119]
    ds_read_b64_tr_b16 a[178:179], v19 offset:4096
    v_mfma_f32_16x16x32_bf16 v[116:119], a[216:219], a[104:107], v[116:119]
    ds_read_b64_tr_b16 a[180:181], v19 offset:8192
    v_mfma_f32_16x16x32_bf16 v[116:119], a[220:223], a[108:111], v[116:119]
    ds_read_b64_tr_b16 a[182:183], v19 offset:12288
    v_mfma_f32_16x16x32_bf16 v[116:119], a[224:227], a[112:115], v[116:119]
    ds_read_b64_tr_b16 a[184:185], v19 offset:16384
    v_cvt_pk_bf16_f32 v232, v112, v113
    v_mfma_f32_16x16x32_bf16 v[116:119], a[228:231], a[116:119], v[116:119]
    ds_read_b64_tr_b16 a[186:187], v19 offset:20480
    v_cvt_pk_bf16_f32 v233, v114, v115
    v_mfma_f32_16x16x32_bf16 v[116:119], a[232:235], a[120:123], v[116:119]
    ds_read_b64_tr_b16 a[188:189], v19 offset:24576
    v_mfma_f32_16x16x32_bf16 v[116:119], a[236:239], a[124:127], v[116:119]
    s_waitcnt lgkmcnt(13)
    ds_read_b64_tr_b16 a[190:191], v19 offset:28672
    v_mfma_f32_16x16x32_bf16 v[120:123], a[160:163], a[64:67], v[120:123]
    s_waitcnt lgkmcnt(12)
    v_mfma_f32_16x16x32_bf16 v[120:123], a[164:167], a[68:71], v[120:123]
    s_waitcnt lgkmcnt(10)
    v_mfma_f32_16x16x32_bf16 v[120:123], a[168:171], a[72:75], v[120:123]
    s_waitcnt lgkmcnt(8)
    v_mfma_f32_16x16x32_bf16 v[120:123], a[172:175], a[76:79], v[120:123]
    s_waitcnt lgkmcnt(6)
    v_mfma_f32_16x16x32_bf16 v[120:123], a[176:179], a[80:83], v[120:123]
    s_waitcnt lgkmcnt(4)
    v_cvt_pk_bf16_f32 v236, v116, v117
    v_mfma_f32_16x16x32_bf16 v[120:123], a[180:183], a[84:87], v[120:123]
    s_waitcnt lgkmcnt(2)
    v_cvt_pk_bf16_f32 v237, v118, v119
    v_mfma_f32_16x16x32_bf16 v[120:123], a[184:187], a[88:91], v[120:123]
    s_waitcnt lgkmcnt(0)
    v_mfma_f32_16x16x32_bf16 v[120:123], a[188:191], a[92:95], v[120:123]
    v_mfma_f32_16x16x32_bf16 v[124:127], a[160:163], a[96:99], v[124:127]
    v_mfma_f32_16x16x32_bf16 v[124:127], a[164:167], a[100:103], v[124:127]
    v_mfma_f32_16x16x32_bf16 v[124:127], a[168:171], a[104:107], v[124:127]
    v_mfma_f32_16x16x32_bf16 v[124:127], a[172:175], a[108:111], v[124:127]
    v_mfma_f32_16x16x32_bf16 v[124:127], a[176:179], a[112:115], v[124:127]
    s_nop 2
    v_cvt_pk_bf16_f32 v234, v120, v121
    v_mfma_f32_16x16x32_bf16 v[124:127], a[180:183], a[116:119], v[124:127]
    s_add_u32 s38, s93, 1664
    v_cvt_pk_bf16_f32 v235, v122, v123
    v_mfma_f32_16x16x32_bf16 v[124:127], a[184:187], a[120:123], v[124:127]
    buffer_store_dwordx4 v[232:235], v56, s[28:31], s38 offen sc1
    v_mfma_f32_16x16x32_bf16 v[124:127], a[188:191], a[124:127], v[124:127]
    s_nop 7
    v_cvt_pk_bf16_f32 v238, v124, v125
    s_add_u32 s38, s93, 165504
    v_cvt_pk_bf16_f32 v239, v126, v127
    buffer_store_dwordx4 v[236:239], v56, s[28:31], s38 offen sc1
    s_add_u32 s92, s92, 16
    s_waitcnt vmcnt(27)
    v_lshlrev_b32 v96, 16, v160
    v_and_b32 v97, 0xffff0000, v160
    v_lshlrev_b32 v98, 16, v161
    v_and_b32 v99, 0xffff0000, v161
    v_lshlrev_b32 v100, 16, v162
    v_and_b32 v101, 0xffff0000, v162
    v_lshlrev_b32 v102, 16, v163
    v_and_b32 v103, 0xffff0000, v163
    s_waitcnt vmcnt(25)
    v_lshlrev_b32 v104, 16, v164
    v_and_b32 v105, 0xffff0000, v164
    v_lshlrev_b32 v106, 16, v165
    v_and_b32 v107, 0xffff0000, v165
    v_lshlrev_b32 v108, 16, v166
    v_and_b32 v109, 0xffff0000, v166
    v_lshlrev_b32 v110, 16, v167
    v_and_b32 v111, 0xffff0000, v167
    s_waitcnt vmcnt(24)
    v_lshlrev_b32 v112, 16, v168
    v_and_b32 v113, 0xffff0000, v168
    v_lshlrev_b32 v114, 16, v169
    v_and_b32 v115, 0xffff0000, v169
    v_lshlrev_b32 v116, 16, v170
    v_and_b32 v117, 0xffff0000, v170
    v_lshlrev_b32 v118, 16, v171
    v_and_b32 v119, 0xffff0000, v171
    s_waitcnt vmcnt(23)
    v_lshlrev_b32 v120, 16, v172
    v_and_b32 v121, 0xffff0000, v172
    v_lshlrev_b32 v122, 16, v173
    v_and_b32 v123, 0xffff0000, v173
    v_lshlrev_b32 v124, 16, v174
    v_and_b32 v125, 0xffff0000, v174
    v_lshlrev_b32 v126, 16, v175
    v_and_b32 v127, 0xffff0000, v175
    s_waitcnt vmcnt(22)
    v_lshlrev_b32 v128, 16, v208
    v_and_b32 v129, 0xffff0000, v208
    v_lshlrev_b32 v130, 16, v209
    v_and_b32 v131, 0xffff0000, v209
    v_lshlrev_b32 v132, 16, v210
    v_and_b32 v133, 0xffff0000, v210
    v_lshlrev_b32 v134, 16, v211
    v_and_b32 v135, 0xffff0000, v211
    s_waitcnt vmcnt(20)
    v_lshlrev_b32 v136, 16, v212
    v_and_b32 v137, 0xffff0000, v212
    v_lshlrev_b32 v138, 16, v213
    v_and_b32 v139, 0xffff0000, v213
    v_lshlrev_b32 v140, 16, v214
    v_and_b32 v141, 0xffff0000, v214
    v_lshlrev_b32 v142, 16, v215
    v_and_b32 v143, 0xffff0000, v215
    s_waitcnt vmcnt(16)
    v_lshlrev_b32 v144, 16, v64
    v_and_b32 v145, 0xffff0000, v64
    v_lshlrev_b32 v146, 16, v65
    v_and_b32 v147, 0xffff0000, v65
    v_lshlrev_b32 v148, 16, v66
    v_and_b32 v149, 0xffff0000, v66
    v_lshlrev_b32 v150, 16, v67
    v_and_b32 v151, 0xffff0000, v67
    s_waitcnt vmcnt(15)
    v_lshlrev_b32 v152, 16, v68
    v_and_b32 v153, 0xffff0000, v68
    v_lshlrev_b32 v154, 16, v69
    v_and_b32 v155, 0xffff0000, v69
    v_lshlrev_b32 v156, 16, v70
    v_and_b32 v157, 0xffff0000, v70
    v_lshlrev_b32 v158, 16, v71
    v_and_b32 v159, 0xffff0000, v71
    s_waitcnt vmcnt(14)
    v_lshlrev_b32 v160, 16, v72
    v_and_b32 v161, 0xffff0000, v72
    v_lshlrev_b32 v162, 16, v73
    v_and_b32 v163, 0xffff0000, v73
    v_lshlrev_b32 v164, 16, v74
    v_and_b32 v165, 0xffff0000, v74
    v_lshlrev_b32 v166, 16, v75
    v_and_b32 v167, 0xffff0000, v75
    s_waitcnt vmcnt(13)
    v_lshlrev_b32 v168, 16, v76
    v_and_b32 v169, 0xffff0000, v76
    v_lshlrev_b32 v170, 16, v77
    v_and_b32 v171, 0xffff0000, v77
    s_waitcnt vmcnt(12)
    v_lshlrev_b32 v172, 16, v78
    v_and_b32 v173, 0xffff0000, v78
    v_lshlrev_b32 v174, 16, v79
    v_and_b32 v175, 0xffff0000, v79
    s_waitcnt vmcnt(11)
    v_lshlrev_b32 v176, 16, v80
    v_and_b32 v177, 0xffff0000, v80
    v_lshlrev_b32 v178, 16, v81
    v_and_b32 v179, 0xffff0000, v81
    s_waitcnt vmcnt(10)
    v_lshlrev_b32 v180, 16, v82
    v_and_b32 v181, 0xffff0000, v82
    v_lshlrev_b32 v182, 16, v83
    v_and_b32 v183, 0xffff0000, v83
    s_waitcnt vmcnt(8)
    v_lshlrev_b32 v184, 16, v84
    v_and_b32 v185, 0xffff0000, v84
    v_lshlrev_b32 v186, 16, v85
    v_and_b32 v187, 0xffff0000, v85
    s_waitcnt vmcnt(7)
    v_lshlrev_b32 v188, 16, v86
    v_and_b32 v189, 0xffff0000, v86
    v_lshlrev_b32 v190, 16, v87
    v_and_b32 v191, 0xffff0000, v87
    s_waitcnt vmcnt(0)
    buffer_store_dword v10, v8, s[24:27], s92 offen sc1
    v_cmp_ne_u32 s[54:55], s95, v11
    s_cmp_lg_u64 s[54:55], 0
    s_cbranch_scc1 Ltail_spin1
Ltail_got1:
    s_add_u32 s56, s44, 16384
    buffer_load_dwordx4 a[0:3], v54, s[28:31], s56 offen offset:0 sc1
    buffer_load_dwordx4 a[4:7], v54, s[28:31], s56 offen offset:1024 sc1
    buffer_load_dwordx4 a[8:11], v54, s[28:31], s56 offen offset:2048 sc1
    buffer_load_dwordx4 a[12:15], v54, s[28:31], s56 offen offset:3072 sc1
    s_add_u32 s56, s44, 0
    buffer_load_dwordx4 a[16:19], v2, s[28:31], s56 offen offset:0 sc1
    s_add_u32 s56, s44, 4096
    buffer_load_dwordx4 a[20:23], v2, s[28:31], s56 offen offset:0 sc1
    s_add_u32 s56, s44, 8192
    buffer_load_dwordx4 a[24:27], v2, s[28:31], s56 offen offset:0 sc1
    s_add_u32 s56, s44, 12288
    buffer_load_dwordx4 a[28:31], v2, s[28:31], s56 offen offset:0 sc1
    ds_write_b128 v51, a[128:131] offset:0
    ds_write_b128 v51, a[132:135] offset:4096
    ds_write_b128 v51, a[136:139] offset:8192
    ds_write_b128 v51, a[140:143] offset:12288
    ds_write_b128 v51, a[144:147] offset:16384
    ds_write_b128 v51, a[148:151] offset:20480
    ds_write_b128 v51, a[152:155] offset:24576
    ds_write_b128 v51, a[156:159] offset:28672
    ds_write_b128 v51, a[240:243] offset:32768
    ds_write_b128 v255, a[244:247] offset:40960
    ds_write_b128 v255, a[248:251] offset:45056
    ds_write_b128 v255, a[252:255] offset:49152
    v_lshlrev_b32 v12, 16, v36
    v_and_b32 v13, 0xffff0000, v36
    v_lshlrev_b32 v14, 16, v37
    v_and_b32 v15, 0xffff0000, v37
    v_lshlrev_b32 v16, 16, v38
    v_and_b32 v17, 0xffff0000, v38
    v_lshlrev_b32 v18, 16, v39
    v_and_b32 v19, 0xffff0000, v39
    v_lshlrev_b32 v20, 16, v40
    v_and_b32 v21, 0xffff0000, v40
    v_lshlrev_b32 v22, 16, v41
    v_and_b32 v23, 0xffff0000, v41
    v_lshlrev_b32 v24, 16, v42
    v_and_b32 v25, 0xffff0000, v42
    v_lshlrev_b32 v26, 16, v43
    v_and_b32 v27, 0xffff0000, v43
    v_lshlrev_b32 v28, 16, v92
    v_and_b32 v29, 0xffff0000, v92
    v_lshlrev_b32 v30, 16, v93
    v_and_b32 v31, 0xffff0000, v93
    v_lshlrev_b32 v32, 16, v94
    v_and_b32 v33, 0xffff0000, v94
    v_lshlrev_b32 v34, 16, v95
    v_and_b32 v35, 0xffff0000, v95
    v_lshlrev_b32 v192, 16, v216
    v_and_b32 v193, 0xffff0000, v216
    v_lshlrev_b32 v194, 16, v217
    v_and_b32 v195, 0xffff0000, v217
    v_lshlrev_b32 v196, 16, v218
    v_and_b32 v197, 0xffff0000, v218
    v_lshlrev_b32 v198, 16, v219
    v_and_b32 v199, 0xffff0000, v219
    v_lshlrev_b32 v200, 16, v220
    v_and_b32 v201, 0xffff0000, v220
    v_lshlrev_b32 v202, 16, v221
    v_and_b32 v203, 0xffff0000, v221
    v_lshlrev_b32 v204, 16, v222
    v_and_b32 v205, 0xffff0000, v222
    v_lshlrev_b32 v206, 16, v223
    v_and_b32 v207, 0xffff0000, v223
    v_lshlrev_b32 v208, 16, v88
    v_and_b32 v209, 0xffff0000, v88
    v_lshlrev_b32 v210, 16, v89
    v_and_b32 v211, 0xffff0000, v89
    v_lshlrev_b32 v212, 16, v90
    v_and_b32 v213, 0xffff0000, v90
    v_lshlrev_b32 v214, 16, v91
    v_and_b32 v215, 0xffff0000, v91
    s_add_u32 s39, s39, 16
    buffer_load_dword v11, v9, s[24:27], s39 offen sc1
    s_add_u32 s56, s44, 0
    buffer_load_dwordx4 a[32:35], v2, s[28:31], s56 offen offset:512 sc1
    s_add_u32 s56, s44, 4096
    buffer_load_dwordx4 a[36:39], v2, s[28:31], s56 offen offset:512 sc1
    s_add_u32 s56, s44, 8192
    buffer_load_dwordx4 a[40:43], v2, s[28:31], s56 offen offset:512 sc1
    s_add_u32 s56, s44, 12288
    buffer_load_dwordx4 a[44:47], v2, s[28:31], s56 offen offset:512 sc1
    v_pk_mul_f32 v[62:63], v[144:145], v[168:169]
    v_pk_mul_f32 v[168:169], v[168:169], v[120:121]
    v_pk_fma_f32 v[62:63], v[146:147], v[170:171], v[62:63]
    v_pk_mul_f32 v[170:171], v[170:171], v[122:123]
    v_pk_add_f32 v[88:89], v[168:169], v[170:171]
    v_pk_fma_f32 v[62:63], v[148:149], v[172:173], v[62:63]
    v_pk_mul_f32 v[172:173], v[172:173], v[124:125]
    v_pk_add_f32 v[88:89], v[88:89], v[172:173]
    v_pk_fma_f32 v[62:63], v[150:151], v[174:175], v[62:63]
    v_pk_mul_f32 v[174:175], v[174:175], v[126:127]
    v_pk_add_f32 v[88:89], v[88:89], v[174:175]
    v_pk_fma_f32 v[62:63], v[152:153], v[176:177], v[62:63]
    v_pk_mul_f32 v[176:177], v[176:177], v[128:129]
    v_pk_add_f32 v[88:89], v[88:89], v[176:177]
    v_pk_fma_f32 v[62:63], v[154:155], v[178:179], v[62:63]
    v_pk_mul_f32 v[178:179], v[178:179], v[130:131]
    v_pk_add_f32 v[88:89], v[88:89], v[178:179]
    v_pk_fma_f32 v[62:63], v[156:157], v[180:181], v[62:63]
    v_pk_mul_f32 v[180:181], v[180:181], v[132:133]
    v_pk_add_f32 v[88:89], v[88:89], v[180:181]
    v_pk_fma_f32 v[62:63], v[158:159], v[182:183], v[62:63]
    v_pk_mul_f32 v[182:183], v[182:183], v[134:135]
    v_pk_add_f32 v[88:89], v[88:89], v[182:183]
    v_pk_fma_f32 v[62:63], v[160:161], v[184:185], v[62:63]
    v_pk_mul_f32 v[184:185], v[184:185], v[136:137]
    v_pk_add_f32 v[88:89], v[88:89], v[184:185]
    v_pk_fma_f32 v[62:63], v[162:163], v[186:187], v[62:63]
    v_pk_mul_f32 v[186:187], v[186:187], v[138:139]
    v_pk_add_f32 v[88:89], v[88:89], v[186:187]
    v_pk_fma_f32 v[62:63], v[164:165], v[188:189], v[62:63]
    v_pk_mul_f32 v[188:189], v[188:189], v[140:141]
    v_pk_add_f32 v[88:89], v[88:89], v[188:189]
    v_pk_fma_f32 v[62:63], v[166:167], v[190:191], v[62:63]
    v_pk_mul_f32 v[190:191], v[190:191], v[142:143]
    v_pk_add_f32 v[88:89], v[88:89], v[190:191]
    v_add_f32 v91, v62, v63
    v_add_f32 v90, v88, v89
    s_nop 1
    v_add_f32_dpp v90, v90, v90 row_ror:8 row_mask:0xf bank_mask:0xf
    v_add_f32_dpp v91, v91, v91 row_ror:8 row_mask:0xf bank_mask:0xf
    s_nop 0
    v_add_f32_dpp v90, v90, v90 row_ror:4 row_mask:0xf bank_mask:0xf
    v_add_f32_dpp v91, v91, v91 row_ror:4 row_mask:0xf bank_mask:0xf
    s_nop 0
    v_add_f32_dpp v90, v90, v90 row_ror:2 row_mask:0xf bank_mask:0xf
    v_add_f32_dpp v91, v91, v91 row_ror:2 row_mask:0xf bank_mask:0xf
    s_nop 0
    v_add_f32_dpp v90, v90, v90 row_ror:1 row_mask:0xf bank_mask:0xf
    v_add_f32_dpp v91, v91, v91 row_ror:1 row_mask:0xf bank_mask:0xf
    v_mov_b32 v62, v90
    v_mov_b32 v63, v91
    s_nop 0
    v_permlane16_swap_b32 v90, v62
    v_permlane16_swap_b32 v91, v63
    v_add_f32 v90, v90, v62
    v_add_f32 v91, v91, v63
    v_lshlrev_b32 v92, 2, v7
    v_and_b32 v92, 28, v92
    v_sub_u32 v93, 2047, v7
    s_waitcnt vmcnt(4)
    v_cmp_ne_u32 s[54:55], s95, v11
    s_cmp_lg_u64 s[54:55], 0
    s_cbranch_scc1 Ltail_spin2
Ltail_got2:
    s_add_u32 s56, s44, 0
    buffer_load_dwordx4 a[48:51], v2, s[28:31], s56 offen offset:1024 sc1
    s_add_u32 s56, s44, 4096
    buffer_load_dwordx4 a[52:55], v2, s[28:31], s56 offen offset:1024 sc1
    s_add_u32 s56, s44, 8192
    buffer_load_dwordx4 a[56:59], v2, s[28:31], s56 offen offset:1024 sc1
    s_add_u32 s56, s44, 12288
    buffer_load_dwordx4 a[60:63], v2, s[28:31], s56 offen offset:1024 sc1
    s_add_u32 s56, s44, 0
    buffer_load_dwordx4 a[64:67], v2, s[28:31], s56 offen offset:1536 sc1
    s_add_u32 s56, s44, 4096
    buffer_load_dwordx4 a[68:71], v2, s[28:31], s56 offen offset:1536 sc1
    s_add_u32 s56, s44, 8192
    buffer_load_dwordx4 a[72:75], v2, s[28:31], s56 offen offset:1536 sc1
    s_add_u32 s56, s44, 12288
    buffer_load_dwordx4 a[76:79], v2, s[28:31], s56 offen offset:1536 sc1
    s_movk_i32 s48, 0x7ff
    v_mfma_f32_16x16x32_bf16 v[80:83], v[242:245], a[0:3], 0
    v_mfma_f32_16x16x32_bf16 v[84:87], v[240:243], a[0:3], 0
    v_mfma_f32_16x16x32_bf16 v[80:83], v[242:245], a[4:7], v[80:83]
    v_mfma_f32_16x16x32_bf16 v[84:87], v[240:243], a[4:7], v[84:87]
    v_mfma_f32_16x16x32_bf16 v[80:83], v[242:245], a[8:11], v[80:83]
    v_mfma_f32_16x16x32_bf16 v[84:87], v[240:243], a[8:11], v[84:87]
    v_mfma_f32_16x16x32_bf16 v[80:83], v[242:245], a[12:15], v[80:83]
    v_mfma_f32_16x16x32_bf16 v[84:87], v[240:243], a[12:15], v[84:87]
    s_nop 6
    v_mov_b32_dpp v80, v80 row_ror:8 row_mask:0x4 bank_mask:0xf
    v_mov_b32_dpp v81, v81 row_ror:8 row_mask:0x4 bank_mask:0xf
    v_mov_b32_dpp v82, v82 row_ror:8 row_mask:0x4 bank_mask:0xf
    v_mov_b32_dpp v83, v83 row_ror:8 row_mask:0x4 bank_mask:0xf
    v_mov_b32_dpp v84, v84 row_ror:8 row_mask:0x4 bank_mask:0xf
    v_mov_b32_dpp v85, v85 row_ror:8 row_mask:0x4 bank_mask:0xf
    v_mov_b32_dpp v86, v86 row_ror:8 row_mask:0x4 bank_mask:0xf
    v_mov_b32_dpp v87, v87 row_ror:8 row_mask:0x4 bank_mask:0xf
    v_pk_fma_f32 v[28:29], v[112:113], v[80:81], v[28:29]
    v_pk_fma_f32 v[30:31], v[114:115], v[82:83], v[30:31]
    v_pk_fma_f32 v[32:33], v[116:117], v[84:85], v[32:33]
    v_pk_fma_f32 v[34:35], v[118:119], v[86:87], v[34:35]
    v_cvt_pk_bf16_f32 v44, v28, v29
    v_cvt_pk_bf16_f32 v45, v30, v31
    v_cvt_pk_bf16_f32 v46, v32, v33
    v_cvt_pk_bf16_f32 v47, v34, v35
    v_lshlrev_b32 v28, 16, v44
    v_and_b32 v29, 0xffff0000, v44
    v_lshlrev_b32 v30, 16, v45
    v_and_b32 v31, 0xffff0000, v45
    v_lshlrev_b32 v32, 16, v46
    v_and_b32 v33, 0xffff0000, v46
    v_lshlrev_b32 v34, 16, v47
    v_and_b32 v35, 0xffff0000, v47
    v_mfma_f32_16x16x32_bf16 v[64:67], v[246:249], a[16:19], 0
    v_mfma_f32_16x16x32_bf16 v[68:71], v[244:247], a[16:19], 0
    v_mfma_f32_16x16x32_bf16 v[64:67], v[246:249], a[20:23], v[64:67]
    v_mfma_f32_16x16x32_bf16 v[68:71], v[244:247], a[20:23], v[68:71]
    v_mfma_f32_16x16x32_bf16 v[64:67], v[246:249], a[24:27], v[64:67]
    v_mfma_f32_16x16x32_bf16 v[68:71], v[244:247], a[24:27], v[68:71]
    v_mfma_f32_16x16x32_bf16 v[64:67], v[246:249], a[28:31], v[64:67]
    v_mfma_f32_16x16x32_bf16 v[68:71], v[244:247], a[28:31], v[68:71]
    s_waitcnt vmcnt(11)
    v_mfma_f32_16x16x32_bf16 v[64:67], v[250:253], a[32:35], v[64:67]
    v_mfma_f32_16x16x32_bf16 v[68:71], v[248:251], a[32:35], v[68:71]
    s_waitcnt vmcnt(10)
    v_mfma_f32_16x16x32_bf16 v[64:67], v[250:253], a[36:39], v[64:67]
    v_mfma_f32_16x16x32_bf16 v[68:71], v[248:251], a[36:39], v[68:71]
    s_waitcnt vmcnt(9)
    v_mfma_f32_16x16x32_bf16 v[64:67], v[250:253], a[40:43], v[64:67]
    v_mfma_f32_16x16x32_bf16 v[68:71], v[248:251], a[40:43], v[68:71]
    s_waitcnt vmcnt(8)
    v_mfma_f32_16x16x32_bf16 v[64:67], v[250:253], a[44:47], v[64:67]
    v_mfma_f32_16x16x32_bf16 v[68:71], v[248:251], a[44:47], v[68:71]
    s_waitcnt vmcnt(7)
    s_nop 5
    v_pk_fma_f32 v[12:13], v[96:97], v[64:65], v[12:13]
    v_pk_fma_f32 v[14:15], v[98:99], v[66:67], v[14:15]
    v_pk_fma_f32 v[16:17], v[100:101], v[68:69], v[16:17]
    v_pk_fma_f32 v[18:19], v[102:103], v[70:71], v[18:19]
    v_cvt_pk_bf16_f32 v36, v12, v13
    v_cvt_pk_bf16_f32 v37, v14, v15
    v_cvt_pk_bf16_f32 v38, v16, v17
    v_cvt_pk_bf16_f32 v39, v18, v19
    v_lshlrev_b32 v12, 16, v36
    v_and_b32 v13, 0xffff0000, v36
    v_lshlrev_b32 v14, 16, v37
    v_and_b32 v15, 0xffff0000, v37
    v_lshlrev_b32 v16, 16, v38
    v_and_b32 v17, 0xffff0000, v38
    v_lshlrev_b32 v18, 16, v39
    v_and_b32 v19, 0xffff0000, v39
    v_pk_add_f32 v[88:89], v[12:13], v[14:15]
    v_pk_add_f32 v[62:63], v[16:17], v[18:19]
    v_pk_add_f32 v[88:89], v[88:89], v[62:63]
    v_add_f32 v88, v88, v89
    s_nop 1
    v_add_f32_dpp v88, v88, v88 row_ror:8 row_mask:0xf bank_mask:0xf
    s_nop 1
    v_add_f32_dpp v88, v88, v88 row_ror:4 row_mask:0xf bank_mask:0xf
    s_nop 1
    v_add_f32_dpp v88, v88, v88 row_ror:2 row_mask:0xf bank_mask:0xf
    s_nop 1
    v_add_f32_dpp v88, v88, v88 row_ror:1 row_mask:0xf bank_mask:0xf
    v_mov_b32 v62, v88
    s_nop 1
    v_permlane16_swap_b32 v88, v62
    s_nop 0
    v_add_f32 v88, v88, v62
    v_mul_f32 v88, 0x3b800000, v88
    v_pk_add_f32 v[232:233], v[28:29], v[88:89] op_sel_hi:[1,0] neg_lo:[0,1] neg_hi:[0,1]
    v_pk_add_f32 v[234:235], v[30:31], v[88:89] op_sel_hi:[1,0] neg_lo:[0,1] neg_hi:[0,1]
    v_pk_add_f32 v[236:237], v[32:33], v[88:89] op_sel_hi:[1,0] neg_lo:[0,1] neg_hi:[0,1]
    v_pk_add_f32 v[238:239], v[34:35], v[88:89] op_sel_hi:[1,0] neg_lo:[0,1] neg_hi:[0,1]
    v_pk_add_f32 v[48:49], v[232:233], v[234:235]
    v_pk_mul_f32 v[50:51], v[232:233], v[232:233]
    v_pk_mul_f32 v[52:53], v[232:233], v[184:185]
    v_pk_fma_f32 v[50:51], v[234:235], v[234:235], v[50:51]
    v_pk_fma_f32 v[52:53], v[234:235], v[186:187], v[52:53]
    v_pk_add_f32 v[48:49], v[48:49], v[236:237]
    v_pk_fma_f32 v[50:51], v[236:237], v[236:237], v[50:51]
    v_pk_fma_f32 v[52:53], v[236:237], v[188:189], v[52:53]
    v_pk_add_f32 v[48:49], v[48:49], v[238:239]
    v_pk_fma_f32 v[50:51], v[238:239], v[238:239], v[50:51]
    v_pk_fma_f32 v[52:53], v[238:239], v[190:191], v[52:53]
    v_cndmask_b32 v48, 0, v48, vcc
    v_cndmask_b32 v49, 0, v49, vcc
    v_cndmask_b32 v50, 0, v50, vcc
    v_cndmask_b32 v51, 0, v51, vcc
    v_pk_add_f32 v[216:217], v[12:13], v[88:89] op_sel_hi:[1,0] neg_lo:[0,1] neg_hi:[0,1]
    v_pk_add_f32 v[218:219], v[14:15], v[88:89] op_sel_hi:[1,0] neg_lo:[0,1] neg_hi:[0,1]
    v_pk_add_f32 v[220:221], v[16:17], v[88:89] op_sel_hi:[1,0] neg_lo:[0,1] neg_hi:[0,1]
    v_pk_add_f32 v[222:223], v[18:19], v[88:89] op_sel_hi:[1,0] neg_lo:[0,1] neg_hi:[0,1]
    v_pk_add_f32 v[48:49], v[48:49], v[216:217]
    v_pk_fma_f32 v[50:51], v[216:217], v[216:217], v[50:51]
    v_pk_fma_f32 v[52:53], v[216:217], v[168:169], v[52:53]
    v_pk_add_f32 v[48:49], v[48:49], v[218:219]
    v_pk_fma_f32 v[50:51], v[218:219], v[218:219], v[50:51]
    v_pk_fma_f32 v[52:53], v[218:219], v[170:171], v[52:53]
    v_pk_add_f32 v[48:49], v[48:49], v[220:221]
    v_pk_fma_f32 v[50:51], v[220:221], v[220:221], v[50:51]
    v_pk_fma_f32 v[52:53], v[220:221], v[172:173], v[52:53]
    v_pk_add_f32 v[48:49], v[48:49], v[222:223]
    v_pk_fma_f32 v[50:51], v[222:223], v[222:223], v[50:51]
    v_pk_fma_f32 v[52:53], v[222:223], v[174:175], v[52:53]
    v_mfma_f32_16x16x32_bf16 v[72:75], v[246:249], a[48:51], 0
    v_mfma_f32_16x16x32_bf16 v[76:79], v[244:247], a[48:51], 0
    s_waitcnt vmcnt(6)
    v_mfma_f32_16x16x32_bf16 v[72:75], v[246:249], a[52:55], v[72:75]
    v_mfma_f32_16x16x32_bf16 v[76:79], v[244:247], a[52:55], v[76:79]
    s_waitcnt vmcnt(5)
    v_mfma_f32_16x16x32_bf16 v[72:75], v[246:249], a[56:59], v[72:75]
    v_mfma_f32_16x16x32_bf16 v[76:79], v[244:247], a[56:59], v[76:79]
    s_waitcnt vmcnt(4)
    v_mfma_f32_16x16x32_bf16 v[72:75], v[246:249], a[60:63], v[72:75]
    v_mfma_f32_16x16x32_bf16 v[76:79], v[244:247], a[60:63], v[76:79]
    s_waitcnt vmcnt(3)
    v_mfma_f32_16x16x32_bf16 v[72:75], v[250:253], a[64:67], v[72:75]
    v_mfma_f32_16x16x32_bf16 v[76:79], v[248:251], a[64:67], v[76:79]
    s_waitcnt vmcnt(2)
    v_mfma_f32_16x16x32_bf16 v[72:75], v[250:253], a[68:71], v[72:75]
    v_mfma_f32_16x16x32_bf16 v[76:79], v[248:251], a[68:71], v[76:79]
    s_waitcnt vmcnt(1)
    v_mfma_f32_16x16x32_bf16 v[72:75], v[250:253], a[72:75], v[72:75]
    v_mfma_f32_16x16x32_bf16 v[76:79], v[248:251], a[72:75], v[76:79]
    s_waitcnt vmcnt(0)
    v_mfma_f32_16x16x32_bf16 v[72:75], v[250:253], a[76:79], v[72:75]
    v_mfma_f32_16x16x32_bf16 v[76:79], v[248:251], a[76:79], v[76:79]
    s_nop 6
    v_pk_fma_f32 v[20:21], v[104:105], v[72:73], v[20:21]
    v_pk_fma_f32 v[22:23], v[106:107], v[74:75], v[22:23]
    v_pk_fma_f32 v[24:25], v[108:109], v[76:77], v[24:25]
    v_pk_fma_f32 v[26:27], v[110:111], v[78:79], v[26:27]
    v_cvt_pk_bf16_f32 v40, v20, v21
    v_cvt_pk_bf16_f32 v41, v22, v23
    v_cvt_pk_bf16_f32 v42, v24, v25
    v_cvt_pk_bf16_f32 v43, v26, v27
    v_lshlrev_b32 v20, 16, v40
    v_and_b32 v21, 0xffff0000, v40
    v_lshlrev_b32 v22, 16, v41
    v_and_b32 v23, 0xffff0000, v41
    v_lshlrev_b32 v24, 16, v42
    v_and_b32 v25, 0xffff0000, v42
    v_lshlrev_b32 v26, 16, v43
    v_and_b32 v27, 0xffff0000, v43
    v_pk_add_f32 v[224:225], v[20:21], v[88:89] op_sel_hi:[1,0] neg_lo:[0,1] neg_hi:[0,1]
    v_pk_add_f32 v[226:227], v[22:23], v[88:89] op_sel_hi:[1,0] neg_lo:[0,1] neg_hi:[0,1]
    v_pk_add_f32 v[228:229], v[24:25], v[88:89] op_sel_hi:[1,0] neg_lo:[0,1] neg_hi:[0,1]
    v_pk_add_f32 v[230:231], v[26:27], v[88:89] op_sel_hi:[1,0] neg_lo:[0,1] neg_hi:[0,1]
    v_pk_add_f32 v[48:49], v[48:49], v[224:225]
    v_pk_fma_f32 v[50:51], v[224:225], v[224:225], v[50:51]
    v_pk_fma_f32 v[52:53], v[224:225], v[176:177], v[52:53]
    v_pk_add_f32 v[48:49], v[48:49], v[226:227]
    v_pk_fma_f32 v[50:51], v[226:227], v[226:227], v[50:51]
    v_pk_fma_f32 v[52:53], v[226:227], v[178:179], v[52:53]
    v_pk_add_f32 v[48:49], v[48:49], v[228:229]
    v_pk_fma_f32 v[50:51], v[228:229], v[228:229], v[50:51]
    v_pk_fma_f32 v[52:53], v[228:229], v[180:181], v[52:53]
    v_pk_add_f32 v[48:49], v[48:49], v[230:231]
    v_pk_fma_f32 v[50:51], v[230:231], v[230:231], v[50:51]
    v_pk_fma_f32 v[52:53], v[230:231], v[182:183], v[52:53]
    v_add_f32 v48, v48, v49
    v_add_f32 v50, v50, v51
    v_add_f32 v52, v52, v53
    v_add_f32_dpp v48, v48, v48 row_ror:8 row_mask:0xf bank_mask:0xf
Ltour12:
    s_cbranch_execz Ltour16
    v_add_f32_dpp v50, v50, v50 row_ror:8 row_mask:0xf bank_mask:0xf
    v_add_f32_dpp v52, v52, v52 row_ror:8 row_mask:0xf bank_mask:0xf
    v_add_f32_dpp v48, v48, v48 row_ror:4 row_mask:0xf bank_mask:0xf
    v_add_f32_dpp v50, v50, v50 row_ror:4 row_mask:0xf bank_mask:0xf
    v_add_f32_dpp v52, v52, v52 row_ror:4 row_mask:0xf bank_mask:0xf
    v_add_f32_dpp v48, v48, v48 row_ror:2 row_mask:0xf bank_mask:0xf
    v_add_f32_dpp v50, v50, v50 row_ror:2 row_mask:0xf bank_mask:0xf
    v_add_f32_dpp v52, v52, v52 row_ror:2 row_mask:0xf bank_mask:0xf
    v_add_f32_dpp v48, v48, v48 row_ror:1 row_mask:0xf bank_mask:0xf
    v_add_f32_dpp v50, v50, v50 row_ror:1 row_mask:0xf bank_mask:0xf
    v_add_f32_dpp v52, v52, v52 row_ror:1 row_mask:0xf bank_mask:0xf
    v_mov_b32 v49, v48
    v_mov_b32 v51, v50
    v_mov_b32 v53, v52
    v_permlane16_swap_b32 v48, v49
    v_permlane16_swap_b32 v50, v51
    v_permlane16_swap_b32 v52, v53
    v_add_f32 v48, v48, v49
    v_add_f32 v50, v50, v51
    v_add_f32 v52, v52, v53
    v_mul_f32 v48, 0x3ae38e39, v48
    v_mul_f32 v50, 0x3ae38e39, v50
    v_fma_f32 v50, -v48, v48, v50
    v_add_f32 v48, v48, v88
    v_max_f32 v50, 0, v50
    v_cvt_pk_bf16_f32 v48, v48, v50
    v_and_b32 v50, 0xffff0000, v48
    v_lshlrev_b32 v48, 16, v48
    v_add_f32 v50, 0x3727c5ac, v50
    v_sub_f32 v48, v88, v48
    v_cvt_pk_bf16_f32 v50, v50, v50
    v_and_b32 v50, 0xffff0000, v50
    v_sqrt_f32 v50, v50
    v_fmac_f32 v52, v48, v90
    v_cvt_pk_bf16_f32 v50, v50, v50
    v_and_b32 v50, 0xffff0000, v50
    v_rcp_f32 v50, v50
    s_mov_b32 exec_lo, 1
    s_mov_b32 exec_hi, 1
    v_fma_f32 v52, v52, v50, v91
    v_ashrrev_i32 v62, 31, v52
    v_or_b32 v62, 0x80000000, v62
    v_xor_b32 v52, v62, v52
    v_min_u32 v52, 0xfffff000, v52
    v_bfi_b32 v52, s48, v93, v52
    ds_write_b32 v92, v52 offset:36864
    s_mov_b64 exec, -1
    v_mul_f32 v48, v48, v50
    s_waitcnt lgkmcnt(0)
    s_barrier
    v_mov_b32 v109, 36864
    ds_read_b128 v[96:99], v109
    ds_read_b128 v[100:103], v109 offset:16
    s_lshl_b32 s45, s2, 7
    s_add_u32 s45, s45, 9306112
    s_cmp_eq_u32 s3, 0
    s_cselect_b32 s45, s45, 2147483648
    s_waitcnt lgkmcnt(1)
    v_max_u32 v104, v96, v97
    v_min_u32 v105, v96, v97
    v_med3_u32 v105, v104, v105, v98
    v_max_u32 v104, v104, v98
    v_med3_u32 v105, v104, v105, v99
    v_max_u32 v104, v104, v99
    s_waitcnt lgkmcnt(0)
    v_med3_u32 v105, v104, v105, v100
    v_max_u32 v104, v104, v100
    v_med3_u32 v105, v104, v105, v101
    v_max_u32 v104, v104, v101
    v_med3_u32 v105, v104, v105, v102
    v_max_u32 v104, v104, v102
    v_med3_u32 v105, v104, v105, v103
    v_max_u32 v104, v104, v103
    buffer_store_dwordx2 v[104:105], v8, s[24:27], s45 offen sc1
    v_pk_fma_f32 v[216:217], v[216:217], v[50:51], v[48:49] op_sel_hi:[1,0,0]
    v_pk_fma_f32 v[218:219], v[218:219], v[50:51], v[48:49] op_sel_hi:[1,0,0]
    v_pk_fma_f32 v[220:221], v[220:221], v[50:51], v[48:49] op_sel_hi:[1,0,0]
    v_pk_fma_f32 v[222:223], v[222:223], v[50:51], v[48:49] op_sel_hi:[1,0,0]
    v_pk_fma_f32 v[224:225], v[224:225], v[50:51], v[48:49] op_sel_hi:[1,0,0]
    v_pk_fma_f32 v[226:227], v[226:227], v[50:51], v[48:49] op_sel_hi:[1,0,0]
    v_pk_fma_f32 v[228:229], v[228:229], v[50:51], v[48:49] op_sel_hi:[1,0,0]
    v_pk_fma_f32 v[230:231], v[230:231], v[50:51], v[48:49] op_sel_hi:[1,0,0]
    v_pk_fma_f32 v[232:233], v[232:233], v[50:51], v[48:49] op_sel_hi:[1,0,0]
    v_pk_fma_f32 v[234:235], v[234:235], v[50:51], v[48:49] op_sel_hi:[1,0,0]
    v_pk_fma_f32 v[236:237], v[236:237], v[50:51], v[48:49] op_sel_hi:[1,0,0]
    v_pk_fma_f32 v[238:239], v[238:239], v[50:51], v[48:49] op_sel_hi:[1,0,0]
    v_pk_fma_f32 v[216:217], v[216:217], v[120:121], v[144:145]
    v_pk_fma_f32 v[218:219], v[218:219], v[122:123], v[146:147]
    v_pk_fma_f32 v[220:221], v[220:221], v[124:125], v[148:149]
    v_pk_fma_f32 v[222:223], v[222:223], v[126:127], v[150:151]
    v_pk_fma_f32 v[224:225], v[224:225], v[128:129], v[152:153]
    v_pk_fma_f32 v[226:227], v[226:227], v[130:131], v[154:155]
    v_pk_fma_f32 v[228:229], v[228:229], v[132:133], v[156:157]
    v_pk_fma_f32 v[230:231], v[230:231], v[134:135], v[158:159]
    v_pk_fma_f32 v[232:233], v[232:233], v[136:137], v[160:161]
    v_pk_fma_f32 v[234:235], v[234:235], v[138:139], v[162:163]
    v_pk_fma_f32 v[236:237], v[236:237], v[140:141], v[164:165]
    v_pk_fma_f32 v[238:239], v[238:239], v[142:143], v[166:167]
    v_cvt_pk_bf16_f32 v64, v216, v217
    v_cvt_pk_bf16_f32 v65, v218, v219
    v_cvt_pk_bf16_f32 v66, v220, v221
    v_cvt_pk_bf16_f32 v67, v222, v223
    v_cvt_pk_bf16_f32 v68, v224, v225
    v_cvt_pk_bf16_f32 v69, v226, v227
    v_cvt_pk_bf16_f32 v70, v228, v229
    v_cvt_pk_bf16_f32 v71, v230, v231
    v_cvt_pk_bf16_f32 v72, v232, v233
    v_cvt_pk_bf16_f32 v73, v234, v235
    v_cvt_pk_bf16_f32 v74, v236, v237
    v_cvt_pk_bf16_f32 v75, v238, v239
    v_and_b32 v106, 0x7ff, v104
    v_and_b32 v107, 0x7ff, v105
    v_cmp_eq_u32 vcc, v106, v93
    v_cmp_eq_u32 s[36:37], v107, v93
    v_mov_b32 v106, 2147483648
    s_or_b64 vcc, vcc, s[36:37]
    s_mov_b32 s45, 2621440
    s_nop 0
    v_cndmask_b32 v6, v106, v6, vcc
    v_cndmask_b32 v60, v106, v60, vcc
    buffer_store_dwordx4 v[64:67], v6, s[24:27], s45 offen offset:0 sc1
    buffer_store_dwordx4 v[68:71], v6, s[24:27], s45 offen offset:512 sc1
    buffer_store_dwordx4 v[72:75], v60, s[24:27], s45 offen offset:1024 sc1
    s_cmp_ge_u32 s41, 18
    s_cbranch_scc1 Ltail_idle
    s_mov_b32 s36, 2622592
    buffer_store_dwordx4 v[36:39], v6, s[24:27], s36 offen offset:0 sc1
    buffer_store_dwordx4 v[40:43], v6, s[24:27], s36 offen offset:512 sc1
    buffer_store_dwordx4 v[44:47], v60, s[24:27], s36 offen offset:1024 sc1
    s_add_u32 s57, s59, 4096
    s_add_u32 m0, s6, -110592
    s_nop 0
    buffer_load_dwordx4 v255, s[84:87], s57 offen lds
    s_add_u32 s57, s59, 8192
    s_add_u32 m0, s6, -106496
    s_nop 0
    buffer_load_dwordx4 v255, s[84:87], s57 offen lds
    s_add_u32 s57, s59, 12288
    s_add_u32 m0, s6, -102400
    s_nop 0
    buffer_load_dwordx4 v255, s[84:87], s57 offen lds
    s_add_u32 s57, s59, 16384
    s_add_u32 m0, s6, -98304
    s_nop 0
    buffer_load_dwordx4 v255, s[84:87], s57 offen lds
    s_add_u32 s57, s59, 20480
    s_add_u32 m0, s6, -94208
    s_nop 0
    buffer_load_dwordx4 v255, s[84:87], s57 offen lds
    s_add_u32 s57, s59, 24576
    s_add_u32 m0, s6, -90112
    s_nop 0
    buffer_load_dwordx4 v255, s[84:87], s57 offen lds
    s_add_u32 s57, s59, 28672
    s_add_u32 m0, s6, -86016
    s_nop 0
    buffer_load_dwordx4 v255, s[84:87], s57 offen lds
    s_add_u32 s57, s59, 32768
    s_add_u32 m0, s6, -81920
    s_nop 0
    buffer_load_dwordx4 v255, s[84:87], s57 offen lds
    v_lshlrev_b32 v216, 16, v64
    v_and_b32 v217, 0xffff0000, v64
    v_lshlrev_b32 v218, 16, v65
    v_and_b32 v219, 0xffff0000, v65
    v_lshlrev_b32 v220, 16, v66
    v_and_b32 v221, 0xffff0000, v66
    v_lshlrev_b32 v222, 16, v67
    v_and_b32 v223, 0xffff0000, v67
    v_lshlrev_b32 v224, 16, v68
    v_and_b32 v225, 0xffff0000, v68
    v_lshlrev_b32 v226, 16, v69
    v_and_b32 v227, 0xffff0000, v69
    v_lshlrev_b32 v228, 16, v70
    v_and_b32 v229, 0xffff0000, v70
    v_lshlrev_b32 v230, 16, v71
    v_and_b32 v231, 0xffff0000, v71
    v_lshlrev_b32 v232, 16, v72
    v_and_b32 v233, 0xffff0000, v72
    v_lshlrev_b32 v234, 16, v73
    v_and_b32 v235, 0xffff0000, v73
    v_lshlrev_b32 v236, 16, v74
    v_and_b32 v237, 0xffff0000, v74
    v_lshlrev_b32 v238, 16, v75
    v_and_b32 v239, 0xffff0000, v75
    v_pk_mul_f32 v[192:193], v[192:193], v[216:217]
    v_pk_mul_f32 v[194:195], v[194:195], v[218:219]
    v_pk_mul_f32 v[196:197], v[196:197], v[220:221]
    v_pk_mul_f32 v[198:199], v[198:199], v[222:223]
    v_pk_mul_f32 v[200:201], v[200:201], v[224:225]
    v_pk_mul_f32 v[202:203], v[202:203], v[226:227]
    v_pk_mul_f32 v[204:205], v[204:205], v[228:229]
    v_pk_mul_f32 v[206:207], v[206:207], v[230:231]
    v_pk_mul_f32 v[208:209], v[208:209], v[232:233]
    v_pk_mul_f32 v[210:211], v[210:211], v[234:235]
    v_pk_mul_f32 v[212:213], v[212:213], v[236:237]
    v_pk_mul_f32 v[214:215], v[214:215], v[238:239]
    v_cvt_pk_bf16_f32 v144, v192, v193
    v_cvt_pk_bf16_f32 v145, v194, v195
    v_cvt_pk_bf16_f32 v146, v196, v197
    v_cvt_pk_bf16_f32 v147, v198, v199
    v_cvt_pk_bf16_f32 v148, v200, v201
    v_cvt_pk_bf16_f32 v149, v202, v203
    v_cvt_pk_bf16_f32 v150, v204, v205
    v_cvt_pk_bf16_f32 v151, v206, v207
    v_cvt_pk_bf16_f32 v152, v208, v209
    v_cvt_pk_bf16_f32 v153, v210, v211
    v_cvt_pk_bf16_f32 v154, v212, v213
    v_cvt_pk_bf16_f32 v155, v214, v215
    v_lshlrev_b32 v192, 16, v144
    v_and_b32 v193, 0xffff0000, v144
    v_lshlrev_b32 v194, 16, v145
    v_and_b32 v195, 0xffff0000, v145
    v_lshlrev_b32 v196, 16, v146
    v_and_b32 v197, 0xffff0000, v146
    v_lshlrev_b32 v198, 16, v147
    v_and_b32 v199, 0xffff0000, v147
    v_lshlrev_b32 v200, 16, v148
    v_and_b32 v201, 0xffff0000, v148
    v_lshlrev_b32 v202, 16, v149
    v_and_b32 v203, 0xffff0000, v149
    v_lshlrev_b32 v204, 16, v150
    v_and_b32 v205, 0xffff0000, v150
    v_lshlrev_b32 v206, 16, v151
    v_and_b32 v207, 0xffff0000, v151
    v_lshlrev_b32 v208, 16, v152
    v_and_b32 v209, 0xffff0000, v152
    v_lshlrev_b32 v210, 16, v153
    v_and_b32 v211, 0xffff0000, v153
    v_lshlrev_b32 v212, 16, v154
    v_and_b32 v213, 0xffff0000, v154
    v_lshlrev_b32 v214, 16, v155
    v_and_b32 v215, 0xffff0000, v155
    v_pk_add_f32 v[192:193], v[192:193], v[12:13]
    v_pk_add_f32 v[194:195], v[194:195], v[14:15]
    v_pk_add_f32 v[196:197], v[196:197], v[16:17]
    v_pk_add_f32 v[198:199], v[198:199], v[18:19]
    v_pk_add_f32 v[200:201], v[200:201], v[20:21]
    v_pk_add_f32 v[202:203], v[202:203], v[22:23]
    v_pk_add_f32 v[204:205], v[204:205], v[24:25]
    v_pk_add_f32 v[206:207], v[206:207], v[26:27]
    v_pk_add_f32 v[208:209], v[208:209], v[28:29]
    v_pk_add_f32 v[210:211], v[210:211], v[30:31]
    v_pk_add_f32 v[212:213], v[212:213], v[32:33]
    v_pk_add_f32 v[214:215], v[214:215], v[34:35]
    v_cvt_pk_bf16_f32 v156, v192, v193
    v_cvt_pk_bf16_f32 v157, v194, v195
    v_cvt_pk_bf16_f32 v158, v196, v197
    v_cvt_pk_bf16_f32 v159, v198, v199
    v_cvt_pk_bf16_f32 v160, v200, v201
    v_cvt_pk_bf16_f32 v161, v202, v203
    v_cvt_pk_bf16_f32 v162, v204, v205
    v_cvt_pk_bf16_f32 v163, v206, v207
    v_cvt_pk_bf16_f32 v164, v208, v209
    v_cvt_pk_bf16_f32 v165, v210, v211
    v_cvt_pk_bf16_f32 v166, v212, v213
    v_cvt_pk_bf16_f32 v167, v214, v215
    v_and_b32 v30, 2, v1
    v_cmp_ne_u32 vcc, 0, v30
    v_mul_u32_u24 v30, 1152, v7
    v_add_u32 v4, v30, v5
    v_add_u32 v58, v30, v59
    v_mov_b32_dpp v192, v158 quad_perm:[0,2,0,2] row_mask:0xf bank_mask:0xf
    v_mov_b32_dpp v193, v159 quad_perm:[0,2,0,2] row_mask:0xf bank_mask:0xf
    v_mov_b32_dpp v194, v158 quad_perm:[1,3,1,3] row_mask:0xf bank_mask:0xf
    v_mov_b32_dpp v195, v159 quad_perm:[1,3,1,3] row_mask:0xf bank_mask:0xf
    v_mov_b32_dpp v196, v162 quad_perm:[0,2,0,2] row_mask:0xf bank_mask:0xf
    v_mov_b32_dpp v197, v163 quad_perm:[0,2,0,2] row_mask:0xf bank_mask:0xf
    v_mov_b32_dpp v198, v162 quad_perm:[1,3,1,3] row_mask:0xf bank_mask:0xf
    v_mov_b32_dpp v199, v163 quad_perm:[1,3,1,3] row_mask:0xf bank_mask:0xf
    v_mov_b32_dpp v200, v166 quad_perm:[0,2,0,2] row_mask:0xf bank_mask:0xf
    v_mov_b32_dpp v201, v167 quad_perm:[0,2,0,2] row_mask:0xf bank_mask:0xf
    v_mov_b32_dpp v202, v166 quad_perm:[1,3,1,3] row_mask:0xf bank_mask:0xf
    v_mov_b32_dpp v203, v167 quad_perm:[1,3,1,3] row_mask:0xf bank_mask:0xf
    v_cndmask_b32_dpp v144, v156, v192, vcc quad_perm:[0,2,0,2] row_mask:0xf bank_mask:0xf
    v_cndmask_b32_dpp v145, v157, v193, vcc quad_perm:[0,2,0,2] row_mask:0xf bank_mask:0xf
    v_cndmask_b32_dpp v146, v156, v194, vcc quad_perm:[1,3,1,3] row_mask:0xf bank_mask:0xf
    v_cndmask_b32_dpp v147, v157, v195, vcc quad_perm:[1,3,1,3] row_mask:0xf bank_mask:0xf
    v_cndmask_b32_dpp v148, v160, v196, vcc quad_perm:[0,2,0,2] row_mask:0xf bank_mask:0xf
    v_cndmask_b32_dpp v149, v161, v197, vcc quad_perm:[0,2,0,2] row_mask:0xf bank_mask:0xf
    v_cndmask_b32_dpp v150, v160, v198, vcc quad_perm:[1,3,1,3] row_mask:0xf bank_mask:0xf
    v_cndmask_b32_dpp v151, v161, v199, vcc quad_perm:[1,3,1,3] row_mask:0xf bank_mask:0xf
    v_cndmask_b32_dpp v152, v164, v200, vcc quad_perm:[0,2,0,2] row_mask:0xf bank_mask:0xf
    v_cndmask_b32_dpp v153, v165, v201, vcc quad_perm:[0,2,0,2] row_mask:0xf bank_mask:0xf
    v_cndmask_b32_dpp v154, v164, v202, vcc quad_perm:[1,3,1,3] row_mask:0xf bank_mask:0xf
    v_cndmask_b32_dpp v155, v165, v203, vcc quad_perm:[1,3,1,3] row_mask:0xf bank_mask:0xf
    s_mov_b32 s38, 135168
    s_mov_b32 s39, 12288
    v_lshrrev_b32 v9, 2, v1
    v_and_b32 v10, 3, v1
    v_lshlrev_b32 v10, 3, v10
    s_and_b32 s45, s3, 1
    s_lshl_b32 s45, s45, 5
    v_lshl_add_u32 v11, v9, 6, v10
    v_add_u32 v11, s45, v11
    s_cmp_lt_u32 s3, 2
    s_cselect_b32 s44, 98304, s38
    s_cselect_b32 s45, 98304, s39
    v_add_u32 v12, s45, v11
    v_add_u32 v11, s44, v11
    ds_read_b64_tr_b16 a[0:1], v11 offset:0
    ds_read_b64_tr_b16 a[2:3], v11 offset:1024
    ds_read_b64_tr_b16 a[4:5], v11 offset:2048
    ds_read_b64_tr_b16 a[6:7], v11 offset:3072
    ds_read_b64_tr_b16 a[8:9], v11 offset:4096
    ds_read_b64_tr_b16 a[10:11], v11 offset:5120
    ds_read_b64_tr_b16 a[12:13], v11 offset:6144
    ds_read_b64_tr_b16 a[14:15], v11 offset:7168
    ds_read_b64_tr_b16 a[16:17], v11 offset:8192
    ds_read_b64_tr_b16 a[18:19], v11 offset:9216
    ds_read_b64_tr_b16 a[20:21], v11 offset:10240
    ds_read_b64_tr_b16 a[22:23], v11 offset:11264
    ds_read_b64_tr_b16 a[24:25], v11 offset:12288
    ds_read_b64_tr_b16 a[26:27], v11 offset:13312
    ds_read_b64_tr_b16 a[28:29], v11 offset:14336
    ds_read_b64_tr_b16 a[30:31], v11 offset:15360
    ds_read_b64_tr_b16 a[32:33], v11 offset:16384
    ds_read_b64_tr_b16 a[34:35], v11 offset:17408
    ds_read_b64_tr_b16 a[36:37], v11 offset:18432
    ds_read_b64_tr_b16 a[38:39], v11 offset:19456
    ds_read_b64_tr_b16 a[40:41], v11 offset:20480
    ds_read_b64_tr_b16 a[42:43], v11 offset:21504
    ds_read_b64_tr_b16 a[44:45], v11 offset:22528
    ds_read_b64_tr_b16 a[46:47], v11 offset:23552
    ds_read_b64_tr_b16 a[48:49], v11 offset:24576
    ds_read_b64_tr_b16 a[50:51], v11 offset:25600
    ds_read_b64_tr_b16 a[52:53], v11 offset:26624
    ds_read_b64_tr_b16 a[54:55], v11 offset:27648
    ds_read_b64_tr_b16 a[56:57], v12 offset:28672
    ds_read_b64_tr_b16 a[58:59], v12 offset:29696
    ds_read_b64_tr_b16 a[60:61], v12 offset:30720
    ds_read_b64_tr_b16 a[62:63], v12 offset:31744
    ds_read_b64_tr_b16 a[64:65], v12 offset:32768
    ds_read_b64_tr_b16 a[66:67], v12 offset:33792
    ds_read_b64_tr_b16 a[68:69], v12 offset:34816
    ds_read_b64_tr_b16 a[70:71], v12 offset:35840
    v_mul_u32_u24 v12, 1152, v9
    s_lshl_b32 s44, s3, 7
    s_add_u32 s44, s44, 49152
    v_add3_u32 v12, v12, v10, s44
    v_lshlrev_b32 v13, 4, v1
    v_add_u32 v13, 32768, v13
    s_lshl_b32 s44, s3, 10
    v_add_u32 v14, s44, v13
    v_and_b32 v13, 0xffffff1f, v13
    v_bfe_u32 v15, v1, 2, 2
    v_cmp_eq_u32 s[52:53], 0, v15
    v_cmp_eq_u32 s[54:55], 1, v15
    v_cmp_eq_u32 s[56:57], 2, v15
    v_cmp_eq_u32 s[58:59], 3, v15
    s_mul_i32 s43, s42, 18
    s_add_u32 s43, s43, s41
    s_lshl_b32 s43, s43, 9
    s_mul_i32 s44, s3, 73728
    s_add_u32 s43, s43, s44
    v_lshlrev_b32 v15, 3, v1
    v_and_b32 v10, 1, v1
    v_and_b32 v9, 48, v1
    v_lshlrev_b32 v108, 7, v0
    s_mov_b32 s45, 9306112
    s_lshl_b32 s36, s3, 3
    v_mov_b32 v109, s36
    s_mov_b32 s48, 16384
Ltail_pollk:
    buffer_load_dwordx2 v[104:105], v108, s[24:27], s45 offen sc1
    s_sub_u32 s48, s48, 1
    s_cbranch_scc1 Ltail_gotk
    s_waitcnt vmcnt(0)
    v_max_u32 v106, v104, v105
    v_cmp_eq_u32 vcc, -1, v106
    s_cbranch_vccnz Ltail_pollk
Ltail_gotk:
    s_waitcnt vmcnt(0)
    v_mov_b32_dpp v106, v104 row_ror:1 row_mask:0xf bank_mask:0xf
    v_mov_b32_dpp v107, v105 row_ror:1 row_mask:0xf bank_mask:0xf
    v_min_u32 v110, v104, v106
    v_max_u32 v104, v104, v106
    v_max3_u32 v105, v110, v105, v107
    s_nop 0
    v_mov_b32_dpp v106, v104 row_ror:2 row_mask:0xf bank_mask:0xf
    v_mov_b32_dpp v107, v105 row_ror:2 row_mask:0xf bank_mask:0xf
    v_min_u32 v110, v104, v106
    v_max_u32 v104, v104, v106
    v_max3_u32 v105, v110, v105, v107
    s_nop 0
    v_mov_b32_dpp v106, v104 row_ror:4 row_mask:0xf bank_mask:0xf
    v_mov_b32_dpp v107, v105 row_ror:4 row_mask:0xf bank_mask:0xf
    v_min_u32 v110, v104, v106
    v_max_u32 v104, v104, v106
    v_max3_u32 v105, v110, v105, v107
    s_nop 0
    v_mov_b32_dpp v106, v104 row_ror:8 row_mask:0xf bank_mask:0xf
    v_mov_b32_dpp v107, v105 row_ror:8 row_mask:0xf bank_mask:0xf
    v_min_u32 v110, v104, v106
    v_max_u32 v104, v104, v106
    v_max3_u32 v105, v110, v105, v107
    v_mov_b32 v106, v104
    v_mov_b32 v107, v105
    s_nop 0
    v_permlane16_swap_b32 v104, v106
    v_permlane16_swap_b32 v105, v107
    v_min_u32 v110, v104, v106
    v_max_u32 v104, v104, v106
    v_max3_u32 v105, v110, v105, v107
    v_mov_b32 v106, v104
    v_mov_b32 v107, v105
    s_nop 0
    v_permlane32_swap_b32 v104, v106
    v_permlane32_swap_b32 v105, v107
    v_min_u32 v110, v104, v106
    v_max_u32 v104, v104, v106
    v_max3_u32 v105, v110, v105, v107
    ds_write_b64 v109, v[104:105] offset:36928
    v_mov_b32 v109, 36928
    s_waitcnt lgkmcnt(0)
    s_barrier
    ds_read_b128 v[96:99], v109
    ds_read_b128 v[100:103], v109 offset:16
    s_waitcnt lgkmcnt(1)
    v_max_u32 v104, v96, v97
    v_min_u32 v105, v96, v97
    v_med3_u32 v105, v104, v105, v98
    v_max_u32 v104, v104, v98
    v_med3_u32 v105, v104, v105, v99
    v_max_u32 v104, v104, v99
    s_waitcnt lgkmcnt(0)
    v_med3_u32 v105, v104, v105, v100
    v_max_u32 v104, v104, v100
    v_med3_u32 v105, v104, v105, v101
    v_max_u32 v104, v104, v101
    v_med3_u32 v105, v104, v105, v102
    v_max_u32 v104, v104, v102
    v_med3_u32 v105, v104, v105, v103
    v_max_u32 v104, v104, v103
    s_nop 0
    v_readfirstlane_b32 s92, v104
    v_readfirstlane_b32 s93, v105
    s_andn2_b32 s46, 0x7ff, s92
    s_andn2_b32 s47, 0x7ff, s93
    s_mul_i32 s44, s46, 2304
    s_mul_i32 s45, s47, 2304
    s_sub_u32 s45, s45, s44
    v_mad_i32_i24 v10, v10, s45, v9
    v_add_u32 v10, s44, v10
    s_mov_b32 s45, 2621440
    s_mov_b32 s48, 16384
Ltail_pollh:
    s_mov_b32 exec_lo, 0x30003
    s_mov_b32 exec_hi, 0x30003
    buffer_load_dwordx4 a[120:123], v10, s[24:27], s45 offen offset:0 sc1
    buffer_load_dwordx4 a[124:127], v10, s[24:27], s45 offen offset:64 sc1
    buffer_load_dwordx4 a[128:131], v10, s[24:27], s45 offen offset:128 sc1
    buffer_load_dwordx4 a[132:135], v10, s[24:27], s45 offen offset:192 sc1
    buffer_load_dwordx4 a[136:139], v10, s[24:27], s45 offen offset:256 sc1
    buffer_load_dwordx4 a[140:143], v10, s[24:27], s45 offen offset:320 sc1
    buffer_load_dwordx4 a[144:147], v10, s[24:27], s45 offen offset:384 sc1
    buffer_load_dwordx4 a[148:151], v10, s[24:27], s45 offen offset:448 sc1
    buffer_load_dwordx4 a[152:155], v10, s[24:27], s45 offen offset:512 sc1
    buffer_load_dwordx4 a[156:159], v10, s[24:27], s45 offen offset:576 sc1
    buffer_load_dwordx4 a[160:163], v10, s[24:27], s45 offen offset:640 sc1
    buffer_load_dwordx4 a[164:167], v10, s[24:27], s45 offen offset:704 sc1
    buffer_load_dwordx4 a[168:171], v10, s[24:27], s45 offen offset:768 sc1
    buffer_load_dwordx4 a[172:175], v10, s[24:27], s45 offen offset:832 sc1
    buffer_load_dwordx4 a[176:179], v10, s[24:27], s45 offen offset:896 sc1
    buffer_load_dwordx4 a[180:183], v10, s[24:27], s45 offen offset:960 sc1
    buffer_load_dwordx4 a[184:187], v10, s[24:27], s45 offen offset:1024 sc1
    buffer_load_dwordx4 a[188:191], v10, s[24:27], s45 offen offset:1088 sc1
    s_mov_b64 exec, -1
    ds_read_b64_tr_b16 a[72:73], v12 offset:0
    ds_read_b64_tr_b16 a[74:75], v12 offset:18432
    ds_read_b64_tr_b16 a[76:77], v12 offset:32
    ds_read_b64_tr_b16 a[78:79], v12 offset:18464
    ds_read_b64_tr_b16 a[80:81], v12 offset:64
    ds_read_b64_tr_b16 a[82:83], v12 offset:18496
    ds_read_b64_tr_b16 a[84:85], v12 offset:96
    ds_read_b64_tr_b16 a[86:87], v12 offset:18528
    ds_read_b64_tr_b16 a[88:89], v12 offset:512
    ds_read_b64_tr_b16 a[90:91], v12 offset:18944
    ds_read_b64_tr_b16 a[92:93], v12 offset:544
    ds_read_b64_tr_b16 a[94:95], v12 offset:18976
    ds_read_b64_tr_b16 a[96:97], v12 offset:576
    ds_read_b64_tr_b16 a[98:99], v12 offset:19008
    ds_read_b64_tr_b16 a[100:101], v12 offset:608
    ds_read_b64_tr_b16 a[102:103], v12 offset:19040
    ds_read_b64_tr_b16 a[104:105], v12 offset:1024
    ds_read_b64_tr_b16 a[106:107], v12 offset:19456
    ds_read_b64_tr_b16 a[108:109], v12 offset:1056
    ds_read_b64_tr_b16 a[110:111], v12 offset:19488
    ds_read_b64_tr_b16 a[112:113], v12 offset:1088
    ds_read_b64_tr_b16 a[114:115], v12 offset:19520
    ds_read_b64_tr_b16 a[116:117], v12 offset:1120
    ds_read_b64_tr_b16 a[118:119], v12 offset:19552
    s_waitcnt vmcnt(17)
    v_mfma_f32_16x16x32_bf16 v[16:19], a[0:3], a[120:123], 0
    s_waitcnt vmcnt(16)
    v_mfma_f32_16x16x32_bf16 v[20:23], a[4:7], a[124:127], 0
    s_waitcnt vmcnt(15)
    v_mfma_f32_16x16x32_bf16 v[16:19], a[8:11], a[128:131], v[16:19]
    s_waitcnt vmcnt(14)
    v_mfma_f32_16x16x32_bf16 v[20:23], a[12:15], a[132:135], v[20:23]
    s_waitcnt vmcnt(13)
    v_mfma_f32_16x16x32_bf16 v[16:19], a[16:19], a[136:139], v[16:19]
    s_waitcnt vmcnt(12)
    v_mfma_f32_16x16x32_bf16 v[20:23], a[20:23], a[140:143], v[20:23]
    s_waitcnt vmcnt(11)
    v_mfma_f32_16x16x32_bf16 v[16:19], a[24:27], a[144:147], v[16:19]
    s_waitcnt vmcnt(10)
    v_mfma_f32_16x16x32_bf16 v[20:23], a[28:31], a[148:151], v[20:23]
    s_waitcnt vmcnt(9)
    v_mfma_f32_16x16x32_bf16 v[16:19], a[32:35], a[152:155], v[16:19]
    s_waitcnt vmcnt(8)
    v_mfma_f32_16x16x32_bf16 v[20:23], a[36:39], a[156:159], v[20:23]
    s_waitcnt vmcnt(7)
    v_mfma_f32_16x16x32_bf16 v[16:19], a[40:43], a[160:163], v[16:19]
    s_waitcnt vmcnt(6)
    v_mfma_f32_16x16x32_bf16 v[20:23], a[44:47], a[164:167], v[20:23]
    s_waitcnt vmcnt(5)
    v_mfma_f32_16x16x32_bf16 v[16:19], a[48:51], a[168:171], v[16:19]
    s_waitcnt vmcnt(4)
    v_mfma_f32_16x16x32_bf16 v[20:23], a[52:55], a[172:175], v[20:23]
    s_waitcnt vmcnt(3)
    v_mfma_f32_16x16x32_bf16 v[16:19], a[56:59], a[176:179], v[16:19]
    s_waitcnt vmcnt(2)
    v_mfma_f32_16x16x32_bf16 v[20:23], a[60:63], a[180:183], v[20:23]
    s_waitcnt vmcnt(1)
    v_mfma_f32_16x16x32_bf16 v[16:19], a[64:67], a[184:187], v[16:19]
    s_waitcnt vmcnt(0)
    v_mfma_f32_16x16x32_bf16 v[20:23], a[68:71], a[188:191], v[20:23]
    s_sub_u32 s48, s48, 1
    s_nop 6
    v_pk_add_f32 v[16:17], v[16:17], v[20:21]
    v_pk_add_f32 v[18:19], v[18:19], v[22:23]
    s_cbranch_scc1 Ltail_goth
    v_cmp_u_f32 vcc, v16, v16
    s_and_b32 s36, vcc_lo, 3
    s_cbranch_scc1 Ltail_pollh
Ltail_goth:
    ds_write_b128 v14, v[16:19]
    s_waitcnt lgkmcnt(0)
    s_barrier
    ds_read_b128 v[16:19], v13 offset:0
    ds_read_b128 v[20:23], v13 offset:1024
    ds_read_b128 v[24:27], v13 offset:2048
    ds_read_b128 v[28:31], v13 offset:3072
    s_mov_b32 s36, 0xbfb8aa3b
    s_mov_b32 s37, 0xbfb8aa3b
    s_waitcnt lgkmcnt(3)
    v_cvt_pk_bf16_f32 v32, v16, v17
    v_cvt_pk_bf16_f32 v33, v18, v19
    s_waitcnt lgkmcnt(2)
    v_cvt_pk_bf16_f32 v34, v20, v21
    v_cvt_pk_bf16_f32 v35, v22, v23
    v_lshlrev_b32 v16, 16, v32
    v_and_b32 v17, 0xffff0000, v32
    v_lshlrev_b32 v18, 16, v33
    v_and_b32 v19, 0xffff0000, v33
    v_lshlrev_b32 v20, 16, v34
    v_and_b32 v21, 0xffff0000, v34
    v_lshlrev_b32 v22, 16, v35
    v_and_b32 v23, 0xffff0000, v35
    v_pk_mul_f32 v[32:33], v[16:17], s[36:37]
    v_pk_mul_f32 v[34:35], v[18:19], s[36:37]
    v_pk_mul_f32 v[36:37], v[20:21], s[36:37]
    v_pk_mul_f32 v[38:39], v[22:23], s[36:37]
    v_exp_f32 v32, v32
    v_exp_f32 v33, v33
    v_exp_f32 v34, v34
    v_exp_f32 v35, v35
    v_exp_f32 v36, v36
    v_exp_f32 v37, v37
    v_exp_f32 v38, v38
    v_exp_f32 v39, v39
    s_waitcnt lgkmcnt(1)
    v_cvt_pk_bf16_f32 v60, v24, v25
    v_cvt_pk_bf16_f32 v61, v26, v27
    s_waitcnt lgkmcnt(0)
    v_cvt_pk_bf16_f32 v62, v28, v29
    v_cvt_pk_bf16_f32 v63, v30, v31
    v_pk_add_f32 v[32:33], v[32:33], 1.0 op_sel_hi:[1,0]
    v_pk_add_f32 v[34:35], v[34:35], 1.0 op_sel_hi:[1,0]
    v_pk_add_f32 v[36:37], v[36:37], 1.0 op_sel_hi:[1,0]
    v_pk_add_f32 v[38:39], v[38:39], 1.0 op_sel_hi:[1,0]
    v_rcp_f32 v32, v32
    v_rcp_f32 v33, v33
    v_rcp_f32 v34, v34
    v_rcp_f32 v35, v35
    v_rcp_f32 v36, v36
    v_rcp_f32 v37, v37
    v_rcp_f32 v38, v38
    v_rcp_f32 v39, v39
    v_lshlrev_b32 v24, 16, v60
    v_and_b32 v25, 0xffff0000, v60
    v_lshlrev_b32 v26, 16, v61
    v_and_b32 v27, 0xffff0000, v61
    v_lshlrev_b32 v28, 16, v62
    v_and_b32 v29, 0xffff0000, v62
    v_lshlrev_b32 v30, 16, v63
    v_and_b32 v31, 0xffff0000, v63
    v_pk_mul_f32 v[16:17], v[16:17], v[32:33]
    v_pk_mul_f32 v[18:19], v[18:19], v[34:35]
    v_pk_mul_f32 v[20:21], v[20:21], v[36:37]
    v_pk_mul_f32 v[22:23], v[22:23], v[38:39]
    v_cvt_pk_bf16_f32 v32, v16, v17
    v_cvt_pk_bf16_f32 v33, v18, v19
    v_cvt_pk_bf16_f32 v34, v20, v21
    v_cvt_pk_bf16_f32 v35, v22, v23
    v_lshlrev_b32 v16, 16, v32
    v_and_b32 v17, 0xffff0000, v32
    v_lshlrev_b32 v18, 16, v33
    v_and_b32 v19, 0xffff0000, v33
    v_lshlrev_b32 v20, 16, v34
    v_and_b32 v21, 0xffff0000, v34
    v_lshlrev_b32 v22, 16, v35
    v_and_b32 v23, 0xffff0000, v35
    v_pk_mul_f32 v[16:17], v[16:17], v[24:25]
    v_pk_mul_f32 v[18:19], v[18:19], v[26:27]
    v_pk_mul_f32 v[20:21], v[20:21], v[28:29]
    v_pk_mul_f32 v[22:23], v[22:23], v[30:31]
    v_cvt_pk_bf16_f32 v32, v16, v17
    v_cvt_pk_bf16_f32 v33, v18, v19
    v_cvt_pk_bf16_f32 v34, v20, v21
Ltour13:
    s_cbranch_execz Ltour17
    v_cvt_pk_bf16_f32 v35, v22, v23
    v_cndmask_b32 v64, 0, v32, s[52:53]
    v_cndmask_b32 v65, 0, v33, s[52:53]
    v_cndmask_b32 v66, 0, v34, s[52:53]
    v_cndmask_b32 v67, 0, v35, s[52:53]
    v_cndmask_b32 v68, 0, v32, s[54:55]
    v_cndmask_b32 v69, 0, v33, s[54:55]
    v_cndmask_b32 v70, 0, v34, s[54:55]
    v_cndmask_b32 v71, 0, v35, s[54:55]
    v_cndmask_b32 v72, 0, v32, s[56:57]
    v_cndmask_b32 v73, 0, v33, s[56:57]
    v_cndmask_b32 v74, 0, v34, s[56:57]
    v_cndmask_b32 v75, 0, v35, s[56:57]
    v_cndmask_b32 v76, 0, v32, s[58:59]
    v_cndmask_b32 v77, 0, v33, s[58:59]
    v_cndmask_b32 v78, 0, v34, s[58:59]
    v_cndmask_b32 v79, 0, v35, s[58:59]
    v_mfma_f32_16x16x32_bf16 v[16:19], v[64:67], a[72:75], 0
    v_mfma_f32_16x16x32_bf16 v[16:19], v[68:71], a[76:79], v[16:19]
    v_mfma_f32_16x16x32_bf16 v[16:19], v[72:75], a[80:83], v[16:19]
    v_mfma_f32_16x16x32_bf16 v[16:19], v[76:79], a[84:87], v[16:19]
    v_mfma_f32_16x16x32_bf16 v[20:23], v[64:67], a[88:91], 0
    v_mfma_f32_16x16x32_bf16 v[20:23], v[68:71], a[92:95], v[20:23]
    v_mfma_f32_16x16x32_bf16 v[20:23], v[72:75], a[96:99], v[20:23]
    v_mfma_f32_16x16x32_bf16 v[20:23], v[76:79], a[100:103], v[20:23]
    v_mfma_f32_16x16x32_bf16 v[24:27], v[64:67], a[104:107], 0
    v_mfma_f32_16x16x32_bf16 v[24:27], v[68:71], a[108:111], v[24:27]
    v_mfma_f32_16x16x32_bf16 v[24:27], v[72:75], a[112:115], v[24:27]
    v_mfma_f32_16x16x32_bf16 v[24:27], v[76:79], a[116:119], v[24:27]
    v_min_u32 v16, -2, v16
    v_min_u32 v17, -2, v17
    buffer_store_dwordx2 v[16:17], v15, s[8:11], s43 offen sc1
    s_add_u32 s43, s43, 294912
    v_min_u32 v20, -2, v20
    v_min_u32 v21, -2, v21
    buffer_store_dwordx2 v[20:21], v15, s[8:11], s43 offen sc1
    s_add_u32 s43, s43, 294912
    v_min_u32 v24, -2, v24
    v_min_u32 v25, -2, v25
    buffer_store_dwordx2 v[24:25], v15, s[8:11], s43 offen sc1
    s_or_b32 s36, s2, s3
    s_cselect_b32 s37, -4, 24576
    s_add_u32 s36, s94, 1
    v_mov_b32 v106, s36
    buffer_store_dword v106, v8, s[24:27], s37 offen sc1
    v_cmp_ne_u32 vcc, s46, v7
    v_cmp_ne_u32 s[36:37], s47, v7
    v_mov_b32 v31, 2147483648
    s_and_b64 vcc, vcc, s[36:37]
    s_nop 1
    v_cndmask_b32 v30, v31, v58, vcc
    v_cndmask_b32 v31, v31, v4, vcc
    buffer_store_dwordx4 v[144:147], v31, s[16:19], 0 offen offset:0 nt
    buffer_store_dwordx4 v[148:151], v31, s[16:19], 0 offen offset:512 nt
    buffer_store_dwordx4 v[152:155], v30, s[16:19], 0 offen offset:1024 nt
    s_cmp_lt_u32 s41, 9
    s_cselect_b32 s36, s3, 0
    s_cmp_lg_u32 s36, 3
    s_cbranch_scc1 Ltail_done
    s_mul_i32 s43, s42, 9
    s_add_u32 s43, s43, s41
    v_bfe_u32 v8, v1, 2, 1
    v_cmp_eq_u32 vcc, 1, v8
    v_mov_b32 v9, s46
    v_mov_b32 v10, s47
    v_and_b32 v11, 3, v1
    v_cndmask_b32 v9, v9, v10, vcc
    s_lshr_b32 s44, s43, 2
    s_lshl_b32 s44, s44, 6
    s_and_b32 s45, s43, 1
    s_lshl_b32 s45, s45, 5
    s_add_u32 s44, s44, s45
    s_and_b32 s45, s43, 2
    s_lshl_b32 s45, s45, 2
    s_add_u32 s44, s44, s45
    v_lshrrev_b32 v12, 1, v11
    v_lshl_add_u32 v12, v12, 4, s44
    v_and_b32 v13, 1, v11
    v_lshl_add_u32 v12, v13, 2, v12
    v_mul_u32_u24 v13, 1152, v9
    v_lshl_add_u32 v14, v13, 1, v12
    v_add_u32 v15, 2621440, v14
    s_mov_b32 s45, 22144
    buffer_load_dword v18, v12, s[24:27], s45 offen sc1
    v_mov_b32 v19, s92
    v_mov_b32 v10, s93
    v_cndmask_b32 v19, v19, v10, vcc
    v_and_b32 v19, 0xfffff800, v19
    v_or_b32 v19, 0x400, v19
    v_ashrrev_i32 v10, 31, v19
    v_not_b32 v10, v10
    v_or_b32 v10, 0x80000000, v10
    v_xor_b32 v19, v19, v10
    s_lshl_b32 s45, s43, 4
    v_lshl_add_u32 v13, v11, 2, v13
    v_add_u32 v13, s45, v13
    v_lshrrev_b32 v14, 2, v1
    v_lshlrev_b32 v14, 9, v14
    v_lshl_add_u32 v14, v11, 4, v14
    s_lshr_b32 s44, s43, 3
    s_mul_i32 s44, s44, 73728
    s_and_b32 s45, s43, 7
    s_lshl_b32 s45, s45, 6
    s_add_u32 s44, s44, s45
    v_cmp_eq_u32 s[38:39], 1, v8
    v_cvt_pk_bf16_f32 v19, v19, v19
    v_and_b32 v19, 0xffff0000, v19
    v_mul_f32 v19, 0xbfb8aa3b, v19
    v_exp_f32 v19, v19
    s_waitcnt vmcnt(0)
    v_lshlrev_b32 v24, 16, v18
    v_and_b32 v25, 0xffff0000, v18
    v_add_f32 v19, 1.0, v19
    v_rcp_f32 v19, v19
    s_mov_b32 s48, 16384
    v_cvt_pk_bf16_f32 v19, v19, v19
    v_and_b32 v19, 0xffff0000, v19
Ltail_polly:
    s_add_u32 s45, s44, 0
    buffer_load_dwordx4 v[64:67], v14, s[8:11], s45 offen sc1
    s_add_u32 s45, s44, 8192
    buffer_load_dwordx4 v[68:71], v14, s[8:11], s45 offen sc1
    s_add_u32 s45, s44, 16384
    buffer_load_dwordx4 v[72:75], v14, s[8:11], s45 offen sc1
    s_add_u32 s45, s44, 24576
    buffer_load_dwordx4 v[76:79], v14, s[8:11], s45 offen sc1
    s_add_u32 s45, s44, 32768
    buffer_load_dwordx4 v[80:83], v14, s[8:11], s45 offen sc1
    s_add_u32 s45, s44, 40960
    buffer_load_dwordx4 v[84:87], v14, s[8:11], s45 offen sc1
    s_add_u32 s45, s44, 49152
    buffer_load_dwordx4 v[88:91], v14, s[8:11], s45 offen sc1
    s_add_u32 s45, s44, 57344
    buffer_load_dwordx4 v[92:95], v14, s[8:11], s45 offen sc1
    s_add_u32 s45, s44, 65536
    buffer_load_dwordx4 v[96:99], v14, s[8:11], s45 offen sc1
    s_mov_b32 s45, 1152
    buffer_load_dword v16, v15, s[24:27], s45 offen sc1
    buffer_load_dword v17, v15, s[24:27], 0 offen sc1
    s_sub_u32 s48, s48, 1
    s_cbranch_scc1 Ltail_goty
    s_waitcnt vmcnt(10)
    v_max3_u32 v26, v64, v65, v66
    s_waitcnt vmcnt(9)
    v_max3_u32 v26, v26, v67, v68
    v_max3_u32 v26, v26, v69, v70
    s_waitcnt vmcnt(8)
    v_max3_u32 v26, v26, v71, v72
    v_max3_u32 v26, v26, v73, v74
    s_waitcnt vmcnt(7)
    v_max3_u32 v26, v26, v75, v76
    v_max3_u32 v26, v26, v77, v78
    s_waitcnt vmcnt(6)
    v_max3_u32 v26, v26, v79, v80
    v_max3_u32 v26, v26, v81, v82
    s_waitcnt vmcnt(5)
    v_max3_u32 v26, v26, v83, v84
    v_max3_u32 v26, v26, v85, v86
    s_waitcnt vmcnt(4)
    v_max3_u32 v26, v26, v87, v88
    v_max3_u32 v26, v26, v89, v90
    s_waitcnt vmcnt(3)
    v_max3_u32 v26, v26, v91, v92
    v_max3_u32 v26, v26, v93, v94
    s_waitcnt vmcnt(2)
    v_max3_u32 v26, v26, v95, v96
    v_max3_u32 v26, v26, v97, v98
    v_max_u32 v26, v26, v99
    s_waitcnt vmcnt(0)
    v_max3_u32 v26, v26, v16, v17
    v_cmp_eq_u32 vcc, -1, v26
    s_cbranch_vccnz Ltail_polly
Ltail_goty:
    s_waitcnt vmcnt(0) lgkmcnt(0)
    v_lshlrev_b32 v20, 16, v16
    v_and_b32 v21, 0xffff0000, v16
    v_lshlrev_b32 v22, 16, v17
    v_and_b32 v23, 0xffff0000, v17
    v_pk_add_f32 v[64:65], v[64:65], v[68:69]
    v_pk_add_f32 v[66:67], v[66:67], v[70:71]
    v_pk_add_f32 v[64:65], v[64:65], v[72:73]
    v_pk_add_f32 v[66:67], v[66:67], v[74:75]
    v_pk_add_f32 v[64:65], v[64:65], v[76:77]
    v_pk_add_f32 v[66:67], v[66:67], v[78:79]
    v_pk_add_f32 v[64:65], v[64:65], v[80:81]
    v_pk_add_f32 v[66:67], v[66:67], v[82:83]
    v_pk_add_f32 v[64:65], v[64:65], v[84:85]
    v_pk_add_f32 v[66:67], v[66:67], v[86:87]
    v_pk_add_f32 v[64:65], v[64:65], v[88:89]
    v_pk_add_f32 v[66:67], v[66:67], v[90:91]
    v_pk_add_f32 v[64:65], v[64:65], v[92:93]
    v_pk_add_f32 v[66:67], v[66:67], v[94:95]
    v_pk_add_f32 v[64:65], v[64:65], v[96:97]
    v_pk_add_f32 v[66:67], v[66:67], v[98:99]
    s_nop 0
    v_add_f32_dpp v64, v64, v64 row_ror:4 row_mask:0xf bank_mask:0xf
    v_add_f32_dpp v65, v65, v65 row_ror:4 row_mask:0xf bank_mask:0xf
    v_add_f32_dpp v66, v66, v66 row_ror:4 row_mask:0xf bank_mask:0xf
    v_add_f32_dpp v67, v67, v67 row_ror:4 row_mask:0xf bank_mask:0xf
    v_add_f32_dpp v64, v64, v64 row_ror:8 row_mask:0xf bank_mask:0xf
    v_add_f32_dpp v65, v65, v65 row_ror:8 row_mask:0xf bank_mask:0xf
    v_add_f32_dpp v66, v66, v66 row_ror:8 row_mask:0xf bank_mask:0xf
    v_add_f32_dpp v67, v67, v67 row_ror:8 row_mask:0xf bank_mask:0xf
    v_mov_b32 v68, v64
    v_mov_b32 v69, v65
    v_mov_b32 v70, v66
    v_mov_b32 v71, v67
    v_permlane16_swap_b32 v64, v68
    v_permlane16_swap_b32 v65, v69
    v_permlane16_swap_b32 v66, v70
    v_permlane16_swap_b32 v67, v71
    v_add_f32 v64, v64, v68
    v_add_f32 v65, v65, v69
    v_add_f32 v66, v66, v70
    v_add_f32 v67, v67, v71
    v_mov_b32 v68, v64
    v_mov_b32 v69, v65
    v_mov_b32 v70, v66
    v_mov_b32 v71, v67
    v_permlane32_swap_b32 v64, v68
    v_permlane32_swap_b32 v65, v69
    v_permlane32_swap_b32 v66, v70
    v_permlane32_swap_b32 v67, v71
    v_add_f32 v64, v64, v68
    v_add_f32 v65, v65, v69
    v_add_f32 v66, v66, v70
    v_add_f32 v67, v67, v71
    v_cndmask_b32 v26, v64, v65, s[38:39]
    v_cndmask_b32 v27, v66, v67, s[38:39]
    v_cvt_pk_bf16_f32 v28, v26, v27
    v_lshlrev_b32 v26, 16, v28
    v_and_b32 v27, 0xffff0000, v28
    v_mul_f32 v26, v26, v19
    v_mul_f32 v27, v27, v19
    v_cvt_pk_bf16_f32 v28, v26, v27
    v_lshlrev_b32 v26, 16, v28
    v_and_b32 v27, 0xffff0000, v28
    v_pk_add_f32 v[26:27], v[26:27], v[22:23]
    v_cvt_pk_bf16_f32 v28, v26, v27
    v_lshlrev_b32 v26, 16, v28
    v_and_b32 v27, 0xffff0000, v28
    v_pk_mul_f32 v[26:27], v[26:27], v[24:25]
    v_cvt_pk_bf16_f32 v28, v26, v27
    v_lshlrev_b32 v26, 16, v28
    v_and_b32 v27, 0xffff0000, v28
    v_pk_add_f32 v[26:27], v[26:27], v[20:21]
    v_cvt_pk_bf16_f32 v28, v26, v27
    s_mov_b64 exec, 0xff
    buffer_store_dword v28, v13, s[16:19], 0 offen nt
    s_branch Ltail_done
Ltail_idle:
Ltour14:
    s_cbranch_execz Lmain
    v_lshlrev_b32 v216, 16, v64
    v_and_b32 v217, 0xffff0000, v64
    v_lshlrev_b32 v218, 16, v65
    v_and_b32 v219, 0xffff0000, v65
    v_lshlrev_b32 v220, 16, v66
    v_and_b32 v221, 0xffff0000, v66
    v_lshlrev_b32 v222, 16, v67
    v_and_b32 v223, 0xffff0000, v67
    v_lshlrev_b32 v224, 16, v68
    v_and_b32 v225, 0xffff0000, v68
    v_lshlrev_b32 v226, 16, v69
    v_and_b32 v227, 0xffff0000, v69
    v_lshlrev_b32 v228, 16, v70
    v_and_b32 v229, 0xffff0000, v70
    v_lshlrev_b32 v230, 16, v71
    v_and_b32 v231, 0xffff0000, v71
    v_lshlrev_b32 v232, 16, v72
    v_and_b32 v233, 0xffff0000, v72
    v_lshlrev_b32 v234, 16, v73
    v_and_b32 v235, 0xffff0000, v73
    v_lshlrev_b32 v236, 16, v74
    v_and_b32 v237, 0xffff0000, v74
    v_lshlrev_b32 v238, 16, v75
    v_and_b32 v239, 0xffff0000, v75
    v_pk_mul_f32 v[192:193], v[192:193], v[216:217]
    v_pk_mul_f32 v[194:195], v[194:195], v[218:219]
    v_pk_mul_f32 v[196:197], v[196:197], v[220:221]
    v_pk_mul_f32 v[198:199], v[198:199], v[222:223]
    v_pk_mul_f32 v[200:201], v[200:201], v[224:225]
    v_pk_mul_f32 v[202:203], v[202:203], v[226:227]
    v_pk_mul_f32 v[204:205], v[204:205], v[228:229]
    v_pk_mul_f32 v[206:207], v[206:207], v[230:231]
    v_pk_mul_f32 v[208:209], v[208:209], v[232:233]
    v_pk_mul_f32 v[210:211], v[210:211], v[234:235]
    v_pk_mul_f32 v[212:213], v[212:213], v[236:237]
    v_pk_mul_f32 v[214:215], v[214:215], v[238:239]
    v_cvt_pk_bf16_f32 v144, v192, v193
    v_cvt_pk_bf16_f32 v145, v194, v195
    v_cvt_pk_bf16_f32 v146, v196, v197
    v_cvt_pk_bf16_f32 v147, v198, v199
    v_cvt_pk_bf16_f32 v148, v200, v201
    v_cvt_pk_bf16_f32 v149, v202, v203
    v_cvt_pk_bf16_f32 v150, v204, v205
    v_cvt_pk_bf16_f32 v151, v206, v207
    v_cvt_pk_bf16_f32 v152, v208, v209
    v_cvt_pk_bf16_f32 v153, v210, v211
    v_cvt_pk_bf16_f32 v154, v212, v213
    v_cvt_pk_bf16_f32 v155, v214, v215
    v_lshlrev_b32 v192, 16, v144
    v_and_b32 v193, 0xffff0000, v144
    v_lshlrev_b32 v194, 16, v145
    v_and_b32 v195, 0xffff0000, v145
    v_lshlrev_b32 v196, 16, v146
    v_and_b32 v197, 0xffff0000, v146
    v_lshlrev_b32 v198, 16, v147
    v_and_b32 v199, 0xffff0000, v147
    v_lshlrev_b32 v200, 16, v148
    v_and_b32 v201, 0xffff0000, v148
    v_lshlrev_b32 v202, 16, v149
    v_and_b32 v203, 0xffff0000, v149
    v_lshlrev_b32 v204, 16, v150
    v_and_b32 v205, 0xffff0000, v150
    v_lshlrev_b32 v206, 16, v151
    v_and_b32 v207, 0xffff0000, v151
    v_lshlrev_b32 v208, 16, v152
    v_and_b32 v209, 0xffff0000, v152
    v_lshlrev_b32 v210, 16, v153
    v_and_b32 v211, 0xffff0000, v153
    v_lshlrev_b32 v212, 16, v154
    v_and_b32 v213, 0xffff0000, v154
    v_lshlrev_b32 v214, 16, v155
    v_and_b32 v215, 0xffff0000, v155
    v_pk_add_f32 v[192:193], v[192:193], v[12:13]
    v_pk_add_f32 v[194:195], v[194:195], v[14:15]
    v_pk_add_f32 v[196:197], v[196:197], v[16:17]
    v_pk_add_f32 v[198:199], v[198:199], v[18:19]
    v_pk_add_f32 v[200:201], v[200:201], v[20:21]
    v_pk_add_f32 v[202:203], v[202:203], v[22:23]
    v_pk_add_f32 v[204:205], v[204:205], v[24:25]
    v_pk_add_f32 v[206:207], v[206:207], v[26:27]
    v_pk_add_f32 v[208:209], v[208:209], v[28:29]
    v_pk_add_f32 v[210:211], v[210:211], v[30:31]
    v_pk_add_f32 v[212:213], v[212:213], v[32:33]
    v_pk_add_f32 v[214:215], v[214:215], v[34:35]
    v_cvt_pk_bf16_f32 v156, v192, v193
    v_cvt_pk_bf16_f32 v157, v194, v195
    v_cvt_pk_bf16_f32 v158, v196, v197
    v_cvt_pk_bf16_f32 v159, v198, v199
    v_cvt_pk_bf16_f32 v160, v200, v201
    v_cvt_pk_bf16_f32 v161, v202, v203
    v_cvt_pk_bf16_f32 v162, v204, v205
    v_cvt_pk_bf16_f32 v163, v206, v207
    v_cvt_pk_bf16_f32 v164, v208, v209
    v_cvt_pk_bf16_f32 v165, v210, v211
    v_cvt_pk_bf16_f32 v166, v212, v213
    v_cvt_pk_bf16_f32 v167, v214, v215
    v_and_b32 v30, 2, v1
    v_cmp_ne_u32 vcc, 0, v30
    v_mul_u32_u24 v30, 1152, v7
    v_add_u32 v4, v30, v5
    v_add_u32 v58, v30, v59
    v_mov_b32_dpp v192, v158 quad_perm:[0,2,0,2] row_mask:0xf bank_mask:0xf
    v_mov_b32_dpp v193, v159 quad_perm:[0,2,0,2] row_mask:0xf bank_mask:0xf
    v_mov_b32_dpp v194, v158 quad_perm:[1,3,1,3] row_mask:0xf bank_mask:0xf
    v_mov_b32_dpp v195, v159 quad_perm:[1,3,1,3] row_mask:0xf bank_mask:0xf
    v_mov_b32_dpp v196, v162 quad_perm:[0,2,0,2] row_mask:0xf bank_mask:0xf
    v_mov_b32_dpp v197, v163 quad_perm:[0,2,0,2] row_mask:0xf bank_mask:0xf
    v_mov_b32_dpp v198, v162 quad_perm:[1,3,1,3] row_mask:0xf bank_mask:0xf
    v_mov_b32_dpp v199, v163 quad_perm:[1,3,1,3] row_mask:0xf bank_mask:0xf
    v_mov_b32_dpp v200, v166 quad_perm:[0,2,0,2] row_mask:0xf bank_mask:0xf
    v_mov_b32_dpp v201, v167 quad_perm:[0,2,0,2] row_mask:0xf bank_mask:0xf
    v_mov_b32_dpp v202, v166 quad_perm:[1,3,1,3] row_mask:0xf bank_mask:0xf
    v_mov_b32_dpp v203, v167 quad_perm:[1,3,1,3] row_mask:0xf bank_mask:0xf
    v_cndmask_b32_dpp v144, v156, v192, vcc quad_perm:[0,2,0,2] row_mask:0xf bank_mask:0xf
    v_cndmask_b32_dpp v145, v157, v193, vcc quad_perm:[0,2,0,2] row_mask:0xf bank_mask:0xf
    v_cndmask_b32_dpp v146, v156, v194, vcc quad_perm:[1,3,1,3] row_mask:0xf bank_mask:0xf
    v_cndmask_b32_dpp v147, v157, v195, vcc quad_perm:[1,3,1,3] row_mask:0xf bank_mask:0xf
    v_cndmask_b32_dpp v148, v160, v196, vcc quad_perm:[0,2,0,2] row_mask:0xf bank_mask:0xf
    v_cndmask_b32_dpp v149, v161, v197, vcc quad_perm:[0,2,0,2] row_mask:0xf bank_mask:0xf
    v_cndmask_b32_dpp v150, v160, v198, vcc quad_perm:[1,3,1,3] row_mask:0xf bank_mask:0xf
    v_cndmask_b32_dpp v151, v161, v199, vcc quad_perm:[1,3,1,3] row_mask:0xf bank_mask:0xf
    v_cndmask_b32_dpp v152, v164, v200, vcc quad_perm:[0,2,0,2] row_mask:0xf bank_mask:0xf
    v_cndmask_b32_dpp v153, v165, v201, vcc quad_perm:[0,2,0,2] row_mask:0xf bank_mask:0xf
    v_cndmask_b32_dpp v154, v164, v202, vcc quad_perm:[1,3,1,3] row_mask:0xf bank_mask:0xf
    v_cndmask_b32_dpp v155, v165, v203, vcc quad_perm:[1,3,1,3] row_mask:0xf bank_mask:0xf
    buffer_store_dwordx4 v[144:147], v4, s[16:19], 0 offen offset:0 sc1
    buffer_store_dwordx4 v[148:151], v4, s[16:19], 0 offen offset:512 sc1
    buffer_store_dwordx4 v[152:155], v58, s[16:19], 0 offen offset:1024 sc1
    s_waitcnt vmcnt(0)
    s_mov_b32 s36, 2622592
    buffer_store_dwordx4 v[36:39], v6, s[24:27], s36 offen offset:0 sc1
    buffer_store_dwordx4 v[40:43], v6, s[24:27], s36 offen offset:512 sc1
    buffer_store_dwordx4 v[44:47], v60, s[24:27], s36 offen offset:1024 sc1
Ltail_done:
    s_endpgm
Lattn_wb:
    buffer_wbl2 sc1
    s_waitcnt vmcnt(0)
    s_branch Lattn_wbdone
Lattn_xspin:
Ltour15:
    s_cbranch_execz Lmain
    s_mov_b32 s37, 16384
Lattn_xloop:
    buffer_load_dword v11, v8, s[24:27], s54 offen offset:8 sc1
    s_waitcnt vmcnt(0)
    v_readfirstlane_b32 s36, v11
    s_sub_u32 s37, s37, 1
    s_cbranch_scc1 Lattn_xgot
    s_cmp_lg_u32 s36, s95
    s_cbranch_scc1 Lattn_xloop
    s_branch Lattn_xgot
Ltail_spin1:
Ltour16:
    s_cbranch_execz Lmain
    s_mov_b32 s48, 16384
Ltail_spinl1:
    buffer_load_dword v11, v9, s[24:27], s39 offen sc1
    s_waitcnt vmcnt(0)
    v_cmp_ne_u32 s[54:55], s95, v11
    s_sub_u32 s48, s48, 1
    s_cbranch_scc1 Ltail_got1
    s_cmp_lg_u64 s[54:55], 0
    s_cbranch_scc1 Ltail_spinl1
    s_branch Ltail_got1
Ltail_spin2:
Ltour17:
    s_cbranch_execz Lmain
    s_mov_b32 s48, 16384
Ltail_spinl2:
    buffer_load_dword v11, v9, s[24:27], s39 offen sc1
    s_waitcnt vmcnt(0)
    v_cmp_ne_u32 s[54:55], s95, v11
    s_sub_u32 s48, s48, 1
    s_cbranch_scc1 Ltail_got2
    s_cmp_lg_u64 s[54:55], 0
    s_cbranch_scc1 Ltail_spinl2
    s_branch Ltail_got2
Lattn_redo:
    v_xor_b32 v8, 64, v9
    v_xor_b32 v10, 64, v11
    s_waitcnt vmcnt(0) lgkmcnt(0)
    s_barrier
    v_mov_b32 v232, 0xff800000
    v_mov_b32 v233, 0xff800000
    v_mov_b32 v234, 0xff800000
    v_mov_b32 v235, 0xff800000
    s_mov_b32 s40, 0
    s_mov_b32 s48, -1
Lattn_redo_loop:
    s_add_u32 m0, s42, 0
    s_nop 0
    buffer_load_dwordx4 v36, s[8:11], s40 offen lds
    buffer_load_dwordx4 v37, s[8:11], s40 offen offset:1024 lds
    buffer_load_dwordx4 v38, s[8:11], s40 offen offset:2048 lds
    buffer_load_dwordx4 v39, s[8:11], s40 offen offset:3072 lds
    s_add_u32 s40, s40, 16384
    s_waitcnt vmcnt(0) lgkmcnt(0)
    s_barrier
    ds_read_b128 a[208:211], v8 offset:0
    ds_read_b128 a[212:215], v9 offset:0
    ds_read_b128 a[216:219], v10 offset:0
    ds_read_b128 a[220:223], v11 offset:0
    s_waitcnt lgkmcnt(3)
    v_mfma_f32_16x16x32_bf16 v[216:219], a[208:211], v[64:67], 0
    s_waitcnt lgkmcnt(2)
    v_mfma_f32_16x16x32_bf16 v[216:219], a[212:215], v[68:71], v[216:219]
    s_waitcnt lgkmcnt(1)
    v_mfma_f32_16x16x32_bf16 v[216:219], a[216:219], v[72:75], v[216:219]
    s_waitcnt lgkmcnt(0)
    v_mfma_f32_16x16x32_bf16 v[216:219], a[220:223], v[76:79], v[216:219]
    v_mfma_f32_16x16x32_bf16 v[220:223], a[208:211], v[80:83], 0
    v_mfma_f32_16x16x32_bf16 v[220:223], a[212:215], v[84:87], v[220:223]
    v_mfma_f32_16x16x32_bf16 v[220:223], a[216:219], v[88:91], v[220:223]
    v_mfma_f32_16x16x32_bf16 v[220:223], a[220:223], v[92:95], v[220:223]
    v_mfma_f32_16x16x32_bf16 v[224:227], a[208:211], v[96:99], 0
    v_mfma_f32_16x16x32_bf16 v[224:227], a[212:215], v[100:103], v[224:227]
    v_mfma_f32_16x16x32_bf16 v[224:227], a[216:219], v[104:107], v[224:227]
    v_mfma_f32_16x16x32_bf16 v[224:227], a[220:223], v[108:111], v[224:227]
    v_mfma_f32_16x16x32_bf16 v[228:231], a[208:211], v[112:115], 0
    v_mfma_f32_16x16x32_bf16 v[228:231], a[212:215], v[116:119], v[228:231]
    v_mfma_f32_16x16x32_bf16 v[228:231], a[216:219], v[120:123], v[228:231]
    v_mfma_f32_16x16x32_bf16 v[228:231], a[220:223], v[124:127], v[228:231]
    v_max3_f32 v232, v232, v216, v217
    v_max3_f32 v232, v232, v218, v219
    v_max3_f32 v233, v233, v220, v221
    v_max3_f32 v233, v233, v222, v223
    v_max3_f32 v234, v234, v224, v225
    v_max3_f32 v234, v234, v226, v227
    s_nop 1
    v_max3_f32 v235, v235, v228, v229
    v_max3_f32 v235, v235, v230, v231
    ds_read_b128 a[224:227], v8 offset:4096
    ds_read_b128 a[228:231], v9 offset:4096
    ds_read_b128 a[232:235], v10 offset:4096
    ds_read_b128 a[236:239], v11 offset:4096
    s_waitcnt lgkmcnt(3)
    v_mfma_f32_16x16x32_bf16 v[216:219], a[224:227], v[64:67], 0
    s_waitcnt lgkmcnt(2)
    v_mfma_f32_16x16x32_bf16 v[216:219], a[228:231], v[68:71], v[216:219]
    s_waitcnt lgkmcnt(1)
    v_mfma_f32_16x16x32_bf16 v[216:219], a[232:235], v[72:75], v[216:219]
    s_waitcnt lgkmcnt(0)
    v_mfma_f32_16x16x32_bf16 v[216:219], a[236:239], v[76:79], v[216:219]
    v_mfma_f32_16x16x32_bf16 v[220:223], a[224:227], v[80:83], 0
    v_mfma_f32_16x16x32_bf16 v[220:223], a[228:231], v[84:87], v[220:223]
    v_mfma_f32_16x16x32_bf16 v[220:223], a[232:235], v[88:91], v[220:223]
    v_mfma_f32_16x16x32_bf16 v[220:223], a[236:239], v[92:95], v[220:223]
    v_mfma_f32_16x16x32_bf16 v[224:227], a[224:227], v[96:99], 0
    v_mfma_f32_16x16x32_bf16 v[224:227], a[228:231], v[100:103], v[224:227]
    v_mfma_f32_16x16x32_bf16 v[224:227], a[232:235], v[104:107], v[224:227]
    v_mfma_f32_16x16x32_bf16 v[224:227], a[236:239], v[108:111], v[224:227]
    v_mfma_f32_16x16x32_bf16 v[228:231], a[224:227], v[112:115], 0
    v_mfma_f32_16x16x32_bf16 v[228:231], a[228:231], v[116:119], v[228:231]
    v_mfma_f32_16x16x32_bf16 v[228:231], a[232:235], v[120:123], v[228:231]
    v_mfma_f32_16x16x32_bf16 v[228:231], a[236:239], v[124:127], v[228:231]
    v_max3_f32 v232, v232, v216, v217
    v_max3_f32 v232, v232, v218, v219
    v_max3_f32 v233, v233, v220, v221
    v_max3_f32 v233, v233, v222, v223
    v_max3_f32 v234, v234, v224, v225
    v_max3_f32 v234, v234, v226, v227
    s_nop 1
    v_max3_f32 v235, v235, v228, v229
    v_max3_f32 v235, v235, v230, v231
    ds_read_b128 a[208:211], v8 offset:8192
    ds_read_b128 a[212:215], v9 offset:8192
    ds_read_b128 a[216:219], v10 offset:8192
    ds_read_b128 a[220:223], v11 offset:8192
    s_waitcnt lgkmcnt(3)
    v_mfma_f32_16x16x32_bf16 v[216:219], a[208:211], v[64:67], 0
    s_waitcnt lgkmcnt(2)
    v_mfma_f32_16x16x32_bf16 v[216:219], a[212:215], v[68:71], v[216:219]
    s_waitcnt lgkmcnt(1)
    v_mfma_f32_16x16x32_bf16 v[216:219], a[216:219], v[72:75], v[216:219]
    s_waitcnt lgkmcnt(0)
    v_mfma_f32_16x16x32_bf16 v[216:219], a[220:223], v[76:79], v[216:219]
    v_mfma_f32_16x16x32_bf16 v[220:223], a[208:211], v[80:83], 0
    v_mfma_f32_16x16x32_bf16 v[220:223], a[212:215], v[84:87], v[220:223]
    v_mfma_f32_16x16x32_bf16 v[220:223], a[216:219], v[88:91], v[220:223]
    v_mfma_f32_16x16x32_bf16 v[220:223], a[220:223], v[92:95], v[220:223]
    v_mfma_f32_16x16x32_bf16 v[224:227], a[208:211], v[96:99], 0
    v_mfma_f32_16x16x32_bf16 v[224:227], a[212:215], v[100:103], v[224:227]
    v_mfma_f32_16x16x32_bf16 v[224:227], a[216:219], v[104:107], v[224:227]
    v_mfma_f32_16x16x32_bf16 v[224:227], a[220:223], v[108:111], v[224:227]
    v_mfma_f32_16x16x32_bf16 v[228:231], a[208:211], v[112:115], 0
    v_mfma_f32_16x16x32_bf16 v[228:231], a[212:215], v[116:119], v[228:231]
    v_mfma_f32_16x16x32_bf16 v[228:231], a[216:219], v[120:123], v[228:231]
    v_mfma_f32_16x16x32_bf16 v[228:231], a[220:223], v[124:127], v[228:231]
    v_max3_f32 v232, v232, v216, v217
    v_max3_f32 v232, v232, v218, v219
    v_max3_f32 v233, v233, v220, v221
    v_max3_f32 v233, v233, v222, v223
    v_max3_f32 v234, v234, v224, v225
    v_max3_f32 v234, v234, v226, v227
    s_nop 1
    v_max3_f32 v235, v235, v228, v229
    v_max3_f32 v235, v235, v230, v231
    ds_read_b128 a[224:227], v8 offset:12288
    ds_read_b128 a[228:231], v9 offset:12288
    ds_read_b128 a[232:235], v10 offset:12288
    ds_read_b128 a[236:239], v11 offset:12288
    s_waitcnt lgkmcnt(3)
    v_mfma_f32_16x16x32_bf16 v[216:219], a[224:227], v[64:67], 0
    s_waitcnt lgkmcnt(2)
    v_mfma_f32_16x16x32_bf16 v[216:219], a[228:231], v[68:71], v[216:219]
    s_waitcnt lgkmcnt(1)
    v_mfma_f32_16x16x32_bf16 v[216:219], a[232:235], v[72:75], v[216:219]
    s_waitcnt lgkmcnt(0)
    v_mfma_f32_16x16x32_bf16 v[216:219], a[236:239], v[76:79], v[216:219]
    v_mfma_f32_16x16x32_bf16 v[220:223], a[224:227], v[80:83], 0
    v_mfma_f32_16x16x32_bf16 v[220:223], a[228:231], v[84:87], v[220:223]
    v_mfma_f32_16x16x32_bf16 v[220:223], a[232:235], v[88:91], v[220:223]
    v_mfma_f32_16x16x32_bf16 v[220:223], a[236:239], v[92:95], v[220:223]
    v_mfma_f32_16x16x32_bf16 v[224:227], a[224:227], v[96:99], 0
    v_mfma_f32_16x16x32_bf16 v[224:227], a[228:231], v[100:103], v[224:227]
    v_mfma_f32_16x16x32_bf16 v[224:227], a[232:235], v[104:107], v[224:227]
    v_mfma_f32_16x16x32_bf16 v[224:227], a[236:239], v[108:111], v[224:227]
    v_mfma_f32_16x16x32_bf16 v[228:231], a[224:227], v[112:115], 0
    v_mfma_f32_16x16x32_bf16 v[228:231], a[228:231], v[116:119], v[228:231]
    v_mfma_f32_16x16x32_bf16 v[228:231], a[232:235], v[120:123], v[228:231]
    v_mfma_f32_16x16x32_bf16 v[228:231], a[236:239], v[124:127], v[228:231]
    v_max3_f32 v232, v232, v216, v217
    v_max3_f32 v232, v232, v218, v219
    v_max3_f32 v233, v233, v220, v221
    v_max3_f32 v233, v233, v222, v223
    v_max3_f32 v234, v234, v224, v225
    v_max3_f32 v234, v234, v226, v227
    s_nop 1
    v_max3_f32 v235, v235, v228, v229
    v_max3_f32 v235, v235, v230, v231
    s_barrier
    s_cmp_lt_u32 s40, 524288
    s_cbranch_scc1 Lattn_redo_loop
    v_mov_b32 v236, v232
    v_mov_b32 v237, v233
    v_mov_b32 v238, v234
    v_mov_b32 v239, v235
    v_permlane16_swap_b32 v232, v236
    v_permlane16_swap_b32 v233, v237
    v_permlane16_swap_b32 v234, v238
    v_permlane16_swap_b32 v235, v239
    v_max_f32 v232, v232, v236
    v_max_f32 v233, v233, v237
    v_max_f32 v234, v234, v238
    v_max_f32 v235, v235, v239
    v_mov_b32 v236, v232
    v_mov_b32 v237, v233
    v_mov_b32 v238, v234
    v_mov_b32 v239, v235
    v_permlane32_swap_b32 v232, v236
    v_permlane32_swap_b32 v233, v237
    v_permlane32_swap_b32 v234, v238
    v_permlane32_swap_b32 v235, v239
    v_max_f32 v232, v232, v236
    v_max_f32 v233, v233, v237
    v_max_f32 v234, v234, v238
    v_max_f32 v235, v235, v239
    v_sub_f32 v192, 0, v232
    v_sub_f32 v193, 0, v232
    v_sub_f32 v194, 0, v232
    v_sub_f32 v195, 0, v232
    v_sub_f32 v196, 0, v233
    v_sub_f32 v197, 0, v233
    v_sub_f32 v198, 0, v233
    v_sub_f32 v199, 0, v233
    v_sub_f32 v200, 0, v234
    v_sub_f32 v201, 0, v234
    v_sub_f32 v202, 0, v234
    v_sub_f32 v203, 0, v234
    v_sub_f32 v204, 0, v235
    v_sub_f32 v205, 0, v235
    v_sub_f32 v206, 0, v235
    v_sub_f32 v207, 0, v235
    s_mov_b32 s40, 0
    s_mov_b32 s41, 0
    s_add_u32 m0, s42, 0
    s_nop 0
    buffer_load_dwordx4 v36, s[8:11], s40 offen lds
    buffer_load_dwordx4 v37, s[8:11], s40 offen offset:1024 lds
    buffer_load_dwordx4 v38, s[8:11], s40 offen offset:2048 lds
    buffer_load_dwordx4 v39, s[8:11], s40 offen offset:3072 lds
    s_add_u32 s40, s40, 16384
    s_add_u32 m0, s42, 16384
    s_nop 0
    buffer_load_dwordx4 v36, s[8:11], s40 offen lds
    buffer_load_dwordx4 v37, s[8:11], s40 offen offset:1024 lds
    buffer_load_dwordx4 v38, s[8:11], s40 offen offset:2048 lds
    buffer_load_dwordx4 v39, s[8:11], s40 offen offset:3072 lds
    s_add_u32 s40, s40, 16384
    s_add_u32 m0, s42, 32768
    s_nop 0
    buffer_load_dwordx4 v36, s[8:11], s40 offen lds
    buffer_load_dwordx4 v37, s[8:11], s40 offen offset:1024 lds
    buffer_load_dwordx4 v38, s[8:11], s40 offen offset:2048 lds
    buffer_load_dwordx4 v39, s[8:11], s40 offen offset:3072 lds
    s_add_u32 s40, s40, 16384
    s_add_u32 m0, s42, 65536
    s_nop 0
    buffer_load_dwordx4 v40, s[12:15], s41 offen lds
    buffer_load_dwordx4 v41, s[12:15], s41 offen offset:1024 lds
    buffer_load_dwordx4 v40, s[12:15], s41 offen offset:2048 lds
    buffer_load_dwordx4 v41, s[12:15], s41 offen offset:3072 lds
    s_add_u32 s41, s41, 16384
    s_add_u32 m0, s42, 81920
    s_nop 0
    buffer_load_dwordx4 v40, s[12:15], s41 offen lds
    buffer_load_dwordx4 v41, s[12:15], s41 offen offset:1024 lds
    buffer_load_dwordx4 v40, s[12:15], s41 offen offset:2048 lds
    buffer_load_dwordx4 v41, s[12:15], s41 offen offset:3072 lds
    s_add_u32 s41, s41, 16384
    v_accvgpr_write_b32 a0, 0
    v_accvgpr_write_b32 a1, 0
    v_accvgpr_write_b32 a2, 0
    v_accvgpr_write_b32 a3, 0
    v_accvgpr_write_b32 a4, 0
    v_accvgpr_write_b32 a5, 0
    v_accvgpr_write_b32 a6, 0
    v_accvgpr_write_b32 a7, 0
    v_accvgpr_write_b32 a8, 0
    v_accvgpr_write_b32 a9, 0
    v_accvgpr_write_b32 a10, 0
    v_accvgpr_write_b32 a11, 0
    v_accvgpr_write_b32 a12, 0
    v_accvgpr_write_b32 a13, 0
    v_accvgpr_write_b32 a14, 0
    v_accvgpr_write_b32 a15, 0
    v_accvgpr_write_b32 a16, 0
    v_accvgpr_write_b32 a17, 0
    v_accvgpr_write_b32 a18, 0
    v_accvgpr_write_b32 a19, 0
    v_accvgpr_write_b32 a20, 0
    v_accvgpr_write_b32 a21, 0
    v_accvgpr_write_b32 a22, 0
    v_accvgpr_write_b32 a23, 0
    v_accvgpr_write_b32 a24, 0
    v_accvgpr_write_b32 a25, 0
    v_accvgpr_write_b32 a26, 0
    v_accvgpr_write_b32 a27, 0
    v_accvgpr_write_b32 a28, 0
    v_accvgpr_write_b32 a29, 0
    v_accvgpr_write_b32 a30, 0
    v_accvgpr_write_b32 a31, 0
    v_accvgpr_write_b32 a32, 0
    v_accvgpr_write_b32 a33, 0
    v_accvgpr_write_b32 a34, 0
    v_accvgpr_write_b32 a35, 0
    v_accvgpr_write_b32 a36, 0
    v_accvgpr_write_b32 a37, 0
    v_accvgpr_write_b32 a38, 0
    v_accvgpr_write_b32 a39, 0
    v_accvgpr_write_b32 a40, 0
    v_accvgpr_write_b32 a41, 0
    v_accvgpr_write_b32 a42, 0
    v_accvgpr_write_b32 a43, 0
    v_accvgpr_write_b32 a44, 0
    v_accvgpr_write_b32 a45, 0
    v_accvgpr_write_b32 a46, 0
    v_accvgpr_write_b32 a47, 0
    v_accvgpr_write_b32 a48, 0
    v_accvgpr_write_b32 a49, 0
    v_accvgpr_write_b32 a50, 0
    v_accvgpr_write_b32 a51, 0
    v_accvgpr_write_b32 a52, 0
    v_accvgpr_write_b32 a53, 0
    v_accvgpr_write_b32 a54, 0
    v_accvgpr_write_b32 a55, 0
    v_accvgpr_write_b32 a56, 0
    v_accvgpr_write_b32 a57, 0
    v_accvgpr_write_b32 a58, 0
    v_accvgpr_write_b32 a59, 0
    v_accvgpr_write_b32 a60, 0
    v_accvgpr_write_b32 a61, 0
    v_accvgpr_write_b32 a62, 0
    v_accvgpr_write_b32 a63, 0
    v_accvgpr_write_b32 a64, 0
    v_accvgpr_write_b32 a65, 0
    v_accvgpr_write_b32 a66, 0
    v_accvgpr_write_b32 a67, 0
    v_accvgpr_write_b32 a68, 0
    v_accvgpr_write_b32 a69, 0
    v_accvgpr_write_b32 a70, 0
    v_accvgpr_write_b32 a71, 0
    v_accvgpr_write_b32 a72, 0
    v_accvgpr_write_b32 a73, 0
    v_accvgpr_write_b32 a74, 0
    v_accvgpr_write_b32 a75, 0
    v_accvgpr_write_b32 a76, 0
    v_accvgpr_write_b32 a77, 0
    v_accvgpr_write_b32 a78, 0
    v_accvgpr_write_b32 a79, 0
    v_accvgpr_write_b32 a80, 0
    v_accvgpr_write_b32 a81, 0
    v_accvgpr_write_b32 a82, 0
    v_accvgpr_write_b32 a83, 0
    v_accvgpr_write_b32 a84, 0
    v_accvgpr_write_b32 a85, 0
    v_accvgpr_write_b32 a86, 0
    v_accvgpr_write_b32 a87, 0
    v_accvgpr_write_b32 a88, 0
    v_accvgpr_write_b32 a89, 0
    v_accvgpr_write_b32 a90, 0
    v_accvgpr_write_b32 a91, 0
    v_accvgpr_write_b32 a92, 0
    v_accvgpr_write_b32 a93, 0
    v_accvgpr_write_b32 a94, 0
    v_accvgpr_write_b32 a95, 0
    v_accvgpr_write_b32 a96, 0
    v_accvgpr_write_b32 a97, 0
    v_accvgpr_write_b32 a98, 0
    v_accvgpr_write_b32 a99, 0
    v_accvgpr_write_b32 a100, 0
    v_accvgpr_write_b32 a101, 0
    v_accvgpr_write_b32 a102, 0
    v_accvgpr_write_b32 a103, 0
    v_accvgpr_write_b32 a104, 0
    v_accvgpr_write_b32 a105, 0
    v_accvgpr_write_b32 a106, 0
    v_accvgpr_write_b32 a107, 0
    v_accvgpr_write_b32 a108, 0
    v_accvgpr_write_b32 a109, 0
    v_accvgpr_write_b32 a110, 0
    v_accvgpr_write_b32 a111, 0
    v_accvgpr_write_b32 a112, 0
    v_accvgpr_write_b32 a113, 0
    v_accvgpr_write_b32 a114, 0
    v_accvgpr_write_b32 a115, 0
    v_accvgpr_write_b32 a116, 0
    v_accvgpr_write_b32 a117, 0
    v_accvgpr_write_b32 a118, 0
    v_accvgpr_write_b32 a119, 0
    v_accvgpr_write_b32 a120, 0
    v_accvgpr_write_b32 a121, 0
    v_accvgpr_write_b32 a122, 0
    v_accvgpr_write_b32 a123, 0
    v_accvgpr_write_b32 a124, 0
    v_accvgpr_write_b32 a125, 0
    v_accvgpr_write_b32 a126, 0
    v_accvgpr_write_b32 a127, 0
    v_accvgpr_write_b32 a192, 0
    v_accvgpr_write_b32 a193, 0
    v_accvgpr_write_b32 a194, 0
    v_accvgpr_write_b32 a195, 0
    v_accvgpr_write_b32 a196, 0
    v_accvgpr_write_b32 a197, 0
    v_accvgpr_write_b32 a198, 0
    v_accvgpr_write_b32 a199, 0
    v_accvgpr_write_b32 a200, 0
    v_accvgpr_write_b32 a201, 0
    v_accvgpr_write_b32 a202, 0
    v_accvgpr_write_b32 a203, 0
    v_accvgpr_write_b32 a204, 0
    v_accvgpr_write_b32 a205, 0
    v_accvgpr_write_b32 a206, 0
    v_accvgpr_write_b32 a207, 0
    s_waitcnt vmcnt(0) lgkmcnt(0)
    s_barrier
    ds_read_b128 a[208:211], v8 offset:0
    ds_read_b128 a[212:215], v9 offset:0
    ds_read_b128 a[216:219], v10 offset:0
    ds_read_b128 a[220:223], v11 offset:0
    ds_read_b128 a[224:227], v8 offset:4096
    s_waitcnt vmcnt(0) lgkmcnt(0)
    s_branch Lattn_stage0
Lattn_armwait:
    s_mov_b32 s36, 16384
Lattn_armloop:
    v_mov_b32 v63, 0
    buffer_load_dword v63, v63, s[88:91], 0 offen sc1
    s_waitcnt vmcnt(0)
    v_readfirstlane_b32 s37, v63
    s_sub_u32 s36, s36, 1
    s_cbranch_scc1 Lattn_armed
    s_cmp_lt_u32 s37, 256
    s_cbranch_scc1 Lattn_armloop
    s_branch Lattn_armed
Lattn_end:
    s_endpgm
.section .rodata,"a"
.p2align 6
.amdhsa_kernel adaLN_cond__gqa_block_cached__moe_arch_mod__prompt_kernel
  .amdhsa_next_free_vgpr 512
  .amdhsa_next_free_sgpr 102
  .amdhsa_accum_offset 256
  .amdhsa_group_segment_fixed_size 0
  .amdhsa_kernarg_size 120
  .amdhsa_user_sgpr_count 2
  .amdhsa_user_sgpr_kernarg_segment_ptr 1
  .amdhsa_system_sgpr_workgroup_id_x 1
  .amdhsa_float_denorm_mode_32 3
.end_amdhsa_kernel
```

```asm
; @launch grid=(256,1,1) block=(256,1,1) lds=163840
.amdgcn_target "amdgcn-amd-amdhsa--gfx950"
.text
.globl adaLN_cond__gqa_block_cached__moe_arch_mod__prompt_kernel
.p2align 8
.type adaLN_cond__gqa_block_cached__moe_arch_mod__prompt_kernel,@function
adaLN_cond__gqa_block_cached__moe_arch_mod__prompt_kernel:
    s_cmp_ge_u32 s2, 256
    s_cbranch_scc1 Lattn_end
    s_load_dwordx2 s[8:9], s[0:1], 80
    s_load_dwordx2 s[12:13], s[0:1], 88
    s_load_dwordx2 s[20:21], s[0:1], 0
    s_load_dwordx2 s[50:51], s[0:1], 112
    s_load_dwordx8 s[52:59], s[0:1], 8
    s_load_dwordx4 s[80:83], s[0:1], 56
    s_load_dwordx2 s[84:85], s[0:1], 72
    s_load_dwordx2 s[88:89], s[0:1], 104
    s_load_dwordx2 s[28:29], s[0:1], 48
    s_getpc_b64 s[32:33]
Lattn_pc:
    s_mov_b32 s34, Lattn_end-Lattn_pc
    s_mov_b32 s35, 0x20000
    s_lshr_b32 s6, s2, 3
    s_lshl_b32 s7, s6, 6
    v_lshrrev_b32 v3, 6, v0
    v_and_b32 v1, 63, v0
    v_lshrrev_b32 v2, 2, v0
    v_lshlrev_b32 v2, 11, v2
    v_readfirstlane_b32 s3, v3
    buffer_load_dword v240, v2, s[32:35], s7 offen
    s_and_b32 s7, s2, 7
    s_lshl_b32 s4, s7, 1
    s_and_b32 s5, s6, 1
    s_add_u32 s4, s4, s5
    s_lshr_b32 s5, s2, 4
    s_lshr_b32 s38, s6, 2
    s_lshl_b32 s38, s38, 3
    s_add_u32 s38, s38, s7
    s_cmp_lt_u32 s38, 18
    s_cselect_b32 s39, 0, 2147483648
    s_lshl_b32 s38, s38, 2
    s_and_b32 s36, s6, 3
    s_add_u32 s38, s38, s36
    s_mov_b32 s14, 3981312
    s_mul_i32 s92, s6, 124416
    s_lshl_b32 s36, s7, 7
    s_add_u32 s92, s92, s36
    s_cmp_lt_u32 s7, 2
    s_cselect_b32 s36, 53, 35
    v_lshrrev_b32 v2, 2, v0
    v_min_u32 v2, s36, v2
    v_mul_u32_u24 v3, 57, v2
    v_lshrrev_b32 v3, 10, v3
    v_mul_i32_i24 v3, -123392, v3
    v_mul_u32_u24 v2, 6912, v2
    v_add_u32 v72, v2, v3
    s_mov_b32 s15, 0x20000
    s_mov_b32 s10, 1152
    s_mov_b32 s11, 0x20000
    s_mov_b32 s22, 2359296
    s_mov_b32 s23, 0x20000
    v_and_b32 v64, 0xfe, v0
    v_mul_u32_u24 v65, 3456, v64
    v_and_b32 v2, 1, v0
    v_lshl_add_u32 v65, v2, 4, v65
    s_lshl_b32 s36, s38, 5
    s_or_b32 s36, s36, s39
    v_and_b32 v4, 31, v1
    v_lshrrev_b32 v5, 5, v1
    v_cmp_gt_u32 vcc, 24, v4
    v_mov_b32 v6, 2147483648
    s_lshl_b32 s7, s5, 4
    s_add_u32 s7, s7, s4
    s_lshl_b32 s7, s7, 2
    s_add_u32 s7, s7, s3
    v_cndmask_b32 v6, v6, 0, vcc
    s_mul_i32 s49, s7, 2304
    v_lshrrev_b32 v7, 2, v4
    v_lshl_add_u32 v7, v7, 6, v6
    v_and_b32 v2, 3, v4
    v_lshl_add_u32 v7, v2, 3, v7
    v_mul_u32_u24 v2, 1152, v5
    v_add_u32 v66, v7, v2
    s_waitcnt lgkmcnt(0)
    s_load_dword s94, s[50:51], 24576
    buffer_load_dword v241, v72, s[12:15], s92 offen
    buffer_load_ushort v80, v64, s[8:11], 0 offen offset:0
    buffer_load_ushort v81, v64, s[8:11], 0 offen offset:256
    buffer_load_ushort v82, v64, s[8:11], 0 offen offset:512
    buffer_load_ushort v83, v64, s[8:11], 0 offen offset:768
    buffer_load_ushort v84, v64, s[8:11], 0 offen offset:1024
    buffer_load_dwordx4 v[88:91], v65, s[12:15], s36 offen
    s_add_u32 s36, s36, 884736
    buffer_load_dwordx4 v[92:95], v65, s[12:15], s36 offen
    s_add_u32 s36, s36, 884736
    buffer_load_dwordx4 v[96:99], v65, s[12:15], s36 offen
    s_add_u32 s36, s36, 884736
    buffer_load_dwordx4 v[100:103], v65, s[12:15], s36 offen
    s_add_u32 s36, s36, 884736
    buffer_load_dwordx4 v[104:107], v65, s[12:15], s36 offen
    s_mov_b32 s16, s56
    s_mov_b32 s17, s57
    s_mov_b32 s18, 4718592
    s_mov_b32 s19, 0x20000
    s_lshl_b32 s44, s4, 9
    s_mul_i32 s36, s5, 98304
    s_add_u32 s36, s36, 0
    v_lshrrev_b32 v2, 2, v0
    v_min_u32 v2, 47, v2
    v_lshrrev_b32 v3, 2, v2
    v_and_b32 v2, 3, v2
    v_lshl_add_u32 v2, v2, 7, s36
    v_lshl_add_u32 v71, v3, 13, v2
    s_mul_i32 s36, s5, 196608
    s_add_u32 s36, s36, 1572864
    v_lshrrev_b32 v2, 1, v0
    v_min_u32 v2, 95, v2
    v_lshrrev_b32 v3, 2, v2
    v_and_b32 v2, 3, v2
    v_lshl_add_u32 v2, v2, 7, s36
    v_lshl_add_u32 v70, v3, 13, v2
    s_add_u32 s92, s49, 65536
    v_lshl_add_u32 v7, v5, 4, v6
    v_lshl_add_u32 v67, v4, 5, v7
    v_min_u32 v4, 23, v4
    v_lshlrev_b32 v68, 4, v4
    s_mov_b32 s24, s50
    s_mov_b32 s25, s51
    s_mov_b32 s26, 10485760
    s_mov_b32 s27, 0x20000
    s_mov_b32 s90, 256
    s_mov_b32 s91, 0x20000
    s_cmp_ge_u32 s38, 36
    s_cselect_b32 s93, 1.0, 0
    s_lshl_b32 s36, s38, 7
    v_lshl_add_u32 v69, v0, 3, s36
    v_cmp_gt_u32 s[36:37], 16, v0
    v_mov_b32 v2, 2147483648
    v_mov_b32 v3, s39
    v_cndmask_b32 v2, v2, v3, s[36:37]
    v_or_b32 v69, v69, v2
    s_mul_i32 s36, s5, 3072
    s_lshl_b32 s37, s5, 11
    v_lshrrev_b32 v120, 3, v0
    v_min_u32 v120, 23, v120
    v_lshl_add_u32 v120, v120, 7, s36
    v_lshrrev_b32 v121, 4, v0
    v_lshl_add_u32 v121, v121, 7, s37
    s_lshl_b32 s42, s3, 12
    v_lshrrev_b32 v2, 4, v1
    v_and_b32 v3, 15, v1
    v_lshrrev_b32 v5, 1, v3
    v_mul_u32_u24 v5, 2304, v5
    v_lshl_add_u32 v5, v2, 5, v5
    v_and_b32 v6, 1, v3
    v_lshl_add_u32 v51, v6, 4, v5
    s_lshl_b32 s6, s5, 2
    s_add_u32 s6, s6, s3
    s_mul_i32 s46, s6, 36864
    s_add_u32 s46, s46, 65536
    s_add_u32 s43, s46, 18432
    s_mul_i32 s45, s4, 294912
    s_lshl_b32 s7, s3, 4
    v_add_u32 v4, s7, v2
    v_lshlrev_b32 v5, 1, v2
    v_xor_b32 v5, v5, v3
    v_xor_b32 v6, 8, v5
    v_lshlrev_b32 v7, 13, v4
    v_lshl_add_u32 v42, v5, 4, v7
    v_lshl_add_u32 v43, v6, 4, v7
    v_add_u32 v44, 63488, v42
    v_add_u32 v45, 95232, v43
    v_add_u32 v43, 31744, v43
    s_lshl_b32 s7, s4, 19
    s_add_u32 s8, s52, s7
    s_addc_u32 s9, s53, 0
    s_mov_b32 s10, 524288
    s_mov_b32 s11, 0x20000
    s_add_u32 s12, s54, s7
    s_addc_u32 s13, s55, 0
    s_mov_b32 s14, 524288
    s_mov_b32 s15, 0x20000
    s_add_u32 s28, s50, 10485760
    s_addc_u32 s29, s51, 0
    s_mov_b32 s30, 37748736
    s_mov_b32 s31, 0x20000
    v_lshlrev_b32 v7, 8, v4
    v_lshl_add_u32 v40, v5, 4, v7
    v_lshl_add_u32 v41, v6, 4, v7
    v_xor_b32 v224, v3, v2
    v_lshl_add_u32 v36, v224, 4, v7
    v_xor_b32 v37, 64, v36
    v_xor_b32 v38, 128, v36
    v_xor_b32 v39, 192, v36
    v_lshrrev_b32 v7, 3, v5
    v_lshl_add_u32 v7, v7, 7, v4
    v_mul_u32_u24 v7, 1152, v7
    v_and_b32 v225, 7, v5
    v_lshl_add_u32 v46, v225, 4, v7
    v_lshrrev_b32 v7, 3, v6
    v_lshl_add_u32 v7, v7, 7, v4
    v_mul_u32_u24 v7, 1152, v7
    v_and_b32 v225, 7, v6
    v_lshl_add_u32 v47, v225, 4, v7
    v_add_u32 v48, 7168, v46
    v_add_u32 v49, 10752, v47
    v_add_u32 v47, 3584, v47
    v_lshlrev_b32 v7, 8, v3
    v_lshl_add_u32 v8, v224, 4, v7
    v_xor_b32 v9, 64, v8
    v_xor_b32 v10, 128, v8
    v_xor_b32 v11, 192, v8
    v_lshrrev_b32 v5, 2, v1
    v_and_b32 v6, 7, v5
    v_lshlrev_b32 v6, 5, v6
    v_lshl_add_u32 v6, v5, 8, v6
    v_and_b32 v7, 3, v1
    v_lshl_add_u32 v12, v7, 3, v6
    v_xor_b32 v13, 32, v12
    v_xor_b32 v14, 64, v12
    v_xor_b32 v15, 96, v12
    v_xor_b32 v16, 128, v12
    v_xor_b32 v17, 160, v12
    v_xor_b32 v18, 192, v12
    v_xor_b32 v19, 224, v12
    v_add_u32 v20, 65536, v12
    v_add_u32 v21, 65536, v13
    v_add_u32 v22, 65536, v14
    v_add_u32 v23, 65536, v15
    v_add_u32 v24, 65536, v16
    v_add_u32 v25, 65536, v17
    v_add_u32 v26, 65536, v18
    v_add_u32 v27, 65536, v19
    v_add_u32 v28, 131072, v12
    v_add_u32 v29, 131072, v13
    v_add_u32 v30, 131072, v14
    v_add_u32 v31, 131072, v15
    v_add_u32 v32, 131072, v16
    v_add_u32 v33, 131072, v17
    v_add_u32 v34, 131072, v18
    v_add_u32 v35, 131072, v19
    v_mov_b32 v52, 0x3f803f80
    v_mov_b32 v53, 0x3f803f80
    v_mov_b32 v54, 0x3f803f80
    v_mov_b32 v55, 0x3f803f80
    v_and_b32 v5, 1, v1
    v_mul_u32_u24 v5, 0xaaaa, v5
    v_add_u32 v5, 0x4444, v5
    v_lshl_add_u32 v50, v5, 16, v5
    v_lshrrev_b32 v5, 1, v3
    v_mul_u32_u24 v5, 20480, v5
    v_lshl_add_u32 v5, v2, 5, v5
    v_and_b32 v6, 1, v3
    v_lshl_add_u32 v56, v6, 4, v5
    s_mul_i32 s47, s6, 327680
    s_mov_b32 s32, s82
    s_mov_b32 s33, s83
    s_mov_b32 s34, 5308416
    s_mov_b32 s35, 0x20000
    s_mov_b32 s82, 5308416
    s_mov_b32 s83, 0x20000
    s_mov_b32 s86, 5308416
    s_mov_b32 s87, 0x20000
    s_lshr_b32 s7, s2, 3
    s_mul_i32 s7, s7, 18
    s_add_u32 s7, s7, s3
    s_and_b32 s36, s2, 7
    s_mul_i32 s37, s36, 576
    s_add_u32 s37, s37, s7
    s_mul_i32 s37, s37, 1152
    s_mul_i32 s7, s7, 9216
    s_mul_i32 s36, s36, 1152
    s_add_u32 s7, s7, s36
    v_min_u32 v5, 17, v1
    v_lshl_add_u32 v57, v5, 6, s7
    v_lshl_add_u32 v62, v5, 6, s37
    s_mov_b32 s40, 0
    s_mov_b32 s41, 0
    s_mov_b32 s48, 0
    s_waitcnt vmcnt(9)
    v_lshlrev_b32 v80, 16, v80
    s_waitcnt vmcnt(8)
    v_lshlrev_b32 v81, 16, v81
    s_waitcnt vmcnt(7)
    v_lshlrev_b32 v82, 16, v82
    s_waitcnt vmcnt(6)
    v_lshlrev_b32 v83, 16, v83
    s_waitcnt vmcnt(5)
    v_lshlrev_b32 v84, 16, v84
    v_mul_f32 v144, 0xbfb8aa3b, v80
    v_mul_f32 v148, 0xbfb8aa3b, v81
    v_mul_f32 v152, 0xbfb8aa3b, v82
    v_mul_f32 v156, 0xbfb8aa3b, v83
    v_mul_f32 v160, 0xbfb8aa3b, v84
    v_min_f32 v144, 0x42fc0000, v144
    v_min_f32 v148, 0x42fc0000, v148
    v_min_f32 v152, 0x42fc0000, v152
    v_min_f32 v156, 0x42fc0000, v156
    v_min_f32 v160, 0x42fc0000, v160
    v_exp_f32 v144, v144
    v_exp_f32 v148, v148
    v_exp_f32 v152, v152
    v_exp_f32 v156, v156
    v_exp_f32 v160, v160
    v_add_f32 v144, 1.0, v144
    v_add_f32 v148, 1.0, v148
    v_add_f32 v152, 1.0, v152
    v_add_f32 v156, 1.0, v156
    v_add_f32 v160, 1.0, v160
    v_rcp_f32 v145, v144
    v_rcp_f32 v149, v148
    v_rcp_f32 v153, v152
    v_rcp_f32 v157, v156
    v_rcp_f32 v161, v160
    v_mul_f32 v146, v80, v145
    v_mul_f32 v150, v81, v149
    v_mul_f32 v154, v82, v153
    v_mul_f32 v158, v83, v157
    v_mul_f32 v162, v84, v161
    v_fma_f32 v144, -v146, v144, v80
    v_fma_f32 v148, -v150, v148, v81
    v_fma_f32 v152, -v154, v152, v82
    v_fma_f32 v156, -v158, v156, v83
    v_fma_f32 v160, -v162, v160, v84
    v_fma_f32 v80, v144, v145, v146
    v_fma_f32 v81, v148, v149, v150
    v_fma_f32 v82, v152, v153, v154
    v_fma_f32 v83, v156, v157, v158
    v_fma_f32 v84, v160, v161, v162
    v_cvt_pk_bf16_f32 v80, v80, v80
    v_cvt_pk_bf16_f32 v81, v81, v81
    v_cvt_pk_bf16_f32 v82, v82, v82
    v_cvt_pk_bf16_f32 v83, v83, v83
    v_cvt_pk_bf16_f32 v84, v84, v84
    v_and_b32 v80, 0xffff0000, v80
    v_and_b32 v81, 0xffff0000, v81
    v_and_b32 v82, 0xffff0000, v82
    v_and_b32 v83, 0xffff0000, v83
    v_and_b32 v84, 0xffff0000, v84
    buffer_load_dwordx2 v[108:109], v66, s[20:23], s49 offen offset:0
    buffer_load_dwordx2 v[110:111], v66, s[20:23], s49 offen offset:32
    buffer_load_dwordx2 v[112:113], v66, s[20:23], s49 offen offset:384
    buffer_load_dwordx2 v[114:115], v66, s[20:23], s49 offen offset:416
    buffer_load_dwordx2 v[116:117], v66, s[20:23], s49 offen offset:768
    buffer_load_dwordx2 v[118:119], v66, s[20:23], s49 offen offset:800
    s_mov_b32 s20, s58
    s_mov_b32 s21, s59
    s_mov_b32 s22, 4718592
    s_mov_b32 s23, 0x20000
    s_waitcnt vmcnt(10)
    v_lshlrev_b32 v136, 16, v88
    v_and_b32 v137, 0xffff0000, v88
    v_lshlrev_b32 v138, 16, v89
    v_and_b32 v139, 0xffff0000, v89
    v_lshlrev_b32 v140, 16, v90
    v_and_b32 v141, 0xffff0000, v90
    v_lshlrev_b32 v142, 16, v91
    v_and_b32 v143, 0xffff0000, v91
    v_pk_mul_f32 v[128:129], v[136:137], v[80:81] op_sel:[0,0] op_sel_hi:[1,0]
    v_pk_mul_f32 v[130:131], v[138:139], v[80:81] op_sel:[0,0] op_sel_hi:[1,0]
    v_pk_mul_f32 v[132:133], v[140:141], v[80:81] op_sel:[0,0] op_sel_hi:[1,0]
    v_pk_mul_f32 v[134:135], v[142:143], v[80:81] op_sel:[0,0] op_sel_hi:[1,0]
    s_waitcnt vmcnt(9)
    v_lshlrev_b32 v136, 16, v92
    v_and_b32 v137, 0xffff0000, v92
    v_lshlrev_b32 v138, 16, v93
    v_and_b32 v139, 0xffff0000, v93
    v_lshlrev_b32 v140, 16, v94
    v_and_b32 v141, 0xffff0000, v94
    v_lshlrev_b32 v142, 16, v95
    v_and_b32 v143, 0xffff0000, v95
    v_pk_fma_f32 v[128:129], v[136:137], v[80:81], v[128:129] op_sel:[0,1,0] op_sel_hi:[1,1,1]
    v_pk_fma_f32 v[130:131], v[138:139], v[80:81], v[130:131] op_sel:[0,1,0] op_sel_hi:[1,1,1]
    v_pk_fma_f32 v[132:133], v[140:141], v[80:81], v[132:133] op_sel:[0,1,0] op_sel_hi:[1,1,1]
    v_pk_fma_f32 v[134:135], v[142:143], v[80:81], v[134:135] op_sel:[0,1,0] op_sel_hi:[1,1,1]
    s_waitcnt vmcnt(8)
    v_lshlrev_b32 v136, 16, v96
    v_and_b32 v137, 0xffff0000, v96
    v_lshlrev_b32 v138, 16, v97
    v_and_b32 v139, 0xffff0000, v97
    v_lshlrev_b32 v140, 16, v98
    v_and_b32 v141, 0xffff0000, v98
    v_lshlrev_b32 v142, 16, v99
    v_and_b32 v143, 0xffff0000, v99
    v_pk_fma_f32 v[128:129], v[136:137], v[82:83], v[128:129] op_sel:[0,0,0] op_sel_hi:[1,0,1]
    v_pk_fma_f32 v[130:131], v[138:139], v[82:83], v[130:131] op_sel:[0,0,0] op_sel_hi:[1,0,1]
    v_pk_fma_f32 v[132:133], v[140:141], v[82:83], v[132:133] op_sel:[0,0,0] op_sel_hi:[1,0,1]
    v_pk_fma_f32 v[134:135], v[142:143], v[82:83], v[134:135] op_sel:[0,0,0] op_sel_hi:[1,0,1]
    s_waitcnt vmcnt(7)
    v_lshlrev_b32 v136, 16, v100
    v_and_b32 v137, 0xffff0000, v100
    v_lshlrev_b32 v138, 16, v101
    v_and_b32 v139, 0xffff0000, v101
    v_lshlrev_b32 v140, 16, v102
    v_and_b32 v141, 0xffff0000, v102
    v_lshlrev_b32 v142, 16, v103
    v_and_b32 v143, 0xffff0000, v103
    v_pk_fma_f32 v[128:129], v[136:137], v[82:83], v[128:129] op_sel:[0,1,0] op_sel_hi:[1,1,1]
    v_pk_fma_f32 v[130:131], v[138:139], v[82:83], v[130:131] op_sel:[0,1,0] op_sel_hi:[1,1,1]
    v_pk_fma_f32 v[132:133], v[140:141], v[82:83], v[132:133] op_sel:[0,1,0] op_sel_hi:[1,1,1]
    v_pk_fma_f32 v[134:135], v[142:143], v[82:83], v[134:135] op_sel:[0,1,0] op_sel_hi:[1,1,1]
    s_waitcnt vmcnt(6)
    v_lshlrev_b32 v136, 16, v104
    v_and_b32 v137, 0xffff0000, v104
    v_lshlrev_b32 v138, 16, v105
    v_and_b32 v139, 0xffff0000, v105
    v_lshlrev_b32 v140, 16, v106
    v_and_b32 v141, 0xffff0000, v106
    v_lshlrev_b32 v142, 16, v107
    v_and_b32 v143, 0xffff0000, v107
    v_pk_fma_f32 v[128:129], v[136:137], v[84:85], v[128:129] op_sel:[0,0,0] op_sel_hi:[1,0,1]
    v_pk_fma_f32 v[130:131], v[138:139], v[84:85], v[130:131] op_sel:[0,0,0] op_sel_hi:[1,0,1]
    v_pk_fma_f32 v[132:133], v[140:141], v[84:85], v[132:133] op_sel:[0,0,0] op_sel_hi:[1,0,1]
    v_pk_fma_f32 v[134:135], v[142:143], v[84:85], v[134:135] op_sel:[0,0,0] op_sel_hi:[1,0,1]
    s_nop 0
    v_permlane32_swap_b32 v128, v132
    v_permlane32_swap_b32 v129, v133
    v_permlane32_swap_b32 v130, v134
    v_permlane32_swap_b32 v131, v135
    v_and_b32 v72, 1, v1
    v_pk_add_f32 v[128:129], v[128:129], v[132:133]
    v_pk_add_f32 v[130:131], v[130:131], v[134:135]
    v_lshlrev_b32 v72, 5, v72
    v_lshrrev_b32 v73, 4, v1
    v_permlane16_swap_b32 v128, v130
    v_permlane16_swap_b32 v129, v131
    v_lshl_add_u32 v72, v73, 3, v72
    v_pk_add_f32 v[128:129], v[128:129], v[130:131]
    s_lshl_b32 s36, s3, 6
    v_add_u32 v72, s36, v72
    v_add_f32_dpp v128, v128, v128 row_ror:2 row_mask:0xf bank_mask:0xf
    v_add_f32_dpp v129, v129, v129 row_ror:2 row_mask:0xf bank_mask:0xf
    s_nop 0
    v_add_f32_dpp v128, v128, v128 row_ror:4 row_mask:0xf bank_mask:0xf
    v_add_f32_dpp v129, v129, v129 row_ror:4 row_mask:0xf bank_mask:0xf
    s_nop 0
    v_add_f32_dpp v128, v128, v128 row_ror:8 row_mask:0xf bank_mask:0xf
    v_add_f32_dpp v129, v129, v129 row_ror:8 row_mask:0xf bank_mask:0xf
    ds_write_b64 v72, v[128:129] offset:0
    v_and_b32 v73, 7, v1
    v_lshlrev_b32 v73, 3, v73
    s_waitcnt lgkmcnt(0)
    s_barrier
    ds_read_b64 v[128:129], v73 offset:0
    ds_read_b64 v[130:131], v73 offset:64
    ds_read_b64 v[132:133], v73 offset:128
    ds_read_b64 v[134:135], v73 offset:192
    s_add_u32 s95, s94, 0x9e3779b9
    v_mov_b32 v137, s95
    s_mov_b32 s37, 32768
    s_waitcnt lgkmcnt(2)
    v_pk_add_f32 v[128:129], v[128:129], v[130:131]
    s_waitcnt lgkmcnt(0)
    v_pk_add_f32 v[132:133], v[132:133], v[134:135]
    v_pk_add_f32 v[128:129], v[128:129], v[132:133]
    v_cvt_pk_bf16_f32 v136, v128, v129
    v_lshlrev_b32 v128, 16, v136
    v_and_b32 v129, 0xffff0000, v136
    v_add_f32 v128, s93, v128
    v_add_f32 v129, s93, v129
    v_cvt_pk_bf16_f32 v136, v128, v129
    buffer_store_dwordx2 v[136:137], v69, s[24:27], s37 offen sc1
    s_mul_i32 s36, s3, 72
    v_add_u32 v122, s36, v1
    v_and_b32 v123, 7, v1
    s_add_u32 s36, s36, 64
    v_add_u32 v123, s36, v123
    s_movk_i32 s36, 1024
    v_and_b32 v76, 3, v122
    v_lshlrev_b32 v76, 4, v76
    v_lshrrev_b32 v122, 2, v122
    v_lshl_add_u32 v124, v122, 7, v76
    v_and_b32 v77, 1, v122
    v_lshl_add_u32 v76, v77, 3, v76
    v_lshrrev_b32 v122, 1, v122
    v_lshl_add_u32 v122, v122, 6, v76
    v_add_u32 v122, s36, v122
    v_and_b32 v76, 3, v123
    v_lshlrev_b32 v76, 4, v76
    v_lshrrev_b32 v123, 2, v123
    v_lshl_add_u32 v125, v123, 7, v76
    v_and_b32 v77, 1, v123
    v_lshl_add_u32 v76, v77, 3, v76
    v_lshrrev_b32 v123, 1, v123
    v_lshl_add_u32 v123, v123, 6, v76
    v_add_u32 v123, s36, v123
    s_mov_b64 exec, 0
    s_cmp_eq_u32 s3, 0
    s_cbranch_scc1 Ltour0
    s_cmp_eq_u32 s3, 1
    s_cbranch_scc1 Ltour1
    s_cmp_eq_u32 s3, 2
    s_cbranch_scc1 Ltour2
    s_branch Ltour3
.p2align 12
Lmain:
    s_mov_b64 exec, -1
    s_waitcnt vmcnt(6)
    v_lshlrev_b32 v144, 16, v108
    v_and_b32 v145, 0xffff0000, v108
    v_lshlrev_b32 v146, 16, v109
    v_and_b32 v147, 0xffff0000, v109
    s_waitcnt vmcnt(5)
    v_lshlrev_b32 v148, 16, v110
    v_and_b32 v149, 0xffff0000, v110
    v_lshlrev_b32 v150, 16, v111
    v_and_b32 v151, 0xffff0000, v111
    s_waitcnt vmcnt(4)
    v_lshlrev_b32 v152, 16, v112
    v_and_b32 v153, 0xffff0000, v112
    v_lshlrev_b32 v154, 16, v113
    v_and_b32 v155, 0xffff0000, v113
    s_waitcnt vmcnt(3)
    v_lshlrev_b32 v156, 16, v114
    v_and_b32 v157, 0xffff0000, v114
    v_lshlrev_b32 v158, 16, v115
    v_and_b32 v159, 0xffff0000, v115
    s_waitcnt vmcnt(2)
    v_lshlrev_b32 v160, 16, v116
    v_and_b32 v161, 0xffff0000, v116
    v_lshlrev_b32 v162, 16, v117
    v_and_b32 v163, 0xffff0000, v117
    s_waitcnt vmcnt(1)
    v_lshlrev_b32 v164, 16, v118
    v_and_b32 v165, 0xffff0000, v118
    v_lshlrev_b32 v166, 16, v119
    v_and_b32 v167, 0xffff0000, v119
    buffer_load_dwordx4 v[88:91], v124, s[24:27], s37 offen sc1
    buffer_load_dwordx4 v[92:95], v125, s[24:27], s37 offen sc1
    buffer_load_dword v242, v71, s[16:19], s44 offen
    v_pk_add_f32 v[72:73], v[144:145], v[148:149]
    v_pk_add_f32 v[76:77], v[146:147], v[150:151]
    v_pk_add_f32 v[72:73], v[72:73], v[152:153]
    v_pk_add_f32 v[76:77], v[76:77], v[154:155]
    v_pk_add_f32 v[72:73], v[72:73], v[156:157]
    v_pk_add_f32 v[76:77], v[76:77], v[158:159]
    v_pk_add_f32 v[72:73], v[72:73], v[160:161]
    v_pk_add_f32 v[76:77], v[76:77], v[162:163]
    v_pk_add_f32 v[72:73], v[72:73], v[164:165]
    v_pk_add_f32 v[76:77], v[76:77], v[166:167]
    v_pk_add_f32 v[72:73], v[72:73], v[76:77]
    v_add_f32 v72, v72, v73
    s_nop 1
    v_add_f32_dpp v72, v72, v72 row_ror:8 row_mask:0xf bank_mask:0xf
    s_nop 1
    v_add_f32_dpp v72, v72, v72 row_ror:4 row_mask:0xf bank_mask:0xf
    s_nop 1
    v_add_f32_dpp v72, v72, v72 row_ror:2 row_mask:0xf bank_mask:0xf
    s_nop 1
    v_add_f32_dpp v72, v72, v72 row_ror:1 row_mask:0xf bank_mask:0xf
    v_mov_b32 v76, v72
    s_nop 1
    v_permlane16_swap_b32 v72, v76
    s_nop 0
    v_add_f32 v72, v72, v76
    v_mul_f32 v72, 0x3ae38e39, v72
    v_pk_add_f32 v[168:169], v[144:145], v[72:73] op_sel_hi:[1,0] neg_lo:[0,1] neg_hi:[0,1]
    v_pk_add_f32 v[170:171], v[146:147], v[72:73] op_sel_hi:[1,0] neg_lo:[0,1] neg_hi:[0,1]
    v_pk_add_f32 v[172:173], v[148:149], v[72:73] op_sel_hi:[1,0] neg_lo:[0,1] neg_hi:[0,1]
    v_pk_add_f32 v[174:175], v[150:151], v[72:73] op_sel_hi:[1,0] neg_lo:[0,1] neg_hi:[0,1]
    v_pk_add_f32 v[176:177], v[152:153], v[72:73] op_sel_hi:[1,0] neg_lo:[0,1] neg_hi:[0,1]
    v_pk_add_f32 v[178:179], v[154:155], v[72:73] op_sel_hi:[1,0] neg_lo:[0,1] neg_hi:[0,1]
    v_pk_add_f32 v[180:181], v[156:157], v[72:73] op_sel_hi:[1,0] neg_lo:[0,1] neg_hi:[0,1]
    v_pk_add_f32 v[182:183], v[158:159], v[72:73] op_sel_hi:[1,0] neg_lo:[0,1] neg_hi:[0,1]
    v_pk_add_f32 v[184:185], v[160:161], v[72:73] op_sel_hi:[1,0] neg_lo:[0,1] neg_hi:[0,1]
    v_pk_add_f32 v[186:187], v[162:163], v[72:73] op_sel_hi:[1,0] neg_lo:[0,1] neg_hi:[0,1]
    v_pk_add_f32 v[188:189], v[164:165], v[72:73] op_sel_hi:[1,0] neg_lo:[0,1] neg_hi:[0,1]
    v_pk_add_f32 v[190:191], v[166:167], v[72:73] op_sel_hi:[1,0] neg_lo:[0,1] neg_hi:[0,1]
    v_pk_mul_f32 v[74:75], v[168:169], v[168:169]
    v_pk_mul_f32 v[76:77], v[170:171], v[170:171]
    v_pk_fma_f32 v[74:75], v[172:173], v[172:173], v[74:75]
    v_pk_fma_f32 v[76:77], v[174:175], v[174:175], v[76:77]
    v_pk_fma_f32 v[74:75], v[176:177], v[176:177], v[74:75]
    v_pk_fma_f32 v[76:77], v[178:179], v[178:179], v[76:77]
    v_pk_fma_f32 v[74:75], v[180:181], v[180:181], v[74:75]
    v_pk_fma_f32 v[76:77], v[182:183], v[182:183], v[76:77]
    v_pk_fma_f32 v[74:75], v[184:185], v[184:185], v[74:75]
    v_pk_fma_f32 v[76:77], v[186:187], v[186:187], v[76:77]
    v_pk_fma_f32 v[74:75], v[188:189], v[188:189], v[74:75]
    v_pk_fma_f32 v[76:77], v[190:191], v[190:191], v[76:77]
    v_pk_add_f32 v[74:75], v[74:75], v[76:77]
    v_add_f32 v74, v74, v75
    v_cndmask_b32 v74, 0, v74, vcc
    s_nop 1
    v_add_f32_dpp v74, v74, v74 row_ror:8 row_mask:0xf bank_mask:0xf
    s_nop 1
    v_add_f32_dpp v74, v74, v74 row_ror:4 row_mask:0xf bank_mask:0xf
    s_nop 1
    v_add_f32_dpp v74, v74, v74 row_ror:2 row_mask:0xf bank_mask:0xf
    s_nop 1
    v_add_f32_dpp v74, v74, v74 row_ror:1 row_mask:0xf bank_mask:0xf
    v_mov_b32 v76, v74
    s_nop 1
    v_permlane16_swap_b32 v74, v76
    s_nop 0
    v_add_f32 v74, v74, v76
    v_mul_f32 v74, 0x3ae38e39, v74
    v_cvt_pk_bf16_f32 v76, v72, v74
    v_and_b32 v74, 0xffff0000, v76
    v_lshlrev_b32 v72, 16, v76
    v_add_f32 v74, 0x3727c5ac, v74
    v_cvt_pk_bf16_f32 v74, v74, v74
    v_and_b32 v74, 0xffff0000, v74
    v_sqrt_f32 v74, v74
    v_pk_add_f32 v[168:169], v[144:145], v[72:73] op_sel_hi:[1,0] neg_lo:[0,1] neg_hi:[0,1]
    v_pk_add_f32 v[170:171], v[146:147], v[72:73] op_sel_hi:[1,0] neg_lo:[0,1] neg_hi:[0,1]
    v_pk_add_f32 v[172:173], v[148:149], v[72:73] op_sel_hi:[1,0] neg_lo:[0,1] neg_hi:[0,1]
    v_pk_add_f32 v[174:175], v[150:151], v[72:73] op_sel_hi:[1,0] neg_lo:[0,1] neg_hi:[0,1]
    v_pk_add_f32 v[176:177], v[152:153], v[72:73] op_sel_hi:[1,0] neg_lo:[0,1] neg_hi:[0,1]
    v_pk_add_f32 v[178:179], v[154:155], v[72:73] op_sel_hi:[1,0] neg_lo:[0,1] neg_hi:[0,1]
    v_pk_add_f32 v[180:181], v[156:157], v[72:73] op_sel_hi:[1,0] neg_lo:[0,1] neg_hi:[0,1]
    v_pk_add_f32 v[182:183], v[158:159], v[72:73] op_sel_hi:[1,0] neg_lo:[0,1] neg_hi:[0,1]
    v_pk_add_f32 v[184:185], v[160:161], v[72:73] op_sel_hi:[1,0] neg_lo:[0,1] neg_hi:[0,1]
    v_pk_add_f32 v[186:187], v[162:163], v[72:73] op_sel_hi:[1,0] neg_lo:[0,1] neg_hi:[0,1]
    v_pk_add_f32 v[188:189], v[164:165], v[72:73] op_sel_hi:[1,0] neg_lo:[0,1] neg_hi:[0,1]
    v_pk_add_f32 v[190:191], v[166:167], v[72:73] op_sel_hi:[1,0] neg_lo:[0,1] neg_hi:[0,1]
    v_cvt_pk_bf16_f32 v74, v74, v74
    v_and_b32 v74, 0xffff0000, v74
    v_rcp_f32 v74, v74
    v_cvt_pk_bf16_f32 v108, v168, v169
    v_cvt_pk_bf16_f32 v109, v170, v171
    v_cvt_pk_bf16_f32 v110, v172, v173
    v_cvt_pk_bf16_f32 v111, v174, v175
    v_cvt_pk_bf16_f32 v112, v176, v177
    v_cvt_pk_bf16_f32 v113, v178, v179
    v_cvt_pk_bf16_f32 v114, v180, v181
    v_cvt_pk_bf16_f32 v115, v182, v183
    v_cvt_pk_bf16_f32 v116, v184, v185
    v_cvt_pk_bf16_f32 v117, v186, v187
    v_cvt_pk_bf16_f32 v118, v188, v189
    v_cvt_pk_bf16_f32 v119, v190, v191
    v_lshlrev_b32 v168, 16, v108
    v_and_b32 v169, 0xffff0000, v108
    v_lshlrev_b32 v170, 16, v109
    v_and_b32 v171, 0xffff0000, v109
    v_lshlrev_b32 v172, 16, v110
    v_and_b32 v173, 0xffff0000, v110
    v_lshlrev_b32 v174, 16, v111
    v_and_b32 v175, 0xffff0000, v111
    v_lshlrev_b32 v176, 16, v112
    v_and_b32 v177, 0xffff0000, v112
    v_lshlrev_b32 v178, 16, v113
    v_and_b32 v179, 0xffff0000, v113
    v_lshlrev_b32 v180, 16, v114
    v_and_b32 v181, 0xffff0000, v114
    v_lshlrev_b32 v182, 16, v115
    v_and_b32 v183, 0xffff0000, v115
    v_lshlrev_b32 v184, 16, v116
    v_and_b32 v185, 0xffff0000, v116
    v_lshlrev_b32 v186, 16, v117
    v_and_b32 v187, 0xffff0000, v117
    v_lshlrev_b32 v188, 16, v118
    v_and_b32 v189, 0xffff0000, v118
    v_lshlrev_b32 v190, 16, v119
    v_and_b32 v191, 0xffff0000, v119
    v_pk_mul_f32 v[168:169], v[168:169], v[74:75] op_sel_hi:[1,0]
    v_pk_mul_f32 v[170:171], v[170:171], v[74:75] op_sel_hi:[1,0]
    v_pk_mul_f32 v[172:173], v[172:173], v[74:75] op_sel_hi:[1,0]
    v_pk_mul_f32 v[174:175], v[174:175], v[74:75] op_sel_hi:[1,0]
    v_pk_mul_f32 v[176:177], v[176:177], v[74:75] op_sel_hi:[1,0]
    v_pk_mul_f32 v[178:179], v[178:179], v[74:75] op_sel_hi:[1,0]
    v_pk_mul_f32 v[180:181], v[180:181], v[74:75] op_sel_hi:[1,0]
    v_pk_mul_f32 v[182:183], v[182:183], v[74:75] op_sel_hi:[1,0]
    v_pk_mul_f32 v[184:185], v[184:185], v[74:75] op_sel_hi:[1,0]
    v_pk_mul_f32 v[186:187], v[186:187], v[74:75] op_sel_hi:[1,0]
    v_pk_mul_f32 v[188:189], v[188:189], v[74:75] op_sel_hi:[1,0]
    v_pk_mul_f32 v[190:191], v[190:191], v[74:75] op_sel_hi:[1,0]
    v_cvt_pk_bf16_f32 v108, v168, v169
    v_cvt_pk_bf16_f32 v109, v170, v171
    v_cvt_pk_bf16_f32 v110, v172, v173
    v_cvt_pk_bf16_f32 v111, v174, v175
    v_cvt_pk_bf16_f32 v112, v176, v177
    v_cvt_pk_bf16_f32 v113, v178, v179
    v_cvt_pk_bf16_f32 v114, v180, v181
    v_cvt_pk_bf16_f32 v115, v182, v183
    v_cvt_pk_bf16_f32 v116, v184, v185
    v_cvt_pk_bf16_f32 v117, v186, v187
    v_cvt_pk_bf16_f32 v118, v188, v189
    v_cvt_pk_bf16_f32 v119, v190, v191
    v_lshlrev_b32 v168, 16, v108
    v_and_b32 v169, 0xffff0000, v108
    v_lshlrev_b32 v170, 16, v109
    v_and_b32 v171, 0xffff0000, v109
    v_lshlrev_b32 v172, 16, v110
    v_and_b32 v173, 0xffff0000, v110
    v_lshlrev_b32 v174, 16, v111
    v_and_b32 v175, 0xffff0000, v111
    v_lshlrev_b32 v176, 16, v112
    v_and_b32 v177, 0xffff0000, v112
    v_lshlrev_b32 v178, 16, v113
    v_and_b32 v179, 0xffff0000, v113
    v_lshlrev_b32 v180, 16, v114
    v_and_b32 v181, 0xffff0000, v114
    v_lshlrev_b32 v182, 16, v115
    v_and_b32 v183, 0xffff0000, v115
    v_lshlrev_b32 v184, 16, v116
    v_and_b32 v185, 0xffff0000, v116
    v_lshlrev_b32 v186, 16, v117
    v_and_b32 v187, 0xffff0000, v117
    v_lshlrev_b32 v188, 16, v118
    v_and_b32 v189, 0xffff0000, v118
    v_lshlrev_b32 v190, 16, v119
    v_and_b32 v191, 0xffff0000, v119
    s_mov_b32 s38, 16384
    s_waitcnt vmcnt(2)
    v_xor_b32 v89, s95, v89
    v_xor_b32 v91, s95, v91
    s_waitcnt vmcnt(1)
    v_xor_b32 v93, s95, v93
    v_xor_b32 v95, s95, v95
    v_or3_b32 v89, v89, v91, v93
    v_or_b32 v89, v89, v95
    v_cmp_ne_u32 vcc, 0, v89
    s_cbranch_vccz Lhead_gotm
Lhead_pollm:
    buffer_load_dwordx4 v[88:91], v124, s[24:27], s37 offen sc1
    buffer_load_dwordx4 v[92:95], v125, s[24:27], s37 offen sc1
    s_waitcnt vmcnt(0)
    s_sub_u32 s38, s38, 1
    s_cbranch_scc1 Lhead_gotm
    v_xor_b32 v89, s95, v89
    v_xor_b32 v91, s95, v91
    v_xor_b32 v93, s95, v93
    v_xor_b32 v95, s95, v95
    v_or3_b32 v89, v89, v91, v93
    v_or_b32 v89, v89, v95
    v_cmp_ne_u32 vcc, 0, v89
    s_cbranch_vccnz Lhead_pollm
Lhead_gotm:
    ds_write2_b32 v122, v88, v90 offset0:0 offset1:1
    ds_write2_b32 v123, v92, v94 offset0:0 offset1:1
    s_waitcnt lgkmcnt(0)
    s_barrier
    ds_read_b128 v[144:147], v68 offset:2176
    ds_read_b128 v[148:151], v68 offset:2560
    ds_read_b128 v[152:155], v68 offset:2944
    ds_read_b128 v[156:159], v68 offset:1024
    ds_read_b128 v[160:163], v68 offset:1408
    ds_read_b128 v[164:167], v68 offset:1792
    s_waitcnt lgkmcnt(5)
    v_lshlrev_b32 v192, 16, v144
    v_and_b32 v193, 0xffff0000, v144
    v_lshlrev_b32 v194, 16, v145
    v_and_b32 v195, 0xffff0000, v145
    v_lshlrev_b32 v196, 16, v146
    v_and_b32 v197, 0xffff0000, v146
    v_lshlrev_b32 v198, 16, v147
    v_and_b32 v199, 0xffff0000, v147
    s_waitcnt lgkmcnt(4)
    v_lshlrev_b32 v200, 16, v148
    v_and_b32 v201, 0xffff0000, v148
    v_lshlrev_b32 v202, 16, v149
    v_and_b32 v203, 0xffff0000, v149
    v_lshlrev_b32 v204, 16, v150
    v_and_b32 v205, 0xffff0000, v150
    v_lshlrev_b32 v206, 16, v151
    v_and_b32 v207, 0xffff0000, v151
    s_waitcnt lgkmcnt(3)
    v_lshlrev_b32 v208, 16, v152
    v_and_b32 v209, 0xffff0000, v152
    v_lshlrev_b32 v210, 16, v153
    v_and_b32 v211, 0xffff0000, v153
    v_lshlrev_b32 v212, 16, v154
    v_and_b32 v213, 0xffff0000, v154
    v_lshlrev_b32 v214, 16, v155
    v_and_b32 v215, 0xffff0000, v155
    v_pk_mul_f32 v[168:169], v[168:169], v[192:193]
    v_pk_mul_f32 v[170:171], v[170:171], v[194:195]
    v_pk_mul_f32 v[172:173], v[172:173], v[196:197]
    v_pk_mul_f32 v[174:175], v[174:175], v[198:199]
    v_pk_mul_f32 v[176:177], v[176:177], v[200:201]
    v_pk_mul_f32 v[178:179], v[178:179], v[202:203]
    v_pk_mul_f32 v[180:181], v[180:181], v[204:205]
    v_pk_mul_f32 v[182:183], v[182:183], v[206:207]
    v_pk_mul_f32 v[184:185], v[184:185], v[208:209]
    v_pk_mul_f32 v[186:187], v[186:187], v[210:211]
    v_pk_mul_f32 v[188:189], v[188:189], v[212:213]
    v_pk_mul_f32 v[190:191], v[190:191], v[214:215]
    v_cvt_pk_bf16_f32 v108, v168, v169
    v_cvt_pk_bf16_f32 v109, v170, v171
    v_cvt_pk_bf16_f32 v110, v172, v173
    v_cvt_pk_bf16_f32 v111, v174, v175
    v_cvt_pk_bf16_f32 v112, v176, v177
    v_cvt_pk_bf16_f32 v113, v178, v179
    v_cvt_pk_bf16_f32 v114, v180, v181
    v_cvt_pk_bf16_f32 v115, v182, v183
    v_cvt_pk_bf16_f32 v116, v184, v185
    v_cvt_pk_bf16_f32 v117, v186, v187
    v_cvt_pk_bf16_f32 v118, v188, v189
    v_cvt_pk_bf16_f32 v119, v190, v191
    s_waitcnt lgkmcnt(2)
    v_lshlrev_b32 v216, 16, v156
    v_and_b32 v217, 0xffff0000, v156
    v_lshlrev_b32 v218, 16, v157
    v_and_b32 v219, 0xffff0000, v157
    v_lshlrev_b32 v220, 16, v158
    v_and_b32 v221, 0xffff0000, v158
    v_lshlrev_b32 v222, 16, v159
    v_and_b32 v223, 0xffff0000, v159
    s_waitcnt lgkmcnt(1)
    v_lshlrev_b32 v224, 16, v160
    v_and_b32 v225, 0xffff0000, v160
    v_lshlrev_b32 v226, 16, v161
    v_and_b32 v227, 0xffff0000, v161
    v_lshlrev_b32 v228, 16, v162
    v_and_b32 v229, 0xffff0000, v162
    v_lshlrev_b32 v230, 16, v163
    v_and_b32 v231, 0xffff0000, v163
    s_waitcnt lgkmcnt(0)
    v_lshlrev_b32 v232, 16, v164
    v_and_b32 v233, 0xffff0000, v164
    v_lshlrev_b32 v234, 16, v165
    v_and_b32 v235, 0xffff0000, v165
    v_lshlrev_b32 v236, 16, v166
    v_and_b32 v237, 0xffff0000, v166
    v_lshlrev_b32 v238, 16, v167
    v_and_b32 v239, 0xffff0000, v167
    v_lshlrev_b32 v168, 16, v108
    v_and_b32 v169, 0xffff0000, v108
    v_lshlrev_b32 v170, 16, v109
    v_and_b32 v171, 0xffff0000, v109
    v_lshlrev_b32 v172, 16, v110
    v_and_b32 v173, 0xffff0000, v110
    v_lshlrev_b32 v174, 16, v111
    v_and_b32 v175, 0xffff0000, v111
    v_lshlrev_b32 v176, 16, v112
    v_and_b32 v177, 0xffff0000, v112
    v_lshlrev_b32 v178, 16, v113
    v_and_b32 v179, 0xffff0000, v113
    v_lshlrev_b32 v180, 16, v114
    v_and_b32 v181, 0xffff0000, v114
    v_lshlrev_b32 v182, 16, v115
    v_and_b32 v183, 0xffff0000, v115
    v_lshlrev_b32 v184, 16, v116
    v_and_b32 v185, 0xffff0000, v116
    v_lshlrev_b32 v186, 16, v117
    v_and_b32 v187, 0xffff0000, v117
    v_lshlrev_b32 v188, 16, v118
    v_and_b32 v189, 0xffff0000, v118
    v_lshlrev_b32 v190, 16, v119
    v_and_b32 v191, 0xffff0000, v119
    v_pk_add_f32 v[168:169], v[168:169], v[216:217]
    v_pk_add_f32 v[170:171], v[170:171], v[218:219]
    v_pk_add_f32 v[172:173], v[172:173], v[220:221]
    v_pk_add_f32 v[174:175], v[174:175], v[222:223]
    v_cvt_pk_bf16_f32 v108, v168, v169
    v_cvt_pk_bf16_f32 v109, v170, v171
    v_cvt_pk_bf16_f32 v110, v172, v173
    v_cvt_pk_bf16_f32 v111, v174, v175
    buffer_store_dwordx4 v[108:111], v67, s[24:27], s92 offen offset:0 sc1
    v_pk_add_f32 v[176:177], v[176:177], v[224:225]
    v_pk_add_f32 v[178:179], v[178:179], v[226:227]
    v_pk_add_f32 v[180:181], v[180:181], v[228:229]
    v_pk_add_f32 v[182:183], v[182:183], v[230:231]
    v_cvt_pk_bf16_f32 v112, v176, v177
    v_cvt_pk_bf16_f32 v113, v178, v179
    v_cvt_pk_bf16_f32 v114, v180, v181
    v_cvt_pk_bf16_f32 v115, v182, v183
    buffer_store_dwordx4 v[112:115], v67, s[24:27], s92 offen offset:768 sc1
    v_pk_add_f32 v[184:185], v[184:185], v[232:233]
    v_pk_add_f32 v[186:187], v[186:187], v[234:235]
    v_pk_add_f32 v[188:189], v[188:189], v[236:237]
    v_pk_add_f32 v[190:191], v[190:191], v[238:239]
    v_cvt_pk_bf16_f32 v116, v184, v185
    v_cvt_pk_bf16_f32 v117, v186, v187
    v_cvt_pk_bf16_f32 v118, v188, v189
    v_cvt_pk_bf16_f32 v119, v190, v191
    buffer_store_dwordx4 v[116:119], v67, s[24:27], s92 offen offset:1536 sc1
    s_lshl_b32 s36, s5, 13
    s_add_u32 s36, s36, 8650752
    s_lshl_b32 s37, s4, 9
    s_add_u32 s37, s37, s36
    s_lshl_b32 s38, s3, 7
    s_add_u32 s37, s37, s38
    s_lshl_b32 s38, s3, 11
    s_add_u32 s36, s36, s38
    v_min_u32 v72, 1, v1
    v_lshlrev_b32 v72, 31, v72
    v_and_b32 v73, 15, v1
    v_lshlrev_b32 v73, 7, v73
    v_cmp_gt_u32 vcc, 162, v0
    v_mov_b32 v88, -1
    v_mov_b32 v89, -1
    v_mov_b32 v90, -1
    v_mov_b32 v91, -1
    s_mul_i32 s39, s2, 2592
    s_add_u32 s39, s39, 7864320
    v_lshl_add_u32 v74, v0, 4, s39
    s_lshl_b32 s39, s2, 7
    s_add_u32 s39, s39, 9306112
    v_mov_b32 v75, s39
    v_cndmask_b32 v74, v75, v74, vcc
    s_lshl_b32 s92, s5, 13
    s_add_u32 s92, s92, 8781824
    s_add_u32 s92, s92, s38
    s_lshl_b32 s38, s4, 7
    s_add_u32 s92, s92, s38
    s_getreg_b32 s38, hwreg(HW_REG_XCC_ID, 0, 4)
    s_add_u32 s38, s38, s95
    v_mov_b32 v76, s38
    v_mov_b32 v2, v80
    v_mov_b32 v3, v81
    v_mov_b32 v4, v82
    v_mov_b32 v5, v83
    v_mov_b32 v6, v84
    v_mov_b32 v7, v65
    v_and_b32 v126, 31, v1
    v_lshlrev_b32 v126, 2, v126
    s_waitcnt vmcnt(0)
    buffer_store_dword v137, v126, s[24:27], s37 offen sc1
    s_add_u32 s49, s44, 0
    s_add_u32 m0, s42, 32768
    s_nop 0
    buffer_load_dwordx4 v42, s[16:19], s49 offen lds
    buffer_load_dwordx4 v43, s[16:19], s49 offen offset:1024 lds
    buffer_load_dwordx4 v44, s[16:19], s49 offen offset:2048 lds
    buffer_load_dwordx4 v45, s[16:19], s49 offen offset:3072 lds
    s_add_u32 s49, s44, 256
    s_add_u32 m0, s42, 49152
    s_nop 0
    buffer_load_dwordx4 v42, s[16:19], s49 offen lds
    buffer_load_dwordx4 v43, s[16:19], s49 offen offset:1024 lds
    buffer_load_dwordx4 v44, s[16:19], s49 offen offset:2048 lds
    buffer_load_dwordx4 v45, s[16:19], s49 offen offset:3072 lds
    s_add_u32 s49, s44, 524288
    s_add_u32 m0, s42, 65536
    s_nop 0
    buffer_load_dwordx4 v42, s[16:19], s49 offen lds
    buffer_load_dwordx4 v43, s[16:19], s49 offen offset:1024 lds
    buffer_load_dwordx4 v44, s[16:19], s49 offen offset:2048 lds
    buffer_load_dwordx4 v45, s[16:19], s49 offen offset:3072 lds
    s_add_u32 s49, s44, 524544
    s_add_u32 m0, s42, 81920
    s_nop 0
    buffer_load_dwordx4 v42, s[16:19], s49 offen lds
    buffer_load_dwordx4 v43, s[16:19], s49 offen offset:1024 lds
    buffer_load_dwordx4 v44, s[16:19], s49 offen offset:2048 lds
    buffer_load_dwordx4 v45, s[16:19], s49 offen offset:3072 lds
    s_add_u32 s49, s44, 1048576
    s_add_u32 m0, s42, 98304
    s_nop 0
    buffer_load_dwordx4 v42, s[16:19], s49 offen lds
    buffer_load_dwordx4 v43, s[16:19], s49 offen offset:1024 lds
    buffer_load_dwordx4 v44, s[16:19], s49 offen offset:2048 lds
    buffer_load_dwordx4 v45, s[16:19], s49 offen offset:3072 lds
    s_add_u32 s49, s44, 1048832
    s_add_u32 m0, s42, 114688
    s_nop 0
    buffer_load_dwordx4 v42, s[16:19], s49 offen lds
    buffer_load_dwordx4 v43, s[16:19], s49 offen offset:1024 lds
    buffer_load_dwordx4 v44, s[16:19], s49 offen offset:2048 lds
    buffer_load_dwordx4 v45, s[16:19], s49 offen offset:3072 lds
    s_mov_b32 s38, 16384
Lhead_pollh:
    buffer_load_dword v75, v73, s[24:27], s36 offen sc1
    s_sub_u32 s38, s38, 1
    s_cbranch_scc1 Lhead_goth
    s_waitcnt vmcnt(0) lgkmcnt(0)
    v_cmp_ne_u32 vcc, s95, v75
    s_cbranch_vccnz Lhead_pollh
Lhead_goth:
    s_waitcnt vmcnt(0) lgkmcnt(0)
    buffer_load_dwordx4 a[0:3], v51, s[24:27], s46 offen offset:0 sc1
    buffer_load_dwordx4 a[8:11], v51, s[24:27], s46 offen offset:128 sc1
    buffer_load_dwordx4 a[4:7], v51, s[24:27], s43 offen offset:0 sc1
    buffer_load_dwordx4 a[12:15], v51, s[24:27], s43 offen offset:128 sc1
    s_barrier
    ds_read_b64_tr_b16 a[160:161], v12 offset:32768
    ds_read_b64_tr_b16 a[162:163], v12 offset:36864
    ds_read_b64_tr_b16 a[164:165], v12 offset:40960
    ds_read_b64_tr_b16 a[166:167], v12 offset:45056
    ds_read_b64_tr_b16 a[168:169], v13 offset:32768
    ds_read_b64_tr_b16 a[170:171], v13 offset:36864
    ds_read_b64_tr_b16 a[172:173], v13 offset:40960
    ds_read_b64_tr_b16 a[174:175], v13 offset:45056
    ds_read_b64_tr_b16 a[176:177], v14 offset:32768
    ds_read_b64_tr_b16 a[178:179], v14 offset:36864
    ds_read_b64_tr_b16 a[180:181], v14 offset:40960
    ds_read_b64_tr_b16 a[182:183], v14 offset:45056
    buffer_load_dwordx4 a[16:19], v51, s[24:27], s46 offen offset:256 sc1
    buffer_load_dwordx4 a[24:27], v51, s[24:27], s46 offen offset:384 sc1
    buffer_load_dwordx4 a[20:23], v51, s[24:27], s43 offen offset:256 sc1
    buffer_load_dwordx4 a[28:31], v51, s[24:27], s43 offen offset:384 sc1
    s_waitcnt lgkmcnt(10)
    s_waitcnt vmcnt(7)
    v_mfma_f32_16x16x32_bf16 v[128:131], a[160:163], a[0:3], 0
    s_waitcnt vmcnt(6)
    s_waitcnt lgkmcnt(8)
    ds_read_b64_tr_b16 a[184:185], v15 offset:32768
    v_mfma_f32_16x16x32_bf16 v[128:131], a[164:167], a[8:11], v[128:131]
    s_waitcnt vmcnt(5)
    ds_read_b64_tr_b16 a[186:187], v15 offset:36864
    v_mfma_f32_16x16x32_bf16 v[132:135], a[160:163], a[4:7], 0
    s_waitcnt vmcnt(4)
    ds_read_b64_tr_b16 a[188:189], v15 offset:40960
    v_mfma_f32_16x16x32_bf16 v[132:135], a[164:167], a[12:15], v[132:135]
    s_waitcnt lgkmcnt(9)
    buffer_load_dwordx4 a[32:35], v51, s[24:27], s46 offen offset:512 sc1
    v_mfma_f32_16x16x32_bf16 v[136:139], a[168:171], a[0:3], 0
    s_waitcnt lgkmcnt(7)
    ds_read_b64_tr_b16 a[190:191], v15 offset:45056
    ds_read_b64_tr_b16 a[160:161], v16 offset:32768
    v_mfma_f32_16x16x32_bf16 v[136:139], a[172:175], a[8:11], v[136:139]
    ds_read_b64_tr_b16 a[162:163], v16 offset:36864
    v_mfma_f32_16x16x32_bf16 v[140:143], a[168:171], a[4:7], 0
    ds_read_b64_tr_b16 a[164:165], v16 offset:40960
    v_mfma_f32_16x16x32_bf16 v[140:143], a[172:175], a[12:15], v[140:143]
    s_waitcnt lgkmcnt(9)
    buffer_load_dwordx4 a[40:43], v51, s[24:27], s46 offen offset:640 sc1
    v_mfma_f32_16x16x32_bf16 v[144:147], a[176:179], a[0:3], 0
    s_waitcnt lgkmcnt(7)
    ds_read_b64_tr_b16 a[166:167], v16 offset:45056
    ds_read_b64_tr_b16 a[168:169], v17 offset:32768
    v_mfma_f32_16x16x32_bf16 v[144:147], a[180:183], a[8:11], v[144:147]
    ds_read_b64_tr_b16 a[170:171], v17 offset:36864
    v_mfma_f32_16x16x32_bf16 v[148:151], a[176:179], a[4:7], 0
    ds_read_b64_tr_b16 a[172:173], v17 offset:40960
    v_mfma_f32_16x16x32_bf16 v[148:151], a[180:183], a[12:15], v[148:151]
    s_waitcnt lgkmcnt(9)
    buffer_load_dwordx4 a[36:39], v51, s[24:27], s43 offen offset:512 sc1
    v_mfma_f32_16x16x32_bf16 v[152:155], a[184:187], a[0:3], 0
    s_waitcnt lgkmcnt(7)
    ds_read_b64_tr_b16 a[174:175], v17 offset:45056
    ds_read_b64_tr_b16 a[176:177], v18 offset:32768
    v_mfma_f32_16x16x32_bf16 v[152:155], a[188:191], a[8:11], v[152:155]
    ds_read_b64_tr_b16 a[178:179], v18 offset:36864
    v_mfma_f32_16x16x32_bf16 v[156:159], a[184:187], a[4:7], 0
    ds_read_b64_tr_b16 a[180:181], v18 offset:40960
    v_mfma_f32_16x16x32_bf16 v[156:159], a[188:191], a[12:15], v[156:159]
    s_waitcnt lgkmcnt(9)
    buffer_load_dwordx4 a[44:47], v51, s[24:27], s43 offen offset:640 sc1
    v_mfma_f32_16x16x32_bf16 v[160:163], a[160:163], a[0:3], 0
    s_waitcnt lgkmcnt(7)
    ds_read_b64_tr_b16 a[182:183], v18 offset:45056
    ds_read_b64_tr_b16 a[184:185], v19 offset:32768
    v_mfma_f32_16x16x32_bf16 v[160:163], a[164:167], a[8:11], v[160:163]
    ds_read_b64_tr_b16 a[186:187], v19 offset:36864
    v_mfma_f32_16x16x32_bf16 v[164:167], a[160:163], a[4:7], 0
    ds_read_b64_tr_b16 a[188:189], v19 offset:40960
    v_mfma_f32_16x16x32_bf16 v[164:167], a[164:167], a[12:15], v[164:167]
    s_waitcnt lgkmcnt(9)
    buffer_load_dword v77, v70, s[16:19], s44 offen
    v_mfma_f32_16x16x32_bf16 v[168:171], a[168:171], a[0:3], 0
    s_waitcnt lgkmcnt(7)
    ds_read_b64_tr_b16 a[190:191], v19 offset:45056
    ds_read_b64_tr_b16 a[160:161], v12 offset:49152
    v_mfma_f32_16x16x32_bf16 v[168:171], a[172:175], a[8:11], v[168:171]
    ds_read_b64_tr_b16 a[162:163], v12 offset:53248
    v_mfma_f32_16x16x32_bf16 v[172:175], a[168:171], a[4:7], 0
    ds_read_b64_tr_b16 a[164:165], v12 offset:57344
    v_mfma_f32_16x16x32_bf16 v[172:175], a[172:175], a[12:15], v[172:175]
    s_waitcnt lgkmcnt(9)
    ds_read_b64_tr_b16 a[166:167], v12 offset:61440
    v_mfma_f32_16x16x32_bf16 v[176:179], a[176:179], a[0:3], 0
    s_waitcnt lgkmcnt(8)
    ds_read_b64_tr_b16 a[168:169], v13 offset:49152
    v_mfma_f32_16x16x32_bf16 v[176:179], a[180:183], a[8:11], v[176:179]
    ds_read_b64_tr_b16 a[170:171], v13 offset:53248
    v_mfma_f32_16x16x32_bf16 v[180:183], a[176:179], a[4:7], 0
    ds_read_b64_tr_b16 a[172:173], v13 offset:57344
    v_mfma_f32_16x16x32_bf16 v[180:183], a[180:183], a[12:15], v[180:183]
    s_waitcnt lgkmcnt(9)
    ds_read_b64_tr_b16 a[174:175], v13 offset:61440
    v_mfma_f32_16x16x32_bf16 v[184:187], a[184:187], a[0:3], 0
    s_waitcnt lgkmcnt(8)
    ds_read_b64_tr_b16 a[176:177], v14 offset:49152
    v_mfma_f32_16x16x32_bf16 v[184:187], a[188:191], a[8:11], v[184:187]
    ds_read_b64_tr_b16 a[178:179], v14 offset:53248
    v_mfma_f32_16x16x32_bf16 v[188:191], a[184:187], a[4:7], 0
    ds_read_b64_tr_b16 a[180:181], v14 offset:57344
    v_mfma_f32_16x16x32_bf16 v[188:191], a[188:191], a[12:15], v[188:191]
    s_waitcnt lgkmcnt(9)
    ds_read_b64_tr_b16 a[182:183], v14 offset:61440
    v_mfma_f32_16x16x32_bf16 v[192:195], a[160:163], a[0:3], 0
    s_waitcnt lgkmcnt(8)
    ds_read_b64_tr_b16 a[184:185], v15 offset:49152
    v_mfma_f32_16x16x32_bf16 v[192:195], a[164:167], a[8:11], v[192:195]
    ds_read_b64_tr_b16 a[186:187], v15 offset:53248
    v_mfma_f32_16x16x32_bf16 v[196:199], a[160:163], a[4:7], 0
    ds_read_b64_tr_b16 a[188:189], v15 offset:57344
    v_mfma_f32_16x16x32_bf16 v[196:199], a[164:167], a[12:15], v[196:199]
    s_waitcnt lgkmcnt(9)
    ds_read_b64_tr_b16 a[190:191], v15 offset:61440
    v_mfma_f32_16x16x32_bf16 v[200:203], a[168:171], a[0:3], 0
    s_waitcnt lgkmcnt(8)
    ds_read_b64_tr_b16 a[160:161], v16 offset:49152
    v_mfma_f32_16x16x32_bf16 v[200:203], a[172:175], a[8:11], v[200:203]
    ds_read_b64_tr_b16 a[162:163], v16 offset:53248
    v_mfma_f32_16x16x32_bf16 v[204:207], a[168:171], a[4:7], 0
    ds_read_b64_tr_b16 a[164:165], v16 offset:57344
    v_mfma_f32_16x16x32_bf16 v[204:207], a[172:175], a[12:15], v[204:207]
    s_waitcnt lgkmcnt(9)
    ds_read_b64_tr_b16 a[166:167], v16 offset:61440
    v_mfma_f32_16x16x32_bf16 v[208:211], a[176:179], a[0:3], 0
    s_waitcnt lgkmcnt(8)
    ds_read_b64_tr_b16 a[168:169], v17 offset:49152
    v_mfma_f32_16x16x32_bf16 v[208:211], a[180:183], a[8:11], v[208:211]
    ds_read_b64_tr_b16 a[170:171], v17 offset:53248
    v_mfma_f32_16x16x32_bf16 v[212:215], a[176:179], a[4:7], 0
    ds_read_b64_tr_b16 a[172:173], v17 offset:57344
    v_mfma_f32_16x16x32_bf16 v[212:215], a[180:183], a[12:15], v[212:215]
    s_waitcnt lgkmcnt(9)
    ds_read_b64_tr_b16 a[174:175], v17 offset:61440
    v_mfma_f32_16x16x32_bf16 v[216:219], a[184:187], a[0:3], 0
    s_waitcnt lgkmcnt(8)
    ds_read_b64_tr_b16 a[176:177], v18 offset:49152
    v_mfma_f32_16x16x32_bf16 v[216:219], a[188:191], a[8:11], v[216:219]
    ds_read_b64_tr_b16 a[178:179], v18 offset:53248
    v_mfma_f32_16x16x32_bf16 v[220:223], a[184:187], a[4:7], 0
    ds_read_b64_tr_b16 a[180:181], v18 offset:57344
    v_mfma_f32_16x16x32_bf16 v[220:223], a[188:191], a[12:15], v[220:223]
    s_waitcnt lgkmcnt(9)
    ds_read_b64_tr_b16 a[182:183], v18 offset:61440
    v_mfma_f32_16x16x32_bf16 v[224:227], a[160:163], a[0:3], 0
    s_waitcnt lgkmcnt(8)
    ds_read_b64_tr_b16 a[184:185], v19 offset:49152
    v_mfma_f32_16x16x32_bf16 v[224:227], a[164:167], a[8:11], v[224:227]
Ltour0:
    s_cbranch_execz Ltour4
    ds_read_b64_tr_b16 a[186:187], v19 offset:53248
    v_mfma_f32_16x16x32_bf16 v[228:231], a[160:163], a[4:7], 0
    ds_read_b64_tr_b16 a[188:189], v19 offset:57344
    v_mfma_f32_16x16x32_bf16 v[228:231], a[164:167], a[12:15], v[228:231]
    s_waitcnt lgkmcnt(9)
    ds_read_b64_tr_b16 a[190:191], v19 offset:61440
    s_barrier
    v_mfma_f32_16x16x32_bf16 v[232:235], a[168:171], a[0:3], 0
    s_waitcnt lgkmcnt(8)
    ds_read_b64_tr_b16 a[160:161], v20 offset:0
    v_mfma_f32_16x16x32_bf16 v[232:235], a[172:175], a[8:11], v[232:235]
    s_add_u32 s49, s44, 1572864
    ds_read_b64_tr_b16 a[162:163], v20 offset:4096
    v_mfma_f32_16x16x32_bf16 v[236:239], a[168:171], a[4:7], 0
    s_add_u32 m0, s42, 131072
    ds_read_b64_tr_b16 a[164:165], v20 offset:8192
    v_mfma_f32_16x16x32_bf16 v[236:239], a[172:175], a[12:15], v[236:239]
    s_waitcnt lgkmcnt(9)
    buffer_load_dwordx4 v42, s[16:19], s49 offen lds
    v_mfma_f32_16x16x32_bf16 v[240:243], a[176:179], a[0:3], 0
    s_waitcnt lgkmcnt(7)
    ds_read_b64_tr_b16 a[166:167], v20 offset:12288
    ds_read_b64_tr_b16 a[168:169], v21 offset:0
    v_mfma_f32_16x16x32_bf16 v[240:243], a[180:183], a[8:11], v[240:243]
    ds_read_b64_tr_b16 a[170:171], v21 offset:4096
    v_mfma_f32_16x16x32_bf16 v[244:247], a[176:179], a[4:7], 0
    ds_read_b64_tr_b16 a[172:173], v21 offset:8192
    v_mfma_f32_16x16x32_bf16 v[244:247], a[180:183], a[12:15], v[244:247]
    s_waitcnt lgkmcnt(9)
    buffer_load_dwordx4 v43, s[16:19], s49 offen offset:1024 lds
    v_mfma_f32_16x16x32_bf16 v[248:251], a[184:187], a[0:3], 0
    s_waitcnt lgkmcnt(7)
    ds_read_b64_tr_b16 a[174:175], v21 offset:12288
    ds_read_b64_tr_b16 a[176:177], v22 offset:0
    v_mfma_f32_16x16x32_bf16 v[248:251], a[188:191], a[8:11], v[248:251]
    ds_read_b64_tr_b16 a[178:179], v22 offset:4096
    v_mfma_f32_16x16x32_bf16 v[252:255], a[184:187], a[4:7], 0
    ds_read_b64_tr_b16 a[180:181], v22 offset:8192
    v_mfma_f32_16x16x32_bf16 v[252:255], a[188:191], a[12:15], v[252:255]
    s_waitcnt vmcnt(10)
    s_waitcnt lgkmcnt(9)
    buffer_load_dwordx4 v44, s[16:19], s49 offen offset:2048 lds
    v_mfma_f32_16x16x32_bf16 v[128:131], a[160:163], a[16:19], v[128:131]
    s_waitcnt vmcnt(10)
    s_waitcnt lgkmcnt(7)
    ds_read_b64_tr_b16 a[182:183], v22 offset:12288
    ds_read_b64_tr_b16 a[184:185], v23 offset:0
    v_mfma_f32_16x16x32_bf16 v[128:131], a[164:167], a[24:27], v[128:131]
    s_waitcnt vmcnt(9)
    ds_read_b64_tr_b16 a[186:187], v23 offset:4096
    v_mfma_f32_16x16x32_bf16 v[132:135], a[160:163], a[20:23], v[132:135]
    s_waitcnt vmcnt(8)
    ds_read_b64_tr_b16 a[188:189], v23 offset:8192
    v_mfma_f32_16x16x32_bf16 v[132:135], a[164:167], a[28:31], v[132:135]
    s_waitcnt lgkmcnt(9)
    buffer_load_dwordx4 v45, s[16:19], s49 offen offset:3072 lds
    v_mfma_f32_16x16x32_bf16 v[136:139], a[168:171], a[16:19], v[136:139]
    s_waitcnt lgkmcnt(7)
    ds_read_b64_tr_b16 a[190:191], v23 offset:12288
    ds_read_b64_tr_b16 a[160:161], v24 offset:0
    v_mfma_f32_16x16x32_bf16 v[136:139], a[172:175], a[24:27], v[136:139]
    s_add_u32 s49, s44, 1573120
    ds_read_b64_tr_b16 a[162:163], v24 offset:4096
    v_mfma_f32_16x16x32_bf16 v[140:143], a[168:171], a[20:23], v[140:143]
    s_add_u32 m0, s42, 147456
    ds_read_b64_tr_b16 a[164:165], v24 offset:8192
    v_mfma_f32_16x16x32_bf16 v[140:143], a[172:175], a[28:31], v[140:143]
    s_waitcnt lgkmcnt(9)
    buffer_load_dwordx4 v42, s[16:19], s49 offen lds
    v_mfma_f32_16x16x32_bf16 v[144:147], a[176:179], a[16:19], v[144:147]
    s_waitcnt lgkmcnt(7)
    ds_read_b64_tr_b16 a[166:167], v24 offset:12288
    ds_read_b64_tr_b16 a[168:169], v25 offset:0
    v_mfma_f32_16x16x32_bf16 v[144:147], a[180:183], a[24:27], v[144:147]
    ds_read_b64_tr_b16 a[170:171], v25 offset:4096
    v_mfma_f32_16x16x32_bf16 v[148:151], a[176:179], a[20:23], v[148:151]
    ds_read_b64_tr_b16 a[172:173], v25 offset:8192
    v_mfma_f32_16x16x32_bf16 v[148:151], a[180:183], a[28:31], v[148:151]
    s_waitcnt lgkmcnt(9)
    buffer_load_dwordx4 v43, s[16:19], s49 offen offset:1024 lds
    v_mfma_f32_16x16x32_bf16 v[152:155], a[184:187], a[16:19], v[152:155]
    s_waitcnt lgkmcnt(7)
    ds_read_b64_tr_b16 a[174:175], v25 offset:12288
    ds_read_b64_tr_b16 a[176:177], v26 offset:0
    v_mfma_f32_16x16x32_bf16 v[152:155], a[188:191], a[24:27], v[152:155]
    ds_read_b64_tr_b16 a[178:179], v26 offset:4096
    v_mfma_f32_16x16x32_bf16 v[156:159], a[184:187], a[20:23], v[156:159]
    ds_read_b64_tr_b16 a[180:181], v26 offset:8192
    v_mfma_f32_16x16x32_bf16 v[156:159], a[188:191], a[28:31], v[156:159]
    s_waitcnt lgkmcnt(9)
    buffer_load_dwordx4 v44, s[16:19], s49 offen offset:2048 lds
    v_mfma_f32_16x16x32_bf16 v[160:163], a[160:163], a[16:19], v[160:163]
    s_waitcnt lgkmcnt(7)
    ds_read_b64_tr_b16 a[182:183], v26 offset:12288
    ds_read_b64_tr_b16 a[184:185], v27 offset:0
    v_mfma_f32_16x16x32_bf16 v[160:163], a[164:167], a[24:27], v[160:163]
    ds_read_b64_tr_b16 a[186:187], v27 offset:4096
    v_mfma_f32_16x16x32_bf16 v[164:167], a[160:163], a[20:23], v[164:167]
    ds_read_b64_tr_b16 a[188:189], v27 offset:8192
    v_mfma_f32_16x16x32_bf16 v[164:167], a[164:167], a[28:31], v[164:167]
    s_waitcnt lgkmcnt(9)
    buffer_load_dwordx4 v45, s[16:19], s49 offen offset:3072 lds
    v_mfma_f32_16x16x32_bf16 v[168:171], a[168:171], a[16:19], v[168:171]
    s_waitcnt lgkmcnt(7)
    ds_read_b64_tr_b16 a[190:191], v27 offset:12288
    ds_read_b64_tr_b16 a[160:161], v20 offset:16384
    v_mfma_f32_16x16x32_bf16 v[168:171], a[172:175], a[24:27], v[168:171]
    ds_read_b64_tr_b16 a[162:163], v20 offset:20480
    v_mfma_f32_16x16x32_bf16 v[172:175], a[168:171], a[20:23], v[172:175]
    ds_read_b64_tr_b16 a[164:165], v20 offset:24576
    v_mfma_f32_16x16x32_bf16 v[172:175], a[172:175], a[28:31], v[172:175]
    s_waitcnt lgkmcnt(9)
    buffer_load_dwordx4 a[48:51], v51, s[24:27], s46 offen offset:768 sc1
    v_mfma_f32_16x16x32_bf16 v[176:179], a[176:179], a[16:19], v[176:179]
    s_waitcnt lgkmcnt(7)
    ds_read_b64_tr_b16 a[166:167], v20 offset:28672
    ds_read_b64_tr_b16 a[168:169], v21 offset:16384
    v_mfma_f32_16x16x32_bf16 v[176:179], a[180:183], a[24:27], v[176:179]
    ds_read_b64_tr_b16 a[170:171], v21 offset:20480
    v_mfma_f32_16x16x32_bf16 v[180:183], a[176:179], a[20:23], v[180:183]
    ds_read_b64_tr_b16 a[172:173], v21 offset:24576
    v_mfma_f32_16x16x32_bf16 v[180:183], a[180:183], a[28:31], v[180:183]
    s_waitcnt lgkmcnt(9)
    buffer_load_dwordx4 a[56:59], v51, s[24:27], s46 offen offset:896 sc1
    v_mfma_f32_16x16x32_bf16 v[184:187], a[184:187], a[16:19], v[184:187]
    s_waitcnt lgkmcnt(7)
    ds_read_b64_tr_b16 a[174:175], v21 offset:28672
    ds_read_b64_tr_b16 a[176:177], v22 offset:16384
    v_mfma_f32_16x16x32_bf16 v[184:187], a[188:191], a[24:27], v[184:187]
    ds_read_b64_tr_b16 a[178:179], v22 offset:20480
    v_mfma_f32_16x16x32_bf16 v[188:191], a[184:187], a[20:23], v[188:191]
    ds_read_b64_tr_b16 a[180:181], v22 offset:24576
    v_mfma_f32_16x16x32_bf16 v[188:191], a[188:191], a[28:31], v[188:191]
    s_waitcnt lgkmcnt(9)
    buffer_load_dwordx4 a[52:55], v51, s[24:27], s43 offen offset:768 sc1
    v_mfma_f32_16x16x32_bf16 v[192:195], a[160:163], a[16:19], v[192:195]
    s_waitcnt lgkmcnt(7)
    ds_read_b64_tr_b16 a[182:183], v22 offset:28672
    ds_read_b64_tr_b16 a[184:185], v23 offset:16384
    v_mfma_f32_16x16x32_bf16 v[192:195], a[164:167], a[24:27], v[192:195]
    ds_read_b64_tr_b16 a[186:187], v23 offset:20480
    v_mfma_f32_16x16x32_bf16 v[196:199], a[160:163], a[20:23], v[196:199]
    ds_read_b64_tr_b16 a[188:189], v23 offset:24576
    v_mfma_f32_16x16x32_bf16 v[196:199], a[164:167], a[28:31], v[196:199]
    s_waitcnt lgkmcnt(9)
    buffer_load_dwordx4 a[60:63], v51, s[24:27], s43 offen offset:896 sc1
    v_mfma_f32_16x16x32_bf16 v[200:203], a[168:171], a[16:19], v[200:203]
    s_waitcnt lgkmcnt(7)
    ds_read_b64_tr_b16 a[190:191], v23 offset:28672
    ds_read_b64_tr_b16 a[160:161], v24 offset:16384
    v_mfma_f32_16x16x32_bf16 v[200:203], a[172:175], a[24:27], v[200:203]
    ds_read_b64_tr_b16 a[162:163], v24 offset:20480
    v_mfma_f32_16x16x32_bf16 v[204:207], a[168:171], a[20:23], v[204:207]
    ds_read_b64_tr_b16 a[164:165], v24 offset:24576
    v_mfma_f32_16x16x32_bf16 v[204:207], a[172:175], a[28:31], v[204:207]
    s_waitcnt lgkmcnt(9)
    ds_read_b64_tr_b16 a[166:167], v24 offset:28672
    v_mfma_f32_16x16x32_bf16 v[208:211], a[176:179], a[16:19], v[208:211]
    s_waitcnt lgkmcnt(8)
    ds_read_b64_tr_b16 a[168:169], v25 offset:16384
    v_mfma_f32_16x16x32_bf16 v[208:211], a[180:183], a[24:27], v[208:211]
    ds_read_b64_tr_b16 a[170:171], v25 offset:20480
    v_mfma_f32_16x16x32_bf16 v[212:215], a[176:179], a[20:23], v[212:215]
    ds_read_b64_tr_b16 a[172:173], v25 offset:24576
    v_mfma_f32_16x16x32_bf16 v[212:215], a[180:183], a[28:31], v[212:215]
    s_waitcnt lgkmcnt(9)
    ds_read_b64_tr_b16 a[174:175], v25 offset:28672
    v_mfma_f32_16x16x32_bf16 v[216:219], a[184:187], a[16:19], v[216:219]
    s_waitcnt lgkmcnt(8)
    ds_read_b64_tr_b16 a[176:177], v26 offset:16384
    v_mfma_f32_16x16x32_bf16 v[216:219], a[188:191], a[24:27], v[216:219]
    ds_read_b64_tr_b16 a[178:179], v26 offset:20480
    v_mfma_f32_16x16x32_bf16 v[220:223], a[184:187], a[20:23], v[220:223]
    ds_read_b64_tr_b16 a[180:181], v26 offset:24576
    v_mfma_f32_16x16x32_bf16 v[220:223], a[188:191], a[28:31], v[220:223]
    s_waitcnt lgkmcnt(9)
    ds_read_b64_tr_b16 a[182:183], v26 offset:28672
    v_mfma_f32_16x16x32_bf16 v[224:227], a[160:163], a[16:19], v[224:227]
    s_waitcnt lgkmcnt(8)
    ds_read_b64_tr_b16 a[184:185], v27 offset:16384
    v_mfma_f32_16x16x32_bf16 v[224:227], a[164:167], a[24:27], v[224:227]
    ds_read_b64_tr_b16 a[186:187], v27 offset:20480
    v_mfma_f32_16x16x32_bf16 v[228:231], a[160:163], a[20:23], v[228:231]
    ds_read_b64_tr_b16 a[188:189], v27 offset:24576
    v_mfma_f32_16x16x32_bf16 v[228:231], a[164:167], a[28:31], v[228:231]
    s_waitcnt lgkmcnt(9)
    ds_read_b64_tr_b16 a[190:191], v27 offset:28672
    s_barrier
    v_mfma_f32_16x16x32_bf16 v[232:235], a[168:171], a[16:19], v[232:235]
    s_waitcnt lgkmcnt(8)
    ds_read_b64_tr_b16 a[160:161], v20 offset:32768
    v_mfma_f32_16x16x32_bf16 v[232:235], a[172:175], a[24:27], v[232:235]
    s_add_u32 s49, s44, 2097152
    ds_read_b64_tr_b16 a[162:163], v20 offset:36864
    v_mfma_f32_16x16x32_bf16 v[236:239], a[168:171], a[20:23], v[236:239]
    s_add_u32 m0, s42, 0
    ds_read_b64_tr_b16 a[164:165], v20 offset:40960
    v_mfma_f32_16x16x32_bf16 v[236:239], a[172:175], a[28:31], v[236:239]
    s_waitcnt lgkmcnt(9)
    buffer_load_dwordx4 v42, s[16:19], s49 offen lds
    v_mfma_f32_16x16x32_bf16 v[240:243], a[176:179], a[16:19], v[240:243]
    s_waitcnt lgkmcnt(7)
    ds_read_b64_tr_b16 a[166:167], v20 offset:45056
    ds_read_b64_tr_b16 a[168:169], v21 offset:32768
    v_mfma_f32_16x16x32_bf16 v[240:243], a[180:183], a[24:27], v[240:243]
    ds_read_b64_tr_b16 a[170:171], v21 offset:36864
    v_mfma_f32_16x16x32_bf16 v[244:247], a[176:179], a[20:23], v[244:247]
    ds_read_b64_tr_b16 a[172:173], v21 offset:40960
    v_mfma_f32_16x16x32_bf16 v[244:247], a[180:183], a[28:31], v[244:247]
    s_waitcnt lgkmcnt(9)
    buffer_load_dwordx4 v43, s[16:19], s49 offen offset:1024 lds
    v_mfma_f32_16x16x32_bf16 v[248:251], a[184:187], a[16:19], v[248:251]
    s_waitcnt lgkmcnt(7)
    ds_read_b64_tr_b16 a[174:175], v21 offset:45056
    ds_read_b64_tr_b16 a[176:177], v22 offset:32768
    v_mfma_f32_16x16x32_bf16 v[248:251], a[188:191], a[24:27], v[248:251]
    ds_read_b64_tr_b16 a[178:179], v22 offset:36864
    v_mfma_f32_16x16x32_bf16 v[252:255], a[184:187], a[20:23], v[252:255]
    ds_read_b64_tr_b16 a[180:181], v22 offset:40960
    v_mfma_f32_16x16x32_bf16 v[252:255], a[188:191], a[28:31], v[252:255]
    s_waitcnt vmcnt(18)
    s_waitcnt lgkmcnt(9)
    buffer_load_dwordx4 v44, s[16:19], s49 offen offset:2048 lds
    v_mfma_f32_16x16x32_bf16 v[128:131], a[160:163], a[32:35], v[128:131]
    s_waitcnt vmcnt(18)
    s_waitcnt lgkmcnt(7)
    ds_read_b64_tr_b16 a[182:183], v22 offset:45056
    ds_read_b64_tr_b16 a[184:185], v23 offset:32768
    v_mfma_f32_16x16x32_bf16 v[128:131], a[164:167], a[40:43], v[128:131]
    s_waitcnt vmcnt(17)
    ds_read_b64_tr_b16 a[186:187], v23 offset:36864
    v_mfma_f32_16x16x32_bf16 v[132:135], a[160:163], a[36:39], v[132:135]
    s_waitcnt vmcnt(16)
    ds_read_b64_tr_b16 a[188:189], v23 offset:40960
    v_mfma_f32_16x16x32_bf16 v[132:135], a[164:167], a[44:47], v[132:135]
    s_waitcnt lgkmcnt(9)
    buffer_load_dwordx4 v45, s[16:19], s49 offen offset:3072 lds
    v_mfma_f32_16x16x32_bf16 v[136:139], a[168:171], a[32:35], v[136:139]
    s_waitcnt lgkmcnt(7)
    ds_read_b64_tr_b16 a[190:191], v23 offset:45056
    ds_read_b64_tr_b16 a[160:161], v24 offset:32768
    v_mfma_f32_16x16x32_bf16 v[136:139], a[172:175], a[40:43], v[136:139]
    s_add_u32 s49, s44, 2097408
    ds_read_b64_tr_b16 a[162:163], v24 offset:36864
    v_mfma_f32_16x16x32_bf16 v[140:143], a[168:171], a[36:39], v[140:143]
    s_add_u32 m0, s42, 16384
    ds_read_b64_tr_b16 a[164:165], v24 offset:40960
    v_mfma_f32_16x16x32_bf16 v[140:143], a[172:175], a[44:47], v[140:143]
    s_waitcnt lgkmcnt(9)
    buffer_load_dwordx4 v42, s[16:19], s49 offen lds
    v_mfma_f32_16x16x32_bf16 v[144:147], a[176:179], a[32:35], v[144:147]
    s_waitcnt lgkmcnt(7)
    ds_read_b64_tr_b16 a[166:167], v24 offset:45056
    ds_read_b64_tr_b16 a[168:169], v25 offset:32768
    v_mfma_f32_16x16x32_bf16 v[144:147], a[180:183], a[40:43], v[144:147]
    ds_read_b64_tr_b16 a[170:171], v25 offset:36864
    v_mfma_f32_16x16x32_bf16 v[148:151], a[176:179], a[36:39], v[148:151]
    ds_read_b64_tr_b16 a[172:173], v25 offset:40960
    v_mfma_f32_16x16x32_bf16 v[148:151], a[180:183], a[44:47], v[148:151]
    s_waitcnt lgkmcnt(9)
    buffer_load_dwordx4 v43, s[16:19], s49 offen offset:1024 lds
    v_mfma_f32_16x16x32_bf16 v[152:155], a[184:187], a[32:35], v[152:155]
    s_waitcnt lgkmcnt(7)
    ds_read_b64_tr_b16 a[174:175], v25 offset:45056
    ds_read_b64_tr_b16 a[176:177], v26 offset:32768
    v_mfma_f32_16x16x32_bf16 v[152:155], a[188:191], a[40:43], v[152:155]
    ds_read_b64_tr_b16 a[178:179], v26 offset:36864
    v_mfma_f32_16x16x32_bf16 v[156:159], a[184:187], a[36:39], v[156:159]
    ds_read_b64_tr_b16 a[180:181], v26 offset:40960
    v_mfma_f32_16x16x32_bf16 v[156:159], a[188:191], a[44:47], v[156:159]
    s_waitcnt lgkmcnt(9)
    buffer_load_dwordx4 v44, s[16:19], s49 offen offset:2048 lds
    v_mfma_f32_16x16x32_bf16 v[160:163], a[160:163], a[32:35], v[160:163]
    s_waitcnt lgkmcnt(7)
    ds_read_b64_tr_b16 a[182:183], v26 offset:45056
    ds_read_b64_tr_b16 a[184:185], v27 offset:32768
    v_mfma_f32_16x16x32_bf16 v[160:163], a[164:167], a[40:43], v[160:163]
    ds_read_b64_tr_b16 a[186:187], v27 offset:36864
    v_mfma_f32_16x16x32_bf16 v[164:167], a[160:163], a[36:39], v[164:167]
    ds_read_b64_tr_b16 a[188:189], v27 offset:40960
    v_mfma_f32_16x16x32_bf16 v[164:167], a[164:167], a[44:47], v[164:167]
    s_waitcnt lgkmcnt(9)
    buffer_load_dwordx4 v45, s[16:19], s49 offen offset:3072 lds
    v_mfma_f32_16x16x32_bf16 v[168:171], a[168:171], a[32:35], v[168:171]
    s_waitcnt lgkmcnt(7)
    ds_read_b64_tr_b16 a[190:191], v27 offset:45056
    ds_read_b64_tr_b16 a[160:161], v20 offset:49152
    v_mfma_f32_16x16x32_bf16 v[168:171], a[172:175], a[40:43], v[168:171]
    ds_read_b64_tr_b16 a[162:163], v20 offset:53248
    v_mfma_f32_16x16x32_bf16 v[172:175], a[168:171], a[36:39], v[172:175]
    ds_read_b64_tr_b16 a[164:165], v20 offset:57344
    v_mfma_f32_16x16x32_bf16 v[172:175], a[172:175], a[44:47], v[172:175]
    s_waitcnt lgkmcnt(9)
    buffer_load_dwordx4 a[64:67], v51, s[24:27], s46 offen offset:1024 sc1
    v_mfma_f32_16x16x32_bf16 v[176:179], a[176:179], a[32:35], v[176:179]
    s_waitcnt lgkmcnt(7)
    ds_read_b64_tr_b16 a[166:167], v20 offset:61440
    ds_read_b64_tr_b16 a[168:169], v21 offset:49152
    v_mfma_f32_16x16x32_bf16 v[176:179], a[180:183], a[40:43], v[176:179]
    ds_read_b64_tr_b16 a[170:171], v21 offset:53248
    v_mfma_f32_16x16x32_bf16 v[180:183], a[176:179], a[36:39], v[180:183]
    ds_read_b64_tr_b16 a[172:173], v21 offset:57344
    v_mfma_f32_16x16x32_bf16 v[180:183], a[180:183], a[44:47], v[180:183]
    s_waitcnt lgkmcnt(9)
    buffer_load_dwordx4 a[72:75], v51, s[24:27], s46 offen offset:1152 sc1
    v_mfma_f32_16x16x32_bf16 v[184:187], a[184:187], a[32:35], v[184:187]
    s_waitcnt lgkmcnt(7)
    ds_read_b64_tr_b16 a[174:175], v21 offset:61440
    ds_read_b64_tr_b16 a[176:177], v22 offset:49152
    v_mfma_f32_16x16x32_bf16 v[184:187], a[188:191], a[40:43], v[184:187]
    ds_read_b64_tr_b16 a[178:179], v22 offset:53248
    v_mfma_f32_16x16x32_bf16 v[188:191], a[184:187], a[36:39], v[188:191]
    ds_read_b64_tr_b16 a[180:181], v22 offset:57344
    v_mfma_f32_16x16x32_bf16 v[188:191], a[188:191], a[44:47], v[188:191]
    s_waitcnt lgkmcnt(9)
    buffer_load_dwordx4 a[68:71], v51, s[24:27], s43 offen offset:1024 sc1
    v_mfma_f32_16x16x32_bf16 v[192:195], a[160:163], a[32:35], v[192:195]
    s_waitcnt lgkmcnt(7)
    ds_read_b64_tr_b16 a[182:183], v22 offset:61440
    ds_read_b64_tr_b16 a[184:185], v23 offset:49152
    v_mfma_f32_16x16x32_bf16 v[192:195], a[164:167], a[40:43], v[192:195]
    ds_read_b64_tr_b16 a[186:187], v23 offset:53248
    v_mfma_f32_16x16x32_bf16 v[196:199], a[160:163], a[36:39], v[196:199]
    ds_read_b64_tr_b16 a[188:189], v23 offset:57344
    v_mfma_f32_16x16x32_bf16 v[196:199], a[164:167], a[44:47], v[196:199]
    s_waitcnt lgkmcnt(9)
    buffer_load_dwordx4 a[76:79], v51, s[24:27], s43 offen offset:1152 sc1
    v_mfma_f32_16x16x32_bf16 v[200:203], a[168:171], a[32:35], v[200:203]
    s_waitcnt lgkmcnt(7)
    ds_read_b64_tr_b16 a[190:191], v23 offset:61440
    ds_read_b64_tr_b16 a[160:161], v24 offset:49152
    v_mfma_f32_16x16x32_bf16 v[200:203], a[172:175], a[40:43], v[200:203]
    ds_read_b64_tr_b16 a[162:163], v24 offset:53248
    v_mfma_f32_16x16x32_bf16 v[204:207], a[168:171], a[36:39], v[204:207]
    ds_read_b64_tr_b16 a[164:165], v24 offset:57344
    v_mfma_f32_16x16x32_bf16 v[204:207], a[172:175], a[44:47], v[204:207]
    s_waitcnt lgkmcnt(9)
    buffer_load_dwordx4 a[80:83], v51, s[24:27], s46 offen offset:1280 sc1
    v_mfma_f32_16x16x32_bf16 v[208:211], a[176:179], a[32:35], v[208:211]
    s_waitcnt lgkmcnt(7)
    ds_read_b64_tr_b16 a[166:167], v24 offset:61440
    ds_read_b64_tr_b16 a[168:169], v25 offset:49152
    v_mfma_f32_16x16x32_bf16 v[208:211], a[180:183], a[40:43], v[208:211]
    ds_read_b64_tr_b16 a[170:171], v25 offset:53248
    v_mfma_f32_16x16x32_bf16 v[212:215], a[176:179], a[36:39], v[212:215]
    ds_read_b64_tr_b16 a[172:173], v25 offset:57344
    v_mfma_f32_16x16x32_bf16 v[212:215], a[180:183], a[44:47], v[212:215]
    s_waitcnt lgkmcnt(9)
    buffer_load_dwordx4 a[88:91], v51, s[24:27], s46 offen offset:1408 sc1
    v_mfma_f32_16x16x32_bf16 v[216:219], a[184:187], a[32:35], v[216:219]
    s_waitcnt lgkmcnt(7)
    ds_read_b64_tr_b16 a[174:175], v25 offset:61440
    ds_read_b64_tr_b16 a[176:177], v26 offset:49152
    v_mfma_f32_16x16x32_bf16 v[216:219], a[188:191], a[40:43], v[216:219]
    ds_read_b64_tr_b16 a[178:179], v26 offset:53248
    v_mfma_f32_16x16x32_bf16 v[220:223], a[184:187], a[36:39], v[220:223]
    ds_read_b64_tr_b16 a[180:181], v26 offset:57344
    v_mfma_f32_16x16x32_bf16 v[220:223], a[188:191], a[44:47], v[220:223]
    s_waitcnt lgkmcnt(9)
    ds_read_b64_tr_b16 a[182:183], v26 offset:61440
    v_mfma_f32_16x16x32_bf16 v[224:227], a[160:163], a[32:35], v[224:227]
    s_waitcnt lgkmcnt(8)
    ds_read_b64_tr_b16 a[184:185], v27 offset:49152
    v_mfma_f32_16x16x32_bf16 v[224:227], a[164:167], a[40:43], v[224:227]
    ds_read_b64_tr_b16 a[186:187], v27 offset:53248
    v_mfma_f32_16x16x32_bf16 v[228:231], a[160:163], a[36:39], v[228:231]
    ds_read_b64_tr_b16 a[188:189], v27 offset:57344
    v_mfma_f32_16x16x32_bf16 v[228:231], a[164:167], a[44:47], v[228:231]
    s_waitcnt lgkmcnt(9)
    ds_read_b64_tr_b16 a[190:191], v27 offset:61440
    s_waitcnt vmcnt(18)
    s_barrier
    v_mfma_f32_16x16x32_bf16 v[232:235], a[168:171], a[32:35], v[232:235]
    s_waitcnt lgkmcnt(8)
    ds_read_b64_tr_b16 a[160:161], v28 offset:0
    v_mfma_f32_16x16x32_bf16 v[232:235], a[172:175], a[40:43], v[232:235]
    s_add_u32 s49, s44, 2621440
    ds_read_b64_tr_b16 a[162:163], v28 offset:4096
    v_mfma_f32_16x16x32_bf16 v[236:239], a[168:171], a[36:39], v[236:239]
    s_add_u32 m0, s42, 32768
    ds_read_b64_tr_b16 a[164:165], v28 offset:8192
    v_mfma_f32_16x16x32_bf16 v[236:239], a[172:175], a[44:47], v[236:239]
    s_waitcnt lgkmcnt(9)
    buffer_load_dwordx4 v42, s[16:19], s49 offen lds
    v_mfma_f32_16x16x32_bf16 v[240:243], a[176:179], a[32:35], v[240:243]
    s_waitcnt lgkmcnt(7)
    ds_read_b64_tr_b16 a[166:167], v28 offset:12288
    ds_read_b64_tr_b16 a[168:169], v29 offset:0
    v_mfma_f32_16x16x32_bf16 v[240:243], a[180:183], a[40:43], v[240:243]
    ds_read_b64_tr_b16 a[170:171], v29 offset:4096
    v_mfma_f32_16x16x32_bf16 v[244:247], a[176:179], a[36:39], v[244:247]
    ds_read_b64_tr_b16 a[172:173], v29 offset:8192
    v_mfma_f32_16x16x32_bf16 v[244:247], a[180:183], a[44:47], v[244:247]
    s_waitcnt lgkmcnt(9)
    buffer_load_dwordx4 v43, s[16:19], s49 offen offset:1024 lds
    v_mfma_f32_16x16x32_bf16 v[248:251], a[184:187], a[32:35], v[248:251]
    s_waitcnt lgkmcnt(7)
    ds_read_b64_tr_b16 a[174:175], v29 offset:12288
    ds_read_b64_tr_b16 a[176:177], v30 offset:0
    v_mfma_f32_16x16x32_bf16 v[248:251], a[188:191], a[40:43], v[248:251]
    ds_read_b64_tr_b16 a[178:179], v30 offset:4096
    v_mfma_f32_16x16x32_bf16 v[252:255], a[184:187], a[36:39], v[252:255]
    ds_read_b64_tr_b16 a[180:181], v30 offset:8192
    v_mfma_f32_16x16x32_bf16 v[252:255], a[188:191], a[44:47], v[252:255]
    s_waitcnt vmcnt(19)
    s_waitcnt lgkmcnt(9)
    buffer_load_dwordx4 v44, s[16:19], s49 offen offset:2048 lds
    v_mfma_f32_16x16x32_bf16 v[128:131], a[160:163], a[48:51], v[128:131]
    s_waitcnt vmcnt(19)
    s_waitcnt lgkmcnt(7)
    ds_read_b64_tr_b16 a[182:183], v30 offset:12288
    ds_read_b64_tr_b16 a[184:185], v31 offset:0
    v_mfma_f32_16x16x32_bf16 v[128:131], a[164:167], a[56:59], v[128:131]
    s_waitcnt vmcnt(18)
    ds_read_b64_tr_b16 a[186:187], v31 offset:4096
    v_mfma_f32_16x16x32_bf16 v[132:135], a[160:163], a[52:55], v[132:135]
    s_waitcnt vmcnt(17)
    ds_read_b64_tr_b16 a[188:189], v31 offset:8192
    v_mfma_f32_16x16x32_bf16 v[132:135], a[164:167], a[60:63], v[132:135]
    s_waitcnt lgkmcnt(9)
    buffer_load_dwordx4 v45, s[16:19], s49 offen offset:3072 lds
    v_mfma_f32_16x16x32_bf16 v[136:139], a[168:171], a[48:51], v[136:139]
    s_waitcnt lgkmcnt(7)
    ds_read_b64_tr_b16 a[190:191], v31 offset:12288
    ds_read_b64_tr_b16 a[160:161], v32 offset:0
    v_mfma_f32_16x16x32_bf16 v[136:139], a[172:175], a[56:59], v[136:139]
    s_add_u32 s49, s44, 3145728
    ds_read_b64_tr_b16 a[162:163], v32 offset:4096
    v_mfma_f32_16x16x32_bf16 v[140:143], a[168:171], a[52:55], v[140:143]
    s_add_u32 m0, s42, 49152
    ds_read_b64_tr_b16 a[164:165], v32 offset:8192
    v_mfma_f32_16x16x32_bf16 v[140:143], a[172:175], a[60:63], v[140:143]
    s_waitcnt lgkmcnt(9)
    buffer_load_dwordx4 v42, s[16:19], s49 offen lds
    v_mfma_f32_16x16x32_bf16 v[144:147], a[176:179], a[48:51], v[144:147]
    s_waitcnt lgkmcnt(7)
    ds_read_b64_tr_b16 a[166:167], v32 offset:12288
    ds_read_b64_tr_b16 a[168:169], v33 offset:0
    v_mfma_f32_16x16x32_bf16 v[144:147], a[180:183], a[56:59], v[144:147]
    ds_read_b64_tr_b16 a[170:171], v33 offset:4096
    v_mfma_f32_16x16x32_bf16 v[148:151], a[176:179], a[52:55], v[148:151]
    ds_read_b64_tr_b16 a[172:173], v33 offset:8192
    v_mfma_f32_16x16x32_bf16 v[148:151], a[180:183], a[60:63], v[148:151]
    s_waitcnt lgkmcnt(9)
    buffer_load_dwordx4 v43, s[16:19], s49 offen offset:1024 lds
    v_mfma_f32_16x16x32_bf16 v[152:155], a[184:187], a[48:51], v[152:155]
    s_waitcnt lgkmcnt(7)
    ds_read_b64_tr_b16 a[174:175], v33 offset:12288
    ds_read_b64_tr_b16 a[176:177], v34 offset:0
    v_mfma_f32_16x16x32_bf16 v[152:155], a[188:191], a[56:59], v[152:155]
    ds_read_b64_tr_b16 a[178:179], v34 offset:4096
    v_mfma_f32_16x16x32_bf16 v[156:159], a[184:187], a[52:55], v[156:159]
    ds_read_b64_tr_b16 a[180:181], v34 offset:8192
    v_mfma_f32_16x16x32_bf16 v[156:159], a[188:191], a[60:63], v[156:159]
    s_waitcnt lgkmcnt(9)
    buffer_load_dwordx4 v44, s[16:19], s49 offen offset:2048 lds
    v_mfma_f32_16x16x32_bf16 v[160:163], a[160:163], a[48:51], v[160:163]
    s_waitcnt lgkmcnt(7)
    ds_read_b64_tr_b16 a[182:183], v34 offset:12288
    ds_read_b64_tr_b16 a[184:185], v35 offset:0
    v_mfma_f32_16x16x32_bf16 v[160:163], a[164:167], a[56:59], v[160:163]
    ds_read_b64_tr_b16 a[186:187], v35 offset:4096
    v_mfma_f32_16x16x32_bf16 v[164:167], a[160:163], a[52:55], v[164:167]
    ds_read_b64_tr_b16 a[188:189], v35 offset:8192
    v_mfma_f32_16x16x32_bf16 v[164:167], a[164:167], a[60:63], v[164:167]
    s_waitcnt lgkmcnt(9)
    buffer_load_dwordx4 v45, s[16:19], s49 offen offset:3072 lds
    v_mfma_f32_16x16x32_bf16 v[168:171], a[168:171], a[48:51], v[168:171]
    s_waitcnt lgkmcnt(7)
    ds_read_b64_tr_b16 a[190:191], v35 offset:12288
    ds_read_b64_tr_b16 a[160:161], v28 offset:16384
    v_mfma_f32_16x16x32_bf16 v[168:171], a[172:175], a[56:59], v[168:171]
    ds_read_b64_tr_b16 a[162:163], v28 offset:20480
    v_mfma_f32_16x16x32_bf16 v[172:175], a[168:171], a[52:55], v[172:175]
    ds_read_b64_tr_b16 a[164:165], v28 offset:24576
    v_mfma_f32_16x16x32_bf16 v[172:175], a[172:175], a[60:63], v[172:175]
    s_waitcnt lgkmcnt(9)
    buffer_load_dwordx4 a[84:87], v51, s[24:27], s43 offen offset:1280 sc1
    v_mfma_f32_16x16x32_bf16 v[176:179], a[176:179], a[48:51], v[176:179]
    s_waitcnt lgkmcnt(7)
    ds_read_b64_tr_b16 a[166:167], v28 offset:28672
    ds_read_b64_tr_b16 a[168:169], v29 offset:16384
    v_mfma_f32_16x16x32_bf16 v[176:179], a[180:183], a[56:59], v[176:179]
    ds_read_b64_tr_b16 a[170:171], v29 offset:20480
    v_mfma_f32_16x16x32_bf16 v[180:183], a[176:179], a[52:55], v[180:183]
    ds_read_b64_tr_b16 a[172:173], v29 offset:24576
    v_mfma_f32_16x16x32_bf16 v[180:183], a[180:183], a[60:63], v[180:183]
    s_waitcnt lgkmcnt(9)
    buffer_load_dwordx4 a[92:95], v51, s[24:27], s43 offen offset:1408 sc1
    v_mfma_f32_16x16x32_bf16 v[184:187], a[184:187], a[48:51], v[184:187]
    s_waitcnt lgkmcnt(7)
    ds_read_b64_tr_b16 a[174:175], v29 offset:28672
    ds_read_b64_tr_b16 a[176:177], v30 offset:16384
    v_mfma_f32_16x16x32_bf16 v[184:187], a[188:191], a[56:59], v[184:187]
    ds_read_b64_tr_b16 a[178:179], v30 offset:20480
    v_mfma_f32_16x16x32_bf16 v[188:191], a[184:187], a[52:55], v[188:191]
    ds_read_b64_tr_b16 a[180:181], v30 offset:24576
    v_mfma_f32_16x16x32_bf16 v[188:191], a[188:191], a[60:63], v[188:191]
    s_waitcnt lgkmcnt(9)
    buffer_load_dwordx4 a[96:99], v51, s[24:27], s46 offen offset:1536 sc1
    v_mfma_f32_16x16x32_bf16 v[192:195], a[160:163], a[48:51], v[192:195]
    s_waitcnt lgkmcnt(7)
    ds_read_b64_tr_b16 a[182:183], v30 offset:28672
    ds_read_b64_tr_b16 a[184:185], v31 offset:16384
    v_mfma_f32_16x16x32_bf16 v[192:195], a[164:167], a[56:59], v[192:195]
    ds_read_b64_tr_b16 a[186:187], v31 offset:20480
    v_mfma_f32_16x16x32_bf16 v[196:199], a[160:163], a[52:55], v[196:199]
    ds_read_b64_tr_b16 a[188:189], v31 offset:24576
    v_mfma_f32_16x16x32_bf16 v[196:199], a[164:167], a[60:63], v[196:199]
    s_waitcnt lgkmcnt(9)
    buffer_load_dwordx4 a[104:107], v51, s[24:27], s46 offen offset:1664 sc1
    v_mfma_f32_16x16x32_bf16 v[200:203], a[168:171], a[48:51], v[200:203]
    s_waitcnt lgkmcnt(7)
    ds_read_b64_tr_b16 a[190:191], v31 offset:28672
    ds_read_b64_tr_b16 a[160:161], v32 offset:16384
    v_mfma_f32_16x16x32_bf16 v[200:203], a[172:175], a[56:59], v[200:203]
    ds_read_b64_tr_b16 a[162:163], v32 offset:20480
    v_mfma_f32_16x16x32_bf16 v[204:207], a[168:171], a[52:55], v[204:207]
    ds_read_b64_tr_b16 a[164:165], v32 offset:24576
    v_mfma_f32_16x16x32_bf16 v[204:207], a[172:175], a[60:63], v[204:207]
    s_waitcnt lgkmcnt(9)
    buffer_load_dwordx4 a[100:103], v51, s[24:27], s43 offen offset:1536 sc1
    v_mfma_f32_16x16x32_bf16 v[208:211], a[176:179], a[48:51], v[208:211]
    s_waitcnt lgkmcnt(7)
    ds_read_b64_tr_b16 a[166:167], v32 offset:28672
    ds_read_b64_tr_b16 a[168:169], v33 offset:16384
    v_mfma_f32_16x16x32_bf16 v[208:211], a[180:183], a[56:59], v[208:211]
    ds_read_b64_tr_b16 a[170:171], v33 offset:20480
    v_mfma_f32_16x16x32_bf16 v[212:215], a[176:179], a[52:55], v[212:215]
    ds_read_b64_tr_b16 a[172:173], v33 offset:24576
    v_mfma_f32_16x16x32_bf16 v[212:215], a[180:183], a[60:63], v[212:215]
    s_waitcnt lgkmcnt(9)
    buffer_load_dwordx4 a[108:111], v51, s[24:27], s43 offen offset:1664 sc1
    v_mfma_f32_16x16x32_bf16 v[216:219], a[184:187], a[48:51], v[216:219]
    s_waitcnt lgkmcnt(7)
    ds_read_b64_tr_b16 a[174:175], v33 offset:28672
    ds_read_b64_tr_b16 a[176:177], v34 offset:16384
    v_mfma_f32_16x16x32_bf16 v[216:219], a[188:191], a[56:59], v[216:219]
    ds_read_b64_tr_b16 a[178:179], v34 offset:20480
    v_mfma_f32_16x16x32_bf16 v[220:223], a[184:187], a[52:55], v[220:223]
    ds_read_b64_tr_b16 a[180:181], v34 offset:24576
    v_mfma_f32_16x16x32_bf16 v[220:223], a[188:191], a[60:63], v[220:223]
    s_waitcnt lgkmcnt(9)
    ds_read_b64_tr_b16 a[182:183], v34 offset:28672
    v_mfma_f32_16x16x32_bf16 v[224:227], a[160:163], a[48:51], v[224:227]
    s_waitcnt lgkmcnt(8)
    ds_read_b64_tr_b16 a[184:185], v35 offset:16384
    v_mfma_f32_16x16x32_bf16 v[224:227], a[164:167], a[56:59], v[224:227]
    ds_read_b64_tr_b16 a[186:187], v35 offset:20480
    v_mfma_f32_16x16x32_bf16 v[228:231], a[160:163], a[52:55], v[228:231]
    ds_read_b64_tr_b16 a[188:189], v35 offset:24576
    v_mfma_f32_16x16x32_bf16 v[228:231], a[164:167], a[60:63], v[228:231]
    s_waitcnt lgkmcnt(9)
    ds_read_b64_tr_b16 a[190:191], v35 offset:28672
    s_waitcnt vmcnt(20)
    s_barrier
    v_mfma_f32_16x16x32_bf16 v[232:235], a[168:171], a[48:51], v[232:235]
    s_waitcnt lgkmcnt(8)
    ds_read_b64_tr_b16 a[160:161], v12 offset:0
    v_mfma_f32_16x16x32_bf16 v[232:235], a[172:175], a[56:59], v[232:235]
    s_add_u32 s49, s44, 3670016
    ds_read_b64_tr_b16 a[162:163], v12 offset:4096
    v_mfma_f32_16x16x32_bf16 v[236:239], a[168:171], a[52:55], v[236:239]
    s_add_u32 m0, s42, 65536
    ds_read_b64_tr_b16 a[164:165], v12 offset:8192
    v_mfma_f32_16x16x32_bf16 v[236:239], a[172:175], a[60:63], v[236:239]
    s_waitcnt lgkmcnt(9)
    buffer_load_dwordx4 v42, s[16:19], s49 offen lds
    v_mfma_f32_16x16x32_bf16 v[240:243], a[176:179], a[48:51], v[240:243]
    s_waitcnt lgkmcnt(7)
    ds_read_b64_tr_b16 a[166:167], v12 offset:12288
    ds_read_b64_tr_b16 a[168:169], v13 offset:0
    v_mfma_f32_16x16x32_bf16 v[240:243], a[180:183], a[56:59], v[240:243]
Ltour1:
    s_cbranch_execz Ltour5
    ds_read_b64_tr_b16 a[170:171], v13 offset:4096
    v_mfma_f32_16x16x32_bf16 v[244:247], a[176:179], a[52:55], v[244:247]
    ds_read_b64_tr_b16 a[172:173], v13 offset:8192
    v_mfma_f32_16x16x32_bf16 v[244:247], a[180:183], a[60:63], v[244:247]
    s_waitcnt lgkmcnt(9)
    buffer_load_dwordx4 v43, s[16:19], s49 offen offset:1024 lds
    v_mfma_f32_16x16x32_bf16 v[248:251], a[184:187], a[48:51], v[248:251]
    s_waitcnt lgkmcnt(7)
    ds_read_b64_tr_b16 a[174:175], v13 offset:12288
    ds_read_b64_tr_b16 a[176:177], v14 offset:0
    v_mfma_f32_16x16x32_bf16 v[248:251], a[188:191], a[56:59], v[248:251]
    ds_read_b64_tr_b16 a[178:179], v14 offset:4096
    v_mfma_f32_16x16x32_bf16 v[252:255], a[184:187], a[52:55], v[252:255]
    ds_read_b64_tr_b16 a[180:181], v14 offset:8192
    v_mfma_f32_16x16x32_bf16 v[252:255], a[188:191], a[60:63], v[252:255]
    s_waitcnt vmcnt(21)
    s_waitcnt lgkmcnt(9)
    buffer_load_dwordx4 v44, s[16:19], s49 offen offset:2048 lds
    v_mfma_f32_16x16x32_bf16 v[128:131], a[160:163], a[64:67], v[128:131]
    s_waitcnt vmcnt(21)
    s_waitcnt lgkmcnt(7)
    ds_read_b64_tr_b16 a[182:183], v14 offset:12288
    ds_read_b64_tr_b16 a[184:185], v15 offset:0
    v_mfma_f32_16x16x32_bf16 v[128:131], a[164:167], a[72:75], v[128:131]
    s_waitcnt vmcnt(20)
    ds_read_b64_tr_b16 a[186:187], v15 offset:4096
    v_mfma_f32_16x16x32_bf16 v[132:135], a[160:163], a[68:71], v[132:135]
    s_waitcnt vmcnt(19)
    ds_read_b64_tr_b16 a[188:189], v15 offset:8192
    v_mfma_f32_16x16x32_bf16 v[132:135], a[164:167], a[76:79], v[132:135]
    s_waitcnt lgkmcnt(9)
    buffer_load_dwordx4 v45, s[16:19], s49 offen offset:3072 lds
    v_mfma_f32_16x16x32_bf16 v[136:139], a[168:171], a[64:67], v[136:139]
    s_waitcnt lgkmcnt(7)
    ds_read_b64_tr_b16 a[190:191], v15 offset:12288
    ds_read_b64_tr_b16 a[160:161], v16 offset:0
    v_mfma_f32_16x16x32_bf16 v[136:139], a[172:175], a[72:75], v[136:139]
    s_add_u32 s49, s44, 4194304
    ds_read_b64_tr_b16 a[162:163], v16 offset:4096
    v_mfma_f32_16x16x32_bf16 v[140:143], a[168:171], a[68:71], v[140:143]
    s_add_u32 m0, s42, 81920
    ds_read_b64_tr_b16 a[164:165], v16 offset:8192
    v_mfma_f32_16x16x32_bf16 v[140:143], a[172:175], a[76:79], v[140:143]
    s_waitcnt lgkmcnt(9)
    buffer_load_dwordx4 v42, s[16:19], s49 offen lds
    v_mfma_f32_16x16x32_bf16 v[144:147], a[176:179], a[64:67], v[144:147]
    s_waitcnt lgkmcnt(7)
    ds_read_b64_tr_b16 a[166:167], v16 offset:12288
    ds_read_b64_tr_b16 a[168:169], v17 offset:0
    v_mfma_f32_16x16x32_bf16 v[144:147], a[180:183], a[72:75], v[144:147]
    ds_read_b64_tr_b16 a[170:171], v17 offset:4096
    v_mfma_f32_16x16x32_bf16 v[148:151], a[176:179], a[68:71], v[148:151]
    ds_read_b64_tr_b16 a[172:173], v17 offset:8192
    v_mfma_f32_16x16x32_bf16 v[148:151], a[180:183], a[76:79], v[148:151]
    s_waitcnt lgkmcnt(9)
    buffer_load_dwordx4 v43, s[16:19], s49 offen offset:1024 lds
    v_mfma_f32_16x16x32_bf16 v[152:155], a[184:187], a[64:67], v[152:155]
    s_waitcnt lgkmcnt(7)
    ds_read_b64_tr_b16 a[174:175], v17 offset:12288
    ds_read_b64_tr_b16 a[176:177], v18 offset:0
    v_mfma_f32_16x16x32_bf16 v[152:155], a[188:191], a[72:75], v[152:155]
    ds_read_b64_tr_b16 a[178:179], v18 offset:4096
    v_mfma_f32_16x16x32_bf16 v[156:159], a[184:187], a[68:71], v[156:159]
    ds_read_b64_tr_b16 a[180:181], v18 offset:8192
    v_mfma_f32_16x16x32_bf16 v[156:159], a[188:191], a[76:79], v[156:159]
    s_waitcnt lgkmcnt(9)
    buffer_load_dwordx4 v44, s[16:19], s49 offen offset:2048 lds
    v_mfma_f32_16x16x32_bf16 v[160:163], a[160:163], a[64:67], v[160:163]
    s_waitcnt lgkmcnt(7)
    ds_read_b64_tr_b16 a[182:183], v18 offset:12288
    ds_read_b64_tr_b16 a[184:185], v19 offset:0
    v_mfma_f32_16x16x32_bf16 v[160:163], a[164:167], a[72:75], v[160:163]
    ds_read_b64_tr_b16 a[186:187], v19 offset:4096
    v_mfma_f32_16x16x32_bf16 v[164:167], a[160:163], a[68:71], v[164:167]
    ds_read_b64_tr_b16 a[188:189], v19 offset:8192
    v_mfma_f32_16x16x32_bf16 v[164:167], a[164:167], a[76:79], v[164:167]
    s_waitcnt lgkmcnt(9)
    buffer_load_dwordx4 v45, s[16:19], s49 offen offset:3072 lds
    v_mfma_f32_16x16x32_bf16 v[168:171], a[168:171], a[64:67], v[168:171]
    s_waitcnt lgkmcnt(7)
    ds_read_b64_tr_b16 a[190:191], v19 offset:12288
    ds_read_b64_tr_b16 a[160:161], v12 offset:16384
    v_mfma_f32_16x16x32_bf16 v[168:171], a[172:175], a[72:75], v[168:171]
    ds_read_b64_tr_b16 a[162:163], v12 offset:20480
    v_mfma_f32_16x16x32_bf16 v[172:175], a[168:171], a[68:71], v[172:175]
    ds_read_b64_tr_b16 a[164:165], v12 offset:24576
    v_mfma_f32_16x16x32_bf16 v[172:175], a[172:175], a[76:79], v[172:175]
    s_waitcnt lgkmcnt(9)
    buffer_load_dwordx4 a[112:115], v51, s[24:27], s46 offen offset:1792 sc1
    v_mfma_f32_16x16x32_bf16 v[176:179], a[176:179], a[64:67], v[176:179]
    s_waitcnt lgkmcnt(7)
    ds_read_b64_tr_b16 a[166:167], v12 offset:28672
    ds_read_b64_tr_b16 a[168:169], v13 offset:16384
    v_mfma_f32_16x16x32_bf16 v[176:179], a[180:183], a[72:75], v[176:179]
    ds_read_b64_tr_b16 a[170:171], v13 offset:20480
    v_mfma_f32_16x16x32_bf16 v[180:183], a[176:179], a[68:71], v[180:183]
    ds_read_b64_tr_b16 a[172:173], v13 offset:24576
    v_mfma_f32_16x16x32_bf16 v[180:183], a[180:183], a[76:79], v[180:183]
    s_waitcnt lgkmcnt(9)
    buffer_load_dwordx4 a[120:123], v51, s[24:27], s46 offen offset:1920 sc1
    v_mfma_f32_16x16x32_bf16 v[184:187], a[184:187], a[64:67], v[184:187]
    s_waitcnt lgkmcnt(7)
    ds_read_b64_tr_b16 a[174:175], v13 offset:28672
    ds_read_b64_tr_b16 a[176:177], v14 offset:16384
    v_mfma_f32_16x16x32_bf16 v[184:187], a[188:191], a[72:75], v[184:187]
    ds_read_b64_tr_b16 a[178:179], v14 offset:20480
    v_mfma_f32_16x16x32_bf16 v[188:191], a[184:187], a[68:71], v[188:191]
    ds_read_b64_tr_b16 a[180:181], v14 offset:24576
    v_mfma_f32_16x16x32_bf16 v[188:191], a[188:191], a[76:79], v[188:191]
    s_waitcnt lgkmcnt(9)
    buffer_load_dwordx4 a[116:119], v51, s[24:27], s43 offen offset:1792 sc1
    v_mfma_f32_16x16x32_bf16 v[192:195], a[160:163], a[64:67], v[192:195]
    s_waitcnt lgkmcnt(7)
    ds_read_b64_tr_b16 a[182:183], v14 offset:28672
    ds_read_b64_tr_b16 a[184:185], v15 offset:16384
    v_mfma_f32_16x16x32_bf16 v[192:195], a[164:167], a[72:75], v[192:195]
    ds_read_b64_tr_b16 a[186:187], v15 offset:20480
    v_mfma_f32_16x16x32_bf16 v[196:199], a[160:163], a[68:71], v[196:199]
    ds_read_b64_tr_b16 a[188:189], v15 offset:24576
    v_mfma_f32_16x16x32_bf16 v[196:199], a[164:167], a[76:79], v[196:199]
    s_waitcnt lgkmcnt(9)
    buffer_load_dwordx4 a[124:127], v51, s[24:27], s43 offen offset:1920 sc1
    v_mfma_f32_16x16x32_bf16 v[200:203], a[168:171], a[64:67], v[200:203]
    s_waitcnt lgkmcnt(7)
    ds_read_b64_tr_b16 a[190:191], v15 offset:28672
    ds_read_b64_tr_b16 a[160:161], v16 offset:16384
    v_mfma_f32_16x16x32_bf16 v[200:203], a[172:175], a[72:75], v[200:203]
    ds_read_b64_tr_b16 a[162:163], v16 offset:20480
    v_mfma_f32_16x16x32_bf16 v[204:207], a[168:171], a[68:71], v[204:207]
    ds_read_b64_tr_b16 a[164:165], v16 offset:24576
    v_mfma_f32_16x16x32_bf16 v[204:207], a[172:175], a[76:79], v[204:207]
    s_waitcnt lgkmcnt(9)
    buffer_load_dwordx4 a[128:131], v51, s[24:27], s46 offen offset:2048 sc1
    v_mfma_f32_16x16x32_bf16 v[208:211], a[176:179], a[64:67], v[208:211]
    s_waitcnt lgkmcnt(7)
    ds_read_b64_tr_b16 a[166:167], v16 offset:28672
    ds_read_b64_tr_b16 a[168:169], v17 offset:16384
    v_mfma_f32_16x16x32_bf16 v[208:211], a[180:183], a[72:75], v[208:211]
    ds_read_b64_tr_b16 a[170:171], v17 offset:20480
    v_mfma_f32_16x16x32_bf16 v[212:215], a[176:179], a[68:71], v[212:215]
    ds_read_b64_tr_b16 a[172:173], v17 offset:24576
    v_mfma_f32_16x16x32_bf16 v[212:215], a[180:183], a[76:79], v[212:215]
    s_waitcnt lgkmcnt(9)
    buffer_load_dwordx4 a[136:139], v51, s[24:27], s46 offen offset:2176 sc1
    v_mfma_f32_16x16x32_bf16 v[216:219], a[184:187], a[64:67], v[216:219]
    s_waitcnt lgkmcnt(7)
    ds_read_b64_tr_b16 a[174:175], v17 offset:28672
    ds_read_b64_tr_b16 a[176:177], v18 offset:16384
    v_mfma_f32_16x16x32_bf16 v[216:219], a[188:191], a[72:75], v[216:219]
    ds_read_b64_tr_b16 a[178:179], v18 offset:20480
    v_mfma_f32_16x16x32_bf16 v[220:223], a[184:187], a[68:71], v[220:223]
    ds_read_b64_tr_b16 a[180:181], v18 offset:24576
    v_mfma_f32_16x16x32_bf16 v[220:223], a[188:191], a[76:79], v[220:223]
    s_waitcnt lgkmcnt(9)
    ds_read_b64_tr_b16 a[182:183], v18 offset:28672
    v_mfma_f32_16x16x32_bf16 v[224:227], a[160:163], a[64:67], v[224:227]
    s_waitcnt lgkmcnt(8)
    ds_read_b64_tr_b16 a[184:185], v19 offset:16384
    v_mfma_f32_16x16x32_bf16 v[224:227], a[164:167], a[72:75], v[224:227]
    ds_read_b64_tr_b16 a[186:187], v19 offset:20480
    v_mfma_f32_16x16x32_bf16 v[228:231], a[160:163], a[68:71], v[228:231]
    ds_read_b64_tr_b16 a[188:189], v19 offset:24576
    v_mfma_f32_16x16x32_bf16 v[228:231], a[164:167], a[76:79], v[228:231]
    s_waitcnt lgkmcnt(9)
    ds_read_b64_tr_b16 a[190:191], v19 offset:28672
    s_waitcnt vmcnt(20)
    s_barrier
    v_mfma_f32_16x16x32_bf16 v[232:235], a[168:171], a[64:67], v[232:235]
    s_waitcnt lgkmcnt(8)
    ds_read_b64_tr_b16 a[160:161], v12 offset:32768
    v_mfma_f32_16x16x32_bf16 v[232:235], a[172:175], a[72:75], v[232:235]
    s_add_u32 s49, s44, 2621696
    ds_read_b64_tr_b16 a[162:163], v12 offset:36864
    v_mfma_f32_16x16x32_bf16 v[236:239], a[168:171], a[68:71], v[236:239]
    s_add_u32 m0, s42, 98304
    ds_read_b64_tr_b16 a[164:165], v12 offset:40960
    v_mfma_f32_16x16x32_bf16 v[236:239], a[172:175], a[76:79], v[236:239]
    s_waitcnt lgkmcnt(9)
    buffer_load_dwordx4 v42, s[16:19], s49 offen lds
    v_mfma_f32_16x16x32_bf16 v[240:243], a[176:179], a[64:67], v[240:243]
    s_waitcnt lgkmcnt(7)
    ds_read_b64_tr_b16 a[166:167], v12 offset:45056
    ds_read_b64_tr_b16 a[168:169], v13 offset:32768
    v_mfma_f32_16x16x32_bf16 v[240:243], a[180:183], a[72:75], v[240:243]
    ds_read_b64_tr_b16 a[170:171], v13 offset:36864
    v_mfma_f32_16x16x32_bf16 v[244:247], a[176:179], a[68:71], v[244:247]
    ds_read_b64_tr_b16 a[172:173], v13 offset:40960
    v_mfma_f32_16x16x32_bf16 v[244:247], a[180:183], a[76:79], v[244:247]
    s_waitcnt lgkmcnt(9)
    buffer_load_dwordx4 v43, s[16:19], s49 offen offset:1024 lds
    v_mfma_f32_16x16x32_bf16 v[248:251], a[184:187], a[64:67], v[248:251]
    s_waitcnt lgkmcnt(7)
    ds_read_b64_tr_b16 a[174:175], v13 offset:45056
    ds_read_b64_tr_b16 a[176:177], v14 offset:32768
    v_mfma_f32_16x16x32_bf16 v[248:251], a[188:191], a[72:75], v[248:251]
    ds_read_b64_tr_b16 a[178:179], v14 offset:36864
    v_mfma_f32_16x16x32_bf16 v[252:255], a[184:187], a[68:71], v[252:255]
    ds_read_b64_tr_b16 a[180:181], v14 offset:40960
    v_mfma_f32_16x16x32_bf16 v[252:255], a[188:191], a[76:79], v[252:255]
    s_waitcnt lgkmcnt(9)
    buffer_load_dwordx4 v44, s[16:19], s49 offen offset:2048 lds
    v_mfma_f32_16x16x32_bf16 v[128:131], a[160:163], a[80:83], v[128:131]
    s_waitcnt lgkmcnt(7)
    ds_read_b64_tr_b16 a[182:183], v14 offset:45056
    ds_read_b64_tr_b16 a[184:185], v15 offset:32768
    v_mfma_f32_16x16x32_bf16 v[128:131], a[164:167], a[88:91], v[128:131]
    s_waitcnt vmcnt(22)
    ds_read_b64_tr_b16 a[186:187], v15 offset:36864
    v_mfma_f32_16x16x32_bf16 v[132:135], a[160:163], a[84:87], v[132:135]
    s_waitcnt vmcnt(21)
    ds_read_b64_tr_b16 a[188:189], v15 offset:40960
    v_mfma_f32_16x16x32_bf16 v[132:135], a[164:167], a[92:95], v[132:135]
    s_waitcnt lgkmcnt(9)
    buffer_load_dwordx4 v45, s[16:19], s49 offen offset:3072 lds
    v_mfma_f32_16x16x32_bf16 v[136:139], a[168:171], a[80:83], v[136:139]
    s_waitcnt lgkmcnt(7)
    ds_read_b64_tr_b16 a[190:191], v15 offset:45056
    ds_read_b64_tr_b16 a[160:161], v16 offset:32768
    v_mfma_f32_16x16x32_bf16 v[136:139], a[172:175], a[88:91], v[136:139]
    s_add_u32 s49, s44, 3145984
    ds_read_b64_tr_b16 a[162:163], v16 offset:36864
    v_mfma_f32_16x16x32_bf16 v[140:143], a[168:171], a[84:87], v[140:143]
    s_add_u32 m0, s42, 114688
    ds_read_b64_tr_b16 a[164:165], v16 offset:40960
    v_mfma_f32_16x16x32_bf16 v[140:143], a[172:175], a[92:95], v[140:143]
    s_waitcnt lgkmcnt(9)
    buffer_load_dwordx4 v42, s[16:19], s49 offen lds
    v_mfma_f32_16x16x32_bf16 v[144:147], a[176:179], a[80:83], v[144:147]
    s_waitcnt lgkmcnt(7)
    ds_read_b64_tr_b16 a[166:167], v16 offset:45056
    ds_read_b64_tr_b16 a[168:169], v17 offset:32768
    v_mfma_f32_16x16x32_bf16 v[144:147], a[180:183], a[88:91], v[144:147]
    ds_read_b64_tr_b16 a[170:171], v17 offset:36864
    v_mfma_f32_16x16x32_bf16 v[148:151], a[176:179], a[84:87], v[148:151]
    ds_read_b64_tr_b16 a[172:173], v17 offset:40960
    v_mfma_f32_16x16x32_bf16 v[148:151], a[180:183], a[92:95], v[148:151]
    s_waitcnt lgkmcnt(9)
    buffer_load_dwordx4 v43, s[16:19], s49 offen offset:1024 lds
    v_mfma_f32_16x16x32_bf16 v[152:155], a[184:187], a[80:83], v[152:155]
    s_waitcnt lgkmcnt(7)
    ds_read_b64_tr_b16 a[174:175], v17 offset:45056
    ds_read_b64_tr_b16 a[176:177], v18 offset:32768
    v_mfma_f32_16x16x32_bf16 v[152:155], a[188:191], a[88:91], v[152:155]
    ds_read_b64_tr_b16 a[178:179], v18 offset:36864
    v_mfma_f32_16x16x32_bf16 v[156:159], a[184:187], a[84:87], v[156:159]
    ds_read_b64_tr_b16 a[180:181], v18 offset:40960
    v_mfma_f32_16x16x32_bf16 v[156:159], a[188:191], a[92:95], v[156:159]
    s_waitcnt lgkmcnt(9)
    buffer_load_dwordx4 v44, s[16:19], s49 offen offset:2048 lds
    v_mfma_f32_16x16x32_bf16 v[160:163], a[160:163], a[80:83], v[160:163]
    s_waitcnt lgkmcnt(7)
    ds_read_b64_tr_b16 a[182:183], v18 offset:45056
    ds_read_b64_tr_b16 a[184:185], v19 offset:32768
    v_mfma_f32_16x16x32_bf16 v[160:163], a[164:167], a[88:91], v[160:163]
    ds_read_b64_tr_b16 a[186:187], v19 offset:36864
    v_mfma_f32_16x16x32_bf16 v[164:167], a[160:163], a[84:87], v[164:167]
    ds_read_b64_tr_b16 a[188:189], v19 offset:40960
    v_mfma_f32_16x16x32_bf16 v[164:167], a[164:167], a[92:95], v[164:167]
    s_waitcnt lgkmcnt(9)
    buffer_load_dwordx4 v45, s[16:19], s49 offen offset:3072 lds
    v_mfma_f32_16x16x32_bf16 v[168:171], a[168:171], a[80:83], v[168:171]
    s_waitcnt lgkmcnt(7)
    ds_read_b64_tr_b16 a[190:191], v19 offset:45056
    ds_read_b64_tr_b16 a[160:161], v12 offset:49152
    v_mfma_f32_16x16x32_bf16 v[168:171], a[172:175], a[88:91], v[168:171]
    ds_read_b64_tr_b16 a[162:163], v12 offset:53248
    v_mfma_f32_16x16x32_bf16 v[172:175], a[168:171], a[84:87], v[172:175]
    ds_read_b64_tr_b16 a[164:165], v12 offset:57344
    v_mfma_f32_16x16x32_bf16 v[172:175], a[172:175], a[92:95], v[172:175]
    s_waitcnt lgkmcnt(9)
    buffer_load_dwordx4 a[132:135], v51, s[24:27], s43 offen offset:2048 sc1
    v_mfma_f32_16x16x32_bf16 v[176:179], a[176:179], a[80:83], v[176:179]
    s_waitcnt lgkmcnt(7)
    ds_read_b64_tr_b16 a[166:167], v12 offset:61440
    ds_read_b64_tr_b16 a[168:169], v13 offset:49152
    v_mfma_f32_16x16x32_bf16 v[176:179], a[180:183], a[88:91], v[176:179]
    ds_read_b64_tr_b16 a[170:171], v13 offset:53248
    v_mfma_f32_16x16x32_bf16 v[180:183], a[176:179], a[84:87], v[180:183]
    ds_read_b64_tr_b16 a[172:173], v13 offset:57344
    v_mfma_f32_16x16x32_bf16 v[180:183], a[180:183], a[92:95], v[180:183]
    s_waitcnt lgkmcnt(9)
    buffer_load_dwordx4 a[140:143], v51, s[24:27], s43 offen offset:2176 sc1
    v_mfma_f32_16x16x32_bf16 v[184:187], a[184:187], a[80:83], v[184:187]
    s_waitcnt lgkmcnt(7)
    ds_read_b64_tr_b16 a[174:175], v13 offset:61440
    ds_read_b64_tr_b16 a[176:177], v14 offset:49152
    v_mfma_f32_16x16x32_bf16 v[184:187], a[188:191], a[88:91], v[184:187]
    ds_read_b64_tr_b16 a[178:179], v14 offset:53248
    v_mfma_f32_16x16x32_bf16 v[188:191], a[184:187], a[84:87], v[188:191]
    ds_read_b64_tr_b16 a[180:181], v14 offset:57344
    v_mfma_f32_16x16x32_bf16 v[188:191], a[188:191], a[92:95], v[188:191]
    s_waitcnt vmcnt(27)
    s_waitcnt lgkmcnt(9)
    ds_read_b64_tr_b16 a[182:183], v14 offset:61440
    v_mfma_f32_16x16x32_bf16 v[128:131], a[160:163], a[96:99], v[128:131]
    s_waitcnt vmcnt(26)
    s_waitcnt lgkmcnt(8)
    ds_read_b64_tr_b16 a[184:185], v15 offset:49152
    v_mfma_f32_16x16x32_bf16 v[128:131], a[164:167], a[104:107], v[128:131]
    s_waitcnt vmcnt(25)
    ds_read_b64_tr_b16 a[186:187], v15 offset:53248
    v_mfma_f32_16x16x32_bf16 v[132:135], a[160:163], a[100:103], v[132:135]
    s_waitcnt vmcnt(24)
    ds_read_b64_tr_b16 a[188:189], v15 offset:57344
    v_mfma_f32_16x16x32_bf16 v[132:135], a[164:167], a[108:111], v[132:135]
    s_waitcnt lgkmcnt(9)
    ds_read_b64_tr_b16 a[190:191], v15 offset:61440
    v_mfma_f32_16x16x32_bf16 v[136:139], a[168:171], a[96:99], v[136:139]
    s_waitcnt lgkmcnt(8)
    ds_read_b64_tr_b16 a[160:161], v16 offset:49152
    v_mfma_f32_16x16x32_bf16 v[136:139], a[172:175], a[104:107], v[136:139]
    ds_read_b64_tr_b16 a[162:163], v16 offset:53248
    v_mfma_f32_16x16x32_bf16 v[140:143], a[168:171], a[100:103], v[140:143]
    ds_read_b64_tr_b16 a[164:165], v16 offset:57344
    v_mfma_f32_16x16x32_bf16 v[140:143], a[172:175], a[108:111], v[140:143]
    s_waitcnt lgkmcnt(9)
    ds_read_b64_tr_b16 a[166:167], v16 offset:61440
    v_mfma_f32_16x16x32_bf16 v[144:147], a[176:179], a[96:99], v[144:147]
    s_waitcnt lgkmcnt(8)
    ds_read_b64_tr_b16 a[168:169], v17 offset:49152
    v_mfma_f32_16x16x32_bf16 v[144:147], a[180:183], a[104:107], v[144:147]
    ds_read_b64_tr_b16 a[170:171], v17 offset:53248
    v_mfma_f32_16x16x32_bf16 v[148:151], a[176:179], a[100:103], v[148:151]
    ds_read_b64_tr_b16 a[172:173], v17 offset:57344
    v_mfma_f32_16x16x32_bf16 v[148:151], a[180:183], a[108:111], v[148:151]
    s_waitcnt lgkmcnt(9)
    ds_read_b64_tr_b16 a[174:175], v17 offset:61440
    v_mfma_f32_16x16x32_bf16 v[152:155], a[184:187], a[96:99], v[152:155]
    s_waitcnt lgkmcnt(8)
    ds_read_b64_tr_b16 a[176:177], v18 offset:49152
    v_mfma_f32_16x16x32_bf16 v[152:155], a[188:191], a[104:107], v[152:155]
    ds_read_b64_tr_b16 a[178:179], v18 offset:53248
    v_mfma_f32_16x16x32_bf16 v[156:159], a[184:187], a[100:103], v[156:159]
    ds_read_b64_tr_b16 a[180:181], v18 offset:57344
    v_mfma_f32_16x16x32_bf16 v[156:159], a[188:191], a[108:111], v[156:159]
    s_waitcnt lgkmcnt(9)
    ds_read_b64_tr_b16 a[182:183], v18 offset:61440
    v_mfma_f32_16x16x32_bf16 v[160:163], a[160:163], a[96:99], v[160:163]
    s_waitcnt lgkmcnt(8)
    ds_read_b64_tr_b16 a[184:185], v19 offset:49152
    v_mfma_f32_16x16x32_bf16 v[160:163], a[164:167], a[104:107], v[160:163]
    ds_read_b64_tr_b16 a[186:187], v19 offset:53248
    v_mfma_f32_16x16x32_bf16 v[164:167], a[160:163], a[100:103], v[164:167]
    ds_read_b64_tr_b16 a[188:189], v19 offset:57344
    v_mfma_f32_16x16x32_bf16 v[164:167], a[164:167], a[108:111], v[164:167]
    s_waitcnt lgkmcnt(9)
    ds_read_b64_tr_b16 a[190:191], v19 offset:61440
    s_waitcnt vmcnt(16)
    s_barrier
    v_mfma_f32_16x16x32_bf16 v[168:171], a[168:171], a[96:99], v[168:171]
    s_waitcnt lgkmcnt(8)
    ds_read_b64_tr_b16 a[160:161], v20 offset:0
    v_mfma_f32_16x16x32_bf16 v[168:171], a[172:175], a[104:107], v[168:171]
    s_add_u32 s49, s44, 3670272
    ds_read_b64_tr_b16 a[162:163], v20 offset:4096
    v_mfma_f32_16x16x32_bf16 v[172:175], a[168:171], a[100:103], v[172:175]
    s_add_u32 m0, s42, 131072
    ds_read_b64_tr_b16 a[164:165], v20 offset:8192
    v_mfma_f32_16x16x32_bf16 v[172:175], a[172:175], a[108:111], v[172:175]
    s_waitcnt lgkmcnt(9)
    buffer_load_dwordx4 v42, s[16:19], s49 offen lds
    v_mfma_f32_16x16x32_bf16 v[176:179], a[176:179], a[96:99], v[176:179]
    s_waitcnt lgkmcnt(7)
    ds_read_b64_tr_b16 a[166:167], v20 offset:12288
    ds_read_b64_tr_b16 a[168:169], v21 offset:0
    v_mfma_f32_16x16x32_bf16 v[176:179], a[180:183], a[104:107], v[176:179]
    ds_read_b64_tr_b16 a[170:171], v21 offset:4096
    v_mfma_f32_16x16x32_bf16 v[180:183], a[176:179], a[100:103], v[180:183]
    ds_read_b64_tr_b16 a[172:173], v21 offset:8192
    v_mfma_f32_16x16x32_bf16 v[180:183], a[180:183], a[108:111], v[180:183]
    s_waitcnt lgkmcnt(9)
    buffer_load_dwordx4 v43, s[16:19], s49 offen offset:1024 lds
    v_mfma_f32_16x16x32_bf16 v[184:187], a[184:187], a[96:99], v[184:187]
    s_waitcnt lgkmcnt(7)
    ds_read_b64_tr_b16 a[174:175], v21 offset:12288
    ds_read_b64_tr_b16 a[176:177], v22 offset:0
    v_mfma_f32_16x16x32_bf16 v[184:187], a[188:191], a[104:107], v[184:187]
    ds_read_b64_tr_b16 a[178:179], v22 offset:4096
    v_mfma_f32_16x16x32_bf16 v[188:191], a[184:187], a[100:103], v[188:191]
    ds_read_b64_tr_b16 a[180:181], v22 offset:8192
    v_mfma_f32_16x16x32_bf16 v[188:191], a[188:191], a[108:111], v[188:191]
    s_waitcnt vmcnt(17)
    s_waitcnt lgkmcnt(9)
    buffer_load_dwordx4 v44, s[16:19], s49 offen offset:2048 lds
    v_mfma_f32_16x16x32_bf16 v[128:131], a[160:163], a[112:115], v[128:131]
    s_waitcnt vmcnt(17)
    s_waitcnt lgkmcnt(7)
    ds_read_b64_tr_b16 a[182:183], v22 offset:12288
    ds_read_b64_tr_b16 a[184:185], v23 offset:0
    v_mfma_f32_16x16x32_bf16 v[128:131], a[164:167], a[120:123], v[128:131]
    s_waitcnt vmcnt(16)
    ds_read_b64_tr_b16 a[186:187], v23 offset:4096
    v_mfma_f32_16x16x32_bf16 v[132:135], a[160:163], a[116:119], v[132:135]
    s_waitcnt vmcnt(15)
    ds_read_b64_tr_b16 a[188:189], v23 offset:8192
    v_mfma_f32_16x16x32_bf16 v[132:135], a[164:167], a[124:127], v[132:135]
    s_waitcnt lgkmcnt(9)
    buffer_load_dwordx4 v45, s[16:19], s49 offen offset:3072 lds
    v_mfma_f32_16x16x32_bf16 v[136:139], a[168:171], a[112:115], v[136:139]
    s_waitcnt lgkmcnt(7)
    ds_read_b64_tr_b16 a[190:191], v23 offset:12288
    ds_read_b64_tr_b16 a[160:161], v24 offset:0
    v_mfma_f32_16x16x32_bf16 v[136:139], a[172:175], a[120:123], v[136:139]
    s_add_u32 s49, s44, 4194560
    ds_read_b64_tr_b16 a[162:163], v24 offset:4096
    v_mfma_f32_16x16x32_bf16 v[140:143], a[168:171], a[116:119], v[140:143]
    s_add_u32 m0, s42, 147456
    ds_read_b64_tr_b16 a[164:165], v24 offset:8192
    v_mfma_f32_16x16x32_bf16 v[140:143], a[172:175], a[124:127], v[140:143]
    s_waitcnt lgkmcnt(9)
    buffer_load_dwordx4 v42, s[16:19], s49 offen lds
    v_mfma_f32_16x16x32_bf16 v[144:147], a[176:179], a[112:115], v[144:147]
    s_waitcnt lgkmcnt(7)
    ds_read_b64_tr_b16 a[166:167], v24 offset:12288
    ds_read_b64_tr_b16 a[168:169], v25 offset:0
    v_mfma_f32_16x16x32_bf16 v[144:147], a[180:183], a[120:123], v[144:147]
    ds_read_b64_tr_b16 a[170:171], v25 offset:4096
    v_mfma_f32_16x16x32_bf16 v[148:151], a[176:179], a[116:119], v[148:151]
    ds_read_b64_tr_b16 a[172:173], v25 offset:8192
    v_mfma_f32_16x16x32_bf16 v[148:151], a[180:183], a[124:127], v[148:151]
    s_waitcnt lgkmcnt(9)
    buffer_load_dwordx4 v43, s[16:19], s49 offen offset:1024 lds
    v_mfma_f32_16x16x32_bf16 v[152:155], a[184:187], a[112:115], v[152:155]
    s_waitcnt lgkmcnt(7)
    ds_read_b64_tr_b16 a[174:175], v25 offset:12288
    ds_read_b64_tr_b16 a[176:177], v26 offset:0
    v_mfma_f32_16x16x32_bf16 v[152:155], a[188:191], a[120:123], v[152:155]
    ds_read_b64_tr_b16 a[178:179], v26 offset:4096
    v_mfma_f32_16x16x32_bf16 v[156:159], a[184:187], a[116:119], v[156:159]
    ds_read_b64_tr_b16 a[180:181], v26 offset:8192
    v_mfma_f32_16x16x32_bf16 v[156:159], a[188:191], a[124:127], v[156:159]
    s_waitcnt lgkmcnt(9)
    buffer_load_dwordx4 v44, s[16:19], s49 offen offset:2048 lds
    v_mfma_f32_16x16x32_bf16 v[160:163], a[160:163], a[112:115], v[160:163]
    s_waitcnt lgkmcnt(7)
    ds_read_b64_tr_b16 a[182:183], v26 offset:12288
    ds_read_b64_tr_b16 a[184:185], v27 offset:0
    v_mfma_f32_16x16x32_bf16 v[160:163], a[164:167], a[120:123], v[160:163]
    ds_read_b64_tr_b16 a[186:187], v27 offset:4096
    v_mfma_f32_16x16x32_bf16 v[164:167], a[160:163], a[116:119], v[164:167]
    ds_read_b64_tr_b16 a[188:189], v27 offset:8192
    v_mfma_f32_16x16x32_bf16 v[164:167], a[164:167], a[124:127], v[164:167]
    s_waitcnt lgkmcnt(9)
    buffer_load_dwordx4 v45, s[16:19], s49 offen offset:3072 lds
    v_mfma_f32_16x16x32_bf16 v[168:171], a[168:171], a[112:115], v[168:171]
    s_waitcnt lgkmcnt(7)
    ds_read_b64_tr_b16 a[190:191], v27 offset:12288
    ds_read_b64_tr_b16 a[160:161], v20 offset:16384
    v_mfma_f32_16x16x32_bf16 v[168:171], a[172:175], a[120:123], v[168:171]
    ds_read_b64_tr_b16 a[162:163], v20 offset:20480
    v_mfma_f32_16x16x32_bf16 v[172:175], a[168:171], a[116:119], v[172:175]
    ds_read_b64_tr_b16 a[164:165], v20 offset:24576
    v_mfma_f32_16x16x32_bf16 v[172:175], a[172:175], a[124:127], v[172:175]
    s_waitcnt lgkmcnt(9)
    buffer_load_dword v78, v120, s[8:11], 0 offen
    v_mfma_f32_16x16x32_bf16 v[176:179], a[176:179], a[112:115], v[176:179]
    s_waitcnt lgkmcnt(7)
    ds_read_b64_tr_b16 a[166:167], v20 offset:28672
    ds_read_b64_tr_b16 a[168:169], v21 offset:16384
    v_mfma_f32_16x16x32_bf16 v[176:179], a[180:183], a[120:123], v[176:179]
    ds_read_b64_tr_b16 a[170:171], v21 offset:20480
    v_mfma_f32_16x16x32_bf16 v[180:183], a[176:179], a[116:119], v[180:183]
    ds_read_b64_tr_b16 a[172:173], v21 offset:24576
    v_mfma_f32_16x16x32_bf16 v[180:183], a[180:183], a[124:127], v[180:183]
    s_waitcnt lgkmcnt(9)
    buffer_load_dword v79, v121, s[12:15], 0 offen
    v_mfma_f32_16x16x32_bf16 v[184:187], a[184:187], a[112:115], v[184:187]
    s_waitcnt lgkmcnt(7)
    ds_read_b64_tr_b16 a[174:175], v21 offset:28672
    ds_read_b64_tr_b16 a[176:177], v22 offset:16384
    v_mfma_f32_16x16x32_bf16 v[184:187], a[188:191], a[120:123], v[184:187]
    ds_read_b64_tr_b16 a[178:179], v22 offset:20480
    v_mfma_f32_16x16x32_bf16 v[188:191], a[184:187], a[116:119], v[188:191]
    s_mov_b32 s36, 1040356334
    ds_read_b64_tr_b16 a[180:181], v22 offset:24576
    v_mfma_f32_16x16x32_bf16 v[188:191], a[188:191], a[124:127], v[188:191]
    s_waitcnt vmcnt(21)
    s_waitcnt lgkmcnt(9)
    buffer_store_dword v76, v72, s[24:27], s92 offen offset:12 sc1
    v_mfma_f32_16x16x32_bf16 v[128:131], a[160:163], a[128:131], v[128:131]
    s_waitcnt vmcnt(21)
    s_waitcnt lgkmcnt(7)
    ds_read_b64_tr_b16 a[182:183], v22 offset:28672
    ds_read_b64_tr_b16 a[184:185], v23 offset:16384
    v_mfma_f32_16x16x32_bf16 v[128:131], a[164:167], a[136:139], v[128:131]
    s_waitcnt vmcnt(12)
    ds_read_b64_tr_b16 a[186:187], v23 offset:20480
    v_mfma_f32_16x16x32_bf16 v[132:135], a[160:163], a[132:135], v[132:135]
    s_waitcnt vmcnt(11)
    ds_read_b64_tr_b16 a[188:189], v23 offset:24576
    v_mfma_f32_16x16x32_bf16 v[132:135], a[164:167], a[140:143], v[132:135]
    s_waitcnt lgkmcnt(9)
    buffer_store_dwordx4 v[88:91], v74, s[24:27], 0 offen sc1
    v_mfma_f32_16x16x32_bf16 v[136:139], a[168:171], a[128:131], v[136:139]
    s_waitcnt lgkmcnt(7)
    ds_read_b64_tr_b16 a[190:191], v23 offset:28672
    ds_read_b64_tr_b16 a[160:161], v24 offset:16384
    v_mfma_f32_16x16x32_bf16 v[136:139], a[172:175], a[136:139], v[136:139]
    ds_read_b64_tr_b16 a[162:163], v24 offset:20480
    v_mfma_f32_16x16x32_bf16 v[140:143], a[168:171], a[132:135], v[140:143]
    ds_read_b64_tr_b16 a[164:165], v24 offset:24576
    v_mfma_f32_16x16x32_bf16 v[140:143], a[172:175], a[140:143], v[140:143]
    s_waitcnt lgkmcnt(9)
    ds_read_b64_tr_b16 a[166:167], v24 offset:28672
    v_mfma_f32_16x16x32_bf16 v[144:147], a[176:179], a[128:131], v[144:147]
    s_waitcnt lgkmcnt(8)
    ds_read_b64_tr_b16 a[168:169], v25 offset:16384
    v_mfma_f32_16x16x32_bf16 v[144:147], a[180:183], a[136:139], v[144:147]
    ds_read_b64_tr_b16 a[170:171], v25 offset:20480
    v_mfma_f32_16x16x32_bf16 v[148:151], a[176:179], a[132:135], v[148:151]
    ds_read_b64_tr_b16 a[172:173], v25 offset:24576
    v_mfma_f32_16x16x32_bf16 v[148:151], a[180:183], a[140:143], v[148:151]
    s_waitcnt lgkmcnt(9)
    ds_read_b64_tr_b16 a[174:175], v25 offset:28672
    v_mul_f32 v128, s36, v128
    v_mfma_f32_16x16x32_bf16 v[152:155], a[184:187], a[128:131], v[152:155]
    s_waitcnt lgkmcnt(8)
    ds_read_b64_tr_b16 a[176:177], v26 offset:16384
    v_mul_f32 v129, s36, v129
    v_mfma_f32_16x16x32_bf16 v[152:155], a[188:191], a[136:139], v[152:155]
    ds_read_b64_tr_b16 a[178:179], v26 offset:20480
    v_mul_f32 v130, s36, v130
    v_mfma_f32_16x16x32_bf16 v[156:159], a[184:187], a[132:135], v[156:159]
    ds_read_b64_tr_b16 a[180:181], v26 offset:24576
    v_mul_f32 v131, s36, v131
    v_mfma_f32_16x16x32_bf16 v[156:159], a[188:191], a[140:143], v[156:159]
    s_waitcnt lgkmcnt(9)
    ds_read_b64_tr_b16 a[182:183], v26 offset:28672
    v_mul_f32 v136, s36, v136
    v_mfma_f32_16x16x32_bf16 v[160:163], a[160:163], a[128:131], v[160:163]
    s_waitcnt lgkmcnt(8)
    ds_read_b64_tr_b16 a[184:185], v27 offset:16384
    v_mul_f32 v137, s36, v137
    v_mfma_f32_16x16x32_bf16 v[160:163], a[164:167], a[136:139], v[160:163]
    ds_read_b64_tr_b16 a[186:187], v27 offset:20480
    v_mul_f32 v138, s36, v138
    v_mfma_f32_16x16x32_bf16 v[164:167], a[160:163], a[132:135], v[164:167]
    ds_read_b64_tr_b16 a[188:189], v27 offset:24576
    v_mul_f32 v139, s36, v139
    v_mfma_f32_16x16x32_bf16 v[164:167], a[164:167], a[140:143], v[164:167]
    s_waitcnt lgkmcnt(9)
    ds_read_b64_tr_b16 a[190:191], v27 offset:28672
    v_mul_f32 v132, s36, v132
    s_barrier
    v_mfma_f32_16x16x32_bf16 v[168:171], a[168:171], a[128:131], v[168:171]
    s_waitcnt lgkmcnt(8)
    ds_read_b64_tr_b16 a[160:161], v20 offset:32768
    v_mul_f32 v133, s36, v133
    v_mfma_f32_16x16x32_bf16 v[168:171], a[172:175], a[136:139], v[168:171]
    ds_read_b64_tr_b16 a[162:163], v20 offset:36864
    v_mul_f32 v134, s36, v134
    v_mfma_f32_16x16x32_bf16 v[172:175], a[168:171], a[132:135], v[172:175]
    s_add_u32 m0, s42, 0
    ds_read_b64_tr_b16 a[164:165], v20 offset:40960
    v_mul_f32 v135, s36, v135
    v_mfma_f32_16x16x32_bf16 v[172:175], a[172:175], a[140:143], v[172:175]
    s_waitcnt lgkmcnt(9)
    buffer_load_dwordx4 v36, s[8:11], s40 offen lds
    v_mfma_f32_16x16x32_bf16 v[176:179], a[176:179], a[128:131], v[176:179]
    s_waitcnt lgkmcnt(7)
    ds_read_b64_tr_b16 a[166:167], v20 offset:45056
    ds_read_b64_tr_b16 a[168:169], v21 offset:32768
    v_mfma_f32_16x16x32_bf16 v[176:179], a[180:183], a[136:139], v[176:179]
    ds_read_b64_tr_b16 a[170:171], v21 offset:36864
    v_mul_f32 v140, s36, v140
    v_mfma_f32_16x16x32_bf16 v[180:183], a[176:179], a[132:135], v[180:183]
    ds_read_b64_tr_b16 a[172:173], v21 offset:40960
    v_mul_f32 v141, s36, v141
    v_mfma_f32_16x16x32_bf16 v[180:183], a[180:183], a[140:143], v[180:183]
    s_waitcnt lgkmcnt(9)
    buffer_load_dwordx4 v37, s[8:11], s40 offen offset:1024 lds
    v_mfma_f32_16x16x32_bf16 v[184:187], a[184:187], a[128:131], v[184:187]
    s_waitcnt lgkmcnt(7)
    ds_read_b64_tr_b16 a[174:175], v21 offset:45056
    ds_read_b64_tr_b16 a[176:177], v22 offset:32768
    v_mfma_f32_16x16x32_bf16 v[184:187], a[188:191], a[136:139], v[184:187]
    ds_read_b64_tr_b16 a[178:179], v22 offset:36864
    v_mul_f32 v142, s36, v142
    v_mfma_f32_16x16x32_bf16 v[188:191], a[184:187], a[132:135], v[188:191]
Ltour2:
    s_cbranch_execz Ltour6
    ds_read_b64_tr_b16 a[180:181], v22 offset:40960
    v_mul_f32 v143, s36, v143
    v_mfma_f32_16x16x32_bf16 v[188:191], a[188:191], a[140:143], v[188:191]
    s_waitcnt lgkmcnt(9)
    buffer_load_dwordx4 v38, s[8:11], s40 offen offset:2048 lds
    v_mfma_f32_16x16x32_bf16 v[192:195], a[160:163], a[80:83], v[192:195]
    s_waitcnt lgkmcnt(7)
    ds_read_b64_tr_b16 a[182:183], v22 offset:45056
    ds_read_b64_tr_b16 a[184:185], v23 offset:32768
    v_mfma_f32_16x16x32_bf16 v[192:195], a[164:167], a[88:91], v[192:195]
    ds_read_b64_tr_b16 a[186:187], v23 offset:36864
    v_cvt_pk_bf16_f32 v64, v128, v129
    v_mfma_f32_16x16x32_bf16 v[196:199], a[160:163], a[84:87], v[196:199]
    ds_read_b64_tr_b16 a[188:189], v23 offset:40960
    v_cvt_pk_bf16_f32 v65, v130, v131
    v_mfma_f32_16x16x32_bf16 v[196:199], a[164:167], a[92:95], v[196:199]
    s_waitcnt lgkmcnt(9)
    buffer_load_dwordx4 v39, s[8:11], s40 offen offset:3072 lds
    v_mfma_f32_16x16x32_bf16 v[200:203], a[168:171], a[80:83], v[200:203]
    s_waitcnt lgkmcnt(7)
    s_add_u32 s40, s40, 16384
    ds_read_b64_tr_b16 a[190:191], v23 offset:45056
    ds_read_b64_tr_b16 a[160:161], v24 offset:32768
    v_mfma_f32_16x16x32_bf16 v[200:203], a[172:175], a[88:91], v[200:203]
    ds_read_b64_tr_b16 a[162:163], v24 offset:36864
    v_cvt_pk_bf16_f32 v66, v136, v137
    v_mfma_f32_16x16x32_bf16 v[204:207], a[168:171], a[84:87], v[204:207]
    s_add_u32 m0, s42, 16384
    ds_read_b64_tr_b16 a[164:165], v24 offset:40960
    v_cvt_pk_bf16_f32 v67, v138, v139
    v_mfma_f32_16x16x32_bf16 v[204:207], a[172:175], a[92:95], v[204:207]
    s_waitcnt lgkmcnt(9)
    buffer_load_dwordx4 v36, s[8:11], s40 offen lds
    v_mfma_f32_16x16x32_bf16 v[208:211], a[176:179], a[80:83], v[208:211]
    s_waitcnt lgkmcnt(7)
    ds_read_b64_tr_b16 a[166:167], v24 offset:45056
    ds_read_b64_tr_b16 a[168:169], v25 offset:32768
    v_mfma_f32_16x16x32_bf16 v[208:211], a[180:183], a[88:91], v[208:211]
    ds_read_b64_tr_b16 a[170:171], v25 offset:36864
    v_cvt_pk_bf16_f32 v80, v132, v133
    v_mfma_f32_16x16x32_bf16 v[212:215], a[176:179], a[84:87], v[212:215]
    ds_read_b64_tr_b16 a[172:173], v25 offset:40960
    v_cvt_pk_bf16_f32 v81, v134, v135
    v_mfma_f32_16x16x32_bf16 v[212:215], a[180:183], a[92:95], v[212:215]
    s_waitcnt lgkmcnt(9)
    buffer_load_dwordx4 v37, s[8:11], s40 offen offset:1024 lds
    v_mfma_f32_16x16x32_bf16 v[216:219], a[184:187], a[80:83], v[216:219]
    s_waitcnt lgkmcnt(7)
    ds_read_b64_tr_b16 a[174:175], v25 offset:45056
    ds_read_b64_tr_b16 a[176:177], v26 offset:32768
    v_mfma_f32_16x16x32_bf16 v[216:219], a[188:191], a[88:91], v[216:219]
    ds_read_b64_tr_b16 a[178:179], v26 offset:36864
    v_cvt_pk_bf16_f32 v82, v140, v141
    v_mfma_f32_16x16x32_bf16 v[220:223], a[184:187], a[84:87], v[220:223]
    ds_read_b64_tr_b16 a[180:181], v26 offset:40960
    v_cvt_pk_bf16_f32 v83, v142, v143
    v_mfma_f32_16x16x32_bf16 v[220:223], a[188:191], a[92:95], v[220:223]
    s_waitcnt lgkmcnt(9)
    buffer_load_dwordx4 v38, s[8:11], s40 offen offset:2048 lds
    v_mfma_f32_16x16x32_bf16 v[224:227], a[160:163], a[80:83], v[224:227]
    s_waitcnt lgkmcnt(7)
    ds_read_b64_tr_b16 a[182:183], v26 offset:45056
    ds_read_b64_tr_b16 a[184:185], v27 offset:32768
    v_mfma_f32_16x16x32_bf16 v[224:227], a[164:167], a[88:91], v[224:227]
    ds_read_b64_tr_b16 a[186:187], v27 offset:36864
    v_permlane32_swap_b32 v64, v66
    v_mfma_f32_16x16x32_bf16 v[228:231], a[160:163], a[84:87], v[228:231]
    ds_read_b64_tr_b16 a[188:189], v27 offset:40960
    v_permlane32_swap_b32 v65, v67
    v_mfma_f32_16x16x32_bf16 v[228:231], a[164:167], a[92:95], v[228:231]
    s_waitcnt lgkmcnt(9)
    buffer_load_dwordx4 v39, s[8:11], s40 offen offset:3072 lds
    v_mfma_f32_16x16x32_bf16 v[232:235], a[168:171], a[80:83], v[232:235]
    s_waitcnt lgkmcnt(7)
    s_add_u32 s40, s40, 16384
    ds_read_b64_tr_b16 a[190:191], v27 offset:45056
    ds_read_b64_tr_b16 a[160:161], v20 offset:49152
    v_mfma_f32_16x16x32_bf16 v[232:235], a[172:175], a[88:91], v[232:235]
    ds_read_b64_tr_b16 a[162:163], v20 offset:53248
    v_permlane32_swap_b32 v80, v82
    v_mfma_f32_16x16x32_bf16 v[236:239], a[168:171], a[84:87], v[236:239]
    ds_read_b64_tr_b16 a[164:165], v20 offset:57344
    v_permlane32_swap_b32 v81, v83
    v_mfma_f32_16x16x32_bf16 v[236:239], a[172:175], a[92:95], v[236:239]
    s_waitcnt lgkmcnt(9)
    ds_read_b64_tr_b16 a[166:167], v20 offset:61440
    v_permlane16_swap_b32 v64, v66
    v_mfma_f32_16x16x32_bf16 v[240:243], a[176:179], a[80:83], v[240:243]
    s_waitcnt lgkmcnt(8)
    ds_read_b64_tr_b16 a[168:169], v21 offset:49152
    v_permlane16_swap_b32 v65, v67
    v_mfma_f32_16x16x32_bf16 v[240:243], a[180:183], a[88:91], v[240:243]
    ds_read_b64_tr_b16 a[170:171], v21 offset:53248
    v_permlane16_swap_b32 v80, v82
    v_mfma_f32_16x16x32_bf16 v[244:247], a[176:179], a[84:87], v[244:247]
    ds_read_b64_tr_b16 a[172:173], v21 offset:57344
    v_permlane16_swap_b32 v81, v83
    v_mfma_f32_16x16x32_bf16 v[244:247], a[180:183], a[92:95], v[244:247]
    s_waitcnt lgkmcnt(9)
    ds_read_b64_tr_b16 a[174:175], v21 offset:61440
    v_mul_f32 v144, s36, v144
    v_mfma_f32_16x16x32_bf16 v[248:251], a[184:187], a[80:83], v[248:251]
    s_waitcnt lgkmcnt(8)
    ds_read_b64_tr_b16 a[176:177], v22 offset:49152
    v_mul_f32 v145, s36, v145
    v_mfma_f32_16x16x32_bf16 v[248:251], a[188:191], a[88:91], v[248:251]
    ds_read_b64_tr_b16 a[178:179], v22 offset:53248
    v_mul_f32 v146, s36, v146
    v_mfma_f32_16x16x32_bf16 v[252:255], a[184:187], a[84:87], v[252:255]
    ds_read_b64_tr_b16 a[180:181], v22 offset:57344
    v_mul_f32 v147, s36, v147
    v_mfma_f32_16x16x32_bf16 v[252:255], a[188:191], a[92:95], v[252:255]
    s_waitcnt lgkmcnt(9)
    ds_read_b64_tr_b16 a[182:183], v22 offset:61440
    v_mul_f32 v152, s36, v152
    v_mfma_f32_16x16x32_bf16 v[192:195], a[160:163], a[96:99], v[192:195]
    s_waitcnt lgkmcnt(8)
    ds_read_b64_tr_b16 a[184:185], v23 offset:49152
    v_mul_f32 v153, s36, v153
    v_mfma_f32_16x16x32_bf16 v[192:195], a[164:167], a[104:107], v[192:195]
    ds_read_b64_tr_b16 a[186:187], v23 offset:53248
    v_mul_f32 v154, s36, v154
    v_mfma_f32_16x16x32_bf16 v[196:199], a[160:163], a[100:103], v[196:199]
    ds_read_b64_tr_b16 a[188:189], v23 offset:57344
    v_mul_f32 v155, s36, v155
    v_mfma_f32_16x16x32_bf16 v[196:199], a[164:167], a[108:111], v[196:199]
    s_waitcnt lgkmcnt(9)
    ds_read_b64_tr_b16 a[190:191], v23 offset:61440
    v_mul_f32 v148, s36, v148
    v_mfma_f32_16x16x32_bf16 v[200:203], a[168:171], a[96:99], v[200:203]
    s_waitcnt lgkmcnt(8)
    ds_read_b64_tr_b16 a[160:161], v24 offset:49152
    v_mul_f32 v149, s36, v149
    v_mfma_f32_16x16x32_bf16 v[200:203], a[172:175], a[104:107], v[200:203]
    ds_read_b64_tr_b16 a[162:163], v24 offset:53248
    v_mul_f32 v150, s36, v150
    v_mfma_f32_16x16x32_bf16 v[204:207], a[168:171], a[100:103], v[204:207]
    ds_read_b64_tr_b16 a[164:165], v24 offset:57344
    v_mul_f32 v151, s36, v151
    v_mfma_f32_16x16x32_bf16 v[204:207], a[172:175], a[108:111], v[204:207]
    s_waitcnt lgkmcnt(9)
    ds_read_b64_tr_b16 a[166:167], v24 offset:61440
    v_mul_f32 v156, s36, v156
    v_mfma_f32_16x16x32_bf16 v[208:211], a[176:179], a[96:99], v[208:211]
    s_waitcnt lgkmcnt(8)
    ds_read_b64_tr_b16 a[168:169], v25 offset:49152
    v_mul_f32 v157, s36, v157
    v_mfma_f32_16x16x32_bf16 v[208:211], a[180:183], a[104:107], v[208:211]
    ds_read_b64_tr_b16 a[170:171], v25 offset:53248
    v_mul_f32 v158, s36, v158
    v_mfma_f32_16x16x32_bf16 v[212:215], a[176:179], a[100:103], v[212:215]
    ds_read_b64_tr_b16 a[172:173], v25 offset:57344
    v_mul_f32 v159, s36, v159
    v_mfma_f32_16x16x32_bf16 v[212:215], a[180:183], a[108:111], v[212:215]
    s_waitcnt lgkmcnt(9)
    ds_read_b64_tr_b16 a[174:175], v25 offset:61440
    v_cvt_pk_bf16_f32 v68, v144, v145
    v_mfma_f32_16x16x32_bf16 v[216:219], a[184:187], a[96:99], v[216:219]
    s_waitcnt lgkmcnt(8)
    ds_read_b64_tr_b16 a[176:177], v26 offset:49152
    v_cvt_pk_bf16_f32 v69, v146, v147
    v_mfma_f32_16x16x32_bf16 v[216:219], a[188:191], a[104:107], v[216:219]
    ds_read_b64_tr_b16 a[178:179], v26 offset:53248
    v_cvt_pk_bf16_f32 v70, v152, v153
    v_mfma_f32_16x16x32_bf16 v[220:223], a[184:187], a[100:103], v[220:223]
    ds_read_b64_tr_b16 a[180:181], v26 offset:57344
    v_cvt_pk_bf16_f32 v71, v154, v155
    v_mfma_f32_16x16x32_bf16 v[220:223], a[188:191], a[108:111], v[220:223]
    s_waitcnt lgkmcnt(9)
    ds_read_b64_tr_b16 a[182:183], v26 offset:61440
    v_cvt_pk_bf16_f32 v84, v148, v149
    v_mfma_f32_16x16x32_bf16 v[224:227], a[160:163], a[96:99], v[224:227]
    s_waitcnt lgkmcnt(8)
    ds_read_b64_tr_b16 a[184:185], v27 offset:49152
    v_cvt_pk_bf16_f32 v85, v150, v151
    v_mfma_f32_16x16x32_bf16 v[224:227], a[164:167], a[104:107], v[224:227]
    ds_read_b64_tr_b16 a[186:187], v27 offset:53248
    v_cvt_pk_bf16_f32 v86, v156, v157
    v_mfma_f32_16x16x32_bf16 v[228:231], a[160:163], a[100:103], v[228:231]
    ds_read_b64_tr_b16 a[188:189], v27 offset:57344
    v_cvt_pk_bf16_f32 v87, v158, v159
    v_mfma_f32_16x16x32_bf16 v[228:231], a[164:167], a[108:111], v[228:231]
    s_waitcnt lgkmcnt(9)
    ds_read_b64_tr_b16 a[190:191], v27 offset:61440
    v_permlane32_swap_b32 v68, v70
    s_waitcnt vmcnt(12)
    s_barrier
    v_mfma_f32_16x16x32_bf16 v[232:235], a[168:171], a[96:99], v[232:235]
    s_waitcnt lgkmcnt(8)
    ds_read_b64_tr_b16 a[160:161], v28 offset:0
    v_permlane32_swap_b32 v69, v71
    v_mfma_f32_16x16x32_bf16 v[232:235], a[172:175], a[104:107], v[232:235]
    ds_read_b64_tr_b16 a[162:163], v28 offset:4096
    v_permlane32_swap_b32 v84, v86
    v_mfma_f32_16x16x32_bf16 v[236:239], a[168:171], a[100:103], v[236:239]
    s_add_u32 m0, s42, 32768
    ds_read_b64_tr_b16 a[164:165], v28 offset:8192
    v_permlane32_swap_b32 v85, v87
    v_mfma_f32_16x16x32_bf16 v[236:239], a[172:175], a[108:111], v[236:239]
    s_waitcnt lgkmcnt(9)
    buffer_load_dwordx4 v36, s[8:11], s40 offen lds
    v_mfma_f32_16x16x32_bf16 v[240:243], a[176:179], a[96:99], v[240:243]
    s_waitcnt lgkmcnt(7)
    ds_read_b64_tr_b16 a[166:167], v28 offset:12288
    ds_read_b64_tr_b16 a[168:169], v29 offset:0
    v_mfma_f32_16x16x32_bf16 v[240:243], a[180:183], a[104:107], v[240:243]
    ds_read_b64_tr_b16 a[170:171], v29 offset:4096
    v_permlane16_swap_b32 v68, v70
    v_mfma_f32_16x16x32_bf16 v[244:247], a[176:179], a[100:103], v[244:247]
    ds_read_b64_tr_b16 a[172:173], v29 offset:8192
    v_permlane16_swap_b32 v69, v71
    v_mfma_f32_16x16x32_bf16 v[244:247], a[180:183], a[108:111], v[244:247]
    s_waitcnt lgkmcnt(9)
    buffer_load_dwordx4 v37, s[8:11], s40 offen offset:1024 lds
    v_mfma_f32_16x16x32_bf16 v[248:251], a[184:187], a[96:99], v[248:251]
    s_waitcnt lgkmcnt(7)
    ds_read_b64_tr_b16 a[174:175], v29 offset:12288
    ds_read_b64_tr_b16 a[176:177], v30 offset:0
    v_mfma_f32_16x16x32_bf16 v[248:251], a[188:191], a[104:107], v[248:251]
    ds_read_b64_tr_b16 a[178:179], v30 offset:4096
    v_permlane16_swap_b32 v84, v86
    v_mfma_f32_16x16x32_bf16 v[252:255], a[184:187], a[100:103], v[252:255]
    ds_read_b64_tr_b16 a[180:181], v30 offset:8192
    v_permlane16_swap_b32 v85, v87
    v_mfma_f32_16x16x32_bf16 v[252:255], a[188:191], a[108:111], v[252:255]
    s_waitcnt lgkmcnt(9)
    buffer_load_dwordx4 v38, s[8:11], s40 offen offset:2048 lds
    v_mfma_f32_16x16x32_bf16 v[192:195], a[160:163], a[112:115], v[192:195]
    s_waitcnt lgkmcnt(7)
    ds_read_b64_tr_b16 a[182:183], v30 offset:12288
    ds_read_b64_tr_b16 a[184:185], v31 offset:0
    v_mfma_f32_16x16x32_bf16 v[192:195], a[164:167], a[120:123], v[192:195]
    ds_read_b64_tr_b16 a[186:187], v31 offset:4096
    v_mul_f32 v160, s36, v160
    v_mfma_f32_16x16x32_bf16 v[196:199], a[160:163], a[116:119], v[196:199]
    ds_read_b64_tr_b16 a[188:189], v31 offset:8192
    v_mul_f32 v161, s36, v161
    v_mfma_f32_16x16x32_bf16 v[196:199], a[164:167], a[124:127], v[196:199]
    s_waitcnt lgkmcnt(9)
    buffer_load_dwordx4 v39, s[8:11], s40 offen offset:3072 lds
    v_mfma_f32_16x16x32_bf16 v[200:203], a[168:171], a[112:115], v[200:203]
    s_waitcnt lgkmcnt(7)
    s_add_u32 s40, s40, 16384
    ds_read_b64_tr_b16 a[190:191], v31 offset:12288
    ds_read_b64_tr_b16 a[160:161], v32 offset:0
    v_mfma_f32_16x16x32_bf16 v[200:203], a[172:175], a[120:123], v[200:203]
    ds_read_b64_tr_b16 a[162:163], v32 offset:4096
    v_mul_f32 v162, s36, v162
    v_mfma_f32_16x16x32_bf16 v[204:207], a[168:171], a[116:119], v[204:207]
    s_add_u32 m0, s42, 65536
    ds_read_b64_tr_b16 a[164:165], v32 offset:8192
    v_mul_f32 v163, s36, v163
    v_mfma_f32_16x16x32_bf16 v[204:207], a[172:175], a[124:127], v[204:207]
    s_waitcnt lgkmcnt(9)
    buffer_load_dwordx4 v40, s[12:15], s41 offen lds
    v_mfma_f32_16x16x32_bf16 v[208:211], a[176:179], a[112:115], v[208:211]
    s_waitcnt lgkmcnt(7)
    ds_read_b64_tr_b16 a[166:167], v32 offset:12288
    ds_read_b64_tr_b16 a[168:169], v33 offset:0
    v_mfma_f32_16x16x32_bf16 v[208:211], a[180:183], a[120:123], v[208:211]
    ds_read_b64_tr_b16 a[170:171], v33 offset:4096
    v_mul_f32 v168, s36, v168
    v_mfma_f32_16x16x32_bf16 v[212:215], a[176:179], a[116:119], v[212:215]
    ds_read_b64_tr_b16 a[172:173], v33 offset:8192
    v_mul_f32 v169, s36, v169
    v_mfma_f32_16x16x32_bf16 v[212:215], a[180:183], a[124:127], v[212:215]
    s_waitcnt lgkmcnt(9)
    buffer_load_dwordx4 v41, s[12:15], s41 offen offset:1024 lds
    v_mfma_f32_16x16x32_bf16 v[216:219], a[184:187], a[112:115], v[216:219]
    s_waitcnt lgkmcnt(7)
    ds_read_b64_tr_b16 a[174:175], v33 offset:12288
    ds_read_b64_tr_b16 a[176:177], v34 offset:0
    v_mfma_f32_16x16x32_bf16 v[216:219], a[188:191], a[120:123], v[216:219]
    ds_read_b64_tr_b16 a[178:179], v34 offset:4096
    v_mul_f32 v170, s36, v170
    v_mfma_f32_16x16x32_bf16 v[220:223], a[184:187], a[116:119], v[220:223]
    ds_read_b64_tr_b16 a[180:181], v34 offset:8192
    v_mul_f32 v171, s36, v171
    v_mfma_f32_16x16x32_bf16 v[220:223], a[188:191], a[124:127], v[220:223]
    s_waitcnt lgkmcnt(9)
    buffer_load_dwordx4 v40, s[12:15], s41 offen offset:2048 lds
    v_mfma_f32_16x16x32_bf16 v[224:227], a[160:163], a[112:115], v[224:227]
    s_waitcnt lgkmcnt(7)
    ds_read_b64_tr_b16 a[182:183], v34 offset:12288
    ds_read_b64_tr_b16 a[184:185], v35 offset:0
    v_mfma_f32_16x16x32_bf16 v[224:227], a[164:167], a[120:123], v[224:227]
    ds_read_b64_tr_b16 a[186:187], v35 offset:4096
    v_mul_f32 v164, s36, v164
    v_mfma_f32_16x16x32_bf16 v[228:231], a[160:163], a[116:119], v[228:231]
    ds_read_b64_tr_b16 a[188:189], v35 offset:8192
    v_mul_f32 v165, s36, v165
    v_mfma_f32_16x16x32_bf16 v[228:231], a[164:167], a[124:127], v[228:231]
    s_waitcnt lgkmcnt(9)
    buffer_load_dwordx4 v41, s[12:15], s41 offen offset:3072 lds
    v_mfma_f32_16x16x32_bf16 v[232:235], a[168:171], a[112:115], v[232:235]
    s_waitcnt lgkmcnt(7)
    s_add_u32 s41, s41, 16384
    ds_read_b64_tr_b16 a[190:191], v35 offset:12288
    ds_read_b64_tr_b16 a[160:161], v28 offset:16384
    v_mfma_f32_16x16x32_bf16 v[232:235], a[172:175], a[120:123], v[232:235]
    ds_read_b64_tr_b16 a[162:163], v28 offset:20480
    v_mul_f32 v166, s36, v166
    v_mfma_f32_16x16x32_bf16 v[236:239], a[168:171], a[116:119], v[236:239]
    s_add_u32 m0, s42, 81920
    ds_read_b64_tr_b16 a[164:165], v28 offset:24576
    v_mul_f32 v167, s36, v167
    v_mfma_f32_16x16x32_bf16 v[236:239], a[172:175], a[124:127], v[236:239]
    s_waitcnt lgkmcnt(9)
    buffer_load_dwordx4 v40, s[12:15], s41 offen lds
    v_mfma_f32_16x16x32_bf16 v[240:243], a[176:179], a[112:115], v[240:243]
    s_waitcnt lgkmcnt(7)
    ds_read_b64_tr_b16 a[166:167], v28 offset:28672
    ds_read_b64_tr_b16 a[168:169], v29 offset:16384
    v_mfma_f32_16x16x32_bf16 v[240:243], a[180:183], a[120:123], v[240:243]
    ds_read_b64_tr_b16 a[170:171], v29 offset:20480
    v_mul_f32 v172, s36, v172
    v_mfma_f32_16x16x32_bf16 v[244:247], a[176:179], a[116:119], v[244:247]
    ds_read_b64_tr_b16 a[172:173], v29 offset:24576
    v_mul_f32 v173, s36, v173
    v_mfma_f32_16x16x32_bf16 v[244:247], a[180:183], a[124:127], v[244:247]
    s_waitcnt lgkmcnt(9)
    buffer_load_dwordx4 v41, s[12:15], s41 offen offset:1024 lds
    v_mfma_f32_16x16x32_bf16 v[248:251], a[184:187], a[112:115], v[248:251]
    s_waitcnt lgkmcnt(7)
    ds_read_b64_tr_b16 a[174:175], v29 offset:28672
    ds_read_b64_tr_b16 a[176:177], v30 offset:16384
    v_mfma_f32_16x16x32_bf16 v[248:251], a[188:191], a[120:123], v[248:251]
    ds_read_b64_tr_b16 a[178:179], v30 offset:20480
    v_mul_f32 v174, s36, v174
    v_mfma_f32_16x16x32_bf16 v[252:255], a[184:187], a[116:119], v[252:255]
    ds_read_b64_tr_b16 a[180:181], v30 offset:24576
    v_mul_f32 v175, s36, v175
    v_mfma_f32_16x16x32_bf16 v[252:255], a[188:191], a[124:127], v[252:255]
    s_waitcnt lgkmcnt(9)
    buffer_load_dwordx4 v40, s[12:15], s41 offen offset:2048 lds
    v_mfma_f32_16x16x32_bf16 v[192:195], a[160:163], a[128:131], v[192:195]
    s_waitcnt lgkmcnt(7)
    ds_read_b64_tr_b16 a[182:183], v30 offset:28672
    ds_read_b64_tr_b16 a[184:185], v31 offset:16384
    v_mfma_f32_16x16x32_bf16 v[192:195], a[164:167], a[136:139], v[192:195]
    ds_read_b64_tr_b16 a[186:187], v31 offset:20480
    v_cvt_pk_bf16_f32 v72, v160, v161
    v_mfma_f32_16x16x32_bf16 v[196:199], a[160:163], a[132:135], v[196:199]
    ds_read_b64_tr_b16 a[188:189], v31 offset:24576
    v_cvt_pk_bf16_f32 v73, v162, v163
    v_mfma_f32_16x16x32_bf16 v[196:199], a[164:167], a[140:143], v[196:199]
    s_waitcnt lgkmcnt(9)
    buffer_load_dwordx4 v41, s[12:15], s41 offen offset:3072 lds
    v_mfma_f32_16x16x32_bf16 v[200:203], a[168:171], a[128:131], v[200:203]
    s_waitcnt lgkmcnt(7)
    s_add_u32 s41, s41, 16384
    ds_read_b64_tr_b16 a[190:191], v31 offset:28672
    ds_read_b64_tr_b16 a[160:161], v32 offset:16384
    v_mfma_f32_16x16x32_bf16 v[200:203], a[172:175], a[136:139], v[200:203]
    ds_read_b64_tr_b16 a[162:163], v32 offset:20480
    v_cvt_pk_bf16_f32 v74, v168, v169
    v_mfma_f32_16x16x32_bf16 v[204:207], a[168:171], a[132:135], v[204:207]
    ds_read_b64_tr_b16 a[164:165], v32 offset:24576
    v_cvt_pk_bf16_f32 v75, v170, v171
    v_mfma_f32_16x16x32_bf16 v[204:207], a[172:175], a[140:143], v[204:207]
    s_waitcnt lgkmcnt(9)
    ds_read_b64_tr_b16 a[166:167], v32 offset:28672
    v_cvt_pk_bf16_f32 v88, v164, v165
    v_mfma_f32_16x16x32_bf16 v[208:211], a[176:179], a[128:131], v[208:211]
    s_waitcnt lgkmcnt(8)
    ds_read_b64_tr_b16 a[168:169], v33 offset:16384
    v_cvt_pk_bf16_f32 v89, v166, v167
    v_mfma_f32_16x16x32_bf16 v[208:211], a[180:183], a[136:139], v[208:211]
    ds_read_b64_tr_b16 a[170:171], v33 offset:20480
    v_cvt_pk_bf16_f32 v90, v172, v173
    v_mfma_f32_16x16x32_bf16 v[212:215], a[176:179], a[132:135], v[212:215]
    ds_read_b64_tr_b16 a[172:173], v33 offset:24576
    v_cvt_pk_bf16_f32 v91, v174, v175
    v_mfma_f32_16x16x32_bf16 v[212:215], a[180:183], a[140:143], v[212:215]
    s_waitcnt lgkmcnt(9)
    ds_read_b64_tr_b16 a[174:175], v33 offset:28672
    v_permlane32_swap_b32 v72, v74
    v_mfma_f32_16x16x32_bf16 v[216:219], a[184:187], a[128:131], v[216:219]
    s_waitcnt lgkmcnt(8)
    ds_read_b64_tr_b16 a[176:177], v34 offset:16384
    v_permlane32_swap_b32 v73, v75
    v_mfma_f32_16x16x32_bf16 v[216:219], a[188:191], a[136:139], v[216:219]
    ds_read_b64_tr_b16 a[178:179], v34 offset:20480
    v_permlane32_swap_b32 v88, v90
    v_mfma_f32_16x16x32_bf16 v[220:223], a[184:187], a[132:135], v[220:223]
    ds_read_b64_tr_b16 a[180:181], v34 offset:24576
    v_permlane32_swap_b32 v89, v91
    v_mfma_f32_16x16x32_bf16 v[220:223], a[188:191], a[140:143], v[220:223]
    s_waitcnt lgkmcnt(9)
    ds_read_b64_tr_b16 a[182:183], v34 offset:28672
    v_permlane16_swap_b32 v72, v74
    v_mfma_f32_16x16x32_bf16 v[224:227], a[160:163], a[128:131], v[224:227]
    s_waitcnt lgkmcnt(8)
    ds_read_b64_tr_b16 a[184:185], v35 offset:16384
    v_permlane16_swap_b32 v73, v75
    v_mfma_f32_16x16x32_bf16 v[224:227], a[164:167], a[136:139], v[224:227]
    ds_read_b64_tr_b16 a[186:187], v35 offset:20480
    v_permlane16_swap_b32 v88, v90
    v_mfma_f32_16x16x32_bf16 v[228:231], a[160:163], a[132:135], v[228:231]
    ds_read_b64_tr_b16 a[188:189], v35 offset:24576
    v_permlane16_swap_b32 v89, v91
    v_mfma_f32_16x16x32_bf16 v[228:231], a[164:167], a[140:143], v[228:231]
    s_waitcnt lgkmcnt(9)
    ds_read_b64_tr_b16 a[190:191], v35 offset:28672
    v_mul_f32 v176, s36, v176
    v_mfma_f32_16x16x32_bf16 v[232:235], a[168:171], a[128:131], v[232:235]
    s_waitcnt lgkmcnt(8)
    v_mul_f32 v177, s36, v177
    v_mul_f32 v178, s36, v178
    v_mfma_f32_16x16x32_bf16 v[232:235], a[172:175], a[136:139], v[232:235]
    v_mul_f32 v179, s36, v179
    v_mul_f32 v184, s36, v184
    v_mfma_f32_16x16x32_bf16 v[236:239], a[168:171], a[132:135], v[236:239]
    v_mul_f32 v185, s36, v185
    v_mul_f32 v186, s36, v186
    v_mfma_f32_16x16x32_bf16 v[236:239], a[172:175], a[140:143], v[236:239]
    s_waitcnt lgkmcnt(6)
    v_mul_f32 v187, s36, v187
    v_mul_f32 v180, s36, v180
    s_waitcnt vmcnt(16)
    s_barrier
    v_mfma_f32_16x16x32_bf16 v[240:243], a[176:179], a[128:131], v[240:243]
    s_waitcnt lgkmcnt(4)
    ds_read_b128 a[208:211], v8 offset:0
    v_mul_f32 v181, s36, v181
    v_mfma_f32_16x16x32_bf16 v[240:243], a[180:183], a[136:139], v[240:243]
    ds_read_b128 a[212:215], v9 offset:0
    v_mul_f32 v182, s36, v182
    v_mfma_f32_16x16x32_bf16 v[244:247], a[176:179], a[132:135], v[244:247]
    ds_read_b128 a[216:219], v10 offset:0
    v_mul_f32 v183, s36, v183
    v_mfma_f32_16x16x32_bf16 v[244:247], a[180:183], a[140:143], v[244:247]
    s_waitcnt lgkmcnt(5)
    ds_read_b128 a[220:223], v11 offset:0
    v_mul_f32 v188, s36, v188
    v_mfma_f32_16x16x32_bf16 v[248:251], a[184:187], a[128:131], v[248:251]
    s_waitcnt lgkmcnt(4)
    ds_read_b128 a[224:227], v8 offset:4096
    v_mul_f32 v189, s36, v189
    v_mfma_f32_16x16x32_bf16 v[248:251], a[188:191], a[136:139], v[248:251]
    v_mul_f32 v190, s36, v190
    v_mul_f32 v191, s36, v191
    v_mfma_f32_16x16x32_bf16 v[252:255], a[184:187], a[132:135], v[252:255]
    s_load_dwordx2 s[16:17], s[0:1], 88
    v_cvt_pk_bf16_f32 v76, v176, v177
    v_cvt_pk_bf16_f32 v77, v178, v179
    v_mfma_f32_16x16x32_bf16 v[252:255], a[188:191], a[140:143], v[252:255]
    v_cvt_pk_bf16_f32 v78, v184, v185
    v_cvt_pk_bf16_f32 v79, v186, v187
    v_cvt_pk_bf16_f32 v92, v180, v181
    v_cvt_pk_bf16_f32 v93, v182, v183
    v_cvt_pk_bf16_f32 v94, v188, v189
    v_cvt_pk_bf16_f32 v95, v190, v191
    v_permlane32_swap_b32 v76, v78
    v_permlane32_swap_b32 v77, v79
    v_permlane32_swap_b32 v92, v94
    v_permlane32_swap_b32 v93, v95
    v_permlane16_swap_b32 v76, v78
    v_permlane16_swap_b32 v77, v79
    v_permlane16_swap_b32 v92, v94
    v_permlane16_swap_b32 v93, v95
    s_mov_b32 s36, 1040356334
    s_mov_b32 s37, 1040356334
    v_mov_b32 v58, 0
    v_mov_b32 v59, 0
    v_mov_b32 v60, 0
    v_mov_b32 v61, 0
    v_pk_mul_f32 v[192:193], v[192:193], s[36:37]
    v_pk_mul_f32 v[194:195], v[194:195], s[36:37]
    v_pk_mul_f32 v[200:201], v[200:201], s[36:37]
    v_pk_mul_f32 v[202:203], v[202:203], s[36:37]
    v_pk_mul_f32 v[196:197], v[196:197], s[36:37]
    v_pk_mul_f32 v[198:199], v[198:199], s[36:37]
    v_pk_mul_f32 v[204:205], v[204:205], s[36:37]
    v_pk_mul_f32 v[206:207], v[206:207], s[36:37]
    v_mfma_f32_32x32x16_bf16 a[0:15], v[58:61], v[58:61], 0
    v_cvt_pk_bf16_f32 v96, v192, v193
    v_cvt_pk_bf16_f32 v97, v194, v195
    v_cvt_pk_bf16_f32 v98, v200, v201
    v_cvt_pk_bf16_f32 v99, v202, v203
    v_cvt_pk_bf16_f32 v112, v196, v197
    v_cvt_pk_bf16_f32 v113, v198, v199
    v_cvt_pk_bf16_f32 v114, v204, v205
    v_cvt_pk_bf16_f32 v115, v206, v207
    v_mfma_f32_32x32x16_bf16 a[16:31], v[58:61], v[58:61], 0
    v_permlane32_swap_b32 v96, v98
    v_permlane32_swap_b32 v97, v99
    v_permlane32_swap_b32 v112, v114
    v_permlane32_swap_b32 v113, v115
    v_permlane16_swap_b32 v96, v98
    v_permlane16_swap_b32 v97, v99
    v_permlane16_swap_b32 v112, v114
    v_permlane16_swap_b32 v113, v115
    v_pk_mul_f32 v[208:209], v[208:209], s[36:37]
    v_pk_mul_f32 v[210:211], v[210:211], s[36:37]
    v_pk_mul_f32 v[216:217], v[216:217], s[36:37]
    v_pk_mul_f32 v[218:219], v[218:219], s[36:37]
    v_pk_mul_f32 v[212:213], v[212:213], s[36:37]
    v_pk_mul_f32 v[214:215], v[214:215], s[36:37]
    v_pk_mul_f32 v[220:221], v[220:221], s[36:37]
    v_pk_mul_f32 v[222:223], v[222:223], s[36:37]
    v_mfma_f32_32x32x16_bf16 a[32:47], v[58:61], v[58:61], 0
    v_cvt_pk_bf16_f32 v100, v208, v209
    v_cvt_pk_bf16_f32 v101, v210, v211
    v_cvt_pk_bf16_f32 v102, v216, v217
    v_cvt_pk_bf16_f32 v103, v218, v219
    v_cvt_pk_bf16_f32 v116, v212, v213
    v_cvt_pk_bf16_f32 v117, v214, v215
    v_cvt_pk_bf16_f32 v118, v220, v221
    v_cvt_pk_bf16_f32 v119, v222, v223
    v_mfma_f32_32x32x16_bf16 a[48:63], v[58:61], v[58:61], 0
    v_permlane32_swap_b32 v100, v102
    v_permlane32_swap_b32 v101, v103
    v_permlane32_swap_b32 v116, v118
    v_permlane32_swap_b32 v117, v119
    v_permlane16_swap_b32 v100, v102
    v_permlane16_swap_b32 v101, v103
    v_permlane16_swap_b32 v116, v118
    v_permlane16_swap_b32 v117, v119
    v_pk_mul_f32 v[224:225], v[224:225], s[36:37]
    v_pk_mul_f32 v[226:227], v[226:227], s[36:37]
    v_pk_mul_f32 v[232:233], v[232:233], s[36:37]
    v_pk_mul_f32 v[234:235], v[234:235], s[36:37]
    v_pk_mul_f32 v[228:229], v[228:229], s[36:37]
    v_pk_mul_f32 v[230:231], v[230:231], s[36:37]
    v_pk_mul_f32 v[236:237], v[236:237], s[36:37]
    v_pk_mul_f32 v[238:239], v[238:239], s[36:37]
    v_mfma_f32_32x32x16_bf16 a[64:79], v[58:61], v[58:61], 0
    v_cvt_pk_bf16_f32 v104, v224, v225
    v_cvt_pk_bf16_f32 v105, v226, v227
    v_cvt_pk_bf16_f32 v106, v232, v233
    v_cvt_pk_bf16_f32 v107, v234, v235
    v_cvt_pk_bf16_f32 v120, v228, v229
    v_cvt_pk_bf16_f32 v121, v230, v231
    v_cvt_pk_bf16_f32 v122, v236, v237
    v_cvt_pk_bf16_f32 v123, v238, v239
    v_mfma_f32_32x32x16_bf16 a[80:95], v[58:61], v[58:61], 0
    v_permlane32_swap_b32 v104, v106
    v_permlane32_swap_b32 v105, v107
    v_permlane32_swap_b32 v120, v122
    v_permlane32_swap_b32 v121, v123
    v_permlane16_swap_b32 v104, v106
    v_permlane16_swap_b32 v105, v107
    v_permlane16_swap_b32 v120, v122
    v_permlane16_swap_b32 v121, v123
    v_pk_mul_f32 v[240:241], v[240:241], s[36:37]
    v_pk_mul_f32 v[242:243], v[242:243], s[36:37]
    v_pk_mul_f32 v[248:249], v[248:249], s[36:37]
    v_pk_mul_f32 v[250:251], v[250:251], s[36:37]
    v_pk_mul_f32 v[244:245], v[244:245], s[36:37]
    v_pk_mul_f32 v[246:247], v[246:247], s[36:37]
    v_pk_mul_f32 v[252:253], v[252:253], s[36:37]
    v_pk_mul_f32 v[254:255], v[254:255], s[36:37]
    v_mfma_f32_32x32x16_bf16 a[96:111], v[58:61], v[58:61], 0
    v_cvt_pk_bf16_f32 v108, v240, v241
    v_cvt_pk_bf16_f32 v109, v242, v243
    v_cvt_pk_bf16_f32 v110, v248, v249
    v_cvt_pk_bf16_f32 v111, v250, v251
    v_cvt_pk_bf16_f32 v124, v244, v245
    v_cvt_pk_bf16_f32 v125, v246, v247
    v_cvt_pk_bf16_f32 v126, v252, v253
    v_cvt_pk_bf16_f32 v127, v254, v255
    v_mfma_f32_32x32x16_bf16 a[112:127], v[58:61], v[58:61], 0
    v_permlane32_swap_b32 v108, v110
    v_permlane32_swap_b32 v109, v111
    v_permlane32_swap_b32 v124, v126
    v_permlane32_swap_b32 v125, v127
    v_permlane16_swap_b32 v108, v110
    v_permlane16_swap_b32 v109, v111
    v_permlane16_swap_b32 v124, v126
    v_permlane16_swap_b32 v125, v127
    s_waitcnt lgkmcnt(0)
    v_mfma_f32_16x16x32_bf16 v[216:219], a[208:211], v[64:67], 0
    v_mfma_f32_16x16x32_bf16 v[216:219], a[212:215], v[68:71], v[216:219]
    v_mfma_f32_16x16x32_bf16 v[216:219], a[216:219], v[72:75], v[216:219]
    v_mfma_f32_16x16x32_bf16 v[216:219], a[220:223], v[76:79], v[216:219]
    v_mfma_f32_16x16x32_bf16 v[220:223], a[208:211], v[80:83], 0
    v_mfma_f32_16x16x32_bf16 v[220:223], a[212:215], v[84:87], v[220:223]
    v_mfma_f32_16x16x32_bf16 v[220:223], a[216:219], v[88:91], v[220:223]
    v_mfma_f32_16x16x32_bf16 v[220:223], a[220:223], v[92:95], v[220:223]
    v_mfma_f32_16x16x32_bf16 v[224:227], a[208:211], v[96:99], 0
    v_mfma_f32_16x16x32_bf16 v[224:227], a[212:215], v[100:103], v[224:227]
    v_mfma_f32_16x16x32_bf16 v[224:227], a[216:219], v[104:107], v[224:227]
    v_mfma_f32_16x16x32_bf16 v[224:227], a[220:223], v[108:111], v[224:227]
    v_mfma_f32_16x16x32_bf16 v[228:231], a[208:211], v[112:115], 0
    v_mfma_f32_16x16x32_bf16 v[228:231], a[212:215], v[116:119], v[228:231]
    v_mfma_f32_16x16x32_bf16 v[228:231], a[216:219], v[120:123], v[228:231]
    v_mfma_f32_16x16x32_bf16 v[228:231], a[220:223], v[124:127], v[228:231]
    v_mfma_f32_32x32x16_bf16 a[192:207], v[58:61], v[58:61], 0
    v_max3_f32 v232, v216, v217, v218
    v_max_f32 v232, v232, v219
    v_max3_f32 v233, v220, v221, v222
    v_max_f32 v233, v233, v223
    v_max3_f32 v234, v224, v225, v226
    v_max_f32 v234, v234, v227
    s_nop 0
    v_max3_f32 v235, v228, v229, v230
    v_max_f32 v235, v235, v231
    v_mov_b32 v236, v232
    v_mov_b32 v237, v233
    v_mov_b32 v238, v234
    v_mov_b32 v239, v235
    v_permlane16_swap_b32 v232, v236
    v_permlane16_swap_b32 v233, v237
    v_permlane16_swap_b32 v234, v238
    v_permlane16_swap_b32 v235, v239
    v_max_f32 v232, v232, v236
    v_max_f32 v233, v233, v237
    v_max_f32 v234, v234, v238
    v_max_f32 v235, v235, v239
    v_mov_b32 v236, v232
    v_mov_b32 v237, v233
    v_mov_b32 v238, v234
    v_mov_b32 v239, v235
    v_permlane32_swap_b32 v232, v236
    v_permlane32_swap_b32 v233, v237
    v_permlane32_swap_b32 v234, v238
    v_permlane32_swap_b32 v235, v239
    v_max_f32 v232, v232, v236
    v_max_f32 v233, v233, v237
    v_max_f32 v234, v234, v238
    v_max_f32 v235, v235, v239
Ltour3:
    s_cbranch_execz Ltour7
    v_sub_f32 v192, 3250585600, v232
    v_sub_f32 v193, 3250585600, v232
    v_sub_f32 v194, 3250585600, v232
    v_sub_f32 v195, 3250585600, v232
    v_sub_f32 v196, 3250585600, v233
    v_sub_f32 v197, 3250585600, v233
    v_sub_f32 v198, 3250585600, v233
    v_sub_f32 v199, 3250585600, v233
    v_sub_f32 v200, 3250585600, v234
    v_sub_f32 v201, 3250585600, v234
    v_sub_f32 v202, 3250585600, v234
    v_sub_f32 v203, 3250585600, v234
    v_sub_f32 v204, 3250585600, v235
    v_sub_f32 v205, 3250585600, v235
    v_sub_f32 v206, 3250585600, v235
    v_sub_f32 v207, 3250585600, v235
Lattn_stage0:
    s_mov_b32 s43, 7
    v_mfma_f32_16x16x32_bf16 v[208:211], a[208:211], v[64:67], v[192:195]
    s_lshl_b32 s53, s5, 4
    v_mfma_f32_16x16x32_bf16 v[208:211], a[212:215], v[68:71], v[208:211]
    s_add_u32 s53, s53, s4
    v_mfma_f32_16x16x32_bf16 v[208:211], a[216:219], v[72:75], v[208:211]
    s_lshl_b32 s53, s53, 2
    v_mfma_f32_16x16x32_bf16 v[208:211], a[220:223], v[76:79], v[208:211]
    s_add_u32 s53, s53, s3
    ds_read_b128 a[228:231], v9 offset:4096
    v_mfma_f32_16x16x32_bf16 v[212:215], a[208:211], v[80:83], v[196:199]
    s_mul_i32 s53, s53, 4608
    s_nop 3
    v_exp_f32 v208, v208
    v_mfma_f32_16x16x32_bf16 v[212:215], a[212:215], v[84:87], v[212:215]
    s_add_u32 s53, s53, 2621440
    v_exp_f32 v209, v209
    v_mfma_f32_16x16x32_bf16 v[212:215], a[216:219], v[88:91], v[212:215]
    s_lshr_b32 s44, s2, 5
    v_exp_f32 v210, v210
    v_mfma_f32_16x16x32_bf16 v[212:215], a[220:223], v[92:95], v[212:215]
    s_lshl_b32 s44, s44, 3
    v_exp_f32 v211, v211
    v_cvt_pk_bf16_f32 v128, v208, v209
    ds_read_b128 a[232:235], v10 offset:4096
    v_cvt_pk_bf16_f32 v129, v210, v211
    v_mfma_f32_16x16x32_bf16 v[208:211], a[208:211], v[96:99], v[200:203]
    s_and_b32 s37, s2, 7
    s_nop 0
    v_exp_f32 v212, v212
    v_mfma_f32_16x16x32_bf16 v[208:211], a[212:215], v[100:103], v[208:211]
    s_add_u32 s44, s44, s37
    v_exp_f32 v213, v213
    v_mfma_f32_16x16x32_bf16 v[208:211], a[216:219], v[104:107], v[208:211]
    s_lshl_b32 s44, s44, 2
    v_exp_f32 v214, v214
    v_mfma_f32_16x16x32_bf16 v[208:211], a[220:223], v[108:111], v[208:211]
    s_bfe_u32 s37, s2, 0x20003
    v_exp_f32 v215, v215
    v_cvt_pk_bf16_f32 v136, v212, v213
    ds_read_b128 a[236:239], v11 offset:4096
    v_cvt_pk_bf16_f32 v137, v214, v215
    v_mfma_f32_16x16x32_bf16 v[212:215], a[208:211], v[112:115], v[204:207]
    s_add_u32 s44, s44, s37
    s_nop 0
    v_exp_f32 v208, v208
    v_mfma_f32_16x16x32_bf16 v[212:215], a[212:215], v[116:119], v[212:215]
    s_add_u32 s44, s44, 72
    v_exp_f32 v209, v209
    v_mfma_f32_16x16x32_bf16 v[212:215], a[216:219], v[120:123], v[212:215]
    s_cmp_lt_u32 s44, 216
    s_cselect_b32 s37, 0, 2147483648
    v_exp_f32 v210, v210
    v_mfma_f32_16x16x32_bf16 v[212:215], a[220:223], v[124:127], v[212:215]
    s_lshl_b32 s44, s44, 5
    v_exp_f32 v211, v211
    v_cvt_pk_bf16_f32 v144, v208, v209
    ds_read_b128 a[208:211], v8 offset:8192
    v_cvt_pk_bf16_f32 v145, v210, v211
    v_mfma_f32_16x16x32_bf16 v[208:211], a[224:227], v[64:67], v[192:195]
    s_waitcnt lgkmcnt(3)
    s_or_b32 s44, s44, s37
    v_exp_f32 v212, v212
    v_mfma_f32_16x16x32_bf16 v[208:211], a[228:231], v[68:71], v[208:211]
    s_waitcnt lgkmcnt(2)
    s_mov_b32 s18, 3981312
    v_exp_f32 v213, v213
    v_mfma_f32_16x16x32_bf16 v[208:211], a[232:235], v[72:75], v[208:211]
    s_waitcnt lgkmcnt(1)
    s_lshr_b32 s6, s2, 3
    v_exp_f32 v214, v214
    v_mfma_f32_16x16x32_bf16 v[208:211], a[236:239], v[76:79], v[208:211]
    s_and_b32 s7, s2, 7
    v_exp_f32 v215, v215
    v_cvt_pk_bf16_f32 v152, v212, v213
    ds_read_b128 a[212:215], v9 offset:8192
    v_cvt_pk_bf16_f32 v153, v214, v215
    v_mfma_f32_16x16x32_bf16 v[212:215], a[224:227], v[80:83], v[196:199]
    s_mul_i32 s7, s7, 18
    s_nop 0
    v_exp_f32 v208, v208
    v_mfma_f32_16x16x32_bf16 v[212:215], a[228:231], v[84:87], v[212:215]
    s_add_u32 s7, s7, s6
    v_exp_f32 v209, v209
    v_mfma_f32_16x16x32_bf16 v[212:215], a[232:235], v[88:91], v[212:215]
    s_lshl_b32 s58, s7, 6
    v_exp_f32 v210, v210
    v_mfma_f32_16x16x32_bf16 v[212:215], a[236:239], v[92:95], v[212:215]
    s_mul_i32 s59, s7, 36864
    v_exp_f32 v211, v211
    v_cvt_pk_bf16_f32 v130, v208, v209
    ds_read_b128 a[216:219], v10 offset:8192
    v_cvt_pk_bf16_f32 v131, v210, v211
    v_mfma_f32_16x16x32_bf16 v[208:211], a[224:227], v[96:99], v[200:203]
    s_cmp_lt_u32 s6, 18
    s_cselect_b32 s7, 0, 2147483648
    v_exp_f32 v212, v212
    v_mfma_f32_16x16x32_bf16 v[208:211], a[228:231], v[100:103], v[208:211]
    s_or_b32 s58, s58, s7
    v_exp_f32 v213, v213
    v_mfma_f32_16x16x32_bf16 v[208:211], a[232:235], v[104:107], v[208:211]
    s_or_b32 s59, s59, s7
    v_exp_f32 v214, v214
    v_mfma_f32_16x16x32_bf16 v[208:211], a[236:239], v[108:111], v[208:211]
    s_and_b32 s7, s4, 1
    v_exp_f32 v215, v215
    v_cvt_pk_bf16_f32 v138, v212, v213
    ds_read_b128 a[220:223], v11 offset:8192
    v_cvt_pk_bf16_f32 v139, v214, v215
    s_mov_b32 s39, 221184
    s_mov_b32 s38, 27648
    v_mfma_f32_16x16x32_bf16 v[212:215], a[224:227], v[112:115], v[204:207]
    s_lshl_b32 s6, s7, 7
    v_exp_f32 v208, v208
    v_mfma_f32_16x16x32_bf16 v[212:215], a[228:231], v[116:119], v[212:215]
    s_xor_b32 s36, s4, 1
    v_exp_f32 v209, v209
    v_mfma_f32_16x16x32_bf16 v[212:215], a[232:235], v[120:123], v[212:215]
    s_mul_i32 s36, s36, 294912
    v_exp_f32 v210, v210
    v_mfma_f32_16x16x32_bf16 v[212:215], a[236:239], v[124:127], v[212:215]
    s_waitcnt lgkmcnt(3)
    s_add_u32 s46, s36, s6
    v_exp_f32 v211, v211
    v_cvt_pk_bf16_f32 v146, v208, v209
    ds_read_b128 a[224:227], v8 offset:12288
    v_cvt_pk_bf16_f32 v147, v210, v211
    v_mfma_f32_16x16x32_bf16 v[208:211], a[208:211], v[64:67], v[192:195]
    s_waitcnt lgkmcnt(3)
    s_lshl_b32 s36, s4, 8
    v_exp_f32 v212, v212
    v_mfma_f32_16x16x32_bf16 v[208:211], a[212:215], v[68:71], v[208:211]
    s_waitcnt lgkmcnt(2)
    s_add_u32 s56, s47, s36
    v_exp_f32 v213, v213
    v_mfma_f32_16x16x32_bf16 v[208:211], a[216:219], v[72:75], v[208:211]
    s_waitcnt lgkmcnt(1)
    s_lshr_b32 s36, s4, 1
    v_exp_f32 v214, v214
    v_mfma_f32_16x16x32_bf16 v[208:211], a[220:223], v[76:79], v[208:211]
    s_lshl_b32 s36, s36, 11
    v_exp_f32 v215, v215
    v_cvt_pk_bf16_f32 v154, v212, v213
    ds_read_b128 a[228:231], v9 offset:12288
    v_cvt_pk_bf16_f32 v155, v214, v215
    v_mfma_f32_16x16x32_bf16 v[212:215], a[208:211], v[80:83], v[196:199]
    s_lshl_b32 s7, s7, 8
    s_nop 0
    v_exp_f32 v208, v208
    v_mfma_f32_16x16x32_bf16 v[212:215], a[212:215], v[84:87], v[212:215]
    s_add_u32 s36, s36, s7
    v_exp_f32 v209, v209
    v_mfma_f32_16x16x32_bf16 v[212:215], a[216:219], v[88:91], v[212:215]
    s_add_u32 s93, s47, s36
    v_exp_f32 v210, v210
    v_mfma_f32_16x16x32_bf16 v[212:215], a[220:223], v[92:95], v[212:215]
    s_lshr_b32 s36, s4, 1
    v_exp_f32 v211, v211
    v_cvt_pk_bf16_f32 v132, v208, v209
    ds_read_b128 a[232:235], v10 offset:12288
    v_cvt_pk_bf16_f32 v133, v210, v211
    v_mfma_f32_16x16x32_bf16 v[208:211], a[208:211], v[96:99], v[200:203]
    s_lshl_b32 s36, s36, 4
    s_nop 0
    v_exp_f32 v212, v212
    v_mfma_f32_16x16x32_bf16 v[208:211], a[212:215], v[100:103], v[208:211]
    s_add_u32 s36, s36, s5
    v_exp_f32 v213, v213
    v_mfma_f32_16x16x32_bf16 v[208:211], a[216:219], v[104:107], v[208:211]
    s_lshl_b32 s36, s36, 9
    v_exp_f32 v214, v214
    v_mfma_f32_16x16x32_bf16 v[208:211], a[220:223], v[108:111], v[208:211]
    s_add_u32 s36, s36, s7
    v_exp_f32 v215, v215
    v_cvt_pk_bf16_f32 v140, v212, v213
    ds_read_b128 a[236:239], v11 offset:12288
    v_cvt_pk_bf16_f32 v141, v214, v215
    s_waitcnt vmcnt(4)
    s_barrier
    v_mfma_f32_16x16x32_bf16 v[212:215], a[208:211], v[112:115], v[204:207]
    s_lshl_b32 s36, s36, 8
    v_exp_f32 v208, v208
    v_mfma_f32_16x16x32_bf16 v[212:215], a[212:215], v[116:119], v[212:215]
    s_add_u32 m0, s42, 49152
    s_add_u32 s55, s36, 20971520
    v_exp_f32 v209, v209
    v_mfma_f32_16x16x32_bf16 v[212:215], a[216:219], v[120:123], v[212:215]
    s_add_u32 s7, s45, s6
    v_exp_f32 v210, v210
    v_mfma_f32_16x16x32_bf16 v[212:215], a[220:223], v[124:127], v[212:215]
    s_waitcnt lgkmcnt(3)
    s_xor_b32 s54, s92, 128
    v_exp_f32 v211, v211
    v_cvt_pk_bf16_f32 v148, v208, v209
    ds_read_b128 a[208:211], v8 offset:16384
    v_cvt_pk_bf16_f32 v149, v210, v211
    buffer_load_dwordx4 v36, s[8:11], s40 offen lds
    v_mfma_f32_16x16x32_bf16 v[208:211], a[224:227], v[64:67], v[192:195]
    s_waitcnt lgkmcnt(3)
    s_lshl_b32 s36, s3, 14
    v_exp_f32 v212, v212
    v_mfma_f32_16x16x32_bf16 v[208:211], a[228:231], v[68:71], v[208:211]
    s_waitcnt lgkmcnt(2)
    v_exp_f32 v213, v213
    v_mfma_f32_16x16x32_bf16 v[208:211], a[232:235], v[72:75], v[208:211]
    s_waitcnt lgkmcnt(1)
    v_exp_f32 v214, v214
    v_mfma_f32_16x16x32_bf16 v[208:211], a[236:239], v[76:79], v[208:211]
    v_exp_f32 v215, v215
    v_cvt_pk_bf16_f32 v156, v212, v213
    ds_read_b128 a[212:215], v9 offset:16384
    v_cvt_pk_bf16_f32 v157, v214, v215
    v_mfma_f32_16x16x32_bf16 v[212:215], a[224:227], v[80:83], v[196:199]
    s_nop 2
    v_exp_f32 v208, v208
    v_mfma_f32_16x16x32_bf16 v[212:215], a[228:231], v[84:87], v[212:215]
    v_exp_f32 v209, v209
    v_mfma_f32_16x16x32_bf16 v[212:215], a[232:235], v[88:91], v[212:215]
    v_exp_f32 v210, v210
    v_mfma_f32_16x16x32_bf16 v[212:215], a[236:239], v[92:95], v[212:215]
    v_exp_f32 v211, v211
    ds_read_b64_tr_b16 a[160:161], v20 offset:0
    v_cvt_pk_bf16_f32 v134, v208, v209
    v_lshrrev_b32 v51, 2, v0
    v_mul_u32_u24 v51, 9216, v51
    v_and_b32 v254, 3, v0
    v_lshl_add_u32 v254, v254, 4, v51
    v_lshlrev_b32 v255, 4, v0
    v_add_u32 v51, 98304, v255
    v_lshl_add_u32 v252, v1, 4, s36
    v_mov_b32 v224, 0
    v_mov_b32 v225, 0
    v_mov_b32 v226, 0
    v_mov_b32 v227, 0
    v_mov_b32 v228, 0
    v_mov_b32 v229, 0
    v_mov_b32 v230, 0
    v_mov_b32 v231, 0
    v_mov_b32 v248, -1
    v_mov_b32 v249, -1
    v_mov_b32 v250, -1
    v_mov_b32 v251, -1
    v_min_u32 v232, 41, v1
    v_lshlrev_b32 v232, 4, v232
    s_mov_b32 s57, s58
    s_lshl_b32 s6, s3, 10
    s_add_u32 s6, s6, 135168
    s_lshr_b32 s37, s2, 3
    s_mul_i32 s37, s37, -129024
    s_add_u32 s37, s37, 4128768
    ds_read_b64_tr_b16 a[162:163], v20 offset:4096
    ds_read_b128 a[216:219], v10 offset:16384
    v_cvt_pk_bf16_f32 v135, v210, v211
    buffer_load_dwordx4 v37, s[8:11], s40 offen offset:1024 lds
    v_mfma_f32_16x16x32_bf16 v[208:211], a[224:227], v[96:99], v[200:203]
    v_exp_f32 v212, v212
    v_mfma_f32_16x16x32_bf16 v[208:211], a[228:231], v[100:103], v[208:211]
    v_exp_f32 v213, v213
    v_mfma_f32_16x16x32_bf16 v[208:211], a[232:235], v[104:107], v[208:211]
    v_exp_f32 v214, v214
    v_mfma_f32_16x16x32_bf16 v[208:211], a[236:239], v[108:111], v[208:211]
    s_mov_b32 s52, s55
    v_exp_f32 v215, v215
    ds_read_b64_tr_b16 a[164:165], v20 offset:8192
    v_cvt_pk_bf16_f32 v142, v212, v213
    ds_read_b64_tr_b16 a[166:167], v20 offset:12288
    v_min_u32 v237, 19, v1
    v_lshl_add_u32 v237, v237, 7, s36
    v_lshl_add_u32 v238, v1, 7, s36
    ds_read_b128 a[220:223], v11 offset:16384
    v_cvt_pk_bf16_f32 v143, v214, v215
    buffer_load_dword v217, v57, s[32:35], s37 offen
    v_mfma_f32_16x16x32_bf16 v[212:215], a[224:227], v[112:115], v[204:207]
    v_exp_f32 v208, v208
    v_mfma_f32_16x16x32_bf16 v[212:215], a[228:231], v[116:119], v[212:215]
    v_exp_f32 v209, v209
    v_mfma_f32_16x16x32_bf16 v[212:215], a[232:235], v[120:123], v[212:215]
    s_mul_i32 s37, s5, 18432
    v_exp_f32 v210, v210
    v_mfma_f32_16x16x32_bf16 v[212:215], a[236:239], v[124:127], v[212:215]
    s_add_u32 s37, s37, s45
    v_exp_f32 v211, v211
    ds_read_b64_tr_b16 a[168:169], v21 offset:0
    v_cvt_pk_bf16_f32 v150, v208, v209
    ds_read_b64_tr_b16 a[170:171], v21 offset:4096
    v_min_u32 v236, 143, v0
    v_lshl_add_u32 v236, v236, 7, s37
    v_mul_u32_u24 v235, 24, v0
    v_lshrrev_b32 v235, 8, v235
    v_lshl_add_u32 v235, v235, 7, s37
    ds_read_b128 a[224:227], v8 offset:20480
    v_cvt_pk_bf16_f32 v151, v210, v211
    s_waitcnt lgkmcnt(3)
    buffer_load_dwordx4 v38, s[8:11], s40 offen offset:2048 lds
    s_nop 0
    s_nop 0
    s_nop 0
    s_nop 0
    s_nop 0
Lattn_loop:
    v_mfma_f32_16x16x32_bf16 v[208:211], a[208:211], v[64:67], v[192:195]
    v_exp_f32 v212, v212
    v_mfma_f32_16x16x32_bf16 v[208:211], a[212:215], v[68:71], v[208:211]
    v_exp_f32 v213, v213
    v_mfma_f32_16x16x32_bf16 v[208:211], a[216:219], v[72:75], v[208:211]
    v_exp_f32 v214, v214
    v_mfma_f32_16x16x32_bf16 v[208:211], a[220:223], v[76:79], v[208:211]
    v_exp_f32 v215, v215
    v_mfma_f32_16x16x32_bf16 a[0:3], a[160:163], v[128:131], a[0:3]
    ds_read_b64_tr_b16 a[172:173], v21 offset:8192
    v_cvt_pk_bf16_f32 v158, v212, v213
    v_mfma_f32_16x16x32_bf16 a[0:3], a[164:167], v[132:135], a[0:3]
    ds_read_b64_tr_b16 a[174:175], v21 offset:12288
    v_mfma_f32_16x16x32_bf16 a[4:7], a[160:163], v[136:139], a[4:7]
    ds_read_b128 a[228:231], v9 offset:20480
    v_cvt_pk_bf16_f32 v159, v214, v215
    v_mfma_f32_16x16x32_bf16 a[4:7], a[164:167], v[140:143], a[4:7]
    v_mfma_f32_16x16x32_bf16 v[212:215], a[208:211], v[80:83], v[196:199]
    v_exp_f32 v208, v208
    v_mfma_f32_16x16x32_bf16 v[212:215], a[212:215], v[84:87], v[212:215]
    v_exp_f32 v209, v209
    v_mfma_f32_16x16x32_bf16 v[212:215], a[216:219], v[88:91], v[212:215]
    v_exp_f32 v210, v210
    v_mfma_f32_16x16x32_bf16 v[212:215], a[220:223], v[92:95], v[212:215]
    v_exp_f32 v211, v211
    v_mfma_f32_16x16x32_bf16 a[8:11], a[160:163], v[144:147], a[8:11]
    ds_read_b64_tr_b16 a[176:177], v22 offset:0
    v_cvt_pk_bf16_f32 v160, v208, v209
    v_mfma_f32_16x16x32_bf16 a[8:11], a[164:167], v[148:151], a[8:11]
    ds_read_b64_tr_b16 a[178:179], v22 offset:4096
    v_mfma_f32_16x16x32_bf16 a[12:15], a[160:163], v[152:155], a[12:15]
    ds_read_b128 a[232:235], v10 offset:20480
    v_cvt_pk_bf16_f32 v161, v210, v211
    v_mfma_f32_16x16x32_bf16 a[12:15], a[164:167], v[156:159], a[12:15]
    s_waitcnt lgkmcnt(3)
    buffer_load_dwordx4 v39, s[8:11], s40 offen offset:3072 lds
    v_mfma_f32_16x16x32_bf16 v[208:211], a[208:211], v[96:99], v[200:203]
    v_exp_f32 v212, v212
    v_mfma_f32_16x16x32_bf16 v[208:211], a[212:215], v[100:103], v[208:211]
    s_add_u32 s40, s40, 16384
    v_exp_f32 v213, v213
    v_mfma_f32_16x16x32_bf16 v[208:211], a[216:219], v[104:107], v[208:211]
    s_mov_b32 m0, s6
    v_exp_f32 v214, v214
    v_mfma_f32_16x16x32_bf16 v[208:211], a[220:223], v[108:111], v[208:211]
    v_exp_f32 v215, v215
    v_mfma_f32_16x16x32_bf16 a[16:19], a[168:171], v[128:131], a[16:19]
    ds_read_b64_tr_b16 a[180:181], v22 offset:8192
    v_cvt_pk_bf16_f32 v168, v212, v213
    v_mfma_f32_16x16x32_bf16 a[16:19], a[172:175], v[132:135], a[16:19]
    ds_read_b64_tr_b16 a[182:183], v22 offset:12288
    v_mfma_f32_16x16x32_bf16 a[20:23], a[168:171], v[136:139], a[20:23]
    ds_read_b128 a[236:239], v11 offset:20480
    v_cvt_pk_bf16_f32 v169, v214, v215
    v_mfma_f32_16x16x32_bf16 a[20:23], a[172:175], v[140:143], a[20:23]
    buffer_load_dwordx4 v254, s[32:35], s57 offen  lds
    v_smfmac_f32_16x16x64_bf16 a[192:195], v[52:55], v[128:135], v50
    v_mfma_f32_16x16x32_bf16 v[212:215], a[208:211], v[112:115], v[204:207]
    v_exp_f32 v208, v208
    v_mfma_f32_16x16x32_bf16 v[212:215], a[212:215], v[116:119], v[212:215]
    s_add_u32 m0, s42, 98304
    v_exp_f32 v209, v209
    v_mfma_f32_16x16x32_bf16 v[212:215], a[216:219], v[120:123], v[212:215]
    v_exp_f32 v210, v210
    v_mfma_f32_16x16x32_bf16 v[212:215], a[220:223], v[124:127], v[212:215]
    v_exp_f32 v211, v211
    v_mfma_f32_16x16x32_bf16 a[24:27], a[168:171], v[144:147], a[24:27]
    ds_read_b64_tr_b16 a[184:185], v23 offset:0
    v_cvt_pk_bf16_f32 v176, v208, v209
    v_mfma_f32_16x16x32_bf16 a[24:27], a[172:175], v[148:151], a[24:27]
    ds_read_b64_tr_b16 a[186:187], v23 offset:4096
    v_mfma_f32_16x16x32_bf16 a[28:31], a[168:171], v[152:155], a[28:31]
    ds_read_b128 a[208:211], v8 offset:24576
    v_cvt_pk_bf16_f32 v177, v210, v211
    v_mfma_f32_16x16x32_bf16 a[28:31], a[172:175], v[156:159], a[28:31]
    s_waitcnt lgkmcnt(3)
    buffer_load_dwordx4 v40, s[12:15], s41 offen lds
    v_mfma_f32_16x16x32_bf16 v[208:211], a[224:227], v[64:67], v[192:195]
    v_exp_f32 v212, v212
    v_mfma_f32_16x16x32_bf16 v[208:211], a[228:231], v[68:71], v[208:211]
    s_add_u32 s6, s6, 4096
    v_exp_f32 v213, v213
    v_mfma_f32_16x16x32_bf16 v[208:211], a[232:235], v[72:75], v[208:211]
    s_add_u32 s57, s57, 589824
    v_exp_f32 v214, v214
    v_mfma_f32_16x16x32_bf16 v[208:211], a[236:239], v[76:79], v[208:211]
    v_exp_f32 v215, v215
    v_mfma_f32_16x16x32_bf16 a[32:35], a[176:179], v[128:131], a[32:35]
    ds_read_b64_tr_b16 a[188:189], v23 offset:8192
    v_cvt_pk_bf16_f32 v184, v212, v213
    v_mfma_f32_16x16x32_bf16 a[32:35], a[180:183], v[132:135], a[32:35]
    ds_read_b64_tr_b16 a[190:191], v23 offset:12288
    v_mfma_f32_16x16x32_bf16 a[36:39], a[176:179], v[136:139], a[36:39]
    ds_read_b128 a[212:215], v9 offset:24576
    v_cvt_pk_bf16_f32 v185, v214, v215
    v_mfma_f32_16x16x32_bf16 a[36:39], a[180:183], v[140:143], a[36:39]
    v_smfmac_f32_16x16x64_bf16 a[196:199], v[52:55], v[136:143], v50
    v_mfma_f32_16x16x32_bf16 v[212:215], a[224:227], v[80:83], v[196:199]
    v_exp_f32 v208, v208
    v_mfma_f32_16x16x32_bf16 v[212:215], a[228:231], v[84:87], v[212:215]
    v_exp_f32 v209, v209
    v_mfma_f32_16x16x32_bf16 v[212:215], a[232:235], v[88:91], v[212:215]
    v_exp_f32 v210, v210
    v_mfma_f32_16x16x32_bf16 v[212:215], a[236:239], v[92:95], v[212:215]
    v_exp_f32 v211, v211
    v_mfma_f32_16x16x32_bf16 a[40:43], a[176:179], v[144:147], a[40:43]
    ds_read_b64_tr_b16 a[160:161], v24 offset:0
    v_cvt_pk_bf16_f32 v162, v208, v209
    v_mfma_f32_16x16x32_bf16 a[40:43], a[180:183], v[148:151], a[40:43]
    ds_read_b64_tr_b16 a[162:163], v24 offset:4096
    v_mfma_f32_16x16x32_bf16 a[44:47], a[176:179], v[152:155], a[44:47]
    ds_read_b128 a[216:219], v10 offset:24576
    v_cvt_pk_bf16_f32 v163, v210, v211
    v_mfma_f32_16x16x32_bf16 a[44:47], a[180:183], v[156:159], a[44:47]
    s_waitcnt lgkmcnt(3)
    buffer_load_dwordx4 v41, s[12:15], s41 offen offset:1024 lds
    v_mfma_f32_16x16x32_bf16 v[208:211], a[224:227], v[96:99], v[200:203]
    v_exp_f32 v212, v212
    v_mfma_f32_16x16x32_bf16 v[208:211], a[228:231], v[100:103], v[208:211]
    v_exp_f32 v213, v213
    v_mfma_f32_16x16x32_bf16 v[208:211], a[232:235], v[104:107], v[208:211]
    v_exp_f32 v214, v214
    v_mfma_f32_16x16x32_bf16 v[208:211], a[236:239], v[108:111], v[208:211]
    v_exp_f32 v215, v215
    v_mfma_f32_16x16x32_bf16 a[48:51], a[184:187], v[128:131], a[48:51]
    ds_read_b64_tr_b16 a[164:165], v24 offset:8192
    v_cvt_pk_bf16_f32 v170, v212, v213
    v_mfma_f32_16x16x32_bf16 a[48:51], a[188:191], v[132:135], a[48:51]
    ds_read_b64_tr_b16 a[166:167], v24 offset:12288
    v_mfma_f32_16x16x32_bf16 a[52:55], a[184:187], v[136:139], a[52:55]
    ds_read_b128 a[220:223], v11 offset:24576
    v_cvt_pk_bf16_f32 v171, v214, v215
    v_mfma_f32_16x16x32_bf16 a[52:55], a[188:191], v[140:143], a[52:55]
    v_smfmac_f32_16x16x64_bf16 a[200:203], v[52:55], v[144:151], v50
    v_mfma_f32_16x16x32_bf16 v[212:215], a[224:227], v[112:115], v[204:207]
    v_exp_f32 v208, v208
    v_mfma_f32_16x16x32_bf16 v[212:215], a[228:231], v[116:119], v[212:215]
    v_exp_f32 v209, v209
    v_mfma_f32_16x16x32_bf16 v[212:215], a[232:235], v[120:123], v[212:215]
    v_exp_f32 v210, v210
    v_mfma_f32_16x16x32_bf16 v[212:215], a[236:239], v[124:127], v[212:215]
    v_exp_f32 v211, v211
    v_mfma_f32_16x16x32_bf16 a[56:59], a[184:187], v[144:147], a[56:59]
    ds_read_b64_tr_b16 a[168:169], v25 offset:0
    v_cvt_pk_bf16_f32 v178, v208, v209
    v_mfma_f32_16x16x32_bf16 a[56:59], a[188:191], v[148:151], a[56:59]
    ds_read_b64_tr_b16 a[170:171], v25 offset:4096
    v_mfma_f32_16x16x32_bf16 a[60:63], a[184:187], v[152:155], a[60:63]
    ds_read_b128 a[224:227], v8 offset:28672
    v_cvt_pk_bf16_f32 v179, v210, v211
    v_mfma_f32_16x16x32_bf16 a[60:63], a[188:191], v[156:159], a[60:63]
    s_waitcnt lgkmcnt(3)
    buffer_load_dwordx4 v40, s[12:15], s41 offen offset:2048 lds
    v_mfma_f32_16x16x32_bf16 v[208:211], a[208:211], v[64:67], v[192:195]
    v_exp_f32 v212, v212
    v_mfma_f32_16x16x32_bf16 v[208:211], a[212:215], v[68:71], v[208:211]
    v_exp_f32 v213, v213
    v_mfma_f32_16x16x32_bf16 v[208:211], a[216:219], v[72:75], v[208:211]
    v_exp_f32 v214, v214
    v_mfma_f32_16x16x32_bf16 v[208:211], a[220:223], v[76:79], v[208:211]
    v_exp_f32 v215, v215
    v_mfma_f32_16x16x32_bf16 a[64:67], a[160:163], v[128:131], a[64:67]
    ds_read_b64_tr_b16 a[172:173], v25 offset:8192
    v_cvt_pk_bf16_f32 v186, v212, v213
    v_mfma_f32_16x16x32_bf16 a[64:67], a[164:167], v[132:135], a[64:67]
    ds_read_b64_tr_b16 a[174:175], v25 offset:12288
    v_mfma_f32_16x16x32_bf16 a[68:71], a[160:163], v[136:139], a[68:71]
    ds_read_b128 a[228:231], v9 offset:28672
    v_cvt_pk_bf16_f32 v187, v214, v215
    v_mfma_f32_16x16x32_bf16 a[68:71], a[164:167], v[140:143], a[68:71]
    v_smfmac_f32_16x16x64_bf16 a[204:207], v[52:55], v[152:159], v50
    v_mfma_f32_16x16x32_bf16 v[212:215], a[208:211], v[80:83], v[196:199]
    v_exp_f32 v208, v208
    v_mfma_f32_16x16x32_bf16 v[212:215], a[212:215], v[84:87], v[212:215]
    v_exp_f32 v209, v209
    v_mfma_f32_16x16x32_bf16 v[212:215], a[216:219], v[88:91], v[212:215]
    v_exp_f32 v210, v210
    v_mfma_f32_16x16x32_bf16 v[212:215], a[220:223], v[92:95], v[212:215]
    v_exp_f32 v211, v211
    v_mfma_f32_16x16x32_bf16 a[72:75], a[160:163], v[144:147], a[72:75]
    ds_read_b64_tr_b16 a[176:177], v26 offset:0
    v_cvt_pk_bf16_f32 v164, v208, v209
    v_mfma_f32_16x16x32_bf16 a[72:75], a[164:167], v[148:151], a[72:75]
    ds_read_b64_tr_b16 a[178:179], v26 offset:4096
    v_mfma_f32_16x16x32_bf16 a[76:79], a[160:163], v[152:155], a[76:79]
    ds_read_b128 a[232:235], v10 offset:28672
    v_cvt_pk_bf16_f32 v165, v210, v211
    v_mfma_f32_16x16x32_bf16 a[76:79], a[164:167], v[156:159], a[76:79]
    s_waitcnt lgkmcnt(3)
    buffer_load_dwordx4 v41, s[12:15], s41 offen offset:3072 lds
    v_mfma_f32_16x16x32_bf16 v[208:211], a[208:211], v[96:99], v[200:203]
    v_exp_f32 v212, v212
    v_mfma_f32_16x16x32_bf16 v[208:211], a[212:215], v[100:103], v[208:211]
    s_add_u32 s41, s41, 16384
    v_exp_f32 v213, v213
    v_mfma_f32_16x16x32_bf16 v[208:211], a[216:219], v[104:107], v[208:211]
    v_exp_f32 v214, v214
    v_mfma_f32_16x16x32_bf16 v[208:211], a[220:223], v[108:111], v[208:211]
    v_exp_f32 v215, v215
    v_mfma_f32_16x16x32_bf16 a[80:83], a[168:171], v[128:131], a[80:83]
    ds_read_b64_tr_b16 a[180:181], v26 offset:8192
    v_cvt_pk_bf16_f32 v172, v212, v213
    v_mfma_f32_16x16x32_bf16 a[80:83], a[172:175], v[132:135], a[80:83]
    ds_read_b64_tr_b16 a[182:183], v26 offset:12288
    v_mfma_f32_16x16x32_bf16 a[84:87], a[168:171], v[136:139], a[84:87]
    ds_read_b128 a[236:239], v11 offset:28672
    v_cvt_pk_bf16_f32 v173, v214, v215
    v_mfma_f32_16x16x32_bf16 a[84:87], a[172:175], v[140:143], a[84:87]
    s_waitcnt vmcnt(10)
    s_barrier
    v_mfma_f32_16x16x32_bf16 v[212:215], a[208:211], v[112:115], v[204:207]
    v_exp_f32 v208, v208
    v_mfma_f32_16x16x32_bf16 v[212:215], a[212:215], v[116:119], v[212:215]
    s_add_u32 m0, s42, 0
    v_exp_f32 v209, v209
    v_mfma_f32_16x16x32_bf16 v[212:215], a[216:219], v[120:123], v[212:215]
    v_exp_f32 v210, v210
    v_mfma_f32_16x16x32_bf16 v[212:215], a[220:223], v[124:127], v[212:215]
    v_exp_f32 v211, v211
    v_mfma_f32_16x16x32_bf16 a[88:91], a[168:171], v[144:147], a[88:91]
    ds_read_b64_tr_b16 a[184:185], v27 offset:0
    v_cvt_pk_bf16_f32 v180, v208, v209
    v_mfma_f32_16x16x32_bf16 a[88:91], a[172:175], v[148:151], a[88:91]
    ds_read_b64_tr_b16 a[186:187], v27 offset:4096
    v_mfma_f32_16x16x32_bf16 a[92:95], a[168:171], v[152:155], a[92:95]
    ds_read_b128 a[208:211], v8 offset:32768
    v_cvt_pk_bf16_f32 v181, v210, v211
    v_mfma_f32_16x16x32_bf16 a[92:95], a[172:175], v[156:159], a[92:95]
    s_waitcnt lgkmcnt(3)
    buffer_load_dwordx4 v36, s[8:11], s40 offen lds
    v_mfma_f32_16x16x32_bf16 v[208:211], a[224:227], v[64:67], v[192:195]
    v_exp_f32 v212, v212
    v_mfma_f32_16x16x32_bf16 v[208:211], a[228:231], v[68:71], v[208:211]
    v_exp_f32 v213, v213
    v_mfma_f32_16x16x32_bf16 v[208:211], a[232:235], v[72:75], v[208:211]
    v_exp_f32 v214, v214
    v_mfma_f32_16x16x32_bf16 v[208:211], a[236:239], v[76:79], v[208:211]
    v_exp_f32 v215, v215
    v_mfma_f32_16x16x32_bf16 a[96:99], a[176:179], v[128:131], a[96:99]
    ds_read_b64_tr_b16 a[188:189], v27 offset:8192
    v_cvt_pk_bf16_f32 v188, v212, v213
    v_mfma_f32_16x16x32_bf16 a[96:99], a[180:183], v[132:135], a[96:99]
    ds_read_b64_tr_b16 a[190:191], v27 offset:12288
    v_mfma_f32_16x16x32_bf16 a[100:103], a[176:179], v[136:139], a[100:103]
    ds_read_b128 a[212:215], v9 offset:32768
    v_cvt_pk_bf16_f32 v189, v214, v215
    v_mfma_f32_16x16x32_bf16 a[100:103], a[180:183], v[140:143], a[100:103]
    v_mfma_f32_16x16x32_bf16 v[212:215], a[224:227], v[80:83], v[196:199]
    v_exp_f32 v208, v208
    v_mfma_f32_16x16x32_bf16 v[212:215], a[228:231], v[84:87], v[212:215]
    v_exp_f32 v209, v209
    v_mfma_f32_16x16x32_bf16 v[212:215], a[232:235], v[88:91], v[212:215]
    v_exp_f32 v210, v210
    v_mfma_f32_16x16x32_bf16 v[212:215], a[236:239], v[92:95], v[212:215]
    v_exp_f32 v211, v211
    v_mfma_f32_16x16x32_bf16 a[104:107], a[176:179], v[144:147], a[104:107]
    ds_read_b64_tr_b16 a[160:161], v20 offset:16384
    v_cvt_pk_bf16_f32 v166, v208, v209
    v_mfma_f32_16x16x32_bf16 a[104:107], a[180:183], v[148:151], a[104:107]
    ds_read_b64_tr_b16 a[162:163], v20 offset:20480
    v_mfma_f32_16x16x32_bf16 a[108:111], a[176:179], v[152:155], a[108:111]
    ds_read_b128 a[216:219], v10 offset:32768
    v_cvt_pk_bf16_f32 v167, v210, v211
    v_mfma_f32_16x16x32_bf16 a[108:111], a[180:183], v[156:159], a[108:111]
    s_waitcnt lgkmcnt(3)
    buffer_load_dwordx4 v37, s[8:11], s40 offen offset:1024 lds
    v_mfma_f32_16x16x32_bf16 v[208:211], a[224:227], v[96:99], v[200:203]
    v_exp_f32 v212, v212
    v_mfma_f32_16x16x32_bf16 v[208:211], a[228:231], v[100:103], v[208:211]
    v_exp_f32 v213, v213
    v_mfma_f32_16x16x32_bf16 v[208:211], a[232:235], v[104:107], v[208:211]
    v_exp_f32 v214, v214
    v_mfma_f32_16x16x32_bf16 v[208:211], a[236:239], v[108:111], v[208:211]
    v_exp_f32 v215, v215
    v_mfma_f32_16x16x32_bf16 a[112:115], a[184:187], v[128:131], a[112:115]
    ds_read_b64_tr_b16 a[164:165], v20 offset:24576
    v_cvt_pk_bf16_f32 v174, v212, v213
    v_mfma_f32_16x16x32_bf16 a[112:115], a[188:191], v[132:135], a[112:115]
    ds_read_b64_tr_b16 a[166:167], v20 offset:28672
    v_mfma_f32_16x16x32_bf16 a[116:119], a[184:187], v[136:139], a[116:119]
    ds_read_b128 a[220:223], v11 offset:32768
    v_cvt_pk_bf16_f32 v175, v214, v215
    v_mfma_f32_16x16x32_bf16 a[116:119], a[188:191], v[140:143], a[116:119]
    buffer_load_dwordx4 v[240:243], v7, s[16:19], s44 offen
    v_mfma_f32_16x16x32_bf16 v[212:215], a[224:227], v[112:115], v[204:207]
    v_exp_f32 v208, v208
    v_mfma_f32_16x16x32_bf16 v[212:215], a[228:231], v[116:119], v[212:215]
    v_exp_f32 v209, v209
    v_mfma_f32_16x16x32_bf16 v[212:215], a[232:235], v[120:123], v[212:215]
    v_exp_f32 v210, v210
    v_mfma_f32_16x16x32_bf16 v[212:215], a[236:239], v[124:127], v[212:215]
    s_add_u32 s44, s44, 884736
    v_exp_f32 v211, v211
    v_mfma_f32_16x16x32_bf16 a[120:123], a[184:187], v[144:147], a[120:123]
    ds_read_b64_tr_b16 a[168:169], v21 offset:16384
    v_cvt_pk_bf16_f32 v182, v208, v209
    v_mfma_f32_16x16x32_bf16 a[120:123], a[188:191], v[148:151], a[120:123]
    ds_read_b64_tr_b16 a[170:171], v21 offset:20480
    v_mfma_f32_16x16x32_bf16 a[124:127], a[184:187], v[152:155], a[124:127]
    ds_read_b128 a[224:227], v8 offset:36864
    v_cvt_pk_bf16_f32 v183, v210, v211
    v_mfma_f32_16x16x32_bf16 a[124:127], a[188:191], v[156:159], a[124:127]
    s_waitcnt lgkmcnt(3)
    buffer_load_dwordx4 v38, s[8:11], s40 offen offset:2048 lds
    v_mfma_f32_16x16x32_bf16 v[208:211], a[208:211], v[64:67], v[192:195]
Ltour4:
    s_cbranch_execz Ltour8
    v_exp_f32 v212, v212
    v_mfma_f32_16x16x32_bf16 v[208:211], a[212:215], v[68:71], v[208:211]
    v_exp_f32 v213, v213
    v_mfma_f32_16x16x32_bf16 v[208:211], a[216:219], v[72:75], v[208:211]
    v_exp_f32 v214, v214
    v_mfma_f32_16x16x32_bf16 v[208:211], a[220:223], v[76:79], v[208:211]
    v_exp_f32 v215, v215
    v_mfma_f32_16x16x32_bf16 a[0:3], a[160:163], v[160:163], a[0:3]
    ds_read_b64_tr_b16 a[172:173], v21 offset:24576
    v_cvt_pk_bf16_f32 v190, v212, v213
    v_mfma_f32_16x16x32_bf16 a[0:3], a[164:167], v[164:167], a[0:3]
    ds_read_b64_tr_b16 a[174:175], v21 offset:28672
    v_mfma_f32_16x16x32_bf16 a[4:7], a[160:163], v[168:171], a[4:7]
    ds_read_b128 a[228:231], v9 offset:36864
    v_cvt_pk_bf16_f32 v191, v214, v215
    v_mfma_f32_16x16x32_bf16 a[4:7], a[164:167], v[172:175], a[4:7]
    v_mfma_f32_16x16x32_bf16 v[212:215], a[208:211], v[80:83], v[196:199]
    v_exp_f32 v208, v208
    v_mfma_f32_16x16x32_bf16 v[212:215], a[212:215], v[84:87], v[212:215]
    v_exp_f32 v209, v209
    v_mfma_f32_16x16x32_bf16 v[212:215], a[216:219], v[88:91], v[212:215]
    v_exp_f32 v210, v210
    v_mfma_f32_16x16x32_bf16 v[212:215], a[220:223], v[92:95], v[212:215]
    v_exp_f32 v211, v211
    v_mfma_f32_16x16x32_bf16 a[8:11], a[160:163], v[176:179], a[8:11]
    ds_read_b64_tr_b16 a[176:177], v22 offset:16384
    v_cvt_pk_bf16_f32 v128, v208, v209
    v_mfma_f32_16x16x32_bf16 a[8:11], a[164:167], v[180:183], a[8:11]
    ds_read_b64_tr_b16 a[178:179], v22 offset:20480
    v_mfma_f32_16x16x32_bf16 a[12:15], a[160:163], v[184:187], a[12:15]
    ds_read_b128 a[232:235], v10 offset:36864
    v_cvt_pk_bf16_f32 v129, v210, v211
    v_mfma_f32_16x16x32_bf16 a[12:15], a[164:167], v[188:191], a[12:15]
    s_waitcnt lgkmcnt(3)
    buffer_load_dwordx4 v39, s[8:11], s40 offen offset:3072 lds
    v_mfma_f32_16x16x32_bf16 v[208:211], a[208:211], v[96:99], v[200:203]
    v_exp_f32 v212, v212
    v_mfma_f32_16x16x32_bf16 v[208:211], a[212:215], v[100:103], v[208:211]
    s_add_u32 s40, s40, 16384
    v_exp_f32 v213, v213
    v_mfma_f32_16x16x32_bf16 v[208:211], a[216:219], v[104:107], v[208:211]
    v_exp_f32 v214, v214
    v_mfma_f32_16x16x32_bf16 v[208:211], a[220:223], v[108:111], v[208:211]
    v_exp_f32 v215, v215
    v_mfma_f32_16x16x32_bf16 a[16:19], a[168:171], v[160:163], a[16:19]
    ds_read_b64_tr_b16 a[180:181], v22 offset:24576
    v_cvt_pk_bf16_f32 v136, v212, v213
    v_mfma_f32_16x16x32_bf16 a[16:19], a[172:175], v[164:167], a[16:19]
    ds_read_b64_tr_b16 a[182:183], v22 offset:28672
    v_mfma_f32_16x16x32_bf16 a[20:23], a[168:171], v[168:171], a[20:23]
    ds_read_b128 a[236:239], v11 offset:36864
    v_cvt_pk_bf16_f32 v137, v214, v215
    v_mfma_f32_16x16x32_bf16 a[20:23], a[172:175], v[172:175], a[20:23]
    v_smfmac_f32_16x16x64_bf16 a[192:195], v[52:55], v[160:167], v50
    v_mfma_f32_16x16x32_bf16 v[212:215], a[208:211], v[112:115], v[204:207]
    v_exp_f32 v208, v208
    v_mfma_f32_16x16x32_bf16 v[212:215], a[212:215], v[116:119], v[212:215]
    s_add_u32 m0, s42, 114688
    v_exp_f32 v209, v209
    v_mfma_f32_16x16x32_bf16 v[212:215], a[216:219], v[120:123], v[212:215]
    v_exp_f32 v210, v210
    v_mfma_f32_16x16x32_bf16 v[212:215], a[220:223], v[124:127], v[212:215]
    v_exp_f32 v211, v211
    v_mfma_f32_16x16x32_bf16 a[24:27], a[168:171], v[176:179], a[24:27]
    ds_read_b64_tr_b16 a[184:185], v23 offset:16384
    v_cvt_pk_bf16_f32 v144, v208, v209
    v_mfma_f32_16x16x32_bf16 a[24:27], a[172:175], v[180:183], a[24:27]
    ds_read_b64_tr_b16 a[186:187], v23 offset:20480
    v_mfma_f32_16x16x32_bf16 a[28:31], a[168:171], v[184:187], a[28:31]
    ds_read_b128 a[208:211], v8 offset:40960
    v_cvt_pk_bf16_f32 v145, v210, v211
    v_mfma_f32_16x16x32_bf16 a[28:31], a[172:175], v[188:191], a[28:31]
    s_waitcnt lgkmcnt(3)
    buffer_load_dwordx4 v40, s[12:15], s41 offen lds
    v_mfma_f32_16x16x32_bf16 v[208:211], a[224:227], v[64:67], v[192:195]
    v_exp_f32 v212, v212
    v_mfma_f32_16x16x32_bf16 v[208:211], a[228:231], v[68:71], v[208:211]
    v_exp_f32 v213, v213
    v_mfma_f32_16x16x32_bf16 v[208:211], a[232:235], v[72:75], v[208:211]
    v_exp_f32 v214, v214
    v_mfma_f32_16x16x32_bf16 v[208:211], a[236:239], v[76:79], v[208:211]
    v_exp_f32 v215, v215
    v_mfma_f32_16x16x32_bf16 a[32:35], a[176:179], v[160:163], a[32:35]
    ds_read_b64_tr_b16 a[188:189], v23 offset:24576
    v_cvt_pk_bf16_f32 v152, v212, v213
    v_mfma_f32_16x16x32_bf16 a[32:35], a[180:183], v[164:167], a[32:35]
    ds_read_b64_tr_b16 a[190:191], v23 offset:28672
    v_mfma_f32_16x16x32_bf16 a[36:39], a[176:179], v[168:171], a[36:39]
    ds_read_b128 a[212:215], v9 offset:40960
    v_cvt_pk_bf16_f32 v153, v214, v215
    v_mfma_f32_16x16x32_bf16 a[36:39], a[180:183], v[172:175], a[36:39]
    v_smfmac_f32_16x16x64_bf16 a[196:199], v[52:55], v[168:175], v50
    v_mfma_f32_16x16x32_bf16 v[212:215], a[224:227], v[80:83], v[196:199]
    v_exp_f32 v208, v208
    v_mfma_f32_16x16x32_bf16 v[212:215], a[228:231], v[84:87], v[212:215]
    v_exp_f32 v209, v209
    v_mfma_f32_16x16x32_bf16 v[212:215], a[232:235], v[88:91], v[212:215]
    v_exp_f32 v210, v210
    v_mfma_f32_16x16x32_bf16 v[212:215], a[236:239], v[92:95], v[212:215]
    v_exp_f32 v211, v211
    v_mfma_f32_16x16x32_bf16 a[40:43], a[176:179], v[176:179], a[40:43]
    ds_read_b64_tr_b16 a[160:161], v24 offset:16384
    v_cvt_pk_bf16_f32 v130, v208, v209
    v_mfma_f32_16x16x32_bf16 a[40:43], a[180:183], v[180:183], a[40:43]
    ds_read_b64_tr_b16 a[162:163], v24 offset:20480
    v_mfma_f32_16x16x32_bf16 a[44:47], a[176:179], v[184:187], a[44:47]
    ds_read_b128 a[216:219], v10 offset:40960
    v_cvt_pk_bf16_f32 v131, v210, v211
    v_mfma_f32_16x16x32_bf16 a[44:47], a[180:183], v[188:191], a[44:47]
    s_waitcnt lgkmcnt(3)
    buffer_load_dwordx4 v41, s[12:15], s41 offen offset:1024 lds
    v_mfma_f32_16x16x32_bf16 v[208:211], a[224:227], v[96:99], v[200:203]
    v_exp_f32 v212, v212
    v_mfma_f32_16x16x32_bf16 v[208:211], a[228:231], v[100:103], v[208:211]
    v_exp_f32 v213, v213
    v_mfma_f32_16x16x32_bf16 v[208:211], a[232:235], v[104:107], v[208:211]
    v_exp_f32 v214, v214
    v_mfma_f32_16x16x32_bf16 v[208:211], a[236:239], v[108:111], v[208:211]
    v_exp_f32 v215, v215
    v_mfma_f32_16x16x32_bf16 a[48:51], a[184:187], v[160:163], a[48:51]
    ds_read_b64_tr_b16 a[164:165], v24 offset:24576
    v_cvt_pk_bf16_f32 v138, v212, v213
    v_mfma_f32_16x16x32_bf16 a[48:51], a[188:191], v[164:167], a[48:51]
    ds_read_b64_tr_b16 a[166:167], v24 offset:28672
    v_mfma_f32_16x16x32_bf16 a[52:55], a[184:187], v[168:171], a[52:55]
    ds_read_b128 a[220:223], v11 offset:40960
    v_cvt_pk_bf16_f32 v139, v214, v215
    v_mfma_f32_16x16x32_bf16 a[52:55], a[188:191], v[172:175], a[52:55]
    v_smfmac_f32_16x16x64_bf16 a[200:203], v[52:55], v[176:183], v50
    v_mfma_f32_16x16x32_bf16 v[212:215], a[224:227], v[112:115], v[204:207]
    v_exp_f32 v208, v208
    v_mfma_f32_16x16x32_bf16 v[212:215], a[228:231], v[116:119], v[212:215]
    v_exp_f32 v209, v209
    v_mfma_f32_16x16x32_bf16 v[212:215], a[232:235], v[120:123], v[212:215]
    v_exp_f32 v210, v210
    v_mfma_f32_16x16x32_bf16 v[212:215], a[236:239], v[124:127], v[212:215]
    v_exp_f32 v211, v211
    v_mfma_f32_16x16x32_bf16 a[56:59], a[184:187], v[176:179], a[56:59]
    ds_read_b64_tr_b16 a[168:169], v25 offset:16384
    v_cvt_pk_bf16_f32 v146, v208, v209
    v_mfma_f32_16x16x32_bf16 a[56:59], a[188:191], v[180:183], a[56:59]
    ds_read_b64_tr_b16 a[170:171], v25 offset:20480
    v_mfma_f32_16x16x32_bf16 a[60:63], a[184:187], v[184:187], a[60:63]
    ds_read_b128 a[224:227], v8 offset:45056
    v_cvt_pk_bf16_f32 v147, v210, v211
    v_mfma_f32_16x16x32_bf16 a[60:63], a[188:191], v[188:191], a[60:63]
    s_waitcnt lgkmcnt(3)
    buffer_load_dwordx4 v40, s[12:15], s41 offen offset:2048 lds
    v_mfma_f32_16x16x32_bf16 v[208:211], a[208:211], v[64:67], v[192:195]
    v_exp_f32 v212, v212
    v_mfma_f32_16x16x32_bf16 v[208:211], a[212:215], v[68:71], v[208:211]
    v_exp_f32 v213, v213
    v_mfma_f32_16x16x32_bf16 v[208:211], a[216:219], v[72:75], v[208:211]
    v_exp_f32 v214, v214
    v_mfma_f32_16x16x32_bf16 v[208:211], a[220:223], v[76:79], v[208:211]
    v_exp_f32 v215, v215
    v_mfma_f32_16x16x32_bf16 a[64:67], a[160:163], v[160:163], a[64:67]
    ds_read_b64_tr_b16 a[172:173], v25 offset:24576
    v_cvt_pk_bf16_f32 v154, v212, v213
    v_mfma_f32_16x16x32_bf16 a[64:67], a[164:167], v[164:167], a[64:67]
    ds_read_b64_tr_b16 a[174:175], v25 offset:28672
    v_mfma_f32_16x16x32_bf16 a[68:71], a[160:163], v[168:171], a[68:71]
    ds_read_b128 a[228:231], v9 offset:45056
    v_cvt_pk_bf16_f32 v155, v214, v215
    v_mfma_f32_16x16x32_bf16 a[68:71], a[164:167], v[172:175], a[68:71]
    v_smfmac_f32_16x16x64_bf16 a[204:207], v[52:55], v[184:191], v50
    v_mfma_f32_16x16x32_bf16 v[212:215], a[208:211], v[80:83], v[196:199]
    v_exp_f32 v208, v208
    v_mfma_f32_16x16x32_bf16 v[212:215], a[212:215], v[84:87], v[212:215]
    v_exp_f32 v209, v209
    v_mfma_f32_16x16x32_bf16 v[212:215], a[216:219], v[88:91], v[212:215]
    v_exp_f32 v210, v210
    v_mfma_f32_16x16x32_bf16 v[212:215], a[220:223], v[92:95], v[212:215]
    v_exp_f32 v211, v211
    v_mfma_f32_16x16x32_bf16 a[72:75], a[160:163], v[176:179], a[72:75]
    ds_read_b64_tr_b16 a[176:177], v26 offset:16384
    v_cvt_pk_bf16_f32 v132, v208, v209
    v_mfma_f32_16x16x32_bf16 a[72:75], a[164:167], v[180:183], a[72:75]
    ds_read_b64_tr_b16 a[178:179], v26 offset:20480
    v_mfma_f32_16x16x32_bf16 a[76:79], a[160:163], v[184:187], a[76:79]
    ds_read_b128 a[232:235], v10 offset:45056
    v_cvt_pk_bf16_f32 v133, v210, v211
    v_mfma_f32_16x16x32_bf16 a[76:79], a[164:167], v[188:191], a[76:79]
    s_waitcnt lgkmcnt(3)
    buffer_load_dwordx4 v41, s[12:15], s41 offen offset:3072 lds
    v_mfma_f32_16x16x32_bf16 v[208:211], a[208:211], v[96:99], v[200:203]
    v_exp_f32 v212, v212
    v_mfma_f32_16x16x32_bf16 v[208:211], a[212:215], v[100:103], v[208:211]
    s_add_u32 s41, s41, 16384
    v_exp_f32 v213, v213
    v_mfma_f32_16x16x32_bf16 v[208:211], a[216:219], v[104:107], v[208:211]
    v_exp_f32 v214, v214
    v_mfma_f32_16x16x32_bf16 v[208:211], a[220:223], v[108:111], v[208:211]
    v_exp_f32 v215, v215
    v_mfma_f32_16x16x32_bf16 a[80:83], a[168:171], v[160:163], a[80:83]
    ds_read_b64_tr_b16 a[180:181], v26 offset:24576
    v_cvt_pk_bf16_f32 v140, v212, v213
    v_mfma_f32_16x16x32_bf16 a[80:83], a[172:175], v[164:167], a[80:83]
    ds_read_b64_tr_b16 a[182:183], v26 offset:28672
    v_mfma_f32_16x16x32_bf16 a[84:87], a[168:171], v[168:171], a[84:87]
    ds_read_b128 a[236:239], v11 offset:45056
    v_cvt_pk_bf16_f32 v141, v214, v215
    v_mfma_f32_16x16x32_bf16 a[84:87], a[172:175], v[172:175], a[84:87]
    s_waitcnt vmcnt(9)
    s_barrier
    v_mfma_f32_16x16x32_bf16 v[212:215], a[208:211], v[112:115], v[204:207]
    v_exp_f32 v208, v208
    v_mfma_f32_16x16x32_bf16 v[212:215], a[212:215], v[116:119], v[212:215]
    s_add_u32 m0, s42, 16384
    v_exp_f32 v209, v209
    v_mfma_f32_16x16x32_bf16 v[212:215], a[216:219], v[120:123], v[212:215]
    v_exp_f32 v210, v210
    v_mfma_f32_16x16x32_bf16 v[212:215], a[220:223], v[124:127], v[212:215]
    v_exp_f32 v211, v211
    v_mfma_f32_16x16x32_bf16 a[88:91], a[168:171], v[176:179], a[88:91]
    ds_read_b64_tr_b16 a[184:185], v27 offset:16384
    v_cvt_pk_bf16_f32 v148, v208, v209
    v_mfma_f32_16x16x32_bf16 a[88:91], a[172:175], v[180:183], a[88:91]
    ds_read_b64_tr_b16 a[186:187], v27 offset:20480
    v_mfma_f32_16x16x32_bf16 a[92:95], a[168:171], v[184:187], a[92:95]
    ds_read_b128 a[208:211], v8 offset:49152
    v_cvt_pk_bf16_f32 v149, v210, v211
    v_mfma_f32_16x16x32_bf16 a[92:95], a[172:175], v[188:191], a[92:95]
    s_waitcnt lgkmcnt(3)
    buffer_load_dwordx4 v36, s[8:11], s40 offen lds
    v_mfma_f32_16x16x32_bf16 v[208:211], a[224:227], v[64:67], v[192:195]
    v_exp_f32 v212, v212
    v_mfma_f32_16x16x32_bf16 v[208:211], a[228:231], v[68:71], v[208:211]
    v_exp_f32 v213, v213
    v_mfma_f32_16x16x32_bf16 v[208:211], a[232:235], v[72:75], v[208:211]
    v_exp_f32 v214, v214
    v_mfma_f32_16x16x32_bf16 v[208:211], a[236:239], v[76:79], v[208:211]
    v_exp_f32 v215, v215
    v_mfma_f32_16x16x32_bf16 a[96:99], a[176:179], v[160:163], a[96:99]
    ds_read_b64_tr_b16 a[188:189], v27 offset:24576
    v_cvt_pk_bf16_f32 v156, v212, v213
    v_mfma_f32_16x16x32_bf16 a[96:99], a[180:183], v[164:167], a[96:99]
    ds_read_b64_tr_b16 a[190:191], v27 offset:28672
    v_mfma_f32_16x16x32_bf16 a[100:103], a[176:179], v[168:171], a[100:103]
    ds_read_b128 a[212:215], v9 offset:49152
    v_cvt_pk_bf16_f32 v157, v214, v215
    v_mfma_f32_16x16x32_bf16 a[100:103], a[180:183], v[172:175], a[100:103]
    buffer_load_dword v218, v57, s[80:83], s39 offen
    v_mfma_f32_16x16x32_bf16 v[212:215], a[224:227], v[80:83], v[196:199]
    v_exp_f32 v208, v208
    v_mfma_f32_16x16x32_bf16 v[212:215], a[228:231], v[84:87], v[212:215]
    v_exp_f32 v209, v209
    v_mfma_f32_16x16x32_bf16 v[212:215], a[232:235], v[88:91], v[212:215]
    v_exp_f32 v210, v210
    v_mfma_f32_16x16x32_bf16 v[212:215], a[236:239], v[92:95], v[212:215]
    v_exp_f32 v211, v211
    v_mfma_f32_16x16x32_bf16 a[104:107], a[176:179], v[176:179], a[104:107]
    ds_read_b64_tr_b16 a[160:161], v20 offset:32768
    v_cvt_pk_bf16_f32 v134, v208, v209
    v_mfma_f32_16x16x32_bf16 a[104:107], a[180:183], v[180:183], a[104:107]
    ds_read_b64_tr_b16 a[162:163], v20 offset:36864
    v_mfma_f32_16x16x32_bf16 a[108:111], a[176:179], v[184:187], a[108:111]
    ds_read_b128 a[216:219], v10 offset:49152
    v_cvt_pk_bf16_f32 v135, v210, v211
    v_mfma_f32_16x16x32_bf16 a[108:111], a[180:183], v[188:191], a[108:111]
    s_waitcnt lgkmcnt(3)
    buffer_load_dwordx4 v37, s[8:11], s40 offen offset:1024 lds
    v_mfma_f32_16x16x32_bf16 v[208:211], a[224:227], v[96:99], v[200:203]
    v_exp_f32 v212, v212
    v_mfma_f32_16x16x32_bf16 v[208:211], a[228:231], v[100:103], v[208:211]
    v_exp_f32 v213, v213
    v_mfma_f32_16x16x32_bf16 v[208:211], a[232:235], v[104:107], v[208:211]
    v_exp_f32 v214, v214
    v_mfma_f32_16x16x32_bf16 v[208:211], a[236:239], v[108:111], v[208:211]
    v_exp_f32 v215, v215
    v_mfma_f32_16x16x32_bf16 a[112:115], a[184:187], v[160:163], a[112:115]
    ds_read_b64_tr_b16 a[164:165], v20 offset:40960
    v_cvt_pk_bf16_f32 v142, v212, v213
    v_mfma_f32_16x16x32_bf16 a[112:115], a[188:191], v[164:167], a[112:115]
    ds_read_b64_tr_b16 a[166:167], v20 offset:45056
    v_mfma_f32_16x16x32_bf16 a[116:119], a[184:187], v[168:171], a[116:119]
    ds_read_b128 a[220:223], v11 offset:49152
    v_cvt_pk_bf16_f32 v143, v214, v215
    v_mfma_f32_16x16x32_bf16 a[116:119], a[188:191], v[172:175], a[116:119]
    buffer_store_dwordx4 v[248:251], v232, s[24:27], s53 offen sc1
    v_mfma_f32_16x16x32_bf16 v[212:215], a[224:227], v[112:115], v[204:207]
    v_exp_f32 v208, v208
    v_mfma_f32_16x16x32_bf16 v[212:215], a[228:231], v[116:119], v[212:215]
    v_exp_f32 v209, v209
    v_mfma_f32_16x16x32_bf16 v[212:215], a[232:235], v[120:123], v[212:215]
    v_exp_f32 v210, v210
    v_mfma_f32_16x16x32_bf16 v[212:215], a[236:239], v[124:127], v[212:215]
    s_add_u32 s53, s53, 656
    v_exp_f32 v211, v211
    v_mfma_f32_16x16x32_bf16 a[120:123], a[184:187], v[176:179], a[120:123]
    ds_read_b64_tr_b16 a[168:169], v21 offset:32768
    v_cvt_pk_bf16_f32 v150, v208, v209
    v_mfma_f32_16x16x32_bf16 a[120:123], a[188:191], v[180:183], a[120:123]
    ds_read_b64_tr_b16 a[170:171], v21 offset:36864
    v_mfma_f32_16x16x32_bf16 a[124:127], a[184:187], v[184:187], a[124:127]
    ds_read_b128 a[224:227], v8 offset:53248
    v_cvt_pk_bf16_f32 v151, v210, v211
    v_mfma_f32_16x16x32_bf16 a[124:127], a[188:191], v[188:191], a[124:127]
    s_waitcnt lgkmcnt(3)
    buffer_load_dwordx4 v38, s[8:11], s40 offen offset:2048 lds
    v_mfma_f32_16x16x32_bf16 v[208:211], a[208:211], v[64:67], v[192:195]
    v_exp_f32 v212, v212
    v_mfma_f32_16x16x32_bf16 v[208:211], a[212:215], v[68:71], v[208:211]
    v_exp_f32 v213, v213
    v_mfma_f32_16x16x32_bf16 v[208:211], a[216:219], v[72:75], v[208:211]
    v_exp_f32 v214, v214
    v_mfma_f32_16x16x32_bf16 v[208:211], a[220:223], v[76:79], v[208:211]
    v_exp_f32 v215, v215
    v_mfma_f32_16x16x32_bf16 a[0:3], a[160:163], v[128:131], a[0:3]
    ds_read_b64_tr_b16 a[172:173], v21 offset:40960
    v_cvt_pk_bf16_f32 v158, v212, v213
    v_mfma_f32_16x16x32_bf16 a[0:3], a[164:167], v[132:135], a[0:3]
    ds_read_b64_tr_b16 a[174:175], v21 offset:45056
    v_mfma_f32_16x16x32_bf16 a[4:7], a[160:163], v[136:139], a[4:7]
    ds_read_b128 a[228:231], v9 offset:53248
    v_cvt_pk_bf16_f32 v159, v214, v215
    v_mfma_f32_16x16x32_bf16 a[4:7], a[164:167], v[140:143], a[4:7]
    v_mfma_f32_16x16x32_bf16 v[212:215], a[208:211], v[80:83], v[196:199]
    v_exp_f32 v208, v208
    v_mfma_f32_16x16x32_bf16 v[212:215], a[212:215], v[84:87], v[212:215]
    v_exp_f32 v209, v209
    v_mfma_f32_16x16x32_bf16 v[212:215], a[216:219], v[88:91], v[212:215]
    v_exp_f32 v210, v210
    v_mfma_f32_16x16x32_bf16 v[212:215], a[220:223], v[92:95], v[212:215]
    v_exp_f32 v211, v211
    v_mfma_f32_16x16x32_bf16 a[8:11], a[160:163], v[144:147], a[8:11]
    ds_read_b64_tr_b16 a[176:177], v22 offset:32768
    v_cvt_pk_bf16_f32 v160, v208, v209
    v_mfma_f32_16x16x32_bf16 a[8:11], a[164:167], v[148:151], a[8:11]
    ds_read_b64_tr_b16 a[178:179], v22 offset:36864
    v_mfma_f32_16x16x32_bf16 a[12:15], a[160:163], v[152:155], a[12:15]
    ds_read_b128 a[232:235], v10 offset:53248
    v_cvt_pk_bf16_f32 v161, v210, v211
    v_mfma_f32_16x16x32_bf16 a[12:15], a[164:167], v[156:159], a[12:15]
    s_waitcnt lgkmcnt(3)
    buffer_load_dwordx4 v39, s[8:11], s40 offen offset:3072 lds
    v_mfma_f32_16x16x32_bf16 v[208:211], a[208:211], v[96:99], v[200:203]
    v_exp_f32 v212, v212
    v_mfma_f32_16x16x32_bf16 v[208:211], a[212:215], v[100:103], v[208:211]
    s_add_u32 s40, s40, 16384
    v_exp_f32 v213, v213
    v_mfma_f32_16x16x32_bf16 v[208:211], a[216:219], v[104:107], v[208:211]
    v_exp_f32 v214, v214
    v_mfma_f32_16x16x32_bf16 v[208:211], a[220:223], v[108:111], v[208:211]
    v_exp_f32 v215, v215
    v_mfma_f32_16x16x32_bf16 a[16:19], a[168:171], v[128:131], a[16:19]
    ds_read_b64_tr_b16 a[180:181], v22 offset:40960
    v_cvt_pk_bf16_f32 v168, v212, v213
    v_mfma_f32_16x16x32_bf16 a[16:19], a[172:175], v[132:135], a[16:19]
    ds_read_b64_tr_b16 a[182:183], v22 offset:45056
    v_mfma_f32_16x16x32_bf16 a[20:23], a[168:171], v[136:139], a[20:23]
    ds_read_b128 a[236:239], v11 offset:53248
    v_cvt_pk_bf16_f32 v169, v214, v215
    v_mfma_f32_16x16x32_bf16 a[20:23], a[172:175], v[140:143], a[20:23]
    v_smfmac_f32_16x16x64_bf16 a[192:195], v[52:55], v[128:135], v50
    v_mfma_f32_16x16x32_bf16 v[212:215], a[208:211], v[112:115], v[204:207]
    v_exp_f32 v208, v208
    v_mfma_f32_16x16x32_bf16 v[212:215], a[212:215], v[116:119], v[212:215]
    s_add_u32 m0, s42, 65536
    v_exp_f32 v209, v209
    v_mfma_f32_16x16x32_bf16 v[212:215], a[216:219], v[120:123], v[212:215]
    v_exp_f32 v210, v210
    v_mfma_f32_16x16x32_bf16 v[212:215], a[220:223], v[124:127], v[212:215]
    v_exp_f32 v211, v211
    v_mfma_f32_16x16x32_bf16 a[24:27], a[168:171], v[144:147], a[24:27]
    ds_read_b64_tr_b16 a[184:185], v23 offset:32768
    v_cvt_pk_bf16_f32 v176, v208, v209
    v_mfma_f32_16x16x32_bf16 a[24:27], a[172:175], v[148:151], a[24:27]
    ds_read_b64_tr_b16 a[186:187], v23 offset:36864
    v_mfma_f32_16x16x32_bf16 a[28:31], a[168:171], v[152:155], a[28:31]
    ds_read_b128 a[208:211], v8 offset:57344
    v_cvt_pk_bf16_f32 v177, v210, v211
    v_mfma_f32_16x16x32_bf16 a[28:31], a[172:175], v[156:159], a[28:31]
    s_waitcnt lgkmcnt(3)
    buffer_load_dwordx4 v40, s[12:15], s41 offen lds
    v_mfma_f32_16x16x32_bf16 v[208:211], a[224:227], v[64:67], v[192:195]
    v_exp_f32 v212, v212
    v_mfma_f32_16x16x32_bf16 v[208:211], a[228:231], v[68:71], v[208:211]
    v_exp_f32 v213, v213
    v_mfma_f32_16x16x32_bf16 v[208:211], a[232:235], v[72:75], v[208:211]
    v_exp_f32 v214, v214
    v_mfma_f32_16x16x32_bf16 v[208:211], a[236:239], v[76:79], v[208:211]
    v_exp_f32 v215, v215
    v_mfma_f32_16x16x32_bf16 a[32:35], a[176:179], v[128:131], a[32:35]
    ds_read_b64_tr_b16 a[188:189], v23 offset:40960
    v_cvt_pk_bf16_f32 v184, v212, v213
    v_mfma_f32_16x16x32_bf16 a[32:35], a[180:183], v[132:135], a[32:35]
    ds_read_b64_tr_b16 a[190:191], v23 offset:45056
    v_mfma_f32_16x16x32_bf16 a[36:39], a[176:179], v[136:139], a[36:39]
    ds_read_b128 a[212:215], v9 offset:57344
    v_cvt_pk_bf16_f32 v185, v214, v215
    v_mfma_f32_16x16x32_bf16 a[36:39], a[180:183], v[140:143], a[36:39]
    v_smfmac_f32_16x16x64_bf16 a[196:199], v[52:55], v[136:143], v50
    v_mfma_f32_16x16x32_bf16 v[212:215], a[224:227], v[80:83], v[196:199]
    v_exp_f32 v208, v208
    v_mfma_f32_16x16x32_bf16 v[212:215], a[228:231], v[84:87], v[212:215]
    v_exp_f32 v209, v209
    v_mfma_f32_16x16x32_bf16 v[212:215], a[232:235], v[88:91], v[212:215]
    v_exp_f32 v210, v210
    v_mfma_f32_16x16x32_bf16 v[212:215], a[236:239], v[92:95], v[212:215]
    v_exp_f32 v211, v211
    v_mfma_f32_16x16x32_bf16 a[40:43], a[176:179], v[144:147], a[40:43]
    ds_read_b64_tr_b16 a[160:161], v24 offset:32768
    v_cvt_pk_bf16_f32 v162, v208, v209
    v_mfma_f32_16x16x32_bf16 a[40:43], a[180:183], v[148:151], a[40:43]
    ds_read_b64_tr_b16 a[162:163], v24 offset:36864
    v_mfma_f32_16x16x32_bf16 a[44:47], a[176:179], v[152:155], a[44:47]
    ds_read_b128 a[216:219], v10 offset:57344
    v_cvt_pk_bf16_f32 v163, v210, v211
    v_mfma_f32_16x16x32_bf16 a[44:47], a[180:183], v[156:159], a[44:47]
    s_waitcnt lgkmcnt(3)
    buffer_load_dwordx4 v41, s[12:15], s41 offen offset:1024 lds
    v_mfma_f32_16x16x32_bf16 v[208:211], a[224:227], v[96:99], v[200:203]
    v_exp_f32 v212, v212
    v_mfma_f32_16x16x32_bf16 v[208:211], a[228:231], v[100:103], v[208:211]
    v_exp_f32 v213, v213
    v_mfma_f32_16x16x32_bf16 v[208:211], a[232:235], v[104:107], v[208:211]
    v_exp_f32 v214, v214
    v_mfma_f32_16x16x32_bf16 v[208:211], a[236:239], v[108:111], v[208:211]
    v_exp_f32 v215, v215
    v_mfma_f32_16x16x32_bf16 a[48:51], a[184:187], v[128:131], a[48:51]
    ds_read_b64_tr_b16 a[164:165], v24 offset:40960
    v_cvt_pk_bf16_f32 v170, v212, v213
    v_mfma_f32_16x16x32_bf16 a[48:51], a[188:191], v[132:135], a[48:51]
    ds_read_b64_tr_b16 a[166:167], v24 offset:45056
    v_mfma_f32_16x16x32_bf16 a[52:55], a[184:187], v[136:139], a[52:55]
    ds_read_b128 a[220:223], v11 offset:57344
    v_cvt_pk_bf16_f32 v171, v214, v215
    v_mfma_f32_16x16x32_bf16 a[52:55], a[188:191], v[140:143], a[52:55]
    v_smfmac_f32_16x16x64_bf16 a[200:203], v[52:55], v[144:151], v50
    v_mfma_f32_16x16x32_bf16 v[212:215], a[224:227], v[112:115], v[204:207]
    v_exp_f32 v208, v208
    v_mfma_f32_16x16x32_bf16 v[212:215], a[228:231], v[116:119], v[212:215]
    v_exp_f32 v209, v209
    v_mfma_f32_16x16x32_bf16 v[212:215], a[232:235], v[120:123], v[212:215]
    v_exp_f32 v210, v210
    v_mfma_f32_16x16x32_bf16 v[212:215], a[236:239], v[124:127], v[212:215]
    v_exp_f32 v211, v211
    v_mfma_f32_16x16x32_bf16 a[56:59], a[184:187], v[144:147], a[56:59]
    ds_read_b64_tr_b16 a[168:169], v25 offset:32768
    v_cvt_pk_bf16_f32 v178, v208, v209
    v_mfma_f32_16x16x32_bf16 a[56:59], a[188:191], v[148:151], a[56:59]
    ds_read_b64_tr_b16 a[170:171], v25 offset:36864
    v_mfma_f32_16x16x32_bf16 a[60:63], a[184:187], v[152:155], a[60:63]
    ds_read_b128 a[224:227], v8 offset:61440
    v_cvt_pk_bf16_f32 v179, v210, v211
    v_mfma_f32_16x16x32_bf16 a[60:63], a[188:191], v[156:159], a[60:63]
    s_waitcnt lgkmcnt(3)
    buffer_load_dwordx4 v40, s[12:15], s41 offen offset:2048 lds
    v_mfma_f32_16x16x32_bf16 v[208:211], a[208:211], v[64:67], v[192:195]
    v_exp_f32 v212, v212
    v_mfma_f32_16x16x32_bf16 v[208:211], a[212:215], v[68:71], v[208:211]
    v_exp_f32 v213, v213
    v_mfma_f32_16x16x32_bf16 v[208:211], a[216:219], v[72:75], v[208:211]
    v_exp_f32 v214, v214
    v_mfma_f32_16x16x32_bf16 v[208:211], a[220:223], v[76:79], v[208:211]
    v_exp_f32 v215, v215
    v_mfma_f32_16x16x32_bf16 a[64:67], a[160:163], v[128:131], a[64:67]
    ds_read_b64_tr_b16 a[172:173], v25 offset:40960
    v_cvt_pk_bf16_f32 v186, v212, v213
    v_mfma_f32_16x16x32_bf16 a[64:67], a[164:167], v[132:135], a[64:67]
    ds_read_b64_tr_b16 a[174:175], v25 offset:45056
    v_mfma_f32_16x16x32_bf16 a[68:71], a[160:163], v[136:139], a[68:71]
    ds_read_b128 a[228:231], v9 offset:61440
    v_cvt_pk_bf16_f32 v187, v214, v215
    v_mfma_f32_16x16x32_bf16 a[68:71], a[164:167], v[140:143], a[68:71]
    v_smfmac_f32_16x16x64_bf16 a[204:207], v[52:55], v[152:159], v50
    v_mfma_f32_16x16x32_bf16 v[212:215], a[208:211], v[80:83], v[196:199]
    v_exp_f32 v208, v208
    v_mfma_f32_16x16x32_bf16 v[212:215], a[212:215], v[84:87], v[212:215]
    v_exp_f32 v209, v209
    v_mfma_f32_16x16x32_bf16 v[212:215], a[216:219], v[88:91], v[212:215]
    v_exp_f32 v210, v210
    v_mfma_f32_16x16x32_bf16 v[212:215], a[220:223], v[92:95], v[212:215]
    v_exp_f32 v211, v211
    v_mfma_f32_16x16x32_bf16 a[72:75], a[160:163], v[144:147], a[72:75]
    ds_read_b64_tr_b16 a[176:177], v26 offset:32768
    v_cvt_pk_bf16_f32 v164, v208, v209
    v_mfma_f32_16x16x32_bf16 a[72:75], a[164:167], v[148:151], a[72:75]
    ds_read_b64_tr_b16 a[178:179], v26 offset:36864
    v_mfma_f32_16x16x32_bf16 a[76:79], a[160:163], v[152:155], a[76:79]
    ds_read_b128 a[232:235], v10 offset:61440
    v_cvt_pk_bf16_f32 v165, v210, v211
    v_mfma_f32_16x16x32_bf16 a[76:79], a[164:167], v[156:159], a[76:79]
    s_waitcnt lgkmcnt(3)
    buffer_load_dwordx4 v41, s[12:15], s41 offen offset:3072 lds
    v_mfma_f32_16x16x32_bf16 v[208:211], a[208:211], v[96:99], v[200:203]
    v_exp_f32 v212, v212
    v_mfma_f32_16x16x32_bf16 v[208:211], a[212:215], v[100:103], v[208:211]
    s_add_u32 s41, s41, 16384
    v_exp_f32 v213, v213
    v_mfma_f32_16x16x32_bf16 v[208:211], a[216:219], v[104:107], v[208:211]
    v_exp_f32 v214, v214
    v_mfma_f32_16x16x32_bf16 v[208:211], a[220:223], v[108:111], v[208:211]
    v_exp_f32 v215, v215
    v_mfma_f32_16x16x32_bf16 a[80:83], a[168:171], v[128:131], a[80:83]
    ds_read_b64_tr_b16 a[180:181], v26 offset:40960
    v_cvt_pk_bf16_f32 v172, v212, v213
    v_mfma_f32_16x16x32_bf16 a[80:83], a[172:175], v[132:135], a[80:83]
    ds_read_b64_tr_b16 a[182:183], v26 offset:45056
    v_mfma_f32_16x16x32_bf16 a[84:87], a[168:171], v[136:139], a[84:87]
    ds_read_b128 a[236:239], v11 offset:61440
    v_cvt_pk_bf16_f32 v173, v214, v215
    v_mfma_f32_16x16x32_bf16 a[84:87], a[172:175], v[140:143], a[84:87]
    s_waitcnt vmcnt(10)
    s_barrier
    v_mfma_f32_16x16x32_bf16 v[212:215], a[208:211], v[112:115], v[204:207]
    v_exp_f32 v208, v208
    v_mfma_f32_16x16x32_bf16 v[212:215], a[212:215], v[116:119], v[212:215]
    s_add_u32 m0, s42, 32768
    v_exp_f32 v209, v209
    v_mfma_f32_16x16x32_bf16 v[212:215], a[216:219], v[120:123], v[212:215]
    v_exp_f32 v210, v210
    v_mfma_f32_16x16x32_bf16 v[212:215], a[220:223], v[124:127], v[212:215]
    v_exp_f32 v211, v211
    v_mfma_f32_16x16x32_bf16 a[88:91], a[168:171], v[144:147], a[88:91]
    ds_read_b64_tr_b16 a[184:185], v27 offset:32768
    v_cvt_pk_bf16_f32 v180, v208, v209
    v_mfma_f32_16x16x32_bf16 a[88:91], a[172:175], v[148:151], a[88:91]
    ds_read_b64_tr_b16 a[186:187], v27 offset:36864
    v_mfma_f32_16x16x32_bf16 a[92:95], a[168:171], v[152:155], a[92:95]
    ds_read_b128 a[208:211], v8 offset:0
    v_cvt_pk_bf16_f32 v181, v210, v211
    v_mfma_f32_16x16x32_bf16 a[92:95], a[172:175], v[156:159], a[92:95]
    s_waitcnt lgkmcnt(3)
    buffer_load_dwordx4 v36, s[8:11], s40 offen lds
    v_mfma_f32_16x16x32_bf16 v[208:211], a[224:227], v[64:67], v[192:195]
    v_exp_f32 v212, v212
    v_mfma_f32_16x16x32_bf16 v[208:211], a[228:231], v[68:71], v[208:211]
    v_exp_f32 v213, v213
    v_mfma_f32_16x16x32_bf16 v[208:211], a[232:235], v[72:75], v[208:211]
    v_exp_f32 v214, v214
    v_mfma_f32_16x16x32_bf16 v[208:211], a[236:239], v[76:79], v[208:211]
    v_exp_f32 v215, v215
    v_mfma_f32_16x16x32_bf16 a[96:99], a[176:179], v[128:131], a[96:99]
    ds_read_b64_tr_b16 a[188:189], v27 offset:40960
    v_cvt_pk_bf16_f32 v188, v212, v213
    v_mfma_f32_16x16x32_bf16 a[96:99], a[180:183], v[132:135], a[96:99]
    ds_read_b64_tr_b16 a[190:191], v27 offset:45056
    v_mfma_f32_16x16x32_bf16 a[100:103], a[176:179], v[136:139], a[100:103]
    ds_read_b128 a[212:215], v9 offset:0
    v_cvt_pk_bf16_f32 v189, v214, v215
    v_mfma_f32_16x16x32_bf16 a[100:103], a[180:183], v[140:143], a[100:103]
    buffer_load_dword v219, v62, s[84:87], s38 offen
    v_mfma_f32_16x16x32_bf16 v[212:215], a[224:227], v[80:83], v[196:199]
    v_exp_f32 v208, v208
    v_mfma_f32_16x16x32_bf16 v[212:215], a[228:231], v[84:87], v[212:215]
    v_exp_f32 v209, v209
    v_mfma_f32_16x16x32_bf16 v[212:215], a[232:235], v[88:91], v[212:215]
    v_exp_f32 v210, v210
    v_mfma_f32_16x16x32_bf16 v[212:215], a[236:239], v[92:95], v[212:215]
    v_exp_f32 v211, v211
    v_mfma_f32_16x16x32_bf16 a[104:107], a[176:179], v[144:147], a[104:107]
    ds_read_b64_tr_b16 a[160:161], v20 offset:49152
    v_cvt_pk_bf16_f32 v166, v208, v209
    v_mfma_f32_16x16x32_bf16 a[104:107], a[180:183], v[148:151], a[104:107]
    ds_read_b64_tr_b16 a[162:163], v20 offset:53248
    v_mfma_f32_16x16x32_bf16 a[108:111], a[176:179], v[152:155], a[108:111]
    ds_read_b128 a[216:219], v10 offset:0
    v_cvt_pk_bf16_f32 v167, v210, v211
    v_mfma_f32_16x16x32_bf16 a[108:111], a[180:183], v[156:159], a[108:111]
    s_waitcnt lgkmcnt(3)
    buffer_load_dwordx4 v37, s[8:11], s40 offen offset:1024 lds
    v_mfma_f32_16x16x32_bf16 v[208:211], a[224:227], v[96:99], v[200:203]
    v_exp_f32 v212, v212
    v_mfma_f32_16x16x32_bf16 v[208:211], a[228:231], v[100:103], v[208:211]
    v_exp_f32 v213, v213
    v_mfma_f32_16x16x32_bf16 v[208:211], a[232:235], v[104:107], v[208:211]
    v_exp_f32 v214, v214
    v_mfma_f32_16x16x32_bf16 v[208:211], a[236:239], v[108:111], v[208:211]
    v_exp_f32 v215, v215
    v_mfma_f32_16x16x32_bf16 a[112:115], a[184:187], v[128:131], a[112:115]
    ds_read_b64_tr_b16 a[164:165], v20 offset:57344
    v_cvt_pk_bf16_f32 v174, v212, v213
    v_mfma_f32_16x16x32_bf16 a[112:115], a[188:191], v[132:135], a[112:115]
    ds_read_b64_tr_b16 a[166:167], v20 offset:61440
    v_mfma_f32_16x16x32_bf16 a[116:119], a[184:187], v[136:139], a[116:119]
    ds_read_b128 a[220:223], v11 offset:0
    v_cvt_pk_bf16_f32 v175, v214, v215
    v_mfma_f32_16x16x32_bf16 a[116:119], a[188:191], v[140:143], a[116:119]
    buffer_load_dword v221, v235, s[20:23], 0 offen
    v_mfma_f32_16x16x32_bf16 v[212:215], a[224:227], v[112:115], v[204:207]
    v_exp_f32 v208, v208
    v_mfma_f32_16x16x32_bf16 v[212:215], a[228:231], v[116:119], v[212:215]
Ltour5:
    s_cbranch_execz Ltour9
    v_exp_f32 v209, v209
    v_mfma_f32_16x16x32_bf16 v[212:215], a[232:235], v[120:123], v[212:215]
    v_exp_f32 v210, v210
    v_mfma_f32_16x16x32_bf16 v[212:215], a[236:239], v[124:127], v[212:215]
    v_exp_f32 v211, v211
    v_mfma_f32_16x16x32_bf16 a[120:123], a[184:187], v[144:147], a[120:123]
    ds_read_b64_tr_b16 a[168:169], v21 offset:49152
    v_cvt_pk_bf16_f32 v182, v208, v209
    v_mfma_f32_16x16x32_bf16 a[120:123], a[188:191], v[148:151], a[120:123]
    ds_read_b64_tr_b16 a[170:171], v21 offset:53248
    v_add_u32 v235, 2560, v235
    v_mfma_f32_16x16x32_bf16 a[124:127], a[184:187], v[152:155], a[124:127]
    ds_read_b128 a[224:227], v8 offset:4096
    v_cvt_pk_bf16_f32 v183, v210, v211
    v_mfma_f32_16x16x32_bf16 a[124:127], a[188:191], v[156:159], a[124:127]
    s_waitcnt lgkmcnt(3)
    buffer_load_dwordx4 v38, s[8:11], s40 offen offset:2048 lds
    v_mfma_f32_16x16x32_bf16 v[208:211], a[208:211], v[64:67], v[192:195]
    v_exp_f32 v212, v212
    v_mfma_f32_16x16x32_bf16 v[208:211], a[212:215], v[68:71], v[208:211]
    v_exp_f32 v213, v213
    v_mfma_f32_16x16x32_bf16 v[208:211], a[216:219], v[72:75], v[208:211]
    v_exp_f32 v214, v214
    v_mfma_f32_16x16x32_bf16 v[208:211], a[220:223], v[76:79], v[208:211]
    v_exp_f32 v215, v215
    v_mfma_f32_16x16x32_bf16 a[0:3], a[160:163], v[160:163], a[0:3]
    ds_read_b64_tr_b16 a[172:173], v21 offset:57344
    v_cvt_pk_bf16_f32 v190, v212, v213
    v_mfma_f32_16x16x32_bf16 a[0:3], a[164:167], v[164:167], a[0:3]
    ds_read_b64_tr_b16 a[174:175], v21 offset:61440
    v_lshlrev_b32 v244, 16, v240
    v_mfma_f32_16x16x32_bf16 a[4:7], a[160:163], v[168:171], a[4:7]
    ds_read_b128 a[228:231], v9 offset:4096
    v_cvt_pk_bf16_f32 v191, v214, v215
    v_mfma_f32_16x16x32_bf16 a[4:7], a[164:167], v[172:175], a[4:7]
    v_and_b32 v245, 0xffff0000, v240
    v_fmac_f32 v224, v2, v244
    v_mfma_f32_16x16x32_bf16 v[212:215], a[208:211], v[80:83], v[196:199]
    v_exp_f32 v208, v208
    v_mfma_f32_16x16x32_bf16 v[212:215], a[212:215], v[84:87], v[212:215]
    v_exp_f32 v209, v209
    v_mfma_f32_16x16x32_bf16 v[212:215], a[216:219], v[88:91], v[212:215]
    v_exp_f32 v210, v210
    v_mfma_f32_16x16x32_bf16 v[212:215], a[220:223], v[92:95], v[212:215]
    v_exp_f32 v211, v211
    v_mfma_f32_16x16x32_bf16 a[8:11], a[160:163], v[176:179], a[8:11]
    ds_read_b64_tr_b16 a[176:177], v22 offset:49152
    v_cvt_pk_bf16_f32 v128, v208, v209
    v_mfma_f32_16x16x32_bf16 a[8:11], a[164:167], v[180:183], a[8:11]
    ds_read_b64_tr_b16 a[178:179], v22 offset:53248
    v_fmac_f32 v225, v2, v245
    v_mfma_f32_16x16x32_bf16 a[12:15], a[160:163], v[184:187], a[12:15]
    ds_read_b128 a[232:235], v10 offset:4096
    v_cvt_pk_bf16_f32 v129, v210, v211
    v_mfma_f32_16x16x32_bf16 a[12:15], a[164:167], v[188:191], a[12:15]
    s_waitcnt lgkmcnt(3)
    buffer_load_dwordx4 v39, s[8:11], s40 offen offset:3072 lds
    v_mfma_f32_16x16x32_bf16 v[208:211], a[208:211], v[96:99], v[200:203]
    v_exp_f32 v212, v212
    v_mfma_f32_16x16x32_bf16 v[208:211], a[212:215], v[100:103], v[208:211]
    s_add_u32 s40, s40, 16384
    v_exp_f32 v213, v213
    v_mfma_f32_16x16x32_bf16 v[208:211], a[216:219], v[104:107], v[208:211]
    v_exp_f32 v214, v214
    v_mfma_f32_16x16x32_bf16 v[208:211], a[220:223], v[108:111], v[208:211]
    v_exp_f32 v215, v215
    v_mfma_f32_16x16x32_bf16 a[16:19], a[168:171], v[160:163], a[16:19]
    ds_read_b64_tr_b16 a[180:181], v22 offset:57344
    v_cvt_pk_bf16_f32 v136, v212, v213
    v_mfma_f32_16x16x32_bf16 a[16:19], a[172:175], v[164:167], a[16:19]
    ds_read_b64_tr_b16 a[182:183], v22 offset:61440
    v_lshlrev_b32 v246, 16, v241
    v_mfma_f32_16x16x32_bf16 a[20:23], a[168:171], v[168:171], a[20:23]
    ds_read_b128 a[236:239], v11 offset:4096
    v_cvt_pk_bf16_f32 v137, v214, v215
    v_mfma_f32_16x16x32_bf16 a[20:23], a[172:175], v[172:175], a[20:23]
    v_and_b32 v247, 0xffff0000, v241
    v_fmac_f32 v226, v2, v246
    v_smfmac_f32_16x16x64_bf16 a[192:195], v[52:55], v[160:167], v50
    v_mfma_f32_16x16x32_bf16 v[212:215], a[208:211], v[112:115], v[204:207]
    v_exp_f32 v208, v208
    v_mfma_f32_16x16x32_bf16 v[212:215], a[212:215], v[116:119], v[212:215]
    s_add_u32 m0, s42, 81920
    v_exp_f32 v209, v209
    v_mfma_f32_16x16x32_bf16 v[212:215], a[216:219], v[120:123], v[212:215]
    v_exp_f32 v210, v210
    v_mfma_f32_16x16x32_bf16 v[212:215], a[220:223], v[124:127], v[212:215]
    v_exp_f32 v211, v211
    v_mfma_f32_16x16x32_bf16 a[24:27], a[168:171], v[176:179], a[24:27]
    ds_read_b64_tr_b16 a[184:185], v23 offset:49152
    v_cvt_pk_bf16_f32 v144, v208, v209
    v_mfma_f32_16x16x32_bf16 a[24:27], a[172:175], v[180:183], a[24:27]
    ds_read_b64_tr_b16 a[186:187], v23 offset:53248
    v_fmac_f32 v227, v2, v247
    v_mfma_f32_16x16x32_bf16 a[28:31], a[168:171], v[184:187], a[28:31]
    ds_read_b128 a[208:211], v8 offset:8192
    v_cvt_pk_bf16_f32 v145, v210, v211
    v_mfma_f32_16x16x32_bf16 a[28:31], a[172:175], v[188:191], a[28:31]
    s_waitcnt lgkmcnt(3)
    buffer_load_dwordx4 v40, s[12:15], s41 offen lds
    v_mfma_f32_16x16x32_bf16 v[208:211], a[224:227], v[64:67], v[192:195]
    v_exp_f32 v212, v212
    v_mfma_f32_16x16x32_bf16 v[208:211], a[228:231], v[68:71], v[208:211]
    v_exp_f32 v213, v213
    v_mfma_f32_16x16x32_bf16 v[208:211], a[232:235], v[72:75], v[208:211]
    v_exp_f32 v214, v214
    v_mfma_f32_16x16x32_bf16 v[208:211], a[236:239], v[76:79], v[208:211]
    v_exp_f32 v215, v215
    v_mfma_f32_16x16x32_bf16 a[32:35], a[176:179], v[160:163], a[32:35]
    ds_read_b64_tr_b16 a[188:189], v23 offset:57344
    v_cvt_pk_bf16_f32 v152, v212, v213
    v_mfma_f32_16x16x32_bf16 a[32:35], a[180:183], v[164:167], a[32:35]
    ds_read_b64_tr_b16 a[190:191], v23 offset:61440
    v_lshlrev_b32 v244, 16, v242
    v_mfma_f32_16x16x32_bf16 a[36:39], a[176:179], v[168:171], a[36:39]
    ds_read_b128 a[212:215], v9 offset:8192
    v_cvt_pk_bf16_f32 v153, v214, v215
    v_mfma_f32_16x16x32_bf16 a[36:39], a[180:183], v[172:175], a[36:39]
    v_and_b32 v245, 0xffff0000, v242
    v_fmac_f32 v228, v2, v244
    v_smfmac_f32_16x16x64_bf16 a[196:199], v[52:55], v[168:175], v50
    v_mfma_f32_16x16x32_bf16 v[212:215], a[224:227], v[80:83], v[196:199]
    v_exp_f32 v208, v208
    v_mfma_f32_16x16x32_bf16 v[212:215], a[228:231], v[84:87], v[212:215]
    v_exp_f32 v209, v209
    v_mfma_f32_16x16x32_bf16 v[212:215], a[232:235], v[88:91], v[212:215]
    v_exp_f32 v210, v210
    v_mfma_f32_16x16x32_bf16 v[212:215], a[236:239], v[92:95], v[212:215]
    v_exp_f32 v211, v211
    v_mfma_f32_16x16x32_bf16 a[40:43], a[176:179], v[176:179], a[40:43]
    ds_read_b64_tr_b16 a[160:161], v24 offset:49152
    v_cvt_pk_bf16_f32 v130, v208, v209
    v_mfma_f32_16x16x32_bf16 a[40:43], a[180:183], v[180:183], a[40:43]
    ds_read_b64_tr_b16 a[162:163], v24 offset:53248
    v_fmac_f32 v229, v2, v245
    v_mfma_f32_16x16x32_bf16 a[44:47], a[176:179], v[184:187], a[44:47]
    ds_read_b128 a[216:219], v10 offset:8192
    v_cvt_pk_bf16_f32 v131, v210, v211
    v_mfma_f32_16x16x32_bf16 a[44:47], a[180:183], v[188:191], a[44:47]
    s_waitcnt lgkmcnt(3)
    buffer_load_dwordx4 v41, s[12:15], s41 offen offset:1024 lds
    v_mfma_f32_16x16x32_bf16 v[208:211], a[224:227], v[96:99], v[200:203]
    v_exp_f32 v212, v212
    v_mfma_f32_16x16x32_bf16 v[208:211], a[228:231], v[100:103], v[208:211]
    v_exp_f32 v213, v213
    v_mfma_f32_16x16x32_bf16 v[208:211], a[232:235], v[104:107], v[208:211]
    v_exp_f32 v214, v214
    v_mfma_f32_16x16x32_bf16 v[208:211], a[236:239], v[108:111], v[208:211]
    v_exp_f32 v215, v215
    v_mfma_f32_16x16x32_bf16 a[48:51], a[184:187], v[160:163], a[48:51]
    ds_read_b64_tr_b16 a[164:165], v24 offset:57344
    v_cvt_pk_bf16_f32 v138, v212, v213
    v_mfma_f32_16x16x32_bf16 a[48:51], a[188:191], v[164:167], a[48:51]
    ds_read_b64_tr_b16 a[166:167], v24 offset:61440
    v_lshlrev_b32 v246, 16, v243
    v_mfma_f32_16x16x32_bf16 a[52:55], a[184:187], v[168:171], a[52:55]
    ds_read_b128 a[220:223], v11 offset:8192
    v_cvt_pk_bf16_f32 v139, v214, v215
    v_mfma_f32_16x16x32_bf16 a[52:55], a[188:191], v[172:175], a[52:55]
    v_and_b32 v247, 0xffff0000, v243
    v_fmac_f32 v230, v2, v246
    v_smfmac_f32_16x16x64_bf16 a[200:203], v[52:55], v[176:183], v50
    v_mfma_f32_16x16x32_bf16 v[212:215], a[224:227], v[112:115], v[204:207]
    v_exp_f32 v208, v208
    v_mfma_f32_16x16x32_bf16 v[212:215], a[228:231], v[116:119], v[212:215]
    v_exp_f32 v209, v209
    v_mfma_f32_16x16x32_bf16 v[212:215], a[232:235], v[120:123], v[212:215]
    v_exp_f32 v210, v210
    v_mfma_f32_16x16x32_bf16 v[212:215], a[236:239], v[124:127], v[212:215]
    v_exp_f32 v211, v211
    v_mfma_f32_16x16x32_bf16 a[56:59], a[184:187], v[176:179], a[56:59]
    ds_read_b64_tr_b16 a[168:169], v25 offset:49152
    v_cvt_pk_bf16_f32 v146, v208, v209
    v_mfma_f32_16x16x32_bf16 a[56:59], a[188:191], v[180:183], a[56:59]
    ds_read_b64_tr_b16 a[170:171], v25 offset:53248
    v_fmac_f32 v231, v2, v247
    v_mfma_f32_16x16x32_bf16 a[60:63], a[184:187], v[184:187], a[60:63]
    ds_read_b128 a[224:227], v8 offset:12288
    v_cvt_pk_bf16_f32 v147, v210, v211
    v_mfma_f32_16x16x32_bf16 a[60:63], a[188:191], v[188:191], a[60:63]
    s_waitcnt lgkmcnt(3)
    buffer_load_dwordx4 v40, s[12:15], s41 offen offset:2048 lds
    v_mfma_f32_16x16x32_bf16 v[208:211], a[208:211], v[64:67], v[192:195]
    v_exp_f32 v212, v212
    v_mfma_f32_16x16x32_bf16 v[208:211], a[212:215], v[68:71], v[208:211]
    v_exp_f32 v213, v213
    v_mfma_f32_16x16x32_bf16 v[208:211], a[216:219], v[72:75], v[208:211]
    v_exp_f32 v214, v214
    v_mfma_f32_16x16x32_bf16 v[208:211], a[220:223], v[76:79], v[208:211]
    v_exp_f32 v215, v215
    v_mfma_f32_16x16x32_bf16 a[64:67], a[160:163], v[160:163], a[64:67]
    ds_read_b64_tr_b16 a[172:173], v25 offset:57344
    v_cvt_pk_bf16_f32 v154, v212, v213
    v_mfma_f32_16x16x32_bf16 a[64:67], a[164:167], v[164:167], a[64:67]
    ds_read_b64_tr_b16 a[174:175], v25 offset:61440
    v_mov_b32 v2, v3
    v_mfma_f32_16x16x32_bf16 a[68:71], a[160:163], v[168:171], a[68:71]
    ds_read_b128 a[228:231], v9 offset:12288
    v_cvt_pk_bf16_f32 v155, v214, v215
    v_mfma_f32_16x16x32_bf16 a[68:71], a[164:167], v[172:175], a[68:71]
    v_mov_b32 v3, v4
    v_mov_b32 v4, v5
    v_smfmac_f32_16x16x64_bf16 a[204:207], v[52:55], v[184:191], v50
    v_mfma_f32_16x16x32_bf16 v[212:215], a[208:211], v[80:83], v[196:199]
    v_exp_f32 v208, v208
    v_mfma_f32_16x16x32_bf16 v[212:215], a[212:215], v[84:87], v[212:215]
    v_exp_f32 v209, v209
    v_mfma_f32_16x16x32_bf16 v[212:215], a[216:219], v[88:91], v[212:215]
    v_exp_f32 v210, v210
    v_mfma_f32_16x16x32_bf16 v[212:215], a[220:223], v[92:95], v[212:215]
    v_exp_f32 v211, v211
    v_mfma_f32_16x16x32_bf16 a[72:75], a[160:163], v[176:179], a[72:75]
    ds_read_b64_tr_b16 a[176:177], v26 offset:49152
    v_cvt_pk_bf16_f32 v132, v208, v209
    v_mfma_f32_16x16x32_bf16 a[72:75], a[164:167], v[180:183], a[72:75]
    ds_read_b64_tr_b16 a[178:179], v26 offset:53248
    v_mov_b32 v5, v6
    v_mfma_f32_16x16x32_bf16 a[76:79], a[160:163], v[184:187], a[76:79]
    ds_read_b128 a[232:235], v10 offset:12288
    v_cvt_pk_bf16_f32 v133, v210, v211
    v_mfma_f32_16x16x32_bf16 a[76:79], a[164:167], v[188:191], a[76:79]
    s_waitcnt lgkmcnt(3)
    buffer_load_dwordx4 v41, s[12:15], s41 offen offset:3072 lds
    v_mfma_f32_16x16x32_bf16 v[208:211], a[208:211], v[96:99], v[200:203]
    v_exp_f32 v212, v212
    v_mfma_f32_16x16x32_bf16 v[208:211], a[212:215], v[100:103], v[208:211]
    s_add_u32 s41, s41, 16384
    v_exp_f32 v213, v213
    v_mfma_f32_16x16x32_bf16 v[208:211], a[216:219], v[104:107], v[208:211]
    v_exp_f32 v214, v214
    v_mfma_f32_16x16x32_bf16 v[208:211], a[220:223], v[108:111], v[208:211]
    v_exp_f32 v215, v215
    v_mfma_f32_16x16x32_bf16 a[80:83], a[168:171], v[160:163], a[80:83]
    ds_read_b64_tr_b16 a[180:181], v26 offset:57344
    v_cvt_pk_bf16_f32 v140, v212, v213
    v_mfma_f32_16x16x32_bf16 a[80:83], a[172:175], v[164:167], a[80:83]
    ds_read_b64_tr_b16 a[182:183], v26 offset:61440
    v_mfma_f32_16x16x32_bf16 a[84:87], a[168:171], v[168:171], a[84:87]
    ds_read_b128 a[236:239], v11 offset:12288
    v_cvt_pk_bf16_f32 v141, v214, v215
    v_mfma_f32_16x16x32_bf16 a[84:87], a[172:175], v[172:175], a[84:87]
    s_waitcnt vmcnt(10)
    s_barrier
    v_mfma_f32_16x16x32_bf16 v[212:215], a[208:211], v[112:115], v[204:207]
    v_exp_f32 v208, v208
    v_mfma_f32_16x16x32_bf16 v[212:215], a[212:215], v[116:119], v[212:215]
    s_add_u32 m0, s42, 49152
    v_exp_f32 v209, v209
    v_mfma_f32_16x16x32_bf16 v[212:215], a[216:219], v[120:123], v[212:215]
    v_exp_f32 v210, v210
    v_mfma_f32_16x16x32_bf16 v[212:215], a[220:223], v[124:127], v[212:215]
    v_exp_f32 v211, v211
    v_mfma_f32_16x16x32_bf16 a[88:91], a[168:171], v[176:179], a[88:91]
    ds_read_b64_tr_b16 a[184:185], v27 offset:49152
    v_cvt_pk_bf16_f32 v148, v208, v209
    v_mfma_f32_16x16x32_bf16 a[88:91], a[172:175], v[180:183], a[88:91]
    ds_read_b64_tr_b16 a[186:187], v27 offset:53248
    v_mfma_f32_16x16x32_bf16 a[92:95], a[168:171], v[184:187], a[92:95]
    ds_read_b128 a[208:211], v8 offset:16384
    v_cvt_pk_bf16_f32 v149, v210, v211
    v_mfma_f32_16x16x32_bf16 a[92:95], a[172:175], v[188:191], a[92:95]
    s_waitcnt lgkmcnt(3)
    buffer_load_dwordx4 v36, s[8:11], s40 offen lds
    v_mfma_f32_16x16x32_bf16 v[208:211], a[224:227], v[64:67], v[192:195]
    v_exp_f32 v212, v212
    v_mfma_f32_16x16x32_bf16 v[208:211], a[228:231], v[68:71], v[208:211]
    v_exp_f32 v213, v213
    v_mfma_f32_16x16x32_bf16 v[208:211], a[232:235], v[72:75], v[208:211]
    v_exp_f32 v214, v214
    v_mfma_f32_16x16x32_bf16 v[208:211], a[236:239], v[76:79], v[208:211]
    v_exp_f32 v215, v215
    v_mfma_f32_16x16x32_bf16 a[96:99], a[176:179], v[160:163], a[96:99]
    ds_read_b64_tr_b16 a[188:189], v27 offset:57344
    v_cvt_pk_bf16_f32 v156, v212, v213
    v_mfma_f32_16x16x32_bf16 a[96:99], a[180:183], v[164:167], a[96:99]
    ds_read_b64_tr_b16 a[190:191], v27 offset:61440
    v_mfma_f32_16x16x32_bf16 a[100:103], a[176:179], v[168:171], a[100:103]
    ds_read_b128 a[212:215], v9 offset:16384
    v_cvt_pk_bf16_f32 v157, v214, v215
    v_mfma_f32_16x16x32_bf16 a[100:103], a[180:183], v[172:175], a[100:103]
    buffer_load_dword v216, v237, s[28:31], s52 offen
    v_mfma_f32_16x16x32_bf16 v[212:215], a[224:227], v[80:83], v[196:199]
    v_exp_f32 v208, v208
    v_mfma_f32_16x16x32_bf16 v[212:215], a[228:231], v[84:87], v[212:215]
    s_sub_u32 s39, s39, 36864
    v_exp_f32 v209, v209
    v_mfma_f32_16x16x32_bf16 v[212:215], a[232:235], v[88:91], v[212:215]
    s_sub_u32 s38, s38, 4608
    v_exp_f32 v210, v210
    v_mfma_f32_16x16x32_bf16 v[212:215], a[236:239], v[92:95], v[212:215]
    s_add_u32 s52, s52, 2304
    v_exp_f32 v211, v211
    v_mfma_f32_16x16x32_bf16 a[104:107], a[176:179], v[176:179], a[104:107]
    ds_read_b64_tr_b16 a[160:161], v20 offset:0
    v_cvt_pk_bf16_f32 v134, v208, v209
    v_mfma_f32_16x16x32_bf16 a[104:107], a[180:183], v[180:183], a[104:107]
    ds_read_b64_tr_b16 a[162:163], v20 offset:4096
    v_mfma_f32_16x16x32_bf16 a[108:111], a[176:179], v[184:187], a[108:111]
    ds_read_b128 a[216:219], v10 offset:16384
    v_cvt_pk_bf16_f32 v135, v210, v211
    v_mfma_f32_16x16x32_bf16 a[108:111], a[180:183], v[188:191], a[108:111]
    s_waitcnt lgkmcnt(3)
    buffer_load_dwordx4 v37, s[8:11], s40 offen offset:1024 lds
    v_mfma_f32_16x16x32_bf16 v[208:211], a[224:227], v[96:99], v[200:203]
    v_exp_f32 v212, v212
    v_mfma_f32_16x16x32_bf16 v[208:211], a[228:231], v[100:103], v[208:211]
    v_exp_f32 v213, v213
    v_mfma_f32_16x16x32_bf16 v[208:211], a[232:235], v[104:107], v[208:211]
    v_exp_f32 v214, v214
    v_mfma_f32_16x16x32_bf16 v[208:211], a[236:239], v[108:111], v[208:211]
    v_exp_f32 v215, v215
    v_mfma_f32_16x16x32_bf16 a[112:115], a[184:187], v[160:163], a[112:115]
    ds_read_b64_tr_b16 a[164:165], v20 offset:8192
    v_cvt_pk_bf16_f32 v142, v212, v213
    v_mfma_f32_16x16x32_bf16 a[112:115], a[188:191], v[164:167], a[112:115]
    ds_read_b64_tr_b16 a[166:167], v20 offset:12288
    v_mfma_f32_16x16x32_bf16 a[116:119], a[184:187], v[168:171], a[116:119]
    ds_read_b128 a[220:223], v11 offset:16384
    v_cvt_pk_bf16_f32 v143, v214, v215
    v_mfma_f32_16x16x32_bf16 a[116:119], a[188:191], v[172:175], a[116:119]
    v_mfma_f32_16x16x32_bf16 v[212:215], a[224:227], v[112:115], v[204:207]
    v_exp_f32 v208, v208
    v_mfma_f32_16x16x32_bf16 v[212:215], a[228:231], v[116:119], v[212:215]
    v_exp_f32 v209, v209
    v_mfma_f32_16x16x32_bf16 v[212:215], a[232:235], v[120:123], v[212:215]
    v_exp_f32 v210, v210
    v_mfma_f32_16x16x32_bf16 v[212:215], a[236:239], v[124:127], v[212:215]
    v_exp_f32 v211, v211
    v_mfma_f32_16x16x32_bf16 a[120:123], a[184:187], v[176:179], a[120:123]
    ds_read_b64_tr_b16 a[168:169], v21 offset:0
    v_cvt_pk_bf16_f32 v150, v208, v209
    v_mfma_f32_16x16x32_bf16 a[120:123], a[188:191], v[180:183], a[120:123]
    ds_read_b64_tr_b16 a[170:171], v21 offset:4096
    v_mfma_f32_16x16x32_bf16 a[124:127], a[184:187], v[184:187], a[124:127]
    ds_read_b128 a[224:227], v8 offset:20480
    v_cvt_pk_bf16_f32 v151, v210, v211
    v_mfma_f32_16x16x32_bf16 a[124:127], a[188:191], v[188:191], a[124:127]
    s_waitcnt lgkmcnt(3)
    buffer_load_dwordx4 v38, s[8:11], s40 offen offset:2048 lds
    s_sub_u32 s43, s43, 1
    s_cmp_lg_u32 s43, 0
    s_cbranch_scc1 Lattn_loop
    v_mfma_f32_16x16x32_bf16 v[208:211], a[208:211], v[64:67], v[192:195]
    s_lshl_b32 s38, s3, 6
    v_exp_f32 v212, v212
    v_mfma_f32_16x16x32_bf16 v[208:211], a[212:215], v[68:71], v[208:211]
    s_add_u32 s38, s38, 131136
    v_exp_f32 v213, v213
    v_mfma_f32_16x16x32_bf16 v[208:211], a[216:219], v[72:75], v[208:211]
    v_exp_f32 v214, v214
    v_mfma_f32_16x16x32_bf16 v[208:211], a[220:223], v[76:79], v[208:211]
    s_add_u32 s57, s58, 0
    v_exp_f32 v215, v215
    v_mfma_f32_16x16x32_bf16 a[0:3], a[160:163], v[128:131], a[0:3]
    ds_read_b64_tr_b16 a[172:173], v21 offset:8192
    v_cvt_pk_bf16_f32 v158, v212, v213
    v_mfma_f32_16x16x32_bf16 a[0:3], a[164:167], v[132:135], a[0:3]
    ds_read_b64_tr_b16 a[174:175], v21 offset:12288
    v_permlane32_swap_b32 v224, v228
    v_mfma_f32_16x16x32_bf16 a[4:7], a[160:163], v[136:139], a[4:7]
    ds_read_b128 a[228:231], v9 offset:20480
    v_cvt_pk_bf16_f32 v159, v214, v215
    v_mfma_f32_16x16x32_bf16 a[4:7], a[164:167], v[140:143], a[4:7]
    buffer_load_dwordx4 a[128:131], v254, s[80:83], s57 offen
    v_mfma_f32_16x16x32_bf16 v[212:215], a[208:211], v[80:83], v[196:199]
    v_exp_f32 v208, v208
    v_mfma_f32_16x16x32_bf16 v[212:215], a[212:215], v[84:87], v[212:215]
    v_exp_f32 v209, v209
    v_mfma_f32_16x16x32_bf16 v[212:215], a[216:219], v[88:91], v[212:215]
    v_exp_f32 v210, v210
    v_mfma_f32_16x16x32_bf16 v[212:215], a[220:223], v[92:95], v[212:215]
    v_exp_f32 v211, v211
    v_mfma_f32_16x16x32_bf16 a[8:11], a[160:163], v[144:147], a[8:11]
    ds_read_b64_tr_b16 a[176:177], v22 offset:0
    v_cvt_pk_bf16_f32 v160, v208, v209
    v_mfma_f32_16x16x32_bf16 a[8:11], a[164:167], v[148:151], a[8:11]
    ds_read_b64_tr_b16 a[178:179], v22 offset:4096
    v_permlane32_swap_b32 v225, v229
    v_mfma_f32_16x16x32_bf16 a[12:15], a[160:163], v[152:155], a[12:15]
    ds_read_b128 a[232:235], v10 offset:20480
    v_cvt_pk_bf16_f32 v161, v210, v211
    v_mfma_f32_16x16x32_bf16 a[12:15], a[164:167], v[156:159], a[12:15]
    s_waitcnt lgkmcnt(3)
    buffer_load_dwordx4 v39, s[8:11], s40 offen offset:3072 lds
    v_mfma_f32_16x16x32_bf16 v[208:211], a[208:211], v[96:99], v[200:203]
    v_exp_f32 v212, v212
    v_mfma_f32_16x16x32_bf16 v[208:211], a[212:215], v[100:103], v[208:211]
    s_add_u32 s40, s40, 16384
    v_exp_f32 v213, v213
    v_mfma_f32_16x16x32_bf16 v[208:211], a[216:219], v[104:107], v[208:211]
    v_exp_f32 v214, v214
    v_mfma_f32_16x16x32_bf16 v[208:211], a[220:223], v[108:111], v[208:211]
    v_exp_f32 v215, v215
    v_mfma_f32_16x16x32_bf16 a[16:19], a[168:171], v[128:131], a[16:19]
    ds_read_b64_tr_b16 a[180:181], v22 offset:8192
    v_cvt_pk_bf16_f32 v168, v212, v213
    v_mfma_f32_16x16x32_bf16 a[16:19], a[172:175], v[132:135], a[16:19]
    ds_read_b64_tr_b16 a[182:183], v22 offset:12288
    v_permlane32_swap_b32 v226, v230
    v_mfma_f32_16x16x32_bf16 a[20:23], a[168:171], v[136:139], a[20:23]
    ds_read_b128 a[236:239], v11 offset:20480
    v_cvt_pk_bf16_f32 v169, v214, v215
    v_mfma_f32_16x16x32_bf16 a[20:23], a[172:175], v[140:143], a[20:23]
    v_permlane32_swap_b32 v227, v231
    v_add_f32 v224, v224, v228
    v_smfmac_f32_16x16x64_bf16 a[192:195], v[52:55], v[128:135], v50
    v_mfma_f32_16x16x32_bf16 v[212:215], a[208:211], v[112:115], v[204:207]
    v_exp_f32 v208, v208
    v_mfma_f32_16x16x32_bf16 v[212:215], a[212:215], v[116:119], v[212:215]
    s_add_u32 m0, s42, 98304
    v_exp_f32 v209, v209
    v_mfma_f32_16x16x32_bf16 v[212:215], a[216:219], v[120:123], v[212:215]
    v_exp_f32 v210, v210
    v_mfma_f32_16x16x32_bf16 v[212:215], a[220:223], v[124:127], v[212:215]
    v_exp_f32 v211, v211
    v_mfma_f32_16x16x32_bf16 a[24:27], a[168:171], v[144:147], a[24:27]
    ds_read_b64_tr_b16 a[184:185], v23 offset:0
    v_cvt_pk_bf16_f32 v176, v208, v209
    v_mfma_f32_16x16x32_bf16 a[24:27], a[172:175], v[148:151], a[24:27]
    ds_read_b64_tr_b16 a[186:187], v23 offset:4096
    v_add_f32 v225, v225, v229
    v_mfma_f32_16x16x32_bf16 a[28:31], a[168:171], v[152:155], a[28:31]
    ds_read_b128 a[208:211], v8 offset:24576
    v_cvt_pk_bf16_f32 v177, v210, v211
    v_mfma_f32_16x16x32_bf16 a[28:31], a[172:175], v[156:159], a[28:31]
    s_waitcnt lgkmcnt(3)
    buffer_load_dwordx4 v40, s[12:15], s41 offen lds
    v_mfma_f32_16x16x32_bf16 v[208:211], a[224:227], v[64:67], v[192:195]
    v_exp_f32 v212, v212
    v_mfma_f32_16x16x32_bf16 v[208:211], a[228:231], v[68:71], v[208:211]
    v_exp_f32 v213, v213
    v_mfma_f32_16x16x32_bf16 v[208:211], a[232:235], v[72:75], v[208:211]
    v_exp_f32 v214, v214
    v_mfma_f32_16x16x32_bf16 v[208:211], a[236:239], v[76:79], v[208:211]
    s_add_u32 s57, s58, 589824
    v_exp_f32 v215, v215
    v_mfma_f32_16x16x32_bf16 a[32:35], a[176:179], v[128:131], a[32:35]
    ds_read_b64_tr_b16 a[188:189], v23 offset:8192
    v_cvt_pk_bf16_f32 v184, v212, v213
    v_mfma_f32_16x16x32_bf16 a[32:35], a[180:183], v[132:135], a[32:35]
    ds_read_b64_tr_b16 a[190:191], v23 offset:12288
    v_add_f32 v226, v226, v230
    v_mfma_f32_16x16x32_bf16 a[36:39], a[176:179], v[136:139], a[36:39]
    ds_read_b128 a[212:215], v9 offset:24576
    v_cvt_pk_bf16_f32 v185, v214, v215
    v_mfma_f32_16x16x32_bf16 a[36:39], a[180:183], v[140:143], a[36:39]
    buffer_load_dwordx4 a[132:135], v254, s[80:83], s57 offen
    v_smfmac_f32_16x16x64_bf16 a[196:199], v[52:55], v[136:143], v50
    v_mfma_f32_16x16x32_bf16 v[212:215], a[224:227], v[80:83], v[196:199]
    v_exp_f32 v208, v208
    v_mfma_f32_16x16x32_bf16 v[212:215], a[228:231], v[84:87], v[212:215]
    v_exp_f32 v209, v209
    v_mfma_f32_16x16x32_bf16 v[212:215], a[232:235], v[88:91], v[212:215]
    v_exp_f32 v210, v210
    v_mfma_f32_16x16x32_bf16 v[212:215], a[236:239], v[92:95], v[212:215]
    v_exp_f32 v211, v211
    v_mfma_f32_16x16x32_bf16 a[40:43], a[176:179], v[144:147], a[40:43]
    ds_read_b64_tr_b16 a[160:161], v24 offset:0
    v_cvt_pk_bf16_f32 v162, v208, v209
    v_mfma_f32_16x16x32_bf16 a[40:43], a[180:183], v[148:151], a[40:43]
    ds_read_b64_tr_b16 a[162:163], v24 offset:4096
    v_add_f32 v227, v227, v231
    v_mfma_f32_16x16x32_bf16 a[44:47], a[176:179], v[152:155], a[44:47]
    ds_read_b128 a[216:219], v10 offset:24576
    v_cvt_pk_bf16_f32 v163, v210, v211
    v_mfma_f32_16x16x32_bf16 a[44:47], a[180:183], v[156:159], a[44:47]
    s_waitcnt lgkmcnt(3)
    buffer_load_dwordx4 v41, s[12:15], s41 offen offset:1024 lds
    v_mfma_f32_16x16x32_bf16 v[208:211], a[224:227], v[96:99], v[200:203]
    v_exp_f32 v212, v212
    v_mfma_f32_16x16x32_bf16 v[208:211], a[228:231], v[100:103], v[208:211]
    v_exp_f32 v213, v213
    v_mfma_f32_16x16x32_bf16 v[208:211], a[232:235], v[104:107], v[208:211]
    v_exp_f32 v214, v214
    v_mfma_f32_16x16x32_bf16 v[208:211], a[236:239], v[108:111], v[208:211]
    v_exp_f32 v215, v215
    v_mfma_f32_16x16x32_bf16 a[48:51], a[184:187], v[128:131], a[48:51]
    ds_read_b64_tr_b16 a[164:165], v24 offset:8192
    v_cvt_pk_bf16_f32 v170, v212, v213
    v_mfma_f32_16x16x32_bf16 a[48:51], a[188:191], v[132:135], a[48:51]
    ds_read_b64_tr_b16 a[166:167], v24 offset:12288
    v_and_b32 v244, 1, v1
    v_mfma_f32_16x16x32_bf16 a[52:55], a[184:187], v[136:139], a[52:55]
    ds_read_b128 a[220:223], v11 offset:24576
    v_cvt_pk_bf16_f32 v171, v214, v215
    v_mfma_f32_16x16x32_bf16 a[52:55], a[188:191], v[140:143], a[52:55]
    s_waitcnt vmcnt(15)
    buffer_load_dword v221, v236, s[20:23], 0 offen
    v_smfmac_f32_16x16x64_bf16 a[200:203], v[52:55], v[144:151], v50
    v_mfma_f32_16x16x32_bf16 v[212:215], a[224:227], v[112:115], v[204:207]
    v_exp_f32 v208, v208
    v_mfma_f32_16x16x32_bf16 v[212:215], a[228:231], v[116:119], v[212:215]
    v_exp_f32 v209, v209
    v_mfma_f32_16x16x32_bf16 v[212:215], a[232:235], v[120:123], v[212:215]
    v_exp_f32 v210, v210
    v_mfma_f32_16x16x32_bf16 v[212:215], a[236:239], v[124:127], v[212:215]
    v_exp_f32 v211, v211
    v_mfma_f32_16x16x32_bf16 a[56:59], a[184:187], v[144:147], a[56:59]
    ds_read_b64_tr_b16 a[168:169], v25 offset:0
    v_cvt_pk_bf16_f32 v178, v208, v209
    v_mfma_f32_16x16x32_bf16 a[56:59], a[188:191], v[148:151], a[56:59]
    ds_read_b64_tr_b16 a[170:171], v25 offset:4096
    v_permlane16_swap_b32 v224, v226
    v_mfma_f32_16x16x32_bf16 a[60:63], a[184:187], v[152:155], a[60:63]
    ds_read_b128 a[224:227], v8 offset:28672
    v_cvt_pk_bf16_f32 v179, v210, v211
    v_mfma_f32_16x16x32_bf16 a[60:63], a[188:191], v[156:159], a[60:63]
    s_waitcnt lgkmcnt(3)
    buffer_load_dwordx4 v40, s[12:15], s41 offen offset:2048 lds
    v_mfma_f32_16x16x32_bf16 v[208:211], a[208:211], v[64:67], v[192:195]
    v_exp_f32 v212, v212
    v_mfma_f32_16x16x32_bf16 v[208:211], a[212:215], v[68:71], v[208:211]
    v_exp_f32 v213, v213
    v_mfma_f32_16x16x32_bf16 v[208:211], a[216:219], v[72:75], v[208:211]
    v_exp_f32 v214, v214
    v_mfma_f32_16x16x32_bf16 v[208:211], a[220:223], v[76:79], v[208:211]
    s_add_u32 s57, s58, 1179648
    v_exp_f32 v215, v215
    v_mfma_f32_16x16x32_bf16 a[64:67], a[160:163], v[128:131], a[64:67]
    ds_read_b64_tr_b16 a[172:173], v25 offset:8192
    v_cvt_pk_bf16_f32 v186, v212, v213
    v_mfma_f32_16x16x32_bf16 a[64:67], a[164:167], v[132:135], a[64:67]
    ds_read_b64_tr_b16 a[174:175], v25 offset:12288
    v_permlane16_swap_b32 v225, v227
    v_mfma_f32_16x16x32_bf16 a[68:71], a[160:163], v[136:139], a[68:71]
    ds_read_b128 a[228:231], v9 offset:28672
    v_cvt_pk_bf16_f32 v187, v214, v215
    v_mfma_f32_16x16x32_bf16 a[68:71], a[164:167], v[140:143], a[68:71]
    buffer_load_dwordx4 a[136:139], v254, s[80:83], s57 offen
    v_smfmac_f32_16x16x64_bf16 a[204:207], v[52:55], v[152:159], v50
    v_mfma_f32_16x16x32_bf16 v[212:215], a[208:211], v[80:83], v[196:199]
    v_exp_f32 v208, v208
    v_mfma_f32_16x16x32_bf16 v[212:215], a[212:215], v[84:87], v[212:215]
    v_exp_f32 v209, v209
    v_mfma_f32_16x16x32_bf16 v[212:215], a[216:219], v[88:91], v[212:215]
    v_exp_f32 v210, v210
    v_mfma_f32_16x16x32_bf16 v[212:215], a[220:223], v[92:95], v[212:215]
    v_exp_f32 v211, v211
    v_mfma_f32_16x16x32_bf16 a[72:75], a[160:163], v[144:147], a[72:75]
    ds_read_b64_tr_b16 a[176:177], v26 offset:0
    v_cvt_pk_bf16_f32 v164, v208, v209
    v_mfma_f32_16x16x32_bf16 a[72:75], a[164:167], v[148:151], a[72:75]
    ds_read_b64_tr_b16 a[178:179], v26 offset:4096
    v_lshlrev_b32 v244, 5, v244
    v_mfma_f32_16x16x32_bf16 a[76:79], a[160:163], v[152:155], a[76:79]
    ds_read_b128 a[232:235], v10 offset:28672
    v_cvt_pk_bf16_f32 v165, v210, v211
    v_mfma_f32_16x16x32_bf16 a[76:79], a[164:167], v[156:159], a[76:79]
    s_waitcnt lgkmcnt(3)
    buffer_load_dwordx4 v41, s[12:15], s41 offen offset:3072 lds
    v_mfma_f32_16x16x32_bf16 v[208:211], a[208:211], v[96:99], v[200:203]
    v_exp_f32 v212, v212
    v_mfma_f32_16x16x32_bf16 v[208:211], a[212:215], v[100:103], v[208:211]
    s_add_u32 s41, s41, 16384
    v_exp_f32 v213, v213
    v_mfma_f32_16x16x32_bf16 v[208:211], a[216:219], v[104:107], v[208:211]
    v_exp_f32 v214, v214
    v_mfma_f32_16x16x32_bf16 v[208:211], a[220:223], v[108:111], v[208:211]
    v_exp_f32 v215, v215
    v_mfma_f32_16x16x32_bf16 a[80:83], a[168:171], v[128:131], a[80:83]
    ds_read_b64_tr_b16 a[180:181], v26 offset:8192
    v_cvt_pk_bf16_f32 v172, v212, v213
    v_mfma_f32_16x16x32_bf16 a[80:83], a[172:175], v[132:135], a[80:83]
    ds_read_b64_tr_b16 a[182:183], v26 offset:12288
    v_add_f32 v224, v224, v226
    v_mfma_f32_16x16x32_bf16 a[84:87], a[168:171], v[136:139], a[84:87]
    ds_read_b128 a[236:239], v11 offset:28672
    v_cvt_pk_bf16_f32 v173, v214, v215
    v_mfma_f32_16x16x32_bf16 a[84:87], a[172:175], v[140:143], a[84:87]
    s_waitcnt vmcnt(13)
    s_barrier
    v_mfma_f32_16x16x32_bf16 v[212:215], a[208:211], v[112:115], v[204:207]
    v_exp_f32 v208, v208
    v_mfma_f32_16x16x32_bf16 v[212:215], a[212:215], v[116:119], v[212:215]
    s_add_u32 s49, s45, 1024
    v_exp_f32 v209, v209
    v_mfma_f32_16x16x32_bf16 v[212:215], a[216:219], v[120:123], v[212:215]
    s_add_u32 m0, s42, 0
    v_exp_f32 v210, v210
    v_mfma_f32_16x16x32_bf16 v[212:215], a[220:223], v[124:127], v[212:215]
    v_exp_f32 v211, v211
    v_mfma_f32_16x16x32_bf16 a[88:91], a[168:171], v[144:147], a[88:91]
    ds_read_b64_tr_b16 a[184:185], v27 offset:0
    v_cvt_pk_bf16_f32 v180, v208, v209
    v_mfma_f32_16x16x32_bf16 a[88:91], a[172:175], v[148:151], a[88:91]
    ds_read_b64_tr_b16 a[186:187], v27 offset:4096
    v_add_f32 v225, v225, v227
    v_mfma_f32_16x16x32_bf16 a[92:95], a[168:171], v[152:155], a[92:95]
    ds_read_b128 a[208:211], v8 offset:32768
    v_cvt_pk_bf16_f32 v181, v210, v211
    v_mfma_f32_16x16x32_bf16 a[92:95], a[172:175], v[156:159], a[92:95]
    s_waitcnt lgkmcnt(3)
    buffer_load_dwordx4 v46, s[20:23], s49 offen lds
    v_mfma_f32_16x16x32_bf16 v[208:211], a[224:227], v[64:67], v[192:195]
    v_exp_f32 v212, v212
    v_mfma_f32_16x16x32_bf16 v[208:211], a[228:231], v[68:71], v[208:211]
    v_exp_f32 v213, v213
    v_mfma_f32_16x16x32_bf16 v[208:211], a[232:235], v[72:75], v[208:211]
Ltour6:
    s_cbranch_execz Ltour10
    v_exp_f32 v214, v214
    v_mfma_f32_16x16x32_bf16 v[208:211], a[236:239], v[76:79], v[208:211]
    s_add_u32 s37, s55, 0
    v_exp_f32 v215, v215
    v_mfma_f32_16x16x32_bf16 a[96:99], a[176:179], v[128:131], a[96:99]
    ds_read_b64_tr_b16 a[188:189], v27 offset:8192
    v_cvt_pk_bf16_f32 v188, v212, v213
    v_mfma_f32_16x16x32_bf16 a[96:99], a[180:183], v[132:135], a[96:99]
    ds_read_b64_tr_b16 a[190:191], v27 offset:12288
    v_lshrrev_b32 v245, 4, v1
    v_mfma_f32_16x16x32_bf16 a[100:103], a[176:179], v[136:139], a[100:103]
    ds_read_b128 a[212:215], v9 offset:32768
    v_cvt_pk_bf16_f32 v189, v214, v215
    v_mfma_f32_16x16x32_bf16 a[100:103], a[180:183], v[140:143], a[100:103]
    buffer_load_dword v239, v238, s[28:31], s37 offen
    v_mfma_f32_16x16x32_bf16 v[212:215], a[224:227], v[80:83], v[196:199]
    v_exp_f32 v208, v208
    v_mfma_f32_16x16x32_bf16 v[212:215], a[228:231], v[84:87], v[212:215]
    v_exp_f32 v209, v209
    v_mfma_f32_16x16x32_bf16 v[212:215], a[232:235], v[88:91], v[212:215]
    v_exp_f32 v210, v210
    v_mfma_f32_16x16x32_bf16 v[212:215], a[236:239], v[92:95], v[212:215]
    v_exp_f32 v211, v211
    v_mfma_f32_16x16x32_bf16 a[104:107], a[176:179], v[144:147], a[104:107]
    ds_read_b64_tr_b16 a[160:161], v20 offset:16384
    v_cvt_pk_bf16_f32 v166, v208, v209
    v_mfma_f32_16x16x32_bf16 a[104:107], a[180:183], v[148:151], a[104:107]
    ds_read_b64_tr_b16 a[162:163], v20 offset:20480
    v_lshl_add_u32 v244, v245, 3, v244
    v_mfma_f32_16x16x32_bf16 a[108:111], a[176:179], v[152:155], a[108:111]
    ds_read_b128 a[216:219], v10 offset:32768
    v_cvt_pk_bf16_f32 v167, v210, v211
    v_mfma_f32_16x16x32_bf16 a[108:111], a[180:183], v[156:159], a[108:111]
    s_waitcnt lgkmcnt(3)
    buffer_load_dwordx4 v47, s[20:23], s49 offen offset:1024 lds
    v_mfma_f32_16x16x32_bf16 v[208:211], a[224:227], v[96:99], v[200:203]
    v_exp_f32 v212, v212
    v_mfma_f32_16x16x32_bf16 v[208:211], a[228:231], v[100:103], v[208:211]
    v_exp_f32 v213, v213
    v_mfma_f32_16x16x32_bf16 v[208:211], a[232:235], v[104:107], v[208:211]
    v_exp_f32 v214, v214
    v_mfma_f32_16x16x32_bf16 v[208:211], a[236:239], v[108:111], v[208:211]
    s_add_u32 s57, s58, 1769472
    v_exp_f32 v215, v215
    v_mfma_f32_16x16x32_bf16 a[112:115], a[184:187], v[128:131], a[112:115]
    ds_read_b64_tr_b16 a[164:165], v20 offset:24576
    v_cvt_pk_bf16_f32 v174, v212, v213
    v_mfma_f32_16x16x32_bf16 a[112:115], a[188:191], v[132:135], a[112:115]
    ds_read_b64_tr_b16 a[166:167], v20 offset:28672
    v_mfma_f32_16x16x32_bf16 a[116:119], a[184:187], v[136:139], a[116:119]
    ds_read_b128 a[220:223], v11 offset:32768
    v_cvt_pk_bf16_f32 v175, v214, v215
    v_mfma_f32_16x16x32_bf16 a[116:119], a[188:191], v[140:143], a[116:119]
    buffer_load_dwordx4 a[140:143], v254, s[80:83], s57 offen
    v_mfma_f32_16x16x32_bf16 v[212:215], a[224:227], v[112:115], v[204:207]
    v_exp_f32 v208, v208
    v_mfma_f32_16x16x32_bf16 v[212:215], a[228:231], v[116:119], v[212:215]
    v_exp_f32 v209, v209
    v_mfma_f32_16x16x32_bf16 v[212:215], a[232:235], v[120:123], v[212:215]
    v_exp_f32 v210, v210
    v_mfma_f32_16x16x32_bf16 v[212:215], a[236:239], v[124:127], v[212:215]
    v_exp_f32 v211, v211
    v_mfma_f32_16x16x32_bf16 a[120:123], a[184:187], v[144:147], a[120:123]
    ds_read_b64_tr_b16 a[168:169], v21 offset:16384
    v_cvt_pk_bf16_f32 v182, v208, v209
    v_mfma_f32_16x16x32_bf16 a[120:123], a[188:191], v[148:151], a[120:123]
    ds_read_b64_tr_b16 a[170:171], v21 offset:20480
    v_mfma_f32_16x16x32_bf16 a[124:127], a[184:187], v[152:155], a[124:127]
    ds_read_b128 a[224:227], v8 offset:36864
    v_cvt_pk_bf16_f32 v183, v210, v211
    v_mfma_f32_16x16x32_bf16 a[124:127], a[188:191], v[156:159], a[124:127]
    s_waitcnt lgkmcnt(3)
    buffer_load_dwordx4 v48, s[20:23], s49 offen offset:2048 lds
    v_mfma_f32_16x16x32_bf16 v[208:211], a[208:211], v[64:67], v[192:195]
    v_exp_f32 v212, v212
    v_mfma_f32_16x16x32_bf16 v[208:211], a[212:215], v[68:71], v[208:211]
    v_exp_f32 v213, v213
    v_mfma_f32_16x16x32_bf16 v[208:211], a[216:219], v[72:75], v[208:211]
    v_exp_f32 v214, v214
    v_mfma_f32_16x16x32_bf16 v[208:211], a[220:223], v[76:79], v[208:211]
    s_add_u32 s57, s58, 2359296
    v_exp_f32 v215, v215
    v_mfma_f32_16x16x32_bf16 a[0:3], a[160:163], v[160:163], a[0:3]
    ds_read_b64_tr_b16 a[172:173], v21 offset:24576
    v_cvt_pk_bf16_f32 v190, v212, v213
    v_mfma_f32_16x16x32_bf16 a[0:3], a[164:167], v[164:167], a[0:3]
    ds_read_b64_tr_b16 a[174:175], v21 offset:28672
    v_mov_b32 v63, 0
    v_mfma_f32_16x16x32_bf16 a[4:7], a[160:163], v[168:171], a[4:7]
    ds_read_b128 a[228:231], v9 offset:36864
    v_cvt_pk_bf16_f32 v191, v214, v215
    v_mfma_f32_16x16x32_bf16 a[4:7], a[164:167], v[172:175], a[4:7]
    buffer_load_dwordx4 a[144:147], v254, s[80:83], s57 offen
    v_mfma_f32_16x16x32_bf16 v[212:215], a[208:211], v[80:83], v[196:199]
    v_exp_f32 v208, v208
    v_mfma_f32_16x16x32_bf16 v[212:215], a[212:215], v[84:87], v[212:215]
    v_exp_f32 v209, v209
    v_mfma_f32_16x16x32_bf16 v[212:215], a[216:219], v[88:91], v[212:215]
    v_exp_f32 v210, v210
    v_mfma_f32_16x16x32_bf16 v[212:215], a[220:223], v[92:95], v[212:215]
    v_exp_f32 v211, v211
    v_mfma_f32_16x16x32_bf16 a[8:11], a[160:163], v[176:179], a[8:11]
    ds_read_b64_tr_b16 a[176:177], v22 offset:16384
    v_cvt_pk_bf16_f32 v128, v208, v209
    v_mfma_f32_16x16x32_bf16 a[8:11], a[164:167], v[180:183], a[8:11]
    ds_read_b64_tr_b16 a[178:179], v22 offset:20480
    v_add_f32_dpp v224, v224, v224 row_ror:2 row_mask:0xf bank_mask:0xf
    v_mfma_f32_16x16x32_bf16 a[12:15], a[160:163], v[184:187], a[12:15]
    ds_read_b128 a[232:235], v10 offset:36864
    v_cvt_pk_bf16_f32 v129, v210, v211
    v_mfma_f32_16x16x32_bf16 a[12:15], a[164:167], v[188:191], a[12:15]
    s_waitcnt lgkmcnt(3)
    buffer_load_dwordx4 v49, s[20:23], s49 offen offset:3072 lds
    v_mfma_f32_16x16x32_bf16 v[208:211], a[208:211], v[96:99], v[200:203]
    s_lshr_b32 s39, s2, 5
    v_exp_f32 v212, v212
    v_mfma_f32_16x16x32_bf16 v[208:211], a[212:215], v[100:103], v[208:211]
    s_lshl_b32 s39, s39, 3
    v_exp_f32 v213, v213
    v_mfma_f32_16x16x32_bf16 v[208:211], a[216:219], v[104:107], v[208:211]
    s_and_b32 s43, s2, 7
    v_exp_f32 v214, v214
    v_mfma_f32_16x16x32_bf16 v[208:211], a[220:223], v[108:111], v[208:211]
    s_add_u32 s39, s39, s43
    v_exp_f32 v215, v215
    v_mfma_f32_16x16x32_bf16 a[16:19], a[168:171], v[160:163], a[16:19]
    ds_read_b64_tr_b16 a[180:181], v22 offset:24576
    v_cvt_pk_bf16_f32 v136, v212, v213
    v_mfma_f32_16x16x32_bf16 a[16:19], a[172:175], v[164:167], a[16:19]
    ds_read_b64_tr_b16 a[182:183], v22 offset:28672
    v_add_f32_dpp v225, v225, v225 row_ror:2 row_mask:0xf bank_mask:0xf
    v_mfma_f32_16x16x32_bf16 a[20:23], a[168:171], v[168:171], a[20:23]
    ds_read_b128 a[236:239], v11 offset:36864
    v_cvt_pk_bf16_f32 v137, v214, v215
    v_mfma_f32_16x16x32_bf16 a[20:23], a[172:175], v[172:175], a[20:23]
    buffer_load_dword v253, v63, s[24:27], s54 offen offset:12 sc1
    v_smfmac_f32_16x16x64_bf16 a[192:195], v[52:55], v[160:167], v50
    v_mfma_f32_16x16x32_bf16 v[212:215], a[208:211], v[112:115], v[204:207]
    s_lshl_b32 s39, s39, 2
    v_exp_f32 v208, v208
    v_mfma_f32_16x16x32_bf16 v[212:215], a[212:215], v[116:119], v[212:215]
    s_add_u32 m0, s42, 114688
    v_exp_f32 v209, v209
    v_mfma_f32_16x16x32_bf16 v[212:215], a[216:219], v[120:123], v[212:215]
    s_bfe_u32 s43, s2, 0x20003
    v_exp_f32 v210, v210
    v_mfma_f32_16x16x32_bf16 v[212:215], a[220:223], v[124:127], v[212:215]
    s_add_u32 s39, s39, s43
    v_exp_f32 v211, v211
    v_mfma_f32_16x16x32_bf16 a[24:27], a[168:171], v[176:179], a[24:27]
    ds_read_b64_tr_b16 a[184:185], v23 offset:16384
    v_cvt_pk_bf16_f32 v144, v208, v209
    v_mfma_f32_16x16x32_bf16 a[24:27], a[172:175], v[180:183], a[24:27]
    ds_read_b64_tr_b16 a[186:187], v23 offset:20480
    v_add_f32_dpp v224, v224, v224 row_ror:4 row_mask:0xf bank_mask:0xf
    v_mfma_f32_16x16x32_bf16 a[28:31], a[168:171], v[184:187], a[28:31]
    ds_read_b128 a[208:211], v8 offset:40960
    v_cvt_pk_bf16_f32 v145, v210, v211
    v_mfma_f32_16x16x32_bf16 a[28:31], a[172:175], v[188:191], a[28:31]
    s_waitcnt lgkmcnt(3)
    buffer_load_dwordx4 v40, s[12:15], s41 offen lds
    v_mfma_f32_16x16x32_bf16 v[208:211], a[224:227], v[64:67], v[192:195]
    s_add_u32 s39, s39, 72
    v_exp_f32 v212, v212
    v_mfma_f32_16x16x32_bf16 v[208:211], a[228:231], v[68:71], v[208:211]
    s_cmp_lt_u32 s39, 216
    s_cselect_b32 s43, 0, 2147483648
    v_exp_f32 v213, v213
    v_mfma_f32_16x16x32_bf16 v[208:211], a[232:235], v[72:75], v[208:211]
    s_or_b32 s43, s43, s48
    v_exp_f32 v214, v214
    v_mfma_f32_16x16x32_bf16 v[208:211], a[236:239], v[76:79], v[208:211]
    s_add_u32 s57, s58, 2949120
    v_exp_f32 v215, v215
    v_mfma_f32_16x16x32_bf16 a[32:35], a[176:179], v[160:163], a[32:35]
    ds_read_b64_tr_b16 a[188:189], v23 offset:24576
    v_cvt_pk_bf16_f32 v152, v212, v213
    v_mfma_f32_16x16x32_bf16 a[32:35], a[180:183], v[164:167], a[32:35]
    ds_read_b64_tr_b16 a[190:191], v23 offset:28672
    v_add_f32_dpp v225, v225, v225 row_ror:4 row_mask:0xf bank_mask:0xf
    v_mfma_f32_16x16x32_bf16 a[36:39], a[176:179], v[168:171], a[36:39]
    ds_read_b128 a[212:215], v9 offset:40960
    v_cvt_pk_bf16_f32 v153, v214, v215
    v_mfma_f32_16x16x32_bf16 a[36:39], a[180:183], v[172:175], a[36:39]
    buffer_load_dwordx4 a[148:151], v254, s[80:83], s57 offen
    v_smfmac_f32_16x16x64_bf16 a[196:199], v[52:55], v[168:175], v50
    v_mfma_f32_16x16x32_bf16 v[212:215], a[224:227], v[80:83], v[196:199]
    s_and_b32 s43, s43, 2147483648
    v_exp_f32 v208, v208
    v_mfma_f32_16x16x32_bf16 v[212:215], a[228:231], v[84:87], v[212:215]
    s_sub_u32 s36, s39, 144
    v_exp_f32 v209, v209
    v_mfma_f32_16x16x32_bf16 v[212:215], a[232:235], v[88:91], v[212:215]
    s_cmp_lt_u32 s36, 36
    s_cselect_b32 s36, 1.0, 0
    v_exp_f32 v210, v210
    v_mfma_f32_16x16x32_bf16 v[212:215], a[236:239], v[92:95], v[212:215]
    s_lshr_b32 s44, s39, 1
    v_exp_f32 v211, v211
    v_mfma_f32_16x16x32_bf16 a[40:43], a[176:179], v[176:179], a[40:43]
    ds_read_b64_tr_b16 a[160:161], v24 offset:16384
    v_cvt_pk_bf16_f32 v130, v208, v209
    v_mfma_f32_16x16x32_bf16 a[40:43], a[180:183], v[180:183], a[40:43]
    ds_read_b64_tr_b16 a[162:163], v24 offset:20480
    v_add_f32_dpp v224, v224, v224 row_ror:8 row_mask:0xf bank_mask:0xf
    v_mfma_f32_16x16x32_bf16 a[44:47], a[176:179], v[184:187], a[44:47]
    ds_read_b128 a[216:219], v10 offset:40960
    v_cvt_pk_bf16_f32 v131, v210, v211
    v_mfma_f32_16x16x32_bf16 a[44:47], a[180:183], v[188:191], a[44:47]
    s_waitcnt lgkmcnt(3)
    buffer_load_dwordx4 v41, s[12:15], s41 offen offset:1024 lds
    v_mfma_f32_16x16x32_bf16 v[208:211], a[224:227], v[96:99], v[200:203]
    s_lshl_b32 s44, s44, 6
    v_exp_f32 v212, v212
    v_mfma_f32_16x16x32_bf16 v[208:211], a[228:231], v[100:103], v[208:211]
    s_and_b32 s39, s39, 1
    v_exp_f32 v213, v213
    v_mfma_f32_16x16x32_bf16 v[208:211], a[232:235], v[104:107], v[208:211]
    s_lshl_b32 s39, s39, 3
    v_exp_f32 v214, v214
    v_mfma_f32_16x16x32_bf16 v[208:211], a[236:239], v[108:111], v[208:211]
    s_add_u32 s39, s39, s44
    v_exp_f32 v215, v215
    v_mfma_f32_16x16x32_bf16 a[48:51], a[184:187], v[160:163], a[48:51]
    ds_read_b64_tr_b16 a[164:165], v24 offset:24576
    v_cvt_pk_bf16_f32 v138, v212, v213
    v_mfma_f32_16x16x32_bf16 a[48:51], a[188:191], v[164:167], a[48:51]
    ds_read_b64_tr_b16 a[166:167], v24 offset:28672
    v_add_f32_dpp v225, v225, v225 row_ror:8 row_mask:0xf bank_mask:0xf
    v_mfma_f32_16x16x32_bf16 a[52:55], a[184:187], v[168:171], a[52:55]
    ds_read_b128 a[220:223], v11 offset:40960
    v_cvt_pk_bf16_f32 v139, v214, v215
    v_mfma_f32_16x16x32_bf16 a[52:55], a[188:191], v[172:175], a[52:55]
    v_add_u32 v244, s38, v244
    v_and_b32 v245, 7, v1
    v_smfmac_f32_16x16x64_bf16 a[200:203], v[52:55], v[176:183], v50
    v_mfma_f32_16x16x32_bf16 v[212:215], a[224:227], v[112:115], v[204:207]
    s_add_u32 s39, s39, 16384
    v_exp_f32 v208, v208
    v_mfma_f32_16x16x32_bf16 v[212:215], a[228:231], v[116:119], v[212:215]
    s_or_b32 s39, s39, s43
    v_exp_f32 v209, v209
    v_mfma_f32_16x16x32_bf16 v[212:215], a[232:235], v[120:123], v[212:215]
    v_exp_f32 v210, v210
    v_mfma_f32_16x16x32_bf16 v[212:215], a[236:239], v[124:127], v[212:215]
    v_exp_f32 v211, v211
    v_mfma_f32_16x16x32_bf16 a[56:59], a[184:187], v[176:179], a[56:59]
    ds_read_b64_tr_b16 a[168:169], v25 offset:16384
    v_cvt_pk_bf16_f32 v146, v208, v209
    v_mfma_f32_16x16x32_bf16 a[56:59], a[188:191], v[180:183], a[56:59]
    ds_read_b64_tr_b16 a[170:171], v25 offset:20480
    v_mfma_f32_16x16x32_bf16 a[60:63], a[184:187], v[184:187], a[60:63]
    ds_read_b128 a[224:227], v8 offset:45056
    v_cvt_pk_bf16_f32 v147, v210, v211
    v_mfma_f32_16x16x32_bf16 a[60:63], a[188:191], v[188:191], a[60:63]
    s_waitcnt lgkmcnt(3)
    buffer_load_dwordx4 v40, s[12:15], s41 offen offset:2048 lds
    v_mfma_f32_16x16x32_bf16 v[208:211], a[208:211], v[64:67], v[192:195]
    v_exp_f32 v212, v212
    v_mfma_f32_16x16x32_bf16 v[208:211], a[212:215], v[68:71], v[208:211]
    v_exp_f32 v213, v213
    v_mfma_f32_16x16x32_bf16 v[208:211], a[216:219], v[72:75], v[208:211]
    v_exp_f32 v214, v214
    v_mfma_f32_16x16x32_bf16 v[208:211], a[220:223], v[76:79], v[208:211]
    s_add_u32 s57, s58, 3538944
    v_exp_f32 v215, v215
    v_mfma_f32_16x16x32_bf16 a[64:67], a[160:163], v[160:163], a[64:67]
    ds_read_b64_tr_b16 a[172:173], v25 offset:24576
    v_cvt_pk_bf16_f32 v154, v212, v213
    v_mfma_f32_16x16x32_bf16 a[64:67], a[164:167], v[164:167], a[64:67]
    ds_read_b64_tr_b16 a[174:175], v25 offset:28672
    v_lshlrev_b32 v245, 3, v245
    v_mfma_f32_16x16x32_bf16 a[68:71], a[160:163], v[168:171], a[68:71]
    ds_read_b128 a[228:231], v9 offset:45056
    v_cvt_pk_bf16_f32 v155, v214, v215
    v_mfma_f32_16x16x32_bf16 a[68:71], a[164:167], v[172:175], a[68:71]
    buffer_load_dwordx4 a[152:155], v254, s[80:83], s57 offen
    v_smfmac_f32_16x16x64_bf16 a[204:207], v[52:55], v[184:191], v50
    ds_write_b64 v244, v[224:225]
    v_mfma_f32_16x16x32_bf16 v[212:215], a[208:211], v[80:83], v[196:199]
    v_exp_f32 v208, v208
    v_mfma_f32_16x16x32_bf16 v[212:215], a[212:215], v[84:87], v[212:215]
    v_exp_f32 v209, v209
    v_mfma_f32_16x16x32_bf16 v[212:215], a[216:219], v[88:91], v[212:215]
    v_exp_f32 v210, v210
    v_mfma_f32_16x16x32_bf16 v[212:215], a[220:223], v[92:95], v[212:215]
    v_exp_f32 v211, v211
    v_mfma_f32_16x16x32_bf16 a[72:75], a[160:163], v[176:179], a[72:75]
    ds_read_b64_tr_b16 a[176:177], v26 offset:16384
    v_cvt_pk_bf16_f32 v132, v208, v209
    v_mfma_f32_16x16x32_bf16 a[72:75], a[164:167], v[180:183], a[72:75]
    ds_read_b64_tr_b16 a[178:179], v26 offset:20480
    v_add_u32 v245, 131136, v245
    v_mfma_f32_16x16x32_bf16 a[76:79], a[160:163], v[184:187], a[76:79]
    ds_read_b128 a[232:235], v10 offset:45056
    v_cvt_pk_bf16_f32 v133, v210, v211
    v_mfma_f32_16x16x32_bf16 a[76:79], a[164:167], v[188:191], a[76:79]
    s_waitcnt lgkmcnt(3)
    buffer_load_dwordx4 v41, s[12:15], s41 offen offset:3072 lds
    v_mfma_f32_16x16x32_bf16 v[208:211], a[208:211], v[96:99], v[200:203]
    v_exp_f32 v212, v212
    v_mfma_f32_16x16x32_bf16 v[208:211], a[212:215], v[100:103], v[208:211]
    s_add_u32 s41, s41, 16384
    v_exp_f32 v213, v213
    v_mfma_f32_16x16x32_bf16 v[208:211], a[216:219], v[104:107], v[208:211]
    v_exp_f32 v214, v214
    v_mfma_f32_16x16x32_bf16 v[208:211], a[220:223], v[108:111], v[208:211]
    v_exp_f32 v215, v215
    v_mfma_f32_16x16x32_bf16 a[80:83], a[168:171], v[160:163], a[80:83]
    ds_read_b64_tr_b16 a[180:181], v26 offset:24576
    v_cvt_pk_bf16_f32 v140, v212, v213
    v_mfma_f32_16x16x32_bf16 a[80:83], a[172:175], v[164:167], a[80:83]
    ds_read_b64_tr_b16 a[182:183], v26 offset:28672
    v_mfma_f32_16x16x32_bf16 a[84:87], a[168:171], v[168:171], a[84:87]
    ds_read_b128 a[236:239], v11 offset:45056
    v_cvt_pk_bf16_f32 v141, v214, v215
    v_mfma_f32_16x16x32_bf16 a[84:87], a[172:175], v[172:175], a[84:87]
    s_waitcnt vmcnt(14)
    s_barrier
    v_mfma_f32_16x16x32_bf16 v[212:215], a[208:211], v[112:115], v[204:207]
    v_exp_f32 v208, v208
    v_mfma_f32_16x16x32_bf16 v[212:215], a[212:215], v[116:119], v[212:215]
    s_add_u32 s49, s45, 74752
    v_exp_f32 v209, v209
    v_mfma_f32_16x16x32_bf16 v[212:215], a[216:219], v[120:123], v[212:215]
    s_add_u32 m0, s42, 16384
    v_exp_f32 v210, v210
    v_mfma_f32_16x16x32_bf16 v[212:215], a[220:223], v[124:127], v[212:215]
    v_exp_f32 v211, v211
    v_mfma_f32_16x16x32_bf16 a[88:91], a[168:171], v[176:179], a[88:91]
    ds_read_b64_tr_b16 a[184:185], v27 offset:16384
    v_cvt_pk_bf16_f32 v148, v208, v209
    v_mfma_f32_16x16x32_bf16 a[88:91], a[172:175], v[180:183], a[88:91]
    ds_read_b64_tr_b16 a[186:187], v27 offset:20480
    ds_read_b64 v[224:225], v245 offset:0
    v_mfma_f32_16x16x32_bf16 a[92:95], a[168:171], v[184:187], a[92:95]
    ds_read_b128 a[208:211], v8 offset:49152
    v_cvt_pk_bf16_f32 v149, v210, v211
    v_mfma_f32_16x16x32_bf16 a[92:95], a[172:175], v[188:191], a[92:95]
    s_waitcnt lgkmcnt(3)
    buffer_load_dwordx4 v46, s[20:23], s49 offen lds
    v_mfma_f32_16x16x32_bf16 v[208:211], a[224:227], v[64:67], v[192:195]
    v_exp_f32 v212, v212
    v_mfma_f32_16x16x32_bf16 v[208:211], a[228:231], v[68:71], v[208:211]
    v_exp_f32 v213, v213
    v_mfma_f32_16x16x32_bf16 v[208:211], a[232:235], v[72:75], v[208:211]
    v_exp_f32 v214, v214
    v_mfma_f32_16x16x32_bf16 v[208:211], a[236:239], v[76:79], v[208:211]
    s_add_u32 s37, s55, 8192
    v_exp_f32 v215, v215
    v_mfma_f32_16x16x32_bf16 a[96:99], a[176:179], v[160:163], a[96:99]
    ds_read_b64_tr_b16 a[188:189], v27 offset:24576
    v_cvt_pk_bf16_f32 v156, v212, v213
    v_mfma_f32_16x16x32_bf16 a[96:99], a[180:183], v[164:167], a[96:99]
    ds_read_b64_tr_b16 a[190:191], v27 offset:28672
    ds_read_b64 v[226:227], v245 offset:64
    v_mfma_f32_16x16x32_bf16 a[100:103], a[176:179], v[168:171], a[100:103]
    ds_read_b128 a[212:215], v9 offset:49152
    v_cvt_pk_bf16_f32 v157, v214, v215
    v_mfma_f32_16x16x32_bf16 a[100:103], a[180:183], v[172:175], a[100:103]
    buffer_load_dword v234, v238, s[28:31], s37 offen
    v_mfma_f32_16x16x32_bf16 v[212:215], a[224:227], v[80:83], v[196:199]
    v_exp_f32 v208, v208
    v_mfma_f32_16x16x32_bf16 v[212:215], a[228:231], v[84:87], v[212:215]
    v_exp_f32 v209, v209
    v_mfma_f32_16x16x32_bf16 v[212:215], a[232:235], v[88:91], v[212:215]
    v_exp_f32 v210, v210
    v_mfma_f32_16x16x32_bf16 v[212:215], a[236:239], v[92:95], v[212:215]
    v_exp_f32 v211, v211
    v_mfma_f32_16x16x32_bf16 a[104:107], a[176:179], v[176:179], a[104:107]
    ds_read_b64_tr_b16 a[160:161], v20 offset:32768
    v_cvt_pk_bf16_f32 v134, v208, v209
    v_mfma_f32_16x16x32_bf16 a[104:107], a[180:183], v[180:183], a[104:107]
    ds_read_b64_tr_b16 a[162:163], v20 offset:36864
    ds_read_b64 v[228:229], v245 offset:128
    v_mfma_f32_16x16x32_bf16 a[108:111], a[176:179], v[184:187], a[108:111]
    ds_read_b128 a[216:219], v10 offset:49152
    v_cvt_pk_bf16_f32 v135, v210, v211
    v_mfma_f32_16x16x32_bf16 a[108:111], a[180:183], v[188:191], a[108:111]
    s_waitcnt lgkmcnt(3)
    buffer_load_dwordx4 v47, s[20:23], s49 offen offset:1024 lds
    v_mfma_f32_16x16x32_bf16 v[208:211], a[224:227], v[96:99], v[200:203]
    v_exp_f32 v212, v212
    v_mfma_f32_16x16x32_bf16 v[208:211], a[228:231], v[100:103], v[208:211]
    v_exp_f32 v213, v213
    v_mfma_f32_16x16x32_bf16 v[208:211], a[232:235], v[104:107], v[208:211]
    v_exp_f32 v214, v214
    v_mfma_f32_16x16x32_bf16 v[208:211], a[236:239], v[108:111], v[208:211]
    s_add_u32 s57, s58, 4128768
    v_exp_f32 v215, v215
    v_mfma_f32_16x16x32_bf16 a[112:115], a[184:187], v[160:163], a[112:115]
    ds_read_b64_tr_b16 a[164:165], v20 offset:40960
    v_cvt_pk_bf16_f32 v142, v212, v213
    v_mfma_f32_16x16x32_bf16 a[112:115], a[188:191], v[164:167], a[112:115]
    ds_read_b64_tr_b16 a[166:167], v20 offset:45056
    ds_read_b64 v[230:231], v245 offset:192
    v_mfma_f32_16x16x32_bf16 a[116:119], a[184:187], v[168:171], a[116:119]
    ds_read_b128 a[220:223], v11 offset:49152
    v_cvt_pk_bf16_f32 v143, v214, v215
    v_mfma_f32_16x16x32_bf16 a[116:119], a[188:191], v[172:175], a[116:119]
    buffer_load_dwordx4 a[156:159], v254, s[80:83], s57 offen
    v_mfma_f32_16x16x32_bf16 v[212:215], a[224:227], v[112:115], v[204:207]
    v_exp_f32 v208, v208
    v_mfma_f32_16x16x32_bf16 v[212:215], a[228:231], v[116:119], v[212:215]
    v_exp_f32 v209, v209
    v_mfma_f32_16x16x32_bf16 v[212:215], a[232:235], v[120:123], v[212:215]
    v_exp_f32 v210, v210
    v_mfma_f32_16x16x32_bf16 v[212:215], a[236:239], v[124:127], v[212:215]
    v_exp_f32 v211, v211
    v_mfma_f32_16x16x32_bf16 a[120:123], a[184:187], v[176:179], a[120:123]
    ds_read_b64_tr_b16 a[168:169], v21 offset:32768
    v_cvt_pk_bf16_f32 v150, v208, v209
    v_mfma_f32_16x16x32_bf16 a[120:123], a[188:191], v[180:183], a[120:123]
    ds_read_b64_tr_b16 a[170:171], v21 offset:36864
    v_mfma_f32_16x16x32_bf16 a[124:127], a[184:187], v[184:187], a[124:127]
    ds_read_b128 a[224:227], v8 offset:53248
    v_cvt_pk_bf16_f32 v151, v210, v211
    v_mfma_f32_16x16x32_bf16 a[124:127], a[188:191], v[188:191], a[124:127]
    s_waitcnt lgkmcnt(3)
    buffer_load_dwordx4 v48, s[20:23], s49 offen offset:2048 lds
    v_mfma_f32_16x16x32_bf16 v[208:211], a[208:211], v[64:67], v[192:195]
    v_exp_f32 v212, v212
    v_mfma_f32_16x16x32_bf16 v[208:211], a[212:215], v[68:71], v[208:211]
    v_exp_f32 v213, v213
    v_mfma_f32_16x16x32_bf16 v[208:211], a[216:219], v[72:75], v[208:211]
    v_exp_f32 v214, v214
    v_mfma_f32_16x16x32_bf16 v[208:211], a[220:223], v[76:79], v[208:211]
    s_add_u32 s57, s58, 4718592
    v_exp_f32 v215, v215
    v_mfma_f32_16x16x32_bf16 a[0:3], a[160:163], v[128:131], a[0:3]
    ds_read_b64_tr_b16 a[172:173], v21 offset:40960
    v_cvt_pk_bf16_f32 v158, v212, v213
    v_mfma_f32_16x16x32_bf16 a[0:3], a[164:167], v[132:135], a[0:3]
    ds_read_b64_tr_b16 a[174:175], v21 offset:45056
    v_add_f32 v224, v224, v228
    v_mfma_f32_16x16x32_bf16 a[4:7], a[160:163], v[136:139], a[4:7]
    ds_read_b128 a[228:231], v9 offset:53248
    v_cvt_pk_bf16_f32 v159, v214, v215
    v_mfma_f32_16x16x32_bf16 a[4:7], a[164:167], v[140:143], a[4:7]
    buffer_load_dwordx4 a[240:243], v254, s[80:83], s57 offen
    v_mfma_f32_16x16x32_bf16 v[212:215], a[208:211], v[80:83], v[196:199]
    v_exp_f32 v208, v208
    v_mfma_f32_16x16x32_bf16 v[212:215], a[212:215], v[84:87], v[212:215]
    v_exp_f32 v209, v209
    v_mfma_f32_16x16x32_bf16 v[212:215], a[216:219], v[88:91], v[212:215]
    v_exp_f32 v210, v210
    v_mfma_f32_16x16x32_bf16 v[212:215], a[220:223], v[92:95], v[212:215]
    v_exp_f32 v211, v211
    v_mfma_f32_16x16x32_bf16 a[8:11], a[160:163], v[144:147], a[8:11]
    ds_read_b64_tr_b16 a[176:177], v22 offset:32768
    v_cvt_pk_bf16_f32 v160, v208, v209
    v_mfma_f32_16x16x32_bf16 a[8:11], a[164:167], v[148:151], a[8:11]
    ds_read_b64_tr_b16 a[178:179], v22 offset:36864
    v_add_f32 v225, v225, v229
    v_mfma_f32_16x16x32_bf16 a[12:15], a[160:163], v[152:155], a[12:15]
    ds_read_b128 a[232:235], v10 offset:53248
    v_cvt_pk_bf16_f32 v161, v210, v211
    v_mfma_f32_16x16x32_bf16 a[12:15], a[164:167], v[156:159], a[12:15]
    s_waitcnt lgkmcnt(3)
    buffer_load_dwordx4 v49, s[20:23], s49 offen offset:3072 lds
    v_mfma_f32_16x16x32_bf16 v[208:211], a[208:211], v[96:99], v[200:203]
    v_exp_f32 v212, v212
    v_mfma_f32_16x16x32_bf16 v[208:211], a[212:215], v[100:103], v[208:211]
    v_exp_f32 v213, v213
    v_mfma_f32_16x16x32_bf16 v[208:211], a[216:219], v[104:107], v[208:211]
    v_exp_f32 v214, v214
    v_mfma_f32_16x16x32_bf16 v[208:211], a[220:223], v[108:111], v[208:211]
    v_exp_f32 v215, v215
    v_mfma_f32_16x16x32_bf16 a[16:19], a[168:171], v[128:131], a[16:19]
    ds_read_b64_tr_b16 a[180:181], v22 offset:40960
    v_cvt_pk_bf16_f32 v168, v212, v213
    v_mfma_f32_16x16x32_bf16 a[16:19], a[172:175], v[132:135], a[16:19]
    ds_read_b64_tr_b16 a[182:183], v22 offset:45056
    v_add_f32 v226, v226, v230
    v_mfma_f32_16x16x32_bf16 a[20:23], a[168:171], v[136:139], a[20:23]
    ds_read_b128 a[236:239], v11 offset:53248
    v_cvt_pk_bf16_f32 v169, v214, v215
    v_mfma_f32_16x16x32_bf16 a[20:23], a[172:175], v[140:143], a[20:23]
    v_add_f32 v227, v227, v231
    v_add_f32 v224, v224, v226
    v_smfmac_f32_16x16x64_bf16 a[192:195], v[52:55], v[128:135], v50
    v_mfma_f32_16x16x32_bf16 v[212:215], a[208:211], v[112:115], v[204:207]
    v_exp_f32 v208, v208
    v_mfma_f32_16x16x32_bf16 v[212:215], a[212:215], v[116:119], v[212:215]
    s_add_u32 s49, s7, 0
    v_exp_f32 v209, v209
    v_mfma_f32_16x16x32_bf16 v[212:215], a[216:219], v[120:123], v[212:215]
    s_add_u32 m0, s42, 65536
    v_exp_f32 v210, v210
    v_mfma_f32_16x16x32_bf16 v[212:215], a[220:223], v[124:127], v[212:215]
    v_exp_f32 v211, v211
    v_mfma_f32_16x16x32_bf16 a[24:27], a[168:171], v[144:147], a[24:27]
    ds_read_b64_tr_b16 a[184:185], v23 offset:32768
    v_cvt_pk_bf16_f32 v176, v208, v209
    v_mfma_f32_16x16x32_bf16 a[24:27], a[172:175], v[148:151], a[24:27]
    ds_read_b64_tr_b16 a[186:187], v23 offset:36864
    v_add_f32 v225, v225, v227
    v_mfma_f32_16x16x32_bf16 a[28:31], a[168:171], v[152:155], a[28:31]
    ds_read_b128 a[208:211], v8 offset:57344
    v_cvt_pk_bf16_f32 v177, v210, v211
    v_mfma_f32_16x16x32_bf16 a[28:31], a[172:175], v[156:159], a[28:31]
    s_waitcnt lgkmcnt(3)
    buffer_load_dwordx4 v46, s[20:23], s49 offen lds
    v_mfma_f32_16x16x32_bf16 v[208:211], a[224:227], v[64:67], v[192:195]
    v_exp_f32 v212, v212
    v_mfma_f32_16x16x32_bf16 v[208:211], a[228:231], v[68:71], v[208:211]
    v_exp_f32 v213, v213
    v_mfma_f32_16x16x32_bf16 v[208:211], a[232:235], v[72:75], v[208:211]
    v_exp_f32 v214, v214
    v_mfma_f32_16x16x32_bf16 v[208:211], a[236:239], v[76:79], v[208:211]
    s_add_u32 s57, s58, 4128768
    v_exp_f32 v215, v215
    v_mfma_f32_16x16x32_bf16 a[32:35], a[176:179], v[128:131], a[32:35]
    ds_read_b64_tr_b16 a[188:189], v23 offset:40960
    v_cvt_pk_bf16_f32 v184, v212, v213
    v_mfma_f32_16x16x32_bf16 a[32:35], a[180:183], v[132:135], a[32:35]
    ds_read_b64_tr_b16 a[190:191], v23 offset:45056
    v_cvt_pk_bf16_f32 v246, v224, v225
    v_mfma_f32_16x16x32_bf16 a[36:39], a[176:179], v[136:139], a[36:39]
    ds_read_b128 a[212:215], v9 offset:57344
    v_cvt_pk_bf16_f32 v185, v214, v215
    v_mfma_f32_16x16x32_bf16 a[36:39], a[180:183], v[140:143], a[36:39]
    buffer_load_dwordx4 a[244:247], v254, s[32:35], s57 offen
    v_smfmac_f32_16x16x64_bf16 a[196:199], v[52:55], v[136:143], v50
    v_mfma_f32_16x16x32_bf16 v[212:215], a[224:227], v[80:83], v[196:199]
    v_exp_f32 v208, v208
    v_mfma_f32_16x16x32_bf16 v[212:215], a[228:231], v[84:87], v[212:215]
    v_exp_f32 v209, v209
    v_mfma_f32_16x16x32_bf16 v[212:215], a[232:235], v[88:91], v[212:215]
    v_exp_f32 v210, v210
    v_mfma_f32_16x16x32_bf16 v[212:215], a[236:239], v[92:95], v[212:215]
    v_exp_f32 v211, v211
    v_mfma_f32_16x16x32_bf16 a[40:43], a[176:179], v[144:147], a[40:43]
    ds_read_b64_tr_b16 a[160:161], v24 offset:32768
    v_cvt_pk_bf16_f32 v162, v208, v209
    v_mfma_f32_16x16x32_bf16 a[40:43], a[180:183], v[148:151], a[40:43]
    ds_read_b64_tr_b16 a[162:163], v24 offset:36864
    v_lshlrev_b32 v224, 16, v246
    v_mfma_f32_16x16x32_bf16 a[44:47], a[176:179], v[152:155], a[44:47]
    ds_read_b128 a[216:219], v10 offset:57344
    v_cvt_pk_bf16_f32 v163, v210, v211
    v_mfma_f32_16x16x32_bf16 a[44:47], a[180:183], v[156:159], a[44:47]
    s_waitcnt lgkmcnt(3)
    buffer_load_dwordx4 v47, s[20:23], s49 offen offset:1024 lds
    v_mfma_f32_16x16x32_bf16 v[208:211], a[224:227], v[96:99], v[200:203]
    v_exp_f32 v212, v212
    v_mfma_f32_16x16x32_bf16 v[208:211], a[228:231], v[100:103], v[208:211]
    v_exp_f32 v213, v213
    v_mfma_f32_16x16x32_bf16 v[208:211], a[232:235], v[104:107], v[208:211]
    v_exp_f32 v214, v214
    v_mfma_f32_16x16x32_bf16 v[208:211], a[236:239], v[108:111], v[208:211]
    v_exp_f32 v215, v215
    v_mfma_f32_16x16x32_bf16 a[48:51], a[184:187], v[128:131], a[48:51]
    ds_read_b64_tr_b16 a[164:165], v24 offset:40960
    v_cvt_pk_bf16_f32 v170, v212, v213
    v_mfma_f32_16x16x32_bf16 a[48:51], a[188:191], v[132:135], a[48:51]
    ds_read_b64_tr_b16 a[166:167], v24 offset:45056
    v_and_b32 v225, 0xffff0000, v246
    v_mfma_f32_16x16x32_bf16 a[52:55], a[184:187], v[136:139], a[52:55]
    ds_read_b128 a[220:223], v11 offset:57344
    v_cvt_pk_bf16_f32 v171, v214, v215
    v_mfma_f32_16x16x32_bf16 a[52:55], a[188:191], v[140:143], a[52:55]
    v_add_f32 v224, s36, v224
    v_add_f32 v225, s36, v225
    v_smfmac_f32_16x16x64_bf16 a[200:203], v[52:55], v[144:151], v50
    v_mfma_f32_16x16x32_bf16 v[212:215], a[224:227], v[112:115], v[204:207]
    v_exp_f32 v208, v208
    v_mfma_f32_16x16x32_bf16 v[212:215], a[228:231], v[116:119], v[212:215]
    v_exp_f32 v209, v209
    v_mfma_f32_16x16x32_bf16 v[212:215], a[232:235], v[120:123], v[212:215]
    v_exp_f32 v210, v210
    v_mfma_f32_16x16x32_bf16 v[212:215], a[236:239], v[124:127], v[212:215]
    v_exp_f32 v211, v211
    v_mfma_f32_16x16x32_bf16 a[56:59], a[184:187], v[144:147], a[56:59]
    ds_read_b64_tr_b16 a[168:169], v25 offset:32768
    v_cvt_pk_bf16_f32 v178, v208, v209
    v_mfma_f32_16x16x32_bf16 a[56:59], a[188:191], v[148:151], a[56:59]
    ds_read_b64_tr_b16 a[170:171], v25 offset:36864
    v_cvt_pk_bf16_f32 v246, v224, v225
    v_mfma_f32_16x16x32_bf16 a[60:63], a[184:187], v[152:155], a[60:63]
    ds_read_b128 a[224:227], v8 offset:61440
    v_cvt_pk_bf16_f32 v179, v210, v211
    v_mfma_f32_16x16x32_bf16 a[60:63], a[188:191], v[156:159], a[60:63]
    s_waitcnt lgkmcnt(3)
    buffer_load_dwordx4 v48, s[20:23], s49 offen offset:2048 lds
    v_mfma_f32_16x16x32_bf16 v[208:211], a[208:211], v[64:67], v[192:195]
    v_exp_f32 v212, v212
    v_mfma_f32_16x16x32_bf16 v[208:211], a[212:215], v[68:71], v[208:211]
    v_exp_f32 v213, v213
    v_mfma_f32_16x16x32_bf16 v[208:211], a[216:219], v[72:75], v[208:211]
    v_exp_f32 v214, v214
    v_mfma_f32_16x16x32_bf16 v[208:211], a[220:223], v[76:79], v[208:211]
    s_add_u32 s57, s58, 4718592
    v_exp_f32 v215, v215
    v_mfma_f32_16x16x32_bf16 a[64:67], a[160:163], v[128:131], a[64:67]
Ltour7:
    s_cbranch_execz Ltour11
    ds_read_b64_tr_b16 a[172:173], v25 offset:40960
    v_cvt_pk_bf16_f32 v186, v212, v213
    v_mfma_f32_16x16x32_bf16 a[64:67], a[164:167], v[132:135], a[64:67]
    ds_read_b64_tr_b16 a[174:175], v25 offset:45056
    v_lshrrev_b32 v244, 1, v0
    v_mfma_f32_16x16x32_bf16 a[68:71], a[160:163], v[136:139], a[68:71]
    ds_read_b128 a[228:231], v9 offset:61440
    v_cvt_pk_bf16_f32 v187, v214, v215
    v_mfma_f32_16x16x32_bf16 a[68:71], a[164:167], v[140:143], a[68:71]
    buffer_load_dwordx4 a[248:251], v254, s[32:35], s57 offen
    v_smfmac_f32_16x16x64_bf16 a[204:207], v[52:55], v[152:159], v50
    v_mfma_f32_16x16x32_bf16 v[212:215], a[208:211], v[80:83], v[196:199]
    v_exp_f32 v208, v208
    v_mfma_f32_16x16x32_bf16 v[212:215], a[212:215], v[84:87], v[212:215]
    v_exp_f32 v209, v209
    v_mfma_f32_16x16x32_bf16 v[212:215], a[216:219], v[88:91], v[212:215]
    v_exp_f32 v210, v210
    v_mfma_f32_16x16x32_bf16 v[212:215], a[220:223], v[92:95], v[212:215]
    v_exp_f32 v211, v211
    v_mfma_f32_16x16x32_bf16 a[72:75], a[160:163], v[144:147], a[72:75]
    ds_read_b64_tr_b16 a[176:177], v26 offset:32768
    v_cvt_pk_bf16_f32 v164, v208, v209
    v_mfma_f32_16x16x32_bf16 a[72:75], a[164:167], v[148:151], a[72:75]
    ds_read_b64_tr_b16 a[178:179], v26 offset:36864
    v_lshlrev_b32 v244, 4, v244
    v_mfma_f32_16x16x32_bf16 a[76:79], a[160:163], v[152:155], a[76:79]
    ds_read_b128 a[232:235], v10 offset:61440
    v_cvt_pk_bf16_f32 v165, v210, v211
    v_mfma_f32_16x16x32_bf16 a[76:79], a[164:167], v[156:159], a[76:79]
    s_waitcnt lgkmcnt(3)
    buffer_load_dwordx4 v49, s[20:23], s49 offen offset:3072 lds
    v_mfma_f32_16x16x32_bf16 v[208:211], a[208:211], v[96:99], v[200:203]
    v_exp_f32 v212, v212
    v_mfma_f32_16x16x32_bf16 v[208:211], a[212:215], v[100:103], v[208:211]
    v_exp_f32 v213, v213
    v_mfma_f32_16x16x32_bf16 v[208:211], a[216:219], v[104:107], v[208:211]
    v_exp_f32 v214, v214
    v_mfma_f32_16x16x32_bf16 v[208:211], a[220:223], v[108:111], v[208:211]
    v_exp_f32 v215, v215
    v_mfma_f32_16x16x32_bf16 a[80:83], a[168:171], v[128:131], a[80:83]
    ds_read_b64_tr_b16 a[180:181], v26 offset:40960
    v_cvt_pk_bf16_f32 v172, v212, v213
    v_mfma_f32_16x16x32_bf16 a[80:83], a[172:175], v[132:135], a[80:83]
    ds_read_b64_tr_b16 a[182:183], v26 offset:45056
    v_and_b32 v245, 1, v0
    v_mfma_f32_16x16x32_bf16 a[84:87], a[168:171], v[136:139], a[84:87]
    ds_read_b128 a[236:239], v11 offset:61440
    v_cvt_pk_bf16_f32 v173, v214, v215
    v_mfma_f32_16x16x32_bf16 a[84:87], a[172:175], v[140:143], a[84:87]
    s_waitcnt vmcnt(13)
    s_barrier
    v_mfma_f32_16x16x32_bf16 v[212:215], a[208:211], v[112:115], v[204:207]
    v_exp_f32 v208, v208
    v_mfma_f32_16x16x32_bf16 v[212:215], a[212:215], v[116:119], v[212:215]
    s_add_u32 s49, s7, 73728
    v_exp_f32 v209, v209
    v_mfma_f32_16x16x32_bf16 v[212:215], a[216:219], v[120:123], v[212:215]
    s_add_u32 m0, s42, 81920
    v_exp_f32 v210, v210
    v_mfma_f32_16x16x32_bf16 v[212:215], a[220:223], v[124:127], v[212:215]
    v_exp_f32 v211, v211
    v_mfma_f32_16x16x32_bf16 a[88:91], a[168:171], v[144:147], a[88:91]
    ds_read_b64_tr_b16 a[184:185], v27 offset:32768
    v_cvt_pk_bf16_f32 v180, v208, v209
    v_mfma_f32_16x16x32_bf16 a[88:91], a[172:175], v[148:151], a[88:91]
    ds_read_b64_tr_b16 a[186:187], v27 offset:36864
    v_lshl_add_u32 v244, v245, 2, v244
    v_mfma_f32_16x16x32_bf16 a[92:95], a[168:171], v[152:155], a[92:95]
    v_cvt_pk_bf16_f32 v181, v210, v211
    v_mfma_f32_16x16x32_bf16 a[92:95], a[172:175], v[156:159], a[92:95]
    s_waitcnt lgkmcnt(3)
    buffer_load_dwordx4 v46, s[20:23], s49 offen lds
    v_mfma_f32_16x16x32_bf16 v[208:211], a[224:227], v[64:67], v[192:195]
    v_exp_f32 v212, v212
    v_mfma_f32_16x16x32_bf16 v[208:211], a[228:231], v[68:71], v[208:211]
    v_exp_f32 v213, v213
    v_mfma_f32_16x16x32_bf16 v[208:211], a[232:235], v[72:75], v[208:211]
    s_waitcnt lgkmcnt(2)
    v_exp_f32 v214, v214
    v_mfma_f32_16x16x32_bf16 v[208:211], a[236:239], v[76:79], v[208:211]
    v_exp_f32 v215, v215
    v_mfma_f32_16x16x32_bf16 a[96:99], a[176:179], v[128:131], a[96:99]
    ds_read_b64_tr_b16 a[188:189], v27 offset:40960
    v_cvt_pk_bf16_f32 v188, v212, v213
    v_mfma_f32_16x16x32_bf16 a[96:99], a[180:183], v[132:135], a[96:99]
    ds_read_b64_tr_b16 a[190:191], v27 offset:45056
    v_lshrrev_b32 v245, 3, v0
    v_mfma_f32_16x16x32_bf16 a[100:103], a[176:179], v[136:139], a[100:103]
    v_cvt_pk_bf16_f32 v189, v214, v215
    v_mfma_f32_16x16x32_bf16 a[100:103], a[180:183], v[140:143], a[100:103]
    v_min_u32 v245, 1, v245
    v_lshl_or_b32 v244, v245, 31, v244
    v_mfma_f32_16x16x32_bf16 v[212:215], a[224:227], v[80:83], v[196:199]
    v_exp_f32 v208, v208
    v_mfma_f32_16x16x32_bf16 v[212:215], a[228:231], v[84:87], v[212:215]
    v_exp_f32 v209, v209
    v_mfma_f32_16x16x32_bf16 v[212:215], a[232:235], v[88:91], v[212:215]
    v_exp_f32 v210, v210
    v_mfma_f32_16x16x32_bf16 v[212:215], a[236:239], v[92:95], v[212:215]
    v_exp_f32 v211, v211
    v_mfma_f32_16x16x32_bf16 a[104:107], a[176:179], v[144:147], a[104:107]
    ds_read_b64_tr_b16 a[160:161], v20 offset:49152
    v_cvt_pk_bf16_f32 v166, v208, v209
    v_mfma_f32_16x16x32_bf16 a[104:107], a[180:183], v[148:151], a[104:107]
    ds_read_b64_tr_b16 a[162:163], v20 offset:53248
    v_mfma_f32_16x16x32_bf16 a[108:111], a[176:179], v[152:155], a[108:111]
    v_cvt_pk_bf16_f32 v167, v210, v211
    v_mfma_f32_16x16x32_bf16 a[108:111], a[180:183], v[156:159], a[108:111]
    s_waitcnt lgkmcnt(3)
    buffer_load_dwordx4 v47, s[20:23], s49 offen offset:1024 lds
    v_mfma_f32_16x16x32_bf16 v[208:211], a[224:227], v[96:99], v[200:203]
    v_exp_f32 v212, v212
    v_mfma_f32_16x16x32_bf16 v[208:211], a[228:231], v[100:103], v[208:211]
    v_exp_f32 v213, v213
    v_mfma_f32_16x16x32_bf16 v[208:211], a[232:235], v[104:107], v[208:211]
    v_exp_f32 v214, v214
    v_mfma_f32_16x16x32_bf16 v[208:211], a[236:239], v[108:111], v[208:211]
    s_add_u32 s57, s59, 0
    v_exp_f32 v215, v215
    v_mfma_f32_16x16x32_bf16 a[112:115], a[184:187], v[128:131], a[112:115]
    s_waitcnt lgkmcnt(2)
    ds_read_b64_tr_b16 a[164:165], v20 offset:57344
    v_cvt_pk_bf16_f32 v174, v212, v213
    v_mfma_f32_16x16x32_bf16 a[112:115], a[188:191], v[132:135], a[112:115]
    ds_read_b64_tr_b16 a[166:167], v20 offset:61440
    v_mfma_f32_16x16x32_bf16 a[116:119], a[184:187], v[136:139], a[116:119]
    v_cvt_pk_bf16_f32 v175, v214, v215
    v_mfma_f32_16x16x32_bf16 a[116:119], a[188:191], v[140:143], a[116:119]
    buffer_load_dwordx4 a[252:255], v255, s[84:87], s57 offen
    v_mfma_f32_16x16x32_bf16 v[212:215], a[224:227], v[112:115], v[204:207]
    v_exp_f32 v208, v208
    v_mfma_f32_16x16x32_bf16 v[212:215], a[228:231], v[116:119], v[212:215]
    v_exp_f32 v209, v209
    v_mfma_f32_16x16x32_bf16 v[212:215], a[232:235], v[120:123], v[212:215]
    v_exp_f32 v210, v210
    v_mfma_f32_16x16x32_bf16 v[212:215], a[236:239], v[124:127], v[212:215]
    v_exp_f32 v211, v211
    v_mfma_f32_16x16x32_bf16 a[120:123], a[184:187], v[144:147], a[120:123]
    ds_read_b64_tr_b16 a[168:169], v21 offset:49152
    v_cvt_pk_bf16_f32 v182, v208, v209
    v_mfma_f32_16x16x32_bf16 a[120:123], a[188:191], v[148:151], a[120:123]
    ds_read_b64_tr_b16 a[170:171], v21 offset:53248
    v_mfma_f32_16x16x32_bf16 a[124:127], a[184:187], v[152:155], a[124:127]
    v_cvt_pk_bf16_f32 v183, v210, v211
    v_mfma_f32_16x16x32_bf16 a[124:127], a[188:191], v[156:159], a[124:127]
    s_waitcnt lgkmcnt(3)
    buffer_load_dwordx4 v48, s[20:23], s49 offen offset:2048 lds
    v_smfmac_f32_16x16x64_bf16 a[192:195], v[52:55], v[160:167], v50
    v_exp_f32 v212, v212
    v_smfmac_f32_16x16x64_bf16 a[196:199], v[52:55], v[168:175], v50
    v_exp_f32 v213, v213
    v_smfmac_f32_16x16x64_bf16 a[200:203], v[52:55], v[176:183], v50
    v_exp_f32 v214, v214
    v_exp_f32 v215, v215
    v_mfma_f32_16x16x32_bf16 a[0:3], a[160:163], v[160:163], a[0:3]
    s_waitcnt lgkmcnt(2)
    ds_read_b64_tr_b16 a[172:173], v21 offset:57344
    v_cvt_pk_bf16_f32 v190, v212, v213
    v_mfma_f32_16x16x32_bf16 a[0:3], a[164:167], v[164:167], a[0:3]
    ds_read_b64_tr_b16 a[174:175], v21 offset:61440
    v_mfma_f32_16x16x32_bf16 a[4:7], a[160:163], v[168:171], a[4:7]
    v_cvt_pk_bf16_f32 v191, v214, v215
    v_mfma_f32_16x16x32_bf16 a[4:7], a[164:167], v[172:175], a[4:7]
    buffer_store_dword v246, v244, s[24:27], s39 offen sc1
    v_smfmac_f32_16x16x64_bf16 a[204:207], v[52:55], v[184:191], v50
    v_mfma_f32_16x16x32_bf16 a[8:11], a[160:163], v[176:179], a[8:11]
    ds_read_b64_tr_b16 a[176:177], v22 offset:49152
    v_mfma_f32_16x16x32_bf16 a[8:11], a[164:167], v[180:183], a[8:11]
    ds_read_b64_tr_b16 a[178:179], v22 offset:53248
    v_accvgpr_read_b32 v216, a192
    v_accvgpr_read_b32 v217, a193
    v_mfma_f32_16x16x32_bf16 a[12:15], a[160:163], v[184:187], a[12:15]
    v_accvgpr_read_b32 v218, a196
    v_accvgpr_read_b32 v219, a197
    v_mfma_f32_16x16x32_bf16 a[12:15], a[164:167], v[188:191], a[12:15]
    s_waitcnt lgkmcnt(4)
    buffer_load_dwordx4 v49, s[20:23], s49 offen offset:3072 lds
    v_accvgpr_read_b32 v220, a200
    v_accvgpr_read_b32 v221, a201
    v_mfma_f32_16x16x32_bf16 a[16:19], a[168:171], v[160:163], a[16:19]
    s_waitcnt lgkmcnt(2)
    ds_read_b64_tr_b16 a[180:181], v22 offset:57344
    v_accvgpr_read_b32 v222, a204
    v_mfma_f32_16x16x32_bf16 a[16:19], a[172:175], v[164:167], a[16:19]
    ds_read_b64_tr_b16 a[182:183], v22 offset:61440
    v_accvgpr_read_b32 v223, a205
    v_add_f32 v58, v216, v217
    v_mfma_f32_16x16x32_bf16 a[20:23], a[168:171], v[168:171], a[20:23]
    v_add_f32 v59, v218, v219
    v_add_f32 v60, v220, v221
    v_mfma_f32_16x16x32_bf16 a[20:23], a[172:175], v[172:175], a[20:23]
    v_add_f32 v61, v222, v223
    v_add_f32 v216, v58, v59
    s_add_u32 s49, s7, 256
    s_add_u32 m0, s42, 32768
    v_mfma_f32_16x16x32_bf16 a[24:27], a[168:171], v[176:179], a[24:27]
    ds_read_b64_tr_b16 a[184:185], v23 offset:49152
    v_add_f32 v217, v60, v61
    v_mfma_f32_16x16x32_bf16 a[24:27], a[172:175], v[180:183], a[24:27]
    ds_read_b64_tr_b16 a[186:187], v23 offset:53248
    v_add_f32 v216, v216, v217
    v_cmp_ngt_f32 vcc, 1669332992, v216
    v_mfma_f32_16x16x32_bf16 a[28:31], a[168:171], v[184:187], a[28:31]
    v_rcp_f32 v58, v58
    v_rcp_f32 v59, v59
    v_mfma_f32_16x16x32_bf16 a[28:31], a[172:175], v[188:191], a[28:31]
    s_waitcnt lgkmcnt(4)
    buffer_load_dwordx4 v46, s[20:23], s49 offen lds
    v_rcp_f32 v60, v60
    v_rcp_f32 v61, v61
    v_mfma_f32_16x16x32_bf16 a[32:35], a[176:179], v[160:163], a[32:35]
    s_waitcnt lgkmcnt(2)
    ds_read_b64_tr_b16 a[188:189], v23 offset:57344
    v_mov_b32 v228, 131072
    v_mfma_f32_16x16x32_bf16 a[32:35], a[180:183], v[164:167], a[32:35]
    ds_read_b64_tr_b16 a[190:191], v23 offset:61440
    s_or_b32 s36, vcc_lo, vcc_hi
    v_mfma_f32_16x16x32_bf16 a[36:39], a[176:179], v[168:171], a[36:39]
    v_accvgpr_read_b32 v208, a0
    v_accvgpr_read_b32 v209, a1
    v_accvgpr_read_b32 v210, a2
    v_accvgpr_read_b32 v211, a3
    v_pk_mul_f32 v[208:209], v[208:209], v[58:59] op_sel:[0,0] op_sel_hi:[1,0]
    v_pk_mul_f32 v[210:211], v[210:211], v[58:59] op_sel:[0,0] op_sel_hi:[1,0]
    v_cvt_pk_bf16_f32 v128, v208, v209
    v_cvt_pk_bf16_f32 v129, v210, v211
    v_mfma_f32_16x16x32_bf16 a[36:39], a[180:183], v[172:175], a[36:39]
    v_accvgpr_read_b32 v212, a4
    v_accvgpr_read_b32 v213, a5
    v_accvgpr_read_b32 v214, a6
    v_accvgpr_read_b32 v215, a7
    v_pk_mul_f32 v[212:213], v[212:213], v[58:59] op_sel:[0,1] op_sel_hi:[1,1]
    v_pk_mul_f32 v[214:215], v[214:215], v[58:59] op_sel:[0,1] op_sel_hi:[1,1]
    v_cvt_pk_bf16_f32 v132, v212, v213
    v_cvt_pk_bf16_f32 v133, v214, v215
    v_mfma_f32_16x16x32_bf16 a[40:43], a[176:179], v[176:179], a[40:43]
    ds_read_b64_tr_b16 a[160:161], v24 offset:49152
    v_mov_b32 v218, s36
    v_mfma_f32_16x16x32_bf16 a[40:43], a[180:183], v[180:183], a[40:43]
    ds_read_b64_tr_b16 a[162:163], v24 offset:53248
    s_lshl_b32 s38, s3, 2
    v_mfma_f32_16x16x32_bf16 a[44:47], a[176:179], v[184:187], a[44:47]
    v_accvgpr_read_b32 v208, a8
    v_accvgpr_read_b32 v209, a9
    v_accvgpr_read_b32 v210, a10
    v_accvgpr_read_b32 v211, a11
    v_pk_mul_f32 v[208:209], v[208:209], v[60:61] op_sel:[0,0] op_sel_hi:[1,0]
    v_pk_mul_f32 v[210:211], v[210:211], v[60:61] op_sel:[0,0] op_sel_hi:[1,0]
    v_cvt_pk_bf16_f32 v136, v208, v209
    v_cvt_pk_bf16_f32 v137, v210, v211
    v_mfma_f32_16x16x32_bf16 a[44:47], a[180:183], v[188:191], a[44:47]
    s_waitcnt lgkmcnt(4)
    buffer_load_dwordx4 v47, s[20:23], s49 offen offset:1024 lds
    v_accvgpr_read_b32 v212, a12
    v_accvgpr_read_b32 v213, a13
    v_accvgpr_read_b32 v214, a14
    v_accvgpr_read_b32 v215, a15
    v_pk_mul_f32 v[212:213], v[212:213], v[60:61] op_sel:[0,1] op_sel_hi:[1,1]
    v_pk_mul_f32 v[214:215], v[214:215], v[60:61] op_sel:[0,1] op_sel_hi:[1,1]
    v_cvt_pk_bf16_f32 v140, v212, v213
    v_cvt_pk_bf16_f32 v141, v214, v215
    v_mfma_f32_16x16x32_bf16 a[48:51], a[184:187], v[160:163], a[48:51]
    s_waitcnt lgkmcnt(2)
    ds_read_b64_tr_b16 a[164:165], v24 offset:57344
    v_add_u32 v219, s38, v228
    v_mfma_f32_16x16x32_bf16 a[48:51], a[188:191], v[164:167], a[48:51]
    ds_read_b64_tr_b16 a[166:167], v24 offset:61440
    ds_write_b32 v219, v218
    v_mfma_f32_16x16x32_bf16 a[52:55], a[184:187], v[168:171], a[52:55]
    v_accvgpr_read_b32 v208, a16
    v_accvgpr_read_b32 v209, a17
    v_accvgpr_read_b32 v210, a18
    v_accvgpr_read_b32 v211, a19
    v_pk_mul_f32 v[208:209], v[208:209], v[58:59] op_sel:[0,0] op_sel_hi:[1,0]
    v_pk_mul_f32 v[210:211], v[210:211], v[58:59] op_sel:[0,0] op_sel_hi:[1,0]
    v_cvt_pk_bf16_f32 v130, v208, v209
    v_cvt_pk_bf16_f32 v131, v210, v211
    s_add_u32 s37, s55, 0
    buffer_store_dwordx4 v[128:131], v252, s[28:31], s37 offen offset:0
    v_mfma_f32_16x16x32_bf16 a[52:55], a[188:191], v[172:175], a[52:55]
    v_accvgpr_read_b32 v212, a20
    v_accvgpr_read_b32 v213, a21
    v_accvgpr_read_b32 v214, a22
    v_accvgpr_read_b32 v215, a23
    v_pk_mul_f32 v[212:213], v[212:213], v[58:59] op_sel:[0,1] op_sel_hi:[1,1]
    v_pk_mul_f32 v[214:215], v[214:215], v[58:59] op_sel:[0,1] op_sel_hi:[1,1]
    v_cvt_pk_bf16_f32 v134, v212, v213
    v_cvt_pk_bf16_f32 v135, v214, v215
    s_add_u32 s37, s55, 8192
    buffer_store_dwordx4 v[132:135], v252, s[28:31], s37 offen offset:0
    v_mfma_f32_16x16x32_bf16 a[56:59], a[184:187], v[176:179], a[56:59]
    ds_read_b64_tr_b16 a[168:169], v25 offset:49152
    v_min_u32 v240, 1, v0
    v_mfma_f32_16x16x32_bf16 a[56:59], a[188:191], v[180:183], a[56:59]
    ds_read_b64_tr_b16 a[170:171], v25 offset:53248
    v_mfma_f32_16x16x32_bf16 a[60:63], a[184:187], v[184:187], a[60:63]
    v_accvgpr_read_b32 v208, a24
    v_accvgpr_read_b32 v209, a25
    v_accvgpr_read_b32 v210, a26
    v_accvgpr_read_b32 v211, a27
    v_pk_mul_f32 v[208:209], v[208:209], v[60:61] op_sel:[0,0] op_sel_hi:[1,0]
    v_pk_mul_f32 v[210:211], v[210:211], v[60:61] op_sel:[0,0] op_sel_hi:[1,0]
    v_cvt_pk_bf16_f32 v138, v208, v209
    v_cvt_pk_bf16_f32 v139, v210, v211
    s_add_u32 s37, s55, 4096
    buffer_store_dwordx4 v[136:139], v252, s[28:31], s37 offen offset:0
    v_mfma_f32_16x16x32_bf16 a[60:63], a[188:191], v[188:191], a[60:63]
    s_waitcnt lgkmcnt(5)
    buffer_load_dwordx4 v48, s[20:23], s49 offen offset:2048 lds
    v_accvgpr_read_b32 v212, a28
    v_accvgpr_read_b32 v213, a29
    v_accvgpr_read_b32 v214, a30
    v_accvgpr_read_b32 v215, a31
    v_pk_mul_f32 v[212:213], v[212:213], v[60:61] op_sel:[0,1] op_sel_hi:[1,1]
    v_pk_mul_f32 v[214:215], v[214:215], v[60:61] op_sel:[0,1] op_sel_hi:[1,1]
    v_cvt_pk_bf16_f32 v142, v212, v213
    v_cvt_pk_bf16_f32 v143, v214, v215
    s_add_u32 s37, s55, 12288
    buffer_store_dwordx4 v[140:143], v252, s[28:31], s37 offen offset:0
    v_mfma_f32_16x16x32_bf16 a[64:67], a[160:163], v[160:163], a[64:67]
    s_waitcnt lgkmcnt(3)
    ds_read_b64_tr_b16 a[172:173], v25 offset:57344
    v_lshlrev_b32 v240, 31, v240
    v_mfma_f32_16x16x32_bf16 a[64:67], a[164:167], v[164:167], a[64:67]
    ds_read_b64_tr_b16 a[174:175], v25 offset:61440
    v_mfma_f32_16x16x32_bf16 a[68:71], a[160:163], v[168:171], a[68:71]
    v_accvgpr_read_b32 v208, a32
    v_accvgpr_read_b32 v209, a33
    v_accvgpr_read_b32 v210, a34
    v_accvgpr_read_b32 v211, a35
    v_pk_mul_f32 v[208:209], v[208:209], v[58:59] op_sel:[0,0] op_sel_hi:[1,0]
    v_pk_mul_f32 v[210:211], v[210:211], v[58:59] op_sel:[0,0] op_sel_hi:[1,0]
    v_cvt_pk_bf16_f32 v144, v208, v209
    v_cvt_pk_bf16_f32 v145, v210, v211
    v_mfma_f32_16x16x32_bf16 a[68:71], a[164:167], v[172:175], a[68:71]
    v_accvgpr_read_b32 v212, a36
    v_accvgpr_read_b32 v213, a37
    v_accvgpr_read_b32 v214, a38
    v_accvgpr_read_b32 v215, a39
    v_pk_mul_f32 v[212:213], v[212:213], v[58:59] op_sel:[0,1] op_sel_hi:[1,1]
    v_pk_mul_f32 v[214:215], v[214:215], v[58:59] op_sel:[0,1] op_sel_hi:[1,1]
    v_cvt_pk_bf16_f32 v148, v212, v213
    v_cvt_pk_bf16_f32 v149, v214, v215
    v_mfma_f32_16x16x32_bf16 a[72:75], a[160:163], v[176:179], a[72:75]
    ds_read_b64_tr_b16 a[176:177], v26 offset:49152
    v_mov_b32 v241, 1
    v_mfma_f32_16x16x32_bf16 a[72:75], a[164:167], v[180:183], a[72:75]
    ds_read_b64_tr_b16 a[178:179], v26 offset:53248
    v_mfma_f32_16x16x32_bf16 a[76:79], a[160:163], v[184:187], a[76:79]
    v_accvgpr_read_b32 v208, a40
    v_accvgpr_read_b32 v209, a41
    v_accvgpr_read_b32 v210, a42
    v_accvgpr_read_b32 v211, a43
    v_pk_mul_f32 v[208:209], v[208:209], v[60:61] op_sel:[0,0] op_sel_hi:[1,0]
    v_pk_mul_f32 v[210:211], v[210:211], v[60:61] op_sel:[0,0] op_sel_hi:[1,0]
    v_cvt_pk_bf16_f32 v152, v208, v209
    v_cvt_pk_bf16_f32 v153, v210, v211
    v_mfma_f32_16x16x32_bf16 a[76:79], a[164:167], v[188:191], a[76:79]
    s_waitcnt lgkmcnt(4)
    buffer_load_dwordx4 v49, s[20:23], s49 offen offset:3072 lds
    v_accvgpr_read_b32 v212, a44
    v_accvgpr_read_b32 v213, a45
    v_accvgpr_read_b32 v214, a46
    v_accvgpr_read_b32 v215, a47
    v_pk_mul_f32 v[212:213], v[212:213], v[60:61] op_sel:[0,1] op_sel_hi:[1,1]
    v_pk_mul_f32 v[214:215], v[214:215], v[60:61] op_sel:[0,1] op_sel_hi:[1,1]
    v_cvt_pk_bf16_f32 v156, v212, v213
    v_cvt_pk_bf16_f32 v157, v214, v215
    v_mfma_f32_16x16x32_bf16 a[80:83], a[168:171], v[160:163], a[80:83]
    s_waitcnt lgkmcnt(2)
    ds_read_b64_tr_b16 a[180:181], v26 offset:57344
    v_mfma_f32_16x16x32_bf16 a[80:83], a[172:175], v[164:167], a[80:83]
    ds_read_b64_tr_b16 a[182:183], v26 offset:61440
    v_mfma_f32_16x16x32_bf16 a[84:87], a[168:171], v[168:171], a[84:87]
    v_accvgpr_read_b32 v208, a48
    v_accvgpr_read_b32 v209, a49
    v_accvgpr_read_b32 v210, a50
    v_accvgpr_read_b32 v211, a51
    v_pk_mul_f32 v[208:209], v[208:209], v[58:59] op_sel:[0,0] op_sel_hi:[1,0]
    v_pk_mul_f32 v[210:211], v[210:211], v[58:59] op_sel:[0,0] op_sel_hi:[1,0]
    v_cvt_pk_bf16_f32 v146, v208, v209
    v_cvt_pk_bf16_f32 v147, v210, v211
    s_add_u32 s37, s55, 0
    buffer_store_dwordx4 v[144:147], v252, s[28:31], s37 offen offset:1024
    v_mfma_f32_16x16x32_bf16 a[84:87], a[172:175], v[172:175], a[84:87]
    v_accvgpr_read_b32 v212, a52
    v_accvgpr_read_b32 v213, a53
    v_accvgpr_read_b32 v214, a54
    v_accvgpr_read_b32 v215, a55
    v_pk_mul_f32 v[212:213], v[212:213], v[58:59] op_sel:[0,1] op_sel_hi:[1,1]
    v_pk_mul_f32 v[214:215], v[214:215], v[58:59] op_sel:[0,1] op_sel_hi:[1,1]
    v_cvt_pk_bf16_f32 v150, v212, v213
    v_cvt_pk_bf16_f32 v151, v214, v215
    s_add_u32 s37, s55, 8192
    buffer_store_dwordx4 v[148:151], v252, s[28:31], s37 offen offset:1024
    s_waitcnt vmcnt(22)
    s_barrier
    v_mfma_f32_16x16x32_bf16 a[88:91], a[168:171], v[176:179], a[88:91]
    ds_read_b64_tr_b16 a[184:185], v27 offset:49152
    v_mfma_f32_16x16x32_bf16 a[88:91], a[172:175], v[180:183], a[88:91]
    ds_read_b64_tr_b16 a[186:187], v27 offset:53248
    v_mfma_f32_16x16x32_bf16 a[92:95], a[168:171], v[184:187], a[92:95]
    ds_read_b128 v[224:227], v228
    v_accvgpr_read_b32 v208, a56
    v_accvgpr_read_b32 v209, a57
    v_accvgpr_read_b32 v210, a58
    v_accvgpr_read_b32 v211, a59
    v_pk_mul_f32 v[208:209], v[208:209], v[60:61] op_sel:[0,0] op_sel_hi:[1,0]
    v_pk_mul_f32 v[210:211], v[210:211], v[60:61] op_sel:[0,0] op_sel_hi:[1,0]
    v_cvt_pk_bf16_f32 v154, v208, v209
    v_cvt_pk_bf16_f32 v155, v210, v211
    s_add_u32 s37, s55, 4096
    buffer_store_dwordx4 v[152:155], v252, s[28:31], s37 offen offset:1024
    v_mfma_f32_16x16x32_bf16 a[92:95], a[172:175], v[188:191], a[92:95]
    s_waitcnt lgkmcnt(5)
    v_accvgpr_read_b32 v212, a60
    v_accvgpr_read_b32 v213, a61
    v_accvgpr_read_b32 v214, a62
    v_accvgpr_read_b32 v215, a63
    v_pk_mul_f32 v[212:213], v[212:213], v[60:61] op_sel:[0,1] op_sel_hi:[1,1]
    v_pk_mul_f32 v[214:215], v[214:215], v[60:61] op_sel:[0,1] op_sel_hi:[1,1]
    v_cvt_pk_bf16_f32 v158, v212, v213
    v_cvt_pk_bf16_f32 v159, v214, v215
    s_add_u32 s37, s55, 12288
    buffer_store_dwordx4 v[156:159], v252, s[28:31], s37 offen offset:1024
    s_add_u32 s49, s7, 73984
    v_mfma_f32_16x16x32_bf16 a[96:99], a[176:179], v[160:163], a[96:99]
    s_waitcnt lgkmcnt(3)
    s_add_u32 m0, s42, 49152
    ds_read_b64_tr_b16 a[188:189], v27 offset:57344
    v_mfma_f32_16x16x32_bf16 a[96:99], a[180:183], v[164:167], a[96:99]
    buffer_load_dwordx4 v46, s[20:23], s49 offen lds
    v_mfma_f32_16x16x32_bf16 a[100:103], a[176:179], v[168:171], a[100:103]
    ds_read_b64_tr_b16 a[190:191], v27 offset:61440
    v_accvgpr_read_b32 v208, a64
    v_accvgpr_read_b32 v209, a65
    v_accvgpr_read_b32 v210, a66
    v_accvgpr_read_b32 v211, a67
    v_pk_mul_f32 v[208:209], v[208:209], v[58:59] op_sel:[0,0] op_sel_hi:[1,0]
    v_pk_mul_f32 v[210:211], v[210:211], v[58:59] op_sel:[0,0] op_sel_hi:[1,0]
    v_cvt_pk_bf16_f32 v192, v208, v209
    v_cvt_pk_bf16_f32 v193, v210, v211
    v_mfma_f32_16x16x32_bf16 a[100:103], a[180:183], v[172:175], a[100:103]
    buffer_load_dwordx4 v47, s[20:23], s49 offen offset:1024 lds
    v_accvgpr_read_b32 v212, a68
    v_accvgpr_read_b32 v213, a69
    v_accvgpr_read_b32 v214, a70
    v_accvgpr_read_b32 v215, a71
    v_pk_mul_f32 v[212:213], v[212:213], v[58:59] op_sel:[0,1] op_sel_hi:[1,1]
    v_pk_mul_f32 v[214:215], v[214:215], v[58:59] op_sel:[0,1] op_sel_hi:[1,1]
    v_cvt_pk_bf16_f32 v196, v212, v213
    v_cvt_pk_bf16_f32 v197, v214, v215
    v_mfma_f32_16x16x32_bf16 a[104:107], a[176:179], v[176:179], a[104:107]
    v_mfma_f32_16x16x32_bf16 a[104:107], a[180:183], v[180:183], a[104:107]
    buffer_load_dwordx4 v48, s[20:23], s49 offen offset:2048 lds
    v_mfma_f32_16x16x32_bf16 a[108:111], a[176:179], v[184:187], a[108:111]
    v_accvgpr_read_b32 v208, a72
    v_accvgpr_read_b32 v209, a73
    v_accvgpr_read_b32 v210, a74
    v_accvgpr_read_b32 v211, a75
    v_pk_mul_f32 v[208:209], v[208:209], v[60:61] op_sel:[0,0] op_sel_hi:[1,0]
    v_pk_mul_f32 v[210:211], v[210:211], v[60:61] op_sel:[0,0] op_sel_hi:[1,0]
    v_cvt_pk_bf16_f32 v200, v208, v209
    v_cvt_pk_bf16_f32 v201, v210, v211
    v_mfma_f32_16x16x32_bf16 a[108:111], a[180:183], v[188:191], a[108:111]
    s_waitcnt lgkmcnt(3)
    buffer_load_dwordx4 v49, s[20:23], s49 offen offset:3072 lds
    v_accvgpr_read_b32 v212, a76
    v_accvgpr_read_b32 v213, a77
    v_accvgpr_read_b32 v214, a78
    v_accvgpr_read_b32 v215, a79
    v_pk_mul_f32 v[212:213], v[212:213], v[60:61] op_sel:[0,1] op_sel_hi:[1,1]
    v_pk_mul_f32 v[214:215], v[214:215], v[60:61] op_sel:[0,1] op_sel_hi:[1,1]
    v_cvt_pk_bf16_f32 v204, v212, v213
    v_cvt_pk_bf16_f32 v205, v214, v215
    s_add_u32 s49, s46, 0
    v_mfma_f32_16x16x32_bf16 a[112:115], a[184:187], v[160:163], a[112:115]
    s_waitcnt lgkmcnt(0)
    s_add_u32 m0, s42, 98304
    v_mfma_f32_16x16x32_bf16 a[112:115], a[188:191], v[164:167], a[112:115]
    buffer_load_dwordx4 v46, s[20:23], s49 offen lds
    v_mfma_f32_16x16x32_bf16 a[116:119], a[184:187], v[168:171], a[116:119]
    v_accvgpr_read_b32 v208, a80
    v_accvgpr_read_b32 v209, a81
    v_accvgpr_read_b32 v210, a82
    v_accvgpr_read_b32 v211, a83
    v_pk_mul_f32 v[208:209], v[208:209], v[58:59] op_sel:[0,0] op_sel_hi:[1,0]
    v_pk_mul_f32 v[210:211], v[210:211], v[58:59] op_sel:[0,0] op_sel_hi:[1,0]
    v_cvt_pk_bf16_f32 v194, v208, v209
    v_cvt_pk_bf16_f32 v195, v210, v211
    s_add_u32 s37, s55, 0
    buffer_store_dwordx4 v[192:195], v252, s[28:31], s37 offen offset:2048
    v_mfma_f32_16x16x32_bf16 a[116:119], a[188:191], v[172:175], a[116:119]
    buffer_load_dwordx4 v47, s[20:23], s49 offen offset:1024 lds
    v_accvgpr_read_b32 v212, a84
    v_accvgpr_read_b32 v213, a85
    v_accvgpr_read_b32 v214, a86
    v_accvgpr_read_b32 v215, a87
    v_pk_mul_f32 v[212:213], v[212:213], v[58:59] op_sel:[0,1] op_sel_hi:[1,1]
    v_pk_mul_f32 v[214:215], v[214:215], v[58:59] op_sel:[0,1] op_sel_hi:[1,1]
    v_cvt_pk_bf16_f32 v198, v212, v213
    v_cvt_pk_bf16_f32 v199, v214, v215
    s_add_u32 s37, s55, 8192
    buffer_store_dwordx4 v[196:199], v252, s[28:31], s37 offen offset:2048
    v_mfma_f32_16x16x32_bf16 a[120:123], a[184:187], v[176:179], a[120:123]
    v_mfma_f32_16x16x32_bf16 a[120:123], a[188:191], v[180:183], a[120:123]
    buffer_load_dwordx4 v48, s[20:23], s49 offen offset:2048 lds
    v_mfma_f32_16x16x32_bf16 a[124:127], a[184:187], v[184:187], a[124:127]
    v_accvgpr_read_b32 v208, a88
    v_accvgpr_read_b32 v209, a89
    v_accvgpr_read_b32 v210, a90
    v_accvgpr_read_b32 v211, a91
    v_pk_mul_f32 v[208:209], v[208:209], v[60:61] op_sel:[0,0] op_sel_hi:[1,0]
    v_pk_mul_f32 v[210:211], v[210:211], v[60:61] op_sel:[0,0] op_sel_hi:[1,0]
    v_cvt_pk_bf16_f32 v202, v208, v209
    v_cvt_pk_bf16_f32 v203, v210, v211
    s_add_u32 s37, s55, 4096
    buffer_store_dwordx4 v[200:203], v252, s[28:31], s37 offen offset:2048
    v_mfma_f32_16x16x32_bf16 a[124:127], a[188:191], v[188:191], a[124:127]
    buffer_load_dwordx4 v49, s[20:23], s49 offen offset:3072 lds
    v_accvgpr_read_b32 v212, a92
    v_accvgpr_read_b32 v213, a93
    v_accvgpr_read_b32 v214, a94
    v_accvgpr_read_b32 v215, a95
    v_pk_mul_f32 v[212:213], v[212:213], v[60:61] op_sel:[0,1] op_sel_hi:[1,1]
    v_pk_mul_f32 v[214:215], v[214:215], v[60:61] op_sel:[0,1] op_sel_hi:[1,1]
    v_cvt_pk_bf16_f32 v206, v212, v213
    v_cvt_pk_bf16_f32 v207, v214, v215
    s_add_u32 s37, s55, 12288
    buffer_store_dwordx4 v[204:207], v252, s[28:31], s37 offen offset:2048
    v_or3_b32 v224, v224, v225, v226
    v_or_b32 v224, v224, v227
    s_nop 0
    v_readfirstlane_b32 s36, v224
    v_readfirstlane_b32 s38, v253
    v_min_u32 v8, 1, v1
    v_lshlrev_b32 v8, 31, v8
    v_mov_b32 v10, s95
    s_getreg_b32 s39, hwreg(HW_REG_XCC_ID, 0, 4)
    s_add_u32 s39, s39, s95
    s_cmp_eq_u32 s38, s39
    s_cselect_b32 s53, 1, 0
    ds_read_b64_tr_b16 a[208:209], v12 offset:0
    ds_read_b64_tr_b16 a[210:211], v12 offset:4096
    ds_read_b64_tr_b16 a[212:213], v12 offset:8192
    ds_read_b64_tr_b16 a[214:215], v12 offset:12288
    ds_read_b64_tr_b16 a[216:217], v12 offset:16384
    ds_read_b64_tr_b16 a[218:219], v12 offset:20480
    ds_read_b64_tr_b16 a[220:221], v12 offset:24576
    ds_read_b64_tr_b16 a[222:223], v12 offset:28672
    ds_read_b64_tr_b16 a[224:225], v16 offset:0
    ds_read_b64_tr_b16 a[226:227], v16 offset:4096
    ds_read_b64_tr_b16 a[228:229], v16 offset:8192
    ds_read_b64_tr_b16 a[230:231], v16 offset:12288
    ds_read_b64_tr_b16 a[232:233], v16 offset:16384
    ds_read_b64_tr_b16 a[234:235], v16 offset:20480
    ds_read_b64_tr_b16 a[236:237], v16 offset:24576
    ds_read_b64_tr_b16 a[238:239], v16 offset:28672
    s_andn2_b32 s36, s36, s48
    s_cbranch_scc1 Lattn_redo
    v_accvgpr_read_b32 v208, a96
    v_accvgpr_read_b32 v209, a97
Ltour8:
    s_cbranch_execz Ltour12
    v_accvgpr_read_b32 v210, a98
    v_accvgpr_read_b32 v211, a99
    v_pk_mul_f32 v[208:209], v[208:209], v[58:59] op_sel:[0,0] op_sel_hi:[1,0]
    v_pk_mul_f32 v[210:211], v[210:211], v[58:59] op_sel:[0,0] op_sel_hi:[1,0]
    v_cvt_pk_bf16_f32 v176, v208, v209
    v_cvt_pk_bf16_f32 v177, v210, v211
    v_accvgpr_read_b32 v212, a100
    v_accvgpr_read_b32 v213, a101
    v_accvgpr_read_b32 v214, a102
    v_accvgpr_read_b32 v215, a103
    v_pk_mul_f32 v[212:213], v[212:213], v[58:59] op_sel:[0,1] op_sel_hi:[1,1]
    v_pk_mul_f32 v[214:215], v[214:215], v[58:59] op_sel:[0,1] op_sel_hi:[1,1]
    v_cvt_pk_bf16_f32 v180, v212, v213
    v_cvt_pk_bf16_f32 v181, v214, v215
    v_accvgpr_read_b32 v208, a104
    v_accvgpr_read_b32 v209, a105
    v_accvgpr_read_b32 v210, a106
    v_accvgpr_read_b32 v211, a107
    v_pk_mul_f32 v[208:209], v[208:209], v[60:61] op_sel:[0,0] op_sel_hi:[1,0]
    v_pk_mul_f32 v[210:211], v[210:211], v[60:61] op_sel:[0,0] op_sel_hi:[1,0]
    v_cvt_pk_bf16_f32 v184, v208, v209
    v_cvt_pk_bf16_f32 v185, v210, v211
    v_accvgpr_read_b32 v212, a108
    v_accvgpr_read_b32 v213, a109
    v_accvgpr_read_b32 v214, a110
    v_accvgpr_read_b32 v215, a111
    v_pk_mul_f32 v[212:213], v[212:213], v[60:61] op_sel:[0,1] op_sel_hi:[1,1]
    v_pk_mul_f32 v[214:215], v[214:215], v[60:61] op_sel:[0,1] op_sel_hi:[1,1]
    v_cvt_pk_bf16_f32 v188, v212, v213
    v_cvt_pk_bf16_f32 v189, v214, v215
    v_accvgpr_read_b32 v208, a112
    v_accvgpr_read_b32 v209, a113
    v_accvgpr_read_b32 v210, a114
    v_accvgpr_read_b32 v211, a115
    v_pk_mul_f32 v[208:209], v[208:209], v[58:59] op_sel:[0,0] op_sel_hi:[1,0]
    v_pk_mul_f32 v[210:211], v[210:211], v[58:59] op_sel:[0,0] op_sel_hi:[1,0]
    v_cvt_pk_bf16_f32 v178, v208, v209
    v_cvt_pk_bf16_f32 v179, v210, v211
    s_add_u32 s37, s55, 0
    buffer_store_dwordx4 v[176:179], v252, s[28:31], s37 offen offset:3072
    v_accvgpr_read_b32 v212, a116
    v_accvgpr_read_b32 v213, a117
    v_accvgpr_read_b32 v214, a118
    v_accvgpr_read_b32 v215, a119
    v_pk_mul_f32 v[212:213], v[212:213], v[58:59] op_sel:[0,1] op_sel_hi:[1,1]
    v_pk_mul_f32 v[214:215], v[214:215], v[58:59] op_sel:[0,1] op_sel_hi:[1,1]
    v_cvt_pk_bf16_f32 v182, v212, v213
    v_cvt_pk_bf16_f32 v183, v214, v215
    s_add_u32 s37, s55, 8192
    buffer_store_dwordx4 v[180:183], v252, s[28:31], s37 offen offset:3072
    v_accvgpr_read_b32 v208, a120
    v_accvgpr_read_b32 v209, a121
    v_accvgpr_read_b32 v210, a122
    v_accvgpr_read_b32 v211, a123
    v_pk_mul_f32 v[208:209], v[208:209], v[60:61] op_sel:[0,0] op_sel_hi:[1,0]
    v_pk_mul_f32 v[210:211], v[210:211], v[60:61] op_sel:[0,0] op_sel_hi:[1,0]
    v_cvt_pk_bf16_f32 v186, v208, v209
    v_cvt_pk_bf16_f32 v187, v210, v211
    s_add_u32 s37, s55, 4096
    buffer_store_dwordx4 v[184:187], v252, s[28:31], s37 offen offset:3072
    v_accvgpr_read_b32 v212, a124
    v_accvgpr_read_b32 v213, a125
    v_accvgpr_read_b32 v214, a126
    v_accvgpr_read_b32 v215, a127
    v_pk_mul_f32 v[212:213], v[212:213], v[60:61] op_sel:[0,1] op_sel_hi:[1,1]
    v_pk_mul_f32 v[214:215], v[214:215], v[60:61] op_sel:[0,1] op_sel_hi:[1,1]
    v_cvt_pk_bf16_f32 v190, v212, v213
    v_cvt_pk_bf16_f32 v191, v214, v215
    s_add_u32 s37, s55, 12288
    buffer_store_dwordx4 v[188:191], v252, s[28:31], s37 offen offset:3072
    s_waitcnt lgkmcnt(14)
    v_mfma_f32_16x16x32_bf16 v[96:99], a[208:211], v[128:131], 0
    s_waitcnt lgkmcnt(12)
    ds_read_b64_tr_b16 a[160:161], v13 offset:0
    v_mfma_f32_16x16x32_bf16 v[96:99], a[212:215], v[144:147], v[96:99]
    s_waitcnt lgkmcnt(11)
    ds_read_b64_tr_b16 a[162:163], v13 offset:4096
    v_mfma_f32_16x16x32_bf16 v[96:99], a[216:219], v[192:195], v[96:99]
    s_waitcnt lgkmcnt(10)
    ds_read_b64_tr_b16 a[164:165], v13 offset:8192
    v_mfma_f32_16x16x32_bf16 v[96:99], a[220:223], v[176:179], v[96:99]
    s_waitcnt lgkmcnt(9)
    ds_read_b64_tr_b16 a[166:167], v13 offset:12288
    v_mfma_f32_16x16x32_bf16 v[96:99], a[224:227], v[136:139], v[96:99]
    s_waitcnt lgkmcnt(8)
    ds_read_b64_tr_b16 a[168:169], v13 offset:16384
    v_mfma_f32_16x16x32_bf16 v[96:99], a[228:231], v[152:155], v[96:99]
    s_waitcnt lgkmcnt(7)
    ds_read_b64_tr_b16 a[170:171], v13 offset:20480
    v_mfma_f32_16x16x32_bf16 v[96:99], a[232:235], v[200:203], v[96:99]
    s_waitcnt lgkmcnt(6)
    ds_read_b64_tr_b16 a[172:173], v13 offset:24576
    v_mfma_f32_16x16x32_bf16 v[96:99], a[236:239], v[184:187], v[96:99]
    ds_read_b64_tr_b16 a[174:175], v13 offset:28672
    v_mfma_f32_16x16x32_bf16 v[100:103], a[208:211], v[132:135], 0
    ds_read_b64_tr_b16 a[176:177], v17 offset:0
    v_mfma_f32_16x16x32_bf16 v[100:103], a[212:215], v[148:151], v[100:103]
    ds_read_b64_tr_b16 a[178:179], v17 offset:4096
    v_mfma_f32_16x16x32_bf16 v[100:103], a[216:219], v[196:199], v[100:103]
    ds_read_b64_tr_b16 a[180:181], v17 offset:8192
    v_mfma_f32_16x16x32_bf16 v[100:103], a[220:223], v[180:183], v[100:103]
    ds_read_b64_tr_b16 a[182:183], v17 offset:12288
    v_mfma_f32_16x16x32_bf16 v[100:103], a[224:227], v[140:143], v[100:103]
    ds_read_b64_tr_b16 a[184:185], v17 offset:16384
    v_cvt_pk_bf16_f32 v224, v96, v97
    v_mfma_f32_16x16x32_bf16 v[100:103], a[228:231], v[156:159], v[100:103]
    ds_read_b64_tr_b16 a[186:187], v17 offset:20480
    v_cvt_pk_bf16_f32 v225, v98, v99
    v_mfma_f32_16x16x32_bf16 v[100:103], a[232:235], v[204:207], v[100:103]
    ds_read_b64_tr_b16 a[188:189], v17 offset:24576
    v_mfma_f32_16x16x32_bf16 v[100:103], a[236:239], v[188:191], v[100:103]
    s_waitcnt lgkmcnt(13)
    ds_read_b64_tr_b16 a[190:191], v17 offset:28672
    v_mfma_f32_16x16x32_bf16 v[104:107], a[160:163], v[128:131], 0
    s_waitcnt lgkmcnt(12)
    ds_read_b64_tr_b16 a[208:209], v14 offset:0
    v_mfma_f32_16x16x32_bf16 v[104:107], a[164:167], v[144:147], v[104:107]
    s_waitcnt lgkmcnt(11)
    ds_read_b64_tr_b16 a[210:211], v14 offset:4096
    v_mfma_f32_16x16x32_bf16 v[104:107], a[168:171], v[192:195], v[104:107]
    s_waitcnt lgkmcnt(10)
    ds_read_b64_tr_b16 a[212:213], v14 offset:8192
    v_mfma_f32_16x16x32_bf16 v[104:107], a[172:175], v[176:179], v[104:107]
    s_waitcnt lgkmcnt(9)
    ds_read_b64_tr_b16 a[214:215], v14 offset:12288
    v_mfma_f32_16x16x32_bf16 v[104:107], a[176:179], v[136:139], v[104:107]
    s_waitcnt lgkmcnt(8)
    ds_read_b64_tr_b16 a[216:217], v14 offset:16384
    v_cvt_pk_bf16_f32 v228, v100, v101
    v_mfma_f32_16x16x32_bf16 v[104:107], a[180:183], v[152:155], v[104:107]
    s_waitcnt lgkmcnt(7)
    ds_read_b64_tr_b16 a[218:219], v14 offset:20480
    v_cvt_pk_bf16_f32 v229, v102, v103
    v_mfma_f32_16x16x32_bf16 v[104:107], a[184:187], v[200:203], v[104:107]
    s_waitcnt lgkmcnt(6)
    ds_read_b64_tr_b16 a[220:221], v14 offset:24576
    v_mfma_f32_16x16x32_bf16 v[104:107], a[188:191], v[184:187], v[104:107]
    ds_read_b64_tr_b16 a[222:223], v14 offset:28672
    s_waitcnt vmcnt(0)
    s_cmp_eq_u32 s53, 0
    s_cbranch_scc1 Lattn_wb
Lattn_wbdone:
    v_mfma_f32_16x16x32_bf16 v[108:111], a[160:163], v[132:135], 0
    buffer_store_dword v10, v8, s[24:27], s92 offen offset:8 sc1
    v_mfma_f32_16x16x32_bf16 v[108:111], a[164:167], v[148:151], v[108:111]
    s_xor_b32 s55, s55, 65536
    ds_read_b64_tr_b16 a[224:225], v18 offset:0
    ds_read_b64_tr_b16 a[226:227], v18 offset:4096
    v_mfma_f32_16x16x32_bf16 v[108:111], a[168:171], v[196:199], v[108:111]
    buffer_atomic_add v241, v240, s[88:91], 0 offen sc1
    v_mfma_f32_16x16x32_bf16 v[108:111], a[172:175], v[180:183], v[108:111]
    ds_read_b64_tr_b16 a[228:229], v18 offset:8192
    ds_read_b64_tr_b16 a[230:231], v18 offset:12288
    s_load_dwordx2 s[12:13], s[0:1], 0
    v_mfma_f32_16x16x32_bf16 v[108:111], a[176:179], v[140:143], v[108:111]
    ds_read_b64_tr_b16 a[232:233], v18 offset:16384
    v_cvt_pk_bf16_f32 v226, v104, v105
    v_mfma_f32_16x16x32_bf16 v[108:111], a[180:183], v[156:159], v[108:111]
    s_add_u32 s38, s56, 16384
    ds_read_b64_tr_b16 a[234:235], v18 offset:20480
    v_cvt_pk_bf16_f32 v227, v106, v107
    s_load_dwordx2 s[16:17], s[0:1], 96
    v_mfma_f32_16x16x32_bf16 v[108:111], a[184:187], v[204:207], v[108:111]
    buffer_store_dwordx4 v[224:227], v56, s[28:31], s38 offen sc1
    v_mfma_f32_16x16x32_bf16 v[108:111], a[188:191], v[188:191], v[108:111]
    s_waitcnt lgkmcnt(12)
    ds_read_b64_tr_b16 a[236:237], v18 offset:24576
    ds_read_b64_tr_b16 a[238:239], v18 offset:28672
    s_load_dwordx2 s[52:53], s[0:1], 48
    v_mfma_f32_16x16x32_bf16 v[112:115], a[208:211], v[128:131], 0
    s_waitcnt lgkmcnt(12)
    ds_read_b64_tr_b16 a[160:161], v15 offset:0
    v_mfma_f32_16x16x32_bf16 v[112:115], a[212:215], v[144:147], v[112:115]
    s_waitcnt lgkmcnt(11)
    ds_read_b64_tr_b16 a[162:163], v15 offset:4096
    v_mfma_f32_16x16x32_bf16 v[112:115], a[216:219], v[192:195], v[112:115]
    s_waitcnt lgkmcnt(10)
    ds_read_b64_tr_b16 a[164:165], v15 offset:8192
    v_mfma_f32_16x16x32_bf16 v[112:115], a[220:223], v[176:179], v[112:115]
    s_waitcnt lgkmcnt(9)
    ds_read_b64_tr_b16 a[166:167], v15 offset:12288
    v_mfma_f32_16x16x32_bf16 v[112:115], a[224:227], v[136:139], v[112:115]
    s_waitcnt lgkmcnt(8)
    ds_read_b64_tr_b16 a[168:169], v15 offset:16384
    v_cvt_pk_bf16_f32 v230, v108, v109
    v_mfma_f32_16x16x32_bf16 v[112:115], a[228:231], v[152:155], v[112:115]
    s_waitcnt lgkmcnt(7)
    s_add_u32 s38, s56, 180224
    ds_read_b64_tr_b16 a[170:171], v15 offset:20480
    v_cvt_pk_bf16_f32 v231, v110, v111
    v_mfma_f32_16x16x32_bf16 v[112:115], a[232:235], v[200:203], v[112:115]
    s_waitcnt lgkmcnt(6)
    buffer_store_dwordx4 v[228:231], v56, s[28:31], s38 offen sc1
    v_mfma_f32_16x16x32_bf16 v[112:115], a[236:239], v[184:187], v[112:115]
    ds_read_b64_tr_b16 a[172:173], v15 offset:24576
    ds_read_b64_tr_b16 a[174:175], v15 offset:28672
    v_mfma_f32_16x16x32_bf16 v[116:119], a[208:211], v[132:135], 0
    ds_read_b64_tr_b16 a[176:177], v19 offset:0
    v_mfma_f32_16x16x32_bf16 v[116:119], a[212:215], v[148:151], v[116:119]
    ds_read_b64_tr_b16 a[178:179], v19 offset:4096
    v_mfma_f32_16x16x32_bf16 v[116:119], a[216:219], v[196:199], v[116:119]
    ds_read_b64_tr_b16 a[180:181], v19 offset:8192
    v_mfma_f32_16x16x32_bf16 v[116:119], a[220:223], v[180:183], v[116:119]
    ds_read_b64_tr_b16 a[182:183], v19 offset:12288
    v_mfma_f32_16x16x32_bf16 v[116:119], a[224:227], v[140:143], v[116:119]
    ds_read_b64_tr_b16 a[184:185], v19 offset:16384
    v_cvt_pk_bf16_f32 v232, v112, v113
    v_mfma_f32_16x16x32_bf16 v[116:119], a[228:231], v[156:159], v[116:119]
    ds_read_b64_tr_b16 a[186:187], v19 offset:20480
    v_cvt_pk_bf16_f32 v233, v114, v115
    v_mfma_f32_16x16x32_bf16 v[116:119], a[232:235], v[204:207], v[116:119]
    ds_read_b64_tr_b16 a[188:189], v19 offset:24576
    v_mfma_f32_16x16x32_bf16 v[116:119], a[236:239], v[188:191], v[116:119]
    s_waitcnt lgkmcnt(13)
    ds_read_b64_tr_b16 a[190:191], v19 offset:28672
    s_barrier
    v_mfma_f32_16x16x32_bf16 v[120:123], a[160:163], v[128:131], 0
    s_waitcnt lgkmcnt(12)
    buffer_load_dword v11, v8, s[24:27], s54 offen offset:8 sc1
    v_mfma_f32_16x16x32_bf16 v[120:123], a[164:167], v[144:147], v[120:123]
    s_waitcnt lgkmcnt(10)
    ds_read_b64_tr_b16 a[208:209], v20 offset:0
    ds_read_b64_tr_b16 a[210:211], v20 offset:4096
    v_mfma_f32_16x16x32_bf16 v[120:123], a[168:171], v[192:195], v[120:123]
    s_waitcnt lgkmcnt(10)
    ds_read_b64_tr_b16 a[212:213], v20 offset:8192
    v_mfma_f32_16x16x32_bf16 v[120:123], a[172:175], v[176:179], v[120:123]
    s_waitcnt lgkmcnt(9)
    ds_read_b64_tr_b16 a[214:215], v20 offset:12288
    v_mfma_f32_16x16x32_bf16 v[120:123], a[176:179], v[136:139], v[120:123]
    s_waitcnt lgkmcnt(8)
    ds_read_b64_tr_b16 a[216:217], v20 offset:16384
    v_cvt_pk_bf16_f32 v236, v116, v117
    v_mfma_f32_16x16x32_bf16 v[120:123], a[180:183], v[152:155], v[120:123]
    s_waitcnt lgkmcnt(7)
    ds_read_b64_tr_b16 a[218:219], v20 offset:20480
    v_cvt_pk_bf16_f32 v237, v118, v119
    v_mfma_f32_16x16x32_bf16 v[120:123], a[184:187], v[200:203], v[120:123]
    s_waitcnt lgkmcnt(6)
    s_add_u32 s49, s46, 73728
    ds_read_b64_tr_b16 a[220:221], v20 offset:24576
    v_mfma_f32_16x16x32_bf16 v[120:123], a[188:191], v[184:187], v[120:123]
    s_add_u32 m0, s42, 114688
    ds_read_b64_tr_b16 a[222:223], v20 offset:28672
    v_mfma_f32_16x16x32_bf16 v[124:127], a[160:163], v[132:135], 0
    buffer_load_dwordx4 v46, s[20:23], s49 offen lds
    v_mfma_f32_16x16x32_bf16 v[124:127], a[164:167], v[148:151], v[124:127]
    ds_read_b64_tr_b16 a[224:225], v24 offset:0
    ds_read_b64_tr_b16 a[226:227], v24 offset:4096
    v_mfma_f32_16x16x32_bf16 v[124:127], a[168:171], v[196:199], v[124:127]
    buffer_load_dwordx4 v47, s[20:23], s49 offen offset:1024 lds
    v_mfma_f32_16x16x32_bf16 v[124:127], a[172:175], v[180:183], v[124:127]
    ds_read_b64_tr_b16 a[228:229], v24 offset:8192
    ds_read_b64_tr_b16 a[230:231], v24 offset:12288
    v_mfma_f32_16x16x32_bf16 v[124:127], a[176:179], v[140:143], v[124:127]
    ds_read_b64_tr_b16 a[232:233], v24 offset:16384
    v_cvt_pk_bf16_f32 v234, v120, v121
    v_mfma_f32_16x16x32_bf16 v[124:127], a[180:183], v[156:159], v[124:127]
    s_add_u32 s38, s56, 16512
    ds_read_b64_tr_b16 a[234:235], v24 offset:20480
    v_cvt_pk_bf16_f32 v235, v122, v123
    v_mfma_f32_16x16x32_bf16 v[124:127], a[184:187], v[204:207], v[124:127]
    buffer_store_dwordx4 v[232:235], v56, s[28:31], s38 offen sc1
    v_mfma_f32_16x16x32_bf16 v[124:127], a[188:191], v[188:191], v[124:127]
    s_waitcnt lgkmcnt(12)
    ds_read_b64_tr_b16 a[236:237], v24 offset:24576
    ds_read_b64_tr_b16 a[238:239], v24 offset:28672
    v_mfma_f32_16x16x32_bf16 v[64:67], a[208:211], v[128:131], 0
    s_waitcnt lgkmcnt(12)
    buffer_load_dwordx4 v48, s[20:23], s49 offen offset:2048 lds
    v_mfma_f32_16x16x32_bf16 v[64:67], a[212:215], v[144:147], v[64:67]
    s_waitcnt lgkmcnt(10)
    ds_read_b64_tr_b16 a[160:161], v21 offset:0
    ds_read_b64_tr_b16 a[162:163], v21 offset:4096
    v_mfma_f32_16x16x32_bf16 v[64:67], a[216:219], v[192:195], v[64:67]
    s_waitcnt lgkmcnt(10)
    buffer_load_dwordx4 v49, s[20:23], s49 offen offset:3072 lds
    v_mfma_f32_16x16x32_bf16 v[64:67], a[220:223], v[176:179], v[64:67]
    s_waitcnt lgkmcnt(8)
    ds_read_b64_tr_b16 a[164:165], v21 offset:8192
    ds_read_b64_tr_b16 a[166:167], v21 offset:12288
    v_mfma_f32_16x16x32_bf16 v[64:67], a[224:227], v[136:139], v[64:67]
    s_waitcnt lgkmcnt(8)
    ds_read_b64_tr_b16 a[168:169], v21 offset:16384
    v_cvt_pk_bf16_f32 v238, v124, v125
    v_mfma_f32_16x16x32_bf16 v[64:67], a[228:231], v[152:155], v[64:67]
    s_waitcnt lgkmcnt(7)
    s_add_u32 s38, s56, 180352
    ds_read_b64_tr_b16 a[170:171], v21 offset:20480
    v_cvt_pk_bf16_f32 v239, v126, v127
    v_mfma_f32_16x16x32_bf16 v[64:67], a[232:235], v[200:203], v[64:67]
    s_waitcnt lgkmcnt(6)
    buffer_store_dwordx4 v[236:239], v56, s[28:31], s38 offen sc1
    v_mfma_f32_16x16x32_bf16 v[64:67], a[236:239], v[184:187], v[64:67]
    ds_read_b64_tr_b16 a[172:173], v21 offset:24576
    ds_read_b64_tr_b16 a[174:175], v21 offset:28672
    v_mfma_f32_16x16x32_bf16 v[68:71], a[208:211], v[132:135], 0
    s_lshl_b32 s40, s5, 4
    ds_read_b64_tr_b16 a[176:177], v25 offset:0
    v_mfma_f32_16x16x32_bf16 v[68:71], a[212:215], v[148:151], v[68:71]
    s_add_u32 s40, s40, s4
    ds_read_b64_tr_b16 a[178:179], v25 offset:4096
    v_and_b32 v240, 31, v1
    v_mfma_f32_16x16x32_bf16 v[68:71], a[216:219], v[196:199], v[68:71]
    ds_read_b64_tr_b16 a[180:181], v25 offset:8192
    v_lshrrev_b32 v241, 5, v1
    v_mfma_f32_16x16x32_bf16 v[68:71], a[220:223], v[180:183], v[68:71]
    ds_read_b64_tr_b16 a[182:183], v25 offset:12288
    v_cmp_gt_u32 vcc, 8, v240
    v_mfma_f32_16x16x32_bf16 v[68:71], a[224:227], v[140:143], v[68:71]
    ds_read_b64_tr_b16 a[184:185], v25 offset:16384
    v_mov_b32 v242, 2147483648
    v_mfma_f32_16x16x32_bf16 v[68:71], a[228:231], v[156:159], v[68:71]
    s_lshl_b32 s43, s40, 3
    ds_read_b64_tr_b16 a[186:187], v25 offset:20480
    v_mfma_f32_16x16x32_bf16 v[68:71], a[232:235], v[204:207], v[68:71]
    s_lshl_b32 s44, s3, 1
    ds_read_b64_tr_b16 a[188:189], v25 offset:24576
    v_mfma_f32_16x16x32_bf16 v[68:71], a[236:239], v[188:191], v[68:71]
    s_waitcnt lgkmcnt(13)
    s_add_u32 s43, s43, s44
    ds_read_b64_tr_b16 a[190:191], v25 offset:28672
    v_cndmask_b32 v242, v242, 0, vcc
    v_mfma_f32_16x16x32_bf16 v[72:75], a[160:163], v[128:131], 0
    s_waitcnt lgkmcnt(12)
    ds_read_b64_tr_b16 a[208:209], v22 offset:0
    v_add_u32 v7, s43, v241
    v_mfma_f32_16x16x32_bf16 v[72:75], a[164:167], v[144:147], v[72:75]
    s_waitcnt lgkmcnt(11)
    ds_read_b64_tr_b16 a[210:211], v22 offset:4096
    v_lshlrev_b32 v5, 4, v240
    v_mfma_f32_16x16x32_bf16 v[72:75], a[168:171], v[192:195], v[72:75]
    s_waitcnt lgkmcnt(10)
    ds_read_b64_tr_b16 a[212:213], v22 offset:8192
    v_lshlrev_b32 v243, 4, v241
    v_mfma_f32_16x16x32_bf16 v[72:75], a[172:175], v[176:179], v[72:75]
    s_waitcnt lgkmcnt(9)
    ds_read_b64_tr_b16 a[214:215], v22 offset:12288
    v_lshl_add_u32 v2, v240, 5, v243
    v_mfma_f32_16x16x32_bf16 v[72:75], a[176:179], v[136:139], v[72:75]
    s_waitcnt lgkmcnt(8)
    ds_read_b64_tr_b16 a[216:217], v22 offset:16384
    v_lshrrev_b32 v243, 4, v240
    v_mfma_f32_16x16x32_bf16 v[72:75], a[180:183], v[152:155], v[72:75]
    s_waitcnt lgkmcnt(7)
    ds_read_b64_tr_b16 a[218:219], v22 offset:20480
    v_mul_u32_u24 v243, 1536, v243
    v_mfma_f32_16x16x32_bf16 v[72:75], a[184:187], v[200:203], v[72:75]
    s_waitcnt lgkmcnt(6)
    ds_read_b64_tr_b16 a[220:221], v22 offset:24576
    v_add_u32 v2, v2, v243
    v_mfma_f32_16x16x32_bf16 v[72:75], a[188:191], v[184:187], v[72:75]
    s_mul_i32 s44, s43, 10240
    ds_read_b64_tr_b16 a[222:223], v22 offset:28672
    v_lshrrev_b32 v243, 2, v240
    v_mfma_f32_16x16x32_bf16 v[76:79], a[160:163], v[132:135], 0
    ds_read_b64_tr_b16 a[224:225], v26 offset:0
    v_lshlrev_b32 v243, 6, v243
    v_mfma_f32_16x16x32_bf16 v[76:79], a[164:167], v[148:151], v[76:79]
    ds_read_b64_tr_b16 a[226:227], v26 offset:4096
    v_and_b32 v241, 3, v240
    v_mfma_f32_16x16x32_bf16 v[76:79], a[168:171], v[196:199], v[76:79]
    ds_read_b64_tr_b16 a[228:229], v26 offset:8192
    v_lshl_add_u32 v3, v241, 3, v243
    v_mfma_f32_16x16x32_bf16 v[76:79], a[172:175], v[180:183], v[76:79]
    ds_read_b64_tr_b16 a[230:231], v26 offset:12288
    v_mul_u32_u24 v243, 1152, v7
    v_mfma_f32_16x16x32_bf16 v[76:79], a[176:179], v[140:143], v[76:79]
    ds_read_b64_tr_b16 a[232:233], v26 offset:16384
    v_add_u32 v4, v243, v3
    v_mfma_f32_16x16x32_bf16 v[76:79], a[180:183], v[156:159], v[76:79]
    ds_read_b64_tr_b16 a[234:235], v26 offset:20480
    v_lshl_add_u32 v6, v243, 1, v5
    v_mfma_f32_16x16x32_bf16 v[76:79], a[184:187], v[204:207], v[76:79]
    ds_read_b64_tr_b16 a[236:237], v26 offset:24576
    v_or_b32 v55, v3, v242
    v_mfma_f32_16x16x32_bf16 v[76:79], a[188:191], v[188:191], v[76:79]
    s_waitcnt lgkmcnt(13)
    ds_read_b64_tr_b16 a[238:239], v26 offset:28672
    v_or_b32 v58, v4, v242
    v_mfma_f32_16x16x32_bf16 v[80:83], a[208:211], v[128:131], 0
    s_waitcnt lgkmcnt(12)
    ds_read_b64_tr_b16 a[160:161], v23 offset:0
    v_or_b32 v59, v5, v242
    v_mfma_f32_16x16x32_bf16 v[80:83], a[212:215], v[144:147], v[80:83]
    s_waitcnt lgkmcnt(11)
    ds_read_b64_tr_b16 a[162:163], v23 offset:4096
    v_or_b32 v60, v6, v242
    v_mfma_f32_16x16x32_bf16 v[80:83], a[216:219], v[192:195], v[80:83]
    s_waitcnt lgkmcnt(10)
    ds_read_b64_tr_b16 a[164:165], v23 offset:8192
    s_waitcnt vmcnt(6)
    v_readfirstlane_b32 s36, v11
    v_mfma_f32_16x16x32_bf16 v[80:83], a[220:223], v[176:179], v[80:83]
    s_waitcnt lgkmcnt(9)
    ds_read_b64_tr_b16 a[166:167], v23 offset:12288
    v_lshrrev_b32 v243, 4, v1
    v_mfma_f32_16x16x32_bf16 v[80:83], a[224:227], v[136:139], v[80:83]
    ds_read_b64_tr_b16 a[168:169], v23 offset:16384
    v_lshlrev_b32 v243, 8, v243
    s_cmp_lg_u32 s36, s95
    s_cbranch_scc1 Lattn_xspin
Lattn_xgot:
    s_waitcnt lgkmcnt(9)
    v_mfma_f32_16x16x32_bf16 v[80:83], a[228:231], v[152:155], v[80:83]
    s_waitcnt lgkmcnt(7)
    ds_read_b64_tr_b16 a[170:171], v23 offset:20480
    v_and_b32 v241, 7, v1
    v_mfma_f32_16x16x32_bf16 v[80:83], a[232:235], v[200:203], v[80:83]
    s_waitcnt lgkmcnt(6)
    ds_read_b64_tr_b16 a[172:173], v23 offset:24576
    v_lshl_add_u32 v243, v241, 5, v243
    v_mfma_f32_16x16x32_bf16 v[80:83], a[236:239], v[184:187], v[80:83]
    s_add_u32 s37, s55, 0
    ds_read_b64_tr_b16 a[174:175], v23 offset:28672
    v_and_b32 v241, 8, v1
    v_mfma_f32_16x16x32_bf16 v[84:87], a[208:211], v[132:135], 0
    buffer_load_dwordx4 a[64:67], v252, s[28:31], s37 offen offset:0 sc1
    v_mfma_f32_16x16x32_bf16 v[84:87], a[212:215], v[148:151], v[84:87]
    ds_read_b64_tr_b16 a[176:177], v27 offset:0
    ds_read_b64_tr_b16 a[178:179], v27 offset:4096
    v_mfma_f32_16x16x32_bf16 v[84:87], a[216:219], v[196:199], v[84:87]
    buffer_load_dwordx4 a[68:71], v252, s[28:31], s37 offen offset:1024 sc1
    v_mfma_f32_16x16x32_bf16 v[84:87], a[220:223], v[180:183], v[84:87]
    ds_read_b64_tr_b16 a[180:181], v27 offset:8192
    ds_read_b64_tr_b16 a[182:183], v27 offset:12288
    v_mfma_f32_16x16x32_bf16 v[84:87], a[224:227], v[140:143], v[84:87]
    ds_read_b64_tr_b16 a[184:185], v27 offset:16384
    v_lshl_add_u32 v54, v241, 1, v243
    v_mfma_f32_16x16x32_bf16 v[84:87], a[228:231], v[156:159], v[84:87]
    s_lshr_b32 s41, s2, 3
    ds_read_b64_tr_b16 a[186:187], v27 offset:20480
    v_mfma_f32_16x16x32_bf16 v[84:87], a[232:235], v[204:207], v[84:87]
    buffer_load_dwordx4 a[72:75], v252, s[28:31], s37 offen offset:2048 sc1
    v_mfma_f32_16x16x32_bf16 v[84:87], a[236:239], v[188:191], v[84:87]
    s_waitcnt lgkmcnt(12)
    s_mov_b32 s14, 2359296
    ds_read_b64_tr_b16 a[188:189], v27 offset:24576
    ds_read_b64_tr_b16 a[190:191], v27 offset:28672
    s_barrier
    v_mfma_f32_16x16x32_bf16 v[88:91], a[160:163], v[128:131], 0
    s_waitcnt lgkmcnt(12)
    s_mov_b32 s15, 0x20000
    ds_read_b64_tr_b16 a[208:209], v12 offset:32768
    v_mfma_f32_16x16x32_bf16 v[88:91], a[164:167], v[144:147], v[88:91]
    s_waitcnt lgkmcnt(11)
    s_mov_b32 s18, 2359296
    ds_read_b64_tr_b16 a[210:211], v12 offset:36864
    v_mfma_f32_16x16x32_bf16 v[88:91], a[168:171], v[192:195], v[88:91]
    s_waitcnt lgkmcnt(10)
    buffer_load_dwordx4 a[76:79], v252, s[28:31], s37 offen offset:3072 sc1
    v_mfma_f32_16x16x32_bf16 v[88:91], a[172:175], v[176:179], v[88:91]
    s_waitcnt lgkmcnt(8)
    s_mov_b32 s19, 0x20000
    ds_read_b64_tr_b16 a[212:213], v12 offset:40960
    ds_read_b64_tr_b16 a[214:215], v12 offset:45056
    v_mfma_f32_16x16x32_bf16 v[88:91], a[176:179], v[136:139], v[88:91]
    s_waitcnt lgkmcnt(8)
    s_add_u32 s8, s50, 7864320
    s_addc_u32 s9, s51, 0
    ds_read_b64_tr_b16 a[216:217], v12 offset:49152
    v_mfma_f32_16x16x32_bf16 v[88:91], a[180:183], v[152:155], v[88:91]
    s_waitcnt lgkmcnt(7)
    s_add_u32 s37, s55, 4096
    ds_read_b64_tr_b16 a[218:219], v12 offset:53248
    v_mfma_f32_16x16x32_bf16 v[88:91], a[184:187], v[200:203], v[88:91]
    s_waitcnt lgkmcnt(6)
    s_add_u32 s49, s46, 256
    buffer_load_dwordx4 a[80:83], v252, s[28:31], s37 offen offset:0 sc1
    v_mfma_f32_16x16x32_bf16 v[88:91], a[188:191], v[184:187], v[88:91]
    s_add_u32 m0, s42, 0
    ds_read_b64_tr_b16 a[220:221], v12 offset:57344
    ds_read_b64_tr_b16 a[222:223], v12 offset:61440
    v_mfma_f32_16x16x32_bf16 v[92:95], a[160:163], v[132:135], 0
    buffer_load_dwordx4 v46, s[20:23], s49 offen lds
    v_mfma_f32_16x16x32_bf16 v[92:95], a[164:167], v[148:151], v[92:95]
    s_mov_b32 s10, 663552
    ds_read_b64_tr_b16 a[224:225], v16 offset:32768
    ds_read_b64_tr_b16 a[226:227], v16 offset:36864
    v_mfma_f32_16x16x32_bf16 v[92:95], a[168:171], v[196:199], v[92:95]
    buffer_load_dwordx4 v47, s[20:23], s49 offen offset:1024 lds
    v_mfma_f32_16x16x32_bf16 v[92:95], a[172:175], v[180:183], v[92:95]
    s_mov_b32 s11, 0x20000
    ds_read_b64_tr_b16 a[228:229], v16 offset:40960
    ds_read_b64_tr_b16 a[230:231], v16 offset:45056
    v_mfma_f32_16x16x32_bf16 v[92:95], a[176:179], v[140:143], v[92:95]
    buffer_load_dwordx4 a[84:87], v252, s[28:31], s37 offen offset:1024 sc1
    v_mfma_f32_16x16x32_bf16 v[92:95], a[180:183], v[156:159], v[92:95]
    s_lshl_b32 s39, s5, 13
    ds_read_b64_tr_b16 a[232:233], v16 offset:49152
    ds_read_b64_tr_b16 a[234:235], v16 offset:53248
    v_mfma_f32_16x16x32_bf16 v[92:95], a[184:187], v[204:207], v[92:95]
    s_add_u32 s39, s39, 8781824
    ds_read_b64_tr_b16 a[236:237], v16 offset:57344
    v_mfma_f32_16x16x32_bf16 v[92:95], a[188:191], v[188:191], v[92:95]
    s_waitcnt lgkmcnt(13)
    s_lshr_b32 s45, s4, 2
    ds_read_b64_tr_b16 a[238:239], v16 offset:61440
    v_mfma_f32_16x16x32_bf16 v[96:99], a[208:211], v[128:131], 0
    s_waitcnt lgkmcnt(12)
    buffer_load_dwordx4 v48, s[20:23], s49 offen offset:2048 lds
    v_mfma_f32_16x16x32_bf16 v[96:99], a[212:215], v[144:147], v[96:99]
    s_waitcnt lgkmcnt(10)
    s_lshl_b32 s45, s45, 11
    ds_read_b64_tr_b16 a[160:161], v13 offset:32768
    ds_read_b64_tr_b16 a[162:163], v13 offset:36864
    v_mfma_f32_16x16x32_bf16 v[96:99], a[216:219], v[192:195], v[96:99]
    s_waitcnt lgkmcnt(10)
    buffer_load_dwordx4 v49, s[20:23], s49 offen offset:3072 lds
    v_mfma_f32_16x16x32_bf16 v[96:99], a[220:223], v[176:179], v[96:99]
    s_waitcnt lgkmcnt(8)
    s_add_u32 s39, s39, s45
    ds_read_b64_tr_b16 a[164:165], v13 offset:40960
    ds_read_b64_tr_b16 a[166:167], v13 offset:45056
    v_mfma_f32_16x16x32_bf16 v[96:99], a[224:227], v[136:139], v[96:99]
    s_waitcnt lgkmcnt(8)
    buffer_load_dwordx4 a[88:91], v252, s[28:31], s37 offen offset:2048 sc1
    v_mfma_f32_16x16x32_bf16 v[96:99], a[228:231], v[152:155], v[96:99]
    s_waitcnt lgkmcnt(6)
    ds_read_b64_tr_b16 a[168:169], v13 offset:49152
    ds_read_b64_tr_b16 a[170:171], v13 offset:53248
    v_mfma_f32_16x16x32_bf16 v[96:99], a[232:235], v[200:203], v[96:99]
    s_waitcnt lgkmcnt(6)
    s_add_u32 s49, s46, 73984
    ds_read_b64_tr_b16 a[172:173], v13 offset:57344
    v_and_b32 v9, 15, v1
    v_mfma_f32_16x16x32_bf16 v[96:99], a[236:239], v[184:187], v[96:99]
    s_add_u32 m0, s42, 16384
    ds_read_b64_tr_b16 a[174:175], v13 offset:61440
    v_lshlrev_b32 v9, 7, v9
    v_mfma_f32_16x16x32_bf16 v[100:103], a[208:211], v[132:135], 0
    buffer_load_dwordx4 v46, s[20:23], s49 offen lds
    v_mfma_f32_16x16x32_bf16 v[100:103], a[212:215], v[148:151], v[100:103]
    ds_read_b64_tr_b16 a[176:177], v17 offset:32768
    ds_read_b64_tr_b16 a[178:179], v17 offset:36864
    v_mfma_f32_16x16x32_bf16 v[100:103], a[216:219], v[196:199], v[100:103]
    buffer_load_dwordx4 v47, s[20:23], s49 offen offset:1024 lds
    v_mfma_f32_16x16x32_bf16 v[100:103], a[220:223], v[180:183], v[100:103]
    ds_read_b64_tr_b16 a[180:181], v17 offset:40960
    ds_read_b64_tr_b16 a[182:183], v17 offset:45056
    v_mfma_f32_16x16x32_bf16 v[100:103], a[224:227], v[140:143], v[100:103]
    buffer_load_dwordx4 a[92:95], v252, s[28:31], s37 offen offset:3072 sc1
    v_mfma_f32_16x16x32_bf16 v[100:103], a[228:231], v[156:159], v[100:103]
    ds_read_b64_tr_b16 a[184:185], v17 offset:49152
    ds_read_b64_tr_b16 a[186:187], v17 offset:53248
    v_mfma_f32_16x16x32_bf16 v[100:103], a[232:235], v[204:207], v[100:103]
    ds_read_b64_tr_b16 a[188:189], v17 offset:57344
    v_mfma_f32_16x16x32_bf16 v[100:103], a[236:239], v[188:191], v[100:103]
    s_waitcnt lgkmcnt(13)
    ds_read_b64_tr_b16 a[190:191], v17 offset:61440
    v_mfma_f32_16x16x32_bf16 v[104:107], a[160:163], v[128:131], 0
    s_waitcnt lgkmcnt(12)
    buffer_load_dwordx4 v48, s[20:23], s49 offen offset:2048 lds
    v_mfma_f32_16x16x32_bf16 v[104:107], a[164:167], v[144:147], v[104:107]
    s_waitcnt lgkmcnt(10)
    ds_read_b64_tr_b16 a[208:209], v14 offset:32768
    ds_read_b64_tr_b16 a[210:211], v14 offset:36864
    v_mfma_f32_16x16x32_bf16 v[104:107], a[168:171], v[192:195], v[104:107]
    s_waitcnt lgkmcnt(10)
    buffer_load_dwordx4 v49, s[20:23], s49 offen offset:3072 lds
    v_mfma_f32_16x16x32_bf16 v[104:107], a[172:175], v[176:179], v[104:107]
    s_waitcnt lgkmcnt(8)
    s_add_u32 s37, s55, 8192
    ds_read_b64_tr_b16 a[212:213], v14 offset:40960
    ds_read_b64_tr_b16 a[214:215], v14 offset:45056
    v_mfma_f32_16x16x32_bf16 v[104:107], a[176:179], v[136:139], v[104:107]
    s_waitcnt lgkmcnt(8)
    buffer_load_dwordx4 a[96:99], v252, s[28:31], s37 offen offset:0 sc1
    v_mfma_f32_16x16x32_bf16 v[104:107], a[180:183], v[152:155], v[104:107]
    s_waitcnt lgkmcnt(6)
    ds_read_b64_tr_b16 a[216:217], v14 offset:49152
    ds_read_b64_tr_b16 a[218:219], v14 offset:53248
    v_mfma_f32_16x16x32_bf16 v[104:107], a[184:187], v[200:203], v[104:107]
    s_waitcnt lgkmcnt(6)
    buffer_load_dwordx4 a[100:103], v252, s[28:31], s37 offen offset:1024 sc1
    v_mfma_f32_16x16x32_bf16 v[104:107], a[188:191], v[184:187], v[104:107]
Ltour9:
    s_cbranch_execz Ltour13
    ds_read_b64_tr_b16 a[220:221], v14 offset:57344
    ds_read_b64_tr_b16 a[222:223], v14 offset:61440
    v_mfma_f32_16x16x32_bf16 v[108:111], a[160:163], v[132:135], 0
    ds_read_b64_tr_b16 a[224:225], v18 offset:32768
    v_mfma_f32_16x16x32_bf16 v[108:111], a[164:167], v[148:151], v[108:111]
    ds_read_b64_tr_b16 a[226:227], v18 offset:36864
    v_mfma_f32_16x16x32_bf16 v[108:111], a[168:171], v[196:199], v[108:111]
    buffer_load_dwordx4 a[104:107], v252, s[28:31], s37 offen offset:2048 sc1
    v_mfma_f32_16x16x32_bf16 v[108:111], a[172:175], v[180:183], v[108:111]
    ds_read_b64_tr_b16 a[228:229], v18 offset:40960
    ds_read_b64_tr_b16 a[230:231], v18 offset:45056
    v_mfma_f32_16x16x32_bf16 v[108:111], a[176:179], v[140:143], v[108:111]
    ds_read_b64_tr_b16 a[232:233], v18 offset:49152
    v_mfma_f32_16x16x32_bf16 v[108:111], a[180:183], v[156:159], v[108:111]
    ds_read_b64_tr_b16 a[234:235], v18 offset:53248
    v_mfma_f32_16x16x32_bf16 v[108:111], a[184:187], v[204:207], v[108:111]
    buffer_load_dwordx4 a[108:111], v252, s[28:31], s37 offen offset:3072 sc1
    v_mfma_f32_16x16x32_bf16 v[108:111], a[188:191], v[188:191], v[108:111]
    s_waitcnt lgkmcnt(12)
    ds_read_b64_tr_b16 a[236:237], v18 offset:57344
    ds_read_b64_tr_b16 a[238:239], v18 offset:61440
    v_mfma_f32_16x16x32_bf16 v[112:115], a[208:211], v[128:131], 0
    s_waitcnt lgkmcnt(12)
    ds_read_b64_tr_b16 a[160:161], v15 offset:32768
    v_mfma_f32_16x16x32_bf16 v[112:115], a[212:215], v[144:147], v[112:115]
    s_waitcnt lgkmcnt(11)
    s_add_u32 s37, s55, 12288
    ds_read_b64_tr_b16 a[162:163], v15 offset:36864
    v_mfma_f32_16x16x32_bf16 v[112:115], a[216:219], v[192:195], v[112:115]
    s_waitcnt lgkmcnt(10)
    buffer_load_dwordx4 a[112:115], v252, s[28:31], s37 offen offset:0 sc1
    v_mfma_f32_16x16x32_bf16 v[112:115], a[220:223], v[176:179], v[112:115]
    s_waitcnt lgkmcnt(8)
    ds_read_b64_tr_b16 a[164:165], v15 offset:40960
    ds_read_b64_tr_b16 a[166:167], v15 offset:45056
    v_mfma_f32_16x16x32_bf16 v[112:115], a[224:227], v[136:139], v[112:115]
    s_waitcnt lgkmcnt(8)
    buffer_load_dwordx4 a[116:119], v252, s[28:31], s37 offen offset:1024 sc1
    v_mfma_f32_16x16x32_bf16 v[112:115], a[228:231], v[152:155], v[112:115]
    s_waitcnt lgkmcnt(6)
    ds_read_b64_tr_b16 a[168:169], v15 offset:49152
    ds_read_b64_tr_b16 a[170:171], v15 offset:53248
    v_mfma_f32_16x16x32_bf16 v[112:115], a[232:235], v[200:203], v[112:115]
    s_waitcnt lgkmcnt(6)
    ds_read_b64_tr_b16 a[172:173], v15 offset:57344
    v_mfma_f32_16x16x32_bf16 v[112:115], a[236:239], v[184:187], v[112:115]
    ds_read_b64_tr_b16 a[174:175], v15 offset:61440
    v_mfma_f32_16x16x32_bf16 v[116:119], a[208:211], v[132:135], 0
    buffer_load_dwordx4 a[120:123], v252, s[28:31], s37 offen offset:2048 sc1
    v_mfma_f32_16x16x32_bf16 v[116:119], a[212:215], v[148:151], v[116:119]
    ds_read_b64_tr_b16 a[176:177], v19 offset:32768
    ds_read_b64_tr_b16 a[178:179], v19 offset:36864
    v_mfma_f32_16x16x32_bf16 v[116:119], a[216:219], v[196:199], v[116:119]
    ds_read_b64_tr_b16 a[180:181], v19 offset:40960
    v_mfma_f32_16x16x32_bf16 v[116:119], a[220:223], v[180:183], v[116:119]
    ds_read_b64_tr_b16 a[182:183], v19 offset:45056
    v_mfma_f32_16x16x32_bf16 v[116:119], a[224:227], v[140:143], v[116:119]
    buffer_load_dwordx4 a[124:127], v252, s[28:31], s37 offen offset:3072 sc1
    v_mfma_f32_16x16x32_bf16 v[116:119], a[228:231], v[156:159], v[116:119]
    ds_read_b64_tr_b16 a[184:185], v19 offset:49152
    ds_read_b64_tr_b16 a[186:187], v19 offset:53248
    v_mfma_f32_16x16x32_bf16 v[116:119], a[232:235], v[204:207], v[116:119]
    ds_read_b64_tr_b16 a[188:189], v19 offset:57344
    v_mfma_f32_16x16x32_bf16 v[116:119], a[236:239], v[188:191], v[116:119]
    ds_read_b64_tr_b16 a[190:191], v19 offset:61440
    s_waitcnt vmcnt(25)
    s_waitcnt lgkmcnt(0)
    s_barrier
    v_mfma_f32_16x16x32_bf16 v[120:123], a[160:163], v[128:131], 0
    ds_read_b64_tr_b16 a[208:209], v20 offset:32768
    v_mfma_f32_16x16x32_bf16 v[120:123], a[164:167], v[144:147], v[120:123]
    ds_read_b64_tr_b16 a[210:211], v20 offset:36864
    v_mfma_f32_16x16x32_bf16 v[120:123], a[168:171], v[192:195], v[120:123]
    ds_read_b64_tr_b16 a[212:213], v20 offset:40960
    v_mfma_f32_16x16x32_bf16 v[120:123], a[172:175], v[176:179], v[120:123]
    ds_read_b64_tr_b16 a[214:215], v20 offset:45056
    v_mfma_f32_16x16x32_bf16 v[120:123], a[176:179], v[136:139], v[120:123]
    ds_read_b64_tr_b16 a[216:217], v20 offset:49152
    v_mfma_f32_16x16x32_bf16 v[120:123], a[180:183], v[152:155], v[120:123]
    ds_read_b64_tr_b16 a[218:219], v20 offset:53248
    v_mfma_f32_16x16x32_bf16 v[120:123], a[184:187], v[200:203], v[120:123]
    s_add_u32 s49, s7, 512
    ds_read_b64_tr_b16 a[220:221], v20 offset:57344
    v_mfma_f32_16x16x32_bf16 v[120:123], a[188:191], v[184:187], v[120:123]
    s_add_u32 m0, s42, 65536
    ds_read_b64_tr_b16 a[222:223], v20 offset:61440
    v_mfma_f32_16x16x32_bf16 v[124:127], a[160:163], v[132:135], 0
    buffer_load_dwordx4 v46, s[20:23], s49 offen lds
    v_mfma_f32_16x16x32_bf16 v[124:127], a[164:167], v[148:151], v[124:127]
    ds_read_b64_tr_b16 a[224:225], v24 offset:32768
    ds_read_b64_tr_b16 a[226:227], v24 offset:36864
    v_mfma_f32_16x16x32_bf16 v[124:127], a[168:171], v[196:199], v[124:127]
    buffer_load_dwordx4 v47, s[20:23], s49 offen offset:1024 lds
    v_mfma_f32_16x16x32_bf16 v[124:127], a[172:175], v[180:183], v[124:127]
    ds_read_b64_tr_b16 a[228:229], v24 offset:40960
    ds_read_b64_tr_b16 a[230:231], v24 offset:45056
    v_mfma_f32_16x16x32_bf16 v[124:127], a[176:179], v[140:143], v[124:127]
    ds_read_b64_tr_b16 a[232:233], v24 offset:49152
    v_mfma_f32_16x16x32_bf16 v[124:127], a[180:183], v[156:159], v[124:127]
    ds_read_b64_tr_b16 a[234:235], v24 offset:53248
    v_mfma_f32_16x16x32_bf16 v[124:127], a[184:187], v[204:207], v[124:127]
    ds_read_b64_tr_b16 a[236:237], v24 offset:57344
    v_lshrrev_b32 v240, 4, v1
    v_mfma_f32_16x16x32_bf16 v[124:127], a[188:191], v[188:191], v[124:127]
    s_waitcnt vmcnt(25)
    s_waitcnt lgkmcnt(13)
    ds_read_b64_tr_b16 a[238:239], v24 offset:61440
    v_and_b32 v240, 2, v240
    v_mfma_f32_16x16x32_bf16 v[64:67], a[208:211], a[64:67], v[64:67]
    s_waitcnt vmcnt(24)
    s_waitcnt lgkmcnt(12)
    buffer_load_dwordx4 v48, s[20:23], s49 offen offset:2048 lds
    v_mfma_f32_16x16x32_bf16 v[64:67], a[212:215], a[68:71], v[64:67]
    s_waitcnt vmcnt(24)
    s_waitcnt lgkmcnt(10)
    ds_read_b64_tr_b16 a[160:161], v21 offset:32768
    ds_read_b64_tr_b16 a[162:163], v21 offset:36864
    v_mfma_f32_16x16x32_bf16 v[64:67], a[216:219], a[72:75], v[64:67]
    s_waitcnt vmcnt(23)
    s_waitcnt lgkmcnt(10)
    buffer_load_dwordx4 v49, s[20:23], s49 offen offset:3072 lds
    v_mfma_f32_16x16x32_bf16 v[64:67], a[220:223], a[76:79], v[64:67]
    s_waitcnt vmcnt(23)
    s_waitcnt lgkmcnt(8)
    ds_read_b64_tr_b16 a[164:165], v21 offset:40960
    ds_read_b64_tr_b16 a[166:167], v21 offset:45056
    v_mfma_f32_16x16x32_bf16 v[64:67], a[224:227], a[80:83], v[64:67]
    s_waitcnt vmcnt(20)
    s_waitcnt lgkmcnt(8)
    ds_read_b64_tr_b16 a[168:169], v21 offset:49152
    v_bfe_u32 v241, v1, 2, 2
    v_mfma_f32_16x16x32_bf16 v[64:67], a[228:231], a[84:87], v[64:67]
    s_waitcnt vmcnt(17)
    s_waitcnt lgkmcnt(7)
    ds_read_b64_tr_b16 a[170:171], v21 offset:53248
    v_cmp_eq_u32 s[54:55], v240, v241
    v_mfma_f32_16x16x32_bf16 v[64:67], a[232:235], a[88:91], v[64:67]
    s_waitcnt vmcnt(14)
    s_waitcnt lgkmcnt(6)
    s_add_u32 s49, s7, 74240
    ds_read_b64_tr_b16 a[172:173], v21 offset:57344
    v_or_b32 v240, 1, v240
    v_mfma_f32_16x16x32_bf16 v[64:67], a[236:239], a[92:95], v[64:67]
    s_waitcnt vmcnt(11)
    s_add_u32 m0, s42, 81920
    ds_read_b64_tr_b16 a[174:175], v21 offset:61440
    v_cmp_eq_u32 s[36:37], v240, v241
    v_mfma_f32_16x16x32_bf16 v[68:71], a[208:211], a[96:99], v[68:71]
    s_waitcnt vmcnt(10)
    buffer_load_dwordx4 v46, s[20:23], s49 offen lds
    v_mfma_f32_16x16x32_bf16 v[68:71], a[212:215], a[100:103], v[68:71]
    s_waitcnt vmcnt(10)
    ds_read_b64_tr_b16 a[176:177], v25 offset:32768
    ds_read_b64_tr_b16 a[178:179], v25 offset:36864
    v_mfma_f32_16x16x32_bf16 v[68:71], a[216:219], a[104:107], v[68:71]
    s_waitcnt vmcnt(9)
    buffer_load_dwordx4 v47, s[20:23], s49 offen offset:1024 lds
    v_mfma_f32_16x16x32_bf16 v[68:71], a[220:223], a[108:111], v[68:71]
    s_waitcnt vmcnt(9)
    ds_read_b64_tr_b16 a[180:181], v25 offset:40960
    ds_read_b64_tr_b16 a[182:183], v25 offset:45056
    v_mfma_f32_16x16x32_bf16 v[68:71], a[224:227], a[112:115], v[68:71]
    s_waitcnt vmcnt(8)
    ds_read_b64_tr_b16 a[184:185], v25 offset:49152
    v_cvt_pk_bf16_f32 v224, v64, v65
    v_mfma_f32_16x16x32_bf16 v[68:71], a[228:231], a[116:119], v[68:71]
    s_waitcnt vmcnt(7)
    ds_read_b64_tr_b16 a[186:187], v25 offset:53248
    v_cvt_pk_bf16_f32 v225, v66, v67
    v_mfma_f32_16x16x32_bf16 v[68:71], a[232:235], a[120:123], v[68:71]
    s_waitcnt vmcnt(6)
    buffer_load_dwordx2 v[36:37], v4, s[12:15], 0 offen offset:0
    v_mfma_f32_16x16x32_bf16 v[68:71], a[236:239], a[124:127], v[68:71]
    s_waitcnt lgkmcnt(12)
    ds_read_b64_tr_b16 a[188:189], v25 offset:57344
    ds_read_b64_tr_b16 a[190:191], v25 offset:61440
    v_mfma_f32_16x16x32_bf16 v[72:75], a[160:163], a[64:67], v[72:75]
    s_waitcnt lgkmcnt(12)
    buffer_load_dwordx4 v48, s[20:23], s49 offen offset:2048 lds
    v_mfma_f32_16x16x32_bf16 v[72:75], a[164:167], a[68:71], v[72:75]
    s_waitcnt lgkmcnt(10)
    ds_read_b64_tr_b16 a[208:209], v22 offset:32768
    ds_read_b64_tr_b16 a[210:211], v22 offset:36864
    v_mfma_f32_16x16x32_bf16 v[72:75], a[168:171], a[72:75], v[72:75]
    s_waitcnt lgkmcnt(10)
    buffer_load_dwordx4 v49, s[20:23], s49 offen offset:3072 lds
    v_mfma_f32_16x16x32_bf16 v[72:75], a[172:175], a[76:79], v[72:75]
    s_waitcnt lgkmcnt(8)
    ds_read_b64_tr_b16 a[212:213], v22 offset:40960
    ds_read_b64_tr_b16 a[214:215], v22 offset:45056
    v_mfma_f32_16x16x32_bf16 v[72:75], a[176:179], a[80:83], v[72:75]
    s_waitcnt lgkmcnt(8)
    ds_read_b64_tr_b16 a[216:217], v22 offset:49152
    v_cvt_pk_bf16_f32 v228, v68, v69
    v_mfma_f32_16x16x32_bf16 v[72:75], a[180:183], a[84:87], v[72:75]
    s_waitcnt lgkmcnt(7)
    ds_read_b64_tr_b16 a[218:219], v22 offset:53248
    v_cvt_pk_bf16_f32 v229, v70, v71
    v_mfma_f32_16x16x32_bf16 v[72:75], a[184:187], a[88:91], v[72:75]
    s_waitcnt lgkmcnt(6)
    ds_read_b64_tr_b16 a[220:221], v22 offset:57344
    v_and_b32 v240, 1, v1
    v_mfma_f32_16x16x32_bf16 v[72:75], a[188:191], a[92:95], v[72:75]
    ds_read_b64_tr_b16 a[222:223], v22 offset:61440
    v_lshlrev_b32 v240, 4, v240
    v_mfma_f32_16x16x32_bf16 v[76:79], a[160:163], a[96:99], v[76:79]
    buffer_load_dwordx2 v[38:39], v4, s[12:15], 0 offen offset:32
    v_mfma_f32_16x16x32_bf16 v[76:79], a[164:167], a[100:103], v[76:79]
    ds_read_b64_tr_b16 a[224:225], v26 offset:32768
    ds_read_b64_tr_b16 a[226:227], v26 offset:36864
    v_mfma_f32_16x16x32_bf16 v[76:79], a[168:171], a[104:107], v[76:79]
    ds_read_b64_tr_b16 a[228:229], v26 offset:40960
    v_mov_b32 v241, 0x3f80
    v_mfma_f32_16x16x32_bf16 v[76:79], a[172:175], a[108:111], v[76:79]
    ds_read_b64_tr_b16 a[230:231], v26 offset:45056
    v_lshlrev_b32 v240, v240, v241
    v_mfma_f32_16x16x32_bf16 v[76:79], a[176:179], a[112:115], v[76:79]
    ds_read_b64_tr_b16 a[232:233], v26 offset:49152
    v_cvt_pk_bf16_f32 v226, v72, v73
    v_mfma_f32_16x16x32_bf16 v[76:79], a[180:183], a[116:119], v[76:79]
    s_add_u32 s38, s93, 0
    ds_read_b64_tr_b16 a[234:235], v26 offset:53248
    v_cvt_pk_bf16_f32 v227, v74, v75
    v_mfma_f32_16x16x32_bf16 v[76:79], a[184:187], a[120:123], v[76:79]
    buffer_store_dwordx4 v[224:227], v56, s[28:31], s38 offen sc1
    v_mfma_f32_16x16x32_bf16 v[76:79], a[188:191], a[124:127], v[76:79]
    s_waitcnt lgkmcnt(12)
    ds_read_b64_tr_b16 a[236:237], v26 offset:57344
    ds_read_b64_tr_b16 a[238:239], v26 offset:61440
    v_mfma_f32_16x16x32_bf16 v[80:83], a[208:211], a[64:67], v[80:83]
    s_waitcnt lgkmcnt(12)
    ds_read_b64_tr_b16 a[160:161], v23 offset:32768
    v_bfe_i32 v241, v1, 1, 1
    v_mfma_f32_16x16x32_bf16 v[80:83], a[212:215], a[68:71], v[80:83]
    s_waitcnt lgkmcnt(11)
    ds_read_b64_tr_b16 a[162:163], v23 offset:36864
    v_and_b32 v243, v240, v241
    v_mfma_f32_16x16x32_bf16 v[80:83], a[216:219], a[72:75], v[80:83]
    s_waitcnt lgkmcnt(10)
    buffer_load_dwordx2 v[40:41], v4, s[12:15], 0 offen offset:512
    v_mfma_f32_16x16x32_bf16 v[80:83], a[220:223], a[76:79], v[80:83]
    s_waitcnt lgkmcnt(8)
    ds_read_b64_tr_b16 a[164:165], v23 offset:40960
    ds_read_b64_tr_b16 a[166:167], v23 offset:45056
    v_mfma_f32_16x16x32_bf16 v[80:83], a[224:227], a[80:83], v[80:83]
    s_waitcnt lgkmcnt(8)
    ds_read_b64_tr_b16 a[168:169], v23 offset:49152
    v_cvt_pk_bf16_f32 v230, v76, v77
    v_mfma_f32_16x16x32_bf16 v[80:83], a[228:231], a[84:87], v[80:83]
    s_waitcnt lgkmcnt(7)
    s_add_u32 s38, s93, 163840
    ds_read_b64_tr_b16 a[170:171], v23 offset:53248
    v_cvt_pk_bf16_f32 v231, v78, v79
    v_mfma_f32_16x16x32_bf16 v[80:83], a[232:235], a[88:91], v[80:83]
    s_waitcnt lgkmcnt(6)
    buffer_store_dwordx4 v[228:231], v56, s[28:31], s38 offen sc1
    v_mfma_f32_16x16x32_bf16 v[80:83], a[236:239], a[92:95], v[80:83]
    ds_read_b64_tr_b16 a[172:173], v23 offset:57344
    ds_read_b64_tr_b16 a[174:175], v23 offset:61440
    v_mfma_f32_16x16x32_bf16 v[84:87], a[208:211], a[96:99], v[84:87]
    ds_read_b64_tr_b16 a[176:177], v27 offset:32768
    v_xor_b32 v242, v240, v243
    v_mfma_f32_16x16x32_bf16 v[84:87], a[212:215], a[100:103], v[84:87]
    ds_read_b64_tr_b16 a[178:179], v27 offset:36864
    v_cndmask_b32 v246, 0, v242, s[54:55]
    v_mfma_f32_16x16x32_bf16 v[84:87], a[216:219], a[104:107], v[84:87]
    ds_read_b64_tr_b16 a[180:181], v27 offset:40960
    v_cndmask_b32 v247, 0, v243, s[54:55]
    v_mfma_f32_16x16x32_bf16 v[84:87], a[220:223], a[108:111], v[84:87]
    ds_read_b64_tr_b16 a[182:183], v27 offset:45056
    v_cndmask_b32 v250, 0, v242, s[36:37]
    v_mfma_f32_16x16x32_bf16 v[84:87], a[224:227], a[112:115], v[84:87]
    ds_read_b64_tr_b16 a[184:185], v27 offset:49152
    v_cvt_pk_bf16_f32 v232, v80, v81
    v_mfma_f32_16x16x32_bf16 v[84:87], a[228:231], a[116:119], v[84:87]
    ds_read_b64_tr_b16 a[186:187], v27 offset:53248
    v_cvt_pk_bf16_f32 v233, v82, v83
    v_mfma_f32_16x16x32_bf16 v[84:87], a[232:235], a[120:123], v[84:87]
    buffer_load_dwordx2 v[42:43], v4, s[12:15], 0 offen offset:544
    v_mfma_f32_16x16x32_bf16 v[84:87], a[236:239], a[124:127], v[84:87]
    s_waitcnt lgkmcnt(12)
    ds_read_b64_tr_b16 a[188:189], v27 offset:57344
    ds_read_b64_tr_b16 a[190:191], v27 offset:61440
    s_barrier
    v_mfma_f32_16x16x32_bf16 v[88:91], a[160:163], a[64:67], v[88:91]
    s_waitcnt lgkmcnt(12)
    ds_read_b64_tr_b16 a[208:209], v12 offset:0
    v_cndmask_b32 v251, 0, v243, s[36:37]
    v_mfma_f32_16x16x32_bf16 v[88:91], a[164:167], a[68:71], v[88:91]
    s_waitcnt lgkmcnt(11)
    ds_read_b64_tr_b16 a[210:211], v12 offset:4096
    v_mov_b32 v240, 0
    v_mfma_f32_16x16x32_bf16 v[88:91], a[168:171], a[72:75], v[88:91]
    s_waitcnt lgkmcnt(10)
    ds_read_b64_tr_b16 a[212:213], v12 offset:8192
    v_mov_b32 v241, 0
    v_mfma_f32_16x16x32_bf16 v[88:91], a[172:175], a[76:79], v[88:91]
    s_waitcnt lgkmcnt(9)
    ds_read_b64_tr_b16 a[214:215], v12 offset:12288
    v_mov_b32 v244, 0
    v_mfma_f32_16x16x32_bf16 v[88:91], a[176:179], a[80:83], v[88:91]
    s_waitcnt lgkmcnt(8)
    ds_read_b64_tr_b16 a[216:217], v12 offset:16384
    v_cvt_pk_bf16_f32 v236, v84, v85
    v_mfma_f32_16x16x32_bf16 v[88:91], a[180:183], a[84:87], v[88:91]
    s_waitcnt lgkmcnt(7)
    ds_read_b64_tr_b16 a[218:219], v12 offset:20480
    v_cvt_pk_bf16_f32 v237, v86, v87
    v_mfma_f32_16x16x32_bf16 v[88:91], a[184:187], a[88:91], v[88:91]
    s_waitcnt lgkmcnt(6)
    s_add_u32 s49, s46, 512
    ds_read_b64_tr_b16 a[220:221], v12 offset:24576
    v_mov_b32 v245, 0
    v_mfma_f32_16x16x32_bf16 v[88:91], a[188:191], a[92:95], v[88:91]
    s_add_u32 m0, s42, 32768
    ds_read_b64_tr_b16 a[222:223], v12 offset:28672
    v_mov_b32 v248, 0
    v_mfma_f32_16x16x32_bf16 v[92:95], a[160:163], a[96:99], v[92:95]
    buffer_load_dwordx4 v46, s[20:23], s49 offen lds
    v_mfma_f32_16x16x32_bf16 v[92:95], a[164:167], a[100:103], v[92:95]
    ds_read_b64_tr_b16 a[224:225], v16 offset:0
    ds_read_b64_tr_b16 a[226:227], v16 offset:4096
    v_mfma_f32_16x16x32_bf16 v[92:95], a[168:171], a[104:107], v[92:95]
    buffer_load_dwordx4 v47, s[20:23], s49 offen offset:1024 lds
    v_mfma_f32_16x16x32_bf16 v[92:95], a[172:175], a[108:111], v[92:95]
    ds_read_b64_tr_b16 a[228:229], v16 offset:8192
    ds_read_b64_tr_b16 a[230:231], v16 offset:12288
    v_mfma_f32_16x16x32_bf16 v[92:95], a[176:179], a[112:115], v[92:95]
    ds_read_b64_tr_b16 a[232:233], v16 offset:16384
    v_cvt_pk_bf16_f32 v234, v88, v89
    v_mfma_f32_16x16x32_bf16 v[92:95], a[180:183], a[116:119], v[92:95]
    s_add_u32 s38, s93, 128
    ds_read_b64_tr_b16 a[234:235], v16 offset:20480
    v_cvt_pk_bf16_f32 v235, v90, v91
    v_mfma_f32_16x16x32_bf16 v[92:95], a[184:187], a[120:123], v[92:95]
    buffer_store_dwordx4 v[232:235], v56, s[28:31], s38 offen sc1
    v_mfma_f32_16x16x32_bf16 v[92:95], a[188:191], a[124:127], v[92:95]
    s_waitcnt lgkmcnt(12)
    ds_read_b64_tr_b16 a[236:237], v16 offset:24576
    ds_read_b64_tr_b16 a[238:239], v16 offset:28672
    v_mfma_f32_16x16x32_bf16 v[96:99], a[208:211], a[64:67], v[96:99]
    s_waitcnt lgkmcnt(12)
    buffer_load_dwordx4 v48, s[20:23], s49 offen offset:2048 lds
    v_mfma_f32_16x16x32_bf16 v[96:99], a[212:215], a[68:71], v[96:99]
    s_waitcnt lgkmcnt(10)
    ds_read_b64_tr_b16 a[160:161], v13 offset:0
    ds_read_b64_tr_b16 a[162:163], v13 offset:4096
    v_mfma_f32_16x16x32_bf16 v[96:99], a[216:219], a[72:75], v[96:99]
    s_waitcnt lgkmcnt(10)
    buffer_load_dwordx4 v49, s[20:23], s49 offen offset:3072 lds
    v_mfma_f32_16x16x32_bf16 v[96:99], a[220:223], a[76:79], v[96:99]
    s_waitcnt lgkmcnt(8)
    ds_read_b64_tr_b16 a[164:165], v13 offset:8192
    ds_read_b64_tr_b16 a[166:167], v13 offset:12288
    v_mfma_f32_16x16x32_bf16 v[96:99], a[224:227], a[80:83], v[96:99]
    s_waitcnt lgkmcnt(8)
    ds_read_b64_tr_b16 a[168:169], v13 offset:16384
    v_cvt_pk_bf16_f32 v238, v92, v93
    v_mfma_f32_16x16x32_bf16 v[96:99], a[228:231], a[84:87], v[96:99]
    s_waitcnt lgkmcnt(7)
    s_add_u32 s38, s93, 163968
    ds_read_b64_tr_b16 a[170:171], v13 offset:20480
    v_cvt_pk_bf16_f32 v239, v94, v95
    v_mfma_f32_16x16x32_bf16 v[96:99], a[232:235], a[88:91], v[96:99]
    s_waitcnt lgkmcnt(6)
    s_add_u32 s49, s46, 74240
    buffer_store_dwordx4 v[236:239], v56, s[28:31], s38 offen sc1
    v_mfma_f32_16x16x32_bf16 v[96:99], a[236:239], a[92:95], v[96:99]
    s_add_u32 m0, s42, 49152
    ds_read_b64_tr_b16 a[172:173], v13 offset:24576
    ds_read_b64_tr_b16 a[174:175], v13 offset:28672
    v_mfma_f32_16x16x32_bf16 v[100:103], a[208:211], a[96:99], v[100:103]
    buffer_load_dwordx4 v46, s[20:23], s49 offen lds
    v_mfma_f32_16x16x32_bf16 v[100:103], a[212:215], a[100:103], v[100:103]
    ds_read_b64_tr_b16 a[176:177], v17 offset:0
    ds_read_b64_tr_b16 a[178:179], v17 offset:4096
    v_mfma_f32_16x16x32_bf16 v[100:103], a[216:219], a[104:107], v[100:103]
    buffer_load_dwordx4 v47, s[20:23], s49 offen offset:1024 lds
    v_mfma_f32_16x16x32_bf16 v[100:103], a[220:223], a[108:111], v[100:103]
    ds_read_b64_tr_b16 a[180:181], v17 offset:8192
    ds_read_b64_tr_b16 a[182:183], v17 offset:12288
    v_mfma_f32_16x16x32_bf16 v[100:103], a[224:227], a[112:115], v[100:103]
    ds_read_b64_tr_b16 a[184:185], v17 offset:16384
    v_cvt_pk_bf16_f32 v224, v96, v97
    v_mfma_f32_16x16x32_bf16 v[100:103], a[228:231], a[116:119], v[100:103]
    ds_read_b64_tr_b16 a[186:187], v17 offset:20480
    v_cvt_pk_bf16_f32 v225, v98, v99
    v_mfma_f32_16x16x32_bf16 v[100:103], a[232:235], a[120:123], v[100:103]
    ds_read_b64_tr_b16 a[188:189], v17 offset:24576
    v_mov_b32 v249, 0
    v_mfma_f32_16x16x32_bf16 v[100:103], a[236:239], a[124:127], v[100:103]
    s_waitcnt lgkmcnt(13)
    ds_read_b64_tr_b16 a[190:191], v17 offset:28672
    v_mov_b32 v252, 0
    v_mfma_f32_16x16x32_bf16 v[104:107], a[160:163], a[64:67], v[104:107]
    s_waitcnt lgkmcnt(12)
    buffer_load_dwordx4 v48, s[20:23], s49 offen offset:2048 lds
    v_mfma_f32_16x16x32_bf16 v[104:107], a[164:167], a[68:71], v[104:107]
    s_waitcnt lgkmcnt(10)
    ds_read_b64_tr_b16 a[208:209], v14 offset:0
    ds_read_b64_tr_b16 a[210:211], v14 offset:4096
    v_mfma_f32_16x16x32_bf16 v[104:107], a[168:171], a[72:75], v[104:107]
    s_waitcnt lgkmcnt(10)
    buffer_load_dwordx4 v49, s[20:23], s49 offen offset:3072 lds
    v_mfma_f32_16x16x32_bf16 v[104:107], a[172:175], a[76:79], v[104:107]
    s_waitcnt lgkmcnt(8)
    ds_read_b64_tr_b16 a[212:213], v14 offset:8192
    ds_read_b64_tr_b16 a[214:215], v14 offset:12288
    v_mfma_f32_16x16x32_bf16 v[104:107], a[176:179], a[80:83], v[104:107]
    s_waitcnt lgkmcnt(8)
    ds_read_b64_tr_b16 a[216:217], v14 offset:16384
    v_cvt_pk_bf16_f32 v228, v100, v101
    v_mfma_f32_16x16x32_bf16 v[104:107], a[180:183], a[84:87], v[104:107]
    s_waitcnt lgkmcnt(7)
    ds_read_b64_tr_b16 a[218:219], v14 offset:20480
    v_cvt_pk_bf16_f32 v229, v102, v103
    v_mfma_f32_16x16x32_bf16 v[104:107], a[184:187], a[88:91], v[104:107]
    s_waitcnt lgkmcnt(6)
    ds_read_b64_tr_b16 a[220:221], v14 offset:24576
    v_mov_b32 v253, 0
    v_mfma_f32_16x16x32_bf16 v[104:107], a[188:191], a[92:95], v[104:107]
    ds_read_b64_tr_b16 a[222:223], v14 offset:28672
    v_mfma_f32_16x16x32_bf16 v[108:111], a[160:163], a[96:99], v[108:111]
    ds_read_b64_tr_b16 a[224:225], v18 offset:0
    v_mfma_f32_16x16x32_bf16 v[108:111], a[164:167], a[100:103], v[108:111]
    ds_read_b64_tr_b16 a[226:227], v18 offset:4096
    v_mfma_f32_16x16x32_bf16 v[108:111], a[168:171], a[104:107], v[108:111]
    ds_read_b64_tr_b16 a[228:229], v18 offset:8192
    v_mfma_f32_16x16x32_bf16 v[108:111], a[172:175], a[108:111], v[108:111]
    ds_read_b64_tr_b16 a[230:231], v18 offset:12288
    v_mfma_f32_16x16x32_bf16 v[108:111], a[176:179], a[112:115], v[108:111]
    ds_read_b64_tr_b16 a[232:233], v18 offset:16384
    v_cvt_pk_bf16_f32 v226, v104, v105
    v_mfma_f32_16x16x32_bf16 v[108:111], a[180:183], a[116:119], v[108:111]
    s_add_u32 s38, s93, 512
    ds_read_b64_tr_b16 a[234:235], v18 offset:20480
    v_cvt_pk_bf16_f32 v227, v106, v107
    v_mfma_f32_16x16x32_bf16 v[108:111], a[184:187], a[120:123], v[108:111]
    buffer_store_dwordx4 v[224:227], v56, s[28:31], s38 offen sc1
    v_mfma_f32_16x16x32_bf16 v[108:111], a[188:191], a[124:127], v[108:111]
    s_waitcnt lgkmcnt(12)
    ds_read_b64_tr_b16 a[236:237], v18 offset:24576
    ds_read_b64_tr_b16 a[238:239], v18 offset:28672
    v_mfma_f32_16x16x32_bf16 v[112:115], a[208:211], a[64:67], v[112:115]
    s_waitcnt lgkmcnt(12)
    ds_read_b64_tr_b16 a[160:161], v15 offset:0
    v_mfma_f32_16x16x32_bf16 v[112:115], a[212:215], a[68:71], v[112:115]
    s_waitcnt lgkmcnt(11)
    ds_read_b64_tr_b16 a[162:163], v15 offset:4096
    v_mfma_f32_16x16x32_bf16 v[112:115], a[216:219], a[72:75], v[112:115]
    s_waitcnt lgkmcnt(10)
    ds_read_b64_tr_b16 a[164:165], v15 offset:8192
    v_mfma_f32_16x16x32_bf16 v[112:115], a[220:223], a[76:79], v[112:115]
    s_waitcnt lgkmcnt(9)
    ds_read_b64_tr_b16 a[166:167], v15 offset:12288
    v_mfma_f32_16x16x32_bf16 v[112:115], a[224:227], a[80:83], v[112:115]
    s_waitcnt lgkmcnt(8)
    ds_read_b64_tr_b16 a[168:169], v15 offset:16384
    v_cvt_pk_bf16_f32 v230, v108, v109
    v_mfma_f32_16x16x32_bf16 v[112:115], a[228:231], a[84:87], v[112:115]
    s_waitcnt lgkmcnt(7)
    s_add_u32 s38, s93, 164352
    ds_read_b64_tr_b16 a[170:171], v15 offset:20480
    v_cvt_pk_bf16_f32 v231, v110, v111
    v_mfma_f32_16x16x32_bf16 v[112:115], a[232:235], a[88:91], v[112:115]
    s_waitcnt lgkmcnt(6)
    buffer_store_dwordx4 v[228:231], v56, s[28:31], s38 offen sc1
    v_mfma_f32_16x16x32_bf16 v[112:115], a[236:239], a[92:95], v[112:115]
    ds_read_b64_tr_b16 a[172:173], v15 offset:24576
    ds_read_b64_tr_b16 a[174:175], v15 offset:28672
    v_mfma_f32_16x16x32_bf16 v[116:119], a[208:211], a[96:99], v[116:119]
    ds_read_b64_tr_b16 a[176:177], v19 offset:0
    v_mfma_f32_16x16x32_bf16 v[116:119], a[212:215], a[100:103], v[116:119]
    ds_read_b64_tr_b16 a[178:179], v19 offset:4096
    v_mfma_f32_16x16x32_bf16 v[116:119], a[216:219], a[104:107], v[116:119]
    ds_read_b64_tr_b16 a[180:181], v19 offset:8192
    v_mfma_f32_16x16x32_bf16 v[116:119], a[220:223], a[108:111], v[116:119]
    ds_read_b64_tr_b16 a[182:183], v19 offset:12288
    v_mfma_f32_16x16x32_bf16 v[116:119], a[224:227], a[112:115], v[116:119]
    ds_read_b64_tr_b16 a[184:185], v19 offset:16384
    v_cvt_pk_bf16_f32 v232, v112, v113
    v_mfma_f32_16x16x32_bf16 v[116:119], a[228:231], a[116:119], v[116:119]
    ds_read_b64_tr_b16 a[186:187], v19 offset:20480
    v_cvt_pk_bf16_f32 v233, v114, v115
    v_mfma_f32_16x16x32_bf16 v[116:119], a[232:235], a[120:123], v[116:119]
    ds_read_b64_tr_b16 a[188:189], v19 offset:24576
    v_mfma_f32_16x16x32_bf16 v[116:119], a[236:239], a[124:127], v[116:119]
    s_waitcnt lgkmcnt(13)
    ds_read_b64_tr_b16 a[190:191], v19 offset:28672
    s_waitcnt vmcnt(17)
    s_barrier
    v_mfma_f32_16x16x32_bf16 v[120:123], a[160:163], a[64:67], v[120:123]
    s_waitcnt lgkmcnt(12)
    ds_read_b64_tr_b16 a[208:209], v20 offset:0
    v_mfma_f32_16x16x32_bf16 v[120:123], a[164:167], a[68:71], v[120:123]
    s_waitcnt lgkmcnt(11)
    ds_read_b64_tr_b16 a[210:211], v20 offset:4096
    v_mfma_f32_16x16x32_bf16 v[120:123], a[168:171], a[72:75], v[120:123]
    s_waitcnt lgkmcnt(10)
    ds_read_b64_tr_b16 a[212:213], v20 offset:8192
    v_mfma_f32_16x16x32_bf16 v[120:123], a[172:175], a[76:79], v[120:123]
    s_waitcnt lgkmcnt(9)
    ds_read_b64_tr_b16 a[214:215], v20 offset:12288
    v_mfma_f32_16x16x32_bf16 v[120:123], a[176:179], a[80:83], v[120:123]
    s_waitcnt lgkmcnt(8)
    ds_read_b64_tr_b16 a[216:217], v20 offset:16384
    v_cvt_pk_bf16_f32 v236, v116, v117
    v_mfma_f32_16x16x32_bf16 v[120:123], a[180:183], a[84:87], v[120:123]
    s_waitcnt lgkmcnt(7)
    ds_read_b64_tr_b16 a[218:219], v20 offset:20480
    v_cvt_pk_bf16_f32 v237, v118, v119
    v_mfma_f32_16x16x32_bf16 v[120:123], a[184:187], a[88:91], v[120:123]
    s_waitcnt lgkmcnt(6)
    s_add_u32 s49, s7, 768
    ds_read_b64_tr_b16 a[220:221], v20 offset:24576
    v_mfma_f32_16x16x32_bf16 v[120:123], a[188:191], a[92:95], v[120:123]
    s_add_u32 m0, s42, 98304
    ds_read_b64_tr_b16 a[222:223], v20 offset:28672
    v_mfma_f32_16x16x32_bf16 v[124:127], a[160:163], a[96:99], v[124:127]
    buffer_load_dwordx4 v46, s[20:23], s49 offen lds
    v_mfma_f32_16x16x32_bf16 v[124:127], a[164:167], a[100:103], v[124:127]
    ds_read_b64_tr_b16 a[224:225], v24 offset:0
    ds_read_b64_tr_b16 a[226:227], v24 offset:4096
    v_mfma_f32_16x16x32_bf16 v[124:127], a[168:171], a[104:107], v[124:127]
    buffer_load_dwordx4 v47, s[20:23], s49 offen offset:1024 lds
    v_mfma_f32_16x16x32_bf16 v[124:127], a[172:175], a[108:111], v[124:127]
    ds_read_b64_tr_b16 a[228:229], v24 offset:8192
    ds_read_b64_tr_b16 a[230:231], v24 offset:12288
    v_mfma_f32_16x16x32_bf16 v[124:127], a[176:179], a[112:115], v[124:127]
    ds_read_b64_tr_b16 a[232:233], v24 offset:16384
    v_cvt_pk_bf16_f32 v234, v120, v121
    v_mfma_f32_16x16x32_bf16 v[124:127], a[180:183], a[116:119], v[124:127]
    s_add_u32 s38, s93, 640
    ds_read_b64_tr_b16 a[234:235], v24 offset:20480
    v_cvt_pk_bf16_f32 v235, v122, v123
    v_mfma_f32_16x16x32_bf16 v[124:127], a[184:187], a[120:123], v[124:127]
    buffer_store_dwordx4 v[232:235], v56, s[28:31], s38 offen sc1
    v_mfma_f32_16x16x32_bf16 v[124:127], a[188:191], a[124:127], v[124:127]
    s_waitcnt lgkmcnt(12)
    ds_read_b64_tr_b16 a[236:237], v24 offset:24576
    ds_read_b64_tr_b16 a[238:239], v24 offset:28672
    v_mfma_f32_16x16x32_bf16 v[64:67], a[208:211], v[128:131], 0
    s_waitcnt lgkmcnt(12)
    buffer_load_dwordx4 v48, s[20:23], s49 offen offset:2048 lds
    v_mfma_f32_16x16x32_bf16 v[64:67], a[212:215], v[144:147], v[64:67]
    s_waitcnt lgkmcnt(10)
    ds_read_b64_tr_b16 a[160:161], v21 offset:0
    ds_read_b64_tr_b16 a[162:163], v21 offset:4096
    v_mfma_f32_16x16x32_bf16 v[64:67], a[216:219], v[192:195], v[64:67]
    s_waitcnt lgkmcnt(10)
    buffer_load_dwordx4 v49, s[20:23], s49 offen offset:3072 lds
    v_mfma_f32_16x16x32_bf16 v[64:67], a[220:223], v[176:179], v[64:67]
    s_waitcnt lgkmcnt(8)
    ds_read_b64_tr_b16 a[164:165], v21 offset:8192
    ds_read_b64_tr_b16 a[166:167], v21 offset:12288
    v_mfma_f32_16x16x32_bf16 v[64:67], a[224:227], v[136:139], v[64:67]
    s_waitcnt lgkmcnt(8)
    ds_read_b64_tr_b16 a[168:169], v21 offset:16384
    v_cvt_pk_bf16_f32 v238, v124, v125
    v_mfma_f32_16x16x32_bf16 v[64:67], a[228:231], v[152:155], v[64:67]
    s_waitcnt lgkmcnt(7)
    s_add_u32 s38, s93, 164480
    ds_read_b64_tr_b16 a[170:171], v21 offset:20480
    v_cvt_pk_bf16_f32 v239, v126, v127
    v_mfma_f32_16x16x32_bf16 v[64:67], a[232:235], v[200:203], v[64:67]
    s_waitcnt lgkmcnt(6)
    s_add_u32 s49, s7, 74496
    buffer_store_dwordx4 v[236:239], v56, s[28:31], s38 offen sc1
    v_mfma_f32_16x16x32_bf16 v[64:67], a[236:239], v[184:187], v[64:67]
    s_add_u32 m0, s42, 114688
    ds_read_b64_tr_b16 a[172:173], v21 offset:24576
Ltour10:
    s_cbranch_execz Ltour14
    ds_read_b64_tr_b16 a[174:175], v21 offset:28672
    v_mfma_f32_16x16x32_bf16 v[68:71], a[208:211], v[132:135], 0
    buffer_load_dwordx4 v46, s[20:23], s49 offen lds
    v_mfma_f32_16x16x32_bf16 v[68:71], a[212:215], v[148:151], v[68:71]
    ds_read_b64_tr_b16 a[176:177], v25 offset:0
    ds_read_b64_tr_b16 a[178:179], v25 offset:4096
    v_mfma_f32_16x16x32_bf16 v[68:71], a[216:219], v[196:199], v[68:71]
    buffer_load_dwordx4 v47, s[20:23], s49 offen offset:1024 lds
    v_mfma_f32_16x16x32_bf16 v[68:71], a[220:223], v[180:183], v[68:71]
    ds_read_b64_tr_b16 a[180:181], v25 offset:8192
    ds_read_b64_tr_b16 a[182:183], v25 offset:12288
    v_mfma_f32_16x16x32_bf16 v[68:71], a[224:227], v[140:143], v[68:71]
    ds_read_b64_tr_b16 a[184:185], v25 offset:16384
    v_mfma_f32_16x16x32_bf16 v[68:71], a[228:231], v[156:159], v[68:71]
    ds_read_b64_tr_b16 a[186:187], v25 offset:20480
    v_mfma_f32_16x16x32_bf16 v[68:71], a[232:235], v[204:207], v[68:71]
    ds_read_b64_tr_b16 a[188:189], v25 offset:24576
    v_mfma_f32_16x16x32_bf16 v[68:71], a[236:239], v[188:191], v[68:71]
    s_waitcnt lgkmcnt(13)
    ds_read_b64_tr_b16 a[190:191], v25 offset:28672
    v_mfma_f32_16x16x32_bf16 v[72:75], a[160:163], v[128:131], 0
    s_waitcnt lgkmcnt(12)
    buffer_load_dwordx4 v48, s[20:23], s49 offen offset:2048 lds
    v_mfma_f32_16x16x32_bf16 v[72:75], a[164:167], v[144:147], v[72:75]
    s_waitcnt lgkmcnt(10)
    ds_read_b64_tr_b16 a[208:209], v22 offset:0
    ds_read_b64_tr_b16 a[210:211], v22 offset:4096
    v_mfma_f32_16x16x32_bf16 v[72:75], a[168:171], v[192:195], v[72:75]
    s_waitcnt lgkmcnt(10)
    buffer_load_dwordx4 v49, s[20:23], s49 offen offset:3072 lds
    v_mfma_f32_16x16x32_bf16 v[72:75], a[172:175], v[176:179], v[72:75]
    s_waitcnt lgkmcnt(8)
    ds_read_b64_tr_b16 a[212:213], v22 offset:8192
    ds_read_b64_tr_b16 a[214:215], v22 offset:12288
    v_mfma_f32_16x16x32_bf16 v[72:75], a[176:179], v[136:139], v[72:75]
    s_waitcnt lgkmcnt(8)
    ds_read_b64_tr_b16 a[216:217], v22 offset:16384
    v_mfma_f32_16x16x32_bf16 v[72:75], a[180:183], v[152:155], v[72:75]
    s_waitcnt lgkmcnt(7)
    ds_read_b64_tr_b16 a[218:219], v22 offset:20480
    v_mfma_f32_16x16x32_bf16 v[72:75], a[184:187], v[200:203], v[72:75]
    s_waitcnt lgkmcnt(6)
    ds_read_b64_tr_b16 a[220:221], v22 offset:24576
    v_mfma_f32_16x16x32_bf16 v[72:75], a[188:191], v[184:187], v[72:75]
    ds_read_b64_tr_b16 a[222:223], v22 offset:28672
    v_mfma_f32_16x16x32_bf16 v[76:79], a[160:163], v[132:135], 0
    ds_read_b64_tr_b16 a[224:225], v26 offset:0
    v_mfma_f32_16x16x32_bf16 v[76:79], a[164:167], v[148:151], v[76:79]
    ds_read_b64_tr_b16 a[226:227], v26 offset:4096
    v_mfma_f32_16x16x32_bf16 v[76:79], a[168:171], v[196:199], v[76:79]
    ds_read_b64_tr_b16 a[228:229], v26 offset:8192
    v_mfma_f32_16x16x32_bf16 v[76:79], a[172:175], v[180:183], v[76:79]
    ds_read_b64_tr_b16 a[230:231], v26 offset:12288
    v_mfma_f32_16x16x32_bf16 v[76:79], a[176:179], v[140:143], v[76:79]
    ds_read_b64_tr_b16 a[232:233], v26 offset:16384
    v_mfma_f32_16x16x32_bf16 v[76:79], a[180:183], v[156:159], v[76:79]
    ds_read_b64_tr_b16 a[234:235], v26 offset:20480
    v_mfma_f32_16x16x32_bf16 v[76:79], a[184:187], v[204:207], v[76:79]
    buffer_load_dword v63, v63, s[88:91], 0 offen sc1
    v_mfma_f32_16x16x32_bf16 v[76:79], a[188:191], v[188:191], v[76:79]
    s_waitcnt lgkmcnt(12)
    ds_read_b64_tr_b16 a[236:237], v26 offset:24576
    ds_read_b64_tr_b16 a[238:239], v26 offset:28672
    v_mfma_f32_16x16x32_bf16 v[80:83], a[208:211], v[128:131], 0
    s_waitcnt lgkmcnt(12)
    ds_read_b64_tr_b16 a[160:161], v23 offset:0
    v_mfma_f32_16x16x32_bf16 v[80:83], a[212:215], v[144:147], v[80:83]
    s_waitcnt lgkmcnt(11)
    ds_read_b64_tr_b16 a[162:163], v23 offset:4096
    v_mfma_f32_16x16x32_bf16 v[80:83], a[216:219], v[192:195], v[80:83]
    s_waitcnt lgkmcnt(10)
    ds_read_b64_tr_b16 a[164:165], v23 offset:8192
    v_mfma_f32_16x16x32_bf16 v[80:83], a[220:223], v[176:179], v[80:83]
    s_waitcnt lgkmcnt(9)
    ds_read_b64_tr_b16 a[166:167], v23 offset:12288
    v_mfma_f32_16x16x32_bf16 v[80:83], a[224:227], v[136:139], v[80:83]
    s_waitcnt lgkmcnt(8)
    ds_read_b64_tr_b16 a[168:169], v23 offset:16384
    v_mfma_f32_16x16x32_bf16 v[80:83], a[228:231], v[152:155], v[80:83]
    s_waitcnt lgkmcnt(7)
    ds_read_b64_tr_b16 a[170:171], v23 offset:20480
    v_mfma_f32_16x16x32_bf16 v[80:83], a[232:235], v[200:203], v[80:83]
    s_waitcnt lgkmcnt(6)
    ds_read_b64_tr_b16 a[172:173], v23 offset:24576
    v_mfma_f32_16x16x32_bf16 v[80:83], a[236:239], v[184:187], v[80:83]
    ds_read_b64_tr_b16 a[174:175], v23 offset:28672
    v_mfma_f32_16x16x32_bf16 v[84:87], a[208:211], v[132:135], 0
    ds_read_b64_tr_b16 a[176:177], v27 offset:0
    v_mfma_f32_16x16x32_bf16 v[84:87], a[212:215], v[148:151], v[84:87]
    ds_read_b64_tr_b16 a[178:179], v27 offset:4096
    v_mfma_f32_16x16x32_bf16 v[84:87], a[216:219], v[196:199], v[84:87]
    ds_read_b64_tr_b16 a[180:181], v27 offset:8192
    v_mfma_f32_16x16x32_bf16 v[84:87], a[220:223], v[180:183], v[84:87]
    ds_read_b64_tr_b16 a[182:183], v27 offset:12288
    v_mfma_f32_16x16x32_bf16 v[84:87], a[224:227], v[140:143], v[84:87]
    ds_read_b64_tr_b16 a[184:185], v27 offset:16384
    v_mfma_f32_16x16x32_bf16 v[84:87], a[228:231], v[156:159], v[84:87]
    ds_read_b64_tr_b16 a[186:187], v27 offset:20480
    v_mfma_f32_16x16x32_bf16 v[84:87], a[232:235], v[204:207], v[84:87]
    ds_read_b64_tr_b16 a[188:189], v27 offset:24576
    v_mfma_f32_16x16x32_bf16 v[84:87], a[236:239], v[188:191], v[84:87]
    s_waitcnt lgkmcnt(13)
    ds_read_b64_tr_b16 a[190:191], v27 offset:28672
    s_waitcnt vmcnt(13)
    s_barrier
    v_mfma_f32_16x16x32_bf16 v[88:91], a[160:163], v[128:131], 0
    s_waitcnt lgkmcnt(12)
    ds_read_b64_tr_b16 a[208:209], v12 offset:32768
    v_mfma_f32_16x16x32_bf16 v[88:91], a[164:167], v[144:147], v[88:91]
    s_waitcnt lgkmcnt(11)
    ds_read_b64_tr_b16 a[210:211], v12 offset:36864
    v_mfma_f32_16x16x32_bf16 v[88:91], a[168:171], v[192:195], v[88:91]
    s_waitcnt lgkmcnt(10)
    ds_read_b64_tr_b16 a[212:213], v12 offset:40960
    v_mfma_f32_16x16x32_bf16 v[88:91], a[172:175], v[176:179], v[88:91]
    s_waitcnt lgkmcnt(9)
    ds_read_b64_tr_b16 a[214:215], v12 offset:45056
    v_mfma_f32_16x16x32_bf16 v[88:91], a[176:179], v[136:139], v[88:91]
    s_waitcnt lgkmcnt(8)
    ds_read_b64_tr_b16 a[216:217], v12 offset:49152
    v_mfma_f32_16x16x32_bf16 v[88:91], a[180:183], v[152:155], v[88:91]
    s_waitcnt lgkmcnt(7)
    ds_read_b64_tr_b16 a[218:219], v12 offset:53248
    v_mfma_f32_16x16x32_bf16 v[88:91], a[184:187], v[200:203], v[88:91]
    s_waitcnt lgkmcnt(6)
    s_add_u32 s49, s46, 768
    ds_read_b64_tr_b16 a[220:221], v12 offset:57344
    v_mfma_f32_16x16x32_bf16 v[88:91], a[188:191], v[184:187], v[88:91]
    s_add_u32 m0, s42, 0
    ds_read_b64_tr_b16 a[222:223], v12 offset:61440
    v_mfma_f32_16x16x32_bf16 v[92:95], a[160:163], v[132:135], 0
    buffer_load_dwordx4 v46, s[20:23], s49 offen lds
    v_mfma_f32_16x16x32_bf16 v[92:95], a[164:167], v[148:151], v[92:95]
    ds_read_b64_tr_b16 a[224:225], v16 offset:32768
    ds_read_b64_tr_b16 a[226:227], v16 offset:36864
    v_mfma_f32_16x16x32_bf16 v[92:95], a[168:171], v[196:199], v[92:95]
    buffer_load_dwordx4 v47, s[20:23], s49 offen offset:1024 lds
    v_mfma_f32_16x16x32_bf16 v[92:95], a[172:175], v[180:183], v[92:95]
    ds_read_b64_tr_b16 a[228:229], v16 offset:40960
    ds_read_b64_tr_b16 a[230:231], v16 offset:45056
    v_mfma_f32_16x16x32_bf16 v[92:95], a[176:179], v[140:143], v[92:95]
    ds_read_b64_tr_b16 a[232:233], v16 offset:49152
    v_mfma_f32_16x16x32_bf16 v[92:95], a[180:183], v[156:159], v[92:95]
    ds_read_b64_tr_b16 a[234:235], v16 offset:53248
    v_mfma_f32_16x16x32_bf16 v[92:95], a[184:187], v[204:207], v[92:95]
    ds_read_b64_tr_b16 a[236:237], v16 offset:57344
    v_mfma_f32_16x16x32_bf16 v[92:95], a[188:191], v[188:191], v[92:95]
    s_waitcnt lgkmcnt(13)
    ds_read_b64_tr_b16 a[238:239], v16 offset:61440
    v_mfma_f32_16x16x32_bf16 v[64:67], a[208:211], a[64:67], v[64:67]
    s_waitcnt lgkmcnt(12)
    buffer_load_dwordx4 v48, s[20:23], s49 offen offset:2048 lds
    v_mfma_f32_16x16x32_bf16 v[64:67], a[212:215], a[68:71], v[64:67]
    s_waitcnt lgkmcnt(10)
    ds_read_b64_tr_b16 a[160:161], v13 offset:32768
    ds_read_b64_tr_b16 a[162:163], v13 offset:36864
    v_mfma_f32_16x16x32_bf16 v[64:67], a[216:219], a[72:75], v[64:67]
    s_waitcnt lgkmcnt(10)
    s_add_u32 s92, s92, 16
    buffer_load_dwordx4 v49, s[20:23], s49 offen offset:3072 lds
    v_mfma_f32_16x16x32_bf16 v[64:67], a[220:223], a[76:79], v[64:67]
    s_waitcnt lgkmcnt(8)
    s_waitcnt vmcnt(9)
    ds_read_b64_tr_b16 a[164:165], v13 offset:40960
    ds_read_b64_tr_b16 a[166:167], v13 offset:45056
    v_mfma_f32_16x16x32_bf16 v[64:67], a[224:227], a[80:83], v[64:67]
    s_waitcnt lgkmcnt(8)
    buffer_store_dword v10, v8, s[24:27], s92 offen sc1
    v_mfma_f32_16x16x32_bf16 v[64:67], a[228:231], a[84:87], v[64:67]
    s_waitcnt lgkmcnt(6)
    ds_read_b64_tr_b16 a[168:169], v13 offset:49152
    ds_read_b64_tr_b16 a[170:171], v13 offset:53248
    v_mfma_f32_16x16x32_bf16 v[64:67], a[232:235], a[88:91], v[64:67]
    s_waitcnt lgkmcnt(6)
    s_add_u32 s49, s46, 74496
    ds_read_b64_tr_b16 a[172:173], v13 offset:57344
    v_mfma_f32_16x16x32_bf16 v[64:67], a[236:239], a[92:95], v[64:67]
    s_add_u32 m0, s42, 16384
    ds_read_b64_tr_b16 a[174:175], v13 offset:61440
    v_mfma_f32_16x16x32_bf16 v[68:71], a[208:211], a[96:99], v[68:71]
    buffer_load_dwordx4 v46, s[20:23], s49 offen lds
    v_mfma_f32_16x16x32_bf16 v[68:71], a[212:215], a[100:103], v[68:71]
    ds_read_b64_tr_b16 a[176:177], v17 offset:32768
    ds_read_b64_tr_b16 a[178:179], v17 offset:36864
    v_mfma_f32_16x16x32_bf16 v[68:71], a[216:219], a[104:107], v[68:71]
    buffer_load_dwordx4 v47, s[20:23], s49 offen offset:1024 lds
    v_mfma_f32_16x16x32_bf16 v[68:71], a[220:223], a[108:111], v[68:71]
    ds_read_b64_tr_b16 a[180:181], v17 offset:40960
    ds_read_b64_tr_b16 a[182:183], v17 offset:45056
    v_mfma_f32_16x16x32_bf16 v[68:71], a[224:227], a[112:115], v[68:71]
    ds_read_b64_tr_b16 a[184:185], v17 offset:49152
    v_cvt_pk_bf16_f32 v224, v64, v65
    v_mfma_f32_16x16x32_bf16 v[68:71], a[228:231], a[116:119], v[68:71]
    ds_read_b64_tr_b16 a[186:187], v17 offset:53248
    v_cvt_pk_bf16_f32 v225, v66, v67
    v_mfma_f32_16x16x32_bf16 v[68:71], a[232:235], a[120:123], v[68:71]
    ds_read_b64_tr_b16 a[188:189], v17 offset:57344
    v_mfma_f32_16x16x32_bf16 v[68:71], a[236:239], a[124:127], v[68:71]
    s_waitcnt lgkmcnt(13)
    ds_read_b64_tr_b16 a[190:191], v17 offset:61440
    v_mfma_f32_16x16x32_bf16 v[72:75], a[160:163], a[64:67], v[72:75]
    s_waitcnt lgkmcnt(12)
    buffer_load_dwordx4 v48, s[20:23], s49 offen offset:2048 lds
    v_mfma_f32_16x16x32_bf16 v[72:75], a[164:167], a[68:71], v[72:75]
    s_waitcnt lgkmcnt(10)
    ds_read_b64_tr_b16 a[208:209], v14 offset:32768
    ds_read_b64_tr_b16 a[210:211], v14 offset:36864
    v_mfma_f32_16x16x32_bf16 v[72:75], a[168:171], a[72:75], v[72:75]
    s_waitcnt lgkmcnt(10)
    buffer_load_dwordx4 v49, s[20:23], s49 offen offset:3072 lds
    v_mfma_f32_16x16x32_bf16 v[72:75], a[172:175], a[76:79], v[72:75]
    s_waitcnt lgkmcnt(8)
    ds_read_b64_tr_b16 a[212:213], v14 offset:40960
    ds_read_b64_tr_b16 a[214:215], v14 offset:45056
    v_mfma_f32_16x16x32_bf16 v[72:75], a[176:179], a[80:83], v[72:75]
    s_waitcnt lgkmcnt(8)
    ds_read_b64_tr_b16 a[216:217], v14 offset:49152
    v_cvt_pk_bf16_f32 v228, v68, v69
    v_mfma_f32_16x16x32_bf16 v[72:75], a[180:183], a[84:87], v[72:75]
    s_waitcnt lgkmcnt(7)
    ds_read_b64_tr_b16 a[218:219], v14 offset:53248
    v_cvt_pk_bf16_f32 v229, v70, v71
    v_mfma_f32_16x16x32_bf16 v[72:75], a[184:187], a[88:91], v[72:75]
    s_waitcnt lgkmcnt(6)
    s_and_b32 s42, s2, 7
    ds_read_b64_tr_b16 a[220:221], v14 offset:57344
    v_mfma_f32_16x16x32_bf16 v[72:75], a[188:191], a[92:95], v[72:75]
    s_mov_b64 s[20:21], s[52:53]
    ds_read_b64_tr_b16 a[222:223], v14 offset:61440
    v_mfma_f32_16x16x32_bf16 v[76:79], a[160:163], a[96:99], v[76:79]
    ds_read_b64_tr_b16 a[224:225], v18 offset:32768
    s_waitcnt vmcnt(9)
    v_readfirstlane_b32 s37, v63
    v_mfma_f32_16x16x32_bf16 v[76:79], a[164:167], a[100:103], v[76:79]
    s_mov_b32 s22, 1152
    ds_read_b64_tr_b16 a[226:227], v18 offset:36864
    v_mfma_f32_16x16x32_bf16 v[76:79], a[168:171], a[104:107], v[76:79]
    s_mov_b32 s23, 0x20000
    ds_read_b64_tr_b16 a[228:229], v18 offset:40960
    s_cmp_lt_u32 s37, 256
    s_cbranch_scc1 Lattn_armwait
Lattn_armed:
    v_mfma_f32_16x16x32_bf16 v[76:79], a[172:175], a[108:111], v[76:79]
    ds_read_b64_tr_b16 a[230:231], v18 offset:45056
    v_mfma_f32_16x16x32_bf16 v[76:79], a[176:179], a[112:115], v[76:79]
    ds_read_b64_tr_b16 a[232:233], v18 offset:49152
    v_cvt_pk_bf16_f32 v226, v72, v73
    v_mfma_f32_16x16x32_bf16 v[76:79], a[180:183], a[116:119], v[76:79]
    s_add_u32 s38, s93, 1024
    ds_read_b64_tr_b16 a[234:235], v18 offset:53248
    v_cvt_pk_bf16_f32 v227, v74, v75
    v_mfma_f32_16x16x32_bf16 v[76:79], a[184:187], a[120:123], v[76:79]
    buffer_store_dwordx4 v[224:227], v56, s[28:31], s38 offen sc1
    v_mfma_f32_16x16x32_bf16 v[76:79], a[188:191], a[124:127], v[76:79]
    s_waitcnt lgkmcnt(12)
    s_mov_b32 s45, 18688
    ds_read_b64_tr_b16 a[236:237], v18 offset:57344
    ds_read_b64_tr_b16 a[238:239], v18 offset:61440
    v_mfma_f32_16x16x32_bf16 v[80:83], a[208:211], a[64:67], v[80:83]
    s_waitcnt lgkmcnt(12)
    buffer_load_dwordx4 v[160:163], v5, s[24:27], s45 offen offset:0 sc1
    v_mfma_f32_16x16x32_bf16 v[80:83], a[212:215], a[68:71], v[80:83]
    s_waitcnt lgkmcnt(10)
    ds_read_b64_tr_b16 a[160:161], v15 offset:32768
    ds_read_b64_tr_b16 a[162:163], v15 offset:36864
    v_mfma_f32_16x16x32_bf16 v[80:83], a[216:219], a[72:75], v[80:83]
    s_waitcnt lgkmcnt(10)
    buffer_load_dwordx4 v[164:167], v5, s[24:27], s45 offen offset:512 sc1
    v_mfma_f32_16x16x32_bf16 v[80:83], a[220:223], a[76:79], v[80:83]
    s_waitcnt lgkmcnt(8)
    ds_read_b64_tr_b16 a[164:165], v15 offset:40960
    ds_read_b64_tr_b16 a[166:167], v15 offset:45056
    v_mfma_f32_16x16x32_bf16 v[80:83], a[224:227], a[80:83], v[80:83]
    s_waitcnt lgkmcnt(8)
    ds_read_b64_tr_b16 a[168:169], v15 offset:49152
    v_cvt_pk_bf16_f32 v230, v76, v77
    v_mfma_f32_16x16x32_bf16 v[80:83], a[228:231], a[84:87], v[80:83]
    s_waitcnt lgkmcnt(7)
    s_add_u32 s38, s93, 164864
    ds_read_b64_tr_b16 a[170:171], v15 offset:53248
    v_cvt_pk_bf16_f32 v231, v78, v79
    v_mfma_f32_16x16x32_bf16 v[80:83], a[232:235], a[88:91], v[80:83]
    s_waitcnt lgkmcnt(6)
    buffer_store_dwordx4 v[228:231], v56, s[28:31], s38 offen sc1
    v_mfma_f32_16x16x32_bf16 v[80:83], a[236:239], a[92:95], v[80:83]
    ds_read_b64_tr_b16 a[172:173], v15 offset:57344
    ds_read_b64_tr_b16 a[174:175], v15 offset:61440
    v_mfma_f32_16x16x32_bf16 v[84:87], a[208:211], a[96:99], v[84:87]
    ds_read_b64_tr_b16 a[176:177], v19 offset:32768
    v_mfma_f32_16x16x32_bf16 v[84:87], a[212:215], a[100:103], v[84:87]
    ds_read_b64_tr_b16 a[178:179], v19 offset:36864
    v_mfma_f32_16x16x32_bf16 v[84:87], a[216:219], a[104:107], v[84:87]
    buffer_load_dwordx4 v[168:171], v59, s[24:27], s45 offen offset:1024 sc1
    v_mfma_f32_16x16x32_bf16 v[84:87], a[220:223], a[108:111], v[84:87]
    ds_read_b64_tr_b16 a[180:181], v19 offset:40960
    ds_read_b64_tr_b16 a[182:183], v19 offset:45056
    v_mfma_f32_16x16x32_bf16 v[84:87], a[224:227], a[112:115], v[84:87]
    ds_read_b64_tr_b16 a[184:185], v19 offset:49152
    v_cvt_pk_bf16_f32 v232, v80, v81
    v_mfma_f32_16x16x32_bf16 v[84:87], a[228:231], a[116:119], v[84:87]
    s_mov_b32 s45, 20992
    ds_read_b64_tr_b16 a[186:187], v19 offset:53248
    v_cvt_pk_bf16_f32 v233, v82, v83
    v_mfma_f32_16x16x32_bf16 v[84:87], a[232:235], a[120:123], v[84:87]
    buffer_load_dwordx4 v[172:175], v5, s[24:27], s45 offen offset:0 sc1
    v_mfma_f32_16x16x32_bf16 v[84:87], a[236:239], a[124:127], v[84:87]
    s_waitcnt lgkmcnt(12)
    ds_read_b64_tr_b16 a[188:189], v19 offset:57344
    ds_read_b64_tr_b16 a[190:191], v19 offset:61440
    s_barrier
    v_mfma_f32_16x16x32_bf16 v[88:91], a[160:163], a[64:67], v[88:91]
    s_waitcnt lgkmcnt(12)
    ds_read_b64_tr_b16 a[208:209], v20 offset:32768
    v_mfma_f32_16x16x32_bf16 v[88:91], a[164:167], a[68:71], v[88:91]
    s_waitcnt lgkmcnt(11)
    ds_read_b64_tr_b16 a[210:211], v20 offset:36864
    v_mfma_f32_16x16x32_bf16 v[88:91], a[168:171], a[72:75], v[88:91]
    s_waitcnt lgkmcnt(10)
    buffer_load_dwordx4 v[208:211], v5, s[24:27], s45 offen offset:512 sc1
    v_mfma_f32_16x16x32_bf16 v[88:91], a[172:175], a[76:79], v[88:91]
    s_waitcnt lgkmcnt(8)
    ds_read_b64_tr_b16 a[212:213], v20 offset:40960
    ds_read_b64_tr_b16 a[214:215], v20 offset:45056
    v_mfma_f32_16x16x32_bf16 v[88:91], a[176:179], a[80:83], v[88:91]
    s_waitcnt lgkmcnt(8)
    s_add_u32 s57, s59, 4096
    ds_read_b64_tr_b16 a[216:217], v20 offset:49152
    v_cvt_pk_bf16_f32 v236, v84, v85
    v_mfma_f32_16x16x32_bf16 v[88:91], a[180:183], a[84:87], v[88:91]
    s_waitcnt lgkmcnt(7)
    s_add_u32 m0, s6, -98304
    ds_read_b64_tr_b16 a[218:219], v20 offset:53248
    v_cvt_pk_bf16_f32 v237, v86, v87
    v_mfma_f32_16x16x32_bf16 v[88:91], a[184:187], a[88:91], v[88:91]
    s_waitcnt lgkmcnt(6)
    buffer_load_dwordx4 v255, s[84:87], s57 offen lds
    v_mfma_f32_16x16x32_bf16 v[88:91], a[188:191], a[92:95], v[88:91]
    ds_read_b64_tr_b16 a[220:221], v20 offset:57344
    ds_read_b64_tr_b16 a[222:223], v20 offset:61440
    v_mfma_f32_16x16x32_bf16 v[92:95], a[160:163], a[96:99], v[92:95]
    s_add_u32 s57, s59, 8192
    buffer_load_dwordx4 v[212:215], v59, s[24:27], s45 offen offset:1024 sc1
    v_mfma_f32_16x16x32_bf16 v[92:95], a[164:167], a[100:103], v[92:95]
    s_add_u32 m0, s6, -94208
    ds_read_b64_tr_b16 a[224:225], v24 offset:32768
    ds_read_b64_tr_b16 a[226:227], v24 offset:36864
    v_mfma_f32_16x16x32_bf16 v[92:95], a[168:171], a[104:107], v[92:95]
    buffer_load_dwordx4 v255, s[84:87], s57 offen lds
    v_mfma_f32_16x16x32_bf16 v[92:95], a[172:175], a[108:111], v[92:95]
    ds_read_b64_tr_b16 a[228:229], v24 offset:40960
    ds_read_b64_tr_b16 a[230:231], v24 offset:45056
    v_mfma_f32_16x16x32_bf16 v[92:95], a[176:179], a[112:115], v[92:95]
    ds_read_b64_tr_b16 a[232:233], v24 offset:49152
    v_cvt_pk_bf16_f32 v234, v88, v89
    v_mfma_f32_16x16x32_bf16 v[92:95], a[180:183], a[116:119], v[92:95]
    s_add_u32 s38, s93, 1152
    ds_read_b64_tr_b16 a[234:235], v24 offset:53248
    v_cvt_pk_bf16_f32 v235, v90, v91
    v_mfma_f32_16x16x32_bf16 v[92:95], a[184:187], a[120:123], v[92:95]
    buffer_store_dwordx4 v[232:235], v56, s[28:31], s38 offen sc1
    v_mfma_f32_16x16x32_bf16 v[92:95], a[188:191], a[124:127], v[92:95]
    s_waitcnt lgkmcnt(12)
    ds_read_b64_tr_b16 a[236:237], v24 offset:57344
    ds_read_b64_tr_b16 a[238:239], v24 offset:61440
    v_mfma_f32_16x16x32_bf16 v[96:99], a[208:211], v[128:131], 0
    s_waitcnt lgkmcnt(12)
    s_add_u32 s57, s59, 12288
    ds_read_b64_tr_b16 a[160:161], v21 offset:32768
    v_mfma_f32_16x16x32_bf16 v[96:99], a[212:215], v[144:147], v[96:99]
    s_waitcnt lgkmcnt(11)
    s_add_u32 m0, s6, -90112
    ds_read_b64_tr_b16 a[162:163], v21 offset:36864
    v_mfma_f32_16x16x32_bf16 v[96:99], a[216:219], v[192:195], v[96:99]
    s_waitcnt lgkmcnt(10)
    buffer_load_dwordx4 v255, s[84:87], s57 offen lds
    v_mfma_f32_16x16x32_bf16 v[96:99], a[220:223], v[176:179], v[96:99]
    s_waitcnt lgkmcnt(8)
    ds_read_b64_tr_b16 a[164:165], v21 offset:40960
    ds_read_b64_tr_b16 a[166:167], v21 offset:45056
    v_mfma_f32_16x16x32_bf16 v[96:99], a[224:227], v[136:139], v[96:99]
    s_waitcnt lgkmcnt(8)
    ds_read_b64_tr_b16 a[168:169], v21 offset:49152
    v_cvt_pk_bf16_f32 v238, v92, v93
    v_mfma_f32_16x16x32_bf16 v[96:99], a[228:231], v[152:155], v[96:99]
    s_waitcnt lgkmcnt(7)
    s_add_u32 s38, s93, 164992
    ds_read_b64_tr_b16 a[170:171], v21 offset:53248
    v_cvt_pk_bf16_f32 v239, v94, v95
    v_mfma_f32_16x16x32_bf16 v[96:99], a[232:235], v[200:203], v[96:99]
    s_waitcnt lgkmcnt(6)
    buffer_store_dwordx4 v[236:239], v56, s[28:31], s38 offen sc1
    v_mfma_f32_16x16x32_bf16 v[96:99], a[236:239], v[184:187], v[96:99]
    ds_read_b64_tr_b16 a[172:173], v21 offset:57344
    ds_read_b64_tr_b16 a[174:175], v21 offset:61440
    v_mfma_f32_16x16x32_bf16 v[100:103], a[208:211], v[132:135], 0
    s_add_u32 s57, s59, 16384
    buffer_load_dwordx2 v[92:93], v58, s[12:15], 0 offen offset:1024
    v_mfma_f32_16x16x32_bf16 v[100:103], a[212:215], v[148:151], v[100:103]
    s_add_u32 m0, s6, -86016
    ds_read_b64_tr_b16 a[176:177], v25 offset:32768
    ds_read_b64_tr_b16 a[178:179], v25 offset:36864
    v_mfma_f32_16x16x32_bf16 v[100:103], a[216:219], v[196:199], v[100:103]
    buffer_load_dwordx4 v255, s[84:87], s57 offen lds
    v_mfma_f32_16x16x32_bf16 v[100:103], a[220:223], v[180:183], v[100:103]
    ds_read_b64_tr_b16 a[180:181], v25 offset:40960
    ds_read_b64_tr_b16 a[182:183], v25 offset:45056
    v_mfma_f32_16x16x32_bf16 v[100:103], a[224:227], v[140:143], v[100:103]
    ds_read_b64_tr_b16 a[184:185], v25 offset:49152
    v_mfma_f32_16x16x32_bf16 v[100:103], a[228:231], v[156:159], v[100:103]
    ds_read_b64_tr_b16 a[186:187], v25 offset:53248
    v_mfma_f32_16x16x32_bf16 v[100:103], a[232:235], v[204:207], v[100:103]
    buffer_load_dwordx2 v[94:95], v58, s[12:15], 0 offen offset:1056
    v_mfma_f32_16x16x32_bf16 v[100:103], a[236:239], v[188:191], v[100:103]
    s_waitcnt lgkmcnt(12)
    ds_read_b64_tr_b16 a[188:189], v25 offset:57344
    ds_read_b64_tr_b16 a[190:191], v25 offset:61440
    v_mfma_f32_16x16x32_bf16 v[104:107], a[160:163], v[128:131], 0
    s_waitcnt lgkmcnt(12)
    s_add_u32 s57, s59, 20480
    ds_read_b64_tr_b16 a[208:209], v22 offset:32768
    v_mfma_f32_16x16x32_bf16 v[104:107], a[164:167], v[144:147], v[104:107]
    s_waitcnt lgkmcnt(11)
    s_add_u32 m0, s6, -81920
    ds_read_b64_tr_b16 a[210:211], v22 offset:36864
    v_mfma_f32_16x16x32_bf16 v[104:107], a[168:171], v[192:195], v[104:107]
    s_waitcnt lgkmcnt(10)
    buffer_load_dwordx4 v255, s[84:87], s57 offen lds
    v_mfma_f32_16x16x32_bf16 v[104:107], a[172:175], v[176:179], v[104:107]
    s_waitcnt lgkmcnt(8)
    s_mov_b32 s45, 19840
    ds_read_b64_tr_b16 a[212:213], v22 offset:40960
    ds_read_b64_tr_b16 a[214:215], v22 offset:45056
    v_mfma_f32_16x16x32_bf16 v[104:107], a[176:179], v[136:139], v[104:107]
    s_waitcnt lgkmcnt(8)
    s_add_u32 s57, s59, 24576
    buffer_load_dwordx4 v[64:67], v5, s[24:27], s45 offen offset:0 sc1
    v_mfma_f32_16x16x32_bf16 v[104:107], a[180:183], v[152:155], v[104:107]
    s_waitcnt lgkmcnt(6)
    s_add_u32 m0, s6, -77824
    ds_read_b64_tr_b16 a[216:217], v22 offset:49152
    ds_read_b64_tr_b16 a[218:219], v22 offset:53248
    v_mfma_f32_16x16x32_bf16 v[104:107], a[184:187], v[200:203], v[104:107]
    s_waitcnt lgkmcnt(6)
    buffer_load_dwordx4 v255, s[84:87], s57 offen lds
    v_mfma_f32_16x16x32_bf16 v[104:107], a[188:191], v[184:187], v[104:107]
    ds_read_b64_tr_b16 a[220:221], v22 offset:57344
    ds_read_b64_tr_b16 a[222:223], v22 offset:61440
    v_mfma_f32_16x16x32_bf16 v[108:111], a[160:163], v[132:135], 0
    s_add_u32 s57, s59, 28672
    ds_read_b64_tr_b16 a[224:225], v26 offset:32768
    v_mfma_f32_16x16x32_bf16 v[108:111], a[164:167], v[148:151], v[108:111]
    s_add_u32 m0, s6, -73728
    ds_read_b64_tr_b16 a[226:227], v26 offset:36864
    v_mfma_f32_16x16x32_bf16 v[108:111], a[168:171], v[196:199], v[108:111]
    buffer_load_dwordx4 v255, s[84:87], s57 offen lds
    v_mfma_f32_16x16x32_bf16 v[108:111], a[172:175], v[180:183], v[108:111]
    ds_read_b64_tr_b16 a[228:229], v26 offset:40960
    ds_read_b64_tr_b16 a[230:231], v26 offset:45056
    v_mfma_f32_16x16x32_bf16 v[108:111], a[176:179], v[140:143], v[108:111]
    s_add_u32 s57, s59, 32768
    buffer_load_dwordx4 v[68:71], v5, s[24:27], s45 offen offset:512 sc1
    v_mfma_f32_16x16x32_bf16 v[108:111], a[180:183], v[156:159], v[108:111]
    s_add_u32 m0, s6, -69632
    ds_read_b64_tr_b16 a[232:233], v26 offset:49152
    ds_read_b64_tr_b16 a[234:235], v26 offset:53248
    v_mfma_f32_16x16x32_bf16 v[108:111], a[184:187], v[204:207], v[108:111]
    buffer_load_dwordx4 v255, s[84:87], s57 offen lds
    v_mfma_f32_16x16x32_bf16 v[108:111], a[188:191], v[188:191], v[108:111]
    s_waitcnt lgkmcnt(12)
    ds_read_b64_tr_b16 a[236:237], v26 offset:57344
    ds_read_b64_tr_b16 a[238:239], v26 offset:61440
    v_mfma_f32_16x16x32_bf16 v[112:115], a[208:211], v[128:131], 0
    s_waitcnt lgkmcnt(12)
    ds_read_b64_tr_b16 a[160:161], v23 offset:32768
    v_mfma_f32_16x16x32_bf16 v[112:115], a[212:215], v[144:147], v[112:115]
    s_waitcnt lgkmcnt(11)
    ds_read_b64_tr_b16 a[162:163], v23 offset:36864
    v_mfma_f32_16x16x32_bf16 v[112:115], a[216:219], v[192:195], v[112:115]
    s_waitcnt lgkmcnt(10)
    ds_read_b64_tr_b16 a[164:165], v23 offset:40960
    v_mfma_f32_16x16x32_bf16 v[112:115], a[220:223], v[176:179], v[112:115]
    s_waitcnt lgkmcnt(9)
    ds_read_b64_tr_b16 a[166:167], v23 offset:45056
    v_mfma_f32_16x16x32_bf16 v[112:115], a[224:227], v[136:139], v[112:115]
    s_waitcnt lgkmcnt(8)
    buffer_load_dwordx4 v[72:75], v59, s[24:27], s45 offen offset:1024 sc1
    v_mfma_f32_16x16x32_bf16 v[112:115], a[228:231], v[152:155], v[112:115]
    s_waitcnt lgkmcnt(6)
    ds_read_b64_tr_b16 a[168:169], v23 offset:49152
    ds_read_b64_tr_b16 a[170:171], v23 offset:53248
    v_mfma_f32_16x16x32_bf16 v[112:115], a[232:235], v[200:203], v[112:115]
    s_waitcnt lgkmcnt(6)
    ds_read_b64_tr_b16 a[172:173], v23 offset:57344
    v_mfma_f32_16x16x32_bf16 v[112:115], a[236:239], v[184:187], v[112:115]
    ds_read_b64_tr_b16 a[174:175], v23 offset:61440
    v_mfma_f32_16x16x32_bf16 v[116:119], a[208:211], v[132:135], 0
    buffer_load_dwordx2 v[76:77], v3, s[20:23], 0 offen offset:0
    v_mfma_f32_16x16x32_bf16 v[116:119], a[212:215], v[148:151], v[116:119]
    ds_read_b64_tr_b16 a[176:177], v27 offset:32768
    ds_read_b64_tr_b16 a[178:179], v27 offset:36864
    v_mfma_f32_16x16x32_bf16 v[116:119], a[216:219], v[196:199], v[116:119]
    ds_read_b64_tr_b16 a[180:181], v27 offset:40960
    v_mfma_f32_16x16x32_bf16 v[116:119], a[220:223], v[180:183], v[116:119]
    ds_read_b64_tr_b16 a[182:183], v27 offset:45056
    v_mfma_f32_16x16x32_bf16 v[116:119], a[224:227], v[140:143], v[116:119]
    buffer_load_dwordx2 v[78:79], v3, s[20:23], 0 offen offset:32
    v_mfma_f32_16x16x32_bf16 v[116:119], a[228:231], v[156:159], v[116:119]
    ds_read_b64_tr_b16 a[184:185], v27 offset:49152
    ds_read_b64_tr_b16 a[186:187], v27 offset:53248
    v_mfma_f32_16x16x32_bf16 v[116:119], a[232:235], v[204:207], v[116:119]
    ds_read_b64_tr_b16 a[188:189], v27 offset:57344
    v_mfma_f32_16x16x32_bf16 v[116:119], a[236:239], v[188:191], v[116:119]
    ds_read_b64_tr_b16 a[190:191], v27 offset:61440
    s_waitcnt vmcnt(25)
    s_waitcnt lgkmcnt(0)
    s_barrier
    v_mfma_f32_16x16x32_bf16 v[120:123], a[160:163], v[128:131], 0
    ds_read_b64_tr_b16 a[208:209], v12 offset:0
    v_mfma_f32_16x16x32_bf16 v[120:123], a[164:167], v[144:147], v[120:123]
    ds_read_b64_tr_b16 a[210:211], v12 offset:4096
    v_mfma_f32_16x16x32_bf16 v[120:123], a[168:171], v[192:195], v[120:123]
    buffer_load_dwordx2 v[80:81], v3, s[20:23], 0 offen offset:512
    v_mfma_f32_16x16x32_bf16 v[120:123], a[172:175], v[176:179], v[120:123]
    s_add_u32 s39, s39, 16
    ds_read_b64_tr_b16 a[212:213], v12 offset:8192
    ds_read_b64_tr_b16 a[214:215], v12 offset:12288
    v_mfma_f32_16x16x32_bf16 v[120:123], a[176:179], v[136:139], v[120:123]
    buffer_load_dword v11, v9, s[24:27], s39 offen sc1
    v_mfma_f32_16x16x32_bf16 v[120:123], a[180:183], v[152:155], v[120:123]
    ds_read_b64_tr_b16 a[216:217], v12 offset:16384
    ds_read_b64_tr_b16 a[218:219], v12 offset:20480
    v_mfma_f32_16x16x32_bf16 v[120:123], a[184:187], v[200:203], v[120:123]
    ds_read_b64_tr_b16 a[220:221], v12 offset:24576
    v_mfma_f32_16x16x32_bf16 v[120:123], a[188:191], v[184:187], v[120:123]
    ds_read_b64_tr_b16 a[222:223], v12 offset:28672
    v_mfma_f32_16x16x32_bf16 v[124:127], a[160:163], v[132:135], 0
    buffer_load_dwordx2 v[82:83], v3, s[20:23], 0 offen offset:544
    v_mfma_f32_16x16x32_bf16 v[124:127], a[164:167], v[148:151], v[124:127]
    ds_read_b64_tr_b16 a[224:225], v16 offset:0
    ds_read_b64_tr_b16 a[226:227], v16 offset:4096
    v_mfma_f32_16x16x32_bf16 v[124:127], a[168:171], v[196:199], v[124:127]
    ds_read_b64_tr_b16 a[228:229], v16 offset:8192
    v_mfma_f32_16x16x32_bf16 v[124:127], a[172:175], v[180:183], v[124:127]
    ds_read_b64_tr_b16 a[230:231], v16 offset:12288
    v_mfma_f32_16x16x32_bf16 v[124:127], a[176:179], v[140:143], v[124:127]
    buffer_load_dwordx2 v[84:85], v55, s[20:23], 0 offen offset:1024
    v_mfma_f32_16x16x32_bf16 v[124:127], a[180:183], v[156:159], v[124:127]
    ds_read_b64_tr_b16 a[232:233], v16 offset:16384
    ds_read_b64_tr_b16 a[234:235], v16 offset:20480
    v_mfma_f32_16x16x32_bf16 v[124:127], a[184:187], v[204:207], v[124:127]
    ds_read_b64_tr_b16 a[236:237], v16 offset:24576
    v_mfma_f32_16x16x32_bf16 v[124:127], a[188:191], v[188:191], v[124:127]
    s_waitcnt lgkmcnt(13)
    ds_read_b64_tr_b16 a[238:239], v16 offset:28672
    v_mfma_f32_16x16x32_bf16 v[96:99], a[208:211], a[64:67], v[96:99]
    s_waitcnt lgkmcnt(12)
    buffer_load_dwordx2 v[86:87], v55, s[20:23], 0 offen offset:1056
    v_mfma_f32_16x16x32_bf16 v[96:99], a[212:215], a[68:71], v[96:99]
    s_waitcnt lgkmcnt(10)
    ds_read_b64_tr_b16 a[160:161], v13 offset:0
    ds_read_b64_tr_b16 a[162:163], v13 offset:4096
    v_mfma_f32_16x16x32_bf16 v[96:99], a[216:219], a[72:75], v[96:99]
Ltour11:
    s_cbranch_execz Ltour15
    s_waitcnt lgkmcnt(10)
    ds_read_b64_tr_b16 a[164:165], v13 offset:8192
    v_mfma_f32_16x16x32_bf16 v[96:99], a[220:223], a[76:79], v[96:99]
    s_waitcnt lgkmcnt(9)
    ds_read_b64_tr_b16 a[166:167], v13 offset:12288
    v_mfma_f32_16x16x32_bf16 v[96:99], a[224:227], a[80:83], v[96:99]
    s_waitcnt lgkmcnt(8)
    ds_read_b64_tr_b16 a[168:169], v13 offset:16384
    v_mfma_f32_16x16x32_bf16 v[96:99], a[228:231], a[84:87], v[96:99]
    s_waitcnt lgkmcnt(7)
    s_mov_b32 s45, 22144
    ds_read_b64_tr_b16 a[170:171], v13 offset:20480
    v_mfma_f32_16x16x32_bf16 v[96:99], a[232:235], a[88:91], v[96:99]
    s_waitcnt lgkmcnt(6)
    buffer_load_dwordx4 v[216:219], v5, s[24:27], s45 offen offset:0 sc1
    v_mfma_f32_16x16x32_bf16 v[96:99], a[236:239], a[92:95], v[96:99]
    ds_read_b64_tr_b16 a[172:173], v13 offset:24576
    ds_read_b64_tr_b16 a[174:175], v13 offset:28672
    v_mfma_f32_16x16x32_bf16 v[100:103], a[208:211], a[96:99], v[100:103]
    ds_read_b64_tr_b16 a[176:177], v17 offset:0
    v_mfma_f32_16x16x32_bf16 v[100:103], a[212:215], a[100:103], v[100:103]
    ds_read_b64_tr_b16 a[178:179], v17 offset:4096
    v_mfma_f32_16x16x32_bf16 v[100:103], a[216:219], a[104:107], v[100:103]
    buffer_load_dwordx4 v[220:223], v5, s[24:27], s45 offen offset:512 sc1
    v_mfma_f32_16x16x32_bf16 v[100:103], a[220:223], a[108:111], v[100:103]
    ds_read_b64_tr_b16 a[180:181], v17 offset:8192
    ds_read_b64_tr_b16 a[182:183], v17 offset:12288
    v_mfma_f32_16x16x32_bf16 v[100:103], a[224:227], a[112:115], v[100:103]
    ds_read_b64_tr_b16 a[184:185], v17 offset:16384
    v_cvt_pk_bf16_f32 v224, v96, v97
    v_mfma_f32_16x16x32_bf16 v[100:103], a[228:231], a[116:119], v[100:103]
    ds_read_b64_tr_b16 a[186:187], v17 offset:20480
    v_cvt_pk_bf16_f32 v225, v98, v99
    v_mfma_f32_16x16x32_bf16 v[100:103], a[232:235], a[120:123], v[100:103]
    ds_read_b64_tr_b16 a[188:189], v17 offset:24576
    v_mfma_f32_16x16x32_bf16 v[100:103], a[236:239], a[124:127], v[100:103]
    s_waitcnt lgkmcnt(13)
    ds_read_b64_tr_b16 a[190:191], v17 offset:28672
    v_mfma_f32_16x16x32_bf16 v[104:107], a[160:163], a[64:67], v[104:107]
    s_waitcnt lgkmcnt(12)
    buffer_load_dwordx4 v[88:91], v59, s[24:27], s45 offen offset:1024 sc1
    v_mfma_f32_16x16x32_bf16 v[104:107], a[164:167], a[68:71], v[104:107]
    s_waitcnt lgkmcnt(10)
    ds_read_b64_tr_b16 a[208:209], v14 offset:0
    ds_read_b64_tr_b16 a[210:211], v14 offset:4096
    v_mfma_f32_16x16x32_bf16 v[104:107], a[168:171], a[72:75], v[104:107]
    s_waitcnt lgkmcnt(10)
    ds_read_b64_tr_b16 a[212:213], v14 offset:8192
    v_mfma_f32_16x16x32_bf16 v[104:107], a[172:175], a[76:79], v[104:107]
    s_waitcnt lgkmcnt(9)
    ds_read_b64_tr_b16 a[214:215], v14 offset:12288
    v_mfma_f32_16x16x32_bf16 v[104:107], a[176:179], a[80:83], v[104:107]
    s_waitcnt lgkmcnt(8)
    ds_read_b64_tr_b16 a[216:217], v14 offset:16384
    v_cvt_pk_bf16_f32 v228, v100, v101
    v_mfma_f32_16x16x32_bf16 v[104:107], a[180:183], a[84:87], v[104:107]
    s_waitcnt lgkmcnt(7)
    ds_read_b64_tr_b16 a[218:219], v14 offset:20480
    v_cvt_pk_bf16_f32 v229, v102, v103
    v_mfma_f32_16x16x32_bf16 v[104:107], a[184:187], a[88:91], v[104:107]
    s_waitcnt lgkmcnt(6)
    ds_read_b64_tr_b16 a[220:221], v14 offset:24576
    v_mfma_f32_16x16x32_bf16 v[104:107], a[188:191], a[92:95], v[104:107]
    ds_read_b64_tr_b16 a[222:223], v14 offset:28672
    v_mfma_f32_16x16x32_bf16 v[108:111], a[160:163], a[96:99], v[108:111]
    ds_read_b64_tr_b16 a[224:225], v18 offset:0
    v_mfma_f32_16x16x32_bf16 v[108:111], a[164:167], a[100:103], v[108:111]
    ds_read_b64_tr_b16 a[226:227], v18 offset:4096
    v_mfma_f32_16x16x32_bf16 v[108:111], a[168:171], a[104:107], v[108:111]
    ds_read_b64_tr_b16 a[228:229], v18 offset:8192
    v_mfma_f32_16x16x32_bf16 v[108:111], a[172:175], a[108:111], v[108:111]
    ds_read_b64_tr_b16 a[230:231], v18 offset:12288
    v_mfma_f32_16x16x32_bf16 v[108:111], a[176:179], a[112:115], v[108:111]
    ds_read_b64_tr_b16 a[232:233], v18 offset:16384
    v_cvt_pk_bf16_f32 v226, v104, v105
    v_mfma_f32_16x16x32_bf16 v[108:111], a[180:183], a[116:119], v[108:111]
    s_add_u32 s38, s93, 1536
    ds_read_b64_tr_b16 a[234:235], v18 offset:20480
    v_cvt_pk_bf16_f32 v227, v106, v107
    v_mfma_f32_16x16x32_bf16 v[108:111], a[184:187], a[120:123], v[108:111]
    buffer_store_dwordx4 v[224:227], v56, s[28:31], s38 offen sc1
    v_mfma_f32_16x16x32_bf16 v[108:111], a[188:191], a[124:127], v[108:111]
    s_waitcnt lgkmcnt(12)
    ds_read_b64_tr_b16 a[236:237], v18 offset:24576
    ds_read_b64_tr_b16 a[238:239], v18 offset:28672
    v_mfma_f32_16x16x32_bf16 v[112:115], a[208:211], a[64:67], v[112:115]
    s_waitcnt lgkmcnt(12)
    ds_read_b64_tr_b16 a[160:161], v15 offset:0
    v_mfma_f32_16x16x32_bf16 v[112:115], a[212:215], a[68:71], v[112:115]
    s_waitcnt lgkmcnt(11)
    ds_read_b64_tr_b16 a[162:163], v15 offset:4096
    v_mfma_f32_16x16x32_bf16 v[112:115], a[216:219], a[72:75], v[112:115]
    s_waitcnt lgkmcnt(10)
    ds_read_b64_tr_b16 a[164:165], v15 offset:8192
    v_mfma_f32_16x16x32_bf16 v[112:115], a[220:223], a[76:79], v[112:115]
    s_waitcnt lgkmcnt(9)
    ds_read_b64_tr_b16 a[166:167], v15 offset:12288
    v_mfma_f32_16x16x32_bf16 v[112:115], a[224:227], a[80:83], v[112:115]
    s_waitcnt lgkmcnt(8)
    ds_read_b64_tr_b16 a[168:169], v15 offset:16384
    v_cvt_pk_bf16_f32 v230, v108, v109
    v_mfma_f32_16x16x32_bf16 v[112:115], a[228:231], a[84:87], v[112:115]
    s_waitcnt lgkmcnt(7)
    s_add_u32 s38, s93, 165376
    ds_read_b64_tr_b16 a[170:171], v15 offset:20480
    v_cvt_pk_bf16_f32 v231, v110, v111
    v_mfma_f32_16x16x32_bf16 v[112:115], a[232:235], a[88:91], v[112:115]
    s_waitcnt lgkmcnt(6)
    buffer_store_dwordx4 v[228:231], v56, s[28:31], s38 offen sc1
    v_mfma_f32_16x16x32_bf16 v[112:115], a[236:239], a[92:95], v[112:115]
    ds_read_b64_tr_b16 a[172:173], v15 offset:24576
    ds_read_b64_tr_b16 a[174:175], v15 offset:28672
    v_mfma_f32_16x16x32_bf16 v[116:119], a[208:211], a[96:99], v[116:119]
    ds_read_b64_tr_b16 a[176:177], v19 offset:0
    v_mfma_f32_16x16x32_bf16 v[116:119], a[212:215], a[100:103], v[116:119]
    ds_read_b64_tr_b16 a[178:179], v19 offset:4096
    v_mfma_f32_16x16x32_bf16 v[116:119], a[216:219], a[104:107], v[116:119]
    ds_read_b64_tr_b16 a[180:181], v19 offset:8192
    v_mfma_f32_16x16x32_bf16 v[116:119], a[220:223], a[108:111], v[116:119]
    ds_read_b64_tr_b16 a[182:183], v19 offset:12288
    v_mfma_f32_16x16x32_bf16 v[116:119], a[224:227], a[112:115], v[116:119]
    ds_read_b64_tr_b16 a[184:185], v19 offset:16384
    v_cvt_pk_bf16_f32 v232, v112, v113
    v_mfma_f32_16x16x32_bf16 v[116:119], a[228:231], a[116:119], v[116:119]
    ds_read_b64_tr_b16 a[186:187], v19 offset:20480
    v_cvt_pk_bf16_f32 v233, v114, v115
    v_mfma_f32_16x16x32_bf16 v[116:119], a[232:235], a[120:123], v[116:119]
    ds_read_b64_tr_b16 a[188:189], v19 offset:24576
    v_mfma_f32_16x16x32_bf16 v[116:119], a[236:239], a[124:127], v[116:119]
    s_waitcnt lgkmcnt(13)
    ds_read_b64_tr_b16 a[190:191], v19 offset:28672
    v_mfma_f32_16x16x32_bf16 v[120:123], a[160:163], a[64:67], v[120:123]
    s_waitcnt lgkmcnt(12)
    v_mfma_f32_16x16x32_bf16 v[120:123], a[164:167], a[68:71], v[120:123]
    s_waitcnt lgkmcnt(10)
    v_mfma_f32_16x16x32_bf16 v[120:123], a[168:171], a[72:75], v[120:123]
    s_waitcnt lgkmcnt(8)
    v_mfma_f32_16x16x32_bf16 v[120:123], a[172:175], a[76:79], v[120:123]
    s_waitcnt lgkmcnt(6)
    v_mfma_f32_16x16x32_bf16 v[120:123], a[176:179], a[80:83], v[120:123]
    s_waitcnt lgkmcnt(4)
    v_cvt_pk_bf16_f32 v236, v116, v117
    v_mfma_f32_16x16x32_bf16 v[120:123], a[180:183], a[84:87], v[120:123]
    s_waitcnt lgkmcnt(2)
    v_cvt_pk_bf16_f32 v237, v118, v119
    v_mfma_f32_16x16x32_bf16 v[120:123], a[184:187], a[88:91], v[120:123]
    s_waitcnt lgkmcnt(0)
    v_mfma_f32_16x16x32_bf16 v[120:123], a[188:191], a[92:95], v[120:123]
    v_mfma_f32_16x16x32_bf16 v[124:127], a[160:163], a[96:99], v[124:127]
    v_mfma_f32_16x16x32_bf16 v[124:127], a[164:167], a[100:103], v[124:127]
    v_mfma_f32_16x16x32_bf16 v[124:127], a[168:171], a[104:107], v[124:127]
    v_mfma_f32_16x16x32_bf16 v[124:127], a[172:175], a[108:111], v[124:127]
    v_mfma_f32_16x16x32_bf16 v[124:127], a[176:179], a[112:115], v[124:127]
    s_nop 2
    v_cvt_pk_bf16_f32 v234, v120, v121
    v_mfma_f32_16x16x32_bf16 v[124:127], a[180:183], a[116:119], v[124:127]
    s_add_u32 s38, s93, 1664
    v_cvt_pk_bf16_f32 v235, v122, v123
    v_mfma_f32_16x16x32_bf16 v[124:127], a[184:187], a[120:123], v[124:127]
    buffer_store_dwordx4 v[232:235], v56, s[28:31], s38 offen sc1
    v_mfma_f32_16x16x32_bf16 v[124:127], a[188:191], a[124:127], v[124:127]
    s_nop 7
    v_cvt_pk_bf16_f32 v238, v124, v125
    s_add_u32 s38, s93, 165504
    v_cvt_pk_bf16_f32 v239, v126, v127
    buffer_store_dwordx4 v[236:239], v56, s[28:31], s38 offen sc1
    s_add_u32 s92, s92, 16
    s_waitcnt vmcnt(35)
    v_lshlrev_b32 v96, 16, v160
    v_and_b32 v97, 0xffff0000, v160
    v_lshlrev_b32 v98, 16, v161
    v_and_b32 v99, 0xffff0000, v161
    v_lshlrev_b32 v100, 16, v162
    v_and_b32 v101, 0xffff0000, v162
    v_lshlrev_b32 v102, 16, v163
    v_and_b32 v103, 0xffff0000, v163
    s_waitcnt vmcnt(34)
    v_lshlrev_b32 v104, 16, v164
    v_and_b32 v105, 0xffff0000, v164
    v_lshlrev_b32 v106, 16, v165
    v_and_b32 v107, 0xffff0000, v165
    v_lshlrev_b32 v108, 16, v166
    v_and_b32 v109, 0xffff0000, v166
    v_lshlrev_b32 v110, 16, v167
    v_and_b32 v111, 0xffff0000, v167
    s_waitcnt vmcnt(32)
    v_lshlrev_b32 v112, 16, v168
    v_and_b32 v113, 0xffff0000, v168
    v_lshlrev_b32 v114, 16, v169
    v_and_b32 v115, 0xffff0000, v169
    v_lshlrev_b32 v116, 16, v170
    v_and_b32 v117, 0xffff0000, v170
    v_lshlrev_b32 v118, 16, v171
    v_and_b32 v119, 0xffff0000, v171
    s_waitcnt vmcnt(31)
    v_lshlrev_b32 v120, 16, v172
    v_and_b32 v121, 0xffff0000, v172
    v_lshlrev_b32 v122, 16, v173
    v_and_b32 v123, 0xffff0000, v173
    v_lshlrev_b32 v124, 16, v174
    v_and_b32 v125, 0xffff0000, v174
    v_lshlrev_b32 v126, 16, v175
    v_and_b32 v127, 0xffff0000, v175
    s_waitcnt vmcnt(30)
    v_lshlrev_b32 v128, 16, v208
    v_and_b32 v129, 0xffff0000, v208
    v_lshlrev_b32 v130, 16, v209
    v_and_b32 v131, 0xffff0000, v209
    v_lshlrev_b32 v132, 16, v210
    v_and_b32 v133, 0xffff0000, v210
    v_lshlrev_b32 v134, 16, v211
    v_and_b32 v135, 0xffff0000, v211
    s_waitcnt vmcnt(28)
    v_lshlrev_b32 v136, 16, v212
    v_and_b32 v137, 0xffff0000, v212
    v_lshlrev_b32 v138, 16, v213
    v_and_b32 v139, 0xffff0000, v213
    v_lshlrev_b32 v140, 16, v214
    v_and_b32 v141, 0xffff0000, v214
    v_lshlrev_b32 v142, 16, v215
    v_and_b32 v143, 0xffff0000, v215
    s_waitcnt vmcnt(19)
    v_lshlrev_b32 v144, 16, v64
    v_and_b32 v145, 0xffff0000, v64
    v_lshlrev_b32 v146, 16, v65
    v_and_b32 v147, 0xffff0000, v65
    v_lshlrev_b32 v148, 16, v66
    v_and_b32 v149, 0xffff0000, v66
    v_lshlrev_b32 v150, 16, v67
    v_and_b32 v151, 0xffff0000, v67
    s_waitcnt vmcnt(16)
    v_lshlrev_b32 v152, 16, v68
    v_and_b32 v153, 0xffff0000, v68
    v_lshlrev_b32 v154, 16, v69
    v_and_b32 v155, 0xffff0000, v69
    v_lshlrev_b32 v156, 16, v70
    v_and_b32 v157, 0xffff0000, v70
    v_lshlrev_b32 v158, 16, v71
    v_and_b32 v159, 0xffff0000, v71
    s_waitcnt vmcnt(14)
    v_lshlrev_b32 v160, 16, v72
    v_and_b32 v161, 0xffff0000, v72
    v_lshlrev_b32 v162, 16, v73
    v_and_b32 v163, 0xffff0000, v73
    v_lshlrev_b32 v164, 16, v74
    v_and_b32 v165, 0xffff0000, v74
    v_lshlrev_b32 v166, 16, v75
    v_and_b32 v167, 0xffff0000, v75
    s_waitcnt vmcnt(13)
    v_lshlrev_b32 v168, 16, v76
    v_and_b32 v169, 0xffff0000, v76
    v_lshlrev_b32 v170, 16, v77
    v_and_b32 v171, 0xffff0000, v77
    s_waitcnt vmcnt(12)
    v_lshlrev_b32 v172, 16, v78
    v_and_b32 v173, 0xffff0000, v78
    v_lshlrev_b32 v174, 16, v79
    v_and_b32 v175, 0xffff0000, v79
    s_waitcnt vmcnt(11)
    v_lshlrev_b32 v176, 16, v80
    v_and_b32 v177, 0xffff0000, v80
    v_lshlrev_b32 v178, 16, v81
    v_and_b32 v179, 0xffff0000, v81
    s_waitcnt vmcnt(9)
    v_lshlrev_b32 v180, 16, v82
    v_and_b32 v181, 0xffff0000, v82
    v_lshlrev_b32 v182, 16, v83
    v_and_b32 v183, 0xffff0000, v83
    s_waitcnt vmcnt(8)
    v_lshlrev_b32 v184, 16, v84
    v_and_b32 v185, 0xffff0000, v84
    v_lshlrev_b32 v186, 16, v85
    v_and_b32 v187, 0xffff0000, v85
    s_waitcnt vmcnt(7)
    v_lshlrev_b32 v188, 16, v86
    v_and_b32 v189, 0xffff0000, v86
    v_lshlrev_b32 v190, 16, v87
    v_and_b32 v191, 0xffff0000, v87
    s_waitcnt vmcnt(0)
    buffer_store_dword v10, v8, s[24:27], s92 offen sc1
    v_cmp_ne_u32 s[54:55], s95, v11
    s_cmp_lg_u64 s[54:55], 0
    s_cbranch_scc1 Ltail_spin1
Ltail_got1:
    s_add_u32 s56, s44, 16384
    buffer_load_dwordx4 a[0:3], v54, s[28:31], s56 offen offset:0 sc1
    buffer_load_dwordx4 a[4:7], v54, s[28:31], s56 offen offset:1024 sc1
    buffer_load_dwordx4 a[8:11], v54, s[28:31], s56 offen offset:2048 sc1
    buffer_load_dwordx4 a[12:15], v54, s[28:31], s56 offen offset:3072 sc1
    s_add_u32 s56, s44, 0
    buffer_load_dwordx4 a[16:19], v2, s[28:31], s56 offen offset:0 sc1
    s_add_u32 s56, s44, 4096
    buffer_load_dwordx4 a[20:23], v2, s[28:31], s56 offen offset:0 sc1
    s_add_u32 s56, s44, 8192
    buffer_load_dwordx4 a[24:27], v2, s[28:31], s56 offen offset:0 sc1
    s_add_u32 s56, s44, 12288
    buffer_load_dwordx4 a[28:31], v2, s[28:31], s56 offen offset:0 sc1
    ds_write_b128 v51, a[128:131] offset:0
    ds_write_b128 v51, a[132:135] offset:4096
    ds_write_b128 v51, a[136:139] offset:8192
    ds_write_b128 v51, a[140:143] offset:12288
    ds_write_b128 v51, a[144:147] offset:16384
    ds_write_b128 v51, a[148:151] offset:20480
    ds_write_b128 v51, a[152:155] offset:24576
    ds_write_b128 v51, a[156:159] offset:28672
    ds_write_b128 v51, a[240:243] offset:32768
    ds_write_b128 v255, a[244:247] offset:40960
    ds_write_b128 v255, a[248:251] offset:45056
    ds_write_b128 v255, a[252:255] offset:61440
    v_lshlrev_b32 v12, 16, v36
    v_and_b32 v13, 0xffff0000, v36
    v_lshlrev_b32 v14, 16, v37
    v_and_b32 v15, 0xffff0000, v37
    v_lshlrev_b32 v16, 16, v38
    v_and_b32 v17, 0xffff0000, v38
    v_lshlrev_b32 v18, 16, v39
    v_and_b32 v19, 0xffff0000, v39
    v_lshlrev_b32 v20, 16, v40
    v_and_b32 v21, 0xffff0000, v40
    v_lshlrev_b32 v22, 16, v41
    v_and_b32 v23, 0xffff0000, v41
    v_lshlrev_b32 v24, 16, v42
    v_and_b32 v25, 0xffff0000, v42
    v_lshlrev_b32 v26, 16, v43
    v_and_b32 v27, 0xffff0000, v43
    v_lshlrev_b32 v28, 16, v92
    v_and_b32 v29, 0xffff0000, v92
    v_lshlrev_b32 v30, 16, v93
    v_and_b32 v31, 0xffff0000, v93
    v_lshlrev_b32 v32, 16, v94
    v_and_b32 v33, 0xffff0000, v94
    v_lshlrev_b32 v34, 16, v95
    v_and_b32 v35, 0xffff0000, v95
    v_lshlrev_b32 v192, 16, v216
    v_and_b32 v193, 0xffff0000, v216
    v_lshlrev_b32 v194, 16, v217
    v_and_b32 v195, 0xffff0000, v217
    v_lshlrev_b32 v196, 16, v218
    v_and_b32 v197, 0xffff0000, v218
    v_lshlrev_b32 v198, 16, v219
    v_and_b32 v199, 0xffff0000, v219
    v_lshlrev_b32 v200, 16, v220
    v_and_b32 v201, 0xffff0000, v220
    v_lshlrev_b32 v202, 16, v221
    v_and_b32 v203, 0xffff0000, v221
    v_lshlrev_b32 v204, 16, v222
    v_and_b32 v205, 0xffff0000, v222
    v_lshlrev_b32 v206, 16, v223
    v_and_b32 v207, 0xffff0000, v223
    v_lshlrev_b32 v208, 16, v88
    v_and_b32 v209, 0xffff0000, v88
    v_lshlrev_b32 v210, 16, v89
    v_and_b32 v211, 0xffff0000, v89
    v_lshlrev_b32 v212, 16, v90
    v_and_b32 v213, 0xffff0000, v90
    v_lshlrev_b32 v214, 16, v91
    v_and_b32 v215, 0xffff0000, v91
    s_add_u32 s39, s39, 16
    buffer_load_dword v11, v9, s[24:27], s39 offen sc1
    s_add_u32 s56, s44, 0
    buffer_load_dwordx4 a[32:35], v2, s[28:31], s56 offen offset:512 sc1
    s_add_u32 s56, s44, 4096
    buffer_load_dwordx4 a[36:39], v2, s[28:31], s56 offen offset:512 sc1
    s_add_u32 s56, s44, 8192
    buffer_load_dwordx4 a[40:43], v2, s[28:31], s56 offen offset:512 sc1
    s_add_u32 s56, s44, 12288
    buffer_load_dwordx4 a[44:47], v2, s[28:31], s56 offen offset:512 sc1
    v_lshrrev_b32 v56, 2, v1
    v_and_b32 v57, 3, v1
    v_lshlrev_b32 v57, 3, v57
    s_and_b32 s36, s3, 1
    s_lshl_b32 s36, s36, 5
    v_lshl_add_u32 v61, v56, 6, v57
    v_add_u32 v61, s36, v61
    s_mov_b32 s36, 135168
    s_mov_b32 s37, 12288
    s_cmp_lt_u32 s3, 2
    s_cselect_b32 s36, 98304, s36
    s_cselect_b32 s37, 98304, s37
    v_add_u32 v94, s37, v61
    v_add_u32 v61, s36, v61
    v_mul_u32_u24 v95, 1152, v56
    s_lshl_b32 s36, s3, 7
    s_add_u32 s36, s36, 61440
    v_add3_u32 v95, v95, v57, s36
    s_waitcnt lgkmcnt(0)
    s_barrier
    ds_read_b64_tr_b16 a[96:97], v61 offset:0
    ds_read_b64_tr_b16 a[98:99], v61 offset:1024
    ds_read_b64_tr_b16 a[100:101], v61 offset:2048
    ds_read_b64_tr_b16 a[102:103], v61 offset:3072
    ds_read_b64_tr_b16 a[104:105], v61 offset:4096
    ds_read_b64_tr_b16 a[106:107], v61 offset:5120
    ds_read_b64_tr_b16 a[108:109], v61 offset:6144
    ds_read_b64_tr_b16 a[110:111], v61 offset:7168
    ds_read_b64_tr_b16 a[112:113], v61 offset:8192
    ds_read_b64_tr_b16 a[114:115], v61 offset:9216
    ds_read_b64_tr_b16 a[116:117], v61 offset:10240
    ds_read_b64_tr_b16 a[118:119], v61 offset:11264
    ds_read_b64_tr_b16 a[120:121], v61 offset:12288
    ds_read_b64_tr_b16 a[122:123], v61 offset:13312
    ds_read_b64_tr_b16 a[124:125], v61 offset:14336
    ds_read_b64_tr_b16 a[126:127], v61 offset:15360
    ds_read_b64_tr_b16 a[128:129], v61 offset:16384
    ds_read_b64_tr_b16 a[130:131], v61 offset:17408
    ds_read_b64_tr_b16 a[132:133], v61 offset:18432
    ds_read_b64_tr_b16 a[134:135], v61 offset:19456
    ds_read_b64_tr_b16 a[136:137], v61 offset:20480
    ds_read_b64_tr_b16 a[138:139], v61 offset:21504
    ds_read_b64_tr_b16 a[140:141], v61 offset:22528
    ds_read_b64_tr_b16 a[142:143], v61 offset:23552
    ds_read_b64_tr_b16 a[144:145], v61 offset:24576
    ds_read_b64_tr_b16 a[146:147], v61 offset:25600
    ds_read_b64_tr_b16 a[148:149], v61 offset:26624
    ds_read_b64_tr_b16 a[150:151], v61 offset:27648
    ds_read_b64_tr_b16 a[152:153], v94 offset:28672
    ds_read_b64_tr_b16 a[154:155], v94 offset:29696
    ds_read_b64_tr_b16 a[156:157], v94 offset:30720
    ds_read_b64_tr_b16 a[158:159], v94 offset:31744
    ds_read_b64_tr_b16 a[160:161], v94 offset:32768
    ds_read_b64_tr_b16 a[162:163], v94 offset:33792
    ds_read_b64_tr_b16 a[164:165], v94 offset:34816
    ds_read_b64_tr_b16 a[166:167], v94 offset:35840
    ds_read_b64_tr_b16 a[168:169], v95 offset:0
    ds_read_b64_tr_b16 a[170:171], v95 offset:18432
    ds_read_b64_tr_b16 a[172:173], v95 offset:32
    ds_read_b64_tr_b16 a[174:175], v95 offset:18464
    ds_read_b64_tr_b16 a[176:177], v95 offset:64
    ds_read_b64_tr_b16 a[178:179], v95 offset:18496
    ds_read_b64_tr_b16 a[180:181], v95 offset:96
    ds_read_b64_tr_b16 a[182:183], v95 offset:18528
    ds_read_b64_tr_b16 a[184:185], v95 offset:512
    ds_read_b64_tr_b16 a[186:187], v95 offset:18944
    ds_read_b64_tr_b16 a[188:189], v95 offset:544
    ds_read_b64_tr_b16 a[190:191], v95 offset:18976
    ds_read_b64_tr_b16 a[192:193], v95 offset:576
    ds_read_b64_tr_b16 a[194:195], v95 offset:19008
    ds_read_b64_tr_b16 a[196:197], v95 offset:608
    ds_read_b64_tr_b16 a[198:199], v95 offset:19040
    ds_read_b64_tr_b16 a[200:201], v95 offset:1024
    ds_read_b64_tr_b16 a[202:203], v95 offset:19456
    ds_read_b64_tr_b16 a[204:205], v95 offset:1056
    ds_read_b64_tr_b16 a[206:207], v95 offset:19488
    ds_read_b64_tr_b16 a[208:209], v95 offset:1088
    ds_read_b64_tr_b16 a[210:211], v95 offset:19520
    ds_read_b64_tr_b16 a[212:213], v95 offset:1120
    ds_read_b64_tr_b16 a[214:215], v95 offset:19552
    v_pk_mul_f32 v[62:63], v[144:145], v[168:169]
    v_pk_mul_f32 v[168:169], v[168:169], v[120:121]
    v_pk_fma_f32 v[62:63], v[146:147], v[170:171], v[62:63]
    v_pk_mul_f32 v[170:171], v[170:171], v[122:123]
    v_pk_add_f32 v[88:89], v[168:169], v[170:171]
    v_pk_fma_f32 v[62:63], v[148:149], v[172:173], v[62:63]
    v_pk_mul_f32 v[172:173], v[172:173], v[124:125]
    v_pk_add_f32 v[88:89], v[88:89], v[172:173]
    v_pk_fma_f32 v[62:63], v[150:151], v[174:175], v[62:63]
    v_pk_mul_f32 v[174:175], v[174:175], v[126:127]
    v_pk_add_f32 v[88:89], v[88:89], v[174:175]
    v_pk_fma_f32 v[62:63], v[152:153], v[176:177], v[62:63]
    v_pk_mul_f32 v[176:177], v[176:177], v[128:129]
    v_pk_add_f32 v[88:89], v[88:89], v[176:177]
    v_pk_fma_f32 v[62:63], v[154:155], v[178:179], v[62:63]
    v_pk_mul_f32 v[178:179], v[178:179], v[130:131]
    v_pk_add_f32 v[88:89], v[88:89], v[178:179]
    v_pk_fma_f32 v[62:63], v[156:157], v[180:181], v[62:63]
    v_pk_mul_f32 v[180:181], v[180:181], v[132:133]
    v_pk_add_f32 v[88:89], v[88:89], v[180:181]
    v_pk_fma_f32 v[62:63], v[158:159], v[182:183], v[62:63]
    v_pk_mul_f32 v[182:183], v[182:183], v[134:135]
    v_pk_add_f32 v[88:89], v[88:89], v[182:183]
    v_pk_fma_f32 v[62:63], v[160:161], v[184:185], v[62:63]
    v_pk_mul_f32 v[184:185], v[184:185], v[136:137]
    v_pk_add_f32 v[88:89], v[88:89], v[184:185]
    v_pk_fma_f32 v[62:63], v[162:163], v[186:187], v[62:63]
    v_pk_mul_f32 v[186:187], v[186:187], v[138:139]
    v_pk_add_f32 v[88:89], v[88:89], v[186:187]
    v_pk_fma_f32 v[62:63], v[164:165], v[188:189], v[62:63]
    v_pk_mul_f32 v[188:189], v[188:189], v[140:141]
    v_pk_add_f32 v[88:89], v[88:89], v[188:189]
    v_pk_fma_f32 v[62:63], v[166:167], v[190:191], v[62:63]
    v_pk_mul_f32 v[190:191], v[190:191], v[142:143]
    v_pk_add_f32 v[88:89], v[88:89], v[190:191]
    v_add_f32 v91, v62, v63
    v_add_f32 v90, v88, v89
    s_nop 1
    v_add_f32_dpp v90, v90, v90 row_ror:8 row_mask:0xf bank_mask:0xf
    v_add_f32_dpp v91, v91, v91 row_ror:8 row_mask:0xf bank_mask:0xf
    s_nop 0
    v_add_f32_dpp v90, v90, v90 row_ror:4 row_mask:0xf bank_mask:0xf
    v_add_f32_dpp v91, v91, v91 row_ror:4 row_mask:0xf bank_mask:0xf
    s_nop 0
    v_add_f32_dpp v90, v90, v90 row_ror:2 row_mask:0xf bank_mask:0xf
    v_add_f32_dpp v91, v91, v91 row_ror:2 row_mask:0xf bank_mask:0xf
    s_nop 0
    v_add_f32_dpp v90, v90, v90 row_ror:1 row_mask:0xf bank_mask:0xf
    v_add_f32_dpp v91, v91, v91 row_ror:1 row_mask:0xf bank_mask:0xf
    v_mov_b32 v62, v90
    v_mov_b32 v63, v91
    s_nop 0
    v_permlane16_swap_b32 v90, v62
    v_permlane16_swap_b32 v91, v63
    v_add_f32 v90, v90, v62
    v_add_f32 v91, v91, v63
    v_lshlrev_b32 v92, 2, v7
    v_and_b32 v92, 28, v92
    v_sub_u32 v93, 2047, v7
    s_waitcnt vmcnt(4)
    v_cmp_ne_u32 s[54:55], s95, v11
    s_cmp_lg_u64 s[54:55], 0
    s_cbranch_scc1 Ltail_spin2
Ltail_got2:
    s_add_u32 s56, s44, 0
    buffer_load_dwordx4 a[48:51], v2, s[28:31], s56 offen offset:1024 sc1
    s_add_u32 s56, s44, 4096
    buffer_load_dwordx4 a[52:55], v2, s[28:31], s56 offen offset:1024 sc1
    s_add_u32 s56, s44, 8192
    buffer_load_dwordx4 a[56:59], v2, s[28:31], s56 offen offset:1024 sc1
    s_add_u32 s56, s44, 12288
    buffer_load_dwordx4 a[60:63], v2, s[28:31], s56 offen offset:1024 sc1
    s_add_u32 s56, s44, 0
    buffer_load_dwordx4 a[64:67], v2, s[28:31], s56 offen offset:1536 sc1
    s_add_u32 s56, s44, 4096
    buffer_load_dwordx4 a[68:71], v2, s[28:31], s56 offen offset:1536 sc1
    s_add_u32 s56, s44, 8192
    buffer_load_dwordx4 a[72:75], v2, s[28:31], s56 offen offset:1536 sc1
    s_add_u32 s56, s44, 12288
    buffer_load_dwordx4 a[76:79], v2, s[28:31], s56 offen offset:1536 sc1
    s_movk_i32 s48, 0x7ff
    v_mfma_f32_16x16x32_bf16 v[80:83], v[242:245], a[0:3], 0
    v_mfma_f32_16x16x32_bf16 v[84:87], v[240:243], a[0:3], 0
    v_mfma_f32_16x16x32_bf16 v[80:83], v[242:245], a[4:7], v[80:83]
    v_mfma_f32_16x16x32_bf16 v[84:87], v[240:243], a[4:7], v[84:87]
    v_mfma_f32_16x16x32_bf16 v[80:83], v[242:245], a[8:11], v[80:83]
    v_mfma_f32_16x16x32_bf16 v[84:87], v[240:243], a[8:11], v[84:87]
    v_mfma_f32_16x16x32_bf16 v[80:83], v[242:245], a[12:15], v[80:83]
    v_mfma_f32_16x16x32_bf16 v[84:87], v[240:243], a[12:15], v[84:87]
    s_nop 6
    v_mov_b32_dpp v80, v80 row_ror:8 row_mask:0x4 bank_mask:0xf
    v_mov_b32_dpp v81, v81 row_ror:8 row_mask:0x4 bank_mask:0xf
    v_mov_b32_dpp v82, v82 row_ror:8 row_mask:0x4 bank_mask:0xf
    v_mov_b32_dpp v83, v83 row_ror:8 row_mask:0x4 bank_mask:0xf
    v_mov_b32_dpp v84, v84 row_ror:8 row_mask:0x4 bank_mask:0xf
    v_mov_b32_dpp v85, v85 row_ror:8 row_mask:0x4 bank_mask:0xf
    v_mov_b32_dpp v86, v86 row_ror:8 row_mask:0x4 bank_mask:0xf
    v_mov_b32_dpp v87, v87 row_ror:8 row_mask:0x4 bank_mask:0xf
    v_pk_fma_f32 v[28:29], v[112:113], v[80:81], v[28:29]
    v_pk_fma_f32 v[30:31], v[114:115], v[82:83], v[30:31]
    v_pk_fma_f32 v[32:33], v[116:117], v[84:85], v[32:33]
    v_pk_fma_f32 v[34:35], v[118:119], v[86:87], v[34:35]
    v_cvt_pk_bf16_f32 v44, v28, v29
    v_cvt_pk_bf16_f32 v45, v30, v31
    v_cvt_pk_bf16_f32 v46, v32, v33
    v_cvt_pk_bf16_f32 v47, v34, v35
    v_lshlrev_b32 v28, 16, v44
    v_and_b32 v29, 0xffff0000, v44
    v_lshlrev_b32 v30, 16, v45
    v_and_b32 v31, 0xffff0000, v45
    v_lshlrev_b32 v32, 16, v46
    v_and_b32 v33, 0xffff0000, v46
    v_lshlrev_b32 v34, 16, v47
    v_and_b32 v35, 0xffff0000, v47
    v_mfma_f32_16x16x32_bf16 v[64:67], v[246:249], a[16:19], 0
    v_mfma_f32_16x16x32_bf16 v[68:71], v[244:247], a[16:19], 0
    v_mfma_f32_16x16x32_bf16 v[64:67], v[246:249], a[20:23], v[64:67]
    v_mfma_f32_16x16x32_bf16 v[68:71], v[244:247], a[20:23], v[68:71]
    v_mfma_f32_16x16x32_bf16 v[64:67], v[246:249], a[24:27], v[64:67]
    v_mfma_f32_16x16x32_bf16 v[68:71], v[244:247], a[24:27], v[68:71]
    v_mfma_f32_16x16x32_bf16 v[64:67], v[246:249], a[28:31], v[64:67]
    v_mfma_f32_16x16x32_bf16 v[68:71], v[244:247], a[28:31], v[68:71]
    s_waitcnt vmcnt(11)
    v_mfma_f32_16x16x32_bf16 v[64:67], v[250:253], a[32:35], v[64:67]
    v_mfma_f32_16x16x32_bf16 v[68:71], v[248:251], a[32:35], v[68:71]
    s_waitcnt vmcnt(10)
    v_mfma_f32_16x16x32_bf16 v[64:67], v[250:253], a[36:39], v[64:67]
    v_mfma_f32_16x16x32_bf16 v[68:71], v[248:251], a[36:39], v[68:71]
    s_waitcnt vmcnt(9)
    v_mfma_f32_16x16x32_bf16 v[64:67], v[250:253], a[40:43], v[64:67]
    v_mfma_f32_16x16x32_bf16 v[68:71], v[248:251], a[40:43], v[68:71]
    s_waitcnt vmcnt(8)
    v_mfma_f32_16x16x32_bf16 v[64:67], v[250:253], a[44:47], v[64:67]
    v_mfma_f32_16x16x32_bf16 v[68:71], v[248:251], a[44:47], v[68:71]
    s_waitcnt vmcnt(7)
    s_nop 5
    v_pk_fma_f32 v[12:13], v[96:97], v[64:65], v[12:13]
    v_pk_fma_f32 v[14:15], v[98:99], v[66:67], v[14:15]
    v_pk_fma_f32 v[16:17], v[100:101], v[68:69], v[16:17]
    v_pk_fma_f32 v[18:19], v[102:103], v[70:71], v[18:19]
    v_cvt_pk_bf16_f32 v36, v12, v13
    v_cvt_pk_bf16_f32 v37, v14, v15
    v_cvt_pk_bf16_f32 v38, v16, v17
    v_cvt_pk_bf16_f32 v39, v18, v19
    v_lshlrev_b32 v12, 16, v36
    v_and_b32 v13, 0xffff0000, v36
    v_lshlrev_b32 v14, 16, v37
    v_and_b32 v15, 0xffff0000, v37
    v_lshlrev_b32 v16, 16, v38
    v_and_b32 v17, 0xffff0000, v38
    v_lshlrev_b32 v18, 16, v39
    v_and_b32 v19, 0xffff0000, v39
    v_pk_add_f32 v[88:89], v[12:13], v[14:15]
Ltour12:
    s_cbranch_execz Ltour16
    v_pk_add_f32 v[62:63], v[16:17], v[18:19]
    v_pk_add_f32 v[88:89], v[88:89], v[62:63]
    v_add_f32 v88, v88, v89
    s_nop 1
    v_add_f32_dpp v88, v88, v88 row_ror:8 row_mask:0xf bank_mask:0xf
    s_nop 1
    v_add_f32_dpp v88, v88, v88 row_ror:4 row_mask:0xf bank_mask:0xf
    s_nop 1
    v_add_f32_dpp v88, v88, v88 row_ror:2 row_mask:0xf bank_mask:0xf
    s_nop 1
    v_add_f32_dpp v88, v88, v88 row_ror:1 row_mask:0xf bank_mask:0xf
    v_mov_b32 v62, v88
    s_nop 1
    v_permlane16_swap_b32 v88, v62
    s_nop 0
    v_add_f32 v88, v88, v62
    v_mul_f32 v88, 0x3b800000, v88
    v_pk_add_f32 v[232:233], v[28:29], v[88:89] op_sel_hi:[1,0] neg_lo:[0,1] neg_hi:[0,1]
    v_pk_add_f32 v[234:235], v[30:31], v[88:89] op_sel_hi:[1,0] neg_lo:[0,1] neg_hi:[0,1]
    v_pk_add_f32 v[236:237], v[32:33], v[88:89] op_sel_hi:[1,0] neg_lo:[0,1] neg_hi:[0,1]
    v_pk_add_f32 v[238:239], v[34:35], v[88:89] op_sel_hi:[1,0] neg_lo:[0,1] neg_hi:[0,1]
    v_pk_add_f32 v[48:49], v[232:233], v[234:235]
    v_pk_mul_f32 v[50:51], v[232:233], v[232:233]
    v_pk_mul_f32 v[52:53], v[232:233], v[184:185]
    v_pk_fma_f32 v[50:51], v[234:235], v[234:235], v[50:51]
    v_pk_fma_f32 v[52:53], v[234:235], v[186:187], v[52:53]
    v_pk_add_f32 v[48:49], v[48:49], v[236:237]
    v_pk_fma_f32 v[50:51], v[236:237], v[236:237], v[50:51]
    v_pk_fma_f32 v[52:53], v[236:237], v[188:189], v[52:53]
    v_pk_add_f32 v[48:49], v[48:49], v[238:239]
    v_pk_fma_f32 v[50:51], v[238:239], v[238:239], v[50:51]
    v_pk_fma_f32 v[52:53], v[238:239], v[190:191], v[52:53]
    v_cndmask_b32 v48, 0, v48, vcc
    v_cndmask_b32 v49, 0, v49, vcc
    v_cndmask_b32 v50, 0, v50, vcc
    v_cndmask_b32 v51, 0, v51, vcc
    v_pk_add_f32 v[216:217], v[12:13], v[88:89] op_sel_hi:[1,0] neg_lo:[0,1] neg_hi:[0,1]
    v_pk_add_f32 v[218:219], v[14:15], v[88:89] op_sel_hi:[1,0] neg_lo:[0,1] neg_hi:[0,1]
    v_pk_add_f32 v[220:221], v[16:17], v[88:89] op_sel_hi:[1,0] neg_lo:[0,1] neg_hi:[0,1]
    v_pk_add_f32 v[222:223], v[18:19], v[88:89] op_sel_hi:[1,0] neg_lo:[0,1] neg_hi:[0,1]
    v_pk_add_f32 v[48:49], v[48:49], v[216:217]
    v_pk_fma_f32 v[50:51], v[216:217], v[216:217], v[50:51]
    v_pk_fma_f32 v[52:53], v[216:217], v[168:169], v[52:53]
    v_pk_add_f32 v[48:49], v[48:49], v[218:219]
    v_pk_fma_f32 v[50:51], v[218:219], v[218:219], v[50:51]
    v_pk_fma_f32 v[52:53], v[218:219], v[170:171], v[52:53]
    v_pk_add_f32 v[48:49], v[48:49], v[220:221]
    v_pk_fma_f32 v[50:51], v[220:221], v[220:221], v[50:51]
    v_pk_fma_f32 v[52:53], v[220:221], v[172:173], v[52:53]
    v_pk_add_f32 v[48:49], v[48:49], v[222:223]
    v_pk_fma_f32 v[50:51], v[222:223], v[222:223], v[50:51]
    v_pk_fma_f32 v[52:53], v[222:223], v[174:175], v[52:53]
    v_mfma_f32_16x16x32_bf16 v[72:75], v[246:249], a[48:51], 0
    v_mfma_f32_16x16x32_bf16 v[76:79], v[244:247], a[48:51], 0
    s_waitcnt vmcnt(6)
    v_mfma_f32_16x16x32_bf16 v[72:75], v[246:249], a[52:55], v[72:75]
    v_mfma_f32_16x16x32_bf16 v[76:79], v[244:247], a[52:55], v[76:79]
    s_waitcnt vmcnt(5)
    v_mfma_f32_16x16x32_bf16 v[72:75], v[246:249], a[56:59], v[72:75]
    v_mfma_f32_16x16x32_bf16 v[76:79], v[244:247], a[56:59], v[76:79]
    s_waitcnt vmcnt(4)
    v_mfma_f32_16x16x32_bf16 v[72:75], v[246:249], a[60:63], v[72:75]
    v_mfma_f32_16x16x32_bf16 v[76:79], v[244:247], a[60:63], v[76:79]
    s_waitcnt vmcnt(3)
    v_mfma_f32_16x16x32_bf16 v[72:75], v[250:253], a[64:67], v[72:75]
    v_mfma_f32_16x16x32_bf16 v[76:79], v[248:251], a[64:67], v[76:79]
    s_waitcnt vmcnt(2)
    v_mfma_f32_16x16x32_bf16 v[72:75], v[250:253], a[68:71], v[72:75]
    v_mfma_f32_16x16x32_bf16 v[76:79], v[248:251], a[68:71], v[76:79]
    s_waitcnt vmcnt(1)
    v_mfma_f32_16x16x32_bf16 v[72:75], v[250:253], a[72:75], v[72:75]
    v_mfma_f32_16x16x32_bf16 v[76:79], v[248:251], a[72:75], v[76:79]
    s_waitcnt vmcnt(0)
    v_mfma_f32_16x16x32_bf16 v[72:75], v[250:253], a[76:79], v[72:75]
    v_mfma_f32_16x16x32_bf16 v[76:79], v[248:251], a[76:79], v[76:79]
    s_nop 6
    v_pk_fma_f32 v[20:21], v[104:105], v[72:73], v[20:21]
    v_pk_fma_f32 v[22:23], v[106:107], v[74:75], v[22:23]
    v_pk_fma_f32 v[24:25], v[108:109], v[76:77], v[24:25]
    v_pk_fma_f32 v[26:27], v[110:111], v[78:79], v[26:27]
    v_cvt_pk_bf16_f32 v40, v20, v21
    v_cvt_pk_bf16_f32 v41, v22, v23
    v_cvt_pk_bf16_f32 v42, v24, v25
    v_cvt_pk_bf16_f32 v43, v26, v27
    v_lshlrev_b32 v20, 16, v40
    v_and_b32 v21, 0xffff0000, v40
    v_lshlrev_b32 v22, 16, v41
    v_and_b32 v23, 0xffff0000, v41
    v_lshlrev_b32 v24, 16, v42
    v_and_b32 v25, 0xffff0000, v42
    v_lshlrev_b32 v26, 16, v43
    v_and_b32 v27, 0xffff0000, v43
    v_pk_add_f32 v[224:225], v[20:21], v[88:89] op_sel_hi:[1,0] neg_lo:[0,1] neg_hi:[0,1]
    v_pk_add_f32 v[226:227], v[22:23], v[88:89] op_sel_hi:[1,0] neg_lo:[0,1] neg_hi:[0,1]
    v_pk_add_f32 v[228:229], v[24:25], v[88:89] op_sel_hi:[1,0] neg_lo:[0,1] neg_hi:[0,1]
    v_pk_add_f32 v[230:231], v[26:27], v[88:89] op_sel_hi:[1,0] neg_lo:[0,1] neg_hi:[0,1]
    v_pk_add_f32 v[48:49], v[48:49], v[224:225]
    v_pk_fma_f32 v[50:51], v[224:225], v[224:225], v[50:51]
    v_pk_fma_f32 v[52:53], v[224:225], v[176:177], v[52:53]
    v_pk_add_f32 v[48:49], v[48:49], v[226:227]
    v_pk_fma_f32 v[50:51], v[226:227], v[226:227], v[50:51]
    v_pk_fma_f32 v[52:53], v[226:227], v[178:179], v[52:53]
    v_pk_add_f32 v[48:49], v[48:49], v[228:229]
    v_pk_fma_f32 v[50:51], v[228:229], v[228:229], v[50:51]
    v_pk_fma_f32 v[52:53], v[228:229], v[180:181], v[52:53]
    v_pk_add_f32 v[48:49], v[48:49], v[230:231]
    v_pk_fma_f32 v[50:51], v[230:231], v[230:231], v[50:51]
    v_pk_fma_f32 v[52:53], v[230:231], v[182:183], v[52:53]
    v_add_f32 v48, v48, v49
    v_add_f32 v50, v50, v51
    v_add_f32 v52, v52, v53
    v_add_f32_dpp v48, v48, v48 row_ror:8 row_mask:0xf bank_mask:0xf
    v_add_f32_dpp v50, v50, v50 row_ror:8 row_mask:0xf bank_mask:0xf
    v_add_f32_dpp v52, v52, v52 row_ror:8 row_mask:0xf bank_mask:0xf
    v_add_f32_dpp v48, v48, v48 row_ror:4 row_mask:0xf bank_mask:0xf
    v_add_f32_dpp v50, v50, v50 row_ror:4 row_mask:0xf bank_mask:0xf
    v_add_f32_dpp v52, v52, v52 row_ror:4 row_mask:0xf bank_mask:0xf
    v_add_f32_dpp v48, v48, v48 row_ror:2 row_mask:0xf bank_mask:0xf
    v_add_f32_dpp v50, v50, v50 row_ror:2 row_mask:0xf bank_mask:0xf
    v_add_f32_dpp v52, v52, v52 row_ror:2 row_mask:0xf bank_mask:0xf
    v_add_f32_dpp v48, v48, v48 row_ror:1 row_mask:0xf bank_mask:0xf
    v_add_f32_dpp v50, v50, v50 row_ror:1 row_mask:0xf bank_mask:0xf
    v_add_f32_dpp v52, v52, v52 row_ror:1 row_mask:0xf bank_mask:0xf
    v_mov_b32 v49, v48
    v_mov_b32 v51, v50
    v_mov_b32 v53, v52
    v_permlane16_swap_b32 v48, v49
    v_permlane16_swap_b32 v50, v51
    v_permlane16_swap_b32 v52, v53
    v_add_f32 v48, v48, v49
    v_add_f32 v50, v50, v51
    v_add_f32 v52, v52, v53
    v_mul_f32 v48, 0x3ae38e39, v48
    v_mul_f32 v50, 0x3ae38e39, v50
    v_fma_f32 v50, -v48, v48, v50
    v_add_f32 v48, v48, v88
    v_max_f32 v50, 0, v50
    v_cvt_pk_bf16_f32 v48, v48, v50
    v_and_b32 v50, 0xffff0000, v48
    v_lshlrev_b32 v48, 16, v48
    v_add_f32 v50, 0x3727c5ac, v50
    v_sub_f32 v48, v88, v48
    v_cvt_pk_bf16_f32 v50, v50, v50
    v_and_b32 v50, 0xffff0000, v50
    v_sqrt_f32 v50, v50
    v_fmac_f32 v52, v48, v90
    v_cvt_pk_bf16_f32 v50, v50, v50
    v_and_b32 v50, 0xffff0000, v50
    v_rcp_f32 v50, v50
    s_mov_b32 exec_lo, 1
    s_mov_b32 exec_hi, 1
    v_fma_f32 v52, v52, v50, v91
    v_ashrrev_i32 v62, 31, v52
    v_or_b32 v62, 0x80000000, v62
    v_xor_b32 v52, v62, v52
    v_min_u32 v52, 0xfffff000, v52
    v_bfi_b32 v52, s48, v93, v52
    ds_write_b32 v92, v52 offset:36864
    s_mov_b64 exec, -1
    v_mul_f32 v48, v48, v50
    s_waitcnt lgkmcnt(0)
    s_barrier
    v_mov_b32 v109, 36864
    ds_read_b128 v[96:99], v109
    ds_read_b128 v[100:103], v109 offset:16
    s_lshl_b32 s45, s2, 7
    s_add_u32 s45, s45, 9306112
    s_cmp_eq_u32 s3, 0
    s_cselect_b32 s45, s45, 2147483648
    s_waitcnt lgkmcnt(1)
    v_max_u32 v104, v96, v97
    v_min_u32 v105, v96, v97
    v_med3_u32 v105, v104, v105, v98
    v_max_u32 v104, v104, v98
    v_med3_u32 v105, v104, v105, v99
    v_max_u32 v104, v104, v99
    s_waitcnt lgkmcnt(0)
    v_med3_u32 v105, v104, v105, v100
    v_max_u32 v104, v104, v100
    v_med3_u32 v105, v104, v105, v101
    v_max_u32 v104, v104, v101
    v_med3_u32 v105, v104, v105, v102
    v_max_u32 v104, v104, v102
    v_med3_u32 v105, v104, v105, v103
    v_max_u32 v104, v104, v103
    buffer_store_dwordx2 v[104:105], v8, s[24:27], s45 offen sc1
    v_pk_fma_f32 v[216:217], v[216:217], v[50:51], v[48:49] op_sel_hi:[1,0,0]
    v_pk_fma_f32 v[218:219], v[218:219], v[50:51], v[48:49] op_sel_hi:[1,0,0]
    v_pk_fma_f32 v[220:221], v[220:221], v[50:51], v[48:49] op_sel_hi:[1,0,0]
    v_pk_fma_f32 v[222:223], v[222:223], v[50:51], v[48:49] op_sel_hi:[1,0,0]
    v_pk_fma_f32 v[224:225], v[224:225], v[50:51], v[48:49] op_sel_hi:[1,0,0]
    v_pk_fma_f32 v[226:227], v[226:227], v[50:51], v[48:49] op_sel_hi:[1,0,0]
    v_pk_fma_f32 v[228:229], v[228:229], v[50:51], v[48:49] op_sel_hi:[1,0,0]
    v_pk_fma_f32 v[230:231], v[230:231], v[50:51], v[48:49] op_sel_hi:[1,0,0]
    v_pk_fma_f32 v[232:233], v[232:233], v[50:51], v[48:49] op_sel_hi:[1,0,0]
    v_pk_fma_f32 v[234:235], v[234:235], v[50:51], v[48:49] op_sel_hi:[1,0,0]
    v_pk_fma_f32 v[236:237], v[236:237], v[50:51], v[48:49] op_sel_hi:[1,0,0]
    v_pk_fma_f32 v[238:239], v[238:239], v[50:51], v[48:49] op_sel_hi:[1,0,0]
    v_pk_fma_f32 v[216:217], v[216:217], v[120:121], v[144:145]
    v_pk_fma_f32 v[218:219], v[218:219], v[122:123], v[146:147]
    v_pk_fma_f32 v[220:221], v[220:221], v[124:125], v[148:149]
    v_pk_fma_f32 v[222:223], v[222:223], v[126:127], v[150:151]
    v_pk_fma_f32 v[224:225], v[224:225], v[128:129], v[152:153]
    v_pk_fma_f32 v[226:227], v[226:227], v[130:131], v[154:155]
    v_pk_fma_f32 v[228:229], v[228:229], v[132:133], v[156:157]
    v_pk_fma_f32 v[230:231], v[230:231], v[134:135], v[158:159]
    v_pk_fma_f32 v[232:233], v[232:233], v[136:137], v[160:161]
    v_pk_fma_f32 v[234:235], v[234:235], v[138:139], v[162:163]
    v_pk_fma_f32 v[236:237], v[236:237], v[140:141], v[164:165]
    v_pk_fma_f32 v[238:239], v[238:239], v[142:143], v[166:167]
    v_cvt_pk_bf16_f32 v64, v216, v217
    v_cvt_pk_bf16_f32 v65, v218, v219
    v_cvt_pk_bf16_f32 v66, v220, v221
    v_cvt_pk_bf16_f32 v67, v222, v223
    v_cvt_pk_bf16_f32 v68, v224, v225
    v_cvt_pk_bf16_f32 v69, v226, v227
    v_cvt_pk_bf16_f32 v70, v228, v229
    v_cvt_pk_bf16_f32 v71, v230, v231
    v_cvt_pk_bf16_f32 v72, v232, v233
    v_cvt_pk_bf16_f32 v73, v234, v235
    v_cvt_pk_bf16_f32 v74, v236, v237
    v_cvt_pk_bf16_f32 v75, v238, v239
    v_and_b32 v106, 0x7ff, v104
    v_and_b32 v107, 0x7ff, v105
    v_cmp_eq_u32 vcc, v106, v93
    v_cmp_eq_u32 s[36:37], v107, v93
    v_mov_b32 v106, 2147483648
    s_or_b64 vcc, vcc, s[36:37]
    s_mov_b32 s45, 2621440
    s_nop 0
    v_cndmask_b32 v6, v106, v6, vcc
    v_cndmask_b32 v60, v106, v60, vcc
    buffer_store_dwordx4 v[64:67], v6, s[24:27], s45 offen offset:0 sc1
    buffer_store_dwordx4 v[68:71], v6, s[24:27], s45 offen offset:512 sc1
    buffer_store_dwordx4 v[72:75], v60, s[24:27], s45 offen offset:1024 sc1
    s_cmp_ge_u32 s41, 18
    s_cbranch_scc1 Ltail_idle
    s_mov_b32 s36, 2622592
    buffer_store_dwordx4 v[36:39], v6, s[24:27], s36 offen offset:0 sc1
    buffer_store_dwordx4 v[40:43], v6, s[24:27], s36 offen offset:512 sc1
    buffer_store_dwordx4 v[44:47], v60, s[24:27], s36 offen offset:1024 sc1
    v_lshlrev_b32 v216, 16, v64
    v_and_b32 v217, 0xffff0000, v64
    v_lshlrev_b32 v218, 16, v65
    v_and_b32 v219, 0xffff0000, v65
    v_lshlrev_b32 v220, 16, v66
    v_and_b32 v221, 0xffff0000, v66
    v_lshlrev_b32 v222, 16, v67
    v_and_b32 v223, 0xffff0000, v67
    v_lshlrev_b32 v224, 16, v68
    v_and_b32 v225, 0xffff0000, v68
    v_lshlrev_b32 v226, 16, v69
    v_and_b32 v227, 0xffff0000, v69
    v_lshlrev_b32 v228, 16, v70
    v_and_b32 v229, 0xffff0000, v70
    v_lshlrev_b32 v230, 16, v71
    v_and_b32 v231, 0xffff0000, v71
    v_lshlrev_b32 v232, 16, v72
    v_and_b32 v233, 0xffff0000, v72
    v_lshlrev_b32 v234, 16, v73
    v_and_b32 v235, 0xffff0000, v73
    v_lshlrev_b32 v236, 16, v74
    v_and_b32 v237, 0xffff0000, v74
    v_lshlrev_b32 v238, 16, v75
    v_and_b32 v239, 0xffff0000, v75
    v_pk_mul_f32 v[192:193], v[192:193], v[216:217]
    v_pk_mul_f32 v[194:195], v[194:195], v[218:219]
    v_pk_mul_f32 v[196:197], v[196:197], v[220:221]
    v_pk_mul_f32 v[198:199], v[198:199], v[222:223]
    v_pk_mul_f32 v[200:201], v[200:201], v[224:225]
    v_pk_mul_f32 v[202:203], v[202:203], v[226:227]
    v_pk_mul_f32 v[204:205], v[204:205], v[228:229]
    v_pk_mul_f32 v[206:207], v[206:207], v[230:231]
    v_pk_mul_f32 v[208:209], v[208:209], v[232:233]
    v_pk_mul_f32 v[210:211], v[210:211], v[234:235]
    v_pk_mul_f32 v[212:213], v[212:213], v[236:237]
    v_pk_mul_f32 v[214:215], v[214:215], v[238:239]
    v_cvt_pk_bf16_f32 v144, v192, v193
    v_cvt_pk_bf16_f32 v145, v194, v195
    v_cvt_pk_bf16_f32 v146, v196, v197
    v_cvt_pk_bf16_f32 v147, v198, v199
    v_cvt_pk_bf16_f32 v148, v200, v201
    v_cvt_pk_bf16_f32 v149, v202, v203
    v_cvt_pk_bf16_f32 v150, v204, v205
    v_cvt_pk_bf16_f32 v151, v206, v207
    v_cvt_pk_bf16_f32 v152, v208, v209
    v_cvt_pk_bf16_f32 v153, v210, v211
    v_cvt_pk_bf16_f32 v154, v212, v213
    v_cvt_pk_bf16_f32 v155, v214, v215
    v_lshlrev_b32 v192, 16, v144
    v_and_b32 v193, 0xffff0000, v144
    v_lshlrev_b32 v194, 16, v145
    v_and_b32 v195, 0xffff0000, v145
    v_lshlrev_b32 v196, 16, v146
    v_and_b32 v197, 0xffff0000, v146
    v_lshlrev_b32 v198, 16, v147
    v_and_b32 v199, 0xffff0000, v147
    v_lshlrev_b32 v200, 16, v148
    v_and_b32 v201, 0xffff0000, v148
    v_lshlrev_b32 v202, 16, v149
    v_and_b32 v203, 0xffff0000, v149
    v_lshlrev_b32 v204, 16, v150
    v_and_b32 v205, 0xffff0000, v150
    v_lshlrev_b32 v206, 16, v151
    v_and_b32 v207, 0xffff0000, v151
    v_lshlrev_b32 v208, 16, v152
    v_and_b32 v209, 0xffff0000, v152
    v_lshlrev_b32 v210, 16, v153
    v_and_b32 v211, 0xffff0000, v153
    v_lshlrev_b32 v212, 16, v154
    v_and_b32 v213, 0xffff0000, v154
    v_lshlrev_b32 v214, 16, v155
    v_and_b32 v215, 0xffff0000, v155
    v_pk_add_f32 v[192:193], v[192:193], v[12:13]
    v_pk_add_f32 v[194:195], v[194:195], v[14:15]
    v_pk_add_f32 v[196:197], v[196:197], v[16:17]
    v_pk_add_f32 v[198:199], v[198:199], v[18:19]
    v_pk_add_f32 v[200:201], v[200:201], v[20:21]
    v_pk_add_f32 v[202:203], v[202:203], v[22:23]
    v_pk_add_f32 v[204:205], v[204:205], v[24:25]
    v_pk_add_f32 v[206:207], v[206:207], v[26:27]
    v_pk_add_f32 v[208:209], v[208:209], v[28:29]
    v_pk_add_f32 v[210:211], v[210:211], v[30:31]
    v_pk_add_f32 v[212:213], v[212:213], v[32:33]
    v_pk_add_f32 v[214:215], v[214:215], v[34:35]
    v_cvt_pk_bf16_f32 v156, v192, v193
    v_cvt_pk_bf16_f32 v157, v194, v195
    v_cvt_pk_bf16_f32 v158, v196, v197
    v_cvt_pk_bf16_f32 v159, v198, v199
    v_cvt_pk_bf16_f32 v160, v200, v201
    v_cvt_pk_bf16_f32 v161, v202, v203
    v_cvt_pk_bf16_f32 v162, v204, v205
    v_cvt_pk_bf16_f32 v163, v206, v207
    v_cvt_pk_bf16_f32 v164, v208, v209
    v_cvt_pk_bf16_f32 v165, v210, v211
    v_cvt_pk_bf16_f32 v166, v212, v213
    v_cvt_pk_bf16_f32 v167, v214, v215
    v_and_b32 v30, 2, v1
    v_cmp_ne_u32 vcc, 0, v30
    v_mul_u32_u24 v30, 1152, v7
    v_add_u32 v4, v30, v5
    v_add_u32 v58, v30, v59
    v_mov_b32_dpp v192, v158 quad_perm:[0,2,0,2] row_mask:0xf bank_mask:0xf
    v_mov_b32_dpp v193, v159 quad_perm:[0,2,0,2] row_mask:0xf bank_mask:0xf
    v_mov_b32_dpp v194, v158 quad_perm:[1,3,1,3] row_mask:0xf bank_mask:0xf
    v_mov_b32_dpp v195, v159 quad_perm:[1,3,1,3] row_mask:0xf bank_mask:0xf
    v_mov_b32_dpp v196, v162 quad_perm:[0,2,0,2] row_mask:0xf bank_mask:0xf
    v_mov_b32_dpp v197, v163 quad_perm:[0,2,0,2] row_mask:0xf bank_mask:0xf
    v_mov_b32_dpp v198, v162 quad_perm:[1,3,1,3] row_mask:0xf bank_mask:0xf
    v_mov_b32_dpp v199, v163 quad_perm:[1,3,1,3] row_mask:0xf bank_mask:0xf
    v_mov_b32_dpp v200, v166 quad_perm:[0,2,0,2] row_mask:0xf bank_mask:0xf
    v_mov_b32_dpp v201, v167 quad_perm:[0,2,0,2] row_mask:0xf bank_mask:0xf
    v_mov_b32_dpp v202, v166 quad_perm:[1,3,1,3] row_mask:0xf bank_mask:0xf
    v_mov_b32_dpp v203, v167 quad_perm:[1,3,1,3] row_mask:0xf bank_mask:0xf
    v_cndmask_b32_dpp v144, v156, v192, vcc quad_perm:[0,2,0,2] row_mask:0xf bank_mask:0xf
    v_cndmask_b32_dpp v145, v157, v193, vcc quad_perm:[0,2,0,2] row_mask:0xf bank_mask:0xf
    v_cndmask_b32_dpp v146, v156, v194, vcc quad_perm:[1,3,1,3] row_mask:0xf bank_mask:0xf
    v_cndmask_b32_dpp v147, v157, v195, vcc quad_perm:[1,3,1,3] row_mask:0xf bank_mask:0xf
    v_cndmask_b32_dpp v148, v160, v196, vcc quad_perm:[0,2,0,2] row_mask:0xf bank_mask:0xf
    v_cndmask_b32_dpp v149, v161, v197, vcc quad_perm:[0,2,0,2] row_mask:0xf bank_mask:0xf
    v_cndmask_b32_dpp v150, v160, v198, vcc quad_perm:[1,3,1,3] row_mask:0xf bank_mask:0xf
    v_cndmask_b32_dpp v151, v161, v199, vcc quad_perm:[1,3,1,3] row_mask:0xf bank_mask:0xf
    v_cndmask_b32_dpp v152, v164, v200, vcc quad_perm:[0,2,0,2] row_mask:0xf bank_mask:0xf
    v_cndmask_b32_dpp v153, v165, v201, vcc quad_perm:[0,2,0,2] row_mask:0xf bank_mask:0xf
    v_cndmask_b32_dpp v154, v164, v202, vcc quad_perm:[1,3,1,3] row_mask:0xf bank_mask:0xf
    v_cndmask_b32_dpp v155, v165, v203, vcc quad_perm:[1,3,1,3] row_mask:0xf bank_mask:0xf
    v_lshlrev_b32 v13, 4, v1
    v_add_u32 v13, 32768, v13
    s_lshl_b32 s44, s3, 10
    v_add_u32 v14, s44, v13
    v_and_b32 v13, 0xffffff1f, v13
    v_bfe_u32 v15, v1, 2, 2
    v_cmp_eq_u32 s[52:53], 0, v15
    v_cmp_eq_u32 s[54:55], 1, v15
    v_cmp_eq_u32 s[56:57], 2, v15
    v_cmp_eq_u32 s[58:59], 3, v15
    s_mul_i32 s43, s42, 18
    s_add_u32 s43, s43, s41
    s_lshl_b32 s43, s43, 9
    s_mul_i32 s44, s3, 73728
    s_add_u32 s43, s43, s44
    v_lshlrev_b32 v15, 3, v1
    v_and_b32 v10, 1, v1
    v_and_b32 v9, 48, v1
    s_mul_i32 s38, s3, 3072
    s_add_u32 s38, s38, 49152
    v_lshl_add_u32 v11, v10, 9, v9
    v_add_u32 v11, s38, v11
    v_lshrrev_b32 v10, 5, v1
    v_and_b32 v9, 31, v1
    v_lshlrev_b32 v9, 4, v9
    v_lshlrev_b32 v108, 7, v0
    s_mov_b32 s45, 9306112
    s_lshl_b32 s36, s3, 3
    v_mov_b32 v109, s36
    s_mov_b32 s48, 16384
Ltail_pollk:
    buffer_load_dwordx2 v[104:105], v108, s[24:27], s45 offen sc1
    s_sub_u32 s48, s48, 1
    s_cbranch_scc1 Ltail_gotk
    s_waitcnt vmcnt(0)
    v_max_u32 v106, v104, v105
    v_cmp_eq_u32 vcc, -1, v106
    s_cbranch_vccnz Ltail_pollk
Ltail_gotk:
    s_waitcnt vmcnt(0)
    v_mov_b32_dpp v106, v104 row_ror:1 row_mask:0xf bank_mask:0xf
    v_mov_b32_dpp v107, v105 row_ror:1 row_mask:0xf bank_mask:0xf
    v_min_u32 v110, v104, v106
    v_max_u32 v104, v104, v106
    v_max3_u32 v105, v110, v105, v107
    s_nop 0
    v_mov_b32_dpp v106, v104 row_ror:2 row_mask:0xf bank_mask:0xf
    v_mov_b32_dpp v107, v105 row_ror:2 row_mask:0xf bank_mask:0xf
    v_min_u32 v110, v104, v106
    v_max_u32 v104, v104, v106
    v_max3_u32 v105, v110, v105, v107
    s_nop 0
    v_mov_b32_dpp v106, v104 row_ror:4 row_mask:0xf bank_mask:0xf
    v_mov_b32_dpp v107, v105 row_ror:4 row_mask:0xf bank_mask:0xf
    v_min_u32 v110, v104, v106
    v_max_u32 v104, v104, v106
    v_max3_u32 v105, v110, v105, v107
    s_nop 0
    v_mov_b32_dpp v106, v104 row_ror:8 row_mask:0xf bank_mask:0xf
    v_mov_b32_dpp v107, v105 row_ror:8 row_mask:0xf bank_mask:0xf
    v_min_u32 v110, v104, v106
    v_max_u32 v104, v104, v106
    v_max3_u32 v105, v110, v105, v107
    v_mov_b32 v106, v104
    v_mov_b32 v107, v105
    s_nop 0
    v_permlane16_swap_b32 v104, v106
    v_permlane16_swap_b32 v105, v107
    v_min_u32 v110, v104, v106
    v_max_u32 v104, v104, v106
    v_max3_u32 v105, v110, v105, v107
    v_mov_b32 v106, v104
    v_mov_b32 v107, v105
    s_nop 0
    v_permlane32_swap_b32 v104, v106
    v_permlane32_swap_b32 v105, v107
    v_min_u32 v110, v104, v106
    v_max_u32 v104, v104, v106
    v_max3_u32 v105, v110, v105, v107
    ds_write_b64 v109, v[104:105] offset:36928
    v_mov_b32 v109, 36928
    s_waitcnt lgkmcnt(0)
    s_barrier
    ds_read_b128 v[96:99], v109
    ds_read_b128 v[100:103], v109 offset:16
    s_waitcnt lgkmcnt(1)
    v_max_u32 v104, v96, v97
    v_min_u32 v105, v96, v97
    v_med3_u32 v105, v104, v105, v98
    v_max_u32 v104, v104, v98
    v_med3_u32 v105, v104, v105, v99
    v_max_u32 v104, v104, v99
    s_waitcnt lgkmcnt(0)
    v_med3_u32 v105, v104, v105, v100
    v_max_u32 v104, v104, v100
    v_med3_u32 v105, v104, v105, v101
    v_max_u32 v104, v104, v101
    v_med3_u32 v105, v104, v105, v102
    v_max_u32 v104, v104, v102
    v_med3_u32 v105, v104, v105, v103
    v_max_u32 v104, v104, v103
    s_nop 0
    v_readfirstlane_b32 s92, v104
    v_readfirstlane_b32 s93, v105
    s_andn2_b32 s46, 0x7ff, s92
    s_andn2_b32 s47, 0x7ff, s93
    s_mul_i32 s44, s46, 2304
    s_mul_i32 s45, s47, 2304
    s_sub_u32 s45, s45, s44
    v_mad_i32_i24 v10, v10, s45, v9
    s_add_u32 s45, s44, 2621440
    v_add_u32 v10, s45, v10
    s_mov_b32 s48, 16384
Ltail_pollh:
    s_mov_b32 exec_lo, 0xffffff
    s_mov_b32 exec_hi, 0xffffff
    s_add_u32 m0, s38, 0
    s_nop 0
    buffer_load_dwordx4 v10, s[24:27], 0 offen offset:0 sc1 lds
    s_add_u32 m0, s38, 640
    s_nop 0
    buffer_load_dwordx4 v10, s[24:27], 0 offen offset:384 sc1 lds
    s_add_u32 m0, s38, 1280
    s_nop 0
    buffer_load_dwordx4 v10, s[24:27], 0 offen offset:768 sc1 lds
    s_mov_b64 exec, -1
    s_waitcnt vmcnt(0)
    ds_read_b128 a[0:3], v11 offset:0
    ds_read_b128 a[4:7], v11 offset:64
    ds_read_b128 a[8:11], v11 offset:128
    ds_read_b128 a[12:15], v11 offset:192
    ds_read_b128 a[16:19], v11 offset:256
    ds_read_b128 a[20:23], v11 offset:320
    ds_read_b128 a[24:27], v11 offset:1024
    ds_read_b128 a[28:31], v11 offset:1088
    ds_read_b128 a[32:35], v11 offset:1152
    ds_read_b128 a[36:39], v11 offset:1216
    ds_read_b128 a[40:43], v11 offset:1280
    ds_read_b128 a[44:47], v11 offset:1344
    ds_read_b128 a[48:51], v11 offset:2048
    ds_read_b128 a[52:55], v11 offset:2112
    ds_read_b128 a[56:59], v11 offset:2176
    ds_read_b128 a[60:63], v11 offset:2240
    ds_read_b128 a[64:67], v11 offset:2304
    ds_read_b128 a[68:71], v11 offset:2368
    s_waitcnt lgkmcnt(15)
    v_mfma_f32_16x16x32_bf16 v[16:19], a[96:99], a[0:3], 0
    v_mfma_f32_16x16x32_bf16 v[20:23], a[100:103], a[4:7], 0
    v_mfma_f32_16x16x32_bf16 v[16:19], a[104:107], a[8:11], v[16:19]
    s_waitcnt lgkmcnt(14)
    v_mfma_f32_16x16x32_bf16 v[20:23], a[108:111], a[12:15], v[20:23]
    s_waitcnt lgkmcnt(13)
    v_mfma_f32_16x16x32_bf16 v[16:19], a[112:115], a[16:19], v[16:19]
    s_waitcnt lgkmcnt(12)
    v_mfma_f32_16x16x32_bf16 v[20:23], a[116:119], a[20:23], v[20:23]
    s_waitcnt lgkmcnt(11)
    v_mfma_f32_16x16x32_bf16 v[16:19], a[120:123], a[24:27], v[16:19]
    s_waitcnt lgkmcnt(10)
    v_mfma_f32_16x16x32_bf16 v[20:23], a[124:127], a[28:31], v[20:23]
    s_waitcnt lgkmcnt(9)
    v_mfma_f32_16x16x32_bf16 v[16:19], a[128:131], a[32:35], v[16:19]
    s_waitcnt lgkmcnt(8)
    v_mfma_f32_16x16x32_bf16 v[20:23], a[132:135], a[36:39], v[20:23]
    s_waitcnt lgkmcnt(7)
    v_mfma_f32_16x16x32_bf16 v[16:19], a[136:139], a[40:43], v[16:19]
    s_waitcnt lgkmcnt(6)
    v_mfma_f32_16x16x32_bf16 v[20:23], a[140:143], a[44:47], v[20:23]
    s_waitcnt lgkmcnt(5)
    v_mfma_f32_16x16x32_bf16 v[16:19], a[144:147], a[48:51], v[16:19]
    s_waitcnt lgkmcnt(4)
    v_mfma_f32_16x16x32_bf16 v[20:23], a[148:151], a[52:55], v[20:23]
    s_waitcnt lgkmcnt(3)
    v_mfma_f32_16x16x32_bf16 v[16:19], a[152:155], a[56:59], v[16:19]
    s_waitcnt lgkmcnt(2)
    v_mfma_f32_16x16x32_bf16 v[20:23], a[156:159], a[60:63], v[20:23]
    s_waitcnt lgkmcnt(1)
    v_mfma_f32_16x16x32_bf16 v[16:19], a[160:163], a[64:67], v[16:19]
    s_waitcnt lgkmcnt(0)
    v_mfma_f32_16x16x32_bf16 v[20:23], a[164:167], a[68:71], v[20:23]
    s_sub_u32 s48, s48, 1
    s_nop 6
    v_pk_add_f32 v[16:17], v[16:17], v[20:21]
    v_pk_add_f32 v[18:19], v[18:19], v[22:23]
    s_cbranch_scc1 Ltail_goth
    v_cmp_u_f32 vcc, v16, v16
    s_and_b32 s36, vcc_lo, 3
    s_cbranch_scc1 Ltail_pollh
Ltail_goth:
    ds_write_b128 v14, v[16:19]
    s_waitcnt lgkmcnt(0)
    s_barrier
    ds_read_b128 v[16:19], v13 offset:0
    ds_read_b128 v[20:23], v13 offset:1024
    ds_read_b128 v[24:27], v13 offset:2048
    ds_read_b128 v[28:31], v13 offset:3072
    s_mov_b32 s36, 0xbfb8aa3b
    s_mov_b32 s37, 0xbfb8aa3b
    s_waitcnt lgkmcnt(3)
    v_cvt_pk_bf16_f32 v32, v16, v17
    v_cvt_pk_bf16_f32 v33, v18, v19
    s_waitcnt lgkmcnt(2)
    v_cvt_pk_bf16_f32 v34, v20, v21
    v_cvt_pk_bf16_f32 v35, v22, v23
    v_lshlrev_b32 v16, 16, v32
    v_and_b32 v17, 0xffff0000, v32
    v_lshlrev_b32 v18, 16, v33
    v_and_b32 v19, 0xffff0000, v33
    v_lshlrev_b32 v20, 16, v34
    v_and_b32 v21, 0xffff0000, v34
    v_lshlrev_b32 v22, 16, v35
    v_and_b32 v23, 0xffff0000, v35
    v_pk_mul_f32 v[32:33], v[16:17], s[36:37]
    v_pk_mul_f32 v[34:35], v[18:19], s[36:37]
    v_pk_mul_f32 v[36:37], v[20:21], s[36:37]
    v_pk_mul_f32 v[38:39], v[22:23], s[36:37]
    v_exp_f32 v32, v32
    v_exp_f32 v33, v33
    v_exp_f32 v34, v34
    v_exp_f32 v35, v35
    v_exp_f32 v36, v36
    v_exp_f32 v37, v37
    v_exp_f32 v38, v38
    v_exp_f32 v39, v39
    s_waitcnt lgkmcnt(1)
    v_cvt_pk_bf16_f32 v60, v24, v25
    v_cvt_pk_bf16_f32 v61, v26, v27
    s_waitcnt lgkmcnt(0)
    v_cvt_pk_bf16_f32 v62, v28, v29
    v_cvt_pk_bf16_f32 v63, v30, v31
    v_pk_add_f32 v[32:33], v[32:33], 1.0 op_sel_hi:[1,0]
    v_pk_add_f32 v[34:35], v[34:35], 1.0 op_sel_hi:[1,0]
    v_pk_add_f32 v[36:37], v[36:37], 1.0 op_sel_hi:[1,0]
    v_pk_add_f32 v[38:39], v[38:39], 1.0 op_sel_hi:[1,0]
    v_rcp_f32 v32, v32
    v_rcp_f32 v33, v33
    v_rcp_f32 v34, v34
    v_rcp_f32 v35, v35
    v_rcp_f32 v36, v36
    v_rcp_f32 v37, v37
    v_rcp_f32 v38, v38
    v_rcp_f32 v39, v39
    v_lshlrev_b32 v24, 16, v60
    v_and_b32 v25, 0xffff0000, v60
    v_lshlrev_b32 v26, 16, v61
    v_and_b32 v27, 0xffff0000, v61
    v_lshlrev_b32 v28, 16, v62
    v_and_b32 v29, 0xffff0000, v62
    v_lshlrev_b32 v30, 16, v63
    v_and_b32 v31, 0xffff0000, v63
    v_pk_mul_f32 v[16:17], v[16:17], v[32:33]
    v_pk_mul_f32 v[18:19], v[18:19], v[34:35]
    v_pk_mul_f32 v[20:21], v[20:21], v[36:37]
    v_pk_mul_f32 v[22:23], v[22:23], v[38:39]
    v_cvt_pk_bf16_f32 v32, v16, v17
    v_cvt_pk_bf16_f32 v33, v18, v19
    v_cvt_pk_bf16_f32 v34, v20, v21
    v_cvt_pk_bf16_f32 v35, v22, v23
    v_lshlrev_b32 v16, 16, v32
    v_and_b32 v17, 0xffff0000, v32
    v_lshlrev_b32 v18, 16, v33
    v_and_b32 v19, 0xffff0000, v33
    v_lshlrev_b32 v20, 16, v34
    v_and_b32 v21, 0xffff0000, v34
Ltour13:
    s_cbranch_execz Ltour17
    v_lshlrev_b32 v22, 16, v35
    v_and_b32 v23, 0xffff0000, v35
    v_pk_mul_f32 v[16:17], v[16:17], v[24:25]
    v_pk_mul_f32 v[18:19], v[18:19], v[26:27]
    v_pk_mul_f32 v[20:21], v[20:21], v[28:29]
    v_pk_mul_f32 v[22:23], v[22:23], v[30:31]
    v_cvt_pk_bf16_f32 v32, v16, v17
    v_cvt_pk_bf16_f32 v33, v18, v19
    v_cvt_pk_bf16_f32 v34, v20, v21
    v_cvt_pk_bf16_f32 v35, v22, v23
    v_cndmask_b32 v64, 0, v32, s[52:53]
    v_cndmask_b32 v65, 0, v33, s[52:53]
    v_cndmask_b32 v66, 0, v34, s[52:53]
    v_cndmask_b32 v67, 0, v35, s[52:53]
    v_cndmask_b32 v68, 0, v32, s[54:55]
    v_cndmask_b32 v69, 0, v33, s[54:55]
    v_cndmask_b32 v70, 0, v34, s[54:55]
    v_cndmask_b32 v71, 0, v35, s[54:55]
    v_cndmask_b32 v72, 0, v32, s[56:57]
    v_cndmask_b32 v73, 0, v33, s[56:57]
    v_cndmask_b32 v74, 0, v34, s[56:57]
    v_cndmask_b32 v75, 0, v35, s[56:57]
    v_cndmask_b32 v76, 0, v32, s[58:59]
    v_cndmask_b32 v77, 0, v33, s[58:59]
    v_cndmask_b32 v78, 0, v34, s[58:59]
    v_cndmask_b32 v79, 0, v35, s[58:59]
    v_mfma_f32_16x16x32_bf16 v[16:19], v[64:67], a[168:171], 0
    v_mfma_f32_16x16x32_bf16 v[16:19], v[68:71], a[172:175], v[16:19]
    v_mfma_f32_16x16x32_bf16 v[16:19], v[72:75], a[176:179], v[16:19]
    v_mfma_f32_16x16x32_bf16 v[16:19], v[76:79], a[180:183], v[16:19]
    v_mfma_f32_16x16x32_bf16 v[20:23], v[64:67], a[184:187], 0
    v_mfma_f32_16x16x32_bf16 v[20:23], v[68:71], a[188:191], v[20:23]
    v_mfma_f32_16x16x32_bf16 v[20:23], v[72:75], a[192:195], v[20:23]
    v_mfma_f32_16x16x32_bf16 v[20:23], v[76:79], a[196:199], v[20:23]
    v_mfma_f32_16x16x32_bf16 v[24:27], v[64:67], a[200:203], 0
    v_mfma_f32_16x16x32_bf16 v[24:27], v[68:71], a[204:207], v[24:27]
    v_mfma_f32_16x16x32_bf16 v[24:27], v[72:75], a[208:211], v[24:27]
    v_mfma_f32_16x16x32_bf16 v[24:27], v[76:79], a[212:215], v[24:27]
    v_min_u32 v16, -2, v16
    v_min_u32 v17, -2, v17
    buffer_store_dwordx2 v[16:17], v15, s[8:11], s43 offen sc1
    s_add_u32 s43, s43, 294912
    v_min_u32 v20, -2, v20
    v_min_u32 v21, -2, v21
    buffer_store_dwordx2 v[20:21], v15, s[8:11], s43 offen sc1
    s_add_u32 s43, s43, 294912
    v_min_u32 v24, -2, v24
    v_min_u32 v25, -2, v25
    buffer_store_dwordx2 v[24:25], v15, s[8:11], s43 offen sc1
    s_or_b32 s36, s2, s3
    s_cselect_b32 s37, -4, 24576
    s_add_u32 s36, s94, 1
    v_mov_b32 v106, s36
    buffer_store_dword v106, v8, s[24:27], s37 offen sc1
    v_cmp_ne_u32 vcc, s46, v7
    v_cmp_ne_u32 s[36:37], s47, v7
    v_mov_b32 v31, 2147483648
    s_and_b64 vcc, vcc, s[36:37]
    s_nop 1
    v_cndmask_b32 v30, v31, v58, vcc
    v_cndmask_b32 v31, v31, v4, vcc
    buffer_store_dwordx4 v[144:147], v31, s[16:19], 0 offen offset:0 nt
    buffer_store_dwordx4 v[148:151], v31, s[16:19], 0 offen offset:512 nt
    buffer_store_dwordx4 v[152:155], v30, s[16:19], 0 offen offset:1024 nt
    s_cmp_lt_u32 s41, 9
    s_cselect_b32 s36, s3, 0
    s_cmp_lg_u32 s36, 3
    s_cbranch_scc1 Ltail_done
    s_mul_i32 s43, s42, 9
    s_add_u32 s43, s43, s41
    v_bfe_u32 v8, v1, 2, 1
    v_cmp_eq_u32 vcc, 1, v8
    v_mov_b32 v9, s46
    v_mov_b32 v10, s47
    v_and_b32 v11, 3, v1
    v_cndmask_b32 v9, v9, v10, vcc
    s_lshr_b32 s44, s43, 2
    s_lshl_b32 s44, s44, 6
    s_and_b32 s45, s43, 1
    s_lshl_b32 s45, s45, 5
    s_add_u32 s44, s44, s45
    s_and_b32 s45, s43, 2
    s_lshl_b32 s45, s45, 2
    s_add_u32 s44, s44, s45
    v_lshrrev_b32 v12, 1, v11
    v_lshl_add_u32 v12, v12, 4, s44
    v_and_b32 v13, 1, v11
    v_lshl_add_u32 v12, v13, 2, v12
    v_mul_u32_u24 v13, 1152, v9
    v_lshl_add_u32 v14, v13, 1, v12
    v_add_u32 v15, 2621440, v14
    s_mov_b32 s45, 22144
    buffer_load_dword v18, v12, s[24:27], s45 offen sc1
    v_mov_b32 v19, s92
    v_mov_b32 v10, s93
    v_cndmask_b32 v19, v19, v10, vcc
    v_and_b32 v19, 0xfffff800, v19
    v_or_b32 v19, 0x400, v19
    v_ashrrev_i32 v10, 31, v19
    v_not_b32 v10, v10
    v_or_b32 v10, 0x80000000, v10
    v_xor_b32 v19, v19, v10
    s_lshl_b32 s45, s43, 4
    v_lshl_add_u32 v13, v11, 2, v13
    v_add_u32 v13, s45, v13
    v_lshrrev_b32 v14, 2, v1
    v_lshlrev_b32 v14, 9, v14
    v_lshl_add_u32 v14, v11, 4, v14
    s_lshr_b32 s44, s43, 3
    s_mul_i32 s44, s44, 73728
    s_and_b32 s45, s43, 7
    s_lshl_b32 s45, s45, 6
    s_add_u32 s44, s44, s45
    v_cmp_eq_u32 s[38:39], 1, v8
    v_cvt_pk_bf16_f32 v19, v19, v19
    v_and_b32 v19, 0xffff0000, v19
    v_mul_f32 v19, 0xbfb8aa3b, v19
    v_exp_f32 v19, v19
    s_waitcnt vmcnt(0)
    v_lshlrev_b32 v24, 16, v18
    v_and_b32 v25, 0xffff0000, v18
    v_add_f32 v19, 1.0, v19
    v_rcp_f32 v19, v19
    s_mov_b32 s48, 16384
    v_cvt_pk_bf16_f32 v19, v19, v19
    v_and_b32 v19, 0xffff0000, v19
Ltail_polly:
    s_add_u32 s45, s44, 0
    buffer_load_dwordx4 v[64:67], v14, s[8:11], s45 offen sc1
    s_add_u32 s45, s44, 8192
    buffer_load_dwordx4 v[68:71], v14, s[8:11], s45 offen sc1
    s_add_u32 s45, s44, 16384
    buffer_load_dwordx4 v[72:75], v14, s[8:11], s45 offen sc1
    s_add_u32 s45, s44, 24576
    buffer_load_dwordx4 v[76:79], v14, s[8:11], s45 offen sc1
    s_add_u32 s45, s44, 32768
    buffer_load_dwordx4 v[80:83], v14, s[8:11], s45 offen sc1
    s_add_u32 s45, s44, 40960
    buffer_load_dwordx4 v[84:87], v14, s[8:11], s45 offen sc1
    s_add_u32 s45, s44, 49152
    buffer_load_dwordx4 v[88:91], v14, s[8:11], s45 offen sc1
    s_add_u32 s45, s44, 57344
    buffer_load_dwordx4 v[92:95], v14, s[8:11], s45 offen sc1
    s_add_u32 s45, s44, 65536
    buffer_load_dwordx4 v[96:99], v14, s[8:11], s45 offen sc1
    s_mov_b32 s45, 1152
    buffer_load_dword v16, v15, s[24:27], s45 offen sc1
    buffer_load_dword v17, v15, s[24:27], 0 offen sc1
    s_sub_u32 s48, s48, 1
    s_cbranch_scc1 Ltail_goty
    s_waitcnt vmcnt(10)
    v_max3_u32 v26, v64, v65, v66
    s_waitcnt vmcnt(9)
    v_max3_u32 v26, v26, v67, v68
    v_max3_u32 v26, v26, v69, v70
    s_waitcnt vmcnt(8)
    v_max3_u32 v26, v26, v71, v72
    v_max3_u32 v26, v26, v73, v74
    s_waitcnt vmcnt(7)
    v_max3_u32 v26, v26, v75, v76
    v_max3_u32 v26, v26, v77, v78
    s_waitcnt vmcnt(6)
    v_max3_u32 v26, v26, v79, v80
    v_max3_u32 v26, v26, v81, v82
    s_waitcnt vmcnt(5)
    v_max3_u32 v26, v26, v83, v84
    v_max3_u32 v26, v26, v85, v86
    s_waitcnt vmcnt(4)
    v_max3_u32 v26, v26, v87, v88
    v_max3_u32 v26, v26, v89, v90
    s_waitcnt vmcnt(3)
    v_max3_u32 v26, v26, v91, v92
    v_max3_u32 v26, v26, v93, v94
    s_waitcnt vmcnt(2)
    v_max3_u32 v26, v26, v95, v96
    v_max3_u32 v26, v26, v97, v98
    v_max_u32 v26, v26, v99
    s_waitcnt vmcnt(0)
    v_max3_u32 v26, v26, v16, v17
    v_cmp_eq_u32 vcc, -1, v26
    s_cbranch_vccnz Ltail_polly
Ltail_goty:
    s_waitcnt vmcnt(0) lgkmcnt(0)
    v_lshlrev_b32 v20, 16, v16
    v_and_b32 v21, 0xffff0000, v16
    v_lshlrev_b32 v22, 16, v17
    v_and_b32 v23, 0xffff0000, v17
    v_pk_add_f32 v[64:65], v[64:65], v[68:69]
    v_pk_add_f32 v[66:67], v[66:67], v[70:71]
    v_pk_add_f32 v[64:65], v[64:65], v[72:73]
    v_pk_add_f32 v[66:67], v[66:67], v[74:75]
    v_pk_add_f32 v[64:65], v[64:65], v[76:77]
    v_pk_add_f32 v[66:67], v[66:67], v[78:79]
    v_pk_add_f32 v[64:65], v[64:65], v[80:81]
    v_pk_add_f32 v[66:67], v[66:67], v[82:83]
    v_pk_add_f32 v[64:65], v[64:65], v[84:85]
    v_pk_add_f32 v[66:67], v[66:67], v[86:87]
    v_pk_add_f32 v[64:65], v[64:65], v[88:89]
    v_pk_add_f32 v[66:67], v[66:67], v[90:91]
    v_pk_add_f32 v[64:65], v[64:65], v[92:93]
    v_pk_add_f32 v[66:67], v[66:67], v[94:95]
    v_pk_add_f32 v[64:65], v[64:65], v[96:97]
    v_pk_add_f32 v[66:67], v[66:67], v[98:99]
    s_nop 0
    v_add_f32_dpp v64, v64, v64 row_ror:4 row_mask:0xf bank_mask:0xf
    v_add_f32_dpp v65, v65, v65 row_ror:4 row_mask:0xf bank_mask:0xf
    v_add_f32_dpp v66, v66, v66 row_ror:4 row_mask:0xf bank_mask:0xf
    v_add_f32_dpp v67, v67, v67 row_ror:4 row_mask:0xf bank_mask:0xf
    v_add_f32_dpp v64, v64, v64 row_ror:8 row_mask:0xf bank_mask:0xf
    v_add_f32_dpp v65, v65, v65 row_ror:8 row_mask:0xf bank_mask:0xf
    v_add_f32_dpp v66, v66, v66 row_ror:8 row_mask:0xf bank_mask:0xf
    v_add_f32_dpp v67, v67, v67 row_ror:8 row_mask:0xf bank_mask:0xf
    v_mov_b32 v68, v64
    v_mov_b32 v69, v65
    v_mov_b32 v70, v66
    v_mov_b32 v71, v67
    v_permlane16_swap_b32 v64, v68
    v_permlane16_swap_b32 v65, v69
    v_permlane16_swap_b32 v66, v70
    v_permlane16_swap_b32 v67, v71
    v_add_f32 v64, v64, v68
    v_add_f32 v65, v65, v69
    v_add_f32 v66, v66, v70
    v_add_f32 v67, v67, v71
    v_mov_b32 v68, v64
    v_mov_b32 v69, v65
    v_mov_b32 v70, v66
    v_mov_b32 v71, v67
    v_permlane32_swap_b32 v64, v68
    v_permlane32_swap_b32 v65, v69
    v_permlane32_swap_b32 v66, v70
    v_permlane32_swap_b32 v67, v71
    v_add_f32 v64, v64, v68
    v_add_f32 v65, v65, v69
    v_add_f32 v66, v66, v70
    v_add_f32 v67, v67, v71
    v_cndmask_b32 v26, v64, v65, s[38:39]
    v_cndmask_b32 v27, v66, v67, s[38:39]
    v_cvt_pk_bf16_f32 v28, v26, v27
    v_lshlrev_b32 v26, 16, v28
    v_and_b32 v27, 0xffff0000, v28
    v_mul_f32 v26, v26, v19
    v_mul_f32 v27, v27, v19
    v_cvt_pk_bf16_f32 v28, v26, v27
    v_lshlrev_b32 v26, 16, v28
    v_and_b32 v27, 0xffff0000, v28
    v_pk_add_f32 v[26:27], v[26:27], v[22:23]
    v_cvt_pk_bf16_f32 v28, v26, v27
    v_lshlrev_b32 v26, 16, v28
    v_and_b32 v27, 0xffff0000, v28
    v_pk_mul_f32 v[26:27], v[26:27], v[24:25]
    v_cvt_pk_bf16_f32 v28, v26, v27
    v_lshlrev_b32 v26, 16, v28
    v_and_b32 v27, 0xffff0000, v28
    v_pk_add_f32 v[26:27], v[26:27], v[20:21]
    v_cvt_pk_bf16_f32 v28, v26, v27
    s_mov_b64 exec, 0xff
    buffer_store_dword v28, v13, s[16:19], 0 offen nt
    s_branch Ltail_done
Ltail_idle:
Ltour14:
    s_cbranch_execz Lmain
    v_lshlrev_b32 v216, 16, v64
    v_and_b32 v217, 0xffff0000, v64
    v_lshlrev_b32 v218, 16, v65
    v_and_b32 v219, 0xffff0000, v65
    v_lshlrev_b32 v220, 16, v66
    v_and_b32 v221, 0xffff0000, v66
    v_lshlrev_b32 v222, 16, v67
    v_and_b32 v223, 0xffff0000, v67
    v_lshlrev_b32 v224, 16, v68
    v_and_b32 v225, 0xffff0000, v68
    v_lshlrev_b32 v226, 16, v69
    v_and_b32 v227, 0xffff0000, v69
    v_lshlrev_b32 v228, 16, v70
    v_and_b32 v229, 0xffff0000, v70
    v_lshlrev_b32 v230, 16, v71
    v_and_b32 v231, 0xffff0000, v71
    v_lshlrev_b32 v232, 16, v72
    v_and_b32 v233, 0xffff0000, v72
    v_lshlrev_b32 v234, 16, v73
    v_and_b32 v235, 0xffff0000, v73
    v_lshlrev_b32 v236, 16, v74
    v_and_b32 v237, 0xffff0000, v74
    v_lshlrev_b32 v238, 16, v75
    v_and_b32 v239, 0xffff0000, v75
    v_pk_mul_f32 v[192:193], v[192:193], v[216:217]
    v_pk_mul_f32 v[194:195], v[194:195], v[218:219]
    v_pk_mul_f32 v[196:197], v[196:197], v[220:221]
    v_pk_mul_f32 v[198:199], v[198:199], v[222:223]
    v_pk_mul_f32 v[200:201], v[200:201], v[224:225]
    v_pk_mul_f32 v[202:203], v[202:203], v[226:227]
    v_pk_mul_f32 v[204:205], v[204:205], v[228:229]
    v_pk_mul_f32 v[206:207], v[206:207], v[230:231]
    v_pk_mul_f32 v[208:209], v[208:209], v[232:233]
    v_pk_mul_f32 v[210:211], v[210:211], v[234:235]
    v_pk_mul_f32 v[212:213], v[212:213], v[236:237]
    v_pk_mul_f32 v[214:215], v[214:215], v[238:239]
    v_cvt_pk_bf16_f32 v144, v192, v193
    v_cvt_pk_bf16_f32 v145, v194, v195
    v_cvt_pk_bf16_f32 v146, v196, v197
    v_cvt_pk_bf16_f32 v147, v198, v199
    v_cvt_pk_bf16_f32 v148, v200, v201
    v_cvt_pk_bf16_f32 v149, v202, v203
    v_cvt_pk_bf16_f32 v150, v204, v205
    v_cvt_pk_bf16_f32 v151, v206, v207
    v_cvt_pk_bf16_f32 v152, v208, v209
    v_cvt_pk_bf16_f32 v153, v210, v211
    v_cvt_pk_bf16_f32 v154, v212, v213
    v_cvt_pk_bf16_f32 v155, v214, v215
    v_lshlrev_b32 v192, 16, v144
    v_and_b32 v193, 0xffff0000, v144
    v_lshlrev_b32 v194, 16, v145
    v_and_b32 v195, 0xffff0000, v145
    v_lshlrev_b32 v196, 16, v146
    v_and_b32 v197, 0xffff0000, v146
    v_lshlrev_b32 v198, 16, v147
    v_and_b32 v199, 0xffff0000, v147
    v_lshlrev_b32 v200, 16, v148
    v_and_b32 v201, 0xffff0000, v148
    v_lshlrev_b32 v202, 16, v149
    v_and_b32 v203, 0xffff0000, v149
    v_lshlrev_b32 v204, 16, v150
    v_and_b32 v205, 0xffff0000, v150
    v_lshlrev_b32 v206, 16, v151
    v_and_b32 v207, 0xffff0000, v151
    v_lshlrev_b32 v208, 16, v152
    v_and_b32 v209, 0xffff0000, v152
    v_lshlrev_b32 v210, 16, v153
    v_and_b32 v211, 0xffff0000, v153
    v_lshlrev_b32 v212, 16, v154
    v_and_b32 v213, 0xffff0000, v154
    v_lshlrev_b32 v214, 16, v155
    v_and_b32 v215, 0xffff0000, v155
    v_pk_add_f32 v[192:193], v[192:193], v[12:13]
    v_pk_add_f32 v[194:195], v[194:195], v[14:15]
    v_pk_add_f32 v[196:197], v[196:197], v[16:17]
    v_pk_add_f32 v[198:199], v[198:199], v[18:19]
    v_pk_add_f32 v[200:201], v[200:201], v[20:21]
    v_pk_add_f32 v[202:203], v[202:203], v[22:23]
    v_pk_add_f32 v[204:205], v[204:205], v[24:25]
    v_pk_add_f32 v[206:207], v[206:207], v[26:27]
    v_pk_add_f32 v[208:209], v[208:209], v[28:29]
    v_pk_add_f32 v[210:211], v[210:211], v[30:31]
    v_pk_add_f32 v[212:213], v[212:213], v[32:33]
    v_pk_add_f32 v[214:215], v[214:215], v[34:35]
    v_cvt_pk_bf16_f32 v156, v192, v193
    v_cvt_pk_bf16_f32 v157, v194, v195
    v_cvt_pk_bf16_f32 v158, v196, v197
    v_cvt_pk_bf16_f32 v159, v198, v199
    v_cvt_pk_bf16_f32 v160, v200, v201
    v_cvt_pk_bf16_f32 v161, v202, v203
    v_cvt_pk_bf16_f32 v162, v204, v205
    v_cvt_pk_bf16_f32 v163, v206, v207
    v_cvt_pk_bf16_f32 v164, v208, v209
    v_cvt_pk_bf16_f32 v165, v210, v211
    v_cvt_pk_bf16_f32 v166, v212, v213
    v_cvt_pk_bf16_f32 v167, v214, v215
    v_and_b32 v30, 2, v1
    v_cmp_ne_u32 vcc, 0, v30
    v_mul_u32_u24 v30, 1152, v7
    v_add_u32 v4, v30, v5
    v_add_u32 v58, v30, v59
    v_mov_b32_dpp v192, v158 quad_perm:[0,2,0,2] row_mask:0xf bank_mask:0xf
    v_mov_b32_dpp v193, v159 quad_perm:[0,2,0,2] row_mask:0xf bank_mask:0xf
    v_mov_b32_dpp v194, v158 quad_perm:[1,3,1,3] row_mask:0xf bank_mask:0xf
    v_mov_b32_dpp v195, v159 quad_perm:[1,3,1,3] row_mask:0xf bank_mask:0xf
    v_mov_b32_dpp v196, v162 quad_perm:[0,2,0,2] row_mask:0xf bank_mask:0xf
    v_mov_b32_dpp v197, v163 quad_perm:[0,2,0,2] row_mask:0xf bank_mask:0xf
    v_mov_b32_dpp v198, v162 quad_perm:[1,3,1,3] row_mask:0xf bank_mask:0xf
    v_mov_b32_dpp v199, v163 quad_perm:[1,3,1,3] row_mask:0xf bank_mask:0xf
    v_mov_b32_dpp v200, v166 quad_perm:[0,2,0,2] row_mask:0xf bank_mask:0xf
    v_mov_b32_dpp v201, v167 quad_perm:[0,2,0,2] row_mask:0xf bank_mask:0xf
    v_mov_b32_dpp v202, v166 quad_perm:[1,3,1,3] row_mask:0xf bank_mask:0xf
    v_mov_b32_dpp v203, v167 quad_perm:[1,3,1,3] row_mask:0xf bank_mask:0xf
    v_cndmask_b32_dpp v144, v156, v192, vcc quad_perm:[0,2,0,2] row_mask:0xf bank_mask:0xf
    v_cndmask_b32_dpp v145, v157, v193, vcc quad_perm:[0,2,0,2] row_mask:0xf bank_mask:0xf
    v_cndmask_b32_dpp v146, v156, v194, vcc quad_perm:[1,3,1,3] row_mask:0xf bank_mask:0xf
    v_cndmask_b32_dpp v147, v157, v195, vcc quad_perm:[1,3,1,3] row_mask:0xf bank_mask:0xf
    v_cndmask_b32_dpp v148, v160, v196, vcc quad_perm:[0,2,0,2] row_mask:0xf bank_mask:0xf
    v_cndmask_b32_dpp v149, v161, v197, vcc quad_perm:[0,2,0,2] row_mask:0xf bank_mask:0xf
    v_cndmask_b32_dpp v150, v160, v198, vcc quad_perm:[1,3,1,3] row_mask:0xf bank_mask:0xf
    v_cndmask_b32_dpp v151, v161, v199, vcc quad_perm:[1,3,1,3] row_mask:0xf bank_mask:0xf
    v_cndmask_b32_dpp v152, v164, v200, vcc quad_perm:[0,2,0,2] row_mask:0xf bank_mask:0xf
    v_cndmask_b32_dpp v153, v165, v201, vcc quad_perm:[0,2,0,2] row_mask:0xf bank_mask:0xf
    v_cndmask_b32_dpp v154, v164, v202, vcc quad_perm:[1,3,1,3] row_mask:0xf bank_mask:0xf
    v_cndmask_b32_dpp v155, v165, v203, vcc quad_perm:[1,3,1,3] row_mask:0xf bank_mask:0xf
    buffer_store_dwordx4 v[144:147], v4, s[16:19], 0 offen offset:0 sc1
    buffer_store_dwordx4 v[148:151], v4, s[16:19], 0 offen offset:512 sc1
    buffer_store_dwordx4 v[152:155], v58, s[16:19], 0 offen offset:1024 sc1
    s_waitcnt vmcnt(0)
    s_mov_b32 s36, 2622592
    buffer_store_dwordx4 v[36:39], v6, s[24:27], s36 offen offset:0 sc1
    buffer_store_dwordx4 v[40:43], v6, s[24:27], s36 offen offset:512 sc1
    buffer_store_dwordx4 v[44:47], v60, s[24:27], s36 offen offset:1024 sc1
Ltail_done:
    s_endpgm
Lattn_wb:
    buffer_wbl2 sc1
    s_waitcnt vmcnt(0)
    s_branch Lattn_wbdone
Lattn_xspin:
Ltour15:
    s_cbranch_execz Lmain
    s_mov_b32 s37, 16384
Lattn_xloop:
    buffer_load_dword v11, v8, s[24:27], s54 offen offset:8 sc1
    s_waitcnt vmcnt(0)
    v_readfirstlane_b32 s36, v11
    s_sub_u32 s37, s37, 1
    s_cbranch_scc1 Lattn_xgot
    s_cmp_lg_u32 s36, s95
    s_cbranch_scc1 Lattn_xloop
    s_branch Lattn_xgot
Ltail_spin1:
Ltour16:
    s_cbranch_execz Lmain
    s_mov_b32 s48, 16384
Ltail_spinl1:
    buffer_load_dword v11, v9, s[24:27], s39 offen sc1
    s_waitcnt vmcnt(0)
    v_cmp_ne_u32 s[54:55], s95, v11
    s_sub_u32 s48, s48, 1
    s_cbranch_scc1 Ltail_got1
    s_cmp_lg_u64 s[54:55], 0
    s_cbranch_scc1 Ltail_spinl1
    s_branch Ltail_got1
Ltail_spin2:
Ltour17:
    s_cbranch_execz Lmain
    s_mov_b32 s48, 16384
Ltail_spinl2:
    buffer_load_dword v11, v9, s[24:27], s39 offen sc1
    s_waitcnt vmcnt(0)
    v_cmp_ne_u32 s[54:55], s95, v11
    s_sub_u32 s48, s48, 1
    s_cbranch_scc1 Ltail_got2
    s_cmp_lg_u64 s[54:55], 0
    s_cbranch_scc1 Ltail_spinl2
    s_branch Ltail_got2
Lattn_redo:
    v_xor_b32 v8, 64, v9
    v_xor_b32 v10, 64, v11
    s_waitcnt vmcnt(0) lgkmcnt(0)
    s_barrier
    v_mov_b32 v232, 0xff800000
    v_mov_b32 v233, 0xff800000
    v_mov_b32 v234, 0xff800000
    v_mov_b32 v235, 0xff800000
    s_mov_b32 s40, 0
    s_mov_b32 s48, -1
Lattn_redo_loop:
    s_add_u32 m0, s42, 0
    s_nop 0
    buffer_load_dwordx4 v36, s[8:11], s40 offen lds
    buffer_load_dwordx4 v37, s[8:11], s40 offen offset:1024 lds
    buffer_load_dwordx4 v38, s[8:11], s40 offen offset:2048 lds
    buffer_load_dwordx4 v39, s[8:11], s40 offen offset:3072 lds
    s_add_u32 s40, s40, 16384
    s_waitcnt vmcnt(0) lgkmcnt(0)
    s_barrier
    ds_read_b128 a[208:211], v8 offset:0
    ds_read_b128 a[212:215], v9 offset:0
    ds_read_b128 a[216:219], v10 offset:0
    ds_read_b128 a[220:223], v11 offset:0
    s_waitcnt lgkmcnt(3)
    v_mfma_f32_16x16x32_bf16 v[216:219], a[208:211], v[64:67], 0
    s_waitcnt lgkmcnt(2)
    v_mfma_f32_16x16x32_bf16 v[216:219], a[212:215], v[68:71], v[216:219]
    s_waitcnt lgkmcnt(1)
    v_mfma_f32_16x16x32_bf16 v[216:219], a[216:219], v[72:75], v[216:219]
    s_waitcnt lgkmcnt(0)
    v_mfma_f32_16x16x32_bf16 v[216:219], a[220:223], v[76:79], v[216:219]
    v_mfma_f32_16x16x32_bf16 v[220:223], a[208:211], v[80:83], 0
    v_mfma_f32_16x16x32_bf16 v[220:223], a[212:215], v[84:87], v[220:223]
    v_mfma_f32_16x16x32_bf16 v[220:223], a[216:219], v[88:91], v[220:223]
    v_mfma_f32_16x16x32_bf16 v[220:223], a[220:223], v[92:95], v[220:223]
    v_mfma_f32_16x16x32_bf16 v[224:227], a[208:211], v[96:99], 0
    v_mfma_f32_16x16x32_bf16 v[224:227], a[212:215], v[100:103], v[224:227]
    v_mfma_f32_16x16x32_bf16 v[224:227], a[216:219], v[104:107], v[224:227]
    v_mfma_f32_16x16x32_bf16 v[224:227], a[220:223], v[108:111], v[224:227]
    v_mfma_f32_16x16x32_bf16 v[228:231], a[208:211], v[112:115], 0
    v_mfma_f32_16x16x32_bf16 v[228:231], a[212:215], v[116:119], v[228:231]
    v_mfma_f32_16x16x32_bf16 v[228:231], a[216:219], v[120:123], v[228:231]
    v_mfma_f32_16x16x32_bf16 v[228:231], a[220:223], v[124:127], v[228:231]
    v_max3_f32 v232, v232, v216, v217
    v_max3_f32 v232, v232, v218, v219
    v_max3_f32 v233, v233, v220, v221
    v_max3_f32 v233, v233, v222, v223
    v_max3_f32 v234, v234, v224, v225
    v_max3_f32 v234, v234, v226, v227
    s_nop 1
    v_max3_f32 v235, v235, v228, v229
    v_max3_f32 v235, v235, v230, v231
    ds_read_b128 a[224:227], v8 offset:4096
    ds_read_b128 a[228:231], v9 offset:4096
    ds_read_b128 a[232:235], v10 offset:4096
    ds_read_b128 a[236:239], v11 offset:4096
    s_waitcnt lgkmcnt(3)
    v_mfma_f32_16x16x32_bf16 v[216:219], a[224:227], v[64:67], 0
    s_waitcnt lgkmcnt(2)
    v_mfma_f32_16x16x32_bf16 v[216:219], a[228:231], v[68:71], v[216:219]
    s_waitcnt lgkmcnt(1)
    v_mfma_f32_16x16x32_bf16 v[216:219], a[232:235], v[72:75], v[216:219]
    s_waitcnt lgkmcnt(0)
    v_mfma_f32_16x16x32_bf16 v[216:219], a[236:239], v[76:79], v[216:219]
    v_mfma_f32_16x16x32_bf16 v[220:223], a[224:227], v[80:83], 0
    v_mfma_f32_16x16x32_bf16 v[220:223], a[228:231], v[84:87], v[220:223]
    v_mfma_f32_16x16x32_bf16 v[220:223], a[232:235], v[88:91], v[220:223]
    v_mfma_f32_16x16x32_bf16 v[220:223], a[236:239], v[92:95], v[220:223]
    v_mfma_f32_16x16x32_bf16 v[224:227], a[224:227], v[96:99], 0
    v_mfma_f32_16x16x32_bf16 v[224:227], a[228:231], v[100:103], v[224:227]
    v_mfma_f32_16x16x32_bf16 v[224:227], a[232:235], v[104:107], v[224:227]
    v_mfma_f32_16x16x32_bf16 v[224:227], a[236:239], v[108:111], v[224:227]
    v_mfma_f32_16x16x32_bf16 v[228:231], a[224:227], v[112:115], 0
    v_mfma_f32_16x16x32_bf16 v[228:231], a[228:231], v[116:119], v[228:231]
    v_mfma_f32_16x16x32_bf16 v[228:231], a[232:235], v[120:123], v[228:231]
    v_mfma_f32_16x16x32_bf16 v[228:231], a[236:239], v[124:127], v[228:231]
    v_max3_f32 v232, v232, v216, v217
    v_max3_f32 v232, v232, v218, v219
    v_max3_f32 v233, v233, v220, v221
    v_max3_f32 v233, v233, v222, v223
    v_max3_f32 v234, v234, v224, v225
    v_max3_f32 v234, v234, v226, v227
    s_nop 1
    v_max3_f32 v235, v235, v228, v229
    v_max3_f32 v235, v235, v230, v231
    ds_read_b128 a[208:211], v8 offset:8192
    ds_read_b128 a[212:215], v9 offset:8192
    ds_read_b128 a[216:219], v10 offset:8192
    ds_read_b128 a[220:223], v11 offset:8192
    s_waitcnt lgkmcnt(3)
    v_mfma_f32_16x16x32_bf16 v[216:219], a[208:211], v[64:67], 0
    s_waitcnt lgkmcnt(2)
    v_mfma_f32_16x16x32_bf16 v[216:219], a[212:215], v[68:71], v[216:219]
    s_waitcnt lgkmcnt(1)
    v_mfma_f32_16x16x32_bf16 v[216:219], a[216:219], v[72:75], v[216:219]
    s_waitcnt lgkmcnt(0)
    v_mfma_f32_16x16x32_bf16 v[216:219], a[220:223], v[76:79], v[216:219]
    v_mfma_f32_16x16x32_bf16 v[220:223], a[208:211], v[80:83], 0
    v_mfma_f32_16x16x32_bf16 v[220:223], a[212:215], v[84:87], v[220:223]
    v_mfma_f32_16x16x32_bf16 v[220:223], a[216:219], v[88:91], v[220:223]
    v_mfma_f32_16x16x32_bf16 v[220:223], a[220:223], v[92:95], v[220:223]
    v_mfma_f32_16x16x32_bf16 v[224:227], a[208:211], v[96:99], 0
    v_mfma_f32_16x16x32_bf16 v[224:227], a[212:215], v[100:103], v[224:227]
    v_mfma_f32_16x16x32_bf16 v[224:227], a[216:219], v[104:107], v[224:227]
    v_mfma_f32_16x16x32_bf16 v[224:227], a[220:223], v[108:111], v[224:227]
    v_mfma_f32_16x16x32_bf16 v[228:231], a[208:211], v[112:115], 0
    v_mfma_f32_16x16x32_bf16 v[228:231], a[212:215], v[116:119], v[228:231]
    v_mfma_f32_16x16x32_bf16 v[228:231], a[216:219], v[120:123], v[228:231]
    v_mfma_f32_16x16x32_bf16 v[228:231], a[220:223], v[124:127], v[228:231]
    v_max3_f32 v232, v232, v216, v217
    v_max3_f32 v232, v232, v218, v219
    v_max3_f32 v233, v233, v220, v221
    v_max3_f32 v233, v233, v222, v223
    v_max3_f32 v234, v234, v224, v225
    v_max3_f32 v234, v234, v226, v227
    s_nop 1
    v_max3_f32 v235, v235, v228, v229
    v_max3_f32 v235, v235, v230, v231
    ds_read_b128 a[224:227], v8 offset:12288
    ds_read_b128 a[228:231], v9 offset:12288
    ds_read_b128 a[232:235], v10 offset:12288
    ds_read_b128 a[236:239], v11 offset:12288
    s_waitcnt lgkmcnt(3)
    v_mfma_f32_16x16x32_bf16 v[216:219], a[224:227], v[64:67], 0
    s_waitcnt lgkmcnt(2)
    v_mfma_f32_16x16x32_bf16 v[216:219], a[228:231], v[68:71], v[216:219]
    s_waitcnt lgkmcnt(1)
    v_mfma_f32_16x16x32_bf16 v[216:219], a[232:235], v[72:75], v[216:219]
    s_waitcnt lgkmcnt(0)
    v_mfma_f32_16x16x32_bf16 v[216:219], a[236:239], v[76:79], v[216:219]
    v_mfma_f32_16x16x32_bf16 v[220:223], a[224:227], v[80:83], 0
    v_mfma_f32_16x16x32_bf16 v[220:223], a[228:231], v[84:87], v[220:223]
    v_mfma_f32_16x16x32_bf16 v[220:223], a[232:235], v[88:91], v[220:223]
    v_mfma_f32_16x16x32_bf16 v[220:223], a[236:239], v[92:95], v[220:223]
    v_mfma_f32_16x16x32_bf16 v[224:227], a[224:227], v[96:99], 0
    v_mfma_f32_16x16x32_bf16 v[224:227], a[228:231], v[100:103], v[224:227]
    v_mfma_f32_16x16x32_bf16 v[224:227], a[232:235], v[104:107], v[224:227]
    v_mfma_f32_16x16x32_bf16 v[224:227], a[236:239], v[108:111], v[224:227]
    v_mfma_f32_16x16x32_bf16 v[228:231], a[224:227], v[112:115], 0
    v_mfma_f32_16x16x32_bf16 v[228:231], a[228:231], v[116:119], v[228:231]
    v_mfma_f32_16x16x32_bf16 v[228:231], a[232:235], v[120:123], v[228:231]
    v_mfma_f32_16x16x32_bf16 v[228:231], a[236:239], v[124:127], v[228:231]
    v_max3_f32 v232, v232, v216, v217
    v_max3_f32 v232, v232, v218, v219
    v_max3_f32 v233, v233, v220, v221
    v_max3_f32 v233, v233, v222, v223
    v_max3_f32 v234, v234, v224, v225
    v_max3_f32 v234, v234, v226, v227
    s_nop 1
    v_max3_f32 v235, v235, v228, v229
    v_max3_f32 v235, v235, v230, v231
    s_barrier
    s_cmp_lt_u32 s40, 524288
    s_cbranch_scc1 Lattn_redo_loop
    v_mov_b32 v236, v232
    v_mov_b32 v237, v233
    v_mov_b32 v238, v234
    v_mov_b32 v239, v235
    v_permlane16_swap_b32 v232, v236
    v_permlane16_swap_b32 v233, v237
    v_permlane16_swap_b32 v234, v238
    v_permlane16_swap_b32 v235, v239
    v_max_f32 v232, v232, v236
    v_max_f32 v233, v233, v237
    v_max_f32 v234, v234, v238
    v_max_f32 v235, v235, v239
    v_mov_b32 v236, v232
    v_mov_b32 v237, v233
    v_mov_b32 v238, v234
    v_mov_b32 v239, v235
    v_permlane32_swap_b32 v232, v236
    v_permlane32_swap_b32 v233, v237
    v_permlane32_swap_b32 v234, v238
    v_permlane32_swap_b32 v235, v239
    v_max_f32 v232, v232, v236
    v_max_f32 v233, v233, v237
    v_max_f32 v234, v234, v238
    v_max_f32 v235, v235, v239
    v_sub_f32 v192, 0, v232
    v_sub_f32 v193, 0, v232
    v_sub_f32 v194, 0, v232
    v_sub_f32 v195, 0, v232
    v_sub_f32 v196, 0, v233
    v_sub_f32 v197, 0, v233
    v_sub_f32 v198, 0, v233
    v_sub_f32 v199, 0, v233
    v_sub_f32 v200, 0, v234
    v_sub_f32 v201, 0, v234
    v_sub_f32 v202, 0, v234
    v_sub_f32 v203, 0, v234
    v_sub_f32 v204, 0, v235
    v_sub_f32 v205, 0, v235
    v_sub_f32 v206, 0, v235
    v_sub_f32 v207, 0, v235
    s_mov_b32 s40, 0
    s_mov_b32 s41, 0
    s_add_u32 m0, s42, 0
    s_nop 0
    buffer_load_dwordx4 v36, s[8:11], s40 offen lds
    buffer_load_dwordx4 v37, s[8:11], s40 offen offset:1024 lds
    buffer_load_dwordx4 v38, s[8:11], s40 offen offset:2048 lds
    buffer_load_dwordx4 v39, s[8:11], s40 offen offset:3072 lds
    s_add_u32 s40, s40, 16384
    s_add_u32 m0, s42, 16384
    s_nop 0
    buffer_load_dwordx4 v36, s[8:11], s40 offen lds
    buffer_load_dwordx4 v37, s[8:11], s40 offen offset:1024 lds
    buffer_load_dwordx4 v38, s[8:11], s40 offen offset:2048 lds
    buffer_load_dwordx4 v39, s[8:11], s40 offen offset:3072 lds
    s_add_u32 s40, s40, 16384
    s_add_u32 m0, s42, 32768
    s_nop 0
    buffer_load_dwordx4 v36, s[8:11], s40 offen lds
    buffer_load_dwordx4 v37, s[8:11], s40 offen offset:1024 lds
    buffer_load_dwordx4 v38, s[8:11], s40 offen offset:2048 lds
    buffer_load_dwordx4 v39, s[8:11], s40 offen offset:3072 lds
    s_add_u32 s40, s40, 16384
    s_add_u32 m0, s42, 65536
    s_nop 0
    buffer_load_dwordx4 v40, s[12:15], s41 offen lds
    buffer_load_dwordx4 v41, s[12:15], s41 offen offset:1024 lds
    buffer_load_dwordx4 v40, s[12:15], s41 offen offset:2048 lds
    buffer_load_dwordx4 v41, s[12:15], s41 offen offset:3072 lds
    s_add_u32 s41, s41, 16384
    s_add_u32 m0, s42, 81920
    s_nop 0
    buffer_load_dwordx4 v40, s[12:15], s41 offen lds
    buffer_load_dwordx4 v41, s[12:15], s41 offen offset:1024 lds
    buffer_load_dwordx4 v40, s[12:15], s41 offen offset:2048 lds
    buffer_load_dwordx4 v41, s[12:15], s41 offen offset:3072 lds
    s_add_u32 s41, s41, 16384
    v_accvgpr_write_b32 a0, 0
    v_accvgpr_write_b32 a1, 0
    v_accvgpr_write_b32 a2, 0
    v_accvgpr_write_b32 a3, 0
    v_accvgpr_write_b32 a4, 0
    v_accvgpr_write_b32 a5, 0
    v_accvgpr_write_b32 a6, 0
    v_accvgpr_write_b32 a7, 0
    v_accvgpr_write_b32 a8, 0
    v_accvgpr_write_b32 a9, 0
    v_accvgpr_write_b32 a10, 0
    v_accvgpr_write_b32 a11, 0
    v_accvgpr_write_b32 a12, 0
    v_accvgpr_write_b32 a13, 0
    v_accvgpr_write_b32 a14, 0
    v_accvgpr_write_b32 a15, 0
    v_accvgpr_write_b32 a16, 0
    v_accvgpr_write_b32 a17, 0
    v_accvgpr_write_b32 a18, 0
    v_accvgpr_write_b32 a19, 0
    v_accvgpr_write_b32 a20, 0
    v_accvgpr_write_b32 a21, 0
    v_accvgpr_write_b32 a22, 0
    v_accvgpr_write_b32 a23, 0
    v_accvgpr_write_b32 a24, 0
    v_accvgpr_write_b32 a25, 0
    v_accvgpr_write_b32 a26, 0
    v_accvgpr_write_b32 a27, 0
    v_accvgpr_write_b32 a28, 0
    v_accvgpr_write_b32 a29, 0
    v_accvgpr_write_b32 a30, 0
    v_accvgpr_write_b32 a31, 0
    v_accvgpr_write_b32 a32, 0
    v_accvgpr_write_b32 a33, 0
    v_accvgpr_write_b32 a34, 0
    v_accvgpr_write_b32 a35, 0
    v_accvgpr_write_b32 a36, 0
    v_accvgpr_write_b32 a37, 0
    v_accvgpr_write_b32 a38, 0
    v_accvgpr_write_b32 a39, 0
    v_accvgpr_write_b32 a40, 0
    v_accvgpr_write_b32 a41, 0
    v_accvgpr_write_b32 a42, 0
    v_accvgpr_write_b32 a43, 0
    v_accvgpr_write_b32 a44, 0
    v_accvgpr_write_b32 a45, 0
    v_accvgpr_write_b32 a46, 0
    v_accvgpr_write_b32 a47, 0
    v_accvgpr_write_b32 a48, 0
    v_accvgpr_write_b32 a49, 0
    v_accvgpr_write_b32 a50, 0
    v_accvgpr_write_b32 a51, 0
    v_accvgpr_write_b32 a52, 0
    v_accvgpr_write_b32 a53, 0
    v_accvgpr_write_b32 a54, 0
    v_accvgpr_write_b32 a55, 0
    v_accvgpr_write_b32 a56, 0
    v_accvgpr_write_b32 a57, 0
    v_accvgpr_write_b32 a58, 0
    v_accvgpr_write_b32 a59, 0
    v_accvgpr_write_b32 a60, 0
    v_accvgpr_write_b32 a61, 0
    v_accvgpr_write_b32 a62, 0
    v_accvgpr_write_b32 a63, 0
    v_accvgpr_write_b32 a64, 0
    v_accvgpr_write_b32 a65, 0
    v_accvgpr_write_b32 a66, 0
    v_accvgpr_write_b32 a67, 0
    v_accvgpr_write_b32 a68, 0
    v_accvgpr_write_b32 a69, 0
    v_accvgpr_write_b32 a70, 0
    v_accvgpr_write_b32 a71, 0
    v_accvgpr_write_b32 a72, 0
    v_accvgpr_write_b32 a73, 0
    v_accvgpr_write_b32 a74, 0
    v_accvgpr_write_b32 a75, 0
    v_accvgpr_write_b32 a76, 0
    v_accvgpr_write_b32 a77, 0
    v_accvgpr_write_b32 a78, 0
    v_accvgpr_write_b32 a79, 0
    v_accvgpr_write_b32 a80, 0
    v_accvgpr_write_b32 a81, 0
    v_accvgpr_write_b32 a82, 0
    v_accvgpr_write_b32 a83, 0
    v_accvgpr_write_b32 a84, 0
    v_accvgpr_write_b32 a85, 0
    v_accvgpr_write_b32 a86, 0
    v_accvgpr_write_b32 a87, 0
    v_accvgpr_write_b32 a88, 0
    v_accvgpr_write_b32 a89, 0
    v_accvgpr_write_b32 a90, 0
    v_accvgpr_write_b32 a91, 0
    v_accvgpr_write_b32 a92, 0
    v_accvgpr_write_b32 a93, 0
    v_accvgpr_write_b32 a94, 0
    v_accvgpr_write_b32 a95, 0
    v_accvgpr_write_b32 a96, 0
    v_accvgpr_write_b32 a97, 0
    v_accvgpr_write_b32 a98, 0
    v_accvgpr_write_b32 a99, 0
    v_accvgpr_write_b32 a100, 0
    v_accvgpr_write_b32 a101, 0
    v_accvgpr_write_b32 a102, 0
    v_accvgpr_write_b32 a103, 0
    v_accvgpr_write_b32 a104, 0
    v_accvgpr_write_b32 a105, 0
    v_accvgpr_write_b32 a106, 0
    v_accvgpr_write_b32 a107, 0
    v_accvgpr_write_b32 a108, 0
    v_accvgpr_write_b32 a109, 0
    v_accvgpr_write_b32 a110, 0
    v_accvgpr_write_b32 a111, 0
    v_accvgpr_write_b32 a112, 0
    v_accvgpr_write_b32 a113, 0
    v_accvgpr_write_b32 a114, 0
    v_accvgpr_write_b32 a115, 0
    v_accvgpr_write_b32 a116, 0
    v_accvgpr_write_b32 a117, 0
    v_accvgpr_write_b32 a118, 0
    v_accvgpr_write_b32 a119, 0
    v_accvgpr_write_b32 a120, 0
    v_accvgpr_write_b32 a121, 0
    v_accvgpr_write_b32 a122, 0
    v_accvgpr_write_b32 a123, 0
    v_accvgpr_write_b32 a124, 0
    v_accvgpr_write_b32 a125, 0
    v_accvgpr_write_b32 a126, 0
    v_accvgpr_write_b32 a127, 0
    v_accvgpr_write_b32 a192, 0
    v_accvgpr_write_b32 a193, 0
    v_accvgpr_write_b32 a194, 0
    v_accvgpr_write_b32 a195, 0
    v_accvgpr_write_b32 a196, 0
    v_accvgpr_write_b32 a197, 0
    v_accvgpr_write_b32 a198, 0
    v_accvgpr_write_b32 a199, 0
    v_accvgpr_write_b32 a200, 0
    v_accvgpr_write_b32 a201, 0
    v_accvgpr_write_b32 a202, 0
    v_accvgpr_write_b32 a203, 0
    v_accvgpr_write_b32 a204, 0
    v_accvgpr_write_b32 a205, 0
    v_accvgpr_write_b32 a206, 0
    v_accvgpr_write_b32 a207, 0
    s_waitcnt vmcnt(0) lgkmcnt(0)
    s_barrier
    ds_read_b128 a[208:211], v8 offset:0
    ds_read_b128 a[212:215], v9 offset:0
    ds_read_b128 a[216:219], v10 offset:0
    ds_read_b128 a[220:223], v11 offset:0
    ds_read_b128 a[224:227], v8 offset:4096
    s_waitcnt vmcnt(0) lgkmcnt(0)
    s_branch Lattn_stage0
Lattn_armwait:
    s_mov_b32 s36, 16384
Lattn_armloop:
    v_mov_b32 v63, 0
    buffer_load_dword v63, v63, s[88:91], 0 offen sc1
    s_waitcnt vmcnt(0)
    v_readfirstlane_b32 s37, v63
    s_sub_u32 s36, s36, 1
    s_cbranch_scc1 Lattn_armed
    s_cmp_lt_u32 s37, 256
    s_cbranch_scc1 Lattn_armloop
    s_branch Lattn_armed
Lattn_end:
    s_endpgm
.section .rodata,"a"
.p2align 6
.amdhsa_kernel adaLN_cond__gqa_block_cached__moe_arch_mod__prompt_kernel
  .amdhsa_next_free_vgpr 512
  .amdhsa_next_free_sgpr 102
  .amdhsa_accum_offset 256
  .amdhsa_group_segment_fixed_size 0
  .amdhsa_kernarg_size 120
  .amdhsa_user_sgpr_count 2
  .amdhsa_user_sgpr_kernarg_segment_ptr 1
  .amdhsa_system_sgpr_workgroup_id_x 1
  .amdhsa_float_denorm_mode_32 3
.end_amdhsa_kernel
```

```asm
; @launch grid=(256,1,1) block=(256,1,1) lds=163840
.amdgcn_target "amdgcn-amd-amdhsa--gfx950"
.text
.globl adaLN_cond__gqa_block_cached__moe_arch_mod__prompt_kernel
.p2align 8
.type adaLN_cond__gqa_block_cached__moe_arch_mod__prompt_kernel,@function
adaLN_cond__gqa_block_cached__moe_arch_mod__prompt_kernel:
    s_cmp_ge_u32 s2, 256
    s_cbranch_scc1 Lattn_end
    s_load_dwordx2 s[8:9], s[0:1], 80
    s_load_dwordx2 s[12:13], s[0:1], 88
    s_load_dwordx2 s[20:21], s[0:1], 0
    s_load_dwordx2 s[50:51], s[0:1], 112
    s_load_dwordx8 s[52:59], s[0:1], 8
    s_load_dwordx4 s[80:83], s[0:1], 56
    s_load_dwordx2 s[84:85], s[0:1], 72
    s_load_dwordx2 s[88:89], s[0:1], 104
    s_load_dwordx2 s[28:29], s[0:1], 48
    s_getpc_b64 s[32:33]
Lattn_pc:
    s_mov_b32 s34, Lattn_end-Lattn_pc
    s_mov_b32 s35, 0x20000
    s_lshr_b32 s6, s2, 3
    s_lshl_b32 s7, s6, 6
    v_lshrrev_b32 v3, 6, v0
    v_and_b32 v1, 63, v0
    v_lshrrev_b32 v2, 2, v0
    v_lshlrev_b32 v2, 11, v2
    v_readfirstlane_b32 s3, v3
    buffer_load_dword v240, v2, s[32:35], s7 offen
    s_and_b32 s7, s2, 7
    s_lshl_b32 s4, s7, 1
    s_and_b32 s5, s6, 1
    s_add_u32 s4, s4, s5
    s_lshr_b32 s5, s2, 4
    s_lshr_b32 s38, s6, 2
    s_lshl_b32 s38, s38, 3
    s_add_u32 s38, s38, s7
    s_cmp_lt_u32 s38, 18
    s_cselect_b32 s39, 0, 2147483648
    s_lshl_b32 s38, s38, 2
    s_and_b32 s36, s6, 3
    s_add_u32 s38, s38, s36
    s_mov_b32 s14, 3981312
    s_mul_i32 s92, s6, 124416
    s_lshl_b32 s36, s7, 7
    s_add_u32 s92, s92, s36
    s_cmp_lt_u32 s7, 2
    s_cselect_b32 s36, 53, 35
    v_lshrrev_b32 v2, 2, v0
    v_min_u32 v2, s36, v2
    v_mul_u32_u24 v3, 57, v2
    v_lshrrev_b32 v3, 10, v3
    v_mul_i32_i24 v3, -123392, v3
    v_mul_u32_u24 v2, 6912, v2
    v_add_u32 v72, v2, v3
    s_mov_b32 s15, 0x20000
    s_mov_b32 s10, 1152
    s_mov_b32 s11, 0x20000
    s_mov_b32 s22, 2359296
    s_mov_b32 s23, 0x20000
    v_and_b32 v64, 0xfe, v0
    v_mul_u32_u24 v65, 3456, v64
    v_and_b32 v2, 1, v0
    v_lshl_add_u32 v65, v2, 4, v65
    s_lshl_b32 s36, s38, 5
    s_or_b32 s36, s36, s39
    v_and_b32 v4, 31, v1
    v_lshrrev_b32 v5, 5, v1
    v_cmp_gt_u32 vcc, 24, v4
    v_mov_b32 v6, 2147483648
    s_lshl_b32 s7, s5, 4
    s_add_u32 s7, s7, s4
    s_lshl_b32 s7, s7, 2
    s_add_u32 s7, s7, s3
    v_cndmask_b32 v6, v6, 0, vcc
    s_mul_i32 s49, s7, 2304
    v_lshrrev_b32 v7, 2, v4
    v_lshl_add_u32 v7, v7, 6, v6
    v_and_b32 v2, 3, v4
    v_lshl_add_u32 v7, v2, 3, v7
    v_mul_u32_u24 v2, 1152, v5
    v_add_u32 v66, v7, v2
    s_waitcnt lgkmcnt(0)
    s_load_dword s94, s[50:51], 24576
    buffer_load_dword v241, v72, s[12:15], s92 offen
    buffer_load_ushort v80, v64, s[8:11], 0 offen offset:0
    buffer_load_ushort v81, v64, s[8:11], 0 offen offset:256
    buffer_load_ushort v82, v64, s[8:11], 0 offen offset:512
    buffer_load_ushort v83, v64, s[8:11], 0 offen offset:768
    buffer_load_ushort v84, v64, s[8:11], 0 offen offset:1024
    buffer_load_dwordx4 v[88:91], v65, s[12:15], s36 offen
    s_add_u32 s36, s36, 884736
    buffer_load_dwordx4 v[92:95], v65, s[12:15], s36 offen
    s_add_u32 s36, s36, 884736
    buffer_load_dwordx4 v[96:99], v65, s[12:15], s36 offen
    s_add_u32 s36, s36, 884736
    buffer_load_dwordx4 v[100:103], v65, s[12:15], s36 offen
    s_add_u32 s36, s36, 884736
    buffer_load_dwordx4 v[104:107], v65, s[12:15], s36 offen
    s_mov_b32 s16, s56
    s_mov_b32 s17, s57
    s_mov_b32 s18, 4718592
    s_mov_b32 s19, 0x20000
    s_lshl_b32 s44, s4, 9
    s_mul_i32 s36, s5, 98304
    s_add_u32 s36, s36, 0
    v_lshrrev_b32 v2, 2, v0
    v_min_u32 v2, 47, v2
    v_lshrrev_b32 v3, 2, v2
    v_and_b32 v2, 3, v2
    v_lshl_add_u32 v2, v2, 7, s36
    v_lshl_add_u32 v71, v3, 13, v2
    s_mul_i32 s36, s5, 196608
    s_add_u32 s36, s36, 1572864
    v_lshrrev_b32 v2, 1, v0
    v_min_u32 v2, 95, v2
    v_lshrrev_b32 v3, 2, v2
    v_and_b32 v2, 3, v2
    v_lshl_add_u32 v2, v2, 7, s36
    v_lshl_add_u32 v70, v3, 13, v2
    s_add_u32 s92, s49, 65536
    v_lshl_add_u32 v7, v5, 4, v6
    v_lshl_add_u32 v67, v4, 5, v7
    v_min_u32 v4, 23, v4
    v_lshlrev_b32 v68, 4, v4
    s_mov_b32 s24, s50
    s_mov_b32 s25, s51
    s_mov_b32 s26, 10485760
    s_mov_b32 s27, 0x20000
    s_mov_b32 s90, 256
    s_mov_b32 s91, 0x20000
    s_cmp_ge_u32 s38, 36
    s_cselect_b32 s93, 1.0, 0
    s_lshl_b32 s36, s38, 7
    v_lshl_add_u32 v69, v0, 3, s36
    v_cmp_gt_u32 s[36:37], 16, v0
    v_mov_b32 v2, 2147483648
    v_mov_b32 v3, s39
    v_cndmask_b32 v2, v2, v3, s[36:37]
    v_or_b32 v69, v69, v2
    s_mul_i32 s36, s5, 3072
    s_lshl_b32 s37, s5, 11
    v_lshrrev_b32 v120, 3, v0
    v_min_u32 v120, 23, v120
    v_lshl_add_u32 v120, v120, 7, s36
    v_lshrrev_b32 v121, 4, v0
    v_lshl_add_u32 v121, v121, 7, s37
    s_lshl_b32 s42, s3, 12
    v_lshrrev_b32 v2, 4, v1
    v_and_b32 v3, 15, v1
    v_lshrrev_b32 v5, 1, v3
    v_mul_u32_u24 v5, 2304, v5
    v_lshl_add_u32 v5, v2, 5, v5
    v_and_b32 v6, 1, v3
    v_lshl_add_u32 v51, v6, 4, v5
    s_lshl_b32 s6, s5, 2
    s_add_u32 s6, s6, s3
    s_mul_i32 s46, s6, 36864
    s_add_u32 s46, s46, 65536
    s_add_u32 s43, s46, 18432
    s_mul_i32 s45, s4, 294912
    s_lshl_b32 s7, s3, 4
    v_add_u32 v4, s7, v2
    v_lshlrev_b32 v5, 1, v2
    v_xor_b32 v5, v5, v3
    v_xor_b32 v6, 8, v5
    v_lshlrev_b32 v7, 13, v4
    v_lshl_add_u32 v42, v5, 4, v7
    v_lshl_add_u32 v43, v6, 4, v7
    v_add_u32 v44, 63488, v42
    v_add_u32 v45, 95232, v43
    v_add_u32 v43, 31744, v43
    s_lshl_b32 s7, s4, 19
    s_add_u32 s8, s52, s7
    s_addc_u32 s9, s53, 0
    s_mov_b32 s10, 524288
    s_mov_b32 s11, 0x20000
    s_add_u32 s12, s54, s7
    s_addc_u32 s13, s55, 0
    s_mov_b32 s14, 524288
    s_mov_b32 s15, 0x20000
    s_add_u32 s28, s50, 10485760
    s_addc_u32 s29, s51, 0
    s_mov_b32 s30, 37748736
    s_mov_b32 s31, 0x20000
    v_lshlrev_b32 v7, 8, v4
    v_lshl_add_u32 v40, v5, 4, v7
    v_lshl_add_u32 v41, v6, 4, v7
    v_xor_b32 v224, v3, v2
    v_lshl_add_u32 v36, v224, 4, v7
    v_xor_b32 v37, 64, v36
    v_xor_b32 v38, 128, v36
    v_xor_b32 v39, 192, v36
    v_lshrrev_b32 v7, 3, v5
    v_lshl_add_u32 v7, v7, 7, v4
    v_mul_u32_u24 v7, 1152, v7
    v_and_b32 v225, 7, v5
    v_lshl_add_u32 v46, v225, 4, v7
    v_lshrrev_b32 v7, 3, v6
    v_lshl_add_u32 v7, v7, 7, v4
    v_mul_u32_u24 v7, 1152, v7
    v_and_b32 v225, 7, v6
    v_lshl_add_u32 v47, v225, 4, v7
    v_add_u32 v48, 7168, v46
    v_add_u32 v49, 10752, v47
    v_add_u32 v47, 3584, v47
    v_lshlrev_b32 v7, 8, v3
    v_lshl_add_u32 v8, v224, 4, v7
    v_xor_b32 v9, 64, v8
    v_xor_b32 v10, 128, v8
    v_xor_b32 v11, 192, v8
    v_lshrrev_b32 v5, 2, v1
    v_and_b32 v6, 7, v5
    v_lshlrev_b32 v6, 5, v6
    v_lshl_add_u32 v6, v5, 8, v6
    v_and_b32 v7, 3, v1
    v_lshl_add_u32 v12, v7, 3, v6
    v_xor_b32 v13, 32, v12
    v_xor_b32 v14, 64, v12
    v_xor_b32 v15, 96, v12
    v_xor_b32 v16, 128, v12
    v_xor_b32 v17, 160, v12
    v_xor_b32 v18, 192, v12
    v_xor_b32 v19, 224, v12
    v_add_u32 v20, 65536, v12
    v_add_u32 v21, 65536, v13
    v_add_u32 v22, 65536, v14
    v_add_u32 v23, 65536, v15
    v_add_u32 v24, 65536, v16
    v_add_u32 v25, 65536, v17
    v_add_u32 v26, 65536, v18
    v_add_u32 v27, 65536, v19
    v_add_u32 v28, 131072, v12
    v_add_u32 v29, 131072, v13
    v_add_u32 v30, 131072, v14
    v_add_u32 v31, 131072, v15
    v_add_u32 v32, 131072, v16
    v_add_u32 v33, 131072, v17
    v_add_u32 v34, 131072, v18
    v_add_u32 v35, 131072, v19
    v_mov_b32 v52, 0x3f803f80
    v_mov_b32 v53, 0x3f803f80
    v_mov_b32 v54, 0x3f803f80
    v_mov_b32 v55, 0x3f803f80
    v_and_b32 v5, 1, v1
    v_mul_u32_u24 v5, 0xaaaa, v5
    v_add_u32 v5, 0x4444, v5
    v_lshl_add_u32 v50, v5, 16, v5
    v_lshrrev_b32 v5, 1, v3
    v_mul_u32_u24 v5, 20480, v5
    v_lshl_add_u32 v5, v2, 5, v5
    v_and_b32 v6, 1, v3
    v_lshl_add_u32 v56, v6, 4, v5
    s_mul_i32 s47, s6, 327680
    s_mov_b32 s32, s82
    s_mov_b32 s33, s83
    s_mov_b32 s34, 5308416
    s_mov_b32 s35, 0x20000
    s_mov_b32 s82, 5308416
    s_mov_b32 s83, 0x20000
    s_mov_b32 s86, 5308416
    s_mov_b32 s87, 0x20000
    s_lshr_b32 s7, s2, 3
    s_mul_i32 s7, s7, 18
    s_add_u32 s7, s7, s3
    s_and_b32 s36, s2, 7
    s_mul_i32 s37, s36, 576
    s_add_u32 s37, s37, s7
    s_mul_i32 s37, s37, 1152
    s_mul_i32 s7, s7, 9216
    s_mul_i32 s36, s36, 1152
    s_add_u32 s7, s7, s36
    v_min_u32 v5, 17, v1
    v_lshl_add_u32 v57, v5, 6, s7
    v_lshl_add_u32 v62, v5, 6, s37
    s_mov_b32 s40, 0
    s_mov_b32 s41, 0
    s_mov_b32 s48, 0
    s_waitcnt vmcnt(9)
    v_lshlrev_b32 v80, 16, v80
    s_waitcnt vmcnt(8)
    v_lshlrev_b32 v81, 16, v81
    s_waitcnt vmcnt(7)
    v_lshlrev_b32 v82, 16, v82
    s_waitcnt vmcnt(6)
    v_lshlrev_b32 v83, 16, v83
    s_waitcnt vmcnt(5)
    v_lshlrev_b32 v84, 16, v84
    v_mul_f32 v144, 0xbfb8aa3b, v80
    v_mul_f32 v148, 0xbfb8aa3b, v81
    v_mul_f32 v152, 0xbfb8aa3b, v82
    v_mul_f32 v156, 0xbfb8aa3b, v83
    v_mul_f32 v160, 0xbfb8aa3b, v84
    v_min_f32 v144, 0x42fc0000, v144
    v_min_f32 v148, 0x42fc0000, v148
    v_min_f32 v152, 0x42fc0000, v152
    v_min_f32 v156, 0x42fc0000, v156
    v_min_f32 v160, 0x42fc0000, v160
    v_exp_f32 v144, v144
    v_exp_f32 v148, v148
    v_exp_f32 v152, v152
    v_exp_f32 v156, v156
    v_exp_f32 v160, v160
    v_add_f32 v144, 1.0, v144
    v_add_f32 v148, 1.0, v148
    v_add_f32 v152, 1.0, v152
    v_add_f32 v156, 1.0, v156
    v_add_f32 v160, 1.0, v160
    v_rcp_f32 v145, v144
    v_rcp_f32 v149, v148
    v_rcp_f32 v153, v152
    v_rcp_f32 v157, v156
    v_rcp_f32 v161, v160
    v_mul_f32 v146, v80, v145
    v_mul_f32 v150, v81, v149
    v_mul_f32 v154, v82, v153
    v_mul_f32 v158, v83, v157
    v_mul_f32 v162, v84, v161
    v_fma_f32 v144, -v146, v144, v80
    v_fma_f32 v148, -v150, v148, v81
    v_fma_f32 v152, -v154, v152, v82
    v_fma_f32 v156, -v158, v156, v83
    v_fma_f32 v160, -v162, v160, v84
    v_fma_f32 v80, v144, v145, v146
    v_fma_f32 v81, v148, v149, v150
    v_fma_f32 v82, v152, v153, v154
    v_fma_f32 v83, v156, v157, v158
    v_fma_f32 v84, v160, v161, v162
    v_cvt_pk_bf16_f32 v80, v80, v80
    v_cvt_pk_bf16_f32 v81, v81, v81
    v_cvt_pk_bf16_f32 v82, v82, v82
    v_cvt_pk_bf16_f32 v83, v83, v83
    v_cvt_pk_bf16_f32 v84, v84, v84
    v_and_b32 v80, 0xffff0000, v80
    v_and_b32 v81, 0xffff0000, v81
    v_and_b32 v82, 0xffff0000, v82
    v_and_b32 v83, 0xffff0000, v83
    v_and_b32 v84, 0xffff0000, v84
    buffer_load_dwordx2 v[108:109], v66, s[20:23], s49 offen offset:0
    buffer_load_dwordx2 v[110:111], v66, s[20:23], s49 offen offset:32
    buffer_load_dwordx2 v[112:113], v66, s[20:23], s49 offen offset:384
    buffer_load_dwordx2 v[114:115], v66, s[20:23], s49 offen offset:416
    buffer_load_dwordx2 v[116:117], v66, s[20:23], s49 offen offset:768
    buffer_load_dwordx2 v[118:119], v66, s[20:23], s49 offen offset:800
    s_mov_b32 s20, s58
    s_mov_b32 s21, s59
    s_mov_b32 s22, 4718592
    s_mov_b32 s23, 0x20000
    s_waitcnt vmcnt(10)
    v_lshlrev_b32 v136, 16, v88
    v_and_b32 v137, 0xffff0000, v88
    v_lshlrev_b32 v138, 16, v89
    v_and_b32 v139, 0xffff0000, v89
    v_lshlrev_b32 v140, 16, v90
    v_and_b32 v141, 0xffff0000, v90
    v_lshlrev_b32 v142, 16, v91
    v_and_b32 v143, 0xffff0000, v91
    v_pk_mul_f32 v[128:129], v[136:137], v[80:81] op_sel:[0,0] op_sel_hi:[1,0]
    v_pk_mul_f32 v[130:131], v[138:139], v[80:81] op_sel:[0,0] op_sel_hi:[1,0]
    v_pk_mul_f32 v[132:133], v[140:141], v[80:81] op_sel:[0,0] op_sel_hi:[1,0]
    v_pk_mul_f32 v[134:135], v[142:143], v[80:81] op_sel:[0,0] op_sel_hi:[1,0]
    s_waitcnt vmcnt(9)
    v_lshlrev_b32 v136, 16, v92
    v_and_b32 v137, 0xffff0000, v92
    v_lshlrev_b32 v138, 16, v93
    v_and_b32 v139, 0xffff0000, v93
    v_lshlrev_b32 v140, 16, v94
    v_and_b32 v141, 0xffff0000, v94
    v_lshlrev_b32 v142, 16, v95
    v_and_b32 v143, 0xffff0000, v95
    v_pk_fma_f32 v[128:129], v[136:137], v[80:81], v[128:129] op_sel:[0,1,0] op_sel_hi:[1,1,1]
    v_pk_fma_f32 v[130:131], v[138:139], v[80:81], v[130:131] op_sel:[0,1,0] op_sel_hi:[1,1,1]
    v_pk_fma_f32 v[132:133], v[140:141], v[80:81], v[132:133] op_sel:[0,1,0] op_sel_hi:[1,1,1]
    v_pk_fma_f32 v[134:135], v[142:143], v[80:81], v[134:135] op_sel:[0,1,0] op_sel_hi:[1,1,1]
    s_waitcnt vmcnt(8)
    v_lshlrev_b32 v136, 16, v96
    v_and_b32 v137, 0xffff0000, v96
    v_lshlrev_b32 v138, 16, v97
    v_and_b32 v139, 0xffff0000, v97
    v_lshlrev_b32 v140, 16, v98
    v_and_b32 v141, 0xffff0000, v98
    v_lshlrev_b32 v142, 16, v99
    v_and_b32 v143, 0xffff0000, v99
    v_pk_fma_f32 v[128:129], v[136:137], v[82:83], v[128:129] op_sel:[0,0,0] op_sel_hi:[1,0,1]
    v_pk_fma_f32 v[130:131], v[138:139], v[82:83], v[130:131] op_sel:[0,0,0] op_sel_hi:[1,0,1]
    v_pk_fma_f32 v[132:133], v[140:141], v[82:83], v[132:133] op_sel:[0,0,0] op_sel_hi:[1,0,1]
    v_pk_fma_f32 v[134:135], v[142:143], v[82:83], v[134:135] op_sel:[0,0,0] op_sel_hi:[1,0,1]
    s_waitcnt vmcnt(7)
    v_lshlrev_b32 v136, 16, v100
    v_and_b32 v137, 0xffff0000, v100
    v_lshlrev_b32 v138, 16, v101
    v_and_b32 v139, 0xffff0000, v101
    v_lshlrev_b32 v140, 16, v102
    v_and_b32 v141, 0xffff0000, v102
    v_lshlrev_b32 v142, 16, v103
    v_and_b32 v143, 0xffff0000, v103
    v_pk_fma_f32 v[128:129], v[136:137], v[82:83], v[128:129] op_sel:[0,1,0] op_sel_hi:[1,1,1]
    v_pk_fma_f32 v[130:131], v[138:139], v[82:83], v[130:131] op_sel:[0,1,0] op_sel_hi:[1,1,1]
    v_pk_fma_f32 v[132:133], v[140:141], v[82:83], v[132:133] op_sel:[0,1,0] op_sel_hi:[1,1,1]
    v_pk_fma_f32 v[134:135], v[142:143], v[82:83], v[134:135] op_sel:[0,1,0] op_sel_hi:[1,1,1]
    s_waitcnt vmcnt(6)
    v_lshlrev_b32 v136, 16, v104
    v_and_b32 v137, 0xffff0000, v104
    v_lshlrev_b32 v138, 16, v105
    v_and_b32 v139, 0xffff0000, v105
    v_lshlrev_b32 v140, 16, v106
    v_and_b32 v141, 0xffff0000, v106
    v_lshlrev_b32 v142, 16, v107
    v_and_b32 v143, 0xffff0000, v107
    v_pk_fma_f32 v[128:129], v[136:137], v[84:85], v[128:129] op_sel:[0,0,0] op_sel_hi:[1,0,1]
    v_pk_fma_f32 v[130:131], v[138:139], v[84:85], v[130:131] op_sel:[0,0,0] op_sel_hi:[1,0,1]
    v_pk_fma_f32 v[132:133], v[140:141], v[84:85], v[132:133] op_sel:[0,0,0] op_sel_hi:[1,0,1]
    v_pk_fma_f32 v[134:135], v[142:143], v[84:85], v[134:135] op_sel:[0,0,0] op_sel_hi:[1,0,1]
    s_nop 0
    v_permlane32_swap_b32 v128, v132
    v_permlane32_swap_b32 v129, v133
    v_permlane32_swap_b32 v130, v134
    v_permlane32_swap_b32 v131, v135
    v_and_b32 v72, 1, v1
    v_pk_add_f32 v[128:129], v[128:129], v[132:133]
    v_pk_add_f32 v[130:131], v[130:131], v[134:135]
    v_lshlrev_b32 v72, 5, v72
    v_lshrrev_b32 v73, 4, v1
    v_permlane16_swap_b32 v128, v130
    v_permlane16_swap_b32 v129, v131
    v_lshl_add_u32 v72, v73, 3, v72
    v_pk_add_f32 v[128:129], v[128:129], v[130:131]
    s_lshl_b32 s36, s3, 6
    v_add_u32 v72, s36, v72
    v_add_f32_dpp v128, v128, v128 row_ror:2 row_mask:0xf bank_mask:0xf
    v_add_f32_dpp v129, v129, v129 row_ror:2 row_mask:0xf bank_mask:0xf
    s_nop 0
    v_add_f32_dpp v128, v128, v128 row_ror:4 row_mask:0xf bank_mask:0xf
    v_add_f32_dpp v129, v129, v129 row_ror:4 row_mask:0xf bank_mask:0xf
    s_nop 0
    v_add_f32_dpp v128, v128, v128 row_ror:8 row_mask:0xf bank_mask:0xf
    v_add_f32_dpp v129, v129, v129 row_ror:8 row_mask:0xf bank_mask:0xf
    ds_write_b64 v72, v[128:129] offset:0
    v_and_b32 v73, 7, v1
    v_lshlrev_b32 v73, 3, v73
    s_waitcnt lgkmcnt(0)
    s_barrier
    ds_read_b64 v[128:129], v73 offset:0
    ds_read_b64 v[130:131], v73 offset:64
    ds_read_b64 v[132:133], v73 offset:128
    ds_read_b64 v[134:135], v73 offset:192
    s_add_u32 s95, s94, 0x9e3779b9
    v_mov_b32 v137, s95
    s_mov_b32 s37, 32768
    s_waitcnt lgkmcnt(2)
    v_pk_add_f32 v[128:129], v[128:129], v[130:131]
    s_waitcnt lgkmcnt(0)
    v_pk_add_f32 v[132:133], v[132:133], v[134:135]
    v_pk_add_f32 v[128:129], v[128:129], v[132:133]
    v_cvt_pk_bf16_f32 v136, v128, v129
    v_lshlrev_b32 v128, 16, v136
    v_and_b32 v129, 0xffff0000, v136
    v_add_f32 v128, s93, v128
    v_add_f32 v129, s93, v129
    v_cvt_pk_bf16_f32 v136, v128, v129
    buffer_store_dwordx2 v[136:137], v69, s[24:27], s37 offen sc1
    s_mul_i32 s36, s3, 72
    v_add_u32 v122, s36, v1
    v_and_b32 v123, 7, v1
    s_add_u32 s36, s36, 64
    v_add_u32 v123, s36, v123
    s_movk_i32 s36, 1024
    v_and_b32 v76, 3, v122
    v_lshlrev_b32 v76, 4, v76
    v_lshrrev_b32 v122, 2, v122
    v_lshl_add_u32 v124, v122, 7, v76
    v_and_b32 v77, 1, v122
    v_lshl_add_u32 v76, v77, 3, v76
    v_lshrrev_b32 v122, 1, v122
    v_lshl_add_u32 v122, v122, 6, v76
    v_add_u32 v122, s36, v122
    v_and_b32 v76, 3, v123
    v_lshlrev_b32 v76, 4, v76
    v_lshrrev_b32 v123, 2, v123
    v_lshl_add_u32 v125, v123, 7, v76
    v_and_b32 v77, 1, v123
    v_lshl_add_u32 v76, v77, 3, v76
    v_lshrrev_b32 v123, 1, v123
    v_lshl_add_u32 v123, v123, 6, v76
    v_add_u32 v123, s36, v123
    s_mov_b64 exec, 0
    s_cmp_eq_u32 s3, 0
    s_cbranch_scc1 Ltour0
    s_cmp_eq_u32 s3, 1
    s_cbranch_scc1 Ltour1
    s_cmp_eq_u32 s3, 2
    s_cbranch_scc1 Ltour2
    s_branch Ltour3
.p2align 12
Lmain:
    s_mov_b64 exec, -1
    s_waitcnt vmcnt(6)
    v_lshlrev_b32 v144, 16, v108
    v_and_b32 v145, 0xffff0000, v108
    v_lshlrev_b32 v146, 16, v109
    v_and_b32 v147, 0xffff0000, v109
    s_waitcnt vmcnt(5)
    v_lshlrev_b32 v148, 16, v110
    v_and_b32 v149, 0xffff0000, v110
    v_lshlrev_b32 v150, 16, v111
    v_and_b32 v151, 0xffff0000, v111
    s_waitcnt vmcnt(4)
    v_lshlrev_b32 v152, 16, v112
    v_and_b32 v153, 0xffff0000, v112
    v_lshlrev_b32 v154, 16, v113
    v_and_b32 v155, 0xffff0000, v113
    s_waitcnt vmcnt(3)
    v_lshlrev_b32 v156, 16, v114
    v_and_b32 v157, 0xffff0000, v114
    v_lshlrev_b32 v158, 16, v115
    v_and_b32 v159, 0xffff0000, v115
    s_waitcnt vmcnt(2)
    v_lshlrev_b32 v160, 16, v116
    v_and_b32 v161, 0xffff0000, v116
    v_lshlrev_b32 v162, 16, v117
    v_and_b32 v163, 0xffff0000, v117
    s_waitcnt vmcnt(1)
    v_lshlrev_b32 v164, 16, v118
    v_and_b32 v165, 0xffff0000, v118
    v_lshlrev_b32 v166, 16, v119
    v_and_b32 v167, 0xffff0000, v119
    buffer_load_dwordx4 v[88:91], v124, s[24:27], s37 offen sc1
    buffer_load_dwordx4 v[92:95], v125, s[24:27], s37 offen sc1
    buffer_load_dword v242, v71, s[16:19], s44 offen
    v_pk_add_f32 v[72:73], v[144:145], v[148:149]
    v_pk_add_f32 v[76:77], v[146:147], v[150:151]
    v_pk_add_f32 v[72:73], v[72:73], v[152:153]
    v_pk_add_f32 v[76:77], v[76:77], v[154:155]
    v_pk_add_f32 v[72:73], v[72:73], v[156:157]
    v_pk_add_f32 v[76:77], v[76:77], v[158:159]
    v_pk_add_f32 v[72:73], v[72:73], v[160:161]
    v_pk_add_f32 v[76:77], v[76:77], v[162:163]
    v_pk_add_f32 v[72:73], v[72:73], v[164:165]
    v_pk_add_f32 v[76:77], v[76:77], v[166:167]
    v_pk_add_f32 v[72:73], v[72:73], v[76:77]
    v_add_f32 v72, v72, v73
    s_nop 1
    v_add_f32_dpp v72, v72, v72 row_ror:8 row_mask:0xf bank_mask:0xf
    s_nop 1
    v_add_f32_dpp v72, v72, v72 row_ror:4 row_mask:0xf bank_mask:0xf
    s_nop 1
    v_add_f32_dpp v72, v72, v72 row_ror:2 row_mask:0xf bank_mask:0xf
    s_nop 1
    v_add_f32_dpp v72, v72, v72 row_ror:1 row_mask:0xf bank_mask:0xf
    v_mov_b32 v76, v72
    s_nop 1
    v_permlane16_swap_b32 v72, v76
    s_nop 0
    v_add_f32 v72, v72, v76
    v_mul_f32 v72, 0x3ae38e39, v72
    v_pk_add_f32 v[168:169], v[144:145], v[72:73] op_sel_hi:[1,0] neg_lo:[0,1] neg_hi:[0,1]
    v_pk_add_f32 v[170:171], v[146:147], v[72:73] op_sel_hi:[1,0] neg_lo:[0,1] neg_hi:[0,1]
    v_pk_add_f32 v[172:173], v[148:149], v[72:73] op_sel_hi:[1,0] neg_lo:[0,1] neg_hi:[0,1]
    v_pk_add_f32 v[174:175], v[150:151], v[72:73] op_sel_hi:[1,0] neg_lo:[0,1] neg_hi:[0,1]
    v_pk_add_f32 v[176:177], v[152:153], v[72:73] op_sel_hi:[1,0] neg_lo:[0,1] neg_hi:[0,1]
    v_pk_add_f32 v[178:179], v[154:155], v[72:73] op_sel_hi:[1,0] neg_lo:[0,1] neg_hi:[0,1]
    v_pk_add_f32 v[180:181], v[156:157], v[72:73] op_sel_hi:[1,0] neg_lo:[0,1] neg_hi:[0,1]
    v_pk_add_f32 v[182:183], v[158:159], v[72:73] op_sel_hi:[1,0] neg_lo:[0,1] neg_hi:[0,1]
    v_pk_add_f32 v[184:185], v[160:161], v[72:73] op_sel_hi:[1,0] neg_lo:[0,1] neg_hi:[0,1]
    v_pk_add_f32 v[186:187], v[162:163], v[72:73] op_sel_hi:[1,0] neg_lo:[0,1] neg_hi:[0,1]
    v_pk_add_f32 v[188:189], v[164:165], v[72:73] op_sel_hi:[1,0] neg_lo:[0,1] neg_hi:[0,1]
    v_pk_add_f32 v[190:191], v[166:167], v[72:73] op_sel_hi:[1,0] neg_lo:[0,1] neg_hi:[0,1]
    v_pk_mul_f32 v[74:75], v[168:169], v[168:169]
    v_pk_mul_f32 v[76:77], v[170:171], v[170:171]
    v_pk_fma_f32 v[74:75], v[172:173], v[172:173], v[74:75]
    v_pk_fma_f32 v[76:77], v[174:175], v[174:175], v[76:77]
    v_pk_fma_f32 v[74:75], v[176:177], v[176:177], v[74:75]
    v_pk_fma_f32 v[76:77], v[178:179], v[178:179], v[76:77]
    v_pk_fma_f32 v[74:75], v[180:181], v[180:181], v[74:75]
    v_pk_fma_f32 v[76:77], v[182:183], v[182:183], v[76:77]
    v_pk_fma_f32 v[74:75], v[184:185], v[184:185], v[74:75]
    v_pk_fma_f32 v[76:77], v[186:187], v[186:187], v[76:77]
    v_pk_fma_f32 v[74:75], v[188:189], v[188:189], v[74:75]
    v_pk_fma_f32 v[76:77], v[190:191], v[190:191], v[76:77]
    v_pk_add_f32 v[74:75], v[74:75], v[76:77]
    v_add_f32 v74, v74, v75
    v_cndmask_b32 v74, 0, v74, vcc
    s_nop 1
    v_add_f32_dpp v74, v74, v74 row_ror:8 row_mask:0xf bank_mask:0xf
    s_nop 1
    v_add_f32_dpp v74, v74, v74 row_ror:4 row_mask:0xf bank_mask:0xf
    s_nop 1
    v_add_f32_dpp v74, v74, v74 row_ror:2 row_mask:0xf bank_mask:0xf
    s_nop 1
    v_add_f32_dpp v74, v74, v74 row_ror:1 row_mask:0xf bank_mask:0xf
    v_mov_b32 v76, v74
    s_nop 1
    v_permlane16_swap_b32 v74, v76
    s_nop 0
    v_add_f32 v74, v74, v76
    v_mul_f32 v74, 0x3ae38e39, v74
    v_cvt_pk_bf16_f32 v76, v72, v74
    v_and_b32 v74, 0xffff0000, v76
    v_lshlrev_b32 v72, 16, v76
    v_add_f32 v74, 0x3727c5ac, v74
    v_cvt_pk_bf16_f32 v74, v74, v74
    v_and_b32 v74, 0xffff0000, v74
    v_sqrt_f32 v74, v74
    v_pk_add_f32 v[168:169], v[144:145], v[72:73] op_sel_hi:[1,0] neg_lo:[0,1] neg_hi:[0,1]
    v_pk_add_f32 v[170:171], v[146:147], v[72:73] op_sel_hi:[1,0] neg_lo:[0,1] neg_hi:[0,1]
    v_pk_add_f32 v[172:173], v[148:149], v[72:73] op_sel_hi:[1,0] neg_lo:[0,1] neg_hi:[0,1]
    v_pk_add_f32 v[174:175], v[150:151], v[72:73] op_sel_hi:[1,0] neg_lo:[0,1] neg_hi:[0,1]
    v_pk_add_f32 v[176:177], v[152:153], v[72:73] op_sel_hi:[1,0] neg_lo:[0,1] neg_hi:[0,1]
    v_pk_add_f32 v[178:179], v[154:155], v[72:73] op_sel_hi:[1,0] neg_lo:[0,1] neg_hi:[0,1]
    v_pk_add_f32 v[180:181], v[156:157], v[72:73] op_sel_hi:[1,0] neg_lo:[0,1] neg_hi:[0,1]
    v_pk_add_f32 v[182:183], v[158:159], v[72:73] op_sel_hi:[1,0] neg_lo:[0,1] neg_hi:[0,1]
    v_pk_add_f32 v[184:185], v[160:161], v[72:73] op_sel_hi:[1,0] neg_lo:[0,1] neg_hi:[0,1]
    v_pk_add_f32 v[186:187], v[162:163], v[72:73] op_sel_hi:[1,0] neg_lo:[0,1] neg_hi:[0,1]
    v_pk_add_f32 v[188:189], v[164:165], v[72:73] op_sel_hi:[1,0] neg_lo:[0,1] neg_hi:[0,1]
    v_pk_add_f32 v[190:191], v[166:167], v[72:73] op_sel_hi:[1,0] neg_lo:[0,1] neg_hi:[0,1]
    v_cvt_pk_bf16_f32 v74, v74, v74
    v_and_b32 v74, 0xffff0000, v74
    v_rcp_f32 v74, v74
    v_cvt_pk_bf16_f32 v108, v168, v169
    v_cvt_pk_bf16_f32 v109, v170, v171
    v_cvt_pk_bf16_f32 v110, v172, v173
    v_cvt_pk_bf16_f32 v111, v174, v175
    v_cvt_pk_bf16_f32 v112, v176, v177
    v_cvt_pk_bf16_f32 v113, v178, v179
    v_cvt_pk_bf16_f32 v114, v180, v181
    v_cvt_pk_bf16_f32 v115, v182, v183
    v_cvt_pk_bf16_f32 v116, v184, v185
    v_cvt_pk_bf16_f32 v117, v186, v187
    v_cvt_pk_bf16_f32 v118, v188, v189
    v_cvt_pk_bf16_f32 v119, v190, v191
    v_lshlrev_b32 v168, 16, v108
    v_and_b32 v169, 0xffff0000, v108
    v_lshlrev_b32 v170, 16, v109
    v_and_b32 v171, 0xffff0000, v109
    v_lshlrev_b32 v172, 16, v110
    v_and_b32 v173, 0xffff0000, v110
    v_lshlrev_b32 v174, 16, v111
    v_and_b32 v175, 0xffff0000, v111
    v_lshlrev_b32 v176, 16, v112
    v_and_b32 v177, 0xffff0000, v112
    v_lshlrev_b32 v178, 16, v113
    v_and_b32 v179, 0xffff0000, v113
    v_lshlrev_b32 v180, 16, v114
    v_and_b32 v181, 0xffff0000, v114
    v_lshlrev_b32 v182, 16, v115
    v_and_b32 v183, 0xffff0000, v115
    v_lshlrev_b32 v184, 16, v116
    v_and_b32 v185, 0xffff0000, v116
    v_lshlrev_b32 v186, 16, v117
    v_and_b32 v187, 0xffff0000, v117
    v_lshlrev_b32 v188, 16, v118
    v_and_b32 v189, 0xffff0000, v118
    v_lshlrev_b32 v190, 16, v119
    v_and_b32 v191, 0xffff0000, v119
    v_pk_mul_f32 v[168:169], v[168:169], v[74:75] op_sel_hi:[1,0]
    v_pk_mul_f32 v[170:171], v[170:171], v[74:75] op_sel_hi:[1,0]
    v_pk_mul_f32 v[172:173], v[172:173], v[74:75] op_sel_hi:[1,0]
    v_pk_mul_f32 v[174:175], v[174:175], v[74:75] op_sel_hi:[1,0]
    v_pk_mul_f32 v[176:177], v[176:177], v[74:75] op_sel_hi:[1,0]
    v_pk_mul_f32 v[178:179], v[178:179], v[74:75] op_sel_hi:[1,0]
    v_pk_mul_f32 v[180:181], v[180:181], v[74:75] op_sel_hi:[1,0]
    v_pk_mul_f32 v[182:183], v[182:183], v[74:75] op_sel_hi:[1,0]
    v_pk_mul_f32 v[184:185], v[184:185], v[74:75] op_sel_hi:[1,0]
    v_pk_mul_f32 v[186:187], v[186:187], v[74:75] op_sel_hi:[1,0]
    v_pk_mul_f32 v[188:189], v[188:189], v[74:75] op_sel_hi:[1,0]
    v_pk_mul_f32 v[190:191], v[190:191], v[74:75] op_sel_hi:[1,0]
    v_cvt_pk_bf16_f32 v108, v168, v169
    v_cvt_pk_bf16_f32 v109, v170, v171
    v_cvt_pk_bf16_f32 v110, v172, v173
    v_cvt_pk_bf16_f32 v111, v174, v175
    v_cvt_pk_bf16_f32 v112, v176, v177
    v_cvt_pk_bf16_f32 v113, v178, v179
    v_cvt_pk_bf16_f32 v114, v180, v181
    v_cvt_pk_bf16_f32 v115, v182, v183
    v_cvt_pk_bf16_f32 v116, v184, v185
    v_cvt_pk_bf16_f32 v117, v186, v187
    v_cvt_pk_bf16_f32 v118, v188, v189
    v_cvt_pk_bf16_f32 v119, v190, v191
    v_lshlrev_b32 v168, 16, v108
    v_and_b32 v169, 0xffff0000, v108
    v_lshlrev_b32 v170, 16, v109
    v_and_b32 v171, 0xffff0000, v109
    v_lshlrev_b32 v172, 16, v110
    v_and_b32 v173, 0xffff0000, v110
    v_lshlrev_b32 v174, 16, v111
    v_and_b32 v175, 0xffff0000, v111
    v_lshlrev_b32 v176, 16, v112
    v_and_b32 v177, 0xffff0000, v112
    v_lshlrev_b32 v178, 16, v113
    v_and_b32 v179, 0xffff0000, v113
    v_lshlrev_b32 v180, 16, v114
    v_and_b32 v181, 0xffff0000, v114
    v_lshlrev_b32 v182, 16, v115
    v_and_b32 v183, 0xffff0000, v115
    v_lshlrev_b32 v184, 16, v116
    v_and_b32 v185, 0xffff0000, v116
    v_lshlrev_b32 v186, 16, v117
    v_and_b32 v187, 0xffff0000, v117
    v_lshlrev_b32 v188, 16, v118
    v_and_b32 v189, 0xffff0000, v118
    v_lshlrev_b32 v190, 16, v119
    v_and_b32 v191, 0xffff0000, v119
    s_mov_b32 s38, 262144
    s_waitcnt vmcnt(2)
    v_xor_b32 v89, s95, v89
    v_xor_b32 v91, s95, v91
    s_waitcnt vmcnt(1)
    v_xor_b32 v93, s95, v93
    v_xor_b32 v95, s95, v95
    v_or3_b32 v89, v89, v91, v93
    v_or_b32 v89, v89, v95
    v_cmp_ne_u32 vcc, 0, v89
    s_cbranch_vccz Lhead_gotm
Lhead_pollm:
    buffer_load_dwordx4 v[88:91], v124, s[24:27], s37 offen sc1
    buffer_load_dwordx4 v[92:95], v125, s[24:27], s37 offen sc1
    s_waitcnt vmcnt(0)
    s_sub_u32 s38, s38, 1
    s_cbranch_scc1 Lhead_gotm
    v_xor_b32 v89, s95, v89
    v_xor_b32 v91, s95, v91
    v_xor_b32 v93, s95, v93
    v_xor_b32 v95, s95, v95
    v_or3_b32 v89, v89, v91, v93
    v_or_b32 v89, v89, v95
    v_cmp_ne_u32 vcc, 0, v89
    s_cbranch_vccnz Lhead_pollm
Lhead_gotm:
    ds_write2_b32 v122, v88, v90 offset0:0 offset1:1
    ds_write2_b32 v123, v92, v94 offset0:0 offset1:1
    s_waitcnt lgkmcnt(0)
    s_barrier
    ds_read_b128 v[144:147], v68 offset:2176
    ds_read_b128 v[148:151], v68 offset:2560
    ds_read_b128 v[152:155], v68 offset:2944
    ds_read_b128 v[156:159], v68 offset:1024
    ds_read_b128 v[160:163], v68 offset:1408
    ds_read_b128 v[164:167], v68 offset:1792
    s_waitcnt lgkmcnt(5)
    v_lshlrev_b32 v192, 16, v144
    v_and_b32 v193, 0xffff0000, v144
    v_lshlrev_b32 v194, 16, v145
    v_and_b32 v195, 0xffff0000, v145
    v_lshlrev_b32 v196, 16, v146
    v_and_b32 v197, 0xffff0000, v146
    v_lshlrev_b32 v198, 16, v147
    v_and_b32 v199, 0xffff0000, v147
    s_waitcnt lgkmcnt(4)
    v_lshlrev_b32 v200, 16, v148
    v_and_b32 v201, 0xffff0000, v148
    v_lshlrev_b32 v202, 16, v149
    v_and_b32 v203, 0xffff0000, v149
    v_lshlrev_b32 v204, 16, v150
    v_and_b32 v205, 0xffff0000, v150
    v_lshlrev_b32 v206, 16, v151
    v_and_b32 v207, 0xffff0000, v151
    s_waitcnt lgkmcnt(3)
    v_lshlrev_b32 v208, 16, v152
    v_and_b32 v209, 0xffff0000, v152
    v_lshlrev_b32 v210, 16, v153
    v_and_b32 v211, 0xffff0000, v153
    v_lshlrev_b32 v212, 16, v154
    v_and_b32 v213, 0xffff0000, v154
    v_lshlrev_b32 v214, 16, v155
    v_and_b32 v215, 0xffff0000, v155
    v_pk_mul_f32 v[168:169], v[168:169], v[192:193]
    v_pk_mul_f32 v[170:171], v[170:171], v[194:195]
    v_pk_mul_f32 v[172:173], v[172:173], v[196:197]
    v_pk_mul_f32 v[174:175], v[174:175], v[198:199]
    v_pk_mul_f32 v[176:177], v[176:177], v[200:201]
    v_pk_mul_f32 v[178:179], v[178:179], v[202:203]
    v_pk_mul_f32 v[180:181], v[180:181], v[204:205]
    v_pk_mul_f32 v[182:183], v[182:183], v[206:207]
    v_pk_mul_f32 v[184:185], v[184:185], v[208:209]
    v_pk_mul_f32 v[186:187], v[186:187], v[210:211]
    v_pk_mul_f32 v[188:189], v[188:189], v[212:213]
    v_pk_mul_f32 v[190:191], v[190:191], v[214:215]
    v_cvt_pk_bf16_f32 v108, v168, v169
    v_cvt_pk_bf16_f32 v109, v170, v171
    v_cvt_pk_bf16_f32 v110, v172, v173
    v_cvt_pk_bf16_f32 v111, v174, v175
    v_cvt_pk_bf16_f32 v112, v176, v177
    v_cvt_pk_bf16_f32 v113, v178, v179
    v_cvt_pk_bf16_f32 v114, v180, v181
    v_cvt_pk_bf16_f32 v115, v182, v183
    v_cvt_pk_bf16_f32 v116, v184, v185
    v_cvt_pk_bf16_f32 v117, v186, v187
    v_cvt_pk_bf16_f32 v118, v188, v189
    v_cvt_pk_bf16_f32 v119, v190, v191
    s_waitcnt lgkmcnt(2)
    v_lshlrev_b32 v216, 16, v156
    v_and_b32 v217, 0xffff0000, v156
    v_lshlrev_b32 v218, 16, v157
    v_and_b32 v219, 0xffff0000, v157
    v_lshlrev_b32 v220, 16, v158
    v_and_b32 v221, 0xffff0000, v158
    v_lshlrev_b32 v222, 16, v159
    v_and_b32 v223, 0xffff0000, v159
    s_waitcnt lgkmcnt(1)
    v_lshlrev_b32 v224, 16, v160
    v_and_b32 v225, 0xffff0000, v160
    v_lshlrev_b32 v226, 16, v161
    v_and_b32 v227, 0xffff0000, v161
    v_lshlrev_b32 v228, 16, v162
    v_and_b32 v229, 0xffff0000, v162
    v_lshlrev_b32 v230, 16, v163
    v_and_b32 v231, 0xffff0000, v163
    s_waitcnt lgkmcnt(0)
    v_lshlrev_b32 v232, 16, v164
    v_and_b32 v233, 0xffff0000, v164
    v_lshlrev_b32 v234, 16, v165
    v_and_b32 v235, 0xffff0000, v165
    v_lshlrev_b32 v236, 16, v166
    v_and_b32 v237, 0xffff0000, v166
    v_lshlrev_b32 v238, 16, v167
    v_and_b32 v239, 0xffff0000, v167
    v_lshlrev_b32 v168, 16, v108
    v_and_b32 v169, 0xffff0000, v108
    v_lshlrev_b32 v170, 16, v109
    v_and_b32 v171, 0xffff0000, v109
    v_lshlrev_b32 v172, 16, v110
    v_and_b32 v173, 0xffff0000, v110
    v_lshlrev_b32 v174, 16, v111
    v_and_b32 v175, 0xffff0000, v111
    v_lshlrev_b32 v176, 16, v112
    v_and_b32 v177, 0xffff0000, v112
    v_lshlrev_b32 v178, 16, v113
    v_and_b32 v179, 0xffff0000, v113
    v_lshlrev_b32 v180, 16, v114
    v_and_b32 v181, 0xffff0000, v114
    v_lshlrev_b32 v182, 16, v115
    v_and_b32 v183, 0xffff0000, v115
    v_lshlrev_b32 v184, 16, v116
    v_and_b32 v185, 0xffff0000, v116
    v_lshlrev_b32 v186, 16, v117
    v_and_b32 v187, 0xffff0000, v117
    v_lshlrev_b32 v188, 16, v118
    v_and_b32 v189, 0xffff0000, v118
    v_lshlrev_b32 v190, 16, v119
    v_and_b32 v191, 0xffff0000, v119
    v_pk_add_f32 v[168:169], v[168:169], v[216:217]
    v_pk_add_f32 v[170:171], v[170:171], v[218:219]
    v_pk_add_f32 v[172:173], v[172:173], v[220:221]
    v_pk_add_f32 v[174:175], v[174:175], v[222:223]
    v_cvt_pk_bf16_f32 v108, v168, v169
    v_cvt_pk_bf16_f32 v109, v170, v171
    v_cvt_pk_bf16_f32 v110, v172, v173
    v_cvt_pk_bf16_f32 v111, v174, v175
    buffer_store_dwordx4 v[108:111], v67, s[24:27], s92 offen offset:0 sc1
    v_pk_add_f32 v[176:177], v[176:177], v[224:225]
    v_pk_add_f32 v[178:179], v[178:179], v[226:227]
    v_pk_add_f32 v[180:181], v[180:181], v[228:229]
    v_pk_add_f32 v[182:183], v[182:183], v[230:231]
    v_cvt_pk_bf16_f32 v112, v176, v177
    v_cvt_pk_bf16_f32 v113, v178, v179
    v_cvt_pk_bf16_f32 v114, v180, v181
    v_cvt_pk_bf16_f32 v115, v182, v183
    buffer_store_dwordx4 v[112:115], v67, s[24:27], s92 offen offset:768 sc1
    v_pk_add_f32 v[184:185], v[184:185], v[232:233]
    v_pk_add_f32 v[186:187], v[186:187], v[234:235]
    v_pk_add_f32 v[188:189], v[188:189], v[236:237]
    v_pk_add_f32 v[190:191], v[190:191], v[238:239]
    v_cvt_pk_bf16_f32 v116, v184, v185
    v_cvt_pk_bf16_f32 v117, v186, v187
    v_cvt_pk_bf16_f32 v118, v188, v189
    v_cvt_pk_bf16_f32 v119, v190, v191
    buffer_store_dwordx4 v[116:119], v67, s[24:27], s92 offen offset:1536 sc1
    s_lshl_b32 s36, s5, 13
    s_add_u32 s36, s36, 8650752
    s_lshl_b32 s37, s4, 9
    s_add_u32 s37, s37, s36
    s_lshl_b32 s38, s3, 7
    s_add_u32 s37, s37, s38
    s_lshl_b32 s38, s3, 11
    s_add_u32 s36, s36, s38
    v_min_u32 v72, 1, v1
    v_lshlrev_b32 v72, 31, v72
    v_and_b32 v73, 15, v1
    v_lshlrev_b32 v73, 7, v73
    v_cmp_gt_u32 vcc, 162, v0
    v_mov_b32 v88, -1
    v_mov_b32 v89, -1
    v_mov_b32 v90, -1
    v_mov_b32 v91, -1
    s_mul_i32 s39, s2, 2592
    s_add_u32 s39, s39, 7864320
    v_lshl_add_u32 v74, v0, 4, s39
    s_lshl_b32 s39, s2, 7
    s_add_u32 s39, s39, 9306112
    v_mov_b32 v75, s39
    v_cndmask_b32 v74, v75, v74, vcc
    s_lshl_b32 s92, s5, 13
    s_add_u32 s92, s92, 8781824
    s_add_u32 s92, s92, s38
    s_lshl_b32 s38, s4, 7
    s_add_u32 s92, s92, s38
    s_getreg_b32 s38, hwreg(HW_REG_XCC_ID, 0, 4)
    s_lshl_b32 s38, s38, 28
    s_xor_b32 s38, s38, s95
    v_mov_b32 v76, s38
    v_mov_b32 v2, v80
    v_mov_b32 v3, v81
    v_mov_b32 v4, v82
    v_mov_b32 v5, v83
    v_mov_b32 v6, v84
    v_mov_b32 v7, v65
    v_and_b32 v126, 31, v1
    v_lshlrev_b32 v126, 2, v126
    s_waitcnt vmcnt(0)
    buffer_store_dword v137, v126, s[24:27], s37 offen sc1
    s_add_u32 s49, s44, 0
    s_add_u32 m0, s42, 32768
    s_nop 0
    buffer_load_dwordx4 v42, s[16:19], s49 offen lds
    buffer_load_dwordx4 v43, s[16:19], s49 offen offset:1024 lds
    buffer_load_dwordx4 v44, s[16:19], s49 offen offset:2048 lds
    buffer_load_dwordx4 v45, s[16:19], s49 offen offset:3072 lds
    s_add_u32 s49, s44, 256
    s_add_u32 m0, s42, 49152
    s_nop 0
    buffer_load_dwordx4 v42, s[16:19], s49 offen lds
    buffer_load_dwordx4 v43, s[16:19], s49 offen offset:1024 lds
    buffer_load_dwordx4 v44, s[16:19], s49 offen offset:2048 lds
    buffer_load_dwordx4 v45, s[16:19], s49 offen offset:3072 lds
    s_add_u32 s49, s44, 524288
    s_add_u32 m0, s42, 65536
    s_nop 0
    buffer_load_dwordx4 v42, s[16:19], s49 offen lds
    buffer_load_dwordx4 v43, s[16:19], s49 offen offset:1024 lds
    buffer_load_dwordx4 v44, s[16:19], s49 offen offset:2048 lds
    buffer_load_dwordx4 v45, s[16:19], s49 offen offset:3072 lds
    s_add_u32 s49, s44, 524544
    s_add_u32 m0, s42, 81920
    s_nop 0
    buffer_load_dwordx4 v42, s[16:19], s49 offen lds
    buffer_load_dwordx4 v43, s[16:19], s49 offen offset:1024 lds
    buffer_load_dwordx4 v44, s[16:19], s49 offen offset:2048 lds
    buffer_load_dwordx4 v45, s[16:19], s49 offen offset:3072 lds
    s_add_u32 s49, s44, 1048576
    s_add_u32 m0, s42, 98304
    s_nop 0
    buffer_load_dwordx4 v42, s[16:19], s49 offen lds
    buffer_load_dwordx4 v43, s[16:19], s49 offen offset:1024 lds
    buffer_load_dwordx4 v44, s[16:19], s49 offen offset:2048 lds
    buffer_load_dwordx4 v45, s[16:19], s49 offen offset:3072 lds
    s_add_u32 s49, s44, 1048832
    s_add_u32 m0, s42, 114688
    s_nop 0
    buffer_load_dwordx4 v42, s[16:19], s49 offen lds
    buffer_load_dwordx4 v43, s[16:19], s49 offen offset:1024 lds
    buffer_load_dwordx4 v44, s[16:19], s49 offen offset:2048 lds
    buffer_load_dwordx4 v45, s[16:19], s49 offen offset:3072 lds
    s_mov_b32 s38, 262144
Lhead_pollh:
    buffer_load_dword v75, v73, s[24:27], s36 offen sc1
    s_sub_u32 s38, s38, 1
    s_cbranch_scc1 Lhead_goth
    s_waitcnt vmcnt(0) lgkmcnt(0)
    v_cmp_ne_u32 vcc, s95, v75
    s_cbranch_vccnz Lhead_pollh
Lhead_goth:
    s_waitcnt vmcnt(0) lgkmcnt(0)
    buffer_load_dwordx4 a[0:3], v51, s[24:27], s46 offen offset:0 sc1
    buffer_load_dwordx4 a[8:11], v51, s[24:27], s46 offen offset:128 sc1
    buffer_load_dwordx4 a[4:7], v51, s[24:27], s43 offen offset:0 sc1
    buffer_load_dwordx4 a[12:15], v51, s[24:27], s43 offen offset:128 sc1
    s_barrier
    ds_read_b64_tr_b16 a[160:161], v12 offset:32768
    ds_read_b64_tr_b16 a[162:163], v12 offset:36864
    ds_read_b64_tr_b16 a[164:165], v12 offset:40960
    ds_read_b64_tr_b16 a[166:167], v12 offset:45056
    ds_read_b64_tr_b16 a[168:169], v13 offset:32768
    ds_read_b64_tr_b16 a[170:171], v13 offset:36864
    ds_read_b64_tr_b16 a[172:173], v13 offset:40960
    ds_read_b64_tr_b16 a[174:175], v13 offset:45056
    ds_read_b64_tr_b16 a[176:177], v14 offset:32768
    ds_read_b64_tr_b16 a[178:179], v14 offset:36864
    ds_read_b64_tr_b16 a[180:181], v14 offset:40960
    ds_read_b64_tr_b16 a[182:183], v14 offset:45056
    buffer_load_dwordx4 a[16:19], v51, s[24:27], s46 offen offset:256 sc1
    buffer_load_dwordx4 a[24:27], v51, s[24:27], s46 offen offset:384 sc1
    buffer_load_dwordx4 a[20:23], v51, s[24:27], s43 offen offset:256 sc1
    buffer_load_dwordx4 a[28:31], v51, s[24:27], s43 offen offset:384 sc1
    s_waitcnt lgkmcnt(10)
    s_waitcnt vmcnt(7)
    v_mfma_f32_16x16x32_bf16 v[128:131], a[160:163], a[0:3], 0
    s_waitcnt vmcnt(6)
    s_waitcnt lgkmcnt(8)
    ds_read_b64_tr_b16 a[184:185], v15 offset:32768
    v_mfma_f32_16x16x32_bf16 v[128:131], a[164:167], a[8:11], v[128:131]
    s_waitcnt vmcnt(4)
    ds_read_b64_tr_b16 a[186:187], v15 offset:36864
    v_mfma_f32_16x16x32_bf16 v[132:135], a[164:167], a[12:15], 0
    ds_read_b64_tr_b16 a[188:189], v15 offset:40960
    v_mfma_f32_16x16x32_bf16 v[132:135], a[160:163], a[4:7], v[132:135]
    s_waitcnt lgkmcnt(9)
    buffer_load_dwordx4 a[32:35], v51, s[24:27], s46 offen offset:512 sc1
    v_mfma_f32_16x16x32_bf16 v[140:143], a[168:171], a[4:7], 0
    s_waitcnt lgkmcnt(7)
    ds_read_b64_tr_b16 a[190:191], v15 offset:45056
    ds_read_b64_tr_b16 a[160:161], v16 offset:32768
    v_mfma_f32_16x16x32_bf16 v[140:143], a[172:175], a[12:15], v[140:143]
    ds_read_b64_tr_b16 a[162:163], v16 offset:36864
    v_mfma_f32_16x16x32_bf16 v[136:139], a[172:175], a[8:11], 0
    ds_read_b64_tr_b16 a[164:165], v16 offset:40960
    v_mfma_f32_16x16x32_bf16 v[136:139], a[168:171], a[0:3], v[136:139]
    s_waitcnt lgkmcnt(9)
    buffer_load_dwordx4 a[40:43], v51, s[24:27], s46 offen offset:640 sc1
    v_mfma_f32_16x16x32_bf16 v[144:147], a[176:179], a[0:3], 0
    s_waitcnt lgkmcnt(7)
    ds_read_b64_tr_b16 a[166:167], v16 offset:45056
    ds_read_b64_tr_b16 a[168:169], v17 offset:32768
    v_mfma_f32_16x16x32_bf16 v[144:147], a[180:183], a[8:11], v[144:147]
    ds_read_b64_tr_b16 a[170:171], v17 offset:36864
    v_mfma_f32_16x16x32_bf16 v[148:151], a[180:183], a[12:15], 0
    ds_read_b64_tr_b16 a[172:173], v17 offset:40960
    v_mfma_f32_16x16x32_bf16 v[148:151], a[176:179], a[4:7], v[148:151]
    s_waitcnt lgkmcnt(9)
    buffer_load_dwordx4 a[36:39], v51, s[24:27], s43 offen offset:512 sc1
    v_mfma_f32_16x16x32_bf16 v[156:159], a[184:187], a[4:7], 0
    s_waitcnt lgkmcnt(7)
    ds_read_b64_tr_b16 a[174:175], v17 offset:45056
    ds_read_b64_tr_b16 a[176:177], v18 offset:32768
    v_mfma_f32_16x16x32_bf16 v[156:159], a[188:191], a[12:15], v[156:159]
    ds_read_b64_tr_b16 a[178:179], v18 offset:36864
    v_mfma_f32_16x16x32_bf16 v[152:155], a[188:191], a[8:11], 0
    ds_read_b64_tr_b16 a[180:181], v18 offset:40960
    v_mfma_f32_16x16x32_bf16 v[152:155], a[184:187], a[0:3], v[152:155]
    s_waitcnt lgkmcnt(9)
    buffer_load_dwordx4 a[44:47], v51, s[24:27], s43 offen offset:640 sc1
    v_mfma_f32_16x16x32_bf16 v[160:163], a[160:163], a[0:3], 0
    s_waitcnt lgkmcnt(7)
    ds_read_b64_tr_b16 a[182:183], v18 offset:45056
    ds_read_b64_tr_b16 a[184:185], v19 offset:32768
    v_mfma_f32_16x16x32_bf16 v[160:163], a[164:167], a[8:11], v[160:163]
    ds_read_b64_tr_b16 a[186:187], v19 offset:36864
    v_mfma_f32_16x16x32_bf16 v[164:167], a[164:167], a[12:15], 0
    ds_read_b64_tr_b16 a[188:189], v19 offset:40960
    v_mfma_f32_16x16x32_bf16 v[164:167], a[160:163], a[4:7], v[164:167]
    s_waitcnt lgkmcnt(9)
    buffer_load_dword v77, v70, s[16:19], s44 offen
    v_mfma_f32_16x16x32_bf16 v[172:175], a[168:171], a[4:7], 0
    s_waitcnt lgkmcnt(7)
    ds_read_b64_tr_b16 a[190:191], v19 offset:45056
    ds_read_b64_tr_b16 a[160:161], v12 offset:49152
    v_mfma_f32_16x16x32_bf16 v[172:175], a[172:175], a[12:15], v[172:175]
    ds_read_b64_tr_b16 a[162:163], v12 offset:53248
    v_mfma_f32_16x16x32_bf16 v[168:171], a[172:175], a[8:11], 0
    ds_read_b64_tr_b16 a[164:165], v12 offset:57344
    v_mfma_f32_16x16x32_bf16 v[168:171], a[168:171], a[0:3], v[168:171]
    s_waitcnt lgkmcnt(9)
    ds_read_b64_tr_b16 a[166:167], v12 offset:61440
    v_mfma_f32_16x16x32_bf16 v[176:179], a[176:179], a[0:3], 0
    s_waitcnt lgkmcnt(8)
    ds_read_b64_tr_b16 a[168:169], v13 offset:49152
    v_mfma_f32_16x16x32_bf16 v[176:179], a[180:183], a[8:11], v[176:179]
    ds_read_b64_tr_b16 a[170:171], v13 offset:53248
    v_mfma_f32_16x16x32_bf16 v[180:183], a[180:183], a[12:15], 0
    ds_read_b64_tr_b16 a[172:173], v13 offset:57344
    v_mfma_f32_16x16x32_bf16 v[180:183], a[176:179], a[4:7], v[180:183]
    s_waitcnt lgkmcnt(9)
    ds_read_b64_tr_b16 a[174:175], v13 offset:61440
    v_mfma_f32_16x16x32_bf16 v[188:191], a[184:187], a[4:7], 0
    s_waitcnt lgkmcnt(8)
    ds_read_b64_tr_b16 a[176:177], v14 offset:49152
    v_mfma_f32_16x16x32_bf16 v[188:191], a[188:191], a[12:15], v[188:191]
    ds_read_b64_tr_b16 a[178:179], v14 offset:53248
    v_mfma_f32_16x16x32_bf16 v[184:187], a[188:191], a[8:11], 0
    ds_read_b64_tr_b16 a[180:181], v14 offset:57344
    v_mfma_f32_16x16x32_bf16 v[184:187], a[184:187], a[0:3], v[184:187]
    s_waitcnt lgkmcnt(9)
    ds_read_b64_tr_b16 a[182:183], v14 offset:61440
    v_mfma_f32_16x16x32_bf16 v[192:195], a[160:163], a[0:3], 0
    s_waitcnt lgkmcnt(8)
    ds_read_b64_tr_b16 a[184:185], v15 offset:49152
    v_mfma_f32_16x16x32_bf16 v[192:195], a[164:167], a[8:11], v[192:195]
    ds_read_b64_tr_b16 a[186:187], v15 offset:53248
    v_mfma_f32_16x16x32_bf16 v[196:199], a[164:167], a[12:15], 0
    ds_read_b64_tr_b16 a[188:189], v15 offset:57344
    v_mfma_f32_16x16x32_bf16 v[196:199], a[160:163], a[4:7], v[196:199]
    s_waitcnt lgkmcnt(9)
    ds_read_b64_tr_b16 a[190:191], v15 offset:61440
    v_mfma_f32_16x16x32_bf16 v[204:207], a[168:171], a[4:7], 0
    s_waitcnt lgkmcnt(8)
    ds_read_b64_tr_b16 a[160:161], v16 offset:49152
    v_mfma_f32_16x16x32_bf16 v[204:207], a[172:175], a[12:15], v[204:207]
    ds_read_b64_tr_b16 a[162:163], v16 offset:53248
    v_mfma_f32_16x16x32_bf16 v[200:203], a[172:175], a[8:11], 0
    ds_read_b64_tr_b16 a[164:165], v16 offset:57344
    v_mfma_f32_16x16x32_bf16 v[200:203], a[168:171], a[0:3], v[200:203]
    s_waitcnt lgkmcnt(9)
    ds_read_b64_tr_b16 a[166:167], v16 offset:61440
    v_mfma_f32_16x16x32_bf16 v[208:211], a[176:179], a[0:3], 0
    s_waitcnt lgkmcnt(8)
    ds_read_b64_tr_b16 a[168:169], v17 offset:49152
    v_mfma_f32_16x16x32_bf16 v[208:211], a[180:183], a[8:11], v[208:211]
    ds_read_b64_tr_b16 a[170:171], v17 offset:53248
    v_mfma_f32_16x16x32_bf16 v[212:215], a[180:183], a[12:15], 0
    ds_read_b64_tr_b16 a[172:173], v17 offset:57344
    v_mfma_f32_16x16x32_bf16 v[212:215], a[176:179], a[4:7], v[212:215]
    s_waitcnt lgkmcnt(9)
    ds_read_b64_tr_b16 a[174:175], v17 offset:61440
    v_mfma_f32_16x16x32_bf16 v[220:223], a[184:187], a[4:7], 0
    s_waitcnt lgkmcnt(8)
    ds_read_b64_tr_b16 a[176:177], v18 offset:49152
    v_mfma_f32_16x16x32_bf16 v[220:223], a[188:191], a[12:15], v[220:223]
    ds_read_b64_tr_b16 a[178:179], v18 offset:53248
    v_mfma_f32_16x16x32_bf16 v[216:219], a[188:191], a[8:11], 0
    ds_read_b64_tr_b16 a[180:181], v18 offset:57344
    v_mfma_f32_16x16x32_bf16 v[216:219], a[184:187], a[0:3], v[216:219]
    s_waitcnt lgkmcnt(9)
    ds_read_b64_tr_b16 a[182:183], v18 offset:61440
    v_mfma_f32_16x16x32_bf16 v[224:227], a[160:163], a[0:3], 0
    s_waitcnt lgkmcnt(8)
    ds_read_b64_tr_b16 a[184:185], v19 offset:49152
    v_mfma_f32_16x16x32_bf16 v[224:227], a[164:167], a[8:11], v[224:227]
Ltour0:
    s_cbranch_execz Ltour4
    ds_read_b64_tr_b16 a[186:187], v19 offset:53248
    v_mfma_f32_16x16x32_bf16 v[228:231], a[164:167], a[12:15], 0
    ds_read_b64_tr_b16 a[188:189], v19 offset:57344
    v_mfma_f32_16x16x32_bf16 v[228:231], a[160:163], a[4:7], v[228:231]
    s_waitcnt lgkmcnt(9)
    ds_read_b64_tr_b16 a[190:191], v19 offset:61440
    s_barrier
    v_mfma_f32_16x16x32_bf16 v[236:239], a[168:171], a[4:7], 0
    s_waitcnt lgkmcnt(8)
    ds_read_b64_tr_b16 a[160:161], v20 offset:0
    v_mfma_f32_16x16x32_bf16 v[236:239], a[172:175], a[12:15], v[236:239]
    s_add_u32 s49, s44, 1572864
    ds_read_b64_tr_b16 a[162:163], v20 offset:4096
    v_mfma_f32_16x16x32_bf16 v[232:235], a[172:175], a[8:11], 0
    s_add_u32 m0, s42, 131072
    ds_read_b64_tr_b16 a[164:165], v20 offset:8192
    v_mfma_f32_16x16x32_bf16 v[232:235], a[168:171], a[0:3], v[232:235]
    s_waitcnt lgkmcnt(9)
    buffer_load_dwordx4 v42, s[16:19], s49 offen lds
    v_mfma_f32_16x16x32_bf16 v[240:243], a[176:179], a[0:3], 0
    s_waitcnt lgkmcnt(7)
    ds_read_b64_tr_b16 a[166:167], v20 offset:12288
    ds_read_b64_tr_b16 a[168:169], v21 offset:0
    v_mfma_f32_16x16x32_bf16 v[240:243], a[180:183], a[8:11], v[240:243]
    ds_read_b64_tr_b16 a[170:171], v21 offset:4096
    v_mfma_f32_16x16x32_bf16 v[244:247], a[180:183], a[12:15], 0
    ds_read_b64_tr_b16 a[172:173], v21 offset:8192
    v_mfma_f32_16x16x32_bf16 v[244:247], a[176:179], a[4:7], v[244:247]
    s_waitcnt lgkmcnt(9)
    buffer_load_dwordx4 v43, s[16:19], s49 offen offset:1024 lds
    v_mfma_f32_16x16x32_bf16 v[252:255], a[184:187], a[4:7], 0
    s_waitcnt lgkmcnt(7)
    ds_read_b64_tr_b16 a[174:175], v21 offset:12288
    ds_read_b64_tr_b16 a[176:177], v22 offset:0
    v_mfma_f32_16x16x32_bf16 v[252:255], a[188:191], a[12:15], v[252:255]
    ds_read_b64_tr_b16 a[178:179], v22 offset:4096
    v_mfma_f32_16x16x32_bf16 v[248:251], a[188:191], a[8:11], 0
    ds_read_b64_tr_b16 a[180:181], v22 offset:8192
    v_mfma_f32_16x16x32_bf16 v[248:251], a[184:187], a[0:3], v[248:251]
    s_waitcnt vmcnt(10)
    s_waitcnt lgkmcnt(9)
    buffer_load_dwordx4 v44, s[16:19], s49 offen offset:2048 lds
    v_mfma_f32_16x16x32_bf16 v[128:131], a[160:163], a[16:19], v[128:131]
    s_waitcnt vmcnt(10)
    s_waitcnt lgkmcnt(7)
    ds_read_b64_tr_b16 a[182:183], v22 offset:12288
    ds_read_b64_tr_b16 a[184:185], v23 offset:0
    v_mfma_f32_16x16x32_bf16 v[128:131], a[164:167], a[24:27], v[128:131]
    s_waitcnt vmcnt(8)
    ds_read_b64_tr_b16 a[186:187], v23 offset:4096
    v_mfma_f32_16x16x32_bf16 v[132:135], a[164:167], a[28:31], v[132:135]
    ds_read_b64_tr_b16 a[188:189], v23 offset:8192
    v_mfma_f32_16x16x32_bf16 v[132:135], a[160:163], a[20:23], v[132:135]
    s_waitcnt lgkmcnt(9)
    buffer_load_dwordx4 v45, s[16:19], s49 offen offset:3072 lds
    v_mfma_f32_16x16x32_bf16 v[140:143], a[168:171], a[20:23], v[140:143]
    s_waitcnt lgkmcnt(7)
    ds_read_b64_tr_b16 a[190:191], v23 offset:12288
    ds_read_b64_tr_b16 a[160:161], v24 offset:0
    v_mfma_f32_16x16x32_bf16 v[140:143], a[172:175], a[28:31], v[140:143]
    s_add_u32 s49, s44, 1573120
    ds_read_b64_tr_b16 a[162:163], v24 offset:4096
    v_mfma_f32_16x16x32_bf16 v[136:139], a[172:175], a[24:27], v[136:139]
    s_add_u32 m0, s42, 147456
    ds_read_b64_tr_b16 a[164:165], v24 offset:8192
    v_mfma_f32_16x16x32_bf16 v[136:139], a[168:171], a[16:19], v[136:139]
    s_waitcnt lgkmcnt(9)
    buffer_load_dwordx4 v42, s[16:19], s49 offen lds
    v_mfma_f32_16x16x32_bf16 v[144:147], a[176:179], a[16:19], v[144:147]
    s_waitcnt lgkmcnt(7)
    ds_read_b64_tr_b16 a[166:167], v24 offset:12288
    ds_read_b64_tr_b16 a[168:169], v25 offset:0
    v_mfma_f32_16x16x32_bf16 v[144:147], a[180:183], a[24:27], v[144:147]
    ds_read_b64_tr_b16 a[170:171], v25 offset:4096
    v_mfma_f32_16x16x32_bf16 v[148:151], a[180:183], a[28:31], v[148:151]
    ds_read_b64_tr_b16 a[172:173], v25 offset:8192
    v_mfma_f32_16x16x32_bf16 v[148:151], a[176:179], a[20:23], v[148:151]
    s_waitcnt lgkmcnt(9)
    buffer_load_dwordx4 v43, s[16:19], s49 offen offset:1024 lds
    v_mfma_f32_16x16x32_bf16 v[156:159], a[184:187], a[20:23], v[156:159]
    s_waitcnt lgkmcnt(7)
    ds_read_b64_tr_b16 a[174:175], v25 offset:12288
    ds_read_b64_tr_b16 a[176:177], v26 offset:0
    v_mfma_f32_16x16x32_bf16 v[156:159], a[188:191], a[28:31], v[156:159]
    ds_read_b64_tr_b16 a[178:179], v26 offset:4096
    v_mfma_f32_16x16x32_bf16 v[152:155], a[188:191], a[24:27], v[152:155]
    ds_read_b64_tr_b16 a[180:181], v26 offset:8192
    v_mfma_f32_16x16x32_bf16 v[152:155], a[184:187], a[16:19], v[152:155]
    s_waitcnt lgkmcnt(9)
    buffer_load_dwordx4 v44, s[16:19], s49 offen offset:2048 lds
    v_mfma_f32_16x16x32_bf16 v[160:163], a[160:163], a[16:19], v[160:163]
    s_waitcnt lgkmcnt(7)
    ds_read_b64_tr_b16 a[182:183], v26 offset:12288
    ds_read_b64_tr_b16 a[184:185], v27 offset:0
    v_mfma_f32_16x16x32_bf16 v[160:163], a[164:167], a[24:27], v[160:163]
    ds_read_b64_tr_b16 a[186:187], v27 offset:4096
    v_mfma_f32_16x16x32_bf16 v[164:167], a[164:167], a[28:31], v[164:167]
    ds_read_b64_tr_b16 a[188:189], v27 offset:8192
    v_mfma_f32_16x16x32_bf16 v[164:167], a[160:163], a[20:23], v[164:167]
    s_waitcnt lgkmcnt(9)
    buffer_load_dwordx4 v45, s[16:19], s49 offen offset:3072 lds
    v_mfma_f32_16x16x32_bf16 v[172:175], a[168:171], a[20:23], v[172:175]
    s_waitcnt lgkmcnt(7)
    ds_read_b64_tr_b16 a[190:191], v27 offset:12288
    ds_read_b64_tr_b16 a[160:161], v20 offset:16384
    v_mfma_f32_16x16x32_bf16 v[172:175], a[172:175], a[28:31], v[172:175]
    ds_read_b64_tr_b16 a[162:163], v20 offset:20480
    v_mfma_f32_16x16x32_bf16 v[168:171], a[172:175], a[24:27], v[168:171]
    ds_read_b64_tr_b16 a[164:165], v20 offset:24576
    v_mfma_f32_16x16x32_bf16 v[168:171], a[168:171], a[16:19], v[168:171]
    s_waitcnt lgkmcnt(9)
    buffer_load_dwordx4 a[48:51], v51, s[24:27], s46 offen offset:768 sc1
    v_mfma_f32_16x16x32_bf16 v[176:179], a[176:179], a[16:19], v[176:179]
    s_waitcnt lgkmcnt(7)
    ds_read_b64_tr_b16 a[166:167], v20 offset:28672
    ds_read_b64_tr_b16 a[168:169], v21 offset:16384
    v_mfma_f32_16x16x32_bf16 v[176:179], a[180:183], a[24:27], v[176:179]
    ds_read_b64_tr_b16 a[170:171], v21 offset:20480
    v_mfma_f32_16x16x32_bf16 v[180:183], a[180:183], a[28:31], v[180:183]
    ds_read_b64_tr_b16 a[172:173], v21 offset:24576
    v_mfma_f32_16x16x32_bf16 v[180:183], a[176:179], a[20:23], v[180:183]
    s_waitcnt lgkmcnt(9)
    buffer_load_dwordx4 a[56:59], v51, s[24:27], s46 offen offset:896 sc1
    v_mfma_f32_16x16x32_bf16 v[188:191], a[184:187], a[20:23], v[188:191]
    s_waitcnt lgkmcnt(7)
    ds_read_b64_tr_b16 a[174:175], v21 offset:28672
    ds_read_b64_tr_b16 a[176:177], v22 offset:16384
    v_mfma_f32_16x16x32_bf16 v[188:191], a[188:191], a[28:31], v[188:191]
    ds_read_b64_tr_b16 a[178:179], v22 offset:20480
    v_mfma_f32_16x16x32_bf16 v[184:187], a[188:191], a[24:27], v[184:187]
    ds_read_b64_tr_b16 a[180:181], v22 offset:24576
    v_mfma_f32_16x16x32_bf16 v[184:187], a[184:187], a[16:19], v[184:187]
    s_waitcnt lgkmcnt(9)
    buffer_load_dwordx4 a[52:55], v51, s[24:27], s43 offen offset:768 sc1
    v_mfma_f32_16x16x32_bf16 v[192:195], a[160:163], a[16:19], v[192:195]
    s_waitcnt lgkmcnt(7)
    ds_read_b64_tr_b16 a[182:183], v22 offset:28672
    ds_read_b64_tr_b16 a[184:185], v23 offset:16384
    v_mfma_f32_16x16x32_bf16 v[192:195], a[164:167], a[24:27], v[192:195]
    ds_read_b64_tr_b16 a[186:187], v23 offset:20480
    v_mfma_f32_16x16x32_bf16 v[196:199], a[164:167], a[28:31], v[196:199]
    ds_read_b64_tr_b16 a[188:189], v23 offset:24576
    v_mfma_f32_16x16x32_bf16 v[196:199], a[160:163], a[20:23], v[196:199]
    s_waitcnt lgkmcnt(9)
    buffer_load_dwordx4 a[60:63], v51, s[24:27], s43 offen offset:896 sc1
    v_mfma_f32_16x16x32_bf16 v[204:207], a[168:171], a[20:23], v[204:207]
    s_waitcnt lgkmcnt(7)
    ds_read_b64_tr_b16 a[190:191], v23 offset:28672
    ds_read_b64_tr_b16 a[160:161], v24 offset:16384
    v_mfma_f32_16x16x32_bf16 v[204:207], a[172:175], a[28:31], v[204:207]
    ds_read_b64_tr_b16 a[162:163], v24 offset:20480
    v_mfma_f32_16x16x32_bf16 v[200:203], a[172:175], a[24:27], v[200:203]
    ds_read_b64_tr_b16 a[164:165], v24 offset:24576
    v_mfma_f32_16x16x32_bf16 v[200:203], a[168:171], a[16:19], v[200:203]
    s_waitcnt lgkmcnt(9)
    ds_read_b64_tr_b16 a[166:167], v24 offset:28672
    v_mfma_f32_16x16x32_bf16 v[208:211], a[176:179], a[16:19], v[208:211]
    s_waitcnt lgkmcnt(8)
    ds_read_b64_tr_b16 a[168:169], v25 offset:16384
    v_mfma_f32_16x16x32_bf16 v[208:211], a[180:183], a[24:27], v[208:211]
    ds_read_b64_tr_b16 a[170:171], v25 offset:20480
    v_mfma_f32_16x16x32_bf16 v[212:215], a[180:183], a[28:31], v[212:215]
    ds_read_b64_tr_b16 a[172:173], v25 offset:24576
    v_mfma_f32_16x16x32_bf16 v[212:215], a[176:179], a[20:23], v[212:215]
    s_waitcnt lgkmcnt(9)
    ds_read_b64_tr_b16 a[174:175], v25 offset:28672
    v_mfma_f32_16x16x32_bf16 v[220:223], a[184:187], a[20:23], v[220:223]
    s_waitcnt lgkmcnt(8)
    ds_read_b64_tr_b16 a[176:177], v26 offset:16384
    v_mfma_f32_16x16x32_bf16 v[220:223], a[188:191], a[28:31], v[220:223]
    ds_read_b64_tr_b16 a[178:179], v26 offset:20480
    v_mfma_f32_16x16x32_bf16 v[216:219], a[188:191], a[24:27], v[216:219]
    ds_read_b64_tr_b16 a[180:181], v26 offset:24576
    v_mfma_f32_16x16x32_bf16 v[216:219], a[184:187], a[16:19], v[216:219]
    s_waitcnt lgkmcnt(9)
    ds_read_b64_tr_b16 a[182:183], v26 offset:28672
    v_mfma_f32_16x16x32_bf16 v[224:227], a[160:163], a[16:19], v[224:227]
    s_waitcnt lgkmcnt(8)
    ds_read_b64_tr_b16 a[184:185], v27 offset:16384
    v_mfma_f32_16x16x32_bf16 v[224:227], a[164:167], a[24:27], v[224:227]
    ds_read_b64_tr_b16 a[186:187], v27 offset:20480
    v_mfma_f32_16x16x32_bf16 v[228:231], a[164:167], a[28:31], v[228:231]
    ds_read_b64_tr_b16 a[188:189], v27 offset:24576
    v_mfma_f32_16x16x32_bf16 v[228:231], a[160:163], a[20:23], v[228:231]
    s_waitcnt lgkmcnt(9)
    ds_read_b64_tr_b16 a[190:191], v27 offset:28672
    s_barrier
    v_mfma_f32_16x16x32_bf16 v[236:239], a[168:171], a[20:23], v[236:239]
    s_waitcnt lgkmcnt(8)
    ds_read_b64_tr_b16 a[160:161], v20 offset:32768
    v_mfma_f32_16x16x32_bf16 v[236:239], a[172:175], a[28:31], v[236:239]
    s_add_u32 s49, s44, 2097152
    ds_read_b64_tr_b16 a[162:163], v20 offset:36864
    v_mfma_f32_16x16x32_bf16 v[232:235], a[172:175], a[24:27], v[232:235]
    s_add_u32 m0, s42, 0
    ds_read_b64_tr_b16 a[164:165], v20 offset:40960
    v_mfma_f32_16x16x32_bf16 v[232:235], a[168:171], a[16:19], v[232:235]
    s_waitcnt lgkmcnt(9)
    buffer_load_dwordx4 v42, s[16:19], s49 offen lds
    v_mfma_f32_16x16x32_bf16 v[240:243], a[176:179], a[16:19], v[240:243]
    s_waitcnt lgkmcnt(7)
    ds_read_b64_tr_b16 a[166:167], v20 offset:45056
    ds_read_b64_tr_b16 a[168:169], v21 offset:32768
    v_mfma_f32_16x16x32_bf16 v[240:243], a[180:183], a[24:27], v[240:243]
    ds_read_b64_tr_b16 a[170:171], v21 offset:36864
    v_mfma_f32_16x16x32_bf16 v[244:247], a[180:183], a[28:31], v[244:247]
    ds_read_b64_tr_b16 a[172:173], v21 offset:40960
    v_mfma_f32_16x16x32_bf16 v[244:247], a[176:179], a[20:23], v[244:247]
    s_waitcnt lgkmcnt(9)
    buffer_load_dwordx4 v43, s[16:19], s49 offen offset:1024 lds
    v_mfma_f32_16x16x32_bf16 v[252:255], a[184:187], a[20:23], v[252:255]
    s_waitcnt lgkmcnt(7)
    ds_read_b64_tr_b16 a[174:175], v21 offset:45056
    ds_read_b64_tr_b16 a[176:177], v22 offset:32768
    v_mfma_f32_16x16x32_bf16 v[252:255], a[188:191], a[28:31], v[252:255]
    ds_read_b64_tr_b16 a[178:179], v22 offset:36864
    v_mfma_f32_16x16x32_bf16 v[248:251], a[188:191], a[24:27], v[248:251]
    ds_read_b64_tr_b16 a[180:181], v22 offset:40960
    v_mfma_f32_16x16x32_bf16 v[248:251], a[184:187], a[16:19], v[248:251]
    s_waitcnt vmcnt(18)
    s_waitcnt lgkmcnt(9)
    buffer_load_dwordx4 v44, s[16:19], s49 offen offset:2048 lds
    v_mfma_f32_16x16x32_bf16 v[128:131], a[160:163], a[32:35], v[128:131]
    s_waitcnt vmcnt(18)
    s_waitcnt lgkmcnt(7)
    ds_read_b64_tr_b16 a[182:183], v22 offset:45056
    ds_read_b64_tr_b16 a[184:185], v23 offset:32768
    v_mfma_f32_16x16x32_bf16 v[128:131], a[164:167], a[40:43], v[128:131]
    s_waitcnt vmcnt(16)
    ds_read_b64_tr_b16 a[186:187], v23 offset:36864
    v_mfma_f32_16x16x32_bf16 v[132:135], a[164:167], a[44:47], v[132:135]
    ds_read_b64_tr_b16 a[188:189], v23 offset:40960
    v_mfma_f32_16x16x32_bf16 v[132:135], a[160:163], a[36:39], v[132:135]
    s_waitcnt lgkmcnt(9)
    buffer_load_dwordx4 v45, s[16:19], s49 offen offset:3072 lds
    v_mfma_f32_16x16x32_bf16 v[140:143], a[168:171], a[36:39], v[140:143]
    s_waitcnt lgkmcnt(7)
    ds_read_b64_tr_b16 a[190:191], v23 offset:45056
    ds_read_b64_tr_b16 a[160:161], v24 offset:32768
    v_mfma_f32_16x16x32_bf16 v[140:143], a[172:175], a[44:47], v[140:143]
    s_add_u32 s49, s44, 2097408
    ds_read_b64_tr_b16 a[162:163], v24 offset:36864
    v_mfma_f32_16x16x32_bf16 v[136:139], a[172:175], a[40:43], v[136:139]
    s_add_u32 m0, s42, 16384
    ds_read_b64_tr_b16 a[164:165], v24 offset:40960
    v_mfma_f32_16x16x32_bf16 v[136:139], a[168:171], a[32:35], v[136:139]
    s_waitcnt lgkmcnt(9)
    buffer_load_dwordx4 v42, s[16:19], s49 offen lds
    v_mfma_f32_16x16x32_bf16 v[144:147], a[176:179], a[32:35], v[144:147]
    s_waitcnt lgkmcnt(7)
    ds_read_b64_tr_b16 a[166:167], v24 offset:45056
    ds_read_b64_tr_b16 a[168:169], v25 offset:32768
    v_mfma_f32_16x16x32_bf16 v[144:147], a[180:183], a[40:43], v[144:147]
    ds_read_b64_tr_b16 a[170:171], v25 offset:36864
    v_mfma_f32_16x16x32_bf16 v[148:151], a[180:183], a[44:47], v[148:151]
    ds_read_b64_tr_b16 a[172:173], v25 offset:40960
    v_mfma_f32_16x16x32_bf16 v[148:151], a[176:179], a[36:39], v[148:151]
    s_waitcnt lgkmcnt(9)
    buffer_load_dwordx4 v43, s[16:19], s49 offen offset:1024 lds
    v_mfma_f32_16x16x32_bf16 v[156:159], a[184:187], a[36:39], v[156:159]
    s_waitcnt lgkmcnt(7)
    ds_read_b64_tr_b16 a[174:175], v25 offset:45056
    ds_read_b64_tr_b16 a[176:177], v26 offset:32768
    v_mfma_f32_16x16x32_bf16 v[156:159], a[188:191], a[44:47], v[156:159]
    ds_read_b64_tr_b16 a[178:179], v26 offset:36864
    v_mfma_f32_16x16x32_bf16 v[152:155], a[188:191], a[40:43], v[152:155]
    ds_read_b64_tr_b16 a[180:181], v26 offset:40960
    v_mfma_f32_16x16x32_bf16 v[152:155], a[184:187], a[32:35], v[152:155]
    s_waitcnt lgkmcnt(9)
    buffer_load_dwordx4 v44, s[16:19], s49 offen offset:2048 lds
    v_mfma_f32_16x16x32_bf16 v[160:163], a[160:163], a[32:35], v[160:163]
    s_waitcnt lgkmcnt(7)
    ds_read_b64_tr_b16 a[182:183], v26 offset:45056
    ds_read_b64_tr_b16 a[184:185], v27 offset:32768
    v_mfma_f32_16x16x32_bf16 v[160:163], a[164:167], a[40:43], v[160:163]
    ds_read_b64_tr_b16 a[186:187], v27 offset:36864
    v_mfma_f32_16x16x32_bf16 v[164:167], a[164:167], a[44:47], v[164:167]
    ds_read_b64_tr_b16 a[188:189], v27 offset:40960
    v_mfma_f32_16x16x32_bf16 v[164:167], a[160:163], a[36:39], v[164:167]
    s_waitcnt lgkmcnt(9)
    buffer_load_dwordx4 v45, s[16:19], s49 offen offset:3072 lds
    v_mfma_f32_16x16x32_bf16 v[172:175], a[168:171], a[36:39], v[172:175]
    s_waitcnt lgkmcnt(7)
    ds_read_b64_tr_b16 a[190:191], v27 offset:45056
    ds_read_b64_tr_b16 a[160:161], v20 offset:49152
    v_mfma_f32_16x16x32_bf16 v[172:175], a[172:175], a[44:47], v[172:175]
    ds_read_b64_tr_b16 a[162:163], v20 offset:53248
    v_mfma_f32_16x16x32_bf16 v[168:171], a[172:175], a[40:43], v[168:171]
    ds_read_b64_tr_b16 a[164:165], v20 offset:57344
    v_mfma_f32_16x16x32_bf16 v[168:171], a[168:171], a[32:35], v[168:171]
    s_waitcnt lgkmcnt(9)
    buffer_load_dwordx4 a[64:67], v51, s[24:27], s46 offen offset:1024 sc1
    v_mfma_f32_16x16x32_bf16 v[176:179], a[176:179], a[32:35], v[176:179]
    s_waitcnt lgkmcnt(7)
    ds_read_b64_tr_b16 a[166:167], v20 offset:61440
    ds_read_b64_tr_b16 a[168:169], v21 offset:49152
    v_mfma_f32_16x16x32_bf16 v[176:179], a[180:183], a[40:43], v[176:179]
    ds_read_b64_tr_b16 a[170:171], v21 offset:53248
    v_mfma_f32_16x16x32_bf16 v[180:183], a[180:183], a[44:47], v[180:183]
    ds_read_b64_tr_b16 a[172:173], v21 offset:57344
    v_mfma_f32_16x16x32_bf16 v[180:183], a[176:179], a[36:39], v[180:183]
    s_waitcnt lgkmcnt(9)
    buffer_load_dwordx4 a[72:75], v51, s[24:27], s46 offen offset:1152 sc1
    v_mfma_f32_16x16x32_bf16 v[188:191], a[184:187], a[36:39], v[188:191]
    s_waitcnt lgkmcnt(7)
    ds_read_b64_tr_b16 a[174:175], v21 offset:61440
    ds_read_b64_tr_b16 a[176:177], v22 offset:49152
    v_mfma_f32_16x16x32_bf16 v[188:191], a[188:191], a[44:47], v[188:191]
    ds_read_b64_tr_b16 a[178:179], v22 offset:53248
    v_mfma_f32_16x16x32_bf16 v[184:187], a[188:191], a[40:43], v[184:187]
    ds_read_b64_tr_b16 a[180:181], v22 offset:57344
    v_mfma_f32_16x16x32_bf16 v[184:187], a[184:187], a[32:35], v[184:187]
    s_waitcnt lgkmcnt(9)
    buffer_load_dwordx4 a[68:71], v51, s[24:27], s43 offen offset:1024 sc1
    v_mfma_f32_16x16x32_bf16 v[192:195], a[160:163], a[32:35], v[192:195]
    s_waitcnt lgkmcnt(7)
    ds_read_b64_tr_b16 a[182:183], v22 offset:61440
    ds_read_b64_tr_b16 a[184:185], v23 offset:49152
    v_mfma_f32_16x16x32_bf16 v[192:195], a[164:167], a[40:43], v[192:195]
    ds_read_b64_tr_b16 a[186:187], v23 offset:53248
    v_mfma_f32_16x16x32_bf16 v[196:199], a[164:167], a[44:47], v[196:199]
    ds_read_b64_tr_b16 a[188:189], v23 offset:57344
    v_mfma_f32_16x16x32_bf16 v[196:199], a[160:163], a[36:39], v[196:199]
    s_waitcnt lgkmcnt(9)
    buffer_load_dwordx4 a[76:79], v51, s[24:27], s43 offen offset:1152 sc1
    v_mfma_f32_16x16x32_bf16 v[204:207], a[168:171], a[36:39], v[204:207]
    s_waitcnt lgkmcnt(7)
    ds_read_b64_tr_b16 a[190:191], v23 offset:61440
    ds_read_b64_tr_b16 a[160:161], v24 offset:49152
    v_mfma_f32_16x16x32_bf16 v[204:207], a[172:175], a[44:47], v[204:207]
    ds_read_b64_tr_b16 a[162:163], v24 offset:53248
    v_mfma_f32_16x16x32_bf16 v[200:203], a[172:175], a[40:43], v[200:203]
    ds_read_b64_tr_b16 a[164:165], v24 offset:57344
    v_mfma_f32_16x16x32_bf16 v[200:203], a[168:171], a[32:35], v[200:203]
    s_waitcnt lgkmcnt(9)
    buffer_load_dwordx4 a[80:83], v51, s[24:27], s46 offen offset:1280 sc1
    v_mfma_f32_16x16x32_bf16 v[208:211], a[176:179], a[32:35], v[208:211]
    s_waitcnt lgkmcnt(7)
    ds_read_b64_tr_b16 a[166:167], v24 offset:61440
    ds_read_b64_tr_b16 a[168:169], v25 offset:49152
    v_mfma_f32_16x16x32_bf16 v[208:211], a[180:183], a[40:43], v[208:211]
    ds_read_b64_tr_b16 a[170:171], v25 offset:53248
    v_mfma_f32_16x16x32_bf16 v[212:215], a[180:183], a[44:47], v[212:215]
    ds_read_b64_tr_b16 a[172:173], v25 offset:57344
    v_mfma_f32_16x16x32_bf16 v[212:215], a[176:179], a[36:39], v[212:215]
    s_waitcnt lgkmcnt(9)
    buffer_load_dwordx4 a[88:91], v51, s[24:27], s46 offen offset:1408 sc1
    v_mfma_f32_16x16x32_bf16 v[220:223], a[184:187], a[36:39], v[220:223]
    s_waitcnt lgkmcnt(7)
    ds_read_b64_tr_b16 a[174:175], v25 offset:61440
    ds_read_b64_tr_b16 a[176:177], v26 offset:49152
    v_mfma_f32_16x16x32_bf16 v[220:223], a[188:191], a[44:47], v[220:223]
    ds_read_b64_tr_b16 a[178:179], v26 offset:53248
    v_mfma_f32_16x16x32_bf16 v[216:219], a[188:191], a[40:43], v[216:219]
    ds_read_b64_tr_b16 a[180:181], v26 offset:57344
    v_mfma_f32_16x16x32_bf16 v[216:219], a[184:187], a[32:35], v[216:219]
    s_waitcnt lgkmcnt(9)
    ds_read_b64_tr_b16 a[182:183], v26 offset:61440
    v_mfma_f32_16x16x32_bf16 v[224:227], a[160:163], a[32:35], v[224:227]
    s_waitcnt lgkmcnt(8)
    ds_read_b64_tr_b16 a[184:185], v27 offset:49152
    v_mfma_f32_16x16x32_bf16 v[224:227], a[164:167], a[40:43], v[224:227]
    ds_read_b64_tr_b16 a[186:187], v27 offset:53248
    v_mfma_f32_16x16x32_bf16 v[228:231], a[164:167], a[44:47], v[228:231]
    ds_read_b64_tr_b16 a[188:189], v27 offset:57344
    v_mfma_f32_16x16x32_bf16 v[228:231], a[160:163], a[36:39], v[228:231]
    s_waitcnt lgkmcnt(9)
    ds_read_b64_tr_b16 a[190:191], v27 offset:61440
    s_waitcnt vmcnt(18)
    s_barrier
    v_mfma_f32_16x16x32_bf16 v[236:239], a[168:171], a[36:39], v[236:239]
    s_waitcnt lgkmcnt(8)
    ds_read_b64_tr_b16 a[160:161], v28 offset:0
    v_mfma_f32_16x16x32_bf16 v[236:239], a[172:175], a[44:47], v[236:239]
    s_add_u32 s49, s44, 2621440
    ds_read_b64_tr_b16 a[162:163], v28 offset:4096
    v_mfma_f32_16x16x32_bf16 v[232:235], a[172:175], a[40:43], v[232:235]
    s_add_u32 m0, s42, 32768
    ds_read_b64_tr_b16 a[164:165], v28 offset:8192
    v_mfma_f32_16x16x32_bf16 v[232:235], a[168:171], a[32:35], v[232:235]
    s_waitcnt lgkmcnt(9)
    buffer_load_dwordx4 v42, s[16:19], s49 offen lds
    v_mfma_f32_16x16x32_bf16 v[240:243], a[176:179], a[32:35], v[240:243]
    s_waitcnt lgkmcnt(7)
    ds_read_b64_tr_b16 a[166:167], v28 offset:12288
    ds_read_b64_tr_b16 a[168:169], v29 offset:0
    v_mfma_f32_16x16x32_bf16 v[240:243], a[180:183], a[40:43], v[240:243]
    ds_read_b64_tr_b16 a[170:171], v29 offset:4096
    v_mfma_f32_16x16x32_bf16 v[244:247], a[180:183], a[44:47], v[244:247]
    ds_read_b64_tr_b16 a[172:173], v29 offset:8192
    v_mfma_f32_16x16x32_bf16 v[244:247], a[176:179], a[36:39], v[244:247]
    s_waitcnt lgkmcnt(9)
    buffer_load_dwordx4 v43, s[16:19], s49 offen offset:1024 lds
    v_mfma_f32_16x16x32_bf16 v[252:255], a[184:187], a[36:39], v[252:255]
    s_waitcnt lgkmcnt(7)
    ds_read_b64_tr_b16 a[174:175], v29 offset:12288
    ds_read_b64_tr_b16 a[176:177], v30 offset:0
    v_mfma_f32_16x16x32_bf16 v[252:255], a[188:191], a[44:47], v[252:255]
    ds_read_b64_tr_b16 a[178:179], v30 offset:4096
    v_mfma_f32_16x16x32_bf16 v[248:251], a[188:191], a[40:43], v[248:251]
    ds_read_b64_tr_b16 a[180:181], v30 offset:8192
    v_mfma_f32_16x16x32_bf16 v[248:251], a[184:187], a[32:35], v[248:251]
    s_waitcnt vmcnt(19)
    s_waitcnt lgkmcnt(9)
    buffer_load_dwordx4 v44, s[16:19], s49 offen offset:2048 lds
    v_mfma_f32_16x16x32_bf16 v[128:131], a[160:163], a[48:51], v[128:131]
    s_waitcnt vmcnt(19)
    s_waitcnt lgkmcnt(7)
    ds_read_b64_tr_b16 a[182:183], v30 offset:12288
    ds_read_b64_tr_b16 a[184:185], v31 offset:0
    v_mfma_f32_16x16x32_bf16 v[128:131], a[164:167], a[56:59], v[128:131]
    s_waitcnt vmcnt(17)
    ds_read_b64_tr_b16 a[186:187], v31 offset:4096
    v_mfma_f32_16x16x32_bf16 v[132:135], a[164:167], a[60:63], v[132:135]
    ds_read_b64_tr_b16 a[188:189], v31 offset:8192
    v_mfma_f32_16x16x32_bf16 v[132:135], a[160:163], a[52:55], v[132:135]
    s_waitcnt lgkmcnt(9)
    buffer_load_dwordx4 v45, s[16:19], s49 offen offset:3072 lds
    v_mfma_f32_16x16x32_bf16 v[140:143], a[168:171], a[52:55], v[140:143]
    s_waitcnt lgkmcnt(7)
    ds_read_b64_tr_b16 a[190:191], v31 offset:12288
    ds_read_b64_tr_b16 a[160:161], v32 offset:0
    v_mfma_f32_16x16x32_bf16 v[140:143], a[172:175], a[60:63], v[140:143]
    s_add_u32 s49, s44, 3145728
    ds_read_b64_tr_b16 a[162:163], v32 offset:4096
    v_mfma_f32_16x16x32_bf16 v[136:139], a[172:175], a[56:59], v[136:139]
    s_add_u32 m0, s42, 49152
    ds_read_b64_tr_b16 a[164:165], v32 offset:8192
    v_mfma_f32_16x16x32_bf16 v[136:139], a[168:171], a[48:51], v[136:139]
    s_waitcnt lgkmcnt(9)
    buffer_load_dwordx4 v42, s[16:19], s49 offen lds
    v_mfma_f32_16x16x32_bf16 v[144:147], a[176:179], a[48:51], v[144:147]
    s_waitcnt lgkmcnt(7)
    ds_read_b64_tr_b16 a[166:167], v32 offset:12288
    ds_read_b64_tr_b16 a[168:169], v33 offset:0
    v_mfma_f32_16x16x32_bf16 v[144:147], a[180:183], a[56:59], v[144:147]
    ds_read_b64_tr_b16 a[170:171], v33 offset:4096
    v_mfma_f32_16x16x32_bf16 v[148:151], a[180:183], a[60:63], v[148:151]
    ds_read_b64_tr_b16 a[172:173], v33 offset:8192
    v_mfma_f32_16x16x32_bf16 v[148:151], a[176:179], a[52:55], v[148:151]
    s_waitcnt lgkmcnt(9)
    buffer_load_dwordx4 v43, s[16:19], s49 offen offset:1024 lds
    v_mfma_f32_16x16x32_bf16 v[156:159], a[184:187], a[52:55], v[156:159]
    s_waitcnt lgkmcnt(7)
    ds_read_b64_tr_b16 a[174:175], v33 offset:12288
    ds_read_b64_tr_b16 a[176:177], v34 offset:0
    v_mfma_f32_16x16x32_bf16 v[156:159], a[188:191], a[60:63], v[156:159]
    ds_read_b64_tr_b16 a[178:179], v34 offset:4096
    v_mfma_f32_16x16x32_bf16 v[152:155], a[188:191], a[56:59], v[152:155]
    ds_read_b64_tr_b16 a[180:181], v34 offset:8192
    v_mfma_f32_16x16x32_bf16 v[152:155], a[184:187], a[48:51], v[152:155]
    s_waitcnt lgkmcnt(9)
    buffer_load_dwordx4 v44, s[16:19], s49 offen offset:2048 lds
    v_mfma_f32_16x16x32_bf16 v[160:163], a[160:163], a[48:51], v[160:163]
    s_waitcnt lgkmcnt(7)
    ds_read_b64_tr_b16 a[182:183], v34 offset:12288
    ds_read_b64_tr_b16 a[184:185], v35 offset:0
    v_mfma_f32_16x16x32_bf16 v[160:163], a[164:167], a[56:59], v[160:163]
    ds_read_b64_tr_b16 a[186:187], v35 offset:4096
    v_mfma_f32_16x16x32_bf16 v[164:167], a[164:167], a[60:63], v[164:167]
    ds_read_b64_tr_b16 a[188:189], v35 offset:8192
    v_mfma_f32_16x16x32_bf16 v[164:167], a[160:163], a[52:55], v[164:167]
    s_waitcnt lgkmcnt(9)
    buffer_load_dwordx4 v45, s[16:19], s49 offen offset:3072 lds
    v_mfma_f32_16x16x32_bf16 v[172:175], a[168:171], a[52:55], v[172:175]
    s_waitcnt lgkmcnt(7)
    ds_read_b64_tr_b16 a[190:191], v35 offset:12288
    ds_read_b64_tr_b16 a[160:161], v28 offset:16384
    v_mfma_f32_16x16x32_bf16 v[172:175], a[172:175], a[60:63], v[172:175]
    ds_read_b64_tr_b16 a[162:163], v28 offset:20480
    v_mfma_f32_16x16x32_bf16 v[168:171], a[172:175], a[56:59], v[168:171]
    ds_read_b64_tr_b16 a[164:165], v28 offset:24576
    v_mfma_f32_16x16x32_bf16 v[168:171], a[168:171], a[48:51], v[168:171]
    s_waitcnt lgkmcnt(9)
    buffer_load_dwordx4 a[84:87], v51, s[24:27], s43 offen offset:1280 sc1
    v_mfma_f32_16x16x32_bf16 v[176:179], a[176:179], a[48:51], v[176:179]
    s_waitcnt lgkmcnt(7)
    ds_read_b64_tr_b16 a[166:167], v28 offset:28672
    ds_read_b64_tr_b16 a[168:169], v29 offset:16384
    v_mfma_f32_16x16x32_bf16 v[176:179], a[180:183], a[56:59], v[176:179]
    ds_read_b64_tr_b16 a[170:171], v29 offset:20480
    v_mfma_f32_16x16x32_bf16 v[180:183], a[180:183], a[60:63], v[180:183]
    ds_read_b64_tr_b16 a[172:173], v29 offset:24576
    v_mfma_f32_16x16x32_bf16 v[180:183], a[176:179], a[52:55], v[180:183]
    s_waitcnt lgkmcnt(9)
    buffer_load_dwordx4 a[92:95], v51, s[24:27], s43 offen offset:1408 sc1
    v_mfma_f32_16x16x32_bf16 v[188:191], a[184:187], a[52:55], v[188:191]
    s_waitcnt lgkmcnt(7)
    ds_read_b64_tr_b16 a[174:175], v29 offset:28672
    ds_read_b64_tr_b16 a[176:177], v30 offset:16384
    v_mfma_f32_16x16x32_bf16 v[188:191], a[188:191], a[60:63], v[188:191]
    ds_read_b64_tr_b16 a[178:179], v30 offset:20480
    v_mfma_f32_16x16x32_bf16 v[184:187], a[188:191], a[56:59], v[184:187]
    ds_read_b64_tr_b16 a[180:181], v30 offset:24576
    v_mfma_f32_16x16x32_bf16 v[184:187], a[184:187], a[48:51], v[184:187]
    s_waitcnt lgkmcnt(9)
    buffer_load_dwordx4 a[96:99], v51, s[24:27], s46 offen offset:1536 sc1
    v_mfma_f32_16x16x32_bf16 v[192:195], a[160:163], a[48:51], v[192:195]
    s_waitcnt lgkmcnt(7)
    ds_read_b64_tr_b16 a[182:183], v30 offset:28672
    ds_read_b64_tr_b16 a[184:185], v31 offset:16384
    v_mfma_f32_16x16x32_bf16 v[192:195], a[164:167], a[56:59], v[192:195]
    ds_read_b64_tr_b16 a[186:187], v31 offset:20480
    v_mfma_f32_16x16x32_bf16 v[196:199], a[164:167], a[60:63], v[196:199]
    ds_read_b64_tr_b16 a[188:189], v31 offset:24576
    v_mfma_f32_16x16x32_bf16 v[196:199], a[160:163], a[52:55], v[196:199]
    s_waitcnt lgkmcnt(9)
    buffer_load_dwordx4 a[104:107], v51, s[24:27], s46 offen offset:1664 sc1
    v_mfma_f32_16x16x32_bf16 v[204:207], a[168:171], a[52:55], v[204:207]
    s_waitcnt lgkmcnt(7)
    ds_read_b64_tr_b16 a[190:191], v31 offset:28672
    ds_read_b64_tr_b16 a[160:161], v32 offset:16384
    v_mfma_f32_16x16x32_bf16 v[204:207], a[172:175], a[60:63], v[204:207]
    ds_read_b64_tr_b16 a[162:163], v32 offset:20480
    v_mfma_f32_16x16x32_bf16 v[200:203], a[172:175], a[56:59], v[200:203]
    ds_read_b64_tr_b16 a[164:165], v32 offset:24576
    v_mfma_f32_16x16x32_bf16 v[200:203], a[168:171], a[48:51], v[200:203]
    s_waitcnt lgkmcnt(9)
    buffer_load_dwordx4 a[100:103], v51, s[24:27], s43 offen offset:1536 sc1
    v_mfma_f32_16x16x32_bf16 v[208:211], a[176:179], a[48:51], v[208:211]
    s_waitcnt lgkmcnt(7)
    ds_read_b64_tr_b16 a[166:167], v32 offset:28672
    ds_read_b64_tr_b16 a[168:169], v33 offset:16384
    v_mfma_f32_16x16x32_bf16 v[208:211], a[180:183], a[56:59], v[208:211]
    ds_read_b64_tr_b16 a[170:171], v33 offset:20480
    v_mfma_f32_16x16x32_bf16 v[212:215], a[180:183], a[60:63], v[212:215]
    ds_read_b64_tr_b16 a[172:173], v33 offset:24576
    v_mfma_f32_16x16x32_bf16 v[212:215], a[176:179], a[52:55], v[212:215]
    s_waitcnt lgkmcnt(9)
    buffer_load_dwordx4 a[108:111], v51, s[24:27], s43 offen offset:1664 sc1
    v_mfma_f32_16x16x32_bf16 v[220:223], a[184:187], a[52:55], v[220:223]
    s_waitcnt lgkmcnt(7)
    ds_read_b64_tr_b16 a[174:175], v33 offset:28672
    ds_read_b64_tr_b16 a[176:177], v34 offset:16384
    v_mfma_f32_16x16x32_bf16 v[220:223], a[188:191], a[60:63], v[220:223]
    ds_read_b64_tr_b16 a[178:179], v34 offset:20480
    v_mfma_f32_16x16x32_bf16 v[216:219], a[188:191], a[56:59], v[216:219]
    ds_read_b64_tr_b16 a[180:181], v34 offset:24576
    v_mfma_f32_16x16x32_bf16 v[216:219], a[184:187], a[48:51], v[216:219]
    s_waitcnt lgkmcnt(9)
    ds_read_b64_tr_b16 a[182:183], v34 offset:28672
    v_mfma_f32_16x16x32_bf16 v[224:227], a[160:163], a[48:51], v[224:227]
    s_waitcnt lgkmcnt(8)
    ds_read_b64_tr_b16 a[184:185], v35 offset:16384
    v_mfma_f32_16x16x32_bf16 v[224:227], a[164:167], a[56:59], v[224:227]
    ds_read_b64_tr_b16 a[186:187], v35 offset:20480
    v_mfma_f32_16x16x32_bf16 v[228:231], a[164:167], a[60:63], v[228:231]
    ds_read_b64_tr_b16 a[188:189], v35 offset:24576
    v_mfma_f32_16x16x32_bf16 v[228:231], a[160:163], a[52:55], v[228:231]
    s_waitcnt lgkmcnt(9)
    ds_read_b64_tr_b16 a[190:191], v35 offset:28672
    s_waitcnt vmcnt(20)
    s_barrier
    v_mfma_f32_16x16x32_bf16 v[236:239], a[168:171], a[52:55], v[236:239]
    s_waitcnt lgkmcnt(8)
    ds_read_b64_tr_b16 a[160:161], v12 offset:0
    v_mfma_f32_16x16x32_bf16 v[236:239], a[172:175], a[60:63], v[236:239]
    s_add_u32 s49, s44, 3670016
    ds_read_b64_tr_b16 a[162:163], v12 offset:4096
    v_mfma_f32_16x16x32_bf16 v[232:235], a[172:175], a[56:59], v[232:235]
    s_add_u32 m0, s42, 65536
    ds_read_b64_tr_b16 a[164:165], v12 offset:8192
    v_mfma_f32_16x16x32_bf16 v[232:235], a[168:171], a[48:51], v[232:235]
    s_waitcnt lgkmcnt(9)
    buffer_load_dwordx4 v42, s[16:19], s49 offen lds
    v_mfma_f32_16x16x32_bf16 v[240:243], a[176:179], a[48:51], v[240:243]
    s_waitcnt lgkmcnt(7)
    ds_read_b64_tr_b16 a[166:167], v12 offset:12288
    ds_read_b64_tr_b16 a[168:169], v13 offset:0
    v_mfma_f32_16x16x32_bf16 v[240:243], a[180:183], a[56:59], v[240:243]
Ltour1:
    s_cbranch_execz Ltour5
    ds_read_b64_tr_b16 a[170:171], v13 offset:4096
    v_mfma_f32_16x16x32_bf16 v[244:247], a[180:183], a[60:63], v[244:247]
    ds_read_b64_tr_b16 a[172:173], v13 offset:8192
    v_mfma_f32_16x16x32_bf16 v[244:247], a[176:179], a[52:55], v[244:247]
    s_waitcnt lgkmcnt(9)
    buffer_load_dwordx4 v43, s[16:19], s49 offen offset:1024 lds
    v_mfma_f32_16x16x32_bf16 v[252:255], a[184:187], a[52:55], v[252:255]
    s_waitcnt lgkmcnt(7)
    ds_read_b64_tr_b16 a[174:175], v13 offset:12288
    ds_read_b64_tr_b16 a[176:177], v14 offset:0
    v_mfma_f32_16x16x32_bf16 v[252:255], a[188:191], a[60:63], v[252:255]
    ds_read_b64_tr_b16 a[178:179], v14 offset:4096
    v_mfma_f32_16x16x32_bf16 v[248:251], a[188:191], a[56:59], v[248:251]
    ds_read_b64_tr_b16 a[180:181], v14 offset:8192
    v_mfma_f32_16x16x32_bf16 v[248:251], a[184:187], a[48:51], v[248:251]
    s_waitcnt vmcnt(21)
    s_waitcnt lgkmcnt(9)
    buffer_load_dwordx4 v44, s[16:19], s49 offen offset:2048 lds
    v_mfma_f32_16x16x32_bf16 v[128:131], a[160:163], a[64:67], v[128:131]
    s_waitcnt vmcnt(21)
    s_waitcnt lgkmcnt(7)
    ds_read_b64_tr_b16 a[182:183], v14 offset:12288
    ds_read_b64_tr_b16 a[184:185], v15 offset:0
    v_mfma_f32_16x16x32_bf16 v[128:131], a[164:167], a[72:75], v[128:131]
    s_waitcnt vmcnt(19)
    ds_read_b64_tr_b16 a[186:187], v15 offset:4096
    v_mfma_f32_16x16x32_bf16 v[132:135], a[164:167], a[76:79], v[132:135]
    ds_read_b64_tr_b16 a[188:189], v15 offset:8192
    v_mfma_f32_16x16x32_bf16 v[132:135], a[160:163], a[68:71], v[132:135]
    s_waitcnt lgkmcnt(9)
    buffer_load_dwordx4 v45, s[16:19], s49 offen offset:3072 lds
    v_mfma_f32_16x16x32_bf16 v[140:143], a[168:171], a[68:71], v[140:143]
    s_waitcnt lgkmcnt(7)
    ds_read_b64_tr_b16 a[190:191], v15 offset:12288
    ds_read_b64_tr_b16 a[160:161], v16 offset:0
    v_mfma_f32_16x16x32_bf16 v[140:143], a[172:175], a[76:79], v[140:143]
    s_add_u32 s49, s44, 4194304
    ds_read_b64_tr_b16 a[162:163], v16 offset:4096
    v_mfma_f32_16x16x32_bf16 v[136:139], a[172:175], a[72:75], v[136:139]
    s_add_u32 m0, s42, 81920
    ds_read_b64_tr_b16 a[164:165], v16 offset:8192
    v_mfma_f32_16x16x32_bf16 v[136:139], a[168:171], a[64:67], v[136:139]
    s_waitcnt lgkmcnt(9)
    buffer_load_dwordx4 v42, s[16:19], s49 offen lds
    v_mfma_f32_16x16x32_bf16 v[144:147], a[176:179], a[64:67], v[144:147]
    s_waitcnt lgkmcnt(7)
    ds_read_b64_tr_b16 a[166:167], v16 offset:12288
    ds_read_b64_tr_b16 a[168:169], v17 offset:0
    v_mfma_f32_16x16x32_bf16 v[144:147], a[180:183], a[72:75], v[144:147]
    ds_read_b64_tr_b16 a[170:171], v17 offset:4096
    v_mfma_f32_16x16x32_bf16 v[148:151], a[180:183], a[76:79], v[148:151]
    ds_read_b64_tr_b16 a[172:173], v17 offset:8192
    v_mfma_f32_16x16x32_bf16 v[148:151], a[176:179], a[68:71], v[148:151]
    s_waitcnt lgkmcnt(9)
    buffer_load_dwordx4 v43, s[16:19], s49 offen offset:1024 lds
    v_mfma_f32_16x16x32_bf16 v[156:159], a[184:187], a[68:71], v[156:159]
    s_waitcnt lgkmcnt(7)
    ds_read_b64_tr_b16 a[174:175], v17 offset:12288
    ds_read_b64_tr_b16 a[176:177], v18 offset:0
    v_mfma_f32_16x16x32_bf16 v[156:159], a[188:191], a[76:79], v[156:159]
    ds_read_b64_tr_b16 a[178:179], v18 offset:4096
    v_mfma_f32_16x16x32_bf16 v[152:155], a[188:191], a[72:75], v[152:155]
    ds_read_b64_tr_b16 a[180:181], v18 offset:8192
    v_mfma_f32_16x16x32_bf16 v[152:155], a[184:187], a[64:67], v[152:155]
    s_waitcnt lgkmcnt(9)
    buffer_load_dwordx4 v44, s[16:19], s49 offen offset:2048 lds
    v_mfma_f32_16x16x32_bf16 v[160:163], a[160:163], a[64:67], v[160:163]
    s_waitcnt lgkmcnt(7)
    ds_read_b64_tr_b16 a[182:183], v18 offset:12288
    ds_read_b64_tr_b16 a[184:185], v19 offset:0
    v_mfma_f32_16x16x32_bf16 v[160:163], a[164:167], a[72:75], v[160:163]
    ds_read_b64_tr_b16 a[186:187], v19 offset:4096
    v_mfma_f32_16x16x32_bf16 v[164:167], a[164:167], a[76:79], v[164:167]
    ds_read_b64_tr_b16 a[188:189], v19 offset:8192
    v_mfma_f32_16x16x32_bf16 v[164:167], a[160:163], a[68:71], v[164:167]
    s_waitcnt lgkmcnt(9)
    buffer_load_dwordx4 v45, s[16:19], s49 offen offset:3072 lds
    v_mfma_f32_16x16x32_bf16 v[172:175], a[168:171], a[68:71], v[172:175]
    s_waitcnt lgkmcnt(7)
    ds_read_b64_tr_b16 a[190:191], v19 offset:12288
    ds_read_b64_tr_b16 a[160:161], v12 offset:16384
    v_mfma_f32_16x16x32_bf16 v[172:175], a[172:175], a[76:79], v[172:175]
    ds_read_b64_tr_b16 a[162:163], v12 offset:20480
    v_mfma_f32_16x16x32_bf16 v[168:171], a[172:175], a[72:75], v[168:171]
    ds_read_b64_tr_b16 a[164:165], v12 offset:24576
    v_mfma_f32_16x16x32_bf16 v[168:171], a[168:171], a[64:67], v[168:171]
    s_waitcnt lgkmcnt(9)
    buffer_load_dwordx4 a[112:115], v51, s[24:27], s46 offen offset:1792 sc1
    v_mfma_f32_16x16x32_bf16 v[176:179], a[176:179], a[64:67], v[176:179]
    s_waitcnt lgkmcnt(7)
    ds_read_b64_tr_b16 a[166:167], v12 offset:28672
    ds_read_b64_tr_b16 a[168:169], v13 offset:16384
    v_mfma_f32_16x16x32_bf16 v[176:179], a[180:183], a[72:75], v[176:179]
    ds_read_b64_tr_b16 a[170:171], v13 offset:20480
    v_mfma_f32_16x16x32_bf16 v[180:183], a[180:183], a[76:79], v[180:183]
    ds_read_b64_tr_b16 a[172:173], v13 offset:24576
    v_mfma_f32_16x16x32_bf16 v[180:183], a[176:179], a[68:71], v[180:183]
    s_waitcnt lgkmcnt(9)
    buffer_load_dwordx4 a[120:123], v51, s[24:27], s46 offen offset:1920 sc1
    v_mfma_f32_16x16x32_bf16 v[188:191], a[184:187], a[68:71], v[188:191]
    s_waitcnt lgkmcnt(7)
    ds_read_b64_tr_b16 a[174:175], v13 offset:28672
    ds_read_b64_tr_b16 a[176:177], v14 offset:16384
    v_mfma_f32_16x16x32_bf16 v[188:191], a[188:191], a[76:79], v[188:191]
    ds_read_b64_tr_b16 a[178:179], v14 offset:20480
    v_mfma_f32_16x16x32_bf16 v[184:187], a[188:191], a[72:75], v[184:187]
    ds_read_b64_tr_b16 a[180:181], v14 offset:24576
    v_mfma_f32_16x16x32_bf16 v[184:187], a[184:187], a[64:67], v[184:187]
    s_waitcnt lgkmcnt(9)
    buffer_load_dwordx4 a[116:119], v51, s[24:27], s43 offen offset:1792 sc1
    v_mfma_f32_16x16x32_bf16 v[192:195], a[160:163], a[64:67], v[192:195]
    s_waitcnt lgkmcnt(7)
    ds_read_b64_tr_b16 a[182:183], v14 offset:28672
    ds_read_b64_tr_b16 a[184:185], v15 offset:16384
    v_mfma_f32_16x16x32_bf16 v[192:195], a[164:167], a[72:75], v[192:195]
    ds_read_b64_tr_b16 a[186:187], v15 offset:20480
    v_mfma_f32_16x16x32_bf16 v[196:199], a[164:167], a[76:79], v[196:199]
    ds_read_b64_tr_b16 a[188:189], v15 offset:24576
    v_mfma_f32_16x16x32_bf16 v[196:199], a[160:163], a[68:71], v[196:199]
    s_waitcnt lgkmcnt(9)
    buffer_load_dwordx4 a[124:127], v51, s[24:27], s43 offen offset:1920 sc1
    v_mfma_f32_16x16x32_bf16 v[204:207], a[168:171], a[68:71], v[204:207]
    s_waitcnt lgkmcnt(7)
    ds_read_b64_tr_b16 a[190:191], v15 offset:28672
    ds_read_b64_tr_b16 a[160:161], v16 offset:16384
    v_mfma_f32_16x16x32_bf16 v[204:207], a[172:175], a[76:79], v[204:207]
    ds_read_b64_tr_b16 a[162:163], v16 offset:20480
    v_mfma_f32_16x16x32_bf16 v[200:203], a[172:175], a[72:75], v[200:203]
    ds_read_b64_tr_b16 a[164:165], v16 offset:24576
    v_mfma_f32_16x16x32_bf16 v[200:203], a[168:171], a[64:67], v[200:203]
    s_waitcnt lgkmcnt(9)
    buffer_load_dwordx4 a[128:131], v51, s[24:27], s46 offen offset:2048 sc1
    v_mfma_f32_16x16x32_bf16 v[208:211], a[176:179], a[64:67], v[208:211]
    s_waitcnt lgkmcnt(7)
    ds_read_b64_tr_b16 a[166:167], v16 offset:28672
    ds_read_b64_tr_b16 a[168:169], v17 offset:16384
    v_mfma_f32_16x16x32_bf16 v[208:211], a[180:183], a[72:75], v[208:211]
    ds_read_b64_tr_b16 a[170:171], v17 offset:20480
    v_mfma_f32_16x16x32_bf16 v[212:215], a[180:183], a[76:79], v[212:215]
    ds_read_b64_tr_b16 a[172:173], v17 offset:24576
    v_mfma_f32_16x16x32_bf16 v[212:215], a[176:179], a[68:71], v[212:215]
    s_waitcnt lgkmcnt(9)
    buffer_load_dwordx4 a[136:139], v51, s[24:27], s46 offen offset:2176 sc1
    v_mfma_f32_16x16x32_bf16 v[220:223], a[184:187], a[68:71], v[220:223]
    s_waitcnt lgkmcnt(7)
    ds_read_b64_tr_b16 a[174:175], v17 offset:28672
    ds_read_b64_tr_b16 a[176:177], v18 offset:16384
    v_mfma_f32_16x16x32_bf16 v[220:223], a[188:191], a[76:79], v[220:223]
    ds_read_b64_tr_b16 a[178:179], v18 offset:20480
    v_mfma_f32_16x16x32_bf16 v[216:219], a[188:191], a[72:75], v[216:219]
    ds_read_b64_tr_b16 a[180:181], v18 offset:24576
    v_mfma_f32_16x16x32_bf16 v[216:219], a[184:187], a[64:67], v[216:219]
    s_waitcnt lgkmcnt(9)
    ds_read_b64_tr_b16 a[182:183], v18 offset:28672
    v_mfma_f32_16x16x32_bf16 v[224:227], a[160:163], a[64:67], v[224:227]
    s_waitcnt lgkmcnt(8)
    ds_read_b64_tr_b16 a[184:185], v19 offset:16384
    v_mfma_f32_16x16x32_bf16 v[224:227], a[164:167], a[72:75], v[224:227]
    ds_read_b64_tr_b16 a[186:187], v19 offset:20480
    v_mfma_f32_16x16x32_bf16 v[228:231], a[164:167], a[76:79], v[228:231]
    ds_read_b64_tr_b16 a[188:189], v19 offset:24576
    v_mfma_f32_16x16x32_bf16 v[228:231], a[160:163], a[68:71], v[228:231]
    s_waitcnt lgkmcnt(9)
    ds_read_b64_tr_b16 a[190:191], v19 offset:28672
    s_waitcnt vmcnt(20)
    s_barrier
    v_mfma_f32_16x16x32_bf16 v[236:239], a[168:171], a[68:71], v[236:239]
    s_waitcnt lgkmcnt(8)
    ds_read_b64_tr_b16 a[160:161], v12 offset:32768
    v_mfma_f32_16x16x32_bf16 v[236:239], a[172:175], a[76:79], v[236:239]
    s_add_u32 s49, s44, 2621696
    ds_read_b64_tr_b16 a[162:163], v12 offset:36864
    v_mfma_f32_16x16x32_bf16 v[232:235], a[172:175], a[72:75], v[232:235]
    s_add_u32 m0, s42, 98304
    ds_read_b64_tr_b16 a[164:165], v12 offset:40960
    v_mfma_f32_16x16x32_bf16 v[232:235], a[168:171], a[64:67], v[232:235]
    s_waitcnt lgkmcnt(9)
    buffer_load_dwordx4 v42, s[16:19], s49 offen lds
    v_mfma_f32_16x16x32_bf16 v[240:243], a[176:179], a[64:67], v[240:243]
    s_waitcnt lgkmcnt(7)
    ds_read_b64_tr_b16 a[166:167], v12 offset:45056
    ds_read_b64_tr_b16 a[168:169], v13 offset:32768
    v_mfma_f32_16x16x32_bf16 v[240:243], a[180:183], a[72:75], v[240:243]
    ds_read_b64_tr_b16 a[170:171], v13 offset:36864
    v_mfma_f32_16x16x32_bf16 v[244:247], a[180:183], a[76:79], v[244:247]
    ds_read_b64_tr_b16 a[172:173], v13 offset:40960
    v_mfma_f32_16x16x32_bf16 v[244:247], a[176:179], a[68:71], v[244:247]
    s_waitcnt lgkmcnt(9)
    buffer_load_dwordx4 v43, s[16:19], s49 offen offset:1024 lds
    v_mfma_f32_16x16x32_bf16 v[252:255], a[184:187], a[68:71], v[252:255]
    s_waitcnt lgkmcnt(7)
    ds_read_b64_tr_b16 a[174:175], v13 offset:45056
    ds_read_b64_tr_b16 a[176:177], v14 offset:32768
    v_mfma_f32_16x16x32_bf16 v[252:255], a[188:191], a[76:79], v[252:255]
    ds_read_b64_tr_b16 a[178:179], v14 offset:36864
    v_mfma_f32_16x16x32_bf16 v[248:251], a[188:191], a[72:75], v[248:251]
    ds_read_b64_tr_b16 a[180:181], v14 offset:40960
    v_mfma_f32_16x16x32_bf16 v[248:251], a[184:187], a[64:67], v[248:251]
    s_waitcnt lgkmcnt(9)
    buffer_load_dwordx4 v44, s[16:19], s49 offen offset:2048 lds
    v_mfma_f32_16x16x32_bf16 v[128:131], a[160:163], a[80:83], v[128:131]
    s_waitcnt lgkmcnt(7)
    ds_read_b64_tr_b16 a[182:183], v14 offset:45056
    ds_read_b64_tr_b16 a[184:185], v15 offset:32768
    v_mfma_f32_16x16x32_bf16 v[128:131], a[164:167], a[88:91], v[128:131]
    s_waitcnt vmcnt(21)
    ds_read_b64_tr_b16 a[186:187], v15 offset:36864
    v_mfma_f32_16x16x32_bf16 v[132:135], a[164:167], a[92:95], v[132:135]
    ds_read_b64_tr_b16 a[188:189], v15 offset:40960
    v_mfma_f32_16x16x32_bf16 v[132:135], a[160:163], a[84:87], v[132:135]
    s_waitcnt lgkmcnt(9)
    buffer_load_dwordx4 v45, s[16:19], s49 offen offset:3072 lds
    v_mfma_f32_16x16x32_bf16 v[140:143], a[168:171], a[84:87], v[140:143]
    s_waitcnt lgkmcnt(7)
    ds_read_b64_tr_b16 a[190:191], v15 offset:45056
    ds_read_b64_tr_b16 a[160:161], v16 offset:32768
    v_mfma_f32_16x16x32_bf16 v[140:143], a[172:175], a[92:95], v[140:143]
    s_add_u32 s49, s44, 3145984
    ds_read_b64_tr_b16 a[162:163], v16 offset:36864
    v_mfma_f32_16x16x32_bf16 v[136:139], a[172:175], a[88:91], v[136:139]
    s_add_u32 m0, s42, 114688
    ds_read_b64_tr_b16 a[164:165], v16 offset:40960
    v_mfma_f32_16x16x32_bf16 v[136:139], a[168:171], a[80:83], v[136:139]
    s_waitcnt lgkmcnt(9)
    buffer_load_dwordx4 v42, s[16:19], s49 offen lds
    v_mfma_f32_16x16x32_bf16 v[144:147], a[176:179], a[80:83], v[144:147]
    s_waitcnt lgkmcnt(7)
    ds_read_b64_tr_b16 a[166:167], v16 offset:45056
    ds_read_b64_tr_b16 a[168:169], v17 offset:32768
    v_mfma_f32_16x16x32_bf16 v[144:147], a[180:183], a[88:91], v[144:147]
    ds_read_b64_tr_b16 a[170:171], v17 offset:36864
    v_mfma_f32_16x16x32_bf16 v[148:151], a[180:183], a[92:95], v[148:151]
    ds_read_b64_tr_b16 a[172:173], v17 offset:40960
    v_mfma_f32_16x16x32_bf16 v[148:151], a[176:179], a[84:87], v[148:151]
    s_waitcnt lgkmcnt(9)
    buffer_load_dwordx4 v43, s[16:19], s49 offen offset:1024 lds
    v_mfma_f32_16x16x32_bf16 v[156:159], a[184:187], a[84:87], v[156:159]
    s_waitcnt lgkmcnt(7)
    ds_read_b64_tr_b16 a[174:175], v17 offset:45056
    ds_read_b64_tr_b16 a[176:177], v18 offset:32768
    v_mfma_f32_16x16x32_bf16 v[156:159], a[188:191], a[92:95], v[156:159]
    ds_read_b64_tr_b16 a[178:179], v18 offset:36864
    v_mfma_f32_16x16x32_bf16 v[152:155], a[188:191], a[88:91], v[152:155]
    ds_read_b64_tr_b16 a[180:181], v18 offset:40960
    v_mfma_f32_16x16x32_bf16 v[152:155], a[184:187], a[80:83], v[152:155]
    s_waitcnt lgkmcnt(9)
    buffer_load_dwordx4 v44, s[16:19], s49 offen offset:2048 lds
    v_mfma_f32_16x16x32_bf16 v[160:163], a[160:163], a[80:83], v[160:163]
    s_waitcnt lgkmcnt(7)
    ds_read_b64_tr_b16 a[182:183], v18 offset:45056
    ds_read_b64_tr_b16 a[184:185], v19 offset:32768
    v_mfma_f32_16x16x32_bf16 v[160:163], a[164:167], a[88:91], v[160:163]
    ds_read_b64_tr_b16 a[186:187], v19 offset:36864
    v_mfma_f32_16x16x32_bf16 v[164:167], a[164:167], a[92:95], v[164:167]
    ds_read_b64_tr_b16 a[188:189], v19 offset:40960
    v_mfma_f32_16x16x32_bf16 v[164:167], a[160:163], a[84:87], v[164:167]
    s_waitcnt lgkmcnt(9)
    buffer_load_dwordx4 v45, s[16:19], s49 offen offset:3072 lds
    v_mfma_f32_16x16x32_bf16 v[172:175], a[168:171], a[84:87], v[172:175]
    s_waitcnt lgkmcnt(7)
    ds_read_b64_tr_b16 a[190:191], v19 offset:45056
    ds_read_b64_tr_b16 a[160:161], v12 offset:49152
    v_mfma_f32_16x16x32_bf16 v[172:175], a[172:175], a[92:95], v[172:175]
    ds_read_b64_tr_b16 a[162:163], v12 offset:53248
    v_mfma_f32_16x16x32_bf16 v[168:171], a[172:175], a[88:91], v[168:171]
    ds_read_b64_tr_b16 a[164:165], v12 offset:57344
    v_mfma_f32_16x16x32_bf16 v[168:171], a[168:171], a[80:83], v[168:171]
    s_waitcnt lgkmcnt(9)
    buffer_load_dwordx4 a[132:135], v51, s[24:27], s43 offen offset:2048 sc1
    v_mfma_f32_16x16x32_bf16 v[176:179], a[176:179], a[80:83], v[176:179]
    s_waitcnt lgkmcnt(7)
    ds_read_b64_tr_b16 a[166:167], v12 offset:61440
    ds_read_b64_tr_b16 a[168:169], v13 offset:49152
    v_mfma_f32_16x16x32_bf16 v[176:179], a[180:183], a[88:91], v[176:179]
    ds_read_b64_tr_b16 a[170:171], v13 offset:53248
    v_mfma_f32_16x16x32_bf16 v[180:183], a[180:183], a[92:95], v[180:183]
    ds_read_b64_tr_b16 a[172:173], v13 offset:57344
    v_mfma_f32_16x16x32_bf16 v[180:183], a[176:179], a[84:87], v[180:183]
    s_waitcnt lgkmcnt(9)
    buffer_load_dwordx4 a[140:143], v51, s[24:27], s43 offen offset:2176 sc1
    v_mfma_f32_16x16x32_bf16 v[188:191], a[184:187], a[84:87], v[188:191]
    s_waitcnt lgkmcnt(7)
    ds_read_b64_tr_b16 a[174:175], v13 offset:61440
    ds_read_b64_tr_b16 a[176:177], v14 offset:49152
    v_mfma_f32_16x16x32_bf16 v[188:191], a[188:191], a[92:95], v[188:191]
    ds_read_b64_tr_b16 a[178:179], v14 offset:53248
    v_mfma_f32_16x16x32_bf16 v[184:187], a[188:191], a[88:91], v[184:187]
    ds_read_b64_tr_b16 a[180:181], v14 offset:57344
    v_mfma_f32_16x16x32_bf16 v[184:187], a[184:187], a[80:83], v[184:187]
    s_waitcnt vmcnt(27)
    s_waitcnt lgkmcnt(9)
    ds_read_b64_tr_b16 a[182:183], v14 offset:61440
    v_mfma_f32_16x16x32_bf16 v[128:131], a[160:163], a[96:99], v[128:131]
    s_waitcnt vmcnt(26)
    s_waitcnt lgkmcnt(8)
    ds_read_b64_tr_b16 a[184:185], v15 offset:49152
    v_mfma_f32_16x16x32_bf16 v[128:131], a[164:167], a[104:107], v[128:131]
    s_waitcnt vmcnt(24)
    ds_read_b64_tr_b16 a[186:187], v15 offset:53248
    v_mfma_f32_16x16x32_bf16 v[132:135], a[164:167], a[108:111], v[132:135]
    ds_read_b64_tr_b16 a[188:189], v15 offset:57344
    v_mfma_f32_16x16x32_bf16 v[132:135], a[160:163], a[100:103], v[132:135]
    s_waitcnt lgkmcnt(9)
    ds_read_b64_tr_b16 a[190:191], v15 offset:61440
    v_mfma_f32_16x16x32_bf16 v[140:143], a[168:171], a[100:103], v[140:143]
    s_waitcnt lgkmcnt(8)
    ds_read_b64_tr_b16 a[160:161], v16 offset:49152
    v_mfma_f32_16x16x32_bf16 v[140:143], a[172:175], a[108:111], v[140:143]
    ds_read_b64_tr_b16 a[162:163], v16 offset:53248
    v_mfma_f32_16x16x32_bf16 v[136:139], a[172:175], a[104:107], v[136:139]
    ds_read_b64_tr_b16 a[164:165], v16 offset:57344
    v_mfma_f32_16x16x32_bf16 v[136:139], a[168:171], a[96:99], v[136:139]
    s_waitcnt lgkmcnt(9)
    ds_read_b64_tr_b16 a[166:167], v16 offset:61440
    v_mfma_f32_16x16x32_bf16 v[144:147], a[176:179], a[96:99], v[144:147]
    s_waitcnt lgkmcnt(8)
    ds_read_b64_tr_b16 a[168:169], v17 offset:49152
    v_mfma_f32_16x16x32_bf16 v[144:147], a[180:183], a[104:107], v[144:147]
    ds_read_b64_tr_b16 a[170:171], v17 offset:53248
    v_mfma_f32_16x16x32_bf16 v[148:151], a[180:183], a[108:111], v[148:151]
    ds_read_b64_tr_b16 a[172:173], v17 offset:57344
    v_mfma_f32_16x16x32_bf16 v[148:151], a[176:179], a[100:103], v[148:151]
    s_waitcnt lgkmcnt(9)
    ds_read_b64_tr_b16 a[174:175], v17 offset:61440
    v_mfma_f32_16x16x32_bf16 v[156:159], a[184:187], a[100:103], v[156:159]
    s_waitcnt lgkmcnt(8)
    ds_read_b64_tr_b16 a[176:177], v18 offset:49152
    v_mfma_f32_16x16x32_bf16 v[156:159], a[188:191], a[108:111], v[156:159]
    ds_read_b64_tr_b16 a[178:179], v18 offset:53248
    v_mfma_f32_16x16x32_bf16 v[152:155], a[188:191], a[104:107], v[152:155]
    ds_read_b64_tr_b16 a[180:181], v18 offset:57344
    v_mfma_f32_16x16x32_bf16 v[152:155], a[184:187], a[96:99], v[152:155]
    s_waitcnt lgkmcnt(9)
    ds_read_b64_tr_b16 a[182:183], v18 offset:61440
    v_mfma_f32_16x16x32_bf16 v[160:163], a[160:163], a[96:99], v[160:163]
    s_waitcnt lgkmcnt(8)
    ds_read_b64_tr_b16 a[184:185], v19 offset:49152
    v_mfma_f32_16x16x32_bf16 v[160:163], a[164:167], a[104:107], v[160:163]
    ds_read_b64_tr_b16 a[186:187], v19 offset:53248
    v_mfma_f32_16x16x32_bf16 v[164:167], a[164:167], a[108:111], v[164:167]
    ds_read_b64_tr_b16 a[188:189], v19 offset:57344
    v_mfma_f32_16x16x32_bf16 v[164:167], a[160:163], a[100:103], v[164:167]
    s_waitcnt lgkmcnt(9)
    ds_read_b64_tr_b16 a[190:191], v19 offset:61440
    s_waitcnt vmcnt(16)
    s_barrier
    v_mfma_f32_16x16x32_bf16 v[172:175], a[168:171], a[100:103], v[172:175]
    s_waitcnt lgkmcnt(8)
    ds_read_b64_tr_b16 a[160:161], v20 offset:0
    v_mfma_f32_16x16x32_bf16 v[172:175], a[172:175], a[108:111], v[172:175]
    s_add_u32 s49, s44, 3670272
    ds_read_b64_tr_b16 a[162:163], v20 offset:4096
    v_mfma_f32_16x16x32_bf16 v[168:171], a[172:175], a[104:107], v[168:171]
    s_add_u32 m0, s42, 131072
    ds_read_b64_tr_b16 a[164:165], v20 offset:8192
    v_mfma_f32_16x16x32_bf16 v[168:171], a[168:171], a[96:99], v[168:171]
    s_waitcnt lgkmcnt(9)
    buffer_load_dwordx4 v42, s[16:19], s49 offen lds
    v_mfma_f32_16x16x32_bf16 v[176:179], a[176:179], a[96:99], v[176:179]
    s_waitcnt lgkmcnt(7)
    ds_read_b64_tr_b16 a[166:167], v20 offset:12288
    ds_read_b64_tr_b16 a[168:169], v21 offset:0
    v_mfma_f32_16x16x32_bf16 v[176:179], a[180:183], a[104:107], v[176:179]
    ds_read_b64_tr_b16 a[170:171], v21 offset:4096
    v_mfma_f32_16x16x32_bf16 v[180:183], a[180:183], a[108:111], v[180:183]
    ds_read_b64_tr_b16 a[172:173], v21 offset:8192
    v_mfma_f32_16x16x32_bf16 v[180:183], a[176:179], a[100:103], v[180:183]
    s_waitcnt lgkmcnt(9)
    buffer_load_dwordx4 v43, s[16:19], s49 offen offset:1024 lds
    v_mfma_f32_16x16x32_bf16 v[188:191], a[184:187], a[100:103], v[188:191]
    s_waitcnt lgkmcnt(7)
    ds_read_b64_tr_b16 a[174:175], v21 offset:12288
    ds_read_b64_tr_b16 a[176:177], v22 offset:0
    v_mfma_f32_16x16x32_bf16 v[188:191], a[188:191], a[108:111], v[188:191]
    ds_read_b64_tr_b16 a[178:179], v22 offset:4096
    v_mfma_f32_16x16x32_bf16 v[184:187], a[188:191], a[104:107], v[184:187]
    ds_read_b64_tr_b16 a[180:181], v22 offset:8192
    v_mfma_f32_16x16x32_bf16 v[184:187], a[184:187], a[96:99], v[184:187]
    s_waitcnt vmcnt(17)
    s_waitcnt lgkmcnt(9)
    buffer_load_dwordx4 v44, s[16:19], s49 offen offset:2048 lds
    v_mfma_f32_16x16x32_bf16 v[128:131], a[160:163], a[112:115], v[128:131]
    s_waitcnt vmcnt(17)
    s_waitcnt lgkmcnt(7)
    ds_read_b64_tr_b16 a[182:183], v22 offset:12288
    ds_read_b64_tr_b16 a[184:185], v23 offset:0
    v_mfma_f32_16x16x32_bf16 v[128:131], a[164:167], a[120:123], v[128:131]
    s_waitcnt vmcnt(15)
    ds_read_b64_tr_b16 a[186:187], v23 offset:4096
    v_mfma_f32_16x16x32_bf16 v[132:135], a[164:167], a[124:127], v[132:135]
    ds_read_b64_tr_b16 a[188:189], v23 offset:8192
    v_mfma_f32_16x16x32_bf16 v[132:135], a[160:163], a[116:119], v[132:135]
    s_waitcnt lgkmcnt(9)
    buffer_load_dwordx4 v45, s[16:19], s49 offen offset:3072 lds
    v_mfma_f32_16x16x32_bf16 v[140:143], a[168:171], a[116:119], v[140:143]
    s_waitcnt lgkmcnt(7)
    ds_read_b64_tr_b16 a[190:191], v23 offset:12288
    ds_read_b64_tr_b16 a[160:161], v24 offset:0
    v_mfma_f32_16x16x32_bf16 v[140:143], a[172:175], a[124:127], v[140:143]
    s_add_u32 s49, s44, 4194560
    ds_read_b64_tr_b16 a[162:163], v24 offset:4096
    v_mfma_f32_16x16x32_bf16 v[136:139], a[172:175], a[120:123], v[136:139]
    s_add_u32 m0, s42, 147456
    ds_read_b64_tr_b16 a[164:165], v24 offset:8192
    v_mfma_f32_16x16x32_bf16 v[136:139], a[168:171], a[112:115], v[136:139]
    s_waitcnt lgkmcnt(9)
    buffer_load_dwordx4 v42, s[16:19], s49 offen lds
    v_mfma_f32_16x16x32_bf16 v[144:147], a[176:179], a[112:115], v[144:147]
    s_waitcnt lgkmcnt(7)
    ds_read_b64_tr_b16 a[166:167], v24 offset:12288
    ds_read_b64_tr_b16 a[168:169], v25 offset:0
    v_mfma_f32_16x16x32_bf16 v[144:147], a[180:183], a[120:123], v[144:147]
    ds_read_b64_tr_b16 a[170:171], v25 offset:4096
    v_mfma_f32_16x16x32_bf16 v[148:151], a[180:183], a[124:127], v[148:151]
    ds_read_b64_tr_b16 a[172:173], v25 offset:8192
    v_mfma_f32_16x16x32_bf16 v[148:151], a[176:179], a[116:119], v[148:151]
    s_waitcnt lgkmcnt(9)
    buffer_load_dwordx4 v43, s[16:19], s49 offen offset:1024 lds
    v_mfma_f32_16x16x32_bf16 v[156:159], a[184:187], a[116:119], v[156:159]
    s_waitcnt lgkmcnt(7)
    ds_read_b64_tr_b16 a[174:175], v25 offset:12288
    ds_read_b64_tr_b16 a[176:177], v26 offset:0
    v_mfma_f32_16x16x32_bf16 v[156:159], a[188:191], a[124:127], v[156:159]
    ds_read_b64_tr_b16 a[178:179], v26 offset:4096
    v_mfma_f32_16x16x32_bf16 v[152:155], a[188:191], a[120:123], v[152:155]
    ds_read_b64_tr_b16 a[180:181], v26 offset:8192
    v_mfma_f32_16x16x32_bf16 v[152:155], a[184:187], a[112:115], v[152:155]
    s_waitcnt lgkmcnt(9)
    buffer_load_dwordx4 v44, s[16:19], s49 offen offset:2048 lds
    v_mfma_f32_16x16x32_bf16 v[160:163], a[160:163], a[112:115], v[160:163]
    s_waitcnt lgkmcnt(7)
    ds_read_b64_tr_b16 a[182:183], v26 offset:12288
    ds_read_b64_tr_b16 a[184:185], v27 offset:0
    v_mfma_f32_16x16x32_bf16 v[160:163], a[164:167], a[120:123], v[160:163]
    ds_read_b64_tr_b16 a[186:187], v27 offset:4096
    v_mfma_f32_16x16x32_bf16 v[164:167], a[164:167], a[124:127], v[164:167]
    ds_read_b64_tr_b16 a[188:189], v27 offset:8192
    v_mfma_f32_16x16x32_bf16 v[164:167], a[160:163], a[116:119], v[164:167]
    s_waitcnt lgkmcnt(9)
    buffer_load_dwordx4 v45, s[16:19], s49 offen offset:3072 lds
    v_mfma_f32_16x16x32_bf16 v[172:175], a[168:171], a[116:119], v[172:175]
    s_waitcnt lgkmcnt(7)
    ds_read_b64_tr_b16 a[190:191], v27 offset:12288
    ds_read_b64_tr_b16 a[160:161], v20 offset:16384
    v_mfma_f32_16x16x32_bf16 v[172:175], a[172:175], a[124:127], v[172:175]
    ds_read_b64_tr_b16 a[162:163], v20 offset:20480
    v_mfma_f32_16x16x32_bf16 v[168:171], a[172:175], a[120:123], v[168:171]
    ds_read_b64_tr_b16 a[164:165], v20 offset:24576
    v_mfma_f32_16x16x32_bf16 v[168:171], a[168:171], a[112:115], v[168:171]
    s_waitcnt lgkmcnt(9)
    buffer_load_dword v78, v120, s[8:11], 0 offen
    v_mfma_f32_16x16x32_bf16 v[176:179], a[176:179], a[112:115], v[176:179]
    s_waitcnt lgkmcnt(7)
    ds_read_b64_tr_b16 a[166:167], v20 offset:28672
    ds_read_b64_tr_b16 a[168:169], v21 offset:16384
    v_mfma_f32_16x16x32_bf16 v[176:179], a[180:183], a[120:123], v[176:179]
    ds_read_b64_tr_b16 a[170:171], v21 offset:20480
    v_mfma_f32_16x16x32_bf16 v[180:183], a[180:183], a[124:127], v[180:183]
    ds_read_b64_tr_b16 a[172:173], v21 offset:24576
    v_mfma_f32_16x16x32_bf16 v[180:183], a[176:179], a[116:119], v[180:183]
    s_waitcnt lgkmcnt(9)
    buffer_load_dword v79, v121, s[12:15], 0 offen
    v_mfma_f32_16x16x32_bf16 v[188:191], a[184:187], a[116:119], v[188:191]
    s_waitcnt lgkmcnt(7)
    ds_read_b64_tr_b16 a[174:175], v21 offset:28672
    ds_read_b64_tr_b16 a[176:177], v22 offset:16384
    v_mfma_f32_16x16x32_bf16 v[188:191], a[188:191], a[124:127], v[188:191]
    ds_read_b64_tr_b16 a[178:179], v22 offset:20480
    v_mfma_f32_16x16x32_bf16 v[184:187], a[188:191], a[120:123], v[184:187]
    s_mov_b32 s36, 1040356334
    ds_read_b64_tr_b16 a[180:181], v22 offset:24576
    v_mfma_f32_16x16x32_bf16 v[184:187], a[184:187], a[112:115], v[184:187]
    s_waitcnt vmcnt(21)
    s_waitcnt lgkmcnt(9)
    buffer_store_dword v76, v72, s[24:27], s92 offen offset:12 sc1
    v_mfma_f32_16x16x32_bf16 v[128:131], a[160:163], a[128:131], v[128:131]
    s_waitcnt vmcnt(21)
    s_waitcnt lgkmcnt(7)
    ds_read_b64_tr_b16 a[182:183], v22 offset:28672
    ds_read_b64_tr_b16 a[184:185], v23 offset:16384
    v_mfma_f32_16x16x32_bf16 v[128:131], a[164:167], a[136:139], v[128:131]
    s_waitcnt vmcnt(11)
    ds_read_b64_tr_b16 a[186:187], v23 offset:20480
    v_mfma_f32_16x16x32_bf16 v[132:135], a[164:167], a[140:143], v[132:135]
    ds_read_b64_tr_b16 a[188:189], v23 offset:24576
    v_mfma_f32_16x16x32_bf16 v[132:135], a[160:163], a[132:135], v[132:135]
    s_waitcnt lgkmcnt(9)
    buffer_store_dwordx4 v[88:91], v74, s[24:27], 0 offen sc1
    v_mfma_f32_16x16x32_bf16 v[140:143], a[168:171], a[132:135], v[140:143]
    s_waitcnt lgkmcnt(7)
    ds_read_b64_tr_b16 a[190:191], v23 offset:28672
    ds_read_b64_tr_b16 a[160:161], v24 offset:16384
    v_mfma_f32_16x16x32_bf16 v[140:143], a[172:175], a[140:143], v[140:143]
    ds_read_b64_tr_b16 a[162:163], v24 offset:20480
    v_mfma_f32_16x16x32_bf16 v[136:139], a[172:175], a[136:139], v[136:139]
    ds_read_b64_tr_b16 a[164:165], v24 offset:24576
    v_mfma_f32_16x16x32_bf16 v[136:139], a[168:171], a[128:131], v[136:139]
    s_waitcnt lgkmcnt(9)
    ds_read_b64_tr_b16 a[166:167], v24 offset:28672
    v_mfma_f32_16x16x32_bf16 v[144:147], a[176:179], a[128:131], v[144:147]
    s_waitcnt lgkmcnt(8)
    ds_read_b64_tr_b16 a[168:169], v25 offset:16384
    v_mfma_f32_16x16x32_bf16 v[144:147], a[180:183], a[136:139], v[144:147]
    ds_read_b64_tr_b16 a[170:171], v25 offset:20480
    v_mfma_f32_16x16x32_bf16 v[148:151], a[180:183], a[140:143], v[148:151]
    ds_read_b64_tr_b16 a[172:173], v25 offset:24576
    v_mfma_f32_16x16x32_bf16 v[148:151], a[176:179], a[132:135], v[148:151]
    s_waitcnt lgkmcnt(9)
    ds_read_b64_tr_b16 a[174:175], v25 offset:28672
    v_mul_f32 v128, s36, v128
    v_mfma_f32_16x16x32_bf16 v[156:159], a[184:187], a[132:135], v[156:159]
    s_waitcnt lgkmcnt(8)
    ds_read_b64_tr_b16 a[176:177], v26 offset:16384
    v_mul_f32 v129, s36, v129
    v_mfma_f32_16x16x32_bf16 v[156:159], a[188:191], a[140:143], v[156:159]
    ds_read_b64_tr_b16 a[178:179], v26 offset:20480
    v_mul_f32 v130, s36, v130
    v_mfma_f32_16x16x32_bf16 v[152:155], a[188:191], a[136:139], v[152:155]
    ds_read_b64_tr_b16 a[180:181], v26 offset:24576
    v_mul_f32 v131, s36, v131
    v_mfma_f32_16x16x32_bf16 v[152:155], a[184:187], a[128:131], v[152:155]
    s_waitcnt lgkmcnt(9)
    ds_read_b64_tr_b16 a[182:183], v26 offset:28672
    v_mul_f32 v136, s36, v136
    v_mfma_f32_16x16x32_bf16 v[160:163], a[160:163], a[128:131], v[160:163]
    s_waitcnt lgkmcnt(8)
    ds_read_b64_tr_b16 a[184:185], v27 offset:16384
    v_mul_f32 v137, s36, v137
    v_mfma_f32_16x16x32_bf16 v[160:163], a[164:167], a[136:139], v[160:163]
    ds_read_b64_tr_b16 a[186:187], v27 offset:20480
    v_mul_f32 v138, s36, v138
    v_mfma_f32_16x16x32_bf16 v[164:167], a[164:167], a[140:143], v[164:167]
    ds_read_b64_tr_b16 a[188:189], v27 offset:24576
    v_mul_f32 v139, s36, v139
    v_mfma_f32_16x16x32_bf16 v[164:167], a[160:163], a[132:135], v[164:167]
    s_waitcnt lgkmcnt(9)
    ds_read_b64_tr_b16 a[190:191], v27 offset:28672
    v_mul_f32 v132, s36, v132
    s_barrier
    v_mfma_f32_16x16x32_bf16 v[172:175], a[168:171], a[132:135], v[172:175]
    s_waitcnt lgkmcnt(8)
    ds_read_b64_tr_b16 a[160:161], v20 offset:32768
    v_mul_f32 v133, s36, v133
    v_mfma_f32_16x16x32_bf16 v[172:175], a[172:175], a[140:143], v[172:175]
    ds_read_b64_tr_b16 a[162:163], v20 offset:36864
    v_mul_f32 v134, s36, v134
    v_mfma_f32_16x16x32_bf16 v[168:171], a[172:175], a[136:139], v[168:171]
    s_add_u32 m0, s42, 0
    ds_read_b64_tr_b16 a[164:165], v20 offset:40960
    v_mul_f32 v135, s36, v135
    v_mfma_f32_16x16x32_bf16 v[168:171], a[168:171], a[128:131], v[168:171]
    s_waitcnt lgkmcnt(9)
    buffer_load_dwordx4 v36, s[8:11], s40 offen lds
    v_mfma_f32_16x16x32_bf16 v[176:179], a[176:179], a[128:131], v[176:179]
    s_waitcnt lgkmcnt(7)
    ds_read_b64_tr_b16 a[166:167], v20 offset:45056
    ds_read_b64_tr_b16 a[168:169], v21 offset:32768
    v_mfma_f32_16x16x32_bf16 v[176:179], a[180:183], a[136:139], v[176:179]
    ds_read_b64_tr_b16 a[170:171], v21 offset:36864
    v_mul_f32 v140, s36, v140
    v_mfma_f32_16x16x32_bf16 v[180:183], a[180:183], a[140:143], v[180:183]
    ds_read_b64_tr_b16 a[172:173], v21 offset:40960
    v_mul_f32 v141, s36, v141
    v_mfma_f32_16x16x32_bf16 v[180:183], a[176:179], a[132:135], v[180:183]
    s_waitcnt lgkmcnt(9)
    buffer_load_dwordx4 v37, s[8:11], s40 offen offset:1024 lds
    v_mfma_f32_16x16x32_bf16 v[188:191], a[184:187], a[132:135], v[188:191]
    s_waitcnt lgkmcnt(7)
    ds_read_b64_tr_b16 a[174:175], v21 offset:45056
    ds_read_b64_tr_b16 a[176:177], v22 offset:32768
    v_mfma_f32_16x16x32_bf16 v[188:191], a[188:191], a[140:143], v[188:191]
    ds_read_b64_tr_b16 a[178:179], v22 offset:36864
    v_mul_f32 v142, s36, v142
    v_mfma_f32_16x16x32_bf16 v[184:187], a[188:191], a[136:139], v[184:187]
    ds_read_b64_tr_b16 a[180:181], v22 offset:40960
    v_mul_f32 v143, s36, v143
    v_mfma_f32_16x16x32_bf16 v[184:187], a[184:187], a[128:131], v[184:187]
    s_waitcnt lgkmcnt(9)
    buffer_load_dwordx4 v38, s[8:11], s40 offen offset:2048 lds
    v_mfma_f32_16x16x32_bf16 v[192:195], a[160:163], a[80:83], v[192:195]
    s_waitcnt lgkmcnt(7)
    ds_read_b64_tr_b16 a[182:183], v22 offset:45056
    ds_read_b64_tr_b16 a[184:185], v23 offset:32768
Ltour2:
    s_cbranch_execz Ltour6
    v_mfma_f32_16x16x32_bf16 v[192:195], a[164:167], a[88:91], v[192:195]
    ds_read_b64_tr_b16 a[186:187], v23 offset:36864
    v_cvt_pk_bf16_f32 v64, v128, v129
    v_mfma_f32_16x16x32_bf16 v[196:199], a[164:167], a[92:95], v[196:199]
    ds_read_b64_tr_b16 a[188:189], v23 offset:40960
    v_cvt_pk_bf16_f32 v65, v130, v131
    v_mfma_f32_16x16x32_bf16 v[196:199], a[160:163], a[84:87], v[196:199]
    s_waitcnt lgkmcnt(9)
    buffer_load_dwordx4 v39, s[8:11], s40 offen offset:3072 lds
    v_mfma_f32_16x16x32_bf16 v[204:207], a[168:171], a[84:87], v[204:207]
    s_waitcnt lgkmcnt(7)
    s_add_u32 s40, s40, 16384
    ds_read_b64_tr_b16 a[190:191], v23 offset:45056
    ds_read_b64_tr_b16 a[160:161], v24 offset:32768
    v_mfma_f32_16x16x32_bf16 v[204:207], a[172:175], a[92:95], v[204:207]
    ds_read_b64_tr_b16 a[162:163], v24 offset:36864
    v_cvt_pk_bf16_f32 v66, v136, v137
    v_mfma_f32_16x16x32_bf16 v[200:203], a[172:175], a[88:91], v[200:203]
    s_add_u32 m0, s42, 16384
    ds_read_b64_tr_b16 a[164:165], v24 offset:40960
    v_cvt_pk_bf16_f32 v67, v138, v139
    v_mfma_f32_16x16x32_bf16 v[200:203], a[168:171], a[80:83], v[200:203]
    s_waitcnt lgkmcnt(9)
    buffer_load_dwordx4 v36, s[8:11], s40 offen lds
    v_mfma_f32_16x16x32_bf16 v[208:211], a[176:179], a[80:83], v[208:211]
    s_waitcnt lgkmcnt(7)
    ds_read_b64_tr_b16 a[166:167], v24 offset:45056
    ds_read_b64_tr_b16 a[168:169], v25 offset:32768
    v_mfma_f32_16x16x32_bf16 v[208:211], a[180:183], a[88:91], v[208:211]
    ds_read_b64_tr_b16 a[170:171], v25 offset:36864
    v_cvt_pk_bf16_f32 v80, v132, v133
    v_mfma_f32_16x16x32_bf16 v[212:215], a[180:183], a[92:95], v[212:215]
    ds_read_b64_tr_b16 a[172:173], v25 offset:40960
    v_cvt_pk_bf16_f32 v81, v134, v135
    v_mfma_f32_16x16x32_bf16 v[212:215], a[176:179], a[84:87], v[212:215]
    s_waitcnt lgkmcnt(9)
    buffer_load_dwordx4 v37, s[8:11], s40 offen offset:1024 lds
    v_mfma_f32_16x16x32_bf16 v[220:223], a[184:187], a[84:87], v[220:223]
    s_waitcnt lgkmcnt(7)
    ds_read_b64_tr_b16 a[174:175], v25 offset:45056
    ds_read_b64_tr_b16 a[176:177], v26 offset:32768
    v_mfma_f32_16x16x32_bf16 v[220:223], a[188:191], a[92:95], v[220:223]
    ds_read_b64_tr_b16 a[178:179], v26 offset:36864
    v_cvt_pk_bf16_f32 v82, v140, v141
    v_mfma_f32_16x16x32_bf16 v[216:219], a[188:191], a[88:91], v[216:219]
    ds_read_b64_tr_b16 a[180:181], v26 offset:40960
    v_cvt_pk_bf16_f32 v83, v142, v143
    v_mfma_f32_16x16x32_bf16 v[216:219], a[184:187], a[80:83], v[216:219]
    s_waitcnt lgkmcnt(9)
    buffer_load_dwordx4 v38, s[8:11], s40 offen offset:2048 lds
    v_mfma_f32_16x16x32_bf16 v[224:227], a[160:163], a[80:83], v[224:227]
    s_waitcnt lgkmcnt(7)
    ds_read_b64_tr_b16 a[182:183], v26 offset:45056
    ds_read_b64_tr_b16 a[184:185], v27 offset:32768
    v_mfma_f32_16x16x32_bf16 v[224:227], a[164:167], a[88:91], v[224:227]
    ds_read_b64_tr_b16 a[186:187], v27 offset:36864
    v_permlane32_swap_b32 v64, v66
    v_mfma_f32_16x16x32_bf16 v[228:231], a[164:167], a[92:95], v[228:231]
    ds_read_b64_tr_b16 a[188:189], v27 offset:40960
    v_permlane32_swap_b32 v65, v67
    v_mfma_f32_16x16x32_bf16 v[228:231], a[160:163], a[84:87], v[228:231]
    s_waitcnt lgkmcnt(9)
    buffer_load_dwordx4 v39, s[8:11], s40 offen offset:3072 lds
    v_mfma_f32_16x16x32_bf16 v[236:239], a[168:171], a[84:87], v[236:239]
    s_waitcnt lgkmcnt(7)
    s_add_u32 s40, s40, 16384
    ds_read_b64_tr_b16 a[190:191], v27 offset:45056
    ds_read_b64_tr_b16 a[160:161], v20 offset:49152
    v_mfma_f32_16x16x32_bf16 v[236:239], a[172:175], a[92:95], v[236:239]
    ds_read_b64_tr_b16 a[162:163], v20 offset:53248
    v_permlane32_swap_b32 v80, v82
    v_mfma_f32_16x16x32_bf16 v[232:235], a[172:175], a[88:91], v[232:235]
    ds_read_b64_tr_b16 a[164:165], v20 offset:57344
    v_permlane32_swap_b32 v81, v83
    v_mfma_f32_16x16x32_bf16 v[232:235], a[168:171], a[80:83], v[232:235]
    s_waitcnt lgkmcnt(9)
    ds_read_b64_tr_b16 a[166:167], v20 offset:61440
    v_permlane16_swap_b32 v64, v66
    v_mfma_f32_16x16x32_bf16 v[240:243], a[176:179], a[80:83], v[240:243]
    s_waitcnt lgkmcnt(8)
    ds_read_b64_tr_b16 a[168:169], v21 offset:49152
    v_permlane16_swap_b32 v65, v67
    v_mfma_f32_16x16x32_bf16 v[240:243], a[180:183], a[88:91], v[240:243]
    ds_read_b64_tr_b16 a[170:171], v21 offset:53248
    v_permlane16_swap_b32 v80, v82
    v_mfma_f32_16x16x32_bf16 v[244:247], a[180:183], a[92:95], v[244:247]
    ds_read_b64_tr_b16 a[172:173], v21 offset:57344
    v_permlane16_swap_b32 v81, v83
    v_mfma_f32_16x16x32_bf16 v[244:247], a[176:179], a[84:87], v[244:247]
    s_waitcnt lgkmcnt(9)
    ds_read_b64_tr_b16 a[174:175], v21 offset:61440
    v_mul_f32 v144, s36, v144
    v_mfma_f32_16x16x32_bf16 v[252:255], a[184:187], a[84:87], v[252:255]
    s_waitcnt lgkmcnt(8)
    ds_read_b64_tr_b16 a[176:177], v22 offset:49152
    v_mul_f32 v145, s36, v145
    v_mfma_f32_16x16x32_bf16 v[252:255], a[188:191], a[92:95], v[252:255]
    ds_read_b64_tr_b16 a[178:179], v22 offset:53248
    v_mul_f32 v146, s36, v146
    v_mfma_f32_16x16x32_bf16 v[248:251], a[188:191], a[88:91], v[248:251]
    ds_read_b64_tr_b16 a[180:181], v22 offset:57344
    v_mul_f32 v147, s36, v147
    v_mfma_f32_16x16x32_bf16 v[248:251], a[184:187], a[80:83], v[248:251]
    s_waitcnt lgkmcnt(9)
    ds_read_b64_tr_b16 a[182:183], v22 offset:61440
    v_mul_f32 v152, s36, v152
    v_mfma_f32_16x16x32_bf16 v[192:195], a[160:163], a[96:99], v[192:195]
    s_waitcnt lgkmcnt(8)
    ds_read_b64_tr_b16 a[184:185], v23 offset:49152
    v_mul_f32 v153, s36, v153
    v_mfma_f32_16x16x32_bf16 v[192:195], a[164:167], a[104:107], v[192:195]
    ds_read_b64_tr_b16 a[186:187], v23 offset:53248
    v_mul_f32 v154, s36, v154
    v_mfma_f32_16x16x32_bf16 v[196:199], a[164:167], a[108:111], v[196:199]
    ds_read_b64_tr_b16 a[188:189], v23 offset:57344
    v_mul_f32 v155, s36, v155
    v_mfma_f32_16x16x32_bf16 v[196:199], a[160:163], a[100:103], v[196:199]
    s_waitcnt lgkmcnt(9)
    ds_read_b64_tr_b16 a[190:191], v23 offset:61440
    v_mul_f32 v148, s36, v148
    v_mfma_f32_16x16x32_bf16 v[204:207], a[168:171], a[100:103], v[204:207]
    s_waitcnt lgkmcnt(8)
    ds_read_b64_tr_b16 a[160:161], v24 offset:49152
    v_mul_f32 v149, s36, v149
    v_mfma_f32_16x16x32_bf16 v[204:207], a[172:175], a[108:111], v[204:207]
    ds_read_b64_tr_b16 a[162:163], v24 offset:53248
    v_mul_f32 v150, s36, v150
    v_mfma_f32_16x16x32_bf16 v[200:203], a[172:175], a[104:107], v[200:203]
    ds_read_b64_tr_b16 a[164:165], v24 offset:57344
    v_mul_f32 v151, s36, v151
    v_mfma_f32_16x16x32_bf16 v[200:203], a[168:171], a[96:99], v[200:203]
    s_waitcnt lgkmcnt(9)
    ds_read_b64_tr_b16 a[166:167], v24 offset:61440
    v_mul_f32 v156, s36, v156
    v_mfma_f32_16x16x32_bf16 v[208:211], a[176:179], a[96:99], v[208:211]
    s_waitcnt lgkmcnt(8)
    ds_read_b64_tr_b16 a[168:169], v25 offset:49152
    v_mul_f32 v157, s36, v157
    v_mfma_f32_16x16x32_bf16 v[208:211], a[180:183], a[104:107], v[208:211]
    ds_read_b64_tr_b16 a[170:171], v25 offset:53248
    v_mul_f32 v158, s36, v158
    v_mfma_f32_16x16x32_bf16 v[212:215], a[180:183], a[108:111], v[212:215]
    ds_read_b64_tr_b16 a[172:173], v25 offset:57344
    v_mul_f32 v159, s36, v159
    v_mfma_f32_16x16x32_bf16 v[212:215], a[176:179], a[100:103], v[212:215]
    s_waitcnt lgkmcnt(9)
    ds_read_b64_tr_b16 a[174:175], v25 offset:61440
    v_cvt_pk_bf16_f32 v68, v144, v145
    v_mfma_f32_16x16x32_bf16 v[220:223], a[184:187], a[100:103], v[220:223]
    s_waitcnt lgkmcnt(8)
    ds_read_b64_tr_b16 a[176:177], v26 offset:49152
    v_cvt_pk_bf16_f32 v69, v146, v147
    v_mfma_f32_16x16x32_bf16 v[220:223], a[188:191], a[108:111], v[220:223]
    ds_read_b64_tr_b16 a[178:179], v26 offset:53248
    v_cvt_pk_bf16_f32 v70, v152, v153
    v_mfma_f32_16x16x32_bf16 v[216:219], a[188:191], a[104:107], v[216:219]
    ds_read_b64_tr_b16 a[180:181], v26 offset:57344
    v_cvt_pk_bf16_f32 v71, v154, v155
    v_mfma_f32_16x16x32_bf16 v[216:219], a[184:187], a[96:99], v[216:219]
    s_waitcnt lgkmcnt(9)
    ds_read_b64_tr_b16 a[182:183], v26 offset:61440
    v_cvt_pk_bf16_f32 v84, v148, v149
    v_mfma_f32_16x16x32_bf16 v[224:227], a[160:163], a[96:99], v[224:227]
    s_waitcnt lgkmcnt(8)
    ds_read_b64_tr_b16 a[184:185], v27 offset:49152
    v_cvt_pk_bf16_f32 v85, v150, v151
    v_mfma_f32_16x16x32_bf16 v[224:227], a[164:167], a[104:107], v[224:227]
    ds_read_b64_tr_b16 a[186:187], v27 offset:53248
    v_cvt_pk_bf16_f32 v86, v156, v157
    v_mfma_f32_16x16x32_bf16 v[228:231], a[164:167], a[108:111], v[228:231]
    ds_read_b64_tr_b16 a[188:189], v27 offset:57344
    v_cvt_pk_bf16_f32 v87, v158, v159
    v_mfma_f32_16x16x32_bf16 v[228:231], a[160:163], a[100:103], v[228:231]
    s_waitcnt lgkmcnt(9)
    ds_read_b64_tr_b16 a[190:191], v27 offset:61440
    v_permlane32_swap_b32 v68, v70
    s_waitcnt vmcnt(12)
    s_barrier
    v_mfma_f32_16x16x32_bf16 v[236:239], a[168:171], a[100:103], v[236:239]
    s_waitcnt lgkmcnt(8)
    ds_read_b64_tr_b16 a[160:161], v28 offset:0
    v_permlane32_swap_b32 v69, v71
    v_mfma_f32_16x16x32_bf16 v[236:239], a[172:175], a[108:111], v[236:239]
    ds_read_b64_tr_b16 a[162:163], v28 offset:4096
    v_permlane32_swap_b32 v84, v86
    v_mfma_f32_16x16x32_bf16 v[232:235], a[172:175], a[104:107], v[232:235]
    s_add_u32 m0, s42, 32768
    ds_read_b64_tr_b16 a[164:165], v28 offset:8192
    v_permlane32_swap_b32 v85, v87
    v_mfma_f32_16x16x32_bf16 v[232:235], a[168:171], a[96:99], v[232:235]
    s_waitcnt lgkmcnt(9)
    buffer_load_dwordx4 v36, s[8:11], s40 offen lds
    v_mfma_f32_16x16x32_bf16 v[240:243], a[176:179], a[96:99], v[240:243]
    s_waitcnt lgkmcnt(7)
    ds_read_b64_tr_b16 a[166:167], v28 offset:12288
    ds_read_b64_tr_b16 a[168:169], v29 offset:0
    v_mfma_f32_16x16x32_bf16 v[240:243], a[180:183], a[104:107], v[240:243]
    ds_read_b64_tr_b16 a[170:171], v29 offset:4096
    v_permlane16_swap_b32 v68, v70
    v_mfma_f32_16x16x32_bf16 v[244:247], a[180:183], a[108:111], v[244:247]
    ds_read_b64_tr_b16 a[172:173], v29 offset:8192
    v_permlane16_swap_b32 v69, v71
    v_mfma_f32_16x16x32_bf16 v[244:247], a[176:179], a[100:103], v[244:247]
    s_waitcnt lgkmcnt(9)
    buffer_load_dwordx4 v37, s[8:11], s40 offen offset:1024 lds
    v_mfma_f32_16x16x32_bf16 v[252:255], a[184:187], a[100:103], v[252:255]
    s_waitcnt lgkmcnt(7)
    ds_read_b64_tr_b16 a[174:175], v29 offset:12288
    ds_read_b64_tr_b16 a[176:177], v30 offset:0
    v_mfma_f32_16x16x32_bf16 v[252:255], a[188:191], a[108:111], v[252:255]
    ds_read_b64_tr_b16 a[178:179], v30 offset:4096
    v_permlane16_swap_b32 v84, v86
    v_mfma_f32_16x16x32_bf16 v[248:251], a[188:191], a[104:107], v[248:251]
    ds_read_b64_tr_b16 a[180:181], v30 offset:8192
    v_permlane16_swap_b32 v85, v87
    v_mfma_f32_16x16x32_bf16 v[248:251], a[184:187], a[96:99], v[248:251]
    s_waitcnt lgkmcnt(9)
    buffer_load_dwordx4 v38, s[8:11], s40 offen offset:2048 lds
    v_mfma_f32_16x16x32_bf16 v[192:195], a[160:163], a[112:115], v[192:195]
    s_waitcnt lgkmcnt(7)
    ds_read_b64_tr_b16 a[182:183], v30 offset:12288
    ds_read_b64_tr_b16 a[184:185], v31 offset:0
    v_mfma_f32_16x16x32_bf16 v[192:195], a[164:167], a[120:123], v[192:195]
    ds_read_b64_tr_b16 a[186:187], v31 offset:4096
    v_mul_f32 v160, s36, v160
    v_mfma_f32_16x16x32_bf16 v[196:199], a[164:167], a[124:127], v[196:199]
    ds_read_b64_tr_b16 a[188:189], v31 offset:8192
    v_mul_f32 v161, s36, v161
    v_mfma_f32_16x16x32_bf16 v[196:199], a[160:163], a[116:119], v[196:199]
    s_waitcnt lgkmcnt(9)
    buffer_load_dwordx4 v39, s[8:11], s40 offen offset:3072 lds
    v_mfma_f32_16x16x32_bf16 v[204:207], a[168:171], a[116:119], v[204:207]
    s_waitcnt lgkmcnt(7)
    s_add_u32 s40, s40, 16384
    ds_read_b64_tr_b16 a[190:191], v31 offset:12288
    ds_read_b64_tr_b16 a[160:161], v32 offset:0
    v_mfma_f32_16x16x32_bf16 v[204:207], a[172:175], a[124:127], v[204:207]
    ds_read_b64_tr_b16 a[162:163], v32 offset:4096
    v_mul_f32 v162, s36, v162
    v_mfma_f32_16x16x32_bf16 v[200:203], a[172:175], a[120:123], v[200:203]
    s_add_u32 m0, s42, 65536
    ds_read_b64_tr_b16 a[164:165], v32 offset:8192
    v_mul_f32 v163, s36, v163
    v_mfma_f32_16x16x32_bf16 v[200:203], a[168:171], a[112:115], v[200:203]
    s_waitcnt lgkmcnt(9)
    buffer_load_dwordx4 v40, s[12:15], s41 offen lds
    v_mfma_f32_16x16x32_bf16 v[208:211], a[176:179], a[112:115], v[208:211]
    s_waitcnt lgkmcnt(7)
    ds_read_b64_tr_b16 a[166:167], v32 offset:12288
    ds_read_b64_tr_b16 a[168:169], v33 offset:0
    v_mfma_f32_16x16x32_bf16 v[208:211], a[180:183], a[120:123], v[208:211]
    ds_read_b64_tr_b16 a[170:171], v33 offset:4096
    v_mul_f32 v168, s36, v168
    v_mfma_f32_16x16x32_bf16 v[212:215], a[180:183], a[124:127], v[212:215]
    ds_read_b64_tr_b16 a[172:173], v33 offset:8192
    v_mul_f32 v169, s36, v169
    v_mfma_f32_16x16x32_bf16 v[212:215], a[176:179], a[116:119], v[212:215]
    s_waitcnt lgkmcnt(9)
    buffer_load_dwordx4 v41, s[12:15], s41 offen offset:1024 lds
    v_mfma_f32_16x16x32_bf16 v[220:223], a[184:187], a[116:119], v[220:223]
    s_waitcnt lgkmcnt(7)
    ds_read_b64_tr_b16 a[174:175], v33 offset:12288
    ds_read_b64_tr_b16 a[176:177], v34 offset:0
    v_mfma_f32_16x16x32_bf16 v[220:223], a[188:191], a[124:127], v[220:223]
    ds_read_b64_tr_b16 a[178:179], v34 offset:4096
    v_mul_f32 v170, s36, v170
    v_mfma_f32_16x16x32_bf16 v[216:219], a[188:191], a[120:123], v[216:219]
    ds_read_b64_tr_b16 a[180:181], v34 offset:8192
    v_mul_f32 v171, s36, v171
    v_mfma_f32_16x16x32_bf16 v[216:219], a[184:187], a[112:115], v[216:219]
    s_waitcnt lgkmcnt(9)
    buffer_load_dwordx4 v40, s[12:15], s41 offen offset:2048 lds
    v_mfma_f32_16x16x32_bf16 v[224:227], a[160:163], a[112:115], v[224:227]
    s_waitcnt lgkmcnt(7)
    ds_read_b64_tr_b16 a[182:183], v34 offset:12288
    ds_read_b64_tr_b16 a[184:185], v35 offset:0
    v_mfma_f32_16x16x32_bf16 v[224:227], a[164:167], a[120:123], v[224:227]
    ds_read_b64_tr_b16 a[186:187], v35 offset:4096
    v_mul_f32 v164, s36, v164
    v_mfma_f32_16x16x32_bf16 v[228:231], a[164:167], a[124:127], v[228:231]
    ds_read_b64_tr_b16 a[188:189], v35 offset:8192
    v_mul_f32 v165, s36, v165
    v_mfma_f32_16x16x32_bf16 v[228:231], a[160:163], a[116:119], v[228:231]
    s_waitcnt lgkmcnt(9)
    buffer_load_dwordx4 v41, s[12:15], s41 offen offset:3072 lds
    v_mfma_f32_16x16x32_bf16 v[236:239], a[168:171], a[116:119], v[236:239]
    s_waitcnt lgkmcnt(7)
    s_add_u32 s41, s41, 16384
    ds_read_b64_tr_b16 a[190:191], v35 offset:12288
    ds_read_b64_tr_b16 a[160:161], v28 offset:16384
    v_mfma_f32_16x16x32_bf16 v[236:239], a[172:175], a[124:127], v[236:239]
    ds_read_b64_tr_b16 a[162:163], v28 offset:20480
    v_mul_f32 v166, s36, v166
    v_mfma_f32_16x16x32_bf16 v[232:235], a[172:175], a[120:123], v[232:235]
    s_add_u32 m0, s42, 81920
    ds_read_b64_tr_b16 a[164:165], v28 offset:24576
    v_mul_f32 v167, s36, v167
    v_mfma_f32_16x16x32_bf16 v[232:235], a[168:171], a[112:115], v[232:235]
    s_waitcnt lgkmcnt(9)
    buffer_load_dwordx4 v40, s[12:15], s41 offen lds
    v_mfma_f32_16x16x32_bf16 v[240:243], a[176:179], a[112:115], v[240:243]
    s_waitcnt lgkmcnt(7)
    ds_read_b64_tr_b16 a[166:167], v28 offset:28672
    ds_read_b64_tr_b16 a[168:169], v29 offset:16384
    v_mfma_f32_16x16x32_bf16 v[240:243], a[180:183], a[120:123], v[240:243]
    ds_read_b64_tr_b16 a[170:171], v29 offset:20480
    v_mul_f32 v172, s36, v172
    v_mfma_f32_16x16x32_bf16 v[244:247], a[180:183], a[124:127], v[244:247]
    ds_read_b64_tr_b16 a[172:173], v29 offset:24576
    v_mul_f32 v173, s36, v173
    v_mfma_f32_16x16x32_bf16 v[244:247], a[176:179], a[116:119], v[244:247]
    s_waitcnt lgkmcnt(9)
    buffer_load_dwordx4 v41, s[12:15], s41 offen offset:1024 lds
    v_mfma_f32_16x16x32_bf16 v[252:255], a[184:187], a[116:119], v[252:255]
    s_waitcnt lgkmcnt(7)
    ds_read_b64_tr_b16 a[174:175], v29 offset:28672
    ds_read_b64_tr_b16 a[176:177], v30 offset:16384
    v_mfma_f32_16x16x32_bf16 v[252:255], a[188:191], a[124:127], v[252:255]
    ds_read_b64_tr_b16 a[178:179], v30 offset:20480
    v_mul_f32 v174, s36, v174
    v_mfma_f32_16x16x32_bf16 v[248:251], a[188:191], a[120:123], v[248:251]
    ds_read_b64_tr_b16 a[180:181], v30 offset:24576
    v_mul_f32 v175, s36, v175
    v_mfma_f32_16x16x32_bf16 v[248:251], a[184:187], a[112:115], v[248:251]
    s_waitcnt lgkmcnt(9)
    buffer_load_dwordx4 v40, s[12:15], s41 offen offset:2048 lds
    v_mfma_f32_16x16x32_bf16 v[192:195], a[160:163], a[128:131], v[192:195]
    s_waitcnt lgkmcnt(7)
    ds_read_b64_tr_b16 a[182:183], v30 offset:28672
    ds_read_b64_tr_b16 a[184:185], v31 offset:16384
    v_mfma_f32_16x16x32_bf16 v[192:195], a[164:167], a[136:139], v[192:195]
    ds_read_b64_tr_b16 a[186:187], v31 offset:20480
    v_cvt_pk_bf16_f32 v72, v160, v161
    v_mfma_f32_16x16x32_bf16 v[196:199], a[164:167], a[140:143], v[196:199]
    ds_read_b64_tr_b16 a[188:189], v31 offset:24576
    v_cvt_pk_bf16_f32 v73, v162, v163
    v_mfma_f32_16x16x32_bf16 v[196:199], a[160:163], a[132:135], v[196:199]
    s_waitcnt lgkmcnt(9)
    buffer_load_dwordx4 v41, s[12:15], s41 offen offset:3072 lds
    v_mfma_f32_16x16x32_bf16 v[204:207], a[168:171], a[132:135], v[204:207]
    s_waitcnt lgkmcnt(7)
    s_add_u32 s41, s41, 16384
    ds_read_b64_tr_b16 a[190:191], v31 offset:28672
    ds_read_b64_tr_b16 a[160:161], v32 offset:16384
    v_mfma_f32_16x16x32_bf16 v[204:207], a[172:175], a[140:143], v[204:207]
    ds_read_b64_tr_b16 a[162:163], v32 offset:20480
    v_cvt_pk_bf16_f32 v74, v168, v169
    v_mfma_f32_16x16x32_bf16 v[200:203], a[172:175], a[136:139], v[200:203]
    ds_read_b64_tr_b16 a[164:165], v32 offset:24576
    v_cvt_pk_bf16_f32 v75, v170, v171
    v_mfma_f32_16x16x32_bf16 v[200:203], a[168:171], a[128:131], v[200:203]
    s_waitcnt lgkmcnt(9)
    ds_read_b64_tr_b16 a[166:167], v32 offset:28672
    v_cvt_pk_bf16_f32 v88, v164, v165
    v_mfma_f32_16x16x32_bf16 v[208:211], a[176:179], a[128:131], v[208:211]
    s_waitcnt lgkmcnt(8)
    ds_read_b64_tr_b16 a[168:169], v33 offset:16384
    v_cvt_pk_bf16_f32 v89, v166, v167
    v_mfma_f32_16x16x32_bf16 v[208:211], a[180:183], a[136:139], v[208:211]
    ds_read_b64_tr_b16 a[170:171], v33 offset:20480
    v_cvt_pk_bf16_f32 v90, v172, v173
    v_mfma_f32_16x16x32_bf16 v[212:215], a[180:183], a[140:143], v[212:215]
    ds_read_b64_tr_b16 a[172:173], v33 offset:24576
    v_cvt_pk_bf16_f32 v91, v174, v175
    v_mfma_f32_16x16x32_bf16 v[212:215], a[176:179], a[132:135], v[212:215]
    s_waitcnt lgkmcnt(9)
    ds_read_b64_tr_b16 a[174:175], v33 offset:28672
    v_permlane32_swap_b32 v72, v74
    v_mfma_f32_16x16x32_bf16 v[220:223], a[184:187], a[132:135], v[220:223]
    s_waitcnt lgkmcnt(8)
    ds_read_b64_tr_b16 a[176:177], v34 offset:16384
    v_permlane32_swap_b32 v73, v75
    v_mfma_f32_16x16x32_bf16 v[220:223], a[188:191], a[140:143], v[220:223]
    ds_read_b64_tr_b16 a[178:179], v34 offset:20480
    v_permlane32_swap_b32 v88, v90
    v_mfma_f32_16x16x32_bf16 v[216:219], a[188:191], a[136:139], v[216:219]
    ds_read_b64_tr_b16 a[180:181], v34 offset:24576
    v_permlane32_swap_b32 v89, v91
    v_mfma_f32_16x16x32_bf16 v[216:219], a[184:187], a[128:131], v[216:219]
    s_waitcnt lgkmcnt(9)
    ds_read_b64_tr_b16 a[182:183], v34 offset:28672
    v_permlane16_swap_b32 v72, v74
    v_mfma_f32_16x16x32_bf16 v[224:227], a[160:163], a[128:131], v[224:227]
    s_waitcnt lgkmcnt(8)
    ds_read_b64_tr_b16 a[184:185], v35 offset:16384
    v_permlane16_swap_b32 v73, v75
    v_mfma_f32_16x16x32_bf16 v[224:227], a[164:167], a[136:139], v[224:227]
    ds_read_b64_tr_b16 a[186:187], v35 offset:20480
    v_permlane16_swap_b32 v88, v90
    v_mfma_f32_16x16x32_bf16 v[228:231], a[164:167], a[140:143], v[228:231]
    ds_read_b64_tr_b16 a[188:189], v35 offset:24576
    v_permlane16_swap_b32 v89, v91
    v_mfma_f32_16x16x32_bf16 v[228:231], a[160:163], a[132:135], v[228:231]
    s_waitcnt lgkmcnt(9)
    ds_read_b64_tr_b16 a[190:191], v35 offset:28672
    v_mul_f32 v176, s36, v176
    v_mfma_f32_16x16x32_bf16 v[236:239], a[168:171], a[132:135], v[236:239]
    s_waitcnt lgkmcnt(8)
    v_mul_f32 v177, s36, v177
    v_mul_f32 v178, s36, v178
    v_mfma_f32_16x16x32_bf16 v[236:239], a[172:175], a[140:143], v[236:239]
    v_mul_f32 v179, s36, v179
    v_mul_f32 v184, s36, v184
    v_mfma_f32_16x16x32_bf16 v[232:235], a[172:175], a[136:139], v[232:235]
    v_mul_f32 v185, s36, v185
    v_mul_f32 v186, s36, v186
    v_mfma_f32_16x16x32_bf16 v[232:235], a[168:171], a[128:131], v[232:235]
    s_waitcnt lgkmcnt(6)
    v_mul_f32 v187, s36, v187
    v_mul_f32 v180, s36, v180
    s_waitcnt vmcnt(16)
    s_barrier
    v_mfma_f32_16x16x32_bf16 v[240:243], a[176:179], a[128:131], v[240:243]
    s_waitcnt lgkmcnt(4)
    ds_read_b128 a[208:211], v8 offset:0
    v_mul_f32 v181, s36, v181
    v_mfma_f32_16x16x32_bf16 v[240:243], a[180:183], a[136:139], v[240:243]
    ds_read_b128 a[212:215], v9 offset:0
    v_mul_f32 v182, s36, v182
    v_mfma_f32_16x16x32_bf16 v[244:247], a[180:183], a[140:143], v[244:247]
    ds_read_b128 a[216:219], v10 offset:0
    v_mul_f32 v183, s36, v183
    v_mfma_f32_16x16x32_bf16 v[244:247], a[176:179], a[132:135], v[244:247]
    s_waitcnt lgkmcnt(5)
    ds_read_b128 a[220:223], v11 offset:0
    v_mul_f32 v188, s36, v188
    v_mfma_f32_16x16x32_bf16 v[252:255], a[184:187], a[132:135], v[252:255]
    s_waitcnt lgkmcnt(4)
    ds_read_b128 a[224:227], v8 offset:4096
    v_mul_f32 v189, s36, v189
    v_mfma_f32_16x16x32_bf16 v[252:255], a[188:191], a[140:143], v[252:255]
    v_mul_f32 v190, s36, v190
    v_mul_f32 v191, s36, v191
    v_mfma_f32_16x16x32_bf16 v[248:251], a[188:191], a[136:139], v[248:251]
    s_load_dwordx2 s[16:17], s[0:1], 88
    v_cvt_pk_bf16_f32 v76, v176, v177
    v_cvt_pk_bf16_f32 v77, v178, v179
    v_mfma_f32_16x16x32_bf16 v[248:251], a[184:187], a[128:131], v[248:251]
    v_cvt_pk_bf16_f32 v78, v184, v185
    v_cvt_pk_bf16_f32 v79, v186, v187
    v_cvt_pk_bf16_f32 v92, v180, v181
    v_cvt_pk_bf16_f32 v93, v182, v183
    v_cvt_pk_bf16_f32 v94, v188, v189
    v_cvt_pk_bf16_f32 v95, v190, v191
    v_permlane32_swap_b32 v76, v78
    v_permlane32_swap_b32 v77, v79
    v_permlane32_swap_b32 v92, v94
    v_permlane32_swap_b32 v93, v95
    v_permlane16_swap_b32 v76, v78
    v_permlane16_swap_b32 v77, v79
    v_permlane16_swap_b32 v92, v94
    v_permlane16_swap_b32 v93, v95
    s_mov_b32 s36, 1040356334
    s_mov_b32 s37, 1040356334
    v_mov_b32 v58, 0
    v_mov_b32 v59, 0
    v_mov_b32 v60, 0
    v_mov_b32 v61, 0
    v_pk_mul_f32 v[192:193], v[192:193], s[36:37]
    v_pk_mul_f32 v[194:195], v[194:195], s[36:37]
    v_pk_mul_f32 v[200:201], v[200:201], s[36:37]
    v_pk_mul_f32 v[202:203], v[202:203], s[36:37]
    v_pk_mul_f32 v[196:197], v[196:197], s[36:37]
    v_pk_mul_f32 v[198:199], v[198:199], s[36:37]
    v_pk_mul_f32 v[204:205], v[204:205], s[36:37]
    v_pk_mul_f32 v[206:207], v[206:207], s[36:37]
    v_mfma_f32_32x32x16_bf16 a[0:15], v[58:61], v[58:61], 0
    v_cvt_pk_bf16_f32 v96, v192, v193
    v_cvt_pk_bf16_f32 v97, v194, v195
    v_cvt_pk_bf16_f32 v98, v200, v201
    v_cvt_pk_bf16_f32 v99, v202, v203
    v_cvt_pk_bf16_f32 v112, v196, v197
    v_cvt_pk_bf16_f32 v113, v198, v199
    v_cvt_pk_bf16_f32 v114, v204, v205
    v_cvt_pk_bf16_f32 v115, v206, v207
    v_mfma_f32_32x32x16_bf16 a[16:31], v[58:61], v[58:61], 0
    v_permlane32_swap_b32 v96, v98
    v_permlane32_swap_b32 v97, v99
    v_permlane32_swap_b32 v112, v114
    v_permlane32_swap_b32 v113, v115
    v_permlane16_swap_b32 v96, v98
    v_permlane16_swap_b32 v97, v99
    v_permlane16_swap_b32 v112, v114
    v_permlane16_swap_b32 v113, v115
    v_pk_mul_f32 v[208:209], v[208:209], s[36:37]
    v_pk_mul_f32 v[210:211], v[210:211], s[36:37]
    v_pk_mul_f32 v[216:217], v[216:217], s[36:37]
    v_pk_mul_f32 v[218:219], v[218:219], s[36:37]
    v_pk_mul_f32 v[212:213], v[212:213], s[36:37]
    v_pk_mul_f32 v[214:215], v[214:215], s[36:37]
    v_pk_mul_f32 v[220:221], v[220:221], s[36:37]
    v_pk_mul_f32 v[222:223], v[222:223], s[36:37]
    v_mfma_f32_32x32x16_bf16 a[32:47], v[58:61], v[58:61], 0
    v_cvt_pk_bf16_f32 v100, v208, v209
    v_cvt_pk_bf16_f32 v101, v210, v211
    v_cvt_pk_bf16_f32 v102, v216, v217
    v_cvt_pk_bf16_f32 v103, v218, v219
    v_cvt_pk_bf16_f32 v116, v212, v213
    v_cvt_pk_bf16_f32 v117, v214, v215
    v_cvt_pk_bf16_f32 v118, v220, v221
    v_cvt_pk_bf16_f32 v119, v222, v223
    v_mfma_f32_32x32x16_bf16 a[48:63], v[58:61], v[58:61], 0
    v_permlane32_swap_b32 v100, v102
    v_permlane32_swap_b32 v101, v103
    v_permlane32_swap_b32 v116, v118
    v_permlane32_swap_b32 v117, v119
    v_permlane16_swap_b32 v100, v102
    v_permlane16_swap_b32 v101, v103
    v_permlane16_swap_b32 v116, v118
    v_permlane16_swap_b32 v117, v119
    v_pk_mul_f32 v[224:225], v[224:225], s[36:37]
    v_pk_mul_f32 v[226:227], v[226:227], s[36:37]
    v_pk_mul_f32 v[232:233], v[232:233], s[36:37]
    v_pk_mul_f32 v[234:235], v[234:235], s[36:37]
    v_pk_mul_f32 v[228:229], v[228:229], s[36:37]
    v_pk_mul_f32 v[230:231], v[230:231], s[36:37]
    v_pk_mul_f32 v[236:237], v[236:237], s[36:37]
    v_pk_mul_f32 v[238:239], v[238:239], s[36:37]
    v_mfma_f32_32x32x16_bf16 a[64:79], v[58:61], v[58:61], 0
    v_cvt_pk_bf16_f32 v104, v224, v225
    v_cvt_pk_bf16_f32 v105, v226, v227
    v_cvt_pk_bf16_f32 v106, v232, v233
    v_cvt_pk_bf16_f32 v107, v234, v235
    v_cvt_pk_bf16_f32 v120, v228, v229
    v_cvt_pk_bf16_f32 v121, v230, v231
    v_cvt_pk_bf16_f32 v122, v236, v237
    v_cvt_pk_bf16_f32 v123, v238, v239
    v_mfma_f32_32x32x16_bf16 a[80:95], v[58:61], v[58:61], 0
    v_permlane32_swap_b32 v104, v106
    v_permlane32_swap_b32 v105, v107
    v_permlane32_swap_b32 v120, v122
    v_permlane32_swap_b32 v121, v123
    v_permlane16_swap_b32 v104, v106
    v_permlane16_swap_b32 v105, v107
    v_permlane16_swap_b32 v120, v122
    v_permlane16_swap_b32 v121, v123
    v_pk_mul_f32 v[240:241], v[240:241], s[36:37]
    v_pk_mul_f32 v[242:243], v[242:243], s[36:37]
    v_pk_mul_f32 v[248:249], v[248:249], s[36:37]
    v_pk_mul_f32 v[250:251], v[250:251], s[36:37]
    v_pk_mul_f32 v[244:245], v[244:245], s[36:37]
    v_pk_mul_f32 v[246:247], v[246:247], s[36:37]
    v_pk_mul_f32 v[252:253], v[252:253], s[36:37]
    v_pk_mul_f32 v[254:255], v[254:255], s[36:37]
    v_mfma_f32_32x32x16_bf16 a[96:111], v[58:61], v[58:61], 0
    v_cvt_pk_bf16_f32 v108, v240, v241
    v_cvt_pk_bf16_f32 v109, v242, v243
    v_cvt_pk_bf16_f32 v110, v248, v249
    v_cvt_pk_bf16_f32 v111, v250, v251
    v_cvt_pk_bf16_f32 v124, v244, v245
    v_cvt_pk_bf16_f32 v125, v246, v247
    v_cvt_pk_bf16_f32 v126, v252, v253
    v_cvt_pk_bf16_f32 v127, v254, v255
    v_mfma_f32_32x32x16_bf16 a[112:127], v[58:61], v[58:61], 0
    v_permlane32_swap_b32 v108, v110
    v_permlane32_swap_b32 v109, v111
    v_permlane32_swap_b32 v124, v126
    v_permlane32_swap_b32 v125, v127
    v_permlane16_swap_b32 v108, v110
    v_permlane16_swap_b32 v109, v111
    v_permlane16_swap_b32 v124, v126
    v_permlane16_swap_b32 v125, v127
    s_waitcnt lgkmcnt(0)
    v_mfma_f32_16x16x32_bf16 v[216:219], a[208:211], v[64:67], 0
    v_mfma_f32_16x16x32_bf16 v[216:219], a[212:215], v[68:71], v[216:219]
    v_mfma_f32_16x16x32_bf16 v[216:219], a[216:219], v[72:75], v[216:219]
    v_mfma_f32_16x16x32_bf16 v[216:219], a[220:223], v[76:79], v[216:219]
    v_mfma_f32_16x16x32_bf16 v[220:223], a[208:211], v[80:83], 0
    v_mfma_f32_16x16x32_bf16 v[220:223], a[212:215], v[84:87], v[220:223]
    v_mfma_f32_16x16x32_bf16 v[220:223], a[216:219], v[88:91], v[220:223]
    v_mfma_f32_16x16x32_bf16 v[220:223], a[220:223], v[92:95], v[220:223]
    v_mfma_f32_16x16x32_bf16 v[224:227], a[208:211], v[96:99], 0
    v_mfma_f32_16x16x32_bf16 v[224:227], a[212:215], v[100:103], v[224:227]
    v_mfma_f32_16x16x32_bf16 v[224:227], a[216:219], v[104:107], v[224:227]
    v_mfma_f32_16x16x32_bf16 v[224:227], a[220:223], v[108:111], v[224:227]
    v_mfma_f32_16x16x32_bf16 v[228:231], a[208:211], v[112:115], 0
    v_mfma_f32_16x16x32_bf16 v[228:231], a[212:215], v[116:119], v[228:231]
    v_mfma_f32_16x16x32_bf16 v[228:231], a[216:219], v[120:123], v[228:231]
    v_mfma_f32_16x16x32_bf16 v[228:231], a[220:223], v[124:127], v[228:231]
    v_mfma_f32_32x32x16_bf16 a[192:207], v[58:61], v[58:61], 0
    v_max3_f32 v232, v216, v217, v218
    v_max_f32 v232, v232, v219
    v_max3_f32 v233, v220, v221, v222
    v_max_f32 v233, v233, v223
    v_max3_f32 v234, v224, v225, v226
    v_max_f32 v234, v234, v227
    s_nop 0
    v_max3_f32 v235, v228, v229, v230
    v_max_f32 v235, v235, v231
    v_mov_b32 v236, v232
    v_mov_b32 v237, v233
    v_mov_b32 v238, v234
    v_mov_b32 v239, v235
    v_permlane16_swap_b32 v232, v236
    v_permlane16_swap_b32 v233, v237
    v_permlane16_swap_b32 v234, v238
    v_permlane16_swap_b32 v235, v239
    v_max_f32 v232, v232, v236
    v_max_f32 v233, v233, v237
    v_max_f32 v234, v234, v238
    v_max_f32 v235, v235, v239
    v_mov_b32 v236, v232
    v_mov_b32 v237, v233
    v_mov_b32 v238, v234
    v_mov_b32 v239, v235
    v_permlane32_swap_b32 v232, v236
    v_permlane32_swap_b32 v233, v237
    v_permlane32_swap_b32 v234, v238
    v_permlane32_swap_b32 v235, v239
    v_max_f32 v232, v232, v236
    v_max_f32 v233, v233, v237
    v_max_f32 v234, v234, v238
    v_max_f32 v235, v235, v239
    v_sub_f32 v192, 3250585600, v232
    v_sub_f32 v193, 3250585600, v232
    v_sub_f32 v194, 3250585600, v232
    v_sub_f32 v195, 3250585600, v232
Ltour3:
    s_cbranch_execz Ltour7
    v_sub_f32 v196, 3250585600, v233
    v_sub_f32 v197, 3250585600, v233
    v_sub_f32 v198, 3250585600, v233
    v_sub_f32 v199, 3250585600, v233
    v_sub_f32 v200, 3250585600, v234
    v_sub_f32 v201, 3250585600, v234
    v_sub_f32 v202, 3250585600, v234
    v_sub_f32 v203, 3250585600, v234
    v_sub_f32 v204, 3250585600, v235
    v_sub_f32 v205, 3250585600, v235
    v_sub_f32 v206, 3250585600, v235
    v_sub_f32 v207, 3250585600, v235
Lattn_stage0:
    s_mov_b32 s43, 7
    v_mfma_f32_16x16x32_bf16 v[208:211], a[208:211], v[64:67], v[192:195]
    s_lshl_b32 s53, s5, 4
    v_mfma_f32_16x16x32_bf16 v[208:211], a[212:215], v[68:71], v[208:211]
    s_add_u32 s53, s53, s4
    v_mfma_f32_16x16x32_bf16 v[208:211], a[216:219], v[72:75], v[208:211]
    s_lshl_b32 s53, s53, 2
    v_mfma_f32_16x16x32_bf16 v[208:211], a[220:223], v[76:79], v[208:211]
    s_add_u32 s53, s53, s3
    ds_read_b128 a[228:231], v9 offset:4096
    v_mfma_f32_16x16x32_bf16 v[212:215], a[208:211], v[80:83], v[196:199]
    s_mul_i32 s53, s53, 4608
    s_nop 3
    v_exp_f32 v208, v208
    v_mfma_f32_16x16x32_bf16 v[212:215], a[212:215], v[84:87], v[212:215]
    s_add_u32 s53, s53, 2621440
    v_exp_f32 v209, v209
    v_mfma_f32_16x16x32_bf16 v[212:215], a[216:219], v[88:91], v[212:215]
    s_lshr_b32 s44, s2, 5
    v_exp_f32 v210, v210
    v_mfma_f32_16x16x32_bf16 v[212:215], a[220:223], v[92:95], v[212:215]
    s_lshl_b32 s44, s44, 3
    v_exp_f32 v211, v211
    v_cvt_pk_bf16_f32 v128, v208, v209
    ds_read_b128 a[232:235], v10 offset:4096
    v_cvt_pk_bf16_f32 v129, v210, v211
    v_mfma_f32_16x16x32_bf16 v[208:211], a[208:211], v[96:99], v[200:203]
    s_and_b32 s37, s2, 7
    s_nop 0
    v_exp_f32 v212, v212
    v_mfma_f32_16x16x32_bf16 v[208:211], a[212:215], v[100:103], v[208:211]
    s_add_u32 s44, s44, s37
    v_exp_f32 v213, v213
    v_mfma_f32_16x16x32_bf16 v[208:211], a[216:219], v[104:107], v[208:211]
    s_lshl_b32 s44, s44, 2
    v_exp_f32 v214, v214
    v_mfma_f32_16x16x32_bf16 v[208:211], a[220:223], v[108:111], v[208:211]
    s_bfe_u32 s37, s2, 0x20003
    v_exp_f32 v215, v215
    v_cvt_pk_bf16_f32 v136, v212, v213
    ds_read_b128 a[236:239], v11 offset:4096
    v_cvt_pk_bf16_f32 v137, v214, v215
    v_mfma_f32_16x16x32_bf16 v[212:215], a[208:211], v[112:115], v[204:207]
    s_add_u32 s44, s44, s37
    s_nop 0
    v_exp_f32 v208, v208
    v_mfma_f32_16x16x32_bf16 v[212:215], a[212:215], v[116:119], v[212:215]
    s_add_u32 s44, s44, 72
    v_exp_f32 v209, v209
    v_mfma_f32_16x16x32_bf16 v[212:215], a[216:219], v[120:123], v[212:215]
    s_cmp_lt_u32 s44, 216
    s_cselect_b32 s37, 0, 2147483648
    v_exp_f32 v210, v210
    v_mfma_f32_16x16x32_bf16 v[212:215], a[220:223], v[124:127], v[212:215]
    s_lshl_b32 s44, s44, 5
    v_exp_f32 v211, v211
    v_cvt_pk_bf16_f32 v144, v208, v209
    ds_read_b128 a[208:211], v8 offset:8192
    v_cvt_pk_bf16_f32 v145, v210, v211
    v_mfma_f32_16x16x32_bf16 v[208:211], a[224:227], v[64:67], v[192:195]
    s_waitcnt lgkmcnt(3)
    s_or_b32 s44, s44, s37
    v_exp_f32 v212, v212
    v_mfma_f32_16x16x32_bf16 v[208:211], a[228:231], v[68:71], v[208:211]
    s_waitcnt lgkmcnt(2)
    s_mov_b32 s18, 3981312
    v_exp_f32 v213, v213
    v_mfma_f32_16x16x32_bf16 v[208:211], a[232:235], v[72:75], v[208:211]
    s_waitcnt lgkmcnt(1)
    s_lshr_b32 s6, s2, 3
    v_exp_f32 v214, v214
    v_mfma_f32_16x16x32_bf16 v[208:211], a[236:239], v[76:79], v[208:211]
    s_and_b32 s7, s2, 7
    v_exp_f32 v215, v215
    v_cvt_pk_bf16_f32 v152, v212, v213
    ds_read_b128 a[212:215], v9 offset:8192
    v_cvt_pk_bf16_f32 v153, v214, v215
    v_mfma_f32_16x16x32_bf16 v[212:215], a[224:227], v[80:83], v[196:199]
    s_mul_i32 s7, s7, 18
    s_nop 0
    v_exp_f32 v208, v208
    v_mfma_f32_16x16x32_bf16 v[212:215], a[228:231], v[84:87], v[212:215]
    s_add_u32 s7, s7, s6
    v_exp_f32 v209, v209
    v_mfma_f32_16x16x32_bf16 v[212:215], a[232:235], v[88:91], v[212:215]
    s_lshl_b32 s58, s7, 6
    v_exp_f32 v210, v210
    v_mfma_f32_16x16x32_bf16 v[212:215], a[236:239], v[92:95], v[212:215]
    s_mul_i32 s59, s7, 36864
    v_exp_f32 v211, v211
    v_cvt_pk_bf16_f32 v130, v208, v209
    ds_read_b128 a[216:219], v10 offset:8192
    v_cvt_pk_bf16_f32 v131, v210, v211
    v_mfma_f32_16x16x32_bf16 v[208:211], a[224:227], v[96:99], v[200:203]
    s_cmp_lt_u32 s6, 18
    s_cselect_b32 s7, 0, 2147483648
    v_exp_f32 v212, v212
    v_mfma_f32_16x16x32_bf16 v[208:211], a[228:231], v[100:103], v[208:211]
    s_or_b32 s58, s58, s7
    v_exp_f32 v213, v213
    v_mfma_f32_16x16x32_bf16 v[208:211], a[232:235], v[104:107], v[208:211]
    s_or_b32 s59, s59, s7
    v_exp_f32 v214, v214
    v_mfma_f32_16x16x32_bf16 v[208:211], a[236:239], v[108:111], v[208:211]
    s_and_b32 s7, s4, 1
    v_exp_f32 v215, v215
    v_cvt_pk_bf16_f32 v138, v212, v213
    ds_read_b128 a[220:223], v11 offset:8192
    v_cvt_pk_bf16_f32 v139, v214, v215
    s_mov_b32 s39, 221184
    s_mov_b32 s38, 27648
    v_mfma_f32_16x16x32_bf16 v[212:215], a[224:227], v[112:115], v[204:207]
    s_lshl_b32 s6, s7, 7
    v_exp_f32 v208, v208
    v_mfma_f32_16x16x32_bf16 v[212:215], a[228:231], v[116:119], v[212:215]
    s_xor_b32 s36, s4, 1
    v_exp_f32 v209, v209
    v_mfma_f32_16x16x32_bf16 v[212:215], a[232:235], v[120:123], v[212:215]
    s_mul_i32 s36, s36, 294912
    v_exp_f32 v210, v210
    v_mfma_f32_16x16x32_bf16 v[212:215], a[236:239], v[124:127], v[212:215]
    s_waitcnt lgkmcnt(3)
    s_add_u32 s46, s36, s6
    v_exp_f32 v211, v211
    v_cvt_pk_bf16_f32 v146, v208, v209
    ds_read_b128 a[224:227], v8 offset:12288
    v_cvt_pk_bf16_f32 v147, v210, v211
    v_mfma_f32_16x16x32_bf16 v[208:211], a[208:211], v[64:67], v[192:195]
    s_waitcnt lgkmcnt(3)
    s_lshl_b32 s36, s4, 8
    v_exp_f32 v212, v212
    v_mfma_f32_16x16x32_bf16 v[208:211], a[212:215], v[68:71], v[208:211]
    s_waitcnt lgkmcnt(2)
    s_add_u32 s56, s47, s36
    v_exp_f32 v213, v213
    v_mfma_f32_16x16x32_bf16 v[208:211], a[216:219], v[72:75], v[208:211]
    s_waitcnt lgkmcnt(1)
    s_lshr_b32 s36, s4, 1
    v_exp_f32 v214, v214
    v_mfma_f32_16x16x32_bf16 v[208:211], a[220:223], v[76:79], v[208:211]
    s_lshl_b32 s36, s36, 11
    v_exp_f32 v215, v215
    v_cvt_pk_bf16_f32 v154, v212, v213
    ds_read_b128 a[228:231], v9 offset:12288
    v_cvt_pk_bf16_f32 v155, v214, v215
    v_mfma_f32_16x16x32_bf16 v[212:215], a[208:211], v[80:83], v[196:199]
    s_lshl_b32 s7, s7, 8
    s_nop 0
    v_exp_f32 v208, v208
    v_mfma_f32_16x16x32_bf16 v[212:215], a[212:215], v[84:87], v[212:215]
    s_add_u32 s36, s36, s7
    v_exp_f32 v209, v209
    v_mfma_f32_16x16x32_bf16 v[212:215], a[216:219], v[88:91], v[212:215]
    s_add_u32 s93, s47, s36
    v_exp_f32 v210, v210
    v_mfma_f32_16x16x32_bf16 v[212:215], a[220:223], v[92:95], v[212:215]
    s_lshr_b32 s36, s4, 1
    v_exp_f32 v211, v211
    v_cvt_pk_bf16_f32 v132, v208, v209
    ds_read_b128 a[232:235], v10 offset:12288
    v_cvt_pk_bf16_f32 v133, v210, v211
    v_mfma_f32_16x16x32_bf16 v[208:211], a[208:211], v[96:99], v[200:203]
    s_lshl_b32 s36, s36, 4
    s_nop 0
    v_exp_f32 v212, v212
    v_mfma_f32_16x16x32_bf16 v[208:211], a[212:215], v[100:103], v[208:211]
    s_add_u32 s36, s36, s5
    v_exp_f32 v213, v213
    v_mfma_f32_16x16x32_bf16 v[208:211], a[216:219], v[104:107], v[208:211]
    s_lshl_b32 s36, s36, 9
    v_exp_f32 v214, v214
    v_mfma_f32_16x16x32_bf16 v[208:211], a[220:223], v[108:111], v[208:211]
    s_add_u32 s36, s36, s7
    v_exp_f32 v215, v215
    v_cvt_pk_bf16_f32 v140, v212, v213
    ds_read_b128 a[236:239], v11 offset:12288
    v_cvt_pk_bf16_f32 v141, v214, v215
    s_waitcnt vmcnt(4)
    s_barrier
    v_mfma_f32_16x16x32_bf16 v[212:215], a[208:211], v[112:115], v[204:207]
    s_lshl_b32 s36, s36, 8
    v_exp_f32 v208, v208
    v_mfma_f32_16x16x32_bf16 v[212:215], a[212:215], v[116:119], v[212:215]
    s_add_u32 m0, s42, 49152
    s_add_u32 s55, s36, 20971520
    v_exp_f32 v209, v209
    v_mfma_f32_16x16x32_bf16 v[212:215], a[216:219], v[120:123], v[212:215]
    s_add_u32 s7, s45, s6
    v_exp_f32 v210, v210
    v_mfma_f32_16x16x32_bf16 v[212:215], a[220:223], v[124:127], v[212:215]
    s_waitcnt lgkmcnt(3)
    s_xor_b32 s54, s92, 128
    v_exp_f32 v211, v211
    v_cvt_pk_bf16_f32 v148, v208, v209
    ds_read_b128 a[208:211], v8 offset:16384
    v_cvt_pk_bf16_f32 v149, v210, v211
    buffer_load_dwordx4 v36, s[8:11], s40 offen lds
    v_mfma_f32_16x16x32_bf16 v[208:211], a[224:227], v[64:67], v[192:195]
    s_waitcnt lgkmcnt(3)
    s_lshl_b32 s36, s3, 14
    v_exp_f32 v212, v212
    v_mfma_f32_16x16x32_bf16 v[208:211], a[228:231], v[68:71], v[208:211]
    s_waitcnt lgkmcnt(2)
    v_exp_f32 v213, v213
    v_mfma_f32_16x16x32_bf16 v[208:211], a[232:235], v[72:75], v[208:211]
    s_waitcnt lgkmcnt(1)
    v_exp_f32 v214, v214
    v_mfma_f32_16x16x32_bf16 v[208:211], a[236:239], v[76:79], v[208:211]
    v_exp_f32 v215, v215
    v_cvt_pk_bf16_f32 v156, v212, v213
    ds_read_b128 a[212:215], v9 offset:16384
    v_cvt_pk_bf16_f32 v157, v214, v215
    v_mfma_f32_16x16x32_bf16 v[212:215], a[224:227], v[80:83], v[196:199]
    s_nop 2
    v_exp_f32 v208, v208
    v_mfma_f32_16x16x32_bf16 v[212:215], a[228:231], v[84:87], v[212:215]
    v_exp_f32 v209, v209
    v_mfma_f32_16x16x32_bf16 v[212:215], a[232:235], v[88:91], v[212:215]
    v_exp_f32 v210, v210
    v_mfma_f32_16x16x32_bf16 v[212:215], a[236:239], v[92:95], v[212:215]
    v_exp_f32 v211, v211
    ds_read_b64_tr_b16 a[160:161], v20 offset:0
    v_cvt_pk_bf16_f32 v134, v208, v209
    v_lshrrev_b32 v51, 2, v0
    v_mul_u32_u24 v51, 9216, v51
    v_and_b32 v254, 3, v0
    v_lshl_add_u32 v254, v254, 4, v51
    v_lshlrev_b32 v255, 4, v0
    v_add_u32 v51, 98304, v255
    v_lshl_add_u32 v252, v1, 4, s36
    v_mov_b32 v224, 0
    v_mov_b32 v225, 0
    v_mov_b32 v226, 0
    v_mov_b32 v227, 0
    v_mov_b32 v228, 0
    v_mov_b32 v229, 0
    v_mov_b32 v230, 0
    v_mov_b32 v231, 0
    v_mov_b32 v248, -1
    v_mov_b32 v249, -1
    v_mov_b32 v250, -1
    v_mov_b32 v251, -1
    v_min_u32 v232, 41, v1
    v_lshlrev_b32 v232, 4, v232
    s_mov_b32 s57, s58
    s_lshl_b32 s6, s3, 10
    s_add_u32 s6, s6, 135168
    s_lshr_b32 s37, s2, 3
    s_mul_i32 s37, s37, -129024
    s_add_u32 s37, s37, 4128768
    ds_read_b64_tr_b16 a[162:163], v20 offset:4096
    ds_read_b128 a[216:219], v10 offset:16384
    v_cvt_pk_bf16_f32 v135, v210, v211
    buffer_load_dwordx4 v37, s[8:11], s40 offen offset:1024 lds
    v_mfma_f32_16x16x32_bf16 v[208:211], a[224:227], v[96:99], v[200:203]
    v_exp_f32 v212, v212
    v_mfma_f32_16x16x32_bf16 v[208:211], a[228:231], v[100:103], v[208:211]
    v_exp_f32 v213, v213
    v_mfma_f32_16x16x32_bf16 v[208:211], a[232:235], v[104:107], v[208:211]
    v_exp_f32 v214, v214
    v_mfma_f32_16x16x32_bf16 v[208:211], a[236:239], v[108:111], v[208:211]
    s_mov_b32 s52, s55
    v_exp_f32 v215, v215
    ds_read_b64_tr_b16 a[164:165], v20 offset:8192
    v_cvt_pk_bf16_f32 v142, v212, v213
    ds_read_b64_tr_b16 a[166:167], v20 offset:12288
    v_min_u32 v237, 19, v1
    v_lshl_add_u32 v237, v237, 7, s36
    v_lshl_add_u32 v238, v1, 7, s36
    ds_read_b128 a[220:223], v11 offset:16384
    v_cvt_pk_bf16_f32 v143, v214, v215
    buffer_load_dword v217, v57, s[32:35], s37 offen
    v_mfma_f32_16x16x32_bf16 v[212:215], a[224:227], v[112:115], v[204:207]
    v_exp_f32 v208, v208
    v_mfma_f32_16x16x32_bf16 v[212:215], a[228:231], v[116:119], v[212:215]
    v_exp_f32 v209, v209
    v_mfma_f32_16x16x32_bf16 v[212:215], a[232:235], v[120:123], v[212:215]
    s_mul_i32 s37, s5, 18432
    v_exp_f32 v210, v210
    v_mfma_f32_16x16x32_bf16 v[212:215], a[236:239], v[124:127], v[212:215]
    s_add_u32 s37, s37, s45
    v_exp_f32 v211, v211
    ds_read_b64_tr_b16 a[168:169], v21 offset:0
    v_cvt_pk_bf16_f32 v150, v208, v209
    ds_read_b64_tr_b16 a[170:171], v21 offset:4096
    v_min_u32 v236, 143, v0
    v_lshl_add_u32 v236, v236, 7, s37
    v_mul_u32_u24 v235, 24, v0
    v_lshrrev_b32 v235, 8, v235
    v_lshl_add_u32 v235, v235, 7, s37
    ds_read_b128 a[224:227], v8 offset:20480
    v_cvt_pk_bf16_f32 v151, v210, v211
    s_waitcnt lgkmcnt(3)
    buffer_load_dwordx4 v38, s[8:11], s40 offen offset:2048 lds
    s_nop 0
    s_nop 0
    s_nop 0
    s_nop 0
    s_nop 0
Lattn_loop:
    v_mfma_f32_16x16x32_bf16 v[208:211], a[208:211], v[64:67], v[192:195]
    v_exp_f32 v212, v212
    v_mfma_f32_16x16x32_bf16 v[208:211], a[212:215], v[68:71], v[208:211]
    v_exp_f32 v213, v213
    v_mfma_f32_16x16x32_bf16 v[208:211], a[216:219], v[72:75], v[208:211]
    v_exp_f32 v214, v214
    v_mfma_f32_16x16x32_bf16 v[208:211], a[220:223], v[76:79], v[208:211]
    v_exp_f32 v215, v215
    v_mfma_f32_16x16x32_bf16 a[0:3], a[160:163], v[128:131], a[0:3]
    ds_read_b64_tr_b16 a[172:173], v21 offset:8192
    v_cvt_pk_bf16_f32 v158, v212, v213
    v_mfma_f32_16x16x32_bf16 a[0:3], a[164:167], v[132:135], a[0:3]
    ds_read_b64_tr_b16 a[174:175], v21 offset:12288
    v_mfma_f32_16x16x32_bf16 a[4:7], a[164:167], v[140:143], a[4:7]
    ds_read_b128 a[228:231], v9 offset:20480
    v_cvt_pk_bf16_f32 v159, v214, v215
    v_mfma_f32_16x16x32_bf16 a[4:7], a[160:163], v[136:139], a[4:7]
    v_mfma_f32_16x16x32_bf16 v[212:215], a[208:211], v[80:83], v[196:199]
    v_exp_f32 v208, v208
    v_mfma_f32_16x16x32_bf16 v[212:215], a[212:215], v[84:87], v[212:215]
    v_exp_f32 v209, v209
    v_mfma_f32_16x16x32_bf16 v[212:215], a[216:219], v[88:91], v[212:215]
    v_exp_f32 v210, v210
    v_mfma_f32_16x16x32_bf16 v[212:215], a[220:223], v[92:95], v[212:215]
    v_exp_f32 v211, v211
    v_mfma_f32_16x16x32_bf16 a[8:11], a[160:163], v[144:147], a[8:11]
    ds_read_b64_tr_b16 a[176:177], v22 offset:0
    v_cvt_pk_bf16_f32 v160, v208, v209
    v_mfma_f32_16x16x32_bf16 a[8:11], a[164:167], v[148:151], a[8:11]
    ds_read_b64_tr_b16 a[178:179], v22 offset:4096
    v_mfma_f32_16x16x32_bf16 a[12:15], a[164:167], v[156:159], a[12:15]
    ds_read_b128 a[232:235], v10 offset:20480
    v_cvt_pk_bf16_f32 v161, v210, v211
    v_mfma_f32_16x16x32_bf16 a[12:15], a[160:163], v[152:155], a[12:15]
    s_waitcnt lgkmcnt(3)
    buffer_load_dwordx4 v39, s[8:11], s40 offen offset:3072 lds
    v_mfma_f32_16x16x32_bf16 v[208:211], a[208:211], v[96:99], v[200:203]
    v_exp_f32 v212, v212
    v_mfma_f32_16x16x32_bf16 v[208:211], a[212:215], v[100:103], v[208:211]
    s_add_u32 s40, s40, 16384
    v_exp_f32 v213, v213
    v_mfma_f32_16x16x32_bf16 v[208:211], a[216:219], v[104:107], v[208:211]
    s_mov_b32 m0, s6
    v_exp_f32 v214, v214
    v_mfma_f32_16x16x32_bf16 v[208:211], a[220:223], v[108:111], v[208:211]
    v_exp_f32 v215, v215
    v_mfma_f32_16x16x32_bf16 a[16:19], a[168:171], v[128:131], a[16:19]
    ds_read_b64_tr_b16 a[180:181], v22 offset:8192
    v_cvt_pk_bf16_f32 v168, v212, v213
    v_mfma_f32_16x16x32_bf16 a[16:19], a[172:175], v[132:135], a[16:19]
    ds_read_b64_tr_b16 a[182:183], v22 offset:12288
    v_mfma_f32_16x16x32_bf16 a[20:23], a[172:175], v[140:143], a[20:23]
    ds_read_b128 a[236:239], v11 offset:20480
    v_cvt_pk_bf16_f32 v169, v214, v215
    v_mfma_f32_16x16x32_bf16 a[20:23], a[168:171], v[136:139], a[20:23]
    buffer_load_dwordx4 v254, s[32:35], s57 offen  lds
    v_smfmac_f32_16x16x64_bf16 a[192:195], v[52:55], v[128:135], v50
    v_mfma_f32_16x16x32_bf16 v[212:215], a[208:211], v[112:115], v[204:207]
    v_exp_f32 v208, v208
    v_mfma_f32_16x16x32_bf16 v[212:215], a[212:215], v[116:119], v[212:215]
    s_add_u32 m0, s42, 98304
    v_exp_f32 v209, v209
    v_mfma_f32_16x16x32_bf16 v[212:215], a[216:219], v[120:123], v[212:215]
    v_exp_f32 v210, v210
    v_mfma_f32_16x16x32_bf16 v[212:215], a[220:223], v[124:127], v[212:215]
    v_exp_f32 v211, v211
    v_mfma_f32_16x16x32_bf16 a[24:27], a[168:171], v[144:147], a[24:27]
    ds_read_b64_tr_b16 a[184:185], v23 offset:0
    v_cvt_pk_bf16_f32 v176, v208, v209
    v_mfma_f32_16x16x32_bf16 a[24:27], a[172:175], v[148:151], a[24:27]
    ds_read_b64_tr_b16 a[186:187], v23 offset:4096
    v_mfma_f32_16x16x32_bf16 a[28:31], a[172:175], v[156:159], a[28:31]
    ds_read_b128 a[208:211], v8 offset:24576
    v_cvt_pk_bf16_f32 v177, v210, v211
    v_mfma_f32_16x16x32_bf16 a[28:31], a[168:171], v[152:155], a[28:31]
    s_waitcnt lgkmcnt(3)
    buffer_load_dwordx4 v40, s[12:15], s41 offen lds
    v_mfma_f32_16x16x32_bf16 v[208:211], a[224:227], v[64:67], v[192:195]
    v_exp_f32 v212, v212
    v_mfma_f32_16x16x32_bf16 v[208:211], a[228:231], v[68:71], v[208:211]
    s_add_u32 s6, s6, 4096
    v_exp_f32 v213, v213
    v_mfma_f32_16x16x32_bf16 v[208:211], a[232:235], v[72:75], v[208:211]
    s_add_u32 s57, s57, 589824
    v_exp_f32 v214, v214
    v_mfma_f32_16x16x32_bf16 v[208:211], a[236:239], v[76:79], v[208:211]
    v_exp_f32 v215, v215
    v_mfma_f32_16x16x32_bf16 a[32:35], a[176:179], v[128:131], a[32:35]
    ds_read_b64_tr_b16 a[188:189], v23 offset:8192
    v_cvt_pk_bf16_f32 v184, v212, v213
    v_mfma_f32_16x16x32_bf16 a[32:35], a[180:183], v[132:135], a[32:35]
    ds_read_b64_tr_b16 a[190:191], v23 offset:12288
    v_mfma_f32_16x16x32_bf16 a[36:39], a[180:183], v[140:143], a[36:39]
    ds_read_b128 a[212:215], v9 offset:24576
    v_cvt_pk_bf16_f32 v185, v214, v215
    v_mfma_f32_16x16x32_bf16 a[36:39], a[176:179], v[136:139], a[36:39]
    v_smfmac_f32_16x16x64_bf16 a[196:199], v[52:55], v[136:143], v50
    v_mfma_f32_16x16x32_bf16 v[212:215], a[224:227], v[80:83], v[196:199]
    v_exp_f32 v208, v208
    v_mfma_f32_16x16x32_bf16 v[212:215], a[228:231], v[84:87], v[212:215]
    v_exp_f32 v209, v209
    v_mfma_f32_16x16x32_bf16 v[212:215], a[232:235], v[88:91], v[212:215]
    v_exp_f32 v210, v210
    v_mfma_f32_16x16x32_bf16 v[212:215], a[236:239], v[92:95], v[212:215]
    v_exp_f32 v211, v211
    v_mfma_f32_16x16x32_bf16 a[40:43], a[176:179], v[144:147], a[40:43]
    ds_read_b64_tr_b16 a[160:161], v24 offset:0
    v_cvt_pk_bf16_f32 v162, v208, v209
    v_mfma_f32_16x16x32_bf16 a[40:43], a[180:183], v[148:151], a[40:43]
    ds_read_b64_tr_b16 a[162:163], v24 offset:4096
    v_mfma_f32_16x16x32_bf16 a[44:47], a[180:183], v[156:159], a[44:47]
    ds_read_b128 a[216:219], v10 offset:24576
    v_cvt_pk_bf16_f32 v163, v210, v211
    v_mfma_f32_16x16x32_bf16 a[44:47], a[176:179], v[152:155], a[44:47]
    s_waitcnt lgkmcnt(3)
    buffer_load_dwordx4 v41, s[12:15], s41 offen offset:1024 lds
    v_mfma_f32_16x16x32_bf16 v[208:211], a[224:227], v[96:99], v[200:203]
    v_exp_f32 v212, v212
    v_mfma_f32_16x16x32_bf16 v[208:211], a[228:231], v[100:103], v[208:211]
    v_exp_f32 v213, v213
    v_mfma_f32_16x16x32_bf16 v[208:211], a[232:235], v[104:107], v[208:211]
    v_exp_f32 v214, v214
    v_mfma_f32_16x16x32_bf16 v[208:211], a[236:239], v[108:111], v[208:211]
    v_exp_f32 v215, v215
    v_mfma_f32_16x16x32_bf16 a[48:51], a[184:187], v[128:131], a[48:51]
    ds_read_b64_tr_b16 a[164:165], v24 offset:8192
    v_cvt_pk_bf16_f32 v170, v212, v213
    v_mfma_f32_16x16x32_bf16 a[48:51], a[188:191], v[132:135], a[48:51]
    ds_read_b64_tr_b16 a[166:167], v24 offset:12288
    v_mfma_f32_16x16x32_bf16 a[52:55], a[188:191], v[140:143], a[52:55]
    ds_read_b128 a[220:223], v11 offset:24576
    v_cvt_pk_bf16_f32 v171, v214, v215
    v_mfma_f32_16x16x32_bf16 a[52:55], a[184:187], v[136:139], a[52:55]
    v_smfmac_f32_16x16x64_bf16 a[200:203], v[52:55], v[144:151], v50
    v_mfma_f32_16x16x32_bf16 v[212:215], a[224:227], v[112:115], v[204:207]
    v_exp_f32 v208, v208
    v_mfma_f32_16x16x32_bf16 v[212:215], a[228:231], v[116:119], v[212:215]
    v_exp_f32 v209, v209
    v_mfma_f32_16x16x32_bf16 v[212:215], a[232:235], v[120:123], v[212:215]
    v_exp_f32 v210, v210
    v_mfma_f32_16x16x32_bf16 v[212:215], a[236:239], v[124:127], v[212:215]
    v_exp_f32 v211, v211
    v_mfma_f32_16x16x32_bf16 a[56:59], a[184:187], v[144:147], a[56:59]
    ds_read_b64_tr_b16 a[168:169], v25 offset:0
    v_cvt_pk_bf16_f32 v178, v208, v209
    v_mfma_f32_16x16x32_bf16 a[56:59], a[188:191], v[148:151], a[56:59]
    ds_read_b64_tr_b16 a[170:171], v25 offset:4096
    v_mfma_f32_16x16x32_bf16 a[60:63], a[188:191], v[156:159], a[60:63]
    ds_read_b128 a[224:227], v8 offset:28672
    v_cvt_pk_bf16_f32 v179, v210, v211
    v_mfma_f32_16x16x32_bf16 a[60:63], a[184:187], v[152:155], a[60:63]
    s_waitcnt lgkmcnt(3)
    buffer_load_dwordx4 v40, s[12:15], s41 offen offset:2048 lds
    v_mfma_f32_16x16x32_bf16 v[208:211], a[208:211], v[64:67], v[192:195]
    v_exp_f32 v212, v212
    v_mfma_f32_16x16x32_bf16 v[208:211], a[212:215], v[68:71], v[208:211]
    v_exp_f32 v213, v213
    v_mfma_f32_16x16x32_bf16 v[208:211], a[216:219], v[72:75], v[208:211]
    v_exp_f32 v214, v214
    v_mfma_f32_16x16x32_bf16 v[208:211], a[220:223], v[76:79], v[208:211]
    v_exp_f32 v215, v215
    v_mfma_f32_16x16x32_bf16 a[64:67], a[160:163], v[128:131], a[64:67]
    ds_read_b64_tr_b16 a[172:173], v25 offset:8192
    v_cvt_pk_bf16_f32 v186, v212, v213
    v_mfma_f32_16x16x32_bf16 a[64:67], a[164:167], v[132:135], a[64:67]
    ds_read_b64_tr_b16 a[174:175], v25 offset:12288
    v_mfma_f32_16x16x32_bf16 a[68:71], a[164:167], v[140:143], a[68:71]
    ds_read_b128 a[228:231], v9 offset:28672
    v_cvt_pk_bf16_f32 v187, v214, v215
    v_mfma_f32_16x16x32_bf16 a[68:71], a[160:163], v[136:139], a[68:71]
    v_smfmac_f32_16x16x64_bf16 a[204:207], v[52:55], v[152:159], v50
    v_mfma_f32_16x16x32_bf16 v[212:215], a[208:211], v[80:83], v[196:199]
    v_exp_f32 v208, v208
    v_mfma_f32_16x16x32_bf16 v[212:215], a[212:215], v[84:87], v[212:215]
    v_exp_f32 v209, v209
    v_mfma_f32_16x16x32_bf16 v[212:215], a[216:219], v[88:91], v[212:215]
    v_exp_f32 v210, v210
    v_mfma_f32_16x16x32_bf16 v[212:215], a[220:223], v[92:95], v[212:215]
    v_exp_f32 v211, v211
    v_mfma_f32_16x16x32_bf16 a[72:75], a[160:163], v[144:147], a[72:75]
    ds_read_b64_tr_b16 a[176:177], v26 offset:0
    v_cvt_pk_bf16_f32 v164, v208, v209
    v_mfma_f32_16x16x32_bf16 a[72:75], a[164:167], v[148:151], a[72:75]
    ds_read_b64_tr_b16 a[178:179], v26 offset:4096
    v_mfma_f32_16x16x32_bf16 a[76:79], a[164:167], v[156:159], a[76:79]
    ds_read_b128 a[232:235], v10 offset:28672
    v_cvt_pk_bf16_f32 v165, v210, v211
    v_mfma_f32_16x16x32_bf16 a[76:79], a[160:163], v[152:155], a[76:79]
    s_waitcnt lgkmcnt(3)
    buffer_load_dwordx4 v41, s[12:15], s41 offen offset:3072 lds
    v_mfma_f32_16x16x32_bf16 v[208:211], a[208:211], v[96:99], v[200:203]
    v_exp_f32 v212, v212
    v_mfma_f32_16x16x32_bf16 v[208:211], a[212:215], v[100:103], v[208:211]
    s_add_u32 s41, s41, 16384
    v_exp_f32 v213, v213
    v_mfma_f32_16x16x32_bf16 v[208:211], a[216:219], v[104:107], v[208:211]
    v_exp_f32 v214, v214
    v_mfma_f32_16x16x32_bf16 v[208:211], a[220:223], v[108:111], v[208:211]
    v_exp_f32 v215, v215
    v_mfma_f32_16x16x32_bf16 a[80:83], a[168:171], v[128:131], a[80:83]
    ds_read_b64_tr_b16 a[180:181], v26 offset:8192
    v_cvt_pk_bf16_f32 v172, v212, v213
    v_mfma_f32_16x16x32_bf16 a[80:83], a[172:175], v[132:135], a[80:83]
    ds_read_b64_tr_b16 a[182:183], v26 offset:12288
    v_mfma_f32_16x16x32_bf16 a[84:87], a[172:175], v[140:143], a[84:87]
    ds_read_b128 a[236:239], v11 offset:28672
    v_cvt_pk_bf16_f32 v173, v214, v215
    v_mfma_f32_16x16x32_bf16 a[84:87], a[168:171], v[136:139], a[84:87]
    s_waitcnt vmcnt(10)
    s_barrier
    v_mfma_f32_16x16x32_bf16 v[212:215], a[208:211], v[112:115], v[204:207]
    v_exp_f32 v208, v208
    v_mfma_f32_16x16x32_bf16 v[212:215], a[212:215], v[116:119], v[212:215]
    s_add_u32 m0, s42, 0
    v_exp_f32 v209, v209
    v_mfma_f32_16x16x32_bf16 v[212:215], a[216:219], v[120:123], v[212:215]
    v_exp_f32 v210, v210
    v_mfma_f32_16x16x32_bf16 v[212:215], a[220:223], v[124:127], v[212:215]
    v_exp_f32 v211, v211
    v_mfma_f32_16x16x32_bf16 a[88:91], a[168:171], v[144:147], a[88:91]
    ds_read_b64_tr_b16 a[184:185], v27 offset:0
    v_cvt_pk_bf16_f32 v180, v208, v209
    v_mfma_f32_16x16x32_bf16 a[88:91], a[172:175], v[148:151], a[88:91]
    ds_read_b64_tr_b16 a[186:187], v27 offset:4096
    v_mfma_f32_16x16x32_bf16 a[92:95], a[172:175], v[156:159], a[92:95]
    ds_read_b128 a[208:211], v8 offset:32768
    v_cvt_pk_bf16_f32 v181, v210, v211
    v_mfma_f32_16x16x32_bf16 a[92:95], a[168:171], v[152:155], a[92:95]
    s_waitcnt lgkmcnt(3)
    buffer_load_dwordx4 v36, s[8:11], s40 offen lds
    v_mfma_f32_16x16x32_bf16 v[208:211], a[224:227], v[64:67], v[192:195]
    v_exp_f32 v212, v212
    v_mfma_f32_16x16x32_bf16 v[208:211], a[228:231], v[68:71], v[208:211]
    v_exp_f32 v213, v213
    v_mfma_f32_16x16x32_bf16 v[208:211], a[232:235], v[72:75], v[208:211]
    v_exp_f32 v214, v214
    v_mfma_f32_16x16x32_bf16 v[208:211], a[236:239], v[76:79], v[208:211]
    v_exp_f32 v215, v215
    v_mfma_f32_16x16x32_bf16 a[96:99], a[176:179], v[128:131], a[96:99]
    ds_read_b64_tr_b16 a[188:189], v27 offset:8192
    v_cvt_pk_bf16_f32 v188, v212, v213
    v_mfma_f32_16x16x32_bf16 a[96:99], a[180:183], v[132:135], a[96:99]
    ds_read_b64_tr_b16 a[190:191], v27 offset:12288
    v_mfma_f32_16x16x32_bf16 a[100:103], a[180:183], v[140:143], a[100:103]
    ds_read_b128 a[212:215], v9 offset:32768
    v_cvt_pk_bf16_f32 v189, v214, v215
    v_mfma_f32_16x16x32_bf16 a[100:103], a[176:179], v[136:139], a[100:103]
    v_mfma_f32_16x16x32_bf16 v[212:215], a[224:227], v[80:83], v[196:199]
    v_exp_f32 v208, v208
    v_mfma_f32_16x16x32_bf16 v[212:215], a[228:231], v[84:87], v[212:215]
    v_exp_f32 v209, v209
    v_mfma_f32_16x16x32_bf16 v[212:215], a[232:235], v[88:91], v[212:215]
    v_exp_f32 v210, v210
    v_mfma_f32_16x16x32_bf16 v[212:215], a[236:239], v[92:95], v[212:215]
    v_exp_f32 v211, v211
    v_mfma_f32_16x16x32_bf16 a[104:107], a[176:179], v[144:147], a[104:107]
    ds_read_b64_tr_b16 a[160:161], v20 offset:16384
    v_cvt_pk_bf16_f32 v166, v208, v209
    v_mfma_f32_16x16x32_bf16 a[104:107], a[180:183], v[148:151], a[104:107]
    ds_read_b64_tr_b16 a[162:163], v20 offset:20480
    v_mfma_f32_16x16x32_bf16 a[108:111], a[180:183], v[156:159], a[108:111]
    ds_read_b128 a[216:219], v10 offset:32768
    v_cvt_pk_bf16_f32 v167, v210, v211
    v_mfma_f32_16x16x32_bf16 a[108:111], a[176:179], v[152:155], a[108:111]
    s_waitcnt lgkmcnt(3)
    buffer_load_dwordx4 v37, s[8:11], s40 offen offset:1024 lds
    v_mfma_f32_16x16x32_bf16 v[208:211], a[224:227], v[96:99], v[200:203]
    v_exp_f32 v212, v212
    v_mfma_f32_16x16x32_bf16 v[208:211], a[228:231], v[100:103], v[208:211]
    v_exp_f32 v213, v213
    v_mfma_f32_16x16x32_bf16 v[208:211], a[232:235], v[104:107], v[208:211]
    v_exp_f32 v214, v214
    v_mfma_f32_16x16x32_bf16 v[208:211], a[236:239], v[108:111], v[208:211]
    v_exp_f32 v215, v215
    v_mfma_f32_16x16x32_bf16 a[112:115], a[184:187], v[128:131], a[112:115]
    ds_read_b64_tr_b16 a[164:165], v20 offset:24576
    v_cvt_pk_bf16_f32 v174, v212, v213
    v_mfma_f32_16x16x32_bf16 a[112:115], a[188:191], v[132:135], a[112:115]
    ds_read_b64_tr_b16 a[166:167], v20 offset:28672
    v_mfma_f32_16x16x32_bf16 a[116:119], a[188:191], v[140:143], a[116:119]
    ds_read_b128 a[220:223], v11 offset:32768
    v_cvt_pk_bf16_f32 v175, v214, v215
    v_mfma_f32_16x16x32_bf16 a[116:119], a[184:187], v[136:139], a[116:119]
    buffer_load_dwordx4 v[240:243], v7, s[16:19], s44 offen
    v_mfma_f32_16x16x32_bf16 v[212:215], a[224:227], v[112:115], v[204:207]
    v_exp_f32 v208, v208
    v_mfma_f32_16x16x32_bf16 v[212:215], a[228:231], v[116:119], v[212:215]
    v_exp_f32 v209, v209
    v_mfma_f32_16x16x32_bf16 v[212:215], a[232:235], v[120:123], v[212:215]
    v_exp_f32 v210, v210
    v_mfma_f32_16x16x32_bf16 v[212:215], a[236:239], v[124:127], v[212:215]
    s_add_u32 s44, s44, 884736
    v_exp_f32 v211, v211
    v_mfma_f32_16x16x32_bf16 a[120:123], a[184:187], v[144:147], a[120:123]
    ds_read_b64_tr_b16 a[168:169], v21 offset:16384
    v_cvt_pk_bf16_f32 v182, v208, v209
    v_mfma_f32_16x16x32_bf16 a[120:123], a[188:191], v[148:151], a[120:123]
    ds_read_b64_tr_b16 a[170:171], v21 offset:20480
    v_mfma_f32_16x16x32_bf16 a[124:127], a[188:191], v[156:159], a[124:127]
    ds_read_b128 a[224:227], v8 offset:36864
    v_cvt_pk_bf16_f32 v183, v210, v211
    v_mfma_f32_16x16x32_bf16 a[124:127], a[184:187], v[152:155], a[124:127]
    s_waitcnt lgkmcnt(3)
    buffer_load_dwordx4 v38, s[8:11], s40 offen offset:2048 lds
    v_mfma_f32_16x16x32_bf16 v[208:211], a[208:211], v[64:67], v[192:195]
    v_exp_f32 v212, v212
    v_mfma_f32_16x16x32_bf16 v[208:211], a[212:215], v[68:71], v[208:211]
    v_exp_f32 v213, v213
    v_mfma_f32_16x16x32_bf16 v[208:211], a[216:219], v[72:75], v[208:211]
    v_exp_f32 v214, v214
    v_mfma_f32_16x16x32_bf16 v[208:211], a[220:223], v[76:79], v[208:211]
Ltour4:
    s_cbranch_execz Ltour8
    v_exp_f32 v215, v215
    v_mfma_f32_16x16x32_bf16 a[0:3], a[160:163], v[160:163], a[0:3]
    ds_read_b64_tr_b16 a[172:173], v21 offset:24576
    v_cvt_pk_bf16_f32 v190, v212, v213
    v_mfma_f32_16x16x32_bf16 a[0:3], a[164:167], v[164:167], a[0:3]
    ds_read_b64_tr_b16 a[174:175], v21 offset:28672
    v_mfma_f32_16x16x32_bf16 a[4:7], a[164:167], v[172:175], a[4:7]
    ds_read_b128 a[228:231], v9 offset:36864
    v_cvt_pk_bf16_f32 v191, v214, v215
    v_mfma_f32_16x16x32_bf16 a[4:7], a[160:163], v[168:171], a[4:7]
    v_mfma_f32_16x16x32_bf16 v[212:215], a[208:211], v[80:83], v[196:199]
    v_exp_f32 v208, v208
    v_mfma_f32_16x16x32_bf16 v[212:215], a[212:215], v[84:87], v[212:215]
    v_exp_f32 v209, v209
    v_mfma_f32_16x16x32_bf16 v[212:215], a[216:219], v[88:91], v[212:215]
    v_exp_f32 v210, v210
    v_mfma_f32_16x16x32_bf16 v[212:215], a[220:223], v[92:95], v[212:215]
    v_exp_f32 v211, v211
    v_mfma_f32_16x16x32_bf16 a[8:11], a[160:163], v[176:179], a[8:11]
    ds_read_b64_tr_b16 a[176:177], v22 offset:16384
    v_cvt_pk_bf16_f32 v128, v208, v209
    v_mfma_f32_16x16x32_bf16 a[8:11], a[164:167], v[180:183], a[8:11]
    ds_read_b64_tr_b16 a[178:179], v22 offset:20480
    v_mfma_f32_16x16x32_bf16 a[12:15], a[164:167], v[188:191], a[12:15]
    ds_read_b128 a[232:235], v10 offset:36864
    v_cvt_pk_bf16_f32 v129, v210, v211
    v_mfma_f32_16x16x32_bf16 a[12:15], a[160:163], v[184:187], a[12:15]
    s_waitcnt lgkmcnt(3)
    buffer_load_dwordx4 v39, s[8:11], s40 offen offset:3072 lds
    v_mfma_f32_16x16x32_bf16 v[208:211], a[208:211], v[96:99], v[200:203]
    v_exp_f32 v212, v212
    v_mfma_f32_16x16x32_bf16 v[208:211], a[212:215], v[100:103], v[208:211]
    s_add_u32 s40, s40, 16384
    v_exp_f32 v213, v213
    v_mfma_f32_16x16x32_bf16 v[208:211], a[216:219], v[104:107], v[208:211]
    v_exp_f32 v214, v214
    v_mfma_f32_16x16x32_bf16 v[208:211], a[220:223], v[108:111], v[208:211]
    v_exp_f32 v215, v215
    v_mfma_f32_16x16x32_bf16 a[16:19], a[168:171], v[160:163], a[16:19]
    ds_read_b64_tr_b16 a[180:181], v22 offset:24576
    v_cvt_pk_bf16_f32 v136, v212, v213
    v_mfma_f32_16x16x32_bf16 a[16:19], a[172:175], v[164:167], a[16:19]
    ds_read_b64_tr_b16 a[182:183], v22 offset:28672
    v_mfma_f32_16x16x32_bf16 a[20:23], a[172:175], v[172:175], a[20:23]
    ds_read_b128 a[236:239], v11 offset:36864
    v_cvt_pk_bf16_f32 v137, v214, v215
    v_mfma_f32_16x16x32_bf16 a[20:23], a[168:171], v[168:171], a[20:23]
    v_smfmac_f32_16x16x64_bf16 a[192:195], v[52:55], v[160:167], v50
    v_mfma_f32_16x16x32_bf16 v[212:215], a[208:211], v[112:115], v[204:207]
    v_exp_f32 v208, v208
    v_mfma_f32_16x16x32_bf16 v[212:215], a[212:215], v[116:119], v[212:215]
    s_add_u32 m0, s42, 114688
    v_exp_f32 v209, v209
    v_mfma_f32_16x16x32_bf16 v[212:215], a[216:219], v[120:123], v[212:215]
    v_exp_f32 v210, v210
    v_mfma_f32_16x16x32_bf16 v[212:215], a[220:223], v[124:127], v[212:215]
    v_exp_f32 v211, v211
    v_mfma_f32_16x16x32_bf16 a[24:27], a[168:171], v[176:179], a[24:27]
    ds_read_b64_tr_b16 a[184:185], v23 offset:16384
    v_cvt_pk_bf16_f32 v144, v208, v209
    v_mfma_f32_16x16x32_bf16 a[24:27], a[172:175], v[180:183], a[24:27]
    ds_read_b64_tr_b16 a[186:187], v23 offset:20480
    v_mfma_f32_16x16x32_bf16 a[28:31], a[172:175], v[188:191], a[28:31]
    ds_read_b128 a[208:211], v8 offset:40960
    v_cvt_pk_bf16_f32 v145, v210, v211
    v_mfma_f32_16x16x32_bf16 a[28:31], a[168:171], v[184:187], a[28:31]
    s_waitcnt lgkmcnt(3)
    buffer_load_dwordx4 v40, s[12:15], s41 offen lds
    v_mfma_f32_16x16x32_bf16 v[208:211], a[224:227], v[64:67], v[192:195]
    v_exp_f32 v212, v212
    v_mfma_f32_16x16x32_bf16 v[208:211], a[228:231], v[68:71], v[208:211]
    v_exp_f32 v213, v213
    v_mfma_f32_16x16x32_bf16 v[208:211], a[232:235], v[72:75], v[208:211]
    v_exp_f32 v214, v214
    v_mfma_f32_16x16x32_bf16 v[208:211], a[236:239], v[76:79], v[208:211]
    v_exp_f32 v215, v215
    v_mfma_f32_16x16x32_bf16 a[32:35], a[176:179], v[160:163], a[32:35]
    ds_read_b64_tr_b16 a[188:189], v23 offset:24576
    v_cvt_pk_bf16_f32 v152, v212, v213
    v_mfma_f32_16x16x32_bf16 a[32:35], a[180:183], v[164:167], a[32:35]
    ds_read_b64_tr_b16 a[190:191], v23 offset:28672
    v_mfma_f32_16x16x32_bf16 a[36:39], a[180:183], v[172:175], a[36:39]
    ds_read_b128 a[212:215], v9 offset:40960
    v_cvt_pk_bf16_f32 v153, v214, v215
    v_mfma_f32_16x16x32_bf16 a[36:39], a[176:179], v[168:171], a[36:39]
    v_smfmac_f32_16x16x64_bf16 a[196:199], v[52:55], v[168:175], v50
    v_mfma_f32_16x16x32_bf16 v[212:215], a[224:227], v[80:83], v[196:199]
    v_exp_f32 v208, v208
    v_mfma_f32_16x16x32_bf16 v[212:215], a[228:231], v[84:87], v[212:215]
    v_exp_f32 v209, v209
    v_mfma_f32_16x16x32_bf16 v[212:215], a[232:235], v[88:91], v[212:215]
    v_exp_f32 v210, v210
    v_mfma_f32_16x16x32_bf16 v[212:215], a[236:239], v[92:95], v[212:215]
    v_exp_f32 v211, v211
    v_mfma_f32_16x16x32_bf16 a[40:43], a[176:179], v[176:179], a[40:43]
    ds_read_b64_tr_b16 a[160:161], v24 offset:16384
    v_cvt_pk_bf16_f32 v130, v208, v209
    v_mfma_f32_16x16x32_bf16 a[40:43], a[180:183], v[180:183], a[40:43]
    ds_read_b64_tr_b16 a[162:163], v24 offset:20480
    v_mfma_f32_16x16x32_bf16 a[44:47], a[180:183], v[188:191], a[44:47]
    ds_read_b128 a[216:219], v10 offset:40960
    v_cvt_pk_bf16_f32 v131, v210, v211
    v_mfma_f32_16x16x32_bf16 a[44:47], a[176:179], v[184:187], a[44:47]
    s_waitcnt lgkmcnt(3)
    buffer_load_dwordx4 v41, s[12:15], s41 offen offset:1024 lds
    v_mfma_f32_16x16x32_bf16 v[208:211], a[224:227], v[96:99], v[200:203]
    v_exp_f32 v212, v212
    v_mfma_f32_16x16x32_bf16 v[208:211], a[228:231], v[100:103], v[208:211]
    v_exp_f32 v213, v213
    v_mfma_f32_16x16x32_bf16 v[208:211], a[232:235], v[104:107], v[208:211]
    v_exp_f32 v214, v214
    v_mfma_f32_16x16x32_bf16 v[208:211], a[236:239], v[108:111], v[208:211]
    v_exp_f32 v215, v215
    v_mfma_f32_16x16x32_bf16 a[48:51], a[184:187], v[160:163], a[48:51]
    ds_read_b64_tr_b16 a[164:165], v24 offset:24576
    v_cvt_pk_bf16_f32 v138, v212, v213
    v_mfma_f32_16x16x32_bf16 a[48:51], a[188:191], v[164:167], a[48:51]
    ds_read_b64_tr_b16 a[166:167], v24 offset:28672
    v_mfma_f32_16x16x32_bf16 a[52:55], a[188:191], v[172:175], a[52:55]
    ds_read_b128 a[220:223], v11 offset:40960
    v_cvt_pk_bf16_f32 v139, v214, v215
    v_mfma_f32_16x16x32_bf16 a[52:55], a[184:187], v[168:171], a[52:55]
    v_smfmac_f32_16x16x64_bf16 a[200:203], v[52:55], v[176:183], v50
    v_mfma_f32_16x16x32_bf16 v[212:215], a[224:227], v[112:115], v[204:207]
    v_exp_f32 v208, v208
    v_mfma_f32_16x16x32_bf16 v[212:215], a[228:231], v[116:119], v[212:215]
    v_exp_f32 v209, v209
    v_mfma_f32_16x16x32_bf16 v[212:215], a[232:235], v[120:123], v[212:215]
    v_exp_f32 v210, v210
    v_mfma_f32_16x16x32_bf16 v[212:215], a[236:239], v[124:127], v[212:215]
    v_exp_f32 v211, v211
    v_mfma_f32_16x16x32_bf16 a[56:59], a[184:187], v[176:179], a[56:59]
    ds_read_b64_tr_b16 a[168:169], v25 offset:16384
    v_cvt_pk_bf16_f32 v146, v208, v209
    v_mfma_f32_16x16x32_bf16 a[56:59], a[188:191], v[180:183], a[56:59]
    ds_read_b64_tr_b16 a[170:171], v25 offset:20480
    v_mfma_f32_16x16x32_bf16 a[60:63], a[188:191], v[188:191], a[60:63]
    ds_read_b128 a[224:227], v8 offset:45056
    v_cvt_pk_bf16_f32 v147, v210, v211
    v_mfma_f32_16x16x32_bf16 a[60:63], a[184:187], v[184:187], a[60:63]
    s_waitcnt lgkmcnt(3)
    buffer_load_dwordx4 v40, s[12:15], s41 offen offset:2048 lds
    v_mfma_f32_16x16x32_bf16 v[208:211], a[208:211], v[64:67], v[192:195]
    v_exp_f32 v212, v212
    v_mfma_f32_16x16x32_bf16 v[208:211], a[212:215], v[68:71], v[208:211]
    v_exp_f32 v213, v213
    v_mfma_f32_16x16x32_bf16 v[208:211], a[216:219], v[72:75], v[208:211]
    v_exp_f32 v214, v214
    v_mfma_f32_16x16x32_bf16 v[208:211], a[220:223], v[76:79], v[208:211]
    v_exp_f32 v215, v215
    v_mfma_f32_16x16x32_bf16 a[64:67], a[160:163], v[160:163], a[64:67]
    ds_read_b64_tr_b16 a[172:173], v25 offset:24576
    v_cvt_pk_bf16_f32 v154, v212, v213
    v_mfma_f32_16x16x32_bf16 a[64:67], a[164:167], v[164:167], a[64:67]
    ds_read_b64_tr_b16 a[174:175], v25 offset:28672
    v_mfma_f32_16x16x32_bf16 a[68:71], a[164:167], v[172:175], a[68:71]
    ds_read_b128 a[228:231], v9 offset:45056
    v_cvt_pk_bf16_f32 v155, v214, v215
    v_mfma_f32_16x16x32_bf16 a[68:71], a[160:163], v[168:171], a[68:71]
    v_smfmac_f32_16x16x64_bf16 a[204:207], v[52:55], v[184:191], v50
    v_mfma_f32_16x16x32_bf16 v[212:215], a[208:211], v[80:83], v[196:199]
    v_exp_f32 v208, v208
    v_mfma_f32_16x16x32_bf16 v[212:215], a[212:215], v[84:87], v[212:215]
    v_exp_f32 v209, v209
    v_mfma_f32_16x16x32_bf16 v[212:215], a[216:219], v[88:91], v[212:215]
    v_exp_f32 v210, v210
    v_mfma_f32_16x16x32_bf16 v[212:215], a[220:223], v[92:95], v[212:215]
    v_exp_f32 v211, v211
    v_mfma_f32_16x16x32_bf16 a[72:75], a[160:163], v[176:179], a[72:75]
    ds_read_b64_tr_b16 a[176:177], v26 offset:16384
    v_cvt_pk_bf16_f32 v132, v208, v209
    v_mfma_f32_16x16x32_bf16 a[72:75], a[164:167], v[180:183], a[72:75]
    ds_read_b64_tr_b16 a[178:179], v26 offset:20480
    v_mfma_f32_16x16x32_bf16 a[76:79], a[164:167], v[188:191], a[76:79]
    ds_read_b128 a[232:235], v10 offset:45056
    v_cvt_pk_bf16_f32 v133, v210, v211
    v_mfma_f32_16x16x32_bf16 a[76:79], a[160:163], v[184:187], a[76:79]
    s_waitcnt lgkmcnt(3)
    buffer_load_dwordx4 v41, s[12:15], s41 offen offset:3072 lds
    v_mfma_f32_16x16x32_bf16 v[208:211], a[208:211], v[96:99], v[200:203]
    v_exp_f32 v212, v212
    v_mfma_f32_16x16x32_bf16 v[208:211], a[212:215], v[100:103], v[208:211]
    s_add_u32 s41, s41, 16384
    v_exp_f32 v213, v213
    v_mfma_f32_16x16x32_bf16 v[208:211], a[216:219], v[104:107], v[208:211]
    v_exp_f32 v214, v214
    v_mfma_f32_16x16x32_bf16 v[208:211], a[220:223], v[108:111], v[208:211]
    v_exp_f32 v215, v215
    v_mfma_f32_16x16x32_bf16 a[80:83], a[168:171], v[160:163], a[80:83]
    ds_read_b64_tr_b16 a[180:181], v26 offset:24576
    v_cvt_pk_bf16_f32 v140, v212, v213
    v_mfma_f32_16x16x32_bf16 a[80:83], a[172:175], v[164:167], a[80:83]
    ds_read_b64_tr_b16 a[182:183], v26 offset:28672
    v_mfma_f32_16x16x32_bf16 a[84:87], a[172:175], v[172:175], a[84:87]
    ds_read_b128 a[236:239], v11 offset:45056
    v_cvt_pk_bf16_f32 v141, v214, v215
    v_mfma_f32_16x16x32_bf16 a[84:87], a[168:171], v[168:171], a[84:87]
    s_waitcnt vmcnt(9)
    s_barrier
    v_mfma_f32_16x16x32_bf16 v[212:215], a[208:211], v[112:115], v[204:207]
    v_exp_f32 v208, v208
    v_mfma_f32_16x16x32_bf16 v[212:215], a[212:215], v[116:119], v[212:215]
    s_add_u32 m0, s42, 16384
    v_exp_f32 v209, v209
    v_mfma_f32_16x16x32_bf16 v[212:215], a[216:219], v[120:123], v[212:215]
    v_exp_f32 v210, v210
    v_mfma_f32_16x16x32_bf16 v[212:215], a[220:223], v[124:127], v[212:215]
    v_exp_f32 v211, v211
    v_mfma_f32_16x16x32_bf16 a[88:91], a[168:171], v[176:179], a[88:91]
    ds_read_b64_tr_b16 a[184:185], v27 offset:16384
    v_cvt_pk_bf16_f32 v148, v208, v209
    v_mfma_f32_16x16x32_bf16 a[88:91], a[172:175], v[180:183], a[88:91]
    ds_read_b64_tr_b16 a[186:187], v27 offset:20480
    v_mfma_f32_16x16x32_bf16 a[92:95], a[172:175], v[188:191], a[92:95]
    ds_read_b128 a[208:211], v8 offset:49152
    v_cvt_pk_bf16_f32 v149, v210, v211
    v_mfma_f32_16x16x32_bf16 a[92:95], a[168:171], v[184:187], a[92:95]
    s_waitcnt lgkmcnt(3)
    buffer_load_dwordx4 v36, s[8:11], s40 offen lds
    v_mfma_f32_16x16x32_bf16 v[208:211], a[224:227], v[64:67], v[192:195]
    v_exp_f32 v212, v212
    v_mfma_f32_16x16x32_bf16 v[208:211], a[228:231], v[68:71], v[208:211]
    v_exp_f32 v213, v213
    v_mfma_f32_16x16x32_bf16 v[208:211], a[232:235], v[72:75], v[208:211]
    v_exp_f32 v214, v214
    v_mfma_f32_16x16x32_bf16 v[208:211], a[236:239], v[76:79], v[208:211]
    v_exp_f32 v215, v215
    v_mfma_f32_16x16x32_bf16 a[96:99], a[176:179], v[160:163], a[96:99]
    ds_read_b64_tr_b16 a[188:189], v27 offset:24576
    v_cvt_pk_bf16_f32 v156, v212, v213
    v_mfma_f32_16x16x32_bf16 a[96:99], a[180:183], v[164:167], a[96:99]
    ds_read_b64_tr_b16 a[190:191], v27 offset:28672
    v_mfma_f32_16x16x32_bf16 a[100:103], a[180:183], v[172:175], a[100:103]
    ds_read_b128 a[212:215], v9 offset:49152
    v_cvt_pk_bf16_f32 v157, v214, v215
    v_mfma_f32_16x16x32_bf16 a[100:103], a[176:179], v[168:171], a[100:103]
    buffer_load_dword v218, v57, s[80:83], s39 offen
    v_mfma_f32_16x16x32_bf16 v[212:215], a[224:227], v[80:83], v[196:199]
    v_exp_f32 v208, v208
    v_mfma_f32_16x16x32_bf16 v[212:215], a[228:231], v[84:87], v[212:215]
    v_exp_f32 v209, v209
    v_mfma_f32_16x16x32_bf16 v[212:215], a[232:235], v[88:91], v[212:215]
    v_exp_f32 v210, v210
    v_mfma_f32_16x16x32_bf16 v[212:215], a[236:239], v[92:95], v[212:215]
    v_exp_f32 v211, v211
    v_mfma_f32_16x16x32_bf16 a[104:107], a[176:179], v[176:179], a[104:107]
    ds_read_b64_tr_b16 a[160:161], v20 offset:32768
    v_cvt_pk_bf16_f32 v134, v208, v209
    v_mfma_f32_16x16x32_bf16 a[104:107], a[180:183], v[180:183], a[104:107]
    ds_read_b64_tr_b16 a[162:163], v20 offset:36864
    v_mfma_f32_16x16x32_bf16 a[108:111], a[180:183], v[188:191], a[108:111]
    ds_read_b128 a[216:219], v10 offset:49152
    v_cvt_pk_bf16_f32 v135, v210, v211
    v_mfma_f32_16x16x32_bf16 a[108:111], a[176:179], v[184:187], a[108:111]
    s_waitcnt lgkmcnt(3)
    buffer_load_dwordx4 v37, s[8:11], s40 offen offset:1024 lds
    v_mfma_f32_16x16x32_bf16 v[208:211], a[224:227], v[96:99], v[200:203]
    v_exp_f32 v212, v212
    v_mfma_f32_16x16x32_bf16 v[208:211], a[228:231], v[100:103], v[208:211]
    v_exp_f32 v213, v213
    v_mfma_f32_16x16x32_bf16 v[208:211], a[232:235], v[104:107], v[208:211]
    v_exp_f32 v214, v214
    v_mfma_f32_16x16x32_bf16 v[208:211], a[236:239], v[108:111], v[208:211]
    v_exp_f32 v215, v215
    v_mfma_f32_16x16x32_bf16 a[112:115], a[184:187], v[160:163], a[112:115]
    ds_read_b64_tr_b16 a[164:165], v20 offset:40960
    v_cvt_pk_bf16_f32 v142, v212, v213
    v_mfma_f32_16x16x32_bf16 a[112:115], a[188:191], v[164:167], a[112:115]
    ds_read_b64_tr_b16 a[166:167], v20 offset:45056
    v_mfma_f32_16x16x32_bf16 a[116:119], a[188:191], v[172:175], a[116:119]
    ds_read_b128 a[220:223], v11 offset:49152
    v_cvt_pk_bf16_f32 v143, v214, v215
    v_mfma_f32_16x16x32_bf16 a[116:119], a[184:187], v[168:171], a[116:119]
    buffer_store_dwordx4 v[248:251], v232, s[24:27], s53 offen sc1
    v_mfma_f32_16x16x32_bf16 v[212:215], a[224:227], v[112:115], v[204:207]
    v_exp_f32 v208, v208
    v_mfma_f32_16x16x32_bf16 v[212:215], a[228:231], v[116:119], v[212:215]
    v_exp_f32 v209, v209
    v_mfma_f32_16x16x32_bf16 v[212:215], a[232:235], v[120:123], v[212:215]
    v_exp_f32 v210, v210
    v_mfma_f32_16x16x32_bf16 v[212:215], a[236:239], v[124:127], v[212:215]
    s_add_u32 s53, s53, 656
    v_exp_f32 v211, v211
    v_mfma_f32_16x16x32_bf16 a[120:123], a[184:187], v[176:179], a[120:123]
    ds_read_b64_tr_b16 a[168:169], v21 offset:32768
    v_cvt_pk_bf16_f32 v150, v208, v209
    v_mfma_f32_16x16x32_bf16 a[120:123], a[188:191], v[180:183], a[120:123]
    ds_read_b64_tr_b16 a[170:171], v21 offset:36864
    v_mfma_f32_16x16x32_bf16 a[124:127], a[188:191], v[188:191], a[124:127]
    ds_read_b128 a[224:227], v8 offset:53248
    v_cvt_pk_bf16_f32 v151, v210, v211
    v_mfma_f32_16x16x32_bf16 a[124:127], a[184:187], v[184:187], a[124:127]
    s_waitcnt lgkmcnt(3)
    buffer_load_dwordx4 v38, s[8:11], s40 offen offset:2048 lds
    v_mfma_f32_16x16x32_bf16 v[208:211], a[208:211], v[64:67], v[192:195]
    v_exp_f32 v212, v212
    v_mfma_f32_16x16x32_bf16 v[208:211], a[212:215], v[68:71], v[208:211]
    v_exp_f32 v213, v213
    v_mfma_f32_16x16x32_bf16 v[208:211], a[216:219], v[72:75], v[208:211]
    v_exp_f32 v214, v214
    v_mfma_f32_16x16x32_bf16 v[208:211], a[220:223], v[76:79], v[208:211]
    v_exp_f32 v215, v215
    v_mfma_f32_16x16x32_bf16 a[0:3], a[160:163], v[128:131], a[0:3]
    ds_read_b64_tr_b16 a[172:173], v21 offset:40960
    v_cvt_pk_bf16_f32 v158, v212, v213
    v_mfma_f32_16x16x32_bf16 a[0:3], a[164:167], v[132:135], a[0:3]
    ds_read_b64_tr_b16 a[174:175], v21 offset:45056
    v_mfma_f32_16x16x32_bf16 a[4:7], a[164:167], v[140:143], a[4:7]
    ds_read_b128 a[228:231], v9 offset:53248
    v_cvt_pk_bf16_f32 v159, v214, v215
    v_mfma_f32_16x16x32_bf16 a[4:7], a[160:163], v[136:139], a[4:7]
    v_mfma_f32_16x16x32_bf16 v[212:215], a[208:211], v[80:83], v[196:199]
    v_exp_f32 v208, v208
    v_mfma_f32_16x16x32_bf16 v[212:215], a[212:215], v[84:87], v[212:215]
    v_exp_f32 v209, v209
    v_mfma_f32_16x16x32_bf16 v[212:215], a[216:219], v[88:91], v[212:215]
    v_exp_f32 v210, v210
    v_mfma_f32_16x16x32_bf16 v[212:215], a[220:223], v[92:95], v[212:215]
    v_exp_f32 v211, v211
    v_mfma_f32_16x16x32_bf16 a[8:11], a[160:163], v[144:147], a[8:11]
    ds_read_b64_tr_b16 a[176:177], v22 offset:32768
    v_cvt_pk_bf16_f32 v160, v208, v209
    v_mfma_f32_16x16x32_bf16 a[8:11], a[164:167], v[148:151], a[8:11]
    ds_read_b64_tr_b16 a[178:179], v22 offset:36864
    v_mfma_f32_16x16x32_bf16 a[12:15], a[164:167], v[156:159], a[12:15]
    ds_read_b128 a[232:235], v10 offset:53248
    v_cvt_pk_bf16_f32 v161, v210, v211
    v_mfma_f32_16x16x32_bf16 a[12:15], a[160:163], v[152:155], a[12:15]
    s_waitcnt lgkmcnt(3)
    buffer_load_dwordx4 v39, s[8:11], s40 offen offset:3072 lds
    v_mfma_f32_16x16x32_bf16 v[208:211], a[208:211], v[96:99], v[200:203]
    v_exp_f32 v212, v212
    v_mfma_f32_16x16x32_bf16 v[208:211], a[212:215], v[100:103], v[208:211]
    s_add_u32 s40, s40, 16384
    v_exp_f32 v213, v213
    v_mfma_f32_16x16x32_bf16 v[208:211], a[216:219], v[104:107], v[208:211]
    v_exp_f32 v214, v214
    v_mfma_f32_16x16x32_bf16 v[208:211], a[220:223], v[108:111], v[208:211]
    v_exp_f32 v215, v215
    v_mfma_f32_16x16x32_bf16 a[16:19], a[168:171], v[128:131], a[16:19]
    ds_read_b64_tr_b16 a[180:181], v22 offset:40960
    v_cvt_pk_bf16_f32 v168, v212, v213
    v_mfma_f32_16x16x32_bf16 a[16:19], a[172:175], v[132:135], a[16:19]
    ds_read_b64_tr_b16 a[182:183], v22 offset:45056
    v_mfma_f32_16x16x32_bf16 a[20:23], a[172:175], v[140:143], a[20:23]
    ds_read_b128 a[236:239], v11 offset:53248
    v_cvt_pk_bf16_f32 v169, v214, v215
    v_mfma_f32_16x16x32_bf16 a[20:23], a[168:171], v[136:139], a[20:23]
    v_smfmac_f32_16x16x64_bf16 a[192:195], v[52:55], v[128:135], v50
    v_mfma_f32_16x16x32_bf16 v[212:215], a[208:211], v[112:115], v[204:207]
    v_exp_f32 v208, v208
    v_mfma_f32_16x16x32_bf16 v[212:215], a[212:215], v[116:119], v[212:215]
    s_add_u32 m0, s42, 65536
    v_exp_f32 v209, v209
    v_mfma_f32_16x16x32_bf16 v[212:215], a[216:219], v[120:123], v[212:215]
    v_exp_f32 v210, v210
    v_mfma_f32_16x16x32_bf16 v[212:215], a[220:223], v[124:127], v[212:215]
    v_exp_f32 v211, v211
    v_mfma_f32_16x16x32_bf16 a[24:27], a[168:171], v[144:147], a[24:27]
    ds_read_b64_tr_b16 a[184:185], v23 offset:32768
    v_cvt_pk_bf16_f32 v176, v208, v209
    v_mfma_f32_16x16x32_bf16 a[24:27], a[172:175], v[148:151], a[24:27]
    ds_read_b64_tr_b16 a[186:187], v23 offset:36864
    v_mfma_f32_16x16x32_bf16 a[28:31], a[172:175], v[156:159], a[28:31]
    ds_read_b128 a[208:211], v8 offset:57344
    v_cvt_pk_bf16_f32 v177, v210, v211
    v_mfma_f32_16x16x32_bf16 a[28:31], a[168:171], v[152:155], a[28:31]
    s_waitcnt lgkmcnt(3)
    buffer_load_dwordx4 v40, s[12:15], s41 offen lds
    v_mfma_f32_16x16x32_bf16 v[208:211], a[224:227], v[64:67], v[192:195]
    v_exp_f32 v212, v212
    v_mfma_f32_16x16x32_bf16 v[208:211], a[228:231], v[68:71], v[208:211]
    v_exp_f32 v213, v213
    v_mfma_f32_16x16x32_bf16 v[208:211], a[232:235], v[72:75], v[208:211]
    v_exp_f32 v214, v214
    v_mfma_f32_16x16x32_bf16 v[208:211], a[236:239], v[76:79], v[208:211]
    v_exp_f32 v215, v215
    v_mfma_f32_16x16x32_bf16 a[32:35], a[176:179], v[128:131], a[32:35]
    ds_read_b64_tr_b16 a[188:189], v23 offset:40960
    v_cvt_pk_bf16_f32 v184, v212, v213
    v_mfma_f32_16x16x32_bf16 a[32:35], a[180:183], v[132:135], a[32:35]
    ds_read_b64_tr_b16 a[190:191], v23 offset:45056
    v_mfma_f32_16x16x32_bf16 a[36:39], a[180:183], v[140:143], a[36:39]
    ds_read_b128 a[212:215], v9 offset:57344
    v_cvt_pk_bf16_f32 v185, v214, v215
    v_mfma_f32_16x16x32_bf16 a[36:39], a[176:179], v[136:139], a[36:39]
    v_smfmac_f32_16x16x64_bf16 a[196:199], v[52:55], v[136:143], v50
    v_mfma_f32_16x16x32_bf16 v[212:215], a[224:227], v[80:83], v[196:199]
    v_exp_f32 v208, v208
    v_mfma_f32_16x16x32_bf16 v[212:215], a[228:231], v[84:87], v[212:215]
    v_exp_f32 v209, v209
    v_mfma_f32_16x16x32_bf16 v[212:215], a[232:235], v[88:91], v[212:215]
    v_exp_f32 v210, v210
    v_mfma_f32_16x16x32_bf16 v[212:215], a[236:239], v[92:95], v[212:215]
    v_exp_f32 v211, v211
    v_mfma_f32_16x16x32_bf16 a[40:43], a[176:179], v[144:147], a[40:43]
    ds_read_b64_tr_b16 a[160:161], v24 offset:32768
    v_cvt_pk_bf16_f32 v162, v208, v209
    v_mfma_f32_16x16x32_bf16 a[40:43], a[180:183], v[148:151], a[40:43]
    ds_read_b64_tr_b16 a[162:163], v24 offset:36864
    v_mfma_f32_16x16x32_bf16 a[44:47], a[180:183], v[156:159], a[44:47]
    ds_read_b128 a[216:219], v10 offset:57344
    v_cvt_pk_bf16_f32 v163, v210, v211
    v_mfma_f32_16x16x32_bf16 a[44:47], a[176:179], v[152:155], a[44:47]
    s_waitcnt lgkmcnt(3)
    buffer_load_dwordx4 v41, s[12:15], s41 offen offset:1024 lds
    v_mfma_f32_16x16x32_bf16 v[208:211], a[224:227], v[96:99], v[200:203]
    v_exp_f32 v212, v212
    v_mfma_f32_16x16x32_bf16 v[208:211], a[228:231], v[100:103], v[208:211]
    v_exp_f32 v213, v213
    v_mfma_f32_16x16x32_bf16 v[208:211], a[232:235], v[104:107], v[208:211]
    v_exp_f32 v214, v214
    v_mfma_f32_16x16x32_bf16 v[208:211], a[236:239], v[108:111], v[208:211]
    v_exp_f32 v215, v215
    v_mfma_f32_16x16x32_bf16 a[48:51], a[184:187], v[128:131], a[48:51]
    ds_read_b64_tr_b16 a[164:165], v24 offset:40960
    v_cvt_pk_bf16_f32 v170, v212, v213
    v_mfma_f32_16x16x32_bf16 a[48:51], a[188:191], v[132:135], a[48:51]
    ds_read_b64_tr_b16 a[166:167], v24 offset:45056
    v_mfma_f32_16x16x32_bf16 a[52:55], a[188:191], v[140:143], a[52:55]
    ds_read_b128 a[220:223], v11 offset:57344
    v_cvt_pk_bf16_f32 v171, v214, v215
    v_mfma_f32_16x16x32_bf16 a[52:55], a[184:187], v[136:139], a[52:55]
    v_smfmac_f32_16x16x64_bf16 a[200:203], v[52:55], v[144:151], v50
    v_mfma_f32_16x16x32_bf16 v[212:215], a[224:227], v[112:115], v[204:207]
    v_exp_f32 v208, v208
    v_mfma_f32_16x16x32_bf16 v[212:215], a[228:231], v[116:119], v[212:215]
    v_exp_f32 v209, v209
    v_mfma_f32_16x16x32_bf16 v[212:215], a[232:235], v[120:123], v[212:215]
    v_exp_f32 v210, v210
    v_mfma_f32_16x16x32_bf16 v[212:215], a[236:239], v[124:127], v[212:215]
    v_exp_f32 v211, v211
    v_mfma_f32_16x16x32_bf16 a[56:59], a[184:187], v[144:147], a[56:59]
    ds_read_b64_tr_b16 a[168:169], v25 offset:32768
    v_cvt_pk_bf16_f32 v178, v208, v209
    v_mfma_f32_16x16x32_bf16 a[56:59], a[188:191], v[148:151], a[56:59]
    ds_read_b64_tr_b16 a[170:171], v25 offset:36864
    v_mfma_f32_16x16x32_bf16 a[60:63], a[188:191], v[156:159], a[60:63]
    ds_read_b128 a[224:227], v8 offset:61440
    v_cvt_pk_bf16_f32 v179, v210, v211
    v_mfma_f32_16x16x32_bf16 a[60:63], a[184:187], v[152:155], a[60:63]
    s_waitcnt lgkmcnt(3)
    buffer_load_dwordx4 v40, s[12:15], s41 offen offset:2048 lds
    v_mfma_f32_16x16x32_bf16 v[208:211], a[208:211], v[64:67], v[192:195]
    v_exp_f32 v212, v212
    v_mfma_f32_16x16x32_bf16 v[208:211], a[212:215], v[68:71], v[208:211]
    v_exp_f32 v213, v213
    v_mfma_f32_16x16x32_bf16 v[208:211], a[216:219], v[72:75], v[208:211]
    v_exp_f32 v214, v214
    v_mfma_f32_16x16x32_bf16 v[208:211], a[220:223], v[76:79], v[208:211]
    v_exp_f32 v215, v215
    v_mfma_f32_16x16x32_bf16 a[64:67], a[160:163], v[128:131], a[64:67]
    ds_read_b64_tr_b16 a[172:173], v25 offset:40960
    v_cvt_pk_bf16_f32 v186, v212, v213
    v_mfma_f32_16x16x32_bf16 a[64:67], a[164:167], v[132:135], a[64:67]
    ds_read_b64_tr_b16 a[174:175], v25 offset:45056
    v_mfma_f32_16x16x32_bf16 a[68:71], a[164:167], v[140:143], a[68:71]
    ds_read_b128 a[228:231], v9 offset:61440
    v_cvt_pk_bf16_f32 v187, v214, v215
    v_mfma_f32_16x16x32_bf16 a[68:71], a[160:163], v[136:139], a[68:71]
    v_smfmac_f32_16x16x64_bf16 a[204:207], v[52:55], v[152:159], v50
    v_mfma_f32_16x16x32_bf16 v[212:215], a[208:211], v[80:83], v[196:199]
    v_exp_f32 v208, v208
    v_mfma_f32_16x16x32_bf16 v[212:215], a[212:215], v[84:87], v[212:215]
    v_exp_f32 v209, v209
    v_mfma_f32_16x16x32_bf16 v[212:215], a[216:219], v[88:91], v[212:215]
    v_exp_f32 v210, v210
    v_mfma_f32_16x16x32_bf16 v[212:215], a[220:223], v[92:95], v[212:215]
    v_exp_f32 v211, v211
    v_mfma_f32_16x16x32_bf16 a[72:75], a[160:163], v[144:147], a[72:75]
    ds_read_b64_tr_b16 a[176:177], v26 offset:32768
    v_cvt_pk_bf16_f32 v164, v208, v209
    v_mfma_f32_16x16x32_bf16 a[72:75], a[164:167], v[148:151], a[72:75]
    ds_read_b64_tr_b16 a[178:179], v26 offset:36864
    v_mfma_f32_16x16x32_bf16 a[76:79], a[164:167], v[156:159], a[76:79]
    ds_read_b128 a[232:235], v10 offset:61440
    v_cvt_pk_bf16_f32 v165, v210, v211
    v_mfma_f32_16x16x32_bf16 a[76:79], a[160:163], v[152:155], a[76:79]
    s_waitcnt lgkmcnt(3)
    buffer_load_dwordx4 v41, s[12:15], s41 offen offset:3072 lds
    v_mfma_f32_16x16x32_bf16 v[208:211], a[208:211], v[96:99], v[200:203]
    v_exp_f32 v212, v212
    v_mfma_f32_16x16x32_bf16 v[208:211], a[212:215], v[100:103], v[208:211]
    s_add_u32 s41, s41, 16384
    v_exp_f32 v213, v213
    v_mfma_f32_16x16x32_bf16 v[208:211], a[216:219], v[104:107], v[208:211]
    v_exp_f32 v214, v214
    v_mfma_f32_16x16x32_bf16 v[208:211], a[220:223], v[108:111], v[208:211]
    v_exp_f32 v215, v215
    v_mfma_f32_16x16x32_bf16 a[80:83], a[168:171], v[128:131], a[80:83]
    ds_read_b64_tr_b16 a[180:181], v26 offset:40960
    v_cvt_pk_bf16_f32 v172, v212, v213
    v_mfma_f32_16x16x32_bf16 a[80:83], a[172:175], v[132:135], a[80:83]
    ds_read_b64_tr_b16 a[182:183], v26 offset:45056
    v_mfma_f32_16x16x32_bf16 a[84:87], a[172:175], v[140:143], a[84:87]
    ds_read_b128 a[236:239], v11 offset:61440
    v_cvt_pk_bf16_f32 v173, v214, v215
    v_mfma_f32_16x16x32_bf16 a[84:87], a[168:171], v[136:139], a[84:87]
    s_waitcnt vmcnt(10)
    s_barrier
    v_mfma_f32_16x16x32_bf16 v[212:215], a[208:211], v[112:115], v[204:207]
    v_exp_f32 v208, v208
    v_mfma_f32_16x16x32_bf16 v[212:215], a[212:215], v[116:119], v[212:215]
    s_add_u32 m0, s42, 32768
    v_exp_f32 v209, v209
    v_mfma_f32_16x16x32_bf16 v[212:215], a[216:219], v[120:123], v[212:215]
    v_exp_f32 v210, v210
    v_mfma_f32_16x16x32_bf16 v[212:215], a[220:223], v[124:127], v[212:215]
    v_exp_f32 v211, v211
    v_mfma_f32_16x16x32_bf16 a[88:91], a[168:171], v[144:147], a[88:91]
    ds_read_b64_tr_b16 a[184:185], v27 offset:32768
    v_cvt_pk_bf16_f32 v180, v208, v209
    v_mfma_f32_16x16x32_bf16 a[88:91], a[172:175], v[148:151], a[88:91]
    ds_read_b64_tr_b16 a[186:187], v27 offset:36864
    v_mfma_f32_16x16x32_bf16 a[92:95], a[172:175], v[156:159], a[92:95]
    ds_read_b128 a[208:211], v8 offset:0
    v_cvt_pk_bf16_f32 v181, v210, v211
    v_mfma_f32_16x16x32_bf16 a[92:95], a[168:171], v[152:155], a[92:95]
    s_waitcnt lgkmcnt(3)
    buffer_load_dwordx4 v36, s[8:11], s40 offen lds
    v_mfma_f32_16x16x32_bf16 v[208:211], a[224:227], v[64:67], v[192:195]
    v_exp_f32 v212, v212
    v_mfma_f32_16x16x32_bf16 v[208:211], a[228:231], v[68:71], v[208:211]
    v_exp_f32 v213, v213
    v_mfma_f32_16x16x32_bf16 v[208:211], a[232:235], v[72:75], v[208:211]
    v_exp_f32 v214, v214
    v_mfma_f32_16x16x32_bf16 v[208:211], a[236:239], v[76:79], v[208:211]
    v_exp_f32 v215, v215
    v_mfma_f32_16x16x32_bf16 a[96:99], a[176:179], v[128:131], a[96:99]
    ds_read_b64_tr_b16 a[188:189], v27 offset:40960
    v_cvt_pk_bf16_f32 v188, v212, v213
    v_mfma_f32_16x16x32_bf16 a[96:99], a[180:183], v[132:135], a[96:99]
    ds_read_b64_tr_b16 a[190:191], v27 offset:45056
    v_mfma_f32_16x16x32_bf16 a[100:103], a[180:183], v[140:143], a[100:103]
    ds_read_b128 a[212:215], v9 offset:0
    v_cvt_pk_bf16_f32 v189, v214, v215
    v_mfma_f32_16x16x32_bf16 a[100:103], a[176:179], v[136:139], a[100:103]
    buffer_load_dword v219, v62, s[84:87], s38 offen
    v_mfma_f32_16x16x32_bf16 v[212:215], a[224:227], v[80:83], v[196:199]
    v_exp_f32 v208, v208
    v_mfma_f32_16x16x32_bf16 v[212:215], a[228:231], v[84:87], v[212:215]
    v_exp_f32 v209, v209
    v_mfma_f32_16x16x32_bf16 v[212:215], a[232:235], v[88:91], v[212:215]
    v_exp_f32 v210, v210
    v_mfma_f32_16x16x32_bf16 v[212:215], a[236:239], v[92:95], v[212:215]
    v_exp_f32 v211, v211
    v_mfma_f32_16x16x32_bf16 a[104:107], a[176:179], v[144:147], a[104:107]
    ds_read_b64_tr_b16 a[160:161], v20 offset:49152
    v_cvt_pk_bf16_f32 v166, v208, v209
    v_mfma_f32_16x16x32_bf16 a[104:107], a[180:183], v[148:151], a[104:107]
    ds_read_b64_tr_b16 a[162:163], v20 offset:53248
    v_mfma_f32_16x16x32_bf16 a[108:111], a[180:183], v[156:159], a[108:111]
    ds_read_b128 a[216:219], v10 offset:0
    v_cvt_pk_bf16_f32 v167, v210, v211
    v_mfma_f32_16x16x32_bf16 a[108:111], a[176:179], v[152:155], a[108:111]
    s_waitcnt lgkmcnt(3)
    buffer_load_dwordx4 v37, s[8:11], s40 offen offset:1024 lds
    v_mfma_f32_16x16x32_bf16 v[208:211], a[224:227], v[96:99], v[200:203]
    v_exp_f32 v212, v212
    v_mfma_f32_16x16x32_bf16 v[208:211], a[228:231], v[100:103], v[208:211]
    v_exp_f32 v213, v213
    v_mfma_f32_16x16x32_bf16 v[208:211], a[232:235], v[104:107], v[208:211]
    v_exp_f32 v214, v214
    v_mfma_f32_16x16x32_bf16 v[208:211], a[236:239], v[108:111], v[208:211]
    v_exp_f32 v215, v215
    v_mfma_f32_16x16x32_bf16 a[112:115], a[184:187], v[128:131], a[112:115]
    ds_read_b64_tr_b16 a[164:165], v20 offset:57344
    v_cvt_pk_bf16_f32 v174, v212, v213
    v_mfma_f32_16x16x32_bf16 a[112:115], a[188:191], v[132:135], a[112:115]
    ds_read_b64_tr_b16 a[166:167], v20 offset:61440
    v_mfma_f32_16x16x32_bf16 a[116:119], a[188:191], v[140:143], a[116:119]
    ds_read_b128 a[220:223], v11 offset:0
    v_cvt_pk_bf16_f32 v175, v214, v215
    v_mfma_f32_16x16x32_bf16 a[116:119], a[184:187], v[136:139], a[116:119]
    buffer_load_dword v221, v235, s[20:23], 0 offen
    v_mfma_f32_16x16x32_bf16 v[212:215], a[224:227], v[112:115], v[204:207]
    v_exp_f32 v208, v208
    v_mfma_f32_16x16x32_bf16 v[212:215], a[228:231], v[116:119], v[212:215]
    v_exp_f32 v209, v209
    v_mfma_f32_16x16x32_bf16 v[212:215], a[232:235], v[120:123], v[212:215]
    v_exp_f32 v210, v210
    v_mfma_f32_16x16x32_bf16 v[212:215], a[236:239], v[124:127], v[212:215]
    v_exp_f32 v211, v211
    v_mfma_f32_16x16x32_bf16 a[120:123], a[184:187], v[144:147], a[120:123]
Ltour5:
    s_cbranch_execz Ltour9
    ds_read_b64_tr_b16 a[168:169], v21 offset:49152
    v_cvt_pk_bf16_f32 v182, v208, v209
    v_mfma_f32_16x16x32_bf16 a[120:123], a[188:191], v[148:151], a[120:123]
    ds_read_b64_tr_b16 a[170:171], v21 offset:53248
    v_add_u32 v235, 2560, v235
    v_mfma_f32_16x16x32_bf16 a[124:127], a[188:191], v[156:159], a[124:127]
    ds_read_b128 a[224:227], v8 offset:4096
    v_cvt_pk_bf16_f32 v183, v210, v211
    v_mfma_f32_16x16x32_bf16 a[124:127], a[184:187], v[152:155], a[124:127]
    s_waitcnt lgkmcnt(3)
    buffer_load_dwordx4 v38, s[8:11], s40 offen offset:2048 lds
    v_mfma_f32_16x16x32_bf16 v[208:211], a[208:211], v[64:67], v[192:195]
    v_exp_f32 v212, v212
    v_mfma_f32_16x16x32_bf16 v[208:211], a[212:215], v[68:71], v[208:211]
    v_exp_f32 v213, v213
    v_mfma_f32_16x16x32_bf16 v[208:211], a[216:219], v[72:75], v[208:211]
    v_exp_f32 v214, v214
    v_mfma_f32_16x16x32_bf16 v[208:211], a[220:223], v[76:79], v[208:211]
    v_exp_f32 v215, v215
    v_mfma_f32_16x16x32_bf16 a[0:3], a[160:163], v[160:163], a[0:3]
    ds_read_b64_tr_b16 a[172:173], v21 offset:57344
    v_cvt_pk_bf16_f32 v190, v212, v213
    v_mfma_f32_16x16x32_bf16 a[0:3], a[164:167], v[164:167], a[0:3]
    ds_read_b64_tr_b16 a[174:175], v21 offset:61440
    v_lshlrev_b32 v244, 16, v240
    v_mfma_f32_16x16x32_bf16 a[4:7], a[164:167], v[172:175], a[4:7]
    ds_read_b128 a[228:231], v9 offset:4096
    v_cvt_pk_bf16_f32 v191, v214, v215
    v_mfma_f32_16x16x32_bf16 a[4:7], a[160:163], v[168:171], a[4:7]
    v_and_b32 v245, 0xffff0000, v240
    v_fmac_f32 v224, v2, v244
    v_mfma_f32_16x16x32_bf16 v[212:215], a[208:211], v[80:83], v[196:199]
    v_exp_f32 v208, v208
    v_mfma_f32_16x16x32_bf16 v[212:215], a[212:215], v[84:87], v[212:215]
    v_exp_f32 v209, v209
    v_mfma_f32_16x16x32_bf16 v[212:215], a[216:219], v[88:91], v[212:215]
    v_exp_f32 v210, v210
    v_mfma_f32_16x16x32_bf16 v[212:215], a[220:223], v[92:95], v[212:215]
    v_exp_f32 v211, v211
    v_mfma_f32_16x16x32_bf16 a[8:11], a[160:163], v[176:179], a[8:11]
    ds_read_b64_tr_b16 a[176:177], v22 offset:49152
    v_cvt_pk_bf16_f32 v128, v208, v209
    v_mfma_f32_16x16x32_bf16 a[8:11], a[164:167], v[180:183], a[8:11]
    ds_read_b64_tr_b16 a[178:179], v22 offset:53248
    v_fmac_f32 v225, v2, v245
    v_mfma_f32_16x16x32_bf16 a[12:15], a[164:167], v[188:191], a[12:15]
    ds_read_b128 a[232:235], v10 offset:4096
    v_cvt_pk_bf16_f32 v129, v210, v211
    v_mfma_f32_16x16x32_bf16 a[12:15], a[160:163], v[184:187], a[12:15]
    s_waitcnt lgkmcnt(3)
    buffer_load_dwordx4 v39, s[8:11], s40 offen offset:3072 lds
    v_mfma_f32_16x16x32_bf16 v[208:211], a[208:211], v[96:99], v[200:203]
    v_exp_f32 v212, v212
    v_mfma_f32_16x16x32_bf16 v[208:211], a[212:215], v[100:103], v[208:211]
    s_add_u32 s40, s40, 16384
    v_exp_f32 v213, v213
    v_mfma_f32_16x16x32_bf16 v[208:211], a[216:219], v[104:107], v[208:211]
    v_exp_f32 v214, v214
    v_mfma_f32_16x16x32_bf16 v[208:211], a[220:223], v[108:111], v[208:211]
    v_exp_f32 v215, v215
    v_mfma_f32_16x16x32_bf16 a[16:19], a[168:171], v[160:163], a[16:19]
    ds_read_b64_tr_b16 a[180:181], v22 offset:57344
    v_cvt_pk_bf16_f32 v136, v212, v213
    v_mfma_f32_16x16x32_bf16 a[16:19], a[172:175], v[164:167], a[16:19]
    ds_read_b64_tr_b16 a[182:183], v22 offset:61440
    v_lshlrev_b32 v246, 16, v241
    v_mfma_f32_16x16x32_bf16 a[20:23], a[172:175], v[172:175], a[20:23]
    ds_read_b128 a[236:239], v11 offset:4096
    v_cvt_pk_bf16_f32 v137, v214, v215
    v_mfma_f32_16x16x32_bf16 a[20:23], a[168:171], v[168:171], a[20:23]
    v_and_b32 v247, 0xffff0000, v241
    v_fmac_f32 v226, v2, v246
    v_smfmac_f32_16x16x64_bf16 a[192:195], v[52:55], v[160:167], v50
    v_mfma_f32_16x16x32_bf16 v[212:215], a[208:211], v[112:115], v[204:207]
    v_exp_f32 v208, v208
    v_mfma_f32_16x16x32_bf16 v[212:215], a[212:215], v[116:119], v[212:215]
    s_add_u32 m0, s42, 81920
    v_exp_f32 v209, v209
    v_mfma_f32_16x16x32_bf16 v[212:215], a[216:219], v[120:123], v[212:215]
    v_exp_f32 v210, v210
    v_mfma_f32_16x16x32_bf16 v[212:215], a[220:223], v[124:127], v[212:215]
    v_exp_f32 v211, v211
    v_mfma_f32_16x16x32_bf16 a[24:27], a[168:171], v[176:179], a[24:27]
    ds_read_b64_tr_b16 a[184:185], v23 offset:49152
    v_cvt_pk_bf16_f32 v144, v208, v209
    v_mfma_f32_16x16x32_bf16 a[24:27], a[172:175], v[180:183], a[24:27]
    ds_read_b64_tr_b16 a[186:187], v23 offset:53248
    v_fmac_f32 v227, v2, v247
    v_mfma_f32_16x16x32_bf16 a[28:31], a[172:175], v[188:191], a[28:31]
    ds_read_b128 a[208:211], v8 offset:8192
    v_cvt_pk_bf16_f32 v145, v210, v211
    v_mfma_f32_16x16x32_bf16 a[28:31], a[168:171], v[184:187], a[28:31]
    s_waitcnt lgkmcnt(3)
    buffer_load_dwordx4 v40, s[12:15], s41 offen lds
    v_mfma_f32_16x16x32_bf16 v[208:211], a[224:227], v[64:67], v[192:195]
    v_exp_f32 v212, v212
    v_mfma_f32_16x16x32_bf16 v[208:211], a[228:231], v[68:71], v[208:211]
    v_exp_f32 v213, v213
    v_mfma_f32_16x16x32_bf16 v[208:211], a[232:235], v[72:75], v[208:211]
    v_exp_f32 v214, v214
    v_mfma_f32_16x16x32_bf16 v[208:211], a[236:239], v[76:79], v[208:211]
    v_exp_f32 v215, v215
    v_mfma_f32_16x16x32_bf16 a[32:35], a[176:179], v[160:163], a[32:35]
    ds_read_b64_tr_b16 a[188:189], v23 offset:57344
    v_cvt_pk_bf16_f32 v152, v212, v213
    v_mfma_f32_16x16x32_bf16 a[32:35], a[180:183], v[164:167], a[32:35]
    ds_read_b64_tr_b16 a[190:191], v23 offset:61440
    v_lshlrev_b32 v244, 16, v242
    v_mfma_f32_16x16x32_bf16 a[36:39], a[180:183], v[172:175], a[36:39]
    ds_read_b128 a[212:215], v9 offset:8192
    v_cvt_pk_bf16_f32 v153, v214, v215
    v_mfma_f32_16x16x32_bf16 a[36:39], a[176:179], v[168:171], a[36:39]
    v_and_b32 v245, 0xffff0000, v242
    v_fmac_f32 v228, v2, v244
    v_smfmac_f32_16x16x64_bf16 a[196:199], v[52:55], v[168:175], v50
    v_mfma_f32_16x16x32_bf16 v[212:215], a[224:227], v[80:83], v[196:199]
    v_exp_f32 v208, v208
    v_mfma_f32_16x16x32_bf16 v[212:215], a[228:231], v[84:87], v[212:215]
    v_exp_f32 v209, v209
    v_mfma_f32_16x16x32_bf16 v[212:215], a[232:235], v[88:91], v[212:215]
    v_exp_f32 v210, v210
    v_mfma_f32_16x16x32_bf16 v[212:215], a[236:239], v[92:95], v[212:215]
    v_exp_f32 v211, v211
    v_mfma_f32_16x16x32_bf16 a[40:43], a[176:179], v[176:179], a[40:43]
    ds_read_b64_tr_b16 a[160:161], v24 offset:49152
    v_cvt_pk_bf16_f32 v130, v208, v209
    v_mfma_f32_16x16x32_bf16 a[40:43], a[180:183], v[180:183], a[40:43]
    ds_read_b64_tr_b16 a[162:163], v24 offset:53248
    v_fmac_f32 v229, v2, v245
    v_mfma_f32_16x16x32_bf16 a[44:47], a[180:183], v[188:191], a[44:47]
    ds_read_b128 a[216:219], v10 offset:8192
    v_cvt_pk_bf16_f32 v131, v210, v211
    v_mfma_f32_16x16x32_bf16 a[44:47], a[176:179], v[184:187], a[44:47]
    s_waitcnt lgkmcnt(3)
    buffer_load_dwordx4 v41, s[12:15], s41 offen offset:1024 lds
    v_mfma_f32_16x16x32_bf16 v[208:211], a[224:227], v[96:99], v[200:203]
    v_exp_f32 v212, v212
    v_mfma_f32_16x16x32_bf16 v[208:211], a[228:231], v[100:103], v[208:211]
    v_exp_f32 v213, v213
    v_mfma_f32_16x16x32_bf16 v[208:211], a[232:235], v[104:107], v[208:211]
    v_exp_f32 v214, v214
    v_mfma_f32_16x16x32_bf16 v[208:211], a[236:239], v[108:111], v[208:211]
    v_exp_f32 v215, v215
    v_mfma_f32_16x16x32_bf16 a[48:51], a[184:187], v[160:163], a[48:51]
    ds_read_b64_tr_b16 a[164:165], v24 offset:57344
    v_cvt_pk_bf16_f32 v138, v212, v213
    v_mfma_f32_16x16x32_bf16 a[48:51], a[188:191], v[164:167], a[48:51]
    ds_read_b64_tr_b16 a[166:167], v24 offset:61440
    v_lshlrev_b32 v246, 16, v243
    v_mfma_f32_16x16x32_bf16 a[52:55], a[188:191], v[172:175], a[52:55]
    ds_read_b128 a[220:223], v11 offset:8192
    v_cvt_pk_bf16_f32 v139, v214, v215
    v_mfma_f32_16x16x32_bf16 a[52:55], a[184:187], v[168:171], a[52:55]
    v_and_b32 v247, 0xffff0000, v243
    v_fmac_f32 v230, v2, v246
    v_smfmac_f32_16x16x64_bf16 a[200:203], v[52:55], v[176:183], v50
    v_mfma_f32_16x16x32_bf16 v[212:215], a[224:227], v[112:115], v[204:207]
    v_exp_f32 v208, v208
    v_mfma_f32_16x16x32_bf16 v[212:215], a[228:231], v[116:119], v[212:215]
    v_exp_f32 v209, v209
    v_mfma_f32_16x16x32_bf16 v[212:215], a[232:235], v[120:123], v[212:215]
    v_exp_f32 v210, v210
    v_mfma_f32_16x16x32_bf16 v[212:215], a[236:239], v[124:127], v[212:215]
    v_exp_f32 v211, v211
    v_mfma_f32_16x16x32_bf16 a[56:59], a[184:187], v[176:179], a[56:59]
    ds_read_b64_tr_b16 a[168:169], v25 offset:49152
    v_cvt_pk_bf16_f32 v146, v208, v209
    v_mfma_f32_16x16x32_bf16 a[56:59], a[188:191], v[180:183], a[56:59]
    ds_read_b64_tr_b16 a[170:171], v25 offset:53248
    v_fmac_f32 v231, v2, v247
    v_mfma_f32_16x16x32_bf16 a[60:63], a[188:191], v[188:191], a[60:63]
    ds_read_b128 a[224:227], v8 offset:12288
    v_cvt_pk_bf16_f32 v147, v210, v211
    v_mfma_f32_16x16x32_bf16 a[60:63], a[184:187], v[184:187], a[60:63]
    s_waitcnt lgkmcnt(3)
    buffer_load_dwordx4 v40, s[12:15], s41 offen offset:2048 lds
    v_mfma_f32_16x16x32_bf16 v[208:211], a[208:211], v[64:67], v[192:195]
    v_exp_f32 v212, v212
    v_mfma_f32_16x16x32_bf16 v[208:211], a[212:215], v[68:71], v[208:211]
    v_exp_f32 v213, v213
    v_mfma_f32_16x16x32_bf16 v[208:211], a[216:219], v[72:75], v[208:211]
    v_exp_f32 v214, v214
    v_mfma_f32_16x16x32_bf16 v[208:211], a[220:223], v[76:79], v[208:211]
    v_exp_f32 v215, v215
    v_mfma_f32_16x16x32_bf16 a[64:67], a[160:163], v[160:163], a[64:67]
    ds_read_b64_tr_b16 a[172:173], v25 offset:57344
    v_cvt_pk_bf16_f32 v154, v212, v213
    v_mfma_f32_16x16x32_bf16 a[64:67], a[164:167], v[164:167], a[64:67]
    ds_read_b64_tr_b16 a[174:175], v25 offset:61440
    v_mov_b32 v2, v3
    v_mfma_f32_16x16x32_bf16 a[68:71], a[164:167], v[172:175], a[68:71]
    ds_read_b128 a[228:231], v9 offset:12288
    v_cvt_pk_bf16_f32 v155, v214, v215
    v_mfma_f32_16x16x32_bf16 a[68:71], a[160:163], v[168:171], a[68:71]
    v_mov_b32 v3, v4
    v_mov_b32 v4, v5
    v_smfmac_f32_16x16x64_bf16 a[204:207], v[52:55], v[184:191], v50
    v_mfma_f32_16x16x32_bf16 v[212:215], a[208:211], v[80:83], v[196:199]
    v_exp_f32 v208, v208
    v_mfma_f32_16x16x32_bf16 v[212:215], a[212:215], v[84:87], v[212:215]
    v_exp_f32 v209, v209
    v_mfma_f32_16x16x32_bf16 v[212:215], a[216:219], v[88:91], v[212:215]
    v_exp_f32 v210, v210
    v_mfma_f32_16x16x32_bf16 v[212:215], a[220:223], v[92:95], v[212:215]
    v_exp_f32 v211, v211
    v_mfma_f32_16x16x32_bf16 a[72:75], a[160:163], v[176:179], a[72:75]
    ds_read_b64_tr_b16 a[176:177], v26 offset:49152
    v_cvt_pk_bf16_f32 v132, v208, v209
    v_mfma_f32_16x16x32_bf16 a[72:75], a[164:167], v[180:183], a[72:75]
    ds_read_b64_tr_b16 a[178:179], v26 offset:53248
    v_mov_b32 v5, v6
    v_mfma_f32_16x16x32_bf16 a[76:79], a[164:167], v[188:191], a[76:79]
    ds_read_b128 a[232:235], v10 offset:12288
    v_cvt_pk_bf16_f32 v133, v210, v211
    v_mfma_f32_16x16x32_bf16 a[76:79], a[160:163], v[184:187], a[76:79]
    s_waitcnt lgkmcnt(3)
    buffer_load_dwordx4 v41, s[12:15], s41 offen offset:3072 lds
    v_mfma_f32_16x16x32_bf16 v[208:211], a[208:211], v[96:99], v[200:203]
    v_exp_f32 v212, v212
    v_mfma_f32_16x16x32_bf16 v[208:211], a[212:215], v[100:103], v[208:211]
    s_add_u32 s41, s41, 16384
    v_exp_f32 v213, v213
    v_mfma_f32_16x16x32_bf16 v[208:211], a[216:219], v[104:107], v[208:211]
    v_exp_f32 v214, v214
    v_mfma_f32_16x16x32_bf16 v[208:211], a[220:223], v[108:111], v[208:211]
    v_exp_f32 v215, v215
    v_mfma_f32_16x16x32_bf16 a[80:83], a[168:171], v[160:163], a[80:83]
    ds_read_b64_tr_b16 a[180:181], v26 offset:57344
    v_cvt_pk_bf16_f32 v140, v212, v213
    v_mfma_f32_16x16x32_bf16 a[80:83], a[172:175], v[164:167], a[80:83]
    ds_read_b64_tr_b16 a[182:183], v26 offset:61440
    v_mfma_f32_16x16x32_bf16 a[84:87], a[172:175], v[172:175], a[84:87]
    ds_read_b128 a[236:239], v11 offset:12288
    v_cvt_pk_bf16_f32 v141, v214, v215
    v_mfma_f32_16x16x32_bf16 a[84:87], a[168:171], v[168:171], a[84:87]
    s_waitcnt vmcnt(10)
    s_barrier
    v_mfma_f32_16x16x32_bf16 v[212:215], a[208:211], v[112:115], v[204:207]
    v_exp_f32 v208, v208
    v_mfma_f32_16x16x32_bf16 v[212:215], a[212:215], v[116:119], v[212:215]
    s_add_u32 m0, s42, 49152
    v_exp_f32 v209, v209
    v_mfma_f32_16x16x32_bf16 v[212:215], a[216:219], v[120:123], v[212:215]
    v_exp_f32 v210, v210
    v_mfma_f32_16x16x32_bf16 v[212:215], a[220:223], v[124:127], v[212:215]
    v_exp_f32 v211, v211
    v_mfma_f32_16x16x32_bf16 a[88:91], a[168:171], v[176:179], a[88:91]
    ds_read_b64_tr_b16 a[184:185], v27 offset:49152
    v_cvt_pk_bf16_f32 v148, v208, v209
    v_mfma_f32_16x16x32_bf16 a[88:91], a[172:175], v[180:183], a[88:91]
    ds_read_b64_tr_b16 a[186:187], v27 offset:53248
    v_mfma_f32_16x16x32_bf16 a[92:95], a[172:175], v[188:191], a[92:95]
    ds_read_b128 a[208:211], v8 offset:16384
    v_cvt_pk_bf16_f32 v149, v210, v211
    v_mfma_f32_16x16x32_bf16 a[92:95], a[168:171], v[184:187], a[92:95]
    s_waitcnt lgkmcnt(3)
    buffer_load_dwordx4 v36, s[8:11], s40 offen lds
    v_mfma_f32_16x16x32_bf16 v[208:211], a[224:227], v[64:67], v[192:195]
    v_exp_f32 v212, v212
    v_mfma_f32_16x16x32_bf16 v[208:211], a[228:231], v[68:71], v[208:211]
    v_exp_f32 v213, v213
    v_mfma_f32_16x16x32_bf16 v[208:211], a[232:235], v[72:75], v[208:211]
    v_exp_f32 v214, v214
    v_mfma_f32_16x16x32_bf16 v[208:211], a[236:239], v[76:79], v[208:211]
    v_exp_f32 v215, v215
    v_mfma_f32_16x16x32_bf16 a[96:99], a[176:179], v[160:163], a[96:99]
    ds_read_b64_tr_b16 a[188:189], v27 offset:57344
    v_cvt_pk_bf16_f32 v156, v212, v213
    v_mfma_f32_16x16x32_bf16 a[96:99], a[180:183], v[164:167], a[96:99]
    ds_read_b64_tr_b16 a[190:191], v27 offset:61440
    v_mfma_f32_16x16x32_bf16 a[100:103], a[180:183], v[172:175], a[100:103]
    ds_read_b128 a[212:215], v9 offset:16384
    v_cvt_pk_bf16_f32 v157, v214, v215
    v_mfma_f32_16x16x32_bf16 a[100:103], a[176:179], v[168:171], a[100:103]
    buffer_load_dword v216, v237, s[28:31], s52 offen
    v_mfma_f32_16x16x32_bf16 v[212:215], a[224:227], v[80:83], v[196:199]
    v_exp_f32 v208, v208
    v_mfma_f32_16x16x32_bf16 v[212:215], a[228:231], v[84:87], v[212:215]
    s_sub_u32 s39, s39, 36864
    v_exp_f32 v209, v209
    v_mfma_f32_16x16x32_bf16 v[212:215], a[232:235], v[88:91], v[212:215]
    s_sub_u32 s38, s38, 4608
    v_exp_f32 v210, v210
    v_mfma_f32_16x16x32_bf16 v[212:215], a[236:239], v[92:95], v[212:215]
    s_add_u32 s52, s52, 2304
    v_exp_f32 v211, v211
    v_mfma_f32_16x16x32_bf16 a[104:107], a[176:179], v[176:179], a[104:107]
    ds_read_b64_tr_b16 a[160:161], v20 offset:0
    v_cvt_pk_bf16_f32 v134, v208, v209
    v_mfma_f32_16x16x32_bf16 a[104:107], a[180:183], v[180:183], a[104:107]
    ds_read_b64_tr_b16 a[162:163], v20 offset:4096
    v_mfma_f32_16x16x32_bf16 a[108:111], a[180:183], v[188:191], a[108:111]
    ds_read_b128 a[216:219], v10 offset:16384
    v_cvt_pk_bf16_f32 v135, v210, v211
    v_mfma_f32_16x16x32_bf16 a[108:111], a[176:179], v[184:187], a[108:111]
    s_waitcnt lgkmcnt(3)
    buffer_load_dwordx4 v37, s[8:11], s40 offen offset:1024 lds
    v_mfma_f32_16x16x32_bf16 v[208:211], a[224:227], v[96:99], v[200:203]
    v_exp_f32 v212, v212
    v_mfma_f32_16x16x32_bf16 v[208:211], a[228:231], v[100:103], v[208:211]
    v_exp_f32 v213, v213
    v_mfma_f32_16x16x32_bf16 v[208:211], a[232:235], v[104:107], v[208:211]
    v_exp_f32 v214, v214
    v_mfma_f32_16x16x32_bf16 v[208:211], a[236:239], v[108:111], v[208:211]
    v_exp_f32 v215, v215
    v_mfma_f32_16x16x32_bf16 a[112:115], a[184:187], v[160:163], a[112:115]
    ds_read_b64_tr_b16 a[164:165], v20 offset:8192
    v_cvt_pk_bf16_f32 v142, v212, v213
    v_mfma_f32_16x16x32_bf16 a[112:115], a[188:191], v[164:167], a[112:115]
    ds_read_b64_tr_b16 a[166:167], v20 offset:12288
    v_mfma_f32_16x16x32_bf16 a[116:119], a[188:191], v[172:175], a[116:119]
    ds_read_b128 a[220:223], v11 offset:16384
    v_cvt_pk_bf16_f32 v143, v214, v215
    v_mfma_f32_16x16x32_bf16 a[116:119], a[184:187], v[168:171], a[116:119]
    v_mfma_f32_16x16x32_bf16 v[212:215], a[224:227], v[112:115], v[204:207]
    v_exp_f32 v208, v208
    v_mfma_f32_16x16x32_bf16 v[212:215], a[228:231], v[116:119], v[212:215]
    v_exp_f32 v209, v209
    v_mfma_f32_16x16x32_bf16 v[212:215], a[232:235], v[120:123], v[212:215]
    v_exp_f32 v210, v210
    v_mfma_f32_16x16x32_bf16 v[212:215], a[236:239], v[124:127], v[212:215]
    v_exp_f32 v211, v211
    v_mfma_f32_16x16x32_bf16 a[120:123], a[184:187], v[176:179], a[120:123]
    ds_read_b64_tr_b16 a[168:169], v21 offset:0
    v_cvt_pk_bf16_f32 v150, v208, v209
    v_mfma_f32_16x16x32_bf16 a[120:123], a[188:191], v[180:183], a[120:123]
    ds_read_b64_tr_b16 a[170:171], v21 offset:4096
    v_mfma_f32_16x16x32_bf16 a[124:127], a[188:191], v[188:191], a[124:127]
    ds_read_b128 a[224:227], v8 offset:20480
    v_cvt_pk_bf16_f32 v151, v210, v211
    v_mfma_f32_16x16x32_bf16 a[124:127], a[184:187], v[184:187], a[124:127]
    s_waitcnt lgkmcnt(3)
    buffer_load_dwordx4 v38, s[8:11], s40 offen offset:2048 lds
    s_sub_u32 s43, s43, 1
    s_cmp_lg_u32 s43, 0
    s_cbranch_scc1 Lattn_loop
    v_mfma_f32_16x16x32_bf16 v[208:211], a[208:211], v[64:67], v[192:195]
    s_lshl_b32 s38, s3, 6
    v_exp_f32 v212, v212
    v_mfma_f32_16x16x32_bf16 v[208:211], a[212:215], v[68:71], v[208:211]
    s_add_u32 s38, s38, 131136
    v_exp_f32 v213, v213
    v_mfma_f32_16x16x32_bf16 v[208:211], a[216:219], v[72:75], v[208:211]
    v_exp_f32 v214, v214
    v_mfma_f32_16x16x32_bf16 v[208:211], a[220:223], v[76:79], v[208:211]
    s_add_u32 s57, s58, 0
    v_exp_f32 v215, v215
    v_mfma_f32_16x16x32_bf16 a[0:3], a[160:163], v[128:131], a[0:3]
    ds_read_b64_tr_b16 a[172:173], v21 offset:8192
    v_cvt_pk_bf16_f32 v158, v212, v213
    v_mfma_f32_16x16x32_bf16 a[0:3], a[164:167], v[132:135], a[0:3]
    ds_read_b64_tr_b16 a[174:175], v21 offset:12288
    v_permlane32_swap_b32 v224, v228
    v_mfma_f32_16x16x32_bf16 a[4:7], a[164:167], v[140:143], a[4:7]
    ds_read_b128 a[228:231], v9 offset:20480
    v_cvt_pk_bf16_f32 v159, v214, v215
    v_mfma_f32_16x16x32_bf16 a[4:7], a[160:163], v[136:139], a[4:7]
    buffer_load_dwordx4 a[128:131], v254, s[80:83], s57 offen
    v_mfma_f32_16x16x32_bf16 v[212:215], a[208:211], v[80:83], v[196:199]
    v_exp_f32 v208, v208
    v_mfma_f32_16x16x32_bf16 v[212:215], a[212:215], v[84:87], v[212:215]
    v_exp_f32 v209, v209
    v_mfma_f32_16x16x32_bf16 v[212:215], a[216:219], v[88:91], v[212:215]
    v_exp_f32 v210, v210
    v_mfma_f32_16x16x32_bf16 v[212:215], a[220:223], v[92:95], v[212:215]
    v_exp_f32 v211, v211
    v_mfma_f32_16x16x32_bf16 a[8:11], a[160:163], v[144:147], a[8:11]
    ds_read_b64_tr_b16 a[176:177], v22 offset:0
    v_cvt_pk_bf16_f32 v160, v208, v209
    v_mfma_f32_16x16x32_bf16 a[8:11], a[164:167], v[148:151], a[8:11]
    ds_read_b64_tr_b16 a[178:179], v22 offset:4096
    v_permlane32_swap_b32 v225, v229
    v_mfma_f32_16x16x32_bf16 a[12:15], a[164:167], v[156:159], a[12:15]
    ds_read_b128 a[232:235], v10 offset:20480
    v_cvt_pk_bf16_f32 v161, v210, v211
    v_mfma_f32_16x16x32_bf16 a[12:15], a[160:163], v[152:155], a[12:15]
    s_waitcnt lgkmcnt(3)
    buffer_load_dwordx4 v39, s[8:11], s40 offen offset:3072 lds
    v_mfma_f32_16x16x32_bf16 v[208:211], a[208:211], v[96:99], v[200:203]
    v_exp_f32 v212, v212
    v_mfma_f32_16x16x32_bf16 v[208:211], a[212:215], v[100:103], v[208:211]
    s_add_u32 s40, s40, 16384
    v_exp_f32 v213, v213
    v_mfma_f32_16x16x32_bf16 v[208:211], a[216:219], v[104:107], v[208:211]
    v_exp_f32 v214, v214
    v_mfma_f32_16x16x32_bf16 v[208:211], a[220:223], v[108:111], v[208:211]
    v_exp_f32 v215, v215
    v_mfma_f32_16x16x32_bf16 a[16:19], a[168:171], v[128:131], a[16:19]
    ds_read_b64_tr_b16 a[180:181], v22 offset:8192
    v_cvt_pk_bf16_f32 v168, v212, v213
    v_mfma_f32_16x16x32_bf16 a[16:19], a[172:175], v[132:135], a[16:19]
    ds_read_b64_tr_b16 a[182:183], v22 offset:12288
    v_permlane32_swap_b32 v226, v230
    v_mfma_f32_16x16x32_bf16 a[20:23], a[172:175], v[140:143], a[20:23]
    ds_read_b128 a[236:239], v11 offset:20480
    v_cvt_pk_bf16_f32 v169, v214, v215
    v_mfma_f32_16x16x32_bf16 a[20:23], a[168:171], v[136:139], a[20:23]
    v_permlane32_swap_b32 v227, v231
    v_add_f32 v224, v224, v228
    v_smfmac_f32_16x16x64_bf16 a[192:195], v[52:55], v[128:135], v50
    v_mfma_f32_16x16x32_bf16 v[212:215], a[208:211], v[112:115], v[204:207]
    v_exp_f32 v208, v208
    v_mfma_f32_16x16x32_bf16 v[212:215], a[212:215], v[116:119], v[212:215]
    s_add_u32 m0, s42, 98304
    v_exp_f32 v209, v209
    v_mfma_f32_16x16x32_bf16 v[212:215], a[216:219], v[120:123], v[212:215]
    v_exp_f32 v210, v210
    v_mfma_f32_16x16x32_bf16 v[212:215], a[220:223], v[124:127], v[212:215]
    v_exp_f32 v211, v211
    v_mfma_f32_16x16x32_bf16 a[24:27], a[168:171], v[144:147], a[24:27]
    ds_read_b64_tr_b16 a[184:185], v23 offset:0
    v_cvt_pk_bf16_f32 v176, v208, v209
    v_mfma_f32_16x16x32_bf16 a[24:27], a[172:175], v[148:151], a[24:27]
    ds_read_b64_tr_b16 a[186:187], v23 offset:4096
    v_add_f32 v225, v225, v229
    v_mfma_f32_16x16x32_bf16 a[28:31], a[172:175], v[156:159], a[28:31]
    ds_read_b128 a[208:211], v8 offset:24576
    v_cvt_pk_bf16_f32 v177, v210, v211
    v_mfma_f32_16x16x32_bf16 a[28:31], a[168:171], v[152:155], a[28:31]
    s_waitcnt lgkmcnt(3)
    buffer_load_dwordx4 v40, s[12:15], s41 offen lds
    v_mfma_f32_16x16x32_bf16 v[208:211], a[224:227], v[64:67], v[192:195]
    v_exp_f32 v212, v212
    v_mfma_f32_16x16x32_bf16 v[208:211], a[228:231], v[68:71], v[208:211]
    v_exp_f32 v213, v213
    v_mfma_f32_16x16x32_bf16 v[208:211], a[232:235], v[72:75], v[208:211]
    v_exp_f32 v214, v214
    v_mfma_f32_16x16x32_bf16 v[208:211], a[236:239], v[76:79], v[208:211]
    s_add_u32 s57, s58, 589824
    v_exp_f32 v215, v215
    v_mfma_f32_16x16x32_bf16 a[32:35], a[176:179], v[128:131], a[32:35]
    ds_read_b64_tr_b16 a[188:189], v23 offset:8192
    v_cvt_pk_bf16_f32 v184, v212, v213
    v_mfma_f32_16x16x32_bf16 a[32:35], a[180:183], v[132:135], a[32:35]
    ds_read_b64_tr_b16 a[190:191], v23 offset:12288
    v_add_f32 v226, v226, v230
    v_mfma_f32_16x16x32_bf16 a[36:39], a[180:183], v[140:143], a[36:39]
    ds_read_b128 a[212:215], v9 offset:24576
    v_cvt_pk_bf16_f32 v185, v214, v215
    v_mfma_f32_16x16x32_bf16 a[36:39], a[176:179], v[136:139], a[36:39]
    buffer_load_dwordx4 a[132:135], v254, s[80:83], s57 offen
    v_smfmac_f32_16x16x64_bf16 a[196:199], v[52:55], v[136:143], v50
    v_mfma_f32_16x16x32_bf16 v[212:215], a[224:227], v[80:83], v[196:199]
    v_exp_f32 v208, v208
    v_mfma_f32_16x16x32_bf16 v[212:215], a[228:231], v[84:87], v[212:215]
    v_exp_f32 v209, v209
    v_mfma_f32_16x16x32_bf16 v[212:215], a[232:235], v[88:91], v[212:215]
    v_exp_f32 v210, v210
    v_mfma_f32_16x16x32_bf16 v[212:215], a[236:239], v[92:95], v[212:215]
    v_exp_f32 v211, v211
    v_mfma_f32_16x16x32_bf16 a[40:43], a[176:179], v[144:147], a[40:43]
    ds_read_b64_tr_b16 a[160:161], v24 offset:0
    v_cvt_pk_bf16_f32 v162, v208, v209
    v_mfma_f32_16x16x32_bf16 a[40:43], a[180:183], v[148:151], a[40:43]
    ds_read_b64_tr_b16 a[162:163], v24 offset:4096
    v_add_f32 v227, v227, v231
    v_mfma_f32_16x16x32_bf16 a[44:47], a[180:183], v[156:159], a[44:47]
    ds_read_b128 a[216:219], v10 offset:24576
    v_cvt_pk_bf16_f32 v163, v210, v211
    v_mfma_f32_16x16x32_bf16 a[44:47], a[176:179], v[152:155], a[44:47]
    s_waitcnt lgkmcnt(3)
    buffer_load_dwordx4 v41, s[12:15], s41 offen offset:1024 lds
    v_mfma_f32_16x16x32_bf16 v[208:211], a[224:227], v[96:99], v[200:203]
    v_exp_f32 v212, v212
    v_mfma_f32_16x16x32_bf16 v[208:211], a[228:231], v[100:103], v[208:211]
    v_exp_f32 v213, v213
    v_mfma_f32_16x16x32_bf16 v[208:211], a[232:235], v[104:107], v[208:211]
    v_exp_f32 v214, v214
    v_mfma_f32_16x16x32_bf16 v[208:211], a[236:239], v[108:111], v[208:211]
    v_exp_f32 v215, v215
    v_mfma_f32_16x16x32_bf16 a[48:51], a[184:187], v[128:131], a[48:51]
    ds_read_b64_tr_b16 a[164:165], v24 offset:8192
    v_cvt_pk_bf16_f32 v170, v212, v213
    v_mfma_f32_16x16x32_bf16 a[48:51], a[188:191], v[132:135], a[48:51]
    ds_read_b64_tr_b16 a[166:167], v24 offset:12288
    v_and_b32 v244, 1, v1
    v_mfma_f32_16x16x32_bf16 a[52:55], a[188:191], v[140:143], a[52:55]
    ds_read_b128 a[220:223], v11 offset:24576
    v_cvt_pk_bf16_f32 v171, v214, v215
    v_mfma_f32_16x16x32_bf16 a[52:55], a[184:187], v[136:139], a[52:55]
    s_waitcnt vmcnt(15)
    buffer_load_dword v221, v236, s[20:23], 0 offen
    v_smfmac_f32_16x16x64_bf16 a[200:203], v[52:55], v[144:151], v50
    v_mfma_f32_16x16x32_bf16 v[212:215], a[224:227], v[112:115], v[204:207]
    v_exp_f32 v208, v208
    v_mfma_f32_16x16x32_bf16 v[212:215], a[228:231], v[116:119], v[212:215]
    v_exp_f32 v209, v209
    v_mfma_f32_16x16x32_bf16 v[212:215], a[232:235], v[120:123], v[212:215]
    v_exp_f32 v210, v210
    v_mfma_f32_16x16x32_bf16 v[212:215], a[236:239], v[124:127], v[212:215]
    v_exp_f32 v211, v211
    v_mfma_f32_16x16x32_bf16 a[56:59], a[184:187], v[144:147], a[56:59]
    ds_read_b64_tr_b16 a[168:169], v25 offset:0
    v_cvt_pk_bf16_f32 v178, v208, v209
    v_mfma_f32_16x16x32_bf16 a[56:59], a[188:191], v[148:151], a[56:59]
    ds_read_b64_tr_b16 a[170:171], v25 offset:4096
    v_permlane16_swap_b32 v224, v226
    v_mfma_f32_16x16x32_bf16 a[60:63], a[188:191], v[156:159], a[60:63]
    ds_read_b128 a[224:227], v8 offset:28672
    v_cvt_pk_bf16_f32 v179, v210, v211
    v_mfma_f32_16x16x32_bf16 a[60:63], a[184:187], v[152:155], a[60:63]
    s_waitcnt lgkmcnt(3)
    buffer_load_dwordx4 v40, s[12:15], s41 offen offset:2048 lds
    v_mfma_f32_16x16x32_bf16 v[208:211], a[208:211], v[64:67], v[192:195]
    v_exp_f32 v212, v212
    v_mfma_f32_16x16x32_bf16 v[208:211], a[212:215], v[68:71], v[208:211]
    v_exp_f32 v213, v213
    v_mfma_f32_16x16x32_bf16 v[208:211], a[216:219], v[72:75], v[208:211]
    v_exp_f32 v214, v214
    v_mfma_f32_16x16x32_bf16 v[208:211], a[220:223], v[76:79], v[208:211]
    s_add_u32 s57, s58, 1179648
    v_exp_f32 v215, v215
    v_mfma_f32_16x16x32_bf16 a[64:67], a[160:163], v[128:131], a[64:67]
    ds_read_b64_tr_b16 a[172:173], v25 offset:8192
    v_cvt_pk_bf16_f32 v186, v212, v213
    v_mfma_f32_16x16x32_bf16 a[64:67], a[164:167], v[132:135], a[64:67]
    ds_read_b64_tr_b16 a[174:175], v25 offset:12288
    v_permlane16_swap_b32 v225, v227
    v_mfma_f32_16x16x32_bf16 a[68:71], a[164:167], v[140:143], a[68:71]
    ds_read_b128 a[228:231], v9 offset:28672
    v_cvt_pk_bf16_f32 v187, v214, v215
    v_mfma_f32_16x16x32_bf16 a[68:71], a[160:163], v[136:139], a[68:71]
    buffer_load_dwordx4 a[136:139], v254, s[80:83], s57 offen
    v_smfmac_f32_16x16x64_bf16 a[204:207], v[52:55], v[152:159], v50
    v_mfma_f32_16x16x32_bf16 v[212:215], a[208:211], v[80:83], v[196:199]
    v_exp_f32 v208, v208
    v_mfma_f32_16x16x32_bf16 v[212:215], a[212:215], v[84:87], v[212:215]
    v_exp_f32 v209, v209
    v_mfma_f32_16x16x32_bf16 v[212:215], a[216:219], v[88:91], v[212:215]
    v_exp_f32 v210, v210
    v_mfma_f32_16x16x32_bf16 v[212:215], a[220:223], v[92:95], v[212:215]
    v_exp_f32 v211, v211
    v_mfma_f32_16x16x32_bf16 a[72:75], a[160:163], v[144:147], a[72:75]
    ds_read_b64_tr_b16 a[176:177], v26 offset:0
    v_cvt_pk_bf16_f32 v164, v208, v209
    v_mfma_f32_16x16x32_bf16 a[72:75], a[164:167], v[148:151], a[72:75]
    ds_read_b64_tr_b16 a[178:179], v26 offset:4096
    v_lshlrev_b32 v244, 5, v244
    v_mfma_f32_16x16x32_bf16 a[76:79], a[164:167], v[156:159], a[76:79]
    ds_read_b128 a[232:235], v10 offset:28672
    v_cvt_pk_bf16_f32 v165, v210, v211
    v_mfma_f32_16x16x32_bf16 a[76:79], a[160:163], v[152:155], a[76:79]
    s_waitcnt lgkmcnt(3)
    buffer_load_dwordx4 v41, s[12:15], s41 offen offset:3072 lds
    v_mfma_f32_16x16x32_bf16 v[208:211], a[208:211], v[96:99], v[200:203]
    v_exp_f32 v212, v212
    v_mfma_f32_16x16x32_bf16 v[208:211], a[212:215], v[100:103], v[208:211]
    s_add_u32 s41, s41, 16384
    v_exp_f32 v213, v213
    v_mfma_f32_16x16x32_bf16 v[208:211], a[216:219], v[104:107], v[208:211]
    v_exp_f32 v214, v214
    v_mfma_f32_16x16x32_bf16 v[208:211], a[220:223], v[108:111], v[208:211]
    v_exp_f32 v215, v215
    v_mfma_f32_16x16x32_bf16 a[80:83], a[168:171], v[128:131], a[80:83]
    ds_read_b64_tr_b16 a[180:181], v26 offset:8192
    v_cvt_pk_bf16_f32 v172, v212, v213
    v_mfma_f32_16x16x32_bf16 a[80:83], a[172:175], v[132:135], a[80:83]
    ds_read_b64_tr_b16 a[182:183], v26 offset:12288
    v_add_f32 v224, v224, v226
    v_mfma_f32_16x16x32_bf16 a[84:87], a[172:175], v[140:143], a[84:87]
    ds_read_b128 a[236:239], v11 offset:28672
    v_cvt_pk_bf16_f32 v173, v214, v215
    v_mfma_f32_16x16x32_bf16 a[84:87], a[168:171], v[136:139], a[84:87]
    s_waitcnt vmcnt(13)
    s_barrier
    v_mfma_f32_16x16x32_bf16 v[212:215], a[208:211], v[112:115], v[204:207]
    v_exp_f32 v208, v208
    v_mfma_f32_16x16x32_bf16 v[212:215], a[212:215], v[116:119], v[212:215]
    s_add_u32 s49, s45, 1024
    v_exp_f32 v209, v209
    v_mfma_f32_16x16x32_bf16 v[212:215], a[216:219], v[120:123], v[212:215]
    s_add_u32 m0, s42, 0
    v_exp_f32 v210, v210
    v_mfma_f32_16x16x32_bf16 v[212:215], a[220:223], v[124:127], v[212:215]
    v_exp_f32 v211, v211
    v_mfma_f32_16x16x32_bf16 a[88:91], a[168:171], v[144:147], a[88:91]
    ds_read_b64_tr_b16 a[184:185], v27 offset:0
    v_cvt_pk_bf16_f32 v180, v208, v209
    v_mfma_f32_16x16x32_bf16 a[88:91], a[172:175], v[148:151], a[88:91]
    ds_read_b64_tr_b16 a[186:187], v27 offset:4096
    v_add_f32 v225, v225, v227
    v_mfma_f32_16x16x32_bf16 a[92:95], a[172:175], v[156:159], a[92:95]
    ds_read_b128 a[208:211], v8 offset:32768
    v_cvt_pk_bf16_f32 v181, v210, v211
    v_mfma_f32_16x16x32_bf16 a[92:95], a[168:171], v[152:155], a[92:95]
    s_waitcnt lgkmcnt(3)
    buffer_load_dwordx4 v46, s[20:23], s49 offen lds
    v_mfma_f32_16x16x32_bf16 v[208:211], a[224:227], v[64:67], v[192:195]
    v_exp_f32 v212, v212
    v_mfma_f32_16x16x32_bf16 v[208:211], a[228:231], v[68:71], v[208:211]
    v_exp_f32 v213, v213
    v_mfma_f32_16x16x32_bf16 v[208:211], a[232:235], v[72:75], v[208:211]
    v_exp_f32 v214, v214
    v_mfma_f32_16x16x32_bf16 v[208:211], a[236:239], v[76:79], v[208:211]
    s_add_u32 s37, s55, 0
    v_exp_f32 v215, v215
    v_mfma_f32_16x16x32_bf16 a[96:99], a[176:179], v[128:131], a[96:99]
Ltour6:
    s_cbranch_execz Ltour10
    ds_read_b64_tr_b16 a[188:189], v27 offset:8192
    v_cvt_pk_bf16_f32 v188, v212, v213
    v_mfma_f32_16x16x32_bf16 a[96:99], a[180:183], v[132:135], a[96:99]
    ds_read_b64_tr_b16 a[190:191], v27 offset:12288
    v_lshrrev_b32 v245, 4, v1
    v_mfma_f32_16x16x32_bf16 a[100:103], a[180:183], v[140:143], a[100:103]
    ds_read_b128 a[212:215], v9 offset:32768
    v_cvt_pk_bf16_f32 v189, v214, v215
    v_mfma_f32_16x16x32_bf16 a[100:103], a[176:179], v[136:139], a[100:103]
    buffer_load_dword v239, v238, s[28:31], s37 offen
    v_mfma_f32_16x16x32_bf16 v[212:215], a[224:227], v[80:83], v[196:199]
    v_exp_f32 v208, v208
    v_mfma_f32_16x16x32_bf16 v[212:215], a[228:231], v[84:87], v[212:215]
    v_exp_f32 v209, v209
    v_mfma_f32_16x16x32_bf16 v[212:215], a[232:235], v[88:91], v[212:215]
    v_exp_f32 v210, v210
    v_mfma_f32_16x16x32_bf16 v[212:215], a[236:239], v[92:95], v[212:215]
    v_exp_f32 v211, v211
    v_mfma_f32_16x16x32_bf16 a[104:107], a[176:179], v[144:147], a[104:107]
    ds_read_b64_tr_b16 a[160:161], v20 offset:16384
    v_cvt_pk_bf16_f32 v166, v208, v209
    v_mfma_f32_16x16x32_bf16 a[104:107], a[180:183], v[148:151], a[104:107]
    ds_read_b64_tr_b16 a[162:163], v20 offset:20480
    v_lshl_add_u32 v244, v245, 3, v244
    v_mfma_f32_16x16x32_bf16 a[108:111], a[180:183], v[156:159], a[108:111]
    ds_read_b128 a[216:219], v10 offset:32768
    v_cvt_pk_bf16_f32 v167, v210, v211
    v_mfma_f32_16x16x32_bf16 a[108:111], a[176:179], v[152:155], a[108:111]
    s_waitcnt lgkmcnt(3)
    buffer_load_dwordx4 v47, s[20:23], s49 offen offset:1024 lds
    v_mfma_f32_16x16x32_bf16 v[208:211], a[224:227], v[96:99], v[200:203]
    v_exp_f32 v212, v212
    v_mfma_f32_16x16x32_bf16 v[208:211], a[228:231], v[100:103], v[208:211]
    v_exp_f32 v213, v213
    v_mfma_f32_16x16x32_bf16 v[208:211], a[232:235], v[104:107], v[208:211]
    v_exp_f32 v214, v214
    v_mfma_f32_16x16x32_bf16 v[208:211], a[236:239], v[108:111], v[208:211]
    s_add_u32 s57, s58, 1769472
    v_exp_f32 v215, v215
    v_mfma_f32_16x16x32_bf16 a[112:115], a[184:187], v[128:131], a[112:115]
    ds_read_b64_tr_b16 a[164:165], v20 offset:24576
    v_cvt_pk_bf16_f32 v174, v212, v213
    v_mfma_f32_16x16x32_bf16 a[112:115], a[188:191], v[132:135], a[112:115]
    ds_read_b64_tr_b16 a[166:167], v20 offset:28672
    v_mfma_f32_16x16x32_bf16 a[116:119], a[188:191], v[140:143], a[116:119]
    ds_read_b128 a[220:223], v11 offset:32768
    v_cvt_pk_bf16_f32 v175, v214, v215
    v_mfma_f32_16x16x32_bf16 a[116:119], a[184:187], v[136:139], a[116:119]
    buffer_load_dwordx4 a[140:143], v254, s[80:83], s57 offen
    v_mfma_f32_16x16x32_bf16 v[212:215], a[224:227], v[112:115], v[204:207]
    v_exp_f32 v208, v208
    v_mfma_f32_16x16x32_bf16 v[212:215], a[228:231], v[116:119], v[212:215]
    v_exp_f32 v209, v209
    v_mfma_f32_16x16x32_bf16 v[212:215], a[232:235], v[120:123], v[212:215]
    v_exp_f32 v210, v210
    v_mfma_f32_16x16x32_bf16 v[212:215], a[236:239], v[124:127], v[212:215]
    v_exp_f32 v211, v211
    v_mfma_f32_16x16x32_bf16 a[120:123], a[184:187], v[144:147], a[120:123]
    ds_read_b64_tr_b16 a[168:169], v21 offset:16384
    v_cvt_pk_bf16_f32 v182, v208, v209
    v_mfma_f32_16x16x32_bf16 a[120:123], a[188:191], v[148:151], a[120:123]
    ds_read_b64_tr_b16 a[170:171], v21 offset:20480
    v_mfma_f32_16x16x32_bf16 a[124:127], a[188:191], v[156:159], a[124:127]
    ds_read_b128 a[224:227], v8 offset:36864
    v_cvt_pk_bf16_f32 v183, v210, v211
    v_mfma_f32_16x16x32_bf16 a[124:127], a[184:187], v[152:155], a[124:127]
    s_waitcnt lgkmcnt(3)
    buffer_load_dwordx4 v48, s[20:23], s49 offen offset:2048 lds
    v_mfma_f32_16x16x32_bf16 v[208:211], a[208:211], v[64:67], v[192:195]
    v_exp_f32 v212, v212
    v_mfma_f32_16x16x32_bf16 v[208:211], a[212:215], v[68:71], v[208:211]
    v_exp_f32 v213, v213
    v_mfma_f32_16x16x32_bf16 v[208:211], a[216:219], v[72:75], v[208:211]
    v_exp_f32 v214, v214
    v_mfma_f32_16x16x32_bf16 v[208:211], a[220:223], v[76:79], v[208:211]
    s_add_u32 s57, s58, 2359296
    v_exp_f32 v215, v215
    v_mfma_f32_16x16x32_bf16 a[0:3], a[160:163], v[160:163], a[0:3]
    ds_read_b64_tr_b16 a[172:173], v21 offset:24576
    v_cvt_pk_bf16_f32 v190, v212, v213
    v_mfma_f32_16x16x32_bf16 a[0:3], a[164:167], v[164:167], a[0:3]
    ds_read_b64_tr_b16 a[174:175], v21 offset:28672
    v_mov_b32 v63, 0
    v_mfma_f32_16x16x32_bf16 a[4:7], a[164:167], v[172:175], a[4:7]
    ds_read_b128 a[228:231], v9 offset:36864
    v_cvt_pk_bf16_f32 v191, v214, v215
    v_mfma_f32_16x16x32_bf16 a[4:7], a[160:163], v[168:171], a[4:7]
    buffer_load_dwordx4 a[144:147], v254, s[80:83], s57 offen
    v_mfma_f32_16x16x32_bf16 v[212:215], a[208:211], v[80:83], v[196:199]
    v_exp_f32 v208, v208
    v_mfma_f32_16x16x32_bf16 v[212:215], a[212:215], v[84:87], v[212:215]
    v_exp_f32 v209, v209
    v_mfma_f32_16x16x32_bf16 v[212:215], a[216:219], v[88:91], v[212:215]
    v_exp_f32 v210, v210
    v_mfma_f32_16x16x32_bf16 v[212:215], a[220:223], v[92:95], v[212:215]
    v_exp_f32 v211, v211
    v_mfma_f32_16x16x32_bf16 a[8:11], a[160:163], v[176:179], a[8:11]
    ds_read_b64_tr_b16 a[176:177], v22 offset:16384
    v_cvt_pk_bf16_f32 v128, v208, v209
    v_mfma_f32_16x16x32_bf16 a[8:11], a[164:167], v[180:183], a[8:11]
    ds_read_b64_tr_b16 a[178:179], v22 offset:20480
    v_add_f32_dpp v224, v224, v224 row_ror:2 row_mask:0xf bank_mask:0xf
    v_mfma_f32_16x16x32_bf16 a[12:15], a[164:167], v[188:191], a[12:15]
    ds_read_b128 a[232:235], v10 offset:36864
    v_cvt_pk_bf16_f32 v129, v210, v211
    v_mfma_f32_16x16x32_bf16 a[12:15], a[160:163], v[184:187], a[12:15]
    s_waitcnt lgkmcnt(3)
    buffer_load_dwordx4 v49, s[20:23], s49 offen offset:3072 lds
    v_mfma_f32_16x16x32_bf16 v[208:211], a[208:211], v[96:99], v[200:203]
    s_lshr_b32 s39, s2, 5
    v_exp_f32 v212, v212
    v_mfma_f32_16x16x32_bf16 v[208:211], a[212:215], v[100:103], v[208:211]
    s_lshl_b32 s39, s39, 3
    v_exp_f32 v213, v213
    v_mfma_f32_16x16x32_bf16 v[208:211], a[216:219], v[104:107], v[208:211]
    s_and_b32 s43, s2, 7
    v_exp_f32 v214, v214
    v_mfma_f32_16x16x32_bf16 v[208:211], a[220:223], v[108:111], v[208:211]
    s_add_u32 s39, s39, s43
    v_exp_f32 v215, v215
    v_mfma_f32_16x16x32_bf16 a[16:19], a[168:171], v[160:163], a[16:19]
    ds_read_b64_tr_b16 a[180:181], v22 offset:24576
    v_cvt_pk_bf16_f32 v136, v212, v213
    v_mfma_f32_16x16x32_bf16 a[16:19], a[172:175], v[164:167], a[16:19]
    ds_read_b64_tr_b16 a[182:183], v22 offset:28672
    v_add_f32_dpp v225, v225, v225 row_ror:2 row_mask:0xf bank_mask:0xf
    v_mfma_f32_16x16x32_bf16 a[20:23], a[172:175], v[172:175], a[20:23]
    ds_read_b128 a[236:239], v11 offset:36864
    v_cvt_pk_bf16_f32 v137, v214, v215
    v_mfma_f32_16x16x32_bf16 a[20:23], a[168:171], v[168:171], a[20:23]
    buffer_load_dword v253, v63, s[24:27], s54 offen offset:12 sc1
    v_smfmac_f32_16x16x64_bf16 a[192:195], v[52:55], v[160:167], v50
    v_mfma_f32_16x16x32_bf16 v[212:215], a[208:211], v[112:115], v[204:207]
    s_lshl_b32 s39, s39, 2
    v_exp_f32 v208, v208
    v_mfma_f32_16x16x32_bf16 v[212:215], a[212:215], v[116:119], v[212:215]
    s_add_u32 m0, s42, 114688
    v_exp_f32 v209, v209
    v_mfma_f32_16x16x32_bf16 v[212:215], a[216:219], v[120:123], v[212:215]
    s_bfe_u32 s43, s2, 0x20003
    v_exp_f32 v210, v210
    v_mfma_f32_16x16x32_bf16 v[212:215], a[220:223], v[124:127], v[212:215]
    s_add_u32 s39, s39, s43
    v_exp_f32 v211, v211
    v_mfma_f32_16x16x32_bf16 a[24:27], a[168:171], v[176:179], a[24:27]
    ds_read_b64_tr_b16 a[184:185], v23 offset:16384
    v_cvt_pk_bf16_f32 v144, v208, v209
    v_mfma_f32_16x16x32_bf16 a[24:27], a[172:175], v[180:183], a[24:27]
    ds_read_b64_tr_b16 a[186:187], v23 offset:20480
    v_add_f32_dpp v224, v224, v224 row_ror:4 row_mask:0xf bank_mask:0xf
    v_mfma_f32_16x16x32_bf16 a[28:31], a[172:175], v[188:191], a[28:31]
    ds_read_b128 a[208:211], v8 offset:40960
    v_cvt_pk_bf16_f32 v145, v210, v211
    v_mfma_f32_16x16x32_bf16 a[28:31], a[168:171], v[184:187], a[28:31]
    s_waitcnt lgkmcnt(3)
    buffer_load_dwordx4 v40, s[12:15], s41 offen lds
    v_mfma_f32_16x16x32_bf16 v[208:211], a[224:227], v[64:67], v[192:195]
    s_add_u32 s39, s39, 72
    v_exp_f32 v212, v212
    v_mfma_f32_16x16x32_bf16 v[208:211], a[228:231], v[68:71], v[208:211]
    s_cmp_lt_u32 s39, 216
    s_cselect_b32 s43, 0, 2147483648
    v_exp_f32 v213, v213
    v_mfma_f32_16x16x32_bf16 v[208:211], a[232:235], v[72:75], v[208:211]
    s_or_b32 s43, s43, s48
    v_exp_f32 v214, v214
    v_mfma_f32_16x16x32_bf16 v[208:211], a[236:239], v[76:79], v[208:211]
    s_add_u32 s57, s58, 2949120
    v_exp_f32 v215, v215
    v_mfma_f32_16x16x32_bf16 a[32:35], a[176:179], v[160:163], a[32:35]
    ds_read_b64_tr_b16 a[188:189], v23 offset:24576
    v_cvt_pk_bf16_f32 v152, v212, v213
    v_mfma_f32_16x16x32_bf16 a[32:35], a[180:183], v[164:167], a[32:35]
    ds_read_b64_tr_b16 a[190:191], v23 offset:28672
    v_add_f32_dpp v225, v225, v225 row_ror:4 row_mask:0xf bank_mask:0xf
    v_mfma_f32_16x16x32_bf16 a[36:39], a[180:183], v[172:175], a[36:39]
    ds_read_b128 a[212:215], v9 offset:40960
    v_cvt_pk_bf16_f32 v153, v214, v215
    v_mfma_f32_16x16x32_bf16 a[36:39], a[176:179], v[168:171], a[36:39]
    buffer_load_dwordx4 a[148:151], v254, s[80:83], s57 offen
    v_smfmac_f32_16x16x64_bf16 a[196:199], v[52:55], v[168:175], v50
    v_mfma_f32_16x16x32_bf16 v[212:215], a[224:227], v[80:83], v[196:199]
    s_and_b32 s43, s43, 2147483648
    v_exp_f32 v208, v208
    v_mfma_f32_16x16x32_bf16 v[212:215], a[228:231], v[84:87], v[212:215]
    s_sub_u32 s36, s39, 144
    v_exp_f32 v209, v209
    v_mfma_f32_16x16x32_bf16 v[212:215], a[232:235], v[88:91], v[212:215]
    s_cmp_lt_u32 s36, 36
    s_cselect_b32 s36, 1.0, 0
    v_exp_f32 v210, v210
    v_mfma_f32_16x16x32_bf16 v[212:215], a[236:239], v[92:95], v[212:215]
    s_lshr_b32 s44, s39, 1
    v_exp_f32 v211, v211
    v_mfma_f32_16x16x32_bf16 a[40:43], a[176:179], v[176:179], a[40:43]
    ds_read_b64_tr_b16 a[160:161], v24 offset:16384
    v_cvt_pk_bf16_f32 v130, v208, v209
    v_mfma_f32_16x16x32_bf16 a[40:43], a[180:183], v[180:183], a[40:43]
    ds_read_b64_tr_b16 a[162:163], v24 offset:20480
    v_add_f32_dpp v224, v224, v224 row_ror:8 row_mask:0xf bank_mask:0xf
    v_mfma_f32_16x16x32_bf16 a[44:47], a[180:183], v[188:191], a[44:47]
    ds_read_b128 a[216:219], v10 offset:40960
    v_cvt_pk_bf16_f32 v131, v210, v211
    v_mfma_f32_16x16x32_bf16 a[44:47], a[176:179], v[184:187], a[44:47]
    s_waitcnt lgkmcnt(3)
    buffer_load_dwordx4 v41, s[12:15], s41 offen offset:1024 lds
    v_mfma_f32_16x16x32_bf16 v[208:211], a[224:227], v[96:99], v[200:203]
    s_lshl_b32 s44, s44, 6
    v_exp_f32 v212, v212
    v_mfma_f32_16x16x32_bf16 v[208:211], a[228:231], v[100:103], v[208:211]
    s_and_b32 s39, s39, 1
    v_exp_f32 v213, v213
    v_mfma_f32_16x16x32_bf16 v[208:211], a[232:235], v[104:107], v[208:211]
    s_lshl_b32 s39, s39, 3
    v_exp_f32 v214, v214
    v_mfma_f32_16x16x32_bf16 v[208:211], a[236:239], v[108:111], v[208:211]
    s_add_u32 s39, s39, s44
    v_exp_f32 v215, v215
    v_mfma_f32_16x16x32_bf16 a[48:51], a[184:187], v[160:163], a[48:51]
    ds_read_b64_tr_b16 a[164:165], v24 offset:24576
    v_cvt_pk_bf16_f32 v138, v212, v213
    v_mfma_f32_16x16x32_bf16 a[48:51], a[188:191], v[164:167], a[48:51]
    ds_read_b64_tr_b16 a[166:167], v24 offset:28672
    v_add_f32_dpp v225, v225, v225 row_ror:8 row_mask:0xf bank_mask:0xf
    v_mfma_f32_16x16x32_bf16 a[52:55], a[188:191], v[172:175], a[52:55]
    ds_read_b128 a[220:223], v11 offset:40960
    v_cvt_pk_bf16_f32 v139, v214, v215
    v_mfma_f32_16x16x32_bf16 a[52:55], a[184:187], v[168:171], a[52:55]
    v_add_u32 v244, s38, v244
    v_and_b32 v245, 7, v1
    v_smfmac_f32_16x16x64_bf16 a[200:203], v[52:55], v[176:183], v50
    v_mfma_f32_16x16x32_bf16 v[212:215], a[224:227], v[112:115], v[204:207]
    s_add_u32 s39, s39, 16384
    v_exp_f32 v208, v208
    v_mfma_f32_16x16x32_bf16 v[212:215], a[228:231], v[116:119], v[212:215]
    s_or_b32 s39, s39, s43
    v_exp_f32 v209, v209
    v_mfma_f32_16x16x32_bf16 v[212:215], a[232:235], v[120:123], v[212:215]
    v_exp_f32 v210, v210
    v_mfma_f32_16x16x32_bf16 v[212:215], a[236:239], v[124:127], v[212:215]
    v_exp_f32 v211, v211
    v_mfma_f32_16x16x32_bf16 a[56:59], a[184:187], v[176:179], a[56:59]
    ds_read_b64_tr_b16 a[168:169], v25 offset:16384
    v_cvt_pk_bf16_f32 v146, v208, v209
    v_mfma_f32_16x16x32_bf16 a[56:59], a[188:191], v[180:183], a[56:59]
    ds_read_b64_tr_b16 a[170:171], v25 offset:20480
    v_mfma_f32_16x16x32_bf16 a[60:63], a[188:191], v[188:191], a[60:63]
    ds_read_b128 a[224:227], v8 offset:45056
    v_cvt_pk_bf16_f32 v147, v210, v211
    v_mfma_f32_16x16x32_bf16 a[60:63], a[184:187], v[184:187], a[60:63]
    s_waitcnt lgkmcnt(3)
    buffer_load_dwordx4 v40, s[12:15], s41 offen offset:2048 lds
    v_mfma_f32_16x16x32_bf16 v[208:211], a[208:211], v[64:67], v[192:195]
    v_exp_f32 v212, v212
    v_mfma_f32_16x16x32_bf16 v[208:211], a[212:215], v[68:71], v[208:211]
    v_exp_f32 v213, v213
    v_mfma_f32_16x16x32_bf16 v[208:211], a[216:219], v[72:75], v[208:211]
    v_exp_f32 v214, v214
    v_mfma_f32_16x16x32_bf16 v[208:211], a[220:223], v[76:79], v[208:211]
    s_add_u32 s57, s58, 3538944
    v_exp_f32 v215, v215
    v_mfma_f32_16x16x32_bf16 a[64:67], a[160:163], v[160:163], a[64:67]
    ds_read_b64_tr_b16 a[172:173], v25 offset:24576
    v_cvt_pk_bf16_f32 v154, v212, v213
    v_mfma_f32_16x16x32_bf16 a[64:67], a[164:167], v[164:167], a[64:67]
    ds_read_b64_tr_b16 a[174:175], v25 offset:28672
    v_lshlrev_b32 v245, 3, v245
    v_mfma_f32_16x16x32_bf16 a[68:71], a[164:167], v[172:175], a[68:71]
    ds_read_b128 a[228:231], v9 offset:45056
    v_cvt_pk_bf16_f32 v155, v214, v215
    v_mfma_f32_16x16x32_bf16 a[68:71], a[160:163], v[168:171], a[68:71]
    buffer_load_dwordx4 a[152:155], v254, s[80:83], s57 offen
    v_smfmac_f32_16x16x64_bf16 a[204:207], v[52:55], v[184:191], v50
    ds_write_b64 v244, v[224:225]
    v_mfma_f32_16x16x32_bf16 v[212:215], a[208:211], v[80:83], v[196:199]
    v_exp_f32 v208, v208
    v_mfma_f32_16x16x32_bf16 v[212:215], a[212:215], v[84:87], v[212:215]
    v_exp_f32 v209, v209
    v_mfma_f32_16x16x32_bf16 v[212:215], a[216:219], v[88:91], v[212:215]
    v_exp_f32 v210, v210
    v_mfma_f32_16x16x32_bf16 v[212:215], a[220:223], v[92:95], v[212:215]
    v_exp_f32 v211, v211
    v_mfma_f32_16x16x32_bf16 a[72:75], a[160:163], v[176:179], a[72:75]
    ds_read_b64_tr_b16 a[176:177], v26 offset:16384
    v_cvt_pk_bf16_f32 v132, v208, v209
    v_mfma_f32_16x16x32_bf16 a[72:75], a[164:167], v[180:183], a[72:75]
    ds_read_b64_tr_b16 a[178:179], v26 offset:20480
    v_add_u32 v245, 131136, v245
    v_mfma_f32_16x16x32_bf16 a[76:79], a[164:167], v[188:191], a[76:79]
    ds_read_b128 a[232:235], v10 offset:45056
    v_cvt_pk_bf16_f32 v133, v210, v211
    v_mfma_f32_16x16x32_bf16 a[76:79], a[160:163], v[184:187], a[76:79]
    s_waitcnt lgkmcnt(3)
    buffer_load_dwordx4 v41, s[12:15], s41 offen offset:3072 lds
    v_mfma_f32_16x16x32_bf16 v[208:211], a[208:211], v[96:99], v[200:203]
    v_exp_f32 v212, v212
    v_mfma_f32_16x16x32_bf16 v[208:211], a[212:215], v[100:103], v[208:211]
    s_add_u32 s41, s41, 16384
    v_exp_f32 v213, v213
    v_mfma_f32_16x16x32_bf16 v[208:211], a[216:219], v[104:107], v[208:211]
    v_exp_f32 v214, v214
    v_mfma_f32_16x16x32_bf16 v[208:211], a[220:223], v[108:111], v[208:211]
    v_exp_f32 v215, v215
    v_mfma_f32_16x16x32_bf16 a[80:83], a[168:171], v[160:163], a[80:83]
    ds_read_b64_tr_b16 a[180:181], v26 offset:24576
    v_cvt_pk_bf16_f32 v140, v212, v213
    v_mfma_f32_16x16x32_bf16 a[80:83], a[172:175], v[164:167], a[80:83]
    ds_read_b64_tr_b16 a[182:183], v26 offset:28672
    v_mfma_f32_16x16x32_bf16 a[84:87], a[172:175], v[172:175], a[84:87]
    ds_read_b128 a[236:239], v11 offset:45056
    v_cvt_pk_bf16_f32 v141, v214, v215
    v_mfma_f32_16x16x32_bf16 a[84:87], a[168:171], v[168:171], a[84:87]
    s_waitcnt vmcnt(14)
    s_barrier
    v_mfma_f32_16x16x32_bf16 v[212:215], a[208:211], v[112:115], v[204:207]
    v_exp_f32 v208, v208
    v_mfma_f32_16x16x32_bf16 v[212:215], a[212:215], v[116:119], v[212:215]
    s_add_u32 s49, s45, 74752
    v_exp_f32 v209, v209
    v_mfma_f32_16x16x32_bf16 v[212:215], a[216:219], v[120:123], v[212:215]
    s_add_u32 m0, s42, 16384
    v_exp_f32 v210, v210
    v_mfma_f32_16x16x32_bf16 v[212:215], a[220:223], v[124:127], v[212:215]
    v_exp_f32 v211, v211
    v_mfma_f32_16x16x32_bf16 a[88:91], a[168:171], v[176:179], a[88:91]
    ds_read_b64_tr_b16 a[184:185], v27 offset:16384
    v_cvt_pk_bf16_f32 v148, v208, v209
    v_mfma_f32_16x16x32_bf16 a[88:91], a[172:175], v[180:183], a[88:91]
    ds_read_b64_tr_b16 a[186:187], v27 offset:20480
    ds_read_b64 v[224:225], v245 offset:0
    v_mfma_f32_16x16x32_bf16 a[92:95], a[172:175], v[188:191], a[92:95]
    ds_read_b128 a[208:211], v8 offset:49152
    v_cvt_pk_bf16_f32 v149, v210, v211
    v_mfma_f32_16x16x32_bf16 a[92:95], a[168:171], v[184:187], a[92:95]
    s_waitcnt lgkmcnt(3)
    buffer_load_dwordx4 v46, s[20:23], s49 offen lds
    v_mfma_f32_16x16x32_bf16 v[208:211], a[224:227], v[64:67], v[192:195]
    v_exp_f32 v212, v212
    v_mfma_f32_16x16x32_bf16 v[208:211], a[228:231], v[68:71], v[208:211]
    v_exp_f32 v213, v213
    v_mfma_f32_16x16x32_bf16 v[208:211], a[232:235], v[72:75], v[208:211]
    v_exp_f32 v214, v214
    v_mfma_f32_16x16x32_bf16 v[208:211], a[236:239], v[76:79], v[208:211]
    s_add_u32 s37, s55, 8192
    v_exp_f32 v215, v215
    v_mfma_f32_16x16x32_bf16 a[96:99], a[176:179], v[160:163], a[96:99]
    ds_read_b64_tr_b16 a[188:189], v27 offset:24576
    v_cvt_pk_bf16_f32 v156, v212, v213
    v_mfma_f32_16x16x32_bf16 a[96:99], a[180:183], v[164:167], a[96:99]
    ds_read_b64_tr_b16 a[190:191], v27 offset:28672
    ds_read_b64 v[226:227], v245 offset:64
    v_mfma_f32_16x16x32_bf16 a[100:103], a[180:183], v[172:175], a[100:103]
    ds_read_b128 a[212:215], v9 offset:49152
    v_cvt_pk_bf16_f32 v157, v214, v215
    v_mfma_f32_16x16x32_bf16 a[100:103], a[176:179], v[168:171], a[100:103]
    buffer_load_dword v234, v238, s[28:31], s37 offen
    v_mfma_f32_16x16x32_bf16 v[212:215], a[224:227], v[80:83], v[196:199]
    v_exp_f32 v208, v208
    v_mfma_f32_16x16x32_bf16 v[212:215], a[228:231], v[84:87], v[212:215]
    v_exp_f32 v209, v209
    v_mfma_f32_16x16x32_bf16 v[212:215], a[232:235], v[88:91], v[212:215]
    v_exp_f32 v210, v210
    v_mfma_f32_16x16x32_bf16 v[212:215], a[236:239], v[92:95], v[212:215]
    v_exp_f32 v211, v211
    v_mfma_f32_16x16x32_bf16 a[104:107], a[176:179], v[176:179], a[104:107]
    ds_read_b64_tr_b16 a[160:161], v20 offset:32768
    v_cvt_pk_bf16_f32 v134, v208, v209
    v_mfma_f32_16x16x32_bf16 a[104:107], a[180:183], v[180:183], a[104:107]
    ds_read_b64_tr_b16 a[162:163], v20 offset:36864
    ds_read_b64 v[228:229], v245 offset:128
    v_mfma_f32_16x16x32_bf16 a[108:111], a[180:183], v[188:191], a[108:111]
    ds_read_b128 a[216:219], v10 offset:49152
    v_cvt_pk_bf16_f32 v135, v210, v211
    v_mfma_f32_16x16x32_bf16 a[108:111], a[176:179], v[184:187], a[108:111]
    s_waitcnt lgkmcnt(3)
    buffer_load_dwordx4 v47, s[20:23], s49 offen offset:1024 lds
    v_mfma_f32_16x16x32_bf16 v[208:211], a[224:227], v[96:99], v[200:203]
    v_exp_f32 v212, v212
    v_mfma_f32_16x16x32_bf16 v[208:211], a[228:231], v[100:103], v[208:211]
    v_exp_f32 v213, v213
    v_mfma_f32_16x16x32_bf16 v[208:211], a[232:235], v[104:107], v[208:211]
    v_exp_f32 v214, v214
    v_mfma_f32_16x16x32_bf16 v[208:211], a[236:239], v[108:111], v[208:211]
    s_add_u32 s57, s58, 4128768
    v_exp_f32 v215, v215
    v_mfma_f32_16x16x32_bf16 a[112:115], a[184:187], v[160:163], a[112:115]
    ds_read_b64_tr_b16 a[164:165], v20 offset:40960
    v_cvt_pk_bf16_f32 v142, v212, v213
    v_mfma_f32_16x16x32_bf16 a[112:115], a[188:191], v[164:167], a[112:115]
    ds_read_b64_tr_b16 a[166:167], v20 offset:45056
    ds_read_b64 v[230:231], v245 offset:192
    v_mfma_f32_16x16x32_bf16 a[116:119], a[188:191], v[172:175], a[116:119]
    ds_read_b128 a[220:223], v11 offset:49152
    v_cvt_pk_bf16_f32 v143, v214, v215
    v_mfma_f32_16x16x32_bf16 a[116:119], a[184:187], v[168:171], a[116:119]
    buffer_load_dwordx4 a[156:159], v254, s[80:83], s57 offen
    v_mfma_f32_16x16x32_bf16 v[212:215], a[224:227], v[112:115], v[204:207]
    v_exp_f32 v208, v208
    v_mfma_f32_16x16x32_bf16 v[212:215], a[228:231], v[116:119], v[212:215]
    v_exp_f32 v209, v209
    v_mfma_f32_16x16x32_bf16 v[212:215], a[232:235], v[120:123], v[212:215]
    v_exp_f32 v210, v210
    v_mfma_f32_16x16x32_bf16 v[212:215], a[236:239], v[124:127], v[212:215]
    v_exp_f32 v211, v211
    v_mfma_f32_16x16x32_bf16 a[120:123], a[184:187], v[176:179], a[120:123]
    ds_read_b64_tr_b16 a[168:169], v21 offset:32768
    v_cvt_pk_bf16_f32 v150, v208, v209
    v_mfma_f32_16x16x32_bf16 a[120:123], a[188:191], v[180:183], a[120:123]
    ds_read_b64_tr_b16 a[170:171], v21 offset:36864
    v_mfma_f32_16x16x32_bf16 a[124:127], a[188:191], v[188:191], a[124:127]
    ds_read_b128 a[224:227], v8 offset:53248
    v_cvt_pk_bf16_f32 v151, v210, v211
    v_mfma_f32_16x16x32_bf16 a[124:127], a[184:187], v[184:187], a[124:127]
    s_waitcnt lgkmcnt(3)
    buffer_load_dwordx4 v48, s[20:23], s49 offen offset:2048 lds
    v_mfma_f32_16x16x32_bf16 v[208:211], a[208:211], v[64:67], v[192:195]
    v_exp_f32 v212, v212
    v_mfma_f32_16x16x32_bf16 v[208:211], a[212:215], v[68:71], v[208:211]
    v_exp_f32 v213, v213
    v_mfma_f32_16x16x32_bf16 v[208:211], a[216:219], v[72:75], v[208:211]
    v_exp_f32 v214, v214
    v_mfma_f32_16x16x32_bf16 v[208:211], a[220:223], v[76:79], v[208:211]
    s_add_u32 s57, s58, 4718592
    v_exp_f32 v215, v215
    v_mfma_f32_16x16x32_bf16 a[0:3], a[160:163], v[128:131], a[0:3]
    ds_read_b64_tr_b16 a[172:173], v21 offset:40960
    v_cvt_pk_bf16_f32 v158, v212, v213
    v_mfma_f32_16x16x32_bf16 a[0:3], a[164:167], v[132:135], a[0:3]
    ds_read_b64_tr_b16 a[174:175], v21 offset:45056
    v_add_f32 v224, v224, v228
    v_mfma_f32_16x16x32_bf16 a[4:7], a[164:167], v[140:143], a[4:7]
    ds_read_b128 a[228:231], v9 offset:53248
    v_cvt_pk_bf16_f32 v159, v214, v215
    v_mfma_f32_16x16x32_bf16 a[4:7], a[160:163], v[136:139], a[4:7]
    buffer_load_dwordx4 a[240:243], v254, s[80:83], s57 offen
    v_mfma_f32_16x16x32_bf16 v[212:215], a[208:211], v[80:83], v[196:199]
    v_exp_f32 v208, v208
    v_mfma_f32_16x16x32_bf16 v[212:215], a[212:215], v[84:87], v[212:215]
    v_exp_f32 v209, v209
    v_mfma_f32_16x16x32_bf16 v[212:215], a[216:219], v[88:91], v[212:215]
    v_exp_f32 v210, v210
    v_mfma_f32_16x16x32_bf16 v[212:215], a[220:223], v[92:95], v[212:215]
    v_exp_f32 v211, v211
    v_mfma_f32_16x16x32_bf16 a[8:11], a[160:163], v[144:147], a[8:11]
    ds_read_b64_tr_b16 a[176:177], v22 offset:32768
    v_cvt_pk_bf16_f32 v160, v208, v209
    v_mfma_f32_16x16x32_bf16 a[8:11], a[164:167], v[148:151], a[8:11]
    ds_read_b64_tr_b16 a[178:179], v22 offset:36864
    v_add_f32 v225, v225, v229
    v_mfma_f32_16x16x32_bf16 a[12:15], a[164:167], v[156:159], a[12:15]
    ds_read_b128 a[232:235], v10 offset:53248
    v_cvt_pk_bf16_f32 v161, v210, v211
    v_mfma_f32_16x16x32_bf16 a[12:15], a[160:163], v[152:155], a[12:15]
    s_waitcnt lgkmcnt(3)
    buffer_load_dwordx4 v49, s[20:23], s49 offen offset:3072 lds
    v_mfma_f32_16x16x32_bf16 v[208:211], a[208:211], v[96:99], v[200:203]
    v_exp_f32 v212, v212
    v_mfma_f32_16x16x32_bf16 v[208:211], a[212:215], v[100:103], v[208:211]
    v_exp_f32 v213, v213
    v_mfma_f32_16x16x32_bf16 v[208:211], a[216:219], v[104:107], v[208:211]
    v_exp_f32 v214, v214
    v_mfma_f32_16x16x32_bf16 v[208:211], a[220:223], v[108:111], v[208:211]
    v_exp_f32 v215, v215
    v_mfma_f32_16x16x32_bf16 a[16:19], a[168:171], v[128:131], a[16:19]
    ds_read_b64_tr_b16 a[180:181], v22 offset:40960
    v_cvt_pk_bf16_f32 v168, v212, v213
    v_mfma_f32_16x16x32_bf16 a[16:19], a[172:175], v[132:135], a[16:19]
    ds_read_b64_tr_b16 a[182:183], v22 offset:45056
    v_add_f32 v226, v226, v230
    v_mfma_f32_16x16x32_bf16 a[20:23], a[172:175], v[140:143], a[20:23]
    ds_read_b128 a[236:239], v11 offset:53248
    v_cvt_pk_bf16_f32 v169, v214, v215
    v_mfma_f32_16x16x32_bf16 a[20:23], a[168:171], v[136:139], a[20:23]
    v_add_f32 v227, v227, v231
    v_add_f32 v224, v224, v226
    v_smfmac_f32_16x16x64_bf16 a[192:195], v[52:55], v[128:135], v50
    v_mfma_f32_16x16x32_bf16 v[212:215], a[208:211], v[112:115], v[204:207]
    v_exp_f32 v208, v208
    v_mfma_f32_16x16x32_bf16 v[212:215], a[212:215], v[116:119], v[212:215]
    s_add_u32 s49, s7, 0
    v_exp_f32 v209, v209
    v_mfma_f32_16x16x32_bf16 v[212:215], a[216:219], v[120:123], v[212:215]
    s_add_u32 m0, s42, 65536
    v_exp_f32 v210, v210
    v_mfma_f32_16x16x32_bf16 v[212:215], a[220:223], v[124:127], v[212:215]
    v_exp_f32 v211, v211
    v_mfma_f32_16x16x32_bf16 a[24:27], a[168:171], v[144:147], a[24:27]
    ds_read_b64_tr_b16 a[184:185], v23 offset:32768
    v_cvt_pk_bf16_f32 v176, v208, v209
    v_mfma_f32_16x16x32_bf16 a[24:27], a[172:175], v[148:151], a[24:27]
    ds_read_b64_tr_b16 a[186:187], v23 offset:36864
    v_add_f32 v225, v225, v227
    v_mfma_f32_16x16x32_bf16 a[28:31], a[172:175], v[156:159], a[28:31]
    ds_read_b128 a[208:211], v8 offset:57344
    v_cvt_pk_bf16_f32 v177, v210, v211
    v_mfma_f32_16x16x32_bf16 a[28:31], a[168:171], v[152:155], a[28:31]
    s_waitcnt lgkmcnt(3)
    buffer_load_dwordx4 v46, s[20:23], s49 offen lds
    v_mfma_f32_16x16x32_bf16 v[208:211], a[224:227], v[64:67], v[192:195]
    v_exp_f32 v212, v212
    v_mfma_f32_16x16x32_bf16 v[208:211], a[228:231], v[68:71], v[208:211]
    v_exp_f32 v213, v213
    v_mfma_f32_16x16x32_bf16 v[208:211], a[232:235], v[72:75], v[208:211]
    v_exp_f32 v214, v214
    v_mfma_f32_16x16x32_bf16 v[208:211], a[236:239], v[76:79], v[208:211]
    s_add_u32 s57, s58, 4128768
    v_exp_f32 v215, v215
    v_mfma_f32_16x16x32_bf16 a[32:35], a[176:179], v[128:131], a[32:35]
    ds_read_b64_tr_b16 a[188:189], v23 offset:40960
    v_cvt_pk_bf16_f32 v184, v212, v213
    v_mfma_f32_16x16x32_bf16 a[32:35], a[180:183], v[132:135], a[32:35]
    ds_read_b64_tr_b16 a[190:191], v23 offset:45056
    v_cvt_pk_bf16_f32 v246, v224, v225
    v_mfma_f32_16x16x32_bf16 a[36:39], a[180:183], v[140:143], a[36:39]
    ds_read_b128 a[212:215], v9 offset:57344
    v_cvt_pk_bf16_f32 v185, v214, v215
    v_mfma_f32_16x16x32_bf16 a[36:39], a[176:179], v[136:139], a[36:39]
    buffer_load_dwordx4 a[244:247], v254, s[32:35], s57 offen
    v_smfmac_f32_16x16x64_bf16 a[196:199], v[52:55], v[136:143], v50
    v_mfma_f32_16x16x32_bf16 v[212:215], a[224:227], v[80:83], v[196:199]
    v_exp_f32 v208, v208
    v_mfma_f32_16x16x32_bf16 v[212:215], a[228:231], v[84:87], v[212:215]
    v_exp_f32 v209, v209
    v_mfma_f32_16x16x32_bf16 v[212:215], a[232:235], v[88:91], v[212:215]
    v_exp_f32 v210, v210
    v_mfma_f32_16x16x32_bf16 v[212:215], a[236:239], v[92:95], v[212:215]
    v_exp_f32 v211, v211
    v_mfma_f32_16x16x32_bf16 a[40:43], a[176:179], v[144:147], a[40:43]
    ds_read_b64_tr_b16 a[160:161], v24 offset:32768
    v_cvt_pk_bf16_f32 v162, v208, v209
    v_mfma_f32_16x16x32_bf16 a[40:43], a[180:183], v[148:151], a[40:43]
    ds_read_b64_tr_b16 a[162:163], v24 offset:36864
    v_lshlrev_b32 v224, 16, v246
    v_mfma_f32_16x16x32_bf16 a[44:47], a[180:183], v[156:159], a[44:47]
    ds_read_b128 a[216:219], v10 offset:57344
    v_cvt_pk_bf16_f32 v163, v210, v211
    v_mfma_f32_16x16x32_bf16 a[44:47], a[176:179], v[152:155], a[44:47]
    s_waitcnt lgkmcnt(3)
    buffer_load_dwordx4 v47, s[20:23], s49 offen offset:1024 lds
    v_mfma_f32_16x16x32_bf16 v[208:211], a[224:227], v[96:99], v[200:203]
    v_exp_f32 v212, v212
    v_mfma_f32_16x16x32_bf16 v[208:211], a[228:231], v[100:103], v[208:211]
    v_exp_f32 v213, v213
    v_mfma_f32_16x16x32_bf16 v[208:211], a[232:235], v[104:107], v[208:211]
    v_exp_f32 v214, v214
    v_mfma_f32_16x16x32_bf16 v[208:211], a[236:239], v[108:111], v[208:211]
    v_exp_f32 v215, v215
    v_mfma_f32_16x16x32_bf16 a[48:51], a[184:187], v[128:131], a[48:51]
    ds_read_b64_tr_b16 a[164:165], v24 offset:40960
    v_cvt_pk_bf16_f32 v170, v212, v213
    v_mfma_f32_16x16x32_bf16 a[48:51], a[188:191], v[132:135], a[48:51]
    ds_read_b64_tr_b16 a[166:167], v24 offset:45056
    v_and_b32 v225, 0xffff0000, v246
    v_mfma_f32_16x16x32_bf16 a[52:55], a[188:191], v[140:143], a[52:55]
    ds_read_b128 a[220:223], v11 offset:57344
    v_cvt_pk_bf16_f32 v171, v214, v215
    v_mfma_f32_16x16x32_bf16 a[52:55], a[184:187], v[136:139], a[52:55]
    v_add_f32 v224, s36, v224
    v_add_f32 v225, s36, v225
    v_smfmac_f32_16x16x64_bf16 a[200:203], v[52:55], v[144:151], v50
    v_mfma_f32_16x16x32_bf16 v[212:215], a[224:227], v[112:115], v[204:207]
    v_exp_f32 v208, v208
    v_mfma_f32_16x16x32_bf16 v[212:215], a[228:231], v[116:119], v[212:215]
    v_exp_f32 v209, v209
    v_mfma_f32_16x16x32_bf16 v[212:215], a[232:235], v[120:123], v[212:215]
    v_exp_f32 v210, v210
    v_mfma_f32_16x16x32_bf16 v[212:215], a[236:239], v[124:127], v[212:215]
    v_exp_f32 v211, v211
    v_mfma_f32_16x16x32_bf16 a[56:59], a[184:187], v[144:147], a[56:59]
    ds_read_b64_tr_b16 a[168:169], v25 offset:32768
    v_cvt_pk_bf16_f32 v178, v208, v209
    v_mfma_f32_16x16x32_bf16 a[56:59], a[188:191], v[148:151], a[56:59]
    ds_read_b64_tr_b16 a[170:171], v25 offset:36864
    v_cvt_pk_bf16_f32 v246, v224, v225
    v_mfma_f32_16x16x32_bf16 a[60:63], a[188:191], v[156:159], a[60:63]
    ds_read_b128 a[224:227], v8 offset:61440
    v_cvt_pk_bf16_f32 v179, v210, v211
    v_mfma_f32_16x16x32_bf16 a[60:63], a[184:187], v[152:155], a[60:63]
    s_waitcnt lgkmcnt(3)
    buffer_load_dwordx4 v48, s[20:23], s49 offen offset:2048 lds
    v_mfma_f32_16x16x32_bf16 v[208:211], a[208:211], v[64:67], v[192:195]
    v_exp_f32 v212, v212
    v_mfma_f32_16x16x32_bf16 v[208:211], a[212:215], v[68:71], v[208:211]
    v_exp_f32 v213, v213
    v_mfma_f32_16x16x32_bf16 v[208:211], a[216:219], v[72:75], v[208:211]
    v_exp_f32 v214, v214
    v_mfma_f32_16x16x32_bf16 v[208:211], a[220:223], v[76:79], v[208:211]
    s_add_u32 s57, s58, 4718592
    v_exp_f32 v215, v215
    v_mfma_f32_16x16x32_bf16 a[64:67], a[160:163], v[128:131], a[64:67]
    ds_read_b64_tr_b16 a[172:173], v25 offset:40960
    v_cvt_pk_bf16_f32 v186, v212, v213
    v_mfma_f32_16x16x32_bf16 a[64:67], a[164:167], v[132:135], a[64:67]
Ltour7:
    s_cbranch_execz Ltour11
    ds_read_b64_tr_b16 a[174:175], v25 offset:45056
    v_lshrrev_b32 v244, 1, v0
    v_mfma_f32_16x16x32_bf16 a[68:71], a[164:167], v[140:143], a[68:71]
    ds_read_b128 a[228:231], v9 offset:61440
    v_cvt_pk_bf16_f32 v187, v214, v215
    v_mfma_f32_16x16x32_bf16 a[68:71], a[160:163], v[136:139], a[68:71]
    buffer_load_dwordx4 a[248:251], v254, s[32:35], s57 offen
    v_smfmac_f32_16x16x64_bf16 a[204:207], v[52:55], v[152:159], v50
    v_mfma_f32_16x16x32_bf16 v[212:215], a[208:211], v[80:83], v[196:199]
    v_exp_f32 v208, v208
    v_mfma_f32_16x16x32_bf16 v[212:215], a[212:215], v[84:87], v[212:215]
    v_exp_f32 v209, v209
    v_mfma_f32_16x16x32_bf16 v[212:215], a[216:219], v[88:91], v[212:215]
    v_exp_f32 v210, v210
    v_mfma_f32_16x16x32_bf16 v[212:215], a[220:223], v[92:95], v[212:215]
    v_exp_f32 v211, v211
    v_mfma_f32_16x16x32_bf16 a[72:75], a[160:163], v[144:147], a[72:75]
    ds_read_b64_tr_b16 a[176:177], v26 offset:32768
    v_cvt_pk_bf16_f32 v164, v208, v209
    v_mfma_f32_16x16x32_bf16 a[72:75], a[164:167], v[148:151], a[72:75]
    ds_read_b64_tr_b16 a[178:179], v26 offset:36864
    v_lshlrev_b32 v244, 4, v244
    v_mfma_f32_16x16x32_bf16 a[76:79], a[164:167], v[156:159], a[76:79]
    ds_read_b128 a[232:235], v10 offset:61440
    v_cvt_pk_bf16_f32 v165, v210, v211
    v_mfma_f32_16x16x32_bf16 a[76:79], a[160:163], v[152:155], a[76:79]
    s_waitcnt lgkmcnt(3)
    buffer_load_dwordx4 v49, s[20:23], s49 offen offset:3072 lds
    v_mfma_f32_16x16x32_bf16 v[208:211], a[208:211], v[96:99], v[200:203]
    v_exp_f32 v212, v212
    v_mfma_f32_16x16x32_bf16 v[208:211], a[212:215], v[100:103], v[208:211]
    v_exp_f32 v213, v213
    v_mfma_f32_16x16x32_bf16 v[208:211], a[216:219], v[104:107], v[208:211]
    v_exp_f32 v214, v214
    v_mfma_f32_16x16x32_bf16 v[208:211], a[220:223], v[108:111], v[208:211]
    v_exp_f32 v215, v215
    v_mfma_f32_16x16x32_bf16 a[80:83], a[168:171], v[128:131], a[80:83]
    ds_read_b64_tr_b16 a[180:181], v26 offset:40960
    v_cvt_pk_bf16_f32 v172, v212, v213
    v_mfma_f32_16x16x32_bf16 a[80:83], a[172:175], v[132:135], a[80:83]
    ds_read_b64_tr_b16 a[182:183], v26 offset:45056
    v_and_b32 v245, 1, v0
    v_mfma_f32_16x16x32_bf16 a[84:87], a[172:175], v[140:143], a[84:87]
    ds_read_b128 a[236:239], v11 offset:61440
    v_cvt_pk_bf16_f32 v173, v214, v215
    v_mfma_f32_16x16x32_bf16 a[84:87], a[168:171], v[136:139], a[84:87]
    s_waitcnt vmcnt(13)
    s_barrier
    v_mfma_f32_16x16x32_bf16 v[212:215], a[208:211], v[112:115], v[204:207]
    v_exp_f32 v208, v208
    v_mfma_f32_16x16x32_bf16 v[212:215], a[212:215], v[116:119], v[212:215]
    s_add_u32 s49, s7, 73728
    v_exp_f32 v209, v209
    v_mfma_f32_16x16x32_bf16 v[212:215], a[216:219], v[120:123], v[212:215]
    s_add_u32 m0, s42, 81920
    v_exp_f32 v210, v210
    v_mfma_f32_16x16x32_bf16 v[212:215], a[220:223], v[124:127], v[212:215]
    v_exp_f32 v211, v211
    v_mfma_f32_16x16x32_bf16 a[88:91], a[168:171], v[144:147], a[88:91]
    ds_read_b64_tr_b16 a[184:185], v27 offset:32768
    v_cvt_pk_bf16_f32 v180, v208, v209
    v_mfma_f32_16x16x32_bf16 a[88:91], a[172:175], v[148:151], a[88:91]
    ds_read_b64_tr_b16 a[186:187], v27 offset:36864
    v_lshl_add_u32 v244, v245, 2, v244
    v_mfma_f32_16x16x32_bf16 a[92:95], a[172:175], v[156:159], a[92:95]
    v_cvt_pk_bf16_f32 v181, v210, v211
    v_mfma_f32_16x16x32_bf16 a[92:95], a[168:171], v[152:155], a[92:95]
    s_waitcnt lgkmcnt(3)
    buffer_load_dwordx4 v46, s[20:23], s49 offen lds
    v_mfma_f32_16x16x32_bf16 v[208:211], a[224:227], v[64:67], v[192:195]
    v_exp_f32 v212, v212
    v_mfma_f32_16x16x32_bf16 v[208:211], a[228:231], v[68:71], v[208:211]
    v_exp_f32 v213, v213
    v_mfma_f32_16x16x32_bf16 v[208:211], a[232:235], v[72:75], v[208:211]
    s_waitcnt lgkmcnt(2)
    v_exp_f32 v214, v214
    v_mfma_f32_16x16x32_bf16 v[208:211], a[236:239], v[76:79], v[208:211]
    v_exp_f32 v215, v215
    v_mfma_f32_16x16x32_bf16 a[96:99], a[176:179], v[128:131], a[96:99]
    ds_read_b64_tr_b16 a[188:189], v27 offset:40960
    v_cvt_pk_bf16_f32 v188, v212, v213
    v_mfma_f32_16x16x32_bf16 a[96:99], a[180:183], v[132:135], a[96:99]
    ds_read_b64_tr_b16 a[190:191], v27 offset:45056
    v_lshrrev_b32 v245, 3, v0
    v_mfma_f32_16x16x32_bf16 a[100:103], a[180:183], v[140:143], a[100:103]
    v_cvt_pk_bf16_f32 v189, v214, v215
    v_mfma_f32_16x16x32_bf16 a[100:103], a[176:179], v[136:139], a[100:103]
    v_min_u32 v245, 1, v245
    v_lshl_or_b32 v244, v245, 31, v244
    v_mfma_f32_16x16x32_bf16 v[212:215], a[224:227], v[80:83], v[196:199]
    v_exp_f32 v208, v208
    v_mfma_f32_16x16x32_bf16 v[212:215], a[228:231], v[84:87], v[212:215]
    v_exp_f32 v209, v209
    v_mfma_f32_16x16x32_bf16 v[212:215], a[232:235], v[88:91], v[212:215]
    v_exp_f32 v210, v210
    v_mfma_f32_16x16x32_bf16 v[212:215], a[236:239], v[92:95], v[212:215]
    v_exp_f32 v211, v211
    v_mfma_f32_16x16x32_bf16 a[104:107], a[176:179], v[144:147], a[104:107]
    ds_read_b64_tr_b16 a[160:161], v20 offset:49152
    v_cvt_pk_bf16_f32 v166, v208, v209
    v_mfma_f32_16x16x32_bf16 a[104:107], a[180:183], v[148:151], a[104:107]
    ds_read_b64_tr_b16 a[162:163], v20 offset:53248
    v_mfma_f32_16x16x32_bf16 a[108:111], a[180:183], v[156:159], a[108:111]
    v_cvt_pk_bf16_f32 v167, v210, v211
    v_mfma_f32_16x16x32_bf16 a[108:111], a[176:179], v[152:155], a[108:111]
    s_waitcnt lgkmcnt(3)
    buffer_load_dwordx4 v47, s[20:23], s49 offen offset:1024 lds
    v_mfma_f32_16x16x32_bf16 v[208:211], a[224:227], v[96:99], v[200:203]
    v_exp_f32 v212, v212
    v_mfma_f32_16x16x32_bf16 v[208:211], a[228:231], v[100:103], v[208:211]
    v_exp_f32 v213, v213
    v_mfma_f32_16x16x32_bf16 v[208:211], a[232:235], v[104:107], v[208:211]
    v_exp_f32 v214, v214
    v_mfma_f32_16x16x32_bf16 v[208:211], a[236:239], v[108:111], v[208:211]
    s_add_u32 s57, s59, 0
    v_exp_f32 v215, v215
    v_mfma_f32_16x16x32_bf16 a[112:115], a[184:187], v[128:131], a[112:115]
    s_waitcnt lgkmcnt(2)
    ds_read_b64_tr_b16 a[164:165], v20 offset:57344
    v_cvt_pk_bf16_f32 v174, v212, v213
    v_mfma_f32_16x16x32_bf16 a[112:115], a[188:191], v[132:135], a[112:115]
    ds_read_b64_tr_b16 a[166:167], v20 offset:61440
    v_mfma_f32_16x16x32_bf16 a[116:119], a[188:191], v[140:143], a[116:119]
    v_cvt_pk_bf16_f32 v175, v214, v215
    v_mfma_f32_16x16x32_bf16 a[116:119], a[184:187], v[136:139], a[116:119]
    buffer_load_dwordx4 a[252:255], v255, s[84:87], s57 offen
    v_mfma_f32_16x16x32_bf16 v[212:215], a[224:227], v[112:115], v[204:207]
    v_exp_f32 v208, v208
    v_mfma_f32_16x16x32_bf16 v[212:215], a[228:231], v[116:119], v[212:215]
    v_exp_f32 v209, v209
    v_mfma_f32_16x16x32_bf16 v[212:215], a[232:235], v[120:123], v[212:215]
    v_exp_f32 v210, v210
    v_mfma_f32_16x16x32_bf16 v[212:215], a[236:239], v[124:127], v[212:215]
    v_exp_f32 v211, v211
    v_mfma_f32_16x16x32_bf16 a[120:123], a[184:187], v[144:147], a[120:123]
    ds_read_b64_tr_b16 a[168:169], v21 offset:49152
    v_cvt_pk_bf16_f32 v182, v208, v209
    v_mfma_f32_16x16x32_bf16 a[120:123], a[188:191], v[148:151], a[120:123]
    ds_read_b64_tr_b16 a[170:171], v21 offset:53248
    v_mfma_f32_16x16x32_bf16 a[124:127], a[188:191], v[156:159], a[124:127]
    v_cvt_pk_bf16_f32 v183, v210, v211
    v_mfma_f32_16x16x32_bf16 a[124:127], a[184:187], v[152:155], a[124:127]
    s_waitcnt lgkmcnt(3)
    buffer_load_dwordx4 v48, s[20:23], s49 offen offset:2048 lds
    v_smfmac_f32_16x16x64_bf16 a[192:195], v[52:55], v[160:167], v50
    v_exp_f32 v212, v212
    v_smfmac_f32_16x16x64_bf16 a[196:199], v[52:55], v[168:175], v50
    v_exp_f32 v213, v213
    v_smfmac_f32_16x16x64_bf16 a[200:203], v[52:55], v[176:183], v50
    v_exp_f32 v214, v214
    v_exp_f32 v215, v215
    v_mfma_f32_16x16x32_bf16 a[0:3], a[160:163], v[160:163], a[0:3]
    s_waitcnt lgkmcnt(2)
    ds_read_b64_tr_b16 a[172:173], v21 offset:57344
    v_cvt_pk_bf16_f32 v190, v212, v213
    v_mfma_f32_16x16x32_bf16 a[0:3], a[164:167], v[164:167], a[0:3]
    ds_read_b64_tr_b16 a[174:175], v21 offset:61440
    v_mfma_f32_16x16x32_bf16 a[4:7], a[164:167], v[172:175], a[4:7]
    v_cvt_pk_bf16_f32 v191, v214, v215
    v_mfma_f32_16x16x32_bf16 a[4:7], a[160:163], v[168:171], a[4:7]
    buffer_store_dword v246, v244, s[24:27], s39 offen sc1
    v_smfmac_f32_16x16x64_bf16 a[204:207], v[52:55], v[184:191], v50
    v_mfma_f32_16x16x32_bf16 a[8:11], a[160:163], v[176:179], a[8:11]
    ds_read_b64_tr_b16 a[176:177], v22 offset:49152
    v_mfma_f32_16x16x32_bf16 a[8:11], a[164:167], v[180:183], a[8:11]
    ds_read_b64_tr_b16 a[178:179], v22 offset:53248
    v_accvgpr_read_b32 v216, a192
    v_accvgpr_read_b32 v217, a193
    v_mfma_f32_16x16x32_bf16 a[12:15], a[164:167], v[188:191], a[12:15]
    v_accvgpr_read_b32 v218, a196
    v_accvgpr_read_b32 v219, a197
    v_mfma_f32_16x16x32_bf16 a[12:15], a[160:163], v[184:187], a[12:15]
    s_waitcnt lgkmcnt(4)
    buffer_load_dwordx4 v49, s[20:23], s49 offen offset:3072 lds
    v_accvgpr_read_b32 v220, a200
    v_accvgpr_read_b32 v221, a201
    v_mfma_f32_16x16x32_bf16 a[16:19], a[168:171], v[160:163], a[16:19]
    s_waitcnt lgkmcnt(2)
    ds_read_b64_tr_b16 a[180:181], v22 offset:57344
    v_accvgpr_read_b32 v222, a204
    v_mfma_f32_16x16x32_bf16 a[16:19], a[172:175], v[164:167], a[16:19]
    ds_read_b64_tr_b16 a[182:183], v22 offset:61440
    v_accvgpr_read_b32 v223, a205
    v_add_f32 v58, v216, v217
    v_mfma_f32_16x16x32_bf16 a[20:23], a[172:175], v[172:175], a[20:23]
    v_add_f32 v59, v218, v219
    v_add_f32 v60, v220, v221
    v_mfma_f32_16x16x32_bf16 a[20:23], a[168:171], v[168:171], a[20:23]
    v_add_f32 v61, v222, v223
    v_add_f32 v216, v58, v59
    s_add_u32 s49, s7, 256
    s_add_u32 m0, s42, 32768
    v_mfma_f32_16x16x32_bf16 a[24:27], a[168:171], v[176:179], a[24:27]
    ds_read_b64_tr_b16 a[184:185], v23 offset:49152
    v_add_f32 v217, v60, v61
    v_mfma_f32_16x16x32_bf16 a[24:27], a[172:175], v[180:183], a[24:27]
    ds_read_b64_tr_b16 a[186:187], v23 offset:53248
    v_add_f32 v216, v216, v217
    v_cmp_ngt_f32 vcc, 1669332992, v216
    v_mfma_f32_16x16x32_bf16 a[28:31], a[172:175], v[188:191], a[28:31]
    v_rcp_f32 v58, v58
    v_rcp_f32 v59, v59
    v_mfma_f32_16x16x32_bf16 a[28:31], a[168:171], v[184:187], a[28:31]
    s_waitcnt lgkmcnt(4)
    buffer_load_dwordx4 v46, s[20:23], s49 offen lds
    v_rcp_f32 v60, v60
    v_rcp_f32 v61, v61
    v_mfma_f32_16x16x32_bf16 a[32:35], a[176:179], v[160:163], a[32:35]
    s_waitcnt lgkmcnt(2)
    ds_read_b64_tr_b16 a[188:189], v23 offset:57344
    v_mov_b32 v228, 131072
    v_mfma_f32_16x16x32_bf16 a[32:35], a[180:183], v[164:167], a[32:35]
    ds_read_b64_tr_b16 a[190:191], v23 offset:61440
    s_or_b32 s36, vcc_lo, vcc_hi
    v_mfma_f32_16x16x32_bf16 a[36:39], a[180:183], v[172:175], a[36:39]
    v_accvgpr_read_b32 v208, a0
    v_accvgpr_read_b32 v209, a1
    v_accvgpr_read_b32 v210, a2
    v_accvgpr_read_b32 v211, a3
    v_pk_mul_f32 v[208:209], v[208:209], v[58:59] op_sel:[0,0] op_sel_hi:[1,0]
    v_pk_mul_f32 v[210:211], v[210:211], v[58:59] op_sel:[0,0] op_sel_hi:[1,0]
    v_cvt_pk_bf16_f32 v128, v208, v209
    v_cvt_pk_bf16_f32 v129, v210, v211
    v_mfma_f32_16x16x32_bf16 a[36:39], a[176:179], v[168:171], a[36:39]
    v_accvgpr_read_b32 v212, a4
    v_accvgpr_read_b32 v213, a5
    v_accvgpr_read_b32 v214, a6
    v_accvgpr_read_b32 v215, a7
    v_pk_mul_f32 v[212:213], v[212:213], v[58:59] op_sel:[0,1] op_sel_hi:[1,1]
    v_pk_mul_f32 v[214:215], v[214:215], v[58:59] op_sel:[0,1] op_sel_hi:[1,1]
    v_cvt_pk_bf16_f32 v132, v212, v213
    v_cvt_pk_bf16_f32 v133, v214, v215
    v_mfma_f32_16x16x32_bf16 a[40:43], a[176:179], v[176:179], a[40:43]
    ds_read_b64_tr_b16 a[160:161], v24 offset:49152
    v_mov_b32 v218, s36
    v_mfma_f32_16x16x32_bf16 a[40:43], a[180:183], v[180:183], a[40:43]
    ds_read_b64_tr_b16 a[162:163], v24 offset:53248
    s_lshl_b32 s38, s3, 2
    v_mfma_f32_16x16x32_bf16 a[44:47], a[180:183], v[188:191], a[44:47]
    v_accvgpr_read_b32 v208, a8
    v_accvgpr_read_b32 v209, a9
    v_accvgpr_read_b32 v210, a10
    v_accvgpr_read_b32 v211, a11
    v_pk_mul_f32 v[208:209], v[208:209], v[60:61] op_sel:[0,0] op_sel_hi:[1,0]
    v_pk_mul_f32 v[210:211], v[210:211], v[60:61] op_sel:[0,0] op_sel_hi:[1,0]
    v_cvt_pk_bf16_f32 v136, v208, v209
    v_cvt_pk_bf16_f32 v137, v210, v211
    v_mfma_f32_16x16x32_bf16 a[44:47], a[176:179], v[184:187], a[44:47]
    s_waitcnt lgkmcnt(4)
    buffer_load_dwordx4 v47, s[20:23], s49 offen offset:1024 lds
    v_accvgpr_read_b32 v212, a12
    v_accvgpr_read_b32 v213, a13
    v_accvgpr_read_b32 v214, a14
    v_accvgpr_read_b32 v215, a15
    v_pk_mul_f32 v[212:213], v[212:213], v[60:61] op_sel:[0,1] op_sel_hi:[1,1]
    v_pk_mul_f32 v[214:215], v[214:215], v[60:61] op_sel:[0,1] op_sel_hi:[1,1]
    v_cvt_pk_bf16_f32 v140, v212, v213
    v_cvt_pk_bf16_f32 v141, v214, v215
    v_mfma_f32_16x16x32_bf16 a[48:51], a[184:187], v[160:163], a[48:51]
    s_waitcnt lgkmcnt(2)
    ds_read_b64_tr_b16 a[164:165], v24 offset:57344
    v_add_u32 v219, s38, v228
    v_mfma_f32_16x16x32_bf16 a[48:51], a[188:191], v[164:167], a[48:51]
    ds_read_b64_tr_b16 a[166:167], v24 offset:61440
    ds_write_b32 v219, v218
    v_mfma_f32_16x16x32_bf16 a[52:55], a[188:191], v[172:175], a[52:55]
    v_accvgpr_read_b32 v208, a16
    v_accvgpr_read_b32 v209, a17
    v_accvgpr_read_b32 v210, a18
    v_accvgpr_read_b32 v211, a19
    v_pk_mul_f32 v[208:209], v[208:209], v[58:59] op_sel:[0,0] op_sel_hi:[1,0]
    v_pk_mul_f32 v[210:211], v[210:211], v[58:59] op_sel:[0,0] op_sel_hi:[1,0]
    v_cvt_pk_bf16_f32 v130, v208, v209
    v_cvt_pk_bf16_f32 v131, v210, v211
    s_add_u32 s37, s55, 0
    buffer_store_dwordx4 v[128:131], v252, s[28:31], s37 offen offset:0
    v_mfma_f32_16x16x32_bf16 a[52:55], a[184:187], v[168:171], a[52:55]
    v_accvgpr_read_b32 v212, a20
    v_accvgpr_read_b32 v213, a21
    v_accvgpr_read_b32 v214, a22
    v_accvgpr_read_b32 v215, a23
    v_pk_mul_f32 v[212:213], v[212:213], v[58:59] op_sel:[0,1] op_sel_hi:[1,1]
    v_pk_mul_f32 v[214:215], v[214:215], v[58:59] op_sel:[0,1] op_sel_hi:[1,1]
    v_cvt_pk_bf16_f32 v134, v212, v213
    v_cvt_pk_bf16_f32 v135, v214, v215
    s_add_u32 s37, s55, 8192
    buffer_store_dwordx4 v[132:135], v252, s[28:31], s37 offen offset:0
    v_mfma_f32_16x16x32_bf16 a[56:59], a[184:187], v[176:179], a[56:59]
    ds_read_b64_tr_b16 a[168:169], v25 offset:49152
    v_min_u32 v240, 1, v0
    v_mfma_f32_16x16x32_bf16 a[56:59], a[188:191], v[180:183], a[56:59]
    ds_read_b64_tr_b16 a[170:171], v25 offset:53248
    v_mfma_f32_16x16x32_bf16 a[60:63], a[188:191], v[188:191], a[60:63]
    v_accvgpr_read_b32 v208, a24
    v_accvgpr_read_b32 v209, a25
    v_accvgpr_read_b32 v210, a26
    v_accvgpr_read_b32 v211, a27
    v_pk_mul_f32 v[208:209], v[208:209], v[60:61] op_sel:[0,0] op_sel_hi:[1,0]
    v_pk_mul_f32 v[210:211], v[210:211], v[60:61] op_sel:[0,0] op_sel_hi:[1,0]
    v_cvt_pk_bf16_f32 v138, v208, v209
    v_cvt_pk_bf16_f32 v139, v210, v211
    s_add_u32 s37, s55, 4096
    buffer_store_dwordx4 v[136:139], v252, s[28:31], s37 offen offset:0
    v_mfma_f32_16x16x32_bf16 a[60:63], a[184:187], v[184:187], a[60:63]
    s_waitcnt lgkmcnt(5)
    buffer_load_dwordx4 v48, s[20:23], s49 offen offset:2048 lds
    v_accvgpr_read_b32 v212, a28
    v_accvgpr_read_b32 v213, a29
    v_accvgpr_read_b32 v214, a30
    v_accvgpr_read_b32 v215, a31
    v_pk_mul_f32 v[212:213], v[212:213], v[60:61] op_sel:[0,1] op_sel_hi:[1,1]
    v_pk_mul_f32 v[214:215], v[214:215], v[60:61] op_sel:[0,1] op_sel_hi:[1,1]
    v_cvt_pk_bf16_f32 v142, v212, v213
    v_cvt_pk_bf16_f32 v143, v214, v215
    s_add_u32 s37, s55, 12288
    buffer_store_dwordx4 v[140:143], v252, s[28:31], s37 offen offset:0
    v_mfma_f32_16x16x32_bf16 a[64:67], a[160:163], v[160:163], a[64:67]
    s_waitcnt lgkmcnt(3)
    ds_read_b64_tr_b16 a[172:173], v25 offset:57344
    v_lshlrev_b32 v240, 31, v240
    v_mfma_f32_16x16x32_bf16 a[64:67], a[164:167], v[164:167], a[64:67]
    ds_read_b64_tr_b16 a[174:175], v25 offset:61440
    v_mfma_f32_16x16x32_bf16 a[68:71], a[164:167], v[172:175], a[68:71]
    v_accvgpr_read_b32 v208, a32
    v_accvgpr_read_b32 v209, a33
    v_accvgpr_read_b32 v210, a34
    v_accvgpr_read_b32 v211, a35
    v_pk_mul_f32 v[208:209], v[208:209], v[58:59] op_sel:[0,0] op_sel_hi:[1,0]
    v_pk_mul_f32 v[210:211], v[210:211], v[58:59] op_sel:[0,0] op_sel_hi:[1,0]
    v_cvt_pk_bf16_f32 v144, v208, v209
    v_cvt_pk_bf16_f32 v145, v210, v211
    v_mfma_f32_16x16x32_bf16 a[68:71], a[160:163], v[168:171], a[68:71]
    v_accvgpr_read_b32 v212, a36
    v_accvgpr_read_b32 v213, a37
    v_accvgpr_read_b32 v214, a38
    v_accvgpr_read_b32 v215, a39
    v_pk_mul_f32 v[212:213], v[212:213], v[58:59] op_sel:[0,1] op_sel_hi:[1,1]
    v_pk_mul_f32 v[214:215], v[214:215], v[58:59] op_sel:[0,1] op_sel_hi:[1,1]
    v_cvt_pk_bf16_f32 v148, v212, v213
    v_cvt_pk_bf16_f32 v149, v214, v215
    v_mfma_f32_16x16x32_bf16 a[72:75], a[160:163], v[176:179], a[72:75]
    ds_read_b64_tr_b16 a[176:177], v26 offset:49152
    v_mov_b32 v241, 1
    v_mfma_f32_16x16x32_bf16 a[72:75], a[164:167], v[180:183], a[72:75]
    ds_read_b64_tr_b16 a[178:179], v26 offset:53248
    v_mfma_f32_16x16x32_bf16 a[76:79], a[164:167], v[188:191], a[76:79]
    v_accvgpr_read_b32 v208, a40
    v_accvgpr_read_b32 v209, a41
    v_accvgpr_read_b32 v210, a42
    v_accvgpr_read_b32 v211, a43
    v_pk_mul_f32 v[208:209], v[208:209], v[60:61] op_sel:[0,0] op_sel_hi:[1,0]
    v_pk_mul_f32 v[210:211], v[210:211], v[60:61] op_sel:[0,0] op_sel_hi:[1,0]
    v_cvt_pk_bf16_f32 v152, v208, v209
    v_cvt_pk_bf16_f32 v153, v210, v211
    v_mfma_f32_16x16x32_bf16 a[76:79], a[160:163], v[184:187], a[76:79]
    s_waitcnt lgkmcnt(4)
    buffer_load_dwordx4 v49, s[20:23], s49 offen offset:3072 lds
    v_accvgpr_read_b32 v212, a44
    v_accvgpr_read_b32 v213, a45
    v_accvgpr_read_b32 v214, a46
    v_accvgpr_read_b32 v215, a47
    v_pk_mul_f32 v[212:213], v[212:213], v[60:61] op_sel:[0,1] op_sel_hi:[1,1]
    v_pk_mul_f32 v[214:215], v[214:215], v[60:61] op_sel:[0,1] op_sel_hi:[1,1]
    v_cvt_pk_bf16_f32 v156, v212, v213
    v_cvt_pk_bf16_f32 v157, v214, v215
    v_mfma_f32_16x16x32_bf16 a[80:83], a[168:171], v[160:163], a[80:83]
    s_waitcnt lgkmcnt(2)
    ds_read_b64_tr_b16 a[180:181], v26 offset:57344
    v_mfma_f32_16x16x32_bf16 a[80:83], a[172:175], v[164:167], a[80:83]
    ds_read_b64_tr_b16 a[182:183], v26 offset:61440
    v_mfma_f32_16x16x32_bf16 a[84:87], a[172:175], v[172:175], a[84:87]
    v_accvgpr_read_b32 v208, a48
    v_accvgpr_read_b32 v209, a49
    v_accvgpr_read_b32 v210, a50
    v_accvgpr_read_b32 v211, a51
    v_pk_mul_f32 v[208:209], v[208:209], v[58:59] op_sel:[0,0] op_sel_hi:[1,0]
    v_pk_mul_f32 v[210:211], v[210:211], v[58:59] op_sel:[0,0] op_sel_hi:[1,0]
    v_cvt_pk_bf16_f32 v146, v208, v209
    v_cvt_pk_bf16_f32 v147, v210, v211
    s_add_u32 s37, s55, 0
    buffer_store_dwordx4 v[144:147], v252, s[28:31], s37 offen offset:1024
    v_mfma_f32_16x16x32_bf16 a[84:87], a[168:171], v[168:171], a[84:87]
    v_accvgpr_read_b32 v212, a52
    v_accvgpr_read_b32 v213, a53
    v_accvgpr_read_b32 v214, a54
    v_accvgpr_read_b32 v215, a55
    v_pk_mul_f32 v[212:213], v[212:213], v[58:59] op_sel:[0,1] op_sel_hi:[1,1]
    v_pk_mul_f32 v[214:215], v[214:215], v[58:59] op_sel:[0,1] op_sel_hi:[1,1]
    v_cvt_pk_bf16_f32 v150, v212, v213
    v_cvt_pk_bf16_f32 v151, v214, v215
    s_add_u32 s37, s55, 8192
    buffer_store_dwordx4 v[148:151], v252, s[28:31], s37 offen offset:1024
    s_waitcnt vmcnt(22)
    s_barrier
    v_mfma_f32_16x16x32_bf16 a[88:91], a[168:171], v[176:179], a[88:91]
    ds_read_b64_tr_b16 a[184:185], v27 offset:49152
    v_mfma_f32_16x16x32_bf16 a[88:91], a[172:175], v[180:183], a[88:91]
    ds_read_b64_tr_b16 a[186:187], v27 offset:53248
    v_mfma_f32_16x16x32_bf16 a[92:95], a[172:175], v[188:191], a[92:95]
    ds_read_b128 v[224:227], v228
    v_accvgpr_read_b32 v208, a56
    v_accvgpr_read_b32 v209, a57
    v_accvgpr_read_b32 v210, a58
    v_accvgpr_read_b32 v211, a59
    v_pk_mul_f32 v[208:209], v[208:209], v[60:61] op_sel:[0,0] op_sel_hi:[1,0]
    v_pk_mul_f32 v[210:211], v[210:211], v[60:61] op_sel:[0,0] op_sel_hi:[1,0]
    v_cvt_pk_bf16_f32 v154, v208, v209
    v_cvt_pk_bf16_f32 v155, v210, v211
    s_add_u32 s37, s55, 4096
    buffer_store_dwordx4 v[152:155], v252, s[28:31], s37 offen offset:1024
    v_mfma_f32_16x16x32_bf16 a[92:95], a[168:171], v[184:187], a[92:95]
    s_waitcnt lgkmcnt(5)
    v_accvgpr_read_b32 v212, a60
    v_accvgpr_read_b32 v213, a61
    v_accvgpr_read_b32 v214, a62
    v_accvgpr_read_b32 v215, a63
    v_pk_mul_f32 v[212:213], v[212:213], v[60:61] op_sel:[0,1] op_sel_hi:[1,1]
    v_pk_mul_f32 v[214:215], v[214:215], v[60:61] op_sel:[0,1] op_sel_hi:[1,1]
    v_cvt_pk_bf16_f32 v158, v212, v213
    v_cvt_pk_bf16_f32 v159, v214, v215
    s_add_u32 s37, s55, 12288
    buffer_store_dwordx4 v[156:159], v252, s[28:31], s37 offen offset:1024
    s_add_u32 s49, s7, 73984
    v_mfma_f32_16x16x32_bf16 a[96:99], a[176:179], v[160:163], a[96:99]
    s_waitcnt lgkmcnt(3)
    s_add_u32 m0, s42, 49152
    ds_read_b64_tr_b16 a[188:189], v27 offset:57344
    v_mfma_f32_16x16x32_bf16 a[96:99], a[180:183], v[164:167], a[96:99]
    buffer_load_dwordx4 v46, s[20:23], s49 offen lds
    v_mfma_f32_16x16x32_bf16 a[100:103], a[180:183], v[172:175], a[100:103]
    ds_read_b64_tr_b16 a[190:191], v27 offset:61440
    v_accvgpr_read_b32 v208, a64
    v_accvgpr_read_b32 v209, a65
    v_accvgpr_read_b32 v210, a66
    v_accvgpr_read_b32 v211, a67
    v_pk_mul_f32 v[208:209], v[208:209], v[58:59] op_sel:[0,0] op_sel_hi:[1,0]
    v_pk_mul_f32 v[210:211], v[210:211], v[58:59] op_sel:[0,0] op_sel_hi:[1,0]
    v_cvt_pk_bf16_f32 v192, v208, v209
    v_cvt_pk_bf16_f32 v193, v210, v211
    v_mfma_f32_16x16x32_bf16 a[100:103], a[176:179], v[168:171], a[100:103]
    buffer_load_dwordx4 v47, s[20:23], s49 offen offset:1024 lds
    v_accvgpr_read_b32 v212, a68
    v_accvgpr_read_b32 v213, a69
    v_accvgpr_read_b32 v214, a70
    v_accvgpr_read_b32 v215, a71
    v_pk_mul_f32 v[212:213], v[212:213], v[58:59] op_sel:[0,1] op_sel_hi:[1,1]
    v_pk_mul_f32 v[214:215], v[214:215], v[58:59] op_sel:[0,1] op_sel_hi:[1,1]
    v_cvt_pk_bf16_f32 v196, v212, v213
    v_cvt_pk_bf16_f32 v197, v214, v215
    v_mfma_f32_16x16x32_bf16 a[104:107], a[176:179], v[176:179], a[104:107]
    v_mfma_f32_16x16x32_bf16 a[104:107], a[180:183], v[180:183], a[104:107]
    buffer_load_dwordx4 v48, s[20:23], s49 offen offset:2048 lds
    v_mfma_f32_16x16x32_bf16 a[108:111], a[180:183], v[188:191], a[108:111]
    v_accvgpr_read_b32 v208, a72
    v_accvgpr_read_b32 v209, a73
    v_accvgpr_read_b32 v210, a74
    v_accvgpr_read_b32 v211, a75
    v_pk_mul_f32 v[208:209], v[208:209], v[60:61] op_sel:[0,0] op_sel_hi:[1,0]
    v_pk_mul_f32 v[210:211], v[210:211], v[60:61] op_sel:[0,0] op_sel_hi:[1,0]
    v_cvt_pk_bf16_f32 v200, v208, v209
    v_cvt_pk_bf16_f32 v201, v210, v211
    v_mfma_f32_16x16x32_bf16 a[108:111], a[176:179], v[184:187], a[108:111]
    s_waitcnt lgkmcnt(3)
    buffer_load_dwordx4 v49, s[20:23], s49 offen offset:3072 lds
    v_accvgpr_read_b32 v212, a76
    v_accvgpr_read_b32 v213, a77
    v_accvgpr_read_b32 v214, a78
    v_accvgpr_read_b32 v215, a79
    v_pk_mul_f32 v[212:213], v[212:213], v[60:61] op_sel:[0,1] op_sel_hi:[1,1]
    v_pk_mul_f32 v[214:215], v[214:215], v[60:61] op_sel:[0,1] op_sel_hi:[1,1]
    v_cvt_pk_bf16_f32 v204, v212, v213
    v_cvt_pk_bf16_f32 v205, v214, v215
    s_add_u32 s49, s46, 0
    v_mfma_f32_16x16x32_bf16 a[112:115], a[184:187], v[160:163], a[112:115]
    s_waitcnt lgkmcnt(0)
    s_add_u32 m0, s42, 98304
    v_mfma_f32_16x16x32_bf16 a[112:115], a[188:191], v[164:167], a[112:115]
    buffer_load_dwordx4 v46, s[20:23], s49 offen lds
    v_mfma_f32_16x16x32_bf16 a[116:119], a[188:191], v[172:175], a[116:119]
    v_accvgpr_read_b32 v208, a80
    v_accvgpr_read_b32 v209, a81
    v_accvgpr_read_b32 v210, a82
    v_accvgpr_read_b32 v211, a83
    v_pk_mul_f32 v[208:209], v[208:209], v[58:59] op_sel:[0,0] op_sel_hi:[1,0]
    v_pk_mul_f32 v[210:211], v[210:211], v[58:59] op_sel:[0,0] op_sel_hi:[1,0]
    v_cvt_pk_bf16_f32 v194, v208, v209
    v_cvt_pk_bf16_f32 v195, v210, v211
    s_add_u32 s37, s55, 0
    buffer_store_dwordx4 v[192:195], v252, s[28:31], s37 offen offset:2048
    v_mfma_f32_16x16x32_bf16 a[116:119], a[184:187], v[168:171], a[116:119]
    buffer_load_dwordx4 v47, s[20:23], s49 offen offset:1024 lds
    v_accvgpr_read_b32 v212, a84
    v_accvgpr_read_b32 v213, a85
    v_accvgpr_read_b32 v214, a86
    v_accvgpr_read_b32 v215, a87
    v_pk_mul_f32 v[212:213], v[212:213], v[58:59] op_sel:[0,1] op_sel_hi:[1,1]
    v_pk_mul_f32 v[214:215], v[214:215], v[58:59] op_sel:[0,1] op_sel_hi:[1,1]
    v_cvt_pk_bf16_f32 v198, v212, v213
    v_cvt_pk_bf16_f32 v199, v214, v215
    s_add_u32 s37, s55, 8192
    buffer_store_dwordx4 v[196:199], v252, s[28:31], s37 offen offset:2048
    v_mfma_f32_16x16x32_bf16 a[120:123], a[184:187], v[176:179], a[120:123]
    v_mfma_f32_16x16x32_bf16 a[120:123], a[188:191], v[180:183], a[120:123]
    buffer_load_dwordx4 v48, s[20:23], s49 offen offset:2048 lds
    v_mfma_f32_16x16x32_bf16 a[124:127], a[188:191], v[188:191], a[124:127]
    v_accvgpr_read_b32 v208, a88
    v_accvgpr_read_b32 v209, a89
    v_accvgpr_read_b32 v210, a90
    v_accvgpr_read_b32 v211, a91
    v_pk_mul_f32 v[208:209], v[208:209], v[60:61] op_sel:[0,0] op_sel_hi:[1,0]
    v_pk_mul_f32 v[210:211], v[210:211], v[60:61] op_sel:[0,0] op_sel_hi:[1,0]
    v_cvt_pk_bf16_f32 v202, v208, v209
    v_cvt_pk_bf16_f32 v203, v210, v211
    s_add_u32 s37, s55, 4096
    buffer_store_dwordx4 v[200:203], v252, s[28:31], s37 offen offset:2048
    v_mfma_f32_16x16x32_bf16 a[124:127], a[184:187], v[184:187], a[124:127]
    buffer_load_dwordx4 v49, s[20:23], s49 offen offset:3072 lds
    v_accvgpr_read_b32 v212, a92
    v_accvgpr_read_b32 v213, a93
    v_accvgpr_read_b32 v214, a94
    v_accvgpr_read_b32 v215, a95
    v_pk_mul_f32 v[212:213], v[212:213], v[60:61] op_sel:[0,1] op_sel_hi:[1,1]
    v_pk_mul_f32 v[214:215], v[214:215], v[60:61] op_sel:[0,1] op_sel_hi:[1,1]
    v_cvt_pk_bf16_f32 v206, v212, v213
    v_cvt_pk_bf16_f32 v207, v214, v215
    s_add_u32 s37, s55, 12288
    buffer_store_dwordx4 v[204:207], v252, s[28:31], s37 offen offset:2048
    v_or3_b32 v224, v224, v225, v226
    v_or_b32 v224, v224, v227
    s_nop 0
    v_readfirstlane_b32 s36, v224
    v_readfirstlane_b32 s38, v253
    v_min_u32 v8, 1, v1
    v_lshlrev_b32 v8, 31, v8
    v_mov_b32 v10, s95
    s_getreg_b32 s39, hwreg(HW_REG_XCC_ID, 0, 4)
    s_lshl_b32 s39, s39, 28
    s_xor_b32 s39, s39, s95
    s_cmp_eq_u32 s38, s39
    s_cselect_b32 s53, 1, 0
    ds_read_b64_tr_b16 a[208:209], v12 offset:0
    ds_read_b64_tr_b16 a[210:211], v12 offset:4096
    ds_read_b64_tr_b16 a[212:213], v12 offset:8192
    ds_read_b64_tr_b16 a[214:215], v12 offset:12288
    ds_read_b64_tr_b16 a[216:217], v12 offset:16384
    ds_read_b64_tr_b16 a[218:219], v12 offset:20480
    ds_read_b64_tr_b16 a[220:221], v12 offset:24576
    ds_read_b64_tr_b16 a[222:223], v12 offset:28672
    ds_read_b64_tr_b16 a[224:225], v16 offset:0
    ds_read_b64_tr_b16 a[226:227], v16 offset:4096
    ds_read_b64_tr_b16 a[228:229], v16 offset:8192
    ds_read_b64_tr_b16 a[230:231], v16 offset:12288
    ds_read_b64_tr_b16 a[232:233], v16 offset:16384
    ds_read_b64_tr_b16 a[234:235], v16 offset:20480
    ds_read_b64_tr_b16 a[236:237], v16 offset:24576
    ds_read_b64_tr_b16 a[238:239], v16 offset:28672
    s_andn2_b32 s36, s36, s48
    s_cbranch_scc1 Lattn_redo
    v_accvgpr_read_b32 v208, a96
    v_accvgpr_read_b32 v209, a97
    v_accvgpr_read_b32 v210, a98
    v_accvgpr_read_b32 v211, a99
    v_pk_mul_f32 v[208:209], v[208:209], v[58:59] op_sel:[0,0] op_sel_hi:[1,0]
    v_pk_mul_f32 v[210:211], v[210:211], v[58:59] op_sel:[0,0] op_sel_hi:[1,0]
Ltour8:
    s_cbranch_execz Ltour12
    v_cvt_pk_bf16_f32 v176, v208, v209
    v_cvt_pk_bf16_f32 v177, v210, v211
    v_accvgpr_read_b32 v212, a100
    v_accvgpr_read_b32 v213, a101
    v_accvgpr_read_b32 v214, a102
    v_accvgpr_read_b32 v215, a103
    v_pk_mul_f32 v[212:213], v[212:213], v[58:59] op_sel:[0,1] op_sel_hi:[1,1]
    v_pk_mul_f32 v[214:215], v[214:215], v[58:59] op_sel:[0,1] op_sel_hi:[1,1]
    v_cvt_pk_bf16_f32 v180, v212, v213
    v_cvt_pk_bf16_f32 v181, v214, v215
    v_accvgpr_read_b32 v208, a104
    v_accvgpr_read_b32 v209, a105
    v_accvgpr_read_b32 v210, a106
    v_accvgpr_read_b32 v211, a107
    v_pk_mul_f32 v[208:209], v[208:209], v[60:61] op_sel:[0,0] op_sel_hi:[1,0]
    v_pk_mul_f32 v[210:211], v[210:211], v[60:61] op_sel:[0,0] op_sel_hi:[1,0]
    v_cvt_pk_bf16_f32 v184, v208, v209
    v_cvt_pk_bf16_f32 v185, v210, v211
    v_accvgpr_read_b32 v212, a108
    v_accvgpr_read_b32 v213, a109
    v_accvgpr_read_b32 v214, a110
    v_accvgpr_read_b32 v215, a111
    v_pk_mul_f32 v[212:213], v[212:213], v[60:61] op_sel:[0,1] op_sel_hi:[1,1]
    v_pk_mul_f32 v[214:215], v[214:215], v[60:61] op_sel:[0,1] op_sel_hi:[1,1]
    v_cvt_pk_bf16_f32 v188, v212, v213
    v_cvt_pk_bf16_f32 v189, v214, v215
    v_accvgpr_read_b32 v208, a112
    v_accvgpr_read_b32 v209, a113
    v_accvgpr_read_b32 v210, a114
    v_accvgpr_read_b32 v211, a115
    v_pk_mul_f32 v[208:209], v[208:209], v[58:59] op_sel:[0,0] op_sel_hi:[1,0]
    v_pk_mul_f32 v[210:211], v[210:211], v[58:59] op_sel:[0,0] op_sel_hi:[1,0]
    v_cvt_pk_bf16_f32 v178, v208, v209
    v_cvt_pk_bf16_f32 v179, v210, v211
    s_add_u32 s37, s55, 0
    buffer_store_dwordx4 v[176:179], v252, s[28:31], s37 offen offset:3072
    v_accvgpr_read_b32 v212, a116
    v_accvgpr_read_b32 v213, a117
    v_accvgpr_read_b32 v214, a118
    v_accvgpr_read_b32 v215, a119
    v_pk_mul_f32 v[212:213], v[212:213], v[58:59] op_sel:[0,1] op_sel_hi:[1,1]
    v_pk_mul_f32 v[214:215], v[214:215], v[58:59] op_sel:[0,1] op_sel_hi:[1,1]
    v_cvt_pk_bf16_f32 v182, v212, v213
    v_cvt_pk_bf16_f32 v183, v214, v215
    s_add_u32 s37, s55, 8192
    buffer_store_dwordx4 v[180:183], v252, s[28:31], s37 offen offset:3072
    v_accvgpr_read_b32 v208, a120
    v_accvgpr_read_b32 v209, a121
    v_accvgpr_read_b32 v210, a122
    v_accvgpr_read_b32 v211, a123
    v_pk_mul_f32 v[208:209], v[208:209], v[60:61] op_sel:[0,0] op_sel_hi:[1,0]
    v_pk_mul_f32 v[210:211], v[210:211], v[60:61] op_sel:[0,0] op_sel_hi:[1,0]
    v_cvt_pk_bf16_f32 v186, v208, v209
    v_cvt_pk_bf16_f32 v187, v210, v211
    s_add_u32 s37, s55, 4096
    buffer_store_dwordx4 v[184:187], v252, s[28:31], s37 offen offset:3072
    v_accvgpr_read_b32 v212, a124
    v_accvgpr_read_b32 v213, a125
    v_accvgpr_read_b32 v214, a126
    v_accvgpr_read_b32 v215, a127
    v_pk_mul_f32 v[212:213], v[212:213], v[60:61] op_sel:[0,1] op_sel_hi:[1,1]
    v_pk_mul_f32 v[214:215], v[214:215], v[60:61] op_sel:[0,1] op_sel_hi:[1,1]
    v_cvt_pk_bf16_f32 v190, v212, v213
    v_cvt_pk_bf16_f32 v191, v214, v215
    s_add_u32 s37, s55, 12288
    buffer_store_dwordx4 v[188:191], v252, s[28:31], s37 offen offset:3072
    s_waitcnt lgkmcnt(14)
    v_mfma_f32_16x16x32_bf16 v[96:99], a[208:211], v[128:131], 0
    s_waitcnt lgkmcnt(12)
    ds_read_b64_tr_b16 a[160:161], v13 offset:0
    v_mfma_f32_16x16x32_bf16 v[96:99], a[212:215], v[144:147], v[96:99]
    s_waitcnt lgkmcnt(11)
    ds_read_b64_tr_b16 a[162:163], v13 offset:4096
    v_mfma_f32_16x16x32_bf16 v[96:99], a[216:219], v[192:195], v[96:99]
    s_waitcnt lgkmcnt(10)
    ds_read_b64_tr_b16 a[164:165], v13 offset:8192
    v_mfma_f32_16x16x32_bf16 v[96:99], a[220:223], v[176:179], v[96:99]
    s_waitcnt lgkmcnt(9)
    ds_read_b64_tr_b16 a[166:167], v13 offset:12288
    v_mfma_f32_16x16x32_bf16 v[96:99], a[224:227], v[136:139], v[96:99]
    s_waitcnt lgkmcnt(8)
    ds_read_b64_tr_b16 a[168:169], v13 offset:16384
    v_mfma_f32_16x16x32_bf16 v[96:99], a[228:231], v[152:155], v[96:99]
    s_waitcnt lgkmcnt(7)
    ds_read_b64_tr_b16 a[170:171], v13 offset:20480
    v_mfma_f32_16x16x32_bf16 v[96:99], a[232:235], v[200:203], v[96:99]
    s_waitcnt lgkmcnt(6)
    ds_read_b64_tr_b16 a[172:173], v13 offset:24576
    v_mfma_f32_16x16x32_bf16 v[96:99], a[236:239], v[184:187], v[96:99]
    ds_read_b64_tr_b16 a[174:175], v13 offset:28672
    v_mfma_f32_16x16x32_bf16 v[100:103], a[236:239], v[188:191], 0
    ds_read_b64_tr_b16 a[176:177], v17 offset:0
    v_mfma_f32_16x16x32_bf16 v[100:103], a[232:235], v[204:207], v[100:103]
    ds_read_b64_tr_b16 a[178:179], v17 offset:4096
    v_mfma_f32_16x16x32_bf16 v[100:103], a[228:231], v[156:159], v[100:103]
    ds_read_b64_tr_b16 a[180:181], v17 offset:8192
    v_mfma_f32_16x16x32_bf16 v[100:103], a[224:227], v[140:143], v[100:103]
    ds_read_b64_tr_b16 a[182:183], v17 offset:12288
    v_mfma_f32_16x16x32_bf16 v[100:103], a[220:223], v[180:183], v[100:103]
    ds_read_b64_tr_b16 a[184:185], v17 offset:16384
    v_cvt_pk_bf16_f32 v224, v96, v97
    v_mfma_f32_16x16x32_bf16 v[100:103], a[216:219], v[196:199], v[100:103]
    ds_read_b64_tr_b16 a[186:187], v17 offset:20480
    v_cvt_pk_bf16_f32 v225, v98, v99
    v_mfma_f32_16x16x32_bf16 v[100:103], a[212:215], v[148:151], v[100:103]
    ds_read_b64_tr_b16 a[188:189], v17 offset:24576
    v_mfma_f32_16x16x32_bf16 v[100:103], a[208:211], v[132:135], v[100:103]
    s_waitcnt lgkmcnt(13)
    ds_read_b64_tr_b16 a[190:191], v17 offset:28672
    v_mfma_f32_16x16x32_bf16 v[104:107], a[160:163], v[128:131], 0
    s_waitcnt lgkmcnt(12)
    ds_read_b64_tr_b16 a[208:209], v14 offset:0
    v_mfma_f32_16x16x32_bf16 v[104:107], a[164:167], v[144:147], v[104:107]
    s_waitcnt lgkmcnt(11)
    ds_read_b64_tr_b16 a[210:211], v14 offset:4096
    v_mfma_f32_16x16x32_bf16 v[104:107], a[168:171], v[192:195], v[104:107]
    s_waitcnt lgkmcnt(10)
    ds_read_b64_tr_b16 a[212:213], v14 offset:8192
    v_mfma_f32_16x16x32_bf16 v[104:107], a[172:175], v[176:179], v[104:107]
    s_waitcnt lgkmcnt(9)
    ds_read_b64_tr_b16 a[214:215], v14 offset:12288
    v_mfma_f32_16x16x32_bf16 v[104:107], a[176:179], v[136:139], v[104:107]
    s_waitcnt lgkmcnt(8)
    ds_read_b64_tr_b16 a[216:217], v14 offset:16384
    v_cvt_pk_bf16_f32 v228, v100, v101
    v_mfma_f32_16x16x32_bf16 v[104:107], a[180:183], v[152:155], v[104:107]
    s_waitcnt lgkmcnt(7)
    ds_read_b64_tr_b16 a[218:219], v14 offset:20480
    v_cvt_pk_bf16_f32 v229, v102, v103
    v_mfma_f32_16x16x32_bf16 v[104:107], a[184:187], v[200:203], v[104:107]
    s_waitcnt lgkmcnt(6)
    ds_read_b64_tr_b16 a[220:221], v14 offset:24576
    v_mfma_f32_16x16x32_bf16 v[104:107], a[188:191], v[184:187], v[104:107]
    ds_read_b64_tr_b16 a[222:223], v14 offset:28672
    s_waitcnt vmcnt(0)
    s_cmp_eq_u32 s53, 0
    s_cbranch_scc1 Lattn_wb
Lattn_wbdone:
    v_mfma_f32_16x16x32_bf16 v[108:111], a[188:191], v[188:191], 0
    buffer_store_dword v10, v8, s[24:27], s92 offen offset:8 sc1
    v_mfma_f32_16x16x32_bf16 v[108:111], a[184:187], v[204:207], v[108:111]
    s_xor_b32 s55, s55, 65536
    ds_read_b64_tr_b16 a[224:225], v18 offset:0
    ds_read_b64_tr_b16 a[226:227], v18 offset:4096
    v_mfma_f32_16x16x32_bf16 v[108:111], a[180:183], v[156:159], v[108:111]
    buffer_atomic_add v241, v240, s[88:91], 0 offen sc1
    v_mfma_f32_16x16x32_bf16 v[108:111], a[176:179], v[140:143], v[108:111]
    ds_read_b64_tr_b16 a[228:229], v18 offset:8192
    ds_read_b64_tr_b16 a[230:231], v18 offset:12288
    s_load_dwordx2 s[12:13], s[0:1], 0
    v_mfma_f32_16x16x32_bf16 v[108:111], a[172:175], v[180:183], v[108:111]
    ds_read_b64_tr_b16 a[232:233], v18 offset:16384
    v_cvt_pk_bf16_f32 v226, v104, v105
    v_mfma_f32_16x16x32_bf16 v[108:111], a[168:171], v[196:199], v[108:111]
    s_add_u32 s38, s56, 16384
    ds_read_b64_tr_b16 a[234:235], v18 offset:20480
    v_cvt_pk_bf16_f32 v227, v106, v107
    s_load_dwordx2 s[16:17], s[0:1], 96
    v_mfma_f32_16x16x32_bf16 v[108:111], a[164:167], v[148:151], v[108:111]
    buffer_store_dwordx4 v[224:227], v56, s[28:31], s38 offen sc1
    v_mfma_f32_16x16x32_bf16 v[108:111], a[160:163], v[132:135], v[108:111]
    s_waitcnt lgkmcnt(12)
    ds_read_b64_tr_b16 a[236:237], v18 offset:24576
    ds_read_b64_tr_b16 a[238:239], v18 offset:28672
    s_load_dwordx2 s[52:53], s[0:1], 48
    v_mfma_f32_16x16x32_bf16 v[112:115], a[208:211], v[128:131], 0
    s_waitcnt lgkmcnt(12)
    ds_read_b64_tr_b16 a[160:161], v15 offset:0
    v_mfma_f32_16x16x32_bf16 v[112:115], a[212:215], v[144:147], v[112:115]
    s_waitcnt lgkmcnt(11)
    ds_read_b64_tr_b16 a[162:163], v15 offset:4096
    v_mfma_f32_16x16x32_bf16 v[112:115], a[216:219], v[192:195], v[112:115]
    s_waitcnt lgkmcnt(10)
    ds_read_b64_tr_b16 a[164:165], v15 offset:8192
    v_mfma_f32_16x16x32_bf16 v[112:115], a[220:223], v[176:179], v[112:115]
    s_waitcnt lgkmcnt(9)
    ds_read_b64_tr_b16 a[166:167], v15 offset:12288
    v_mfma_f32_16x16x32_bf16 v[112:115], a[224:227], v[136:139], v[112:115]
    s_waitcnt lgkmcnt(8)
    ds_read_b64_tr_b16 a[168:169], v15 offset:16384
    v_cvt_pk_bf16_f32 v230, v108, v109
    v_mfma_f32_16x16x32_bf16 v[112:115], a[228:231], v[152:155], v[112:115]
    s_waitcnt lgkmcnt(7)
    s_add_u32 s38, s56, 180224
    ds_read_b64_tr_b16 a[170:171], v15 offset:20480
    v_cvt_pk_bf16_f32 v231, v110, v111
    v_mfma_f32_16x16x32_bf16 v[112:115], a[232:235], v[200:203], v[112:115]
    s_waitcnt lgkmcnt(6)
    buffer_store_dwordx4 v[228:231], v56, s[28:31], s38 offen sc1
    v_mfma_f32_16x16x32_bf16 v[112:115], a[236:239], v[184:187], v[112:115]
    ds_read_b64_tr_b16 a[172:173], v15 offset:24576
    ds_read_b64_tr_b16 a[174:175], v15 offset:28672
    v_mfma_f32_16x16x32_bf16 v[116:119], a[236:239], v[188:191], 0
    ds_read_b64_tr_b16 a[176:177], v19 offset:0
    v_mfma_f32_16x16x32_bf16 v[116:119], a[232:235], v[204:207], v[116:119]
    ds_read_b64_tr_b16 a[178:179], v19 offset:4096
    v_mfma_f32_16x16x32_bf16 v[116:119], a[228:231], v[156:159], v[116:119]
    ds_read_b64_tr_b16 a[180:181], v19 offset:8192
    v_mfma_f32_16x16x32_bf16 v[116:119], a[224:227], v[140:143], v[116:119]
    ds_read_b64_tr_b16 a[182:183], v19 offset:12288
    v_mfma_f32_16x16x32_bf16 v[116:119], a[220:223], v[180:183], v[116:119]
    ds_read_b64_tr_b16 a[184:185], v19 offset:16384
    v_cvt_pk_bf16_f32 v232, v112, v113
    v_mfma_f32_16x16x32_bf16 v[116:119], a[216:219], v[196:199], v[116:119]
    ds_read_b64_tr_b16 a[186:187], v19 offset:20480
    v_cvt_pk_bf16_f32 v233, v114, v115
    v_mfma_f32_16x16x32_bf16 v[116:119], a[212:215], v[148:151], v[116:119]
    ds_read_b64_tr_b16 a[188:189], v19 offset:24576
    v_mfma_f32_16x16x32_bf16 v[116:119], a[208:211], v[132:135], v[116:119]
    s_waitcnt lgkmcnt(13)
    ds_read_b64_tr_b16 a[190:191], v19 offset:28672
    s_barrier
    v_mfma_f32_16x16x32_bf16 v[120:123], a[160:163], v[128:131], 0
    s_waitcnt lgkmcnt(12)
    buffer_load_dword v11, v8, s[24:27], s54 offen offset:8 sc1
    v_mfma_f32_16x16x32_bf16 v[120:123], a[164:167], v[144:147], v[120:123]
    s_waitcnt lgkmcnt(10)
    ds_read_b64_tr_b16 a[208:209], v20 offset:0
    ds_read_b64_tr_b16 a[210:211], v20 offset:4096
    v_mfma_f32_16x16x32_bf16 v[120:123], a[168:171], v[192:195], v[120:123]
    s_waitcnt lgkmcnt(10)
    ds_read_b64_tr_b16 a[212:213], v20 offset:8192
    v_mfma_f32_16x16x32_bf16 v[120:123], a[172:175], v[176:179], v[120:123]
    s_waitcnt lgkmcnt(9)
    ds_read_b64_tr_b16 a[214:215], v20 offset:12288
    v_mfma_f32_16x16x32_bf16 v[120:123], a[176:179], v[136:139], v[120:123]
    s_waitcnt lgkmcnt(8)
    ds_read_b64_tr_b16 a[216:217], v20 offset:16384
    v_cvt_pk_bf16_f32 v236, v116, v117
    v_mfma_f32_16x16x32_bf16 v[120:123], a[180:183], v[152:155], v[120:123]
    s_waitcnt lgkmcnt(7)
    ds_read_b64_tr_b16 a[218:219], v20 offset:20480
    v_cvt_pk_bf16_f32 v237, v118, v119
    v_mfma_f32_16x16x32_bf16 v[120:123], a[184:187], v[200:203], v[120:123]
    s_waitcnt lgkmcnt(6)
    s_add_u32 s49, s46, 73728
    ds_read_b64_tr_b16 a[220:221], v20 offset:24576
    v_mfma_f32_16x16x32_bf16 v[120:123], a[188:191], v[184:187], v[120:123]
    s_add_u32 m0, s42, 114688
    ds_read_b64_tr_b16 a[222:223], v20 offset:28672
    v_mfma_f32_16x16x32_bf16 v[124:127], a[188:191], v[188:191], 0
    buffer_load_dwordx4 v46, s[20:23], s49 offen lds
    v_mfma_f32_16x16x32_bf16 v[124:127], a[184:187], v[204:207], v[124:127]
    ds_read_b64_tr_b16 a[224:225], v24 offset:0
    ds_read_b64_tr_b16 a[226:227], v24 offset:4096
    v_mfma_f32_16x16x32_bf16 v[124:127], a[180:183], v[156:159], v[124:127]
    buffer_load_dwordx4 v47, s[20:23], s49 offen offset:1024 lds
    v_mfma_f32_16x16x32_bf16 v[124:127], a[176:179], v[140:143], v[124:127]
    ds_read_b64_tr_b16 a[228:229], v24 offset:8192
    ds_read_b64_tr_b16 a[230:231], v24 offset:12288
    v_mfma_f32_16x16x32_bf16 v[124:127], a[172:175], v[180:183], v[124:127]
    ds_read_b64_tr_b16 a[232:233], v24 offset:16384
    v_cvt_pk_bf16_f32 v234, v120, v121
    v_mfma_f32_16x16x32_bf16 v[124:127], a[168:171], v[196:199], v[124:127]
    s_add_u32 s38, s56, 16512
    ds_read_b64_tr_b16 a[234:235], v24 offset:20480
    v_cvt_pk_bf16_f32 v235, v122, v123
    v_mfma_f32_16x16x32_bf16 v[124:127], a[164:167], v[148:151], v[124:127]
    buffer_store_dwordx4 v[232:235], v56, s[28:31], s38 offen sc1
    v_mfma_f32_16x16x32_bf16 v[124:127], a[160:163], v[132:135], v[124:127]
    s_waitcnt lgkmcnt(12)
    ds_read_b64_tr_b16 a[236:237], v24 offset:24576
    ds_read_b64_tr_b16 a[238:239], v24 offset:28672
    v_mfma_f32_16x16x32_bf16 v[64:67], a[208:211], v[128:131], 0
    s_waitcnt lgkmcnt(12)
    buffer_load_dwordx4 v48, s[20:23], s49 offen offset:2048 lds
    v_mfma_f32_16x16x32_bf16 v[64:67], a[212:215], v[144:147], v[64:67]
    s_waitcnt lgkmcnt(10)
    ds_read_b64_tr_b16 a[160:161], v21 offset:0
    ds_read_b64_tr_b16 a[162:163], v21 offset:4096
    v_mfma_f32_16x16x32_bf16 v[64:67], a[216:219], v[192:195], v[64:67]
    s_waitcnt lgkmcnt(10)
    buffer_load_dwordx4 v49, s[20:23], s49 offen offset:3072 lds
    v_mfma_f32_16x16x32_bf16 v[64:67], a[220:223], v[176:179], v[64:67]
    s_waitcnt lgkmcnt(8)
    ds_read_b64_tr_b16 a[164:165], v21 offset:8192
    ds_read_b64_tr_b16 a[166:167], v21 offset:12288
    v_mfma_f32_16x16x32_bf16 v[64:67], a[224:227], v[136:139], v[64:67]
    s_waitcnt lgkmcnt(8)
    ds_read_b64_tr_b16 a[168:169], v21 offset:16384
    v_cvt_pk_bf16_f32 v238, v124, v125
    v_mfma_f32_16x16x32_bf16 v[64:67], a[228:231], v[152:155], v[64:67]
    s_waitcnt lgkmcnt(7)
    s_add_u32 s38, s56, 180352
    ds_read_b64_tr_b16 a[170:171], v21 offset:20480
    v_cvt_pk_bf16_f32 v239, v126, v127
    v_mfma_f32_16x16x32_bf16 v[64:67], a[232:235], v[200:203], v[64:67]
    s_waitcnt lgkmcnt(6)
    buffer_store_dwordx4 v[236:239], v56, s[28:31], s38 offen sc1
    v_mfma_f32_16x16x32_bf16 v[64:67], a[236:239], v[184:187], v[64:67]
    ds_read_b64_tr_b16 a[172:173], v21 offset:24576
    ds_read_b64_tr_b16 a[174:175], v21 offset:28672
    v_mfma_f32_16x16x32_bf16 v[68:71], a[236:239], v[188:191], 0
    s_lshl_b32 s40, s5, 4
    ds_read_b64_tr_b16 a[176:177], v25 offset:0
    v_mfma_f32_16x16x32_bf16 v[68:71], a[232:235], v[204:207], v[68:71]
    s_add_u32 s40, s40, s4
    ds_read_b64_tr_b16 a[178:179], v25 offset:4096
    v_and_b32 v240, 31, v1
    v_mfma_f32_16x16x32_bf16 v[68:71], a[228:231], v[156:159], v[68:71]
    ds_read_b64_tr_b16 a[180:181], v25 offset:8192
    v_lshrrev_b32 v241, 5, v1
    v_mfma_f32_16x16x32_bf16 v[68:71], a[224:227], v[140:143], v[68:71]
    ds_read_b64_tr_b16 a[182:183], v25 offset:12288
    v_cmp_gt_u32 vcc, 8, v240
    v_mfma_f32_16x16x32_bf16 v[68:71], a[220:223], v[180:183], v[68:71]
    ds_read_b64_tr_b16 a[184:185], v25 offset:16384
    v_mov_b32 v242, 2147483648
    v_mfma_f32_16x16x32_bf16 v[68:71], a[216:219], v[196:199], v[68:71]
    s_lshl_b32 s43, s40, 3
    ds_read_b64_tr_b16 a[186:187], v25 offset:20480
    v_mfma_f32_16x16x32_bf16 v[68:71], a[212:215], v[148:151], v[68:71]
    s_lshl_b32 s44, s3, 1
    ds_read_b64_tr_b16 a[188:189], v25 offset:24576
    v_mfma_f32_16x16x32_bf16 v[68:71], a[208:211], v[132:135], v[68:71]
    s_waitcnt lgkmcnt(13)
    s_add_u32 s43, s43, s44
    ds_read_b64_tr_b16 a[190:191], v25 offset:28672
    v_cndmask_b32 v242, v242, 0, vcc
    v_mfma_f32_16x16x32_bf16 v[72:75], a[160:163], v[128:131], 0
    s_waitcnt lgkmcnt(12)
    ds_read_b64_tr_b16 a[208:209], v22 offset:0
    v_add_u32 v7, s43, v241
    v_mfma_f32_16x16x32_bf16 v[72:75], a[164:167], v[144:147], v[72:75]
    s_waitcnt lgkmcnt(11)
    ds_read_b64_tr_b16 a[210:211], v22 offset:4096
    v_lshlrev_b32 v5, 4, v240
    v_mfma_f32_16x16x32_bf16 v[72:75], a[168:171], v[192:195], v[72:75]
    s_waitcnt lgkmcnt(10)
    ds_read_b64_tr_b16 a[212:213], v22 offset:8192
    v_lshlrev_b32 v243, 4, v241
    v_mfma_f32_16x16x32_bf16 v[72:75], a[172:175], v[176:179], v[72:75]
    s_waitcnt lgkmcnt(9)
    ds_read_b64_tr_b16 a[214:215], v22 offset:12288
    v_lshl_add_u32 v2, v240, 5, v243
    v_mfma_f32_16x16x32_bf16 v[72:75], a[176:179], v[136:139], v[72:75]
    s_waitcnt lgkmcnt(8)
    ds_read_b64_tr_b16 a[216:217], v22 offset:16384
    v_lshrrev_b32 v243, 4, v240
    v_mfma_f32_16x16x32_bf16 v[72:75], a[180:183], v[152:155], v[72:75]
    s_waitcnt lgkmcnt(7)
    ds_read_b64_tr_b16 a[218:219], v22 offset:20480
    v_mul_u32_u24 v243, 1536, v243
    v_mfma_f32_16x16x32_bf16 v[72:75], a[184:187], v[200:203], v[72:75]
    s_waitcnt lgkmcnt(6)
    ds_read_b64_tr_b16 a[220:221], v22 offset:24576
    v_add_u32 v2, v2, v243
    v_mfma_f32_16x16x32_bf16 v[72:75], a[188:191], v[184:187], v[72:75]
    s_mul_i32 s44, s43, 10240
    ds_read_b64_tr_b16 a[222:223], v22 offset:28672
    v_lshrrev_b32 v243, 2, v240
    v_mfma_f32_16x16x32_bf16 v[76:79], a[188:191], v[188:191], 0
    ds_read_b64_tr_b16 a[224:225], v26 offset:0
    v_lshlrev_b32 v243, 6, v243
    v_mfma_f32_16x16x32_bf16 v[76:79], a[184:187], v[204:207], v[76:79]
    ds_read_b64_tr_b16 a[226:227], v26 offset:4096
    v_and_b32 v241, 3, v240
    v_mfma_f32_16x16x32_bf16 v[76:79], a[180:183], v[156:159], v[76:79]
    ds_read_b64_tr_b16 a[228:229], v26 offset:8192
    v_lshl_add_u32 v3, v241, 3, v243
    v_mfma_f32_16x16x32_bf16 v[76:79], a[176:179], v[140:143], v[76:79]
    ds_read_b64_tr_b16 a[230:231], v26 offset:12288
    v_mul_u32_u24 v243, 1152, v7
    v_mfma_f32_16x16x32_bf16 v[76:79], a[172:175], v[180:183], v[76:79]
    ds_read_b64_tr_b16 a[232:233], v26 offset:16384
    v_add_u32 v4, v243, v3
    v_mfma_f32_16x16x32_bf16 v[76:79], a[168:171], v[196:199], v[76:79]
    ds_read_b64_tr_b16 a[234:235], v26 offset:20480
    v_lshl_add_u32 v6, v243, 1, v5
    v_mfma_f32_16x16x32_bf16 v[76:79], a[164:167], v[148:151], v[76:79]
    ds_read_b64_tr_b16 a[236:237], v26 offset:24576
    v_or_b32 v55, v3, v242
    v_mfma_f32_16x16x32_bf16 v[76:79], a[160:163], v[132:135], v[76:79]
    s_waitcnt lgkmcnt(13)
    ds_read_b64_tr_b16 a[238:239], v26 offset:28672
    v_or_b32 v58, v4, v242
    v_mfma_f32_16x16x32_bf16 v[80:83], a[208:211], v[128:131], 0
    s_waitcnt lgkmcnt(12)
    ds_read_b64_tr_b16 a[160:161], v23 offset:0
    v_or_b32 v59, v5, v242
    v_mfma_f32_16x16x32_bf16 v[80:83], a[212:215], v[144:147], v[80:83]
    s_waitcnt lgkmcnt(11)
    ds_read_b64_tr_b16 a[162:163], v23 offset:4096
    v_or_b32 v60, v6, v242
    v_mfma_f32_16x16x32_bf16 v[80:83], a[216:219], v[192:195], v[80:83]
    s_waitcnt lgkmcnt(10)
    ds_read_b64_tr_b16 a[164:165], v23 offset:8192
    s_waitcnt vmcnt(6)
    v_readfirstlane_b32 s36, v11
    v_mfma_f32_16x16x32_bf16 v[80:83], a[220:223], v[176:179], v[80:83]
    s_waitcnt lgkmcnt(9)
    ds_read_b64_tr_b16 a[166:167], v23 offset:12288
    v_lshrrev_b32 v243, 4, v1
    v_mfma_f32_16x16x32_bf16 v[80:83], a[224:227], v[136:139], v[80:83]
    ds_read_b64_tr_b16 a[168:169], v23 offset:16384
    v_lshlrev_b32 v243, 8, v243
    s_cmp_lg_u32 s36, s95
    s_cbranch_scc1 Lattn_xspin
Lattn_xgot:
    s_waitcnt lgkmcnt(9)
    v_mfma_f32_16x16x32_bf16 v[80:83], a[228:231], v[152:155], v[80:83]
    s_waitcnt lgkmcnt(7)
    ds_read_b64_tr_b16 a[170:171], v23 offset:20480
    v_and_b32 v241, 7, v1
    v_mfma_f32_16x16x32_bf16 v[80:83], a[232:235], v[200:203], v[80:83]
    s_waitcnt lgkmcnt(6)
    ds_read_b64_tr_b16 a[172:173], v23 offset:24576
    v_lshl_add_u32 v243, v241, 5, v243
    v_mfma_f32_16x16x32_bf16 v[80:83], a[236:239], v[184:187], v[80:83]
    s_add_u32 s37, s55, 0
    ds_read_b64_tr_b16 a[174:175], v23 offset:28672
    v_and_b32 v241, 8, v1
    v_mfma_f32_16x16x32_bf16 v[84:87], a[236:239], v[188:191], 0
    buffer_load_dwordx4 a[64:67], v252, s[28:31], s37 offen offset:0 sc1
    v_mfma_f32_16x16x32_bf16 v[84:87], a[232:235], v[204:207], v[84:87]
    ds_read_b64_tr_b16 a[176:177], v27 offset:0
    ds_read_b64_tr_b16 a[178:179], v27 offset:4096
    v_mfma_f32_16x16x32_bf16 v[84:87], a[228:231], v[156:159], v[84:87]
    buffer_load_dwordx4 a[68:71], v252, s[28:31], s37 offen offset:1024 sc1
    v_mfma_f32_16x16x32_bf16 v[84:87], a[224:227], v[140:143], v[84:87]
    ds_read_b64_tr_b16 a[180:181], v27 offset:8192
    ds_read_b64_tr_b16 a[182:183], v27 offset:12288
    v_mfma_f32_16x16x32_bf16 v[84:87], a[220:223], v[180:183], v[84:87]
    ds_read_b64_tr_b16 a[184:185], v27 offset:16384
    v_lshl_add_u32 v54, v241, 1, v243
    v_mfma_f32_16x16x32_bf16 v[84:87], a[216:219], v[196:199], v[84:87]
    s_lshr_b32 s41, s2, 3
    ds_read_b64_tr_b16 a[186:187], v27 offset:20480
    v_mfma_f32_16x16x32_bf16 v[84:87], a[212:215], v[148:151], v[84:87]
    buffer_load_dwordx4 a[72:75], v252, s[28:31], s37 offen offset:2048 sc1
    v_mfma_f32_16x16x32_bf16 v[84:87], a[208:211], v[132:135], v[84:87]
    s_waitcnt lgkmcnt(12)
    s_mov_b32 s14, 2359296
    ds_read_b64_tr_b16 a[188:189], v27 offset:24576
    ds_read_b64_tr_b16 a[190:191], v27 offset:28672
    s_barrier
    v_mfma_f32_16x16x32_bf16 v[88:91], a[160:163], v[128:131], 0
    s_waitcnt lgkmcnt(12)
    s_mov_b32 s15, 0x20000
    ds_read_b64_tr_b16 a[208:209], v12 offset:32768
    v_mfma_f32_16x16x32_bf16 v[88:91], a[164:167], v[144:147], v[88:91]
    s_waitcnt lgkmcnt(11)
    s_mov_b32 s18, 2359296
    ds_read_b64_tr_b16 a[210:211], v12 offset:36864
    v_mfma_f32_16x16x32_bf16 v[88:91], a[168:171], v[192:195], v[88:91]
    s_waitcnt lgkmcnt(10)
    buffer_load_dwordx4 a[76:79], v252, s[28:31], s37 offen offset:3072 sc1
    v_mfma_f32_16x16x32_bf16 v[88:91], a[172:175], v[176:179], v[88:91]
    s_waitcnt lgkmcnt(8)
    s_mov_b32 s19, 0x20000
    ds_read_b64_tr_b16 a[212:213], v12 offset:40960
    ds_read_b64_tr_b16 a[214:215], v12 offset:45056
    v_mfma_f32_16x16x32_bf16 v[88:91], a[176:179], v[136:139], v[88:91]
    s_waitcnt lgkmcnt(8)
    s_add_u32 s8, s50, 7864320
    s_addc_u32 s9, s51, 0
    ds_read_b64_tr_b16 a[216:217], v12 offset:49152
    v_mfma_f32_16x16x32_bf16 v[88:91], a[180:183], v[152:155], v[88:91]
    s_waitcnt lgkmcnt(7)
    s_add_u32 s37, s55, 4096
    ds_read_b64_tr_b16 a[218:219], v12 offset:53248
    v_mfma_f32_16x16x32_bf16 v[88:91], a[184:187], v[200:203], v[88:91]
    s_waitcnt lgkmcnt(6)
    s_add_u32 s49, s46, 256
    buffer_load_dwordx4 a[80:83], v252, s[28:31], s37 offen offset:0 sc1
    v_mfma_f32_16x16x32_bf16 v[88:91], a[188:191], v[184:187], v[88:91]
    s_add_u32 m0, s42, 0
    ds_read_b64_tr_b16 a[220:221], v12 offset:57344
    ds_read_b64_tr_b16 a[222:223], v12 offset:61440
    v_mfma_f32_16x16x32_bf16 v[92:95], a[188:191], v[188:191], 0
    buffer_load_dwordx4 v46, s[20:23], s49 offen lds
    v_mfma_f32_16x16x32_bf16 v[92:95], a[184:187], v[204:207], v[92:95]
    s_mov_b32 s10, 663552
    ds_read_b64_tr_b16 a[224:225], v16 offset:32768
    ds_read_b64_tr_b16 a[226:227], v16 offset:36864
    v_mfma_f32_16x16x32_bf16 v[92:95], a[180:183], v[156:159], v[92:95]
    buffer_load_dwordx4 v47, s[20:23], s49 offen offset:1024 lds
    v_mfma_f32_16x16x32_bf16 v[92:95], a[176:179], v[140:143], v[92:95]
    s_mov_b32 s11, 0x20000
    ds_read_b64_tr_b16 a[228:229], v16 offset:40960
    ds_read_b64_tr_b16 a[230:231], v16 offset:45056
    v_mfma_f32_16x16x32_bf16 v[92:95], a[172:175], v[180:183], v[92:95]
    buffer_load_dwordx4 a[84:87], v252, s[28:31], s37 offen offset:1024 sc1
    v_mfma_f32_16x16x32_bf16 v[92:95], a[168:171], v[196:199], v[92:95]
    s_lshl_b32 s39, s5, 13
    ds_read_b64_tr_b16 a[232:233], v16 offset:49152
    ds_read_b64_tr_b16 a[234:235], v16 offset:53248
    v_mfma_f32_16x16x32_bf16 v[92:95], a[164:167], v[148:151], v[92:95]
    s_add_u32 s39, s39, 8781824
    ds_read_b64_tr_b16 a[236:237], v16 offset:57344
    v_mfma_f32_16x16x32_bf16 v[92:95], a[160:163], v[132:135], v[92:95]
    s_waitcnt lgkmcnt(13)
    s_lshr_b32 s45, s4, 2
    ds_read_b64_tr_b16 a[238:239], v16 offset:61440
    v_mfma_f32_16x16x32_bf16 v[96:99], a[208:211], v[128:131], 0
    s_waitcnt lgkmcnt(12)
    buffer_load_dwordx4 v48, s[20:23], s49 offen offset:2048 lds
    v_mfma_f32_16x16x32_bf16 v[96:99], a[212:215], v[144:147], v[96:99]
    s_waitcnt lgkmcnt(10)
    s_lshl_b32 s45, s45, 11
    ds_read_b64_tr_b16 a[160:161], v13 offset:32768
    ds_read_b64_tr_b16 a[162:163], v13 offset:36864
    v_mfma_f32_16x16x32_bf16 v[96:99], a[216:219], v[192:195], v[96:99]
    s_waitcnt lgkmcnt(10)
    buffer_load_dwordx4 v49, s[20:23], s49 offen offset:3072 lds
    v_mfma_f32_16x16x32_bf16 v[96:99], a[220:223], v[176:179], v[96:99]
    s_waitcnt lgkmcnt(8)
    s_add_u32 s39, s39, s45
    ds_read_b64_tr_b16 a[164:165], v13 offset:40960
    ds_read_b64_tr_b16 a[166:167], v13 offset:45056
    v_mfma_f32_16x16x32_bf16 v[96:99], a[224:227], v[136:139], v[96:99]
    s_waitcnt lgkmcnt(8)
    buffer_load_dwordx4 a[88:91], v252, s[28:31], s37 offen offset:2048 sc1
    v_mfma_f32_16x16x32_bf16 v[96:99], a[228:231], v[152:155], v[96:99]
    s_waitcnt lgkmcnt(6)
    ds_read_b64_tr_b16 a[168:169], v13 offset:49152
    ds_read_b64_tr_b16 a[170:171], v13 offset:53248
    v_mfma_f32_16x16x32_bf16 v[96:99], a[232:235], v[200:203], v[96:99]
    s_waitcnt lgkmcnt(6)
    s_add_u32 s49, s46, 73984
    ds_read_b64_tr_b16 a[172:173], v13 offset:57344
    v_and_b32 v9, 15, v1
    v_mfma_f32_16x16x32_bf16 v[96:99], a[236:239], v[184:187], v[96:99]
    s_add_u32 m0, s42, 16384
    ds_read_b64_tr_b16 a[174:175], v13 offset:61440
    v_lshlrev_b32 v9, 7, v9
    v_mfma_f32_16x16x32_bf16 v[100:103], a[236:239], v[188:191], 0
    buffer_load_dwordx4 v46, s[20:23], s49 offen lds
    v_mfma_f32_16x16x32_bf16 v[100:103], a[232:235], v[204:207], v[100:103]
    ds_read_b64_tr_b16 a[176:177], v17 offset:32768
    ds_read_b64_tr_b16 a[178:179], v17 offset:36864
    v_mfma_f32_16x16x32_bf16 v[100:103], a[228:231], v[156:159], v[100:103]
    buffer_load_dwordx4 v47, s[20:23], s49 offen offset:1024 lds
    v_mfma_f32_16x16x32_bf16 v[100:103], a[224:227], v[140:143], v[100:103]
    ds_read_b64_tr_b16 a[180:181], v17 offset:40960
    ds_read_b64_tr_b16 a[182:183], v17 offset:45056
    v_mfma_f32_16x16x32_bf16 v[100:103], a[220:223], v[180:183], v[100:103]
    buffer_load_dwordx4 a[92:95], v252, s[28:31], s37 offen offset:3072 sc1
    v_mfma_f32_16x16x32_bf16 v[100:103], a[216:219], v[196:199], v[100:103]
    ds_read_b64_tr_b16 a[184:185], v17 offset:49152
    ds_read_b64_tr_b16 a[186:187], v17 offset:53248
    v_mfma_f32_16x16x32_bf16 v[100:103], a[212:215], v[148:151], v[100:103]
    ds_read_b64_tr_b16 a[188:189], v17 offset:57344
    v_mfma_f32_16x16x32_bf16 v[100:103], a[208:211], v[132:135], v[100:103]
    s_waitcnt lgkmcnt(13)
    ds_read_b64_tr_b16 a[190:191], v17 offset:61440
    v_mfma_f32_16x16x32_bf16 v[104:107], a[160:163], v[128:131], 0
    s_waitcnt lgkmcnt(12)
    buffer_load_dwordx4 v48, s[20:23], s49 offen offset:2048 lds
    v_mfma_f32_16x16x32_bf16 v[104:107], a[164:167], v[144:147], v[104:107]
    s_waitcnt lgkmcnt(10)
    ds_read_b64_tr_b16 a[208:209], v14 offset:32768
    ds_read_b64_tr_b16 a[210:211], v14 offset:36864
    v_mfma_f32_16x16x32_bf16 v[104:107], a[168:171], v[192:195], v[104:107]
    s_waitcnt lgkmcnt(10)
    buffer_load_dwordx4 v49, s[20:23], s49 offen offset:3072 lds
    v_mfma_f32_16x16x32_bf16 v[104:107], a[172:175], v[176:179], v[104:107]
    s_waitcnt lgkmcnt(8)
    s_add_u32 s37, s55, 8192
    ds_read_b64_tr_b16 a[212:213], v14 offset:40960
    ds_read_b64_tr_b16 a[214:215], v14 offset:45056
    v_mfma_f32_16x16x32_bf16 v[104:107], a[176:179], v[136:139], v[104:107]
    s_waitcnt lgkmcnt(8)
    buffer_load_dwordx4 a[96:99], v252, s[28:31], s37 offen offset:0 sc1
    v_mfma_f32_16x16x32_bf16 v[104:107], a[180:183], v[152:155], v[104:107]
    s_waitcnt lgkmcnt(6)
    ds_read_b64_tr_b16 a[216:217], v14 offset:49152
    ds_read_b64_tr_b16 a[218:219], v14 offset:53248
    v_mfma_f32_16x16x32_bf16 v[104:107], a[184:187], v[200:203], v[104:107]
    s_waitcnt lgkmcnt(6)
    buffer_load_dwordx4 a[100:103], v252, s[28:31], s37 offen offset:1024 sc1
    v_mfma_f32_16x16x32_bf16 v[104:107], a[188:191], v[184:187], v[104:107]
Ltour9:
    s_cbranch_execz Ltour13
    ds_read_b64_tr_b16 a[220:221], v14 offset:57344
    ds_read_b64_tr_b16 a[222:223], v14 offset:61440
    v_mfma_f32_16x16x32_bf16 v[108:111], a[188:191], v[188:191], 0
    ds_read_b64_tr_b16 a[224:225], v18 offset:32768
    v_mfma_f32_16x16x32_bf16 v[108:111], a[184:187], v[204:207], v[108:111]
    ds_read_b64_tr_b16 a[226:227], v18 offset:36864
    v_mfma_f32_16x16x32_bf16 v[108:111], a[180:183], v[156:159], v[108:111]
    buffer_load_dwordx4 a[104:107], v252, s[28:31], s37 offen offset:2048 sc1
    v_mfma_f32_16x16x32_bf16 v[108:111], a[176:179], v[140:143], v[108:111]
    ds_read_b64_tr_b16 a[228:229], v18 offset:40960
    ds_read_b64_tr_b16 a[230:231], v18 offset:45056
    v_mfma_f32_16x16x32_bf16 v[108:111], a[172:175], v[180:183], v[108:111]
    ds_read_b64_tr_b16 a[232:233], v18 offset:49152
    v_mfma_f32_16x16x32_bf16 v[108:111], a[168:171], v[196:199], v[108:111]
    ds_read_b64_tr_b16 a[234:235], v18 offset:53248
    v_mfma_f32_16x16x32_bf16 v[108:111], a[164:167], v[148:151], v[108:111]
    buffer_load_dwordx4 a[108:111], v252, s[28:31], s37 offen offset:3072 sc1
    v_mfma_f32_16x16x32_bf16 v[108:111], a[160:163], v[132:135], v[108:111]
    s_waitcnt lgkmcnt(12)
    ds_read_b64_tr_b16 a[236:237], v18 offset:57344
    ds_read_b64_tr_b16 a[238:239], v18 offset:61440
    v_mfma_f32_16x16x32_bf16 v[112:115], a[208:211], v[128:131], 0
    s_waitcnt lgkmcnt(12)
    ds_read_b64_tr_b16 a[160:161], v15 offset:32768
    v_mfma_f32_16x16x32_bf16 v[112:115], a[212:215], v[144:147], v[112:115]
    s_waitcnt lgkmcnt(11)
    s_add_u32 s37, s55, 12288
    ds_read_b64_tr_b16 a[162:163], v15 offset:36864
    v_mfma_f32_16x16x32_bf16 v[112:115], a[216:219], v[192:195], v[112:115]
    s_waitcnt lgkmcnt(10)
    buffer_load_dwordx4 a[112:115], v252, s[28:31], s37 offen offset:0 sc1
    v_mfma_f32_16x16x32_bf16 v[112:115], a[220:223], v[176:179], v[112:115]
    s_waitcnt lgkmcnt(8)
    ds_read_b64_tr_b16 a[164:165], v15 offset:40960
    ds_read_b64_tr_b16 a[166:167], v15 offset:45056
    v_mfma_f32_16x16x32_bf16 v[112:115], a[224:227], v[136:139], v[112:115]
    s_waitcnt lgkmcnt(8)
    buffer_load_dwordx4 a[116:119], v252, s[28:31], s37 offen offset:1024 sc1
    v_mfma_f32_16x16x32_bf16 v[112:115], a[228:231], v[152:155], v[112:115]
    s_waitcnt lgkmcnt(6)
    ds_read_b64_tr_b16 a[168:169], v15 offset:49152
    ds_read_b64_tr_b16 a[170:171], v15 offset:53248
    v_mfma_f32_16x16x32_bf16 v[112:115], a[232:235], v[200:203], v[112:115]
    s_waitcnt lgkmcnt(6)
    ds_read_b64_tr_b16 a[172:173], v15 offset:57344
    v_mfma_f32_16x16x32_bf16 v[112:115], a[236:239], v[184:187], v[112:115]
    ds_read_b64_tr_b16 a[174:175], v15 offset:61440
    v_mfma_f32_16x16x32_bf16 v[116:119], a[236:239], v[188:191], 0
    buffer_load_dwordx4 a[120:123], v252, s[28:31], s37 offen offset:2048 sc1
    v_mfma_f32_16x16x32_bf16 v[116:119], a[232:235], v[204:207], v[116:119]
    ds_read_b64_tr_b16 a[176:177], v19 offset:32768
    ds_read_b64_tr_b16 a[178:179], v19 offset:36864
    v_mfma_f32_16x16x32_bf16 v[116:119], a[228:231], v[156:159], v[116:119]
    ds_read_b64_tr_b16 a[180:181], v19 offset:40960
    v_mfma_f32_16x16x32_bf16 v[116:119], a[224:227], v[140:143], v[116:119]
    ds_read_b64_tr_b16 a[182:183], v19 offset:45056
    v_mfma_f32_16x16x32_bf16 v[116:119], a[220:223], v[180:183], v[116:119]
    buffer_load_dwordx4 a[124:127], v252, s[28:31], s37 offen offset:3072 sc1
    v_mfma_f32_16x16x32_bf16 v[116:119], a[216:219], v[196:199], v[116:119]
    ds_read_b64_tr_b16 a[184:185], v19 offset:49152
    ds_read_b64_tr_b16 a[186:187], v19 offset:53248
    v_mfma_f32_16x16x32_bf16 v[116:119], a[212:215], v[148:151], v[116:119]
    ds_read_b64_tr_b16 a[188:189], v19 offset:57344
    v_mfma_f32_16x16x32_bf16 v[116:119], a[208:211], v[132:135], v[116:119]
    ds_read_b64_tr_b16 a[190:191], v19 offset:61440
    s_waitcnt vmcnt(25)
    s_waitcnt lgkmcnt(0)
    s_barrier
    v_mfma_f32_16x16x32_bf16 v[120:123], a[160:163], v[128:131], 0
    ds_read_b64_tr_b16 a[208:209], v20 offset:32768
    v_mfma_f32_16x16x32_bf16 v[120:123], a[164:167], v[144:147], v[120:123]
    ds_read_b64_tr_b16 a[210:211], v20 offset:36864
    v_mfma_f32_16x16x32_bf16 v[120:123], a[168:171], v[192:195], v[120:123]
    ds_read_b64_tr_b16 a[212:213], v20 offset:40960
    v_mfma_f32_16x16x32_bf16 v[120:123], a[172:175], v[176:179], v[120:123]
    ds_read_b64_tr_b16 a[214:215], v20 offset:45056
    v_mfma_f32_16x16x32_bf16 v[120:123], a[176:179], v[136:139], v[120:123]
    ds_read_b64_tr_b16 a[216:217], v20 offset:49152
    v_mfma_f32_16x16x32_bf16 v[120:123], a[180:183], v[152:155], v[120:123]
    ds_read_b64_tr_b16 a[218:219], v20 offset:53248
    v_mfma_f32_16x16x32_bf16 v[120:123], a[184:187], v[200:203], v[120:123]
    s_add_u32 s49, s7, 512
    ds_read_b64_tr_b16 a[220:221], v20 offset:57344
    v_mfma_f32_16x16x32_bf16 v[120:123], a[188:191], v[184:187], v[120:123]
    s_add_u32 m0, s42, 65536
    ds_read_b64_tr_b16 a[222:223], v20 offset:61440
    v_mfma_f32_16x16x32_bf16 v[124:127], a[188:191], v[188:191], 0
    buffer_load_dwordx4 v46, s[20:23], s49 offen lds
    v_mfma_f32_16x16x32_bf16 v[124:127], a[184:187], v[204:207], v[124:127]
    ds_read_b64_tr_b16 a[224:225], v24 offset:32768
    ds_read_b64_tr_b16 a[226:227], v24 offset:36864
    v_mfma_f32_16x16x32_bf16 v[124:127], a[180:183], v[156:159], v[124:127]
    buffer_load_dwordx4 v47, s[20:23], s49 offen offset:1024 lds
    v_mfma_f32_16x16x32_bf16 v[124:127], a[176:179], v[140:143], v[124:127]
    ds_read_b64_tr_b16 a[228:229], v24 offset:40960
    ds_read_b64_tr_b16 a[230:231], v24 offset:45056
    v_mfma_f32_16x16x32_bf16 v[124:127], a[172:175], v[180:183], v[124:127]
    ds_read_b64_tr_b16 a[232:233], v24 offset:49152
    v_mfma_f32_16x16x32_bf16 v[124:127], a[168:171], v[196:199], v[124:127]
    ds_read_b64_tr_b16 a[234:235], v24 offset:53248
    v_mfma_f32_16x16x32_bf16 v[124:127], a[164:167], v[148:151], v[124:127]
    ds_read_b64_tr_b16 a[236:237], v24 offset:57344
    v_lshrrev_b32 v240, 4, v1
    v_mfma_f32_16x16x32_bf16 v[124:127], a[160:163], v[132:135], v[124:127]
    s_waitcnt vmcnt(25)
    s_waitcnt lgkmcnt(13)
    ds_read_b64_tr_b16 a[238:239], v24 offset:61440
    v_and_b32 v240, 2, v240
    v_mfma_f32_16x16x32_bf16 v[64:67], a[208:211], a[64:67], v[64:67]
    s_waitcnt vmcnt(24)
    s_waitcnt lgkmcnt(12)
    buffer_load_dwordx4 v48, s[20:23], s49 offen offset:2048 lds
    v_mfma_f32_16x16x32_bf16 v[64:67], a[212:215], a[68:71], v[64:67]
    s_waitcnt vmcnt(24)
    s_waitcnt lgkmcnt(10)
    ds_read_b64_tr_b16 a[160:161], v21 offset:32768
    ds_read_b64_tr_b16 a[162:163], v21 offset:36864
    v_mfma_f32_16x16x32_bf16 v[64:67], a[216:219], a[72:75], v[64:67]
    s_waitcnt vmcnt(23)
    s_waitcnt lgkmcnt(10)
    buffer_load_dwordx4 v49, s[20:23], s49 offen offset:3072 lds
    v_mfma_f32_16x16x32_bf16 v[64:67], a[220:223], a[76:79], v[64:67]
    s_waitcnt vmcnt(23)
    s_waitcnt lgkmcnt(8)
    ds_read_b64_tr_b16 a[164:165], v21 offset:40960
    ds_read_b64_tr_b16 a[166:167], v21 offset:45056
    v_mfma_f32_16x16x32_bf16 v[64:67], a[224:227], a[80:83], v[64:67]
    s_waitcnt vmcnt(20)
    s_waitcnt lgkmcnt(8)
    ds_read_b64_tr_b16 a[168:169], v21 offset:49152
    v_bfe_u32 v241, v1, 2, 2
    v_mfma_f32_16x16x32_bf16 v[64:67], a[228:231], a[84:87], v[64:67]
    s_waitcnt vmcnt(17)
    s_waitcnt lgkmcnt(7)
    ds_read_b64_tr_b16 a[170:171], v21 offset:53248
    v_cmp_eq_u32 s[54:55], v240, v241
    v_mfma_f32_16x16x32_bf16 v[64:67], a[232:235], a[88:91], v[64:67]
    s_waitcnt vmcnt(14)
    s_waitcnt lgkmcnt(6)
    s_add_u32 s49, s7, 74240
    ds_read_b64_tr_b16 a[172:173], v21 offset:57344
    v_or_b32 v240, 1, v240
    v_mfma_f32_16x16x32_bf16 v[64:67], a[236:239], a[92:95], v[64:67]
    s_waitcnt vmcnt(4)
    s_add_u32 m0, s42, 81920
    ds_read_b64_tr_b16 a[174:175], v21 offset:61440
    v_cmp_eq_u32 s[36:37], v240, v241
    v_mfma_f32_16x16x32_bf16 v[68:71], a[236:239], a[124:127], v[68:71]
    buffer_load_dwordx4 v46, s[20:23], s49 offen lds
    v_mfma_f32_16x16x32_bf16 v[68:71], a[232:235], a[120:123], v[68:71]
    ds_read_b64_tr_b16 a[176:177], v25 offset:32768
    ds_read_b64_tr_b16 a[178:179], v25 offset:36864
    v_mfma_f32_16x16x32_bf16 v[68:71], a[228:231], a[116:119], v[68:71]
    buffer_load_dwordx4 v47, s[20:23], s49 offen offset:1024 lds
    v_mfma_f32_16x16x32_bf16 v[68:71], a[224:227], a[112:115], v[68:71]
    ds_read_b64_tr_b16 a[180:181], v25 offset:40960
    ds_read_b64_tr_b16 a[182:183], v25 offset:45056
    v_mfma_f32_16x16x32_bf16 v[68:71], a[220:223], a[108:111], v[68:71]
    ds_read_b64_tr_b16 a[184:185], v25 offset:49152
    v_cvt_pk_bf16_f32 v224, v64, v65
    v_mfma_f32_16x16x32_bf16 v[68:71], a[216:219], a[104:107], v[68:71]
    ds_read_b64_tr_b16 a[186:187], v25 offset:53248
    v_cvt_pk_bf16_f32 v225, v66, v67
    v_mfma_f32_16x16x32_bf16 v[68:71], a[212:215], a[100:103], v[68:71]
    buffer_load_dwordx2 v[36:37], v4, s[12:15], 0 offen offset:0
    v_mfma_f32_16x16x32_bf16 v[68:71], a[208:211], a[96:99], v[68:71]
    s_waitcnt lgkmcnt(12)
    ds_read_b64_tr_b16 a[188:189], v25 offset:57344
    ds_read_b64_tr_b16 a[190:191], v25 offset:61440
    v_mfma_f32_16x16x32_bf16 v[72:75], a[160:163], a[64:67], v[72:75]
    s_waitcnt lgkmcnt(12)
    buffer_load_dwordx4 v48, s[20:23], s49 offen offset:2048 lds
    v_mfma_f32_16x16x32_bf16 v[72:75], a[164:167], a[68:71], v[72:75]
    s_waitcnt lgkmcnt(10)
    ds_read_b64_tr_b16 a[208:209], v22 offset:32768
    ds_read_b64_tr_b16 a[210:211], v22 offset:36864
    v_mfma_f32_16x16x32_bf16 v[72:75], a[168:171], a[72:75], v[72:75]
    s_waitcnt lgkmcnt(10)
    buffer_load_dwordx4 v49, s[20:23], s49 offen offset:3072 lds
    v_mfma_f32_16x16x32_bf16 v[72:75], a[172:175], a[76:79], v[72:75]
    s_waitcnt lgkmcnt(8)
    ds_read_b64_tr_b16 a[212:213], v22 offset:40960
    ds_read_b64_tr_b16 a[214:215], v22 offset:45056
    v_mfma_f32_16x16x32_bf16 v[72:75], a[176:179], a[80:83], v[72:75]
    s_waitcnt lgkmcnt(8)
    ds_read_b64_tr_b16 a[216:217], v22 offset:49152
    v_cvt_pk_bf16_f32 v228, v68, v69
    v_mfma_f32_16x16x32_bf16 v[72:75], a[180:183], a[84:87], v[72:75]
    s_waitcnt lgkmcnt(7)
    ds_read_b64_tr_b16 a[218:219], v22 offset:53248
    v_cvt_pk_bf16_f32 v229, v70, v71
    v_mfma_f32_16x16x32_bf16 v[72:75], a[184:187], a[88:91], v[72:75]
    s_waitcnt lgkmcnt(6)
    ds_read_b64_tr_b16 a[220:221], v22 offset:57344
    v_and_b32 v240, 1, v1
    v_mfma_f32_16x16x32_bf16 v[72:75], a[188:191], a[92:95], v[72:75]
    ds_read_b64_tr_b16 a[222:223], v22 offset:61440
    v_lshlrev_b32 v240, 4, v240
    v_mfma_f32_16x16x32_bf16 v[76:79], a[188:191], a[124:127], v[76:79]
    buffer_load_dwordx2 v[38:39], v4, s[12:15], 0 offen offset:32
    v_mfma_f32_16x16x32_bf16 v[76:79], a[184:187], a[120:123], v[76:79]
    ds_read_b64_tr_b16 a[224:225], v26 offset:32768
    ds_read_b64_tr_b16 a[226:227], v26 offset:36864
    v_mfma_f32_16x16x32_bf16 v[76:79], a[180:183], a[116:119], v[76:79]
    ds_read_b64_tr_b16 a[228:229], v26 offset:40960
    v_mov_b32 v241, 0x3f80
    v_mfma_f32_16x16x32_bf16 v[76:79], a[176:179], a[112:115], v[76:79]
    ds_read_b64_tr_b16 a[230:231], v26 offset:45056
    v_lshlrev_b32 v240, v240, v241
    v_mfma_f32_16x16x32_bf16 v[76:79], a[172:175], a[108:111], v[76:79]
    ds_read_b64_tr_b16 a[232:233], v26 offset:49152
    v_cvt_pk_bf16_f32 v226, v72, v73
    v_mfma_f32_16x16x32_bf16 v[76:79], a[168:171], a[104:107], v[76:79]
    s_add_u32 s38, s93, 0
    ds_read_b64_tr_b16 a[234:235], v26 offset:53248
    v_cvt_pk_bf16_f32 v227, v74, v75
    v_mfma_f32_16x16x32_bf16 v[76:79], a[164:167], a[100:103], v[76:79]
    buffer_store_dwordx4 v[224:227], v56, s[28:31], s38 offen sc1
    v_mfma_f32_16x16x32_bf16 v[76:79], a[160:163], a[96:99], v[76:79]
    s_waitcnt lgkmcnt(12)
    ds_read_b64_tr_b16 a[236:237], v26 offset:57344
    ds_read_b64_tr_b16 a[238:239], v26 offset:61440
    v_mfma_f32_16x16x32_bf16 v[80:83], a[208:211], a[64:67], v[80:83]
    s_waitcnt lgkmcnt(12)
    ds_read_b64_tr_b16 a[160:161], v23 offset:32768
    v_bfe_i32 v241, v1, 1, 1
    v_mfma_f32_16x16x32_bf16 v[80:83], a[212:215], a[68:71], v[80:83]
    s_waitcnt lgkmcnt(11)
    ds_read_b64_tr_b16 a[162:163], v23 offset:36864
    v_and_b32 v243, v240, v241
    v_mfma_f32_16x16x32_bf16 v[80:83], a[216:219], a[72:75], v[80:83]
    s_waitcnt lgkmcnt(10)
    buffer_load_dwordx2 v[40:41], v4, s[12:15], 0 offen offset:512
    v_mfma_f32_16x16x32_bf16 v[80:83], a[220:223], a[76:79], v[80:83]
    s_waitcnt lgkmcnt(8)
    ds_read_b64_tr_b16 a[164:165], v23 offset:40960
    ds_read_b64_tr_b16 a[166:167], v23 offset:45056
    v_mfma_f32_16x16x32_bf16 v[80:83], a[224:227], a[80:83], v[80:83]
    s_waitcnt lgkmcnt(8)
    ds_read_b64_tr_b16 a[168:169], v23 offset:49152
    v_cvt_pk_bf16_f32 v230, v76, v77
    v_mfma_f32_16x16x32_bf16 v[80:83], a[228:231], a[84:87], v[80:83]
    s_waitcnt lgkmcnt(7)
    s_add_u32 s38, s93, 163840
    ds_read_b64_tr_b16 a[170:171], v23 offset:53248
    v_cvt_pk_bf16_f32 v231, v78, v79
    v_mfma_f32_16x16x32_bf16 v[80:83], a[232:235], a[88:91], v[80:83]
    s_waitcnt lgkmcnt(6)
    buffer_store_dwordx4 v[228:231], v56, s[28:31], s38 offen sc1
    v_mfma_f32_16x16x32_bf16 v[80:83], a[236:239], a[92:95], v[80:83]
    ds_read_b64_tr_b16 a[172:173], v23 offset:57344
    ds_read_b64_tr_b16 a[174:175], v23 offset:61440
    v_mfma_f32_16x16x32_bf16 v[84:87], a[236:239], a[124:127], v[84:87]
    ds_read_b64_tr_b16 a[176:177], v27 offset:32768
    v_xor_b32 v242, v240, v243
    v_mfma_f32_16x16x32_bf16 v[84:87], a[232:235], a[120:123], v[84:87]
    ds_read_b64_tr_b16 a[178:179], v27 offset:36864
    v_cndmask_b32 v246, 0, v242, s[54:55]
    v_mfma_f32_16x16x32_bf16 v[84:87], a[228:231], a[116:119], v[84:87]
    ds_read_b64_tr_b16 a[180:181], v27 offset:40960
    v_cndmask_b32 v247, 0, v243, s[54:55]
    v_mfma_f32_16x16x32_bf16 v[84:87], a[224:227], a[112:115], v[84:87]
    ds_read_b64_tr_b16 a[182:183], v27 offset:45056
    v_cndmask_b32 v250, 0, v242, s[36:37]
    v_mfma_f32_16x16x32_bf16 v[84:87], a[220:223], a[108:111], v[84:87]
    ds_read_b64_tr_b16 a[184:185], v27 offset:49152
    v_cvt_pk_bf16_f32 v232, v80, v81
    v_mfma_f32_16x16x32_bf16 v[84:87], a[216:219], a[104:107], v[84:87]
    ds_read_b64_tr_b16 a[186:187], v27 offset:53248
    v_cvt_pk_bf16_f32 v233, v82, v83
    v_mfma_f32_16x16x32_bf16 v[84:87], a[212:215], a[100:103], v[84:87]
    buffer_load_dwordx2 v[42:43], v4, s[12:15], 0 offen offset:544
    v_mfma_f32_16x16x32_bf16 v[84:87], a[208:211], a[96:99], v[84:87]
    s_waitcnt lgkmcnt(12)
    ds_read_b64_tr_b16 a[188:189], v27 offset:57344
    ds_read_b64_tr_b16 a[190:191], v27 offset:61440
    s_barrier
    v_mfma_f32_16x16x32_bf16 v[88:91], a[160:163], a[64:67], v[88:91]
    s_waitcnt lgkmcnt(12)
    ds_read_b64_tr_b16 a[208:209], v12 offset:0
    v_cndmask_b32 v251, 0, v243, s[36:37]
    v_mfma_f32_16x16x32_bf16 v[88:91], a[164:167], a[68:71], v[88:91]
    s_waitcnt lgkmcnt(11)
    ds_read_b64_tr_b16 a[210:211], v12 offset:4096
    v_mov_b32 v240, 0
    v_mfma_f32_16x16x32_bf16 v[88:91], a[168:171], a[72:75], v[88:91]
    s_waitcnt lgkmcnt(10)
    ds_read_b64_tr_b16 a[212:213], v12 offset:8192
    v_mov_b32 v241, 0
    v_mfma_f32_16x16x32_bf16 v[88:91], a[172:175], a[76:79], v[88:91]
    s_waitcnt lgkmcnt(9)
    ds_read_b64_tr_b16 a[214:215], v12 offset:12288
    v_mov_b32 v244, 0
    v_mfma_f32_16x16x32_bf16 v[88:91], a[176:179], a[80:83], v[88:91]
    s_waitcnt lgkmcnt(8)
    ds_read_b64_tr_b16 a[216:217], v12 offset:16384
    v_cvt_pk_bf16_f32 v236, v84, v85
    v_mfma_f32_16x16x32_bf16 v[88:91], a[180:183], a[84:87], v[88:91]
    s_waitcnt lgkmcnt(7)
    ds_read_b64_tr_b16 a[218:219], v12 offset:20480
    v_cvt_pk_bf16_f32 v237, v86, v87
    v_mfma_f32_16x16x32_bf16 v[88:91], a[184:187], a[88:91], v[88:91]
    s_waitcnt lgkmcnt(6)
    s_add_u32 s49, s46, 512
    ds_read_b64_tr_b16 a[220:221], v12 offset:24576
    v_mov_b32 v245, 0
    v_mfma_f32_16x16x32_bf16 v[88:91], a[188:191], a[92:95], v[88:91]
    s_add_u32 m0, s42, 32768
    ds_read_b64_tr_b16 a[222:223], v12 offset:28672
    v_mov_b32 v248, 0
    v_mfma_f32_16x16x32_bf16 v[92:95], a[188:191], a[124:127], v[92:95]
    buffer_load_dwordx4 v46, s[20:23], s49 offen lds
    v_mfma_f32_16x16x32_bf16 v[92:95], a[184:187], a[120:123], v[92:95]
    ds_read_b64_tr_b16 a[224:225], v16 offset:0
    ds_read_b64_tr_b16 a[226:227], v16 offset:4096
    v_mfma_f32_16x16x32_bf16 v[92:95], a[180:183], a[116:119], v[92:95]
    buffer_load_dwordx4 v47, s[20:23], s49 offen offset:1024 lds
    v_mfma_f32_16x16x32_bf16 v[92:95], a[176:179], a[112:115], v[92:95]
    ds_read_b64_tr_b16 a[228:229], v16 offset:8192
    ds_read_b64_tr_b16 a[230:231], v16 offset:12288
    v_mfma_f32_16x16x32_bf16 v[92:95], a[172:175], a[108:111], v[92:95]
    ds_read_b64_tr_b16 a[232:233], v16 offset:16384
    v_cvt_pk_bf16_f32 v234, v88, v89
    v_mfma_f32_16x16x32_bf16 v[92:95], a[168:171], a[104:107], v[92:95]
    s_add_u32 s38, s93, 128
    ds_read_b64_tr_b16 a[234:235], v16 offset:20480
    v_cvt_pk_bf16_f32 v235, v90, v91
    v_mfma_f32_16x16x32_bf16 v[92:95], a[164:167], a[100:103], v[92:95]
    buffer_store_dwordx4 v[232:235], v56, s[28:31], s38 offen sc1
    v_mfma_f32_16x16x32_bf16 v[92:95], a[160:163], a[96:99], v[92:95]
    s_waitcnt lgkmcnt(12)
    ds_read_b64_tr_b16 a[236:237], v16 offset:24576
    ds_read_b64_tr_b16 a[238:239], v16 offset:28672
    v_mfma_f32_16x16x32_bf16 v[96:99], a[208:211], a[64:67], v[96:99]
    s_waitcnt lgkmcnt(12)
    buffer_load_dwordx4 v48, s[20:23], s49 offen offset:2048 lds
    v_mfma_f32_16x16x32_bf16 v[96:99], a[212:215], a[68:71], v[96:99]
    s_waitcnt lgkmcnt(10)
    ds_read_b64_tr_b16 a[160:161], v13 offset:0
    ds_read_b64_tr_b16 a[162:163], v13 offset:4096
    v_mfma_f32_16x16x32_bf16 v[96:99], a[216:219], a[72:75], v[96:99]
    s_waitcnt lgkmcnt(10)
    buffer_load_dwordx4 v49, s[20:23], s49 offen offset:3072 lds
    v_mfma_f32_16x16x32_bf16 v[96:99], a[220:223], a[76:79], v[96:99]
    s_waitcnt lgkmcnt(8)
    ds_read_b64_tr_b16 a[164:165], v13 offset:8192
    ds_read_b64_tr_b16 a[166:167], v13 offset:12288
    v_mfma_f32_16x16x32_bf16 v[96:99], a[224:227], a[80:83], v[96:99]
    s_waitcnt lgkmcnt(8)
    ds_read_b64_tr_b16 a[168:169], v13 offset:16384
    v_cvt_pk_bf16_f32 v238, v92, v93
    v_mfma_f32_16x16x32_bf16 v[96:99], a[228:231], a[84:87], v[96:99]
    s_waitcnt lgkmcnt(7)
    s_add_u32 s38, s93, 163968
    ds_read_b64_tr_b16 a[170:171], v13 offset:20480
    v_cvt_pk_bf16_f32 v239, v94, v95
    v_mfma_f32_16x16x32_bf16 v[96:99], a[232:235], a[88:91], v[96:99]
    s_waitcnt lgkmcnt(6)
    s_add_u32 s49, s46, 74240
    buffer_store_dwordx4 v[236:239], v56, s[28:31], s38 offen sc1
    v_mfma_f32_16x16x32_bf16 v[96:99], a[236:239], a[92:95], v[96:99]
    s_add_u32 m0, s42, 49152
    ds_read_b64_tr_b16 a[172:173], v13 offset:24576
    ds_read_b64_tr_b16 a[174:175], v13 offset:28672
    v_mfma_f32_16x16x32_bf16 v[100:103], a[236:239], a[124:127], v[100:103]
    buffer_load_dwordx4 v46, s[20:23], s49 offen lds
    v_mfma_f32_16x16x32_bf16 v[100:103], a[232:235], a[120:123], v[100:103]
    ds_read_b64_tr_b16 a[176:177], v17 offset:0
    ds_read_b64_tr_b16 a[178:179], v17 offset:4096
    v_mfma_f32_16x16x32_bf16 v[100:103], a[228:231], a[116:119], v[100:103]
    buffer_load_dwordx4 v47, s[20:23], s49 offen offset:1024 lds
    v_mfma_f32_16x16x32_bf16 v[100:103], a[224:227], a[112:115], v[100:103]
    ds_read_b64_tr_b16 a[180:181], v17 offset:8192
    ds_read_b64_tr_b16 a[182:183], v17 offset:12288
    v_mfma_f32_16x16x32_bf16 v[100:103], a[220:223], a[108:111], v[100:103]
    ds_read_b64_tr_b16 a[184:185], v17 offset:16384
    v_cvt_pk_bf16_f32 v224, v96, v97
    v_mfma_f32_16x16x32_bf16 v[100:103], a[216:219], a[104:107], v[100:103]
    ds_read_b64_tr_b16 a[186:187], v17 offset:20480
    v_cvt_pk_bf16_f32 v225, v98, v99
    v_mfma_f32_16x16x32_bf16 v[100:103], a[212:215], a[100:103], v[100:103]
    ds_read_b64_tr_b16 a[188:189], v17 offset:24576
    v_mov_b32 v249, 0
    v_mfma_f32_16x16x32_bf16 v[100:103], a[208:211], a[96:99], v[100:103]
    s_waitcnt lgkmcnt(13)
    ds_read_b64_tr_b16 a[190:191], v17 offset:28672
    v_mov_b32 v252, 0
    v_mfma_f32_16x16x32_bf16 v[104:107], a[160:163], a[64:67], v[104:107]
    s_waitcnt lgkmcnt(12)
    buffer_load_dwordx4 v48, s[20:23], s49 offen offset:2048 lds
    v_mfma_f32_16x16x32_bf16 v[104:107], a[164:167], a[68:71], v[104:107]
    s_waitcnt lgkmcnt(10)
    ds_read_b64_tr_b16 a[208:209], v14 offset:0
    ds_read_b64_tr_b16 a[210:211], v14 offset:4096
    v_mfma_f32_16x16x32_bf16 v[104:107], a[168:171], a[72:75], v[104:107]
    s_waitcnt lgkmcnt(10)
    buffer_load_dwordx4 v49, s[20:23], s49 offen offset:3072 lds
    v_mfma_f32_16x16x32_bf16 v[104:107], a[172:175], a[76:79], v[104:107]
    s_waitcnt lgkmcnt(8)
    ds_read_b64_tr_b16 a[212:213], v14 offset:8192
    ds_read_b64_tr_b16 a[214:215], v14 offset:12288
    v_mfma_f32_16x16x32_bf16 v[104:107], a[176:179], a[80:83], v[104:107]
    s_waitcnt lgkmcnt(8)
    ds_read_b64_tr_b16 a[216:217], v14 offset:16384
    v_cvt_pk_bf16_f32 v228, v100, v101
    v_mfma_f32_16x16x32_bf16 v[104:107], a[180:183], a[84:87], v[104:107]
    s_waitcnt lgkmcnt(7)
    ds_read_b64_tr_b16 a[218:219], v14 offset:20480
    v_cvt_pk_bf16_f32 v229, v102, v103
    v_mfma_f32_16x16x32_bf16 v[104:107], a[184:187], a[88:91], v[104:107]
    s_waitcnt lgkmcnt(6)
    ds_read_b64_tr_b16 a[220:221], v14 offset:24576
    v_mov_b32 v253, 0
    v_mfma_f32_16x16x32_bf16 v[104:107], a[188:191], a[92:95], v[104:107]
    ds_read_b64_tr_b16 a[222:223], v14 offset:28672
    v_mfma_f32_16x16x32_bf16 v[108:111], a[188:191], a[124:127], v[108:111]
    ds_read_b64_tr_b16 a[224:225], v18 offset:0
    v_mfma_f32_16x16x32_bf16 v[108:111], a[184:187], a[120:123], v[108:111]
    ds_read_b64_tr_b16 a[226:227], v18 offset:4096
    v_mfma_f32_16x16x32_bf16 v[108:111], a[180:183], a[116:119], v[108:111]
    ds_read_b64_tr_b16 a[228:229], v18 offset:8192
    v_mfma_f32_16x16x32_bf16 v[108:111], a[176:179], a[112:115], v[108:111]
    ds_read_b64_tr_b16 a[230:231], v18 offset:12288
    v_mfma_f32_16x16x32_bf16 v[108:111], a[172:175], a[108:111], v[108:111]
    ds_read_b64_tr_b16 a[232:233], v18 offset:16384
    v_cvt_pk_bf16_f32 v226, v104, v105
    v_mfma_f32_16x16x32_bf16 v[108:111], a[168:171], a[104:107], v[108:111]
    s_add_u32 s38, s93, 512
    ds_read_b64_tr_b16 a[234:235], v18 offset:20480
    v_cvt_pk_bf16_f32 v227, v106, v107
    v_mfma_f32_16x16x32_bf16 v[108:111], a[164:167], a[100:103], v[108:111]
    buffer_store_dwordx4 v[224:227], v56, s[28:31], s38 offen sc1
    v_mfma_f32_16x16x32_bf16 v[108:111], a[160:163], a[96:99], v[108:111]
    s_waitcnt lgkmcnt(12)
    ds_read_b64_tr_b16 a[236:237], v18 offset:24576
    ds_read_b64_tr_b16 a[238:239], v18 offset:28672
    v_mfma_f32_16x16x32_bf16 v[112:115], a[208:211], a[64:67], v[112:115]
    s_waitcnt lgkmcnt(12)
    ds_read_b64_tr_b16 a[160:161], v15 offset:0
    v_mfma_f32_16x16x32_bf16 v[112:115], a[212:215], a[68:71], v[112:115]
    s_waitcnt lgkmcnt(11)
    ds_read_b64_tr_b16 a[162:163], v15 offset:4096
    v_mfma_f32_16x16x32_bf16 v[112:115], a[216:219], a[72:75], v[112:115]
    s_waitcnt lgkmcnt(10)
    ds_read_b64_tr_b16 a[164:165], v15 offset:8192
    v_mfma_f32_16x16x32_bf16 v[112:115], a[220:223], a[76:79], v[112:115]
    s_waitcnt lgkmcnt(9)
    ds_read_b64_tr_b16 a[166:167], v15 offset:12288
    v_mfma_f32_16x16x32_bf16 v[112:115], a[224:227], a[80:83], v[112:115]
    s_waitcnt lgkmcnt(8)
    ds_read_b64_tr_b16 a[168:169], v15 offset:16384
    v_cvt_pk_bf16_f32 v230, v108, v109
    v_mfma_f32_16x16x32_bf16 v[112:115], a[228:231], a[84:87], v[112:115]
    s_waitcnt lgkmcnt(7)
    s_add_u32 s38, s93, 164352
    ds_read_b64_tr_b16 a[170:171], v15 offset:20480
    v_cvt_pk_bf16_f32 v231, v110, v111
    v_mfma_f32_16x16x32_bf16 v[112:115], a[232:235], a[88:91], v[112:115]
    s_waitcnt lgkmcnt(6)
    buffer_store_dwordx4 v[228:231], v56, s[28:31], s38 offen sc1
    v_mfma_f32_16x16x32_bf16 v[112:115], a[236:239], a[92:95], v[112:115]
    ds_read_b64_tr_b16 a[172:173], v15 offset:24576
    ds_read_b64_tr_b16 a[174:175], v15 offset:28672
    v_mfma_f32_16x16x32_bf16 v[116:119], a[236:239], a[124:127], v[116:119]
    ds_read_b64_tr_b16 a[176:177], v19 offset:0
    v_mfma_f32_16x16x32_bf16 v[116:119], a[232:235], a[120:123], v[116:119]
    ds_read_b64_tr_b16 a[178:179], v19 offset:4096
    v_mfma_f32_16x16x32_bf16 v[116:119], a[228:231], a[116:119], v[116:119]
    ds_read_b64_tr_b16 a[180:181], v19 offset:8192
    v_mfma_f32_16x16x32_bf16 v[116:119], a[224:227], a[112:115], v[116:119]
    ds_read_b64_tr_b16 a[182:183], v19 offset:12288
    v_mfma_f32_16x16x32_bf16 v[116:119], a[220:223], a[108:111], v[116:119]
    ds_read_b64_tr_b16 a[184:185], v19 offset:16384
    v_cvt_pk_bf16_f32 v232, v112, v113
    v_mfma_f32_16x16x32_bf16 v[116:119], a[216:219], a[104:107], v[116:119]
    ds_read_b64_tr_b16 a[186:187], v19 offset:20480
    v_cvt_pk_bf16_f32 v233, v114, v115
    v_mfma_f32_16x16x32_bf16 v[116:119], a[212:215], a[100:103], v[116:119]
    ds_read_b64_tr_b16 a[188:189], v19 offset:24576
    v_mfma_f32_16x16x32_bf16 v[116:119], a[208:211], a[96:99], v[116:119]
    s_waitcnt lgkmcnt(13)
    ds_read_b64_tr_b16 a[190:191], v19 offset:28672
    s_waitcnt vmcnt(17)
    s_barrier
    v_mfma_f32_16x16x32_bf16 v[120:123], a[160:163], a[64:67], v[120:123]
    s_waitcnt lgkmcnt(12)
    ds_read_b64_tr_b16 a[208:209], v20 offset:0
    v_mfma_f32_16x16x32_bf16 v[120:123], a[164:167], a[68:71], v[120:123]
    s_waitcnt lgkmcnt(11)
    ds_read_b64_tr_b16 a[210:211], v20 offset:4096
    v_mfma_f32_16x16x32_bf16 v[120:123], a[168:171], a[72:75], v[120:123]
    s_waitcnt lgkmcnt(10)
    ds_read_b64_tr_b16 a[212:213], v20 offset:8192
    v_mfma_f32_16x16x32_bf16 v[120:123], a[172:175], a[76:79], v[120:123]
    s_waitcnt lgkmcnt(9)
    ds_read_b64_tr_b16 a[214:215], v20 offset:12288
    v_mfma_f32_16x16x32_bf16 v[120:123], a[176:179], a[80:83], v[120:123]
    s_waitcnt lgkmcnt(8)
    ds_read_b64_tr_b16 a[216:217], v20 offset:16384
    v_cvt_pk_bf16_f32 v236, v116, v117
    v_mfma_f32_16x16x32_bf16 v[120:123], a[180:183], a[84:87], v[120:123]
    s_waitcnt lgkmcnt(7)
    ds_read_b64_tr_b16 a[218:219], v20 offset:20480
    v_cvt_pk_bf16_f32 v237, v118, v119
    v_mfma_f32_16x16x32_bf16 v[120:123], a[184:187], a[88:91], v[120:123]
    s_waitcnt lgkmcnt(6)
    s_add_u32 s49, s7, 768
    ds_read_b64_tr_b16 a[220:221], v20 offset:24576
    v_mfma_f32_16x16x32_bf16 v[120:123], a[188:191], a[92:95], v[120:123]
    s_add_u32 m0, s42, 98304
    ds_read_b64_tr_b16 a[222:223], v20 offset:28672
    v_mfma_f32_16x16x32_bf16 v[124:127], a[188:191], a[124:127], v[124:127]
    buffer_load_dwordx4 v46, s[20:23], s49 offen lds
    v_mfma_f32_16x16x32_bf16 v[124:127], a[184:187], a[120:123], v[124:127]
    ds_read_b64_tr_b16 a[224:225], v24 offset:0
    ds_read_b64_tr_b16 a[226:227], v24 offset:4096
    v_mfma_f32_16x16x32_bf16 v[124:127], a[180:183], a[116:119], v[124:127]
    buffer_load_dwordx4 v47, s[20:23], s49 offen offset:1024 lds
    v_mfma_f32_16x16x32_bf16 v[124:127], a[176:179], a[112:115], v[124:127]
    ds_read_b64_tr_b16 a[228:229], v24 offset:8192
    ds_read_b64_tr_b16 a[230:231], v24 offset:12288
    v_mfma_f32_16x16x32_bf16 v[124:127], a[172:175], a[108:111], v[124:127]
    ds_read_b64_tr_b16 a[232:233], v24 offset:16384
    v_cvt_pk_bf16_f32 v234, v120, v121
    v_mfma_f32_16x16x32_bf16 v[124:127], a[168:171], a[104:107], v[124:127]
    s_add_u32 s38, s93, 640
    ds_read_b64_tr_b16 a[234:235], v24 offset:20480
    v_cvt_pk_bf16_f32 v235, v122, v123
    v_mfma_f32_16x16x32_bf16 v[124:127], a[164:167], a[100:103], v[124:127]
    buffer_store_dwordx4 v[232:235], v56, s[28:31], s38 offen sc1
    v_mfma_f32_16x16x32_bf16 v[124:127], a[160:163], a[96:99], v[124:127]
    s_waitcnt lgkmcnt(12)
    ds_read_b64_tr_b16 a[236:237], v24 offset:24576
    ds_read_b64_tr_b16 a[238:239], v24 offset:28672
    v_mfma_f32_16x16x32_bf16 v[64:67], a[208:211], v[128:131], 0
    s_waitcnt lgkmcnt(12)
    buffer_load_dwordx4 v48, s[20:23], s49 offen offset:2048 lds
    v_mfma_f32_16x16x32_bf16 v[64:67], a[212:215], v[144:147], v[64:67]
    s_waitcnt lgkmcnt(10)
    ds_read_b64_tr_b16 a[160:161], v21 offset:0
    ds_read_b64_tr_b16 a[162:163], v21 offset:4096
    v_mfma_f32_16x16x32_bf16 v[64:67], a[216:219], v[192:195], v[64:67]
    s_waitcnt lgkmcnt(10)
    buffer_load_dwordx4 v49, s[20:23], s49 offen offset:3072 lds
    v_mfma_f32_16x16x32_bf16 v[64:67], a[220:223], v[176:179], v[64:67]
    s_waitcnt lgkmcnt(8)
    ds_read_b64_tr_b16 a[164:165], v21 offset:8192
    ds_read_b64_tr_b16 a[166:167], v21 offset:12288
    v_mfma_f32_16x16x32_bf16 v[64:67], a[224:227], v[136:139], v[64:67]
    s_waitcnt lgkmcnt(8)
    ds_read_b64_tr_b16 a[168:169], v21 offset:16384
    v_cvt_pk_bf16_f32 v238, v124, v125
    v_mfma_f32_16x16x32_bf16 v[64:67], a[228:231], v[152:155], v[64:67]
    s_waitcnt lgkmcnt(7)
    s_add_u32 s38, s93, 164480
    ds_read_b64_tr_b16 a[170:171], v21 offset:20480
    v_cvt_pk_bf16_f32 v239, v126, v127
    v_mfma_f32_16x16x32_bf16 v[64:67], a[232:235], v[200:203], v[64:67]
    s_waitcnt lgkmcnt(6)
    s_add_u32 s49, s7, 74496
    buffer_store_dwordx4 v[236:239], v56, s[28:31], s38 offen sc1
    v_mfma_f32_16x16x32_bf16 v[64:67], a[236:239], v[184:187], v[64:67]
    s_add_u32 m0, s42, 114688
    ds_read_b64_tr_b16 a[172:173], v21 offset:24576
    ds_read_b64_tr_b16 a[174:175], v21 offset:28672
    v_mfma_f32_16x16x32_bf16 v[68:71], a[236:239], v[188:191], 0
Ltour10:
    s_cbranch_execz Ltour14
    buffer_load_dwordx4 v46, s[20:23], s49 offen lds
    v_mfma_f32_16x16x32_bf16 v[68:71], a[232:235], v[204:207], v[68:71]
    ds_read_b64_tr_b16 a[176:177], v25 offset:0
    ds_read_b64_tr_b16 a[178:179], v25 offset:4096
    v_mfma_f32_16x16x32_bf16 v[68:71], a[228:231], v[156:159], v[68:71]
    buffer_load_dwordx4 v47, s[20:23], s49 offen offset:1024 lds
    v_mfma_f32_16x16x32_bf16 v[68:71], a[224:227], v[140:143], v[68:71]
    ds_read_b64_tr_b16 a[180:181], v25 offset:8192
    ds_read_b64_tr_b16 a[182:183], v25 offset:12288
    v_mfma_f32_16x16x32_bf16 v[68:71], a[220:223], v[180:183], v[68:71]
    ds_read_b64_tr_b16 a[184:185], v25 offset:16384
    v_mfma_f32_16x16x32_bf16 v[68:71], a[216:219], v[196:199], v[68:71]
    ds_read_b64_tr_b16 a[186:187], v25 offset:20480
    v_mfma_f32_16x16x32_bf16 v[68:71], a[212:215], v[148:151], v[68:71]
    ds_read_b64_tr_b16 a[188:189], v25 offset:24576
    v_mfma_f32_16x16x32_bf16 v[68:71], a[208:211], v[132:135], v[68:71]
    s_waitcnt lgkmcnt(13)
    ds_read_b64_tr_b16 a[190:191], v25 offset:28672
    v_mfma_f32_16x16x32_bf16 v[72:75], a[160:163], v[128:131], 0
    s_waitcnt lgkmcnt(12)
    buffer_load_dwordx4 v48, s[20:23], s49 offen offset:2048 lds
    v_mfma_f32_16x16x32_bf16 v[72:75], a[164:167], v[144:147], v[72:75]
    s_waitcnt lgkmcnt(10)
    ds_read_b64_tr_b16 a[208:209], v22 offset:0
    ds_read_b64_tr_b16 a[210:211], v22 offset:4096
    v_mfma_f32_16x16x32_bf16 v[72:75], a[168:171], v[192:195], v[72:75]
    s_waitcnt lgkmcnt(10)
    buffer_load_dwordx4 v49, s[20:23], s49 offen offset:3072 lds
    v_mfma_f32_16x16x32_bf16 v[72:75], a[172:175], v[176:179], v[72:75]
    s_waitcnt lgkmcnt(8)
    ds_read_b64_tr_b16 a[212:213], v22 offset:8192
    ds_read_b64_tr_b16 a[214:215], v22 offset:12288
    v_mfma_f32_16x16x32_bf16 v[72:75], a[176:179], v[136:139], v[72:75]
    s_waitcnt lgkmcnt(8)
    ds_read_b64_tr_b16 a[216:217], v22 offset:16384
    v_mfma_f32_16x16x32_bf16 v[72:75], a[180:183], v[152:155], v[72:75]
    s_waitcnt lgkmcnt(7)
    ds_read_b64_tr_b16 a[218:219], v22 offset:20480
    v_mfma_f32_16x16x32_bf16 v[72:75], a[184:187], v[200:203], v[72:75]
    s_waitcnt lgkmcnt(6)
    ds_read_b64_tr_b16 a[220:221], v22 offset:24576
    v_mfma_f32_16x16x32_bf16 v[72:75], a[188:191], v[184:187], v[72:75]
    ds_read_b64_tr_b16 a[222:223], v22 offset:28672
    v_mfma_f32_16x16x32_bf16 v[76:79], a[188:191], v[188:191], 0
    ds_read_b64_tr_b16 a[224:225], v26 offset:0
    v_mfma_f32_16x16x32_bf16 v[76:79], a[184:187], v[204:207], v[76:79]
    ds_read_b64_tr_b16 a[226:227], v26 offset:4096
    v_mfma_f32_16x16x32_bf16 v[76:79], a[180:183], v[156:159], v[76:79]
    ds_read_b64_tr_b16 a[228:229], v26 offset:8192
    v_mfma_f32_16x16x32_bf16 v[76:79], a[176:179], v[140:143], v[76:79]
    ds_read_b64_tr_b16 a[230:231], v26 offset:12288
    v_mfma_f32_16x16x32_bf16 v[76:79], a[172:175], v[180:183], v[76:79]
    ds_read_b64_tr_b16 a[232:233], v26 offset:16384
    v_mfma_f32_16x16x32_bf16 v[76:79], a[168:171], v[196:199], v[76:79]
    ds_read_b64_tr_b16 a[234:235], v26 offset:20480
    v_mfma_f32_16x16x32_bf16 v[76:79], a[164:167], v[148:151], v[76:79]
    buffer_load_dword v63, v63, s[88:91], 0 offen sc1
    v_mfma_f32_16x16x32_bf16 v[76:79], a[160:163], v[132:135], v[76:79]
    s_waitcnt lgkmcnt(12)
    ds_read_b64_tr_b16 a[236:237], v26 offset:24576
    ds_read_b64_tr_b16 a[238:239], v26 offset:28672
    v_mfma_f32_16x16x32_bf16 v[80:83], a[208:211], v[128:131], 0
    s_waitcnt lgkmcnt(12)
    ds_read_b64_tr_b16 a[160:161], v23 offset:0
    v_mfma_f32_16x16x32_bf16 v[80:83], a[212:215], v[144:147], v[80:83]
    s_waitcnt lgkmcnt(11)
    ds_read_b64_tr_b16 a[162:163], v23 offset:4096
    v_mfma_f32_16x16x32_bf16 v[80:83], a[216:219], v[192:195], v[80:83]
    s_waitcnt lgkmcnt(10)
    ds_read_b64_tr_b16 a[164:165], v23 offset:8192
    v_mfma_f32_16x16x32_bf16 v[80:83], a[220:223], v[176:179], v[80:83]
    s_waitcnt lgkmcnt(9)
    ds_read_b64_tr_b16 a[166:167], v23 offset:12288
    v_mfma_f32_16x16x32_bf16 v[80:83], a[224:227], v[136:139], v[80:83]
    s_waitcnt lgkmcnt(8)
    ds_read_b64_tr_b16 a[168:169], v23 offset:16384
    v_mfma_f32_16x16x32_bf16 v[80:83], a[228:231], v[152:155], v[80:83]
    s_waitcnt lgkmcnt(7)
    ds_read_b64_tr_b16 a[170:171], v23 offset:20480
    v_mfma_f32_16x16x32_bf16 v[80:83], a[232:235], v[200:203], v[80:83]
    s_waitcnt lgkmcnt(6)
    ds_read_b64_tr_b16 a[172:173], v23 offset:24576
    v_mfma_f32_16x16x32_bf16 v[80:83], a[236:239], v[184:187], v[80:83]
    ds_read_b64_tr_b16 a[174:175], v23 offset:28672
    v_mfma_f32_16x16x32_bf16 v[84:87], a[236:239], v[188:191], 0
    ds_read_b64_tr_b16 a[176:177], v27 offset:0
    v_mfma_f32_16x16x32_bf16 v[84:87], a[232:235], v[204:207], v[84:87]
    ds_read_b64_tr_b16 a[178:179], v27 offset:4096
    v_mfma_f32_16x16x32_bf16 v[84:87], a[228:231], v[156:159], v[84:87]
    ds_read_b64_tr_b16 a[180:181], v27 offset:8192
    v_mfma_f32_16x16x32_bf16 v[84:87], a[224:227], v[140:143], v[84:87]
    ds_read_b64_tr_b16 a[182:183], v27 offset:12288
    v_mfma_f32_16x16x32_bf16 v[84:87], a[220:223], v[180:183], v[84:87]
    ds_read_b64_tr_b16 a[184:185], v27 offset:16384
    v_mfma_f32_16x16x32_bf16 v[84:87], a[216:219], v[196:199], v[84:87]
    ds_read_b64_tr_b16 a[186:187], v27 offset:20480
    v_mfma_f32_16x16x32_bf16 v[84:87], a[212:215], v[148:151], v[84:87]
    ds_read_b64_tr_b16 a[188:189], v27 offset:24576
    v_mfma_f32_16x16x32_bf16 v[84:87], a[208:211], v[132:135], v[84:87]
    s_waitcnt lgkmcnt(13)
    ds_read_b64_tr_b16 a[190:191], v27 offset:28672
    s_waitcnt vmcnt(13)
    s_barrier
    v_mfma_f32_16x16x32_bf16 v[88:91], a[160:163], v[128:131], 0
    s_waitcnt lgkmcnt(12)
    ds_read_b64_tr_b16 a[208:209], v12 offset:32768
    v_mfma_f32_16x16x32_bf16 v[88:91], a[164:167], v[144:147], v[88:91]
    s_waitcnt lgkmcnt(11)
    ds_read_b64_tr_b16 a[210:211], v12 offset:36864
    v_mfma_f32_16x16x32_bf16 v[88:91], a[168:171], v[192:195], v[88:91]
    s_waitcnt lgkmcnt(10)
    ds_read_b64_tr_b16 a[212:213], v12 offset:40960
    v_mfma_f32_16x16x32_bf16 v[88:91], a[172:175], v[176:179], v[88:91]
    s_waitcnt lgkmcnt(9)
    ds_read_b64_tr_b16 a[214:215], v12 offset:45056
    v_mfma_f32_16x16x32_bf16 v[88:91], a[176:179], v[136:139], v[88:91]
    s_waitcnt lgkmcnt(8)
    ds_read_b64_tr_b16 a[216:217], v12 offset:49152
    v_mfma_f32_16x16x32_bf16 v[88:91], a[180:183], v[152:155], v[88:91]
    s_waitcnt lgkmcnt(7)
    ds_read_b64_tr_b16 a[218:219], v12 offset:53248
    v_mfma_f32_16x16x32_bf16 v[88:91], a[184:187], v[200:203], v[88:91]
    s_waitcnt lgkmcnt(6)
    s_add_u32 s49, s46, 768
    ds_read_b64_tr_b16 a[220:221], v12 offset:57344
    v_mfma_f32_16x16x32_bf16 v[88:91], a[188:191], v[184:187], v[88:91]
    s_add_u32 m0, s42, 0
    ds_read_b64_tr_b16 a[222:223], v12 offset:61440
    v_mfma_f32_16x16x32_bf16 v[92:95], a[188:191], v[188:191], 0
    buffer_load_dwordx4 v46, s[20:23], s49 offen lds
    v_mfma_f32_16x16x32_bf16 v[92:95], a[184:187], v[204:207], v[92:95]
    ds_read_b64_tr_b16 a[224:225], v16 offset:32768
    ds_read_b64_tr_b16 a[226:227], v16 offset:36864
    v_mfma_f32_16x16x32_bf16 v[92:95], a[180:183], v[156:159], v[92:95]
    buffer_load_dwordx4 v47, s[20:23], s49 offen offset:1024 lds
    v_mfma_f32_16x16x32_bf16 v[92:95], a[176:179], v[140:143], v[92:95]
    ds_read_b64_tr_b16 a[228:229], v16 offset:40960
    ds_read_b64_tr_b16 a[230:231], v16 offset:45056
    v_mfma_f32_16x16x32_bf16 v[92:95], a[172:175], v[180:183], v[92:95]
    ds_read_b64_tr_b16 a[232:233], v16 offset:49152
    v_mfma_f32_16x16x32_bf16 v[92:95], a[168:171], v[196:199], v[92:95]
    ds_read_b64_tr_b16 a[234:235], v16 offset:53248
    v_mfma_f32_16x16x32_bf16 v[92:95], a[164:167], v[148:151], v[92:95]
    ds_read_b64_tr_b16 a[236:237], v16 offset:57344
    v_mfma_f32_16x16x32_bf16 v[92:95], a[160:163], v[132:135], v[92:95]
    s_waitcnt lgkmcnt(13)
    ds_read_b64_tr_b16 a[238:239], v16 offset:61440
    v_mfma_f32_16x16x32_bf16 v[64:67], a[208:211], a[64:67], v[64:67]
    s_waitcnt lgkmcnt(12)
    buffer_load_dwordx4 v48, s[20:23], s49 offen offset:2048 lds
    v_mfma_f32_16x16x32_bf16 v[64:67], a[212:215], a[68:71], v[64:67]
    s_waitcnt lgkmcnt(10)
    ds_read_b64_tr_b16 a[160:161], v13 offset:32768
    ds_read_b64_tr_b16 a[162:163], v13 offset:36864
    v_mfma_f32_16x16x32_bf16 v[64:67], a[216:219], a[72:75], v[64:67]
    s_waitcnt lgkmcnt(10)
    s_add_u32 s92, s92, 16
    buffer_load_dwordx4 v49, s[20:23], s49 offen offset:3072 lds
    v_mfma_f32_16x16x32_bf16 v[64:67], a[220:223], a[76:79], v[64:67]
    s_waitcnt lgkmcnt(8)
    s_waitcnt vmcnt(9)
    ds_read_b64_tr_b16 a[164:165], v13 offset:40960
    ds_read_b64_tr_b16 a[166:167], v13 offset:45056
    v_mfma_f32_16x16x32_bf16 v[64:67], a[224:227], a[80:83], v[64:67]
    s_waitcnt lgkmcnt(8)
    buffer_store_dword v10, v8, s[24:27], s92 offen sc1
    v_mfma_f32_16x16x32_bf16 v[64:67], a[228:231], a[84:87], v[64:67]
    s_waitcnt lgkmcnt(6)
    ds_read_b64_tr_b16 a[168:169], v13 offset:49152
    ds_read_b64_tr_b16 a[170:171], v13 offset:53248
    v_mfma_f32_16x16x32_bf16 v[64:67], a[232:235], a[88:91], v[64:67]
    s_waitcnt lgkmcnt(6)
    s_add_u32 s49, s46, 74496
    ds_read_b64_tr_b16 a[172:173], v13 offset:57344
    v_mfma_f32_16x16x32_bf16 v[64:67], a[236:239], a[92:95], v[64:67]
    s_add_u32 m0, s42, 16384
    ds_read_b64_tr_b16 a[174:175], v13 offset:61440
    v_mfma_f32_16x16x32_bf16 v[68:71], a[236:239], a[124:127], v[68:71]
    buffer_load_dwordx4 v46, s[20:23], s49 offen lds
    v_mfma_f32_16x16x32_bf16 v[68:71], a[232:235], a[120:123], v[68:71]
    ds_read_b64_tr_b16 a[176:177], v17 offset:32768
    ds_read_b64_tr_b16 a[178:179], v17 offset:36864
    v_mfma_f32_16x16x32_bf16 v[68:71], a[228:231], a[116:119], v[68:71]
    buffer_load_dwordx4 v47, s[20:23], s49 offen offset:1024 lds
    v_mfma_f32_16x16x32_bf16 v[68:71], a[224:227], a[112:115], v[68:71]
    ds_read_b64_tr_b16 a[180:181], v17 offset:40960
    ds_read_b64_tr_b16 a[182:183], v17 offset:45056
    v_mfma_f32_16x16x32_bf16 v[68:71], a[220:223], a[108:111], v[68:71]
    ds_read_b64_tr_b16 a[184:185], v17 offset:49152
    v_cvt_pk_bf16_f32 v224, v64, v65
    v_mfma_f32_16x16x32_bf16 v[68:71], a[216:219], a[104:107], v[68:71]
    ds_read_b64_tr_b16 a[186:187], v17 offset:53248
    v_cvt_pk_bf16_f32 v225, v66, v67
    v_mfma_f32_16x16x32_bf16 v[68:71], a[212:215], a[100:103], v[68:71]
    ds_read_b64_tr_b16 a[188:189], v17 offset:57344
    v_mfma_f32_16x16x32_bf16 v[68:71], a[208:211], a[96:99], v[68:71]
    s_waitcnt lgkmcnt(13)
    ds_read_b64_tr_b16 a[190:191], v17 offset:61440
    v_mfma_f32_16x16x32_bf16 v[72:75], a[160:163], a[64:67], v[72:75]
    s_waitcnt lgkmcnt(12)
    buffer_load_dwordx4 v48, s[20:23], s49 offen offset:2048 lds
    v_mfma_f32_16x16x32_bf16 v[72:75], a[164:167], a[68:71], v[72:75]
    s_waitcnt lgkmcnt(10)
    ds_read_b64_tr_b16 a[208:209], v14 offset:32768
    ds_read_b64_tr_b16 a[210:211], v14 offset:36864
    v_mfma_f32_16x16x32_bf16 v[72:75], a[168:171], a[72:75], v[72:75]
    s_waitcnt lgkmcnt(10)
    buffer_load_dwordx4 v49, s[20:23], s49 offen offset:3072 lds
    v_mfma_f32_16x16x32_bf16 v[72:75], a[172:175], a[76:79], v[72:75]
    s_waitcnt lgkmcnt(8)
    ds_read_b64_tr_b16 a[212:213], v14 offset:40960
    ds_read_b64_tr_b16 a[214:215], v14 offset:45056
    v_mfma_f32_16x16x32_bf16 v[72:75], a[176:179], a[80:83], v[72:75]
    s_waitcnt lgkmcnt(8)
    ds_read_b64_tr_b16 a[216:217], v14 offset:49152
    v_cvt_pk_bf16_f32 v228, v68, v69
    v_mfma_f32_16x16x32_bf16 v[72:75], a[180:183], a[84:87], v[72:75]
    s_waitcnt lgkmcnt(7)
    ds_read_b64_tr_b16 a[218:219], v14 offset:53248
    v_cvt_pk_bf16_f32 v229, v70, v71
    v_mfma_f32_16x16x32_bf16 v[72:75], a[184:187], a[88:91], v[72:75]
    s_waitcnt lgkmcnt(6)
    s_and_b32 s42, s2, 7
    ds_read_b64_tr_b16 a[220:221], v14 offset:57344
    v_mfma_f32_16x16x32_bf16 v[72:75], a[188:191], a[92:95], v[72:75]
    s_mov_b64 s[20:21], s[52:53]
    ds_read_b64_tr_b16 a[222:223], v14 offset:61440
    v_mfma_f32_16x16x32_bf16 v[76:79], a[188:191], a[124:127], v[76:79]
    ds_read_b64_tr_b16 a[224:225], v18 offset:32768
    s_waitcnt vmcnt(9)
    v_readfirstlane_b32 s37, v63
    v_mfma_f32_16x16x32_bf16 v[76:79], a[184:187], a[120:123], v[76:79]
    s_mov_b32 s22, 1152
    ds_read_b64_tr_b16 a[226:227], v18 offset:36864
    v_mfma_f32_16x16x32_bf16 v[76:79], a[180:183], a[116:119], v[76:79]
    s_mov_b32 s23, 0x20000
    ds_read_b64_tr_b16 a[228:229], v18 offset:40960
    s_cmp_lt_u32 s37, 256
    s_cbranch_scc1 Lattn_armwait
Lattn_armed:
    v_mfma_f32_16x16x32_bf16 v[76:79], a[176:179], a[112:115], v[76:79]
    ds_read_b64_tr_b16 a[230:231], v18 offset:45056
    v_mfma_f32_16x16x32_bf16 v[76:79], a[172:175], a[108:111], v[76:79]
    ds_read_b64_tr_b16 a[232:233], v18 offset:49152
    v_cvt_pk_bf16_f32 v226, v72, v73
    v_mfma_f32_16x16x32_bf16 v[76:79], a[168:171], a[104:107], v[76:79]
    s_add_u32 s38, s93, 1024
    ds_read_b64_tr_b16 a[234:235], v18 offset:53248
    v_cvt_pk_bf16_f32 v227, v74, v75
    v_mfma_f32_16x16x32_bf16 v[76:79], a[164:167], a[100:103], v[76:79]
    buffer_store_dwordx4 v[224:227], v56, s[28:31], s38 offen sc1
    v_mfma_f32_16x16x32_bf16 v[76:79], a[160:163], a[96:99], v[76:79]
    s_waitcnt lgkmcnt(12)
    s_mov_b32 s45, 18688
    ds_read_b64_tr_b16 a[236:237], v18 offset:57344
    ds_read_b64_tr_b16 a[238:239], v18 offset:61440
    v_mfma_f32_16x16x32_bf16 v[80:83], a[208:211], a[64:67], v[80:83]
    s_waitcnt lgkmcnt(12)
    buffer_load_dwordx4 v[160:163], v5, s[24:27], s45 offen offset:0 sc1
    v_mfma_f32_16x16x32_bf16 v[80:83], a[212:215], a[68:71], v[80:83]
    s_waitcnt lgkmcnt(10)
    ds_read_b64_tr_b16 a[160:161], v15 offset:32768
    ds_read_b64_tr_b16 a[162:163], v15 offset:36864
    v_mfma_f32_16x16x32_bf16 v[80:83], a[216:219], a[72:75], v[80:83]
    s_waitcnt lgkmcnt(10)
    buffer_load_dwordx4 v[164:167], v5, s[24:27], s45 offen offset:512 sc1
    v_mfma_f32_16x16x32_bf16 v[80:83], a[220:223], a[76:79], v[80:83]
    s_waitcnt lgkmcnt(8)
    ds_read_b64_tr_b16 a[164:165], v15 offset:40960
    ds_read_b64_tr_b16 a[166:167], v15 offset:45056
    v_mfma_f32_16x16x32_bf16 v[80:83], a[224:227], a[80:83], v[80:83]
    s_waitcnt lgkmcnt(8)
    ds_read_b64_tr_b16 a[168:169], v15 offset:49152
    v_cvt_pk_bf16_f32 v230, v76, v77
    v_mfma_f32_16x16x32_bf16 v[80:83], a[228:231], a[84:87], v[80:83]
    s_waitcnt lgkmcnt(7)
    s_add_u32 s38, s93, 164864
    ds_read_b64_tr_b16 a[170:171], v15 offset:53248
    v_cvt_pk_bf16_f32 v231, v78, v79
    v_mfma_f32_16x16x32_bf16 v[80:83], a[232:235], a[88:91], v[80:83]
    s_waitcnt lgkmcnt(6)
    buffer_store_dwordx4 v[228:231], v56, s[28:31], s38 offen sc1
    v_mfma_f32_16x16x32_bf16 v[80:83], a[236:239], a[92:95], v[80:83]
    ds_read_b64_tr_b16 a[172:173], v15 offset:57344
    ds_read_b64_tr_b16 a[174:175], v15 offset:61440
    v_mfma_f32_16x16x32_bf16 v[84:87], a[236:239], a[124:127], v[84:87]
    ds_read_b64_tr_b16 a[176:177], v19 offset:32768
    v_mfma_f32_16x16x32_bf16 v[84:87], a[232:235], a[120:123], v[84:87]
    ds_read_b64_tr_b16 a[178:179], v19 offset:36864
    v_mfma_f32_16x16x32_bf16 v[84:87], a[228:231], a[116:119], v[84:87]
    buffer_load_dwordx4 v[168:171], v59, s[24:27], s45 offen offset:1024 sc1
    v_mfma_f32_16x16x32_bf16 v[84:87], a[224:227], a[112:115], v[84:87]
    ds_read_b64_tr_b16 a[180:181], v19 offset:40960
    ds_read_b64_tr_b16 a[182:183], v19 offset:45056
    v_mfma_f32_16x16x32_bf16 v[84:87], a[220:223], a[108:111], v[84:87]
    ds_read_b64_tr_b16 a[184:185], v19 offset:49152
    v_cvt_pk_bf16_f32 v232, v80, v81
    v_mfma_f32_16x16x32_bf16 v[84:87], a[216:219], a[104:107], v[84:87]
    s_mov_b32 s45, 20992
    ds_read_b64_tr_b16 a[186:187], v19 offset:53248
    v_cvt_pk_bf16_f32 v233, v82, v83
    v_mfma_f32_16x16x32_bf16 v[84:87], a[212:215], a[100:103], v[84:87]
    buffer_load_dwordx4 v[172:175], v5, s[24:27], s45 offen offset:0 sc1
    v_mfma_f32_16x16x32_bf16 v[84:87], a[208:211], a[96:99], v[84:87]
    s_waitcnt lgkmcnt(12)
    ds_read_b64_tr_b16 a[188:189], v19 offset:57344
    ds_read_b64_tr_b16 a[190:191], v19 offset:61440
    s_barrier
    v_mfma_f32_16x16x32_bf16 v[88:91], a[160:163], a[64:67], v[88:91]
    s_waitcnt lgkmcnt(12)
    ds_read_b64_tr_b16 a[208:209], v20 offset:32768
    v_mfma_f32_16x16x32_bf16 v[88:91], a[164:167], a[68:71], v[88:91]
    s_waitcnt lgkmcnt(11)
    ds_read_b64_tr_b16 a[210:211], v20 offset:36864
    v_mfma_f32_16x16x32_bf16 v[88:91], a[168:171], a[72:75], v[88:91]
    s_waitcnt lgkmcnt(10)
    buffer_load_dwordx4 v[208:211], v5, s[24:27], s45 offen offset:512 sc1
    v_mfma_f32_16x16x32_bf16 v[88:91], a[172:175], a[76:79], v[88:91]
    s_waitcnt lgkmcnt(8)
    ds_read_b64_tr_b16 a[212:213], v20 offset:40960
    ds_read_b64_tr_b16 a[214:215], v20 offset:45056
    v_mfma_f32_16x16x32_bf16 v[88:91], a[176:179], a[80:83], v[88:91]
    s_waitcnt lgkmcnt(8)
    s_add_u32 s57, s59, 4096
    ds_read_b64_tr_b16 a[216:217], v20 offset:49152
    v_cvt_pk_bf16_f32 v236, v84, v85
    v_mfma_f32_16x16x32_bf16 v[88:91], a[180:183], a[84:87], v[88:91]
    s_waitcnt lgkmcnt(7)
    s_add_u32 m0, s6, -98304
    ds_read_b64_tr_b16 a[218:219], v20 offset:53248
    v_cvt_pk_bf16_f32 v237, v86, v87
    v_mfma_f32_16x16x32_bf16 v[88:91], a[184:187], a[88:91], v[88:91]
    s_waitcnt lgkmcnt(6)
    buffer_load_dwordx4 v255, s[84:87], s57 offen lds
    v_mfma_f32_16x16x32_bf16 v[88:91], a[188:191], a[92:95], v[88:91]
    ds_read_b64_tr_b16 a[220:221], v20 offset:57344
    ds_read_b64_tr_b16 a[222:223], v20 offset:61440
    v_mfma_f32_16x16x32_bf16 v[92:95], a[188:191], a[124:127], v[92:95]
    s_add_u32 s57, s59, 8192
    buffer_load_dwordx4 v[212:215], v59, s[24:27], s45 offen offset:1024 sc1
    v_mfma_f32_16x16x32_bf16 v[92:95], a[184:187], a[120:123], v[92:95]
    s_add_u32 m0, s6, -94208
    ds_read_b64_tr_b16 a[224:225], v24 offset:32768
    ds_read_b64_tr_b16 a[226:227], v24 offset:36864
    v_mfma_f32_16x16x32_bf16 v[92:95], a[180:183], a[116:119], v[92:95]
    buffer_load_dwordx4 v255, s[84:87], s57 offen lds
    v_mfma_f32_16x16x32_bf16 v[92:95], a[176:179], a[112:115], v[92:95]
    ds_read_b64_tr_b16 a[228:229], v24 offset:40960
    ds_read_b64_tr_b16 a[230:231], v24 offset:45056
    v_mfma_f32_16x16x32_bf16 v[92:95], a[172:175], a[108:111], v[92:95]
    ds_read_b64_tr_b16 a[232:233], v24 offset:49152
    v_cvt_pk_bf16_f32 v234, v88, v89
    v_mfma_f32_16x16x32_bf16 v[92:95], a[168:171], a[104:107], v[92:95]
    s_add_u32 s38, s93, 1152
    ds_read_b64_tr_b16 a[234:235], v24 offset:53248
    v_cvt_pk_bf16_f32 v235, v90, v91
    v_mfma_f32_16x16x32_bf16 v[92:95], a[164:167], a[100:103], v[92:95]
    buffer_store_dwordx4 v[232:235], v56, s[28:31], s38 offen sc1
    v_mfma_f32_16x16x32_bf16 v[92:95], a[160:163], a[96:99], v[92:95]
    s_waitcnt lgkmcnt(12)
    ds_read_b64_tr_b16 a[236:237], v24 offset:57344
    ds_read_b64_tr_b16 a[238:239], v24 offset:61440
    v_mfma_f32_16x16x32_bf16 v[96:99], a[208:211], v[128:131], 0
    s_waitcnt lgkmcnt(12)
    s_add_u32 s57, s59, 12288
    ds_read_b64_tr_b16 a[160:161], v21 offset:32768
    v_mfma_f32_16x16x32_bf16 v[96:99], a[212:215], v[144:147], v[96:99]
    s_waitcnt lgkmcnt(11)
    s_add_u32 m0, s6, -90112
    ds_read_b64_tr_b16 a[162:163], v21 offset:36864
    v_mfma_f32_16x16x32_bf16 v[96:99], a[216:219], v[192:195], v[96:99]
    s_waitcnt lgkmcnt(10)
    buffer_load_dwordx4 v255, s[84:87], s57 offen lds
    v_mfma_f32_16x16x32_bf16 v[96:99], a[220:223], v[176:179], v[96:99]
    s_waitcnt lgkmcnt(8)
    ds_read_b64_tr_b16 a[164:165], v21 offset:40960
    ds_read_b64_tr_b16 a[166:167], v21 offset:45056
    v_mfma_f32_16x16x32_bf16 v[96:99], a[224:227], v[136:139], v[96:99]
    s_waitcnt lgkmcnt(8)
    ds_read_b64_tr_b16 a[168:169], v21 offset:49152
    v_cvt_pk_bf16_f32 v238, v92, v93
    v_mfma_f32_16x16x32_bf16 v[96:99], a[228:231], v[152:155], v[96:99]
    s_waitcnt lgkmcnt(7)
    s_add_u32 s38, s93, 164992
    ds_read_b64_tr_b16 a[170:171], v21 offset:53248
    v_cvt_pk_bf16_f32 v239, v94, v95
    v_mfma_f32_16x16x32_bf16 v[96:99], a[232:235], v[200:203], v[96:99]
    s_waitcnt lgkmcnt(6)
    buffer_store_dwordx4 v[236:239], v56, s[28:31], s38 offen sc1
    v_mfma_f32_16x16x32_bf16 v[96:99], a[236:239], v[184:187], v[96:99]
    ds_read_b64_tr_b16 a[172:173], v21 offset:57344
    ds_read_b64_tr_b16 a[174:175], v21 offset:61440
    v_mfma_f32_16x16x32_bf16 v[100:103], a[236:239], v[188:191], 0
    s_add_u32 s57, s59, 16384
    buffer_load_dwordx2 v[92:93], v58, s[12:15], 0 offen offset:1024
    v_mfma_f32_16x16x32_bf16 v[100:103], a[232:235], v[204:207], v[100:103]
    s_add_u32 m0, s6, -86016
    ds_read_b64_tr_b16 a[176:177], v25 offset:32768
    ds_read_b64_tr_b16 a[178:179], v25 offset:36864
    v_mfma_f32_16x16x32_bf16 v[100:103], a[228:231], v[156:159], v[100:103]
    buffer_load_dwordx4 v255, s[84:87], s57 offen lds
    v_mfma_f32_16x16x32_bf16 v[100:103], a[224:227], v[140:143], v[100:103]
    ds_read_b64_tr_b16 a[180:181], v25 offset:40960
    ds_read_b64_tr_b16 a[182:183], v25 offset:45056
    v_mfma_f32_16x16x32_bf16 v[100:103], a[220:223], v[180:183], v[100:103]
    ds_read_b64_tr_b16 a[184:185], v25 offset:49152
    v_mfma_f32_16x16x32_bf16 v[100:103], a[216:219], v[196:199], v[100:103]
    ds_read_b64_tr_b16 a[186:187], v25 offset:53248
    v_mfma_f32_16x16x32_bf16 v[100:103], a[212:215], v[148:151], v[100:103]
    buffer_load_dwordx2 v[94:95], v58, s[12:15], 0 offen offset:1056
    v_mfma_f32_16x16x32_bf16 v[100:103], a[208:211], v[132:135], v[100:103]
    s_waitcnt lgkmcnt(12)
    ds_read_b64_tr_b16 a[188:189], v25 offset:57344
    ds_read_b64_tr_b16 a[190:191], v25 offset:61440
    v_mfma_f32_16x16x32_bf16 v[104:107], a[160:163], v[128:131], 0
    s_waitcnt lgkmcnt(12)
    s_add_u32 s57, s59, 20480
    ds_read_b64_tr_b16 a[208:209], v22 offset:32768
    v_mfma_f32_16x16x32_bf16 v[104:107], a[164:167], v[144:147], v[104:107]
    s_waitcnt lgkmcnt(11)
    s_add_u32 m0, s6, -81920
    ds_read_b64_tr_b16 a[210:211], v22 offset:36864
    v_mfma_f32_16x16x32_bf16 v[104:107], a[168:171], v[192:195], v[104:107]
    s_waitcnt lgkmcnt(10)
    buffer_load_dwordx4 v255, s[84:87], s57 offen lds
    v_mfma_f32_16x16x32_bf16 v[104:107], a[172:175], v[176:179], v[104:107]
    s_waitcnt lgkmcnt(8)
    s_mov_b32 s45, 19840
    ds_read_b64_tr_b16 a[212:213], v22 offset:40960
    ds_read_b64_tr_b16 a[214:215], v22 offset:45056
    v_mfma_f32_16x16x32_bf16 v[104:107], a[176:179], v[136:139], v[104:107]
    s_waitcnt lgkmcnt(8)
    s_add_u32 s57, s59, 24576
    buffer_load_dwordx4 v[64:67], v5, s[24:27], s45 offen offset:0 sc1
    v_mfma_f32_16x16x32_bf16 v[104:107], a[180:183], v[152:155], v[104:107]
    s_waitcnt lgkmcnt(6)
    s_add_u32 m0, s6, -77824
    ds_read_b64_tr_b16 a[216:217], v22 offset:49152
    ds_read_b64_tr_b16 a[218:219], v22 offset:53248
    v_mfma_f32_16x16x32_bf16 v[104:107], a[184:187], v[200:203], v[104:107]
    s_waitcnt lgkmcnt(6)
    buffer_load_dwordx4 v255, s[84:87], s57 offen lds
    v_mfma_f32_16x16x32_bf16 v[104:107], a[188:191], v[184:187], v[104:107]
    ds_read_b64_tr_b16 a[220:221], v22 offset:57344
    ds_read_b64_tr_b16 a[222:223], v22 offset:61440
    v_mfma_f32_16x16x32_bf16 v[108:111], a[188:191], v[188:191], 0
    s_add_u32 s57, s59, 28672
    ds_read_b64_tr_b16 a[224:225], v26 offset:32768
    v_mfma_f32_16x16x32_bf16 v[108:111], a[184:187], v[204:207], v[108:111]
    s_add_u32 m0, s6, -73728
    ds_read_b64_tr_b16 a[226:227], v26 offset:36864
    v_mfma_f32_16x16x32_bf16 v[108:111], a[180:183], v[156:159], v[108:111]
    buffer_load_dwordx4 v255, s[84:87], s57 offen lds
    v_mfma_f32_16x16x32_bf16 v[108:111], a[176:179], v[140:143], v[108:111]
    ds_read_b64_tr_b16 a[228:229], v26 offset:40960
    ds_read_b64_tr_b16 a[230:231], v26 offset:45056
    v_mfma_f32_16x16x32_bf16 v[108:111], a[172:175], v[180:183], v[108:111]
    s_add_u32 s57, s59, 32768
    buffer_load_dwordx4 v[68:71], v5, s[24:27], s45 offen offset:512 sc1
    v_mfma_f32_16x16x32_bf16 v[108:111], a[168:171], v[196:199], v[108:111]
    s_add_u32 m0, s6, -69632
    ds_read_b64_tr_b16 a[232:233], v26 offset:49152
    ds_read_b64_tr_b16 a[234:235], v26 offset:53248
    v_mfma_f32_16x16x32_bf16 v[108:111], a[164:167], v[148:151], v[108:111]
    buffer_load_dwordx4 v255, s[84:87], s57 offen lds
    v_mfma_f32_16x16x32_bf16 v[108:111], a[160:163], v[132:135], v[108:111]
    s_waitcnt lgkmcnt(12)
    ds_read_b64_tr_b16 a[236:237], v26 offset:57344
    ds_read_b64_tr_b16 a[238:239], v26 offset:61440
    v_mfma_f32_16x16x32_bf16 v[112:115], a[208:211], v[128:131], 0
    s_waitcnt lgkmcnt(12)
    ds_read_b64_tr_b16 a[160:161], v23 offset:32768
    v_mfma_f32_16x16x32_bf16 v[112:115], a[212:215], v[144:147], v[112:115]
    s_waitcnt lgkmcnt(11)
    ds_read_b64_tr_b16 a[162:163], v23 offset:36864
    v_mfma_f32_16x16x32_bf16 v[112:115], a[216:219], v[192:195], v[112:115]
    s_waitcnt lgkmcnt(10)
    ds_read_b64_tr_b16 a[164:165], v23 offset:40960
    v_mfma_f32_16x16x32_bf16 v[112:115], a[220:223], v[176:179], v[112:115]
    s_waitcnt lgkmcnt(9)
    ds_read_b64_tr_b16 a[166:167], v23 offset:45056
    v_mfma_f32_16x16x32_bf16 v[112:115], a[224:227], v[136:139], v[112:115]
    s_waitcnt lgkmcnt(8)
    buffer_load_dwordx4 v[72:75], v59, s[24:27], s45 offen offset:1024 sc1
    v_mfma_f32_16x16x32_bf16 v[112:115], a[228:231], v[152:155], v[112:115]
    s_waitcnt lgkmcnt(6)
    ds_read_b64_tr_b16 a[168:169], v23 offset:49152
    ds_read_b64_tr_b16 a[170:171], v23 offset:53248
    v_mfma_f32_16x16x32_bf16 v[112:115], a[232:235], v[200:203], v[112:115]
    s_waitcnt lgkmcnt(6)
    ds_read_b64_tr_b16 a[172:173], v23 offset:57344
    v_mfma_f32_16x16x32_bf16 v[112:115], a[236:239], v[184:187], v[112:115]
    ds_read_b64_tr_b16 a[174:175], v23 offset:61440
    v_mfma_f32_16x16x32_bf16 v[116:119], a[236:239], v[188:191], 0
    buffer_load_dwordx2 v[76:77], v3, s[20:23], 0 offen offset:0
    v_mfma_f32_16x16x32_bf16 v[116:119], a[232:235], v[204:207], v[116:119]
    ds_read_b64_tr_b16 a[176:177], v27 offset:32768
    ds_read_b64_tr_b16 a[178:179], v27 offset:36864
    v_mfma_f32_16x16x32_bf16 v[116:119], a[228:231], v[156:159], v[116:119]
    ds_read_b64_tr_b16 a[180:181], v27 offset:40960
    v_mfma_f32_16x16x32_bf16 v[116:119], a[224:227], v[140:143], v[116:119]
    ds_read_b64_tr_b16 a[182:183], v27 offset:45056
    v_mfma_f32_16x16x32_bf16 v[116:119], a[220:223], v[180:183], v[116:119]
    buffer_load_dwordx2 v[78:79], v3, s[20:23], 0 offen offset:32
    v_mfma_f32_16x16x32_bf16 v[116:119], a[216:219], v[196:199], v[116:119]
    ds_read_b64_tr_b16 a[184:185], v27 offset:49152
    ds_read_b64_tr_b16 a[186:187], v27 offset:53248
    v_mfma_f32_16x16x32_bf16 v[116:119], a[212:215], v[148:151], v[116:119]
    ds_read_b64_tr_b16 a[188:189], v27 offset:57344
    v_mfma_f32_16x16x32_bf16 v[116:119], a[208:211], v[132:135], v[116:119]
    ds_read_b64_tr_b16 a[190:191], v27 offset:61440
    s_waitcnt vmcnt(25)
    s_waitcnt lgkmcnt(0)
    s_barrier
    v_mfma_f32_16x16x32_bf16 v[120:123], a[160:163], v[128:131], 0
    ds_read_b64_tr_b16 a[208:209], v12 offset:0
    v_mfma_f32_16x16x32_bf16 v[120:123], a[164:167], v[144:147], v[120:123]
    ds_read_b64_tr_b16 a[210:211], v12 offset:4096
    v_mfma_f32_16x16x32_bf16 v[120:123], a[168:171], v[192:195], v[120:123]
    buffer_load_dwordx2 v[80:81], v3, s[20:23], 0 offen offset:512
    v_mfma_f32_16x16x32_bf16 v[120:123], a[172:175], v[176:179], v[120:123]
    s_add_u32 s39, s39, 16
    ds_read_b64_tr_b16 a[212:213], v12 offset:8192
    ds_read_b64_tr_b16 a[214:215], v12 offset:12288
    v_mfma_f32_16x16x32_bf16 v[120:123], a[176:179], v[136:139], v[120:123]
    buffer_load_dword v11, v9, s[24:27], s39 offen sc1
    v_mfma_f32_16x16x32_bf16 v[120:123], a[180:183], v[152:155], v[120:123]
    ds_read_b64_tr_b16 a[216:217], v12 offset:16384
    ds_read_b64_tr_b16 a[218:219], v12 offset:20480
    v_mfma_f32_16x16x32_bf16 v[120:123], a[184:187], v[200:203], v[120:123]
    ds_read_b64_tr_b16 a[220:221], v12 offset:24576
    v_mfma_f32_16x16x32_bf16 v[120:123], a[188:191], v[184:187], v[120:123]
    ds_read_b64_tr_b16 a[222:223], v12 offset:28672
    v_mfma_f32_16x16x32_bf16 v[124:127], a[188:191], v[188:191], 0
    buffer_load_dwordx2 v[82:83], v3, s[20:23], 0 offen offset:544
    v_mfma_f32_16x16x32_bf16 v[124:127], a[184:187], v[204:207], v[124:127]
    ds_read_b64_tr_b16 a[224:225], v16 offset:0
    ds_read_b64_tr_b16 a[226:227], v16 offset:4096
    v_mfma_f32_16x16x32_bf16 v[124:127], a[180:183], v[156:159], v[124:127]
    ds_read_b64_tr_b16 a[228:229], v16 offset:8192
    v_mfma_f32_16x16x32_bf16 v[124:127], a[176:179], v[140:143], v[124:127]
    ds_read_b64_tr_b16 a[230:231], v16 offset:12288
    v_mfma_f32_16x16x32_bf16 v[124:127], a[172:175], v[180:183], v[124:127]
    buffer_load_dwordx2 v[84:85], v55, s[20:23], 0 offen offset:1024
    v_mfma_f32_16x16x32_bf16 v[124:127], a[168:171], v[196:199], v[124:127]
    ds_read_b64_tr_b16 a[232:233], v16 offset:16384
    ds_read_b64_tr_b16 a[234:235], v16 offset:20480
    v_mfma_f32_16x16x32_bf16 v[124:127], a[164:167], v[148:151], v[124:127]
    ds_read_b64_tr_b16 a[236:237], v16 offset:24576
    v_mfma_f32_16x16x32_bf16 v[124:127], a[160:163], v[132:135], v[124:127]
    s_waitcnt lgkmcnt(13)
    ds_read_b64_tr_b16 a[238:239], v16 offset:28672
    v_mfma_f32_16x16x32_bf16 v[96:99], a[208:211], a[64:67], v[96:99]
    s_waitcnt lgkmcnt(12)
    buffer_load_dwordx2 v[86:87], v55, s[20:23], 0 offen offset:1056
    v_mfma_f32_16x16x32_bf16 v[96:99], a[212:215], a[68:71], v[96:99]
    s_waitcnt lgkmcnt(10)
    ds_read_b64_tr_b16 a[160:161], v13 offset:0
    ds_read_b64_tr_b16 a[162:163], v13 offset:4096
    v_mfma_f32_16x16x32_bf16 v[96:99], a[216:219], a[72:75], v[96:99]
    s_waitcnt lgkmcnt(10)
    ds_read_b64_tr_b16 a[164:165], v13 offset:8192
    v_mfma_f32_16x16x32_bf16 v[96:99], a[220:223], a[76:79], v[96:99]
    s_waitcnt lgkmcnt(9)
    ds_read_b64_tr_b16 a[166:167], v13 offset:12288
    v_mfma_f32_16x16x32_bf16 v[96:99], a[224:227], a[80:83], v[96:99]
    s_waitcnt lgkmcnt(8)
    ds_read_b64_tr_b16 a[168:169], v13 offset:16384
Ltour11:
    s_cbranch_execz Ltour15
    v_mfma_f32_16x16x32_bf16 v[96:99], a[228:231], a[84:87], v[96:99]
    s_waitcnt lgkmcnt(7)
    s_mov_b32 s45, 22144
    ds_read_b64_tr_b16 a[170:171], v13 offset:20480
    v_mfma_f32_16x16x32_bf16 v[96:99], a[232:235], a[88:91], v[96:99]
    s_waitcnt lgkmcnt(6)
    buffer_load_dwordx4 v[216:219], v5, s[24:27], s45 offen offset:0 sc1
    v_mfma_f32_16x16x32_bf16 v[96:99], a[236:239], a[92:95], v[96:99]
    ds_read_b64_tr_b16 a[172:173], v13 offset:24576
    ds_read_b64_tr_b16 a[174:175], v13 offset:28672
    v_mfma_f32_16x16x32_bf16 v[100:103], a[236:239], a[124:127], v[100:103]
    ds_read_b64_tr_b16 a[176:177], v17 offset:0
    v_mfma_f32_16x16x32_bf16 v[100:103], a[232:235], a[120:123], v[100:103]
    ds_read_b64_tr_b16 a[178:179], v17 offset:4096
    v_mfma_f32_16x16x32_bf16 v[100:103], a[228:231], a[116:119], v[100:103]
    buffer_load_dwordx4 v[220:223], v5, s[24:27], s45 offen offset:512 sc1
    v_mfma_f32_16x16x32_bf16 v[100:103], a[224:227], a[112:115], v[100:103]
    ds_read_b64_tr_b16 a[180:181], v17 offset:8192
    ds_read_b64_tr_b16 a[182:183], v17 offset:12288
    v_mfma_f32_16x16x32_bf16 v[100:103], a[220:223], a[108:111], v[100:103]
    ds_read_b64_tr_b16 a[184:185], v17 offset:16384
    v_cvt_pk_bf16_f32 v224, v96, v97
    v_mfma_f32_16x16x32_bf16 v[100:103], a[216:219], a[104:107], v[100:103]
    ds_read_b64_tr_b16 a[186:187], v17 offset:20480
    v_cvt_pk_bf16_f32 v225, v98, v99
    v_mfma_f32_16x16x32_bf16 v[100:103], a[212:215], a[100:103], v[100:103]
    ds_read_b64_tr_b16 a[188:189], v17 offset:24576
    v_mfma_f32_16x16x32_bf16 v[100:103], a[208:211], a[96:99], v[100:103]
    s_waitcnt lgkmcnt(13)
    ds_read_b64_tr_b16 a[190:191], v17 offset:28672
    v_mfma_f32_16x16x32_bf16 v[104:107], a[160:163], a[64:67], v[104:107]
    s_waitcnt lgkmcnt(12)
    buffer_load_dwordx4 v[88:91], v59, s[24:27], s45 offen offset:1024 sc1
    v_mfma_f32_16x16x32_bf16 v[104:107], a[164:167], a[68:71], v[104:107]
    s_waitcnt lgkmcnt(10)
    ds_read_b64_tr_b16 a[208:209], v14 offset:0
    ds_read_b64_tr_b16 a[210:211], v14 offset:4096
    v_mfma_f32_16x16x32_bf16 v[104:107], a[168:171], a[72:75], v[104:107]
    s_waitcnt lgkmcnt(10)
    ds_read_b64_tr_b16 a[212:213], v14 offset:8192
    v_mfma_f32_16x16x32_bf16 v[104:107], a[172:175], a[76:79], v[104:107]
    s_waitcnt lgkmcnt(9)
    ds_read_b64_tr_b16 a[214:215], v14 offset:12288
    v_mfma_f32_16x16x32_bf16 v[104:107], a[176:179], a[80:83], v[104:107]
    s_waitcnt lgkmcnt(8)
    ds_read_b64_tr_b16 a[216:217], v14 offset:16384
    v_cvt_pk_bf16_f32 v228, v100, v101
    v_mfma_f32_16x16x32_bf16 v[104:107], a[180:183], a[84:87], v[104:107]
    s_waitcnt lgkmcnt(7)
    ds_read_b64_tr_b16 a[218:219], v14 offset:20480
    v_cvt_pk_bf16_f32 v229, v102, v103
    v_mfma_f32_16x16x32_bf16 v[104:107], a[184:187], a[88:91], v[104:107]
    s_waitcnt lgkmcnt(6)
    ds_read_b64_tr_b16 a[220:221], v14 offset:24576
    v_mfma_f32_16x16x32_bf16 v[104:107], a[188:191], a[92:95], v[104:107]
    ds_read_b64_tr_b16 a[222:223], v14 offset:28672
    v_mfma_f32_16x16x32_bf16 v[108:111], a[188:191], a[124:127], v[108:111]
    ds_read_b64_tr_b16 a[224:225], v18 offset:0
    v_mfma_f32_16x16x32_bf16 v[108:111], a[184:187], a[120:123], v[108:111]
    ds_read_b64_tr_b16 a[226:227], v18 offset:4096
    v_mfma_f32_16x16x32_bf16 v[108:111], a[180:183], a[116:119], v[108:111]
    ds_read_b64_tr_b16 a[228:229], v18 offset:8192
    v_mfma_f32_16x16x32_bf16 v[108:111], a[176:179], a[112:115], v[108:111]
    ds_read_b64_tr_b16 a[230:231], v18 offset:12288
    v_mfma_f32_16x16x32_bf16 v[108:111], a[172:175], a[108:111], v[108:111]
    ds_read_b64_tr_b16 a[232:233], v18 offset:16384
    v_cvt_pk_bf16_f32 v226, v104, v105
    v_mfma_f32_16x16x32_bf16 v[108:111], a[168:171], a[104:107], v[108:111]
    s_add_u32 s38, s93, 1536
    ds_read_b64_tr_b16 a[234:235], v18 offset:20480
    v_cvt_pk_bf16_f32 v227, v106, v107
    v_mfma_f32_16x16x32_bf16 v[108:111], a[164:167], a[100:103], v[108:111]
    buffer_store_dwordx4 v[224:227], v56, s[28:31], s38 offen sc1
    v_mfma_f32_16x16x32_bf16 v[108:111], a[160:163], a[96:99], v[108:111]
    s_waitcnt lgkmcnt(12)
    ds_read_b64_tr_b16 a[236:237], v18 offset:24576
    ds_read_b64_tr_b16 a[238:239], v18 offset:28672
    v_mfma_f32_16x16x32_bf16 v[112:115], a[208:211], a[64:67], v[112:115]
    s_waitcnt lgkmcnt(12)
    ds_read_b64_tr_b16 a[160:161], v15 offset:0
    v_mfma_f32_16x16x32_bf16 v[112:115], a[212:215], a[68:71], v[112:115]
    s_waitcnt lgkmcnt(11)
    ds_read_b64_tr_b16 a[162:163], v15 offset:4096
    v_mfma_f32_16x16x32_bf16 v[112:115], a[216:219], a[72:75], v[112:115]
    s_waitcnt lgkmcnt(10)
    ds_read_b64_tr_b16 a[164:165], v15 offset:8192
    v_mfma_f32_16x16x32_bf16 v[112:115], a[220:223], a[76:79], v[112:115]
    s_waitcnt lgkmcnt(9)
    ds_read_b64_tr_b16 a[166:167], v15 offset:12288
    v_mfma_f32_16x16x32_bf16 v[112:115], a[224:227], a[80:83], v[112:115]
    s_waitcnt lgkmcnt(8)
    ds_read_b64_tr_b16 a[168:169], v15 offset:16384
    v_cvt_pk_bf16_f32 v230, v108, v109
    v_mfma_f32_16x16x32_bf16 v[112:115], a[228:231], a[84:87], v[112:115]
    s_waitcnt lgkmcnt(7)
    s_add_u32 s38, s93, 165376
    ds_read_b64_tr_b16 a[170:171], v15 offset:20480
    v_cvt_pk_bf16_f32 v231, v110, v111
    v_mfma_f32_16x16x32_bf16 v[112:115], a[232:235], a[88:91], v[112:115]
    s_waitcnt lgkmcnt(6)
    buffer_store_dwordx4 v[228:231], v56, s[28:31], s38 offen sc1
    v_mfma_f32_16x16x32_bf16 v[112:115], a[236:239], a[92:95], v[112:115]
    ds_read_b64_tr_b16 a[172:173], v15 offset:24576
    ds_read_b64_tr_b16 a[174:175], v15 offset:28672
    v_mfma_f32_16x16x32_bf16 v[116:119], a[236:239], a[124:127], v[116:119]
    ds_read_b64_tr_b16 a[176:177], v19 offset:0
    v_mfma_f32_16x16x32_bf16 v[116:119], a[232:235], a[120:123], v[116:119]
    ds_read_b64_tr_b16 a[178:179], v19 offset:4096
    v_mfma_f32_16x16x32_bf16 v[116:119], a[228:231], a[116:119], v[116:119]
    ds_read_b64_tr_b16 a[180:181], v19 offset:8192
    v_mfma_f32_16x16x32_bf16 v[116:119], a[224:227], a[112:115], v[116:119]
    ds_read_b64_tr_b16 a[182:183], v19 offset:12288
    v_mfma_f32_16x16x32_bf16 v[116:119], a[220:223], a[108:111], v[116:119]
    ds_read_b64_tr_b16 a[184:185], v19 offset:16384
    v_cvt_pk_bf16_f32 v232, v112, v113
    v_mfma_f32_16x16x32_bf16 v[116:119], a[216:219], a[104:107], v[116:119]
    ds_read_b64_tr_b16 a[186:187], v19 offset:20480
    v_cvt_pk_bf16_f32 v233, v114, v115
    v_mfma_f32_16x16x32_bf16 v[116:119], a[212:215], a[100:103], v[116:119]
    ds_read_b64_tr_b16 a[188:189], v19 offset:24576
    v_mfma_f32_16x16x32_bf16 v[116:119], a[208:211], a[96:99], v[116:119]
    s_waitcnt lgkmcnt(13)
    ds_read_b64_tr_b16 a[190:191], v19 offset:28672
    v_mfma_f32_16x16x32_bf16 v[120:123], a[160:163], a[64:67], v[120:123]
    s_waitcnt lgkmcnt(12)
    v_mfma_f32_16x16x32_bf16 v[120:123], a[164:167], a[68:71], v[120:123]
    s_waitcnt lgkmcnt(10)
    v_mfma_f32_16x16x32_bf16 v[120:123], a[168:171], a[72:75], v[120:123]
    s_waitcnt lgkmcnt(8)
    v_mfma_f32_16x16x32_bf16 v[120:123], a[172:175], a[76:79], v[120:123]
    s_waitcnt lgkmcnt(6)
    v_mfma_f32_16x16x32_bf16 v[120:123], a[176:179], a[80:83], v[120:123]
    s_waitcnt lgkmcnt(4)
    v_cvt_pk_bf16_f32 v236, v116, v117
    v_mfma_f32_16x16x32_bf16 v[120:123], a[180:183], a[84:87], v[120:123]
    s_waitcnt lgkmcnt(2)
    v_cvt_pk_bf16_f32 v237, v118, v119
    v_mfma_f32_16x16x32_bf16 v[120:123], a[184:187], a[88:91], v[120:123]
    s_waitcnt lgkmcnt(0)
    v_mfma_f32_16x16x32_bf16 v[120:123], a[188:191], a[92:95], v[120:123]
    v_mfma_f32_16x16x32_bf16 v[124:127], a[188:191], a[124:127], v[124:127]
    v_mfma_f32_16x16x32_bf16 v[124:127], a[184:187], a[120:123], v[124:127]
    v_mfma_f32_16x16x32_bf16 v[124:127], a[180:183], a[116:119], v[124:127]
    v_mfma_f32_16x16x32_bf16 v[124:127], a[176:179], a[112:115], v[124:127]
    v_mfma_f32_16x16x32_bf16 v[124:127], a[172:175], a[108:111], v[124:127]
    s_nop 2
    v_cvt_pk_bf16_f32 v234, v120, v121
    v_mfma_f32_16x16x32_bf16 v[124:127], a[168:171], a[104:107], v[124:127]
    s_add_u32 s38, s93, 1664
    v_cvt_pk_bf16_f32 v235, v122, v123
    v_mfma_f32_16x16x32_bf16 v[124:127], a[164:167], a[100:103], v[124:127]
    buffer_store_dwordx4 v[232:235], v56, s[28:31], s38 offen sc1
    v_mfma_f32_16x16x32_bf16 v[124:127], a[160:163], a[96:99], v[124:127]
    s_nop 7
    v_cvt_pk_bf16_f32 v238, v124, v125
    s_add_u32 s38, s93, 165504
    v_cvt_pk_bf16_f32 v239, v126, v127
    buffer_store_dwordx4 v[236:239], v56, s[28:31], s38 offen sc1
    s_add_u32 s92, s92, 16
    s_waitcnt vmcnt(35)
    v_lshlrev_b32 v96, 16, v160
    v_and_b32 v97, 0xffff0000, v160
    v_lshlrev_b32 v98, 16, v161
    v_and_b32 v99, 0xffff0000, v161
    v_lshlrev_b32 v100, 16, v162
    v_and_b32 v101, 0xffff0000, v162
    v_lshlrev_b32 v102, 16, v163
    v_and_b32 v103, 0xffff0000, v163
    s_waitcnt vmcnt(34)
    v_lshlrev_b32 v104, 16, v164
    v_and_b32 v105, 0xffff0000, v164
    v_lshlrev_b32 v106, 16, v165
    v_and_b32 v107, 0xffff0000, v165
    v_lshlrev_b32 v108, 16, v166
    v_and_b32 v109, 0xffff0000, v166
    v_lshlrev_b32 v110, 16, v167
    v_and_b32 v111, 0xffff0000, v167
    s_waitcnt vmcnt(32)
    v_lshlrev_b32 v112, 16, v168
    v_and_b32 v113, 0xffff0000, v168
    v_lshlrev_b32 v114, 16, v169
    v_and_b32 v115, 0xffff0000, v169
    v_lshlrev_b32 v116, 16, v170
    v_and_b32 v117, 0xffff0000, v170
    v_lshlrev_b32 v118, 16, v171
    v_and_b32 v119, 0xffff0000, v171
    s_waitcnt vmcnt(31)
    v_lshlrev_b32 v120, 16, v172
    v_and_b32 v121, 0xffff0000, v172
    v_lshlrev_b32 v122, 16, v173
    v_and_b32 v123, 0xffff0000, v173
    v_lshlrev_b32 v124, 16, v174
    v_and_b32 v125, 0xffff0000, v174
    v_lshlrev_b32 v126, 16, v175
    v_and_b32 v127, 0xffff0000, v175
    s_waitcnt vmcnt(30)
    v_lshlrev_b32 v128, 16, v208
    v_and_b32 v129, 0xffff0000, v208
    v_lshlrev_b32 v130, 16, v209
    v_and_b32 v131, 0xffff0000, v209
    v_lshlrev_b32 v132, 16, v210
    v_and_b32 v133, 0xffff0000, v210
    v_lshlrev_b32 v134, 16, v211
    v_and_b32 v135, 0xffff0000, v211
    s_waitcnt vmcnt(28)
    v_lshlrev_b32 v136, 16, v212
    v_and_b32 v137, 0xffff0000, v212
    v_lshlrev_b32 v138, 16, v213
    v_and_b32 v139, 0xffff0000, v213
    v_lshlrev_b32 v140, 16, v214
    v_and_b32 v141, 0xffff0000, v214
    v_lshlrev_b32 v142, 16, v215
    v_and_b32 v143, 0xffff0000, v215
    s_waitcnt vmcnt(19)
    v_lshlrev_b32 v144, 16, v64
    v_and_b32 v145, 0xffff0000, v64
    v_lshlrev_b32 v146, 16, v65
    v_and_b32 v147, 0xffff0000, v65
    v_lshlrev_b32 v148, 16, v66
    v_and_b32 v149, 0xffff0000, v66
    v_lshlrev_b32 v150, 16, v67
    v_and_b32 v151, 0xffff0000, v67
    s_waitcnt vmcnt(16)
    v_lshlrev_b32 v152, 16, v68
    v_and_b32 v153, 0xffff0000, v68
    v_lshlrev_b32 v154, 16, v69
    v_and_b32 v155, 0xffff0000, v69
    v_lshlrev_b32 v156, 16, v70
    v_and_b32 v157, 0xffff0000, v70
    v_lshlrev_b32 v158, 16, v71
    v_and_b32 v159, 0xffff0000, v71
    s_waitcnt vmcnt(14)
    v_lshlrev_b32 v160, 16, v72
    v_and_b32 v161, 0xffff0000, v72
    v_lshlrev_b32 v162, 16, v73
    v_and_b32 v163, 0xffff0000, v73
    v_lshlrev_b32 v164, 16, v74
    v_and_b32 v165, 0xffff0000, v74
    v_lshlrev_b32 v166, 16, v75
    v_and_b32 v167, 0xffff0000, v75
    s_waitcnt vmcnt(13)
    v_lshlrev_b32 v168, 16, v76
    v_and_b32 v169, 0xffff0000, v76
    v_lshlrev_b32 v170, 16, v77
    v_and_b32 v171, 0xffff0000, v77
    s_waitcnt vmcnt(12)
    v_lshlrev_b32 v172, 16, v78
    v_and_b32 v173, 0xffff0000, v78
    v_lshlrev_b32 v174, 16, v79
    v_and_b32 v175, 0xffff0000, v79
    s_waitcnt vmcnt(11)
    v_lshlrev_b32 v176, 16, v80
    v_and_b32 v177, 0xffff0000, v80
    v_lshlrev_b32 v178, 16, v81
    v_and_b32 v179, 0xffff0000, v81
    s_waitcnt vmcnt(9)
    v_lshlrev_b32 v180, 16, v82
    v_and_b32 v181, 0xffff0000, v82
    v_lshlrev_b32 v182, 16, v83
    v_and_b32 v183, 0xffff0000, v83
    s_waitcnt vmcnt(8)
    v_lshlrev_b32 v184, 16, v84
    v_and_b32 v185, 0xffff0000, v84
    v_lshlrev_b32 v186, 16, v85
    v_and_b32 v187, 0xffff0000, v85
    s_waitcnt vmcnt(7)
    v_lshlrev_b32 v188, 16, v86
    v_and_b32 v189, 0xffff0000, v86
    v_lshlrev_b32 v190, 16, v87
    v_and_b32 v191, 0xffff0000, v87
    s_waitcnt vmcnt(0)
    buffer_store_dword v10, v8, s[24:27], s92 offen sc1
    v_cmp_ne_u32 s[54:55], s95, v11
    s_cmp_lg_u64 s[54:55], 0
    s_cbranch_scc1 Ltail_spin1
Ltail_got1:
    s_add_u32 s56, s44, 16384
    buffer_load_dwordx4 a[0:3], v54, s[28:31], s56 offen offset:0 sc1
    buffer_load_dwordx4 a[4:7], v54, s[28:31], s56 offen offset:1024 sc1
    buffer_load_dwordx4 a[8:11], v54, s[28:31], s56 offen offset:2048 sc1
    buffer_load_dwordx4 a[12:15], v54, s[28:31], s56 offen offset:3072 sc1
    s_add_u32 s56, s44, 0
    buffer_load_dwordx4 a[16:19], v2, s[28:31], s56 offen offset:0 sc1
    s_add_u32 s56, s44, 4096
    buffer_load_dwordx4 a[20:23], v2, s[28:31], s56 offen offset:0 sc1
    s_add_u32 s56, s44, 8192
    buffer_load_dwordx4 a[24:27], v2, s[28:31], s56 offen offset:0 sc1
    s_add_u32 s56, s44, 12288
    buffer_load_dwordx4 a[28:31], v2, s[28:31], s56 offen offset:0 sc1
    ds_write_b128 v51, a[128:131] offset:0
    ds_write_b128 v51, a[132:135] offset:4096
    ds_write_b128 v51, a[136:139] offset:8192
    ds_write_b128 v51, a[140:143] offset:12288
    ds_write_b128 v51, a[144:147] offset:16384
    ds_write_b128 v51, a[148:151] offset:20480
    ds_write_b128 v51, a[152:155] offset:24576
    ds_write_b128 v51, a[156:159] offset:28672
    ds_write_b128 v51, a[240:243] offset:32768
    ds_write_b128 v255, a[244:247] offset:40960
    ds_write_b128 v255, a[248:251] offset:45056
    ds_write_b128 v255, a[252:255] offset:61440
    v_lshlrev_b32 v12, 16, v36
    v_and_b32 v13, 0xffff0000, v36
    v_lshlrev_b32 v14, 16, v37
    v_and_b32 v15, 0xffff0000, v37
    v_lshlrev_b32 v16, 16, v38
    v_and_b32 v17, 0xffff0000, v38
    v_lshlrev_b32 v18, 16, v39
    v_and_b32 v19, 0xffff0000, v39
    v_lshlrev_b32 v20, 16, v40
    v_and_b32 v21, 0xffff0000, v40
    v_lshlrev_b32 v22, 16, v41
    v_and_b32 v23, 0xffff0000, v41
    v_lshlrev_b32 v24, 16, v42
    v_and_b32 v25, 0xffff0000, v42
    v_lshlrev_b32 v26, 16, v43
    v_and_b32 v27, 0xffff0000, v43
    v_lshlrev_b32 v28, 16, v92
    v_and_b32 v29, 0xffff0000, v92
    v_lshlrev_b32 v30, 16, v93
    v_and_b32 v31, 0xffff0000, v93
    v_lshlrev_b32 v32, 16, v94
    v_and_b32 v33, 0xffff0000, v94
    v_lshlrev_b32 v34, 16, v95
    v_and_b32 v35, 0xffff0000, v95
    v_lshlrev_b32 v192, 16, v216
    v_and_b32 v193, 0xffff0000, v216
    v_lshlrev_b32 v194, 16, v217
    v_and_b32 v195, 0xffff0000, v217
    v_lshlrev_b32 v196, 16, v218
    v_and_b32 v197, 0xffff0000, v218
    v_lshlrev_b32 v198, 16, v219
    v_and_b32 v199, 0xffff0000, v219
    v_lshlrev_b32 v200, 16, v220
    v_and_b32 v201, 0xffff0000, v220
    v_lshlrev_b32 v202, 16, v221
    v_and_b32 v203, 0xffff0000, v221
    v_lshlrev_b32 v204, 16, v222
    v_and_b32 v205, 0xffff0000, v222
    v_lshlrev_b32 v206, 16, v223
    v_and_b32 v207, 0xffff0000, v223
    v_lshlrev_b32 v208, 16, v88
    v_and_b32 v209, 0xffff0000, v88
    v_lshlrev_b32 v210, 16, v89
    v_and_b32 v211, 0xffff0000, v89
    v_lshlrev_b32 v212, 16, v90
    v_and_b32 v213, 0xffff0000, v90
    v_lshlrev_b32 v214, 16, v91
    v_and_b32 v215, 0xffff0000, v91
    s_add_u32 s39, s39, 16
    buffer_load_dword v11, v9, s[24:27], s39 offen sc1
    s_add_u32 s56, s44, 0
    buffer_load_dwordx4 a[32:35], v2, s[28:31], s56 offen offset:512 sc1
    s_add_u32 s56, s44, 4096
    buffer_load_dwordx4 a[36:39], v2, s[28:31], s56 offen offset:512 sc1
    s_add_u32 s56, s44, 8192
    buffer_load_dwordx4 a[40:43], v2, s[28:31], s56 offen offset:512 sc1
    s_add_u32 s56, s44, 12288
    buffer_load_dwordx4 a[44:47], v2, s[28:31], s56 offen offset:512 sc1
    v_lshrrev_b32 v56, 2, v1
    v_and_b32 v57, 3, v1
    v_lshlrev_b32 v57, 3, v57
    s_and_b32 s36, s3, 1
    s_lshl_b32 s36, s36, 5
    v_lshl_add_u32 v61, v56, 6, v57
    v_add_u32 v61, s36, v61
    s_mov_b32 s36, 135168
    s_mov_b32 s37, 12288
    s_cmp_lt_u32 s3, 2
    s_cselect_b32 s36, 98304, s36
    s_cselect_b32 s37, 98304, s37
    v_add_u32 v94, s37, v61
    v_add_u32 v61, s36, v61
    v_mul_u32_u24 v95, 1152, v56
    s_lshl_b32 s36, s3, 7
    s_add_u32 s36, s36, 61440
    v_add3_u32 v95, v95, v57, s36
    s_waitcnt lgkmcnt(0)
    s_barrier
    ds_read_b64_tr_b16 a[96:97], v61 offset:0
    ds_read_b64_tr_b16 a[98:99], v61 offset:1024
    ds_read_b64_tr_b16 a[100:101], v61 offset:2048
    ds_read_b64_tr_b16 a[102:103], v61 offset:3072
    ds_read_b64_tr_b16 a[104:105], v61 offset:4096
    ds_read_b64_tr_b16 a[106:107], v61 offset:5120
    ds_read_b64_tr_b16 a[108:109], v61 offset:6144
    ds_read_b64_tr_b16 a[110:111], v61 offset:7168
    ds_read_b64_tr_b16 a[112:113], v61 offset:8192
    ds_read_b64_tr_b16 a[114:115], v61 offset:9216
    ds_read_b64_tr_b16 a[116:117], v61 offset:10240
    ds_read_b64_tr_b16 a[118:119], v61 offset:11264
    ds_read_b64_tr_b16 a[120:121], v61 offset:12288
    ds_read_b64_tr_b16 a[122:123], v61 offset:13312
    ds_read_b64_tr_b16 a[124:125], v61 offset:14336
    ds_read_b64_tr_b16 a[126:127], v61 offset:15360
    ds_read_b64_tr_b16 a[128:129], v61 offset:16384
    ds_read_b64_tr_b16 a[130:131], v61 offset:17408
    ds_read_b64_tr_b16 a[132:133], v61 offset:18432
    ds_read_b64_tr_b16 a[134:135], v61 offset:19456
    ds_read_b64_tr_b16 a[136:137], v61 offset:20480
    ds_read_b64_tr_b16 a[138:139], v61 offset:21504
    ds_read_b64_tr_b16 a[140:141], v61 offset:22528
    ds_read_b64_tr_b16 a[142:143], v61 offset:23552
    ds_read_b64_tr_b16 a[144:145], v61 offset:24576
    ds_read_b64_tr_b16 a[146:147], v61 offset:25600
    ds_read_b64_tr_b16 a[148:149], v61 offset:26624
    ds_read_b64_tr_b16 a[150:151], v61 offset:27648
    ds_read_b64_tr_b16 a[152:153], v94 offset:28672
    ds_read_b64_tr_b16 a[154:155], v94 offset:29696
    ds_read_b64_tr_b16 a[156:157], v94 offset:30720
    ds_read_b64_tr_b16 a[158:159], v94 offset:31744
    ds_read_b64_tr_b16 a[160:161], v94 offset:32768
    ds_read_b64_tr_b16 a[162:163], v94 offset:33792
    ds_read_b64_tr_b16 a[164:165], v94 offset:34816
    ds_read_b64_tr_b16 a[166:167], v94 offset:35840
    ds_read_b64_tr_b16 a[168:169], v95 offset:0
    ds_read_b64_tr_b16 a[170:171], v95 offset:18432
    ds_read_b64_tr_b16 a[172:173], v95 offset:32
    ds_read_b64_tr_b16 a[174:175], v95 offset:18464
    ds_read_b64_tr_b16 a[176:177], v95 offset:64
    ds_read_b64_tr_b16 a[178:179], v95 offset:18496
    ds_read_b64_tr_b16 a[180:181], v95 offset:96
    ds_read_b64_tr_b16 a[182:183], v95 offset:18528
    ds_read_b64_tr_b16 a[184:185], v95 offset:512
    ds_read_b64_tr_b16 a[186:187], v95 offset:18944
    ds_read_b64_tr_b16 a[188:189], v95 offset:544
    ds_read_b64_tr_b16 a[190:191], v95 offset:18976
    ds_read_b64_tr_b16 a[192:193], v95 offset:576
    ds_read_b64_tr_b16 a[194:195], v95 offset:19008
    ds_read_b64_tr_b16 a[196:197], v95 offset:608
    ds_read_b64_tr_b16 a[198:199], v95 offset:19040
    ds_read_b64_tr_b16 a[200:201], v95 offset:1024
    ds_read_b64_tr_b16 a[202:203], v95 offset:19456
    ds_read_b64_tr_b16 a[204:205], v95 offset:1056
    ds_read_b64_tr_b16 a[206:207], v95 offset:19488
    ds_read_b64_tr_b16 a[208:209], v95 offset:1088
    ds_read_b64_tr_b16 a[210:211], v95 offset:19520
    ds_read_b64_tr_b16 a[212:213], v95 offset:1120
    ds_read_b64_tr_b16 a[214:215], v95 offset:19552
    v_pk_mul_f32 v[62:63], v[144:145], v[168:169]
    v_pk_mul_f32 v[168:169], v[168:169], v[120:121]
    v_pk_fma_f32 v[62:63], v[146:147], v[170:171], v[62:63]
    v_pk_mul_f32 v[170:171], v[170:171], v[122:123]
    v_pk_add_f32 v[88:89], v[168:169], v[170:171]
    v_pk_fma_f32 v[62:63], v[148:149], v[172:173], v[62:63]
    v_pk_mul_f32 v[172:173], v[172:173], v[124:125]
    v_pk_add_f32 v[88:89], v[88:89], v[172:173]
    v_pk_fma_f32 v[62:63], v[150:151], v[174:175], v[62:63]
    v_pk_mul_f32 v[174:175], v[174:175], v[126:127]
    v_pk_add_f32 v[88:89], v[88:89], v[174:175]
    v_pk_fma_f32 v[62:63], v[152:153], v[176:177], v[62:63]
    v_pk_mul_f32 v[176:177], v[176:177], v[128:129]
    v_pk_add_f32 v[88:89], v[88:89], v[176:177]
    v_pk_fma_f32 v[62:63], v[154:155], v[178:179], v[62:63]
    v_pk_mul_f32 v[178:179], v[178:179], v[130:131]
    v_pk_add_f32 v[88:89], v[88:89], v[178:179]
    v_pk_fma_f32 v[62:63], v[156:157], v[180:181], v[62:63]
    v_pk_mul_f32 v[180:181], v[180:181], v[132:133]
    v_pk_add_f32 v[88:89], v[88:89], v[180:181]
    v_pk_fma_f32 v[62:63], v[158:159], v[182:183], v[62:63]
    v_pk_mul_f32 v[182:183], v[182:183], v[134:135]
    v_pk_add_f32 v[88:89], v[88:89], v[182:183]
    v_pk_fma_f32 v[62:63], v[160:161], v[184:185], v[62:63]
    v_pk_mul_f32 v[184:185], v[184:185], v[136:137]
    v_pk_add_f32 v[88:89], v[88:89], v[184:185]
    v_pk_fma_f32 v[62:63], v[162:163], v[186:187], v[62:63]
    v_pk_mul_f32 v[186:187], v[186:187], v[138:139]
    v_pk_add_f32 v[88:89], v[88:89], v[186:187]
    v_pk_fma_f32 v[62:63], v[164:165], v[188:189], v[62:63]
    v_pk_mul_f32 v[188:189], v[188:189], v[140:141]
    v_pk_add_f32 v[88:89], v[88:89], v[188:189]
    v_pk_fma_f32 v[62:63], v[166:167], v[190:191], v[62:63]
    v_pk_mul_f32 v[190:191], v[190:191], v[142:143]
    v_pk_add_f32 v[88:89], v[88:89], v[190:191]
    v_add_f32 v91, v62, v63
    v_add_f32 v90, v88, v89
    s_nop 1
    v_add_f32_dpp v90, v90, v90 row_ror:8 row_mask:0xf bank_mask:0xf
    v_add_f32_dpp v91, v91, v91 row_ror:8 row_mask:0xf bank_mask:0xf
    s_nop 0
    v_add_f32_dpp v90, v90, v90 row_ror:4 row_mask:0xf bank_mask:0xf
    v_add_f32_dpp v91, v91, v91 row_ror:4 row_mask:0xf bank_mask:0xf
    s_nop 0
    v_add_f32_dpp v90, v90, v90 row_ror:2 row_mask:0xf bank_mask:0xf
    v_add_f32_dpp v91, v91, v91 row_ror:2 row_mask:0xf bank_mask:0xf
    s_nop 0
    v_add_f32_dpp v90, v90, v90 row_ror:1 row_mask:0xf bank_mask:0xf
    v_add_f32_dpp v91, v91, v91 row_ror:1 row_mask:0xf bank_mask:0xf
    v_mov_b32 v62, v90
    v_mov_b32 v63, v91
    s_nop 0
    v_permlane16_swap_b32 v90, v62
    v_permlane16_swap_b32 v91, v63
    v_add_f32 v90, v90, v62
    v_add_f32 v91, v91, v63
    v_lshlrev_b32 v92, 2, v7
    v_and_b32 v92, 28, v92
    v_sub_u32 v93, 2047, v7
    s_waitcnt vmcnt(12)
    v_mfma_f32_16x16x32_bf16 v[80:83], v[242:245], a[0:3], 0
    v_mfma_f32_16x16x32_bf16 v[84:87], v[240:243], a[0:3], 0
    s_waitcnt vmcnt(11)
    v_mfma_f32_16x16x32_bf16 v[80:83], v[242:245], a[4:7], v[80:83]
    v_mfma_f32_16x16x32_bf16 v[84:87], v[240:243], a[4:7], v[84:87]
    s_waitcnt vmcnt(10)
    v_mfma_f32_16x16x32_bf16 v[80:83], v[242:245], a[8:11], v[80:83]
    v_mfma_f32_16x16x32_bf16 v[84:87], v[240:243], a[8:11], v[84:87]
    s_waitcnt vmcnt(9)
    v_mfma_f32_16x16x32_bf16 v[80:83], v[242:245], a[12:15], v[80:83]
    v_mfma_f32_16x16x32_bf16 v[84:87], v[240:243], a[12:15], v[84:87]
    s_waitcnt vmcnt(8)
    s_nop 5
    v_mov_b32_dpp v80, v80 row_ror:8 row_mask:0x4 bank_mask:0xf
    v_mov_b32_dpp v81, v81 row_ror:8 row_mask:0x4 bank_mask:0xf
    v_mov_b32_dpp v82, v82 row_ror:8 row_mask:0x4 bank_mask:0xf
    v_mov_b32_dpp v83, v83 row_ror:8 row_mask:0x4 bank_mask:0xf
    v_mov_b32_dpp v84, v84 row_ror:8 row_mask:0x4 bank_mask:0xf
    v_mov_b32_dpp v85, v85 row_ror:8 row_mask:0x4 bank_mask:0xf
    v_mov_b32_dpp v86, v86 row_ror:8 row_mask:0x4 bank_mask:0xf
    v_mov_b32_dpp v87, v87 row_ror:8 row_mask:0x4 bank_mask:0xf
    v_pk_fma_f32 v[28:29], v[112:113], v[80:81], v[28:29]
    v_pk_fma_f32 v[30:31], v[114:115], v[82:83], v[30:31]
    v_pk_fma_f32 v[32:33], v[116:117], v[84:85], v[32:33]
    v_pk_fma_f32 v[34:35], v[118:119], v[86:87], v[34:35]
    v_cvt_pk_bf16_f32 v44, v28, v29
    v_cvt_pk_bf16_f32 v45, v30, v31
    v_cvt_pk_bf16_f32 v46, v32, v33
    v_cvt_pk_bf16_f32 v47, v34, v35
    v_lshlrev_b32 v28, 16, v44
    v_and_b32 v29, 0xffff0000, v44
    v_lshlrev_b32 v30, 16, v45
    v_and_b32 v31, 0xffff0000, v45
    v_lshlrev_b32 v32, 16, v46
    v_and_b32 v33, 0xffff0000, v46
    v_lshlrev_b32 v34, 16, v47
    v_and_b32 v35, 0xffff0000, v47
    v_mfma_f32_16x16x32_bf16 v[64:67], v[246:249], a[16:19], 0
    v_mfma_f32_16x16x32_bf16 v[68:71], v[244:247], a[16:19], 0
    s_waitcnt vmcnt(7)
    v_mfma_f32_16x16x32_bf16 v[64:67], v[246:249], a[20:23], v[64:67]
    v_mfma_f32_16x16x32_bf16 v[68:71], v[244:247], a[20:23], v[68:71]
    s_waitcnt vmcnt(6)
    v_mfma_f32_16x16x32_bf16 v[64:67], v[246:249], a[24:27], v[64:67]
    v_mfma_f32_16x16x32_bf16 v[68:71], v[244:247], a[24:27], v[68:71]
    s_waitcnt vmcnt(5)
    v_mfma_f32_16x16x32_bf16 v[64:67], v[246:249], a[28:31], v[64:67]
    v_mfma_f32_16x16x32_bf16 v[68:71], v[244:247], a[28:31], v[68:71]
    s_waitcnt vmcnt(4)
    v_cmp_ne_u32 s[54:55], s95, v11
    s_cmp_lg_u64 s[54:55], 0
    s_cbranch_scc1 Ltail_spin2
Ltail_got2:
    s_add_u32 s56, s44, 0
    buffer_load_dwordx4 a[48:51], v2, s[28:31], s56 offen offset:1024 sc1
    s_add_u32 s56, s44, 4096
    buffer_load_dwordx4 a[52:55], v2, s[28:31], s56 offen offset:1024 sc1
    s_add_u32 s56, s44, 8192
    buffer_load_dwordx4 a[56:59], v2, s[28:31], s56 offen offset:1024 sc1
    s_add_u32 s56, s44, 12288
    buffer_load_dwordx4 a[60:63], v2, s[28:31], s56 offen offset:1024 sc1
    s_add_u32 s56, s44, 0
    buffer_load_dwordx4 a[64:67], v2, s[28:31], s56 offen offset:1536 sc1
    s_add_u32 s56, s44, 4096
    buffer_load_dwordx4 a[68:71], v2, s[28:31], s56 offen offset:1536 sc1
    s_add_u32 s56, s44, 8192
    buffer_load_dwordx4 a[72:75], v2, s[28:31], s56 offen offset:1536 sc1
    s_add_u32 s56, s44, 12288
    buffer_load_dwordx4 a[76:79], v2, s[28:31], s56 offen offset:1536 sc1
    s_movk_i32 s48, 0x7ff
    s_waitcnt vmcnt(11)
    v_mfma_f32_16x16x32_bf16 v[64:67], v[250:253], a[32:35], v[64:67]
    v_mfma_f32_16x16x32_bf16 v[68:71], v[248:251], a[32:35], v[68:71]
    s_waitcnt vmcnt(10)
    v_mfma_f32_16x16x32_bf16 v[64:67], v[250:253], a[36:39], v[64:67]
    v_mfma_f32_16x16x32_bf16 v[68:71], v[248:251], a[36:39], v[68:71]
    s_waitcnt vmcnt(9)
    v_mfma_f32_16x16x32_bf16 v[64:67], v[250:253], a[40:43], v[64:67]
    v_mfma_f32_16x16x32_bf16 v[68:71], v[248:251], a[40:43], v[68:71]
    s_waitcnt vmcnt(8)
    v_mfma_f32_16x16x32_bf16 v[64:67], v[250:253], a[44:47], v[64:67]
    v_mfma_f32_16x16x32_bf16 v[68:71], v[248:251], a[44:47], v[68:71]
    s_waitcnt vmcnt(7)
    s_nop 5
    v_pk_fma_f32 v[12:13], v[96:97], v[64:65], v[12:13]
    v_pk_fma_f32 v[14:15], v[98:99], v[66:67], v[14:15]
    v_pk_fma_f32 v[16:17], v[100:101], v[68:69], v[16:17]
    v_pk_fma_f32 v[18:19], v[102:103], v[70:71], v[18:19]
    v_cvt_pk_bf16_f32 v36, v12, v13
    v_cvt_pk_bf16_f32 v37, v14, v15
    v_cvt_pk_bf16_f32 v38, v16, v17
    v_cvt_pk_bf16_f32 v39, v18, v19
    v_lshlrev_b32 v12, 16, v36
    v_and_b32 v13, 0xffff0000, v36
    v_lshlrev_b32 v14, 16, v37
    v_and_b32 v15, 0xffff0000, v37
    v_lshlrev_b32 v16, 16, v38
    v_and_b32 v17, 0xffff0000, v38
    v_lshlrev_b32 v18, 16, v39
    v_and_b32 v19, 0xffff0000, v39
    v_pk_add_f32 v[88:89], v[12:13], v[14:15]
    v_pk_add_f32 v[62:63], v[16:17], v[18:19]
    v_pk_add_f32 v[88:89], v[88:89], v[62:63]
    v_add_f32 v88, v88, v89
Ltour12:
    s_cbranch_execz Ltour16
    s_nop 1
    v_add_f32_dpp v88, v88, v88 row_ror:8 row_mask:0xf bank_mask:0xf
    s_nop 1
    v_add_f32_dpp v88, v88, v88 row_ror:4 row_mask:0xf bank_mask:0xf
    s_nop 1
    v_add_f32_dpp v88, v88, v88 row_ror:2 row_mask:0xf bank_mask:0xf
    s_nop 1
    v_add_f32_dpp v88, v88, v88 row_ror:1 row_mask:0xf bank_mask:0xf
    v_mov_b32 v62, v88
    s_nop 1
    v_permlane16_swap_b32 v88, v62
    s_nop 0
    v_add_f32 v88, v88, v62
    v_mul_f32 v88, 0x3b800000, v88
    v_pk_add_f32 v[232:233], v[28:29], v[88:89] op_sel_hi:[1,0] neg_lo:[0,1] neg_hi:[0,1]
    v_pk_add_f32 v[234:235], v[30:31], v[88:89] op_sel_hi:[1,0] neg_lo:[0,1] neg_hi:[0,1]
    v_pk_add_f32 v[236:237], v[32:33], v[88:89] op_sel_hi:[1,0] neg_lo:[0,1] neg_hi:[0,1]
    v_pk_add_f32 v[238:239], v[34:35], v[88:89] op_sel_hi:[1,0] neg_lo:[0,1] neg_hi:[0,1]
    v_pk_add_f32 v[48:49], v[232:233], v[234:235]
    v_pk_mul_f32 v[50:51], v[232:233], v[232:233]
    v_pk_mul_f32 v[52:53], v[232:233], v[184:185]
    v_pk_fma_f32 v[50:51], v[234:235], v[234:235], v[50:51]
    v_pk_fma_f32 v[52:53], v[234:235], v[186:187], v[52:53]
    v_pk_add_f32 v[48:49], v[48:49], v[236:237]
    v_pk_fma_f32 v[50:51], v[236:237], v[236:237], v[50:51]
    v_pk_fma_f32 v[52:53], v[236:237], v[188:189], v[52:53]
    v_pk_add_f32 v[48:49], v[48:49], v[238:239]
    v_pk_fma_f32 v[50:51], v[238:239], v[238:239], v[50:51]
    v_pk_fma_f32 v[52:53], v[238:239], v[190:191], v[52:53]
    v_cndmask_b32 v48, 0, v48, vcc
    v_cndmask_b32 v49, 0, v49, vcc
    v_cndmask_b32 v50, 0, v50, vcc
    v_cndmask_b32 v51, 0, v51, vcc
    v_pk_add_f32 v[216:217], v[12:13], v[88:89] op_sel_hi:[1,0] neg_lo:[0,1] neg_hi:[0,1]
    v_pk_add_f32 v[218:219], v[14:15], v[88:89] op_sel_hi:[1,0] neg_lo:[0,1] neg_hi:[0,1]
    v_pk_add_f32 v[220:221], v[16:17], v[88:89] op_sel_hi:[1,0] neg_lo:[0,1] neg_hi:[0,1]
    v_pk_add_f32 v[222:223], v[18:19], v[88:89] op_sel_hi:[1,0] neg_lo:[0,1] neg_hi:[0,1]
    v_pk_add_f32 v[48:49], v[48:49], v[216:217]
    v_pk_fma_f32 v[50:51], v[216:217], v[216:217], v[50:51]
    v_pk_fma_f32 v[52:53], v[216:217], v[168:169], v[52:53]
    v_pk_add_f32 v[48:49], v[48:49], v[218:219]
    v_pk_fma_f32 v[50:51], v[218:219], v[218:219], v[50:51]
    v_pk_fma_f32 v[52:53], v[218:219], v[170:171], v[52:53]
    v_pk_add_f32 v[48:49], v[48:49], v[220:221]
    v_pk_fma_f32 v[50:51], v[220:221], v[220:221], v[50:51]
    v_pk_fma_f32 v[52:53], v[220:221], v[172:173], v[52:53]
    v_pk_add_f32 v[48:49], v[48:49], v[222:223]
    v_pk_fma_f32 v[50:51], v[222:223], v[222:223], v[50:51]
    v_pk_fma_f32 v[52:53], v[222:223], v[174:175], v[52:53]
    v_mfma_f32_16x16x32_bf16 v[72:75], v[246:249], a[48:51], 0
    v_mfma_f32_16x16x32_bf16 v[76:79], v[244:247], a[48:51], 0
    s_waitcnt vmcnt(6)
    v_mfma_f32_16x16x32_bf16 v[72:75], v[246:249], a[52:55], v[72:75]
    v_mfma_f32_16x16x32_bf16 v[76:79], v[244:247], a[52:55], v[76:79]
    s_waitcnt vmcnt(5)
    v_mfma_f32_16x16x32_bf16 v[72:75], v[246:249], a[56:59], v[72:75]
    v_mfma_f32_16x16x32_bf16 v[76:79], v[244:247], a[56:59], v[76:79]
    s_waitcnt vmcnt(4)
    v_mfma_f32_16x16x32_bf16 v[72:75], v[246:249], a[60:63], v[72:75]
    v_mfma_f32_16x16x32_bf16 v[76:79], v[244:247], a[60:63], v[76:79]
    s_waitcnt vmcnt(3)
    v_mfma_f32_16x16x32_bf16 v[72:75], v[250:253], a[64:67], v[72:75]
    v_mfma_f32_16x16x32_bf16 v[76:79], v[248:251], a[64:67], v[76:79]
    s_waitcnt vmcnt(2)
    v_mfma_f32_16x16x32_bf16 v[72:75], v[250:253], a[68:71], v[72:75]
    v_mfma_f32_16x16x32_bf16 v[76:79], v[248:251], a[68:71], v[76:79]
    s_waitcnt vmcnt(1)
    v_mfma_f32_16x16x32_bf16 v[72:75], v[250:253], a[72:75], v[72:75]
    v_mfma_f32_16x16x32_bf16 v[76:79], v[248:251], a[72:75], v[76:79]
    s_waitcnt vmcnt(0)
    v_mfma_f32_16x16x32_bf16 v[72:75], v[250:253], a[76:79], v[72:75]
    v_mfma_f32_16x16x32_bf16 v[76:79], v[248:251], a[76:79], v[76:79]
    s_nop 6
    v_pk_fma_f32 v[20:21], v[104:105], v[72:73], v[20:21]
    v_pk_fma_f32 v[22:23], v[106:107], v[74:75], v[22:23]
    v_pk_fma_f32 v[24:25], v[108:109], v[76:77], v[24:25]
    v_pk_fma_f32 v[26:27], v[110:111], v[78:79], v[26:27]
    v_cvt_pk_bf16_f32 v40, v20, v21
    v_cvt_pk_bf16_f32 v41, v22, v23
    v_cvt_pk_bf16_f32 v42, v24, v25
    v_cvt_pk_bf16_f32 v43, v26, v27
    v_lshlrev_b32 v20, 16, v40
    v_and_b32 v21, 0xffff0000, v40
    v_lshlrev_b32 v22, 16, v41
    v_and_b32 v23, 0xffff0000, v41
    v_lshlrev_b32 v24, 16, v42
    v_and_b32 v25, 0xffff0000, v42
    v_lshlrev_b32 v26, 16, v43
    v_and_b32 v27, 0xffff0000, v43
    v_pk_add_f32 v[224:225], v[20:21], v[88:89] op_sel_hi:[1,0] neg_lo:[0,1] neg_hi:[0,1]
    v_pk_add_f32 v[226:227], v[22:23], v[88:89] op_sel_hi:[1,0] neg_lo:[0,1] neg_hi:[0,1]
    v_pk_add_f32 v[228:229], v[24:25], v[88:89] op_sel_hi:[1,0] neg_lo:[0,1] neg_hi:[0,1]
    v_pk_add_f32 v[230:231], v[26:27], v[88:89] op_sel_hi:[1,0] neg_lo:[0,1] neg_hi:[0,1]
    v_pk_add_f32 v[48:49], v[48:49], v[224:225]
    v_pk_fma_f32 v[50:51], v[224:225], v[224:225], v[50:51]
    v_pk_fma_f32 v[52:53], v[224:225], v[176:177], v[52:53]
    v_pk_add_f32 v[48:49], v[48:49], v[226:227]
    v_pk_fma_f32 v[50:51], v[226:227], v[226:227], v[50:51]
    v_pk_fma_f32 v[52:53], v[226:227], v[178:179], v[52:53]
    v_pk_add_f32 v[48:49], v[48:49], v[228:229]
    v_pk_fma_f32 v[50:51], v[228:229], v[228:229], v[50:51]
    v_pk_fma_f32 v[52:53], v[228:229], v[180:181], v[52:53]
    v_pk_add_f32 v[48:49], v[48:49], v[230:231]
    v_pk_fma_f32 v[50:51], v[230:231], v[230:231], v[50:51]
    v_pk_fma_f32 v[52:53], v[230:231], v[182:183], v[52:53]
    v_add_f32 v48, v48, v49
    v_add_f32 v50, v50, v51
    v_add_f32 v52, v52, v53
    v_add_f32_dpp v48, v48, v48 row_ror:8 row_mask:0xf bank_mask:0xf
    v_add_f32_dpp v50, v50, v50 row_ror:8 row_mask:0xf bank_mask:0xf
    v_add_f32_dpp v52, v52, v52 row_ror:8 row_mask:0xf bank_mask:0xf
    v_add_f32_dpp v48, v48, v48 row_ror:4 row_mask:0xf bank_mask:0xf
    v_add_f32_dpp v50, v50, v50 row_ror:4 row_mask:0xf bank_mask:0xf
    v_add_f32_dpp v52, v52, v52 row_ror:4 row_mask:0xf bank_mask:0xf
    v_add_f32_dpp v48, v48, v48 row_ror:2 row_mask:0xf bank_mask:0xf
    v_add_f32_dpp v50, v50, v50 row_ror:2 row_mask:0xf bank_mask:0xf
    v_add_f32_dpp v52, v52, v52 row_ror:2 row_mask:0xf bank_mask:0xf
    v_add_f32_dpp v48, v48, v48 row_ror:1 row_mask:0xf bank_mask:0xf
    v_add_f32_dpp v50, v50, v50 row_ror:1 row_mask:0xf bank_mask:0xf
    v_add_f32_dpp v52, v52, v52 row_ror:1 row_mask:0xf bank_mask:0xf
    v_mov_b32 v49, v48
    v_mov_b32 v51, v50
    v_mov_b32 v53, v52
    v_permlane16_swap_b32 v48, v49
    v_permlane16_swap_b32 v50, v51
    v_permlane16_swap_b32 v52, v53
    v_add_f32 v48, v48, v49
    v_add_f32 v50, v50, v51
    v_add_f32 v52, v52, v53
    v_mul_f32 v48, 0x3ae38e39, v48
    v_mul_f32 v50, 0x3ae38e39, v50
    v_fma_f32 v50, -v48, v48, v50
    v_add_f32 v48, v48, v88
    v_max_f32 v50, 0, v50
    v_cvt_pk_bf16_f32 v48, v48, v50
    v_and_b32 v50, 0xffff0000, v48
    v_lshlrev_b32 v48, 16, v48
    v_add_f32 v50, 0x3727c5ac, v50
    v_sub_f32 v48, v88, v48
    v_cvt_pk_bf16_f32 v50, v50, v50
    v_and_b32 v50, 0xffff0000, v50
    v_sqrt_f32 v50, v50
    v_fmac_f32 v52, v48, v90
    v_cvt_pk_bf16_f32 v50, v50, v50
    v_and_b32 v50, 0xffff0000, v50
    v_rcp_f32 v50, v50
    s_mov_b32 exec_lo, 1
    s_mov_b32 exec_hi, 1
    v_fma_f32 v52, v52, v50, v91
    v_ashrrev_i32 v62, 31, v52
    v_or_b32 v62, 0x80000000, v62
    v_xor_b32 v52, v62, v52
    v_min_u32 v52, 0xfffff000, v52
    v_bfi_b32 v52, s48, v93, v52
    ds_write_b32 v92, v52 offset:36864
    s_mov_b64 exec, -1
    v_mul_f32 v48, v48, v50
    s_waitcnt lgkmcnt(0)
    s_barrier
    v_mov_b32 v109, 36864
    ds_read_b128 v[96:99], v109
    ds_read_b128 v[100:103], v109 offset:16
    s_lshl_b32 s45, s2, 7
    s_add_u32 s45, s45, 9306112
    s_cmp_eq_u32 s3, 0
    s_cselect_b32 s45, s45, 2147483648
    s_waitcnt lgkmcnt(1)
    v_max_u32 v104, v96, v97
    v_min_u32 v105, v96, v97
    v_med3_u32 v105, v104, v105, v98
    v_max_u32 v104, v104, v98
    v_med3_u32 v105, v104, v105, v99
    v_max_u32 v104, v104, v99
    s_waitcnt lgkmcnt(0)
    v_med3_u32 v105, v104, v105, v100
    v_max_u32 v104, v104, v100
    v_med3_u32 v105, v104, v105, v101
    v_max_u32 v104, v104, v101
    v_med3_u32 v105, v104, v105, v102
    v_max_u32 v104, v104, v102
    v_med3_u32 v105, v104, v105, v103
    v_max_u32 v104, v104, v103
    buffer_store_dwordx2 v[104:105], v8, s[24:27], s45 offen sc1
    v_pk_fma_f32 v[216:217], v[216:217], v[50:51], v[48:49] op_sel_hi:[1,0,0]
    v_pk_fma_f32 v[218:219], v[218:219], v[50:51], v[48:49] op_sel_hi:[1,0,0]
    v_pk_fma_f32 v[220:221], v[220:221], v[50:51], v[48:49] op_sel_hi:[1,0,0]
    v_pk_fma_f32 v[222:223], v[222:223], v[50:51], v[48:49] op_sel_hi:[1,0,0]
    v_pk_fma_f32 v[224:225], v[224:225], v[50:51], v[48:49] op_sel_hi:[1,0,0]
    v_pk_fma_f32 v[226:227], v[226:227], v[50:51], v[48:49] op_sel_hi:[1,0,0]
    v_pk_fma_f32 v[228:229], v[228:229], v[50:51], v[48:49] op_sel_hi:[1,0,0]
    v_pk_fma_f32 v[230:231], v[230:231], v[50:51], v[48:49] op_sel_hi:[1,0,0]
    v_pk_fma_f32 v[232:233], v[232:233], v[50:51], v[48:49] op_sel_hi:[1,0,0]
    v_pk_fma_f32 v[234:235], v[234:235], v[50:51], v[48:49] op_sel_hi:[1,0,0]
    v_pk_fma_f32 v[236:237], v[236:237], v[50:51], v[48:49] op_sel_hi:[1,0,0]
    v_pk_fma_f32 v[238:239], v[238:239], v[50:51], v[48:49] op_sel_hi:[1,0,0]
    v_pk_fma_f32 v[216:217], v[216:217], v[120:121], v[144:145]
    v_pk_fma_f32 v[218:219], v[218:219], v[122:123], v[146:147]
    v_pk_fma_f32 v[220:221], v[220:221], v[124:125], v[148:149]
    v_pk_fma_f32 v[222:223], v[222:223], v[126:127], v[150:151]
    v_pk_fma_f32 v[224:225], v[224:225], v[128:129], v[152:153]
    v_pk_fma_f32 v[226:227], v[226:227], v[130:131], v[154:155]
    v_pk_fma_f32 v[228:229], v[228:229], v[132:133], v[156:157]
    v_pk_fma_f32 v[230:231], v[230:231], v[134:135], v[158:159]
    v_pk_fma_f32 v[232:233], v[232:233], v[136:137], v[160:161]
    v_pk_fma_f32 v[234:235], v[234:235], v[138:139], v[162:163]
    v_pk_fma_f32 v[236:237], v[236:237], v[140:141], v[164:165]
    v_pk_fma_f32 v[238:239], v[238:239], v[142:143], v[166:167]
    v_cvt_pk_bf16_f32 v64, v216, v217
    v_cvt_pk_bf16_f32 v65, v218, v219
    v_cvt_pk_bf16_f32 v66, v220, v221
    v_cvt_pk_bf16_f32 v67, v222, v223
    v_cvt_pk_bf16_f32 v68, v224, v225
    v_cvt_pk_bf16_f32 v69, v226, v227
    v_cvt_pk_bf16_f32 v70, v228, v229
    v_cvt_pk_bf16_f32 v71, v230, v231
    v_cvt_pk_bf16_f32 v72, v232, v233
    v_cvt_pk_bf16_f32 v73, v234, v235
    v_cvt_pk_bf16_f32 v74, v236, v237
    v_cvt_pk_bf16_f32 v75, v238, v239
    v_and_b32 v106, 0x7ff, v104
    v_and_b32 v107, 0x7ff, v105
    v_cmp_eq_u32 vcc, v106, v93
    v_cmp_eq_u32 s[36:37], v107, v93
    v_mov_b32 v106, 2147483648
    s_or_b64 vcc, vcc, s[36:37]
    s_mov_b32 s45, 2621440
    s_nop 0
    v_cndmask_b32 v6, v106, v6, vcc
    v_cndmask_b32 v60, v106, v60, vcc
    buffer_store_dwordx4 v[64:67], v6, s[24:27], s45 offen offset:0 sc1
    buffer_store_dwordx4 v[68:71], v6, s[24:27], s45 offen offset:512 sc1
    buffer_store_dwordx4 v[72:75], v60, s[24:27], s45 offen offset:1024 sc1
    s_cmp_ge_u32 s41, 18
    s_cbranch_scc1 Ltail_idle
    s_mov_b32 s36, 2622592
    buffer_store_dwordx4 v[36:39], v6, s[24:27], s36 offen offset:0 sc1
    buffer_store_dwordx4 v[40:43], v6, s[24:27], s36 offen offset:512 sc1
    buffer_store_dwordx4 v[44:47], v60, s[24:27], s36 offen offset:1024 sc1
    v_lshlrev_b32 v216, 16, v64
    v_and_b32 v217, 0xffff0000, v64
    v_lshlrev_b32 v218, 16, v65
    v_and_b32 v219, 0xffff0000, v65
    v_lshlrev_b32 v220, 16, v66
    v_and_b32 v221, 0xffff0000, v66
    v_lshlrev_b32 v222, 16, v67
    v_and_b32 v223, 0xffff0000, v67
    v_lshlrev_b32 v224, 16, v68
    v_and_b32 v225, 0xffff0000, v68
    v_lshlrev_b32 v226, 16, v69
    v_and_b32 v227, 0xffff0000, v69
    v_lshlrev_b32 v228, 16, v70
    v_and_b32 v229, 0xffff0000, v70
    v_lshlrev_b32 v230, 16, v71
    v_and_b32 v231, 0xffff0000, v71
    v_lshlrev_b32 v232, 16, v72
    v_and_b32 v233, 0xffff0000, v72
    v_lshlrev_b32 v234, 16, v73
    v_and_b32 v235, 0xffff0000, v73
    v_lshlrev_b32 v236, 16, v74
    v_and_b32 v237, 0xffff0000, v74
    v_lshlrev_b32 v238, 16, v75
    v_and_b32 v239, 0xffff0000, v75
    v_pk_mul_f32 v[192:193], v[192:193], v[216:217]
    v_pk_mul_f32 v[194:195], v[194:195], v[218:219]
    v_pk_mul_f32 v[196:197], v[196:197], v[220:221]
    v_pk_mul_f32 v[198:199], v[198:199], v[222:223]
    v_pk_mul_f32 v[200:201], v[200:201], v[224:225]
    v_pk_mul_f32 v[202:203], v[202:203], v[226:227]
    v_pk_mul_f32 v[204:205], v[204:205], v[228:229]
    v_pk_mul_f32 v[206:207], v[206:207], v[230:231]
    v_pk_mul_f32 v[208:209], v[208:209], v[232:233]
    v_pk_mul_f32 v[210:211], v[210:211], v[234:235]
    v_pk_mul_f32 v[212:213], v[212:213], v[236:237]
    v_pk_mul_f32 v[214:215], v[214:215], v[238:239]
    v_cvt_pk_bf16_f32 v144, v192, v193
    v_cvt_pk_bf16_f32 v145, v194, v195
    v_cvt_pk_bf16_f32 v146, v196, v197
    v_cvt_pk_bf16_f32 v147, v198, v199
    v_cvt_pk_bf16_f32 v148, v200, v201
    v_cvt_pk_bf16_f32 v149, v202, v203
    v_cvt_pk_bf16_f32 v150, v204, v205
    v_cvt_pk_bf16_f32 v151, v206, v207
    v_cvt_pk_bf16_f32 v152, v208, v209
    v_cvt_pk_bf16_f32 v153, v210, v211
    v_cvt_pk_bf16_f32 v154, v212, v213
    v_cvt_pk_bf16_f32 v155, v214, v215
    v_lshlrev_b32 v192, 16, v144
    v_and_b32 v193, 0xffff0000, v144
    v_lshlrev_b32 v194, 16, v145
    v_and_b32 v195, 0xffff0000, v145
    v_lshlrev_b32 v196, 16, v146
    v_and_b32 v197, 0xffff0000, v146
    v_lshlrev_b32 v198, 16, v147
    v_and_b32 v199, 0xffff0000, v147
    v_lshlrev_b32 v200, 16, v148
    v_and_b32 v201, 0xffff0000, v148
    v_lshlrev_b32 v202, 16, v149
    v_and_b32 v203, 0xffff0000, v149
    v_lshlrev_b32 v204, 16, v150
    v_and_b32 v205, 0xffff0000, v150
    v_lshlrev_b32 v206, 16, v151
    v_and_b32 v207, 0xffff0000, v151
    v_lshlrev_b32 v208, 16, v152
    v_and_b32 v209, 0xffff0000, v152
    v_lshlrev_b32 v210, 16, v153
    v_and_b32 v211, 0xffff0000, v153
    v_lshlrev_b32 v212, 16, v154
    v_and_b32 v213, 0xffff0000, v154
    v_lshlrev_b32 v214, 16, v155
    v_and_b32 v215, 0xffff0000, v155
    v_pk_add_f32 v[192:193], v[192:193], v[12:13]
    v_pk_add_f32 v[194:195], v[194:195], v[14:15]
    v_pk_add_f32 v[196:197], v[196:197], v[16:17]
    v_pk_add_f32 v[198:199], v[198:199], v[18:19]
    v_pk_add_f32 v[200:201], v[200:201], v[20:21]
    v_pk_add_f32 v[202:203], v[202:203], v[22:23]
    v_pk_add_f32 v[204:205], v[204:205], v[24:25]
    v_pk_add_f32 v[206:207], v[206:207], v[26:27]
    v_pk_add_f32 v[208:209], v[208:209], v[28:29]
    v_pk_add_f32 v[210:211], v[210:211], v[30:31]
    v_pk_add_f32 v[212:213], v[212:213], v[32:33]
    v_pk_add_f32 v[214:215], v[214:215], v[34:35]
    v_cvt_pk_bf16_f32 v156, v192, v193
    v_cvt_pk_bf16_f32 v157, v194, v195
    v_cvt_pk_bf16_f32 v158, v196, v197
    v_cvt_pk_bf16_f32 v159, v198, v199
    v_cvt_pk_bf16_f32 v160, v200, v201
    v_cvt_pk_bf16_f32 v161, v202, v203
    v_cvt_pk_bf16_f32 v162, v204, v205
    v_cvt_pk_bf16_f32 v163, v206, v207
    v_cvt_pk_bf16_f32 v164, v208, v209
    v_cvt_pk_bf16_f32 v165, v210, v211
    v_cvt_pk_bf16_f32 v166, v212, v213
    v_cvt_pk_bf16_f32 v167, v214, v215
    v_and_b32 v30, 2, v1
    v_cmp_ne_u32 vcc, 0, v30
    v_mul_u32_u24 v30, 1152, v7
    v_add_u32 v4, v30, v5
    v_add_u32 v58, v30, v59
    v_mov_b32_dpp v192, v158 quad_perm:[0,2,0,2] row_mask:0xf bank_mask:0xf
    v_mov_b32_dpp v193, v159 quad_perm:[0,2,0,2] row_mask:0xf bank_mask:0xf
    v_mov_b32_dpp v194, v158 quad_perm:[1,3,1,3] row_mask:0xf bank_mask:0xf
    v_mov_b32_dpp v195, v159 quad_perm:[1,3,1,3] row_mask:0xf bank_mask:0xf
    v_mov_b32_dpp v196, v162 quad_perm:[0,2,0,2] row_mask:0xf bank_mask:0xf
    v_mov_b32_dpp v197, v163 quad_perm:[0,2,0,2] row_mask:0xf bank_mask:0xf
    v_mov_b32_dpp v198, v162 quad_perm:[1,3,1,3] row_mask:0xf bank_mask:0xf
    v_mov_b32_dpp v199, v163 quad_perm:[1,3,1,3] row_mask:0xf bank_mask:0xf
    v_mov_b32_dpp v200, v166 quad_perm:[0,2,0,2] row_mask:0xf bank_mask:0xf
    v_mov_b32_dpp v201, v167 quad_perm:[0,2,0,2] row_mask:0xf bank_mask:0xf
    v_mov_b32_dpp v202, v166 quad_perm:[1,3,1,3] row_mask:0xf bank_mask:0xf
    v_mov_b32_dpp v203, v167 quad_perm:[1,3,1,3] row_mask:0xf bank_mask:0xf
    v_cndmask_b32_dpp v144, v156, v192, vcc quad_perm:[0,2,0,2] row_mask:0xf bank_mask:0xf
    v_cndmask_b32_dpp v145, v157, v193, vcc quad_perm:[0,2,0,2] row_mask:0xf bank_mask:0xf
    v_cndmask_b32_dpp v146, v156, v194, vcc quad_perm:[1,3,1,3] row_mask:0xf bank_mask:0xf
    v_cndmask_b32_dpp v147, v157, v195, vcc quad_perm:[1,3,1,3] row_mask:0xf bank_mask:0xf
    v_cndmask_b32_dpp v148, v160, v196, vcc quad_perm:[0,2,0,2] row_mask:0xf bank_mask:0xf
    v_cndmask_b32_dpp v149, v161, v197, vcc quad_perm:[0,2,0,2] row_mask:0xf bank_mask:0xf
    v_cndmask_b32_dpp v150, v160, v198, vcc quad_perm:[1,3,1,3] row_mask:0xf bank_mask:0xf
    v_cndmask_b32_dpp v151, v161, v199, vcc quad_perm:[1,3,1,3] row_mask:0xf bank_mask:0xf
    v_cndmask_b32_dpp v152, v164, v200, vcc quad_perm:[0,2,0,2] row_mask:0xf bank_mask:0xf
    v_cndmask_b32_dpp v153, v165, v201, vcc quad_perm:[0,2,0,2] row_mask:0xf bank_mask:0xf
    v_cndmask_b32_dpp v154, v164, v202, vcc quad_perm:[1,3,1,3] row_mask:0xf bank_mask:0xf
    v_cndmask_b32_dpp v155, v165, v203, vcc quad_perm:[1,3,1,3] row_mask:0xf bank_mask:0xf
    v_lshlrev_b32 v13, 4, v1
    v_add_u32 v13, 32768, v13
    s_lshl_b32 s44, s3, 10
    v_add_u32 v14, s44, v13
    v_and_b32 v13, 0xffffff1f, v13
    v_bfe_u32 v15, v1, 2, 2
    v_cmp_eq_u32 s[52:53], 0, v15
    v_cmp_eq_u32 s[54:55], 1, v15
    v_cmp_eq_u32 s[56:57], 2, v15
    v_cmp_eq_u32 s[58:59], 3, v15
    s_mul_i32 s43, s42, 18
    s_add_u32 s43, s43, s41
    s_lshl_b32 s43, s43, 9
    s_mul_i32 s44, s3, 73728
    s_add_u32 s43, s43, s44
    v_lshlrev_b32 v15, 3, v1
    v_and_b32 v10, 1, v1
    v_and_b32 v9, 48, v1
    s_mul_i32 s38, s3, 3072
    s_add_u32 s38, s38, 49152
    v_lshl_add_u32 v11, v10, 9, v9
    v_add_u32 v11, s38, v11
    v_lshrrev_b32 v10, 5, v1
    v_and_b32 v9, 31, v1
    v_lshlrev_b32 v9, 4, v9
    v_lshlrev_b32 v108, 7, v0
    s_mov_b32 s45, 9306112
    s_lshl_b32 s36, s3, 3
    v_mov_b32 v109, s36
    s_mov_b32 s48, 262144
Ltail_pollk:
    buffer_load_dwordx2 v[104:105], v108, s[24:27], s45 offen sc1
    s_sub_u32 s48, s48, 1
    s_cbranch_scc1 Ltail_gotk
    s_waitcnt vmcnt(0)
    v_max_u32 v106, v104, v105
    v_cmp_eq_u32 vcc, -1, v106
    s_cbranch_vccnz Ltail_pollk
Ltail_gotk:
    s_waitcnt vmcnt(0)
    v_mov_b32_dpp v106, v104 row_ror:1 row_mask:0xf bank_mask:0xf
    v_mov_b32_dpp v107, v105 row_ror:1 row_mask:0xf bank_mask:0xf
    v_min_u32 v110, v104, v106
    v_max_u32 v104, v104, v106
    v_max3_u32 v105, v110, v105, v107
    s_nop 0
    v_mov_b32_dpp v106, v104 row_ror:2 row_mask:0xf bank_mask:0xf
    v_mov_b32_dpp v107, v105 row_ror:2 row_mask:0xf bank_mask:0xf
    v_min_u32 v110, v104, v106
    v_max_u32 v104, v104, v106
    v_max3_u32 v105, v110, v105, v107
    s_nop 0
    v_mov_b32_dpp v106, v104 row_ror:4 row_mask:0xf bank_mask:0xf
    v_mov_b32_dpp v107, v105 row_ror:4 row_mask:0xf bank_mask:0xf
    v_min_u32 v110, v104, v106
    v_max_u32 v104, v104, v106
    v_max3_u32 v105, v110, v105, v107
    s_nop 0
    v_mov_b32_dpp v106, v104 row_ror:8 row_mask:0xf bank_mask:0xf
    v_mov_b32_dpp v107, v105 row_ror:8 row_mask:0xf bank_mask:0xf
    v_min_u32 v110, v104, v106
    v_max_u32 v104, v104, v106
    v_max3_u32 v105, v110, v105, v107
    v_mov_b32 v106, v104
    v_mov_b32 v107, v105
    s_nop 0
    v_permlane16_swap_b32 v104, v106
    v_permlane16_swap_b32 v105, v107
    v_min_u32 v110, v104, v106
    v_max_u32 v104, v104, v106
    v_max3_u32 v105, v110, v105, v107
    v_mov_b32 v106, v104
    v_mov_b32 v107, v105
    s_nop 0
    v_permlane32_swap_b32 v104, v106
    v_permlane32_swap_b32 v105, v107
    v_min_u32 v110, v104, v106
    v_max_u32 v104, v104, v106
    v_max3_u32 v105, v110, v105, v107
    ds_write_b64 v109, v[104:105] offset:36928
    v_mov_b32 v109, 36928
    s_waitcnt lgkmcnt(0)
    s_barrier
    ds_read_b128 v[96:99], v109
    ds_read_b128 v[100:103], v109 offset:16
    s_waitcnt lgkmcnt(1)
    v_max_u32 v104, v96, v97
    v_min_u32 v105, v96, v97
    v_med3_u32 v105, v104, v105, v98
    v_max_u32 v104, v104, v98
    v_med3_u32 v105, v104, v105, v99
    v_max_u32 v104, v104, v99
    s_waitcnt lgkmcnt(0)
    v_med3_u32 v105, v104, v105, v100
    v_max_u32 v104, v104, v100
    v_med3_u32 v105, v104, v105, v101
    v_max_u32 v104, v104, v101
    v_med3_u32 v105, v104, v105, v102
    v_max_u32 v104, v104, v102
    v_med3_u32 v105, v104, v105, v103
    v_max_u32 v104, v104, v103
    s_nop 0
    v_readfirstlane_b32 s92, v104
    v_readfirstlane_b32 s93, v105
    s_andn2_b32 s46, 0x7ff, s92
    s_andn2_b32 s47, 0x7ff, s93
    s_mul_i32 s44, s46, 2304
    s_mul_i32 s45, s47, 2304
    s_sub_u32 s45, s45, s44
    v_mad_i32_i24 v10, v10, s45, v9
    s_add_u32 s45, s44, 2621440
    v_add_u32 v10, s45, v10
    s_mov_b32 s48, 16384
Ltail_pollh:
    s_mov_b32 exec_lo, 0xffffff
    s_mov_b32 exec_hi, 0xffffff
    s_add_u32 m0, s38, 0
    s_nop 0
    buffer_load_dwordx4 v10, s[24:27], 0 offen offset:0 sc1 lds
    s_add_u32 m0, s38, 640
    s_nop 0
    buffer_load_dwordx4 v10, s[24:27], 0 offen offset:384 sc1 lds
    s_add_u32 m0, s38, 1280
    s_nop 0
    buffer_load_dwordx4 v10, s[24:27], 0 offen offset:768 sc1 lds
    s_mov_b64 exec, -1
    s_waitcnt vmcnt(0)
    ds_read_b128 a[0:3], v11 offset:0
    ds_read_b128 a[4:7], v11 offset:64
    ds_read_b128 a[8:11], v11 offset:128
    ds_read_b128 a[12:15], v11 offset:192
    ds_read_b128 a[16:19], v11 offset:256
    ds_read_b128 a[20:23], v11 offset:320
    ds_read_b128 a[24:27], v11 offset:1024
    ds_read_b128 a[28:31], v11 offset:1088
    ds_read_b128 a[32:35], v11 offset:1152
    ds_read_b128 a[36:39], v11 offset:1216
    ds_read_b128 a[40:43], v11 offset:1280
    ds_read_b128 a[44:47], v11 offset:1344
    ds_read_b128 a[48:51], v11 offset:2048
    ds_read_b128 a[52:55], v11 offset:2112
    ds_read_b128 a[56:59], v11 offset:2176
    ds_read_b128 a[60:63], v11 offset:2240
    ds_read_b128 a[64:67], v11 offset:2304
    ds_read_b128 a[68:71], v11 offset:2368
    s_waitcnt lgkmcnt(15)
    v_mfma_f32_16x16x32_bf16 v[16:19], a[96:99], a[0:3], 0
    v_mfma_f32_16x16x32_bf16 v[20:23], a[100:103], a[4:7], 0
    v_mfma_f32_16x16x32_bf16 v[16:19], a[104:107], a[8:11], v[16:19]
    s_waitcnt lgkmcnt(14)
    v_mfma_f32_16x16x32_bf16 v[20:23], a[108:111], a[12:15], v[20:23]
    s_waitcnt lgkmcnt(13)
    v_mfma_f32_16x16x32_bf16 v[16:19], a[112:115], a[16:19], v[16:19]
    s_waitcnt lgkmcnt(12)
    v_mfma_f32_16x16x32_bf16 v[20:23], a[116:119], a[20:23], v[20:23]
    s_waitcnt lgkmcnt(11)
    v_mfma_f32_16x16x32_bf16 v[16:19], a[120:123], a[24:27], v[16:19]
    s_waitcnt lgkmcnt(10)
    v_mfma_f32_16x16x32_bf16 v[20:23], a[124:127], a[28:31], v[20:23]
    s_waitcnt lgkmcnt(9)
    v_mfma_f32_16x16x32_bf16 v[16:19], a[128:131], a[32:35], v[16:19]
    s_waitcnt lgkmcnt(8)
    v_mfma_f32_16x16x32_bf16 v[20:23], a[132:135], a[36:39], v[20:23]
    s_waitcnt lgkmcnt(7)
    v_mfma_f32_16x16x32_bf16 v[16:19], a[136:139], a[40:43], v[16:19]
    s_waitcnt lgkmcnt(6)
    v_mfma_f32_16x16x32_bf16 v[20:23], a[140:143], a[44:47], v[20:23]
    s_waitcnt lgkmcnt(5)
    v_mfma_f32_16x16x32_bf16 v[16:19], a[144:147], a[48:51], v[16:19]
    s_waitcnt lgkmcnt(4)
    v_mfma_f32_16x16x32_bf16 v[20:23], a[148:151], a[52:55], v[20:23]
    s_waitcnt lgkmcnt(3)
    v_mfma_f32_16x16x32_bf16 v[16:19], a[152:155], a[56:59], v[16:19]
    s_waitcnt lgkmcnt(2)
    v_mfma_f32_16x16x32_bf16 v[20:23], a[156:159], a[60:63], v[20:23]
    s_waitcnt lgkmcnt(1)
    v_mfma_f32_16x16x32_bf16 v[16:19], a[160:163], a[64:67], v[16:19]
    s_waitcnt lgkmcnt(0)
    v_mfma_f32_16x16x32_bf16 v[20:23], a[164:167], a[68:71], v[20:23]
    s_sub_u32 s48, s48, 1
    s_nop 6
    v_pk_add_f32 v[16:17], v[16:17], v[20:21]
    v_pk_add_f32 v[18:19], v[18:19], v[22:23]
    s_cbranch_scc1 Ltail_goth
    v_cmp_u_f32 vcc, v16, v16
    s_and_b32 s36, vcc_lo, 3
    s_cbranch_scc1 Ltail_pollh
Ltail_goth:
    ds_write_b128 v14, v[16:19]
    s_waitcnt lgkmcnt(0)
    s_barrier
    ds_read_b128 v[16:19], v13 offset:0
    ds_read_b128 v[20:23], v13 offset:1024
    ds_read_b128 v[24:27], v13 offset:2048
    ds_read_b128 v[28:31], v13 offset:3072
    s_mov_b32 s36, 0xbfb8aa3b
    s_mov_b32 s37, 0xbfb8aa3b
    s_waitcnt lgkmcnt(3)
    v_cvt_pk_bf16_f32 v32, v16, v17
    v_cvt_pk_bf16_f32 v33, v18, v19
    s_waitcnt lgkmcnt(2)
    v_cvt_pk_bf16_f32 v34, v20, v21
    v_cvt_pk_bf16_f32 v35, v22, v23
    v_lshlrev_b32 v16, 16, v32
    v_and_b32 v17, 0xffff0000, v32
    v_lshlrev_b32 v18, 16, v33
    v_and_b32 v19, 0xffff0000, v33
    v_lshlrev_b32 v20, 16, v34
    v_and_b32 v21, 0xffff0000, v34
    v_lshlrev_b32 v22, 16, v35
    v_and_b32 v23, 0xffff0000, v35
    v_pk_mul_f32 v[32:33], v[16:17], s[36:37]
    v_pk_mul_f32 v[34:35], v[18:19], s[36:37]
    v_pk_mul_f32 v[36:37], v[20:21], s[36:37]
    v_pk_mul_f32 v[38:39], v[22:23], s[36:37]
    v_exp_f32 v32, v32
    v_exp_f32 v33, v33
    v_exp_f32 v34, v34
    v_exp_f32 v35, v35
    v_exp_f32 v36, v36
    v_exp_f32 v37, v37
    v_exp_f32 v38, v38
    v_exp_f32 v39, v39
    s_waitcnt lgkmcnt(1)
    v_cvt_pk_bf16_f32 v60, v24, v25
    v_cvt_pk_bf16_f32 v61, v26, v27
    s_waitcnt lgkmcnt(0)
    v_cvt_pk_bf16_f32 v62, v28, v29
    v_cvt_pk_bf16_f32 v63, v30, v31
    v_pk_add_f32 v[32:33], v[32:33], 1.0 op_sel_hi:[1,0]
    v_pk_add_f32 v[34:35], v[34:35], 1.0 op_sel_hi:[1,0]
    v_pk_add_f32 v[36:37], v[36:37], 1.0 op_sel_hi:[1,0]
    v_pk_add_f32 v[38:39], v[38:39], 1.0 op_sel_hi:[1,0]
    v_rcp_f32 v32, v32
    v_rcp_f32 v33, v33
    v_rcp_f32 v34, v34
    v_rcp_f32 v35, v35
    v_rcp_f32 v36, v36
    v_rcp_f32 v37, v37
    v_rcp_f32 v38, v38
    v_rcp_f32 v39, v39
    v_lshlrev_b32 v24, 16, v60
    v_and_b32 v25, 0xffff0000, v60
    v_lshlrev_b32 v26, 16, v61
    v_and_b32 v27, 0xffff0000, v61
    v_lshlrev_b32 v28, 16, v62
    v_and_b32 v29, 0xffff0000, v62
    v_lshlrev_b32 v30, 16, v63
    v_and_b32 v31, 0xffff0000, v63
    v_pk_mul_f32 v[16:17], v[16:17], v[32:33]
    v_pk_mul_f32 v[18:19], v[18:19], v[34:35]
    v_pk_mul_f32 v[20:21], v[20:21], v[36:37]
    v_pk_mul_f32 v[22:23], v[22:23], v[38:39]
    v_cvt_pk_bf16_f32 v32, v16, v17
    v_cvt_pk_bf16_f32 v33, v18, v19
    v_cvt_pk_bf16_f32 v34, v20, v21
    v_cvt_pk_bf16_f32 v35, v22, v23
    v_lshlrev_b32 v16, 16, v32
    v_and_b32 v17, 0xffff0000, v32
    v_lshlrev_b32 v18, 16, v33
    v_and_b32 v19, 0xffff0000, v33
    v_lshlrev_b32 v20, 16, v34
    v_and_b32 v21, 0xffff0000, v34
    v_lshlrev_b32 v22, 16, v35
    v_and_b32 v23, 0xffff0000, v35
    v_pk_mul_f32 v[16:17], v[16:17], v[24:25]
Ltour13:
    s_cbranch_execz Ltour17
    v_pk_mul_f32 v[18:19], v[18:19], v[26:27]
    v_pk_mul_f32 v[20:21], v[20:21], v[28:29]
    v_pk_mul_f32 v[22:23], v[22:23], v[30:31]
    v_cvt_pk_bf16_f32 v32, v16, v17
    v_cvt_pk_bf16_f32 v33, v18, v19
    v_cvt_pk_bf16_f32 v34, v20, v21
    v_cvt_pk_bf16_f32 v35, v22, v23
    v_cndmask_b32 v64, 0, v32, s[52:53]
    v_cndmask_b32 v65, 0, v33, s[52:53]
    v_cndmask_b32 v66, 0, v34, s[52:53]
    v_cndmask_b32 v67, 0, v35, s[52:53]
    v_cndmask_b32 v68, 0, v32, s[54:55]
    v_cndmask_b32 v69, 0, v33, s[54:55]
    v_cndmask_b32 v70, 0, v34, s[54:55]
    v_cndmask_b32 v71, 0, v35, s[54:55]
    v_cndmask_b32 v72, 0, v32, s[56:57]
    v_cndmask_b32 v73, 0, v33, s[56:57]
    v_cndmask_b32 v74, 0, v34, s[56:57]
    v_cndmask_b32 v75, 0, v35, s[56:57]
    v_cndmask_b32 v76, 0, v32, s[58:59]
    v_cndmask_b32 v77, 0, v33, s[58:59]
    v_cndmask_b32 v78, 0, v34, s[58:59]
    v_cndmask_b32 v79, 0, v35, s[58:59]
    v_mfma_f32_16x16x32_bf16 v[16:19], v[64:67], a[168:171], 0
    v_mfma_f32_16x16x32_bf16 v[16:19], v[68:71], a[172:175], v[16:19]
    v_mfma_f32_16x16x32_bf16 v[16:19], v[72:75], a[176:179], v[16:19]
    v_mfma_f32_16x16x32_bf16 v[16:19], v[76:79], a[180:183], v[16:19]
    v_mfma_f32_16x16x32_bf16 v[20:23], v[64:67], a[184:187], 0
    v_mfma_f32_16x16x32_bf16 v[20:23], v[68:71], a[188:191], v[20:23]
    v_mfma_f32_16x16x32_bf16 v[20:23], v[72:75], a[192:195], v[20:23]
    v_mfma_f32_16x16x32_bf16 v[20:23], v[76:79], a[196:199], v[20:23]
    v_mfma_f32_16x16x32_bf16 v[24:27], v[64:67], a[200:203], 0
    v_mfma_f32_16x16x32_bf16 v[24:27], v[68:71], a[204:207], v[24:27]
    v_mfma_f32_16x16x32_bf16 v[24:27], v[72:75], a[208:211], v[24:27]
    v_mfma_f32_16x16x32_bf16 v[24:27], v[76:79], a[212:215], v[24:27]
    v_min_u32 v16, -2, v16
    v_min_u32 v17, -2, v17
    buffer_store_dwordx2 v[16:17], v15, s[8:11], s43 offen sc1
    s_add_u32 s43, s43, 294912
    v_min_u32 v20, -2, v20
    v_min_u32 v21, -2, v21
    buffer_store_dwordx2 v[20:21], v15, s[8:11], s43 offen sc1
    s_add_u32 s43, s43, 294912
    v_min_u32 v24, -2, v24
    v_min_u32 v25, -2, v25
    buffer_store_dwordx2 v[24:25], v15, s[8:11], s43 offen sc1
    s_or_b32 s36, s2, s3
    s_cselect_b32 s37, -4, 24576
    s_add_u32 s36, s94, 1
    v_mov_b32 v106, s36
    buffer_store_dword v106, v8, s[24:27], s37 offen sc1
    v_cmp_ne_u32 vcc, s46, v7
    v_cmp_ne_u32 s[36:37], s47, v7
    v_mov_b32 v31, 2147483648
    s_and_b64 vcc, vcc, s[36:37]
    s_nop 1
    v_cndmask_b32 v30, v31, v58, vcc
    v_cndmask_b32 v31, v31, v4, vcc
    buffer_store_dwordx4 v[144:147], v31, s[16:19], 0 offen offset:0 nt
    buffer_store_dwordx4 v[148:151], v31, s[16:19], 0 offen offset:512 nt
    buffer_store_dwordx4 v[152:155], v30, s[16:19], 0 offen offset:1024 nt
    s_cmp_lt_u32 s41, 9
    s_cselect_b32 s36, s3, 0
    s_cmp_lg_u32 s36, 3
    s_cbranch_scc1 Ltail_done
    s_mul_i32 s43, s42, 9
    s_add_u32 s43, s43, s41
    v_bfe_u32 v8, v1, 2, 1
    v_cmp_eq_u32 vcc, 1, v8
    v_mov_b32 v9, s46
    v_mov_b32 v10, s47
    v_and_b32 v11, 3, v1
    v_cndmask_b32 v9, v9, v10, vcc
    s_lshr_b32 s44, s43, 2
    s_lshl_b32 s44, s44, 6
    s_and_b32 s45, s43, 1
    s_lshl_b32 s45, s45, 5
    s_add_u32 s44, s44, s45
    s_and_b32 s45, s43, 2
    s_lshl_b32 s45, s45, 2
    s_add_u32 s44, s44, s45
    v_lshrrev_b32 v12, 1, v11
    v_lshl_add_u32 v12, v12, 4, s44
    v_and_b32 v13, 1, v11
    v_lshl_add_u32 v12, v13, 2, v12
    v_mul_u32_u24 v13, 1152, v9
    v_lshl_add_u32 v14, v13, 1, v12
    v_add_u32 v15, 2621440, v14
    s_mov_b32 s45, 22144
    buffer_load_dword v18, v12, s[24:27], s45 offen sc1
    v_mov_b32 v19, s92
    v_mov_b32 v10, s93
    v_cndmask_b32 v19, v19, v10, vcc
    v_and_b32 v19, 0xfffff800, v19
    v_or_b32 v19, 0x400, v19
    v_ashrrev_i32 v10, 31, v19
    v_not_b32 v10, v10
    v_or_b32 v10, 0x80000000, v10
    v_xor_b32 v19, v19, v10
    s_lshl_b32 s45, s43, 4
    v_lshl_add_u32 v13, v11, 2, v13
    v_add_u32 v13, s45, v13
    v_lshrrev_b32 v14, 2, v1
    v_lshlrev_b32 v14, 9, v14
    v_lshl_add_u32 v14, v11, 4, v14
    s_lshr_b32 s44, s43, 3
    s_mul_i32 s44, s44, 73728
    s_and_b32 s45, s43, 7
    s_lshl_b32 s45, s45, 6
    s_add_u32 s44, s44, s45
    v_cmp_eq_u32 s[38:39], 1, v8
    v_cvt_pk_bf16_f32 v19, v19, v19
    v_and_b32 v19, 0xffff0000, v19
    v_mul_f32 v19, 0xbfb8aa3b, v19
    v_exp_f32 v19, v19
    s_waitcnt vmcnt(0)
    v_lshlrev_b32 v24, 16, v18
    v_and_b32 v25, 0xffff0000, v18
    v_add_f32 v19, 1.0, v19
    v_rcp_f32 v19, v19
    s_mov_b32 s48, 262144
    v_cvt_pk_bf16_f32 v19, v19, v19
    v_and_b32 v19, 0xffff0000, v19
Ltail_polly:
    s_add_u32 s45, s44, 0
    buffer_load_dwordx4 v[64:67], v14, s[8:11], s45 offen sc1
    s_add_u32 s45, s44, 8192
    buffer_load_dwordx4 v[68:71], v14, s[8:11], s45 offen sc1
    s_add_u32 s45, s44, 16384
    buffer_load_dwordx4 v[72:75], v14, s[8:11], s45 offen sc1
    s_add_u32 s45, s44, 24576
    buffer_load_dwordx4 v[76:79], v14, s[8:11], s45 offen sc1
    s_add_u32 s45, s44, 32768
    buffer_load_dwordx4 v[80:83], v14, s[8:11], s45 offen sc1
    s_add_u32 s45, s44, 40960
    buffer_load_dwordx4 v[84:87], v14, s[8:11], s45 offen sc1
    s_add_u32 s45, s44, 49152
    buffer_load_dwordx4 v[88:91], v14, s[8:11], s45 offen sc1
    s_add_u32 s45, s44, 57344
    buffer_load_dwordx4 v[92:95], v14, s[8:11], s45 offen sc1
    s_add_u32 s45, s44, 65536
    buffer_load_dwordx4 v[96:99], v14, s[8:11], s45 offen sc1
    s_mov_b32 s45, 1152
    buffer_load_dword v16, v15, s[24:27], s45 offen sc1
    buffer_load_dword v17, v15, s[24:27], 0 offen sc1
    s_sub_u32 s48, s48, 1
    s_cbranch_scc1 Ltail_goty
    s_waitcnt vmcnt(10)
    v_max3_u32 v26, v64, v65, v66
    s_waitcnt vmcnt(9)
    v_max3_u32 v26, v26, v67, v68
    v_max3_u32 v26, v26, v69, v70
    s_waitcnt vmcnt(8)
    v_max3_u32 v26, v26, v71, v72
    v_max3_u32 v26, v26, v73, v74
    s_waitcnt vmcnt(7)
    v_max3_u32 v26, v26, v75, v76
    v_max3_u32 v26, v26, v77, v78
    s_waitcnt vmcnt(6)
    v_max3_u32 v26, v26, v79, v80
    v_max3_u32 v26, v26, v81, v82
    s_waitcnt vmcnt(5)
    v_max3_u32 v26, v26, v83, v84
    v_max3_u32 v26, v26, v85, v86
    s_waitcnt vmcnt(4)
    v_max3_u32 v26, v26, v87, v88
    v_max3_u32 v26, v26, v89, v90
    s_waitcnt vmcnt(3)
    v_max3_u32 v26, v26, v91, v92
    v_max3_u32 v26, v26, v93, v94
    s_waitcnt vmcnt(2)
    v_max3_u32 v26, v26, v95, v96
    v_max3_u32 v26, v26, v97, v98
    v_max_u32 v26, v26, v99
    s_waitcnt vmcnt(0)
    v_max3_u32 v26, v26, v16, v17
    v_cmp_eq_u32 vcc, -1, v26
    s_cbranch_vccnz Ltail_polly
Ltail_goty:
    s_waitcnt vmcnt(0) lgkmcnt(0)
    v_lshlrev_b32 v20, 16, v16
    v_and_b32 v21, 0xffff0000, v16
    v_lshlrev_b32 v22, 16, v17
    v_and_b32 v23, 0xffff0000, v17
    v_pk_add_f32 v[64:65], v[64:65], v[68:69]
    v_pk_add_f32 v[66:67], v[66:67], v[70:71]
    v_pk_add_f32 v[64:65], v[64:65], v[72:73]
    v_pk_add_f32 v[66:67], v[66:67], v[74:75]
    v_pk_add_f32 v[64:65], v[64:65], v[76:77]
    v_pk_add_f32 v[66:67], v[66:67], v[78:79]
    v_pk_add_f32 v[64:65], v[64:65], v[80:81]
    v_pk_add_f32 v[66:67], v[66:67], v[82:83]
    v_pk_add_f32 v[64:65], v[64:65], v[84:85]
    v_pk_add_f32 v[66:67], v[66:67], v[86:87]
    v_pk_add_f32 v[64:65], v[64:65], v[88:89]
    v_pk_add_f32 v[66:67], v[66:67], v[90:91]
    v_pk_add_f32 v[64:65], v[64:65], v[92:93]
    v_pk_add_f32 v[66:67], v[66:67], v[94:95]
    v_pk_add_f32 v[64:65], v[64:65], v[96:97]
    v_pk_add_f32 v[66:67], v[66:67], v[98:99]
    s_nop 0
    v_add_f32_dpp v64, v64, v64 row_ror:4 row_mask:0xf bank_mask:0xf
    v_add_f32_dpp v65, v65, v65 row_ror:4 row_mask:0xf bank_mask:0xf
    v_add_f32_dpp v66, v66, v66 row_ror:4 row_mask:0xf bank_mask:0xf
    v_add_f32_dpp v67, v67, v67 row_ror:4 row_mask:0xf bank_mask:0xf
    v_add_f32_dpp v64, v64, v64 row_ror:8 row_mask:0xf bank_mask:0xf
    v_add_f32_dpp v65, v65, v65 row_ror:8 row_mask:0xf bank_mask:0xf
    v_add_f32_dpp v66, v66, v66 row_ror:8 row_mask:0xf bank_mask:0xf
    v_add_f32_dpp v67, v67, v67 row_ror:8 row_mask:0xf bank_mask:0xf
    v_mov_b32 v68, v64
    v_mov_b32 v69, v65
    v_mov_b32 v70, v66
    v_mov_b32 v71, v67
    v_permlane16_swap_b32 v64, v68
    v_permlane16_swap_b32 v65, v69
    v_permlane16_swap_b32 v66, v70
    v_permlane16_swap_b32 v67, v71
    v_add_f32 v64, v64, v68
    v_add_f32 v65, v65, v69
    v_add_f32 v66, v66, v70
    v_add_f32 v67, v67, v71
    v_mov_b32 v68, v64
    v_mov_b32 v69, v65
    v_mov_b32 v70, v66
    v_mov_b32 v71, v67
    v_permlane32_swap_b32 v64, v68
    v_permlane32_swap_b32 v65, v69
    v_permlane32_swap_b32 v66, v70
    v_permlane32_swap_b32 v67, v71
    v_add_f32 v64, v64, v68
    v_add_f32 v65, v65, v69
    v_add_f32 v66, v66, v70
    v_add_f32 v67, v67, v71
    v_cndmask_b32 v26, v64, v65, s[38:39]
    v_cndmask_b32 v27, v66, v67, s[38:39]
    v_cvt_pk_bf16_f32 v28, v26, v27
    v_lshlrev_b32 v26, 16, v28
    v_and_b32 v27, 0xffff0000, v28
    v_mul_f32 v26, v26, v19
    v_mul_f32 v27, v27, v19
    v_cvt_pk_bf16_f32 v28, v26, v27
    v_lshlrev_b32 v26, 16, v28
    v_and_b32 v27, 0xffff0000, v28
    v_pk_add_f32 v[26:27], v[26:27], v[22:23]
    v_cvt_pk_bf16_f32 v28, v26, v27
    v_lshlrev_b32 v26, 16, v28
    v_and_b32 v27, 0xffff0000, v28
    v_pk_mul_f32 v[26:27], v[26:27], v[24:25]
    v_cvt_pk_bf16_f32 v28, v26, v27
    v_lshlrev_b32 v26, 16, v28
    v_and_b32 v27, 0xffff0000, v28
    v_pk_add_f32 v[26:27], v[26:27], v[20:21]
    v_cvt_pk_bf16_f32 v28, v26, v27
    s_mov_b64 exec, 0xff
    buffer_store_dword v28, v13, s[16:19], 0 offen nt
    s_branch Ltail_done
Ltail_idle:
Ltour14:
    s_cbranch_execz Lmain
    v_lshlrev_b32 v216, 16, v64
    v_and_b32 v217, 0xffff0000, v64
    v_lshlrev_b32 v218, 16, v65
    v_and_b32 v219, 0xffff0000, v65
    v_lshlrev_b32 v220, 16, v66
    v_and_b32 v221, 0xffff0000, v66
    v_lshlrev_b32 v222, 16, v67
    v_and_b32 v223, 0xffff0000, v67
    v_lshlrev_b32 v224, 16, v68
    v_and_b32 v225, 0xffff0000, v68
    v_lshlrev_b32 v226, 16, v69
    v_and_b32 v227, 0xffff0000, v69
    v_lshlrev_b32 v228, 16, v70
    v_and_b32 v229, 0xffff0000, v70
    v_lshlrev_b32 v230, 16, v71
    v_and_b32 v231, 0xffff0000, v71
    v_lshlrev_b32 v232, 16, v72
    v_and_b32 v233, 0xffff0000, v72
    v_lshlrev_b32 v234, 16, v73
    v_and_b32 v235, 0xffff0000, v73
    v_lshlrev_b32 v236, 16, v74
    v_and_b32 v237, 0xffff0000, v74
    v_lshlrev_b32 v238, 16, v75
    v_and_b32 v239, 0xffff0000, v75
    v_pk_mul_f32 v[192:193], v[192:193], v[216:217]
    v_pk_mul_f32 v[194:195], v[194:195], v[218:219]
    v_pk_mul_f32 v[196:197], v[196:197], v[220:221]
    v_pk_mul_f32 v[198:199], v[198:199], v[222:223]
    v_pk_mul_f32 v[200:201], v[200:201], v[224:225]
    v_pk_mul_f32 v[202:203], v[202:203], v[226:227]
    v_pk_mul_f32 v[204:205], v[204:205], v[228:229]
    v_pk_mul_f32 v[206:207], v[206:207], v[230:231]
    v_pk_mul_f32 v[208:209], v[208:209], v[232:233]
    v_pk_mul_f32 v[210:211], v[210:211], v[234:235]
    v_pk_mul_f32 v[212:213], v[212:213], v[236:237]
    v_pk_mul_f32 v[214:215], v[214:215], v[238:239]
    v_cvt_pk_bf16_f32 v144, v192, v193
    v_cvt_pk_bf16_f32 v145, v194, v195
    v_cvt_pk_bf16_f32 v146, v196, v197
    v_cvt_pk_bf16_f32 v147, v198, v199
    v_cvt_pk_bf16_f32 v148, v200, v201
    v_cvt_pk_bf16_f32 v149, v202, v203
    v_cvt_pk_bf16_f32 v150, v204, v205
    v_cvt_pk_bf16_f32 v151, v206, v207
    v_cvt_pk_bf16_f32 v152, v208, v209
    v_cvt_pk_bf16_f32 v153, v210, v211
    v_cvt_pk_bf16_f32 v154, v212, v213
    v_cvt_pk_bf16_f32 v155, v214, v215
    v_lshlrev_b32 v192, 16, v144
    v_and_b32 v193, 0xffff0000, v144
    v_lshlrev_b32 v194, 16, v145
    v_and_b32 v195, 0xffff0000, v145
    v_lshlrev_b32 v196, 16, v146
    v_and_b32 v197, 0xffff0000, v146
    v_lshlrev_b32 v198, 16, v147
    v_and_b32 v199, 0xffff0000, v147
    v_lshlrev_b32 v200, 16, v148
    v_and_b32 v201, 0xffff0000, v148
    v_lshlrev_b32 v202, 16, v149
    v_and_b32 v203, 0xffff0000, v149
    v_lshlrev_b32 v204, 16, v150
    v_and_b32 v205, 0xffff0000, v150
    v_lshlrev_b32 v206, 16, v151
    v_and_b32 v207, 0xffff0000, v151
    v_lshlrev_b32 v208, 16, v152
    v_and_b32 v209, 0xffff0000, v152
    v_lshlrev_b32 v210, 16, v153
    v_and_b32 v211, 0xffff0000, v153
    v_lshlrev_b32 v212, 16, v154
    v_and_b32 v213, 0xffff0000, v154
    v_lshlrev_b32 v214, 16, v155
    v_and_b32 v215, 0xffff0000, v155
    v_pk_add_f32 v[192:193], v[192:193], v[12:13]
    v_pk_add_f32 v[194:195], v[194:195], v[14:15]
    v_pk_add_f32 v[196:197], v[196:197], v[16:17]
    v_pk_add_f32 v[198:199], v[198:199], v[18:19]
    v_pk_add_f32 v[200:201], v[200:201], v[20:21]
    v_pk_add_f32 v[202:203], v[202:203], v[22:23]
    v_pk_add_f32 v[204:205], v[204:205], v[24:25]
    v_pk_add_f32 v[206:207], v[206:207], v[26:27]
    v_pk_add_f32 v[208:209], v[208:209], v[28:29]
    v_pk_add_f32 v[210:211], v[210:211], v[30:31]
    v_pk_add_f32 v[212:213], v[212:213], v[32:33]
    v_pk_add_f32 v[214:215], v[214:215], v[34:35]
    v_cvt_pk_bf16_f32 v156, v192, v193
    v_cvt_pk_bf16_f32 v157, v194, v195
    v_cvt_pk_bf16_f32 v158, v196, v197
    v_cvt_pk_bf16_f32 v159, v198, v199
    v_cvt_pk_bf16_f32 v160, v200, v201
    v_cvt_pk_bf16_f32 v161, v202, v203
    v_cvt_pk_bf16_f32 v162, v204, v205
    v_cvt_pk_bf16_f32 v163, v206, v207
    v_cvt_pk_bf16_f32 v164, v208, v209
    v_cvt_pk_bf16_f32 v165, v210, v211
    v_cvt_pk_bf16_f32 v166, v212, v213
    v_cvt_pk_bf16_f32 v167, v214, v215
    v_and_b32 v30, 2, v1
    v_cmp_ne_u32 vcc, 0, v30
    v_mul_u32_u24 v30, 1152, v7
    v_add_u32 v4, v30, v5
    v_add_u32 v58, v30, v59
    v_mov_b32_dpp v192, v158 quad_perm:[0,2,0,2] row_mask:0xf bank_mask:0xf
    v_mov_b32_dpp v193, v159 quad_perm:[0,2,0,2] row_mask:0xf bank_mask:0xf
    v_mov_b32_dpp v194, v158 quad_perm:[1,3,1,3] row_mask:0xf bank_mask:0xf
    v_mov_b32_dpp v195, v159 quad_perm:[1,3,1,3] row_mask:0xf bank_mask:0xf
    v_mov_b32_dpp v196, v162 quad_perm:[0,2,0,2] row_mask:0xf bank_mask:0xf
    v_mov_b32_dpp v197, v163 quad_perm:[0,2,0,2] row_mask:0xf bank_mask:0xf
    v_mov_b32_dpp v198, v162 quad_perm:[1,3,1,3] row_mask:0xf bank_mask:0xf
    v_mov_b32_dpp v199, v163 quad_perm:[1,3,1,3] row_mask:0xf bank_mask:0xf
    v_mov_b32_dpp v200, v166 quad_perm:[0,2,0,2] row_mask:0xf bank_mask:0xf
    v_mov_b32_dpp v201, v167 quad_perm:[0,2,0,2] row_mask:0xf bank_mask:0xf
    v_mov_b32_dpp v202, v166 quad_perm:[1,3,1,3] row_mask:0xf bank_mask:0xf
    v_mov_b32_dpp v203, v167 quad_perm:[1,3,1,3] row_mask:0xf bank_mask:0xf
    v_cndmask_b32_dpp v144, v156, v192, vcc quad_perm:[0,2,0,2] row_mask:0xf bank_mask:0xf
    v_cndmask_b32_dpp v145, v157, v193, vcc quad_perm:[0,2,0,2] row_mask:0xf bank_mask:0xf
    v_cndmask_b32_dpp v146, v156, v194, vcc quad_perm:[1,3,1,3] row_mask:0xf bank_mask:0xf
    v_cndmask_b32_dpp v147, v157, v195, vcc quad_perm:[1,3,1,3] row_mask:0xf bank_mask:0xf
    v_cndmask_b32_dpp v148, v160, v196, vcc quad_perm:[0,2,0,2] row_mask:0xf bank_mask:0xf
    v_cndmask_b32_dpp v149, v161, v197, vcc quad_perm:[0,2,0,2] row_mask:0xf bank_mask:0xf
    v_cndmask_b32_dpp v150, v160, v198, vcc quad_perm:[1,3,1,3] row_mask:0xf bank_mask:0xf
    v_cndmask_b32_dpp v151, v161, v199, vcc quad_perm:[1,3,1,3] row_mask:0xf bank_mask:0xf
    v_cndmask_b32_dpp v152, v164, v200, vcc quad_perm:[0,2,0,2] row_mask:0xf bank_mask:0xf
    v_cndmask_b32_dpp v153, v165, v201, vcc quad_perm:[0,2,0,2] row_mask:0xf bank_mask:0xf
    v_cndmask_b32_dpp v154, v164, v202, vcc quad_perm:[1,3,1,3] row_mask:0xf bank_mask:0xf
    v_cndmask_b32_dpp v155, v165, v203, vcc quad_perm:[1,3,1,3] row_mask:0xf bank_mask:0xf
    buffer_store_dwordx4 v[144:147], v4, s[16:19], 0 offen offset:0 sc1
    buffer_store_dwordx4 v[148:151], v4, s[16:19], 0 offen offset:512 sc1
    buffer_store_dwordx4 v[152:155], v58, s[16:19], 0 offen offset:1024 sc1
    s_waitcnt vmcnt(0)
    s_mov_b32 s36, 2622592
    buffer_store_dwordx4 v[36:39], v6, s[24:27], s36 offen offset:0 sc1
    buffer_store_dwordx4 v[40:43], v6, s[24:27], s36 offen offset:512 sc1
    buffer_store_dwordx4 v[44:47], v60, s[24:27], s36 offen offset:1024 sc1
Ltail_done:
    s_endpgm
Lattn_wb:
    buffer_wbl2 sc1
    s_waitcnt vmcnt(0)
    s_branch Lattn_wbdone
Lattn_xspin:
Ltour15:
    s_cbranch_execz Lmain
    s_mov_b32 s37, 262144
Lattn_xloop:
    buffer_load_dword v11, v8, s[24:27], s54 offen offset:8 sc1
    s_waitcnt vmcnt(0)
    v_readfirstlane_b32 s36, v11
    s_sub_u32 s37, s37, 1
    s_cbranch_scc1 Lattn_xgot
    s_cmp_lg_u32 s36, s95
    s_cbranch_scc1 Lattn_xloop
    s_branch Lattn_xgot
Ltail_spin1:
Ltour16:
    s_cbranch_execz Lmain
    s_mov_b32 s48, 262144
Ltail_spinl1:
    buffer_load_dword v11, v9, s[24:27], s39 offen sc1
    s_waitcnt vmcnt(0)
    v_cmp_ne_u32 s[54:55], s95, v11
    s_sub_u32 s48, s48, 1
    s_cbranch_scc1 Ltail_got1
    s_cmp_lg_u64 s[54:55], 0
    s_cbranch_scc1 Ltail_spinl1
    s_branch Ltail_got1
Ltail_spin2:
Ltour17:
    s_cbranch_execz Lmain
    s_mov_b32 s48, 262144
Ltail_spinl2:
    buffer_load_dword v11, v9, s[24:27], s39 offen sc1
    s_waitcnt vmcnt(0)
    v_cmp_ne_u32 s[54:55], s95, v11
    s_sub_u32 s48, s48, 1
    s_cbranch_scc1 Ltail_got2
    s_cmp_lg_u64 s[54:55], 0
    s_cbranch_scc1 Ltail_spinl2
    s_branch Ltail_got2
Lattn_redo:
    v_xor_b32 v8, 64, v9
    v_xor_b32 v10, 64, v11
    s_waitcnt vmcnt(0) lgkmcnt(0)
    s_barrier
    v_mov_b32 v232, 0xff800000
    v_mov_b32 v233, 0xff800000
    v_mov_b32 v234, 0xff800000
    v_mov_b32 v235, 0xff800000
    s_mov_b32 s40, 0
    s_mov_b32 s48, -1
Lattn_redo_loop:
    s_add_u32 m0, s42, 0
    s_nop 0
    buffer_load_dwordx4 v36, s[8:11], s40 offen lds
    buffer_load_dwordx4 v37, s[8:11], s40 offen offset:1024 lds
    buffer_load_dwordx4 v38, s[8:11], s40 offen offset:2048 lds
    buffer_load_dwordx4 v39, s[8:11], s40 offen offset:3072 lds
    s_add_u32 s40, s40, 16384
    s_waitcnt vmcnt(0) lgkmcnt(0)
    s_barrier
    ds_read_b128 a[208:211], v8 offset:0
    ds_read_b128 a[212:215], v9 offset:0
    ds_read_b128 a[216:219], v10 offset:0
    ds_read_b128 a[220:223], v11 offset:0
    s_waitcnt lgkmcnt(3)
    v_mfma_f32_16x16x32_bf16 v[216:219], a[208:211], v[64:67], 0
    s_waitcnt lgkmcnt(2)
    v_mfma_f32_16x16x32_bf16 v[216:219], a[212:215], v[68:71], v[216:219]
    s_waitcnt lgkmcnt(1)
    v_mfma_f32_16x16x32_bf16 v[216:219], a[216:219], v[72:75], v[216:219]
    s_waitcnt lgkmcnt(0)
    v_mfma_f32_16x16x32_bf16 v[216:219], a[220:223], v[76:79], v[216:219]
    v_mfma_f32_16x16x32_bf16 v[220:223], a[208:211], v[80:83], 0
    v_mfma_f32_16x16x32_bf16 v[220:223], a[212:215], v[84:87], v[220:223]
    v_mfma_f32_16x16x32_bf16 v[220:223], a[216:219], v[88:91], v[220:223]
    v_mfma_f32_16x16x32_bf16 v[220:223], a[220:223], v[92:95], v[220:223]
    v_mfma_f32_16x16x32_bf16 v[224:227], a[208:211], v[96:99], 0
    v_mfma_f32_16x16x32_bf16 v[224:227], a[212:215], v[100:103], v[224:227]
    v_mfma_f32_16x16x32_bf16 v[224:227], a[216:219], v[104:107], v[224:227]
    v_mfma_f32_16x16x32_bf16 v[224:227], a[220:223], v[108:111], v[224:227]
    v_mfma_f32_16x16x32_bf16 v[228:231], a[208:211], v[112:115], 0
    v_mfma_f32_16x16x32_bf16 v[228:231], a[212:215], v[116:119], v[228:231]
    v_mfma_f32_16x16x32_bf16 v[228:231], a[216:219], v[120:123], v[228:231]
    v_mfma_f32_16x16x32_bf16 v[228:231], a[220:223], v[124:127], v[228:231]
    v_max3_f32 v232, v232, v216, v217
    v_max3_f32 v232, v232, v218, v219
    v_max3_f32 v233, v233, v220, v221
    v_max3_f32 v233, v233, v222, v223
    v_max3_f32 v234, v234, v224, v225
    v_max3_f32 v234, v234, v226, v227
    s_nop 1
    v_max3_f32 v235, v235, v228, v229
    v_max3_f32 v235, v235, v230, v231
    ds_read_b128 a[224:227], v8 offset:4096
    ds_read_b128 a[228:231], v9 offset:4096
    ds_read_b128 a[232:235], v10 offset:4096
    ds_read_b128 a[236:239], v11 offset:4096
    s_waitcnt lgkmcnt(3)
    v_mfma_f32_16x16x32_bf16 v[216:219], a[224:227], v[64:67], 0
    s_waitcnt lgkmcnt(2)
    v_mfma_f32_16x16x32_bf16 v[216:219], a[228:231], v[68:71], v[216:219]
    s_waitcnt lgkmcnt(1)
    v_mfma_f32_16x16x32_bf16 v[216:219], a[232:235], v[72:75], v[216:219]
    s_waitcnt lgkmcnt(0)
    v_mfma_f32_16x16x32_bf16 v[216:219], a[236:239], v[76:79], v[216:219]
    v_mfma_f32_16x16x32_bf16 v[220:223], a[224:227], v[80:83], 0
    v_mfma_f32_16x16x32_bf16 v[220:223], a[228:231], v[84:87], v[220:223]
    v_mfma_f32_16x16x32_bf16 v[220:223], a[232:235], v[88:91], v[220:223]
    v_mfma_f32_16x16x32_bf16 v[220:223], a[236:239], v[92:95], v[220:223]
    v_mfma_f32_16x16x32_bf16 v[224:227], a[224:227], v[96:99], 0
    v_mfma_f32_16x16x32_bf16 v[224:227], a[228:231], v[100:103], v[224:227]
    v_mfma_f32_16x16x32_bf16 v[224:227], a[232:235], v[104:107], v[224:227]
    v_mfma_f32_16x16x32_bf16 v[224:227], a[236:239], v[108:111], v[224:227]
    v_mfma_f32_16x16x32_bf16 v[228:231], a[224:227], v[112:115], 0
    v_mfma_f32_16x16x32_bf16 v[228:231], a[228:231], v[116:119], v[228:231]
    v_mfma_f32_16x16x32_bf16 v[228:231], a[232:235], v[120:123], v[228:231]
    v_mfma_f32_16x16x32_bf16 v[228:231], a[236:239], v[124:127], v[228:231]
    v_max3_f32 v232, v232, v216, v217
    v_max3_f32 v232, v232, v218, v219
    v_max3_f32 v233, v233, v220, v221
    v_max3_f32 v233, v233, v222, v223
    v_max3_f32 v234, v234, v224, v225
    v_max3_f32 v234, v234, v226, v227
    s_nop 1
    v_max3_f32 v235, v235, v228, v229
    v_max3_f32 v235, v235, v230, v231
    ds_read_b128 a[208:211], v8 offset:8192
    ds_read_b128 a[212:215], v9 offset:8192
    ds_read_b128 a[216:219], v10 offset:8192
    ds_read_b128 a[220:223], v11 offset:8192
    s_waitcnt lgkmcnt(3)
    v_mfma_f32_16x16x32_bf16 v[216:219], a[208:211], v[64:67], 0
    s_waitcnt lgkmcnt(2)
    v_mfma_f32_16x16x32_bf16 v[216:219], a[212:215], v[68:71], v[216:219]
    s_waitcnt lgkmcnt(1)
    v_mfma_f32_16x16x32_bf16 v[216:219], a[216:219], v[72:75], v[216:219]
    s_waitcnt lgkmcnt(0)
    v_mfma_f32_16x16x32_bf16 v[216:219], a[220:223], v[76:79], v[216:219]
    v_mfma_f32_16x16x32_bf16 v[220:223], a[208:211], v[80:83], 0
    v_mfma_f32_16x16x32_bf16 v[220:223], a[212:215], v[84:87], v[220:223]
    v_mfma_f32_16x16x32_bf16 v[220:223], a[216:219], v[88:91], v[220:223]
    v_mfma_f32_16x16x32_bf16 v[220:223], a[220:223], v[92:95], v[220:223]
    v_mfma_f32_16x16x32_bf16 v[224:227], a[208:211], v[96:99], 0
    v_mfma_f32_16x16x32_bf16 v[224:227], a[212:215], v[100:103], v[224:227]
    v_mfma_f32_16x16x32_bf16 v[224:227], a[216:219], v[104:107], v[224:227]
    v_mfma_f32_16x16x32_bf16 v[224:227], a[220:223], v[108:111], v[224:227]
    v_mfma_f32_16x16x32_bf16 v[228:231], a[208:211], v[112:115], 0
    v_mfma_f32_16x16x32_bf16 v[228:231], a[212:215], v[116:119], v[228:231]
    v_mfma_f32_16x16x32_bf16 v[228:231], a[216:219], v[120:123], v[228:231]
    v_mfma_f32_16x16x32_bf16 v[228:231], a[220:223], v[124:127], v[228:231]
    v_max3_f32 v232, v232, v216, v217
    v_max3_f32 v232, v232, v218, v219
    v_max3_f32 v233, v233, v220, v221
    v_max3_f32 v233, v233, v222, v223
    v_max3_f32 v234, v234, v224, v225
    v_max3_f32 v234, v234, v226, v227
    s_nop 1
    v_max3_f32 v235, v235, v228, v229
    v_max3_f32 v235, v235, v230, v231
    ds_read_b128 a[224:227], v8 offset:12288
    ds_read_b128 a[228:231], v9 offset:12288
    ds_read_b128 a[232:235], v10 offset:12288
    ds_read_b128 a[236:239], v11 offset:12288
    s_waitcnt lgkmcnt(3)
    v_mfma_f32_16x16x32_bf16 v[216:219], a[224:227], v[64:67], 0
    s_waitcnt lgkmcnt(2)
    v_mfma_f32_16x16x32_bf16 v[216:219], a[228:231], v[68:71], v[216:219]
    s_waitcnt lgkmcnt(1)
    v_mfma_f32_16x16x32_bf16 v[216:219], a[232:235], v[72:75], v[216:219]
    s_waitcnt lgkmcnt(0)
    v_mfma_f32_16x16x32_bf16 v[216:219], a[236:239], v[76:79], v[216:219]
    v_mfma_f32_16x16x32_bf16 v[220:223], a[224:227], v[80:83], 0
    v_mfma_f32_16x16x32_bf16 v[220:223], a[228:231], v[84:87], v[220:223]
    v_mfma_f32_16x16x32_bf16 v[220:223], a[232:235], v[88:91], v[220:223]
    v_mfma_f32_16x16x32_bf16 v[220:223], a[236:239], v[92:95], v[220:223]
    v_mfma_f32_16x16x32_bf16 v[224:227], a[224:227], v[96:99], 0
    v_mfma_f32_16x16x32_bf16 v[224:227], a[228:231], v[100:103], v[224:227]
    v_mfma_f32_16x16x32_bf16 v[224:227], a[232:235], v[104:107], v[224:227]
    v_mfma_f32_16x16x32_bf16 v[224:227], a[236:239], v[108:111], v[224:227]
    v_mfma_f32_16x16x32_bf16 v[228:231], a[224:227], v[112:115], 0
    v_mfma_f32_16x16x32_bf16 v[228:231], a[228:231], v[116:119], v[228:231]
    v_mfma_f32_16x16x32_bf16 v[228:231], a[232:235], v[120:123], v[228:231]
    v_mfma_f32_16x16x32_bf16 v[228:231], a[236:239], v[124:127], v[228:231]
    v_max3_f32 v232, v232, v216, v217
    v_max3_f32 v232, v232, v218, v219
    v_max3_f32 v233, v233, v220, v221
    v_max3_f32 v233, v233, v222, v223
    v_max3_f32 v234, v234, v224, v225
    v_max3_f32 v234, v234, v226, v227
    s_nop 1
    v_max3_f32 v235, v235, v228, v229
    v_max3_f32 v235, v235, v230, v231
    s_barrier
    s_cmp_lt_u32 s40, 524288
    s_cbranch_scc1 Lattn_redo_loop
    v_mov_b32 v236, v232
    v_mov_b32 v237, v233
    v_mov_b32 v238, v234
    v_mov_b32 v239, v235
    v_permlane16_swap_b32 v232, v236
    v_permlane16_swap_b32 v233, v237
    v_permlane16_swap_b32 v234, v238
    v_permlane16_swap_b32 v235, v239
    v_max_f32 v232, v232, v236
    v_max_f32 v233, v233, v237
    v_max_f32 v234, v234, v238
    v_max_f32 v235, v235, v239
    v_mov_b32 v236, v232
    v_mov_b32 v237, v233
    v_mov_b32 v238, v234
    v_mov_b32 v239, v235
    v_permlane32_swap_b32 v232, v236
    v_permlane32_swap_b32 v233, v237
    v_permlane32_swap_b32 v234, v238
    v_permlane32_swap_b32 v235, v239
    v_max_f32 v232, v232, v236
    v_max_f32 v233, v233, v237
    v_max_f32 v234, v234, v238
    v_max_f32 v235, v235, v239
    v_sub_f32 v192, 0, v232
    v_sub_f32 v193, 0, v232
    v_sub_f32 v194, 0, v232
    v_sub_f32 v195, 0, v232
    v_sub_f32 v196, 0, v233
    v_sub_f32 v197, 0, v233
    v_sub_f32 v198, 0, v233
    v_sub_f32 v199, 0, v233
    v_sub_f32 v200, 0, v234
    v_sub_f32 v201, 0, v234
    v_sub_f32 v202, 0, v234
    v_sub_f32 v203, 0, v234
    v_sub_f32 v204, 0, v235
    v_sub_f32 v205, 0, v235
    v_sub_f32 v206, 0, v235
    v_sub_f32 v207, 0, v235
    s_mov_b32 s40, 0
    s_mov_b32 s41, 0
    s_add_u32 m0, s42, 0
    s_nop 0
    buffer_load_dwordx4 v36, s[8:11], s40 offen lds
    buffer_load_dwordx4 v37, s[8:11], s40 offen offset:1024 lds
    buffer_load_dwordx4 v38, s[8:11], s40 offen offset:2048 lds
    buffer_load_dwordx4 v39, s[8:11], s40 offen offset:3072 lds
    s_add_u32 s40, s40, 16384
    s_add_u32 m0, s42, 16384
    s_nop 0
    buffer_load_dwordx4 v36, s[8:11], s40 offen lds
    buffer_load_dwordx4 v37, s[8:11], s40 offen offset:1024 lds
    buffer_load_dwordx4 v38, s[8:11], s40 offen offset:2048 lds
    buffer_load_dwordx4 v39, s[8:11], s40 offen offset:3072 lds
    s_add_u32 s40, s40, 16384
    s_add_u32 m0, s42, 32768
    s_nop 0
    buffer_load_dwordx4 v36, s[8:11], s40 offen lds
    buffer_load_dwordx4 v37, s[8:11], s40 offen offset:1024 lds
    buffer_load_dwordx4 v38, s[8:11], s40 offen offset:2048 lds
    buffer_load_dwordx4 v39, s[8:11], s40 offen offset:3072 lds
    s_add_u32 s40, s40, 16384
    s_add_u32 m0, s42, 65536
    s_nop 0
    buffer_load_dwordx4 v40, s[12:15], s41 offen lds
    buffer_load_dwordx4 v41, s[12:15], s41 offen offset:1024 lds
    buffer_load_dwordx4 v40, s[12:15], s41 offen offset:2048 lds
    buffer_load_dwordx4 v41, s[12:15], s41 offen offset:3072 lds
    s_add_u32 s41, s41, 16384
    s_add_u32 m0, s42, 81920
    s_nop 0
    buffer_load_dwordx4 v40, s[12:15], s41 offen lds
    buffer_load_dwordx4 v41, s[12:15], s41 offen offset:1024 lds
    buffer_load_dwordx4 v40, s[12:15], s41 offen offset:2048 lds
    buffer_load_dwordx4 v41, s[12:15], s41 offen offset:3072 lds
    s_add_u32 s41, s41, 16384
    v_accvgpr_write_b32 a0, 0
    v_accvgpr_write_b32 a1, 0
    v_accvgpr_write_b32 a2, 0
    v_accvgpr_write_b32 a3, 0
    v_accvgpr_write_b32 a4, 0
    v_accvgpr_write_b32 a5, 0
    v_accvgpr_write_b32 a6, 0
    v_accvgpr_write_b32 a7, 0
    v_accvgpr_write_b32 a8, 0
    v_accvgpr_write_b32 a9, 0
    v_accvgpr_write_b32 a10, 0
    v_accvgpr_write_b32 a11, 0
    v_accvgpr_write_b32 a12, 0
    v_accvgpr_write_b32 a13, 0
    v_accvgpr_write_b32 a14, 0
    v_accvgpr_write_b32 a15, 0
    v_accvgpr_write_b32 a16, 0
    v_accvgpr_write_b32 a17, 0
    v_accvgpr_write_b32 a18, 0
    v_accvgpr_write_b32 a19, 0
    v_accvgpr_write_b32 a20, 0
    v_accvgpr_write_b32 a21, 0
    v_accvgpr_write_b32 a22, 0
    v_accvgpr_write_b32 a23, 0
    v_accvgpr_write_b32 a24, 0
    v_accvgpr_write_b32 a25, 0
    v_accvgpr_write_b32 a26, 0
    v_accvgpr_write_b32 a27, 0
    v_accvgpr_write_b32 a28, 0
    v_accvgpr_write_b32 a29, 0
    v_accvgpr_write_b32 a30, 0
    v_accvgpr_write_b32 a31, 0
    v_accvgpr_write_b32 a32, 0
    v_accvgpr_write_b32 a33, 0
    v_accvgpr_write_b32 a34, 0
    v_accvgpr_write_b32 a35, 0
    v_accvgpr_write_b32 a36, 0
    v_accvgpr_write_b32 a37, 0
    v_accvgpr_write_b32 a38, 0
    v_accvgpr_write_b32 a39, 0
    v_accvgpr_write_b32 a40, 0
    v_accvgpr_write_b32 a41, 0
    v_accvgpr_write_b32 a42, 0
    v_accvgpr_write_b32 a43, 0
    v_accvgpr_write_b32 a44, 0
    v_accvgpr_write_b32 a45, 0
    v_accvgpr_write_b32 a46, 0
    v_accvgpr_write_b32 a47, 0
    v_accvgpr_write_b32 a48, 0
    v_accvgpr_write_b32 a49, 0
    v_accvgpr_write_b32 a50, 0
    v_accvgpr_write_b32 a51, 0
    v_accvgpr_write_b32 a52, 0
    v_accvgpr_write_b32 a53, 0
    v_accvgpr_write_b32 a54, 0
    v_accvgpr_write_b32 a55, 0
    v_accvgpr_write_b32 a56, 0
    v_accvgpr_write_b32 a57, 0
    v_accvgpr_write_b32 a58, 0
    v_accvgpr_write_b32 a59, 0
    v_accvgpr_write_b32 a60, 0
    v_accvgpr_write_b32 a61, 0
    v_accvgpr_write_b32 a62, 0
    v_accvgpr_write_b32 a63, 0
    v_accvgpr_write_b32 a64, 0
    v_accvgpr_write_b32 a65, 0
    v_accvgpr_write_b32 a66, 0
    v_accvgpr_write_b32 a67, 0
    v_accvgpr_write_b32 a68, 0
    v_accvgpr_write_b32 a69, 0
    v_accvgpr_write_b32 a70, 0
    v_accvgpr_write_b32 a71, 0
    v_accvgpr_write_b32 a72, 0
    v_accvgpr_write_b32 a73, 0
    v_accvgpr_write_b32 a74, 0
    v_accvgpr_write_b32 a75, 0
    v_accvgpr_write_b32 a76, 0
    v_accvgpr_write_b32 a77, 0
    v_accvgpr_write_b32 a78, 0
    v_accvgpr_write_b32 a79, 0
    v_accvgpr_write_b32 a80, 0
    v_accvgpr_write_b32 a81, 0
    v_accvgpr_write_b32 a82, 0
    v_accvgpr_write_b32 a83, 0
    v_accvgpr_write_b32 a84, 0
    v_accvgpr_write_b32 a85, 0
    v_accvgpr_write_b32 a86, 0
    v_accvgpr_write_b32 a87, 0
    v_accvgpr_write_b32 a88, 0
    v_accvgpr_write_b32 a89, 0
    v_accvgpr_write_b32 a90, 0
    v_accvgpr_write_b32 a91, 0
    v_accvgpr_write_b32 a92, 0
    v_accvgpr_write_b32 a93, 0
    v_accvgpr_write_b32 a94, 0
    v_accvgpr_write_b32 a95, 0
    v_accvgpr_write_b32 a96, 0
    v_accvgpr_write_b32 a97, 0
    v_accvgpr_write_b32 a98, 0
    v_accvgpr_write_b32 a99, 0
    v_accvgpr_write_b32 a100, 0
    v_accvgpr_write_b32 a101, 0
    v_accvgpr_write_b32 a102, 0
    v_accvgpr_write_b32 a103, 0
    v_accvgpr_write_b32 a104, 0
    v_accvgpr_write_b32 a105, 0
    v_accvgpr_write_b32 a106, 0
    v_accvgpr_write_b32 a107, 0
    v_accvgpr_write_b32 a108, 0
    v_accvgpr_write_b32 a109, 0
    v_accvgpr_write_b32 a110, 0
    v_accvgpr_write_b32 a111, 0
    v_accvgpr_write_b32 a112, 0
    v_accvgpr_write_b32 a113, 0
    v_accvgpr_write_b32 a114, 0
    v_accvgpr_write_b32 a115, 0
    v_accvgpr_write_b32 a116, 0
    v_accvgpr_write_b32 a117, 0
    v_accvgpr_write_b32 a118, 0
    v_accvgpr_write_b32 a119, 0
    v_accvgpr_write_b32 a120, 0
    v_accvgpr_write_b32 a121, 0
    v_accvgpr_write_b32 a122, 0
    v_accvgpr_write_b32 a123, 0
    v_accvgpr_write_b32 a124, 0
    v_accvgpr_write_b32 a125, 0
    v_accvgpr_write_b32 a126, 0
    v_accvgpr_write_b32 a127, 0
    v_accvgpr_write_b32 a192, 0
    v_accvgpr_write_b32 a193, 0
    v_accvgpr_write_b32 a194, 0
    v_accvgpr_write_b32 a195, 0
    v_accvgpr_write_b32 a196, 0
    v_accvgpr_write_b32 a197, 0
    v_accvgpr_write_b32 a198, 0
    v_accvgpr_write_b32 a199, 0
    v_accvgpr_write_b32 a200, 0
    v_accvgpr_write_b32 a201, 0
    v_accvgpr_write_b32 a202, 0
    v_accvgpr_write_b32 a203, 0
    v_accvgpr_write_b32 a204, 0
    v_accvgpr_write_b32 a205, 0
    v_accvgpr_write_b32 a206, 0
    v_accvgpr_write_b32 a207, 0
    s_waitcnt vmcnt(0) lgkmcnt(0)
    s_barrier
    ds_read_b128 a[208:211], v8 offset:0
    ds_read_b128 a[212:215], v9 offset:0
    ds_read_b128 a[216:219], v10 offset:0
    ds_read_b128 a[220:223], v11 offset:0
    ds_read_b128 a[224:227], v8 offset:4096
    s_waitcnt vmcnt(0) lgkmcnt(0)
    s_branch Lattn_stage0
Lattn_armwait:
    s_mov_b32 s36, 262144
Lattn_armloop:
    v_mov_b32 v63, 0
    buffer_load_dword v63, v63, s[88:91], 0 offen sc1
    s_waitcnt vmcnt(0)
    v_readfirstlane_b32 s37, v63
    s_sub_u32 s36, s36, 1
    s_cbranch_scc1 Lattn_armed
    s_cmp_lt_u32 s37, 256
    s_cbranch_scc1 Lattn_armloop
    s_branch Lattn_armed
Lattn_end:
    s_endpgm
.section .rodata,"a"
.p2align 6
.amdhsa_kernel adaLN_cond__gqa_block_cached__moe_arch_mod__prompt_kernel
  .amdhsa_next_free_vgpr 512
  .amdhsa_next_free_sgpr 102
  .amdhsa_accum_offset 256
  .amdhsa_group_segment_fixed_size 0
  .amdhsa_kernarg_size 120
  .amdhsa_user_sgpr_count 2
  .amdhsa_user_sgpr_kernarg_segment_ptr 1
  .amdhsa_system_sgpr_workgroup_id_x 1
  .amdhsa_float_denorm_mode_32 3
.end_amdhsa_kernel
```

```asm
; @launch grid=(256,1,1) block=(256,1,1) lds=163840
.amdgcn_target "amdgcn-amd-amdhsa--gfx950"
.text
.globl adaLN_cond__gqa_block_cached__moe_arch_mod__prompt_kernel
.p2align 8
.type adaLN_cond__gqa_block_cached__moe_arch_mod__prompt_kernel,@function
adaLN_cond__gqa_block_cached__moe_arch_mod__prompt_kernel:
    s_cmp_ge_u32 s2, 256
    s_cbranch_scc1 Lattn_end
    s_load_dwordx2 s[8:9], s[0:1], 80
    s_load_dwordx2 s[12:13], s[0:1], 88
    s_load_dwordx2 s[20:21], s[0:1], 0
    s_load_dwordx2 s[50:51], s[0:1], 112
    s_load_dwordx8 s[52:59], s[0:1], 8
    s_load_dwordx4 s[80:83], s[0:1], 56
    s_load_dwordx2 s[84:85], s[0:1], 72
    s_load_dwordx2 s[88:89], s[0:1], 104
    s_load_dwordx2 s[28:29], s[0:1], 48
    s_getpc_b64 s[32:33]
Lattn_pc:
    s_mov_b32 s34, Lattn_end-Lattn_pc
    s_mov_b32 s35, 0x20000
    s_lshr_b32 s6, s2, 3
    s_lshl_b32 s7, s6, 6
    v_lshrrev_b32 v3, 6, v0
    v_and_b32 v1, 63, v0
    v_lshrrev_b32 v2, 2, v0
    v_lshlrev_b32 v2, 11, v2
    v_readfirstlane_b32 s3, v3
    buffer_load_dword v240, v2, s[32:35], s7 offen
    s_and_b32 s7, s2, 7
    s_lshl_b32 s4, s7, 1
    s_and_b32 s5, s6, 1
    s_add_u32 s4, s4, s5
    s_lshr_b32 s5, s2, 4
    s_lshr_b32 s38, s6, 2
    s_lshl_b32 s38, s38, 3
    s_add_u32 s38, s38, s7
    s_cmp_lt_u32 s38, 18
    s_cselect_b32 s39, 0, 2147483648
    s_lshl_b32 s38, s38, 2
    s_and_b32 s36, s6, 3
    s_add_u32 s38, s38, s36
    s_mov_b32 s14, 3981312
    s_mul_i32 s92, s6, 124416
    s_lshl_b32 s36, s7, 7
    s_add_u32 s92, s92, s36
    s_cmp_lt_u32 s7, 2
    s_cselect_b32 s36, 53, 35
    v_lshrrev_b32 v2, 2, v0
    v_min_u32 v2, s36, v2
    v_mul_u32_u24 v3, 57, v2
    v_lshrrev_b32 v3, 10, v3
    v_mul_i32_i24 v3, -123392, v3
    v_mul_u32_u24 v2, 6912, v2
    v_add_u32 v72, v2, v3
    s_mov_b32 s15, 0x20000
    s_mov_b32 s10, 1152
    s_mov_b32 s11, 0x20000
    s_mov_b32 s22, 2359296
    s_mov_b32 s23, 0x20000
    v_and_b32 v64, 0xfe, v0
    v_mul_u32_u24 v65, 3456, v64
    v_and_b32 v2, 1, v0
    v_lshl_add_u32 v65, v2, 4, v65
    s_lshl_b32 s36, s38, 5
    s_or_b32 s36, s36, s39
    v_and_b32 v4, 31, v1
    v_lshrrev_b32 v5, 5, v1
    v_cmp_gt_u32 vcc, 24, v4
    v_mov_b32 v6, 2147483648
    s_lshl_b32 s7, s5, 4
    s_add_u32 s7, s7, s4
    s_lshl_b32 s7, s7, 2
    s_add_u32 s7, s7, s3
    v_cndmask_b32 v6, v6, 0, vcc
    s_mul_i32 s49, s7, 2304
    v_lshrrev_b32 v7, 2, v4
    v_lshl_add_u32 v7, v7, 6, v6
    v_and_b32 v2, 3, v4
    v_lshl_add_u32 v7, v2, 3, v7
    v_mul_u32_u24 v2, 1152, v5
    v_add_u32 v66, v7, v2
    s_waitcnt lgkmcnt(0)
    s_load_dword s94, s[50:51], 24576
    buffer_load_dword v241, v72, s[12:15], s92 offen
    buffer_load_ushort v80, v64, s[8:11], 0 offen offset:0
    buffer_load_ushort v81, v64, s[8:11], 0 offen offset:256
    buffer_load_ushort v82, v64, s[8:11], 0 offen offset:512
    buffer_load_ushort v83, v64, s[8:11], 0 offen offset:768
    buffer_load_ushort v84, v64, s[8:11], 0 offen offset:1024
    buffer_load_dwordx4 v[88:91], v65, s[12:15], s36 offen
    s_add_u32 s36, s36, 884736
    buffer_load_dwordx4 v[92:95], v65, s[12:15], s36 offen
    s_add_u32 s36, s36, 884736
    buffer_load_dwordx4 v[96:99], v65, s[12:15], s36 offen
    s_add_u32 s36, s36, 884736
    buffer_load_dwordx4 v[100:103], v65, s[12:15], s36 offen
    s_add_u32 s36, s36, 884736
    buffer_load_dwordx4 v[104:107], v65, s[12:15], s36 offen
    s_mov_b32 s16, s56
    s_mov_b32 s17, s57
    s_mov_b32 s18, 4718592
    s_mov_b32 s19, 0x20000
    s_lshl_b32 s44, s4, 9
    s_mul_i32 s36, s5, 98304
    s_add_u32 s36, s36, 0
    v_lshrrev_b32 v2, 2, v0
    v_min_u32 v2, 47, v2
    v_lshrrev_b32 v3, 2, v2
    v_and_b32 v2, 3, v2
    v_lshl_add_u32 v2, v2, 7, s36
    v_lshl_add_u32 v71, v3, 13, v2
    s_mul_i32 s36, s5, 196608
    s_add_u32 s36, s36, 1572864
    v_lshrrev_b32 v2, 1, v0
    v_min_u32 v2, 95, v2
    v_lshrrev_b32 v3, 2, v2
    v_and_b32 v2, 3, v2
    v_lshl_add_u32 v2, v2, 7, s36
    v_lshl_add_u32 v70, v3, 13, v2
    s_add_u32 s92, s49, 65536
    v_lshl_add_u32 v7, v5, 4, v6
    v_lshl_add_u32 v67, v4, 5, v7
    v_min_u32 v4, 23, v4
    v_lshlrev_b32 v68, 4, v4
    s_mov_b32 s24, s50
    s_mov_b32 s25, s51
    s_mov_b32 s26, 10485760
    s_mov_b32 s27, 0x20000
    s_mov_b32 s90, 256
    s_mov_b32 s91, 0x20000
    s_cmp_ge_u32 s38, 36
    s_cselect_b32 s93, 1.0, 0
    s_lshl_b32 s36, s38, 7
    v_lshl_add_u32 v69, v0, 3, s36
    v_cmp_gt_u32 s[36:37], 16, v0
    v_mov_b32 v2, 2147483648
    v_mov_b32 v3, s39
    v_cndmask_b32 v2, v2, v3, s[36:37]
    v_or_b32 v69, v69, v2
    s_mul_i32 s36, s5, 3072
    s_lshl_b32 s37, s5, 11
    v_lshrrev_b32 v120, 3, v0
    v_min_u32 v120, 23, v120
    v_lshl_add_u32 v120, v120, 7, s36
    v_lshrrev_b32 v121, 4, v0
    v_lshl_add_u32 v121, v121, 7, s37
    s_lshl_b32 s42, s3, 12
    v_lshrrev_b32 v2, 4, v1
    v_and_b32 v3, 15, v1
    v_lshrrev_b32 v5, 1, v3
    v_mul_u32_u24 v5, 2304, v5
    v_lshl_add_u32 v5, v2, 5, v5
    v_and_b32 v6, 1, v3
    v_lshl_add_u32 v51, v6, 4, v5
    s_lshl_b32 s6, s5, 2
    s_add_u32 s6, s6, s3
    s_mul_i32 s46, s6, 36864
    s_add_u32 s46, s46, 65536
    s_add_u32 s43, s46, 18432
    s_mul_i32 s45, s4, 294912
    s_lshl_b32 s7, s3, 4
    v_add_u32 v4, s7, v2
    v_lshlrev_b32 v5, 1, v2
    v_xor_b32 v5, v5, v3
    v_xor_b32 v6, 8, v5
    v_lshlrev_b32 v7, 13, v4
    v_lshl_add_u32 v42, v5, 4, v7
    v_lshl_add_u32 v43, v6, 4, v7
    v_add_u32 v44, 63488, v42
    v_add_u32 v45, 95232, v43
    v_add_u32 v43, 31744, v43
    s_lshl_b32 s7, s4, 19
    s_add_u32 s8, s52, s7
    s_addc_u32 s9, s53, 0
    s_mov_b32 s10, 524288
    s_mov_b32 s11, 0x20000
    s_add_u32 s12, s54, s7
    s_addc_u32 s13, s55, 0
    s_mov_b32 s14, 524288
    s_mov_b32 s15, 0x20000
    s_add_u32 s28, s50, 10485760
    s_addc_u32 s29, s51, 0
    s_mov_b32 s30, 37748736
    s_mov_b32 s31, 0x20000
    v_lshlrev_b32 v7, 8, v4
    v_lshl_add_u32 v40, v5, 4, v7
    v_lshl_add_u32 v41, v6, 4, v7
    v_xor_b32 v224, v3, v2
    v_lshl_add_u32 v36, v224, 4, v7
    v_xor_b32 v37, 64, v36
    v_xor_b32 v38, 128, v36
    v_xor_b32 v39, 192, v36
    v_lshrrev_b32 v7, 3, v5
    v_lshl_add_u32 v7, v7, 7, v4
    v_mul_u32_u24 v7, 1152, v7
    v_and_b32 v225, 7, v5
    v_lshl_add_u32 v46, v225, 4, v7
    v_lshrrev_b32 v7, 3, v6
    v_lshl_add_u32 v7, v7, 7, v4
    v_mul_u32_u24 v7, 1152, v7
    v_and_b32 v225, 7, v6
    v_lshl_add_u32 v47, v225, 4, v7
    v_add_u32 v48, 7168, v46
    v_add_u32 v49, 10752, v47
    v_add_u32 v47, 3584, v47
    v_lshlrev_b32 v7, 8, v3
    v_lshl_add_u32 v8, v224, 4, v7
    v_xor_b32 v9, 64, v8
    v_xor_b32 v10, 128, v8
    v_xor_b32 v11, 192, v8
    v_lshrrev_b32 v5, 2, v1
    v_and_b32 v6, 7, v5
    v_lshlrev_b32 v6, 5, v6
    v_lshl_add_u32 v6, v5, 8, v6
    v_and_b32 v7, 3, v1
    v_lshl_add_u32 v12, v7, 3, v6
    v_xor_b32 v13, 32, v12
    v_xor_b32 v14, 64, v12
    v_xor_b32 v15, 96, v12
    v_xor_b32 v16, 128, v12
    v_xor_b32 v17, 160, v12
    v_xor_b32 v18, 192, v12
    v_xor_b32 v19, 224, v12
    v_add_u32 v20, 65536, v12
    v_add_u32 v21, 65536, v13
    v_add_u32 v22, 65536, v14
    v_add_u32 v23, 65536, v15
    v_add_u32 v24, 65536, v16
    v_add_u32 v25, 65536, v17
    v_add_u32 v26, 65536, v18
    v_add_u32 v27, 65536, v19
    v_add_u32 v28, 131072, v12
    v_add_u32 v29, 131072, v13
    v_add_u32 v30, 131072, v14
    v_add_u32 v31, 131072, v15
    v_add_u32 v32, 131072, v16
    v_add_u32 v33, 131072, v17
    v_add_u32 v34, 131072, v18
    v_add_u32 v35, 131072, v19
    v_mov_b32 v52, 0x3f803f80
    v_mov_b32 v53, 0x3f803f80
    v_mov_b32 v54, 0x3f803f80
    v_mov_b32 v55, 0x3f803f80
    v_and_b32 v5, 1, v1
    v_mul_u32_u24 v5, 0xaaaa, v5
    v_add_u32 v5, 0x4444, v5
    v_lshl_add_u32 v50, v5, 16, v5
    v_lshrrev_b32 v5, 1, v3
    v_mul_u32_u24 v5, 20480, v5
    v_lshl_add_u32 v5, v2, 5, v5
    v_and_b32 v6, 1, v3
    v_lshl_add_u32 v56, v6, 4, v5
    s_mul_i32 s47, s6, 327680
    s_mov_b32 s32, s82
    s_mov_b32 s33, s83
    s_mov_b32 s34, 5308416
    s_mov_b32 s35, 0x20000
    s_mov_b32 s82, 5308416
    s_mov_b32 s83, 0x20000
    s_mov_b32 s86, 5308416
    s_mov_b32 s87, 0x20000
    s_lshr_b32 s7, s2, 3
    s_mul_i32 s7, s7, 18
    s_add_u32 s7, s7, s3
    s_and_b32 s36, s2, 7
    s_mul_i32 s37, s36, 576
    s_add_u32 s37, s37, s7
    s_mul_i32 s37, s37, 1152
    s_mul_i32 s7, s7, 9216
    s_mul_i32 s36, s36, 1152
    s_add_u32 s7, s7, s36
    v_min_u32 v5, 17, v1
    v_lshl_add_u32 v57, v5, 6, s7
    v_lshl_add_u32 v62, v5, 6, s37
    s_mov_b32 s40, 0
    s_mov_b32 s41, 0
    s_mov_b32 s48, 0
    s_waitcnt vmcnt(9)
    v_lshlrev_b32 v80, 16, v80
    s_waitcnt vmcnt(8)
    v_lshlrev_b32 v81, 16, v81
    s_waitcnt vmcnt(7)
    v_lshlrev_b32 v82, 16, v82
    s_waitcnt vmcnt(6)
    v_lshlrev_b32 v83, 16, v83
    s_waitcnt vmcnt(5)
    v_lshlrev_b32 v84, 16, v84
    v_mul_f32 v144, 0xbfb8aa3b, v80
    v_mul_f32 v148, 0xbfb8aa3b, v81
    v_mul_f32 v152, 0xbfb8aa3b, v82
    v_mul_f32 v156, 0xbfb8aa3b, v83
    v_mul_f32 v160, 0xbfb8aa3b, v84
    v_min_f32 v144, 0x42fc0000, v144
    v_min_f32 v148, 0x42fc0000, v148
    v_min_f32 v152, 0x42fc0000, v152
    v_min_f32 v156, 0x42fc0000, v156
    v_min_f32 v160, 0x42fc0000, v160
    v_exp_f32 v144, v144
    v_exp_f32 v148, v148
    v_exp_f32 v152, v152
    v_exp_f32 v156, v156
    v_exp_f32 v160, v160
    v_add_f32 v144, 1.0, v144
    v_add_f32 v148, 1.0, v148
    v_add_f32 v152, 1.0, v152
    v_add_f32 v156, 1.0, v156
    v_add_f32 v160, 1.0, v160
    v_rcp_f32 v145, v144
    v_rcp_f32 v149, v148
    v_rcp_f32 v153, v152
    v_rcp_f32 v157, v156
    v_rcp_f32 v161, v160
    v_mul_f32 v146, v80, v145
    v_mul_f32 v150, v81, v149
    v_mul_f32 v154, v82, v153
    v_mul_f32 v158, v83, v157
    v_mul_f32 v162, v84, v161
    v_fma_f32 v144, -v146, v144, v80
    v_fma_f32 v148, -v150, v148, v81
    v_fma_f32 v152, -v154, v152, v82
    v_fma_f32 v156, -v158, v156, v83
    v_fma_f32 v160, -v162, v160, v84
    v_fma_f32 v80, v144, v145, v146
    v_fma_f32 v81, v148, v149, v150
    v_fma_f32 v82, v152, v153, v154
    v_fma_f32 v83, v156, v157, v158
    v_fma_f32 v84, v160, v161, v162
    v_cvt_pk_bf16_f32 v80, v80, v80
    v_cvt_pk_bf16_f32 v81, v81, v81
    v_cvt_pk_bf16_f32 v82, v82, v82
    v_cvt_pk_bf16_f32 v83, v83, v83
    v_cvt_pk_bf16_f32 v84, v84, v84
    v_and_b32 v80, 0xffff0000, v80
    v_and_b32 v81, 0xffff0000, v81
    v_and_b32 v82, 0xffff0000, v82
    v_and_b32 v83, 0xffff0000, v83
    v_and_b32 v84, 0xffff0000, v84
    buffer_load_dwordx2 v[108:109], v66, s[20:23], s49 offen offset:0
    buffer_load_dwordx2 v[110:111], v66, s[20:23], s49 offen offset:32
    buffer_load_dwordx2 v[112:113], v66, s[20:23], s49 offen offset:384
    buffer_load_dwordx2 v[114:115], v66, s[20:23], s49 offen offset:416
    buffer_load_dwordx2 v[116:117], v66, s[20:23], s49 offen offset:768
    buffer_load_dwordx2 v[118:119], v66, s[20:23], s49 offen offset:800
    s_mov_b32 s20, s58
    s_mov_b32 s21, s59
    s_mov_b32 s22, 4718592
    s_mov_b32 s23, 0x20000
    s_waitcnt vmcnt(10)
    v_lshlrev_b32 v136, 16, v88
    v_and_b32 v137, 0xffff0000, v88
    v_lshlrev_b32 v138, 16, v89
    v_and_b32 v139, 0xffff0000, v89
    v_lshlrev_b32 v140, 16, v90
    v_and_b32 v141, 0xffff0000, v90
    v_lshlrev_b32 v142, 16, v91
    v_and_b32 v143, 0xffff0000, v91
    v_pk_mul_f32 v[128:129], v[136:137], v[80:81] op_sel:[0,0] op_sel_hi:[1,0]
    v_pk_mul_f32 v[130:131], v[138:139], v[80:81] op_sel:[0,0] op_sel_hi:[1,0]
    v_pk_mul_f32 v[132:133], v[140:141], v[80:81] op_sel:[0,0] op_sel_hi:[1,0]
    v_pk_mul_f32 v[134:135], v[142:143], v[80:81] op_sel:[0,0] op_sel_hi:[1,0]
    s_waitcnt vmcnt(9)
    v_lshlrev_b32 v136, 16, v92
    v_and_b32 v137, 0xffff0000, v92
    v_lshlrev_b32 v138, 16, v93
    v_and_b32 v139, 0xffff0000, v93
    v_lshlrev_b32 v140, 16, v94
    v_and_b32 v141, 0xffff0000, v94
    v_lshlrev_b32 v142, 16, v95
    v_and_b32 v143, 0xffff0000, v95
    v_pk_fma_f32 v[128:129], v[136:137], v[80:81], v[128:129] op_sel:[0,1,0] op_sel_hi:[1,1,1]
    v_pk_fma_f32 v[130:131], v[138:139], v[80:81], v[130:131] op_sel:[0,1,0] op_sel_hi:[1,1,1]
    v_pk_fma_f32 v[132:133], v[140:141], v[80:81], v[132:133] op_sel:[0,1,0] op_sel_hi:[1,1,1]
    v_pk_fma_f32 v[134:135], v[142:143], v[80:81], v[134:135] op_sel:[0,1,0] op_sel_hi:[1,1,1]
    s_waitcnt vmcnt(8)
    v_lshlrev_b32 v136, 16, v96
    v_and_b32 v137, 0xffff0000, v96
    v_lshlrev_b32 v138, 16, v97
    v_and_b32 v139, 0xffff0000, v97
    v_lshlrev_b32 v140, 16, v98
    v_and_b32 v141, 0xffff0000, v98
    v_lshlrev_b32 v142, 16, v99
    v_and_b32 v143, 0xffff0000, v99
    v_pk_fma_f32 v[128:129], v[136:137], v[82:83], v[128:129] op_sel:[0,0,0] op_sel_hi:[1,0,1]
    v_pk_fma_f32 v[130:131], v[138:139], v[82:83], v[130:131] op_sel:[0,0,0] op_sel_hi:[1,0,1]
    v_pk_fma_f32 v[132:133], v[140:141], v[82:83], v[132:133] op_sel:[0,0,0] op_sel_hi:[1,0,1]
    v_pk_fma_f32 v[134:135], v[142:143], v[82:83], v[134:135] op_sel:[0,0,0] op_sel_hi:[1,0,1]
    s_waitcnt vmcnt(7)
    v_lshlrev_b32 v136, 16, v100
    v_and_b32 v137, 0xffff0000, v100
    v_lshlrev_b32 v138, 16, v101
    v_and_b32 v139, 0xffff0000, v101
    v_lshlrev_b32 v140, 16, v102
    v_and_b32 v141, 0xffff0000, v102
    v_lshlrev_b32 v142, 16, v103
    v_and_b32 v143, 0xffff0000, v103
    v_pk_fma_f32 v[128:129], v[136:137], v[82:83], v[128:129] op_sel:[0,1,0] op_sel_hi:[1,1,1]
    v_pk_fma_f32 v[130:131], v[138:139], v[82:83], v[130:131] op_sel:[0,1,0] op_sel_hi:[1,1,1]
    v_pk_fma_f32 v[132:133], v[140:141], v[82:83], v[132:133] op_sel:[0,1,0] op_sel_hi:[1,1,1]
    v_pk_fma_f32 v[134:135], v[142:143], v[82:83], v[134:135] op_sel:[0,1,0] op_sel_hi:[1,1,1]
    s_waitcnt vmcnt(6)
    v_lshlrev_b32 v136, 16, v104
    v_and_b32 v137, 0xffff0000, v104
    v_lshlrev_b32 v138, 16, v105
    v_and_b32 v139, 0xffff0000, v105
    v_lshlrev_b32 v140, 16, v106
    v_and_b32 v141, 0xffff0000, v106
    v_lshlrev_b32 v142, 16, v107
    v_and_b32 v143, 0xffff0000, v107
    v_pk_fma_f32 v[128:129], v[136:137], v[84:85], v[128:129] op_sel:[0,0,0] op_sel_hi:[1,0,1]
    v_pk_fma_f32 v[130:131], v[138:139], v[84:85], v[130:131] op_sel:[0,0,0] op_sel_hi:[1,0,1]
    v_pk_fma_f32 v[132:133], v[140:141], v[84:85], v[132:133] op_sel:[0,0,0] op_sel_hi:[1,0,1]
    v_pk_fma_f32 v[134:135], v[142:143], v[84:85], v[134:135] op_sel:[0,0,0] op_sel_hi:[1,0,1]
    s_nop 0
    v_permlane32_swap_b32 v128, v132
    v_permlane32_swap_b32 v129, v133
    v_permlane32_swap_b32 v130, v134
    v_permlane32_swap_b32 v131, v135
    v_and_b32 v72, 1, v1
    v_pk_add_f32 v[128:129], v[128:129], v[132:133]
    v_pk_add_f32 v[130:131], v[130:131], v[134:135]
    v_lshlrev_b32 v72, 5, v72
    v_lshrrev_b32 v73, 4, v1
    v_permlane16_swap_b32 v128, v130
    v_permlane16_swap_b32 v129, v131
    v_lshl_add_u32 v72, v73, 3, v72
    v_pk_add_f32 v[128:129], v[128:129], v[130:131]
    s_lshl_b32 s36, s3, 6
    v_add_u32 v72, s36, v72
    v_add_f32_dpp v128, v128, v128 row_ror:2 row_mask:0xf bank_mask:0xf
    v_add_f32_dpp v129, v129, v129 row_ror:2 row_mask:0xf bank_mask:0xf
    s_nop 0
    v_add_f32_dpp v128, v128, v128 row_ror:4 row_mask:0xf bank_mask:0xf
    v_add_f32_dpp v129, v129, v129 row_ror:4 row_mask:0xf bank_mask:0xf
    s_nop 0
    v_add_f32_dpp v128, v128, v128 row_ror:8 row_mask:0xf bank_mask:0xf
    v_add_f32_dpp v129, v129, v129 row_ror:8 row_mask:0xf bank_mask:0xf
    ds_write_b64 v72, v[128:129] offset:0
    v_and_b32 v73, 7, v1
    v_lshlrev_b32 v73, 3, v73
    s_waitcnt lgkmcnt(0)
    s_barrier
    ds_read_b64 v[128:129], v73 offset:0
    ds_read_b64 v[130:131], v73 offset:64
    ds_read_b64 v[132:133], v73 offset:128
    ds_read_b64 v[134:135], v73 offset:192
    s_add_u32 s95, s94, 0x9e3779b9
    v_mov_b32 v137, s95
    s_mov_b32 s37, 32768
    s_waitcnt lgkmcnt(2)
    v_pk_add_f32 v[128:129], v[128:129], v[130:131]
    s_waitcnt lgkmcnt(0)
    v_pk_add_f32 v[132:133], v[132:133], v[134:135]
    v_pk_add_f32 v[128:129], v[128:129], v[132:133]
    v_cvt_pk_bf16_f32 v136, v128, v129
    v_lshlrev_b32 v128, 16, v136
    v_and_b32 v129, 0xffff0000, v136
    v_add_f32 v128, s93, v128
    v_add_f32 v129, s93, v129
    v_cvt_pk_bf16_f32 v136, v128, v129
    buffer_store_dwordx2 v[136:137], v69, s[24:27], s37 offen sc1
    s_mul_i32 s36, s3, 72
    v_add_u32 v122, s36, v1
    v_and_b32 v123, 7, v1
    s_add_u32 s36, s36, 64
    v_add_u32 v123, s36, v123
    s_movk_i32 s36, 1024
    v_and_b32 v76, 3, v122
    v_lshlrev_b32 v76, 4, v76
    v_lshrrev_b32 v122, 2, v122
    v_lshl_add_u32 v124, v122, 7, v76
    v_and_b32 v77, 1, v122
    v_lshl_add_u32 v76, v77, 3, v76
    v_lshrrev_b32 v122, 1, v122
    v_lshl_add_u32 v122, v122, 6, v76
    v_add_u32 v122, s36, v122
    v_and_b32 v76, 3, v123
    v_lshlrev_b32 v76, 4, v76
    v_lshrrev_b32 v123, 2, v123
    v_lshl_add_u32 v125, v123, 7, v76
    v_and_b32 v77, 1, v123
    v_lshl_add_u32 v76, v77, 3, v76
    v_lshrrev_b32 v123, 1, v123
    v_lshl_add_u32 v123, v123, 6, v76
    v_add_u32 v123, s36, v123
    s_mov_b64 exec, 0
    s_cmp_eq_u32 s3, 0
    s_cbranch_scc1 Ltour0
    s_cmp_eq_u32 s3, 1
    s_cbranch_scc1 Ltour1
    s_cmp_eq_u32 s3, 2
    s_cbranch_scc1 Ltour2
    s_branch Ltour3
.p2align 12
Lmain:
    s_mov_b64 exec, -1
    s_waitcnt vmcnt(6)
    v_lshlrev_b32 v144, 16, v108
    v_and_b32 v145, 0xffff0000, v108
    v_lshlrev_b32 v146, 16, v109
    v_and_b32 v147, 0xffff0000, v109
    s_waitcnt vmcnt(5)
    v_lshlrev_b32 v148, 16, v110
    v_and_b32 v149, 0xffff0000, v110
    v_lshlrev_b32 v150, 16, v111
    v_and_b32 v151, 0xffff0000, v111
    s_waitcnt vmcnt(4)
    v_lshlrev_b32 v152, 16, v112
    v_and_b32 v153, 0xffff0000, v112
    v_lshlrev_b32 v154, 16, v113
    v_and_b32 v155, 0xffff0000, v113
    s_waitcnt vmcnt(3)
    v_lshlrev_b32 v156, 16, v114
    v_and_b32 v157, 0xffff0000, v114
    v_lshlrev_b32 v158, 16, v115
    v_and_b32 v159, 0xffff0000, v115
    s_waitcnt vmcnt(2)
    v_lshlrev_b32 v160, 16, v116
    v_and_b32 v161, 0xffff0000, v116
    v_lshlrev_b32 v162, 16, v117
    v_and_b32 v163, 0xffff0000, v117
    s_waitcnt vmcnt(1)
    v_lshlrev_b32 v164, 16, v118
    v_and_b32 v165, 0xffff0000, v118
    v_lshlrev_b32 v166, 16, v119
    v_and_b32 v167, 0xffff0000, v119
    buffer_load_dwordx4 v[88:91], v124, s[24:27], s37 offen sc1
    buffer_load_dwordx4 v[92:95], v125, s[24:27], s37 offen sc1
    buffer_load_dword v242, v71, s[16:19], s44 offen
    v_pk_add_f32 v[72:73], v[144:145], v[148:149]
    v_pk_add_f32 v[76:77], v[146:147], v[150:151]
    v_pk_add_f32 v[72:73], v[72:73], v[152:153]
    v_pk_add_f32 v[76:77], v[76:77], v[154:155]
    v_pk_add_f32 v[72:73], v[72:73], v[156:157]
    v_pk_add_f32 v[76:77], v[76:77], v[158:159]
    v_pk_add_f32 v[72:73], v[72:73], v[160:161]
    v_pk_add_f32 v[76:77], v[76:77], v[162:163]
    v_pk_add_f32 v[72:73], v[72:73], v[164:165]
    v_pk_add_f32 v[76:77], v[76:77], v[166:167]
    v_pk_add_f32 v[72:73], v[72:73], v[76:77]
    v_add_f32 v72, v72, v73
    s_nop 1
    v_add_f32_dpp v72, v72, v72 row_ror:8 row_mask:0xf bank_mask:0xf
    s_nop 1
    v_add_f32_dpp v72, v72, v72 row_ror:4 row_mask:0xf bank_mask:0xf
    s_nop 1
    v_add_f32_dpp v72, v72, v72 row_ror:2 row_mask:0xf bank_mask:0xf
    s_nop 1
    v_add_f32_dpp v72, v72, v72 row_ror:1 row_mask:0xf bank_mask:0xf
    v_mov_b32 v76, v72
    s_nop 1
    v_permlane16_swap_b32 v72, v76
    s_nop 0
    v_add_f32 v72, v72, v76
    v_mul_f32 v72, 0x3ae38e39, v72
    v_pk_add_f32 v[168:169], v[144:145], v[72:73] op_sel_hi:[1,0] neg_lo:[0,1] neg_hi:[0,1]
    v_pk_add_f32 v[170:171], v[146:147], v[72:73] op_sel_hi:[1,0] neg_lo:[0,1] neg_hi:[0,1]
    v_pk_add_f32 v[172:173], v[148:149], v[72:73] op_sel_hi:[1,0] neg_lo:[0,1] neg_hi:[0,1]
    v_pk_add_f32 v[174:175], v[150:151], v[72:73] op_sel_hi:[1,0] neg_lo:[0,1] neg_hi:[0,1]
    v_pk_add_f32 v[176:177], v[152:153], v[72:73] op_sel_hi:[1,0] neg_lo:[0,1] neg_hi:[0,1]
    v_pk_add_f32 v[178:179], v[154:155], v[72:73] op_sel_hi:[1,0] neg_lo:[0,1] neg_hi:[0,1]
    v_pk_add_f32 v[180:181], v[156:157], v[72:73] op_sel_hi:[1,0] neg_lo:[0,1] neg_hi:[0,1]
    v_pk_add_f32 v[182:183], v[158:159], v[72:73] op_sel_hi:[1,0] neg_lo:[0,1] neg_hi:[0,1]
    v_pk_add_f32 v[184:185], v[160:161], v[72:73] op_sel_hi:[1,0] neg_lo:[0,1] neg_hi:[0,1]
    v_pk_add_f32 v[186:187], v[162:163], v[72:73] op_sel_hi:[1,0] neg_lo:[0,1] neg_hi:[0,1]
    v_pk_add_f32 v[188:189], v[164:165], v[72:73] op_sel_hi:[1,0] neg_lo:[0,1] neg_hi:[0,1]
    v_pk_add_f32 v[190:191], v[166:167], v[72:73] op_sel_hi:[1,0] neg_lo:[0,1] neg_hi:[0,1]
    v_pk_mul_f32 v[74:75], v[168:169], v[168:169]
    v_pk_mul_f32 v[76:77], v[170:171], v[170:171]
    v_pk_fma_f32 v[74:75], v[172:173], v[172:173], v[74:75]
    v_pk_fma_f32 v[76:77], v[174:175], v[174:175], v[76:77]
    v_pk_fma_f32 v[74:75], v[176:177], v[176:177], v[74:75]
    v_pk_fma_f32 v[76:77], v[178:179], v[178:179], v[76:77]
    v_pk_fma_f32 v[74:75], v[180:181], v[180:181], v[74:75]
    v_pk_fma_f32 v[76:77], v[182:183], v[182:183], v[76:77]
    v_pk_fma_f32 v[74:75], v[184:185], v[184:185], v[74:75]
    v_pk_fma_f32 v[76:77], v[186:187], v[186:187], v[76:77]
    v_pk_fma_f32 v[74:75], v[188:189], v[188:189], v[74:75]
    v_pk_fma_f32 v[76:77], v[190:191], v[190:191], v[76:77]
    v_pk_add_f32 v[74:75], v[74:75], v[76:77]
    v_add_f32 v74, v74, v75
    v_cndmask_b32 v74, 0, v74, vcc
    s_nop 1
    v_add_f32_dpp v74, v74, v74 row_ror:8 row_mask:0xf bank_mask:0xf
    s_nop 1
    v_add_f32_dpp v74, v74, v74 row_ror:4 row_mask:0xf bank_mask:0xf
    s_nop 1
    v_add_f32_dpp v74, v74, v74 row_ror:2 row_mask:0xf bank_mask:0xf
    s_nop 1
    v_add_f32_dpp v74, v74, v74 row_ror:1 row_mask:0xf bank_mask:0xf
    v_mov_b32 v76, v74
    s_nop 1
    v_permlane16_swap_b32 v74, v76
    s_nop 0
    v_add_f32 v74, v74, v76
    v_mul_f32 v74, 0x3ae38e39, v74
    v_cvt_pk_bf16_f32 v76, v72, v74
    v_and_b32 v74, 0xffff0000, v76
    v_lshlrev_b32 v72, 16, v76
    v_add_f32 v74, 0x3727c5ac, v74
    v_cvt_pk_bf16_f32 v74, v74, v74
    v_and_b32 v74, 0xffff0000, v74
    v_sqrt_f32 v74, v74
    v_pk_add_f32 v[168:169], v[144:145], v[72:73] op_sel_hi:[1,0] neg_lo:[0,1] neg_hi:[0,1]
    v_pk_add_f32 v[170:171], v[146:147], v[72:73] op_sel_hi:[1,0] neg_lo:[0,1] neg_hi:[0,1]
    v_pk_add_f32 v[172:173], v[148:149], v[72:73] op_sel_hi:[1,0] neg_lo:[0,1] neg_hi:[0,1]
    v_pk_add_f32 v[174:175], v[150:151], v[72:73] op_sel_hi:[1,0] neg_lo:[0,1] neg_hi:[0,1]
    v_pk_add_f32 v[176:177], v[152:153], v[72:73] op_sel_hi:[1,0] neg_lo:[0,1] neg_hi:[0,1]
    v_pk_add_f32 v[178:179], v[154:155], v[72:73] op_sel_hi:[1,0] neg_lo:[0,1] neg_hi:[0,1]
    v_pk_add_f32 v[180:181], v[156:157], v[72:73] op_sel_hi:[1,0] neg_lo:[0,1] neg_hi:[0,1]
    v_pk_add_f32 v[182:183], v[158:159], v[72:73] op_sel_hi:[1,0] neg_lo:[0,1] neg_hi:[0,1]
    v_pk_add_f32 v[184:185], v[160:161], v[72:73] op_sel_hi:[1,0] neg_lo:[0,1] neg_hi:[0,1]
    v_pk_add_f32 v[186:187], v[162:163], v[72:73] op_sel_hi:[1,0] neg_lo:[0,1] neg_hi:[0,1]
    v_pk_add_f32 v[188:189], v[164:165], v[72:73] op_sel_hi:[1,0] neg_lo:[0,1] neg_hi:[0,1]
    v_pk_add_f32 v[190:191], v[166:167], v[72:73] op_sel_hi:[1,0] neg_lo:[0,1] neg_hi:[0,1]
    v_cvt_pk_bf16_f32 v74, v74, v74
    v_and_b32 v74, 0xffff0000, v74
    v_rcp_f32 v74, v74
    v_cvt_pk_bf16_f32 v108, v168, v169
    v_cvt_pk_bf16_f32 v109, v170, v171
    v_cvt_pk_bf16_f32 v110, v172, v173
    v_cvt_pk_bf16_f32 v111, v174, v175
    v_cvt_pk_bf16_f32 v112, v176, v177
    v_cvt_pk_bf16_f32 v113, v178, v179
    v_cvt_pk_bf16_f32 v114, v180, v181
    v_cvt_pk_bf16_f32 v115, v182, v183
    v_cvt_pk_bf16_f32 v116, v184, v185
    v_cvt_pk_bf16_f32 v117, v186, v187
    v_cvt_pk_bf16_f32 v118, v188, v189
    v_cvt_pk_bf16_f32 v119, v190, v191
    v_lshlrev_b32 v168, 16, v108
    v_and_b32 v169, 0xffff0000, v108
    v_lshlrev_b32 v170, 16, v109
    v_and_b32 v171, 0xffff0000, v109
    v_lshlrev_b32 v172, 16, v110
    v_and_b32 v173, 0xffff0000, v110
    v_lshlrev_b32 v174, 16, v111
    v_and_b32 v175, 0xffff0000, v111
    v_lshlrev_b32 v176, 16, v112
    v_and_b32 v177, 0xffff0000, v112
    v_lshlrev_b32 v178, 16, v113
    v_and_b32 v179, 0xffff0000, v113
    v_lshlrev_b32 v180, 16, v114
    v_and_b32 v181, 0xffff0000, v114
    v_lshlrev_b32 v182, 16, v115
    v_and_b32 v183, 0xffff0000, v115
    v_lshlrev_b32 v184, 16, v116
    v_and_b32 v185, 0xffff0000, v116
    v_lshlrev_b32 v186, 16, v117
    v_and_b32 v187, 0xffff0000, v117
    v_lshlrev_b32 v188, 16, v118
    v_and_b32 v189, 0xffff0000, v118
    v_lshlrev_b32 v190, 16, v119
    v_and_b32 v191, 0xffff0000, v119
    v_pk_mul_f32 v[168:169], v[168:169], v[74:75] op_sel_hi:[1,0]
    v_pk_mul_f32 v[170:171], v[170:171], v[74:75] op_sel_hi:[1,0]
    v_pk_mul_f32 v[172:173], v[172:173], v[74:75] op_sel_hi:[1,0]
    v_pk_mul_f32 v[174:175], v[174:175], v[74:75] op_sel_hi:[1,0]
    v_pk_mul_f32 v[176:177], v[176:177], v[74:75] op_sel_hi:[1,0]
    v_pk_mul_f32 v[178:179], v[178:179], v[74:75] op_sel_hi:[1,0]
    v_pk_mul_f32 v[180:181], v[180:181], v[74:75] op_sel_hi:[1,0]
    v_pk_mul_f32 v[182:183], v[182:183], v[74:75] op_sel_hi:[1,0]
    v_pk_mul_f32 v[184:185], v[184:185], v[74:75] op_sel_hi:[1,0]
    v_pk_mul_f32 v[186:187], v[186:187], v[74:75] op_sel_hi:[1,0]
    v_pk_mul_f32 v[188:189], v[188:189], v[74:75] op_sel_hi:[1,0]
    v_pk_mul_f32 v[190:191], v[190:191], v[74:75] op_sel_hi:[1,0]
    v_cvt_pk_bf16_f32 v108, v168, v169
    v_cvt_pk_bf16_f32 v109, v170, v171
    v_cvt_pk_bf16_f32 v110, v172, v173
    v_cvt_pk_bf16_f32 v111, v174, v175
    v_cvt_pk_bf16_f32 v112, v176, v177
    v_cvt_pk_bf16_f32 v113, v178, v179
    v_cvt_pk_bf16_f32 v114, v180, v181
    v_cvt_pk_bf16_f32 v115, v182, v183
    v_cvt_pk_bf16_f32 v116, v184, v185
    v_cvt_pk_bf16_f32 v117, v186, v187
    v_cvt_pk_bf16_f32 v118, v188, v189
    v_cvt_pk_bf16_f32 v119, v190, v191
    v_lshlrev_b32 v168, 16, v108
    v_and_b32 v169, 0xffff0000, v108
    v_lshlrev_b32 v170, 16, v109
    v_and_b32 v171, 0xffff0000, v109
    v_lshlrev_b32 v172, 16, v110
    v_and_b32 v173, 0xffff0000, v110
    v_lshlrev_b32 v174, 16, v111
    v_and_b32 v175, 0xffff0000, v111
    v_lshlrev_b32 v176, 16, v112
    v_and_b32 v177, 0xffff0000, v112
    v_lshlrev_b32 v178, 16, v113
    v_and_b32 v179, 0xffff0000, v113
    v_lshlrev_b32 v180, 16, v114
    v_and_b32 v181, 0xffff0000, v114
    v_lshlrev_b32 v182, 16, v115
    v_and_b32 v183, 0xffff0000, v115
    v_lshlrev_b32 v184, 16, v116
    v_and_b32 v185, 0xffff0000, v116
    v_lshlrev_b32 v186, 16, v117
    v_and_b32 v187, 0xffff0000, v117
    v_lshlrev_b32 v188, 16, v118
    v_and_b32 v189, 0xffff0000, v118
    v_lshlrev_b32 v190, 16, v119
    v_and_b32 v191, 0xffff0000, v119
    s_mov_b32 s38, 262144
    s_waitcnt vmcnt(2)
    v_xor_b32 v89, s95, v89
    v_xor_b32 v91, s95, v91
    s_waitcnt vmcnt(1)
    v_xor_b32 v93, s95, v93
    v_xor_b32 v95, s95, v95
    v_or3_b32 v89, v89, v91, v93
    v_or_b32 v89, v89, v95
    v_cmp_ne_u32 vcc, 0, v89
    s_cbranch_vccz Lhead_gotm
Lhead_pollm:
    buffer_load_dwordx4 v[88:91], v124, s[24:27], s37 offen sc1
    buffer_load_dwordx4 v[92:95], v125, s[24:27], s37 offen sc1
    s_waitcnt vmcnt(0)
    s_sub_u32 s38, s38, 1
    s_cbranch_scc1 Lhead_gotm
    v_xor_b32 v89, s95, v89
    v_xor_b32 v91, s95, v91
    v_xor_b32 v93, s95, v93
    v_xor_b32 v95, s95, v95
    v_or3_b32 v89, v89, v91, v93
    v_or_b32 v89, v89, v95
    v_cmp_ne_u32 vcc, 0, v89
    s_cbranch_vccnz Lhead_pollm
Lhead_gotm:
    ds_write2_b32 v122, v88, v90 offset0:0 offset1:1
    ds_write2_b32 v123, v92, v94 offset0:0 offset1:1
    s_waitcnt lgkmcnt(0)
    s_barrier
    ds_read_b128 v[144:147], v68 offset:2176
    ds_read_b128 v[148:151], v68 offset:2560
    ds_read_b128 v[152:155], v68 offset:2944
    ds_read_b128 v[156:159], v68 offset:1024
    ds_read_b128 v[160:163], v68 offset:1408
    ds_read_b128 v[164:167], v68 offset:1792
    s_waitcnt lgkmcnt(5)
    v_lshlrev_b32 v192, 16, v144
    v_and_b32 v193, 0xffff0000, v144
    v_lshlrev_b32 v194, 16, v145
    v_and_b32 v195, 0xffff0000, v145
    v_lshlrev_b32 v196, 16, v146
    v_and_b32 v197, 0xffff0000, v146
    v_lshlrev_b32 v198, 16, v147
    v_and_b32 v199, 0xffff0000, v147
    s_waitcnt lgkmcnt(4)
    v_lshlrev_b32 v200, 16, v148
    v_and_b32 v201, 0xffff0000, v148
    v_lshlrev_b32 v202, 16, v149
    v_and_b32 v203, 0xffff0000, v149
    v_lshlrev_b32 v204, 16, v150
    v_and_b32 v205, 0xffff0000, v150
    v_lshlrev_b32 v206, 16, v151
    v_and_b32 v207, 0xffff0000, v151
    s_waitcnt lgkmcnt(3)
    v_lshlrev_b32 v208, 16, v152
    v_and_b32 v209, 0xffff0000, v152
    v_lshlrev_b32 v210, 16, v153
    v_and_b32 v211, 0xffff0000, v153
    v_lshlrev_b32 v212, 16, v154
    v_and_b32 v213, 0xffff0000, v154
    v_lshlrev_b32 v214, 16, v155
    v_and_b32 v215, 0xffff0000, v155
    v_pk_mul_f32 v[168:169], v[168:169], v[192:193]
    v_pk_mul_f32 v[170:171], v[170:171], v[194:195]
    v_pk_mul_f32 v[172:173], v[172:173], v[196:197]
    v_pk_mul_f32 v[174:175], v[174:175], v[198:199]
    v_pk_mul_f32 v[176:177], v[176:177], v[200:201]
    v_pk_mul_f32 v[178:179], v[178:179], v[202:203]
    v_pk_mul_f32 v[180:181], v[180:181], v[204:205]
    v_pk_mul_f32 v[182:183], v[182:183], v[206:207]
    v_pk_mul_f32 v[184:185], v[184:185], v[208:209]
    v_pk_mul_f32 v[186:187], v[186:187], v[210:211]
    v_pk_mul_f32 v[188:189], v[188:189], v[212:213]
    v_pk_mul_f32 v[190:191], v[190:191], v[214:215]
    v_cvt_pk_bf16_f32 v108, v168, v169
    v_cvt_pk_bf16_f32 v109, v170, v171
    v_cvt_pk_bf16_f32 v110, v172, v173
    v_cvt_pk_bf16_f32 v111, v174, v175
    v_cvt_pk_bf16_f32 v112, v176, v177
    v_cvt_pk_bf16_f32 v113, v178, v179
    v_cvt_pk_bf16_f32 v114, v180, v181
    v_cvt_pk_bf16_f32 v115, v182, v183
    v_cvt_pk_bf16_f32 v116, v184, v185
    v_cvt_pk_bf16_f32 v117, v186, v187
    v_cvt_pk_bf16_f32 v118, v188, v189
    v_cvt_pk_bf16_f32 v119, v190, v191
    s_waitcnt lgkmcnt(2)
    v_lshlrev_b32 v216, 16, v156
    v_and_b32 v217, 0xffff0000, v156
    v_lshlrev_b32 v218, 16, v157
    v_and_b32 v219, 0xffff0000, v157
    v_lshlrev_b32 v220, 16, v158
    v_and_b32 v221, 0xffff0000, v158
    v_lshlrev_b32 v222, 16, v159
    v_and_b32 v223, 0xffff0000, v159
    s_waitcnt lgkmcnt(1)
    v_lshlrev_b32 v224, 16, v160
    v_and_b32 v225, 0xffff0000, v160
    v_lshlrev_b32 v226, 16, v161
    v_and_b32 v227, 0xffff0000, v161
    v_lshlrev_b32 v228, 16, v162
    v_and_b32 v229, 0xffff0000, v162
    v_lshlrev_b32 v230, 16, v163
    v_and_b32 v231, 0xffff0000, v163
    s_waitcnt lgkmcnt(0)
    v_lshlrev_b32 v232, 16, v164
    v_and_b32 v233, 0xffff0000, v164
    v_lshlrev_b32 v234, 16, v165
    v_and_b32 v235, 0xffff0000, v165
    v_lshlrev_b32 v236, 16, v166
    v_and_b32 v237, 0xffff0000, v166
    v_lshlrev_b32 v238, 16, v167
    v_and_b32 v239, 0xffff0000, v167
    v_lshlrev_b32 v168, 16, v108
    v_and_b32 v169, 0xffff0000, v108
    v_lshlrev_b32 v170, 16, v109
    v_and_b32 v171, 0xffff0000, v109
    v_lshlrev_b32 v172, 16, v110
    v_and_b32 v173, 0xffff0000, v110
    v_lshlrev_b32 v174, 16, v111
    v_and_b32 v175, 0xffff0000, v111
    v_lshlrev_b32 v176, 16, v112
    v_and_b32 v177, 0xffff0000, v112
    v_lshlrev_b32 v178, 16, v113
    v_and_b32 v179, 0xffff0000, v113
    v_lshlrev_b32 v180, 16, v114
    v_and_b32 v181, 0xffff0000, v114
    v_lshlrev_b32 v182, 16, v115
    v_and_b32 v183, 0xffff0000, v115
    v_lshlrev_b32 v184, 16, v116
    v_and_b32 v185, 0xffff0000, v116
    v_lshlrev_b32 v186, 16, v117
    v_and_b32 v187, 0xffff0000, v117
    v_lshlrev_b32 v188, 16, v118
    v_and_b32 v189, 0xffff0000, v118
    v_lshlrev_b32 v190, 16, v119
    v_and_b32 v191, 0xffff0000, v119
    v_pk_add_f32 v[168:169], v[168:169], v[216:217]
    v_pk_add_f32 v[170:171], v[170:171], v[218:219]
    v_pk_add_f32 v[172:173], v[172:173], v[220:221]
    v_pk_add_f32 v[174:175], v[174:175], v[222:223]
    v_cvt_pk_bf16_f32 v108, v168, v169
    v_cvt_pk_bf16_f32 v109, v170, v171
    v_cvt_pk_bf16_f32 v110, v172, v173
    v_cvt_pk_bf16_f32 v111, v174, v175
    buffer_store_dwordx4 v[108:111], v67, s[24:27], s92 offen offset:0 sc1
    v_pk_add_f32 v[176:177], v[176:177], v[224:225]
    v_pk_add_f32 v[178:179], v[178:179], v[226:227]
    v_pk_add_f32 v[180:181], v[180:181], v[228:229]
    v_pk_add_f32 v[182:183], v[182:183], v[230:231]
    v_cvt_pk_bf16_f32 v112, v176, v177
    v_cvt_pk_bf16_f32 v113, v178, v179
    v_cvt_pk_bf16_f32 v114, v180, v181
    v_cvt_pk_bf16_f32 v115, v182, v183
    buffer_store_dwordx4 v[112:115], v67, s[24:27], s92 offen offset:768 sc1
    v_pk_add_f32 v[184:185], v[184:185], v[232:233]
    v_pk_add_f32 v[186:187], v[186:187], v[234:235]
    v_pk_add_f32 v[188:189], v[188:189], v[236:237]
    v_pk_add_f32 v[190:191], v[190:191], v[238:239]
    v_cvt_pk_bf16_f32 v116, v184, v185
    v_cvt_pk_bf16_f32 v117, v186, v187
    v_cvt_pk_bf16_f32 v118, v188, v189
    v_cvt_pk_bf16_f32 v119, v190, v191
    buffer_store_dwordx4 v[116:119], v67, s[24:27], s92 offen offset:1536 sc1
    s_lshl_b32 s36, s5, 13
    s_add_u32 s36, s36, 8650752
    s_lshl_b32 s37, s4, 9
    s_add_u32 s37, s37, s36
    s_lshl_b32 s38, s3, 7
    s_add_u32 s37, s37, s38
    s_lshl_b32 s38, s3, 11
    s_add_u32 s36, s36, s38
    v_min_u32 v72, 1, v1
    v_lshlrev_b32 v72, 31, v72
    v_and_b32 v73, 15, v1
    v_lshlrev_b32 v73, 7, v73
    v_cmp_gt_u32 vcc, 162, v0
    v_mov_b32 v88, -1
    v_mov_b32 v89, -1
    v_mov_b32 v90, -1
    v_mov_b32 v91, -1
    s_mul_i32 s39, s2, 2592
    s_add_u32 s39, s39, 7864320
    v_lshl_add_u32 v74, v0, 4, s39
    s_lshl_b32 s39, s2, 7
    s_add_u32 s39, s39, 9306112
    v_mov_b32 v75, s39
    v_cndmask_b32 v74, v75, v74, vcc
    s_lshl_b32 s92, s5, 13
    s_add_u32 s92, s92, 8781824
    s_add_u32 s92, s92, s38
    s_lshl_b32 s38, s4, 7
    s_add_u32 s92, s92, s38
    s_getreg_b32 s38, hwreg(HW_REG_XCC_ID, 0, 4)
    s_lshl_b32 s38, s38, 28
    s_xor_b32 s38, s38, s95
    v_mov_b32 v76, s38
    v_mov_b32 v2, v80
    v_mov_b32 v3, v81
    v_mov_b32 v4, v82
    v_mov_b32 v5, v83
    v_mov_b32 v6, v84
    v_mov_b32 v7, v65
    v_and_b32 v126, 31, v1
    v_lshlrev_b32 v126, 2, v126
    s_waitcnt vmcnt(0)
    buffer_store_dword v137, v126, s[24:27], s37 offen sc1
    s_add_u32 s49, s44, 0
    s_add_u32 m0, s42, 32768
    s_nop 0
    buffer_load_dwordx4 v42, s[16:19], s49 offen lds
    buffer_load_dwordx4 v43, s[16:19], s49 offen offset:1024 lds
    buffer_load_dwordx4 v44, s[16:19], s49 offen offset:2048 lds
    buffer_load_dwordx4 v45, s[16:19], s49 offen offset:3072 lds
    s_add_u32 s49, s44, 256
    s_add_u32 m0, s42, 49152
    s_nop 0
    buffer_load_dwordx4 v42, s[16:19], s49 offen lds
    buffer_load_dwordx4 v43, s[16:19], s49 offen offset:1024 lds
    buffer_load_dwordx4 v44, s[16:19], s49 offen offset:2048 lds
    buffer_load_dwordx4 v45, s[16:19], s49 offen offset:3072 lds
    s_add_u32 s49, s44, 524288
    s_add_u32 m0, s42, 65536
    s_nop 0
    buffer_load_dwordx4 v42, s[16:19], s49 offen lds
    buffer_load_dwordx4 v43, s[16:19], s49 offen offset:1024 lds
    buffer_load_dwordx4 v44, s[16:19], s49 offen offset:2048 lds
    buffer_load_dwordx4 v45, s[16:19], s49 offen offset:3072 lds
    s_add_u32 s49, s44, 524544
    s_add_u32 m0, s42, 81920
    s_nop 0
    buffer_load_dwordx4 v42, s[16:19], s49 offen lds
    buffer_load_dwordx4 v43, s[16:19], s49 offen offset:1024 lds
    buffer_load_dwordx4 v44, s[16:19], s49 offen offset:2048 lds
    buffer_load_dwordx4 v45, s[16:19], s49 offen offset:3072 lds
    s_add_u32 s49, s44, 1048576
    s_add_u32 m0, s42, 98304
    s_nop 0
    buffer_load_dwordx4 v42, s[16:19], s49 offen lds
    buffer_load_dwordx4 v43, s[16:19], s49 offen offset:1024 lds
    buffer_load_dwordx4 v44, s[16:19], s49 offen offset:2048 lds
    buffer_load_dwordx4 v45, s[16:19], s49 offen offset:3072 lds
    s_add_u32 s49, s44, 1048832
    s_add_u32 m0, s42, 114688
    s_nop 0
    buffer_load_dwordx4 v42, s[16:19], s49 offen lds
    buffer_load_dwordx4 v43, s[16:19], s49 offen offset:1024 lds
    buffer_load_dwordx4 v44, s[16:19], s49 offen offset:2048 lds
    buffer_load_dwordx4 v45, s[16:19], s49 offen offset:3072 lds
    s_mov_b32 s38, 262144
Lhead_pollh:
    buffer_load_dword v75, v73, s[24:27], s36 offen sc1
    s_sub_u32 s38, s38, 1
    s_cbranch_scc1 Lhead_goth
    s_waitcnt vmcnt(0) lgkmcnt(0)
    v_cmp_ne_u32 vcc, s95, v75
    s_cbranch_vccnz Lhead_pollh
Lhead_goth:
    s_waitcnt vmcnt(0) lgkmcnt(0)
    buffer_load_dwordx4 a[0:3], v51, s[24:27], s46 offen offset:0 sc1
    buffer_load_dwordx4 a[8:11], v51, s[24:27], s46 offen offset:128 sc1
    buffer_load_dwordx4 a[4:7], v51, s[24:27], s43 offen offset:0 sc1
    buffer_load_dwordx4 a[12:15], v51, s[24:27], s43 offen offset:128 sc1
    s_barrier
    ds_read_b64_tr_b16 a[160:161], v12 offset:32768
    ds_read_b64_tr_b16 a[162:163], v12 offset:36864
    ds_read_b64_tr_b16 a[164:165], v12 offset:40960
    ds_read_b64_tr_b16 a[166:167], v12 offset:45056
    ds_read_b64_tr_b16 a[168:169], v13 offset:32768
    ds_read_b64_tr_b16 a[170:171], v13 offset:36864
    ds_read_b64_tr_b16 a[172:173], v13 offset:40960
    ds_read_b64_tr_b16 a[174:175], v13 offset:45056
    ds_read_b64_tr_b16 a[176:177], v14 offset:32768
    ds_read_b64_tr_b16 a[178:179], v14 offset:36864
    ds_read_b64_tr_b16 a[180:181], v14 offset:40960
    ds_read_b64_tr_b16 a[182:183], v14 offset:45056
    buffer_load_dwordx4 a[16:19], v51, s[24:27], s46 offen offset:256 sc1
    buffer_load_dwordx4 a[24:27], v51, s[24:27], s46 offen offset:384 sc1
    buffer_load_dwordx4 a[20:23], v51, s[24:27], s43 offen offset:256 sc1
    buffer_load_dwordx4 a[28:31], v51, s[24:27], s43 offen offset:384 sc1
    s_waitcnt lgkmcnt(10)
    s_waitcnt vmcnt(7)
    v_mfma_f32_16x16x32_bf16 v[128:131], a[160:163], a[0:3], 0
    s_waitcnt vmcnt(6)
    s_waitcnt lgkmcnt(8)
    ds_read_b64_tr_b16 a[184:185], v15 offset:32768
    v_mfma_f32_16x16x32_bf16 v[128:131], a[164:167], a[8:11], v[128:131]
    s_waitcnt vmcnt(4)
    ds_read_b64_tr_b16 a[186:187], v15 offset:36864
    v_mfma_f32_16x16x32_bf16 v[132:135], a[164:167], a[12:15], 0
    ds_read_b64_tr_b16 a[188:189], v15 offset:40960
    v_mfma_f32_16x16x32_bf16 v[132:135], a[160:163], a[4:7], v[132:135]
    s_waitcnt lgkmcnt(9)
    buffer_load_dwordx4 a[32:35], v51, s[24:27], s46 offen offset:512 sc1
    v_mfma_f32_16x16x32_bf16 v[140:143], a[168:171], a[4:7], 0
    s_waitcnt lgkmcnt(7)
    ds_read_b64_tr_b16 a[190:191], v15 offset:45056
    ds_read_b64_tr_b16 a[160:161], v16 offset:32768
    v_mfma_f32_16x16x32_bf16 v[140:143], a[172:175], a[12:15], v[140:143]
    ds_read_b64_tr_b16 a[162:163], v16 offset:36864
    v_mfma_f32_16x16x32_bf16 v[136:139], a[172:175], a[8:11], 0
    ds_read_b64_tr_b16 a[164:165], v16 offset:40960
    v_mfma_f32_16x16x32_bf16 v[136:139], a[168:171], a[0:3], v[136:139]
    s_waitcnt lgkmcnt(9)
    buffer_load_dwordx4 a[40:43], v51, s[24:27], s46 offen offset:640 sc1
    v_mfma_f32_16x16x32_bf16 v[144:147], a[176:179], a[0:3], 0
    s_waitcnt lgkmcnt(7)
    ds_read_b64_tr_b16 a[166:167], v16 offset:45056
    ds_read_b64_tr_b16 a[168:169], v17 offset:32768
    v_mfma_f32_16x16x32_bf16 v[144:147], a[180:183], a[8:11], v[144:147]
    ds_read_b64_tr_b16 a[170:171], v17 offset:36864
    v_mfma_f32_16x16x32_bf16 v[148:151], a[180:183], a[12:15], 0
    ds_read_b64_tr_b16 a[172:173], v17 offset:40960
    v_mfma_f32_16x16x32_bf16 v[148:151], a[176:179], a[4:7], v[148:151]
    s_waitcnt lgkmcnt(9)
    buffer_load_dwordx4 a[36:39], v51, s[24:27], s43 offen offset:512 sc1
    v_mfma_f32_16x16x32_bf16 v[156:159], a[184:187], a[4:7], 0
    s_waitcnt lgkmcnt(7)
    ds_read_b64_tr_b16 a[174:175], v17 offset:45056
    ds_read_b64_tr_b16 a[176:177], v18 offset:32768
    v_mfma_f32_16x16x32_bf16 v[156:159], a[188:191], a[12:15], v[156:159]
    ds_read_b64_tr_b16 a[178:179], v18 offset:36864
    v_mfma_f32_16x16x32_bf16 v[152:155], a[188:191], a[8:11], 0
    ds_read_b64_tr_b16 a[180:181], v18 offset:40960
    v_mfma_f32_16x16x32_bf16 v[152:155], a[184:187], a[0:3], v[152:155]
    s_waitcnt lgkmcnt(9)
    buffer_load_dwordx4 a[44:47], v51, s[24:27], s43 offen offset:640 sc1
    v_mfma_f32_16x16x32_bf16 v[160:163], a[160:163], a[0:3], 0
    s_waitcnt lgkmcnt(7)
    ds_read_b64_tr_b16 a[182:183], v18 offset:45056
    ds_read_b64_tr_b16 a[184:185], v19 offset:32768
    v_mfma_f32_16x16x32_bf16 v[160:163], a[164:167], a[8:11], v[160:163]
    ds_read_b64_tr_b16 a[186:187], v19 offset:36864
    v_mfma_f32_16x16x32_bf16 v[164:167], a[164:167], a[12:15], 0
    ds_read_b64_tr_b16 a[188:189], v19 offset:40960
    v_mfma_f32_16x16x32_bf16 v[164:167], a[160:163], a[4:7], v[164:167]
    s_waitcnt lgkmcnt(9)
    buffer_load_dword v77, v70, s[16:19], s44 offen
    v_mfma_f32_16x16x32_bf16 v[172:175], a[168:171], a[4:7], 0
    s_waitcnt lgkmcnt(7)
    ds_read_b64_tr_b16 a[190:191], v19 offset:45056
    ds_read_b64_tr_b16 a[160:161], v12 offset:49152
    v_mfma_f32_16x16x32_bf16 v[172:175], a[172:175], a[12:15], v[172:175]
    ds_read_b64_tr_b16 a[162:163], v12 offset:53248
    v_mfma_f32_16x16x32_bf16 v[168:171], a[172:175], a[8:11], 0
    ds_read_b64_tr_b16 a[164:165], v12 offset:57344
    v_mfma_f32_16x16x32_bf16 v[168:171], a[168:171], a[0:3], v[168:171]
    s_waitcnt lgkmcnt(9)
    ds_read_b64_tr_b16 a[166:167], v12 offset:61440
    v_mfma_f32_16x16x32_bf16 v[176:179], a[176:179], a[0:3], 0
    s_waitcnt lgkmcnt(8)
    ds_read_b64_tr_b16 a[168:169], v13 offset:49152
    v_mfma_f32_16x16x32_bf16 v[176:179], a[180:183], a[8:11], v[176:179]
    ds_read_b64_tr_b16 a[170:171], v13 offset:53248
    v_mfma_f32_16x16x32_bf16 v[180:183], a[180:183], a[12:15], 0
    ds_read_b64_tr_b16 a[172:173], v13 offset:57344
    v_mfma_f32_16x16x32_bf16 v[180:183], a[176:179], a[4:7], v[180:183]
    s_waitcnt lgkmcnt(9)
    ds_read_b64_tr_b16 a[174:175], v13 offset:61440
    v_mfma_f32_16x16x32_bf16 v[188:191], a[184:187], a[4:7], 0
    s_waitcnt lgkmcnt(8)
    ds_read_b64_tr_b16 a[176:177], v14 offset:49152
    v_mfma_f32_16x16x32_bf16 v[188:191], a[188:191], a[12:15], v[188:191]
    ds_read_b64_tr_b16 a[178:179], v14 offset:53248
    v_mfma_f32_16x16x32_bf16 v[184:187], a[188:191], a[8:11], 0
    ds_read_b64_tr_b16 a[180:181], v14 offset:57344
    v_mfma_f32_16x16x32_bf16 v[184:187], a[184:187], a[0:3], v[184:187]
    s_waitcnt lgkmcnt(9)
    ds_read_b64_tr_b16 a[182:183], v14 offset:61440
    v_mfma_f32_16x16x32_bf16 v[192:195], a[160:163], a[0:3], 0
    s_waitcnt lgkmcnt(8)
    ds_read_b64_tr_b16 a[184:185], v15 offset:49152
    v_mfma_f32_16x16x32_bf16 v[192:195], a[164:167], a[8:11], v[192:195]
    ds_read_b64_tr_b16 a[186:187], v15 offset:53248
    v_mfma_f32_16x16x32_bf16 v[196:199], a[164:167], a[12:15], 0
    ds_read_b64_tr_b16 a[188:189], v15 offset:57344
    v_mfma_f32_16x16x32_bf16 v[196:199], a[160:163], a[4:7], v[196:199]
    s_waitcnt lgkmcnt(9)
    ds_read_b64_tr_b16 a[190:191], v15 offset:61440
    v_mfma_f32_16x16x32_bf16 v[204:207], a[168:171], a[4:7], 0
    s_waitcnt lgkmcnt(8)
    ds_read_b64_tr_b16 a[160:161], v16 offset:49152
    v_mfma_f32_16x16x32_bf16 v[204:207], a[172:175], a[12:15], v[204:207]
    ds_read_b64_tr_b16 a[162:163], v16 offset:53248
    v_mfma_f32_16x16x32_bf16 v[200:203], a[172:175], a[8:11], 0
    ds_read_b64_tr_b16 a[164:165], v16 offset:57344
    v_mfma_f32_16x16x32_bf16 v[200:203], a[168:171], a[0:3], v[200:203]
    s_waitcnt lgkmcnt(9)
    ds_read_b64_tr_b16 a[166:167], v16 offset:61440
    v_mfma_f32_16x16x32_bf16 v[208:211], a[176:179], a[0:3], 0
    s_waitcnt lgkmcnt(8)
    ds_read_b64_tr_b16 a[168:169], v17 offset:49152
    v_mfma_f32_16x16x32_bf16 v[208:211], a[180:183], a[8:11], v[208:211]
    ds_read_b64_tr_b16 a[170:171], v17 offset:53248
    v_mfma_f32_16x16x32_bf16 v[212:215], a[180:183], a[12:15], 0
    ds_read_b64_tr_b16 a[172:173], v17 offset:57344
    v_mfma_f32_16x16x32_bf16 v[212:215], a[176:179], a[4:7], v[212:215]
    s_waitcnt lgkmcnt(9)
    ds_read_b64_tr_b16 a[174:175], v17 offset:61440
    v_mfma_f32_16x16x32_bf16 v[220:223], a[184:187], a[4:7], 0
    s_waitcnt lgkmcnt(8)
    ds_read_b64_tr_b16 a[176:177], v18 offset:49152
    v_mfma_f32_16x16x32_bf16 v[220:223], a[188:191], a[12:15], v[220:223]
    ds_read_b64_tr_b16 a[178:179], v18 offset:53248
    v_mfma_f32_16x16x32_bf16 v[216:219], a[188:191], a[8:11], 0
    ds_read_b64_tr_b16 a[180:181], v18 offset:57344
    v_mfma_f32_16x16x32_bf16 v[216:219], a[184:187], a[0:3], v[216:219]
    s_waitcnt lgkmcnt(9)
    ds_read_b64_tr_b16 a[182:183], v18 offset:61440
    v_mfma_f32_16x16x32_bf16 v[224:227], a[160:163], a[0:3], 0
    s_waitcnt lgkmcnt(8)
    ds_read_b64_tr_b16 a[184:185], v19 offset:49152
    v_mfma_f32_16x16x32_bf16 v[224:227], a[164:167], a[8:11], v[224:227]
Ltour0:
    s_cbranch_execz Ltour4
    ds_read_b64_tr_b16 a[186:187], v19 offset:53248
    v_mfma_f32_16x16x32_bf16 v[228:231], a[164:167], a[12:15], 0
    ds_read_b64_tr_b16 a[188:189], v19 offset:57344
    v_mfma_f32_16x16x32_bf16 v[228:231], a[160:163], a[4:7], v[228:231]
    s_waitcnt lgkmcnt(9)
    ds_read_b64_tr_b16 a[190:191], v19 offset:61440
    s_barrier
    v_mfma_f32_16x16x32_bf16 v[236:239], a[168:171], a[4:7], 0
    s_waitcnt lgkmcnt(8)
    ds_read_b64_tr_b16 a[160:161], v20 offset:0
    v_mfma_f32_16x16x32_bf16 v[236:239], a[172:175], a[12:15], v[236:239]
    s_add_u32 s49, s44, 1572864
    ds_read_b64_tr_b16 a[162:163], v20 offset:4096
    v_mfma_f32_16x16x32_bf16 v[232:235], a[172:175], a[8:11], 0
    s_add_u32 m0, s42, 131072
    ds_read_b64_tr_b16 a[164:165], v20 offset:8192
    v_mfma_f32_16x16x32_bf16 v[232:235], a[168:171], a[0:3], v[232:235]
    s_waitcnt lgkmcnt(9)
    buffer_load_dwordx4 v42, s[16:19], s49 offen lds
    v_mfma_f32_16x16x32_bf16 v[240:243], a[176:179], a[0:3], 0
    s_waitcnt lgkmcnt(7)
    ds_read_b64_tr_b16 a[166:167], v20 offset:12288
    ds_read_b64_tr_b16 a[168:169], v21 offset:0
    v_mfma_f32_16x16x32_bf16 v[240:243], a[180:183], a[8:11], v[240:243]
    ds_read_b64_tr_b16 a[170:171], v21 offset:4096
    v_mfma_f32_16x16x32_bf16 v[244:247], a[180:183], a[12:15], 0
    ds_read_b64_tr_b16 a[172:173], v21 offset:8192
    v_mfma_f32_16x16x32_bf16 v[244:247], a[176:179], a[4:7], v[244:247]
    s_waitcnt lgkmcnt(9)
    buffer_load_dwordx4 v43, s[16:19], s49 offen offset:1024 lds
    v_mfma_f32_16x16x32_bf16 v[252:255], a[184:187], a[4:7], 0
    s_waitcnt lgkmcnt(7)
    ds_read_b64_tr_b16 a[174:175], v21 offset:12288
    ds_read_b64_tr_b16 a[176:177], v22 offset:0
    v_mfma_f32_16x16x32_bf16 v[252:255], a[188:191], a[12:15], v[252:255]
    ds_read_b64_tr_b16 a[178:179], v22 offset:4096
    v_mfma_f32_16x16x32_bf16 v[248:251], a[188:191], a[8:11], 0
    ds_read_b64_tr_b16 a[180:181], v22 offset:8192
    v_mfma_f32_16x16x32_bf16 v[248:251], a[184:187], a[0:3], v[248:251]
    s_waitcnt vmcnt(10)
    s_waitcnt lgkmcnt(9)
    buffer_load_dwordx4 v44, s[16:19], s49 offen offset:2048 lds
    v_mfma_f32_16x16x32_bf16 v[128:131], a[160:163], a[16:19], v[128:131]
    s_waitcnt vmcnt(10)
    s_waitcnt lgkmcnt(7)
    ds_read_b64_tr_b16 a[182:183], v22 offset:12288
    ds_read_b64_tr_b16 a[184:185], v23 offset:0
    v_mfma_f32_16x16x32_bf16 v[128:131], a[164:167], a[24:27], v[128:131]
    s_waitcnt vmcnt(8)
    ds_read_b64_tr_b16 a[186:187], v23 offset:4096
    v_mfma_f32_16x16x32_bf16 v[132:135], a[164:167], a[28:31], v[132:135]
    ds_read_b64_tr_b16 a[188:189], v23 offset:8192
    v_mfma_f32_16x16x32_bf16 v[132:135], a[160:163], a[20:23], v[132:135]
    s_waitcnt lgkmcnt(9)
    buffer_load_dwordx4 v45, s[16:19], s49 offen offset:3072 lds
    v_mfma_f32_16x16x32_bf16 v[140:143], a[168:171], a[20:23], v[140:143]
    s_waitcnt lgkmcnt(7)
    ds_read_b64_tr_b16 a[190:191], v23 offset:12288
    ds_read_b64_tr_b16 a[160:161], v24 offset:0
    v_mfma_f32_16x16x32_bf16 v[140:143], a[172:175], a[28:31], v[140:143]
    s_add_u32 s49, s44, 1573120
    ds_read_b64_tr_b16 a[162:163], v24 offset:4096
    v_mfma_f32_16x16x32_bf16 v[136:139], a[172:175], a[24:27], v[136:139]
    s_add_u32 m0, s42, 147456
    ds_read_b64_tr_b16 a[164:165], v24 offset:8192
    v_mfma_f32_16x16x32_bf16 v[136:139], a[168:171], a[16:19], v[136:139]
    s_waitcnt lgkmcnt(9)
    buffer_load_dwordx4 v42, s[16:19], s49 offen lds
    v_mfma_f32_16x16x32_bf16 v[144:147], a[176:179], a[16:19], v[144:147]
    s_waitcnt lgkmcnt(7)
    ds_read_b64_tr_b16 a[166:167], v24 offset:12288
    ds_read_b64_tr_b16 a[168:169], v25 offset:0
    v_mfma_f32_16x16x32_bf16 v[144:147], a[180:183], a[24:27], v[144:147]
    ds_read_b64_tr_b16 a[170:171], v25 offset:4096
    v_mfma_f32_16x16x32_bf16 v[148:151], a[180:183], a[28:31], v[148:151]
    ds_read_b64_tr_b16 a[172:173], v25 offset:8192
    v_mfma_f32_16x16x32_bf16 v[148:151], a[176:179], a[20:23], v[148:151]
    s_waitcnt lgkmcnt(9)
    buffer_load_dwordx4 v43, s[16:19], s49 offen offset:1024 lds
    v_mfma_f32_16x16x32_bf16 v[156:159], a[184:187], a[20:23], v[156:159]
    s_waitcnt lgkmcnt(7)
    ds_read_b64_tr_b16 a[174:175], v25 offset:12288
    ds_read_b64_tr_b16 a[176:177], v26 offset:0
    v_mfma_f32_16x16x32_bf16 v[156:159], a[188:191], a[28:31], v[156:159]
    ds_read_b64_tr_b16 a[178:179], v26 offset:4096
    v_mfma_f32_16x16x32_bf16 v[152:155], a[188:191], a[24:27], v[152:155]
    ds_read_b64_tr_b16 a[180:181], v26 offset:8192
    v_mfma_f32_16x16x32_bf16 v[152:155], a[184:187], a[16:19], v[152:155]
    s_waitcnt lgkmcnt(9)
    buffer_load_dwordx4 v44, s[16:19], s49 offen offset:2048 lds
    v_mfma_f32_16x16x32_bf16 v[160:163], a[160:163], a[16:19], v[160:163]
    s_waitcnt lgkmcnt(7)
    ds_read_b64_tr_b16 a[182:183], v26 offset:12288
    ds_read_b64_tr_b16 a[184:185], v27 offset:0
    v_mfma_f32_16x16x32_bf16 v[160:163], a[164:167], a[24:27], v[160:163]
    ds_read_b64_tr_b16 a[186:187], v27 offset:4096
    v_mfma_f32_16x16x32_bf16 v[164:167], a[164:167], a[28:31], v[164:167]
    ds_read_b64_tr_b16 a[188:189], v27 offset:8192
    v_mfma_f32_16x16x32_bf16 v[164:167], a[160:163], a[20:23], v[164:167]
    s_waitcnt lgkmcnt(9)
    buffer_load_dwordx4 v45, s[16:19], s49 offen offset:3072 lds
    v_mfma_f32_16x16x32_bf16 v[172:175], a[168:171], a[20:23], v[172:175]
    s_waitcnt lgkmcnt(7)
    ds_read_b64_tr_b16 a[190:191], v27 offset:12288
    ds_read_b64_tr_b16 a[160:161], v20 offset:16384
    v_mfma_f32_16x16x32_bf16 v[172:175], a[172:175], a[28:31], v[172:175]
    ds_read_b64_tr_b16 a[162:163], v20 offset:20480
    v_mfma_f32_16x16x32_bf16 v[168:171], a[172:175], a[24:27], v[168:171]
    ds_read_b64_tr_b16 a[164:165], v20 offset:24576
    v_mfma_f32_16x16x32_bf16 v[168:171], a[168:171], a[16:19], v[168:171]
    s_waitcnt lgkmcnt(9)
    buffer_load_dwordx4 a[48:51], v51, s[24:27], s46 offen offset:768 sc1
    v_mfma_f32_16x16x32_bf16 v[176:179], a[176:179], a[16:19], v[176:179]
    s_waitcnt lgkmcnt(7)
    ds_read_b64_tr_b16 a[166:167], v20 offset:28672
    ds_read_b64_tr_b16 a[168:169], v21 offset:16384
    v_mfma_f32_16x16x32_bf16 v[176:179], a[180:183], a[24:27], v[176:179]
    ds_read_b64_tr_b16 a[170:171], v21 offset:20480
    v_mfma_f32_16x16x32_bf16 v[180:183], a[180:183], a[28:31], v[180:183]
    ds_read_b64_tr_b16 a[172:173], v21 offset:24576
    v_mfma_f32_16x16x32_bf16 v[180:183], a[176:179], a[20:23], v[180:183]
    s_waitcnt lgkmcnt(9)
    buffer_load_dwordx4 a[56:59], v51, s[24:27], s46 offen offset:896 sc1
    v_mfma_f32_16x16x32_bf16 v[188:191], a[184:187], a[20:23], v[188:191]
    s_waitcnt lgkmcnt(7)
    ds_read_b64_tr_b16 a[174:175], v21 offset:28672
    ds_read_b64_tr_b16 a[176:177], v22 offset:16384
    v_mfma_f32_16x16x32_bf16 v[188:191], a[188:191], a[28:31], v[188:191]
    ds_read_b64_tr_b16 a[178:179], v22 offset:20480
    v_mfma_f32_16x16x32_bf16 v[184:187], a[188:191], a[24:27], v[184:187]
    ds_read_b64_tr_b16 a[180:181], v22 offset:24576
    v_mfma_f32_16x16x32_bf16 v[184:187], a[184:187], a[16:19], v[184:187]
    s_waitcnt lgkmcnt(9)
    buffer_load_dwordx4 a[52:55], v51, s[24:27], s43 offen offset:768 sc1
    v_mfma_f32_16x16x32_bf16 v[192:195], a[160:163], a[16:19], v[192:195]
    s_waitcnt lgkmcnt(7)
    ds_read_b64_tr_b16 a[182:183], v22 offset:28672
    ds_read_b64_tr_b16 a[184:185], v23 offset:16384
    v_mfma_f32_16x16x32_bf16 v[192:195], a[164:167], a[24:27], v[192:195]
    ds_read_b64_tr_b16 a[186:187], v23 offset:20480
    v_mfma_f32_16x16x32_bf16 v[196:199], a[164:167], a[28:31], v[196:199]
    ds_read_b64_tr_b16 a[188:189], v23 offset:24576
    v_mfma_f32_16x16x32_bf16 v[196:199], a[160:163], a[20:23], v[196:199]
    s_waitcnt lgkmcnt(9)
    buffer_load_dwordx4 a[60:63], v51, s[24:27], s43 offen offset:896 sc1
    v_mfma_f32_16x16x32_bf16 v[204:207], a[168:171], a[20:23], v[204:207]
    s_waitcnt lgkmcnt(7)
    ds_read_b64_tr_b16 a[190:191], v23 offset:28672
    ds_read_b64_tr_b16 a[160:161], v24 offset:16384
    v_mfma_f32_16x16x32_bf16 v[204:207], a[172:175], a[28:31], v[204:207]
    ds_read_b64_tr_b16 a[162:163], v24 offset:20480
    v_mfma_f32_16x16x32_bf16 v[200:203], a[172:175], a[24:27], v[200:203]
    ds_read_b64_tr_b16 a[164:165], v24 offset:24576
    v_mfma_f32_16x16x32_bf16 v[200:203], a[168:171], a[16:19], v[200:203]
    s_waitcnt lgkmcnt(9)
    ds_read_b64_tr_b16 a[166:167], v24 offset:28672
    v_mfma_f32_16x16x32_bf16 v[208:211], a[176:179], a[16:19], v[208:211]
    s_waitcnt lgkmcnt(8)
    ds_read_b64_tr_b16 a[168:169], v25 offset:16384
    v_mfma_f32_16x16x32_bf16 v[208:211], a[180:183], a[24:27], v[208:211]
    ds_read_b64_tr_b16 a[170:171], v25 offset:20480
    v_mfma_f32_16x16x32_bf16 v[212:215], a[180:183], a[28:31], v[212:215]
    ds_read_b64_tr_b16 a[172:173], v25 offset:24576
    v_mfma_f32_16x16x32_bf16 v[212:215], a[176:179], a[20:23], v[212:215]
    s_waitcnt lgkmcnt(9)
    ds_read_b64_tr_b16 a[174:175], v25 offset:28672
    v_mfma_f32_16x16x32_bf16 v[220:223], a[184:187], a[20:23], v[220:223]
    s_waitcnt lgkmcnt(8)
    ds_read_b64_tr_b16 a[176:177], v26 offset:16384
    v_mfma_f32_16x16x32_bf16 v[220:223], a[188:191], a[28:31], v[220:223]
    ds_read_b64_tr_b16 a[178:179], v26 offset:20480
    v_mfma_f32_16x16x32_bf16 v[216:219], a[188:191], a[24:27], v[216:219]
    ds_read_b64_tr_b16 a[180:181], v26 offset:24576
    v_mfma_f32_16x16x32_bf16 v[216:219], a[184:187], a[16:19], v[216:219]
    s_waitcnt lgkmcnt(9)
    ds_read_b64_tr_b16 a[182:183], v26 offset:28672
    v_mfma_f32_16x16x32_bf16 v[224:227], a[160:163], a[16:19], v[224:227]
    s_waitcnt lgkmcnt(8)
    ds_read_b64_tr_b16 a[184:185], v27 offset:16384
    v_mfma_f32_16x16x32_bf16 v[224:227], a[164:167], a[24:27], v[224:227]
    ds_read_b64_tr_b16 a[186:187], v27 offset:20480
    v_mfma_f32_16x16x32_bf16 v[228:231], a[164:167], a[28:31], v[228:231]
    ds_read_b64_tr_b16 a[188:189], v27 offset:24576
    v_mfma_f32_16x16x32_bf16 v[228:231], a[160:163], a[20:23], v[228:231]
    s_waitcnt lgkmcnt(9)
    ds_read_b64_tr_b16 a[190:191], v27 offset:28672
    s_barrier
    v_mfma_f32_16x16x32_bf16 v[236:239], a[168:171], a[20:23], v[236:239]
    s_waitcnt lgkmcnt(8)
    ds_read_b64_tr_b16 a[160:161], v20 offset:32768
    v_mfma_f32_16x16x32_bf16 v[236:239], a[172:175], a[28:31], v[236:239]
    s_add_u32 s49, s44, 2097152
    ds_read_b64_tr_b16 a[162:163], v20 offset:36864
    v_mfma_f32_16x16x32_bf16 v[232:235], a[172:175], a[24:27], v[232:235]
    s_add_u32 m0, s42, 0
    ds_read_b64_tr_b16 a[164:165], v20 offset:40960
    v_mfma_f32_16x16x32_bf16 v[232:235], a[168:171], a[16:19], v[232:235]
    s_waitcnt lgkmcnt(9)
    buffer_load_dwordx4 v42, s[16:19], s49 offen lds
    v_mfma_f32_16x16x32_bf16 v[240:243], a[176:179], a[16:19], v[240:243]
    s_waitcnt lgkmcnt(7)
    ds_read_b64_tr_b16 a[166:167], v20 offset:45056
    ds_read_b64_tr_b16 a[168:169], v21 offset:32768
    v_mfma_f32_16x16x32_bf16 v[240:243], a[180:183], a[24:27], v[240:243]
    ds_read_b64_tr_b16 a[170:171], v21 offset:36864
    v_mfma_f32_16x16x32_bf16 v[244:247], a[180:183], a[28:31], v[244:247]
    ds_read_b64_tr_b16 a[172:173], v21 offset:40960
    v_mfma_f32_16x16x32_bf16 v[244:247], a[176:179], a[20:23], v[244:247]
    s_waitcnt lgkmcnt(9)
    buffer_load_dwordx4 v43, s[16:19], s49 offen offset:1024 lds
    v_mfma_f32_16x16x32_bf16 v[252:255], a[184:187], a[20:23], v[252:255]
    s_waitcnt lgkmcnt(7)
    ds_read_b64_tr_b16 a[174:175], v21 offset:45056
    ds_read_b64_tr_b16 a[176:177], v22 offset:32768
    v_mfma_f32_16x16x32_bf16 v[252:255], a[188:191], a[28:31], v[252:255]
    ds_read_b64_tr_b16 a[178:179], v22 offset:36864
    v_mfma_f32_16x16x32_bf16 v[248:251], a[188:191], a[24:27], v[248:251]
    ds_read_b64_tr_b16 a[180:181], v22 offset:40960
    v_mfma_f32_16x16x32_bf16 v[248:251], a[184:187], a[16:19], v[248:251]
    s_waitcnt vmcnt(18)
    s_waitcnt lgkmcnt(9)
    buffer_load_dwordx4 v44, s[16:19], s49 offen offset:2048 lds
    v_mfma_f32_16x16x32_bf16 v[128:131], a[160:163], a[32:35], v[128:131]
    s_waitcnt vmcnt(18)
    s_waitcnt lgkmcnt(7)
    ds_read_b64_tr_b16 a[182:183], v22 offset:45056
    ds_read_b64_tr_b16 a[184:185], v23 offset:32768
    v_mfma_f32_16x16x32_bf16 v[128:131], a[164:167], a[40:43], v[128:131]
    s_waitcnt vmcnt(16)
    ds_read_b64_tr_b16 a[186:187], v23 offset:36864
    v_mfma_f32_16x16x32_bf16 v[132:135], a[164:167], a[44:47], v[132:135]
    ds_read_b64_tr_b16 a[188:189], v23 offset:40960
    v_mfma_f32_16x16x32_bf16 v[132:135], a[160:163], a[36:39], v[132:135]
    s_waitcnt lgkmcnt(9)
    buffer_load_dwordx4 v45, s[16:19], s49 offen offset:3072 lds
    v_mfma_f32_16x16x32_bf16 v[140:143], a[168:171], a[36:39], v[140:143]
    s_waitcnt lgkmcnt(7)
    ds_read_b64_tr_b16 a[190:191], v23 offset:45056
    ds_read_b64_tr_b16 a[160:161], v24 offset:32768
    v_mfma_f32_16x16x32_bf16 v[140:143], a[172:175], a[44:47], v[140:143]
    s_add_u32 s49, s44, 2097408
    ds_read_b64_tr_b16 a[162:163], v24 offset:36864
    v_mfma_f32_16x16x32_bf16 v[136:139], a[172:175], a[40:43], v[136:139]
    s_add_u32 m0, s42, 16384
    ds_read_b64_tr_b16 a[164:165], v24 offset:40960
    v_mfma_f32_16x16x32_bf16 v[136:139], a[168:171], a[32:35], v[136:139]
    s_waitcnt lgkmcnt(9)
    buffer_load_dwordx4 v42, s[16:19], s49 offen lds
    v_mfma_f32_16x16x32_bf16 v[144:147], a[176:179], a[32:35], v[144:147]
    s_waitcnt lgkmcnt(7)
    ds_read_b64_tr_b16 a[166:167], v24 offset:45056
    ds_read_b64_tr_b16 a[168:169], v25 offset:32768
    v_mfma_f32_16x16x32_bf16 v[144:147], a[180:183], a[40:43], v[144:147]
    ds_read_b64_tr_b16 a[170:171], v25 offset:36864
    v_mfma_f32_16x16x32_bf16 v[148:151], a[180:183], a[44:47], v[148:151]
    ds_read_b64_tr_b16 a[172:173], v25 offset:40960
    v_mfma_f32_16x16x32_bf16 v[148:151], a[176:179], a[36:39], v[148:151]
    s_waitcnt lgkmcnt(9)
    buffer_load_dwordx4 v43, s[16:19], s49 offen offset:1024 lds
    v_mfma_f32_16x16x32_bf16 v[156:159], a[184:187], a[36:39], v[156:159]
    s_waitcnt lgkmcnt(7)
    ds_read_b64_tr_b16 a[174:175], v25 offset:45056
    ds_read_b64_tr_b16 a[176:177], v26 offset:32768
    v_mfma_f32_16x16x32_bf16 v[156:159], a[188:191], a[44:47], v[156:159]
    ds_read_b64_tr_b16 a[178:179], v26 offset:36864
    v_mfma_f32_16x16x32_bf16 v[152:155], a[188:191], a[40:43], v[152:155]
    ds_read_b64_tr_b16 a[180:181], v26 offset:40960
    v_mfma_f32_16x16x32_bf16 v[152:155], a[184:187], a[32:35], v[152:155]
    s_waitcnt lgkmcnt(9)
    buffer_load_dwordx4 v44, s[16:19], s49 offen offset:2048 lds
    v_mfma_f32_16x16x32_bf16 v[160:163], a[160:163], a[32:35], v[160:163]
    s_waitcnt lgkmcnt(7)
    ds_read_b64_tr_b16 a[182:183], v26 offset:45056
    ds_read_b64_tr_b16 a[184:185], v27 offset:32768
    v_mfma_f32_16x16x32_bf16 v[160:163], a[164:167], a[40:43], v[160:163]
    ds_read_b64_tr_b16 a[186:187], v27 offset:36864
    v_mfma_f32_16x16x32_bf16 v[164:167], a[164:167], a[44:47], v[164:167]
    ds_read_b64_tr_b16 a[188:189], v27 offset:40960
    v_mfma_f32_16x16x32_bf16 v[164:167], a[160:163], a[36:39], v[164:167]
    s_waitcnt lgkmcnt(9)
    buffer_load_dwordx4 v45, s[16:19], s49 offen offset:3072 lds
    v_mfma_f32_16x16x32_bf16 v[172:175], a[168:171], a[36:39], v[172:175]
    s_waitcnt lgkmcnt(7)
    ds_read_b64_tr_b16 a[190:191], v27 offset:45056
    ds_read_b64_tr_b16 a[160:161], v20 offset:49152
    v_mfma_f32_16x16x32_bf16 v[172:175], a[172:175], a[44:47], v[172:175]
    ds_read_b64_tr_b16 a[162:163], v20 offset:53248
    v_mfma_f32_16x16x32_bf16 v[168:171], a[172:175], a[40:43], v[168:171]
    ds_read_b64_tr_b16 a[164:165], v20 offset:57344
    v_mfma_f32_16x16x32_bf16 v[168:171], a[168:171], a[32:35], v[168:171]
    s_waitcnt lgkmcnt(9)
    buffer_load_dwordx4 a[64:67], v51, s[24:27], s46 offen offset:1024 sc1
    v_mfma_f32_16x16x32_bf16 v[176:179], a[176:179], a[32:35], v[176:179]
    s_waitcnt lgkmcnt(7)
    ds_read_b64_tr_b16 a[166:167], v20 offset:61440
    ds_read_b64_tr_b16 a[168:169], v21 offset:49152
    v_mfma_f32_16x16x32_bf16 v[176:179], a[180:183], a[40:43], v[176:179]
    ds_read_b64_tr_b16 a[170:171], v21 offset:53248
    v_mfma_f32_16x16x32_bf16 v[180:183], a[180:183], a[44:47], v[180:183]
    ds_read_b64_tr_b16 a[172:173], v21 offset:57344
    v_mfma_f32_16x16x32_bf16 v[180:183], a[176:179], a[36:39], v[180:183]
    s_waitcnt lgkmcnt(9)
    buffer_load_dwordx4 a[72:75], v51, s[24:27], s46 offen offset:1152 sc1
    v_mfma_f32_16x16x32_bf16 v[188:191], a[184:187], a[36:39], v[188:191]
    s_waitcnt lgkmcnt(7)
    ds_read_b64_tr_b16 a[174:175], v21 offset:61440
    ds_read_b64_tr_b16 a[176:177], v22 offset:49152
    v_mfma_f32_16x16x32_bf16 v[188:191], a[188:191], a[44:47], v[188:191]
    ds_read_b64_tr_b16 a[178:179], v22 offset:53248
    v_mfma_f32_16x16x32_bf16 v[184:187], a[188:191], a[40:43], v[184:187]
    ds_read_b64_tr_b16 a[180:181], v22 offset:57344
    v_mfma_f32_16x16x32_bf16 v[184:187], a[184:187], a[32:35], v[184:187]
    s_waitcnt lgkmcnt(9)
    buffer_load_dwordx4 a[68:71], v51, s[24:27], s43 offen offset:1024 sc1
    v_mfma_f32_16x16x32_bf16 v[192:195], a[160:163], a[32:35], v[192:195]
    s_waitcnt lgkmcnt(7)
    ds_read_b64_tr_b16 a[182:183], v22 offset:61440
    ds_read_b64_tr_b16 a[184:185], v23 offset:49152
    v_mfma_f32_16x16x32_bf16 v[192:195], a[164:167], a[40:43], v[192:195]
    ds_read_b64_tr_b16 a[186:187], v23 offset:53248
    v_mfma_f32_16x16x32_bf16 v[196:199], a[164:167], a[44:47], v[196:199]
    ds_read_b64_tr_b16 a[188:189], v23 offset:57344
    v_mfma_f32_16x16x32_bf16 v[196:199], a[160:163], a[36:39], v[196:199]
    s_waitcnt lgkmcnt(9)
    buffer_load_dwordx4 a[76:79], v51, s[24:27], s43 offen offset:1152 sc1
    v_mfma_f32_16x16x32_bf16 v[204:207], a[168:171], a[36:39], v[204:207]
    s_waitcnt lgkmcnt(7)
    ds_read_b64_tr_b16 a[190:191], v23 offset:61440
    ds_read_b64_tr_b16 a[160:161], v24 offset:49152
    v_mfma_f32_16x16x32_bf16 v[204:207], a[172:175], a[44:47], v[204:207]
    ds_read_b64_tr_b16 a[162:163], v24 offset:53248
    v_mfma_f32_16x16x32_bf16 v[200:203], a[172:175], a[40:43], v[200:203]
    ds_read_b64_tr_b16 a[164:165], v24 offset:57344
    v_mfma_f32_16x16x32_bf16 v[200:203], a[168:171], a[32:35], v[200:203]
    s_waitcnt lgkmcnt(9)
    buffer_load_dwordx4 a[80:83], v51, s[24:27], s46 offen offset:1280 sc1
    v_mfma_f32_16x16x32_bf16 v[208:211], a[176:179], a[32:35], v[208:211]
    s_waitcnt lgkmcnt(7)
    ds_read_b64_tr_b16 a[166:167], v24 offset:61440
    ds_read_b64_tr_b16 a[168:169], v25 offset:49152
    v_mfma_f32_16x16x32_bf16 v[208:211], a[180:183], a[40:43], v[208:211]
    ds_read_b64_tr_b16 a[170:171], v25 offset:53248
    v_mfma_f32_16x16x32_bf16 v[212:215], a[180:183], a[44:47], v[212:215]
    ds_read_b64_tr_b16 a[172:173], v25 offset:57344
    v_mfma_f32_16x16x32_bf16 v[212:215], a[176:179], a[36:39], v[212:215]
    s_waitcnt lgkmcnt(9)
    buffer_load_dwordx4 a[88:91], v51, s[24:27], s46 offen offset:1408 sc1
    v_mfma_f32_16x16x32_bf16 v[220:223], a[184:187], a[36:39], v[220:223]
    s_waitcnt lgkmcnt(7)
    ds_read_b64_tr_b16 a[174:175], v25 offset:61440
    ds_read_b64_tr_b16 a[176:177], v26 offset:49152
    v_mfma_f32_16x16x32_bf16 v[220:223], a[188:191], a[44:47], v[220:223]
    ds_read_b64_tr_b16 a[178:179], v26 offset:53248
    v_mfma_f32_16x16x32_bf16 v[216:219], a[188:191], a[40:43], v[216:219]
    ds_read_b64_tr_b16 a[180:181], v26 offset:57344
    v_mfma_f32_16x16x32_bf16 v[216:219], a[184:187], a[32:35], v[216:219]
    s_waitcnt lgkmcnt(9)
    ds_read_b64_tr_b16 a[182:183], v26 offset:61440
    v_mfma_f32_16x16x32_bf16 v[224:227], a[160:163], a[32:35], v[224:227]
    s_waitcnt lgkmcnt(8)
    ds_read_b64_tr_b16 a[184:185], v27 offset:49152
    v_mfma_f32_16x16x32_bf16 v[224:227], a[164:167], a[40:43], v[224:227]
    ds_read_b64_tr_b16 a[186:187], v27 offset:53248
    v_mfma_f32_16x16x32_bf16 v[228:231], a[164:167], a[44:47], v[228:231]
    ds_read_b64_tr_b16 a[188:189], v27 offset:57344
    v_mfma_f32_16x16x32_bf16 v[228:231], a[160:163], a[36:39], v[228:231]
    s_waitcnt lgkmcnt(9)
    ds_read_b64_tr_b16 a[190:191], v27 offset:61440
    s_waitcnt vmcnt(18)
    s_barrier
    v_mfma_f32_16x16x32_bf16 v[236:239], a[168:171], a[36:39], v[236:239]
    s_waitcnt lgkmcnt(8)
    ds_read_b64_tr_b16 a[160:161], v28 offset:0
    v_mfma_f32_16x16x32_bf16 v[236:239], a[172:175], a[44:47], v[236:239]
    s_add_u32 s49, s44, 2621440
    ds_read_b64_tr_b16 a[162:163], v28 offset:4096
    v_mfma_f32_16x16x32_bf16 v[232:235], a[172:175], a[40:43], v[232:235]
    s_add_u32 m0, s42, 32768
    ds_read_b64_tr_b16 a[164:165], v28 offset:8192
    v_mfma_f32_16x16x32_bf16 v[232:235], a[168:171], a[32:35], v[232:235]
    s_waitcnt lgkmcnt(9)
    buffer_load_dwordx4 v42, s[16:19], s49 offen lds
    v_mfma_f32_16x16x32_bf16 v[240:243], a[176:179], a[32:35], v[240:243]
    s_waitcnt lgkmcnt(7)
    ds_read_b64_tr_b16 a[166:167], v28 offset:12288
    ds_read_b64_tr_b16 a[168:169], v29 offset:0
    v_mfma_f32_16x16x32_bf16 v[240:243], a[180:183], a[40:43], v[240:243]
    ds_read_b64_tr_b16 a[170:171], v29 offset:4096
    v_mfma_f32_16x16x32_bf16 v[244:247], a[180:183], a[44:47], v[244:247]
    ds_read_b64_tr_b16 a[172:173], v29 offset:8192
    v_mfma_f32_16x16x32_bf16 v[244:247], a[176:179], a[36:39], v[244:247]
    s_waitcnt lgkmcnt(9)
    buffer_load_dwordx4 v43, s[16:19], s49 offen offset:1024 lds
    v_mfma_f32_16x16x32_bf16 v[252:255], a[184:187], a[36:39], v[252:255]
    s_waitcnt lgkmcnt(7)
    ds_read_b64_tr_b16 a[174:175], v29 offset:12288
    ds_read_b64_tr_b16 a[176:177], v30 offset:0
    v_mfma_f32_16x16x32_bf16 v[252:255], a[188:191], a[44:47], v[252:255]
    ds_read_b64_tr_b16 a[178:179], v30 offset:4096
    v_mfma_f32_16x16x32_bf16 v[248:251], a[188:191], a[40:43], v[248:251]
    ds_read_b64_tr_b16 a[180:181], v30 offset:8192
    v_mfma_f32_16x16x32_bf16 v[248:251], a[184:187], a[32:35], v[248:251]
    s_waitcnt vmcnt(19)
    s_waitcnt lgkmcnt(9)
    buffer_load_dwordx4 v44, s[16:19], s49 offen offset:2048 lds
    v_mfma_f32_16x16x32_bf16 v[128:131], a[160:163], a[48:51], v[128:131]
    s_waitcnt vmcnt(19)
    s_waitcnt lgkmcnt(7)
    ds_read_b64_tr_b16 a[182:183], v30 offset:12288
    ds_read_b64_tr_b16 a[184:185], v31 offset:0
    v_mfma_f32_16x16x32_bf16 v[128:131], a[164:167], a[56:59], v[128:131]
    s_waitcnt vmcnt(17)
    ds_read_b64_tr_b16 a[186:187], v31 offset:4096
    v_mfma_f32_16x16x32_bf16 v[132:135], a[164:167], a[60:63], v[132:135]
    ds_read_b64_tr_b16 a[188:189], v31 offset:8192
    v_mfma_f32_16x16x32_bf16 v[132:135], a[160:163], a[52:55], v[132:135]
    s_waitcnt lgkmcnt(9)
    buffer_load_dwordx4 v45, s[16:19], s49 offen offset:3072 lds
    v_mfma_f32_16x16x32_bf16 v[140:143], a[168:171], a[52:55], v[140:143]
    s_waitcnt lgkmcnt(7)
    ds_read_b64_tr_b16 a[190:191], v31 offset:12288
    ds_read_b64_tr_b16 a[160:161], v32 offset:0
    v_mfma_f32_16x16x32_bf16 v[140:143], a[172:175], a[60:63], v[140:143]
    s_add_u32 s49, s44, 3145728
    ds_read_b64_tr_b16 a[162:163], v32 offset:4096
    v_mfma_f32_16x16x32_bf16 v[136:139], a[172:175], a[56:59], v[136:139]
    s_add_u32 m0, s42, 49152
    ds_read_b64_tr_b16 a[164:165], v32 offset:8192
    v_mfma_f32_16x16x32_bf16 v[136:139], a[168:171], a[48:51], v[136:139]
    s_waitcnt lgkmcnt(9)
    buffer_load_dwordx4 v42, s[16:19], s49 offen lds
    v_mfma_f32_16x16x32_bf16 v[144:147], a[176:179], a[48:51], v[144:147]
    s_waitcnt lgkmcnt(7)
    ds_read_b64_tr_b16 a[166:167], v32 offset:12288
    ds_read_b64_tr_b16 a[168:169], v33 offset:0
    v_mfma_f32_16x16x32_bf16 v[144:147], a[180:183], a[56:59], v[144:147]
    ds_read_b64_tr_b16 a[170:171], v33 offset:4096
    v_mfma_f32_16x16x32_bf16 v[148:151], a[180:183], a[60:63], v[148:151]
    ds_read_b64_tr_b16 a[172:173], v33 offset:8192
    v_mfma_f32_16x16x32_bf16 v[148:151], a[176:179], a[52:55], v[148:151]
    s_waitcnt lgkmcnt(9)
    buffer_load_dwordx4 v43, s[16:19], s49 offen offset:1024 lds
    v_mfma_f32_16x16x32_bf16 v[156:159], a[184:187], a[52:55], v[156:159]
    s_waitcnt lgkmcnt(7)
    ds_read_b64_tr_b16 a[174:175], v33 offset:12288
    ds_read_b64_tr_b16 a[176:177], v34 offset:0
    v_mfma_f32_16x16x32_bf16 v[156:159], a[188:191], a[60:63], v[156:159]
    ds_read_b64_tr_b16 a[178:179], v34 offset:4096
    v_mfma_f32_16x16x32_bf16 v[152:155], a[188:191], a[56:59], v[152:155]
    ds_read_b64_tr_b16 a[180:181], v34 offset:8192
    v_mfma_f32_16x16x32_bf16 v[152:155], a[184:187], a[48:51], v[152:155]
    s_waitcnt lgkmcnt(9)
    buffer_load_dwordx4 v44, s[16:19], s49 offen offset:2048 lds
    v_mfma_f32_16x16x32_bf16 v[160:163], a[160:163], a[48:51], v[160:163]
    s_waitcnt lgkmcnt(7)
    ds_read_b64_tr_b16 a[182:183], v34 offset:12288
    ds_read_b64_tr_b16 a[184:185], v35 offset:0
    v_mfma_f32_16x16x32_bf16 v[160:163], a[164:167], a[56:59], v[160:163]
    ds_read_b64_tr_b16 a[186:187], v35 offset:4096
    v_mfma_f32_16x16x32_bf16 v[164:167], a[164:167], a[60:63], v[164:167]
    ds_read_b64_tr_b16 a[188:189], v35 offset:8192
    v_mfma_f32_16x16x32_bf16 v[164:167], a[160:163], a[52:55], v[164:167]
    s_waitcnt lgkmcnt(9)
    buffer_load_dwordx4 v45, s[16:19], s49 offen offset:3072 lds
    v_mfma_f32_16x16x32_bf16 v[172:175], a[168:171], a[52:55], v[172:175]
    s_waitcnt lgkmcnt(7)
    ds_read_b64_tr_b16 a[190:191], v35 offset:12288
    ds_read_b64_tr_b16 a[160:161], v28 offset:16384
    v_mfma_f32_16x16x32_bf16 v[172:175], a[172:175], a[60:63], v[172:175]
    ds_read_b64_tr_b16 a[162:163], v28 offset:20480
    v_mfma_f32_16x16x32_bf16 v[168:171], a[172:175], a[56:59], v[168:171]
    ds_read_b64_tr_b16 a[164:165], v28 offset:24576
    v_mfma_f32_16x16x32_bf16 v[168:171], a[168:171], a[48:51], v[168:171]
    s_waitcnt lgkmcnt(9)
    buffer_load_dwordx4 a[84:87], v51, s[24:27], s43 offen offset:1280 sc1
    v_mfma_f32_16x16x32_bf16 v[176:179], a[176:179], a[48:51], v[176:179]
    s_waitcnt lgkmcnt(7)
    ds_read_b64_tr_b16 a[166:167], v28 offset:28672
    ds_read_b64_tr_b16 a[168:169], v29 offset:16384
    v_mfma_f32_16x16x32_bf16 v[176:179], a[180:183], a[56:59], v[176:179]
    ds_read_b64_tr_b16 a[170:171], v29 offset:20480
    v_mfma_f32_16x16x32_bf16 v[180:183], a[180:183], a[60:63], v[180:183]
    ds_read_b64_tr_b16 a[172:173], v29 offset:24576
    v_mfma_f32_16x16x32_bf16 v[180:183], a[176:179], a[52:55], v[180:183]
    s_waitcnt lgkmcnt(9)
    buffer_load_dwordx4 a[92:95], v51, s[24:27], s43 offen offset:1408 sc1
    v_mfma_f32_16x16x32_bf16 v[188:191], a[184:187], a[52:55], v[188:191]
    s_waitcnt lgkmcnt(7)
    ds_read_b64_tr_b16 a[174:175], v29 offset:28672
    ds_read_b64_tr_b16 a[176:177], v30 offset:16384
    v_mfma_f32_16x16x32_bf16 v[188:191], a[188:191], a[60:63], v[188:191]
    ds_read_b64_tr_b16 a[178:179], v30 offset:20480
    v_mfma_f32_16x16x32_bf16 v[184:187], a[188:191], a[56:59], v[184:187]
    ds_read_b64_tr_b16 a[180:181], v30 offset:24576
    v_mfma_f32_16x16x32_bf16 v[184:187], a[184:187], a[48:51], v[184:187]
    s_waitcnt lgkmcnt(9)
    buffer_load_dwordx4 a[96:99], v51, s[24:27], s46 offen offset:1536 sc1
    v_mfma_f32_16x16x32_bf16 v[192:195], a[160:163], a[48:51], v[192:195]
    s_waitcnt lgkmcnt(7)
    ds_read_b64_tr_b16 a[182:183], v30 offset:28672
    ds_read_b64_tr_b16 a[184:185], v31 offset:16384
    v_mfma_f32_16x16x32_bf16 v[192:195], a[164:167], a[56:59], v[192:195]
    ds_read_b64_tr_b16 a[186:187], v31 offset:20480
    v_mfma_f32_16x16x32_bf16 v[196:199], a[164:167], a[60:63], v[196:199]
    ds_read_b64_tr_b16 a[188:189], v31 offset:24576
    v_mfma_f32_16x16x32_bf16 v[196:199], a[160:163], a[52:55], v[196:199]
    s_waitcnt lgkmcnt(9)
    buffer_load_dwordx4 a[104:107], v51, s[24:27], s46 offen offset:1664 sc1
    v_mfma_f32_16x16x32_bf16 v[204:207], a[168:171], a[52:55], v[204:207]
    s_waitcnt lgkmcnt(7)
    ds_read_b64_tr_b16 a[190:191], v31 offset:28672
    ds_read_b64_tr_b16 a[160:161], v32 offset:16384
    v_mfma_f32_16x16x32_bf16 v[204:207], a[172:175], a[60:63], v[204:207]
    ds_read_b64_tr_b16 a[162:163], v32 offset:20480
    v_mfma_f32_16x16x32_bf16 v[200:203], a[172:175], a[56:59], v[200:203]
    ds_read_b64_tr_b16 a[164:165], v32 offset:24576
    v_mfma_f32_16x16x32_bf16 v[200:203], a[168:171], a[48:51], v[200:203]
    s_waitcnt lgkmcnt(9)
    buffer_load_dwordx4 a[100:103], v51, s[24:27], s43 offen offset:1536 sc1
    v_mfma_f32_16x16x32_bf16 v[208:211], a[176:179], a[48:51], v[208:211]
    s_waitcnt lgkmcnt(7)
    ds_read_b64_tr_b16 a[166:167], v32 offset:28672
    ds_read_b64_tr_b16 a[168:169], v33 offset:16384
    v_mfma_f32_16x16x32_bf16 v[208:211], a[180:183], a[56:59], v[208:211]
    ds_read_b64_tr_b16 a[170:171], v33 offset:20480
    v_mfma_f32_16x16x32_bf16 v[212:215], a[180:183], a[60:63], v[212:215]
    ds_read_b64_tr_b16 a[172:173], v33 offset:24576
    v_mfma_f32_16x16x32_bf16 v[212:215], a[176:179], a[52:55], v[212:215]
    s_waitcnt lgkmcnt(9)
    buffer_load_dwordx4 a[108:111], v51, s[24:27], s43 offen offset:1664 sc1
    v_mfma_f32_16x16x32_bf16 v[220:223], a[184:187], a[52:55], v[220:223]
    s_waitcnt lgkmcnt(7)
    ds_read_b64_tr_b16 a[174:175], v33 offset:28672
    ds_read_b64_tr_b16 a[176:177], v34 offset:16384
    v_mfma_f32_16x16x32_bf16 v[220:223], a[188:191], a[60:63], v[220:223]
    ds_read_b64_tr_b16 a[178:179], v34 offset:20480
    v_mfma_f32_16x16x32_bf16 v[216:219], a[188:191], a[56:59], v[216:219]
    ds_read_b64_tr_b16 a[180:181], v34 offset:24576
    v_mfma_f32_16x16x32_bf16 v[216:219], a[184:187], a[48:51], v[216:219]
    s_waitcnt lgkmcnt(9)
    ds_read_b64_tr_b16 a[182:183], v34 offset:28672
    v_mfma_f32_16x16x32_bf16 v[224:227], a[160:163], a[48:51], v[224:227]
    s_waitcnt lgkmcnt(8)
    ds_read_b64_tr_b16 a[184:185], v35 offset:16384
    v_mfma_f32_16x16x32_bf16 v[224:227], a[164:167], a[56:59], v[224:227]
    ds_read_b64_tr_b16 a[186:187], v35 offset:20480
    v_mfma_f32_16x16x32_bf16 v[228:231], a[164:167], a[60:63], v[228:231]
    ds_read_b64_tr_b16 a[188:189], v35 offset:24576
    v_mfma_f32_16x16x32_bf16 v[228:231], a[160:163], a[52:55], v[228:231]
    s_waitcnt lgkmcnt(9)
    ds_read_b64_tr_b16 a[190:191], v35 offset:28672
    s_waitcnt vmcnt(20)
    s_barrier
    v_mfma_f32_16x16x32_bf16 v[236:239], a[168:171], a[52:55], v[236:239]
    s_waitcnt lgkmcnt(8)
    ds_read_b64_tr_b16 a[160:161], v12 offset:0
    v_mfma_f32_16x16x32_bf16 v[236:239], a[172:175], a[60:63], v[236:239]
    s_add_u32 s49, s44, 3670016
    ds_read_b64_tr_b16 a[162:163], v12 offset:4096
    v_mfma_f32_16x16x32_bf16 v[232:235], a[172:175], a[56:59], v[232:235]
    s_add_u32 m0, s42, 65536
    ds_read_b64_tr_b16 a[164:165], v12 offset:8192
    v_mfma_f32_16x16x32_bf16 v[232:235], a[168:171], a[48:51], v[232:235]
    s_waitcnt lgkmcnt(9)
    buffer_load_dwordx4 v42, s[16:19], s49 offen lds
    v_mfma_f32_16x16x32_bf16 v[240:243], a[176:179], a[48:51], v[240:243]
    s_waitcnt lgkmcnt(7)
    ds_read_b64_tr_b16 a[166:167], v12 offset:12288
    ds_read_b64_tr_b16 a[168:169], v13 offset:0
    v_mfma_f32_16x16x32_bf16 v[240:243], a[180:183], a[56:59], v[240:243]
Ltour1:
    s_cbranch_execz Ltour5
    ds_read_b64_tr_b16 a[170:171], v13 offset:4096
    v_mfma_f32_16x16x32_bf16 v[244:247], a[180:183], a[60:63], v[244:247]
    ds_read_b64_tr_b16 a[172:173], v13 offset:8192
    v_mfma_f32_16x16x32_bf16 v[244:247], a[176:179], a[52:55], v[244:247]
    s_waitcnt lgkmcnt(9)
    buffer_load_dwordx4 v43, s[16:19], s49 offen offset:1024 lds
    v_mfma_f32_16x16x32_bf16 v[252:255], a[184:187], a[52:55], v[252:255]
    s_waitcnt lgkmcnt(7)
    ds_read_b64_tr_b16 a[174:175], v13 offset:12288
    ds_read_b64_tr_b16 a[176:177], v14 offset:0
    v_mfma_f32_16x16x32_bf16 v[252:255], a[188:191], a[60:63], v[252:255]
    ds_read_b64_tr_b16 a[178:179], v14 offset:4096
    v_mfma_f32_16x16x32_bf16 v[248:251], a[188:191], a[56:59], v[248:251]
    ds_read_b64_tr_b16 a[180:181], v14 offset:8192
    v_mfma_f32_16x16x32_bf16 v[248:251], a[184:187], a[48:51], v[248:251]
    s_waitcnt vmcnt(21)
    s_waitcnt lgkmcnt(9)
    buffer_load_dwordx4 v44, s[16:19], s49 offen offset:2048 lds
    v_mfma_f32_16x16x32_bf16 v[128:131], a[160:163], a[64:67], v[128:131]
    s_waitcnt vmcnt(21)
    s_waitcnt lgkmcnt(7)
    ds_read_b64_tr_b16 a[182:183], v14 offset:12288
    ds_read_b64_tr_b16 a[184:185], v15 offset:0
    v_mfma_f32_16x16x32_bf16 v[128:131], a[164:167], a[72:75], v[128:131]
    s_waitcnt vmcnt(19)
    ds_read_b64_tr_b16 a[186:187], v15 offset:4096
    v_mfma_f32_16x16x32_bf16 v[132:135], a[164:167], a[76:79], v[132:135]
    ds_read_b64_tr_b16 a[188:189], v15 offset:8192
    v_mfma_f32_16x16x32_bf16 v[132:135], a[160:163], a[68:71], v[132:135]
    s_waitcnt lgkmcnt(9)
    buffer_load_dwordx4 v45, s[16:19], s49 offen offset:3072 lds
    v_mfma_f32_16x16x32_bf16 v[140:143], a[168:171], a[68:71], v[140:143]
    s_waitcnt lgkmcnt(7)
    ds_read_b64_tr_b16 a[190:191], v15 offset:12288
    ds_read_b64_tr_b16 a[160:161], v16 offset:0
    v_mfma_f32_16x16x32_bf16 v[140:143], a[172:175], a[76:79], v[140:143]
    s_add_u32 s49, s44, 4194304
    ds_read_b64_tr_b16 a[162:163], v16 offset:4096
    v_mfma_f32_16x16x32_bf16 v[136:139], a[172:175], a[72:75], v[136:139]
    s_add_u32 m0, s42, 81920
    ds_read_b64_tr_b16 a[164:165], v16 offset:8192
    v_mfma_f32_16x16x32_bf16 v[136:139], a[168:171], a[64:67], v[136:139]
    s_waitcnt lgkmcnt(9)
    buffer_load_dwordx4 v42, s[16:19], s49 offen lds
    v_mfma_f32_16x16x32_bf16 v[144:147], a[176:179], a[64:67], v[144:147]
    s_waitcnt lgkmcnt(7)
    ds_read_b64_tr_b16 a[166:167], v16 offset:12288
    ds_read_b64_tr_b16 a[168:169], v17 offset:0
    v_mfma_f32_16x16x32_bf16 v[144:147], a[180:183], a[72:75], v[144:147]
    ds_read_b64_tr_b16 a[170:171], v17 offset:4096
    v_mfma_f32_16x16x32_bf16 v[148:151], a[180:183], a[76:79], v[148:151]
    ds_read_b64_tr_b16 a[172:173], v17 offset:8192
    v_mfma_f32_16x16x32_bf16 v[148:151], a[176:179], a[68:71], v[148:151]
    s_waitcnt lgkmcnt(9)
    buffer_load_dwordx4 v43, s[16:19], s49 offen offset:1024 lds
    v_mfma_f32_16x16x32_bf16 v[156:159], a[184:187], a[68:71], v[156:159]
    s_waitcnt lgkmcnt(7)
    ds_read_b64_tr_b16 a[174:175], v17 offset:12288
    ds_read_b64_tr_b16 a[176:177], v18 offset:0
    v_mfma_f32_16x16x32_bf16 v[156:159], a[188:191], a[76:79], v[156:159]
    ds_read_b64_tr_b16 a[178:179], v18 offset:4096
    v_mfma_f32_16x16x32_bf16 v[152:155], a[188:191], a[72:75], v[152:155]
    ds_read_b64_tr_b16 a[180:181], v18 offset:8192
    v_mfma_f32_16x16x32_bf16 v[152:155], a[184:187], a[64:67], v[152:155]
    s_waitcnt lgkmcnt(9)
    buffer_load_dwordx4 v44, s[16:19], s49 offen offset:2048 lds
    v_mfma_f32_16x16x32_bf16 v[160:163], a[160:163], a[64:67], v[160:163]
    s_waitcnt lgkmcnt(7)
    ds_read_b64_tr_b16 a[182:183], v18 offset:12288
    ds_read_b64_tr_b16 a[184:185], v19 offset:0
    v_mfma_f32_16x16x32_bf16 v[160:163], a[164:167], a[72:75], v[160:163]
    ds_read_b64_tr_b16 a[186:187], v19 offset:4096
    v_mfma_f32_16x16x32_bf16 v[164:167], a[164:167], a[76:79], v[164:167]
    ds_read_b64_tr_b16 a[188:189], v19 offset:8192
    v_mfma_f32_16x16x32_bf16 v[164:167], a[160:163], a[68:71], v[164:167]
    s_waitcnt lgkmcnt(9)
    buffer_load_dwordx4 v45, s[16:19], s49 offen offset:3072 lds
    v_mfma_f32_16x16x32_bf16 v[172:175], a[168:171], a[68:71], v[172:175]
    s_waitcnt lgkmcnt(7)
    ds_read_b64_tr_b16 a[190:191], v19 offset:12288
    ds_read_b64_tr_b16 a[160:161], v12 offset:16384
    v_mfma_f32_16x16x32_bf16 v[172:175], a[172:175], a[76:79], v[172:175]
    ds_read_b64_tr_b16 a[162:163], v12 offset:20480
    v_mfma_f32_16x16x32_bf16 v[168:171], a[172:175], a[72:75], v[168:171]
    ds_read_b64_tr_b16 a[164:165], v12 offset:24576
    v_mfma_f32_16x16x32_bf16 v[168:171], a[168:171], a[64:67], v[168:171]
    s_waitcnt lgkmcnt(9)
    buffer_load_dwordx4 a[112:115], v51, s[24:27], s46 offen offset:1792 sc1
    v_mfma_f32_16x16x32_bf16 v[176:179], a[176:179], a[64:67], v[176:179]
    s_waitcnt lgkmcnt(7)
    ds_read_b64_tr_b16 a[166:167], v12 offset:28672
    ds_read_b64_tr_b16 a[168:169], v13 offset:16384
    v_mfma_f32_16x16x32_bf16 v[176:179], a[180:183], a[72:75], v[176:179]
    ds_read_b64_tr_b16 a[170:171], v13 offset:20480
    v_mfma_f32_16x16x32_bf16 v[180:183], a[180:183], a[76:79], v[180:183]
    ds_read_b64_tr_b16 a[172:173], v13 offset:24576
    v_mfma_f32_16x16x32_bf16 v[180:183], a[176:179], a[68:71], v[180:183]
    s_waitcnt lgkmcnt(9)
    buffer_load_dwordx4 a[120:123], v51, s[24:27], s46 offen offset:1920 sc1
    v_mfma_f32_16x16x32_bf16 v[188:191], a[184:187], a[68:71], v[188:191]
    s_waitcnt lgkmcnt(7)
    ds_read_b64_tr_b16 a[174:175], v13 offset:28672
    ds_read_b64_tr_b16 a[176:177], v14 offset:16384
    v_mfma_f32_16x16x32_bf16 v[188:191], a[188:191], a[76:79], v[188:191]
    ds_read_b64_tr_b16 a[178:179], v14 offset:20480
    v_mfma_f32_16x16x32_bf16 v[184:187], a[188:191], a[72:75], v[184:187]
    ds_read_b64_tr_b16 a[180:181], v14 offset:24576
    v_mfma_f32_16x16x32_bf16 v[184:187], a[184:187], a[64:67], v[184:187]
    s_waitcnt lgkmcnt(9)
    buffer_load_dwordx4 a[116:119], v51, s[24:27], s43 offen offset:1792 sc1
    v_mfma_f32_16x16x32_bf16 v[192:195], a[160:163], a[64:67], v[192:195]
    s_waitcnt lgkmcnt(7)
    ds_read_b64_tr_b16 a[182:183], v14 offset:28672
    ds_read_b64_tr_b16 a[184:185], v15 offset:16384
    v_mfma_f32_16x16x32_bf16 v[192:195], a[164:167], a[72:75], v[192:195]
    ds_read_b64_tr_b16 a[186:187], v15 offset:20480
    v_mfma_f32_16x16x32_bf16 v[196:199], a[164:167], a[76:79], v[196:199]
    ds_read_b64_tr_b16 a[188:189], v15 offset:24576
    v_mfma_f32_16x16x32_bf16 v[196:199], a[160:163], a[68:71], v[196:199]
    s_waitcnt lgkmcnt(9)
    buffer_load_dwordx4 a[124:127], v51, s[24:27], s43 offen offset:1920 sc1
    v_mfma_f32_16x16x32_bf16 v[204:207], a[168:171], a[68:71], v[204:207]
    s_waitcnt lgkmcnt(7)
    ds_read_b64_tr_b16 a[190:191], v15 offset:28672
    ds_read_b64_tr_b16 a[160:161], v16 offset:16384
    v_mfma_f32_16x16x32_bf16 v[204:207], a[172:175], a[76:79], v[204:207]
    ds_read_b64_tr_b16 a[162:163], v16 offset:20480
    v_mfma_f32_16x16x32_bf16 v[200:203], a[172:175], a[72:75], v[200:203]
    ds_read_b64_tr_b16 a[164:165], v16 offset:24576
    v_mfma_f32_16x16x32_bf16 v[200:203], a[168:171], a[64:67], v[200:203]
    s_waitcnt lgkmcnt(9)
    buffer_load_dwordx4 a[128:131], v51, s[24:27], s46 offen offset:2048 sc1
    v_mfma_f32_16x16x32_bf16 v[208:211], a[176:179], a[64:67], v[208:211]
    s_waitcnt lgkmcnt(7)
    ds_read_b64_tr_b16 a[166:167], v16 offset:28672
    ds_read_b64_tr_b16 a[168:169], v17 offset:16384
    v_mfma_f32_16x16x32_bf16 v[208:211], a[180:183], a[72:75], v[208:211]
    ds_read_b64_tr_b16 a[170:171], v17 offset:20480
    v_mfma_f32_16x16x32_bf16 v[212:215], a[180:183], a[76:79], v[212:215]
    ds_read_b64_tr_b16 a[172:173], v17 offset:24576
    v_mfma_f32_16x16x32_bf16 v[212:215], a[176:179], a[68:71], v[212:215]
    s_waitcnt lgkmcnt(9)
    buffer_load_dwordx4 a[136:139], v51, s[24:27], s46 offen offset:2176 sc1
    v_mfma_f32_16x16x32_bf16 v[220:223], a[184:187], a[68:71], v[220:223]
    s_waitcnt lgkmcnt(7)
    ds_read_b64_tr_b16 a[174:175], v17 offset:28672
    ds_read_b64_tr_b16 a[176:177], v18 offset:16384
    v_mfma_f32_16x16x32_bf16 v[220:223], a[188:191], a[76:79], v[220:223]
    ds_read_b64_tr_b16 a[178:179], v18 offset:20480
    v_mfma_f32_16x16x32_bf16 v[216:219], a[188:191], a[72:75], v[216:219]
    ds_read_b64_tr_b16 a[180:181], v18 offset:24576
    v_mfma_f32_16x16x32_bf16 v[216:219], a[184:187], a[64:67], v[216:219]
    s_waitcnt lgkmcnt(9)
    ds_read_b64_tr_b16 a[182:183], v18 offset:28672
    v_mfma_f32_16x16x32_bf16 v[224:227], a[160:163], a[64:67], v[224:227]
    s_waitcnt lgkmcnt(8)
    ds_read_b64_tr_b16 a[184:185], v19 offset:16384
    v_mfma_f32_16x16x32_bf16 v[224:227], a[164:167], a[72:75], v[224:227]
    ds_read_b64_tr_b16 a[186:187], v19 offset:20480
    v_mfma_f32_16x16x32_bf16 v[228:231], a[164:167], a[76:79], v[228:231]
    ds_read_b64_tr_b16 a[188:189], v19 offset:24576
    v_mfma_f32_16x16x32_bf16 v[228:231], a[160:163], a[68:71], v[228:231]
    s_waitcnt lgkmcnt(9)
    ds_read_b64_tr_b16 a[190:191], v19 offset:28672
    s_waitcnt vmcnt(20)
    s_barrier
    v_mfma_f32_16x16x32_bf16 v[236:239], a[168:171], a[68:71], v[236:239]
    s_waitcnt lgkmcnt(8)
    ds_read_b64_tr_b16 a[160:161], v12 offset:32768
    v_mfma_f32_16x16x32_bf16 v[236:239], a[172:175], a[76:79], v[236:239]
    s_add_u32 s49, s44, 2621696
    ds_read_b64_tr_b16 a[162:163], v12 offset:36864
    v_mfma_f32_16x16x32_bf16 v[232:235], a[172:175], a[72:75], v[232:235]
    s_add_u32 m0, s42, 98304
    ds_read_b64_tr_b16 a[164:165], v12 offset:40960
    v_mfma_f32_16x16x32_bf16 v[232:235], a[168:171], a[64:67], v[232:235]
    s_waitcnt lgkmcnt(9)
    buffer_load_dwordx4 v42, s[16:19], s49 offen lds
    v_mfma_f32_16x16x32_bf16 v[240:243], a[176:179], a[64:67], v[240:243]
    s_waitcnt lgkmcnt(7)
    ds_read_b64_tr_b16 a[166:167], v12 offset:45056
    ds_read_b64_tr_b16 a[168:169], v13 offset:32768
    v_mfma_f32_16x16x32_bf16 v[240:243], a[180:183], a[72:75], v[240:243]
    ds_read_b64_tr_b16 a[170:171], v13 offset:36864
    v_mfma_f32_16x16x32_bf16 v[244:247], a[180:183], a[76:79], v[244:247]
    ds_read_b64_tr_b16 a[172:173], v13 offset:40960
    v_mfma_f32_16x16x32_bf16 v[244:247], a[176:179], a[68:71], v[244:247]
    s_waitcnt lgkmcnt(9)
    buffer_load_dwordx4 v43, s[16:19], s49 offen offset:1024 lds
    v_mfma_f32_16x16x32_bf16 v[252:255], a[184:187], a[68:71], v[252:255]
    s_waitcnt lgkmcnt(7)
    ds_read_b64_tr_b16 a[174:175], v13 offset:45056
    ds_read_b64_tr_b16 a[176:177], v14 offset:32768
    v_mfma_f32_16x16x32_bf16 v[252:255], a[188:191], a[76:79], v[252:255]
    ds_read_b64_tr_b16 a[178:179], v14 offset:36864
    v_mfma_f32_16x16x32_bf16 v[248:251], a[188:191], a[72:75], v[248:251]
    ds_read_b64_tr_b16 a[180:181], v14 offset:40960
    v_mfma_f32_16x16x32_bf16 v[248:251], a[184:187], a[64:67], v[248:251]
    s_waitcnt lgkmcnt(9)
    buffer_load_dwordx4 v44, s[16:19], s49 offen offset:2048 lds
    v_mfma_f32_16x16x32_bf16 v[128:131], a[160:163], a[80:83], v[128:131]
    s_waitcnt lgkmcnt(7)
    ds_read_b64_tr_b16 a[182:183], v14 offset:45056
    ds_read_b64_tr_b16 a[184:185], v15 offset:32768
    v_mfma_f32_16x16x32_bf16 v[128:131], a[164:167], a[88:91], v[128:131]
    s_waitcnt vmcnt(21)
    ds_read_b64_tr_b16 a[186:187], v15 offset:36864
    v_mfma_f32_16x16x32_bf16 v[132:135], a[164:167], a[92:95], v[132:135]
    ds_read_b64_tr_b16 a[188:189], v15 offset:40960
    v_mfma_f32_16x16x32_bf16 v[132:135], a[160:163], a[84:87], v[132:135]
    s_waitcnt lgkmcnt(9)
    buffer_load_dwordx4 v45, s[16:19], s49 offen offset:3072 lds
    v_mfma_f32_16x16x32_bf16 v[140:143], a[168:171], a[84:87], v[140:143]
    s_waitcnt lgkmcnt(7)
    ds_read_b64_tr_b16 a[190:191], v15 offset:45056
    ds_read_b64_tr_b16 a[160:161], v16 offset:32768
    v_mfma_f32_16x16x32_bf16 v[140:143], a[172:175], a[92:95], v[140:143]
    s_add_u32 s49, s44, 3145984
    ds_read_b64_tr_b16 a[162:163], v16 offset:36864
    v_mfma_f32_16x16x32_bf16 v[136:139], a[172:175], a[88:91], v[136:139]
    s_add_u32 m0, s42, 114688
    ds_read_b64_tr_b16 a[164:165], v16 offset:40960
    v_mfma_f32_16x16x32_bf16 v[136:139], a[168:171], a[80:83], v[136:139]
    s_waitcnt lgkmcnt(9)
    buffer_load_dwordx4 v42, s[16:19], s49 offen lds
    v_mfma_f32_16x16x32_bf16 v[144:147], a[176:179], a[80:83], v[144:147]
    s_waitcnt lgkmcnt(7)
    ds_read_b64_tr_b16 a[166:167], v16 offset:45056
    ds_read_b64_tr_b16 a[168:169], v17 offset:32768
    v_mfma_f32_16x16x32_bf16 v[144:147], a[180:183], a[88:91], v[144:147]
    ds_read_b64_tr_b16 a[170:171], v17 offset:36864
    v_mfma_f32_16x16x32_bf16 v[148:151], a[180:183], a[92:95], v[148:151]
    ds_read_b64_tr_b16 a[172:173], v17 offset:40960
    v_mfma_f32_16x16x32_bf16 v[148:151], a[176:179], a[84:87], v[148:151]
    s_waitcnt lgkmcnt(9)
    buffer_load_dwordx4 v43, s[16:19], s49 offen offset:1024 lds
    v_mfma_f32_16x16x32_bf16 v[156:159], a[184:187], a[84:87], v[156:159]
    s_waitcnt lgkmcnt(7)
    ds_read_b64_tr_b16 a[174:175], v17 offset:45056
    ds_read_b64_tr_b16 a[176:177], v18 offset:32768
    v_mfma_f32_16x16x32_bf16 v[156:159], a[188:191], a[92:95], v[156:159]
    ds_read_b64_tr_b16 a[178:179], v18 offset:36864
    v_mfma_f32_16x16x32_bf16 v[152:155], a[188:191], a[88:91], v[152:155]
    ds_read_b64_tr_b16 a[180:181], v18 offset:40960
    v_mfma_f32_16x16x32_bf16 v[152:155], a[184:187], a[80:83], v[152:155]
    s_waitcnt lgkmcnt(9)
    buffer_load_dwordx4 v44, s[16:19], s49 offen offset:2048 lds
    v_mfma_f32_16x16x32_bf16 v[160:163], a[160:163], a[80:83], v[160:163]
    s_waitcnt lgkmcnt(7)
    ds_read_b64_tr_b16 a[182:183], v18 offset:45056
    ds_read_b64_tr_b16 a[184:185], v19 offset:32768
    v_mfma_f32_16x16x32_bf16 v[160:163], a[164:167], a[88:91], v[160:163]
    ds_read_b64_tr_b16 a[186:187], v19 offset:36864
    v_mfma_f32_16x16x32_bf16 v[164:167], a[164:167], a[92:95], v[164:167]
    ds_read_b64_tr_b16 a[188:189], v19 offset:40960
    v_mfma_f32_16x16x32_bf16 v[164:167], a[160:163], a[84:87], v[164:167]
    s_waitcnt lgkmcnt(9)
    buffer_load_dwordx4 v45, s[16:19], s49 offen offset:3072 lds
    v_mfma_f32_16x16x32_bf16 v[172:175], a[168:171], a[84:87], v[172:175]
    s_waitcnt lgkmcnt(7)
    ds_read_b64_tr_b16 a[190:191], v19 offset:45056
    ds_read_b64_tr_b16 a[160:161], v12 offset:49152
    v_mfma_f32_16x16x32_bf16 v[172:175], a[172:175], a[92:95], v[172:175]
    ds_read_b64_tr_b16 a[162:163], v12 offset:53248
    v_mfma_f32_16x16x32_bf16 v[168:171], a[172:175], a[88:91], v[168:171]
    ds_read_b64_tr_b16 a[164:165], v12 offset:57344
    v_mfma_f32_16x16x32_bf16 v[168:171], a[168:171], a[80:83], v[168:171]
    s_waitcnt lgkmcnt(9)
    buffer_load_dwordx4 a[132:135], v51, s[24:27], s43 offen offset:2048 sc1
    v_mfma_f32_16x16x32_bf16 v[176:179], a[176:179], a[80:83], v[176:179]
    s_waitcnt lgkmcnt(7)
    ds_read_b64_tr_b16 a[166:167], v12 offset:61440
    ds_read_b64_tr_b16 a[168:169], v13 offset:49152
    v_mfma_f32_16x16x32_bf16 v[176:179], a[180:183], a[88:91], v[176:179]
    ds_read_b64_tr_b16 a[170:171], v13 offset:53248
    v_mfma_f32_16x16x32_bf16 v[180:183], a[180:183], a[92:95], v[180:183]
    ds_read_b64_tr_b16 a[172:173], v13 offset:57344
    v_mfma_f32_16x16x32_bf16 v[180:183], a[176:179], a[84:87], v[180:183]
    s_waitcnt lgkmcnt(9)
    buffer_load_dwordx4 a[140:143], v51, s[24:27], s43 offen offset:2176 sc1
    v_mfma_f32_16x16x32_bf16 v[188:191], a[184:187], a[84:87], v[188:191]
    s_waitcnt lgkmcnt(7)
    ds_read_b64_tr_b16 a[174:175], v13 offset:61440
    ds_read_b64_tr_b16 a[176:177], v14 offset:49152
    v_mfma_f32_16x16x32_bf16 v[188:191], a[188:191], a[92:95], v[188:191]
    ds_read_b64_tr_b16 a[178:179], v14 offset:53248
    v_mfma_f32_16x16x32_bf16 v[184:187], a[188:191], a[88:91], v[184:187]
    ds_read_b64_tr_b16 a[180:181], v14 offset:57344
    v_mfma_f32_16x16x32_bf16 v[184:187], a[184:187], a[80:83], v[184:187]
    s_waitcnt vmcnt(27)
    s_waitcnt lgkmcnt(9)
    ds_read_b64_tr_b16 a[182:183], v14 offset:61440
    v_mfma_f32_16x16x32_bf16 v[128:131], a[160:163], a[96:99], v[128:131]
    s_waitcnt vmcnt(26)
    s_waitcnt lgkmcnt(8)
    ds_read_b64_tr_b16 a[184:185], v15 offset:49152
    v_mfma_f32_16x16x32_bf16 v[128:131], a[164:167], a[104:107], v[128:131]
    s_waitcnt vmcnt(24)
    ds_read_b64_tr_b16 a[186:187], v15 offset:53248
    v_mfma_f32_16x16x32_bf16 v[132:135], a[164:167], a[108:111], v[132:135]
    ds_read_b64_tr_b16 a[188:189], v15 offset:57344
    v_mfma_f32_16x16x32_bf16 v[132:135], a[160:163], a[100:103], v[132:135]
    s_waitcnt lgkmcnt(9)
    ds_read_b64_tr_b16 a[190:191], v15 offset:61440
    v_mfma_f32_16x16x32_bf16 v[140:143], a[168:171], a[100:103], v[140:143]
    s_waitcnt lgkmcnt(8)
    ds_read_b64_tr_b16 a[160:161], v16 offset:49152
    v_mfma_f32_16x16x32_bf16 v[140:143], a[172:175], a[108:111], v[140:143]
    ds_read_b64_tr_b16 a[162:163], v16 offset:53248
    v_mfma_f32_16x16x32_bf16 v[136:139], a[172:175], a[104:107], v[136:139]
    ds_read_b64_tr_b16 a[164:165], v16 offset:57344
    v_mfma_f32_16x16x32_bf16 v[136:139], a[168:171], a[96:99], v[136:139]
    s_waitcnt lgkmcnt(9)
    ds_read_b64_tr_b16 a[166:167], v16 offset:61440
    v_mfma_f32_16x16x32_bf16 v[144:147], a[176:179], a[96:99], v[144:147]
    s_waitcnt lgkmcnt(8)
    ds_read_b64_tr_b16 a[168:169], v17 offset:49152
    v_mfma_f32_16x16x32_bf16 v[144:147], a[180:183], a[104:107], v[144:147]
    ds_read_b64_tr_b16 a[170:171], v17 offset:53248
    v_mfma_f32_16x16x32_bf16 v[148:151], a[180:183], a[108:111], v[148:151]
    ds_read_b64_tr_b16 a[172:173], v17 offset:57344
    v_mfma_f32_16x16x32_bf16 v[148:151], a[176:179], a[100:103], v[148:151]
    s_waitcnt lgkmcnt(9)
    ds_read_b64_tr_b16 a[174:175], v17 offset:61440
    v_mfma_f32_16x16x32_bf16 v[156:159], a[184:187], a[100:103], v[156:159]
    s_waitcnt lgkmcnt(8)
    ds_read_b64_tr_b16 a[176:177], v18 offset:49152
    v_mfma_f32_16x16x32_bf16 v[156:159], a[188:191], a[108:111], v[156:159]
    ds_read_b64_tr_b16 a[178:179], v18 offset:53248
    v_mfma_f32_16x16x32_bf16 v[152:155], a[188:191], a[104:107], v[152:155]
    ds_read_b64_tr_b16 a[180:181], v18 offset:57344
    v_mfma_f32_16x16x32_bf16 v[152:155], a[184:187], a[96:99], v[152:155]
    s_waitcnt lgkmcnt(9)
    ds_read_b64_tr_b16 a[182:183], v18 offset:61440
    v_mfma_f32_16x16x32_bf16 v[160:163], a[160:163], a[96:99], v[160:163]
    s_waitcnt lgkmcnt(8)
    ds_read_b64_tr_b16 a[184:185], v19 offset:49152
    v_mfma_f32_16x16x32_bf16 v[160:163], a[164:167], a[104:107], v[160:163]
    ds_read_b64_tr_b16 a[186:187], v19 offset:53248
    v_mfma_f32_16x16x32_bf16 v[164:167], a[164:167], a[108:111], v[164:167]
    ds_read_b64_tr_b16 a[188:189], v19 offset:57344
    v_mfma_f32_16x16x32_bf16 v[164:167], a[160:163], a[100:103], v[164:167]
    s_waitcnt lgkmcnt(9)
    ds_read_b64_tr_b16 a[190:191], v19 offset:61440
    s_waitcnt vmcnt(16)
    s_barrier
    v_mfma_f32_16x16x32_bf16 v[172:175], a[168:171], a[100:103], v[172:175]
    s_waitcnt lgkmcnt(8)
    ds_read_b64_tr_b16 a[160:161], v20 offset:0
    v_mfma_f32_16x16x32_bf16 v[172:175], a[172:175], a[108:111], v[172:175]
    s_add_u32 s49, s44, 3670272
    ds_read_b64_tr_b16 a[162:163], v20 offset:4096
    v_mfma_f32_16x16x32_bf16 v[168:171], a[172:175], a[104:107], v[168:171]
    s_add_u32 m0, s42, 131072
    ds_read_b64_tr_b16 a[164:165], v20 offset:8192
    v_mfma_f32_16x16x32_bf16 v[168:171], a[168:171], a[96:99], v[168:171]
    s_waitcnt lgkmcnt(9)
    buffer_load_dwordx4 v42, s[16:19], s49 offen lds
    v_mfma_f32_16x16x32_bf16 v[176:179], a[176:179], a[96:99], v[176:179]
    s_waitcnt lgkmcnt(7)
    ds_read_b64_tr_b16 a[166:167], v20 offset:12288
    ds_read_b64_tr_b16 a[168:169], v21 offset:0
    v_mfma_f32_16x16x32_bf16 v[176:179], a[180:183], a[104:107], v[176:179]
    ds_read_b64_tr_b16 a[170:171], v21 offset:4096
    v_mfma_f32_16x16x32_bf16 v[180:183], a[180:183], a[108:111], v[180:183]
    ds_read_b64_tr_b16 a[172:173], v21 offset:8192
    v_mfma_f32_16x16x32_bf16 v[180:183], a[176:179], a[100:103], v[180:183]
    s_waitcnt lgkmcnt(9)
    buffer_load_dwordx4 v43, s[16:19], s49 offen offset:1024 lds
    v_mfma_f32_16x16x32_bf16 v[188:191], a[184:187], a[100:103], v[188:191]
    s_waitcnt lgkmcnt(7)
    ds_read_b64_tr_b16 a[174:175], v21 offset:12288
    ds_read_b64_tr_b16 a[176:177], v22 offset:0
    v_mfma_f32_16x16x32_bf16 v[188:191], a[188:191], a[108:111], v[188:191]
    ds_read_b64_tr_b16 a[178:179], v22 offset:4096
    v_mfma_f32_16x16x32_bf16 v[184:187], a[188:191], a[104:107], v[184:187]
    ds_read_b64_tr_b16 a[180:181], v22 offset:8192
    v_mfma_f32_16x16x32_bf16 v[184:187], a[184:187], a[96:99], v[184:187]
    s_waitcnt vmcnt(17)
    s_waitcnt lgkmcnt(9)
    buffer_load_dwordx4 v44, s[16:19], s49 offen offset:2048 lds
    v_mfma_f32_16x16x32_bf16 v[128:131], a[160:163], a[112:115], v[128:131]
    s_waitcnt vmcnt(17)
    s_waitcnt lgkmcnt(7)
    ds_read_b64_tr_b16 a[182:183], v22 offset:12288
    ds_read_b64_tr_b16 a[184:185], v23 offset:0
    v_mfma_f32_16x16x32_bf16 v[128:131], a[164:167], a[120:123], v[128:131]
    s_waitcnt vmcnt(15)
    ds_read_b64_tr_b16 a[186:187], v23 offset:4096
    v_mfma_f32_16x16x32_bf16 v[132:135], a[164:167], a[124:127], v[132:135]
    ds_read_b64_tr_b16 a[188:189], v23 offset:8192
    v_mfma_f32_16x16x32_bf16 v[132:135], a[160:163], a[116:119], v[132:135]
    s_waitcnt lgkmcnt(9)
    buffer_load_dwordx4 v45, s[16:19], s49 offen offset:3072 lds
    v_mfma_f32_16x16x32_bf16 v[140:143], a[168:171], a[116:119], v[140:143]
    s_waitcnt lgkmcnt(7)
    ds_read_b64_tr_b16 a[190:191], v23 offset:12288
    ds_read_b64_tr_b16 a[160:161], v24 offset:0
    v_mfma_f32_16x16x32_bf16 v[140:143], a[172:175], a[124:127], v[140:143]
    s_add_u32 s49, s44, 4194560
    ds_read_b64_tr_b16 a[162:163], v24 offset:4096
    v_mfma_f32_16x16x32_bf16 v[136:139], a[172:175], a[120:123], v[136:139]
    s_add_u32 m0, s42, 147456
    ds_read_b64_tr_b16 a[164:165], v24 offset:8192
    v_mfma_f32_16x16x32_bf16 v[136:139], a[168:171], a[112:115], v[136:139]
    s_waitcnt lgkmcnt(9)
    buffer_load_dwordx4 v42, s[16:19], s49 offen lds
    v_mfma_f32_16x16x32_bf16 v[144:147], a[176:179], a[112:115], v[144:147]
    s_waitcnt lgkmcnt(7)
    ds_read_b64_tr_b16 a[166:167], v24 offset:12288
    ds_read_b64_tr_b16 a[168:169], v25 offset:0
    v_mfma_f32_16x16x32_bf16 v[144:147], a[180:183], a[120:123], v[144:147]
    ds_read_b64_tr_b16 a[170:171], v25 offset:4096
    v_mfma_f32_16x16x32_bf16 v[148:151], a[180:183], a[124:127], v[148:151]
    ds_read_b64_tr_b16 a[172:173], v25 offset:8192
    v_mfma_f32_16x16x32_bf16 v[148:151], a[176:179], a[116:119], v[148:151]
    s_waitcnt lgkmcnt(9)
    buffer_load_dwordx4 v43, s[16:19], s49 offen offset:1024 lds
    v_mfma_f32_16x16x32_bf16 v[156:159], a[184:187], a[116:119], v[156:159]
    s_waitcnt lgkmcnt(7)
    ds_read_b64_tr_b16 a[174:175], v25 offset:12288
    ds_read_b64_tr_b16 a[176:177], v26 offset:0
    v_mfma_f32_16x16x32_bf16 v[156:159], a[188:191], a[124:127], v[156:159]
    ds_read_b64_tr_b16 a[178:179], v26 offset:4096
    v_mfma_f32_16x16x32_bf16 v[152:155], a[188:191], a[120:123], v[152:155]
    ds_read_b64_tr_b16 a[180:181], v26 offset:8192
    v_mfma_f32_16x16x32_bf16 v[152:155], a[184:187], a[112:115], v[152:155]
    s_waitcnt lgkmcnt(9)
    buffer_load_dwordx4 v44, s[16:19], s49 offen offset:2048 lds
    v_mfma_f32_16x16x32_bf16 v[160:163], a[160:163], a[112:115], v[160:163]
    s_waitcnt lgkmcnt(7)
    ds_read_b64_tr_b16 a[182:183], v26 offset:12288
    ds_read_b64_tr_b16 a[184:185], v27 offset:0
    v_mfma_f32_16x16x32_bf16 v[160:163], a[164:167], a[120:123], v[160:163]
    ds_read_b64_tr_b16 a[186:187], v27 offset:4096
    v_mfma_f32_16x16x32_bf16 v[164:167], a[164:167], a[124:127], v[164:167]
    ds_read_b64_tr_b16 a[188:189], v27 offset:8192
    v_mfma_f32_16x16x32_bf16 v[164:167], a[160:163], a[116:119], v[164:167]
    s_waitcnt lgkmcnt(9)
    buffer_load_dwordx4 v45, s[16:19], s49 offen offset:3072 lds
    v_mfma_f32_16x16x32_bf16 v[172:175], a[168:171], a[116:119], v[172:175]
    s_waitcnt lgkmcnt(7)
    ds_read_b64_tr_b16 a[190:191], v27 offset:12288
    ds_read_b64_tr_b16 a[160:161], v20 offset:16384
    v_mfma_f32_16x16x32_bf16 v[172:175], a[172:175], a[124:127], v[172:175]
    ds_read_b64_tr_b16 a[162:163], v20 offset:20480
    v_mfma_f32_16x16x32_bf16 v[168:171], a[172:175], a[120:123], v[168:171]
    ds_read_b64_tr_b16 a[164:165], v20 offset:24576
    v_mfma_f32_16x16x32_bf16 v[168:171], a[168:171], a[112:115], v[168:171]
    s_waitcnt lgkmcnt(9)
    buffer_load_dword v78, v120, s[8:11], 0 offen
    v_mfma_f32_16x16x32_bf16 v[176:179], a[176:179], a[112:115], v[176:179]
    s_waitcnt lgkmcnt(7)
    ds_read_b64_tr_b16 a[166:167], v20 offset:28672
    ds_read_b64_tr_b16 a[168:169], v21 offset:16384
    v_mfma_f32_16x16x32_bf16 v[176:179], a[180:183], a[120:123], v[176:179]
    ds_read_b64_tr_b16 a[170:171], v21 offset:20480
    v_mfma_f32_16x16x32_bf16 v[180:183], a[180:183], a[124:127], v[180:183]
    ds_read_b64_tr_b16 a[172:173], v21 offset:24576
    v_mfma_f32_16x16x32_bf16 v[180:183], a[176:179], a[116:119], v[180:183]
    s_waitcnt lgkmcnt(9)
    buffer_load_dword v79, v121, s[12:15], 0 offen
    v_mfma_f32_16x16x32_bf16 v[188:191], a[184:187], a[116:119], v[188:191]
    s_waitcnt lgkmcnt(7)
    ds_read_b64_tr_b16 a[174:175], v21 offset:28672
    ds_read_b64_tr_b16 a[176:177], v22 offset:16384
    v_mfma_f32_16x16x32_bf16 v[188:191], a[188:191], a[124:127], v[188:191]
    ds_read_b64_tr_b16 a[178:179], v22 offset:20480
    v_mfma_f32_16x16x32_bf16 v[184:187], a[188:191], a[120:123], v[184:187]
    s_mov_b32 s36, 1040356334
    ds_read_b64_tr_b16 a[180:181], v22 offset:24576
    v_mfma_f32_16x16x32_bf16 v[184:187], a[184:187], a[112:115], v[184:187]
    s_waitcnt vmcnt(21)
    s_waitcnt lgkmcnt(9)
    buffer_store_dword v76, v72, s[24:27], s92 offen offset:12 sc1
    v_mfma_f32_16x16x32_bf16 v[128:131], a[160:163], a[128:131], v[128:131]
    s_waitcnt vmcnt(21)
    s_waitcnt lgkmcnt(7)
    ds_read_b64_tr_b16 a[182:183], v22 offset:28672
    ds_read_b64_tr_b16 a[184:185], v23 offset:16384
    v_mfma_f32_16x16x32_bf16 v[128:131], a[164:167], a[136:139], v[128:131]
    s_waitcnt vmcnt(11)
    ds_read_b64_tr_b16 a[186:187], v23 offset:20480
    v_mfma_f32_16x16x32_bf16 v[132:135], a[164:167], a[140:143], v[132:135]
    ds_read_b64_tr_b16 a[188:189], v23 offset:24576
    v_mfma_f32_16x16x32_bf16 v[132:135], a[160:163], a[132:135], v[132:135]
    s_waitcnt lgkmcnt(9)
    buffer_store_dwordx4 v[88:91], v74, s[24:27], 0 offen sc1
    v_mfma_f32_16x16x32_bf16 v[140:143], a[168:171], a[132:135], v[140:143]
    s_waitcnt lgkmcnt(7)
    ds_read_b64_tr_b16 a[190:191], v23 offset:28672
    ds_read_b64_tr_b16 a[160:161], v24 offset:16384
    v_mfma_f32_16x16x32_bf16 v[140:143], a[172:175], a[140:143], v[140:143]
    ds_read_b64_tr_b16 a[162:163], v24 offset:20480
    v_mfma_f32_16x16x32_bf16 v[136:139], a[172:175], a[136:139], v[136:139]
    ds_read_b64_tr_b16 a[164:165], v24 offset:24576
    v_mfma_f32_16x16x32_bf16 v[136:139], a[168:171], a[128:131], v[136:139]
    s_waitcnt lgkmcnt(9)
    ds_read_b64_tr_b16 a[166:167], v24 offset:28672
    v_mfma_f32_16x16x32_bf16 v[144:147], a[176:179], a[128:131], v[144:147]
    s_waitcnt lgkmcnt(8)
    ds_read_b64_tr_b16 a[168:169], v25 offset:16384
    v_mfma_f32_16x16x32_bf16 v[144:147], a[180:183], a[136:139], v[144:147]
    ds_read_b64_tr_b16 a[170:171], v25 offset:20480
    v_mfma_f32_16x16x32_bf16 v[148:151], a[180:183], a[140:143], v[148:151]
    ds_read_b64_tr_b16 a[172:173], v25 offset:24576
    v_mfma_f32_16x16x32_bf16 v[148:151], a[176:179], a[132:135], v[148:151]
    s_waitcnt lgkmcnt(9)
    ds_read_b64_tr_b16 a[174:175], v25 offset:28672
    v_mul_f32 v128, s36, v128
    v_mfma_f32_16x16x32_bf16 v[156:159], a[184:187], a[132:135], v[156:159]
    s_waitcnt lgkmcnt(8)
    ds_read_b64_tr_b16 a[176:177], v26 offset:16384
    v_mul_f32 v129, s36, v129
    v_mfma_f32_16x16x32_bf16 v[156:159], a[188:191], a[140:143], v[156:159]
    ds_read_b64_tr_b16 a[178:179], v26 offset:20480
    v_mul_f32 v130, s36, v130
    v_mfma_f32_16x16x32_bf16 v[152:155], a[188:191], a[136:139], v[152:155]
    ds_read_b64_tr_b16 a[180:181], v26 offset:24576
    v_mul_f32 v131, s36, v131
    v_mfma_f32_16x16x32_bf16 v[152:155], a[184:187], a[128:131], v[152:155]
    s_waitcnt lgkmcnt(9)
    ds_read_b64_tr_b16 a[182:183], v26 offset:28672
    v_mul_f32 v136, s36, v136
    v_mfma_f32_16x16x32_bf16 v[160:163], a[160:163], a[128:131], v[160:163]
    s_waitcnt lgkmcnt(8)
    ds_read_b64_tr_b16 a[184:185], v27 offset:16384
    v_mul_f32 v137, s36, v137
    v_mfma_f32_16x16x32_bf16 v[160:163], a[164:167], a[136:139], v[160:163]
    ds_read_b64_tr_b16 a[186:187], v27 offset:20480
    v_mul_f32 v138, s36, v138
    v_mfma_f32_16x16x32_bf16 v[164:167], a[164:167], a[140:143], v[164:167]
    ds_read_b64_tr_b16 a[188:189], v27 offset:24576
    v_mul_f32 v139, s36, v139
    v_mfma_f32_16x16x32_bf16 v[164:167], a[160:163], a[132:135], v[164:167]
    s_waitcnt lgkmcnt(9)
    ds_read_b64_tr_b16 a[190:191], v27 offset:28672
    v_mul_f32 v132, s36, v132
    s_barrier
    v_mfma_f32_16x16x32_bf16 v[172:175], a[168:171], a[132:135], v[172:175]
    s_waitcnt lgkmcnt(8)
    ds_read_b64_tr_b16 a[160:161], v20 offset:32768
    v_mul_f32 v133, s36, v133
    v_mfma_f32_16x16x32_bf16 v[172:175], a[172:175], a[140:143], v[172:175]
    ds_read_b64_tr_b16 a[162:163], v20 offset:36864
    v_mul_f32 v134, s36, v134
    v_mfma_f32_16x16x32_bf16 v[168:171], a[172:175], a[136:139], v[168:171]
    s_add_u32 m0, s42, 0
    ds_read_b64_tr_b16 a[164:165], v20 offset:40960
    v_mul_f32 v135, s36, v135
    v_mfma_f32_16x16x32_bf16 v[168:171], a[168:171], a[128:131], v[168:171]
    s_waitcnt lgkmcnt(9)
    buffer_load_dwordx4 v36, s[8:11], s40 offen lds
    v_mfma_f32_16x16x32_bf16 v[176:179], a[176:179], a[128:131], v[176:179]
    s_waitcnt lgkmcnt(7)
    ds_read_b64_tr_b16 a[166:167], v20 offset:45056
    ds_read_b64_tr_b16 a[168:169], v21 offset:32768
    v_mfma_f32_16x16x32_bf16 v[176:179], a[180:183], a[136:139], v[176:179]
    ds_read_b64_tr_b16 a[170:171], v21 offset:36864
    v_mul_f32 v140, s36, v140
    v_mfma_f32_16x16x32_bf16 v[180:183], a[180:183], a[140:143], v[180:183]
    ds_read_b64_tr_b16 a[172:173], v21 offset:40960
    v_mul_f32 v141, s36, v141
    v_mfma_f32_16x16x32_bf16 v[180:183], a[176:179], a[132:135], v[180:183]
    s_waitcnt lgkmcnt(9)
    buffer_load_dwordx4 v37, s[8:11], s40 offen offset:1024 lds
    v_mfma_f32_16x16x32_bf16 v[188:191], a[184:187], a[132:135], v[188:191]
    s_waitcnt lgkmcnt(7)
    ds_read_b64_tr_b16 a[174:175], v21 offset:45056
    ds_read_b64_tr_b16 a[176:177], v22 offset:32768
    v_mfma_f32_16x16x32_bf16 v[188:191], a[188:191], a[140:143], v[188:191]
    ds_read_b64_tr_b16 a[178:179], v22 offset:36864
    v_mul_f32 v142, s36, v142
    v_mfma_f32_16x16x32_bf16 v[184:187], a[188:191], a[136:139], v[184:187]
    ds_read_b64_tr_b16 a[180:181], v22 offset:40960
    v_mul_f32 v143, s36, v143
    v_mfma_f32_16x16x32_bf16 v[184:187], a[184:187], a[128:131], v[184:187]
    s_waitcnt lgkmcnt(9)
    buffer_load_dwordx4 v38, s[8:11], s40 offen offset:2048 lds
    v_mfma_f32_16x16x32_bf16 v[192:195], a[160:163], a[80:83], v[192:195]
    s_waitcnt lgkmcnt(7)
    ds_read_b64_tr_b16 a[182:183], v22 offset:45056
    ds_read_b64_tr_b16 a[184:185], v23 offset:32768
Ltour2:
    s_cbranch_execz Ltour6
    v_mfma_f32_16x16x32_bf16 v[192:195], a[164:167], a[88:91], v[192:195]
    ds_read_b64_tr_b16 a[186:187], v23 offset:36864
    v_cvt_pk_bf16_f32 v64, v128, v129
    v_mfma_f32_16x16x32_bf16 v[196:199], a[164:167], a[92:95], v[196:199]
    ds_read_b64_tr_b16 a[188:189], v23 offset:40960
    v_cvt_pk_bf16_f32 v65, v130, v131
    v_mfma_f32_16x16x32_bf16 v[196:199], a[160:163], a[84:87], v[196:199]
    s_waitcnt lgkmcnt(9)
    buffer_load_dwordx4 v39, s[8:11], s40 offen offset:3072 lds
    v_mfma_f32_16x16x32_bf16 v[204:207], a[168:171], a[84:87], v[204:207]
    s_waitcnt lgkmcnt(7)
    s_add_u32 s40, s40, 16384
    ds_read_b64_tr_b16 a[190:191], v23 offset:45056
    ds_read_b64_tr_b16 a[160:161], v24 offset:32768
    v_mfma_f32_16x16x32_bf16 v[204:207], a[172:175], a[92:95], v[204:207]
    ds_read_b64_tr_b16 a[162:163], v24 offset:36864
    v_cvt_pk_bf16_f32 v66, v136, v137
    v_mfma_f32_16x16x32_bf16 v[200:203], a[172:175], a[88:91], v[200:203]
    s_add_u32 m0, s42, 16384
    ds_read_b64_tr_b16 a[164:165], v24 offset:40960
    v_cvt_pk_bf16_f32 v67, v138, v139
    v_mfma_f32_16x16x32_bf16 v[200:203], a[168:171], a[80:83], v[200:203]
    s_waitcnt lgkmcnt(9)
    buffer_load_dwordx4 v36, s[8:11], s40 offen lds
    v_mfma_f32_16x16x32_bf16 v[208:211], a[176:179], a[80:83], v[208:211]
    s_waitcnt lgkmcnt(7)
    ds_read_b64_tr_b16 a[166:167], v24 offset:45056
    ds_read_b64_tr_b16 a[168:169], v25 offset:32768
    v_mfma_f32_16x16x32_bf16 v[208:211], a[180:183], a[88:91], v[208:211]
    ds_read_b64_tr_b16 a[170:171], v25 offset:36864
    v_cvt_pk_bf16_f32 v80, v132, v133
    v_mfma_f32_16x16x32_bf16 v[212:215], a[180:183], a[92:95], v[212:215]
    ds_read_b64_tr_b16 a[172:173], v25 offset:40960
    v_cvt_pk_bf16_f32 v81, v134, v135
    v_mfma_f32_16x16x32_bf16 v[212:215], a[176:179], a[84:87], v[212:215]
    s_waitcnt lgkmcnt(9)
    buffer_load_dwordx4 v37, s[8:11], s40 offen offset:1024 lds
    v_mfma_f32_16x16x32_bf16 v[220:223], a[184:187], a[84:87], v[220:223]
    s_waitcnt lgkmcnt(7)
    ds_read_b64_tr_b16 a[174:175], v25 offset:45056
    ds_read_b64_tr_b16 a[176:177], v26 offset:32768
    v_mfma_f32_16x16x32_bf16 v[220:223], a[188:191], a[92:95], v[220:223]
    ds_read_b64_tr_b16 a[178:179], v26 offset:36864
    v_cvt_pk_bf16_f32 v82, v140, v141
    v_mfma_f32_16x16x32_bf16 v[216:219], a[188:191], a[88:91], v[216:219]
    ds_read_b64_tr_b16 a[180:181], v26 offset:40960
    v_cvt_pk_bf16_f32 v83, v142, v143
    v_mfma_f32_16x16x32_bf16 v[216:219], a[184:187], a[80:83], v[216:219]
    s_waitcnt lgkmcnt(9)
    buffer_load_dwordx4 v38, s[8:11], s40 offen offset:2048 lds
    v_mfma_f32_16x16x32_bf16 v[224:227], a[160:163], a[80:83], v[224:227]
    s_waitcnt lgkmcnt(7)
    ds_read_b64_tr_b16 a[182:183], v26 offset:45056
    ds_read_b64_tr_b16 a[184:185], v27 offset:32768
    v_mfma_f32_16x16x32_bf16 v[224:227], a[164:167], a[88:91], v[224:227]
    ds_read_b64_tr_b16 a[186:187], v27 offset:36864
    v_permlane32_swap_b32 v64, v66
    v_mfma_f32_16x16x32_bf16 v[228:231], a[164:167], a[92:95], v[228:231]
    ds_read_b64_tr_b16 a[188:189], v27 offset:40960
    v_permlane32_swap_b32 v65, v67
    v_mfma_f32_16x16x32_bf16 v[228:231], a[160:163], a[84:87], v[228:231]
    s_waitcnt lgkmcnt(9)
    buffer_load_dwordx4 v39, s[8:11], s40 offen offset:3072 lds
    v_mfma_f32_16x16x32_bf16 v[236:239], a[168:171], a[84:87], v[236:239]
    s_waitcnt lgkmcnt(7)
    s_add_u32 s40, s40, 16384
    ds_read_b64_tr_b16 a[190:191], v27 offset:45056
    ds_read_b64_tr_b16 a[160:161], v20 offset:49152
    v_mfma_f32_16x16x32_bf16 v[236:239], a[172:175], a[92:95], v[236:239]
    ds_read_b64_tr_b16 a[162:163], v20 offset:53248
    v_permlane32_swap_b32 v80, v82
    v_mfma_f32_16x16x32_bf16 v[232:235], a[172:175], a[88:91], v[232:235]
    ds_read_b64_tr_b16 a[164:165], v20 offset:57344
    v_permlane32_swap_b32 v81, v83
    v_mfma_f32_16x16x32_bf16 v[232:235], a[168:171], a[80:83], v[232:235]
    s_waitcnt lgkmcnt(9)
    ds_read_b64_tr_b16 a[166:167], v20 offset:61440
    v_permlane16_swap_b32 v64, v66
    v_mfma_f32_16x16x32_bf16 v[240:243], a[176:179], a[80:83], v[240:243]
    s_waitcnt lgkmcnt(8)
    ds_read_b64_tr_b16 a[168:169], v21 offset:49152
    v_permlane16_swap_b32 v65, v67
    v_mfma_f32_16x16x32_bf16 v[240:243], a[180:183], a[88:91], v[240:243]
    ds_read_b64_tr_b16 a[170:171], v21 offset:53248
    v_permlane16_swap_b32 v80, v82
    v_mfma_f32_16x16x32_bf16 v[244:247], a[180:183], a[92:95], v[244:247]
    ds_read_b64_tr_b16 a[172:173], v21 offset:57344
    v_permlane16_swap_b32 v81, v83
    v_mfma_f32_16x16x32_bf16 v[244:247], a[176:179], a[84:87], v[244:247]
    s_waitcnt lgkmcnt(9)
    ds_read_b64_tr_b16 a[174:175], v21 offset:61440
    v_mul_f32 v144, s36, v144
    v_mfma_f32_16x16x32_bf16 v[252:255], a[184:187], a[84:87], v[252:255]
    s_waitcnt lgkmcnt(8)
    ds_read_b64_tr_b16 a[176:177], v22 offset:49152
    v_mul_f32 v145, s36, v145
    v_mfma_f32_16x16x32_bf16 v[252:255], a[188:191], a[92:95], v[252:255]
    ds_read_b64_tr_b16 a[178:179], v22 offset:53248
    v_mul_f32 v146, s36, v146
    v_mfma_f32_16x16x32_bf16 v[248:251], a[188:191], a[88:91], v[248:251]
    ds_read_b64_tr_b16 a[180:181], v22 offset:57344
    v_mul_f32 v147, s36, v147
    v_mfma_f32_16x16x32_bf16 v[248:251], a[184:187], a[80:83], v[248:251]
    s_waitcnt lgkmcnt(9)
    ds_read_b64_tr_b16 a[182:183], v22 offset:61440
    v_mul_f32 v152, s36, v152
    v_mfma_f32_16x16x32_bf16 v[192:195], a[160:163], a[96:99], v[192:195]
    s_waitcnt lgkmcnt(8)
    ds_read_b64_tr_b16 a[184:185], v23 offset:49152
    v_mul_f32 v153, s36, v153
    v_mfma_f32_16x16x32_bf16 v[192:195], a[164:167], a[104:107], v[192:195]
    ds_read_b64_tr_b16 a[186:187], v23 offset:53248
    v_mul_f32 v154, s36, v154
    v_mfma_f32_16x16x32_bf16 v[196:199], a[164:167], a[108:111], v[196:199]
    ds_read_b64_tr_b16 a[188:189], v23 offset:57344
    v_mul_f32 v155, s36, v155
    v_mfma_f32_16x16x32_bf16 v[196:199], a[160:163], a[100:103], v[196:199]
    s_waitcnt lgkmcnt(9)
    ds_read_b64_tr_b16 a[190:191], v23 offset:61440
    v_mul_f32 v148, s36, v148
    v_mfma_f32_16x16x32_bf16 v[204:207], a[168:171], a[100:103], v[204:207]
    s_waitcnt lgkmcnt(8)
    ds_read_b64_tr_b16 a[160:161], v24 offset:49152
    v_mul_f32 v149, s36, v149
    v_mfma_f32_16x16x32_bf16 v[204:207], a[172:175], a[108:111], v[204:207]
    ds_read_b64_tr_b16 a[162:163], v24 offset:53248
    v_mul_f32 v150, s36, v150
    v_mfma_f32_16x16x32_bf16 v[200:203], a[172:175], a[104:107], v[200:203]
    ds_read_b64_tr_b16 a[164:165], v24 offset:57344
    v_mul_f32 v151, s36, v151
    v_mfma_f32_16x16x32_bf16 v[200:203], a[168:171], a[96:99], v[200:203]
    s_waitcnt lgkmcnt(9)
    ds_read_b64_tr_b16 a[166:167], v24 offset:61440
    v_mul_f32 v156, s36, v156
    v_mfma_f32_16x16x32_bf16 v[208:211], a[176:179], a[96:99], v[208:211]
    s_waitcnt lgkmcnt(8)
    ds_read_b64_tr_b16 a[168:169], v25 offset:49152
    v_mul_f32 v157, s36, v157
    v_mfma_f32_16x16x32_bf16 v[208:211], a[180:183], a[104:107], v[208:211]
    ds_read_b64_tr_b16 a[170:171], v25 offset:53248
    v_mul_f32 v158, s36, v158
    v_mfma_f32_16x16x32_bf16 v[212:215], a[180:183], a[108:111], v[212:215]
    ds_read_b64_tr_b16 a[172:173], v25 offset:57344
    v_mul_f32 v159, s36, v159
    v_mfma_f32_16x16x32_bf16 v[212:215], a[176:179], a[100:103], v[212:215]
    s_waitcnt lgkmcnt(9)
    ds_read_b64_tr_b16 a[174:175], v25 offset:61440
    v_cvt_pk_bf16_f32 v68, v144, v145
    v_mfma_f32_16x16x32_bf16 v[220:223], a[184:187], a[100:103], v[220:223]
    s_waitcnt lgkmcnt(8)
    ds_read_b64_tr_b16 a[176:177], v26 offset:49152
    v_cvt_pk_bf16_f32 v69, v146, v147
    v_mfma_f32_16x16x32_bf16 v[220:223], a[188:191], a[108:111], v[220:223]
    ds_read_b64_tr_b16 a[178:179], v26 offset:53248
    v_cvt_pk_bf16_f32 v70, v152, v153
    v_mfma_f32_16x16x32_bf16 v[216:219], a[188:191], a[104:107], v[216:219]
    ds_read_b64_tr_b16 a[180:181], v26 offset:57344
    v_cvt_pk_bf16_f32 v71, v154, v155
    v_mfma_f32_16x16x32_bf16 v[216:219], a[184:187], a[96:99], v[216:219]
    s_waitcnt lgkmcnt(9)
    ds_read_b64_tr_b16 a[182:183], v26 offset:61440
    v_cvt_pk_bf16_f32 v84, v148, v149
    v_mfma_f32_16x16x32_bf16 v[224:227], a[160:163], a[96:99], v[224:227]
    s_waitcnt lgkmcnt(8)
    ds_read_b64_tr_b16 a[184:185], v27 offset:49152
    v_cvt_pk_bf16_f32 v85, v150, v151
    v_mfma_f32_16x16x32_bf16 v[224:227], a[164:167], a[104:107], v[224:227]
    ds_read_b64_tr_b16 a[186:187], v27 offset:53248
    v_cvt_pk_bf16_f32 v86, v156, v157
    v_mfma_f32_16x16x32_bf16 v[228:231], a[164:167], a[108:111], v[228:231]
    ds_read_b64_tr_b16 a[188:189], v27 offset:57344
    v_cvt_pk_bf16_f32 v87, v158, v159
    v_mfma_f32_16x16x32_bf16 v[228:231], a[160:163], a[100:103], v[228:231]
    s_waitcnt lgkmcnt(9)
    ds_read_b64_tr_b16 a[190:191], v27 offset:61440
    v_permlane32_swap_b32 v68, v70
    s_waitcnt vmcnt(12)
    s_barrier
    v_mfma_f32_16x16x32_bf16 v[236:239], a[168:171], a[100:103], v[236:239]
    s_waitcnt lgkmcnt(8)
    ds_read_b64_tr_b16 a[160:161], v28 offset:0
    v_permlane32_swap_b32 v69, v71
    v_mfma_f32_16x16x32_bf16 v[236:239], a[172:175], a[108:111], v[236:239]
    ds_read_b64_tr_b16 a[162:163], v28 offset:4096
    v_permlane32_swap_b32 v84, v86
    v_mfma_f32_16x16x32_bf16 v[232:235], a[172:175], a[104:107], v[232:235]
    s_add_u32 m0, s42, 32768
    ds_read_b64_tr_b16 a[164:165], v28 offset:8192
    v_permlane32_swap_b32 v85, v87
    v_mfma_f32_16x16x32_bf16 v[232:235], a[168:171], a[96:99], v[232:235]
    s_waitcnt lgkmcnt(9)
    buffer_load_dwordx4 v36, s[8:11], s40 offen lds
    v_mfma_f32_16x16x32_bf16 v[240:243], a[176:179], a[96:99], v[240:243]
    s_waitcnt lgkmcnt(7)
    ds_read_b64_tr_b16 a[166:167], v28 offset:12288
    ds_read_b64_tr_b16 a[168:169], v29 offset:0
    v_mfma_f32_16x16x32_bf16 v[240:243], a[180:183], a[104:107], v[240:243]
    ds_read_b64_tr_b16 a[170:171], v29 offset:4096
    v_permlane16_swap_b32 v68, v70
    v_mfma_f32_16x16x32_bf16 v[244:247], a[180:183], a[108:111], v[244:247]
    ds_read_b64_tr_b16 a[172:173], v29 offset:8192
    v_permlane16_swap_b32 v69, v71
    v_mfma_f32_16x16x32_bf16 v[244:247], a[176:179], a[100:103], v[244:247]
    s_waitcnt lgkmcnt(9)
    buffer_load_dwordx4 v37, s[8:11], s40 offen offset:1024 lds
    v_mfma_f32_16x16x32_bf16 v[252:255], a[184:187], a[100:103], v[252:255]
    s_waitcnt lgkmcnt(7)
    ds_read_b64_tr_b16 a[174:175], v29 offset:12288
    ds_read_b64_tr_b16 a[176:177], v30 offset:0
    v_mfma_f32_16x16x32_bf16 v[252:255], a[188:191], a[108:111], v[252:255]
    ds_read_b64_tr_b16 a[178:179], v30 offset:4096
    v_permlane16_swap_b32 v84, v86
    v_mfma_f32_16x16x32_bf16 v[248:251], a[188:191], a[104:107], v[248:251]
    ds_read_b64_tr_b16 a[180:181], v30 offset:8192
    v_permlane16_swap_b32 v85, v87
    v_mfma_f32_16x16x32_bf16 v[248:251], a[184:187], a[96:99], v[248:251]
    s_waitcnt lgkmcnt(9)
    buffer_load_dwordx4 v38, s[8:11], s40 offen offset:2048 lds
    v_mfma_f32_16x16x32_bf16 v[192:195], a[160:163], a[112:115], v[192:195]
    s_waitcnt lgkmcnt(7)
    ds_read_b64_tr_b16 a[182:183], v30 offset:12288
    ds_read_b64_tr_b16 a[184:185], v31 offset:0
    v_mfma_f32_16x16x32_bf16 v[192:195], a[164:167], a[120:123], v[192:195]
    ds_read_b64_tr_b16 a[186:187], v31 offset:4096
    v_mul_f32 v160, s36, v160
    v_mfma_f32_16x16x32_bf16 v[196:199], a[164:167], a[124:127], v[196:199]
    ds_read_b64_tr_b16 a[188:189], v31 offset:8192
    v_mul_f32 v161, s36, v161
    v_mfma_f32_16x16x32_bf16 v[196:199], a[160:163], a[116:119], v[196:199]
    s_waitcnt lgkmcnt(9)
    buffer_load_dwordx4 v39, s[8:11], s40 offen offset:3072 lds
    v_mfma_f32_16x16x32_bf16 v[204:207], a[168:171], a[116:119], v[204:207]
    s_waitcnt lgkmcnt(7)
    s_add_u32 s40, s40, 16384
    ds_read_b64_tr_b16 a[190:191], v31 offset:12288
    ds_read_b64_tr_b16 a[160:161], v32 offset:0
    v_mfma_f32_16x16x32_bf16 v[204:207], a[172:175], a[124:127], v[204:207]
    ds_read_b64_tr_b16 a[162:163], v32 offset:4096
    v_mul_f32 v162, s36, v162
    v_mfma_f32_16x16x32_bf16 v[200:203], a[172:175], a[120:123], v[200:203]
    s_add_u32 m0, s42, 65536
    ds_read_b64_tr_b16 a[164:165], v32 offset:8192
    v_mul_f32 v163, s36, v163
    v_mfma_f32_16x16x32_bf16 v[200:203], a[168:171], a[112:115], v[200:203]
    s_waitcnt lgkmcnt(9)
    buffer_load_dwordx4 v40, s[12:15], s41 offen lds
    v_mfma_f32_16x16x32_bf16 v[208:211], a[176:179], a[112:115], v[208:211]
    s_waitcnt lgkmcnt(7)
    ds_read_b64_tr_b16 a[166:167], v32 offset:12288
    ds_read_b64_tr_b16 a[168:169], v33 offset:0
    v_mfma_f32_16x16x32_bf16 v[208:211], a[180:183], a[120:123], v[208:211]
    ds_read_b64_tr_b16 a[170:171], v33 offset:4096
    v_mul_f32 v168, s36, v168
    v_mfma_f32_16x16x32_bf16 v[212:215], a[180:183], a[124:127], v[212:215]
    ds_read_b64_tr_b16 a[172:173], v33 offset:8192
    v_mul_f32 v169, s36, v169
    v_mfma_f32_16x16x32_bf16 v[212:215], a[176:179], a[116:119], v[212:215]
    s_waitcnt lgkmcnt(9)
    buffer_load_dwordx4 v41, s[12:15], s41 offen offset:1024 lds
    v_mfma_f32_16x16x32_bf16 v[220:223], a[184:187], a[116:119], v[220:223]
    s_waitcnt lgkmcnt(7)
    ds_read_b64_tr_b16 a[174:175], v33 offset:12288
    ds_read_b64_tr_b16 a[176:177], v34 offset:0
    v_mfma_f32_16x16x32_bf16 v[220:223], a[188:191], a[124:127], v[220:223]
    ds_read_b64_tr_b16 a[178:179], v34 offset:4096
    v_mul_f32 v170, s36, v170
    v_mfma_f32_16x16x32_bf16 v[216:219], a[188:191], a[120:123], v[216:219]
    ds_read_b64_tr_b16 a[180:181], v34 offset:8192
    v_mul_f32 v171, s36, v171
    v_mfma_f32_16x16x32_bf16 v[216:219], a[184:187], a[112:115], v[216:219]
    s_waitcnt lgkmcnt(9)
    buffer_load_dwordx4 v40, s[12:15], s41 offen offset:2048 lds
    v_mfma_f32_16x16x32_bf16 v[224:227], a[160:163], a[112:115], v[224:227]
    s_waitcnt lgkmcnt(7)
    ds_read_b64_tr_b16 a[182:183], v34 offset:12288
    ds_read_b64_tr_b16 a[184:185], v35 offset:0
    v_mfma_f32_16x16x32_bf16 v[224:227], a[164:167], a[120:123], v[224:227]
    ds_read_b64_tr_b16 a[186:187], v35 offset:4096
    v_mul_f32 v164, s36, v164
    v_mfma_f32_16x16x32_bf16 v[228:231], a[164:167], a[124:127], v[228:231]
    ds_read_b64_tr_b16 a[188:189], v35 offset:8192
    v_mul_f32 v165, s36, v165
    v_mfma_f32_16x16x32_bf16 v[228:231], a[160:163], a[116:119], v[228:231]
    s_waitcnt lgkmcnt(9)
    buffer_load_dwordx4 v41, s[12:15], s41 offen offset:3072 lds
    v_mfma_f32_16x16x32_bf16 v[236:239], a[168:171], a[116:119], v[236:239]
    s_waitcnt lgkmcnt(7)
    s_add_u32 s41, s41, 16384
    ds_read_b64_tr_b16 a[190:191], v35 offset:12288
    ds_read_b64_tr_b16 a[160:161], v28 offset:16384
    v_mfma_f32_16x16x32_bf16 v[236:239], a[172:175], a[124:127], v[236:239]
    ds_read_b64_tr_b16 a[162:163], v28 offset:20480
    v_mul_f32 v166, s36, v166
    v_mfma_f32_16x16x32_bf16 v[232:235], a[172:175], a[120:123], v[232:235]
    s_add_u32 m0, s42, 81920
    ds_read_b64_tr_b16 a[164:165], v28 offset:24576
    v_mul_f32 v167, s36, v167
    v_mfma_f32_16x16x32_bf16 v[232:235], a[168:171], a[112:115], v[232:235]
    s_waitcnt lgkmcnt(9)
    buffer_load_dwordx4 v40, s[12:15], s41 offen lds
    v_mfma_f32_16x16x32_bf16 v[240:243], a[176:179], a[112:115], v[240:243]
    s_waitcnt lgkmcnt(7)
    ds_read_b64_tr_b16 a[166:167], v28 offset:28672
    ds_read_b64_tr_b16 a[168:169], v29 offset:16384
    v_mfma_f32_16x16x32_bf16 v[240:243], a[180:183], a[120:123], v[240:243]
    ds_read_b64_tr_b16 a[170:171], v29 offset:20480
    v_mul_f32 v172, s36, v172
    v_mfma_f32_16x16x32_bf16 v[244:247], a[180:183], a[124:127], v[244:247]
    ds_read_b64_tr_b16 a[172:173], v29 offset:24576
    v_mul_f32 v173, s36, v173
    v_mfma_f32_16x16x32_bf16 v[244:247], a[176:179], a[116:119], v[244:247]
    s_waitcnt lgkmcnt(9)
    buffer_load_dwordx4 v41, s[12:15], s41 offen offset:1024 lds
    v_mfma_f32_16x16x32_bf16 v[252:255], a[184:187], a[116:119], v[252:255]
    s_waitcnt lgkmcnt(7)
    ds_read_b64_tr_b16 a[174:175], v29 offset:28672
    ds_read_b64_tr_b16 a[176:177], v30 offset:16384
    v_mfma_f32_16x16x32_bf16 v[252:255], a[188:191], a[124:127], v[252:255]
    ds_read_b64_tr_b16 a[178:179], v30 offset:20480
    v_mul_f32 v174, s36, v174
    v_mfma_f32_16x16x32_bf16 v[248:251], a[188:191], a[120:123], v[248:251]
    ds_read_b64_tr_b16 a[180:181], v30 offset:24576
    v_mul_f32 v175, s36, v175
    v_mfma_f32_16x16x32_bf16 v[248:251], a[184:187], a[112:115], v[248:251]
    s_waitcnt lgkmcnt(9)
    buffer_load_dwordx4 v40, s[12:15], s41 offen offset:2048 lds
    v_mfma_f32_16x16x32_bf16 v[192:195], a[160:163], a[128:131], v[192:195]
    s_waitcnt lgkmcnt(7)
    ds_read_b64_tr_b16 a[182:183], v30 offset:28672
    ds_read_b64_tr_b16 a[184:185], v31 offset:16384
    v_mfma_f32_16x16x32_bf16 v[192:195], a[164:167], a[136:139], v[192:195]
    ds_read_b64_tr_b16 a[186:187], v31 offset:20480
    v_cvt_pk_bf16_f32 v72, v160, v161
    v_mfma_f32_16x16x32_bf16 v[196:199], a[164:167], a[140:143], v[196:199]
    ds_read_b64_tr_b16 a[188:189], v31 offset:24576
    v_cvt_pk_bf16_f32 v73, v162, v163
    v_mfma_f32_16x16x32_bf16 v[196:199], a[160:163], a[132:135], v[196:199]
    s_waitcnt lgkmcnt(9)
    buffer_load_dwordx4 v41, s[12:15], s41 offen offset:3072 lds
    v_mfma_f32_16x16x32_bf16 v[204:207], a[168:171], a[132:135], v[204:207]
    s_waitcnt lgkmcnt(7)
    s_add_u32 s41, s41, 16384
    ds_read_b64_tr_b16 a[190:191], v31 offset:28672
    ds_read_b64_tr_b16 a[160:161], v32 offset:16384
    v_mfma_f32_16x16x32_bf16 v[204:207], a[172:175], a[140:143], v[204:207]
    ds_read_b64_tr_b16 a[162:163], v32 offset:20480
    v_cvt_pk_bf16_f32 v74, v168, v169
    v_mfma_f32_16x16x32_bf16 v[200:203], a[172:175], a[136:139], v[200:203]
    ds_read_b64_tr_b16 a[164:165], v32 offset:24576
    v_cvt_pk_bf16_f32 v75, v170, v171
    v_mfma_f32_16x16x32_bf16 v[200:203], a[168:171], a[128:131], v[200:203]
    s_waitcnt lgkmcnt(9)
    ds_read_b64_tr_b16 a[166:167], v32 offset:28672
    v_cvt_pk_bf16_f32 v88, v164, v165
    v_mfma_f32_16x16x32_bf16 v[208:211], a[176:179], a[128:131], v[208:211]
    s_waitcnt lgkmcnt(8)
    ds_read_b64_tr_b16 a[168:169], v33 offset:16384
    v_cvt_pk_bf16_f32 v89, v166, v167
    v_mfma_f32_16x16x32_bf16 v[208:211], a[180:183], a[136:139], v[208:211]
    ds_read_b64_tr_b16 a[170:171], v33 offset:20480
    v_cvt_pk_bf16_f32 v90, v172, v173
    v_mfma_f32_16x16x32_bf16 v[212:215], a[180:183], a[140:143], v[212:215]
    ds_read_b64_tr_b16 a[172:173], v33 offset:24576
    v_cvt_pk_bf16_f32 v91, v174, v175
    v_mfma_f32_16x16x32_bf16 v[212:215], a[176:179], a[132:135], v[212:215]
    s_waitcnt lgkmcnt(9)
    ds_read_b64_tr_b16 a[174:175], v33 offset:28672
    v_permlane32_swap_b32 v72, v74
    v_mfma_f32_16x16x32_bf16 v[220:223], a[184:187], a[132:135], v[220:223]
    s_waitcnt lgkmcnt(8)
    ds_read_b64_tr_b16 a[176:177], v34 offset:16384
    v_permlane32_swap_b32 v73, v75
    v_mfma_f32_16x16x32_bf16 v[220:223], a[188:191], a[140:143], v[220:223]
    ds_read_b64_tr_b16 a[178:179], v34 offset:20480
    v_permlane32_swap_b32 v88, v90
    v_mfma_f32_16x16x32_bf16 v[216:219], a[188:191], a[136:139], v[216:219]
    ds_read_b64_tr_b16 a[180:181], v34 offset:24576
    v_permlane32_swap_b32 v89, v91
    v_mfma_f32_16x16x32_bf16 v[216:219], a[184:187], a[128:131], v[216:219]
    s_waitcnt lgkmcnt(9)
    ds_read_b64_tr_b16 a[182:183], v34 offset:28672
    v_permlane16_swap_b32 v72, v74
    v_mfma_f32_16x16x32_bf16 v[224:227], a[160:163], a[128:131], v[224:227]
    s_waitcnt lgkmcnt(8)
    ds_read_b64_tr_b16 a[184:185], v35 offset:16384
    v_permlane16_swap_b32 v73, v75
    v_mfma_f32_16x16x32_bf16 v[224:227], a[164:167], a[136:139], v[224:227]
    ds_read_b64_tr_b16 a[186:187], v35 offset:20480
    v_permlane16_swap_b32 v88, v90
    v_mfma_f32_16x16x32_bf16 v[228:231], a[164:167], a[140:143], v[228:231]
    ds_read_b64_tr_b16 a[188:189], v35 offset:24576
    v_permlane16_swap_b32 v89, v91
    v_mfma_f32_16x16x32_bf16 v[228:231], a[160:163], a[132:135], v[228:231]
    s_waitcnt lgkmcnt(9)
    ds_read_b64_tr_b16 a[190:191], v35 offset:28672
    v_mul_f32 v176, s36, v176
    v_mfma_f32_16x16x32_bf16 v[236:239], a[168:171], a[132:135], v[236:239]
    s_waitcnt lgkmcnt(8)
    v_mul_f32 v177, s36, v177
    v_mul_f32 v178, s36, v178
    v_mfma_f32_16x16x32_bf16 v[236:239], a[172:175], a[140:143], v[236:239]
    v_mul_f32 v179, s36, v179
    v_mul_f32 v184, s36, v184
    v_mfma_f32_16x16x32_bf16 v[232:235], a[172:175], a[136:139], v[232:235]
    v_mul_f32 v185, s36, v185
    v_mul_f32 v186, s36, v186
    v_mfma_f32_16x16x32_bf16 v[232:235], a[168:171], a[128:131], v[232:235]
    s_waitcnt lgkmcnt(6)
    v_mul_f32 v187, s36, v187
    v_mul_f32 v180, s36, v180
    s_waitcnt vmcnt(16)
    s_barrier
    v_mfma_f32_16x16x32_bf16 v[240:243], a[176:179], a[128:131], v[240:243]
    s_waitcnt lgkmcnt(4)
    ds_read_b128 a[208:211], v8 offset:0
    v_mul_f32 v181, s36, v181
    v_mfma_f32_16x16x32_bf16 v[240:243], a[180:183], a[136:139], v[240:243]
    ds_read_b128 a[212:215], v9 offset:0
    v_mul_f32 v182, s36, v182
    v_mfma_f32_16x16x32_bf16 v[244:247], a[180:183], a[140:143], v[244:247]
    ds_read_b128 a[216:219], v10 offset:0
    v_mul_f32 v183, s36, v183
    v_mfma_f32_16x16x32_bf16 v[244:247], a[176:179], a[132:135], v[244:247]
    s_waitcnt lgkmcnt(5)
    ds_read_b128 a[220:223], v11 offset:0
    v_mul_f32 v188, s36, v188
    v_mfma_f32_16x16x32_bf16 v[252:255], a[184:187], a[132:135], v[252:255]
    s_waitcnt lgkmcnt(4)
    ds_read_b128 a[224:227], v8 offset:4096
    v_mul_f32 v189, s36, v189
    v_mfma_f32_16x16x32_bf16 v[252:255], a[188:191], a[140:143], v[252:255]
    v_mul_f32 v190, s36, v190
    v_mul_f32 v191, s36, v191
    v_mfma_f32_16x16x32_bf16 v[248:251], a[188:191], a[136:139], v[248:251]
    s_load_dwordx2 s[16:17], s[0:1], 88
    v_cvt_pk_bf16_f32 v76, v176, v177
    v_cvt_pk_bf16_f32 v77, v178, v179
    v_mfma_f32_16x16x32_bf16 v[248:251], a[184:187], a[128:131], v[248:251]
    v_cvt_pk_bf16_f32 v78, v184, v185
    v_cvt_pk_bf16_f32 v79, v186, v187
    v_cvt_pk_bf16_f32 v92, v180, v181
    v_cvt_pk_bf16_f32 v93, v182, v183
    v_cvt_pk_bf16_f32 v94, v188, v189
    v_cvt_pk_bf16_f32 v95, v190, v191
    v_permlane32_swap_b32 v76, v78
    v_permlane32_swap_b32 v77, v79
    v_permlane32_swap_b32 v92, v94
    v_permlane32_swap_b32 v93, v95
    v_permlane16_swap_b32 v76, v78
    v_permlane16_swap_b32 v77, v79
    v_permlane16_swap_b32 v92, v94
    v_permlane16_swap_b32 v93, v95
    s_mov_b32 s36, 1040356334
    s_mov_b32 s37, 1040356334
    v_mov_b32 v58, 0
    v_mov_b32 v59, 0
    v_mov_b32 v60, 0
    v_mov_b32 v61, 0
    v_pk_mul_f32 v[192:193], v[192:193], s[36:37]
    v_pk_mul_f32 v[194:195], v[194:195], s[36:37]
    v_pk_mul_f32 v[200:201], v[200:201], s[36:37]
    v_pk_mul_f32 v[202:203], v[202:203], s[36:37]
    v_pk_mul_f32 v[196:197], v[196:197], s[36:37]
    v_pk_mul_f32 v[198:199], v[198:199], s[36:37]
    v_pk_mul_f32 v[204:205], v[204:205], s[36:37]
    v_pk_mul_f32 v[206:207], v[206:207], s[36:37]
    v_mfma_f32_32x32x16_bf16 a[0:15], v[58:61], v[58:61], 0
    v_cvt_pk_bf16_f32 v96, v192, v193
    v_cvt_pk_bf16_f32 v97, v194, v195
    v_cvt_pk_bf16_f32 v98, v200, v201
    v_cvt_pk_bf16_f32 v99, v202, v203
    v_cvt_pk_bf16_f32 v112, v196, v197
    v_cvt_pk_bf16_f32 v113, v198, v199
    v_cvt_pk_bf16_f32 v114, v204, v205
    v_cvt_pk_bf16_f32 v115, v206, v207
    v_mfma_f32_32x32x16_bf16 a[16:31], v[58:61], v[58:61], 0
    v_permlane32_swap_b32 v96, v98
    v_permlane32_swap_b32 v97, v99
    v_permlane32_swap_b32 v112, v114
    v_permlane32_swap_b32 v113, v115
    v_permlane16_swap_b32 v96, v98
    v_permlane16_swap_b32 v97, v99
    v_permlane16_swap_b32 v112, v114
    v_permlane16_swap_b32 v113, v115
    v_pk_mul_f32 v[208:209], v[208:209], s[36:37]
    v_pk_mul_f32 v[210:211], v[210:211], s[36:37]
    v_pk_mul_f32 v[216:217], v[216:217], s[36:37]
    v_pk_mul_f32 v[218:219], v[218:219], s[36:37]
    v_pk_mul_f32 v[212:213], v[212:213], s[36:37]
    v_pk_mul_f32 v[214:215], v[214:215], s[36:37]
    v_pk_mul_f32 v[220:221], v[220:221], s[36:37]
    v_pk_mul_f32 v[222:223], v[222:223], s[36:37]
    v_mfma_f32_32x32x16_bf16 a[32:47], v[58:61], v[58:61], 0
    v_cvt_pk_bf16_f32 v100, v208, v209
    v_cvt_pk_bf16_f32 v101, v210, v211
    v_cvt_pk_bf16_f32 v102, v216, v217
    v_cvt_pk_bf16_f32 v103, v218, v219
    v_cvt_pk_bf16_f32 v116, v212, v213
    v_cvt_pk_bf16_f32 v117, v214, v215
    v_cvt_pk_bf16_f32 v118, v220, v221
    v_cvt_pk_bf16_f32 v119, v222, v223
    v_mfma_f32_32x32x16_bf16 a[48:63], v[58:61], v[58:61], 0
    v_permlane32_swap_b32 v100, v102
    v_permlane32_swap_b32 v101, v103
    v_permlane32_swap_b32 v116, v118
    v_permlane32_swap_b32 v117, v119
    v_permlane16_swap_b32 v100, v102
    v_permlane16_swap_b32 v101, v103
    v_permlane16_swap_b32 v116, v118
    v_permlane16_swap_b32 v117, v119
    v_pk_mul_f32 v[224:225], v[224:225], s[36:37]
    v_pk_mul_f32 v[226:227], v[226:227], s[36:37]
    v_pk_mul_f32 v[232:233], v[232:233], s[36:37]
    v_pk_mul_f32 v[234:235], v[234:235], s[36:37]
    v_pk_mul_f32 v[228:229], v[228:229], s[36:37]
    v_pk_mul_f32 v[230:231], v[230:231], s[36:37]
    v_pk_mul_f32 v[236:237], v[236:237], s[36:37]
    v_pk_mul_f32 v[238:239], v[238:239], s[36:37]
    v_mfma_f32_32x32x16_bf16 a[64:79], v[58:61], v[58:61], 0
    v_cvt_pk_bf16_f32 v104, v224, v225
    v_cvt_pk_bf16_f32 v105, v226, v227
    v_cvt_pk_bf16_f32 v106, v232, v233
    v_cvt_pk_bf16_f32 v107, v234, v235
    v_cvt_pk_bf16_f32 v120, v228, v229
    v_cvt_pk_bf16_f32 v121, v230, v231
    v_cvt_pk_bf16_f32 v122, v236, v237
    v_cvt_pk_bf16_f32 v123, v238, v239
    v_mfma_f32_32x32x16_bf16 a[80:95], v[58:61], v[58:61], 0
    v_permlane32_swap_b32 v104, v106
    v_permlane32_swap_b32 v105, v107
    v_permlane32_swap_b32 v120, v122
    v_permlane32_swap_b32 v121, v123
    v_permlane16_swap_b32 v104, v106
    v_permlane16_swap_b32 v105, v107
    v_permlane16_swap_b32 v120, v122
    v_permlane16_swap_b32 v121, v123
    v_pk_mul_f32 v[240:241], v[240:241], s[36:37]
    v_pk_mul_f32 v[242:243], v[242:243], s[36:37]
    v_pk_mul_f32 v[248:249], v[248:249], s[36:37]
    v_pk_mul_f32 v[250:251], v[250:251], s[36:37]
    v_pk_mul_f32 v[244:245], v[244:245], s[36:37]
    v_pk_mul_f32 v[246:247], v[246:247], s[36:37]
    v_pk_mul_f32 v[252:253], v[252:253], s[36:37]
    v_pk_mul_f32 v[254:255], v[254:255], s[36:37]
    v_mfma_f32_32x32x16_bf16 a[96:111], v[58:61], v[58:61], 0
    v_cvt_pk_bf16_f32 v108, v240, v241
    v_cvt_pk_bf16_f32 v109, v242, v243
    v_cvt_pk_bf16_f32 v110, v248, v249
    v_cvt_pk_bf16_f32 v111, v250, v251
    v_cvt_pk_bf16_f32 v124, v244, v245
    v_cvt_pk_bf16_f32 v125, v246, v247
    v_cvt_pk_bf16_f32 v126, v252, v253
    v_cvt_pk_bf16_f32 v127, v254, v255
    v_mfma_f32_32x32x16_bf16 a[112:127], v[58:61], v[58:61], 0
    v_permlane32_swap_b32 v108, v110
    v_permlane32_swap_b32 v109, v111
    v_permlane32_swap_b32 v124, v126
    v_permlane32_swap_b32 v125, v127
    v_permlane16_swap_b32 v108, v110
    v_permlane16_swap_b32 v109, v111
    v_permlane16_swap_b32 v124, v126
    v_permlane16_swap_b32 v125, v127
    s_waitcnt lgkmcnt(0)
    v_mfma_f32_16x16x32_bf16 v[216:219], a[208:211], v[64:67], 0
    v_mfma_f32_16x16x32_bf16 v[216:219], a[212:215], v[68:71], v[216:219]
    v_mfma_f32_16x16x32_bf16 v[216:219], a[216:219], v[72:75], v[216:219]
    v_mfma_f32_16x16x32_bf16 v[216:219], a[220:223], v[76:79], v[216:219]
    v_mfma_f32_16x16x32_bf16 v[220:223], a[208:211], v[80:83], 0
    v_mfma_f32_16x16x32_bf16 v[220:223], a[212:215], v[84:87], v[220:223]
    v_mfma_f32_16x16x32_bf16 v[220:223], a[216:219], v[88:91], v[220:223]
    v_mfma_f32_16x16x32_bf16 v[220:223], a[220:223], v[92:95], v[220:223]
    v_mfma_f32_16x16x32_bf16 v[224:227], a[208:211], v[96:99], 0
    v_mfma_f32_16x16x32_bf16 v[224:227], a[212:215], v[100:103], v[224:227]
    v_mfma_f32_16x16x32_bf16 v[224:227], a[216:219], v[104:107], v[224:227]
    v_mfma_f32_16x16x32_bf16 v[224:227], a[220:223], v[108:111], v[224:227]
    v_mfma_f32_16x16x32_bf16 v[228:231], a[208:211], v[112:115], 0
    v_mfma_f32_16x16x32_bf16 v[228:231], a[212:215], v[116:119], v[228:231]
    v_mfma_f32_16x16x32_bf16 v[228:231], a[216:219], v[120:123], v[228:231]
    v_mfma_f32_16x16x32_bf16 v[228:231], a[220:223], v[124:127], v[228:231]
    v_mfma_f32_32x32x16_bf16 a[192:207], v[58:61], v[58:61], 0
    v_max3_f32 v232, v216, v217, v218
    v_max_f32 v232, v232, v219
    v_max3_f32 v233, v220, v221, v222
    v_max_f32 v233, v233, v223
    v_max3_f32 v234, v224, v225, v226
    v_max_f32 v234, v234, v227
    s_nop 0
    v_max3_f32 v235, v228, v229, v230
    v_max_f32 v235, v235, v231
    v_mov_b32 v236, v232
    v_mov_b32 v237, v233
    v_mov_b32 v238, v234
    v_mov_b32 v239, v235
    v_permlane16_swap_b32 v232, v236
    v_permlane16_swap_b32 v233, v237
    v_permlane16_swap_b32 v234, v238
    v_permlane16_swap_b32 v235, v239
    v_max_f32 v232, v232, v236
    v_max_f32 v233, v233, v237
    v_max_f32 v234, v234, v238
    v_max_f32 v235, v235, v239
    v_mov_b32 v236, v232
    v_mov_b32 v237, v233
    v_mov_b32 v238, v234
    v_mov_b32 v239, v235
    v_permlane32_swap_b32 v232, v236
    v_permlane32_swap_b32 v233, v237
    v_permlane32_swap_b32 v234, v238
    v_permlane32_swap_b32 v235, v239
    v_max_f32 v232, v232, v236
    v_max_f32 v233, v233, v237
    v_max_f32 v234, v234, v238
    v_max_f32 v235, v235, v239
    v_sub_f32 v192, 3250585600, v232
    v_sub_f32 v193, 3250585600, v232
    v_sub_f32 v194, 3250585600, v232
    v_sub_f32 v195, 3250585600, v232
Ltour3:
    s_cbranch_execz Ltour7
    v_sub_f32 v196, 3250585600, v233
    v_sub_f32 v197, 3250585600, v233
    v_sub_f32 v198, 3250585600, v233
    v_sub_f32 v199, 3250585600, v233
    v_sub_f32 v200, 3250585600, v234
    v_sub_f32 v201, 3250585600, v234
    v_sub_f32 v202, 3250585600, v234
    v_sub_f32 v203, 3250585600, v234
    v_sub_f32 v204, 3250585600, v235
    v_sub_f32 v205, 3250585600, v235
    v_sub_f32 v206, 3250585600, v235
    v_sub_f32 v207, 3250585600, v235
Lattn_stage0:
    s_mov_b32 s43, 7
    v_mfma_f32_16x16x32_bf16 v[208:211], a[208:211], v[64:67], v[192:195]
    s_lshl_b32 s53, s5, 4
    v_mfma_f32_16x16x32_bf16 v[208:211], a[212:215], v[68:71], v[208:211]
    s_add_u32 s53, s53, s4
    v_mfma_f32_16x16x32_bf16 v[208:211], a[216:219], v[72:75], v[208:211]
    s_lshl_b32 s53, s53, 2
    v_mfma_f32_16x16x32_bf16 v[208:211], a[220:223], v[76:79], v[208:211]
    s_add_u32 s53, s53, s3
    ds_read_b128 a[228:231], v9 offset:4096
    v_mfma_f32_16x16x32_bf16 v[212:215], a[208:211], v[80:83], v[196:199]
    s_mul_i32 s53, s53, 4608
    s_nop 3
    v_exp_f32 v208, v208
    v_mfma_f32_16x16x32_bf16 v[212:215], a[212:215], v[84:87], v[212:215]
    s_add_u32 s53, s53, 2621440
    v_exp_f32 v209, v209
    v_mfma_f32_16x16x32_bf16 v[212:215], a[216:219], v[88:91], v[212:215]
    s_lshr_b32 s44, s2, 5
    v_exp_f32 v210, v210
    v_mfma_f32_16x16x32_bf16 v[212:215], a[220:223], v[92:95], v[212:215]
    s_lshl_b32 s44, s44, 3
    v_exp_f32 v211, v211
    v_cvt_pk_bf16_f32 v128, v208, v209
    ds_read_b128 a[232:235], v10 offset:4096
    v_cvt_pk_bf16_f32 v129, v210, v211
    v_mfma_f32_16x16x32_bf16 v[208:211], a[208:211], v[96:99], v[200:203]
    s_and_b32 s37, s2, 7
    s_nop 0
    v_exp_f32 v212, v212
    v_mfma_f32_16x16x32_bf16 v[208:211], a[212:215], v[100:103], v[208:211]
    s_add_u32 s44, s44, s37
    v_exp_f32 v213, v213
    v_mfma_f32_16x16x32_bf16 v[208:211], a[216:219], v[104:107], v[208:211]
    s_lshl_b32 s44, s44, 2
    v_exp_f32 v214, v214
    v_mfma_f32_16x16x32_bf16 v[208:211], a[220:223], v[108:111], v[208:211]
    s_bfe_u32 s37, s2, 0x20003
    v_exp_f32 v215, v215
    v_cvt_pk_bf16_f32 v136, v212, v213
    ds_read_b128 a[236:239], v11 offset:4096
    v_cvt_pk_bf16_f32 v137, v214, v215
    v_mfma_f32_16x16x32_bf16 v[212:215], a[208:211], v[112:115], v[204:207]
    s_add_u32 s44, s44, s37
    s_nop 0
    v_exp_f32 v208, v208
    v_mfma_f32_16x16x32_bf16 v[212:215], a[212:215], v[116:119], v[212:215]
    s_add_u32 s44, s44, 72
    v_exp_f32 v209, v209
    v_mfma_f32_16x16x32_bf16 v[212:215], a[216:219], v[120:123], v[212:215]
    s_cmp_lt_u32 s44, 216
    s_cselect_b32 s37, 0, 2147483648
    v_exp_f32 v210, v210
    v_mfma_f32_16x16x32_bf16 v[212:215], a[220:223], v[124:127], v[212:215]
    s_lshl_b32 s44, s44, 5
    v_exp_f32 v211, v211
    v_cvt_pk_bf16_f32 v144, v208, v209
    ds_read_b128 a[208:211], v8 offset:8192
    v_cvt_pk_bf16_f32 v145, v210, v211
    v_mfma_f32_16x16x32_bf16 v[208:211], a[224:227], v[64:67], v[192:195]
    s_waitcnt lgkmcnt(3)
    s_or_b32 s44, s44, s37
    v_exp_f32 v212, v212
    v_mfma_f32_16x16x32_bf16 v[208:211], a[228:231], v[68:71], v[208:211]
    s_waitcnt lgkmcnt(2)
    s_mov_b32 s18, 3981312
    v_exp_f32 v213, v213
    v_mfma_f32_16x16x32_bf16 v[208:211], a[232:235], v[72:75], v[208:211]
    s_waitcnt lgkmcnt(1)
    s_lshr_b32 s6, s2, 3
    v_exp_f32 v214, v214
    v_mfma_f32_16x16x32_bf16 v[208:211], a[236:239], v[76:79], v[208:211]
    s_and_b32 s7, s2, 7
    v_exp_f32 v215, v215
    v_cvt_pk_bf16_f32 v152, v212, v213
    ds_read_b128 a[212:215], v9 offset:8192
    v_cvt_pk_bf16_f32 v153, v214, v215
    v_mfma_f32_16x16x32_bf16 v[212:215], a[224:227], v[80:83], v[196:199]
    s_mul_i32 s7, s7, 18
    s_nop 0
    v_exp_f32 v208, v208
    v_mfma_f32_16x16x32_bf16 v[212:215], a[228:231], v[84:87], v[212:215]
    s_add_u32 s7, s7, s6
    v_exp_f32 v209, v209
    v_mfma_f32_16x16x32_bf16 v[212:215], a[232:235], v[88:91], v[212:215]
    s_lshl_b32 s58, s7, 6
    v_exp_f32 v210, v210
    v_mfma_f32_16x16x32_bf16 v[212:215], a[236:239], v[92:95], v[212:215]
    s_mul_i32 s59, s7, 36864
    v_exp_f32 v211, v211
    v_cvt_pk_bf16_f32 v130, v208, v209
    ds_read_b128 a[216:219], v10 offset:8192
    v_cvt_pk_bf16_f32 v131, v210, v211
    v_mfma_f32_16x16x32_bf16 v[208:211], a[224:227], v[96:99], v[200:203]
    s_cmp_lt_u32 s6, 18
    s_cselect_b32 s7, 0, 2147483648
    v_exp_f32 v212, v212
    v_mfma_f32_16x16x32_bf16 v[208:211], a[228:231], v[100:103], v[208:211]
    s_or_b32 s58, s58, s7
    v_exp_f32 v213, v213
    v_mfma_f32_16x16x32_bf16 v[208:211], a[232:235], v[104:107], v[208:211]
    s_or_b32 s59, s59, s7
    v_exp_f32 v214, v214
    v_mfma_f32_16x16x32_bf16 v[208:211], a[236:239], v[108:111], v[208:211]
    s_and_b32 s7, s4, 1
    v_exp_f32 v215, v215
    v_cvt_pk_bf16_f32 v138, v212, v213
    ds_read_b128 a[220:223], v11 offset:8192
    v_cvt_pk_bf16_f32 v139, v214, v215
    s_mov_b32 s39, 221184
    s_mov_b32 s38, 27648
    v_mfma_f32_16x16x32_bf16 v[212:215], a[224:227], v[112:115], v[204:207]
    s_lshl_b32 s6, s7, 7
    v_exp_f32 v208, v208
    v_mfma_f32_16x16x32_bf16 v[212:215], a[228:231], v[116:119], v[212:215]
    s_xor_b32 s36, s4, 1
    v_exp_f32 v209, v209
    v_mfma_f32_16x16x32_bf16 v[212:215], a[232:235], v[120:123], v[212:215]
    s_mul_i32 s36, s36, 294912
    v_exp_f32 v210, v210
    v_mfma_f32_16x16x32_bf16 v[212:215], a[236:239], v[124:127], v[212:215]
    s_waitcnt lgkmcnt(3)
    s_add_u32 s46, s36, s6
    v_exp_f32 v211, v211
    v_cvt_pk_bf16_f32 v146, v208, v209
    ds_read_b128 a[224:227], v8 offset:12288
    v_cvt_pk_bf16_f32 v147, v210, v211
    v_mfma_f32_16x16x32_bf16 v[208:211], a[208:211], v[64:67], v[192:195]
    s_waitcnt lgkmcnt(3)
    s_lshl_b32 s36, s4, 8
    v_exp_f32 v212, v212
    v_mfma_f32_16x16x32_bf16 v[208:211], a[212:215], v[68:71], v[208:211]
    s_waitcnt lgkmcnt(2)
    s_add_u32 s56, s47, s36
    v_exp_f32 v213, v213
    v_mfma_f32_16x16x32_bf16 v[208:211], a[216:219], v[72:75], v[208:211]
    s_waitcnt lgkmcnt(1)
    s_lshr_b32 s36, s4, 1
    v_exp_f32 v214, v214
    v_mfma_f32_16x16x32_bf16 v[208:211], a[220:223], v[76:79], v[208:211]
    s_lshl_b32 s36, s36, 11
    v_exp_f32 v215, v215
    v_cvt_pk_bf16_f32 v154, v212, v213
    ds_read_b128 a[228:231], v9 offset:12288
    v_cvt_pk_bf16_f32 v155, v214, v215
    v_mfma_f32_16x16x32_bf16 v[212:215], a[208:211], v[80:83], v[196:199]
    s_lshl_b32 s7, s7, 8
    s_nop 0
    v_exp_f32 v208, v208
    v_mfma_f32_16x16x32_bf16 v[212:215], a[212:215], v[84:87], v[212:215]
    s_add_u32 s36, s36, s7
    v_exp_f32 v209, v209
    v_mfma_f32_16x16x32_bf16 v[212:215], a[216:219], v[88:91], v[212:215]
    s_add_u32 s93, s47, s36
    v_exp_f32 v210, v210
    v_mfma_f32_16x16x32_bf16 v[212:215], a[220:223], v[92:95], v[212:215]
    s_lshr_b32 s36, s4, 1
    v_exp_f32 v211, v211
    v_cvt_pk_bf16_f32 v132, v208, v209
    ds_read_b128 a[232:235], v10 offset:12288
    v_cvt_pk_bf16_f32 v133, v210, v211
    v_mfma_f32_16x16x32_bf16 v[208:211], a[208:211], v[96:99], v[200:203]
    s_lshl_b32 s36, s36, 4
    s_nop 0
    v_exp_f32 v212, v212
    v_mfma_f32_16x16x32_bf16 v[208:211], a[212:215], v[100:103], v[208:211]
    s_add_u32 s36, s36, s5
    v_exp_f32 v213, v213
    v_mfma_f32_16x16x32_bf16 v[208:211], a[216:219], v[104:107], v[208:211]
    s_lshl_b32 s36, s36, 9
    v_exp_f32 v214, v214
    v_mfma_f32_16x16x32_bf16 v[208:211], a[220:223], v[108:111], v[208:211]
    s_add_u32 s36, s36, s7
    v_exp_f32 v215, v215
    v_cvt_pk_bf16_f32 v140, v212, v213
    ds_read_b128 a[236:239], v11 offset:12288
    v_cvt_pk_bf16_f32 v141, v214, v215
    s_waitcnt vmcnt(4)
    s_barrier
    v_mfma_f32_16x16x32_bf16 v[212:215], a[208:211], v[112:115], v[204:207]
    s_lshl_b32 s36, s36, 8
    v_exp_f32 v208, v208
    v_mfma_f32_16x16x32_bf16 v[212:215], a[212:215], v[116:119], v[212:215]
    s_add_u32 m0, s42, 49152
    s_add_u32 s55, s36, 20971520
    v_exp_f32 v209, v209
    v_mfma_f32_16x16x32_bf16 v[212:215], a[216:219], v[120:123], v[212:215]
    s_add_u32 s7, s45, s6
    v_exp_f32 v210, v210
    v_mfma_f32_16x16x32_bf16 v[212:215], a[220:223], v[124:127], v[212:215]
    s_waitcnt lgkmcnt(3)
    s_xor_b32 s54, s92, 128
    v_exp_f32 v211, v211
    v_cvt_pk_bf16_f32 v148, v208, v209
    ds_read_b128 a[208:211], v8 offset:16384
    v_cvt_pk_bf16_f32 v149, v210, v211
    buffer_load_dwordx4 v36, s[8:11], s40 offen lds
    v_mfma_f32_16x16x32_bf16 v[208:211], a[224:227], v[64:67], v[192:195]
    s_waitcnt lgkmcnt(3)
    s_lshl_b32 s36, s3, 14
    v_exp_f32 v212, v212
    v_mfma_f32_16x16x32_bf16 v[208:211], a[228:231], v[68:71], v[208:211]
    s_waitcnt lgkmcnt(2)
    v_exp_f32 v213, v213
    v_mfma_f32_16x16x32_bf16 v[208:211], a[232:235], v[72:75], v[208:211]
    s_waitcnt lgkmcnt(1)
    v_exp_f32 v214, v214
    v_mfma_f32_16x16x32_bf16 v[208:211], a[236:239], v[76:79], v[208:211]
    v_exp_f32 v215, v215
    v_cvt_pk_bf16_f32 v156, v212, v213
    ds_read_b128 a[212:215], v9 offset:16384
    v_cvt_pk_bf16_f32 v157, v214, v215
    v_mfma_f32_16x16x32_bf16 v[212:215], a[224:227], v[80:83], v[196:199]
    s_nop 2
    v_exp_f32 v208, v208
    v_mfma_f32_16x16x32_bf16 v[212:215], a[228:231], v[84:87], v[212:215]
    v_exp_f32 v209, v209
    v_mfma_f32_16x16x32_bf16 v[212:215], a[232:235], v[88:91], v[212:215]
    v_exp_f32 v210, v210
    v_mfma_f32_16x16x32_bf16 v[212:215], a[236:239], v[92:95], v[212:215]
    v_exp_f32 v211, v211
    ds_read_b64_tr_b16 a[160:161], v20 offset:0
    v_cvt_pk_bf16_f32 v134, v208, v209
    v_lshrrev_b32 v51, 2, v0
    v_mul_u32_u24 v51, 9216, v51
    v_and_b32 v254, 3, v0
    v_lshl_add_u32 v254, v254, 4, v51
    v_lshlrev_b32 v255, 4, v0
    v_add_u32 v51, 98304, v255
    v_lshl_add_u32 v252, v1, 4, s36
    v_mov_b32 v224, 0
    v_mov_b32 v225, 0
    v_mov_b32 v226, 0
    v_mov_b32 v227, 0
    v_mov_b32 v228, 0
    v_mov_b32 v229, 0
    v_mov_b32 v230, 0
    v_mov_b32 v231, 0
    v_mov_b32 v248, -1
    v_mov_b32 v249, -1
    v_mov_b32 v250, -1
    v_mov_b32 v251, -1
    v_min_u32 v232, 41, v1
    v_lshlrev_b32 v232, 4, v232
    s_mov_b32 s57, s58
    s_lshl_b32 s6, s3, 10
    s_add_u32 s6, s6, 135168
    s_lshr_b32 s37, s2, 3
    s_mul_i32 s37, s37, -129024
    s_add_u32 s37, s37, 4128768
    ds_read_b64_tr_b16 a[162:163], v20 offset:4096
    ds_read_b128 a[216:219], v10 offset:16384
    v_cvt_pk_bf16_f32 v135, v210, v211
    buffer_load_dwordx4 v37, s[8:11], s40 offen offset:1024 lds
    v_mfma_f32_16x16x32_bf16 v[208:211], a[224:227], v[96:99], v[200:203]
    v_exp_f32 v212, v212
    v_mfma_f32_16x16x32_bf16 v[208:211], a[228:231], v[100:103], v[208:211]
    v_exp_f32 v213, v213
    v_mfma_f32_16x16x32_bf16 v[208:211], a[232:235], v[104:107], v[208:211]
    v_exp_f32 v214, v214
    v_mfma_f32_16x16x32_bf16 v[208:211], a[236:239], v[108:111], v[208:211]
    s_mov_b32 s52, s55
    v_exp_f32 v215, v215
    ds_read_b64_tr_b16 a[164:165], v20 offset:8192
    v_cvt_pk_bf16_f32 v142, v212, v213
    ds_read_b64_tr_b16 a[166:167], v20 offset:12288
    v_min_u32 v237, 19, v1
    v_lshl_add_u32 v237, v237, 7, s36
    v_lshl_add_u32 v238, v1, 7, s36
    ds_read_b128 a[220:223], v11 offset:16384
    v_cvt_pk_bf16_f32 v143, v214, v215
    buffer_load_dword v217, v57, s[32:35], s37 offen
    v_mfma_f32_16x16x32_bf16 v[212:215], a[224:227], v[112:115], v[204:207]
    v_exp_f32 v208, v208
    v_mfma_f32_16x16x32_bf16 v[212:215], a[228:231], v[116:119], v[212:215]
    v_exp_f32 v209, v209
    v_mfma_f32_16x16x32_bf16 v[212:215], a[232:235], v[120:123], v[212:215]
    s_mul_i32 s37, s5, 18432
    v_exp_f32 v210, v210
    v_mfma_f32_16x16x32_bf16 v[212:215], a[236:239], v[124:127], v[212:215]
    s_add_u32 s37, s37, s45
    v_exp_f32 v211, v211
    ds_read_b64_tr_b16 a[168:169], v21 offset:0
    v_cvt_pk_bf16_f32 v150, v208, v209
    ds_read_b64_tr_b16 a[170:171], v21 offset:4096
    v_min_u32 v236, 143, v0
    v_lshl_add_u32 v236, v236, 7, s37
    v_mul_u32_u24 v235, 24, v0
    v_lshrrev_b32 v235, 8, v235
    v_lshl_add_u32 v235, v235, 7, s37
    ds_read_b128 a[224:227], v8 offset:20480
    v_cvt_pk_bf16_f32 v151, v210, v211
    s_waitcnt lgkmcnt(3)
    buffer_load_dwordx4 v38, s[8:11], s40 offen offset:2048 lds
    s_nop 0
    s_nop 0
    s_nop 0
    s_nop 0
    s_nop 0
Lattn_loop:
    v_mfma_f32_16x16x32_bf16 v[208:211], a[208:211], v[64:67], v[192:195]
    v_exp_f32 v212, v212
    v_mfma_f32_16x16x32_bf16 v[208:211], a[212:215], v[68:71], v[208:211]
    v_exp_f32 v213, v213
    v_mfma_f32_16x16x32_bf16 v[208:211], a[216:219], v[72:75], v[208:211]
    v_exp_f32 v214, v214
    v_mfma_f32_16x16x32_bf16 v[208:211], a[220:223], v[76:79], v[208:211]
    v_exp_f32 v215, v215
    v_mfma_f32_16x16x32_bf16 a[0:3], a[160:163], v[128:131], a[0:3]
    ds_read_b64_tr_b16 a[172:173], v21 offset:8192
    v_cvt_pk_bf16_f32 v158, v212, v213
    v_mfma_f32_16x16x32_bf16 a[0:3], a[164:167], v[132:135], a[0:3]
    ds_read_b64_tr_b16 a[174:175], v21 offset:12288
    v_mfma_f32_16x16x32_bf16 a[4:7], a[164:167], v[140:143], a[4:7]
    ds_read_b128 a[228:231], v9 offset:20480
    v_cvt_pk_bf16_f32 v159, v214, v215
    v_mfma_f32_16x16x32_bf16 a[4:7], a[160:163], v[136:139], a[4:7]
    v_mfma_f32_16x16x32_bf16 v[212:215], a[208:211], v[80:83], v[196:199]
    v_exp_f32 v208, v208
    v_mfma_f32_16x16x32_bf16 v[212:215], a[212:215], v[84:87], v[212:215]
    v_exp_f32 v209, v209
    v_mfma_f32_16x16x32_bf16 v[212:215], a[216:219], v[88:91], v[212:215]
    v_exp_f32 v210, v210
    v_mfma_f32_16x16x32_bf16 v[212:215], a[220:223], v[92:95], v[212:215]
    v_exp_f32 v211, v211
    v_mfma_f32_16x16x32_bf16 a[8:11], a[160:163], v[144:147], a[8:11]
    ds_read_b64_tr_b16 a[176:177], v22 offset:0
    v_cvt_pk_bf16_f32 v160, v208, v209
    v_mfma_f32_16x16x32_bf16 a[8:11], a[164:167], v[148:151], a[8:11]
    ds_read_b64_tr_b16 a[178:179], v22 offset:4096
    v_mfma_f32_16x16x32_bf16 a[12:15], a[164:167], v[156:159], a[12:15]
    ds_read_b128 a[232:235], v10 offset:20480
    v_cvt_pk_bf16_f32 v161, v210, v211
    v_mfma_f32_16x16x32_bf16 a[12:15], a[160:163], v[152:155], a[12:15]
    s_waitcnt lgkmcnt(3)
    buffer_load_dwordx4 v39, s[8:11], s40 offen offset:3072 lds
    v_mfma_f32_16x16x32_bf16 v[208:211], a[208:211], v[96:99], v[200:203]
    v_exp_f32 v212, v212
    v_mfma_f32_16x16x32_bf16 v[208:211], a[212:215], v[100:103], v[208:211]
    s_add_u32 s40, s40, 16384
    v_exp_f32 v213, v213
    v_mfma_f32_16x16x32_bf16 v[208:211], a[216:219], v[104:107], v[208:211]
    s_mov_b32 m0, s6
    v_exp_f32 v214, v214
    v_mfma_f32_16x16x32_bf16 v[208:211], a[220:223], v[108:111], v[208:211]
    v_exp_f32 v215, v215
    v_mfma_f32_16x16x32_bf16 a[16:19], a[168:171], v[128:131], a[16:19]
    ds_read_b64_tr_b16 a[180:181], v22 offset:8192
    v_cvt_pk_bf16_f32 v168, v212, v213
    v_mfma_f32_16x16x32_bf16 a[16:19], a[172:175], v[132:135], a[16:19]
    ds_read_b64_tr_b16 a[182:183], v22 offset:12288
    v_mfma_f32_16x16x32_bf16 a[20:23], a[172:175], v[140:143], a[20:23]
    ds_read_b128 a[236:239], v11 offset:20480
    v_cvt_pk_bf16_f32 v169, v214, v215
    v_mfma_f32_16x16x32_bf16 a[20:23], a[168:171], v[136:139], a[20:23]
    buffer_load_dwordx4 v254, s[32:35], s57 offen  lds
    v_smfmac_f32_16x16x64_bf16 a[192:195], v[52:55], v[128:135], v50
    v_mfma_f32_16x16x32_bf16 v[212:215], a[208:211], v[112:115], v[204:207]
    v_exp_f32 v208, v208
    v_mfma_f32_16x16x32_bf16 v[212:215], a[212:215], v[116:119], v[212:215]
    s_add_u32 m0, s42, 98304
    v_exp_f32 v209, v209
    v_mfma_f32_16x16x32_bf16 v[212:215], a[216:219], v[120:123], v[212:215]
    v_exp_f32 v210, v210
    v_mfma_f32_16x16x32_bf16 v[212:215], a[220:223], v[124:127], v[212:215]
    v_exp_f32 v211, v211
    v_mfma_f32_16x16x32_bf16 a[24:27], a[168:171], v[144:147], a[24:27]
    ds_read_b64_tr_b16 a[184:185], v23 offset:0
    v_cvt_pk_bf16_f32 v176, v208, v209
    v_mfma_f32_16x16x32_bf16 a[24:27], a[172:175], v[148:151], a[24:27]
    ds_read_b64_tr_b16 a[186:187], v23 offset:4096
    v_mfma_f32_16x16x32_bf16 a[28:31], a[172:175], v[156:159], a[28:31]
    ds_read_b128 a[208:211], v8 offset:24576
    v_cvt_pk_bf16_f32 v177, v210, v211
    v_mfma_f32_16x16x32_bf16 a[28:31], a[168:171], v[152:155], a[28:31]
    s_waitcnt lgkmcnt(3)
    buffer_load_dwordx4 v40, s[12:15], s41 offen lds
    v_mfma_f32_16x16x32_bf16 v[208:211], a[224:227], v[64:67], v[192:195]
    v_exp_f32 v212, v212
    v_mfma_f32_16x16x32_bf16 v[208:211], a[228:231], v[68:71], v[208:211]
    s_add_u32 s6, s6, 4096
    v_exp_f32 v213, v213
    v_mfma_f32_16x16x32_bf16 v[208:211], a[232:235], v[72:75], v[208:211]
    s_add_u32 s57, s57, 589824
    v_exp_f32 v214, v214
    v_mfma_f32_16x16x32_bf16 v[208:211], a[236:239], v[76:79], v[208:211]
    v_exp_f32 v215, v215
    v_mfma_f32_16x16x32_bf16 a[32:35], a[176:179], v[128:131], a[32:35]
    ds_read_b64_tr_b16 a[188:189], v23 offset:8192
    v_cvt_pk_bf16_f32 v184, v212, v213
    v_mfma_f32_16x16x32_bf16 a[32:35], a[180:183], v[132:135], a[32:35]
    ds_read_b64_tr_b16 a[190:191], v23 offset:12288
    v_mfma_f32_16x16x32_bf16 a[36:39], a[180:183], v[140:143], a[36:39]
    ds_read_b128 a[212:215], v9 offset:24576
    v_cvt_pk_bf16_f32 v185, v214, v215
    v_mfma_f32_16x16x32_bf16 a[36:39], a[176:179], v[136:139], a[36:39]
    v_smfmac_f32_16x16x64_bf16 a[196:199], v[52:55], v[136:143], v50
    v_mfma_f32_16x16x32_bf16 v[212:215], a[224:227], v[80:83], v[196:199]
    v_exp_f32 v208, v208
    v_mfma_f32_16x16x32_bf16 v[212:215], a[228:231], v[84:87], v[212:215]
    v_exp_f32 v209, v209
    v_mfma_f32_16x16x32_bf16 v[212:215], a[232:235], v[88:91], v[212:215]
    v_exp_f32 v210, v210
    v_mfma_f32_16x16x32_bf16 v[212:215], a[236:239], v[92:95], v[212:215]
    v_exp_f32 v211, v211
    v_mfma_f32_16x16x32_bf16 a[40:43], a[176:179], v[144:147], a[40:43]
    ds_read_b64_tr_b16 a[160:161], v24 offset:0
    v_cvt_pk_bf16_f32 v162, v208, v209
    v_mfma_f32_16x16x32_bf16 a[40:43], a[180:183], v[148:151], a[40:43]
    ds_read_b64_tr_b16 a[162:163], v24 offset:4096
    v_mfma_f32_16x16x32_bf16 a[44:47], a[180:183], v[156:159], a[44:47]
    ds_read_b128 a[216:219], v10 offset:24576
    v_cvt_pk_bf16_f32 v163, v210, v211
    v_mfma_f32_16x16x32_bf16 a[44:47], a[176:179], v[152:155], a[44:47]
    s_waitcnt lgkmcnt(3)
    buffer_load_dwordx4 v41, s[12:15], s41 offen offset:1024 lds
    v_mfma_f32_16x16x32_bf16 v[208:211], a[224:227], v[96:99], v[200:203]
    v_exp_f32 v212, v212
    v_mfma_f32_16x16x32_bf16 v[208:211], a[228:231], v[100:103], v[208:211]
    v_exp_f32 v213, v213
    v_mfma_f32_16x16x32_bf16 v[208:211], a[232:235], v[104:107], v[208:211]
    v_exp_f32 v214, v214
    v_mfma_f32_16x16x32_bf16 v[208:211], a[236:239], v[108:111], v[208:211]
    v_exp_f32 v215, v215
    v_mfma_f32_16x16x32_bf16 a[48:51], a[184:187], v[128:131], a[48:51]
    ds_read_b64_tr_b16 a[164:165], v24 offset:8192
    v_cvt_pk_bf16_f32 v170, v212, v213
    v_mfma_f32_16x16x32_bf16 a[48:51], a[188:191], v[132:135], a[48:51]
    ds_read_b64_tr_b16 a[166:167], v24 offset:12288
    v_mfma_f32_16x16x32_bf16 a[52:55], a[188:191], v[140:143], a[52:55]
    ds_read_b128 a[220:223], v11 offset:24576
    v_cvt_pk_bf16_f32 v171, v214, v215
    v_mfma_f32_16x16x32_bf16 a[52:55], a[184:187], v[136:139], a[52:55]
    v_smfmac_f32_16x16x64_bf16 a[200:203], v[52:55], v[144:151], v50
    v_mfma_f32_16x16x32_bf16 v[212:215], a[224:227], v[112:115], v[204:207]
    v_exp_f32 v208, v208
    v_mfma_f32_16x16x32_bf16 v[212:215], a[228:231], v[116:119], v[212:215]
    v_exp_f32 v209, v209
    v_mfma_f32_16x16x32_bf16 v[212:215], a[232:235], v[120:123], v[212:215]
    v_exp_f32 v210, v210
    v_mfma_f32_16x16x32_bf16 v[212:215], a[236:239], v[124:127], v[212:215]
    v_exp_f32 v211, v211
    v_mfma_f32_16x16x32_bf16 a[56:59], a[184:187], v[144:147], a[56:59]
    ds_read_b64_tr_b16 a[168:169], v25 offset:0
    v_cvt_pk_bf16_f32 v178, v208, v209
    v_mfma_f32_16x16x32_bf16 a[56:59], a[188:191], v[148:151], a[56:59]
    ds_read_b64_tr_b16 a[170:171], v25 offset:4096
    v_mfma_f32_16x16x32_bf16 a[60:63], a[188:191], v[156:159], a[60:63]
    ds_read_b128 a[224:227], v8 offset:28672
    v_cvt_pk_bf16_f32 v179, v210, v211
    v_mfma_f32_16x16x32_bf16 a[60:63], a[184:187], v[152:155], a[60:63]
    s_waitcnt lgkmcnt(3)
    buffer_load_dwordx4 v40, s[12:15], s41 offen offset:2048 lds
    v_mfma_f32_16x16x32_bf16 v[208:211], a[208:211], v[64:67], v[192:195]
    v_exp_f32 v212, v212
    v_mfma_f32_16x16x32_bf16 v[208:211], a[212:215], v[68:71], v[208:211]
    v_exp_f32 v213, v213
    v_mfma_f32_16x16x32_bf16 v[208:211], a[216:219], v[72:75], v[208:211]
    v_exp_f32 v214, v214
    v_mfma_f32_16x16x32_bf16 v[208:211], a[220:223], v[76:79], v[208:211]
    v_exp_f32 v215, v215
    v_mfma_f32_16x16x32_bf16 a[64:67], a[160:163], v[128:131], a[64:67]
    ds_read_b64_tr_b16 a[172:173], v25 offset:8192
    v_cvt_pk_bf16_f32 v186, v212, v213
    v_mfma_f32_16x16x32_bf16 a[64:67], a[164:167], v[132:135], a[64:67]
    ds_read_b64_tr_b16 a[174:175], v25 offset:12288
    v_mfma_f32_16x16x32_bf16 a[68:71], a[164:167], v[140:143], a[68:71]
    ds_read_b128 a[228:231], v9 offset:28672
    v_cvt_pk_bf16_f32 v187, v214, v215
    v_mfma_f32_16x16x32_bf16 a[68:71], a[160:163], v[136:139], a[68:71]
    v_smfmac_f32_16x16x64_bf16 a[204:207], v[52:55], v[152:159], v50
    v_mfma_f32_16x16x32_bf16 v[212:215], a[208:211], v[80:83], v[196:199]
    v_exp_f32 v208, v208
    v_mfma_f32_16x16x32_bf16 v[212:215], a[212:215], v[84:87], v[212:215]
    v_exp_f32 v209, v209
    v_mfma_f32_16x16x32_bf16 v[212:215], a[216:219], v[88:91], v[212:215]
    v_exp_f32 v210, v210
    v_mfma_f32_16x16x32_bf16 v[212:215], a[220:223], v[92:95], v[212:215]
    v_exp_f32 v211, v211
    v_mfma_f32_16x16x32_bf16 a[72:75], a[160:163], v[144:147], a[72:75]
    ds_read_b64_tr_b16 a[176:177], v26 offset:0
    v_cvt_pk_bf16_f32 v164, v208, v209
    v_mfma_f32_16x16x32_bf16 a[72:75], a[164:167], v[148:151], a[72:75]
    ds_read_b64_tr_b16 a[178:179], v26 offset:4096
    v_mfma_f32_16x16x32_bf16 a[76:79], a[164:167], v[156:159], a[76:79]
    ds_read_b128 a[232:235], v10 offset:28672
    v_cvt_pk_bf16_f32 v165, v210, v211
    v_mfma_f32_16x16x32_bf16 a[76:79], a[160:163], v[152:155], a[76:79]
    s_waitcnt lgkmcnt(3)
    buffer_load_dwordx4 v41, s[12:15], s41 offen offset:3072 lds
    v_mfma_f32_16x16x32_bf16 v[208:211], a[208:211], v[96:99], v[200:203]
    v_exp_f32 v212, v212
    v_mfma_f32_16x16x32_bf16 v[208:211], a[212:215], v[100:103], v[208:211]
    s_add_u32 s41, s41, 16384
    v_exp_f32 v213, v213
    v_mfma_f32_16x16x32_bf16 v[208:211], a[216:219], v[104:107], v[208:211]
    v_exp_f32 v214, v214
    v_mfma_f32_16x16x32_bf16 v[208:211], a[220:223], v[108:111], v[208:211]
    v_exp_f32 v215, v215
    v_mfma_f32_16x16x32_bf16 a[80:83], a[168:171], v[128:131], a[80:83]
    ds_read_b64_tr_b16 a[180:181], v26 offset:8192
    v_cvt_pk_bf16_f32 v172, v212, v213
    v_mfma_f32_16x16x32_bf16 a[80:83], a[172:175], v[132:135], a[80:83]
    ds_read_b64_tr_b16 a[182:183], v26 offset:12288
    v_mfma_f32_16x16x32_bf16 a[84:87], a[172:175], v[140:143], a[84:87]
    ds_read_b128 a[236:239], v11 offset:28672
    v_cvt_pk_bf16_f32 v173, v214, v215
    v_mfma_f32_16x16x32_bf16 a[84:87], a[168:171], v[136:139], a[84:87]
    s_waitcnt vmcnt(10)
    s_barrier
    v_mfma_f32_16x16x32_bf16 v[212:215], a[208:211], v[112:115], v[204:207]
    v_exp_f32 v208, v208
    v_mfma_f32_16x16x32_bf16 v[212:215], a[212:215], v[116:119], v[212:215]
    s_add_u32 m0, s42, 0
    v_exp_f32 v209, v209
    v_mfma_f32_16x16x32_bf16 v[212:215], a[216:219], v[120:123], v[212:215]
    v_exp_f32 v210, v210
    v_mfma_f32_16x16x32_bf16 v[212:215], a[220:223], v[124:127], v[212:215]
    v_exp_f32 v211, v211
    v_mfma_f32_16x16x32_bf16 a[88:91], a[168:171], v[144:147], a[88:91]
    ds_read_b64_tr_b16 a[184:185], v27 offset:0
    v_cvt_pk_bf16_f32 v180, v208, v209
    v_mfma_f32_16x16x32_bf16 a[88:91], a[172:175], v[148:151], a[88:91]
    ds_read_b64_tr_b16 a[186:187], v27 offset:4096
    v_mfma_f32_16x16x32_bf16 a[92:95], a[172:175], v[156:159], a[92:95]
    ds_read_b128 a[208:211], v8 offset:32768
    v_cvt_pk_bf16_f32 v181, v210, v211
    v_mfma_f32_16x16x32_bf16 a[92:95], a[168:171], v[152:155], a[92:95]
    s_waitcnt lgkmcnt(3)
    buffer_load_dwordx4 v36, s[8:11], s40 offen lds
    v_mfma_f32_16x16x32_bf16 v[208:211], a[224:227], v[64:67], v[192:195]
    v_exp_f32 v212, v212
    v_mfma_f32_16x16x32_bf16 v[208:211], a[228:231], v[68:71], v[208:211]
    v_exp_f32 v213, v213
    v_mfma_f32_16x16x32_bf16 v[208:211], a[232:235], v[72:75], v[208:211]
    v_exp_f32 v214, v214
    v_mfma_f32_16x16x32_bf16 v[208:211], a[236:239], v[76:79], v[208:211]
    v_exp_f32 v215, v215
    v_mfma_f32_16x16x32_bf16 a[96:99], a[176:179], v[128:131], a[96:99]
    ds_read_b64_tr_b16 a[188:189], v27 offset:8192
    v_cvt_pk_bf16_f32 v188, v212, v213
    v_mfma_f32_16x16x32_bf16 a[96:99], a[180:183], v[132:135], a[96:99]
    ds_read_b64_tr_b16 a[190:191], v27 offset:12288
    v_mfma_f32_16x16x32_bf16 a[100:103], a[180:183], v[140:143], a[100:103]
    ds_read_b128 a[212:215], v9 offset:32768
    v_cvt_pk_bf16_f32 v189, v214, v215
    v_mfma_f32_16x16x32_bf16 a[100:103], a[176:179], v[136:139], a[100:103]
    v_mfma_f32_16x16x32_bf16 v[212:215], a[224:227], v[80:83], v[196:199]
    v_exp_f32 v208, v208
    v_mfma_f32_16x16x32_bf16 v[212:215], a[228:231], v[84:87], v[212:215]
    v_exp_f32 v209, v209
    v_mfma_f32_16x16x32_bf16 v[212:215], a[232:235], v[88:91], v[212:215]
    v_exp_f32 v210, v210
    v_mfma_f32_16x16x32_bf16 v[212:215], a[236:239], v[92:95], v[212:215]
    v_exp_f32 v211, v211
    v_mfma_f32_16x16x32_bf16 a[104:107], a[176:179], v[144:147], a[104:107]
    ds_read_b64_tr_b16 a[160:161], v20 offset:16384
    v_cvt_pk_bf16_f32 v166, v208, v209
    v_mfma_f32_16x16x32_bf16 a[104:107], a[180:183], v[148:151], a[104:107]
    ds_read_b64_tr_b16 a[162:163], v20 offset:20480
    v_mfma_f32_16x16x32_bf16 a[108:111], a[180:183], v[156:159], a[108:111]
    ds_read_b128 a[216:219], v10 offset:32768
    v_cvt_pk_bf16_f32 v167, v210, v211
    v_mfma_f32_16x16x32_bf16 a[108:111], a[176:179], v[152:155], a[108:111]
    s_waitcnt lgkmcnt(3)
    buffer_load_dwordx4 v37, s[8:11], s40 offen offset:1024 lds
    v_mfma_f32_16x16x32_bf16 v[208:211], a[224:227], v[96:99], v[200:203]
    v_exp_f32 v212, v212
    v_mfma_f32_16x16x32_bf16 v[208:211], a[228:231], v[100:103], v[208:211]
    v_exp_f32 v213, v213
    v_mfma_f32_16x16x32_bf16 v[208:211], a[232:235], v[104:107], v[208:211]
    v_exp_f32 v214, v214
    v_mfma_f32_16x16x32_bf16 v[208:211], a[236:239], v[108:111], v[208:211]
    v_exp_f32 v215, v215
    v_mfma_f32_16x16x32_bf16 a[112:115], a[184:187], v[128:131], a[112:115]
    ds_read_b64_tr_b16 a[164:165], v20 offset:24576
    v_cvt_pk_bf16_f32 v174, v212, v213
    v_mfma_f32_16x16x32_bf16 a[112:115], a[188:191], v[132:135], a[112:115]
    ds_read_b64_tr_b16 a[166:167], v20 offset:28672
    v_mfma_f32_16x16x32_bf16 a[116:119], a[188:191], v[140:143], a[116:119]
    ds_read_b128 a[220:223], v11 offset:32768
    v_cvt_pk_bf16_f32 v175, v214, v215
    v_mfma_f32_16x16x32_bf16 a[116:119], a[184:187], v[136:139], a[116:119]
    buffer_load_dwordx4 v[240:243], v7, s[16:19], s44 offen
    v_mfma_f32_16x16x32_bf16 v[212:215], a[224:227], v[112:115], v[204:207]
    v_exp_f32 v208, v208
    v_mfma_f32_16x16x32_bf16 v[212:215], a[228:231], v[116:119], v[212:215]
    v_exp_f32 v209, v209
    v_mfma_f32_16x16x32_bf16 v[212:215], a[232:235], v[120:123], v[212:215]
    v_exp_f32 v210, v210
    v_mfma_f32_16x16x32_bf16 v[212:215], a[236:239], v[124:127], v[212:215]
    s_add_u32 s44, s44, 884736
    v_exp_f32 v211, v211
    v_mfma_f32_16x16x32_bf16 a[120:123], a[184:187], v[144:147], a[120:123]
    ds_read_b64_tr_b16 a[168:169], v21 offset:16384
    v_cvt_pk_bf16_f32 v182, v208, v209
    v_mfma_f32_16x16x32_bf16 a[120:123], a[188:191], v[148:151], a[120:123]
    ds_read_b64_tr_b16 a[170:171], v21 offset:20480
    v_mfma_f32_16x16x32_bf16 a[124:127], a[188:191], v[156:159], a[124:127]
    ds_read_b128 a[224:227], v8 offset:36864
    v_cvt_pk_bf16_f32 v183, v210, v211
    v_mfma_f32_16x16x32_bf16 a[124:127], a[184:187], v[152:155], a[124:127]
    s_waitcnt lgkmcnt(3)
    buffer_load_dwordx4 v38, s[8:11], s40 offen offset:2048 lds
    v_mfma_f32_16x16x32_bf16 v[208:211], a[208:211], v[64:67], v[192:195]
    v_exp_f32 v212, v212
    v_mfma_f32_16x16x32_bf16 v[208:211], a[212:215], v[68:71], v[208:211]
    v_exp_f32 v213, v213
    v_mfma_f32_16x16x32_bf16 v[208:211], a[216:219], v[72:75], v[208:211]
    v_exp_f32 v214, v214
    v_mfma_f32_16x16x32_bf16 v[208:211], a[220:223], v[76:79], v[208:211]
Ltour4:
    s_cbranch_execz Ltour8
    v_exp_f32 v215, v215
    v_mfma_f32_16x16x32_bf16 a[0:3], a[160:163], v[160:163], a[0:3]
    ds_read_b64_tr_b16 a[172:173], v21 offset:24576
    v_cvt_pk_bf16_f32 v190, v212, v213
    v_mfma_f32_16x16x32_bf16 a[0:3], a[164:167], v[164:167], a[0:3]
    ds_read_b64_tr_b16 a[174:175], v21 offset:28672
    v_mfma_f32_16x16x32_bf16 a[4:7], a[164:167], v[172:175], a[4:7]
    ds_read_b128 a[228:231], v9 offset:36864
    v_cvt_pk_bf16_f32 v191, v214, v215
    v_mfma_f32_16x16x32_bf16 a[4:7], a[160:163], v[168:171], a[4:7]
    v_mfma_f32_16x16x32_bf16 v[212:215], a[208:211], v[80:83], v[196:199]
    v_exp_f32 v208, v208
    v_mfma_f32_16x16x32_bf16 v[212:215], a[212:215], v[84:87], v[212:215]
    v_exp_f32 v209, v209
    v_mfma_f32_16x16x32_bf16 v[212:215], a[216:219], v[88:91], v[212:215]
    v_exp_f32 v210, v210
    v_mfma_f32_16x16x32_bf16 v[212:215], a[220:223], v[92:95], v[212:215]
    v_exp_f32 v211, v211
    v_mfma_f32_16x16x32_bf16 a[8:11], a[160:163], v[176:179], a[8:11]
    ds_read_b64_tr_b16 a[176:177], v22 offset:16384
    v_cvt_pk_bf16_f32 v128, v208, v209
    v_mfma_f32_16x16x32_bf16 a[8:11], a[164:167], v[180:183], a[8:11]
    ds_read_b64_tr_b16 a[178:179], v22 offset:20480
    v_mfma_f32_16x16x32_bf16 a[12:15], a[164:167], v[188:191], a[12:15]
    ds_read_b128 a[232:235], v10 offset:36864
    v_cvt_pk_bf16_f32 v129, v210, v211
    v_mfma_f32_16x16x32_bf16 a[12:15], a[160:163], v[184:187], a[12:15]
    s_waitcnt lgkmcnt(3)
    buffer_load_dwordx4 v39, s[8:11], s40 offen offset:3072 lds
    v_mfma_f32_16x16x32_bf16 v[208:211], a[208:211], v[96:99], v[200:203]
    v_exp_f32 v212, v212
    v_mfma_f32_16x16x32_bf16 v[208:211], a[212:215], v[100:103], v[208:211]
    s_add_u32 s40, s40, 16384
    v_exp_f32 v213, v213
    v_mfma_f32_16x16x32_bf16 v[208:211], a[216:219], v[104:107], v[208:211]
    v_exp_f32 v214, v214
    v_mfma_f32_16x16x32_bf16 v[208:211], a[220:223], v[108:111], v[208:211]
    v_exp_f32 v215, v215
    v_mfma_f32_16x16x32_bf16 a[16:19], a[168:171], v[160:163], a[16:19]
    ds_read_b64_tr_b16 a[180:181], v22 offset:24576
    v_cvt_pk_bf16_f32 v136, v212, v213
    v_mfma_f32_16x16x32_bf16 a[16:19], a[172:175], v[164:167], a[16:19]
    ds_read_b64_tr_b16 a[182:183], v22 offset:28672
    v_mfma_f32_16x16x32_bf16 a[20:23], a[172:175], v[172:175], a[20:23]
    ds_read_b128 a[236:239], v11 offset:36864
    v_cvt_pk_bf16_f32 v137, v214, v215
    v_mfma_f32_16x16x32_bf16 a[20:23], a[168:171], v[168:171], a[20:23]
    v_smfmac_f32_16x16x64_bf16 a[192:195], v[52:55], v[160:167], v50
    v_mfma_f32_16x16x32_bf16 v[212:215], a[208:211], v[112:115], v[204:207]
    v_exp_f32 v208, v208
    v_mfma_f32_16x16x32_bf16 v[212:215], a[212:215], v[116:119], v[212:215]
    s_add_u32 m0, s42, 114688
    v_exp_f32 v209, v209
    v_mfma_f32_16x16x32_bf16 v[212:215], a[216:219], v[120:123], v[212:215]
    v_exp_f32 v210, v210
    v_mfma_f32_16x16x32_bf16 v[212:215], a[220:223], v[124:127], v[212:215]
    v_exp_f32 v211, v211
    v_mfma_f32_16x16x32_bf16 a[24:27], a[168:171], v[176:179], a[24:27]
    ds_read_b64_tr_b16 a[184:185], v23 offset:16384
    v_cvt_pk_bf16_f32 v144, v208, v209
    v_mfma_f32_16x16x32_bf16 a[24:27], a[172:175], v[180:183], a[24:27]
    ds_read_b64_tr_b16 a[186:187], v23 offset:20480
    v_mfma_f32_16x16x32_bf16 a[28:31], a[172:175], v[188:191], a[28:31]
    ds_read_b128 a[208:211], v8 offset:40960
    v_cvt_pk_bf16_f32 v145, v210, v211
    v_mfma_f32_16x16x32_bf16 a[28:31], a[168:171], v[184:187], a[28:31]
    s_waitcnt lgkmcnt(3)
    buffer_load_dwordx4 v40, s[12:15], s41 offen lds
    v_mfma_f32_16x16x32_bf16 v[208:211], a[224:227], v[64:67], v[192:195]
    v_exp_f32 v212, v212
    v_mfma_f32_16x16x32_bf16 v[208:211], a[228:231], v[68:71], v[208:211]
    v_exp_f32 v213, v213
    v_mfma_f32_16x16x32_bf16 v[208:211], a[232:235], v[72:75], v[208:211]
    v_exp_f32 v214, v214
    v_mfma_f32_16x16x32_bf16 v[208:211], a[236:239], v[76:79], v[208:211]
    v_exp_f32 v215, v215
    v_mfma_f32_16x16x32_bf16 a[32:35], a[176:179], v[160:163], a[32:35]
    ds_read_b64_tr_b16 a[188:189], v23 offset:24576
    v_cvt_pk_bf16_f32 v152, v212, v213
    v_mfma_f32_16x16x32_bf16 a[32:35], a[180:183], v[164:167], a[32:35]
    ds_read_b64_tr_b16 a[190:191], v23 offset:28672
    v_mfma_f32_16x16x32_bf16 a[36:39], a[180:183], v[172:175], a[36:39]
    ds_read_b128 a[212:215], v9 offset:40960
    v_cvt_pk_bf16_f32 v153, v214, v215
    v_mfma_f32_16x16x32_bf16 a[36:39], a[176:179], v[168:171], a[36:39]
    v_smfmac_f32_16x16x64_bf16 a[196:199], v[52:55], v[168:175], v50
    v_mfma_f32_16x16x32_bf16 v[212:215], a[224:227], v[80:83], v[196:199]
    v_exp_f32 v208, v208
    v_mfma_f32_16x16x32_bf16 v[212:215], a[228:231], v[84:87], v[212:215]
    v_exp_f32 v209, v209
    v_mfma_f32_16x16x32_bf16 v[212:215], a[232:235], v[88:91], v[212:215]
    v_exp_f32 v210, v210
    v_mfma_f32_16x16x32_bf16 v[212:215], a[236:239], v[92:95], v[212:215]
    v_exp_f32 v211, v211
    v_mfma_f32_16x16x32_bf16 a[40:43], a[176:179], v[176:179], a[40:43]
    ds_read_b64_tr_b16 a[160:161], v24 offset:16384
    v_cvt_pk_bf16_f32 v130, v208, v209
    v_mfma_f32_16x16x32_bf16 a[40:43], a[180:183], v[180:183], a[40:43]
    ds_read_b64_tr_b16 a[162:163], v24 offset:20480
    v_mfma_f32_16x16x32_bf16 a[44:47], a[180:183], v[188:191], a[44:47]
    ds_read_b128 a[216:219], v10 offset:40960
    v_cvt_pk_bf16_f32 v131, v210, v211
    v_mfma_f32_16x16x32_bf16 a[44:47], a[176:179], v[184:187], a[44:47]
    s_waitcnt lgkmcnt(3)
    buffer_load_dwordx4 v41, s[12:15], s41 offen offset:1024 lds
    v_mfma_f32_16x16x32_bf16 v[208:211], a[224:227], v[96:99], v[200:203]
    v_exp_f32 v212, v212
    v_mfma_f32_16x16x32_bf16 v[208:211], a[228:231], v[100:103], v[208:211]
    v_exp_f32 v213, v213
    v_mfma_f32_16x16x32_bf16 v[208:211], a[232:235], v[104:107], v[208:211]
    v_exp_f32 v214, v214
    v_mfma_f32_16x16x32_bf16 v[208:211], a[236:239], v[108:111], v[208:211]
    v_exp_f32 v215, v215
    v_mfma_f32_16x16x32_bf16 a[48:51], a[184:187], v[160:163], a[48:51]
    ds_read_b64_tr_b16 a[164:165], v24 offset:24576
    v_cvt_pk_bf16_f32 v138, v212, v213
    v_mfma_f32_16x16x32_bf16 a[48:51], a[188:191], v[164:167], a[48:51]
    ds_read_b64_tr_b16 a[166:167], v24 offset:28672
    v_mfma_f32_16x16x32_bf16 a[52:55], a[188:191], v[172:175], a[52:55]
    ds_read_b128 a[220:223], v11 offset:40960
    v_cvt_pk_bf16_f32 v139, v214, v215
    v_mfma_f32_16x16x32_bf16 a[52:55], a[184:187], v[168:171], a[52:55]
    v_smfmac_f32_16x16x64_bf16 a[200:203], v[52:55], v[176:183], v50
    v_mfma_f32_16x16x32_bf16 v[212:215], a[224:227], v[112:115], v[204:207]
    v_exp_f32 v208, v208
    v_mfma_f32_16x16x32_bf16 v[212:215], a[228:231], v[116:119], v[212:215]
    v_exp_f32 v209, v209
    v_mfma_f32_16x16x32_bf16 v[212:215], a[232:235], v[120:123], v[212:215]
    v_exp_f32 v210, v210
    v_mfma_f32_16x16x32_bf16 v[212:215], a[236:239], v[124:127], v[212:215]
    v_exp_f32 v211, v211
    v_mfma_f32_16x16x32_bf16 a[56:59], a[184:187], v[176:179], a[56:59]
    ds_read_b64_tr_b16 a[168:169], v25 offset:16384
    v_cvt_pk_bf16_f32 v146, v208, v209
    v_mfma_f32_16x16x32_bf16 a[56:59], a[188:191], v[180:183], a[56:59]
    ds_read_b64_tr_b16 a[170:171], v25 offset:20480
    v_mfma_f32_16x16x32_bf16 a[60:63], a[188:191], v[188:191], a[60:63]
    ds_read_b128 a[224:227], v8 offset:45056
    v_cvt_pk_bf16_f32 v147, v210, v211
    v_mfma_f32_16x16x32_bf16 a[60:63], a[184:187], v[184:187], a[60:63]
    s_waitcnt lgkmcnt(3)
    buffer_load_dwordx4 v40, s[12:15], s41 offen offset:2048 lds
    v_mfma_f32_16x16x32_bf16 v[208:211], a[208:211], v[64:67], v[192:195]
    v_exp_f32 v212, v212
    v_mfma_f32_16x16x32_bf16 v[208:211], a[212:215], v[68:71], v[208:211]
    v_exp_f32 v213, v213
    v_mfma_f32_16x16x32_bf16 v[208:211], a[216:219], v[72:75], v[208:211]
    v_exp_f32 v214, v214
    v_mfma_f32_16x16x32_bf16 v[208:211], a[220:223], v[76:79], v[208:211]
    v_exp_f32 v215, v215
    v_mfma_f32_16x16x32_bf16 a[64:67], a[160:163], v[160:163], a[64:67]
    ds_read_b64_tr_b16 a[172:173], v25 offset:24576
    v_cvt_pk_bf16_f32 v154, v212, v213
    v_mfma_f32_16x16x32_bf16 a[64:67], a[164:167], v[164:167], a[64:67]
    ds_read_b64_tr_b16 a[174:175], v25 offset:28672
    v_mfma_f32_16x16x32_bf16 a[68:71], a[164:167], v[172:175], a[68:71]
    ds_read_b128 a[228:231], v9 offset:45056
    v_cvt_pk_bf16_f32 v155, v214, v215
    v_mfma_f32_16x16x32_bf16 a[68:71], a[160:163], v[168:171], a[68:71]
    v_smfmac_f32_16x16x64_bf16 a[204:207], v[52:55], v[184:191], v50
    v_mfma_f32_16x16x32_bf16 v[212:215], a[208:211], v[80:83], v[196:199]
    v_exp_f32 v208, v208
    v_mfma_f32_16x16x32_bf16 v[212:215], a[212:215], v[84:87], v[212:215]
    v_exp_f32 v209, v209
    v_mfma_f32_16x16x32_bf16 v[212:215], a[216:219], v[88:91], v[212:215]
    v_exp_f32 v210, v210
    v_mfma_f32_16x16x32_bf16 v[212:215], a[220:223], v[92:95], v[212:215]
    v_exp_f32 v211, v211
    v_mfma_f32_16x16x32_bf16 a[72:75], a[160:163], v[176:179], a[72:75]
    ds_read_b64_tr_b16 a[176:177], v26 offset:16384
    v_cvt_pk_bf16_f32 v132, v208, v209
    v_mfma_f32_16x16x32_bf16 a[72:75], a[164:167], v[180:183], a[72:75]
    ds_read_b64_tr_b16 a[178:179], v26 offset:20480
    v_mfma_f32_16x16x32_bf16 a[76:79], a[164:167], v[188:191], a[76:79]
    ds_read_b128 a[232:235], v10 offset:45056
    v_cvt_pk_bf16_f32 v133, v210, v211
    v_mfma_f32_16x16x32_bf16 a[76:79], a[160:163], v[184:187], a[76:79]
    s_waitcnt lgkmcnt(3)
    buffer_load_dwordx4 v41, s[12:15], s41 offen offset:3072 lds
    v_mfma_f32_16x16x32_bf16 v[208:211], a[208:211], v[96:99], v[200:203]
    v_exp_f32 v212, v212
    v_mfma_f32_16x16x32_bf16 v[208:211], a[212:215], v[100:103], v[208:211]
    s_add_u32 s41, s41, 16384
    v_exp_f32 v213, v213
    v_mfma_f32_16x16x32_bf16 v[208:211], a[216:219], v[104:107], v[208:211]
    v_exp_f32 v214, v214
    v_mfma_f32_16x16x32_bf16 v[208:211], a[220:223], v[108:111], v[208:211]
    v_exp_f32 v215, v215
    v_mfma_f32_16x16x32_bf16 a[80:83], a[168:171], v[160:163], a[80:83]
    ds_read_b64_tr_b16 a[180:181], v26 offset:24576
    v_cvt_pk_bf16_f32 v140, v212, v213
    v_mfma_f32_16x16x32_bf16 a[80:83], a[172:175], v[164:167], a[80:83]
    ds_read_b64_tr_b16 a[182:183], v26 offset:28672
    v_mfma_f32_16x16x32_bf16 a[84:87], a[172:175], v[172:175], a[84:87]
    ds_read_b128 a[236:239], v11 offset:45056
    v_cvt_pk_bf16_f32 v141, v214, v215
    v_mfma_f32_16x16x32_bf16 a[84:87], a[168:171], v[168:171], a[84:87]
    s_waitcnt vmcnt(9)
    s_barrier
    v_mfma_f32_16x16x32_bf16 v[212:215], a[208:211], v[112:115], v[204:207]
    v_exp_f32 v208, v208
    v_mfma_f32_16x16x32_bf16 v[212:215], a[212:215], v[116:119], v[212:215]
    s_add_u32 m0, s42, 16384
    v_exp_f32 v209, v209
    v_mfma_f32_16x16x32_bf16 v[212:215], a[216:219], v[120:123], v[212:215]
    v_exp_f32 v210, v210
    v_mfma_f32_16x16x32_bf16 v[212:215], a[220:223], v[124:127], v[212:215]
    v_exp_f32 v211, v211
    v_mfma_f32_16x16x32_bf16 a[88:91], a[168:171], v[176:179], a[88:91]
    ds_read_b64_tr_b16 a[184:185], v27 offset:16384
    v_cvt_pk_bf16_f32 v148, v208, v209
    v_mfma_f32_16x16x32_bf16 a[88:91], a[172:175], v[180:183], a[88:91]
    ds_read_b64_tr_b16 a[186:187], v27 offset:20480
    v_mfma_f32_16x16x32_bf16 a[92:95], a[172:175], v[188:191], a[92:95]
    ds_read_b128 a[208:211], v8 offset:49152
    v_cvt_pk_bf16_f32 v149, v210, v211
    v_mfma_f32_16x16x32_bf16 a[92:95], a[168:171], v[184:187], a[92:95]
    s_waitcnt lgkmcnt(3)
    buffer_load_dwordx4 v36, s[8:11], s40 offen lds
    v_mfma_f32_16x16x32_bf16 v[208:211], a[224:227], v[64:67], v[192:195]
    v_exp_f32 v212, v212
    v_mfma_f32_16x16x32_bf16 v[208:211], a[228:231], v[68:71], v[208:211]
    v_exp_f32 v213, v213
    v_mfma_f32_16x16x32_bf16 v[208:211], a[232:235], v[72:75], v[208:211]
    v_exp_f32 v214, v214
    v_mfma_f32_16x16x32_bf16 v[208:211], a[236:239], v[76:79], v[208:211]
    v_exp_f32 v215, v215
    v_mfma_f32_16x16x32_bf16 a[96:99], a[176:179], v[160:163], a[96:99]
    ds_read_b64_tr_b16 a[188:189], v27 offset:24576
    v_cvt_pk_bf16_f32 v156, v212, v213
    v_mfma_f32_16x16x32_bf16 a[96:99], a[180:183], v[164:167], a[96:99]
    ds_read_b64_tr_b16 a[190:191], v27 offset:28672
    v_mfma_f32_16x16x32_bf16 a[100:103], a[180:183], v[172:175], a[100:103]
    ds_read_b128 a[212:215], v9 offset:49152
    v_cvt_pk_bf16_f32 v157, v214, v215
    v_mfma_f32_16x16x32_bf16 a[100:103], a[176:179], v[168:171], a[100:103]
    buffer_load_dword v218, v57, s[80:83], s39 offen
    v_mfma_f32_16x16x32_bf16 v[212:215], a[224:227], v[80:83], v[196:199]
    v_exp_f32 v208, v208
    v_mfma_f32_16x16x32_bf16 v[212:215], a[228:231], v[84:87], v[212:215]
    v_exp_f32 v209, v209
    v_mfma_f32_16x16x32_bf16 v[212:215], a[232:235], v[88:91], v[212:215]
    v_exp_f32 v210, v210
    v_mfma_f32_16x16x32_bf16 v[212:215], a[236:239], v[92:95], v[212:215]
    v_exp_f32 v211, v211
    v_mfma_f32_16x16x32_bf16 a[104:107], a[176:179], v[176:179], a[104:107]
    ds_read_b64_tr_b16 a[160:161], v20 offset:32768
    v_cvt_pk_bf16_f32 v134, v208, v209
    v_mfma_f32_16x16x32_bf16 a[104:107], a[180:183], v[180:183], a[104:107]
    ds_read_b64_tr_b16 a[162:163], v20 offset:36864
    v_mfma_f32_16x16x32_bf16 a[108:111], a[180:183], v[188:191], a[108:111]
    ds_read_b128 a[216:219], v10 offset:49152
    v_cvt_pk_bf16_f32 v135, v210, v211
    v_mfma_f32_16x16x32_bf16 a[108:111], a[176:179], v[184:187], a[108:111]
    s_waitcnt lgkmcnt(3)
    buffer_load_dwordx4 v37, s[8:11], s40 offen offset:1024 lds
    v_mfma_f32_16x16x32_bf16 v[208:211], a[224:227], v[96:99], v[200:203]
    v_exp_f32 v212, v212
    v_mfma_f32_16x16x32_bf16 v[208:211], a[228:231], v[100:103], v[208:211]
    v_exp_f32 v213, v213
    v_mfma_f32_16x16x32_bf16 v[208:211], a[232:235], v[104:107], v[208:211]
    v_exp_f32 v214, v214
    v_mfma_f32_16x16x32_bf16 v[208:211], a[236:239], v[108:111], v[208:211]
    v_exp_f32 v215, v215
    v_mfma_f32_16x16x32_bf16 a[112:115], a[184:187], v[160:163], a[112:115]
    ds_read_b64_tr_b16 a[164:165], v20 offset:40960
    v_cvt_pk_bf16_f32 v142, v212, v213
    v_mfma_f32_16x16x32_bf16 a[112:115], a[188:191], v[164:167], a[112:115]
    ds_read_b64_tr_b16 a[166:167], v20 offset:45056
    v_mfma_f32_16x16x32_bf16 a[116:119], a[188:191], v[172:175], a[116:119]
    ds_read_b128 a[220:223], v11 offset:49152
    v_cvt_pk_bf16_f32 v143, v214, v215
    v_mfma_f32_16x16x32_bf16 a[116:119], a[184:187], v[168:171], a[116:119]
    buffer_store_dwordx4 v[248:251], v232, s[24:27], s53 offen sc1
    v_mfma_f32_16x16x32_bf16 v[212:215], a[224:227], v[112:115], v[204:207]
    v_exp_f32 v208, v208
    v_mfma_f32_16x16x32_bf16 v[212:215], a[228:231], v[116:119], v[212:215]
    v_exp_f32 v209, v209
    v_mfma_f32_16x16x32_bf16 v[212:215], a[232:235], v[120:123], v[212:215]
    v_exp_f32 v210, v210
    v_mfma_f32_16x16x32_bf16 v[212:215], a[236:239], v[124:127], v[212:215]
    s_add_u32 s53, s53, 656
    v_exp_f32 v211, v211
    v_mfma_f32_16x16x32_bf16 a[120:123], a[184:187], v[176:179], a[120:123]
    ds_read_b64_tr_b16 a[168:169], v21 offset:32768
    v_cvt_pk_bf16_f32 v150, v208, v209
    v_mfma_f32_16x16x32_bf16 a[120:123], a[188:191], v[180:183], a[120:123]
    ds_read_b64_tr_b16 a[170:171], v21 offset:36864
    v_mfma_f32_16x16x32_bf16 a[124:127], a[188:191], v[188:191], a[124:127]
    ds_read_b128 a[224:227], v8 offset:53248
    v_cvt_pk_bf16_f32 v151, v210, v211
    v_mfma_f32_16x16x32_bf16 a[124:127], a[184:187], v[184:187], a[124:127]
    s_waitcnt lgkmcnt(3)
    buffer_load_dwordx4 v38, s[8:11], s40 offen offset:2048 lds
    v_mfma_f32_16x16x32_bf16 v[208:211], a[208:211], v[64:67], v[192:195]
    v_exp_f32 v212, v212
    v_mfma_f32_16x16x32_bf16 v[208:211], a[212:215], v[68:71], v[208:211]
    v_exp_f32 v213, v213
    v_mfma_f32_16x16x32_bf16 v[208:211], a[216:219], v[72:75], v[208:211]
    v_exp_f32 v214, v214
    v_mfma_f32_16x16x32_bf16 v[208:211], a[220:223], v[76:79], v[208:211]
    v_exp_f32 v215, v215
    v_mfma_f32_16x16x32_bf16 a[0:3], a[160:163], v[128:131], a[0:3]
    ds_read_b64_tr_b16 a[172:173], v21 offset:40960
    v_cvt_pk_bf16_f32 v158, v212, v213
    v_mfma_f32_16x16x32_bf16 a[0:3], a[164:167], v[132:135], a[0:3]
    ds_read_b64_tr_b16 a[174:175], v21 offset:45056
    v_mfma_f32_16x16x32_bf16 a[4:7], a[164:167], v[140:143], a[4:7]
    ds_read_b128 a[228:231], v9 offset:53248
    v_cvt_pk_bf16_f32 v159, v214, v215
    v_mfma_f32_16x16x32_bf16 a[4:7], a[160:163], v[136:139], a[4:7]
    v_mfma_f32_16x16x32_bf16 v[212:215], a[208:211], v[80:83], v[196:199]
    v_exp_f32 v208, v208
    v_mfma_f32_16x16x32_bf16 v[212:215], a[212:215], v[84:87], v[212:215]
    v_exp_f32 v209, v209
    v_mfma_f32_16x16x32_bf16 v[212:215], a[216:219], v[88:91], v[212:215]
    v_exp_f32 v210, v210
    v_mfma_f32_16x16x32_bf16 v[212:215], a[220:223], v[92:95], v[212:215]
    v_exp_f32 v211, v211
    v_mfma_f32_16x16x32_bf16 a[8:11], a[160:163], v[144:147], a[8:11]
    ds_read_b64_tr_b16 a[176:177], v22 offset:32768
    v_cvt_pk_bf16_f32 v160, v208, v209
    v_mfma_f32_16x16x32_bf16 a[8:11], a[164:167], v[148:151], a[8:11]
    ds_read_b64_tr_b16 a[178:179], v22 offset:36864
    v_mfma_f32_16x16x32_bf16 a[12:15], a[164:167], v[156:159], a[12:15]
    ds_read_b128 a[232:235], v10 offset:53248
    v_cvt_pk_bf16_f32 v161, v210, v211
    v_mfma_f32_16x16x32_bf16 a[12:15], a[160:163], v[152:155], a[12:15]
    s_waitcnt lgkmcnt(3)
    buffer_load_dwordx4 v39, s[8:11], s40 offen offset:3072 lds
    v_mfma_f32_16x16x32_bf16 v[208:211], a[208:211], v[96:99], v[200:203]
    v_exp_f32 v212, v212
    v_mfma_f32_16x16x32_bf16 v[208:211], a[212:215], v[100:103], v[208:211]
    s_add_u32 s40, s40, 16384
    v_exp_f32 v213, v213
    v_mfma_f32_16x16x32_bf16 v[208:211], a[216:219], v[104:107], v[208:211]
    v_exp_f32 v214, v214
    v_mfma_f32_16x16x32_bf16 v[208:211], a[220:223], v[108:111], v[208:211]
    v_exp_f32 v215, v215
    v_mfma_f32_16x16x32_bf16 a[16:19], a[168:171], v[128:131], a[16:19]
    ds_read_b64_tr_b16 a[180:181], v22 offset:40960
    v_cvt_pk_bf16_f32 v168, v212, v213
    v_mfma_f32_16x16x32_bf16 a[16:19], a[172:175], v[132:135], a[16:19]
    ds_read_b64_tr_b16 a[182:183], v22 offset:45056
    v_mfma_f32_16x16x32_bf16 a[20:23], a[172:175], v[140:143], a[20:23]
    ds_read_b128 a[236:239], v11 offset:53248
    v_cvt_pk_bf16_f32 v169, v214, v215
    v_mfma_f32_16x16x32_bf16 a[20:23], a[168:171], v[136:139], a[20:23]
    v_smfmac_f32_16x16x64_bf16 a[192:195], v[52:55], v[128:135], v50
    v_mfma_f32_16x16x32_bf16 v[212:215], a[208:211], v[112:115], v[204:207]
    v_exp_f32 v208, v208
    v_mfma_f32_16x16x32_bf16 v[212:215], a[212:215], v[116:119], v[212:215]
    s_add_u32 m0, s42, 65536
    v_exp_f32 v209, v209
    v_mfma_f32_16x16x32_bf16 v[212:215], a[216:219], v[120:123], v[212:215]
    v_exp_f32 v210, v210
    v_mfma_f32_16x16x32_bf16 v[212:215], a[220:223], v[124:127], v[212:215]
    v_exp_f32 v211, v211
    v_mfma_f32_16x16x32_bf16 a[24:27], a[168:171], v[144:147], a[24:27]
    ds_read_b64_tr_b16 a[184:185], v23 offset:32768
    v_cvt_pk_bf16_f32 v176, v208, v209
    v_mfma_f32_16x16x32_bf16 a[24:27], a[172:175], v[148:151], a[24:27]
    ds_read_b64_tr_b16 a[186:187], v23 offset:36864
    v_mfma_f32_16x16x32_bf16 a[28:31], a[172:175], v[156:159], a[28:31]
    ds_read_b128 a[208:211], v8 offset:57344
    v_cvt_pk_bf16_f32 v177, v210, v211
    v_mfma_f32_16x16x32_bf16 a[28:31], a[168:171], v[152:155], a[28:31]
    s_waitcnt lgkmcnt(3)
    buffer_load_dwordx4 v40, s[12:15], s41 offen lds
    v_mfma_f32_16x16x32_bf16 v[208:211], a[224:227], v[64:67], v[192:195]
    v_exp_f32 v212, v212
    v_mfma_f32_16x16x32_bf16 v[208:211], a[228:231], v[68:71], v[208:211]
    v_exp_f32 v213, v213
    v_mfma_f32_16x16x32_bf16 v[208:211], a[232:235], v[72:75], v[208:211]
    v_exp_f32 v214, v214
    v_mfma_f32_16x16x32_bf16 v[208:211], a[236:239], v[76:79], v[208:211]
    v_exp_f32 v215, v215
    v_mfma_f32_16x16x32_bf16 a[32:35], a[176:179], v[128:131], a[32:35]
    ds_read_b64_tr_b16 a[188:189], v23 offset:40960
    v_cvt_pk_bf16_f32 v184, v212, v213
    v_mfma_f32_16x16x32_bf16 a[32:35], a[180:183], v[132:135], a[32:35]
    ds_read_b64_tr_b16 a[190:191], v23 offset:45056
    v_mfma_f32_16x16x32_bf16 a[36:39], a[180:183], v[140:143], a[36:39]
    ds_read_b128 a[212:215], v9 offset:57344
    v_cvt_pk_bf16_f32 v185, v214, v215
    v_mfma_f32_16x16x32_bf16 a[36:39], a[176:179], v[136:139], a[36:39]
    v_smfmac_f32_16x16x64_bf16 a[196:199], v[52:55], v[136:143], v50
    v_mfma_f32_16x16x32_bf16 v[212:215], a[224:227], v[80:83], v[196:199]
    v_exp_f32 v208, v208
    v_mfma_f32_16x16x32_bf16 v[212:215], a[228:231], v[84:87], v[212:215]
    v_exp_f32 v209, v209
    v_mfma_f32_16x16x32_bf16 v[212:215], a[232:235], v[88:91], v[212:215]
    v_exp_f32 v210, v210
    v_mfma_f32_16x16x32_bf16 v[212:215], a[236:239], v[92:95], v[212:215]
    v_exp_f32 v211, v211
    v_mfma_f32_16x16x32_bf16 a[40:43], a[176:179], v[144:147], a[40:43]
    ds_read_b64_tr_b16 a[160:161], v24 offset:32768
    v_cvt_pk_bf16_f32 v162, v208, v209
    v_mfma_f32_16x16x32_bf16 a[40:43], a[180:183], v[148:151], a[40:43]
    ds_read_b64_tr_b16 a[162:163], v24 offset:36864
    v_mfma_f32_16x16x32_bf16 a[44:47], a[180:183], v[156:159], a[44:47]
    ds_read_b128 a[216:219], v10 offset:57344
    v_cvt_pk_bf16_f32 v163, v210, v211
    v_mfma_f32_16x16x32_bf16 a[44:47], a[176:179], v[152:155], a[44:47]
    s_waitcnt lgkmcnt(3)
    buffer_load_dwordx4 v41, s[12:15], s41 offen offset:1024 lds
    v_mfma_f32_16x16x32_bf16 v[208:211], a[224:227], v[96:99], v[200:203]
    v_exp_f32 v212, v212
    v_mfma_f32_16x16x32_bf16 v[208:211], a[228:231], v[100:103], v[208:211]
    v_exp_f32 v213, v213
    v_mfma_f32_16x16x32_bf16 v[208:211], a[232:235], v[104:107], v[208:211]
    v_exp_f32 v214, v214
    v_mfma_f32_16x16x32_bf16 v[208:211], a[236:239], v[108:111], v[208:211]
    v_exp_f32 v215, v215
    v_mfma_f32_16x16x32_bf16 a[48:51], a[184:187], v[128:131], a[48:51]
    ds_read_b64_tr_b16 a[164:165], v24 offset:40960
    v_cvt_pk_bf16_f32 v170, v212, v213
    v_mfma_f32_16x16x32_bf16 a[48:51], a[188:191], v[132:135], a[48:51]
    ds_read_b64_tr_b16 a[166:167], v24 offset:45056
    v_mfma_f32_16x16x32_bf16 a[52:55], a[188:191], v[140:143], a[52:55]
    ds_read_b128 a[220:223], v11 offset:57344
    v_cvt_pk_bf16_f32 v171, v214, v215
    v_mfma_f32_16x16x32_bf16 a[52:55], a[184:187], v[136:139], a[52:55]
    v_smfmac_f32_16x16x64_bf16 a[200:203], v[52:55], v[144:151], v50
    v_mfma_f32_16x16x32_bf16 v[212:215], a[224:227], v[112:115], v[204:207]
    v_exp_f32 v208, v208
    v_mfma_f32_16x16x32_bf16 v[212:215], a[228:231], v[116:119], v[212:215]
    v_exp_f32 v209, v209
    v_mfma_f32_16x16x32_bf16 v[212:215], a[232:235], v[120:123], v[212:215]
    v_exp_f32 v210, v210
    v_mfma_f32_16x16x32_bf16 v[212:215], a[236:239], v[124:127], v[212:215]
    v_exp_f32 v211, v211
    v_mfma_f32_16x16x32_bf16 a[56:59], a[184:187], v[144:147], a[56:59]
    ds_read_b64_tr_b16 a[168:169], v25 offset:32768
    v_cvt_pk_bf16_f32 v178, v208, v209
    v_mfma_f32_16x16x32_bf16 a[56:59], a[188:191], v[148:151], a[56:59]
    ds_read_b64_tr_b16 a[170:171], v25 offset:36864
    v_mfma_f32_16x16x32_bf16 a[60:63], a[188:191], v[156:159], a[60:63]
    ds_read_b128 a[224:227], v8 offset:61440
    v_cvt_pk_bf16_f32 v179, v210, v211
    v_mfma_f32_16x16x32_bf16 a[60:63], a[184:187], v[152:155], a[60:63]
    s_waitcnt lgkmcnt(3)
    buffer_load_dwordx4 v40, s[12:15], s41 offen offset:2048 lds
    v_mfma_f32_16x16x32_bf16 v[208:211], a[208:211], v[64:67], v[192:195]
    v_exp_f32 v212, v212
    v_mfma_f32_16x16x32_bf16 v[208:211], a[212:215], v[68:71], v[208:211]
    v_exp_f32 v213, v213
    v_mfma_f32_16x16x32_bf16 v[208:211], a[216:219], v[72:75], v[208:211]
    v_exp_f32 v214, v214
    v_mfma_f32_16x16x32_bf16 v[208:211], a[220:223], v[76:79], v[208:211]
    v_exp_f32 v215, v215
    v_mfma_f32_16x16x32_bf16 a[64:67], a[160:163], v[128:131], a[64:67]
    ds_read_b64_tr_b16 a[172:173], v25 offset:40960
    v_cvt_pk_bf16_f32 v186, v212, v213
    v_mfma_f32_16x16x32_bf16 a[64:67], a[164:167], v[132:135], a[64:67]
    ds_read_b64_tr_b16 a[174:175], v25 offset:45056
    v_mfma_f32_16x16x32_bf16 a[68:71], a[164:167], v[140:143], a[68:71]
    ds_read_b128 a[228:231], v9 offset:61440
    v_cvt_pk_bf16_f32 v187, v214, v215
    v_mfma_f32_16x16x32_bf16 a[68:71], a[160:163], v[136:139], a[68:71]
    v_smfmac_f32_16x16x64_bf16 a[204:207], v[52:55], v[152:159], v50
    v_mfma_f32_16x16x32_bf16 v[212:215], a[208:211], v[80:83], v[196:199]
    v_exp_f32 v208, v208
    v_mfma_f32_16x16x32_bf16 v[212:215], a[212:215], v[84:87], v[212:215]
    v_exp_f32 v209, v209
    v_mfma_f32_16x16x32_bf16 v[212:215], a[216:219], v[88:91], v[212:215]
    v_exp_f32 v210, v210
    v_mfma_f32_16x16x32_bf16 v[212:215], a[220:223], v[92:95], v[212:215]
    v_exp_f32 v211, v211
    v_mfma_f32_16x16x32_bf16 a[72:75], a[160:163], v[144:147], a[72:75]
    ds_read_b64_tr_b16 a[176:177], v26 offset:32768
    v_cvt_pk_bf16_f32 v164, v208, v209
    v_mfma_f32_16x16x32_bf16 a[72:75], a[164:167], v[148:151], a[72:75]
    ds_read_b64_tr_b16 a[178:179], v26 offset:36864
    v_mfma_f32_16x16x32_bf16 a[76:79], a[164:167], v[156:159], a[76:79]
    ds_read_b128 a[232:235], v10 offset:61440
    v_cvt_pk_bf16_f32 v165, v210, v211
    v_mfma_f32_16x16x32_bf16 a[76:79], a[160:163], v[152:155], a[76:79]
    s_waitcnt lgkmcnt(3)
    buffer_load_dwordx4 v41, s[12:15], s41 offen offset:3072 lds
    v_mfma_f32_16x16x32_bf16 v[208:211], a[208:211], v[96:99], v[200:203]
    v_exp_f32 v212, v212
    v_mfma_f32_16x16x32_bf16 v[208:211], a[212:215], v[100:103], v[208:211]
    s_add_u32 s41, s41, 16384
    v_exp_f32 v213, v213
    v_mfma_f32_16x16x32_bf16 v[208:211], a[216:219], v[104:107], v[208:211]
    v_exp_f32 v214, v214
    v_mfma_f32_16x16x32_bf16 v[208:211], a[220:223], v[108:111], v[208:211]
    v_exp_f32 v215, v215
    v_mfma_f32_16x16x32_bf16 a[80:83], a[168:171], v[128:131], a[80:83]
    ds_read_b64_tr_b16 a[180:181], v26 offset:40960
    v_cvt_pk_bf16_f32 v172, v212, v213
    v_mfma_f32_16x16x32_bf16 a[80:83], a[172:175], v[132:135], a[80:83]
    ds_read_b64_tr_b16 a[182:183], v26 offset:45056
    v_mfma_f32_16x16x32_bf16 a[84:87], a[172:175], v[140:143], a[84:87]
    ds_read_b128 a[236:239], v11 offset:61440
    v_cvt_pk_bf16_f32 v173, v214, v215
    v_mfma_f32_16x16x32_bf16 a[84:87], a[168:171], v[136:139], a[84:87]
    s_waitcnt vmcnt(10)
    s_barrier
    v_mfma_f32_16x16x32_bf16 v[212:215], a[208:211], v[112:115], v[204:207]
    v_exp_f32 v208, v208
    v_mfma_f32_16x16x32_bf16 v[212:215], a[212:215], v[116:119], v[212:215]
    s_add_u32 m0, s42, 32768
    v_exp_f32 v209, v209
    v_mfma_f32_16x16x32_bf16 v[212:215], a[216:219], v[120:123], v[212:215]
    v_exp_f32 v210, v210
    v_mfma_f32_16x16x32_bf16 v[212:215], a[220:223], v[124:127], v[212:215]
    v_exp_f32 v211, v211
    v_mfma_f32_16x16x32_bf16 a[88:91], a[168:171], v[144:147], a[88:91]
    ds_read_b64_tr_b16 a[184:185], v27 offset:32768
    v_cvt_pk_bf16_f32 v180, v208, v209
    v_mfma_f32_16x16x32_bf16 a[88:91], a[172:175], v[148:151], a[88:91]
    ds_read_b64_tr_b16 a[186:187], v27 offset:36864
    v_mfma_f32_16x16x32_bf16 a[92:95], a[172:175], v[156:159], a[92:95]
    ds_read_b128 a[208:211], v8 offset:0
    v_cvt_pk_bf16_f32 v181, v210, v211
    v_mfma_f32_16x16x32_bf16 a[92:95], a[168:171], v[152:155], a[92:95]
    s_waitcnt lgkmcnt(3)
    buffer_load_dwordx4 v36, s[8:11], s40 offen lds
    v_mfma_f32_16x16x32_bf16 v[208:211], a[224:227], v[64:67], v[192:195]
    v_exp_f32 v212, v212
    v_mfma_f32_16x16x32_bf16 v[208:211], a[228:231], v[68:71], v[208:211]
    v_exp_f32 v213, v213
    v_mfma_f32_16x16x32_bf16 v[208:211], a[232:235], v[72:75], v[208:211]
    v_exp_f32 v214, v214
    v_mfma_f32_16x16x32_bf16 v[208:211], a[236:239], v[76:79], v[208:211]
    v_exp_f32 v215, v215
    v_mfma_f32_16x16x32_bf16 a[96:99], a[176:179], v[128:131], a[96:99]
    ds_read_b64_tr_b16 a[188:189], v27 offset:40960
    v_cvt_pk_bf16_f32 v188, v212, v213
    v_mfma_f32_16x16x32_bf16 a[96:99], a[180:183], v[132:135], a[96:99]
    ds_read_b64_tr_b16 a[190:191], v27 offset:45056
    v_mfma_f32_16x16x32_bf16 a[100:103], a[180:183], v[140:143], a[100:103]
    ds_read_b128 a[212:215], v9 offset:0
    v_cvt_pk_bf16_f32 v189, v214, v215
    v_mfma_f32_16x16x32_bf16 a[100:103], a[176:179], v[136:139], a[100:103]
    buffer_load_dword v219, v62, s[84:87], s38 offen
    v_mfma_f32_16x16x32_bf16 v[212:215], a[224:227], v[80:83], v[196:199]
    v_exp_f32 v208, v208
    v_mfma_f32_16x16x32_bf16 v[212:215], a[228:231], v[84:87], v[212:215]
    v_exp_f32 v209, v209
    v_mfma_f32_16x16x32_bf16 v[212:215], a[232:235], v[88:91], v[212:215]
    v_exp_f32 v210, v210
    v_mfma_f32_16x16x32_bf16 v[212:215], a[236:239], v[92:95], v[212:215]
    v_exp_f32 v211, v211
    v_mfma_f32_16x16x32_bf16 a[104:107], a[176:179], v[144:147], a[104:107]
    ds_read_b64_tr_b16 a[160:161], v20 offset:49152
    v_cvt_pk_bf16_f32 v166, v208, v209
    v_mfma_f32_16x16x32_bf16 a[104:107], a[180:183], v[148:151], a[104:107]
    ds_read_b64_tr_b16 a[162:163], v20 offset:53248
    v_mfma_f32_16x16x32_bf16 a[108:111], a[180:183], v[156:159], a[108:111]
    ds_read_b128 a[216:219], v10 offset:0
    v_cvt_pk_bf16_f32 v167, v210, v211
    v_mfma_f32_16x16x32_bf16 a[108:111], a[176:179], v[152:155], a[108:111]
    s_waitcnt lgkmcnt(3)
    buffer_load_dwordx4 v37, s[8:11], s40 offen offset:1024 lds
    v_mfma_f32_16x16x32_bf16 v[208:211], a[224:227], v[96:99], v[200:203]
    v_exp_f32 v212, v212
    v_mfma_f32_16x16x32_bf16 v[208:211], a[228:231], v[100:103], v[208:211]
    v_exp_f32 v213, v213
    v_mfma_f32_16x16x32_bf16 v[208:211], a[232:235], v[104:107], v[208:211]
    v_exp_f32 v214, v214
    v_mfma_f32_16x16x32_bf16 v[208:211], a[236:239], v[108:111], v[208:211]
    v_exp_f32 v215, v215
    v_mfma_f32_16x16x32_bf16 a[112:115], a[184:187], v[128:131], a[112:115]
    ds_read_b64_tr_b16 a[164:165], v20 offset:57344
    v_cvt_pk_bf16_f32 v174, v212, v213
    v_mfma_f32_16x16x32_bf16 a[112:115], a[188:191], v[132:135], a[112:115]
    ds_read_b64_tr_b16 a[166:167], v20 offset:61440
    v_mfma_f32_16x16x32_bf16 a[116:119], a[188:191], v[140:143], a[116:119]
    ds_read_b128 a[220:223], v11 offset:0
    v_cvt_pk_bf16_f32 v175, v214, v215
    v_mfma_f32_16x16x32_bf16 a[116:119], a[184:187], v[136:139], a[116:119]
    buffer_load_dword v221, v235, s[20:23], 0 offen
    v_mfma_f32_16x16x32_bf16 v[212:215], a[224:227], v[112:115], v[204:207]
    v_exp_f32 v208, v208
    v_mfma_f32_16x16x32_bf16 v[212:215], a[228:231], v[116:119], v[212:215]
    v_exp_f32 v209, v209
    v_mfma_f32_16x16x32_bf16 v[212:215], a[232:235], v[120:123], v[212:215]
    v_exp_f32 v210, v210
    v_mfma_f32_16x16x32_bf16 v[212:215], a[236:239], v[124:127], v[212:215]
    v_exp_f32 v211, v211
    v_mfma_f32_16x16x32_bf16 a[120:123], a[184:187], v[144:147], a[120:123]
Ltour5:
    s_cbranch_execz Ltour9
    ds_read_b64_tr_b16 a[168:169], v21 offset:49152
    v_cvt_pk_bf16_f32 v182, v208, v209
    v_mfma_f32_16x16x32_bf16 a[120:123], a[188:191], v[148:151], a[120:123]
    ds_read_b64_tr_b16 a[170:171], v21 offset:53248
    v_add_u32 v235, 2560, v235
    v_mfma_f32_16x16x32_bf16 a[124:127], a[188:191], v[156:159], a[124:127]
    ds_read_b128 a[224:227], v8 offset:4096
    v_cvt_pk_bf16_f32 v183, v210, v211
    v_mfma_f32_16x16x32_bf16 a[124:127], a[184:187], v[152:155], a[124:127]
    s_waitcnt lgkmcnt(3)
    buffer_load_dwordx4 v38, s[8:11], s40 offen offset:2048 lds
    v_mfma_f32_16x16x32_bf16 v[208:211], a[208:211], v[64:67], v[192:195]
    v_exp_f32 v212, v212
    v_mfma_f32_16x16x32_bf16 v[208:211], a[212:215], v[68:71], v[208:211]
    v_exp_f32 v213, v213
    v_mfma_f32_16x16x32_bf16 v[208:211], a[216:219], v[72:75], v[208:211]
    v_exp_f32 v214, v214
    v_mfma_f32_16x16x32_bf16 v[208:211], a[220:223], v[76:79], v[208:211]
    v_exp_f32 v215, v215
    v_mfma_f32_16x16x32_bf16 a[0:3], a[160:163], v[160:163], a[0:3]
    ds_read_b64_tr_b16 a[172:173], v21 offset:57344
    v_cvt_pk_bf16_f32 v190, v212, v213
    v_mfma_f32_16x16x32_bf16 a[0:3], a[164:167], v[164:167], a[0:3]
    ds_read_b64_tr_b16 a[174:175], v21 offset:61440
    v_lshlrev_b32 v244, 16, v240
    v_mfma_f32_16x16x32_bf16 a[4:7], a[164:167], v[172:175], a[4:7]
    ds_read_b128 a[228:231], v9 offset:4096
    v_cvt_pk_bf16_f32 v191, v214, v215
    v_mfma_f32_16x16x32_bf16 a[4:7], a[160:163], v[168:171], a[4:7]
    v_and_b32 v245, 0xffff0000, v240
    v_fmac_f32 v224, v2, v244
    v_mfma_f32_16x16x32_bf16 v[212:215], a[208:211], v[80:83], v[196:199]
    v_exp_f32 v208, v208
    v_mfma_f32_16x16x32_bf16 v[212:215], a[212:215], v[84:87], v[212:215]
    v_exp_f32 v209, v209
    v_mfma_f32_16x16x32_bf16 v[212:215], a[216:219], v[88:91], v[212:215]
    v_exp_f32 v210, v210
    v_mfma_f32_16x16x32_bf16 v[212:215], a[220:223], v[92:95], v[212:215]
    v_exp_f32 v211, v211
    v_mfma_f32_16x16x32_bf16 a[8:11], a[160:163], v[176:179], a[8:11]
    ds_read_b64_tr_b16 a[176:177], v22 offset:49152
    v_cvt_pk_bf16_f32 v128, v208, v209
    v_mfma_f32_16x16x32_bf16 a[8:11], a[164:167], v[180:183], a[8:11]
    ds_read_b64_tr_b16 a[178:179], v22 offset:53248
    v_fmac_f32 v225, v2, v245
    v_mfma_f32_16x16x32_bf16 a[12:15], a[164:167], v[188:191], a[12:15]
    ds_read_b128 a[232:235], v10 offset:4096
    v_cvt_pk_bf16_f32 v129, v210, v211
    v_mfma_f32_16x16x32_bf16 a[12:15], a[160:163], v[184:187], a[12:15]
    s_waitcnt lgkmcnt(3)
    buffer_load_dwordx4 v39, s[8:11], s40 offen offset:3072 lds
    v_mfma_f32_16x16x32_bf16 v[208:211], a[208:211], v[96:99], v[200:203]
    v_exp_f32 v212, v212
    v_mfma_f32_16x16x32_bf16 v[208:211], a[212:215], v[100:103], v[208:211]
    s_add_u32 s40, s40, 16384
    v_exp_f32 v213, v213
    v_mfma_f32_16x16x32_bf16 v[208:211], a[216:219], v[104:107], v[208:211]
    v_exp_f32 v214, v214
    v_mfma_f32_16x16x32_bf16 v[208:211], a[220:223], v[108:111], v[208:211]
    v_exp_f32 v215, v215
    v_mfma_f32_16x16x32_bf16 a[16:19], a[168:171], v[160:163], a[16:19]
    ds_read_b64_tr_b16 a[180:181], v22 offset:57344
    v_cvt_pk_bf16_f32 v136, v212, v213
    v_mfma_f32_16x16x32_bf16 a[16:19], a[172:175], v[164:167], a[16:19]
    ds_read_b64_tr_b16 a[182:183], v22 offset:61440
    v_lshlrev_b32 v246, 16, v241
    v_mfma_f32_16x16x32_bf16 a[20:23], a[172:175], v[172:175], a[20:23]
    ds_read_b128 a[236:239], v11 offset:4096
    v_cvt_pk_bf16_f32 v137, v214, v215
    v_mfma_f32_16x16x32_bf16 a[20:23], a[168:171], v[168:171], a[20:23]
    v_and_b32 v247, 0xffff0000, v241
    v_fmac_f32 v226, v2, v246
    v_smfmac_f32_16x16x64_bf16 a[192:195], v[52:55], v[160:167], v50
    v_mfma_f32_16x16x32_bf16 v[212:215], a[208:211], v[112:115], v[204:207]
    v_exp_f32 v208, v208
    v_mfma_f32_16x16x32_bf16 v[212:215], a[212:215], v[116:119], v[212:215]
    s_add_u32 m0, s42, 81920
    v_exp_f32 v209, v209
    v_mfma_f32_16x16x32_bf16 v[212:215], a[216:219], v[120:123], v[212:215]
    v_exp_f32 v210, v210
    v_mfma_f32_16x16x32_bf16 v[212:215], a[220:223], v[124:127], v[212:215]
    v_exp_f32 v211, v211
    v_mfma_f32_16x16x32_bf16 a[24:27], a[168:171], v[176:179], a[24:27]
    ds_read_b64_tr_b16 a[184:185], v23 offset:49152
    v_cvt_pk_bf16_f32 v144, v208, v209
    v_mfma_f32_16x16x32_bf16 a[24:27], a[172:175], v[180:183], a[24:27]
    ds_read_b64_tr_b16 a[186:187], v23 offset:53248
    v_fmac_f32 v227, v2, v247
    v_mfma_f32_16x16x32_bf16 a[28:31], a[172:175], v[188:191], a[28:31]
    ds_read_b128 a[208:211], v8 offset:8192
    v_cvt_pk_bf16_f32 v145, v210, v211
    v_mfma_f32_16x16x32_bf16 a[28:31], a[168:171], v[184:187], a[28:31]
    s_waitcnt lgkmcnt(3)
    buffer_load_dwordx4 v40, s[12:15], s41 offen lds
    v_mfma_f32_16x16x32_bf16 v[208:211], a[224:227], v[64:67], v[192:195]
    v_exp_f32 v212, v212
    v_mfma_f32_16x16x32_bf16 v[208:211], a[228:231], v[68:71], v[208:211]
    v_exp_f32 v213, v213
    v_mfma_f32_16x16x32_bf16 v[208:211], a[232:235], v[72:75], v[208:211]
    v_exp_f32 v214, v214
    v_mfma_f32_16x16x32_bf16 v[208:211], a[236:239], v[76:79], v[208:211]
    v_exp_f32 v215, v215
    v_mfma_f32_16x16x32_bf16 a[32:35], a[176:179], v[160:163], a[32:35]
    ds_read_b64_tr_b16 a[188:189], v23 offset:57344
    v_cvt_pk_bf16_f32 v152, v212, v213
    v_mfma_f32_16x16x32_bf16 a[32:35], a[180:183], v[164:167], a[32:35]
    ds_read_b64_tr_b16 a[190:191], v23 offset:61440
    v_lshlrev_b32 v244, 16, v242
    v_mfma_f32_16x16x32_bf16 a[36:39], a[180:183], v[172:175], a[36:39]
    ds_read_b128 a[212:215], v9 offset:8192
    v_cvt_pk_bf16_f32 v153, v214, v215
    v_mfma_f32_16x16x32_bf16 a[36:39], a[176:179], v[168:171], a[36:39]
    v_and_b32 v245, 0xffff0000, v242
    v_fmac_f32 v228, v2, v244
    v_smfmac_f32_16x16x64_bf16 a[196:199], v[52:55], v[168:175], v50
    v_mfma_f32_16x16x32_bf16 v[212:215], a[224:227], v[80:83], v[196:199]
    v_exp_f32 v208, v208
    v_mfma_f32_16x16x32_bf16 v[212:215], a[228:231], v[84:87], v[212:215]
    v_exp_f32 v209, v209
    v_mfma_f32_16x16x32_bf16 v[212:215], a[232:235], v[88:91], v[212:215]
    v_exp_f32 v210, v210
    v_mfma_f32_16x16x32_bf16 v[212:215], a[236:239], v[92:95], v[212:215]
    v_exp_f32 v211, v211
    v_mfma_f32_16x16x32_bf16 a[40:43], a[176:179], v[176:179], a[40:43]
    ds_read_b64_tr_b16 a[160:161], v24 offset:49152
    v_cvt_pk_bf16_f32 v130, v208, v209
    v_mfma_f32_16x16x32_bf16 a[40:43], a[180:183], v[180:183], a[40:43]
    ds_read_b64_tr_b16 a[162:163], v24 offset:53248
    v_fmac_f32 v229, v2, v245
    v_mfma_f32_16x16x32_bf16 a[44:47], a[180:183], v[188:191], a[44:47]
    ds_read_b128 a[216:219], v10 offset:8192
    v_cvt_pk_bf16_f32 v131, v210, v211
    v_mfma_f32_16x16x32_bf16 a[44:47], a[176:179], v[184:187], a[44:47]
    s_waitcnt lgkmcnt(3)
    buffer_load_dwordx4 v41, s[12:15], s41 offen offset:1024 lds
    v_mfma_f32_16x16x32_bf16 v[208:211], a[224:227], v[96:99], v[200:203]
    v_exp_f32 v212, v212
    v_mfma_f32_16x16x32_bf16 v[208:211], a[228:231], v[100:103], v[208:211]
    v_exp_f32 v213, v213
    v_mfma_f32_16x16x32_bf16 v[208:211], a[232:235], v[104:107], v[208:211]
    v_exp_f32 v214, v214
    v_mfma_f32_16x16x32_bf16 v[208:211], a[236:239], v[108:111], v[208:211]
    v_exp_f32 v215, v215
    v_mfma_f32_16x16x32_bf16 a[48:51], a[184:187], v[160:163], a[48:51]
    ds_read_b64_tr_b16 a[164:165], v24 offset:57344
    v_cvt_pk_bf16_f32 v138, v212, v213
    v_mfma_f32_16x16x32_bf16 a[48:51], a[188:191], v[164:167], a[48:51]
    ds_read_b64_tr_b16 a[166:167], v24 offset:61440
    v_lshlrev_b32 v246, 16, v243
    v_mfma_f32_16x16x32_bf16 a[52:55], a[188:191], v[172:175], a[52:55]
    ds_read_b128 a[220:223], v11 offset:8192
    v_cvt_pk_bf16_f32 v139, v214, v215
    v_mfma_f32_16x16x32_bf16 a[52:55], a[184:187], v[168:171], a[52:55]
    v_and_b32 v247, 0xffff0000, v243
    v_fmac_f32 v230, v2, v246
    v_smfmac_f32_16x16x64_bf16 a[200:203], v[52:55], v[176:183], v50
    v_mfma_f32_16x16x32_bf16 v[212:215], a[224:227], v[112:115], v[204:207]
    v_exp_f32 v208, v208
    v_mfma_f32_16x16x32_bf16 v[212:215], a[228:231], v[116:119], v[212:215]
    v_exp_f32 v209, v209
    v_mfma_f32_16x16x32_bf16 v[212:215], a[232:235], v[120:123], v[212:215]
    v_exp_f32 v210, v210
    v_mfma_f32_16x16x32_bf16 v[212:215], a[236:239], v[124:127], v[212:215]
    v_exp_f32 v211, v211
    v_mfma_f32_16x16x32_bf16 a[56:59], a[184:187], v[176:179], a[56:59]
    ds_read_b64_tr_b16 a[168:169], v25 offset:49152
    v_cvt_pk_bf16_f32 v146, v208, v209
    v_mfma_f32_16x16x32_bf16 a[56:59], a[188:191], v[180:183], a[56:59]
    ds_read_b64_tr_b16 a[170:171], v25 offset:53248
    v_fmac_f32 v231, v2, v247
    v_mfma_f32_16x16x32_bf16 a[60:63], a[188:191], v[188:191], a[60:63]
    ds_read_b128 a[224:227], v8 offset:12288
    v_cvt_pk_bf16_f32 v147, v210, v211
    v_mfma_f32_16x16x32_bf16 a[60:63], a[184:187], v[184:187], a[60:63]
    s_waitcnt lgkmcnt(3)
    buffer_load_dwordx4 v40, s[12:15], s41 offen offset:2048 lds
    v_mfma_f32_16x16x32_bf16 v[208:211], a[208:211], v[64:67], v[192:195]
    v_exp_f32 v212, v212
    v_mfma_f32_16x16x32_bf16 v[208:211], a[212:215], v[68:71], v[208:211]
    v_exp_f32 v213, v213
    v_mfma_f32_16x16x32_bf16 v[208:211], a[216:219], v[72:75], v[208:211]
    v_exp_f32 v214, v214
    v_mfma_f32_16x16x32_bf16 v[208:211], a[220:223], v[76:79], v[208:211]
    v_exp_f32 v215, v215
    v_mfma_f32_16x16x32_bf16 a[64:67], a[160:163], v[160:163], a[64:67]
    ds_read_b64_tr_b16 a[172:173], v25 offset:57344
    v_cvt_pk_bf16_f32 v154, v212, v213
    v_mfma_f32_16x16x32_bf16 a[64:67], a[164:167], v[164:167], a[64:67]
    ds_read_b64_tr_b16 a[174:175], v25 offset:61440
    v_mov_b32 v2, v3
    v_mfma_f32_16x16x32_bf16 a[68:71], a[164:167], v[172:175], a[68:71]
    ds_read_b128 a[228:231], v9 offset:12288
    v_cvt_pk_bf16_f32 v155, v214, v215
    v_mfma_f32_16x16x32_bf16 a[68:71], a[160:163], v[168:171], a[68:71]
    v_mov_b32 v3, v4
    v_mov_b32 v4, v5
    v_smfmac_f32_16x16x64_bf16 a[204:207], v[52:55], v[184:191], v50
    v_mfma_f32_16x16x32_bf16 v[212:215], a[208:211], v[80:83], v[196:199]
    v_exp_f32 v208, v208
    v_mfma_f32_16x16x32_bf16 v[212:215], a[212:215], v[84:87], v[212:215]
    v_exp_f32 v209, v209
    v_mfma_f32_16x16x32_bf16 v[212:215], a[216:219], v[88:91], v[212:215]
    v_exp_f32 v210, v210
    v_mfma_f32_16x16x32_bf16 v[212:215], a[220:223], v[92:95], v[212:215]
    v_exp_f32 v211, v211
    v_mfma_f32_16x16x32_bf16 a[72:75], a[160:163], v[176:179], a[72:75]
    ds_read_b64_tr_b16 a[176:177], v26 offset:49152
    v_cvt_pk_bf16_f32 v132, v208, v209
    v_mfma_f32_16x16x32_bf16 a[72:75], a[164:167], v[180:183], a[72:75]
    ds_read_b64_tr_b16 a[178:179], v26 offset:53248
    v_mov_b32 v5, v6
    v_mfma_f32_16x16x32_bf16 a[76:79], a[164:167], v[188:191], a[76:79]
    ds_read_b128 a[232:235], v10 offset:12288
    v_cvt_pk_bf16_f32 v133, v210, v211
    v_mfma_f32_16x16x32_bf16 a[76:79], a[160:163], v[184:187], a[76:79]
    s_waitcnt lgkmcnt(3)
    buffer_load_dwordx4 v41, s[12:15], s41 offen offset:3072 lds
    v_mfma_f32_16x16x32_bf16 v[208:211], a[208:211], v[96:99], v[200:203]
    v_exp_f32 v212, v212
    v_mfma_f32_16x16x32_bf16 v[208:211], a[212:215], v[100:103], v[208:211]
    s_add_u32 s41, s41, 16384
    v_exp_f32 v213, v213
    v_mfma_f32_16x16x32_bf16 v[208:211], a[216:219], v[104:107], v[208:211]
    v_exp_f32 v214, v214
    v_mfma_f32_16x16x32_bf16 v[208:211], a[220:223], v[108:111], v[208:211]
    v_exp_f32 v215, v215
    v_mfma_f32_16x16x32_bf16 a[80:83], a[168:171], v[160:163], a[80:83]
    ds_read_b64_tr_b16 a[180:181], v26 offset:57344
    v_cvt_pk_bf16_f32 v140, v212, v213
    v_mfma_f32_16x16x32_bf16 a[80:83], a[172:175], v[164:167], a[80:83]
    ds_read_b64_tr_b16 a[182:183], v26 offset:61440
    v_mfma_f32_16x16x32_bf16 a[84:87], a[172:175], v[172:175], a[84:87]
    ds_read_b128 a[236:239], v11 offset:12288
    v_cvt_pk_bf16_f32 v141, v214, v215
    v_mfma_f32_16x16x32_bf16 a[84:87], a[168:171], v[168:171], a[84:87]
    s_waitcnt vmcnt(10)
    s_barrier
    v_mfma_f32_16x16x32_bf16 v[212:215], a[208:211], v[112:115], v[204:207]
    v_exp_f32 v208, v208
    v_mfma_f32_16x16x32_bf16 v[212:215], a[212:215], v[116:119], v[212:215]
    s_add_u32 m0, s42, 49152
    v_exp_f32 v209, v209
    v_mfma_f32_16x16x32_bf16 v[212:215], a[216:219], v[120:123], v[212:215]
    v_exp_f32 v210, v210
    v_mfma_f32_16x16x32_bf16 v[212:215], a[220:223], v[124:127], v[212:215]
    v_exp_f32 v211, v211
    v_mfma_f32_16x16x32_bf16 a[88:91], a[168:171], v[176:179], a[88:91]
    ds_read_b64_tr_b16 a[184:185], v27 offset:49152
    v_cvt_pk_bf16_f32 v148, v208, v209
    v_mfma_f32_16x16x32_bf16 a[88:91], a[172:175], v[180:183], a[88:91]
    ds_read_b64_tr_b16 a[186:187], v27 offset:53248
    v_mfma_f32_16x16x32_bf16 a[92:95], a[172:175], v[188:191], a[92:95]
    ds_read_b128 a[208:211], v8 offset:16384
    v_cvt_pk_bf16_f32 v149, v210, v211
    v_mfma_f32_16x16x32_bf16 a[92:95], a[168:171], v[184:187], a[92:95]
    s_waitcnt lgkmcnt(3)
    buffer_load_dwordx4 v36, s[8:11], s40 offen lds
    v_mfma_f32_16x16x32_bf16 v[208:211], a[224:227], v[64:67], v[192:195]
    v_exp_f32 v212, v212
    v_mfma_f32_16x16x32_bf16 v[208:211], a[228:231], v[68:71], v[208:211]
    v_exp_f32 v213, v213
    v_mfma_f32_16x16x32_bf16 v[208:211], a[232:235], v[72:75], v[208:211]
    v_exp_f32 v214, v214
    v_mfma_f32_16x16x32_bf16 v[208:211], a[236:239], v[76:79], v[208:211]
    v_exp_f32 v215, v215
    v_mfma_f32_16x16x32_bf16 a[96:99], a[176:179], v[160:163], a[96:99]
    ds_read_b64_tr_b16 a[188:189], v27 offset:57344
    v_cvt_pk_bf16_f32 v156, v212, v213
    v_mfma_f32_16x16x32_bf16 a[96:99], a[180:183], v[164:167], a[96:99]
    ds_read_b64_tr_b16 a[190:191], v27 offset:61440
    v_mfma_f32_16x16x32_bf16 a[100:103], a[180:183], v[172:175], a[100:103]
    ds_read_b128 a[212:215], v9 offset:16384
    v_cvt_pk_bf16_f32 v157, v214, v215
    v_mfma_f32_16x16x32_bf16 a[100:103], a[176:179], v[168:171], a[100:103]
    buffer_load_dword v216, v237, s[28:31], s52 offen
    v_mfma_f32_16x16x32_bf16 v[212:215], a[224:227], v[80:83], v[196:199]
    v_exp_f32 v208, v208
    v_mfma_f32_16x16x32_bf16 v[212:215], a[228:231], v[84:87], v[212:215]
    s_sub_u32 s39, s39, 36864
    v_exp_f32 v209, v209
    v_mfma_f32_16x16x32_bf16 v[212:215], a[232:235], v[88:91], v[212:215]
    s_sub_u32 s38, s38, 4608
    v_exp_f32 v210, v210
    v_mfma_f32_16x16x32_bf16 v[212:215], a[236:239], v[92:95], v[212:215]
    s_add_u32 s52, s52, 2304
    v_exp_f32 v211, v211
    v_mfma_f32_16x16x32_bf16 a[104:107], a[176:179], v[176:179], a[104:107]
    ds_read_b64_tr_b16 a[160:161], v20 offset:0
    v_cvt_pk_bf16_f32 v134, v208, v209
    v_mfma_f32_16x16x32_bf16 a[104:107], a[180:183], v[180:183], a[104:107]
    ds_read_b64_tr_b16 a[162:163], v20 offset:4096
    v_mfma_f32_16x16x32_bf16 a[108:111], a[180:183], v[188:191], a[108:111]
    ds_read_b128 a[216:219], v10 offset:16384
    v_cvt_pk_bf16_f32 v135, v210, v211
    v_mfma_f32_16x16x32_bf16 a[108:111], a[176:179], v[184:187], a[108:111]
    s_waitcnt lgkmcnt(3)
    buffer_load_dwordx4 v37, s[8:11], s40 offen offset:1024 lds
    v_mfma_f32_16x16x32_bf16 v[208:211], a[224:227], v[96:99], v[200:203]
    v_exp_f32 v212, v212
    v_mfma_f32_16x16x32_bf16 v[208:211], a[228:231], v[100:103], v[208:211]
    v_exp_f32 v213, v213
    v_mfma_f32_16x16x32_bf16 v[208:211], a[232:235], v[104:107], v[208:211]
    v_exp_f32 v214, v214
    v_mfma_f32_16x16x32_bf16 v[208:211], a[236:239], v[108:111], v[208:211]
    v_exp_f32 v215, v215
    v_mfma_f32_16x16x32_bf16 a[112:115], a[184:187], v[160:163], a[112:115]
    ds_read_b64_tr_b16 a[164:165], v20 offset:8192
    v_cvt_pk_bf16_f32 v142, v212, v213
    v_mfma_f32_16x16x32_bf16 a[112:115], a[188:191], v[164:167], a[112:115]
    ds_read_b64_tr_b16 a[166:167], v20 offset:12288
    v_mfma_f32_16x16x32_bf16 a[116:119], a[188:191], v[172:175], a[116:119]
    ds_read_b128 a[220:223], v11 offset:16384
    v_cvt_pk_bf16_f32 v143, v214, v215
    v_mfma_f32_16x16x32_bf16 a[116:119], a[184:187], v[168:171], a[116:119]
    v_mfma_f32_16x16x32_bf16 v[212:215], a[224:227], v[112:115], v[204:207]
    v_exp_f32 v208, v208
    v_mfma_f32_16x16x32_bf16 v[212:215], a[228:231], v[116:119], v[212:215]
    v_exp_f32 v209, v209
    v_mfma_f32_16x16x32_bf16 v[212:215], a[232:235], v[120:123], v[212:215]
    v_exp_f32 v210, v210
    v_mfma_f32_16x16x32_bf16 v[212:215], a[236:239], v[124:127], v[212:215]
    v_exp_f32 v211, v211
    v_mfma_f32_16x16x32_bf16 a[120:123], a[184:187], v[176:179], a[120:123]
    ds_read_b64_tr_b16 a[168:169], v21 offset:0
    v_cvt_pk_bf16_f32 v150, v208, v209
    v_mfma_f32_16x16x32_bf16 a[120:123], a[188:191], v[180:183], a[120:123]
    ds_read_b64_tr_b16 a[170:171], v21 offset:4096
    v_mfma_f32_16x16x32_bf16 a[124:127], a[188:191], v[188:191], a[124:127]
    ds_read_b128 a[224:227], v8 offset:20480
    v_cvt_pk_bf16_f32 v151, v210, v211
    v_mfma_f32_16x16x32_bf16 a[124:127], a[184:187], v[184:187], a[124:127]
    s_waitcnt lgkmcnt(3)
    buffer_load_dwordx4 v38, s[8:11], s40 offen offset:2048 lds
    s_sub_u32 s43, s43, 1
    s_cmp_lg_u32 s43, 0
    s_cbranch_scc1 Lattn_loop
    v_mfma_f32_16x16x32_bf16 v[208:211], a[208:211], v[64:67], v[192:195]
    s_lshl_b32 s38, s3, 6
    v_exp_f32 v212, v212
    v_mfma_f32_16x16x32_bf16 v[208:211], a[212:215], v[68:71], v[208:211]
    s_add_u32 s38, s38, 131136
    v_exp_f32 v213, v213
    v_mfma_f32_16x16x32_bf16 v[208:211], a[216:219], v[72:75], v[208:211]
    v_exp_f32 v214, v214
    v_mfma_f32_16x16x32_bf16 v[208:211], a[220:223], v[76:79], v[208:211]
    s_add_u32 s57, s58, 0
    v_exp_f32 v215, v215
    v_mfma_f32_16x16x32_bf16 a[0:3], a[160:163], v[128:131], a[0:3]
    ds_read_b64_tr_b16 a[172:173], v21 offset:8192
    v_cvt_pk_bf16_f32 v158, v212, v213
    v_mfma_f32_16x16x32_bf16 a[0:3], a[164:167], v[132:135], a[0:3]
    ds_read_b64_tr_b16 a[174:175], v21 offset:12288
    v_permlane32_swap_b32 v224, v228
    v_mfma_f32_16x16x32_bf16 a[4:7], a[164:167], v[140:143], a[4:7]
    ds_read_b128 a[228:231], v9 offset:20480
    v_cvt_pk_bf16_f32 v159, v214, v215
    v_mfma_f32_16x16x32_bf16 a[4:7], a[160:163], v[136:139], a[4:7]
    buffer_load_dwordx4 a[128:131], v254, s[80:83], s57 offen
    v_mfma_f32_16x16x32_bf16 v[212:215], a[208:211], v[80:83], v[196:199]
    v_exp_f32 v208, v208
    v_mfma_f32_16x16x32_bf16 v[212:215], a[212:215], v[84:87], v[212:215]
    v_exp_f32 v209, v209
    v_mfma_f32_16x16x32_bf16 v[212:215], a[216:219], v[88:91], v[212:215]
    v_exp_f32 v210, v210
    v_mfma_f32_16x16x32_bf16 v[212:215], a[220:223], v[92:95], v[212:215]
    v_exp_f32 v211, v211
    v_mfma_f32_16x16x32_bf16 a[8:11], a[160:163], v[144:147], a[8:11]
    ds_read_b64_tr_b16 a[176:177], v22 offset:0
    v_cvt_pk_bf16_f32 v160, v208, v209
    v_mfma_f32_16x16x32_bf16 a[8:11], a[164:167], v[148:151], a[8:11]
    ds_read_b64_tr_b16 a[178:179], v22 offset:4096
    v_permlane32_swap_b32 v225, v229
    v_mfma_f32_16x16x32_bf16 a[12:15], a[164:167], v[156:159], a[12:15]
    ds_read_b128 a[232:235], v10 offset:20480
    v_cvt_pk_bf16_f32 v161, v210, v211
    v_mfma_f32_16x16x32_bf16 a[12:15], a[160:163], v[152:155], a[12:15]
    s_waitcnt lgkmcnt(3)
    buffer_load_dwordx4 v39, s[8:11], s40 offen offset:3072 lds
    v_mfma_f32_16x16x32_bf16 v[208:211], a[208:211], v[96:99], v[200:203]
    v_exp_f32 v212, v212
    v_mfma_f32_16x16x32_bf16 v[208:211], a[212:215], v[100:103], v[208:211]
    s_add_u32 s40, s40, 16384
    v_exp_f32 v213, v213
    v_mfma_f32_16x16x32_bf16 v[208:211], a[216:219], v[104:107], v[208:211]
    v_exp_f32 v214, v214
    v_mfma_f32_16x16x32_bf16 v[208:211], a[220:223], v[108:111], v[208:211]
    v_exp_f32 v215, v215
    v_mfma_f32_16x16x32_bf16 a[16:19], a[168:171], v[128:131], a[16:19]
    ds_read_b64_tr_b16 a[180:181], v22 offset:8192
    v_cvt_pk_bf16_f32 v168, v212, v213
    v_mfma_f32_16x16x32_bf16 a[16:19], a[172:175], v[132:135], a[16:19]
    ds_read_b64_tr_b16 a[182:183], v22 offset:12288
    v_permlane32_swap_b32 v226, v230
    v_mfma_f32_16x16x32_bf16 a[20:23], a[172:175], v[140:143], a[20:23]
    ds_read_b128 a[236:239], v11 offset:20480
    v_cvt_pk_bf16_f32 v169, v214, v215
    v_mfma_f32_16x16x32_bf16 a[20:23], a[168:171], v[136:139], a[20:23]
    v_permlane32_swap_b32 v227, v231
    v_add_f32 v224, v224, v228
    v_smfmac_f32_16x16x64_bf16 a[192:195], v[52:55], v[128:135], v50
    v_mfma_f32_16x16x32_bf16 v[212:215], a[208:211], v[112:115], v[204:207]
    v_exp_f32 v208, v208
    v_mfma_f32_16x16x32_bf16 v[212:215], a[212:215], v[116:119], v[212:215]
    s_add_u32 m0, s42, 98304
    v_exp_f32 v209, v209
    v_mfma_f32_16x16x32_bf16 v[212:215], a[216:219], v[120:123], v[212:215]
    v_exp_f32 v210, v210
    v_mfma_f32_16x16x32_bf16 v[212:215], a[220:223], v[124:127], v[212:215]
    v_exp_f32 v211, v211
    v_mfma_f32_16x16x32_bf16 a[24:27], a[168:171], v[144:147], a[24:27]
    ds_read_b64_tr_b16 a[184:185], v23 offset:0
    v_cvt_pk_bf16_f32 v176, v208, v209
    v_mfma_f32_16x16x32_bf16 a[24:27], a[172:175], v[148:151], a[24:27]
    ds_read_b64_tr_b16 a[186:187], v23 offset:4096
    v_add_f32 v225, v225, v229
    v_mfma_f32_16x16x32_bf16 a[28:31], a[172:175], v[156:159], a[28:31]
    ds_read_b128 a[208:211], v8 offset:24576
    v_cvt_pk_bf16_f32 v177, v210, v211
    v_mfma_f32_16x16x32_bf16 a[28:31], a[168:171], v[152:155], a[28:31]
    s_waitcnt lgkmcnt(3)
    buffer_load_dwordx4 v40, s[12:15], s41 offen lds
    v_mfma_f32_16x16x32_bf16 v[208:211], a[224:227], v[64:67], v[192:195]
    v_exp_f32 v212, v212
    v_mfma_f32_16x16x32_bf16 v[208:211], a[228:231], v[68:71], v[208:211]
    v_exp_f32 v213, v213
    v_mfma_f32_16x16x32_bf16 v[208:211], a[232:235], v[72:75], v[208:211]
    v_exp_f32 v214, v214
    v_mfma_f32_16x16x32_bf16 v[208:211], a[236:239], v[76:79], v[208:211]
    s_add_u32 s57, s58, 589824
    v_exp_f32 v215, v215
    v_mfma_f32_16x16x32_bf16 a[32:35], a[176:179], v[128:131], a[32:35]
    ds_read_b64_tr_b16 a[188:189], v23 offset:8192
    v_cvt_pk_bf16_f32 v184, v212, v213
    v_mfma_f32_16x16x32_bf16 a[32:35], a[180:183], v[132:135], a[32:35]
    ds_read_b64_tr_b16 a[190:191], v23 offset:12288
    v_add_f32 v226, v226, v230
    v_mfma_f32_16x16x32_bf16 a[36:39], a[180:183], v[140:143], a[36:39]
    ds_read_b128 a[212:215], v9 offset:24576
    v_cvt_pk_bf16_f32 v185, v214, v215
    v_mfma_f32_16x16x32_bf16 a[36:39], a[176:179], v[136:139], a[36:39]
    buffer_load_dwordx4 a[132:135], v254, s[80:83], s57 offen
    v_smfmac_f32_16x16x64_bf16 a[196:199], v[52:55], v[136:143], v50
    v_mfma_f32_16x16x32_bf16 v[212:215], a[224:227], v[80:83], v[196:199]
    v_exp_f32 v208, v208
    v_mfma_f32_16x16x32_bf16 v[212:215], a[228:231], v[84:87], v[212:215]
    v_exp_f32 v209, v209
    v_mfma_f32_16x16x32_bf16 v[212:215], a[232:235], v[88:91], v[212:215]
    v_exp_f32 v210, v210
    v_mfma_f32_16x16x32_bf16 v[212:215], a[236:239], v[92:95], v[212:215]
    v_exp_f32 v211, v211
    v_mfma_f32_16x16x32_bf16 a[40:43], a[176:179], v[144:147], a[40:43]
    ds_read_b64_tr_b16 a[160:161], v24 offset:0
    v_cvt_pk_bf16_f32 v162, v208, v209
    v_mfma_f32_16x16x32_bf16 a[40:43], a[180:183], v[148:151], a[40:43]
    ds_read_b64_tr_b16 a[162:163], v24 offset:4096
    v_add_f32 v227, v227, v231
    v_mfma_f32_16x16x32_bf16 a[44:47], a[180:183], v[156:159], a[44:47]
    ds_read_b128 a[216:219], v10 offset:24576
    v_cvt_pk_bf16_f32 v163, v210, v211
    v_mfma_f32_16x16x32_bf16 a[44:47], a[176:179], v[152:155], a[44:47]
    s_waitcnt lgkmcnt(3)
    buffer_load_dwordx4 v41, s[12:15], s41 offen offset:1024 lds
    v_mfma_f32_16x16x32_bf16 v[208:211], a[224:227], v[96:99], v[200:203]
    v_exp_f32 v212, v212
    v_mfma_f32_16x16x32_bf16 v[208:211], a[228:231], v[100:103], v[208:211]
    v_exp_f32 v213, v213
    v_mfma_f32_16x16x32_bf16 v[208:211], a[232:235], v[104:107], v[208:211]
    v_exp_f32 v214, v214
    v_mfma_f32_16x16x32_bf16 v[208:211], a[236:239], v[108:111], v[208:211]
    v_exp_f32 v215, v215
    v_mfma_f32_16x16x32_bf16 a[48:51], a[184:187], v[128:131], a[48:51]
    ds_read_b64_tr_b16 a[164:165], v24 offset:8192
    v_cvt_pk_bf16_f32 v170, v212, v213
    v_mfma_f32_16x16x32_bf16 a[48:51], a[188:191], v[132:135], a[48:51]
    ds_read_b64_tr_b16 a[166:167], v24 offset:12288
    v_and_b32 v244, 1, v1
    v_mfma_f32_16x16x32_bf16 a[52:55], a[188:191], v[140:143], a[52:55]
    ds_read_b128 a[220:223], v11 offset:24576
    v_cvt_pk_bf16_f32 v171, v214, v215
    v_mfma_f32_16x16x32_bf16 a[52:55], a[184:187], v[136:139], a[52:55]
    s_waitcnt vmcnt(15)
    buffer_load_dword v221, v236, s[20:23], 0 offen
    v_smfmac_f32_16x16x64_bf16 a[200:203], v[52:55], v[144:151], v50
    v_mfma_f32_16x16x32_bf16 v[212:215], a[224:227], v[112:115], v[204:207]
    v_exp_f32 v208, v208
    v_mfma_f32_16x16x32_bf16 v[212:215], a[228:231], v[116:119], v[212:215]
    v_exp_f32 v209, v209
    v_mfma_f32_16x16x32_bf16 v[212:215], a[232:235], v[120:123], v[212:215]
    v_exp_f32 v210, v210
    v_mfma_f32_16x16x32_bf16 v[212:215], a[236:239], v[124:127], v[212:215]
    v_exp_f32 v211, v211
    v_mfma_f32_16x16x32_bf16 a[56:59], a[184:187], v[144:147], a[56:59]
    ds_read_b64_tr_b16 a[168:169], v25 offset:0
    v_cvt_pk_bf16_f32 v178, v208, v209
    v_mfma_f32_16x16x32_bf16 a[56:59], a[188:191], v[148:151], a[56:59]
    ds_read_b64_tr_b16 a[170:171], v25 offset:4096
    v_permlane16_swap_b32 v224, v226
    v_mfma_f32_16x16x32_bf16 a[60:63], a[188:191], v[156:159], a[60:63]
    ds_read_b128 a[224:227], v8 offset:28672
    v_cvt_pk_bf16_f32 v179, v210, v211
    v_mfma_f32_16x16x32_bf16 a[60:63], a[184:187], v[152:155], a[60:63]
    s_waitcnt lgkmcnt(3)
    buffer_load_dwordx4 v40, s[12:15], s41 offen offset:2048 lds
    v_mfma_f32_16x16x32_bf16 v[208:211], a[208:211], v[64:67], v[192:195]
    v_exp_f32 v212, v212
    v_mfma_f32_16x16x32_bf16 v[208:211], a[212:215], v[68:71], v[208:211]
    v_exp_f32 v213, v213
    v_mfma_f32_16x16x32_bf16 v[208:211], a[216:219], v[72:75], v[208:211]
    v_exp_f32 v214, v214
    v_mfma_f32_16x16x32_bf16 v[208:211], a[220:223], v[76:79], v[208:211]
    s_add_u32 s57, s58, 1179648
    v_exp_f32 v215, v215
    v_mfma_f32_16x16x32_bf16 a[64:67], a[160:163], v[128:131], a[64:67]
    ds_read_b64_tr_b16 a[172:173], v25 offset:8192
    v_cvt_pk_bf16_f32 v186, v212, v213
    v_mfma_f32_16x16x32_bf16 a[64:67], a[164:167], v[132:135], a[64:67]
    ds_read_b64_tr_b16 a[174:175], v25 offset:12288
    v_permlane16_swap_b32 v225, v227
    v_mfma_f32_16x16x32_bf16 a[68:71], a[164:167], v[140:143], a[68:71]
    ds_read_b128 a[228:231], v9 offset:28672
    v_cvt_pk_bf16_f32 v187, v214, v215
    v_mfma_f32_16x16x32_bf16 a[68:71], a[160:163], v[136:139], a[68:71]
    buffer_load_dwordx4 a[136:139], v254, s[80:83], s57 offen
    v_smfmac_f32_16x16x64_bf16 a[204:207], v[52:55], v[152:159], v50
    v_mfma_f32_16x16x32_bf16 v[212:215], a[208:211], v[80:83], v[196:199]
    v_exp_f32 v208, v208
    v_mfma_f32_16x16x32_bf16 v[212:215], a[212:215], v[84:87], v[212:215]
    v_exp_f32 v209, v209
    v_mfma_f32_16x16x32_bf16 v[212:215], a[216:219], v[88:91], v[212:215]
    v_exp_f32 v210, v210
    v_mfma_f32_16x16x32_bf16 v[212:215], a[220:223], v[92:95], v[212:215]
    v_exp_f32 v211, v211
    v_mfma_f32_16x16x32_bf16 a[72:75], a[160:163], v[144:147], a[72:75]
    ds_read_b64_tr_b16 a[176:177], v26 offset:0
    v_cvt_pk_bf16_f32 v164, v208, v209
    v_mfma_f32_16x16x32_bf16 a[72:75], a[164:167], v[148:151], a[72:75]
    ds_read_b64_tr_b16 a[178:179], v26 offset:4096
    v_lshlrev_b32 v244, 5, v244
    v_mfma_f32_16x16x32_bf16 a[76:79], a[164:167], v[156:159], a[76:79]
    ds_read_b128 a[232:235], v10 offset:28672
    v_cvt_pk_bf16_f32 v165, v210, v211
    v_mfma_f32_16x16x32_bf16 a[76:79], a[160:163], v[152:155], a[76:79]
    s_waitcnt lgkmcnt(3)
    buffer_load_dwordx4 v41, s[12:15], s41 offen offset:3072 lds
    v_mfma_f32_16x16x32_bf16 v[208:211], a[208:211], v[96:99], v[200:203]
    v_exp_f32 v212, v212
    v_mfma_f32_16x16x32_bf16 v[208:211], a[212:215], v[100:103], v[208:211]
    s_add_u32 s41, s41, 16384
    v_exp_f32 v213, v213
    v_mfma_f32_16x16x32_bf16 v[208:211], a[216:219], v[104:107], v[208:211]
    v_exp_f32 v214, v214
    v_mfma_f32_16x16x32_bf16 v[208:211], a[220:223], v[108:111], v[208:211]
    v_exp_f32 v215, v215
    v_mfma_f32_16x16x32_bf16 a[80:83], a[168:171], v[128:131], a[80:83]
    ds_read_b64_tr_b16 a[180:181], v26 offset:8192
    v_cvt_pk_bf16_f32 v172, v212, v213
    v_mfma_f32_16x16x32_bf16 a[80:83], a[172:175], v[132:135], a[80:83]
    ds_read_b64_tr_b16 a[182:183], v26 offset:12288
    v_add_f32 v224, v224, v226
    v_mfma_f32_16x16x32_bf16 a[84:87], a[172:175], v[140:143], a[84:87]
    ds_read_b128 a[236:239], v11 offset:28672
    v_cvt_pk_bf16_f32 v173, v214, v215
    v_mfma_f32_16x16x32_bf16 a[84:87], a[168:171], v[136:139], a[84:87]
    s_waitcnt vmcnt(13)
    s_barrier
    v_mfma_f32_16x16x32_bf16 v[212:215], a[208:211], v[112:115], v[204:207]
    v_exp_f32 v208, v208
    v_mfma_f32_16x16x32_bf16 v[212:215], a[212:215], v[116:119], v[212:215]
    s_add_u32 s49, s45, 1024
    v_exp_f32 v209, v209
    v_mfma_f32_16x16x32_bf16 v[212:215], a[216:219], v[120:123], v[212:215]
    s_add_u32 m0, s42, 0
    v_exp_f32 v210, v210
    v_mfma_f32_16x16x32_bf16 v[212:215], a[220:223], v[124:127], v[212:215]
    v_exp_f32 v211, v211
    v_mfma_f32_16x16x32_bf16 a[88:91], a[168:171], v[144:147], a[88:91]
    ds_read_b64_tr_b16 a[184:185], v27 offset:0
    v_cvt_pk_bf16_f32 v180, v208, v209
    v_mfma_f32_16x16x32_bf16 a[88:91], a[172:175], v[148:151], a[88:91]
    ds_read_b64_tr_b16 a[186:187], v27 offset:4096
    v_add_f32 v225, v225, v227
    v_mfma_f32_16x16x32_bf16 a[92:95], a[172:175], v[156:159], a[92:95]
    ds_read_b128 a[208:211], v8 offset:32768
    v_cvt_pk_bf16_f32 v181, v210, v211
    v_mfma_f32_16x16x32_bf16 a[92:95], a[168:171], v[152:155], a[92:95]
    s_waitcnt lgkmcnt(3)
    buffer_load_dwordx4 v46, s[20:23], s49 offen lds
    v_mfma_f32_16x16x32_bf16 v[208:211], a[224:227], v[64:67], v[192:195]
    v_exp_f32 v212, v212
    v_mfma_f32_16x16x32_bf16 v[208:211], a[228:231], v[68:71], v[208:211]
    v_exp_f32 v213, v213
    v_mfma_f32_16x16x32_bf16 v[208:211], a[232:235], v[72:75], v[208:211]
    v_exp_f32 v214, v214
    v_mfma_f32_16x16x32_bf16 v[208:211], a[236:239], v[76:79], v[208:211]
    s_add_u32 s37, s55, 0
    v_exp_f32 v215, v215
    v_mfma_f32_16x16x32_bf16 a[96:99], a[176:179], v[128:131], a[96:99]
Ltour6:
    s_cbranch_execz Ltour10
    ds_read_b64_tr_b16 a[188:189], v27 offset:8192
    v_cvt_pk_bf16_f32 v188, v212, v213
    v_mfma_f32_16x16x32_bf16 a[96:99], a[180:183], v[132:135], a[96:99]
    ds_read_b64_tr_b16 a[190:191], v27 offset:12288
    v_lshrrev_b32 v245, 4, v1
    v_mfma_f32_16x16x32_bf16 a[100:103], a[180:183], v[140:143], a[100:103]
    ds_read_b128 a[212:215], v9 offset:32768
    v_cvt_pk_bf16_f32 v189, v214, v215
    v_mfma_f32_16x16x32_bf16 a[100:103], a[176:179], v[136:139], a[100:103]
    buffer_load_dword v239, v238, s[28:31], s37 offen
    v_mfma_f32_16x16x32_bf16 v[212:215], a[224:227], v[80:83], v[196:199]
    v_exp_f32 v208, v208
    v_mfma_f32_16x16x32_bf16 v[212:215], a[228:231], v[84:87], v[212:215]
    v_exp_f32 v209, v209
    v_mfma_f32_16x16x32_bf16 v[212:215], a[232:235], v[88:91], v[212:215]
    v_exp_f32 v210, v210
    v_mfma_f32_16x16x32_bf16 v[212:215], a[236:239], v[92:95], v[212:215]
    v_exp_f32 v211, v211
    v_mfma_f32_16x16x32_bf16 a[104:107], a[176:179], v[144:147], a[104:107]
    ds_read_b64_tr_b16 a[160:161], v20 offset:16384
    v_cvt_pk_bf16_f32 v166, v208, v209
    v_mfma_f32_16x16x32_bf16 a[104:107], a[180:183], v[148:151], a[104:107]
    ds_read_b64_tr_b16 a[162:163], v20 offset:20480
    v_lshl_add_u32 v244, v245, 3, v244
    v_mfma_f32_16x16x32_bf16 a[108:111], a[180:183], v[156:159], a[108:111]
    ds_read_b128 a[216:219], v10 offset:32768
    v_cvt_pk_bf16_f32 v167, v210, v211
    v_mfma_f32_16x16x32_bf16 a[108:111], a[176:179], v[152:155], a[108:111]
    s_waitcnt lgkmcnt(3)
    buffer_load_dwordx4 v47, s[20:23], s49 offen offset:1024 lds
    v_mfma_f32_16x16x32_bf16 v[208:211], a[224:227], v[96:99], v[200:203]
    v_exp_f32 v212, v212
    v_mfma_f32_16x16x32_bf16 v[208:211], a[228:231], v[100:103], v[208:211]
    v_exp_f32 v213, v213
    v_mfma_f32_16x16x32_bf16 v[208:211], a[232:235], v[104:107], v[208:211]
    v_exp_f32 v214, v214
    v_mfma_f32_16x16x32_bf16 v[208:211], a[236:239], v[108:111], v[208:211]
    s_add_u32 s57, s58, 1769472
    v_exp_f32 v215, v215
    v_mfma_f32_16x16x32_bf16 a[112:115], a[184:187], v[128:131], a[112:115]
    ds_read_b64_tr_b16 a[164:165], v20 offset:24576
    v_cvt_pk_bf16_f32 v174, v212, v213
    v_mfma_f32_16x16x32_bf16 a[112:115], a[188:191], v[132:135], a[112:115]
    ds_read_b64_tr_b16 a[166:167], v20 offset:28672
    v_mfma_f32_16x16x32_bf16 a[116:119], a[188:191], v[140:143], a[116:119]
    ds_read_b128 a[220:223], v11 offset:32768
    v_cvt_pk_bf16_f32 v175, v214, v215
    v_mfma_f32_16x16x32_bf16 a[116:119], a[184:187], v[136:139], a[116:119]
    buffer_load_dwordx4 a[140:143], v254, s[80:83], s57 offen
    v_mfma_f32_16x16x32_bf16 v[212:215], a[224:227], v[112:115], v[204:207]
    v_exp_f32 v208, v208
    v_mfma_f32_16x16x32_bf16 v[212:215], a[228:231], v[116:119], v[212:215]
    v_exp_f32 v209, v209
    v_mfma_f32_16x16x32_bf16 v[212:215], a[232:235], v[120:123], v[212:215]
    v_exp_f32 v210, v210
    v_mfma_f32_16x16x32_bf16 v[212:215], a[236:239], v[124:127], v[212:215]
    v_exp_f32 v211, v211
    v_mfma_f32_16x16x32_bf16 a[120:123], a[184:187], v[144:147], a[120:123]
    ds_read_b64_tr_b16 a[168:169], v21 offset:16384
    v_cvt_pk_bf16_f32 v182, v208, v209
    v_mfma_f32_16x16x32_bf16 a[120:123], a[188:191], v[148:151], a[120:123]
    ds_read_b64_tr_b16 a[170:171], v21 offset:20480
    v_mfma_f32_16x16x32_bf16 a[124:127], a[188:191], v[156:159], a[124:127]
    ds_read_b128 a[224:227], v8 offset:36864
    v_cvt_pk_bf16_f32 v183, v210, v211
    v_mfma_f32_16x16x32_bf16 a[124:127], a[184:187], v[152:155], a[124:127]
    s_waitcnt lgkmcnt(3)
    buffer_load_dwordx4 v48, s[20:23], s49 offen offset:2048 lds
    v_mfma_f32_16x16x32_bf16 v[208:211], a[208:211], v[64:67], v[192:195]
    v_exp_f32 v212, v212
    v_mfma_f32_16x16x32_bf16 v[208:211], a[212:215], v[68:71], v[208:211]
    v_exp_f32 v213, v213
    v_mfma_f32_16x16x32_bf16 v[208:211], a[216:219], v[72:75], v[208:211]
    v_exp_f32 v214, v214
    v_mfma_f32_16x16x32_bf16 v[208:211], a[220:223], v[76:79], v[208:211]
    s_add_u32 s57, s58, 2359296
    v_exp_f32 v215, v215
    v_mfma_f32_16x16x32_bf16 a[0:3], a[160:163], v[160:163], a[0:3]
    ds_read_b64_tr_b16 a[172:173], v21 offset:24576
    v_cvt_pk_bf16_f32 v190, v212, v213
    v_mfma_f32_16x16x32_bf16 a[0:3], a[164:167], v[164:167], a[0:3]
    ds_read_b64_tr_b16 a[174:175], v21 offset:28672
    v_mov_b32 v63, 0
    v_mfma_f32_16x16x32_bf16 a[4:7], a[164:167], v[172:175], a[4:7]
    ds_read_b128 a[228:231], v9 offset:36864
    v_cvt_pk_bf16_f32 v191, v214, v215
    v_mfma_f32_16x16x32_bf16 a[4:7], a[160:163], v[168:171], a[4:7]
    buffer_load_dwordx4 a[144:147], v254, s[80:83], s57 offen
    v_mfma_f32_16x16x32_bf16 v[212:215], a[208:211], v[80:83], v[196:199]
    v_exp_f32 v208, v208
    v_mfma_f32_16x16x32_bf16 v[212:215], a[212:215], v[84:87], v[212:215]
    v_exp_f32 v209, v209
    v_mfma_f32_16x16x32_bf16 v[212:215], a[216:219], v[88:91], v[212:215]
    v_exp_f32 v210, v210
    v_mfma_f32_16x16x32_bf16 v[212:215], a[220:223], v[92:95], v[212:215]
    v_exp_f32 v211, v211
    v_mfma_f32_16x16x32_bf16 a[8:11], a[160:163], v[176:179], a[8:11]
    ds_read_b64_tr_b16 a[176:177], v22 offset:16384
    v_cvt_pk_bf16_f32 v128, v208, v209
    v_mfma_f32_16x16x32_bf16 a[8:11], a[164:167], v[180:183], a[8:11]
    ds_read_b64_tr_b16 a[178:179], v22 offset:20480
    v_add_f32_dpp v224, v224, v224 row_ror:2 row_mask:0xf bank_mask:0xf
    v_mfma_f32_16x16x32_bf16 a[12:15], a[164:167], v[188:191], a[12:15]
    ds_read_b128 a[232:235], v10 offset:36864
    v_cvt_pk_bf16_f32 v129, v210, v211
    v_mfma_f32_16x16x32_bf16 a[12:15], a[160:163], v[184:187], a[12:15]
    s_waitcnt lgkmcnt(3)
    buffer_load_dwordx4 v49, s[20:23], s49 offen offset:3072 lds
    v_mfma_f32_16x16x32_bf16 v[208:211], a[208:211], v[96:99], v[200:203]
    s_lshr_b32 s39, s2, 5
    v_exp_f32 v212, v212
    v_mfma_f32_16x16x32_bf16 v[208:211], a[212:215], v[100:103], v[208:211]
    s_lshl_b32 s39, s39, 3
    v_exp_f32 v213, v213
    v_mfma_f32_16x16x32_bf16 v[208:211], a[216:219], v[104:107], v[208:211]
    s_and_b32 s43, s2, 7
    v_exp_f32 v214, v214
    v_mfma_f32_16x16x32_bf16 v[208:211], a[220:223], v[108:111], v[208:211]
    s_add_u32 s39, s39, s43
    v_exp_f32 v215, v215
    v_mfma_f32_16x16x32_bf16 a[16:19], a[168:171], v[160:163], a[16:19]
    ds_read_b64_tr_b16 a[180:181], v22 offset:24576
    v_cvt_pk_bf16_f32 v136, v212, v213
    v_mfma_f32_16x16x32_bf16 a[16:19], a[172:175], v[164:167], a[16:19]
    ds_read_b64_tr_b16 a[182:183], v22 offset:28672
    v_add_f32_dpp v225, v225, v225 row_ror:2 row_mask:0xf bank_mask:0xf
    v_mfma_f32_16x16x32_bf16 a[20:23], a[172:175], v[172:175], a[20:23]
    ds_read_b128 a[236:239], v11 offset:36864
    v_cvt_pk_bf16_f32 v137, v214, v215
    v_mfma_f32_16x16x32_bf16 a[20:23], a[168:171], v[168:171], a[20:23]
    buffer_load_dword v253, v63, s[24:27], s54 offen offset:12 sc1
    v_smfmac_f32_16x16x64_bf16 a[192:195], v[52:55], v[160:167], v50
    v_mfma_f32_16x16x32_bf16 v[212:215], a[208:211], v[112:115], v[204:207]
    s_lshl_b32 s39, s39, 2
    v_exp_f32 v208, v208
    v_mfma_f32_16x16x32_bf16 v[212:215], a[212:215], v[116:119], v[212:215]
    s_add_u32 m0, s42, 114688
    v_exp_f32 v209, v209
    v_mfma_f32_16x16x32_bf16 v[212:215], a[216:219], v[120:123], v[212:215]
    s_bfe_u32 s43, s2, 0x20003
    v_exp_f32 v210, v210
    v_mfma_f32_16x16x32_bf16 v[212:215], a[220:223], v[124:127], v[212:215]
    s_add_u32 s39, s39, s43
    v_exp_f32 v211, v211
    v_mfma_f32_16x16x32_bf16 a[24:27], a[168:171], v[176:179], a[24:27]
    ds_read_b64_tr_b16 a[184:185], v23 offset:16384
    v_cvt_pk_bf16_f32 v144, v208, v209
    v_mfma_f32_16x16x32_bf16 a[24:27], a[172:175], v[180:183], a[24:27]
    ds_read_b64_tr_b16 a[186:187], v23 offset:20480
    v_add_f32_dpp v224, v224, v224 row_ror:4 row_mask:0xf bank_mask:0xf
    v_mfma_f32_16x16x32_bf16 a[28:31], a[172:175], v[188:191], a[28:31]
    ds_read_b128 a[208:211], v8 offset:40960
    v_cvt_pk_bf16_f32 v145, v210, v211
    v_mfma_f32_16x16x32_bf16 a[28:31], a[168:171], v[184:187], a[28:31]
    s_waitcnt lgkmcnt(3)
    buffer_load_dwordx4 v40, s[12:15], s41 offen lds
    v_mfma_f32_16x16x32_bf16 v[208:211], a[224:227], v[64:67], v[192:195]
    s_add_u32 s39, s39, 72
    v_exp_f32 v212, v212
    v_mfma_f32_16x16x32_bf16 v[208:211], a[228:231], v[68:71], v[208:211]
    s_cmp_lt_u32 s39, 216
    s_cselect_b32 s43, 0, 2147483648
    v_exp_f32 v213, v213
    v_mfma_f32_16x16x32_bf16 v[208:211], a[232:235], v[72:75], v[208:211]
    s_or_b32 s43, s43, s48
    v_exp_f32 v214, v214
    v_mfma_f32_16x16x32_bf16 v[208:211], a[236:239], v[76:79], v[208:211]
    s_add_u32 s57, s58, 2949120
    v_exp_f32 v215, v215
    v_mfma_f32_16x16x32_bf16 a[32:35], a[176:179], v[160:163], a[32:35]
    ds_read_b64_tr_b16 a[188:189], v23 offset:24576
    v_cvt_pk_bf16_f32 v152, v212, v213
    v_mfma_f32_16x16x32_bf16 a[32:35], a[180:183], v[164:167], a[32:35]
    ds_read_b64_tr_b16 a[190:191], v23 offset:28672
    v_add_f32_dpp v225, v225, v225 row_ror:4 row_mask:0xf bank_mask:0xf
    v_mfma_f32_16x16x32_bf16 a[36:39], a[180:183], v[172:175], a[36:39]
    ds_read_b128 a[212:215], v9 offset:40960
    v_cvt_pk_bf16_f32 v153, v214, v215
    v_mfma_f32_16x16x32_bf16 a[36:39], a[176:179], v[168:171], a[36:39]
    buffer_load_dwordx4 a[148:151], v254, s[80:83], s57 offen
    v_smfmac_f32_16x16x64_bf16 a[196:199], v[52:55], v[168:175], v50
    v_mfma_f32_16x16x32_bf16 v[212:215], a[224:227], v[80:83], v[196:199]
    s_and_b32 s43, s43, 2147483648
    v_exp_f32 v208, v208
    v_mfma_f32_16x16x32_bf16 v[212:215], a[228:231], v[84:87], v[212:215]
    s_sub_u32 s36, s39, 144
    v_exp_f32 v209, v209
    v_mfma_f32_16x16x32_bf16 v[212:215], a[232:235], v[88:91], v[212:215]
    s_cmp_lt_u32 s36, 36
    s_cselect_b32 s36, 1.0, 0
    v_exp_f32 v210, v210
    v_mfma_f32_16x16x32_bf16 v[212:215], a[236:239], v[92:95], v[212:215]
    s_lshr_b32 s44, s39, 1
    v_exp_f32 v211, v211
    v_mfma_f32_16x16x32_bf16 a[40:43], a[176:179], v[176:179], a[40:43]
    ds_read_b64_tr_b16 a[160:161], v24 offset:16384
    v_cvt_pk_bf16_f32 v130, v208, v209
    v_mfma_f32_16x16x32_bf16 a[40:43], a[180:183], v[180:183], a[40:43]
    ds_read_b64_tr_b16 a[162:163], v24 offset:20480
    v_add_f32_dpp v224, v224, v224 row_ror:8 row_mask:0xf bank_mask:0xf
    v_mfma_f32_16x16x32_bf16 a[44:47], a[180:183], v[188:191], a[44:47]
    ds_read_b128 a[216:219], v10 offset:40960
    v_cvt_pk_bf16_f32 v131, v210, v211
    v_mfma_f32_16x16x32_bf16 a[44:47], a[176:179], v[184:187], a[44:47]
    s_waitcnt lgkmcnt(3)
    buffer_load_dwordx4 v41, s[12:15], s41 offen offset:1024 lds
    v_mfma_f32_16x16x32_bf16 v[208:211], a[224:227], v[96:99], v[200:203]
    s_lshl_b32 s44, s44, 6
    v_exp_f32 v212, v212
    v_mfma_f32_16x16x32_bf16 v[208:211], a[228:231], v[100:103], v[208:211]
    s_and_b32 s39, s39, 1
    v_exp_f32 v213, v213
    v_mfma_f32_16x16x32_bf16 v[208:211], a[232:235], v[104:107], v[208:211]
    s_lshl_b32 s39, s39, 3
    v_exp_f32 v214, v214
    v_mfma_f32_16x16x32_bf16 v[208:211], a[236:239], v[108:111], v[208:211]
    s_add_u32 s39, s39, s44
    v_exp_f32 v215, v215
    v_mfma_f32_16x16x32_bf16 a[48:51], a[184:187], v[160:163], a[48:51]
    ds_read_b64_tr_b16 a[164:165], v24 offset:24576
    v_cvt_pk_bf16_f32 v138, v212, v213
    v_mfma_f32_16x16x32_bf16 a[48:51], a[188:191], v[164:167], a[48:51]
    ds_read_b64_tr_b16 a[166:167], v24 offset:28672
    v_add_f32_dpp v225, v225, v225 row_ror:8 row_mask:0xf bank_mask:0xf
    v_mfma_f32_16x16x32_bf16 a[52:55], a[188:191], v[172:175], a[52:55]
    ds_read_b128 a[220:223], v11 offset:40960
    v_cvt_pk_bf16_f32 v139, v214, v215
    v_mfma_f32_16x16x32_bf16 a[52:55], a[184:187], v[168:171], a[52:55]
    v_add_u32 v244, s38, v244
    v_and_b32 v245, 7, v1
    v_smfmac_f32_16x16x64_bf16 a[200:203], v[52:55], v[176:183], v50
    v_mfma_f32_16x16x32_bf16 v[212:215], a[224:227], v[112:115], v[204:207]
    s_add_u32 s39, s39, 16384
    v_exp_f32 v208, v208
    v_mfma_f32_16x16x32_bf16 v[212:215], a[228:231], v[116:119], v[212:215]
    s_or_b32 s39, s39, s43
    v_exp_f32 v209, v209
    v_mfma_f32_16x16x32_bf16 v[212:215], a[232:235], v[120:123], v[212:215]
    v_exp_f32 v210, v210
    v_mfma_f32_16x16x32_bf16 v[212:215], a[236:239], v[124:127], v[212:215]
    v_exp_f32 v211, v211
    v_mfma_f32_16x16x32_bf16 a[56:59], a[184:187], v[176:179], a[56:59]
    ds_read_b64_tr_b16 a[168:169], v25 offset:16384
    v_cvt_pk_bf16_f32 v146, v208, v209
    v_mfma_f32_16x16x32_bf16 a[56:59], a[188:191], v[180:183], a[56:59]
    ds_read_b64_tr_b16 a[170:171], v25 offset:20480
    v_mfma_f32_16x16x32_bf16 a[60:63], a[188:191], v[188:191], a[60:63]
    ds_read_b128 a[224:227], v8 offset:45056
    v_cvt_pk_bf16_f32 v147, v210, v211
    v_mfma_f32_16x16x32_bf16 a[60:63], a[184:187], v[184:187], a[60:63]
    s_waitcnt lgkmcnt(3)
    buffer_load_dwordx4 v40, s[12:15], s41 offen offset:2048 lds
    v_mfma_f32_16x16x32_bf16 v[208:211], a[208:211], v[64:67], v[192:195]
    v_exp_f32 v212, v212
    v_mfma_f32_16x16x32_bf16 v[208:211], a[212:215], v[68:71], v[208:211]
    v_exp_f32 v213, v213
    v_mfma_f32_16x16x32_bf16 v[208:211], a[216:219], v[72:75], v[208:211]
    v_exp_f32 v214, v214
    v_mfma_f32_16x16x32_bf16 v[208:211], a[220:223], v[76:79], v[208:211]
    s_add_u32 s57, s58, 3538944
    v_exp_f32 v215, v215
    v_mfma_f32_16x16x32_bf16 a[64:67], a[160:163], v[160:163], a[64:67]
    ds_read_b64_tr_b16 a[172:173], v25 offset:24576
    v_cvt_pk_bf16_f32 v154, v212, v213
    v_mfma_f32_16x16x32_bf16 a[64:67], a[164:167], v[164:167], a[64:67]
    ds_read_b64_tr_b16 a[174:175], v25 offset:28672
    v_lshlrev_b32 v245, 3, v245
    v_mfma_f32_16x16x32_bf16 a[68:71], a[164:167], v[172:175], a[68:71]
    ds_read_b128 a[228:231], v9 offset:45056
    v_cvt_pk_bf16_f32 v155, v214, v215
    v_mfma_f32_16x16x32_bf16 a[68:71], a[160:163], v[168:171], a[68:71]
    buffer_load_dwordx4 a[152:155], v254, s[80:83], s57 offen
    v_smfmac_f32_16x16x64_bf16 a[204:207], v[52:55], v[184:191], v50
    ds_write_b64 v244, v[224:225]
    v_mfma_f32_16x16x32_bf16 v[212:215], a[208:211], v[80:83], v[196:199]
    v_exp_f32 v208, v208
    v_mfma_f32_16x16x32_bf16 v[212:215], a[212:215], v[84:87], v[212:215]
    v_exp_f32 v209, v209
    v_mfma_f32_16x16x32_bf16 v[212:215], a[216:219], v[88:91], v[212:215]
    v_exp_f32 v210, v210
    v_mfma_f32_16x16x32_bf16 v[212:215], a[220:223], v[92:95], v[212:215]
    v_exp_f32 v211, v211
    v_mfma_f32_16x16x32_bf16 a[72:75], a[160:163], v[176:179], a[72:75]
    ds_read_b64_tr_b16 a[176:177], v26 offset:16384
    v_cvt_pk_bf16_f32 v132, v208, v209
    v_mfma_f32_16x16x32_bf16 a[72:75], a[164:167], v[180:183], a[72:75]
    ds_read_b64_tr_b16 a[178:179], v26 offset:20480
    v_add_u32 v245, 131136, v245
    v_mfma_f32_16x16x32_bf16 a[76:79], a[164:167], v[188:191], a[76:79]
    ds_read_b128 a[232:235], v10 offset:45056
    v_cvt_pk_bf16_f32 v133, v210, v211
    v_mfma_f32_16x16x32_bf16 a[76:79], a[160:163], v[184:187], a[76:79]
    s_waitcnt lgkmcnt(3)
    buffer_load_dwordx4 v41, s[12:15], s41 offen offset:3072 lds
    v_mfma_f32_16x16x32_bf16 v[208:211], a[208:211], v[96:99], v[200:203]
    v_exp_f32 v212, v212
    v_mfma_f32_16x16x32_bf16 v[208:211], a[212:215], v[100:103], v[208:211]
    s_add_u32 s41, s41, 16384
    v_exp_f32 v213, v213
    v_mfma_f32_16x16x32_bf16 v[208:211], a[216:219], v[104:107], v[208:211]
    v_exp_f32 v214, v214
    v_mfma_f32_16x16x32_bf16 v[208:211], a[220:223], v[108:111], v[208:211]
    v_exp_f32 v215, v215
    v_mfma_f32_16x16x32_bf16 a[80:83], a[168:171], v[160:163], a[80:83]
    ds_read_b64_tr_b16 a[180:181], v26 offset:24576
    v_cvt_pk_bf16_f32 v140, v212, v213
    v_mfma_f32_16x16x32_bf16 a[80:83], a[172:175], v[164:167], a[80:83]
    ds_read_b64_tr_b16 a[182:183], v26 offset:28672
    v_mfma_f32_16x16x32_bf16 a[84:87], a[172:175], v[172:175], a[84:87]
    ds_read_b128 a[236:239], v11 offset:45056
    v_cvt_pk_bf16_f32 v141, v214, v215
    v_mfma_f32_16x16x32_bf16 a[84:87], a[168:171], v[168:171], a[84:87]
    s_waitcnt vmcnt(14)
    s_barrier
    v_mfma_f32_16x16x32_bf16 v[212:215], a[208:211], v[112:115], v[204:207]
    v_exp_f32 v208, v208
    v_mfma_f32_16x16x32_bf16 v[212:215], a[212:215], v[116:119], v[212:215]
    s_add_u32 s49, s45, 74752
    v_exp_f32 v209, v209
    v_mfma_f32_16x16x32_bf16 v[212:215], a[216:219], v[120:123], v[212:215]
    s_add_u32 m0, s42, 16384
    v_exp_f32 v210, v210
    v_mfma_f32_16x16x32_bf16 v[212:215], a[220:223], v[124:127], v[212:215]
    v_exp_f32 v211, v211
    v_mfma_f32_16x16x32_bf16 a[88:91], a[168:171], v[176:179], a[88:91]
    ds_read_b64_tr_b16 a[184:185], v27 offset:16384
    v_cvt_pk_bf16_f32 v148, v208, v209
    v_mfma_f32_16x16x32_bf16 a[88:91], a[172:175], v[180:183], a[88:91]
    ds_read_b64_tr_b16 a[186:187], v27 offset:20480
    ds_read_b64 v[224:225], v245 offset:0
    v_mfma_f32_16x16x32_bf16 a[92:95], a[172:175], v[188:191], a[92:95]
    ds_read_b128 a[208:211], v8 offset:49152
    v_cvt_pk_bf16_f32 v149, v210, v211
    v_mfma_f32_16x16x32_bf16 a[92:95], a[168:171], v[184:187], a[92:95]
    s_waitcnt lgkmcnt(3)
    buffer_load_dwordx4 v46, s[20:23], s49 offen lds
    v_mfma_f32_16x16x32_bf16 v[208:211], a[224:227], v[64:67], v[192:195]
    v_exp_f32 v212, v212
    v_mfma_f32_16x16x32_bf16 v[208:211], a[228:231], v[68:71], v[208:211]
    v_exp_f32 v213, v213
    v_mfma_f32_16x16x32_bf16 v[208:211], a[232:235], v[72:75], v[208:211]
    v_exp_f32 v214, v214
    v_mfma_f32_16x16x32_bf16 v[208:211], a[236:239], v[76:79], v[208:211]
    s_add_u32 s37, s55, 8192
    v_exp_f32 v215, v215
    v_mfma_f32_16x16x32_bf16 a[96:99], a[176:179], v[160:163], a[96:99]
    ds_read_b64_tr_b16 a[188:189], v27 offset:24576
    v_cvt_pk_bf16_f32 v156, v212, v213
    v_mfma_f32_16x16x32_bf16 a[96:99], a[180:183], v[164:167], a[96:99]
    ds_read_b64_tr_b16 a[190:191], v27 offset:28672
    ds_read_b64 v[226:227], v245 offset:64
    v_mfma_f32_16x16x32_bf16 a[100:103], a[180:183], v[172:175], a[100:103]
    ds_read_b128 a[212:215], v9 offset:49152
    v_cvt_pk_bf16_f32 v157, v214, v215
    v_mfma_f32_16x16x32_bf16 a[100:103], a[176:179], v[168:171], a[100:103]
    buffer_load_dword v234, v238, s[28:31], s37 offen
    v_mfma_f32_16x16x32_bf16 v[212:215], a[224:227], v[80:83], v[196:199]
    v_exp_f32 v208, v208
    v_mfma_f32_16x16x32_bf16 v[212:215], a[228:231], v[84:87], v[212:215]
    v_exp_f32 v209, v209
    v_mfma_f32_16x16x32_bf16 v[212:215], a[232:235], v[88:91], v[212:215]
    v_exp_f32 v210, v210
    v_mfma_f32_16x16x32_bf16 v[212:215], a[236:239], v[92:95], v[212:215]
    v_exp_f32 v211, v211
    v_mfma_f32_16x16x32_bf16 a[104:107], a[176:179], v[176:179], a[104:107]
    ds_read_b64_tr_b16 a[160:161], v20 offset:32768
    v_cvt_pk_bf16_f32 v134, v208, v209
    v_mfma_f32_16x16x32_bf16 a[104:107], a[180:183], v[180:183], a[104:107]
    ds_read_b64_tr_b16 a[162:163], v20 offset:36864
    ds_read_b64 v[228:229], v245 offset:128
    v_mfma_f32_16x16x32_bf16 a[108:111], a[180:183], v[188:191], a[108:111]
    ds_read_b128 a[216:219], v10 offset:49152
    v_cvt_pk_bf16_f32 v135, v210, v211
    v_mfma_f32_16x16x32_bf16 a[108:111], a[176:179], v[184:187], a[108:111]
    s_waitcnt lgkmcnt(3)
    buffer_load_dwordx4 v47, s[20:23], s49 offen offset:1024 lds
    v_mfma_f32_16x16x32_bf16 v[208:211], a[224:227], v[96:99], v[200:203]
    v_exp_f32 v212, v212
    v_mfma_f32_16x16x32_bf16 v[208:211], a[228:231], v[100:103], v[208:211]
    v_exp_f32 v213, v213
    v_mfma_f32_16x16x32_bf16 v[208:211], a[232:235], v[104:107], v[208:211]
    v_exp_f32 v214, v214
    v_mfma_f32_16x16x32_bf16 v[208:211], a[236:239], v[108:111], v[208:211]
    s_add_u32 s57, s58, 4128768
    v_exp_f32 v215, v215
    v_mfma_f32_16x16x32_bf16 a[112:115], a[184:187], v[160:163], a[112:115]
    ds_read_b64_tr_b16 a[164:165], v20 offset:40960
    v_cvt_pk_bf16_f32 v142, v212, v213
    v_mfma_f32_16x16x32_bf16 a[112:115], a[188:191], v[164:167], a[112:115]
    ds_read_b64_tr_b16 a[166:167], v20 offset:45056
    ds_read_b64 v[230:231], v245 offset:192
    v_mfma_f32_16x16x32_bf16 a[116:119], a[188:191], v[172:175], a[116:119]
    ds_read_b128 a[220:223], v11 offset:49152
    v_cvt_pk_bf16_f32 v143, v214, v215
    v_mfma_f32_16x16x32_bf16 a[116:119], a[184:187], v[168:171], a[116:119]
    buffer_load_dwordx4 a[156:159], v254, s[80:83], s57 offen
    v_mfma_f32_16x16x32_bf16 v[212:215], a[224:227], v[112:115], v[204:207]
    v_exp_f32 v208, v208
    v_mfma_f32_16x16x32_bf16 v[212:215], a[228:231], v[116:119], v[212:215]
    v_exp_f32 v209, v209
    v_mfma_f32_16x16x32_bf16 v[212:215], a[232:235], v[120:123], v[212:215]
    v_exp_f32 v210, v210
    v_mfma_f32_16x16x32_bf16 v[212:215], a[236:239], v[124:127], v[212:215]
    v_exp_f32 v211, v211
    v_mfma_f32_16x16x32_bf16 a[120:123], a[184:187], v[176:179], a[120:123]
    ds_read_b64_tr_b16 a[168:169], v21 offset:32768
    v_cvt_pk_bf16_f32 v150, v208, v209
    v_mfma_f32_16x16x32_bf16 a[120:123], a[188:191], v[180:183], a[120:123]
    ds_read_b64_tr_b16 a[170:171], v21 offset:36864
    v_mfma_f32_16x16x32_bf16 a[124:127], a[188:191], v[188:191], a[124:127]
    ds_read_b128 a[224:227], v8 offset:53248
    v_cvt_pk_bf16_f32 v151, v210, v211
    v_mfma_f32_16x16x32_bf16 a[124:127], a[184:187], v[184:187], a[124:127]
    s_waitcnt lgkmcnt(3)
    buffer_load_dwordx4 v48, s[20:23], s49 offen offset:2048 lds
    v_mfma_f32_16x16x32_bf16 v[208:211], a[208:211], v[64:67], v[192:195]
    v_exp_f32 v212, v212
    v_mfma_f32_16x16x32_bf16 v[208:211], a[212:215], v[68:71], v[208:211]
    v_exp_f32 v213, v213
    v_mfma_f32_16x16x32_bf16 v[208:211], a[216:219], v[72:75], v[208:211]
    v_exp_f32 v214, v214
    v_mfma_f32_16x16x32_bf16 v[208:211], a[220:223], v[76:79], v[208:211]
    s_add_u32 s57, s58, 4718592
    v_exp_f32 v215, v215
    v_mfma_f32_16x16x32_bf16 a[0:3], a[160:163], v[128:131], a[0:3]
    ds_read_b64_tr_b16 a[172:173], v21 offset:40960
    v_cvt_pk_bf16_f32 v158, v212, v213
    v_mfma_f32_16x16x32_bf16 a[0:3], a[164:167], v[132:135], a[0:3]
    ds_read_b64_tr_b16 a[174:175], v21 offset:45056
    v_add_f32 v224, v224, v228
    v_mfma_f32_16x16x32_bf16 a[4:7], a[164:167], v[140:143], a[4:7]
    ds_read_b128 a[228:231], v9 offset:53248
    v_cvt_pk_bf16_f32 v159, v214, v215
    v_mfma_f32_16x16x32_bf16 a[4:7], a[160:163], v[136:139], a[4:7]
    buffer_load_dwordx4 a[240:243], v254, s[80:83], s57 offen
    v_mfma_f32_16x16x32_bf16 v[212:215], a[208:211], v[80:83], v[196:199]
    v_exp_f32 v208, v208
    v_mfma_f32_16x16x32_bf16 v[212:215], a[212:215], v[84:87], v[212:215]
    v_exp_f32 v209, v209
    v_mfma_f32_16x16x32_bf16 v[212:215], a[216:219], v[88:91], v[212:215]
    v_exp_f32 v210, v210
    v_mfma_f32_16x16x32_bf16 v[212:215], a[220:223], v[92:95], v[212:215]
    v_exp_f32 v211, v211
    v_mfma_f32_16x16x32_bf16 a[8:11], a[160:163], v[144:147], a[8:11]
    ds_read_b64_tr_b16 a[176:177], v22 offset:32768
    v_cvt_pk_bf16_f32 v160, v208, v209
    v_mfma_f32_16x16x32_bf16 a[8:11], a[164:167], v[148:151], a[8:11]
    ds_read_b64_tr_b16 a[178:179], v22 offset:36864
    v_add_f32 v225, v225, v229
    v_mfma_f32_16x16x32_bf16 a[12:15], a[164:167], v[156:159], a[12:15]
    ds_read_b128 a[232:235], v10 offset:53248
    v_cvt_pk_bf16_f32 v161, v210, v211
    v_mfma_f32_16x16x32_bf16 a[12:15], a[160:163], v[152:155], a[12:15]
    s_waitcnt lgkmcnt(3)
    buffer_load_dwordx4 v49, s[20:23], s49 offen offset:3072 lds
    v_mfma_f32_16x16x32_bf16 v[208:211], a[208:211], v[96:99], v[200:203]
    v_exp_f32 v212, v212
    v_mfma_f32_16x16x32_bf16 v[208:211], a[212:215], v[100:103], v[208:211]
    v_exp_f32 v213, v213
    v_mfma_f32_16x16x32_bf16 v[208:211], a[216:219], v[104:107], v[208:211]
    v_exp_f32 v214, v214
    v_mfma_f32_16x16x32_bf16 v[208:211], a[220:223], v[108:111], v[208:211]
    v_exp_f32 v215, v215
    v_mfma_f32_16x16x32_bf16 a[16:19], a[168:171], v[128:131], a[16:19]
    ds_read_b64_tr_b16 a[180:181], v22 offset:40960
    v_cvt_pk_bf16_f32 v168, v212, v213
    v_mfma_f32_16x16x32_bf16 a[16:19], a[172:175], v[132:135], a[16:19]
    ds_read_b64_tr_b16 a[182:183], v22 offset:45056
    v_add_f32 v226, v226, v230
    v_mfma_f32_16x16x32_bf16 a[20:23], a[172:175], v[140:143], a[20:23]
    ds_read_b128 a[236:239], v11 offset:53248
    v_cvt_pk_bf16_f32 v169, v214, v215
    v_mfma_f32_16x16x32_bf16 a[20:23], a[168:171], v[136:139], a[20:23]
    v_add_f32 v227, v227, v231
    v_add_f32 v224, v224, v226
    v_smfmac_f32_16x16x64_bf16 a[192:195], v[52:55], v[128:135], v50
    v_mfma_f32_16x16x32_bf16 v[212:215], a[208:211], v[112:115], v[204:207]
    v_exp_f32 v208, v208
    v_mfma_f32_16x16x32_bf16 v[212:215], a[212:215], v[116:119], v[212:215]
    s_add_u32 s49, s7, 0
    v_exp_f32 v209, v209
    v_mfma_f32_16x16x32_bf16 v[212:215], a[216:219], v[120:123], v[212:215]
    s_add_u32 m0, s42, 65536
    v_exp_f32 v210, v210
    v_mfma_f32_16x16x32_bf16 v[212:215], a[220:223], v[124:127], v[212:215]
    v_exp_f32 v211, v211
    v_mfma_f32_16x16x32_bf16 a[24:27], a[168:171], v[144:147], a[24:27]
    ds_read_b64_tr_b16 a[184:185], v23 offset:32768
    v_cvt_pk_bf16_f32 v176, v208, v209
    v_mfma_f32_16x16x32_bf16 a[24:27], a[172:175], v[148:151], a[24:27]
    ds_read_b64_tr_b16 a[186:187], v23 offset:36864
    v_add_f32 v225, v225, v227
    v_mfma_f32_16x16x32_bf16 a[28:31], a[172:175], v[156:159], a[28:31]
    ds_read_b128 a[208:211], v8 offset:57344
    v_cvt_pk_bf16_f32 v177, v210, v211
    v_mfma_f32_16x16x32_bf16 a[28:31], a[168:171], v[152:155], a[28:31]
    s_waitcnt lgkmcnt(3)
    buffer_load_dwordx4 v46, s[20:23], s49 offen lds
    v_mfma_f32_16x16x32_bf16 v[208:211], a[224:227], v[64:67], v[192:195]
    v_exp_f32 v212, v212
    v_mfma_f32_16x16x32_bf16 v[208:211], a[228:231], v[68:71], v[208:211]
    v_exp_f32 v213, v213
    v_mfma_f32_16x16x32_bf16 v[208:211], a[232:235], v[72:75], v[208:211]
    v_exp_f32 v214, v214
    v_mfma_f32_16x16x32_bf16 v[208:211], a[236:239], v[76:79], v[208:211]
    s_add_u32 s57, s58, 4128768
    v_exp_f32 v215, v215
    v_mfma_f32_16x16x32_bf16 a[32:35], a[176:179], v[128:131], a[32:35]
    ds_read_b64_tr_b16 a[188:189], v23 offset:40960
    v_cvt_pk_bf16_f32 v184, v212, v213
    v_mfma_f32_16x16x32_bf16 a[32:35], a[180:183], v[132:135], a[32:35]
    ds_read_b64_tr_b16 a[190:191], v23 offset:45056
    v_cvt_pk_bf16_f32 v246, v224, v225
    v_mfma_f32_16x16x32_bf16 a[36:39], a[180:183], v[140:143], a[36:39]
    ds_read_b128 a[212:215], v9 offset:57344
    v_cvt_pk_bf16_f32 v185, v214, v215
    v_mfma_f32_16x16x32_bf16 a[36:39], a[176:179], v[136:139], a[36:39]
    buffer_load_dwordx4 a[244:247], v254, s[32:35], s57 offen
    v_smfmac_f32_16x16x64_bf16 a[196:199], v[52:55], v[136:143], v50
    v_mfma_f32_16x16x32_bf16 v[212:215], a[224:227], v[80:83], v[196:199]
    v_exp_f32 v208, v208
    v_mfma_f32_16x16x32_bf16 v[212:215], a[228:231], v[84:87], v[212:215]
    v_exp_f32 v209, v209
    v_mfma_f32_16x16x32_bf16 v[212:215], a[232:235], v[88:91], v[212:215]
    v_exp_f32 v210, v210
    v_mfma_f32_16x16x32_bf16 v[212:215], a[236:239], v[92:95], v[212:215]
    v_exp_f32 v211, v211
    v_mfma_f32_16x16x32_bf16 a[40:43], a[176:179], v[144:147], a[40:43]
    ds_read_b64_tr_b16 a[160:161], v24 offset:32768
    v_cvt_pk_bf16_f32 v162, v208, v209
    v_mfma_f32_16x16x32_bf16 a[40:43], a[180:183], v[148:151], a[40:43]
    ds_read_b64_tr_b16 a[162:163], v24 offset:36864
    v_lshlrev_b32 v224, 16, v246
    v_mfma_f32_16x16x32_bf16 a[44:47], a[180:183], v[156:159], a[44:47]
    ds_read_b128 a[216:219], v10 offset:57344
    v_cvt_pk_bf16_f32 v163, v210, v211
    v_mfma_f32_16x16x32_bf16 a[44:47], a[176:179], v[152:155], a[44:47]
    s_waitcnt lgkmcnt(3)
    buffer_load_dwordx4 v47, s[20:23], s49 offen offset:1024 lds
    v_mfma_f32_16x16x32_bf16 v[208:211], a[224:227], v[96:99], v[200:203]
    v_exp_f32 v212, v212
    v_mfma_f32_16x16x32_bf16 v[208:211], a[228:231], v[100:103], v[208:211]
    v_exp_f32 v213, v213
    v_mfma_f32_16x16x32_bf16 v[208:211], a[232:235], v[104:107], v[208:211]
    v_exp_f32 v214, v214
    v_mfma_f32_16x16x32_bf16 v[208:211], a[236:239], v[108:111], v[208:211]
    v_exp_f32 v215, v215
    v_mfma_f32_16x16x32_bf16 a[48:51], a[184:187], v[128:131], a[48:51]
    ds_read_b64_tr_b16 a[164:165], v24 offset:40960
    v_cvt_pk_bf16_f32 v170, v212, v213
    v_mfma_f32_16x16x32_bf16 a[48:51], a[188:191], v[132:135], a[48:51]
    ds_read_b64_tr_b16 a[166:167], v24 offset:45056
    v_and_b32 v225, 0xffff0000, v246
    v_mfma_f32_16x16x32_bf16 a[52:55], a[188:191], v[140:143], a[52:55]
    ds_read_b128 a[220:223], v11 offset:57344
    v_cvt_pk_bf16_f32 v171, v214, v215
    v_mfma_f32_16x16x32_bf16 a[52:55], a[184:187], v[136:139], a[52:55]
    v_add_f32 v224, s36, v224
    v_add_f32 v225, s36, v225
    v_smfmac_f32_16x16x64_bf16 a[200:203], v[52:55], v[144:151], v50
    v_mfma_f32_16x16x32_bf16 v[212:215], a[224:227], v[112:115], v[204:207]
    v_exp_f32 v208, v208
    v_mfma_f32_16x16x32_bf16 v[212:215], a[228:231], v[116:119], v[212:215]
    v_exp_f32 v209, v209
    v_mfma_f32_16x16x32_bf16 v[212:215], a[232:235], v[120:123], v[212:215]
    v_exp_f32 v210, v210
    v_mfma_f32_16x16x32_bf16 v[212:215], a[236:239], v[124:127], v[212:215]
    v_exp_f32 v211, v211
    v_mfma_f32_16x16x32_bf16 a[56:59], a[184:187], v[144:147], a[56:59]
    ds_read_b64_tr_b16 a[168:169], v25 offset:32768
    v_cvt_pk_bf16_f32 v178, v208, v209
    v_mfma_f32_16x16x32_bf16 a[56:59], a[188:191], v[148:151], a[56:59]
    ds_read_b64_tr_b16 a[170:171], v25 offset:36864
    v_cvt_pk_bf16_f32 v246, v224, v225
    v_mfma_f32_16x16x32_bf16 a[60:63], a[188:191], v[156:159], a[60:63]
    ds_read_b128 a[224:227], v8 offset:61440
    v_cvt_pk_bf16_f32 v179, v210, v211
    v_mfma_f32_16x16x32_bf16 a[60:63], a[184:187], v[152:155], a[60:63]
    s_waitcnt lgkmcnt(3)
    buffer_load_dwordx4 v48, s[20:23], s49 offen offset:2048 lds
    v_mfma_f32_16x16x32_bf16 v[208:211], a[208:211], v[64:67], v[192:195]
    v_exp_f32 v212, v212
    v_mfma_f32_16x16x32_bf16 v[208:211], a[212:215], v[68:71], v[208:211]
    v_exp_f32 v213, v213
    v_mfma_f32_16x16x32_bf16 v[208:211], a[216:219], v[72:75], v[208:211]
    v_exp_f32 v214, v214
    v_mfma_f32_16x16x32_bf16 v[208:211], a[220:223], v[76:79], v[208:211]
    s_add_u32 s57, s58, 4718592
    v_exp_f32 v215, v215
    v_mfma_f32_16x16x32_bf16 a[64:67], a[160:163], v[128:131], a[64:67]
    ds_read_b64_tr_b16 a[172:173], v25 offset:40960
    v_cvt_pk_bf16_f32 v186, v212, v213
    v_mfma_f32_16x16x32_bf16 a[64:67], a[164:167], v[132:135], a[64:67]
Ltour7:
    s_cbranch_execz Ltour11
    ds_read_b64_tr_b16 a[174:175], v25 offset:45056
    v_lshrrev_b32 v244, 1, v0
    v_mfma_f32_16x16x32_bf16 a[68:71], a[164:167], v[140:143], a[68:71]
    ds_read_b128 a[228:231], v9 offset:61440
    v_cvt_pk_bf16_f32 v187, v214, v215
    v_mfma_f32_16x16x32_bf16 a[68:71], a[160:163], v[136:139], a[68:71]
    buffer_load_dwordx4 a[248:251], v254, s[32:35], s57 offen
    v_smfmac_f32_16x16x64_bf16 a[204:207], v[52:55], v[152:159], v50
    v_mfma_f32_16x16x32_bf16 v[212:215], a[208:211], v[80:83], v[196:199]
    v_exp_f32 v208, v208
    v_mfma_f32_16x16x32_bf16 v[212:215], a[212:215], v[84:87], v[212:215]
    v_exp_f32 v209, v209
    v_mfma_f32_16x16x32_bf16 v[212:215], a[216:219], v[88:91], v[212:215]
    v_exp_f32 v210, v210
    v_mfma_f32_16x16x32_bf16 v[212:215], a[220:223], v[92:95], v[212:215]
    v_exp_f32 v211, v211
    v_mfma_f32_16x16x32_bf16 a[72:75], a[160:163], v[144:147], a[72:75]
    ds_read_b64_tr_b16 a[176:177], v26 offset:32768
    v_cvt_pk_bf16_f32 v164, v208, v209
    v_mfma_f32_16x16x32_bf16 a[72:75], a[164:167], v[148:151], a[72:75]
    ds_read_b64_tr_b16 a[178:179], v26 offset:36864
    v_lshlrev_b32 v244, 4, v244
    v_mfma_f32_16x16x32_bf16 a[76:79], a[164:167], v[156:159], a[76:79]
    ds_read_b128 a[232:235], v10 offset:61440
    v_cvt_pk_bf16_f32 v165, v210, v211
    v_mfma_f32_16x16x32_bf16 a[76:79], a[160:163], v[152:155], a[76:79]
    s_waitcnt lgkmcnt(3)
    buffer_load_dwordx4 v49, s[20:23], s49 offen offset:3072 lds
    v_mfma_f32_16x16x32_bf16 v[208:211], a[208:211], v[96:99], v[200:203]
    v_exp_f32 v212, v212
    v_mfma_f32_16x16x32_bf16 v[208:211], a[212:215], v[100:103], v[208:211]
    v_exp_f32 v213, v213
    v_mfma_f32_16x16x32_bf16 v[208:211], a[216:219], v[104:107], v[208:211]
    v_exp_f32 v214, v214
    v_mfma_f32_16x16x32_bf16 v[208:211], a[220:223], v[108:111], v[208:211]
    v_exp_f32 v215, v215
    v_mfma_f32_16x16x32_bf16 a[80:83], a[168:171], v[128:131], a[80:83]
    ds_read_b64_tr_b16 a[180:181], v26 offset:40960
    v_cvt_pk_bf16_f32 v172, v212, v213
    v_mfma_f32_16x16x32_bf16 a[80:83], a[172:175], v[132:135], a[80:83]
    ds_read_b64_tr_b16 a[182:183], v26 offset:45056
    v_and_b32 v245, 1, v0
    v_mfma_f32_16x16x32_bf16 a[84:87], a[172:175], v[140:143], a[84:87]
    ds_read_b128 a[236:239], v11 offset:61440
    v_cvt_pk_bf16_f32 v173, v214, v215
    v_mfma_f32_16x16x32_bf16 a[84:87], a[168:171], v[136:139], a[84:87]
    s_waitcnt vmcnt(13)
    s_barrier
    v_mfma_f32_16x16x32_bf16 v[212:215], a[208:211], v[112:115], v[204:207]
    v_exp_f32 v208, v208
    v_mfma_f32_16x16x32_bf16 v[212:215], a[212:215], v[116:119], v[212:215]
    s_add_u32 s49, s7, 73728
    v_exp_f32 v209, v209
    v_mfma_f32_16x16x32_bf16 v[212:215], a[216:219], v[120:123], v[212:215]
    s_add_u32 m0, s42, 81920
    v_exp_f32 v210, v210
    v_mfma_f32_16x16x32_bf16 v[212:215], a[220:223], v[124:127], v[212:215]
    v_exp_f32 v211, v211
    v_mfma_f32_16x16x32_bf16 a[88:91], a[168:171], v[144:147], a[88:91]
    ds_read_b64_tr_b16 a[184:185], v27 offset:32768
    v_cvt_pk_bf16_f32 v180, v208, v209
    v_mfma_f32_16x16x32_bf16 a[88:91], a[172:175], v[148:151], a[88:91]
    ds_read_b64_tr_b16 a[186:187], v27 offset:36864
    v_lshl_add_u32 v244, v245, 2, v244
    v_mfma_f32_16x16x32_bf16 a[92:95], a[172:175], v[156:159], a[92:95]
    v_cvt_pk_bf16_f32 v181, v210, v211
    v_mfma_f32_16x16x32_bf16 a[92:95], a[168:171], v[152:155], a[92:95]
    s_waitcnt lgkmcnt(3)
    buffer_load_dwordx4 v46, s[20:23], s49 offen lds
    v_mfma_f32_16x16x32_bf16 v[208:211], a[224:227], v[64:67], v[192:195]
    v_exp_f32 v212, v212
    v_mfma_f32_16x16x32_bf16 v[208:211], a[228:231], v[68:71], v[208:211]
    v_exp_f32 v213, v213
    v_mfma_f32_16x16x32_bf16 v[208:211], a[232:235], v[72:75], v[208:211]
    s_waitcnt lgkmcnt(2)
    v_exp_f32 v214, v214
    v_mfma_f32_16x16x32_bf16 v[208:211], a[236:239], v[76:79], v[208:211]
    v_exp_f32 v215, v215
    v_mfma_f32_16x16x32_bf16 a[96:99], a[176:179], v[128:131], a[96:99]
    ds_read_b64_tr_b16 a[188:189], v27 offset:40960
    v_cvt_pk_bf16_f32 v188, v212, v213
    v_mfma_f32_16x16x32_bf16 a[96:99], a[180:183], v[132:135], a[96:99]
    ds_read_b64_tr_b16 a[190:191], v27 offset:45056
    v_lshrrev_b32 v245, 3, v0
    v_mfma_f32_16x16x32_bf16 a[100:103], a[180:183], v[140:143], a[100:103]
    v_cvt_pk_bf16_f32 v189, v214, v215
    v_mfma_f32_16x16x32_bf16 a[100:103], a[176:179], v[136:139], a[100:103]
    v_min_u32 v245, 1, v245
    v_lshl_or_b32 v244, v245, 31, v244
    v_mfma_f32_16x16x32_bf16 v[212:215], a[224:227], v[80:83], v[196:199]
    v_exp_f32 v208, v208
    v_mfma_f32_16x16x32_bf16 v[212:215], a[228:231], v[84:87], v[212:215]
    v_exp_f32 v209, v209
    v_mfma_f32_16x16x32_bf16 v[212:215], a[232:235], v[88:91], v[212:215]
    v_exp_f32 v210, v210
    v_mfma_f32_16x16x32_bf16 v[212:215], a[236:239], v[92:95], v[212:215]
    v_exp_f32 v211, v211
    v_mfma_f32_16x16x32_bf16 a[104:107], a[176:179], v[144:147], a[104:107]
    ds_read_b64_tr_b16 a[160:161], v20 offset:49152
    v_cvt_pk_bf16_f32 v166, v208, v209
    v_mfma_f32_16x16x32_bf16 a[104:107], a[180:183], v[148:151], a[104:107]
    ds_read_b64_tr_b16 a[162:163], v20 offset:53248
    v_mfma_f32_16x16x32_bf16 a[108:111], a[180:183], v[156:159], a[108:111]
    v_cvt_pk_bf16_f32 v167, v210, v211
    v_mfma_f32_16x16x32_bf16 a[108:111], a[176:179], v[152:155], a[108:111]
    s_waitcnt lgkmcnt(3)
    buffer_load_dwordx4 v47, s[20:23], s49 offen offset:1024 lds
    v_mfma_f32_16x16x32_bf16 v[208:211], a[224:227], v[96:99], v[200:203]
    v_exp_f32 v212, v212
    v_mfma_f32_16x16x32_bf16 v[208:211], a[228:231], v[100:103], v[208:211]
    v_exp_f32 v213, v213
    v_mfma_f32_16x16x32_bf16 v[208:211], a[232:235], v[104:107], v[208:211]
    v_exp_f32 v214, v214
    v_mfma_f32_16x16x32_bf16 v[208:211], a[236:239], v[108:111], v[208:211]
    s_add_u32 s57, s59, 0
    v_exp_f32 v215, v215
    v_mfma_f32_16x16x32_bf16 a[112:115], a[184:187], v[128:131], a[112:115]
    s_waitcnt lgkmcnt(2)
    ds_read_b64_tr_b16 a[164:165], v20 offset:57344
    v_cvt_pk_bf16_f32 v174, v212, v213
    v_mfma_f32_16x16x32_bf16 a[112:115], a[188:191], v[132:135], a[112:115]
    ds_read_b64_tr_b16 a[166:167], v20 offset:61440
    v_mfma_f32_16x16x32_bf16 a[116:119], a[188:191], v[140:143], a[116:119]
    v_cvt_pk_bf16_f32 v175, v214, v215
    v_mfma_f32_16x16x32_bf16 a[116:119], a[184:187], v[136:139], a[116:119]
    buffer_load_dwordx4 a[252:255], v255, s[84:87], s57 offen
    v_mfma_f32_16x16x32_bf16 v[212:215], a[224:227], v[112:115], v[204:207]
    v_exp_f32 v208, v208
    v_mfma_f32_16x16x32_bf16 v[212:215], a[228:231], v[116:119], v[212:215]
    v_exp_f32 v209, v209
    v_mfma_f32_16x16x32_bf16 v[212:215], a[232:235], v[120:123], v[212:215]
    v_exp_f32 v210, v210
    v_mfma_f32_16x16x32_bf16 v[212:215], a[236:239], v[124:127], v[212:215]
    v_exp_f32 v211, v211
    v_mfma_f32_16x16x32_bf16 a[120:123], a[184:187], v[144:147], a[120:123]
    ds_read_b64_tr_b16 a[168:169], v21 offset:49152
    v_cvt_pk_bf16_f32 v182, v208, v209
    v_mfma_f32_16x16x32_bf16 a[120:123], a[188:191], v[148:151], a[120:123]
    ds_read_b64_tr_b16 a[170:171], v21 offset:53248
    v_mfma_f32_16x16x32_bf16 a[124:127], a[188:191], v[156:159], a[124:127]
    v_cvt_pk_bf16_f32 v183, v210, v211
    v_mfma_f32_16x16x32_bf16 a[124:127], a[184:187], v[152:155], a[124:127]
    s_waitcnt lgkmcnt(3)
    buffer_load_dwordx4 v48, s[20:23], s49 offen offset:2048 lds
    v_smfmac_f32_16x16x64_bf16 a[192:195], v[52:55], v[160:167], v50
    v_exp_f32 v212, v212
    v_smfmac_f32_16x16x64_bf16 a[196:199], v[52:55], v[168:175], v50
    v_exp_f32 v213, v213
    v_smfmac_f32_16x16x64_bf16 a[200:203], v[52:55], v[176:183], v50
    v_exp_f32 v214, v214
    v_exp_f32 v215, v215
    v_mfma_f32_16x16x32_bf16 a[0:3], a[160:163], v[160:163], a[0:3]
    s_waitcnt lgkmcnt(2)
    ds_read_b64_tr_b16 a[172:173], v21 offset:57344
    v_cvt_pk_bf16_f32 v190, v212, v213
    v_mfma_f32_16x16x32_bf16 a[0:3], a[164:167], v[164:167], a[0:3]
    ds_read_b64_tr_b16 a[174:175], v21 offset:61440
    v_mfma_f32_16x16x32_bf16 a[4:7], a[164:167], v[172:175], a[4:7]
    v_cvt_pk_bf16_f32 v191, v214, v215
    v_mfma_f32_16x16x32_bf16 a[4:7], a[160:163], v[168:171], a[4:7]
    buffer_store_dword v246, v244, s[24:27], s39 offen sc1
    v_smfmac_f32_16x16x64_bf16 a[204:207], v[52:55], v[184:191], v50
    v_mfma_f32_16x16x32_bf16 a[8:11], a[160:163], v[176:179], a[8:11]
    ds_read_b64_tr_b16 a[176:177], v22 offset:49152
    v_mfma_f32_16x16x32_bf16 a[8:11], a[164:167], v[180:183], a[8:11]
    ds_read_b64_tr_b16 a[178:179], v22 offset:53248
    v_accvgpr_read_b32 v216, a192
    v_accvgpr_read_b32 v217, a193
    v_mfma_f32_16x16x32_bf16 a[12:15], a[164:167], v[188:191], a[12:15]
    v_accvgpr_read_b32 v218, a196
    v_accvgpr_read_b32 v219, a197
    v_mfma_f32_16x16x32_bf16 a[12:15], a[160:163], v[184:187], a[12:15]
    s_waitcnt lgkmcnt(4)
    buffer_load_dwordx4 v49, s[20:23], s49 offen offset:3072 lds
    v_accvgpr_read_b32 v220, a200
    v_accvgpr_read_b32 v221, a201
    v_mfma_f32_16x16x32_bf16 a[16:19], a[168:171], v[160:163], a[16:19]
    s_waitcnt lgkmcnt(2)
    ds_read_b64_tr_b16 a[180:181], v22 offset:57344
    v_accvgpr_read_b32 v222, a204
    v_mfma_f32_16x16x32_bf16 a[16:19], a[172:175], v[164:167], a[16:19]
    ds_read_b64_tr_b16 a[182:183], v22 offset:61440
    v_accvgpr_read_b32 v223, a205
    v_add_f32 v58, v216, v217
    v_mfma_f32_16x16x32_bf16 a[20:23], a[172:175], v[172:175], a[20:23]
    v_add_f32 v59, v218, v219
    v_add_f32 v60, v220, v221
    v_mfma_f32_16x16x32_bf16 a[20:23], a[168:171], v[168:171], a[20:23]
    v_add_f32 v61, v222, v223
    v_add_f32 v216, v58, v59
    s_add_u32 s49, s7, 256
    s_add_u32 m0, s42, 32768
    v_mfma_f32_16x16x32_bf16 a[24:27], a[168:171], v[176:179], a[24:27]
    ds_read_b64_tr_b16 a[184:185], v23 offset:49152
    v_add_f32 v217, v60, v61
    v_mfma_f32_16x16x32_bf16 a[24:27], a[172:175], v[180:183], a[24:27]
    ds_read_b64_tr_b16 a[186:187], v23 offset:53248
    v_add_f32 v216, v216, v217
    v_cmp_ngt_f32 vcc, 1669332992, v216
    v_mfma_f32_16x16x32_bf16 a[28:31], a[172:175], v[188:191], a[28:31]
    v_rcp_f32 v58, v58
    v_rcp_f32 v59, v59
    v_mfma_f32_16x16x32_bf16 a[28:31], a[168:171], v[184:187], a[28:31]
    s_waitcnt lgkmcnt(4)
    buffer_load_dwordx4 v46, s[20:23], s49 offen lds
    v_rcp_f32 v60, v60
    v_rcp_f32 v61, v61
    v_mfma_f32_16x16x32_bf16 a[32:35], a[176:179], v[160:163], a[32:35]
    s_waitcnt lgkmcnt(2)
    ds_read_b64_tr_b16 a[188:189], v23 offset:57344
    v_mov_b32 v228, 131072
    v_mfma_f32_16x16x32_bf16 a[32:35], a[180:183], v[164:167], a[32:35]
    ds_read_b64_tr_b16 a[190:191], v23 offset:61440
    s_or_b32 s36, vcc_lo, vcc_hi
    v_mfma_f32_16x16x32_bf16 a[36:39], a[180:183], v[172:175], a[36:39]
    v_accvgpr_read_b32 v208, a0
    v_accvgpr_read_b32 v209, a1
    v_accvgpr_read_b32 v210, a2
    v_accvgpr_read_b32 v211, a3
    v_pk_mul_f32 v[208:209], v[208:209], v[58:59] op_sel:[0,0] op_sel_hi:[1,0]
    v_pk_mul_f32 v[210:211], v[210:211], v[58:59] op_sel:[0,0] op_sel_hi:[1,0]
    v_cvt_pk_bf16_f32 v128, v208, v209
    v_cvt_pk_bf16_f32 v129, v210, v211
    v_mfma_f32_16x16x32_bf16 a[36:39], a[176:179], v[168:171], a[36:39]
    v_accvgpr_read_b32 v212, a4
    v_accvgpr_read_b32 v213, a5
    v_accvgpr_read_b32 v214, a6
    v_accvgpr_read_b32 v215, a7
    v_pk_mul_f32 v[212:213], v[212:213], v[58:59] op_sel:[0,1] op_sel_hi:[1,1]
    v_pk_mul_f32 v[214:215], v[214:215], v[58:59] op_sel:[0,1] op_sel_hi:[1,1]
    v_cvt_pk_bf16_f32 v132, v212, v213
    v_cvt_pk_bf16_f32 v133, v214, v215
    v_mfma_f32_16x16x32_bf16 a[40:43], a[176:179], v[176:179], a[40:43]
    ds_read_b64_tr_b16 a[160:161], v24 offset:49152
    v_mov_b32 v218, s36
    v_mfma_f32_16x16x32_bf16 a[40:43], a[180:183], v[180:183], a[40:43]
    ds_read_b64_tr_b16 a[162:163], v24 offset:53248
    s_lshl_b32 s38, s3, 2
    v_mfma_f32_16x16x32_bf16 a[44:47], a[180:183], v[188:191], a[44:47]
    v_accvgpr_read_b32 v208, a8
    v_accvgpr_read_b32 v209, a9
    v_accvgpr_read_b32 v210, a10
    v_accvgpr_read_b32 v211, a11
    v_pk_mul_f32 v[208:209], v[208:209], v[60:61] op_sel:[0,0] op_sel_hi:[1,0]
    v_pk_mul_f32 v[210:211], v[210:211], v[60:61] op_sel:[0,0] op_sel_hi:[1,0]
    v_cvt_pk_bf16_f32 v136, v208, v209
    v_cvt_pk_bf16_f32 v137, v210, v211
    v_mfma_f32_16x16x32_bf16 a[44:47], a[176:179], v[184:187], a[44:47]
    s_waitcnt lgkmcnt(4)
    buffer_load_dwordx4 v47, s[20:23], s49 offen offset:1024 lds
    v_accvgpr_read_b32 v212, a12
    v_accvgpr_read_b32 v213, a13
    v_accvgpr_read_b32 v214, a14
    v_accvgpr_read_b32 v215, a15
    v_pk_mul_f32 v[212:213], v[212:213], v[60:61] op_sel:[0,1] op_sel_hi:[1,1]
    v_pk_mul_f32 v[214:215], v[214:215], v[60:61] op_sel:[0,1] op_sel_hi:[1,1]
    v_cvt_pk_bf16_f32 v140, v212, v213
    v_cvt_pk_bf16_f32 v141, v214, v215
    v_mfma_f32_16x16x32_bf16 a[48:51], a[184:187], v[160:163], a[48:51]
    s_waitcnt lgkmcnt(2)
    ds_read_b64_tr_b16 a[164:165], v24 offset:57344
    v_add_u32 v219, s38, v228
    v_mfma_f32_16x16x32_bf16 a[48:51], a[188:191], v[164:167], a[48:51]
    ds_read_b64_tr_b16 a[166:167], v24 offset:61440
    ds_write_b32 v219, v218
    v_mfma_f32_16x16x32_bf16 a[52:55], a[188:191], v[172:175], a[52:55]
    v_accvgpr_read_b32 v208, a16
    v_accvgpr_read_b32 v209, a17
    v_accvgpr_read_b32 v210, a18
    v_accvgpr_read_b32 v211, a19
    v_pk_mul_f32 v[208:209], v[208:209], v[58:59] op_sel:[0,0] op_sel_hi:[1,0]
    v_pk_mul_f32 v[210:211], v[210:211], v[58:59] op_sel:[0,0] op_sel_hi:[1,0]
    v_cvt_pk_bf16_f32 v130, v208, v209
    v_cvt_pk_bf16_f32 v131, v210, v211
    s_add_u32 s37, s55, 0
    buffer_store_dwordx4 v[128:131], v252, s[28:31], s37 offen offset:0
    v_mfma_f32_16x16x32_bf16 a[52:55], a[184:187], v[168:171], a[52:55]
    v_accvgpr_read_b32 v212, a20
    v_accvgpr_read_b32 v213, a21
    v_accvgpr_read_b32 v214, a22
    v_accvgpr_read_b32 v215, a23
    v_pk_mul_f32 v[212:213], v[212:213], v[58:59] op_sel:[0,1] op_sel_hi:[1,1]
    v_pk_mul_f32 v[214:215], v[214:215], v[58:59] op_sel:[0,1] op_sel_hi:[1,1]
    v_cvt_pk_bf16_f32 v134, v212, v213
    v_cvt_pk_bf16_f32 v135, v214, v215
    s_add_u32 s37, s55, 8192
    buffer_store_dwordx4 v[132:135], v252, s[28:31], s37 offen offset:0
    v_mfma_f32_16x16x32_bf16 a[56:59], a[184:187], v[176:179], a[56:59]
    ds_read_b64_tr_b16 a[168:169], v25 offset:49152
    v_min_u32 v240, 1, v0
    v_mfma_f32_16x16x32_bf16 a[56:59], a[188:191], v[180:183], a[56:59]
    ds_read_b64_tr_b16 a[170:171], v25 offset:53248
    v_mfma_f32_16x16x32_bf16 a[60:63], a[188:191], v[188:191], a[60:63]
    v_accvgpr_read_b32 v208, a24
    v_accvgpr_read_b32 v209, a25
    v_accvgpr_read_b32 v210, a26
    v_accvgpr_read_b32 v211, a27
    v_pk_mul_f32 v[208:209], v[208:209], v[60:61] op_sel:[0,0] op_sel_hi:[1,0]
    v_pk_mul_f32 v[210:211], v[210:211], v[60:61] op_sel:[0,0] op_sel_hi:[1,0]
    v_cvt_pk_bf16_f32 v138, v208, v209
    v_cvt_pk_bf16_f32 v139, v210, v211
    s_add_u32 s37, s55, 4096
    buffer_store_dwordx4 v[136:139], v252, s[28:31], s37 offen offset:0
    v_mfma_f32_16x16x32_bf16 a[60:63], a[184:187], v[184:187], a[60:63]
    s_waitcnt lgkmcnt(5)
    buffer_load_dwordx4 v48, s[20:23], s49 offen offset:2048 lds
    v_accvgpr_read_b32 v212, a28
    v_accvgpr_read_b32 v213, a29
    v_accvgpr_read_b32 v214, a30
    v_accvgpr_read_b32 v215, a31
    v_pk_mul_f32 v[212:213], v[212:213], v[60:61] op_sel:[0,1] op_sel_hi:[1,1]
    v_pk_mul_f32 v[214:215], v[214:215], v[60:61] op_sel:[0,1] op_sel_hi:[1,1]
    v_cvt_pk_bf16_f32 v142, v212, v213
    v_cvt_pk_bf16_f32 v143, v214, v215
    s_add_u32 s37, s55, 12288
    buffer_store_dwordx4 v[140:143], v252, s[28:31], s37 offen offset:0
    v_mfma_f32_16x16x32_bf16 a[64:67], a[160:163], v[160:163], a[64:67]
    s_waitcnt lgkmcnt(3)
    ds_read_b64_tr_b16 a[172:173], v25 offset:57344
    v_lshlrev_b32 v240, 31, v240
    v_mfma_f32_16x16x32_bf16 a[64:67], a[164:167], v[164:167], a[64:67]
    ds_read_b64_tr_b16 a[174:175], v25 offset:61440
    v_mfma_f32_16x16x32_bf16 a[68:71], a[164:167], v[172:175], a[68:71]
    v_accvgpr_read_b32 v208, a32
    v_accvgpr_read_b32 v209, a33
    v_accvgpr_read_b32 v210, a34
    v_accvgpr_read_b32 v211, a35
    v_pk_mul_f32 v[208:209], v[208:209], v[58:59] op_sel:[0,0] op_sel_hi:[1,0]
    v_pk_mul_f32 v[210:211], v[210:211], v[58:59] op_sel:[0,0] op_sel_hi:[1,0]
    v_cvt_pk_bf16_f32 v144, v208, v209
    v_cvt_pk_bf16_f32 v145, v210, v211
    v_mfma_f32_16x16x32_bf16 a[68:71], a[160:163], v[168:171], a[68:71]
    v_accvgpr_read_b32 v212, a36
    v_accvgpr_read_b32 v213, a37
    v_accvgpr_read_b32 v214, a38
    v_accvgpr_read_b32 v215, a39
    v_pk_mul_f32 v[212:213], v[212:213], v[58:59] op_sel:[0,1] op_sel_hi:[1,1]
    v_pk_mul_f32 v[214:215], v[214:215], v[58:59] op_sel:[0,1] op_sel_hi:[1,1]
    v_cvt_pk_bf16_f32 v148, v212, v213
    v_cvt_pk_bf16_f32 v149, v214, v215
    v_mfma_f32_16x16x32_bf16 a[72:75], a[160:163], v[176:179], a[72:75]
    ds_read_b64_tr_b16 a[176:177], v26 offset:49152
    v_mov_b32 v241, 1
    v_mfma_f32_16x16x32_bf16 a[72:75], a[164:167], v[180:183], a[72:75]
    ds_read_b64_tr_b16 a[178:179], v26 offset:53248
    v_mfma_f32_16x16x32_bf16 a[76:79], a[164:167], v[188:191], a[76:79]
    v_accvgpr_read_b32 v208, a40
    v_accvgpr_read_b32 v209, a41
    v_accvgpr_read_b32 v210, a42
    v_accvgpr_read_b32 v211, a43
    v_pk_mul_f32 v[208:209], v[208:209], v[60:61] op_sel:[0,0] op_sel_hi:[1,0]
    v_pk_mul_f32 v[210:211], v[210:211], v[60:61] op_sel:[0,0] op_sel_hi:[1,0]
    v_cvt_pk_bf16_f32 v152, v208, v209
    v_cvt_pk_bf16_f32 v153, v210, v211
    v_mfma_f32_16x16x32_bf16 a[76:79], a[160:163], v[184:187], a[76:79]
    s_waitcnt lgkmcnt(4)
    buffer_load_dwordx4 v49, s[20:23], s49 offen offset:3072 lds
    v_accvgpr_read_b32 v212, a44
    v_accvgpr_read_b32 v213, a45
    v_accvgpr_read_b32 v214, a46
    v_accvgpr_read_b32 v215, a47
    v_pk_mul_f32 v[212:213], v[212:213], v[60:61] op_sel:[0,1] op_sel_hi:[1,1]
    v_pk_mul_f32 v[214:215], v[214:215], v[60:61] op_sel:[0,1] op_sel_hi:[1,1]
    v_cvt_pk_bf16_f32 v156, v212, v213
    v_cvt_pk_bf16_f32 v157, v214, v215
    v_mfma_f32_16x16x32_bf16 a[80:83], a[168:171], v[160:163], a[80:83]
    s_waitcnt lgkmcnt(2)
    ds_read_b64_tr_b16 a[180:181], v26 offset:57344
    v_mfma_f32_16x16x32_bf16 a[80:83], a[172:175], v[164:167], a[80:83]
    ds_read_b64_tr_b16 a[182:183], v26 offset:61440
    v_mfma_f32_16x16x32_bf16 a[84:87], a[172:175], v[172:175], a[84:87]
    v_accvgpr_read_b32 v208, a48
    v_accvgpr_read_b32 v209, a49
    v_accvgpr_read_b32 v210, a50
    v_accvgpr_read_b32 v211, a51
    v_pk_mul_f32 v[208:209], v[208:209], v[58:59] op_sel:[0,0] op_sel_hi:[1,0]
    v_pk_mul_f32 v[210:211], v[210:211], v[58:59] op_sel:[0,0] op_sel_hi:[1,0]
    v_cvt_pk_bf16_f32 v146, v208, v209
    v_cvt_pk_bf16_f32 v147, v210, v211
    s_add_u32 s37, s55, 0
    buffer_store_dwordx4 v[144:147], v252, s[28:31], s37 offen offset:1024
    v_mfma_f32_16x16x32_bf16 a[84:87], a[168:171], v[168:171], a[84:87]
    v_accvgpr_read_b32 v212, a52
    v_accvgpr_read_b32 v213, a53
    v_accvgpr_read_b32 v214, a54
    v_accvgpr_read_b32 v215, a55
    v_pk_mul_f32 v[212:213], v[212:213], v[58:59] op_sel:[0,1] op_sel_hi:[1,1]
    v_pk_mul_f32 v[214:215], v[214:215], v[58:59] op_sel:[0,1] op_sel_hi:[1,1]
    v_cvt_pk_bf16_f32 v150, v212, v213
    v_cvt_pk_bf16_f32 v151, v214, v215
    s_add_u32 s37, s55, 8192
    buffer_store_dwordx4 v[148:151], v252, s[28:31], s37 offen offset:1024
    s_waitcnt vmcnt(22)
    s_barrier
    v_mfma_f32_16x16x32_bf16 a[88:91], a[168:171], v[176:179], a[88:91]
    ds_read_b64_tr_b16 a[184:185], v27 offset:49152
    v_mfma_f32_16x16x32_bf16 a[88:91], a[172:175], v[180:183], a[88:91]
    ds_read_b64_tr_b16 a[186:187], v27 offset:53248
    v_mfma_f32_16x16x32_bf16 a[92:95], a[172:175], v[188:191], a[92:95]
    ds_read_b128 v[224:227], v228
    v_accvgpr_read_b32 v208, a56
    v_accvgpr_read_b32 v209, a57
    v_accvgpr_read_b32 v210, a58
    v_accvgpr_read_b32 v211, a59
    v_pk_mul_f32 v[208:209], v[208:209], v[60:61] op_sel:[0,0] op_sel_hi:[1,0]
    v_pk_mul_f32 v[210:211], v[210:211], v[60:61] op_sel:[0,0] op_sel_hi:[1,0]
    v_cvt_pk_bf16_f32 v154, v208, v209
    v_cvt_pk_bf16_f32 v155, v210, v211
    s_add_u32 s37, s55, 4096
    buffer_store_dwordx4 v[152:155], v252, s[28:31], s37 offen offset:1024
    v_mfma_f32_16x16x32_bf16 a[92:95], a[168:171], v[184:187], a[92:95]
    s_waitcnt lgkmcnt(5)
    v_accvgpr_read_b32 v212, a60
    v_accvgpr_read_b32 v213, a61
    v_accvgpr_read_b32 v214, a62
    v_accvgpr_read_b32 v215, a63
    v_pk_mul_f32 v[212:213], v[212:213], v[60:61] op_sel:[0,1] op_sel_hi:[1,1]
    v_pk_mul_f32 v[214:215], v[214:215], v[60:61] op_sel:[0,1] op_sel_hi:[1,1]
    v_cvt_pk_bf16_f32 v158, v212, v213
    v_cvt_pk_bf16_f32 v159, v214, v215
    s_add_u32 s37, s55, 12288
    buffer_store_dwordx4 v[156:159], v252, s[28:31], s37 offen offset:1024
    s_add_u32 s49, s7, 73984
    v_mfma_f32_16x16x32_bf16 a[96:99], a[176:179], v[160:163], a[96:99]
    s_waitcnt lgkmcnt(3)
    s_add_u32 m0, s42, 49152
    ds_read_b64_tr_b16 a[188:189], v27 offset:57344
    v_mfma_f32_16x16x32_bf16 a[96:99], a[180:183], v[164:167], a[96:99]
    buffer_load_dwordx4 v46, s[20:23], s49 offen lds
    v_mfma_f32_16x16x32_bf16 a[100:103], a[180:183], v[172:175], a[100:103]
    ds_read_b64_tr_b16 a[190:191], v27 offset:61440
    v_accvgpr_read_b32 v208, a64
    v_accvgpr_read_b32 v209, a65
    v_accvgpr_read_b32 v210, a66
    v_accvgpr_read_b32 v211, a67
    v_pk_mul_f32 v[208:209], v[208:209], v[58:59] op_sel:[0,0] op_sel_hi:[1,0]
    v_pk_mul_f32 v[210:211], v[210:211], v[58:59] op_sel:[0,0] op_sel_hi:[1,0]
    v_cvt_pk_bf16_f32 v192, v208, v209
    v_cvt_pk_bf16_f32 v193, v210, v211
    v_mfma_f32_16x16x32_bf16 a[100:103], a[176:179], v[168:171], a[100:103]
    buffer_load_dwordx4 v47, s[20:23], s49 offen offset:1024 lds
    v_accvgpr_read_b32 v212, a68
    v_accvgpr_read_b32 v213, a69
    v_accvgpr_read_b32 v214, a70
    v_accvgpr_read_b32 v215, a71
    v_pk_mul_f32 v[212:213], v[212:213], v[58:59] op_sel:[0,1] op_sel_hi:[1,1]
    v_pk_mul_f32 v[214:215], v[214:215], v[58:59] op_sel:[0,1] op_sel_hi:[1,1]
    v_cvt_pk_bf16_f32 v196, v212, v213
    v_cvt_pk_bf16_f32 v197, v214, v215
    v_mfma_f32_16x16x32_bf16 a[104:107], a[176:179], v[176:179], a[104:107]
    v_mfma_f32_16x16x32_bf16 a[104:107], a[180:183], v[180:183], a[104:107]
    buffer_load_dwordx4 v48, s[20:23], s49 offen offset:2048 lds
    v_mfma_f32_16x16x32_bf16 a[108:111], a[180:183], v[188:191], a[108:111]
    v_accvgpr_read_b32 v208, a72
    v_accvgpr_read_b32 v209, a73
    v_accvgpr_read_b32 v210, a74
    v_accvgpr_read_b32 v211, a75
    v_pk_mul_f32 v[208:209], v[208:209], v[60:61] op_sel:[0,0] op_sel_hi:[1,0]
    v_pk_mul_f32 v[210:211], v[210:211], v[60:61] op_sel:[0,0] op_sel_hi:[1,0]
    v_cvt_pk_bf16_f32 v200, v208, v209
    v_cvt_pk_bf16_f32 v201, v210, v211
    v_mfma_f32_16x16x32_bf16 a[108:111], a[176:179], v[184:187], a[108:111]
    s_waitcnt lgkmcnt(3)
    buffer_load_dwordx4 v49, s[20:23], s49 offen offset:3072 lds
    v_accvgpr_read_b32 v212, a76
    v_accvgpr_read_b32 v213, a77
    v_accvgpr_read_b32 v214, a78
    v_accvgpr_read_b32 v215, a79
    v_pk_mul_f32 v[212:213], v[212:213], v[60:61] op_sel:[0,1] op_sel_hi:[1,1]
    v_pk_mul_f32 v[214:215], v[214:215], v[60:61] op_sel:[0,1] op_sel_hi:[1,1]
    v_cvt_pk_bf16_f32 v204, v212, v213
    v_cvt_pk_bf16_f32 v205, v214, v215
    s_add_u32 s49, s46, 0
    v_mfma_f32_16x16x32_bf16 a[112:115], a[184:187], v[160:163], a[112:115]
    s_waitcnt lgkmcnt(0)
    s_add_u32 m0, s42, 98304
    v_mfma_f32_16x16x32_bf16 a[112:115], a[188:191], v[164:167], a[112:115]
    buffer_load_dwordx4 v46, s[20:23], s49 offen lds
    v_mfma_f32_16x16x32_bf16 a[116:119], a[188:191], v[172:175], a[116:119]
    v_accvgpr_read_b32 v208, a80
    v_accvgpr_read_b32 v209, a81
    v_accvgpr_read_b32 v210, a82
    v_accvgpr_read_b32 v211, a83
    v_pk_mul_f32 v[208:209], v[208:209], v[58:59] op_sel:[0,0] op_sel_hi:[1,0]
    v_pk_mul_f32 v[210:211], v[210:211], v[58:59] op_sel:[0,0] op_sel_hi:[1,0]
    v_cvt_pk_bf16_f32 v194, v208, v209
    v_cvt_pk_bf16_f32 v195, v210, v211
    s_add_u32 s37, s55, 0
    buffer_store_dwordx4 v[192:195], v252, s[28:31], s37 offen offset:2048
    v_mfma_f32_16x16x32_bf16 a[116:119], a[184:187], v[168:171], a[116:119]
    buffer_load_dwordx4 v47, s[20:23], s49 offen offset:1024 lds
    v_accvgpr_read_b32 v212, a84
    v_accvgpr_read_b32 v213, a85
    v_accvgpr_read_b32 v214, a86
    v_accvgpr_read_b32 v215, a87
    v_pk_mul_f32 v[212:213], v[212:213], v[58:59] op_sel:[0,1] op_sel_hi:[1,1]
    v_pk_mul_f32 v[214:215], v[214:215], v[58:59] op_sel:[0,1] op_sel_hi:[1,1]
    v_cvt_pk_bf16_f32 v198, v212, v213
    v_cvt_pk_bf16_f32 v199, v214, v215
    s_add_u32 s37, s55, 8192
    buffer_store_dwordx4 v[196:199], v252, s[28:31], s37 offen offset:2048
    v_mfma_f32_16x16x32_bf16 a[120:123], a[184:187], v[176:179], a[120:123]
    v_mfma_f32_16x16x32_bf16 a[120:123], a[188:191], v[180:183], a[120:123]
    buffer_load_dwordx4 v48, s[20:23], s49 offen offset:2048 lds
    v_mfma_f32_16x16x32_bf16 a[124:127], a[188:191], v[188:191], a[124:127]
    v_accvgpr_read_b32 v208, a88
    v_accvgpr_read_b32 v209, a89
    v_accvgpr_read_b32 v210, a90
    v_accvgpr_read_b32 v211, a91
    v_pk_mul_f32 v[208:209], v[208:209], v[60:61] op_sel:[0,0] op_sel_hi:[1,0]
    v_pk_mul_f32 v[210:211], v[210:211], v[60:61] op_sel:[0,0] op_sel_hi:[1,0]
    v_cvt_pk_bf16_f32 v202, v208, v209
    v_cvt_pk_bf16_f32 v203, v210, v211
    s_add_u32 s37, s55, 4096
    buffer_store_dwordx4 v[200:203], v252, s[28:31], s37 offen offset:2048
    v_mfma_f32_16x16x32_bf16 a[124:127], a[184:187], v[184:187], a[124:127]
    buffer_load_dwordx4 v49, s[20:23], s49 offen offset:3072 lds
    v_accvgpr_read_b32 v212, a92
    v_accvgpr_read_b32 v213, a93
    v_accvgpr_read_b32 v214, a94
    v_accvgpr_read_b32 v215, a95
    v_pk_mul_f32 v[212:213], v[212:213], v[60:61] op_sel:[0,1] op_sel_hi:[1,1]
    v_pk_mul_f32 v[214:215], v[214:215], v[60:61] op_sel:[0,1] op_sel_hi:[1,1]
    v_cvt_pk_bf16_f32 v206, v212, v213
    v_cvt_pk_bf16_f32 v207, v214, v215
    s_add_u32 s37, s55, 12288
    buffer_store_dwordx4 v[204:207], v252, s[28:31], s37 offen offset:2048
    v_or3_b32 v224, v224, v225, v226
    v_or_b32 v224, v224, v227
    s_nop 0
    v_readfirstlane_b32 s36, v224
    v_readfirstlane_b32 s38, v253
    v_min_u32 v8, 1, v1
    v_lshlrev_b32 v8, 31, v8
    v_mov_b32 v10, s95
    s_getreg_b32 s39, hwreg(HW_REG_XCC_ID, 0, 4)
    s_lshl_b32 s39, s39, 28
    s_xor_b32 s39, s39, s95
    s_cmp_eq_u32 s38, s39
    s_cselect_b32 s53, 1, 0
    ds_read_b64_tr_b16 a[208:209], v12 offset:0
    ds_read_b64_tr_b16 a[210:211], v12 offset:4096
    ds_read_b64_tr_b16 a[212:213], v12 offset:8192
    ds_read_b64_tr_b16 a[214:215], v12 offset:12288
    ds_read_b64_tr_b16 a[216:217], v12 offset:16384
    ds_read_b64_tr_b16 a[218:219], v12 offset:20480
    ds_read_b64_tr_b16 a[220:221], v12 offset:24576
    ds_read_b64_tr_b16 a[222:223], v12 offset:28672
    ds_read_b64_tr_b16 a[224:225], v16 offset:0
    ds_read_b64_tr_b16 a[226:227], v16 offset:4096
    ds_read_b64_tr_b16 a[228:229], v16 offset:8192
    ds_read_b64_tr_b16 a[230:231], v16 offset:12288
    ds_read_b64_tr_b16 a[232:233], v16 offset:16384
    ds_read_b64_tr_b16 a[234:235], v16 offset:20480
    ds_read_b64_tr_b16 a[236:237], v16 offset:24576
    ds_read_b64_tr_b16 a[238:239], v16 offset:28672
    s_andn2_b32 s36, s36, s48
    s_cbranch_scc1 Lattn_redo
    v_accvgpr_read_b32 v208, a96
    v_accvgpr_read_b32 v209, a97
    v_accvgpr_read_b32 v210, a98
    v_accvgpr_read_b32 v211, a99
    v_pk_mul_f32 v[208:209], v[208:209], v[58:59] op_sel:[0,0] op_sel_hi:[1,0]
    v_pk_mul_f32 v[210:211], v[210:211], v[58:59] op_sel:[0,0] op_sel_hi:[1,0]
Ltour8:
    s_cbranch_execz Ltour12
    v_cvt_pk_bf16_f32 v176, v208, v209
    v_cvt_pk_bf16_f32 v177, v210, v211
    v_accvgpr_read_b32 v212, a100
    v_accvgpr_read_b32 v213, a101
    v_accvgpr_read_b32 v214, a102
    v_accvgpr_read_b32 v215, a103
    v_pk_mul_f32 v[212:213], v[212:213], v[58:59] op_sel:[0,1] op_sel_hi:[1,1]
    v_pk_mul_f32 v[214:215], v[214:215], v[58:59] op_sel:[0,1] op_sel_hi:[1,1]
    v_cvt_pk_bf16_f32 v180, v212, v213
    v_cvt_pk_bf16_f32 v181, v214, v215
    v_accvgpr_read_b32 v208, a104
    v_accvgpr_read_b32 v209, a105
    v_accvgpr_read_b32 v210, a106
    v_accvgpr_read_b32 v211, a107
    v_pk_mul_f32 v[208:209], v[208:209], v[60:61] op_sel:[0,0] op_sel_hi:[1,0]
    v_pk_mul_f32 v[210:211], v[210:211], v[60:61] op_sel:[0,0] op_sel_hi:[1,0]
    v_cvt_pk_bf16_f32 v184, v208, v209
    v_cvt_pk_bf16_f32 v185, v210, v211
    v_accvgpr_read_b32 v212, a108
    v_accvgpr_read_b32 v213, a109
    v_accvgpr_read_b32 v214, a110
    v_accvgpr_read_b32 v215, a111
    v_pk_mul_f32 v[212:213], v[212:213], v[60:61] op_sel:[0,1] op_sel_hi:[1,1]
    v_pk_mul_f32 v[214:215], v[214:215], v[60:61] op_sel:[0,1] op_sel_hi:[1,1]
    v_cvt_pk_bf16_f32 v188, v212, v213
    v_cvt_pk_bf16_f32 v189, v214, v215
    v_accvgpr_read_b32 v208, a112
    v_accvgpr_read_b32 v209, a113
    v_accvgpr_read_b32 v210, a114
    v_accvgpr_read_b32 v211, a115
    v_pk_mul_f32 v[208:209], v[208:209], v[58:59] op_sel:[0,0] op_sel_hi:[1,0]
    v_pk_mul_f32 v[210:211], v[210:211], v[58:59] op_sel:[0,0] op_sel_hi:[1,0]
    v_cvt_pk_bf16_f32 v178, v208, v209
    v_cvt_pk_bf16_f32 v179, v210, v211
    s_add_u32 s37, s55, 0
    buffer_store_dwordx4 v[176:179], v252, s[28:31], s37 offen offset:3072
    v_accvgpr_read_b32 v212, a116
    v_accvgpr_read_b32 v213, a117
    v_accvgpr_read_b32 v214, a118
    v_accvgpr_read_b32 v215, a119
    v_pk_mul_f32 v[212:213], v[212:213], v[58:59] op_sel:[0,1] op_sel_hi:[1,1]
    v_pk_mul_f32 v[214:215], v[214:215], v[58:59] op_sel:[0,1] op_sel_hi:[1,1]
    v_cvt_pk_bf16_f32 v182, v212, v213
    v_cvt_pk_bf16_f32 v183, v214, v215
    s_add_u32 s37, s55, 8192
    buffer_store_dwordx4 v[180:183], v252, s[28:31], s37 offen offset:3072
    v_accvgpr_read_b32 v208, a120
    v_accvgpr_read_b32 v209, a121
    v_accvgpr_read_b32 v210, a122
    v_accvgpr_read_b32 v211, a123
    v_pk_mul_f32 v[208:209], v[208:209], v[60:61] op_sel:[0,0] op_sel_hi:[1,0]
    v_pk_mul_f32 v[210:211], v[210:211], v[60:61] op_sel:[0,0] op_sel_hi:[1,0]
    v_cvt_pk_bf16_f32 v186, v208, v209
    v_cvt_pk_bf16_f32 v187, v210, v211
    s_add_u32 s37, s55, 4096
    buffer_store_dwordx4 v[184:187], v252, s[28:31], s37 offen offset:3072
    v_accvgpr_read_b32 v212, a124
    v_accvgpr_read_b32 v213, a125
    v_accvgpr_read_b32 v214, a126
    v_accvgpr_read_b32 v215, a127
    v_pk_mul_f32 v[212:213], v[212:213], v[60:61] op_sel:[0,1] op_sel_hi:[1,1]
    v_pk_mul_f32 v[214:215], v[214:215], v[60:61] op_sel:[0,1] op_sel_hi:[1,1]
    v_cvt_pk_bf16_f32 v190, v212, v213
    v_cvt_pk_bf16_f32 v191, v214, v215
    s_add_u32 s37, s55, 12288
    buffer_store_dwordx4 v[188:191], v252, s[28:31], s37 offen offset:3072
    s_waitcnt lgkmcnt(14)
    v_mfma_f32_16x16x32_bf16 v[96:99], a[208:211], v[128:131], 0
    s_waitcnt lgkmcnt(12)
    ds_read_b64_tr_b16 a[160:161], v13 offset:0
    v_mfma_f32_16x16x32_bf16 v[96:99], a[212:215], v[144:147], v[96:99]
    s_waitcnt lgkmcnt(11)
    ds_read_b64_tr_b16 a[162:163], v13 offset:4096
    v_mfma_f32_16x16x32_bf16 v[96:99], a[216:219], v[192:195], v[96:99]
    s_waitcnt lgkmcnt(10)
    ds_read_b64_tr_b16 a[164:165], v13 offset:8192
    v_mfma_f32_16x16x32_bf16 v[96:99], a[220:223], v[176:179], v[96:99]
    s_waitcnt lgkmcnt(9)
    ds_read_b64_tr_b16 a[166:167], v13 offset:12288
    v_mfma_f32_16x16x32_bf16 v[96:99], a[224:227], v[136:139], v[96:99]
    s_waitcnt lgkmcnt(8)
    ds_read_b64_tr_b16 a[168:169], v13 offset:16384
    v_mfma_f32_16x16x32_bf16 v[96:99], a[228:231], v[152:155], v[96:99]
    s_waitcnt lgkmcnt(7)
    ds_read_b64_tr_b16 a[170:171], v13 offset:20480
    v_mfma_f32_16x16x32_bf16 v[96:99], a[232:235], v[200:203], v[96:99]
    s_waitcnt lgkmcnt(6)
    ds_read_b64_tr_b16 a[172:173], v13 offset:24576
    v_mfma_f32_16x16x32_bf16 v[96:99], a[236:239], v[184:187], v[96:99]
    ds_read_b64_tr_b16 a[174:175], v13 offset:28672
    v_mfma_f32_16x16x32_bf16 v[100:103], a[236:239], v[188:191], 0
    ds_read_b64_tr_b16 a[176:177], v17 offset:0
    v_mfma_f32_16x16x32_bf16 v[100:103], a[232:235], v[204:207], v[100:103]
    ds_read_b64_tr_b16 a[178:179], v17 offset:4096
    v_mfma_f32_16x16x32_bf16 v[100:103], a[228:231], v[156:159], v[100:103]
    ds_read_b64_tr_b16 a[180:181], v17 offset:8192
    v_mfma_f32_16x16x32_bf16 v[100:103], a[224:227], v[140:143], v[100:103]
    ds_read_b64_tr_b16 a[182:183], v17 offset:12288
    v_mfma_f32_16x16x32_bf16 v[100:103], a[220:223], v[180:183], v[100:103]
    ds_read_b64_tr_b16 a[184:185], v17 offset:16384
    v_cvt_pk_bf16_f32 v224, v96, v97
    v_mfma_f32_16x16x32_bf16 v[100:103], a[216:219], v[196:199], v[100:103]
    ds_read_b64_tr_b16 a[186:187], v17 offset:20480
    v_cvt_pk_bf16_f32 v225, v98, v99
    v_mfma_f32_16x16x32_bf16 v[100:103], a[212:215], v[148:151], v[100:103]
    ds_read_b64_tr_b16 a[188:189], v17 offset:24576
    v_mfma_f32_16x16x32_bf16 v[100:103], a[208:211], v[132:135], v[100:103]
    s_waitcnt lgkmcnt(13)
    ds_read_b64_tr_b16 a[190:191], v17 offset:28672
    v_mfma_f32_16x16x32_bf16 v[104:107], a[160:163], v[128:131], 0
    s_waitcnt lgkmcnt(12)
    ds_read_b64_tr_b16 a[208:209], v14 offset:0
    v_mfma_f32_16x16x32_bf16 v[104:107], a[164:167], v[144:147], v[104:107]
    s_waitcnt lgkmcnt(11)
    ds_read_b64_tr_b16 a[210:211], v14 offset:4096
    v_mfma_f32_16x16x32_bf16 v[104:107], a[168:171], v[192:195], v[104:107]
    s_waitcnt lgkmcnt(10)
    ds_read_b64_tr_b16 a[212:213], v14 offset:8192
    v_mfma_f32_16x16x32_bf16 v[104:107], a[172:175], v[176:179], v[104:107]
    s_waitcnt lgkmcnt(9)
    ds_read_b64_tr_b16 a[214:215], v14 offset:12288
    v_mfma_f32_16x16x32_bf16 v[104:107], a[176:179], v[136:139], v[104:107]
    s_waitcnt lgkmcnt(8)
    ds_read_b64_tr_b16 a[216:217], v14 offset:16384
    v_cvt_pk_bf16_f32 v228, v100, v101
    v_mfma_f32_16x16x32_bf16 v[104:107], a[180:183], v[152:155], v[104:107]
    s_waitcnt lgkmcnt(7)
    ds_read_b64_tr_b16 a[218:219], v14 offset:20480
    v_cvt_pk_bf16_f32 v229, v102, v103
    v_mfma_f32_16x16x32_bf16 v[104:107], a[184:187], v[200:203], v[104:107]
    s_waitcnt lgkmcnt(6)
    ds_read_b64_tr_b16 a[220:221], v14 offset:24576
    v_mfma_f32_16x16x32_bf16 v[104:107], a[188:191], v[184:187], v[104:107]
    ds_read_b64_tr_b16 a[222:223], v14 offset:28672
    s_waitcnt vmcnt(0)
    s_cmp_eq_u32 s53, 0
    s_cbranch_scc1 Lattn_wb
Lattn_wbdone:
    v_mfma_f32_16x16x32_bf16 v[108:111], a[188:191], v[188:191], 0
    buffer_store_dword v10, v8, s[24:27], s92 offen offset:8 sc1
    v_mfma_f32_16x16x32_bf16 v[108:111], a[184:187], v[204:207], v[108:111]
    s_xor_b32 s55, s55, 65536
    ds_read_b64_tr_b16 a[224:225], v18 offset:0
    ds_read_b64_tr_b16 a[226:227], v18 offset:4096
    v_mfma_f32_16x16x32_bf16 v[108:111], a[180:183], v[156:159], v[108:111]
    buffer_atomic_add v241, v240, s[88:91], 0 offen sc1
    v_mfma_f32_16x16x32_bf16 v[108:111], a[176:179], v[140:143], v[108:111]
    ds_read_b64_tr_b16 a[228:229], v18 offset:8192
    ds_read_b64_tr_b16 a[230:231], v18 offset:12288
    s_load_dwordx2 s[12:13], s[0:1], 0
    v_mfma_f32_16x16x32_bf16 v[108:111], a[172:175], v[180:183], v[108:111]
    ds_read_b64_tr_b16 a[232:233], v18 offset:16384
    v_cvt_pk_bf16_f32 v226, v104, v105
    v_mfma_f32_16x16x32_bf16 v[108:111], a[168:171], v[196:199], v[108:111]
    s_add_u32 s38, s56, 16384
    ds_read_b64_tr_b16 a[234:235], v18 offset:20480
    v_cvt_pk_bf16_f32 v227, v106, v107
    s_load_dwordx2 s[16:17], s[0:1], 96
    v_mfma_f32_16x16x32_bf16 v[108:111], a[164:167], v[148:151], v[108:111]
    buffer_store_dwordx4 v[224:227], v56, s[28:31], s38 offen sc1
    v_mfma_f32_16x16x32_bf16 v[108:111], a[160:163], v[132:135], v[108:111]
    s_waitcnt lgkmcnt(12)
    ds_read_b64_tr_b16 a[236:237], v18 offset:24576
    ds_read_b64_tr_b16 a[238:239], v18 offset:28672
    s_load_dwordx2 s[52:53], s[0:1], 48
    v_mfma_f32_16x16x32_bf16 v[112:115], a[208:211], v[128:131], 0
    s_waitcnt lgkmcnt(12)
    ds_read_b64_tr_b16 a[160:161], v15 offset:0
    v_mfma_f32_16x16x32_bf16 v[112:115], a[212:215], v[144:147], v[112:115]
    s_waitcnt lgkmcnt(11)
    ds_read_b64_tr_b16 a[162:163], v15 offset:4096
    v_mfma_f32_16x16x32_bf16 v[112:115], a[216:219], v[192:195], v[112:115]
    s_waitcnt lgkmcnt(10)
    ds_read_b64_tr_b16 a[164:165], v15 offset:8192
    v_mfma_f32_16x16x32_bf16 v[112:115], a[220:223], v[176:179], v[112:115]
    s_waitcnt lgkmcnt(9)
    ds_read_b64_tr_b16 a[166:167], v15 offset:12288
    v_mfma_f32_16x16x32_bf16 v[112:115], a[224:227], v[136:139], v[112:115]
    s_waitcnt lgkmcnt(8)
    ds_read_b64_tr_b16 a[168:169], v15 offset:16384
    v_cvt_pk_bf16_f32 v230, v108, v109
    v_mfma_f32_16x16x32_bf16 v[112:115], a[228:231], v[152:155], v[112:115]
    s_waitcnt lgkmcnt(7)
    s_add_u32 s38, s56, 180224
    ds_read_b64_tr_b16 a[170:171], v15 offset:20480
    v_cvt_pk_bf16_f32 v231, v110, v111
    v_mfma_f32_16x16x32_bf16 v[112:115], a[232:235], v[200:203], v[112:115]
    s_waitcnt lgkmcnt(6)
    buffer_store_dwordx4 v[228:231], v56, s[28:31], s38 offen sc1
    v_mfma_f32_16x16x32_bf16 v[112:115], a[236:239], v[184:187], v[112:115]
    ds_read_b64_tr_b16 a[172:173], v15 offset:24576
    ds_read_b64_tr_b16 a[174:175], v15 offset:28672
    v_mfma_f32_16x16x32_bf16 v[116:119], a[236:239], v[188:191], 0
    ds_read_b64_tr_b16 a[176:177], v19 offset:0
    v_mfma_f32_16x16x32_bf16 v[116:119], a[232:235], v[204:207], v[116:119]
    ds_read_b64_tr_b16 a[178:179], v19 offset:4096
    v_mfma_f32_16x16x32_bf16 v[116:119], a[228:231], v[156:159], v[116:119]
    ds_read_b64_tr_b16 a[180:181], v19 offset:8192
    v_mfma_f32_16x16x32_bf16 v[116:119], a[224:227], v[140:143], v[116:119]
    ds_read_b64_tr_b16 a[182:183], v19 offset:12288
    v_mfma_f32_16x16x32_bf16 v[116:119], a[220:223], v[180:183], v[116:119]
    ds_read_b64_tr_b16 a[184:185], v19 offset:16384
    v_cvt_pk_bf16_f32 v232, v112, v113
    v_mfma_f32_16x16x32_bf16 v[116:119], a[216:219], v[196:199], v[116:119]
    ds_read_b64_tr_b16 a[186:187], v19 offset:20480
    v_cvt_pk_bf16_f32 v233, v114, v115
    v_mfma_f32_16x16x32_bf16 v[116:119], a[212:215], v[148:151], v[116:119]
    ds_read_b64_tr_b16 a[188:189], v19 offset:24576
    v_mfma_f32_16x16x32_bf16 v[116:119], a[208:211], v[132:135], v[116:119]
    s_waitcnt lgkmcnt(13)
    ds_read_b64_tr_b16 a[190:191], v19 offset:28672
    s_barrier
    v_mfma_f32_16x16x32_bf16 v[120:123], a[160:163], v[128:131], 0
    s_waitcnt lgkmcnt(12)
    buffer_load_dword v11, v8, s[24:27], s54 offen offset:8 sc1
    v_mfma_f32_16x16x32_bf16 v[120:123], a[164:167], v[144:147], v[120:123]
    s_waitcnt lgkmcnt(10)
    ds_read_b64_tr_b16 a[208:209], v20 offset:0
    ds_read_b64_tr_b16 a[210:211], v20 offset:4096
    v_mfma_f32_16x16x32_bf16 v[120:123], a[168:171], v[192:195], v[120:123]
    s_waitcnt lgkmcnt(10)
    ds_read_b64_tr_b16 a[212:213], v20 offset:8192
    v_mfma_f32_16x16x32_bf16 v[120:123], a[172:175], v[176:179], v[120:123]
    s_waitcnt lgkmcnt(9)
    ds_read_b64_tr_b16 a[214:215], v20 offset:12288
    v_mfma_f32_16x16x32_bf16 v[120:123], a[176:179], v[136:139], v[120:123]
    s_waitcnt lgkmcnt(8)
    ds_read_b64_tr_b16 a[216:217], v20 offset:16384
    v_cvt_pk_bf16_f32 v236, v116, v117
    v_mfma_f32_16x16x32_bf16 v[120:123], a[180:183], v[152:155], v[120:123]
    s_waitcnt lgkmcnt(7)
    ds_read_b64_tr_b16 a[218:219], v20 offset:20480
    v_cvt_pk_bf16_f32 v237, v118, v119
    v_mfma_f32_16x16x32_bf16 v[120:123], a[184:187], v[200:203], v[120:123]
    s_waitcnt lgkmcnt(6)
    s_add_u32 s49, s46, 73728
    ds_read_b64_tr_b16 a[220:221], v20 offset:24576
    v_mfma_f32_16x16x32_bf16 v[120:123], a[188:191], v[184:187], v[120:123]
    s_add_u32 m0, s42, 114688
    ds_read_b64_tr_b16 a[222:223], v20 offset:28672
    v_mfma_f32_16x16x32_bf16 v[124:127], a[188:191], v[188:191], 0
    buffer_load_dwordx4 v46, s[20:23], s49 offen lds
    v_mfma_f32_16x16x32_bf16 v[124:127], a[184:187], v[204:207], v[124:127]
    ds_read_b64_tr_b16 a[224:225], v24 offset:0
    ds_read_b64_tr_b16 a[226:227], v24 offset:4096
    v_mfma_f32_16x16x32_bf16 v[124:127], a[180:183], v[156:159], v[124:127]
    buffer_load_dwordx4 v47, s[20:23], s49 offen offset:1024 lds
    v_mfma_f32_16x16x32_bf16 v[124:127], a[176:179], v[140:143], v[124:127]
    ds_read_b64_tr_b16 a[228:229], v24 offset:8192
    ds_read_b64_tr_b16 a[230:231], v24 offset:12288
    v_mfma_f32_16x16x32_bf16 v[124:127], a[172:175], v[180:183], v[124:127]
    ds_read_b64_tr_b16 a[232:233], v24 offset:16384
    v_cvt_pk_bf16_f32 v234, v120, v121
    v_mfma_f32_16x16x32_bf16 v[124:127], a[168:171], v[196:199], v[124:127]
    s_add_u32 s38, s56, 16512
    ds_read_b64_tr_b16 a[234:235], v24 offset:20480
    v_cvt_pk_bf16_f32 v235, v122, v123
    v_mfma_f32_16x16x32_bf16 v[124:127], a[164:167], v[148:151], v[124:127]
    buffer_store_dwordx4 v[232:235], v56, s[28:31], s38 offen sc1
    v_mfma_f32_16x16x32_bf16 v[124:127], a[160:163], v[132:135], v[124:127]
    s_waitcnt lgkmcnt(12)
    ds_read_b64_tr_b16 a[236:237], v24 offset:24576
    ds_read_b64_tr_b16 a[238:239], v24 offset:28672
    v_mfma_f32_16x16x32_bf16 v[64:67], a[208:211], v[128:131], 0
    s_waitcnt lgkmcnt(12)
    buffer_load_dwordx4 v48, s[20:23], s49 offen offset:2048 lds
    v_mfma_f32_16x16x32_bf16 v[64:67], a[212:215], v[144:147], v[64:67]
    s_waitcnt lgkmcnt(10)
    ds_read_b64_tr_b16 a[160:161], v21 offset:0
    ds_read_b64_tr_b16 a[162:163], v21 offset:4096
    v_mfma_f32_16x16x32_bf16 v[64:67], a[216:219], v[192:195], v[64:67]
    s_waitcnt lgkmcnt(10)
    buffer_load_dwordx4 v49, s[20:23], s49 offen offset:3072 lds
    v_mfma_f32_16x16x32_bf16 v[64:67], a[220:223], v[176:179], v[64:67]
    s_waitcnt lgkmcnt(8)
    ds_read_b64_tr_b16 a[164:165], v21 offset:8192
    ds_read_b64_tr_b16 a[166:167], v21 offset:12288
    v_mfma_f32_16x16x32_bf16 v[64:67], a[224:227], v[136:139], v[64:67]
    s_waitcnt lgkmcnt(8)
    ds_read_b64_tr_b16 a[168:169], v21 offset:16384
    v_cvt_pk_bf16_f32 v238, v124, v125
    v_mfma_f32_16x16x32_bf16 v[64:67], a[228:231], v[152:155], v[64:67]
    s_waitcnt lgkmcnt(7)
    s_add_u32 s38, s56, 180352
    ds_read_b64_tr_b16 a[170:171], v21 offset:20480
    v_cvt_pk_bf16_f32 v239, v126, v127
    v_mfma_f32_16x16x32_bf16 v[64:67], a[232:235], v[200:203], v[64:67]
    s_waitcnt lgkmcnt(6)
    buffer_store_dwordx4 v[236:239], v56, s[28:31], s38 offen sc1
    v_mfma_f32_16x16x32_bf16 v[64:67], a[236:239], v[184:187], v[64:67]
    ds_read_b64_tr_b16 a[172:173], v21 offset:24576
    ds_read_b64_tr_b16 a[174:175], v21 offset:28672
    v_mfma_f32_16x16x32_bf16 v[68:71], a[236:239], v[188:191], 0
    s_lshl_b32 s40, s5, 4
    ds_read_b64_tr_b16 a[176:177], v25 offset:0
    v_mfma_f32_16x16x32_bf16 v[68:71], a[232:235], v[204:207], v[68:71]
    s_add_u32 s40, s40, s4
    ds_read_b64_tr_b16 a[178:179], v25 offset:4096
    v_and_b32 v240, 31, v1
    v_mfma_f32_16x16x32_bf16 v[68:71], a[228:231], v[156:159], v[68:71]
    ds_read_b64_tr_b16 a[180:181], v25 offset:8192
    v_lshrrev_b32 v241, 5, v1
    v_mfma_f32_16x16x32_bf16 v[68:71], a[224:227], v[140:143], v[68:71]
    ds_read_b64_tr_b16 a[182:183], v25 offset:12288
    v_cmp_gt_u32 vcc, 8, v240
    v_mfma_f32_16x16x32_bf16 v[68:71], a[220:223], v[180:183], v[68:71]
    ds_read_b64_tr_b16 a[184:185], v25 offset:16384
    v_mov_b32 v242, 2147483648
    v_mfma_f32_16x16x32_bf16 v[68:71], a[216:219], v[196:199], v[68:71]
    s_lshl_b32 s43, s40, 3
    ds_read_b64_tr_b16 a[186:187], v25 offset:20480
    v_mfma_f32_16x16x32_bf16 v[68:71], a[212:215], v[148:151], v[68:71]
    s_lshl_b32 s44, s3, 1
    ds_read_b64_tr_b16 a[188:189], v25 offset:24576
    v_mfma_f32_16x16x32_bf16 v[68:71], a[208:211], v[132:135], v[68:71]
    s_waitcnt lgkmcnt(13)
    s_add_u32 s43, s43, s44
    ds_read_b64_tr_b16 a[190:191], v25 offset:28672
    v_cndmask_b32 v242, v242, 0, vcc
    v_mfma_f32_16x16x32_bf16 v[72:75], a[160:163], v[128:131], 0
    s_waitcnt lgkmcnt(12)
    ds_read_b64_tr_b16 a[208:209], v22 offset:0
    v_add_u32 v7, s43, v241
    v_mfma_f32_16x16x32_bf16 v[72:75], a[164:167], v[144:147], v[72:75]
    s_waitcnt lgkmcnt(11)
    ds_read_b64_tr_b16 a[210:211], v22 offset:4096
    v_lshlrev_b32 v5, 4, v240
    v_mfma_f32_16x16x32_bf16 v[72:75], a[168:171], v[192:195], v[72:75]
    s_waitcnt lgkmcnt(10)
    ds_read_b64_tr_b16 a[212:213], v22 offset:8192
    v_lshlrev_b32 v243, 4, v241
    v_mfma_f32_16x16x32_bf16 v[72:75], a[172:175], v[176:179], v[72:75]
    s_waitcnt lgkmcnt(9)
    ds_read_b64_tr_b16 a[214:215], v22 offset:12288
    v_lshl_add_u32 v2, v240, 5, v243
    v_mfma_f32_16x16x32_bf16 v[72:75], a[176:179], v[136:139], v[72:75]
    s_waitcnt lgkmcnt(8)
    ds_read_b64_tr_b16 a[216:217], v22 offset:16384
    v_lshrrev_b32 v243, 4, v240
    v_mfma_f32_16x16x32_bf16 v[72:75], a[180:183], v[152:155], v[72:75]
    s_waitcnt lgkmcnt(7)
    ds_read_b64_tr_b16 a[218:219], v22 offset:20480
    v_mul_u32_u24 v243, 1536, v243
    v_mfma_f32_16x16x32_bf16 v[72:75], a[184:187], v[200:203], v[72:75]
    s_waitcnt lgkmcnt(6)
    ds_read_b64_tr_b16 a[220:221], v22 offset:24576
    v_add_u32 v2, v2, v243
    v_mfma_f32_16x16x32_bf16 v[72:75], a[188:191], v[184:187], v[72:75]
    s_mul_i32 s44, s43, 10240
    ds_read_b64_tr_b16 a[222:223], v22 offset:28672
    v_lshrrev_b32 v243, 2, v240
    v_mfma_f32_16x16x32_bf16 v[76:79], a[188:191], v[188:191], 0
    ds_read_b64_tr_b16 a[224:225], v26 offset:0
    v_lshlrev_b32 v243, 6, v243
    v_mfma_f32_16x16x32_bf16 v[76:79], a[184:187], v[204:207], v[76:79]
    ds_read_b64_tr_b16 a[226:227], v26 offset:4096
    v_and_b32 v241, 3, v240
    v_mfma_f32_16x16x32_bf16 v[76:79], a[180:183], v[156:159], v[76:79]
    ds_read_b64_tr_b16 a[228:229], v26 offset:8192
    v_lshl_add_u32 v3, v241, 3, v243
    v_mfma_f32_16x16x32_bf16 v[76:79], a[176:179], v[140:143], v[76:79]
    ds_read_b64_tr_b16 a[230:231], v26 offset:12288
    v_mul_u32_u24 v243, 1152, v7
    v_mfma_f32_16x16x32_bf16 v[76:79], a[172:175], v[180:183], v[76:79]
    ds_read_b64_tr_b16 a[232:233], v26 offset:16384
    v_add_u32 v4, v243, v3
    v_mfma_f32_16x16x32_bf16 v[76:79], a[168:171], v[196:199], v[76:79]
    ds_read_b64_tr_b16 a[234:235], v26 offset:20480
    v_lshl_add_u32 v6, v243, 1, v5
    v_mfma_f32_16x16x32_bf16 v[76:79], a[164:167], v[148:151], v[76:79]
    ds_read_b64_tr_b16 a[236:237], v26 offset:24576
    v_or_b32 v55, v3, v242
    v_mfma_f32_16x16x32_bf16 v[76:79], a[160:163], v[132:135], v[76:79]
    s_waitcnt lgkmcnt(13)
    ds_read_b64_tr_b16 a[238:239], v26 offset:28672
    v_or_b32 v58, v4, v242
    v_mfma_f32_16x16x32_bf16 v[80:83], a[208:211], v[128:131], 0
    s_waitcnt lgkmcnt(12)
    ds_read_b64_tr_b16 a[160:161], v23 offset:0
    v_or_b32 v59, v5, v242
    v_mfma_f32_16x16x32_bf16 v[80:83], a[212:215], v[144:147], v[80:83]
    s_waitcnt lgkmcnt(11)
    ds_read_b64_tr_b16 a[162:163], v23 offset:4096
    v_or_b32 v60, v6, v242
    v_mfma_f32_16x16x32_bf16 v[80:83], a[216:219], v[192:195], v[80:83]
    s_waitcnt lgkmcnt(10)
    ds_read_b64_tr_b16 a[164:165], v23 offset:8192
    s_waitcnt vmcnt(6)
    v_readfirstlane_b32 s36, v11
    v_mfma_f32_16x16x32_bf16 v[80:83], a[220:223], v[176:179], v[80:83]
    s_waitcnt lgkmcnt(9)
    ds_read_b64_tr_b16 a[166:167], v23 offset:12288
    v_lshrrev_b32 v243, 4, v1
    v_mfma_f32_16x16x32_bf16 v[80:83], a[224:227], v[136:139], v[80:83]
    ds_read_b64_tr_b16 a[168:169], v23 offset:16384
    v_lshlrev_b32 v243, 8, v243
    s_cmp_lg_u32 s36, s95
    s_cbranch_scc1 Lattn_xspin
Lattn_xgot:
    s_waitcnt lgkmcnt(9)
    v_mfma_f32_16x16x32_bf16 v[80:83], a[228:231], v[152:155], v[80:83]
    s_waitcnt lgkmcnt(7)
    ds_read_b64_tr_b16 a[170:171], v23 offset:20480
    v_and_b32 v241, 7, v1
    v_mfma_f32_16x16x32_bf16 v[80:83], a[232:235], v[200:203], v[80:83]
    s_waitcnt lgkmcnt(6)
    ds_read_b64_tr_b16 a[172:173], v23 offset:24576
    v_lshl_add_u32 v243, v241, 5, v243
    v_mfma_f32_16x16x32_bf16 v[80:83], a[236:239], v[184:187], v[80:83]
    s_add_u32 s37, s55, 0
    ds_read_b64_tr_b16 a[174:175], v23 offset:28672
    v_and_b32 v241, 8, v1
    v_mfma_f32_16x16x32_bf16 v[84:87], a[236:239], v[188:191], 0
    buffer_load_dwordx4 a[64:67], v252, s[28:31], s37 offen offset:0 sc1
    v_mfma_f32_16x16x32_bf16 v[84:87], a[232:235], v[204:207], v[84:87]
    ds_read_b64_tr_b16 a[176:177], v27 offset:0
    ds_read_b64_tr_b16 a[178:179], v27 offset:4096
    v_mfma_f32_16x16x32_bf16 v[84:87], a[228:231], v[156:159], v[84:87]
    buffer_load_dwordx4 a[68:71], v252, s[28:31], s37 offen offset:1024 sc1
    v_mfma_f32_16x16x32_bf16 v[84:87], a[224:227], v[140:143], v[84:87]
    ds_read_b64_tr_b16 a[180:181], v27 offset:8192
    ds_read_b64_tr_b16 a[182:183], v27 offset:12288
    v_mfma_f32_16x16x32_bf16 v[84:87], a[220:223], v[180:183], v[84:87]
    ds_read_b64_tr_b16 a[184:185], v27 offset:16384
    v_lshl_add_u32 v54, v241, 1, v243
    v_mfma_f32_16x16x32_bf16 v[84:87], a[216:219], v[196:199], v[84:87]
    s_lshr_b32 s41, s2, 3
    ds_read_b64_tr_b16 a[186:187], v27 offset:20480
    v_mfma_f32_16x16x32_bf16 v[84:87], a[212:215], v[148:151], v[84:87]
    buffer_load_dwordx4 a[72:75], v252, s[28:31], s37 offen offset:2048 sc1
    v_mfma_f32_16x16x32_bf16 v[84:87], a[208:211], v[132:135], v[84:87]
    s_waitcnt lgkmcnt(12)
    s_mov_b32 s14, 2359296
    ds_read_b64_tr_b16 a[188:189], v27 offset:24576
    ds_read_b64_tr_b16 a[190:191], v27 offset:28672
    s_barrier
    v_mfma_f32_16x16x32_bf16 v[88:91], a[160:163], v[128:131], 0
    s_waitcnt lgkmcnt(12)
    s_mov_b32 s15, 0x20000
    ds_read_b64_tr_b16 a[208:209], v12 offset:32768
    v_mfma_f32_16x16x32_bf16 v[88:91], a[164:167], v[144:147], v[88:91]
    s_waitcnt lgkmcnt(11)
    s_mov_b32 s18, 2359296
    ds_read_b64_tr_b16 a[210:211], v12 offset:36864
    v_mfma_f32_16x16x32_bf16 v[88:91], a[168:171], v[192:195], v[88:91]
    s_waitcnt lgkmcnt(10)
    buffer_load_dwordx4 a[76:79], v252, s[28:31], s37 offen offset:3072 sc1
    v_mfma_f32_16x16x32_bf16 v[88:91], a[172:175], v[176:179], v[88:91]
    s_waitcnt lgkmcnt(8)
    s_mov_b32 s19, 0x20000
    ds_read_b64_tr_b16 a[212:213], v12 offset:40960
    ds_read_b64_tr_b16 a[214:215], v12 offset:45056
    v_mfma_f32_16x16x32_bf16 v[88:91], a[176:179], v[136:139], v[88:91]
    s_waitcnt lgkmcnt(8)
    s_add_u32 s8, s50, 7864320
    s_addc_u32 s9, s51, 0
    ds_read_b64_tr_b16 a[216:217], v12 offset:49152
    v_mfma_f32_16x16x32_bf16 v[88:91], a[180:183], v[152:155], v[88:91]
    s_waitcnt lgkmcnt(7)
    s_add_u32 s37, s55, 4096
    ds_read_b64_tr_b16 a[218:219], v12 offset:53248
    v_mfma_f32_16x16x32_bf16 v[88:91], a[184:187], v[200:203], v[88:91]
    s_waitcnt lgkmcnt(6)
    s_add_u32 s49, s46, 256
    buffer_load_dwordx4 a[80:83], v252, s[28:31], s37 offen offset:0 sc1
    v_mfma_f32_16x16x32_bf16 v[88:91], a[188:191], v[184:187], v[88:91]
    s_add_u32 m0, s42, 0
    ds_read_b64_tr_b16 a[220:221], v12 offset:57344
    ds_read_b64_tr_b16 a[222:223], v12 offset:61440
    v_mfma_f32_16x16x32_bf16 v[92:95], a[188:191], v[188:191], 0
    buffer_load_dwordx4 v46, s[20:23], s49 offen lds
    v_mfma_f32_16x16x32_bf16 v[92:95], a[184:187], v[204:207], v[92:95]
    s_mov_b32 s10, 663552
    ds_read_b64_tr_b16 a[224:225], v16 offset:32768
    ds_read_b64_tr_b16 a[226:227], v16 offset:36864
    v_mfma_f32_16x16x32_bf16 v[92:95], a[180:183], v[156:159], v[92:95]
    buffer_load_dwordx4 v47, s[20:23], s49 offen offset:1024 lds
    v_mfma_f32_16x16x32_bf16 v[92:95], a[176:179], v[140:143], v[92:95]
    s_mov_b32 s11, 0x20000
    ds_read_b64_tr_b16 a[228:229], v16 offset:40960
    ds_read_b64_tr_b16 a[230:231], v16 offset:45056
    v_mfma_f32_16x16x32_bf16 v[92:95], a[172:175], v[180:183], v[92:95]
    buffer_load_dwordx4 a[84:87], v252, s[28:31], s37 offen offset:1024 sc1
    v_mfma_f32_16x16x32_bf16 v[92:95], a[168:171], v[196:199], v[92:95]
    s_lshl_b32 s39, s5, 13
    ds_read_b64_tr_b16 a[232:233], v16 offset:49152
    ds_read_b64_tr_b16 a[234:235], v16 offset:53248
    v_mfma_f32_16x16x32_bf16 v[92:95], a[164:167], v[148:151], v[92:95]
    s_add_u32 s39, s39, 8781824
    ds_read_b64_tr_b16 a[236:237], v16 offset:57344
    v_mfma_f32_16x16x32_bf16 v[92:95], a[160:163], v[132:135], v[92:95]
    s_waitcnt lgkmcnt(13)
    s_lshr_b32 s45, s4, 2
    ds_read_b64_tr_b16 a[238:239], v16 offset:61440
    v_mfma_f32_16x16x32_bf16 v[96:99], a[208:211], v[128:131], 0
    s_waitcnt lgkmcnt(12)
    buffer_load_dwordx4 v48, s[20:23], s49 offen offset:2048 lds
    v_mfma_f32_16x16x32_bf16 v[96:99], a[212:215], v[144:147], v[96:99]
    s_waitcnt lgkmcnt(10)
    s_lshl_b32 s45, s45, 11
    ds_read_b64_tr_b16 a[160:161], v13 offset:32768
    ds_read_b64_tr_b16 a[162:163], v13 offset:36864
    v_mfma_f32_16x16x32_bf16 v[96:99], a[216:219], v[192:195], v[96:99]
    s_waitcnt lgkmcnt(10)
    buffer_load_dwordx4 v49, s[20:23], s49 offen offset:3072 lds
    v_mfma_f32_16x16x32_bf16 v[96:99], a[220:223], v[176:179], v[96:99]
    s_waitcnt lgkmcnt(8)
    s_add_u32 s39, s39, s45
    ds_read_b64_tr_b16 a[164:165], v13 offset:40960
    ds_read_b64_tr_b16 a[166:167], v13 offset:45056
    v_mfma_f32_16x16x32_bf16 v[96:99], a[224:227], v[136:139], v[96:99]
    s_waitcnt lgkmcnt(8)
    buffer_load_dwordx4 a[88:91], v252, s[28:31], s37 offen offset:2048 sc1
    v_mfma_f32_16x16x32_bf16 v[96:99], a[228:231], v[152:155], v[96:99]
    s_waitcnt lgkmcnt(6)
    ds_read_b64_tr_b16 a[168:169], v13 offset:49152
    ds_read_b64_tr_b16 a[170:171], v13 offset:53248
    v_mfma_f32_16x16x32_bf16 v[96:99], a[232:235], v[200:203], v[96:99]
    s_waitcnt lgkmcnt(6)
    s_add_u32 s49, s46, 73984
    ds_read_b64_tr_b16 a[172:173], v13 offset:57344
    v_and_b32 v9, 15, v1
    v_mfma_f32_16x16x32_bf16 v[96:99], a[236:239], v[184:187], v[96:99]
    s_add_u32 m0, s42, 16384
    ds_read_b64_tr_b16 a[174:175], v13 offset:61440
    v_lshlrev_b32 v9, 7, v9
    v_mfma_f32_16x16x32_bf16 v[100:103], a[236:239], v[188:191], 0
    buffer_load_dwordx4 v46, s[20:23], s49 offen lds
    v_mfma_f32_16x16x32_bf16 v[100:103], a[232:235], v[204:207], v[100:103]
    ds_read_b64_tr_b16 a[176:177], v17 offset:32768
    ds_read_b64_tr_b16 a[178:179], v17 offset:36864
    v_mfma_f32_16x16x32_bf16 v[100:103], a[228:231], v[156:159], v[100:103]
    buffer_load_dwordx4 v47, s[20:23], s49 offen offset:1024 lds
    v_mfma_f32_16x16x32_bf16 v[100:103], a[224:227], v[140:143], v[100:103]
    ds_read_b64_tr_b16 a[180:181], v17 offset:40960
    ds_read_b64_tr_b16 a[182:183], v17 offset:45056
    v_mfma_f32_16x16x32_bf16 v[100:103], a[220:223], v[180:183], v[100:103]
    buffer_load_dwordx4 a[92:95], v252, s[28:31], s37 offen offset:3072 sc1
    v_mfma_f32_16x16x32_bf16 v[100:103], a[216:219], v[196:199], v[100:103]
    ds_read_b64_tr_b16 a[184:185], v17 offset:49152
    ds_read_b64_tr_b16 a[186:187], v17 offset:53248
    v_mfma_f32_16x16x32_bf16 v[100:103], a[212:215], v[148:151], v[100:103]
    ds_read_b64_tr_b16 a[188:189], v17 offset:57344
    v_mfma_f32_16x16x32_bf16 v[100:103], a[208:211], v[132:135], v[100:103]
    s_waitcnt lgkmcnt(13)
    ds_read_b64_tr_b16 a[190:191], v17 offset:61440
    v_mfma_f32_16x16x32_bf16 v[104:107], a[160:163], v[128:131], 0
    s_waitcnt lgkmcnt(12)
    buffer_load_dwordx4 v48, s[20:23], s49 offen offset:2048 lds
    v_mfma_f32_16x16x32_bf16 v[104:107], a[164:167], v[144:147], v[104:107]
    s_waitcnt lgkmcnt(10)
    ds_read_b64_tr_b16 a[208:209], v14 offset:32768
    ds_read_b64_tr_b16 a[210:211], v14 offset:36864
    v_mfma_f32_16x16x32_bf16 v[104:107], a[168:171], v[192:195], v[104:107]
    s_waitcnt lgkmcnt(10)
    buffer_load_dwordx4 v49, s[20:23], s49 offen offset:3072 lds
    v_mfma_f32_16x16x32_bf16 v[104:107], a[172:175], v[176:179], v[104:107]
    s_waitcnt lgkmcnt(8)
    s_add_u32 s37, s55, 8192
    ds_read_b64_tr_b16 a[212:213], v14 offset:40960
    ds_read_b64_tr_b16 a[214:215], v14 offset:45056
    v_mfma_f32_16x16x32_bf16 v[104:107], a[176:179], v[136:139], v[104:107]
    s_waitcnt lgkmcnt(8)
    buffer_load_dwordx4 a[96:99], v252, s[28:31], s37 offen offset:0 sc1
    v_mfma_f32_16x16x32_bf16 v[104:107], a[180:183], v[152:155], v[104:107]
    s_waitcnt lgkmcnt(6)
    ds_read_b64_tr_b16 a[216:217], v14 offset:49152
    ds_read_b64_tr_b16 a[218:219], v14 offset:53248
    v_mfma_f32_16x16x32_bf16 v[104:107], a[184:187], v[200:203], v[104:107]
    s_waitcnt lgkmcnt(6)
    buffer_load_dwordx4 a[100:103], v252, s[28:31], s37 offen offset:1024 sc1
    v_mfma_f32_16x16x32_bf16 v[104:107], a[188:191], v[184:187], v[104:107]
Ltour9:
    s_cbranch_execz Ltour13
    ds_read_b64_tr_b16 a[220:221], v14 offset:57344
    ds_read_b64_tr_b16 a[222:223], v14 offset:61440
    v_mfma_f32_16x16x32_bf16 v[108:111], a[188:191], v[188:191], 0
    ds_read_b64_tr_b16 a[224:225], v18 offset:32768
    v_mfma_f32_16x16x32_bf16 v[108:111], a[184:187], v[204:207], v[108:111]
    ds_read_b64_tr_b16 a[226:227], v18 offset:36864
    v_mfma_f32_16x16x32_bf16 v[108:111], a[180:183], v[156:159], v[108:111]
    buffer_load_dwordx4 a[104:107], v252, s[28:31], s37 offen offset:2048 sc1
    v_mfma_f32_16x16x32_bf16 v[108:111], a[176:179], v[140:143], v[108:111]
    ds_read_b64_tr_b16 a[228:229], v18 offset:40960
    ds_read_b64_tr_b16 a[230:231], v18 offset:45056
    v_mfma_f32_16x16x32_bf16 v[108:111], a[172:175], v[180:183], v[108:111]
    ds_read_b64_tr_b16 a[232:233], v18 offset:49152
    v_mfma_f32_16x16x32_bf16 v[108:111], a[168:171], v[196:199], v[108:111]
    ds_read_b64_tr_b16 a[234:235], v18 offset:53248
    v_mfma_f32_16x16x32_bf16 v[108:111], a[164:167], v[148:151], v[108:111]
    buffer_load_dwordx4 a[108:111], v252, s[28:31], s37 offen offset:3072 sc1
    v_mfma_f32_16x16x32_bf16 v[108:111], a[160:163], v[132:135], v[108:111]
    s_waitcnt lgkmcnt(12)
    ds_read_b64_tr_b16 a[236:237], v18 offset:57344
    ds_read_b64_tr_b16 a[238:239], v18 offset:61440
    v_mfma_f32_16x16x32_bf16 v[112:115], a[208:211], v[128:131], 0
    s_waitcnt lgkmcnt(12)
    ds_read_b64_tr_b16 a[160:161], v15 offset:32768
    v_mfma_f32_16x16x32_bf16 v[112:115], a[212:215], v[144:147], v[112:115]
    s_waitcnt lgkmcnt(11)
    s_add_u32 s37, s55, 12288
    ds_read_b64_tr_b16 a[162:163], v15 offset:36864
    v_mfma_f32_16x16x32_bf16 v[112:115], a[216:219], v[192:195], v[112:115]
    s_waitcnt lgkmcnt(10)
    buffer_load_dwordx4 a[112:115], v252, s[28:31], s37 offen offset:0 sc1
    v_mfma_f32_16x16x32_bf16 v[112:115], a[220:223], v[176:179], v[112:115]
    s_waitcnt lgkmcnt(8)
    ds_read_b64_tr_b16 a[164:165], v15 offset:40960
    ds_read_b64_tr_b16 a[166:167], v15 offset:45056
    v_mfma_f32_16x16x32_bf16 v[112:115], a[224:227], v[136:139], v[112:115]
    s_waitcnt lgkmcnt(8)
    buffer_load_dwordx4 a[116:119], v252, s[28:31], s37 offen offset:1024 sc1
    v_mfma_f32_16x16x32_bf16 v[112:115], a[228:231], v[152:155], v[112:115]
    s_waitcnt lgkmcnt(6)
    ds_read_b64_tr_b16 a[168:169], v15 offset:49152
    ds_read_b64_tr_b16 a[170:171], v15 offset:53248
    v_mfma_f32_16x16x32_bf16 v[112:115], a[232:235], v[200:203], v[112:115]
    s_waitcnt lgkmcnt(6)
    ds_read_b64_tr_b16 a[172:173], v15 offset:57344
    v_mfma_f32_16x16x32_bf16 v[112:115], a[236:239], v[184:187], v[112:115]
    ds_read_b64_tr_b16 a[174:175], v15 offset:61440
    v_mfma_f32_16x16x32_bf16 v[116:119], a[236:239], v[188:191], 0
    buffer_load_dwordx4 a[120:123], v252, s[28:31], s37 offen offset:2048 sc1
    v_mfma_f32_16x16x32_bf16 v[116:119], a[232:235], v[204:207], v[116:119]
    ds_read_b64_tr_b16 a[176:177], v19 offset:32768
    ds_read_b64_tr_b16 a[178:179], v19 offset:36864
    v_mfma_f32_16x16x32_bf16 v[116:119], a[228:231], v[156:159], v[116:119]
    ds_read_b64_tr_b16 a[180:181], v19 offset:40960
    v_mfma_f32_16x16x32_bf16 v[116:119], a[224:227], v[140:143], v[116:119]
    ds_read_b64_tr_b16 a[182:183], v19 offset:45056
    v_mfma_f32_16x16x32_bf16 v[116:119], a[220:223], v[180:183], v[116:119]
    buffer_load_dwordx4 a[124:127], v252, s[28:31], s37 offen offset:3072 sc1
    v_mfma_f32_16x16x32_bf16 v[116:119], a[216:219], v[196:199], v[116:119]
    ds_read_b64_tr_b16 a[184:185], v19 offset:49152
    ds_read_b64_tr_b16 a[186:187], v19 offset:53248
    v_mfma_f32_16x16x32_bf16 v[116:119], a[212:215], v[148:151], v[116:119]
    ds_read_b64_tr_b16 a[188:189], v19 offset:57344
    v_mfma_f32_16x16x32_bf16 v[116:119], a[208:211], v[132:135], v[116:119]
    ds_read_b64_tr_b16 a[190:191], v19 offset:61440
    s_waitcnt vmcnt(25)
    s_waitcnt lgkmcnt(0)
    s_barrier
    v_mfma_f32_16x16x32_bf16 v[120:123], a[160:163], v[128:131], 0
    ds_read_b64_tr_b16 a[208:209], v20 offset:32768
    v_mfma_f32_16x16x32_bf16 v[120:123], a[164:167], v[144:147], v[120:123]
    ds_read_b64_tr_b16 a[210:211], v20 offset:36864
    v_mfma_f32_16x16x32_bf16 v[120:123], a[168:171], v[192:195], v[120:123]
    ds_read_b64_tr_b16 a[212:213], v20 offset:40960
    v_mfma_f32_16x16x32_bf16 v[120:123], a[172:175], v[176:179], v[120:123]
    ds_read_b64_tr_b16 a[214:215], v20 offset:45056
    v_mfma_f32_16x16x32_bf16 v[120:123], a[176:179], v[136:139], v[120:123]
    ds_read_b64_tr_b16 a[216:217], v20 offset:49152
    v_mfma_f32_16x16x32_bf16 v[120:123], a[180:183], v[152:155], v[120:123]
    ds_read_b64_tr_b16 a[218:219], v20 offset:53248
    v_mfma_f32_16x16x32_bf16 v[120:123], a[184:187], v[200:203], v[120:123]
    s_add_u32 s49, s7, 512
    ds_read_b64_tr_b16 a[220:221], v20 offset:57344
    v_mfma_f32_16x16x32_bf16 v[120:123], a[188:191], v[184:187], v[120:123]
    s_add_u32 m0, s42, 65536
    ds_read_b64_tr_b16 a[222:223], v20 offset:61440
    v_mfma_f32_16x16x32_bf16 v[124:127], a[188:191], v[188:191], 0
    buffer_load_dwordx4 v46, s[20:23], s49 offen lds
    v_mfma_f32_16x16x32_bf16 v[124:127], a[184:187], v[204:207], v[124:127]
    ds_read_b64_tr_b16 a[224:225], v24 offset:32768
    ds_read_b64_tr_b16 a[226:227], v24 offset:36864
    v_mfma_f32_16x16x32_bf16 v[124:127], a[180:183], v[156:159], v[124:127]
    buffer_load_dwordx4 v47, s[20:23], s49 offen offset:1024 lds
    v_mfma_f32_16x16x32_bf16 v[124:127], a[176:179], v[140:143], v[124:127]
    ds_read_b64_tr_b16 a[228:229], v24 offset:40960
    ds_read_b64_tr_b16 a[230:231], v24 offset:45056
    v_mfma_f32_16x16x32_bf16 v[124:127], a[172:175], v[180:183], v[124:127]
    ds_read_b64_tr_b16 a[232:233], v24 offset:49152
    v_mfma_f32_16x16x32_bf16 v[124:127], a[168:171], v[196:199], v[124:127]
    ds_read_b64_tr_b16 a[234:235], v24 offset:53248
    v_mfma_f32_16x16x32_bf16 v[124:127], a[164:167], v[148:151], v[124:127]
    ds_read_b64_tr_b16 a[236:237], v24 offset:57344
    v_lshrrev_b32 v240, 4, v1
    v_mfma_f32_16x16x32_bf16 v[124:127], a[160:163], v[132:135], v[124:127]
    s_waitcnt vmcnt(25)
    s_waitcnt lgkmcnt(13)
    ds_read_b64_tr_b16 a[238:239], v24 offset:61440
    v_and_b32 v240, 2, v240
    v_mfma_f32_16x16x32_bf16 v[64:67], a[208:211], a[64:67], v[64:67]
    s_waitcnt vmcnt(24)
    s_waitcnt lgkmcnt(12)
    buffer_load_dwordx4 v48, s[20:23], s49 offen offset:2048 lds
    v_mfma_f32_16x16x32_bf16 v[64:67], a[212:215], a[68:71], v[64:67]
    s_waitcnt vmcnt(24)
    s_waitcnt lgkmcnt(10)
    ds_read_b64_tr_b16 a[160:161], v21 offset:32768
    ds_read_b64_tr_b16 a[162:163], v21 offset:36864
    v_mfma_f32_16x16x32_bf16 v[64:67], a[216:219], a[72:75], v[64:67]
    s_waitcnt vmcnt(23)
    s_waitcnt lgkmcnt(10)
    buffer_load_dwordx4 v49, s[20:23], s49 offen offset:3072 lds
    v_mfma_f32_16x16x32_bf16 v[64:67], a[220:223], a[76:79], v[64:67]
    s_waitcnt vmcnt(23)
    s_waitcnt lgkmcnt(8)
    ds_read_b64_tr_b16 a[164:165], v21 offset:40960
    ds_read_b64_tr_b16 a[166:167], v21 offset:45056
    v_mfma_f32_16x16x32_bf16 v[64:67], a[224:227], a[80:83], v[64:67]
    s_waitcnt vmcnt(20)
    s_waitcnt lgkmcnt(8)
    ds_read_b64_tr_b16 a[168:169], v21 offset:49152
    v_bfe_u32 v241, v1, 2, 2
    v_mfma_f32_16x16x32_bf16 v[64:67], a[228:231], a[84:87], v[64:67]
    s_waitcnt vmcnt(17)
    s_waitcnt lgkmcnt(7)
    ds_read_b64_tr_b16 a[170:171], v21 offset:53248
    v_cmp_eq_u32 s[54:55], v240, v241
    v_mfma_f32_16x16x32_bf16 v[64:67], a[232:235], a[88:91], v[64:67]
    s_waitcnt vmcnt(14)
    s_waitcnt lgkmcnt(6)
    s_add_u32 s49, s7, 74240
    ds_read_b64_tr_b16 a[172:173], v21 offset:57344
    v_or_b32 v240, 1, v240
    v_mfma_f32_16x16x32_bf16 v[64:67], a[236:239], a[92:95], v[64:67]
    s_waitcnt vmcnt(4)
    s_add_u32 m0, s42, 81920
    ds_read_b64_tr_b16 a[174:175], v21 offset:61440
    v_cmp_eq_u32 s[36:37], v240, v241
    v_mfma_f32_16x16x32_bf16 v[68:71], a[236:239], a[124:127], v[68:71]
    buffer_load_dwordx4 v46, s[20:23], s49 offen lds
    v_mfma_f32_16x16x32_bf16 v[68:71], a[232:235], a[120:123], v[68:71]
    ds_read_b64_tr_b16 a[176:177], v25 offset:32768
    ds_read_b64_tr_b16 a[178:179], v25 offset:36864
    v_mfma_f32_16x16x32_bf16 v[68:71], a[228:231], a[116:119], v[68:71]
    buffer_load_dwordx4 v47, s[20:23], s49 offen offset:1024 lds
    v_mfma_f32_16x16x32_bf16 v[68:71], a[224:227], a[112:115], v[68:71]
    ds_read_b64_tr_b16 a[180:181], v25 offset:40960
    ds_read_b64_tr_b16 a[182:183], v25 offset:45056
    v_mfma_f32_16x16x32_bf16 v[68:71], a[220:223], a[108:111], v[68:71]
    ds_read_b64_tr_b16 a[184:185], v25 offset:49152
    v_cvt_pk_bf16_f32 v224, v64, v65
    v_mfma_f32_16x16x32_bf16 v[68:71], a[216:219], a[104:107], v[68:71]
    ds_read_b64_tr_b16 a[186:187], v25 offset:53248
    v_cvt_pk_bf16_f32 v225, v66, v67
    v_mfma_f32_16x16x32_bf16 v[68:71], a[212:215], a[100:103], v[68:71]
    buffer_load_dwordx2 v[36:37], v4, s[12:15], 0 offen offset:0
    v_mfma_f32_16x16x32_bf16 v[68:71], a[208:211], a[96:99], v[68:71]
    s_waitcnt lgkmcnt(12)
    ds_read_b64_tr_b16 a[188:189], v25 offset:57344
    ds_read_b64_tr_b16 a[190:191], v25 offset:61440
    v_mfma_f32_16x16x32_bf16 v[72:75], a[160:163], a[64:67], v[72:75]
    s_waitcnt lgkmcnt(12)
    buffer_load_dwordx4 v48, s[20:23], s49 offen offset:2048 lds
    v_mfma_f32_16x16x32_bf16 v[72:75], a[164:167], a[68:71], v[72:75]
    s_waitcnt lgkmcnt(10)
    ds_read_b64_tr_b16 a[208:209], v22 offset:32768
    ds_read_b64_tr_b16 a[210:211], v22 offset:36864
    v_mfma_f32_16x16x32_bf16 v[72:75], a[168:171], a[72:75], v[72:75]
    s_waitcnt lgkmcnt(10)
    buffer_load_dwordx4 v49, s[20:23], s49 offen offset:3072 lds
    v_mfma_f32_16x16x32_bf16 v[72:75], a[172:175], a[76:79], v[72:75]
    s_waitcnt lgkmcnt(8)
    ds_read_b64_tr_b16 a[212:213], v22 offset:40960
    ds_read_b64_tr_b16 a[214:215], v22 offset:45056
    v_mfma_f32_16x16x32_bf16 v[72:75], a[176:179], a[80:83], v[72:75]
    s_waitcnt lgkmcnt(8)
    ds_read_b64_tr_b16 a[216:217], v22 offset:49152
    v_cvt_pk_bf16_f32 v228, v68, v69
    v_mfma_f32_16x16x32_bf16 v[72:75], a[180:183], a[84:87], v[72:75]
    s_waitcnt lgkmcnt(7)
    ds_read_b64_tr_b16 a[218:219], v22 offset:53248
    v_cvt_pk_bf16_f32 v229, v70, v71
    v_mfma_f32_16x16x32_bf16 v[72:75], a[184:187], a[88:91], v[72:75]
    s_waitcnt lgkmcnt(6)
    ds_read_b64_tr_b16 a[220:221], v22 offset:57344
    v_and_b32 v240, 1, v1
    v_mfma_f32_16x16x32_bf16 v[72:75], a[188:191], a[92:95], v[72:75]
    ds_read_b64_tr_b16 a[222:223], v22 offset:61440
    v_lshlrev_b32 v240, 4, v240
    v_mfma_f32_16x16x32_bf16 v[76:79], a[188:191], a[124:127], v[76:79]
    buffer_load_dwordx2 v[38:39], v4, s[12:15], 0 offen offset:32
    v_mfma_f32_16x16x32_bf16 v[76:79], a[184:187], a[120:123], v[76:79]
    ds_read_b64_tr_b16 a[224:225], v26 offset:32768
    ds_read_b64_tr_b16 a[226:227], v26 offset:36864
    v_mfma_f32_16x16x32_bf16 v[76:79], a[180:183], a[116:119], v[76:79]
    ds_read_b64_tr_b16 a[228:229], v26 offset:40960
    v_mov_b32 v241, 0x3f80
    v_mfma_f32_16x16x32_bf16 v[76:79], a[176:179], a[112:115], v[76:79]
    ds_read_b64_tr_b16 a[230:231], v26 offset:45056
    v_lshlrev_b32 v240, v240, v241
    v_mfma_f32_16x16x32_bf16 v[76:79], a[172:175], a[108:111], v[76:79]
    ds_read_b64_tr_b16 a[232:233], v26 offset:49152
    v_cvt_pk_bf16_f32 v226, v72, v73
    v_mfma_f32_16x16x32_bf16 v[76:79], a[168:171], a[104:107], v[76:79]
    s_add_u32 s38, s93, 0
    ds_read_b64_tr_b16 a[234:235], v26 offset:53248
    v_cvt_pk_bf16_f32 v227, v74, v75
    v_mfma_f32_16x16x32_bf16 v[76:79], a[164:167], a[100:103], v[76:79]
    buffer_store_dwordx4 v[224:227], v56, s[28:31], s38 offen sc1
    v_mfma_f32_16x16x32_bf16 v[76:79], a[160:163], a[96:99], v[76:79]
    s_waitcnt lgkmcnt(12)
    ds_read_b64_tr_b16 a[236:237], v26 offset:57344
    ds_read_b64_tr_b16 a[238:239], v26 offset:61440
    v_mfma_f32_16x16x32_bf16 v[80:83], a[208:211], a[64:67], v[80:83]
    s_waitcnt lgkmcnt(12)
    ds_read_b64_tr_b16 a[160:161], v23 offset:32768
    v_bfe_i32 v241, v1, 1, 1
    v_mfma_f32_16x16x32_bf16 v[80:83], a[212:215], a[68:71], v[80:83]
    s_waitcnt lgkmcnt(11)
    ds_read_b64_tr_b16 a[162:163], v23 offset:36864
    v_and_b32 v243, v240, v241
    v_mfma_f32_16x16x32_bf16 v[80:83], a[216:219], a[72:75], v[80:83]
    s_waitcnt lgkmcnt(10)
    buffer_load_dwordx2 v[40:41], v4, s[12:15], 0 offen offset:512
    v_mfma_f32_16x16x32_bf16 v[80:83], a[220:223], a[76:79], v[80:83]
    s_waitcnt lgkmcnt(8)
    ds_read_b64_tr_b16 a[164:165], v23 offset:40960
    ds_read_b64_tr_b16 a[166:167], v23 offset:45056
    v_mfma_f32_16x16x32_bf16 v[80:83], a[224:227], a[80:83], v[80:83]
    s_waitcnt lgkmcnt(8)
    ds_read_b64_tr_b16 a[168:169], v23 offset:49152
    v_cvt_pk_bf16_f32 v230, v76, v77
    v_mfma_f32_16x16x32_bf16 v[80:83], a[228:231], a[84:87], v[80:83]
    s_waitcnt lgkmcnt(7)
    s_add_u32 s38, s93, 163840
    ds_read_b64_tr_b16 a[170:171], v23 offset:53248
    v_cvt_pk_bf16_f32 v231, v78, v79
    v_mfma_f32_16x16x32_bf16 v[80:83], a[232:235], a[88:91], v[80:83]
    s_waitcnt lgkmcnt(6)
    buffer_store_dwordx4 v[228:231], v56, s[28:31], s38 offen sc1
    v_mfma_f32_16x16x32_bf16 v[80:83], a[236:239], a[92:95], v[80:83]
    ds_read_b64_tr_b16 a[172:173], v23 offset:57344
    ds_read_b64_tr_b16 a[174:175], v23 offset:61440
    v_mfma_f32_16x16x32_bf16 v[84:87], a[236:239], a[124:127], v[84:87]
    ds_read_b64_tr_b16 a[176:177], v27 offset:32768
    v_xor_b32 v242, v240, v243
    v_mfma_f32_16x16x32_bf16 v[84:87], a[232:235], a[120:123], v[84:87]
    ds_read_b64_tr_b16 a[178:179], v27 offset:36864
    v_cndmask_b32 v246, 0, v242, s[54:55]
    v_mfma_f32_16x16x32_bf16 v[84:87], a[228:231], a[116:119], v[84:87]
    ds_read_b64_tr_b16 a[180:181], v27 offset:40960
    v_cndmask_b32 v247, 0, v243, s[54:55]
    v_mfma_f32_16x16x32_bf16 v[84:87], a[224:227], a[112:115], v[84:87]
    ds_read_b64_tr_b16 a[182:183], v27 offset:45056
    v_cndmask_b32 v250, 0, v242, s[36:37]
    v_mfma_f32_16x16x32_bf16 v[84:87], a[220:223], a[108:111], v[84:87]
    ds_read_b64_tr_b16 a[184:185], v27 offset:49152
    v_cvt_pk_bf16_f32 v232, v80, v81
    v_mfma_f32_16x16x32_bf16 v[84:87], a[216:219], a[104:107], v[84:87]
    ds_read_b64_tr_b16 a[186:187], v27 offset:53248
    v_cvt_pk_bf16_f32 v233, v82, v83
    v_mfma_f32_16x16x32_bf16 v[84:87], a[212:215], a[100:103], v[84:87]
    buffer_load_dwordx2 v[42:43], v4, s[12:15], 0 offen offset:544
    v_mfma_f32_16x16x32_bf16 v[84:87], a[208:211], a[96:99], v[84:87]
    s_waitcnt lgkmcnt(12)
    ds_read_b64_tr_b16 a[188:189], v27 offset:57344
    ds_read_b64_tr_b16 a[190:191], v27 offset:61440
    s_barrier
    v_mfma_f32_16x16x32_bf16 v[88:91], a[160:163], a[64:67], v[88:91]
    s_waitcnt lgkmcnt(12)
    ds_read_b64_tr_b16 a[208:209], v12 offset:0
    v_cndmask_b32 v251, 0, v243, s[36:37]
    v_mfma_f32_16x16x32_bf16 v[88:91], a[164:167], a[68:71], v[88:91]
    s_waitcnt lgkmcnt(11)
    ds_read_b64_tr_b16 a[210:211], v12 offset:4096
    v_mov_b32 v240, 0
    v_mfma_f32_16x16x32_bf16 v[88:91], a[168:171], a[72:75], v[88:91]
    s_waitcnt lgkmcnt(10)
    ds_read_b64_tr_b16 a[212:213], v12 offset:8192
    v_mov_b32 v241, 0
    v_mfma_f32_16x16x32_bf16 v[88:91], a[172:175], a[76:79], v[88:91]
    s_waitcnt lgkmcnt(9)
    ds_read_b64_tr_b16 a[214:215], v12 offset:12288
    v_mov_b32 v244, 0
    v_mfma_f32_16x16x32_bf16 v[88:91], a[176:179], a[80:83], v[88:91]
    s_waitcnt lgkmcnt(8)
    ds_read_b64_tr_b16 a[216:217], v12 offset:16384
    v_cvt_pk_bf16_f32 v236, v84, v85
    v_mfma_f32_16x16x32_bf16 v[88:91], a[180:183], a[84:87], v[88:91]
    s_waitcnt lgkmcnt(7)
    ds_read_b64_tr_b16 a[218:219], v12 offset:20480
    v_cvt_pk_bf16_f32 v237, v86, v87
    v_mfma_f32_16x16x32_bf16 v[88:91], a[184:187], a[88:91], v[88:91]
    s_waitcnt lgkmcnt(6)
    s_add_u32 s49, s46, 512
    ds_read_b64_tr_b16 a[220:221], v12 offset:24576
    v_mov_b32 v245, 0
    v_mfma_f32_16x16x32_bf16 v[88:91], a[188:191], a[92:95], v[88:91]
    s_add_u32 m0, s42, 32768
    ds_read_b64_tr_b16 a[222:223], v12 offset:28672
    v_mov_b32 v248, 0
    v_mfma_f32_16x16x32_bf16 v[92:95], a[188:191], a[124:127], v[92:95]
    buffer_load_dwordx4 v46, s[20:23], s49 offen lds
    v_mfma_f32_16x16x32_bf16 v[92:95], a[184:187], a[120:123], v[92:95]
    ds_read_b64_tr_b16 a[224:225], v16 offset:0
    ds_read_b64_tr_b16 a[226:227], v16 offset:4096
    v_mfma_f32_16x16x32_bf16 v[92:95], a[180:183], a[116:119], v[92:95]
    buffer_load_dwordx4 v47, s[20:23], s49 offen offset:1024 lds
    v_mfma_f32_16x16x32_bf16 v[92:95], a[176:179], a[112:115], v[92:95]
    ds_read_b64_tr_b16 a[228:229], v16 offset:8192
    ds_read_b64_tr_b16 a[230:231], v16 offset:12288
    v_mfma_f32_16x16x32_bf16 v[92:95], a[172:175], a[108:111], v[92:95]
    ds_read_b64_tr_b16 a[232:233], v16 offset:16384
    v_cvt_pk_bf16_f32 v234, v88, v89
    v_mfma_f32_16x16x32_bf16 v[92:95], a[168:171], a[104:107], v[92:95]
    s_add_u32 s38, s93, 128
    ds_read_b64_tr_b16 a[234:235], v16 offset:20480
    v_cvt_pk_bf16_f32 v235, v90, v91
    v_mfma_f32_16x16x32_bf16 v[92:95], a[164:167], a[100:103], v[92:95]
    buffer_store_dwordx4 v[232:235], v56, s[28:31], s38 offen sc1
    v_mfma_f32_16x16x32_bf16 v[92:95], a[160:163], a[96:99], v[92:95]
    s_waitcnt lgkmcnt(12)
    ds_read_b64_tr_b16 a[236:237], v16 offset:24576
    ds_read_b64_tr_b16 a[238:239], v16 offset:28672
    v_mfma_f32_16x16x32_bf16 v[96:99], a[208:211], a[64:67], v[96:99]
    s_waitcnt lgkmcnt(12)
    buffer_load_dwordx4 v48, s[20:23], s49 offen offset:2048 lds
    v_mfma_f32_16x16x32_bf16 v[96:99], a[212:215], a[68:71], v[96:99]
    s_waitcnt lgkmcnt(10)
    ds_read_b64_tr_b16 a[160:161], v13 offset:0
    ds_read_b64_tr_b16 a[162:163], v13 offset:4096
    v_mfma_f32_16x16x32_bf16 v[96:99], a[216:219], a[72:75], v[96:99]
    s_waitcnt lgkmcnt(10)
    buffer_load_dwordx4 v49, s[20:23], s49 offen offset:3072 lds
    v_mfma_f32_16x16x32_bf16 v[96:99], a[220:223], a[76:79], v[96:99]
    s_waitcnt lgkmcnt(8)
    ds_read_b64_tr_b16 a[164:165], v13 offset:8192
    ds_read_b64_tr_b16 a[166:167], v13 offset:12288
    v_mfma_f32_16x16x32_bf16 v[96:99], a[224:227], a[80:83], v[96:99]
    s_waitcnt lgkmcnt(8)
    ds_read_b64_tr_b16 a[168:169], v13 offset:16384
    v_cvt_pk_bf16_f32 v238, v92, v93
    v_mfma_f32_16x16x32_bf16 v[96:99], a[228:231], a[84:87], v[96:99]
    s_waitcnt lgkmcnt(7)
    s_add_u32 s38, s93, 163968
    ds_read_b64_tr_b16 a[170:171], v13 offset:20480
    v_cvt_pk_bf16_f32 v239, v94, v95
    v_mfma_f32_16x16x32_bf16 v[96:99], a[232:235], a[88:91], v[96:99]
    s_waitcnt lgkmcnt(6)
    s_add_u32 s49, s46, 74240
    buffer_store_dwordx4 v[236:239], v56, s[28:31], s38 offen sc1
    v_mfma_f32_16x16x32_bf16 v[96:99], a[236:239], a[92:95], v[96:99]
    s_add_u32 m0, s42, 49152
    ds_read_b64_tr_b16 a[172:173], v13 offset:24576
    ds_read_b64_tr_b16 a[174:175], v13 offset:28672
    v_mfma_f32_16x16x32_bf16 v[100:103], a[236:239], a[124:127], v[100:103]
    buffer_load_dwordx4 v46, s[20:23], s49 offen lds
    v_mfma_f32_16x16x32_bf16 v[100:103], a[232:235], a[120:123], v[100:103]
    ds_read_b64_tr_b16 a[176:177], v17 offset:0
    ds_read_b64_tr_b16 a[178:179], v17 offset:4096
    v_mfma_f32_16x16x32_bf16 v[100:103], a[228:231], a[116:119], v[100:103]
    buffer_load_dwordx4 v47, s[20:23], s49 offen offset:1024 lds
    v_mfma_f32_16x16x32_bf16 v[100:103], a[224:227], a[112:115], v[100:103]
    ds_read_b64_tr_b16 a[180:181], v17 offset:8192
    ds_read_b64_tr_b16 a[182:183], v17 offset:12288
    v_mfma_f32_16x16x32_bf16 v[100:103], a[220:223], a[108:111], v[100:103]
    ds_read_b64_tr_b16 a[184:185], v17 offset:16384
    v_cvt_pk_bf16_f32 v224, v96, v97
    v_mfma_f32_16x16x32_bf16 v[100:103], a[216:219], a[104:107], v[100:103]
    ds_read_b64_tr_b16 a[186:187], v17 offset:20480
    v_cvt_pk_bf16_f32 v225, v98, v99
    v_mfma_f32_16x16x32_bf16 v[100:103], a[212:215], a[100:103], v[100:103]
    ds_read_b64_tr_b16 a[188:189], v17 offset:24576
    v_mov_b32 v249, 0
    v_mfma_f32_16x16x32_bf16 v[100:103], a[208:211], a[96:99], v[100:103]
    s_waitcnt lgkmcnt(13)
    ds_read_b64_tr_b16 a[190:191], v17 offset:28672
    v_mov_b32 v252, 0
    v_mfma_f32_16x16x32_bf16 v[104:107], a[160:163], a[64:67], v[104:107]
    s_waitcnt lgkmcnt(12)
    buffer_load_dwordx4 v48, s[20:23], s49 offen offset:2048 lds
    v_mfma_f32_16x16x32_bf16 v[104:107], a[164:167], a[68:71], v[104:107]
    s_waitcnt lgkmcnt(10)
    ds_read_b64_tr_b16 a[208:209], v14 offset:0
    ds_read_b64_tr_b16 a[210:211], v14 offset:4096
    v_mfma_f32_16x16x32_bf16 v[104:107], a[168:171], a[72:75], v[104:107]
    s_waitcnt lgkmcnt(10)
    buffer_load_dwordx4 v49, s[20:23], s49 offen offset:3072 lds
    v_mfma_f32_16x16x32_bf16 v[104:107], a[172:175], a[76:79], v[104:107]
    s_waitcnt lgkmcnt(8)
    ds_read_b64_tr_b16 a[212:213], v14 offset:8192
    ds_read_b64_tr_b16 a[214:215], v14 offset:12288
    v_mfma_f32_16x16x32_bf16 v[104:107], a[176:179], a[80:83], v[104:107]
    s_waitcnt lgkmcnt(8)
    ds_read_b64_tr_b16 a[216:217], v14 offset:16384
    v_cvt_pk_bf16_f32 v228, v100, v101
    v_mfma_f32_16x16x32_bf16 v[104:107], a[180:183], a[84:87], v[104:107]
    s_waitcnt lgkmcnt(7)
    ds_read_b64_tr_b16 a[218:219], v14 offset:20480
    v_cvt_pk_bf16_f32 v229, v102, v103
    v_mfma_f32_16x16x32_bf16 v[104:107], a[184:187], a[88:91], v[104:107]
    s_waitcnt lgkmcnt(6)
    ds_read_b64_tr_b16 a[220:221], v14 offset:24576
    v_mov_b32 v253, 0
    v_mfma_f32_16x16x32_bf16 v[104:107], a[188:191], a[92:95], v[104:107]
    ds_read_b64_tr_b16 a[222:223], v14 offset:28672
    v_mfma_f32_16x16x32_bf16 v[108:111], a[188:191], a[124:127], v[108:111]
    ds_read_b64_tr_b16 a[224:225], v18 offset:0
    v_mfma_f32_16x16x32_bf16 v[108:111], a[184:187], a[120:123], v[108:111]
    ds_read_b64_tr_b16 a[226:227], v18 offset:4096
    v_mfma_f32_16x16x32_bf16 v[108:111], a[180:183], a[116:119], v[108:111]
    ds_read_b64_tr_b16 a[228:229], v18 offset:8192
    v_mfma_f32_16x16x32_bf16 v[108:111], a[176:179], a[112:115], v[108:111]
    ds_read_b64_tr_b16 a[230:231], v18 offset:12288
    v_mfma_f32_16x16x32_bf16 v[108:111], a[172:175], a[108:111], v[108:111]
    ds_read_b64_tr_b16 a[232:233], v18 offset:16384
    v_cvt_pk_bf16_f32 v226, v104, v105
    v_mfma_f32_16x16x32_bf16 v[108:111], a[168:171], a[104:107], v[108:111]
    s_add_u32 s38, s93, 512
    ds_read_b64_tr_b16 a[234:235], v18 offset:20480
    v_cvt_pk_bf16_f32 v227, v106, v107
    v_mfma_f32_16x16x32_bf16 v[108:111], a[164:167], a[100:103], v[108:111]
    buffer_store_dwordx4 v[224:227], v56, s[28:31], s38 offen sc1
    v_mfma_f32_16x16x32_bf16 v[108:111], a[160:163], a[96:99], v[108:111]
    s_waitcnt lgkmcnt(12)
    ds_read_b64_tr_b16 a[236:237], v18 offset:24576
    ds_read_b64_tr_b16 a[238:239], v18 offset:28672
    v_mfma_f32_16x16x32_bf16 v[112:115], a[208:211], a[64:67], v[112:115]
    s_waitcnt lgkmcnt(12)
    ds_read_b64_tr_b16 a[160:161], v15 offset:0
    v_mfma_f32_16x16x32_bf16 v[112:115], a[212:215], a[68:71], v[112:115]
    s_waitcnt lgkmcnt(11)
    ds_read_b64_tr_b16 a[162:163], v15 offset:4096
    v_mfma_f32_16x16x32_bf16 v[112:115], a[216:219], a[72:75], v[112:115]
    s_waitcnt lgkmcnt(10)
    ds_read_b64_tr_b16 a[164:165], v15 offset:8192
    v_mfma_f32_16x16x32_bf16 v[112:115], a[220:223], a[76:79], v[112:115]
    s_waitcnt lgkmcnt(9)
    ds_read_b64_tr_b16 a[166:167], v15 offset:12288
    v_mfma_f32_16x16x32_bf16 v[112:115], a[224:227], a[80:83], v[112:115]
    s_waitcnt lgkmcnt(8)
    ds_read_b64_tr_b16 a[168:169], v15 offset:16384
    v_cvt_pk_bf16_f32 v230, v108, v109
    v_mfma_f32_16x16x32_bf16 v[112:115], a[228:231], a[84:87], v[112:115]
    s_waitcnt lgkmcnt(7)
    s_add_u32 s38, s93, 164352
    ds_read_b64_tr_b16 a[170:171], v15 offset:20480
    v_cvt_pk_bf16_f32 v231, v110, v111
    v_mfma_f32_16x16x32_bf16 v[112:115], a[232:235], a[88:91], v[112:115]
    s_waitcnt lgkmcnt(6)
    buffer_store_dwordx4 v[228:231], v56, s[28:31], s38 offen sc1
    v_mfma_f32_16x16x32_bf16 v[112:115], a[236:239], a[92:95], v[112:115]
    ds_read_b64_tr_b16 a[172:173], v15 offset:24576
    ds_read_b64_tr_b16 a[174:175], v15 offset:28672
    v_mfma_f32_16x16x32_bf16 v[116:119], a[236:239], a[124:127], v[116:119]
    ds_read_b64_tr_b16 a[176:177], v19 offset:0
    v_mfma_f32_16x16x32_bf16 v[116:119], a[232:235], a[120:123], v[116:119]
    ds_read_b64_tr_b16 a[178:179], v19 offset:4096
    v_mfma_f32_16x16x32_bf16 v[116:119], a[228:231], a[116:119], v[116:119]
    ds_read_b64_tr_b16 a[180:181], v19 offset:8192
    v_mfma_f32_16x16x32_bf16 v[116:119], a[224:227], a[112:115], v[116:119]
    ds_read_b64_tr_b16 a[182:183], v19 offset:12288
    v_mfma_f32_16x16x32_bf16 v[116:119], a[220:223], a[108:111], v[116:119]
    ds_read_b64_tr_b16 a[184:185], v19 offset:16384
    v_cvt_pk_bf16_f32 v232, v112, v113
    v_mfma_f32_16x16x32_bf16 v[116:119], a[216:219], a[104:107], v[116:119]
    ds_read_b64_tr_b16 a[186:187], v19 offset:20480
    v_cvt_pk_bf16_f32 v233, v114, v115
    v_mfma_f32_16x16x32_bf16 v[116:119], a[212:215], a[100:103], v[116:119]
    ds_read_b64_tr_b16 a[188:189], v19 offset:24576
    v_mfma_f32_16x16x32_bf16 v[116:119], a[208:211], a[96:99], v[116:119]
    s_waitcnt lgkmcnt(13)
    ds_read_b64_tr_b16 a[190:191], v19 offset:28672
    s_waitcnt vmcnt(17)
    s_barrier
    v_mfma_f32_16x16x32_bf16 v[120:123], a[160:163], a[64:67], v[120:123]
    s_waitcnt lgkmcnt(12)
    ds_read_b64_tr_b16 a[208:209], v20 offset:0
    v_mfma_f32_16x16x32_bf16 v[120:123], a[164:167], a[68:71], v[120:123]
    s_waitcnt lgkmcnt(11)
    ds_read_b64_tr_b16 a[210:211], v20 offset:4096
    v_mfma_f32_16x16x32_bf16 v[120:123], a[168:171], a[72:75], v[120:123]
    s_waitcnt lgkmcnt(10)
    ds_read_b64_tr_b16 a[212:213], v20 offset:8192
    v_mfma_f32_16x16x32_bf16 v[120:123], a[172:175], a[76:79], v[120:123]
    s_waitcnt lgkmcnt(9)
    ds_read_b64_tr_b16 a[214:215], v20 offset:12288
    v_mfma_f32_16x16x32_bf16 v[120:123], a[176:179], a[80:83], v[120:123]
    s_waitcnt lgkmcnt(8)
    ds_read_b64_tr_b16 a[216:217], v20 offset:16384
    v_cvt_pk_bf16_f32 v236, v116, v117
    v_mfma_f32_16x16x32_bf16 v[120:123], a[180:183], a[84:87], v[120:123]
    s_waitcnt lgkmcnt(7)
    ds_read_b64_tr_b16 a[218:219], v20 offset:20480
    v_cvt_pk_bf16_f32 v237, v118, v119
    v_mfma_f32_16x16x32_bf16 v[120:123], a[184:187], a[88:91], v[120:123]
    s_waitcnt lgkmcnt(6)
    s_add_u32 s49, s7, 768
    ds_read_b64_tr_b16 a[220:221], v20 offset:24576
    v_mfma_f32_16x16x32_bf16 v[120:123], a[188:191], a[92:95], v[120:123]
    s_add_u32 m0, s42, 98304
    ds_read_b64_tr_b16 a[222:223], v20 offset:28672
    v_mfma_f32_16x16x32_bf16 v[124:127], a[188:191], a[124:127], v[124:127]
    buffer_load_dwordx4 v46, s[20:23], s49 offen lds
    v_mfma_f32_16x16x32_bf16 v[124:127], a[184:187], a[120:123], v[124:127]
    ds_read_b64_tr_b16 a[224:225], v24 offset:0
    ds_read_b64_tr_b16 a[226:227], v24 offset:4096
    v_mfma_f32_16x16x32_bf16 v[124:127], a[180:183], a[116:119], v[124:127]
    buffer_load_dwordx4 v47, s[20:23], s49 offen offset:1024 lds
    v_mfma_f32_16x16x32_bf16 v[124:127], a[176:179], a[112:115], v[124:127]
    ds_read_b64_tr_b16 a[228:229], v24 offset:8192
    ds_read_b64_tr_b16 a[230:231], v24 offset:12288
    v_mfma_f32_16x16x32_bf16 v[124:127], a[172:175], a[108:111], v[124:127]
    ds_read_b64_tr_b16 a[232:233], v24 offset:16384
    v_cvt_pk_bf16_f32 v234, v120, v121
    v_mfma_f32_16x16x32_bf16 v[124:127], a[168:171], a[104:107], v[124:127]
    s_add_u32 s38, s93, 640
    ds_read_b64_tr_b16 a[234:235], v24 offset:20480
    v_cvt_pk_bf16_f32 v235, v122, v123
    v_mfma_f32_16x16x32_bf16 v[124:127], a[164:167], a[100:103], v[124:127]
    buffer_store_dwordx4 v[232:235], v56, s[28:31], s38 offen sc1
    v_mfma_f32_16x16x32_bf16 v[124:127], a[160:163], a[96:99], v[124:127]
    s_waitcnt lgkmcnt(12)
    ds_read_b64_tr_b16 a[236:237], v24 offset:24576
    ds_read_b64_tr_b16 a[238:239], v24 offset:28672
    v_mfma_f32_16x16x32_bf16 v[64:67], a[208:211], v[128:131], 0
    s_waitcnt lgkmcnt(12)
    buffer_load_dwordx4 v48, s[20:23], s49 offen offset:2048 lds
    v_mfma_f32_16x16x32_bf16 v[64:67], a[212:215], v[144:147], v[64:67]
    s_waitcnt lgkmcnt(10)
    ds_read_b64_tr_b16 a[160:161], v21 offset:0
    ds_read_b64_tr_b16 a[162:163], v21 offset:4096
    v_mfma_f32_16x16x32_bf16 v[64:67], a[216:219], v[192:195], v[64:67]
    s_waitcnt lgkmcnt(10)
    buffer_load_dwordx4 v49, s[20:23], s49 offen offset:3072 lds
    v_mfma_f32_16x16x32_bf16 v[64:67], a[220:223], v[176:179], v[64:67]
    s_waitcnt lgkmcnt(8)
    ds_read_b64_tr_b16 a[164:165], v21 offset:8192
    ds_read_b64_tr_b16 a[166:167], v21 offset:12288
    v_mfma_f32_16x16x32_bf16 v[64:67], a[224:227], v[136:139], v[64:67]
    s_waitcnt lgkmcnt(8)
    ds_read_b64_tr_b16 a[168:169], v21 offset:16384
    v_cvt_pk_bf16_f32 v238, v124, v125
    v_mfma_f32_16x16x32_bf16 v[64:67], a[228:231], v[152:155], v[64:67]
    s_waitcnt lgkmcnt(7)
    s_add_u32 s38, s93, 164480
    ds_read_b64_tr_b16 a[170:171], v21 offset:20480
    v_cvt_pk_bf16_f32 v239, v126, v127
    v_mfma_f32_16x16x32_bf16 v[64:67], a[232:235], v[200:203], v[64:67]
    s_waitcnt lgkmcnt(6)
    s_add_u32 s49, s7, 74496
    buffer_store_dwordx4 v[236:239], v56, s[28:31], s38 offen sc1
    v_mfma_f32_16x16x32_bf16 v[64:67], a[236:239], v[184:187], v[64:67]
    s_add_u32 m0, s42, 114688
    ds_read_b64_tr_b16 a[172:173], v21 offset:24576
    ds_read_b64_tr_b16 a[174:175], v21 offset:28672
    v_mfma_f32_16x16x32_bf16 v[68:71], a[236:239], v[188:191], 0
Ltour10:
    s_cbranch_execz Ltour14
    buffer_load_dwordx4 v46, s[20:23], s49 offen lds
    v_mfma_f32_16x16x32_bf16 v[68:71], a[232:235], v[204:207], v[68:71]
    ds_read_b64_tr_b16 a[176:177], v25 offset:0
    ds_read_b64_tr_b16 a[178:179], v25 offset:4096
    v_mfma_f32_16x16x32_bf16 v[68:71], a[228:231], v[156:159], v[68:71]
    buffer_load_dwordx4 v47, s[20:23], s49 offen offset:1024 lds
    v_mfma_f32_16x16x32_bf16 v[68:71], a[224:227], v[140:143], v[68:71]
    ds_read_b64_tr_b16 a[180:181], v25 offset:8192
    ds_read_b64_tr_b16 a[182:183], v25 offset:12288
    v_mfma_f32_16x16x32_bf16 v[68:71], a[220:223], v[180:183], v[68:71]
    ds_read_b64_tr_b16 a[184:185], v25 offset:16384
    v_mfma_f32_16x16x32_bf16 v[68:71], a[216:219], v[196:199], v[68:71]
    ds_read_b64_tr_b16 a[186:187], v25 offset:20480
    v_mfma_f32_16x16x32_bf16 v[68:71], a[212:215], v[148:151], v[68:71]
    ds_read_b64_tr_b16 a[188:189], v25 offset:24576
    v_mfma_f32_16x16x32_bf16 v[68:71], a[208:211], v[132:135], v[68:71]
    s_waitcnt lgkmcnt(13)
    ds_read_b64_tr_b16 a[190:191], v25 offset:28672
    v_mfma_f32_16x16x32_bf16 v[72:75], a[160:163], v[128:131], 0
    s_waitcnt lgkmcnt(12)
    buffer_load_dwordx4 v48, s[20:23], s49 offen offset:2048 lds
    v_mfma_f32_16x16x32_bf16 v[72:75], a[164:167], v[144:147], v[72:75]
    s_waitcnt lgkmcnt(10)
    ds_read_b64_tr_b16 a[208:209], v22 offset:0
    ds_read_b64_tr_b16 a[210:211], v22 offset:4096
    v_mfma_f32_16x16x32_bf16 v[72:75], a[168:171], v[192:195], v[72:75]
    s_waitcnt lgkmcnt(10)
    buffer_load_dwordx4 v49, s[20:23], s49 offen offset:3072 lds
    v_mfma_f32_16x16x32_bf16 v[72:75], a[172:175], v[176:179], v[72:75]
    s_waitcnt lgkmcnt(8)
    ds_read_b64_tr_b16 a[212:213], v22 offset:8192
    ds_read_b64_tr_b16 a[214:215], v22 offset:12288
    v_mfma_f32_16x16x32_bf16 v[72:75], a[176:179], v[136:139], v[72:75]
    s_waitcnt lgkmcnt(8)
    ds_read_b64_tr_b16 a[216:217], v22 offset:16384
    v_mfma_f32_16x16x32_bf16 v[72:75], a[180:183], v[152:155], v[72:75]
    s_waitcnt lgkmcnt(7)
    ds_read_b64_tr_b16 a[218:219], v22 offset:20480
    v_mfma_f32_16x16x32_bf16 v[72:75], a[184:187], v[200:203], v[72:75]
    s_waitcnt lgkmcnt(6)
    ds_read_b64_tr_b16 a[220:221], v22 offset:24576
    v_mfma_f32_16x16x32_bf16 v[72:75], a[188:191], v[184:187], v[72:75]
    ds_read_b64_tr_b16 a[222:223], v22 offset:28672
    v_mfma_f32_16x16x32_bf16 v[76:79], a[188:191], v[188:191], 0
    ds_read_b64_tr_b16 a[224:225], v26 offset:0
    v_mfma_f32_16x16x32_bf16 v[76:79], a[184:187], v[204:207], v[76:79]
    ds_read_b64_tr_b16 a[226:227], v26 offset:4096
    v_mfma_f32_16x16x32_bf16 v[76:79], a[180:183], v[156:159], v[76:79]
    ds_read_b64_tr_b16 a[228:229], v26 offset:8192
    v_mfma_f32_16x16x32_bf16 v[76:79], a[176:179], v[140:143], v[76:79]
    ds_read_b64_tr_b16 a[230:231], v26 offset:12288
    v_mfma_f32_16x16x32_bf16 v[76:79], a[172:175], v[180:183], v[76:79]
    ds_read_b64_tr_b16 a[232:233], v26 offset:16384
    v_mfma_f32_16x16x32_bf16 v[76:79], a[168:171], v[196:199], v[76:79]
    ds_read_b64_tr_b16 a[234:235], v26 offset:20480
    v_mfma_f32_16x16x32_bf16 v[76:79], a[164:167], v[148:151], v[76:79]
    buffer_load_dword v63, v63, s[88:91], 0 offen sc1
    v_mfma_f32_16x16x32_bf16 v[76:79], a[160:163], v[132:135], v[76:79]
    s_waitcnt lgkmcnt(12)
    ds_read_b64_tr_b16 a[236:237], v26 offset:24576
    ds_read_b64_tr_b16 a[238:239], v26 offset:28672
    v_mfma_f32_16x16x32_bf16 v[80:83], a[208:211], v[128:131], 0
    s_waitcnt lgkmcnt(12)
    ds_read_b64_tr_b16 a[160:161], v23 offset:0
    v_mfma_f32_16x16x32_bf16 v[80:83], a[212:215], v[144:147], v[80:83]
    s_waitcnt lgkmcnt(11)
    ds_read_b64_tr_b16 a[162:163], v23 offset:4096
    v_mfma_f32_16x16x32_bf16 v[80:83], a[216:219], v[192:195], v[80:83]
    s_waitcnt lgkmcnt(10)
    ds_read_b64_tr_b16 a[164:165], v23 offset:8192
    v_mfma_f32_16x16x32_bf16 v[80:83], a[220:223], v[176:179], v[80:83]
    s_waitcnt lgkmcnt(9)
    ds_read_b64_tr_b16 a[166:167], v23 offset:12288
    v_mfma_f32_16x16x32_bf16 v[80:83], a[224:227], v[136:139], v[80:83]
    s_waitcnt lgkmcnt(8)
    ds_read_b64_tr_b16 a[168:169], v23 offset:16384
    v_mfma_f32_16x16x32_bf16 v[80:83], a[228:231], v[152:155], v[80:83]
    s_waitcnt lgkmcnt(7)
    ds_read_b64_tr_b16 a[170:171], v23 offset:20480
    v_mfma_f32_16x16x32_bf16 v[80:83], a[232:235], v[200:203], v[80:83]
    s_waitcnt lgkmcnt(6)
    ds_read_b64_tr_b16 a[172:173], v23 offset:24576
    v_mfma_f32_16x16x32_bf16 v[80:83], a[236:239], v[184:187], v[80:83]
    ds_read_b64_tr_b16 a[174:175], v23 offset:28672
    v_mfma_f32_16x16x32_bf16 v[84:87], a[236:239], v[188:191], 0
    ds_read_b64_tr_b16 a[176:177], v27 offset:0
    v_mfma_f32_16x16x32_bf16 v[84:87], a[232:235], v[204:207], v[84:87]
    ds_read_b64_tr_b16 a[178:179], v27 offset:4096
    v_mfma_f32_16x16x32_bf16 v[84:87], a[228:231], v[156:159], v[84:87]
    ds_read_b64_tr_b16 a[180:181], v27 offset:8192
    v_mfma_f32_16x16x32_bf16 v[84:87], a[224:227], v[140:143], v[84:87]
    ds_read_b64_tr_b16 a[182:183], v27 offset:12288
    v_mfma_f32_16x16x32_bf16 v[84:87], a[220:223], v[180:183], v[84:87]
    ds_read_b64_tr_b16 a[184:185], v27 offset:16384
    v_mfma_f32_16x16x32_bf16 v[84:87], a[216:219], v[196:199], v[84:87]
    ds_read_b64_tr_b16 a[186:187], v27 offset:20480
    v_mfma_f32_16x16x32_bf16 v[84:87], a[212:215], v[148:151], v[84:87]
    ds_read_b64_tr_b16 a[188:189], v27 offset:24576
    v_mfma_f32_16x16x32_bf16 v[84:87], a[208:211], v[132:135], v[84:87]
    s_waitcnt lgkmcnt(13)
    ds_read_b64_tr_b16 a[190:191], v27 offset:28672
    s_waitcnt vmcnt(13)
    s_barrier
    v_mfma_f32_16x16x32_bf16 v[88:91], a[160:163], v[128:131], 0
    s_waitcnt lgkmcnt(12)
    ds_read_b64_tr_b16 a[208:209], v12 offset:32768
    v_mfma_f32_16x16x32_bf16 v[88:91], a[164:167], v[144:147], v[88:91]
    s_waitcnt lgkmcnt(11)
    ds_read_b64_tr_b16 a[210:211], v12 offset:36864
    v_mfma_f32_16x16x32_bf16 v[88:91], a[168:171], v[192:195], v[88:91]
    s_waitcnt lgkmcnt(10)
    ds_read_b64_tr_b16 a[212:213], v12 offset:40960
    v_mfma_f32_16x16x32_bf16 v[88:91], a[172:175], v[176:179], v[88:91]
    s_waitcnt lgkmcnt(9)
    ds_read_b64_tr_b16 a[214:215], v12 offset:45056
    v_mfma_f32_16x16x32_bf16 v[88:91], a[176:179], v[136:139], v[88:91]
    s_waitcnt lgkmcnt(8)
    ds_read_b64_tr_b16 a[216:217], v12 offset:49152
    v_mfma_f32_16x16x32_bf16 v[88:91], a[180:183], v[152:155], v[88:91]
    s_waitcnt lgkmcnt(7)
    ds_read_b64_tr_b16 a[218:219], v12 offset:53248
    v_mfma_f32_16x16x32_bf16 v[88:91], a[184:187], v[200:203], v[88:91]
    s_waitcnt lgkmcnt(6)
    s_add_u32 s49, s46, 768
    ds_read_b64_tr_b16 a[220:221], v12 offset:57344
    v_mfma_f32_16x16x32_bf16 v[88:91], a[188:191], v[184:187], v[88:91]
    s_add_u32 m0, s42, 0
    ds_read_b64_tr_b16 a[222:223], v12 offset:61440
    v_mfma_f32_16x16x32_bf16 v[92:95], a[188:191], v[188:191], 0
    buffer_load_dwordx4 v46, s[20:23], s49 offen lds
    v_mfma_f32_16x16x32_bf16 v[92:95], a[184:187], v[204:207], v[92:95]
    ds_read_b64_tr_b16 a[224:225], v16 offset:32768
    ds_read_b64_tr_b16 a[226:227], v16 offset:36864
    v_mfma_f32_16x16x32_bf16 v[92:95], a[180:183], v[156:159], v[92:95]
    buffer_load_dwordx4 v47, s[20:23], s49 offen offset:1024 lds
    v_mfma_f32_16x16x32_bf16 v[92:95], a[176:179], v[140:143], v[92:95]
    ds_read_b64_tr_b16 a[228:229], v16 offset:40960
    ds_read_b64_tr_b16 a[230:231], v16 offset:45056
    v_mfma_f32_16x16x32_bf16 v[92:95], a[172:175], v[180:183], v[92:95]
    ds_read_b64_tr_b16 a[232:233], v16 offset:49152
    v_mfma_f32_16x16x32_bf16 v[92:95], a[168:171], v[196:199], v[92:95]
    ds_read_b64_tr_b16 a[234:235], v16 offset:53248
    v_mfma_f32_16x16x32_bf16 v[92:95], a[164:167], v[148:151], v[92:95]
    ds_read_b64_tr_b16 a[236:237], v16 offset:57344
    v_mfma_f32_16x16x32_bf16 v[92:95], a[160:163], v[132:135], v[92:95]
    s_waitcnt lgkmcnt(13)
    ds_read_b64_tr_b16 a[238:239], v16 offset:61440
    v_mfma_f32_16x16x32_bf16 v[64:67], a[208:211], a[64:67], v[64:67]
    s_waitcnt lgkmcnt(12)
    buffer_load_dwordx4 v48, s[20:23], s49 offen offset:2048 lds
    v_mfma_f32_16x16x32_bf16 v[64:67], a[212:215], a[68:71], v[64:67]
    s_waitcnt lgkmcnt(10)
    ds_read_b64_tr_b16 a[160:161], v13 offset:32768
    ds_read_b64_tr_b16 a[162:163], v13 offset:36864
    v_mfma_f32_16x16x32_bf16 v[64:67], a[216:219], a[72:75], v[64:67]
    s_waitcnt lgkmcnt(10)
    s_add_u32 s92, s92, 16
    buffer_load_dwordx4 v49, s[20:23], s49 offen offset:3072 lds
    v_mfma_f32_16x16x32_bf16 v[64:67], a[220:223], a[76:79], v[64:67]
    s_waitcnt lgkmcnt(8)
    s_waitcnt vmcnt(9)
    ds_read_b64_tr_b16 a[164:165], v13 offset:40960
    ds_read_b64_tr_b16 a[166:167], v13 offset:45056
    v_mfma_f32_16x16x32_bf16 v[64:67], a[224:227], a[80:83], v[64:67]
    s_waitcnt lgkmcnt(8)
    buffer_store_dword v10, v8, s[24:27], s92 offen sc1
    v_mfma_f32_16x16x32_bf16 v[64:67], a[228:231], a[84:87], v[64:67]
    s_waitcnt lgkmcnt(6)
    ds_read_b64_tr_b16 a[168:169], v13 offset:49152
    ds_read_b64_tr_b16 a[170:171], v13 offset:53248
    v_mfma_f32_16x16x32_bf16 v[64:67], a[232:235], a[88:91], v[64:67]
    s_waitcnt lgkmcnt(6)
    s_add_u32 s49, s46, 74496
    ds_read_b64_tr_b16 a[172:173], v13 offset:57344
    v_mfma_f32_16x16x32_bf16 v[64:67], a[236:239], a[92:95], v[64:67]
    s_add_u32 m0, s42, 16384
    ds_read_b64_tr_b16 a[174:175], v13 offset:61440
    v_mfma_f32_16x16x32_bf16 v[68:71], a[236:239], a[124:127], v[68:71]
    buffer_load_dwordx4 v46, s[20:23], s49 offen lds
    v_mfma_f32_16x16x32_bf16 v[68:71], a[232:235], a[120:123], v[68:71]
    ds_read_b64_tr_b16 a[176:177], v17 offset:32768
    ds_read_b64_tr_b16 a[178:179], v17 offset:36864
    v_mfma_f32_16x16x32_bf16 v[68:71], a[228:231], a[116:119], v[68:71]
    buffer_load_dwordx4 v47, s[20:23], s49 offen offset:1024 lds
    v_mfma_f32_16x16x32_bf16 v[68:71], a[224:227], a[112:115], v[68:71]
    ds_read_b64_tr_b16 a[180:181], v17 offset:40960
    ds_read_b64_tr_b16 a[182:183], v17 offset:45056
    v_mfma_f32_16x16x32_bf16 v[68:71], a[220:223], a[108:111], v[68:71]
    ds_read_b64_tr_b16 a[184:185], v17 offset:49152
    v_cvt_pk_bf16_f32 v224, v64, v65
    v_mfma_f32_16x16x32_bf16 v[68:71], a[216:219], a[104:107], v[68:71]
    ds_read_b64_tr_b16 a[186:187], v17 offset:53248
    v_cvt_pk_bf16_f32 v225, v66, v67
    v_mfma_f32_16x16x32_bf16 v[68:71], a[212:215], a[100:103], v[68:71]
    ds_read_b64_tr_b16 a[188:189], v17 offset:57344
    v_mfma_f32_16x16x32_bf16 v[68:71], a[208:211], a[96:99], v[68:71]
    s_waitcnt lgkmcnt(13)
    ds_read_b64_tr_b16 a[190:191], v17 offset:61440
    v_mfma_f32_16x16x32_bf16 v[72:75], a[160:163], a[64:67], v[72:75]
    s_waitcnt lgkmcnt(12)
    buffer_load_dwordx4 v48, s[20:23], s49 offen offset:2048 lds
    v_mfma_f32_16x16x32_bf16 v[72:75], a[164:167], a[68:71], v[72:75]
    s_waitcnt lgkmcnt(10)
    ds_read_b64_tr_b16 a[208:209], v14 offset:32768
    ds_read_b64_tr_b16 a[210:211], v14 offset:36864
    v_mfma_f32_16x16x32_bf16 v[72:75], a[168:171], a[72:75], v[72:75]
    s_waitcnt lgkmcnt(10)
    buffer_load_dwordx4 v49, s[20:23], s49 offen offset:3072 lds
    v_mfma_f32_16x16x32_bf16 v[72:75], a[172:175], a[76:79], v[72:75]
    s_waitcnt lgkmcnt(8)
    ds_read_b64_tr_b16 a[212:213], v14 offset:40960
    ds_read_b64_tr_b16 a[214:215], v14 offset:45056
    v_mfma_f32_16x16x32_bf16 v[72:75], a[176:179], a[80:83], v[72:75]
    s_waitcnt lgkmcnt(8)
    ds_read_b64_tr_b16 a[216:217], v14 offset:49152
    v_cvt_pk_bf16_f32 v228, v68, v69
    v_mfma_f32_16x16x32_bf16 v[72:75], a[180:183], a[84:87], v[72:75]
    s_waitcnt lgkmcnt(7)
    ds_read_b64_tr_b16 a[218:219], v14 offset:53248
    v_cvt_pk_bf16_f32 v229, v70, v71
    v_mfma_f32_16x16x32_bf16 v[72:75], a[184:187], a[88:91], v[72:75]
    s_waitcnt lgkmcnt(6)
    s_and_b32 s42, s2, 7
    ds_read_b64_tr_b16 a[220:221], v14 offset:57344
    v_mfma_f32_16x16x32_bf16 v[72:75], a[188:191], a[92:95], v[72:75]
    s_mov_b64 s[20:21], s[52:53]
    ds_read_b64_tr_b16 a[222:223], v14 offset:61440
    v_mfma_f32_16x16x32_bf16 v[76:79], a[188:191], a[124:127], v[76:79]
    ds_read_b64_tr_b16 a[224:225], v18 offset:32768
    s_waitcnt vmcnt(9)
    v_readfirstlane_b32 s37, v63
    v_mfma_f32_16x16x32_bf16 v[76:79], a[184:187], a[120:123], v[76:79]
    s_mov_b32 s22, 1152
    ds_read_b64_tr_b16 a[226:227], v18 offset:36864
    v_mfma_f32_16x16x32_bf16 v[76:79], a[180:183], a[116:119], v[76:79]
    s_mov_b32 s23, 0x20000
    ds_read_b64_tr_b16 a[228:229], v18 offset:40960
    s_cmp_lt_u32 s37, 256
    s_cbranch_scc1 Lattn_armwait
Lattn_armed:
    v_mfma_f32_16x16x32_bf16 v[76:79], a[176:179], a[112:115], v[76:79]
    ds_read_b64_tr_b16 a[230:231], v18 offset:45056
    v_mfma_f32_16x16x32_bf16 v[76:79], a[172:175], a[108:111], v[76:79]
    ds_read_b64_tr_b16 a[232:233], v18 offset:49152
    v_cvt_pk_bf16_f32 v226, v72, v73
    v_mfma_f32_16x16x32_bf16 v[76:79], a[168:171], a[104:107], v[76:79]
    s_add_u32 s38, s93, 1024
    ds_read_b64_tr_b16 a[234:235], v18 offset:53248
    v_cvt_pk_bf16_f32 v227, v74, v75
    v_mfma_f32_16x16x32_bf16 v[76:79], a[164:167], a[100:103], v[76:79]
    buffer_store_dwordx4 v[224:227], v56, s[28:31], s38 offen sc1
    v_mfma_f32_16x16x32_bf16 v[76:79], a[160:163], a[96:99], v[76:79]
    s_waitcnt lgkmcnt(12)
    s_mov_b32 s45, 18688
    ds_read_b64_tr_b16 a[236:237], v18 offset:57344
    ds_read_b64_tr_b16 a[238:239], v18 offset:61440
    v_mfma_f32_16x16x32_bf16 v[80:83], a[208:211], a[64:67], v[80:83]
    s_waitcnt lgkmcnt(12)
    buffer_load_dwordx4 v[160:163], v5, s[24:27], s45 offen offset:0 sc1
    v_mfma_f32_16x16x32_bf16 v[80:83], a[212:215], a[68:71], v[80:83]
    s_waitcnt lgkmcnt(10)
    ds_read_b64_tr_b16 a[160:161], v15 offset:32768
    ds_read_b64_tr_b16 a[162:163], v15 offset:36864
    v_mfma_f32_16x16x32_bf16 v[80:83], a[216:219], a[72:75], v[80:83]
    s_waitcnt lgkmcnt(10)
    buffer_load_dwordx4 v[164:167], v5, s[24:27], s45 offen offset:512 sc1
    v_mfma_f32_16x16x32_bf16 v[80:83], a[220:223], a[76:79], v[80:83]
    s_waitcnt lgkmcnt(8)
    ds_read_b64_tr_b16 a[164:165], v15 offset:40960
    ds_read_b64_tr_b16 a[166:167], v15 offset:45056
    v_mfma_f32_16x16x32_bf16 v[80:83], a[224:227], a[80:83], v[80:83]
    s_waitcnt lgkmcnt(8)
    ds_read_b64_tr_b16 a[168:169], v15 offset:49152
    v_cvt_pk_bf16_f32 v230, v76, v77
    v_mfma_f32_16x16x32_bf16 v[80:83], a[228:231], a[84:87], v[80:83]
    s_waitcnt lgkmcnt(7)
    s_add_u32 s38, s93, 164864
    ds_read_b64_tr_b16 a[170:171], v15 offset:53248
    v_cvt_pk_bf16_f32 v231, v78, v79
    v_mfma_f32_16x16x32_bf16 v[80:83], a[232:235], a[88:91], v[80:83]
    s_waitcnt lgkmcnt(6)
    buffer_store_dwordx4 v[228:231], v56, s[28:31], s38 offen sc1
    v_mfma_f32_16x16x32_bf16 v[80:83], a[236:239], a[92:95], v[80:83]
    ds_read_b64_tr_b16 a[172:173], v15 offset:57344
    ds_read_b64_tr_b16 a[174:175], v15 offset:61440
    v_mfma_f32_16x16x32_bf16 v[84:87], a[236:239], a[124:127], v[84:87]
    ds_read_b64_tr_b16 a[176:177], v19 offset:32768
    v_mfma_f32_16x16x32_bf16 v[84:87], a[232:235], a[120:123], v[84:87]
    ds_read_b64_tr_b16 a[178:179], v19 offset:36864
    v_mfma_f32_16x16x32_bf16 v[84:87], a[228:231], a[116:119], v[84:87]
    buffer_load_dwordx4 v[168:171], v59, s[24:27], s45 offen offset:1024 sc1
    v_mfma_f32_16x16x32_bf16 v[84:87], a[224:227], a[112:115], v[84:87]
    ds_read_b64_tr_b16 a[180:181], v19 offset:40960
    ds_read_b64_tr_b16 a[182:183], v19 offset:45056
    v_mfma_f32_16x16x32_bf16 v[84:87], a[220:223], a[108:111], v[84:87]
    ds_read_b64_tr_b16 a[184:185], v19 offset:49152
    v_cvt_pk_bf16_f32 v232, v80, v81
    v_mfma_f32_16x16x32_bf16 v[84:87], a[216:219], a[104:107], v[84:87]
    s_mov_b32 s45, 20992
    ds_read_b64_tr_b16 a[186:187], v19 offset:53248
    v_cvt_pk_bf16_f32 v233, v82, v83
    v_mfma_f32_16x16x32_bf16 v[84:87], a[212:215], a[100:103], v[84:87]
    buffer_load_dwordx4 v[172:175], v5, s[24:27], s45 offen offset:0 sc1
    v_mfma_f32_16x16x32_bf16 v[84:87], a[208:211], a[96:99], v[84:87]
    s_waitcnt lgkmcnt(12)
    ds_read_b64_tr_b16 a[188:189], v19 offset:57344
    ds_read_b64_tr_b16 a[190:191], v19 offset:61440
    s_barrier
    v_mfma_f32_16x16x32_bf16 v[88:91], a[160:163], a[64:67], v[88:91]
    s_waitcnt lgkmcnt(12)
    ds_read_b64_tr_b16 a[208:209], v20 offset:32768
    v_mfma_f32_16x16x32_bf16 v[88:91], a[164:167], a[68:71], v[88:91]
    s_waitcnt lgkmcnt(11)
    ds_read_b64_tr_b16 a[210:211], v20 offset:36864
    v_mfma_f32_16x16x32_bf16 v[88:91], a[168:171], a[72:75], v[88:91]
    s_waitcnt lgkmcnt(10)
    buffer_load_dwordx4 v[208:211], v5, s[24:27], s45 offen offset:512 sc1
    v_mfma_f32_16x16x32_bf16 v[88:91], a[172:175], a[76:79], v[88:91]
    s_waitcnt lgkmcnt(8)
    ds_read_b64_tr_b16 a[212:213], v20 offset:40960
    ds_read_b64_tr_b16 a[214:215], v20 offset:45056
    v_mfma_f32_16x16x32_bf16 v[88:91], a[176:179], a[80:83], v[88:91]
    s_waitcnt lgkmcnt(8)
    s_add_u32 s57, s59, 4096
    ds_read_b64_tr_b16 a[216:217], v20 offset:49152
    v_cvt_pk_bf16_f32 v236, v84, v85
    v_mfma_f32_16x16x32_bf16 v[88:91], a[180:183], a[84:87], v[88:91]
    s_waitcnt lgkmcnt(7)
    s_add_u32 m0, s6, -98304
    ds_read_b64_tr_b16 a[218:219], v20 offset:53248
    v_cvt_pk_bf16_f32 v237, v86, v87
    v_mfma_f32_16x16x32_bf16 v[88:91], a[184:187], a[88:91], v[88:91]
    s_waitcnt lgkmcnt(6)
    buffer_load_dwordx4 v255, s[84:87], s57 offen lds
    v_mfma_f32_16x16x32_bf16 v[88:91], a[188:191], a[92:95], v[88:91]
    ds_read_b64_tr_b16 a[220:221], v20 offset:57344
    ds_read_b64_tr_b16 a[222:223], v20 offset:61440
    v_mfma_f32_16x16x32_bf16 v[92:95], a[188:191], a[124:127], v[92:95]
    s_add_u32 s57, s59, 8192
    buffer_load_dwordx4 v[212:215], v59, s[24:27], s45 offen offset:1024 sc1
    v_mfma_f32_16x16x32_bf16 v[92:95], a[184:187], a[120:123], v[92:95]
    s_add_u32 m0, s6, -94208
    ds_read_b64_tr_b16 a[224:225], v24 offset:32768
    ds_read_b64_tr_b16 a[226:227], v24 offset:36864
    v_mfma_f32_16x16x32_bf16 v[92:95], a[180:183], a[116:119], v[92:95]
    buffer_load_dwordx4 v255, s[84:87], s57 offen lds
    v_mfma_f32_16x16x32_bf16 v[92:95], a[176:179], a[112:115], v[92:95]
    ds_read_b64_tr_b16 a[228:229], v24 offset:40960
    ds_read_b64_tr_b16 a[230:231], v24 offset:45056
    v_mfma_f32_16x16x32_bf16 v[92:95], a[172:175], a[108:111], v[92:95]
    ds_read_b64_tr_b16 a[232:233], v24 offset:49152
    v_cvt_pk_bf16_f32 v234, v88, v89
    v_mfma_f32_16x16x32_bf16 v[92:95], a[168:171], a[104:107], v[92:95]
    s_add_u32 s38, s93, 1152
    ds_read_b64_tr_b16 a[234:235], v24 offset:53248
    v_cvt_pk_bf16_f32 v235, v90, v91
    v_mfma_f32_16x16x32_bf16 v[92:95], a[164:167], a[100:103], v[92:95]
    buffer_store_dwordx4 v[232:235], v56, s[28:31], s38 offen sc1
    v_mfma_f32_16x16x32_bf16 v[92:95], a[160:163], a[96:99], v[92:95]
    s_waitcnt lgkmcnt(12)
    ds_read_b64_tr_b16 a[236:237], v24 offset:57344
    ds_read_b64_tr_b16 a[238:239], v24 offset:61440
    v_mfma_f32_16x16x32_bf16 v[96:99], a[208:211], v[128:131], 0
    s_waitcnt lgkmcnt(12)
    s_add_u32 s57, s59, 12288
    ds_read_b64_tr_b16 a[160:161], v21 offset:32768
    v_mfma_f32_16x16x32_bf16 v[96:99], a[212:215], v[144:147], v[96:99]
    s_waitcnt lgkmcnt(11)
    s_add_u32 m0, s6, -90112
    ds_read_b64_tr_b16 a[162:163], v21 offset:36864
    v_mfma_f32_16x16x32_bf16 v[96:99], a[216:219], v[192:195], v[96:99]
    s_waitcnt lgkmcnt(10)
    buffer_load_dwordx4 v255, s[84:87], s57 offen lds
    v_mfma_f32_16x16x32_bf16 v[96:99], a[220:223], v[176:179], v[96:99]
    s_waitcnt lgkmcnt(8)
    ds_read_b64_tr_b16 a[164:165], v21 offset:40960
    ds_read_b64_tr_b16 a[166:167], v21 offset:45056
    v_mfma_f32_16x16x32_bf16 v[96:99], a[224:227], v[136:139], v[96:99]
    s_waitcnt lgkmcnt(8)
    ds_read_b64_tr_b16 a[168:169], v21 offset:49152
    v_cvt_pk_bf16_f32 v238, v92, v93
    v_mfma_f32_16x16x32_bf16 v[96:99], a[228:231], v[152:155], v[96:99]
    s_waitcnt lgkmcnt(7)
    s_add_u32 s38, s93, 164992
    ds_read_b64_tr_b16 a[170:171], v21 offset:53248
    v_cvt_pk_bf16_f32 v239, v94, v95
    v_mfma_f32_16x16x32_bf16 v[96:99], a[232:235], v[200:203], v[96:99]
    s_waitcnt lgkmcnt(6)
    buffer_store_dwordx4 v[236:239], v56, s[28:31], s38 offen sc1
    v_mfma_f32_16x16x32_bf16 v[96:99], a[236:239], v[184:187], v[96:99]
    ds_read_b64_tr_b16 a[172:173], v21 offset:57344
    ds_read_b64_tr_b16 a[174:175], v21 offset:61440
    v_mfma_f32_16x16x32_bf16 v[100:103], a[236:239], v[188:191], 0
    s_add_u32 s57, s59, 16384
    buffer_load_dwordx2 v[92:93], v58, s[12:15], 0 offen offset:1024
    v_mfma_f32_16x16x32_bf16 v[100:103], a[232:235], v[204:207], v[100:103]
    s_add_u32 m0, s6, -86016
    ds_read_b64_tr_b16 a[176:177], v25 offset:32768
    ds_read_b64_tr_b16 a[178:179], v25 offset:36864
    v_mfma_f32_16x16x32_bf16 v[100:103], a[228:231], v[156:159], v[100:103]
    buffer_load_dwordx4 v255, s[84:87], s57 offen lds
    v_mfma_f32_16x16x32_bf16 v[100:103], a[224:227], v[140:143], v[100:103]
    ds_read_b64_tr_b16 a[180:181], v25 offset:40960
    ds_read_b64_tr_b16 a[182:183], v25 offset:45056
    v_mfma_f32_16x16x32_bf16 v[100:103], a[220:223], v[180:183], v[100:103]
    ds_read_b64_tr_b16 a[184:185], v25 offset:49152
    v_mfma_f32_16x16x32_bf16 v[100:103], a[216:219], v[196:199], v[100:103]
    ds_read_b64_tr_b16 a[186:187], v25 offset:53248
    v_mfma_f32_16x16x32_bf16 v[100:103], a[212:215], v[148:151], v[100:103]
    buffer_load_dwordx2 v[94:95], v58, s[12:15], 0 offen offset:1056
    v_mfma_f32_16x16x32_bf16 v[100:103], a[208:211], v[132:135], v[100:103]
    s_waitcnt lgkmcnt(12)
    ds_read_b64_tr_b16 a[188:189], v25 offset:57344
    ds_read_b64_tr_b16 a[190:191], v25 offset:61440
    v_mfma_f32_16x16x32_bf16 v[104:107], a[160:163], v[128:131], 0
    s_waitcnt lgkmcnt(12)
    s_add_u32 s57, s59, 20480
    ds_read_b64_tr_b16 a[208:209], v22 offset:32768
    v_mfma_f32_16x16x32_bf16 v[104:107], a[164:167], v[144:147], v[104:107]
    s_waitcnt lgkmcnt(11)
    s_add_u32 m0, s6, -81920
    ds_read_b64_tr_b16 a[210:211], v22 offset:36864
    v_mfma_f32_16x16x32_bf16 v[104:107], a[168:171], v[192:195], v[104:107]
    s_waitcnt lgkmcnt(10)
    buffer_load_dwordx4 v255, s[84:87], s57 offen lds
    v_mfma_f32_16x16x32_bf16 v[104:107], a[172:175], v[176:179], v[104:107]
    s_waitcnt lgkmcnt(8)
    s_mov_b32 s45, 19840
    ds_read_b64_tr_b16 a[212:213], v22 offset:40960
    ds_read_b64_tr_b16 a[214:215], v22 offset:45056
    v_mfma_f32_16x16x32_bf16 v[104:107], a[176:179], v[136:139], v[104:107]
    s_waitcnt lgkmcnt(8)
    s_add_u32 s57, s59, 24576
    buffer_load_dwordx4 v[64:67], v5, s[24:27], s45 offen offset:0 sc1
    v_mfma_f32_16x16x32_bf16 v[104:107], a[180:183], v[152:155], v[104:107]
    s_waitcnt lgkmcnt(6)
    s_add_u32 m0, s6, -77824
    ds_read_b64_tr_b16 a[216:217], v22 offset:49152
    ds_read_b64_tr_b16 a[218:219], v22 offset:53248
    v_mfma_f32_16x16x32_bf16 v[104:107], a[184:187], v[200:203], v[104:107]
    s_waitcnt lgkmcnt(6)
    buffer_load_dwordx4 v255, s[84:87], s57 offen lds
    v_mfma_f32_16x16x32_bf16 v[104:107], a[188:191], v[184:187], v[104:107]
    ds_read_b64_tr_b16 a[220:221], v22 offset:57344
    ds_read_b64_tr_b16 a[222:223], v22 offset:61440
    v_mfma_f32_16x16x32_bf16 v[108:111], a[188:191], v[188:191], 0
    s_add_u32 s57, s59, 28672
    ds_read_b64_tr_b16 a[224:225], v26 offset:32768
    v_mfma_f32_16x16x32_bf16 v[108:111], a[184:187], v[204:207], v[108:111]
    s_add_u32 m0, s6, -73728
    ds_read_b64_tr_b16 a[226:227], v26 offset:36864
    v_mfma_f32_16x16x32_bf16 v[108:111], a[180:183], v[156:159], v[108:111]
    buffer_load_dwordx4 v255, s[84:87], s57 offen lds
    v_mfma_f32_16x16x32_bf16 v[108:111], a[176:179], v[140:143], v[108:111]
    ds_read_b64_tr_b16 a[228:229], v26 offset:40960
    ds_read_b64_tr_b16 a[230:231], v26 offset:45056
    v_mfma_f32_16x16x32_bf16 v[108:111], a[172:175], v[180:183], v[108:111]
    s_add_u32 s57, s59, 32768
    buffer_load_dwordx4 v[68:71], v5, s[24:27], s45 offen offset:512 sc1
    v_mfma_f32_16x16x32_bf16 v[108:111], a[168:171], v[196:199], v[108:111]
    s_add_u32 m0, s6, -69632
    ds_read_b64_tr_b16 a[232:233], v26 offset:49152
    ds_read_b64_tr_b16 a[234:235], v26 offset:53248
    v_mfma_f32_16x16x32_bf16 v[108:111], a[164:167], v[148:151], v[108:111]
    buffer_load_dwordx4 v255, s[84:87], s57 offen lds
    v_mfma_f32_16x16x32_bf16 v[108:111], a[160:163], v[132:135], v[108:111]
    s_waitcnt lgkmcnt(12)
    ds_read_b64_tr_b16 a[236:237], v26 offset:57344
    ds_read_b64_tr_b16 a[238:239], v26 offset:61440
    v_mfma_f32_16x16x32_bf16 v[112:115], a[208:211], v[128:131], 0
    s_waitcnt lgkmcnt(12)
    ds_read_b64_tr_b16 a[160:161], v23 offset:32768
    v_mfma_f32_16x16x32_bf16 v[112:115], a[212:215], v[144:147], v[112:115]
    s_waitcnt lgkmcnt(11)
    ds_read_b64_tr_b16 a[162:163], v23 offset:36864
    v_mfma_f32_16x16x32_bf16 v[112:115], a[216:219], v[192:195], v[112:115]
    s_waitcnt lgkmcnt(10)
    ds_read_b64_tr_b16 a[164:165], v23 offset:40960
    v_mfma_f32_16x16x32_bf16 v[112:115], a[220:223], v[176:179], v[112:115]
    s_waitcnt lgkmcnt(9)
    ds_read_b64_tr_b16 a[166:167], v23 offset:45056
    v_mfma_f32_16x16x32_bf16 v[112:115], a[224:227], v[136:139], v[112:115]
    s_waitcnt lgkmcnt(8)
    buffer_load_dwordx4 v[72:75], v59, s[24:27], s45 offen offset:1024 sc1
    v_mfma_f32_16x16x32_bf16 v[112:115], a[228:231], v[152:155], v[112:115]
    s_waitcnt lgkmcnt(6)
    ds_read_b64_tr_b16 a[168:169], v23 offset:49152
    ds_read_b64_tr_b16 a[170:171], v23 offset:53248
    v_mfma_f32_16x16x32_bf16 v[112:115], a[232:235], v[200:203], v[112:115]
    s_waitcnt lgkmcnt(6)
    ds_read_b64_tr_b16 a[172:173], v23 offset:57344
    v_mfma_f32_16x16x32_bf16 v[112:115], a[236:239], v[184:187], v[112:115]
    ds_read_b64_tr_b16 a[174:175], v23 offset:61440
    v_mfma_f32_16x16x32_bf16 v[116:119], a[236:239], v[188:191], 0
    buffer_load_dwordx2 v[76:77], v3, s[20:23], 0 offen offset:0
    v_mfma_f32_16x16x32_bf16 v[116:119], a[232:235], v[204:207], v[116:119]
    ds_read_b64_tr_b16 a[176:177], v27 offset:32768
    ds_read_b64_tr_b16 a[178:179], v27 offset:36864
    v_mfma_f32_16x16x32_bf16 v[116:119], a[228:231], v[156:159], v[116:119]
    ds_read_b64_tr_b16 a[180:181], v27 offset:40960
    v_mfma_f32_16x16x32_bf16 v[116:119], a[224:227], v[140:143], v[116:119]
    ds_read_b64_tr_b16 a[182:183], v27 offset:45056
    v_mfma_f32_16x16x32_bf16 v[116:119], a[220:223], v[180:183], v[116:119]
    buffer_load_dwordx2 v[78:79], v3, s[20:23], 0 offen offset:32
    v_mfma_f32_16x16x32_bf16 v[116:119], a[216:219], v[196:199], v[116:119]
    ds_read_b64_tr_b16 a[184:185], v27 offset:49152
    ds_read_b64_tr_b16 a[186:187], v27 offset:53248
    v_mfma_f32_16x16x32_bf16 v[116:119], a[212:215], v[148:151], v[116:119]
    ds_read_b64_tr_b16 a[188:189], v27 offset:57344
    v_mfma_f32_16x16x32_bf16 v[116:119], a[208:211], v[132:135], v[116:119]
    ds_read_b64_tr_b16 a[190:191], v27 offset:61440
    s_waitcnt vmcnt(25)
    s_waitcnt lgkmcnt(0)
    s_barrier
    v_mfma_f32_16x16x32_bf16 v[120:123], a[160:163], v[128:131], 0
    ds_read_b64_tr_b16 a[208:209], v12 offset:0
    v_mfma_f32_16x16x32_bf16 v[120:123], a[164:167], v[144:147], v[120:123]
    ds_read_b64_tr_b16 a[210:211], v12 offset:4096
    v_mfma_f32_16x16x32_bf16 v[120:123], a[168:171], v[192:195], v[120:123]
    buffer_load_dwordx2 v[80:81], v3, s[20:23], 0 offen offset:512
    v_mfma_f32_16x16x32_bf16 v[120:123], a[172:175], v[176:179], v[120:123]
    s_add_u32 s39, s39, 16
    ds_read_b64_tr_b16 a[212:213], v12 offset:8192
    ds_read_b64_tr_b16 a[214:215], v12 offset:12288
    v_mfma_f32_16x16x32_bf16 v[120:123], a[176:179], v[136:139], v[120:123]
    buffer_load_dword v11, v9, s[24:27], s39 offen sc1
    v_mfma_f32_16x16x32_bf16 v[120:123], a[180:183], v[152:155], v[120:123]
    ds_read_b64_tr_b16 a[216:217], v12 offset:16384
    ds_read_b64_tr_b16 a[218:219], v12 offset:20480
    v_mfma_f32_16x16x32_bf16 v[120:123], a[184:187], v[200:203], v[120:123]
    ds_read_b64_tr_b16 a[220:221], v12 offset:24576
    v_mfma_f32_16x16x32_bf16 v[120:123], a[188:191], v[184:187], v[120:123]
    ds_read_b64_tr_b16 a[222:223], v12 offset:28672
    v_mfma_f32_16x16x32_bf16 v[124:127], a[188:191], v[188:191], 0
    buffer_load_dwordx2 v[82:83], v3, s[20:23], 0 offen offset:544
    v_mfma_f32_16x16x32_bf16 v[124:127], a[184:187], v[204:207], v[124:127]
    ds_read_b64_tr_b16 a[224:225], v16 offset:0
    ds_read_b64_tr_b16 a[226:227], v16 offset:4096
    v_mfma_f32_16x16x32_bf16 v[124:127], a[180:183], v[156:159], v[124:127]
    ds_read_b64_tr_b16 a[228:229], v16 offset:8192
    v_mfma_f32_16x16x32_bf16 v[124:127], a[176:179], v[140:143], v[124:127]
    ds_read_b64_tr_b16 a[230:231], v16 offset:12288
    v_mfma_f32_16x16x32_bf16 v[124:127], a[172:175], v[180:183], v[124:127]
    buffer_load_dwordx2 v[84:85], v55, s[20:23], 0 offen offset:1024
    v_mfma_f32_16x16x32_bf16 v[124:127], a[168:171], v[196:199], v[124:127]
    ds_read_b64_tr_b16 a[232:233], v16 offset:16384
    ds_read_b64_tr_b16 a[234:235], v16 offset:20480
    v_mfma_f32_16x16x32_bf16 v[124:127], a[164:167], v[148:151], v[124:127]
    ds_read_b64_tr_b16 a[236:237], v16 offset:24576
    v_mfma_f32_16x16x32_bf16 v[124:127], a[160:163], v[132:135], v[124:127]
    s_waitcnt lgkmcnt(13)
    ds_read_b64_tr_b16 a[238:239], v16 offset:28672
    v_mfma_f32_16x16x32_bf16 v[96:99], a[208:211], a[64:67], v[96:99]
    s_waitcnt lgkmcnt(12)
    buffer_load_dwordx2 v[86:87], v55, s[20:23], 0 offen offset:1056
    v_mfma_f32_16x16x32_bf16 v[96:99], a[212:215], a[68:71], v[96:99]
    s_waitcnt lgkmcnt(10)
    ds_read_b64_tr_b16 a[160:161], v13 offset:0
    ds_read_b64_tr_b16 a[162:163], v13 offset:4096
    v_mfma_f32_16x16x32_bf16 v[96:99], a[216:219], a[72:75], v[96:99]
    s_waitcnt lgkmcnt(10)
    ds_read_b64_tr_b16 a[164:165], v13 offset:8192
    v_mfma_f32_16x16x32_bf16 v[96:99], a[220:223], a[76:79], v[96:99]
    s_waitcnt lgkmcnt(9)
    ds_read_b64_tr_b16 a[166:167], v13 offset:12288
    v_mfma_f32_16x16x32_bf16 v[96:99], a[224:227], a[80:83], v[96:99]
    s_waitcnt lgkmcnt(8)
    ds_read_b64_tr_b16 a[168:169], v13 offset:16384
Ltour11:
    s_cbranch_execz Ltour15
    v_mfma_f32_16x16x32_bf16 v[96:99], a[228:231], a[84:87], v[96:99]
    s_waitcnt lgkmcnt(7)
    s_mov_b32 s45, 22144
    ds_read_b64_tr_b16 a[170:171], v13 offset:20480
    v_mfma_f32_16x16x32_bf16 v[96:99], a[232:235], a[88:91], v[96:99]
    s_waitcnt lgkmcnt(6)
    buffer_load_dwordx4 v[216:219], v5, s[24:27], s45 offen offset:0 sc1
    v_mfma_f32_16x16x32_bf16 v[96:99], a[236:239], a[92:95], v[96:99]
    ds_read_b64_tr_b16 a[172:173], v13 offset:24576
    ds_read_b64_tr_b16 a[174:175], v13 offset:28672
    v_mfma_f32_16x16x32_bf16 v[100:103], a[236:239], a[124:127], v[100:103]
    ds_read_b64_tr_b16 a[176:177], v17 offset:0
    v_mfma_f32_16x16x32_bf16 v[100:103], a[232:235], a[120:123], v[100:103]
    ds_read_b64_tr_b16 a[178:179], v17 offset:4096
    v_mfma_f32_16x16x32_bf16 v[100:103], a[228:231], a[116:119], v[100:103]
    buffer_load_dwordx4 v[220:223], v5, s[24:27], s45 offen offset:512 sc1
    v_mfma_f32_16x16x32_bf16 v[100:103], a[224:227], a[112:115], v[100:103]
    ds_read_b64_tr_b16 a[180:181], v17 offset:8192
    ds_read_b64_tr_b16 a[182:183], v17 offset:12288
    v_mfma_f32_16x16x32_bf16 v[100:103], a[220:223], a[108:111], v[100:103]
    ds_read_b64_tr_b16 a[184:185], v17 offset:16384
    v_cvt_pk_bf16_f32 v224, v96, v97
    v_mfma_f32_16x16x32_bf16 v[100:103], a[216:219], a[104:107], v[100:103]
    ds_read_b64_tr_b16 a[186:187], v17 offset:20480
    v_cvt_pk_bf16_f32 v225, v98, v99
    v_mfma_f32_16x16x32_bf16 v[100:103], a[212:215], a[100:103], v[100:103]
    ds_read_b64_tr_b16 a[188:189], v17 offset:24576
    v_mfma_f32_16x16x32_bf16 v[100:103], a[208:211], a[96:99], v[100:103]
    s_waitcnt lgkmcnt(13)
    ds_read_b64_tr_b16 a[190:191], v17 offset:28672
    v_mfma_f32_16x16x32_bf16 v[104:107], a[160:163], a[64:67], v[104:107]
    s_waitcnt lgkmcnt(12)
    buffer_load_dwordx4 v[88:91], v59, s[24:27], s45 offen offset:1024 sc1
    v_mfma_f32_16x16x32_bf16 v[104:107], a[164:167], a[68:71], v[104:107]
    s_waitcnt lgkmcnt(10)
    ds_read_b64_tr_b16 a[208:209], v14 offset:0
    ds_read_b64_tr_b16 a[210:211], v14 offset:4096
    v_mfma_f32_16x16x32_bf16 v[104:107], a[168:171], a[72:75], v[104:107]
    s_waitcnt lgkmcnt(10)
    ds_read_b64_tr_b16 a[212:213], v14 offset:8192
    v_mfma_f32_16x16x32_bf16 v[104:107], a[172:175], a[76:79], v[104:107]
    s_waitcnt lgkmcnt(9)
    ds_read_b64_tr_b16 a[214:215], v14 offset:12288
    v_mfma_f32_16x16x32_bf16 v[104:107], a[176:179], a[80:83], v[104:107]
    s_waitcnt lgkmcnt(8)
    ds_read_b64_tr_b16 a[216:217], v14 offset:16384
    v_cvt_pk_bf16_f32 v228, v100, v101
    v_mfma_f32_16x16x32_bf16 v[104:107], a[180:183], a[84:87], v[104:107]
    s_waitcnt lgkmcnt(7)
    ds_read_b64_tr_b16 a[218:219], v14 offset:20480
    v_cvt_pk_bf16_f32 v229, v102, v103
    v_mfma_f32_16x16x32_bf16 v[104:107], a[184:187], a[88:91], v[104:107]
    s_waitcnt lgkmcnt(6)
    ds_read_b64_tr_b16 a[220:221], v14 offset:24576
    v_mfma_f32_16x16x32_bf16 v[104:107], a[188:191], a[92:95], v[104:107]
    ds_read_b64_tr_b16 a[222:223], v14 offset:28672
    v_mfma_f32_16x16x32_bf16 v[108:111], a[188:191], a[124:127], v[108:111]
    ds_read_b64_tr_b16 a[224:225], v18 offset:0
    v_mfma_f32_16x16x32_bf16 v[108:111], a[184:187], a[120:123], v[108:111]
    ds_read_b64_tr_b16 a[226:227], v18 offset:4096
    v_mfma_f32_16x16x32_bf16 v[108:111], a[180:183], a[116:119], v[108:111]
    ds_read_b64_tr_b16 a[228:229], v18 offset:8192
    v_mfma_f32_16x16x32_bf16 v[108:111], a[176:179], a[112:115], v[108:111]
    ds_read_b64_tr_b16 a[230:231], v18 offset:12288
    v_mfma_f32_16x16x32_bf16 v[108:111], a[172:175], a[108:111], v[108:111]
    ds_read_b64_tr_b16 a[232:233], v18 offset:16384
    v_cvt_pk_bf16_f32 v226, v104, v105
    v_mfma_f32_16x16x32_bf16 v[108:111], a[168:171], a[104:107], v[108:111]
    s_add_u32 s38, s93, 1536
    ds_read_b64_tr_b16 a[234:235], v18 offset:20480
    v_cvt_pk_bf16_f32 v227, v106, v107
    v_mfma_f32_16x16x32_bf16 v[108:111], a[164:167], a[100:103], v[108:111]
    buffer_store_dwordx4 v[224:227], v56, s[28:31], s38 offen sc1
    v_mfma_f32_16x16x32_bf16 v[108:111], a[160:163], a[96:99], v[108:111]
    s_waitcnt lgkmcnt(12)
    ds_read_b64_tr_b16 a[236:237], v18 offset:24576
    ds_read_b64_tr_b16 a[238:239], v18 offset:28672
    v_mfma_f32_16x16x32_bf16 v[112:115], a[208:211], a[64:67], v[112:115]
    s_waitcnt lgkmcnt(12)
    ds_read_b64_tr_b16 a[160:161], v15 offset:0
    v_mfma_f32_16x16x32_bf16 v[112:115], a[212:215], a[68:71], v[112:115]
    s_waitcnt lgkmcnt(11)
    ds_read_b64_tr_b16 a[162:163], v15 offset:4096
    v_mfma_f32_16x16x32_bf16 v[112:115], a[216:219], a[72:75], v[112:115]
    s_waitcnt lgkmcnt(10)
    ds_read_b64_tr_b16 a[164:165], v15 offset:8192
    v_mfma_f32_16x16x32_bf16 v[112:115], a[220:223], a[76:79], v[112:115]
    s_waitcnt lgkmcnt(9)
    ds_read_b64_tr_b16 a[166:167], v15 offset:12288
    v_mfma_f32_16x16x32_bf16 v[112:115], a[224:227], a[80:83], v[112:115]
    s_waitcnt lgkmcnt(8)
    ds_read_b64_tr_b16 a[168:169], v15 offset:16384
    v_cvt_pk_bf16_f32 v230, v108, v109
    v_mfma_f32_16x16x32_bf16 v[112:115], a[228:231], a[84:87], v[112:115]
    s_waitcnt lgkmcnt(7)
    s_add_u32 s38, s93, 165376
    ds_read_b64_tr_b16 a[170:171], v15 offset:20480
    v_cvt_pk_bf16_f32 v231, v110, v111
    v_mfma_f32_16x16x32_bf16 v[112:115], a[232:235], a[88:91], v[112:115]
    s_waitcnt lgkmcnt(6)
    buffer_store_dwordx4 v[228:231], v56, s[28:31], s38 offen sc1
    v_mfma_f32_16x16x32_bf16 v[112:115], a[236:239], a[92:95], v[112:115]
    ds_read_b64_tr_b16 a[172:173], v15 offset:24576
    ds_read_b64_tr_b16 a[174:175], v15 offset:28672
    v_mfma_f32_16x16x32_bf16 v[116:119], a[236:239], a[124:127], v[116:119]
    ds_read_b64_tr_b16 a[176:177], v19 offset:0
    v_mfma_f32_16x16x32_bf16 v[116:119], a[232:235], a[120:123], v[116:119]
    ds_read_b64_tr_b16 a[178:179], v19 offset:4096
    v_mfma_f32_16x16x32_bf16 v[116:119], a[228:231], a[116:119], v[116:119]
    ds_read_b64_tr_b16 a[180:181], v19 offset:8192
    v_mfma_f32_16x16x32_bf16 v[116:119], a[224:227], a[112:115], v[116:119]
    ds_read_b64_tr_b16 a[182:183], v19 offset:12288
    v_mfma_f32_16x16x32_bf16 v[116:119], a[220:223], a[108:111], v[116:119]
    ds_read_b64_tr_b16 a[184:185], v19 offset:16384
    v_cvt_pk_bf16_f32 v232, v112, v113
    v_mfma_f32_16x16x32_bf16 v[116:119], a[216:219], a[104:107], v[116:119]
    ds_read_b64_tr_b16 a[186:187], v19 offset:20480
    v_cvt_pk_bf16_f32 v233, v114, v115
    v_mfma_f32_16x16x32_bf16 v[116:119], a[212:215], a[100:103], v[116:119]
    ds_read_b64_tr_b16 a[188:189], v19 offset:24576
    v_mfma_f32_16x16x32_bf16 v[116:119], a[208:211], a[96:99], v[116:119]
    s_waitcnt lgkmcnt(13)
    ds_read_b64_tr_b16 a[190:191], v19 offset:28672
    v_mfma_f32_16x16x32_bf16 v[120:123], a[160:163], a[64:67], v[120:123]
    s_waitcnt lgkmcnt(12)
    v_mfma_f32_16x16x32_bf16 v[120:123], a[164:167], a[68:71], v[120:123]
    s_waitcnt lgkmcnt(10)
    v_mfma_f32_16x16x32_bf16 v[120:123], a[168:171], a[72:75], v[120:123]
    s_waitcnt lgkmcnt(8)
    v_mfma_f32_16x16x32_bf16 v[120:123], a[172:175], a[76:79], v[120:123]
    s_waitcnt lgkmcnt(6)
    v_mfma_f32_16x16x32_bf16 v[120:123], a[176:179], a[80:83], v[120:123]
    s_waitcnt lgkmcnt(4)
    v_cvt_pk_bf16_f32 v236, v116, v117
    v_mfma_f32_16x16x32_bf16 v[120:123], a[180:183], a[84:87], v[120:123]
    s_waitcnt lgkmcnt(2)
    v_cvt_pk_bf16_f32 v237, v118, v119
    v_mfma_f32_16x16x32_bf16 v[120:123], a[184:187], a[88:91], v[120:123]
    s_waitcnt lgkmcnt(0)
    v_mfma_f32_16x16x32_bf16 v[120:123], a[188:191], a[92:95], v[120:123]
    v_mfma_f32_16x16x32_bf16 v[124:127], a[188:191], a[124:127], v[124:127]
    v_mfma_f32_16x16x32_bf16 v[124:127], a[184:187], a[120:123], v[124:127]
    v_mfma_f32_16x16x32_bf16 v[124:127], a[180:183], a[116:119], v[124:127]
    v_mfma_f32_16x16x32_bf16 v[124:127], a[176:179], a[112:115], v[124:127]
    v_mfma_f32_16x16x32_bf16 v[124:127], a[172:175], a[108:111], v[124:127]
    s_nop 2
    v_cvt_pk_bf16_f32 v234, v120, v121
    v_mfma_f32_16x16x32_bf16 v[124:127], a[168:171], a[104:107], v[124:127]
    s_add_u32 s38, s93, 1664
    v_cvt_pk_bf16_f32 v235, v122, v123
    v_mfma_f32_16x16x32_bf16 v[124:127], a[164:167], a[100:103], v[124:127]
    buffer_store_dwordx4 v[232:235], v56, s[28:31], s38 offen sc1
    v_mfma_f32_16x16x32_bf16 v[124:127], a[160:163], a[96:99], v[124:127]
    s_nop 7
    v_cvt_pk_bf16_f32 v238, v124, v125
    s_add_u32 s38, s93, 165504
    v_cvt_pk_bf16_f32 v239, v126, v127
    buffer_store_dwordx4 v[236:239], v56, s[28:31], s38 offen sc1
    s_add_u32 s92, s92, 16
    s_waitcnt vmcnt(35)
    v_lshlrev_b32 v96, 16, v160
    v_and_b32 v97, 0xffff0000, v160
    v_lshlrev_b32 v98, 16, v161
    v_and_b32 v99, 0xffff0000, v161
    v_lshlrev_b32 v100, 16, v162
    v_and_b32 v101, 0xffff0000, v162
    v_lshlrev_b32 v102, 16, v163
    v_and_b32 v103, 0xffff0000, v163
    s_waitcnt vmcnt(34)
    v_lshlrev_b32 v104, 16, v164
    v_and_b32 v105, 0xffff0000, v164
    v_lshlrev_b32 v106, 16, v165
    v_and_b32 v107, 0xffff0000, v165
    v_lshlrev_b32 v108, 16, v166
    v_and_b32 v109, 0xffff0000, v166
    v_lshlrev_b32 v110, 16, v167
    v_and_b32 v111, 0xffff0000, v167
    s_waitcnt vmcnt(32)
    v_lshlrev_b32 v112, 16, v168
    v_and_b32 v113, 0xffff0000, v168
    v_lshlrev_b32 v114, 16, v169
    v_and_b32 v115, 0xffff0000, v169
    v_lshlrev_b32 v116, 16, v170
    v_and_b32 v117, 0xffff0000, v170
    v_lshlrev_b32 v118, 16, v171
    v_and_b32 v119, 0xffff0000, v171
    s_waitcnt vmcnt(31)
    v_lshlrev_b32 v120, 16, v172
    v_and_b32 v121, 0xffff0000, v172
    v_lshlrev_b32 v122, 16, v173
    v_and_b32 v123, 0xffff0000, v173
    v_lshlrev_b32 v124, 16, v174
    v_and_b32 v125, 0xffff0000, v174
    v_lshlrev_b32 v126, 16, v175
    v_and_b32 v127, 0xffff0000, v175
    s_waitcnt vmcnt(30)
    v_lshlrev_b32 v128, 16, v208
    v_and_b32 v129, 0xffff0000, v208
    v_lshlrev_b32 v130, 16, v209
    v_and_b32 v131, 0xffff0000, v209
    v_lshlrev_b32 v132, 16, v210
    v_and_b32 v133, 0xffff0000, v210
    v_lshlrev_b32 v134, 16, v211
    v_and_b32 v135, 0xffff0000, v211
    s_waitcnt vmcnt(28)
    v_lshlrev_b32 v136, 16, v212
    v_and_b32 v137, 0xffff0000, v212
    v_lshlrev_b32 v138, 16, v213
    v_and_b32 v139, 0xffff0000, v213
    v_lshlrev_b32 v140, 16, v214
    v_and_b32 v141, 0xffff0000, v214
    v_lshlrev_b32 v142, 16, v215
    v_and_b32 v143, 0xffff0000, v215
    s_waitcnt vmcnt(19)
    v_lshlrev_b32 v144, 16, v64
    v_and_b32 v145, 0xffff0000, v64
    v_lshlrev_b32 v146, 16, v65
    v_and_b32 v147, 0xffff0000, v65
    v_lshlrev_b32 v148, 16, v66
    v_and_b32 v149, 0xffff0000, v66
    v_lshlrev_b32 v150, 16, v67
    v_and_b32 v151, 0xffff0000, v67
    s_waitcnt vmcnt(16)
    v_lshlrev_b32 v152, 16, v68
    v_and_b32 v153, 0xffff0000, v68
    v_lshlrev_b32 v154, 16, v69
    v_and_b32 v155, 0xffff0000, v69
    v_lshlrev_b32 v156, 16, v70
    v_and_b32 v157, 0xffff0000, v70
    v_lshlrev_b32 v158, 16, v71
    v_and_b32 v159, 0xffff0000, v71
    s_waitcnt vmcnt(14)
    v_lshlrev_b32 v160, 16, v72
    v_and_b32 v161, 0xffff0000, v72
    v_lshlrev_b32 v162, 16, v73
    v_and_b32 v163, 0xffff0000, v73
    v_lshlrev_b32 v164, 16, v74
    v_and_b32 v165, 0xffff0000, v74
    v_lshlrev_b32 v166, 16, v75
    v_and_b32 v167, 0xffff0000, v75
    s_waitcnt vmcnt(13)
    v_lshlrev_b32 v168, 16, v76
    v_and_b32 v169, 0xffff0000, v76
    v_lshlrev_b32 v170, 16, v77
    v_and_b32 v171, 0xffff0000, v77
    s_waitcnt vmcnt(12)
    v_lshlrev_b32 v172, 16, v78
    v_and_b32 v173, 0xffff0000, v78
    v_lshlrev_b32 v174, 16, v79
    v_and_b32 v175, 0xffff0000, v79
    s_waitcnt vmcnt(11)
    v_lshlrev_b32 v176, 16, v80
    v_and_b32 v177, 0xffff0000, v80
    v_lshlrev_b32 v178, 16, v81
    v_and_b32 v179, 0xffff0000, v81
    s_waitcnt vmcnt(9)
    v_lshlrev_b32 v180, 16, v82
    v_and_b32 v181, 0xffff0000, v82
    v_lshlrev_b32 v182, 16, v83
    v_and_b32 v183, 0xffff0000, v83
    s_waitcnt vmcnt(8)
    v_lshlrev_b32 v184, 16, v84
    v_and_b32 v185, 0xffff0000, v84
    v_lshlrev_b32 v186, 16, v85
    v_and_b32 v187, 0xffff0000, v85
    s_waitcnt vmcnt(7)
    v_lshlrev_b32 v188, 16, v86
    v_and_b32 v189, 0xffff0000, v86
    v_lshlrev_b32 v190, 16, v87
    v_and_b32 v191, 0xffff0000, v87
    s_waitcnt vmcnt(0)
    buffer_store_dword v10, v8, s[24:27], s92 offen sc1
    v_cmp_ne_u32 s[54:55], s95, v11
    s_cmp_lg_u64 s[54:55], 0
    s_cbranch_scc1 Ltail_spin1
Ltail_got1:
    s_add_u32 s56, s44, 16384
    buffer_load_dwordx4 a[0:3], v54, s[28:31], s56 offen offset:0 sc1
    buffer_load_dwordx4 a[4:7], v54, s[28:31], s56 offen offset:1024 sc1
    buffer_load_dwordx4 a[8:11], v54, s[28:31], s56 offen offset:2048 sc1
    buffer_load_dwordx4 a[12:15], v54, s[28:31], s56 offen offset:3072 sc1
    s_add_u32 s56, s44, 0
    buffer_load_dwordx4 a[16:19], v2, s[28:31], s56 offen offset:0 sc1
    s_add_u32 s56, s44, 4096
    buffer_load_dwordx4 a[20:23], v2, s[28:31], s56 offen offset:0 sc1
    s_add_u32 s56, s44, 8192
    buffer_load_dwordx4 a[24:27], v2, s[28:31], s56 offen offset:0 sc1
    s_add_u32 s56, s44, 12288
    buffer_load_dwordx4 a[28:31], v2, s[28:31], s56 offen offset:0 sc1
    ds_write_b128 v51, a[128:131] offset:0
    ds_write_b128 v51, a[132:135] offset:4096
    ds_write_b128 v51, a[136:139] offset:8192
    ds_write_b128 v51, a[140:143] offset:12288
    ds_write_b128 v51, a[144:147] offset:16384
    ds_write_b128 v51, a[148:151] offset:20480
    ds_write_b128 v51, a[152:155] offset:24576
    ds_write_b128 v51, a[156:159] offset:28672
    ds_write_b128 v51, a[240:243] offset:32768
    ds_write_b128 v255, a[244:247] offset:40960
    ds_write_b128 v255, a[248:251] offset:45056
    ds_write_b128 v255, a[252:255] offset:61440
    v_lshlrev_b32 v12, 16, v36
    v_and_b32 v13, 0xffff0000, v36
    v_lshlrev_b32 v14, 16, v37
    v_and_b32 v15, 0xffff0000, v37
    v_lshlrev_b32 v16, 16, v38
    v_and_b32 v17, 0xffff0000, v38
    v_lshlrev_b32 v18, 16, v39
    v_and_b32 v19, 0xffff0000, v39
    v_lshlrev_b32 v20, 16, v40
    v_and_b32 v21, 0xffff0000, v40
    v_lshlrev_b32 v22, 16, v41
    v_and_b32 v23, 0xffff0000, v41
    v_lshlrev_b32 v24, 16, v42
    v_and_b32 v25, 0xffff0000, v42
    v_lshlrev_b32 v26, 16, v43
    v_and_b32 v27, 0xffff0000, v43
    v_lshlrev_b32 v28, 16, v92
    v_and_b32 v29, 0xffff0000, v92
    v_lshlrev_b32 v30, 16, v93
    v_and_b32 v31, 0xffff0000, v93
    v_lshlrev_b32 v32, 16, v94
    v_and_b32 v33, 0xffff0000, v94
    v_lshlrev_b32 v34, 16, v95
    v_and_b32 v35, 0xffff0000, v95
    v_lshlrev_b32 v192, 16, v216
    v_and_b32 v193, 0xffff0000, v216
    v_lshlrev_b32 v194, 16, v217
    v_and_b32 v195, 0xffff0000, v217
    v_lshlrev_b32 v196, 16, v218
    v_and_b32 v197, 0xffff0000, v218
    v_lshlrev_b32 v198, 16, v219
    v_and_b32 v199, 0xffff0000, v219
    v_lshlrev_b32 v200, 16, v220
    v_and_b32 v201, 0xffff0000, v220
    v_lshlrev_b32 v202, 16, v221
    v_and_b32 v203, 0xffff0000, v221
    v_lshlrev_b32 v204, 16, v222
    v_and_b32 v205, 0xffff0000, v222
    v_lshlrev_b32 v206, 16, v223
    v_and_b32 v207, 0xffff0000, v223
    v_lshlrev_b32 v208, 16, v88
    v_and_b32 v209, 0xffff0000, v88
    v_lshlrev_b32 v210, 16, v89
    v_and_b32 v211, 0xffff0000, v89
    v_lshlrev_b32 v212, 16, v90
    v_and_b32 v213, 0xffff0000, v90
    v_lshlrev_b32 v214, 16, v91
    v_and_b32 v215, 0xffff0000, v91
    s_add_u32 s39, s39, 16
    buffer_load_dword v11, v9, s[24:27], s39 offen sc1
    s_add_u32 s56, s44, 0
    buffer_load_dwordx4 a[32:35], v2, s[28:31], s56 offen offset:512 sc1
    s_add_u32 s56, s44, 4096
    buffer_load_dwordx4 a[36:39], v2, s[28:31], s56 offen offset:512 sc1
    s_add_u32 s56, s44, 8192
    buffer_load_dwordx4 a[40:43], v2, s[28:31], s56 offen offset:512 sc1
    s_add_u32 s56, s44, 12288
    buffer_load_dwordx4 a[44:47], v2, s[28:31], s56 offen offset:512 sc1
    v_lshrrev_b32 v56, 2, v1
    v_and_b32 v57, 3, v1
    v_lshlrev_b32 v57, 3, v57
    s_and_b32 s36, s3, 1
    s_lshl_b32 s36, s36, 5
    v_lshl_add_u32 v61, v56, 6, v57
    v_add_u32 v61, s36, v61
    s_mov_b32 s36, 135168
    s_mov_b32 s37, 12288
    s_cmp_lt_u32 s3, 2
    s_cselect_b32 s36, 98304, s36
    s_cselect_b32 s37, 98304, s37
    v_add_u32 v94, s37, v61
    v_add_u32 v61, s36, v61
    v_mul_u32_u24 v95, 1152, v56
    s_lshl_b32 s36, s3, 7
    s_add_u32 s36, s36, 61440
    v_add3_u32 v95, v95, v57, s36
    s_waitcnt lgkmcnt(0)
    s_barrier
    ds_read_b64_tr_b16 a[96:97], v61 offset:0
    ds_read_b64_tr_b16 a[98:99], v61 offset:1024
    ds_read_b64_tr_b16 a[100:101], v61 offset:2048
    ds_read_b64_tr_b16 a[102:103], v61 offset:3072
    ds_read_b64_tr_b16 a[104:105], v61 offset:4096
    ds_read_b64_tr_b16 a[106:107], v61 offset:5120
    ds_read_b64_tr_b16 a[108:109], v61 offset:6144
    ds_read_b64_tr_b16 a[110:111], v61 offset:7168
    ds_read_b64_tr_b16 a[112:113], v61 offset:8192
    ds_read_b64_tr_b16 a[114:115], v61 offset:9216
    ds_read_b64_tr_b16 a[116:117], v61 offset:10240
    ds_read_b64_tr_b16 a[118:119], v61 offset:11264
    ds_read_b64_tr_b16 a[120:121], v61 offset:12288
    ds_read_b64_tr_b16 a[122:123], v61 offset:13312
    ds_read_b64_tr_b16 a[124:125], v61 offset:14336
    ds_read_b64_tr_b16 a[126:127], v61 offset:15360
    ds_read_b64_tr_b16 a[128:129], v61 offset:16384
    ds_read_b64_tr_b16 a[130:131], v61 offset:17408
    ds_read_b64_tr_b16 a[132:133], v61 offset:18432
    ds_read_b64_tr_b16 a[134:135], v61 offset:19456
    ds_read_b64_tr_b16 a[136:137], v61 offset:20480
    ds_read_b64_tr_b16 a[138:139], v61 offset:21504
    ds_read_b64_tr_b16 a[140:141], v61 offset:22528
    ds_read_b64_tr_b16 a[142:143], v61 offset:23552
    ds_read_b64_tr_b16 a[144:145], v61 offset:24576
    ds_read_b64_tr_b16 a[146:147], v61 offset:25600
    ds_read_b64_tr_b16 a[148:149], v61 offset:26624
    ds_read_b64_tr_b16 a[150:151], v61 offset:27648
    ds_read_b64_tr_b16 a[152:153], v94 offset:28672
    ds_read_b64_tr_b16 a[154:155], v94 offset:29696
    ds_read_b64_tr_b16 a[156:157], v94 offset:30720
    ds_read_b64_tr_b16 a[158:159], v94 offset:31744
    ds_read_b64_tr_b16 a[160:161], v94 offset:32768
    ds_read_b64_tr_b16 a[162:163], v94 offset:33792
    ds_read_b64_tr_b16 a[164:165], v94 offset:34816
    ds_read_b64_tr_b16 a[166:167], v94 offset:35840
    ds_read_b64_tr_b16 a[168:169], v95 offset:0
    ds_read_b64_tr_b16 a[170:171], v95 offset:18432
    ds_read_b64_tr_b16 a[172:173], v95 offset:32
    ds_read_b64_tr_b16 a[174:175], v95 offset:18464
    ds_read_b64_tr_b16 a[176:177], v95 offset:64
    ds_read_b64_tr_b16 a[178:179], v95 offset:18496
    ds_read_b64_tr_b16 a[180:181], v95 offset:96
    ds_read_b64_tr_b16 a[182:183], v95 offset:18528
    ds_read_b64_tr_b16 a[184:185], v95 offset:512
    ds_read_b64_tr_b16 a[186:187], v95 offset:18944
    ds_read_b64_tr_b16 a[188:189], v95 offset:544
    ds_read_b64_tr_b16 a[190:191], v95 offset:18976
    ds_read_b64_tr_b16 a[192:193], v95 offset:576
    ds_read_b64_tr_b16 a[194:195], v95 offset:19008
    ds_read_b64_tr_b16 a[196:197], v95 offset:608
    ds_read_b64_tr_b16 a[198:199], v95 offset:19040
    ds_read_b64_tr_b16 a[200:201], v95 offset:1024
    ds_read_b64_tr_b16 a[202:203], v95 offset:19456
    ds_read_b64_tr_b16 a[204:205], v95 offset:1056
    ds_read_b64_tr_b16 a[206:207], v95 offset:19488
    ds_read_b64_tr_b16 a[208:209], v95 offset:1088
    ds_read_b64_tr_b16 a[210:211], v95 offset:19520
    ds_read_b64_tr_b16 a[212:213], v95 offset:1120
    ds_read_b64_tr_b16 a[214:215], v95 offset:19552
    v_pk_mul_f32 v[62:63], v[144:145], v[168:169]
    v_pk_mul_f32 v[168:169], v[168:169], v[120:121]
    v_pk_fma_f32 v[62:63], v[146:147], v[170:171], v[62:63]
    v_pk_mul_f32 v[170:171], v[170:171], v[122:123]
    v_pk_add_f32 v[88:89], v[168:169], v[170:171]
    v_pk_fma_f32 v[62:63], v[148:149], v[172:173], v[62:63]
    v_pk_mul_f32 v[172:173], v[172:173], v[124:125]
    v_pk_add_f32 v[88:89], v[88:89], v[172:173]
    v_pk_fma_f32 v[62:63], v[150:151], v[174:175], v[62:63]
    v_pk_mul_f32 v[174:175], v[174:175], v[126:127]
    v_pk_add_f32 v[88:89], v[88:89], v[174:175]
    v_pk_fma_f32 v[62:63], v[152:153], v[176:177], v[62:63]
    v_pk_mul_f32 v[176:177], v[176:177], v[128:129]
    v_pk_add_f32 v[88:89], v[88:89], v[176:177]
    v_pk_fma_f32 v[62:63], v[154:155], v[178:179], v[62:63]
    v_pk_mul_f32 v[178:179], v[178:179], v[130:131]
    v_pk_add_f32 v[88:89], v[88:89], v[178:179]
    v_pk_fma_f32 v[62:63], v[156:157], v[180:181], v[62:63]
    v_pk_mul_f32 v[180:181], v[180:181], v[132:133]
    v_pk_add_f32 v[88:89], v[88:89], v[180:181]
    v_pk_fma_f32 v[62:63], v[158:159], v[182:183], v[62:63]
    v_pk_mul_f32 v[182:183], v[182:183], v[134:135]
    v_pk_add_f32 v[88:89], v[88:89], v[182:183]
    v_pk_fma_f32 v[62:63], v[160:161], v[184:185], v[62:63]
    v_pk_mul_f32 v[184:185], v[184:185], v[136:137]
    v_pk_add_f32 v[88:89], v[88:89], v[184:185]
    v_pk_fma_f32 v[62:63], v[162:163], v[186:187], v[62:63]
    v_pk_mul_f32 v[186:187], v[186:187], v[138:139]
    v_pk_add_f32 v[88:89], v[88:89], v[186:187]
    v_pk_fma_f32 v[62:63], v[164:165], v[188:189], v[62:63]
    v_pk_mul_f32 v[188:189], v[188:189], v[140:141]
    v_pk_add_f32 v[88:89], v[88:89], v[188:189]
    v_pk_fma_f32 v[62:63], v[166:167], v[190:191], v[62:63]
    v_pk_mul_f32 v[190:191], v[190:191], v[142:143]
    v_pk_add_f32 v[88:89], v[88:89], v[190:191]
    v_add_f32 v91, v62, v63
    v_add_f32 v90, v88, v89
    s_nop 1
    v_add_f32_dpp v90, v90, v90 row_ror:8 row_mask:0xf bank_mask:0xf
    v_add_f32_dpp v91, v91, v91 row_ror:8 row_mask:0xf bank_mask:0xf
    s_nop 0
    v_add_f32_dpp v90, v90, v90 row_ror:4 row_mask:0xf bank_mask:0xf
    v_add_f32_dpp v91, v91, v91 row_ror:4 row_mask:0xf bank_mask:0xf
    s_nop 0
    v_add_f32_dpp v90, v90, v90 row_ror:2 row_mask:0xf bank_mask:0xf
    v_add_f32_dpp v91, v91, v91 row_ror:2 row_mask:0xf bank_mask:0xf
    s_nop 0
    v_add_f32_dpp v90, v90, v90 row_ror:1 row_mask:0xf bank_mask:0xf
    v_add_f32_dpp v91, v91, v91 row_ror:1 row_mask:0xf bank_mask:0xf
    v_mov_b32 v62, v90
    v_mov_b32 v63, v91
    s_nop 0
    v_permlane16_swap_b32 v90, v62
    v_permlane16_swap_b32 v91, v63
    v_add_f32 v90, v90, v62
    v_add_f32 v91, v91, v63
    v_lshlrev_b32 v92, 2, v7
    v_and_b32 v92, 28, v92
    v_sub_u32 v93, 2047, v7
    s_waitcnt vmcnt(12)
    v_mfma_f32_16x16x32_bf16 v[80:83], v[242:245], a[0:3], 0
    v_mfma_f32_16x16x32_bf16 v[84:87], v[240:243], a[0:3], 0
    s_waitcnt vmcnt(11)
    v_mfma_f32_16x16x32_bf16 v[80:83], v[242:245], a[4:7], v[80:83]
    v_mfma_f32_16x16x32_bf16 v[84:87], v[240:243], a[4:7], v[84:87]
    s_waitcnt vmcnt(10)
    v_mfma_f32_16x16x32_bf16 v[80:83], v[242:245], a[8:11], v[80:83]
    v_mfma_f32_16x16x32_bf16 v[84:87], v[240:243], a[8:11], v[84:87]
    s_waitcnt vmcnt(9)
    v_mfma_f32_16x16x32_bf16 v[80:83], v[242:245], a[12:15], v[80:83]
    v_mfma_f32_16x16x32_bf16 v[84:87], v[240:243], a[12:15], v[84:87]
    s_waitcnt vmcnt(8)
    s_nop 5
    v_mov_b32_dpp v80, v80 row_ror:8 row_mask:0x4 bank_mask:0xf
    v_mov_b32_dpp v81, v81 row_ror:8 row_mask:0x4 bank_mask:0xf
    v_mov_b32_dpp v82, v82 row_ror:8 row_mask:0x4 bank_mask:0xf
    v_mov_b32_dpp v83, v83 row_ror:8 row_mask:0x4 bank_mask:0xf
    v_mov_b32_dpp v84, v84 row_ror:8 row_mask:0x4 bank_mask:0xf
    v_mov_b32_dpp v85, v85 row_ror:8 row_mask:0x4 bank_mask:0xf
    v_mov_b32_dpp v86, v86 row_ror:8 row_mask:0x4 bank_mask:0xf
    v_mov_b32_dpp v87, v87 row_ror:8 row_mask:0x4 bank_mask:0xf
    v_pk_fma_f32 v[28:29], v[112:113], v[80:81], v[28:29]
    v_pk_fma_f32 v[30:31], v[114:115], v[82:83], v[30:31]
    v_pk_fma_f32 v[32:33], v[116:117], v[84:85], v[32:33]
    v_pk_fma_f32 v[34:35], v[118:119], v[86:87], v[34:35]
    v_cvt_pk_bf16_f32 v44, v28, v29
    v_cvt_pk_bf16_f32 v45, v30, v31
    v_cvt_pk_bf16_f32 v46, v32, v33
    v_cvt_pk_bf16_f32 v47, v34, v35
    v_lshlrev_b32 v28, 16, v44
    v_and_b32 v29, 0xffff0000, v44
    v_lshlrev_b32 v30, 16, v45
    v_and_b32 v31, 0xffff0000, v45
    v_lshlrev_b32 v32, 16, v46
    v_and_b32 v33, 0xffff0000, v46
    v_lshlrev_b32 v34, 16, v47
    v_and_b32 v35, 0xffff0000, v47
    v_mfma_f32_16x16x32_bf16 v[64:67], v[246:249], a[16:19], 0
    v_mfma_f32_16x16x32_bf16 v[68:71], v[244:247], a[16:19], 0
    s_waitcnt vmcnt(7)
    v_mfma_f32_16x16x32_bf16 v[64:67], v[246:249], a[20:23], v[64:67]
    v_mfma_f32_16x16x32_bf16 v[68:71], v[244:247], a[20:23], v[68:71]
    s_waitcnt vmcnt(6)
    v_mfma_f32_16x16x32_bf16 v[64:67], v[246:249], a[24:27], v[64:67]
    v_mfma_f32_16x16x32_bf16 v[68:71], v[244:247], a[24:27], v[68:71]
    s_waitcnt vmcnt(5)
    v_mfma_f32_16x16x32_bf16 v[64:67], v[246:249], a[28:31], v[64:67]
    v_mfma_f32_16x16x32_bf16 v[68:71], v[244:247], a[28:31], v[68:71]
    s_waitcnt vmcnt(4)
    v_cmp_ne_u32 s[54:55], s95, v11
    s_cmp_lg_u64 s[54:55], 0
    s_cbranch_scc1 Ltail_spin2
Ltail_got2:
    s_add_u32 s56, s44, 0
    buffer_load_dwordx4 a[48:51], v2, s[28:31], s56 offen offset:1024 sc1
    s_add_u32 s56, s44, 4096
    buffer_load_dwordx4 a[52:55], v2, s[28:31], s56 offen offset:1024 sc1
    s_add_u32 s56, s44, 8192
    buffer_load_dwordx4 a[56:59], v2, s[28:31], s56 offen offset:1024 sc1
    s_add_u32 s56, s44, 12288
    buffer_load_dwordx4 a[60:63], v2, s[28:31], s56 offen offset:1024 sc1
    s_add_u32 s56, s44, 0
    buffer_load_dwordx4 a[64:67], v2, s[28:31], s56 offen offset:1536 sc1
    s_add_u32 s56, s44, 4096
    buffer_load_dwordx4 a[68:71], v2, s[28:31], s56 offen offset:1536 sc1
    s_add_u32 s56, s44, 8192
    buffer_load_dwordx4 a[72:75], v2, s[28:31], s56 offen offset:1536 sc1
    s_add_u32 s56, s44, 12288
    buffer_load_dwordx4 a[76:79], v2, s[28:31], s56 offen offset:1536 sc1
    s_movk_i32 s48, 0x7ff
    s_waitcnt vmcnt(11)
    v_mfma_f32_16x16x32_bf16 v[64:67], v[250:253], a[32:35], v[64:67]
    v_mfma_f32_16x16x32_bf16 v[68:71], v[248:251], a[32:35], v[68:71]
    s_waitcnt vmcnt(10)
    v_mfma_f32_16x16x32_bf16 v[64:67], v[250:253], a[36:39], v[64:67]
    v_mfma_f32_16x16x32_bf16 v[68:71], v[248:251], a[36:39], v[68:71]
    s_waitcnt vmcnt(9)
    v_mfma_f32_16x16x32_bf16 v[64:67], v[250:253], a[40:43], v[64:67]
    v_mfma_f32_16x16x32_bf16 v[68:71], v[248:251], a[40:43], v[68:71]
    s_waitcnt vmcnt(8)
    v_mfma_f32_16x16x32_bf16 v[64:67], v[250:253], a[44:47], v[64:67]
    v_mfma_f32_16x16x32_bf16 v[68:71], v[248:251], a[44:47], v[68:71]
    s_waitcnt vmcnt(7)
    s_nop 5
    v_pk_fma_f32 v[12:13], v[96:97], v[64:65], v[12:13]
    v_pk_fma_f32 v[14:15], v[98:99], v[66:67], v[14:15]
    v_pk_fma_f32 v[16:17], v[100:101], v[68:69], v[16:17]
    v_pk_fma_f32 v[18:19], v[102:103], v[70:71], v[18:19]
    v_cvt_pk_bf16_f32 v36, v12, v13
    v_cvt_pk_bf16_f32 v37, v14, v15
    v_cvt_pk_bf16_f32 v38, v16, v17
    v_cvt_pk_bf16_f32 v39, v18, v19
    v_lshlrev_b32 v12, 16, v36
    v_and_b32 v13, 0xffff0000, v36
    v_lshlrev_b32 v14, 16, v37
    v_and_b32 v15, 0xffff0000, v37
    v_lshlrev_b32 v16, 16, v38
    v_and_b32 v17, 0xffff0000, v38
    v_lshlrev_b32 v18, 16, v39
    v_and_b32 v19, 0xffff0000, v39
    v_pk_add_f32 v[88:89], v[12:13], v[14:15]
    v_pk_add_f32 v[62:63], v[16:17], v[18:19]
    v_pk_add_f32 v[88:89], v[88:89], v[62:63]
    v_add_f32 v88, v88, v89
Ltour12:
    s_cbranch_execz Ltour16
    s_nop 1
    v_add_f32_dpp v88, v88, v88 row_ror:8 row_mask:0xf bank_mask:0xf
    s_nop 1
    v_add_f32_dpp v88, v88, v88 row_ror:4 row_mask:0xf bank_mask:0xf
    s_nop 1
    v_add_f32_dpp v88, v88, v88 row_ror:2 row_mask:0xf bank_mask:0xf
    s_nop 1
    v_add_f32_dpp v88, v88, v88 row_ror:1 row_mask:0xf bank_mask:0xf
    v_mov_b32 v62, v88
    s_nop 1
    v_permlane16_swap_b32 v88, v62
    s_nop 0
    v_add_f32 v88, v88, v62
    v_mul_f32 v88, 0x3b800000, v88
    v_pk_add_f32 v[232:233], v[28:29], v[88:89] op_sel_hi:[1,0] neg_lo:[0,1] neg_hi:[0,1]
    v_pk_add_f32 v[234:235], v[30:31], v[88:89] op_sel_hi:[1,0] neg_lo:[0,1] neg_hi:[0,1]
    v_pk_add_f32 v[236:237], v[32:33], v[88:89] op_sel_hi:[1,0] neg_lo:[0,1] neg_hi:[0,1]
    v_pk_add_f32 v[238:239], v[34:35], v[88:89] op_sel_hi:[1,0] neg_lo:[0,1] neg_hi:[0,1]
    v_pk_add_f32 v[48:49], v[232:233], v[234:235]
    v_pk_mul_f32 v[50:51], v[232:233], v[232:233]
    v_pk_mul_f32 v[52:53], v[232:233], v[184:185]
    v_pk_fma_f32 v[50:51], v[234:235], v[234:235], v[50:51]
    v_pk_fma_f32 v[52:53], v[234:235], v[186:187], v[52:53]
    v_pk_add_f32 v[48:49], v[48:49], v[236:237]
    v_pk_fma_f32 v[50:51], v[236:237], v[236:237], v[50:51]
    v_pk_fma_f32 v[52:53], v[236:237], v[188:189], v[52:53]
    v_pk_add_f32 v[48:49], v[48:49], v[238:239]
    v_pk_fma_f32 v[50:51], v[238:239], v[238:239], v[50:51]
    v_pk_fma_f32 v[52:53], v[238:239], v[190:191], v[52:53]
    v_cndmask_b32 v48, 0, v48, vcc
    v_cndmask_b32 v49, 0, v49, vcc
    v_cndmask_b32 v50, 0, v50, vcc
    v_cndmask_b32 v51, 0, v51, vcc
    v_pk_add_f32 v[216:217], v[12:13], v[88:89] op_sel_hi:[1,0] neg_lo:[0,1] neg_hi:[0,1]
    v_pk_add_f32 v[218:219], v[14:15], v[88:89] op_sel_hi:[1,0] neg_lo:[0,1] neg_hi:[0,1]
    v_pk_add_f32 v[220:221], v[16:17], v[88:89] op_sel_hi:[1,0] neg_lo:[0,1] neg_hi:[0,1]
    v_pk_add_f32 v[222:223], v[18:19], v[88:89] op_sel_hi:[1,0] neg_lo:[0,1] neg_hi:[0,1]
    v_pk_add_f32 v[48:49], v[48:49], v[216:217]
    v_pk_fma_f32 v[50:51], v[216:217], v[216:217], v[50:51]
    v_pk_fma_f32 v[52:53], v[216:217], v[168:169], v[52:53]
    v_pk_add_f32 v[48:49], v[48:49], v[218:219]
    v_pk_fma_f32 v[50:51], v[218:219], v[218:219], v[50:51]
    v_pk_fma_f32 v[52:53], v[218:219], v[170:171], v[52:53]
    v_pk_add_f32 v[48:49], v[48:49], v[220:221]
    v_pk_fma_f32 v[50:51], v[220:221], v[220:221], v[50:51]
    v_pk_fma_f32 v[52:53], v[220:221], v[172:173], v[52:53]
    v_pk_add_f32 v[48:49], v[48:49], v[222:223]
    v_pk_fma_f32 v[50:51], v[222:223], v[222:223], v[50:51]
    v_pk_fma_f32 v[52:53], v[222:223], v[174:175], v[52:53]
    v_mfma_f32_16x16x32_bf16 v[72:75], v[246:249], a[48:51], 0
    v_mfma_f32_16x16x32_bf16 v[76:79], v[244:247], a[48:51], 0
    s_waitcnt vmcnt(6)
    v_mfma_f32_16x16x32_bf16 v[72:75], v[246:249], a[52:55], v[72:75]
    v_mfma_f32_16x16x32_bf16 v[76:79], v[244:247], a[52:55], v[76:79]
    s_waitcnt vmcnt(5)
    v_mfma_f32_16x16x32_bf16 v[72:75], v[246:249], a[56:59], v[72:75]
    v_mfma_f32_16x16x32_bf16 v[76:79], v[244:247], a[56:59], v[76:79]
    s_waitcnt vmcnt(4)
    v_mfma_f32_16x16x32_bf16 v[72:75], v[246:249], a[60:63], v[72:75]
    v_mfma_f32_16x16x32_bf16 v[76:79], v[244:247], a[60:63], v[76:79]
    s_waitcnt vmcnt(3)
    v_mfma_f32_16x16x32_bf16 v[72:75], v[250:253], a[64:67], v[72:75]
    v_mfma_f32_16x16x32_bf16 v[76:79], v[248:251], a[64:67], v[76:79]
    s_waitcnt vmcnt(2)
    v_mfma_f32_16x16x32_bf16 v[72:75], v[250:253], a[68:71], v[72:75]
    v_mfma_f32_16x16x32_bf16 v[76:79], v[248:251], a[68:71], v[76:79]
    s_waitcnt vmcnt(1)
    v_mfma_f32_16x16x32_bf16 v[72:75], v[250:253], a[72:75], v[72:75]
    v_mfma_f32_16x16x32_bf16 v[76:79], v[248:251], a[72:75], v[76:79]
    s_waitcnt vmcnt(0)
    v_mfma_f32_16x16x32_bf16 v[72:75], v[250:253], a[76:79], v[72:75]
    v_mfma_f32_16x16x32_bf16 v[76:79], v[248:251], a[76:79], v[76:79]
    s_nop 6
    v_pk_fma_f32 v[20:21], v[104:105], v[72:73], v[20:21]
    v_pk_fma_f32 v[22:23], v[106:107], v[74:75], v[22:23]
    v_pk_fma_f32 v[24:25], v[108:109], v[76:77], v[24:25]
    v_pk_fma_f32 v[26:27], v[110:111], v[78:79], v[26:27]
    v_cvt_pk_bf16_f32 v40, v20, v21
    v_cvt_pk_bf16_f32 v41, v22, v23
    v_cvt_pk_bf16_f32 v42, v24, v25
    v_cvt_pk_bf16_f32 v43, v26, v27
    v_lshlrev_b32 v20, 16, v40
    v_and_b32 v21, 0xffff0000, v40
    v_lshlrev_b32 v22, 16, v41
    v_and_b32 v23, 0xffff0000, v41
    v_lshlrev_b32 v24, 16, v42
    v_and_b32 v25, 0xffff0000, v42
    v_lshlrev_b32 v26, 16, v43
    v_and_b32 v27, 0xffff0000, v43
    v_pk_add_f32 v[224:225], v[20:21], v[88:89] op_sel_hi:[1,0] neg_lo:[0,1] neg_hi:[0,1]
    v_pk_add_f32 v[226:227], v[22:23], v[88:89] op_sel_hi:[1,0] neg_lo:[0,1] neg_hi:[0,1]
    v_pk_add_f32 v[228:229], v[24:25], v[88:89] op_sel_hi:[1,0] neg_lo:[0,1] neg_hi:[0,1]
    v_pk_add_f32 v[230:231], v[26:27], v[88:89] op_sel_hi:[1,0] neg_lo:[0,1] neg_hi:[0,1]
    v_pk_add_f32 v[48:49], v[48:49], v[224:225]
    v_pk_fma_f32 v[50:51], v[224:225], v[224:225], v[50:51]
    v_pk_fma_f32 v[52:53], v[224:225], v[176:177], v[52:53]
    v_pk_add_f32 v[48:49], v[48:49], v[226:227]
    v_pk_fma_f32 v[50:51], v[226:227], v[226:227], v[50:51]
    v_pk_fma_f32 v[52:53], v[226:227], v[178:179], v[52:53]
    v_pk_add_f32 v[48:49], v[48:49], v[228:229]
    v_pk_fma_f32 v[50:51], v[228:229], v[228:229], v[50:51]
    v_pk_fma_f32 v[52:53], v[228:229], v[180:181], v[52:53]
    v_pk_add_f32 v[48:49], v[48:49], v[230:231]
    v_pk_fma_f32 v[50:51], v[230:231], v[230:231], v[50:51]
    v_pk_fma_f32 v[52:53], v[230:231], v[182:183], v[52:53]
    v_add_f32 v48, v48, v49
    v_add_f32 v50, v50, v51
    v_add_f32 v52, v52, v53
    v_add_f32_dpp v48, v48, v48 row_ror:8 row_mask:0xf bank_mask:0xf
    v_add_f32_dpp v50, v50, v50 row_ror:8 row_mask:0xf bank_mask:0xf
    v_add_f32_dpp v52, v52, v52 row_ror:8 row_mask:0xf bank_mask:0xf
    v_add_f32_dpp v48, v48, v48 row_ror:4 row_mask:0xf bank_mask:0xf
    v_add_f32_dpp v50, v50, v50 row_ror:4 row_mask:0xf bank_mask:0xf
    v_add_f32_dpp v52, v52, v52 row_ror:4 row_mask:0xf bank_mask:0xf
    v_add_f32_dpp v48, v48, v48 row_ror:2 row_mask:0xf bank_mask:0xf
    v_add_f32_dpp v50, v50, v50 row_ror:2 row_mask:0xf bank_mask:0xf
    v_add_f32_dpp v52, v52, v52 row_ror:2 row_mask:0xf bank_mask:0xf
    v_add_f32_dpp v48, v48, v48 row_ror:1 row_mask:0xf bank_mask:0xf
    v_add_f32_dpp v50, v50, v50 row_ror:1 row_mask:0xf bank_mask:0xf
    v_add_f32_dpp v52, v52, v52 row_ror:1 row_mask:0xf bank_mask:0xf
    v_mov_b32 v49, v48
    v_mov_b32 v51, v50
    v_mov_b32 v53, v52
    v_permlane16_swap_b32 v48, v49
    v_permlane16_swap_b32 v50, v51
    v_permlane16_swap_b32 v52, v53
    v_add_f32 v48, v48, v49
    v_add_f32 v50, v50, v51
    v_add_f32 v52, v52, v53
    v_mul_f32 v48, 0x3ae38e39, v48
    v_mul_f32 v50, 0x3ae38e39, v50
    v_fma_f32 v50, -v48, v48, v50
    v_add_f32 v48, v48, v88
    v_max_f32 v50, 0, v50
    v_cvt_pk_bf16_f32 v48, v48, v50
    v_and_b32 v50, 0xffff0000, v48
    v_lshlrev_b32 v48, 16, v48
    v_add_f32 v50, 0x3727c5ac, v50
    v_sub_f32 v48, v88, v48
    v_cvt_pk_bf16_f32 v50, v50, v50
    v_and_b32 v50, 0xffff0000, v50
    v_sqrt_f32 v50, v50
    v_fmac_f32 v52, v48, v90
    v_cvt_pk_bf16_f32 v50, v50, v50
    v_and_b32 v50, 0xffff0000, v50
    v_rcp_f32 v50, v50
    s_mov_b32 exec_lo, 1
    s_mov_b32 exec_hi, 1
    v_fma_f32 v52, v52, v50, v91
    v_ashrrev_i32 v62, 31, v52
    v_or_b32 v62, 0x80000000, v62
    v_xor_b32 v52, v62, v52
    v_min_u32 v52, 0xfffff000, v52
    v_bfi_b32 v52, s48, v93, v52
    ds_write_b32 v92, v52 offset:36864
    s_mov_b64 exec, -1
    v_mul_f32 v48, v48, v50
    s_waitcnt lgkmcnt(0)
    s_barrier
    v_mov_b32 v109, 36864
    ds_read_b128 v[96:99], v109
    ds_read_b128 v[100:103], v109 offset:16
    s_lshl_b32 s45, s2, 7
    s_add_u32 s45, s45, 9306112
    s_cmp_eq_u32 s3, 0
    s_cselect_b32 s45, s45, 2147483648
    s_waitcnt lgkmcnt(1)
    v_max_u32 v104, v96, v97
    v_min_u32 v105, v96, v97
    v_med3_u32 v105, v104, v105, v98
    v_max_u32 v104, v104, v98
    v_med3_u32 v105, v104, v105, v99
    v_max_u32 v104, v104, v99
    s_waitcnt lgkmcnt(0)
    v_med3_u32 v105, v104, v105, v100
    v_max_u32 v104, v104, v100
    v_med3_u32 v105, v104, v105, v101
    v_max_u32 v104, v104, v101
    v_med3_u32 v105, v104, v105, v102
    v_max_u32 v104, v104, v102
    v_med3_u32 v105, v104, v105, v103
    v_max_u32 v104, v104, v103
    buffer_store_dwordx2 v[104:105], v8, s[24:27], s45 offen sc1
    v_pk_fma_f32 v[216:217], v[216:217], v[50:51], v[48:49] op_sel_hi:[1,0,0]
    v_pk_fma_f32 v[218:219], v[218:219], v[50:51], v[48:49] op_sel_hi:[1,0,0]
    v_pk_fma_f32 v[220:221], v[220:221], v[50:51], v[48:49] op_sel_hi:[1,0,0]
    v_pk_fma_f32 v[222:223], v[222:223], v[50:51], v[48:49] op_sel_hi:[1,0,0]
    v_pk_fma_f32 v[224:225], v[224:225], v[50:51], v[48:49] op_sel_hi:[1,0,0]
    v_pk_fma_f32 v[226:227], v[226:227], v[50:51], v[48:49] op_sel_hi:[1,0,0]
    v_pk_fma_f32 v[228:229], v[228:229], v[50:51], v[48:49] op_sel_hi:[1,0,0]
    v_pk_fma_f32 v[230:231], v[230:231], v[50:51], v[48:49] op_sel_hi:[1,0,0]
    v_pk_fma_f32 v[232:233], v[232:233], v[50:51], v[48:49] op_sel_hi:[1,0,0]
    v_pk_fma_f32 v[234:235], v[234:235], v[50:51], v[48:49] op_sel_hi:[1,0,0]
    v_pk_fma_f32 v[236:237], v[236:237], v[50:51], v[48:49] op_sel_hi:[1,0,0]
    v_pk_fma_f32 v[238:239], v[238:239], v[50:51], v[48:49] op_sel_hi:[1,0,0]
    v_pk_fma_f32 v[216:217], v[216:217], v[120:121], v[144:145]
    v_pk_fma_f32 v[218:219], v[218:219], v[122:123], v[146:147]
    v_pk_fma_f32 v[220:221], v[220:221], v[124:125], v[148:149]
    v_pk_fma_f32 v[222:223], v[222:223], v[126:127], v[150:151]
    v_pk_fma_f32 v[224:225], v[224:225], v[128:129], v[152:153]
    v_pk_fma_f32 v[226:227], v[226:227], v[130:131], v[154:155]
    v_pk_fma_f32 v[228:229], v[228:229], v[132:133], v[156:157]
    v_pk_fma_f32 v[230:231], v[230:231], v[134:135], v[158:159]
    v_pk_fma_f32 v[232:233], v[232:233], v[136:137], v[160:161]
    v_pk_fma_f32 v[234:235], v[234:235], v[138:139], v[162:163]
    v_pk_fma_f32 v[236:237], v[236:237], v[140:141], v[164:165]
    v_pk_fma_f32 v[238:239], v[238:239], v[142:143], v[166:167]
    v_cvt_pk_bf16_f32 v64, v216, v217
    v_cvt_pk_bf16_f32 v65, v218, v219
    v_cvt_pk_bf16_f32 v66, v220, v221
    v_cvt_pk_bf16_f32 v67, v222, v223
    v_cvt_pk_bf16_f32 v68, v224, v225
    v_cvt_pk_bf16_f32 v69, v226, v227
    v_cvt_pk_bf16_f32 v70, v228, v229
    v_cvt_pk_bf16_f32 v71, v230, v231
    v_cvt_pk_bf16_f32 v72, v232, v233
    v_cvt_pk_bf16_f32 v73, v234, v235
    v_cvt_pk_bf16_f32 v74, v236, v237
    v_cvt_pk_bf16_f32 v75, v238, v239
    v_and_b32 v106, 0x7ff, v104
    v_and_b32 v107, 0x7ff, v105
    v_cmp_eq_u32 vcc, v106, v93
    v_cmp_eq_u32 s[36:37], v107, v93
    v_mov_b32 v106, 2147483648
    s_or_b64 vcc, vcc, s[36:37]
    s_mov_b32 s45, 2621440
    s_nop 0
    v_cndmask_b32 v6, v106, v6, vcc
    v_cndmask_b32 v60, v106, v60, vcc
    buffer_store_dwordx4 v[64:67], v6, s[24:27], s45 offen offset:0 sc1
    buffer_store_dwordx4 v[68:71], v6, s[24:27], s45 offen offset:512 sc1
    buffer_store_dwordx4 v[72:75], v60, s[24:27], s45 offen offset:1024 sc1
    s_cmp_ge_u32 s41, 18
    s_cbranch_scc1 Ltail_idle
    s_mov_b32 s36, 2622592
    buffer_store_dwordx4 v[36:39], v6, s[24:27], s36 offen offset:0 sc1
    buffer_store_dwordx4 v[40:43], v6, s[24:27], s36 offen offset:512 sc1
    buffer_store_dwordx4 v[44:47], v60, s[24:27], s36 offen offset:1024 sc1
    v_lshlrev_b32 v216, 16, v64
    v_and_b32 v217, 0xffff0000, v64
    v_lshlrev_b32 v218, 16, v65
    v_and_b32 v219, 0xffff0000, v65
    v_lshlrev_b32 v220, 16, v66
    v_and_b32 v221, 0xffff0000, v66
    v_lshlrev_b32 v222, 16, v67
    v_and_b32 v223, 0xffff0000, v67
    v_lshlrev_b32 v224, 16, v68
    v_and_b32 v225, 0xffff0000, v68
    v_lshlrev_b32 v226, 16, v69
    v_and_b32 v227, 0xffff0000, v69
    v_lshlrev_b32 v228, 16, v70
    v_and_b32 v229, 0xffff0000, v70
    v_lshlrev_b32 v230, 16, v71
    v_and_b32 v231, 0xffff0000, v71
    v_lshlrev_b32 v232, 16, v72
    v_and_b32 v233, 0xffff0000, v72
    v_lshlrev_b32 v234, 16, v73
    v_and_b32 v235, 0xffff0000, v73
    v_lshlrev_b32 v236, 16, v74
    v_and_b32 v237, 0xffff0000, v74
    v_lshlrev_b32 v238, 16, v75
    v_and_b32 v239, 0xffff0000, v75
    v_pk_mul_f32 v[192:193], v[192:193], v[216:217]
    v_pk_mul_f32 v[194:195], v[194:195], v[218:219]
    v_pk_mul_f32 v[196:197], v[196:197], v[220:221]
    v_pk_mul_f32 v[198:199], v[198:199], v[222:223]
    v_pk_mul_f32 v[200:201], v[200:201], v[224:225]
    v_pk_mul_f32 v[202:203], v[202:203], v[226:227]
    v_pk_mul_f32 v[204:205], v[204:205], v[228:229]
    v_pk_mul_f32 v[206:207], v[206:207], v[230:231]
    v_pk_mul_f32 v[208:209], v[208:209], v[232:233]
    v_pk_mul_f32 v[210:211], v[210:211], v[234:235]
    v_pk_mul_f32 v[212:213], v[212:213], v[236:237]
    v_pk_mul_f32 v[214:215], v[214:215], v[238:239]
    v_cvt_pk_bf16_f32 v144, v192, v193
    v_cvt_pk_bf16_f32 v145, v194, v195
    v_cvt_pk_bf16_f32 v146, v196, v197
    v_cvt_pk_bf16_f32 v147, v198, v199
    v_cvt_pk_bf16_f32 v148, v200, v201
    v_cvt_pk_bf16_f32 v149, v202, v203
    v_cvt_pk_bf16_f32 v150, v204, v205
    v_cvt_pk_bf16_f32 v151, v206, v207
    v_cvt_pk_bf16_f32 v152, v208, v209
    v_cvt_pk_bf16_f32 v153, v210, v211
    v_cvt_pk_bf16_f32 v154, v212, v213
    v_cvt_pk_bf16_f32 v155, v214, v215
    v_lshlrev_b32 v192, 16, v144
    v_and_b32 v193, 0xffff0000, v144
    v_lshlrev_b32 v194, 16, v145
    v_and_b32 v195, 0xffff0000, v145
    v_lshlrev_b32 v196, 16, v146
    v_and_b32 v197, 0xffff0000, v146
    v_lshlrev_b32 v198, 16, v147
    v_and_b32 v199, 0xffff0000, v147
    v_lshlrev_b32 v200, 16, v148
    v_and_b32 v201, 0xffff0000, v148
    v_lshlrev_b32 v202, 16, v149
    v_and_b32 v203, 0xffff0000, v149
    v_lshlrev_b32 v204, 16, v150
    v_and_b32 v205, 0xffff0000, v150
    v_lshlrev_b32 v206, 16, v151
    v_and_b32 v207, 0xffff0000, v151
    v_lshlrev_b32 v208, 16, v152
    v_and_b32 v209, 0xffff0000, v152
    v_lshlrev_b32 v210, 16, v153
    v_and_b32 v211, 0xffff0000, v153
    v_lshlrev_b32 v212, 16, v154
    v_and_b32 v213, 0xffff0000, v154
    v_lshlrev_b32 v214, 16, v155
    v_and_b32 v215, 0xffff0000, v155
    v_pk_add_f32 v[192:193], v[192:193], v[12:13]
    v_pk_add_f32 v[194:195], v[194:195], v[14:15]
    v_pk_add_f32 v[196:197], v[196:197], v[16:17]
    v_pk_add_f32 v[198:199], v[198:199], v[18:19]
    v_pk_add_f32 v[200:201], v[200:201], v[20:21]
    v_pk_add_f32 v[202:203], v[202:203], v[22:23]
    v_pk_add_f32 v[204:205], v[204:205], v[24:25]
    v_pk_add_f32 v[206:207], v[206:207], v[26:27]
    v_pk_add_f32 v[208:209], v[208:209], v[28:29]
    v_pk_add_f32 v[210:211], v[210:211], v[30:31]
    v_pk_add_f32 v[212:213], v[212:213], v[32:33]
    v_pk_add_f32 v[214:215], v[214:215], v[34:35]
    v_cvt_pk_bf16_f32 v156, v192, v193
    v_cvt_pk_bf16_f32 v157, v194, v195
    v_cvt_pk_bf16_f32 v158, v196, v197
    v_cvt_pk_bf16_f32 v159, v198, v199
    v_cvt_pk_bf16_f32 v160, v200, v201
    v_cvt_pk_bf16_f32 v161, v202, v203
    v_cvt_pk_bf16_f32 v162, v204, v205
    v_cvt_pk_bf16_f32 v163, v206, v207
    v_cvt_pk_bf16_f32 v164, v208, v209
    v_cvt_pk_bf16_f32 v165, v210, v211
    v_cvt_pk_bf16_f32 v166, v212, v213
    v_cvt_pk_bf16_f32 v167, v214, v215
    v_and_b32 v30, 2, v1
    v_cmp_ne_u32 vcc, 0, v30
    v_mul_u32_u24 v30, 1152, v7
    v_add_u32 v4, v30, v5
    v_add_u32 v58, v30, v59
    v_mov_b32_dpp v192, v158 quad_perm:[0,2,0,2] row_mask:0xf bank_mask:0xf
    v_mov_b32_dpp v193, v159 quad_perm:[0,2,0,2] row_mask:0xf bank_mask:0xf
    v_mov_b32_dpp v194, v158 quad_perm:[1,3,1,3] row_mask:0xf bank_mask:0xf
    v_mov_b32_dpp v195, v159 quad_perm:[1,3,1,3] row_mask:0xf bank_mask:0xf
    v_mov_b32_dpp v196, v162 quad_perm:[0,2,0,2] row_mask:0xf bank_mask:0xf
    v_mov_b32_dpp v197, v163 quad_perm:[0,2,0,2] row_mask:0xf bank_mask:0xf
    v_mov_b32_dpp v198, v162 quad_perm:[1,3,1,3] row_mask:0xf bank_mask:0xf
    v_mov_b32_dpp v199, v163 quad_perm:[1,3,1,3] row_mask:0xf bank_mask:0xf
    v_mov_b32_dpp v200, v166 quad_perm:[0,2,0,2] row_mask:0xf bank_mask:0xf
    v_mov_b32_dpp v201, v167 quad_perm:[0,2,0,2] row_mask:0xf bank_mask:0xf
    v_mov_b32_dpp v202, v166 quad_perm:[1,3,1,3] row_mask:0xf bank_mask:0xf
    v_mov_b32_dpp v203, v167 quad_perm:[1,3,1,3] row_mask:0xf bank_mask:0xf
    v_cndmask_b32_dpp v144, v156, v192, vcc quad_perm:[0,2,0,2] row_mask:0xf bank_mask:0xf
    v_cndmask_b32_dpp v145, v157, v193, vcc quad_perm:[0,2,0,2] row_mask:0xf bank_mask:0xf
    v_cndmask_b32_dpp v146, v156, v194, vcc quad_perm:[1,3,1,3] row_mask:0xf bank_mask:0xf
    v_cndmask_b32_dpp v147, v157, v195, vcc quad_perm:[1,3,1,3] row_mask:0xf bank_mask:0xf
    v_cndmask_b32_dpp v148, v160, v196, vcc quad_perm:[0,2,0,2] row_mask:0xf bank_mask:0xf
    v_cndmask_b32_dpp v149, v161, v197, vcc quad_perm:[0,2,0,2] row_mask:0xf bank_mask:0xf
    v_cndmask_b32_dpp v150, v160, v198, vcc quad_perm:[1,3,1,3] row_mask:0xf bank_mask:0xf
    v_cndmask_b32_dpp v151, v161, v199, vcc quad_perm:[1,3,1,3] row_mask:0xf bank_mask:0xf
    v_cndmask_b32_dpp v152, v164, v200, vcc quad_perm:[0,2,0,2] row_mask:0xf bank_mask:0xf
    v_cndmask_b32_dpp v153, v165, v201, vcc quad_perm:[0,2,0,2] row_mask:0xf bank_mask:0xf
    v_cndmask_b32_dpp v154, v164, v202, vcc quad_perm:[1,3,1,3] row_mask:0xf bank_mask:0xf
    v_cndmask_b32_dpp v155, v165, v203, vcc quad_perm:[1,3,1,3] row_mask:0xf bank_mask:0xf
    v_lshlrev_b32 v13, 4, v1
    v_add_u32 v13, 32768, v13
    s_lshl_b32 s44, s3, 10
    v_add_u32 v14, s44, v13
    v_and_b32 v13, 0xffffff1f, v13
    v_bfe_u32 v15, v1, 2, 2
    v_cmp_eq_u32 s[52:53], 0, v15
    v_cmp_eq_u32 s[54:55], 1, v15
    v_cmp_eq_u32 s[56:57], 2, v15
    v_cmp_eq_u32 s[58:59], 3, v15
    s_mul_i32 s43, s42, 18
    s_add_u32 s43, s43, s41
    s_lshl_b32 s43, s43, 9
    s_mul_i32 s44, s3, 73728
    s_add_u32 s43, s43, s44
    v_lshlrev_b32 v15, 3, v1
    s_cmp_lt_u32 s3, 2
    s_cselect_b32 s36, 0xbfb8aa3b, 0
    s_cselect_b32 s37, 1.0, 0
    v_mov_b32 v40, s36
    v_mov_b32 v41, s37
    v_and_b32 v10, 1, v1
    v_and_b32 v9, 48, v1
    s_mul_i32 s38, s3, 3072
    s_add_u32 s38, s38, 49152
    v_lshl_add_u32 v11, v10, 9, v9
    v_add_u32 v11, s38, v11
    v_lshrrev_b32 v10, 5, v1
    v_and_b32 v9, 31, v1
    v_lshlrev_b32 v9, 4, v9
    v_lshlrev_b32 v108, 7, v0
    s_mov_b32 s45, 9306112
    s_lshl_b32 s36, s3, 3
    v_mov_b32 v109, s36
    s_mov_b32 s48, 262144
Ltail_pollk:
    buffer_load_dwordx2 v[104:105], v108, s[24:27], s45 offen sc1
    s_sub_u32 s48, s48, 1
    s_cbranch_scc1 Ltail_gotk
    s_waitcnt vmcnt(0)
    v_max_u32 v106, v104, v105
    v_cmp_eq_u32 vcc, -1, v106
    s_cbranch_vccnz Ltail_pollk
Ltail_gotk:
    s_waitcnt vmcnt(0)
    v_mov_b32_dpp v106, v104 row_ror:1 row_mask:0xf bank_mask:0xf
    v_mov_b32_dpp v107, v105 row_ror:1 row_mask:0xf bank_mask:0xf
    v_min_u32 v110, v104, v106
    v_max_u32 v104, v104, v106
    v_max3_u32 v105, v110, v105, v107
    s_nop 0
    v_mov_b32_dpp v106, v104 row_ror:2 row_mask:0xf bank_mask:0xf
    v_mov_b32_dpp v107, v105 row_ror:2 row_mask:0xf bank_mask:0xf
    v_min_u32 v110, v104, v106
    v_max_u32 v104, v104, v106
    v_max3_u32 v105, v110, v105, v107
    s_nop 0
    v_mov_b32_dpp v106, v104 row_ror:4 row_mask:0xf bank_mask:0xf
    v_mov_b32_dpp v107, v105 row_ror:4 row_mask:0xf bank_mask:0xf
    v_min_u32 v110, v104, v106
    v_max_u32 v104, v104, v106
    v_max3_u32 v105, v110, v105, v107
    s_nop 0
    v_mov_b32_dpp v106, v104 row_ror:8 row_mask:0xf bank_mask:0xf
    v_mov_b32_dpp v107, v105 row_ror:8 row_mask:0xf bank_mask:0xf
    v_min_u32 v110, v104, v106
    v_max_u32 v104, v104, v106
    v_max3_u32 v105, v110, v105, v107
    v_mov_b32 v106, v104
    v_mov_b32 v107, v105
    s_nop 0
    v_permlane16_swap_b32 v104, v106
    v_permlane16_swap_b32 v105, v107
    v_min_u32 v110, v104, v106
    v_max_u32 v104, v104, v106
    v_max3_u32 v105, v110, v105, v107
    v_mov_b32 v106, v104
    v_mov_b32 v107, v105
    s_nop 0
    v_permlane32_swap_b32 v104, v106
    v_permlane32_swap_b32 v105, v107
    v_min_u32 v110, v104, v106
    v_max_u32 v104, v104, v106
    v_max3_u32 v105, v110, v105, v107
    ds_write_b64 v109, v[104:105] offset:36928
    v_mov_b32 v109, 36928
    s_waitcnt lgkmcnt(0)
    s_barrier
    ds_read_b128 v[96:99], v109
    ds_read_b128 v[100:103], v109 offset:16
    s_waitcnt lgkmcnt(1)
    v_max_u32 v104, v96, v97
    v_min_u32 v105, v96, v97
    v_med3_u32 v105, v104, v105, v98
    v_max_u32 v104, v104, v98
    v_med3_u32 v105, v104, v105, v99
    v_max_u32 v104, v104, v99
    s_waitcnt lgkmcnt(0)
    v_med3_u32 v105, v104, v105, v100
    v_max_u32 v104, v104, v100
    v_med3_u32 v105, v104, v105, v101
    v_max_u32 v104, v104, v101
    v_med3_u32 v105, v104, v105, v102
    v_max_u32 v104, v104, v102
    v_med3_u32 v105, v104, v105, v103
    v_max_u32 v104, v104, v103
    s_nop 0
    v_readfirstlane_b32 s92, v104
    v_readfirstlane_b32 s93, v105
    s_andn2_b32 s46, 0x7ff, s92
    s_andn2_b32 s47, 0x7ff, s93
    s_mul_i32 s44, s46, 2304
    s_mul_i32 s45, s47, 2304
    s_sub_u32 s45, s45, s44
    v_mad_i32_i24 v10, v10, s45, v9
    s_add_u32 s45, s44, 2621440
    v_add_u32 v10, s45, v10
    s_mov_b32 s48, 16384
Ltail_pollh:
    s_mov_b32 exec_lo, 0xffffff
    s_mov_b32 exec_hi, 0xffffff
    s_add_u32 m0, s38, 0
    s_nop 0
    buffer_load_dwordx4 v10, s[24:27], 0 offen offset:0 sc1 lds
    s_add_u32 m0, s38, 640
    s_nop 0
    buffer_load_dwordx4 v10, s[24:27], 0 offen offset:384 sc1 lds
    s_add_u32 m0, s38, 1280
    s_nop 0
    buffer_load_dwordx4 v10, s[24:27], 0 offen offset:768 sc1 lds
    s_mov_b64 exec, -1
    s_waitcnt vmcnt(0)
    ds_read_b128 a[0:3], v11 offset:0
    ds_read_b128 a[4:7], v11 offset:64
    ds_read_b128 a[8:11], v11 offset:128
    ds_read_b128 a[12:15], v11 offset:192
    ds_read_b128 a[16:19], v11 offset:256
    ds_read_b128 a[20:23], v11 offset:320
    ds_read_b128 a[24:27], v11 offset:1024
    ds_read_b128 a[28:31], v11 offset:1088
    ds_read_b128 a[32:35], v11 offset:1152
    ds_read_b128 a[36:39], v11 offset:1216
    ds_read_b128 a[40:43], v11 offset:1280
    ds_read_b128 a[44:47], v11 offset:1344
    ds_read_b128 a[48:51], v11 offset:2048
    ds_read_b128 a[52:55], v11 offset:2112
    ds_read_b128 a[56:59], v11 offset:2176
    ds_read_b128 a[60:63], v11 offset:2240
    ds_read_b128 a[64:67], v11 offset:2304
    ds_read_b128 a[68:71], v11 offset:2368
    s_waitcnt lgkmcnt(15)
    v_mfma_f32_16x16x32_bf16 v[16:19], a[96:99], a[0:3], 0
    v_mfma_f32_16x16x32_bf16 v[20:23], a[100:103], a[4:7], 0
    v_mfma_f32_16x16x32_bf16 v[16:19], a[104:107], a[8:11], v[16:19]
    s_waitcnt lgkmcnt(14)
    v_mfma_f32_16x16x32_bf16 v[20:23], a[108:111], a[12:15], v[20:23]
    s_waitcnt lgkmcnt(13)
    v_mfma_f32_16x16x32_bf16 v[16:19], a[112:115], a[16:19], v[16:19]
    s_waitcnt lgkmcnt(12)
    v_mfma_f32_16x16x32_bf16 v[20:23], a[116:119], a[20:23], v[20:23]
    s_waitcnt lgkmcnt(11)
    v_mfma_f32_16x16x32_bf16 v[16:19], a[120:123], a[24:27], v[16:19]
    s_waitcnt lgkmcnt(10)
    v_mfma_f32_16x16x32_bf16 v[20:23], a[124:127], a[28:31], v[20:23]
    s_waitcnt lgkmcnt(9)
    v_mfma_f32_16x16x32_bf16 v[16:19], a[128:131], a[32:35], v[16:19]
    s_waitcnt lgkmcnt(8)
    v_mfma_f32_16x16x32_bf16 v[20:23], a[132:135], a[36:39], v[20:23]
    s_waitcnt lgkmcnt(7)
    v_mfma_f32_16x16x32_bf16 v[16:19], a[136:139], a[40:43], v[16:19]
    s_waitcnt lgkmcnt(6)
    v_mfma_f32_16x16x32_bf16 v[20:23], a[140:143], a[44:47], v[20:23]
    s_waitcnt lgkmcnt(5)
    v_mfma_f32_16x16x32_bf16 v[16:19], a[144:147], a[48:51], v[16:19]
    s_waitcnt lgkmcnt(4)
    v_mfma_f32_16x16x32_bf16 v[20:23], a[148:151], a[52:55], v[20:23]
    s_waitcnt lgkmcnt(3)
    v_mfma_f32_16x16x32_bf16 v[16:19], a[152:155], a[56:59], v[16:19]
    s_waitcnt lgkmcnt(2)
    v_mfma_f32_16x16x32_bf16 v[20:23], a[156:159], a[60:63], v[20:23]
    s_waitcnt lgkmcnt(1)
    v_mfma_f32_16x16x32_bf16 v[16:19], a[160:163], a[64:67], v[16:19]
    s_waitcnt lgkmcnt(0)
    v_mfma_f32_16x16x32_bf16 v[20:23], a[164:167], a[68:71], v[20:23]
    s_sub_u32 s48, s48, 1
    s_nop 6
    v_pk_add_f32 v[16:17], v[16:17], v[20:21]
    v_pk_add_f32 v[18:19], v[18:19], v[22:23]
    s_cbranch_scc1 Ltail_goth
    v_cmp_u_f32 vcc, v16, v16
    s_and_b32 s36, vcc_lo, 3
    s_cbranch_scc1 Ltail_pollh
Ltail_goth:
    v_cvt_pk_bf16_f32 v32, v16, v17
    v_cvt_pk_bf16_f32 v33, v18, v19
    v_lshlrev_b32 v16, 16, v32
    v_and_b32 v17, 0xffff0000, v32
    v_lshlrev_b32 v18, 16, v33
    v_and_b32 v19, 0xffff0000, v33
    v_pk_mul_f32 v[32:33], v[16:17], v[40:41] op_sel_hi:[1,0]
    v_pk_mul_f32 v[34:35], v[18:19], v[40:41] op_sel_hi:[1,0]
    v_exp_f32 v32, v32
    v_exp_f32 v33, v33
    v_exp_f32 v34, v34
    v_exp_f32 v35, v35
    v_fma_f32 v32, v32, v41, 1.0
    v_fma_f32 v33, v33, v41, 1.0
    v_fma_f32 v34, v34, v41, 1.0
    v_fma_f32 v35, v35, v41, 1.0
    v_rcp_f32 v32, v32
    v_rcp_f32 v33, v33
    v_rcp_f32 v34, v34
    v_rcp_f32 v35, v35
    v_pk_mul_f32 v[16:17], v[16:17], v[32:33]
    v_pk_mul_f32 v[18:19], v[18:19], v[34:35]
    v_cvt_pk_bf16_f32 v32, v16, v17
    v_cvt_pk_bf16_f32 v33, v18, v19
    v_lshlrev_b32 v16, 16, v32
    v_and_b32 v17, 0xffff0000, v32
    v_lshlrev_b32 v18, 16, v33
    v_and_b32 v19, 0xffff0000, v33
    ds_write_b128 v14, v[16:19]
    s_waitcnt lgkmcnt(0)
    s_barrier
    ds_read_b128 v[16:19], v13 offset:0
    ds_read_b128 v[24:27], v13 offset:2048
    ds_read_b128 v[20:23], v13 offset:1024
    ds_read_b128 v[28:31], v13 offset:3072
    s_waitcnt lgkmcnt(2)
    v_pk_mul_f32 v[16:17], v[16:17], v[24:25]
    v_pk_mul_f32 v[18:19], v[18:19], v[26:27]
    v_cvt_pk_bf16_f32 v32, v16, v17
    v_cvt_pk_bf16_f32 v33, v18, v19
    s_waitcnt lgkmcnt(0)
    v_pk_mul_f32 v[20:21], v[20:21], v[28:29]
    v_pk_mul_f32 v[22:23], v[22:23], v[30:31]
    v_cvt_pk_bf16_f32 v34, v20, v21
    v_cvt_pk_bf16_f32 v35, v22, v23
    v_cndmask_b32 v64, 0, v32, s[52:53]
    v_cndmask_b32 v65, 0, v33, s[52:53]
    v_cndmask_b32 v66, 0, v34, s[52:53]
    v_cndmask_b32 v67, 0, v35, s[52:53]
    s_nop 1
    v_mfma_f32_16x16x32_bf16 v[16:19], v[64:67], a[168:171], 0
    v_cndmask_b32 v68, 0, v32, s[54:55]
    v_cndmask_b32 v69, 0, v33, s[54:55]
    v_mfma_f32_16x16x32_bf16 v[20:23], v[64:67], a[184:187], 0
    v_cndmask_b32 v70, 0, v34, s[54:55]
    v_cndmask_b32 v71, 0, v35, s[54:55]
    v_mfma_f32_16x16x32_bf16 v[24:27], v[64:67], a[200:203], 0
    s_nop 0
    v_mfma_f32_16x16x32_bf16 v[16:19], v[68:71], a[172:175], v[16:19]
    v_cndmask_b32 v72, 0, v32, s[56:57]
    v_cndmask_b32 v73, 0, v33, s[56:57]
    v_mfma_f32_16x16x32_bf16 v[20:23], v[68:71], a[188:191], v[20:23]
Ltour13:
    s_cbranch_execz Ltour17
    v_cndmask_b32 v74, 0, v34, s[56:57]
    v_cndmask_b32 v75, 0, v35, s[56:57]
    v_mfma_f32_16x16x32_bf16 v[24:27], v[68:71], a[204:207], v[24:27]
    s_nop 0
    v_mfma_f32_16x16x32_bf16 v[16:19], v[72:75], a[176:179], v[16:19]
    v_cndmask_b32 v76, 0, v32, s[58:59]
    v_cndmask_b32 v77, 0, v33, s[58:59]
    v_mfma_f32_16x16x32_bf16 v[20:23], v[72:75], a[192:195], v[20:23]
    v_cndmask_b32 v78, 0, v34, s[58:59]
    v_cndmask_b32 v79, 0, v35, s[58:59]
    v_mfma_f32_16x16x32_bf16 v[24:27], v[72:75], a[208:211], v[24:27]
    s_nop 0
    v_mfma_f32_16x16x32_bf16 v[16:19], v[76:79], a[180:183], v[16:19]
    v_mfma_f32_16x16x32_bf16 v[20:23], v[76:79], a[196:199], v[20:23]
    v_mfma_f32_16x16x32_bf16 v[24:27], v[76:79], a[212:215], v[24:27]
    s_nop 5
    v_min_u32 v16, -2, v16
    v_min_u32 v17, -2, v17
    buffer_store_dwordx2 v[16:17], v15, s[8:11], s43 offen sc1
    s_add_u32 s43, s43, 294912
    v_min_u32 v20, -2, v20
    v_min_u32 v21, -2, v21
    buffer_store_dwordx2 v[20:21], v15, s[8:11], s43 offen sc1
    s_add_u32 s43, s43, 294912
    v_min_u32 v24, -2, v24
    v_min_u32 v25, -2, v25
    buffer_store_dwordx2 v[24:25], v15, s[8:11], s43 offen sc1
    s_or_b32 s36, s2, s3
    s_cselect_b32 s37, -4, 24576
    s_add_u32 s36, s94, 1
    v_mov_b32 v106, s36
    buffer_store_dword v106, v8, s[24:27], s37 offen sc1
    v_cmp_ne_u32 vcc, s46, v7
    v_cmp_ne_u32 s[36:37], s47, v7
    v_mov_b32 v31, 2147483648
    s_and_b64 vcc, vcc, s[36:37]
    s_nop 1
    v_cndmask_b32 v30, v31, v58, vcc
    v_cndmask_b32 v31, v31, v4, vcc
    buffer_store_dwordx4 v[144:147], v31, s[16:19], 0 offen offset:0 nt
    buffer_store_dwordx4 v[148:151], v31, s[16:19], 0 offen offset:512 nt
    buffer_store_dwordx4 v[152:155], v30, s[16:19], 0 offen offset:1024 nt
    s_cmp_lt_u32 s41, 9
    s_cselect_b32 s36, s3, 0
    s_cmp_lg_u32 s36, 3
    s_cbranch_scc1 Ltail_done
    s_mul_i32 s43, s42, 9
    s_add_u32 s43, s43, s41
    v_bfe_u32 v8, v1, 2, 1
    v_cmp_eq_u32 vcc, 1, v8
    v_mov_b32 v9, s46
    v_mov_b32 v10, s47
    v_and_b32 v11, 3, v1
    v_cndmask_b32 v9, v9, v10, vcc
    s_lshr_b32 s44, s43, 2
    s_lshl_b32 s44, s44, 6
    s_and_b32 s45, s43, 1
    s_lshl_b32 s45, s45, 5
    s_add_u32 s44, s44, s45
    s_and_b32 s45, s43, 2
    s_lshl_b32 s45, s45, 2
    s_add_u32 s44, s44, s45
    v_lshrrev_b32 v12, 1, v11
    v_lshl_add_u32 v12, v12, 4, s44
    v_and_b32 v13, 1, v11
    v_lshl_add_u32 v12, v13, 2, v12
    v_mul_u32_u24 v13, 1152, v9
    v_lshl_add_u32 v14, v13, 1, v12
    v_add_u32 v15, 2621440, v14
    s_mov_b32 s45, 22144
    buffer_load_dword v18, v12, s[24:27], s45 offen sc1
    v_mov_b32 v19, s92
    v_mov_b32 v10, s93
    v_cndmask_b32 v19, v19, v10, vcc
    v_and_b32 v19, 0xfffff800, v19
    v_or_b32 v19, 0x400, v19
    v_ashrrev_i32 v10, 31, v19
    v_not_b32 v10, v10
    v_or_b32 v10, 0x80000000, v10
    v_xor_b32 v19, v19, v10
    s_lshl_b32 s45, s43, 4
    v_lshl_add_u32 v13, v11, 2, v13
    v_add_u32 v13, s45, v13
    v_lshrrev_b32 v14, 2, v1
    v_lshlrev_b32 v14, 9, v14
    v_lshl_add_u32 v14, v11, 4, v14
    s_lshr_b32 s44, s43, 3
    s_mul_i32 s44, s44, 73728
    s_and_b32 s45, s43, 7
    s_lshl_b32 s45, s45, 6
    s_add_u32 s44, s44, s45
    v_cmp_eq_u32 s[38:39], 1, v8
    v_cvt_pk_bf16_f32 v19, v19, v19
    v_and_b32 v19, 0xffff0000, v19
    v_mul_f32 v19, 0xbfb8aa3b, v19
    v_exp_f32 v19, v19
    s_waitcnt vmcnt(0)
    v_lshlrev_b32 v24, 16, v18
    v_and_b32 v25, 0xffff0000, v18
    v_add_f32 v19, 1.0, v19
    v_rcp_f32 v19, v19
    s_mov_b32 s48, 262144
    v_cvt_pk_bf16_f32 v19, v19, v19
    v_and_b32 v19, 0xffff0000, v19
Ltail_polly:
    s_add_u32 s45, s44, 0
    buffer_load_dwordx4 v[64:67], v14, s[8:11], s45 offen sc1
    s_add_u32 s45, s44, 8192
    buffer_load_dwordx4 v[68:71], v14, s[8:11], s45 offen sc1
    s_add_u32 s45, s44, 16384
    buffer_load_dwordx4 v[72:75], v14, s[8:11], s45 offen sc1
    s_add_u32 s45, s44, 24576
    buffer_load_dwordx4 v[76:79], v14, s[8:11], s45 offen sc1
    s_add_u32 s45, s44, 32768
    buffer_load_dwordx4 v[80:83], v14, s[8:11], s45 offen sc1
    s_add_u32 s45, s44, 40960
    buffer_load_dwordx4 v[84:87], v14, s[8:11], s45 offen sc1
    s_add_u32 s45, s44, 49152
    buffer_load_dwordx4 v[88:91], v14, s[8:11], s45 offen sc1
    s_add_u32 s45, s44, 57344
    buffer_load_dwordx4 v[92:95], v14, s[8:11], s45 offen sc1
    s_add_u32 s45, s44, 65536
    buffer_load_dwordx4 v[96:99], v14, s[8:11], s45 offen sc1
    s_mov_b32 s45, 1152
    buffer_load_dword v16, v15, s[24:27], s45 offen sc1
    buffer_load_dword v17, v15, s[24:27], 0 offen sc1
    s_sub_u32 s48, s48, 1
    s_cbranch_scc1 Ltail_goty
    s_waitcnt vmcnt(10)
    v_max3_u32 v26, v64, v65, v66
    s_waitcnt vmcnt(9)
    v_max3_u32 v26, v26, v67, v68
    v_max3_u32 v26, v26, v69, v70
    s_waitcnt vmcnt(8)
    v_max3_u32 v26, v26, v71, v72
    v_max3_u32 v26, v26, v73, v74
    s_waitcnt vmcnt(7)
    v_max3_u32 v26, v26, v75, v76
    v_max3_u32 v26, v26, v77, v78
    s_waitcnt vmcnt(6)
    v_max3_u32 v26, v26, v79, v80
    v_max3_u32 v26, v26, v81, v82
    s_waitcnt vmcnt(5)
    v_max3_u32 v26, v26, v83, v84
    v_max3_u32 v26, v26, v85, v86
    s_waitcnt vmcnt(4)
    v_max3_u32 v26, v26, v87, v88
    v_max3_u32 v26, v26, v89, v90
    s_waitcnt vmcnt(3)
    v_max3_u32 v26, v26, v91, v92
    v_max3_u32 v26, v26, v93, v94
    s_waitcnt vmcnt(2)
    v_max3_u32 v26, v26, v95, v96
    v_max3_u32 v26, v26, v97, v98
    v_max_u32 v26, v26, v99
    s_waitcnt vmcnt(0)
    v_max3_u32 v26, v26, v16, v17
    v_cmp_eq_u32 vcc, -1, v26
    s_cbranch_vccnz Ltail_polly
Ltail_goty:
    s_waitcnt vmcnt(0) lgkmcnt(0)
    v_lshlrev_b32 v20, 16, v16
    v_and_b32 v21, 0xffff0000, v16
    v_lshlrev_b32 v22, 16, v17
    v_and_b32 v23, 0xffff0000, v17
    v_pk_add_f32 v[64:65], v[64:65], v[68:69]
    v_pk_add_f32 v[66:67], v[66:67], v[70:71]
    v_pk_add_f32 v[64:65], v[64:65], v[72:73]
    v_pk_add_f32 v[66:67], v[66:67], v[74:75]
    v_pk_add_f32 v[64:65], v[64:65], v[76:77]
    v_pk_add_f32 v[66:67], v[66:67], v[78:79]
    v_pk_add_f32 v[64:65], v[64:65], v[80:81]
    v_pk_add_f32 v[66:67], v[66:67], v[82:83]
    v_pk_add_f32 v[64:65], v[64:65], v[84:85]
    v_pk_add_f32 v[66:67], v[66:67], v[86:87]
    v_pk_add_f32 v[64:65], v[64:65], v[88:89]
    v_pk_add_f32 v[66:67], v[66:67], v[90:91]
    v_pk_add_f32 v[64:65], v[64:65], v[92:93]
    v_pk_add_f32 v[66:67], v[66:67], v[94:95]
    v_pk_add_f32 v[64:65], v[64:65], v[96:97]
    v_pk_add_f32 v[66:67], v[66:67], v[98:99]
    s_nop 0
    v_add_f32_dpp v64, v64, v64 row_ror:4 row_mask:0xf bank_mask:0xf
    v_add_f32_dpp v65, v65, v65 row_ror:4 row_mask:0xf bank_mask:0xf
    v_add_f32_dpp v66, v66, v66 row_ror:4 row_mask:0xf bank_mask:0xf
    v_add_f32_dpp v67, v67, v67 row_ror:4 row_mask:0xf bank_mask:0xf
    v_add_f32_dpp v64, v64, v64 row_ror:8 row_mask:0xf bank_mask:0xf
    v_add_f32_dpp v65, v65, v65 row_ror:8 row_mask:0xf bank_mask:0xf
    v_add_f32_dpp v66, v66, v66 row_ror:8 row_mask:0xf bank_mask:0xf
    v_add_f32_dpp v67, v67, v67 row_ror:8 row_mask:0xf bank_mask:0xf
    v_mov_b32 v68, v64
    v_mov_b32 v69, v65
    v_mov_b32 v70, v66
    v_mov_b32 v71, v67
    v_permlane16_swap_b32 v64, v68
    v_permlane16_swap_b32 v65, v69
    v_permlane16_swap_b32 v66, v70
    v_permlane16_swap_b32 v67, v71
    v_add_f32 v64, v64, v68
    v_add_f32 v65, v65, v69
    v_add_f32 v66, v66, v70
    v_add_f32 v67, v67, v71
    v_mov_b32 v68, v64
    v_mov_b32 v69, v65
    v_mov_b32 v70, v66
    v_mov_b32 v71, v67
    v_permlane32_swap_b32 v64, v68
    v_permlane32_swap_b32 v65, v69
    v_permlane32_swap_b32 v66, v70
    v_permlane32_swap_b32 v67, v71
    v_add_f32 v64, v64, v68
    v_add_f32 v65, v65, v69
    v_add_f32 v66, v66, v70
    v_add_f32 v67, v67, v71
    v_cndmask_b32 v26, v64, v65, s[38:39]
    v_cndmask_b32 v27, v66, v67, s[38:39]
    v_cvt_pk_bf16_f32 v28, v26, v27
    v_lshlrev_b32 v26, 16, v28
    v_and_b32 v27, 0xffff0000, v28
    v_mul_f32 v26, v26, v19
    v_mul_f32 v27, v27, v19
    v_cvt_pk_bf16_f32 v28, v26, v27
    v_lshlrev_b32 v26, 16, v28
    v_and_b32 v27, 0xffff0000, v28
    v_pk_add_f32 v[26:27], v[26:27], v[22:23]
    v_cvt_pk_bf16_f32 v28, v26, v27
    v_lshlrev_b32 v26, 16, v28
    v_and_b32 v27, 0xffff0000, v28
    v_pk_mul_f32 v[26:27], v[26:27], v[24:25]
    v_cvt_pk_bf16_f32 v28, v26, v27
    v_lshlrev_b32 v26, 16, v28
    v_and_b32 v27, 0xffff0000, v28
    v_pk_add_f32 v[26:27], v[26:27], v[20:21]
    v_cvt_pk_bf16_f32 v28, v26, v27
    s_mov_b64 exec, 0xff
    buffer_store_dword v28, v13, s[16:19], 0 offen nt
    s_branch Ltail_done
Ltail_idle:
Ltour14:
    s_cbranch_execz Lmain
    v_lshlrev_b32 v216, 16, v64
    v_and_b32 v217, 0xffff0000, v64
    v_lshlrev_b32 v218, 16, v65
    v_and_b32 v219, 0xffff0000, v65
    v_lshlrev_b32 v220, 16, v66
    v_and_b32 v221, 0xffff0000, v66
    v_lshlrev_b32 v222, 16, v67
    v_and_b32 v223, 0xffff0000, v67
    v_lshlrev_b32 v224, 16, v68
    v_and_b32 v225, 0xffff0000, v68
    v_lshlrev_b32 v226, 16, v69
    v_and_b32 v227, 0xffff0000, v69
    v_lshlrev_b32 v228, 16, v70
    v_and_b32 v229, 0xffff0000, v70
    v_lshlrev_b32 v230, 16, v71
    v_and_b32 v231, 0xffff0000, v71
    v_lshlrev_b32 v232, 16, v72
    v_and_b32 v233, 0xffff0000, v72
    v_lshlrev_b32 v234, 16, v73
    v_and_b32 v235, 0xffff0000, v73
    v_lshlrev_b32 v236, 16, v74
    v_and_b32 v237, 0xffff0000, v74
    v_lshlrev_b32 v238, 16, v75
    v_and_b32 v239, 0xffff0000, v75
    v_pk_mul_f32 v[192:193], v[192:193], v[216:217]
    v_pk_mul_f32 v[194:195], v[194:195], v[218:219]
    v_pk_mul_f32 v[196:197], v[196:197], v[220:221]
    v_pk_mul_f32 v[198:199], v[198:199], v[222:223]
    v_pk_mul_f32 v[200:201], v[200:201], v[224:225]
    v_pk_mul_f32 v[202:203], v[202:203], v[226:227]
    v_pk_mul_f32 v[204:205], v[204:205], v[228:229]
    v_pk_mul_f32 v[206:207], v[206:207], v[230:231]
    v_pk_mul_f32 v[208:209], v[208:209], v[232:233]
    v_pk_mul_f32 v[210:211], v[210:211], v[234:235]
    v_pk_mul_f32 v[212:213], v[212:213], v[236:237]
    v_pk_mul_f32 v[214:215], v[214:215], v[238:239]
    v_cvt_pk_bf16_f32 v144, v192, v193
    v_cvt_pk_bf16_f32 v145, v194, v195
    v_cvt_pk_bf16_f32 v146, v196, v197
    v_cvt_pk_bf16_f32 v147, v198, v199
    v_cvt_pk_bf16_f32 v148, v200, v201
    v_cvt_pk_bf16_f32 v149, v202, v203
    v_cvt_pk_bf16_f32 v150, v204, v205
    v_cvt_pk_bf16_f32 v151, v206, v207
    v_cvt_pk_bf16_f32 v152, v208, v209
    v_cvt_pk_bf16_f32 v153, v210, v211
    v_cvt_pk_bf16_f32 v154, v212, v213
    v_cvt_pk_bf16_f32 v155, v214, v215
    v_lshlrev_b32 v192, 16, v144
    v_and_b32 v193, 0xffff0000, v144
    v_lshlrev_b32 v194, 16, v145
    v_and_b32 v195, 0xffff0000, v145
    v_lshlrev_b32 v196, 16, v146
    v_and_b32 v197, 0xffff0000, v146
    v_lshlrev_b32 v198, 16, v147
    v_and_b32 v199, 0xffff0000, v147
    v_lshlrev_b32 v200, 16, v148
    v_and_b32 v201, 0xffff0000, v148
    v_lshlrev_b32 v202, 16, v149
    v_and_b32 v203, 0xffff0000, v149
    v_lshlrev_b32 v204, 16, v150
    v_and_b32 v205, 0xffff0000, v150
    v_lshlrev_b32 v206, 16, v151
    v_and_b32 v207, 0xffff0000, v151
    v_lshlrev_b32 v208, 16, v152
    v_and_b32 v209, 0xffff0000, v152
    v_lshlrev_b32 v210, 16, v153
    v_and_b32 v211, 0xffff0000, v153
    v_lshlrev_b32 v212, 16, v154
    v_and_b32 v213, 0xffff0000, v154
    v_lshlrev_b32 v214, 16, v155
    v_and_b32 v215, 0xffff0000, v155
    v_pk_add_f32 v[192:193], v[192:193], v[12:13]
    v_pk_add_f32 v[194:195], v[194:195], v[14:15]
    v_pk_add_f32 v[196:197], v[196:197], v[16:17]
    v_pk_add_f32 v[198:199], v[198:199], v[18:19]
    v_pk_add_f32 v[200:201], v[200:201], v[20:21]
    v_pk_add_f32 v[202:203], v[202:203], v[22:23]
    v_pk_add_f32 v[204:205], v[204:205], v[24:25]
    v_pk_add_f32 v[206:207], v[206:207], v[26:27]
    v_pk_add_f32 v[208:209], v[208:209], v[28:29]
    v_pk_add_f32 v[210:211], v[210:211], v[30:31]
    v_pk_add_f32 v[212:213], v[212:213], v[32:33]
    v_pk_add_f32 v[214:215], v[214:215], v[34:35]
    v_cvt_pk_bf16_f32 v156, v192, v193
    v_cvt_pk_bf16_f32 v157, v194, v195
    v_cvt_pk_bf16_f32 v158, v196, v197
    v_cvt_pk_bf16_f32 v159, v198, v199
    v_cvt_pk_bf16_f32 v160, v200, v201
    v_cvt_pk_bf16_f32 v161, v202, v203
    v_cvt_pk_bf16_f32 v162, v204, v205
    v_cvt_pk_bf16_f32 v163, v206, v207
    v_cvt_pk_bf16_f32 v164, v208, v209
    v_cvt_pk_bf16_f32 v165, v210, v211
    v_cvt_pk_bf16_f32 v166, v212, v213
    v_cvt_pk_bf16_f32 v167, v214, v215
    v_and_b32 v30, 2, v1
    v_cmp_ne_u32 vcc, 0, v30
    v_mul_u32_u24 v30, 1152, v7
    v_add_u32 v4, v30, v5
    v_add_u32 v58, v30, v59
    v_mov_b32_dpp v192, v158 quad_perm:[0,2,0,2] row_mask:0xf bank_mask:0xf
    v_mov_b32_dpp v193, v159 quad_perm:[0,2,0,2] row_mask:0xf bank_mask:0xf
    v_mov_b32_dpp v194, v158 quad_perm:[1,3,1,3] row_mask:0xf bank_mask:0xf
    v_mov_b32_dpp v195, v159 quad_perm:[1,3,1,3] row_mask:0xf bank_mask:0xf
    v_mov_b32_dpp v196, v162 quad_perm:[0,2,0,2] row_mask:0xf bank_mask:0xf
    v_mov_b32_dpp v197, v163 quad_perm:[0,2,0,2] row_mask:0xf bank_mask:0xf
    v_mov_b32_dpp v198, v162 quad_perm:[1,3,1,3] row_mask:0xf bank_mask:0xf
    v_mov_b32_dpp v199, v163 quad_perm:[1,3,1,3] row_mask:0xf bank_mask:0xf
    v_mov_b32_dpp v200, v166 quad_perm:[0,2,0,2] row_mask:0xf bank_mask:0xf
    v_mov_b32_dpp v201, v167 quad_perm:[0,2,0,2] row_mask:0xf bank_mask:0xf
    v_mov_b32_dpp v202, v166 quad_perm:[1,3,1,3] row_mask:0xf bank_mask:0xf
    v_mov_b32_dpp v203, v167 quad_perm:[1,3,1,3] row_mask:0xf bank_mask:0xf
    v_cndmask_b32_dpp v144, v156, v192, vcc quad_perm:[0,2,0,2] row_mask:0xf bank_mask:0xf
    v_cndmask_b32_dpp v145, v157, v193, vcc quad_perm:[0,2,0,2] row_mask:0xf bank_mask:0xf
    v_cndmask_b32_dpp v146, v156, v194, vcc quad_perm:[1,3,1,3] row_mask:0xf bank_mask:0xf
    v_cndmask_b32_dpp v147, v157, v195, vcc quad_perm:[1,3,1,3] row_mask:0xf bank_mask:0xf
    v_cndmask_b32_dpp v148, v160, v196, vcc quad_perm:[0,2,0,2] row_mask:0xf bank_mask:0xf
    v_cndmask_b32_dpp v149, v161, v197, vcc quad_perm:[0,2,0,2] row_mask:0xf bank_mask:0xf
    v_cndmask_b32_dpp v150, v160, v198, vcc quad_perm:[1,3,1,3] row_mask:0xf bank_mask:0xf
    v_cndmask_b32_dpp v151, v161, v199, vcc quad_perm:[1,3,1,3] row_mask:0xf bank_mask:0xf
    v_cndmask_b32_dpp v152, v164, v200, vcc quad_perm:[0,2,0,2] row_mask:0xf bank_mask:0xf
    v_cndmask_b32_dpp v153, v165, v201, vcc quad_perm:[0,2,0,2] row_mask:0xf bank_mask:0xf
    v_cndmask_b32_dpp v154, v164, v202, vcc quad_perm:[1,3,1,3] row_mask:0xf bank_mask:0xf
    v_cndmask_b32_dpp v155, v165, v203, vcc quad_perm:[1,3,1,3] row_mask:0xf bank_mask:0xf
    buffer_store_dwordx4 v[144:147], v4, s[16:19], 0 offen offset:0 sc1
    buffer_store_dwordx4 v[148:151], v4, s[16:19], 0 offen offset:512 sc1
    buffer_store_dwordx4 v[152:155], v58, s[16:19], 0 offen offset:1024 sc1
    s_waitcnt vmcnt(0)
    s_mov_b32 s36, 2622592
    buffer_store_dwordx4 v[36:39], v6, s[24:27], s36 offen offset:0 sc1
    buffer_store_dwordx4 v[40:43], v6, s[24:27], s36 offen offset:512 sc1
    buffer_store_dwordx4 v[44:47], v60, s[24:27], s36 offen offset:1024 sc1
Ltail_done:
    s_endpgm
Lattn_wb:
    buffer_wbl2 sc1
    s_waitcnt vmcnt(0)
    s_branch Lattn_wbdone
Lattn_xspin:
Ltour15:
    s_cbranch_execz Lmain
    s_mov_b32 s37, 262144
Lattn_xloop:
    buffer_load_dword v11, v8, s[24:27], s54 offen offset:8 sc1
    s_waitcnt vmcnt(0)
    v_readfirstlane_b32 s36, v11
    s_sub_u32 s37, s37, 1
    s_cbranch_scc1 Lattn_xgot
    s_cmp_lg_u32 s36, s95
    s_cbranch_scc1 Lattn_xloop
    s_branch Lattn_xgot
Ltail_spin1:
Ltour16:
    s_cbranch_execz Lmain
    s_mov_b32 s48, 262144
Ltail_spinl1:
    buffer_load_dword v11, v9, s[24:27], s39 offen sc1
    s_waitcnt vmcnt(0)
    v_cmp_ne_u32 s[54:55], s95, v11
    s_sub_u32 s48, s48, 1
    s_cbranch_scc1 Ltail_got1
    s_cmp_lg_u64 s[54:55], 0
    s_cbranch_scc1 Ltail_spinl1
    s_branch Ltail_got1
Ltail_spin2:
Ltour17:
    s_cbranch_execz Lmain
    s_mov_b32 s48, 262144
Ltail_spinl2:
    buffer_load_dword v11, v9, s[24:27], s39 offen sc1
    s_waitcnt vmcnt(0)
    v_cmp_ne_u32 s[54:55], s95, v11
    s_sub_u32 s48, s48, 1
    s_cbranch_scc1 Ltail_got2
    s_cmp_lg_u64 s[54:55], 0
    s_cbranch_scc1 Ltail_spinl2
    s_branch Ltail_got2
Lattn_redo:
    v_xor_b32 v8, 64, v9
    v_xor_b32 v10, 64, v11
    s_waitcnt vmcnt(0) lgkmcnt(0)
    s_barrier
    v_mov_b32 v232, 0xff800000
    v_mov_b32 v233, 0xff800000
    v_mov_b32 v234, 0xff800000
    v_mov_b32 v235, 0xff800000
    s_mov_b32 s40, 0
    s_mov_b32 s48, -1
Lattn_redo_loop:
    s_add_u32 m0, s42, 0
    s_nop 0
    buffer_load_dwordx4 v36, s[8:11], s40 offen lds
    buffer_load_dwordx4 v37, s[8:11], s40 offen offset:1024 lds
    buffer_load_dwordx4 v38, s[8:11], s40 offen offset:2048 lds
    buffer_load_dwordx4 v39, s[8:11], s40 offen offset:3072 lds
    s_add_u32 s40, s40, 16384
    s_waitcnt vmcnt(0) lgkmcnt(0)
    s_barrier
    ds_read_b128 a[208:211], v8 offset:0
    ds_read_b128 a[212:215], v9 offset:0
    ds_read_b128 a[216:219], v10 offset:0
    ds_read_b128 a[220:223], v11 offset:0
    s_waitcnt lgkmcnt(3)
    v_mfma_f32_16x16x32_bf16 v[216:219], a[208:211], v[64:67], 0
    s_waitcnt lgkmcnt(2)
    v_mfma_f32_16x16x32_bf16 v[216:219], a[212:215], v[68:71], v[216:219]
    s_waitcnt lgkmcnt(1)
    v_mfma_f32_16x16x32_bf16 v[216:219], a[216:219], v[72:75], v[216:219]
    s_waitcnt lgkmcnt(0)
    v_mfma_f32_16x16x32_bf16 v[216:219], a[220:223], v[76:79], v[216:219]
    v_mfma_f32_16x16x32_bf16 v[220:223], a[208:211], v[80:83], 0
    v_mfma_f32_16x16x32_bf16 v[220:223], a[212:215], v[84:87], v[220:223]
    v_mfma_f32_16x16x32_bf16 v[220:223], a[216:219], v[88:91], v[220:223]
    v_mfma_f32_16x16x32_bf16 v[220:223], a[220:223], v[92:95], v[220:223]
    v_mfma_f32_16x16x32_bf16 v[224:227], a[208:211], v[96:99], 0
    v_mfma_f32_16x16x32_bf16 v[224:227], a[212:215], v[100:103], v[224:227]
    v_mfma_f32_16x16x32_bf16 v[224:227], a[216:219], v[104:107], v[224:227]
    v_mfma_f32_16x16x32_bf16 v[224:227], a[220:223], v[108:111], v[224:227]
    v_mfma_f32_16x16x32_bf16 v[228:231], a[208:211], v[112:115], 0
    v_mfma_f32_16x16x32_bf16 v[228:231], a[212:215], v[116:119], v[228:231]
    v_mfma_f32_16x16x32_bf16 v[228:231], a[216:219], v[120:123], v[228:231]
    v_mfma_f32_16x16x32_bf16 v[228:231], a[220:223], v[124:127], v[228:231]
    v_max3_f32 v232, v232, v216, v217
    v_max3_f32 v232, v232, v218, v219
    v_max3_f32 v233, v233, v220, v221
    v_max3_f32 v233, v233, v222, v223
    v_max3_f32 v234, v234, v224, v225
    v_max3_f32 v234, v234, v226, v227
    s_nop 1
    v_max3_f32 v235, v235, v228, v229
    v_max3_f32 v235, v235, v230, v231
    ds_read_b128 a[224:227], v8 offset:4096
    ds_read_b128 a[228:231], v9 offset:4096
    ds_read_b128 a[232:235], v10 offset:4096
    ds_read_b128 a[236:239], v11 offset:4096
    s_waitcnt lgkmcnt(3)
    v_mfma_f32_16x16x32_bf16 v[216:219], a[224:227], v[64:67], 0
    s_waitcnt lgkmcnt(2)
    v_mfma_f32_16x16x32_bf16 v[216:219], a[228:231], v[68:71], v[216:219]
    s_waitcnt lgkmcnt(1)
    v_mfma_f32_16x16x32_bf16 v[216:219], a[232:235], v[72:75], v[216:219]
    s_waitcnt lgkmcnt(0)
    v_mfma_f32_16x16x32_bf16 v[216:219], a[236:239], v[76:79], v[216:219]
    v_mfma_f32_16x16x32_bf16 v[220:223], a[224:227], v[80:83], 0
    v_mfma_f32_16x16x32_bf16 v[220:223], a[228:231], v[84:87], v[220:223]
    v_mfma_f32_16x16x32_bf16 v[220:223], a[232:235], v[88:91], v[220:223]
    v_mfma_f32_16x16x32_bf16 v[220:223], a[236:239], v[92:95], v[220:223]
    v_mfma_f32_16x16x32_bf16 v[224:227], a[224:227], v[96:99], 0
    v_mfma_f32_16x16x32_bf16 v[224:227], a[228:231], v[100:103], v[224:227]
    v_mfma_f32_16x16x32_bf16 v[224:227], a[232:235], v[104:107], v[224:227]
    v_mfma_f32_16x16x32_bf16 v[224:227], a[236:239], v[108:111], v[224:227]
    v_mfma_f32_16x16x32_bf16 v[228:231], a[224:227], v[112:115], 0
    v_mfma_f32_16x16x32_bf16 v[228:231], a[228:231], v[116:119], v[228:231]
    v_mfma_f32_16x16x32_bf16 v[228:231], a[232:235], v[120:123], v[228:231]
    v_mfma_f32_16x16x32_bf16 v[228:231], a[236:239], v[124:127], v[228:231]
    v_max3_f32 v232, v232, v216, v217
    v_max3_f32 v232, v232, v218, v219
    v_max3_f32 v233, v233, v220, v221
    v_max3_f32 v233, v233, v222, v223
    v_max3_f32 v234, v234, v224, v225
    v_max3_f32 v234, v234, v226, v227
    s_nop 1
    v_max3_f32 v235, v235, v228, v229
    v_max3_f32 v235, v235, v230, v231
    ds_read_b128 a[208:211], v8 offset:8192
    ds_read_b128 a[212:215], v9 offset:8192
    ds_read_b128 a[216:219], v10 offset:8192
    ds_read_b128 a[220:223], v11 offset:8192
    s_waitcnt lgkmcnt(3)
    v_mfma_f32_16x16x32_bf16 v[216:219], a[208:211], v[64:67], 0
    s_waitcnt lgkmcnt(2)
    v_mfma_f32_16x16x32_bf16 v[216:219], a[212:215], v[68:71], v[216:219]
    s_waitcnt lgkmcnt(1)
    v_mfma_f32_16x16x32_bf16 v[216:219], a[216:219], v[72:75], v[216:219]
    s_waitcnt lgkmcnt(0)
    v_mfma_f32_16x16x32_bf16 v[216:219], a[220:223], v[76:79], v[216:219]
    v_mfma_f32_16x16x32_bf16 v[220:223], a[208:211], v[80:83], 0
    v_mfma_f32_16x16x32_bf16 v[220:223], a[212:215], v[84:87], v[220:223]
    v_mfma_f32_16x16x32_bf16 v[220:223], a[216:219], v[88:91], v[220:223]
    v_mfma_f32_16x16x32_bf16 v[220:223], a[220:223], v[92:95], v[220:223]
    v_mfma_f32_16x16x32_bf16 v[224:227], a[208:211], v[96:99], 0
    v_mfma_f32_16x16x32_bf16 v[224:227], a[212:215], v[100:103], v[224:227]
    v_mfma_f32_16x16x32_bf16 v[224:227], a[216:219], v[104:107], v[224:227]
    v_mfma_f32_16x16x32_bf16 v[224:227], a[220:223], v[108:111], v[224:227]
    v_mfma_f32_16x16x32_bf16 v[228:231], a[208:211], v[112:115], 0
    v_mfma_f32_16x16x32_bf16 v[228:231], a[212:215], v[116:119], v[228:231]
    v_mfma_f32_16x16x32_bf16 v[228:231], a[216:219], v[120:123], v[228:231]
    v_mfma_f32_16x16x32_bf16 v[228:231], a[220:223], v[124:127], v[228:231]
    v_max3_f32 v232, v232, v216, v217
    v_max3_f32 v232, v232, v218, v219
    v_max3_f32 v233, v233, v220, v221
    v_max3_f32 v233, v233, v222, v223
    v_max3_f32 v234, v234, v224, v225
    v_max3_f32 v234, v234, v226, v227
    s_nop 1
    v_max3_f32 v235, v235, v228, v229
    v_max3_f32 v235, v235, v230, v231
    ds_read_b128 a[224:227], v8 offset:12288
    ds_read_b128 a[228:231], v9 offset:12288
    ds_read_b128 a[232:235], v10 offset:12288
    ds_read_b128 a[236:239], v11 offset:12288
    s_waitcnt lgkmcnt(3)
    v_mfma_f32_16x16x32_bf16 v[216:219], a[224:227], v[64:67], 0
    s_waitcnt lgkmcnt(2)
    v_mfma_f32_16x16x32_bf16 v[216:219], a[228:231], v[68:71], v[216:219]
    s_waitcnt lgkmcnt(1)
    v_mfma_f32_16x16x32_bf16 v[216:219], a[232:235], v[72:75], v[216:219]
    s_waitcnt lgkmcnt(0)
    v_mfma_f32_16x16x32_bf16 v[216:219], a[236:239], v[76:79], v[216:219]
    v_mfma_f32_16x16x32_bf16 v[220:223], a[224:227], v[80:83], 0
    v_mfma_f32_16x16x32_bf16 v[220:223], a[228:231], v[84:87], v[220:223]
    v_mfma_f32_16x16x32_bf16 v[220:223], a[232:235], v[88:91], v[220:223]
    v_mfma_f32_16x16x32_bf16 v[220:223], a[236:239], v[92:95], v[220:223]
    v_mfma_f32_16x16x32_bf16 v[224:227], a[224:227], v[96:99], 0
    v_mfma_f32_16x16x32_bf16 v[224:227], a[228:231], v[100:103], v[224:227]
    v_mfma_f32_16x16x32_bf16 v[224:227], a[232:235], v[104:107], v[224:227]
    v_mfma_f32_16x16x32_bf16 v[224:227], a[236:239], v[108:111], v[224:227]
    v_mfma_f32_16x16x32_bf16 v[228:231], a[224:227], v[112:115], 0
    v_mfma_f32_16x16x32_bf16 v[228:231], a[228:231], v[116:119], v[228:231]
    v_mfma_f32_16x16x32_bf16 v[228:231], a[232:235], v[120:123], v[228:231]
    v_mfma_f32_16x16x32_bf16 v[228:231], a[236:239], v[124:127], v[228:231]
    v_max3_f32 v232, v232, v216, v217
    v_max3_f32 v232, v232, v218, v219
    v_max3_f32 v233, v233, v220, v221
    v_max3_f32 v233, v233, v222, v223
    v_max3_f32 v234, v234, v224, v225
    v_max3_f32 v234, v234, v226, v227
    s_nop 1
    v_max3_f32 v235, v235, v228, v229
    v_max3_f32 v235, v235, v230, v231
    s_barrier
    s_cmp_lt_u32 s40, 524288
    s_cbranch_scc1 Lattn_redo_loop
    v_mov_b32 v236, v232
    v_mov_b32 v237, v233
    v_mov_b32 v238, v234
    v_mov_b32 v239, v235
    v_permlane16_swap_b32 v232, v236
    v_permlane16_swap_b32 v233, v237
    v_permlane16_swap_b32 v234, v238
    v_permlane16_swap_b32 v235, v239
    v_max_f32 v232, v232, v236
    v_max_f32 v233, v233, v237
    v_max_f32 v234, v234, v238
    v_max_f32 v235, v235, v239
    v_mov_b32 v236, v232
    v_mov_b32 v237, v233
    v_mov_b32 v238, v234
    v_mov_b32 v239, v235
    v_permlane32_swap_b32 v232, v236
    v_permlane32_swap_b32 v233, v237
    v_permlane32_swap_b32 v234, v238
    v_permlane32_swap_b32 v235, v239
    v_max_f32 v232, v232, v236
    v_max_f32 v233, v233, v237
    v_max_f32 v234, v234, v238
    v_max_f32 v235, v235, v239
    v_sub_f32 v192, 0, v232
    v_sub_f32 v193, 0, v232
    v_sub_f32 v194, 0, v232
    v_sub_f32 v195, 0, v232
    v_sub_f32 v196, 0, v233
    v_sub_f32 v197, 0, v233
    v_sub_f32 v198, 0, v233
    v_sub_f32 v199, 0, v233
    v_sub_f32 v200, 0, v234
    v_sub_f32 v201, 0, v234
    v_sub_f32 v202, 0, v234
    v_sub_f32 v203, 0, v234
    v_sub_f32 v204, 0, v235
    v_sub_f32 v205, 0, v235
    v_sub_f32 v206, 0, v235
    v_sub_f32 v207, 0, v235
    s_mov_b32 s40, 0
    s_mov_b32 s41, 0
    s_add_u32 m0, s42, 0
    s_nop 0
    buffer_load_dwordx4 v36, s[8:11], s40 offen lds
    buffer_load_dwordx4 v37, s[8:11], s40 offen offset:1024 lds
    buffer_load_dwordx4 v38, s[8:11], s40 offen offset:2048 lds
    buffer_load_dwordx4 v39, s[8:11], s40 offen offset:3072 lds
    s_add_u32 s40, s40, 16384
    s_add_u32 m0, s42, 16384
    s_nop 0
    buffer_load_dwordx4 v36, s[8:11], s40 offen lds
    buffer_load_dwordx4 v37, s[8:11], s40 offen offset:1024 lds
    buffer_load_dwordx4 v38, s[8:11], s40 offen offset:2048 lds
    buffer_load_dwordx4 v39, s[8:11], s40 offen offset:3072 lds
    s_add_u32 s40, s40, 16384
    s_add_u32 m0, s42, 32768
    s_nop 0
    buffer_load_dwordx4 v36, s[8:11], s40 offen lds
    buffer_load_dwordx4 v37, s[8:11], s40 offen offset:1024 lds
    buffer_load_dwordx4 v38, s[8:11], s40 offen offset:2048 lds
    buffer_load_dwordx4 v39, s[8:11], s40 offen offset:3072 lds
    s_add_u32 s40, s40, 16384
    s_add_u32 m0, s42, 65536
    s_nop 0
    buffer_load_dwordx4 v40, s[12:15], s41 offen lds
    buffer_load_dwordx4 v41, s[12:15], s41 offen offset:1024 lds
    buffer_load_dwordx4 v40, s[12:15], s41 offen offset:2048 lds
    buffer_load_dwordx4 v41, s[12:15], s41 offen offset:3072 lds
    s_add_u32 s41, s41, 16384
    s_add_u32 m0, s42, 81920
    s_nop 0
    buffer_load_dwordx4 v40, s[12:15], s41 offen lds
    buffer_load_dwordx4 v41, s[12:15], s41 offen offset:1024 lds
    buffer_load_dwordx4 v40, s[12:15], s41 offen offset:2048 lds
    buffer_load_dwordx4 v41, s[12:15], s41 offen offset:3072 lds
    s_add_u32 s41, s41, 16384
    v_accvgpr_write_b32 a0, 0
    v_accvgpr_write_b32 a1, 0
    v_accvgpr_write_b32 a2, 0
    v_accvgpr_write_b32 a3, 0
    v_accvgpr_write_b32 a4, 0
    v_accvgpr_write_b32 a5, 0
    v_accvgpr_write_b32 a6, 0
    v_accvgpr_write_b32 a7, 0
    v_accvgpr_write_b32 a8, 0
    v_accvgpr_write_b32 a9, 0
    v_accvgpr_write_b32 a10, 0
    v_accvgpr_write_b32 a11, 0
    v_accvgpr_write_b32 a12, 0
    v_accvgpr_write_b32 a13, 0
    v_accvgpr_write_b32 a14, 0
    v_accvgpr_write_b32 a15, 0
    v_accvgpr_write_b32 a16, 0
    v_accvgpr_write_b32 a17, 0
    v_accvgpr_write_b32 a18, 0
    v_accvgpr_write_b32 a19, 0
    v_accvgpr_write_b32 a20, 0
    v_accvgpr_write_b32 a21, 0
    v_accvgpr_write_b32 a22, 0
    v_accvgpr_write_b32 a23, 0
    v_accvgpr_write_b32 a24, 0
    v_accvgpr_write_b32 a25, 0
    v_accvgpr_write_b32 a26, 0
    v_accvgpr_write_b32 a27, 0
    v_accvgpr_write_b32 a28, 0
    v_accvgpr_write_b32 a29, 0
    v_accvgpr_write_b32 a30, 0
    v_accvgpr_write_b32 a31, 0
    v_accvgpr_write_b32 a32, 0
    v_accvgpr_write_b32 a33, 0
    v_accvgpr_write_b32 a34, 0
    v_accvgpr_write_b32 a35, 0
    v_accvgpr_write_b32 a36, 0
    v_accvgpr_write_b32 a37, 0
    v_accvgpr_write_b32 a38, 0
    v_accvgpr_write_b32 a39, 0
    v_accvgpr_write_b32 a40, 0
    v_accvgpr_write_b32 a41, 0
    v_accvgpr_write_b32 a42, 0
    v_accvgpr_write_b32 a43, 0
    v_accvgpr_write_b32 a44, 0
    v_accvgpr_write_b32 a45, 0
    v_accvgpr_write_b32 a46, 0
    v_accvgpr_write_b32 a47, 0
    v_accvgpr_write_b32 a48, 0
    v_accvgpr_write_b32 a49, 0
    v_accvgpr_write_b32 a50, 0
    v_accvgpr_write_b32 a51, 0
    v_accvgpr_write_b32 a52, 0
    v_accvgpr_write_b32 a53, 0
    v_accvgpr_write_b32 a54, 0
    v_accvgpr_write_b32 a55, 0
    v_accvgpr_write_b32 a56, 0
    v_accvgpr_write_b32 a57, 0
    v_accvgpr_write_b32 a58, 0
    v_accvgpr_write_b32 a59, 0
    v_accvgpr_write_b32 a60, 0
    v_accvgpr_write_b32 a61, 0
    v_accvgpr_write_b32 a62, 0
    v_accvgpr_write_b32 a63, 0
    v_accvgpr_write_b32 a64, 0
    v_accvgpr_write_b32 a65, 0
    v_accvgpr_write_b32 a66, 0
    v_accvgpr_write_b32 a67, 0
    v_accvgpr_write_b32 a68, 0
    v_accvgpr_write_b32 a69, 0
    v_accvgpr_write_b32 a70, 0
    v_accvgpr_write_b32 a71, 0
    v_accvgpr_write_b32 a72, 0
    v_accvgpr_write_b32 a73, 0
    v_accvgpr_write_b32 a74, 0
    v_accvgpr_write_b32 a75, 0
    v_accvgpr_write_b32 a76, 0
    v_accvgpr_write_b32 a77, 0
    v_accvgpr_write_b32 a78, 0
    v_accvgpr_write_b32 a79, 0
    v_accvgpr_write_b32 a80, 0
    v_accvgpr_write_b32 a81, 0
    v_accvgpr_write_b32 a82, 0
    v_accvgpr_write_b32 a83, 0
    v_accvgpr_write_b32 a84, 0
    v_accvgpr_write_b32 a85, 0
    v_accvgpr_write_b32 a86, 0
    v_accvgpr_write_b32 a87, 0
    v_accvgpr_write_b32 a88, 0
    v_accvgpr_write_b32 a89, 0
    v_accvgpr_write_b32 a90, 0
    v_accvgpr_write_b32 a91, 0
    v_accvgpr_write_b32 a92, 0
    v_accvgpr_write_b32 a93, 0
    v_accvgpr_write_b32 a94, 0
    v_accvgpr_write_b32 a95, 0
    v_accvgpr_write_b32 a96, 0
    v_accvgpr_write_b32 a97, 0
    v_accvgpr_write_b32 a98, 0
    v_accvgpr_write_b32 a99, 0
    v_accvgpr_write_b32 a100, 0
    v_accvgpr_write_b32 a101, 0
    v_accvgpr_write_b32 a102, 0
    v_accvgpr_write_b32 a103, 0
    v_accvgpr_write_b32 a104, 0
    v_accvgpr_write_b32 a105, 0
    v_accvgpr_write_b32 a106, 0
    v_accvgpr_write_b32 a107, 0
    v_accvgpr_write_b32 a108, 0
    v_accvgpr_write_b32 a109, 0
    v_accvgpr_write_b32 a110, 0
    v_accvgpr_write_b32 a111, 0
    v_accvgpr_write_b32 a112, 0
    v_accvgpr_write_b32 a113, 0
    v_accvgpr_write_b32 a114, 0
    v_accvgpr_write_b32 a115, 0
    v_accvgpr_write_b32 a116, 0
    v_accvgpr_write_b32 a117, 0
    v_accvgpr_write_b32 a118, 0
    v_accvgpr_write_b32 a119, 0
    v_accvgpr_write_b32 a120, 0
    v_accvgpr_write_b32 a121, 0
    v_accvgpr_write_b32 a122, 0
    v_accvgpr_write_b32 a123, 0
    v_accvgpr_write_b32 a124, 0
    v_accvgpr_write_b32 a125, 0
    v_accvgpr_write_b32 a126, 0
    v_accvgpr_write_b32 a127, 0
    v_accvgpr_write_b32 a192, 0
    v_accvgpr_write_b32 a193, 0
    v_accvgpr_write_b32 a194, 0
    v_accvgpr_write_b32 a195, 0
    v_accvgpr_write_b32 a196, 0
    v_accvgpr_write_b32 a197, 0
    v_accvgpr_write_b32 a198, 0
    v_accvgpr_write_b32 a199, 0
    v_accvgpr_write_b32 a200, 0
    v_accvgpr_write_b32 a201, 0
    v_accvgpr_write_b32 a202, 0
    v_accvgpr_write_b32 a203, 0
    v_accvgpr_write_b32 a204, 0
    v_accvgpr_write_b32 a205, 0
    v_accvgpr_write_b32 a206, 0
    v_accvgpr_write_b32 a207, 0
    s_waitcnt vmcnt(0) lgkmcnt(0)
    s_barrier
    ds_read_b128 a[208:211], v8 offset:0
    ds_read_b128 a[212:215], v9 offset:0
    ds_read_b128 a[216:219], v10 offset:0
    ds_read_b128 a[220:223], v11 offset:0
    ds_read_b128 a[224:227], v8 offset:4096
    s_waitcnt vmcnt(0) lgkmcnt(0)
    s_branch Lattn_stage0
Lattn_armwait:
    s_mov_b32 s36, 262144
Lattn_armloop:
    v_mov_b32 v63, 0
    buffer_load_dword v63, v63, s[88:91], 0 offen sc1
    s_waitcnt vmcnt(0)
    v_readfirstlane_b32 s37, v63
    s_sub_u32 s36, s36, 1
    s_cbranch_scc1 Lattn_armed
    s_cmp_lt_u32 s37, 256
    s_cbranch_scc1 Lattn_armloop
    s_branch Lattn_armed
Lattn_end:
    s_endpgm
.section .rodata,"a"
.p2align 6
.amdhsa_kernel adaLN_cond__gqa_block_cached__moe_arch_mod__prompt_kernel
  .amdhsa_next_free_vgpr 512
  .amdhsa_next_free_sgpr 102
  .amdhsa_accum_offset 256
  .amdhsa_group_segment_fixed_size 0
  .amdhsa_kernarg_size 120
  .amdhsa_user_sgpr_count 2
  .amdhsa_user_sgpr_kernarg_segment_ptr 1
  .amdhsa_system_sgpr_workgroup_id_x 1
  .amdhsa_float_denorm_mode_32 3
.end_amdhsa_kernel
```

```asm
; @launch grid=(256,1,1) block=(256,1,1) lds=163840
.amdgcn_target "amdgcn-amd-amdhsa--gfx950"
.text
.globl adaLN_cond__gqa_block_cached__moe_arch_mod__prompt_kernel
.p2align 8
.type adaLN_cond__gqa_block_cached__moe_arch_mod__prompt_kernel,@function
adaLN_cond__gqa_block_cached__moe_arch_mod__prompt_kernel:
    s_cmp_ge_u32 s2, 256
    s_cbranch_scc1 Lattn_end
    s_load_dwordx2 s[8:9], s[0:1], 80
    s_load_dwordx2 s[12:13], s[0:1], 88
    s_load_dwordx2 s[20:21], s[0:1], 0
    s_load_dwordx2 s[50:51], s[0:1], 112
    s_load_dwordx8 s[52:59], s[0:1], 8
    s_load_dwordx4 s[80:83], s[0:1], 56
    s_load_dwordx2 s[84:85], s[0:1], 72
    s_load_dwordx2 s[88:89], s[0:1], 104
    s_load_dwordx2 s[28:29], s[0:1], 48
    s_getpc_b64 s[32:33]
Lattn_pc:
    s_mov_b32 s34, Lattn_end-Lattn_pc
    s_mov_b32 s35, 0x20000
    s_lshr_b32 s6, s2, 3
    s_lshl_b32 s7, s6, 6
    v_lshrrev_b32 v3, 6, v0
    v_and_b32 v1, 63, v0
    v_lshrrev_b32 v2, 2, v0
    v_lshlrev_b32 v2, 11, v2
    v_readfirstlane_b32 s3, v3
    buffer_load_dword v240, v2, s[32:35], s7 offen
    s_and_b32 s7, s2, 7
    s_lshl_b32 s4, s7, 1
    s_and_b32 s5, s6, 1
    s_add_u32 s4, s4, s5
    s_lshr_b32 s5, s2, 4
    s_lshr_b32 s38, s6, 2
    s_lshl_b32 s38, s38, 3
    s_add_u32 s38, s38, s7
    s_cmp_lt_u32 s38, 18
    s_cselect_b32 s39, 0, 2147483648
    s_lshl_b32 s38, s38, 2
    s_and_b32 s36, s6, 3
    s_add_u32 s38, s38, s36
    s_mov_b32 s14, 3981312
    s_mul_i32 s92, s6, 124416
    s_lshl_b32 s36, s7, 7
    s_add_u32 s92, s92, s36
    s_cmp_lt_u32 s7, 2
    s_cselect_b32 s36, 53, 35
    v_lshrrev_b32 v2, 2, v0
    v_min_u32 v2, s36, v2
    v_mul_u32_u24 v3, 57, v2
    v_lshrrev_b32 v3, 10, v3
    v_mul_i32_i24 v3, -123392, v3
    v_mul_u32_u24 v2, 6912, v2
    v_add_u32 v72, v2, v3
    s_mov_b32 s15, 0x20000
    s_mov_b32 s10, 1152
    s_mov_b32 s11, 0x20000
    s_mov_b32 s22, 2359296
    s_mov_b32 s23, 0x20000
    v_and_b32 v64, 0xfe, v0
    v_mul_u32_u24 v65, 3456, v64
    v_and_b32 v2, 1, v0
    v_lshl_add_u32 v65, v2, 4, v65
    s_lshl_b32 s36, s38, 5
    s_or_b32 s36, s36, s39
    v_and_b32 v4, 31, v1
    v_lshrrev_b32 v5, 5, v1
    v_cmp_gt_u32 vcc, 24, v4
    v_mov_b32 v6, 2147483648
    s_lshl_b32 s7, s5, 4
    s_add_u32 s7, s7, s4
    s_lshl_b32 s7, s7, 2
    s_add_u32 s7, s7, s3
    v_cndmask_b32 v6, v6, 0, vcc
    s_mul_i32 s49, s7, 2304
    v_lshrrev_b32 v7, 2, v4
    v_lshl_add_u32 v7, v7, 6, v6
    v_and_b32 v2, 3, v4
    v_lshl_add_u32 v7, v2, 3, v7
    v_mul_u32_u24 v2, 1152, v5
    v_add_u32 v66, v7, v2
    s_waitcnt lgkmcnt(0)
    s_load_dword s94, s[50:51], 24576
    buffer_load_dword v241, v72, s[12:15], s92 offen
    buffer_load_ushort v80, v64, s[8:11], 0 offen offset:0
    buffer_load_ushort v81, v64, s[8:11], 0 offen offset:256
    buffer_load_ushort v82, v64, s[8:11], 0 offen offset:512
    buffer_load_ushort v83, v64, s[8:11], 0 offen offset:768
    buffer_load_ushort v84, v64, s[8:11], 0 offen offset:1024
    buffer_load_dwordx4 v[88:91], v65, s[12:15], s36 offen
    s_add_u32 s36, s36, 884736
    buffer_load_dwordx4 v[92:95], v65, s[12:15], s36 offen
    s_add_u32 s36, s36, 884736
    buffer_load_dwordx4 v[96:99], v65, s[12:15], s36 offen
    s_add_u32 s36, s36, 884736
    buffer_load_dwordx4 v[100:103], v65, s[12:15], s36 offen
    s_add_u32 s36, s36, 884736
    buffer_load_dwordx4 v[104:107], v65, s[12:15], s36 offen
    s_mov_b32 s16, s56
    s_mov_b32 s17, s57
    s_mov_b32 s18, 4718592
    s_mov_b32 s19, 0x20000
    s_lshl_b32 s44, s4, 9
    s_mul_i32 s36, s5, 98304
    s_add_u32 s36, s36, 0
    v_lshrrev_b32 v2, 2, v0
    v_min_u32 v2, 47, v2
    v_lshrrev_b32 v3, 2, v2
    v_and_b32 v2, 3, v2
    v_lshl_add_u32 v2, v2, 7, s36
    v_lshl_add_u32 v71, v3, 13, v2
    s_mul_i32 s36, s5, 196608
    s_add_u32 s36, s36, 1572864
    v_lshrrev_b32 v2, 1, v0
    v_min_u32 v2, 95, v2
    v_lshrrev_b32 v3, 2, v2
    v_and_b32 v2, 3, v2
    v_lshl_add_u32 v2, v2, 7, s36
    v_lshl_add_u32 v70, v3, 13, v2
    s_add_u32 s92, s49, 65536
    v_lshl_add_u32 v7, v5, 4, v6
    v_lshl_add_u32 v67, v4, 5, v7
    v_min_u32 v4, 23, v4
    v_lshlrev_b32 v68, 4, v4
    s_mov_b32 s24, s50
    s_mov_b32 s25, s51
    s_mov_b32 s26, 10485760
    s_mov_b32 s27, 0x20000
    s_mov_b32 s90, 256
    s_mov_b32 s91, 0x20000
    s_cmp_ge_u32 s38, 36
    s_cselect_b32 s93, 1.0, 0
    s_lshl_b32 s36, s38, 7
    v_lshl_add_u32 v69, v0, 3, s36
    v_cmp_gt_u32 s[36:37], 16, v0
    v_mov_b32 v2, 2147483648
    v_mov_b32 v3, s39
    v_cndmask_b32 v2, v2, v3, s[36:37]
    v_or_b32 v69, v69, v2
    s_mul_i32 s36, s5, 3072
    s_lshl_b32 s37, s5, 11
    v_lshrrev_b32 v120, 3, v0
    v_min_u32 v120, 23, v120
    v_lshl_add_u32 v120, v120, 7, s36
    v_lshrrev_b32 v121, 4, v0
    v_lshl_add_u32 v121, v121, 7, s37
    s_lshl_b32 s42, s3, 12
    v_lshrrev_b32 v2, 4, v1
    v_and_b32 v3, 15, v1
    v_lshrrev_b32 v5, 1, v3
    v_mul_u32_u24 v5, 2304, v5
    v_lshl_add_u32 v5, v2, 5, v5
    v_and_b32 v6, 1, v3
    v_lshl_add_u32 v51, v6, 4, v5
    s_lshl_b32 s6, s5, 2
    s_add_u32 s6, s6, s3
    s_mul_i32 s46, s6, 36864
    s_add_u32 s46, s46, 65536
    s_add_u32 s43, s46, 18432
    s_mul_i32 s45, s4, 294912
    s_lshl_b32 s7, s3, 4
    v_add_u32 v4, s7, v2
    v_lshlrev_b32 v5, 1, v2
    v_xor_b32 v5, v5, v3
    v_xor_b32 v6, 8, v5
    v_lshlrev_b32 v7, 13, v4
    v_lshl_add_u32 v42, v5, 4, v7
    v_lshl_add_u32 v43, v6, 4, v7
    v_add_u32 v44, 63488, v42
    v_add_u32 v45, 95232, v43
    v_add_u32 v43, 31744, v43
    s_lshl_b32 s7, s4, 19
    s_add_u32 s8, s52, s7
    s_addc_u32 s9, s53, 0
    s_mov_b32 s10, 524288
    s_mov_b32 s11, 0x20000
    s_add_u32 s12, s54, s7
    s_addc_u32 s13, s55, 0
    s_mov_b32 s14, 524288
    s_mov_b32 s15, 0x20000
    s_add_u32 s28, s50, 10485760
    s_addc_u32 s29, s51, 0
    s_mov_b32 s30, 37748736
    s_mov_b32 s31, 0x20000
    v_lshlrev_b32 v7, 8, v4
    v_lshl_add_u32 v40, v5, 4, v7
    v_lshl_add_u32 v41, v6, 4, v7
    v_xor_b32 v224, v3, v2
    v_lshl_add_u32 v36, v224, 4, v7
    v_xor_b32 v37, 64, v36
    v_xor_b32 v38, 128, v36
    v_xor_b32 v39, 192, v36
    v_lshrrev_b32 v7, 3, v5
    v_lshl_add_u32 v7, v7, 7, v4
    v_mul_u32_u24 v7, 1152, v7
    v_and_b32 v225, 7, v5
    v_lshl_add_u32 v46, v225, 4, v7
    v_lshrrev_b32 v7, 3, v6
    v_lshl_add_u32 v7, v7, 7, v4
    v_mul_u32_u24 v7, 1152, v7
    v_and_b32 v225, 7, v6
    v_lshl_add_u32 v47, v225, 4, v7
    v_add_u32 v48, 7168, v46
    v_add_u32 v49, 10752, v47
    v_add_u32 v47, 3584, v47
    v_lshlrev_b32 v7, 8, v3
    v_lshl_add_u32 v8, v224, 4, v7
    v_xor_b32 v9, 64, v8
    v_xor_b32 v10, 128, v8
    v_xor_b32 v11, 192, v8
    v_lshrrev_b32 v5, 2, v1
    v_and_b32 v6, 7, v5
    v_lshlrev_b32 v6, 5, v6
    v_lshl_add_u32 v6, v5, 8, v6
    v_and_b32 v7, 3, v1
    v_lshl_add_u32 v12, v7, 3, v6
    v_xor_b32 v13, 32, v12
    v_xor_b32 v14, 64, v12
    v_xor_b32 v15, 96, v12
    v_xor_b32 v16, 128, v12
    v_xor_b32 v17, 160, v12
    v_xor_b32 v18, 192, v12
    v_xor_b32 v19, 224, v12
    v_add_u32 v20, 65536, v12
    v_add_u32 v21, 65536, v13
    v_add_u32 v22, 65536, v14
    v_add_u32 v23, 65536, v15
    v_add_u32 v24, 65536, v16
    v_add_u32 v25, 65536, v17
    v_add_u32 v26, 65536, v18
    v_add_u32 v27, 65536, v19
    v_add_u32 v28, 131072, v12
    v_add_u32 v29, 131072, v13
    v_add_u32 v30, 131072, v14
    v_add_u32 v31, 131072, v15
    v_add_u32 v32, 131072, v16
    v_add_u32 v33, 131072, v17
    v_add_u32 v34, 131072, v18
    v_add_u32 v35, 131072, v19
    v_mov_b32 v52, 0x3f803f80
    v_mov_b32 v53, 0x3f803f80
    v_mov_b32 v54, 0x3f803f80
    v_mov_b32 v55, 0x3f803f80
    v_and_b32 v5, 1, v1
    v_mul_u32_u24 v5, 0xaaaa, v5
    v_add_u32 v5, 0x4444, v5
    v_lshl_add_u32 v50, v5, 16, v5
    v_lshrrev_b32 v5, 1, v3
    v_mul_u32_u24 v5, 20480, v5
    v_lshl_add_u32 v5, v2, 5, v5
    v_and_b32 v6, 1, v3
    v_lshl_add_u32 v56, v6, 4, v5
    s_mul_i32 s47, s6, 327680
    s_mov_b32 s32, s82
    s_mov_b32 s33, s83
    s_mov_b32 s34, 5308416
    s_mov_b32 s35, 0x20000
    s_mov_b32 s82, 5308416
    s_mov_b32 s83, 0x20000
    s_mov_b32 s86, 5308416
    s_mov_b32 s87, 0x20000
    s_lshr_b32 s7, s2, 3
    s_mul_i32 s7, s7, 18
    s_add_u32 s7, s7, s3
    s_and_b32 s36, s2, 7
    s_mul_i32 s37, s36, 576
    s_add_u32 s37, s37, s7
    s_mul_i32 s37, s37, 1152
    s_mul_i32 s7, s7, 9216
    s_mul_i32 s36, s36, 1152
    s_add_u32 s7, s7, s36
    v_min_u32 v5, 17, v1
    v_lshl_add_u32 v57, v5, 6, s7
    v_lshl_add_u32 v62, v5, 6, s37
    s_mov_b32 s40, 0
    s_mov_b32 s41, 0
    s_mov_b32 s48, 0
    s_waitcnt vmcnt(9)
    v_lshlrev_b32 v80, 16, v80
    s_waitcnt vmcnt(8)
    v_lshlrev_b32 v81, 16, v81
    s_waitcnt vmcnt(7)
    v_lshlrev_b32 v82, 16, v82
    s_waitcnt vmcnt(6)
    v_lshlrev_b32 v83, 16, v83
    s_waitcnt vmcnt(5)
    v_lshlrev_b32 v84, 16, v84
    v_mul_f32 v144, 0xbfb8aa3b, v80
    v_mul_f32 v148, 0xbfb8aa3b, v81
    v_mul_f32 v152, 0xbfb8aa3b, v82
    v_mul_f32 v156, 0xbfb8aa3b, v83
    v_mul_f32 v160, 0xbfb8aa3b, v84
    v_min_f32 v144, 0x42fc0000, v144
    v_min_f32 v148, 0x42fc0000, v148
    v_min_f32 v152, 0x42fc0000, v152
    v_min_f32 v156, 0x42fc0000, v156
    v_min_f32 v160, 0x42fc0000, v160
    v_exp_f32 v144, v144
    v_exp_f32 v148, v148
    v_exp_f32 v152, v152
    v_exp_f32 v156, v156
    v_exp_f32 v160, v160
    v_add_f32 v144, 1.0, v144
    v_add_f32 v148, 1.0, v148
    v_add_f32 v152, 1.0, v152
    v_add_f32 v156, 1.0, v156
    v_add_f32 v160, 1.0, v160
    v_rcp_f32 v145, v144
    v_rcp_f32 v149, v148
    v_rcp_f32 v153, v152
    v_rcp_f32 v157, v156
    v_rcp_f32 v161, v160
    v_mul_f32 v146, v80, v145
    v_mul_f32 v150, v81, v149
    v_mul_f32 v154, v82, v153
    v_mul_f32 v158, v83, v157
    v_mul_f32 v162, v84, v161
    v_fma_f32 v144, -v146, v144, v80
    v_fma_f32 v148, -v150, v148, v81
    v_fma_f32 v152, -v154, v152, v82
    v_fma_f32 v156, -v158, v156, v83
    v_fma_f32 v160, -v162, v160, v84
    v_fma_f32 v80, v144, v145, v146
    v_fma_f32 v81, v148, v149, v150
    v_fma_f32 v82, v152, v153, v154
    v_fma_f32 v83, v156, v157, v158
    v_fma_f32 v84, v160, v161, v162
    v_cvt_pk_bf16_f32 v80, v80, v80
    v_cvt_pk_bf16_f32 v81, v81, v81
    v_cvt_pk_bf16_f32 v82, v82, v82
    v_cvt_pk_bf16_f32 v83, v83, v83
    v_cvt_pk_bf16_f32 v84, v84, v84
    v_and_b32 v80, 0xffff0000, v80
    v_and_b32 v81, 0xffff0000, v81
    v_and_b32 v82, 0xffff0000, v82
    v_and_b32 v83, 0xffff0000, v83
    v_and_b32 v84, 0xffff0000, v84
    buffer_load_dwordx2 v[108:109], v66, s[20:23], s49 offen offset:0
    buffer_load_dwordx2 v[110:111], v66, s[20:23], s49 offen offset:32
    buffer_load_dwordx2 v[112:113], v66, s[20:23], s49 offen offset:384
    buffer_load_dwordx2 v[114:115], v66, s[20:23], s49 offen offset:416
    buffer_load_dwordx2 v[116:117], v66, s[20:23], s49 offen offset:768
    buffer_load_dwordx2 v[118:119], v66, s[20:23], s49 offen offset:800
    s_mov_b32 s20, s58
    s_mov_b32 s21, s59
    s_mov_b32 s22, 4718592
    s_mov_b32 s23, 0x20000
    s_waitcnt vmcnt(10)
    v_lshlrev_b32 v136, 16, v88
    v_and_b32 v137, 0xffff0000, v88
    v_lshlrev_b32 v138, 16, v89
    v_and_b32 v139, 0xffff0000, v89
    v_lshlrev_b32 v140, 16, v90
    v_and_b32 v141, 0xffff0000, v90
    v_lshlrev_b32 v142, 16, v91
    v_and_b32 v143, 0xffff0000, v91
    v_pk_mul_f32 v[128:129], v[136:137], v[80:81] op_sel:[0,0] op_sel_hi:[1,0]
    v_pk_mul_f32 v[130:131], v[138:139], v[80:81] op_sel:[0,0] op_sel_hi:[1,0]
    v_pk_mul_f32 v[132:133], v[140:141], v[80:81] op_sel:[0,0] op_sel_hi:[1,0]
    v_pk_mul_f32 v[134:135], v[142:143], v[80:81] op_sel:[0,0] op_sel_hi:[1,0]
    s_waitcnt vmcnt(9)
    v_lshlrev_b32 v136, 16, v92
    v_and_b32 v137, 0xffff0000, v92
    v_lshlrev_b32 v138, 16, v93
    v_and_b32 v139, 0xffff0000, v93
    v_lshlrev_b32 v140, 16, v94
    v_and_b32 v141, 0xffff0000, v94
    v_lshlrev_b32 v142, 16, v95
    v_and_b32 v143, 0xffff0000, v95
    v_pk_fma_f32 v[128:129], v[136:137], v[80:81], v[128:129] op_sel:[0,1,0] op_sel_hi:[1,1,1]
    v_pk_fma_f32 v[130:131], v[138:139], v[80:81], v[130:131] op_sel:[0,1,0] op_sel_hi:[1,1,1]
    v_pk_fma_f32 v[132:133], v[140:141], v[80:81], v[132:133] op_sel:[0,1,0] op_sel_hi:[1,1,1]
    v_pk_fma_f32 v[134:135], v[142:143], v[80:81], v[134:135] op_sel:[0,1,0] op_sel_hi:[1,1,1]
    s_waitcnt vmcnt(8)
    v_lshlrev_b32 v136, 16, v96
    v_and_b32 v137, 0xffff0000, v96
    v_lshlrev_b32 v138, 16, v97
    v_and_b32 v139, 0xffff0000, v97
    v_lshlrev_b32 v140, 16, v98
    v_and_b32 v141, 0xffff0000, v98
    v_lshlrev_b32 v142, 16, v99
    v_and_b32 v143, 0xffff0000, v99
    v_pk_fma_f32 v[128:129], v[136:137], v[82:83], v[128:129] op_sel:[0,0,0] op_sel_hi:[1,0,1]
    v_pk_fma_f32 v[130:131], v[138:139], v[82:83], v[130:131] op_sel:[0,0,0] op_sel_hi:[1,0,1]
    v_pk_fma_f32 v[132:133], v[140:141], v[82:83], v[132:133] op_sel:[0,0,0] op_sel_hi:[1,0,1]
    v_pk_fma_f32 v[134:135], v[142:143], v[82:83], v[134:135] op_sel:[0,0,0] op_sel_hi:[1,0,1]
    s_waitcnt vmcnt(7)
    v_lshlrev_b32 v136, 16, v100
    v_and_b32 v137, 0xffff0000, v100
    v_lshlrev_b32 v138, 16, v101
    v_and_b32 v139, 0xffff0000, v101
    v_lshlrev_b32 v140, 16, v102
    v_and_b32 v141, 0xffff0000, v102
    v_lshlrev_b32 v142, 16, v103
    v_and_b32 v143, 0xffff0000, v103
    v_pk_fma_f32 v[128:129], v[136:137], v[82:83], v[128:129] op_sel:[0,1,0] op_sel_hi:[1,1,1]
    v_pk_fma_f32 v[130:131], v[138:139], v[82:83], v[130:131] op_sel:[0,1,0] op_sel_hi:[1,1,1]
    v_pk_fma_f32 v[132:133], v[140:141], v[82:83], v[132:133] op_sel:[0,1,0] op_sel_hi:[1,1,1]
    v_pk_fma_f32 v[134:135], v[142:143], v[82:83], v[134:135] op_sel:[0,1,0] op_sel_hi:[1,1,1]
    s_waitcnt vmcnt(6)
    v_lshlrev_b32 v136, 16, v104
    v_and_b32 v137, 0xffff0000, v104
    v_lshlrev_b32 v138, 16, v105
    v_and_b32 v139, 0xffff0000, v105
    v_lshlrev_b32 v140, 16, v106
    v_and_b32 v141, 0xffff0000, v106
    v_lshlrev_b32 v142, 16, v107
    v_and_b32 v143, 0xffff0000, v107
    v_pk_fma_f32 v[128:129], v[136:137], v[84:85], v[128:129] op_sel:[0,0,0] op_sel_hi:[1,0,1]
    v_pk_fma_f32 v[130:131], v[138:139], v[84:85], v[130:131] op_sel:[0,0,0] op_sel_hi:[1,0,1]
    v_pk_fma_f32 v[132:133], v[140:141], v[84:85], v[132:133] op_sel:[0,0,0] op_sel_hi:[1,0,1]
    v_pk_fma_f32 v[134:135], v[142:143], v[84:85], v[134:135] op_sel:[0,0,0] op_sel_hi:[1,0,1]
    s_nop 0
    v_permlane32_swap_b32 v128, v132
    v_permlane32_swap_b32 v129, v133
    v_permlane32_swap_b32 v130, v134
    v_permlane32_swap_b32 v131, v135
    v_and_b32 v72, 1, v1
    v_pk_add_f32 v[128:129], v[128:129], v[132:133]
    v_pk_add_f32 v[130:131], v[130:131], v[134:135]
    v_lshlrev_b32 v72, 5, v72
    v_lshrrev_b32 v73, 4, v1
    v_permlane16_swap_b32 v128, v130
    v_permlane16_swap_b32 v129, v131
    v_lshl_add_u32 v72, v73, 3, v72
    v_pk_add_f32 v[128:129], v[128:129], v[130:131]
    s_lshl_b32 s36, s3, 6
    v_add_u32 v72, s36, v72
    v_add_f32_dpp v128, v128, v128 row_ror:2 row_mask:0xf bank_mask:0xf
    v_add_f32_dpp v129, v129, v129 row_ror:2 row_mask:0xf bank_mask:0xf
    s_nop 0
    v_add_f32_dpp v128, v128, v128 row_ror:4 row_mask:0xf bank_mask:0xf
    v_add_f32_dpp v129, v129, v129 row_ror:4 row_mask:0xf bank_mask:0xf
    s_nop 0
    v_add_f32_dpp v128, v128, v128 row_ror:8 row_mask:0xf bank_mask:0xf
    v_add_f32_dpp v129, v129, v129 row_ror:8 row_mask:0xf bank_mask:0xf
    ds_write_b64 v72, v[128:129] offset:0
    v_and_b32 v73, 7, v1
    v_lshlrev_b32 v73, 3, v73
    s_waitcnt lgkmcnt(0)
    s_barrier
    ds_read_b64 v[128:129], v73 offset:0
    ds_read_b64 v[130:131], v73 offset:64
    ds_read_b64 v[132:133], v73 offset:128
    ds_read_b64 v[134:135], v73 offset:192
    s_add_u32 s95, s94, 0x9e3779b9
    v_mov_b32 v137, s95
    s_mov_b32 s37, 32768
    s_waitcnt lgkmcnt(2)
    v_pk_add_f32 v[128:129], v[128:129], v[130:131]
    s_waitcnt lgkmcnt(0)
    v_pk_add_f32 v[132:133], v[132:133], v[134:135]
    v_pk_add_f32 v[128:129], v[128:129], v[132:133]
    v_cvt_pk_bf16_f32 v136, v128, v129
    v_lshlrev_b32 v128, 16, v136
    v_and_b32 v129, 0xffff0000, v136
    v_add_f32 v128, s93, v128
    v_add_f32 v129, s93, v129
    v_cvt_pk_bf16_f32 v136, v128, v129
    buffer_store_dwordx2 v[136:137], v69, s[24:27], s37 offen sc1
    s_mul_i32 s36, s3, 72
    v_add_u32 v122, s36, v1
    v_and_b32 v123, 7, v1
    s_add_u32 s36, s36, 64
    v_add_u32 v123, s36, v123
    s_movk_i32 s36, 1024
    v_and_b32 v76, 3, v122
    v_lshlrev_b32 v76, 4, v76
    v_lshrrev_b32 v122, 2, v122
    v_lshl_add_u32 v124, v122, 7, v76
    v_and_b32 v77, 1, v122
    v_lshl_add_u32 v76, v77, 3, v76
    v_lshrrev_b32 v122, 1, v122
    v_lshl_add_u32 v122, v122, 6, v76
    v_add_u32 v122, s36, v122
    v_and_b32 v76, 3, v123
    v_lshlrev_b32 v76, 4, v76
    v_lshrrev_b32 v123, 2, v123
    v_lshl_add_u32 v125, v123, 7, v76
    v_and_b32 v77, 1, v123
    v_lshl_add_u32 v76, v77, 3, v76
    v_lshrrev_b32 v123, 1, v123
    v_lshl_add_u32 v123, v123, 6, v76
    v_add_u32 v123, s36, v123
    s_mov_b64 exec, 0
    s_cmp_eq_u32 s3, 0
    s_cbranch_scc1 Ltour0_0
    s_cmp_eq_u32 s3, 1
    s_cbranch_scc1 Ltour0_1
    s_cmp_eq_u32 s3, 2
    s_cbranch_scc1 Ltour0_2
    s_branch Ltour0_3
.p2align 12
Lmain0:
    s_mov_b64 exec, -1
    s_waitcnt vmcnt(6)
    v_lshlrev_b32 v144, 16, v108
    v_and_b32 v145, 0xffff0000, v108
    v_lshlrev_b32 v146, 16, v109
    v_and_b32 v147, 0xffff0000, v109
    s_waitcnt vmcnt(5)
    v_lshlrev_b32 v148, 16, v110
    v_and_b32 v149, 0xffff0000, v110
    v_lshlrev_b32 v150, 16, v111
    v_and_b32 v151, 0xffff0000, v111
    s_waitcnt vmcnt(4)
    v_lshlrev_b32 v152, 16, v112
    v_and_b32 v153, 0xffff0000, v112
    v_lshlrev_b32 v154, 16, v113
    v_and_b32 v155, 0xffff0000, v113
    s_waitcnt vmcnt(3)
    v_lshlrev_b32 v156, 16, v114
    v_and_b32 v157, 0xffff0000, v114
    v_lshlrev_b32 v158, 16, v115
    v_and_b32 v159, 0xffff0000, v115
    s_waitcnt vmcnt(2)
    v_lshlrev_b32 v160, 16, v116
    v_and_b32 v161, 0xffff0000, v116
    v_lshlrev_b32 v162, 16, v117
    v_and_b32 v163, 0xffff0000, v117
    s_waitcnt vmcnt(1)
    v_lshlrev_b32 v164, 16, v118
    v_and_b32 v165, 0xffff0000, v118
    v_lshlrev_b32 v166, 16, v119
    v_and_b32 v167, 0xffff0000, v119
    buffer_load_dwordx4 v[88:91], v124, s[24:27], s37 offen sc1
    buffer_load_dwordx4 v[92:95], v125, s[24:27], s37 offen sc1
    buffer_load_dword v242, v71, s[16:19], s44 offen
    v_pk_add_f32 v[72:73], v[144:145], v[148:149]
    v_pk_add_f32 v[76:77], v[146:147], v[150:151]
    v_pk_add_f32 v[72:73], v[72:73], v[152:153]
    v_pk_add_f32 v[76:77], v[76:77], v[154:155]
    v_pk_add_f32 v[72:73], v[72:73], v[156:157]
    v_pk_add_f32 v[76:77], v[76:77], v[158:159]
    v_pk_add_f32 v[72:73], v[72:73], v[160:161]
    v_pk_add_f32 v[76:77], v[76:77], v[162:163]
    v_pk_add_f32 v[72:73], v[72:73], v[164:165]
    v_pk_add_f32 v[76:77], v[76:77], v[166:167]
    v_pk_add_f32 v[72:73], v[72:73], v[76:77]
    v_add_f32 v72, v72, v73
    s_nop 1
    v_add_f32_dpp v72, v72, v72 row_ror:8 row_mask:0xf bank_mask:0xf
    s_nop 1
    v_add_f32_dpp v72, v72, v72 row_ror:4 row_mask:0xf bank_mask:0xf
    s_nop 1
    v_add_f32_dpp v72, v72, v72 row_ror:2 row_mask:0xf bank_mask:0xf
    s_nop 1
    v_add_f32_dpp v72, v72, v72 row_ror:1 row_mask:0xf bank_mask:0xf
    v_mov_b32 v76, v72
    s_nop 1
    v_permlane16_swap_b32 v72, v76
    s_nop 0
    v_add_f32 v72, v72, v76
    v_mul_f32 v72, 0x3ae38e39, v72
    v_pk_add_f32 v[168:169], v[144:145], v[72:73] op_sel_hi:[1,0] neg_lo:[0,1] neg_hi:[0,1]
    v_pk_add_f32 v[170:171], v[146:147], v[72:73] op_sel_hi:[1,0] neg_lo:[0,1] neg_hi:[0,1]
    v_pk_add_f32 v[172:173], v[148:149], v[72:73] op_sel_hi:[1,0] neg_lo:[0,1] neg_hi:[0,1]
    v_pk_add_f32 v[174:175], v[150:151], v[72:73] op_sel_hi:[1,0] neg_lo:[0,1] neg_hi:[0,1]
    v_pk_add_f32 v[176:177], v[152:153], v[72:73] op_sel_hi:[1,0] neg_lo:[0,1] neg_hi:[0,1]
    v_pk_add_f32 v[178:179], v[154:155], v[72:73] op_sel_hi:[1,0] neg_lo:[0,1] neg_hi:[0,1]
    v_pk_add_f32 v[180:181], v[156:157], v[72:73] op_sel_hi:[1,0] neg_lo:[0,1] neg_hi:[0,1]
    v_pk_add_f32 v[182:183], v[158:159], v[72:73] op_sel_hi:[1,0] neg_lo:[0,1] neg_hi:[0,1]
    v_pk_add_f32 v[184:185], v[160:161], v[72:73] op_sel_hi:[1,0] neg_lo:[0,1] neg_hi:[0,1]
    v_pk_add_f32 v[186:187], v[162:163], v[72:73] op_sel_hi:[1,0] neg_lo:[0,1] neg_hi:[0,1]
    v_pk_add_f32 v[188:189], v[164:165], v[72:73] op_sel_hi:[1,0] neg_lo:[0,1] neg_hi:[0,1]
    v_pk_add_f32 v[190:191], v[166:167], v[72:73] op_sel_hi:[1,0] neg_lo:[0,1] neg_hi:[0,1]
    v_pk_mul_f32 v[74:75], v[168:169], v[168:169]
    v_pk_mul_f32 v[76:77], v[170:171], v[170:171]
    v_pk_fma_f32 v[74:75], v[172:173], v[172:173], v[74:75]
    v_pk_fma_f32 v[76:77], v[174:175], v[174:175], v[76:77]
    v_pk_fma_f32 v[74:75], v[176:177], v[176:177], v[74:75]
    v_pk_fma_f32 v[76:77], v[178:179], v[178:179], v[76:77]
    v_pk_fma_f32 v[74:75], v[180:181], v[180:181], v[74:75]
    v_pk_fma_f32 v[76:77], v[182:183], v[182:183], v[76:77]
    v_pk_fma_f32 v[74:75], v[184:185], v[184:185], v[74:75]
    v_pk_fma_f32 v[76:77], v[186:187], v[186:187], v[76:77]
    v_pk_fma_f32 v[74:75], v[188:189], v[188:189], v[74:75]
    v_pk_fma_f32 v[76:77], v[190:191], v[190:191], v[76:77]
    v_pk_add_f32 v[74:75], v[74:75], v[76:77]
    v_add_f32 v74, v74, v75
    v_cndmask_b32 v74, 0, v74, vcc
    s_nop 1
    v_add_f32_dpp v74, v74, v74 row_ror:8 row_mask:0xf bank_mask:0xf
    s_nop 1
    v_add_f32_dpp v74, v74, v74 row_ror:4 row_mask:0xf bank_mask:0xf
    s_nop 1
    v_add_f32_dpp v74, v74, v74 row_ror:2 row_mask:0xf bank_mask:0xf
    s_nop 1
    v_add_f32_dpp v74, v74, v74 row_ror:1 row_mask:0xf bank_mask:0xf
    v_mov_b32 v76, v74
    s_nop 1
    v_permlane16_swap_b32 v74, v76
    s_nop 0
    v_add_f32 v74, v74, v76
    v_mul_f32 v74, 0x3ae38e39, v74
    v_cvt_pk_bf16_f32 v76, v72, v74
    v_and_b32 v74, 0xffff0000, v76
    v_lshlrev_b32 v72, 16, v76
    v_add_f32 v74, 0x3727c5ac, v74
    v_cvt_pk_bf16_f32 v74, v74, v74
    v_and_b32 v74, 0xffff0000, v74
    v_sqrt_f32 v74, v74
    v_pk_add_f32 v[168:169], v[144:145], v[72:73] op_sel_hi:[1,0] neg_lo:[0,1] neg_hi:[0,1]
    v_pk_add_f32 v[170:171], v[146:147], v[72:73] op_sel_hi:[1,0] neg_lo:[0,1] neg_hi:[0,1]
    v_pk_add_f32 v[172:173], v[148:149], v[72:73] op_sel_hi:[1,0] neg_lo:[0,1] neg_hi:[0,1]
    v_pk_add_f32 v[174:175], v[150:151], v[72:73] op_sel_hi:[1,0] neg_lo:[0,1] neg_hi:[0,1]
    v_pk_add_f32 v[176:177], v[152:153], v[72:73] op_sel_hi:[1,0] neg_lo:[0,1] neg_hi:[0,1]
    v_pk_add_f32 v[178:179], v[154:155], v[72:73] op_sel_hi:[1,0] neg_lo:[0,1] neg_hi:[0,1]
    v_pk_add_f32 v[180:181], v[156:157], v[72:73] op_sel_hi:[1,0] neg_lo:[0,1] neg_hi:[0,1]
    v_pk_add_f32 v[182:183], v[158:159], v[72:73] op_sel_hi:[1,0] neg_lo:[0,1] neg_hi:[0,1]
    v_pk_add_f32 v[184:185], v[160:161], v[72:73] op_sel_hi:[1,0] neg_lo:[0,1] neg_hi:[0,1]
    v_pk_add_f32 v[186:187], v[162:163], v[72:73] op_sel_hi:[1,0] neg_lo:[0,1] neg_hi:[0,1]
    v_pk_add_f32 v[188:189], v[164:165], v[72:73] op_sel_hi:[1,0] neg_lo:[0,1] neg_hi:[0,1]
    v_pk_add_f32 v[190:191], v[166:167], v[72:73] op_sel_hi:[1,0] neg_lo:[0,1] neg_hi:[0,1]
    v_cvt_pk_bf16_f32 v74, v74, v74
    v_and_b32 v74, 0xffff0000, v74
    v_rcp_f32 v74, v74
    v_cvt_pk_bf16_f32 v108, v168, v169
    v_cvt_pk_bf16_f32 v109, v170, v171
    v_cvt_pk_bf16_f32 v110, v172, v173
    v_cvt_pk_bf16_f32 v111, v174, v175
    v_cvt_pk_bf16_f32 v112, v176, v177
    v_cvt_pk_bf16_f32 v113, v178, v179
    v_cvt_pk_bf16_f32 v114, v180, v181
    v_cvt_pk_bf16_f32 v115, v182, v183
    v_cvt_pk_bf16_f32 v116, v184, v185
    v_cvt_pk_bf16_f32 v117, v186, v187
    v_cvt_pk_bf16_f32 v118, v188, v189
    v_cvt_pk_bf16_f32 v119, v190, v191
    v_lshlrev_b32 v168, 16, v108
    v_and_b32 v169, 0xffff0000, v108
    v_lshlrev_b32 v170, 16, v109
    v_and_b32 v171, 0xffff0000, v109
    v_lshlrev_b32 v172, 16, v110
    v_and_b32 v173, 0xffff0000, v110
    v_lshlrev_b32 v174, 16, v111
    v_and_b32 v175, 0xffff0000, v111
    v_lshlrev_b32 v176, 16, v112
    v_and_b32 v177, 0xffff0000, v112
    v_lshlrev_b32 v178, 16, v113
    v_and_b32 v179, 0xffff0000, v113
    v_lshlrev_b32 v180, 16, v114
    v_and_b32 v181, 0xffff0000, v114
    v_lshlrev_b32 v182, 16, v115
    v_and_b32 v183, 0xffff0000, v115
    v_lshlrev_b32 v184, 16, v116
    v_and_b32 v185, 0xffff0000, v116
    v_lshlrev_b32 v186, 16, v117
    v_and_b32 v187, 0xffff0000, v117
    v_lshlrev_b32 v188, 16, v118
    v_and_b32 v189, 0xffff0000, v118
    v_lshlrev_b32 v190, 16, v119
    v_and_b32 v191, 0xffff0000, v119
    v_pk_mul_f32 v[168:169], v[168:169], v[74:75] op_sel_hi:[1,0]
    v_pk_mul_f32 v[170:171], v[170:171], v[74:75] op_sel_hi:[1,0]
    v_pk_mul_f32 v[172:173], v[172:173], v[74:75] op_sel_hi:[1,0]
    v_pk_mul_f32 v[174:175], v[174:175], v[74:75] op_sel_hi:[1,0]
    v_pk_mul_f32 v[176:177], v[176:177], v[74:75] op_sel_hi:[1,0]
    v_pk_mul_f32 v[178:179], v[178:179], v[74:75] op_sel_hi:[1,0]
    v_pk_mul_f32 v[180:181], v[180:181], v[74:75] op_sel_hi:[1,0]
    v_pk_mul_f32 v[182:183], v[182:183], v[74:75] op_sel_hi:[1,0]
    v_pk_mul_f32 v[184:185], v[184:185], v[74:75] op_sel_hi:[1,0]
    v_pk_mul_f32 v[186:187], v[186:187], v[74:75] op_sel_hi:[1,0]
    v_pk_mul_f32 v[188:189], v[188:189], v[74:75] op_sel_hi:[1,0]
    v_pk_mul_f32 v[190:191], v[190:191], v[74:75] op_sel_hi:[1,0]
    v_cvt_pk_bf16_f32 v108, v168, v169
    v_cvt_pk_bf16_f32 v109, v170, v171
    v_cvt_pk_bf16_f32 v110, v172, v173
    v_cvt_pk_bf16_f32 v111, v174, v175
    v_cvt_pk_bf16_f32 v112, v176, v177
    v_cvt_pk_bf16_f32 v113, v178, v179
    v_cvt_pk_bf16_f32 v114, v180, v181
    v_cvt_pk_bf16_f32 v115, v182, v183
    v_cvt_pk_bf16_f32 v116, v184, v185
    v_cvt_pk_bf16_f32 v117, v186, v187
    v_cvt_pk_bf16_f32 v118, v188, v189
    v_cvt_pk_bf16_f32 v119, v190, v191
    v_lshlrev_b32 v168, 16, v108
    v_and_b32 v169, 0xffff0000, v108
    v_lshlrev_b32 v170, 16, v109
    v_and_b32 v171, 0xffff0000, v109
    v_lshlrev_b32 v172, 16, v110
    v_and_b32 v173, 0xffff0000, v110
    v_lshlrev_b32 v174, 16, v111
    v_and_b32 v175, 0xffff0000, v111
    v_lshlrev_b32 v176, 16, v112
    v_and_b32 v177, 0xffff0000, v112
    v_lshlrev_b32 v178, 16, v113
    v_and_b32 v179, 0xffff0000, v113
    v_lshlrev_b32 v180, 16, v114
    v_and_b32 v181, 0xffff0000, v114
    v_lshlrev_b32 v182, 16, v115
    v_and_b32 v183, 0xffff0000, v115
    v_lshlrev_b32 v184, 16, v116
    v_and_b32 v185, 0xffff0000, v116
    v_lshlrev_b32 v186, 16, v117
    v_and_b32 v187, 0xffff0000, v117
    v_lshlrev_b32 v188, 16, v118
    v_and_b32 v189, 0xffff0000, v118
    v_lshlrev_b32 v190, 16, v119
    v_and_b32 v191, 0xffff0000, v119
    s_mov_b32 s38, 262144
    s_waitcnt vmcnt(2)
    v_xor_b32 v89, s95, v89
    v_xor_b32 v91, s95, v91
    s_waitcnt vmcnt(1)
    v_xor_b32 v93, s95, v93
    v_xor_b32 v95, s95, v95
    v_or3_b32 v89, v89, v91, v93
    v_or_b32 v89, v89, v95
    v_cmp_ne_u32 vcc, 0, v89
    s_cbranch_vccz Lhead_gotm
Lhead_pollm:
    buffer_load_dwordx4 v[88:91], v124, s[24:27], s37 offen sc1
    buffer_load_dwordx4 v[92:95], v125, s[24:27], s37 offen sc1
    s_waitcnt vmcnt(0)
    s_sub_u32 s38, s38, 1
    s_cbranch_scc1 Lhead_gotm
    v_xor_b32 v89, s95, v89
    v_xor_b32 v91, s95, v91
    v_xor_b32 v93, s95, v93
    v_xor_b32 v95, s95, v95
    v_or3_b32 v89, v89, v91, v93
    v_or_b32 v89, v89, v95
    v_cmp_ne_u32 vcc, 0, v89
    s_cbranch_vccnz Lhead_pollm
Lhead_gotm:
    ds_write2_b32 v122, v88, v90 offset0:0 offset1:1
    ds_write2_b32 v123, v92, v94 offset0:0 offset1:1
    s_waitcnt lgkmcnt(0)
    s_barrier
    ds_read_b128 v[144:147], v68 offset:2176
    ds_read_b128 v[148:151], v68 offset:2560
    ds_read_b128 v[152:155], v68 offset:2944
    ds_read_b128 v[156:159], v68 offset:1024
    ds_read_b128 v[160:163], v68 offset:1408
    ds_read_b128 v[164:167], v68 offset:1792
    s_waitcnt lgkmcnt(5)
    v_lshlrev_b32 v192, 16, v144
    v_and_b32 v193, 0xffff0000, v144
    v_lshlrev_b32 v194, 16, v145
    v_and_b32 v195, 0xffff0000, v145
    v_lshlrev_b32 v196, 16, v146
    v_and_b32 v197, 0xffff0000, v146
    v_lshlrev_b32 v198, 16, v147
    v_and_b32 v199, 0xffff0000, v147
    s_waitcnt lgkmcnt(4)
    v_lshlrev_b32 v200, 16, v148
    v_and_b32 v201, 0xffff0000, v148
    v_lshlrev_b32 v202, 16, v149
    v_and_b32 v203, 0xffff0000, v149
    v_lshlrev_b32 v204, 16, v150
    v_and_b32 v205, 0xffff0000, v150
    v_lshlrev_b32 v206, 16, v151
    v_and_b32 v207, 0xffff0000, v151
    s_waitcnt lgkmcnt(3)
    v_lshlrev_b32 v208, 16, v152
    v_and_b32 v209, 0xffff0000, v152
    v_lshlrev_b32 v210, 16, v153
    v_and_b32 v211, 0xffff0000, v153
    v_lshlrev_b32 v212, 16, v154
    v_and_b32 v213, 0xffff0000, v154
    v_lshlrev_b32 v214, 16, v155
    v_and_b32 v215, 0xffff0000, v155
    v_pk_mul_f32 v[168:169], v[168:169], v[192:193]
    v_pk_mul_f32 v[170:171], v[170:171], v[194:195]
    v_pk_mul_f32 v[172:173], v[172:173], v[196:197]
    v_pk_mul_f32 v[174:175], v[174:175], v[198:199]
    v_pk_mul_f32 v[176:177], v[176:177], v[200:201]
    v_pk_mul_f32 v[178:179], v[178:179], v[202:203]
    v_pk_mul_f32 v[180:181], v[180:181], v[204:205]
    v_pk_mul_f32 v[182:183], v[182:183], v[206:207]
    v_pk_mul_f32 v[184:185], v[184:185], v[208:209]
    v_pk_mul_f32 v[186:187], v[186:187], v[210:211]
    v_pk_mul_f32 v[188:189], v[188:189], v[212:213]
    v_pk_mul_f32 v[190:191], v[190:191], v[214:215]
    v_cvt_pk_bf16_f32 v108, v168, v169
    v_cvt_pk_bf16_f32 v109, v170, v171
    v_cvt_pk_bf16_f32 v110, v172, v173
    v_cvt_pk_bf16_f32 v111, v174, v175
    v_cvt_pk_bf16_f32 v112, v176, v177
    v_cvt_pk_bf16_f32 v113, v178, v179
    v_cvt_pk_bf16_f32 v114, v180, v181
    v_cvt_pk_bf16_f32 v115, v182, v183
    v_cvt_pk_bf16_f32 v116, v184, v185
    v_cvt_pk_bf16_f32 v117, v186, v187
    v_cvt_pk_bf16_f32 v118, v188, v189
    v_cvt_pk_bf16_f32 v119, v190, v191
    s_waitcnt lgkmcnt(2)
    v_lshlrev_b32 v216, 16, v156
    v_and_b32 v217, 0xffff0000, v156
    v_lshlrev_b32 v218, 16, v157
    v_and_b32 v219, 0xffff0000, v157
    v_lshlrev_b32 v220, 16, v158
    v_and_b32 v221, 0xffff0000, v158
    v_lshlrev_b32 v222, 16, v159
    v_and_b32 v223, 0xffff0000, v159
    s_waitcnt lgkmcnt(1)
    v_lshlrev_b32 v224, 16, v160
    v_and_b32 v225, 0xffff0000, v160
    v_lshlrev_b32 v226, 16, v161
    v_and_b32 v227, 0xffff0000, v161
    v_lshlrev_b32 v228, 16, v162
    v_and_b32 v229, 0xffff0000, v162
    v_lshlrev_b32 v230, 16, v163
    v_and_b32 v231, 0xffff0000, v163
    s_waitcnt lgkmcnt(0)
    v_lshlrev_b32 v232, 16, v164
    v_and_b32 v233, 0xffff0000, v164
    v_lshlrev_b32 v234, 16, v165
    v_and_b32 v235, 0xffff0000, v165
    v_lshlrev_b32 v236, 16, v166
    v_and_b32 v237, 0xffff0000, v166
    v_lshlrev_b32 v238, 16, v167
    v_and_b32 v239, 0xffff0000, v167
    v_lshlrev_b32 v168, 16, v108
    v_and_b32 v169, 0xffff0000, v108
    v_lshlrev_b32 v170, 16, v109
    v_and_b32 v171, 0xffff0000, v109
    v_lshlrev_b32 v172, 16, v110
    v_and_b32 v173, 0xffff0000, v110
    v_lshlrev_b32 v174, 16, v111
    v_and_b32 v175, 0xffff0000, v111
    v_lshlrev_b32 v176, 16, v112
    v_and_b32 v177, 0xffff0000, v112
    v_lshlrev_b32 v178, 16, v113
    v_and_b32 v179, 0xffff0000, v113
    v_lshlrev_b32 v180, 16, v114
    v_and_b32 v181, 0xffff0000, v114
    v_lshlrev_b32 v182, 16, v115
    v_and_b32 v183, 0xffff0000, v115
    v_lshlrev_b32 v184, 16, v116
    v_and_b32 v185, 0xffff0000, v116
    v_lshlrev_b32 v186, 16, v117
    v_and_b32 v187, 0xffff0000, v117
    v_lshlrev_b32 v188, 16, v118
    v_and_b32 v189, 0xffff0000, v118
    v_lshlrev_b32 v190, 16, v119
    v_and_b32 v191, 0xffff0000, v119
    v_pk_add_f32 v[168:169], v[168:169], v[216:217]
    v_pk_add_f32 v[170:171], v[170:171], v[218:219]
    v_pk_add_f32 v[172:173], v[172:173], v[220:221]
    v_pk_add_f32 v[174:175], v[174:175], v[222:223]
    v_cvt_pk_bf16_f32 v108, v168, v169
    v_cvt_pk_bf16_f32 v109, v170, v171
    v_cvt_pk_bf16_f32 v110, v172, v173
    v_cvt_pk_bf16_f32 v111, v174, v175
    buffer_store_dwordx4 v[108:111], v67, s[24:27], s92 offen offset:0 sc1
    v_pk_add_f32 v[176:177], v[176:177], v[224:225]
    v_pk_add_f32 v[178:179], v[178:179], v[226:227]
    v_pk_add_f32 v[180:181], v[180:181], v[228:229]
    v_pk_add_f32 v[182:183], v[182:183], v[230:231]
    v_cvt_pk_bf16_f32 v112, v176, v177
    v_cvt_pk_bf16_f32 v113, v178, v179
    v_cvt_pk_bf16_f32 v114, v180, v181
    v_cvt_pk_bf16_f32 v115, v182, v183
    buffer_store_dwordx4 v[112:115], v67, s[24:27], s92 offen offset:768 sc1
    v_pk_add_f32 v[184:185], v[184:185], v[232:233]
    v_pk_add_f32 v[186:187], v[186:187], v[234:235]
    v_pk_add_f32 v[188:189], v[188:189], v[236:237]
    v_pk_add_f32 v[190:191], v[190:191], v[238:239]
    v_cvt_pk_bf16_f32 v116, v184, v185
    v_cvt_pk_bf16_f32 v117, v186, v187
    v_cvt_pk_bf16_f32 v118, v188, v189
    v_cvt_pk_bf16_f32 v119, v190, v191
    buffer_store_dwordx4 v[116:119], v67, s[24:27], s92 offen offset:1536 sc1
    s_lshl_b32 s36, s5, 13
    s_add_u32 s36, s36, 8650752
    s_lshl_b32 s37, s4, 9
    s_add_u32 s37, s37, s36
    s_lshl_b32 s38, s3, 7
    s_add_u32 s37, s37, s38
    s_lshl_b32 s38, s3, 11
    s_add_u32 s36, s36, s38
    v_min_u32 v72, 1, v1
    v_lshlrev_b32 v72, 31, v72
    v_and_b32 v73, 15, v1
    v_lshlrev_b32 v73, 7, v73
    v_cmp_gt_u32 vcc, 162, v0
    v_mov_b32 v88, -1
    v_mov_b32 v89, -1
    v_mov_b32 v90, -1
    v_mov_b32 v91, -1
    s_mul_i32 s39, s2, 2592
    s_add_u32 s39, s39, 7864320
    v_lshl_add_u32 v74, v0, 4, s39
    s_lshl_b32 s39, s2, 7
    s_add_u32 s39, s39, 9306112
    v_mov_b32 v75, s39
    v_cndmask_b32 v74, v75, v74, vcc
    s_lshl_b32 s92, s5, 13
    s_add_u32 s92, s92, 8781824
    s_add_u32 s92, s92, s38
    s_lshl_b32 s38, s4, 7
    s_add_u32 s92, s92, s38
    s_getreg_b32 s38, hwreg(HW_REG_XCC_ID, 0, 4)
    s_lshl_b32 s38, s38, 28
    s_xor_b32 s38, s38, s95
    v_mov_b32 v76, s38
    v_mov_b32 v2, v80
    v_mov_b32 v3, v81
    v_mov_b32 v4, v82
    v_mov_b32 v5, v83
    v_mov_b32 v6, v84
    v_mov_b32 v7, v65
    v_and_b32 v126, 31, v1
    v_lshlrev_b32 v126, 2, v126
    s_waitcnt vmcnt(0)
    buffer_store_dword v137, v126, s[24:27], s37 offen sc1
    s_add_u32 s49, s44, 0
    s_add_u32 m0, s42, 32768
    s_nop 0
    buffer_load_dwordx4 v42, s[16:19], s49 offen lds
    buffer_load_dwordx4 v43, s[16:19], s49 offen offset:1024 lds
    buffer_load_dwordx4 v44, s[16:19], s49 offen offset:2048 lds
    buffer_load_dwordx4 v45, s[16:19], s49 offen offset:3072 lds
    s_add_u32 s49, s44, 256
    s_add_u32 m0, s42, 49152
    s_nop 0
    buffer_load_dwordx4 v42, s[16:19], s49 offen lds
    buffer_load_dwordx4 v43, s[16:19], s49 offen offset:1024 lds
    buffer_load_dwordx4 v44, s[16:19], s49 offen offset:2048 lds
    buffer_load_dwordx4 v45, s[16:19], s49 offen offset:3072 lds
    s_add_u32 s49, s44, 524288
    s_add_u32 m0, s42, 65536
    s_nop 0
    buffer_load_dwordx4 v42, s[16:19], s49 offen lds
    buffer_load_dwordx4 v43, s[16:19], s49 offen offset:1024 lds
    buffer_load_dwordx4 v44, s[16:19], s49 offen offset:2048 lds
    buffer_load_dwordx4 v45, s[16:19], s49 offen offset:3072 lds
    s_add_u32 s49, s44, 524544
    s_add_u32 m0, s42, 81920
    s_nop 0
    buffer_load_dwordx4 v42, s[16:19], s49 offen lds
    buffer_load_dwordx4 v43, s[16:19], s49 offen offset:1024 lds
    buffer_load_dwordx4 v44, s[16:19], s49 offen offset:2048 lds
    buffer_load_dwordx4 v45, s[16:19], s49 offen offset:3072 lds
    s_add_u32 s49, s44, 1048576
    s_add_u32 m0, s42, 98304
    s_nop 0
    buffer_load_dwordx4 v42, s[16:19], s49 offen lds
    buffer_load_dwordx4 v43, s[16:19], s49 offen offset:1024 lds
    buffer_load_dwordx4 v44, s[16:19], s49 offen offset:2048 lds
    buffer_load_dwordx4 v45, s[16:19], s49 offen offset:3072 lds
    s_add_u32 s49, s44, 1048832
    s_add_u32 m0, s42, 114688
    s_nop 0
    buffer_load_dwordx4 v42, s[16:19], s49 offen lds
    buffer_load_dwordx4 v43, s[16:19], s49 offen offset:1024 lds
    buffer_load_dwordx4 v44, s[16:19], s49 offen offset:2048 lds
    buffer_load_dwordx4 v45, s[16:19], s49 offen offset:3072 lds
    s_mov_b32 s38, 262144
Lhead_pollh:
    buffer_load_dword v75, v73, s[24:27], s36 offen sc1
    s_sub_u32 s38, s38, 1
    s_cbranch_scc1 Lhead_goth
    s_waitcnt vmcnt(0) lgkmcnt(0)
    v_cmp_ne_u32 vcc, s95, v75
    s_cbranch_vccnz Lhead_pollh
Lhead_goth:
    s_waitcnt vmcnt(0) lgkmcnt(0)
    buffer_load_dwordx4 a[0:3], v51, s[24:27], s46 offen offset:0 sc1
    buffer_load_dwordx4 a[8:11], v51, s[24:27], s46 offen offset:128 sc1
    buffer_load_dwordx4 a[4:7], v51, s[24:27], s43 offen offset:0 sc1
    buffer_load_dwordx4 a[12:15], v51, s[24:27], s43 offen offset:128 sc1
    s_barrier
    ds_read_b64_tr_b16 a[160:161], v12 offset:32768
    ds_read_b64_tr_b16 a[162:163], v12 offset:36864
    ds_read_b64_tr_b16 a[164:165], v12 offset:40960
    ds_read_b64_tr_b16 a[166:167], v12 offset:45056
    ds_read_b64_tr_b16 a[168:169], v13 offset:32768
    ds_read_b64_tr_b16 a[170:171], v13 offset:36864
    ds_read_b64_tr_b16 a[172:173], v13 offset:40960
    ds_read_b64_tr_b16 a[174:175], v13 offset:45056
    ds_read_b64_tr_b16 a[176:177], v14 offset:32768
    ds_read_b64_tr_b16 a[178:179], v14 offset:36864
    ds_read_b64_tr_b16 a[180:181], v14 offset:40960
    ds_read_b64_tr_b16 a[182:183], v14 offset:45056
    buffer_load_dwordx4 a[16:19], v51, s[24:27], s46 offen offset:256 sc1
    buffer_load_dwordx4 a[24:27], v51, s[24:27], s46 offen offset:384 sc1
    buffer_load_dwordx4 a[20:23], v51, s[24:27], s43 offen offset:256 sc1
    buffer_load_dwordx4 a[28:31], v51, s[24:27], s43 offen offset:384 sc1
    s_waitcnt lgkmcnt(10)
    s_waitcnt vmcnt(7)
    v_mfma_f32_16x16x32_bf16 v[128:131], a[160:163], a[0:3], 0
    s_waitcnt vmcnt(6)
    s_waitcnt lgkmcnt(8)
    ds_read_b64_tr_b16 a[184:185], v15 offset:32768
    v_mfma_f32_16x16x32_bf16 v[128:131], a[164:167], a[8:11], v[128:131]
    s_waitcnt vmcnt(4)
    ds_read_b64_tr_b16 a[186:187], v15 offset:36864
    v_mfma_f32_16x16x32_bf16 v[132:135], a[164:167], a[12:15], 0
    ds_read_b64_tr_b16 a[188:189], v15 offset:40960
    v_mfma_f32_16x16x32_bf16 v[132:135], a[160:163], a[4:7], v[132:135]
    s_waitcnt lgkmcnt(9)
    buffer_load_dwordx4 a[32:35], v51, s[24:27], s46 offen offset:512 sc1
    v_mfma_f32_16x16x32_bf16 v[140:143], a[168:171], a[4:7], 0
    s_waitcnt lgkmcnt(7)
    ds_read_b64_tr_b16 a[190:191], v15 offset:45056
    ds_read_b64_tr_b16 a[160:161], v16 offset:32768
    v_mfma_f32_16x16x32_bf16 v[140:143], a[172:175], a[12:15], v[140:143]
    ds_read_b64_tr_b16 a[162:163], v16 offset:36864
    v_mfma_f32_16x16x32_bf16 v[136:139], a[172:175], a[8:11], 0
    ds_read_b64_tr_b16 a[164:165], v16 offset:40960
    v_mfma_f32_16x16x32_bf16 v[136:139], a[168:171], a[0:3], v[136:139]
    s_waitcnt lgkmcnt(9)
    buffer_load_dwordx4 a[40:43], v51, s[24:27], s46 offen offset:640 sc1
    v_mfma_f32_16x16x32_bf16 v[144:147], a[176:179], a[0:3], 0
    s_waitcnt lgkmcnt(7)
    ds_read_b64_tr_b16 a[166:167], v16 offset:45056
    ds_read_b64_tr_b16 a[168:169], v17 offset:32768
    v_mfma_f32_16x16x32_bf16 v[144:147], a[180:183], a[8:11], v[144:147]
    ds_read_b64_tr_b16 a[170:171], v17 offset:36864
    v_mfma_f32_16x16x32_bf16 v[148:151], a[180:183], a[12:15], 0
    ds_read_b64_tr_b16 a[172:173], v17 offset:40960
    v_mfma_f32_16x16x32_bf16 v[148:151], a[176:179], a[4:7], v[148:151]
    s_waitcnt lgkmcnt(9)
    buffer_load_dwordx4 a[36:39], v51, s[24:27], s43 offen offset:512 sc1
    v_mfma_f32_16x16x32_bf16 v[156:159], a[184:187], a[4:7], 0
    s_waitcnt lgkmcnt(7)
    ds_read_b64_tr_b16 a[174:175], v17 offset:45056
    ds_read_b64_tr_b16 a[176:177], v18 offset:32768
    v_mfma_f32_16x16x32_bf16 v[156:159], a[188:191], a[12:15], v[156:159]
    ds_read_b64_tr_b16 a[178:179], v18 offset:36864
    v_mfma_f32_16x16x32_bf16 v[152:155], a[188:191], a[8:11], 0
    ds_read_b64_tr_b16 a[180:181], v18 offset:40960
    v_mfma_f32_16x16x32_bf16 v[152:155], a[184:187], a[0:3], v[152:155]
    s_waitcnt lgkmcnt(9)
    buffer_load_dwordx4 a[44:47], v51, s[24:27], s43 offen offset:640 sc1
    v_mfma_f32_16x16x32_bf16 v[160:163], a[160:163], a[0:3], 0
    s_waitcnt lgkmcnt(7)
    ds_read_b64_tr_b16 a[182:183], v18 offset:45056
    ds_read_b64_tr_b16 a[184:185], v19 offset:32768
    v_mfma_f32_16x16x32_bf16 v[160:163], a[164:167], a[8:11], v[160:163]
    ds_read_b64_tr_b16 a[186:187], v19 offset:36864
    v_mfma_f32_16x16x32_bf16 v[164:167], a[164:167], a[12:15], 0
    ds_read_b64_tr_b16 a[188:189], v19 offset:40960
    v_mfma_f32_16x16x32_bf16 v[164:167], a[160:163], a[4:7], v[164:167]
    s_waitcnt lgkmcnt(9)
    buffer_load_dword v77, v70, s[16:19], s44 offen
    v_mfma_f32_16x16x32_bf16 v[172:175], a[168:171], a[4:7], 0
    s_waitcnt lgkmcnt(7)
    ds_read_b64_tr_b16 a[190:191], v19 offset:45056
    ds_read_b64_tr_b16 a[160:161], v12 offset:49152
    v_mfma_f32_16x16x32_bf16 v[172:175], a[172:175], a[12:15], v[172:175]
    ds_read_b64_tr_b16 a[162:163], v12 offset:53248
    v_mfma_f32_16x16x32_bf16 v[168:171], a[172:175], a[8:11], 0
    ds_read_b64_tr_b16 a[164:165], v12 offset:57344
    v_mfma_f32_16x16x32_bf16 v[168:171], a[168:171], a[0:3], v[168:171]
    s_waitcnt lgkmcnt(9)
    ds_read_b64_tr_b16 a[166:167], v12 offset:61440
    v_mfma_f32_16x16x32_bf16 v[176:179], a[176:179], a[0:3], 0
    s_waitcnt lgkmcnt(8)
    ds_read_b64_tr_b16 a[168:169], v13 offset:49152
    v_mfma_f32_16x16x32_bf16 v[176:179], a[180:183], a[8:11], v[176:179]
    ds_read_b64_tr_b16 a[170:171], v13 offset:53248
    v_mfma_f32_16x16x32_bf16 v[180:183], a[180:183], a[12:15], 0
    ds_read_b64_tr_b16 a[172:173], v13 offset:57344
    v_mfma_f32_16x16x32_bf16 v[180:183], a[176:179], a[4:7], v[180:183]
    s_waitcnt lgkmcnt(9)
    ds_read_b64_tr_b16 a[174:175], v13 offset:61440
    v_mfma_f32_16x16x32_bf16 v[188:191], a[184:187], a[4:7], 0
    s_waitcnt lgkmcnt(8)
    ds_read_b64_tr_b16 a[176:177], v14 offset:49152
    v_mfma_f32_16x16x32_bf16 v[188:191], a[188:191], a[12:15], v[188:191]
    ds_read_b64_tr_b16 a[178:179], v14 offset:53248
    v_mfma_f32_16x16x32_bf16 v[184:187], a[188:191], a[8:11], 0
    ds_read_b64_tr_b16 a[180:181], v14 offset:57344
    v_mfma_f32_16x16x32_bf16 v[184:187], a[184:187], a[0:3], v[184:187]
    s_waitcnt lgkmcnt(9)
    ds_read_b64_tr_b16 a[182:183], v14 offset:61440
    v_mfma_f32_16x16x32_bf16 v[192:195], a[160:163], a[0:3], 0
    s_waitcnt lgkmcnt(8)
    ds_read_b64_tr_b16 a[184:185], v15 offset:49152
    v_mfma_f32_16x16x32_bf16 v[192:195], a[164:167], a[8:11], v[192:195]
    ds_read_b64_tr_b16 a[186:187], v15 offset:53248
    v_mfma_f32_16x16x32_bf16 v[196:199], a[164:167], a[12:15], 0
    ds_read_b64_tr_b16 a[188:189], v15 offset:57344
    v_mfma_f32_16x16x32_bf16 v[196:199], a[160:163], a[4:7], v[196:199]
    s_waitcnt lgkmcnt(9)
    ds_read_b64_tr_b16 a[190:191], v15 offset:61440
    v_mfma_f32_16x16x32_bf16 v[204:207], a[168:171], a[4:7], 0
    s_waitcnt lgkmcnt(8)
    ds_read_b64_tr_b16 a[160:161], v16 offset:49152
    v_mfma_f32_16x16x32_bf16 v[204:207], a[172:175], a[12:15], v[204:207]
    ds_read_b64_tr_b16 a[162:163], v16 offset:53248
    v_mfma_f32_16x16x32_bf16 v[200:203], a[172:175], a[8:11], 0
    ds_read_b64_tr_b16 a[164:165], v16 offset:57344
    v_mfma_f32_16x16x32_bf16 v[200:203], a[168:171], a[0:3], v[200:203]
    s_waitcnt lgkmcnt(9)
    ds_read_b64_tr_b16 a[166:167], v16 offset:61440
    v_mfma_f32_16x16x32_bf16 v[208:211], a[176:179], a[0:3], 0
    s_waitcnt lgkmcnt(8)
    ds_read_b64_tr_b16 a[168:169], v17 offset:49152
    v_mfma_f32_16x16x32_bf16 v[208:211], a[180:183], a[8:11], v[208:211]
    ds_read_b64_tr_b16 a[170:171], v17 offset:53248
    v_mfma_f32_16x16x32_bf16 v[212:215], a[180:183], a[12:15], 0
    ds_read_b64_tr_b16 a[172:173], v17 offset:57344
    v_mfma_f32_16x16x32_bf16 v[212:215], a[176:179], a[4:7], v[212:215]
    s_waitcnt lgkmcnt(9)
    ds_read_b64_tr_b16 a[174:175], v17 offset:61440
    v_mfma_f32_16x16x32_bf16 v[220:223], a[184:187], a[4:7], 0
    s_waitcnt lgkmcnt(8)
    ds_read_b64_tr_b16 a[176:177], v18 offset:49152
    v_mfma_f32_16x16x32_bf16 v[220:223], a[188:191], a[12:15], v[220:223]
    ds_read_b64_tr_b16 a[178:179], v18 offset:53248
    v_mfma_f32_16x16x32_bf16 v[216:219], a[188:191], a[8:11], 0
    ds_read_b64_tr_b16 a[180:181], v18 offset:57344
    v_mfma_f32_16x16x32_bf16 v[216:219], a[184:187], a[0:3], v[216:219]
    s_waitcnt lgkmcnt(9)
    ds_read_b64_tr_b16 a[182:183], v18 offset:61440
    v_mfma_f32_16x16x32_bf16 v[224:227], a[160:163], a[0:3], 0
    s_waitcnt lgkmcnt(8)
    ds_read_b64_tr_b16 a[184:185], v19 offset:49152
    v_mfma_f32_16x16x32_bf16 v[224:227], a[164:167], a[8:11], v[224:227]
Ltour0_0:
    s_cbranch_execz Ltour0_4
    ds_read_b64_tr_b16 a[186:187], v19 offset:53248
    v_mfma_f32_16x16x32_bf16 v[228:231], a[164:167], a[12:15], 0
    ds_read_b64_tr_b16 a[188:189], v19 offset:57344
    v_mfma_f32_16x16x32_bf16 v[228:231], a[160:163], a[4:7], v[228:231]
    s_waitcnt lgkmcnt(9)
    ds_read_b64_tr_b16 a[190:191], v19 offset:61440
    s_barrier
    v_mfma_f32_16x16x32_bf16 v[236:239], a[168:171], a[4:7], 0
    s_waitcnt lgkmcnt(8)
    ds_read_b64_tr_b16 a[160:161], v20 offset:0
    v_mfma_f32_16x16x32_bf16 v[236:239], a[172:175], a[12:15], v[236:239]
    s_add_u32 s49, s44, 1572864
    ds_read_b64_tr_b16 a[162:163], v20 offset:4096
    v_mfma_f32_16x16x32_bf16 v[232:235], a[172:175], a[8:11], 0
    s_add_u32 m0, s42, 131072
    ds_read_b64_tr_b16 a[164:165], v20 offset:8192
    v_mfma_f32_16x16x32_bf16 v[232:235], a[168:171], a[0:3], v[232:235]
    s_waitcnt lgkmcnt(9)
    buffer_load_dwordx4 v42, s[16:19], s49 offen lds
    v_mfma_f32_16x16x32_bf16 v[240:243], a[176:179], a[0:3], 0
    s_waitcnt lgkmcnt(7)
    ds_read_b64_tr_b16 a[166:167], v20 offset:12288
    ds_read_b64_tr_b16 a[168:169], v21 offset:0
    v_mfma_f32_16x16x32_bf16 v[240:243], a[180:183], a[8:11], v[240:243]
    ds_read_b64_tr_b16 a[170:171], v21 offset:4096
    v_mfma_f32_16x16x32_bf16 v[244:247], a[180:183], a[12:15], 0
    ds_read_b64_tr_b16 a[172:173], v21 offset:8192
    v_mfma_f32_16x16x32_bf16 v[244:247], a[176:179], a[4:7], v[244:247]
    s_waitcnt lgkmcnt(9)
    buffer_load_dwordx4 v43, s[16:19], s49 offen offset:1024 lds
    v_mfma_f32_16x16x32_bf16 v[252:255], a[184:187], a[4:7], 0
    s_waitcnt lgkmcnt(7)
    ds_read_b64_tr_b16 a[174:175], v21 offset:12288
    ds_read_b64_tr_b16 a[176:177], v22 offset:0
    v_mfma_f32_16x16x32_bf16 v[252:255], a[188:191], a[12:15], v[252:255]
    ds_read_b64_tr_b16 a[178:179], v22 offset:4096
    v_mfma_f32_16x16x32_bf16 v[248:251], a[188:191], a[8:11], 0
    ds_read_b64_tr_b16 a[180:181], v22 offset:8192
    v_mfma_f32_16x16x32_bf16 v[248:251], a[184:187], a[0:3], v[248:251]
    s_waitcnt vmcnt(10)
    s_waitcnt lgkmcnt(9)
    buffer_load_dwordx4 v44, s[16:19], s49 offen offset:2048 lds
    v_mfma_f32_16x16x32_bf16 v[128:131], a[160:163], a[16:19], v[128:131]
    s_waitcnt vmcnt(10)
    s_waitcnt lgkmcnt(7)
    ds_read_b64_tr_b16 a[182:183], v22 offset:12288
    ds_read_b64_tr_b16 a[184:185], v23 offset:0
    v_mfma_f32_16x16x32_bf16 v[128:131], a[164:167], a[24:27], v[128:131]
    s_waitcnt vmcnt(8)
    ds_read_b64_tr_b16 a[186:187], v23 offset:4096
    v_mfma_f32_16x16x32_bf16 v[132:135], a[164:167], a[28:31], v[132:135]
    ds_read_b64_tr_b16 a[188:189], v23 offset:8192
    v_mfma_f32_16x16x32_bf16 v[132:135], a[160:163], a[20:23], v[132:135]
    s_waitcnt lgkmcnt(9)
    buffer_load_dwordx4 v45, s[16:19], s49 offen offset:3072 lds
    v_mfma_f32_16x16x32_bf16 v[140:143], a[168:171], a[20:23], v[140:143]
    s_waitcnt lgkmcnt(7)
    ds_read_b64_tr_b16 a[190:191], v23 offset:12288
    ds_read_b64_tr_b16 a[160:161], v24 offset:0
    v_mfma_f32_16x16x32_bf16 v[140:143], a[172:175], a[28:31], v[140:143]
    s_add_u32 s49, s44, 1573120
    ds_read_b64_tr_b16 a[162:163], v24 offset:4096
    v_mfma_f32_16x16x32_bf16 v[136:139], a[172:175], a[24:27], v[136:139]
    s_add_u32 m0, s42, 147456
    ds_read_b64_tr_b16 a[164:165], v24 offset:8192
    v_mfma_f32_16x16x32_bf16 v[136:139], a[168:171], a[16:19], v[136:139]
    s_waitcnt lgkmcnt(9)
    buffer_load_dwordx4 v42, s[16:19], s49 offen lds
    v_mfma_f32_16x16x32_bf16 v[144:147], a[176:179], a[16:19], v[144:147]
    s_waitcnt lgkmcnt(7)
    ds_read_b64_tr_b16 a[166:167], v24 offset:12288
    ds_read_b64_tr_b16 a[168:169], v25 offset:0
    v_mfma_f32_16x16x32_bf16 v[144:147], a[180:183], a[24:27], v[144:147]
    ds_read_b64_tr_b16 a[170:171], v25 offset:4096
    v_mfma_f32_16x16x32_bf16 v[148:151], a[180:183], a[28:31], v[148:151]
    ds_read_b64_tr_b16 a[172:173], v25 offset:8192
    v_mfma_f32_16x16x32_bf16 v[148:151], a[176:179], a[20:23], v[148:151]
    s_waitcnt lgkmcnt(9)
    buffer_load_dwordx4 v43, s[16:19], s49 offen offset:1024 lds
    v_mfma_f32_16x16x32_bf16 v[156:159], a[184:187], a[20:23], v[156:159]
    s_waitcnt lgkmcnt(7)
    ds_read_b64_tr_b16 a[174:175], v25 offset:12288
    ds_read_b64_tr_b16 a[176:177], v26 offset:0
    v_mfma_f32_16x16x32_bf16 v[156:159], a[188:191], a[28:31], v[156:159]
    ds_read_b64_tr_b16 a[178:179], v26 offset:4096
    v_mfma_f32_16x16x32_bf16 v[152:155], a[188:191], a[24:27], v[152:155]
    ds_read_b64_tr_b16 a[180:181], v26 offset:8192
    v_mfma_f32_16x16x32_bf16 v[152:155], a[184:187], a[16:19], v[152:155]
    s_waitcnt lgkmcnt(9)
    buffer_load_dwordx4 v44, s[16:19], s49 offen offset:2048 lds
    v_mfma_f32_16x16x32_bf16 v[160:163], a[160:163], a[16:19], v[160:163]
    s_waitcnt lgkmcnt(7)
    ds_read_b64_tr_b16 a[182:183], v26 offset:12288
    ds_read_b64_tr_b16 a[184:185], v27 offset:0
    v_mfma_f32_16x16x32_bf16 v[160:163], a[164:167], a[24:27], v[160:163]
    ds_read_b64_tr_b16 a[186:187], v27 offset:4096
    v_mfma_f32_16x16x32_bf16 v[164:167], a[164:167], a[28:31], v[164:167]
    ds_read_b64_tr_b16 a[188:189], v27 offset:8192
    v_mfma_f32_16x16x32_bf16 v[164:167], a[160:163], a[20:23], v[164:167]
    s_waitcnt lgkmcnt(9)
    buffer_load_dwordx4 v45, s[16:19], s49 offen offset:3072 lds
    v_mfma_f32_16x16x32_bf16 v[172:175], a[168:171], a[20:23], v[172:175]
    s_waitcnt lgkmcnt(7)
    ds_read_b64_tr_b16 a[190:191], v27 offset:12288
    ds_read_b64_tr_b16 a[160:161], v20 offset:16384
    v_mfma_f32_16x16x32_bf16 v[172:175], a[172:175], a[28:31], v[172:175]
    ds_read_b64_tr_b16 a[162:163], v20 offset:20480
    v_mfma_f32_16x16x32_bf16 v[168:171], a[172:175], a[24:27], v[168:171]
    ds_read_b64_tr_b16 a[164:165], v20 offset:24576
    v_mfma_f32_16x16x32_bf16 v[168:171], a[168:171], a[16:19], v[168:171]
    s_waitcnt lgkmcnt(9)
    buffer_load_dwordx4 a[48:51], v51, s[24:27], s46 offen offset:768 sc1
    v_mfma_f32_16x16x32_bf16 v[176:179], a[176:179], a[16:19], v[176:179]
    s_waitcnt lgkmcnt(7)
    ds_read_b64_tr_b16 a[166:167], v20 offset:28672
    ds_read_b64_tr_b16 a[168:169], v21 offset:16384
    v_mfma_f32_16x16x32_bf16 v[176:179], a[180:183], a[24:27], v[176:179]
    ds_read_b64_tr_b16 a[170:171], v21 offset:20480
    v_mfma_f32_16x16x32_bf16 v[180:183], a[180:183], a[28:31], v[180:183]
    ds_read_b64_tr_b16 a[172:173], v21 offset:24576
    v_mfma_f32_16x16x32_bf16 v[180:183], a[176:179], a[20:23], v[180:183]
    s_waitcnt lgkmcnt(9)
    buffer_load_dwordx4 a[56:59], v51, s[24:27], s46 offen offset:896 sc1
    v_mfma_f32_16x16x32_bf16 v[188:191], a[184:187], a[20:23], v[188:191]
    s_waitcnt lgkmcnt(7)
    ds_read_b64_tr_b16 a[174:175], v21 offset:28672
    ds_read_b64_tr_b16 a[176:177], v22 offset:16384
    v_mfma_f32_16x16x32_bf16 v[188:191], a[188:191], a[28:31], v[188:191]
    ds_read_b64_tr_b16 a[178:179], v22 offset:20480
    v_mfma_f32_16x16x32_bf16 v[184:187], a[188:191], a[24:27], v[184:187]
    ds_read_b64_tr_b16 a[180:181], v22 offset:24576
    v_mfma_f32_16x16x32_bf16 v[184:187], a[184:187], a[16:19], v[184:187]
    s_waitcnt lgkmcnt(9)
    buffer_load_dwordx4 a[52:55], v51, s[24:27], s43 offen offset:768 sc1
    v_mfma_f32_16x16x32_bf16 v[192:195], a[160:163], a[16:19], v[192:195]
    s_waitcnt lgkmcnt(7)
    ds_read_b64_tr_b16 a[182:183], v22 offset:28672
    ds_read_b64_tr_b16 a[184:185], v23 offset:16384
    v_mfma_f32_16x16x32_bf16 v[192:195], a[164:167], a[24:27], v[192:195]
    ds_read_b64_tr_b16 a[186:187], v23 offset:20480
    v_mfma_f32_16x16x32_bf16 v[196:199], a[164:167], a[28:31], v[196:199]
    ds_read_b64_tr_b16 a[188:189], v23 offset:24576
    v_mfma_f32_16x16x32_bf16 v[196:199], a[160:163], a[20:23], v[196:199]
    s_waitcnt lgkmcnt(9)
    buffer_load_dwordx4 a[60:63], v51, s[24:27], s43 offen offset:896 sc1
    v_mfma_f32_16x16x32_bf16 v[204:207], a[168:171], a[20:23], v[204:207]
    s_waitcnt lgkmcnt(7)
    ds_read_b64_tr_b16 a[190:191], v23 offset:28672
    ds_read_b64_tr_b16 a[160:161], v24 offset:16384
    v_mfma_f32_16x16x32_bf16 v[204:207], a[172:175], a[28:31], v[204:207]
    ds_read_b64_tr_b16 a[162:163], v24 offset:20480
    v_mfma_f32_16x16x32_bf16 v[200:203], a[172:175], a[24:27], v[200:203]
    ds_read_b64_tr_b16 a[164:165], v24 offset:24576
    v_mfma_f32_16x16x32_bf16 v[200:203], a[168:171], a[16:19], v[200:203]
    s_waitcnt lgkmcnt(9)
    ds_read_b64_tr_b16 a[166:167], v24 offset:28672
    v_mfma_f32_16x16x32_bf16 v[208:211], a[176:179], a[16:19], v[208:211]
    s_waitcnt lgkmcnt(8)
    ds_read_b64_tr_b16 a[168:169], v25 offset:16384
    v_mfma_f32_16x16x32_bf16 v[208:211], a[180:183], a[24:27], v[208:211]
    ds_read_b64_tr_b16 a[170:171], v25 offset:20480
    v_mfma_f32_16x16x32_bf16 v[212:215], a[180:183], a[28:31], v[212:215]
    ds_read_b64_tr_b16 a[172:173], v25 offset:24576
    v_mfma_f32_16x16x32_bf16 v[212:215], a[176:179], a[20:23], v[212:215]
    s_waitcnt lgkmcnt(9)
    ds_read_b64_tr_b16 a[174:175], v25 offset:28672
    v_mfma_f32_16x16x32_bf16 v[220:223], a[184:187], a[20:23], v[220:223]
    s_waitcnt lgkmcnt(8)
    ds_read_b64_tr_b16 a[176:177], v26 offset:16384
    v_mfma_f32_16x16x32_bf16 v[220:223], a[188:191], a[28:31], v[220:223]
    ds_read_b64_tr_b16 a[178:179], v26 offset:20480
    v_mfma_f32_16x16x32_bf16 v[216:219], a[188:191], a[24:27], v[216:219]
    ds_read_b64_tr_b16 a[180:181], v26 offset:24576
    v_mfma_f32_16x16x32_bf16 v[216:219], a[184:187], a[16:19], v[216:219]
    s_waitcnt lgkmcnt(9)
    ds_read_b64_tr_b16 a[182:183], v26 offset:28672
    v_mfma_f32_16x16x32_bf16 v[224:227], a[160:163], a[16:19], v[224:227]
    s_waitcnt lgkmcnt(8)
    ds_read_b64_tr_b16 a[184:185], v27 offset:16384
    v_mfma_f32_16x16x32_bf16 v[224:227], a[164:167], a[24:27], v[224:227]
    ds_read_b64_tr_b16 a[186:187], v27 offset:20480
    v_mfma_f32_16x16x32_bf16 v[228:231], a[164:167], a[28:31], v[228:231]
    ds_read_b64_tr_b16 a[188:189], v27 offset:24576
    v_mfma_f32_16x16x32_bf16 v[228:231], a[160:163], a[20:23], v[228:231]
    s_waitcnt lgkmcnt(9)
    ds_read_b64_tr_b16 a[190:191], v27 offset:28672
    s_barrier
    v_mfma_f32_16x16x32_bf16 v[236:239], a[168:171], a[20:23], v[236:239]
    s_waitcnt lgkmcnt(8)
    ds_read_b64_tr_b16 a[160:161], v20 offset:32768
    v_mfma_f32_16x16x32_bf16 v[236:239], a[172:175], a[28:31], v[236:239]
    s_add_u32 s49, s44, 2097152
    ds_read_b64_tr_b16 a[162:163], v20 offset:36864
    v_mfma_f32_16x16x32_bf16 v[232:235], a[172:175], a[24:27], v[232:235]
    s_add_u32 m0, s42, 0
    ds_read_b64_tr_b16 a[164:165], v20 offset:40960
    v_mfma_f32_16x16x32_bf16 v[232:235], a[168:171], a[16:19], v[232:235]
    s_waitcnt lgkmcnt(9)
    buffer_load_dwordx4 v42, s[16:19], s49 offen lds
    v_mfma_f32_16x16x32_bf16 v[240:243], a[176:179], a[16:19], v[240:243]
    s_waitcnt lgkmcnt(7)
    ds_read_b64_tr_b16 a[166:167], v20 offset:45056
    ds_read_b64_tr_b16 a[168:169], v21 offset:32768
    v_mfma_f32_16x16x32_bf16 v[240:243], a[180:183], a[24:27], v[240:243]
    ds_read_b64_tr_b16 a[170:171], v21 offset:36864
    v_mfma_f32_16x16x32_bf16 v[244:247], a[180:183], a[28:31], v[244:247]
    ds_read_b64_tr_b16 a[172:173], v21 offset:40960
    v_mfma_f32_16x16x32_bf16 v[244:247], a[176:179], a[20:23], v[244:247]
    s_waitcnt lgkmcnt(9)
    buffer_load_dwordx4 v43, s[16:19], s49 offen offset:1024 lds
    v_mfma_f32_16x16x32_bf16 v[252:255], a[184:187], a[20:23], v[252:255]
    s_waitcnt lgkmcnt(7)
    ds_read_b64_tr_b16 a[174:175], v21 offset:45056
    ds_read_b64_tr_b16 a[176:177], v22 offset:32768
    v_mfma_f32_16x16x32_bf16 v[252:255], a[188:191], a[28:31], v[252:255]
    ds_read_b64_tr_b16 a[178:179], v22 offset:36864
    v_mfma_f32_16x16x32_bf16 v[248:251], a[188:191], a[24:27], v[248:251]
    ds_read_b64_tr_b16 a[180:181], v22 offset:40960
    v_mfma_f32_16x16x32_bf16 v[248:251], a[184:187], a[16:19], v[248:251]
    s_waitcnt vmcnt(18)
    s_waitcnt lgkmcnt(9)
    buffer_load_dwordx4 v44, s[16:19], s49 offen offset:2048 lds
    v_mfma_f32_16x16x32_bf16 v[128:131], a[160:163], a[32:35], v[128:131]
    s_waitcnt vmcnt(18)
    s_waitcnt lgkmcnt(7)
    ds_read_b64_tr_b16 a[182:183], v22 offset:45056
    ds_read_b64_tr_b16 a[184:185], v23 offset:32768
    v_mfma_f32_16x16x32_bf16 v[128:131], a[164:167], a[40:43], v[128:131]
    s_waitcnt vmcnt(16)
    ds_read_b64_tr_b16 a[186:187], v23 offset:36864
    v_mfma_f32_16x16x32_bf16 v[132:135], a[164:167], a[44:47], v[132:135]
    ds_read_b64_tr_b16 a[188:189], v23 offset:40960
    v_mfma_f32_16x16x32_bf16 v[132:135], a[160:163], a[36:39], v[132:135]
    s_waitcnt lgkmcnt(9)
    buffer_load_dwordx4 v45, s[16:19], s49 offen offset:3072 lds
    v_mfma_f32_16x16x32_bf16 v[140:143], a[168:171], a[36:39], v[140:143]
    s_waitcnt lgkmcnt(7)
    ds_read_b64_tr_b16 a[190:191], v23 offset:45056
    ds_read_b64_tr_b16 a[160:161], v24 offset:32768
    v_mfma_f32_16x16x32_bf16 v[140:143], a[172:175], a[44:47], v[140:143]
    s_add_u32 s49, s44, 2097408
    ds_read_b64_tr_b16 a[162:163], v24 offset:36864
    v_mfma_f32_16x16x32_bf16 v[136:139], a[172:175], a[40:43], v[136:139]
    s_add_u32 m0, s42, 16384
    ds_read_b64_tr_b16 a[164:165], v24 offset:40960
    v_mfma_f32_16x16x32_bf16 v[136:139], a[168:171], a[32:35], v[136:139]
    s_waitcnt lgkmcnt(9)
    buffer_load_dwordx4 v42, s[16:19], s49 offen lds
    v_mfma_f32_16x16x32_bf16 v[144:147], a[176:179], a[32:35], v[144:147]
    s_waitcnt lgkmcnt(7)
    ds_read_b64_tr_b16 a[166:167], v24 offset:45056
    ds_read_b64_tr_b16 a[168:169], v25 offset:32768
    v_mfma_f32_16x16x32_bf16 v[144:147], a[180:183], a[40:43], v[144:147]
    ds_read_b64_tr_b16 a[170:171], v25 offset:36864
    v_mfma_f32_16x16x32_bf16 v[148:151], a[180:183], a[44:47], v[148:151]
    ds_read_b64_tr_b16 a[172:173], v25 offset:40960
    v_mfma_f32_16x16x32_bf16 v[148:151], a[176:179], a[36:39], v[148:151]
    s_waitcnt lgkmcnt(9)
    buffer_load_dwordx4 v43, s[16:19], s49 offen offset:1024 lds
    v_mfma_f32_16x16x32_bf16 v[156:159], a[184:187], a[36:39], v[156:159]
    s_waitcnt lgkmcnt(7)
    ds_read_b64_tr_b16 a[174:175], v25 offset:45056
    ds_read_b64_tr_b16 a[176:177], v26 offset:32768
    v_mfma_f32_16x16x32_bf16 v[156:159], a[188:191], a[44:47], v[156:159]
    ds_read_b64_tr_b16 a[178:179], v26 offset:36864
    v_mfma_f32_16x16x32_bf16 v[152:155], a[188:191], a[40:43], v[152:155]
    ds_read_b64_tr_b16 a[180:181], v26 offset:40960
    v_mfma_f32_16x16x32_bf16 v[152:155], a[184:187], a[32:35], v[152:155]
    s_waitcnt lgkmcnt(9)
    buffer_load_dwordx4 v44, s[16:19], s49 offen offset:2048 lds
    v_mfma_f32_16x16x32_bf16 v[160:163], a[160:163], a[32:35], v[160:163]
    s_waitcnt lgkmcnt(7)
    ds_read_b64_tr_b16 a[182:183], v26 offset:45056
    ds_read_b64_tr_b16 a[184:185], v27 offset:32768
    v_mfma_f32_16x16x32_bf16 v[160:163], a[164:167], a[40:43], v[160:163]
    ds_read_b64_tr_b16 a[186:187], v27 offset:36864
    v_mfma_f32_16x16x32_bf16 v[164:167], a[164:167], a[44:47], v[164:167]
    ds_read_b64_tr_b16 a[188:189], v27 offset:40960
    v_mfma_f32_16x16x32_bf16 v[164:167], a[160:163], a[36:39], v[164:167]
    s_waitcnt lgkmcnt(9)
    buffer_load_dwordx4 v45, s[16:19], s49 offen offset:3072 lds
    v_mfma_f32_16x16x32_bf16 v[172:175], a[168:171], a[36:39], v[172:175]
    s_waitcnt lgkmcnt(7)
    ds_read_b64_tr_b16 a[190:191], v27 offset:45056
    ds_read_b64_tr_b16 a[160:161], v20 offset:49152
    v_mfma_f32_16x16x32_bf16 v[172:175], a[172:175], a[44:47], v[172:175]
    ds_read_b64_tr_b16 a[162:163], v20 offset:53248
    v_mfma_f32_16x16x32_bf16 v[168:171], a[172:175], a[40:43], v[168:171]
    ds_read_b64_tr_b16 a[164:165], v20 offset:57344
    v_mfma_f32_16x16x32_bf16 v[168:171], a[168:171], a[32:35], v[168:171]
    s_waitcnt lgkmcnt(9)
    buffer_load_dwordx4 a[64:67], v51, s[24:27], s46 offen offset:1024 sc1
    v_mfma_f32_16x16x32_bf16 v[176:179], a[176:179], a[32:35], v[176:179]
    s_waitcnt lgkmcnt(7)
    ds_read_b64_tr_b16 a[166:167], v20 offset:61440
    ds_read_b64_tr_b16 a[168:169], v21 offset:49152
    v_mfma_f32_16x16x32_bf16 v[176:179], a[180:183], a[40:43], v[176:179]
    ds_read_b64_tr_b16 a[170:171], v21 offset:53248
    v_mfma_f32_16x16x32_bf16 v[180:183], a[180:183], a[44:47], v[180:183]
    ds_read_b64_tr_b16 a[172:173], v21 offset:57344
    v_mfma_f32_16x16x32_bf16 v[180:183], a[176:179], a[36:39], v[180:183]
    s_waitcnt lgkmcnt(9)
    buffer_load_dwordx4 a[72:75], v51, s[24:27], s46 offen offset:1152 sc1
    v_mfma_f32_16x16x32_bf16 v[188:191], a[184:187], a[36:39], v[188:191]
    s_waitcnt lgkmcnt(7)
    ds_read_b64_tr_b16 a[174:175], v21 offset:61440
    ds_read_b64_tr_b16 a[176:177], v22 offset:49152
    v_mfma_f32_16x16x32_bf16 v[188:191], a[188:191], a[44:47], v[188:191]
    ds_read_b64_tr_b16 a[178:179], v22 offset:53248
    v_mfma_f32_16x16x32_bf16 v[184:187], a[188:191], a[40:43], v[184:187]
    ds_read_b64_tr_b16 a[180:181], v22 offset:57344
    v_mfma_f32_16x16x32_bf16 v[184:187], a[184:187], a[32:35], v[184:187]
    s_waitcnt lgkmcnt(9)
    buffer_load_dwordx4 a[68:71], v51, s[24:27], s43 offen offset:1024 sc1
    v_mfma_f32_16x16x32_bf16 v[192:195], a[160:163], a[32:35], v[192:195]
    s_waitcnt lgkmcnt(7)
    ds_read_b64_tr_b16 a[182:183], v22 offset:61440
    ds_read_b64_tr_b16 a[184:185], v23 offset:49152
    v_mfma_f32_16x16x32_bf16 v[192:195], a[164:167], a[40:43], v[192:195]
    ds_read_b64_tr_b16 a[186:187], v23 offset:53248
    v_mfma_f32_16x16x32_bf16 v[196:199], a[164:167], a[44:47], v[196:199]
    ds_read_b64_tr_b16 a[188:189], v23 offset:57344
    v_mfma_f32_16x16x32_bf16 v[196:199], a[160:163], a[36:39], v[196:199]
    s_waitcnt lgkmcnt(9)
    buffer_load_dwordx4 a[76:79], v51, s[24:27], s43 offen offset:1152 sc1
    v_mfma_f32_16x16x32_bf16 v[204:207], a[168:171], a[36:39], v[204:207]
    s_waitcnt lgkmcnt(7)
    ds_read_b64_tr_b16 a[190:191], v23 offset:61440
    ds_read_b64_tr_b16 a[160:161], v24 offset:49152
    v_mfma_f32_16x16x32_bf16 v[204:207], a[172:175], a[44:47], v[204:207]
    ds_read_b64_tr_b16 a[162:163], v24 offset:53248
    v_mfma_f32_16x16x32_bf16 v[200:203], a[172:175], a[40:43], v[200:203]
    ds_read_b64_tr_b16 a[164:165], v24 offset:57344
    v_mfma_f32_16x16x32_bf16 v[200:203], a[168:171], a[32:35], v[200:203]
    s_waitcnt lgkmcnt(9)
    buffer_load_dwordx4 a[80:83], v51, s[24:27], s46 offen offset:1280 sc1
    v_mfma_f32_16x16x32_bf16 v[208:211], a[176:179], a[32:35], v[208:211]
    s_waitcnt lgkmcnt(7)
    ds_read_b64_tr_b16 a[166:167], v24 offset:61440
    ds_read_b64_tr_b16 a[168:169], v25 offset:49152
    v_mfma_f32_16x16x32_bf16 v[208:211], a[180:183], a[40:43], v[208:211]
    ds_read_b64_tr_b16 a[170:171], v25 offset:53248
    v_mfma_f32_16x16x32_bf16 v[212:215], a[180:183], a[44:47], v[212:215]
    ds_read_b64_tr_b16 a[172:173], v25 offset:57344
    v_mfma_f32_16x16x32_bf16 v[212:215], a[176:179], a[36:39], v[212:215]
    s_waitcnt lgkmcnt(9)
    buffer_load_dwordx4 a[88:91], v51, s[24:27], s46 offen offset:1408 sc1
    v_mfma_f32_16x16x32_bf16 v[220:223], a[184:187], a[36:39], v[220:223]
    s_waitcnt lgkmcnt(7)
    ds_read_b64_tr_b16 a[174:175], v25 offset:61440
    ds_read_b64_tr_b16 a[176:177], v26 offset:49152
    v_mfma_f32_16x16x32_bf16 v[220:223], a[188:191], a[44:47], v[220:223]
    ds_read_b64_tr_b16 a[178:179], v26 offset:53248
    v_mfma_f32_16x16x32_bf16 v[216:219], a[188:191], a[40:43], v[216:219]
    ds_read_b64_tr_b16 a[180:181], v26 offset:57344
    v_mfma_f32_16x16x32_bf16 v[216:219], a[184:187], a[32:35], v[216:219]
    s_waitcnt lgkmcnt(9)
    ds_read_b64_tr_b16 a[182:183], v26 offset:61440
    v_mfma_f32_16x16x32_bf16 v[224:227], a[160:163], a[32:35], v[224:227]
    s_waitcnt lgkmcnt(8)
    ds_read_b64_tr_b16 a[184:185], v27 offset:49152
    v_mfma_f32_16x16x32_bf16 v[224:227], a[164:167], a[40:43], v[224:227]
    ds_read_b64_tr_b16 a[186:187], v27 offset:53248
    v_mfma_f32_16x16x32_bf16 v[228:231], a[164:167], a[44:47], v[228:231]
    ds_read_b64_tr_b16 a[188:189], v27 offset:57344
    v_mfma_f32_16x16x32_bf16 v[228:231], a[160:163], a[36:39], v[228:231]
    s_waitcnt lgkmcnt(9)
    ds_read_b64_tr_b16 a[190:191], v27 offset:61440
    s_waitcnt vmcnt(18)
    s_barrier
    v_mfma_f32_16x16x32_bf16 v[236:239], a[168:171], a[36:39], v[236:239]
    s_waitcnt lgkmcnt(8)
    ds_read_b64_tr_b16 a[160:161], v28 offset:0
    v_mfma_f32_16x16x32_bf16 v[236:239], a[172:175], a[44:47], v[236:239]
    s_add_u32 s49, s44, 2621440
    ds_read_b64_tr_b16 a[162:163], v28 offset:4096
    v_mfma_f32_16x16x32_bf16 v[232:235], a[172:175], a[40:43], v[232:235]
    s_add_u32 m0, s42, 32768
    ds_read_b64_tr_b16 a[164:165], v28 offset:8192
    v_mfma_f32_16x16x32_bf16 v[232:235], a[168:171], a[32:35], v[232:235]
    s_waitcnt lgkmcnt(9)
    buffer_load_dwordx4 v42, s[16:19], s49 offen lds
    v_mfma_f32_16x16x32_bf16 v[240:243], a[176:179], a[32:35], v[240:243]
    s_waitcnt lgkmcnt(7)
    ds_read_b64_tr_b16 a[166:167], v28 offset:12288
    ds_read_b64_tr_b16 a[168:169], v29 offset:0
    v_mfma_f32_16x16x32_bf16 v[240:243], a[180:183], a[40:43], v[240:243]
    ds_read_b64_tr_b16 a[170:171], v29 offset:4096
    v_mfma_f32_16x16x32_bf16 v[244:247], a[180:183], a[44:47], v[244:247]
    ds_read_b64_tr_b16 a[172:173], v29 offset:8192
    v_mfma_f32_16x16x32_bf16 v[244:247], a[176:179], a[36:39], v[244:247]
    s_waitcnt lgkmcnt(9)
    buffer_load_dwordx4 v43, s[16:19], s49 offen offset:1024 lds
    v_mfma_f32_16x16x32_bf16 v[252:255], a[184:187], a[36:39], v[252:255]
    s_waitcnt lgkmcnt(7)
    ds_read_b64_tr_b16 a[174:175], v29 offset:12288
    ds_read_b64_tr_b16 a[176:177], v30 offset:0
    v_mfma_f32_16x16x32_bf16 v[252:255], a[188:191], a[44:47], v[252:255]
    ds_read_b64_tr_b16 a[178:179], v30 offset:4096
    v_mfma_f32_16x16x32_bf16 v[248:251], a[188:191], a[40:43], v[248:251]
    ds_read_b64_tr_b16 a[180:181], v30 offset:8192
    v_mfma_f32_16x16x32_bf16 v[248:251], a[184:187], a[32:35], v[248:251]
    s_waitcnt vmcnt(19)
    s_waitcnt lgkmcnt(9)
    buffer_load_dwordx4 v44, s[16:19], s49 offen offset:2048 lds
    v_mfma_f32_16x16x32_bf16 v[128:131], a[160:163], a[48:51], v[128:131]
    s_waitcnt vmcnt(19)
    s_waitcnt lgkmcnt(7)
    ds_read_b64_tr_b16 a[182:183], v30 offset:12288
    ds_read_b64_tr_b16 a[184:185], v31 offset:0
    v_mfma_f32_16x16x32_bf16 v[128:131], a[164:167], a[56:59], v[128:131]
    s_waitcnt vmcnt(17)
    ds_read_b64_tr_b16 a[186:187], v31 offset:4096
    v_mfma_f32_16x16x32_bf16 v[132:135], a[164:167], a[60:63], v[132:135]
    ds_read_b64_tr_b16 a[188:189], v31 offset:8192
    v_mfma_f32_16x16x32_bf16 v[132:135], a[160:163], a[52:55], v[132:135]
    s_waitcnt lgkmcnt(9)
    buffer_load_dwordx4 v45, s[16:19], s49 offen offset:3072 lds
    v_mfma_f32_16x16x32_bf16 v[140:143], a[168:171], a[52:55], v[140:143]
    s_waitcnt lgkmcnt(7)
    ds_read_b64_tr_b16 a[190:191], v31 offset:12288
    ds_read_b64_tr_b16 a[160:161], v32 offset:0
    v_mfma_f32_16x16x32_bf16 v[140:143], a[172:175], a[60:63], v[140:143]
    s_add_u32 s49, s44, 3145728
    ds_read_b64_tr_b16 a[162:163], v32 offset:4096
    v_mfma_f32_16x16x32_bf16 v[136:139], a[172:175], a[56:59], v[136:139]
    s_add_u32 m0, s42, 49152
    ds_read_b64_tr_b16 a[164:165], v32 offset:8192
    v_mfma_f32_16x16x32_bf16 v[136:139], a[168:171], a[48:51], v[136:139]
    s_waitcnt lgkmcnt(9)
    buffer_load_dwordx4 v42, s[16:19], s49 offen lds
    v_mfma_f32_16x16x32_bf16 v[144:147], a[176:179], a[48:51], v[144:147]
    s_waitcnt lgkmcnt(7)
    ds_read_b64_tr_b16 a[166:167], v32 offset:12288
    ds_read_b64_tr_b16 a[168:169], v33 offset:0
    v_mfma_f32_16x16x32_bf16 v[144:147], a[180:183], a[56:59], v[144:147]
    ds_read_b64_tr_b16 a[170:171], v33 offset:4096
    v_mfma_f32_16x16x32_bf16 v[148:151], a[180:183], a[60:63], v[148:151]
    ds_read_b64_tr_b16 a[172:173], v33 offset:8192
    v_mfma_f32_16x16x32_bf16 v[148:151], a[176:179], a[52:55], v[148:151]
    s_waitcnt lgkmcnt(9)
    buffer_load_dwordx4 v43, s[16:19], s49 offen offset:1024 lds
    v_mfma_f32_16x16x32_bf16 v[156:159], a[184:187], a[52:55], v[156:159]
    s_waitcnt lgkmcnt(7)
    ds_read_b64_tr_b16 a[174:175], v33 offset:12288
    ds_read_b64_tr_b16 a[176:177], v34 offset:0
    v_mfma_f32_16x16x32_bf16 v[156:159], a[188:191], a[60:63], v[156:159]
    ds_read_b64_tr_b16 a[178:179], v34 offset:4096
    v_mfma_f32_16x16x32_bf16 v[152:155], a[188:191], a[56:59], v[152:155]
    ds_read_b64_tr_b16 a[180:181], v34 offset:8192
    v_mfma_f32_16x16x32_bf16 v[152:155], a[184:187], a[48:51], v[152:155]
    s_waitcnt lgkmcnt(9)
    buffer_load_dwordx4 v44, s[16:19], s49 offen offset:2048 lds
    v_mfma_f32_16x16x32_bf16 v[160:163], a[160:163], a[48:51], v[160:163]
    s_waitcnt lgkmcnt(7)
    ds_read_b64_tr_b16 a[182:183], v34 offset:12288
    ds_read_b64_tr_b16 a[184:185], v35 offset:0
    v_mfma_f32_16x16x32_bf16 v[160:163], a[164:167], a[56:59], v[160:163]
    ds_read_b64_tr_b16 a[186:187], v35 offset:4096
    v_mfma_f32_16x16x32_bf16 v[164:167], a[164:167], a[60:63], v[164:167]
    ds_read_b64_tr_b16 a[188:189], v35 offset:8192
    v_mfma_f32_16x16x32_bf16 v[164:167], a[160:163], a[52:55], v[164:167]
    s_waitcnt lgkmcnt(9)
    buffer_load_dwordx4 v45, s[16:19], s49 offen offset:3072 lds
    v_mfma_f32_16x16x32_bf16 v[172:175], a[168:171], a[52:55], v[172:175]
    s_waitcnt lgkmcnt(7)
    ds_read_b64_tr_b16 a[190:191], v35 offset:12288
    ds_read_b64_tr_b16 a[160:161], v28 offset:16384
    v_mfma_f32_16x16x32_bf16 v[172:175], a[172:175], a[60:63], v[172:175]
    ds_read_b64_tr_b16 a[162:163], v28 offset:20480
    v_mfma_f32_16x16x32_bf16 v[168:171], a[172:175], a[56:59], v[168:171]
    ds_read_b64_tr_b16 a[164:165], v28 offset:24576
    v_mfma_f32_16x16x32_bf16 v[168:171], a[168:171], a[48:51], v[168:171]
    s_waitcnt lgkmcnt(9)
    buffer_load_dwordx4 a[84:87], v51, s[24:27], s43 offen offset:1280 sc1
    v_mfma_f32_16x16x32_bf16 v[176:179], a[176:179], a[48:51], v[176:179]
    s_waitcnt lgkmcnt(7)
    ds_read_b64_tr_b16 a[166:167], v28 offset:28672
    ds_read_b64_tr_b16 a[168:169], v29 offset:16384
    v_mfma_f32_16x16x32_bf16 v[176:179], a[180:183], a[56:59], v[176:179]
    ds_read_b64_tr_b16 a[170:171], v29 offset:20480
    v_mfma_f32_16x16x32_bf16 v[180:183], a[180:183], a[60:63], v[180:183]
    ds_read_b64_tr_b16 a[172:173], v29 offset:24576
    v_mfma_f32_16x16x32_bf16 v[180:183], a[176:179], a[52:55], v[180:183]
    s_waitcnt lgkmcnt(9)
    buffer_load_dwordx4 a[92:95], v51, s[24:27], s43 offen offset:1408 sc1
    v_mfma_f32_16x16x32_bf16 v[188:191], a[184:187], a[52:55], v[188:191]
    s_waitcnt lgkmcnt(7)
    ds_read_b64_tr_b16 a[174:175], v29 offset:28672
    ds_read_b64_tr_b16 a[176:177], v30 offset:16384
    v_mfma_f32_16x16x32_bf16 v[188:191], a[188:191], a[60:63], v[188:191]
    ds_read_b64_tr_b16 a[178:179], v30 offset:20480
    v_mfma_f32_16x16x32_bf16 v[184:187], a[188:191], a[56:59], v[184:187]
    ds_read_b64_tr_b16 a[180:181], v30 offset:24576
    v_mfma_f32_16x16x32_bf16 v[184:187], a[184:187], a[48:51], v[184:187]
    s_waitcnt lgkmcnt(9)
    buffer_load_dwordx4 a[96:99], v51, s[24:27], s46 offen offset:1536 sc1
    v_mfma_f32_16x16x32_bf16 v[192:195], a[160:163], a[48:51], v[192:195]
    s_waitcnt lgkmcnt(7)
    ds_read_b64_tr_b16 a[182:183], v30 offset:28672
    ds_read_b64_tr_b16 a[184:185], v31 offset:16384
    v_mfma_f32_16x16x32_bf16 v[192:195], a[164:167], a[56:59], v[192:195]
    ds_read_b64_tr_b16 a[186:187], v31 offset:20480
    v_mfma_f32_16x16x32_bf16 v[196:199], a[164:167], a[60:63], v[196:199]
    ds_read_b64_tr_b16 a[188:189], v31 offset:24576
    v_mfma_f32_16x16x32_bf16 v[196:199], a[160:163], a[52:55], v[196:199]
    s_waitcnt lgkmcnt(9)
    buffer_load_dwordx4 a[104:107], v51, s[24:27], s46 offen offset:1664 sc1
    v_mfma_f32_16x16x32_bf16 v[204:207], a[168:171], a[52:55], v[204:207]
    s_waitcnt lgkmcnt(7)
    ds_read_b64_tr_b16 a[190:191], v31 offset:28672
    ds_read_b64_tr_b16 a[160:161], v32 offset:16384
    v_mfma_f32_16x16x32_bf16 v[204:207], a[172:175], a[60:63], v[204:207]
    ds_read_b64_tr_b16 a[162:163], v32 offset:20480
    v_mfma_f32_16x16x32_bf16 v[200:203], a[172:175], a[56:59], v[200:203]
    ds_read_b64_tr_b16 a[164:165], v32 offset:24576
    v_mfma_f32_16x16x32_bf16 v[200:203], a[168:171], a[48:51], v[200:203]
    s_waitcnt lgkmcnt(9)
    buffer_load_dwordx4 a[100:103], v51, s[24:27], s43 offen offset:1536 sc1
    v_mfma_f32_16x16x32_bf16 v[208:211], a[176:179], a[48:51], v[208:211]
    s_waitcnt lgkmcnt(7)
    ds_read_b64_tr_b16 a[166:167], v32 offset:28672
    ds_read_b64_tr_b16 a[168:169], v33 offset:16384
    v_mfma_f32_16x16x32_bf16 v[208:211], a[180:183], a[56:59], v[208:211]
    ds_read_b64_tr_b16 a[170:171], v33 offset:20480
    v_mfma_f32_16x16x32_bf16 v[212:215], a[180:183], a[60:63], v[212:215]
    ds_read_b64_tr_b16 a[172:173], v33 offset:24576
    v_mfma_f32_16x16x32_bf16 v[212:215], a[176:179], a[52:55], v[212:215]
    s_waitcnt lgkmcnt(9)
    buffer_load_dwordx4 a[108:111], v51, s[24:27], s43 offen offset:1664 sc1
    v_mfma_f32_16x16x32_bf16 v[220:223], a[184:187], a[52:55], v[220:223]
    s_waitcnt lgkmcnt(7)
    ds_read_b64_tr_b16 a[174:175], v33 offset:28672
    ds_read_b64_tr_b16 a[176:177], v34 offset:16384
    v_mfma_f32_16x16x32_bf16 v[220:223], a[188:191], a[60:63], v[220:223]
    ds_read_b64_tr_b16 a[178:179], v34 offset:20480
    v_mfma_f32_16x16x32_bf16 v[216:219], a[188:191], a[56:59], v[216:219]
    ds_read_b64_tr_b16 a[180:181], v34 offset:24576
    v_mfma_f32_16x16x32_bf16 v[216:219], a[184:187], a[48:51], v[216:219]
    s_waitcnt lgkmcnt(9)
    ds_read_b64_tr_b16 a[182:183], v34 offset:28672
    v_mfma_f32_16x16x32_bf16 v[224:227], a[160:163], a[48:51], v[224:227]
    s_waitcnt lgkmcnt(8)
    ds_read_b64_tr_b16 a[184:185], v35 offset:16384
    v_mfma_f32_16x16x32_bf16 v[224:227], a[164:167], a[56:59], v[224:227]
    ds_read_b64_tr_b16 a[186:187], v35 offset:20480
    v_mfma_f32_16x16x32_bf16 v[228:231], a[164:167], a[60:63], v[228:231]
    ds_read_b64_tr_b16 a[188:189], v35 offset:24576
    v_mfma_f32_16x16x32_bf16 v[228:231], a[160:163], a[52:55], v[228:231]
    s_waitcnt lgkmcnt(9)
    ds_read_b64_tr_b16 a[190:191], v35 offset:28672
    s_waitcnt vmcnt(20)
    s_barrier
    v_mfma_f32_16x16x32_bf16 v[236:239], a[168:171], a[52:55], v[236:239]
    s_waitcnt lgkmcnt(8)
    ds_read_b64_tr_b16 a[160:161], v12 offset:0
    v_mfma_f32_16x16x32_bf16 v[236:239], a[172:175], a[60:63], v[236:239]
    s_add_u32 s49, s44, 3670016
    ds_read_b64_tr_b16 a[162:163], v12 offset:4096
    v_mfma_f32_16x16x32_bf16 v[232:235], a[172:175], a[56:59], v[232:235]
    s_add_u32 m0, s42, 65536
    ds_read_b64_tr_b16 a[164:165], v12 offset:8192
    v_mfma_f32_16x16x32_bf16 v[232:235], a[168:171], a[48:51], v[232:235]
    s_waitcnt lgkmcnt(9)
    buffer_load_dwordx4 v42, s[16:19], s49 offen lds
    v_mfma_f32_16x16x32_bf16 v[240:243], a[176:179], a[48:51], v[240:243]
    s_waitcnt lgkmcnt(7)
    ds_read_b64_tr_b16 a[166:167], v12 offset:12288
    ds_read_b64_tr_b16 a[168:169], v13 offset:0
    v_mfma_f32_16x16x32_bf16 v[240:243], a[180:183], a[56:59], v[240:243]
Ltour0_1:
    s_cbranch_execz Ltour0_5
    ds_read_b64_tr_b16 a[170:171], v13 offset:4096
    v_mfma_f32_16x16x32_bf16 v[244:247], a[180:183], a[60:63], v[244:247]
    ds_read_b64_tr_b16 a[172:173], v13 offset:8192
    v_mfma_f32_16x16x32_bf16 v[244:247], a[176:179], a[52:55], v[244:247]
    s_waitcnt lgkmcnt(9)
    buffer_load_dwordx4 v43, s[16:19], s49 offen offset:1024 lds
    v_mfma_f32_16x16x32_bf16 v[252:255], a[184:187], a[52:55], v[252:255]
    s_waitcnt lgkmcnt(7)
    ds_read_b64_tr_b16 a[174:175], v13 offset:12288
    ds_read_b64_tr_b16 a[176:177], v14 offset:0
    v_mfma_f32_16x16x32_bf16 v[252:255], a[188:191], a[60:63], v[252:255]
    ds_read_b64_tr_b16 a[178:179], v14 offset:4096
    v_mfma_f32_16x16x32_bf16 v[248:251], a[188:191], a[56:59], v[248:251]
    ds_read_b64_tr_b16 a[180:181], v14 offset:8192
    v_mfma_f32_16x16x32_bf16 v[248:251], a[184:187], a[48:51], v[248:251]
    s_waitcnt vmcnt(21)
    s_waitcnt lgkmcnt(9)
    buffer_load_dwordx4 v44, s[16:19], s49 offen offset:2048 lds
    v_mfma_f32_16x16x32_bf16 v[128:131], a[160:163], a[64:67], v[128:131]
    s_waitcnt vmcnt(21)
    s_waitcnt lgkmcnt(7)
    ds_read_b64_tr_b16 a[182:183], v14 offset:12288
    ds_read_b64_tr_b16 a[184:185], v15 offset:0
    v_mfma_f32_16x16x32_bf16 v[128:131], a[164:167], a[72:75], v[128:131]
    s_waitcnt vmcnt(19)
    ds_read_b64_tr_b16 a[186:187], v15 offset:4096
    v_mfma_f32_16x16x32_bf16 v[132:135], a[164:167], a[76:79], v[132:135]
    ds_read_b64_tr_b16 a[188:189], v15 offset:8192
    v_mfma_f32_16x16x32_bf16 v[132:135], a[160:163], a[68:71], v[132:135]
    s_waitcnt lgkmcnt(9)
    buffer_load_dwordx4 v45, s[16:19], s49 offen offset:3072 lds
    v_mfma_f32_16x16x32_bf16 v[140:143], a[168:171], a[68:71], v[140:143]
    s_waitcnt lgkmcnt(7)
    ds_read_b64_tr_b16 a[190:191], v15 offset:12288
    ds_read_b64_tr_b16 a[160:161], v16 offset:0
    v_mfma_f32_16x16x32_bf16 v[140:143], a[172:175], a[76:79], v[140:143]
    s_add_u32 s49, s44, 4194304
    ds_read_b64_tr_b16 a[162:163], v16 offset:4096
    v_mfma_f32_16x16x32_bf16 v[136:139], a[172:175], a[72:75], v[136:139]
    s_add_u32 m0, s42, 81920
    ds_read_b64_tr_b16 a[164:165], v16 offset:8192
    v_mfma_f32_16x16x32_bf16 v[136:139], a[168:171], a[64:67], v[136:139]
    s_waitcnt lgkmcnt(9)
    buffer_load_dwordx4 v42, s[16:19], s49 offen lds
    v_mfma_f32_16x16x32_bf16 v[144:147], a[176:179], a[64:67], v[144:147]
    s_waitcnt lgkmcnt(7)
    ds_read_b64_tr_b16 a[166:167], v16 offset:12288
    ds_read_b64_tr_b16 a[168:169], v17 offset:0
    v_mfma_f32_16x16x32_bf16 v[144:147], a[180:183], a[72:75], v[144:147]
    ds_read_b64_tr_b16 a[170:171], v17 offset:4096
    v_mfma_f32_16x16x32_bf16 v[148:151], a[180:183], a[76:79], v[148:151]
    ds_read_b64_tr_b16 a[172:173], v17 offset:8192
    v_mfma_f32_16x16x32_bf16 v[148:151], a[176:179], a[68:71], v[148:151]
    s_waitcnt lgkmcnt(9)
    buffer_load_dwordx4 v43, s[16:19], s49 offen offset:1024 lds
    v_mfma_f32_16x16x32_bf16 v[156:159], a[184:187], a[68:71], v[156:159]
    s_waitcnt lgkmcnt(7)
    ds_read_b64_tr_b16 a[174:175], v17 offset:12288
    ds_read_b64_tr_b16 a[176:177], v18 offset:0
    v_mfma_f32_16x16x32_bf16 v[156:159], a[188:191], a[76:79], v[156:159]
    ds_read_b64_tr_b16 a[178:179], v18 offset:4096
    v_mfma_f32_16x16x32_bf16 v[152:155], a[188:191], a[72:75], v[152:155]
    ds_read_b64_tr_b16 a[180:181], v18 offset:8192
    v_mfma_f32_16x16x32_bf16 v[152:155], a[184:187], a[64:67], v[152:155]
    s_waitcnt lgkmcnt(9)
    buffer_load_dwordx4 v44, s[16:19], s49 offen offset:2048 lds
    v_mfma_f32_16x16x32_bf16 v[160:163], a[160:163], a[64:67], v[160:163]
    s_waitcnt lgkmcnt(7)
    ds_read_b64_tr_b16 a[182:183], v18 offset:12288
    ds_read_b64_tr_b16 a[184:185], v19 offset:0
    v_mfma_f32_16x16x32_bf16 v[160:163], a[164:167], a[72:75], v[160:163]
    ds_read_b64_tr_b16 a[186:187], v19 offset:4096
    v_mfma_f32_16x16x32_bf16 v[164:167], a[164:167], a[76:79], v[164:167]
    ds_read_b64_tr_b16 a[188:189], v19 offset:8192
    v_mfma_f32_16x16x32_bf16 v[164:167], a[160:163], a[68:71], v[164:167]
    s_waitcnt lgkmcnt(9)
    buffer_load_dwordx4 v45, s[16:19], s49 offen offset:3072 lds
    v_mfma_f32_16x16x32_bf16 v[172:175], a[168:171], a[68:71], v[172:175]
    s_waitcnt lgkmcnt(7)
    ds_read_b64_tr_b16 a[190:191], v19 offset:12288
    ds_read_b64_tr_b16 a[160:161], v12 offset:16384
    v_mfma_f32_16x16x32_bf16 v[172:175], a[172:175], a[76:79], v[172:175]
    ds_read_b64_tr_b16 a[162:163], v12 offset:20480
    v_mfma_f32_16x16x32_bf16 v[168:171], a[172:175], a[72:75], v[168:171]
    ds_read_b64_tr_b16 a[164:165], v12 offset:24576
    v_mfma_f32_16x16x32_bf16 v[168:171], a[168:171], a[64:67], v[168:171]
    s_waitcnt lgkmcnt(9)
    buffer_load_dwordx4 a[112:115], v51, s[24:27], s46 offen offset:1792 sc1
    v_mfma_f32_16x16x32_bf16 v[176:179], a[176:179], a[64:67], v[176:179]
    s_waitcnt lgkmcnt(7)
    ds_read_b64_tr_b16 a[166:167], v12 offset:28672
    ds_read_b64_tr_b16 a[168:169], v13 offset:16384
    v_mfma_f32_16x16x32_bf16 v[176:179], a[180:183], a[72:75], v[176:179]
    ds_read_b64_tr_b16 a[170:171], v13 offset:20480
    v_mfma_f32_16x16x32_bf16 v[180:183], a[180:183], a[76:79], v[180:183]
    ds_read_b64_tr_b16 a[172:173], v13 offset:24576
    v_mfma_f32_16x16x32_bf16 v[180:183], a[176:179], a[68:71], v[180:183]
    s_waitcnt lgkmcnt(9)
    buffer_load_dwordx4 a[120:123], v51, s[24:27], s46 offen offset:1920 sc1
    v_mfma_f32_16x16x32_bf16 v[188:191], a[184:187], a[68:71], v[188:191]
    s_waitcnt lgkmcnt(7)
    ds_read_b64_tr_b16 a[174:175], v13 offset:28672
    ds_read_b64_tr_b16 a[176:177], v14 offset:16384
    v_mfma_f32_16x16x32_bf16 v[188:191], a[188:191], a[76:79], v[188:191]
    ds_read_b64_tr_b16 a[178:179], v14 offset:20480
    v_mfma_f32_16x16x32_bf16 v[184:187], a[188:191], a[72:75], v[184:187]
    ds_read_b64_tr_b16 a[180:181], v14 offset:24576
    v_mfma_f32_16x16x32_bf16 v[184:187], a[184:187], a[64:67], v[184:187]
    s_waitcnt lgkmcnt(9)
    buffer_load_dwordx4 a[116:119], v51, s[24:27], s43 offen offset:1792 sc1
    v_mfma_f32_16x16x32_bf16 v[192:195], a[160:163], a[64:67], v[192:195]
    s_waitcnt lgkmcnt(7)
    ds_read_b64_tr_b16 a[182:183], v14 offset:28672
    ds_read_b64_tr_b16 a[184:185], v15 offset:16384
    v_mfma_f32_16x16x32_bf16 v[192:195], a[164:167], a[72:75], v[192:195]
    ds_read_b64_tr_b16 a[186:187], v15 offset:20480
    v_mfma_f32_16x16x32_bf16 v[196:199], a[164:167], a[76:79], v[196:199]
    ds_read_b64_tr_b16 a[188:189], v15 offset:24576
    v_mfma_f32_16x16x32_bf16 v[196:199], a[160:163], a[68:71], v[196:199]
    s_waitcnt lgkmcnt(9)
    buffer_load_dwordx4 a[124:127], v51, s[24:27], s43 offen offset:1920 sc1
    v_mfma_f32_16x16x32_bf16 v[204:207], a[168:171], a[68:71], v[204:207]
    s_waitcnt lgkmcnt(7)
    ds_read_b64_tr_b16 a[190:191], v15 offset:28672
    ds_read_b64_tr_b16 a[160:161], v16 offset:16384
    v_mfma_f32_16x16x32_bf16 v[204:207], a[172:175], a[76:79], v[204:207]
    ds_read_b64_tr_b16 a[162:163], v16 offset:20480
    v_mfma_f32_16x16x32_bf16 v[200:203], a[172:175], a[72:75], v[200:203]
    ds_read_b64_tr_b16 a[164:165], v16 offset:24576
    v_mfma_f32_16x16x32_bf16 v[200:203], a[168:171], a[64:67], v[200:203]
    s_waitcnt lgkmcnt(9)
    buffer_load_dwordx4 a[128:131], v51, s[24:27], s46 offen offset:2048 sc1
    v_mfma_f32_16x16x32_bf16 v[208:211], a[176:179], a[64:67], v[208:211]
    s_waitcnt lgkmcnt(7)
    ds_read_b64_tr_b16 a[166:167], v16 offset:28672
    ds_read_b64_tr_b16 a[168:169], v17 offset:16384
    v_mfma_f32_16x16x32_bf16 v[208:211], a[180:183], a[72:75], v[208:211]
    ds_read_b64_tr_b16 a[170:171], v17 offset:20480
    v_mfma_f32_16x16x32_bf16 v[212:215], a[180:183], a[76:79], v[212:215]
    ds_read_b64_tr_b16 a[172:173], v17 offset:24576
    v_mfma_f32_16x16x32_bf16 v[212:215], a[176:179], a[68:71], v[212:215]
    s_waitcnt lgkmcnt(9)
    buffer_load_dwordx4 a[136:139], v51, s[24:27], s46 offen offset:2176 sc1
    v_mfma_f32_16x16x32_bf16 v[220:223], a[184:187], a[68:71], v[220:223]
    s_waitcnt lgkmcnt(7)
    ds_read_b64_tr_b16 a[174:175], v17 offset:28672
    ds_read_b64_tr_b16 a[176:177], v18 offset:16384
    v_mfma_f32_16x16x32_bf16 v[220:223], a[188:191], a[76:79], v[220:223]
    ds_read_b64_tr_b16 a[178:179], v18 offset:20480
    v_mfma_f32_16x16x32_bf16 v[216:219], a[188:191], a[72:75], v[216:219]
    ds_read_b64_tr_b16 a[180:181], v18 offset:24576
    v_mfma_f32_16x16x32_bf16 v[216:219], a[184:187], a[64:67], v[216:219]
    s_waitcnt lgkmcnt(9)
    ds_read_b64_tr_b16 a[182:183], v18 offset:28672
    v_mfma_f32_16x16x32_bf16 v[224:227], a[160:163], a[64:67], v[224:227]
    s_waitcnt lgkmcnt(8)
    ds_read_b64_tr_b16 a[184:185], v19 offset:16384
    v_mfma_f32_16x16x32_bf16 v[224:227], a[164:167], a[72:75], v[224:227]
    ds_read_b64_tr_b16 a[186:187], v19 offset:20480
    v_mfma_f32_16x16x32_bf16 v[228:231], a[164:167], a[76:79], v[228:231]
    ds_read_b64_tr_b16 a[188:189], v19 offset:24576
    v_mfma_f32_16x16x32_bf16 v[228:231], a[160:163], a[68:71], v[228:231]
    s_waitcnt lgkmcnt(9)
    ds_read_b64_tr_b16 a[190:191], v19 offset:28672
    s_waitcnt vmcnt(20)
    s_barrier
    v_mfma_f32_16x16x32_bf16 v[236:239], a[168:171], a[68:71], v[236:239]
    s_waitcnt lgkmcnt(8)
    ds_read_b64_tr_b16 a[160:161], v12 offset:32768
    v_mfma_f32_16x16x32_bf16 v[236:239], a[172:175], a[76:79], v[236:239]
    s_add_u32 s49, s44, 2621696
    ds_read_b64_tr_b16 a[162:163], v12 offset:36864
    v_mfma_f32_16x16x32_bf16 v[232:235], a[172:175], a[72:75], v[232:235]
    s_add_u32 m0, s42, 98304
    ds_read_b64_tr_b16 a[164:165], v12 offset:40960
    v_mfma_f32_16x16x32_bf16 v[232:235], a[168:171], a[64:67], v[232:235]
    s_waitcnt lgkmcnt(9)
    buffer_load_dwordx4 v42, s[16:19], s49 offen lds
    v_mfma_f32_16x16x32_bf16 v[240:243], a[176:179], a[64:67], v[240:243]
    s_waitcnt lgkmcnt(7)
    ds_read_b64_tr_b16 a[166:167], v12 offset:45056
    ds_read_b64_tr_b16 a[168:169], v13 offset:32768
    v_mfma_f32_16x16x32_bf16 v[240:243], a[180:183], a[72:75], v[240:243]
    ds_read_b64_tr_b16 a[170:171], v13 offset:36864
    v_mfma_f32_16x16x32_bf16 v[244:247], a[180:183], a[76:79], v[244:247]
    ds_read_b64_tr_b16 a[172:173], v13 offset:40960
    v_mfma_f32_16x16x32_bf16 v[244:247], a[176:179], a[68:71], v[244:247]
    s_waitcnt lgkmcnt(9)
    buffer_load_dwordx4 v43, s[16:19], s49 offen offset:1024 lds
    v_mfma_f32_16x16x32_bf16 v[252:255], a[184:187], a[68:71], v[252:255]
    s_waitcnt lgkmcnt(7)
    ds_read_b64_tr_b16 a[174:175], v13 offset:45056
    ds_read_b64_tr_b16 a[176:177], v14 offset:32768
    v_mfma_f32_16x16x32_bf16 v[252:255], a[188:191], a[76:79], v[252:255]
    ds_read_b64_tr_b16 a[178:179], v14 offset:36864
    v_mfma_f32_16x16x32_bf16 v[248:251], a[188:191], a[72:75], v[248:251]
    ds_read_b64_tr_b16 a[180:181], v14 offset:40960
    v_mfma_f32_16x16x32_bf16 v[248:251], a[184:187], a[64:67], v[248:251]
    s_waitcnt lgkmcnt(9)
    buffer_load_dwordx4 v44, s[16:19], s49 offen offset:2048 lds
    v_mfma_f32_16x16x32_bf16 v[128:131], a[160:163], a[80:83], v[128:131]
    s_waitcnt lgkmcnt(7)
    ds_read_b64_tr_b16 a[182:183], v14 offset:45056
    ds_read_b64_tr_b16 a[184:185], v15 offset:32768
    v_mfma_f32_16x16x32_bf16 v[128:131], a[164:167], a[88:91], v[128:131]
    s_waitcnt vmcnt(21)
    ds_read_b64_tr_b16 a[186:187], v15 offset:36864
    v_mfma_f32_16x16x32_bf16 v[132:135], a[164:167], a[92:95], v[132:135]
    ds_read_b64_tr_b16 a[188:189], v15 offset:40960
    v_mfma_f32_16x16x32_bf16 v[132:135], a[160:163], a[84:87], v[132:135]
    s_waitcnt lgkmcnt(9)
    buffer_load_dwordx4 v45, s[16:19], s49 offen offset:3072 lds
    v_mfma_f32_16x16x32_bf16 v[140:143], a[168:171], a[84:87], v[140:143]
    s_waitcnt lgkmcnt(7)
    ds_read_b64_tr_b16 a[190:191], v15 offset:45056
    ds_read_b64_tr_b16 a[160:161], v16 offset:32768
    v_mfma_f32_16x16x32_bf16 v[140:143], a[172:175], a[92:95], v[140:143]
    s_add_u32 s49, s44, 3145984
    ds_read_b64_tr_b16 a[162:163], v16 offset:36864
    v_mfma_f32_16x16x32_bf16 v[136:139], a[172:175], a[88:91], v[136:139]
    s_add_u32 m0, s42, 114688
    ds_read_b64_tr_b16 a[164:165], v16 offset:40960
    v_mfma_f32_16x16x32_bf16 v[136:139], a[168:171], a[80:83], v[136:139]
    s_waitcnt lgkmcnt(9)
    buffer_load_dwordx4 v42, s[16:19], s49 offen lds
    v_mfma_f32_16x16x32_bf16 v[144:147], a[176:179], a[80:83], v[144:147]
    s_waitcnt lgkmcnt(7)
    ds_read_b64_tr_b16 a[166:167], v16 offset:45056
    ds_read_b64_tr_b16 a[168:169], v17 offset:32768
    v_mfma_f32_16x16x32_bf16 v[144:147], a[180:183], a[88:91], v[144:147]
    ds_read_b64_tr_b16 a[170:171], v17 offset:36864
    v_mfma_f32_16x16x32_bf16 v[148:151], a[180:183], a[92:95], v[148:151]
    ds_read_b64_tr_b16 a[172:173], v17 offset:40960
    v_mfma_f32_16x16x32_bf16 v[148:151], a[176:179], a[84:87], v[148:151]
    s_waitcnt lgkmcnt(9)
    buffer_load_dwordx4 v43, s[16:19], s49 offen offset:1024 lds
    v_mfma_f32_16x16x32_bf16 v[156:159], a[184:187], a[84:87], v[156:159]
    s_waitcnt lgkmcnt(7)
    ds_read_b64_tr_b16 a[174:175], v17 offset:45056
    ds_read_b64_tr_b16 a[176:177], v18 offset:32768
    v_mfma_f32_16x16x32_bf16 v[156:159], a[188:191], a[92:95], v[156:159]
    ds_read_b64_tr_b16 a[178:179], v18 offset:36864
    v_mfma_f32_16x16x32_bf16 v[152:155], a[188:191], a[88:91], v[152:155]
    ds_read_b64_tr_b16 a[180:181], v18 offset:40960
    v_mfma_f32_16x16x32_bf16 v[152:155], a[184:187], a[80:83], v[152:155]
    s_waitcnt lgkmcnt(9)
    buffer_load_dwordx4 v44, s[16:19], s49 offen offset:2048 lds
    v_mfma_f32_16x16x32_bf16 v[160:163], a[160:163], a[80:83], v[160:163]
    s_waitcnt lgkmcnt(7)
    ds_read_b64_tr_b16 a[182:183], v18 offset:45056
    ds_read_b64_tr_b16 a[184:185], v19 offset:32768
    v_mfma_f32_16x16x32_bf16 v[160:163], a[164:167], a[88:91], v[160:163]
    ds_read_b64_tr_b16 a[186:187], v19 offset:36864
    v_mfma_f32_16x16x32_bf16 v[164:167], a[164:167], a[92:95], v[164:167]
    ds_read_b64_tr_b16 a[188:189], v19 offset:40960
    v_mfma_f32_16x16x32_bf16 v[164:167], a[160:163], a[84:87], v[164:167]
    s_waitcnt lgkmcnt(9)
    buffer_load_dwordx4 v45, s[16:19], s49 offen offset:3072 lds
    v_mfma_f32_16x16x32_bf16 v[172:175], a[168:171], a[84:87], v[172:175]
    s_waitcnt lgkmcnt(7)
    ds_read_b64_tr_b16 a[190:191], v19 offset:45056
    ds_read_b64_tr_b16 a[160:161], v12 offset:49152
    v_mfma_f32_16x16x32_bf16 v[172:175], a[172:175], a[92:95], v[172:175]
    ds_read_b64_tr_b16 a[162:163], v12 offset:53248
    v_mfma_f32_16x16x32_bf16 v[168:171], a[172:175], a[88:91], v[168:171]
    ds_read_b64_tr_b16 a[164:165], v12 offset:57344
    v_mfma_f32_16x16x32_bf16 v[168:171], a[168:171], a[80:83], v[168:171]
    s_waitcnt lgkmcnt(9)
    buffer_load_dwordx4 a[132:135], v51, s[24:27], s43 offen offset:2048 sc1
    v_mfma_f32_16x16x32_bf16 v[176:179], a[176:179], a[80:83], v[176:179]
    s_waitcnt lgkmcnt(7)
    ds_read_b64_tr_b16 a[166:167], v12 offset:61440
    ds_read_b64_tr_b16 a[168:169], v13 offset:49152
    v_mfma_f32_16x16x32_bf16 v[176:179], a[180:183], a[88:91], v[176:179]
    ds_read_b64_tr_b16 a[170:171], v13 offset:53248
    v_mfma_f32_16x16x32_bf16 v[180:183], a[180:183], a[92:95], v[180:183]
    ds_read_b64_tr_b16 a[172:173], v13 offset:57344
    v_mfma_f32_16x16x32_bf16 v[180:183], a[176:179], a[84:87], v[180:183]
    s_waitcnt lgkmcnt(9)
    buffer_load_dwordx4 a[140:143], v51, s[24:27], s43 offen offset:2176 sc1
    v_mfma_f32_16x16x32_bf16 v[188:191], a[184:187], a[84:87], v[188:191]
    s_waitcnt lgkmcnt(7)
    ds_read_b64_tr_b16 a[174:175], v13 offset:61440
    ds_read_b64_tr_b16 a[176:177], v14 offset:49152
    v_mfma_f32_16x16x32_bf16 v[188:191], a[188:191], a[92:95], v[188:191]
    ds_read_b64_tr_b16 a[178:179], v14 offset:53248
    v_mfma_f32_16x16x32_bf16 v[184:187], a[188:191], a[88:91], v[184:187]
    ds_read_b64_tr_b16 a[180:181], v14 offset:57344
    v_mfma_f32_16x16x32_bf16 v[184:187], a[184:187], a[80:83], v[184:187]
    s_waitcnt vmcnt(27)
    s_waitcnt lgkmcnt(9)
    ds_read_b64_tr_b16 a[182:183], v14 offset:61440
    v_mfma_f32_16x16x32_bf16 v[128:131], a[160:163], a[96:99], v[128:131]
    s_waitcnt vmcnt(26)
    s_waitcnt lgkmcnt(8)
    ds_read_b64_tr_b16 a[184:185], v15 offset:49152
    v_mfma_f32_16x16x32_bf16 v[128:131], a[164:167], a[104:107], v[128:131]
    s_waitcnt vmcnt(24)
    ds_read_b64_tr_b16 a[186:187], v15 offset:53248
    v_mfma_f32_16x16x32_bf16 v[132:135], a[164:167], a[108:111], v[132:135]
    ds_read_b64_tr_b16 a[188:189], v15 offset:57344
    v_mfma_f32_16x16x32_bf16 v[132:135], a[160:163], a[100:103], v[132:135]
    s_waitcnt lgkmcnt(9)
    ds_read_b64_tr_b16 a[190:191], v15 offset:61440
    v_mfma_f32_16x16x32_bf16 v[140:143], a[168:171], a[100:103], v[140:143]
    s_waitcnt lgkmcnt(8)
    ds_read_b64_tr_b16 a[160:161], v16 offset:49152
    v_mfma_f32_16x16x32_bf16 v[140:143], a[172:175], a[108:111], v[140:143]
    ds_read_b64_tr_b16 a[162:163], v16 offset:53248
    v_mfma_f32_16x16x32_bf16 v[136:139], a[172:175], a[104:107], v[136:139]
    ds_read_b64_tr_b16 a[164:165], v16 offset:57344
    v_mfma_f32_16x16x32_bf16 v[136:139], a[168:171], a[96:99], v[136:139]
    s_waitcnt lgkmcnt(9)
    ds_read_b64_tr_b16 a[166:167], v16 offset:61440
    v_mfma_f32_16x16x32_bf16 v[144:147], a[176:179], a[96:99], v[144:147]
    s_waitcnt lgkmcnt(8)
    ds_read_b64_tr_b16 a[168:169], v17 offset:49152
    v_mfma_f32_16x16x32_bf16 v[144:147], a[180:183], a[104:107], v[144:147]
    ds_read_b64_tr_b16 a[170:171], v17 offset:53248
    v_mfma_f32_16x16x32_bf16 v[148:151], a[180:183], a[108:111], v[148:151]
    ds_read_b64_tr_b16 a[172:173], v17 offset:57344
    v_mfma_f32_16x16x32_bf16 v[148:151], a[176:179], a[100:103], v[148:151]
    s_waitcnt lgkmcnt(9)
    ds_read_b64_tr_b16 a[174:175], v17 offset:61440
    v_mfma_f32_16x16x32_bf16 v[156:159], a[184:187], a[100:103], v[156:159]
    s_waitcnt lgkmcnt(8)
    ds_read_b64_tr_b16 a[176:177], v18 offset:49152
    v_mfma_f32_16x16x32_bf16 v[156:159], a[188:191], a[108:111], v[156:159]
    ds_read_b64_tr_b16 a[178:179], v18 offset:53248
    v_mfma_f32_16x16x32_bf16 v[152:155], a[188:191], a[104:107], v[152:155]
    ds_read_b64_tr_b16 a[180:181], v18 offset:57344
    v_mfma_f32_16x16x32_bf16 v[152:155], a[184:187], a[96:99], v[152:155]
    s_waitcnt lgkmcnt(9)
    ds_read_b64_tr_b16 a[182:183], v18 offset:61440
    v_mfma_f32_16x16x32_bf16 v[160:163], a[160:163], a[96:99], v[160:163]
    s_waitcnt lgkmcnt(8)
    ds_read_b64_tr_b16 a[184:185], v19 offset:49152
    v_mfma_f32_16x16x32_bf16 v[160:163], a[164:167], a[104:107], v[160:163]
    ds_read_b64_tr_b16 a[186:187], v19 offset:53248
    v_mfma_f32_16x16x32_bf16 v[164:167], a[164:167], a[108:111], v[164:167]
    ds_read_b64_tr_b16 a[188:189], v19 offset:57344
    v_mfma_f32_16x16x32_bf16 v[164:167], a[160:163], a[100:103], v[164:167]
    s_waitcnt lgkmcnt(9)
    ds_read_b64_tr_b16 a[190:191], v19 offset:61440
    s_waitcnt vmcnt(16)
    s_barrier
    v_mfma_f32_16x16x32_bf16 v[172:175], a[168:171], a[100:103], v[172:175]
    s_waitcnt lgkmcnt(8)
    ds_read_b64_tr_b16 a[160:161], v20 offset:0
    v_mfma_f32_16x16x32_bf16 v[172:175], a[172:175], a[108:111], v[172:175]
    s_add_u32 s49, s44, 3670272
    ds_read_b64_tr_b16 a[162:163], v20 offset:4096
    v_mfma_f32_16x16x32_bf16 v[168:171], a[172:175], a[104:107], v[168:171]
    s_add_u32 m0, s42, 131072
    ds_read_b64_tr_b16 a[164:165], v20 offset:8192
    v_mfma_f32_16x16x32_bf16 v[168:171], a[168:171], a[96:99], v[168:171]
    s_waitcnt lgkmcnt(9)
    buffer_load_dwordx4 v42, s[16:19], s49 offen lds
    v_mfma_f32_16x16x32_bf16 v[176:179], a[176:179], a[96:99], v[176:179]
    s_waitcnt lgkmcnt(7)
    ds_read_b64_tr_b16 a[166:167], v20 offset:12288
    ds_read_b64_tr_b16 a[168:169], v21 offset:0
    v_mfma_f32_16x16x32_bf16 v[176:179], a[180:183], a[104:107], v[176:179]
    ds_read_b64_tr_b16 a[170:171], v21 offset:4096
    v_mfma_f32_16x16x32_bf16 v[180:183], a[180:183], a[108:111], v[180:183]
    ds_read_b64_tr_b16 a[172:173], v21 offset:8192
    v_mfma_f32_16x16x32_bf16 v[180:183], a[176:179], a[100:103], v[180:183]
    s_waitcnt lgkmcnt(9)
    buffer_load_dwordx4 v43, s[16:19], s49 offen offset:1024 lds
    v_mfma_f32_16x16x32_bf16 v[188:191], a[184:187], a[100:103], v[188:191]
    s_waitcnt lgkmcnt(7)
    ds_read_b64_tr_b16 a[174:175], v21 offset:12288
    ds_read_b64_tr_b16 a[176:177], v22 offset:0
    v_mfma_f32_16x16x32_bf16 v[188:191], a[188:191], a[108:111], v[188:191]
    ds_read_b64_tr_b16 a[178:179], v22 offset:4096
    v_mfma_f32_16x16x32_bf16 v[184:187], a[188:191], a[104:107], v[184:187]
    ds_read_b64_tr_b16 a[180:181], v22 offset:8192
    v_mfma_f32_16x16x32_bf16 v[184:187], a[184:187], a[96:99], v[184:187]
    s_waitcnt vmcnt(17)
    s_waitcnt lgkmcnt(9)
    buffer_load_dwordx4 v44, s[16:19], s49 offen offset:2048 lds
    v_mfma_f32_16x16x32_bf16 v[128:131], a[160:163], a[112:115], v[128:131]
    s_waitcnt vmcnt(17)
    s_waitcnt lgkmcnt(7)
    ds_read_b64_tr_b16 a[182:183], v22 offset:12288
    ds_read_b64_tr_b16 a[184:185], v23 offset:0
    v_mfma_f32_16x16x32_bf16 v[128:131], a[164:167], a[120:123], v[128:131]
    s_waitcnt vmcnt(15)
    ds_read_b64_tr_b16 a[186:187], v23 offset:4096
    v_mfma_f32_16x16x32_bf16 v[132:135], a[164:167], a[124:127], v[132:135]
    ds_read_b64_tr_b16 a[188:189], v23 offset:8192
    v_mfma_f32_16x16x32_bf16 v[132:135], a[160:163], a[116:119], v[132:135]
    s_waitcnt lgkmcnt(9)
    buffer_load_dwordx4 v45, s[16:19], s49 offen offset:3072 lds
    v_mfma_f32_16x16x32_bf16 v[140:143], a[168:171], a[116:119], v[140:143]
    s_waitcnt lgkmcnt(7)
    ds_read_b64_tr_b16 a[190:191], v23 offset:12288
    ds_read_b64_tr_b16 a[160:161], v24 offset:0
    v_mfma_f32_16x16x32_bf16 v[140:143], a[172:175], a[124:127], v[140:143]
    s_add_u32 s49, s44, 4194560
    ds_read_b64_tr_b16 a[162:163], v24 offset:4096
    v_mfma_f32_16x16x32_bf16 v[136:139], a[172:175], a[120:123], v[136:139]
    s_add_u32 m0, s42, 147456
    ds_read_b64_tr_b16 a[164:165], v24 offset:8192
    v_mfma_f32_16x16x32_bf16 v[136:139], a[168:171], a[112:115], v[136:139]
    s_waitcnt lgkmcnt(9)
    buffer_load_dwordx4 v42, s[16:19], s49 offen lds
    v_mfma_f32_16x16x32_bf16 v[144:147], a[176:179], a[112:115], v[144:147]
    s_waitcnt lgkmcnt(7)
    ds_read_b64_tr_b16 a[166:167], v24 offset:12288
    ds_read_b64_tr_b16 a[168:169], v25 offset:0
    v_mfma_f32_16x16x32_bf16 v[144:147], a[180:183], a[120:123], v[144:147]
    ds_read_b64_tr_b16 a[170:171], v25 offset:4096
    v_mfma_f32_16x16x32_bf16 v[148:151], a[180:183], a[124:127], v[148:151]
    ds_read_b64_tr_b16 a[172:173], v25 offset:8192
    v_mfma_f32_16x16x32_bf16 v[148:151], a[176:179], a[116:119], v[148:151]
    s_waitcnt lgkmcnt(9)
    buffer_load_dwordx4 v43, s[16:19], s49 offen offset:1024 lds
    v_mfma_f32_16x16x32_bf16 v[156:159], a[184:187], a[116:119], v[156:159]
    s_waitcnt lgkmcnt(7)
    ds_read_b64_tr_b16 a[174:175], v25 offset:12288
    ds_read_b64_tr_b16 a[176:177], v26 offset:0
    v_mfma_f32_16x16x32_bf16 v[156:159], a[188:191], a[124:127], v[156:159]
    ds_read_b64_tr_b16 a[178:179], v26 offset:4096
    v_mfma_f32_16x16x32_bf16 v[152:155], a[188:191], a[120:123], v[152:155]
    ds_read_b64_tr_b16 a[180:181], v26 offset:8192
    v_mfma_f32_16x16x32_bf16 v[152:155], a[184:187], a[112:115], v[152:155]
    s_waitcnt lgkmcnt(9)
    buffer_load_dwordx4 v44, s[16:19], s49 offen offset:2048 lds
    v_mfma_f32_16x16x32_bf16 v[160:163], a[160:163], a[112:115], v[160:163]
    s_waitcnt lgkmcnt(7)
    ds_read_b64_tr_b16 a[182:183], v26 offset:12288
    ds_read_b64_tr_b16 a[184:185], v27 offset:0
    v_mfma_f32_16x16x32_bf16 v[160:163], a[164:167], a[120:123], v[160:163]
    ds_read_b64_tr_b16 a[186:187], v27 offset:4096
    v_mfma_f32_16x16x32_bf16 v[164:167], a[164:167], a[124:127], v[164:167]
    ds_read_b64_tr_b16 a[188:189], v27 offset:8192
    v_mfma_f32_16x16x32_bf16 v[164:167], a[160:163], a[116:119], v[164:167]
    s_waitcnt lgkmcnt(9)
    buffer_load_dwordx4 v45, s[16:19], s49 offen offset:3072 lds
    v_mfma_f32_16x16x32_bf16 v[172:175], a[168:171], a[116:119], v[172:175]
    s_waitcnt lgkmcnt(7)
    ds_read_b64_tr_b16 a[190:191], v27 offset:12288
    ds_read_b64_tr_b16 a[160:161], v20 offset:16384
    v_mfma_f32_16x16x32_bf16 v[172:175], a[172:175], a[124:127], v[172:175]
    ds_read_b64_tr_b16 a[162:163], v20 offset:20480
    v_mfma_f32_16x16x32_bf16 v[168:171], a[172:175], a[120:123], v[168:171]
    ds_read_b64_tr_b16 a[164:165], v20 offset:24576
    v_mfma_f32_16x16x32_bf16 v[168:171], a[168:171], a[112:115], v[168:171]
    s_waitcnt lgkmcnt(9)
    buffer_load_dword v78, v120, s[8:11], 0 offen
    v_mfma_f32_16x16x32_bf16 v[176:179], a[176:179], a[112:115], v[176:179]
    s_waitcnt lgkmcnt(7)
    ds_read_b64_tr_b16 a[166:167], v20 offset:28672
    ds_read_b64_tr_b16 a[168:169], v21 offset:16384
    v_mfma_f32_16x16x32_bf16 v[176:179], a[180:183], a[120:123], v[176:179]
    ds_read_b64_tr_b16 a[170:171], v21 offset:20480
    v_mfma_f32_16x16x32_bf16 v[180:183], a[180:183], a[124:127], v[180:183]
    ds_read_b64_tr_b16 a[172:173], v21 offset:24576
    v_mfma_f32_16x16x32_bf16 v[180:183], a[176:179], a[116:119], v[180:183]
    s_waitcnt lgkmcnt(9)
    buffer_load_dword v79, v121, s[12:15], 0 offen
    v_mfma_f32_16x16x32_bf16 v[188:191], a[184:187], a[116:119], v[188:191]
    s_waitcnt lgkmcnt(7)
    ds_read_b64_tr_b16 a[174:175], v21 offset:28672
    ds_read_b64_tr_b16 a[176:177], v22 offset:16384
    v_mfma_f32_16x16x32_bf16 v[188:191], a[188:191], a[124:127], v[188:191]
    ds_read_b64_tr_b16 a[178:179], v22 offset:20480
    v_mfma_f32_16x16x32_bf16 v[184:187], a[188:191], a[120:123], v[184:187]
    s_mov_b32 s36, 1040356334
    ds_read_b64_tr_b16 a[180:181], v22 offset:24576
    v_mfma_f32_16x16x32_bf16 v[184:187], a[184:187], a[112:115], v[184:187]
    s_waitcnt vmcnt(21)
    s_waitcnt lgkmcnt(9)
    buffer_store_dword v76, v72, s[24:27], s92 offen offset:12 sc1
    v_mfma_f32_16x16x32_bf16 v[128:131], a[160:163], a[128:131], v[128:131]
    s_waitcnt vmcnt(21)
    s_waitcnt lgkmcnt(7)
    ds_read_b64_tr_b16 a[182:183], v22 offset:28672
    ds_read_b64_tr_b16 a[184:185], v23 offset:16384
    v_mfma_f32_16x16x32_bf16 v[128:131], a[164:167], a[136:139], v[128:131]
    s_waitcnt vmcnt(11)
    ds_read_b64_tr_b16 a[186:187], v23 offset:20480
    v_mfma_f32_16x16x32_bf16 v[132:135], a[164:167], a[140:143], v[132:135]
    ds_read_b64_tr_b16 a[188:189], v23 offset:24576
    v_mfma_f32_16x16x32_bf16 v[132:135], a[160:163], a[132:135], v[132:135]
    s_waitcnt lgkmcnt(9)
    buffer_store_dwordx4 v[88:91], v74, s[24:27], 0 offen sc1
    v_mfma_f32_16x16x32_bf16 v[140:143], a[168:171], a[132:135], v[140:143]
    s_waitcnt lgkmcnt(7)
    ds_read_b64_tr_b16 a[190:191], v23 offset:28672
    ds_read_b64_tr_b16 a[160:161], v24 offset:16384
    v_mfma_f32_16x16x32_bf16 v[140:143], a[172:175], a[140:143], v[140:143]
    ds_read_b64_tr_b16 a[162:163], v24 offset:20480
    v_mfma_f32_16x16x32_bf16 v[136:139], a[172:175], a[136:139], v[136:139]
    ds_read_b64_tr_b16 a[164:165], v24 offset:24576
    v_mfma_f32_16x16x32_bf16 v[136:139], a[168:171], a[128:131], v[136:139]
    s_waitcnt lgkmcnt(9)
    ds_read_b64_tr_b16 a[166:167], v24 offset:28672
    v_mfma_f32_16x16x32_bf16 v[144:147], a[176:179], a[128:131], v[144:147]
    s_waitcnt lgkmcnt(8)
    ds_read_b64_tr_b16 a[168:169], v25 offset:16384
    v_mfma_f32_16x16x32_bf16 v[144:147], a[180:183], a[136:139], v[144:147]
    ds_read_b64_tr_b16 a[170:171], v25 offset:20480
    v_mfma_f32_16x16x32_bf16 v[148:151], a[180:183], a[140:143], v[148:151]
    ds_read_b64_tr_b16 a[172:173], v25 offset:24576
    v_mfma_f32_16x16x32_bf16 v[148:151], a[176:179], a[132:135], v[148:151]
    s_waitcnt lgkmcnt(9)
    ds_read_b64_tr_b16 a[174:175], v25 offset:28672
    v_mul_f32 v128, s36, v128
    v_mfma_f32_16x16x32_bf16 v[156:159], a[184:187], a[132:135], v[156:159]
    s_waitcnt lgkmcnt(8)
    ds_read_b64_tr_b16 a[176:177], v26 offset:16384
    v_mul_f32 v129, s36, v129
    v_mfma_f32_16x16x32_bf16 v[156:159], a[188:191], a[140:143], v[156:159]
    ds_read_b64_tr_b16 a[178:179], v26 offset:20480
    v_mul_f32 v130, s36, v130
    v_mfma_f32_16x16x32_bf16 v[152:155], a[188:191], a[136:139], v[152:155]
    ds_read_b64_tr_b16 a[180:181], v26 offset:24576
    v_mul_f32 v131, s36, v131
    v_mfma_f32_16x16x32_bf16 v[152:155], a[184:187], a[128:131], v[152:155]
    s_waitcnt lgkmcnt(9)
    ds_read_b64_tr_b16 a[182:183], v26 offset:28672
    v_mul_f32 v136, s36, v136
    v_mfma_f32_16x16x32_bf16 v[160:163], a[160:163], a[128:131], v[160:163]
    s_waitcnt lgkmcnt(8)
    ds_read_b64_tr_b16 a[184:185], v27 offset:16384
    v_mul_f32 v137, s36, v137
    v_mfma_f32_16x16x32_bf16 v[160:163], a[164:167], a[136:139], v[160:163]
    ds_read_b64_tr_b16 a[186:187], v27 offset:20480
    v_mul_f32 v138, s36, v138
    v_mfma_f32_16x16x32_bf16 v[164:167], a[164:167], a[140:143], v[164:167]
    ds_read_b64_tr_b16 a[188:189], v27 offset:24576
    v_mul_f32 v139, s36, v139
    v_mfma_f32_16x16x32_bf16 v[164:167], a[160:163], a[132:135], v[164:167]
    s_waitcnt lgkmcnt(9)
    ds_read_b64_tr_b16 a[190:191], v27 offset:28672
    v_mul_f32 v132, s36, v132
    s_barrier
    v_mfma_f32_16x16x32_bf16 v[172:175], a[168:171], a[132:135], v[172:175]
    s_waitcnt lgkmcnt(8)
    ds_read_b64_tr_b16 a[160:161], v20 offset:32768
    v_mul_f32 v133, s36, v133
    v_mfma_f32_16x16x32_bf16 v[172:175], a[172:175], a[140:143], v[172:175]
    ds_read_b64_tr_b16 a[162:163], v20 offset:36864
    v_mul_f32 v134, s36, v134
    v_mfma_f32_16x16x32_bf16 v[168:171], a[172:175], a[136:139], v[168:171]
    s_add_u32 m0, s42, 0
    ds_read_b64_tr_b16 a[164:165], v20 offset:40960
    v_mul_f32 v135, s36, v135
    v_mfma_f32_16x16x32_bf16 v[168:171], a[168:171], a[128:131], v[168:171]
    s_waitcnt lgkmcnt(9)
    buffer_load_dwordx4 v36, s[8:11], s40 offen lds
    v_mfma_f32_16x16x32_bf16 v[176:179], a[176:179], a[128:131], v[176:179]
    s_waitcnt lgkmcnt(7)
    ds_read_b64_tr_b16 a[166:167], v20 offset:45056
    ds_read_b64_tr_b16 a[168:169], v21 offset:32768
    v_mfma_f32_16x16x32_bf16 v[176:179], a[180:183], a[136:139], v[176:179]
    ds_read_b64_tr_b16 a[170:171], v21 offset:36864
    v_mul_f32 v140, s36, v140
    v_mfma_f32_16x16x32_bf16 v[180:183], a[180:183], a[140:143], v[180:183]
    ds_read_b64_tr_b16 a[172:173], v21 offset:40960
    v_mul_f32 v141, s36, v141
    v_mfma_f32_16x16x32_bf16 v[180:183], a[176:179], a[132:135], v[180:183]
    s_waitcnt lgkmcnt(9)
    buffer_load_dwordx4 v37, s[8:11], s40 offen offset:1024 lds
    v_mfma_f32_16x16x32_bf16 v[188:191], a[184:187], a[132:135], v[188:191]
    s_waitcnt lgkmcnt(7)
    ds_read_b64_tr_b16 a[174:175], v21 offset:45056
    ds_read_b64_tr_b16 a[176:177], v22 offset:32768
    v_mfma_f32_16x16x32_bf16 v[188:191], a[188:191], a[140:143], v[188:191]
    ds_read_b64_tr_b16 a[178:179], v22 offset:36864
    v_mul_f32 v142, s36, v142
    v_mfma_f32_16x16x32_bf16 v[184:187], a[188:191], a[136:139], v[184:187]
    ds_read_b64_tr_b16 a[180:181], v22 offset:40960
    v_mul_f32 v143, s36, v143
    v_mfma_f32_16x16x32_bf16 v[184:187], a[184:187], a[128:131], v[184:187]
    s_waitcnt lgkmcnt(9)
    buffer_load_dwordx4 v38, s[8:11], s40 offen offset:2048 lds
    v_mfma_f32_16x16x32_bf16 v[192:195], a[160:163], a[80:83], v[192:195]
    s_waitcnt lgkmcnt(7)
    ds_read_b64_tr_b16 a[182:183], v22 offset:45056
    ds_read_b64_tr_b16 a[184:185], v23 offset:32768
Ltour0_2:
    s_cbranch_execz Ltour0_6
    v_mfma_f32_16x16x32_bf16 v[192:195], a[164:167], a[88:91], v[192:195]
    ds_read_b64_tr_b16 a[186:187], v23 offset:36864
    v_cvt_pk_bf16_f32 v64, v128, v129
    v_mfma_f32_16x16x32_bf16 v[196:199], a[164:167], a[92:95], v[196:199]
    ds_read_b64_tr_b16 a[188:189], v23 offset:40960
    v_cvt_pk_bf16_f32 v65, v130, v131
    v_mfma_f32_16x16x32_bf16 v[196:199], a[160:163], a[84:87], v[196:199]
    s_waitcnt lgkmcnt(9)
    buffer_load_dwordx4 v39, s[8:11], s40 offen offset:3072 lds
    v_mfma_f32_16x16x32_bf16 v[204:207], a[168:171], a[84:87], v[204:207]
    s_waitcnt lgkmcnt(7)
    s_add_u32 s40, s40, 16384
    ds_read_b64_tr_b16 a[190:191], v23 offset:45056
    ds_read_b64_tr_b16 a[160:161], v24 offset:32768
    v_mfma_f32_16x16x32_bf16 v[204:207], a[172:175], a[92:95], v[204:207]
    ds_read_b64_tr_b16 a[162:163], v24 offset:36864
    v_cvt_pk_bf16_f32 v66, v136, v137
    v_mfma_f32_16x16x32_bf16 v[200:203], a[172:175], a[88:91], v[200:203]
    s_add_u32 m0, s42, 16384
    ds_read_b64_tr_b16 a[164:165], v24 offset:40960
    v_cvt_pk_bf16_f32 v67, v138, v139
    v_mfma_f32_16x16x32_bf16 v[200:203], a[168:171], a[80:83], v[200:203]
    s_waitcnt lgkmcnt(9)
    buffer_load_dwordx4 v36, s[8:11], s40 offen lds
    v_mfma_f32_16x16x32_bf16 v[208:211], a[176:179], a[80:83], v[208:211]
    s_waitcnt lgkmcnt(7)
    ds_read_b64_tr_b16 a[166:167], v24 offset:45056
    ds_read_b64_tr_b16 a[168:169], v25 offset:32768
    v_mfma_f32_16x16x32_bf16 v[208:211], a[180:183], a[88:91], v[208:211]
    ds_read_b64_tr_b16 a[170:171], v25 offset:36864
    v_cvt_pk_bf16_f32 v80, v132, v133
    v_mfma_f32_16x16x32_bf16 v[212:215], a[180:183], a[92:95], v[212:215]
    ds_read_b64_tr_b16 a[172:173], v25 offset:40960
    v_cvt_pk_bf16_f32 v81, v134, v135
    v_mfma_f32_16x16x32_bf16 v[212:215], a[176:179], a[84:87], v[212:215]
    s_waitcnt lgkmcnt(9)
    buffer_load_dwordx4 v37, s[8:11], s40 offen offset:1024 lds
    v_mfma_f32_16x16x32_bf16 v[220:223], a[184:187], a[84:87], v[220:223]
    s_waitcnt lgkmcnt(7)
    ds_read_b64_tr_b16 a[174:175], v25 offset:45056
    ds_read_b64_tr_b16 a[176:177], v26 offset:32768
    v_mfma_f32_16x16x32_bf16 v[220:223], a[188:191], a[92:95], v[220:223]
    ds_read_b64_tr_b16 a[178:179], v26 offset:36864
    v_cvt_pk_bf16_f32 v82, v140, v141
    v_mfma_f32_16x16x32_bf16 v[216:219], a[188:191], a[88:91], v[216:219]
    ds_read_b64_tr_b16 a[180:181], v26 offset:40960
    v_cvt_pk_bf16_f32 v83, v142, v143
    v_mfma_f32_16x16x32_bf16 v[216:219], a[184:187], a[80:83], v[216:219]
    s_waitcnt lgkmcnt(9)
    buffer_load_dwordx4 v38, s[8:11], s40 offen offset:2048 lds
    v_mfma_f32_16x16x32_bf16 v[224:227], a[160:163], a[80:83], v[224:227]
    s_waitcnt lgkmcnt(7)
    ds_read_b64_tr_b16 a[182:183], v26 offset:45056
    ds_read_b64_tr_b16 a[184:185], v27 offset:32768
    v_mfma_f32_16x16x32_bf16 v[224:227], a[164:167], a[88:91], v[224:227]
    ds_read_b64_tr_b16 a[186:187], v27 offset:36864
    v_permlane32_swap_b32 v64, v66
    v_mfma_f32_16x16x32_bf16 v[228:231], a[164:167], a[92:95], v[228:231]
    ds_read_b64_tr_b16 a[188:189], v27 offset:40960
    v_permlane32_swap_b32 v65, v67
    v_mfma_f32_16x16x32_bf16 v[228:231], a[160:163], a[84:87], v[228:231]
    s_waitcnt lgkmcnt(9)
    buffer_load_dwordx4 v39, s[8:11], s40 offen offset:3072 lds
    v_mfma_f32_16x16x32_bf16 v[236:239], a[168:171], a[84:87], v[236:239]
    s_waitcnt lgkmcnt(7)
    s_add_u32 s40, s40, 16384
    ds_read_b64_tr_b16 a[190:191], v27 offset:45056
    ds_read_b64_tr_b16 a[160:161], v20 offset:49152
    v_mfma_f32_16x16x32_bf16 v[236:239], a[172:175], a[92:95], v[236:239]
    ds_read_b64_tr_b16 a[162:163], v20 offset:53248
    v_permlane32_swap_b32 v80, v82
    v_mfma_f32_16x16x32_bf16 v[232:235], a[172:175], a[88:91], v[232:235]
    ds_read_b64_tr_b16 a[164:165], v20 offset:57344
    v_permlane32_swap_b32 v81, v83
    v_mfma_f32_16x16x32_bf16 v[232:235], a[168:171], a[80:83], v[232:235]
    s_waitcnt lgkmcnt(9)
    ds_read_b64_tr_b16 a[166:167], v20 offset:61440
    v_permlane16_swap_b32 v64, v66
    v_mfma_f32_16x16x32_bf16 v[240:243], a[176:179], a[80:83], v[240:243]
    s_waitcnt lgkmcnt(8)
    ds_read_b64_tr_b16 a[168:169], v21 offset:49152
    v_permlane16_swap_b32 v65, v67
    v_mfma_f32_16x16x32_bf16 v[240:243], a[180:183], a[88:91], v[240:243]
    ds_read_b64_tr_b16 a[170:171], v21 offset:53248
    v_permlane16_swap_b32 v80, v82
    v_mfma_f32_16x16x32_bf16 v[244:247], a[180:183], a[92:95], v[244:247]
    ds_read_b64_tr_b16 a[172:173], v21 offset:57344
    v_permlane16_swap_b32 v81, v83
    v_mfma_f32_16x16x32_bf16 v[244:247], a[176:179], a[84:87], v[244:247]
    s_waitcnt lgkmcnt(9)
    ds_read_b64_tr_b16 a[174:175], v21 offset:61440
    v_mul_f32 v144, s36, v144
    v_mfma_f32_16x16x32_bf16 v[252:255], a[184:187], a[84:87], v[252:255]
    s_waitcnt lgkmcnt(8)
    ds_read_b64_tr_b16 a[176:177], v22 offset:49152
    v_mul_f32 v145, s36, v145
    v_mfma_f32_16x16x32_bf16 v[252:255], a[188:191], a[92:95], v[252:255]
    ds_read_b64_tr_b16 a[178:179], v22 offset:53248
    v_mul_f32 v146, s36, v146
    v_mfma_f32_16x16x32_bf16 v[248:251], a[188:191], a[88:91], v[248:251]
    ds_read_b64_tr_b16 a[180:181], v22 offset:57344
    v_mul_f32 v147, s36, v147
    v_mfma_f32_16x16x32_bf16 v[248:251], a[184:187], a[80:83], v[248:251]
    s_waitcnt lgkmcnt(9)
    ds_read_b64_tr_b16 a[182:183], v22 offset:61440
    v_mul_f32 v152, s36, v152
    v_mfma_f32_16x16x32_bf16 v[192:195], a[160:163], a[96:99], v[192:195]
    s_waitcnt lgkmcnt(8)
    ds_read_b64_tr_b16 a[184:185], v23 offset:49152
    v_mul_f32 v153, s36, v153
    v_mfma_f32_16x16x32_bf16 v[192:195], a[164:167], a[104:107], v[192:195]
    ds_read_b64_tr_b16 a[186:187], v23 offset:53248
    v_mul_f32 v154, s36, v154
    v_mfma_f32_16x16x32_bf16 v[196:199], a[164:167], a[108:111], v[196:199]
    ds_read_b64_tr_b16 a[188:189], v23 offset:57344
    v_mul_f32 v155, s36, v155
    v_mfma_f32_16x16x32_bf16 v[196:199], a[160:163], a[100:103], v[196:199]
    s_waitcnt lgkmcnt(9)
    ds_read_b64_tr_b16 a[190:191], v23 offset:61440
    v_mul_f32 v148, s36, v148
    v_mfma_f32_16x16x32_bf16 v[204:207], a[168:171], a[100:103], v[204:207]
    s_waitcnt lgkmcnt(8)
    ds_read_b64_tr_b16 a[160:161], v24 offset:49152
    v_mul_f32 v149, s36, v149
    v_mfma_f32_16x16x32_bf16 v[204:207], a[172:175], a[108:111], v[204:207]
    ds_read_b64_tr_b16 a[162:163], v24 offset:53248
    v_mul_f32 v150, s36, v150
    v_mfma_f32_16x16x32_bf16 v[200:203], a[172:175], a[104:107], v[200:203]
    ds_read_b64_tr_b16 a[164:165], v24 offset:57344
    v_mul_f32 v151, s36, v151
    v_mfma_f32_16x16x32_bf16 v[200:203], a[168:171], a[96:99], v[200:203]
    s_waitcnt lgkmcnt(9)
    ds_read_b64_tr_b16 a[166:167], v24 offset:61440
    v_mul_f32 v156, s36, v156
    v_mfma_f32_16x16x32_bf16 v[208:211], a[176:179], a[96:99], v[208:211]
    s_waitcnt lgkmcnt(8)
    ds_read_b64_tr_b16 a[168:169], v25 offset:49152
    v_mul_f32 v157, s36, v157
    v_mfma_f32_16x16x32_bf16 v[208:211], a[180:183], a[104:107], v[208:211]
    ds_read_b64_tr_b16 a[170:171], v25 offset:53248
    v_mul_f32 v158, s36, v158
    v_mfma_f32_16x16x32_bf16 v[212:215], a[180:183], a[108:111], v[212:215]
    ds_read_b64_tr_b16 a[172:173], v25 offset:57344
    v_mul_f32 v159, s36, v159
    v_mfma_f32_16x16x32_bf16 v[212:215], a[176:179], a[100:103], v[212:215]
    s_waitcnt lgkmcnt(9)
    ds_read_b64_tr_b16 a[174:175], v25 offset:61440
    v_cvt_pk_bf16_f32 v68, v144, v145
    v_mfma_f32_16x16x32_bf16 v[220:223], a[184:187], a[100:103], v[220:223]
    s_waitcnt lgkmcnt(8)
    ds_read_b64_tr_b16 a[176:177], v26 offset:49152
    v_cvt_pk_bf16_f32 v69, v146, v147
    v_mfma_f32_16x16x32_bf16 v[220:223], a[188:191], a[108:111], v[220:223]
    ds_read_b64_tr_b16 a[178:179], v26 offset:53248
    v_cvt_pk_bf16_f32 v70, v152, v153
    v_mfma_f32_16x16x32_bf16 v[216:219], a[188:191], a[104:107], v[216:219]
    ds_read_b64_tr_b16 a[180:181], v26 offset:57344
    v_cvt_pk_bf16_f32 v71, v154, v155
    v_mfma_f32_16x16x32_bf16 v[216:219], a[184:187], a[96:99], v[216:219]
    s_waitcnt lgkmcnt(9)
    ds_read_b64_tr_b16 a[182:183], v26 offset:61440
    v_cvt_pk_bf16_f32 v84, v148, v149
    v_mfma_f32_16x16x32_bf16 v[224:227], a[160:163], a[96:99], v[224:227]
    s_waitcnt lgkmcnt(8)
    ds_read_b64_tr_b16 a[184:185], v27 offset:49152
    v_cvt_pk_bf16_f32 v85, v150, v151
    v_mfma_f32_16x16x32_bf16 v[224:227], a[164:167], a[104:107], v[224:227]
    ds_read_b64_tr_b16 a[186:187], v27 offset:53248
    v_cvt_pk_bf16_f32 v86, v156, v157
    v_mfma_f32_16x16x32_bf16 v[228:231], a[164:167], a[108:111], v[228:231]
    ds_read_b64_tr_b16 a[188:189], v27 offset:57344
    v_cvt_pk_bf16_f32 v87, v158, v159
    v_mfma_f32_16x16x32_bf16 v[228:231], a[160:163], a[100:103], v[228:231]
    s_waitcnt lgkmcnt(9)
    ds_read_b64_tr_b16 a[190:191], v27 offset:61440
    v_permlane32_swap_b32 v68, v70
    s_waitcnt vmcnt(12)
    s_barrier
    v_mfma_f32_16x16x32_bf16 v[236:239], a[168:171], a[100:103], v[236:239]
    s_waitcnt lgkmcnt(8)
    ds_read_b64_tr_b16 a[160:161], v28 offset:0
    v_permlane32_swap_b32 v69, v71
    v_mfma_f32_16x16x32_bf16 v[236:239], a[172:175], a[108:111], v[236:239]
    ds_read_b64_tr_b16 a[162:163], v28 offset:4096
    v_permlane32_swap_b32 v84, v86
    v_mfma_f32_16x16x32_bf16 v[232:235], a[172:175], a[104:107], v[232:235]
    s_add_u32 m0, s42, 32768
    ds_read_b64_tr_b16 a[164:165], v28 offset:8192
    v_permlane32_swap_b32 v85, v87
    v_mfma_f32_16x16x32_bf16 v[232:235], a[168:171], a[96:99], v[232:235]
    s_waitcnt lgkmcnt(9)
    buffer_load_dwordx4 v36, s[8:11], s40 offen lds
    v_mfma_f32_16x16x32_bf16 v[240:243], a[176:179], a[96:99], v[240:243]
    s_waitcnt lgkmcnt(7)
    ds_read_b64_tr_b16 a[166:167], v28 offset:12288
    ds_read_b64_tr_b16 a[168:169], v29 offset:0
    v_mfma_f32_16x16x32_bf16 v[240:243], a[180:183], a[104:107], v[240:243]
    ds_read_b64_tr_b16 a[170:171], v29 offset:4096
    v_permlane16_swap_b32 v68, v70
    v_mfma_f32_16x16x32_bf16 v[244:247], a[180:183], a[108:111], v[244:247]
    ds_read_b64_tr_b16 a[172:173], v29 offset:8192
    v_permlane16_swap_b32 v69, v71
    v_mfma_f32_16x16x32_bf16 v[244:247], a[176:179], a[100:103], v[244:247]
    s_waitcnt lgkmcnt(9)
    buffer_load_dwordx4 v37, s[8:11], s40 offen offset:1024 lds
    v_mfma_f32_16x16x32_bf16 v[252:255], a[184:187], a[100:103], v[252:255]
    s_waitcnt lgkmcnt(7)
    ds_read_b64_tr_b16 a[174:175], v29 offset:12288
    ds_read_b64_tr_b16 a[176:177], v30 offset:0
    v_mfma_f32_16x16x32_bf16 v[252:255], a[188:191], a[108:111], v[252:255]
    ds_read_b64_tr_b16 a[178:179], v30 offset:4096
    v_permlane16_swap_b32 v84, v86
    v_mfma_f32_16x16x32_bf16 v[248:251], a[188:191], a[104:107], v[248:251]
    ds_read_b64_tr_b16 a[180:181], v30 offset:8192
    v_permlane16_swap_b32 v85, v87
    v_mfma_f32_16x16x32_bf16 v[248:251], a[184:187], a[96:99], v[248:251]
    s_waitcnt lgkmcnt(9)
    buffer_load_dwordx4 v38, s[8:11], s40 offen offset:2048 lds
    v_mfma_f32_16x16x32_bf16 v[192:195], a[160:163], a[112:115], v[192:195]
    s_waitcnt lgkmcnt(7)
    ds_read_b64_tr_b16 a[182:183], v30 offset:12288
    ds_read_b64_tr_b16 a[184:185], v31 offset:0
    v_mfma_f32_16x16x32_bf16 v[192:195], a[164:167], a[120:123], v[192:195]
    ds_read_b64_tr_b16 a[186:187], v31 offset:4096
    v_mul_f32 v160, s36, v160
    v_mfma_f32_16x16x32_bf16 v[196:199], a[164:167], a[124:127], v[196:199]
    ds_read_b64_tr_b16 a[188:189], v31 offset:8192
    v_mul_f32 v161, s36, v161
    v_mfma_f32_16x16x32_bf16 v[196:199], a[160:163], a[116:119], v[196:199]
    s_waitcnt lgkmcnt(9)
    buffer_load_dwordx4 v39, s[8:11], s40 offen offset:3072 lds
    v_mfma_f32_16x16x32_bf16 v[204:207], a[168:171], a[116:119], v[204:207]
    s_waitcnt lgkmcnt(7)
    s_add_u32 s40, s40, 16384
    ds_read_b64_tr_b16 a[190:191], v31 offset:12288
    ds_read_b64_tr_b16 a[160:161], v32 offset:0
    v_mfma_f32_16x16x32_bf16 v[204:207], a[172:175], a[124:127], v[204:207]
    ds_read_b64_tr_b16 a[162:163], v32 offset:4096
    v_mul_f32 v162, s36, v162
    v_mfma_f32_16x16x32_bf16 v[200:203], a[172:175], a[120:123], v[200:203]
    s_add_u32 m0, s42, 65536
    ds_read_b64_tr_b16 a[164:165], v32 offset:8192
    v_mul_f32 v163, s36, v163
    v_mfma_f32_16x16x32_bf16 v[200:203], a[168:171], a[112:115], v[200:203]
    s_waitcnt lgkmcnt(9)
    buffer_load_dwordx4 v40, s[12:15], s41 offen lds
    v_mfma_f32_16x16x32_bf16 v[208:211], a[176:179], a[112:115], v[208:211]
    s_waitcnt lgkmcnt(7)
    ds_read_b64_tr_b16 a[166:167], v32 offset:12288
    ds_read_b64_tr_b16 a[168:169], v33 offset:0
    v_mfma_f32_16x16x32_bf16 v[208:211], a[180:183], a[120:123], v[208:211]
    ds_read_b64_tr_b16 a[170:171], v33 offset:4096
    v_mul_f32 v168, s36, v168
    v_mfma_f32_16x16x32_bf16 v[212:215], a[180:183], a[124:127], v[212:215]
    ds_read_b64_tr_b16 a[172:173], v33 offset:8192
    v_mul_f32 v169, s36, v169
    v_mfma_f32_16x16x32_bf16 v[212:215], a[176:179], a[116:119], v[212:215]
    s_waitcnt lgkmcnt(9)
    buffer_load_dwordx4 v41, s[12:15], s41 offen offset:1024 lds
    v_mfma_f32_16x16x32_bf16 v[220:223], a[184:187], a[116:119], v[220:223]
    s_waitcnt lgkmcnt(7)
    ds_read_b64_tr_b16 a[174:175], v33 offset:12288
    ds_read_b64_tr_b16 a[176:177], v34 offset:0
    v_mfma_f32_16x16x32_bf16 v[220:223], a[188:191], a[124:127], v[220:223]
    ds_read_b64_tr_b16 a[178:179], v34 offset:4096
    v_mul_f32 v170, s36, v170
    v_mfma_f32_16x16x32_bf16 v[216:219], a[188:191], a[120:123], v[216:219]
    ds_read_b64_tr_b16 a[180:181], v34 offset:8192
    v_mul_f32 v171, s36, v171
    v_mfma_f32_16x16x32_bf16 v[216:219], a[184:187], a[112:115], v[216:219]
    s_waitcnt lgkmcnt(9)
    buffer_load_dwordx4 v40, s[12:15], s41 offen offset:2048 lds
    v_mfma_f32_16x16x32_bf16 v[224:227], a[160:163], a[112:115], v[224:227]
    s_waitcnt lgkmcnt(7)
    ds_read_b64_tr_b16 a[182:183], v34 offset:12288
    ds_read_b64_tr_b16 a[184:185], v35 offset:0
    v_mfma_f32_16x16x32_bf16 v[224:227], a[164:167], a[120:123], v[224:227]
    ds_read_b64_tr_b16 a[186:187], v35 offset:4096
    v_mul_f32 v164, s36, v164
    v_mfma_f32_16x16x32_bf16 v[228:231], a[164:167], a[124:127], v[228:231]
    ds_read_b64_tr_b16 a[188:189], v35 offset:8192
    v_mul_f32 v165, s36, v165
    v_mfma_f32_16x16x32_bf16 v[228:231], a[160:163], a[116:119], v[228:231]
    s_waitcnt lgkmcnt(9)
    buffer_load_dwordx4 v41, s[12:15], s41 offen offset:3072 lds
    v_mfma_f32_16x16x32_bf16 v[236:239], a[168:171], a[116:119], v[236:239]
    s_waitcnt lgkmcnt(7)
    s_add_u32 s41, s41, 16384
    ds_read_b64_tr_b16 a[190:191], v35 offset:12288
    ds_read_b64_tr_b16 a[160:161], v28 offset:16384
    v_mfma_f32_16x16x32_bf16 v[236:239], a[172:175], a[124:127], v[236:239]
    ds_read_b64_tr_b16 a[162:163], v28 offset:20480
    v_mul_f32 v166, s36, v166
    v_mfma_f32_16x16x32_bf16 v[232:235], a[172:175], a[120:123], v[232:235]
    s_add_u32 m0, s42, 81920
    ds_read_b64_tr_b16 a[164:165], v28 offset:24576
    v_mul_f32 v167, s36, v167
    v_mfma_f32_16x16x32_bf16 v[232:235], a[168:171], a[112:115], v[232:235]
    s_waitcnt lgkmcnt(9)
    buffer_load_dwordx4 v40, s[12:15], s41 offen lds
    v_mfma_f32_16x16x32_bf16 v[240:243], a[176:179], a[112:115], v[240:243]
    s_waitcnt lgkmcnt(7)
    ds_read_b64_tr_b16 a[166:167], v28 offset:28672
    ds_read_b64_tr_b16 a[168:169], v29 offset:16384
    v_mfma_f32_16x16x32_bf16 v[240:243], a[180:183], a[120:123], v[240:243]
    ds_read_b64_tr_b16 a[170:171], v29 offset:20480
    v_mul_f32 v172, s36, v172
    v_mfma_f32_16x16x32_bf16 v[244:247], a[180:183], a[124:127], v[244:247]
    ds_read_b64_tr_b16 a[172:173], v29 offset:24576
    v_mul_f32 v173, s36, v173
    v_mfma_f32_16x16x32_bf16 v[244:247], a[176:179], a[116:119], v[244:247]
    s_waitcnt lgkmcnt(9)
    buffer_load_dwordx4 v41, s[12:15], s41 offen offset:1024 lds
    v_mfma_f32_16x16x32_bf16 v[252:255], a[184:187], a[116:119], v[252:255]
    s_waitcnt lgkmcnt(7)
    ds_read_b64_tr_b16 a[174:175], v29 offset:28672
    ds_read_b64_tr_b16 a[176:177], v30 offset:16384
    v_mfma_f32_16x16x32_bf16 v[252:255], a[188:191], a[124:127], v[252:255]
    ds_read_b64_tr_b16 a[178:179], v30 offset:20480
    v_mul_f32 v174, s36, v174
    v_mfma_f32_16x16x32_bf16 v[248:251], a[188:191], a[120:123], v[248:251]
    ds_read_b64_tr_b16 a[180:181], v30 offset:24576
    v_mul_f32 v175, s36, v175
    v_mfma_f32_16x16x32_bf16 v[248:251], a[184:187], a[112:115], v[248:251]
    s_waitcnt lgkmcnt(9)
    buffer_load_dwordx4 v40, s[12:15], s41 offen offset:2048 lds
    v_mfma_f32_16x16x32_bf16 v[192:195], a[160:163], a[128:131], v[192:195]
    s_waitcnt lgkmcnt(7)
    ds_read_b64_tr_b16 a[182:183], v30 offset:28672
    ds_read_b64_tr_b16 a[184:185], v31 offset:16384
    v_mfma_f32_16x16x32_bf16 v[192:195], a[164:167], a[136:139], v[192:195]
    ds_read_b64_tr_b16 a[186:187], v31 offset:20480
    v_cvt_pk_bf16_f32 v72, v160, v161
    v_mfma_f32_16x16x32_bf16 v[196:199], a[164:167], a[140:143], v[196:199]
    ds_read_b64_tr_b16 a[188:189], v31 offset:24576
    v_cvt_pk_bf16_f32 v73, v162, v163
    v_mfma_f32_16x16x32_bf16 v[196:199], a[160:163], a[132:135], v[196:199]
    s_waitcnt lgkmcnt(9)
    buffer_load_dwordx4 v41, s[12:15], s41 offen offset:3072 lds
    v_mfma_f32_16x16x32_bf16 v[204:207], a[168:171], a[132:135], v[204:207]
    s_waitcnt lgkmcnt(7)
    s_add_u32 s41, s41, 16384
    ds_read_b64_tr_b16 a[190:191], v31 offset:28672
    ds_read_b64_tr_b16 a[160:161], v32 offset:16384
    v_mfma_f32_16x16x32_bf16 v[204:207], a[172:175], a[140:143], v[204:207]
    ds_read_b64_tr_b16 a[162:163], v32 offset:20480
    v_cvt_pk_bf16_f32 v74, v168, v169
    v_mfma_f32_16x16x32_bf16 v[200:203], a[172:175], a[136:139], v[200:203]
    ds_read_b64_tr_b16 a[164:165], v32 offset:24576
    v_cvt_pk_bf16_f32 v75, v170, v171
    v_mfma_f32_16x16x32_bf16 v[200:203], a[168:171], a[128:131], v[200:203]
    s_waitcnt lgkmcnt(9)
    ds_read_b64_tr_b16 a[166:167], v32 offset:28672
    v_cvt_pk_bf16_f32 v88, v164, v165
    v_mfma_f32_16x16x32_bf16 v[208:211], a[176:179], a[128:131], v[208:211]
    s_waitcnt lgkmcnt(8)
    ds_read_b64_tr_b16 a[168:169], v33 offset:16384
    v_cvt_pk_bf16_f32 v89, v166, v167
    v_mfma_f32_16x16x32_bf16 v[208:211], a[180:183], a[136:139], v[208:211]
    ds_read_b64_tr_b16 a[170:171], v33 offset:20480
    v_cvt_pk_bf16_f32 v90, v172, v173
    v_mfma_f32_16x16x32_bf16 v[212:215], a[180:183], a[140:143], v[212:215]
    ds_read_b64_tr_b16 a[172:173], v33 offset:24576
    v_cvt_pk_bf16_f32 v91, v174, v175
    v_mfma_f32_16x16x32_bf16 v[212:215], a[176:179], a[132:135], v[212:215]
    s_waitcnt lgkmcnt(9)
    ds_read_b64_tr_b16 a[174:175], v33 offset:28672
    v_permlane32_swap_b32 v72, v74
    v_mfma_f32_16x16x32_bf16 v[220:223], a[184:187], a[132:135], v[220:223]
    s_waitcnt lgkmcnt(8)
    ds_read_b64_tr_b16 a[176:177], v34 offset:16384
    v_permlane32_swap_b32 v73, v75
    v_mfma_f32_16x16x32_bf16 v[220:223], a[188:191], a[140:143], v[220:223]
    ds_read_b64_tr_b16 a[178:179], v34 offset:20480
    v_permlane32_swap_b32 v88, v90
    v_mfma_f32_16x16x32_bf16 v[216:219], a[188:191], a[136:139], v[216:219]
    ds_read_b64_tr_b16 a[180:181], v34 offset:24576
    v_permlane32_swap_b32 v89, v91
    v_mfma_f32_16x16x32_bf16 v[216:219], a[184:187], a[128:131], v[216:219]
    s_waitcnt lgkmcnt(9)
    ds_read_b64_tr_b16 a[182:183], v34 offset:28672
    v_permlane16_swap_b32 v72, v74
    v_mfma_f32_16x16x32_bf16 v[224:227], a[160:163], a[128:131], v[224:227]
    s_waitcnt lgkmcnt(8)
    ds_read_b64_tr_b16 a[184:185], v35 offset:16384
    v_permlane16_swap_b32 v73, v75
    v_mfma_f32_16x16x32_bf16 v[224:227], a[164:167], a[136:139], v[224:227]
    ds_read_b64_tr_b16 a[186:187], v35 offset:20480
    v_permlane16_swap_b32 v88, v90
    v_mfma_f32_16x16x32_bf16 v[228:231], a[164:167], a[140:143], v[228:231]
    ds_read_b64_tr_b16 a[188:189], v35 offset:24576
    v_permlane16_swap_b32 v89, v91
    v_mfma_f32_16x16x32_bf16 v[228:231], a[160:163], a[132:135], v[228:231]
    s_waitcnt lgkmcnt(9)
    ds_read_b64_tr_b16 a[190:191], v35 offset:28672
    v_mul_f32 v176, s36, v176
    v_mfma_f32_16x16x32_bf16 v[236:239], a[168:171], a[132:135], v[236:239]
    s_waitcnt lgkmcnt(8)
    v_mul_f32 v177, s36, v177
    v_mul_f32 v178, s36, v178
    v_mfma_f32_16x16x32_bf16 v[236:239], a[172:175], a[140:143], v[236:239]
    v_mul_f32 v179, s36, v179
    v_mul_f32 v184, s36, v184
    v_mfma_f32_16x16x32_bf16 v[232:235], a[172:175], a[136:139], v[232:235]
    v_mul_f32 v185, s36, v185
    v_mul_f32 v186, s36, v186
    v_mfma_f32_16x16x32_bf16 v[232:235], a[168:171], a[128:131], v[232:235]
    s_waitcnt lgkmcnt(6)
    v_mul_f32 v187, s36, v187
    v_mul_f32 v180, s36, v180
    s_waitcnt vmcnt(16)
    s_barrier
    v_mfma_f32_16x16x32_bf16 v[240:243], a[176:179], a[128:131], v[240:243]
    s_waitcnt lgkmcnt(4)
    ds_read_b128 a[208:211], v8 offset:0
    v_mul_f32 v181, s36, v181
    v_mfma_f32_16x16x32_bf16 v[240:243], a[180:183], a[136:139], v[240:243]
    ds_read_b128 a[212:215], v9 offset:0
    v_mul_f32 v182, s36, v182
    v_mfma_f32_16x16x32_bf16 v[244:247], a[180:183], a[140:143], v[244:247]
    ds_read_b128 a[216:219], v10 offset:0
    v_mul_f32 v183, s36, v183
    v_mfma_f32_16x16x32_bf16 v[244:247], a[176:179], a[132:135], v[244:247]
    s_waitcnt lgkmcnt(5)
    ds_read_b128 a[220:223], v11 offset:0
    v_mul_f32 v188, s36, v188
    v_mfma_f32_16x16x32_bf16 v[252:255], a[184:187], a[132:135], v[252:255]
    s_waitcnt lgkmcnt(4)
    ds_read_b128 a[224:227], v8 offset:4096
    v_mul_f32 v189, s36, v189
    v_mfma_f32_16x16x32_bf16 v[252:255], a[188:191], a[140:143], v[252:255]
    v_mul_f32 v190, s36, v190
    v_mul_f32 v191, s36, v191
    v_mfma_f32_16x16x32_bf16 v[248:251], a[188:191], a[136:139], v[248:251]
    s_load_dwordx2 s[16:17], s[0:1], 88
    v_cvt_pk_bf16_f32 v76, v176, v177
    v_cvt_pk_bf16_f32 v77, v178, v179
    v_mfma_f32_16x16x32_bf16 v[248:251], a[184:187], a[128:131], v[248:251]
    v_cvt_pk_bf16_f32 v78, v184, v185
    v_cvt_pk_bf16_f32 v79, v186, v187
    v_cvt_pk_bf16_f32 v92, v180, v181
    v_cvt_pk_bf16_f32 v93, v182, v183
    v_cvt_pk_bf16_f32 v94, v188, v189
    v_cvt_pk_bf16_f32 v95, v190, v191
    v_permlane32_swap_b32 v76, v78
    v_permlane32_swap_b32 v77, v79
    v_permlane32_swap_b32 v92, v94
    v_permlane32_swap_b32 v93, v95
    v_permlane16_swap_b32 v76, v78
    v_permlane16_swap_b32 v77, v79
    v_permlane16_swap_b32 v92, v94
    v_permlane16_swap_b32 v93, v95
    s_mov_b32 s36, 1040356334
    s_mov_b32 s37, 1040356334
    v_mov_b32 v58, 0
    v_mov_b32 v59, 0
    v_mov_b32 v60, 0
    v_mov_b32 v61, 0
    v_pk_mul_f32 v[192:193], v[192:193], s[36:37]
    v_pk_mul_f32 v[194:195], v[194:195], s[36:37]
    v_pk_mul_f32 v[200:201], v[200:201], s[36:37]
    v_pk_mul_f32 v[202:203], v[202:203], s[36:37]
    v_pk_mul_f32 v[196:197], v[196:197], s[36:37]
    v_pk_mul_f32 v[198:199], v[198:199], s[36:37]
    v_pk_mul_f32 v[204:205], v[204:205], s[36:37]
    v_pk_mul_f32 v[206:207], v[206:207], s[36:37]
    v_mfma_f32_32x32x16_bf16 a[0:15], v[58:61], v[58:61], 0
    v_cvt_pk_bf16_f32 v96, v192, v193
    v_cvt_pk_bf16_f32 v97, v194, v195
    v_cvt_pk_bf16_f32 v98, v200, v201
    v_cvt_pk_bf16_f32 v99, v202, v203
    v_cvt_pk_bf16_f32 v112, v196, v197
    v_cvt_pk_bf16_f32 v113, v198, v199
    v_cvt_pk_bf16_f32 v114, v204, v205
    v_cvt_pk_bf16_f32 v115, v206, v207
    v_mfma_f32_32x32x16_bf16 a[16:31], v[58:61], v[58:61], 0
    v_permlane32_swap_b32 v96, v98
    v_permlane32_swap_b32 v97, v99
    v_permlane32_swap_b32 v112, v114
    v_permlane32_swap_b32 v113, v115
    v_permlane16_swap_b32 v96, v98
    v_permlane16_swap_b32 v97, v99
    v_permlane16_swap_b32 v112, v114
    v_permlane16_swap_b32 v113, v115
    v_pk_mul_f32 v[208:209], v[208:209], s[36:37]
    v_pk_mul_f32 v[210:211], v[210:211], s[36:37]
    v_pk_mul_f32 v[216:217], v[216:217], s[36:37]
    v_pk_mul_f32 v[218:219], v[218:219], s[36:37]
    v_pk_mul_f32 v[212:213], v[212:213], s[36:37]
    v_pk_mul_f32 v[214:215], v[214:215], s[36:37]
    v_pk_mul_f32 v[220:221], v[220:221], s[36:37]
    v_pk_mul_f32 v[222:223], v[222:223], s[36:37]
    v_mfma_f32_32x32x16_bf16 a[32:47], v[58:61], v[58:61], 0
    v_cvt_pk_bf16_f32 v100, v208, v209
    v_cvt_pk_bf16_f32 v101, v210, v211
    v_cvt_pk_bf16_f32 v102, v216, v217
    v_cvt_pk_bf16_f32 v103, v218, v219
    v_cvt_pk_bf16_f32 v116, v212, v213
    v_cvt_pk_bf16_f32 v117, v214, v215
    v_cvt_pk_bf16_f32 v118, v220, v221
    v_cvt_pk_bf16_f32 v119, v222, v223
    v_mfma_f32_32x32x16_bf16 a[48:63], v[58:61], v[58:61], 0
    v_permlane32_swap_b32 v100, v102
    v_permlane32_swap_b32 v101, v103
    v_permlane32_swap_b32 v116, v118
    v_permlane32_swap_b32 v117, v119
    v_permlane16_swap_b32 v100, v102
    v_permlane16_swap_b32 v101, v103
    v_permlane16_swap_b32 v116, v118
    v_permlane16_swap_b32 v117, v119
    v_pk_mul_f32 v[224:225], v[224:225], s[36:37]
    v_pk_mul_f32 v[226:227], v[226:227], s[36:37]
    v_pk_mul_f32 v[232:233], v[232:233], s[36:37]
    v_pk_mul_f32 v[234:235], v[234:235], s[36:37]
    v_pk_mul_f32 v[228:229], v[228:229], s[36:37]
    v_pk_mul_f32 v[230:231], v[230:231], s[36:37]
    v_pk_mul_f32 v[236:237], v[236:237], s[36:37]
    v_pk_mul_f32 v[238:239], v[238:239], s[36:37]
    v_mfma_f32_32x32x16_bf16 a[64:79], v[58:61], v[58:61], 0
    v_cvt_pk_bf16_f32 v104, v224, v225
    v_cvt_pk_bf16_f32 v105, v226, v227
    v_cvt_pk_bf16_f32 v106, v232, v233
    v_cvt_pk_bf16_f32 v107, v234, v235
    v_cvt_pk_bf16_f32 v120, v228, v229
    v_cvt_pk_bf16_f32 v121, v230, v231
    v_cvt_pk_bf16_f32 v122, v236, v237
    v_cvt_pk_bf16_f32 v123, v238, v239
    v_mfma_f32_32x32x16_bf16 a[80:95], v[58:61], v[58:61], 0
    v_permlane32_swap_b32 v104, v106
    v_permlane32_swap_b32 v105, v107
    v_permlane32_swap_b32 v120, v122
    v_permlane32_swap_b32 v121, v123
    v_permlane16_swap_b32 v104, v106
    v_permlane16_swap_b32 v105, v107
    v_permlane16_swap_b32 v120, v122
    v_permlane16_swap_b32 v121, v123
    v_pk_mul_f32 v[240:241], v[240:241], s[36:37]
    v_pk_mul_f32 v[242:243], v[242:243], s[36:37]
    v_pk_mul_f32 v[248:249], v[248:249], s[36:37]
    v_pk_mul_f32 v[250:251], v[250:251], s[36:37]
    v_pk_mul_f32 v[244:245], v[244:245], s[36:37]
    v_pk_mul_f32 v[246:247], v[246:247], s[36:37]
    v_pk_mul_f32 v[252:253], v[252:253], s[36:37]
    v_pk_mul_f32 v[254:255], v[254:255], s[36:37]
    v_mfma_f32_32x32x16_bf16 a[96:111], v[58:61], v[58:61], 0
    v_cvt_pk_bf16_f32 v108, v240, v241
    v_cvt_pk_bf16_f32 v109, v242, v243
    v_cvt_pk_bf16_f32 v110, v248, v249
    v_cvt_pk_bf16_f32 v111, v250, v251
    v_cvt_pk_bf16_f32 v124, v244, v245
    v_cvt_pk_bf16_f32 v125, v246, v247
    v_cvt_pk_bf16_f32 v126, v252, v253
    v_cvt_pk_bf16_f32 v127, v254, v255
    v_mfma_f32_32x32x16_bf16 a[112:127], v[58:61], v[58:61], 0
    v_permlane32_swap_b32 v108, v110
    v_permlane32_swap_b32 v109, v111
    v_permlane32_swap_b32 v124, v126
    v_permlane32_swap_b32 v125, v127
    v_permlane16_swap_b32 v108, v110
    v_permlane16_swap_b32 v109, v111
    v_permlane16_swap_b32 v124, v126
    v_permlane16_swap_b32 v125, v127
    s_waitcnt lgkmcnt(0)
    v_mfma_f32_16x16x32_bf16 v[216:219], a[208:211], v[64:67], 0
    v_mfma_f32_16x16x32_bf16 v[216:219], a[212:215], v[68:71], v[216:219]
    v_mfma_f32_16x16x32_bf16 v[216:219], a[216:219], v[72:75], v[216:219]
    v_mfma_f32_16x16x32_bf16 v[216:219], a[220:223], v[76:79], v[216:219]
    v_mfma_f32_16x16x32_bf16 v[220:223], a[208:211], v[80:83], 0
    v_mfma_f32_16x16x32_bf16 v[220:223], a[212:215], v[84:87], v[220:223]
    v_mfma_f32_16x16x32_bf16 v[220:223], a[216:219], v[88:91], v[220:223]
    v_mfma_f32_16x16x32_bf16 v[220:223], a[220:223], v[92:95], v[220:223]
    v_mfma_f32_16x16x32_bf16 v[224:227], a[208:211], v[96:99], 0
    v_mfma_f32_16x16x32_bf16 v[224:227], a[212:215], v[100:103], v[224:227]
    v_mfma_f32_16x16x32_bf16 v[224:227], a[216:219], v[104:107], v[224:227]
    v_mfma_f32_16x16x32_bf16 v[224:227], a[220:223], v[108:111], v[224:227]
    v_mfma_f32_16x16x32_bf16 v[228:231], a[208:211], v[112:115], 0
    v_mfma_f32_16x16x32_bf16 v[228:231], a[212:215], v[116:119], v[228:231]
    v_mfma_f32_16x16x32_bf16 v[228:231], a[216:219], v[120:123], v[228:231]
    v_mfma_f32_16x16x32_bf16 v[228:231], a[220:223], v[124:127], v[228:231]
    v_mfma_f32_32x32x16_bf16 a[192:207], v[58:61], v[58:61], 0
    v_max3_f32 v232, v216, v217, v218
    v_max_f32 v232, v232, v219
    v_max3_f32 v233, v220, v221, v222
    v_max_f32 v233, v233, v223
    v_max3_f32 v234, v224, v225, v226
    v_max_f32 v234, v234, v227
    s_nop 0
    v_max3_f32 v235, v228, v229, v230
    v_max_f32 v235, v235, v231
    v_mov_b32 v236, v232
    v_mov_b32 v237, v233
    v_mov_b32 v238, v234
    v_mov_b32 v239, v235
    v_permlane16_swap_b32 v232, v236
    v_permlane16_swap_b32 v233, v237
    v_permlane16_swap_b32 v234, v238
    v_permlane16_swap_b32 v235, v239
    v_max_f32 v232, v232, v236
    v_max_f32 v233, v233, v237
    v_max_f32 v234, v234, v238
    v_max_f32 v235, v235, v239
    v_mov_b32 v236, v232
    v_mov_b32 v237, v233
    v_mov_b32 v238, v234
    v_mov_b32 v239, v235
    v_permlane32_swap_b32 v232, v236
    v_permlane32_swap_b32 v233, v237
    v_permlane32_swap_b32 v234, v238
    v_permlane32_swap_b32 v235, v239
    v_max_f32 v232, v232, v236
    v_max_f32 v233, v233, v237
    v_max_f32 v234, v234, v238
    v_max_f32 v235, v235, v239
    v_sub_f32 v192, 3250585600, v232
    v_sub_f32 v193, 3250585600, v232
    v_sub_f32 v194, 3250585600, v232
    v_sub_f32 v195, 3250585600, v232
Ltour0_3:
    s_cbranch_execz Ltour0_7
    v_sub_f32 v196, 3250585600, v233
    v_sub_f32 v197, 3250585600, v233
    v_sub_f32 v198, 3250585600, v233
    v_sub_f32 v199, 3250585600, v233
    v_sub_f32 v200, 3250585600, v234
    v_sub_f32 v201, 3250585600, v234
    v_sub_f32 v202, 3250585600, v234
    v_sub_f32 v203, 3250585600, v234
    v_sub_f32 v204, 3250585600, v235
    v_sub_f32 v205, 3250585600, v235
    v_sub_f32 v206, 3250585600, v235
    v_sub_f32 v207, 3250585600, v235
Lattn_stage0:
    s_mov_b32 s43, 7
    v_mfma_f32_16x16x32_bf16 v[208:211], a[208:211], v[64:67], v[192:195]
    s_lshl_b32 s53, s5, 4
    v_mfma_f32_16x16x32_bf16 v[208:211], a[212:215], v[68:71], v[208:211]
    s_add_u32 s53, s53, s4
    v_mfma_f32_16x16x32_bf16 v[208:211], a[216:219], v[72:75], v[208:211]
    s_lshl_b32 s53, s53, 2
    v_mfma_f32_16x16x32_bf16 v[208:211], a[220:223], v[76:79], v[208:211]
    s_add_u32 s53, s53, s3
    ds_read_b128 a[228:231], v9 offset:4096
    v_mfma_f32_16x16x32_bf16 v[212:215], a[208:211], v[80:83], v[196:199]
    s_mul_i32 s53, s53, 4608
    s_nop 3
    v_exp_f32 v208, v208
    v_mfma_f32_16x16x32_bf16 v[212:215], a[212:215], v[84:87], v[212:215]
    s_add_u32 s53, s53, 2621440
    v_exp_f32 v209, v209
    v_mfma_f32_16x16x32_bf16 v[212:215], a[216:219], v[88:91], v[212:215]
    s_lshr_b32 s44, s2, 5
    v_exp_f32 v210, v210
    v_mfma_f32_16x16x32_bf16 v[212:215], a[220:223], v[92:95], v[212:215]
    s_lshl_b32 s44, s44, 3
    v_exp_f32 v211, v211
    v_cvt_pk_bf16_f32 v128, v208, v209
    ds_read_b128 a[232:235], v10 offset:4096
    v_cvt_pk_bf16_f32 v129, v210, v211
    v_mfma_f32_16x16x32_bf16 v[208:211], a[208:211], v[96:99], v[200:203]
    s_and_b32 s37, s2, 7
    s_nop 0
    v_exp_f32 v212, v212
    v_mfma_f32_16x16x32_bf16 v[208:211], a[212:215], v[100:103], v[208:211]
    s_add_u32 s44, s44, s37
    v_exp_f32 v213, v213
    v_mfma_f32_16x16x32_bf16 v[208:211], a[216:219], v[104:107], v[208:211]
    s_lshl_b32 s44, s44, 2
    v_exp_f32 v214, v214
    v_mfma_f32_16x16x32_bf16 v[208:211], a[220:223], v[108:111], v[208:211]
    s_bfe_u32 s37, s2, 0x20003
    v_exp_f32 v215, v215
    v_cvt_pk_bf16_f32 v136, v212, v213
    ds_read_b128 a[236:239], v11 offset:4096
    v_cvt_pk_bf16_f32 v137, v214, v215
    v_mfma_f32_16x16x32_bf16 v[212:215], a[208:211], v[112:115], v[204:207]
    s_add_u32 s44, s44, s37
    s_nop 0
    v_exp_f32 v208, v208
    v_mfma_f32_16x16x32_bf16 v[212:215], a[212:215], v[116:119], v[212:215]
    s_add_u32 s44, s44, 72
    v_exp_f32 v209, v209
    v_mfma_f32_16x16x32_bf16 v[212:215], a[216:219], v[120:123], v[212:215]
    s_cmp_lt_u32 s44, 216
    s_cselect_b32 s37, 0, 2147483648
    v_exp_f32 v210, v210
    v_mfma_f32_16x16x32_bf16 v[212:215], a[220:223], v[124:127], v[212:215]
    s_lshl_b32 s44, s44, 5
    v_exp_f32 v211, v211
    v_cvt_pk_bf16_f32 v144, v208, v209
    ds_read_b128 a[208:211], v8 offset:8192
    v_cvt_pk_bf16_f32 v145, v210, v211
    v_mfma_f32_16x16x32_bf16 v[208:211], a[224:227], v[64:67], v[192:195]
    s_waitcnt lgkmcnt(3)
    s_or_b32 s44, s44, s37
    v_exp_f32 v212, v212
    v_mfma_f32_16x16x32_bf16 v[208:211], a[228:231], v[68:71], v[208:211]
    s_waitcnt lgkmcnt(2)
    s_mov_b32 s18, 3981312
    v_exp_f32 v213, v213
    v_mfma_f32_16x16x32_bf16 v[208:211], a[232:235], v[72:75], v[208:211]
    s_waitcnt lgkmcnt(1)
    s_lshr_b32 s6, s2, 3
    v_exp_f32 v214, v214
    v_mfma_f32_16x16x32_bf16 v[208:211], a[236:239], v[76:79], v[208:211]
    s_and_b32 s7, s2, 7
    v_exp_f32 v215, v215
    v_cvt_pk_bf16_f32 v152, v212, v213
    ds_read_b128 a[212:215], v9 offset:8192
    v_cvt_pk_bf16_f32 v153, v214, v215
    v_mfma_f32_16x16x32_bf16 v[212:215], a[224:227], v[80:83], v[196:199]
    s_mul_i32 s7, s7, 18
    s_nop 0
    v_exp_f32 v208, v208
    v_mfma_f32_16x16x32_bf16 v[212:215], a[228:231], v[84:87], v[212:215]
    s_add_u32 s7, s7, s6
    v_exp_f32 v209, v209
    v_mfma_f32_16x16x32_bf16 v[212:215], a[232:235], v[88:91], v[212:215]
    s_lshl_b32 s58, s7, 6
    v_exp_f32 v210, v210
    v_mfma_f32_16x16x32_bf16 v[212:215], a[236:239], v[92:95], v[212:215]
    s_mul_i32 s59, s7, 36864
    v_exp_f32 v211, v211
    v_cvt_pk_bf16_f32 v130, v208, v209
    ds_read_b128 a[216:219], v10 offset:8192
    v_cvt_pk_bf16_f32 v131, v210, v211
    v_mfma_f32_16x16x32_bf16 v[208:211], a[224:227], v[96:99], v[200:203]
    s_cmp_lt_u32 s6, 18
    s_cselect_b32 s7, 0, 2147483648
    v_exp_f32 v212, v212
    v_mfma_f32_16x16x32_bf16 v[208:211], a[228:231], v[100:103], v[208:211]
    s_or_b32 s58, s58, s7
    v_exp_f32 v213, v213
    v_mfma_f32_16x16x32_bf16 v[208:211], a[232:235], v[104:107], v[208:211]
    s_or_b32 s59, s59, s7
    v_exp_f32 v214, v214
    v_mfma_f32_16x16x32_bf16 v[208:211], a[236:239], v[108:111], v[208:211]
    s_and_b32 s7, s4, 1
    v_exp_f32 v215, v215
    v_cvt_pk_bf16_f32 v138, v212, v213
    ds_read_b128 a[220:223], v11 offset:8192
    v_cvt_pk_bf16_f32 v139, v214, v215
    s_mov_b32 s39, 221184
    s_mov_b32 s38, 27648
    v_mfma_f32_16x16x32_bf16 v[212:215], a[224:227], v[112:115], v[204:207]
    s_lshl_b32 s6, s7, 7
    v_exp_f32 v208, v208
    v_mfma_f32_16x16x32_bf16 v[212:215], a[228:231], v[116:119], v[212:215]
    s_xor_b32 s36, s4, 1
    v_exp_f32 v209, v209
    v_mfma_f32_16x16x32_bf16 v[212:215], a[232:235], v[120:123], v[212:215]
    s_mul_i32 s36, s36, 294912
    v_exp_f32 v210, v210
    v_mfma_f32_16x16x32_bf16 v[212:215], a[236:239], v[124:127], v[212:215]
    s_waitcnt lgkmcnt(3)
    s_add_u32 s46, s36, s6
    v_exp_f32 v211, v211
    v_cvt_pk_bf16_f32 v146, v208, v209
    ds_read_b128 a[224:227], v8 offset:12288
    v_cvt_pk_bf16_f32 v147, v210, v211
    v_mfma_f32_16x16x32_bf16 v[208:211], a[208:211], v[64:67], v[192:195]
    s_waitcnt lgkmcnt(3)
    s_lshl_b32 s36, s4, 8
    v_exp_f32 v212, v212
    v_mfma_f32_16x16x32_bf16 v[208:211], a[212:215], v[68:71], v[208:211]
    s_waitcnt lgkmcnt(2)
    s_add_u32 s56, s47, s36
    v_exp_f32 v213, v213
    v_mfma_f32_16x16x32_bf16 v[208:211], a[216:219], v[72:75], v[208:211]
    s_waitcnt lgkmcnt(1)
    s_lshr_b32 s36, s4, 1
    v_exp_f32 v214, v214
    v_mfma_f32_16x16x32_bf16 v[208:211], a[220:223], v[76:79], v[208:211]
    s_lshl_b32 s36, s36, 11
    v_exp_f32 v215, v215
    v_cvt_pk_bf16_f32 v154, v212, v213
    ds_read_b128 a[228:231], v9 offset:12288
    v_cvt_pk_bf16_f32 v155, v214, v215
    v_mfma_f32_16x16x32_bf16 v[212:215], a[208:211], v[80:83], v[196:199]
    s_lshl_b32 s7, s7, 8
    s_nop 0
    v_exp_f32 v208, v208
    v_mfma_f32_16x16x32_bf16 v[212:215], a[212:215], v[84:87], v[212:215]
    s_add_u32 s36, s36, s7
    v_exp_f32 v209, v209
    v_mfma_f32_16x16x32_bf16 v[212:215], a[216:219], v[88:91], v[212:215]
    s_add_u32 s93, s47, s36
    v_exp_f32 v210, v210
    v_mfma_f32_16x16x32_bf16 v[212:215], a[220:223], v[92:95], v[212:215]
    s_lshr_b32 s36, s4, 1
    v_exp_f32 v211, v211
    v_cvt_pk_bf16_f32 v132, v208, v209
    ds_read_b128 a[232:235], v10 offset:12288
    v_cvt_pk_bf16_f32 v133, v210, v211
    v_mfma_f32_16x16x32_bf16 v[208:211], a[208:211], v[96:99], v[200:203]
    s_lshl_b32 s36, s36, 4
    s_nop 0
    v_exp_f32 v212, v212
    v_mfma_f32_16x16x32_bf16 v[208:211], a[212:215], v[100:103], v[208:211]
    s_add_u32 s36, s36, s5
    v_exp_f32 v213, v213
    v_mfma_f32_16x16x32_bf16 v[208:211], a[216:219], v[104:107], v[208:211]
    s_lshl_b32 s36, s36, 9
    v_exp_f32 v214, v214
    v_mfma_f32_16x16x32_bf16 v[208:211], a[220:223], v[108:111], v[208:211]
    s_add_u32 s36, s36, s7
    v_exp_f32 v215, v215
    v_cvt_pk_bf16_f32 v140, v212, v213
    ds_read_b128 a[236:239], v11 offset:12288
    v_cvt_pk_bf16_f32 v141, v214, v215
    s_waitcnt vmcnt(4)
    s_barrier
    v_mfma_f32_16x16x32_bf16 v[212:215], a[208:211], v[112:115], v[204:207]
    s_lshl_b32 s36, s36, 8
    v_exp_f32 v208, v208
    v_mfma_f32_16x16x32_bf16 v[212:215], a[212:215], v[116:119], v[212:215]
    s_add_u32 m0, s42, 49152
    s_add_u32 s55, s36, 20971520
    v_exp_f32 v209, v209
    v_mfma_f32_16x16x32_bf16 v[212:215], a[216:219], v[120:123], v[212:215]
    s_add_u32 s7, s45, s6
    v_exp_f32 v210, v210
    v_mfma_f32_16x16x32_bf16 v[212:215], a[220:223], v[124:127], v[212:215]
    s_waitcnt lgkmcnt(3)
    s_xor_b32 s54, s92, 128
    v_exp_f32 v211, v211
    v_cvt_pk_bf16_f32 v148, v208, v209
    ds_read_b128 a[208:211], v8 offset:16384
    v_cvt_pk_bf16_f32 v149, v210, v211
    buffer_load_dwordx4 v36, s[8:11], s40 offen lds
    v_mfma_f32_16x16x32_bf16 v[208:211], a[224:227], v[64:67], v[192:195]
    s_waitcnt lgkmcnt(3)
    s_lshl_b32 s36, s3, 14
    v_exp_f32 v212, v212
    v_mfma_f32_16x16x32_bf16 v[208:211], a[228:231], v[68:71], v[208:211]
    s_waitcnt lgkmcnt(2)
    v_exp_f32 v213, v213
    v_mfma_f32_16x16x32_bf16 v[208:211], a[232:235], v[72:75], v[208:211]
    s_waitcnt lgkmcnt(1)
    v_exp_f32 v214, v214
    v_mfma_f32_16x16x32_bf16 v[208:211], a[236:239], v[76:79], v[208:211]
    v_exp_f32 v215, v215
    v_cvt_pk_bf16_f32 v156, v212, v213
    ds_read_b128 a[212:215], v9 offset:16384
    v_cvt_pk_bf16_f32 v157, v214, v215
    v_mfma_f32_16x16x32_bf16 v[212:215], a[224:227], v[80:83], v[196:199]
    s_nop 2
    v_exp_f32 v208, v208
    v_mfma_f32_16x16x32_bf16 v[212:215], a[228:231], v[84:87], v[212:215]
    v_exp_f32 v209, v209
    v_mfma_f32_16x16x32_bf16 v[212:215], a[232:235], v[88:91], v[212:215]
    v_exp_f32 v210, v210
    v_mfma_f32_16x16x32_bf16 v[212:215], a[236:239], v[92:95], v[212:215]
    v_exp_f32 v211, v211
    ds_read_b64_tr_b16 a[160:161], v20 offset:0
    v_cvt_pk_bf16_f32 v134, v208, v209
    v_lshrrev_b32 v51, 2, v0
    v_mul_u32_u24 v51, 9216, v51
    v_and_b32 v254, 3, v0
    v_lshl_add_u32 v254, v254, 4, v51
    v_lshlrev_b32 v255, 4, v0
    v_add_u32 v51, 98304, v255
    v_lshl_add_u32 v252, v1, 4, s36
    v_mov_b32 v224, 0
    v_mov_b32 v225, 0
    v_mov_b32 v226, 0
    v_mov_b32 v227, 0
    v_mov_b32 v228, 0
    v_mov_b32 v229, 0
    v_mov_b32 v230, 0
    v_mov_b32 v231, 0
    v_mov_b32 v248, -1
    v_mov_b32 v249, -1
    v_mov_b32 v250, -1
    v_mov_b32 v251, -1
    v_min_u32 v232, 41, v1
    v_lshlrev_b32 v232, 4, v232
    s_mov_b32 s57, s58
    s_lshl_b32 s6, s3, 10
    s_add_u32 s6, s6, 135168
    s_lshr_b32 s37, s2, 3
    s_mul_i32 s37, s37, -129024
    s_add_u32 s37, s37, 4128768
    ds_read_b64_tr_b16 a[162:163], v20 offset:4096
    ds_read_b128 a[216:219], v10 offset:16384
    v_cvt_pk_bf16_f32 v135, v210, v211
    buffer_load_dwordx4 v37, s[8:11], s40 offen offset:1024 lds
    v_mfma_f32_16x16x32_bf16 v[208:211], a[224:227], v[96:99], v[200:203]
    v_exp_f32 v212, v212
    v_mfma_f32_16x16x32_bf16 v[208:211], a[228:231], v[100:103], v[208:211]
    v_exp_f32 v213, v213
    v_mfma_f32_16x16x32_bf16 v[208:211], a[232:235], v[104:107], v[208:211]
    v_exp_f32 v214, v214
    v_mfma_f32_16x16x32_bf16 v[208:211], a[236:239], v[108:111], v[208:211]
    s_mov_b32 s52, s55
    v_exp_f32 v215, v215
    ds_read_b64_tr_b16 a[164:165], v20 offset:8192
    v_cvt_pk_bf16_f32 v142, v212, v213
    ds_read_b64_tr_b16 a[166:167], v20 offset:12288
    v_min_u32 v237, 19, v1
    v_lshl_add_u32 v237, v237, 7, s36
    v_lshl_add_u32 v238, v1, 7, s36
    ds_read_b128 a[220:223], v11 offset:16384
    v_cvt_pk_bf16_f32 v143, v214, v215
    buffer_load_dword v217, v57, s[32:35], s37 offen
    v_mfma_f32_16x16x32_bf16 v[212:215], a[224:227], v[112:115], v[204:207]
    v_exp_f32 v208, v208
    v_mfma_f32_16x16x32_bf16 v[212:215], a[228:231], v[116:119], v[212:215]
    v_exp_f32 v209, v209
    v_mfma_f32_16x16x32_bf16 v[212:215], a[232:235], v[120:123], v[212:215]
    s_mul_i32 s37, s5, 18432
    v_exp_f32 v210, v210
    v_mfma_f32_16x16x32_bf16 v[212:215], a[236:239], v[124:127], v[212:215]
    s_add_u32 s37, s37, s45
    v_exp_f32 v211, v211
    ds_read_b64_tr_b16 a[168:169], v21 offset:0
    v_cvt_pk_bf16_f32 v150, v208, v209
    ds_read_b64_tr_b16 a[170:171], v21 offset:4096
    v_min_u32 v236, 143, v0
    v_lshl_add_u32 v236, v236, 7, s37
    v_mul_u32_u24 v235, 24, v0
    v_lshrrev_b32 v235, 8, v235
    v_lshl_add_u32 v235, v235, 7, s37
    ds_read_b128 a[224:227], v8 offset:20480
    v_cvt_pk_bf16_f32 v151, v210, v211
    s_waitcnt lgkmcnt(3)
    buffer_load_dwordx4 v38, s[8:11], s40 offen offset:2048 lds
    s_nop 0
    s_nop 0
    s_nop 0
    s_nop 0
    s_nop 0
Lattn_loop:
    v_mfma_f32_16x16x32_bf16 v[208:211], a[208:211], v[64:67], v[192:195]
    v_exp_f32 v212, v212
    v_mfma_f32_16x16x32_bf16 v[208:211], a[212:215], v[68:71], v[208:211]
    v_exp_f32 v213, v213
    v_mfma_f32_16x16x32_bf16 v[208:211], a[216:219], v[72:75], v[208:211]
    v_exp_f32 v214, v214
    v_mfma_f32_16x16x32_bf16 v[208:211], a[220:223], v[76:79], v[208:211]
    v_exp_f32 v215, v215
    v_mfma_f32_16x16x32_bf16 a[0:3], a[160:163], v[128:131], a[0:3]
    ds_read_b64_tr_b16 a[172:173], v21 offset:8192
    v_cvt_pk_bf16_f32 v158, v212, v213
    v_mfma_f32_16x16x32_bf16 a[0:3], a[164:167], v[132:135], a[0:3]
    ds_read_b64_tr_b16 a[174:175], v21 offset:12288
    v_mfma_f32_16x16x32_bf16 a[4:7], a[164:167], v[140:143], a[4:7]
    ds_read_b128 a[228:231], v9 offset:20480
    v_cvt_pk_bf16_f32 v159, v214, v215
    v_mfma_f32_16x16x32_bf16 a[4:7], a[160:163], v[136:139], a[4:7]
    v_mfma_f32_16x16x32_bf16 v[212:215], a[208:211], v[80:83], v[196:199]
    v_exp_f32 v208, v208
    v_mfma_f32_16x16x32_bf16 v[212:215], a[212:215], v[84:87], v[212:215]
    v_exp_f32 v209, v209
    v_mfma_f32_16x16x32_bf16 v[212:215], a[216:219], v[88:91], v[212:215]
    v_exp_f32 v210, v210
    v_mfma_f32_16x16x32_bf16 v[212:215], a[220:223], v[92:95], v[212:215]
    v_exp_f32 v211, v211
    v_mfma_f32_16x16x32_bf16 a[8:11], a[160:163], v[144:147], a[8:11]
    ds_read_b64_tr_b16 a[176:177], v22 offset:0
    v_cvt_pk_bf16_f32 v160, v208, v209
    v_mfma_f32_16x16x32_bf16 a[8:11], a[164:167], v[148:151], a[8:11]
    ds_read_b64_tr_b16 a[178:179], v22 offset:4096
    v_mfma_f32_16x16x32_bf16 a[12:15], a[164:167], v[156:159], a[12:15]
    ds_read_b128 a[232:235], v10 offset:20480
    v_cvt_pk_bf16_f32 v161, v210, v211
    v_mfma_f32_16x16x32_bf16 a[12:15], a[160:163], v[152:155], a[12:15]
    s_waitcnt lgkmcnt(3)
    buffer_load_dwordx4 v39, s[8:11], s40 offen offset:3072 lds
    v_mfma_f32_16x16x32_bf16 v[208:211], a[208:211], v[96:99], v[200:203]
    v_exp_f32 v212, v212
    v_mfma_f32_16x16x32_bf16 v[208:211], a[212:215], v[100:103], v[208:211]
    s_add_u32 s40, s40, 16384
    v_exp_f32 v213, v213
    v_mfma_f32_16x16x32_bf16 v[208:211], a[216:219], v[104:107], v[208:211]
    s_mov_b32 m0, s6
    v_exp_f32 v214, v214
    v_mfma_f32_16x16x32_bf16 v[208:211], a[220:223], v[108:111], v[208:211]
    v_exp_f32 v215, v215
    v_mfma_f32_16x16x32_bf16 a[16:19], a[168:171], v[128:131], a[16:19]
    ds_read_b64_tr_b16 a[180:181], v22 offset:8192
    v_cvt_pk_bf16_f32 v168, v212, v213
    v_mfma_f32_16x16x32_bf16 a[16:19], a[172:175], v[132:135], a[16:19]
    ds_read_b64_tr_b16 a[182:183], v22 offset:12288
    v_mfma_f32_16x16x32_bf16 a[20:23], a[172:175], v[140:143], a[20:23]
    ds_read_b128 a[236:239], v11 offset:20480
    v_cvt_pk_bf16_f32 v169, v214, v215
    v_mfma_f32_16x16x32_bf16 a[20:23], a[168:171], v[136:139], a[20:23]
    buffer_load_dwordx4 v254, s[32:35], s57 offen  lds
    v_smfmac_f32_16x16x64_bf16 a[192:195], v[52:55], v[128:135], v50
    v_mfma_f32_16x16x32_bf16 v[212:215], a[208:211], v[112:115], v[204:207]
    v_exp_f32 v208, v208
    v_mfma_f32_16x16x32_bf16 v[212:215], a[212:215], v[116:119], v[212:215]
    s_add_u32 m0, s42, 98304
    v_exp_f32 v209, v209
    v_mfma_f32_16x16x32_bf16 v[212:215], a[216:219], v[120:123], v[212:215]
    v_exp_f32 v210, v210
    v_mfma_f32_16x16x32_bf16 v[212:215], a[220:223], v[124:127], v[212:215]
    v_exp_f32 v211, v211
    v_mfma_f32_16x16x32_bf16 a[24:27], a[168:171], v[144:147], a[24:27]
    ds_read_b64_tr_b16 a[184:185], v23 offset:0
    v_cvt_pk_bf16_f32 v176, v208, v209
    v_mfma_f32_16x16x32_bf16 a[24:27], a[172:175], v[148:151], a[24:27]
    ds_read_b64_tr_b16 a[186:187], v23 offset:4096
    v_mfma_f32_16x16x32_bf16 a[28:31], a[172:175], v[156:159], a[28:31]
    ds_read_b128 a[208:211], v8 offset:24576
    v_cvt_pk_bf16_f32 v177, v210, v211
    v_mfma_f32_16x16x32_bf16 a[28:31], a[168:171], v[152:155], a[28:31]
    s_waitcnt lgkmcnt(3)
    buffer_load_dwordx4 v40, s[12:15], s41 offen lds
    v_mfma_f32_16x16x32_bf16 v[208:211], a[224:227], v[64:67], v[192:195]
    v_exp_f32 v212, v212
    v_mfma_f32_16x16x32_bf16 v[208:211], a[228:231], v[68:71], v[208:211]
    s_add_u32 s6, s6, 4096
    v_exp_f32 v213, v213
    v_mfma_f32_16x16x32_bf16 v[208:211], a[232:235], v[72:75], v[208:211]
    s_add_u32 s57, s57, 589824
    v_exp_f32 v214, v214
    v_mfma_f32_16x16x32_bf16 v[208:211], a[236:239], v[76:79], v[208:211]
    v_exp_f32 v215, v215
    v_mfma_f32_16x16x32_bf16 a[32:35], a[176:179], v[128:131], a[32:35]
    ds_read_b64_tr_b16 a[188:189], v23 offset:8192
    v_cvt_pk_bf16_f32 v184, v212, v213
    v_mfma_f32_16x16x32_bf16 a[32:35], a[180:183], v[132:135], a[32:35]
    ds_read_b64_tr_b16 a[190:191], v23 offset:12288
    v_mfma_f32_16x16x32_bf16 a[36:39], a[180:183], v[140:143], a[36:39]
    ds_read_b128 a[212:215], v9 offset:24576
    v_cvt_pk_bf16_f32 v185, v214, v215
    v_mfma_f32_16x16x32_bf16 a[36:39], a[176:179], v[136:139], a[36:39]
    v_smfmac_f32_16x16x64_bf16 a[196:199], v[52:55], v[136:143], v50
    v_mfma_f32_16x16x32_bf16 v[212:215], a[224:227], v[80:83], v[196:199]
    v_exp_f32 v208, v208
    v_mfma_f32_16x16x32_bf16 v[212:215], a[228:231], v[84:87], v[212:215]
    v_exp_f32 v209, v209
    v_mfma_f32_16x16x32_bf16 v[212:215], a[232:235], v[88:91], v[212:215]
    v_exp_f32 v210, v210
    v_mfma_f32_16x16x32_bf16 v[212:215], a[236:239], v[92:95], v[212:215]
    v_exp_f32 v211, v211
    v_mfma_f32_16x16x32_bf16 a[40:43], a[176:179], v[144:147], a[40:43]
    ds_read_b64_tr_b16 a[160:161], v24 offset:0
    v_cvt_pk_bf16_f32 v162, v208, v209
    v_mfma_f32_16x16x32_bf16 a[40:43], a[180:183], v[148:151], a[40:43]
    ds_read_b64_tr_b16 a[162:163], v24 offset:4096
    v_mfma_f32_16x16x32_bf16 a[44:47], a[180:183], v[156:159], a[44:47]
    ds_read_b128 a[216:219], v10 offset:24576
    v_cvt_pk_bf16_f32 v163, v210, v211
    v_mfma_f32_16x16x32_bf16 a[44:47], a[176:179], v[152:155], a[44:47]
    s_waitcnt lgkmcnt(3)
    buffer_load_dwordx4 v41, s[12:15], s41 offen offset:1024 lds
    v_mfma_f32_16x16x32_bf16 v[208:211], a[224:227], v[96:99], v[200:203]
    v_exp_f32 v212, v212
    v_mfma_f32_16x16x32_bf16 v[208:211], a[228:231], v[100:103], v[208:211]
    v_exp_f32 v213, v213
    v_mfma_f32_16x16x32_bf16 v[208:211], a[232:235], v[104:107], v[208:211]
    v_exp_f32 v214, v214
    v_mfma_f32_16x16x32_bf16 v[208:211], a[236:239], v[108:111], v[208:211]
    v_exp_f32 v215, v215
    v_mfma_f32_16x16x32_bf16 a[48:51], a[184:187], v[128:131], a[48:51]
    ds_read_b64_tr_b16 a[164:165], v24 offset:8192
    v_cvt_pk_bf16_f32 v170, v212, v213
    v_mfma_f32_16x16x32_bf16 a[48:51], a[188:191], v[132:135], a[48:51]
    ds_read_b64_tr_b16 a[166:167], v24 offset:12288
    v_mfma_f32_16x16x32_bf16 a[52:55], a[188:191], v[140:143], a[52:55]
    ds_read_b128 a[220:223], v11 offset:24576
    v_cvt_pk_bf16_f32 v171, v214, v215
    v_mfma_f32_16x16x32_bf16 a[52:55], a[184:187], v[136:139], a[52:55]
    v_smfmac_f32_16x16x64_bf16 a[200:203], v[52:55], v[144:151], v50
    v_mfma_f32_16x16x32_bf16 v[212:215], a[224:227], v[112:115], v[204:207]
    v_exp_f32 v208, v208
    v_mfma_f32_16x16x32_bf16 v[212:215], a[228:231], v[116:119], v[212:215]
    v_exp_f32 v209, v209
    v_mfma_f32_16x16x32_bf16 v[212:215], a[232:235], v[120:123], v[212:215]
    v_exp_f32 v210, v210
    v_mfma_f32_16x16x32_bf16 v[212:215], a[236:239], v[124:127], v[212:215]
    v_exp_f32 v211, v211
    v_mfma_f32_16x16x32_bf16 a[56:59], a[184:187], v[144:147], a[56:59]
    ds_read_b64_tr_b16 a[168:169], v25 offset:0
    v_cvt_pk_bf16_f32 v178, v208, v209
    v_mfma_f32_16x16x32_bf16 a[56:59], a[188:191], v[148:151], a[56:59]
    ds_read_b64_tr_b16 a[170:171], v25 offset:4096
    v_mfma_f32_16x16x32_bf16 a[60:63], a[188:191], v[156:159], a[60:63]
    ds_read_b128 a[224:227], v8 offset:28672
    v_cvt_pk_bf16_f32 v179, v210, v211
    v_mfma_f32_16x16x32_bf16 a[60:63], a[184:187], v[152:155], a[60:63]
    s_waitcnt lgkmcnt(3)
    buffer_load_dwordx4 v40, s[12:15], s41 offen offset:2048 lds
    v_mfma_f32_16x16x32_bf16 v[208:211], a[208:211], v[64:67], v[192:195]
    v_exp_f32 v212, v212
    v_mfma_f32_16x16x32_bf16 v[208:211], a[212:215], v[68:71], v[208:211]
    v_exp_f32 v213, v213
    v_mfma_f32_16x16x32_bf16 v[208:211], a[216:219], v[72:75], v[208:211]
    v_exp_f32 v214, v214
    v_mfma_f32_16x16x32_bf16 v[208:211], a[220:223], v[76:79], v[208:211]
    v_exp_f32 v215, v215
    v_mfma_f32_16x16x32_bf16 a[64:67], a[160:163], v[128:131], a[64:67]
    ds_read_b64_tr_b16 a[172:173], v25 offset:8192
    v_cvt_pk_bf16_f32 v186, v212, v213
    v_mfma_f32_16x16x32_bf16 a[64:67], a[164:167], v[132:135], a[64:67]
    ds_read_b64_tr_b16 a[174:175], v25 offset:12288
    v_mfma_f32_16x16x32_bf16 a[68:71], a[164:167], v[140:143], a[68:71]
    ds_read_b128 a[228:231], v9 offset:28672
    v_cvt_pk_bf16_f32 v187, v214, v215
    v_mfma_f32_16x16x32_bf16 a[68:71], a[160:163], v[136:139], a[68:71]
    v_smfmac_f32_16x16x64_bf16 a[204:207], v[52:55], v[152:159], v50
    v_mfma_f32_16x16x32_bf16 v[212:215], a[208:211], v[80:83], v[196:199]
    v_exp_f32 v208, v208
    v_mfma_f32_16x16x32_bf16 v[212:215], a[212:215], v[84:87], v[212:215]
    v_exp_f32 v209, v209
    v_mfma_f32_16x16x32_bf16 v[212:215], a[216:219], v[88:91], v[212:215]
    v_exp_f32 v210, v210
    v_mfma_f32_16x16x32_bf16 v[212:215], a[220:223], v[92:95], v[212:215]
    v_exp_f32 v211, v211
    v_mfma_f32_16x16x32_bf16 a[72:75], a[160:163], v[144:147], a[72:75]
    ds_read_b64_tr_b16 a[176:177], v26 offset:0
    v_cvt_pk_bf16_f32 v164, v208, v209
    v_mfma_f32_16x16x32_bf16 a[72:75], a[164:167], v[148:151], a[72:75]
    ds_read_b64_tr_b16 a[178:179], v26 offset:4096
    v_mfma_f32_16x16x32_bf16 a[76:79], a[164:167], v[156:159], a[76:79]
    ds_read_b128 a[232:235], v10 offset:28672
    v_cvt_pk_bf16_f32 v165, v210, v211
    v_mfma_f32_16x16x32_bf16 a[76:79], a[160:163], v[152:155], a[76:79]
    s_waitcnt lgkmcnt(3)
    buffer_load_dwordx4 v41, s[12:15], s41 offen offset:3072 lds
    v_mfma_f32_16x16x32_bf16 v[208:211], a[208:211], v[96:99], v[200:203]
    v_exp_f32 v212, v212
    v_mfma_f32_16x16x32_bf16 v[208:211], a[212:215], v[100:103], v[208:211]
    s_add_u32 s41, s41, 16384
    v_exp_f32 v213, v213
    v_mfma_f32_16x16x32_bf16 v[208:211], a[216:219], v[104:107], v[208:211]
    v_exp_f32 v214, v214
    v_mfma_f32_16x16x32_bf16 v[208:211], a[220:223], v[108:111], v[208:211]
    v_exp_f32 v215, v215
    v_mfma_f32_16x16x32_bf16 a[80:83], a[168:171], v[128:131], a[80:83]
    ds_read_b64_tr_b16 a[180:181], v26 offset:8192
    v_cvt_pk_bf16_f32 v172, v212, v213
    v_mfma_f32_16x16x32_bf16 a[80:83], a[172:175], v[132:135], a[80:83]
    ds_read_b64_tr_b16 a[182:183], v26 offset:12288
    v_mfma_f32_16x16x32_bf16 a[84:87], a[172:175], v[140:143], a[84:87]
    ds_read_b128 a[236:239], v11 offset:28672
    v_cvt_pk_bf16_f32 v173, v214, v215
    v_mfma_f32_16x16x32_bf16 a[84:87], a[168:171], v[136:139], a[84:87]
    s_waitcnt vmcnt(10)
    s_barrier
    v_mfma_f32_16x16x32_bf16 v[212:215], a[208:211], v[112:115], v[204:207]
    v_exp_f32 v208, v208
    v_mfma_f32_16x16x32_bf16 v[212:215], a[212:215], v[116:119], v[212:215]
    s_add_u32 m0, s42, 0
    v_exp_f32 v209, v209
    v_mfma_f32_16x16x32_bf16 v[212:215], a[216:219], v[120:123], v[212:215]
    v_exp_f32 v210, v210
    v_mfma_f32_16x16x32_bf16 v[212:215], a[220:223], v[124:127], v[212:215]
    v_exp_f32 v211, v211
    v_mfma_f32_16x16x32_bf16 a[88:91], a[168:171], v[144:147], a[88:91]
    ds_read_b64_tr_b16 a[184:185], v27 offset:0
    v_cvt_pk_bf16_f32 v180, v208, v209
    v_mfma_f32_16x16x32_bf16 a[88:91], a[172:175], v[148:151], a[88:91]
    ds_read_b64_tr_b16 a[186:187], v27 offset:4096
    v_mfma_f32_16x16x32_bf16 a[92:95], a[172:175], v[156:159], a[92:95]
    ds_read_b128 a[208:211], v8 offset:32768
    v_cvt_pk_bf16_f32 v181, v210, v211
    v_mfma_f32_16x16x32_bf16 a[92:95], a[168:171], v[152:155], a[92:95]
    s_waitcnt lgkmcnt(3)
    buffer_load_dwordx4 v36, s[8:11], s40 offen lds
    v_mfma_f32_16x16x32_bf16 v[208:211], a[224:227], v[64:67], v[192:195]
    v_exp_f32 v212, v212
    v_mfma_f32_16x16x32_bf16 v[208:211], a[228:231], v[68:71], v[208:211]
    v_exp_f32 v213, v213
    v_mfma_f32_16x16x32_bf16 v[208:211], a[232:235], v[72:75], v[208:211]
    v_exp_f32 v214, v214
    v_mfma_f32_16x16x32_bf16 v[208:211], a[236:239], v[76:79], v[208:211]
    v_exp_f32 v215, v215
    v_mfma_f32_16x16x32_bf16 a[96:99], a[176:179], v[128:131], a[96:99]
    ds_read_b64_tr_b16 a[188:189], v27 offset:8192
    v_cvt_pk_bf16_f32 v188, v212, v213
    v_mfma_f32_16x16x32_bf16 a[96:99], a[180:183], v[132:135], a[96:99]
    ds_read_b64_tr_b16 a[190:191], v27 offset:12288
    v_mfma_f32_16x16x32_bf16 a[100:103], a[180:183], v[140:143], a[100:103]
    ds_read_b128 a[212:215], v9 offset:32768
    v_cvt_pk_bf16_f32 v189, v214, v215
    v_mfma_f32_16x16x32_bf16 a[100:103], a[176:179], v[136:139], a[100:103]
    v_mfma_f32_16x16x32_bf16 v[212:215], a[224:227], v[80:83], v[196:199]
    v_exp_f32 v208, v208
    v_mfma_f32_16x16x32_bf16 v[212:215], a[228:231], v[84:87], v[212:215]
    v_exp_f32 v209, v209
    v_mfma_f32_16x16x32_bf16 v[212:215], a[232:235], v[88:91], v[212:215]
    v_exp_f32 v210, v210
    v_mfma_f32_16x16x32_bf16 v[212:215], a[236:239], v[92:95], v[212:215]
    v_exp_f32 v211, v211
    v_mfma_f32_16x16x32_bf16 a[104:107], a[176:179], v[144:147], a[104:107]
    ds_read_b64_tr_b16 a[160:161], v20 offset:16384
    v_cvt_pk_bf16_f32 v166, v208, v209
    v_mfma_f32_16x16x32_bf16 a[104:107], a[180:183], v[148:151], a[104:107]
    ds_read_b64_tr_b16 a[162:163], v20 offset:20480
    v_mfma_f32_16x16x32_bf16 a[108:111], a[180:183], v[156:159], a[108:111]
    ds_read_b128 a[216:219], v10 offset:32768
    v_cvt_pk_bf16_f32 v167, v210, v211
    v_mfma_f32_16x16x32_bf16 a[108:111], a[176:179], v[152:155], a[108:111]
    s_waitcnt lgkmcnt(3)
    buffer_load_dwordx4 v37, s[8:11], s40 offen offset:1024 lds
    v_mfma_f32_16x16x32_bf16 v[208:211], a[224:227], v[96:99], v[200:203]
    v_exp_f32 v212, v212
    v_mfma_f32_16x16x32_bf16 v[208:211], a[228:231], v[100:103], v[208:211]
    v_exp_f32 v213, v213
    v_mfma_f32_16x16x32_bf16 v[208:211], a[232:235], v[104:107], v[208:211]
    v_exp_f32 v214, v214
    v_mfma_f32_16x16x32_bf16 v[208:211], a[236:239], v[108:111], v[208:211]
    v_exp_f32 v215, v215
    v_mfma_f32_16x16x32_bf16 a[112:115], a[184:187], v[128:131], a[112:115]
    ds_read_b64_tr_b16 a[164:165], v20 offset:24576
    v_cvt_pk_bf16_f32 v174, v212, v213
    v_mfma_f32_16x16x32_bf16 a[112:115], a[188:191], v[132:135], a[112:115]
    ds_read_b64_tr_b16 a[166:167], v20 offset:28672
    v_mfma_f32_16x16x32_bf16 a[116:119], a[188:191], v[140:143], a[116:119]
    ds_read_b128 a[220:223], v11 offset:32768
    v_cvt_pk_bf16_f32 v175, v214, v215
    v_mfma_f32_16x16x32_bf16 a[116:119], a[184:187], v[136:139], a[116:119]
    buffer_load_dwordx4 v[240:243], v7, s[16:19], s44 offen
    v_mfma_f32_16x16x32_bf16 v[212:215], a[224:227], v[112:115], v[204:207]
    v_exp_f32 v208, v208
    v_mfma_f32_16x16x32_bf16 v[212:215], a[228:231], v[116:119], v[212:215]
    v_exp_f32 v209, v209
    v_mfma_f32_16x16x32_bf16 v[212:215], a[232:235], v[120:123], v[212:215]
    v_exp_f32 v210, v210
    v_mfma_f32_16x16x32_bf16 v[212:215], a[236:239], v[124:127], v[212:215]
    s_add_u32 s44, s44, 884736
    v_exp_f32 v211, v211
    v_mfma_f32_16x16x32_bf16 a[120:123], a[184:187], v[144:147], a[120:123]
    ds_read_b64_tr_b16 a[168:169], v21 offset:16384
    v_cvt_pk_bf16_f32 v182, v208, v209
    v_mfma_f32_16x16x32_bf16 a[120:123], a[188:191], v[148:151], a[120:123]
    ds_read_b64_tr_b16 a[170:171], v21 offset:20480
    v_mfma_f32_16x16x32_bf16 a[124:127], a[188:191], v[156:159], a[124:127]
    ds_read_b128 a[224:227], v8 offset:36864
    v_cvt_pk_bf16_f32 v183, v210, v211
    v_mfma_f32_16x16x32_bf16 a[124:127], a[184:187], v[152:155], a[124:127]
    s_waitcnt lgkmcnt(3)
    buffer_load_dwordx4 v38, s[8:11], s40 offen offset:2048 lds
    v_mfma_f32_16x16x32_bf16 v[208:211], a[208:211], v[64:67], v[192:195]
    v_exp_f32 v212, v212
    v_mfma_f32_16x16x32_bf16 v[208:211], a[212:215], v[68:71], v[208:211]
    v_exp_f32 v213, v213
    v_mfma_f32_16x16x32_bf16 v[208:211], a[216:219], v[72:75], v[208:211]
    v_exp_f32 v214, v214
    v_mfma_f32_16x16x32_bf16 v[208:211], a[220:223], v[76:79], v[208:211]
Ltour0_4:
    s_cbranch_execz Ltour0_8
    v_exp_f32 v215, v215
    v_mfma_f32_16x16x32_bf16 a[0:3], a[160:163], v[160:163], a[0:3]
    ds_read_b64_tr_b16 a[172:173], v21 offset:24576
    v_cvt_pk_bf16_f32 v190, v212, v213
    v_mfma_f32_16x16x32_bf16 a[0:3], a[164:167], v[164:167], a[0:3]
    ds_read_b64_tr_b16 a[174:175], v21 offset:28672
    v_mfma_f32_16x16x32_bf16 a[4:7], a[164:167], v[172:175], a[4:7]
    ds_read_b128 a[228:231], v9 offset:36864
    v_cvt_pk_bf16_f32 v191, v214, v215
    v_mfma_f32_16x16x32_bf16 a[4:7], a[160:163], v[168:171], a[4:7]
    v_mfma_f32_16x16x32_bf16 v[212:215], a[208:211], v[80:83], v[196:199]
    v_exp_f32 v208, v208
    v_mfma_f32_16x16x32_bf16 v[212:215], a[212:215], v[84:87], v[212:215]
    v_exp_f32 v209, v209
    v_mfma_f32_16x16x32_bf16 v[212:215], a[216:219], v[88:91], v[212:215]
    v_exp_f32 v210, v210
    v_mfma_f32_16x16x32_bf16 v[212:215], a[220:223], v[92:95], v[212:215]
    v_exp_f32 v211, v211
    v_mfma_f32_16x16x32_bf16 a[8:11], a[160:163], v[176:179], a[8:11]
    ds_read_b64_tr_b16 a[176:177], v22 offset:16384
    v_cvt_pk_bf16_f32 v128, v208, v209
    v_mfma_f32_16x16x32_bf16 a[8:11], a[164:167], v[180:183], a[8:11]
    ds_read_b64_tr_b16 a[178:179], v22 offset:20480
    v_mfma_f32_16x16x32_bf16 a[12:15], a[164:167], v[188:191], a[12:15]
    ds_read_b128 a[232:235], v10 offset:36864
    v_cvt_pk_bf16_f32 v129, v210, v211
    v_mfma_f32_16x16x32_bf16 a[12:15], a[160:163], v[184:187], a[12:15]
    s_waitcnt lgkmcnt(3)
    buffer_load_dwordx4 v39, s[8:11], s40 offen offset:3072 lds
    v_mfma_f32_16x16x32_bf16 v[208:211], a[208:211], v[96:99], v[200:203]
    v_exp_f32 v212, v212
    v_mfma_f32_16x16x32_bf16 v[208:211], a[212:215], v[100:103], v[208:211]
    s_add_u32 s40, s40, 16384
    v_exp_f32 v213, v213
    v_mfma_f32_16x16x32_bf16 v[208:211], a[216:219], v[104:107], v[208:211]
    v_exp_f32 v214, v214
    v_mfma_f32_16x16x32_bf16 v[208:211], a[220:223], v[108:111], v[208:211]
    v_exp_f32 v215, v215
    v_mfma_f32_16x16x32_bf16 a[16:19], a[168:171], v[160:163], a[16:19]
    ds_read_b64_tr_b16 a[180:181], v22 offset:24576
    v_cvt_pk_bf16_f32 v136, v212, v213
    v_mfma_f32_16x16x32_bf16 a[16:19], a[172:175], v[164:167], a[16:19]
    ds_read_b64_tr_b16 a[182:183], v22 offset:28672
    v_mfma_f32_16x16x32_bf16 a[20:23], a[172:175], v[172:175], a[20:23]
    ds_read_b128 a[236:239], v11 offset:36864
    v_cvt_pk_bf16_f32 v137, v214, v215
    v_mfma_f32_16x16x32_bf16 a[20:23], a[168:171], v[168:171], a[20:23]
    v_smfmac_f32_16x16x64_bf16 a[192:195], v[52:55], v[160:167], v50
    v_mfma_f32_16x16x32_bf16 v[212:215], a[208:211], v[112:115], v[204:207]
    v_exp_f32 v208, v208
    v_mfma_f32_16x16x32_bf16 v[212:215], a[212:215], v[116:119], v[212:215]
    s_add_u32 m0, s42, 114688
    v_exp_f32 v209, v209
    v_mfma_f32_16x16x32_bf16 v[212:215], a[216:219], v[120:123], v[212:215]
    v_exp_f32 v210, v210
    v_mfma_f32_16x16x32_bf16 v[212:215], a[220:223], v[124:127], v[212:215]
    v_exp_f32 v211, v211
    v_mfma_f32_16x16x32_bf16 a[24:27], a[168:171], v[176:179], a[24:27]
    ds_read_b64_tr_b16 a[184:185], v23 offset:16384
    v_cvt_pk_bf16_f32 v144, v208, v209
    v_mfma_f32_16x16x32_bf16 a[24:27], a[172:175], v[180:183], a[24:27]
    ds_read_b64_tr_b16 a[186:187], v23 offset:20480
    v_mfma_f32_16x16x32_bf16 a[28:31], a[172:175], v[188:191], a[28:31]
    ds_read_b128 a[208:211], v8 offset:40960
    v_cvt_pk_bf16_f32 v145, v210, v211
    v_mfma_f32_16x16x32_bf16 a[28:31], a[168:171], v[184:187], a[28:31]
    s_waitcnt lgkmcnt(3)
    buffer_load_dwordx4 v40, s[12:15], s41 offen lds
    v_mfma_f32_16x16x32_bf16 v[208:211], a[224:227], v[64:67], v[192:195]
    v_exp_f32 v212, v212
    v_mfma_f32_16x16x32_bf16 v[208:211], a[228:231], v[68:71], v[208:211]
    v_exp_f32 v213, v213
    v_mfma_f32_16x16x32_bf16 v[208:211], a[232:235], v[72:75], v[208:211]
    v_exp_f32 v214, v214
    v_mfma_f32_16x16x32_bf16 v[208:211], a[236:239], v[76:79], v[208:211]
    v_exp_f32 v215, v215
    v_mfma_f32_16x16x32_bf16 a[32:35], a[176:179], v[160:163], a[32:35]
    ds_read_b64_tr_b16 a[188:189], v23 offset:24576
    v_cvt_pk_bf16_f32 v152, v212, v213
    v_mfma_f32_16x16x32_bf16 a[32:35], a[180:183], v[164:167], a[32:35]
    ds_read_b64_tr_b16 a[190:191], v23 offset:28672
    v_mfma_f32_16x16x32_bf16 a[36:39], a[180:183], v[172:175], a[36:39]
    ds_read_b128 a[212:215], v9 offset:40960
    v_cvt_pk_bf16_f32 v153, v214, v215
    v_mfma_f32_16x16x32_bf16 a[36:39], a[176:179], v[168:171], a[36:39]
    v_smfmac_f32_16x16x64_bf16 a[196:199], v[52:55], v[168:175], v50
    v_mfma_f32_16x16x32_bf16 v[212:215], a[224:227], v[80:83], v[196:199]
    v_exp_f32 v208, v208
    v_mfma_f32_16x16x32_bf16 v[212:215], a[228:231], v[84:87], v[212:215]
    v_exp_f32 v209, v209
    v_mfma_f32_16x16x32_bf16 v[212:215], a[232:235], v[88:91], v[212:215]
    v_exp_f32 v210, v210
    v_mfma_f32_16x16x32_bf16 v[212:215], a[236:239], v[92:95], v[212:215]
    v_exp_f32 v211, v211
    v_mfma_f32_16x16x32_bf16 a[40:43], a[176:179], v[176:179], a[40:43]
    ds_read_b64_tr_b16 a[160:161], v24 offset:16384
    v_cvt_pk_bf16_f32 v130, v208, v209
    v_mfma_f32_16x16x32_bf16 a[40:43], a[180:183], v[180:183], a[40:43]
    ds_read_b64_tr_b16 a[162:163], v24 offset:20480
    v_mfma_f32_16x16x32_bf16 a[44:47], a[180:183], v[188:191], a[44:47]
    ds_read_b128 a[216:219], v10 offset:40960
    v_cvt_pk_bf16_f32 v131, v210, v211
    v_mfma_f32_16x16x32_bf16 a[44:47], a[176:179], v[184:187], a[44:47]
    s_waitcnt lgkmcnt(3)
    buffer_load_dwordx4 v41, s[12:15], s41 offen offset:1024 lds
    v_mfma_f32_16x16x32_bf16 v[208:211], a[224:227], v[96:99], v[200:203]
    v_exp_f32 v212, v212
    v_mfma_f32_16x16x32_bf16 v[208:211], a[228:231], v[100:103], v[208:211]
    v_exp_f32 v213, v213
    v_mfma_f32_16x16x32_bf16 v[208:211], a[232:235], v[104:107], v[208:211]
    v_exp_f32 v214, v214
    v_mfma_f32_16x16x32_bf16 v[208:211], a[236:239], v[108:111], v[208:211]
    v_exp_f32 v215, v215
    v_mfma_f32_16x16x32_bf16 a[48:51], a[184:187], v[160:163], a[48:51]
    ds_read_b64_tr_b16 a[164:165], v24 offset:24576
    v_cvt_pk_bf16_f32 v138, v212, v213
    v_mfma_f32_16x16x32_bf16 a[48:51], a[188:191], v[164:167], a[48:51]
    ds_read_b64_tr_b16 a[166:167], v24 offset:28672
    v_mfma_f32_16x16x32_bf16 a[52:55], a[188:191], v[172:175], a[52:55]
    ds_read_b128 a[220:223], v11 offset:40960
    v_cvt_pk_bf16_f32 v139, v214, v215
    v_mfma_f32_16x16x32_bf16 a[52:55], a[184:187], v[168:171], a[52:55]
    v_smfmac_f32_16x16x64_bf16 a[200:203], v[52:55], v[176:183], v50
    v_mfma_f32_16x16x32_bf16 v[212:215], a[224:227], v[112:115], v[204:207]
    v_exp_f32 v208, v208
    v_mfma_f32_16x16x32_bf16 v[212:215], a[228:231], v[116:119], v[212:215]
    v_exp_f32 v209, v209
    v_mfma_f32_16x16x32_bf16 v[212:215], a[232:235], v[120:123], v[212:215]
    v_exp_f32 v210, v210
    v_mfma_f32_16x16x32_bf16 v[212:215], a[236:239], v[124:127], v[212:215]
    v_exp_f32 v211, v211
    v_mfma_f32_16x16x32_bf16 a[56:59], a[184:187], v[176:179], a[56:59]
    ds_read_b64_tr_b16 a[168:169], v25 offset:16384
    v_cvt_pk_bf16_f32 v146, v208, v209
    v_mfma_f32_16x16x32_bf16 a[56:59], a[188:191], v[180:183], a[56:59]
    ds_read_b64_tr_b16 a[170:171], v25 offset:20480
    v_mfma_f32_16x16x32_bf16 a[60:63], a[188:191], v[188:191], a[60:63]
    ds_read_b128 a[224:227], v8 offset:45056
    v_cvt_pk_bf16_f32 v147, v210, v211
    v_mfma_f32_16x16x32_bf16 a[60:63], a[184:187], v[184:187], a[60:63]
    s_waitcnt lgkmcnt(3)
    buffer_load_dwordx4 v40, s[12:15], s41 offen offset:2048 lds
    v_mfma_f32_16x16x32_bf16 v[208:211], a[208:211], v[64:67], v[192:195]
    v_exp_f32 v212, v212
    v_mfma_f32_16x16x32_bf16 v[208:211], a[212:215], v[68:71], v[208:211]
    v_exp_f32 v213, v213
    v_mfma_f32_16x16x32_bf16 v[208:211], a[216:219], v[72:75], v[208:211]
    v_exp_f32 v214, v214
    v_mfma_f32_16x16x32_bf16 v[208:211], a[220:223], v[76:79], v[208:211]
    v_exp_f32 v215, v215
    v_mfma_f32_16x16x32_bf16 a[64:67], a[160:163], v[160:163], a[64:67]
    ds_read_b64_tr_b16 a[172:173], v25 offset:24576
    v_cvt_pk_bf16_f32 v154, v212, v213
    v_mfma_f32_16x16x32_bf16 a[64:67], a[164:167], v[164:167], a[64:67]
    ds_read_b64_tr_b16 a[174:175], v25 offset:28672
    v_mfma_f32_16x16x32_bf16 a[68:71], a[164:167], v[172:175], a[68:71]
    ds_read_b128 a[228:231], v9 offset:45056
    v_cvt_pk_bf16_f32 v155, v214, v215
    v_mfma_f32_16x16x32_bf16 a[68:71], a[160:163], v[168:171], a[68:71]
    v_smfmac_f32_16x16x64_bf16 a[204:207], v[52:55], v[184:191], v50
    v_mfma_f32_16x16x32_bf16 v[212:215], a[208:211], v[80:83], v[196:199]
    v_exp_f32 v208, v208
    v_mfma_f32_16x16x32_bf16 v[212:215], a[212:215], v[84:87], v[212:215]
    v_exp_f32 v209, v209
    v_mfma_f32_16x16x32_bf16 v[212:215], a[216:219], v[88:91], v[212:215]
    v_exp_f32 v210, v210
    v_mfma_f32_16x16x32_bf16 v[212:215], a[220:223], v[92:95], v[212:215]
    v_exp_f32 v211, v211
    v_mfma_f32_16x16x32_bf16 a[72:75], a[160:163], v[176:179], a[72:75]
    ds_read_b64_tr_b16 a[176:177], v26 offset:16384
    v_cvt_pk_bf16_f32 v132, v208, v209
    v_mfma_f32_16x16x32_bf16 a[72:75], a[164:167], v[180:183], a[72:75]
    ds_read_b64_tr_b16 a[178:179], v26 offset:20480
    v_mfma_f32_16x16x32_bf16 a[76:79], a[164:167], v[188:191], a[76:79]
    ds_read_b128 a[232:235], v10 offset:45056
    v_cvt_pk_bf16_f32 v133, v210, v211
    v_mfma_f32_16x16x32_bf16 a[76:79], a[160:163], v[184:187], a[76:79]
    s_waitcnt lgkmcnt(3)
    buffer_load_dwordx4 v41, s[12:15], s41 offen offset:3072 lds
    v_mfma_f32_16x16x32_bf16 v[208:211], a[208:211], v[96:99], v[200:203]
    v_exp_f32 v212, v212
    v_mfma_f32_16x16x32_bf16 v[208:211], a[212:215], v[100:103], v[208:211]
    s_add_u32 s41, s41, 16384
    v_exp_f32 v213, v213
    v_mfma_f32_16x16x32_bf16 v[208:211], a[216:219], v[104:107], v[208:211]
    v_exp_f32 v214, v214
    v_mfma_f32_16x16x32_bf16 v[208:211], a[220:223], v[108:111], v[208:211]
    v_exp_f32 v215, v215
    v_mfma_f32_16x16x32_bf16 a[80:83], a[168:171], v[160:163], a[80:83]
    ds_read_b64_tr_b16 a[180:181], v26 offset:24576
    v_cvt_pk_bf16_f32 v140, v212, v213
    v_mfma_f32_16x16x32_bf16 a[80:83], a[172:175], v[164:167], a[80:83]
    ds_read_b64_tr_b16 a[182:183], v26 offset:28672
    v_mfma_f32_16x16x32_bf16 a[84:87], a[172:175], v[172:175], a[84:87]
    ds_read_b128 a[236:239], v11 offset:45056
    v_cvt_pk_bf16_f32 v141, v214, v215
    v_mfma_f32_16x16x32_bf16 a[84:87], a[168:171], v[168:171], a[84:87]
    s_waitcnt vmcnt(9)
    s_barrier
    v_mfma_f32_16x16x32_bf16 v[212:215], a[208:211], v[112:115], v[204:207]
    v_exp_f32 v208, v208
    v_mfma_f32_16x16x32_bf16 v[212:215], a[212:215], v[116:119], v[212:215]
    s_add_u32 m0, s42, 16384
    v_exp_f32 v209, v209
    v_mfma_f32_16x16x32_bf16 v[212:215], a[216:219], v[120:123], v[212:215]
    v_exp_f32 v210, v210
    v_mfma_f32_16x16x32_bf16 v[212:215], a[220:223], v[124:127], v[212:215]
    v_exp_f32 v211, v211
    v_mfma_f32_16x16x32_bf16 a[88:91], a[168:171], v[176:179], a[88:91]
    ds_read_b64_tr_b16 a[184:185], v27 offset:16384
    v_cvt_pk_bf16_f32 v148, v208, v209
    v_mfma_f32_16x16x32_bf16 a[88:91], a[172:175], v[180:183], a[88:91]
    ds_read_b64_tr_b16 a[186:187], v27 offset:20480
    v_mfma_f32_16x16x32_bf16 a[92:95], a[172:175], v[188:191], a[92:95]
    ds_read_b128 a[208:211], v8 offset:49152
    v_cvt_pk_bf16_f32 v149, v210, v211
    v_mfma_f32_16x16x32_bf16 a[92:95], a[168:171], v[184:187], a[92:95]
    s_waitcnt lgkmcnt(3)
    buffer_load_dwordx4 v36, s[8:11], s40 offen lds
    v_mfma_f32_16x16x32_bf16 v[208:211], a[224:227], v[64:67], v[192:195]
    v_exp_f32 v212, v212
    v_mfma_f32_16x16x32_bf16 v[208:211], a[228:231], v[68:71], v[208:211]
    v_exp_f32 v213, v213
    v_mfma_f32_16x16x32_bf16 v[208:211], a[232:235], v[72:75], v[208:211]
    v_exp_f32 v214, v214
    v_mfma_f32_16x16x32_bf16 v[208:211], a[236:239], v[76:79], v[208:211]
    v_exp_f32 v215, v215
    v_mfma_f32_16x16x32_bf16 a[96:99], a[176:179], v[160:163], a[96:99]
    ds_read_b64_tr_b16 a[188:189], v27 offset:24576
    v_cvt_pk_bf16_f32 v156, v212, v213
    v_mfma_f32_16x16x32_bf16 a[96:99], a[180:183], v[164:167], a[96:99]
    ds_read_b64_tr_b16 a[190:191], v27 offset:28672
    v_mfma_f32_16x16x32_bf16 a[100:103], a[180:183], v[172:175], a[100:103]
    ds_read_b128 a[212:215], v9 offset:49152
    v_cvt_pk_bf16_f32 v157, v214, v215
    v_mfma_f32_16x16x32_bf16 a[100:103], a[176:179], v[168:171], a[100:103]
    buffer_load_dword v218, v57, s[80:83], s39 offen
    v_mfma_f32_16x16x32_bf16 v[212:215], a[224:227], v[80:83], v[196:199]
    v_exp_f32 v208, v208
    v_mfma_f32_16x16x32_bf16 v[212:215], a[228:231], v[84:87], v[212:215]
    v_exp_f32 v209, v209
    v_mfma_f32_16x16x32_bf16 v[212:215], a[232:235], v[88:91], v[212:215]
    v_exp_f32 v210, v210
    v_mfma_f32_16x16x32_bf16 v[212:215], a[236:239], v[92:95], v[212:215]
    v_exp_f32 v211, v211
    v_mfma_f32_16x16x32_bf16 a[104:107], a[176:179], v[176:179], a[104:107]
    ds_read_b64_tr_b16 a[160:161], v20 offset:32768
    v_cvt_pk_bf16_f32 v134, v208, v209
    v_mfma_f32_16x16x32_bf16 a[104:107], a[180:183], v[180:183], a[104:107]
    ds_read_b64_tr_b16 a[162:163], v20 offset:36864
    v_mfma_f32_16x16x32_bf16 a[108:111], a[180:183], v[188:191], a[108:111]
    ds_read_b128 a[216:219], v10 offset:49152
    v_cvt_pk_bf16_f32 v135, v210, v211
    v_mfma_f32_16x16x32_bf16 a[108:111], a[176:179], v[184:187], a[108:111]
    s_waitcnt lgkmcnt(3)
    buffer_load_dwordx4 v37, s[8:11], s40 offen offset:1024 lds
    v_mfma_f32_16x16x32_bf16 v[208:211], a[224:227], v[96:99], v[200:203]
    v_exp_f32 v212, v212
    v_mfma_f32_16x16x32_bf16 v[208:211], a[228:231], v[100:103], v[208:211]
    v_exp_f32 v213, v213
    v_mfma_f32_16x16x32_bf16 v[208:211], a[232:235], v[104:107], v[208:211]
    v_exp_f32 v214, v214
    v_mfma_f32_16x16x32_bf16 v[208:211], a[236:239], v[108:111], v[208:211]
    v_exp_f32 v215, v215
    v_mfma_f32_16x16x32_bf16 a[112:115], a[184:187], v[160:163], a[112:115]
    ds_read_b64_tr_b16 a[164:165], v20 offset:40960
    v_cvt_pk_bf16_f32 v142, v212, v213
    v_mfma_f32_16x16x32_bf16 a[112:115], a[188:191], v[164:167], a[112:115]
    ds_read_b64_tr_b16 a[166:167], v20 offset:45056
    v_mfma_f32_16x16x32_bf16 a[116:119], a[188:191], v[172:175], a[116:119]
    ds_read_b128 a[220:223], v11 offset:49152
    v_cvt_pk_bf16_f32 v143, v214, v215
    v_mfma_f32_16x16x32_bf16 a[116:119], a[184:187], v[168:171], a[116:119]
    buffer_store_dwordx4 v[248:251], v232, s[24:27], s53 offen sc1
    v_mfma_f32_16x16x32_bf16 v[212:215], a[224:227], v[112:115], v[204:207]
    v_exp_f32 v208, v208
    v_mfma_f32_16x16x32_bf16 v[212:215], a[228:231], v[116:119], v[212:215]
    v_exp_f32 v209, v209
    v_mfma_f32_16x16x32_bf16 v[212:215], a[232:235], v[120:123], v[212:215]
    v_exp_f32 v210, v210
    v_mfma_f32_16x16x32_bf16 v[212:215], a[236:239], v[124:127], v[212:215]
    s_add_u32 s53, s53, 656
    v_exp_f32 v211, v211
    v_mfma_f32_16x16x32_bf16 a[120:123], a[184:187], v[176:179], a[120:123]
    ds_read_b64_tr_b16 a[168:169], v21 offset:32768
    v_cvt_pk_bf16_f32 v150, v208, v209
    v_mfma_f32_16x16x32_bf16 a[120:123], a[188:191], v[180:183], a[120:123]
    ds_read_b64_tr_b16 a[170:171], v21 offset:36864
    v_mfma_f32_16x16x32_bf16 a[124:127], a[188:191], v[188:191], a[124:127]
    ds_read_b128 a[224:227], v8 offset:53248
    v_cvt_pk_bf16_f32 v151, v210, v211
    v_mfma_f32_16x16x32_bf16 a[124:127], a[184:187], v[184:187], a[124:127]
    s_waitcnt lgkmcnt(3)
    buffer_load_dwordx4 v38, s[8:11], s40 offen offset:2048 lds
    v_mfma_f32_16x16x32_bf16 v[208:211], a[208:211], v[64:67], v[192:195]
    v_exp_f32 v212, v212
    v_mfma_f32_16x16x32_bf16 v[208:211], a[212:215], v[68:71], v[208:211]
    v_exp_f32 v213, v213
    v_mfma_f32_16x16x32_bf16 v[208:211], a[216:219], v[72:75], v[208:211]
    v_exp_f32 v214, v214
    v_mfma_f32_16x16x32_bf16 v[208:211], a[220:223], v[76:79], v[208:211]
    v_exp_f32 v215, v215
    v_mfma_f32_16x16x32_bf16 a[0:3], a[160:163], v[128:131], a[0:3]
    ds_read_b64_tr_b16 a[172:173], v21 offset:40960
    v_cvt_pk_bf16_f32 v158, v212, v213
    v_mfma_f32_16x16x32_bf16 a[0:3], a[164:167], v[132:135], a[0:3]
    ds_read_b64_tr_b16 a[174:175], v21 offset:45056
    v_mfma_f32_16x16x32_bf16 a[4:7], a[164:167], v[140:143], a[4:7]
    ds_read_b128 a[228:231], v9 offset:53248
    v_cvt_pk_bf16_f32 v159, v214, v215
    v_mfma_f32_16x16x32_bf16 a[4:7], a[160:163], v[136:139], a[4:7]
    v_mfma_f32_16x16x32_bf16 v[212:215], a[208:211], v[80:83], v[196:199]
    v_exp_f32 v208, v208
    v_mfma_f32_16x16x32_bf16 v[212:215], a[212:215], v[84:87], v[212:215]
    v_exp_f32 v209, v209
    v_mfma_f32_16x16x32_bf16 v[212:215], a[216:219], v[88:91], v[212:215]
    v_exp_f32 v210, v210
    v_mfma_f32_16x16x32_bf16 v[212:215], a[220:223], v[92:95], v[212:215]
    v_exp_f32 v211, v211
    v_mfma_f32_16x16x32_bf16 a[8:11], a[160:163], v[144:147], a[8:11]
    ds_read_b64_tr_b16 a[176:177], v22 offset:32768
    v_cvt_pk_bf16_f32 v160, v208, v209
    v_mfma_f32_16x16x32_bf16 a[8:11], a[164:167], v[148:151], a[8:11]
    ds_read_b64_tr_b16 a[178:179], v22 offset:36864
    v_mfma_f32_16x16x32_bf16 a[12:15], a[164:167], v[156:159], a[12:15]
    ds_read_b128 a[232:235], v10 offset:53248
    v_cvt_pk_bf16_f32 v161, v210, v211
    v_mfma_f32_16x16x32_bf16 a[12:15], a[160:163], v[152:155], a[12:15]
    s_waitcnt lgkmcnt(3)
    buffer_load_dwordx4 v39, s[8:11], s40 offen offset:3072 lds
    v_mfma_f32_16x16x32_bf16 v[208:211], a[208:211], v[96:99], v[200:203]
    v_exp_f32 v212, v212
    v_mfma_f32_16x16x32_bf16 v[208:211], a[212:215], v[100:103], v[208:211]
    s_add_u32 s40, s40, 16384
    v_exp_f32 v213, v213
    v_mfma_f32_16x16x32_bf16 v[208:211], a[216:219], v[104:107], v[208:211]
    v_exp_f32 v214, v214
    v_mfma_f32_16x16x32_bf16 v[208:211], a[220:223], v[108:111], v[208:211]
    v_exp_f32 v215, v215
    v_mfma_f32_16x16x32_bf16 a[16:19], a[168:171], v[128:131], a[16:19]
    ds_read_b64_tr_b16 a[180:181], v22 offset:40960
    v_cvt_pk_bf16_f32 v168, v212, v213
    v_mfma_f32_16x16x32_bf16 a[16:19], a[172:175], v[132:135], a[16:19]
    ds_read_b64_tr_b16 a[182:183], v22 offset:45056
    v_mfma_f32_16x16x32_bf16 a[20:23], a[172:175], v[140:143], a[20:23]
    ds_read_b128 a[236:239], v11 offset:53248
    v_cvt_pk_bf16_f32 v169, v214, v215
    v_mfma_f32_16x16x32_bf16 a[20:23], a[168:171], v[136:139], a[20:23]
    v_smfmac_f32_16x16x64_bf16 a[192:195], v[52:55], v[128:135], v50
    v_mfma_f32_16x16x32_bf16 v[212:215], a[208:211], v[112:115], v[204:207]
    v_exp_f32 v208, v208
    v_mfma_f32_16x16x32_bf16 v[212:215], a[212:215], v[116:119], v[212:215]
    s_add_u32 m0, s42, 65536
    v_exp_f32 v209, v209
    v_mfma_f32_16x16x32_bf16 v[212:215], a[216:219], v[120:123], v[212:215]
    v_exp_f32 v210, v210
    v_mfma_f32_16x16x32_bf16 v[212:215], a[220:223], v[124:127], v[212:215]
    v_exp_f32 v211, v211
    v_mfma_f32_16x16x32_bf16 a[24:27], a[168:171], v[144:147], a[24:27]
    ds_read_b64_tr_b16 a[184:185], v23 offset:32768
    v_cvt_pk_bf16_f32 v176, v208, v209
    v_mfma_f32_16x16x32_bf16 a[24:27], a[172:175], v[148:151], a[24:27]
    ds_read_b64_tr_b16 a[186:187], v23 offset:36864
    v_mfma_f32_16x16x32_bf16 a[28:31], a[172:175], v[156:159], a[28:31]
    ds_read_b128 a[208:211], v8 offset:57344
    v_cvt_pk_bf16_f32 v177, v210, v211
    v_mfma_f32_16x16x32_bf16 a[28:31], a[168:171], v[152:155], a[28:31]
    s_waitcnt lgkmcnt(3)
    buffer_load_dwordx4 v40, s[12:15], s41 offen lds
    v_mfma_f32_16x16x32_bf16 v[208:211], a[224:227], v[64:67], v[192:195]
    v_exp_f32 v212, v212
    v_mfma_f32_16x16x32_bf16 v[208:211], a[228:231], v[68:71], v[208:211]
    v_exp_f32 v213, v213
    v_mfma_f32_16x16x32_bf16 v[208:211], a[232:235], v[72:75], v[208:211]
    v_exp_f32 v214, v214
    v_mfma_f32_16x16x32_bf16 v[208:211], a[236:239], v[76:79], v[208:211]
    v_exp_f32 v215, v215
    v_mfma_f32_16x16x32_bf16 a[32:35], a[176:179], v[128:131], a[32:35]
    ds_read_b64_tr_b16 a[188:189], v23 offset:40960
    v_cvt_pk_bf16_f32 v184, v212, v213
    v_mfma_f32_16x16x32_bf16 a[32:35], a[180:183], v[132:135], a[32:35]
    ds_read_b64_tr_b16 a[190:191], v23 offset:45056
    v_mfma_f32_16x16x32_bf16 a[36:39], a[180:183], v[140:143], a[36:39]
    ds_read_b128 a[212:215], v9 offset:57344
    v_cvt_pk_bf16_f32 v185, v214, v215
    v_mfma_f32_16x16x32_bf16 a[36:39], a[176:179], v[136:139], a[36:39]
    v_smfmac_f32_16x16x64_bf16 a[196:199], v[52:55], v[136:143], v50
    v_mfma_f32_16x16x32_bf16 v[212:215], a[224:227], v[80:83], v[196:199]
    v_exp_f32 v208, v208
    v_mfma_f32_16x16x32_bf16 v[212:215], a[228:231], v[84:87], v[212:215]
    v_exp_f32 v209, v209
    v_mfma_f32_16x16x32_bf16 v[212:215], a[232:235], v[88:91], v[212:215]
    v_exp_f32 v210, v210
    v_mfma_f32_16x16x32_bf16 v[212:215], a[236:239], v[92:95], v[212:215]
    v_exp_f32 v211, v211
    v_mfma_f32_16x16x32_bf16 a[40:43], a[176:179], v[144:147], a[40:43]
    ds_read_b64_tr_b16 a[160:161], v24 offset:32768
    v_cvt_pk_bf16_f32 v162, v208, v209
    v_mfma_f32_16x16x32_bf16 a[40:43], a[180:183], v[148:151], a[40:43]
    ds_read_b64_tr_b16 a[162:163], v24 offset:36864
    v_mfma_f32_16x16x32_bf16 a[44:47], a[180:183], v[156:159], a[44:47]
    ds_read_b128 a[216:219], v10 offset:57344
    v_cvt_pk_bf16_f32 v163, v210, v211
    v_mfma_f32_16x16x32_bf16 a[44:47], a[176:179], v[152:155], a[44:47]
    s_waitcnt lgkmcnt(3)
    buffer_load_dwordx4 v41, s[12:15], s41 offen offset:1024 lds
    v_mfma_f32_16x16x32_bf16 v[208:211], a[224:227], v[96:99], v[200:203]
    v_exp_f32 v212, v212
    v_mfma_f32_16x16x32_bf16 v[208:211], a[228:231], v[100:103], v[208:211]
    v_exp_f32 v213, v213
    v_mfma_f32_16x16x32_bf16 v[208:211], a[232:235], v[104:107], v[208:211]
    v_exp_f32 v214, v214
    v_mfma_f32_16x16x32_bf16 v[208:211], a[236:239], v[108:111], v[208:211]
    v_exp_f32 v215, v215
    v_mfma_f32_16x16x32_bf16 a[48:51], a[184:187], v[128:131], a[48:51]
    ds_read_b64_tr_b16 a[164:165], v24 offset:40960
    v_cvt_pk_bf16_f32 v170, v212, v213
    v_mfma_f32_16x16x32_bf16 a[48:51], a[188:191], v[132:135], a[48:51]
    ds_read_b64_tr_b16 a[166:167], v24 offset:45056
    v_mfma_f32_16x16x32_bf16 a[52:55], a[188:191], v[140:143], a[52:55]
    ds_read_b128 a[220:223], v11 offset:57344
    v_cvt_pk_bf16_f32 v171, v214, v215
    v_mfma_f32_16x16x32_bf16 a[52:55], a[184:187], v[136:139], a[52:55]
    v_smfmac_f32_16x16x64_bf16 a[200:203], v[52:55], v[144:151], v50
    v_mfma_f32_16x16x32_bf16 v[212:215], a[224:227], v[112:115], v[204:207]
    v_exp_f32 v208, v208
    v_mfma_f32_16x16x32_bf16 v[212:215], a[228:231], v[116:119], v[212:215]
    v_exp_f32 v209, v209
    v_mfma_f32_16x16x32_bf16 v[212:215], a[232:235], v[120:123], v[212:215]
    v_exp_f32 v210, v210
    v_mfma_f32_16x16x32_bf16 v[212:215], a[236:239], v[124:127], v[212:215]
    v_exp_f32 v211, v211
    v_mfma_f32_16x16x32_bf16 a[56:59], a[184:187], v[144:147], a[56:59]
    ds_read_b64_tr_b16 a[168:169], v25 offset:32768
    v_cvt_pk_bf16_f32 v178, v208, v209
    v_mfma_f32_16x16x32_bf16 a[56:59], a[188:191], v[148:151], a[56:59]
    ds_read_b64_tr_b16 a[170:171], v25 offset:36864
    v_mfma_f32_16x16x32_bf16 a[60:63], a[188:191], v[156:159], a[60:63]
    ds_read_b128 a[224:227], v8 offset:61440
    v_cvt_pk_bf16_f32 v179, v210, v211
    v_mfma_f32_16x16x32_bf16 a[60:63], a[184:187], v[152:155], a[60:63]
    s_waitcnt lgkmcnt(3)
    buffer_load_dwordx4 v40, s[12:15], s41 offen offset:2048 lds
    v_mfma_f32_16x16x32_bf16 v[208:211], a[208:211], v[64:67], v[192:195]
    v_exp_f32 v212, v212
    v_mfma_f32_16x16x32_bf16 v[208:211], a[212:215], v[68:71], v[208:211]
    v_exp_f32 v213, v213
    v_mfma_f32_16x16x32_bf16 v[208:211], a[216:219], v[72:75], v[208:211]
    v_exp_f32 v214, v214
    v_mfma_f32_16x16x32_bf16 v[208:211], a[220:223], v[76:79], v[208:211]
    v_exp_f32 v215, v215
    v_mfma_f32_16x16x32_bf16 a[64:67], a[160:163], v[128:131], a[64:67]
    ds_read_b64_tr_b16 a[172:173], v25 offset:40960
    v_cvt_pk_bf16_f32 v186, v212, v213
    v_mfma_f32_16x16x32_bf16 a[64:67], a[164:167], v[132:135], a[64:67]
    ds_read_b64_tr_b16 a[174:175], v25 offset:45056
    v_mfma_f32_16x16x32_bf16 a[68:71], a[164:167], v[140:143], a[68:71]
    ds_read_b128 a[228:231], v9 offset:61440
    v_cvt_pk_bf16_f32 v187, v214, v215
    v_mfma_f32_16x16x32_bf16 a[68:71], a[160:163], v[136:139], a[68:71]
    v_smfmac_f32_16x16x64_bf16 a[204:207], v[52:55], v[152:159], v50
    v_mfma_f32_16x16x32_bf16 v[212:215], a[208:211], v[80:83], v[196:199]
    v_exp_f32 v208, v208
    v_mfma_f32_16x16x32_bf16 v[212:215], a[212:215], v[84:87], v[212:215]
    v_exp_f32 v209, v209
    v_mfma_f32_16x16x32_bf16 v[212:215], a[216:219], v[88:91], v[212:215]
    v_exp_f32 v210, v210
    v_mfma_f32_16x16x32_bf16 v[212:215], a[220:223], v[92:95], v[212:215]
    v_exp_f32 v211, v211
    v_mfma_f32_16x16x32_bf16 a[72:75], a[160:163], v[144:147], a[72:75]
    ds_read_b64_tr_b16 a[176:177], v26 offset:32768
    v_cvt_pk_bf16_f32 v164, v208, v209
    v_mfma_f32_16x16x32_bf16 a[72:75], a[164:167], v[148:151], a[72:75]
    ds_read_b64_tr_b16 a[178:179], v26 offset:36864
    v_mfma_f32_16x16x32_bf16 a[76:79], a[164:167], v[156:159], a[76:79]
    ds_read_b128 a[232:235], v10 offset:61440
    v_cvt_pk_bf16_f32 v165, v210, v211
    v_mfma_f32_16x16x32_bf16 a[76:79], a[160:163], v[152:155], a[76:79]
    s_waitcnt lgkmcnt(3)
    buffer_load_dwordx4 v41, s[12:15], s41 offen offset:3072 lds
    v_mfma_f32_16x16x32_bf16 v[208:211], a[208:211], v[96:99], v[200:203]
    v_exp_f32 v212, v212
    v_mfma_f32_16x16x32_bf16 v[208:211], a[212:215], v[100:103], v[208:211]
    s_add_u32 s41, s41, 16384
    v_exp_f32 v213, v213
    v_mfma_f32_16x16x32_bf16 v[208:211], a[216:219], v[104:107], v[208:211]
    v_exp_f32 v214, v214
    v_mfma_f32_16x16x32_bf16 v[208:211], a[220:223], v[108:111], v[208:211]
    v_exp_f32 v215, v215
    v_mfma_f32_16x16x32_bf16 a[80:83], a[168:171], v[128:131], a[80:83]
    ds_read_b64_tr_b16 a[180:181], v26 offset:40960
    v_cvt_pk_bf16_f32 v172, v212, v213
    v_mfma_f32_16x16x32_bf16 a[80:83], a[172:175], v[132:135], a[80:83]
    ds_read_b64_tr_b16 a[182:183], v26 offset:45056
    v_mfma_f32_16x16x32_bf16 a[84:87], a[172:175], v[140:143], a[84:87]
    ds_read_b128 a[236:239], v11 offset:61440
    v_cvt_pk_bf16_f32 v173, v214, v215
    v_mfma_f32_16x16x32_bf16 a[84:87], a[168:171], v[136:139], a[84:87]
    s_waitcnt vmcnt(10)
    s_barrier
    v_mfma_f32_16x16x32_bf16 v[212:215], a[208:211], v[112:115], v[204:207]
    v_exp_f32 v208, v208
    v_mfma_f32_16x16x32_bf16 v[212:215], a[212:215], v[116:119], v[212:215]
    s_add_u32 m0, s42, 32768
    v_exp_f32 v209, v209
    v_mfma_f32_16x16x32_bf16 v[212:215], a[216:219], v[120:123], v[212:215]
    v_exp_f32 v210, v210
    v_mfma_f32_16x16x32_bf16 v[212:215], a[220:223], v[124:127], v[212:215]
    v_exp_f32 v211, v211
    v_mfma_f32_16x16x32_bf16 a[88:91], a[168:171], v[144:147], a[88:91]
    ds_read_b64_tr_b16 a[184:185], v27 offset:32768
    v_cvt_pk_bf16_f32 v180, v208, v209
    v_mfma_f32_16x16x32_bf16 a[88:91], a[172:175], v[148:151], a[88:91]
    ds_read_b64_tr_b16 a[186:187], v27 offset:36864
    v_mfma_f32_16x16x32_bf16 a[92:95], a[172:175], v[156:159], a[92:95]
    ds_read_b128 a[208:211], v8 offset:0
    v_cvt_pk_bf16_f32 v181, v210, v211
    v_mfma_f32_16x16x32_bf16 a[92:95], a[168:171], v[152:155], a[92:95]
    s_waitcnt lgkmcnt(3)
    buffer_load_dwordx4 v36, s[8:11], s40 offen lds
    v_mfma_f32_16x16x32_bf16 v[208:211], a[224:227], v[64:67], v[192:195]
    v_exp_f32 v212, v212
    v_mfma_f32_16x16x32_bf16 v[208:211], a[228:231], v[68:71], v[208:211]
    v_exp_f32 v213, v213
    v_mfma_f32_16x16x32_bf16 v[208:211], a[232:235], v[72:75], v[208:211]
    v_exp_f32 v214, v214
    v_mfma_f32_16x16x32_bf16 v[208:211], a[236:239], v[76:79], v[208:211]
    v_exp_f32 v215, v215
    v_mfma_f32_16x16x32_bf16 a[96:99], a[176:179], v[128:131], a[96:99]
    ds_read_b64_tr_b16 a[188:189], v27 offset:40960
    v_cvt_pk_bf16_f32 v188, v212, v213
    v_mfma_f32_16x16x32_bf16 a[96:99], a[180:183], v[132:135], a[96:99]
    ds_read_b64_tr_b16 a[190:191], v27 offset:45056
    v_mfma_f32_16x16x32_bf16 a[100:103], a[180:183], v[140:143], a[100:103]
    ds_read_b128 a[212:215], v9 offset:0
    v_cvt_pk_bf16_f32 v189, v214, v215
    v_mfma_f32_16x16x32_bf16 a[100:103], a[176:179], v[136:139], a[100:103]
    buffer_load_dword v219, v62, s[84:87], s38 offen
    v_mfma_f32_16x16x32_bf16 v[212:215], a[224:227], v[80:83], v[196:199]
    v_exp_f32 v208, v208
    v_mfma_f32_16x16x32_bf16 v[212:215], a[228:231], v[84:87], v[212:215]
    v_exp_f32 v209, v209
    v_mfma_f32_16x16x32_bf16 v[212:215], a[232:235], v[88:91], v[212:215]
    v_exp_f32 v210, v210
    v_mfma_f32_16x16x32_bf16 v[212:215], a[236:239], v[92:95], v[212:215]
    v_exp_f32 v211, v211
    v_mfma_f32_16x16x32_bf16 a[104:107], a[176:179], v[144:147], a[104:107]
    ds_read_b64_tr_b16 a[160:161], v20 offset:49152
    v_cvt_pk_bf16_f32 v166, v208, v209
    v_mfma_f32_16x16x32_bf16 a[104:107], a[180:183], v[148:151], a[104:107]
    ds_read_b64_tr_b16 a[162:163], v20 offset:53248
    v_mfma_f32_16x16x32_bf16 a[108:111], a[180:183], v[156:159], a[108:111]
    ds_read_b128 a[216:219], v10 offset:0
    v_cvt_pk_bf16_f32 v167, v210, v211
    v_mfma_f32_16x16x32_bf16 a[108:111], a[176:179], v[152:155], a[108:111]
    s_waitcnt lgkmcnt(3)
    buffer_load_dwordx4 v37, s[8:11], s40 offen offset:1024 lds
    v_mfma_f32_16x16x32_bf16 v[208:211], a[224:227], v[96:99], v[200:203]
    v_exp_f32 v212, v212
    v_mfma_f32_16x16x32_bf16 v[208:211], a[228:231], v[100:103], v[208:211]
    v_exp_f32 v213, v213
    v_mfma_f32_16x16x32_bf16 v[208:211], a[232:235], v[104:107], v[208:211]
    v_exp_f32 v214, v214
    v_mfma_f32_16x16x32_bf16 v[208:211], a[236:239], v[108:111], v[208:211]
    v_exp_f32 v215, v215
    v_mfma_f32_16x16x32_bf16 a[112:115], a[184:187], v[128:131], a[112:115]
    ds_read_b64_tr_b16 a[164:165], v20 offset:57344
    v_cvt_pk_bf16_f32 v174, v212, v213
    v_mfma_f32_16x16x32_bf16 a[112:115], a[188:191], v[132:135], a[112:115]
    ds_read_b64_tr_b16 a[166:167], v20 offset:61440
    v_mfma_f32_16x16x32_bf16 a[116:119], a[188:191], v[140:143], a[116:119]
    ds_read_b128 a[220:223], v11 offset:0
    v_cvt_pk_bf16_f32 v175, v214, v215
    v_mfma_f32_16x16x32_bf16 a[116:119], a[184:187], v[136:139], a[116:119]
    buffer_load_dword v221, v235, s[20:23], 0 offen
    v_mfma_f32_16x16x32_bf16 v[212:215], a[224:227], v[112:115], v[204:207]
    v_exp_f32 v208, v208
    v_mfma_f32_16x16x32_bf16 v[212:215], a[228:231], v[116:119], v[212:215]
    v_exp_f32 v209, v209
    v_mfma_f32_16x16x32_bf16 v[212:215], a[232:235], v[120:123], v[212:215]
    v_exp_f32 v210, v210
    v_mfma_f32_16x16x32_bf16 v[212:215], a[236:239], v[124:127], v[212:215]
    v_exp_f32 v211, v211
    v_mfma_f32_16x16x32_bf16 a[120:123], a[184:187], v[144:147], a[120:123]
Ltour0_5:
    s_cbranch_execz Ltour0_9
    ds_read_b64_tr_b16 a[168:169], v21 offset:49152
    v_cvt_pk_bf16_f32 v182, v208, v209
    v_mfma_f32_16x16x32_bf16 a[120:123], a[188:191], v[148:151], a[120:123]
    ds_read_b64_tr_b16 a[170:171], v21 offset:53248
    v_add_u32 v235, 2560, v235
    v_mfma_f32_16x16x32_bf16 a[124:127], a[188:191], v[156:159], a[124:127]
    ds_read_b128 a[224:227], v8 offset:4096
    v_cvt_pk_bf16_f32 v183, v210, v211
    v_mfma_f32_16x16x32_bf16 a[124:127], a[184:187], v[152:155], a[124:127]
    s_waitcnt lgkmcnt(3)
    buffer_load_dwordx4 v38, s[8:11], s40 offen offset:2048 lds
    v_mfma_f32_16x16x32_bf16 v[208:211], a[208:211], v[64:67], v[192:195]
    v_exp_f32 v212, v212
    v_mfma_f32_16x16x32_bf16 v[208:211], a[212:215], v[68:71], v[208:211]
    v_exp_f32 v213, v213
    v_mfma_f32_16x16x32_bf16 v[208:211], a[216:219], v[72:75], v[208:211]
    v_exp_f32 v214, v214
    v_mfma_f32_16x16x32_bf16 v[208:211], a[220:223], v[76:79], v[208:211]
    v_exp_f32 v215, v215
    v_mfma_f32_16x16x32_bf16 a[0:3], a[160:163], v[160:163], a[0:3]
    ds_read_b64_tr_b16 a[172:173], v21 offset:57344
    v_cvt_pk_bf16_f32 v190, v212, v213
    v_mfma_f32_16x16x32_bf16 a[0:3], a[164:167], v[164:167], a[0:3]
    ds_read_b64_tr_b16 a[174:175], v21 offset:61440
    v_lshlrev_b32 v244, 16, v240
    v_mfma_f32_16x16x32_bf16 a[4:7], a[164:167], v[172:175], a[4:7]
    ds_read_b128 a[228:231], v9 offset:4096
    v_cvt_pk_bf16_f32 v191, v214, v215
    v_mfma_f32_16x16x32_bf16 a[4:7], a[160:163], v[168:171], a[4:7]
    v_and_b32 v245, 0xffff0000, v240
    v_fmac_f32 v224, v2, v244
    v_mfma_f32_16x16x32_bf16 v[212:215], a[208:211], v[80:83], v[196:199]
    v_exp_f32 v208, v208
    v_mfma_f32_16x16x32_bf16 v[212:215], a[212:215], v[84:87], v[212:215]
    v_exp_f32 v209, v209
    v_mfma_f32_16x16x32_bf16 v[212:215], a[216:219], v[88:91], v[212:215]
    v_exp_f32 v210, v210
    v_mfma_f32_16x16x32_bf16 v[212:215], a[220:223], v[92:95], v[212:215]
    v_exp_f32 v211, v211
    v_mfma_f32_16x16x32_bf16 a[8:11], a[160:163], v[176:179], a[8:11]
    ds_read_b64_tr_b16 a[176:177], v22 offset:49152
    v_cvt_pk_bf16_f32 v128, v208, v209
    v_mfma_f32_16x16x32_bf16 a[8:11], a[164:167], v[180:183], a[8:11]
    ds_read_b64_tr_b16 a[178:179], v22 offset:53248
    v_fmac_f32 v225, v2, v245
    v_mfma_f32_16x16x32_bf16 a[12:15], a[164:167], v[188:191], a[12:15]
    ds_read_b128 a[232:235], v10 offset:4096
    v_cvt_pk_bf16_f32 v129, v210, v211
    v_mfma_f32_16x16x32_bf16 a[12:15], a[160:163], v[184:187], a[12:15]
    s_waitcnt lgkmcnt(3)
    buffer_load_dwordx4 v39, s[8:11], s40 offen offset:3072 lds
    v_mfma_f32_16x16x32_bf16 v[208:211], a[208:211], v[96:99], v[200:203]
    v_exp_f32 v212, v212
    v_mfma_f32_16x16x32_bf16 v[208:211], a[212:215], v[100:103], v[208:211]
    s_add_u32 s40, s40, 16384
    v_exp_f32 v213, v213
    v_mfma_f32_16x16x32_bf16 v[208:211], a[216:219], v[104:107], v[208:211]
    v_exp_f32 v214, v214
    v_mfma_f32_16x16x32_bf16 v[208:211], a[220:223], v[108:111], v[208:211]
    v_exp_f32 v215, v215
    v_mfma_f32_16x16x32_bf16 a[16:19], a[168:171], v[160:163], a[16:19]
    ds_read_b64_tr_b16 a[180:181], v22 offset:57344
    v_cvt_pk_bf16_f32 v136, v212, v213
    v_mfma_f32_16x16x32_bf16 a[16:19], a[172:175], v[164:167], a[16:19]
    ds_read_b64_tr_b16 a[182:183], v22 offset:61440
    v_lshlrev_b32 v246, 16, v241
    v_mfma_f32_16x16x32_bf16 a[20:23], a[172:175], v[172:175], a[20:23]
    ds_read_b128 a[236:239], v11 offset:4096
    v_cvt_pk_bf16_f32 v137, v214, v215
    v_mfma_f32_16x16x32_bf16 a[20:23], a[168:171], v[168:171], a[20:23]
    v_and_b32 v247, 0xffff0000, v241
    v_fmac_f32 v226, v2, v246
    v_smfmac_f32_16x16x64_bf16 a[192:195], v[52:55], v[160:167], v50
    v_mfma_f32_16x16x32_bf16 v[212:215], a[208:211], v[112:115], v[204:207]
    v_exp_f32 v208, v208
    v_mfma_f32_16x16x32_bf16 v[212:215], a[212:215], v[116:119], v[212:215]
    s_add_u32 m0, s42, 81920
    v_exp_f32 v209, v209
    v_mfma_f32_16x16x32_bf16 v[212:215], a[216:219], v[120:123], v[212:215]
    v_exp_f32 v210, v210
    v_mfma_f32_16x16x32_bf16 v[212:215], a[220:223], v[124:127], v[212:215]
    v_exp_f32 v211, v211
    v_mfma_f32_16x16x32_bf16 a[24:27], a[168:171], v[176:179], a[24:27]
    ds_read_b64_tr_b16 a[184:185], v23 offset:49152
    v_cvt_pk_bf16_f32 v144, v208, v209
    v_mfma_f32_16x16x32_bf16 a[24:27], a[172:175], v[180:183], a[24:27]
    ds_read_b64_tr_b16 a[186:187], v23 offset:53248
    v_fmac_f32 v227, v2, v247
    v_mfma_f32_16x16x32_bf16 a[28:31], a[172:175], v[188:191], a[28:31]
    ds_read_b128 a[208:211], v8 offset:8192
    v_cvt_pk_bf16_f32 v145, v210, v211
    v_mfma_f32_16x16x32_bf16 a[28:31], a[168:171], v[184:187], a[28:31]
    s_waitcnt lgkmcnt(3)
    buffer_load_dwordx4 v40, s[12:15], s41 offen lds
    v_mfma_f32_16x16x32_bf16 v[208:211], a[224:227], v[64:67], v[192:195]
    v_exp_f32 v212, v212
    v_mfma_f32_16x16x32_bf16 v[208:211], a[228:231], v[68:71], v[208:211]
    v_exp_f32 v213, v213
    v_mfma_f32_16x16x32_bf16 v[208:211], a[232:235], v[72:75], v[208:211]
    v_exp_f32 v214, v214
    v_mfma_f32_16x16x32_bf16 v[208:211], a[236:239], v[76:79], v[208:211]
    v_exp_f32 v215, v215
    v_mfma_f32_16x16x32_bf16 a[32:35], a[176:179], v[160:163], a[32:35]
    ds_read_b64_tr_b16 a[188:189], v23 offset:57344
    v_cvt_pk_bf16_f32 v152, v212, v213
    v_mfma_f32_16x16x32_bf16 a[32:35], a[180:183], v[164:167], a[32:35]
    ds_read_b64_tr_b16 a[190:191], v23 offset:61440
    v_lshlrev_b32 v244, 16, v242
    v_mfma_f32_16x16x32_bf16 a[36:39], a[180:183], v[172:175], a[36:39]
    ds_read_b128 a[212:215], v9 offset:8192
    v_cvt_pk_bf16_f32 v153, v214, v215
    v_mfma_f32_16x16x32_bf16 a[36:39], a[176:179], v[168:171], a[36:39]
    v_and_b32 v245, 0xffff0000, v242
    v_fmac_f32 v228, v2, v244
    v_smfmac_f32_16x16x64_bf16 a[196:199], v[52:55], v[168:175], v50
    v_mfma_f32_16x16x32_bf16 v[212:215], a[224:227], v[80:83], v[196:199]
    v_exp_f32 v208, v208
    v_mfma_f32_16x16x32_bf16 v[212:215], a[228:231], v[84:87], v[212:215]
    v_exp_f32 v209, v209
    v_mfma_f32_16x16x32_bf16 v[212:215], a[232:235], v[88:91], v[212:215]
    v_exp_f32 v210, v210
    v_mfma_f32_16x16x32_bf16 v[212:215], a[236:239], v[92:95], v[212:215]
    v_exp_f32 v211, v211
    v_mfma_f32_16x16x32_bf16 a[40:43], a[176:179], v[176:179], a[40:43]
    ds_read_b64_tr_b16 a[160:161], v24 offset:49152
    v_cvt_pk_bf16_f32 v130, v208, v209
    v_mfma_f32_16x16x32_bf16 a[40:43], a[180:183], v[180:183], a[40:43]
    ds_read_b64_tr_b16 a[162:163], v24 offset:53248
    v_fmac_f32 v229, v2, v245
    v_mfma_f32_16x16x32_bf16 a[44:47], a[180:183], v[188:191], a[44:47]
    ds_read_b128 a[216:219], v10 offset:8192
    v_cvt_pk_bf16_f32 v131, v210, v211
    v_mfma_f32_16x16x32_bf16 a[44:47], a[176:179], v[184:187], a[44:47]
    s_waitcnt lgkmcnt(3)
    buffer_load_dwordx4 v41, s[12:15], s41 offen offset:1024 lds
    v_mfma_f32_16x16x32_bf16 v[208:211], a[224:227], v[96:99], v[200:203]
    v_exp_f32 v212, v212
    v_mfma_f32_16x16x32_bf16 v[208:211], a[228:231], v[100:103], v[208:211]
    v_exp_f32 v213, v213
    v_mfma_f32_16x16x32_bf16 v[208:211], a[232:235], v[104:107], v[208:211]
    v_exp_f32 v214, v214
    v_mfma_f32_16x16x32_bf16 v[208:211], a[236:239], v[108:111], v[208:211]
    v_exp_f32 v215, v215
    v_mfma_f32_16x16x32_bf16 a[48:51], a[184:187], v[160:163], a[48:51]
    ds_read_b64_tr_b16 a[164:165], v24 offset:57344
    v_cvt_pk_bf16_f32 v138, v212, v213
    v_mfma_f32_16x16x32_bf16 a[48:51], a[188:191], v[164:167], a[48:51]
    ds_read_b64_tr_b16 a[166:167], v24 offset:61440
    v_lshlrev_b32 v246, 16, v243
    v_mfma_f32_16x16x32_bf16 a[52:55], a[188:191], v[172:175], a[52:55]
    ds_read_b128 a[220:223], v11 offset:8192
    v_cvt_pk_bf16_f32 v139, v214, v215
    v_mfma_f32_16x16x32_bf16 a[52:55], a[184:187], v[168:171], a[52:55]
    v_and_b32 v247, 0xffff0000, v243
    v_fmac_f32 v230, v2, v246
    v_smfmac_f32_16x16x64_bf16 a[200:203], v[52:55], v[176:183], v50
    v_mfma_f32_16x16x32_bf16 v[212:215], a[224:227], v[112:115], v[204:207]
    v_exp_f32 v208, v208
    v_mfma_f32_16x16x32_bf16 v[212:215], a[228:231], v[116:119], v[212:215]
    v_exp_f32 v209, v209
    v_mfma_f32_16x16x32_bf16 v[212:215], a[232:235], v[120:123], v[212:215]
    v_exp_f32 v210, v210
    v_mfma_f32_16x16x32_bf16 v[212:215], a[236:239], v[124:127], v[212:215]
    v_exp_f32 v211, v211
    v_mfma_f32_16x16x32_bf16 a[56:59], a[184:187], v[176:179], a[56:59]
    ds_read_b64_tr_b16 a[168:169], v25 offset:49152
    v_cvt_pk_bf16_f32 v146, v208, v209
    v_mfma_f32_16x16x32_bf16 a[56:59], a[188:191], v[180:183], a[56:59]
    ds_read_b64_tr_b16 a[170:171], v25 offset:53248
    v_fmac_f32 v231, v2, v247
    v_mfma_f32_16x16x32_bf16 a[60:63], a[188:191], v[188:191], a[60:63]
    ds_read_b128 a[224:227], v8 offset:12288
    v_cvt_pk_bf16_f32 v147, v210, v211
    v_mfma_f32_16x16x32_bf16 a[60:63], a[184:187], v[184:187], a[60:63]
    s_waitcnt lgkmcnt(3)
    buffer_load_dwordx4 v40, s[12:15], s41 offen offset:2048 lds
    v_mfma_f32_16x16x32_bf16 v[208:211], a[208:211], v[64:67], v[192:195]
    v_exp_f32 v212, v212
    v_mfma_f32_16x16x32_bf16 v[208:211], a[212:215], v[68:71], v[208:211]
    v_exp_f32 v213, v213
    v_mfma_f32_16x16x32_bf16 v[208:211], a[216:219], v[72:75], v[208:211]
    v_exp_f32 v214, v214
    v_mfma_f32_16x16x32_bf16 v[208:211], a[220:223], v[76:79], v[208:211]
    v_exp_f32 v215, v215
    v_mfma_f32_16x16x32_bf16 a[64:67], a[160:163], v[160:163], a[64:67]
    ds_read_b64_tr_b16 a[172:173], v25 offset:57344
    v_cvt_pk_bf16_f32 v154, v212, v213
    v_mfma_f32_16x16x32_bf16 a[64:67], a[164:167], v[164:167], a[64:67]
    ds_read_b64_tr_b16 a[174:175], v25 offset:61440
    v_mov_b32 v2, v3
    v_mfma_f32_16x16x32_bf16 a[68:71], a[164:167], v[172:175], a[68:71]
    ds_read_b128 a[228:231], v9 offset:12288
    v_cvt_pk_bf16_f32 v155, v214, v215
    v_mfma_f32_16x16x32_bf16 a[68:71], a[160:163], v[168:171], a[68:71]
    v_mov_b32 v3, v4
    v_mov_b32 v4, v5
    v_smfmac_f32_16x16x64_bf16 a[204:207], v[52:55], v[184:191], v50
    v_mfma_f32_16x16x32_bf16 v[212:215], a[208:211], v[80:83], v[196:199]
    v_exp_f32 v208, v208
    v_mfma_f32_16x16x32_bf16 v[212:215], a[212:215], v[84:87], v[212:215]
    v_exp_f32 v209, v209
    v_mfma_f32_16x16x32_bf16 v[212:215], a[216:219], v[88:91], v[212:215]
    v_exp_f32 v210, v210
    v_mfma_f32_16x16x32_bf16 v[212:215], a[220:223], v[92:95], v[212:215]
    v_exp_f32 v211, v211
    v_mfma_f32_16x16x32_bf16 a[72:75], a[160:163], v[176:179], a[72:75]
    ds_read_b64_tr_b16 a[176:177], v26 offset:49152
    v_cvt_pk_bf16_f32 v132, v208, v209
    v_mfma_f32_16x16x32_bf16 a[72:75], a[164:167], v[180:183], a[72:75]
    ds_read_b64_tr_b16 a[178:179], v26 offset:53248
    v_mov_b32 v5, v6
    v_mfma_f32_16x16x32_bf16 a[76:79], a[164:167], v[188:191], a[76:79]
    ds_read_b128 a[232:235], v10 offset:12288
    v_cvt_pk_bf16_f32 v133, v210, v211
    v_mfma_f32_16x16x32_bf16 a[76:79], a[160:163], v[184:187], a[76:79]
    s_waitcnt lgkmcnt(3)
    buffer_load_dwordx4 v41, s[12:15], s41 offen offset:3072 lds
    v_mfma_f32_16x16x32_bf16 v[208:211], a[208:211], v[96:99], v[200:203]
    v_exp_f32 v212, v212
    v_mfma_f32_16x16x32_bf16 v[208:211], a[212:215], v[100:103], v[208:211]
    s_add_u32 s41, s41, 16384
    v_exp_f32 v213, v213
    v_mfma_f32_16x16x32_bf16 v[208:211], a[216:219], v[104:107], v[208:211]
    v_exp_f32 v214, v214
    v_mfma_f32_16x16x32_bf16 v[208:211], a[220:223], v[108:111], v[208:211]
    v_exp_f32 v215, v215
    v_mfma_f32_16x16x32_bf16 a[80:83], a[168:171], v[160:163], a[80:83]
    ds_read_b64_tr_b16 a[180:181], v26 offset:57344
    v_cvt_pk_bf16_f32 v140, v212, v213
    v_mfma_f32_16x16x32_bf16 a[80:83], a[172:175], v[164:167], a[80:83]
    ds_read_b64_tr_b16 a[182:183], v26 offset:61440
    v_mfma_f32_16x16x32_bf16 a[84:87], a[172:175], v[172:175], a[84:87]
    ds_read_b128 a[236:239], v11 offset:12288
    v_cvt_pk_bf16_f32 v141, v214, v215
    v_mfma_f32_16x16x32_bf16 a[84:87], a[168:171], v[168:171], a[84:87]
    s_waitcnt vmcnt(10)
    s_barrier
    v_mfma_f32_16x16x32_bf16 v[212:215], a[208:211], v[112:115], v[204:207]
    v_exp_f32 v208, v208
    v_mfma_f32_16x16x32_bf16 v[212:215], a[212:215], v[116:119], v[212:215]
    s_add_u32 m0, s42, 49152
    v_exp_f32 v209, v209
    v_mfma_f32_16x16x32_bf16 v[212:215], a[216:219], v[120:123], v[212:215]
    v_exp_f32 v210, v210
    v_mfma_f32_16x16x32_bf16 v[212:215], a[220:223], v[124:127], v[212:215]
    v_exp_f32 v211, v211
    v_mfma_f32_16x16x32_bf16 a[88:91], a[168:171], v[176:179], a[88:91]
    ds_read_b64_tr_b16 a[184:185], v27 offset:49152
    v_cvt_pk_bf16_f32 v148, v208, v209
    v_mfma_f32_16x16x32_bf16 a[88:91], a[172:175], v[180:183], a[88:91]
    ds_read_b64_tr_b16 a[186:187], v27 offset:53248
    v_mfma_f32_16x16x32_bf16 a[92:95], a[172:175], v[188:191], a[92:95]
    ds_read_b128 a[208:211], v8 offset:16384
    v_cvt_pk_bf16_f32 v149, v210, v211
    v_mfma_f32_16x16x32_bf16 a[92:95], a[168:171], v[184:187], a[92:95]
    s_waitcnt lgkmcnt(3)
    buffer_load_dwordx4 v36, s[8:11], s40 offen lds
    v_mfma_f32_16x16x32_bf16 v[208:211], a[224:227], v[64:67], v[192:195]
    v_exp_f32 v212, v212
    v_mfma_f32_16x16x32_bf16 v[208:211], a[228:231], v[68:71], v[208:211]
    v_exp_f32 v213, v213
    v_mfma_f32_16x16x32_bf16 v[208:211], a[232:235], v[72:75], v[208:211]
    v_exp_f32 v214, v214
    v_mfma_f32_16x16x32_bf16 v[208:211], a[236:239], v[76:79], v[208:211]
    v_exp_f32 v215, v215
    v_mfma_f32_16x16x32_bf16 a[96:99], a[176:179], v[160:163], a[96:99]
    ds_read_b64_tr_b16 a[188:189], v27 offset:57344
    v_cvt_pk_bf16_f32 v156, v212, v213
    v_mfma_f32_16x16x32_bf16 a[96:99], a[180:183], v[164:167], a[96:99]
    ds_read_b64_tr_b16 a[190:191], v27 offset:61440
    v_mfma_f32_16x16x32_bf16 a[100:103], a[180:183], v[172:175], a[100:103]
    ds_read_b128 a[212:215], v9 offset:16384
    v_cvt_pk_bf16_f32 v157, v214, v215
    v_mfma_f32_16x16x32_bf16 a[100:103], a[176:179], v[168:171], a[100:103]
    buffer_load_dword v216, v237, s[28:31], s52 offen
    v_mfma_f32_16x16x32_bf16 v[212:215], a[224:227], v[80:83], v[196:199]
    v_exp_f32 v208, v208
    v_mfma_f32_16x16x32_bf16 v[212:215], a[228:231], v[84:87], v[212:215]
    s_sub_u32 s39, s39, 36864
    v_exp_f32 v209, v209
    v_mfma_f32_16x16x32_bf16 v[212:215], a[232:235], v[88:91], v[212:215]
    s_sub_u32 s38, s38, 4608
    v_exp_f32 v210, v210
    v_mfma_f32_16x16x32_bf16 v[212:215], a[236:239], v[92:95], v[212:215]
    s_add_u32 s52, s52, 2304
    v_exp_f32 v211, v211
    v_mfma_f32_16x16x32_bf16 a[104:107], a[176:179], v[176:179], a[104:107]
    ds_read_b64_tr_b16 a[160:161], v20 offset:0
    v_cvt_pk_bf16_f32 v134, v208, v209
    v_mfma_f32_16x16x32_bf16 a[104:107], a[180:183], v[180:183], a[104:107]
    ds_read_b64_tr_b16 a[162:163], v20 offset:4096
    v_mfma_f32_16x16x32_bf16 a[108:111], a[180:183], v[188:191], a[108:111]
    ds_read_b128 a[216:219], v10 offset:16384
    v_cvt_pk_bf16_f32 v135, v210, v211
    v_mfma_f32_16x16x32_bf16 a[108:111], a[176:179], v[184:187], a[108:111]
    s_waitcnt lgkmcnt(3)
    buffer_load_dwordx4 v37, s[8:11], s40 offen offset:1024 lds
    v_mfma_f32_16x16x32_bf16 v[208:211], a[224:227], v[96:99], v[200:203]
    v_exp_f32 v212, v212
    v_mfma_f32_16x16x32_bf16 v[208:211], a[228:231], v[100:103], v[208:211]
    v_exp_f32 v213, v213
    v_mfma_f32_16x16x32_bf16 v[208:211], a[232:235], v[104:107], v[208:211]
    v_exp_f32 v214, v214
    v_mfma_f32_16x16x32_bf16 v[208:211], a[236:239], v[108:111], v[208:211]
    v_exp_f32 v215, v215
    v_mfma_f32_16x16x32_bf16 a[112:115], a[184:187], v[160:163], a[112:115]
    ds_read_b64_tr_b16 a[164:165], v20 offset:8192
    v_cvt_pk_bf16_f32 v142, v212, v213
    v_mfma_f32_16x16x32_bf16 a[112:115], a[188:191], v[164:167], a[112:115]
    ds_read_b64_tr_b16 a[166:167], v20 offset:12288
    v_mfma_f32_16x16x32_bf16 a[116:119], a[188:191], v[172:175], a[116:119]
    ds_read_b128 a[220:223], v11 offset:16384
    v_cvt_pk_bf16_f32 v143, v214, v215
    v_mfma_f32_16x16x32_bf16 a[116:119], a[184:187], v[168:171], a[116:119]
    v_mfma_f32_16x16x32_bf16 v[212:215], a[224:227], v[112:115], v[204:207]
    v_exp_f32 v208, v208
    v_mfma_f32_16x16x32_bf16 v[212:215], a[228:231], v[116:119], v[212:215]
    v_exp_f32 v209, v209
    v_mfma_f32_16x16x32_bf16 v[212:215], a[232:235], v[120:123], v[212:215]
    v_exp_f32 v210, v210
    v_mfma_f32_16x16x32_bf16 v[212:215], a[236:239], v[124:127], v[212:215]
    v_exp_f32 v211, v211
    v_mfma_f32_16x16x32_bf16 a[120:123], a[184:187], v[176:179], a[120:123]
    ds_read_b64_tr_b16 a[168:169], v21 offset:0
    v_cvt_pk_bf16_f32 v150, v208, v209
    v_mfma_f32_16x16x32_bf16 a[120:123], a[188:191], v[180:183], a[120:123]
    ds_read_b64_tr_b16 a[170:171], v21 offset:4096
    v_mfma_f32_16x16x32_bf16 a[124:127], a[188:191], v[188:191], a[124:127]
    ds_read_b128 a[224:227], v8 offset:20480
    v_cvt_pk_bf16_f32 v151, v210, v211
    v_mfma_f32_16x16x32_bf16 a[124:127], a[184:187], v[184:187], a[124:127]
    s_waitcnt lgkmcnt(3)
    buffer_load_dwordx4 v38, s[8:11], s40 offen offset:2048 lds
    s_sub_u32 s43, s43, 1
    s_cmp_lg_u32 s43, 0
    s_cbranch_scc1 Lattn_loop
    v_mfma_f32_16x16x32_bf16 v[208:211], a[208:211], v[64:67], v[192:195]
    s_lshl_b32 s38, s3, 6
    v_exp_f32 v212, v212
    v_mfma_f32_16x16x32_bf16 v[208:211], a[212:215], v[68:71], v[208:211]
    s_add_u32 s38, s38, 131136
    v_exp_f32 v213, v213
    v_mfma_f32_16x16x32_bf16 v[208:211], a[216:219], v[72:75], v[208:211]
    v_exp_f32 v214, v214
    v_mfma_f32_16x16x32_bf16 v[208:211], a[220:223], v[76:79], v[208:211]
    s_add_u32 s57, s58, 0
    v_exp_f32 v215, v215
    v_mfma_f32_16x16x32_bf16 a[0:3], a[160:163], v[128:131], a[0:3]
    ds_read_b64_tr_b16 a[172:173], v21 offset:8192
    v_cvt_pk_bf16_f32 v158, v212, v213
    v_mfma_f32_16x16x32_bf16 a[0:3], a[164:167], v[132:135], a[0:3]
    ds_read_b64_tr_b16 a[174:175], v21 offset:12288
    v_permlane32_swap_b32 v224, v228
    v_mfma_f32_16x16x32_bf16 a[4:7], a[164:167], v[140:143], a[4:7]
    ds_read_b128 a[228:231], v9 offset:20480
    v_cvt_pk_bf16_f32 v159, v214, v215
    v_mfma_f32_16x16x32_bf16 a[4:7], a[160:163], v[136:139], a[4:7]
    buffer_load_dwordx4 a[128:131], v254, s[80:83], s57 offen
    v_mfma_f32_16x16x32_bf16 v[212:215], a[208:211], v[80:83], v[196:199]
    v_exp_f32 v208, v208
    v_mfma_f32_16x16x32_bf16 v[212:215], a[212:215], v[84:87], v[212:215]
    v_exp_f32 v209, v209
    v_mfma_f32_16x16x32_bf16 v[212:215], a[216:219], v[88:91], v[212:215]
    v_exp_f32 v210, v210
    v_mfma_f32_16x16x32_bf16 v[212:215], a[220:223], v[92:95], v[212:215]
    v_exp_f32 v211, v211
    v_mfma_f32_16x16x32_bf16 a[8:11], a[160:163], v[144:147], a[8:11]
    ds_read_b64_tr_b16 a[176:177], v22 offset:0
    v_cvt_pk_bf16_f32 v160, v208, v209
    v_mfma_f32_16x16x32_bf16 a[8:11], a[164:167], v[148:151], a[8:11]
    ds_read_b64_tr_b16 a[178:179], v22 offset:4096
    v_permlane32_swap_b32 v225, v229
    v_mfma_f32_16x16x32_bf16 a[12:15], a[164:167], v[156:159], a[12:15]
    ds_read_b128 a[232:235], v10 offset:20480
    v_cvt_pk_bf16_f32 v161, v210, v211
    v_mfma_f32_16x16x32_bf16 a[12:15], a[160:163], v[152:155], a[12:15]
    s_waitcnt lgkmcnt(3)
    buffer_load_dwordx4 v39, s[8:11], s40 offen offset:3072 lds
    v_mfma_f32_16x16x32_bf16 v[208:211], a[208:211], v[96:99], v[200:203]
    v_exp_f32 v212, v212
    v_mfma_f32_16x16x32_bf16 v[208:211], a[212:215], v[100:103], v[208:211]
    s_add_u32 s40, s40, 16384
    v_exp_f32 v213, v213
    v_mfma_f32_16x16x32_bf16 v[208:211], a[216:219], v[104:107], v[208:211]
    v_exp_f32 v214, v214
    v_mfma_f32_16x16x32_bf16 v[208:211], a[220:223], v[108:111], v[208:211]
    v_exp_f32 v215, v215
    v_mfma_f32_16x16x32_bf16 a[16:19], a[168:171], v[128:131], a[16:19]
    ds_read_b64_tr_b16 a[180:181], v22 offset:8192
    v_cvt_pk_bf16_f32 v168, v212, v213
    v_mfma_f32_16x16x32_bf16 a[16:19], a[172:175], v[132:135], a[16:19]
    ds_read_b64_tr_b16 a[182:183], v22 offset:12288
    v_permlane32_swap_b32 v226, v230
    v_mfma_f32_16x16x32_bf16 a[20:23], a[172:175], v[140:143], a[20:23]
    ds_read_b128 a[236:239], v11 offset:20480
    v_cvt_pk_bf16_f32 v169, v214, v215
    v_mfma_f32_16x16x32_bf16 a[20:23], a[168:171], v[136:139], a[20:23]
    v_permlane32_swap_b32 v227, v231
    v_add_f32 v224, v224, v228
    v_smfmac_f32_16x16x64_bf16 a[192:195], v[52:55], v[128:135], v50
    v_mfma_f32_16x16x32_bf16 v[212:215], a[208:211], v[112:115], v[204:207]
    v_exp_f32 v208, v208
    v_mfma_f32_16x16x32_bf16 v[212:215], a[212:215], v[116:119], v[212:215]
    s_add_u32 m0, s42, 98304
    v_exp_f32 v209, v209
    v_mfma_f32_16x16x32_bf16 v[212:215], a[216:219], v[120:123], v[212:215]
    v_exp_f32 v210, v210
    v_mfma_f32_16x16x32_bf16 v[212:215], a[220:223], v[124:127], v[212:215]
    v_exp_f32 v211, v211
    v_mfma_f32_16x16x32_bf16 a[24:27], a[168:171], v[144:147], a[24:27]
    ds_read_b64_tr_b16 a[184:185], v23 offset:0
    v_cvt_pk_bf16_f32 v176, v208, v209
    v_mfma_f32_16x16x32_bf16 a[24:27], a[172:175], v[148:151], a[24:27]
    ds_read_b64_tr_b16 a[186:187], v23 offset:4096
    v_add_f32 v225, v225, v229
    v_mfma_f32_16x16x32_bf16 a[28:31], a[172:175], v[156:159], a[28:31]
    ds_read_b128 a[208:211], v8 offset:24576
    v_cvt_pk_bf16_f32 v177, v210, v211
    v_mfma_f32_16x16x32_bf16 a[28:31], a[168:171], v[152:155], a[28:31]
    s_waitcnt lgkmcnt(3)
    buffer_load_dwordx4 v40, s[12:15], s41 offen lds
    v_mfma_f32_16x16x32_bf16 v[208:211], a[224:227], v[64:67], v[192:195]
    v_exp_f32 v212, v212
    v_mfma_f32_16x16x32_bf16 v[208:211], a[228:231], v[68:71], v[208:211]
    v_exp_f32 v213, v213
    v_mfma_f32_16x16x32_bf16 v[208:211], a[232:235], v[72:75], v[208:211]
    v_exp_f32 v214, v214
    v_mfma_f32_16x16x32_bf16 v[208:211], a[236:239], v[76:79], v[208:211]
    s_add_u32 s57, s58, 589824
    v_exp_f32 v215, v215
    v_mfma_f32_16x16x32_bf16 a[32:35], a[176:179], v[128:131], a[32:35]
    ds_read_b64_tr_b16 a[188:189], v23 offset:8192
    v_cvt_pk_bf16_f32 v184, v212, v213
    v_mfma_f32_16x16x32_bf16 a[32:35], a[180:183], v[132:135], a[32:35]
    ds_read_b64_tr_b16 a[190:191], v23 offset:12288
    v_add_f32 v226, v226, v230
    v_mfma_f32_16x16x32_bf16 a[36:39], a[180:183], v[140:143], a[36:39]
    ds_read_b128 a[212:215], v9 offset:24576
    v_cvt_pk_bf16_f32 v185, v214, v215
    v_mfma_f32_16x16x32_bf16 a[36:39], a[176:179], v[136:139], a[36:39]
    buffer_load_dwordx4 a[132:135], v254, s[80:83], s57 offen
    v_smfmac_f32_16x16x64_bf16 a[196:199], v[52:55], v[136:143], v50
    v_mfma_f32_16x16x32_bf16 v[212:215], a[224:227], v[80:83], v[196:199]
    v_exp_f32 v208, v208
    v_mfma_f32_16x16x32_bf16 v[212:215], a[228:231], v[84:87], v[212:215]
    v_exp_f32 v209, v209
    v_mfma_f32_16x16x32_bf16 v[212:215], a[232:235], v[88:91], v[212:215]
    v_exp_f32 v210, v210
    v_mfma_f32_16x16x32_bf16 v[212:215], a[236:239], v[92:95], v[212:215]
    v_exp_f32 v211, v211
    v_mfma_f32_16x16x32_bf16 a[40:43], a[176:179], v[144:147], a[40:43]
    ds_read_b64_tr_b16 a[160:161], v24 offset:0
    v_cvt_pk_bf16_f32 v162, v208, v209
    v_mfma_f32_16x16x32_bf16 a[40:43], a[180:183], v[148:151], a[40:43]
    ds_read_b64_tr_b16 a[162:163], v24 offset:4096
    v_add_f32 v227, v227, v231
    v_mfma_f32_16x16x32_bf16 a[44:47], a[180:183], v[156:159], a[44:47]
    ds_read_b128 a[216:219], v10 offset:24576
    v_cvt_pk_bf16_f32 v163, v210, v211
    v_mfma_f32_16x16x32_bf16 a[44:47], a[176:179], v[152:155], a[44:47]
    s_waitcnt lgkmcnt(3)
    buffer_load_dwordx4 v41, s[12:15], s41 offen offset:1024 lds
    v_mfma_f32_16x16x32_bf16 v[208:211], a[224:227], v[96:99], v[200:203]
    v_exp_f32 v212, v212
    v_mfma_f32_16x16x32_bf16 v[208:211], a[228:231], v[100:103], v[208:211]
    v_exp_f32 v213, v213
    v_mfma_f32_16x16x32_bf16 v[208:211], a[232:235], v[104:107], v[208:211]
    v_exp_f32 v214, v214
    v_mfma_f32_16x16x32_bf16 v[208:211], a[236:239], v[108:111], v[208:211]
    v_exp_f32 v215, v215
    v_mfma_f32_16x16x32_bf16 a[48:51], a[184:187], v[128:131], a[48:51]
    ds_read_b64_tr_b16 a[164:165], v24 offset:8192
    v_cvt_pk_bf16_f32 v170, v212, v213
    v_mfma_f32_16x16x32_bf16 a[48:51], a[188:191], v[132:135], a[48:51]
    ds_read_b64_tr_b16 a[166:167], v24 offset:12288
    v_and_b32 v244, 1, v1
    v_mfma_f32_16x16x32_bf16 a[52:55], a[188:191], v[140:143], a[52:55]
    ds_read_b128 a[220:223], v11 offset:24576
    v_cvt_pk_bf16_f32 v171, v214, v215
    v_mfma_f32_16x16x32_bf16 a[52:55], a[184:187], v[136:139], a[52:55]
    s_waitcnt vmcnt(15)
    buffer_load_dword v221, v236, s[20:23], 0 offen
    v_smfmac_f32_16x16x64_bf16 a[200:203], v[52:55], v[144:151], v50
    v_mfma_f32_16x16x32_bf16 v[212:215], a[224:227], v[112:115], v[204:207]
    v_exp_f32 v208, v208
    v_mfma_f32_16x16x32_bf16 v[212:215], a[228:231], v[116:119], v[212:215]
    v_exp_f32 v209, v209
    v_mfma_f32_16x16x32_bf16 v[212:215], a[232:235], v[120:123], v[212:215]
    v_exp_f32 v210, v210
    v_mfma_f32_16x16x32_bf16 v[212:215], a[236:239], v[124:127], v[212:215]
    v_exp_f32 v211, v211
    v_mfma_f32_16x16x32_bf16 a[56:59], a[184:187], v[144:147], a[56:59]
    ds_read_b64_tr_b16 a[168:169], v25 offset:0
    v_cvt_pk_bf16_f32 v178, v208, v209
    v_mfma_f32_16x16x32_bf16 a[56:59], a[188:191], v[148:151], a[56:59]
    ds_read_b64_tr_b16 a[170:171], v25 offset:4096
    v_permlane16_swap_b32 v224, v226
    v_mfma_f32_16x16x32_bf16 a[60:63], a[188:191], v[156:159], a[60:63]
    ds_read_b128 a[224:227], v8 offset:28672
    v_cvt_pk_bf16_f32 v179, v210, v211
    v_mfma_f32_16x16x32_bf16 a[60:63], a[184:187], v[152:155], a[60:63]
    s_waitcnt lgkmcnt(3)
    buffer_load_dwordx4 v40, s[12:15], s41 offen offset:2048 lds
    v_mfma_f32_16x16x32_bf16 v[208:211], a[208:211], v[64:67], v[192:195]
    v_exp_f32 v212, v212
    v_mfma_f32_16x16x32_bf16 v[208:211], a[212:215], v[68:71], v[208:211]
    v_exp_f32 v213, v213
    v_mfma_f32_16x16x32_bf16 v[208:211], a[216:219], v[72:75], v[208:211]
    v_exp_f32 v214, v214
    v_mfma_f32_16x16x32_bf16 v[208:211], a[220:223], v[76:79], v[208:211]
    s_add_u32 s57, s58, 1179648
    v_exp_f32 v215, v215
    v_mfma_f32_16x16x32_bf16 a[64:67], a[160:163], v[128:131], a[64:67]
    ds_read_b64_tr_b16 a[172:173], v25 offset:8192
    v_cvt_pk_bf16_f32 v186, v212, v213
    v_mfma_f32_16x16x32_bf16 a[64:67], a[164:167], v[132:135], a[64:67]
    ds_read_b64_tr_b16 a[174:175], v25 offset:12288
    v_permlane16_swap_b32 v225, v227
    v_mfma_f32_16x16x32_bf16 a[68:71], a[164:167], v[140:143], a[68:71]
    ds_read_b128 a[228:231], v9 offset:28672
    v_cvt_pk_bf16_f32 v187, v214, v215
    v_mfma_f32_16x16x32_bf16 a[68:71], a[160:163], v[136:139], a[68:71]
    buffer_load_dwordx4 a[136:139], v254, s[80:83], s57 offen
    v_smfmac_f32_16x16x64_bf16 a[204:207], v[52:55], v[152:159], v50
    v_mfma_f32_16x16x32_bf16 v[212:215], a[208:211], v[80:83], v[196:199]
    v_exp_f32 v208, v208
    v_mfma_f32_16x16x32_bf16 v[212:215], a[212:215], v[84:87], v[212:215]
    v_exp_f32 v209, v209
    v_mfma_f32_16x16x32_bf16 v[212:215], a[216:219], v[88:91], v[212:215]
    v_exp_f32 v210, v210
    v_mfma_f32_16x16x32_bf16 v[212:215], a[220:223], v[92:95], v[212:215]
    v_exp_f32 v211, v211
    v_mfma_f32_16x16x32_bf16 a[72:75], a[160:163], v[144:147], a[72:75]
    ds_read_b64_tr_b16 a[176:177], v26 offset:0
    v_cvt_pk_bf16_f32 v164, v208, v209
    v_mfma_f32_16x16x32_bf16 a[72:75], a[164:167], v[148:151], a[72:75]
    ds_read_b64_tr_b16 a[178:179], v26 offset:4096
    v_lshlrev_b32 v244, 5, v244
    v_mfma_f32_16x16x32_bf16 a[76:79], a[164:167], v[156:159], a[76:79]
    ds_read_b128 a[232:235], v10 offset:28672
    v_cvt_pk_bf16_f32 v165, v210, v211
    v_mfma_f32_16x16x32_bf16 a[76:79], a[160:163], v[152:155], a[76:79]
    s_waitcnt lgkmcnt(3)
    buffer_load_dwordx4 v41, s[12:15], s41 offen offset:3072 lds
    v_mfma_f32_16x16x32_bf16 v[208:211], a[208:211], v[96:99], v[200:203]
    v_exp_f32 v212, v212
    v_mfma_f32_16x16x32_bf16 v[208:211], a[212:215], v[100:103], v[208:211]
    s_add_u32 s41, s41, 16384
    v_exp_f32 v213, v213
    v_mfma_f32_16x16x32_bf16 v[208:211], a[216:219], v[104:107], v[208:211]
    v_exp_f32 v214, v214
    v_mfma_f32_16x16x32_bf16 v[208:211], a[220:223], v[108:111], v[208:211]
    v_exp_f32 v215, v215
    v_mfma_f32_16x16x32_bf16 a[80:83], a[168:171], v[128:131], a[80:83]
    ds_read_b64_tr_b16 a[180:181], v26 offset:8192
    v_cvt_pk_bf16_f32 v172, v212, v213
    v_mfma_f32_16x16x32_bf16 a[80:83], a[172:175], v[132:135], a[80:83]
    ds_read_b64_tr_b16 a[182:183], v26 offset:12288
    v_add_f32 v224, v224, v226
    v_mfma_f32_16x16x32_bf16 a[84:87], a[172:175], v[140:143], a[84:87]
    ds_read_b128 a[236:239], v11 offset:28672
    v_cvt_pk_bf16_f32 v173, v214, v215
    v_mfma_f32_16x16x32_bf16 a[84:87], a[168:171], v[136:139], a[84:87]
    s_waitcnt vmcnt(13)
    s_barrier
    v_mfma_f32_16x16x32_bf16 v[212:215], a[208:211], v[112:115], v[204:207]
    v_exp_f32 v208, v208
    v_mfma_f32_16x16x32_bf16 v[212:215], a[212:215], v[116:119], v[212:215]
    s_add_u32 s49, s45, 1024
    v_exp_f32 v209, v209
    v_mfma_f32_16x16x32_bf16 v[212:215], a[216:219], v[120:123], v[212:215]
    s_add_u32 m0, s42, 0
    v_exp_f32 v210, v210
    v_mfma_f32_16x16x32_bf16 v[212:215], a[220:223], v[124:127], v[212:215]
    v_exp_f32 v211, v211
    v_mfma_f32_16x16x32_bf16 a[88:91], a[168:171], v[144:147], a[88:91]
    ds_read_b64_tr_b16 a[184:185], v27 offset:0
    v_cvt_pk_bf16_f32 v180, v208, v209
    v_mfma_f32_16x16x32_bf16 a[88:91], a[172:175], v[148:151], a[88:91]
    ds_read_b64_tr_b16 a[186:187], v27 offset:4096
    v_add_f32 v225, v225, v227
    v_mfma_f32_16x16x32_bf16 a[92:95], a[172:175], v[156:159], a[92:95]
    ds_read_b128 a[208:211], v8 offset:32768
    v_cvt_pk_bf16_f32 v181, v210, v211
    v_mfma_f32_16x16x32_bf16 a[92:95], a[168:171], v[152:155], a[92:95]
    s_waitcnt lgkmcnt(3)
    buffer_load_dwordx4 v46, s[20:23], s49 offen lds
    v_mfma_f32_16x16x32_bf16 v[208:211], a[224:227], v[64:67], v[192:195]
    v_exp_f32 v212, v212
    v_mfma_f32_16x16x32_bf16 v[208:211], a[228:231], v[68:71], v[208:211]
    v_exp_f32 v213, v213
    v_mfma_f32_16x16x32_bf16 v[208:211], a[232:235], v[72:75], v[208:211]
    v_exp_f32 v214, v214
    v_mfma_f32_16x16x32_bf16 v[208:211], a[236:239], v[76:79], v[208:211]
    s_add_u32 s37, s55, 0
    v_exp_f32 v215, v215
    v_mfma_f32_16x16x32_bf16 a[96:99], a[176:179], v[128:131], a[96:99]
Ltour0_6:
    s_cbranch_execz Ltour0_10
    ds_read_b64_tr_b16 a[188:189], v27 offset:8192
    v_cvt_pk_bf16_f32 v188, v212, v213
    v_mfma_f32_16x16x32_bf16 a[96:99], a[180:183], v[132:135], a[96:99]
    ds_read_b64_tr_b16 a[190:191], v27 offset:12288
    v_lshrrev_b32 v245, 4, v1
    v_mfma_f32_16x16x32_bf16 a[100:103], a[180:183], v[140:143], a[100:103]
    ds_read_b128 a[212:215], v9 offset:32768
    v_cvt_pk_bf16_f32 v189, v214, v215
    v_mfma_f32_16x16x32_bf16 a[100:103], a[176:179], v[136:139], a[100:103]
    buffer_load_dword v239, v238, s[28:31], s37 offen
    v_mfma_f32_16x16x32_bf16 v[212:215], a[224:227], v[80:83], v[196:199]
    v_exp_f32 v208, v208
    v_mfma_f32_16x16x32_bf16 v[212:215], a[228:231], v[84:87], v[212:215]
    v_exp_f32 v209, v209
    v_mfma_f32_16x16x32_bf16 v[212:215], a[232:235], v[88:91], v[212:215]
    v_exp_f32 v210, v210
    v_mfma_f32_16x16x32_bf16 v[212:215], a[236:239], v[92:95], v[212:215]
    v_exp_f32 v211, v211
    v_mfma_f32_16x16x32_bf16 a[104:107], a[176:179], v[144:147], a[104:107]
    ds_read_b64_tr_b16 a[160:161], v20 offset:16384
    v_cvt_pk_bf16_f32 v166, v208, v209
    v_mfma_f32_16x16x32_bf16 a[104:107], a[180:183], v[148:151], a[104:107]
    ds_read_b64_tr_b16 a[162:163], v20 offset:20480
    v_lshl_add_u32 v244, v245, 3, v244
    v_mfma_f32_16x16x32_bf16 a[108:111], a[180:183], v[156:159], a[108:111]
    ds_read_b128 a[216:219], v10 offset:32768
    v_cvt_pk_bf16_f32 v167, v210, v211
    v_mfma_f32_16x16x32_bf16 a[108:111], a[176:179], v[152:155], a[108:111]
    s_waitcnt lgkmcnt(3)
    buffer_load_dwordx4 v47, s[20:23], s49 offen offset:1024 lds
    v_mfma_f32_16x16x32_bf16 v[208:211], a[224:227], v[96:99], v[200:203]
    v_exp_f32 v212, v212
    v_mfma_f32_16x16x32_bf16 v[208:211], a[228:231], v[100:103], v[208:211]
    v_exp_f32 v213, v213
    v_mfma_f32_16x16x32_bf16 v[208:211], a[232:235], v[104:107], v[208:211]
    v_exp_f32 v214, v214
    v_mfma_f32_16x16x32_bf16 v[208:211], a[236:239], v[108:111], v[208:211]
    s_add_u32 s57, s58, 1769472
    v_exp_f32 v215, v215
    v_mfma_f32_16x16x32_bf16 a[112:115], a[184:187], v[128:131], a[112:115]
    ds_read_b64_tr_b16 a[164:165], v20 offset:24576
    v_cvt_pk_bf16_f32 v174, v212, v213
    v_mfma_f32_16x16x32_bf16 a[112:115], a[188:191], v[132:135], a[112:115]
    ds_read_b64_tr_b16 a[166:167], v20 offset:28672
    v_mfma_f32_16x16x32_bf16 a[116:119], a[188:191], v[140:143], a[116:119]
    ds_read_b128 a[220:223], v11 offset:32768
    v_cvt_pk_bf16_f32 v175, v214, v215
    v_mfma_f32_16x16x32_bf16 a[116:119], a[184:187], v[136:139], a[116:119]
    buffer_load_dwordx4 a[140:143], v254, s[80:83], s57 offen
    v_mfma_f32_16x16x32_bf16 v[212:215], a[224:227], v[112:115], v[204:207]
    v_exp_f32 v208, v208
    v_mfma_f32_16x16x32_bf16 v[212:215], a[228:231], v[116:119], v[212:215]
    v_exp_f32 v209, v209
    v_mfma_f32_16x16x32_bf16 v[212:215], a[232:235], v[120:123], v[212:215]
    v_exp_f32 v210, v210
    v_mfma_f32_16x16x32_bf16 v[212:215], a[236:239], v[124:127], v[212:215]
    v_exp_f32 v211, v211
    v_mfma_f32_16x16x32_bf16 a[120:123], a[184:187], v[144:147], a[120:123]
    ds_read_b64_tr_b16 a[168:169], v21 offset:16384
    v_cvt_pk_bf16_f32 v182, v208, v209
    v_mfma_f32_16x16x32_bf16 a[120:123], a[188:191], v[148:151], a[120:123]
    ds_read_b64_tr_b16 a[170:171], v21 offset:20480
    v_mfma_f32_16x16x32_bf16 a[124:127], a[188:191], v[156:159], a[124:127]
    ds_read_b128 a[224:227], v8 offset:36864
    v_cvt_pk_bf16_f32 v183, v210, v211
    v_mfma_f32_16x16x32_bf16 a[124:127], a[184:187], v[152:155], a[124:127]
    s_waitcnt lgkmcnt(3)
    buffer_load_dwordx4 v48, s[20:23], s49 offen offset:2048 lds
    v_mfma_f32_16x16x32_bf16 v[208:211], a[208:211], v[64:67], v[192:195]
    v_exp_f32 v212, v212
    v_mfma_f32_16x16x32_bf16 v[208:211], a[212:215], v[68:71], v[208:211]
    v_exp_f32 v213, v213
    v_mfma_f32_16x16x32_bf16 v[208:211], a[216:219], v[72:75], v[208:211]
    v_exp_f32 v214, v214
    v_mfma_f32_16x16x32_bf16 v[208:211], a[220:223], v[76:79], v[208:211]
    s_add_u32 s57, s58, 2359296
    v_exp_f32 v215, v215
    v_mfma_f32_16x16x32_bf16 a[0:3], a[160:163], v[160:163], a[0:3]
    ds_read_b64_tr_b16 a[172:173], v21 offset:24576
    v_cvt_pk_bf16_f32 v190, v212, v213
    v_mfma_f32_16x16x32_bf16 a[0:3], a[164:167], v[164:167], a[0:3]
    ds_read_b64_tr_b16 a[174:175], v21 offset:28672
    v_mov_b32 v63, 0
    v_mfma_f32_16x16x32_bf16 a[4:7], a[164:167], v[172:175], a[4:7]
    ds_read_b128 a[228:231], v9 offset:36864
    v_cvt_pk_bf16_f32 v191, v214, v215
    v_mfma_f32_16x16x32_bf16 a[4:7], a[160:163], v[168:171], a[4:7]
    buffer_load_dwordx4 a[144:147], v254, s[80:83], s57 offen
    v_mfma_f32_16x16x32_bf16 v[212:215], a[208:211], v[80:83], v[196:199]
    v_exp_f32 v208, v208
    v_mfma_f32_16x16x32_bf16 v[212:215], a[212:215], v[84:87], v[212:215]
    v_exp_f32 v209, v209
    v_mfma_f32_16x16x32_bf16 v[212:215], a[216:219], v[88:91], v[212:215]
    v_exp_f32 v210, v210
    v_mfma_f32_16x16x32_bf16 v[212:215], a[220:223], v[92:95], v[212:215]
    v_exp_f32 v211, v211
    v_mfma_f32_16x16x32_bf16 a[8:11], a[160:163], v[176:179], a[8:11]
    ds_read_b64_tr_b16 a[176:177], v22 offset:16384
    v_cvt_pk_bf16_f32 v128, v208, v209
    v_mfma_f32_16x16x32_bf16 a[8:11], a[164:167], v[180:183], a[8:11]
    ds_read_b64_tr_b16 a[178:179], v22 offset:20480
    v_add_f32_dpp v224, v224, v224 row_ror:2 row_mask:0xf bank_mask:0xf
    v_mfma_f32_16x16x32_bf16 a[12:15], a[164:167], v[188:191], a[12:15]
    ds_read_b128 a[232:235], v10 offset:36864
    v_cvt_pk_bf16_f32 v129, v210, v211
    v_mfma_f32_16x16x32_bf16 a[12:15], a[160:163], v[184:187], a[12:15]
    s_waitcnt lgkmcnt(3)
    buffer_load_dwordx4 v49, s[20:23], s49 offen offset:3072 lds
    v_mfma_f32_16x16x32_bf16 v[208:211], a[208:211], v[96:99], v[200:203]
    s_lshr_b32 s39, s2, 5
    v_exp_f32 v212, v212
    v_mfma_f32_16x16x32_bf16 v[208:211], a[212:215], v[100:103], v[208:211]
    s_lshl_b32 s39, s39, 3
    v_exp_f32 v213, v213
    v_mfma_f32_16x16x32_bf16 v[208:211], a[216:219], v[104:107], v[208:211]
    s_and_b32 s43, s2, 7
    v_exp_f32 v214, v214
    v_mfma_f32_16x16x32_bf16 v[208:211], a[220:223], v[108:111], v[208:211]
    s_add_u32 s39, s39, s43
    v_exp_f32 v215, v215
    v_mfma_f32_16x16x32_bf16 a[16:19], a[168:171], v[160:163], a[16:19]
    ds_read_b64_tr_b16 a[180:181], v22 offset:24576
    v_cvt_pk_bf16_f32 v136, v212, v213
    v_mfma_f32_16x16x32_bf16 a[16:19], a[172:175], v[164:167], a[16:19]
    ds_read_b64_tr_b16 a[182:183], v22 offset:28672
    v_add_f32_dpp v225, v225, v225 row_ror:2 row_mask:0xf bank_mask:0xf
    v_mfma_f32_16x16x32_bf16 a[20:23], a[172:175], v[172:175], a[20:23]
    ds_read_b128 a[236:239], v11 offset:36864
    v_cvt_pk_bf16_f32 v137, v214, v215
    v_mfma_f32_16x16x32_bf16 a[20:23], a[168:171], v[168:171], a[20:23]
    buffer_load_dword v253, v63, s[24:27], s54 offen offset:12 sc1
    v_smfmac_f32_16x16x64_bf16 a[192:195], v[52:55], v[160:167], v50
    v_mfma_f32_16x16x32_bf16 v[212:215], a[208:211], v[112:115], v[204:207]
    s_lshl_b32 s39, s39, 2
    v_exp_f32 v208, v208
    v_mfma_f32_16x16x32_bf16 v[212:215], a[212:215], v[116:119], v[212:215]
    s_add_u32 m0, s42, 114688
    v_exp_f32 v209, v209
    v_mfma_f32_16x16x32_bf16 v[212:215], a[216:219], v[120:123], v[212:215]
    s_bfe_u32 s43, s2, 0x20003
    v_exp_f32 v210, v210
    v_mfma_f32_16x16x32_bf16 v[212:215], a[220:223], v[124:127], v[212:215]
    s_add_u32 s39, s39, s43
    v_exp_f32 v211, v211
    v_mfma_f32_16x16x32_bf16 a[24:27], a[168:171], v[176:179], a[24:27]
    ds_read_b64_tr_b16 a[184:185], v23 offset:16384
    v_cvt_pk_bf16_f32 v144, v208, v209
    v_mfma_f32_16x16x32_bf16 a[24:27], a[172:175], v[180:183], a[24:27]
    ds_read_b64_tr_b16 a[186:187], v23 offset:20480
    v_add_f32_dpp v224, v224, v224 row_ror:4 row_mask:0xf bank_mask:0xf
    v_mfma_f32_16x16x32_bf16 a[28:31], a[172:175], v[188:191], a[28:31]
    ds_read_b128 a[208:211], v8 offset:40960
    v_cvt_pk_bf16_f32 v145, v210, v211
    v_mfma_f32_16x16x32_bf16 a[28:31], a[168:171], v[184:187], a[28:31]
    s_waitcnt lgkmcnt(3)
    buffer_load_dwordx4 v40, s[12:15], s41 offen lds
    v_mfma_f32_16x16x32_bf16 v[208:211], a[224:227], v[64:67], v[192:195]
    s_add_u32 s39, s39, 72
    v_exp_f32 v212, v212
    v_mfma_f32_16x16x32_bf16 v[208:211], a[228:231], v[68:71], v[208:211]
    s_cmp_lt_u32 s39, 216
    s_cselect_b32 s43, 0, 2147483648
    v_exp_f32 v213, v213
    v_mfma_f32_16x16x32_bf16 v[208:211], a[232:235], v[72:75], v[208:211]
    s_or_b32 s43, s43, s48
    v_exp_f32 v214, v214
    v_mfma_f32_16x16x32_bf16 v[208:211], a[236:239], v[76:79], v[208:211]
    s_add_u32 s57, s58, 2949120
    v_exp_f32 v215, v215
    v_mfma_f32_16x16x32_bf16 a[32:35], a[176:179], v[160:163], a[32:35]
    ds_read_b64_tr_b16 a[188:189], v23 offset:24576
    v_cvt_pk_bf16_f32 v152, v212, v213
    v_mfma_f32_16x16x32_bf16 a[32:35], a[180:183], v[164:167], a[32:35]
    ds_read_b64_tr_b16 a[190:191], v23 offset:28672
    v_add_f32_dpp v225, v225, v225 row_ror:4 row_mask:0xf bank_mask:0xf
    v_mfma_f32_16x16x32_bf16 a[36:39], a[180:183], v[172:175], a[36:39]
    ds_read_b128 a[212:215], v9 offset:40960
    v_cvt_pk_bf16_f32 v153, v214, v215
    v_mfma_f32_16x16x32_bf16 a[36:39], a[176:179], v[168:171], a[36:39]
    buffer_load_dwordx4 a[148:151], v254, s[80:83], s57 offen
    v_smfmac_f32_16x16x64_bf16 a[196:199], v[52:55], v[168:175], v50
    v_mfma_f32_16x16x32_bf16 v[212:215], a[224:227], v[80:83], v[196:199]
    s_and_b32 s43, s43, 2147483648
    v_exp_f32 v208, v208
    v_mfma_f32_16x16x32_bf16 v[212:215], a[228:231], v[84:87], v[212:215]
    s_sub_u32 s36, s39, 144
    v_exp_f32 v209, v209
    v_mfma_f32_16x16x32_bf16 v[212:215], a[232:235], v[88:91], v[212:215]
    s_cmp_lt_u32 s36, 36
    s_cselect_b32 s36, 1.0, 0
    v_exp_f32 v210, v210
    v_mfma_f32_16x16x32_bf16 v[212:215], a[236:239], v[92:95], v[212:215]
    s_lshr_b32 s44, s39, 1
    v_exp_f32 v211, v211
    v_mfma_f32_16x16x32_bf16 a[40:43], a[176:179], v[176:179], a[40:43]
    ds_read_b64_tr_b16 a[160:161], v24 offset:16384
    v_cvt_pk_bf16_f32 v130, v208, v209
    v_mfma_f32_16x16x32_bf16 a[40:43], a[180:183], v[180:183], a[40:43]
    ds_read_b64_tr_b16 a[162:163], v24 offset:20480
    v_add_f32_dpp v224, v224, v224 row_ror:8 row_mask:0xf bank_mask:0xf
    v_mfma_f32_16x16x32_bf16 a[44:47], a[180:183], v[188:191], a[44:47]
    ds_read_b128 a[216:219], v10 offset:40960
    v_cvt_pk_bf16_f32 v131, v210, v211
    v_mfma_f32_16x16x32_bf16 a[44:47], a[176:179], v[184:187], a[44:47]
    s_waitcnt lgkmcnt(3)
    buffer_load_dwordx4 v41, s[12:15], s41 offen offset:1024 lds
    v_mfma_f32_16x16x32_bf16 v[208:211], a[224:227], v[96:99], v[200:203]
    s_lshl_b32 s44, s44, 6
    v_exp_f32 v212, v212
    v_mfma_f32_16x16x32_bf16 v[208:211], a[228:231], v[100:103], v[208:211]
    s_and_b32 s39, s39, 1
    v_exp_f32 v213, v213
    v_mfma_f32_16x16x32_bf16 v[208:211], a[232:235], v[104:107], v[208:211]
    s_lshl_b32 s39, s39, 3
    v_exp_f32 v214, v214
    v_mfma_f32_16x16x32_bf16 v[208:211], a[236:239], v[108:111], v[208:211]
    s_add_u32 s39, s39, s44
    v_exp_f32 v215, v215
    v_mfma_f32_16x16x32_bf16 a[48:51], a[184:187], v[160:163], a[48:51]
    ds_read_b64_tr_b16 a[164:165], v24 offset:24576
    v_cvt_pk_bf16_f32 v138, v212, v213
    v_mfma_f32_16x16x32_bf16 a[48:51], a[188:191], v[164:167], a[48:51]
    ds_read_b64_tr_b16 a[166:167], v24 offset:28672
    v_add_f32_dpp v225, v225, v225 row_ror:8 row_mask:0xf bank_mask:0xf
    v_mfma_f32_16x16x32_bf16 a[52:55], a[188:191], v[172:175], a[52:55]
    ds_read_b128 a[220:223], v11 offset:40960
    v_cvt_pk_bf16_f32 v139, v214, v215
    v_mfma_f32_16x16x32_bf16 a[52:55], a[184:187], v[168:171], a[52:55]
    v_add_u32 v244, s38, v244
    v_and_b32 v245, 7, v1
    v_smfmac_f32_16x16x64_bf16 a[200:203], v[52:55], v[176:183], v50
    v_mfma_f32_16x16x32_bf16 v[212:215], a[224:227], v[112:115], v[204:207]
    s_add_u32 s39, s39, 16384
    v_exp_f32 v208, v208
    v_mfma_f32_16x16x32_bf16 v[212:215], a[228:231], v[116:119], v[212:215]
    s_or_b32 s39, s39, s43
    v_exp_f32 v209, v209
    v_mfma_f32_16x16x32_bf16 v[212:215], a[232:235], v[120:123], v[212:215]
    v_exp_f32 v210, v210
    v_mfma_f32_16x16x32_bf16 v[212:215], a[236:239], v[124:127], v[212:215]
    v_exp_f32 v211, v211
    v_mfma_f32_16x16x32_bf16 a[56:59], a[184:187], v[176:179], a[56:59]
    ds_read_b64_tr_b16 a[168:169], v25 offset:16384
    v_cvt_pk_bf16_f32 v146, v208, v209
    v_mfma_f32_16x16x32_bf16 a[56:59], a[188:191], v[180:183], a[56:59]
    ds_read_b64_tr_b16 a[170:171], v25 offset:20480
    v_mfma_f32_16x16x32_bf16 a[60:63], a[188:191], v[188:191], a[60:63]
    ds_read_b128 a[224:227], v8 offset:45056
    v_cvt_pk_bf16_f32 v147, v210, v211
    v_mfma_f32_16x16x32_bf16 a[60:63], a[184:187], v[184:187], a[60:63]
    s_waitcnt lgkmcnt(3)
    buffer_load_dwordx4 v40, s[12:15], s41 offen offset:2048 lds
    v_mfma_f32_16x16x32_bf16 v[208:211], a[208:211], v[64:67], v[192:195]
    v_exp_f32 v212, v212
    v_mfma_f32_16x16x32_bf16 v[208:211], a[212:215], v[68:71], v[208:211]
    v_exp_f32 v213, v213
    v_mfma_f32_16x16x32_bf16 v[208:211], a[216:219], v[72:75], v[208:211]
    v_exp_f32 v214, v214
    v_mfma_f32_16x16x32_bf16 v[208:211], a[220:223], v[76:79], v[208:211]
    s_add_u32 s57, s58, 3538944
    v_exp_f32 v215, v215
    v_mfma_f32_16x16x32_bf16 a[64:67], a[160:163], v[160:163], a[64:67]
    ds_read_b64_tr_b16 a[172:173], v25 offset:24576
    v_cvt_pk_bf16_f32 v154, v212, v213
    v_mfma_f32_16x16x32_bf16 a[64:67], a[164:167], v[164:167], a[64:67]
    ds_read_b64_tr_b16 a[174:175], v25 offset:28672
    v_lshlrev_b32 v245, 3, v245
    v_mfma_f32_16x16x32_bf16 a[68:71], a[164:167], v[172:175], a[68:71]
    ds_read_b128 a[228:231], v9 offset:45056
    v_cvt_pk_bf16_f32 v155, v214, v215
    v_mfma_f32_16x16x32_bf16 a[68:71], a[160:163], v[168:171], a[68:71]
    buffer_load_dwordx4 a[152:155], v254, s[80:83], s57 offen
    v_smfmac_f32_16x16x64_bf16 a[204:207], v[52:55], v[184:191], v50
    ds_write_b64 v244, v[224:225]
    v_mfma_f32_16x16x32_bf16 v[212:215], a[208:211], v[80:83], v[196:199]
    v_exp_f32 v208, v208
    v_mfma_f32_16x16x32_bf16 v[212:215], a[212:215], v[84:87], v[212:215]
    v_exp_f32 v209, v209
    v_mfma_f32_16x16x32_bf16 v[212:215], a[216:219], v[88:91], v[212:215]
    v_exp_f32 v210, v210
    v_mfma_f32_16x16x32_bf16 v[212:215], a[220:223], v[92:95], v[212:215]
    v_exp_f32 v211, v211
    v_mfma_f32_16x16x32_bf16 a[72:75], a[160:163], v[176:179], a[72:75]
    ds_read_b64_tr_b16 a[176:177], v26 offset:16384
    v_cvt_pk_bf16_f32 v132, v208, v209
    v_mfma_f32_16x16x32_bf16 a[72:75], a[164:167], v[180:183], a[72:75]
    ds_read_b64_tr_b16 a[178:179], v26 offset:20480
    v_add_u32 v245, 131136, v245
    v_mfma_f32_16x16x32_bf16 a[76:79], a[164:167], v[188:191], a[76:79]
    ds_read_b128 a[232:235], v10 offset:45056
    v_cvt_pk_bf16_f32 v133, v210, v211
    v_mfma_f32_16x16x32_bf16 a[76:79], a[160:163], v[184:187], a[76:79]
    s_waitcnt lgkmcnt(3)
    buffer_load_dwordx4 v41, s[12:15], s41 offen offset:3072 lds
    v_mfma_f32_16x16x32_bf16 v[208:211], a[208:211], v[96:99], v[200:203]
    v_exp_f32 v212, v212
    v_mfma_f32_16x16x32_bf16 v[208:211], a[212:215], v[100:103], v[208:211]
    s_add_u32 s41, s41, 16384
    v_exp_f32 v213, v213
    v_mfma_f32_16x16x32_bf16 v[208:211], a[216:219], v[104:107], v[208:211]
    v_exp_f32 v214, v214
    v_mfma_f32_16x16x32_bf16 v[208:211], a[220:223], v[108:111], v[208:211]
    v_exp_f32 v215, v215
    v_mfma_f32_16x16x32_bf16 a[80:83], a[168:171], v[160:163], a[80:83]
    ds_read_b64_tr_b16 a[180:181], v26 offset:24576
    v_cvt_pk_bf16_f32 v140, v212, v213
    v_mfma_f32_16x16x32_bf16 a[80:83], a[172:175], v[164:167], a[80:83]
    ds_read_b64_tr_b16 a[182:183], v26 offset:28672
    v_mfma_f32_16x16x32_bf16 a[84:87], a[172:175], v[172:175], a[84:87]
    ds_read_b128 a[236:239], v11 offset:45056
    v_cvt_pk_bf16_f32 v141, v214, v215
    v_mfma_f32_16x16x32_bf16 a[84:87], a[168:171], v[168:171], a[84:87]
    s_waitcnt vmcnt(14)
    s_barrier
    v_mfma_f32_16x16x32_bf16 v[212:215], a[208:211], v[112:115], v[204:207]
    v_exp_f32 v208, v208
    v_mfma_f32_16x16x32_bf16 v[212:215], a[212:215], v[116:119], v[212:215]
    s_add_u32 s49, s45, 74752
    v_exp_f32 v209, v209
    v_mfma_f32_16x16x32_bf16 v[212:215], a[216:219], v[120:123], v[212:215]
    s_add_u32 m0, s42, 16384
    v_exp_f32 v210, v210
    v_mfma_f32_16x16x32_bf16 v[212:215], a[220:223], v[124:127], v[212:215]
    v_exp_f32 v211, v211
    v_mfma_f32_16x16x32_bf16 a[88:91], a[168:171], v[176:179], a[88:91]
    ds_read_b64_tr_b16 a[184:185], v27 offset:16384
    v_cvt_pk_bf16_f32 v148, v208, v209
    v_mfma_f32_16x16x32_bf16 a[88:91], a[172:175], v[180:183], a[88:91]
    ds_read_b64_tr_b16 a[186:187], v27 offset:20480
    ds_read_b64 v[224:225], v245 offset:0
    v_mfma_f32_16x16x32_bf16 a[92:95], a[172:175], v[188:191], a[92:95]
    ds_read_b128 a[208:211], v8 offset:49152
    v_cvt_pk_bf16_f32 v149, v210, v211
    v_mfma_f32_16x16x32_bf16 a[92:95], a[168:171], v[184:187], a[92:95]
    s_waitcnt lgkmcnt(3)
    buffer_load_dwordx4 v46, s[20:23], s49 offen lds
    v_mfma_f32_16x16x32_bf16 v[208:211], a[224:227], v[64:67], v[192:195]
    v_exp_f32 v212, v212
    v_mfma_f32_16x16x32_bf16 v[208:211], a[228:231], v[68:71], v[208:211]
    v_exp_f32 v213, v213
    v_mfma_f32_16x16x32_bf16 v[208:211], a[232:235], v[72:75], v[208:211]
    v_exp_f32 v214, v214
    v_mfma_f32_16x16x32_bf16 v[208:211], a[236:239], v[76:79], v[208:211]
    s_add_u32 s37, s55, 8192
    v_exp_f32 v215, v215
    v_mfma_f32_16x16x32_bf16 a[96:99], a[176:179], v[160:163], a[96:99]
    ds_read_b64_tr_b16 a[188:189], v27 offset:24576
    v_cvt_pk_bf16_f32 v156, v212, v213
    v_mfma_f32_16x16x32_bf16 a[96:99], a[180:183], v[164:167], a[96:99]
    ds_read_b64_tr_b16 a[190:191], v27 offset:28672
    ds_read_b64 v[226:227], v245 offset:64
    v_mfma_f32_16x16x32_bf16 a[100:103], a[180:183], v[172:175], a[100:103]
    ds_read_b128 a[212:215], v9 offset:49152
    v_cvt_pk_bf16_f32 v157, v214, v215
    v_mfma_f32_16x16x32_bf16 a[100:103], a[176:179], v[168:171], a[100:103]
    buffer_load_dword v234, v238, s[28:31], s37 offen
    v_mfma_f32_16x16x32_bf16 v[212:215], a[224:227], v[80:83], v[196:199]
    v_exp_f32 v208, v208
    v_mfma_f32_16x16x32_bf16 v[212:215], a[228:231], v[84:87], v[212:215]
    v_exp_f32 v209, v209
    v_mfma_f32_16x16x32_bf16 v[212:215], a[232:235], v[88:91], v[212:215]
    v_exp_f32 v210, v210
    v_mfma_f32_16x16x32_bf16 v[212:215], a[236:239], v[92:95], v[212:215]
    v_exp_f32 v211, v211
    v_mfma_f32_16x16x32_bf16 a[104:107], a[176:179], v[176:179], a[104:107]
    ds_read_b64_tr_b16 a[160:161], v20 offset:32768
    v_cvt_pk_bf16_f32 v134, v208, v209
    v_mfma_f32_16x16x32_bf16 a[104:107], a[180:183], v[180:183], a[104:107]
    ds_read_b64_tr_b16 a[162:163], v20 offset:36864
    ds_read_b64 v[228:229], v245 offset:128
    v_mfma_f32_16x16x32_bf16 a[108:111], a[180:183], v[188:191], a[108:111]
    ds_read_b128 a[216:219], v10 offset:49152
    v_cvt_pk_bf16_f32 v135, v210, v211
    v_mfma_f32_16x16x32_bf16 a[108:111], a[176:179], v[184:187], a[108:111]
    s_waitcnt lgkmcnt(3)
    buffer_load_dwordx4 v47, s[20:23], s49 offen offset:1024 lds
    v_mfma_f32_16x16x32_bf16 v[208:211], a[224:227], v[96:99], v[200:203]
    v_exp_f32 v212, v212
    v_mfma_f32_16x16x32_bf16 v[208:211], a[228:231], v[100:103], v[208:211]
    v_exp_f32 v213, v213
    v_mfma_f32_16x16x32_bf16 v[208:211], a[232:235], v[104:107], v[208:211]
    v_exp_f32 v214, v214
    v_mfma_f32_16x16x32_bf16 v[208:211], a[236:239], v[108:111], v[208:211]
    s_add_u32 s57, s58, 4128768
    v_exp_f32 v215, v215
    v_mfma_f32_16x16x32_bf16 a[112:115], a[184:187], v[160:163], a[112:115]
    ds_read_b64_tr_b16 a[164:165], v20 offset:40960
    v_cvt_pk_bf16_f32 v142, v212, v213
    v_mfma_f32_16x16x32_bf16 a[112:115], a[188:191], v[164:167], a[112:115]
    ds_read_b64_tr_b16 a[166:167], v20 offset:45056
    ds_read_b64 v[230:231], v245 offset:192
    v_mfma_f32_16x16x32_bf16 a[116:119], a[188:191], v[172:175], a[116:119]
    ds_read_b128 a[220:223], v11 offset:49152
    v_cvt_pk_bf16_f32 v143, v214, v215
    v_mfma_f32_16x16x32_bf16 a[116:119], a[184:187], v[168:171], a[116:119]
    buffer_load_dwordx4 a[156:159], v254, s[80:83], s57 offen
    v_mfma_f32_16x16x32_bf16 v[212:215], a[224:227], v[112:115], v[204:207]
    v_exp_f32 v208, v208
    v_mfma_f32_16x16x32_bf16 v[212:215], a[228:231], v[116:119], v[212:215]
    v_exp_f32 v209, v209
    v_mfma_f32_16x16x32_bf16 v[212:215], a[232:235], v[120:123], v[212:215]
    v_exp_f32 v210, v210
    v_mfma_f32_16x16x32_bf16 v[212:215], a[236:239], v[124:127], v[212:215]
    v_exp_f32 v211, v211
    v_mfma_f32_16x16x32_bf16 a[120:123], a[184:187], v[176:179], a[120:123]
    ds_read_b64_tr_b16 a[168:169], v21 offset:32768
    v_cvt_pk_bf16_f32 v150, v208, v209
    v_mfma_f32_16x16x32_bf16 a[120:123], a[188:191], v[180:183], a[120:123]
    ds_read_b64_tr_b16 a[170:171], v21 offset:36864
    v_mfma_f32_16x16x32_bf16 a[124:127], a[188:191], v[188:191], a[124:127]
    ds_read_b128 a[224:227], v8 offset:53248
    v_cvt_pk_bf16_f32 v151, v210, v211
    v_mfma_f32_16x16x32_bf16 a[124:127], a[184:187], v[184:187], a[124:127]
    s_waitcnt lgkmcnt(3)
    buffer_load_dwordx4 v48, s[20:23], s49 offen offset:2048 lds
    v_mfma_f32_16x16x32_bf16 v[208:211], a[208:211], v[64:67], v[192:195]
    v_exp_f32 v212, v212
    v_mfma_f32_16x16x32_bf16 v[208:211], a[212:215], v[68:71], v[208:211]
    v_exp_f32 v213, v213
    v_mfma_f32_16x16x32_bf16 v[208:211], a[216:219], v[72:75], v[208:211]
    v_exp_f32 v214, v214
    v_mfma_f32_16x16x32_bf16 v[208:211], a[220:223], v[76:79], v[208:211]
    s_add_u32 s57, s58, 4718592
    v_exp_f32 v215, v215
    v_mfma_f32_16x16x32_bf16 a[0:3], a[160:163], v[128:131], a[0:3]
    ds_read_b64_tr_b16 a[172:173], v21 offset:40960
    v_cvt_pk_bf16_f32 v158, v212, v213
    v_mfma_f32_16x16x32_bf16 a[0:3], a[164:167], v[132:135], a[0:3]
    ds_read_b64_tr_b16 a[174:175], v21 offset:45056
    v_add_f32 v224, v224, v228
    v_mfma_f32_16x16x32_bf16 a[4:7], a[164:167], v[140:143], a[4:7]
    ds_read_b128 a[228:231], v9 offset:53248
    v_cvt_pk_bf16_f32 v159, v214, v215
    v_mfma_f32_16x16x32_bf16 a[4:7], a[160:163], v[136:139], a[4:7]
    buffer_load_dwordx4 a[240:243], v254, s[80:83], s57 offen
    v_mfma_f32_16x16x32_bf16 v[212:215], a[208:211], v[80:83], v[196:199]
    v_exp_f32 v208, v208
    v_mfma_f32_16x16x32_bf16 v[212:215], a[212:215], v[84:87], v[212:215]
    v_exp_f32 v209, v209
    v_mfma_f32_16x16x32_bf16 v[212:215], a[216:219], v[88:91], v[212:215]
    v_exp_f32 v210, v210
    v_mfma_f32_16x16x32_bf16 v[212:215], a[220:223], v[92:95], v[212:215]
    v_exp_f32 v211, v211
    v_mfma_f32_16x16x32_bf16 a[8:11], a[160:163], v[144:147], a[8:11]
    ds_read_b64_tr_b16 a[176:177], v22 offset:32768
    v_cvt_pk_bf16_f32 v160, v208, v209
    v_mfma_f32_16x16x32_bf16 a[8:11], a[164:167], v[148:151], a[8:11]
    ds_read_b64_tr_b16 a[178:179], v22 offset:36864
    v_add_f32 v225, v225, v229
    v_mfma_f32_16x16x32_bf16 a[12:15], a[164:167], v[156:159], a[12:15]
    ds_read_b128 a[232:235], v10 offset:53248
    v_cvt_pk_bf16_f32 v161, v210, v211
    v_mfma_f32_16x16x32_bf16 a[12:15], a[160:163], v[152:155], a[12:15]
    s_waitcnt lgkmcnt(3)
    buffer_load_dwordx4 v49, s[20:23], s49 offen offset:3072 lds
    v_mfma_f32_16x16x32_bf16 v[208:211], a[208:211], v[96:99], v[200:203]
    v_exp_f32 v212, v212
    v_mfma_f32_16x16x32_bf16 v[208:211], a[212:215], v[100:103], v[208:211]
    v_exp_f32 v213, v213
    v_mfma_f32_16x16x32_bf16 v[208:211], a[216:219], v[104:107], v[208:211]
    v_exp_f32 v214, v214
    v_mfma_f32_16x16x32_bf16 v[208:211], a[220:223], v[108:111], v[208:211]
    v_exp_f32 v215, v215
    v_mfma_f32_16x16x32_bf16 a[16:19], a[168:171], v[128:131], a[16:19]
    ds_read_b64_tr_b16 a[180:181], v22 offset:40960
    v_cvt_pk_bf16_f32 v168, v212, v213
    v_mfma_f32_16x16x32_bf16 a[16:19], a[172:175], v[132:135], a[16:19]
    ds_read_b64_tr_b16 a[182:183], v22 offset:45056
    v_add_f32 v226, v226, v230
    v_mfma_f32_16x16x32_bf16 a[20:23], a[172:175], v[140:143], a[20:23]
    ds_read_b128 a[236:239], v11 offset:53248
    v_cvt_pk_bf16_f32 v169, v214, v215
    v_mfma_f32_16x16x32_bf16 a[20:23], a[168:171], v[136:139], a[20:23]
    v_add_f32 v227, v227, v231
    v_add_f32 v224, v224, v226
    v_smfmac_f32_16x16x64_bf16 a[192:195], v[52:55], v[128:135], v50
    v_mfma_f32_16x16x32_bf16 v[212:215], a[208:211], v[112:115], v[204:207]
    v_exp_f32 v208, v208
    v_mfma_f32_16x16x32_bf16 v[212:215], a[212:215], v[116:119], v[212:215]
    s_add_u32 s49, s7, 0
    v_exp_f32 v209, v209
    v_mfma_f32_16x16x32_bf16 v[212:215], a[216:219], v[120:123], v[212:215]
    s_add_u32 m0, s42, 65536
    v_exp_f32 v210, v210
    v_mfma_f32_16x16x32_bf16 v[212:215], a[220:223], v[124:127], v[212:215]
    v_exp_f32 v211, v211
    v_mfma_f32_16x16x32_bf16 a[24:27], a[168:171], v[144:147], a[24:27]
    ds_read_b64_tr_b16 a[184:185], v23 offset:32768
    v_cvt_pk_bf16_f32 v176, v208, v209
    v_mfma_f32_16x16x32_bf16 a[24:27], a[172:175], v[148:151], a[24:27]
    ds_read_b64_tr_b16 a[186:187], v23 offset:36864
    v_add_f32 v225, v225, v227
    v_mfma_f32_16x16x32_bf16 a[28:31], a[172:175], v[156:159], a[28:31]
    ds_read_b128 a[208:211], v8 offset:57344
    v_cvt_pk_bf16_f32 v177, v210, v211
    v_mfma_f32_16x16x32_bf16 a[28:31], a[168:171], v[152:155], a[28:31]
    s_waitcnt lgkmcnt(3)
    buffer_load_dwordx4 v46, s[20:23], s49 offen lds
    v_mfma_f32_16x16x32_bf16 v[208:211], a[224:227], v[64:67], v[192:195]
    v_exp_f32 v212, v212
    v_mfma_f32_16x16x32_bf16 v[208:211], a[228:231], v[68:71], v[208:211]
    v_exp_f32 v213, v213
    v_mfma_f32_16x16x32_bf16 v[208:211], a[232:235], v[72:75], v[208:211]
    v_exp_f32 v214, v214
    v_mfma_f32_16x16x32_bf16 v[208:211], a[236:239], v[76:79], v[208:211]
    s_add_u32 s57, s58, 4128768
    v_exp_f32 v215, v215
    v_mfma_f32_16x16x32_bf16 a[32:35], a[176:179], v[128:131], a[32:35]
    ds_read_b64_tr_b16 a[188:189], v23 offset:40960
    v_cvt_pk_bf16_f32 v184, v212, v213
    v_mfma_f32_16x16x32_bf16 a[32:35], a[180:183], v[132:135], a[32:35]
    ds_read_b64_tr_b16 a[190:191], v23 offset:45056
    v_cvt_pk_bf16_f32 v246, v224, v225
    v_mfma_f32_16x16x32_bf16 a[36:39], a[180:183], v[140:143], a[36:39]
    ds_read_b128 a[212:215], v9 offset:57344
    v_cvt_pk_bf16_f32 v185, v214, v215
    v_mfma_f32_16x16x32_bf16 a[36:39], a[176:179], v[136:139], a[36:39]
    buffer_load_dwordx4 a[244:247], v254, s[32:35], s57 offen
    v_smfmac_f32_16x16x64_bf16 a[196:199], v[52:55], v[136:143], v50
    v_lshrrev_b32 v222, 5, v0
    v_mfma_f32_16x16x32_bf16 v[212:215], a[224:227], v[80:83], v[196:199]
    s_getpc_b64 s[16:17]
Lattn_pc2:
    v_exp_f32 v208, v208
    v_mfma_f32_16x16x32_bf16 v[212:215], a[228:231], v[84:87], v[212:215]
    s_mov_b32 s18, Lattn_redo-Lattn_pc2
    v_exp_f32 v209, v209
    v_mfma_f32_16x16x32_bf16 v[212:215], a[232:235], v[88:91], v[212:215]
    s_lshr_b32 s37, s2, 3
    v_exp_f32 v210, v210
    v_mfma_f32_16x16x32_bf16 v[212:215], a[236:239], v[92:95], v[212:215]
    v_exp_f32 v211, v211
    v_mfma_f32_16x16x32_bf16 a[40:43], a[176:179], v[144:147], a[40:43]
    ds_read_b64_tr_b16 a[160:161], v24 offset:32768
    v_cvt_pk_bf16_f32 v162, v208, v209
    v_mfma_f32_16x16x32_bf16 a[40:43], a[180:183], v[148:151], a[40:43]
    ds_read_b64_tr_b16 a[162:163], v24 offset:36864
    v_lshlrev_b32 v222, 12, v222
    v_mfma_f32_16x16x32_bf16 a[44:47], a[180:183], v[156:159], a[44:47]
    ds_read_b128 a[216:219], v10 offset:57344
    v_cvt_pk_bf16_f32 v163, v210, v211
    v_mfma_f32_16x16x32_bf16 a[44:47], a[176:179], v[152:155], a[44:47]
    s_waitcnt lgkmcnt(3)
    buffer_load_dwordx4 v47, s[20:23], s49 offen offset:1024 lds
    v_mfma_f32_16x16x32_bf16 v[208:211], a[224:227], v[96:99], v[200:203]
    s_lshl_b32 s37, s37, 7
    v_exp_f32 v212, v212
    v_mfma_f32_16x16x32_bf16 v[208:211], a[228:231], v[100:103], v[208:211]
    v_exp_f32 v213, v213
    v_mfma_f32_16x16x32_bf16 v[208:211], a[232:235], v[104:107], v[208:211]
    v_exp_f32 v214, v214
    v_mfma_f32_16x16x32_bf16 v[208:211], a[236:239], v[108:111], v[208:211]
    v_exp_f32 v215, v215
    v_mfma_f32_16x16x32_bf16 a[48:51], a[184:187], v[128:131], a[48:51]
    ds_read_b64_tr_b16 a[164:165], v24 offset:40960
    v_cvt_pk_bf16_f32 v170, v212, v213
    v_mfma_f32_16x16x32_bf16 a[48:51], a[188:191], v[132:135], a[48:51]
    ds_read_b64_tr_b16 a[166:167], v24 offset:45056
    v_lshlrev_b32 v224, 16, v246
    v_mfma_f32_16x16x32_bf16 a[52:55], a[188:191], v[140:143], a[52:55]
    ds_read_b128 a[220:223], v11 offset:57344
    v_cvt_pk_bf16_f32 v171, v214, v215
    v_mfma_f32_16x16x32_bf16 a[52:55], a[184:187], v[136:139], a[52:55]
    buffer_load_dword v222, v222, s[16:19], s37 offen
    v_smfmac_f32_16x16x64_bf16 a[200:203], v[52:55], v[144:151], v50
    v_mfma_f32_16x16x32_bf16 v[212:215], a[224:227], v[112:115], v[204:207]
    v_exp_f32 v208, v208
    v_mfma_f32_16x16x32_bf16 v[212:215], a[228:231], v[116:119], v[212:215]
    v_exp_f32 v209, v209
    v_mfma_f32_16x16x32_bf16 v[212:215], a[232:235], v[120:123], v[212:215]
    v_exp_f32 v210, v210
    v_mfma_f32_16x16x32_bf16 v[212:215], a[236:239], v[124:127], v[212:215]
    v_exp_f32 v211, v211
    v_mfma_f32_16x16x32_bf16 a[56:59], a[184:187], v[144:147], a[56:59]
    ds_read_b64_tr_b16 a[168:169], v25 offset:32768
    v_cvt_pk_bf16_f32 v178, v208, v209
    v_mfma_f32_16x16x32_bf16 a[56:59], a[188:191], v[148:151], a[56:59]
    ds_read_b64_tr_b16 a[170:171], v25 offset:36864
    v_and_b32 v225, 0xffff0000, v246
    v_mfma_f32_16x16x32_bf16 a[60:63], a[188:191], v[156:159], a[60:63]
    ds_read_b128 a[224:227], v8 offset:61440
    v_cvt_pk_bf16_f32 v179, v210, v211
    v_mfma_f32_16x16x32_bf16 a[60:63], a[184:187], v[152:155], a[60:63]
    s_waitcnt lgkmcnt(3)
    buffer_load_dwordx4 v48, s[20:23], s49 offen offset:2048 lds
    v_mfma_f32_16x16x32_bf16 v[208:211], a[208:211], v[64:67], v[192:195]
    v_exp_f32 v212, v212
    v_mfma_f32_16x16x32_bf16 v[208:211], a[212:215], v[68:71], v[208:211]
    v_exp_f32 v213, v213
    v_mfma_f32_16x16x32_bf16 v[208:211], a[216:219], v[72:75], v[208:211]
    v_exp_f32 v214, v214
    v_mfma_f32_16x16x32_bf16 v[208:211], a[220:223], v[76:79], v[208:211]
    s_add_u32 s57, s58, 4718592
    v_exp_f32 v215, v215
    v_mfma_f32_16x16x32_bf16 a[64:67], a[160:163], v[128:131], a[64:67]
Ltour0_7:
    s_cbranch_execz Ltour0_11
    ds_read_b64_tr_b16 a[172:173], v25 offset:40960
    v_cvt_pk_bf16_f32 v186, v212, v213
    v_mfma_f32_16x16x32_bf16 a[64:67], a[164:167], v[132:135], a[64:67]
    ds_read_b64_tr_b16 a[174:175], v25 offset:45056
    v_add_f32 v224, s36, v224
    v_mfma_f32_16x16x32_bf16 a[68:71], a[164:167], v[140:143], a[68:71]
    ds_read_b128 a[228:231], v9 offset:61440
    v_cvt_pk_bf16_f32 v187, v214, v215
    v_mfma_f32_16x16x32_bf16 a[68:71], a[160:163], v[136:139], a[68:71]
    buffer_load_dwordx4 a[248:251], v254, s[32:35], s57 offen
    v_smfmac_f32_16x16x64_bf16 a[204:207], v[52:55], v[152:159], v50
    v_mfma_f32_16x16x32_bf16 v[212:215], a[208:211], v[80:83], v[196:199]
    v_exp_f32 v208, v208
    v_mfma_f32_16x16x32_bf16 v[212:215], a[212:215], v[84:87], v[212:215]
    v_exp_f32 v209, v209
    v_mfma_f32_16x16x32_bf16 v[212:215], a[216:219], v[88:91], v[212:215]
    v_exp_f32 v210, v210
    v_mfma_f32_16x16x32_bf16 v[212:215], a[220:223], v[92:95], v[212:215]
    v_exp_f32 v211, v211
    v_mfma_f32_16x16x32_bf16 a[72:75], a[160:163], v[144:147], a[72:75]
    ds_read_b64_tr_b16 a[176:177], v26 offset:32768
    v_cvt_pk_bf16_f32 v164, v208, v209
    v_mfma_f32_16x16x32_bf16 a[72:75], a[164:167], v[148:151], a[72:75]
    ds_read_b64_tr_b16 a[178:179], v26 offset:36864
    v_add_f32 v225, s36, v225
    v_mfma_f32_16x16x32_bf16 a[76:79], a[164:167], v[156:159], a[76:79]
    ds_read_b128 a[232:235], v10 offset:61440
    v_cvt_pk_bf16_f32 v165, v210, v211
    v_mfma_f32_16x16x32_bf16 a[76:79], a[160:163], v[152:155], a[76:79]
    s_waitcnt lgkmcnt(3)
    buffer_load_dwordx4 v49, s[20:23], s49 offen offset:3072 lds
    v_mfma_f32_16x16x32_bf16 v[208:211], a[208:211], v[96:99], v[200:203]
    v_exp_f32 v212, v212
    v_mfma_f32_16x16x32_bf16 v[208:211], a[212:215], v[100:103], v[208:211]
    v_exp_f32 v213, v213
    v_mfma_f32_16x16x32_bf16 v[208:211], a[216:219], v[104:107], v[208:211]
    v_exp_f32 v214, v214
    v_mfma_f32_16x16x32_bf16 v[208:211], a[220:223], v[108:111], v[208:211]
    v_exp_f32 v215, v215
    v_mfma_f32_16x16x32_bf16 a[80:83], a[168:171], v[128:131], a[80:83]
    ds_read_b64_tr_b16 a[180:181], v26 offset:40960
    v_cvt_pk_bf16_f32 v172, v212, v213
    v_mfma_f32_16x16x32_bf16 a[80:83], a[172:175], v[132:135], a[80:83]
    ds_read_b64_tr_b16 a[182:183], v26 offset:45056
    v_cvt_pk_bf16_f32 v246, v224, v225
    v_mfma_f32_16x16x32_bf16 a[84:87], a[172:175], v[140:143], a[84:87]
    ds_read_b128 a[236:239], v11 offset:61440
    v_cvt_pk_bf16_f32 v173, v214, v215
    v_mfma_f32_16x16x32_bf16 a[84:87], a[168:171], v[136:139], a[84:87]
    s_waitcnt vmcnt(14)
    s_barrier
    v_mfma_f32_16x16x32_bf16 v[212:215], a[208:211], v[112:115], v[204:207]
    v_exp_f32 v208, v208
    v_mfma_f32_16x16x32_bf16 v[212:215], a[212:215], v[116:119], v[212:215]
    s_add_u32 s49, s7, 73728
    v_exp_f32 v209, v209
    v_mfma_f32_16x16x32_bf16 v[212:215], a[216:219], v[120:123], v[212:215]
    s_add_u32 m0, s42, 81920
    v_exp_f32 v210, v210
    v_mfma_f32_16x16x32_bf16 v[212:215], a[220:223], v[124:127], v[212:215]
    v_exp_f32 v211, v211
    v_mfma_f32_16x16x32_bf16 a[88:91], a[168:171], v[144:147], a[88:91]
    ds_read_b64_tr_b16 a[184:185], v27 offset:32768
    v_cvt_pk_bf16_f32 v180, v208, v209
    v_mfma_f32_16x16x32_bf16 a[88:91], a[172:175], v[148:151], a[88:91]
    ds_read_b64_tr_b16 a[186:187], v27 offset:36864
    v_lshrrev_b32 v244, 1, v0
    v_mfma_f32_16x16x32_bf16 a[92:95], a[172:175], v[156:159], a[92:95]
    v_cvt_pk_bf16_f32 v181, v210, v211
    v_mfma_f32_16x16x32_bf16 a[92:95], a[168:171], v[152:155], a[92:95]
    s_waitcnt lgkmcnt(3)
    buffer_load_dwordx4 v46, s[20:23], s49 offen lds
    v_mfma_f32_16x16x32_bf16 v[208:211], a[224:227], v[64:67], v[192:195]
    v_exp_f32 v212, v212
    v_mfma_f32_16x16x32_bf16 v[208:211], a[228:231], v[68:71], v[208:211]
    v_exp_f32 v213, v213
    v_mfma_f32_16x16x32_bf16 v[208:211], a[232:235], v[72:75], v[208:211]
    s_waitcnt lgkmcnt(2)
    v_exp_f32 v214, v214
    v_mfma_f32_16x16x32_bf16 v[208:211], a[236:239], v[76:79], v[208:211]
    v_exp_f32 v215, v215
    v_mfma_f32_16x16x32_bf16 a[96:99], a[176:179], v[128:131], a[96:99]
    ds_read_b64_tr_b16 a[188:189], v27 offset:40960
    v_cvt_pk_bf16_f32 v188, v212, v213
    v_mfma_f32_16x16x32_bf16 a[96:99], a[180:183], v[132:135], a[96:99]
    ds_read_b64_tr_b16 a[190:191], v27 offset:45056
    v_lshlrev_b32 v244, 4, v244
    v_mfma_f32_16x16x32_bf16 a[100:103], a[180:183], v[140:143], a[100:103]
    v_cvt_pk_bf16_f32 v189, v214, v215
    v_mfma_f32_16x16x32_bf16 a[100:103], a[176:179], v[136:139], a[100:103]
    v_and_b32 v245, 1, v0
    v_lshl_add_u32 v244, v245, 2, v244
    v_mfma_f32_16x16x32_bf16 v[212:215], a[224:227], v[80:83], v[196:199]
    v_exp_f32 v208, v208
    v_mfma_f32_16x16x32_bf16 v[212:215], a[228:231], v[84:87], v[212:215]
    v_exp_f32 v209, v209
    v_mfma_f32_16x16x32_bf16 v[212:215], a[232:235], v[88:91], v[212:215]
    v_exp_f32 v210, v210
    v_mfma_f32_16x16x32_bf16 v[212:215], a[236:239], v[92:95], v[212:215]
    v_exp_f32 v211, v211
    v_mfma_f32_16x16x32_bf16 a[104:107], a[176:179], v[144:147], a[104:107]
    ds_read_b64_tr_b16 a[160:161], v20 offset:49152
    v_cvt_pk_bf16_f32 v166, v208, v209
    v_mfma_f32_16x16x32_bf16 a[104:107], a[180:183], v[148:151], a[104:107]
    ds_read_b64_tr_b16 a[162:163], v20 offset:53248
    v_lshrrev_b32 v245, 3, v0
    v_mfma_f32_16x16x32_bf16 a[108:111], a[180:183], v[156:159], a[108:111]
    v_cvt_pk_bf16_f32 v167, v210, v211
    v_mfma_f32_16x16x32_bf16 a[108:111], a[176:179], v[152:155], a[108:111]
    s_waitcnt lgkmcnt(3)
    buffer_load_dwordx4 v47, s[20:23], s49 offen offset:1024 lds
    v_mfma_f32_16x16x32_bf16 v[208:211], a[224:227], v[96:99], v[200:203]
    v_exp_f32 v212, v212
    v_mfma_f32_16x16x32_bf16 v[208:211], a[228:231], v[100:103], v[208:211]
    v_exp_f32 v213, v213
    v_mfma_f32_16x16x32_bf16 v[208:211], a[232:235], v[104:107], v[208:211]
    v_exp_f32 v214, v214
    v_mfma_f32_16x16x32_bf16 v[208:211], a[236:239], v[108:111], v[208:211]
    s_add_u32 s57, s59, 0
    v_exp_f32 v215, v215
    v_mfma_f32_16x16x32_bf16 a[112:115], a[184:187], v[128:131], a[112:115]
    s_waitcnt lgkmcnt(2)
    ds_read_b64_tr_b16 a[164:165], v20 offset:57344
    v_cvt_pk_bf16_f32 v174, v212, v213
    v_mfma_f32_16x16x32_bf16 a[112:115], a[188:191], v[132:135], a[112:115]
    ds_read_b64_tr_b16 a[166:167], v20 offset:61440
    v_min_u32 v245, 1, v245
    v_mfma_f32_16x16x32_bf16 a[116:119], a[188:191], v[140:143], a[116:119]
    v_cvt_pk_bf16_f32 v175, v214, v215
    v_mfma_f32_16x16x32_bf16 a[116:119], a[184:187], v[136:139], a[116:119]
    buffer_load_dwordx4 a[252:255], v255, s[84:87], s57 offen
    v_mfma_f32_16x16x32_bf16 v[212:215], a[224:227], v[112:115], v[204:207]
    v_exp_f32 v208, v208
    v_mfma_f32_16x16x32_bf16 v[212:215], a[228:231], v[116:119], v[212:215]
    v_exp_f32 v209, v209
    v_mfma_f32_16x16x32_bf16 v[212:215], a[232:235], v[120:123], v[212:215]
    v_exp_f32 v210, v210
    v_mfma_f32_16x16x32_bf16 v[212:215], a[236:239], v[124:127], v[212:215]
    v_exp_f32 v211, v211
    v_mfma_f32_16x16x32_bf16 a[120:123], a[184:187], v[144:147], a[120:123]
    ds_read_b64_tr_b16 a[168:169], v21 offset:49152
    v_cvt_pk_bf16_f32 v182, v208, v209
    v_mfma_f32_16x16x32_bf16 a[120:123], a[188:191], v[148:151], a[120:123]
    ds_read_b64_tr_b16 a[170:171], v21 offset:53248
    v_lshl_or_b32 v244, v245, 31, v244
    v_mfma_f32_16x16x32_bf16 a[124:127], a[188:191], v[156:159], a[124:127]
    v_cvt_pk_bf16_f32 v183, v210, v211
    v_mfma_f32_16x16x32_bf16 a[124:127], a[184:187], v[152:155], a[124:127]
    s_waitcnt lgkmcnt(3)
    buffer_load_dwordx4 v48, s[20:23], s49 offen offset:2048 lds
    v_smfmac_f32_16x16x64_bf16 a[192:195], v[52:55], v[160:167], v50
    v_exp_f32 v212, v212
    v_smfmac_f32_16x16x64_bf16 a[196:199], v[52:55], v[168:175], v50
    v_exp_f32 v213, v213
    v_smfmac_f32_16x16x64_bf16 a[200:203], v[52:55], v[176:183], v50
    v_exp_f32 v214, v214
    v_exp_f32 v215, v215
    v_mfma_f32_16x16x32_bf16 a[0:3], a[160:163], v[160:163], a[0:3]
    s_waitcnt lgkmcnt(2)
    ds_read_b64_tr_b16 a[172:173], v21 offset:57344
    v_cvt_pk_bf16_f32 v190, v212, v213
    v_mfma_f32_16x16x32_bf16 a[0:3], a[164:167], v[164:167], a[0:3]
    ds_read_b64_tr_b16 a[174:175], v21 offset:61440
    v_mfma_f32_16x16x32_bf16 a[4:7], a[164:167], v[172:175], a[4:7]
    v_cvt_pk_bf16_f32 v191, v214, v215
    v_mfma_f32_16x16x32_bf16 a[4:7], a[160:163], v[168:171], a[4:7]
    buffer_store_dword v246, v244, s[24:27], s39 offen sc1
    v_smfmac_f32_16x16x64_bf16 a[204:207], v[52:55], v[184:191], v50
    v_mfma_f32_16x16x32_bf16 a[8:11], a[160:163], v[176:179], a[8:11]
    ds_read_b64_tr_b16 a[176:177], v22 offset:49152
    v_mfma_f32_16x16x32_bf16 a[8:11], a[164:167], v[180:183], a[8:11]
    ds_read_b64_tr_b16 a[178:179], v22 offset:53248
    v_accvgpr_read_b32 v216, a192
    v_accvgpr_read_b32 v217, a193
    v_mfma_f32_16x16x32_bf16 a[12:15], a[164:167], v[188:191], a[12:15]
    v_accvgpr_read_b32 v218, a196
    v_accvgpr_read_b32 v219, a197
    v_mfma_f32_16x16x32_bf16 a[12:15], a[160:163], v[184:187], a[12:15]
    s_waitcnt lgkmcnt(4)
    buffer_load_dwordx4 v49, s[20:23], s49 offen offset:3072 lds
    v_accvgpr_read_b32 v220, a200
    v_accvgpr_read_b32 v221, a201
    v_mfma_f32_16x16x32_bf16 a[16:19], a[168:171], v[160:163], a[16:19]
    s_waitcnt lgkmcnt(2)
    ds_read_b64_tr_b16 a[180:181], v22 offset:57344
    s_waitcnt vmcnt(9)
    v_accvgpr_read_b32 v222, a204
    v_mfma_f32_16x16x32_bf16 a[16:19], a[172:175], v[164:167], a[16:19]
    ds_read_b64_tr_b16 a[182:183], v22 offset:61440
    v_accvgpr_read_b32 v223, a205
    v_add_f32 v58, v216, v217
    v_mfma_f32_16x16x32_bf16 a[20:23], a[172:175], v[172:175], a[20:23]
    v_add_f32 v59, v218, v219
    v_add_f32 v60, v220, v221
    v_mfma_f32_16x16x32_bf16 a[20:23], a[168:171], v[168:171], a[20:23]
    v_add_f32 v61, v222, v223
    v_add_f32 v216, v58, v59
    s_add_u32 s49, s7, 256
    s_add_u32 m0, s42, 32768
    v_mfma_f32_16x16x32_bf16 a[24:27], a[168:171], v[176:179], a[24:27]
    ds_read_b64_tr_b16 a[184:185], v23 offset:49152
    v_add_f32 v217, v60, v61
    v_mfma_f32_16x16x32_bf16 a[24:27], a[172:175], v[180:183], a[24:27]
    ds_read_b64_tr_b16 a[186:187], v23 offset:53248
    v_add_f32 v216, v216, v217
    v_cmp_ngt_f32 vcc, 1669332992, v216
    v_mfma_f32_16x16x32_bf16 a[28:31], a[172:175], v[188:191], a[28:31]
    v_rcp_f32 v58, v58
    v_rcp_f32 v59, v59
    v_mfma_f32_16x16x32_bf16 a[28:31], a[168:171], v[184:187], a[28:31]
    s_waitcnt lgkmcnt(4)
    buffer_load_dwordx4 v46, s[20:23], s49 offen lds
    v_rcp_f32 v60, v60
    v_rcp_f32 v61, v61
    v_mfma_f32_16x16x32_bf16 a[32:35], a[176:179], v[160:163], a[32:35]
    s_waitcnt lgkmcnt(2)
    ds_read_b64_tr_b16 a[188:189], v23 offset:57344
    v_mov_b32 v228, 131072
    v_mfma_f32_16x16x32_bf16 a[32:35], a[180:183], v[164:167], a[32:35]
    ds_read_b64_tr_b16 a[190:191], v23 offset:61440
    s_or_b32 s36, vcc_lo, vcc_hi
    v_mfma_f32_16x16x32_bf16 a[36:39], a[180:183], v[172:175], a[36:39]
    v_accvgpr_read_b32 v208, a0
    v_accvgpr_read_b32 v209, a1
    v_accvgpr_read_b32 v210, a2
    v_accvgpr_read_b32 v211, a3
    v_pk_mul_f32 v[208:209], v[208:209], v[58:59] op_sel:[0,0] op_sel_hi:[1,0]
    v_pk_mul_f32 v[210:211], v[210:211], v[58:59] op_sel:[0,0] op_sel_hi:[1,0]
    v_cvt_pk_bf16_f32 v128, v208, v209
    v_cvt_pk_bf16_f32 v129, v210, v211
    v_mfma_f32_16x16x32_bf16 a[36:39], a[176:179], v[168:171], a[36:39]
    v_accvgpr_read_b32 v212, a4
    v_accvgpr_read_b32 v213, a5
    v_accvgpr_read_b32 v214, a6
    v_accvgpr_read_b32 v215, a7
    v_pk_mul_f32 v[212:213], v[212:213], v[58:59] op_sel:[0,1] op_sel_hi:[1,1]
    v_pk_mul_f32 v[214:215], v[214:215], v[58:59] op_sel:[0,1] op_sel_hi:[1,1]
    v_cvt_pk_bf16_f32 v132, v212, v213
    v_cvt_pk_bf16_f32 v133, v214, v215
    v_mfma_f32_16x16x32_bf16 a[40:43], a[176:179], v[176:179], a[40:43]
    ds_read_b64_tr_b16 a[160:161], v24 offset:49152
    v_mov_b32 v218, s36
    v_mfma_f32_16x16x32_bf16 a[40:43], a[180:183], v[180:183], a[40:43]
    ds_read_b64_tr_b16 a[162:163], v24 offset:53248
    s_lshl_b32 s38, s3, 2
    v_mfma_f32_16x16x32_bf16 a[44:47], a[180:183], v[188:191], a[44:47]
    v_accvgpr_read_b32 v208, a8
    v_accvgpr_read_b32 v209, a9
    v_accvgpr_read_b32 v210, a10
    v_accvgpr_read_b32 v211, a11
    v_pk_mul_f32 v[208:209], v[208:209], v[60:61] op_sel:[0,0] op_sel_hi:[1,0]
    v_pk_mul_f32 v[210:211], v[210:211], v[60:61] op_sel:[0,0] op_sel_hi:[1,0]
    v_cvt_pk_bf16_f32 v136, v208, v209
    v_cvt_pk_bf16_f32 v137, v210, v211
    v_mfma_f32_16x16x32_bf16 a[44:47], a[176:179], v[184:187], a[44:47]
    s_waitcnt lgkmcnt(4)
    buffer_load_dwordx4 v47, s[20:23], s49 offen offset:1024 lds
    v_accvgpr_read_b32 v212, a12
    v_accvgpr_read_b32 v213, a13
    v_accvgpr_read_b32 v214, a14
    v_accvgpr_read_b32 v215, a15
    v_pk_mul_f32 v[212:213], v[212:213], v[60:61] op_sel:[0,1] op_sel_hi:[1,1]
    v_pk_mul_f32 v[214:215], v[214:215], v[60:61] op_sel:[0,1] op_sel_hi:[1,1]
    v_cvt_pk_bf16_f32 v140, v212, v213
    v_cvt_pk_bf16_f32 v141, v214, v215
    v_mfma_f32_16x16x32_bf16 a[48:51], a[184:187], v[160:163], a[48:51]
    s_waitcnt lgkmcnt(2)
    ds_read_b64_tr_b16 a[164:165], v24 offset:57344
    v_add_u32 v219, s38, v228
    v_mfma_f32_16x16x32_bf16 a[48:51], a[188:191], v[164:167], a[48:51]
    ds_read_b64_tr_b16 a[166:167], v24 offset:61440
    ds_write_b32 v219, v218
    v_mfma_f32_16x16x32_bf16 a[52:55], a[188:191], v[172:175], a[52:55]
    v_accvgpr_read_b32 v208, a16
    v_accvgpr_read_b32 v209, a17
    v_accvgpr_read_b32 v210, a18
    v_accvgpr_read_b32 v211, a19
    v_pk_mul_f32 v[208:209], v[208:209], v[58:59] op_sel:[0,0] op_sel_hi:[1,0]
    v_pk_mul_f32 v[210:211], v[210:211], v[58:59] op_sel:[0,0] op_sel_hi:[1,0]
    v_cvt_pk_bf16_f32 v130, v208, v209
    v_cvt_pk_bf16_f32 v131, v210, v211
    s_add_u32 s37, s55, 0
    buffer_store_dwordx4 v[128:131], v252, s[28:31], s37 offen offset:0
    v_mfma_f32_16x16x32_bf16 a[52:55], a[184:187], v[168:171], a[52:55]
    v_accvgpr_read_b32 v212, a20
    v_accvgpr_read_b32 v213, a21
    v_accvgpr_read_b32 v214, a22
    v_accvgpr_read_b32 v215, a23
    v_pk_mul_f32 v[212:213], v[212:213], v[58:59] op_sel:[0,1] op_sel_hi:[1,1]
    v_pk_mul_f32 v[214:215], v[214:215], v[58:59] op_sel:[0,1] op_sel_hi:[1,1]
    v_cvt_pk_bf16_f32 v134, v212, v213
    v_cvt_pk_bf16_f32 v135, v214, v215
    s_add_u32 s37, s55, 8192
    buffer_store_dwordx4 v[132:135], v252, s[28:31], s37 offen offset:0
    v_mfma_f32_16x16x32_bf16 a[56:59], a[184:187], v[176:179], a[56:59]
    ds_read_b64_tr_b16 a[168:169], v25 offset:49152
    v_min_u32 v240, 1, v0
    v_mfma_f32_16x16x32_bf16 a[56:59], a[188:191], v[180:183], a[56:59]
    ds_read_b64_tr_b16 a[170:171], v25 offset:53248
    v_mfma_f32_16x16x32_bf16 a[60:63], a[188:191], v[188:191], a[60:63]
    v_accvgpr_read_b32 v208, a24
    v_accvgpr_read_b32 v209, a25
    v_accvgpr_read_b32 v210, a26
    v_accvgpr_read_b32 v211, a27
    v_pk_mul_f32 v[208:209], v[208:209], v[60:61] op_sel:[0,0] op_sel_hi:[1,0]
    v_pk_mul_f32 v[210:211], v[210:211], v[60:61] op_sel:[0,0] op_sel_hi:[1,0]
    v_cvt_pk_bf16_f32 v138, v208, v209
    v_cvt_pk_bf16_f32 v139, v210, v211
    s_add_u32 s37, s55, 4096
    buffer_store_dwordx4 v[136:139], v252, s[28:31], s37 offen offset:0
    v_mfma_f32_16x16x32_bf16 a[60:63], a[184:187], v[184:187], a[60:63]
    s_waitcnt lgkmcnt(5)
    buffer_load_dwordx4 v48, s[20:23], s49 offen offset:2048 lds
    v_accvgpr_read_b32 v212, a28
    v_accvgpr_read_b32 v213, a29
    v_accvgpr_read_b32 v214, a30
    v_accvgpr_read_b32 v215, a31
    v_pk_mul_f32 v[212:213], v[212:213], v[60:61] op_sel:[0,1] op_sel_hi:[1,1]
    v_pk_mul_f32 v[214:215], v[214:215], v[60:61] op_sel:[0,1] op_sel_hi:[1,1]
    v_cvt_pk_bf16_f32 v142, v212, v213
    v_cvt_pk_bf16_f32 v143, v214, v215
    s_add_u32 s37, s55, 12288
    buffer_store_dwordx4 v[140:143], v252, s[28:31], s37 offen offset:0
    v_mfma_f32_16x16x32_bf16 a[64:67], a[160:163], v[160:163], a[64:67]
    s_waitcnt lgkmcnt(3)
    ds_read_b64_tr_b16 a[172:173], v25 offset:57344
    v_lshlrev_b32 v240, 31, v240
    v_mfma_f32_16x16x32_bf16 a[64:67], a[164:167], v[164:167], a[64:67]
    ds_read_b64_tr_b16 a[174:175], v25 offset:61440
    v_mfma_f32_16x16x32_bf16 a[68:71], a[164:167], v[172:175], a[68:71]
    v_accvgpr_read_b32 v208, a32
    v_accvgpr_read_b32 v209, a33
    v_accvgpr_read_b32 v210, a34
    v_accvgpr_read_b32 v211, a35
    v_pk_mul_f32 v[208:209], v[208:209], v[58:59] op_sel:[0,0] op_sel_hi:[1,0]
    v_pk_mul_f32 v[210:211], v[210:211], v[58:59] op_sel:[0,0] op_sel_hi:[1,0]
    v_cvt_pk_bf16_f32 v144, v208, v209
    v_cvt_pk_bf16_f32 v145, v210, v211
    v_mfma_f32_16x16x32_bf16 a[68:71], a[160:163], v[168:171], a[68:71]
    v_accvgpr_read_b32 v212, a36
    v_accvgpr_read_b32 v213, a37
    v_accvgpr_read_b32 v214, a38
    v_accvgpr_read_b32 v215, a39
    v_pk_mul_f32 v[212:213], v[212:213], v[58:59] op_sel:[0,1] op_sel_hi:[1,1]
    v_pk_mul_f32 v[214:215], v[214:215], v[58:59] op_sel:[0,1] op_sel_hi:[1,1]
    v_cvt_pk_bf16_f32 v148, v212, v213
    v_cvt_pk_bf16_f32 v149, v214, v215
    v_mfma_f32_16x16x32_bf16 a[72:75], a[160:163], v[176:179], a[72:75]
    ds_read_b64_tr_b16 a[176:177], v26 offset:49152
    v_mov_b32 v241, 1
    v_mfma_f32_16x16x32_bf16 a[72:75], a[164:167], v[180:183], a[72:75]
    ds_read_b64_tr_b16 a[178:179], v26 offset:53248
    v_mfma_f32_16x16x32_bf16 a[76:79], a[164:167], v[188:191], a[76:79]
    v_accvgpr_read_b32 v208, a40
    v_accvgpr_read_b32 v209, a41
    v_accvgpr_read_b32 v210, a42
    v_accvgpr_read_b32 v211, a43
    v_pk_mul_f32 v[208:209], v[208:209], v[60:61] op_sel:[0,0] op_sel_hi:[1,0]
    v_pk_mul_f32 v[210:211], v[210:211], v[60:61] op_sel:[0,0] op_sel_hi:[1,0]
    v_cvt_pk_bf16_f32 v152, v208, v209
    v_cvt_pk_bf16_f32 v153, v210, v211
    v_mfma_f32_16x16x32_bf16 a[76:79], a[160:163], v[184:187], a[76:79]
    s_waitcnt lgkmcnt(4)
    buffer_load_dwordx4 v49, s[20:23], s49 offen offset:3072 lds
    v_accvgpr_read_b32 v212, a44
    v_accvgpr_read_b32 v213, a45
    v_accvgpr_read_b32 v214, a46
    v_accvgpr_read_b32 v215, a47
    v_pk_mul_f32 v[212:213], v[212:213], v[60:61] op_sel:[0,1] op_sel_hi:[1,1]
    v_pk_mul_f32 v[214:215], v[214:215], v[60:61] op_sel:[0,1] op_sel_hi:[1,1]
    v_cvt_pk_bf16_f32 v156, v212, v213
    v_cvt_pk_bf16_f32 v157, v214, v215
    v_mfma_f32_16x16x32_bf16 a[80:83], a[168:171], v[160:163], a[80:83]
    s_waitcnt lgkmcnt(2)
    ds_read_b64_tr_b16 a[180:181], v26 offset:57344
    v_mfma_f32_16x16x32_bf16 a[80:83], a[172:175], v[164:167], a[80:83]
    ds_read_b64_tr_b16 a[182:183], v26 offset:61440
    v_mfma_f32_16x16x32_bf16 a[84:87], a[172:175], v[172:175], a[84:87]
    v_accvgpr_read_b32 v208, a48
    v_accvgpr_read_b32 v209, a49
    v_accvgpr_read_b32 v210, a50
    v_accvgpr_read_b32 v211, a51
    v_pk_mul_f32 v[208:209], v[208:209], v[58:59] op_sel:[0,0] op_sel_hi:[1,0]
    v_pk_mul_f32 v[210:211], v[210:211], v[58:59] op_sel:[0,0] op_sel_hi:[1,0]
    v_cvt_pk_bf16_f32 v146, v208, v209
    v_cvt_pk_bf16_f32 v147, v210, v211
    s_add_u32 s37, s55, 0
    buffer_store_dwordx4 v[144:147], v252, s[28:31], s37 offen offset:1024
    v_mfma_f32_16x16x32_bf16 a[84:87], a[168:171], v[168:171], a[84:87]
    v_accvgpr_read_b32 v212, a52
    v_accvgpr_read_b32 v213, a53
    v_accvgpr_read_b32 v214, a54
    v_accvgpr_read_b32 v215, a55
    v_pk_mul_f32 v[212:213], v[212:213], v[58:59] op_sel:[0,1] op_sel_hi:[1,1]
    v_pk_mul_f32 v[214:215], v[214:215], v[58:59] op_sel:[0,1] op_sel_hi:[1,1]
    v_cvt_pk_bf16_f32 v150, v212, v213
    v_cvt_pk_bf16_f32 v151, v214, v215
    s_add_u32 s37, s55, 8192
    buffer_store_dwordx4 v[148:151], v252, s[28:31], s37 offen offset:1024
    s_waitcnt vmcnt(23)
    s_barrier
    v_mfma_f32_16x16x32_bf16 a[88:91], a[168:171], v[176:179], a[88:91]
    ds_read_b64_tr_b16 a[184:185], v27 offset:49152
    v_mfma_f32_16x16x32_bf16 a[88:91], a[172:175], v[180:183], a[88:91]
    ds_read_b64_tr_b16 a[186:187], v27 offset:53248
    v_mfma_f32_16x16x32_bf16 a[92:95], a[172:175], v[188:191], a[92:95]
    ds_read_b128 v[224:227], v228
    v_accvgpr_read_b32 v208, a56
    v_accvgpr_read_b32 v209, a57
    v_accvgpr_read_b32 v210, a58
    v_accvgpr_read_b32 v211, a59
    v_pk_mul_f32 v[208:209], v[208:209], v[60:61] op_sel:[0,0] op_sel_hi:[1,0]
    v_pk_mul_f32 v[210:211], v[210:211], v[60:61] op_sel:[0,0] op_sel_hi:[1,0]
    v_cvt_pk_bf16_f32 v154, v208, v209
    v_cvt_pk_bf16_f32 v155, v210, v211
    s_add_u32 s37, s55, 4096
    buffer_store_dwordx4 v[152:155], v252, s[28:31], s37 offen offset:1024
    v_mfma_f32_16x16x32_bf16 a[92:95], a[168:171], v[184:187], a[92:95]
    s_waitcnt lgkmcnt(5)
    v_accvgpr_read_b32 v212, a60
    v_accvgpr_read_b32 v213, a61
    v_accvgpr_read_b32 v214, a62
    v_accvgpr_read_b32 v215, a63
    v_pk_mul_f32 v[212:213], v[212:213], v[60:61] op_sel:[0,1] op_sel_hi:[1,1]
    v_pk_mul_f32 v[214:215], v[214:215], v[60:61] op_sel:[0,1] op_sel_hi:[1,1]
    v_cvt_pk_bf16_f32 v158, v212, v213
    v_cvt_pk_bf16_f32 v159, v214, v215
    s_add_u32 s37, s55, 12288
    buffer_store_dwordx4 v[156:159], v252, s[28:31], s37 offen offset:1024
    s_add_u32 s49, s7, 73984
    v_mfma_f32_16x16x32_bf16 a[96:99], a[176:179], v[160:163], a[96:99]
    s_waitcnt lgkmcnt(3)
    s_add_u32 m0, s42, 49152
    ds_read_b64_tr_b16 a[188:189], v27 offset:57344
    v_mfma_f32_16x16x32_bf16 a[96:99], a[180:183], v[164:167], a[96:99]
    buffer_load_dwordx4 v46, s[20:23], s49 offen lds
    v_mfma_f32_16x16x32_bf16 a[100:103], a[180:183], v[172:175], a[100:103]
    ds_read_b64_tr_b16 a[190:191], v27 offset:61440
    v_accvgpr_read_b32 v208, a64
    v_accvgpr_read_b32 v209, a65
    v_accvgpr_read_b32 v210, a66
    v_accvgpr_read_b32 v211, a67
    v_pk_mul_f32 v[208:209], v[208:209], v[58:59] op_sel:[0,0] op_sel_hi:[1,0]
    v_pk_mul_f32 v[210:211], v[210:211], v[58:59] op_sel:[0,0] op_sel_hi:[1,0]
    v_cvt_pk_bf16_f32 v192, v208, v209
    v_cvt_pk_bf16_f32 v193, v210, v211
    v_mfma_f32_16x16x32_bf16 a[100:103], a[176:179], v[168:171], a[100:103]
    buffer_load_dwordx4 v47, s[20:23], s49 offen offset:1024 lds
    v_accvgpr_read_b32 v212, a68
    v_accvgpr_read_b32 v213, a69
    v_accvgpr_read_b32 v214, a70
    v_accvgpr_read_b32 v215, a71
    v_pk_mul_f32 v[212:213], v[212:213], v[58:59] op_sel:[0,1] op_sel_hi:[1,1]
    v_pk_mul_f32 v[214:215], v[214:215], v[58:59] op_sel:[0,1] op_sel_hi:[1,1]
    v_cvt_pk_bf16_f32 v196, v212, v213
    v_cvt_pk_bf16_f32 v197, v214, v215
    v_mfma_f32_16x16x32_bf16 a[104:107], a[176:179], v[176:179], a[104:107]
    v_mfma_f32_16x16x32_bf16 a[104:107], a[180:183], v[180:183], a[104:107]
    buffer_load_dwordx4 v48, s[20:23], s49 offen offset:2048 lds
    v_mfma_f32_16x16x32_bf16 a[108:111], a[180:183], v[188:191], a[108:111]
    v_accvgpr_read_b32 v208, a72
    v_accvgpr_read_b32 v209, a73
    v_accvgpr_read_b32 v210, a74
    v_accvgpr_read_b32 v211, a75
    v_pk_mul_f32 v[208:209], v[208:209], v[60:61] op_sel:[0,0] op_sel_hi:[1,0]
    v_pk_mul_f32 v[210:211], v[210:211], v[60:61] op_sel:[0,0] op_sel_hi:[1,0]
    v_cvt_pk_bf16_f32 v200, v208, v209
    v_cvt_pk_bf16_f32 v201, v210, v211
    v_mfma_f32_16x16x32_bf16 a[108:111], a[176:179], v[184:187], a[108:111]
    s_waitcnt lgkmcnt(3)
    buffer_load_dwordx4 v49, s[20:23], s49 offen offset:3072 lds
    v_accvgpr_read_b32 v212, a76
    v_accvgpr_read_b32 v213, a77
    v_accvgpr_read_b32 v214, a78
    v_accvgpr_read_b32 v215, a79
    v_pk_mul_f32 v[212:213], v[212:213], v[60:61] op_sel:[0,1] op_sel_hi:[1,1]
    v_pk_mul_f32 v[214:215], v[214:215], v[60:61] op_sel:[0,1] op_sel_hi:[1,1]
    v_cvt_pk_bf16_f32 v204, v212, v213
    v_cvt_pk_bf16_f32 v205, v214, v215
    s_add_u32 s49, s46, 0
    v_mfma_f32_16x16x32_bf16 a[112:115], a[184:187], v[160:163], a[112:115]
    s_waitcnt lgkmcnt(0)
    s_add_u32 m0, s42, 98304
    v_mfma_f32_16x16x32_bf16 a[112:115], a[188:191], v[164:167], a[112:115]
    buffer_load_dwordx4 v46, s[20:23], s49 offen lds
    v_mfma_f32_16x16x32_bf16 a[116:119], a[188:191], v[172:175], a[116:119]
    v_accvgpr_read_b32 v208, a80
    v_accvgpr_read_b32 v209, a81
    v_accvgpr_read_b32 v210, a82
    v_accvgpr_read_b32 v211, a83
    v_pk_mul_f32 v[208:209], v[208:209], v[58:59] op_sel:[0,0] op_sel_hi:[1,0]
    v_pk_mul_f32 v[210:211], v[210:211], v[58:59] op_sel:[0,0] op_sel_hi:[1,0]
    v_cvt_pk_bf16_f32 v194, v208, v209
    v_cvt_pk_bf16_f32 v195, v210, v211
    s_add_u32 s37, s55, 0
    buffer_store_dwordx4 v[192:195], v252, s[28:31], s37 offen offset:2048
    v_mfma_f32_16x16x32_bf16 a[116:119], a[184:187], v[168:171], a[116:119]
    buffer_load_dwordx4 v47, s[20:23], s49 offen offset:1024 lds
    v_accvgpr_read_b32 v212, a84
    v_accvgpr_read_b32 v213, a85
    v_accvgpr_read_b32 v214, a86
    v_accvgpr_read_b32 v215, a87
    v_pk_mul_f32 v[212:213], v[212:213], v[58:59] op_sel:[0,1] op_sel_hi:[1,1]
    v_pk_mul_f32 v[214:215], v[214:215], v[58:59] op_sel:[0,1] op_sel_hi:[1,1]
    v_cvt_pk_bf16_f32 v198, v212, v213
    v_cvt_pk_bf16_f32 v199, v214, v215
    s_add_u32 s37, s55, 8192
    buffer_store_dwordx4 v[196:199], v252, s[28:31], s37 offen offset:2048
    v_mfma_f32_16x16x32_bf16 a[120:123], a[184:187], v[176:179], a[120:123]
    v_mfma_f32_16x16x32_bf16 a[120:123], a[188:191], v[180:183], a[120:123]
    buffer_load_dwordx4 v48, s[20:23], s49 offen offset:2048 lds
    v_mfma_f32_16x16x32_bf16 a[124:127], a[188:191], v[188:191], a[124:127]
    v_accvgpr_read_b32 v208, a88
    v_accvgpr_read_b32 v209, a89
    v_accvgpr_read_b32 v210, a90
    v_accvgpr_read_b32 v211, a91
    v_pk_mul_f32 v[208:209], v[208:209], v[60:61] op_sel:[0,0] op_sel_hi:[1,0]
    v_pk_mul_f32 v[210:211], v[210:211], v[60:61] op_sel:[0,0] op_sel_hi:[1,0]
    v_cvt_pk_bf16_f32 v202, v208, v209
    v_cvt_pk_bf16_f32 v203, v210, v211
    s_add_u32 s37, s55, 4096
    buffer_store_dwordx4 v[200:203], v252, s[28:31], s37 offen offset:2048
    v_mfma_f32_16x16x32_bf16 a[124:127], a[184:187], v[184:187], a[124:127]
    buffer_load_dwordx4 v49, s[20:23], s49 offen offset:3072 lds
    v_accvgpr_read_b32 v212, a92
    v_accvgpr_read_b32 v213, a93
    v_accvgpr_read_b32 v214, a94
    v_accvgpr_read_b32 v215, a95
    v_pk_mul_f32 v[212:213], v[212:213], v[60:61] op_sel:[0,1] op_sel_hi:[1,1]
    v_pk_mul_f32 v[214:215], v[214:215], v[60:61] op_sel:[0,1] op_sel_hi:[1,1]
    v_cvt_pk_bf16_f32 v206, v212, v213
    v_cvt_pk_bf16_f32 v207, v214, v215
    s_add_u32 s37, s55, 12288
    buffer_store_dwordx4 v[204:207], v252, s[28:31], s37 offen offset:2048
    v_or3_b32 v224, v224, v225, v226
    v_or_b32 v224, v224, v227
    s_nop 0
    v_readfirstlane_b32 s36, v224
    v_readfirstlane_b32 s38, v253
    v_min_u32 v8, 1, v1
    v_lshlrev_b32 v8, 31, v8
    v_mov_b32 v10, s95
    s_getreg_b32 s39, hwreg(HW_REG_XCC_ID, 0, 4)
    s_lshl_b32 s39, s39, 28
    s_xor_b32 s39, s39, s95
    s_cmp_eq_u32 s38, s39
    s_cselect_b32 s53, 1, 0
    ds_read_b64_tr_b16 a[208:209], v12 offset:0
    ds_read_b64_tr_b16 a[210:211], v12 offset:4096
    ds_read_b64_tr_b16 a[212:213], v12 offset:8192
    ds_read_b64_tr_b16 a[214:215], v12 offset:12288
    ds_read_b64_tr_b16 a[216:217], v12 offset:16384
    ds_read_b64_tr_b16 a[218:219], v12 offset:20480
    ds_read_b64_tr_b16 a[220:221], v12 offset:24576
    ds_read_b64_tr_b16 a[222:223], v12 offset:28672
    ds_read_b64_tr_b16 a[224:225], v16 offset:0
    ds_read_b64_tr_b16 a[226:227], v16 offset:4096
    ds_read_b64_tr_b16 a[228:229], v16 offset:8192
    ds_read_b64_tr_b16 a[230:231], v16 offset:12288
    ds_read_b64_tr_b16 a[232:233], v16 offset:16384
    ds_read_b64_tr_b16 a[234:235], v16 offset:20480
    ds_read_b64_tr_b16 a[236:237], v16 offset:24576
    ds_read_b64_tr_b16 a[238:239], v16 offset:28672
    s_andn2_b32 s36, s36, s48
    s_cbranch_scc1 Lattn_redo
    v_accvgpr_read_b32 v208, a96
Ltour0_8:
    s_cbranch_execz Ltour0_12
    v_accvgpr_read_b32 v209, a97
    v_accvgpr_read_b32 v210, a98
    v_accvgpr_read_b32 v211, a99
    v_pk_mul_f32 v[208:209], v[208:209], v[58:59] op_sel:[0,0] op_sel_hi:[1,0]
    v_pk_mul_f32 v[210:211], v[210:211], v[58:59] op_sel:[0,0] op_sel_hi:[1,0]
    v_cvt_pk_bf16_f32 v176, v208, v209
    v_cvt_pk_bf16_f32 v177, v210, v211
    v_accvgpr_read_b32 v212, a100
    v_accvgpr_read_b32 v213, a101
    v_accvgpr_read_b32 v214, a102
    v_accvgpr_read_b32 v215, a103
    v_pk_mul_f32 v[212:213], v[212:213], v[58:59] op_sel:[0,1] op_sel_hi:[1,1]
    v_pk_mul_f32 v[214:215], v[214:215], v[58:59] op_sel:[0,1] op_sel_hi:[1,1]
    v_cvt_pk_bf16_f32 v180, v212, v213
    v_cvt_pk_bf16_f32 v181, v214, v215
    v_accvgpr_read_b32 v208, a104
    v_accvgpr_read_b32 v209, a105
    v_accvgpr_read_b32 v210, a106
    v_accvgpr_read_b32 v211, a107
    v_pk_mul_f32 v[208:209], v[208:209], v[60:61] op_sel:[0,0] op_sel_hi:[1,0]
    v_pk_mul_f32 v[210:211], v[210:211], v[60:61] op_sel:[0,0] op_sel_hi:[1,0]
    v_cvt_pk_bf16_f32 v184, v208, v209
    v_cvt_pk_bf16_f32 v185, v210, v211
    v_accvgpr_read_b32 v212, a108
    v_accvgpr_read_b32 v213, a109
    v_accvgpr_read_b32 v214, a110
    v_accvgpr_read_b32 v215, a111
    v_pk_mul_f32 v[212:213], v[212:213], v[60:61] op_sel:[0,1] op_sel_hi:[1,1]
    v_pk_mul_f32 v[214:215], v[214:215], v[60:61] op_sel:[0,1] op_sel_hi:[1,1]
    v_cvt_pk_bf16_f32 v188, v212, v213
    v_cvt_pk_bf16_f32 v189, v214, v215
    v_accvgpr_read_b32 v208, a112
    v_accvgpr_read_b32 v209, a113
    v_accvgpr_read_b32 v210, a114
    v_accvgpr_read_b32 v211, a115
    v_pk_mul_f32 v[208:209], v[208:209], v[58:59] op_sel:[0,0] op_sel_hi:[1,0]
    v_pk_mul_f32 v[210:211], v[210:211], v[58:59] op_sel:[0,0] op_sel_hi:[1,0]
    v_cvt_pk_bf16_f32 v178, v208, v209
    v_cvt_pk_bf16_f32 v179, v210, v211
    s_add_u32 s37, s55, 0
    buffer_store_dwordx4 v[176:179], v252, s[28:31], s37 offen offset:3072
    v_accvgpr_read_b32 v212, a116
    v_accvgpr_read_b32 v213, a117
    v_accvgpr_read_b32 v214, a118
    v_accvgpr_read_b32 v215, a119
    v_pk_mul_f32 v[212:213], v[212:213], v[58:59] op_sel:[0,1] op_sel_hi:[1,1]
    v_pk_mul_f32 v[214:215], v[214:215], v[58:59] op_sel:[0,1] op_sel_hi:[1,1]
    v_cvt_pk_bf16_f32 v182, v212, v213
    v_cvt_pk_bf16_f32 v183, v214, v215
    s_add_u32 s37, s55, 8192
    buffer_store_dwordx4 v[180:183], v252, s[28:31], s37 offen offset:3072
    v_accvgpr_read_b32 v208, a120
    v_accvgpr_read_b32 v209, a121
    v_accvgpr_read_b32 v210, a122
    v_accvgpr_read_b32 v211, a123
    v_pk_mul_f32 v[208:209], v[208:209], v[60:61] op_sel:[0,0] op_sel_hi:[1,0]
    v_pk_mul_f32 v[210:211], v[210:211], v[60:61] op_sel:[0,0] op_sel_hi:[1,0]
    v_cvt_pk_bf16_f32 v186, v208, v209
    v_cvt_pk_bf16_f32 v187, v210, v211
    s_add_u32 s37, s55, 4096
    buffer_store_dwordx4 v[184:187], v252, s[28:31], s37 offen offset:3072
    v_accvgpr_read_b32 v212, a124
    v_accvgpr_read_b32 v213, a125
    v_accvgpr_read_b32 v214, a126
    v_accvgpr_read_b32 v215, a127
    v_pk_mul_f32 v[212:213], v[212:213], v[60:61] op_sel:[0,1] op_sel_hi:[1,1]
    v_pk_mul_f32 v[214:215], v[214:215], v[60:61] op_sel:[0,1] op_sel_hi:[1,1]
    v_cvt_pk_bf16_f32 v190, v212, v213
    v_cvt_pk_bf16_f32 v191, v214, v215
    s_add_u32 s37, s55, 12288
    buffer_store_dwordx4 v[188:191], v252, s[28:31], s37 offen offset:3072
    s_waitcnt lgkmcnt(14)
    v_mfma_f32_16x16x32_bf16 v[96:99], a[208:211], v[128:131], 0
    s_waitcnt lgkmcnt(12)
    ds_read_b64_tr_b16 a[160:161], v13 offset:0
    v_mfma_f32_16x16x32_bf16 v[96:99], a[212:215], v[144:147], v[96:99]
    s_waitcnt lgkmcnt(11)
    ds_read_b64_tr_b16 a[162:163], v13 offset:4096
    v_mfma_f32_16x16x32_bf16 v[96:99], a[216:219], v[192:195], v[96:99]
    s_waitcnt lgkmcnt(10)
    ds_read_b64_tr_b16 a[164:165], v13 offset:8192
    v_mfma_f32_16x16x32_bf16 v[96:99], a[220:223], v[176:179], v[96:99]
    s_waitcnt lgkmcnt(9)
    ds_read_b64_tr_b16 a[166:167], v13 offset:12288
    v_mfma_f32_16x16x32_bf16 v[96:99], a[224:227], v[136:139], v[96:99]
    s_waitcnt lgkmcnt(8)
    ds_read_b64_tr_b16 a[168:169], v13 offset:16384
    v_mfma_f32_16x16x32_bf16 v[96:99], a[228:231], v[152:155], v[96:99]
    s_waitcnt lgkmcnt(7)
    ds_read_b64_tr_b16 a[170:171], v13 offset:20480
    v_mfma_f32_16x16x32_bf16 v[96:99], a[232:235], v[200:203], v[96:99]
    s_waitcnt lgkmcnt(6)
    ds_read_b64_tr_b16 a[172:173], v13 offset:24576
    v_mfma_f32_16x16x32_bf16 v[96:99], a[236:239], v[184:187], v[96:99]
    ds_read_b64_tr_b16 a[174:175], v13 offset:28672
    v_mfma_f32_16x16x32_bf16 v[100:103], a[236:239], v[188:191], 0
    ds_read_b64_tr_b16 a[176:177], v17 offset:0
    v_mfma_f32_16x16x32_bf16 v[100:103], a[232:235], v[204:207], v[100:103]
    ds_read_b64_tr_b16 a[178:179], v17 offset:4096
    v_mfma_f32_16x16x32_bf16 v[100:103], a[228:231], v[156:159], v[100:103]
    ds_read_b64_tr_b16 a[180:181], v17 offset:8192
    v_mfma_f32_16x16x32_bf16 v[100:103], a[224:227], v[140:143], v[100:103]
    ds_read_b64_tr_b16 a[182:183], v17 offset:12288
    v_mfma_f32_16x16x32_bf16 v[100:103], a[220:223], v[180:183], v[100:103]
    ds_read_b64_tr_b16 a[184:185], v17 offset:16384
    v_cvt_pk_bf16_f32 v224, v96, v97
    v_mfma_f32_16x16x32_bf16 v[100:103], a[216:219], v[196:199], v[100:103]
    ds_read_b64_tr_b16 a[186:187], v17 offset:20480
    v_cvt_pk_bf16_f32 v225, v98, v99
    v_mfma_f32_16x16x32_bf16 v[100:103], a[212:215], v[148:151], v[100:103]
    ds_read_b64_tr_b16 a[188:189], v17 offset:24576
    v_mfma_f32_16x16x32_bf16 v[100:103], a[208:211], v[132:135], v[100:103]
    s_waitcnt lgkmcnt(13)
    ds_read_b64_tr_b16 a[190:191], v17 offset:28672
    v_mfma_f32_16x16x32_bf16 v[104:107], a[160:163], v[128:131], 0
    s_waitcnt lgkmcnt(12)
    ds_read_b64_tr_b16 a[208:209], v14 offset:0
    v_mfma_f32_16x16x32_bf16 v[104:107], a[164:167], v[144:147], v[104:107]
    s_waitcnt lgkmcnt(11)
    ds_read_b64_tr_b16 a[210:211], v14 offset:4096
    v_mfma_f32_16x16x32_bf16 v[104:107], a[168:171], v[192:195], v[104:107]
    s_waitcnt lgkmcnt(10)
    ds_read_b64_tr_b16 a[212:213], v14 offset:8192
    v_mfma_f32_16x16x32_bf16 v[104:107], a[172:175], v[176:179], v[104:107]
    s_waitcnt lgkmcnt(9)
    ds_read_b64_tr_b16 a[214:215], v14 offset:12288
    v_mfma_f32_16x16x32_bf16 v[104:107], a[176:179], v[136:139], v[104:107]
    s_waitcnt lgkmcnt(8)
    ds_read_b64_tr_b16 a[216:217], v14 offset:16384
    v_cvt_pk_bf16_f32 v228, v100, v101
    v_mfma_f32_16x16x32_bf16 v[104:107], a[180:183], v[152:155], v[104:107]
    s_waitcnt lgkmcnt(7)
    ds_read_b64_tr_b16 a[218:219], v14 offset:20480
    v_cvt_pk_bf16_f32 v229, v102, v103
    v_mfma_f32_16x16x32_bf16 v[104:107], a[184:187], v[200:203], v[104:107]
    s_waitcnt lgkmcnt(6)
    ds_read_b64_tr_b16 a[220:221], v14 offset:24576
    v_mfma_f32_16x16x32_bf16 v[104:107], a[188:191], v[184:187], v[104:107]
    ds_read_b64_tr_b16 a[222:223], v14 offset:28672
    s_waitcnt vmcnt(0)
    s_cmp_eq_u32 s53, 0
    s_cbranch_scc1 Lattn_wb
Lattn_wbdone:
    v_mfma_f32_16x16x32_bf16 v[108:111], a[188:191], v[188:191], 0
    buffer_store_dword v10, v8, s[24:27], s92 offen offset:8 sc1
    v_mfma_f32_16x16x32_bf16 v[108:111], a[184:187], v[204:207], v[108:111]
    s_xor_b32 s55, s55, 65536
    ds_read_b64_tr_b16 a[224:225], v18 offset:0
    ds_read_b64_tr_b16 a[226:227], v18 offset:4096
    v_mfma_f32_16x16x32_bf16 v[108:111], a[180:183], v[156:159], v[108:111]
    buffer_atomic_add v241, v240, s[88:91], 0 offen sc1
    v_mfma_f32_16x16x32_bf16 v[108:111], a[176:179], v[140:143], v[108:111]
    ds_read_b64_tr_b16 a[228:229], v18 offset:8192
    ds_read_b64_tr_b16 a[230:231], v18 offset:12288
    s_load_dwordx2 s[12:13], s[0:1], 0
    v_mfma_f32_16x16x32_bf16 v[108:111], a[172:175], v[180:183], v[108:111]
    ds_read_b64_tr_b16 a[232:233], v18 offset:16384
    v_cvt_pk_bf16_f32 v226, v104, v105
    v_mfma_f32_16x16x32_bf16 v[108:111], a[168:171], v[196:199], v[108:111]
    s_add_u32 s38, s56, 16384
    ds_read_b64_tr_b16 a[234:235], v18 offset:20480
    v_cvt_pk_bf16_f32 v227, v106, v107
    s_load_dwordx2 s[16:17], s[0:1], 96
    v_mfma_f32_16x16x32_bf16 v[108:111], a[164:167], v[148:151], v[108:111]
    buffer_store_dwordx4 v[224:227], v56, s[28:31], s38 offen sc1
    v_mfma_f32_16x16x32_bf16 v[108:111], a[160:163], v[132:135], v[108:111]
    s_waitcnt lgkmcnt(12)
    ds_read_b64_tr_b16 a[236:237], v18 offset:24576
    ds_read_b64_tr_b16 a[238:239], v18 offset:28672
    s_load_dwordx2 s[52:53], s[0:1], 48
    v_mfma_f32_16x16x32_bf16 v[112:115], a[208:211], v[128:131], 0
    s_waitcnt lgkmcnt(12)
    ds_read_b64_tr_b16 a[160:161], v15 offset:0
    v_mfma_f32_16x16x32_bf16 v[112:115], a[212:215], v[144:147], v[112:115]
    s_waitcnt lgkmcnt(11)
    ds_read_b64_tr_b16 a[162:163], v15 offset:4096
    v_mfma_f32_16x16x32_bf16 v[112:115], a[216:219], v[192:195], v[112:115]
    s_waitcnt lgkmcnt(10)
    ds_read_b64_tr_b16 a[164:165], v15 offset:8192
    v_mfma_f32_16x16x32_bf16 v[112:115], a[220:223], v[176:179], v[112:115]
    s_waitcnt lgkmcnt(9)
    ds_read_b64_tr_b16 a[166:167], v15 offset:12288
    v_mfma_f32_16x16x32_bf16 v[112:115], a[224:227], v[136:139], v[112:115]
    s_waitcnt lgkmcnt(8)
    ds_read_b64_tr_b16 a[168:169], v15 offset:16384
    v_cvt_pk_bf16_f32 v230, v108, v109
    v_mfma_f32_16x16x32_bf16 v[112:115], a[228:231], v[152:155], v[112:115]
    s_waitcnt lgkmcnt(7)
    s_add_u32 s38, s56, 180224
    ds_read_b64_tr_b16 a[170:171], v15 offset:20480
    v_cvt_pk_bf16_f32 v231, v110, v111
    v_mfma_f32_16x16x32_bf16 v[112:115], a[232:235], v[200:203], v[112:115]
    s_waitcnt lgkmcnt(6)
    buffer_store_dwordx4 v[228:231], v56, s[28:31], s38 offen sc1
    v_mfma_f32_16x16x32_bf16 v[112:115], a[236:239], v[184:187], v[112:115]
    ds_read_b64_tr_b16 a[172:173], v15 offset:24576
    ds_read_b64_tr_b16 a[174:175], v15 offset:28672
    v_mfma_f32_16x16x32_bf16 v[116:119], a[236:239], v[188:191], 0
    ds_read_b64_tr_b16 a[176:177], v19 offset:0
    v_mfma_f32_16x16x32_bf16 v[116:119], a[232:235], v[204:207], v[116:119]
    ds_read_b64_tr_b16 a[178:179], v19 offset:4096
    v_mfma_f32_16x16x32_bf16 v[116:119], a[228:231], v[156:159], v[116:119]
    ds_read_b64_tr_b16 a[180:181], v19 offset:8192
    v_mfma_f32_16x16x32_bf16 v[116:119], a[224:227], v[140:143], v[116:119]
    ds_read_b64_tr_b16 a[182:183], v19 offset:12288
    v_mfma_f32_16x16x32_bf16 v[116:119], a[220:223], v[180:183], v[116:119]
    ds_read_b64_tr_b16 a[184:185], v19 offset:16384
    v_cvt_pk_bf16_f32 v232, v112, v113
    v_mfma_f32_16x16x32_bf16 v[116:119], a[216:219], v[196:199], v[116:119]
    ds_read_b64_tr_b16 a[186:187], v19 offset:20480
    v_cvt_pk_bf16_f32 v233, v114, v115
    v_mfma_f32_16x16x32_bf16 v[116:119], a[212:215], v[148:151], v[116:119]
    ds_read_b64_tr_b16 a[188:189], v19 offset:24576
    v_mfma_f32_16x16x32_bf16 v[116:119], a[208:211], v[132:135], v[116:119]
    s_waitcnt lgkmcnt(13)
    ds_read_b64_tr_b16 a[190:191], v19 offset:28672
    s_barrier
    v_mfma_f32_16x16x32_bf16 v[120:123], a[160:163], v[128:131], 0
    s_waitcnt lgkmcnt(12)
    buffer_load_dword v11, v8, s[24:27], s54 offen offset:8 sc1
    v_mfma_f32_16x16x32_bf16 v[120:123], a[164:167], v[144:147], v[120:123]
    s_waitcnt lgkmcnt(10)
    ds_read_b64_tr_b16 a[208:209], v20 offset:0
    ds_read_b64_tr_b16 a[210:211], v20 offset:4096
    v_mfma_f32_16x16x32_bf16 v[120:123], a[168:171], v[192:195], v[120:123]
    s_waitcnt lgkmcnt(10)
    ds_read_b64_tr_b16 a[212:213], v20 offset:8192
    v_mfma_f32_16x16x32_bf16 v[120:123], a[172:175], v[176:179], v[120:123]
    s_waitcnt lgkmcnt(9)
    ds_read_b64_tr_b16 a[214:215], v20 offset:12288
    v_mfma_f32_16x16x32_bf16 v[120:123], a[176:179], v[136:139], v[120:123]
    s_waitcnt lgkmcnt(8)
    ds_read_b64_tr_b16 a[216:217], v20 offset:16384
    v_cvt_pk_bf16_f32 v236, v116, v117
    v_mfma_f32_16x16x32_bf16 v[120:123], a[180:183], v[152:155], v[120:123]
    s_waitcnt lgkmcnt(7)
    ds_read_b64_tr_b16 a[218:219], v20 offset:20480
    v_cvt_pk_bf16_f32 v237, v118, v119
    v_mfma_f32_16x16x32_bf16 v[120:123], a[184:187], v[200:203], v[120:123]
    s_waitcnt lgkmcnt(6)
    s_add_u32 s49, s46, 73728
    ds_read_b64_tr_b16 a[220:221], v20 offset:24576
    v_mfma_f32_16x16x32_bf16 v[120:123], a[188:191], v[184:187], v[120:123]
    s_add_u32 m0, s42, 114688
    ds_read_b64_tr_b16 a[222:223], v20 offset:28672
    v_mfma_f32_16x16x32_bf16 v[124:127], a[188:191], v[188:191], 0
    buffer_load_dwordx4 v46, s[20:23], s49 offen lds
    v_mfma_f32_16x16x32_bf16 v[124:127], a[184:187], v[204:207], v[124:127]
    ds_read_b64_tr_b16 a[224:225], v24 offset:0
    ds_read_b64_tr_b16 a[226:227], v24 offset:4096
    v_mfma_f32_16x16x32_bf16 v[124:127], a[180:183], v[156:159], v[124:127]
    buffer_load_dwordx4 v47, s[20:23], s49 offen offset:1024 lds
    v_mfma_f32_16x16x32_bf16 v[124:127], a[176:179], v[140:143], v[124:127]
    ds_read_b64_tr_b16 a[228:229], v24 offset:8192
    ds_read_b64_tr_b16 a[230:231], v24 offset:12288
    v_mfma_f32_16x16x32_bf16 v[124:127], a[172:175], v[180:183], v[124:127]
    ds_read_b64_tr_b16 a[232:233], v24 offset:16384
    v_cvt_pk_bf16_f32 v234, v120, v121
    v_mfma_f32_16x16x32_bf16 v[124:127], a[168:171], v[196:199], v[124:127]
    s_add_u32 s38, s56, 16512
    ds_read_b64_tr_b16 a[234:235], v24 offset:20480
    v_cvt_pk_bf16_f32 v235, v122, v123
    v_mfma_f32_16x16x32_bf16 v[124:127], a[164:167], v[148:151], v[124:127]
    buffer_store_dwordx4 v[232:235], v56, s[28:31], s38 offen sc1
    v_mfma_f32_16x16x32_bf16 v[124:127], a[160:163], v[132:135], v[124:127]
    s_waitcnt lgkmcnt(12)
    ds_read_b64_tr_b16 a[236:237], v24 offset:24576
    ds_read_b64_tr_b16 a[238:239], v24 offset:28672
    v_mfma_f32_16x16x32_bf16 v[64:67], a[208:211], v[128:131], 0
    s_waitcnt lgkmcnt(12)
    buffer_load_dwordx4 v48, s[20:23], s49 offen offset:2048 lds
    v_mfma_f32_16x16x32_bf16 v[64:67], a[212:215], v[144:147], v[64:67]
    s_waitcnt lgkmcnt(10)
    ds_read_b64_tr_b16 a[160:161], v21 offset:0
    ds_read_b64_tr_b16 a[162:163], v21 offset:4096
    v_mfma_f32_16x16x32_bf16 v[64:67], a[216:219], v[192:195], v[64:67]
    s_waitcnt lgkmcnt(10)
    buffer_load_dwordx4 v49, s[20:23], s49 offen offset:3072 lds
    v_mfma_f32_16x16x32_bf16 v[64:67], a[220:223], v[176:179], v[64:67]
    s_waitcnt lgkmcnt(8)
    ds_read_b64_tr_b16 a[164:165], v21 offset:8192
    ds_read_b64_tr_b16 a[166:167], v21 offset:12288
    v_mfma_f32_16x16x32_bf16 v[64:67], a[224:227], v[136:139], v[64:67]
    s_waitcnt lgkmcnt(8)
    ds_read_b64_tr_b16 a[168:169], v21 offset:16384
    v_cvt_pk_bf16_f32 v238, v124, v125
    v_mfma_f32_16x16x32_bf16 v[64:67], a[228:231], v[152:155], v[64:67]
    s_waitcnt lgkmcnt(7)
    s_add_u32 s38, s56, 180352
    ds_read_b64_tr_b16 a[170:171], v21 offset:20480
    v_cvt_pk_bf16_f32 v239, v126, v127
    v_mfma_f32_16x16x32_bf16 v[64:67], a[232:235], v[200:203], v[64:67]
    s_waitcnt lgkmcnt(6)
    buffer_store_dwordx4 v[236:239], v56, s[28:31], s38 offen sc1
    v_mfma_f32_16x16x32_bf16 v[64:67], a[236:239], v[184:187], v[64:67]
    ds_read_b64_tr_b16 a[172:173], v21 offset:24576
    ds_read_b64_tr_b16 a[174:175], v21 offset:28672
    v_mfma_f32_16x16x32_bf16 v[68:71], a[236:239], v[188:191], 0
    s_lshl_b32 s40, s5, 4
    ds_read_b64_tr_b16 a[176:177], v25 offset:0
    v_mfma_f32_16x16x32_bf16 v[68:71], a[232:235], v[204:207], v[68:71]
    s_add_u32 s40, s40, s4
    ds_read_b64_tr_b16 a[178:179], v25 offset:4096
    v_and_b32 v240, 31, v1
    v_mfma_f32_16x16x32_bf16 v[68:71], a[228:231], v[156:159], v[68:71]
    ds_read_b64_tr_b16 a[180:181], v25 offset:8192
    v_lshrrev_b32 v241, 5, v1
    v_mfma_f32_16x16x32_bf16 v[68:71], a[224:227], v[140:143], v[68:71]
    ds_read_b64_tr_b16 a[182:183], v25 offset:12288
    v_cmp_gt_u32 vcc, 8, v240
    v_mfma_f32_16x16x32_bf16 v[68:71], a[220:223], v[180:183], v[68:71]
    ds_read_b64_tr_b16 a[184:185], v25 offset:16384
    v_mov_b32 v242, 2147483648
    v_mfma_f32_16x16x32_bf16 v[68:71], a[216:219], v[196:199], v[68:71]
    s_lshl_b32 s43, s40, 3
    ds_read_b64_tr_b16 a[186:187], v25 offset:20480
    v_mfma_f32_16x16x32_bf16 v[68:71], a[212:215], v[148:151], v[68:71]
    s_lshl_b32 s44, s3, 1
    ds_read_b64_tr_b16 a[188:189], v25 offset:24576
    v_mfma_f32_16x16x32_bf16 v[68:71], a[208:211], v[132:135], v[68:71]
    s_waitcnt lgkmcnt(13)
    s_add_u32 s43, s43, s44
    ds_read_b64_tr_b16 a[190:191], v25 offset:28672
    v_cndmask_b32 v242, v242, 0, vcc
    v_mfma_f32_16x16x32_bf16 v[72:75], a[160:163], v[128:131], 0
    s_waitcnt lgkmcnt(12)
    ds_read_b64_tr_b16 a[208:209], v22 offset:0
    v_add_u32 v7, s43, v241
    v_mfma_f32_16x16x32_bf16 v[72:75], a[164:167], v[144:147], v[72:75]
    s_waitcnt lgkmcnt(11)
    ds_read_b64_tr_b16 a[210:211], v22 offset:4096
    v_lshlrev_b32 v5, 4, v240
    v_mfma_f32_16x16x32_bf16 v[72:75], a[168:171], v[192:195], v[72:75]
    s_waitcnt lgkmcnt(10)
    ds_read_b64_tr_b16 a[212:213], v22 offset:8192
    v_lshlrev_b32 v243, 4, v241
    v_mfma_f32_16x16x32_bf16 v[72:75], a[172:175], v[176:179], v[72:75]
    s_waitcnt lgkmcnt(9)
    ds_read_b64_tr_b16 a[214:215], v22 offset:12288
    v_lshl_add_u32 v2, v240, 5, v243
    v_mfma_f32_16x16x32_bf16 v[72:75], a[176:179], v[136:139], v[72:75]
    s_waitcnt lgkmcnt(8)
    ds_read_b64_tr_b16 a[216:217], v22 offset:16384
    v_lshrrev_b32 v243, 4, v240
    v_mfma_f32_16x16x32_bf16 v[72:75], a[180:183], v[152:155], v[72:75]
    s_waitcnt lgkmcnt(7)
    ds_read_b64_tr_b16 a[218:219], v22 offset:20480
    v_mul_u32_u24 v243, 1536, v243
    v_mfma_f32_16x16x32_bf16 v[72:75], a[184:187], v[200:203], v[72:75]
    s_waitcnt lgkmcnt(6)
    ds_read_b64_tr_b16 a[220:221], v22 offset:24576
    v_add_u32 v2, v2, v243
    v_mfma_f32_16x16x32_bf16 v[72:75], a[188:191], v[184:187], v[72:75]
    s_mul_i32 s44, s43, 10240
    ds_read_b64_tr_b16 a[222:223], v22 offset:28672
    v_lshrrev_b32 v243, 2, v240
    v_mfma_f32_16x16x32_bf16 v[76:79], a[188:191], v[188:191], 0
    ds_read_b64_tr_b16 a[224:225], v26 offset:0
    v_lshlrev_b32 v243, 6, v243
    v_mfma_f32_16x16x32_bf16 v[76:79], a[184:187], v[204:207], v[76:79]
    ds_read_b64_tr_b16 a[226:227], v26 offset:4096
    v_and_b32 v241, 3, v240
    v_mfma_f32_16x16x32_bf16 v[76:79], a[180:183], v[156:159], v[76:79]
    ds_read_b64_tr_b16 a[228:229], v26 offset:8192
    v_lshl_add_u32 v3, v241, 3, v243
    v_mfma_f32_16x16x32_bf16 v[76:79], a[176:179], v[140:143], v[76:79]
    ds_read_b64_tr_b16 a[230:231], v26 offset:12288
    v_mul_u32_u24 v243, 1152, v7
    v_mfma_f32_16x16x32_bf16 v[76:79], a[172:175], v[180:183], v[76:79]
    ds_read_b64_tr_b16 a[232:233], v26 offset:16384
    v_add_u32 v4, v243, v3
    v_mfma_f32_16x16x32_bf16 v[76:79], a[168:171], v[196:199], v[76:79]
    ds_read_b64_tr_b16 a[234:235], v26 offset:20480
    v_lshl_add_u32 v6, v243, 1, v5
    v_mfma_f32_16x16x32_bf16 v[76:79], a[164:167], v[148:151], v[76:79]
    ds_read_b64_tr_b16 a[236:237], v26 offset:24576
    v_or_b32 v55, v3, v242
    v_mfma_f32_16x16x32_bf16 v[76:79], a[160:163], v[132:135], v[76:79]
    s_waitcnt lgkmcnt(13)
    ds_read_b64_tr_b16 a[238:239], v26 offset:28672
    v_or_b32 v58, v4, v242
    v_mfma_f32_16x16x32_bf16 v[80:83], a[208:211], v[128:131], 0
    s_waitcnt lgkmcnt(12)
    ds_read_b64_tr_b16 a[160:161], v23 offset:0
    v_or_b32 v59, v5, v242
    v_mfma_f32_16x16x32_bf16 v[80:83], a[212:215], v[144:147], v[80:83]
    s_waitcnt lgkmcnt(11)
    ds_read_b64_tr_b16 a[162:163], v23 offset:4096
    v_or_b32 v60, v6, v242
    v_mfma_f32_16x16x32_bf16 v[80:83], a[216:219], v[192:195], v[80:83]
    s_waitcnt lgkmcnt(10)
    ds_read_b64_tr_b16 a[164:165], v23 offset:8192
    s_waitcnt vmcnt(6)
    v_readfirstlane_b32 s36, v11
    v_mfma_f32_16x16x32_bf16 v[80:83], a[220:223], v[176:179], v[80:83]
    s_waitcnt lgkmcnt(9)
    ds_read_b64_tr_b16 a[166:167], v23 offset:12288
    v_lshrrev_b32 v243, 4, v1
    v_mfma_f32_16x16x32_bf16 v[80:83], a[224:227], v[136:139], v[80:83]
    ds_read_b64_tr_b16 a[168:169], v23 offset:16384
    v_lshlrev_b32 v243, 8, v243
    s_cmp_lg_u32 s36, s95
    s_cbranch_scc1 Lattn_xspin
Lattn_xgot:
    s_waitcnt lgkmcnt(9)
    v_mfma_f32_16x16x32_bf16 v[80:83], a[228:231], v[152:155], v[80:83]
    s_waitcnt lgkmcnt(7)
    ds_read_b64_tr_b16 a[170:171], v23 offset:20480
    v_and_b32 v241, 7, v1
    v_mfma_f32_16x16x32_bf16 v[80:83], a[232:235], v[200:203], v[80:83]
    s_waitcnt lgkmcnt(6)
    ds_read_b64_tr_b16 a[172:173], v23 offset:24576
    v_lshl_add_u32 v243, v241, 5, v243
    v_mfma_f32_16x16x32_bf16 v[80:83], a[236:239], v[184:187], v[80:83]
    s_add_u32 s37, s55, 0
    ds_read_b64_tr_b16 a[174:175], v23 offset:28672
    v_and_b32 v241, 8, v1
    v_mfma_f32_16x16x32_bf16 v[84:87], a[236:239], v[188:191], 0
    buffer_load_dwordx4 a[64:67], v252, s[28:31], s37 offen offset:0 sc1
    v_mfma_f32_16x16x32_bf16 v[84:87], a[232:235], v[204:207], v[84:87]
    ds_read_b64_tr_b16 a[176:177], v27 offset:0
    ds_read_b64_tr_b16 a[178:179], v27 offset:4096
    v_mfma_f32_16x16x32_bf16 v[84:87], a[228:231], v[156:159], v[84:87]
    buffer_load_dwordx4 a[68:71], v252, s[28:31], s37 offen offset:1024 sc1
    v_mfma_f32_16x16x32_bf16 v[84:87], a[224:227], v[140:143], v[84:87]
    ds_read_b64_tr_b16 a[180:181], v27 offset:8192
    ds_read_b64_tr_b16 a[182:183], v27 offset:12288
    v_mfma_f32_16x16x32_bf16 v[84:87], a[220:223], v[180:183], v[84:87]
    ds_read_b64_tr_b16 a[184:185], v27 offset:16384
    v_lshl_add_u32 v54, v241, 1, v243
    v_mfma_f32_16x16x32_bf16 v[84:87], a[216:219], v[196:199], v[84:87]
    s_lshr_b32 s41, s2, 3
    ds_read_b64_tr_b16 a[186:187], v27 offset:20480
    v_mfma_f32_16x16x32_bf16 v[84:87], a[212:215], v[148:151], v[84:87]
    buffer_load_dwordx4 a[72:75], v252, s[28:31], s37 offen offset:2048 sc1
    v_mfma_f32_16x16x32_bf16 v[84:87], a[208:211], v[132:135], v[84:87]
    s_waitcnt lgkmcnt(12)
    s_mov_b32 s14, 2359296
    ds_read_b64_tr_b16 a[188:189], v27 offset:24576
    ds_read_b64_tr_b16 a[190:191], v27 offset:28672
    s_barrier
    v_mfma_f32_16x16x32_bf16 v[88:91], a[160:163], v[128:131], 0
    s_waitcnt lgkmcnt(12)
    s_mov_b32 s15, 0x20000
    ds_read_b64_tr_b16 a[208:209], v12 offset:32768
    v_mfma_f32_16x16x32_bf16 v[88:91], a[164:167], v[144:147], v[88:91]
    s_waitcnt lgkmcnt(11)
    s_mov_b32 s18, 2359296
    ds_read_b64_tr_b16 a[210:211], v12 offset:36864
    v_mfma_f32_16x16x32_bf16 v[88:91], a[168:171], v[192:195], v[88:91]
    s_waitcnt lgkmcnt(10)
    buffer_load_dwordx4 a[76:79], v252, s[28:31], s37 offen offset:3072 sc1
    v_mfma_f32_16x16x32_bf16 v[88:91], a[172:175], v[176:179], v[88:91]
    s_waitcnt lgkmcnt(8)
    s_mov_b32 s19, 0x20000
    ds_read_b64_tr_b16 a[212:213], v12 offset:40960
    ds_read_b64_tr_b16 a[214:215], v12 offset:45056
    v_mfma_f32_16x16x32_bf16 v[88:91], a[176:179], v[136:139], v[88:91]
    s_waitcnt lgkmcnt(8)
    s_add_u32 s8, s50, 7864320
    s_addc_u32 s9, s51, 0
    ds_read_b64_tr_b16 a[216:217], v12 offset:49152
    v_mfma_f32_16x16x32_bf16 v[88:91], a[180:183], v[152:155], v[88:91]
    s_waitcnt lgkmcnt(7)
    s_add_u32 s37, s55, 4096
    ds_read_b64_tr_b16 a[218:219], v12 offset:53248
    v_mfma_f32_16x16x32_bf16 v[88:91], a[184:187], v[200:203], v[88:91]
    s_waitcnt lgkmcnt(6)
    s_add_u32 s49, s46, 256
    buffer_load_dwordx4 a[80:83], v252, s[28:31], s37 offen offset:0 sc1
    v_mfma_f32_16x16x32_bf16 v[88:91], a[188:191], v[184:187], v[88:91]
    s_add_u32 m0, s42, 0
    ds_read_b64_tr_b16 a[220:221], v12 offset:57344
    ds_read_b64_tr_b16 a[222:223], v12 offset:61440
    v_mfma_f32_16x16x32_bf16 v[92:95], a[188:191], v[188:191], 0
    buffer_load_dwordx4 v46, s[20:23], s49 offen lds
    v_mfma_f32_16x16x32_bf16 v[92:95], a[184:187], v[204:207], v[92:95]
    s_mov_b32 s10, 663552
    ds_read_b64_tr_b16 a[224:225], v16 offset:32768
    ds_read_b64_tr_b16 a[226:227], v16 offset:36864
    v_mfma_f32_16x16x32_bf16 v[92:95], a[180:183], v[156:159], v[92:95]
    buffer_load_dwordx4 v47, s[20:23], s49 offen offset:1024 lds
    v_mfma_f32_16x16x32_bf16 v[92:95], a[176:179], v[140:143], v[92:95]
    s_mov_b32 s11, 0x20000
    ds_read_b64_tr_b16 a[228:229], v16 offset:40960
    ds_read_b64_tr_b16 a[230:231], v16 offset:45056
    v_mfma_f32_16x16x32_bf16 v[92:95], a[172:175], v[180:183], v[92:95]
    buffer_load_dwordx4 a[84:87], v252, s[28:31], s37 offen offset:1024 sc1
    v_mfma_f32_16x16x32_bf16 v[92:95], a[168:171], v[196:199], v[92:95]
    s_lshl_b32 s39, s5, 13
    ds_read_b64_tr_b16 a[232:233], v16 offset:49152
    ds_read_b64_tr_b16 a[234:235], v16 offset:53248
    v_mfma_f32_16x16x32_bf16 v[92:95], a[164:167], v[148:151], v[92:95]
    s_add_u32 s39, s39, 8781824
    ds_read_b64_tr_b16 a[236:237], v16 offset:57344
    v_mfma_f32_16x16x32_bf16 v[92:95], a[160:163], v[132:135], v[92:95]
    s_waitcnt lgkmcnt(13)
    s_lshr_b32 s45, s4, 2
    ds_read_b64_tr_b16 a[238:239], v16 offset:61440
    v_mfma_f32_16x16x32_bf16 v[96:99], a[208:211], v[128:131], 0
    s_waitcnt lgkmcnt(12)
    buffer_load_dwordx4 v48, s[20:23], s49 offen offset:2048 lds
    v_mfma_f32_16x16x32_bf16 v[96:99], a[212:215], v[144:147], v[96:99]
    s_waitcnt lgkmcnt(10)
    s_lshl_b32 s45, s45, 11
    ds_read_b64_tr_b16 a[160:161], v13 offset:32768
    ds_read_b64_tr_b16 a[162:163], v13 offset:36864
    v_mfma_f32_16x16x32_bf16 v[96:99], a[216:219], v[192:195], v[96:99]
    s_waitcnt lgkmcnt(10)
    buffer_load_dwordx4 v49, s[20:23], s49 offen offset:3072 lds
    v_mfma_f32_16x16x32_bf16 v[96:99], a[220:223], v[176:179], v[96:99]
    s_waitcnt lgkmcnt(8)
    s_add_u32 s39, s39, s45
    ds_read_b64_tr_b16 a[164:165], v13 offset:40960
    ds_read_b64_tr_b16 a[166:167], v13 offset:45056
    v_mfma_f32_16x16x32_bf16 v[96:99], a[224:227], v[136:139], v[96:99]
    s_waitcnt lgkmcnt(8)
    buffer_load_dwordx4 a[88:91], v252, s[28:31], s37 offen offset:2048 sc1
    v_mfma_f32_16x16x32_bf16 v[96:99], a[228:231], v[152:155], v[96:99]
    s_waitcnt lgkmcnt(6)
    ds_read_b64_tr_b16 a[168:169], v13 offset:49152
    ds_read_b64_tr_b16 a[170:171], v13 offset:53248
    v_mfma_f32_16x16x32_bf16 v[96:99], a[232:235], v[200:203], v[96:99]
    s_waitcnt lgkmcnt(6)
    s_add_u32 s49, s46, 73984
    ds_read_b64_tr_b16 a[172:173], v13 offset:57344
    v_and_b32 v9, 15, v1
    v_mfma_f32_16x16x32_bf16 v[96:99], a[236:239], v[184:187], v[96:99]
    s_add_u32 m0, s42, 16384
    ds_read_b64_tr_b16 a[174:175], v13 offset:61440
    v_lshlrev_b32 v9, 7, v9
    v_mfma_f32_16x16x32_bf16 v[100:103], a[236:239], v[188:191], 0
    buffer_load_dwordx4 v46, s[20:23], s49 offen lds
    v_mfma_f32_16x16x32_bf16 v[100:103], a[232:235], v[204:207], v[100:103]
    ds_read_b64_tr_b16 a[176:177], v17 offset:32768
    ds_read_b64_tr_b16 a[178:179], v17 offset:36864
    v_mfma_f32_16x16x32_bf16 v[100:103], a[228:231], v[156:159], v[100:103]
    buffer_load_dwordx4 v47, s[20:23], s49 offen offset:1024 lds
    v_mfma_f32_16x16x32_bf16 v[100:103], a[224:227], v[140:143], v[100:103]
    ds_read_b64_tr_b16 a[180:181], v17 offset:40960
    ds_read_b64_tr_b16 a[182:183], v17 offset:45056
    v_mfma_f32_16x16x32_bf16 v[100:103], a[220:223], v[180:183], v[100:103]
    buffer_load_dwordx4 a[92:95], v252, s[28:31], s37 offen offset:3072 sc1
    v_mfma_f32_16x16x32_bf16 v[100:103], a[216:219], v[196:199], v[100:103]
    ds_read_b64_tr_b16 a[184:185], v17 offset:49152
    ds_read_b64_tr_b16 a[186:187], v17 offset:53248
    v_mfma_f32_16x16x32_bf16 v[100:103], a[212:215], v[148:151], v[100:103]
    ds_read_b64_tr_b16 a[188:189], v17 offset:57344
    v_mfma_f32_16x16x32_bf16 v[100:103], a[208:211], v[132:135], v[100:103]
    s_waitcnt lgkmcnt(13)
    ds_read_b64_tr_b16 a[190:191], v17 offset:61440
    v_mfma_f32_16x16x32_bf16 v[104:107], a[160:163], v[128:131], 0
    s_waitcnt lgkmcnt(12)
    buffer_load_dwordx4 v48, s[20:23], s49 offen offset:2048 lds
    v_mfma_f32_16x16x32_bf16 v[104:107], a[164:167], v[144:147], v[104:107]
    s_waitcnt lgkmcnt(10)
    ds_read_b64_tr_b16 a[208:209], v14 offset:32768
    ds_read_b64_tr_b16 a[210:211], v14 offset:36864
    v_mfma_f32_16x16x32_bf16 v[104:107], a[168:171], v[192:195], v[104:107]
    s_waitcnt lgkmcnt(10)
    buffer_load_dwordx4 v49, s[20:23], s49 offen offset:3072 lds
    v_mfma_f32_16x16x32_bf16 v[104:107], a[172:175], v[176:179], v[104:107]
    s_waitcnt lgkmcnt(8)
    s_add_u32 s37, s55, 8192
    ds_read_b64_tr_b16 a[212:213], v14 offset:40960
    ds_read_b64_tr_b16 a[214:215], v14 offset:45056
    v_mfma_f32_16x16x32_bf16 v[104:107], a[176:179], v[136:139], v[104:107]
    s_waitcnt lgkmcnt(8)
    buffer_load_dwordx4 a[96:99], v252, s[28:31], s37 offen offset:0 sc1
    v_mfma_f32_16x16x32_bf16 v[104:107], a[180:183], v[152:155], v[104:107]
    s_waitcnt lgkmcnt(6)
    ds_read_b64_tr_b16 a[216:217], v14 offset:49152
    ds_read_b64_tr_b16 a[218:219], v14 offset:53248
    v_mfma_f32_16x16x32_bf16 v[104:107], a[184:187], v[200:203], v[104:107]
    s_waitcnt lgkmcnt(6)
    buffer_load_dwordx4 a[100:103], v252, s[28:31], s37 offen offset:1024 sc1
Ltour0_9:
    s_cbranch_execz Lmain0
    v_mfma_f32_16x16x32_bf16 v[104:107], a[188:191], v[184:187], v[104:107]
    ds_read_b64_tr_b16 a[220:221], v14 offset:57344
    ds_read_b64_tr_b16 a[222:223], v14 offset:61440
    v_mfma_f32_16x16x32_bf16 v[108:111], a[188:191], v[188:191], 0
    ds_read_b64_tr_b16 a[224:225], v18 offset:32768
    v_mfma_f32_16x16x32_bf16 v[108:111], a[184:187], v[204:207], v[108:111]
    ds_read_b64_tr_b16 a[226:227], v18 offset:36864
    v_mfma_f32_16x16x32_bf16 v[108:111], a[180:183], v[156:159], v[108:111]
    buffer_load_dwordx4 a[104:107], v252, s[28:31], s37 offen offset:2048 sc1
    v_mfma_f32_16x16x32_bf16 v[108:111], a[176:179], v[140:143], v[108:111]
    ds_read_b64_tr_b16 a[228:229], v18 offset:40960
    ds_read_b64_tr_b16 a[230:231], v18 offset:45056
    v_mfma_f32_16x16x32_bf16 v[108:111], a[172:175], v[180:183], v[108:111]
    ds_read_b64_tr_b16 a[232:233], v18 offset:49152
    v_mfma_f32_16x16x32_bf16 v[108:111], a[168:171], v[196:199], v[108:111]
    ds_read_b64_tr_b16 a[234:235], v18 offset:53248
    v_mfma_f32_16x16x32_bf16 v[108:111], a[164:167], v[148:151], v[108:111]
    buffer_load_dwordx4 a[108:111], v252, s[28:31], s37 offen offset:3072 sc1
    v_mfma_f32_16x16x32_bf16 v[108:111], a[160:163], v[132:135], v[108:111]
    s_waitcnt lgkmcnt(12)
    ds_read_b64_tr_b16 a[236:237], v18 offset:57344
    ds_read_b64_tr_b16 a[238:239], v18 offset:61440
    v_mfma_f32_16x16x32_bf16 v[112:115], a[208:211], v[128:131], 0
    s_waitcnt lgkmcnt(12)
    ds_read_b64_tr_b16 a[160:161], v15 offset:32768
    v_mfma_f32_16x16x32_bf16 v[112:115], a[212:215], v[144:147], v[112:115]
    s_waitcnt lgkmcnt(11)
    s_add_u32 s37, s55, 12288
    ds_read_b64_tr_b16 a[162:163], v15 offset:36864
    v_mfma_f32_16x16x32_bf16 v[112:115], a[216:219], v[192:195], v[112:115]
    s_waitcnt lgkmcnt(10)
    buffer_load_dwordx4 a[112:115], v252, s[28:31], s37 offen offset:0 sc1
    v_mfma_f32_16x16x32_bf16 v[112:115], a[220:223], v[176:179], v[112:115]
    s_waitcnt lgkmcnt(8)
    ds_read_b64_tr_b16 a[164:165], v15 offset:40960
    ds_read_b64_tr_b16 a[166:167], v15 offset:45056
    v_mfma_f32_16x16x32_bf16 v[112:115], a[224:227], v[136:139], v[112:115]
    s_waitcnt lgkmcnt(8)
    buffer_load_dwordx4 a[116:119], v252, s[28:31], s37 offen offset:1024 sc1
    v_mfma_f32_16x16x32_bf16 v[112:115], a[228:231], v[152:155], v[112:115]
    s_waitcnt lgkmcnt(6)
    ds_read_b64_tr_b16 a[168:169], v15 offset:49152
    ds_read_b64_tr_b16 a[170:171], v15 offset:53248
    v_mfma_f32_16x16x32_bf16 v[112:115], a[232:235], v[200:203], v[112:115]
    s_waitcnt lgkmcnt(6)
    ds_read_b64_tr_b16 a[172:173], v15 offset:57344
    v_mfma_f32_16x16x32_bf16 v[112:115], a[236:239], v[184:187], v[112:115]
    ds_read_b64_tr_b16 a[174:175], v15 offset:61440
    v_mfma_f32_16x16x32_bf16 v[116:119], a[236:239], v[188:191], 0
    buffer_load_dwordx4 a[120:123], v252, s[28:31], s37 offen offset:2048 sc1
    v_mfma_f32_16x16x32_bf16 v[116:119], a[232:235], v[204:207], v[116:119]
    ds_read_b64_tr_b16 a[176:177], v19 offset:32768
    ds_read_b64_tr_b16 a[178:179], v19 offset:36864
    v_mfma_f32_16x16x32_bf16 v[116:119], a[228:231], v[156:159], v[116:119]
    ds_read_b64_tr_b16 a[180:181], v19 offset:40960
    v_mfma_f32_16x16x32_bf16 v[116:119], a[224:227], v[140:143], v[116:119]
    ds_read_b64_tr_b16 a[182:183], v19 offset:45056
    v_mfma_f32_16x16x32_bf16 v[116:119], a[220:223], v[180:183], v[116:119]
    buffer_load_dwordx4 a[124:127], v252, s[28:31], s37 offen offset:3072 sc1
    v_mfma_f32_16x16x32_bf16 v[116:119], a[216:219], v[196:199], v[116:119]
    ds_read_b64_tr_b16 a[184:185], v19 offset:49152
    ds_read_b64_tr_b16 a[186:187], v19 offset:53248
    v_mfma_f32_16x16x32_bf16 v[116:119], a[212:215], v[148:151], v[116:119]
    ds_read_b64_tr_b16 a[188:189], v19 offset:57344
    v_mfma_f32_16x16x32_bf16 v[116:119], a[208:211], v[132:135], v[116:119]
    ds_read_b64_tr_b16 a[190:191], v19 offset:61440
    s_waitcnt vmcnt(25)
    s_waitcnt lgkmcnt(0)
    s_barrier
    v_mfma_f32_16x16x32_bf16 v[120:123], a[160:163], v[128:131], 0
    ds_read_b64_tr_b16 a[208:209], v20 offset:32768
    v_mfma_f32_16x16x32_bf16 v[120:123], a[164:167], v[144:147], v[120:123]
    ds_read_b64_tr_b16 a[210:211], v20 offset:36864
    v_mfma_f32_16x16x32_bf16 v[120:123], a[168:171], v[192:195], v[120:123]
    ds_read_b64_tr_b16 a[212:213], v20 offset:40960
    v_mfma_f32_16x16x32_bf16 v[120:123], a[172:175], v[176:179], v[120:123]
    ds_read_b64_tr_b16 a[214:215], v20 offset:45056
    v_mfma_f32_16x16x32_bf16 v[120:123], a[176:179], v[136:139], v[120:123]
    ds_read_b64_tr_b16 a[216:217], v20 offset:49152
    v_mfma_f32_16x16x32_bf16 v[120:123], a[180:183], v[152:155], v[120:123]
    ds_read_b64_tr_b16 a[218:219], v20 offset:53248
    v_mfma_f32_16x16x32_bf16 v[120:123], a[184:187], v[200:203], v[120:123]
    s_add_u32 s49, s7, 512
    ds_read_b64_tr_b16 a[220:221], v20 offset:57344
    v_mfma_f32_16x16x32_bf16 v[120:123], a[188:191], v[184:187], v[120:123]
    s_add_u32 m0, s42, 65536
    ds_read_b64_tr_b16 a[222:223], v20 offset:61440
    v_mfma_f32_16x16x32_bf16 v[124:127], a[188:191], v[188:191], 0
    buffer_load_dwordx4 v46, s[20:23], s49 offen lds
    v_mfma_f32_16x16x32_bf16 v[124:127], a[184:187], v[204:207], v[124:127]
    ds_read_b64_tr_b16 a[224:225], v24 offset:32768
    ds_read_b64_tr_b16 a[226:227], v24 offset:36864
    v_mfma_f32_16x16x32_bf16 v[124:127], a[180:183], v[156:159], v[124:127]
    buffer_load_dwordx4 v47, s[20:23], s49 offen offset:1024 lds
    v_mfma_f32_16x16x32_bf16 v[124:127], a[176:179], v[140:143], v[124:127]
    ds_read_b64_tr_b16 a[228:229], v24 offset:40960
    ds_read_b64_tr_b16 a[230:231], v24 offset:45056
    v_mfma_f32_16x16x32_bf16 v[124:127], a[172:175], v[180:183], v[124:127]
    ds_read_b64_tr_b16 a[232:233], v24 offset:49152
    v_mfma_f32_16x16x32_bf16 v[124:127], a[168:171], v[196:199], v[124:127]
    ds_read_b64_tr_b16 a[234:235], v24 offset:53248
    v_mfma_f32_16x16x32_bf16 v[124:127], a[164:167], v[148:151], v[124:127]
    ds_read_b64_tr_b16 a[236:237], v24 offset:57344
    v_lshrrev_b32 v240, 4, v1
    v_mfma_f32_16x16x32_bf16 v[124:127], a[160:163], v[132:135], v[124:127]
    s_waitcnt vmcnt(25)
    s_waitcnt lgkmcnt(13)
    ds_read_b64_tr_b16 a[238:239], v24 offset:61440
    v_and_b32 v240, 2, v240
    v_mfma_f32_16x16x32_bf16 v[64:67], a[208:211], a[64:67], v[64:67]
    s_waitcnt vmcnt(24)
    s_waitcnt lgkmcnt(12)
    buffer_load_dwordx4 v48, s[20:23], s49 offen offset:2048 lds
    v_mfma_f32_16x16x32_bf16 v[64:67], a[212:215], a[68:71], v[64:67]
    s_waitcnt vmcnt(24)
    s_waitcnt lgkmcnt(10)
    ds_read_b64_tr_b16 a[160:161], v21 offset:32768
    ds_read_b64_tr_b16 a[162:163], v21 offset:36864
    v_mfma_f32_16x16x32_bf16 v[64:67], a[216:219], a[72:75], v[64:67]
    s_waitcnt vmcnt(23)
    s_waitcnt lgkmcnt(10)
    buffer_load_dwordx4 v49, s[20:23], s49 offen offset:3072 lds
    v_mfma_f32_16x16x32_bf16 v[64:67], a[220:223], a[76:79], v[64:67]
    s_waitcnt vmcnt(23)
    s_waitcnt lgkmcnt(8)
    ds_read_b64_tr_b16 a[164:165], v21 offset:40960
    ds_read_b64_tr_b16 a[166:167], v21 offset:45056
    v_mfma_f32_16x16x32_bf16 v[64:67], a[224:227], a[80:83], v[64:67]
    s_waitcnt vmcnt(20)
    s_waitcnt lgkmcnt(8)
    ds_read_b64_tr_b16 a[168:169], v21 offset:49152
    v_bfe_u32 v241, v1, 2, 2
    v_mfma_f32_16x16x32_bf16 v[64:67], a[228:231], a[84:87], v[64:67]
    s_waitcnt vmcnt(17)
    s_waitcnt lgkmcnt(7)
    ds_read_b64_tr_b16 a[170:171], v21 offset:53248
    v_cmp_eq_u32 s[54:55], v240, v241
    v_mfma_f32_16x16x32_bf16 v[64:67], a[232:235], a[88:91], v[64:67]
    s_waitcnt vmcnt(14)
    s_waitcnt lgkmcnt(6)
    s_add_u32 s49, s7, 74240
    ds_read_b64_tr_b16 a[172:173], v21 offset:57344
    v_or_b32 v240, 1, v240
    v_mfma_f32_16x16x32_bf16 v[64:67], a[236:239], a[92:95], v[64:67]
    s_waitcnt vmcnt(4)
    s_add_u32 m0, s42, 81920
    ds_read_b64_tr_b16 a[174:175], v21 offset:61440
    v_cmp_eq_u32 s[36:37], v240, v241
    v_mfma_f32_16x16x32_bf16 v[68:71], a[236:239], a[124:127], v[68:71]
    buffer_load_dwordx4 v46, s[20:23], s49 offen lds
    v_mfma_f32_16x16x32_bf16 v[68:71], a[232:235], a[120:123], v[68:71]
    ds_read_b64_tr_b16 a[176:177], v25 offset:32768
    ds_read_b64_tr_b16 a[178:179], v25 offset:36864
    v_mfma_f32_16x16x32_bf16 v[68:71], a[228:231], a[116:119], v[68:71]
    buffer_load_dwordx4 v47, s[20:23], s49 offen offset:1024 lds
    v_mfma_f32_16x16x32_bf16 v[68:71], a[224:227], a[112:115], v[68:71]
    ds_read_b64_tr_b16 a[180:181], v25 offset:40960
    ds_read_b64_tr_b16 a[182:183], v25 offset:45056
    v_mfma_f32_16x16x32_bf16 v[68:71], a[220:223], a[108:111], v[68:71]
    ds_read_b64_tr_b16 a[184:185], v25 offset:49152
    v_cvt_pk_bf16_f32 v224, v64, v65
    v_mfma_f32_16x16x32_bf16 v[68:71], a[216:219], a[104:107], v[68:71]
    ds_read_b64_tr_b16 a[186:187], v25 offset:53248
    v_cvt_pk_bf16_f32 v225, v66, v67
    v_mfma_f32_16x16x32_bf16 v[68:71], a[212:215], a[100:103], v[68:71]
    buffer_load_dwordx2 v[36:37], v4, s[12:15], 0 offen offset:0
    v_mfma_f32_16x16x32_bf16 v[68:71], a[208:211], a[96:99], v[68:71]
    s_waitcnt lgkmcnt(12)
    ds_read_b64_tr_b16 a[188:189], v25 offset:57344
    ds_read_b64_tr_b16 a[190:191], v25 offset:61440
    v_mfma_f32_16x16x32_bf16 v[72:75], a[160:163], a[64:67], v[72:75]
    s_waitcnt lgkmcnt(12)
    buffer_load_dwordx4 v48, s[20:23], s49 offen offset:2048 lds
    v_mfma_f32_16x16x32_bf16 v[72:75], a[164:167], a[68:71], v[72:75]
    s_waitcnt lgkmcnt(10)
    ds_read_b64_tr_b16 a[208:209], v22 offset:32768
    ds_read_b64_tr_b16 a[210:211], v22 offset:36864
    v_mfma_f32_16x16x32_bf16 v[72:75], a[168:171], a[72:75], v[72:75]
    s_waitcnt lgkmcnt(10)
    buffer_load_dwordx4 v49, s[20:23], s49 offen offset:3072 lds
    v_mfma_f32_16x16x32_bf16 v[72:75], a[172:175], a[76:79], v[72:75]
    s_waitcnt lgkmcnt(8)
    ds_read_b64_tr_b16 a[212:213], v22 offset:40960
    ds_read_b64_tr_b16 a[214:215], v22 offset:45056
    v_mfma_f32_16x16x32_bf16 v[72:75], a[176:179], a[80:83], v[72:75]
    s_waitcnt lgkmcnt(8)
    ds_read_b64_tr_b16 a[216:217], v22 offset:49152
    v_cvt_pk_bf16_f32 v228, v68, v69
    v_mfma_f32_16x16x32_bf16 v[72:75], a[180:183], a[84:87], v[72:75]
    s_waitcnt lgkmcnt(7)
    ds_read_b64_tr_b16 a[218:219], v22 offset:53248
    v_cvt_pk_bf16_f32 v229, v70, v71
    v_mfma_f32_16x16x32_bf16 v[72:75], a[184:187], a[88:91], v[72:75]
    s_waitcnt lgkmcnt(6)
    ds_read_b64_tr_b16 a[220:221], v22 offset:57344
    v_and_b32 v240, 1, v1
    v_mfma_f32_16x16x32_bf16 v[72:75], a[188:191], a[92:95], v[72:75]
    ds_read_b64_tr_b16 a[222:223], v22 offset:61440
    v_lshlrev_b32 v240, 4, v240
    v_mfma_f32_16x16x32_bf16 v[76:79], a[188:191], a[124:127], v[76:79]
    buffer_load_dwordx2 v[38:39], v4, s[12:15], 0 offen offset:32
    v_mfma_f32_16x16x32_bf16 v[76:79], a[184:187], a[120:123], v[76:79]
    ds_read_b64_tr_b16 a[224:225], v26 offset:32768
    ds_read_b64_tr_b16 a[226:227], v26 offset:36864
    v_mfma_f32_16x16x32_bf16 v[76:79], a[180:183], a[116:119], v[76:79]
    ds_read_b64_tr_b16 a[228:229], v26 offset:40960
    v_mov_b32 v241, 0x3f80
    v_mfma_f32_16x16x32_bf16 v[76:79], a[176:179], a[112:115], v[76:79]
    ds_read_b64_tr_b16 a[230:231], v26 offset:45056
    v_lshlrev_b32 v240, v240, v241
    v_mfma_f32_16x16x32_bf16 v[76:79], a[172:175], a[108:111], v[76:79]
    ds_read_b64_tr_b16 a[232:233], v26 offset:49152
    v_cvt_pk_bf16_f32 v226, v72, v73
    v_mfma_f32_16x16x32_bf16 v[76:79], a[168:171], a[104:107], v[76:79]
    s_add_u32 s38, s93, 0
    ds_read_b64_tr_b16 a[234:235], v26 offset:53248
    v_cvt_pk_bf16_f32 v227, v74, v75
    v_mfma_f32_16x16x32_bf16 v[76:79], a[164:167], a[100:103], v[76:79]
    buffer_store_dwordx4 v[224:227], v56, s[28:31], s38 offen sc1
    v_mfma_f32_16x16x32_bf16 v[76:79], a[160:163], a[96:99], v[76:79]
    s_waitcnt lgkmcnt(12)
    ds_read_b64_tr_b16 a[236:237], v26 offset:57344
    ds_read_b64_tr_b16 a[238:239], v26 offset:61440
    v_mfma_f32_16x16x32_bf16 v[80:83], a[208:211], a[64:67], v[80:83]
    s_waitcnt lgkmcnt(12)
    ds_read_b64_tr_b16 a[160:161], v23 offset:32768
    v_bfe_i32 v241, v1, 1, 1
    v_mfma_f32_16x16x32_bf16 v[80:83], a[212:215], a[68:71], v[80:83]
    s_waitcnt lgkmcnt(11)
    ds_read_b64_tr_b16 a[162:163], v23 offset:36864
    v_and_b32 v243, v240, v241
    v_mfma_f32_16x16x32_bf16 v[80:83], a[216:219], a[72:75], v[80:83]
    s_waitcnt lgkmcnt(10)
    buffer_load_dwordx2 v[40:41], v4, s[12:15], 0 offen offset:512
    v_mfma_f32_16x16x32_bf16 v[80:83], a[220:223], a[76:79], v[80:83]
    s_waitcnt lgkmcnt(8)
    ds_read_b64_tr_b16 a[164:165], v23 offset:40960
    ds_read_b64_tr_b16 a[166:167], v23 offset:45056
    v_mfma_f32_16x16x32_bf16 v[80:83], a[224:227], a[80:83], v[80:83]
    s_waitcnt lgkmcnt(8)
    ds_read_b64_tr_b16 a[168:169], v23 offset:49152
    v_cvt_pk_bf16_f32 v230, v76, v77
    v_mfma_f32_16x16x32_bf16 v[80:83], a[228:231], a[84:87], v[80:83]
    s_waitcnt lgkmcnt(7)
    s_add_u32 s38, s93, 163840
    ds_read_b64_tr_b16 a[170:171], v23 offset:53248
    v_cvt_pk_bf16_f32 v231, v78, v79
    v_mfma_f32_16x16x32_bf16 v[80:83], a[232:235], a[88:91], v[80:83]
    s_waitcnt lgkmcnt(6)
    buffer_store_dwordx4 v[228:231], v56, s[28:31], s38 offen sc1
    v_mfma_f32_16x16x32_bf16 v[80:83], a[236:239], a[92:95], v[80:83]
    ds_read_b64_tr_b16 a[172:173], v23 offset:57344
    ds_read_b64_tr_b16 a[174:175], v23 offset:61440
    v_mfma_f32_16x16x32_bf16 v[84:87], a[236:239], a[124:127], v[84:87]
    ds_read_b64_tr_b16 a[176:177], v27 offset:32768
    v_xor_b32 v242, v240, v243
    v_mfma_f32_16x16x32_bf16 v[84:87], a[232:235], a[120:123], v[84:87]
    ds_read_b64_tr_b16 a[178:179], v27 offset:36864
    v_cndmask_b32 v246, 0, v242, s[54:55]
    v_mfma_f32_16x16x32_bf16 v[84:87], a[228:231], a[116:119], v[84:87]
    ds_read_b64_tr_b16 a[180:181], v27 offset:40960
    v_cndmask_b32 v247, 0, v243, s[54:55]
    v_mfma_f32_16x16x32_bf16 v[84:87], a[224:227], a[112:115], v[84:87]
    ds_read_b64_tr_b16 a[182:183], v27 offset:45056
    v_cndmask_b32 v250, 0, v242, s[36:37]
    v_mfma_f32_16x16x32_bf16 v[84:87], a[220:223], a[108:111], v[84:87]
    ds_read_b64_tr_b16 a[184:185], v27 offset:49152
    v_cvt_pk_bf16_f32 v232, v80, v81
    v_mfma_f32_16x16x32_bf16 v[84:87], a[216:219], a[104:107], v[84:87]
    ds_read_b64_tr_b16 a[186:187], v27 offset:53248
    v_cvt_pk_bf16_f32 v233, v82, v83
    v_mfma_f32_16x16x32_bf16 v[84:87], a[212:215], a[100:103], v[84:87]
    buffer_load_dwordx2 v[42:43], v4, s[12:15], 0 offen offset:544
    v_mfma_f32_16x16x32_bf16 v[84:87], a[208:211], a[96:99], v[84:87]
    s_waitcnt lgkmcnt(12)
    ds_read_b64_tr_b16 a[188:189], v27 offset:57344
    ds_read_b64_tr_b16 a[190:191], v27 offset:61440
    s_barrier
    v_mfma_f32_16x16x32_bf16 v[88:91], a[160:163], a[64:67], v[88:91]
    s_waitcnt lgkmcnt(12)
    ds_read_b64_tr_b16 a[208:209], v12 offset:0
    v_cndmask_b32 v251, 0, v243, s[36:37]
    v_mfma_f32_16x16x32_bf16 v[88:91], a[164:167], a[68:71], v[88:91]
    s_waitcnt lgkmcnt(11)
    ds_read_b64_tr_b16 a[210:211], v12 offset:4096
    v_mov_b32 v240, 0
    v_mfma_f32_16x16x32_bf16 v[88:91], a[168:171], a[72:75], v[88:91]
    s_waitcnt lgkmcnt(10)
    ds_read_b64_tr_b16 a[212:213], v12 offset:8192
    v_mov_b32 v241, 0
    v_mfma_f32_16x16x32_bf16 v[88:91], a[172:175], a[76:79], v[88:91]
    s_waitcnt lgkmcnt(9)
    ds_read_b64_tr_b16 a[214:215], v12 offset:12288
    v_mov_b32 v244, 0
    v_mfma_f32_16x16x32_bf16 v[88:91], a[176:179], a[80:83], v[88:91]
    s_waitcnt lgkmcnt(8)
    ds_read_b64_tr_b16 a[216:217], v12 offset:16384
    v_cvt_pk_bf16_f32 v236, v84, v85
    v_mfma_f32_16x16x32_bf16 v[88:91], a[180:183], a[84:87], v[88:91]
    s_waitcnt lgkmcnt(7)
    ds_read_b64_tr_b16 a[218:219], v12 offset:20480
    v_cvt_pk_bf16_f32 v237, v86, v87
    v_mfma_f32_16x16x32_bf16 v[88:91], a[184:187], a[88:91], v[88:91]
    s_waitcnt lgkmcnt(6)
    s_add_u32 s49, s46, 512
    ds_read_b64_tr_b16 a[220:221], v12 offset:24576
    v_mov_b32 v245, 0
    v_mfma_f32_16x16x32_bf16 v[88:91], a[188:191], a[92:95], v[88:91]
    s_add_u32 m0, s42, 32768
    ds_read_b64_tr_b16 a[222:223], v12 offset:28672
    v_mov_b32 v248, 0
    v_mfma_f32_16x16x32_bf16 v[92:95], a[188:191], a[124:127], v[92:95]
    buffer_load_dwordx4 v46, s[20:23], s49 offen lds
    v_mfma_f32_16x16x32_bf16 v[92:95], a[184:187], a[120:123], v[92:95]
    ds_read_b64_tr_b16 a[224:225], v16 offset:0
    ds_read_b64_tr_b16 a[226:227], v16 offset:4096
    v_mfma_f32_16x16x32_bf16 v[92:95], a[180:183], a[116:119], v[92:95]
    buffer_load_dwordx4 v47, s[20:23], s49 offen offset:1024 lds
    v_mfma_f32_16x16x32_bf16 v[92:95], a[176:179], a[112:115], v[92:95]
    ds_read_b64_tr_b16 a[228:229], v16 offset:8192
    ds_read_b64_tr_b16 a[230:231], v16 offset:12288
    v_mfma_f32_16x16x32_bf16 v[92:95], a[172:175], a[108:111], v[92:95]
    ds_read_b64_tr_b16 a[232:233], v16 offset:16384
    v_cvt_pk_bf16_f32 v234, v88, v89
    v_mfma_f32_16x16x32_bf16 v[92:95], a[168:171], a[104:107], v[92:95]
    s_add_u32 s38, s93, 128
    ds_read_b64_tr_b16 a[234:235], v16 offset:20480
    v_cvt_pk_bf16_f32 v235, v90, v91
    v_mfma_f32_16x16x32_bf16 v[92:95], a[164:167], a[100:103], v[92:95]
    buffer_store_dwordx4 v[232:235], v56, s[28:31], s38 offen sc1
    v_mfma_f32_16x16x32_bf16 v[92:95], a[160:163], a[96:99], v[92:95]
    s_waitcnt lgkmcnt(12)
    ds_read_b64_tr_b16 a[236:237], v16 offset:24576
    ds_read_b64_tr_b16 a[238:239], v16 offset:28672
    v_mfma_f32_16x16x32_bf16 v[96:99], a[208:211], a[64:67], v[96:99]
    s_waitcnt lgkmcnt(12)
    buffer_load_dwordx4 v48, s[20:23], s49 offen offset:2048 lds
    v_mfma_f32_16x16x32_bf16 v[96:99], a[212:215], a[68:71], v[96:99]
    s_waitcnt lgkmcnt(10)
    ds_read_b64_tr_b16 a[160:161], v13 offset:0
    ds_read_b64_tr_b16 a[162:163], v13 offset:4096
    v_mfma_f32_16x16x32_bf16 v[96:99], a[216:219], a[72:75], v[96:99]
    s_waitcnt lgkmcnt(10)
    buffer_load_dwordx4 v49, s[20:23], s49 offen offset:3072 lds
    v_mfma_f32_16x16x32_bf16 v[96:99], a[220:223], a[76:79], v[96:99]
    s_waitcnt lgkmcnt(8)
    ds_read_b64_tr_b16 a[164:165], v13 offset:8192
    ds_read_b64_tr_b16 a[166:167], v13 offset:12288
    v_mfma_f32_16x16x32_bf16 v[96:99], a[224:227], a[80:83], v[96:99]
    s_waitcnt lgkmcnt(8)
    ds_read_b64_tr_b16 a[168:169], v13 offset:16384
    v_cvt_pk_bf16_f32 v238, v92, v93
    v_mfma_f32_16x16x32_bf16 v[96:99], a[228:231], a[84:87], v[96:99]
    s_waitcnt lgkmcnt(7)
    s_add_u32 s38, s93, 163968
    ds_read_b64_tr_b16 a[170:171], v13 offset:20480
    v_cvt_pk_bf16_f32 v239, v94, v95
    v_mfma_f32_16x16x32_bf16 v[96:99], a[232:235], a[88:91], v[96:99]
    s_waitcnt lgkmcnt(6)
    s_add_u32 s49, s46, 74240
    buffer_store_dwordx4 v[236:239], v56, s[28:31], s38 offen sc1
    v_mfma_f32_16x16x32_bf16 v[96:99], a[236:239], a[92:95], v[96:99]
    s_add_u32 m0, s42, 49152
    ds_read_b64_tr_b16 a[172:173], v13 offset:24576
    ds_read_b64_tr_b16 a[174:175], v13 offset:28672
    v_mfma_f32_16x16x32_bf16 v[100:103], a[236:239], a[124:127], v[100:103]
    buffer_load_dwordx4 v46, s[20:23], s49 offen lds
    v_mfma_f32_16x16x32_bf16 v[100:103], a[232:235], a[120:123], v[100:103]
    ds_read_b64_tr_b16 a[176:177], v17 offset:0
    ds_read_b64_tr_b16 a[178:179], v17 offset:4096
    v_mfma_f32_16x16x32_bf16 v[100:103], a[228:231], a[116:119], v[100:103]
    buffer_load_dwordx4 v47, s[20:23], s49 offen offset:1024 lds
    v_mfma_f32_16x16x32_bf16 v[100:103], a[224:227], a[112:115], v[100:103]
    ds_read_b64_tr_b16 a[180:181], v17 offset:8192
    ds_read_b64_tr_b16 a[182:183], v17 offset:12288
    v_mfma_f32_16x16x32_bf16 v[100:103], a[220:223], a[108:111], v[100:103]
    ds_read_b64_tr_b16 a[184:185], v17 offset:16384
    v_cvt_pk_bf16_f32 v224, v96, v97
    v_mfma_f32_16x16x32_bf16 v[100:103], a[216:219], a[104:107], v[100:103]
    ds_read_b64_tr_b16 a[186:187], v17 offset:20480
    v_cvt_pk_bf16_f32 v225, v98, v99
    v_mfma_f32_16x16x32_bf16 v[100:103], a[212:215], a[100:103], v[100:103]
    ds_read_b64_tr_b16 a[188:189], v17 offset:24576
    v_mov_b32 v249, 0
    v_mfma_f32_16x16x32_bf16 v[100:103], a[208:211], a[96:99], v[100:103]
    s_waitcnt lgkmcnt(13)
    ds_read_b64_tr_b16 a[190:191], v17 offset:28672
    v_mov_b32 v252, 0
    v_mfma_f32_16x16x32_bf16 v[104:107], a[160:163], a[64:67], v[104:107]
    s_waitcnt lgkmcnt(12)
    buffer_load_dwordx4 v48, s[20:23], s49 offen offset:2048 lds
    v_mfma_f32_16x16x32_bf16 v[104:107], a[164:167], a[68:71], v[104:107]
    s_waitcnt lgkmcnt(10)
    ds_read_b64_tr_b16 a[208:209], v14 offset:0
    ds_read_b64_tr_b16 a[210:211], v14 offset:4096
    v_mfma_f32_16x16x32_bf16 v[104:107], a[168:171], a[72:75], v[104:107]
    s_waitcnt lgkmcnt(10)
    buffer_load_dwordx4 v49, s[20:23], s49 offen offset:3072 lds
    v_mfma_f32_16x16x32_bf16 v[104:107], a[172:175], a[76:79], v[104:107]
    s_waitcnt lgkmcnt(8)
    ds_read_b64_tr_b16 a[212:213], v14 offset:8192
    ds_read_b64_tr_b16 a[214:215], v14 offset:12288
    v_mfma_f32_16x16x32_bf16 v[104:107], a[176:179], a[80:83], v[104:107]
    s_waitcnt lgkmcnt(8)
    ds_read_b64_tr_b16 a[216:217], v14 offset:16384
    v_cvt_pk_bf16_f32 v228, v100, v101
    v_mfma_f32_16x16x32_bf16 v[104:107], a[180:183], a[84:87], v[104:107]
    s_waitcnt lgkmcnt(7)
    ds_read_b64_tr_b16 a[218:219], v14 offset:20480
    v_cvt_pk_bf16_f32 v229, v102, v103
    v_mfma_f32_16x16x32_bf16 v[104:107], a[184:187], a[88:91], v[104:107]
    s_waitcnt lgkmcnt(6)
    ds_read_b64_tr_b16 a[220:221], v14 offset:24576
    v_mov_b32 v253, 0
    v_mfma_f32_16x16x32_bf16 v[104:107], a[188:191], a[92:95], v[104:107]
    ds_read_b64_tr_b16 a[222:223], v14 offset:28672
    v_mfma_f32_16x16x32_bf16 v[108:111], a[188:191], a[124:127], v[108:111]
    ds_read_b64_tr_b16 a[224:225], v18 offset:0
    v_mfma_f32_16x16x32_bf16 v[108:111], a[184:187], a[120:123], v[108:111]
    ds_read_b64_tr_b16 a[226:227], v18 offset:4096
    v_mfma_f32_16x16x32_bf16 v[108:111], a[180:183], a[116:119], v[108:111]
    ds_read_b64_tr_b16 a[228:229], v18 offset:8192
    v_mfma_f32_16x16x32_bf16 v[108:111], a[176:179], a[112:115], v[108:111]
    ds_read_b64_tr_b16 a[230:231], v18 offset:12288
    v_mfma_f32_16x16x32_bf16 v[108:111], a[172:175], a[108:111], v[108:111]
    ds_read_b64_tr_b16 a[232:233], v18 offset:16384
    v_cvt_pk_bf16_f32 v226, v104, v105
    v_mfma_f32_16x16x32_bf16 v[108:111], a[168:171], a[104:107], v[108:111]
    s_add_u32 s38, s93, 512
    ds_read_b64_tr_b16 a[234:235], v18 offset:20480
    v_cvt_pk_bf16_f32 v227, v106, v107
    v_mfma_f32_16x16x32_bf16 v[108:111], a[164:167], a[100:103], v[108:111]
    buffer_store_dwordx4 v[224:227], v56, s[28:31], s38 offen sc1
    v_mfma_f32_16x16x32_bf16 v[108:111], a[160:163], a[96:99], v[108:111]
    s_waitcnt lgkmcnt(12)
    ds_read_b64_tr_b16 a[236:237], v18 offset:24576
    ds_read_b64_tr_b16 a[238:239], v18 offset:28672
    v_mfma_f32_16x16x32_bf16 v[112:115], a[208:211], a[64:67], v[112:115]
    s_waitcnt lgkmcnt(12)
    ds_read_b64_tr_b16 a[160:161], v15 offset:0
    v_mfma_f32_16x16x32_bf16 v[112:115], a[212:215], a[68:71], v[112:115]
    s_waitcnt lgkmcnt(11)
    ds_read_b64_tr_b16 a[162:163], v15 offset:4096
    v_mfma_f32_16x16x32_bf16 v[112:115], a[216:219], a[72:75], v[112:115]
    s_waitcnt lgkmcnt(10)
    ds_read_b64_tr_b16 a[164:165], v15 offset:8192
    v_mfma_f32_16x16x32_bf16 v[112:115], a[220:223], a[76:79], v[112:115]
    s_waitcnt lgkmcnt(9)
    ds_read_b64_tr_b16 a[166:167], v15 offset:12288
    v_mfma_f32_16x16x32_bf16 v[112:115], a[224:227], a[80:83], v[112:115]
    s_waitcnt lgkmcnt(8)
    ds_read_b64_tr_b16 a[168:169], v15 offset:16384
    v_cvt_pk_bf16_f32 v230, v108, v109
    v_mfma_f32_16x16x32_bf16 v[112:115], a[228:231], a[84:87], v[112:115]
    s_waitcnt lgkmcnt(7)
    s_add_u32 s38, s93, 164352
    ds_read_b64_tr_b16 a[170:171], v15 offset:20480
    v_cvt_pk_bf16_f32 v231, v110, v111
    v_mfma_f32_16x16x32_bf16 v[112:115], a[232:235], a[88:91], v[112:115]
    s_waitcnt lgkmcnt(6)
    buffer_store_dwordx4 v[228:231], v56, s[28:31], s38 offen sc1
    v_mfma_f32_16x16x32_bf16 v[112:115], a[236:239], a[92:95], v[112:115]
    ds_read_b64_tr_b16 a[172:173], v15 offset:24576
    ds_read_b64_tr_b16 a[174:175], v15 offset:28672
    v_mfma_f32_16x16x32_bf16 v[116:119], a[236:239], a[124:127], v[116:119]
    ds_read_b64_tr_b16 a[176:177], v19 offset:0
    v_mfma_f32_16x16x32_bf16 v[116:119], a[232:235], a[120:123], v[116:119]
    ds_read_b64_tr_b16 a[178:179], v19 offset:4096
    v_mfma_f32_16x16x32_bf16 v[116:119], a[228:231], a[116:119], v[116:119]
    ds_read_b64_tr_b16 a[180:181], v19 offset:8192
    v_mfma_f32_16x16x32_bf16 v[116:119], a[224:227], a[112:115], v[116:119]
    ds_read_b64_tr_b16 a[182:183], v19 offset:12288
    v_mfma_f32_16x16x32_bf16 v[116:119], a[220:223], a[108:111], v[116:119]
    ds_read_b64_tr_b16 a[184:185], v19 offset:16384
    v_cvt_pk_bf16_f32 v232, v112, v113
    v_mfma_f32_16x16x32_bf16 v[116:119], a[216:219], a[104:107], v[116:119]
    ds_read_b64_tr_b16 a[186:187], v19 offset:20480
    v_cvt_pk_bf16_f32 v233, v114, v115
    v_mfma_f32_16x16x32_bf16 v[116:119], a[212:215], a[100:103], v[116:119]
    ds_read_b64_tr_b16 a[188:189], v19 offset:24576
    v_mfma_f32_16x16x32_bf16 v[116:119], a[208:211], a[96:99], v[116:119]
    s_waitcnt lgkmcnt(13)
    ds_read_b64_tr_b16 a[190:191], v19 offset:28672
    s_waitcnt vmcnt(17)
    s_barrier
    v_mfma_f32_16x16x32_bf16 v[120:123], a[160:163], a[64:67], v[120:123]
    s_waitcnt lgkmcnt(12)
    ds_read_b64_tr_b16 a[208:209], v20 offset:0
    v_mfma_f32_16x16x32_bf16 v[120:123], a[164:167], a[68:71], v[120:123]
    s_waitcnt lgkmcnt(11)
    ds_read_b64_tr_b16 a[210:211], v20 offset:4096
    v_mfma_f32_16x16x32_bf16 v[120:123], a[168:171], a[72:75], v[120:123]
    s_waitcnt lgkmcnt(10)
    ds_read_b64_tr_b16 a[212:213], v20 offset:8192
    v_mfma_f32_16x16x32_bf16 v[120:123], a[172:175], a[76:79], v[120:123]
    s_waitcnt lgkmcnt(9)
    ds_read_b64_tr_b16 a[214:215], v20 offset:12288
    v_mfma_f32_16x16x32_bf16 v[120:123], a[176:179], a[80:83], v[120:123]
    s_waitcnt lgkmcnt(8)
    ds_read_b64_tr_b16 a[216:217], v20 offset:16384
    v_cvt_pk_bf16_f32 v236, v116, v117
    v_mfma_f32_16x16x32_bf16 v[120:123], a[180:183], a[84:87], v[120:123]
    s_waitcnt lgkmcnt(7)
    ds_read_b64_tr_b16 a[218:219], v20 offset:20480
    v_cvt_pk_bf16_f32 v237, v118, v119
    v_mfma_f32_16x16x32_bf16 v[120:123], a[184:187], a[88:91], v[120:123]
    s_waitcnt lgkmcnt(6)
    s_add_u32 s49, s7, 768
    ds_read_b64_tr_b16 a[220:221], v20 offset:24576
    v_mfma_f32_16x16x32_bf16 v[120:123], a[188:191], a[92:95], v[120:123]
    s_add_u32 m0, s42, 98304
    ds_read_b64_tr_b16 a[222:223], v20 offset:28672
    v_mfma_f32_16x16x32_bf16 v[124:127], a[188:191], a[124:127], v[124:127]
    buffer_load_dwordx4 v46, s[20:23], s49 offen lds
    v_mfma_f32_16x16x32_bf16 v[124:127], a[184:187], a[120:123], v[124:127]
    ds_read_b64_tr_b16 a[224:225], v24 offset:0
    ds_read_b64_tr_b16 a[226:227], v24 offset:4096
    v_mfma_f32_16x16x32_bf16 v[124:127], a[180:183], a[116:119], v[124:127]
    buffer_load_dwordx4 v47, s[20:23], s49 offen offset:1024 lds
    v_mfma_f32_16x16x32_bf16 v[124:127], a[176:179], a[112:115], v[124:127]
    ds_read_b64_tr_b16 a[228:229], v24 offset:8192
    ds_read_b64_tr_b16 a[230:231], v24 offset:12288
    v_mfma_f32_16x16x32_bf16 v[124:127], a[172:175], a[108:111], v[124:127]
    ds_read_b64_tr_b16 a[232:233], v24 offset:16384
    v_cvt_pk_bf16_f32 v234, v120, v121
    v_mfma_f32_16x16x32_bf16 v[124:127], a[168:171], a[104:107], v[124:127]
    s_add_u32 s38, s93, 640
    ds_read_b64_tr_b16 a[234:235], v24 offset:20480
    v_cvt_pk_bf16_f32 v235, v122, v123
    v_mfma_f32_16x16x32_bf16 v[124:127], a[164:167], a[100:103], v[124:127]
    buffer_store_dwordx4 v[232:235], v56, s[28:31], s38 offen sc1
    v_mfma_f32_16x16x32_bf16 v[124:127], a[160:163], a[96:99], v[124:127]
    s_waitcnt lgkmcnt(12)
    ds_read_b64_tr_b16 a[236:237], v24 offset:24576
    ds_read_b64_tr_b16 a[238:239], v24 offset:28672
    v_mfma_f32_16x16x32_bf16 v[64:67], a[208:211], v[128:131], 0
    s_waitcnt lgkmcnt(12)
    buffer_load_dwordx4 v48, s[20:23], s49 offen offset:2048 lds
    v_mfma_f32_16x16x32_bf16 v[64:67], a[212:215], v[144:147], v[64:67]
    s_waitcnt lgkmcnt(10)
    ds_read_b64_tr_b16 a[160:161], v21 offset:0
    ds_read_b64_tr_b16 a[162:163], v21 offset:4096
    v_mfma_f32_16x16x32_bf16 v[64:67], a[216:219], v[192:195], v[64:67]
    s_waitcnt lgkmcnt(10)
    buffer_load_dwordx4 v49, s[20:23], s49 offen offset:3072 lds
    v_mfma_f32_16x16x32_bf16 v[64:67], a[220:223], v[176:179], v[64:67]
    s_waitcnt lgkmcnt(8)
    ds_read_b64_tr_b16 a[164:165], v21 offset:8192
    ds_read_b64_tr_b16 a[166:167], v21 offset:12288
    v_mfma_f32_16x16x32_bf16 v[64:67], a[224:227], v[136:139], v[64:67]
    s_waitcnt lgkmcnt(8)
    ds_read_b64_tr_b16 a[168:169], v21 offset:16384
    v_cvt_pk_bf16_f32 v238, v124, v125
    v_mfma_f32_16x16x32_bf16 v[64:67], a[228:231], v[152:155], v[64:67]
    s_waitcnt lgkmcnt(7)
    s_add_u32 s38, s93, 164480
    ds_read_b64_tr_b16 a[170:171], v21 offset:20480
    v_cvt_pk_bf16_f32 v239, v126, v127
    v_mfma_f32_16x16x32_bf16 v[64:67], a[232:235], v[200:203], v[64:67]
    s_waitcnt lgkmcnt(6)
    s_add_u32 s49, s7, 74496
    buffer_store_dwordx4 v[236:239], v56, s[28:31], s38 offen sc1
    v_mfma_f32_16x16x32_bf16 v[64:67], a[236:239], v[184:187], v[64:67]
    s_add_u32 m0, s42, 114688
    ds_read_b64_tr_b16 a[172:173], v21 offset:24576
    ds_read_b64_tr_b16 a[174:175], v21 offset:28672
    v_mfma_f32_16x16x32_bf16 v[68:71], a[236:239], v[188:191], 0
Ltour0_10:
    s_cbranch_execz Lmain0
    buffer_load_dwordx4 v46, s[20:23], s49 offen lds
    v_mfma_f32_16x16x32_bf16 v[68:71], a[232:235], v[204:207], v[68:71]
    ds_read_b64_tr_b16 a[176:177], v25 offset:0
    ds_read_b64_tr_b16 a[178:179], v25 offset:4096
    v_mfma_f32_16x16x32_bf16 v[68:71], a[228:231], v[156:159], v[68:71]
    buffer_load_dwordx4 v47, s[20:23], s49 offen offset:1024 lds
    v_mfma_f32_16x16x32_bf16 v[68:71], a[224:227], v[140:143], v[68:71]
    ds_read_b64_tr_b16 a[180:181], v25 offset:8192
    ds_read_b64_tr_b16 a[182:183], v25 offset:12288
    v_mfma_f32_16x16x32_bf16 v[68:71], a[220:223], v[180:183], v[68:71]
    ds_read_b64_tr_b16 a[184:185], v25 offset:16384
    v_mfma_f32_16x16x32_bf16 v[68:71], a[216:219], v[196:199], v[68:71]
    ds_read_b64_tr_b16 a[186:187], v25 offset:20480
    v_mfma_f32_16x16x32_bf16 v[68:71], a[212:215], v[148:151], v[68:71]
    ds_read_b64_tr_b16 a[188:189], v25 offset:24576
    v_mfma_f32_16x16x32_bf16 v[68:71], a[208:211], v[132:135], v[68:71]
    s_waitcnt lgkmcnt(13)
    ds_read_b64_tr_b16 a[190:191], v25 offset:28672
    v_mfma_f32_16x16x32_bf16 v[72:75], a[160:163], v[128:131], 0
    s_waitcnt lgkmcnt(12)
    buffer_load_dwordx4 v48, s[20:23], s49 offen offset:2048 lds
    v_mfma_f32_16x16x32_bf16 v[72:75], a[164:167], v[144:147], v[72:75]
    s_waitcnt lgkmcnt(10)
    ds_read_b64_tr_b16 a[208:209], v22 offset:0
    ds_read_b64_tr_b16 a[210:211], v22 offset:4096
    v_mfma_f32_16x16x32_bf16 v[72:75], a[168:171], v[192:195], v[72:75]
    s_waitcnt lgkmcnt(10)
    buffer_load_dwordx4 v49, s[20:23], s49 offen offset:3072 lds
    v_mfma_f32_16x16x32_bf16 v[72:75], a[172:175], v[176:179], v[72:75]
    s_waitcnt lgkmcnt(8)
    ds_read_b64_tr_b16 a[212:213], v22 offset:8192
    ds_read_b64_tr_b16 a[214:215], v22 offset:12288
    v_mfma_f32_16x16x32_bf16 v[72:75], a[176:179], v[136:139], v[72:75]
    s_waitcnt lgkmcnt(8)
    ds_read_b64_tr_b16 a[216:217], v22 offset:16384
    v_mfma_f32_16x16x32_bf16 v[72:75], a[180:183], v[152:155], v[72:75]
    s_waitcnt lgkmcnt(7)
    ds_read_b64_tr_b16 a[218:219], v22 offset:20480
    v_mfma_f32_16x16x32_bf16 v[72:75], a[184:187], v[200:203], v[72:75]
    s_waitcnt lgkmcnt(6)
    ds_read_b64_tr_b16 a[220:221], v22 offset:24576
    v_mfma_f32_16x16x32_bf16 v[72:75], a[188:191], v[184:187], v[72:75]
    ds_read_b64_tr_b16 a[222:223], v22 offset:28672
    v_mfma_f32_16x16x32_bf16 v[76:79], a[188:191], v[188:191], 0
    ds_read_b64_tr_b16 a[224:225], v26 offset:0
    v_mfma_f32_16x16x32_bf16 v[76:79], a[184:187], v[204:207], v[76:79]
    ds_read_b64_tr_b16 a[226:227], v26 offset:4096
    v_mfma_f32_16x16x32_bf16 v[76:79], a[180:183], v[156:159], v[76:79]
    ds_read_b64_tr_b16 a[228:229], v26 offset:8192
    v_mfma_f32_16x16x32_bf16 v[76:79], a[176:179], v[140:143], v[76:79]
    ds_read_b64_tr_b16 a[230:231], v26 offset:12288
    v_mfma_f32_16x16x32_bf16 v[76:79], a[172:175], v[180:183], v[76:79]
    ds_read_b64_tr_b16 a[232:233], v26 offset:16384
    v_mfma_f32_16x16x32_bf16 v[76:79], a[168:171], v[196:199], v[76:79]
    ds_read_b64_tr_b16 a[234:235], v26 offset:20480
    v_mfma_f32_16x16x32_bf16 v[76:79], a[164:167], v[148:151], v[76:79]
    buffer_load_dword v63, v63, s[88:91], 0 offen sc1
    v_mfma_f32_16x16x32_bf16 v[76:79], a[160:163], v[132:135], v[76:79]
    s_waitcnt lgkmcnt(12)
    ds_read_b64_tr_b16 a[236:237], v26 offset:24576
    ds_read_b64_tr_b16 a[238:239], v26 offset:28672
    v_mfma_f32_16x16x32_bf16 v[80:83], a[208:211], v[128:131], 0
    s_waitcnt lgkmcnt(12)
    ds_read_b64_tr_b16 a[160:161], v23 offset:0
    v_mfma_f32_16x16x32_bf16 v[80:83], a[212:215], v[144:147], v[80:83]
    s_waitcnt lgkmcnt(11)
    ds_read_b64_tr_b16 a[162:163], v23 offset:4096
    v_mfma_f32_16x16x32_bf16 v[80:83], a[216:219], v[192:195], v[80:83]
    s_waitcnt lgkmcnt(10)
    ds_read_b64_tr_b16 a[164:165], v23 offset:8192
    v_mfma_f32_16x16x32_bf16 v[80:83], a[220:223], v[176:179], v[80:83]
    s_waitcnt lgkmcnt(9)
    ds_read_b64_tr_b16 a[166:167], v23 offset:12288
    v_mfma_f32_16x16x32_bf16 v[80:83], a[224:227], v[136:139], v[80:83]
    s_waitcnt lgkmcnt(8)
    ds_read_b64_tr_b16 a[168:169], v23 offset:16384
    v_mfma_f32_16x16x32_bf16 v[80:83], a[228:231], v[152:155], v[80:83]
    s_waitcnt lgkmcnt(7)
    ds_read_b64_tr_b16 a[170:171], v23 offset:20480
    v_mfma_f32_16x16x32_bf16 v[80:83], a[232:235], v[200:203], v[80:83]
    s_waitcnt lgkmcnt(6)
    ds_read_b64_tr_b16 a[172:173], v23 offset:24576
    v_mfma_f32_16x16x32_bf16 v[80:83], a[236:239], v[184:187], v[80:83]
    ds_read_b64_tr_b16 a[174:175], v23 offset:28672
    v_mfma_f32_16x16x32_bf16 v[84:87], a[236:239], v[188:191], 0
    ds_read_b64_tr_b16 a[176:177], v27 offset:0
    v_mfma_f32_16x16x32_bf16 v[84:87], a[232:235], v[204:207], v[84:87]
    ds_read_b64_tr_b16 a[178:179], v27 offset:4096
    v_mfma_f32_16x16x32_bf16 v[84:87], a[228:231], v[156:159], v[84:87]
    ds_read_b64_tr_b16 a[180:181], v27 offset:8192
    v_mfma_f32_16x16x32_bf16 v[84:87], a[224:227], v[140:143], v[84:87]
    ds_read_b64_tr_b16 a[182:183], v27 offset:12288
    v_mfma_f32_16x16x32_bf16 v[84:87], a[220:223], v[180:183], v[84:87]
    ds_read_b64_tr_b16 a[184:185], v27 offset:16384
    v_mfma_f32_16x16x32_bf16 v[84:87], a[216:219], v[196:199], v[84:87]
    ds_read_b64_tr_b16 a[186:187], v27 offset:20480
    v_mfma_f32_16x16x32_bf16 v[84:87], a[212:215], v[148:151], v[84:87]
    ds_read_b64_tr_b16 a[188:189], v27 offset:24576
    v_mfma_f32_16x16x32_bf16 v[84:87], a[208:211], v[132:135], v[84:87]
    s_waitcnt lgkmcnt(13)
    ds_read_b64_tr_b16 a[190:191], v27 offset:28672
    s_waitcnt vmcnt(13)
    s_barrier
    v_mfma_f32_16x16x32_bf16 v[88:91], a[160:163], v[128:131], 0
    s_waitcnt lgkmcnt(12)
    ds_read_b64_tr_b16 a[208:209], v12 offset:32768
    v_mfma_f32_16x16x32_bf16 v[88:91], a[164:167], v[144:147], v[88:91]
    s_waitcnt lgkmcnt(11)
    ds_read_b64_tr_b16 a[210:211], v12 offset:36864
    v_mfma_f32_16x16x32_bf16 v[88:91], a[168:171], v[192:195], v[88:91]
    s_waitcnt lgkmcnt(10)
    ds_read_b64_tr_b16 a[212:213], v12 offset:40960
    v_mfma_f32_16x16x32_bf16 v[88:91], a[172:175], v[176:179], v[88:91]
    s_waitcnt lgkmcnt(9)
    ds_read_b64_tr_b16 a[214:215], v12 offset:45056
    v_mfma_f32_16x16x32_bf16 v[88:91], a[176:179], v[136:139], v[88:91]
    s_waitcnt lgkmcnt(8)
    ds_read_b64_tr_b16 a[216:217], v12 offset:49152
    v_mfma_f32_16x16x32_bf16 v[88:91], a[180:183], v[152:155], v[88:91]
    s_waitcnt lgkmcnt(7)
    ds_read_b64_tr_b16 a[218:219], v12 offset:53248
    v_mfma_f32_16x16x32_bf16 v[88:91], a[184:187], v[200:203], v[88:91]
    s_waitcnt lgkmcnt(6)
    s_add_u32 s49, s46, 768
    ds_read_b64_tr_b16 a[220:221], v12 offset:57344
    v_mfma_f32_16x16x32_bf16 v[88:91], a[188:191], v[184:187], v[88:91]
    s_add_u32 m0, s42, 0
    ds_read_b64_tr_b16 a[222:223], v12 offset:61440
    v_mfma_f32_16x16x32_bf16 v[92:95], a[188:191], v[188:191], 0
    buffer_load_dwordx4 v46, s[20:23], s49 offen lds
    v_mfma_f32_16x16x32_bf16 v[92:95], a[184:187], v[204:207], v[92:95]
    ds_read_b64_tr_b16 a[224:225], v16 offset:32768
    ds_read_b64_tr_b16 a[226:227], v16 offset:36864
    v_mfma_f32_16x16x32_bf16 v[92:95], a[180:183], v[156:159], v[92:95]
    buffer_load_dwordx4 v47, s[20:23], s49 offen offset:1024 lds
    v_mfma_f32_16x16x32_bf16 v[92:95], a[176:179], v[140:143], v[92:95]
    ds_read_b64_tr_b16 a[228:229], v16 offset:40960
    ds_read_b64_tr_b16 a[230:231], v16 offset:45056
    v_mfma_f32_16x16x32_bf16 v[92:95], a[172:175], v[180:183], v[92:95]
    ds_read_b64_tr_b16 a[232:233], v16 offset:49152
    v_mfma_f32_16x16x32_bf16 v[92:95], a[168:171], v[196:199], v[92:95]
    ds_read_b64_tr_b16 a[234:235], v16 offset:53248
    v_mfma_f32_16x16x32_bf16 v[92:95], a[164:167], v[148:151], v[92:95]
    ds_read_b64_tr_b16 a[236:237], v16 offset:57344
    v_mfma_f32_16x16x32_bf16 v[92:95], a[160:163], v[132:135], v[92:95]
    s_waitcnt lgkmcnt(13)
    ds_read_b64_tr_b16 a[238:239], v16 offset:61440
    v_mfma_f32_16x16x32_bf16 v[64:67], a[208:211], a[64:67], v[64:67]
    s_waitcnt lgkmcnt(12)
    buffer_load_dwordx4 v48, s[20:23], s49 offen offset:2048 lds
    v_mfma_f32_16x16x32_bf16 v[64:67], a[212:215], a[68:71], v[64:67]
    s_waitcnt lgkmcnt(10)
    ds_read_b64_tr_b16 a[160:161], v13 offset:32768
    ds_read_b64_tr_b16 a[162:163], v13 offset:36864
    v_mfma_f32_16x16x32_bf16 v[64:67], a[216:219], a[72:75], v[64:67]
    s_waitcnt lgkmcnt(10)
    s_add_u32 s92, s92, 16
    buffer_load_dwordx4 v49, s[20:23], s49 offen offset:3072 lds
    v_mfma_f32_16x16x32_bf16 v[64:67], a[220:223], a[76:79], v[64:67]
    s_waitcnt lgkmcnt(8)
    s_waitcnt vmcnt(9)
    ds_read_b64_tr_b16 a[164:165], v13 offset:40960
    ds_read_b64_tr_b16 a[166:167], v13 offset:45056
    v_mfma_f32_16x16x32_bf16 v[64:67], a[224:227], a[80:83], v[64:67]
    s_waitcnt lgkmcnt(8)
    buffer_store_dword v10, v8, s[24:27], s92 offen sc1
    v_mfma_f32_16x16x32_bf16 v[64:67], a[228:231], a[84:87], v[64:67]
    s_waitcnt lgkmcnt(6)
    ds_read_b64_tr_b16 a[168:169], v13 offset:49152
    ds_read_b64_tr_b16 a[170:171], v13 offset:53248
    v_mfma_f32_16x16x32_bf16 v[64:67], a[232:235], a[88:91], v[64:67]
    s_waitcnt lgkmcnt(6)
    s_add_u32 s49, s46, 74496
    ds_read_b64_tr_b16 a[172:173], v13 offset:57344
    v_mfma_f32_16x16x32_bf16 v[64:67], a[236:239], a[92:95], v[64:67]
    s_add_u32 m0, s42, 16384
    ds_read_b64_tr_b16 a[174:175], v13 offset:61440
    v_mfma_f32_16x16x32_bf16 v[68:71], a[236:239], a[124:127], v[68:71]
    buffer_load_dwordx4 v46, s[20:23], s49 offen lds
    v_mfma_f32_16x16x32_bf16 v[68:71], a[232:235], a[120:123], v[68:71]
    ds_read_b64_tr_b16 a[176:177], v17 offset:32768
    ds_read_b64_tr_b16 a[178:179], v17 offset:36864
    v_mfma_f32_16x16x32_bf16 v[68:71], a[228:231], a[116:119], v[68:71]
    buffer_load_dwordx4 v47, s[20:23], s49 offen offset:1024 lds
    v_mfma_f32_16x16x32_bf16 v[68:71], a[224:227], a[112:115], v[68:71]
    ds_read_b64_tr_b16 a[180:181], v17 offset:40960
    ds_read_b64_tr_b16 a[182:183], v17 offset:45056
    v_mfma_f32_16x16x32_bf16 v[68:71], a[220:223], a[108:111], v[68:71]
    ds_read_b64_tr_b16 a[184:185], v17 offset:49152
    v_cvt_pk_bf16_f32 v224, v64, v65
    v_mfma_f32_16x16x32_bf16 v[68:71], a[216:219], a[104:107], v[68:71]
    ds_read_b64_tr_b16 a[186:187], v17 offset:53248
    v_cvt_pk_bf16_f32 v225, v66, v67
    v_mfma_f32_16x16x32_bf16 v[68:71], a[212:215], a[100:103], v[68:71]
    ds_read_b64_tr_b16 a[188:189], v17 offset:57344
    v_mfma_f32_16x16x32_bf16 v[68:71], a[208:211], a[96:99], v[68:71]
    s_waitcnt lgkmcnt(13)
    ds_read_b64_tr_b16 a[190:191], v17 offset:61440
    v_mfma_f32_16x16x32_bf16 v[72:75], a[160:163], a[64:67], v[72:75]
    s_waitcnt lgkmcnt(12)
    buffer_load_dwordx4 v48, s[20:23], s49 offen offset:2048 lds
    v_mfma_f32_16x16x32_bf16 v[72:75], a[164:167], a[68:71], v[72:75]
    s_waitcnt lgkmcnt(10)
    ds_read_b64_tr_b16 a[208:209], v14 offset:32768
    ds_read_b64_tr_b16 a[210:211], v14 offset:36864
    v_mfma_f32_16x16x32_bf16 v[72:75], a[168:171], a[72:75], v[72:75]
    s_waitcnt lgkmcnt(10)
    buffer_load_dwordx4 v49, s[20:23], s49 offen offset:3072 lds
    v_mfma_f32_16x16x32_bf16 v[72:75], a[172:175], a[76:79], v[72:75]
    s_waitcnt lgkmcnt(8)
    ds_read_b64_tr_b16 a[212:213], v14 offset:40960
    ds_read_b64_tr_b16 a[214:215], v14 offset:45056
    v_mfma_f32_16x16x32_bf16 v[72:75], a[176:179], a[80:83], v[72:75]
    s_waitcnt lgkmcnt(8)
    ds_read_b64_tr_b16 a[216:217], v14 offset:49152
    v_cvt_pk_bf16_f32 v228, v68, v69
    v_mfma_f32_16x16x32_bf16 v[72:75], a[180:183], a[84:87], v[72:75]
    s_waitcnt lgkmcnt(7)
    ds_read_b64_tr_b16 a[218:219], v14 offset:53248
    v_cvt_pk_bf16_f32 v229, v70, v71
    v_mfma_f32_16x16x32_bf16 v[72:75], a[184:187], a[88:91], v[72:75]
    s_waitcnt lgkmcnt(6)
    s_and_b32 s42, s2, 7
    ds_read_b64_tr_b16 a[220:221], v14 offset:57344
    v_mfma_f32_16x16x32_bf16 v[72:75], a[188:191], a[92:95], v[72:75]
    s_mov_b64 s[20:21], s[52:53]
    ds_read_b64_tr_b16 a[222:223], v14 offset:61440
    v_mfma_f32_16x16x32_bf16 v[76:79], a[188:191], a[124:127], v[76:79]
    ds_read_b64_tr_b16 a[224:225], v18 offset:32768
    s_waitcnt vmcnt(9)
    v_readfirstlane_b32 s37, v63
    v_mfma_f32_16x16x32_bf16 v[76:79], a[184:187], a[120:123], v[76:79]
    s_mov_b32 s22, 1152
    ds_read_b64_tr_b16 a[226:227], v18 offset:36864
    v_mfma_f32_16x16x32_bf16 v[76:79], a[180:183], a[116:119], v[76:79]
    s_mov_b32 s23, 0x20000
    ds_read_b64_tr_b16 a[228:229], v18 offset:40960
    s_cmp_lt_u32 s37, 256
    s_cbranch_scc1 Lattn_armwait
Lattn_armed:
    v_mfma_f32_16x16x32_bf16 v[76:79], a[176:179], a[112:115], v[76:79]
    ds_read_b64_tr_b16 a[230:231], v18 offset:45056
    v_mfma_f32_16x16x32_bf16 v[76:79], a[172:175], a[108:111], v[76:79]
    ds_read_b64_tr_b16 a[232:233], v18 offset:49152
    v_cvt_pk_bf16_f32 v226, v72, v73
    v_mfma_f32_16x16x32_bf16 v[76:79], a[168:171], a[104:107], v[76:79]
    s_add_u32 s38, s93, 1024
    ds_read_b64_tr_b16 a[234:235], v18 offset:53248
    v_cvt_pk_bf16_f32 v227, v74, v75
    v_mfma_f32_16x16x32_bf16 v[76:79], a[164:167], a[100:103], v[76:79]
    buffer_store_dwordx4 v[224:227], v56, s[28:31], s38 offen sc1
    v_mfma_f32_16x16x32_bf16 v[76:79], a[160:163], a[96:99], v[76:79]
    s_waitcnt lgkmcnt(12)
    s_mov_b32 s45, 18688
    ds_read_b64_tr_b16 a[236:237], v18 offset:57344
    ds_read_b64_tr_b16 a[238:239], v18 offset:61440
    v_mfma_f32_16x16x32_bf16 v[80:83], a[208:211], a[64:67], v[80:83]
    s_waitcnt lgkmcnt(12)
    buffer_load_dwordx4 v[160:163], v5, s[24:27], s45 offen offset:0 sc1
    v_mfma_f32_16x16x32_bf16 v[80:83], a[212:215], a[68:71], v[80:83]
    s_waitcnt lgkmcnt(10)
    ds_read_b64_tr_b16 a[160:161], v15 offset:32768
    ds_read_b64_tr_b16 a[162:163], v15 offset:36864
    v_mfma_f32_16x16x32_bf16 v[80:83], a[216:219], a[72:75], v[80:83]
    s_waitcnt lgkmcnt(10)
    buffer_load_dwordx4 v[164:167], v5, s[24:27], s45 offen offset:512 sc1
    v_mfma_f32_16x16x32_bf16 v[80:83], a[220:223], a[76:79], v[80:83]
    s_waitcnt lgkmcnt(8)
    ds_read_b64_tr_b16 a[164:165], v15 offset:40960
    ds_read_b64_tr_b16 a[166:167], v15 offset:45056
    v_mfma_f32_16x16x32_bf16 v[80:83], a[224:227], a[80:83], v[80:83]
    s_waitcnt lgkmcnt(8)
    ds_read_b64_tr_b16 a[168:169], v15 offset:49152
    v_cvt_pk_bf16_f32 v230, v76, v77
    v_mfma_f32_16x16x32_bf16 v[80:83], a[228:231], a[84:87], v[80:83]
    s_waitcnt lgkmcnt(7)
    s_add_u32 s38, s93, 164864
    ds_read_b64_tr_b16 a[170:171], v15 offset:53248
    v_cvt_pk_bf16_f32 v231, v78, v79
    v_mfma_f32_16x16x32_bf16 v[80:83], a[232:235], a[88:91], v[80:83]
    s_waitcnt lgkmcnt(6)
    buffer_store_dwordx4 v[228:231], v56, s[28:31], s38 offen sc1
    v_mfma_f32_16x16x32_bf16 v[80:83], a[236:239], a[92:95], v[80:83]
    ds_read_b64_tr_b16 a[172:173], v15 offset:57344
    ds_read_b64_tr_b16 a[174:175], v15 offset:61440
    v_mfma_f32_16x16x32_bf16 v[84:87], a[236:239], a[124:127], v[84:87]
    ds_read_b64_tr_b16 a[176:177], v19 offset:32768
    v_mfma_f32_16x16x32_bf16 v[84:87], a[232:235], a[120:123], v[84:87]
    ds_read_b64_tr_b16 a[178:179], v19 offset:36864
    v_mfma_f32_16x16x32_bf16 v[84:87], a[228:231], a[116:119], v[84:87]
    buffer_load_dwordx4 v[168:171], v59, s[24:27], s45 offen offset:1024 sc1
    v_mfma_f32_16x16x32_bf16 v[84:87], a[224:227], a[112:115], v[84:87]
    ds_read_b64_tr_b16 a[180:181], v19 offset:40960
    ds_read_b64_tr_b16 a[182:183], v19 offset:45056
    v_mfma_f32_16x16x32_bf16 v[84:87], a[220:223], a[108:111], v[84:87]
    ds_read_b64_tr_b16 a[184:185], v19 offset:49152
    v_cvt_pk_bf16_f32 v232, v80, v81
    v_mfma_f32_16x16x32_bf16 v[84:87], a[216:219], a[104:107], v[84:87]
    s_mov_b32 s45, 20992
    ds_read_b64_tr_b16 a[186:187], v19 offset:53248
    v_cvt_pk_bf16_f32 v233, v82, v83
    v_mfma_f32_16x16x32_bf16 v[84:87], a[212:215], a[100:103], v[84:87]
    buffer_load_dwordx4 v[172:175], v5, s[24:27], s45 offen offset:0 sc1
    v_mfma_f32_16x16x32_bf16 v[84:87], a[208:211], a[96:99], v[84:87]
    s_waitcnt lgkmcnt(12)
    ds_read_b64_tr_b16 a[188:189], v19 offset:57344
    ds_read_b64_tr_b16 a[190:191], v19 offset:61440
    s_barrier
    v_mfma_f32_16x16x32_bf16 v[88:91], a[160:163], a[64:67], v[88:91]
    s_waitcnt lgkmcnt(12)
    ds_read_b64_tr_b16 a[208:209], v20 offset:32768
    v_mfma_f32_16x16x32_bf16 v[88:91], a[164:167], a[68:71], v[88:91]
    s_waitcnt lgkmcnt(11)
    ds_read_b64_tr_b16 a[210:211], v20 offset:36864
    v_mfma_f32_16x16x32_bf16 v[88:91], a[168:171], a[72:75], v[88:91]
    s_waitcnt lgkmcnt(10)
    buffer_load_dwordx4 v[208:211], v5, s[24:27], s45 offen offset:512 sc1
    v_mfma_f32_16x16x32_bf16 v[88:91], a[172:175], a[76:79], v[88:91]
    s_waitcnt lgkmcnt(8)
    ds_read_b64_tr_b16 a[212:213], v20 offset:40960
    ds_read_b64_tr_b16 a[214:215], v20 offset:45056
    v_mfma_f32_16x16x32_bf16 v[88:91], a[176:179], a[80:83], v[88:91]
    s_waitcnt lgkmcnt(8)
    s_add_u32 s57, s59, 4096
    ds_read_b64_tr_b16 a[216:217], v20 offset:49152
    v_cvt_pk_bf16_f32 v236, v84, v85
    v_mfma_f32_16x16x32_bf16 v[88:91], a[180:183], a[84:87], v[88:91]
    s_waitcnt lgkmcnt(7)
    s_add_u32 m0, s6, -98304
    ds_read_b64_tr_b16 a[218:219], v20 offset:53248
    v_cvt_pk_bf16_f32 v237, v86, v87
    v_mfma_f32_16x16x32_bf16 v[88:91], a[184:187], a[88:91], v[88:91]
    s_waitcnt lgkmcnt(6)
    buffer_load_dwordx4 v255, s[84:87], s57 offen lds
    v_mfma_f32_16x16x32_bf16 v[88:91], a[188:191], a[92:95], v[88:91]
    ds_read_b64_tr_b16 a[220:221], v20 offset:57344
    ds_read_b64_tr_b16 a[222:223], v20 offset:61440
    v_mfma_f32_16x16x32_bf16 v[92:95], a[188:191], a[124:127], v[92:95]
    s_add_u32 s57, s59, 8192
    buffer_load_dwordx4 v[212:215], v59, s[24:27], s45 offen offset:1024 sc1
    v_mfma_f32_16x16x32_bf16 v[92:95], a[184:187], a[120:123], v[92:95]
    s_add_u32 m0, s6, -94208
    ds_read_b64_tr_b16 a[224:225], v24 offset:32768
    ds_read_b64_tr_b16 a[226:227], v24 offset:36864
    v_mfma_f32_16x16x32_bf16 v[92:95], a[180:183], a[116:119], v[92:95]
    buffer_load_dwordx4 v255, s[84:87], s57 offen lds
    v_mfma_f32_16x16x32_bf16 v[92:95], a[176:179], a[112:115], v[92:95]
    ds_read_b64_tr_b16 a[228:229], v24 offset:40960
    ds_read_b64_tr_b16 a[230:231], v24 offset:45056
    v_mfma_f32_16x16x32_bf16 v[92:95], a[172:175], a[108:111], v[92:95]
    ds_read_b64_tr_b16 a[232:233], v24 offset:49152
    v_cvt_pk_bf16_f32 v234, v88, v89
    v_mfma_f32_16x16x32_bf16 v[92:95], a[168:171], a[104:107], v[92:95]
    s_add_u32 s38, s93, 1152
    ds_read_b64_tr_b16 a[234:235], v24 offset:53248
    v_cvt_pk_bf16_f32 v235, v90, v91
    v_mfma_f32_16x16x32_bf16 v[92:95], a[164:167], a[100:103], v[92:95]
    buffer_store_dwordx4 v[232:235], v56, s[28:31], s38 offen sc1
    v_mfma_f32_16x16x32_bf16 v[92:95], a[160:163], a[96:99], v[92:95]
    s_waitcnt lgkmcnt(12)
    ds_read_b64_tr_b16 a[236:237], v24 offset:57344
    ds_read_b64_tr_b16 a[238:239], v24 offset:61440
    v_mfma_f32_16x16x32_bf16 v[96:99], a[208:211], v[128:131], 0
    s_waitcnt lgkmcnt(12)
    s_add_u32 s57, s59, 12288
    ds_read_b64_tr_b16 a[160:161], v21 offset:32768
    v_mfma_f32_16x16x32_bf16 v[96:99], a[212:215], v[144:147], v[96:99]
    s_waitcnt lgkmcnt(11)
    s_add_u32 m0, s6, -90112
    ds_read_b64_tr_b16 a[162:163], v21 offset:36864
    v_mfma_f32_16x16x32_bf16 v[96:99], a[216:219], v[192:195], v[96:99]
    s_waitcnt lgkmcnt(10)
    buffer_load_dwordx4 v255, s[84:87], s57 offen lds
    v_mfma_f32_16x16x32_bf16 v[96:99], a[220:223], v[176:179], v[96:99]
    s_waitcnt lgkmcnt(8)
    ds_read_b64_tr_b16 a[164:165], v21 offset:40960
    ds_read_b64_tr_b16 a[166:167], v21 offset:45056
    v_mfma_f32_16x16x32_bf16 v[96:99], a[224:227], v[136:139], v[96:99]
    s_waitcnt lgkmcnt(8)
    ds_read_b64_tr_b16 a[168:169], v21 offset:49152
    v_cvt_pk_bf16_f32 v238, v92, v93
    v_mfma_f32_16x16x32_bf16 v[96:99], a[228:231], v[152:155], v[96:99]
    s_waitcnt lgkmcnt(7)
    s_add_u32 s38, s93, 164992
    ds_read_b64_tr_b16 a[170:171], v21 offset:53248
    v_cvt_pk_bf16_f32 v239, v94, v95
    v_mfma_f32_16x16x32_bf16 v[96:99], a[232:235], v[200:203], v[96:99]
    s_waitcnt lgkmcnt(6)
    buffer_store_dwordx4 v[236:239], v56, s[28:31], s38 offen sc1
    v_mfma_f32_16x16x32_bf16 v[96:99], a[236:239], v[184:187], v[96:99]
    ds_read_b64_tr_b16 a[172:173], v21 offset:57344
    ds_read_b64_tr_b16 a[174:175], v21 offset:61440
    v_mfma_f32_16x16x32_bf16 v[100:103], a[236:239], v[188:191], 0
    s_add_u32 s57, s59, 16384
    buffer_load_dwordx2 v[92:93], v58, s[12:15], 0 offen offset:1024
    v_mfma_f32_16x16x32_bf16 v[100:103], a[232:235], v[204:207], v[100:103]
    s_add_u32 m0, s6, -86016
    ds_read_b64_tr_b16 a[176:177], v25 offset:32768
    ds_read_b64_tr_b16 a[178:179], v25 offset:36864
    v_mfma_f32_16x16x32_bf16 v[100:103], a[228:231], v[156:159], v[100:103]
    buffer_load_dwordx4 v255, s[84:87], s57 offen lds
    v_mfma_f32_16x16x32_bf16 v[100:103], a[224:227], v[140:143], v[100:103]
    ds_read_b64_tr_b16 a[180:181], v25 offset:40960
    ds_read_b64_tr_b16 a[182:183], v25 offset:45056
    v_mfma_f32_16x16x32_bf16 v[100:103], a[220:223], v[180:183], v[100:103]
    ds_read_b64_tr_b16 a[184:185], v25 offset:49152
    v_mfma_f32_16x16x32_bf16 v[100:103], a[216:219], v[196:199], v[100:103]
    ds_read_b64_tr_b16 a[186:187], v25 offset:53248
    v_mfma_f32_16x16x32_bf16 v[100:103], a[212:215], v[148:151], v[100:103]
    buffer_load_dwordx2 v[94:95], v58, s[12:15], 0 offen offset:1056
    v_mfma_f32_16x16x32_bf16 v[100:103], a[208:211], v[132:135], v[100:103]
    s_waitcnt lgkmcnt(12)
    ds_read_b64_tr_b16 a[188:189], v25 offset:57344
    ds_read_b64_tr_b16 a[190:191], v25 offset:61440
    v_mfma_f32_16x16x32_bf16 v[104:107], a[160:163], v[128:131], 0
    s_waitcnt lgkmcnt(12)
    s_add_u32 s57, s59, 20480
    ds_read_b64_tr_b16 a[208:209], v22 offset:32768
    v_mfma_f32_16x16x32_bf16 v[104:107], a[164:167], v[144:147], v[104:107]
    s_waitcnt lgkmcnt(11)
    s_add_u32 m0, s6, -81920
    ds_read_b64_tr_b16 a[210:211], v22 offset:36864
    v_mfma_f32_16x16x32_bf16 v[104:107], a[168:171], v[192:195], v[104:107]
    s_waitcnt lgkmcnt(10)
    buffer_load_dwordx4 v255, s[84:87], s57 offen lds
    v_mfma_f32_16x16x32_bf16 v[104:107], a[172:175], v[176:179], v[104:107]
    s_waitcnt lgkmcnt(8)
    s_mov_b32 s45, 19840
    ds_read_b64_tr_b16 a[212:213], v22 offset:40960
    ds_read_b64_tr_b16 a[214:215], v22 offset:45056
    v_mfma_f32_16x16x32_bf16 v[104:107], a[176:179], v[136:139], v[104:107]
    s_waitcnt lgkmcnt(8)
    s_add_u32 s57, s59, 24576
    buffer_load_dwordx4 v[64:67], v5, s[24:27], s45 offen offset:0 sc1
    v_mfma_f32_16x16x32_bf16 v[104:107], a[180:183], v[152:155], v[104:107]
    s_waitcnt lgkmcnt(6)
    s_add_u32 m0, s6, -77824
    ds_read_b64_tr_b16 a[216:217], v22 offset:49152
    ds_read_b64_tr_b16 a[218:219], v22 offset:53248
    v_mfma_f32_16x16x32_bf16 v[104:107], a[184:187], v[200:203], v[104:107]
    s_waitcnt lgkmcnt(6)
    buffer_load_dwordx4 v255, s[84:87], s57 offen lds
    v_mfma_f32_16x16x32_bf16 v[104:107], a[188:191], v[184:187], v[104:107]
    ds_read_b64_tr_b16 a[220:221], v22 offset:57344
    ds_read_b64_tr_b16 a[222:223], v22 offset:61440
    v_mfma_f32_16x16x32_bf16 v[108:111], a[188:191], v[188:191], 0
    s_add_u32 s57, s59, 28672
    ds_read_b64_tr_b16 a[224:225], v26 offset:32768
    v_mfma_f32_16x16x32_bf16 v[108:111], a[184:187], v[204:207], v[108:111]
    s_add_u32 m0, s6, -73728
    ds_read_b64_tr_b16 a[226:227], v26 offset:36864
    v_mfma_f32_16x16x32_bf16 v[108:111], a[180:183], v[156:159], v[108:111]
    buffer_load_dwordx4 v255, s[84:87], s57 offen lds
    v_mfma_f32_16x16x32_bf16 v[108:111], a[176:179], v[140:143], v[108:111]
    ds_read_b64_tr_b16 a[228:229], v26 offset:40960
    ds_read_b64_tr_b16 a[230:231], v26 offset:45056
    v_mfma_f32_16x16x32_bf16 v[108:111], a[172:175], v[180:183], v[108:111]
    s_add_u32 s57, s59, 32768
    buffer_load_dwordx4 v[68:71], v5, s[24:27], s45 offen offset:512 sc1
    v_mfma_f32_16x16x32_bf16 v[108:111], a[168:171], v[196:199], v[108:111]
    s_add_u32 m0, s6, -69632
    ds_read_b64_tr_b16 a[232:233], v26 offset:49152
    ds_read_b64_tr_b16 a[234:235], v26 offset:53248
    v_mfma_f32_16x16x32_bf16 v[108:111], a[164:167], v[148:151], v[108:111]
    buffer_load_dwordx4 v255, s[84:87], s57 offen lds
    v_mfma_f32_16x16x32_bf16 v[108:111], a[160:163], v[132:135], v[108:111]
    s_waitcnt lgkmcnt(12)
    ds_read_b64_tr_b16 a[236:237], v26 offset:57344
    ds_read_b64_tr_b16 a[238:239], v26 offset:61440
    v_mfma_f32_16x16x32_bf16 v[112:115], a[208:211], v[128:131], 0
    s_waitcnt lgkmcnt(12)
    ds_read_b64_tr_b16 a[160:161], v23 offset:32768
    v_mfma_f32_16x16x32_bf16 v[112:115], a[212:215], v[144:147], v[112:115]
    s_waitcnt lgkmcnt(11)
    ds_read_b64_tr_b16 a[162:163], v23 offset:36864
    v_mfma_f32_16x16x32_bf16 v[112:115], a[216:219], v[192:195], v[112:115]
    s_waitcnt lgkmcnt(10)
    ds_read_b64_tr_b16 a[164:165], v23 offset:40960
    v_mfma_f32_16x16x32_bf16 v[112:115], a[220:223], v[176:179], v[112:115]
    s_waitcnt lgkmcnt(9)
    ds_read_b64_tr_b16 a[166:167], v23 offset:45056
    v_mfma_f32_16x16x32_bf16 v[112:115], a[224:227], v[136:139], v[112:115]
    s_waitcnt lgkmcnt(8)
    buffer_load_dwordx4 v[72:75], v59, s[24:27], s45 offen offset:1024 sc1
    v_mfma_f32_16x16x32_bf16 v[112:115], a[228:231], v[152:155], v[112:115]
    s_waitcnt lgkmcnt(6)
    ds_read_b64_tr_b16 a[168:169], v23 offset:49152
    ds_read_b64_tr_b16 a[170:171], v23 offset:53248
    v_mfma_f32_16x16x32_bf16 v[112:115], a[232:235], v[200:203], v[112:115]
    s_waitcnt lgkmcnt(6)
    ds_read_b64_tr_b16 a[172:173], v23 offset:57344
    v_mfma_f32_16x16x32_bf16 v[112:115], a[236:239], v[184:187], v[112:115]
    ds_read_b64_tr_b16 a[174:175], v23 offset:61440
    v_mfma_f32_16x16x32_bf16 v[116:119], a[236:239], v[188:191], 0
    buffer_load_dwordx2 v[76:77], v3, s[20:23], 0 offen offset:0
    v_mfma_f32_16x16x32_bf16 v[116:119], a[232:235], v[204:207], v[116:119]
    ds_read_b64_tr_b16 a[176:177], v27 offset:32768
    ds_read_b64_tr_b16 a[178:179], v27 offset:36864
    v_mfma_f32_16x16x32_bf16 v[116:119], a[228:231], v[156:159], v[116:119]
    ds_read_b64_tr_b16 a[180:181], v27 offset:40960
    v_mfma_f32_16x16x32_bf16 v[116:119], a[224:227], v[140:143], v[116:119]
    ds_read_b64_tr_b16 a[182:183], v27 offset:45056
    v_mfma_f32_16x16x32_bf16 v[116:119], a[220:223], v[180:183], v[116:119]
    buffer_load_dwordx2 v[78:79], v3, s[20:23], 0 offen offset:32
    v_mfma_f32_16x16x32_bf16 v[116:119], a[216:219], v[196:199], v[116:119]
    ds_read_b64_tr_b16 a[184:185], v27 offset:49152
    ds_read_b64_tr_b16 a[186:187], v27 offset:53248
    v_mfma_f32_16x16x32_bf16 v[116:119], a[212:215], v[148:151], v[116:119]
    ds_read_b64_tr_b16 a[188:189], v27 offset:57344
    v_mfma_f32_16x16x32_bf16 v[116:119], a[208:211], v[132:135], v[116:119]
    ds_read_b64_tr_b16 a[190:191], v27 offset:61440
    s_waitcnt vmcnt(25)
    s_waitcnt lgkmcnt(0)
    s_barrier
    v_mfma_f32_16x16x32_bf16 v[120:123], a[160:163], v[128:131], 0
    ds_read_b64_tr_b16 a[208:209], v12 offset:0
    v_mfma_f32_16x16x32_bf16 v[120:123], a[164:167], v[144:147], v[120:123]
    ds_read_b64_tr_b16 a[210:211], v12 offset:4096
    v_mfma_f32_16x16x32_bf16 v[120:123], a[168:171], v[192:195], v[120:123]
    buffer_load_dwordx2 v[80:81], v3, s[20:23], 0 offen offset:512
    v_mfma_f32_16x16x32_bf16 v[120:123], a[172:175], v[176:179], v[120:123]
    s_add_u32 s39, s39, 16
    ds_read_b64_tr_b16 a[212:213], v12 offset:8192
    ds_read_b64_tr_b16 a[214:215], v12 offset:12288
    v_mfma_f32_16x16x32_bf16 v[120:123], a[176:179], v[136:139], v[120:123]
    buffer_load_dword v11, v9, s[24:27], s39 offen sc1
    v_mfma_f32_16x16x32_bf16 v[120:123], a[180:183], v[152:155], v[120:123]
    ds_read_b64_tr_b16 a[216:217], v12 offset:16384
    ds_read_b64_tr_b16 a[218:219], v12 offset:20480
    v_mfma_f32_16x16x32_bf16 v[120:123], a[184:187], v[200:203], v[120:123]
    ds_read_b64_tr_b16 a[220:221], v12 offset:24576
    v_mfma_f32_16x16x32_bf16 v[120:123], a[188:191], v[184:187], v[120:123]
    ds_read_b64_tr_b16 a[222:223], v12 offset:28672
    v_mfma_f32_16x16x32_bf16 v[124:127], a[188:191], v[188:191], 0
    buffer_load_dwordx2 v[82:83], v3, s[20:23], 0 offen offset:544
    v_mfma_f32_16x16x32_bf16 v[124:127], a[184:187], v[204:207], v[124:127]
    ds_read_b64_tr_b16 a[224:225], v16 offset:0
    ds_read_b64_tr_b16 a[226:227], v16 offset:4096
    v_mfma_f32_16x16x32_bf16 v[124:127], a[180:183], v[156:159], v[124:127]
    ds_read_b64_tr_b16 a[228:229], v16 offset:8192
    v_mfma_f32_16x16x32_bf16 v[124:127], a[176:179], v[140:143], v[124:127]
    ds_read_b64_tr_b16 a[230:231], v16 offset:12288
    v_mfma_f32_16x16x32_bf16 v[124:127], a[172:175], v[180:183], v[124:127]
    buffer_load_dwordx2 v[84:85], v55, s[20:23], 0 offen offset:1024
    v_mfma_f32_16x16x32_bf16 v[124:127], a[168:171], v[196:199], v[124:127]
    ds_read_b64_tr_b16 a[232:233], v16 offset:16384
    ds_read_b64_tr_b16 a[234:235], v16 offset:20480
    v_mfma_f32_16x16x32_bf16 v[124:127], a[164:167], v[148:151], v[124:127]
    ds_read_b64_tr_b16 a[236:237], v16 offset:24576
    v_mfma_f32_16x16x32_bf16 v[124:127], a[160:163], v[132:135], v[124:127]
    s_waitcnt lgkmcnt(13)
    ds_read_b64_tr_b16 a[238:239], v16 offset:28672
    v_mfma_f32_16x16x32_bf16 v[96:99], a[208:211], a[64:67], v[96:99]
    s_waitcnt lgkmcnt(12)
    buffer_load_dwordx2 v[86:87], v55, s[20:23], 0 offen offset:1056
    v_mfma_f32_16x16x32_bf16 v[96:99], a[212:215], a[68:71], v[96:99]
    s_waitcnt lgkmcnt(10)
    ds_read_b64_tr_b16 a[160:161], v13 offset:0
    ds_read_b64_tr_b16 a[162:163], v13 offset:4096
    v_mfma_f32_16x16x32_bf16 v[96:99], a[216:219], a[72:75], v[96:99]
    s_waitcnt lgkmcnt(10)
    ds_read_b64_tr_b16 a[164:165], v13 offset:8192
Ltour0_11:
    s_cbranch_execz Lmain0
    v_mfma_f32_16x16x32_bf16 v[96:99], a[220:223], a[76:79], v[96:99]
    s_waitcnt lgkmcnt(9)
    ds_read_b64_tr_b16 a[166:167], v13 offset:12288
    v_mfma_f32_16x16x32_bf16 v[96:99], a[224:227], a[80:83], v[96:99]
    s_waitcnt lgkmcnt(8)
    ds_read_b64_tr_b16 a[168:169], v13 offset:16384
    v_mfma_f32_16x16x32_bf16 v[96:99], a[228:231], a[84:87], v[96:99]
    s_waitcnt lgkmcnt(7)
    s_mov_b32 s45, 22144
    ds_read_b64_tr_b16 a[170:171], v13 offset:20480
    v_mfma_f32_16x16x32_bf16 v[96:99], a[232:235], a[88:91], v[96:99]
    s_waitcnt lgkmcnt(6)
    buffer_load_dwordx4 v[216:219], v5, s[24:27], s45 offen offset:0 sc1
    v_mfma_f32_16x16x32_bf16 v[96:99], a[236:239], a[92:95], v[96:99]
    ds_read_b64_tr_b16 a[172:173], v13 offset:24576
    ds_read_b64_tr_b16 a[174:175], v13 offset:28672
    v_mfma_f32_16x16x32_bf16 v[100:103], a[236:239], a[124:127], v[100:103]
    ds_read_b64_tr_b16 a[176:177], v17 offset:0
    v_mfma_f32_16x16x32_bf16 v[100:103], a[232:235], a[120:123], v[100:103]
    ds_read_b64_tr_b16 a[178:179], v17 offset:4096
    v_mfma_f32_16x16x32_bf16 v[100:103], a[228:231], a[116:119], v[100:103]
    buffer_load_dwordx4 v[220:223], v5, s[24:27], s45 offen offset:512 sc1
    v_mfma_f32_16x16x32_bf16 v[100:103], a[224:227], a[112:115], v[100:103]
    ds_read_b64_tr_b16 a[180:181], v17 offset:8192
    ds_read_b64_tr_b16 a[182:183], v17 offset:12288
    v_mfma_f32_16x16x32_bf16 v[100:103], a[220:223], a[108:111], v[100:103]
    ds_read_b64_tr_b16 a[184:185], v17 offset:16384
    v_cvt_pk_bf16_f32 v224, v96, v97
    v_mfma_f32_16x16x32_bf16 v[100:103], a[216:219], a[104:107], v[100:103]
    ds_read_b64_tr_b16 a[186:187], v17 offset:20480
    v_cvt_pk_bf16_f32 v225, v98, v99
    v_mfma_f32_16x16x32_bf16 v[100:103], a[212:215], a[100:103], v[100:103]
    ds_read_b64_tr_b16 a[188:189], v17 offset:24576
    v_mfma_f32_16x16x32_bf16 v[100:103], a[208:211], a[96:99], v[100:103]
    s_waitcnt lgkmcnt(13)
    ds_read_b64_tr_b16 a[190:191], v17 offset:28672
    v_mfma_f32_16x16x32_bf16 v[104:107], a[160:163], a[64:67], v[104:107]
    s_waitcnt lgkmcnt(12)
    buffer_load_dwordx4 v[88:91], v59, s[24:27], s45 offen offset:1024 sc1
    v_mfma_f32_16x16x32_bf16 v[104:107], a[164:167], a[68:71], v[104:107]
    s_waitcnt lgkmcnt(10)
    ds_read_b64_tr_b16 a[208:209], v14 offset:0
    ds_read_b64_tr_b16 a[210:211], v14 offset:4096
    v_mfma_f32_16x16x32_bf16 v[104:107], a[168:171], a[72:75], v[104:107]
    s_waitcnt lgkmcnt(10)
    ds_read_b64_tr_b16 a[212:213], v14 offset:8192
    v_mfma_f32_16x16x32_bf16 v[104:107], a[172:175], a[76:79], v[104:107]
    s_waitcnt lgkmcnt(9)
    ds_read_b64_tr_b16 a[214:215], v14 offset:12288
    v_mfma_f32_16x16x32_bf16 v[104:107], a[176:179], a[80:83], v[104:107]
    s_waitcnt lgkmcnt(8)
    ds_read_b64_tr_b16 a[216:217], v14 offset:16384
    v_cvt_pk_bf16_f32 v228, v100, v101
    v_mfma_f32_16x16x32_bf16 v[104:107], a[180:183], a[84:87], v[104:107]
    s_waitcnt lgkmcnt(7)
    ds_read_b64_tr_b16 a[218:219], v14 offset:20480
    v_cvt_pk_bf16_f32 v229, v102, v103
    v_mfma_f32_16x16x32_bf16 v[104:107], a[184:187], a[88:91], v[104:107]
    s_waitcnt lgkmcnt(6)
    ds_read_b64_tr_b16 a[220:221], v14 offset:24576
    v_mfma_f32_16x16x32_bf16 v[104:107], a[188:191], a[92:95], v[104:107]
    ds_read_b64_tr_b16 a[222:223], v14 offset:28672
    v_mfma_f32_16x16x32_bf16 v[108:111], a[188:191], a[124:127], v[108:111]
    ds_read_b64_tr_b16 a[224:225], v18 offset:0
    v_mfma_f32_16x16x32_bf16 v[108:111], a[184:187], a[120:123], v[108:111]
    ds_read_b64_tr_b16 a[226:227], v18 offset:4096
    v_mfma_f32_16x16x32_bf16 v[108:111], a[180:183], a[116:119], v[108:111]
    ds_read_b64_tr_b16 a[228:229], v18 offset:8192
    v_mfma_f32_16x16x32_bf16 v[108:111], a[176:179], a[112:115], v[108:111]
    ds_read_b64_tr_b16 a[230:231], v18 offset:12288
    v_mfma_f32_16x16x32_bf16 v[108:111], a[172:175], a[108:111], v[108:111]
    ds_read_b64_tr_b16 a[232:233], v18 offset:16384
    v_cvt_pk_bf16_f32 v226, v104, v105
    v_mfma_f32_16x16x32_bf16 v[108:111], a[168:171], a[104:107], v[108:111]
    s_add_u32 s38, s93, 1536
    ds_read_b64_tr_b16 a[234:235], v18 offset:20480
    v_cvt_pk_bf16_f32 v227, v106, v107
    v_mfma_f32_16x16x32_bf16 v[108:111], a[164:167], a[100:103], v[108:111]
    buffer_store_dwordx4 v[224:227], v56, s[28:31], s38 offen sc1
    v_mfma_f32_16x16x32_bf16 v[108:111], a[160:163], a[96:99], v[108:111]
    s_waitcnt lgkmcnt(12)
    ds_read_b64_tr_b16 a[236:237], v18 offset:24576
    ds_read_b64_tr_b16 a[238:239], v18 offset:28672
    v_mfma_f32_16x16x32_bf16 v[112:115], a[208:211], a[64:67], v[112:115]
    s_waitcnt lgkmcnt(12)
    ds_read_b64_tr_b16 a[160:161], v15 offset:0
    v_mfma_f32_16x16x32_bf16 v[112:115], a[212:215], a[68:71], v[112:115]
    s_waitcnt lgkmcnt(11)
    ds_read_b64_tr_b16 a[162:163], v15 offset:4096
    v_mfma_f32_16x16x32_bf16 v[112:115], a[216:219], a[72:75], v[112:115]
    s_waitcnt lgkmcnt(10)
    ds_read_b64_tr_b16 a[164:165], v15 offset:8192
    v_mfma_f32_16x16x32_bf16 v[112:115], a[220:223], a[76:79], v[112:115]
    s_waitcnt lgkmcnt(9)
    ds_read_b64_tr_b16 a[166:167], v15 offset:12288
    v_mfma_f32_16x16x32_bf16 v[112:115], a[224:227], a[80:83], v[112:115]
    s_waitcnt lgkmcnt(8)
    ds_read_b64_tr_b16 a[168:169], v15 offset:16384
    v_cvt_pk_bf16_f32 v230, v108, v109
    v_mfma_f32_16x16x32_bf16 v[112:115], a[228:231], a[84:87], v[112:115]
    s_waitcnt lgkmcnt(7)
    s_add_u32 s38, s93, 165376
    ds_read_b64_tr_b16 a[170:171], v15 offset:20480
    v_cvt_pk_bf16_f32 v231, v110, v111
    v_mfma_f32_16x16x32_bf16 v[112:115], a[232:235], a[88:91], v[112:115]
    s_waitcnt lgkmcnt(6)
    buffer_store_dwordx4 v[228:231], v56, s[28:31], s38 offen sc1
    v_mfma_f32_16x16x32_bf16 v[112:115], a[236:239], a[92:95], v[112:115]
    ds_read_b64_tr_b16 a[172:173], v15 offset:24576
    ds_read_b64_tr_b16 a[174:175], v15 offset:28672
    v_mfma_f32_16x16x32_bf16 v[116:119], a[236:239], a[124:127], v[116:119]
    ds_read_b64_tr_b16 a[176:177], v19 offset:0
    v_mfma_f32_16x16x32_bf16 v[116:119], a[232:235], a[120:123], v[116:119]
    ds_read_b64_tr_b16 a[178:179], v19 offset:4096
    v_mfma_f32_16x16x32_bf16 v[116:119], a[228:231], a[116:119], v[116:119]
    ds_read_b64_tr_b16 a[180:181], v19 offset:8192
    v_mfma_f32_16x16x32_bf16 v[116:119], a[224:227], a[112:115], v[116:119]
    ds_read_b64_tr_b16 a[182:183], v19 offset:12288
    v_mfma_f32_16x16x32_bf16 v[116:119], a[220:223], a[108:111], v[116:119]
    ds_read_b64_tr_b16 a[184:185], v19 offset:16384
    v_cvt_pk_bf16_f32 v232, v112, v113
    v_mfma_f32_16x16x32_bf16 v[116:119], a[216:219], a[104:107], v[116:119]
    ds_read_b64_tr_b16 a[186:187], v19 offset:20480
    v_cvt_pk_bf16_f32 v233, v114, v115
    v_mfma_f32_16x16x32_bf16 v[116:119], a[212:215], a[100:103], v[116:119]
    ds_read_b64_tr_b16 a[188:189], v19 offset:24576
    v_mfma_f32_16x16x32_bf16 v[116:119], a[208:211], a[96:99], v[116:119]
    s_waitcnt lgkmcnt(13)
    ds_read_b64_tr_b16 a[190:191], v19 offset:28672
    v_mfma_f32_16x16x32_bf16 v[120:123], a[160:163], a[64:67], v[120:123]
    s_waitcnt lgkmcnt(12)
    v_mfma_f32_16x16x32_bf16 v[120:123], a[164:167], a[68:71], v[120:123]
    s_waitcnt lgkmcnt(10)
    v_mfma_f32_16x16x32_bf16 v[120:123], a[168:171], a[72:75], v[120:123]
    s_waitcnt lgkmcnt(8)
    v_mfma_f32_16x16x32_bf16 v[120:123], a[172:175], a[76:79], v[120:123]
    s_waitcnt lgkmcnt(6)
    v_mfma_f32_16x16x32_bf16 v[120:123], a[176:179], a[80:83], v[120:123]
    s_waitcnt lgkmcnt(4)
    v_cvt_pk_bf16_f32 v236, v116, v117
    v_mfma_f32_16x16x32_bf16 v[120:123], a[180:183], a[84:87], v[120:123]
    s_waitcnt lgkmcnt(2)
    v_cvt_pk_bf16_f32 v237, v118, v119
    v_mfma_f32_16x16x32_bf16 v[120:123], a[184:187], a[88:91], v[120:123]
    s_waitcnt lgkmcnt(0)
    v_mfma_f32_16x16x32_bf16 v[120:123], a[188:191], a[92:95], v[120:123]
    v_mfma_f32_16x16x32_bf16 v[124:127], a[188:191], a[124:127], v[124:127]
    v_mfma_f32_16x16x32_bf16 v[124:127], a[184:187], a[120:123], v[124:127]
    v_mfma_f32_16x16x32_bf16 v[124:127], a[180:183], a[116:119], v[124:127]
    v_mfma_f32_16x16x32_bf16 v[124:127], a[176:179], a[112:115], v[124:127]
    v_mfma_f32_16x16x32_bf16 v[124:127], a[172:175], a[108:111], v[124:127]
    s_nop 2
    v_cvt_pk_bf16_f32 v234, v120, v121
    v_mfma_f32_16x16x32_bf16 v[124:127], a[168:171], a[104:107], v[124:127]
    s_add_u32 s38, s93, 1664
    v_cvt_pk_bf16_f32 v235, v122, v123
    v_mfma_f32_16x16x32_bf16 v[124:127], a[164:167], a[100:103], v[124:127]
    buffer_store_dwordx4 v[232:235], v56, s[28:31], s38 offen sc1
    v_mfma_f32_16x16x32_bf16 v[124:127], a[160:163], a[96:99], v[124:127]
    s_nop 7
    v_cvt_pk_bf16_f32 v238, v124, v125
    s_add_u32 s38, s93, 165504
    v_cvt_pk_bf16_f32 v239, v126, v127
    buffer_store_dwordx4 v[236:239], v56, s[28:31], s38 offen sc1
    s_add_u32 s92, s92, 16
    s_waitcnt vmcnt(35)
    v_lshlrev_b32 v96, 16, v160
    v_and_b32 v97, 0xffff0000, v160
    v_lshlrev_b32 v98, 16, v161
    v_and_b32 v99, 0xffff0000, v161
    v_lshlrev_b32 v100, 16, v162
    v_and_b32 v101, 0xffff0000, v162
    v_lshlrev_b32 v102, 16, v163
    v_and_b32 v103, 0xffff0000, v163
    s_waitcnt vmcnt(34)
    v_lshlrev_b32 v104, 16, v164
    v_and_b32 v105, 0xffff0000, v164
    v_lshlrev_b32 v106, 16, v165
    v_and_b32 v107, 0xffff0000, v165
    v_lshlrev_b32 v108, 16, v166
    v_and_b32 v109, 0xffff0000, v166
    v_lshlrev_b32 v110, 16, v167
    v_and_b32 v111, 0xffff0000, v167
    s_waitcnt vmcnt(32)
    v_lshlrev_b32 v112, 16, v168
    v_and_b32 v113, 0xffff0000, v168
    v_lshlrev_b32 v114, 16, v169
    v_and_b32 v115, 0xffff0000, v169
    v_lshlrev_b32 v116, 16, v170
    v_and_b32 v117, 0xffff0000, v170
    v_lshlrev_b32 v118, 16, v171
    v_and_b32 v119, 0xffff0000, v171
    s_waitcnt vmcnt(31)
    v_lshlrev_b32 v120, 16, v172
    v_and_b32 v121, 0xffff0000, v172
    v_lshlrev_b32 v122, 16, v173
    v_and_b32 v123, 0xffff0000, v173
    v_lshlrev_b32 v124, 16, v174
    v_and_b32 v125, 0xffff0000, v174
    v_lshlrev_b32 v126, 16, v175
    v_and_b32 v127, 0xffff0000, v175
    s_waitcnt vmcnt(30)
    v_lshlrev_b32 v128, 16, v208
    v_and_b32 v129, 0xffff0000, v208
    v_lshlrev_b32 v130, 16, v209
    v_and_b32 v131, 0xffff0000, v209
    v_lshlrev_b32 v132, 16, v210
    v_and_b32 v133, 0xffff0000, v210
    v_lshlrev_b32 v134, 16, v211
    v_and_b32 v135, 0xffff0000, v211
    s_waitcnt vmcnt(28)
    v_lshlrev_b32 v136, 16, v212
    v_and_b32 v137, 0xffff0000, v212
    v_lshlrev_b32 v138, 16, v213
    v_and_b32 v139, 0xffff0000, v213
    v_lshlrev_b32 v140, 16, v214
    v_and_b32 v141, 0xffff0000, v214
    v_lshlrev_b32 v142, 16, v215
    v_and_b32 v143, 0xffff0000, v215
    s_waitcnt vmcnt(19)
    v_lshlrev_b32 v144, 16, v64
    v_and_b32 v145, 0xffff0000, v64
    v_lshlrev_b32 v146, 16, v65
    v_and_b32 v147, 0xffff0000, v65
    v_lshlrev_b32 v148, 16, v66
    v_and_b32 v149, 0xffff0000, v66
    v_lshlrev_b32 v150, 16, v67
    v_and_b32 v151, 0xffff0000, v67
    s_waitcnt vmcnt(16)
    v_lshlrev_b32 v152, 16, v68
    v_and_b32 v153, 0xffff0000, v68
    v_lshlrev_b32 v154, 16, v69
    v_and_b32 v155, 0xffff0000, v69
    v_lshlrev_b32 v156, 16, v70
    v_and_b32 v157, 0xffff0000, v70
    v_lshlrev_b32 v158, 16, v71
    v_and_b32 v159, 0xffff0000, v71
    s_waitcnt vmcnt(14)
    v_lshlrev_b32 v160, 16, v72
    v_and_b32 v161, 0xffff0000, v72
    v_lshlrev_b32 v162, 16, v73
    v_and_b32 v163, 0xffff0000, v73
    v_lshlrev_b32 v164, 16, v74
    v_and_b32 v165, 0xffff0000, v74
    v_lshlrev_b32 v166, 16, v75
    v_and_b32 v167, 0xffff0000, v75
    s_waitcnt vmcnt(13)
    v_lshlrev_b32 v168, 16, v76
    v_and_b32 v169, 0xffff0000, v76
    v_lshlrev_b32 v170, 16, v77
    v_and_b32 v171, 0xffff0000, v77
    s_waitcnt vmcnt(12)
    v_lshlrev_b32 v172, 16, v78
    v_and_b32 v173, 0xffff0000, v78
    v_lshlrev_b32 v174, 16, v79
    v_and_b32 v175, 0xffff0000, v79
    s_waitcnt vmcnt(11)
    v_lshlrev_b32 v176, 16, v80
    v_and_b32 v177, 0xffff0000, v80
    v_lshlrev_b32 v178, 16, v81
    v_and_b32 v179, 0xffff0000, v81
    s_waitcnt vmcnt(9)
    v_lshlrev_b32 v180, 16, v82
    v_and_b32 v181, 0xffff0000, v82
    v_lshlrev_b32 v182, 16, v83
    v_and_b32 v183, 0xffff0000, v83
    s_waitcnt vmcnt(8)
    v_lshlrev_b32 v184, 16, v84
    v_and_b32 v185, 0xffff0000, v84
    v_lshlrev_b32 v186, 16, v85
    v_and_b32 v187, 0xffff0000, v85
    s_waitcnt vmcnt(7)
    v_lshlrev_b32 v188, 16, v86
    v_and_b32 v189, 0xffff0000, v86
    v_lshlrev_b32 v190, 16, v87
    v_and_b32 v191, 0xffff0000, v87
    s_waitcnt vmcnt(0)
    buffer_store_dword v10, v8, s[24:27], s92 offen sc1
    v_cmp_ne_u32 s[54:55], s95, v11
    s_cmp_lg_u64 s[54:55], 0
    s_cbranch_scc1 Ltail_spin1
Ltail_got1:
    s_add_u32 s56, s44, 16384
    buffer_load_dwordx4 a[0:3], v54, s[28:31], s56 offen offset:0 sc1
    buffer_load_dwordx4 a[4:7], v54, s[28:31], s56 offen offset:1024 sc1
    buffer_load_dwordx4 a[8:11], v54, s[28:31], s56 offen offset:2048 sc1
    buffer_load_dwordx4 a[12:15], v54, s[28:31], s56 offen offset:3072 sc1
    s_add_u32 s56, s44, 0
    buffer_load_dwordx4 a[16:19], v2, s[28:31], s56 offen offset:0 sc1
    s_add_u32 s56, s44, 4096
    buffer_load_dwordx4 a[20:23], v2, s[28:31], s56 offen offset:0 sc1
    s_add_u32 s56, s44, 8192
    buffer_load_dwordx4 a[24:27], v2, s[28:31], s56 offen offset:0 sc1
    s_add_u32 s56, s44, 12288
    buffer_load_dwordx4 a[28:31], v2, s[28:31], s56 offen offset:0 sc1
    ds_write_b128 v51, a[128:131] offset:0
    ds_write_b128 v51, a[132:135] offset:4096
    ds_write_b128 v51, a[136:139] offset:8192
    ds_write_b128 v51, a[140:143] offset:12288
    ds_write_b128 v51, a[144:147] offset:16384
    ds_write_b128 v51, a[148:151] offset:20480
    ds_write_b128 v51, a[152:155] offset:24576
    ds_write_b128 v51, a[156:159] offset:28672
    ds_write_b128 v51, a[240:243] offset:32768
    ds_write_b128 v255, a[244:247] offset:40960
    ds_write_b128 v255, a[248:251] offset:45056
    ds_write_b128 v255, a[252:255] offset:61440
    v_lshlrev_b32 v12, 16, v36
    v_and_b32 v13, 0xffff0000, v36
    v_lshlrev_b32 v14, 16, v37
    v_and_b32 v15, 0xffff0000, v37
    v_lshlrev_b32 v16, 16, v38
    v_and_b32 v17, 0xffff0000, v38
    v_lshlrev_b32 v18, 16, v39
    v_and_b32 v19, 0xffff0000, v39
    v_lshlrev_b32 v20, 16, v40
    v_and_b32 v21, 0xffff0000, v40
    v_lshlrev_b32 v22, 16, v41
    v_and_b32 v23, 0xffff0000, v41
    v_lshlrev_b32 v24, 16, v42
    v_and_b32 v25, 0xffff0000, v42
    v_lshlrev_b32 v26, 16, v43
    v_and_b32 v27, 0xffff0000, v43
    v_lshlrev_b32 v28, 16, v92
    v_and_b32 v29, 0xffff0000, v92
    v_lshlrev_b32 v30, 16, v93
    v_and_b32 v31, 0xffff0000, v93
    v_lshlrev_b32 v32, 16, v94
    v_and_b32 v33, 0xffff0000, v94
    v_lshlrev_b32 v34, 16, v95
    v_and_b32 v35, 0xffff0000, v95
    v_lshlrev_b32 v192, 16, v216
    v_and_b32 v193, 0xffff0000, v216
    v_lshlrev_b32 v194, 16, v217
    v_and_b32 v195, 0xffff0000, v217
    v_lshlrev_b32 v196, 16, v218
    v_and_b32 v197, 0xffff0000, v218
    v_lshlrev_b32 v198, 16, v219
    v_and_b32 v199, 0xffff0000, v219
    v_lshlrev_b32 v200, 16, v220
    v_and_b32 v201, 0xffff0000, v220
    v_lshlrev_b32 v202, 16, v221
    v_and_b32 v203, 0xffff0000, v221
    v_lshlrev_b32 v204, 16, v222
    v_and_b32 v205, 0xffff0000, v222
    v_lshlrev_b32 v206, 16, v223
    v_and_b32 v207, 0xffff0000, v223
    v_lshlrev_b32 v208, 16, v88
    v_and_b32 v209, 0xffff0000, v88
    v_lshlrev_b32 v210, 16, v89
    v_and_b32 v211, 0xffff0000, v89
    v_lshlrev_b32 v212, 16, v90
    v_and_b32 v213, 0xffff0000, v90
    v_lshlrev_b32 v214, 16, v91
    v_and_b32 v215, 0xffff0000, v91
    s_add_u32 s39, s39, 16
    buffer_load_dword v11, v9, s[24:27], s39 offen sc1
    s_add_u32 s56, s44, 0
    buffer_load_dwordx4 a[32:35], v2, s[28:31], s56 offen offset:512 sc1
    s_add_u32 s56, s44, 4096
    buffer_load_dwordx4 a[36:39], v2, s[28:31], s56 offen offset:512 sc1
    s_add_u32 s56, s44, 8192
    buffer_load_dwordx4 a[40:43], v2, s[28:31], s56 offen offset:512 sc1
    s_add_u32 s56, s44, 12288
    buffer_load_dwordx4 a[44:47], v2, s[28:31], s56 offen offset:512 sc1
    v_lshrrev_b32 v56, 2, v1
    v_and_b32 v57, 3, v1
    v_lshlrev_b32 v57, 3, v57
    s_and_b32 s36, s3, 1
    s_lshl_b32 s36, s36, 5
    v_lshl_add_u32 v61, v56, 6, v57
    v_add_u32 v61, s36, v61
    s_mov_b32 s36, 135168
    s_mov_b32 s37, 12288
    s_cmp_lt_u32 s3, 2
    s_cselect_b32 s36, 98304, s36
    s_cselect_b32 s37, 98304, s37
    v_add_u32 v94, s37, v61
    v_add_u32 v61, s36, v61
    v_mul_u32_u24 v95, 1152, v56
    s_lshl_b32 s36, s3, 7
    s_add_u32 s36, s36, 61440
    v_add3_u32 v95, v95, v57, s36
    s_waitcnt lgkmcnt(0)
    s_barrier
    ds_read_b64_tr_b16 a[96:97], v61 offset:0
    ds_read_b64_tr_b16 a[98:99], v61 offset:1024
    ds_read_b64_tr_b16 a[100:101], v61 offset:2048
    ds_read_b64_tr_b16 a[102:103], v61 offset:3072
    ds_read_b64_tr_b16 a[104:105], v61 offset:4096
    ds_read_b64_tr_b16 a[106:107], v61 offset:5120
    ds_read_b64_tr_b16 a[108:109], v61 offset:6144
    ds_read_b64_tr_b16 a[110:111], v61 offset:7168
    ds_read_b64_tr_b16 a[112:113], v61 offset:8192
    ds_read_b64_tr_b16 a[114:115], v61 offset:9216
    ds_read_b64_tr_b16 a[116:117], v61 offset:10240
    ds_read_b64_tr_b16 a[118:119], v61 offset:11264
    ds_read_b64_tr_b16 a[120:121], v61 offset:12288
    ds_read_b64_tr_b16 a[122:123], v61 offset:13312
    ds_read_b64_tr_b16 a[124:125], v61 offset:14336
    ds_read_b64_tr_b16 a[126:127], v61 offset:15360
    ds_read_b64_tr_b16 a[128:129], v61 offset:16384
    ds_read_b64_tr_b16 a[130:131], v61 offset:17408
    ds_read_b64_tr_b16 a[132:133], v61 offset:18432
    ds_read_b64_tr_b16 a[134:135], v61 offset:19456
    ds_read_b64_tr_b16 a[136:137], v61 offset:20480
    ds_read_b64_tr_b16 a[138:139], v61 offset:21504
    ds_read_b64_tr_b16 a[140:141], v61 offset:22528
    ds_read_b64_tr_b16 a[142:143], v61 offset:23552
    ds_read_b64_tr_b16 a[144:145], v61 offset:24576
    ds_read_b64_tr_b16 a[146:147], v61 offset:25600
    ds_read_b64_tr_b16 a[148:149], v61 offset:26624
    ds_read_b64_tr_b16 a[150:151], v61 offset:27648
    ds_read_b64_tr_b16 a[152:153], v94 offset:28672
    ds_read_b64_tr_b16 a[154:155], v94 offset:29696
    ds_read_b64_tr_b16 a[156:157], v94 offset:30720
    ds_read_b64_tr_b16 a[158:159], v94 offset:31744
    ds_read_b64_tr_b16 a[160:161], v94 offset:32768
    ds_read_b64_tr_b16 a[162:163], v94 offset:33792
    ds_read_b64_tr_b16 a[164:165], v94 offset:34816
    ds_read_b64_tr_b16 a[166:167], v94 offset:35840
    ds_read_b64_tr_b16 a[168:169], v95 offset:0
    ds_read_b64_tr_b16 a[170:171], v95 offset:18432
    ds_read_b64_tr_b16 a[172:173], v95 offset:32
    ds_read_b64_tr_b16 a[174:175], v95 offset:18464
    ds_read_b64_tr_b16 a[176:177], v95 offset:64
    ds_read_b64_tr_b16 a[178:179], v95 offset:18496
    ds_read_b64_tr_b16 a[180:181], v95 offset:96
    ds_read_b64_tr_b16 a[182:183], v95 offset:18528
    ds_read_b64_tr_b16 a[184:185], v95 offset:512
    ds_read_b64_tr_b16 a[186:187], v95 offset:18944
    ds_read_b64_tr_b16 a[188:189], v95 offset:544
    ds_read_b64_tr_b16 a[190:191], v95 offset:18976
    ds_read_b64_tr_b16 a[192:193], v95 offset:576
    ds_read_b64_tr_b16 a[194:195], v95 offset:19008
    ds_read_b64_tr_b16 a[196:197], v95 offset:608
    ds_read_b64_tr_b16 a[198:199], v95 offset:19040
    ds_read_b64_tr_b16 a[200:201], v95 offset:1024
    ds_read_b64_tr_b16 a[202:203], v95 offset:19456
    ds_read_b64_tr_b16 a[204:205], v95 offset:1056
    ds_read_b64_tr_b16 a[206:207], v95 offset:19488
    ds_read_b64_tr_b16 a[208:209], v95 offset:1088
    ds_read_b64_tr_b16 a[210:211], v95 offset:19520
    ds_read_b64_tr_b16 a[212:213], v95 offset:1120
    ds_read_b64_tr_b16 a[214:215], v95 offset:19552
    s_mov_b64 exec, 0
    s_cmp_eq_u32 s3, 0
    s_cbranch_scc1 Ltour1_0
    s_cmp_eq_u32 s3, 1
    s_cbranch_scc1 Ltour1_1
    s_cmp_eq_u32 s3, 2
    s_cbranch_scc1 Ltour1_2
    s_branch Ltour1_3
Lmain1:
    s_mov_b64 exec, -1
    v_pk_mul_f32 v[62:63], v[144:145], v[168:169]
    v_pk_mul_f32 v[168:169], v[168:169], v[120:121]
    v_pk_fma_f32 v[62:63], v[146:147], v[170:171], v[62:63]
    v_pk_mul_f32 v[170:171], v[170:171], v[122:123]
    v_pk_add_f32 v[88:89], v[168:169], v[170:171]
    v_pk_fma_f32 v[62:63], v[148:149], v[172:173], v[62:63]
    v_pk_mul_f32 v[172:173], v[172:173], v[124:125]
    v_pk_add_f32 v[88:89], v[88:89], v[172:173]
    v_pk_fma_f32 v[62:63], v[150:151], v[174:175], v[62:63]
    v_pk_mul_f32 v[174:175], v[174:175], v[126:127]
    v_pk_add_f32 v[88:89], v[88:89], v[174:175]
    v_pk_fma_f32 v[62:63], v[152:153], v[176:177], v[62:63]
    v_pk_mul_f32 v[176:177], v[176:177], v[128:129]
    v_pk_add_f32 v[88:89], v[88:89], v[176:177]
    v_pk_fma_f32 v[62:63], v[154:155], v[178:179], v[62:63]
    v_pk_mul_f32 v[178:179], v[178:179], v[130:131]
    v_pk_add_f32 v[88:89], v[88:89], v[178:179]
    v_pk_fma_f32 v[62:63], v[156:157], v[180:181], v[62:63]
    v_pk_mul_f32 v[180:181], v[180:181], v[132:133]
    v_pk_add_f32 v[88:89], v[88:89], v[180:181]
    v_pk_fma_f32 v[62:63], v[158:159], v[182:183], v[62:63]
    v_pk_mul_f32 v[182:183], v[182:183], v[134:135]
    v_pk_add_f32 v[88:89], v[88:89], v[182:183]
    v_pk_fma_f32 v[62:63], v[160:161], v[184:185], v[62:63]
    v_pk_mul_f32 v[184:185], v[184:185], v[136:137]
    v_pk_add_f32 v[88:89], v[88:89], v[184:185]
    v_pk_fma_f32 v[62:63], v[162:163], v[186:187], v[62:63]
    v_pk_mul_f32 v[186:187], v[186:187], v[138:139]
    v_pk_add_f32 v[88:89], v[88:89], v[186:187]
    v_pk_fma_f32 v[62:63], v[164:165], v[188:189], v[62:63]
    v_pk_mul_f32 v[188:189], v[188:189], v[140:141]
    v_pk_add_f32 v[88:89], v[88:89], v[188:189]
    v_pk_fma_f32 v[62:63], v[166:167], v[190:191], v[62:63]
    v_pk_mul_f32 v[190:191], v[190:191], v[142:143]
    v_pk_add_f32 v[88:89], v[88:89], v[190:191]
    v_add_f32 v91, v62, v63
    v_add_f32 v90, v88, v89
    s_nop 1
    v_add_f32_dpp v90, v90, v90 row_ror:8 row_mask:0xf bank_mask:0xf
    v_add_f32_dpp v91, v91, v91 row_ror:8 row_mask:0xf bank_mask:0xf
    s_nop 0
    v_add_f32_dpp v90, v90, v90 row_ror:4 row_mask:0xf bank_mask:0xf
    v_add_f32_dpp v91, v91, v91 row_ror:4 row_mask:0xf bank_mask:0xf
    s_nop 0
    v_add_f32_dpp v90, v90, v90 row_ror:2 row_mask:0xf bank_mask:0xf
    v_add_f32_dpp v91, v91, v91 row_ror:2 row_mask:0xf bank_mask:0xf
    s_nop 0
    v_add_f32_dpp v90, v90, v90 row_ror:1 row_mask:0xf bank_mask:0xf
    v_add_f32_dpp v91, v91, v91 row_ror:1 row_mask:0xf bank_mask:0xf
    v_mov_b32 v62, v90
    v_mov_b32 v63, v91
    s_nop 0
    v_permlane16_swap_b32 v90, v62
    v_permlane16_swap_b32 v91, v63
    v_add_f32 v90, v90, v62
    v_add_f32 v91, v91, v63
    v_lshlrev_b32 v92, 2, v7
    v_and_b32 v92, 28, v92
    v_sub_u32 v93, 2047, v7
    s_waitcnt vmcnt(12)
    v_mfma_f32_16x16x32_bf16 v[80:83], v[242:245], a[0:3], 0
    v_mfma_f32_16x16x32_bf16 v[84:87], v[240:243], a[0:3], 0
    s_waitcnt vmcnt(11)
    v_mfma_f32_16x16x32_bf16 v[80:83], v[242:245], a[4:7], v[80:83]
    v_mfma_f32_16x16x32_bf16 v[84:87], v[240:243], a[4:7], v[84:87]
    s_waitcnt vmcnt(10)
    v_mfma_f32_16x16x32_bf16 v[80:83], v[242:245], a[8:11], v[80:83]
    v_mfma_f32_16x16x32_bf16 v[84:87], v[240:243], a[8:11], v[84:87]
    s_waitcnt vmcnt(9)
    v_mfma_f32_16x16x32_bf16 v[80:83], v[242:245], a[12:15], v[80:83]
    v_mfma_f32_16x16x32_bf16 v[84:87], v[240:243], a[12:15], v[84:87]
    s_waitcnt vmcnt(8)
    s_nop 5
    v_mov_b32_dpp v80, v80 row_ror:8 row_mask:0x4 bank_mask:0xf
    v_mov_b32_dpp v81, v81 row_ror:8 row_mask:0x4 bank_mask:0xf
    v_mov_b32_dpp v82, v82 row_ror:8 row_mask:0x4 bank_mask:0xf
    v_mov_b32_dpp v83, v83 row_ror:8 row_mask:0x4 bank_mask:0xf
    v_mov_b32_dpp v84, v84 row_ror:8 row_mask:0x4 bank_mask:0xf
    v_mov_b32_dpp v85, v85 row_ror:8 row_mask:0x4 bank_mask:0xf
    v_mov_b32_dpp v86, v86 row_ror:8 row_mask:0x4 bank_mask:0xf
    v_mov_b32_dpp v87, v87 row_ror:8 row_mask:0x4 bank_mask:0xf
    v_pk_fma_f32 v[28:29], v[112:113], v[80:81], v[28:29]
    v_pk_fma_f32 v[30:31], v[114:115], v[82:83], v[30:31]
    v_pk_fma_f32 v[32:33], v[116:117], v[84:85], v[32:33]
    v_pk_fma_f32 v[34:35], v[118:119], v[86:87], v[34:35]
    v_cvt_pk_bf16_f32 v44, v28, v29
    v_cvt_pk_bf16_f32 v45, v30, v31
    v_cvt_pk_bf16_f32 v46, v32, v33
    v_cvt_pk_bf16_f32 v47, v34, v35
    v_lshlrev_b32 v28, 16, v44
    v_and_b32 v29, 0xffff0000, v44
    v_lshlrev_b32 v30, 16, v45
    v_and_b32 v31, 0xffff0000, v45
    v_lshlrev_b32 v32, 16, v46
    v_and_b32 v33, 0xffff0000, v46
    v_lshlrev_b32 v34, 16, v47
    v_and_b32 v35, 0xffff0000, v47
    v_mfma_f32_16x16x32_bf16 v[64:67], v[246:249], a[16:19], 0
    v_mfma_f32_16x16x32_bf16 v[68:71], v[244:247], a[16:19], 0
    s_waitcnt vmcnt(7)
    v_mfma_f32_16x16x32_bf16 v[64:67], v[246:249], a[20:23], v[64:67]
    v_mfma_f32_16x16x32_bf16 v[68:71], v[244:247], a[20:23], v[68:71]
    s_waitcnt vmcnt(6)
    v_mfma_f32_16x16x32_bf16 v[64:67], v[246:249], a[24:27], v[64:67]
    v_mfma_f32_16x16x32_bf16 v[68:71], v[244:247], a[24:27], v[68:71]
    s_waitcnt vmcnt(5)
    v_mfma_f32_16x16x32_bf16 v[64:67], v[246:249], a[28:31], v[64:67]
    v_mfma_f32_16x16x32_bf16 v[68:71], v[244:247], a[28:31], v[68:71]
    s_waitcnt vmcnt(4)
    v_cmp_ne_u32 s[54:55], s95, v11
    s_cmp_lg_u64 s[54:55], 0
    s_cbranch_scc1 Ltail_spin2
Ltail_got2:
    s_add_u32 s56, s44, 0
    buffer_load_dwordx4 a[48:51], v2, s[28:31], s56 offen offset:1024 sc1
    s_add_u32 s56, s44, 4096
    buffer_load_dwordx4 a[52:55], v2, s[28:31], s56 offen offset:1024 sc1
    s_add_u32 s56, s44, 8192
    buffer_load_dwordx4 a[56:59], v2, s[28:31], s56 offen offset:1024 sc1
    s_add_u32 s56, s44, 12288
    buffer_load_dwordx4 a[60:63], v2, s[28:31], s56 offen offset:1024 sc1
    s_add_u32 s56, s44, 0
    buffer_load_dwordx4 a[64:67], v2, s[28:31], s56 offen offset:1536 sc1
    s_add_u32 s56, s44, 4096
    buffer_load_dwordx4 a[68:71], v2, s[28:31], s56 offen offset:1536 sc1
    s_add_u32 s56, s44, 8192
    buffer_load_dwordx4 a[72:75], v2, s[28:31], s56 offen offset:1536 sc1
    s_add_u32 s56, s44, 12288
    buffer_load_dwordx4 a[76:79], v2, s[28:31], s56 offen offset:1536 sc1
    s_movk_i32 s48, 0x7ff
    s_waitcnt vmcnt(11)
    v_mfma_f32_16x16x32_bf16 v[64:67], v[250:253], a[32:35], v[64:67]
    v_mfma_f32_16x16x32_bf16 v[68:71], v[248:251], a[32:35], v[68:71]
    s_waitcnt vmcnt(10)
    v_mfma_f32_16x16x32_bf16 v[64:67], v[250:253], a[36:39], v[64:67]
    v_mfma_f32_16x16x32_bf16 v[68:71], v[248:251], a[36:39], v[68:71]
    s_waitcnt vmcnt(9)
    v_mfma_f32_16x16x32_bf16 v[64:67], v[250:253], a[40:43], v[64:67]
    v_mfma_f32_16x16x32_bf16 v[68:71], v[248:251], a[40:43], v[68:71]
    s_waitcnt vmcnt(8)
    v_mfma_f32_16x16x32_bf16 v[64:67], v[250:253], a[44:47], v[64:67]
    v_mfma_f32_16x16x32_bf16 v[68:71], v[248:251], a[44:47], v[68:71]
    s_waitcnt vmcnt(7)
    s_nop 5
    v_pk_fma_f32 v[12:13], v[96:97], v[64:65], v[12:13]
    v_pk_fma_f32 v[14:15], v[98:99], v[66:67], v[14:15]
    v_pk_fma_f32 v[16:17], v[100:101], v[68:69], v[16:17]
    v_pk_fma_f32 v[18:19], v[102:103], v[70:71], v[18:19]
    v_cvt_pk_bf16_f32 v36, v12, v13
    v_cvt_pk_bf16_f32 v37, v14, v15
    v_cvt_pk_bf16_f32 v38, v16, v17
    v_cvt_pk_bf16_f32 v39, v18, v19
Ltour1_0:
    s_cbranch_execz Ltour1_4
    v_lshlrev_b32 v12, 16, v36
    v_and_b32 v13, 0xffff0000, v36
    v_lshlrev_b32 v14, 16, v37
    v_and_b32 v15, 0xffff0000, v37
    v_lshlrev_b32 v16, 16, v38
    v_and_b32 v17, 0xffff0000, v38
    v_lshlrev_b32 v18, 16, v39
    v_and_b32 v19, 0xffff0000, v39
    v_pk_add_f32 v[88:89], v[12:13], v[14:15]
    v_pk_add_f32 v[62:63], v[16:17], v[18:19]
    v_pk_add_f32 v[88:89], v[88:89], v[62:63]
    v_add_f32 v88, v88, v89
    s_nop 1
    v_add_f32_dpp v88, v88, v88 row_ror:8 row_mask:0xf bank_mask:0xf
    s_nop 1
    v_add_f32_dpp v88, v88, v88 row_ror:4 row_mask:0xf bank_mask:0xf
    s_nop 1
    v_add_f32_dpp v88, v88, v88 row_ror:2 row_mask:0xf bank_mask:0xf
    s_nop 1
    v_add_f32_dpp v88, v88, v88 row_ror:1 row_mask:0xf bank_mask:0xf
    v_mov_b32 v62, v88
    s_nop 1
    v_permlane16_swap_b32 v88, v62
    s_nop 0
    v_add_f32 v88, v88, v62
    v_mul_f32 v88, 0x3b800000, v88
    v_pk_add_f32 v[232:233], v[28:29], v[88:89] op_sel_hi:[1,0] neg_lo:[0,1] neg_hi:[0,1]
    v_pk_add_f32 v[234:235], v[30:31], v[88:89] op_sel_hi:[1,0] neg_lo:[0,1] neg_hi:[0,1]
    v_pk_add_f32 v[236:237], v[32:33], v[88:89] op_sel_hi:[1,0] neg_lo:[0,1] neg_hi:[0,1]
    v_pk_add_f32 v[238:239], v[34:35], v[88:89] op_sel_hi:[1,0] neg_lo:[0,1] neg_hi:[0,1]
    v_pk_add_f32 v[48:49], v[232:233], v[234:235]
    v_pk_mul_f32 v[50:51], v[232:233], v[232:233]
    v_pk_mul_f32 v[52:53], v[232:233], v[184:185]
    v_pk_fma_f32 v[50:51], v[234:235], v[234:235], v[50:51]
    v_pk_fma_f32 v[52:53], v[234:235], v[186:187], v[52:53]
    v_pk_add_f32 v[48:49], v[48:49], v[236:237]
    v_pk_fma_f32 v[50:51], v[236:237], v[236:237], v[50:51]
    v_pk_fma_f32 v[52:53], v[236:237], v[188:189], v[52:53]
    v_pk_add_f32 v[48:49], v[48:49], v[238:239]
    v_pk_fma_f32 v[50:51], v[238:239], v[238:239], v[50:51]
    v_pk_fma_f32 v[52:53], v[238:239], v[190:191], v[52:53]
    v_cndmask_b32 v48, 0, v48, vcc
    v_cndmask_b32 v49, 0, v49, vcc
    v_cndmask_b32 v50, 0, v50, vcc
    v_cndmask_b32 v51, 0, v51, vcc
    v_pk_add_f32 v[216:217], v[12:13], v[88:89] op_sel_hi:[1,0] neg_lo:[0,1] neg_hi:[0,1]
    v_pk_add_f32 v[218:219], v[14:15], v[88:89] op_sel_hi:[1,0] neg_lo:[0,1] neg_hi:[0,1]
    v_pk_add_f32 v[220:221], v[16:17], v[88:89] op_sel_hi:[1,0] neg_lo:[0,1] neg_hi:[0,1]
    v_pk_add_f32 v[222:223], v[18:19], v[88:89] op_sel_hi:[1,0] neg_lo:[0,1] neg_hi:[0,1]
    v_pk_add_f32 v[48:49], v[48:49], v[216:217]
    v_pk_fma_f32 v[50:51], v[216:217], v[216:217], v[50:51]
    v_pk_fma_f32 v[52:53], v[216:217], v[168:169], v[52:53]
    v_pk_add_f32 v[48:49], v[48:49], v[218:219]
    v_pk_fma_f32 v[50:51], v[218:219], v[218:219], v[50:51]
    v_pk_fma_f32 v[52:53], v[218:219], v[170:171], v[52:53]
    v_pk_add_f32 v[48:49], v[48:49], v[220:221]
    v_pk_fma_f32 v[50:51], v[220:221], v[220:221], v[50:51]
    v_pk_fma_f32 v[52:53], v[220:221], v[172:173], v[52:53]
    v_pk_add_f32 v[48:49], v[48:49], v[222:223]
    v_pk_fma_f32 v[50:51], v[222:223], v[222:223], v[50:51]
    v_pk_fma_f32 v[52:53], v[222:223], v[174:175], v[52:53]
    v_mfma_f32_16x16x32_bf16 v[72:75], v[246:249], a[48:51], 0
    v_mfma_f32_16x16x32_bf16 v[76:79], v[244:247], a[48:51], 0
    s_waitcnt vmcnt(6)
    v_mfma_f32_16x16x32_bf16 v[72:75], v[246:249], a[52:55], v[72:75]
    v_mfma_f32_16x16x32_bf16 v[76:79], v[244:247], a[52:55], v[76:79]
    s_waitcnt vmcnt(5)
    v_mfma_f32_16x16x32_bf16 v[72:75], v[246:249], a[56:59], v[72:75]
    v_mfma_f32_16x16x32_bf16 v[76:79], v[244:247], a[56:59], v[76:79]
    s_waitcnt vmcnt(4)
    v_mfma_f32_16x16x32_bf16 v[72:75], v[246:249], a[60:63], v[72:75]
    v_mfma_f32_16x16x32_bf16 v[76:79], v[244:247], a[60:63], v[76:79]
    s_waitcnt vmcnt(3)
    v_mfma_f32_16x16x32_bf16 v[72:75], v[250:253], a[64:67], v[72:75]
    v_mfma_f32_16x16x32_bf16 v[76:79], v[248:251], a[64:67], v[76:79]
    s_waitcnt vmcnt(2)
    v_mfma_f32_16x16x32_bf16 v[72:75], v[250:253], a[68:71], v[72:75]
    v_mfma_f32_16x16x32_bf16 v[76:79], v[248:251], a[68:71], v[76:79]
    s_waitcnt vmcnt(1)
    v_mfma_f32_16x16x32_bf16 v[72:75], v[250:253], a[72:75], v[72:75]
    v_mfma_f32_16x16x32_bf16 v[76:79], v[248:251], a[72:75], v[76:79]
    s_waitcnt vmcnt(0)
    v_mfma_f32_16x16x32_bf16 v[72:75], v[250:253], a[76:79], v[72:75]
    v_mfma_f32_16x16x32_bf16 v[76:79], v[248:251], a[76:79], v[76:79]
    s_nop 6
    v_pk_fma_f32 v[20:21], v[104:105], v[72:73], v[20:21]
    v_pk_fma_f32 v[22:23], v[106:107], v[74:75], v[22:23]
    v_pk_fma_f32 v[24:25], v[108:109], v[76:77], v[24:25]
    v_pk_fma_f32 v[26:27], v[110:111], v[78:79], v[26:27]
    v_cvt_pk_bf16_f32 v40, v20, v21
    v_cvt_pk_bf16_f32 v41, v22, v23
    v_cvt_pk_bf16_f32 v42, v24, v25
    v_cvt_pk_bf16_f32 v43, v26, v27
    v_lshlrev_b32 v20, 16, v40
    v_and_b32 v21, 0xffff0000, v40
    v_lshlrev_b32 v22, 16, v41
    v_and_b32 v23, 0xffff0000, v41
    v_lshlrev_b32 v24, 16, v42
    v_and_b32 v25, 0xffff0000, v42
    v_lshlrev_b32 v26, 16, v43
    v_and_b32 v27, 0xffff0000, v43
    v_pk_add_f32 v[224:225], v[20:21], v[88:89] op_sel_hi:[1,0] neg_lo:[0,1] neg_hi:[0,1]
    v_pk_add_f32 v[226:227], v[22:23], v[88:89] op_sel_hi:[1,0] neg_lo:[0,1] neg_hi:[0,1]
    v_pk_add_f32 v[228:229], v[24:25], v[88:89] op_sel_hi:[1,0] neg_lo:[0,1] neg_hi:[0,1]
    v_pk_add_f32 v[230:231], v[26:27], v[88:89] op_sel_hi:[1,0] neg_lo:[0,1] neg_hi:[0,1]
    v_pk_add_f32 v[48:49], v[48:49], v[224:225]
    v_pk_fma_f32 v[50:51], v[224:225], v[224:225], v[50:51]
    v_pk_fma_f32 v[52:53], v[224:225], v[176:177], v[52:53]
    v_pk_add_f32 v[48:49], v[48:49], v[226:227]
    v_pk_fma_f32 v[50:51], v[226:227], v[226:227], v[50:51]
    v_pk_fma_f32 v[52:53], v[226:227], v[178:179], v[52:53]
    v_pk_add_f32 v[48:49], v[48:49], v[228:229]
    v_pk_fma_f32 v[50:51], v[228:229], v[228:229], v[50:51]
    v_pk_fma_f32 v[52:53], v[228:229], v[180:181], v[52:53]
    v_pk_add_f32 v[48:49], v[48:49], v[230:231]
    v_pk_fma_f32 v[50:51], v[230:231], v[230:231], v[50:51]
    v_pk_fma_f32 v[52:53], v[230:231], v[182:183], v[52:53]
    v_add_f32 v48, v48, v49
    v_add_f32 v50, v50, v51
    v_add_f32 v52, v52, v53
    v_add_f32_dpp v48, v48, v48 row_ror:8 row_mask:0xf bank_mask:0xf
    v_add_f32_dpp v50, v50, v50 row_ror:8 row_mask:0xf bank_mask:0xf
    v_add_f32_dpp v52, v52, v52 row_ror:8 row_mask:0xf bank_mask:0xf
    v_add_f32_dpp v48, v48, v48 row_ror:4 row_mask:0xf bank_mask:0xf
    v_add_f32_dpp v50, v50, v50 row_ror:4 row_mask:0xf bank_mask:0xf
    v_add_f32_dpp v52, v52, v52 row_ror:4 row_mask:0xf bank_mask:0xf
    v_add_f32_dpp v48, v48, v48 row_ror:2 row_mask:0xf bank_mask:0xf
    v_add_f32_dpp v50, v50, v50 row_ror:2 row_mask:0xf bank_mask:0xf
    v_add_f32_dpp v52, v52, v52 row_ror:2 row_mask:0xf bank_mask:0xf
    v_add_f32_dpp v48, v48, v48 row_ror:1 row_mask:0xf bank_mask:0xf
    v_add_f32_dpp v50, v50, v50 row_ror:1 row_mask:0xf bank_mask:0xf
    v_add_f32_dpp v52, v52, v52 row_ror:1 row_mask:0xf bank_mask:0xf
    v_mov_b32 v49, v48
    v_mov_b32 v51, v50
    v_mov_b32 v53, v52
    v_permlane16_swap_b32 v48, v49
    v_permlane16_swap_b32 v50, v51
    v_permlane16_swap_b32 v52, v53
    v_add_f32 v48, v48, v49
    v_add_f32 v50, v50, v51
    v_add_f32 v52, v52, v53
    v_mul_f32 v48, 0x3ae38e39, v48
    v_mul_f32 v50, 0x3ae38e39, v50
    v_fma_f32 v50, -v48, v48, v50
    v_add_f32 v48, v48, v88
    v_max_f32 v50, 0, v50
    v_cvt_pk_bf16_f32 v48, v48, v50
    v_and_b32 v50, 0xffff0000, v48
    v_lshlrev_b32 v48, 16, v48
    v_add_f32 v50, 0x3727c5ac, v50
    v_sub_f32 v48, v88, v48
    v_cvt_pk_bf16_f32 v50, v50, v50
    v_and_b32 v50, 0xffff0000, v50
    v_sqrt_f32 v50, v50
    v_fmac_f32 v52, v48, v90
    v_cvt_pk_bf16_f32 v50, v50, v50
    v_and_b32 v50, 0xffff0000, v50
    v_rcp_f32 v50, v50
    s_mov_b32 exec_lo, 1
    s_mov_b32 exec_hi, 1
    v_fma_f32 v52, v52, v50, v91
    v_ashrrev_i32 v62, 31, v52
    v_or_b32 v62, 0x80000000, v62
    v_xor_b32 v52, v62, v52
    v_min_u32 v52, 0xfffff000, v52
    v_bfi_b32 v52, s48, v93, v52
    ds_write_b32 v92, v52 offset:36864
    s_mov_b64 exec, -1
    v_mul_f32 v48, v48, v50
    s_waitcnt lgkmcnt(0)
    s_barrier
    v_mov_b32 v109, 36864
    ds_read_b128 v[96:99], v109
    ds_read_b128 v[100:103], v109 offset:16
    s_lshl_b32 s45, s2, 7
    s_add_u32 s45, s45, 9306112
    s_cmp_eq_u32 s3, 0
    s_cselect_b32 s45, s45, 2147483648
    s_waitcnt lgkmcnt(1)
    v_max_u32 v104, v96, v97
    v_min_u32 v105, v96, v97
    v_med3_u32 v105, v104, v105, v98
    v_max_u32 v104, v104, v98
    v_med3_u32 v105, v104, v105, v99
    v_max_u32 v104, v104, v99
    s_waitcnt lgkmcnt(0)
    v_med3_u32 v105, v104, v105, v100
    v_max_u32 v104, v104, v100
    v_med3_u32 v105, v104, v105, v101
    v_max_u32 v104, v104, v101
    v_med3_u32 v105, v104, v105, v102
    v_max_u32 v104, v104, v102
    v_med3_u32 v105, v104, v105, v103
    v_max_u32 v104, v104, v103
    buffer_store_dwordx2 v[104:105], v8, s[24:27], s45 offen sc1
    v_pk_fma_f32 v[216:217], v[216:217], v[50:51], v[48:49] op_sel_hi:[1,0,0]
    v_pk_fma_f32 v[218:219], v[218:219], v[50:51], v[48:49] op_sel_hi:[1,0,0]
    v_pk_fma_f32 v[220:221], v[220:221], v[50:51], v[48:49] op_sel_hi:[1,0,0]
    v_pk_fma_f32 v[222:223], v[222:223], v[50:51], v[48:49] op_sel_hi:[1,0,0]
    v_pk_fma_f32 v[224:225], v[224:225], v[50:51], v[48:49] op_sel_hi:[1,0,0]
    v_pk_fma_f32 v[226:227], v[226:227], v[50:51], v[48:49] op_sel_hi:[1,0,0]
    v_pk_fma_f32 v[228:229], v[228:229], v[50:51], v[48:49] op_sel_hi:[1,0,0]
    v_pk_fma_f32 v[230:231], v[230:231], v[50:51], v[48:49] op_sel_hi:[1,0,0]
    v_pk_fma_f32 v[232:233], v[232:233], v[50:51], v[48:49] op_sel_hi:[1,0,0]
    v_pk_fma_f32 v[234:235], v[234:235], v[50:51], v[48:49] op_sel_hi:[1,0,0]
    v_pk_fma_f32 v[236:237], v[236:237], v[50:51], v[48:49] op_sel_hi:[1,0,0]
    v_pk_fma_f32 v[238:239], v[238:239], v[50:51], v[48:49] op_sel_hi:[1,0,0]
    v_pk_fma_f32 v[216:217], v[216:217], v[120:121], v[144:145]
    v_pk_fma_f32 v[218:219], v[218:219], v[122:123], v[146:147]
    v_pk_fma_f32 v[220:221], v[220:221], v[124:125], v[148:149]
    v_pk_fma_f32 v[222:223], v[222:223], v[126:127], v[150:151]
    v_pk_fma_f32 v[224:225], v[224:225], v[128:129], v[152:153]
    v_pk_fma_f32 v[226:227], v[226:227], v[130:131], v[154:155]
    v_pk_fma_f32 v[228:229], v[228:229], v[132:133], v[156:157]
    v_pk_fma_f32 v[230:231], v[230:231], v[134:135], v[158:159]
    v_pk_fma_f32 v[232:233], v[232:233], v[136:137], v[160:161]
    v_pk_fma_f32 v[234:235], v[234:235], v[138:139], v[162:163]
    v_pk_fma_f32 v[236:237], v[236:237], v[140:141], v[164:165]
    v_pk_fma_f32 v[238:239], v[238:239], v[142:143], v[166:167]
    v_cvt_pk_bf16_f32 v64, v216, v217
    v_cvt_pk_bf16_f32 v65, v218, v219
    v_cvt_pk_bf16_f32 v66, v220, v221
    v_cvt_pk_bf16_f32 v67, v222, v223
    v_cvt_pk_bf16_f32 v68, v224, v225
    v_cvt_pk_bf16_f32 v69, v226, v227
    v_cvt_pk_bf16_f32 v70, v228, v229
    v_cvt_pk_bf16_f32 v71, v230, v231
    v_cvt_pk_bf16_f32 v72, v232, v233
    v_cvt_pk_bf16_f32 v73, v234, v235
    v_cvt_pk_bf16_f32 v74, v236, v237
    v_cvt_pk_bf16_f32 v75, v238, v239
    v_and_b32 v106, 0x7ff, v104
    v_and_b32 v107, 0x7ff, v105
    v_cmp_eq_u32 vcc, v106, v93
    v_cmp_eq_u32 s[36:37], v107, v93
    v_mov_b32 v106, 2147483648
    s_or_b64 vcc, vcc, s[36:37]
    s_mov_b32 s45, 2621440
    s_nop 0
    v_cndmask_b32 v6, v106, v6, vcc
    v_cndmask_b32 v60, v106, v60, vcc
    buffer_store_dwordx4 v[64:67], v6, s[24:27], s45 offen offset:0 sc1
    buffer_store_dwordx4 v[68:71], v6, s[24:27], s45 offen offset:512 sc1
    buffer_store_dwordx4 v[72:75], v60, s[24:27], s45 offen offset:1024 sc1
    s_cmp_ge_u32 s41, 18
    s_cbranch_scc1 Ltail_idle
    s_mov_b32 s36, 2622592
    buffer_store_dwordx4 v[36:39], v6, s[24:27], s36 offen offset:0 sc1
    buffer_store_dwordx4 v[40:43], v6, s[24:27], s36 offen offset:512 sc1
    buffer_store_dwordx4 v[44:47], v60, s[24:27], s36 offen offset:1024 sc1
    v_lshlrev_b32 v216, 16, v64
    v_and_b32 v217, 0xffff0000, v64
    v_lshlrev_b32 v218, 16, v65
    v_and_b32 v219, 0xffff0000, v65
    v_lshlrev_b32 v220, 16, v66
    v_and_b32 v221, 0xffff0000, v66
    v_lshlrev_b32 v222, 16, v67
    v_and_b32 v223, 0xffff0000, v67
    v_lshlrev_b32 v224, 16, v68
    v_and_b32 v225, 0xffff0000, v68
    v_lshlrev_b32 v226, 16, v69
    v_and_b32 v227, 0xffff0000, v69
    v_lshlrev_b32 v228, 16, v70
    v_and_b32 v229, 0xffff0000, v70
    v_lshlrev_b32 v230, 16, v71
    v_and_b32 v231, 0xffff0000, v71
    v_lshlrev_b32 v232, 16, v72
    v_and_b32 v233, 0xffff0000, v72
    v_lshlrev_b32 v234, 16, v73
    v_and_b32 v235, 0xffff0000, v73
    v_lshlrev_b32 v236, 16, v74
    v_and_b32 v237, 0xffff0000, v74
    v_lshlrev_b32 v238, 16, v75
    v_and_b32 v239, 0xffff0000, v75
    v_pk_mul_f32 v[192:193], v[192:193], v[216:217]
    v_pk_mul_f32 v[194:195], v[194:195], v[218:219]
    v_pk_mul_f32 v[196:197], v[196:197], v[220:221]
    v_pk_mul_f32 v[198:199], v[198:199], v[222:223]
    v_pk_mul_f32 v[200:201], v[200:201], v[224:225]
    v_pk_mul_f32 v[202:203], v[202:203], v[226:227]
    v_pk_mul_f32 v[204:205], v[204:205], v[228:229]
    v_pk_mul_f32 v[206:207], v[206:207], v[230:231]
    v_pk_mul_f32 v[208:209], v[208:209], v[232:233]
    v_pk_mul_f32 v[210:211], v[210:211], v[234:235]
    v_pk_mul_f32 v[212:213], v[212:213], v[236:237]
    v_pk_mul_f32 v[214:215], v[214:215], v[238:239]
    v_cvt_pk_bf16_f32 v144, v192, v193
    v_cvt_pk_bf16_f32 v145, v194, v195
    v_cvt_pk_bf16_f32 v146, v196, v197
    v_cvt_pk_bf16_f32 v147, v198, v199
    v_cvt_pk_bf16_f32 v148, v200, v201
    v_cvt_pk_bf16_f32 v149, v202, v203
    v_cvt_pk_bf16_f32 v150, v204, v205
    v_cvt_pk_bf16_f32 v151, v206, v207
    v_cvt_pk_bf16_f32 v152, v208, v209
    v_cvt_pk_bf16_f32 v153, v210, v211
    v_cvt_pk_bf16_f32 v154, v212, v213
    v_cvt_pk_bf16_f32 v155, v214, v215
    v_lshlrev_b32 v192, 16, v144
    v_and_b32 v193, 0xffff0000, v144
    v_lshlrev_b32 v194, 16, v145
    v_and_b32 v195, 0xffff0000, v145
    v_lshlrev_b32 v196, 16, v146
    v_and_b32 v197, 0xffff0000, v146
    v_lshlrev_b32 v198, 16, v147
    v_and_b32 v199, 0xffff0000, v147
    v_lshlrev_b32 v200, 16, v148
    v_and_b32 v201, 0xffff0000, v148
    v_lshlrev_b32 v202, 16, v149
    v_and_b32 v203, 0xffff0000, v149
    v_lshlrev_b32 v204, 16, v150
    v_and_b32 v205, 0xffff0000, v150
    v_lshlrev_b32 v206, 16, v151
    v_and_b32 v207, 0xffff0000, v151
    v_lshlrev_b32 v208, 16, v152
    v_and_b32 v209, 0xffff0000, v152
    v_lshlrev_b32 v210, 16, v153
    v_and_b32 v211, 0xffff0000, v153
    v_lshlrev_b32 v212, 16, v154
    v_and_b32 v213, 0xffff0000, v154
    v_lshlrev_b32 v214, 16, v155
    v_and_b32 v215, 0xffff0000, v155
    v_pk_add_f32 v[192:193], v[192:193], v[12:13]
    v_pk_add_f32 v[194:195], v[194:195], v[14:15]
    v_pk_add_f32 v[196:197], v[196:197], v[16:17]
    v_pk_add_f32 v[198:199], v[198:199], v[18:19]
    v_pk_add_f32 v[200:201], v[200:201], v[20:21]
    v_pk_add_f32 v[202:203], v[202:203], v[22:23]
    v_pk_add_f32 v[204:205], v[204:205], v[24:25]
    v_pk_add_f32 v[206:207], v[206:207], v[26:27]
    v_pk_add_f32 v[208:209], v[208:209], v[28:29]
    v_pk_add_f32 v[210:211], v[210:211], v[30:31]
    v_pk_add_f32 v[212:213], v[212:213], v[32:33]
    v_pk_add_f32 v[214:215], v[214:215], v[34:35]
    v_cvt_pk_bf16_f32 v156, v192, v193
    v_cvt_pk_bf16_f32 v157, v194, v195
    v_cvt_pk_bf16_f32 v158, v196, v197
    v_cvt_pk_bf16_f32 v159, v198, v199
    v_cvt_pk_bf16_f32 v160, v200, v201
    v_cvt_pk_bf16_f32 v161, v202, v203
    v_cvt_pk_bf16_f32 v162, v204, v205
    v_cvt_pk_bf16_f32 v163, v206, v207
    v_cvt_pk_bf16_f32 v164, v208, v209
    v_cvt_pk_bf16_f32 v165, v210, v211
    v_cvt_pk_bf16_f32 v166, v212, v213
    v_cvt_pk_bf16_f32 v167, v214, v215
    v_and_b32 v30, 2, v1
    v_cmp_ne_u32 vcc, 0, v30
    v_mul_u32_u24 v30, 1152, v7
    v_add_u32 v4, v30, v5
    v_add_u32 v58, v30, v59
    v_mov_b32_dpp v192, v158 quad_perm:[0,2,0,2] row_mask:0xf bank_mask:0xf
    v_mov_b32_dpp v193, v159 quad_perm:[0,2,0,2] row_mask:0xf bank_mask:0xf
    v_mov_b32_dpp v194, v158 quad_perm:[1,3,1,3] row_mask:0xf bank_mask:0xf
    v_mov_b32_dpp v195, v159 quad_perm:[1,3,1,3] row_mask:0xf bank_mask:0xf
    v_mov_b32_dpp v196, v162 quad_perm:[0,2,0,2] row_mask:0xf bank_mask:0xf
    v_mov_b32_dpp v197, v163 quad_perm:[0,2,0,2] row_mask:0xf bank_mask:0xf
    v_mov_b32_dpp v198, v162 quad_perm:[1,3,1,3] row_mask:0xf bank_mask:0xf
    v_mov_b32_dpp v199, v163 quad_perm:[1,3,1,3] row_mask:0xf bank_mask:0xf
    v_mov_b32_dpp v200, v166 quad_perm:[0,2,0,2] row_mask:0xf bank_mask:0xf
    v_mov_b32_dpp v201, v167 quad_perm:[0,2,0,2] row_mask:0xf bank_mask:0xf
    v_mov_b32_dpp v202, v166 quad_perm:[1,3,1,3] row_mask:0xf bank_mask:0xf
    v_mov_b32_dpp v203, v167 quad_perm:[1,3,1,3] row_mask:0xf bank_mask:0xf
    v_cndmask_b32_dpp v144, v156, v192, vcc quad_perm:[0,2,0,2] row_mask:0xf bank_mask:0xf
    v_cndmask_b32_dpp v145, v157, v193, vcc quad_perm:[0,2,0,2] row_mask:0xf bank_mask:0xf
    v_cndmask_b32_dpp v146, v156, v194, vcc quad_perm:[1,3,1,3] row_mask:0xf bank_mask:0xf
    v_cndmask_b32_dpp v147, v157, v195, vcc quad_perm:[1,3,1,3] row_mask:0xf bank_mask:0xf
    v_cndmask_b32_dpp v148, v160, v196, vcc quad_perm:[0,2,0,2] row_mask:0xf bank_mask:0xf
    v_cndmask_b32_dpp v149, v161, v197, vcc quad_perm:[0,2,0,2] row_mask:0xf bank_mask:0xf
    v_cndmask_b32_dpp v150, v160, v198, vcc quad_perm:[1,3,1,3] row_mask:0xf bank_mask:0xf
    v_cndmask_b32_dpp v151, v161, v199, vcc quad_perm:[1,3,1,3] row_mask:0xf bank_mask:0xf
    v_cndmask_b32_dpp v152, v164, v200, vcc quad_perm:[0,2,0,2] row_mask:0xf bank_mask:0xf
    v_cndmask_b32_dpp v153, v165, v201, vcc quad_perm:[0,2,0,2] row_mask:0xf bank_mask:0xf
    v_cndmask_b32_dpp v154, v164, v202, vcc quad_perm:[1,3,1,3] row_mask:0xf bank_mask:0xf
    v_cndmask_b32_dpp v155, v165, v203, vcc quad_perm:[1,3,1,3] row_mask:0xf bank_mask:0xf
    v_lshlrev_b32 v13, 4, v1
    v_add_u32 v13, 32768, v13
    s_lshl_b32 s44, s3, 10
    v_add_u32 v14, s44, v13
    v_and_b32 v13, 0xffffff1f, v13
    v_bfe_u32 v15, v1, 2, 2
    v_cmp_eq_u32 s[52:53], 0, v15
    v_cmp_eq_u32 s[54:55], 1, v15
    v_cmp_eq_u32 s[56:57], 2, v15
    v_cmp_eq_u32 s[58:59], 3, v15
    s_mul_i32 s43, s42, 18
    s_add_u32 s43, s43, s41
    s_lshl_b32 s43, s43, 9
    s_mul_i32 s44, s3, 73728
    s_add_u32 s43, s43, s44
    v_lshlrev_b32 v15, 3, v1
    s_cmp_lt_u32 s3, 2
    s_cselect_b32 s36, 0xbfb8aa3b, 0
    s_cselect_b32 s37, 1.0, 0
    v_mov_b32 v40, s36
    v_mov_b32 v41, s37
    v_and_b32 v10, 1, v1
    v_and_b32 v9, 48, v1
    s_mul_i32 s38, s3, 3072
    s_add_u32 s38, s38, 49152
    v_lshl_add_u32 v11, v10, 9, v9
    v_add_u32 v11, s38, v11
    v_lshrrev_b32 v10, 5, v1
    v_and_b32 v9, 31, v1
    v_lshlrev_b32 v9, 4, v9
    v_lshlrev_b32 v108, 7, v0
    s_mov_b32 s45, 9306112
    s_lshl_b32 s36, s3, 3
    v_mov_b32 v109, s36
    s_mov_b32 s48, 262144
Ltail_pollk:
    buffer_load_dwordx2 v[104:105], v108, s[24:27], s45 offen sc1
    s_sub_u32 s48, s48, 1
    s_cbranch_scc1 Ltail_gotk
    s_waitcnt vmcnt(0)
    v_max_u32 v106, v104, v105
    v_cmp_eq_u32 vcc, -1, v106
    s_cbranch_vccnz Ltail_pollk
Ltail_gotk:
    s_waitcnt vmcnt(0)
    v_mov_b32_dpp v106, v104 row_ror:1 row_mask:0xf bank_mask:0xf
    v_mov_b32_dpp v107, v105 row_ror:1 row_mask:0xf bank_mask:0xf
    v_min_u32 v110, v104, v106
    v_max_u32 v104, v104, v106
    v_max3_u32 v105, v110, v105, v107
    s_nop 0
    v_mov_b32_dpp v106, v104 row_ror:2 row_mask:0xf bank_mask:0xf
    v_mov_b32_dpp v107, v105 row_ror:2 row_mask:0xf bank_mask:0xf
    v_min_u32 v110, v104, v106
    v_max_u32 v104, v104, v106
    v_max3_u32 v105, v110, v105, v107
    s_nop 0
    v_mov_b32_dpp v106, v104 row_ror:4 row_mask:0xf bank_mask:0xf
    v_mov_b32_dpp v107, v105 row_ror:4 row_mask:0xf bank_mask:0xf
    v_min_u32 v110, v104, v106
    v_max_u32 v104, v104, v106
    v_max3_u32 v105, v110, v105, v107
    s_nop 0
    v_mov_b32_dpp v106, v104 row_ror:8 row_mask:0xf bank_mask:0xf
    v_mov_b32_dpp v107, v105 row_ror:8 row_mask:0xf bank_mask:0xf
    v_min_u32 v110, v104, v106
    v_max_u32 v104, v104, v106
    v_max3_u32 v105, v110, v105, v107
    v_mov_b32 v106, v104
    v_mov_b32 v107, v105
    s_nop 0
    v_permlane16_swap_b32 v104, v106
    v_permlane16_swap_b32 v105, v107
    v_min_u32 v110, v104, v106
    v_max_u32 v104, v104, v106
    v_max3_u32 v105, v110, v105, v107
    v_mov_b32 v106, v104
    v_mov_b32 v107, v105
    s_nop 0
    v_permlane32_swap_b32 v104, v106
    v_permlane32_swap_b32 v105, v107
    v_min_u32 v110, v104, v106
    v_max_u32 v104, v104, v106
    v_max3_u32 v105, v110, v105, v107
    ds_write_b64 v109, v[104:105] offset:36928
    v_mov_b32 v109, 36928
    s_waitcnt lgkmcnt(0)
    s_barrier
    ds_read_b128 v[96:99], v109
    ds_read_b128 v[100:103], v109 offset:16
    s_waitcnt lgkmcnt(1)
    v_max_u32 v104, v96, v97
    v_min_u32 v105, v96, v97
    v_med3_u32 v105, v104, v105, v98
    v_max_u32 v104, v104, v98
    v_med3_u32 v105, v104, v105, v99
    v_max_u32 v104, v104, v99
    s_waitcnt lgkmcnt(0)
    v_med3_u32 v105, v104, v105, v100
    v_max_u32 v104, v104, v100
    v_med3_u32 v105, v104, v105, v101
    v_max_u32 v104, v104, v101
    v_med3_u32 v105, v104, v105, v102
    v_max_u32 v104, v104, v102
    v_med3_u32 v105, v104, v105, v103
    v_max_u32 v104, v104, v103
    s_nop 0
    v_readfirstlane_b32 s92, v104
    v_readfirstlane_b32 s93, v105
    s_andn2_b32 s46, 0x7ff, s92
    s_andn2_b32 s47, 0x7ff, s93
    s_mul_i32 s44, s46, 2304
    s_mul_i32 s45, s47, 2304
    s_sub_u32 s45, s45, s44
    v_mad_i32_i24 v10, v10, s45, v9
    s_add_u32 s45, s44, 2621440
    v_add_u32 v10, s45, v10
    s_mov_b32 s48, 16384
Ltail_pollh:
    s_mov_b32 exec_lo, 0xffffff
    s_mov_b32 exec_hi, 0xffffff
    s_add_u32 m0, s38, 0
    s_nop 0
    buffer_load_dwordx4 v10, s[24:27], 0 offen offset:0 sc1 lds
    s_add_u32 m0, s38, 640
    s_nop 0
    buffer_load_dwordx4 v10, s[24:27], 0 offen offset:384 sc1 lds
    s_add_u32 m0, s38, 1280
    s_nop 0
    buffer_load_dwordx4 v10, s[24:27], 0 offen offset:768 sc1 lds
    s_mov_b64 exec, -1
    s_waitcnt vmcnt(0)
    ds_read_b128 a[0:3], v11 offset:0
    ds_read_b128 a[4:7], v11 offset:64
    ds_read_b128 a[8:11], v11 offset:128
    ds_read_b128 a[12:15], v11 offset:192
    ds_read_b128 a[16:19], v11 offset:256
    ds_read_b128 a[20:23], v11 offset:320
    ds_read_b128 a[24:27], v11 offset:1024
    ds_read_b128 a[28:31], v11 offset:1088
    ds_read_b128 a[32:35], v11 offset:1152
    ds_read_b128 a[36:39], v11 offset:1216
    ds_read_b128 a[40:43], v11 offset:1280
    ds_read_b128 a[44:47], v11 offset:1344
    ds_read_b128 a[48:51], v11 offset:2048
    ds_read_b128 a[52:55], v11 offset:2112
    ds_read_b128 a[56:59], v11 offset:2176
    ds_read_b128 a[60:63], v11 offset:2240
    ds_read_b128 a[64:67], v11 offset:2304
    ds_read_b128 a[68:71], v11 offset:2368
    s_waitcnt lgkmcnt(15)
    v_mfma_f32_16x16x32_bf16 v[16:19], a[96:99], a[0:3], 0
    v_mfma_f32_16x16x32_bf16 v[20:23], a[100:103], a[4:7], 0
    v_mfma_f32_16x16x32_bf16 v[16:19], a[104:107], a[8:11], v[16:19]
    s_waitcnt lgkmcnt(14)
    v_mfma_f32_16x16x32_bf16 v[20:23], a[108:111], a[12:15], v[20:23]
    s_waitcnt lgkmcnt(13)
    v_mfma_f32_16x16x32_bf16 v[16:19], a[112:115], a[16:19], v[16:19]
    s_waitcnt lgkmcnt(12)
    v_mfma_f32_16x16x32_bf16 v[20:23], a[116:119], a[20:23], v[20:23]
    s_waitcnt lgkmcnt(11)
    v_mfma_f32_16x16x32_bf16 v[16:19], a[120:123], a[24:27], v[16:19]
    s_waitcnt lgkmcnt(10)
    v_mfma_f32_16x16x32_bf16 v[20:23], a[124:127], a[28:31], v[20:23]
    s_waitcnt lgkmcnt(9)
    v_mfma_f32_16x16x32_bf16 v[16:19], a[128:131], a[32:35], v[16:19]
    s_waitcnt lgkmcnt(8)
    v_mfma_f32_16x16x32_bf16 v[20:23], a[132:135], a[36:39], v[20:23]
    s_waitcnt lgkmcnt(7)
    v_mfma_f32_16x16x32_bf16 v[16:19], a[136:139], a[40:43], v[16:19]
    s_waitcnt lgkmcnt(6)
    v_mfma_f32_16x16x32_bf16 v[20:23], a[140:143], a[44:47], v[20:23]
    s_waitcnt lgkmcnt(5)
    v_mfma_f32_16x16x32_bf16 v[16:19], a[144:147], a[48:51], v[16:19]
    s_waitcnt lgkmcnt(4)
    v_mfma_f32_16x16x32_bf16 v[20:23], a[148:151], a[52:55], v[20:23]
    s_waitcnt lgkmcnt(3)
    v_mfma_f32_16x16x32_bf16 v[16:19], a[152:155], a[56:59], v[16:19]
    s_waitcnt lgkmcnt(2)
    v_mfma_f32_16x16x32_bf16 v[20:23], a[156:159], a[60:63], v[20:23]
    s_waitcnt lgkmcnt(1)
    v_mfma_f32_16x16x32_bf16 v[16:19], a[160:163], a[64:67], v[16:19]
    s_waitcnt lgkmcnt(0)
    v_mfma_f32_16x16x32_bf16 v[20:23], a[164:167], a[68:71], v[20:23]
    s_sub_u32 s48, s48, 1
    s_nop 6
    v_pk_add_f32 v[16:17], v[16:17], v[20:21]
    v_pk_add_f32 v[18:19], v[18:19], v[22:23]
    s_cbranch_scc1 Ltail_goth
    v_cmp_u_f32 vcc, v16, v16
    s_and_b32 s36, vcc_lo, 3
    s_cbranch_scc1 Ltail_pollh
Ltail_goth:
    v_cvt_pk_bf16_f32 v32, v16, v17
    v_cvt_pk_bf16_f32 v33, v18, v19
    v_lshlrev_b32 v16, 16, v32
    v_and_b32 v17, 0xffff0000, v32
    v_lshlrev_b32 v18, 16, v33
    v_and_b32 v19, 0xffff0000, v33
    v_pk_mul_f32 v[32:33], v[16:17], v[40:41] op_sel_hi:[1,0]
    v_pk_mul_f32 v[34:35], v[18:19], v[40:41] op_sel_hi:[1,0]
    v_exp_f32 v32, v32
    v_exp_f32 v33, v33
    v_exp_f32 v34, v34
    v_exp_f32 v35, v35
    v_fma_f32 v32, v32, v41, 1.0
    v_fma_f32 v33, v33, v41, 1.0
    v_fma_f32 v34, v34, v41, 1.0
    v_fma_f32 v35, v35, v41, 1.0
    v_rcp_f32 v32, v32
    v_rcp_f32 v33, v33
    v_rcp_f32 v34, v34
    v_rcp_f32 v35, v35
    v_pk_mul_f32 v[16:17], v[16:17], v[32:33]
    v_pk_mul_f32 v[18:19], v[18:19], v[34:35]
    v_cvt_pk_bf16_f32 v32, v16, v17
    v_cvt_pk_bf16_f32 v33, v18, v19
    v_lshlrev_b32 v16, 16, v32
    v_and_b32 v17, 0xffff0000, v32
    v_lshlrev_b32 v18, 16, v33
    v_and_b32 v19, 0xffff0000, v33
    ds_write_b128 v14, v[16:19]
    s_waitcnt lgkmcnt(0)
    s_barrier
    ds_read_b128 v[16:19], v13 offset:0
    ds_read_b128 v[24:27], v13 offset:2048
    ds_read_b128 v[20:23], v13 offset:1024
    ds_read_b128 v[28:31], v13 offset:3072
    s_waitcnt lgkmcnt(2)
    v_pk_mul_f32 v[16:17], v[16:17], v[24:25]
    v_pk_mul_f32 v[18:19], v[18:19], v[26:27]
    v_cvt_pk_bf16_f32 v32, v16, v17
    v_cvt_pk_bf16_f32 v33, v18, v19
    s_waitcnt lgkmcnt(0)
    v_pk_mul_f32 v[20:21], v[20:21], v[28:29]
    v_pk_mul_f32 v[22:23], v[22:23], v[30:31]
    v_cvt_pk_bf16_f32 v34, v20, v21
    v_cvt_pk_bf16_f32 v35, v22, v23
    v_cndmask_b32 v64, 0, v32, s[52:53]
    v_cndmask_b32 v65, 0, v33, s[52:53]
    v_cndmask_b32 v66, 0, v34, s[52:53]
    v_cndmask_b32 v67, 0, v35, s[52:53]
    s_nop 1
    v_mfma_f32_16x16x32_bf16 v[16:19], v[64:67], a[168:171], 0
    v_cndmask_b32 v68, 0, v32, s[54:55]
    v_cndmask_b32 v69, 0, v33, s[54:55]
    v_mfma_f32_16x16x32_bf16 v[20:23], v[64:67], a[184:187], 0
Ltour1_1:
    s_cbranch_execz Lmain1
    v_cndmask_b32 v70, 0, v34, s[54:55]
    v_cndmask_b32 v71, 0, v35, s[54:55]
    v_mfma_f32_16x16x32_bf16 v[24:27], v[64:67], a[200:203], 0
    s_nop 0
    v_mfma_f32_16x16x32_bf16 v[16:19], v[68:71], a[172:175], v[16:19]
    v_cndmask_b32 v72, 0, v32, s[56:57]
    v_cndmask_b32 v73, 0, v33, s[56:57]
    v_mfma_f32_16x16x32_bf16 v[20:23], v[68:71], a[188:191], v[20:23]
    v_cndmask_b32 v74, 0, v34, s[56:57]
    v_cndmask_b32 v75, 0, v35, s[56:57]
    v_mfma_f32_16x16x32_bf16 v[24:27], v[68:71], a[204:207], v[24:27]
    s_nop 0
    v_mfma_f32_16x16x32_bf16 v[16:19], v[72:75], a[176:179], v[16:19]
    v_cndmask_b32 v76, 0, v32, s[58:59]
    v_cndmask_b32 v77, 0, v33, s[58:59]
    v_mfma_f32_16x16x32_bf16 v[20:23], v[72:75], a[192:195], v[20:23]
    v_cndmask_b32 v78, 0, v34, s[58:59]
    v_cndmask_b32 v79, 0, v35, s[58:59]
    v_mfma_f32_16x16x32_bf16 v[24:27], v[72:75], a[208:211], v[24:27]
    s_nop 0
    v_mfma_f32_16x16x32_bf16 v[16:19], v[76:79], a[180:183], v[16:19]
    v_mfma_f32_16x16x32_bf16 v[20:23], v[76:79], a[196:199], v[20:23]
    v_mfma_f32_16x16x32_bf16 v[24:27], v[76:79], a[212:215], v[24:27]
    s_nop 5
    v_min_u32 v16, -2, v16
    v_min_u32 v17, -2, v17
    buffer_store_dwordx2 v[16:17], v15, s[8:11], s43 offen sc1
    s_add_u32 s43, s43, 294912
    v_min_u32 v20, -2, v20
    v_min_u32 v21, -2, v21
    buffer_store_dwordx2 v[20:21], v15, s[8:11], s43 offen sc1
    s_add_u32 s43, s43, 294912
    v_min_u32 v24, -2, v24
    v_min_u32 v25, -2, v25
    buffer_store_dwordx2 v[24:25], v15, s[8:11], s43 offen sc1
    s_or_b32 s36, s2, s3
    s_cselect_b32 s37, -4, 24576
    s_add_u32 s36, s94, 1
    v_mov_b32 v106, s36
    buffer_store_dword v106, v8, s[24:27], s37 offen sc1
    v_cmp_ne_u32 vcc, s46, v7
    v_cmp_ne_u32 s[36:37], s47, v7
    v_mov_b32 v31, 2147483648
    s_and_b64 vcc, vcc, s[36:37]
    s_nop 1
    v_cndmask_b32 v30, v31, v58, vcc
    v_cndmask_b32 v31, v31, v4, vcc
    buffer_store_dwordx4 v[144:147], v31, s[16:19], 0 offen offset:0 nt
    buffer_store_dwordx4 v[148:151], v31, s[16:19], 0 offen offset:512 nt
    buffer_store_dwordx4 v[152:155], v30, s[16:19], 0 offen offset:1024 nt
    s_cmp_lt_u32 s41, 9
    s_cselect_b32 s36, s3, 0
    s_cmp_lg_u32 s36, 3
    s_cbranch_scc1 Ltail_done
    s_mul_i32 s43, s42, 9
    s_add_u32 s43, s43, s41
    v_bfe_u32 v8, v1, 2, 1
    v_cmp_eq_u32 vcc, 1, v8
    v_mov_b32 v9, s46
    v_mov_b32 v10, s47
    v_and_b32 v11, 3, v1
    v_cndmask_b32 v9, v9, v10, vcc
    s_lshr_b32 s44, s43, 2
    s_lshl_b32 s44, s44, 6
    s_and_b32 s45, s43, 1
    s_lshl_b32 s45, s45, 5
    s_add_u32 s44, s44, s45
    s_and_b32 s45, s43, 2
    s_lshl_b32 s45, s45, 2
    s_add_u32 s44, s44, s45
    v_lshrrev_b32 v12, 1, v11
    v_lshl_add_u32 v12, v12, 4, s44
    v_and_b32 v13, 1, v11
    v_lshl_add_u32 v12, v13, 2, v12
    v_mul_u32_u24 v13, 1152, v9
    v_lshl_add_u32 v14, v13, 1, v12
    v_add_u32 v15, 2621440, v14
    s_mov_b32 s45, 22144
    buffer_load_dword v18, v12, s[24:27], s45 offen sc1
    v_mov_b32 v19, s92
    v_mov_b32 v10, s93
    v_cndmask_b32 v19, v19, v10, vcc
    v_and_b32 v19, 0xfffff800, v19
    v_or_b32 v19, 0x400, v19
    v_ashrrev_i32 v10, 31, v19
    v_not_b32 v10, v10
    v_or_b32 v10, 0x80000000, v10
    v_xor_b32 v19, v19, v10
    s_lshl_b32 s45, s43, 4
    v_lshl_add_u32 v13, v11, 2, v13
    v_add_u32 v13, s45, v13
    v_lshrrev_b32 v14, 2, v1
    v_lshlrev_b32 v14, 9, v14
    v_lshl_add_u32 v14, v11, 4, v14
    s_lshr_b32 s44, s43, 3
    s_mul_i32 s44, s44, 73728
    s_and_b32 s45, s43, 7
    s_lshl_b32 s45, s45, 6
    s_add_u32 s44, s44, s45
    v_cmp_eq_u32 s[38:39], 1, v8
    v_cvt_pk_bf16_f32 v19, v19, v19
    v_and_b32 v19, 0xffff0000, v19
    v_mul_f32 v19, 0xbfb8aa3b, v19
    v_exp_f32 v19, v19
    s_waitcnt vmcnt(0)
    v_lshlrev_b32 v24, 16, v18
    v_and_b32 v25, 0xffff0000, v18
    v_add_f32 v19, 1.0, v19
    v_rcp_f32 v19, v19
    s_mov_b32 s48, 262144
    v_cvt_pk_bf16_f32 v19, v19, v19
    v_and_b32 v19, 0xffff0000, v19
Ltail_polly:
    s_add_u32 s45, s44, 0
    buffer_load_dwordx4 v[64:67], v14, s[8:11], s45 offen sc1
    s_add_u32 s45, s44, 8192
    buffer_load_dwordx4 v[68:71], v14, s[8:11], s45 offen sc1
    s_add_u32 s45, s44, 16384
    buffer_load_dwordx4 v[72:75], v14, s[8:11], s45 offen sc1
    s_add_u32 s45, s44, 24576
    buffer_load_dwordx4 v[76:79], v14, s[8:11], s45 offen sc1
    s_add_u32 s45, s44, 32768
    buffer_load_dwordx4 v[80:83], v14, s[8:11], s45 offen sc1
    s_add_u32 s45, s44, 40960
    buffer_load_dwordx4 v[84:87], v14, s[8:11], s45 offen sc1
    s_add_u32 s45, s44, 49152
    buffer_load_dwordx4 v[88:91], v14, s[8:11], s45 offen sc1
    s_add_u32 s45, s44, 57344
    buffer_load_dwordx4 v[92:95], v14, s[8:11], s45 offen sc1
    s_add_u32 s45, s44, 65536
    buffer_load_dwordx4 v[96:99], v14, s[8:11], s45 offen sc1
    s_mov_b32 s45, 1152
    buffer_load_dword v16, v15, s[24:27], s45 offen sc1
    buffer_load_dword v17, v15, s[24:27], 0 offen sc1
    s_sub_u32 s48, s48, 1
    s_cbranch_scc1 Ltail_goty
    s_waitcnt vmcnt(10)
    v_max3_u32 v26, v64, v65, v66
    s_waitcnt vmcnt(9)
    v_max3_u32 v26, v26, v67, v68
    v_max3_u32 v26, v26, v69, v70
    s_waitcnt vmcnt(8)
    v_max3_u32 v26, v26, v71, v72
    v_max3_u32 v26, v26, v73, v74
    s_waitcnt vmcnt(7)
    v_max3_u32 v26, v26, v75, v76
    v_max3_u32 v26, v26, v77, v78
    s_waitcnt vmcnt(6)
    v_max3_u32 v26, v26, v79, v80
    v_max3_u32 v26, v26, v81, v82
    s_waitcnt vmcnt(5)
    v_max3_u32 v26, v26, v83, v84
    v_max3_u32 v26, v26, v85, v86
    s_waitcnt vmcnt(4)
    v_max3_u32 v26, v26, v87, v88
    v_max3_u32 v26, v26, v89, v90
    s_waitcnt vmcnt(3)
    v_max3_u32 v26, v26, v91, v92
    v_max3_u32 v26, v26, v93, v94
    s_waitcnt vmcnt(2)
    v_max3_u32 v26, v26, v95, v96
    v_max3_u32 v26, v26, v97, v98
    v_max_u32 v26, v26, v99
    s_waitcnt vmcnt(0)
    v_max3_u32 v26, v26, v16, v17
    v_cmp_eq_u32 vcc, -1, v26
    s_cbranch_vccnz Ltail_polly
Ltail_goty:
    s_waitcnt vmcnt(0) lgkmcnt(0)
    v_lshlrev_b32 v20, 16, v16
    v_and_b32 v21, 0xffff0000, v16
    v_lshlrev_b32 v22, 16, v17
    v_and_b32 v23, 0xffff0000, v17
    v_pk_add_f32 v[64:65], v[64:65], v[68:69]
    v_pk_add_f32 v[66:67], v[66:67], v[70:71]
    v_pk_add_f32 v[64:65], v[64:65], v[72:73]
    v_pk_add_f32 v[66:67], v[66:67], v[74:75]
    v_pk_add_f32 v[64:65], v[64:65], v[76:77]
    v_pk_add_f32 v[66:67], v[66:67], v[78:79]
    v_pk_add_f32 v[64:65], v[64:65], v[80:81]
    v_pk_add_f32 v[66:67], v[66:67], v[82:83]
    v_pk_add_f32 v[64:65], v[64:65], v[84:85]
    v_pk_add_f32 v[66:67], v[66:67], v[86:87]
    v_pk_add_f32 v[64:65], v[64:65], v[88:89]
    v_pk_add_f32 v[66:67], v[66:67], v[90:91]
    v_pk_add_f32 v[64:65], v[64:65], v[92:93]
    v_pk_add_f32 v[66:67], v[66:67], v[94:95]
    v_pk_add_f32 v[64:65], v[64:65], v[96:97]
    v_pk_add_f32 v[66:67], v[66:67], v[98:99]
    s_nop 0
    v_add_f32_dpp v64, v64, v64 row_ror:4 row_mask:0xf bank_mask:0xf
    v_add_f32_dpp v65, v65, v65 row_ror:4 row_mask:0xf bank_mask:0xf
    v_add_f32_dpp v66, v66, v66 row_ror:4 row_mask:0xf bank_mask:0xf
    v_add_f32_dpp v67, v67, v67 row_ror:4 row_mask:0xf bank_mask:0xf
    v_add_f32_dpp v64, v64, v64 row_ror:8 row_mask:0xf bank_mask:0xf
    v_add_f32_dpp v65, v65, v65 row_ror:8 row_mask:0xf bank_mask:0xf
    v_add_f32_dpp v66, v66, v66 row_ror:8 row_mask:0xf bank_mask:0xf
    v_add_f32_dpp v67, v67, v67 row_ror:8 row_mask:0xf bank_mask:0xf
    v_mov_b32 v68, v64
    v_mov_b32 v69, v65
    v_mov_b32 v70, v66
    v_mov_b32 v71, v67
    v_permlane16_swap_b32 v64, v68
    v_permlane16_swap_b32 v65, v69
    v_permlane16_swap_b32 v66, v70
    v_permlane16_swap_b32 v67, v71
    v_add_f32 v64, v64, v68
    v_add_f32 v65, v65, v69
    v_add_f32 v66, v66, v70
    v_add_f32 v67, v67, v71
    v_mov_b32 v68, v64
    v_mov_b32 v69, v65
    v_mov_b32 v70, v66
    v_mov_b32 v71, v67
    v_permlane32_swap_b32 v64, v68
    v_permlane32_swap_b32 v65, v69
    v_permlane32_swap_b32 v66, v70
    v_permlane32_swap_b32 v67, v71
    v_add_f32 v64, v64, v68
    v_add_f32 v65, v65, v69
    v_add_f32 v66, v66, v70
    v_add_f32 v67, v67, v71
    v_cndmask_b32 v26, v64, v65, s[38:39]
    v_cndmask_b32 v27, v66, v67, s[38:39]
    v_cvt_pk_bf16_f32 v28, v26, v27
    v_lshlrev_b32 v26, 16, v28
    v_and_b32 v27, 0xffff0000, v28
    v_mul_f32 v26, v26, v19
    v_mul_f32 v27, v27, v19
    v_cvt_pk_bf16_f32 v28, v26, v27
    v_lshlrev_b32 v26, 16, v28
    v_and_b32 v27, 0xffff0000, v28
    v_pk_add_f32 v[26:27], v[26:27], v[22:23]
    v_cvt_pk_bf16_f32 v28, v26, v27
    v_lshlrev_b32 v26, 16, v28
    v_and_b32 v27, 0xffff0000, v28
    v_pk_mul_f32 v[26:27], v[26:27], v[24:25]
    v_cvt_pk_bf16_f32 v28, v26, v27
    v_lshlrev_b32 v26, 16, v28
    v_and_b32 v27, 0xffff0000, v28
    v_pk_add_f32 v[26:27], v[26:27], v[20:21]
    v_cvt_pk_bf16_f32 v28, v26, v27
    s_mov_b64 exec, 0xff
    buffer_store_dword v28, v13, s[16:19], 0 offen nt
    s_branch Ltail_done
Ltail_idle:
Ltour1_2:
    s_cbranch_execz Lmain1
    v_lshlrev_b32 v216, 16, v64
    v_and_b32 v217, 0xffff0000, v64
    v_lshlrev_b32 v218, 16, v65
    v_and_b32 v219, 0xffff0000, v65
    v_lshlrev_b32 v220, 16, v66
    v_and_b32 v221, 0xffff0000, v66
    v_lshlrev_b32 v222, 16, v67
    v_and_b32 v223, 0xffff0000, v67
    v_lshlrev_b32 v224, 16, v68
    v_and_b32 v225, 0xffff0000, v68
    v_lshlrev_b32 v226, 16, v69
    v_and_b32 v227, 0xffff0000, v69
    v_lshlrev_b32 v228, 16, v70
    v_and_b32 v229, 0xffff0000, v70
    v_lshlrev_b32 v230, 16, v71
    v_and_b32 v231, 0xffff0000, v71
    v_lshlrev_b32 v232, 16, v72
    v_and_b32 v233, 0xffff0000, v72
    v_lshlrev_b32 v234, 16, v73
    v_and_b32 v235, 0xffff0000, v73
    v_lshlrev_b32 v236, 16, v74
    v_and_b32 v237, 0xffff0000, v74
    v_lshlrev_b32 v238, 16, v75
    v_and_b32 v239, 0xffff0000, v75
    v_pk_mul_f32 v[192:193], v[192:193], v[216:217]
    v_pk_mul_f32 v[194:195], v[194:195], v[218:219]
    v_pk_mul_f32 v[196:197], v[196:197], v[220:221]
    v_pk_mul_f32 v[198:199], v[198:199], v[222:223]
    v_pk_mul_f32 v[200:201], v[200:201], v[224:225]
    v_pk_mul_f32 v[202:203], v[202:203], v[226:227]
    v_pk_mul_f32 v[204:205], v[204:205], v[228:229]
    v_pk_mul_f32 v[206:207], v[206:207], v[230:231]
    v_pk_mul_f32 v[208:209], v[208:209], v[232:233]
    v_pk_mul_f32 v[210:211], v[210:211], v[234:235]
    v_pk_mul_f32 v[212:213], v[212:213], v[236:237]
    v_pk_mul_f32 v[214:215], v[214:215], v[238:239]
    v_cvt_pk_bf16_f32 v144, v192, v193
    v_cvt_pk_bf16_f32 v145, v194, v195
    v_cvt_pk_bf16_f32 v146, v196, v197
    v_cvt_pk_bf16_f32 v147, v198, v199
    v_cvt_pk_bf16_f32 v148, v200, v201
    v_cvt_pk_bf16_f32 v149, v202, v203
    v_cvt_pk_bf16_f32 v150, v204, v205
    v_cvt_pk_bf16_f32 v151, v206, v207
    v_cvt_pk_bf16_f32 v152, v208, v209
    v_cvt_pk_bf16_f32 v153, v210, v211
    v_cvt_pk_bf16_f32 v154, v212, v213
    v_cvt_pk_bf16_f32 v155, v214, v215
    v_lshlrev_b32 v192, 16, v144
    v_and_b32 v193, 0xffff0000, v144
    v_lshlrev_b32 v194, 16, v145
    v_and_b32 v195, 0xffff0000, v145
    v_lshlrev_b32 v196, 16, v146
    v_and_b32 v197, 0xffff0000, v146
    v_lshlrev_b32 v198, 16, v147
    v_and_b32 v199, 0xffff0000, v147
    v_lshlrev_b32 v200, 16, v148
    v_and_b32 v201, 0xffff0000, v148
    v_lshlrev_b32 v202, 16, v149
    v_and_b32 v203, 0xffff0000, v149
    v_lshlrev_b32 v204, 16, v150
    v_and_b32 v205, 0xffff0000, v150
    v_lshlrev_b32 v206, 16, v151
    v_and_b32 v207, 0xffff0000, v151
    v_lshlrev_b32 v208, 16, v152
    v_and_b32 v209, 0xffff0000, v152
    v_lshlrev_b32 v210, 16, v153
    v_and_b32 v211, 0xffff0000, v153
    v_lshlrev_b32 v212, 16, v154
    v_and_b32 v213, 0xffff0000, v154
    v_lshlrev_b32 v214, 16, v155
    v_and_b32 v215, 0xffff0000, v155
    v_pk_add_f32 v[192:193], v[192:193], v[12:13]
    v_pk_add_f32 v[194:195], v[194:195], v[14:15]
    v_pk_add_f32 v[196:197], v[196:197], v[16:17]
    v_pk_add_f32 v[198:199], v[198:199], v[18:19]
    v_pk_add_f32 v[200:201], v[200:201], v[20:21]
    v_pk_add_f32 v[202:203], v[202:203], v[22:23]
    v_pk_add_f32 v[204:205], v[204:205], v[24:25]
    v_pk_add_f32 v[206:207], v[206:207], v[26:27]
    v_pk_add_f32 v[208:209], v[208:209], v[28:29]
    v_pk_add_f32 v[210:211], v[210:211], v[30:31]
    v_pk_add_f32 v[212:213], v[212:213], v[32:33]
    v_pk_add_f32 v[214:215], v[214:215], v[34:35]
    v_cvt_pk_bf16_f32 v156, v192, v193
    v_cvt_pk_bf16_f32 v157, v194, v195
    v_cvt_pk_bf16_f32 v158, v196, v197
    v_cvt_pk_bf16_f32 v159, v198, v199
    v_cvt_pk_bf16_f32 v160, v200, v201
    v_cvt_pk_bf16_f32 v161, v202, v203
    v_cvt_pk_bf16_f32 v162, v204, v205
    v_cvt_pk_bf16_f32 v163, v206, v207
    v_cvt_pk_bf16_f32 v164, v208, v209
    v_cvt_pk_bf16_f32 v165, v210, v211
    v_cvt_pk_bf16_f32 v166, v212, v213
    v_cvt_pk_bf16_f32 v167, v214, v215
    v_and_b32 v30, 2, v1
    v_cmp_ne_u32 vcc, 0, v30
    v_mul_u32_u24 v30, 1152, v7
    v_add_u32 v4, v30, v5
    v_add_u32 v58, v30, v59
    v_mov_b32_dpp v192, v158 quad_perm:[0,2,0,2] row_mask:0xf bank_mask:0xf
    v_mov_b32_dpp v193, v159 quad_perm:[0,2,0,2] row_mask:0xf bank_mask:0xf
    v_mov_b32_dpp v194, v158 quad_perm:[1,3,1,3] row_mask:0xf bank_mask:0xf
    v_mov_b32_dpp v195, v159 quad_perm:[1,3,1,3] row_mask:0xf bank_mask:0xf
    v_mov_b32_dpp v196, v162 quad_perm:[0,2,0,2] row_mask:0xf bank_mask:0xf
    v_mov_b32_dpp v197, v163 quad_perm:[0,2,0,2] row_mask:0xf bank_mask:0xf
    v_mov_b32_dpp v198, v162 quad_perm:[1,3,1,3] row_mask:0xf bank_mask:0xf
    v_mov_b32_dpp v199, v163 quad_perm:[1,3,1,3] row_mask:0xf bank_mask:0xf
    v_mov_b32_dpp v200, v166 quad_perm:[0,2,0,2] row_mask:0xf bank_mask:0xf
    v_mov_b32_dpp v201, v167 quad_perm:[0,2,0,2] row_mask:0xf bank_mask:0xf
    v_mov_b32_dpp v202, v166 quad_perm:[1,3,1,3] row_mask:0xf bank_mask:0xf
    v_mov_b32_dpp v203, v167 quad_perm:[1,3,1,3] row_mask:0xf bank_mask:0xf
    v_cndmask_b32_dpp v144, v156, v192, vcc quad_perm:[0,2,0,2] row_mask:0xf bank_mask:0xf
    v_cndmask_b32_dpp v145, v157, v193, vcc quad_perm:[0,2,0,2] row_mask:0xf bank_mask:0xf
    v_cndmask_b32_dpp v146, v156, v194, vcc quad_perm:[1,3,1,3] row_mask:0xf bank_mask:0xf
    v_cndmask_b32_dpp v147, v157, v195, vcc quad_perm:[1,3,1,3] row_mask:0xf bank_mask:0xf
    v_cndmask_b32_dpp v148, v160, v196, vcc quad_perm:[0,2,0,2] row_mask:0xf bank_mask:0xf
    v_cndmask_b32_dpp v149, v161, v197, vcc quad_perm:[0,2,0,2] row_mask:0xf bank_mask:0xf
    v_cndmask_b32_dpp v150, v160, v198, vcc quad_perm:[1,3,1,3] row_mask:0xf bank_mask:0xf
    v_cndmask_b32_dpp v151, v161, v199, vcc quad_perm:[1,3,1,3] row_mask:0xf bank_mask:0xf
    v_cndmask_b32_dpp v152, v164, v200, vcc quad_perm:[0,2,0,2] row_mask:0xf bank_mask:0xf
    v_cndmask_b32_dpp v153, v165, v201, vcc quad_perm:[0,2,0,2] row_mask:0xf bank_mask:0xf
    v_cndmask_b32_dpp v154, v164, v202, vcc quad_perm:[1,3,1,3] row_mask:0xf bank_mask:0xf
    v_cndmask_b32_dpp v155, v165, v203, vcc quad_perm:[1,3,1,3] row_mask:0xf bank_mask:0xf
    buffer_store_dwordx4 v[144:147], v4, s[16:19], 0 offen offset:0 sc1
    buffer_store_dwordx4 v[148:151], v4, s[16:19], 0 offen offset:512 sc1
    buffer_store_dwordx4 v[152:155], v58, s[16:19], 0 offen offset:1024 sc1
    s_waitcnt vmcnt(0)
    s_mov_b32 s36, 2622592
    buffer_store_dwordx4 v[36:39], v6, s[24:27], s36 offen offset:0 sc1
    buffer_store_dwordx4 v[40:43], v6, s[24:27], s36 offen offset:512 sc1
    buffer_store_dwordx4 v[44:47], v60, s[24:27], s36 offen offset:1024 sc1
Ltail_done:
    s_endpgm
Lattn_wb:
    buffer_wbl2 sc1
    s_waitcnt vmcnt(0)
    s_branch Lattn_wbdone
Lattn_xspin:
Ltour0_12:
    s_cbranch_execz Lmain0
    s_mov_b32 s37, 262144
Lattn_xloop:
    buffer_load_dword v11, v8, s[24:27], s54 offen offset:8 sc1
    s_waitcnt vmcnt(0)
    v_readfirstlane_b32 s36, v11
    s_sub_u32 s37, s37, 1
    s_cbranch_scc1 Lattn_xgot
    s_cmp_lg_u32 s36, s95
    s_cbranch_scc1 Lattn_xloop
    s_branch Lattn_xgot
Ltail_spin1:
Ltour1_3:
    s_cbranch_execz Lmain1
    s_mov_b32 s48, 262144
Ltail_spinl1:
    buffer_load_dword v11, v9, s[24:27], s39 offen sc1
    s_waitcnt vmcnt(0)
    v_cmp_ne_u32 s[54:55], s95, v11
    s_sub_u32 s48, s48, 1
    s_cbranch_scc1 Ltail_got1
    s_cmp_lg_u64 s[54:55], 0
    s_cbranch_scc1 Ltail_spinl1
    s_branch Ltail_got1
Ltail_spin2:
Ltour1_4:
    s_cbranch_execz Lmain1
    s_mov_b32 s48, 262144
Ltail_spinl2:
    buffer_load_dword v11, v9, s[24:27], s39 offen sc1
    s_waitcnt vmcnt(0)
    v_cmp_ne_u32 s[54:55], s95, v11
    s_sub_u32 s48, s48, 1
    s_cbranch_scc1 Ltail_got2
    s_cmp_lg_u64 s[54:55], 0
    s_cbranch_scc1 Ltail_spinl2
    s_branch Ltail_got2
Lattn_redo:
    s_load_dwordx2 s[16:17], s[0:1], 88
    v_xor_b32 v8, 64, v9
    v_xor_b32 v10, 64, v11
    s_waitcnt vmcnt(0) lgkmcnt(0)
    s_barrier
    v_mov_b32 v232, 0xff800000
    v_mov_b32 v233, 0xff800000
    v_mov_b32 v234, 0xff800000
    v_mov_b32 v235, 0xff800000
    s_mov_b32 s40, 0
    s_mov_b32 s48, -1
Lattn_redo_loop:
    s_add_u32 m0, s42, 0
    s_nop 0
    buffer_load_dwordx4 v36, s[8:11], s40 offen lds
    buffer_load_dwordx4 v37, s[8:11], s40 offen offset:1024 lds
    buffer_load_dwordx4 v38, s[8:11], s40 offen offset:2048 lds
    buffer_load_dwordx4 v39, s[8:11], s40 offen offset:3072 lds
    s_add_u32 s40, s40, 16384
    s_waitcnt vmcnt(0) lgkmcnt(0)
    s_barrier
    ds_read_b128 a[208:211], v8 offset:0
    ds_read_b128 a[212:215], v9 offset:0
    ds_read_b128 a[216:219], v10 offset:0
    ds_read_b128 a[220:223], v11 offset:0
    s_waitcnt lgkmcnt(3)
    v_mfma_f32_16x16x32_bf16 v[216:219], a[208:211], v[64:67], 0
    s_waitcnt lgkmcnt(2)
    v_mfma_f32_16x16x32_bf16 v[216:219], a[212:215], v[68:71], v[216:219]
    s_waitcnt lgkmcnt(1)
    v_mfma_f32_16x16x32_bf16 v[216:219], a[216:219], v[72:75], v[216:219]
    s_waitcnt lgkmcnt(0)
    v_mfma_f32_16x16x32_bf16 v[216:219], a[220:223], v[76:79], v[216:219]
    v_mfma_f32_16x16x32_bf16 v[220:223], a[208:211], v[80:83], 0
    v_mfma_f32_16x16x32_bf16 v[220:223], a[212:215], v[84:87], v[220:223]
    v_mfma_f32_16x16x32_bf16 v[220:223], a[216:219], v[88:91], v[220:223]
    v_mfma_f32_16x16x32_bf16 v[220:223], a[220:223], v[92:95], v[220:223]
    v_mfma_f32_16x16x32_bf16 v[224:227], a[208:211], v[96:99], 0
    v_mfma_f32_16x16x32_bf16 v[224:227], a[212:215], v[100:103], v[224:227]
    v_mfma_f32_16x16x32_bf16 v[224:227], a[216:219], v[104:107], v[224:227]
    v_mfma_f32_16x16x32_bf16 v[224:227], a[220:223], v[108:111], v[224:227]
    v_mfma_f32_16x16x32_bf16 v[228:231], a[208:211], v[112:115], 0
    v_mfma_f32_16x16x32_bf16 v[228:231], a[212:215], v[116:119], v[228:231]
    v_mfma_f32_16x16x32_bf16 v[228:231], a[216:219], v[120:123], v[228:231]
    v_mfma_f32_16x16x32_bf16 v[228:231], a[220:223], v[124:127], v[228:231]
    v_max3_f32 v232, v232, v216, v217
    v_max3_f32 v232, v232, v218, v219
    v_max3_f32 v233, v233, v220, v221
    v_max3_f32 v233, v233, v222, v223
    v_max3_f32 v234, v234, v224, v225
    v_max3_f32 v234, v234, v226, v227
    s_nop 1
    v_max3_f32 v235, v235, v228, v229
    v_max3_f32 v235, v235, v230, v231
    ds_read_b128 a[224:227], v8 offset:4096
    ds_read_b128 a[228:231], v9 offset:4096
    ds_read_b128 a[232:235], v10 offset:4096
    ds_read_b128 a[236:239], v11 offset:4096
    s_waitcnt lgkmcnt(3)
    v_mfma_f32_16x16x32_bf16 v[216:219], a[224:227], v[64:67], 0
    s_waitcnt lgkmcnt(2)
    v_mfma_f32_16x16x32_bf16 v[216:219], a[228:231], v[68:71], v[216:219]
    s_waitcnt lgkmcnt(1)
    v_mfma_f32_16x16x32_bf16 v[216:219], a[232:235], v[72:75], v[216:219]
    s_waitcnt lgkmcnt(0)
    v_mfma_f32_16x16x32_bf16 v[216:219], a[236:239], v[76:79], v[216:219]
    v_mfma_f32_16x16x32_bf16 v[220:223], a[224:227], v[80:83], 0
    v_mfma_f32_16x16x32_bf16 v[220:223], a[228:231], v[84:87], v[220:223]
    v_mfma_f32_16x16x32_bf16 v[220:223], a[232:235], v[88:91], v[220:223]
    v_mfma_f32_16x16x32_bf16 v[220:223], a[236:239], v[92:95], v[220:223]
    v_mfma_f32_16x16x32_bf16 v[224:227], a[224:227], v[96:99], 0
    v_mfma_f32_16x16x32_bf16 v[224:227], a[228:231], v[100:103], v[224:227]
    v_mfma_f32_16x16x32_bf16 v[224:227], a[232:235], v[104:107], v[224:227]
    v_mfma_f32_16x16x32_bf16 v[224:227], a[236:239], v[108:111], v[224:227]
    v_mfma_f32_16x16x32_bf16 v[228:231], a[224:227], v[112:115], 0
    v_mfma_f32_16x16x32_bf16 v[228:231], a[228:231], v[116:119], v[228:231]
    v_mfma_f32_16x16x32_bf16 v[228:231], a[232:235], v[120:123], v[228:231]
    v_mfma_f32_16x16x32_bf16 v[228:231], a[236:239], v[124:127], v[228:231]
    v_max3_f32 v232, v232, v216, v217
    v_max3_f32 v232, v232, v218, v219
    v_max3_f32 v233, v233, v220, v221
    v_max3_f32 v233, v233, v222, v223
    v_max3_f32 v234, v234, v224, v225
    v_max3_f32 v234, v234, v226, v227
    s_nop 1
    v_max3_f32 v235, v235, v228, v229
    v_max3_f32 v235, v235, v230, v231
    ds_read_b128 a[208:211], v8 offset:8192
    ds_read_b128 a[212:215], v9 offset:8192
    ds_read_b128 a[216:219], v10 offset:8192
    ds_read_b128 a[220:223], v11 offset:8192
    s_waitcnt lgkmcnt(3)
    v_mfma_f32_16x16x32_bf16 v[216:219], a[208:211], v[64:67], 0
    s_waitcnt lgkmcnt(2)
    v_mfma_f32_16x16x32_bf16 v[216:219], a[212:215], v[68:71], v[216:219]
    s_waitcnt lgkmcnt(1)
    v_mfma_f32_16x16x32_bf16 v[216:219], a[216:219], v[72:75], v[216:219]
    s_waitcnt lgkmcnt(0)
    v_mfma_f32_16x16x32_bf16 v[216:219], a[220:223], v[76:79], v[216:219]
    v_mfma_f32_16x16x32_bf16 v[220:223], a[208:211], v[80:83], 0
    v_mfma_f32_16x16x32_bf16 v[220:223], a[212:215], v[84:87], v[220:223]
    v_mfma_f32_16x16x32_bf16 v[220:223], a[216:219], v[88:91], v[220:223]
    v_mfma_f32_16x16x32_bf16 v[220:223], a[220:223], v[92:95], v[220:223]
    v_mfma_f32_16x16x32_bf16 v[224:227], a[208:211], v[96:99], 0
    v_mfma_f32_16x16x32_bf16 v[224:227], a[212:215], v[100:103], v[224:227]
    v_mfma_f32_16x16x32_bf16 v[224:227], a[216:219], v[104:107], v[224:227]
    v_mfma_f32_16x16x32_bf16 v[224:227], a[220:223], v[108:111], v[224:227]
    v_mfma_f32_16x16x32_bf16 v[228:231], a[208:211], v[112:115], 0
    v_mfma_f32_16x16x32_bf16 v[228:231], a[212:215], v[116:119], v[228:231]
    v_mfma_f32_16x16x32_bf16 v[228:231], a[216:219], v[120:123], v[228:231]
    v_mfma_f32_16x16x32_bf16 v[228:231], a[220:223], v[124:127], v[228:231]
    v_max3_f32 v232, v232, v216, v217
    v_max3_f32 v232, v232, v218, v219
    v_max3_f32 v233, v233, v220, v221
    v_max3_f32 v233, v233, v222, v223
    v_max3_f32 v234, v234, v224, v225
    v_max3_f32 v234, v234, v226, v227
    s_nop 1
    v_max3_f32 v235, v235, v228, v229
    v_max3_f32 v235, v235, v230, v231
    ds_read_b128 a[224:227], v8 offset:12288
    ds_read_b128 a[228:231], v9 offset:12288
    ds_read_b128 a[232:235], v10 offset:12288
    ds_read_b128 a[236:239], v11 offset:12288
    s_waitcnt lgkmcnt(3)
    v_mfma_f32_16x16x32_bf16 v[216:219], a[224:227], v[64:67], 0
    s_waitcnt lgkmcnt(2)
    v_mfma_f32_16x16x32_bf16 v[216:219], a[228:231], v[68:71], v[216:219]
    s_waitcnt lgkmcnt(1)
    v_mfma_f32_16x16x32_bf16 v[216:219], a[232:235], v[72:75], v[216:219]
    s_waitcnt lgkmcnt(0)
    v_mfma_f32_16x16x32_bf16 v[216:219], a[236:239], v[76:79], v[216:219]
    v_mfma_f32_16x16x32_bf16 v[220:223], a[224:227], v[80:83], 0
    v_mfma_f32_16x16x32_bf16 v[220:223], a[228:231], v[84:87], v[220:223]
    v_mfma_f32_16x16x32_bf16 v[220:223], a[232:235], v[88:91], v[220:223]
    v_mfma_f32_16x16x32_bf16 v[220:223], a[236:239], v[92:95], v[220:223]
    v_mfma_f32_16x16x32_bf16 v[224:227], a[224:227], v[96:99], 0
    v_mfma_f32_16x16x32_bf16 v[224:227], a[228:231], v[100:103], v[224:227]
    v_mfma_f32_16x16x32_bf16 v[224:227], a[232:235], v[104:107], v[224:227]
    v_mfma_f32_16x16x32_bf16 v[224:227], a[236:239], v[108:111], v[224:227]
    v_mfma_f32_16x16x32_bf16 v[228:231], a[224:227], v[112:115], 0
    v_mfma_f32_16x16x32_bf16 v[228:231], a[228:231], v[116:119], v[228:231]
    v_mfma_f32_16x16x32_bf16 v[228:231], a[232:235], v[120:123], v[228:231]
    v_mfma_f32_16x16x32_bf16 v[228:231], a[236:239], v[124:127], v[228:231]
    v_max3_f32 v232, v232, v216, v217
    v_max3_f32 v232, v232, v218, v219
    v_max3_f32 v233, v233, v220, v221
    v_max3_f32 v233, v233, v222, v223
    v_max3_f32 v234, v234, v224, v225
    v_max3_f32 v234, v234, v226, v227
    s_nop 1
    v_max3_f32 v235, v235, v228, v229
    v_max3_f32 v235, v235, v230, v231
    s_barrier
    s_cmp_lt_u32 s40, 524288
    s_cbranch_scc1 Lattn_redo_loop
    v_mov_b32 v236, v232
    v_mov_b32 v237, v233
    v_mov_b32 v238, v234
    v_mov_b32 v239, v235
    v_permlane16_swap_b32 v232, v236
    v_permlane16_swap_b32 v233, v237
    v_permlane16_swap_b32 v234, v238
    v_permlane16_swap_b32 v235, v239
    v_max_f32 v232, v232, v236
    v_max_f32 v233, v233, v237
    v_max_f32 v234, v234, v238
    v_max_f32 v235, v235, v239
    v_mov_b32 v236, v232
    v_mov_b32 v237, v233
    v_mov_b32 v238, v234
    v_mov_b32 v239, v235
    v_permlane32_swap_b32 v232, v236
    v_permlane32_swap_b32 v233, v237
    v_permlane32_swap_b32 v234, v238
    v_permlane32_swap_b32 v235, v239
    v_max_f32 v232, v232, v236
    v_max_f32 v233, v233, v237
    v_max_f32 v234, v234, v238
    v_max_f32 v235, v235, v239
    v_sub_f32 v192, 0, v232
    v_sub_f32 v193, 0, v232
    v_sub_f32 v194, 0, v232
    v_sub_f32 v195, 0, v232
    v_sub_f32 v196, 0, v233
    v_sub_f32 v197, 0, v233
    v_sub_f32 v198, 0, v233
    v_sub_f32 v199, 0, v233
    v_sub_f32 v200, 0, v234
    v_sub_f32 v201, 0, v234
    v_sub_f32 v202, 0, v234
    v_sub_f32 v203, 0, v234
    v_sub_f32 v204, 0, v235
    v_sub_f32 v205, 0, v235
    v_sub_f32 v206, 0, v235
    v_sub_f32 v207, 0, v235
    s_mov_b32 s40, 0
    s_mov_b32 s41, 0
    s_add_u32 m0, s42, 0
    s_nop 0
    buffer_load_dwordx4 v36, s[8:11], s40 offen lds
    buffer_load_dwordx4 v37, s[8:11], s40 offen offset:1024 lds
    buffer_load_dwordx4 v38, s[8:11], s40 offen offset:2048 lds
    buffer_load_dwordx4 v39, s[8:11], s40 offen offset:3072 lds
    s_add_u32 s40, s40, 16384
    s_add_u32 m0, s42, 16384
    s_nop 0
    buffer_load_dwordx4 v36, s[8:11], s40 offen lds
    buffer_load_dwordx4 v37, s[8:11], s40 offen offset:1024 lds
    buffer_load_dwordx4 v38, s[8:11], s40 offen offset:2048 lds
    buffer_load_dwordx4 v39, s[8:11], s40 offen offset:3072 lds
    s_add_u32 s40, s40, 16384
    s_add_u32 m0, s42, 32768
    s_nop 0
    buffer_load_dwordx4 v36, s[8:11], s40 offen lds
    buffer_load_dwordx4 v37, s[8:11], s40 offen offset:1024 lds
    buffer_load_dwordx4 v38, s[8:11], s40 offen offset:2048 lds
    buffer_load_dwordx4 v39, s[8:11], s40 offen offset:3072 lds
    s_add_u32 s40, s40, 16384
    s_add_u32 m0, s42, 65536
    s_nop 0
    buffer_load_dwordx4 v40, s[12:15], s41 offen lds
    buffer_load_dwordx4 v41, s[12:15], s41 offen offset:1024 lds
    buffer_load_dwordx4 v40, s[12:15], s41 offen offset:2048 lds
    buffer_load_dwordx4 v41, s[12:15], s41 offen offset:3072 lds
    s_add_u32 s41, s41, 16384
    s_add_u32 m0, s42, 81920
    s_nop 0
    buffer_load_dwordx4 v40, s[12:15], s41 offen lds
    buffer_load_dwordx4 v41, s[12:15], s41 offen offset:1024 lds
    buffer_load_dwordx4 v40, s[12:15], s41 offen offset:2048 lds
    buffer_load_dwordx4 v41, s[12:15], s41 offen offset:3072 lds
    s_add_u32 s41, s41, 16384
    v_accvgpr_write_b32 a0, 0
    v_accvgpr_write_b32 a1, 0
    v_accvgpr_write_b32 a2, 0
    v_accvgpr_write_b32 a3, 0
    v_accvgpr_write_b32 a4, 0
    v_accvgpr_write_b32 a5, 0
    v_accvgpr_write_b32 a6, 0
    v_accvgpr_write_b32 a7, 0
    v_accvgpr_write_b32 a8, 0
    v_accvgpr_write_b32 a9, 0
    v_accvgpr_write_b32 a10, 0
    v_accvgpr_write_b32 a11, 0
    v_accvgpr_write_b32 a12, 0
    v_accvgpr_write_b32 a13, 0
    v_accvgpr_write_b32 a14, 0
    v_accvgpr_write_b32 a15, 0
    v_accvgpr_write_b32 a16, 0
    v_accvgpr_write_b32 a17, 0
    v_accvgpr_write_b32 a18, 0
    v_accvgpr_write_b32 a19, 0
    v_accvgpr_write_b32 a20, 0
    v_accvgpr_write_b32 a21, 0
    v_accvgpr_write_b32 a22, 0
    v_accvgpr_write_b32 a23, 0
    v_accvgpr_write_b32 a24, 0
    v_accvgpr_write_b32 a25, 0
    v_accvgpr_write_b32 a26, 0
    v_accvgpr_write_b32 a27, 0
    v_accvgpr_write_b32 a28, 0
    v_accvgpr_write_b32 a29, 0
    v_accvgpr_write_b32 a30, 0
    v_accvgpr_write_b32 a31, 0
    v_accvgpr_write_b32 a32, 0
    v_accvgpr_write_b32 a33, 0
    v_accvgpr_write_b32 a34, 0
    v_accvgpr_write_b32 a35, 0
    v_accvgpr_write_b32 a36, 0
    v_accvgpr_write_b32 a37, 0
    v_accvgpr_write_b32 a38, 0
    v_accvgpr_write_b32 a39, 0
    v_accvgpr_write_b32 a40, 0
    v_accvgpr_write_b32 a41, 0
    v_accvgpr_write_b32 a42, 0
    v_accvgpr_write_b32 a43, 0
    v_accvgpr_write_b32 a44, 0
    v_accvgpr_write_b32 a45, 0
    v_accvgpr_write_b32 a46, 0
    v_accvgpr_write_b32 a47, 0
    v_accvgpr_write_b32 a48, 0
    v_accvgpr_write_b32 a49, 0
    v_accvgpr_write_b32 a50, 0
    v_accvgpr_write_b32 a51, 0
    v_accvgpr_write_b32 a52, 0
    v_accvgpr_write_b32 a53, 0
    v_accvgpr_write_b32 a54, 0
    v_accvgpr_write_b32 a55, 0
    v_accvgpr_write_b32 a56, 0
    v_accvgpr_write_b32 a57, 0
    v_accvgpr_write_b32 a58, 0
    v_accvgpr_write_b32 a59, 0
    v_accvgpr_write_b32 a60, 0
    v_accvgpr_write_b32 a61, 0
    v_accvgpr_write_b32 a62, 0
    v_accvgpr_write_b32 a63, 0
    v_accvgpr_write_b32 a64, 0
    v_accvgpr_write_b32 a65, 0
    v_accvgpr_write_b32 a66, 0
    v_accvgpr_write_b32 a67, 0
    v_accvgpr_write_b32 a68, 0
    v_accvgpr_write_b32 a69, 0
    v_accvgpr_write_b32 a70, 0
    v_accvgpr_write_b32 a71, 0
    v_accvgpr_write_b32 a72, 0
    v_accvgpr_write_b32 a73, 0
    v_accvgpr_write_b32 a74, 0
    v_accvgpr_write_b32 a75, 0
    v_accvgpr_write_b32 a76, 0
    v_accvgpr_write_b32 a77, 0
    v_accvgpr_write_b32 a78, 0
    v_accvgpr_write_b32 a79, 0
    v_accvgpr_write_b32 a80, 0
    v_accvgpr_write_b32 a81, 0
    v_accvgpr_write_b32 a82, 0
    v_accvgpr_write_b32 a83, 0
    v_accvgpr_write_b32 a84, 0
    v_accvgpr_write_b32 a85, 0
    v_accvgpr_write_b32 a86, 0
    v_accvgpr_write_b32 a87, 0
    v_accvgpr_write_b32 a88, 0
    v_accvgpr_write_b32 a89, 0
    v_accvgpr_write_b32 a90, 0
    v_accvgpr_write_b32 a91, 0
    v_accvgpr_write_b32 a92, 0
    v_accvgpr_write_b32 a93, 0
    v_accvgpr_write_b32 a94, 0
    v_accvgpr_write_b32 a95, 0
    v_accvgpr_write_b32 a96, 0
    v_accvgpr_write_b32 a97, 0
    v_accvgpr_write_b32 a98, 0
    v_accvgpr_write_b32 a99, 0
    v_accvgpr_write_b32 a100, 0
    v_accvgpr_write_b32 a101, 0
    v_accvgpr_write_b32 a102, 0
    v_accvgpr_write_b32 a103, 0
    v_accvgpr_write_b32 a104, 0
    v_accvgpr_write_b32 a105, 0
    v_accvgpr_write_b32 a106, 0
    v_accvgpr_write_b32 a107, 0
    v_accvgpr_write_b32 a108, 0
    v_accvgpr_write_b32 a109, 0
    v_accvgpr_write_b32 a110, 0
    v_accvgpr_write_b32 a111, 0
    v_accvgpr_write_b32 a112, 0
    v_accvgpr_write_b32 a113, 0
    v_accvgpr_write_b32 a114, 0
    v_accvgpr_write_b32 a115, 0
    v_accvgpr_write_b32 a116, 0
    v_accvgpr_write_b32 a117, 0
    v_accvgpr_write_b32 a118, 0
    v_accvgpr_write_b32 a119, 0
    v_accvgpr_write_b32 a120, 0
    v_accvgpr_write_b32 a121, 0
    v_accvgpr_write_b32 a122, 0
    v_accvgpr_write_b32 a123, 0
    v_accvgpr_write_b32 a124, 0
    v_accvgpr_write_b32 a125, 0
    v_accvgpr_write_b32 a126, 0
    v_accvgpr_write_b32 a127, 0
    v_accvgpr_write_b32 a192, 0
    v_accvgpr_write_b32 a193, 0
    v_accvgpr_write_b32 a194, 0
    v_accvgpr_write_b32 a195, 0
    v_accvgpr_write_b32 a196, 0
    v_accvgpr_write_b32 a197, 0
    v_accvgpr_write_b32 a198, 0
    v_accvgpr_write_b32 a199, 0
    v_accvgpr_write_b32 a200, 0
    v_accvgpr_write_b32 a201, 0
    v_accvgpr_write_b32 a202, 0
    v_accvgpr_write_b32 a203, 0
    v_accvgpr_write_b32 a204, 0
    v_accvgpr_write_b32 a205, 0
    v_accvgpr_write_b32 a206, 0
    v_accvgpr_write_b32 a207, 0
    s_waitcnt vmcnt(0) lgkmcnt(0)
    s_barrier
    ds_read_b128 a[208:211], v8 offset:0
    ds_read_b128 a[212:215], v9 offset:0
    ds_read_b128 a[216:219], v10 offset:0
    ds_read_b128 a[220:223], v11 offset:0
    ds_read_b128 a[224:227], v8 offset:4096
    s_waitcnt vmcnt(0) lgkmcnt(0)
    s_branch Lattn_stage0
Lattn_armwait:
    s_mov_b32 s36, 262144
Lattn_armloop:
    v_mov_b32 v63, 0
    buffer_load_dword v63, v63, s[88:91], 0 offen sc1
    s_waitcnt vmcnt(0)
    v_readfirstlane_b32 s37, v63
    s_sub_u32 s36, s36, 1
    s_cbranch_scc1 Lattn_armed
    s_cmp_lt_u32 s37, 256
    s_cbranch_scc1 Lattn_armloop
    s_branch Lattn_armed
Lattn_end:
    s_endpgm
.section .rodata,"a"
.p2align 6
.amdhsa_kernel adaLN_cond__gqa_block_cached__moe_arch_mod__prompt_kernel
  .amdhsa_next_free_vgpr 512
  .amdhsa_next_free_sgpr 102
  .amdhsa_accum_offset 256
  .amdhsa_group_segment_fixed_size 0
  .amdhsa_kernarg_size 120
  .amdhsa_user_sgpr_count 2
  .amdhsa_user_sgpr_kernarg_segment_ptr 1
  .amdhsa_system_sgpr_workgroup_id_x 1
  .amdhsa_float_denorm_mode_32 3
.end_amdhsa_kernel
```

```asm
; @launch grid=(256,1,1) block=(256,1,1) lds=163840
.amdgcn_target "amdgcn-amd-amdhsa--gfx950"
.text
.globl adaLN_cond__gqa_block_cached__moe_arch_mod__prompt_kernel
.p2align 8
.type adaLN_cond__gqa_block_cached__moe_arch_mod__prompt_kernel,@function
adaLN_cond__gqa_block_cached__moe_arch_mod__prompt_kernel:
    s_cmp_ge_u32 s2, 256
    s_cbranch_scc1 Lattn_end
    s_load_dwordx2 s[8:9], s[0:1], 80
    s_load_dwordx2 s[12:13], s[0:1], 88
    s_load_dwordx2 s[20:21], s[0:1], 0
    s_load_dwordx2 s[50:51], s[0:1], 112
    s_load_dwordx8 s[52:59], s[0:1], 8
    s_load_dwordx4 s[80:83], s[0:1], 56
    s_load_dwordx2 s[84:85], s[0:1], 72
    s_load_dwordx2 s[88:89], s[0:1], 104
    s_load_dwordx2 s[28:29], s[0:1], 48
    s_getpc_b64 s[32:33]
Lattn_pc:
    s_mov_b32 s34, Lattn_end-Lattn_pc
    s_mov_b32 s35, 0x20000
    s_lshr_b32 s6, s2, 3
    s_lshl_b32 s7, s6, 6
    v_lshrrev_b32 v3, 6, v0
    v_and_b32 v1, 63, v0
    v_lshrrev_b32 v2, 2, v0
    v_lshlrev_b32 v2, 11, v2
    v_readfirstlane_b32 s3, v3
    buffer_load_dword v240, v2, s[32:35], s7 offen
    s_and_b32 s7, s2, 7
    s_lshl_b32 s4, s7, 1
    s_and_b32 s5, s6, 1
    s_add_u32 s4, s4, s5
    s_lshr_b32 s5, s2, 4
    s_lshr_b32 s38, s6, 2
    s_lshl_b32 s38, s38, 3
    s_add_u32 s38, s38, s7
    s_cmp_lt_u32 s38, 18
    s_cselect_b32 s39, 0, 2147483648
    s_lshl_b32 s38, s38, 2
    s_and_b32 s36, s6, 3
    s_add_u32 s38, s38, s36
    s_mov_b32 s14, 3981312
    s_mul_i32 s92, s6, 124416
    s_lshl_b32 s36, s7, 7
    s_add_u32 s92, s92, s36
    s_cmp_lt_u32 s7, 2
    s_cselect_b32 s36, 53, 35
    v_lshrrev_b32 v2, 2, v0
    v_min_u32 v2, s36, v2
    v_mul_u32_u24 v3, 57, v2
    v_lshrrev_b32 v3, 10, v3
    v_mul_i32_i24 v3, -123392, v3
    v_mul_u32_u24 v2, 6912, v2
    v_add_u32 v72, v2, v3
    s_mov_b32 s15, 0x20000
    s_mov_b32 s10, 1152
    s_mov_b32 s11, 0x20000
    s_mov_b32 s22, 2359296
    s_mov_b32 s23, 0x20000
    v_and_b32 v64, 0xfe, v0
    v_mul_u32_u24 v65, 3456, v64
    v_and_b32 v2, 1, v0
    v_lshl_add_u32 v65, v2, 4, v65
    s_lshl_b32 s36, s38, 5
    s_or_b32 s36, s36, s39
    v_and_b32 v4, 31, v1
    v_lshrrev_b32 v5, 5, v1
    v_cmp_gt_u32 vcc, 24, v4
    v_mov_b32 v6, 2147483648
    s_lshl_b32 s7, s5, 4
    s_add_u32 s7, s7, s4
    s_lshl_b32 s7, s7, 2
    s_add_u32 s7, s7, s3
    v_cndmask_b32 v6, v6, 0, vcc
    s_mul_i32 s49, s7, 2304
    v_lshrrev_b32 v7, 2, v4
    v_lshl_add_u32 v7, v7, 6, v6
    v_and_b32 v2, 3, v4
    v_lshl_add_u32 v7, v2, 3, v7
    v_mul_u32_u24 v2, 1152, v5
    v_add_u32 v66, v7, v2
    s_waitcnt lgkmcnt(0)
    s_load_dword s94, s[50:51], 24576
    buffer_load_dword v241, v72, s[12:15], s92 offen
    buffer_load_ushort v80, v64, s[8:11], 0 offen offset:0
    buffer_load_ushort v81, v64, s[8:11], 0 offen offset:256
    buffer_load_ushort v82, v64, s[8:11], 0 offen offset:512
    buffer_load_ushort v83, v64, s[8:11], 0 offen offset:768
    buffer_load_ushort v84, v64, s[8:11], 0 offen offset:1024
    buffer_load_dwordx4 v[88:91], v65, s[12:15], s36 offen
    s_add_u32 s36, s36, 884736
    buffer_load_dwordx4 v[92:95], v65, s[12:15], s36 offen
    s_add_u32 s36, s36, 884736
    buffer_load_dwordx4 v[96:99], v65, s[12:15], s36 offen
    s_add_u32 s36, s36, 884736
    buffer_load_dwordx4 v[100:103], v65, s[12:15], s36 offen
    s_add_u32 s36, s36, 884736
    buffer_load_dwordx4 v[104:107], v65, s[12:15], s36 offen
    s_mov_b32 s16, s56
    s_mov_b32 s17, s57
    s_mov_b32 s18, 4718592
    s_mov_b32 s19, 0x20000
    s_lshl_b32 s44, s4, 9
    s_mul_i32 s36, s5, 131072
    s_add_u32 s36, s36, 0
    v_lshrrev_b32 v2, 2, v0
    v_min_u32 v2, 63, v2
    v_lshrrev_b32 v3, 2, v2
    v_and_b32 v2, 3, v2
    v_lshl_add_u32 v2, v2, 7, s36
    v_lshl_add_u32 v71, v3, 13, v2
    s_mul_i32 s36, s5, 163840
    s_add_u32 s36, s36, 2097152
    v_lshrrev_b32 v2, 1, v0
    v_min_u32 v2, 79, v2
    v_lshrrev_b32 v3, 2, v2
    v_and_b32 v2, 3, v2
    v_lshl_add_u32 v2, v2, 7, s36
    v_lshl_add_u32 v70, v3, 13, v2
    s_add_u32 s92, s49, 65536
    v_lshl_add_u32 v7, v5, 4, v6
    v_lshl_add_u32 v67, v4, 5, v7
    v_min_u32 v4, 23, v4
    v_lshlrev_b32 v68, 4, v4
    s_mov_b32 s24, s50
    s_mov_b32 s25, s51
    s_mov_b32 s26, 10485760
    s_mov_b32 s27, 0x20000
    s_mov_b32 s90, 256
    s_mov_b32 s91, 0x20000
    s_cmp_ge_u32 s38, 36
    s_cselect_b32 s93, 1.0, 0
    s_lshl_b32 s36, s38, 7
    v_lshl_add_u32 v69, v0, 3, s36
    v_cmp_gt_u32 s[36:37], 16, v0
    v_mov_b32 v2, 2147483648
    v_mov_b32 v3, s39
    v_cndmask_b32 v2, v2, v3, s[36:37]
    v_or_b32 v69, v69, v2
    s_mul_i32 s36, s5, 3072
    s_lshl_b32 s37, s5, 11
    v_lshrrev_b32 v120, 3, v0
    v_min_u32 v120, 23, v120
    v_lshl_add_u32 v120, v120, 7, s36
    v_lshrrev_b32 v121, 4, v0
    v_lshl_add_u32 v121, v121, 7, s37
    s_lshl_b32 s42, s3, 12
    v_lshrrev_b32 v2, 4, v1
    v_and_b32 v3, 15, v1
    v_lshrrev_b32 v5, 1, v3
    v_mul_u32_u24 v5, 2304, v5
    v_lshl_add_u32 v5, v2, 5, v5
    v_and_b32 v6, 1, v3
    v_lshl_add_u32 v51, v6, 4, v5
    s_lshl_b32 s6, s5, 2
    s_add_u32 s6, s6, s3
    s_mul_i32 s46, s6, 36864
    s_add_u32 s46, s46, 65536
    s_add_u32 s43, s46, 18432
    s_mul_i32 s45, s4, 294912
    s_lshl_b32 s7, s3, 4
    v_add_u32 v4, s7, v2
    v_lshlrev_b32 v5, 1, v2
    v_xor_b32 v5, v5, v3
    v_xor_b32 v6, 8, v5
    v_lshlrev_b32 v7, 13, v4
    v_lshl_add_u32 v42, v5, 4, v7
    v_lshl_add_u32 v43, v6, 4, v7
    v_add_u32 v44, 63488, v42
    v_add_u32 v45, 95232, v43
    v_add_u32 v43, 31744, v43
    s_lshl_b32 s7, s4, 19
    s_add_u32 s8, s52, s7
    s_addc_u32 s9, s53, 0
    s_mov_b32 s10, 524288
    s_mov_b32 s11, 0x20000
    s_add_u32 s12, s54, s7
    s_addc_u32 s13, s55, 0
    s_mov_b32 s14, 524288
    s_mov_b32 s15, 0x20000
    s_add_u32 s28, s50, 10485760
    s_addc_u32 s29, s51, 0
    s_mov_b32 s30, 37748736
    s_mov_b32 s31, 0x20000
    v_lshlrev_b32 v7, 8, v4
    v_lshl_add_u32 v40, v5, 4, v7
    v_lshl_add_u32 v41, v6, 4, v7
    v_xor_b32 v224, v3, v2
    v_lshl_add_u32 v36, v224, 4, v7
    v_xor_b32 v37, 64, v36
    v_xor_b32 v38, 128, v36
    v_xor_b32 v39, 192, v36
    v_lshrrev_b32 v7, 3, v5
    v_lshl_add_u32 v7, v7, 7, v4
    v_mul_u32_u24 v7, 1152, v7
    v_and_b32 v225, 7, v5
    v_lshl_add_u32 v46, v225, 4, v7
    v_lshrrev_b32 v7, 3, v6
    v_lshl_add_u32 v7, v7, 7, v4
    v_mul_u32_u24 v7, 1152, v7
    v_and_b32 v225, 7, v6
    v_lshl_add_u32 v47, v225, 4, v7
    v_add_u32 v48, 7168, v46
    v_add_u32 v49, 10752, v47
    v_add_u32 v47, 3584, v47
    v_lshlrev_b32 v7, 8, v3
    v_lshl_add_u32 v8, v224, 4, v7
    v_xor_b32 v9, 64, v8
    v_xor_b32 v10, 128, v8
    v_xor_b32 v11, 192, v8
    v_lshrrev_b32 v5, 2, v1
    v_and_b32 v6, 7, v5
    v_lshlrev_b32 v6, 5, v6
    v_lshl_add_u32 v6, v5, 8, v6
    v_and_b32 v7, 3, v1
    v_lshl_add_u32 v12, v7, 3, v6
    v_xor_b32 v13, 32, v12
    v_xor_b32 v14, 64, v12
    v_xor_b32 v15, 96, v12
    v_xor_b32 v16, 128, v12
    v_xor_b32 v17, 160, v12
    v_xor_b32 v18, 192, v12
    v_xor_b32 v19, 224, v12
    v_add_u32 v20, 65536, v12
    v_add_u32 v21, 65536, v13
    v_add_u32 v22, 65536, v14
    v_add_u32 v23, 65536, v15
    v_add_u32 v24, 65536, v16
    v_add_u32 v25, 65536, v17
    v_add_u32 v26, 65536, v18
    v_add_u32 v27, 65536, v19
    v_add_u32 v28, 131072, v12
    v_add_u32 v29, 131072, v13
    v_add_u32 v30, 131072, v14
    v_add_u32 v31, 131072, v15
    v_add_u32 v32, 131072, v16
    v_add_u32 v33, 131072, v17
    v_add_u32 v34, 131072, v18
    v_add_u32 v35, 131072, v19
    v_mov_b32 v52, 0x3f803f80
    v_mov_b32 v53, 0x3f803f80
    v_mov_b32 v54, 0x3f803f80
    v_mov_b32 v55, 0x3f803f80
    v_and_b32 v5, 1, v1
    v_mul_u32_u24 v5, 0xaaaa, v5
    v_add_u32 v5, 0x4444, v5
    v_lshl_add_u32 v50, v5, 16, v5
    v_lshrrev_b32 v5, 1, v3
    v_mul_u32_u24 v5, 20480, v5
    v_lshl_add_u32 v5, v2, 5, v5
    v_and_b32 v6, 1, v3
    v_lshl_add_u32 v56, v6, 4, v5
    s_mul_i32 s47, s6, 327680
    s_mov_b32 s32, s82
    s_mov_b32 s33, s83
    s_mov_b32 s34, 5308416
    s_mov_b32 s35, 0x20000
    s_mov_b32 s82, 5308416
    s_mov_b32 s83, 0x20000
    s_mov_b32 s86, 5308416
    s_mov_b32 s87, 0x20000
    s_lshr_b32 s7, s2, 3
    s_mul_i32 s7, s7, 18
    s_add_u32 s7, s7, s3
    s_and_b32 s36, s2, 7
    s_mul_i32 s37, s36, 576
    s_add_u32 s37, s37, s7
    s_mul_i32 s37, s37, 1152
    s_mul_i32 s7, s7, 9216
    s_mul_i32 s36, s36, 1152
    s_add_u32 s7, s7, s36
    v_min_u32 v5, 17, v1
    v_lshl_add_u32 v57, v5, 6, s7
    v_lshl_add_u32 v62, v5, 6, s37
    s_mov_b32 s40, 0
    s_mov_b32 s41, 0
    s_mov_b32 s48, 0
    s_waitcnt vmcnt(9)
    v_lshlrev_b32 v80, 16, v80
    s_waitcnt vmcnt(8)
    v_lshlrev_b32 v81, 16, v81
    s_waitcnt vmcnt(7)
    v_lshlrev_b32 v82, 16, v82
    s_waitcnt vmcnt(6)
    v_lshlrev_b32 v83, 16, v83
    s_waitcnt vmcnt(5)
    v_lshlrev_b32 v84, 16, v84
    v_mul_f32 v144, 0xbfb8aa3b, v80
    v_mul_f32 v148, 0xbfb8aa3b, v81
    v_mul_f32 v152, 0xbfb8aa3b, v82
    v_mul_f32 v156, 0xbfb8aa3b, v83
    v_mul_f32 v160, 0xbfb8aa3b, v84
    v_min_f32 v144, 0x42fc0000, v144
    v_min_f32 v148, 0x42fc0000, v148
    v_min_f32 v152, 0x42fc0000, v152
    v_min_f32 v156, 0x42fc0000, v156
    v_min_f32 v160, 0x42fc0000, v160
    v_exp_f32 v144, v144
    v_exp_f32 v148, v148
    v_exp_f32 v152, v152
    v_exp_f32 v156, v156
    v_exp_f32 v160, v160
    v_add_f32 v144, 1.0, v144
    v_add_f32 v148, 1.0, v148
    v_add_f32 v152, 1.0, v152
    v_add_f32 v156, 1.0, v156
    v_add_f32 v160, 1.0, v160
    v_rcp_f32 v145, v144
    v_rcp_f32 v149, v148
    v_rcp_f32 v153, v152
    v_rcp_f32 v157, v156
    v_rcp_f32 v161, v160
    v_mul_f32 v146, v80, v145
    v_mul_f32 v150, v81, v149
    v_mul_f32 v154, v82, v153
    v_mul_f32 v158, v83, v157
    v_mul_f32 v162, v84, v161
    v_fma_f32 v144, -v146, v144, v80
    v_fma_f32 v148, -v150, v148, v81
    v_fma_f32 v152, -v154, v152, v82
    v_fma_f32 v156, -v158, v156, v83
    v_fma_f32 v160, -v162, v160, v84
    v_fma_f32 v80, v144, v145, v146
    v_fma_f32 v81, v148, v149, v150
    v_fma_f32 v82, v152, v153, v154
    v_fma_f32 v83, v156, v157, v158
    v_fma_f32 v84, v160, v161, v162
    v_cvt_pk_bf16_f32 v80, v80, v80
    v_cvt_pk_bf16_f32 v81, v81, v81
    v_cvt_pk_bf16_f32 v82, v82, v82
    v_cvt_pk_bf16_f32 v83, v83, v83
    v_cvt_pk_bf16_f32 v84, v84, v84
    v_and_b32 v80, 0xffff0000, v80
    v_and_b32 v81, 0xffff0000, v81
    v_and_b32 v82, 0xffff0000, v82
    v_and_b32 v83, 0xffff0000, v83
    v_and_b32 v84, 0xffff0000, v84
    buffer_load_dwordx2 v[108:109], v66, s[20:23], s49 offen offset:0
    buffer_load_dwordx2 v[110:111], v66, s[20:23], s49 offen offset:32
    buffer_load_dwordx2 v[112:113], v66, s[20:23], s49 offen offset:384
    buffer_load_dwordx2 v[114:115], v66, s[20:23], s49 offen offset:416
    buffer_load_dwordx2 v[116:117], v66, s[20:23], s49 offen offset:768
    buffer_load_dwordx2 v[118:119], v66, s[20:23], s49 offen offset:800
    s_mov_b32 s20, s58
    s_mov_b32 s21, s59
    s_mov_b32 s22, 4718592
    s_mov_b32 s23, 0x20000
    s_waitcnt vmcnt(10)
    v_lshlrev_b32 v136, 16, v88
    v_and_b32 v137, 0xffff0000, v88
    v_lshlrev_b32 v138, 16, v89
    v_and_b32 v139, 0xffff0000, v89
    v_lshlrev_b32 v140, 16, v90
    v_and_b32 v141, 0xffff0000, v90
    v_lshlrev_b32 v142, 16, v91
    v_and_b32 v143, 0xffff0000, v91
    v_pk_mul_f32 v[128:129], v[136:137], v[80:81] op_sel:[0,0] op_sel_hi:[1,0]
    v_pk_mul_f32 v[130:131], v[138:139], v[80:81] op_sel:[0,0] op_sel_hi:[1,0]
    v_pk_mul_f32 v[132:133], v[140:141], v[80:81] op_sel:[0,0] op_sel_hi:[1,0]
    v_pk_mul_f32 v[134:135], v[142:143], v[80:81] op_sel:[0,0] op_sel_hi:[1,0]
    s_waitcnt vmcnt(9)
    v_lshlrev_b32 v136, 16, v92
    v_and_b32 v137, 0xffff0000, v92
    v_lshlrev_b32 v138, 16, v93
    v_and_b32 v139, 0xffff0000, v93
    v_lshlrev_b32 v140, 16, v94
    v_and_b32 v141, 0xffff0000, v94
    v_lshlrev_b32 v142, 16, v95
    v_and_b32 v143, 0xffff0000, v95
    v_pk_fma_f32 v[128:129], v[136:137], v[80:81], v[128:129] op_sel:[0,1,0] op_sel_hi:[1,1,1]
    v_pk_fma_f32 v[130:131], v[138:139], v[80:81], v[130:131] op_sel:[0,1,0] op_sel_hi:[1,1,1]
    v_pk_fma_f32 v[132:133], v[140:141], v[80:81], v[132:133] op_sel:[0,1,0] op_sel_hi:[1,1,1]
    v_pk_fma_f32 v[134:135], v[142:143], v[80:81], v[134:135] op_sel:[0,1,0] op_sel_hi:[1,1,1]
    s_waitcnt vmcnt(8)
    v_lshlrev_b32 v136, 16, v96
    v_and_b32 v137, 0xffff0000, v96
    v_lshlrev_b32 v138, 16, v97
    v_and_b32 v139, 0xffff0000, v97
    v_lshlrev_b32 v140, 16, v98
    v_and_b32 v141, 0xffff0000, v98
    v_lshlrev_b32 v142, 16, v99
    v_and_b32 v143, 0xffff0000, v99
    v_pk_fma_f32 v[128:129], v[136:137], v[82:83], v[128:129] op_sel:[0,0,0] op_sel_hi:[1,0,1]
    v_pk_fma_f32 v[130:131], v[138:139], v[82:83], v[130:131] op_sel:[0,0,0] op_sel_hi:[1,0,1]
    v_pk_fma_f32 v[132:133], v[140:141], v[82:83], v[132:133] op_sel:[0,0,0] op_sel_hi:[1,0,1]
    v_pk_fma_f32 v[134:135], v[142:143], v[82:83], v[134:135] op_sel:[0,0,0] op_sel_hi:[1,0,1]
    s_waitcnt vmcnt(7)
    v_lshlrev_b32 v136, 16, v100
    v_and_b32 v137, 0xffff0000, v100
    v_lshlrev_b32 v138, 16, v101
    v_and_b32 v139, 0xffff0000, v101
    v_lshlrev_b32 v140, 16, v102
    v_and_b32 v141, 0xffff0000, v102
    v_lshlrev_b32 v142, 16, v103
    v_and_b32 v143, 0xffff0000, v103
    v_pk_fma_f32 v[128:129], v[136:137], v[82:83], v[128:129] op_sel:[0,1,0] op_sel_hi:[1,1,1]
    v_pk_fma_f32 v[130:131], v[138:139], v[82:83], v[130:131] op_sel:[0,1,0] op_sel_hi:[1,1,1]
    v_pk_fma_f32 v[132:133], v[140:141], v[82:83], v[132:133] op_sel:[0,1,0] op_sel_hi:[1,1,1]
    v_pk_fma_f32 v[134:135], v[142:143], v[82:83], v[134:135] op_sel:[0,1,0] op_sel_hi:[1,1,1]
    s_waitcnt vmcnt(6)
    v_lshlrev_b32 v136, 16, v104
    v_and_b32 v137, 0xffff0000, v104
    v_lshlrev_b32 v138, 16, v105
    v_and_b32 v139, 0xffff0000, v105
    v_lshlrev_b32 v140, 16, v106
    v_and_b32 v141, 0xffff0000, v106
    v_lshlrev_b32 v142, 16, v107
    v_and_b32 v143, 0xffff0000, v107
    v_pk_fma_f32 v[128:129], v[136:137], v[84:85], v[128:129] op_sel:[0,0,0] op_sel_hi:[1,0,1]
    v_pk_fma_f32 v[130:131], v[138:139], v[84:85], v[130:131] op_sel:[0,0,0] op_sel_hi:[1,0,1]
    v_pk_fma_f32 v[132:133], v[140:141], v[84:85], v[132:133] op_sel:[0,0,0] op_sel_hi:[1,0,1]
    v_pk_fma_f32 v[134:135], v[142:143], v[84:85], v[134:135] op_sel:[0,0,0] op_sel_hi:[1,0,1]
    s_nop 0
    v_permlane32_swap_b32 v128, v132
    v_permlane32_swap_b32 v129, v133
    v_permlane32_swap_b32 v130, v134
    v_permlane32_swap_b32 v131, v135
    v_and_b32 v72, 1, v1
    v_pk_add_f32 v[128:129], v[128:129], v[132:133]
    v_pk_add_f32 v[130:131], v[130:131], v[134:135]
    v_lshlrev_b32 v72, 5, v72
    v_lshrrev_b32 v73, 4, v1
    v_permlane16_swap_b32 v128, v130
    v_permlane16_swap_b32 v129, v131
    v_lshl_add_u32 v72, v73, 3, v72
    v_pk_add_f32 v[128:129], v[128:129], v[130:131]
    s_lshl_b32 s36, s3, 6
    v_add_u32 v72, s36, v72
    v_add_f32_dpp v128, v128, v128 row_ror:2 row_mask:0xf bank_mask:0xf
    v_add_f32_dpp v129, v129, v129 row_ror:2 row_mask:0xf bank_mask:0xf
    s_nop 0
    v_add_f32_dpp v128, v128, v128 row_ror:4 row_mask:0xf bank_mask:0xf
    v_add_f32_dpp v129, v129, v129 row_ror:4 row_mask:0xf bank_mask:0xf
    s_nop 0
    v_add_f32_dpp v128, v128, v128 row_ror:8 row_mask:0xf bank_mask:0xf
    v_add_f32_dpp v129, v129, v129 row_ror:8 row_mask:0xf bank_mask:0xf
    ds_write_b64 v72, v[128:129] offset:0
    v_and_b32 v73, 7, v1
    v_lshlrev_b32 v73, 3, v73
    s_waitcnt lgkmcnt(0)
    s_barrier
    ds_read_b64 v[128:129], v73 offset:0
    ds_read_b64 v[130:131], v73 offset:64
    ds_read_b64 v[132:133], v73 offset:128
    ds_read_b64 v[134:135], v73 offset:192
    s_add_u32 s95, s94, 0x9e3779b9
    v_mov_b32 v137, s95
    s_mov_b32 s37, 32768
    s_waitcnt lgkmcnt(2)
    v_pk_add_f32 v[128:129], v[128:129], v[130:131]
    s_waitcnt lgkmcnt(0)
    v_pk_add_f32 v[132:133], v[132:133], v[134:135]
    v_pk_add_f32 v[128:129], v[128:129], v[132:133]
    v_cvt_pk_bf16_f32 v136, v128, v129
    v_lshlrev_b32 v128, 16, v136
    v_and_b32 v129, 0xffff0000, v136
    v_add_f32 v128, s93, v128
    v_add_f32 v129, s93, v129
    v_cvt_pk_bf16_f32 v136, v128, v129
    buffer_store_dwordx2 v[136:137], v69, s[24:27], s37 offen sc1
    s_mul_i32 s36, s3, 72
    v_add_u32 v122, s36, v1
    v_and_b32 v123, 7, v1
    s_add_u32 s36, s36, 64
    v_add_u32 v123, s36, v123
    s_movk_i32 s36, 1024
    v_and_b32 v76, 3, v122
    v_lshlrev_b32 v76, 4, v76
    v_lshrrev_b32 v122, 2, v122
    v_lshl_add_u32 v124, v122, 7, v76
    v_and_b32 v77, 1, v122
    v_lshl_add_u32 v76, v77, 3, v76
    v_lshrrev_b32 v122, 1, v122
    v_lshl_add_u32 v122, v122, 6, v76
    v_add_u32 v122, s36, v122
    v_and_b32 v76, 3, v123
    v_lshlrev_b32 v76, 4, v76
    v_lshrrev_b32 v123, 2, v123
    v_lshl_add_u32 v125, v123, 7, v76
    v_and_b32 v77, 1, v123
    v_lshl_add_u32 v76, v77, 3, v76
    v_lshrrev_b32 v123, 1, v123
    v_lshl_add_u32 v123, v123, 6, v76
    v_add_u32 v123, s36, v123
    s_mov_b64 exec, 0
    s_cmp_eq_u32 s3, 0
    s_cbranch_scc1 Ltour0_0
    s_cmp_eq_u32 s3, 1
    s_cbranch_scc1 Ltour0_1
    s_cmp_eq_u32 s3, 2
    s_cbranch_scc1 Ltour0_2
    s_branch Ltour0_3
.p2align 12
Lmain0:
    s_mov_b64 exec, -1
    s_waitcnt vmcnt(6)
    v_lshlrev_b32 v144, 16, v108
    v_and_b32 v145, 0xffff0000, v108
    v_lshlrev_b32 v146, 16, v109
    v_and_b32 v147, 0xffff0000, v109
    s_waitcnt vmcnt(5)
    v_lshlrev_b32 v148, 16, v110
    v_and_b32 v149, 0xffff0000, v110
    v_lshlrev_b32 v150, 16, v111
    v_and_b32 v151, 0xffff0000, v111
    s_waitcnt vmcnt(4)
    v_lshlrev_b32 v152, 16, v112
    v_and_b32 v153, 0xffff0000, v112
    v_lshlrev_b32 v154, 16, v113
    v_and_b32 v155, 0xffff0000, v113
    s_waitcnt vmcnt(3)
    v_lshlrev_b32 v156, 16, v114
    v_and_b32 v157, 0xffff0000, v114
    v_lshlrev_b32 v158, 16, v115
    v_and_b32 v159, 0xffff0000, v115
    s_waitcnt vmcnt(2)
    v_lshlrev_b32 v160, 16, v116
    v_and_b32 v161, 0xffff0000, v116
    v_lshlrev_b32 v162, 16, v117
    v_and_b32 v163, 0xffff0000, v117
    s_waitcnt vmcnt(1)
    v_lshlrev_b32 v164, 16, v118
    v_and_b32 v165, 0xffff0000, v118
    v_lshlrev_b32 v166, 16, v119
    v_and_b32 v167, 0xffff0000, v119
    buffer_load_dwordx4 v[88:91], v124, s[24:27], s37 offen sc1
    buffer_load_dwordx4 v[92:95], v125, s[24:27], s37 offen sc1
    buffer_load_dword v242, v71, s[16:19], s44 offen
    v_pk_add_f32 v[72:73], v[144:145], v[148:149]
    v_pk_add_f32 v[76:77], v[146:147], v[150:151]
    v_pk_add_f32 v[72:73], v[72:73], v[152:153]
    v_pk_add_f32 v[76:77], v[76:77], v[154:155]
    v_pk_add_f32 v[72:73], v[72:73], v[156:157]
    v_pk_add_f32 v[76:77], v[76:77], v[158:159]
    v_pk_add_f32 v[72:73], v[72:73], v[160:161]
    v_pk_add_f32 v[76:77], v[76:77], v[162:163]
    v_pk_add_f32 v[72:73], v[72:73], v[164:165]
    v_pk_add_f32 v[76:77], v[76:77], v[166:167]
    v_pk_add_f32 v[72:73], v[72:73], v[76:77]
    v_add_f32 v72, v72, v73
    s_nop 1
    v_add_f32_dpp v72, v72, v72 row_ror:8 row_mask:0xf bank_mask:0xf
    s_nop 1
    v_add_f32_dpp v72, v72, v72 row_ror:4 row_mask:0xf bank_mask:0xf
    s_nop 1
    v_add_f32_dpp v72, v72, v72 row_ror:2 row_mask:0xf bank_mask:0xf
    s_nop 1
    v_add_f32_dpp v72, v72, v72 row_ror:1 row_mask:0xf bank_mask:0xf
    v_mov_b32 v76, v72
    s_nop 1
    v_permlane16_swap_b32 v72, v76
    s_nop 0
    v_add_f32 v72, v72, v76
    v_mul_f32 v72, 0x3ae38e39, v72
    v_pk_add_f32 v[168:169], v[144:145], v[72:73] op_sel_hi:[1,0] neg_lo:[0,1] neg_hi:[0,1]
    v_pk_add_f32 v[170:171], v[146:147], v[72:73] op_sel_hi:[1,0] neg_lo:[0,1] neg_hi:[0,1]
    v_pk_add_f32 v[172:173], v[148:149], v[72:73] op_sel_hi:[1,0] neg_lo:[0,1] neg_hi:[0,1]
    v_pk_add_f32 v[174:175], v[150:151], v[72:73] op_sel_hi:[1,0] neg_lo:[0,1] neg_hi:[0,1]
    v_pk_add_f32 v[176:177], v[152:153], v[72:73] op_sel_hi:[1,0] neg_lo:[0,1] neg_hi:[0,1]
    v_pk_add_f32 v[178:179], v[154:155], v[72:73] op_sel_hi:[1,0] neg_lo:[0,1] neg_hi:[0,1]
    v_pk_add_f32 v[180:181], v[156:157], v[72:73] op_sel_hi:[1,0] neg_lo:[0,1] neg_hi:[0,1]
    v_pk_add_f32 v[182:183], v[158:159], v[72:73] op_sel_hi:[1,0] neg_lo:[0,1] neg_hi:[0,1]
    v_pk_add_f32 v[184:185], v[160:161], v[72:73] op_sel_hi:[1,0] neg_lo:[0,1] neg_hi:[0,1]
    v_pk_add_f32 v[186:187], v[162:163], v[72:73] op_sel_hi:[1,0] neg_lo:[0,1] neg_hi:[0,1]
    v_pk_add_f32 v[188:189], v[164:165], v[72:73] op_sel_hi:[1,0] neg_lo:[0,1] neg_hi:[0,1]
    v_pk_add_f32 v[190:191], v[166:167], v[72:73] op_sel_hi:[1,0] neg_lo:[0,1] neg_hi:[0,1]
    v_pk_mul_f32 v[74:75], v[168:169], v[168:169]
    v_pk_mul_f32 v[76:77], v[170:171], v[170:171]
    v_pk_fma_f32 v[74:75], v[172:173], v[172:173], v[74:75]
    v_pk_fma_f32 v[76:77], v[174:175], v[174:175], v[76:77]
    v_pk_fma_f32 v[74:75], v[176:177], v[176:177], v[74:75]
    v_pk_fma_f32 v[76:77], v[178:179], v[178:179], v[76:77]
    v_pk_fma_f32 v[74:75], v[180:181], v[180:181], v[74:75]
    v_pk_fma_f32 v[76:77], v[182:183], v[182:183], v[76:77]
    v_pk_fma_f32 v[74:75], v[184:185], v[184:185], v[74:75]
    v_pk_fma_f32 v[76:77], v[186:187], v[186:187], v[76:77]
    v_pk_fma_f32 v[74:75], v[188:189], v[188:189], v[74:75]
    v_pk_fma_f32 v[76:77], v[190:191], v[190:191], v[76:77]
    v_pk_add_f32 v[74:75], v[74:75], v[76:77]
    v_add_f32 v74, v74, v75
    v_cndmask_b32 v74, 0, v74, vcc
    s_nop 1
    v_add_f32_dpp v74, v74, v74 row_ror:8 row_mask:0xf bank_mask:0xf
    s_nop 1
    v_add_f32_dpp v74, v74, v74 row_ror:4 row_mask:0xf bank_mask:0xf
    s_nop 1
    v_add_f32_dpp v74, v74, v74 row_ror:2 row_mask:0xf bank_mask:0xf
    s_nop 1
    v_add_f32_dpp v74, v74, v74 row_ror:1 row_mask:0xf bank_mask:0xf
    v_mov_b32 v76, v74
    s_nop 1
    v_permlane16_swap_b32 v74, v76
    s_nop 0
    v_add_f32 v74, v74, v76
    v_mul_f32 v74, 0x3ae38e39, v74
    v_cvt_pk_bf16_f32 v76, v72, v74
    v_and_b32 v74, 0xffff0000, v76
    v_lshlrev_b32 v72, 16, v76
    v_add_f32 v74, 0x3727c5ac, v74
    v_cvt_pk_bf16_f32 v74, v74, v74
    v_and_b32 v74, 0xffff0000, v74
    v_sqrt_f32 v74, v74
    v_pk_add_f32 v[168:169], v[144:145], v[72:73] op_sel_hi:[1,0] neg_lo:[0,1] neg_hi:[0,1]
    v_pk_add_f32 v[170:171], v[146:147], v[72:73] op_sel_hi:[1,0] neg_lo:[0,1] neg_hi:[0,1]
    v_pk_add_f32 v[172:173], v[148:149], v[72:73] op_sel_hi:[1,0] neg_lo:[0,1] neg_hi:[0,1]
    v_pk_add_f32 v[174:175], v[150:151], v[72:73] op_sel_hi:[1,0] neg_lo:[0,1] neg_hi:[0,1]
    v_pk_add_f32 v[176:177], v[152:153], v[72:73] op_sel_hi:[1,0] neg_lo:[0,1] neg_hi:[0,1]
    v_pk_add_f32 v[178:179], v[154:155], v[72:73] op_sel_hi:[1,0] neg_lo:[0,1] neg_hi:[0,1]
    v_pk_add_f32 v[180:181], v[156:157], v[72:73] op_sel_hi:[1,0] neg_lo:[0,1] neg_hi:[0,1]
    v_pk_add_f32 v[182:183], v[158:159], v[72:73] op_sel_hi:[1,0] neg_lo:[0,1] neg_hi:[0,1]
    v_pk_add_f32 v[184:185], v[160:161], v[72:73] op_sel_hi:[1,0] neg_lo:[0,1] neg_hi:[0,1]
    v_pk_add_f32 v[186:187], v[162:163], v[72:73] op_sel_hi:[1,0] neg_lo:[0,1] neg_hi:[0,1]
    v_pk_add_f32 v[188:189], v[164:165], v[72:73] op_sel_hi:[1,0] neg_lo:[0,1] neg_hi:[0,1]
    v_pk_add_f32 v[190:191], v[166:167], v[72:73] op_sel_hi:[1,0] neg_lo:[0,1] neg_hi:[0,1]
    v_cvt_pk_bf16_f32 v74, v74, v74
    v_and_b32 v74, 0xffff0000, v74
    v_rcp_f32 v74, v74
    v_cvt_pk_bf16_f32 v108, v168, v169
    v_cvt_pk_bf16_f32 v109, v170, v171
    v_cvt_pk_bf16_f32 v110, v172, v173
    v_cvt_pk_bf16_f32 v111, v174, v175
    v_cvt_pk_bf16_f32 v112, v176, v177
    v_cvt_pk_bf16_f32 v113, v178, v179
    v_cvt_pk_bf16_f32 v114, v180, v181
    v_cvt_pk_bf16_f32 v115, v182, v183
    v_cvt_pk_bf16_f32 v116, v184, v185
    v_cvt_pk_bf16_f32 v117, v186, v187
    v_cvt_pk_bf16_f32 v118, v188, v189
    v_cvt_pk_bf16_f32 v119, v190, v191
    v_lshlrev_b32 v168, 16, v108
    v_and_b32 v169, 0xffff0000, v108
    v_lshlrev_b32 v170, 16, v109
    v_and_b32 v171, 0xffff0000, v109
    v_lshlrev_b32 v172, 16, v110
    v_and_b32 v173, 0xffff0000, v110
    v_lshlrev_b32 v174, 16, v111
    v_and_b32 v175, 0xffff0000, v111
    v_lshlrev_b32 v176, 16, v112
    v_and_b32 v177, 0xffff0000, v112
    v_lshlrev_b32 v178, 16, v113
    v_and_b32 v179, 0xffff0000, v113
    v_lshlrev_b32 v180, 16, v114
    v_and_b32 v181, 0xffff0000, v114
    v_lshlrev_b32 v182, 16, v115
    v_and_b32 v183, 0xffff0000, v115
    v_lshlrev_b32 v184, 16, v116
    v_and_b32 v185, 0xffff0000, v116
    v_lshlrev_b32 v186, 16, v117
    v_and_b32 v187, 0xffff0000, v117
    v_lshlrev_b32 v188, 16, v118
    v_and_b32 v189, 0xffff0000, v118
    v_lshlrev_b32 v190, 16, v119
    v_and_b32 v191, 0xffff0000, v119
    v_pk_mul_f32 v[168:169], v[168:169], v[74:75] op_sel_hi:[1,0]
    v_pk_mul_f32 v[170:171], v[170:171], v[74:75] op_sel_hi:[1,0]
    v_pk_mul_f32 v[172:173], v[172:173], v[74:75] op_sel_hi:[1,0]
    v_pk_mul_f32 v[174:175], v[174:175], v[74:75] op_sel_hi:[1,0]
    v_pk_mul_f32 v[176:177], v[176:177], v[74:75] op_sel_hi:[1,0]
    v_pk_mul_f32 v[178:179], v[178:179], v[74:75] op_sel_hi:[1,0]
    v_pk_mul_f32 v[180:181], v[180:181], v[74:75] op_sel_hi:[1,0]
    v_pk_mul_f32 v[182:183], v[182:183], v[74:75] op_sel_hi:[1,0]
    v_pk_mul_f32 v[184:185], v[184:185], v[74:75] op_sel_hi:[1,0]
    v_pk_mul_f32 v[186:187], v[186:187], v[74:75] op_sel_hi:[1,0]
    v_pk_mul_f32 v[188:189], v[188:189], v[74:75] op_sel_hi:[1,0]
    v_pk_mul_f32 v[190:191], v[190:191], v[74:75] op_sel_hi:[1,0]
    v_cvt_pk_bf16_f32 v108, v168, v169
    v_cvt_pk_bf16_f32 v109, v170, v171
    v_cvt_pk_bf16_f32 v110, v172, v173
    v_cvt_pk_bf16_f32 v111, v174, v175
    v_cvt_pk_bf16_f32 v112, v176, v177
    v_cvt_pk_bf16_f32 v113, v178, v179
    v_cvt_pk_bf16_f32 v114, v180, v181
    v_cvt_pk_bf16_f32 v115, v182, v183
    v_cvt_pk_bf16_f32 v116, v184, v185
    v_cvt_pk_bf16_f32 v117, v186, v187
    v_cvt_pk_bf16_f32 v118, v188, v189
    v_cvt_pk_bf16_f32 v119, v190, v191
    v_lshlrev_b32 v168, 16, v108
    v_and_b32 v169, 0xffff0000, v108
    v_lshlrev_b32 v170, 16, v109
    v_and_b32 v171, 0xffff0000, v109
    v_lshlrev_b32 v172, 16, v110
    v_and_b32 v173, 0xffff0000, v110
    v_lshlrev_b32 v174, 16, v111
    v_and_b32 v175, 0xffff0000, v111
    v_lshlrev_b32 v176, 16, v112
    v_and_b32 v177, 0xffff0000, v112
    v_lshlrev_b32 v178, 16, v113
    v_and_b32 v179, 0xffff0000, v113
    v_lshlrev_b32 v180, 16, v114
    v_and_b32 v181, 0xffff0000, v114
    v_lshlrev_b32 v182, 16, v115
    v_and_b32 v183, 0xffff0000, v115
    v_lshlrev_b32 v184, 16, v116
    v_and_b32 v185, 0xffff0000, v116
    v_lshlrev_b32 v186, 16, v117
    v_and_b32 v187, 0xffff0000, v117
    v_lshlrev_b32 v188, 16, v118
    v_and_b32 v189, 0xffff0000, v118
    v_lshlrev_b32 v190, 16, v119
    v_and_b32 v191, 0xffff0000, v119
    s_mov_b32 s38, 262144
    s_waitcnt vmcnt(2)
    v_xor_b32 v89, s95, v89
    v_xor_b32 v91, s95, v91
    s_waitcnt vmcnt(1)
    v_xor_b32 v93, s95, v93
    v_xor_b32 v95, s95, v95
    v_or3_b32 v89, v89, v91, v93
    v_or_b32 v89, v89, v95
    v_cmp_ne_u32 vcc, 0, v89
    s_cbranch_vccz Lhead_gotm
Lhead_pollm:
    buffer_load_dwordx4 v[88:91], v124, s[24:27], s37 offen sc1
    buffer_load_dwordx4 v[92:95], v125, s[24:27], s37 offen sc1
    s_waitcnt vmcnt(0)
    s_sub_u32 s38, s38, 1
    s_cbranch_scc1 Lhead_gotm
    v_xor_b32 v89, s95, v89
    v_xor_b32 v91, s95, v91
    v_xor_b32 v93, s95, v93
    v_xor_b32 v95, s95, v95
    v_or3_b32 v89, v89, v91, v93
    v_or_b32 v89, v89, v95
    v_cmp_ne_u32 vcc, 0, v89
    s_cbranch_vccnz Lhead_pollm
Lhead_gotm:
    ds_write2_b32 v122, v88, v90 offset0:0 offset1:1
    ds_write2_b32 v123, v92, v94 offset0:0 offset1:1
    s_waitcnt lgkmcnt(0)
    s_barrier
    ds_read_b128 v[144:147], v68 offset:2176
    ds_read_b128 v[148:151], v68 offset:2560
    ds_read_b128 v[152:155], v68 offset:2944
    ds_read_b128 v[156:159], v68 offset:1024
    ds_read_b128 v[160:163], v68 offset:1408
    ds_read_b128 v[164:167], v68 offset:1792
    s_waitcnt lgkmcnt(5)
    v_lshlrev_b32 v192, 16, v144
    v_and_b32 v193, 0xffff0000, v144
    v_lshlrev_b32 v194, 16, v145
    v_and_b32 v195, 0xffff0000, v145
    v_lshlrev_b32 v196, 16, v146
    v_and_b32 v197, 0xffff0000, v146
    v_lshlrev_b32 v198, 16, v147
    v_and_b32 v199, 0xffff0000, v147
    s_waitcnt lgkmcnt(4)
    v_lshlrev_b32 v200, 16, v148
    v_and_b32 v201, 0xffff0000, v148
    v_lshlrev_b32 v202, 16, v149
    v_and_b32 v203, 0xffff0000, v149
    v_lshlrev_b32 v204, 16, v150
    v_and_b32 v205, 0xffff0000, v150
    v_lshlrev_b32 v206, 16, v151
    v_and_b32 v207, 0xffff0000, v151
    s_waitcnt lgkmcnt(3)
    v_lshlrev_b32 v208, 16, v152
    v_and_b32 v209, 0xffff0000, v152
    v_lshlrev_b32 v210, 16, v153
    v_and_b32 v211, 0xffff0000, v153
    v_lshlrev_b32 v212, 16, v154
    v_and_b32 v213, 0xffff0000, v154
    v_lshlrev_b32 v214, 16, v155
    v_and_b32 v215, 0xffff0000, v155
    v_pk_mul_f32 v[168:169], v[168:169], v[192:193]
    v_pk_mul_f32 v[170:171], v[170:171], v[194:195]
    v_pk_mul_f32 v[172:173], v[172:173], v[196:197]
    v_pk_mul_f32 v[174:175], v[174:175], v[198:199]
    v_pk_mul_f32 v[176:177], v[176:177], v[200:201]
    v_pk_mul_f32 v[178:179], v[178:179], v[202:203]
    v_pk_mul_f32 v[180:181], v[180:181], v[204:205]
    v_pk_mul_f32 v[182:183], v[182:183], v[206:207]
    v_pk_mul_f32 v[184:185], v[184:185], v[208:209]
    v_pk_mul_f32 v[186:187], v[186:187], v[210:211]
    v_pk_mul_f32 v[188:189], v[188:189], v[212:213]
    v_pk_mul_f32 v[190:191], v[190:191], v[214:215]
    v_cvt_pk_bf16_f32 v108, v168, v169
    v_cvt_pk_bf16_f32 v109, v170, v171
    v_cvt_pk_bf16_f32 v110, v172, v173
    v_cvt_pk_bf16_f32 v111, v174, v175
    v_cvt_pk_bf16_f32 v112, v176, v177
    v_cvt_pk_bf16_f32 v113, v178, v179
    v_cvt_pk_bf16_f32 v114, v180, v181
    v_cvt_pk_bf16_f32 v115, v182, v183
    v_cvt_pk_bf16_f32 v116, v184, v185
    v_cvt_pk_bf16_f32 v117, v186, v187
    v_cvt_pk_bf16_f32 v118, v188, v189
    v_cvt_pk_bf16_f32 v119, v190, v191
    s_waitcnt lgkmcnt(2)
    v_lshlrev_b32 v216, 16, v156
    v_and_b32 v217, 0xffff0000, v156
    v_lshlrev_b32 v218, 16, v157
    v_and_b32 v219, 0xffff0000, v157
    v_lshlrev_b32 v220, 16, v158
    v_and_b32 v221, 0xffff0000, v158
    v_lshlrev_b32 v222, 16, v159
    v_and_b32 v223, 0xffff0000, v159
    s_waitcnt lgkmcnt(1)
    v_lshlrev_b32 v224, 16, v160
    v_and_b32 v225, 0xffff0000, v160
    v_lshlrev_b32 v226, 16, v161
    v_and_b32 v227, 0xffff0000, v161
    v_lshlrev_b32 v228, 16, v162
    v_and_b32 v229, 0xffff0000, v162
    v_lshlrev_b32 v230, 16, v163
    v_and_b32 v231, 0xffff0000, v163
    s_waitcnt lgkmcnt(0)
    v_lshlrev_b32 v232, 16, v164
    v_and_b32 v233, 0xffff0000, v164
    v_lshlrev_b32 v234, 16, v165
    v_and_b32 v235, 0xffff0000, v165
    v_lshlrev_b32 v236, 16, v166
    v_and_b32 v237, 0xffff0000, v166
    v_lshlrev_b32 v238, 16, v167
    v_and_b32 v239, 0xffff0000, v167
    v_lshlrev_b32 v168, 16, v108
    v_and_b32 v169, 0xffff0000, v108
    v_lshlrev_b32 v170, 16, v109
    v_and_b32 v171, 0xffff0000, v109
    v_lshlrev_b32 v172, 16, v110
    v_and_b32 v173, 0xffff0000, v110
    v_lshlrev_b32 v174, 16, v111
    v_and_b32 v175, 0xffff0000, v111
    v_lshlrev_b32 v176, 16, v112
    v_and_b32 v177, 0xffff0000, v112
    v_lshlrev_b32 v178, 16, v113
    v_and_b32 v179, 0xffff0000, v113
    v_lshlrev_b32 v180, 16, v114
    v_and_b32 v181, 0xffff0000, v114
    v_lshlrev_b32 v182, 16, v115
    v_and_b32 v183, 0xffff0000, v115
    v_lshlrev_b32 v184, 16, v116
    v_and_b32 v185, 0xffff0000, v116
    v_lshlrev_b32 v186, 16, v117
    v_and_b32 v187, 0xffff0000, v117
    v_lshlrev_b32 v188, 16, v118
    v_and_b32 v189, 0xffff0000, v118
    v_lshlrev_b32 v190, 16, v119
    v_and_b32 v191, 0xffff0000, v119
    v_pk_add_f32 v[168:169], v[168:169], v[216:217]
    v_pk_add_f32 v[170:171], v[170:171], v[218:219]
    v_pk_add_f32 v[172:173], v[172:173], v[220:221]
    v_pk_add_f32 v[174:175], v[174:175], v[222:223]
    v_cvt_pk_bf16_f32 v108, v168, v169
    v_cvt_pk_bf16_f32 v109, v170, v171
    v_cvt_pk_bf16_f32 v110, v172, v173
    v_cvt_pk_bf16_f32 v111, v174, v175
    buffer_store_dwordx4 v[108:111], v67, s[24:27], s92 offen offset:0 sc1
    v_pk_add_f32 v[176:177], v[176:177], v[224:225]
    v_pk_add_f32 v[178:179], v[178:179], v[226:227]
    v_pk_add_f32 v[180:181], v[180:181], v[228:229]
    v_pk_add_f32 v[182:183], v[182:183], v[230:231]
    v_cvt_pk_bf16_f32 v112, v176, v177
    v_cvt_pk_bf16_f32 v113, v178, v179
    v_cvt_pk_bf16_f32 v114, v180, v181
    v_cvt_pk_bf16_f32 v115, v182, v183
    buffer_store_dwordx4 v[112:115], v67, s[24:27], s92 offen offset:768 sc1
    v_pk_add_f32 v[184:185], v[184:185], v[232:233]
    v_pk_add_f32 v[186:187], v[186:187], v[234:235]
    v_pk_add_f32 v[188:189], v[188:189], v[236:237]
    v_pk_add_f32 v[190:191], v[190:191], v[238:239]
    v_cvt_pk_bf16_f32 v116, v184, v185
    v_cvt_pk_bf16_f32 v117, v186, v187
    v_cvt_pk_bf16_f32 v118, v188, v189
    v_cvt_pk_bf16_f32 v119, v190, v191
    buffer_store_dwordx4 v[116:119], v67, s[24:27], s92 offen offset:1536 sc1
    s_lshl_b32 s36, s5, 13
    s_add_u32 s36, s36, 8650752
    s_lshl_b32 s37, s4, 9
    s_add_u32 s37, s37, s36
    s_lshl_b32 s38, s3, 7
    s_add_u32 s37, s37, s38
    s_lshl_b32 s38, s3, 11
    s_add_u32 s36, s36, s38
    v_min_u32 v72, 1, v1
    v_lshlrev_b32 v72, 31, v72
    v_and_b32 v73, 15, v1
    v_lshlrev_b32 v73, 7, v73
    v_cmp_gt_u32 vcc, 162, v0
    v_mov_b32 v88, -1
    v_mov_b32 v89, -1
    v_mov_b32 v90, -1
    v_mov_b32 v91, -1
    s_mul_i32 s39, s2, 2592
    s_add_u32 s39, s39, 7864320
    v_lshl_add_u32 v74, v0, 4, s39
    s_lshl_b32 s39, s2, 7
    s_add_u32 s39, s39, 9306112
    v_mov_b32 v75, s39
    v_cndmask_b32 v74, v75, v74, vcc
    s_lshl_b32 s92, s5, 13
    s_add_u32 s92, s92, 8781824
    s_add_u32 s92, s92, s38
    s_lshl_b32 s38, s4, 7
    s_add_u32 s92, s92, s38
    s_getreg_b32 s38, hwreg(HW_REG_XCC_ID, 0, 4)
    s_lshl_b32 s38, s38, 28
    s_xor_b32 s38, s38, s95
    v_mov_b32 v76, s38
    v_mov_b32 v2, v80
    v_mov_b32 v3, v81
    v_mov_b32 v4, v82
    v_mov_b32 v5, v83
    v_mov_b32 v6, v84
    v_mov_b32 v7, v65
    v_and_b32 v126, 31, v1
    v_lshlrev_b32 v126, 2, v126
    s_add_u32 s49, s44, 0
    s_add_u32 m0, s42, 32768
    s_nop 0
    buffer_load_dwordx4 v42, s[16:19], s49 offen lds
    buffer_load_dwordx4 v43, s[16:19], s49 offen offset:1024 lds
    buffer_load_dwordx4 v44, s[16:19], s49 offen offset:2048 lds
    buffer_load_dwordx4 v45, s[16:19], s49 offen offset:3072 lds
    s_add_u32 s49, s44, 256
    s_add_u32 m0, s42, 49152
    s_nop 0
    buffer_load_dwordx4 v42, s[16:19], s49 offen lds
    buffer_load_dwordx4 v43, s[16:19], s49 offen offset:1024 lds
    buffer_load_dwordx4 v44, s[16:19], s49 offen offset:2048 lds
    buffer_load_dwordx4 v45, s[16:19], s49 offen offset:3072 lds
    s_waitcnt vmcnt(8)
    buffer_store_dword v137, v126, s[24:27], s37 offen sc1
    s_add_u32 s49, s44, 524288
    s_add_u32 m0, s42, 65536
    s_nop 0
    buffer_load_dwordx4 v42, s[16:19], s49 offen lds
    buffer_load_dwordx4 v43, s[16:19], s49 offen offset:1024 lds
    buffer_load_dwordx4 v44, s[16:19], s49 offen offset:2048 lds
    buffer_load_dwordx4 v45, s[16:19], s49 offen offset:3072 lds
    s_add_u32 s49, s44, 524544
    s_add_u32 m0, s42, 81920
    s_nop 0
    buffer_load_dwordx4 v42, s[16:19], s49 offen lds
    buffer_load_dwordx4 v43, s[16:19], s49 offen offset:1024 lds
    buffer_load_dwordx4 v44, s[16:19], s49 offen offset:2048 lds
    buffer_load_dwordx4 v45, s[16:19], s49 offen offset:3072 lds
    s_add_u32 s49, s44, 1048576
    s_add_u32 m0, s42, 98304
    s_nop 0
    buffer_load_dwordx4 v42, s[16:19], s49 offen lds
    buffer_load_dwordx4 v43, s[16:19], s49 offen offset:1024 lds
    buffer_load_dwordx4 v44, s[16:19], s49 offen offset:2048 lds
    buffer_load_dwordx4 v45, s[16:19], s49 offen offset:3072 lds
    s_add_u32 s49, s44, 1048832
    s_add_u32 m0, s42, 114688
    s_nop 0
    buffer_load_dwordx4 v42, s[16:19], s49 offen lds
    buffer_load_dwordx4 v43, s[16:19], s49 offen offset:1024 lds
    buffer_load_dwordx4 v44, s[16:19], s49 offen offset:2048 lds
    buffer_load_dwordx4 v45, s[16:19], s49 offen offset:3072 lds
    s_add_u32 s49, s44, 1572864
    s_add_u32 m0, s42, 131072
    s_nop 0
    buffer_load_dwordx4 v42, s[16:19], s49 offen lds
    buffer_load_dwordx4 v43, s[16:19], s49 offen offset:1024 lds
    buffer_load_dwordx4 v44, s[16:19], s49 offen offset:2048 lds
    buffer_load_dwordx4 v45, s[16:19], s49 offen offset:3072 lds
    s_add_u32 s49, s44, 1573120
    s_add_u32 m0, s42, 147456
    s_nop 0
    buffer_load_dwordx4 v42, s[16:19], s49 offen lds
    buffer_load_dwordx4 v43, s[16:19], s49 offen offset:1024 lds
    buffer_load_dwordx4 v44, s[16:19], s49 offen offset:2048 lds
    buffer_load_dwordx4 v45, s[16:19], s49 offen offset:3072 lds
    s_mov_b32 s38, 262144
Lhead_pollh:
    buffer_load_dword v75, v73, s[24:27], s36 offen sc1
    s_sub_u32 s38, s38, 1
    s_cbranch_scc1 Lhead_goth
    s_waitcnt vmcnt(0) lgkmcnt(0)
    v_cmp_ne_u32 vcc, s95, v75
    s_cbranch_vccnz Lhead_pollh
Lhead_goth:
    s_waitcnt vmcnt(0) lgkmcnt(0)
    buffer_load_dwordx4 a[0:3], v51, s[24:27], s46 offen offset:0 sc1
    buffer_load_dwordx4 a[8:11], v51, s[24:27], s46 offen offset:128 sc1
    buffer_load_dwordx4 a[4:7], v51, s[24:27], s43 offen offset:0 sc1
    buffer_load_dwordx4 a[12:15], v51, s[24:27], s43 offen offset:128 sc1
    s_barrier
    ds_read_b64_tr_b16 a[160:161], v12 offset:32768
    ds_read_b64_tr_b16 a[162:163], v12 offset:36864
    ds_read_b64_tr_b16 a[164:165], v12 offset:40960
    ds_read_b64_tr_b16 a[166:167], v12 offset:45056
    ds_read_b64_tr_b16 a[168:169], v13 offset:32768
    ds_read_b64_tr_b16 a[170:171], v13 offset:36864
    ds_read_b64_tr_b16 a[172:173], v13 offset:40960
    ds_read_b64_tr_b16 a[174:175], v13 offset:45056
    ds_read_b64_tr_b16 a[176:177], v14 offset:32768
    ds_read_b64_tr_b16 a[178:179], v14 offset:36864
    ds_read_b64_tr_b16 a[180:181], v14 offset:40960
    ds_read_b64_tr_b16 a[182:183], v14 offset:45056
    buffer_load_dwordx4 a[16:19], v51, s[24:27], s46 offen offset:256 sc1
    buffer_load_dwordx4 a[24:27], v51, s[24:27], s46 offen offset:384 sc1
    buffer_load_dwordx4 a[20:23], v51, s[24:27], s43 offen offset:256 sc1
    buffer_load_dwordx4 a[28:31], v51, s[24:27], s43 offen offset:384 sc1
    s_waitcnt lgkmcnt(10)
    s_waitcnt vmcnt(7)
    v_mfma_f32_16x16x32_bf16 v[128:131], a[160:163], a[0:3], 0
    s_waitcnt vmcnt(6)
    s_waitcnt lgkmcnt(8)
    ds_read_b64_tr_b16 a[184:185], v15 offset:32768
    v_mfma_f32_16x16x32_bf16 v[128:131], a[164:167], a[8:11], v[128:131]
    s_waitcnt vmcnt(4)
    ds_read_b64_tr_b16 a[186:187], v15 offset:36864
    v_mfma_f32_16x16x32_bf16 v[132:135], a[164:167], a[12:15], 0
    ds_read_b64_tr_b16 a[188:189], v15 offset:40960
    v_mfma_f32_16x16x32_bf16 v[132:135], a[160:163], a[4:7], v[132:135]
    s_waitcnt lgkmcnt(9)
    buffer_load_dwordx4 a[32:35], v51, s[24:27], s46 offen offset:512 sc1
    v_mfma_f32_16x16x32_bf16 v[140:143], a[168:171], a[4:7], 0
    s_waitcnt lgkmcnt(7)
    ds_read_b64_tr_b16 a[190:191], v15 offset:45056
    ds_read_b64_tr_b16 a[160:161], v16 offset:32768
    v_mfma_f32_16x16x32_bf16 v[140:143], a[172:175], a[12:15], v[140:143]
    ds_read_b64_tr_b16 a[162:163], v16 offset:36864
    v_mfma_f32_16x16x32_bf16 v[136:139], a[172:175], a[8:11], 0
    ds_read_b64_tr_b16 a[164:165], v16 offset:40960
    v_mfma_f32_16x16x32_bf16 v[136:139], a[168:171], a[0:3], v[136:139]
    s_waitcnt lgkmcnt(9)
    buffer_load_dwordx4 a[40:43], v51, s[24:27], s46 offen offset:640 sc1
    v_mfma_f32_16x16x32_bf16 v[144:147], a[176:179], a[0:3], 0
    s_waitcnt lgkmcnt(7)
    ds_read_b64_tr_b16 a[166:167], v16 offset:45056
    ds_read_b64_tr_b16 a[168:169], v17 offset:32768
    v_mfma_f32_16x16x32_bf16 v[144:147], a[180:183], a[8:11], v[144:147]
    ds_read_b64_tr_b16 a[170:171], v17 offset:36864
    v_mfma_f32_16x16x32_bf16 v[148:151], a[180:183], a[12:15], 0
    ds_read_b64_tr_b16 a[172:173], v17 offset:40960
    v_mfma_f32_16x16x32_bf16 v[148:151], a[176:179], a[4:7], v[148:151]
    s_waitcnt lgkmcnt(9)
    buffer_load_dwordx4 a[36:39], v51, s[24:27], s43 offen offset:512 sc1
    v_mfma_f32_16x16x32_bf16 v[156:159], a[184:187], a[4:7], 0
    s_waitcnt lgkmcnt(7)
    ds_read_b64_tr_b16 a[174:175], v17 offset:45056
    ds_read_b64_tr_b16 a[176:177], v18 offset:32768
    v_mfma_f32_16x16x32_bf16 v[156:159], a[188:191], a[12:15], v[156:159]
    ds_read_b64_tr_b16 a[178:179], v18 offset:36864
    v_mfma_f32_16x16x32_bf16 v[152:155], a[188:191], a[8:11], 0
    ds_read_b64_tr_b16 a[180:181], v18 offset:40960
    v_mfma_f32_16x16x32_bf16 v[152:155], a[184:187], a[0:3], v[152:155]
    s_waitcnt lgkmcnt(9)
    buffer_load_dwordx4 a[44:47], v51, s[24:27], s43 offen offset:640 sc1
    v_mfma_f32_16x16x32_bf16 v[160:163], a[160:163], a[0:3], 0
    s_waitcnt lgkmcnt(7)
    ds_read_b64_tr_b16 a[182:183], v18 offset:45056
    ds_read_b64_tr_b16 a[184:185], v19 offset:32768
    v_mfma_f32_16x16x32_bf16 v[160:163], a[164:167], a[8:11], v[160:163]
    ds_read_b64_tr_b16 a[186:187], v19 offset:36864
    v_mfma_f32_16x16x32_bf16 v[164:167], a[164:167], a[12:15], 0
    ds_read_b64_tr_b16 a[188:189], v19 offset:40960
    v_mfma_f32_16x16x32_bf16 v[164:167], a[160:163], a[4:7], v[164:167]
    s_waitcnt lgkmcnt(9)
    buffer_load_dword v77, v70, s[16:19], s44 offen
    v_mfma_f32_16x16x32_bf16 v[172:175], a[168:171], a[4:7], 0
    s_waitcnt lgkmcnt(7)
    ds_read_b64_tr_b16 a[190:191], v19 offset:45056
    ds_read_b64_tr_b16 a[160:161], v12 offset:49152
    v_mfma_f32_16x16x32_bf16 v[172:175], a[172:175], a[12:15], v[172:175]
    ds_read_b64_tr_b16 a[162:163], v12 offset:53248
    v_mfma_f32_16x16x32_bf16 v[168:171], a[172:175], a[8:11], 0
    ds_read_b64_tr_b16 a[164:165], v12 offset:57344
    v_mfma_f32_16x16x32_bf16 v[168:171], a[168:171], a[0:3], v[168:171]
    s_waitcnt lgkmcnt(9)
    ds_read_b64_tr_b16 a[166:167], v12 offset:61440
    v_mfma_f32_16x16x32_bf16 v[176:179], a[176:179], a[0:3], 0
    s_waitcnt lgkmcnt(8)
    ds_read_b64_tr_b16 a[168:169], v13 offset:49152
    v_mfma_f32_16x16x32_bf16 v[176:179], a[180:183], a[8:11], v[176:179]
    ds_read_b64_tr_b16 a[170:171], v13 offset:53248
    v_mfma_f32_16x16x32_bf16 v[180:183], a[180:183], a[12:15], 0
    ds_read_b64_tr_b16 a[172:173], v13 offset:57344
    v_mfma_f32_16x16x32_bf16 v[180:183], a[176:179], a[4:7], v[180:183]
    s_waitcnt lgkmcnt(9)
    ds_read_b64_tr_b16 a[174:175], v13 offset:61440
    v_mfma_f32_16x16x32_bf16 v[188:191], a[184:187], a[4:7], 0
    s_waitcnt lgkmcnt(8)
    ds_read_b64_tr_b16 a[176:177], v14 offset:49152
    v_mfma_f32_16x16x32_bf16 v[188:191], a[188:191], a[12:15], v[188:191]
    ds_read_b64_tr_b16 a[178:179], v14 offset:53248
    v_mfma_f32_16x16x32_bf16 v[184:187], a[188:191], a[8:11], 0
    ds_read_b64_tr_b16 a[180:181], v14 offset:57344
    v_mfma_f32_16x16x32_bf16 v[184:187], a[184:187], a[0:3], v[184:187]
    s_waitcnt lgkmcnt(9)
    ds_read_b64_tr_b16 a[182:183], v14 offset:61440
    v_mfma_f32_16x16x32_bf16 v[192:195], a[160:163], a[0:3], 0
    s_waitcnt lgkmcnt(8)
    ds_read_b64_tr_b16 a[184:185], v15 offset:49152
    v_mfma_f32_16x16x32_bf16 v[192:195], a[164:167], a[8:11], v[192:195]
    ds_read_b64_tr_b16 a[186:187], v15 offset:53248
    v_mfma_f32_16x16x32_bf16 v[196:199], a[164:167], a[12:15], 0
    ds_read_b64_tr_b16 a[188:189], v15 offset:57344
    v_mfma_f32_16x16x32_bf16 v[196:199], a[160:163], a[4:7], v[196:199]
    s_waitcnt lgkmcnt(9)
    ds_read_b64_tr_b16 a[190:191], v15 offset:61440
    v_mfma_f32_16x16x32_bf16 v[204:207], a[168:171], a[4:7], 0
    s_waitcnt lgkmcnt(8)
    ds_read_b64_tr_b16 a[160:161], v16 offset:49152
    v_mfma_f32_16x16x32_bf16 v[204:207], a[172:175], a[12:15], v[204:207]
    ds_read_b64_tr_b16 a[162:163], v16 offset:53248
    v_mfma_f32_16x16x32_bf16 v[200:203], a[172:175], a[8:11], 0
    ds_read_b64_tr_b16 a[164:165], v16 offset:57344
    v_mfma_f32_16x16x32_bf16 v[200:203], a[168:171], a[0:3], v[200:203]
    s_waitcnt lgkmcnt(9)
    ds_read_b64_tr_b16 a[166:167], v16 offset:61440
    v_mfma_f32_16x16x32_bf16 v[208:211], a[176:179], a[0:3], 0
    s_waitcnt lgkmcnt(8)
    ds_read_b64_tr_b16 a[168:169], v17 offset:49152
    v_mfma_f32_16x16x32_bf16 v[208:211], a[180:183], a[8:11], v[208:211]
    ds_read_b64_tr_b16 a[170:171], v17 offset:53248
    v_mfma_f32_16x16x32_bf16 v[212:215], a[180:183], a[12:15], 0
    ds_read_b64_tr_b16 a[172:173], v17 offset:57344
    v_mfma_f32_16x16x32_bf16 v[212:215], a[176:179], a[4:7], v[212:215]
    s_waitcnt lgkmcnt(9)
    ds_read_b64_tr_b16 a[174:175], v17 offset:61440
    v_mfma_f32_16x16x32_bf16 v[220:223], a[184:187], a[4:7], 0
    s_waitcnt lgkmcnt(8)
    ds_read_b64_tr_b16 a[176:177], v18 offset:49152
    v_mfma_f32_16x16x32_bf16 v[220:223], a[188:191], a[12:15], v[220:223]
Ltour0_0:
    s_cbranch_execz Ltour0_4
    ds_read_b64_tr_b16 a[178:179], v18 offset:53248
    v_mfma_f32_16x16x32_bf16 v[216:219], a[188:191], a[8:11], 0
    ds_read_b64_tr_b16 a[180:181], v18 offset:57344
    v_mfma_f32_16x16x32_bf16 v[216:219], a[184:187], a[0:3], v[216:219]
    s_waitcnt lgkmcnt(9)
    ds_read_b64_tr_b16 a[182:183], v18 offset:61440
    v_mfma_f32_16x16x32_bf16 v[224:227], a[160:163], a[0:3], 0
    s_waitcnt lgkmcnt(8)
    ds_read_b64_tr_b16 a[184:185], v19 offset:49152
    v_mfma_f32_16x16x32_bf16 v[224:227], a[164:167], a[8:11], v[224:227]
    ds_read_b64_tr_b16 a[186:187], v19 offset:53248
    v_mfma_f32_16x16x32_bf16 v[228:231], a[164:167], a[12:15], 0
    ds_read_b64_tr_b16 a[188:189], v19 offset:57344
    v_mfma_f32_16x16x32_bf16 v[228:231], a[160:163], a[4:7], v[228:231]
    s_waitcnt lgkmcnt(9)
    ds_read_b64_tr_b16 a[190:191], v19 offset:61440
    s_barrier
    v_mfma_f32_16x16x32_bf16 v[236:239], a[168:171], a[4:7], 0
    s_waitcnt lgkmcnt(8)
    ds_read_b64_tr_b16 a[160:161], v20 offset:0
    v_mfma_f32_16x16x32_bf16 v[236:239], a[172:175], a[12:15], v[236:239]
    ds_read_b64_tr_b16 a[162:163], v20 offset:4096
    v_mfma_f32_16x16x32_bf16 v[232:235], a[172:175], a[8:11], 0
    ds_read_b64_tr_b16 a[164:165], v20 offset:8192
    v_mfma_f32_16x16x32_bf16 v[232:235], a[168:171], a[0:3], v[232:235]
    s_waitcnt lgkmcnt(9)
    buffer_load_dwordx4 a[48:51], v51, s[24:27], s46 offen offset:768 sc1
    v_mfma_f32_16x16x32_bf16 v[240:243], a[176:179], a[0:3], 0
    s_waitcnt lgkmcnt(7)
    ds_read_b64_tr_b16 a[166:167], v20 offset:12288
    ds_read_b64_tr_b16 a[168:169], v21 offset:0
    v_mfma_f32_16x16x32_bf16 v[240:243], a[180:183], a[8:11], v[240:243]
    ds_read_b64_tr_b16 a[170:171], v21 offset:4096
    v_mfma_f32_16x16x32_bf16 v[244:247], a[180:183], a[12:15], 0
    ds_read_b64_tr_b16 a[172:173], v21 offset:8192
    v_mfma_f32_16x16x32_bf16 v[244:247], a[176:179], a[4:7], v[244:247]
    s_waitcnt lgkmcnt(9)
    buffer_load_dwordx4 a[56:59], v51, s[24:27], s46 offen offset:896 sc1
    v_mfma_f32_16x16x32_bf16 v[252:255], a[184:187], a[4:7], 0
    s_waitcnt lgkmcnt(7)
    ds_read_b64_tr_b16 a[174:175], v21 offset:12288
    ds_read_b64_tr_b16 a[176:177], v22 offset:0
    v_mfma_f32_16x16x32_bf16 v[252:255], a[188:191], a[12:15], v[252:255]
    ds_read_b64_tr_b16 a[178:179], v22 offset:4096
    v_mfma_f32_16x16x32_bf16 v[248:251], a[188:191], a[8:11], 0
    ds_read_b64_tr_b16 a[180:181], v22 offset:8192
    v_mfma_f32_16x16x32_bf16 v[248:251], a[184:187], a[0:3], v[248:251]
    s_waitcnt vmcnt(10)
    s_waitcnt lgkmcnt(9)
    buffer_load_dwordx4 a[52:55], v51, s[24:27], s43 offen offset:768 sc1
    v_mfma_f32_16x16x32_bf16 v[128:131], a[160:163], a[16:19], v[128:131]
    s_waitcnt vmcnt(10)
    s_waitcnt lgkmcnt(7)
    ds_read_b64_tr_b16 a[182:183], v22 offset:12288
    ds_read_b64_tr_b16 a[184:185], v23 offset:0
    v_mfma_f32_16x16x32_bf16 v[128:131], a[164:167], a[24:27], v[128:131]
    s_waitcnt vmcnt(8)
    ds_read_b64_tr_b16 a[186:187], v23 offset:4096
    v_mfma_f32_16x16x32_bf16 v[132:135], a[164:167], a[28:31], v[132:135]
    ds_read_b64_tr_b16 a[188:189], v23 offset:8192
    v_mfma_f32_16x16x32_bf16 v[132:135], a[160:163], a[20:23], v[132:135]
    s_waitcnt lgkmcnt(9)
    buffer_load_dwordx4 a[60:63], v51, s[24:27], s43 offen offset:896 sc1
    v_mfma_f32_16x16x32_bf16 v[140:143], a[168:171], a[20:23], v[140:143]
    s_waitcnt lgkmcnt(7)
    ds_read_b64_tr_b16 a[190:191], v23 offset:12288
    ds_read_b64_tr_b16 a[160:161], v24 offset:0
    v_mfma_f32_16x16x32_bf16 v[140:143], a[172:175], a[28:31], v[140:143]
    ds_read_b64_tr_b16 a[162:163], v24 offset:4096
    v_mfma_f32_16x16x32_bf16 v[136:139], a[172:175], a[24:27], v[136:139]
    ds_read_b64_tr_b16 a[164:165], v24 offset:8192
    v_mfma_f32_16x16x32_bf16 v[136:139], a[168:171], a[16:19], v[136:139]
    s_waitcnt lgkmcnt(9)
    buffer_load_dwordx4 a[64:67], v51, s[24:27], s46 offen offset:1024 sc1
    v_mfma_f32_16x16x32_bf16 v[144:147], a[176:179], a[16:19], v[144:147]
    s_waitcnt lgkmcnt(7)
    ds_read_b64_tr_b16 a[166:167], v24 offset:12288
    ds_read_b64_tr_b16 a[168:169], v25 offset:0
    v_mfma_f32_16x16x32_bf16 v[144:147], a[180:183], a[24:27], v[144:147]
    ds_read_b64_tr_b16 a[170:171], v25 offset:4096
    v_mfma_f32_16x16x32_bf16 v[148:151], a[180:183], a[28:31], v[148:151]
    ds_read_b64_tr_b16 a[172:173], v25 offset:8192
    v_mfma_f32_16x16x32_bf16 v[148:151], a[176:179], a[20:23], v[148:151]
    s_waitcnt lgkmcnt(9)
    buffer_load_dwordx4 a[72:75], v51, s[24:27], s46 offen offset:1152 sc1
    v_mfma_f32_16x16x32_bf16 v[156:159], a[184:187], a[20:23], v[156:159]
    s_waitcnt lgkmcnt(7)
    ds_read_b64_tr_b16 a[174:175], v25 offset:12288
    ds_read_b64_tr_b16 a[176:177], v26 offset:0
    v_mfma_f32_16x16x32_bf16 v[156:159], a[188:191], a[28:31], v[156:159]
    ds_read_b64_tr_b16 a[178:179], v26 offset:4096
    v_mfma_f32_16x16x32_bf16 v[152:155], a[188:191], a[24:27], v[152:155]
    ds_read_b64_tr_b16 a[180:181], v26 offset:8192
    v_mfma_f32_16x16x32_bf16 v[152:155], a[184:187], a[16:19], v[152:155]
    s_waitcnt lgkmcnt(9)
    buffer_load_dwordx4 a[68:71], v51, s[24:27], s43 offen offset:1024 sc1
    v_mfma_f32_16x16x32_bf16 v[160:163], a[160:163], a[16:19], v[160:163]
    s_waitcnt lgkmcnt(7)
    ds_read_b64_tr_b16 a[182:183], v26 offset:12288
    ds_read_b64_tr_b16 a[184:185], v27 offset:0
    v_mfma_f32_16x16x32_bf16 v[160:163], a[164:167], a[24:27], v[160:163]
    ds_read_b64_tr_b16 a[186:187], v27 offset:4096
    v_mfma_f32_16x16x32_bf16 v[164:167], a[164:167], a[28:31], v[164:167]
    ds_read_b64_tr_b16 a[188:189], v27 offset:8192
    v_mfma_f32_16x16x32_bf16 v[164:167], a[160:163], a[20:23], v[164:167]
    s_waitcnt lgkmcnt(9)
    buffer_load_dwordx4 a[76:79], v51, s[24:27], s43 offen offset:1152 sc1
    v_mfma_f32_16x16x32_bf16 v[172:175], a[168:171], a[20:23], v[172:175]
    s_waitcnt lgkmcnt(7)
    ds_read_b64_tr_b16 a[190:191], v27 offset:12288
    ds_read_b64_tr_b16 a[160:161], v20 offset:16384
    v_mfma_f32_16x16x32_bf16 v[172:175], a[172:175], a[28:31], v[172:175]
    ds_read_b64_tr_b16 a[162:163], v20 offset:20480
    v_mfma_f32_16x16x32_bf16 v[168:171], a[172:175], a[24:27], v[168:171]
    ds_read_b64_tr_b16 a[164:165], v20 offset:24576
    v_mfma_f32_16x16x32_bf16 v[168:171], a[168:171], a[16:19], v[168:171]
    s_waitcnt lgkmcnt(9)
    ds_read_b64_tr_b16 a[166:167], v20 offset:28672
    v_mfma_f32_16x16x32_bf16 v[176:179], a[176:179], a[16:19], v[176:179]
    s_waitcnt lgkmcnt(8)
    ds_read_b64_tr_b16 a[168:169], v21 offset:16384
    v_mfma_f32_16x16x32_bf16 v[176:179], a[180:183], a[24:27], v[176:179]
    ds_read_b64_tr_b16 a[170:171], v21 offset:20480
    v_mfma_f32_16x16x32_bf16 v[180:183], a[180:183], a[28:31], v[180:183]
    ds_read_b64_tr_b16 a[172:173], v21 offset:24576
    v_mfma_f32_16x16x32_bf16 v[180:183], a[176:179], a[20:23], v[180:183]
    s_waitcnt lgkmcnt(9)
    ds_read_b64_tr_b16 a[174:175], v21 offset:28672
    v_mfma_f32_16x16x32_bf16 v[188:191], a[184:187], a[20:23], v[188:191]
    s_waitcnt lgkmcnt(8)
    ds_read_b64_tr_b16 a[176:177], v22 offset:16384
    v_mfma_f32_16x16x32_bf16 v[188:191], a[188:191], a[28:31], v[188:191]
    ds_read_b64_tr_b16 a[178:179], v22 offset:20480
    v_mfma_f32_16x16x32_bf16 v[184:187], a[188:191], a[24:27], v[184:187]
    ds_read_b64_tr_b16 a[180:181], v22 offset:24576
    v_mfma_f32_16x16x32_bf16 v[184:187], a[184:187], a[16:19], v[184:187]
    s_waitcnt lgkmcnt(9)
    ds_read_b64_tr_b16 a[182:183], v22 offset:28672
    v_mfma_f32_16x16x32_bf16 v[192:195], a[160:163], a[16:19], v[192:195]
    s_waitcnt lgkmcnt(8)
    ds_read_b64_tr_b16 a[184:185], v23 offset:16384
    v_mfma_f32_16x16x32_bf16 v[192:195], a[164:167], a[24:27], v[192:195]
    ds_read_b64_tr_b16 a[186:187], v23 offset:20480
    v_mfma_f32_16x16x32_bf16 v[196:199], a[164:167], a[28:31], v[196:199]
    ds_read_b64_tr_b16 a[188:189], v23 offset:24576
    v_mfma_f32_16x16x32_bf16 v[196:199], a[160:163], a[20:23], v[196:199]
    s_waitcnt lgkmcnt(9)
    ds_read_b64_tr_b16 a[190:191], v23 offset:28672
    v_mfma_f32_16x16x32_bf16 v[204:207], a[168:171], a[20:23], v[204:207]
    s_waitcnt lgkmcnt(8)
    ds_read_b64_tr_b16 a[160:161], v24 offset:16384
    v_mfma_f32_16x16x32_bf16 v[204:207], a[172:175], a[28:31], v[204:207]
    ds_read_b64_tr_b16 a[162:163], v24 offset:20480
    v_mfma_f32_16x16x32_bf16 v[200:203], a[172:175], a[24:27], v[200:203]
    ds_read_b64_tr_b16 a[164:165], v24 offset:24576
    v_mfma_f32_16x16x32_bf16 v[200:203], a[168:171], a[16:19], v[200:203]
    s_waitcnt lgkmcnt(9)
    ds_read_b64_tr_b16 a[166:167], v24 offset:28672
    v_mfma_f32_16x16x32_bf16 v[208:211], a[176:179], a[16:19], v[208:211]
    s_waitcnt lgkmcnt(8)
    ds_read_b64_tr_b16 a[168:169], v25 offset:16384
    v_mfma_f32_16x16x32_bf16 v[208:211], a[180:183], a[24:27], v[208:211]
    ds_read_b64_tr_b16 a[170:171], v25 offset:20480
    v_mfma_f32_16x16x32_bf16 v[212:215], a[180:183], a[28:31], v[212:215]
    ds_read_b64_tr_b16 a[172:173], v25 offset:24576
    v_mfma_f32_16x16x32_bf16 v[212:215], a[176:179], a[20:23], v[212:215]
    s_waitcnt lgkmcnt(9)
    ds_read_b64_tr_b16 a[174:175], v25 offset:28672
    v_mfma_f32_16x16x32_bf16 v[220:223], a[184:187], a[20:23], v[220:223]
    s_waitcnt lgkmcnt(8)
    ds_read_b64_tr_b16 a[176:177], v26 offset:16384
    v_mfma_f32_16x16x32_bf16 v[220:223], a[188:191], a[28:31], v[220:223]
    ds_read_b64_tr_b16 a[178:179], v26 offset:20480
    v_mfma_f32_16x16x32_bf16 v[216:219], a[188:191], a[24:27], v[216:219]
    ds_read_b64_tr_b16 a[180:181], v26 offset:24576
    v_mfma_f32_16x16x32_bf16 v[216:219], a[184:187], a[16:19], v[216:219]
    s_waitcnt lgkmcnt(9)
    ds_read_b64_tr_b16 a[182:183], v26 offset:28672
    v_mfma_f32_16x16x32_bf16 v[224:227], a[160:163], a[16:19], v[224:227]
    s_waitcnt lgkmcnt(8)
    ds_read_b64_tr_b16 a[184:185], v27 offset:16384
    v_mfma_f32_16x16x32_bf16 v[224:227], a[164:167], a[24:27], v[224:227]
    ds_read_b64_tr_b16 a[186:187], v27 offset:20480
    v_mfma_f32_16x16x32_bf16 v[228:231], a[164:167], a[28:31], v[228:231]
    ds_read_b64_tr_b16 a[188:189], v27 offset:24576
    v_mfma_f32_16x16x32_bf16 v[228:231], a[160:163], a[20:23], v[228:231]
    s_waitcnt lgkmcnt(9)
    ds_read_b64_tr_b16 a[190:191], v27 offset:28672
    s_barrier
    v_mfma_f32_16x16x32_bf16 v[236:239], a[168:171], a[20:23], v[236:239]
    s_waitcnt lgkmcnt(8)
    ds_read_b64_tr_b16 a[160:161], v20 offset:32768
    v_mfma_f32_16x16x32_bf16 v[236:239], a[172:175], a[28:31], v[236:239]
    s_add_u32 s49, s44, 2097152
    ds_read_b64_tr_b16 a[162:163], v20 offset:36864
    v_mfma_f32_16x16x32_bf16 v[232:235], a[172:175], a[24:27], v[232:235]
    s_add_u32 m0, s42, 0
    ds_read_b64_tr_b16 a[164:165], v20 offset:40960
    v_mfma_f32_16x16x32_bf16 v[232:235], a[168:171], a[16:19], v[232:235]
    s_waitcnt lgkmcnt(9)
    buffer_load_dwordx4 v42, s[16:19], s49 offen lds
    v_mfma_f32_16x16x32_bf16 v[240:243], a[176:179], a[16:19], v[240:243]
    s_waitcnt lgkmcnt(7)
    ds_read_b64_tr_b16 a[166:167], v20 offset:45056
    ds_read_b64_tr_b16 a[168:169], v21 offset:32768
    v_mfma_f32_16x16x32_bf16 v[240:243], a[180:183], a[24:27], v[240:243]
    ds_read_b64_tr_b16 a[170:171], v21 offset:36864
    v_mfma_f32_16x16x32_bf16 v[244:247], a[180:183], a[28:31], v[244:247]
    ds_read_b64_tr_b16 a[172:173], v21 offset:40960
    v_mfma_f32_16x16x32_bf16 v[244:247], a[176:179], a[20:23], v[244:247]
    s_waitcnt lgkmcnt(9)
    buffer_load_dwordx4 v43, s[16:19], s49 offen offset:1024 lds
    v_mfma_f32_16x16x32_bf16 v[252:255], a[184:187], a[20:23], v[252:255]
    s_waitcnt lgkmcnt(7)
    ds_read_b64_tr_b16 a[174:175], v21 offset:45056
    ds_read_b64_tr_b16 a[176:177], v22 offset:32768
    v_mfma_f32_16x16x32_bf16 v[252:255], a[188:191], a[28:31], v[252:255]
    ds_read_b64_tr_b16 a[178:179], v22 offset:36864
    v_mfma_f32_16x16x32_bf16 v[248:251], a[188:191], a[24:27], v[248:251]
    ds_read_b64_tr_b16 a[180:181], v22 offset:40960
    v_mfma_f32_16x16x32_bf16 v[248:251], a[184:187], a[16:19], v[248:251]
    s_waitcnt vmcnt(14)
    s_waitcnt lgkmcnt(9)
    buffer_load_dwordx4 v44, s[16:19], s49 offen offset:2048 lds
    v_mfma_f32_16x16x32_bf16 v[128:131], a[160:163], a[32:35], v[128:131]
    s_waitcnt vmcnt(14)
    s_waitcnt lgkmcnt(7)
    ds_read_b64_tr_b16 a[182:183], v22 offset:45056
    ds_read_b64_tr_b16 a[184:185], v23 offset:32768
    v_mfma_f32_16x16x32_bf16 v[128:131], a[164:167], a[40:43], v[128:131]
    s_waitcnt vmcnt(12)
    ds_read_b64_tr_b16 a[186:187], v23 offset:36864
    v_mfma_f32_16x16x32_bf16 v[132:135], a[164:167], a[44:47], v[132:135]
    ds_read_b64_tr_b16 a[188:189], v23 offset:40960
    v_mfma_f32_16x16x32_bf16 v[132:135], a[160:163], a[36:39], v[132:135]
    s_waitcnt lgkmcnt(9)
    buffer_load_dwordx4 v45, s[16:19], s49 offen offset:3072 lds
    v_mfma_f32_16x16x32_bf16 v[140:143], a[168:171], a[36:39], v[140:143]
    s_waitcnt lgkmcnt(7)
    ds_read_b64_tr_b16 a[190:191], v23 offset:45056
    ds_read_b64_tr_b16 a[160:161], v24 offset:32768
    v_mfma_f32_16x16x32_bf16 v[140:143], a[172:175], a[44:47], v[140:143]
    s_add_u32 s49, s44, 2097408
    ds_read_b64_tr_b16 a[162:163], v24 offset:36864
    v_mfma_f32_16x16x32_bf16 v[136:139], a[172:175], a[40:43], v[136:139]
    s_add_u32 m0, s42, 16384
    ds_read_b64_tr_b16 a[164:165], v24 offset:40960
    v_mfma_f32_16x16x32_bf16 v[136:139], a[168:171], a[32:35], v[136:139]
    s_waitcnt lgkmcnt(9)
    buffer_load_dwordx4 v42, s[16:19], s49 offen lds
    v_mfma_f32_16x16x32_bf16 v[144:147], a[176:179], a[32:35], v[144:147]
    s_waitcnt lgkmcnt(7)
    ds_read_b64_tr_b16 a[166:167], v24 offset:45056
    ds_read_b64_tr_b16 a[168:169], v25 offset:32768
    v_mfma_f32_16x16x32_bf16 v[144:147], a[180:183], a[40:43], v[144:147]
    ds_read_b64_tr_b16 a[170:171], v25 offset:36864
    v_mfma_f32_16x16x32_bf16 v[148:151], a[180:183], a[44:47], v[148:151]
    ds_read_b64_tr_b16 a[172:173], v25 offset:40960
    v_mfma_f32_16x16x32_bf16 v[148:151], a[176:179], a[36:39], v[148:151]
    s_waitcnt lgkmcnt(9)
    buffer_load_dwordx4 v43, s[16:19], s49 offen offset:1024 lds
    v_mfma_f32_16x16x32_bf16 v[156:159], a[184:187], a[36:39], v[156:159]
    s_waitcnt lgkmcnt(7)
    ds_read_b64_tr_b16 a[174:175], v25 offset:45056
    ds_read_b64_tr_b16 a[176:177], v26 offset:32768
    v_mfma_f32_16x16x32_bf16 v[156:159], a[188:191], a[44:47], v[156:159]
    ds_read_b64_tr_b16 a[178:179], v26 offset:36864
    v_mfma_f32_16x16x32_bf16 v[152:155], a[188:191], a[40:43], v[152:155]
    ds_read_b64_tr_b16 a[180:181], v26 offset:40960
    v_mfma_f32_16x16x32_bf16 v[152:155], a[184:187], a[32:35], v[152:155]
    s_waitcnt lgkmcnt(9)
    buffer_load_dwordx4 v44, s[16:19], s49 offen offset:2048 lds
    v_mfma_f32_16x16x32_bf16 v[160:163], a[160:163], a[32:35], v[160:163]
    s_waitcnt lgkmcnt(7)
    ds_read_b64_tr_b16 a[182:183], v26 offset:45056
    ds_read_b64_tr_b16 a[184:185], v27 offset:32768
    v_mfma_f32_16x16x32_bf16 v[160:163], a[164:167], a[40:43], v[160:163]
    ds_read_b64_tr_b16 a[186:187], v27 offset:36864
    v_mfma_f32_16x16x32_bf16 v[164:167], a[164:167], a[44:47], v[164:167]
    ds_read_b64_tr_b16 a[188:189], v27 offset:40960
    v_mfma_f32_16x16x32_bf16 v[164:167], a[160:163], a[36:39], v[164:167]
    s_waitcnt lgkmcnt(9)
    buffer_load_dwordx4 v45, s[16:19], s49 offen offset:3072 lds
    v_mfma_f32_16x16x32_bf16 v[172:175], a[168:171], a[36:39], v[172:175]
    s_waitcnt lgkmcnt(7)
    ds_read_b64_tr_b16 a[190:191], v27 offset:45056
    ds_read_b64_tr_b16 a[160:161], v20 offset:49152
    v_mfma_f32_16x16x32_bf16 v[172:175], a[172:175], a[44:47], v[172:175]
    ds_read_b64_tr_b16 a[162:163], v20 offset:53248
    v_mfma_f32_16x16x32_bf16 v[168:171], a[172:175], a[40:43], v[168:171]
    ds_read_b64_tr_b16 a[164:165], v20 offset:57344
    v_mfma_f32_16x16x32_bf16 v[168:171], a[168:171], a[32:35], v[168:171]
    s_waitcnt lgkmcnt(9)
    buffer_load_dwordx4 a[80:83], v51, s[24:27], s46 offen offset:1280 sc1
    v_mfma_f32_16x16x32_bf16 v[176:179], a[176:179], a[32:35], v[176:179]
    s_waitcnt lgkmcnt(7)
    ds_read_b64_tr_b16 a[166:167], v20 offset:61440
    ds_read_b64_tr_b16 a[168:169], v21 offset:49152
    v_mfma_f32_16x16x32_bf16 v[176:179], a[180:183], a[40:43], v[176:179]
    ds_read_b64_tr_b16 a[170:171], v21 offset:53248
    v_mfma_f32_16x16x32_bf16 v[180:183], a[180:183], a[44:47], v[180:183]
    ds_read_b64_tr_b16 a[172:173], v21 offset:57344
    v_mfma_f32_16x16x32_bf16 v[180:183], a[176:179], a[36:39], v[180:183]
    s_waitcnt lgkmcnt(9)
    buffer_load_dwordx4 a[88:91], v51, s[24:27], s46 offen offset:1408 sc1
    v_mfma_f32_16x16x32_bf16 v[188:191], a[184:187], a[36:39], v[188:191]
    s_waitcnt lgkmcnt(7)
    ds_read_b64_tr_b16 a[174:175], v21 offset:61440
    ds_read_b64_tr_b16 a[176:177], v22 offset:49152
    v_mfma_f32_16x16x32_bf16 v[188:191], a[188:191], a[44:47], v[188:191]
    ds_read_b64_tr_b16 a[178:179], v22 offset:53248
    v_mfma_f32_16x16x32_bf16 v[184:187], a[188:191], a[40:43], v[184:187]
    ds_read_b64_tr_b16 a[180:181], v22 offset:57344
    v_mfma_f32_16x16x32_bf16 v[184:187], a[184:187], a[32:35], v[184:187]
    s_waitcnt lgkmcnt(9)
    buffer_load_dwordx4 a[84:87], v51, s[24:27], s43 offen offset:1280 sc1
    v_mfma_f32_16x16x32_bf16 v[192:195], a[160:163], a[32:35], v[192:195]
    s_waitcnt lgkmcnt(7)
    ds_read_b64_tr_b16 a[182:183], v22 offset:61440
    ds_read_b64_tr_b16 a[184:185], v23 offset:49152
    v_mfma_f32_16x16x32_bf16 v[192:195], a[164:167], a[40:43], v[192:195]
    ds_read_b64_tr_b16 a[186:187], v23 offset:53248
    v_mfma_f32_16x16x32_bf16 v[196:199], a[164:167], a[44:47], v[196:199]
    ds_read_b64_tr_b16 a[188:189], v23 offset:57344
    v_mfma_f32_16x16x32_bf16 v[196:199], a[160:163], a[36:39], v[196:199]
    s_waitcnt lgkmcnt(9)
    buffer_load_dwordx4 a[92:95], v51, s[24:27], s43 offen offset:1408 sc1
    v_mfma_f32_16x16x32_bf16 v[204:207], a[168:171], a[36:39], v[204:207]
    s_waitcnt lgkmcnt(7)
    ds_read_b64_tr_b16 a[190:191], v23 offset:61440
    ds_read_b64_tr_b16 a[160:161], v24 offset:49152
    v_mfma_f32_16x16x32_bf16 v[204:207], a[172:175], a[44:47], v[204:207]
    ds_read_b64_tr_b16 a[162:163], v24 offset:53248
    v_mfma_f32_16x16x32_bf16 v[200:203], a[172:175], a[40:43], v[200:203]
    ds_read_b64_tr_b16 a[164:165], v24 offset:57344
    v_mfma_f32_16x16x32_bf16 v[200:203], a[168:171], a[32:35], v[200:203]
    s_waitcnt lgkmcnt(9)
    ds_read_b64_tr_b16 a[166:167], v24 offset:61440
    v_mfma_f32_16x16x32_bf16 v[208:211], a[176:179], a[32:35], v[208:211]
    s_waitcnt lgkmcnt(8)
    ds_read_b64_tr_b16 a[168:169], v25 offset:49152
    v_mfma_f32_16x16x32_bf16 v[208:211], a[180:183], a[40:43], v[208:211]
    ds_read_b64_tr_b16 a[170:171], v25 offset:53248
    v_mfma_f32_16x16x32_bf16 v[212:215], a[180:183], a[44:47], v[212:215]
    ds_read_b64_tr_b16 a[172:173], v25 offset:57344
    v_mfma_f32_16x16x32_bf16 v[212:215], a[176:179], a[36:39], v[212:215]
    s_waitcnt lgkmcnt(9)
    ds_read_b64_tr_b16 a[174:175], v25 offset:61440
    v_mfma_f32_16x16x32_bf16 v[220:223], a[184:187], a[36:39], v[220:223]
    s_waitcnt lgkmcnt(8)
    ds_read_b64_tr_b16 a[176:177], v26 offset:49152
    v_mfma_f32_16x16x32_bf16 v[220:223], a[188:191], a[44:47], v[220:223]
    ds_read_b64_tr_b16 a[178:179], v26 offset:53248
    v_mfma_f32_16x16x32_bf16 v[216:219], a[188:191], a[40:43], v[216:219]
    ds_read_b64_tr_b16 a[180:181], v26 offset:57344
    v_mfma_f32_16x16x32_bf16 v[216:219], a[184:187], a[32:35], v[216:219]
    s_waitcnt lgkmcnt(9)
    ds_read_b64_tr_b16 a[182:183], v26 offset:61440
    v_mfma_f32_16x16x32_bf16 v[224:227], a[160:163], a[32:35], v[224:227]
    s_waitcnt lgkmcnt(8)
    ds_read_b64_tr_b16 a[184:185], v27 offset:49152
    v_mfma_f32_16x16x32_bf16 v[224:227], a[164:167], a[40:43], v[224:227]
    ds_read_b64_tr_b16 a[186:187], v27 offset:53248
    v_mfma_f32_16x16x32_bf16 v[228:231], a[164:167], a[44:47], v[228:231]
    ds_read_b64_tr_b16 a[188:189], v27 offset:57344
    v_mfma_f32_16x16x32_bf16 v[228:231], a[160:163], a[36:39], v[228:231]
    s_waitcnt lgkmcnt(9)
    ds_read_b64_tr_b16 a[190:191], v27 offset:61440
    s_barrier
    v_mfma_f32_16x16x32_bf16 v[236:239], a[168:171], a[36:39], v[236:239]
    s_waitcnt lgkmcnt(8)
    ds_read_b64_tr_b16 a[160:161], v28 offset:0
    v_mfma_f32_16x16x32_bf16 v[236:239], a[172:175], a[44:47], v[236:239]
    s_add_u32 s49, s44, 2621440
    ds_read_b64_tr_b16 a[162:163], v28 offset:4096
    v_mfma_f32_16x16x32_bf16 v[232:235], a[172:175], a[40:43], v[232:235]
    s_add_u32 m0, s42, 32768
    ds_read_b64_tr_b16 a[164:165], v28 offset:8192
    v_mfma_f32_16x16x32_bf16 v[232:235], a[168:171], a[32:35], v[232:235]
    s_waitcnt lgkmcnt(9)
    buffer_load_dwordx4 v42, s[16:19], s49 offen lds
    v_mfma_f32_16x16x32_bf16 v[240:243], a[176:179], a[32:35], v[240:243]
    s_waitcnt lgkmcnt(7)
    ds_read_b64_tr_b16 a[166:167], v28 offset:12288
    ds_read_b64_tr_b16 a[168:169], v29 offset:0
    v_mfma_f32_16x16x32_bf16 v[240:243], a[180:183], a[40:43], v[240:243]
    ds_read_b64_tr_b16 a[170:171], v29 offset:4096
    v_mfma_f32_16x16x32_bf16 v[244:247], a[180:183], a[44:47], v[244:247]
    ds_read_b64_tr_b16 a[172:173], v29 offset:8192
    v_mfma_f32_16x16x32_bf16 v[244:247], a[176:179], a[36:39], v[244:247]
    s_waitcnt lgkmcnt(9)
    buffer_load_dwordx4 v43, s[16:19], s49 offen offset:1024 lds
    v_mfma_f32_16x16x32_bf16 v[252:255], a[184:187], a[36:39], v[252:255]
    s_waitcnt lgkmcnt(7)
    ds_read_b64_tr_b16 a[174:175], v29 offset:12288
    ds_read_b64_tr_b16 a[176:177], v30 offset:0
    v_mfma_f32_16x16x32_bf16 v[252:255], a[188:191], a[44:47], v[252:255]
    ds_read_b64_tr_b16 a[178:179], v30 offset:4096
    v_mfma_f32_16x16x32_bf16 v[248:251], a[188:191], a[40:43], v[248:251]
    ds_read_b64_tr_b16 a[180:181], v30 offset:8192
    v_mfma_f32_16x16x32_bf16 v[248:251], a[184:187], a[32:35], v[248:251]
    s_waitcnt vmcnt(21)
    s_waitcnt lgkmcnt(9)
    buffer_load_dwordx4 v44, s[16:19], s49 offen offset:2048 lds
    v_mfma_f32_16x16x32_bf16 v[128:131], a[160:163], a[48:51], v[128:131]
    s_waitcnt vmcnt(21)
    s_waitcnt lgkmcnt(7)
    ds_read_b64_tr_b16 a[182:183], v30 offset:12288
    ds_read_b64_tr_b16 a[184:185], v31 offset:0
    v_mfma_f32_16x16x32_bf16 v[128:131], a[164:167], a[56:59], v[128:131]
    s_waitcnt vmcnt(19)
    ds_read_b64_tr_b16 a[186:187], v31 offset:4096
    v_mfma_f32_16x16x32_bf16 v[132:135], a[164:167], a[60:63], v[132:135]
    ds_read_b64_tr_b16 a[188:189], v31 offset:8192
    v_mfma_f32_16x16x32_bf16 v[132:135], a[160:163], a[52:55], v[132:135]
    s_waitcnt lgkmcnt(9)
    buffer_load_dwordx4 v45, s[16:19], s49 offen offset:3072 lds
    v_mfma_f32_16x16x32_bf16 v[140:143], a[168:171], a[52:55], v[140:143]
    s_waitcnt lgkmcnt(7)
    ds_read_b64_tr_b16 a[190:191], v31 offset:12288
    ds_read_b64_tr_b16 a[160:161], v32 offset:0
    v_mfma_f32_16x16x32_bf16 v[140:143], a[172:175], a[60:63], v[140:143]
    s_add_u32 s49, s44, 3145728
    ds_read_b64_tr_b16 a[162:163], v32 offset:4096
    v_mfma_f32_16x16x32_bf16 v[136:139], a[172:175], a[56:59], v[136:139]
    s_add_u32 m0, s42, 49152
    ds_read_b64_tr_b16 a[164:165], v32 offset:8192
    v_mfma_f32_16x16x32_bf16 v[136:139], a[168:171], a[48:51], v[136:139]
    s_waitcnt lgkmcnt(9)
    buffer_load_dwordx4 v42, s[16:19], s49 offen lds
    v_mfma_f32_16x16x32_bf16 v[144:147], a[176:179], a[48:51], v[144:147]
    s_waitcnt lgkmcnt(7)
    ds_read_b64_tr_b16 a[166:167], v32 offset:12288
    ds_read_b64_tr_b16 a[168:169], v33 offset:0
    v_mfma_f32_16x16x32_bf16 v[144:147], a[180:183], a[56:59], v[144:147]
    ds_read_b64_tr_b16 a[170:171], v33 offset:4096
    v_mfma_f32_16x16x32_bf16 v[148:151], a[180:183], a[60:63], v[148:151]
    ds_read_b64_tr_b16 a[172:173], v33 offset:8192
    v_mfma_f32_16x16x32_bf16 v[148:151], a[176:179], a[52:55], v[148:151]
    s_waitcnt lgkmcnt(9)
    buffer_load_dwordx4 v43, s[16:19], s49 offen offset:1024 lds
    v_mfma_f32_16x16x32_bf16 v[156:159], a[184:187], a[52:55], v[156:159]
    s_waitcnt lgkmcnt(7)
    ds_read_b64_tr_b16 a[174:175], v33 offset:12288
    ds_read_b64_tr_b16 a[176:177], v34 offset:0
    v_mfma_f32_16x16x32_bf16 v[156:159], a[188:191], a[60:63], v[156:159]
    ds_read_b64_tr_b16 a[178:179], v34 offset:4096
    v_mfma_f32_16x16x32_bf16 v[152:155], a[188:191], a[56:59], v[152:155]
    ds_read_b64_tr_b16 a[180:181], v34 offset:8192
    v_mfma_f32_16x16x32_bf16 v[152:155], a[184:187], a[48:51], v[152:155]
    s_waitcnt lgkmcnt(9)
    buffer_load_dwordx4 v44, s[16:19], s49 offen offset:2048 lds
    v_mfma_f32_16x16x32_bf16 v[160:163], a[160:163], a[48:51], v[160:163]
    s_waitcnt lgkmcnt(7)
    ds_read_b64_tr_b16 a[182:183], v34 offset:12288
    ds_read_b64_tr_b16 a[184:185], v35 offset:0
    v_mfma_f32_16x16x32_bf16 v[160:163], a[164:167], a[56:59], v[160:163]
    ds_read_b64_tr_b16 a[186:187], v35 offset:4096
    v_mfma_f32_16x16x32_bf16 v[164:167], a[164:167], a[60:63], v[164:167]
    ds_read_b64_tr_b16 a[188:189], v35 offset:8192
    v_mfma_f32_16x16x32_bf16 v[164:167], a[160:163], a[52:55], v[164:167]
    s_waitcnt lgkmcnt(9)
    buffer_load_dwordx4 v45, s[16:19], s49 offen offset:3072 lds
    v_mfma_f32_16x16x32_bf16 v[172:175], a[168:171], a[52:55], v[172:175]
    s_waitcnt lgkmcnt(7)
    ds_read_b64_tr_b16 a[190:191], v35 offset:12288
    ds_read_b64_tr_b16 a[160:161], v28 offset:16384
    v_mfma_f32_16x16x32_bf16 v[172:175], a[172:175], a[60:63], v[172:175]
    ds_read_b64_tr_b16 a[162:163], v28 offset:20480
    v_mfma_f32_16x16x32_bf16 v[168:171], a[172:175], a[56:59], v[168:171]
    ds_read_b64_tr_b16 a[164:165], v28 offset:24576
    v_mfma_f32_16x16x32_bf16 v[168:171], a[168:171], a[48:51], v[168:171]
    s_waitcnt lgkmcnt(9)
    buffer_load_dwordx4 a[96:99], v51, s[24:27], s46 offen offset:1536 sc1
    v_mfma_f32_16x16x32_bf16 v[176:179], a[176:179], a[48:51], v[176:179]
    s_waitcnt lgkmcnt(7)
    ds_read_b64_tr_b16 a[166:167], v28 offset:28672
    ds_read_b64_tr_b16 a[168:169], v29 offset:16384
    v_mfma_f32_16x16x32_bf16 v[176:179], a[180:183], a[56:59], v[176:179]
    ds_read_b64_tr_b16 a[170:171], v29 offset:20480
    v_mfma_f32_16x16x32_bf16 v[180:183], a[180:183], a[60:63], v[180:183]
    ds_read_b64_tr_b16 a[172:173], v29 offset:24576
    v_mfma_f32_16x16x32_bf16 v[180:183], a[176:179], a[52:55], v[180:183]
    s_waitcnt lgkmcnt(9)
    buffer_load_dwordx4 a[104:107], v51, s[24:27], s46 offen offset:1664 sc1
    v_mfma_f32_16x16x32_bf16 v[188:191], a[184:187], a[52:55], v[188:191]
    s_waitcnt lgkmcnt(7)
    ds_read_b64_tr_b16 a[174:175], v29 offset:28672
    ds_read_b64_tr_b16 a[176:177], v30 offset:16384
    v_mfma_f32_16x16x32_bf16 v[188:191], a[188:191], a[60:63], v[188:191]
    ds_read_b64_tr_b16 a[178:179], v30 offset:20480
    v_mfma_f32_16x16x32_bf16 v[184:187], a[188:191], a[56:59], v[184:187]
    ds_read_b64_tr_b16 a[180:181], v30 offset:24576
    v_mfma_f32_16x16x32_bf16 v[184:187], a[184:187], a[48:51], v[184:187]
    s_waitcnt lgkmcnt(9)
    buffer_load_dwordx4 a[100:103], v51, s[24:27], s43 offen offset:1536 sc1
    v_mfma_f32_16x16x32_bf16 v[192:195], a[160:163], a[48:51], v[192:195]
    s_waitcnt lgkmcnt(7)
    ds_read_b64_tr_b16 a[182:183], v30 offset:28672
    ds_read_b64_tr_b16 a[184:185], v31 offset:16384
    v_mfma_f32_16x16x32_bf16 v[192:195], a[164:167], a[56:59], v[192:195]
    ds_read_b64_tr_b16 a[186:187], v31 offset:20480
    v_mfma_f32_16x16x32_bf16 v[196:199], a[164:167], a[60:63], v[196:199]
    ds_read_b64_tr_b16 a[188:189], v31 offset:24576
    v_mfma_f32_16x16x32_bf16 v[196:199], a[160:163], a[52:55], v[196:199]
    s_waitcnt lgkmcnt(9)
    buffer_load_dwordx4 a[108:111], v51, s[24:27], s43 offen offset:1664 sc1
    v_mfma_f32_16x16x32_bf16 v[204:207], a[168:171], a[52:55], v[204:207]
    s_waitcnt lgkmcnt(7)
    ds_read_b64_tr_b16 a[190:191], v31 offset:28672
    ds_read_b64_tr_b16 a[160:161], v32 offset:16384
    v_mfma_f32_16x16x32_bf16 v[204:207], a[172:175], a[60:63], v[204:207]
    ds_read_b64_tr_b16 a[162:163], v32 offset:20480
    v_mfma_f32_16x16x32_bf16 v[200:203], a[172:175], a[56:59], v[200:203]
    ds_read_b64_tr_b16 a[164:165], v32 offset:24576
    v_mfma_f32_16x16x32_bf16 v[200:203], a[168:171], a[48:51], v[200:203]
    s_waitcnt lgkmcnt(9)
    ds_read_b64_tr_b16 a[166:167], v32 offset:28672
    v_mfma_f32_16x16x32_bf16 v[208:211], a[176:179], a[48:51], v[208:211]
    s_waitcnt lgkmcnt(8)
    ds_read_b64_tr_b16 a[168:169], v33 offset:16384
    v_mfma_f32_16x16x32_bf16 v[208:211], a[180:183], a[56:59], v[208:211]
    ds_read_b64_tr_b16 a[170:171], v33 offset:20480
    v_mfma_f32_16x16x32_bf16 v[212:215], a[180:183], a[60:63], v[212:215]
    ds_read_b64_tr_b16 a[172:173], v33 offset:24576
    v_mfma_f32_16x16x32_bf16 v[212:215], a[176:179], a[52:55], v[212:215]
    s_waitcnt lgkmcnt(9)
    ds_read_b64_tr_b16 a[174:175], v33 offset:28672
    v_mfma_f32_16x16x32_bf16 v[220:223], a[184:187], a[52:55], v[220:223]
    s_waitcnt lgkmcnt(8)
    ds_read_b64_tr_b16 a[176:177], v34 offset:16384
    v_mfma_f32_16x16x32_bf16 v[220:223], a[188:191], a[60:63], v[220:223]
    ds_read_b64_tr_b16 a[178:179], v34 offset:20480
    v_mfma_f32_16x16x32_bf16 v[216:219], a[188:191], a[56:59], v[216:219]
    ds_read_b64_tr_b16 a[180:181], v34 offset:24576
    v_mfma_f32_16x16x32_bf16 v[216:219], a[184:187], a[48:51], v[216:219]
    s_waitcnt lgkmcnt(9)
    ds_read_b64_tr_b16 a[182:183], v34 offset:28672
    v_mfma_f32_16x16x32_bf16 v[224:227], a[160:163], a[48:51], v[224:227]
    s_waitcnt lgkmcnt(8)
    ds_read_b64_tr_b16 a[184:185], v35 offset:16384
    v_mfma_f32_16x16x32_bf16 v[224:227], a[164:167], a[56:59], v[224:227]
    ds_read_b64_tr_b16 a[186:187], v35 offset:20480
    v_mfma_f32_16x16x32_bf16 v[228:231], a[164:167], a[60:63], v[228:231]
    ds_read_b64_tr_b16 a[188:189], v35 offset:24576
    v_mfma_f32_16x16x32_bf16 v[228:231], a[160:163], a[52:55], v[228:231]
    s_waitcnt lgkmcnt(9)
    ds_read_b64_tr_b16 a[190:191], v35 offset:28672
    s_waitcnt vmcnt(16)
    s_barrier
    v_mfma_f32_16x16x32_bf16 v[236:239], a[168:171], a[52:55], v[236:239]
    s_waitcnt lgkmcnt(8)
    ds_read_b64_tr_b16 a[160:161], v12 offset:0
    v_mfma_f32_16x16x32_bf16 v[236:239], a[172:175], a[60:63], v[236:239]
    s_add_u32 s49, s44, 3670016
    ds_read_b64_tr_b16 a[162:163], v12 offset:4096
    v_mfma_f32_16x16x32_bf16 v[232:235], a[172:175], a[56:59], v[232:235]
    s_add_u32 m0, s42, 65536
    ds_read_b64_tr_b16 a[164:165], v12 offset:8192
    v_mfma_f32_16x16x32_bf16 v[232:235], a[168:171], a[48:51], v[232:235]
    s_waitcnt lgkmcnt(9)
    buffer_load_dwordx4 v42, s[16:19], s49 offen lds
    v_mfma_f32_16x16x32_bf16 v[240:243], a[176:179], a[48:51], v[240:243]
    s_waitcnt lgkmcnt(7)
    ds_read_b64_tr_b16 a[166:167], v12 offset:12288
    ds_read_b64_tr_b16 a[168:169], v13 offset:0
    v_mfma_f32_16x16x32_bf16 v[240:243], a[180:183], a[56:59], v[240:243]
Ltour0_1:
    s_cbranch_execz Ltour0_5
    ds_read_b64_tr_b16 a[170:171], v13 offset:4096
    v_mfma_f32_16x16x32_bf16 v[244:247], a[180:183], a[60:63], v[244:247]
    ds_read_b64_tr_b16 a[172:173], v13 offset:8192
    v_mfma_f32_16x16x32_bf16 v[244:247], a[176:179], a[52:55], v[244:247]
    s_waitcnt lgkmcnt(9)
    buffer_load_dwordx4 v43, s[16:19], s49 offen offset:1024 lds
    v_mfma_f32_16x16x32_bf16 v[252:255], a[184:187], a[52:55], v[252:255]
    s_waitcnt lgkmcnt(7)
    ds_read_b64_tr_b16 a[174:175], v13 offset:12288
    ds_read_b64_tr_b16 a[176:177], v14 offset:0
    v_mfma_f32_16x16x32_bf16 v[252:255], a[188:191], a[60:63], v[252:255]
    ds_read_b64_tr_b16 a[178:179], v14 offset:4096
    v_mfma_f32_16x16x32_bf16 v[248:251], a[188:191], a[56:59], v[248:251]
    ds_read_b64_tr_b16 a[180:181], v14 offset:8192
    v_mfma_f32_16x16x32_bf16 v[248:251], a[184:187], a[48:51], v[248:251]
    s_waitcnt lgkmcnt(9)
    buffer_load_dwordx4 v44, s[16:19], s49 offen offset:2048 lds
    v_mfma_f32_16x16x32_bf16 v[128:131], a[160:163], a[64:67], v[128:131]
    s_waitcnt lgkmcnt(7)
    ds_read_b64_tr_b16 a[182:183], v14 offset:12288
    ds_read_b64_tr_b16 a[184:185], v15 offset:0
    v_mfma_f32_16x16x32_bf16 v[128:131], a[164:167], a[72:75], v[128:131]
    ds_read_b64_tr_b16 a[186:187], v15 offset:4096
    v_mfma_f32_16x16x32_bf16 v[132:135], a[164:167], a[76:79], v[132:135]
    ds_read_b64_tr_b16 a[188:189], v15 offset:8192
    v_mfma_f32_16x16x32_bf16 v[132:135], a[160:163], a[68:71], v[132:135]
    s_waitcnt lgkmcnt(9)
    buffer_load_dwordx4 v45, s[16:19], s49 offen offset:3072 lds
    v_mfma_f32_16x16x32_bf16 v[140:143], a[168:171], a[68:71], v[140:143]
    s_waitcnt lgkmcnt(7)
    ds_read_b64_tr_b16 a[190:191], v15 offset:12288
    ds_read_b64_tr_b16 a[160:161], v16 offset:0
    v_mfma_f32_16x16x32_bf16 v[140:143], a[172:175], a[76:79], v[140:143]
    s_add_u32 s49, s44, 4194304
    ds_read_b64_tr_b16 a[162:163], v16 offset:4096
    v_mfma_f32_16x16x32_bf16 v[136:139], a[172:175], a[72:75], v[136:139]
    s_add_u32 m0, s42, 81920
    ds_read_b64_tr_b16 a[164:165], v16 offset:8192
    v_mfma_f32_16x16x32_bf16 v[136:139], a[168:171], a[64:67], v[136:139]
    s_waitcnt lgkmcnt(9)
    buffer_load_dwordx4 v42, s[16:19], s49 offen lds
    v_mfma_f32_16x16x32_bf16 v[144:147], a[176:179], a[64:67], v[144:147]
    s_waitcnt lgkmcnt(7)
    ds_read_b64_tr_b16 a[166:167], v16 offset:12288
    ds_read_b64_tr_b16 a[168:169], v17 offset:0
    v_mfma_f32_16x16x32_bf16 v[144:147], a[180:183], a[72:75], v[144:147]
    ds_read_b64_tr_b16 a[170:171], v17 offset:4096
    v_mfma_f32_16x16x32_bf16 v[148:151], a[180:183], a[76:79], v[148:151]
    ds_read_b64_tr_b16 a[172:173], v17 offset:8192
    v_mfma_f32_16x16x32_bf16 v[148:151], a[176:179], a[68:71], v[148:151]
    s_waitcnt lgkmcnt(9)
    buffer_load_dwordx4 v43, s[16:19], s49 offen offset:1024 lds
    v_mfma_f32_16x16x32_bf16 v[156:159], a[184:187], a[68:71], v[156:159]
    s_waitcnt lgkmcnt(7)
    ds_read_b64_tr_b16 a[174:175], v17 offset:12288
    ds_read_b64_tr_b16 a[176:177], v18 offset:0
    v_mfma_f32_16x16x32_bf16 v[156:159], a[188:191], a[76:79], v[156:159]
    ds_read_b64_tr_b16 a[178:179], v18 offset:4096
    v_mfma_f32_16x16x32_bf16 v[152:155], a[188:191], a[72:75], v[152:155]
    ds_read_b64_tr_b16 a[180:181], v18 offset:8192
    v_mfma_f32_16x16x32_bf16 v[152:155], a[184:187], a[64:67], v[152:155]
    s_waitcnt lgkmcnt(9)
    buffer_load_dwordx4 v44, s[16:19], s49 offen offset:2048 lds
    v_mfma_f32_16x16x32_bf16 v[160:163], a[160:163], a[64:67], v[160:163]
    s_waitcnt lgkmcnt(7)
    ds_read_b64_tr_b16 a[182:183], v18 offset:12288
    ds_read_b64_tr_b16 a[184:185], v19 offset:0
    v_mfma_f32_16x16x32_bf16 v[160:163], a[164:167], a[72:75], v[160:163]
    ds_read_b64_tr_b16 a[186:187], v19 offset:4096
    v_mfma_f32_16x16x32_bf16 v[164:167], a[164:167], a[76:79], v[164:167]
    ds_read_b64_tr_b16 a[188:189], v19 offset:8192
    v_mfma_f32_16x16x32_bf16 v[164:167], a[160:163], a[68:71], v[164:167]
    s_waitcnt lgkmcnt(9)
    buffer_load_dwordx4 v45, s[16:19], s49 offen offset:3072 lds
    v_mfma_f32_16x16x32_bf16 v[172:175], a[168:171], a[68:71], v[172:175]
    s_waitcnt lgkmcnt(7)
    ds_read_b64_tr_b16 a[190:191], v19 offset:12288
    ds_read_b64_tr_b16 a[160:161], v12 offset:16384
    v_mfma_f32_16x16x32_bf16 v[172:175], a[172:175], a[76:79], v[172:175]
    ds_read_b64_tr_b16 a[162:163], v12 offset:20480
    v_mfma_f32_16x16x32_bf16 v[168:171], a[172:175], a[72:75], v[168:171]
    ds_read_b64_tr_b16 a[164:165], v12 offset:24576
    v_mfma_f32_16x16x32_bf16 v[168:171], a[168:171], a[64:67], v[168:171]
    s_waitcnt lgkmcnt(9)
    buffer_load_dwordx4 a[112:115], v51, s[24:27], s46 offen offset:1792 sc1
    v_mfma_f32_16x16x32_bf16 v[176:179], a[176:179], a[64:67], v[176:179]
    s_waitcnt lgkmcnt(7)
    ds_read_b64_tr_b16 a[166:167], v12 offset:28672
    ds_read_b64_tr_b16 a[168:169], v13 offset:16384
    v_mfma_f32_16x16x32_bf16 v[176:179], a[180:183], a[72:75], v[176:179]
    ds_read_b64_tr_b16 a[170:171], v13 offset:20480
    v_mfma_f32_16x16x32_bf16 v[180:183], a[180:183], a[76:79], v[180:183]
    ds_read_b64_tr_b16 a[172:173], v13 offset:24576
    v_mfma_f32_16x16x32_bf16 v[180:183], a[176:179], a[68:71], v[180:183]
    s_waitcnt lgkmcnt(9)
    buffer_load_dwordx4 a[120:123], v51, s[24:27], s46 offen offset:1920 sc1
    v_mfma_f32_16x16x32_bf16 v[188:191], a[184:187], a[68:71], v[188:191]
    s_waitcnt lgkmcnt(7)
    ds_read_b64_tr_b16 a[174:175], v13 offset:28672
    ds_read_b64_tr_b16 a[176:177], v14 offset:16384
    v_mfma_f32_16x16x32_bf16 v[188:191], a[188:191], a[76:79], v[188:191]
    ds_read_b64_tr_b16 a[178:179], v14 offset:20480
    v_mfma_f32_16x16x32_bf16 v[184:187], a[188:191], a[72:75], v[184:187]
    ds_read_b64_tr_b16 a[180:181], v14 offset:24576
    v_mfma_f32_16x16x32_bf16 v[184:187], a[184:187], a[64:67], v[184:187]
    s_waitcnt lgkmcnt(9)
    buffer_load_dwordx4 a[116:119], v51, s[24:27], s43 offen offset:1792 sc1
    v_mfma_f32_16x16x32_bf16 v[192:195], a[160:163], a[64:67], v[192:195]
    s_waitcnt lgkmcnt(7)
    ds_read_b64_tr_b16 a[182:183], v14 offset:28672
    ds_read_b64_tr_b16 a[184:185], v15 offset:16384
    v_mfma_f32_16x16x32_bf16 v[192:195], a[164:167], a[72:75], v[192:195]
    ds_read_b64_tr_b16 a[186:187], v15 offset:20480
    v_mfma_f32_16x16x32_bf16 v[196:199], a[164:167], a[76:79], v[196:199]
    ds_read_b64_tr_b16 a[188:189], v15 offset:24576
    v_mfma_f32_16x16x32_bf16 v[196:199], a[160:163], a[68:71], v[196:199]
    s_waitcnt lgkmcnt(9)
    buffer_load_dwordx4 a[124:127], v51, s[24:27], s43 offen offset:1920 sc1
    v_mfma_f32_16x16x32_bf16 v[204:207], a[168:171], a[68:71], v[204:207]
    s_waitcnt lgkmcnt(7)
    ds_read_b64_tr_b16 a[190:191], v15 offset:28672
    ds_read_b64_tr_b16 a[160:161], v16 offset:16384
    v_mfma_f32_16x16x32_bf16 v[204:207], a[172:175], a[76:79], v[204:207]
    ds_read_b64_tr_b16 a[162:163], v16 offset:20480
    v_mfma_f32_16x16x32_bf16 v[200:203], a[172:175], a[72:75], v[200:203]
    ds_read_b64_tr_b16 a[164:165], v16 offset:24576
    v_mfma_f32_16x16x32_bf16 v[200:203], a[168:171], a[64:67], v[200:203]
    s_waitcnt lgkmcnt(9)
    ds_read_b64_tr_b16 a[166:167], v16 offset:28672
    v_mfma_f32_16x16x32_bf16 v[208:211], a[176:179], a[64:67], v[208:211]
    s_waitcnt lgkmcnt(8)
    ds_read_b64_tr_b16 a[168:169], v17 offset:16384
    v_mfma_f32_16x16x32_bf16 v[208:211], a[180:183], a[72:75], v[208:211]
    ds_read_b64_tr_b16 a[170:171], v17 offset:20480
    v_mfma_f32_16x16x32_bf16 v[212:215], a[180:183], a[76:79], v[212:215]
    ds_read_b64_tr_b16 a[172:173], v17 offset:24576
    v_mfma_f32_16x16x32_bf16 v[212:215], a[176:179], a[68:71], v[212:215]
    s_waitcnt lgkmcnt(9)
    ds_read_b64_tr_b16 a[174:175], v17 offset:28672
    v_mfma_f32_16x16x32_bf16 v[220:223], a[184:187], a[68:71], v[220:223]
    s_waitcnt lgkmcnt(8)
    ds_read_b64_tr_b16 a[176:177], v18 offset:16384
    v_mfma_f32_16x16x32_bf16 v[220:223], a[188:191], a[76:79], v[220:223]
    ds_read_b64_tr_b16 a[178:179], v18 offset:20480
    v_mfma_f32_16x16x32_bf16 v[216:219], a[188:191], a[72:75], v[216:219]
    ds_read_b64_tr_b16 a[180:181], v18 offset:24576
    v_mfma_f32_16x16x32_bf16 v[216:219], a[184:187], a[64:67], v[216:219]
    s_waitcnt lgkmcnt(9)
    ds_read_b64_tr_b16 a[182:183], v18 offset:28672
    v_mfma_f32_16x16x32_bf16 v[224:227], a[160:163], a[64:67], v[224:227]
    s_waitcnt lgkmcnt(8)
    ds_read_b64_tr_b16 a[184:185], v19 offset:16384
    v_mfma_f32_16x16x32_bf16 v[224:227], a[164:167], a[72:75], v[224:227]
    ds_read_b64_tr_b16 a[186:187], v19 offset:20480
    v_mfma_f32_16x16x32_bf16 v[228:231], a[164:167], a[76:79], v[228:231]
    ds_read_b64_tr_b16 a[188:189], v19 offset:24576
    v_mfma_f32_16x16x32_bf16 v[228:231], a[160:163], a[68:71], v[228:231]
    s_waitcnt lgkmcnt(9)
    ds_read_b64_tr_b16 a[190:191], v19 offset:28672
    s_waitcnt vmcnt(16)
    s_barrier
    v_mfma_f32_16x16x32_bf16 v[236:239], a[168:171], a[68:71], v[236:239]
    s_waitcnt lgkmcnt(8)
    ds_read_b64_tr_b16 a[160:161], v12 offset:32768
    v_mfma_f32_16x16x32_bf16 v[236:239], a[172:175], a[76:79], v[236:239]
    s_add_u32 s49, s44, 2621696
    ds_read_b64_tr_b16 a[162:163], v12 offset:36864
    v_mfma_f32_16x16x32_bf16 v[232:235], a[172:175], a[72:75], v[232:235]
    s_add_u32 m0, s42, 98304
    ds_read_b64_tr_b16 a[164:165], v12 offset:40960
    v_mfma_f32_16x16x32_bf16 v[232:235], a[168:171], a[64:67], v[232:235]
    s_waitcnt lgkmcnt(9)
    buffer_load_dwordx4 v42, s[16:19], s49 offen lds
    v_mfma_f32_16x16x32_bf16 v[240:243], a[176:179], a[64:67], v[240:243]
    s_waitcnt lgkmcnt(7)
    ds_read_b64_tr_b16 a[166:167], v12 offset:45056
    ds_read_b64_tr_b16 a[168:169], v13 offset:32768
    v_mfma_f32_16x16x32_bf16 v[240:243], a[180:183], a[72:75], v[240:243]
    ds_read_b64_tr_b16 a[170:171], v13 offset:36864
    v_mfma_f32_16x16x32_bf16 v[244:247], a[180:183], a[76:79], v[244:247]
    ds_read_b64_tr_b16 a[172:173], v13 offset:40960
    v_mfma_f32_16x16x32_bf16 v[244:247], a[176:179], a[68:71], v[244:247]
    s_waitcnt lgkmcnt(9)
    buffer_load_dwordx4 v43, s[16:19], s49 offen offset:1024 lds
    v_mfma_f32_16x16x32_bf16 v[252:255], a[184:187], a[68:71], v[252:255]
    s_waitcnt lgkmcnt(7)
    ds_read_b64_tr_b16 a[174:175], v13 offset:45056
    ds_read_b64_tr_b16 a[176:177], v14 offset:32768
    v_mfma_f32_16x16x32_bf16 v[252:255], a[188:191], a[76:79], v[252:255]
    ds_read_b64_tr_b16 a[178:179], v14 offset:36864
    v_mfma_f32_16x16x32_bf16 v[248:251], a[188:191], a[72:75], v[248:251]
    ds_read_b64_tr_b16 a[180:181], v14 offset:40960
    v_mfma_f32_16x16x32_bf16 v[248:251], a[184:187], a[64:67], v[248:251]
    s_waitcnt lgkmcnt(9)
    buffer_load_dwordx4 v44, s[16:19], s49 offen offset:2048 lds
    v_mfma_f32_16x16x32_bf16 v[128:131], a[160:163], a[80:83], v[128:131]
    s_waitcnt lgkmcnt(7)
    ds_read_b64_tr_b16 a[182:183], v14 offset:45056
    ds_read_b64_tr_b16 a[184:185], v15 offset:32768
    v_mfma_f32_16x16x32_bf16 v[128:131], a[164:167], a[88:91], v[128:131]
    ds_read_b64_tr_b16 a[186:187], v15 offset:36864
    v_mfma_f32_16x16x32_bf16 v[132:135], a[164:167], a[92:95], v[132:135]
    ds_read_b64_tr_b16 a[188:189], v15 offset:40960
    v_mfma_f32_16x16x32_bf16 v[132:135], a[160:163], a[84:87], v[132:135]
    s_waitcnt lgkmcnt(9)
    buffer_load_dwordx4 v45, s[16:19], s49 offen offset:3072 lds
    v_mfma_f32_16x16x32_bf16 v[140:143], a[168:171], a[84:87], v[140:143]
    s_waitcnt lgkmcnt(7)
    ds_read_b64_tr_b16 a[190:191], v15 offset:45056
    ds_read_b64_tr_b16 a[160:161], v16 offset:32768
    v_mfma_f32_16x16x32_bf16 v[140:143], a[172:175], a[92:95], v[140:143]
    s_add_u32 s49, s44, 3145984
    ds_read_b64_tr_b16 a[162:163], v16 offset:36864
    v_mfma_f32_16x16x32_bf16 v[136:139], a[172:175], a[88:91], v[136:139]
    s_add_u32 m0, s42, 114688
    ds_read_b64_tr_b16 a[164:165], v16 offset:40960
    v_mfma_f32_16x16x32_bf16 v[136:139], a[168:171], a[80:83], v[136:139]
    s_waitcnt lgkmcnt(9)
    buffer_load_dwordx4 v42, s[16:19], s49 offen lds
    v_mfma_f32_16x16x32_bf16 v[144:147], a[176:179], a[80:83], v[144:147]
    s_waitcnt lgkmcnt(7)
    ds_read_b64_tr_b16 a[166:167], v16 offset:45056
    ds_read_b64_tr_b16 a[168:169], v17 offset:32768
    v_mfma_f32_16x16x32_bf16 v[144:147], a[180:183], a[88:91], v[144:147]
    ds_read_b64_tr_b16 a[170:171], v17 offset:36864
    v_mfma_f32_16x16x32_bf16 v[148:151], a[180:183], a[92:95], v[148:151]
    ds_read_b64_tr_b16 a[172:173], v17 offset:40960
    v_mfma_f32_16x16x32_bf16 v[148:151], a[176:179], a[84:87], v[148:151]
    s_waitcnt lgkmcnt(9)
    buffer_load_dwordx4 v43, s[16:19], s49 offen offset:1024 lds
    v_mfma_f32_16x16x32_bf16 v[156:159], a[184:187], a[84:87], v[156:159]
    s_waitcnt lgkmcnt(7)
    ds_read_b64_tr_b16 a[174:175], v17 offset:45056
    ds_read_b64_tr_b16 a[176:177], v18 offset:32768
    v_mfma_f32_16x16x32_bf16 v[156:159], a[188:191], a[92:95], v[156:159]
    ds_read_b64_tr_b16 a[178:179], v18 offset:36864
    v_mfma_f32_16x16x32_bf16 v[152:155], a[188:191], a[88:91], v[152:155]
    ds_read_b64_tr_b16 a[180:181], v18 offset:40960
    v_mfma_f32_16x16x32_bf16 v[152:155], a[184:187], a[80:83], v[152:155]
    s_waitcnt lgkmcnt(9)
    buffer_load_dwordx4 v44, s[16:19], s49 offen offset:2048 lds
    v_mfma_f32_16x16x32_bf16 v[160:163], a[160:163], a[80:83], v[160:163]
    s_waitcnt lgkmcnt(7)
    ds_read_b64_tr_b16 a[182:183], v18 offset:45056
    ds_read_b64_tr_b16 a[184:185], v19 offset:32768
    v_mfma_f32_16x16x32_bf16 v[160:163], a[164:167], a[88:91], v[160:163]
    ds_read_b64_tr_b16 a[186:187], v19 offset:36864
    v_mfma_f32_16x16x32_bf16 v[164:167], a[164:167], a[92:95], v[164:167]
    ds_read_b64_tr_b16 a[188:189], v19 offset:40960
    v_mfma_f32_16x16x32_bf16 v[164:167], a[160:163], a[84:87], v[164:167]
    s_waitcnt lgkmcnt(9)
    buffer_load_dwordx4 v45, s[16:19], s49 offen offset:3072 lds
    v_mfma_f32_16x16x32_bf16 v[172:175], a[168:171], a[84:87], v[172:175]
    s_waitcnt lgkmcnt(7)
    ds_read_b64_tr_b16 a[190:191], v19 offset:45056
    ds_read_b64_tr_b16 a[160:161], v12 offset:49152
    v_mfma_f32_16x16x32_bf16 v[172:175], a[172:175], a[92:95], v[172:175]
    ds_read_b64_tr_b16 a[162:163], v12 offset:53248
    v_mfma_f32_16x16x32_bf16 v[168:171], a[172:175], a[88:91], v[168:171]
    ds_read_b64_tr_b16 a[164:165], v12 offset:57344
    v_mfma_f32_16x16x32_bf16 v[168:171], a[168:171], a[80:83], v[168:171]
    s_waitcnt lgkmcnt(9)
    buffer_load_dwordx4 a[128:131], v51, s[24:27], s46 offen offset:2048 sc1
    v_mfma_f32_16x16x32_bf16 v[176:179], a[176:179], a[80:83], v[176:179]
    s_waitcnt lgkmcnt(7)
    ds_read_b64_tr_b16 a[166:167], v12 offset:61440
    ds_read_b64_tr_b16 a[168:169], v13 offset:49152
    v_mfma_f32_16x16x32_bf16 v[176:179], a[180:183], a[88:91], v[176:179]
    ds_read_b64_tr_b16 a[170:171], v13 offset:53248
    v_mfma_f32_16x16x32_bf16 v[180:183], a[180:183], a[92:95], v[180:183]
    ds_read_b64_tr_b16 a[172:173], v13 offset:57344
    v_mfma_f32_16x16x32_bf16 v[180:183], a[176:179], a[84:87], v[180:183]
    s_waitcnt lgkmcnt(9)
    buffer_load_dwordx4 a[136:139], v51, s[24:27], s46 offen offset:2176 sc1
    v_mfma_f32_16x16x32_bf16 v[188:191], a[184:187], a[84:87], v[188:191]
    s_waitcnt lgkmcnt(7)
    ds_read_b64_tr_b16 a[174:175], v13 offset:61440
    ds_read_b64_tr_b16 a[176:177], v14 offset:49152
    v_mfma_f32_16x16x32_bf16 v[188:191], a[188:191], a[92:95], v[188:191]
    ds_read_b64_tr_b16 a[178:179], v14 offset:53248
    v_mfma_f32_16x16x32_bf16 v[184:187], a[188:191], a[88:91], v[184:187]
    ds_read_b64_tr_b16 a[180:181], v14 offset:57344
    v_mfma_f32_16x16x32_bf16 v[184:187], a[184:187], a[80:83], v[184:187]
    s_waitcnt vmcnt(25)
    s_waitcnt lgkmcnt(9)
    buffer_load_dwordx4 a[132:135], v51, s[24:27], s43 offen offset:2048 sc1
    v_mfma_f32_16x16x32_bf16 v[128:131], a[160:163], a[96:99], v[128:131]
    s_waitcnt vmcnt(25)
    s_waitcnt lgkmcnt(7)
    ds_read_b64_tr_b16 a[182:183], v14 offset:61440
    ds_read_b64_tr_b16 a[184:185], v15 offset:49152
    v_mfma_f32_16x16x32_bf16 v[128:131], a[164:167], a[104:107], v[128:131]
    s_waitcnt vmcnt(23)
    ds_read_b64_tr_b16 a[186:187], v15 offset:53248
    v_mfma_f32_16x16x32_bf16 v[132:135], a[164:167], a[108:111], v[132:135]
    ds_read_b64_tr_b16 a[188:189], v15 offset:57344
    v_mfma_f32_16x16x32_bf16 v[132:135], a[160:163], a[100:103], v[132:135]
    s_waitcnt lgkmcnt(9)
    buffer_load_dwordx4 a[140:143], v51, s[24:27], s43 offen offset:2176 sc1
    v_mfma_f32_16x16x32_bf16 v[140:143], a[168:171], a[100:103], v[140:143]
    s_waitcnt lgkmcnt(7)
    ds_read_b64_tr_b16 a[190:191], v15 offset:61440
    ds_read_b64_tr_b16 a[160:161], v16 offset:49152
    v_mfma_f32_16x16x32_bf16 v[140:143], a[172:175], a[108:111], v[140:143]
    ds_read_b64_tr_b16 a[162:163], v16 offset:53248
    v_mfma_f32_16x16x32_bf16 v[136:139], a[172:175], a[104:107], v[136:139]
    ds_read_b64_tr_b16 a[164:165], v16 offset:57344
    v_mfma_f32_16x16x32_bf16 v[136:139], a[168:171], a[96:99], v[136:139]
    s_waitcnt lgkmcnt(9)
    ds_read_b64_tr_b16 a[166:167], v16 offset:61440
    v_mfma_f32_16x16x32_bf16 v[144:147], a[176:179], a[96:99], v[144:147]
    s_waitcnt lgkmcnt(8)
    ds_read_b64_tr_b16 a[168:169], v17 offset:49152
    v_mfma_f32_16x16x32_bf16 v[144:147], a[180:183], a[104:107], v[144:147]
    ds_read_b64_tr_b16 a[170:171], v17 offset:53248
    v_mfma_f32_16x16x32_bf16 v[148:151], a[180:183], a[108:111], v[148:151]
    ds_read_b64_tr_b16 a[172:173], v17 offset:57344
    v_mfma_f32_16x16x32_bf16 v[148:151], a[176:179], a[100:103], v[148:151]
    s_waitcnt lgkmcnt(9)
    ds_read_b64_tr_b16 a[174:175], v17 offset:61440
    v_mfma_f32_16x16x32_bf16 v[156:159], a[184:187], a[100:103], v[156:159]
    s_waitcnt lgkmcnt(8)
    ds_read_b64_tr_b16 a[176:177], v18 offset:49152
    v_mfma_f32_16x16x32_bf16 v[156:159], a[188:191], a[108:111], v[156:159]
    ds_read_b64_tr_b16 a[178:179], v18 offset:53248
    v_mfma_f32_16x16x32_bf16 v[152:155], a[188:191], a[104:107], v[152:155]
    ds_read_b64_tr_b16 a[180:181], v18 offset:57344
    v_mfma_f32_16x16x32_bf16 v[152:155], a[184:187], a[96:99], v[152:155]
    s_waitcnt lgkmcnt(9)
    ds_read_b64_tr_b16 a[182:183], v18 offset:61440
    v_mfma_f32_16x16x32_bf16 v[160:163], a[160:163], a[96:99], v[160:163]
    s_waitcnt lgkmcnt(8)
    ds_read_b64_tr_b16 a[184:185], v19 offset:49152
    v_mfma_f32_16x16x32_bf16 v[160:163], a[164:167], a[104:107], v[160:163]
    ds_read_b64_tr_b16 a[186:187], v19 offset:53248
    v_mfma_f32_16x16x32_bf16 v[164:167], a[164:167], a[108:111], v[164:167]
    ds_read_b64_tr_b16 a[188:189], v19 offset:57344
    v_mfma_f32_16x16x32_bf16 v[164:167], a[160:163], a[100:103], v[164:167]
    s_waitcnt lgkmcnt(9)
    ds_read_b64_tr_b16 a[190:191], v19 offset:61440
    s_waitcnt vmcnt(16)
    s_barrier
    v_mfma_f32_16x16x32_bf16 v[172:175], a[168:171], a[100:103], v[172:175]
    s_waitcnt lgkmcnt(8)
    ds_read_b64_tr_b16 a[160:161], v20 offset:0
    v_mfma_f32_16x16x32_bf16 v[172:175], a[172:175], a[108:111], v[172:175]
    s_add_u32 s49, s44, 3670272
    ds_read_b64_tr_b16 a[162:163], v20 offset:4096
    v_mfma_f32_16x16x32_bf16 v[168:171], a[172:175], a[104:107], v[168:171]
    s_add_u32 m0, s42, 131072
    ds_read_b64_tr_b16 a[164:165], v20 offset:8192
    v_mfma_f32_16x16x32_bf16 v[168:171], a[168:171], a[96:99], v[168:171]
    s_waitcnt lgkmcnt(9)
    buffer_load_dwordx4 v42, s[16:19], s49 offen lds
    v_mfma_f32_16x16x32_bf16 v[176:179], a[176:179], a[96:99], v[176:179]
    s_waitcnt lgkmcnt(7)
    ds_read_b64_tr_b16 a[166:167], v20 offset:12288
    ds_read_b64_tr_b16 a[168:169], v21 offset:0
    v_mfma_f32_16x16x32_bf16 v[176:179], a[180:183], a[104:107], v[176:179]
    ds_read_b64_tr_b16 a[170:171], v21 offset:4096
    v_mfma_f32_16x16x32_bf16 v[180:183], a[180:183], a[108:111], v[180:183]
    ds_read_b64_tr_b16 a[172:173], v21 offset:8192
    v_mfma_f32_16x16x32_bf16 v[180:183], a[176:179], a[100:103], v[180:183]
    s_waitcnt lgkmcnt(9)
    buffer_load_dwordx4 v43, s[16:19], s49 offen offset:1024 lds
    v_mfma_f32_16x16x32_bf16 v[188:191], a[184:187], a[100:103], v[188:191]
    s_waitcnt lgkmcnt(7)
    ds_read_b64_tr_b16 a[174:175], v21 offset:12288
    ds_read_b64_tr_b16 a[176:177], v22 offset:0
    v_mfma_f32_16x16x32_bf16 v[188:191], a[188:191], a[108:111], v[188:191]
    ds_read_b64_tr_b16 a[178:179], v22 offset:4096
    v_mfma_f32_16x16x32_bf16 v[184:187], a[188:191], a[104:107], v[184:187]
    ds_read_b64_tr_b16 a[180:181], v22 offset:8192
    v_mfma_f32_16x16x32_bf16 v[184:187], a[184:187], a[96:99], v[184:187]
    s_waitcnt vmcnt(17)
    s_waitcnt lgkmcnt(9)
    buffer_load_dwordx4 v44, s[16:19], s49 offen offset:2048 lds
    v_mfma_f32_16x16x32_bf16 v[128:131], a[160:163], a[112:115], v[128:131]
    s_waitcnt vmcnt(17)
    s_waitcnt lgkmcnt(7)
    ds_read_b64_tr_b16 a[182:183], v22 offset:12288
    ds_read_b64_tr_b16 a[184:185], v23 offset:0
    v_mfma_f32_16x16x32_bf16 v[128:131], a[164:167], a[120:123], v[128:131]
    s_waitcnt vmcnt(15)
    ds_read_b64_tr_b16 a[186:187], v23 offset:4096
    v_mfma_f32_16x16x32_bf16 v[132:135], a[164:167], a[124:127], v[132:135]
    ds_read_b64_tr_b16 a[188:189], v23 offset:8192
    v_mfma_f32_16x16x32_bf16 v[132:135], a[160:163], a[116:119], v[132:135]
    s_waitcnt lgkmcnt(9)
    buffer_load_dwordx4 v45, s[16:19], s49 offen offset:3072 lds
    v_mfma_f32_16x16x32_bf16 v[140:143], a[168:171], a[116:119], v[140:143]
    s_waitcnt lgkmcnt(7)
    ds_read_b64_tr_b16 a[190:191], v23 offset:12288
    ds_read_b64_tr_b16 a[160:161], v24 offset:0
    v_mfma_f32_16x16x32_bf16 v[140:143], a[172:175], a[124:127], v[140:143]
    s_add_u32 s49, s44, 4194560
    ds_read_b64_tr_b16 a[162:163], v24 offset:4096
    v_mfma_f32_16x16x32_bf16 v[136:139], a[172:175], a[120:123], v[136:139]
    s_add_u32 m0, s42, 147456
    ds_read_b64_tr_b16 a[164:165], v24 offset:8192
    v_mfma_f32_16x16x32_bf16 v[136:139], a[168:171], a[112:115], v[136:139]
    s_waitcnt lgkmcnt(9)
    buffer_load_dwordx4 v42, s[16:19], s49 offen lds
    v_mfma_f32_16x16x32_bf16 v[144:147], a[176:179], a[112:115], v[144:147]
    s_waitcnt lgkmcnt(7)
    ds_read_b64_tr_b16 a[166:167], v24 offset:12288
    ds_read_b64_tr_b16 a[168:169], v25 offset:0
    v_mfma_f32_16x16x32_bf16 v[144:147], a[180:183], a[120:123], v[144:147]
    ds_read_b64_tr_b16 a[170:171], v25 offset:4096
    v_mfma_f32_16x16x32_bf16 v[148:151], a[180:183], a[124:127], v[148:151]
    ds_read_b64_tr_b16 a[172:173], v25 offset:8192
    v_mfma_f32_16x16x32_bf16 v[148:151], a[176:179], a[116:119], v[148:151]
    s_waitcnt lgkmcnt(9)
    buffer_load_dwordx4 v43, s[16:19], s49 offen offset:1024 lds
    v_mfma_f32_16x16x32_bf16 v[156:159], a[184:187], a[116:119], v[156:159]
    s_waitcnt lgkmcnt(7)
    ds_read_b64_tr_b16 a[174:175], v25 offset:12288
    ds_read_b64_tr_b16 a[176:177], v26 offset:0
    v_mfma_f32_16x16x32_bf16 v[156:159], a[188:191], a[124:127], v[156:159]
    ds_read_b64_tr_b16 a[178:179], v26 offset:4096
    v_mfma_f32_16x16x32_bf16 v[152:155], a[188:191], a[120:123], v[152:155]
    ds_read_b64_tr_b16 a[180:181], v26 offset:8192
    v_mfma_f32_16x16x32_bf16 v[152:155], a[184:187], a[112:115], v[152:155]
    s_waitcnt lgkmcnt(9)
    buffer_load_dwordx4 v44, s[16:19], s49 offen offset:2048 lds
    v_mfma_f32_16x16x32_bf16 v[160:163], a[160:163], a[112:115], v[160:163]
    s_waitcnt lgkmcnt(7)
    ds_read_b64_tr_b16 a[182:183], v26 offset:12288
    ds_read_b64_tr_b16 a[184:185], v27 offset:0
    v_mfma_f32_16x16x32_bf16 v[160:163], a[164:167], a[120:123], v[160:163]
    ds_read_b64_tr_b16 a[186:187], v27 offset:4096
    v_mfma_f32_16x16x32_bf16 v[164:167], a[164:167], a[124:127], v[164:167]
    ds_read_b64_tr_b16 a[188:189], v27 offset:8192
    v_mfma_f32_16x16x32_bf16 v[164:167], a[160:163], a[116:119], v[164:167]
    s_waitcnt lgkmcnt(9)
    buffer_load_dwordx4 v45, s[16:19], s49 offen offset:3072 lds
    v_mfma_f32_16x16x32_bf16 v[172:175], a[168:171], a[116:119], v[172:175]
    s_waitcnt lgkmcnt(7)
    ds_read_b64_tr_b16 a[190:191], v27 offset:12288
    ds_read_b64_tr_b16 a[160:161], v20 offset:16384
    v_mfma_f32_16x16x32_bf16 v[172:175], a[172:175], a[124:127], v[172:175]
    ds_read_b64_tr_b16 a[162:163], v20 offset:20480
    v_mfma_f32_16x16x32_bf16 v[168:171], a[172:175], a[120:123], v[168:171]
    ds_read_b64_tr_b16 a[164:165], v20 offset:24576
    v_mfma_f32_16x16x32_bf16 v[168:171], a[168:171], a[112:115], v[168:171]
    s_waitcnt lgkmcnt(9)
    buffer_load_dword v78, v120, s[8:11], 0 offen
    v_mfma_f32_16x16x32_bf16 v[176:179], a[176:179], a[112:115], v[176:179]
    s_waitcnt lgkmcnt(7)
    ds_read_b64_tr_b16 a[166:167], v20 offset:28672
    ds_read_b64_tr_b16 a[168:169], v21 offset:16384
    v_mfma_f32_16x16x32_bf16 v[176:179], a[180:183], a[120:123], v[176:179]
    ds_read_b64_tr_b16 a[170:171], v21 offset:20480
    v_mfma_f32_16x16x32_bf16 v[180:183], a[180:183], a[124:127], v[180:183]
    ds_read_b64_tr_b16 a[172:173], v21 offset:24576
    v_mfma_f32_16x16x32_bf16 v[180:183], a[176:179], a[116:119], v[180:183]
    s_waitcnt lgkmcnt(9)
    buffer_load_dword v79, v121, s[12:15], 0 offen
    v_mfma_f32_16x16x32_bf16 v[188:191], a[184:187], a[116:119], v[188:191]
    s_waitcnt lgkmcnt(7)
    ds_read_b64_tr_b16 a[174:175], v21 offset:28672
    ds_read_b64_tr_b16 a[176:177], v22 offset:16384
    v_mfma_f32_16x16x32_bf16 v[188:191], a[188:191], a[124:127], v[188:191]
    ds_read_b64_tr_b16 a[178:179], v22 offset:20480
    v_mfma_f32_16x16x32_bf16 v[184:187], a[188:191], a[120:123], v[184:187]
    s_mov_b32 s36, 1040356334
    ds_read_b64_tr_b16 a[180:181], v22 offset:24576
    v_mfma_f32_16x16x32_bf16 v[184:187], a[184:187], a[112:115], v[184:187]
    s_waitcnt vmcnt(13)
    s_waitcnt lgkmcnt(9)
    buffer_store_dword v76, v72, s[24:27], s92 offen offset:12 sc1
    v_mfma_f32_16x16x32_bf16 v[128:131], a[160:163], a[128:131], v[128:131]
    s_waitcnt vmcnt(13)
    s_waitcnt lgkmcnt(7)
    ds_read_b64_tr_b16 a[182:183], v22 offset:28672
    ds_read_b64_tr_b16 a[184:185], v23 offset:16384
    v_mfma_f32_16x16x32_bf16 v[128:131], a[164:167], a[136:139], v[128:131]
    s_waitcnt vmcnt(11)
    ds_read_b64_tr_b16 a[186:187], v23 offset:20480
    v_mfma_f32_16x16x32_bf16 v[132:135], a[164:167], a[140:143], v[132:135]
    ds_read_b64_tr_b16 a[188:189], v23 offset:24576
    v_mfma_f32_16x16x32_bf16 v[132:135], a[160:163], a[132:135], v[132:135]
    s_waitcnt lgkmcnt(9)
    buffer_store_dwordx4 v[88:91], v74, s[24:27], 0 offen sc1
    v_mfma_f32_16x16x32_bf16 v[140:143], a[168:171], a[132:135], v[140:143]
    s_waitcnt lgkmcnt(7)
    ds_read_b64_tr_b16 a[190:191], v23 offset:28672
    ds_read_b64_tr_b16 a[160:161], v24 offset:16384
    v_mfma_f32_16x16x32_bf16 v[140:143], a[172:175], a[140:143], v[140:143]
    ds_read_b64_tr_b16 a[162:163], v24 offset:20480
    v_mfma_f32_16x16x32_bf16 v[136:139], a[172:175], a[136:139], v[136:139]
    ds_read_b64_tr_b16 a[164:165], v24 offset:24576
    v_mfma_f32_16x16x32_bf16 v[136:139], a[168:171], a[128:131], v[136:139]
    s_waitcnt lgkmcnt(9)
    ds_read_b64_tr_b16 a[166:167], v24 offset:28672
    v_mfma_f32_16x16x32_bf16 v[144:147], a[176:179], a[128:131], v[144:147]
    s_waitcnt lgkmcnt(8)
    ds_read_b64_tr_b16 a[168:169], v25 offset:16384
    v_mfma_f32_16x16x32_bf16 v[144:147], a[180:183], a[136:139], v[144:147]
    ds_read_b64_tr_b16 a[170:171], v25 offset:20480
    v_mfma_f32_16x16x32_bf16 v[148:151], a[180:183], a[140:143], v[148:151]
    ds_read_b64_tr_b16 a[172:173], v25 offset:24576
    v_mfma_f32_16x16x32_bf16 v[148:151], a[176:179], a[132:135], v[148:151]
    s_waitcnt lgkmcnt(9)
    ds_read_b64_tr_b16 a[174:175], v25 offset:28672
    v_mul_f32 v128, s36, v128
    v_mfma_f32_16x16x32_bf16 v[156:159], a[184:187], a[132:135], v[156:159]
    s_waitcnt lgkmcnt(8)
    ds_read_b64_tr_b16 a[176:177], v26 offset:16384
    v_mul_f32 v129, s36, v129
    v_mfma_f32_16x16x32_bf16 v[156:159], a[188:191], a[140:143], v[156:159]
    ds_read_b64_tr_b16 a[178:179], v26 offset:20480
    v_mul_f32 v130, s36, v130
    v_mfma_f32_16x16x32_bf16 v[152:155], a[188:191], a[136:139], v[152:155]
    ds_read_b64_tr_b16 a[180:181], v26 offset:24576
    v_mul_f32 v131, s36, v131
    v_mfma_f32_16x16x32_bf16 v[152:155], a[184:187], a[128:131], v[152:155]
    s_waitcnt lgkmcnt(9)
    ds_read_b64_tr_b16 a[182:183], v26 offset:28672
    v_mul_f32 v136, s36, v136
    v_mfma_f32_16x16x32_bf16 v[160:163], a[160:163], a[128:131], v[160:163]
    s_waitcnt lgkmcnt(8)
    ds_read_b64_tr_b16 a[184:185], v27 offset:16384
    v_mul_f32 v137, s36, v137
    v_mfma_f32_16x16x32_bf16 v[160:163], a[164:167], a[136:139], v[160:163]
    ds_read_b64_tr_b16 a[186:187], v27 offset:20480
    v_mul_f32 v138, s36, v138
    v_mfma_f32_16x16x32_bf16 v[164:167], a[164:167], a[140:143], v[164:167]
    ds_read_b64_tr_b16 a[188:189], v27 offset:24576
    v_mul_f32 v139, s36, v139
    v_mfma_f32_16x16x32_bf16 v[164:167], a[160:163], a[132:135], v[164:167]
    s_waitcnt lgkmcnt(9)
    ds_read_b64_tr_b16 a[190:191], v27 offset:28672
    v_mul_f32 v132, s36, v132
    s_barrier
    v_mfma_f32_16x16x32_bf16 v[172:175], a[168:171], a[132:135], v[172:175]
    s_waitcnt lgkmcnt(8)
    ds_read_b64_tr_b16 a[160:161], v20 offset:32768
    v_mul_f32 v133, s36, v133
    v_mfma_f32_16x16x32_bf16 v[172:175], a[172:175], a[140:143], v[172:175]
    ds_read_b64_tr_b16 a[162:163], v20 offset:36864
    v_mul_f32 v134, s36, v134
    v_mfma_f32_16x16x32_bf16 v[168:171], a[172:175], a[136:139], v[168:171]
    s_add_u32 m0, s42, 0
    ds_read_b64_tr_b16 a[164:165], v20 offset:40960
    v_mul_f32 v135, s36, v135
    v_mfma_f32_16x16x32_bf16 v[168:171], a[168:171], a[128:131], v[168:171]
    s_waitcnt lgkmcnt(9)
    buffer_load_dwordx4 v36, s[8:11], s40 offen lds
    v_mfma_f32_16x16x32_bf16 v[176:179], a[176:179], a[128:131], v[176:179]
    s_waitcnt lgkmcnt(7)
    ds_read_b64_tr_b16 a[166:167], v20 offset:45056
    ds_read_b64_tr_b16 a[168:169], v21 offset:32768
    v_mfma_f32_16x16x32_bf16 v[176:179], a[180:183], a[136:139], v[176:179]
    ds_read_b64_tr_b16 a[170:171], v21 offset:36864
    v_mul_f32 v140, s36, v140
    v_mfma_f32_16x16x32_bf16 v[180:183], a[180:183], a[140:143], v[180:183]
    ds_read_b64_tr_b16 a[172:173], v21 offset:40960
    v_mul_f32 v141, s36, v141
    v_mfma_f32_16x16x32_bf16 v[180:183], a[176:179], a[132:135], v[180:183]
    s_waitcnt lgkmcnt(9)
    buffer_load_dwordx4 v37, s[8:11], s40 offen offset:1024 lds
    v_mfma_f32_16x16x32_bf16 v[188:191], a[184:187], a[132:135], v[188:191]
    s_waitcnt lgkmcnt(7)
    ds_read_b64_tr_b16 a[174:175], v21 offset:45056
    ds_read_b64_tr_b16 a[176:177], v22 offset:32768
    v_mfma_f32_16x16x32_bf16 v[188:191], a[188:191], a[140:143], v[188:191]
    ds_read_b64_tr_b16 a[178:179], v22 offset:36864
    v_mul_f32 v142, s36, v142
    v_mfma_f32_16x16x32_bf16 v[184:187], a[188:191], a[136:139], v[184:187]
    ds_read_b64_tr_b16 a[180:181], v22 offset:40960
    v_mul_f32 v143, s36, v143
    v_mfma_f32_16x16x32_bf16 v[184:187], a[184:187], a[128:131], v[184:187]
    s_waitcnt lgkmcnt(9)
    buffer_load_dwordx4 v38, s[8:11], s40 offen offset:2048 lds
    v_mfma_f32_16x16x32_bf16 v[192:195], a[160:163], a[80:83], v[192:195]
    s_waitcnt lgkmcnt(7)
    ds_read_b64_tr_b16 a[182:183], v22 offset:45056
    ds_read_b64_tr_b16 a[184:185], v23 offset:32768
    v_mfma_f32_16x16x32_bf16 v[192:195], a[164:167], a[88:91], v[192:195]
Ltour0_2:
    s_cbranch_execz Ltour0_6
    ds_read_b64_tr_b16 a[186:187], v23 offset:36864
    v_cvt_pk_bf16_f32 v64, v128, v129
    v_mfma_f32_16x16x32_bf16 v[196:199], a[164:167], a[92:95], v[196:199]
    ds_read_b64_tr_b16 a[188:189], v23 offset:40960
    v_cvt_pk_bf16_f32 v65, v130, v131
    v_mfma_f32_16x16x32_bf16 v[196:199], a[160:163], a[84:87], v[196:199]
    s_waitcnt lgkmcnt(9)
    buffer_load_dwordx4 v39, s[8:11], s40 offen offset:3072 lds
    v_mfma_f32_16x16x32_bf16 v[204:207], a[168:171], a[84:87], v[204:207]
    s_waitcnt lgkmcnt(7)
    s_add_u32 s40, s40, 16384
    ds_read_b64_tr_b16 a[190:191], v23 offset:45056
    ds_read_b64_tr_b16 a[160:161], v24 offset:32768
    v_mfma_f32_16x16x32_bf16 v[204:207], a[172:175], a[92:95], v[204:207]
    ds_read_b64_tr_b16 a[162:163], v24 offset:36864
    v_cvt_pk_bf16_f32 v66, v136, v137
    v_mfma_f32_16x16x32_bf16 v[200:203], a[172:175], a[88:91], v[200:203]
    s_add_u32 m0, s42, 16384
    ds_read_b64_tr_b16 a[164:165], v24 offset:40960
    v_cvt_pk_bf16_f32 v67, v138, v139
    v_mfma_f32_16x16x32_bf16 v[200:203], a[168:171], a[80:83], v[200:203]
    s_waitcnt lgkmcnt(9)
    buffer_load_dwordx4 v36, s[8:11], s40 offen lds
    v_mfma_f32_16x16x32_bf16 v[208:211], a[176:179], a[80:83], v[208:211]
    s_waitcnt lgkmcnt(7)
    ds_read_b64_tr_b16 a[166:167], v24 offset:45056
    ds_read_b64_tr_b16 a[168:169], v25 offset:32768
    v_mfma_f32_16x16x32_bf16 v[208:211], a[180:183], a[88:91], v[208:211]
    ds_read_b64_tr_b16 a[170:171], v25 offset:36864
    v_cvt_pk_bf16_f32 v80, v132, v133
    v_mfma_f32_16x16x32_bf16 v[212:215], a[180:183], a[92:95], v[212:215]
    ds_read_b64_tr_b16 a[172:173], v25 offset:40960
    v_cvt_pk_bf16_f32 v81, v134, v135
    v_mfma_f32_16x16x32_bf16 v[212:215], a[176:179], a[84:87], v[212:215]
    s_waitcnt lgkmcnt(9)
    buffer_load_dwordx4 v37, s[8:11], s40 offen offset:1024 lds
    v_mfma_f32_16x16x32_bf16 v[220:223], a[184:187], a[84:87], v[220:223]
    s_waitcnt lgkmcnt(7)
    ds_read_b64_tr_b16 a[174:175], v25 offset:45056
    ds_read_b64_tr_b16 a[176:177], v26 offset:32768
    v_mfma_f32_16x16x32_bf16 v[220:223], a[188:191], a[92:95], v[220:223]
    ds_read_b64_tr_b16 a[178:179], v26 offset:36864
    v_cvt_pk_bf16_f32 v82, v140, v141
    v_mfma_f32_16x16x32_bf16 v[216:219], a[188:191], a[88:91], v[216:219]
    ds_read_b64_tr_b16 a[180:181], v26 offset:40960
    v_cvt_pk_bf16_f32 v83, v142, v143
    v_mfma_f32_16x16x32_bf16 v[216:219], a[184:187], a[80:83], v[216:219]
    s_waitcnt lgkmcnt(9)
    buffer_load_dwordx4 v38, s[8:11], s40 offen offset:2048 lds
    v_mfma_f32_16x16x32_bf16 v[224:227], a[160:163], a[80:83], v[224:227]
    s_waitcnt lgkmcnt(7)
    ds_read_b64_tr_b16 a[182:183], v26 offset:45056
    ds_read_b64_tr_b16 a[184:185], v27 offset:32768
    v_mfma_f32_16x16x32_bf16 v[224:227], a[164:167], a[88:91], v[224:227]
    ds_read_b64_tr_b16 a[186:187], v27 offset:36864
    v_permlane32_swap_b32 v64, v66
    v_mfma_f32_16x16x32_bf16 v[228:231], a[164:167], a[92:95], v[228:231]
    ds_read_b64_tr_b16 a[188:189], v27 offset:40960
    v_permlane32_swap_b32 v65, v67
    v_mfma_f32_16x16x32_bf16 v[228:231], a[160:163], a[84:87], v[228:231]
    s_waitcnt lgkmcnt(9)
    buffer_load_dwordx4 v39, s[8:11], s40 offen offset:3072 lds
    v_mfma_f32_16x16x32_bf16 v[236:239], a[168:171], a[84:87], v[236:239]
    s_waitcnt lgkmcnt(7)
    s_add_u32 s40, s40, 16384
    ds_read_b64_tr_b16 a[190:191], v27 offset:45056
    ds_read_b64_tr_b16 a[160:161], v20 offset:49152
    v_mfma_f32_16x16x32_bf16 v[236:239], a[172:175], a[92:95], v[236:239]
    ds_read_b64_tr_b16 a[162:163], v20 offset:53248
    v_permlane32_swap_b32 v80, v82
    v_mfma_f32_16x16x32_bf16 v[232:235], a[172:175], a[88:91], v[232:235]
    ds_read_b64_tr_b16 a[164:165], v20 offset:57344
    v_permlane32_swap_b32 v81, v83
    v_mfma_f32_16x16x32_bf16 v[232:235], a[168:171], a[80:83], v[232:235]
    s_waitcnt lgkmcnt(9)
    ds_read_b64_tr_b16 a[166:167], v20 offset:61440
    v_permlane16_swap_b32 v64, v66
    v_mfma_f32_16x16x32_bf16 v[240:243], a[176:179], a[80:83], v[240:243]
    s_waitcnt lgkmcnt(8)
    ds_read_b64_tr_b16 a[168:169], v21 offset:49152
    v_permlane16_swap_b32 v65, v67
    v_mfma_f32_16x16x32_bf16 v[240:243], a[180:183], a[88:91], v[240:243]
    ds_read_b64_tr_b16 a[170:171], v21 offset:53248
    v_permlane16_swap_b32 v80, v82
    v_mfma_f32_16x16x32_bf16 v[244:247], a[180:183], a[92:95], v[244:247]
    ds_read_b64_tr_b16 a[172:173], v21 offset:57344
    v_permlane16_swap_b32 v81, v83
    v_mfma_f32_16x16x32_bf16 v[244:247], a[176:179], a[84:87], v[244:247]
    s_waitcnt lgkmcnt(9)
    ds_read_b64_tr_b16 a[174:175], v21 offset:61440
    v_mul_f32 v144, s36, v144
    v_mfma_f32_16x16x32_bf16 v[252:255], a[184:187], a[84:87], v[252:255]
    s_waitcnt lgkmcnt(8)
    ds_read_b64_tr_b16 a[176:177], v22 offset:49152
    v_mul_f32 v145, s36, v145
    v_mfma_f32_16x16x32_bf16 v[252:255], a[188:191], a[92:95], v[252:255]
    ds_read_b64_tr_b16 a[178:179], v22 offset:53248
    v_mul_f32 v146, s36, v146
    v_mfma_f32_16x16x32_bf16 v[248:251], a[188:191], a[88:91], v[248:251]
    ds_read_b64_tr_b16 a[180:181], v22 offset:57344
    v_mul_f32 v147, s36, v147
    v_mfma_f32_16x16x32_bf16 v[248:251], a[184:187], a[80:83], v[248:251]
    s_waitcnt lgkmcnt(9)
    ds_read_b64_tr_b16 a[182:183], v22 offset:61440
    v_mul_f32 v152, s36, v152
    v_mfma_f32_16x16x32_bf16 v[192:195], a[160:163], a[96:99], v[192:195]
    s_waitcnt lgkmcnt(8)
    ds_read_b64_tr_b16 a[184:185], v23 offset:49152
    v_mul_f32 v153, s36, v153
    v_mfma_f32_16x16x32_bf16 v[192:195], a[164:167], a[104:107], v[192:195]
    ds_read_b64_tr_b16 a[186:187], v23 offset:53248
    v_mul_f32 v154, s36, v154
    v_mfma_f32_16x16x32_bf16 v[196:199], a[164:167], a[108:111], v[196:199]
    ds_read_b64_tr_b16 a[188:189], v23 offset:57344
    v_mul_f32 v155, s36, v155
    v_mfma_f32_16x16x32_bf16 v[196:199], a[160:163], a[100:103], v[196:199]
    s_waitcnt lgkmcnt(9)
    ds_read_b64_tr_b16 a[190:191], v23 offset:61440
    v_mul_f32 v148, s36, v148
    v_mfma_f32_16x16x32_bf16 v[204:207], a[168:171], a[100:103], v[204:207]
    s_waitcnt lgkmcnt(8)
    ds_read_b64_tr_b16 a[160:161], v24 offset:49152
    v_mul_f32 v149, s36, v149
    v_mfma_f32_16x16x32_bf16 v[204:207], a[172:175], a[108:111], v[204:207]
    ds_read_b64_tr_b16 a[162:163], v24 offset:53248
    v_mul_f32 v150, s36, v150
    v_mfma_f32_16x16x32_bf16 v[200:203], a[172:175], a[104:107], v[200:203]
    ds_read_b64_tr_b16 a[164:165], v24 offset:57344
    v_mul_f32 v151, s36, v151
    v_mfma_f32_16x16x32_bf16 v[200:203], a[168:171], a[96:99], v[200:203]
    s_waitcnt lgkmcnt(9)
    ds_read_b64_tr_b16 a[166:167], v24 offset:61440
    v_mul_f32 v156, s36, v156
    v_mfma_f32_16x16x32_bf16 v[208:211], a[176:179], a[96:99], v[208:211]
    s_waitcnt lgkmcnt(8)
    ds_read_b64_tr_b16 a[168:169], v25 offset:49152
    v_mul_f32 v157, s36, v157
    v_mfma_f32_16x16x32_bf16 v[208:211], a[180:183], a[104:107], v[208:211]
    ds_read_b64_tr_b16 a[170:171], v25 offset:53248
    v_mul_f32 v158, s36, v158
    v_mfma_f32_16x16x32_bf16 v[212:215], a[180:183], a[108:111], v[212:215]
    ds_read_b64_tr_b16 a[172:173], v25 offset:57344
    v_mul_f32 v159, s36, v159
    v_mfma_f32_16x16x32_bf16 v[212:215], a[176:179], a[100:103], v[212:215]
    s_waitcnt lgkmcnt(9)
    ds_read_b64_tr_b16 a[174:175], v25 offset:61440
    v_cvt_pk_bf16_f32 v68, v144, v145
    v_mfma_f32_16x16x32_bf16 v[220:223], a[184:187], a[100:103], v[220:223]
    s_waitcnt lgkmcnt(8)
    ds_read_b64_tr_b16 a[176:177], v26 offset:49152
    v_cvt_pk_bf16_f32 v69, v146, v147
    v_mfma_f32_16x16x32_bf16 v[220:223], a[188:191], a[108:111], v[220:223]
    ds_read_b64_tr_b16 a[178:179], v26 offset:53248
    v_cvt_pk_bf16_f32 v70, v152, v153
    v_mfma_f32_16x16x32_bf16 v[216:219], a[188:191], a[104:107], v[216:219]
    ds_read_b64_tr_b16 a[180:181], v26 offset:57344
    v_cvt_pk_bf16_f32 v71, v154, v155
    v_mfma_f32_16x16x32_bf16 v[216:219], a[184:187], a[96:99], v[216:219]
    s_waitcnt lgkmcnt(9)
    ds_read_b64_tr_b16 a[182:183], v26 offset:61440
    v_cvt_pk_bf16_f32 v84, v148, v149
    v_mfma_f32_16x16x32_bf16 v[224:227], a[160:163], a[96:99], v[224:227]
    s_waitcnt lgkmcnt(8)
    ds_read_b64_tr_b16 a[184:185], v27 offset:49152
    v_cvt_pk_bf16_f32 v85, v150, v151
    v_mfma_f32_16x16x32_bf16 v[224:227], a[164:167], a[104:107], v[224:227]
    ds_read_b64_tr_b16 a[186:187], v27 offset:53248
    v_cvt_pk_bf16_f32 v86, v156, v157
    v_mfma_f32_16x16x32_bf16 v[228:231], a[164:167], a[108:111], v[228:231]
    ds_read_b64_tr_b16 a[188:189], v27 offset:57344
    v_cvt_pk_bf16_f32 v87, v158, v159
    v_mfma_f32_16x16x32_bf16 v[228:231], a[160:163], a[100:103], v[228:231]
    s_waitcnt lgkmcnt(9)
    ds_read_b64_tr_b16 a[190:191], v27 offset:61440
    v_permlane32_swap_b32 v68, v70
    s_waitcnt vmcnt(12)
    s_barrier
    v_mfma_f32_16x16x32_bf16 v[236:239], a[168:171], a[100:103], v[236:239]
    s_waitcnt lgkmcnt(8)
    ds_read_b64_tr_b16 a[160:161], v28 offset:0
    v_permlane32_swap_b32 v69, v71
    v_mfma_f32_16x16x32_bf16 v[236:239], a[172:175], a[108:111], v[236:239]
    ds_read_b64_tr_b16 a[162:163], v28 offset:4096
    v_permlane32_swap_b32 v84, v86
    v_mfma_f32_16x16x32_bf16 v[232:235], a[172:175], a[104:107], v[232:235]
    s_add_u32 m0, s42, 32768
    ds_read_b64_tr_b16 a[164:165], v28 offset:8192
    v_permlane32_swap_b32 v85, v87
    v_mfma_f32_16x16x32_bf16 v[232:235], a[168:171], a[96:99], v[232:235]
    s_waitcnt lgkmcnt(9)
    buffer_load_dwordx4 v36, s[8:11], s40 offen lds
    v_mfma_f32_16x16x32_bf16 v[240:243], a[176:179], a[96:99], v[240:243]
    s_waitcnt lgkmcnt(7)
    ds_read_b64_tr_b16 a[166:167], v28 offset:12288
    ds_read_b64_tr_b16 a[168:169], v29 offset:0
    v_mfma_f32_16x16x32_bf16 v[240:243], a[180:183], a[104:107], v[240:243]
    ds_read_b64_tr_b16 a[170:171], v29 offset:4096
    v_permlane16_swap_b32 v68, v70
    v_mfma_f32_16x16x32_bf16 v[244:247], a[180:183], a[108:111], v[244:247]
    ds_read_b64_tr_b16 a[172:173], v29 offset:8192
    v_permlane16_swap_b32 v69, v71
    v_mfma_f32_16x16x32_bf16 v[244:247], a[176:179], a[100:103], v[244:247]
    s_waitcnt lgkmcnt(9)
    buffer_load_dwordx4 v37, s[8:11], s40 offen offset:1024 lds
    v_mfma_f32_16x16x32_bf16 v[252:255], a[184:187], a[100:103], v[252:255]
    s_waitcnt lgkmcnt(7)
    ds_read_b64_tr_b16 a[174:175], v29 offset:12288
    ds_read_b64_tr_b16 a[176:177], v30 offset:0
    v_mfma_f32_16x16x32_bf16 v[252:255], a[188:191], a[108:111], v[252:255]
    ds_read_b64_tr_b16 a[178:179], v30 offset:4096
    v_permlane16_swap_b32 v84, v86
    v_mfma_f32_16x16x32_bf16 v[248:251], a[188:191], a[104:107], v[248:251]
    ds_read_b64_tr_b16 a[180:181], v30 offset:8192
    v_permlane16_swap_b32 v85, v87
    v_mfma_f32_16x16x32_bf16 v[248:251], a[184:187], a[96:99], v[248:251]
    s_waitcnt lgkmcnt(9)
    buffer_load_dwordx4 v38, s[8:11], s40 offen offset:2048 lds
    v_mfma_f32_16x16x32_bf16 v[192:195], a[160:163], a[112:115], v[192:195]
    s_waitcnt lgkmcnt(7)
    ds_read_b64_tr_b16 a[182:183], v30 offset:12288
    ds_read_b64_tr_b16 a[184:185], v31 offset:0
    v_mfma_f32_16x16x32_bf16 v[192:195], a[164:167], a[120:123], v[192:195]
    ds_read_b64_tr_b16 a[186:187], v31 offset:4096
    v_mul_f32 v160, s36, v160
    v_mfma_f32_16x16x32_bf16 v[196:199], a[164:167], a[124:127], v[196:199]
    ds_read_b64_tr_b16 a[188:189], v31 offset:8192
    v_mul_f32 v161, s36, v161
    v_mfma_f32_16x16x32_bf16 v[196:199], a[160:163], a[116:119], v[196:199]
    s_waitcnt lgkmcnt(9)
    buffer_load_dwordx4 v39, s[8:11], s40 offen offset:3072 lds
    v_mfma_f32_16x16x32_bf16 v[204:207], a[168:171], a[116:119], v[204:207]
    s_waitcnt lgkmcnt(7)
    s_add_u32 s40, s40, 16384
    ds_read_b64_tr_b16 a[190:191], v31 offset:12288
    ds_read_b64_tr_b16 a[160:161], v32 offset:0
    v_mfma_f32_16x16x32_bf16 v[204:207], a[172:175], a[124:127], v[204:207]
    ds_read_b64_tr_b16 a[162:163], v32 offset:4096
    v_mul_f32 v162, s36, v162
    v_mfma_f32_16x16x32_bf16 v[200:203], a[172:175], a[120:123], v[200:203]
    s_add_u32 m0, s42, 65536
    ds_read_b64_tr_b16 a[164:165], v32 offset:8192
    v_mul_f32 v163, s36, v163
    v_mfma_f32_16x16x32_bf16 v[200:203], a[168:171], a[112:115], v[200:203]
    s_waitcnt lgkmcnt(9)
    buffer_load_dwordx4 v40, s[12:15], s41 offen lds
    v_mfma_f32_16x16x32_bf16 v[208:211], a[176:179], a[112:115], v[208:211]
    s_waitcnt lgkmcnt(7)
    ds_read_b64_tr_b16 a[166:167], v32 offset:12288
    ds_read_b64_tr_b16 a[168:169], v33 offset:0
    v_mfma_f32_16x16x32_bf16 v[208:211], a[180:183], a[120:123], v[208:211]
    ds_read_b64_tr_b16 a[170:171], v33 offset:4096
    v_mul_f32 v168, s36, v168
    v_mfma_f32_16x16x32_bf16 v[212:215], a[180:183], a[124:127], v[212:215]
    ds_read_b64_tr_b16 a[172:173], v33 offset:8192
    v_mul_f32 v169, s36, v169
    v_mfma_f32_16x16x32_bf16 v[212:215], a[176:179], a[116:119], v[212:215]
    s_waitcnt lgkmcnt(9)
    buffer_load_dwordx4 v41, s[12:15], s41 offen offset:1024 lds
    v_mfma_f32_16x16x32_bf16 v[220:223], a[184:187], a[116:119], v[220:223]
    s_waitcnt lgkmcnt(7)
    ds_read_b64_tr_b16 a[174:175], v33 offset:12288
    ds_read_b64_tr_b16 a[176:177], v34 offset:0
    v_mfma_f32_16x16x32_bf16 v[220:223], a[188:191], a[124:127], v[220:223]
    ds_read_b64_tr_b16 a[178:179], v34 offset:4096
    v_mul_f32 v170, s36, v170
    v_mfma_f32_16x16x32_bf16 v[216:219], a[188:191], a[120:123], v[216:219]
    ds_read_b64_tr_b16 a[180:181], v34 offset:8192
    v_mul_f32 v171, s36, v171
    v_mfma_f32_16x16x32_bf16 v[216:219], a[184:187], a[112:115], v[216:219]
    s_waitcnt lgkmcnt(9)
    buffer_load_dwordx4 v40, s[12:15], s41 offen offset:2048 lds
    v_mfma_f32_16x16x32_bf16 v[224:227], a[160:163], a[112:115], v[224:227]
    s_waitcnt lgkmcnt(7)
    ds_read_b64_tr_b16 a[182:183], v34 offset:12288
    ds_read_b64_tr_b16 a[184:185], v35 offset:0
    v_mfma_f32_16x16x32_bf16 v[224:227], a[164:167], a[120:123], v[224:227]
    ds_read_b64_tr_b16 a[186:187], v35 offset:4096
    v_mul_f32 v164, s36, v164
    v_mfma_f32_16x16x32_bf16 v[228:231], a[164:167], a[124:127], v[228:231]
    ds_read_b64_tr_b16 a[188:189], v35 offset:8192
    v_mul_f32 v165, s36, v165
    v_mfma_f32_16x16x32_bf16 v[228:231], a[160:163], a[116:119], v[228:231]
    s_waitcnt lgkmcnt(9)
    buffer_load_dwordx4 v41, s[12:15], s41 offen offset:3072 lds
    v_mfma_f32_16x16x32_bf16 v[236:239], a[168:171], a[116:119], v[236:239]
    s_waitcnt lgkmcnt(7)
    s_add_u32 s41, s41, 16384
    ds_read_b64_tr_b16 a[190:191], v35 offset:12288
    ds_read_b64_tr_b16 a[160:161], v28 offset:16384
    v_mfma_f32_16x16x32_bf16 v[236:239], a[172:175], a[124:127], v[236:239]
    ds_read_b64_tr_b16 a[162:163], v28 offset:20480
    v_mul_f32 v166, s36, v166
    v_mfma_f32_16x16x32_bf16 v[232:235], a[172:175], a[120:123], v[232:235]
    s_add_u32 m0, s42, 81920
    ds_read_b64_tr_b16 a[164:165], v28 offset:24576
    v_mul_f32 v167, s36, v167
    v_mfma_f32_16x16x32_bf16 v[232:235], a[168:171], a[112:115], v[232:235]
    s_waitcnt lgkmcnt(9)
    buffer_load_dwordx4 v40, s[12:15], s41 offen lds
    v_mfma_f32_16x16x32_bf16 v[240:243], a[176:179], a[112:115], v[240:243]
    s_waitcnt lgkmcnt(7)
    ds_read_b64_tr_b16 a[166:167], v28 offset:28672
    ds_read_b64_tr_b16 a[168:169], v29 offset:16384
    v_mfma_f32_16x16x32_bf16 v[240:243], a[180:183], a[120:123], v[240:243]
    ds_read_b64_tr_b16 a[170:171], v29 offset:20480
    v_mul_f32 v172, s36, v172
    v_mfma_f32_16x16x32_bf16 v[244:247], a[180:183], a[124:127], v[244:247]
    ds_read_b64_tr_b16 a[172:173], v29 offset:24576
    v_mul_f32 v173, s36, v173
    v_mfma_f32_16x16x32_bf16 v[244:247], a[176:179], a[116:119], v[244:247]
    s_waitcnt lgkmcnt(9)
    buffer_load_dwordx4 v41, s[12:15], s41 offen offset:1024 lds
    v_mfma_f32_16x16x32_bf16 v[252:255], a[184:187], a[116:119], v[252:255]
    s_waitcnt lgkmcnt(7)
    ds_read_b64_tr_b16 a[174:175], v29 offset:28672
    ds_read_b64_tr_b16 a[176:177], v30 offset:16384
    v_mfma_f32_16x16x32_bf16 v[252:255], a[188:191], a[124:127], v[252:255]
    ds_read_b64_tr_b16 a[178:179], v30 offset:20480
    v_mul_f32 v174, s36, v174
    v_mfma_f32_16x16x32_bf16 v[248:251], a[188:191], a[120:123], v[248:251]
    ds_read_b64_tr_b16 a[180:181], v30 offset:24576
    v_mul_f32 v175, s36, v175
    v_mfma_f32_16x16x32_bf16 v[248:251], a[184:187], a[112:115], v[248:251]
    s_waitcnt lgkmcnt(9)
    buffer_load_dwordx4 v40, s[12:15], s41 offen offset:2048 lds
    v_mfma_f32_16x16x32_bf16 v[192:195], a[160:163], a[128:131], v[192:195]
    s_waitcnt lgkmcnt(7)
    ds_read_b64_tr_b16 a[182:183], v30 offset:28672
    ds_read_b64_tr_b16 a[184:185], v31 offset:16384
    v_mfma_f32_16x16x32_bf16 v[192:195], a[164:167], a[136:139], v[192:195]
    ds_read_b64_tr_b16 a[186:187], v31 offset:20480
    v_cvt_pk_bf16_f32 v72, v160, v161
    v_mfma_f32_16x16x32_bf16 v[196:199], a[164:167], a[140:143], v[196:199]
    ds_read_b64_tr_b16 a[188:189], v31 offset:24576
    v_cvt_pk_bf16_f32 v73, v162, v163
    v_mfma_f32_16x16x32_bf16 v[196:199], a[160:163], a[132:135], v[196:199]
    s_waitcnt lgkmcnt(9)
    buffer_load_dwordx4 v41, s[12:15], s41 offen offset:3072 lds
    v_mfma_f32_16x16x32_bf16 v[204:207], a[168:171], a[132:135], v[204:207]
    s_waitcnt lgkmcnt(7)
    s_add_u32 s41, s41, 16384
    ds_read_b64_tr_b16 a[190:191], v31 offset:28672
    ds_read_b64_tr_b16 a[160:161], v32 offset:16384
    v_mfma_f32_16x16x32_bf16 v[204:207], a[172:175], a[140:143], v[204:207]
    ds_read_b64_tr_b16 a[162:163], v32 offset:20480
    v_cvt_pk_bf16_f32 v74, v168, v169
    v_mfma_f32_16x16x32_bf16 v[200:203], a[172:175], a[136:139], v[200:203]
    ds_read_b64_tr_b16 a[164:165], v32 offset:24576
    v_cvt_pk_bf16_f32 v75, v170, v171
    v_mfma_f32_16x16x32_bf16 v[200:203], a[168:171], a[128:131], v[200:203]
    s_waitcnt lgkmcnt(9)
    ds_read_b64_tr_b16 a[166:167], v32 offset:28672
    v_cvt_pk_bf16_f32 v88, v164, v165
    v_mfma_f32_16x16x32_bf16 v[208:211], a[176:179], a[128:131], v[208:211]
    s_waitcnt lgkmcnt(8)
    ds_read_b64_tr_b16 a[168:169], v33 offset:16384
    v_cvt_pk_bf16_f32 v89, v166, v167
    v_mfma_f32_16x16x32_bf16 v[208:211], a[180:183], a[136:139], v[208:211]
    ds_read_b64_tr_b16 a[170:171], v33 offset:20480
    v_cvt_pk_bf16_f32 v90, v172, v173
    v_mfma_f32_16x16x32_bf16 v[212:215], a[180:183], a[140:143], v[212:215]
    ds_read_b64_tr_b16 a[172:173], v33 offset:24576
    v_cvt_pk_bf16_f32 v91, v174, v175
    v_mfma_f32_16x16x32_bf16 v[212:215], a[176:179], a[132:135], v[212:215]
    s_waitcnt lgkmcnt(9)
    ds_read_b64_tr_b16 a[174:175], v33 offset:28672
    v_permlane32_swap_b32 v72, v74
    v_mfma_f32_16x16x32_bf16 v[220:223], a[184:187], a[132:135], v[220:223]
    s_waitcnt lgkmcnt(8)
    ds_read_b64_tr_b16 a[176:177], v34 offset:16384
    v_permlane32_swap_b32 v73, v75
    v_mfma_f32_16x16x32_bf16 v[220:223], a[188:191], a[140:143], v[220:223]
    ds_read_b64_tr_b16 a[178:179], v34 offset:20480
    v_permlane32_swap_b32 v88, v90
    v_mfma_f32_16x16x32_bf16 v[216:219], a[188:191], a[136:139], v[216:219]
    ds_read_b64_tr_b16 a[180:181], v34 offset:24576
    v_permlane32_swap_b32 v89, v91
    v_mfma_f32_16x16x32_bf16 v[216:219], a[184:187], a[128:131], v[216:219]
    s_waitcnt lgkmcnt(9)
    ds_read_b64_tr_b16 a[182:183], v34 offset:28672
    v_permlane16_swap_b32 v72, v74
    v_mfma_f32_16x16x32_bf16 v[224:227], a[160:163], a[128:131], v[224:227]
    s_waitcnt lgkmcnt(8)
    ds_read_b64_tr_b16 a[184:185], v35 offset:16384
    v_permlane16_swap_b32 v73, v75
    v_mfma_f32_16x16x32_bf16 v[224:227], a[164:167], a[136:139], v[224:227]
    ds_read_b64_tr_b16 a[186:187], v35 offset:20480
    v_permlane16_swap_b32 v88, v90
    v_mfma_f32_16x16x32_bf16 v[228:231], a[164:167], a[140:143], v[228:231]
    ds_read_b64_tr_b16 a[188:189], v35 offset:24576
    v_permlane16_swap_b32 v89, v91
    v_mfma_f32_16x16x32_bf16 v[228:231], a[160:163], a[132:135], v[228:231]
    s_waitcnt lgkmcnt(9)
    ds_read_b64_tr_b16 a[190:191], v35 offset:28672
    v_mul_f32 v176, s36, v176
    v_mfma_f32_16x16x32_bf16 v[236:239], a[168:171], a[132:135], v[236:239]
    s_waitcnt lgkmcnt(8)
    v_mul_f32 v177, s36, v177
    v_mul_f32 v178, s36, v178
    v_mfma_f32_16x16x32_bf16 v[236:239], a[172:175], a[140:143], v[236:239]
    v_mul_f32 v179, s36, v179
    v_mul_f32 v184, s36, v184
    v_mfma_f32_16x16x32_bf16 v[232:235], a[172:175], a[136:139], v[232:235]
    v_mul_f32 v185, s36, v185
    v_mul_f32 v186, s36, v186
    v_mfma_f32_16x16x32_bf16 v[232:235], a[168:171], a[128:131], v[232:235]
    s_waitcnt lgkmcnt(6)
    v_mul_f32 v187, s36, v187
    v_mul_f32 v180, s36, v180
    s_waitcnt vmcnt(16)
    s_barrier
    v_mfma_f32_16x16x32_bf16 v[240:243], a[176:179], a[128:131], v[240:243]
    s_waitcnt lgkmcnt(4)
    ds_read_b128 a[208:211], v8 offset:0
    v_mul_f32 v181, s36, v181
    v_mfma_f32_16x16x32_bf16 v[240:243], a[180:183], a[136:139], v[240:243]
    ds_read_b128 a[212:215], v9 offset:0
    v_mul_f32 v182, s36, v182
    v_mfma_f32_16x16x32_bf16 v[244:247], a[180:183], a[140:143], v[244:247]
    ds_read_b128 a[216:219], v10 offset:0
    v_mul_f32 v183, s36, v183
    v_mfma_f32_16x16x32_bf16 v[244:247], a[176:179], a[132:135], v[244:247]
    s_waitcnt lgkmcnt(5)
    ds_read_b128 a[220:223], v11 offset:0
    v_mul_f32 v188, s36, v188
    v_mfma_f32_16x16x32_bf16 v[252:255], a[184:187], a[132:135], v[252:255]
    s_waitcnt lgkmcnt(4)
    ds_read_b128 a[224:227], v8 offset:4096
    v_mul_f32 v189, s36, v189
    v_mfma_f32_16x16x32_bf16 v[252:255], a[188:191], a[140:143], v[252:255]
    v_mul_f32 v190, s36, v190
    v_mul_f32 v191, s36, v191
    v_mfma_f32_16x16x32_bf16 v[248:251], a[188:191], a[136:139], v[248:251]
    s_load_dwordx2 s[16:17], s[0:1], 88
    v_cvt_pk_bf16_f32 v76, v176, v177
    v_cvt_pk_bf16_f32 v77, v178, v179
    v_mfma_f32_16x16x32_bf16 v[248:251], a[184:187], a[128:131], v[248:251]
    v_cvt_pk_bf16_f32 v78, v184, v185
    v_cvt_pk_bf16_f32 v79, v186, v187
    v_cvt_pk_bf16_f32 v92, v180, v181
    v_cvt_pk_bf16_f32 v93, v182, v183
    v_cvt_pk_bf16_f32 v94, v188, v189
    v_cvt_pk_bf16_f32 v95, v190, v191
    v_permlane32_swap_b32 v76, v78
    v_permlane32_swap_b32 v77, v79
    v_permlane32_swap_b32 v92, v94
    v_permlane32_swap_b32 v93, v95
    v_permlane16_swap_b32 v76, v78
    v_permlane16_swap_b32 v77, v79
    v_permlane16_swap_b32 v92, v94
    v_permlane16_swap_b32 v93, v95
    s_mov_b32 s36, 1040356334
    s_mov_b32 s37, 1040356334
    v_mov_b32 v58, 0
    v_mov_b32 v59, 0
    v_mov_b32 v60, 0
    v_mov_b32 v61, 0
    v_pk_mul_f32 v[192:193], v[192:193], s[36:37]
    v_pk_mul_f32 v[194:195], v[194:195], s[36:37]
    v_pk_mul_f32 v[200:201], v[200:201], s[36:37]
    v_pk_mul_f32 v[202:203], v[202:203], s[36:37]
    v_pk_mul_f32 v[196:197], v[196:197], s[36:37]
    v_pk_mul_f32 v[198:199], v[198:199], s[36:37]
    v_pk_mul_f32 v[204:205], v[204:205], s[36:37]
    v_pk_mul_f32 v[206:207], v[206:207], s[36:37]
    v_mfma_f32_32x32x16_bf16 a[0:15], v[58:61], v[58:61], 0
    v_cvt_pk_bf16_f32 v96, v192, v193
    v_cvt_pk_bf16_f32 v97, v194, v195
    v_cvt_pk_bf16_f32 v98, v200, v201
    v_cvt_pk_bf16_f32 v99, v202, v203
    v_cvt_pk_bf16_f32 v112, v196, v197
    v_cvt_pk_bf16_f32 v113, v198, v199
    v_cvt_pk_bf16_f32 v114, v204, v205
    v_cvt_pk_bf16_f32 v115, v206, v207
    v_mfma_f32_32x32x16_bf16 a[16:31], v[58:61], v[58:61], 0
    v_permlane32_swap_b32 v96, v98
    v_permlane32_swap_b32 v97, v99
    v_permlane32_swap_b32 v112, v114
    v_permlane32_swap_b32 v113, v115
    v_permlane16_swap_b32 v96, v98
    v_permlane16_swap_b32 v97, v99
    v_permlane16_swap_b32 v112, v114
    v_permlane16_swap_b32 v113, v115
    v_pk_mul_f32 v[208:209], v[208:209], s[36:37]
    v_pk_mul_f32 v[210:211], v[210:211], s[36:37]
    v_pk_mul_f32 v[216:217], v[216:217], s[36:37]
    v_pk_mul_f32 v[218:219], v[218:219], s[36:37]
    v_pk_mul_f32 v[212:213], v[212:213], s[36:37]
    v_pk_mul_f32 v[214:215], v[214:215], s[36:37]
    v_pk_mul_f32 v[220:221], v[220:221], s[36:37]
    v_pk_mul_f32 v[222:223], v[222:223], s[36:37]
    v_mfma_f32_32x32x16_bf16 a[32:47], v[58:61], v[58:61], 0
    v_cvt_pk_bf16_f32 v100, v208, v209
    v_cvt_pk_bf16_f32 v101, v210, v211
    v_cvt_pk_bf16_f32 v102, v216, v217
    v_cvt_pk_bf16_f32 v103, v218, v219
    v_cvt_pk_bf16_f32 v116, v212, v213
    v_cvt_pk_bf16_f32 v117, v214, v215
    v_cvt_pk_bf16_f32 v118, v220, v221
    v_cvt_pk_bf16_f32 v119, v222, v223
    v_mfma_f32_32x32x16_bf16 a[48:63], v[58:61], v[58:61], 0
    v_permlane32_swap_b32 v100, v102
    v_permlane32_swap_b32 v101, v103
    v_permlane32_swap_b32 v116, v118
    v_permlane32_swap_b32 v117, v119
    v_permlane16_swap_b32 v100, v102
    v_permlane16_swap_b32 v101, v103
    v_permlane16_swap_b32 v116, v118
    v_permlane16_swap_b32 v117, v119
    v_pk_mul_f32 v[224:225], v[224:225], s[36:37]
    v_pk_mul_f32 v[226:227], v[226:227], s[36:37]
    v_pk_mul_f32 v[232:233], v[232:233], s[36:37]
    v_pk_mul_f32 v[234:235], v[234:235], s[36:37]
    v_pk_mul_f32 v[228:229], v[228:229], s[36:37]
    v_pk_mul_f32 v[230:231], v[230:231], s[36:37]
    v_pk_mul_f32 v[236:237], v[236:237], s[36:37]
    v_pk_mul_f32 v[238:239], v[238:239], s[36:37]
    v_mfma_f32_32x32x16_bf16 a[64:79], v[58:61], v[58:61], 0
    v_cvt_pk_bf16_f32 v104, v224, v225
    v_cvt_pk_bf16_f32 v105, v226, v227
    v_cvt_pk_bf16_f32 v106, v232, v233
    v_cvt_pk_bf16_f32 v107, v234, v235
    v_cvt_pk_bf16_f32 v120, v228, v229
    v_cvt_pk_bf16_f32 v121, v230, v231
    v_cvt_pk_bf16_f32 v122, v236, v237
    v_cvt_pk_bf16_f32 v123, v238, v239
    v_mfma_f32_32x32x16_bf16 a[80:95], v[58:61], v[58:61], 0
    v_permlane32_swap_b32 v104, v106
    v_permlane32_swap_b32 v105, v107
    v_permlane32_swap_b32 v120, v122
    v_permlane32_swap_b32 v121, v123
    v_permlane16_swap_b32 v104, v106
    v_permlane16_swap_b32 v105, v107
    v_permlane16_swap_b32 v120, v122
    v_permlane16_swap_b32 v121, v123
    v_pk_mul_f32 v[240:241], v[240:241], s[36:37]
    v_pk_mul_f32 v[242:243], v[242:243], s[36:37]
    v_pk_mul_f32 v[248:249], v[248:249], s[36:37]
    v_pk_mul_f32 v[250:251], v[250:251], s[36:37]
    v_pk_mul_f32 v[244:245], v[244:245], s[36:37]
    v_pk_mul_f32 v[246:247], v[246:247], s[36:37]
    v_pk_mul_f32 v[252:253], v[252:253], s[36:37]
    v_pk_mul_f32 v[254:255], v[254:255], s[36:37]
    v_mfma_f32_32x32x16_bf16 a[96:111], v[58:61], v[58:61], 0
    v_cvt_pk_bf16_f32 v108, v240, v241
    v_cvt_pk_bf16_f32 v109, v242, v243
    v_cvt_pk_bf16_f32 v110, v248, v249
    v_cvt_pk_bf16_f32 v111, v250, v251
    v_cvt_pk_bf16_f32 v124, v244, v245
    v_cvt_pk_bf16_f32 v125, v246, v247
    v_cvt_pk_bf16_f32 v126, v252, v253
    v_cvt_pk_bf16_f32 v127, v254, v255
    v_mfma_f32_32x32x16_bf16 a[112:127], v[58:61], v[58:61], 0
    v_permlane32_swap_b32 v108, v110
    v_permlane32_swap_b32 v109, v111
    v_permlane32_swap_b32 v124, v126
    v_permlane32_swap_b32 v125, v127
    v_permlane16_swap_b32 v108, v110
    v_permlane16_swap_b32 v109, v111
    v_permlane16_swap_b32 v124, v126
    v_permlane16_swap_b32 v125, v127
    s_waitcnt lgkmcnt(0)
    v_mfma_f32_16x16x32_bf16 v[216:219], a[208:211], v[64:67], 0
    v_mfma_f32_16x16x32_bf16 v[216:219], a[212:215], v[68:71], v[216:219]
    v_mfma_f32_16x16x32_bf16 v[216:219], a[216:219], v[72:75], v[216:219]
    v_mfma_f32_16x16x32_bf16 v[216:219], a[220:223], v[76:79], v[216:219]
    v_mfma_f32_16x16x32_bf16 v[220:223], a[208:211], v[80:83], 0
    v_mfma_f32_16x16x32_bf16 v[220:223], a[212:215], v[84:87], v[220:223]
    v_mfma_f32_16x16x32_bf16 v[220:223], a[216:219], v[88:91], v[220:223]
    v_mfma_f32_16x16x32_bf16 v[220:223], a[220:223], v[92:95], v[220:223]
    v_mfma_f32_16x16x32_bf16 v[224:227], a[208:211], v[96:99], 0
    v_mfma_f32_16x16x32_bf16 v[224:227], a[212:215], v[100:103], v[224:227]
    v_mfma_f32_16x16x32_bf16 v[224:227], a[216:219], v[104:107], v[224:227]
    v_mfma_f32_16x16x32_bf16 v[224:227], a[220:223], v[108:111], v[224:227]
    v_mfma_f32_16x16x32_bf16 v[228:231], a[208:211], v[112:115], 0
    v_mfma_f32_16x16x32_bf16 v[228:231], a[212:215], v[116:119], v[228:231]
    v_mfma_f32_16x16x32_bf16 v[228:231], a[216:219], v[120:123], v[228:231]
    v_mfma_f32_16x16x32_bf16 v[228:231], a[220:223], v[124:127], v[228:231]
    v_mfma_f32_32x32x16_bf16 a[192:207], v[58:61], v[58:61], 0
    v_max3_f32 v232, v216, v217, v218
    v_max_f32 v232, v232, v219
    v_max3_f32 v233, v220, v221, v222
    v_max_f32 v233, v233, v223
    v_max3_f32 v234, v224, v225, v226
    v_max_f32 v234, v234, v227
    s_nop 0
    v_max3_f32 v235, v228, v229, v230
    v_max_f32 v235, v235, v231
    v_mov_b32 v236, v232
    v_mov_b32 v237, v233
    v_mov_b32 v238, v234
    v_mov_b32 v239, v235
    v_permlane16_swap_b32 v232, v236
    v_permlane16_swap_b32 v233, v237
    v_permlane16_swap_b32 v234, v238
    v_permlane16_swap_b32 v235, v239
    v_max_f32 v232, v232, v236
    v_max_f32 v233, v233, v237
    v_max_f32 v234, v234, v238
    v_max_f32 v235, v235, v239
    v_mov_b32 v236, v232
    v_mov_b32 v237, v233
    v_mov_b32 v238, v234
    v_mov_b32 v239, v235
    v_permlane32_swap_b32 v232, v236
    v_permlane32_swap_b32 v233, v237
    v_permlane32_swap_b32 v234, v238
    v_permlane32_swap_b32 v235, v239
    v_max_f32 v232, v232, v236
    v_max_f32 v233, v233, v237
    v_max_f32 v234, v234, v238
    v_max_f32 v235, v235, v239
    v_sub_f32 v192, 3250585600, v232
    v_sub_f32 v193, 3250585600, v232
    v_sub_f32 v194, 3250585600, v232
    v_sub_f32 v195, 3250585600, v232
    v_sub_f32 v196, 3250585600, v233
    v_sub_f32 v197, 3250585600, v233
Ltour0_3:
    s_cbranch_execz Ltour0_7
    v_sub_f32 v198, 3250585600, v233
    v_sub_f32 v199, 3250585600, v233
    v_sub_f32 v200, 3250585600, v234
    v_sub_f32 v201, 3250585600, v234
    v_sub_f32 v202, 3250585600, v234
    v_sub_f32 v203, 3250585600, v234
    v_sub_f32 v204, 3250585600, v235
    v_sub_f32 v205, 3250585600, v235
    v_sub_f32 v206, 3250585600, v235
    v_sub_f32 v207, 3250585600, v235
Lattn_stage0:
    s_mov_b32 s43, 7
    v_mfma_f32_16x16x32_bf16 v[208:211], a[208:211], v[64:67], v[192:195]
    s_lshl_b32 s53, s5, 4
    v_lshrrev_b32 v51, 2, v0
    v_mul_u32_u24 v51, 9216, v51
    v_mfma_f32_16x16x32_bf16 v[208:211], a[212:215], v[68:71], v[208:211]
    s_add_u32 s53, s53, s4
    v_and_b32 v254, 3, v0
    v_lshl_add_u32 v254, v254, 4, v51
    v_mfma_f32_16x16x32_bf16 v[208:211], a[216:219], v[72:75], v[208:211]
    s_lshl_b32 s53, s53, 2
    v_lshlrev_b32 v255, 4, v0
    v_add_u32 v51, 98304, v255
    v_mfma_f32_16x16x32_bf16 v[208:211], a[220:223], v[76:79], v[208:211]
    s_add_u32 s53, s53, s3
    v_mov_b32 v224, 0
    v_mfma_f32_16x16x32_bf16 v[212:215], a[208:211], v[80:83], v[196:199]
    s_mul_i32 s53, s53, 4608
    ds_read_b128 a[228:231], v9 offset:4096
    v_mov_b32 v225, 0
    v_mfma_f32_16x16x32_bf16 v[212:215], a[212:215], v[84:87], v[212:215]
    s_add_u32 s53, s53, 2621440
    v_exp_f32 v208, v208
    v_mfma_f32_16x16x32_bf16 v[212:215], a[216:219], v[88:91], v[212:215]
    s_lshr_b32 s44, s2, 5
    v_exp_f32 v209, v209
    v_mfma_f32_16x16x32_bf16 v[212:215], a[220:223], v[92:95], v[212:215]
    s_lshl_b32 s44, s44, 3
    v_exp_f32 v210, v210
    v_exp_f32 v211, v211
    v_cvt_pk_bf16_f32 v128, v208, v209
    v_cvt_pk_bf16_f32 v129, v210, v211
    v_mfma_f32_16x16x32_bf16 v[208:211], a[208:211], v[96:99], v[200:203]
    s_and_b32 s37, s2, 7
    ds_read_b128 a[232:235], v10 offset:4096
    v_mov_b32 v226, 0
    v_mfma_f32_16x16x32_bf16 v[208:211], a[212:215], v[100:103], v[208:211]
    s_add_u32 s44, s44, s37
    v_exp_f32 v212, v212
    v_mfma_f32_16x16x32_bf16 v[208:211], a[216:219], v[104:107], v[208:211]
    s_lshl_b32 s44, s44, 2
    v_exp_f32 v213, v213
    v_mfma_f32_16x16x32_bf16 v[208:211], a[220:223], v[108:111], v[208:211]
    s_bfe_u32 s37, s2, 0x20003
    v_exp_f32 v214, v214
    v_exp_f32 v215, v215
    v_cvt_pk_bf16_f32 v136, v212, v213
    v_cvt_pk_bf16_f32 v137, v214, v215
    v_mfma_f32_16x16x32_bf16 v[212:215], a[208:211], v[112:115], v[204:207]
    s_add_u32 s44, s44, s37
    ds_read_b128 a[236:239], v11 offset:4096
    v_mov_b32 v227, 0
    v_mfma_f32_16x16x32_bf16 v[212:215], a[212:215], v[116:119], v[212:215]
    s_add_u32 s44, s44, 72
    v_exp_f32 v208, v208
    v_mfma_f32_16x16x32_bf16 v[212:215], a[216:219], v[120:123], v[212:215]
    s_cmp_lt_u32 s44, 216
    s_cselect_b32 s37, 0, 2147483648
    v_exp_f32 v209, v209
    v_mfma_f32_16x16x32_bf16 v[212:215], a[220:223], v[124:127], v[212:215]
    s_lshl_b32 s44, s44, 5
    v_exp_f32 v210, v210
    v_exp_f32 v211, v211
    v_cvt_pk_bf16_f32 v144, v208, v209
    v_cvt_pk_bf16_f32 v145, v210, v211
    v_mfma_f32_16x16x32_bf16 v[208:211], a[224:227], v[64:67], v[192:195]
    s_waitcnt lgkmcnt(2)
    s_or_b32 s44, s44, s37
    ds_read_b128 a[208:211], v8 offset:8192
    v_mov_b32 v228, 0
    v_mfma_f32_16x16x32_bf16 v[208:211], a[228:231], v[68:71], v[208:211]
    s_waitcnt lgkmcnt(2)
    s_mov_b32 s18, 3981312
    v_exp_f32 v212, v212
    v_mfma_f32_16x16x32_bf16 v[208:211], a[232:235], v[72:75], v[208:211]
    s_waitcnt lgkmcnt(1)
    s_lshr_b32 s6, s2, 3
    v_exp_f32 v213, v213
    v_mfma_f32_16x16x32_bf16 v[208:211], a[236:239], v[76:79], v[208:211]
    s_and_b32 s7, s2, 7
    v_exp_f32 v214, v214
    v_exp_f32 v215, v215
    v_cvt_pk_bf16_f32 v152, v212, v213
    v_cvt_pk_bf16_f32 v153, v214, v215
    v_mfma_f32_16x16x32_bf16 v[212:215], a[224:227], v[80:83], v[196:199]
    s_mul_i32 s7, s7, 18
    ds_read_b128 a[212:215], v9 offset:8192
    v_mov_b32 v229, 0
    v_mfma_f32_16x16x32_bf16 v[212:215], a[228:231], v[84:87], v[212:215]
    s_add_u32 s7, s7, s6
    v_exp_f32 v208, v208
    v_mfma_f32_16x16x32_bf16 v[212:215], a[232:235], v[88:91], v[212:215]
    s_lshl_b32 s58, s7, 6
    v_exp_f32 v209, v209
    v_mfma_f32_16x16x32_bf16 v[212:215], a[236:239], v[92:95], v[212:215]
    s_mul_i32 s59, s7, 36864
    v_exp_f32 v210, v210
    v_exp_f32 v211, v211
    v_cvt_pk_bf16_f32 v130, v208, v209
    v_cvt_pk_bf16_f32 v131, v210, v211
    v_mfma_f32_16x16x32_bf16 v[208:211], a[224:227], v[96:99], v[200:203]
    s_cmp_lt_u32 s6, 18
    s_cselect_b32 s7, 0, 2147483648
    ds_read_b128 a[216:219], v10 offset:8192
    v_mov_b32 v230, 0
    v_mfma_f32_16x16x32_bf16 v[208:211], a[228:231], v[100:103], v[208:211]
    s_or_b32 s58, s58, s7
    v_exp_f32 v212, v212
    v_mfma_f32_16x16x32_bf16 v[208:211], a[232:235], v[104:107], v[208:211]
    s_or_b32 s59, s59, s7
    v_exp_f32 v213, v213
    v_mfma_f32_16x16x32_bf16 v[208:211], a[236:239], v[108:111], v[208:211]
    s_and_b32 s7, s4, 1
    v_exp_f32 v214, v214
    v_exp_f32 v215, v215
    v_cvt_pk_bf16_f32 v138, v212, v213
    v_cvt_pk_bf16_f32 v139, v214, v215
    s_mov_b32 s39, 221184
    s_mov_b32 s38, 27648
    v_mfma_f32_16x16x32_bf16 v[212:215], a[224:227], v[112:115], v[204:207]
    s_lshl_b32 s6, s7, 7
    ds_read_b128 a[220:223], v11 offset:8192
    v_mov_b32 v231, 0
    v_mfma_f32_16x16x32_bf16 v[212:215], a[228:231], v[116:119], v[212:215]
    s_xor_b32 s36, s4, 1
    v_exp_f32 v208, v208
    v_mfma_f32_16x16x32_bf16 v[212:215], a[232:235], v[120:123], v[212:215]
    s_mul_i32 s36, s36, 294912
    v_exp_f32 v209, v209
    v_mfma_f32_16x16x32_bf16 v[212:215], a[236:239], v[124:127], v[212:215]
    s_waitcnt lgkmcnt(3)
    s_add_u32 s46, s36, s6
    v_exp_f32 v210, v210
    v_exp_f32 v211, v211
    v_cvt_pk_bf16_f32 v146, v208, v209
    v_cvt_pk_bf16_f32 v147, v210, v211
    v_mfma_f32_16x16x32_bf16 v[208:211], a[208:211], v[64:67], v[192:195]
    s_waitcnt lgkmcnt(2)
    s_lshl_b32 s36, s4, 8
    ds_read_b128 a[224:227], v8 offset:12288
    v_mov_b32 v248, -1
    v_mfma_f32_16x16x32_bf16 v[208:211], a[212:215], v[68:71], v[208:211]
    s_waitcnt lgkmcnt(2)
    s_add_u32 s56, s47, s36
    v_exp_f32 v212, v212
    v_mfma_f32_16x16x32_bf16 v[208:211], a[216:219], v[72:75], v[208:211]
    s_waitcnt lgkmcnt(1)
    s_lshr_b32 s36, s4, 1
    v_exp_f32 v213, v213
    v_mfma_f32_16x16x32_bf16 v[208:211], a[220:223], v[76:79], v[208:211]
    s_lshl_b32 s36, s36, 11
    v_exp_f32 v214, v214
    v_exp_f32 v215, v215
    v_cvt_pk_bf16_f32 v154, v212, v213
    v_cvt_pk_bf16_f32 v155, v214, v215
    v_mfma_f32_16x16x32_bf16 v[212:215], a[208:211], v[80:83], v[196:199]
    s_lshl_b32 s7, s7, 8
    ds_read_b128 a[228:231], v9 offset:12288
    v_mov_b32 v249, -1
    v_mfma_f32_16x16x32_bf16 v[212:215], a[212:215], v[84:87], v[212:215]
    s_add_u32 s36, s36, s7
    v_exp_f32 v208, v208
    v_mfma_f32_16x16x32_bf16 v[212:215], a[216:219], v[88:91], v[212:215]
    s_add_u32 s93, s47, s36
    v_exp_f32 v209, v209
    v_mfma_f32_16x16x32_bf16 v[212:215], a[220:223], v[92:95], v[212:215]
    s_lshr_b32 s36, s4, 1
    v_exp_f32 v210, v210
    v_exp_f32 v211, v211
    v_cvt_pk_bf16_f32 v132, v208, v209
    v_cvt_pk_bf16_f32 v133, v210, v211
    v_mfma_f32_16x16x32_bf16 v[208:211], a[208:211], v[96:99], v[200:203]
    s_lshl_b32 s36, s36, 4
    ds_read_b128 a[232:235], v10 offset:12288
    v_mov_b32 v250, -1
    v_mfma_f32_16x16x32_bf16 v[208:211], a[212:215], v[100:103], v[208:211]
    s_add_u32 s36, s36, s5
    v_exp_f32 v212, v212
    v_mfma_f32_16x16x32_bf16 v[208:211], a[216:219], v[104:107], v[208:211]
    s_lshl_b32 s36, s36, 9
    v_exp_f32 v213, v213
    v_mfma_f32_16x16x32_bf16 v[208:211], a[220:223], v[108:111], v[208:211]
    s_add_u32 s36, s36, s7
    v_exp_f32 v214, v214
    v_exp_f32 v215, v215
    v_cvt_pk_bf16_f32 v140, v212, v213
    v_cvt_pk_bf16_f32 v141, v214, v215
    s_waitcnt vmcnt(4)
    s_barrier
    v_mfma_f32_16x16x32_bf16 v[212:215], a[208:211], v[112:115], v[204:207]
    s_lshl_b32 s36, s36, 8
    ds_read_b128 a[236:239], v11 offset:12288
    v_mov_b32 v251, -1
    v_mfma_f32_16x16x32_bf16 v[212:215], a[212:215], v[116:119], v[212:215]
    s_add_u32 m0, s42, 49152
    s_add_u32 s55, s36, 20971520
    v_exp_f32 v208, v208
    v_mfma_f32_16x16x32_bf16 v[212:215], a[216:219], v[120:123], v[212:215]
    s_add_u32 s7, s45, s6
    v_exp_f32 v209, v209
    v_mfma_f32_16x16x32_bf16 v[212:215], a[220:223], v[124:127], v[212:215]
    s_waitcnt lgkmcnt(3)
    s_xor_b32 s54, s92, 128
    v_exp_f32 v210, v210
    v_exp_f32 v211, v211
    v_cvt_pk_bf16_f32 v148, v208, v209
    v_cvt_pk_bf16_f32 v149, v210, v211
    buffer_load_dwordx4 v36, s[8:11], s40 offen lds
    v_mfma_f32_16x16x32_bf16 v[208:211], a[224:227], v[64:67], v[192:195]
    s_waitcnt lgkmcnt(2)
    s_lshl_b32 s36, s3, 14
    ds_read_b128 a[208:211], v8 offset:16384
    v_min_u32 v232, 41, v1
    v_mfma_f32_16x16x32_bf16 v[208:211], a[228:231], v[68:71], v[208:211]
    s_waitcnt lgkmcnt(2)
    v_exp_f32 v212, v212
    v_mfma_f32_16x16x32_bf16 v[208:211], a[232:235], v[72:75], v[208:211]
    s_waitcnt lgkmcnt(1)
    v_exp_f32 v213, v213
    v_mfma_f32_16x16x32_bf16 v[208:211], a[236:239], v[76:79], v[208:211]
    v_exp_f32 v214, v214
    v_exp_f32 v215, v215
    v_cvt_pk_bf16_f32 v156, v212, v213
    v_cvt_pk_bf16_f32 v157, v214, v215
    v_mfma_f32_16x16x32_bf16 v[212:215], a[224:227], v[80:83], v[196:199]
    ds_read_b128 a[212:215], v9 offset:16384
    v_mfma_f32_16x16x32_bf16 v[212:215], a[228:231], v[84:87], v[212:215]
    s_nop 0
    v_exp_f32 v208, v208
    v_mfma_f32_16x16x32_bf16 v[212:215], a[232:235], v[88:91], v[212:215]
    v_exp_f32 v209, v209
    v_mfma_f32_16x16x32_bf16 v[212:215], a[236:239], v[92:95], v[212:215]
    v_exp_f32 v210, v210
    v_exp_f32 v211, v211
    ds_read_b64_tr_b16 a[160:161], v20 offset:0
    v_cvt_pk_bf16_f32 v134, v208, v209
    v_lshl_add_u32 v252, v1, 4, s36
    v_lshlrev_b32 v232, 4, v232
    s_mov_b32 s57, s58
    s_lshl_b32 s6, s3, 10
    s_add_u32 s6, s6, 135168
    s_lshr_b32 s37, s2, 3
    s_mul_i32 s37, s37, -129024
    s_add_u32 s37, s37, 4128768
    ds_read_b64_tr_b16 a[162:163], v20 offset:4096
    ds_read_b128 a[216:219], v10 offset:16384
    v_cvt_pk_bf16_f32 v135, v210, v211
    buffer_load_dwordx4 v37, s[8:11], s40 offen offset:1024 lds
    v_mfma_f32_16x16x32_bf16 v[208:211], a[224:227], v[96:99], v[200:203]
    v_mfma_f32_16x16x32_bf16 v[208:211], a[228:231], v[100:103], v[208:211]
    v_exp_f32 v212, v212
    v_mfma_f32_16x16x32_bf16 v[208:211], a[232:235], v[104:107], v[208:211]
    v_exp_f32 v213, v213
    v_mfma_f32_16x16x32_bf16 v[208:211], a[236:239], v[108:111], v[208:211]
    s_mov_b32 s52, s55
    v_exp_f32 v214, v214
    v_exp_f32 v215, v215
    ds_read_b64_tr_b16 a[164:165], v20 offset:8192
    v_cvt_pk_bf16_f32 v142, v212, v213
    ds_read_b64_tr_b16 a[166:167], v20 offset:12288
    v_min_u32 v237, 19, v1
    v_lshl_add_u32 v237, v237, 7, s36
    v_lshl_add_u32 v238, v1, 7, s36
    ds_read_b128 a[220:223], v11 offset:16384
    v_cvt_pk_bf16_f32 v143, v214, v215
    buffer_load_dword v217, v57, s[32:35], s37 offen
    v_mfma_f32_16x16x32_bf16 v[212:215], a[224:227], v[112:115], v[204:207]
    v_mfma_f32_16x16x32_bf16 v[212:215], a[228:231], v[116:119], v[212:215]
    v_exp_f32 v208, v208
    v_mfma_f32_16x16x32_bf16 v[212:215], a[232:235], v[120:123], v[212:215]
    s_mul_i32 s37, s5, 18432
    v_exp_f32 v209, v209
    v_mfma_f32_16x16x32_bf16 v[212:215], a[236:239], v[124:127], v[212:215]
    s_add_u32 s37, s37, s45
    v_exp_f32 v210, v210
    v_exp_f32 v211, v211
    ds_read_b64_tr_b16 a[168:169], v21 offset:0
    v_cvt_pk_bf16_f32 v150, v208, v209
    ds_read_b64_tr_b16 a[170:171], v21 offset:4096
    v_min_u32 v236, 143, v0
    v_lshl_add_u32 v236, v236, 7, s37
    v_mul_u32_u24 v235, 24, v0
    v_lshrrev_b32 v235, 8, v235
    v_lshl_add_u32 v235, v235, 7, s37
    ds_read_b128 a[224:227], v8 offset:20480
    v_cvt_pk_bf16_f32 v151, v210, v211
    s_waitcnt lgkmcnt(3)
    buffer_load_dwordx4 v38, s[8:11], s40 offen offset:2048 lds
    s_nop 0
    s_nop 0
    s_nop 0
    s_nop 0
    s_nop 0
    s_nop 0
Lattn_loop:
    v_mfma_f32_16x16x32_bf16 v[208:211], a[208:211], v[64:67], v[192:195]
    v_exp_f32 v212, v212
    v_mfma_f32_16x16x32_bf16 v[208:211], a[212:215], v[68:71], v[208:211]
    v_exp_f32 v213, v213
    v_mfma_f32_16x16x32_bf16 v[208:211], a[216:219], v[72:75], v[208:211]
    v_exp_f32 v214, v214
    v_mfma_f32_16x16x32_bf16 v[208:211], a[220:223], v[76:79], v[208:211]
    v_exp_f32 v215, v215
    v_mfma_f32_16x16x32_bf16 a[0:3], a[160:163], v[128:131], a[0:3]
    ds_read_b64_tr_b16 a[172:173], v21 offset:8192
    v_cvt_pk_bf16_f32 v158, v212, v213
    v_mfma_f32_16x16x32_bf16 a[0:3], a[164:167], v[132:135], a[0:3]
    ds_read_b64_tr_b16 a[174:175], v21 offset:12288
    v_mfma_f32_16x16x32_bf16 a[4:7], a[164:167], v[140:143], a[4:7]
    ds_read_b128 a[228:231], v9 offset:20480
    v_cvt_pk_bf16_f32 v159, v214, v215
    v_mfma_f32_16x16x32_bf16 a[4:7], a[160:163], v[136:139], a[4:7]
    v_mfma_f32_16x16x32_bf16 v[212:215], a[208:211], v[80:83], v[196:199]
    v_exp_f32 v208, v208
    v_mfma_f32_16x16x32_bf16 v[212:215], a[212:215], v[84:87], v[212:215]
    v_exp_f32 v209, v209
    v_mfma_f32_16x16x32_bf16 v[212:215], a[216:219], v[88:91], v[212:215]
    v_exp_f32 v210, v210
    v_mfma_f32_16x16x32_bf16 v[212:215], a[220:223], v[92:95], v[212:215]
    v_exp_f32 v211, v211
    v_mfma_f32_16x16x32_bf16 a[8:11], a[160:163], v[144:147], a[8:11]
    ds_read_b64_tr_b16 a[176:177], v22 offset:0
    v_cvt_pk_bf16_f32 v160, v208, v209
    v_mfma_f32_16x16x32_bf16 a[8:11], a[164:167], v[148:151], a[8:11]
    ds_read_b64_tr_b16 a[178:179], v22 offset:4096
    v_mfma_f32_16x16x32_bf16 a[12:15], a[164:167], v[156:159], a[12:15]
    ds_read_b128 a[232:235], v10 offset:20480
    v_cvt_pk_bf16_f32 v161, v210, v211
    v_mfma_f32_16x16x32_bf16 a[12:15], a[160:163], v[152:155], a[12:15]
    s_waitcnt lgkmcnt(3)
    buffer_load_dwordx4 v39, s[8:11], s40 offen offset:3072 lds
    v_mfma_f32_16x16x32_bf16 v[208:211], a[208:211], v[96:99], v[200:203]
    v_exp_f32 v212, v212
    v_mfma_f32_16x16x32_bf16 v[208:211], a[212:215], v[100:103], v[208:211]
    s_add_u32 s40, s40, 16384
    v_exp_f32 v213, v213
    v_mfma_f32_16x16x32_bf16 v[208:211], a[216:219], v[104:107], v[208:211]
    s_mov_b32 m0, s6
    v_exp_f32 v214, v214
    v_mfma_f32_16x16x32_bf16 v[208:211], a[220:223], v[108:111], v[208:211]
    v_exp_f32 v215, v215
    v_mfma_f32_16x16x32_bf16 a[16:19], a[168:171], v[128:131], a[16:19]
    ds_read_b64_tr_b16 a[180:181], v22 offset:8192
    v_cvt_pk_bf16_f32 v168, v212, v213
    v_mfma_f32_16x16x32_bf16 a[16:19], a[172:175], v[132:135], a[16:19]
    ds_read_b64_tr_b16 a[182:183], v22 offset:12288
    v_mfma_f32_16x16x32_bf16 a[20:23], a[172:175], v[140:143], a[20:23]
    ds_read_b128 a[236:239], v11 offset:20480
    v_cvt_pk_bf16_f32 v169, v214, v215
    v_mfma_f32_16x16x32_bf16 a[20:23], a[168:171], v[136:139], a[20:23]
    buffer_load_dwordx4 v254, s[32:35], s57 offen  lds
    v_smfmac_f32_16x16x64_bf16 a[192:195], v[52:55], v[128:135], v50
    v_mfma_f32_16x16x32_bf16 v[212:215], a[208:211], v[112:115], v[204:207]
    v_exp_f32 v208, v208
    v_mfma_f32_16x16x32_bf16 v[212:215], a[212:215], v[116:119], v[212:215]
    s_add_u32 m0, s42, 98304
    v_exp_f32 v209, v209
    v_mfma_f32_16x16x32_bf16 v[212:215], a[216:219], v[120:123], v[212:215]
    v_exp_f32 v210, v210
    v_mfma_f32_16x16x32_bf16 v[212:215], a[220:223], v[124:127], v[212:215]
    v_exp_f32 v211, v211
    v_mfma_f32_16x16x32_bf16 a[24:27], a[168:171], v[144:147], a[24:27]
    ds_read_b64_tr_b16 a[184:185], v23 offset:0
    v_cvt_pk_bf16_f32 v176, v208, v209
    v_mfma_f32_16x16x32_bf16 a[24:27], a[172:175], v[148:151], a[24:27]
    ds_read_b64_tr_b16 a[186:187], v23 offset:4096
    v_mfma_f32_16x16x32_bf16 a[28:31], a[172:175], v[156:159], a[28:31]
    ds_read_b128 a[208:211], v8 offset:24576
    v_cvt_pk_bf16_f32 v177, v210, v211
    v_mfma_f32_16x16x32_bf16 a[28:31], a[168:171], v[152:155], a[28:31]
    s_waitcnt lgkmcnt(3)
    buffer_load_dwordx4 v40, s[12:15], s41 offen lds
    v_mfma_f32_16x16x32_bf16 v[208:211], a[224:227], v[64:67], v[192:195]
    v_exp_f32 v212, v212
    v_mfma_f32_16x16x32_bf16 v[208:211], a[228:231], v[68:71], v[208:211]
    s_add_u32 s6, s6, 4096
    v_exp_f32 v213, v213
    v_mfma_f32_16x16x32_bf16 v[208:211], a[232:235], v[72:75], v[208:211]
    s_add_u32 s57, s57, 589824
    v_exp_f32 v214, v214
    v_mfma_f32_16x16x32_bf16 v[208:211], a[236:239], v[76:79], v[208:211]
    v_exp_f32 v215, v215
    v_mfma_f32_16x16x32_bf16 a[32:35], a[176:179], v[128:131], a[32:35]
    ds_read_b64_tr_b16 a[188:189], v23 offset:8192
    v_cvt_pk_bf16_f32 v184, v212, v213
    v_mfma_f32_16x16x32_bf16 a[32:35], a[180:183], v[132:135], a[32:35]
    ds_read_b64_tr_b16 a[190:191], v23 offset:12288
    v_mfma_f32_16x16x32_bf16 a[36:39], a[180:183], v[140:143], a[36:39]
    ds_read_b128 a[212:215], v9 offset:24576
    v_cvt_pk_bf16_f32 v185, v214, v215
    v_mfma_f32_16x16x32_bf16 a[36:39], a[176:179], v[136:139], a[36:39]
    v_smfmac_f32_16x16x64_bf16 a[196:199], v[52:55], v[136:143], v50
    v_mfma_f32_16x16x32_bf16 v[212:215], a[224:227], v[80:83], v[196:199]
    v_exp_f32 v208, v208
    v_mfma_f32_16x16x32_bf16 v[212:215], a[228:231], v[84:87], v[212:215]
    v_exp_f32 v209, v209
    v_mfma_f32_16x16x32_bf16 v[212:215], a[232:235], v[88:91], v[212:215]
    v_exp_f32 v210, v210
    v_mfma_f32_16x16x32_bf16 v[212:215], a[236:239], v[92:95], v[212:215]
    v_exp_f32 v211, v211
    v_mfma_f32_16x16x32_bf16 a[40:43], a[176:179], v[144:147], a[40:43]
    ds_read_b64_tr_b16 a[160:161], v24 offset:0
    v_cvt_pk_bf16_f32 v162, v208, v209
    v_mfma_f32_16x16x32_bf16 a[40:43], a[180:183], v[148:151], a[40:43]
    ds_read_b64_tr_b16 a[162:163], v24 offset:4096
    v_mfma_f32_16x16x32_bf16 a[44:47], a[180:183], v[156:159], a[44:47]
    ds_read_b128 a[216:219], v10 offset:24576
    v_cvt_pk_bf16_f32 v163, v210, v211
    v_mfma_f32_16x16x32_bf16 a[44:47], a[176:179], v[152:155], a[44:47]
    s_waitcnt lgkmcnt(3)
    buffer_load_dwordx4 v41, s[12:15], s41 offen offset:1024 lds
    v_mfma_f32_16x16x32_bf16 v[208:211], a[224:227], v[96:99], v[200:203]
    v_exp_f32 v212, v212
    v_mfma_f32_16x16x32_bf16 v[208:211], a[228:231], v[100:103], v[208:211]
    v_exp_f32 v213, v213
    v_mfma_f32_16x16x32_bf16 v[208:211], a[232:235], v[104:107], v[208:211]
    v_exp_f32 v214, v214
    v_mfma_f32_16x16x32_bf16 v[208:211], a[236:239], v[108:111], v[208:211]
    v_exp_f32 v215, v215
    v_mfma_f32_16x16x32_bf16 a[48:51], a[184:187], v[128:131], a[48:51]
    ds_read_b64_tr_b16 a[164:165], v24 offset:8192
    v_cvt_pk_bf16_f32 v170, v212, v213
    v_mfma_f32_16x16x32_bf16 a[48:51], a[188:191], v[132:135], a[48:51]
    ds_read_b64_tr_b16 a[166:167], v24 offset:12288
    v_mfma_f32_16x16x32_bf16 a[52:55], a[188:191], v[140:143], a[52:55]
    ds_read_b128 a[220:223], v11 offset:24576
    v_cvt_pk_bf16_f32 v171, v214, v215
    v_mfma_f32_16x16x32_bf16 a[52:55], a[184:187], v[136:139], a[52:55]
    v_smfmac_f32_16x16x64_bf16 a[200:203], v[52:55], v[144:151], v50
    v_mfma_f32_16x16x32_bf16 v[212:215], a[224:227], v[112:115], v[204:207]
    v_exp_f32 v208, v208
    v_mfma_f32_16x16x32_bf16 v[212:215], a[228:231], v[116:119], v[212:215]
    v_exp_f32 v209, v209
    v_mfma_f32_16x16x32_bf16 v[212:215], a[232:235], v[120:123], v[212:215]
    v_exp_f32 v210, v210
    v_mfma_f32_16x16x32_bf16 v[212:215], a[236:239], v[124:127], v[212:215]
    v_exp_f32 v211, v211
    v_mfma_f32_16x16x32_bf16 a[56:59], a[184:187], v[144:147], a[56:59]
    ds_read_b64_tr_b16 a[168:169], v25 offset:0
    v_cvt_pk_bf16_f32 v178, v208, v209
    v_mfma_f32_16x16x32_bf16 a[56:59], a[188:191], v[148:151], a[56:59]
    ds_read_b64_tr_b16 a[170:171], v25 offset:4096
    v_mfma_f32_16x16x32_bf16 a[60:63], a[188:191], v[156:159], a[60:63]
    ds_read_b128 a[224:227], v8 offset:28672
    v_cvt_pk_bf16_f32 v179, v210, v211
    v_mfma_f32_16x16x32_bf16 a[60:63], a[184:187], v[152:155], a[60:63]
    s_waitcnt lgkmcnt(3)
    buffer_load_dwordx4 v40, s[12:15], s41 offen offset:2048 lds
    v_mfma_f32_16x16x32_bf16 v[208:211], a[208:211], v[64:67], v[192:195]
    v_exp_f32 v212, v212
    v_mfma_f32_16x16x32_bf16 v[208:211], a[212:215], v[68:71], v[208:211]
    v_exp_f32 v213, v213
    v_mfma_f32_16x16x32_bf16 v[208:211], a[216:219], v[72:75], v[208:211]
    v_exp_f32 v214, v214
    v_mfma_f32_16x16x32_bf16 v[208:211], a[220:223], v[76:79], v[208:211]
    v_exp_f32 v215, v215
    v_mfma_f32_16x16x32_bf16 a[64:67], a[160:163], v[128:131], a[64:67]
    ds_read_b64_tr_b16 a[172:173], v25 offset:8192
    v_cvt_pk_bf16_f32 v186, v212, v213
    v_mfma_f32_16x16x32_bf16 a[64:67], a[164:167], v[132:135], a[64:67]
    ds_read_b64_tr_b16 a[174:175], v25 offset:12288
    v_mfma_f32_16x16x32_bf16 a[68:71], a[164:167], v[140:143], a[68:71]
    ds_read_b128 a[228:231], v9 offset:28672
    v_cvt_pk_bf16_f32 v187, v214, v215
    v_mfma_f32_16x16x32_bf16 a[68:71], a[160:163], v[136:139], a[68:71]
    v_smfmac_f32_16x16x64_bf16 a[204:207], v[52:55], v[152:159], v50
    v_mfma_f32_16x16x32_bf16 v[212:215], a[208:211], v[80:83], v[196:199]
    v_exp_f32 v208, v208
    v_mfma_f32_16x16x32_bf16 v[212:215], a[212:215], v[84:87], v[212:215]
    v_exp_f32 v209, v209
    v_mfma_f32_16x16x32_bf16 v[212:215], a[216:219], v[88:91], v[212:215]
    v_exp_f32 v210, v210
    v_mfma_f32_16x16x32_bf16 v[212:215], a[220:223], v[92:95], v[212:215]
    v_exp_f32 v211, v211
    v_mfma_f32_16x16x32_bf16 a[72:75], a[160:163], v[144:147], a[72:75]
    ds_read_b64_tr_b16 a[176:177], v26 offset:0
    v_cvt_pk_bf16_f32 v164, v208, v209
    v_mfma_f32_16x16x32_bf16 a[72:75], a[164:167], v[148:151], a[72:75]
    ds_read_b64_tr_b16 a[178:179], v26 offset:4096
    v_mfma_f32_16x16x32_bf16 a[76:79], a[164:167], v[156:159], a[76:79]
    ds_read_b128 a[232:235], v10 offset:28672
    v_cvt_pk_bf16_f32 v165, v210, v211
    v_mfma_f32_16x16x32_bf16 a[76:79], a[160:163], v[152:155], a[76:79]
    s_waitcnt lgkmcnt(3)
    buffer_load_dwordx4 v41, s[12:15], s41 offen offset:3072 lds
    v_mfma_f32_16x16x32_bf16 v[208:211], a[208:211], v[96:99], v[200:203]
    v_exp_f32 v212, v212
    v_mfma_f32_16x16x32_bf16 v[208:211], a[212:215], v[100:103], v[208:211]
    s_add_u32 s41, s41, 16384
    v_exp_f32 v213, v213
    v_mfma_f32_16x16x32_bf16 v[208:211], a[216:219], v[104:107], v[208:211]
    v_exp_f32 v214, v214
    v_mfma_f32_16x16x32_bf16 v[208:211], a[220:223], v[108:111], v[208:211]
    v_exp_f32 v215, v215
    v_mfma_f32_16x16x32_bf16 a[80:83], a[168:171], v[128:131], a[80:83]
    ds_read_b64_tr_b16 a[180:181], v26 offset:8192
    v_cvt_pk_bf16_f32 v172, v212, v213
    v_mfma_f32_16x16x32_bf16 a[80:83], a[172:175], v[132:135], a[80:83]
    ds_read_b64_tr_b16 a[182:183], v26 offset:12288
    v_mfma_f32_16x16x32_bf16 a[84:87], a[172:175], v[140:143], a[84:87]
    ds_read_b128 a[236:239], v11 offset:28672
    v_cvt_pk_bf16_f32 v173, v214, v215
    v_mfma_f32_16x16x32_bf16 a[84:87], a[168:171], v[136:139], a[84:87]
    s_waitcnt vmcnt(10)
    s_barrier
    v_mfma_f32_16x16x32_bf16 v[212:215], a[208:211], v[112:115], v[204:207]
    v_exp_f32 v208, v208
    v_mfma_f32_16x16x32_bf16 v[212:215], a[212:215], v[116:119], v[212:215]
    s_add_u32 m0, s42, 0
    v_exp_f32 v209, v209
    v_mfma_f32_16x16x32_bf16 v[212:215], a[216:219], v[120:123], v[212:215]
    v_exp_f32 v210, v210
    v_mfma_f32_16x16x32_bf16 v[212:215], a[220:223], v[124:127], v[212:215]
    v_exp_f32 v211, v211
    v_mfma_f32_16x16x32_bf16 a[88:91], a[168:171], v[144:147], a[88:91]
    ds_read_b64_tr_b16 a[184:185], v27 offset:0
    v_cvt_pk_bf16_f32 v180, v208, v209
    v_mfma_f32_16x16x32_bf16 a[88:91], a[172:175], v[148:151], a[88:91]
    ds_read_b64_tr_b16 a[186:187], v27 offset:4096
    v_mfma_f32_16x16x32_bf16 a[92:95], a[172:175], v[156:159], a[92:95]
    ds_read_b128 a[208:211], v8 offset:32768
    v_cvt_pk_bf16_f32 v181, v210, v211
    v_mfma_f32_16x16x32_bf16 a[92:95], a[168:171], v[152:155], a[92:95]
    s_waitcnt lgkmcnt(3)
    buffer_load_dwordx4 v36, s[8:11], s40 offen lds
    v_mfma_f32_16x16x32_bf16 v[208:211], a[224:227], v[64:67], v[192:195]
    v_exp_f32 v212, v212
    v_mfma_f32_16x16x32_bf16 v[208:211], a[228:231], v[68:71], v[208:211]
    v_exp_f32 v213, v213
    v_mfma_f32_16x16x32_bf16 v[208:211], a[232:235], v[72:75], v[208:211]
    v_exp_f32 v214, v214
    v_mfma_f32_16x16x32_bf16 v[208:211], a[236:239], v[76:79], v[208:211]
    v_exp_f32 v215, v215
    v_mfma_f32_16x16x32_bf16 a[96:99], a[176:179], v[128:131], a[96:99]
    ds_read_b64_tr_b16 a[188:189], v27 offset:8192
    v_cvt_pk_bf16_f32 v188, v212, v213
    v_mfma_f32_16x16x32_bf16 a[96:99], a[180:183], v[132:135], a[96:99]
    ds_read_b64_tr_b16 a[190:191], v27 offset:12288
    v_mfma_f32_16x16x32_bf16 a[100:103], a[180:183], v[140:143], a[100:103]
    ds_read_b128 a[212:215], v9 offset:32768
    v_cvt_pk_bf16_f32 v189, v214, v215
    v_mfma_f32_16x16x32_bf16 a[100:103], a[176:179], v[136:139], a[100:103]
    v_mfma_f32_16x16x32_bf16 v[212:215], a[224:227], v[80:83], v[196:199]
    v_exp_f32 v208, v208
    v_mfma_f32_16x16x32_bf16 v[212:215], a[228:231], v[84:87], v[212:215]
    v_exp_f32 v209, v209
    v_mfma_f32_16x16x32_bf16 v[212:215], a[232:235], v[88:91], v[212:215]
    v_exp_f32 v210, v210
    v_mfma_f32_16x16x32_bf16 v[212:215], a[236:239], v[92:95], v[212:215]
    v_exp_f32 v211, v211
    v_mfma_f32_16x16x32_bf16 a[104:107], a[176:179], v[144:147], a[104:107]
    ds_read_b64_tr_b16 a[160:161], v20 offset:16384
    v_cvt_pk_bf16_f32 v166, v208, v209
    v_mfma_f32_16x16x32_bf16 a[104:107], a[180:183], v[148:151], a[104:107]
    ds_read_b64_tr_b16 a[162:163], v20 offset:20480
    v_mfma_f32_16x16x32_bf16 a[108:111], a[180:183], v[156:159], a[108:111]
    ds_read_b128 a[216:219], v10 offset:32768
    v_cvt_pk_bf16_f32 v167, v210, v211
    v_mfma_f32_16x16x32_bf16 a[108:111], a[176:179], v[152:155], a[108:111]
    s_waitcnt lgkmcnt(3)
    buffer_load_dwordx4 v37, s[8:11], s40 offen offset:1024 lds
    v_mfma_f32_16x16x32_bf16 v[208:211], a[224:227], v[96:99], v[200:203]
    v_exp_f32 v212, v212
    v_mfma_f32_16x16x32_bf16 v[208:211], a[228:231], v[100:103], v[208:211]
    v_exp_f32 v213, v213
    v_mfma_f32_16x16x32_bf16 v[208:211], a[232:235], v[104:107], v[208:211]
    v_exp_f32 v214, v214
    v_mfma_f32_16x16x32_bf16 v[208:211], a[236:239], v[108:111], v[208:211]
    v_exp_f32 v215, v215
    v_mfma_f32_16x16x32_bf16 a[112:115], a[184:187], v[128:131], a[112:115]
    ds_read_b64_tr_b16 a[164:165], v20 offset:24576
    v_cvt_pk_bf16_f32 v174, v212, v213
    v_mfma_f32_16x16x32_bf16 a[112:115], a[188:191], v[132:135], a[112:115]
    ds_read_b64_tr_b16 a[166:167], v20 offset:28672
    v_mfma_f32_16x16x32_bf16 a[116:119], a[188:191], v[140:143], a[116:119]
    ds_read_b128 a[220:223], v11 offset:32768
    v_cvt_pk_bf16_f32 v175, v214, v215
    v_mfma_f32_16x16x32_bf16 a[116:119], a[184:187], v[136:139], a[116:119]
    buffer_load_dwordx4 v[240:243], v7, s[16:19], s44 offen
    v_mfma_f32_16x16x32_bf16 v[212:215], a[224:227], v[112:115], v[204:207]
    v_exp_f32 v208, v208
    v_mfma_f32_16x16x32_bf16 v[212:215], a[228:231], v[116:119], v[212:215]
    v_exp_f32 v209, v209
    v_mfma_f32_16x16x32_bf16 v[212:215], a[232:235], v[120:123], v[212:215]
    v_exp_f32 v210, v210
    v_mfma_f32_16x16x32_bf16 v[212:215], a[236:239], v[124:127], v[212:215]
    s_add_u32 s44, s44, 884736
    v_exp_f32 v211, v211
    v_mfma_f32_16x16x32_bf16 a[120:123], a[184:187], v[144:147], a[120:123]
    ds_read_b64_tr_b16 a[168:169], v21 offset:16384
    v_cvt_pk_bf16_f32 v182, v208, v209
    v_mfma_f32_16x16x32_bf16 a[120:123], a[188:191], v[148:151], a[120:123]
    ds_read_b64_tr_b16 a[170:171], v21 offset:20480
    v_mfma_f32_16x16x32_bf16 a[124:127], a[188:191], v[156:159], a[124:127]
    ds_read_b128 a[224:227], v8 offset:36864
    v_cvt_pk_bf16_f32 v183, v210, v211
    v_mfma_f32_16x16x32_bf16 a[124:127], a[184:187], v[152:155], a[124:127]
    s_waitcnt lgkmcnt(3)
    buffer_load_dwordx4 v38, s[8:11], s40 offen offset:2048 lds
    v_mfma_f32_16x16x32_bf16 v[208:211], a[208:211], v[64:67], v[192:195]
    v_exp_f32 v212, v212
    v_mfma_f32_16x16x32_bf16 v[208:211], a[212:215], v[68:71], v[208:211]
    v_exp_f32 v213, v213
    v_mfma_f32_16x16x32_bf16 v[208:211], a[216:219], v[72:75], v[208:211]
    v_exp_f32 v214, v214
    v_mfma_f32_16x16x32_bf16 v[208:211], a[220:223], v[76:79], v[208:211]
    v_exp_f32 v215, v215
    v_mfma_f32_16x16x32_bf16 a[0:3], a[160:163], v[160:163], a[0:3]
    ds_read_b64_tr_b16 a[172:173], v21 offset:24576
    v_cvt_pk_bf16_f32 v190, v212, v213
    v_mfma_f32_16x16x32_bf16 a[0:3], a[164:167], v[164:167], a[0:3]
Ltour0_4:
    s_cbranch_execz Ltour0_8
    ds_read_b64_tr_b16 a[174:175], v21 offset:28672
    v_mfma_f32_16x16x32_bf16 a[4:7], a[164:167], v[172:175], a[4:7]
    ds_read_b128 a[228:231], v9 offset:36864
    v_cvt_pk_bf16_f32 v191, v214, v215
    v_mfma_f32_16x16x32_bf16 a[4:7], a[160:163], v[168:171], a[4:7]
    v_mfma_f32_16x16x32_bf16 v[212:215], a[208:211], v[80:83], v[196:199]
    v_exp_f32 v208, v208
    v_mfma_f32_16x16x32_bf16 v[212:215], a[212:215], v[84:87], v[212:215]
    v_exp_f32 v209, v209
    v_mfma_f32_16x16x32_bf16 v[212:215], a[216:219], v[88:91], v[212:215]
    v_exp_f32 v210, v210
    v_mfma_f32_16x16x32_bf16 v[212:215], a[220:223], v[92:95], v[212:215]
    v_exp_f32 v211, v211
    v_mfma_f32_16x16x32_bf16 a[8:11], a[160:163], v[176:179], a[8:11]
    ds_read_b64_tr_b16 a[176:177], v22 offset:16384
    v_cvt_pk_bf16_f32 v128, v208, v209
    v_mfma_f32_16x16x32_bf16 a[8:11], a[164:167], v[180:183], a[8:11]
    ds_read_b64_tr_b16 a[178:179], v22 offset:20480
    v_mfma_f32_16x16x32_bf16 a[12:15], a[164:167], v[188:191], a[12:15]
    ds_read_b128 a[232:235], v10 offset:36864
    v_cvt_pk_bf16_f32 v129, v210, v211
    v_mfma_f32_16x16x32_bf16 a[12:15], a[160:163], v[184:187], a[12:15]
    s_waitcnt lgkmcnt(3)
    buffer_load_dwordx4 v39, s[8:11], s40 offen offset:3072 lds
    v_mfma_f32_16x16x32_bf16 v[208:211], a[208:211], v[96:99], v[200:203]
    v_exp_f32 v212, v212
    v_mfma_f32_16x16x32_bf16 v[208:211], a[212:215], v[100:103], v[208:211]
    s_add_u32 s40, s40, 16384
    v_exp_f32 v213, v213
    v_mfma_f32_16x16x32_bf16 v[208:211], a[216:219], v[104:107], v[208:211]
    v_exp_f32 v214, v214
    v_mfma_f32_16x16x32_bf16 v[208:211], a[220:223], v[108:111], v[208:211]
    v_exp_f32 v215, v215
    v_mfma_f32_16x16x32_bf16 a[16:19], a[168:171], v[160:163], a[16:19]
    ds_read_b64_tr_b16 a[180:181], v22 offset:24576
    v_cvt_pk_bf16_f32 v136, v212, v213
    v_mfma_f32_16x16x32_bf16 a[16:19], a[172:175], v[164:167], a[16:19]
    ds_read_b64_tr_b16 a[182:183], v22 offset:28672
    v_mfma_f32_16x16x32_bf16 a[20:23], a[172:175], v[172:175], a[20:23]
    ds_read_b128 a[236:239], v11 offset:36864
    v_cvt_pk_bf16_f32 v137, v214, v215
    v_mfma_f32_16x16x32_bf16 a[20:23], a[168:171], v[168:171], a[20:23]
    v_smfmac_f32_16x16x64_bf16 a[192:195], v[52:55], v[160:167], v50
    v_mfma_f32_16x16x32_bf16 v[212:215], a[208:211], v[112:115], v[204:207]
    v_exp_f32 v208, v208
    v_mfma_f32_16x16x32_bf16 v[212:215], a[212:215], v[116:119], v[212:215]
    s_add_u32 m0, s42, 114688
    v_exp_f32 v209, v209
    v_mfma_f32_16x16x32_bf16 v[212:215], a[216:219], v[120:123], v[212:215]
    v_exp_f32 v210, v210
    v_mfma_f32_16x16x32_bf16 v[212:215], a[220:223], v[124:127], v[212:215]
    v_exp_f32 v211, v211
    v_mfma_f32_16x16x32_bf16 a[24:27], a[168:171], v[176:179], a[24:27]
    ds_read_b64_tr_b16 a[184:185], v23 offset:16384
    v_cvt_pk_bf16_f32 v144, v208, v209
    v_mfma_f32_16x16x32_bf16 a[24:27], a[172:175], v[180:183], a[24:27]
    ds_read_b64_tr_b16 a[186:187], v23 offset:20480
    v_mfma_f32_16x16x32_bf16 a[28:31], a[172:175], v[188:191], a[28:31]
    ds_read_b128 a[208:211], v8 offset:40960
    v_cvt_pk_bf16_f32 v145, v210, v211
    v_mfma_f32_16x16x32_bf16 a[28:31], a[168:171], v[184:187], a[28:31]
    s_waitcnt lgkmcnt(3)
    buffer_load_dwordx4 v40, s[12:15], s41 offen lds
    v_mfma_f32_16x16x32_bf16 v[208:211], a[224:227], v[64:67], v[192:195]
    v_exp_f32 v212, v212
    v_mfma_f32_16x16x32_bf16 v[208:211], a[228:231], v[68:71], v[208:211]
    v_exp_f32 v213, v213
    v_mfma_f32_16x16x32_bf16 v[208:211], a[232:235], v[72:75], v[208:211]
    v_exp_f32 v214, v214
    v_mfma_f32_16x16x32_bf16 v[208:211], a[236:239], v[76:79], v[208:211]
    v_exp_f32 v215, v215
    v_mfma_f32_16x16x32_bf16 a[32:35], a[176:179], v[160:163], a[32:35]
    ds_read_b64_tr_b16 a[188:189], v23 offset:24576
    v_cvt_pk_bf16_f32 v152, v212, v213
    v_mfma_f32_16x16x32_bf16 a[32:35], a[180:183], v[164:167], a[32:35]
    ds_read_b64_tr_b16 a[190:191], v23 offset:28672
    v_mfma_f32_16x16x32_bf16 a[36:39], a[180:183], v[172:175], a[36:39]
    ds_read_b128 a[212:215], v9 offset:40960
    v_cvt_pk_bf16_f32 v153, v214, v215
    v_mfma_f32_16x16x32_bf16 a[36:39], a[176:179], v[168:171], a[36:39]
    v_smfmac_f32_16x16x64_bf16 a[196:199], v[52:55], v[168:175], v50
    v_mfma_f32_16x16x32_bf16 v[212:215], a[224:227], v[80:83], v[196:199]
    v_exp_f32 v208, v208
    v_mfma_f32_16x16x32_bf16 v[212:215], a[228:231], v[84:87], v[212:215]
    v_exp_f32 v209, v209
    v_mfma_f32_16x16x32_bf16 v[212:215], a[232:235], v[88:91], v[212:215]
    v_exp_f32 v210, v210
    v_mfma_f32_16x16x32_bf16 v[212:215], a[236:239], v[92:95], v[212:215]
    v_exp_f32 v211, v211
    v_mfma_f32_16x16x32_bf16 a[40:43], a[176:179], v[176:179], a[40:43]
    ds_read_b64_tr_b16 a[160:161], v24 offset:16384
    v_cvt_pk_bf16_f32 v130, v208, v209
    v_mfma_f32_16x16x32_bf16 a[40:43], a[180:183], v[180:183], a[40:43]
    ds_read_b64_tr_b16 a[162:163], v24 offset:20480
    v_mfma_f32_16x16x32_bf16 a[44:47], a[180:183], v[188:191], a[44:47]
    ds_read_b128 a[216:219], v10 offset:40960
    v_cvt_pk_bf16_f32 v131, v210, v211
    v_mfma_f32_16x16x32_bf16 a[44:47], a[176:179], v[184:187], a[44:47]
    s_waitcnt lgkmcnt(3)
    buffer_load_dwordx4 v41, s[12:15], s41 offen offset:1024 lds
    v_mfma_f32_16x16x32_bf16 v[208:211], a[224:227], v[96:99], v[200:203]
    v_exp_f32 v212, v212
    v_mfma_f32_16x16x32_bf16 v[208:211], a[228:231], v[100:103], v[208:211]
    v_exp_f32 v213, v213
    v_mfma_f32_16x16x32_bf16 v[208:211], a[232:235], v[104:107], v[208:211]
    v_exp_f32 v214, v214
    v_mfma_f32_16x16x32_bf16 v[208:211], a[236:239], v[108:111], v[208:211]
    v_exp_f32 v215, v215
    v_mfma_f32_16x16x32_bf16 a[48:51], a[184:187], v[160:163], a[48:51]
    ds_read_b64_tr_b16 a[164:165], v24 offset:24576
    v_cvt_pk_bf16_f32 v138, v212, v213
    v_mfma_f32_16x16x32_bf16 a[48:51], a[188:191], v[164:167], a[48:51]
    ds_read_b64_tr_b16 a[166:167], v24 offset:28672
    v_mfma_f32_16x16x32_bf16 a[52:55], a[188:191], v[172:175], a[52:55]
    ds_read_b128 a[220:223], v11 offset:40960
    v_cvt_pk_bf16_f32 v139, v214, v215
    v_mfma_f32_16x16x32_bf16 a[52:55], a[184:187], v[168:171], a[52:55]
    v_smfmac_f32_16x16x64_bf16 a[200:203], v[52:55], v[176:183], v50
    v_mfma_f32_16x16x32_bf16 v[212:215], a[224:227], v[112:115], v[204:207]
    v_exp_f32 v208, v208
    v_mfma_f32_16x16x32_bf16 v[212:215], a[228:231], v[116:119], v[212:215]
    v_exp_f32 v209, v209
    v_mfma_f32_16x16x32_bf16 v[212:215], a[232:235], v[120:123], v[212:215]
    v_exp_f32 v210, v210
    v_mfma_f32_16x16x32_bf16 v[212:215], a[236:239], v[124:127], v[212:215]
    v_exp_f32 v211, v211
    v_mfma_f32_16x16x32_bf16 a[56:59], a[184:187], v[176:179], a[56:59]
    ds_read_b64_tr_b16 a[168:169], v25 offset:16384
    v_cvt_pk_bf16_f32 v146, v208, v209
    v_mfma_f32_16x16x32_bf16 a[56:59], a[188:191], v[180:183], a[56:59]
    ds_read_b64_tr_b16 a[170:171], v25 offset:20480
    v_mfma_f32_16x16x32_bf16 a[60:63], a[188:191], v[188:191], a[60:63]
    ds_read_b128 a[224:227], v8 offset:45056
    v_cvt_pk_bf16_f32 v147, v210, v211
    v_mfma_f32_16x16x32_bf16 a[60:63], a[184:187], v[184:187], a[60:63]
    s_waitcnt lgkmcnt(3)
    buffer_load_dwordx4 v40, s[12:15], s41 offen offset:2048 lds
    v_mfma_f32_16x16x32_bf16 v[208:211], a[208:211], v[64:67], v[192:195]
    v_exp_f32 v212, v212
    v_mfma_f32_16x16x32_bf16 v[208:211], a[212:215], v[68:71], v[208:211]
    v_exp_f32 v213, v213
    v_mfma_f32_16x16x32_bf16 v[208:211], a[216:219], v[72:75], v[208:211]
    v_exp_f32 v214, v214
    v_mfma_f32_16x16x32_bf16 v[208:211], a[220:223], v[76:79], v[208:211]
    v_exp_f32 v215, v215
    v_mfma_f32_16x16x32_bf16 a[64:67], a[160:163], v[160:163], a[64:67]
    ds_read_b64_tr_b16 a[172:173], v25 offset:24576
    v_cvt_pk_bf16_f32 v154, v212, v213
    v_mfma_f32_16x16x32_bf16 a[64:67], a[164:167], v[164:167], a[64:67]
    ds_read_b64_tr_b16 a[174:175], v25 offset:28672
    v_mfma_f32_16x16x32_bf16 a[68:71], a[164:167], v[172:175], a[68:71]
    ds_read_b128 a[228:231], v9 offset:45056
    v_cvt_pk_bf16_f32 v155, v214, v215
    v_mfma_f32_16x16x32_bf16 a[68:71], a[160:163], v[168:171], a[68:71]
    v_smfmac_f32_16x16x64_bf16 a[204:207], v[52:55], v[184:191], v50
    v_mfma_f32_16x16x32_bf16 v[212:215], a[208:211], v[80:83], v[196:199]
    v_exp_f32 v208, v208
    v_mfma_f32_16x16x32_bf16 v[212:215], a[212:215], v[84:87], v[212:215]
    v_exp_f32 v209, v209
    v_mfma_f32_16x16x32_bf16 v[212:215], a[216:219], v[88:91], v[212:215]
    v_exp_f32 v210, v210
    v_mfma_f32_16x16x32_bf16 v[212:215], a[220:223], v[92:95], v[212:215]
    v_exp_f32 v211, v211
    v_mfma_f32_16x16x32_bf16 a[72:75], a[160:163], v[176:179], a[72:75]
    ds_read_b64_tr_b16 a[176:177], v26 offset:16384
    v_cvt_pk_bf16_f32 v132, v208, v209
    v_mfma_f32_16x16x32_bf16 a[72:75], a[164:167], v[180:183], a[72:75]
    ds_read_b64_tr_b16 a[178:179], v26 offset:20480
    v_mfma_f32_16x16x32_bf16 a[76:79], a[164:167], v[188:191], a[76:79]
    ds_read_b128 a[232:235], v10 offset:45056
    v_cvt_pk_bf16_f32 v133, v210, v211
    v_mfma_f32_16x16x32_bf16 a[76:79], a[160:163], v[184:187], a[76:79]
    s_waitcnt lgkmcnt(3)
    buffer_load_dwordx4 v41, s[12:15], s41 offen offset:3072 lds
    v_mfma_f32_16x16x32_bf16 v[208:211], a[208:211], v[96:99], v[200:203]
    v_exp_f32 v212, v212
    v_mfma_f32_16x16x32_bf16 v[208:211], a[212:215], v[100:103], v[208:211]
    s_add_u32 s41, s41, 16384
    v_exp_f32 v213, v213
    v_mfma_f32_16x16x32_bf16 v[208:211], a[216:219], v[104:107], v[208:211]
    v_exp_f32 v214, v214
    v_mfma_f32_16x16x32_bf16 v[208:211], a[220:223], v[108:111], v[208:211]
    v_exp_f32 v215, v215
    v_mfma_f32_16x16x32_bf16 a[80:83], a[168:171], v[160:163], a[80:83]
    ds_read_b64_tr_b16 a[180:181], v26 offset:24576
    v_cvt_pk_bf16_f32 v140, v212, v213
    v_mfma_f32_16x16x32_bf16 a[80:83], a[172:175], v[164:167], a[80:83]
    ds_read_b64_tr_b16 a[182:183], v26 offset:28672
    v_mfma_f32_16x16x32_bf16 a[84:87], a[172:175], v[172:175], a[84:87]
    ds_read_b128 a[236:239], v11 offset:45056
    v_cvt_pk_bf16_f32 v141, v214, v215
    v_mfma_f32_16x16x32_bf16 a[84:87], a[168:171], v[168:171], a[84:87]
    s_waitcnt vmcnt(9)
    s_barrier
    v_mfma_f32_16x16x32_bf16 v[212:215], a[208:211], v[112:115], v[204:207]
    v_exp_f32 v208, v208
    v_mfma_f32_16x16x32_bf16 v[212:215], a[212:215], v[116:119], v[212:215]
    s_add_u32 m0, s42, 16384
    v_exp_f32 v209, v209
    v_mfma_f32_16x16x32_bf16 v[212:215], a[216:219], v[120:123], v[212:215]
    v_exp_f32 v210, v210
    v_mfma_f32_16x16x32_bf16 v[212:215], a[220:223], v[124:127], v[212:215]
    v_exp_f32 v211, v211
    v_mfma_f32_16x16x32_bf16 a[88:91], a[168:171], v[176:179], a[88:91]
    ds_read_b64_tr_b16 a[184:185], v27 offset:16384
    v_cvt_pk_bf16_f32 v148, v208, v209
    v_mfma_f32_16x16x32_bf16 a[88:91], a[172:175], v[180:183], a[88:91]
    ds_read_b64_tr_b16 a[186:187], v27 offset:20480
    v_mfma_f32_16x16x32_bf16 a[92:95], a[172:175], v[188:191], a[92:95]
    ds_read_b128 a[208:211], v8 offset:49152
    v_cvt_pk_bf16_f32 v149, v210, v211
    v_mfma_f32_16x16x32_bf16 a[92:95], a[168:171], v[184:187], a[92:95]
    s_waitcnt lgkmcnt(3)
    buffer_load_dwordx4 v36, s[8:11], s40 offen lds
    v_mfma_f32_16x16x32_bf16 v[208:211], a[224:227], v[64:67], v[192:195]
    v_exp_f32 v212, v212
    v_mfma_f32_16x16x32_bf16 v[208:211], a[228:231], v[68:71], v[208:211]
    v_exp_f32 v213, v213
    v_mfma_f32_16x16x32_bf16 v[208:211], a[232:235], v[72:75], v[208:211]
    v_exp_f32 v214, v214
    v_mfma_f32_16x16x32_bf16 v[208:211], a[236:239], v[76:79], v[208:211]
    v_exp_f32 v215, v215
    v_mfma_f32_16x16x32_bf16 a[96:99], a[176:179], v[160:163], a[96:99]
    ds_read_b64_tr_b16 a[188:189], v27 offset:24576
    v_cvt_pk_bf16_f32 v156, v212, v213
    v_mfma_f32_16x16x32_bf16 a[96:99], a[180:183], v[164:167], a[96:99]
    ds_read_b64_tr_b16 a[190:191], v27 offset:28672
    v_mfma_f32_16x16x32_bf16 a[100:103], a[180:183], v[172:175], a[100:103]
    ds_read_b128 a[212:215], v9 offset:49152
    v_cvt_pk_bf16_f32 v157, v214, v215
    v_mfma_f32_16x16x32_bf16 a[100:103], a[176:179], v[168:171], a[100:103]
    buffer_load_dword v218, v57, s[80:83], s39 offen
    v_mfma_f32_16x16x32_bf16 v[212:215], a[224:227], v[80:83], v[196:199]
    v_exp_f32 v208, v208
    v_mfma_f32_16x16x32_bf16 v[212:215], a[228:231], v[84:87], v[212:215]
    v_exp_f32 v209, v209
    v_mfma_f32_16x16x32_bf16 v[212:215], a[232:235], v[88:91], v[212:215]
    v_exp_f32 v210, v210
    v_mfma_f32_16x16x32_bf16 v[212:215], a[236:239], v[92:95], v[212:215]
    v_exp_f32 v211, v211
    v_mfma_f32_16x16x32_bf16 a[104:107], a[176:179], v[176:179], a[104:107]
    ds_read_b64_tr_b16 a[160:161], v20 offset:32768
    v_cvt_pk_bf16_f32 v134, v208, v209
    v_mfma_f32_16x16x32_bf16 a[104:107], a[180:183], v[180:183], a[104:107]
    ds_read_b64_tr_b16 a[162:163], v20 offset:36864
    v_mfma_f32_16x16x32_bf16 a[108:111], a[180:183], v[188:191], a[108:111]
    ds_read_b128 a[216:219], v10 offset:49152
    v_cvt_pk_bf16_f32 v135, v210, v211
    v_mfma_f32_16x16x32_bf16 a[108:111], a[176:179], v[184:187], a[108:111]
    s_waitcnt lgkmcnt(3)
    buffer_load_dwordx4 v37, s[8:11], s40 offen offset:1024 lds
    v_mfma_f32_16x16x32_bf16 v[208:211], a[224:227], v[96:99], v[200:203]
    v_exp_f32 v212, v212
    v_mfma_f32_16x16x32_bf16 v[208:211], a[228:231], v[100:103], v[208:211]
    v_exp_f32 v213, v213
    v_mfma_f32_16x16x32_bf16 v[208:211], a[232:235], v[104:107], v[208:211]
    v_exp_f32 v214, v214
    v_mfma_f32_16x16x32_bf16 v[208:211], a[236:239], v[108:111], v[208:211]
    v_exp_f32 v215, v215
    v_mfma_f32_16x16x32_bf16 a[112:115], a[184:187], v[160:163], a[112:115]
    ds_read_b64_tr_b16 a[164:165], v20 offset:40960
    v_cvt_pk_bf16_f32 v142, v212, v213
    v_mfma_f32_16x16x32_bf16 a[112:115], a[188:191], v[164:167], a[112:115]
    ds_read_b64_tr_b16 a[166:167], v20 offset:45056
    v_mfma_f32_16x16x32_bf16 a[116:119], a[188:191], v[172:175], a[116:119]
    ds_read_b128 a[220:223], v11 offset:49152
    v_cvt_pk_bf16_f32 v143, v214, v215
    v_mfma_f32_16x16x32_bf16 a[116:119], a[184:187], v[168:171], a[116:119]
    buffer_store_dwordx4 v[248:251], v232, s[24:27], s53 offen sc1
    v_mfma_f32_16x16x32_bf16 v[212:215], a[224:227], v[112:115], v[204:207]
    v_exp_f32 v208, v208
    v_mfma_f32_16x16x32_bf16 v[212:215], a[228:231], v[116:119], v[212:215]
    v_exp_f32 v209, v209
    v_mfma_f32_16x16x32_bf16 v[212:215], a[232:235], v[120:123], v[212:215]
    v_exp_f32 v210, v210
    v_mfma_f32_16x16x32_bf16 v[212:215], a[236:239], v[124:127], v[212:215]
    s_add_u32 s53, s53, 656
    v_exp_f32 v211, v211
    v_mfma_f32_16x16x32_bf16 a[120:123], a[184:187], v[176:179], a[120:123]
    ds_read_b64_tr_b16 a[168:169], v21 offset:32768
    v_cvt_pk_bf16_f32 v150, v208, v209
    v_mfma_f32_16x16x32_bf16 a[120:123], a[188:191], v[180:183], a[120:123]
    ds_read_b64_tr_b16 a[170:171], v21 offset:36864
    v_mfma_f32_16x16x32_bf16 a[124:127], a[188:191], v[188:191], a[124:127]
    ds_read_b128 a[224:227], v8 offset:53248
    v_cvt_pk_bf16_f32 v151, v210, v211
    v_mfma_f32_16x16x32_bf16 a[124:127], a[184:187], v[184:187], a[124:127]
    s_waitcnt lgkmcnt(3)
    buffer_load_dwordx4 v38, s[8:11], s40 offen offset:2048 lds
    v_mfma_f32_16x16x32_bf16 v[208:211], a[208:211], v[64:67], v[192:195]
    v_exp_f32 v212, v212
    v_mfma_f32_16x16x32_bf16 v[208:211], a[212:215], v[68:71], v[208:211]
    v_exp_f32 v213, v213
    v_mfma_f32_16x16x32_bf16 v[208:211], a[216:219], v[72:75], v[208:211]
    v_exp_f32 v214, v214
    v_mfma_f32_16x16x32_bf16 v[208:211], a[220:223], v[76:79], v[208:211]
    v_exp_f32 v215, v215
    v_mfma_f32_16x16x32_bf16 a[0:3], a[160:163], v[128:131], a[0:3]
    ds_read_b64_tr_b16 a[172:173], v21 offset:40960
    v_cvt_pk_bf16_f32 v158, v212, v213
    v_mfma_f32_16x16x32_bf16 a[0:3], a[164:167], v[132:135], a[0:3]
    ds_read_b64_tr_b16 a[174:175], v21 offset:45056
    v_mfma_f32_16x16x32_bf16 a[4:7], a[164:167], v[140:143], a[4:7]
    ds_read_b128 a[228:231], v9 offset:53248
    v_cvt_pk_bf16_f32 v159, v214, v215
    v_mfma_f32_16x16x32_bf16 a[4:7], a[160:163], v[136:139], a[4:7]
    v_mfma_f32_16x16x32_bf16 v[212:215], a[208:211], v[80:83], v[196:199]
    v_exp_f32 v208, v208
    v_mfma_f32_16x16x32_bf16 v[212:215], a[212:215], v[84:87], v[212:215]
    v_exp_f32 v209, v209
    v_mfma_f32_16x16x32_bf16 v[212:215], a[216:219], v[88:91], v[212:215]
    v_exp_f32 v210, v210
    v_mfma_f32_16x16x32_bf16 v[212:215], a[220:223], v[92:95], v[212:215]
    v_exp_f32 v211, v211
    v_mfma_f32_16x16x32_bf16 a[8:11], a[160:163], v[144:147], a[8:11]
    ds_read_b64_tr_b16 a[176:177], v22 offset:32768
    v_cvt_pk_bf16_f32 v160, v208, v209
    v_mfma_f32_16x16x32_bf16 a[8:11], a[164:167], v[148:151], a[8:11]
    ds_read_b64_tr_b16 a[178:179], v22 offset:36864
    v_mfma_f32_16x16x32_bf16 a[12:15], a[164:167], v[156:159], a[12:15]
    ds_read_b128 a[232:235], v10 offset:53248
    v_cvt_pk_bf16_f32 v161, v210, v211
    v_mfma_f32_16x16x32_bf16 a[12:15], a[160:163], v[152:155], a[12:15]
    s_waitcnt lgkmcnt(3)
    buffer_load_dwordx4 v39, s[8:11], s40 offen offset:3072 lds
    v_mfma_f32_16x16x32_bf16 v[208:211], a[208:211], v[96:99], v[200:203]
    v_exp_f32 v212, v212
    v_mfma_f32_16x16x32_bf16 v[208:211], a[212:215], v[100:103], v[208:211]
    s_add_u32 s40, s40, 16384
    v_exp_f32 v213, v213
    v_mfma_f32_16x16x32_bf16 v[208:211], a[216:219], v[104:107], v[208:211]
    v_exp_f32 v214, v214
    v_mfma_f32_16x16x32_bf16 v[208:211], a[220:223], v[108:111], v[208:211]
    v_exp_f32 v215, v215
    v_mfma_f32_16x16x32_bf16 a[16:19], a[168:171], v[128:131], a[16:19]
    ds_read_b64_tr_b16 a[180:181], v22 offset:40960
    v_cvt_pk_bf16_f32 v168, v212, v213
    v_mfma_f32_16x16x32_bf16 a[16:19], a[172:175], v[132:135], a[16:19]
    ds_read_b64_tr_b16 a[182:183], v22 offset:45056
    v_mfma_f32_16x16x32_bf16 a[20:23], a[172:175], v[140:143], a[20:23]
    ds_read_b128 a[236:239], v11 offset:53248
    v_cvt_pk_bf16_f32 v169, v214, v215
    v_mfma_f32_16x16x32_bf16 a[20:23], a[168:171], v[136:139], a[20:23]
    v_smfmac_f32_16x16x64_bf16 a[192:195], v[52:55], v[128:135], v50
    v_mfma_f32_16x16x32_bf16 v[212:215], a[208:211], v[112:115], v[204:207]
    v_exp_f32 v208, v208
    v_mfma_f32_16x16x32_bf16 v[212:215], a[212:215], v[116:119], v[212:215]
    s_add_u32 m0, s42, 65536
    v_exp_f32 v209, v209
    v_mfma_f32_16x16x32_bf16 v[212:215], a[216:219], v[120:123], v[212:215]
    v_exp_f32 v210, v210
    v_mfma_f32_16x16x32_bf16 v[212:215], a[220:223], v[124:127], v[212:215]
    v_exp_f32 v211, v211
    v_mfma_f32_16x16x32_bf16 a[24:27], a[168:171], v[144:147], a[24:27]
    ds_read_b64_tr_b16 a[184:185], v23 offset:32768
    v_cvt_pk_bf16_f32 v176, v208, v209
    v_mfma_f32_16x16x32_bf16 a[24:27], a[172:175], v[148:151], a[24:27]
    ds_read_b64_tr_b16 a[186:187], v23 offset:36864
    v_mfma_f32_16x16x32_bf16 a[28:31], a[172:175], v[156:159], a[28:31]
    ds_read_b128 a[208:211], v8 offset:57344
    v_cvt_pk_bf16_f32 v177, v210, v211
    v_mfma_f32_16x16x32_bf16 a[28:31], a[168:171], v[152:155], a[28:31]
    s_waitcnt lgkmcnt(3)
    buffer_load_dwordx4 v40, s[12:15], s41 offen lds
    v_mfma_f32_16x16x32_bf16 v[208:211], a[224:227], v[64:67], v[192:195]
    v_exp_f32 v212, v212
    v_mfma_f32_16x16x32_bf16 v[208:211], a[228:231], v[68:71], v[208:211]
    v_exp_f32 v213, v213
    v_mfma_f32_16x16x32_bf16 v[208:211], a[232:235], v[72:75], v[208:211]
    v_exp_f32 v214, v214
    v_mfma_f32_16x16x32_bf16 v[208:211], a[236:239], v[76:79], v[208:211]
    v_exp_f32 v215, v215
    v_mfma_f32_16x16x32_bf16 a[32:35], a[176:179], v[128:131], a[32:35]
    ds_read_b64_tr_b16 a[188:189], v23 offset:40960
    v_cvt_pk_bf16_f32 v184, v212, v213
    v_mfma_f32_16x16x32_bf16 a[32:35], a[180:183], v[132:135], a[32:35]
    ds_read_b64_tr_b16 a[190:191], v23 offset:45056
    v_mfma_f32_16x16x32_bf16 a[36:39], a[180:183], v[140:143], a[36:39]
    ds_read_b128 a[212:215], v9 offset:57344
    v_cvt_pk_bf16_f32 v185, v214, v215
    v_mfma_f32_16x16x32_bf16 a[36:39], a[176:179], v[136:139], a[36:39]
    v_smfmac_f32_16x16x64_bf16 a[196:199], v[52:55], v[136:143], v50
    v_mfma_f32_16x16x32_bf16 v[212:215], a[224:227], v[80:83], v[196:199]
    v_exp_f32 v208, v208
    v_mfma_f32_16x16x32_bf16 v[212:215], a[228:231], v[84:87], v[212:215]
    v_exp_f32 v209, v209
    v_mfma_f32_16x16x32_bf16 v[212:215], a[232:235], v[88:91], v[212:215]
    v_exp_f32 v210, v210
    v_mfma_f32_16x16x32_bf16 v[212:215], a[236:239], v[92:95], v[212:215]
    v_exp_f32 v211, v211
    v_mfma_f32_16x16x32_bf16 a[40:43], a[176:179], v[144:147], a[40:43]
    ds_read_b64_tr_b16 a[160:161], v24 offset:32768
    v_cvt_pk_bf16_f32 v162, v208, v209
    v_mfma_f32_16x16x32_bf16 a[40:43], a[180:183], v[148:151], a[40:43]
    ds_read_b64_tr_b16 a[162:163], v24 offset:36864
    v_mfma_f32_16x16x32_bf16 a[44:47], a[180:183], v[156:159], a[44:47]
    ds_read_b128 a[216:219], v10 offset:57344
    v_cvt_pk_bf16_f32 v163, v210, v211
    v_mfma_f32_16x16x32_bf16 a[44:47], a[176:179], v[152:155], a[44:47]
    s_waitcnt lgkmcnt(3)
    buffer_load_dwordx4 v41, s[12:15], s41 offen offset:1024 lds
    v_mfma_f32_16x16x32_bf16 v[208:211], a[224:227], v[96:99], v[200:203]
    v_exp_f32 v212, v212
    v_mfma_f32_16x16x32_bf16 v[208:211], a[228:231], v[100:103], v[208:211]
    v_exp_f32 v213, v213
    v_mfma_f32_16x16x32_bf16 v[208:211], a[232:235], v[104:107], v[208:211]
    v_exp_f32 v214, v214
    v_mfma_f32_16x16x32_bf16 v[208:211], a[236:239], v[108:111], v[208:211]
    v_exp_f32 v215, v215
    v_mfma_f32_16x16x32_bf16 a[48:51], a[184:187], v[128:131], a[48:51]
    ds_read_b64_tr_b16 a[164:165], v24 offset:40960
    v_cvt_pk_bf16_f32 v170, v212, v213
    v_mfma_f32_16x16x32_bf16 a[48:51], a[188:191], v[132:135], a[48:51]
    ds_read_b64_tr_b16 a[166:167], v24 offset:45056
    v_mfma_f32_16x16x32_bf16 a[52:55], a[188:191], v[140:143], a[52:55]
    ds_read_b128 a[220:223], v11 offset:57344
    v_cvt_pk_bf16_f32 v171, v214, v215
    v_mfma_f32_16x16x32_bf16 a[52:55], a[184:187], v[136:139], a[52:55]
    v_smfmac_f32_16x16x64_bf16 a[200:203], v[52:55], v[144:151], v50
    v_mfma_f32_16x16x32_bf16 v[212:215], a[224:227], v[112:115], v[204:207]
    v_exp_f32 v208, v208
    v_mfma_f32_16x16x32_bf16 v[212:215], a[228:231], v[116:119], v[212:215]
    v_exp_f32 v209, v209
    v_mfma_f32_16x16x32_bf16 v[212:215], a[232:235], v[120:123], v[212:215]
    v_exp_f32 v210, v210
    v_mfma_f32_16x16x32_bf16 v[212:215], a[236:239], v[124:127], v[212:215]
    v_exp_f32 v211, v211
    v_mfma_f32_16x16x32_bf16 a[56:59], a[184:187], v[144:147], a[56:59]
    ds_read_b64_tr_b16 a[168:169], v25 offset:32768
    v_cvt_pk_bf16_f32 v178, v208, v209
    v_mfma_f32_16x16x32_bf16 a[56:59], a[188:191], v[148:151], a[56:59]
    ds_read_b64_tr_b16 a[170:171], v25 offset:36864
    v_mfma_f32_16x16x32_bf16 a[60:63], a[188:191], v[156:159], a[60:63]
    ds_read_b128 a[224:227], v8 offset:61440
    v_cvt_pk_bf16_f32 v179, v210, v211
    v_mfma_f32_16x16x32_bf16 a[60:63], a[184:187], v[152:155], a[60:63]
    s_waitcnt lgkmcnt(3)
    buffer_load_dwordx4 v40, s[12:15], s41 offen offset:2048 lds
    v_mfma_f32_16x16x32_bf16 v[208:211], a[208:211], v[64:67], v[192:195]
    v_exp_f32 v212, v212
    v_mfma_f32_16x16x32_bf16 v[208:211], a[212:215], v[68:71], v[208:211]
    v_exp_f32 v213, v213
    v_mfma_f32_16x16x32_bf16 v[208:211], a[216:219], v[72:75], v[208:211]
    v_exp_f32 v214, v214
    v_mfma_f32_16x16x32_bf16 v[208:211], a[220:223], v[76:79], v[208:211]
    v_exp_f32 v215, v215
    v_mfma_f32_16x16x32_bf16 a[64:67], a[160:163], v[128:131], a[64:67]
    ds_read_b64_tr_b16 a[172:173], v25 offset:40960
    v_cvt_pk_bf16_f32 v186, v212, v213
    v_mfma_f32_16x16x32_bf16 a[64:67], a[164:167], v[132:135], a[64:67]
    ds_read_b64_tr_b16 a[174:175], v25 offset:45056
    v_mfma_f32_16x16x32_bf16 a[68:71], a[164:167], v[140:143], a[68:71]
    ds_read_b128 a[228:231], v9 offset:61440
    v_cvt_pk_bf16_f32 v187, v214, v215
    v_mfma_f32_16x16x32_bf16 a[68:71], a[160:163], v[136:139], a[68:71]
    v_smfmac_f32_16x16x64_bf16 a[204:207], v[52:55], v[152:159], v50
    v_mfma_f32_16x16x32_bf16 v[212:215], a[208:211], v[80:83], v[196:199]
    v_exp_f32 v208, v208
    v_mfma_f32_16x16x32_bf16 v[212:215], a[212:215], v[84:87], v[212:215]
    v_exp_f32 v209, v209
    v_mfma_f32_16x16x32_bf16 v[212:215], a[216:219], v[88:91], v[212:215]
    v_exp_f32 v210, v210
    v_mfma_f32_16x16x32_bf16 v[212:215], a[220:223], v[92:95], v[212:215]
    v_exp_f32 v211, v211
    v_mfma_f32_16x16x32_bf16 a[72:75], a[160:163], v[144:147], a[72:75]
    ds_read_b64_tr_b16 a[176:177], v26 offset:32768
    v_cvt_pk_bf16_f32 v164, v208, v209
    v_mfma_f32_16x16x32_bf16 a[72:75], a[164:167], v[148:151], a[72:75]
    ds_read_b64_tr_b16 a[178:179], v26 offset:36864
    v_mfma_f32_16x16x32_bf16 a[76:79], a[164:167], v[156:159], a[76:79]
    ds_read_b128 a[232:235], v10 offset:61440
    v_cvt_pk_bf16_f32 v165, v210, v211
    v_mfma_f32_16x16x32_bf16 a[76:79], a[160:163], v[152:155], a[76:79]
    s_waitcnt lgkmcnt(3)
    buffer_load_dwordx4 v41, s[12:15], s41 offen offset:3072 lds
    v_mfma_f32_16x16x32_bf16 v[208:211], a[208:211], v[96:99], v[200:203]
    v_exp_f32 v212, v212
    v_mfma_f32_16x16x32_bf16 v[208:211], a[212:215], v[100:103], v[208:211]
    s_add_u32 s41, s41, 16384
    v_exp_f32 v213, v213
    v_mfma_f32_16x16x32_bf16 v[208:211], a[216:219], v[104:107], v[208:211]
    v_exp_f32 v214, v214
    v_mfma_f32_16x16x32_bf16 v[208:211], a[220:223], v[108:111], v[208:211]
    v_exp_f32 v215, v215
    v_mfma_f32_16x16x32_bf16 a[80:83], a[168:171], v[128:131], a[80:83]
    ds_read_b64_tr_b16 a[180:181], v26 offset:40960
    v_cvt_pk_bf16_f32 v172, v212, v213
    v_mfma_f32_16x16x32_bf16 a[80:83], a[172:175], v[132:135], a[80:83]
    ds_read_b64_tr_b16 a[182:183], v26 offset:45056
    v_mfma_f32_16x16x32_bf16 a[84:87], a[172:175], v[140:143], a[84:87]
    ds_read_b128 a[236:239], v11 offset:61440
    v_cvt_pk_bf16_f32 v173, v214, v215
    v_mfma_f32_16x16x32_bf16 a[84:87], a[168:171], v[136:139], a[84:87]
    s_waitcnt vmcnt(10)
    s_barrier
    v_mfma_f32_16x16x32_bf16 v[212:215], a[208:211], v[112:115], v[204:207]
    v_exp_f32 v208, v208
    v_mfma_f32_16x16x32_bf16 v[212:215], a[212:215], v[116:119], v[212:215]
    s_add_u32 m0, s42, 32768
    v_exp_f32 v209, v209
    v_mfma_f32_16x16x32_bf16 v[212:215], a[216:219], v[120:123], v[212:215]
    v_exp_f32 v210, v210
    v_mfma_f32_16x16x32_bf16 v[212:215], a[220:223], v[124:127], v[212:215]
    v_exp_f32 v211, v211
    v_mfma_f32_16x16x32_bf16 a[88:91], a[168:171], v[144:147], a[88:91]
    ds_read_b64_tr_b16 a[184:185], v27 offset:32768
    v_cvt_pk_bf16_f32 v180, v208, v209
    v_mfma_f32_16x16x32_bf16 a[88:91], a[172:175], v[148:151], a[88:91]
    ds_read_b64_tr_b16 a[186:187], v27 offset:36864
    v_mfma_f32_16x16x32_bf16 a[92:95], a[172:175], v[156:159], a[92:95]
    ds_read_b128 a[208:211], v8 offset:0
    v_cvt_pk_bf16_f32 v181, v210, v211
    v_mfma_f32_16x16x32_bf16 a[92:95], a[168:171], v[152:155], a[92:95]
    s_waitcnt lgkmcnt(3)
    buffer_load_dwordx4 v36, s[8:11], s40 offen lds
    v_mfma_f32_16x16x32_bf16 v[208:211], a[224:227], v[64:67], v[192:195]
    v_exp_f32 v212, v212
    v_mfma_f32_16x16x32_bf16 v[208:211], a[228:231], v[68:71], v[208:211]
    v_exp_f32 v213, v213
    v_mfma_f32_16x16x32_bf16 v[208:211], a[232:235], v[72:75], v[208:211]
    v_exp_f32 v214, v214
    v_mfma_f32_16x16x32_bf16 v[208:211], a[236:239], v[76:79], v[208:211]
    v_exp_f32 v215, v215
    v_mfma_f32_16x16x32_bf16 a[96:99], a[176:179], v[128:131], a[96:99]
    ds_read_b64_tr_b16 a[188:189], v27 offset:40960
    v_cvt_pk_bf16_f32 v188, v212, v213
    v_mfma_f32_16x16x32_bf16 a[96:99], a[180:183], v[132:135], a[96:99]
    ds_read_b64_tr_b16 a[190:191], v27 offset:45056
    v_mfma_f32_16x16x32_bf16 a[100:103], a[180:183], v[140:143], a[100:103]
    ds_read_b128 a[212:215], v9 offset:0
    v_cvt_pk_bf16_f32 v189, v214, v215
    v_mfma_f32_16x16x32_bf16 a[100:103], a[176:179], v[136:139], a[100:103]
    buffer_load_dword v219, v62, s[84:87], s38 offen
    v_mfma_f32_16x16x32_bf16 v[212:215], a[224:227], v[80:83], v[196:199]
    v_exp_f32 v208, v208
    v_mfma_f32_16x16x32_bf16 v[212:215], a[228:231], v[84:87], v[212:215]
    v_exp_f32 v209, v209
    v_mfma_f32_16x16x32_bf16 v[212:215], a[232:235], v[88:91], v[212:215]
    v_exp_f32 v210, v210
    v_mfma_f32_16x16x32_bf16 v[212:215], a[236:239], v[92:95], v[212:215]
    v_exp_f32 v211, v211
    v_mfma_f32_16x16x32_bf16 a[104:107], a[176:179], v[144:147], a[104:107]
    ds_read_b64_tr_b16 a[160:161], v20 offset:49152
    v_cvt_pk_bf16_f32 v166, v208, v209
    v_mfma_f32_16x16x32_bf16 a[104:107], a[180:183], v[148:151], a[104:107]
    ds_read_b64_tr_b16 a[162:163], v20 offset:53248
    v_mfma_f32_16x16x32_bf16 a[108:111], a[180:183], v[156:159], a[108:111]
    ds_read_b128 a[216:219], v10 offset:0
    v_cvt_pk_bf16_f32 v167, v210, v211
    v_mfma_f32_16x16x32_bf16 a[108:111], a[176:179], v[152:155], a[108:111]
    s_waitcnt lgkmcnt(3)
    buffer_load_dwordx4 v37, s[8:11], s40 offen offset:1024 lds
    v_mfma_f32_16x16x32_bf16 v[208:211], a[224:227], v[96:99], v[200:203]
    v_exp_f32 v212, v212
    v_mfma_f32_16x16x32_bf16 v[208:211], a[228:231], v[100:103], v[208:211]
    v_exp_f32 v213, v213
    v_mfma_f32_16x16x32_bf16 v[208:211], a[232:235], v[104:107], v[208:211]
    v_exp_f32 v214, v214
    v_mfma_f32_16x16x32_bf16 v[208:211], a[236:239], v[108:111], v[208:211]
    v_exp_f32 v215, v215
    v_mfma_f32_16x16x32_bf16 a[112:115], a[184:187], v[128:131], a[112:115]
    ds_read_b64_tr_b16 a[164:165], v20 offset:57344
    v_cvt_pk_bf16_f32 v174, v212, v213
    v_mfma_f32_16x16x32_bf16 a[112:115], a[188:191], v[132:135], a[112:115]
    ds_read_b64_tr_b16 a[166:167], v20 offset:61440
    v_mfma_f32_16x16x32_bf16 a[116:119], a[188:191], v[140:143], a[116:119]
    ds_read_b128 a[220:223], v11 offset:0
    v_cvt_pk_bf16_f32 v175, v214, v215
    v_mfma_f32_16x16x32_bf16 a[116:119], a[184:187], v[136:139], a[116:119]
    buffer_load_dword v221, v235, s[20:23], 0 offen
    v_mfma_f32_16x16x32_bf16 v[212:215], a[224:227], v[112:115], v[204:207]
    v_exp_f32 v208, v208
    v_mfma_f32_16x16x32_bf16 v[212:215], a[228:231], v[116:119], v[212:215]
    v_exp_f32 v209, v209
    v_mfma_f32_16x16x32_bf16 v[212:215], a[232:235], v[120:123], v[212:215]
    v_exp_f32 v210, v210
    v_mfma_f32_16x16x32_bf16 v[212:215], a[236:239], v[124:127], v[212:215]
    v_exp_f32 v211, v211
    v_mfma_f32_16x16x32_bf16 a[120:123], a[184:187], v[144:147], a[120:123]
    ds_read_b64_tr_b16 a[168:169], v21 offset:49152
    v_cvt_pk_bf16_f32 v182, v208, v209
    v_mfma_f32_16x16x32_bf16 a[120:123], a[188:191], v[148:151], a[120:123]
Ltour0_5:
    s_cbranch_execz Ltour0_9
    ds_read_b64_tr_b16 a[170:171], v21 offset:53248
    v_add_u32 v235, 2560, v235
    v_mfma_f32_16x16x32_bf16 a[124:127], a[188:191], v[156:159], a[124:127]
    ds_read_b128 a[224:227], v8 offset:4096
    v_cvt_pk_bf16_f32 v183, v210, v211
    v_mfma_f32_16x16x32_bf16 a[124:127], a[184:187], v[152:155], a[124:127]
    s_waitcnt lgkmcnt(3)
    buffer_load_dwordx4 v38, s[8:11], s40 offen offset:2048 lds
    v_mfma_f32_16x16x32_bf16 v[208:211], a[208:211], v[64:67], v[192:195]
    v_exp_f32 v212, v212
    v_mfma_f32_16x16x32_bf16 v[208:211], a[212:215], v[68:71], v[208:211]
    v_exp_f32 v213, v213
    v_mfma_f32_16x16x32_bf16 v[208:211], a[216:219], v[72:75], v[208:211]
    v_exp_f32 v214, v214
    v_mfma_f32_16x16x32_bf16 v[208:211], a[220:223], v[76:79], v[208:211]
    v_exp_f32 v215, v215
    v_mfma_f32_16x16x32_bf16 a[0:3], a[160:163], v[160:163], a[0:3]
    ds_read_b64_tr_b16 a[172:173], v21 offset:57344
    v_cvt_pk_bf16_f32 v190, v212, v213
    v_mfma_f32_16x16x32_bf16 a[0:3], a[164:167], v[164:167], a[0:3]
    ds_read_b64_tr_b16 a[174:175], v21 offset:61440
    v_lshlrev_b32 v244, 16, v240
    v_mfma_f32_16x16x32_bf16 a[4:7], a[164:167], v[172:175], a[4:7]
    ds_read_b128 a[228:231], v9 offset:4096
    v_cvt_pk_bf16_f32 v191, v214, v215
    v_mfma_f32_16x16x32_bf16 a[4:7], a[160:163], v[168:171], a[4:7]
    v_and_b32 v245, 0xffff0000, v240
    v_fmac_f32 v224, v2, v244
    v_mfma_f32_16x16x32_bf16 v[212:215], a[208:211], v[80:83], v[196:199]
    v_exp_f32 v208, v208
    v_mfma_f32_16x16x32_bf16 v[212:215], a[212:215], v[84:87], v[212:215]
    v_exp_f32 v209, v209
    v_mfma_f32_16x16x32_bf16 v[212:215], a[216:219], v[88:91], v[212:215]
    v_exp_f32 v210, v210
    v_mfma_f32_16x16x32_bf16 v[212:215], a[220:223], v[92:95], v[212:215]
    v_exp_f32 v211, v211
    v_mfma_f32_16x16x32_bf16 a[8:11], a[160:163], v[176:179], a[8:11]
    ds_read_b64_tr_b16 a[176:177], v22 offset:49152
    v_cvt_pk_bf16_f32 v128, v208, v209
    v_mfma_f32_16x16x32_bf16 a[8:11], a[164:167], v[180:183], a[8:11]
    ds_read_b64_tr_b16 a[178:179], v22 offset:53248
    v_fmac_f32 v225, v2, v245
    v_mfma_f32_16x16x32_bf16 a[12:15], a[164:167], v[188:191], a[12:15]
    ds_read_b128 a[232:235], v10 offset:4096
    v_cvt_pk_bf16_f32 v129, v210, v211
    v_mfma_f32_16x16x32_bf16 a[12:15], a[160:163], v[184:187], a[12:15]
    s_waitcnt lgkmcnt(3)
    buffer_load_dwordx4 v39, s[8:11], s40 offen offset:3072 lds
    v_mfma_f32_16x16x32_bf16 v[208:211], a[208:211], v[96:99], v[200:203]
    v_exp_f32 v212, v212
    v_mfma_f32_16x16x32_bf16 v[208:211], a[212:215], v[100:103], v[208:211]
    s_add_u32 s40, s40, 16384
    v_exp_f32 v213, v213
    v_mfma_f32_16x16x32_bf16 v[208:211], a[216:219], v[104:107], v[208:211]
    v_exp_f32 v214, v214
    v_mfma_f32_16x16x32_bf16 v[208:211], a[220:223], v[108:111], v[208:211]
    v_exp_f32 v215, v215
    v_mfma_f32_16x16x32_bf16 a[16:19], a[168:171], v[160:163], a[16:19]
    ds_read_b64_tr_b16 a[180:181], v22 offset:57344
    v_cvt_pk_bf16_f32 v136, v212, v213
    v_mfma_f32_16x16x32_bf16 a[16:19], a[172:175], v[164:167], a[16:19]
    ds_read_b64_tr_b16 a[182:183], v22 offset:61440
    v_lshlrev_b32 v246, 16, v241
    v_mfma_f32_16x16x32_bf16 a[20:23], a[172:175], v[172:175], a[20:23]
    ds_read_b128 a[236:239], v11 offset:4096
    v_cvt_pk_bf16_f32 v137, v214, v215
    v_mfma_f32_16x16x32_bf16 a[20:23], a[168:171], v[168:171], a[20:23]
    v_and_b32 v247, 0xffff0000, v241
    v_fmac_f32 v226, v2, v246
    v_smfmac_f32_16x16x64_bf16 a[192:195], v[52:55], v[160:167], v50
    v_mfma_f32_16x16x32_bf16 v[212:215], a[208:211], v[112:115], v[204:207]
    v_exp_f32 v208, v208
    v_mfma_f32_16x16x32_bf16 v[212:215], a[212:215], v[116:119], v[212:215]
    s_add_u32 m0, s42, 81920
    v_exp_f32 v209, v209
    v_mfma_f32_16x16x32_bf16 v[212:215], a[216:219], v[120:123], v[212:215]
    v_exp_f32 v210, v210
    v_mfma_f32_16x16x32_bf16 v[212:215], a[220:223], v[124:127], v[212:215]
    v_exp_f32 v211, v211
    v_mfma_f32_16x16x32_bf16 a[24:27], a[168:171], v[176:179], a[24:27]
    ds_read_b64_tr_b16 a[184:185], v23 offset:49152
    v_cvt_pk_bf16_f32 v144, v208, v209
    v_mfma_f32_16x16x32_bf16 a[24:27], a[172:175], v[180:183], a[24:27]
    ds_read_b64_tr_b16 a[186:187], v23 offset:53248
    v_fmac_f32 v227, v2, v247
    v_mfma_f32_16x16x32_bf16 a[28:31], a[172:175], v[188:191], a[28:31]
    ds_read_b128 a[208:211], v8 offset:8192
    v_cvt_pk_bf16_f32 v145, v210, v211
    v_mfma_f32_16x16x32_bf16 a[28:31], a[168:171], v[184:187], a[28:31]
    s_waitcnt lgkmcnt(3)
    buffer_load_dwordx4 v40, s[12:15], s41 offen lds
    v_mfma_f32_16x16x32_bf16 v[208:211], a[224:227], v[64:67], v[192:195]
    v_exp_f32 v212, v212
    v_mfma_f32_16x16x32_bf16 v[208:211], a[228:231], v[68:71], v[208:211]
    v_exp_f32 v213, v213
    v_mfma_f32_16x16x32_bf16 v[208:211], a[232:235], v[72:75], v[208:211]
    v_exp_f32 v214, v214
    v_mfma_f32_16x16x32_bf16 v[208:211], a[236:239], v[76:79], v[208:211]
    v_exp_f32 v215, v215
    v_mfma_f32_16x16x32_bf16 a[32:35], a[176:179], v[160:163], a[32:35]
    ds_read_b64_tr_b16 a[188:189], v23 offset:57344
    v_cvt_pk_bf16_f32 v152, v212, v213
    v_mfma_f32_16x16x32_bf16 a[32:35], a[180:183], v[164:167], a[32:35]
    ds_read_b64_tr_b16 a[190:191], v23 offset:61440
    v_lshlrev_b32 v244, 16, v242
    v_mfma_f32_16x16x32_bf16 a[36:39], a[180:183], v[172:175], a[36:39]
    ds_read_b128 a[212:215], v9 offset:8192
    v_cvt_pk_bf16_f32 v153, v214, v215
    v_mfma_f32_16x16x32_bf16 a[36:39], a[176:179], v[168:171], a[36:39]
    v_and_b32 v245, 0xffff0000, v242
    v_fmac_f32 v228, v2, v244
    v_smfmac_f32_16x16x64_bf16 a[196:199], v[52:55], v[168:175], v50
    v_mfma_f32_16x16x32_bf16 v[212:215], a[224:227], v[80:83], v[196:199]
    v_exp_f32 v208, v208
    v_mfma_f32_16x16x32_bf16 v[212:215], a[228:231], v[84:87], v[212:215]
    v_exp_f32 v209, v209
    v_mfma_f32_16x16x32_bf16 v[212:215], a[232:235], v[88:91], v[212:215]
    v_exp_f32 v210, v210
    v_mfma_f32_16x16x32_bf16 v[212:215], a[236:239], v[92:95], v[212:215]
    v_exp_f32 v211, v211
    v_mfma_f32_16x16x32_bf16 a[40:43], a[176:179], v[176:179], a[40:43]
    ds_read_b64_tr_b16 a[160:161], v24 offset:49152
    v_cvt_pk_bf16_f32 v130, v208, v209
    v_mfma_f32_16x16x32_bf16 a[40:43], a[180:183], v[180:183], a[40:43]
    ds_read_b64_tr_b16 a[162:163], v24 offset:53248
    v_fmac_f32 v229, v2, v245
    v_mfma_f32_16x16x32_bf16 a[44:47], a[180:183], v[188:191], a[44:47]
    ds_read_b128 a[216:219], v10 offset:8192
    v_cvt_pk_bf16_f32 v131, v210, v211
    v_mfma_f32_16x16x32_bf16 a[44:47], a[176:179], v[184:187], a[44:47]
    s_waitcnt lgkmcnt(3)
    buffer_load_dwordx4 v41, s[12:15], s41 offen offset:1024 lds
    v_mfma_f32_16x16x32_bf16 v[208:211], a[224:227], v[96:99], v[200:203]
    v_exp_f32 v212, v212
    v_mfma_f32_16x16x32_bf16 v[208:211], a[228:231], v[100:103], v[208:211]
    v_exp_f32 v213, v213
    v_mfma_f32_16x16x32_bf16 v[208:211], a[232:235], v[104:107], v[208:211]
    v_exp_f32 v214, v214
    v_mfma_f32_16x16x32_bf16 v[208:211], a[236:239], v[108:111], v[208:211]
    v_exp_f32 v215, v215
    v_mfma_f32_16x16x32_bf16 a[48:51], a[184:187], v[160:163], a[48:51]
    ds_read_b64_tr_b16 a[164:165], v24 offset:57344
    v_cvt_pk_bf16_f32 v138, v212, v213
    v_mfma_f32_16x16x32_bf16 a[48:51], a[188:191], v[164:167], a[48:51]
    ds_read_b64_tr_b16 a[166:167], v24 offset:61440
    v_lshlrev_b32 v246, 16, v243
    v_mfma_f32_16x16x32_bf16 a[52:55], a[188:191], v[172:175], a[52:55]
    ds_read_b128 a[220:223], v11 offset:8192
    v_cvt_pk_bf16_f32 v139, v214, v215
    v_mfma_f32_16x16x32_bf16 a[52:55], a[184:187], v[168:171], a[52:55]
    v_and_b32 v247, 0xffff0000, v243
    v_fmac_f32 v230, v2, v246
    v_smfmac_f32_16x16x64_bf16 a[200:203], v[52:55], v[176:183], v50
    v_mfma_f32_16x16x32_bf16 v[212:215], a[224:227], v[112:115], v[204:207]
    v_exp_f32 v208, v208
    v_mfma_f32_16x16x32_bf16 v[212:215], a[228:231], v[116:119], v[212:215]
    v_exp_f32 v209, v209
    v_mfma_f32_16x16x32_bf16 v[212:215], a[232:235], v[120:123], v[212:215]
    v_exp_f32 v210, v210
    v_mfma_f32_16x16x32_bf16 v[212:215], a[236:239], v[124:127], v[212:215]
    v_exp_f32 v211, v211
    v_mfma_f32_16x16x32_bf16 a[56:59], a[184:187], v[176:179], a[56:59]
    ds_read_b64_tr_b16 a[168:169], v25 offset:49152
    v_cvt_pk_bf16_f32 v146, v208, v209
    v_mfma_f32_16x16x32_bf16 a[56:59], a[188:191], v[180:183], a[56:59]
    ds_read_b64_tr_b16 a[170:171], v25 offset:53248
    v_fmac_f32 v231, v2, v247
    v_mfma_f32_16x16x32_bf16 a[60:63], a[188:191], v[188:191], a[60:63]
    ds_read_b128 a[224:227], v8 offset:12288
    v_cvt_pk_bf16_f32 v147, v210, v211
    v_mfma_f32_16x16x32_bf16 a[60:63], a[184:187], v[184:187], a[60:63]
    s_waitcnt lgkmcnt(3)
    buffer_load_dwordx4 v40, s[12:15], s41 offen offset:2048 lds
    v_mfma_f32_16x16x32_bf16 v[208:211], a[208:211], v[64:67], v[192:195]
    v_exp_f32 v212, v212
    v_mfma_f32_16x16x32_bf16 v[208:211], a[212:215], v[68:71], v[208:211]
    v_exp_f32 v213, v213
    v_mfma_f32_16x16x32_bf16 v[208:211], a[216:219], v[72:75], v[208:211]
    v_exp_f32 v214, v214
    v_mfma_f32_16x16x32_bf16 v[208:211], a[220:223], v[76:79], v[208:211]
    v_exp_f32 v215, v215
    v_mfma_f32_16x16x32_bf16 a[64:67], a[160:163], v[160:163], a[64:67]
    ds_read_b64_tr_b16 a[172:173], v25 offset:57344
    v_cvt_pk_bf16_f32 v154, v212, v213
    v_mfma_f32_16x16x32_bf16 a[64:67], a[164:167], v[164:167], a[64:67]
    ds_read_b64_tr_b16 a[174:175], v25 offset:61440
    v_mov_b32 v2, v3
    v_mfma_f32_16x16x32_bf16 a[68:71], a[164:167], v[172:175], a[68:71]
    ds_read_b128 a[228:231], v9 offset:12288
    v_cvt_pk_bf16_f32 v155, v214, v215
    v_mfma_f32_16x16x32_bf16 a[68:71], a[160:163], v[168:171], a[68:71]
    v_mov_b32 v3, v4
    v_mov_b32 v4, v5
    v_smfmac_f32_16x16x64_bf16 a[204:207], v[52:55], v[184:191], v50
    v_mfma_f32_16x16x32_bf16 v[212:215], a[208:211], v[80:83], v[196:199]
    v_exp_f32 v208, v208
    v_mfma_f32_16x16x32_bf16 v[212:215], a[212:215], v[84:87], v[212:215]
    v_exp_f32 v209, v209
    v_mfma_f32_16x16x32_bf16 v[212:215], a[216:219], v[88:91], v[212:215]
    v_exp_f32 v210, v210
    v_mfma_f32_16x16x32_bf16 v[212:215], a[220:223], v[92:95], v[212:215]
    v_exp_f32 v211, v211
    v_mfma_f32_16x16x32_bf16 a[72:75], a[160:163], v[176:179], a[72:75]
    ds_read_b64_tr_b16 a[176:177], v26 offset:49152
    v_cvt_pk_bf16_f32 v132, v208, v209
    v_mfma_f32_16x16x32_bf16 a[72:75], a[164:167], v[180:183], a[72:75]
    ds_read_b64_tr_b16 a[178:179], v26 offset:53248
    v_mov_b32 v5, v6
    v_mfma_f32_16x16x32_bf16 a[76:79], a[164:167], v[188:191], a[76:79]
    ds_read_b128 a[232:235], v10 offset:12288
    v_cvt_pk_bf16_f32 v133, v210, v211
    v_mfma_f32_16x16x32_bf16 a[76:79], a[160:163], v[184:187], a[76:79]
    s_waitcnt lgkmcnt(3)
    buffer_load_dwordx4 v41, s[12:15], s41 offen offset:3072 lds
    v_mfma_f32_16x16x32_bf16 v[208:211], a[208:211], v[96:99], v[200:203]
    v_exp_f32 v212, v212
    v_mfma_f32_16x16x32_bf16 v[208:211], a[212:215], v[100:103], v[208:211]
    s_add_u32 s41, s41, 16384
    v_exp_f32 v213, v213
    v_mfma_f32_16x16x32_bf16 v[208:211], a[216:219], v[104:107], v[208:211]
    v_exp_f32 v214, v214
    v_mfma_f32_16x16x32_bf16 v[208:211], a[220:223], v[108:111], v[208:211]
    v_exp_f32 v215, v215
    v_mfma_f32_16x16x32_bf16 a[80:83], a[168:171], v[160:163], a[80:83]
    ds_read_b64_tr_b16 a[180:181], v26 offset:57344
    v_cvt_pk_bf16_f32 v140, v212, v213
    v_mfma_f32_16x16x32_bf16 a[80:83], a[172:175], v[164:167], a[80:83]
    ds_read_b64_tr_b16 a[182:183], v26 offset:61440
    v_mfma_f32_16x16x32_bf16 a[84:87], a[172:175], v[172:175], a[84:87]
    ds_read_b128 a[236:239], v11 offset:12288
    v_cvt_pk_bf16_f32 v141, v214, v215
    v_mfma_f32_16x16x32_bf16 a[84:87], a[168:171], v[168:171], a[84:87]
    s_waitcnt vmcnt(10)
    s_barrier
    v_mfma_f32_16x16x32_bf16 v[212:215], a[208:211], v[112:115], v[204:207]
    v_exp_f32 v208, v208
    v_mfma_f32_16x16x32_bf16 v[212:215], a[212:215], v[116:119], v[212:215]
    s_add_u32 m0, s42, 49152
    v_exp_f32 v209, v209
    v_mfma_f32_16x16x32_bf16 v[212:215], a[216:219], v[120:123], v[212:215]
    v_exp_f32 v210, v210
    v_mfma_f32_16x16x32_bf16 v[212:215], a[220:223], v[124:127], v[212:215]
    v_exp_f32 v211, v211
    v_mfma_f32_16x16x32_bf16 a[88:91], a[168:171], v[176:179], a[88:91]
    ds_read_b64_tr_b16 a[184:185], v27 offset:49152
    v_cvt_pk_bf16_f32 v148, v208, v209
    v_mfma_f32_16x16x32_bf16 a[88:91], a[172:175], v[180:183], a[88:91]
    ds_read_b64_tr_b16 a[186:187], v27 offset:53248
    v_mfma_f32_16x16x32_bf16 a[92:95], a[172:175], v[188:191], a[92:95]
    ds_read_b128 a[208:211], v8 offset:16384
    v_cvt_pk_bf16_f32 v149, v210, v211
    v_mfma_f32_16x16x32_bf16 a[92:95], a[168:171], v[184:187], a[92:95]
    s_waitcnt lgkmcnt(3)
    buffer_load_dwordx4 v36, s[8:11], s40 offen lds
    v_mfma_f32_16x16x32_bf16 v[208:211], a[224:227], v[64:67], v[192:195]
    v_exp_f32 v212, v212
    v_mfma_f32_16x16x32_bf16 v[208:211], a[228:231], v[68:71], v[208:211]
    v_exp_f32 v213, v213
    v_mfma_f32_16x16x32_bf16 v[208:211], a[232:235], v[72:75], v[208:211]
    v_exp_f32 v214, v214
    v_mfma_f32_16x16x32_bf16 v[208:211], a[236:239], v[76:79], v[208:211]
    v_exp_f32 v215, v215
    v_mfma_f32_16x16x32_bf16 a[96:99], a[176:179], v[160:163], a[96:99]
    ds_read_b64_tr_b16 a[188:189], v27 offset:57344
    v_cvt_pk_bf16_f32 v156, v212, v213
    v_mfma_f32_16x16x32_bf16 a[96:99], a[180:183], v[164:167], a[96:99]
    ds_read_b64_tr_b16 a[190:191], v27 offset:61440
    v_mfma_f32_16x16x32_bf16 a[100:103], a[180:183], v[172:175], a[100:103]
    ds_read_b128 a[212:215], v9 offset:16384
    v_cvt_pk_bf16_f32 v157, v214, v215
    v_mfma_f32_16x16x32_bf16 a[100:103], a[176:179], v[168:171], a[100:103]
    buffer_load_dword v216, v237, s[28:31], s52 offen
    v_mfma_f32_16x16x32_bf16 v[212:215], a[224:227], v[80:83], v[196:199]
    v_exp_f32 v208, v208
    v_mfma_f32_16x16x32_bf16 v[212:215], a[228:231], v[84:87], v[212:215]
    s_sub_u32 s39, s39, 36864
    v_exp_f32 v209, v209
    v_mfma_f32_16x16x32_bf16 v[212:215], a[232:235], v[88:91], v[212:215]
    s_sub_u32 s38, s38, 4608
    v_exp_f32 v210, v210
    v_mfma_f32_16x16x32_bf16 v[212:215], a[236:239], v[92:95], v[212:215]
    s_add_u32 s52, s52, 2304
    v_exp_f32 v211, v211
    v_mfma_f32_16x16x32_bf16 a[104:107], a[176:179], v[176:179], a[104:107]
    ds_read_b64_tr_b16 a[160:161], v20 offset:0
    v_cvt_pk_bf16_f32 v134, v208, v209
    v_mfma_f32_16x16x32_bf16 a[104:107], a[180:183], v[180:183], a[104:107]
    ds_read_b64_tr_b16 a[162:163], v20 offset:4096
    v_mfma_f32_16x16x32_bf16 a[108:111], a[180:183], v[188:191], a[108:111]
    ds_read_b128 a[216:219], v10 offset:16384
    v_cvt_pk_bf16_f32 v135, v210, v211
    v_mfma_f32_16x16x32_bf16 a[108:111], a[176:179], v[184:187], a[108:111]
    s_waitcnt lgkmcnt(3)
    buffer_load_dwordx4 v37, s[8:11], s40 offen offset:1024 lds
    v_mfma_f32_16x16x32_bf16 v[208:211], a[224:227], v[96:99], v[200:203]
    v_exp_f32 v212, v212
    v_mfma_f32_16x16x32_bf16 v[208:211], a[228:231], v[100:103], v[208:211]
    v_exp_f32 v213, v213
    v_mfma_f32_16x16x32_bf16 v[208:211], a[232:235], v[104:107], v[208:211]
    v_exp_f32 v214, v214
    v_mfma_f32_16x16x32_bf16 v[208:211], a[236:239], v[108:111], v[208:211]
    v_exp_f32 v215, v215
    v_mfma_f32_16x16x32_bf16 a[112:115], a[184:187], v[160:163], a[112:115]
    ds_read_b64_tr_b16 a[164:165], v20 offset:8192
    v_cvt_pk_bf16_f32 v142, v212, v213
    v_mfma_f32_16x16x32_bf16 a[112:115], a[188:191], v[164:167], a[112:115]
    ds_read_b64_tr_b16 a[166:167], v20 offset:12288
    v_mfma_f32_16x16x32_bf16 a[116:119], a[188:191], v[172:175], a[116:119]
    ds_read_b128 a[220:223], v11 offset:16384
    v_cvt_pk_bf16_f32 v143, v214, v215
    v_mfma_f32_16x16x32_bf16 a[116:119], a[184:187], v[168:171], a[116:119]
    v_mfma_f32_16x16x32_bf16 v[212:215], a[224:227], v[112:115], v[204:207]
    v_exp_f32 v208, v208
    v_mfma_f32_16x16x32_bf16 v[212:215], a[228:231], v[116:119], v[212:215]
    v_exp_f32 v209, v209
    v_mfma_f32_16x16x32_bf16 v[212:215], a[232:235], v[120:123], v[212:215]
    v_exp_f32 v210, v210
    v_mfma_f32_16x16x32_bf16 v[212:215], a[236:239], v[124:127], v[212:215]
    v_exp_f32 v211, v211
    v_mfma_f32_16x16x32_bf16 a[120:123], a[184:187], v[176:179], a[120:123]
    ds_read_b64_tr_b16 a[168:169], v21 offset:0
    v_cvt_pk_bf16_f32 v150, v208, v209
    v_mfma_f32_16x16x32_bf16 a[120:123], a[188:191], v[180:183], a[120:123]
    ds_read_b64_tr_b16 a[170:171], v21 offset:4096
    v_mfma_f32_16x16x32_bf16 a[124:127], a[188:191], v[188:191], a[124:127]
    ds_read_b128 a[224:227], v8 offset:20480
    v_cvt_pk_bf16_f32 v151, v210, v211
    v_mfma_f32_16x16x32_bf16 a[124:127], a[184:187], v[184:187], a[124:127]
    s_waitcnt lgkmcnt(3)
    buffer_load_dwordx4 v38, s[8:11], s40 offen offset:2048 lds
    s_sub_u32 s43, s43, 1
    s_cmp_lg_u32 s43, 0
    s_cbranch_scc1 Lattn_loop
    v_mfma_f32_16x16x32_bf16 v[208:211], a[208:211], v[64:67], v[192:195]
    s_lshl_b32 s38, s3, 6
    v_exp_f32 v212, v212
    v_mfma_f32_16x16x32_bf16 v[208:211], a[212:215], v[68:71], v[208:211]
    s_add_u32 s38, s38, 131136
    v_exp_f32 v213, v213
    v_mfma_f32_16x16x32_bf16 v[208:211], a[216:219], v[72:75], v[208:211]
    v_exp_f32 v214, v214
    v_mfma_f32_16x16x32_bf16 v[208:211], a[220:223], v[76:79], v[208:211]
    s_add_u32 s57, s58, 0
    v_exp_f32 v215, v215
    v_mfma_f32_16x16x32_bf16 a[0:3], a[160:163], v[128:131], a[0:3]
    ds_read_b64_tr_b16 a[172:173], v21 offset:8192
    v_cvt_pk_bf16_f32 v158, v212, v213
    v_mfma_f32_16x16x32_bf16 a[0:3], a[164:167], v[132:135], a[0:3]
    ds_read_b64_tr_b16 a[174:175], v21 offset:12288
    v_permlane32_swap_b32 v224, v228
    v_mfma_f32_16x16x32_bf16 a[4:7], a[164:167], v[140:143], a[4:7]
    ds_read_b128 a[228:231], v9 offset:20480
    v_cvt_pk_bf16_f32 v159, v214, v215
    v_mfma_f32_16x16x32_bf16 a[4:7], a[160:163], v[136:139], a[4:7]
    buffer_load_dwordx4 a[128:131], v254, s[80:83], s57 offen
    v_mfma_f32_16x16x32_bf16 v[212:215], a[208:211], v[80:83], v[196:199]
    v_exp_f32 v208, v208
    v_mfma_f32_16x16x32_bf16 v[212:215], a[212:215], v[84:87], v[212:215]
    v_exp_f32 v209, v209
    v_mfma_f32_16x16x32_bf16 v[212:215], a[216:219], v[88:91], v[212:215]
    v_exp_f32 v210, v210
    v_mfma_f32_16x16x32_bf16 v[212:215], a[220:223], v[92:95], v[212:215]
    v_exp_f32 v211, v211
    v_mfma_f32_16x16x32_bf16 a[8:11], a[160:163], v[144:147], a[8:11]
    ds_read_b64_tr_b16 a[176:177], v22 offset:0
    v_cvt_pk_bf16_f32 v160, v208, v209
    v_mfma_f32_16x16x32_bf16 a[8:11], a[164:167], v[148:151], a[8:11]
    ds_read_b64_tr_b16 a[178:179], v22 offset:4096
    v_permlane32_swap_b32 v225, v229
    v_mfma_f32_16x16x32_bf16 a[12:15], a[164:167], v[156:159], a[12:15]
    ds_read_b128 a[232:235], v10 offset:20480
    v_cvt_pk_bf16_f32 v161, v210, v211
    v_mfma_f32_16x16x32_bf16 a[12:15], a[160:163], v[152:155], a[12:15]
    s_waitcnt lgkmcnt(3)
    buffer_load_dwordx4 v39, s[8:11], s40 offen offset:3072 lds
    v_mfma_f32_16x16x32_bf16 v[208:211], a[208:211], v[96:99], v[200:203]
    v_exp_f32 v212, v212
    v_mfma_f32_16x16x32_bf16 v[208:211], a[212:215], v[100:103], v[208:211]
    s_add_u32 s40, s40, 16384
    v_exp_f32 v213, v213
    v_mfma_f32_16x16x32_bf16 v[208:211], a[216:219], v[104:107], v[208:211]
    v_exp_f32 v214, v214
    v_mfma_f32_16x16x32_bf16 v[208:211], a[220:223], v[108:111], v[208:211]
    v_exp_f32 v215, v215
    v_mfma_f32_16x16x32_bf16 a[16:19], a[168:171], v[128:131], a[16:19]
    ds_read_b64_tr_b16 a[180:181], v22 offset:8192
    v_cvt_pk_bf16_f32 v168, v212, v213
    v_mfma_f32_16x16x32_bf16 a[16:19], a[172:175], v[132:135], a[16:19]
    ds_read_b64_tr_b16 a[182:183], v22 offset:12288
    v_permlane32_swap_b32 v226, v230
    v_mfma_f32_16x16x32_bf16 a[20:23], a[172:175], v[140:143], a[20:23]
    ds_read_b128 a[236:239], v11 offset:20480
    v_cvt_pk_bf16_f32 v169, v214, v215
    v_mfma_f32_16x16x32_bf16 a[20:23], a[168:171], v[136:139], a[20:23]
    v_permlane32_swap_b32 v227, v231
    v_add_f32 v224, v224, v228
    v_smfmac_f32_16x16x64_bf16 a[192:195], v[52:55], v[128:135], v50
    v_mfma_f32_16x16x32_bf16 v[212:215], a[208:211], v[112:115], v[204:207]
    v_exp_f32 v208, v208
    v_mfma_f32_16x16x32_bf16 v[212:215], a[212:215], v[116:119], v[212:215]
    s_add_u32 m0, s42, 98304
    v_exp_f32 v209, v209
    v_mfma_f32_16x16x32_bf16 v[212:215], a[216:219], v[120:123], v[212:215]
    v_exp_f32 v210, v210
    v_mfma_f32_16x16x32_bf16 v[212:215], a[220:223], v[124:127], v[212:215]
    v_exp_f32 v211, v211
    v_mfma_f32_16x16x32_bf16 a[24:27], a[168:171], v[144:147], a[24:27]
    ds_read_b64_tr_b16 a[184:185], v23 offset:0
    v_cvt_pk_bf16_f32 v176, v208, v209
    v_mfma_f32_16x16x32_bf16 a[24:27], a[172:175], v[148:151], a[24:27]
    ds_read_b64_tr_b16 a[186:187], v23 offset:4096
    v_add_f32 v225, v225, v229
    v_mfma_f32_16x16x32_bf16 a[28:31], a[172:175], v[156:159], a[28:31]
    ds_read_b128 a[208:211], v8 offset:24576
    v_cvt_pk_bf16_f32 v177, v210, v211
    v_mfma_f32_16x16x32_bf16 a[28:31], a[168:171], v[152:155], a[28:31]
    s_waitcnt lgkmcnt(3)
    buffer_load_dwordx4 v40, s[12:15], s41 offen lds
    v_mfma_f32_16x16x32_bf16 v[208:211], a[224:227], v[64:67], v[192:195]
    v_exp_f32 v212, v212
    v_mfma_f32_16x16x32_bf16 v[208:211], a[228:231], v[68:71], v[208:211]
    v_exp_f32 v213, v213
    v_mfma_f32_16x16x32_bf16 v[208:211], a[232:235], v[72:75], v[208:211]
    v_exp_f32 v214, v214
    v_mfma_f32_16x16x32_bf16 v[208:211], a[236:239], v[76:79], v[208:211]
    s_add_u32 s57, s58, 589824
    v_exp_f32 v215, v215
    v_mfma_f32_16x16x32_bf16 a[32:35], a[176:179], v[128:131], a[32:35]
    ds_read_b64_tr_b16 a[188:189], v23 offset:8192
    v_cvt_pk_bf16_f32 v184, v212, v213
    v_mfma_f32_16x16x32_bf16 a[32:35], a[180:183], v[132:135], a[32:35]
    ds_read_b64_tr_b16 a[190:191], v23 offset:12288
    v_add_f32 v226, v226, v230
    v_mfma_f32_16x16x32_bf16 a[36:39], a[180:183], v[140:143], a[36:39]
    ds_read_b128 a[212:215], v9 offset:24576
    v_cvt_pk_bf16_f32 v185, v214, v215
    v_mfma_f32_16x16x32_bf16 a[36:39], a[176:179], v[136:139], a[36:39]
    buffer_load_dwordx4 a[132:135], v254, s[80:83], s57 offen
    v_smfmac_f32_16x16x64_bf16 a[196:199], v[52:55], v[136:143], v50
    v_mfma_f32_16x16x32_bf16 v[212:215], a[224:227], v[80:83], v[196:199]
    v_exp_f32 v208, v208
    v_mfma_f32_16x16x32_bf16 v[212:215], a[228:231], v[84:87], v[212:215]
    v_exp_f32 v209, v209
    v_mfma_f32_16x16x32_bf16 v[212:215], a[232:235], v[88:91], v[212:215]
    v_exp_f32 v210, v210
    v_mfma_f32_16x16x32_bf16 v[212:215], a[236:239], v[92:95], v[212:215]
    v_exp_f32 v211, v211
    v_mfma_f32_16x16x32_bf16 a[40:43], a[176:179], v[144:147], a[40:43]
    ds_read_b64_tr_b16 a[160:161], v24 offset:0
    v_cvt_pk_bf16_f32 v162, v208, v209
    v_mfma_f32_16x16x32_bf16 a[40:43], a[180:183], v[148:151], a[40:43]
    ds_read_b64_tr_b16 a[162:163], v24 offset:4096
    v_add_f32 v227, v227, v231
    v_mfma_f32_16x16x32_bf16 a[44:47], a[180:183], v[156:159], a[44:47]
    ds_read_b128 a[216:219], v10 offset:24576
    v_cvt_pk_bf16_f32 v163, v210, v211
    v_mfma_f32_16x16x32_bf16 a[44:47], a[176:179], v[152:155], a[44:47]
    s_waitcnt lgkmcnt(3)
    buffer_load_dwordx4 v41, s[12:15], s41 offen offset:1024 lds
    v_mfma_f32_16x16x32_bf16 v[208:211], a[224:227], v[96:99], v[200:203]
    v_exp_f32 v212, v212
    v_mfma_f32_16x16x32_bf16 v[208:211], a[228:231], v[100:103], v[208:211]
    v_exp_f32 v213, v213
    v_mfma_f32_16x16x32_bf16 v[208:211], a[232:235], v[104:107], v[208:211]
    v_exp_f32 v214, v214
    v_mfma_f32_16x16x32_bf16 v[208:211], a[236:239], v[108:111], v[208:211]
    v_exp_f32 v215, v215
    v_mfma_f32_16x16x32_bf16 a[48:51], a[184:187], v[128:131], a[48:51]
    ds_read_b64_tr_b16 a[164:165], v24 offset:8192
    v_cvt_pk_bf16_f32 v170, v212, v213
    v_mfma_f32_16x16x32_bf16 a[48:51], a[188:191], v[132:135], a[48:51]
    ds_read_b64_tr_b16 a[166:167], v24 offset:12288
    v_and_b32 v244, 1, v1
    v_mfma_f32_16x16x32_bf16 a[52:55], a[188:191], v[140:143], a[52:55]
    ds_read_b128 a[220:223], v11 offset:24576
    v_cvt_pk_bf16_f32 v171, v214, v215
    v_mfma_f32_16x16x32_bf16 a[52:55], a[184:187], v[136:139], a[52:55]
    s_waitcnt vmcnt(15)
    buffer_load_dword v221, v236, s[20:23], 0 offen
    v_smfmac_f32_16x16x64_bf16 a[200:203], v[52:55], v[144:151], v50
    v_mfma_f32_16x16x32_bf16 v[212:215], a[224:227], v[112:115], v[204:207]
    v_exp_f32 v208, v208
    v_mfma_f32_16x16x32_bf16 v[212:215], a[228:231], v[116:119], v[212:215]
    v_exp_f32 v209, v209
    v_mfma_f32_16x16x32_bf16 v[212:215], a[232:235], v[120:123], v[212:215]
    v_exp_f32 v210, v210
    v_mfma_f32_16x16x32_bf16 v[212:215], a[236:239], v[124:127], v[212:215]
    v_exp_f32 v211, v211
    v_mfma_f32_16x16x32_bf16 a[56:59], a[184:187], v[144:147], a[56:59]
    ds_read_b64_tr_b16 a[168:169], v25 offset:0
    v_cvt_pk_bf16_f32 v178, v208, v209
    v_mfma_f32_16x16x32_bf16 a[56:59], a[188:191], v[148:151], a[56:59]
    ds_read_b64_tr_b16 a[170:171], v25 offset:4096
    v_permlane16_swap_b32 v224, v226
    v_mfma_f32_16x16x32_bf16 a[60:63], a[188:191], v[156:159], a[60:63]
    ds_read_b128 a[224:227], v8 offset:28672
    v_cvt_pk_bf16_f32 v179, v210, v211
    v_mfma_f32_16x16x32_bf16 a[60:63], a[184:187], v[152:155], a[60:63]
    s_waitcnt lgkmcnt(3)
    buffer_load_dwordx4 v40, s[12:15], s41 offen offset:2048 lds
    v_mfma_f32_16x16x32_bf16 v[208:211], a[208:211], v[64:67], v[192:195]
    v_exp_f32 v212, v212
    v_mfma_f32_16x16x32_bf16 v[208:211], a[212:215], v[68:71], v[208:211]
    v_exp_f32 v213, v213
    v_mfma_f32_16x16x32_bf16 v[208:211], a[216:219], v[72:75], v[208:211]
    v_exp_f32 v214, v214
    v_mfma_f32_16x16x32_bf16 v[208:211], a[220:223], v[76:79], v[208:211]
    s_add_u32 s57, s58, 1179648
    v_exp_f32 v215, v215
    v_mfma_f32_16x16x32_bf16 a[64:67], a[160:163], v[128:131], a[64:67]
    ds_read_b64_tr_b16 a[172:173], v25 offset:8192
    v_cvt_pk_bf16_f32 v186, v212, v213
    v_mfma_f32_16x16x32_bf16 a[64:67], a[164:167], v[132:135], a[64:67]
    ds_read_b64_tr_b16 a[174:175], v25 offset:12288
    v_permlane16_swap_b32 v225, v227
    v_mfma_f32_16x16x32_bf16 a[68:71], a[164:167], v[140:143], a[68:71]
    ds_read_b128 a[228:231], v9 offset:28672
    v_cvt_pk_bf16_f32 v187, v214, v215
    v_mfma_f32_16x16x32_bf16 a[68:71], a[160:163], v[136:139], a[68:71]
    buffer_load_dwordx4 a[136:139], v254, s[80:83], s57 offen
    v_smfmac_f32_16x16x64_bf16 a[204:207], v[52:55], v[152:159], v50
    v_mfma_f32_16x16x32_bf16 v[212:215], a[208:211], v[80:83], v[196:199]
    v_exp_f32 v208, v208
    v_mfma_f32_16x16x32_bf16 v[212:215], a[212:215], v[84:87], v[212:215]
    v_exp_f32 v209, v209
    v_mfma_f32_16x16x32_bf16 v[212:215], a[216:219], v[88:91], v[212:215]
    v_exp_f32 v210, v210
    v_mfma_f32_16x16x32_bf16 v[212:215], a[220:223], v[92:95], v[212:215]
    v_exp_f32 v211, v211
    v_mfma_f32_16x16x32_bf16 a[72:75], a[160:163], v[144:147], a[72:75]
    ds_read_b64_tr_b16 a[176:177], v26 offset:0
    v_cvt_pk_bf16_f32 v164, v208, v209
    v_mfma_f32_16x16x32_bf16 a[72:75], a[164:167], v[148:151], a[72:75]
    ds_read_b64_tr_b16 a[178:179], v26 offset:4096
    v_lshlrev_b32 v244, 5, v244
    v_mfma_f32_16x16x32_bf16 a[76:79], a[164:167], v[156:159], a[76:79]
    ds_read_b128 a[232:235], v10 offset:28672
    v_cvt_pk_bf16_f32 v165, v210, v211
    v_mfma_f32_16x16x32_bf16 a[76:79], a[160:163], v[152:155], a[76:79]
    s_waitcnt lgkmcnt(3)
    buffer_load_dwordx4 v41, s[12:15], s41 offen offset:3072 lds
    v_mfma_f32_16x16x32_bf16 v[208:211], a[208:211], v[96:99], v[200:203]
    v_exp_f32 v212, v212
    v_mfma_f32_16x16x32_bf16 v[208:211], a[212:215], v[100:103], v[208:211]
    s_add_u32 s41, s41, 16384
    v_exp_f32 v213, v213
    v_mfma_f32_16x16x32_bf16 v[208:211], a[216:219], v[104:107], v[208:211]
    v_exp_f32 v214, v214
    v_mfma_f32_16x16x32_bf16 v[208:211], a[220:223], v[108:111], v[208:211]
    v_exp_f32 v215, v215
    v_mfma_f32_16x16x32_bf16 a[80:83], a[168:171], v[128:131], a[80:83]
    ds_read_b64_tr_b16 a[180:181], v26 offset:8192
    v_cvt_pk_bf16_f32 v172, v212, v213
    v_mfma_f32_16x16x32_bf16 a[80:83], a[172:175], v[132:135], a[80:83]
    ds_read_b64_tr_b16 a[182:183], v26 offset:12288
    v_add_f32 v224, v224, v226
    v_mfma_f32_16x16x32_bf16 a[84:87], a[172:175], v[140:143], a[84:87]
    ds_read_b128 a[236:239], v11 offset:28672
    v_cvt_pk_bf16_f32 v173, v214, v215
    v_mfma_f32_16x16x32_bf16 a[84:87], a[168:171], v[136:139], a[84:87]
    s_waitcnt vmcnt(13)
    s_barrier
    v_mfma_f32_16x16x32_bf16 v[212:215], a[208:211], v[112:115], v[204:207]
    v_exp_f32 v208, v208
    v_mfma_f32_16x16x32_bf16 v[212:215], a[212:215], v[116:119], v[212:215]
    s_add_u32 s49, s45, 1024
    v_exp_f32 v209, v209
    v_mfma_f32_16x16x32_bf16 v[212:215], a[216:219], v[120:123], v[212:215]
    s_add_u32 m0, s42, 0
    v_exp_f32 v210, v210
    v_mfma_f32_16x16x32_bf16 v[212:215], a[220:223], v[124:127], v[212:215]
    v_exp_f32 v211, v211
    v_mfma_f32_16x16x32_bf16 a[88:91], a[168:171], v[144:147], a[88:91]
    ds_read_b64_tr_b16 a[184:185], v27 offset:0
    v_cvt_pk_bf16_f32 v180, v208, v209
    v_mfma_f32_16x16x32_bf16 a[88:91], a[172:175], v[148:151], a[88:91]
    ds_read_b64_tr_b16 a[186:187], v27 offset:4096
    v_add_f32 v225, v225, v227
    v_mfma_f32_16x16x32_bf16 a[92:95], a[172:175], v[156:159], a[92:95]
    ds_read_b128 a[208:211], v8 offset:32768
    v_cvt_pk_bf16_f32 v181, v210, v211
    v_mfma_f32_16x16x32_bf16 a[92:95], a[168:171], v[152:155], a[92:95]
    s_waitcnt lgkmcnt(3)
    buffer_load_dwordx4 v46, s[20:23], s49 offen lds
    v_mfma_f32_16x16x32_bf16 v[208:211], a[224:227], v[64:67], v[192:195]
    v_exp_f32 v212, v212
    v_mfma_f32_16x16x32_bf16 v[208:211], a[228:231], v[68:71], v[208:211]
    v_exp_f32 v213, v213
    v_mfma_f32_16x16x32_bf16 v[208:211], a[232:235], v[72:75], v[208:211]
    v_exp_f32 v214, v214
    v_mfma_f32_16x16x32_bf16 v[208:211], a[236:239], v[76:79], v[208:211]
    s_add_u32 s37, s55, 0
    v_exp_f32 v215, v215
    v_mfma_f32_16x16x32_bf16 a[96:99], a[176:179], v[128:131], a[96:99]
    ds_read_b64_tr_b16 a[188:189], v27 offset:8192
    v_cvt_pk_bf16_f32 v188, v212, v213
    v_mfma_f32_16x16x32_bf16 a[96:99], a[180:183], v[132:135], a[96:99]
    ds_read_b64_tr_b16 a[190:191], v27 offset:12288
    v_lshrrev_b32 v245, 4, v1
    v_mfma_f32_16x16x32_bf16 a[100:103], a[180:183], v[140:143], a[100:103]
Ltour0_6:
    s_cbranch_execz Ltour0_10
    ds_read_b128 a[212:215], v9 offset:32768
    v_cvt_pk_bf16_f32 v189, v214, v215
    v_mfma_f32_16x16x32_bf16 a[100:103], a[176:179], v[136:139], a[100:103]
    buffer_load_dword v239, v238, s[28:31], s37 offen
    v_mfma_f32_16x16x32_bf16 v[212:215], a[224:227], v[80:83], v[196:199]
    v_exp_f32 v208, v208
    v_mfma_f32_16x16x32_bf16 v[212:215], a[228:231], v[84:87], v[212:215]
    v_exp_f32 v209, v209
    v_mfma_f32_16x16x32_bf16 v[212:215], a[232:235], v[88:91], v[212:215]
    v_exp_f32 v210, v210
    v_mfma_f32_16x16x32_bf16 v[212:215], a[236:239], v[92:95], v[212:215]
    v_exp_f32 v211, v211
    v_mfma_f32_16x16x32_bf16 a[104:107], a[176:179], v[144:147], a[104:107]
    ds_read_b64_tr_b16 a[160:161], v20 offset:16384
    v_cvt_pk_bf16_f32 v166, v208, v209
    v_mfma_f32_16x16x32_bf16 a[104:107], a[180:183], v[148:151], a[104:107]
    ds_read_b64_tr_b16 a[162:163], v20 offset:20480
    v_lshl_add_u32 v244, v245, 3, v244
    v_mfma_f32_16x16x32_bf16 a[108:111], a[180:183], v[156:159], a[108:111]
    ds_read_b128 a[216:219], v10 offset:32768
    v_cvt_pk_bf16_f32 v167, v210, v211
    v_mfma_f32_16x16x32_bf16 a[108:111], a[176:179], v[152:155], a[108:111]
    s_waitcnt lgkmcnt(3)
    buffer_load_dwordx4 v47, s[20:23], s49 offen offset:1024 lds
    v_mfma_f32_16x16x32_bf16 v[208:211], a[224:227], v[96:99], v[200:203]
    v_exp_f32 v212, v212
    v_mfma_f32_16x16x32_bf16 v[208:211], a[228:231], v[100:103], v[208:211]
    v_exp_f32 v213, v213
    v_mfma_f32_16x16x32_bf16 v[208:211], a[232:235], v[104:107], v[208:211]
    v_exp_f32 v214, v214
    v_mfma_f32_16x16x32_bf16 v[208:211], a[236:239], v[108:111], v[208:211]
    s_add_u32 s57, s58, 1769472
    v_exp_f32 v215, v215
    v_mfma_f32_16x16x32_bf16 a[112:115], a[184:187], v[128:131], a[112:115]
    ds_read_b64_tr_b16 a[164:165], v20 offset:24576
    v_cvt_pk_bf16_f32 v174, v212, v213
    v_mfma_f32_16x16x32_bf16 a[112:115], a[188:191], v[132:135], a[112:115]
    ds_read_b64_tr_b16 a[166:167], v20 offset:28672
    v_mfma_f32_16x16x32_bf16 a[116:119], a[188:191], v[140:143], a[116:119]
    ds_read_b128 a[220:223], v11 offset:32768
    v_cvt_pk_bf16_f32 v175, v214, v215
    v_mfma_f32_16x16x32_bf16 a[116:119], a[184:187], v[136:139], a[116:119]
    buffer_load_dwordx4 a[140:143], v254, s[80:83], s57 offen
    v_mfma_f32_16x16x32_bf16 v[212:215], a[224:227], v[112:115], v[204:207]
    v_exp_f32 v208, v208
    v_mfma_f32_16x16x32_bf16 v[212:215], a[228:231], v[116:119], v[212:215]
    v_exp_f32 v209, v209
    v_mfma_f32_16x16x32_bf16 v[212:215], a[232:235], v[120:123], v[212:215]
    v_exp_f32 v210, v210
    v_mfma_f32_16x16x32_bf16 v[212:215], a[236:239], v[124:127], v[212:215]
    v_exp_f32 v211, v211
    v_mfma_f32_16x16x32_bf16 a[120:123], a[184:187], v[144:147], a[120:123]
    ds_read_b64_tr_b16 a[168:169], v21 offset:16384
    v_cvt_pk_bf16_f32 v182, v208, v209
    v_mfma_f32_16x16x32_bf16 a[120:123], a[188:191], v[148:151], a[120:123]
    ds_read_b64_tr_b16 a[170:171], v21 offset:20480
    v_mfma_f32_16x16x32_bf16 a[124:127], a[188:191], v[156:159], a[124:127]
    ds_read_b128 a[224:227], v8 offset:36864
    v_cvt_pk_bf16_f32 v183, v210, v211
    v_mfma_f32_16x16x32_bf16 a[124:127], a[184:187], v[152:155], a[124:127]
    s_waitcnt lgkmcnt(3)
    buffer_load_dwordx4 v48, s[20:23], s49 offen offset:2048 lds
    v_mfma_f32_16x16x32_bf16 v[208:211], a[208:211], v[64:67], v[192:195]
    v_exp_f32 v212, v212
    v_mfma_f32_16x16x32_bf16 v[208:211], a[212:215], v[68:71], v[208:211]
    v_exp_f32 v213, v213
    v_mfma_f32_16x16x32_bf16 v[208:211], a[216:219], v[72:75], v[208:211]
    v_exp_f32 v214, v214
    v_mfma_f32_16x16x32_bf16 v[208:211], a[220:223], v[76:79], v[208:211]
    s_add_u32 s57, s58, 2359296
    v_exp_f32 v215, v215
    v_mfma_f32_16x16x32_bf16 a[0:3], a[160:163], v[160:163], a[0:3]
    ds_read_b64_tr_b16 a[172:173], v21 offset:24576
    v_cvt_pk_bf16_f32 v190, v212, v213
    v_mfma_f32_16x16x32_bf16 a[0:3], a[164:167], v[164:167], a[0:3]
    ds_read_b64_tr_b16 a[174:175], v21 offset:28672
    v_mov_b32 v63, 0
    v_mfma_f32_16x16x32_bf16 a[4:7], a[164:167], v[172:175], a[4:7]
    ds_read_b128 a[228:231], v9 offset:36864
    v_cvt_pk_bf16_f32 v191, v214, v215
    v_mfma_f32_16x16x32_bf16 a[4:7], a[160:163], v[168:171], a[4:7]
    buffer_load_dwordx4 a[144:147], v254, s[80:83], s57 offen
    v_mfma_f32_16x16x32_bf16 v[212:215], a[208:211], v[80:83], v[196:199]
    v_exp_f32 v208, v208
    v_mfma_f32_16x16x32_bf16 v[212:215], a[212:215], v[84:87], v[212:215]
    v_exp_f32 v209, v209
    v_mfma_f32_16x16x32_bf16 v[212:215], a[216:219], v[88:91], v[212:215]
    v_exp_f32 v210, v210
    v_mfma_f32_16x16x32_bf16 v[212:215], a[220:223], v[92:95], v[212:215]
    v_exp_f32 v211, v211
    v_mfma_f32_16x16x32_bf16 a[8:11], a[160:163], v[176:179], a[8:11]
    ds_read_b64_tr_b16 a[176:177], v22 offset:16384
    v_cvt_pk_bf16_f32 v128, v208, v209
    v_mfma_f32_16x16x32_bf16 a[8:11], a[164:167], v[180:183], a[8:11]
    ds_read_b64_tr_b16 a[178:179], v22 offset:20480
    v_add_f32_dpp v224, v224, v224 row_ror:2 row_mask:0xf bank_mask:0xf
    v_mfma_f32_16x16x32_bf16 a[12:15], a[164:167], v[188:191], a[12:15]
    ds_read_b128 a[232:235], v10 offset:36864
    v_cvt_pk_bf16_f32 v129, v210, v211
    v_mfma_f32_16x16x32_bf16 a[12:15], a[160:163], v[184:187], a[12:15]
    s_waitcnt lgkmcnt(3)
    buffer_load_dwordx4 v49, s[20:23], s49 offen offset:3072 lds
    v_mfma_f32_16x16x32_bf16 v[208:211], a[208:211], v[96:99], v[200:203]
    s_lshr_b32 s39, s2, 5
    v_exp_f32 v212, v212
    v_mfma_f32_16x16x32_bf16 v[208:211], a[212:215], v[100:103], v[208:211]
    s_lshl_b32 s39, s39, 3
    v_exp_f32 v213, v213
    v_mfma_f32_16x16x32_bf16 v[208:211], a[216:219], v[104:107], v[208:211]
    s_and_b32 s43, s2, 7
    v_exp_f32 v214, v214
    v_mfma_f32_16x16x32_bf16 v[208:211], a[220:223], v[108:111], v[208:211]
    s_add_u32 s39, s39, s43
    v_exp_f32 v215, v215
    v_mfma_f32_16x16x32_bf16 a[16:19], a[168:171], v[160:163], a[16:19]
    ds_read_b64_tr_b16 a[180:181], v22 offset:24576
    v_cvt_pk_bf16_f32 v136, v212, v213
    v_mfma_f32_16x16x32_bf16 a[16:19], a[172:175], v[164:167], a[16:19]
    ds_read_b64_tr_b16 a[182:183], v22 offset:28672
    v_add_f32_dpp v225, v225, v225 row_ror:2 row_mask:0xf bank_mask:0xf
    v_mfma_f32_16x16x32_bf16 a[20:23], a[172:175], v[172:175], a[20:23]
    ds_read_b128 a[236:239], v11 offset:36864
    v_cvt_pk_bf16_f32 v137, v214, v215
    v_mfma_f32_16x16x32_bf16 a[20:23], a[168:171], v[168:171], a[20:23]
    buffer_load_dword v253, v63, s[24:27], s54 offen offset:12 sc1
    v_smfmac_f32_16x16x64_bf16 a[192:195], v[52:55], v[160:167], v50
    v_mfma_f32_16x16x32_bf16 v[212:215], a[208:211], v[112:115], v[204:207]
    s_lshl_b32 s39, s39, 2
    v_exp_f32 v208, v208
    v_mfma_f32_16x16x32_bf16 v[212:215], a[212:215], v[116:119], v[212:215]
    s_add_u32 m0, s42, 114688
    v_exp_f32 v209, v209
    v_mfma_f32_16x16x32_bf16 v[212:215], a[216:219], v[120:123], v[212:215]
    s_bfe_u32 s43, s2, 0x20003
    v_exp_f32 v210, v210
    v_mfma_f32_16x16x32_bf16 v[212:215], a[220:223], v[124:127], v[212:215]
    s_add_u32 s39, s39, s43
    v_exp_f32 v211, v211
    v_mfma_f32_16x16x32_bf16 a[24:27], a[168:171], v[176:179], a[24:27]
    ds_read_b64_tr_b16 a[184:185], v23 offset:16384
    v_cvt_pk_bf16_f32 v144, v208, v209
    v_mfma_f32_16x16x32_bf16 a[24:27], a[172:175], v[180:183], a[24:27]
    ds_read_b64_tr_b16 a[186:187], v23 offset:20480
    v_add_f32_dpp v224, v224, v224 row_ror:4 row_mask:0xf bank_mask:0xf
    v_mfma_f32_16x16x32_bf16 a[28:31], a[172:175], v[188:191], a[28:31]
    ds_read_b128 a[208:211], v8 offset:40960
    v_cvt_pk_bf16_f32 v145, v210, v211
    v_mfma_f32_16x16x32_bf16 a[28:31], a[168:171], v[184:187], a[28:31]
    s_waitcnt lgkmcnt(3)
    buffer_load_dwordx4 v40, s[12:15], s41 offen lds
    v_mfma_f32_16x16x32_bf16 v[208:211], a[224:227], v[64:67], v[192:195]
    s_add_u32 s39, s39, 72
    v_exp_f32 v212, v212
    v_mfma_f32_16x16x32_bf16 v[208:211], a[228:231], v[68:71], v[208:211]
    s_cmp_lt_u32 s39, 216
    s_cselect_b32 s43, 0, 2147483648
    v_exp_f32 v213, v213
    v_mfma_f32_16x16x32_bf16 v[208:211], a[232:235], v[72:75], v[208:211]
    s_or_b32 s43, s43, s48
    v_exp_f32 v214, v214
    v_mfma_f32_16x16x32_bf16 v[208:211], a[236:239], v[76:79], v[208:211]
    s_add_u32 s57, s58, 2949120
    v_exp_f32 v215, v215
    v_mfma_f32_16x16x32_bf16 a[32:35], a[176:179], v[160:163], a[32:35]
    ds_read_b64_tr_b16 a[188:189], v23 offset:24576
    v_cvt_pk_bf16_f32 v152, v212, v213
    v_mfma_f32_16x16x32_bf16 a[32:35], a[180:183], v[164:167], a[32:35]
    ds_read_b64_tr_b16 a[190:191], v23 offset:28672
    v_add_f32_dpp v225, v225, v225 row_ror:4 row_mask:0xf bank_mask:0xf
    v_mfma_f32_16x16x32_bf16 a[36:39], a[180:183], v[172:175], a[36:39]
    ds_read_b128 a[212:215], v9 offset:40960
    v_cvt_pk_bf16_f32 v153, v214, v215
    v_mfma_f32_16x16x32_bf16 a[36:39], a[176:179], v[168:171], a[36:39]
    buffer_load_dwordx4 a[148:151], v254, s[80:83], s57 offen
    v_smfmac_f32_16x16x64_bf16 a[196:199], v[52:55], v[168:175], v50
    v_mfma_f32_16x16x32_bf16 v[212:215], a[224:227], v[80:83], v[196:199]
    s_and_b32 s43, s43, 2147483648
    v_exp_f32 v208, v208
    v_mfma_f32_16x16x32_bf16 v[212:215], a[228:231], v[84:87], v[212:215]
    s_sub_u32 s36, s39, 144
    v_exp_f32 v209, v209
    v_mfma_f32_16x16x32_bf16 v[212:215], a[232:235], v[88:91], v[212:215]
    s_cmp_lt_u32 s36, 36
    s_cselect_b32 s36, 1.0, 0
    v_exp_f32 v210, v210
    v_mfma_f32_16x16x32_bf16 v[212:215], a[236:239], v[92:95], v[212:215]
    s_lshr_b32 s44, s39, 1
    v_exp_f32 v211, v211
    v_mfma_f32_16x16x32_bf16 a[40:43], a[176:179], v[176:179], a[40:43]
    ds_read_b64_tr_b16 a[160:161], v24 offset:16384
    v_cvt_pk_bf16_f32 v130, v208, v209
    v_mfma_f32_16x16x32_bf16 a[40:43], a[180:183], v[180:183], a[40:43]
    ds_read_b64_tr_b16 a[162:163], v24 offset:20480
    v_add_f32_dpp v224, v224, v224 row_ror:8 row_mask:0xf bank_mask:0xf
    v_mfma_f32_16x16x32_bf16 a[44:47], a[180:183], v[188:191], a[44:47]
    ds_read_b128 a[216:219], v10 offset:40960
    v_cvt_pk_bf16_f32 v131, v210, v211
    v_mfma_f32_16x16x32_bf16 a[44:47], a[176:179], v[184:187], a[44:47]
    s_waitcnt lgkmcnt(3)
    buffer_load_dwordx4 v41, s[12:15], s41 offen offset:1024 lds
    v_mfma_f32_16x16x32_bf16 v[208:211], a[224:227], v[96:99], v[200:203]
    s_lshl_b32 s44, s44, 6
    v_exp_f32 v212, v212
    v_mfma_f32_16x16x32_bf16 v[208:211], a[228:231], v[100:103], v[208:211]
    s_and_b32 s39, s39, 1
    v_exp_f32 v213, v213
    v_mfma_f32_16x16x32_bf16 v[208:211], a[232:235], v[104:107], v[208:211]
    s_lshl_b32 s39, s39, 3
    v_exp_f32 v214, v214
    v_mfma_f32_16x16x32_bf16 v[208:211], a[236:239], v[108:111], v[208:211]
    s_add_u32 s39, s39, s44
    v_exp_f32 v215, v215
    v_mfma_f32_16x16x32_bf16 a[48:51], a[184:187], v[160:163], a[48:51]
    ds_read_b64_tr_b16 a[164:165], v24 offset:24576
    v_cvt_pk_bf16_f32 v138, v212, v213
    v_mfma_f32_16x16x32_bf16 a[48:51], a[188:191], v[164:167], a[48:51]
    ds_read_b64_tr_b16 a[166:167], v24 offset:28672
    v_add_f32_dpp v225, v225, v225 row_ror:8 row_mask:0xf bank_mask:0xf
    v_mfma_f32_16x16x32_bf16 a[52:55], a[188:191], v[172:175], a[52:55]
    ds_read_b128 a[220:223], v11 offset:40960
    v_cvt_pk_bf16_f32 v139, v214, v215
    v_mfma_f32_16x16x32_bf16 a[52:55], a[184:187], v[168:171], a[52:55]
    v_add_u32 v244, s38, v244
    v_and_b32 v245, 7, v1
    v_smfmac_f32_16x16x64_bf16 a[200:203], v[52:55], v[176:183], v50
    v_mfma_f32_16x16x32_bf16 v[212:215], a[224:227], v[112:115], v[204:207]
    s_add_u32 s39, s39, 16384
    v_exp_f32 v208, v208
    v_mfma_f32_16x16x32_bf16 v[212:215], a[228:231], v[116:119], v[212:215]
    s_or_b32 s39, s39, s43
    v_exp_f32 v209, v209
    v_mfma_f32_16x16x32_bf16 v[212:215], a[232:235], v[120:123], v[212:215]
    v_exp_f32 v210, v210
    v_mfma_f32_16x16x32_bf16 v[212:215], a[236:239], v[124:127], v[212:215]
    v_exp_f32 v211, v211
    v_mfma_f32_16x16x32_bf16 a[56:59], a[184:187], v[176:179], a[56:59]
    ds_read_b64_tr_b16 a[168:169], v25 offset:16384
    v_cvt_pk_bf16_f32 v146, v208, v209
    v_mfma_f32_16x16x32_bf16 a[56:59], a[188:191], v[180:183], a[56:59]
    ds_read_b64_tr_b16 a[170:171], v25 offset:20480
    v_mfma_f32_16x16x32_bf16 a[60:63], a[188:191], v[188:191], a[60:63]
    ds_read_b128 a[224:227], v8 offset:45056
    v_cvt_pk_bf16_f32 v147, v210, v211
    v_mfma_f32_16x16x32_bf16 a[60:63], a[184:187], v[184:187], a[60:63]
    s_waitcnt lgkmcnt(3)
    buffer_load_dwordx4 v40, s[12:15], s41 offen offset:2048 lds
    v_mfma_f32_16x16x32_bf16 v[208:211], a[208:211], v[64:67], v[192:195]
    v_exp_f32 v212, v212
    v_mfma_f32_16x16x32_bf16 v[208:211], a[212:215], v[68:71], v[208:211]
    v_exp_f32 v213, v213
    v_mfma_f32_16x16x32_bf16 v[208:211], a[216:219], v[72:75], v[208:211]
    v_exp_f32 v214, v214
    v_mfma_f32_16x16x32_bf16 v[208:211], a[220:223], v[76:79], v[208:211]
    s_add_u32 s57, s58, 3538944
    v_exp_f32 v215, v215
    v_mfma_f32_16x16x32_bf16 a[64:67], a[160:163], v[160:163], a[64:67]
    ds_read_b64_tr_b16 a[172:173], v25 offset:24576
    v_cvt_pk_bf16_f32 v154, v212, v213
    v_mfma_f32_16x16x32_bf16 a[64:67], a[164:167], v[164:167], a[64:67]
    ds_read_b64_tr_b16 a[174:175], v25 offset:28672
    v_lshlrev_b32 v245, 3, v245
    v_mfma_f32_16x16x32_bf16 a[68:71], a[164:167], v[172:175], a[68:71]
    ds_read_b128 a[228:231], v9 offset:45056
    v_cvt_pk_bf16_f32 v155, v214, v215
    v_mfma_f32_16x16x32_bf16 a[68:71], a[160:163], v[168:171], a[68:71]
    buffer_load_dwordx4 a[152:155], v254, s[80:83], s57 offen
    v_smfmac_f32_16x16x64_bf16 a[204:207], v[52:55], v[184:191], v50
    ds_write_b64 v244, v[224:225]
    v_mfma_f32_16x16x32_bf16 v[212:215], a[208:211], v[80:83], v[196:199]
    v_exp_f32 v208, v208
    v_mfma_f32_16x16x32_bf16 v[212:215], a[212:215], v[84:87], v[212:215]
    v_exp_f32 v209, v209
    v_mfma_f32_16x16x32_bf16 v[212:215], a[216:219], v[88:91], v[212:215]
    v_exp_f32 v210, v210
    v_mfma_f32_16x16x32_bf16 v[212:215], a[220:223], v[92:95], v[212:215]
    v_exp_f32 v211, v211
    v_mfma_f32_16x16x32_bf16 a[72:75], a[160:163], v[176:179], a[72:75]
    ds_read_b64_tr_b16 a[176:177], v26 offset:16384
    v_cvt_pk_bf16_f32 v132, v208, v209
    v_mfma_f32_16x16x32_bf16 a[72:75], a[164:167], v[180:183], a[72:75]
    ds_read_b64_tr_b16 a[178:179], v26 offset:20480
    v_add_u32 v245, 131136, v245
    v_mfma_f32_16x16x32_bf16 a[76:79], a[164:167], v[188:191], a[76:79]
    ds_read_b128 a[232:235], v10 offset:45056
    v_cvt_pk_bf16_f32 v133, v210, v211
    v_mfma_f32_16x16x32_bf16 a[76:79], a[160:163], v[184:187], a[76:79]
    s_waitcnt lgkmcnt(3)
    buffer_load_dwordx4 v41, s[12:15], s41 offen offset:3072 lds
    v_mfma_f32_16x16x32_bf16 v[208:211], a[208:211], v[96:99], v[200:203]
    v_exp_f32 v212, v212
    v_mfma_f32_16x16x32_bf16 v[208:211], a[212:215], v[100:103], v[208:211]
    s_add_u32 s41, s41, 16384
    v_exp_f32 v213, v213
    v_mfma_f32_16x16x32_bf16 v[208:211], a[216:219], v[104:107], v[208:211]
    v_exp_f32 v214, v214
    v_mfma_f32_16x16x32_bf16 v[208:211], a[220:223], v[108:111], v[208:211]
    v_exp_f32 v215, v215
    v_mfma_f32_16x16x32_bf16 a[80:83], a[168:171], v[160:163], a[80:83]
    ds_read_b64_tr_b16 a[180:181], v26 offset:24576
    v_cvt_pk_bf16_f32 v140, v212, v213
    v_mfma_f32_16x16x32_bf16 a[80:83], a[172:175], v[164:167], a[80:83]
    ds_read_b64_tr_b16 a[182:183], v26 offset:28672
    v_mfma_f32_16x16x32_bf16 a[84:87], a[172:175], v[172:175], a[84:87]
    ds_read_b128 a[236:239], v11 offset:45056
    v_cvt_pk_bf16_f32 v141, v214, v215
    v_mfma_f32_16x16x32_bf16 a[84:87], a[168:171], v[168:171], a[84:87]
    s_waitcnt vmcnt(14)
    s_barrier
    v_mfma_f32_16x16x32_bf16 v[212:215], a[208:211], v[112:115], v[204:207]
    v_exp_f32 v208, v208
    v_mfma_f32_16x16x32_bf16 v[212:215], a[212:215], v[116:119], v[212:215]
    s_add_u32 s49, s45, 74752
    v_exp_f32 v209, v209
    v_mfma_f32_16x16x32_bf16 v[212:215], a[216:219], v[120:123], v[212:215]
    s_add_u32 m0, s42, 16384
    v_exp_f32 v210, v210
    v_mfma_f32_16x16x32_bf16 v[212:215], a[220:223], v[124:127], v[212:215]
    v_exp_f32 v211, v211
    v_mfma_f32_16x16x32_bf16 a[88:91], a[168:171], v[176:179], a[88:91]
    ds_read_b64_tr_b16 a[184:185], v27 offset:16384
    v_cvt_pk_bf16_f32 v148, v208, v209
    v_mfma_f32_16x16x32_bf16 a[88:91], a[172:175], v[180:183], a[88:91]
    ds_read_b64_tr_b16 a[186:187], v27 offset:20480
    ds_read_b64 v[224:225], v245 offset:0
    v_mfma_f32_16x16x32_bf16 a[92:95], a[172:175], v[188:191], a[92:95]
    ds_read_b128 a[208:211], v8 offset:49152
    v_cvt_pk_bf16_f32 v149, v210, v211
    v_mfma_f32_16x16x32_bf16 a[92:95], a[168:171], v[184:187], a[92:95]
    s_waitcnt lgkmcnt(3)
    buffer_load_dwordx4 v46, s[20:23], s49 offen lds
    v_mfma_f32_16x16x32_bf16 v[208:211], a[224:227], v[64:67], v[192:195]
    v_exp_f32 v212, v212
    v_mfma_f32_16x16x32_bf16 v[208:211], a[228:231], v[68:71], v[208:211]
    v_exp_f32 v213, v213
    v_mfma_f32_16x16x32_bf16 v[208:211], a[232:235], v[72:75], v[208:211]
    v_exp_f32 v214, v214
    v_mfma_f32_16x16x32_bf16 v[208:211], a[236:239], v[76:79], v[208:211]
    s_add_u32 s37, s55, 8192
    v_exp_f32 v215, v215
    v_mfma_f32_16x16x32_bf16 a[96:99], a[176:179], v[160:163], a[96:99]
    ds_read_b64_tr_b16 a[188:189], v27 offset:24576
    v_cvt_pk_bf16_f32 v156, v212, v213
    v_mfma_f32_16x16x32_bf16 a[96:99], a[180:183], v[164:167], a[96:99]
    ds_read_b64_tr_b16 a[190:191], v27 offset:28672
    ds_read_b64 v[226:227], v245 offset:64
    v_mfma_f32_16x16x32_bf16 a[100:103], a[180:183], v[172:175], a[100:103]
    ds_read_b128 a[212:215], v9 offset:49152
    v_cvt_pk_bf16_f32 v157, v214, v215
    v_mfma_f32_16x16x32_bf16 a[100:103], a[176:179], v[168:171], a[100:103]
    buffer_load_dword v234, v238, s[28:31], s37 offen
    v_mfma_f32_16x16x32_bf16 v[212:215], a[224:227], v[80:83], v[196:199]
    v_exp_f32 v208, v208
    v_mfma_f32_16x16x32_bf16 v[212:215], a[228:231], v[84:87], v[212:215]
    v_exp_f32 v209, v209
    v_mfma_f32_16x16x32_bf16 v[212:215], a[232:235], v[88:91], v[212:215]
    v_exp_f32 v210, v210
    v_mfma_f32_16x16x32_bf16 v[212:215], a[236:239], v[92:95], v[212:215]
    v_exp_f32 v211, v211
    v_mfma_f32_16x16x32_bf16 a[104:107], a[176:179], v[176:179], a[104:107]
    ds_read_b64_tr_b16 a[160:161], v20 offset:32768
    v_cvt_pk_bf16_f32 v134, v208, v209
    v_mfma_f32_16x16x32_bf16 a[104:107], a[180:183], v[180:183], a[104:107]
    ds_read_b64_tr_b16 a[162:163], v20 offset:36864
    ds_read_b64 v[228:229], v245 offset:128
    v_mfma_f32_16x16x32_bf16 a[108:111], a[180:183], v[188:191], a[108:111]
    ds_read_b128 a[216:219], v10 offset:49152
    v_cvt_pk_bf16_f32 v135, v210, v211
    v_mfma_f32_16x16x32_bf16 a[108:111], a[176:179], v[184:187], a[108:111]
    s_waitcnt lgkmcnt(3)
    buffer_load_dwordx4 v47, s[20:23], s49 offen offset:1024 lds
    v_mfma_f32_16x16x32_bf16 v[208:211], a[224:227], v[96:99], v[200:203]
    v_exp_f32 v212, v212
    v_mfma_f32_16x16x32_bf16 v[208:211], a[228:231], v[100:103], v[208:211]
    v_exp_f32 v213, v213
    v_mfma_f32_16x16x32_bf16 v[208:211], a[232:235], v[104:107], v[208:211]
    v_exp_f32 v214, v214
    v_mfma_f32_16x16x32_bf16 v[208:211], a[236:239], v[108:111], v[208:211]
    s_add_u32 s57, s58, 4128768
    v_exp_f32 v215, v215
    v_mfma_f32_16x16x32_bf16 a[112:115], a[184:187], v[160:163], a[112:115]
    ds_read_b64_tr_b16 a[164:165], v20 offset:40960
    v_cvt_pk_bf16_f32 v142, v212, v213
    v_mfma_f32_16x16x32_bf16 a[112:115], a[188:191], v[164:167], a[112:115]
    ds_read_b64_tr_b16 a[166:167], v20 offset:45056
    ds_read_b64 v[230:231], v245 offset:192
    v_mfma_f32_16x16x32_bf16 a[116:119], a[188:191], v[172:175], a[116:119]
    ds_read_b128 a[220:223], v11 offset:49152
    v_cvt_pk_bf16_f32 v143, v214, v215
    v_mfma_f32_16x16x32_bf16 a[116:119], a[184:187], v[168:171], a[116:119]
    buffer_load_dwordx4 a[156:159], v254, s[80:83], s57 offen
    v_mfma_f32_16x16x32_bf16 v[212:215], a[224:227], v[112:115], v[204:207]
    v_exp_f32 v208, v208
    v_mfma_f32_16x16x32_bf16 v[212:215], a[228:231], v[116:119], v[212:215]
    v_exp_f32 v209, v209
    v_mfma_f32_16x16x32_bf16 v[212:215], a[232:235], v[120:123], v[212:215]
    v_exp_f32 v210, v210
    v_mfma_f32_16x16x32_bf16 v[212:215], a[236:239], v[124:127], v[212:215]
    v_exp_f32 v211, v211
    v_mfma_f32_16x16x32_bf16 a[120:123], a[184:187], v[176:179], a[120:123]
    ds_read_b64_tr_b16 a[168:169], v21 offset:32768
    v_cvt_pk_bf16_f32 v150, v208, v209
    v_mfma_f32_16x16x32_bf16 a[120:123], a[188:191], v[180:183], a[120:123]
    ds_read_b64_tr_b16 a[170:171], v21 offset:36864
    v_mfma_f32_16x16x32_bf16 a[124:127], a[188:191], v[188:191], a[124:127]
    ds_read_b128 a[224:227], v8 offset:53248
    v_cvt_pk_bf16_f32 v151, v210, v211
    v_mfma_f32_16x16x32_bf16 a[124:127], a[184:187], v[184:187], a[124:127]
    s_waitcnt lgkmcnt(3)
    buffer_load_dwordx4 v48, s[20:23], s49 offen offset:2048 lds
    v_mfma_f32_16x16x32_bf16 v[208:211], a[208:211], v[64:67], v[192:195]
    v_exp_f32 v212, v212
    v_mfma_f32_16x16x32_bf16 v[208:211], a[212:215], v[68:71], v[208:211]
    v_exp_f32 v213, v213
    v_mfma_f32_16x16x32_bf16 v[208:211], a[216:219], v[72:75], v[208:211]
    v_exp_f32 v214, v214
    v_mfma_f32_16x16x32_bf16 v[208:211], a[220:223], v[76:79], v[208:211]
    s_add_u32 s57, s58, 4718592
    v_exp_f32 v215, v215
    v_mfma_f32_16x16x32_bf16 a[0:3], a[160:163], v[128:131], a[0:3]
    ds_read_b64_tr_b16 a[172:173], v21 offset:40960
    v_cvt_pk_bf16_f32 v158, v212, v213
    v_mfma_f32_16x16x32_bf16 a[0:3], a[164:167], v[132:135], a[0:3]
    ds_read_b64_tr_b16 a[174:175], v21 offset:45056
    v_add_f32 v224, v224, v228
    v_mfma_f32_16x16x32_bf16 a[4:7], a[164:167], v[140:143], a[4:7]
    ds_read_b128 a[228:231], v9 offset:53248
    v_cvt_pk_bf16_f32 v159, v214, v215
    v_mfma_f32_16x16x32_bf16 a[4:7], a[160:163], v[136:139], a[4:7]
    buffer_load_dwordx4 a[240:243], v254, s[80:83], s57 offen
    v_mfma_f32_16x16x32_bf16 v[212:215], a[208:211], v[80:83], v[196:199]
    v_exp_f32 v208, v208
    v_mfma_f32_16x16x32_bf16 v[212:215], a[212:215], v[84:87], v[212:215]
    v_exp_f32 v209, v209
    v_mfma_f32_16x16x32_bf16 v[212:215], a[216:219], v[88:91], v[212:215]
    v_exp_f32 v210, v210
    v_mfma_f32_16x16x32_bf16 v[212:215], a[220:223], v[92:95], v[212:215]
    v_exp_f32 v211, v211
    v_mfma_f32_16x16x32_bf16 a[8:11], a[160:163], v[144:147], a[8:11]
    ds_read_b64_tr_b16 a[176:177], v22 offset:32768
    v_cvt_pk_bf16_f32 v160, v208, v209
    v_mfma_f32_16x16x32_bf16 a[8:11], a[164:167], v[148:151], a[8:11]
    ds_read_b64_tr_b16 a[178:179], v22 offset:36864
    v_add_f32 v225, v225, v229
    v_mfma_f32_16x16x32_bf16 a[12:15], a[164:167], v[156:159], a[12:15]
    ds_read_b128 a[232:235], v10 offset:53248
    v_cvt_pk_bf16_f32 v161, v210, v211
    v_mfma_f32_16x16x32_bf16 a[12:15], a[160:163], v[152:155], a[12:15]
    s_waitcnt lgkmcnt(3)
    buffer_load_dwordx4 v49, s[20:23], s49 offen offset:3072 lds
    v_mfma_f32_16x16x32_bf16 v[208:211], a[208:211], v[96:99], v[200:203]
    v_exp_f32 v212, v212
    v_mfma_f32_16x16x32_bf16 v[208:211], a[212:215], v[100:103], v[208:211]
    v_exp_f32 v213, v213
    v_mfma_f32_16x16x32_bf16 v[208:211], a[216:219], v[104:107], v[208:211]
    v_exp_f32 v214, v214
    v_mfma_f32_16x16x32_bf16 v[208:211], a[220:223], v[108:111], v[208:211]
    v_exp_f32 v215, v215
    v_mfma_f32_16x16x32_bf16 a[16:19], a[168:171], v[128:131], a[16:19]
    ds_read_b64_tr_b16 a[180:181], v22 offset:40960
    v_cvt_pk_bf16_f32 v168, v212, v213
    v_mfma_f32_16x16x32_bf16 a[16:19], a[172:175], v[132:135], a[16:19]
    ds_read_b64_tr_b16 a[182:183], v22 offset:45056
    v_add_f32 v226, v226, v230
    v_mfma_f32_16x16x32_bf16 a[20:23], a[172:175], v[140:143], a[20:23]
    ds_read_b128 a[236:239], v11 offset:53248
    v_cvt_pk_bf16_f32 v169, v214, v215
    v_mfma_f32_16x16x32_bf16 a[20:23], a[168:171], v[136:139], a[20:23]
    v_add_f32 v227, v227, v231
    v_add_f32 v224, v224, v226
    v_smfmac_f32_16x16x64_bf16 a[192:195], v[52:55], v[128:135], v50
    v_mfma_f32_16x16x32_bf16 v[212:215], a[208:211], v[112:115], v[204:207]
    v_exp_f32 v208, v208
    v_mfma_f32_16x16x32_bf16 v[212:215], a[212:215], v[116:119], v[212:215]
    s_add_u32 s49, s7, 0
    v_exp_f32 v209, v209
    v_mfma_f32_16x16x32_bf16 v[212:215], a[216:219], v[120:123], v[212:215]
    s_add_u32 m0, s42, 65536
    v_exp_f32 v210, v210
    v_mfma_f32_16x16x32_bf16 v[212:215], a[220:223], v[124:127], v[212:215]
    v_exp_f32 v211, v211
    v_mfma_f32_16x16x32_bf16 a[24:27], a[168:171], v[144:147], a[24:27]
    ds_read_b64_tr_b16 a[184:185], v23 offset:32768
    v_cvt_pk_bf16_f32 v176, v208, v209
    v_mfma_f32_16x16x32_bf16 a[24:27], a[172:175], v[148:151], a[24:27]
    ds_read_b64_tr_b16 a[186:187], v23 offset:36864
    v_add_f32 v225, v225, v227
    v_mfma_f32_16x16x32_bf16 a[28:31], a[172:175], v[156:159], a[28:31]
    ds_read_b128 a[208:211], v8 offset:57344
    v_cvt_pk_bf16_f32 v177, v210, v211
    v_mfma_f32_16x16x32_bf16 a[28:31], a[168:171], v[152:155], a[28:31]
    s_waitcnt lgkmcnt(3)
    buffer_load_dwordx4 v46, s[20:23], s49 offen lds
    v_mfma_f32_16x16x32_bf16 v[208:211], a[224:227], v[64:67], v[192:195]
    v_exp_f32 v212, v212
    v_mfma_f32_16x16x32_bf16 v[208:211], a[228:231], v[68:71], v[208:211]
    v_exp_f32 v213, v213
    v_mfma_f32_16x16x32_bf16 v[208:211], a[232:235], v[72:75], v[208:211]
    v_exp_f32 v214, v214
    v_mfma_f32_16x16x32_bf16 v[208:211], a[236:239], v[76:79], v[208:211]
    s_add_u32 s57, s58, 4128768
    v_exp_f32 v215, v215
    v_mfma_f32_16x16x32_bf16 a[32:35], a[176:179], v[128:131], a[32:35]
    ds_read_b64_tr_b16 a[188:189], v23 offset:40960
    v_cvt_pk_bf16_f32 v184, v212, v213
    v_mfma_f32_16x16x32_bf16 a[32:35], a[180:183], v[132:135], a[32:35]
    ds_read_b64_tr_b16 a[190:191], v23 offset:45056
    v_cvt_pk_bf16_f32 v246, v224, v225
    v_mfma_f32_16x16x32_bf16 a[36:39], a[180:183], v[140:143], a[36:39]
    ds_read_b128 a[212:215], v9 offset:57344
    v_cvt_pk_bf16_f32 v185, v214, v215
    v_mfma_f32_16x16x32_bf16 a[36:39], a[176:179], v[136:139], a[36:39]
    buffer_load_dwordx4 a[244:247], v254, s[32:35], s57 offen
    v_smfmac_f32_16x16x64_bf16 a[196:199], v[52:55], v[136:143], v50
    v_lshrrev_b32 v222, 5, v0
    v_mfma_f32_16x16x32_bf16 v[212:215], a[224:227], v[80:83], v[196:199]
    s_getpc_b64 s[16:17]
Lattn_pc2:
    v_exp_f32 v208, v208
    v_mfma_f32_16x16x32_bf16 v[212:215], a[228:231], v[84:87], v[212:215]
    s_mov_b32 s18, Lattn_redo-Lattn_pc2
    v_exp_f32 v209, v209
    v_mfma_f32_16x16x32_bf16 v[212:215], a[232:235], v[88:91], v[212:215]
    s_lshr_b32 s37, s2, 3
    v_exp_f32 v210, v210
    v_mfma_f32_16x16x32_bf16 v[212:215], a[236:239], v[92:95], v[212:215]
    v_exp_f32 v211, v211
    v_mfma_f32_16x16x32_bf16 a[40:43], a[176:179], v[144:147], a[40:43]
    ds_read_b64_tr_b16 a[160:161], v24 offset:32768
    v_cvt_pk_bf16_f32 v162, v208, v209
    v_mfma_f32_16x16x32_bf16 a[40:43], a[180:183], v[148:151], a[40:43]
    ds_read_b64_tr_b16 a[162:163], v24 offset:36864
    v_lshlrev_b32 v222, 12, v222
    v_mfma_f32_16x16x32_bf16 a[44:47], a[180:183], v[156:159], a[44:47]
    ds_read_b128 a[216:219], v10 offset:57344
    v_cvt_pk_bf16_f32 v163, v210, v211
    v_mfma_f32_16x16x32_bf16 a[44:47], a[176:179], v[152:155], a[44:47]
    s_waitcnt lgkmcnt(3)
    buffer_load_dwordx4 v47, s[20:23], s49 offen offset:1024 lds
    v_mfma_f32_16x16x32_bf16 v[208:211], a[224:227], v[96:99], v[200:203]
    s_lshl_b32 s37, s37, 7
    v_exp_f32 v212, v212
    v_mfma_f32_16x16x32_bf16 v[208:211], a[228:231], v[100:103], v[208:211]
    v_exp_f32 v213, v213
    v_mfma_f32_16x16x32_bf16 v[208:211], a[232:235], v[104:107], v[208:211]
    v_exp_f32 v214, v214
    v_mfma_f32_16x16x32_bf16 v[208:211], a[236:239], v[108:111], v[208:211]
    v_exp_f32 v215, v215
    v_mfma_f32_16x16x32_bf16 a[48:51], a[184:187], v[128:131], a[48:51]
    ds_read_b64_tr_b16 a[164:165], v24 offset:40960
    v_cvt_pk_bf16_f32 v170, v212, v213
    v_mfma_f32_16x16x32_bf16 a[48:51], a[188:191], v[132:135], a[48:51]
    ds_read_b64_tr_b16 a[166:167], v24 offset:45056
    v_lshlrev_b32 v224, 16, v246
    v_mfma_f32_16x16x32_bf16 a[52:55], a[188:191], v[140:143], a[52:55]
    ds_read_b128 a[220:223], v11 offset:57344
    v_cvt_pk_bf16_f32 v171, v214, v215
    v_mfma_f32_16x16x32_bf16 a[52:55], a[184:187], v[136:139], a[52:55]
    buffer_load_dword v222, v222, s[16:19], s37 offen
    v_smfmac_f32_16x16x64_bf16 a[200:203], v[52:55], v[144:151], v50
    v_mfma_f32_16x16x32_bf16 v[212:215], a[224:227], v[112:115], v[204:207]
    v_exp_f32 v208, v208
    v_mfma_f32_16x16x32_bf16 v[212:215], a[228:231], v[116:119], v[212:215]
    v_exp_f32 v209, v209
    v_mfma_f32_16x16x32_bf16 v[212:215], a[232:235], v[120:123], v[212:215]
    v_exp_f32 v210, v210
    v_mfma_f32_16x16x32_bf16 v[212:215], a[236:239], v[124:127], v[212:215]
    v_exp_f32 v211, v211
    v_mfma_f32_16x16x32_bf16 a[56:59], a[184:187], v[144:147], a[56:59]
    ds_read_b64_tr_b16 a[168:169], v25 offset:32768
    v_cvt_pk_bf16_f32 v178, v208, v209
    v_mfma_f32_16x16x32_bf16 a[56:59], a[188:191], v[148:151], a[56:59]
    ds_read_b64_tr_b16 a[170:171], v25 offset:36864
    v_and_b32 v225, 0xffff0000, v246
    v_mfma_f32_16x16x32_bf16 a[60:63], a[188:191], v[156:159], a[60:63]
    ds_read_b128 a[224:227], v8 offset:61440
    v_cvt_pk_bf16_f32 v179, v210, v211
    v_mfma_f32_16x16x32_bf16 a[60:63], a[184:187], v[152:155], a[60:63]
    s_waitcnt lgkmcnt(3)
    buffer_load_dwordx4 v48, s[20:23], s49 offen offset:2048 lds
    v_mfma_f32_16x16x32_bf16 v[208:211], a[208:211], v[64:67], v[192:195]
    v_exp_f32 v212, v212
    v_mfma_f32_16x16x32_bf16 v[208:211], a[212:215], v[68:71], v[208:211]
    v_exp_f32 v213, v213
    v_mfma_f32_16x16x32_bf16 v[208:211], a[216:219], v[72:75], v[208:211]
    v_exp_f32 v214, v214
    v_mfma_f32_16x16x32_bf16 v[208:211], a[220:223], v[76:79], v[208:211]
    s_add_u32 s57, s58, 4718592
    v_exp_f32 v215, v215
    v_mfma_f32_16x16x32_bf16 a[64:67], a[160:163], v[128:131], a[64:67]
    ds_read_b64_tr_b16 a[172:173], v25 offset:40960
    v_cvt_pk_bf16_f32 v186, v212, v213
    v_mfma_f32_16x16x32_bf16 a[64:67], a[164:167], v[132:135], a[64:67]
Ltour0_7:
    s_cbranch_execz Ltour0_11
    ds_read_b64_tr_b16 a[174:175], v25 offset:45056
    v_add_f32 v224, s36, v224
    v_mfma_f32_16x16x32_bf16 a[68:71], a[164:167], v[140:143], a[68:71]
    ds_read_b128 a[228:231], v9 offset:61440
    v_cvt_pk_bf16_f32 v187, v214, v215
    v_mfma_f32_16x16x32_bf16 a[68:71], a[160:163], v[136:139], a[68:71]
    buffer_load_dwordx4 a[248:251], v254, s[32:35], s57 offen
    v_smfmac_f32_16x16x64_bf16 a[204:207], v[52:55], v[152:159], v50
    v_mfma_f32_16x16x32_bf16 v[212:215], a[208:211], v[80:83], v[196:199]
    v_exp_f32 v208, v208
    v_mfma_f32_16x16x32_bf16 v[212:215], a[212:215], v[84:87], v[212:215]
    v_exp_f32 v209, v209
    v_mfma_f32_16x16x32_bf16 v[212:215], a[216:219], v[88:91], v[212:215]
    v_exp_f32 v210, v210
    v_mfma_f32_16x16x32_bf16 v[212:215], a[220:223], v[92:95], v[212:215]
    v_exp_f32 v211, v211
    v_mfma_f32_16x16x32_bf16 a[72:75], a[160:163], v[144:147], a[72:75]
    ds_read_b64_tr_b16 a[176:177], v26 offset:32768
    v_cvt_pk_bf16_f32 v164, v208, v209
    v_mfma_f32_16x16x32_bf16 a[72:75], a[164:167], v[148:151], a[72:75]
    ds_read_b64_tr_b16 a[178:179], v26 offset:36864
    v_add_f32 v225, s36, v225
    v_mfma_f32_16x16x32_bf16 a[76:79], a[164:167], v[156:159], a[76:79]
    ds_read_b128 a[232:235], v10 offset:61440
    v_cvt_pk_bf16_f32 v165, v210, v211
    v_mfma_f32_16x16x32_bf16 a[76:79], a[160:163], v[152:155], a[76:79]
    s_waitcnt lgkmcnt(3)
    buffer_load_dwordx4 v49, s[20:23], s49 offen offset:3072 lds
    v_mfma_f32_16x16x32_bf16 v[208:211], a[208:211], v[96:99], v[200:203]
    v_exp_f32 v212, v212
    v_mfma_f32_16x16x32_bf16 v[208:211], a[212:215], v[100:103], v[208:211]
    v_exp_f32 v213, v213
    v_mfma_f32_16x16x32_bf16 v[208:211], a[216:219], v[104:107], v[208:211]
    v_exp_f32 v214, v214
    v_mfma_f32_16x16x32_bf16 v[208:211], a[220:223], v[108:111], v[208:211]
    v_exp_f32 v215, v215
    v_mfma_f32_16x16x32_bf16 a[80:83], a[168:171], v[128:131], a[80:83]
    ds_read_b64_tr_b16 a[180:181], v26 offset:40960
    v_cvt_pk_bf16_f32 v172, v212, v213
    v_mfma_f32_16x16x32_bf16 a[80:83], a[172:175], v[132:135], a[80:83]
    ds_read_b64_tr_b16 a[182:183], v26 offset:45056
    v_cvt_pk_bf16_f32 v246, v224, v225
    v_mfma_f32_16x16x32_bf16 a[84:87], a[172:175], v[140:143], a[84:87]
    ds_read_b128 a[236:239], v11 offset:61440
    v_cvt_pk_bf16_f32 v173, v214, v215
    v_mfma_f32_16x16x32_bf16 a[84:87], a[168:171], v[136:139], a[84:87]
    s_waitcnt vmcnt(14)
    s_barrier
    v_mfma_f32_16x16x32_bf16 v[212:215], a[208:211], v[112:115], v[204:207]
    v_exp_f32 v208, v208
    v_mfma_f32_16x16x32_bf16 v[212:215], a[212:215], v[116:119], v[212:215]
    s_add_u32 s49, s7, 73728
    v_exp_f32 v209, v209
    v_mfma_f32_16x16x32_bf16 v[212:215], a[216:219], v[120:123], v[212:215]
    s_add_u32 m0, s42, 81920
    v_exp_f32 v210, v210
    v_mfma_f32_16x16x32_bf16 v[212:215], a[220:223], v[124:127], v[212:215]
    v_exp_f32 v211, v211
    v_mfma_f32_16x16x32_bf16 a[88:91], a[168:171], v[144:147], a[88:91]
    ds_read_b64_tr_b16 a[184:185], v27 offset:32768
    v_cvt_pk_bf16_f32 v180, v208, v209
    v_mfma_f32_16x16x32_bf16 a[88:91], a[172:175], v[148:151], a[88:91]
    ds_read_b64_tr_b16 a[186:187], v27 offset:36864
    v_lshrrev_b32 v244, 1, v0
    v_mfma_f32_16x16x32_bf16 a[92:95], a[172:175], v[156:159], a[92:95]
    v_cvt_pk_bf16_f32 v181, v210, v211
    v_mfma_f32_16x16x32_bf16 a[92:95], a[168:171], v[152:155], a[92:95]
    s_waitcnt lgkmcnt(3)
    buffer_load_dwordx4 v46, s[20:23], s49 offen lds
    v_mfma_f32_16x16x32_bf16 v[208:211], a[224:227], v[64:67], v[192:195]
    v_exp_f32 v212, v212
    v_mfma_f32_16x16x32_bf16 v[208:211], a[228:231], v[68:71], v[208:211]
    v_exp_f32 v213, v213
    v_mfma_f32_16x16x32_bf16 v[208:211], a[232:235], v[72:75], v[208:211]
    s_waitcnt lgkmcnt(2)
    v_exp_f32 v214, v214
    v_mfma_f32_16x16x32_bf16 v[208:211], a[236:239], v[76:79], v[208:211]
    v_exp_f32 v215, v215
    v_mfma_f32_16x16x32_bf16 a[96:99], a[176:179], v[128:131], a[96:99]
    ds_read_b64_tr_b16 a[188:189], v27 offset:40960
    v_cvt_pk_bf16_f32 v188, v212, v213
    v_mfma_f32_16x16x32_bf16 a[96:99], a[180:183], v[132:135], a[96:99]
    ds_read_b64_tr_b16 a[190:191], v27 offset:45056
    v_lshlrev_b32 v244, 4, v244
    v_mfma_f32_16x16x32_bf16 a[100:103], a[180:183], v[140:143], a[100:103]
    v_cvt_pk_bf16_f32 v189, v214, v215
    v_mfma_f32_16x16x32_bf16 a[100:103], a[176:179], v[136:139], a[100:103]
    v_and_b32 v245, 1, v0
    v_lshl_add_u32 v244, v245, 2, v244
    v_mfma_f32_16x16x32_bf16 v[212:215], a[224:227], v[80:83], v[196:199]
    v_exp_f32 v208, v208
    v_mfma_f32_16x16x32_bf16 v[212:215], a[228:231], v[84:87], v[212:215]
    v_exp_f32 v209, v209
    v_mfma_f32_16x16x32_bf16 v[212:215], a[232:235], v[88:91], v[212:215]
    v_exp_f32 v210, v210
    v_mfma_f32_16x16x32_bf16 v[212:215], a[236:239], v[92:95], v[212:215]
    v_exp_f32 v211, v211
    v_mfma_f32_16x16x32_bf16 a[104:107], a[176:179], v[144:147], a[104:107]
    ds_read_b64_tr_b16 a[160:161], v20 offset:49152
    v_cvt_pk_bf16_f32 v166, v208, v209
    v_mfma_f32_16x16x32_bf16 a[104:107], a[180:183], v[148:151], a[104:107]
    ds_read_b64_tr_b16 a[162:163], v20 offset:53248
    v_lshrrev_b32 v245, 3, v0
    v_mfma_f32_16x16x32_bf16 a[108:111], a[180:183], v[156:159], a[108:111]
    v_cvt_pk_bf16_f32 v167, v210, v211
    v_mfma_f32_16x16x32_bf16 a[108:111], a[176:179], v[152:155], a[108:111]
    s_waitcnt lgkmcnt(3)
    buffer_load_dwordx4 v47, s[20:23], s49 offen offset:1024 lds
    v_mfma_f32_16x16x32_bf16 v[208:211], a[224:227], v[96:99], v[200:203]
    v_exp_f32 v212, v212
    v_mfma_f32_16x16x32_bf16 v[208:211], a[228:231], v[100:103], v[208:211]
    v_exp_f32 v213, v213
    v_mfma_f32_16x16x32_bf16 v[208:211], a[232:235], v[104:107], v[208:211]
    v_exp_f32 v214, v214
    v_mfma_f32_16x16x32_bf16 v[208:211], a[236:239], v[108:111], v[208:211]
    s_add_u32 s57, s59, 0
    v_exp_f32 v215, v215
    v_mfma_f32_16x16x32_bf16 a[112:115], a[184:187], v[128:131], a[112:115]
    s_waitcnt lgkmcnt(2)
    ds_read_b64_tr_b16 a[164:165], v20 offset:57344
    v_cvt_pk_bf16_f32 v174, v212, v213
    v_mfma_f32_16x16x32_bf16 a[112:115], a[188:191], v[132:135], a[112:115]
    ds_read_b64_tr_b16 a[166:167], v20 offset:61440
    v_min_u32 v245, 1, v245
    v_mfma_f32_16x16x32_bf16 a[116:119], a[188:191], v[140:143], a[116:119]
    v_cvt_pk_bf16_f32 v175, v214, v215
    v_mfma_f32_16x16x32_bf16 a[116:119], a[184:187], v[136:139], a[116:119]
    buffer_load_dwordx4 a[252:255], v255, s[84:87], s57 offen
    v_mfma_f32_16x16x32_bf16 v[212:215], a[224:227], v[112:115], v[204:207]
    v_exp_f32 v208, v208
    v_mfma_f32_16x16x32_bf16 v[212:215], a[228:231], v[116:119], v[212:215]
    v_exp_f32 v209, v209
    v_mfma_f32_16x16x32_bf16 v[212:215], a[232:235], v[120:123], v[212:215]
    v_exp_f32 v210, v210
    v_mfma_f32_16x16x32_bf16 v[212:215], a[236:239], v[124:127], v[212:215]
    v_exp_f32 v211, v211
    v_mfma_f32_16x16x32_bf16 a[120:123], a[184:187], v[144:147], a[120:123]
    ds_read_b64_tr_b16 a[168:169], v21 offset:49152
    v_cvt_pk_bf16_f32 v182, v208, v209
    v_mfma_f32_16x16x32_bf16 a[120:123], a[188:191], v[148:151], a[120:123]
    ds_read_b64_tr_b16 a[170:171], v21 offset:53248
    v_lshl_or_b32 v244, v245, 31, v244
    v_mfma_f32_16x16x32_bf16 a[124:127], a[188:191], v[156:159], a[124:127]
    v_cvt_pk_bf16_f32 v183, v210, v211
    v_mfma_f32_16x16x32_bf16 a[124:127], a[184:187], v[152:155], a[124:127]
    s_waitcnt lgkmcnt(3)
    buffer_load_dwordx4 v48, s[20:23], s49 offen offset:2048 lds
    v_smfmac_f32_16x16x64_bf16 a[192:195], v[52:55], v[160:167], v50
    v_exp_f32 v212, v212
    v_smfmac_f32_16x16x64_bf16 a[196:199], v[52:55], v[168:175], v50
    v_exp_f32 v213, v213
    v_smfmac_f32_16x16x64_bf16 a[200:203], v[52:55], v[176:183], v50
    v_exp_f32 v214, v214
    v_exp_f32 v215, v215
    v_mfma_f32_16x16x32_bf16 a[0:3], a[160:163], v[160:163], a[0:3]
    s_waitcnt lgkmcnt(2)
    ds_read_b64_tr_b16 a[172:173], v21 offset:57344
    v_cvt_pk_bf16_f32 v190, v212, v213
    v_mfma_f32_16x16x32_bf16 a[0:3], a[164:167], v[164:167], a[0:3]
    ds_read_b64_tr_b16 a[174:175], v21 offset:61440
    v_mfma_f32_16x16x32_bf16 a[4:7], a[164:167], v[172:175], a[4:7]
    v_cvt_pk_bf16_f32 v191, v214, v215
    v_mfma_f32_16x16x32_bf16 a[4:7], a[160:163], v[168:171], a[4:7]
    buffer_store_dword v246, v244, s[24:27], s39 offen sc1
    v_smfmac_f32_16x16x64_bf16 a[204:207], v[52:55], v[184:191], v50
    v_mfma_f32_16x16x32_bf16 a[8:11], a[160:163], v[176:179], a[8:11]
    ds_read_b64_tr_b16 a[176:177], v22 offset:49152
    v_mfma_f32_16x16x32_bf16 a[8:11], a[164:167], v[180:183], a[8:11]
    ds_read_b64_tr_b16 a[178:179], v22 offset:53248
    v_accvgpr_read_b32 v216, a192
    v_accvgpr_read_b32 v217, a193
    v_mfma_f32_16x16x32_bf16 a[12:15], a[164:167], v[188:191], a[12:15]
    v_accvgpr_read_b32 v218, a196
    v_accvgpr_read_b32 v219, a197
    v_mfma_f32_16x16x32_bf16 a[12:15], a[160:163], v[184:187], a[12:15]
    s_waitcnt lgkmcnt(4)
    buffer_load_dwordx4 v49, s[20:23], s49 offen offset:3072 lds
    v_accvgpr_read_b32 v220, a200
    v_accvgpr_read_b32 v221, a201
    v_mfma_f32_16x16x32_bf16 a[16:19], a[168:171], v[160:163], a[16:19]
    s_waitcnt lgkmcnt(2)
    ds_read_b64_tr_b16 a[180:181], v22 offset:57344
    s_waitcnt vmcnt(9)
    v_accvgpr_read_b32 v222, a204
    v_mfma_f32_16x16x32_bf16 a[16:19], a[172:175], v[164:167], a[16:19]
    ds_read_b64_tr_b16 a[182:183], v22 offset:61440
    v_accvgpr_read_b32 v223, a205
    v_add_f32 v58, v216, v217
    v_mfma_f32_16x16x32_bf16 a[20:23], a[172:175], v[172:175], a[20:23]
    v_add_f32 v59, v218, v219
    v_add_f32 v60, v220, v221
    v_mfma_f32_16x16x32_bf16 a[20:23], a[168:171], v[168:171], a[20:23]
    v_add_f32 v61, v222, v223
    v_add_f32 v216, v58, v59
    s_add_u32 s49, s7, 256
    s_add_u32 m0, s42, 32768
    v_mfma_f32_16x16x32_bf16 a[24:27], a[168:171], v[176:179], a[24:27]
    ds_read_b64_tr_b16 a[184:185], v23 offset:49152
    v_add_f32 v217, v60, v61
    v_mfma_f32_16x16x32_bf16 a[24:27], a[172:175], v[180:183], a[24:27]
    ds_read_b64_tr_b16 a[186:187], v23 offset:53248
    v_add_f32 v216, v216, v217
    v_cmp_ngt_f32 vcc, 1669332992, v216
    v_mfma_f32_16x16x32_bf16 a[28:31], a[172:175], v[188:191], a[28:31]
    v_rcp_f32 v58, v58
    v_rcp_f32 v59, v59
    v_mfma_f32_16x16x32_bf16 a[28:31], a[168:171], v[184:187], a[28:31]
    s_waitcnt lgkmcnt(4)
    buffer_load_dwordx4 v46, s[20:23], s49 offen lds
    v_rcp_f32 v60, v60
    v_rcp_f32 v61, v61
    v_mfma_f32_16x16x32_bf16 a[32:35], a[176:179], v[160:163], a[32:35]
    s_waitcnt lgkmcnt(2)
    ds_read_b64_tr_b16 a[188:189], v23 offset:57344
    v_mov_b32 v228, 131072
    v_mfma_f32_16x16x32_bf16 a[32:35], a[180:183], v[164:167], a[32:35]
    ds_read_b64_tr_b16 a[190:191], v23 offset:61440
    s_or_b32 s36, vcc_lo, vcc_hi
    v_mfma_f32_16x16x32_bf16 a[36:39], a[180:183], v[172:175], a[36:39]
    v_accvgpr_read_b32 v208, a0
    v_accvgpr_read_b32 v209, a1
    v_accvgpr_read_b32 v210, a2
    v_accvgpr_read_b32 v211, a3
    v_pk_mul_f32 v[208:209], v[208:209], v[58:59] op_sel:[0,0] op_sel_hi:[1,0]
    v_pk_mul_f32 v[210:211], v[210:211], v[58:59] op_sel:[0,0] op_sel_hi:[1,0]
    v_cvt_pk_bf16_f32 v128, v208, v209
    v_cvt_pk_bf16_f32 v129, v210, v211
    v_mfma_f32_16x16x32_bf16 a[36:39], a[176:179], v[168:171], a[36:39]
    v_accvgpr_read_b32 v212, a4
    v_accvgpr_read_b32 v213, a5
    v_accvgpr_read_b32 v214, a6
    v_accvgpr_read_b32 v215, a7
    v_pk_mul_f32 v[212:213], v[212:213], v[58:59] op_sel:[0,1] op_sel_hi:[1,1]
    v_pk_mul_f32 v[214:215], v[214:215], v[58:59] op_sel:[0,1] op_sel_hi:[1,1]
    v_cvt_pk_bf16_f32 v132, v212, v213
    v_cvt_pk_bf16_f32 v133, v214, v215
    v_mfma_f32_16x16x32_bf16 a[40:43], a[176:179], v[176:179], a[40:43]
    ds_read_b64_tr_b16 a[160:161], v24 offset:49152
    v_mov_b32 v218, s36
    v_mfma_f32_16x16x32_bf16 a[40:43], a[180:183], v[180:183], a[40:43]
    ds_read_b64_tr_b16 a[162:163], v24 offset:53248
    s_lshl_b32 s38, s3, 2
    v_mfma_f32_16x16x32_bf16 a[44:47], a[180:183], v[188:191], a[44:47]
    v_accvgpr_read_b32 v208, a8
    v_accvgpr_read_b32 v209, a9
    v_accvgpr_read_b32 v210, a10
    v_accvgpr_read_b32 v211, a11
    v_pk_mul_f32 v[208:209], v[208:209], v[60:61] op_sel:[0,0] op_sel_hi:[1,0]
    v_pk_mul_f32 v[210:211], v[210:211], v[60:61] op_sel:[0,0] op_sel_hi:[1,0]
    v_cvt_pk_bf16_f32 v136, v208, v209
    v_cvt_pk_bf16_f32 v137, v210, v211
    v_mfma_f32_16x16x32_bf16 a[44:47], a[176:179], v[184:187], a[44:47]
    s_waitcnt lgkmcnt(4)
    buffer_load_dwordx4 v47, s[20:23], s49 offen offset:1024 lds
    v_accvgpr_read_b32 v212, a12
    v_accvgpr_read_b32 v213, a13
    v_accvgpr_read_b32 v214, a14
    v_accvgpr_read_b32 v215, a15
    v_pk_mul_f32 v[212:213], v[212:213], v[60:61] op_sel:[0,1] op_sel_hi:[1,1]
    v_pk_mul_f32 v[214:215], v[214:215], v[60:61] op_sel:[0,1] op_sel_hi:[1,1]
    v_cvt_pk_bf16_f32 v140, v212, v213
    v_cvt_pk_bf16_f32 v141, v214, v215
    v_mfma_f32_16x16x32_bf16 a[48:51], a[184:187], v[160:163], a[48:51]
    s_waitcnt lgkmcnt(2)
    ds_read_b64_tr_b16 a[164:165], v24 offset:57344
    v_add_u32 v219, s38, v228
    v_mfma_f32_16x16x32_bf16 a[48:51], a[188:191], v[164:167], a[48:51]
    ds_read_b64_tr_b16 a[166:167], v24 offset:61440
    ds_write_b32 v219, v218
    v_mfma_f32_16x16x32_bf16 a[52:55], a[188:191], v[172:175], a[52:55]
    v_accvgpr_read_b32 v208, a16
    v_accvgpr_read_b32 v209, a17
    v_accvgpr_read_b32 v210, a18
    v_accvgpr_read_b32 v211, a19
    v_pk_mul_f32 v[208:209], v[208:209], v[58:59] op_sel:[0,0] op_sel_hi:[1,0]
    v_pk_mul_f32 v[210:211], v[210:211], v[58:59] op_sel:[0,0] op_sel_hi:[1,0]
    v_cvt_pk_bf16_f32 v130, v208, v209
    v_cvt_pk_bf16_f32 v131, v210, v211
    s_add_u32 s37, s55, 0
    buffer_store_dwordx4 v[128:131], v252, s[28:31], s37 offen offset:0
    v_mfma_f32_16x16x32_bf16 a[52:55], a[184:187], v[168:171], a[52:55]
    v_accvgpr_read_b32 v212, a20
    v_accvgpr_read_b32 v213, a21
    v_accvgpr_read_b32 v214, a22
    v_accvgpr_read_b32 v215, a23
    v_pk_mul_f32 v[212:213], v[212:213], v[58:59] op_sel:[0,1] op_sel_hi:[1,1]
    v_pk_mul_f32 v[214:215], v[214:215], v[58:59] op_sel:[0,1] op_sel_hi:[1,1]
    v_cvt_pk_bf16_f32 v134, v212, v213
    v_cvt_pk_bf16_f32 v135, v214, v215
    s_add_u32 s37, s55, 8192
    buffer_store_dwordx4 v[132:135], v252, s[28:31], s37 offen offset:0
    v_mfma_f32_16x16x32_bf16 a[56:59], a[184:187], v[176:179], a[56:59]
    ds_read_b64_tr_b16 a[168:169], v25 offset:49152
    v_min_u32 v240, 1, v0
    v_mfma_f32_16x16x32_bf16 a[56:59], a[188:191], v[180:183], a[56:59]
    ds_read_b64_tr_b16 a[170:171], v25 offset:53248
    v_mfma_f32_16x16x32_bf16 a[60:63], a[188:191], v[188:191], a[60:63]
    v_accvgpr_read_b32 v208, a24
    v_accvgpr_read_b32 v209, a25
    v_accvgpr_read_b32 v210, a26
    v_accvgpr_read_b32 v211, a27
    v_pk_mul_f32 v[208:209], v[208:209], v[60:61] op_sel:[0,0] op_sel_hi:[1,0]
    v_pk_mul_f32 v[210:211], v[210:211], v[60:61] op_sel:[0,0] op_sel_hi:[1,0]
    v_cvt_pk_bf16_f32 v138, v208, v209
    v_cvt_pk_bf16_f32 v139, v210, v211
    s_add_u32 s37, s55, 4096
    buffer_store_dwordx4 v[136:139], v252, s[28:31], s37 offen offset:0
    v_mfma_f32_16x16x32_bf16 a[60:63], a[184:187], v[184:187], a[60:63]
    s_waitcnt lgkmcnt(5)
    buffer_load_dwordx4 v48, s[20:23], s49 offen offset:2048 lds
    v_accvgpr_read_b32 v212, a28
    v_accvgpr_read_b32 v213, a29
    v_accvgpr_read_b32 v214, a30
    v_accvgpr_read_b32 v215, a31
    v_pk_mul_f32 v[212:213], v[212:213], v[60:61] op_sel:[0,1] op_sel_hi:[1,1]
    v_pk_mul_f32 v[214:215], v[214:215], v[60:61] op_sel:[0,1] op_sel_hi:[1,1]
    v_cvt_pk_bf16_f32 v142, v212, v213
    v_cvt_pk_bf16_f32 v143, v214, v215
    s_add_u32 s37, s55, 12288
    buffer_store_dwordx4 v[140:143], v252, s[28:31], s37 offen offset:0
    v_mfma_f32_16x16x32_bf16 a[64:67], a[160:163], v[160:163], a[64:67]
    s_waitcnt lgkmcnt(3)
    ds_read_b64_tr_b16 a[172:173], v25 offset:57344
    v_lshlrev_b32 v240, 31, v240
    v_mfma_f32_16x16x32_bf16 a[64:67], a[164:167], v[164:167], a[64:67]
    ds_read_b64_tr_b16 a[174:175], v25 offset:61440
    v_mfma_f32_16x16x32_bf16 a[68:71], a[164:167], v[172:175], a[68:71]
    v_accvgpr_read_b32 v208, a32
    v_accvgpr_read_b32 v209, a33
    v_accvgpr_read_b32 v210, a34
    v_accvgpr_read_b32 v211, a35
    v_pk_mul_f32 v[208:209], v[208:209], v[58:59] op_sel:[0,0] op_sel_hi:[1,0]
    v_pk_mul_f32 v[210:211], v[210:211], v[58:59] op_sel:[0,0] op_sel_hi:[1,0]
    v_cvt_pk_bf16_f32 v144, v208, v209
    v_cvt_pk_bf16_f32 v145, v210, v211
    v_mfma_f32_16x16x32_bf16 a[68:71], a[160:163], v[168:171], a[68:71]
    v_accvgpr_read_b32 v212, a36
    v_accvgpr_read_b32 v213, a37
    v_accvgpr_read_b32 v214, a38
    v_accvgpr_read_b32 v215, a39
    v_pk_mul_f32 v[212:213], v[212:213], v[58:59] op_sel:[0,1] op_sel_hi:[1,1]
    v_pk_mul_f32 v[214:215], v[214:215], v[58:59] op_sel:[0,1] op_sel_hi:[1,1]
    v_cvt_pk_bf16_f32 v148, v212, v213
    v_cvt_pk_bf16_f32 v149, v214, v215
    v_mfma_f32_16x16x32_bf16 a[72:75], a[160:163], v[176:179], a[72:75]
    ds_read_b64_tr_b16 a[176:177], v26 offset:49152
    v_mov_b32 v241, 1
    v_mfma_f32_16x16x32_bf16 a[72:75], a[164:167], v[180:183], a[72:75]
    ds_read_b64_tr_b16 a[178:179], v26 offset:53248
    v_mfma_f32_16x16x32_bf16 a[76:79], a[164:167], v[188:191], a[76:79]
    v_accvgpr_read_b32 v208, a40
    v_accvgpr_read_b32 v209, a41
    v_accvgpr_read_b32 v210, a42
    v_accvgpr_read_b32 v211, a43
    v_pk_mul_f32 v[208:209], v[208:209], v[60:61] op_sel:[0,0] op_sel_hi:[1,0]
    v_pk_mul_f32 v[210:211], v[210:211], v[60:61] op_sel:[0,0] op_sel_hi:[1,0]
    v_cvt_pk_bf16_f32 v152, v208, v209
    v_cvt_pk_bf16_f32 v153, v210, v211
    v_mfma_f32_16x16x32_bf16 a[76:79], a[160:163], v[184:187], a[76:79]
    s_waitcnt lgkmcnt(4)
    buffer_load_dwordx4 v49, s[20:23], s49 offen offset:3072 lds
    v_accvgpr_read_b32 v212, a44
    v_accvgpr_read_b32 v213, a45
    v_accvgpr_read_b32 v214, a46
    v_accvgpr_read_b32 v215, a47
    v_pk_mul_f32 v[212:213], v[212:213], v[60:61] op_sel:[0,1] op_sel_hi:[1,1]
    v_pk_mul_f32 v[214:215], v[214:215], v[60:61] op_sel:[0,1] op_sel_hi:[1,1]
    v_cvt_pk_bf16_f32 v156, v212, v213
    v_cvt_pk_bf16_f32 v157, v214, v215
    v_mfma_f32_16x16x32_bf16 a[80:83], a[168:171], v[160:163], a[80:83]
    s_waitcnt lgkmcnt(2)
    ds_read_b64_tr_b16 a[180:181], v26 offset:57344
    v_mfma_f32_16x16x32_bf16 a[80:83], a[172:175], v[164:167], a[80:83]
    ds_read_b64_tr_b16 a[182:183], v26 offset:61440
    v_mfma_f32_16x16x32_bf16 a[84:87], a[172:175], v[172:175], a[84:87]
    v_accvgpr_read_b32 v208, a48
    v_accvgpr_read_b32 v209, a49
    v_accvgpr_read_b32 v210, a50
    v_accvgpr_read_b32 v211, a51
    v_pk_mul_f32 v[208:209], v[208:209], v[58:59] op_sel:[0,0] op_sel_hi:[1,0]
    v_pk_mul_f32 v[210:211], v[210:211], v[58:59] op_sel:[0,0] op_sel_hi:[1,0]
    v_cvt_pk_bf16_f32 v146, v208, v209
    v_cvt_pk_bf16_f32 v147, v210, v211
    s_add_u32 s37, s55, 0
    buffer_store_dwordx4 v[144:147], v252, s[28:31], s37 offen offset:1024
    v_mfma_f32_16x16x32_bf16 a[84:87], a[168:171], v[168:171], a[84:87]
    v_accvgpr_read_b32 v212, a52
    v_accvgpr_read_b32 v213, a53
    v_accvgpr_read_b32 v214, a54
    v_accvgpr_read_b32 v215, a55
    v_pk_mul_f32 v[212:213], v[212:213], v[58:59] op_sel:[0,1] op_sel_hi:[1,1]
    v_pk_mul_f32 v[214:215], v[214:215], v[58:59] op_sel:[0,1] op_sel_hi:[1,1]
    v_cvt_pk_bf16_f32 v150, v212, v213
    v_cvt_pk_bf16_f32 v151, v214, v215
    s_add_u32 s37, s55, 8192
    buffer_store_dwordx4 v[148:151], v252, s[28:31], s37 offen offset:1024
    s_waitcnt vmcnt(23)
    s_barrier
    v_mfma_f32_16x16x32_bf16 a[88:91], a[168:171], v[176:179], a[88:91]
    ds_read_b64_tr_b16 a[184:185], v27 offset:49152
    v_mfma_f32_16x16x32_bf16 a[88:91], a[172:175], v[180:183], a[88:91]
    ds_read_b64_tr_b16 a[186:187], v27 offset:53248
    v_mfma_f32_16x16x32_bf16 a[92:95], a[172:175], v[188:191], a[92:95]
    ds_read_b128 v[224:227], v228
    v_accvgpr_read_b32 v208, a56
    v_accvgpr_read_b32 v209, a57
    v_accvgpr_read_b32 v210, a58
    v_accvgpr_read_b32 v211, a59
    v_pk_mul_f32 v[208:209], v[208:209], v[60:61] op_sel:[0,0] op_sel_hi:[1,0]
    v_pk_mul_f32 v[210:211], v[210:211], v[60:61] op_sel:[0,0] op_sel_hi:[1,0]
    v_cvt_pk_bf16_f32 v154, v208, v209
    v_cvt_pk_bf16_f32 v155, v210, v211
    s_add_u32 s37, s55, 4096
    buffer_store_dwordx4 v[152:155], v252, s[28:31], s37 offen offset:1024
    v_mfma_f32_16x16x32_bf16 a[92:95], a[168:171], v[184:187], a[92:95]
    s_waitcnt lgkmcnt(5)
    v_accvgpr_read_b32 v212, a60
    v_accvgpr_read_b32 v213, a61
    v_accvgpr_read_b32 v214, a62
    v_accvgpr_read_b32 v215, a63
    v_pk_mul_f32 v[212:213], v[212:213], v[60:61] op_sel:[0,1] op_sel_hi:[1,1]
    v_pk_mul_f32 v[214:215], v[214:215], v[60:61] op_sel:[0,1] op_sel_hi:[1,1]
    v_cvt_pk_bf16_f32 v158, v212, v213
    v_cvt_pk_bf16_f32 v159, v214, v215
    s_add_u32 s37, s55, 12288
    buffer_store_dwordx4 v[156:159], v252, s[28:31], s37 offen offset:1024
    s_add_u32 s49, s7, 73984
    v_mfma_f32_16x16x32_bf16 a[96:99], a[176:179], v[160:163], a[96:99]
    s_waitcnt lgkmcnt(3)
    s_add_u32 m0, s42, 49152
    ds_read_b64_tr_b16 a[188:189], v27 offset:57344
    v_mfma_f32_16x16x32_bf16 a[96:99], a[180:183], v[164:167], a[96:99]
    buffer_load_dwordx4 v46, s[20:23], s49 offen lds
    v_mfma_f32_16x16x32_bf16 a[100:103], a[180:183], v[172:175], a[100:103]
    ds_read_b64_tr_b16 a[190:191], v27 offset:61440
    v_accvgpr_read_b32 v208, a64
    v_accvgpr_read_b32 v209, a65
    v_accvgpr_read_b32 v210, a66
    v_accvgpr_read_b32 v211, a67
    v_pk_mul_f32 v[208:209], v[208:209], v[58:59] op_sel:[0,0] op_sel_hi:[1,0]
    v_pk_mul_f32 v[210:211], v[210:211], v[58:59] op_sel:[0,0] op_sel_hi:[1,0]
    v_cvt_pk_bf16_f32 v192, v208, v209
    v_cvt_pk_bf16_f32 v193, v210, v211
    v_mfma_f32_16x16x32_bf16 a[100:103], a[176:179], v[168:171], a[100:103]
    buffer_load_dwordx4 v47, s[20:23], s49 offen offset:1024 lds
    v_accvgpr_read_b32 v212, a68
    v_accvgpr_read_b32 v213, a69
    v_accvgpr_read_b32 v214, a70
    v_accvgpr_read_b32 v215, a71
    v_pk_mul_f32 v[212:213], v[212:213], v[58:59] op_sel:[0,1] op_sel_hi:[1,1]
    v_pk_mul_f32 v[214:215], v[214:215], v[58:59] op_sel:[0,1] op_sel_hi:[1,1]
    v_cvt_pk_bf16_f32 v196, v212, v213
    v_cvt_pk_bf16_f32 v197, v214, v215
    v_mfma_f32_16x16x32_bf16 a[104:107], a[176:179], v[176:179], a[104:107]
    v_mfma_f32_16x16x32_bf16 a[104:107], a[180:183], v[180:183], a[104:107]
    buffer_load_dwordx4 v48, s[20:23], s49 offen offset:2048 lds
    v_mfma_f32_16x16x32_bf16 a[108:111], a[180:183], v[188:191], a[108:111]
    v_accvgpr_read_b32 v208, a72
    v_accvgpr_read_b32 v209, a73
    v_accvgpr_read_b32 v210, a74
    v_accvgpr_read_b32 v211, a75
    v_pk_mul_f32 v[208:209], v[208:209], v[60:61] op_sel:[0,0] op_sel_hi:[1,0]
    v_pk_mul_f32 v[210:211], v[210:211], v[60:61] op_sel:[0,0] op_sel_hi:[1,0]
    v_cvt_pk_bf16_f32 v200, v208, v209
    v_cvt_pk_bf16_f32 v201, v210, v211
    v_mfma_f32_16x16x32_bf16 a[108:111], a[176:179], v[184:187], a[108:111]
    s_waitcnt lgkmcnt(3)
    buffer_load_dwordx4 v49, s[20:23], s49 offen offset:3072 lds
    v_accvgpr_read_b32 v212, a76
    v_accvgpr_read_b32 v213, a77
    v_accvgpr_read_b32 v214, a78
    v_accvgpr_read_b32 v215, a79
    v_pk_mul_f32 v[212:213], v[212:213], v[60:61] op_sel:[0,1] op_sel_hi:[1,1]
    v_pk_mul_f32 v[214:215], v[214:215], v[60:61] op_sel:[0,1] op_sel_hi:[1,1]
    v_cvt_pk_bf16_f32 v204, v212, v213
    v_cvt_pk_bf16_f32 v205, v214, v215
    s_add_u32 s49, s46, 0
    v_mfma_f32_16x16x32_bf16 a[112:115], a[184:187], v[160:163], a[112:115]
    s_waitcnt lgkmcnt(0)
    s_add_u32 m0, s42, 98304
    v_mfma_f32_16x16x32_bf16 a[112:115], a[188:191], v[164:167], a[112:115]
    buffer_load_dwordx4 v46, s[20:23], s49 offen lds
    v_mfma_f32_16x16x32_bf16 a[116:119], a[188:191], v[172:175], a[116:119]
    v_accvgpr_read_b32 v208, a80
    v_accvgpr_read_b32 v209, a81
    v_accvgpr_read_b32 v210, a82
    v_accvgpr_read_b32 v211, a83
    v_pk_mul_f32 v[208:209], v[208:209], v[58:59] op_sel:[0,0] op_sel_hi:[1,0]
    v_pk_mul_f32 v[210:211], v[210:211], v[58:59] op_sel:[0,0] op_sel_hi:[1,0]
    v_cvt_pk_bf16_f32 v194, v208, v209
    v_cvt_pk_bf16_f32 v195, v210, v211
    s_add_u32 s37, s55, 0
    buffer_store_dwordx4 v[192:195], v252, s[28:31], s37 offen offset:2048
    v_mfma_f32_16x16x32_bf16 a[116:119], a[184:187], v[168:171], a[116:119]
    buffer_load_dwordx4 v47, s[20:23], s49 offen offset:1024 lds
    v_accvgpr_read_b32 v212, a84
    v_accvgpr_read_b32 v213, a85
    v_accvgpr_read_b32 v214, a86
    v_accvgpr_read_b32 v215, a87
    v_pk_mul_f32 v[212:213], v[212:213], v[58:59] op_sel:[0,1] op_sel_hi:[1,1]
    v_pk_mul_f32 v[214:215], v[214:215], v[58:59] op_sel:[0,1] op_sel_hi:[1,1]
    v_cvt_pk_bf16_f32 v198, v212, v213
    v_cvt_pk_bf16_f32 v199, v214, v215
    s_add_u32 s37, s55, 8192
    buffer_store_dwordx4 v[196:199], v252, s[28:31], s37 offen offset:2048
    v_mfma_f32_16x16x32_bf16 a[120:123], a[184:187], v[176:179], a[120:123]
    v_mfma_f32_16x16x32_bf16 a[120:123], a[188:191], v[180:183], a[120:123]
    buffer_load_dwordx4 v48, s[20:23], s49 offen offset:2048 lds
    v_mfma_f32_16x16x32_bf16 a[124:127], a[188:191], v[188:191], a[124:127]
    v_accvgpr_read_b32 v208, a88
    v_accvgpr_read_b32 v209, a89
    v_accvgpr_read_b32 v210, a90
    v_accvgpr_read_b32 v211, a91
    v_pk_mul_f32 v[208:209], v[208:209], v[60:61] op_sel:[0,0] op_sel_hi:[1,0]
    v_pk_mul_f32 v[210:211], v[210:211], v[60:61] op_sel:[0,0] op_sel_hi:[1,0]
    v_cvt_pk_bf16_f32 v202, v208, v209
    v_cvt_pk_bf16_f32 v203, v210, v211
    s_add_u32 s37, s55, 4096
    buffer_store_dwordx4 v[200:203], v252, s[28:31], s37 offen offset:2048
    v_mfma_f32_16x16x32_bf16 a[124:127], a[184:187], v[184:187], a[124:127]
    buffer_load_dwordx4 v49, s[20:23], s49 offen offset:3072 lds
    v_accvgpr_read_b32 v212, a92
    v_accvgpr_read_b32 v213, a93
    v_accvgpr_read_b32 v214, a94
    v_accvgpr_read_b32 v215, a95
    v_pk_mul_f32 v[212:213], v[212:213], v[60:61] op_sel:[0,1] op_sel_hi:[1,1]
    v_pk_mul_f32 v[214:215], v[214:215], v[60:61] op_sel:[0,1] op_sel_hi:[1,1]
    v_cvt_pk_bf16_f32 v206, v212, v213
    v_cvt_pk_bf16_f32 v207, v214, v215
    s_add_u32 s37, s55, 12288
    buffer_store_dwordx4 v[204:207], v252, s[28:31], s37 offen offset:2048
    v_or3_b32 v224, v224, v225, v226
    v_or_b32 v224, v224, v227
    s_nop 0
    v_readfirstlane_b32 s36, v224
    v_readfirstlane_b32 s38, v253
    v_min_u32 v8, 1, v1
    v_lshlrev_b32 v8, 31, v8
    v_mov_b32 v10, s95
    s_getreg_b32 s39, hwreg(HW_REG_XCC_ID, 0, 4)
    s_lshl_b32 s39, s39, 28
    s_xor_b32 s39, s39, s95
    s_cmp_eq_u32 s38, s39
    s_cselect_b32 s53, 1, 0
    ds_read_b64_tr_b16 a[208:209], v12 offset:0
    ds_read_b64_tr_b16 a[210:211], v12 offset:4096
    ds_read_b64_tr_b16 a[212:213], v12 offset:8192
    ds_read_b64_tr_b16 a[214:215], v12 offset:12288
    ds_read_b64_tr_b16 a[216:217], v12 offset:16384
    ds_read_b64_tr_b16 a[218:219], v12 offset:20480
    ds_read_b64_tr_b16 a[220:221], v12 offset:24576
    ds_read_b64_tr_b16 a[222:223], v12 offset:28672
    ds_read_b64_tr_b16 a[224:225], v16 offset:0
    ds_read_b64_tr_b16 a[226:227], v16 offset:4096
    ds_read_b64_tr_b16 a[228:229], v16 offset:8192
    ds_read_b64_tr_b16 a[230:231], v16 offset:12288
    ds_read_b64_tr_b16 a[232:233], v16 offset:16384
    ds_read_b64_tr_b16 a[234:235], v16 offset:20480
    ds_read_b64_tr_b16 a[236:237], v16 offset:24576
    ds_read_b64_tr_b16 a[238:239], v16 offset:28672
    s_andn2_b32 s36, s36, s48
    s_cbranch_scc1 Lattn_redo
    v_accvgpr_read_b32 v208, a96
    v_accvgpr_read_b32 v209, a97
    v_accvgpr_read_b32 v210, a98
    v_accvgpr_read_b32 v211, a99
    v_pk_mul_f32 v[208:209], v[208:209], v[58:59] op_sel:[0,0] op_sel_hi:[1,0]
Ltour0_8:
    s_cbranch_execz Ltour0_12
    v_pk_mul_f32 v[210:211], v[210:211], v[58:59] op_sel:[0,0] op_sel_hi:[1,0]
    v_cvt_pk_bf16_f32 v176, v208, v209
    v_cvt_pk_bf16_f32 v177, v210, v211
    v_accvgpr_read_b32 v212, a100
    v_accvgpr_read_b32 v213, a101
    v_accvgpr_read_b32 v214, a102
    v_accvgpr_read_b32 v215, a103
    v_pk_mul_f32 v[212:213], v[212:213], v[58:59] op_sel:[0,1] op_sel_hi:[1,1]
    v_pk_mul_f32 v[214:215], v[214:215], v[58:59] op_sel:[0,1] op_sel_hi:[1,1]
    v_cvt_pk_bf16_f32 v180, v212, v213
    v_cvt_pk_bf16_f32 v181, v214, v215
    v_accvgpr_read_b32 v208, a104
    v_accvgpr_read_b32 v209, a105
    v_accvgpr_read_b32 v210, a106
    v_accvgpr_read_b32 v211, a107
    v_pk_mul_f32 v[208:209], v[208:209], v[60:61] op_sel:[0,0] op_sel_hi:[1,0]
    v_pk_mul_f32 v[210:211], v[210:211], v[60:61] op_sel:[0,0] op_sel_hi:[1,0]
    v_cvt_pk_bf16_f32 v184, v208, v209
    v_cvt_pk_bf16_f32 v185, v210, v211
    v_accvgpr_read_b32 v212, a108
    v_accvgpr_read_b32 v213, a109
    v_accvgpr_read_b32 v214, a110
    v_accvgpr_read_b32 v215, a111
    v_pk_mul_f32 v[212:213], v[212:213], v[60:61] op_sel:[0,1] op_sel_hi:[1,1]
    v_pk_mul_f32 v[214:215], v[214:215], v[60:61] op_sel:[0,1] op_sel_hi:[1,1]
    v_cvt_pk_bf16_f32 v188, v212, v213
    v_cvt_pk_bf16_f32 v189, v214, v215
    v_accvgpr_read_b32 v208, a112
    v_accvgpr_read_b32 v209, a113
    v_accvgpr_read_b32 v210, a114
    v_accvgpr_read_b32 v211, a115
    v_pk_mul_f32 v[208:209], v[208:209], v[58:59] op_sel:[0,0] op_sel_hi:[1,0]
    v_pk_mul_f32 v[210:211], v[210:211], v[58:59] op_sel:[0,0] op_sel_hi:[1,0]
    v_cvt_pk_bf16_f32 v178, v208, v209
    v_cvt_pk_bf16_f32 v179, v210, v211
    s_add_u32 s37, s55, 0
    buffer_store_dwordx4 v[176:179], v252, s[28:31], s37 offen offset:3072
    v_accvgpr_read_b32 v212, a116
    v_accvgpr_read_b32 v213, a117
    v_accvgpr_read_b32 v214, a118
    v_accvgpr_read_b32 v215, a119
    v_pk_mul_f32 v[212:213], v[212:213], v[58:59] op_sel:[0,1] op_sel_hi:[1,1]
    v_pk_mul_f32 v[214:215], v[214:215], v[58:59] op_sel:[0,1] op_sel_hi:[1,1]
    v_cvt_pk_bf16_f32 v182, v212, v213
    v_cvt_pk_bf16_f32 v183, v214, v215
    s_add_u32 s37, s55, 8192
    buffer_store_dwordx4 v[180:183], v252, s[28:31], s37 offen offset:3072
    v_accvgpr_read_b32 v208, a120
    v_accvgpr_read_b32 v209, a121
    v_accvgpr_read_b32 v210, a122
    v_accvgpr_read_b32 v211, a123
    v_pk_mul_f32 v[208:209], v[208:209], v[60:61] op_sel:[0,0] op_sel_hi:[1,0]
    v_pk_mul_f32 v[210:211], v[210:211], v[60:61] op_sel:[0,0] op_sel_hi:[1,0]
    v_cvt_pk_bf16_f32 v186, v208, v209
    v_cvt_pk_bf16_f32 v187, v210, v211
    s_add_u32 s37, s55, 4096
    buffer_store_dwordx4 v[184:187], v252, s[28:31], s37 offen offset:3072
    v_accvgpr_read_b32 v212, a124
    v_accvgpr_read_b32 v213, a125
    v_accvgpr_read_b32 v214, a126
    v_accvgpr_read_b32 v215, a127
    v_pk_mul_f32 v[212:213], v[212:213], v[60:61] op_sel:[0,1] op_sel_hi:[1,1]
    v_pk_mul_f32 v[214:215], v[214:215], v[60:61] op_sel:[0,1] op_sel_hi:[1,1]
    v_cvt_pk_bf16_f32 v190, v212, v213
    v_cvt_pk_bf16_f32 v191, v214, v215
    s_add_u32 s37, s55, 12288
    buffer_store_dwordx4 v[188:191], v252, s[28:31], s37 offen offset:3072
    s_waitcnt lgkmcnt(14)
    v_mfma_f32_16x16x32_bf16 v[96:99], a[208:211], v[128:131], 0
    s_waitcnt lgkmcnt(12)
    ds_read_b64_tr_b16 a[160:161], v13 offset:0
    v_mfma_f32_16x16x32_bf16 v[96:99], a[212:215], v[144:147], v[96:99]
    s_waitcnt lgkmcnt(11)
    ds_read_b64_tr_b16 a[162:163], v13 offset:4096
    v_mfma_f32_16x16x32_bf16 v[96:99], a[216:219], v[192:195], v[96:99]
    s_waitcnt lgkmcnt(10)
    ds_read_b64_tr_b16 a[164:165], v13 offset:8192
    v_mfma_f32_16x16x32_bf16 v[96:99], a[220:223], v[176:179], v[96:99]
    s_waitcnt lgkmcnt(9)
    ds_read_b64_tr_b16 a[166:167], v13 offset:12288
    v_mfma_f32_16x16x32_bf16 v[96:99], a[224:227], v[136:139], v[96:99]
    s_waitcnt lgkmcnt(8)
    ds_read_b64_tr_b16 a[168:169], v13 offset:16384
    v_mfma_f32_16x16x32_bf16 v[96:99], a[228:231], v[152:155], v[96:99]
    s_waitcnt lgkmcnt(7)
    ds_read_b64_tr_b16 a[170:171], v13 offset:20480
    v_mfma_f32_16x16x32_bf16 v[96:99], a[232:235], v[200:203], v[96:99]
    s_waitcnt lgkmcnt(6)
    ds_read_b64_tr_b16 a[172:173], v13 offset:24576
    v_mfma_f32_16x16x32_bf16 v[96:99], a[236:239], v[184:187], v[96:99]
    ds_read_b64_tr_b16 a[174:175], v13 offset:28672
    v_mfma_f32_16x16x32_bf16 v[100:103], a[236:239], v[188:191], 0
    ds_read_b64_tr_b16 a[176:177], v17 offset:0
    v_mfma_f32_16x16x32_bf16 v[100:103], a[232:235], v[204:207], v[100:103]
    ds_read_b64_tr_b16 a[178:179], v17 offset:4096
    v_mfma_f32_16x16x32_bf16 v[100:103], a[228:231], v[156:159], v[100:103]
    ds_read_b64_tr_b16 a[180:181], v17 offset:8192
    v_mfma_f32_16x16x32_bf16 v[100:103], a[224:227], v[140:143], v[100:103]
    ds_read_b64_tr_b16 a[182:183], v17 offset:12288
    v_mfma_f32_16x16x32_bf16 v[100:103], a[220:223], v[180:183], v[100:103]
    ds_read_b64_tr_b16 a[184:185], v17 offset:16384
    v_cvt_pk_bf16_f32 v224, v96, v97
    v_mfma_f32_16x16x32_bf16 v[100:103], a[216:219], v[196:199], v[100:103]
    ds_read_b64_tr_b16 a[186:187], v17 offset:20480
    v_cvt_pk_bf16_f32 v225, v98, v99
    v_mfma_f32_16x16x32_bf16 v[100:103], a[212:215], v[148:151], v[100:103]
    ds_read_b64_tr_b16 a[188:189], v17 offset:24576
    v_mfma_f32_16x16x32_bf16 v[100:103], a[208:211], v[132:135], v[100:103]
    s_waitcnt lgkmcnt(13)
    ds_read_b64_tr_b16 a[190:191], v17 offset:28672
    v_mfma_f32_16x16x32_bf16 v[104:107], a[160:163], v[128:131], 0
    s_waitcnt lgkmcnt(12)
    ds_read_b64_tr_b16 a[208:209], v14 offset:0
    v_mfma_f32_16x16x32_bf16 v[104:107], a[164:167], v[144:147], v[104:107]
    s_waitcnt lgkmcnt(11)
    ds_read_b64_tr_b16 a[210:211], v14 offset:4096
    v_mfma_f32_16x16x32_bf16 v[104:107], a[168:171], v[192:195], v[104:107]
    s_waitcnt lgkmcnt(10)
    ds_read_b64_tr_b16 a[212:213], v14 offset:8192
    v_mfma_f32_16x16x32_bf16 v[104:107], a[172:175], v[176:179], v[104:107]
    s_waitcnt lgkmcnt(9)
    ds_read_b64_tr_b16 a[214:215], v14 offset:12288
    v_mfma_f32_16x16x32_bf16 v[104:107], a[176:179], v[136:139], v[104:107]
    s_waitcnt lgkmcnt(8)
    ds_read_b64_tr_b16 a[216:217], v14 offset:16384
    v_cvt_pk_bf16_f32 v228, v100, v101
    v_mfma_f32_16x16x32_bf16 v[104:107], a[180:183], v[152:155], v[104:107]
    s_waitcnt lgkmcnt(7)
    ds_read_b64_tr_b16 a[218:219], v14 offset:20480
    v_cvt_pk_bf16_f32 v229, v102, v103
    v_mfma_f32_16x16x32_bf16 v[104:107], a[184:187], v[200:203], v[104:107]
    s_waitcnt lgkmcnt(6)
    ds_read_b64_tr_b16 a[220:221], v14 offset:24576
    v_mfma_f32_16x16x32_bf16 v[104:107], a[188:191], v[184:187], v[104:107]
    ds_read_b64_tr_b16 a[222:223], v14 offset:28672
    s_waitcnt vmcnt(0)
    s_cmp_eq_u32 s53, 0
    s_cbranch_scc1 Lattn_wb
Lattn_wbdone:
    v_mfma_f32_16x16x32_bf16 v[108:111], a[188:191], v[188:191], 0
    buffer_store_dword v10, v8, s[24:27], s92 offen offset:8 sc1
    v_mfma_f32_16x16x32_bf16 v[108:111], a[184:187], v[204:207], v[108:111]
    s_xor_b32 s55, s55, 65536
    ds_read_b64_tr_b16 a[224:225], v18 offset:0
    ds_read_b64_tr_b16 a[226:227], v18 offset:4096
    v_mfma_f32_16x16x32_bf16 v[108:111], a[180:183], v[156:159], v[108:111]
    buffer_atomic_add v241, v240, s[88:91], 0 offen sc1
    v_mfma_f32_16x16x32_bf16 v[108:111], a[176:179], v[140:143], v[108:111]
    ds_read_b64_tr_b16 a[228:229], v18 offset:8192
    ds_read_b64_tr_b16 a[230:231], v18 offset:12288
    s_load_dwordx2 s[12:13], s[0:1], 0
    v_mfma_f32_16x16x32_bf16 v[108:111], a[172:175], v[180:183], v[108:111]
    ds_read_b64_tr_b16 a[232:233], v18 offset:16384
    v_cvt_pk_bf16_f32 v226, v104, v105
    v_mfma_f32_16x16x32_bf16 v[108:111], a[168:171], v[196:199], v[108:111]
    s_add_u32 s38, s56, 16384
    ds_read_b64_tr_b16 a[234:235], v18 offset:20480
    v_cvt_pk_bf16_f32 v227, v106, v107
    s_load_dwordx2 s[16:17], s[0:1], 96
    v_mfma_f32_16x16x32_bf16 v[108:111], a[164:167], v[148:151], v[108:111]
    buffer_store_dwordx4 v[224:227], v56, s[28:31], s38 offen sc1
    v_mfma_f32_16x16x32_bf16 v[108:111], a[160:163], v[132:135], v[108:111]
    s_waitcnt lgkmcnt(12)
    ds_read_b64_tr_b16 a[236:237], v18 offset:24576
    ds_read_b64_tr_b16 a[238:239], v18 offset:28672
    s_load_dwordx2 s[52:53], s[0:1], 48
    v_mfma_f32_16x16x32_bf16 v[112:115], a[208:211], v[128:131], 0
    s_waitcnt lgkmcnt(12)
    ds_read_b64_tr_b16 a[160:161], v15 offset:0
    v_mfma_f32_16x16x32_bf16 v[112:115], a[212:215], v[144:147], v[112:115]
    s_waitcnt lgkmcnt(11)
    ds_read_b64_tr_b16 a[162:163], v15 offset:4096
    v_mfma_f32_16x16x32_bf16 v[112:115], a[216:219], v[192:195], v[112:115]
    s_waitcnt lgkmcnt(10)
    ds_read_b64_tr_b16 a[164:165], v15 offset:8192
    v_mfma_f32_16x16x32_bf16 v[112:115], a[220:223], v[176:179], v[112:115]
    s_waitcnt lgkmcnt(9)
    ds_read_b64_tr_b16 a[166:167], v15 offset:12288
    v_mfma_f32_16x16x32_bf16 v[112:115], a[224:227], v[136:139], v[112:115]
    s_waitcnt lgkmcnt(8)
    ds_read_b64_tr_b16 a[168:169], v15 offset:16384
    v_cvt_pk_bf16_f32 v230, v108, v109
    v_mfma_f32_16x16x32_bf16 v[112:115], a[228:231], v[152:155], v[112:115]
    s_waitcnt lgkmcnt(7)
    s_add_u32 s38, s56, 180224
    ds_read_b64_tr_b16 a[170:171], v15 offset:20480
    v_cvt_pk_bf16_f32 v231, v110, v111
    v_mfma_f32_16x16x32_bf16 v[112:115], a[232:235], v[200:203], v[112:115]
    s_waitcnt lgkmcnt(6)
    buffer_store_dwordx4 v[228:231], v56, s[28:31], s38 offen sc1
    v_mfma_f32_16x16x32_bf16 v[112:115], a[236:239], v[184:187], v[112:115]
    ds_read_b64_tr_b16 a[172:173], v15 offset:24576
    ds_read_b64_tr_b16 a[174:175], v15 offset:28672
    v_mfma_f32_16x16x32_bf16 v[116:119], a[236:239], v[188:191], 0
    ds_read_b64_tr_b16 a[176:177], v19 offset:0
    v_mfma_f32_16x16x32_bf16 v[116:119], a[232:235], v[204:207], v[116:119]
    ds_read_b64_tr_b16 a[178:179], v19 offset:4096
    v_mfma_f32_16x16x32_bf16 v[116:119], a[228:231], v[156:159], v[116:119]
    ds_read_b64_tr_b16 a[180:181], v19 offset:8192
    v_mfma_f32_16x16x32_bf16 v[116:119], a[224:227], v[140:143], v[116:119]
    ds_read_b64_tr_b16 a[182:183], v19 offset:12288
    v_mfma_f32_16x16x32_bf16 v[116:119], a[220:223], v[180:183], v[116:119]
    ds_read_b64_tr_b16 a[184:185], v19 offset:16384
    v_cvt_pk_bf16_f32 v232, v112, v113
    v_mfma_f32_16x16x32_bf16 v[116:119], a[216:219], v[196:199], v[116:119]
    ds_read_b64_tr_b16 a[186:187], v19 offset:20480
    v_cvt_pk_bf16_f32 v233, v114, v115
    v_mfma_f32_16x16x32_bf16 v[116:119], a[212:215], v[148:151], v[116:119]
    ds_read_b64_tr_b16 a[188:189], v19 offset:24576
    v_mfma_f32_16x16x32_bf16 v[116:119], a[208:211], v[132:135], v[116:119]
    s_waitcnt lgkmcnt(13)
    ds_read_b64_tr_b16 a[190:191], v19 offset:28672
    s_barrier
    v_mfma_f32_16x16x32_bf16 v[120:123], a[160:163], v[128:131], 0
    s_waitcnt lgkmcnt(12)
    buffer_load_dword v11, v8, s[24:27], s54 offen offset:8 sc1
    v_mfma_f32_16x16x32_bf16 v[120:123], a[164:167], v[144:147], v[120:123]
    s_waitcnt lgkmcnt(10)
    ds_read_b64_tr_b16 a[208:209], v20 offset:0
    ds_read_b64_tr_b16 a[210:211], v20 offset:4096
    v_mfma_f32_16x16x32_bf16 v[120:123], a[168:171], v[192:195], v[120:123]
    s_waitcnt lgkmcnt(10)
    ds_read_b64_tr_b16 a[212:213], v20 offset:8192
    v_mfma_f32_16x16x32_bf16 v[120:123], a[172:175], v[176:179], v[120:123]
    s_waitcnt lgkmcnt(9)
    ds_read_b64_tr_b16 a[214:215], v20 offset:12288
    v_mfma_f32_16x16x32_bf16 v[120:123], a[176:179], v[136:139], v[120:123]
    s_waitcnt lgkmcnt(8)
    ds_read_b64_tr_b16 a[216:217], v20 offset:16384
    v_cvt_pk_bf16_f32 v236, v116, v117
    v_mfma_f32_16x16x32_bf16 v[120:123], a[180:183], v[152:155], v[120:123]
    s_waitcnt lgkmcnt(7)
    ds_read_b64_tr_b16 a[218:219], v20 offset:20480
    v_cvt_pk_bf16_f32 v237, v118, v119
    v_mfma_f32_16x16x32_bf16 v[120:123], a[184:187], v[200:203], v[120:123]
    s_waitcnt lgkmcnt(6)
    s_add_u32 s49, s46, 73728
    ds_read_b64_tr_b16 a[220:221], v20 offset:24576
    v_mfma_f32_16x16x32_bf16 v[120:123], a[188:191], v[184:187], v[120:123]
    s_add_u32 m0, s42, 114688
    ds_read_b64_tr_b16 a[222:223], v20 offset:28672
    v_mfma_f32_16x16x32_bf16 v[124:127], a[188:191], v[188:191], 0
    buffer_load_dwordx4 v46, s[20:23], s49 offen lds
    v_mfma_f32_16x16x32_bf16 v[124:127], a[184:187], v[204:207], v[124:127]
    ds_read_b64_tr_b16 a[224:225], v24 offset:0
    ds_read_b64_tr_b16 a[226:227], v24 offset:4096
    v_mfma_f32_16x16x32_bf16 v[124:127], a[180:183], v[156:159], v[124:127]
    buffer_load_dwordx4 v47, s[20:23], s49 offen offset:1024 lds
    v_mfma_f32_16x16x32_bf16 v[124:127], a[176:179], v[140:143], v[124:127]
    ds_read_b64_tr_b16 a[228:229], v24 offset:8192
    ds_read_b64_tr_b16 a[230:231], v24 offset:12288
    v_mfma_f32_16x16x32_bf16 v[124:127], a[172:175], v[180:183], v[124:127]
    ds_read_b64_tr_b16 a[232:233], v24 offset:16384
    v_cvt_pk_bf16_f32 v234, v120, v121
    v_mfma_f32_16x16x32_bf16 v[124:127], a[168:171], v[196:199], v[124:127]
    s_add_u32 s38, s56, 16512
    ds_read_b64_tr_b16 a[234:235], v24 offset:20480
    v_cvt_pk_bf16_f32 v235, v122, v123
    v_mfma_f32_16x16x32_bf16 v[124:127], a[164:167], v[148:151], v[124:127]
    buffer_store_dwordx4 v[232:235], v56, s[28:31], s38 offen sc1
    v_mfma_f32_16x16x32_bf16 v[124:127], a[160:163], v[132:135], v[124:127]
    s_waitcnt lgkmcnt(12)
    ds_read_b64_tr_b16 a[236:237], v24 offset:24576
    ds_read_b64_tr_b16 a[238:239], v24 offset:28672
    v_mfma_f32_16x16x32_bf16 v[64:67], a[208:211], v[128:131], 0
    s_waitcnt lgkmcnt(12)
    buffer_load_dwordx4 v48, s[20:23], s49 offen offset:2048 lds
    v_mfma_f32_16x16x32_bf16 v[64:67], a[212:215], v[144:147], v[64:67]
    s_waitcnt lgkmcnt(10)
    ds_read_b64_tr_b16 a[160:161], v21 offset:0
    ds_read_b64_tr_b16 a[162:163], v21 offset:4096
    v_mfma_f32_16x16x32_bf16 v[64:67], a[216:219], v[192:195], v[64:67]
    s_waitcnt lgkmcnt(10)
    buffer_load_dwordx4 v49, s[20:23], s49 offen offset:3072 lds
    v_mfma_f32_16x16x32_bf16 v[64:67], a[220:223], v[176:179], v[64:67]
    s_waitcnt lgkmcnt(8)
    ds_read_b64_tr_b16 a[164:165], v21 offset:8192
    ds_read_b64_tr_b16 a[166:167], v21 offset:12288
    v_mfma_f32_16x16x32_bf16 v[64:67], a[224:227], v[136:139], v[64:67]
    s_waitcnt lgkmcnt(8)
    ds_read_b64_tr_b16 a[168:169], v21 offset:16384
    v_cvt_pk_bf16_f32 v238, v124, v125
    v_mfma_f32_16x16x32_bf16 v[64:67], a[228:231], v[152:155], v[64:67]
    s_waitcnt lgkmcnt(7)
    s_add_u32 s38, s56, 180352
    ds_read_b64_tr_b16 a[170:171], v21 offset:20480
    v_cvt_pk_bf16_f32 v239, v126, v127
    v_mfma_f32_16x16x32_bf16 v[64:67], a[232:235], v[200:203], v[64:67]
    s_waitcnt lgkmcnt(6)
    buffer_store_dwordx4 v[236:239], v56, s[28:31], s38 offen sc1
    v_mfma_f32_16x16x32_bf16 v[64:67], a[236:239], v[184:187], v[64:67]
    ds_read_b64_tr_b16 a[172:173], v21 offset:24576
    ds_read_b64_tr_b16 a[174:175], v21 offset:28672
    v_mfma_f32_16x16x32_bf16 v[68:71], a[236:239], v[188:191], 0
    s_lshl_b32 s40, s5, 4
    ds_read_b64_tr_b16 a[176:177], v25 offset:0
    v_mfma_f32_16x16x32_bf16 v[68:71], a[232:235], v[204:207], v[68:71]
    s_add_u32 s40, s40, s4
    ds_read_b64_tr_b16 a[178:179], v25 offset:4096
    v_and_b32 v240, 31, v1
    v_mfma_f32_16x16x32_bf16 v[68:71], a[228:231], v[156:159], v[68:71]
    ds_read_b64_tr_b16 a[180:181], v25 offset:8192
    v_lshrrev_b32 v241, 5, v1
    v_mfma_f32_16x16x32_bf16 v[68:71], a[224:227], v[140:143], v[68:71]
    ds_read_b64_tr_b16 a[182:183], v25 offset:12288
    v_cmp_gt_u32 vcc, 8, v240
    v_mfma_f32_16x16x32_bf16 v[68:71], a[220:223], v[180:183], v[68:71]
    ds_read_b64_tr_b16 a[184:185], v25 offset:16384
    v_mov_b32 v242, 2147483648
    v_mfma_f32_16x16x32_bf16 v[68:71], a[216:219], v[196:199], v[68:71]
    s_lshl_b32 s43, s40, 3
    ds_read_b64_tr_b16 a[186:187], v25 offset:20480
    v_mfma_f32_16x16x32_bf16 v[68:71], a[212:215], v[148:151], v[68:71]
    s_lshl_b32 s44, s3, 1
    ds_read_b64_tr_b16 a[188:189], v25 offset:24576
    v_mfma_f32_16x16x32_bf16 v[68:71], a[208:211], v[132:135], v[68:71]
    s_waitcnt lgkmcnt(13)
    s_add_u32 s43, s43, s44
    ds_read_b64_tr_b16 a[190:191], v25 offset:28672
    v_cndmask_b32 v242, v242, 0, vcc
    v_mfma_f32_16x16x32_bf16 v[72:75], a[160:163], v[128:131], 0
    s_waitcnt lgkmcnt(12)
    ds_read_b64_tr_b16 a[208:209], v22 offset:0
    v_add_u32 v7, s43, v241
    v_mfma_f32_16x16x32_bf16 v[72:75], a[164:167], v[144:147], v[72:75]
    s_waitcnt lgkmcnt(11)
    ds_read_b64_tr_b16 a[210:211], v22 offset:4096
    v_lshlrev_b32 v5, 4, v240
    v_mfma_f32_16x16x32_bf16 v[72:75], a[168:171], v[192:195], v[72:75]
    s_waitcnt lgkmcnt(10)
    ds_read_b64_tr_b16 a[212:213], v22 offset:8192
    v_lshlrev_b32 v243, 4, v241
    v_mfma_f32_16x16x32_bf16 v[72:75], a[172:175], v[176:179], v[72:75]
    s_waitcnt lgkmcnt(9)
    ds_read_b64_tr_b16 a[214:215], v22 offset:12288
    v_lshl_add_u32 v2, v240, 5, v243
    v_mfma_f32_16x16x32_bf16 v[72:75], a[176:179], v[136:139], v[72:75]
    s_waitcnt lgkmcnt(8)
    ds_read_b64_tr_b16 a[216:217], v22 offset:16384
    v_lshrrev_b32 v243, 4, v240
    v_mfma_f32_16x16x32_bf16 v[72:75], a[180:183], v[152:155], v[72:75]
    s_waitcnt lgkmcnt(7)
    ds_read_b64_tr_b16 a[218:219], v22 offset:20480
    v_mul_u32_u24 v243, 1536, v243
    v_mfma_f32_16x16x32_bf16 v[72:75], a[184:187], v[200:203], v[72:75]
    s_waitcnt lgkmcnt(6)
    ds_read_b64_tr_b16 a[220:221], v22 offset:24576
    v_add_u32 v2, v2, v243
    v_mfma_f32_16x16x32_bf16 v[72:75], a[188:191], v[184:187], v[72:75]
    s_mul_i32 s44, s43, 10240
    ds_read_b64_tr_b16 a[222:223], v22 offset:28672
    v_lshrrev_b32 v243, 2, v240
    v_mfma_f32_16x16x32_bf16 v[76:79], a[188:191], v[188:191], 0
    ds_read_b64_tr_b16 a[224:225], v26 offset:0
    v_lshlrev_b32 v243, 6, v243
    v_mfma_f32_16x16x32_bf16 v[76:79], a[184:187], v[204:207], v[76:79]
    ds_read_b64_tr_b16 a[226:227], v26 offset:4096
    v_and_b32 v241, 3, v240
    v_mfma_f32_16x16x32_bf16 v[76:79], a[180:183], v[156:159], v[76:79]
    ds_read_b64_tr_b16 a[228:229], v26 offset:8192
    v_lshl_add_u32 v3, v241, 3, v243
    v_mfma_f32_16x16x32_bf16 v[76:79], a[176:179], v[140:143], v[76:79]
    ds_read_b64_tr_b16 a[230:231], v26 offset:12288
    v_mul_u32_u24 v243, 1152, v7
    v_mfma_f32_16x16x32_bf16 v[76:79], a[172:175], v[180:183], v[76:79]
    ds_read_b64_tr_b16 a[232:233], v26 offset:16384
    v_add_u32 v4, v243, v3
    v_mfma_f32_16x16x32_bf16 v[76:79], a[168:171], v[196:199], v[76:79]
    ds_read_b64_tr_b16 a[234:235], v26 offset:20480
    v_lshl_add_u32 v6, v243, 1, v5
    v_mfma_f32_16x16x32_bf16 v[76:79], a[164:167], v[148:151], v[76:79]
    ds_read_b64_tr_b16 a[236:237], v26 offset:24576
    v_or_b32 v55, v3, v242
    v_mfma_f32_16x16x32_bf16 v[76:79], a[160:163], v[132:135], v[76:79]
    s_waitcnt lgkmcnt(13)
    ds_read_b64_tr_b16 a[238:239], v26 offset:28672
    v_or_b32 v58, v4, v242
    v_mfma_f32_16x16x32_bf16 v[80:83], a[208:211], v[128:131], 0
    s_waitcnt lgkmcnt(12)
    ds_read_b64_tr_b16 a[160:161], v23 offset:0
    v_or_b32 v59, v5, v242
    v_mfma_f32_16x16x32_bf16 v[80:83], a[212:215], v[144:147], v[80:83]
    s_waitcnt lgkmcnt(11)
    ds_read_b64_tr_b16 a[162:163], v23 offset:4096
    v_or_b32 v60, v6, v242
    v_mfma_f32_16x16x32_bf16 v[80:83], a[216:219], v[192:195], v[80:83]
    s_waitcnt lgkmcnt(10)
    ds_read_b64_tr_b16 a[164:165], v23 offset:8192
    s_waitcnt vmcnt(6)
    v_readfirstlane_b32 s36, v11
    v_mfma_f32_16x16x32_bf16 v[80:83], a[220:223], v[176:179], v[80:83]
    s_waitcnt lgkmcnt(9)
    ds_read_b64_tr_b16 a[166:167], v23 offset:12288
    v_lshrrev_b32 v243, 4, v1
    v_mfma_f32_16x16x32_bf16 v[80:83], a[224:227], v[136:139], v[80:83]
    ds_read_b64_tr_b16 a[168:169], v23 offset:16384
    v_lshlrev_b32 v243, 8, v243
    s_cmp_lg_u32 s36, s95
    s_cbranch_scc1 Lattn_xspin
Lattn_xgot:
    s_waitcnt lgkmcnt(9)
    v_mfma_f32_16x16x32_bf16 v[80:83], a[228:231], v[152:155], v[80:83]
    s_waitcnt lgkmcnt(7)
    ds_read_b64_tr_b16 a[170:171], v23 offset:20480
    v_and_b32 v241, 7, v1
    v_mfma_f32_16x16x32_bf16 v[80:83], a[232:235], v[200:203], v[80:83]
    s_waitcnt lgkmcnt(6)
    ds_read_b64_tr_b16 a[172:173], v23 offset:24576
    v_lshl_add_u32 v243, v241, 5, v243
    v_mfma_f32_16x16x32_bf16 v[80:83], a[236:239], v[184:187], v[80:83]
    s_add_u32 s37, s55, 0
    ds_read_b64_tr_b16 a[174:175], v23 offset:28672
    v_and_b32 v241, 8, v1
    v_mfma_f32_16x16x32_bf16 v[84:87], a[236:239], v[188:191], 0
    buffer_load_dwordx4 a[64:67], v252, s[28:31], s37 offen offset:0 sc1
    v_mfma_f32_16x16x32_bf16 v[84:87], a[232:235], v[204:207], v[84:87]
    ds_read_b64_tr_b16 a[176:177], v27 offset:0
    ds_read_b64_tr_b16 a[178:179], v27 offset:4096
    v_mfma_f32_16x16x32_bf16 v[84:87], a[228:231], v[156:159], v[84:87]
    buffer_load_dwordx4 a[68:71], v252, s[28:31], s37 offen offset:1024 sc1
    v_mfma_f32_16x16x32_bf16 v[84:87], a[224:227], v[140:143], v[84:87]
    ds_read_b64_tr_b16 a[180:181], v27 offset:8192
    ds_read_b64_tr_b16 a[182:183], v27 offset:12288
    v_mfma_f32_16x16x32_bf16 v[84:87], a[220:223], v[180:183], v[84:87]
    ds_read_b64_tr_b16 a[184:185], v27 offset:16384
    v_lshl_add_u32 v54, v241, 1, v243
    v_mfma_f32_16x16x32_bf16 v[84:87], a[216:219], v[196:199], v[84:87]
    s_lshr_b32 s41, s2, 3
    ds_read_b64_tr_b16 a[186:187], v27 offset:20480
    v_mfma_f32_16x16x32_bf16 v[84:87], a[212:215], v[148:151], v[84:87]
    buffer_load_dwordx4 a[72:75], v252, s[28:31], s37 offen offset:2048 sc1
    v_mfma_f32_16x16x32_bf16 v[84:87], a[208:211], v[132:135], v[84:87]
    s_waitcnt lgkmcnt(12)
    s_mov_b32 s14, 2359296
    ds_read_b64_tr_b16 a[188:189], v27 offset:24576
    ds_read_b64_tr_b16 a[190:191], v27 offset:28672
    s_barrier
    v_mfma_f32_16x16x32_bf16 v[88:91], a[160:163], v[128:131], 0
    s_waitcnt lgkmcnt(12)
    s_mov_b32 s15, 0x20000
    ds_read_b64_tr_b16 a[208:209], v12 offset:32768
    v_mfma_f32_16x16x32_bf16 v[88:91], a[164:167], v[144:147], v[88:91]
    s_waitcnt lgkmcnt(11)
    s_mov_b32 s18, 2359296
    ds_read_b64_tr_b16 a[210:211], v12 offset:36864
    v_mfma_f32_16x16x32_bf16 v[88:91], a[168:171], v[192:195], v[88:91]
    s_waitcnt lgkmcnt(10)
    buffer_load_dwordx4 a[76:79], v252, s[28:31], s37 offen offset:3072 sc1
    v_mfma_f32_16x16x32_bf16 v[88:91], a[172:175], v[176:179], v[88:91]
    s_waitcnt lgkmcnt(8)
    s_mov_b32 s19, 0x20000
    ds_read_b64_tr_b16 a[212:213], v12 offset:40960
    ds_read_b64_tr_b16 a[214:215], v12 offset:45056
    v_mfma_f32_16x16x32_bf16 v[88:91], a[176:179], v[136:139], v[88:91]
    s_waitcnt lgkmcnt(8)
    s_add_u32 s8, s50, 7864320
    s_addc_u32 s9, s51, 0
    ds_read_b64_tr_b16 a[216:217], v12 offset:49152
    v_mfma_f32_16x16x32_bf16 v[88:91], a[180:183], v[152:155], v[88:91]
    s_waitcnt lgkmcnt(7)
    s_add_u32 s37, s55, 4096
    ds_read_b64_tr_b16 a[218:219], v12 offset:53248
    v_mfma_f32_16x16x32_bf16 v[88:91], a[184:187], v[200:203], v[88:91]
    s_waitcnt lgkmcnt(6)
    s_add_u32 s49, s46, 256
    buffer_load_dwordx4 a[80:83], v252, s[28:31], s37 offen offset:0 sc1
    v_mfma_f32_16x16x32_bf16 v[88:91], a[188:191], v[184:187], v[88:91]
    s_add_u32 m0, s42, 0
    ds_read_b64_tr_b16 a[220:221], v12 offset:57344
    ds_read_b64_tr_b16 a[222:223], v12 offset:61440
    v_mfma_f32_16x16x32_bf16 v[92:95], a[188:191], v[188:191], 0
    buffer_load_dwordx4 v46, s[20:23], s49 offen lds
    v_mfma_f32_16x16x32_bf16 v[92:95], a[184:187], v[204:207], v[92:95]
    s_mov_b32 s10, 663552
    ds_read_b64_tr_b16 a[224:225], v16 offset:32768
    ds_read_b64_tr_b16 a[226:227], v16 offset:36864
    v_mfma_f32_16x16x32_bf16 v[92:95], a[180:183], v[156:159], v[92:95]
    buffer_load_dwordx4 v47, s[20:23], s49 offen offset:1024 lds
    v_mfma_f32_16x16x32_bf16 v[92:95], a[176:179], v[140:143], v[92:95]
    s_mov_b32 s11, 0x20000
    ds_read_b64_tr_b16 a[228:229], v16 offset:40960
    ds_read_b64_tr_b16 a[230:231], v16 offset:45056
    v_mfma_f32_16x16x32_bf16 v[92:95], a[172:175], v[180:183], v[92:95]
    buffer_load_dwordx4 a[84:87], v252, s[28:31], s37 offen offset:1024 sc1
    v_mfma_f32_16x16x32_bf16 v[92:95], a[168:171], v[196:199], v[92:95]
    s_lshl_b32 s39, s5, 13
    ds_read_b64_tr_b16 a[232:233], v16 offset:49152
    ds_read_b64_tr_b16 a[234:235], v16 offset:53248
    v_mfma_f32_16x16x32_bf16 v[92:95], a[164:167], v[148:151], v[92:95]
    s_add_u32 s39, s39, 8781824
    ds_read_b64_tr_b16 a[236:237], v16 offset:57344
    v_mfma_f32_16x16x32_bf16 v[92:95], a[160:163], v[132:135], v[92:95]
    s_waitcnt lgkmcnt(13)
    s_lshr_b32 s45, s4, 2
    ds_read_b64_tr_b16 a[238:239], v16 offset:61440
    v_mfma_f32_16x16x32_bf16 v[96:99], a[208:211], v[128:131], 0
    s_waitcnt lgkmcnt(12)
    buffer_load_dwordx4 v48, s[20:23], s49 offen offset:2048 lds
    v_mfma_f32_16x16x32_bf16 v[96:99], a[212:215], v[144:147], v[96:99]
    s_waitcnt lgkmcnt(10)
    s_lshl_b32 s45, s45, 11
    ds_read_b64_tr_b16 a[160:161], v13 offset:32768
    ds_read_b64_tr_b16 a[162:163], v13 offset:36864
    v_mfma_f32_16x16x32_bf16 v[96:99], a[216:219], v[192:195], v[96:99]
    s_waitcnt lgkmcnt(10)
    buffer_load_dwordx4 v49, s[20:23], s49 offen offset:3072 lds
    v_mfma_f32_16x16x32_bf16 v[96:99], a[220:223], v[176:179], v[96:99]
    s_waitcnt lgkmcnt(8)
    s_add_u32 s39, s39, s45
    ds_read_b64_tr_b16 a[164:165], v13 offset:40960
    ds_read_b64_tr_b16 a[166:167], v13 offset:45056
    v_mfma_f32_16x16x32_bf16 v[96:99], a[224:227], v[136:139], v[96:99]
    s_waitcnt lgkmcnt(8)
    buffer_load_dwordx4 a[88:91], v252, s[28:31], s37 offen offset:2048 sc1
    v_mfma_f32_16x16x32_bf16 v[96:99], a[228:231], v[152:155], v[96:99]
    s_waitcnt lgkmcnt(6)
    ds_read_b64_tr_b16 a[168:169], v13 offset:49152
    ds_read_b64_tr_b16 a[170:171], v13 offset:53248
    v_mfma_f32_16x16x32_bf16 v[96:99], a[232:235], v[200:203], v[96:99]
    s_waitcnt lgkmcnt(6)
    s_add_u32 s49, s46, 73984
    ds_read_b64_tr_b16 a[172:173], v13 offset:57344
    v_and_b32 v9, 15, v1
    v_mfma_f32_16x16x32_bf16 v[96:99], a[236:239], v[184:187], v[96:99]
    s_add_u32 m0, s42, 16384
    ds_read_b64_tr_b16 a[174:175], v13 offset:61440
    v_lshlrev_b32 v9, 7, v9
    v_mfma_f32_16x16x32_bf16 v[100:103], a[236:239], v[188:191], 0
    buffer_load_dwordx4 v46, s[20:23], s49 offen lds
    v_mfma_f32_16x16x32_bf16 v[100:103], a[232:235], v[204:207], v[100:103]
    ds_read_b64_tr_b16 a[176:177], v17 offset:32768
    ds_read_b64_tr_b16 a[178:179], v17 offset:36864
    v_mfma_f32_16x16x32_bf16 v[100:103], a[228:231], v[156:159], v[100:103]
    buffer_load_dwordx4 v47, s[20:23], s49 offen offset:1024 lds
    v_mfma_f32_16x16x32_bf16 v[100:103], a[224:227], v[140:143], v[100:103]
    ds_read_b64_tr_b16 a[180:181], v17 offset:40960
    ds_read_b64_tr_b16 a[182:183], v17 offset:45056
    v_mfma_f32_16x16x32_bf16 v[100:103], a[220:223], v[180:183], v[100:103]
    buffer_load_dwordx4 a[92:95], v252, s[28:31], s37 offen offset:3072 sc1
    v_mfma_f32_16x16x32_bf16 v[100:103], a[216:219], v[196:199], v[100:103]
    ds_read_b64_tr_b16 a[184:185], v17 offset:49152
    ds_read_b64_tr_b16 a[186:187], v17 offset:53248
    v_mfma_f32_16x16x32_bf16 v[100:103], a[212:215], v[148:151], v[100:103]
    ds_read_b64_tr_b16 a[188:189], v17 offset:57344
    v_mfma_f32_16x16x32_bf16 v[100:103], a[208:211], v[132:135], v[100:103]
    s_waitcnt lgkmcnt(13)
    ds_read_b64_tr_b16 a[190:191], v17 offset:61440
    v_mfma_f32_16x16x32_bf16 v[104:107], a[160:163], v[128:131], 0
    s_waitcnt lgkmcnt(12)
    buffer_load_dwordx4 v48, s[20:23], s49 offen offset:2048 lds
    v_mfma_f32_16x16x32_bf16 v[104:107], a[164:167], v[144:147], v[104:107]
    s_waitcnt lgkmcnt(10)
    ds_read_b64_tr_b16 a[208:209], v14 offset:32768
    ds_read_b64_tr_b16 a[210:211], v14 offset:36864
    v_mfma_f32_16x16x32_bf16 v[104:107], a[168:171], v[192:195], v[104:107]
    s_waitcnt lgkmcnt(10)
    buffer_load_dwordx4 v49, s[20:23], s49 offen offset:3072 lds
    v_mfma_f32_16x16x32_bf16 v[104:107], a[172:175], v[176:179], v[104:107]
    s_waitcnt lgkmcnt(8)
    s_add_u32 s37, s55, 8192
    ds_read_b64_tr_b16 a[212:213], v14 offset:40960
    ds_read_b64_tr_b16 a[214:215], v14 offset:45056
    v_mfma_f32_16x16x32_bf16 v[104:107], a[176:179], v[136:139], v[104:107]
    s_waitcnt lgkmcnt(8)
    buffer_load_dwordx4 a[96:99], v252, s[28:31], s37 offen offset:0 sc1
    v_mfma_f32_16x16x32_bf16 v[104:107], a[180:183], v[152:155], v[104:107]
    s_waitcnt lgkmcnt(6)
    ds_read_b64_tr_b16 a[216:217], v14 offset:49152
    ds_read_b64_tr_b16 a[218:219], v14 offset:53248
    v_mfma_f32_16x16x32_bf16 v[104:107], a[184:187], v[200:203], v[104:107]
    s_waitcnt lgkmcnt(6)
    buffer_load_dwordx4 a[100:103], v252, s[28:31], s37 offen offset:1024 sc1
    v_mfma_f32_16x16x32_bf16 v[104:107], a[188:191], v[184:187], v[104:107]
Ltour0_9:
    s_cbranch_execz Lmain0
    ds_read_b64_tr_b16 a[220:221], v14 offset:57344
    ds_read_b64_tr_b16 a[222:223], v14 offset:61440
    v_mfma_f32_16x16x32_bf16 v[108:111], a[188:191], v[188:191], 0
    ds_read_b64_tr_b16 a[224:225], v18 offset:32768
    v_mfma_f32_16x16x32_bf16 v[108:111], a[184:187], v[204:207], v[108:111]
    ds_read_b64_tr_b16 a[226:227], v18 offset:36864
    v_mfma_f32_16x16x32_bf16 v[108:111], a[180:183], v[156:159], v[108:111]
    buffer_load_dwordx4 a[104:107], v252, s[28:31], s37 offen offset:2048 sc1
    v_mfma_f32_16x16x32_bf16 v[108:111], a[176:179], v[140:143], v[108:111]
    ds_read_b64_tr_b16 a[228:229], v18 offset:40960
    ds_read_b64_tr_b16 a[230:231], v18 offset:45056
    v_mfma_f32_16x16x32_bf16 v[108:111], a[172:175], v[180:183], v[108:111]
    ds_read_b64_tr_b16 a[232:233], v18 offset:49152
    v_mfma_f32_16x16x32_bf16 v[108:111], a[168:171], v[196:199], v[108:111]
    ds_read_b64_tr_b16 a[234:235], v18 offset:53248
    v_mfma_f32_16x16x32_bf16 v[108:111], a[164:167], v[148:151], v[108:111]
    buffer_load_dwordx4 a[108:111], v252, s[28:31], s37 offen offset:3072 sc1
    v_mfma_f32_16x16x32_bf16 v[108:111], a[160:163], v[132:135], v[108:111]
    s_waitcnt lgkmcnt(12)
    ds_read_b64_tr_b16 a[236:237], v18 offset:57344
    ds_read_b64_tr_b16 a[238:239], v18 offset:61440
    v_mfma_f32_16x16x32_bf16 v[112:115], a[208:211], v[128:131], 0
    s_waitcnt lgkmcnt(12)
    ds_read_b64_tr_b16 a[160:161], v15 offset:32768
    v_mfma_f32_16x16x32_bf16 v[112:115], a[212:215], v[144:147], v[112:115]
    s_waitcnt lgkmcnt(11)
    s_add_u32 s37, s55, 12288
    ds_read_b64_tr_b16 a[162:163], v15 offset:36864
    v_mfma_f32_16x16x32_bf16 v[112:115], a[216:219], v[192:195], v[112:115]
    s_waitcnt lgkmcnt(10)
    buffer_load_dwordx4 a[112:115], v252, s[28:31], s37 offen offset:0 sc1
    v_mfma_f32_16x16x32_bf16 v[112:115], a[220:223], v[176:179], v[112:115]
    s_waitcnt lgkmcnt(8)
    ds_read_b64_tr_b16 a[164:165], v15 offset:40960
    ds_read_b64_tr_b16 a[166:167], v15 offset:45056
    v_mfma_f32_16x16x32_bf16 v[112:115], a[224:227], v[136:139], v[112:115]
    s_waitcnt lgkmcnt(8)
    buffer_load_dwordx4 a[116:119], v252, s[28:31], s37 offen offset:1024 sc1
    v_mfma_f32_16x16x32_bf16 v[112:115], a[228:231], v[152:155], v[112:115]
    s_waitcnt lgkmcnt(6)
    ds_read_b64_tr_b16 a[168:169], v15 offset:49152
    ds_read_b64_tr_b16 a[170:171], v15 offset:53248
    v_mfma_f32_16x16x32_bf16 v[112:115], a[232:235], v[200:203], v[112:115]
    s_waitcnt lgkmcnt(6)
    ds_read_b64_tr_b16 a[172:173], v15 offset:57344
    v_mfma_f32_16x16x32_bf16 v[112:115], a[236:239], v[184:187], v[112:115]
    ds_read_b64_tr_b16 a[174:175], v15 offset:61440
    v_mfma_f32_16x16x32_bf16 v[116:119], a[236:239], v[188:191], 0
    buffer_load_dwordx4 a[120:123], v252, s[28:31], s37 offen offset:2048 sc1
    v_mfma_f32_16x16x32_bf16 v[116:119], a[232:235], v[204:207], v[116:119]
    ds_read_b64_tr_b16 a[176:177], v19 offset:32768
    ds_read_b64_tr_b16 a[178:179], v19 offset:36864
    v_mfma_f32_16x16x32_bf16 v[116:119], a[228:231], v[156:159], v[116:119]
    ds_read_b64_tr_b16 a[180:181], v19 offset:40960
    v_mfma_f32_16x16x32_bf16 v[116:119], a[224:227], v[140:143], v[116:119]
    ds_read_b64_tr_b16 a[182:183], v19 offset:45056
    v_mfma_f32_16x16x32_bf16 v[116:119], a[220:223], v[180:183], v[116:119]
    buffer_load_dwordx4 a[124:127], v252, s[28:31], s37 offen offset:3072 sc1
    v_mfma_f32_16x16x32_bf16 v[116:119], a[216:219], v[196:199], v[116:119]
    ds_read_b64_tr_b16 a[184:185], v19 offset:49152
    ds_read_b64_tr_b16 a[186:187], v19 offset:53248
    v_mfma_f32_16x16x32_bf16 v[116:119], a[212:215], v[148:151], v[116:119]
    ds_read_b64_tr_b16 a[188:189], v19 offset:57344
    v_mfma_f32_16x16x32_bf16 v[116:119], a[208:211], v[132:135], v[116:119]
    ds_read_b64_tr_b16 a[190:191], v19 offset:61440
    s_waitcnt vmcnt(25)
    s_waitcnt lgkmcnt(0)
    s_barrier
    v_mfma_f32_16x16x32_bf16 v[120:123], a[160:163], v[128:131], 0
    ds_read_b64_tr_b16 a[208:209], v20 offset:32768
    v_mfma_f32_16x16x32_bf16 v[120:123], a[164:167], v[144:147], v[120:123]
    ds_read_b64_tr_b16 a[210:211], v20 offset:36864
    v_mfma_f32_16x16x32_bf16 v[120:123], a[168:171], v[192:195], v[120:123]
    ds_read_b64_tr_b16 a[212:213], v20 offset:40960
    v_mfma_f32_16x16x32_bf16 v[120:123], a[172:175], v[176:179], v[120:123]
    ds_read_b64_tr_b16 a[214:215], v20 offset:45056
    v_mfma_f32_16x16x32_bf16 v[120:123], a[176:179], v[136:139], v[120:123]
    ds_read_b64_tr_b16 a[216:217], v20 offset:49152
    v_mfma_f32_16x16x32_bf16 v[120:123], a[180:183], v[152:155], v[120:123]
    ds_read_b64_tr_b16 a[218:219], v20 offset:53248
    v_mfma_f32_16x16x32_bf16 v[120:123], a[184:187], v[200:203], v[120:123]
    s_add_u32 s49, s7, 512
    ds_read_b64_tr_b16 a[220:221], v20 offset:57344
    v_mfma_f32_16x16x32_bf16 v[120:123], a[188:191], v[184:187], v[120:123]
    s_add_u32 m0, s42, 65536
    ds_read_b64_tr_b16 a[222:223], v20 offset:61440
    v_mfma_f32_16x16x32_bf16 v[124:127], a[188:191], v[188:191], 0
    buffer_load_dwordx4 v46, s[20:23], s49 offen lds
    v_mfma_f32_16x16x32_bf16 v[124:127], a[184:187], v[204:207], v[124:127]
    ds_read_b64_tr_b16 a[224:225], v24 offset:32768
    ds_read_b64_tr_b16 a[226:227], v24 offset:36864
    v_mfma_f32_16x16x32_bf16 v[124:127], a[180:183], v[156:159], v[124:127]
    buffer_load_dwordx4 v47, s[20:23], s49 offen offset:1024 lds
    v_mfma_f32_16x16x32_bf16 v[124:127], a[176:179], v[140:143], v[124:127]
    ds_read_b64_tr_b16 a[228:229], v24 offset:40960
    ds_read_b64_tr_b16 a[230:231], v24 offset:45056
    v_mfma_f32_16x16x32_bf16 v[124:127], a[172:175], v[180:183], v[124:127]
    ds_read_b64_tr_b16 a[232:233], v24 offset:49152
    v_mfma_f32_16x16x32_bf16 v[124:127], a[168:171], v[196:199], v[124:127]
    ds_read_b64_tr_b16 a[234:235], v24 offset:53248
    v_mfma_f32_16x16x32_bf16 v[124:127], a[164:167], v[148:151], v[124:127]
    ds_read_b64_tr_b16 a[236:237], v24 offset:57344
    v_lshrrev_b32 v240, 4, v1
    v_mfma_f32_16x16x32_bf16 v[124:127], a[160:163], v[132:135], v[124:127]
    s_waitcnt vmcnt(25)
    s_waitcnt lgkmcnt(13)
    ds_read_b64_tr_b16 a[238:239], v24 offset:61440
    v_and_b32 v240, 2, v240
    v_mfma_f32_16x16x32_bf16 v[64:67], a[208:211], a[64:67], v[64:67]
    s_waitcnt vmcnt(24)
    s_waitcnt lgkmcnt(12)
    buffer_load_dwordx4 v48, s[20:23], s49 offen offset:2048 lds
    v_mfma_f32_16x16x32_bf16 v[64:67], a[212:215], a[68:71], v[64:67]
    s_waitcnt vmcnt(24)
    s_waitcnt lgkmcnt(10)
    ds_read_b64_tr_b16 a[160:161], v21 offset:32768
    ds_read_b64_tr_b16 a[162:163], v21 offset:36864
    v_mfma_f32_16x16x32_bf16 v[64:67], a[216:219], a[72:75], v[64:67]
    s_waitcnt vmcnt(23)
    s_waitcnt lgkmcnt(10)
    buffer_load_dwordx4 v49, s[20:23], s49 offen offset:3072 lds
    v_mfma_f32_16x16x32_bf16 v[64:67], a[220:223], a[76:79], v[64:67]
    s_waitcnt vmcnt(23)
    s_waitcnt lgkmcnt(8)
    ds_read_b64_tr_b16 a[164:165], v21 offset:40960
    ds_read_b64_tr_b16 a[166:167], v21 offset:45056
    v_mfma_f32_16x16x32_bf16 v[64:67], a[224:227], a[80:83], v[64:67]
    s_waitcnt vmcnt(20)
    s_waitcnt lgkmcnt(8)
    ds_read_b64_tr_b16 a[168:169], v21 offset:49152
    v_bfe_u32 v241, v1, 2, 2
    v_mfma_f32_16x16x32_bf16 v[64:67], a[228:231], a[84:87], v[64:67]
    s_waitcnt vmcnt(17)
    s_waitcnt lgkmcnt(7)
    ds_read_b64_tr_b16 a[170:171], v21 offset:53248
    v_cmp_eq_u32 s[54:55], v240, v241
    v_mfma_f32_16x16x32_bf16 v[64:67], a[232:235], a[88:91], v[64:67]
    s_waitcnt vmcnt(14)
    s_waitcnt lgkmcnt(6)
    s_add_u32 s49, s7, 74240
    ds_read_b64_tr_b16 a[172:173], v21 offset:57344
    v_or_b32 v240, 1, v240
    v_mfma_f32_16x16x32_bf16 v[64:67], a[236:239], a[92:95], v[64:67]
    s_waitcnt vmcnt(4)
    s_add_u32 m0, s42, 81920
    ds_read_b64_tr_b16 a[174:175], v21 offset:61440
    v_cmp_eq_u32 s[36:37], v240, v241
    v_mfma_f32_16x16x32_bf16 v[68:71], a[236:239], a[124:127], v[68:71]
    buffer_load_dwordx4 v46, s[20:23], s49 offen lds
    v_mfma_f32_16x16x32_bf16 v[68:71], a[232:235], a[120:123], v[68:71]
    ds_read_b64_tr_b16 a[176:177], v25 offset:32768
    ds_read_b64_tr_b16 a[178:179], v25 offset:36864
    v_mfma_f32_16x16x32_bf16 v[68:71], a[228:231], a[116:119], v[68:71]
    buffer_load_dwordx4 v47, s[20:23], s49 offen offset:1024 lds
    v_mfma_f32_16x16x32_bf16 v[68:71], a[224:227], a[112:115], v[68:71]
    ds_read_b64_tr_b16 a[180:181], v25 offset:40960
    ds_read_b64_tr_b16 a[182:183], v25 offset:45056
    v_mfma_f32_16x16x32_bf16 v[68:71], a[220:223], a[108:111], v[68:71]
    ds_read_b64_tr_b16 a[184:185], v25 offset:49152
    v_cvt_pk_bf16_f32 v224, v64, v65
    v_mfma_f32_16x16x32_bf16 v[68:71], a[216:219], a[104:107], v[68:71]
    ds_read_b64_tr_b16 a[186:187], v25 offset:53248
    v_cvt_pk_bf16_f32 v225, v66, v67
    v_mfma_f32_16x16x32_bf16 v[68:71], a[212:215], a[100:103], v[68:71]
    buffer_load_dwordx2 v[36:37], v4, s[12:15], 0 offen offset:0
    v_mfma_f32_16x16x32_bf16 v[68:71], a[208:211], a[96:99], v[68:71]
    s_waitcnt lgkmcnt(12)
    ds_read_b64_tr_b16 a[188:189], v25 offset:57344
    ds_read_b64_tr_b16 a[190:191], v25 offset:61440
    v_mfma_f32_16x16x32_bf16 v[72:75], a[160:163], a[64:67], v[72:75]
    s_waitcnt lgkmcnt(12)
    buffer_load_dwordx4 v48, s[20:23], s49 offen offset:2048 lds
    v_mfma_f32_16x16x32_bf16 v[72:75], a[164:167], a[68:71], v[72:75]
    s_waitcnt lgkmcnt(10)
    ds_read_b64_tr_b16 a[208:209], v22 offset:32768
    ds_read_b64_tr_b16 a[210:211], v22 offset:36864
    v_mfma_f32_16x16x32_bf16 v[72:75], a[168:171], a[72:75], v[72:75]
    s_waitcnt lgkmcnt(10)
    buffer_load_dwordx4 v49, s[20:23], s49 offen offset:3072 lds
    v_mfma_f32_16x16x32_bf16 v[72:75], a[172:175], a[76:79], v[72:75]
    s_waitcnt lgkmcnt(8)
    ds_read_b64_tr_b16 a[212:213], v22 offset:40960
    ds_read_b64_tr_b16 a[214:215], v22 offset:45056
    v_mfma_f32_16x16x32_bf16 v[72:75], a[176:179], a[80:83], v[72:75]
    s_waitcnt lgkmcnt(8)
    ds_read_b64_tr_b16 a[216:217], v22 offset:49152
    v_cvt_pk_bf16_f32 v228, v68, v69
    v_mfma_f32_16x16x32_bf16 v[72:75], a[180:183], a[84:87], v[72:75]
    s_waitcnt lgkmcnt(7)
    ds_read_b64_tr_b16 a[218:219], v22 offset:53248
    v_cvt_pk_bf16_f32 v229, v70, v71
    v_mfma_f32_16x16x32_bf16 v[72:75], a[184:187], a[88:91], v[72:75]
    s_waitcnt lgkmcnt(6)
    ds_read_b64_tr_b16 a[220:221], v22 offset:57344
    v_and_b32 v240, 1, v1
    v_mfma_f32_16x16x32_bf16 v[72:75], a[188:191], a[92:95], v[72:75]
    ds_read_b64_tr_b16 a[222:223], v22 offset:61440
    v_lshlrev_b32 v240, 4, v240
    v_mfma_f32_16x16x32_bf16 v[76:79], a[188:191], a[124:127], v[76:79]
    buffer_load_dwordx2 v[38:39], v4, s[12:15], 0 offen offset:32
    v_mfma_f32_16x16x32_bf16 v[76:79], a[184:187], a[120:123], v[76:79]
    ds_read_b64_tr_b16 a[224:225], v26 offset:32768
    ds_read_b64_tr_b16 a[226:227], v26 offset:36864
    v_mfma_f32_16x16x32_bf16 v[76:79], a[180:183], a[116:119], v[76:79]
    ds_read_b64_tr_b16 a[228:229], v26 offset:40960
    v_mov_b32 v241, 0x3f80
    v_mfma_f32_16x16x32_bf16 v[76:79], a[176:179], a[112:115], v[76:79]
    ds_read_b64_tr_b16 a[230:231], v26 offset:45056
    v_lshlrev_b32 v240, v240, v241
    v_mfma_f32_16x16x32_bf16 v[76:79], a[172:175], a[108:111], v[76:79]
    ds_read_b64_tr_b16 a[232:233], v26 offset:49152
    v_cvt_pk_bf16_f32 v226, v72, v73
    v_mfma_f32_16x16x32_bf16 v[76:79], a[168:171], a[104:107], v[76:79]
    s_add_u32 s38, s93, 0
    ds_read_b64_tr_b16 a[234:235], v26 offset:53248
    v_cvt_pk_bf16_f32 v227, v74, v75
    v_mfma_f32_16x16x32_bf16 v[76:79], a[164:167], a[100:103], v[76:79]
    buffer_store_dwordx4 v[224:227], v56, s[28:31], s38 offen sc1
    v_mfma_f32_16x16x32_bf16 v[76:79], a[160:163], a[96:99], v[76:79]
    s_waitcnt lgkmcnt(12)
    ds_read_b64_tr_b16 a[236:237], v26 offset:57344
    ds_read_b64_tr_b16 a[238:239], v26 offset:61440
    v_mfma_f32_16x16x32_bf16 v[80:83], a[208:211], a[64:67], v[80:83]
    s_waitcnt lgkmcnt(12)
    ds_read_b64_tr_b16 a[160:161], v23 offset:32768
    v_bfe_i32 v241, v1, 1, 1
    v_mfma_f32_16x16x32_bf16 v[80:83], a[212:215], a[68:71], v[80:83]
    s_waitcnt lgkmcnt(11)
    ds_read_b64_tr_b16 a[162:163], v23 offset:36864
    v_and_b32 v243, v240, v241
    v_mfma_f32_16x16x32_bf16 v[80:83], a[216:219], a[72:75], v[80:83]
    s_waitcnt lgkmcnt(10)
    buffer_load_dwordx2 v[40:41], v4, s[12:15], 0 offen offset:512
    v_mfma_f32_16x16x32_bf16 v[80:83], a[220:223], a[76:79], v[80:83]
    s_waitcnt lgkmcnt(8)
    ds_read_b64_tr_b16 a[164:165], v23 offset:40960
    ds_read_b64_tr_b16 a[166:167], v23 offset:45056
    v_mfma_f32_16x16x32_bf16 v[80:83], a[224:227], a[80:83], v[80:83]
    s_waitcnt lgkmcnt(8)
    ds_read_b64_tr_b16 a[168:169], v23 offset:49152
    v_cvt_pk_bf16_f32 v230, v76, v77
    v_mfma_f32_16x16x32_bf16 v[80:83], a[228:231], a[84:87], v[80:83]
    s_waitcnt lgkmcnt(7)
    s_add_u32 s38, s93, 163840
    ds_read_b64_tr_b16 a[170:171], v23 offset:53248
    v_cvt_pk_bf16_f32 v231, v78, v79
    v_mfma_f32_16x16x32_bf16 v[80:83], a[232:235], a[88:91], v[80:83]
    s_waitcnt lgkmcnt(6)
    buffer_store_dwordx4 v[228:231], v56, s[28:31], s38 offen sc1
    v_mfma_f32_16x16x32_bf16 v[80:83], a[236:239], a[92:95], v[80:83]
    ds_read_b64_tr_b16 a[172:173], v23 offset:57344
    ds_read_b64_tr_b16 a[174:175], v23 offset:61440
    v_mfma_f32_16x16x32_bf16 v[84:87], a[236:239], a[124:127], v[84:87]
    ds_read_b64_tr_b16 a[176:177], v27 offset:32768
    v_xor_b32 v242, v240, v243
    v_mfma_f32_16x16x32_bf16 v[84:87], a[232:235], a[120:123], v[84:87]
    ds_read_b64_tr_b16 a[178:179], v27 offset:36864
    v_cndmask_b32 v246, 0, v242, s[54:55]
    v_mfma_f32_16x16x32_bf16 v[84:87], a[228:231], a[116:119], v[84:87]
    ds_read_b64_tr_b16 a[180:181], v27 offset:40960
    v_cndmask_b32 v247, 0, v243, s[54:55]
    v_mfma_f32_16x16x32_bf16 v[84:87], a[224:227], a[112:115], v[84:87]
    ds_read_b64_tr_b16 a[182:183], v27 offset:45056
    v_cndmask_b32 v250, 0, v242, s[36:37]
    v_mfma_f32_16x16x32_bf16 v[84:87], a[220:223], a[108:111], v[84:87]
    ds_read_b64_tr_b16 a[184:185], v27 offset:49152
    v_cvt_pk_bf16_f32 v232, v80, v81
    v_mfma_f32_16x16x32_bf16 v[84:87], a[216:219], a[104:107], v[84:87]
    ds_read_b64_tr_b16 a[186:187], v27 offset:53248
    v_cvt_pk_bf16_f32 v233, v82, v83
    v_mfma_f32_16x16x32_bf16 v[84:87], a[212:215], a[100:103], v[84:87]
    buffer_load_dwordx2 v[42:43], v4, s[12:15], 0 offen offset:544
    v_mfma_f32_16x16x32_bf16 v[84:87], a[208:211], a[96:99], v[84:87]
    s_waitcnt lgkmcnt(12)
    ds_read_b64_tr_b16 a[188:189], v27 offset:57344
    ds_read_b64_tr_b16 a[190:191], v27 offset:61440
    s_barrier
    v_mfma_f32_16x16x32_bf16 v[88:91], a[160:163], a[64:67], v[88:91]
    s_waitcnt lgkmcnt(12)
    ds_read_b64_tr_b16 a[208:209], v12 offset:0
    v_cndmask_b32 v251, 0, v243, s[36:37]
    v_mfma_f32_16x16x32_bf16 v[88:91], a[164:167], a[68:71], v[88:91]
    s_waitcnt lgkmcnt(11)
    ds_read_b64_tr_b16 a[210:211], v12 offset:4096
    v_mov_b32 v240, 0
    v_mfma_f32_16x16x32_bf16 v[88:91], a[168:171], a[72:75], v[88:91]
    s_waitcnt lgkmcnt(10)
    ds_read_b64_tr_b16 a[212:213], v12 offset:8192
    v_mov_b32 v241, 0
    v_mfma_f32_16x16x32_bf16 v[88:91], a[172:175], a[76:79], v[88:91]
    s_waitcnt lgkmcnt(9)
    ds_read_b64_tr_b16 a[214:215], v12 offset:12288
    v_mov_b32 v244, 0
    v_mfma_f32_16x16x32_bf16 v[88:91], a[176:179], a[80:83], v[88:91]
    s_waitcnt lgkmcnt(8)
    ds_read_b64_tr_b16 a[216:217], v12 offset:16384
    v_cvt_pk_bf16_f32 v236, v84, v85
    v_mfma_f32_16x16x32_bf16 v[88:91], a[180:183], a[84:87], v[88:91]
    s_waitcnt lgkmcnt(7)
    ds_read_b64_tr_b16 a[218:219], v12 offset:20480
    v_cvt_pk_bf16_f32 v237, v86, v87
    v_mfma_f32_16x16x32_bf16 v[88:91], a[184:187], a[88:91], v[88:91]
    s_waitcnt lgkmcnt(6)
    s_add_u32 s49, s46, 512
    ds_read_b64_tr_b16 a[220:221], v12 offset:24576
    v_mov_b32 v245, 0
    v_mfma_f32_16x16x32_bf16 v[88:91], a[188:191], a[92:95], v[88:91]
    s_add_u32 m0, s42, 32768
    ds_read_b64_tr_b16 a[222:223], v12 offset:28672
    v_mov_b32 v248, 0
    v_mfma_f32_16x16x32_bf16 v[92:95], a[188:191], a[124:127], v[92:95]
    buffer_load_dwordx4 v46, s[20:23], s49 offen lds
    v_mfma_f32_16x16x32_bf16 v[92:95], a[184:187], a[120:123], v[92:95]
    ds_read_b64_tr_b16 a[224:225], v16 offset:0
    ds_read_b64_tr_b16 a[226:227], v16 offset:4096
    v_mfma_f32_16x16x32_bf16 v[92:95], a[180:183], a[116:119], v[92:95]
    buffer_load_dwordx4 v47, s[20:23], s49 offen offset:1024 lds
    v_mfma_f32_16x16x32_bf16 v[92:95], a[176:179], a[112:115], v[92:95]
    ds_read_b64_tr_b16 a[228:229], v16 offset:8192
    ds_read_b64_tr_b16 a[230:231], v16 offset:12288
    v_mfma_f32_16x16x32_bf16 v[92:95], a[172:175], a[108:111], v[92:95]
    ds_read_b64_tr_b16 a[232:233], v16 offset:16384
    v_cvt_pk_bf16_f32 v234, v88, v89
    v_mfma_f32_16x16x32_bf16 v[92:95], a[168:171], a[104:107], v[92:95]
    s_add_u32 s38, s93, 128
    ds_read_b64_tr_b16 a[234:235], v16 offset:20480
    v_cvt_pk_bf16_f32 v235, v90, v91
    v_mfma_f32_16x16x32_bf16 v[92:95], a[164:167], a[100:103], v[92:95]
    buffer_store_dwordx4 v[232:235], v56, s[28:31], s38 offen sc1
    v_mfma_f32_16x16x32_bf16 v[92:95], a[160:163], a[96:99], v[92:95]
    s_waitcnt lgkmcnt(12)
    ds_read_b64_tr_b16 a[236:237], v16 offset:24576
    ds_read_b64_tr_b16 a[238:239], v16 offset:28672
    v_mfma_f32_16x16x32_bf16 v[96:99], a[208:211], a[64:67], v[96:99]
    s_waitcnt lgkmcnt(12)
    buffer_load_dwordx4 v48, s[20:23], s49 offen offset:2048 lds
    v_mfma_f32_16x16x32_bf16 v[96:99], a[212:215], a[68:71], v[96:99]
    s_waitcnt lgkmcnt(10)
    ds_read_b64_tr_b16 a[160:161], v13 offset:0
    ds_read_b64_tr_b16 a[162:163], v13 offset:4096
    v_mfma_f32_16x16x32_bf16 v[96:99], a[216:219], a[72:75], v[96:99]
    s_waitcnt lgkmcnt(10)
    buffer_load_dwordx4 v49, s[20:23], s49 offen offset:3072 lds
    v_mfma_f32_16x16x32_bf16 v[96:99], a[220:223], a[76:79], v[96:99]
    s_waitcnt lgkmcnt(8)
    ds_read_b64_tr_b16 a[164:165], v13 offset:8192
    ds_read_b64_tr_b16 a[166:167], v13 offset:12288
    v_mfma_f32_16x16x32_bf16 v[96:99], a[224:227], a[80:83], v[96:99]
    s_waitcnt lgkmcnt(8)
    ds_read_b64_tr_b16 a[168:169], v13 offset:16384
    v_cvt_pk_bf16_f32 v238, v92, v93
    v_mfma_f32_16x16x32_bf16 v[96:99], a[228:231], a[84:87], v[96:99]
    s_waitcnt lgkmcnt(7)
    s_add_u32 s38, s93, 163968
    ds_read_b64_tr_b16 a[170:171], v13 offset:20480
    v_cvt_pk_bf16_f32 v239, v94, v95
    v_mfma_f32_16x16x32_bf16 v[96:99], a[232:235], a[88:91], v[96:99]
    s_waitcnt lgkmcnt(6)
    s_add_u32 s49, s46, 74240
    buffer_store_dwordx4 v[236:239], v56, s[28:31], s38 offen sc1
    v_mfma_f32_16x16x32_bf16 v[96:99], a[236:239], a[92:95], v[96:99]
    s_add_u32 m0, s42, 49152
    ds_read_b64_tr_b16 a[172:173], v13 offset:24576
    ds_read_b64_tr_b16 a[174:175], v13 offset:28672
    v_mfma_f32_16x16x32_bf16 v[100:103], a[236:239], a[124:127], v[100:103]
    buffer_load_dwordx4 v46, s[20:23], s49 offen lds
    v_mfma_f32_16x16x32_bf16 v[100:103], a[232:235], a[120:123], v[100:103]
    ds_read_b64_tr_b16 a[176:177], v17 offset:0
    ds_read_b64_tr_b16 a[178:179], v17 offset:4096
    v_mfma_f32_16x16x32_bf16 v[100:103], a[228:231], a[116:119], v[100:103]
    buffer_load_dwordx4 v47, s[20:23], s49 offen offset:1024 lds
    v_mfma_f32_16x16x32_bf16 v[100:103], a[224:227], a[112:115], v[100:103]
    ds_read_b64_tr_b16 a[180:181], v17 offset:8192
    ds_read_b64_tr_b16 a[182:183], v17 offset:12288
    v_mfma_f32_16x16x32_bf16 v[100:103], a[220:223], a[108:111], v[100:103]
    ds_read_b64_tr_b16 a[184:185], v17 offset:16384
    v_cvt_pk_bf16_f32 v224, v96, v97
    v_mfma_f32_16x16x32_bf16 v[100:103], a[216:219], a[104:107], v[100:103]
    ds_read_b64_tr_b16 a[186:187], v17 offset:20480
    v_cvt_pk_bf16_f32 v225, v98, v99
    v_mfma_f32_16x16x32_bf16 v[100:103], a[212:215], a[100:103], v[100:103]
    ds_read_b64_tr_b16 a[188:189], v17 offset:24576
    v_mov_b32 v249, 0
    v_mfma_f32_16x16x32_bf16 v[100:103], a[208:211], a[96:99], v[100:103]
    s_waitcnt lgkmcnt(13)
    ds_read_b64_tr_b16 a[190:191], v17 offset:28672
    v_mov_b32 v252, 0
    v_mfma_f32_16x16x32_bf16 v[104:107], a[160:163], a[64:67], v[104:107]
    s_waitcnt lgkmcnt(12)
    buffer_load_dwordx4 v48, s[20:23], s49 offen offset:2048 lds
    v_mfma_f32_16x16x32_bf16 v[104:107], a[164:167], a[68:71], v[104:107]
    s_waitcnt lgkmcnt(10)
    ds_read_b64_tr_b16 a[208:209], v14 offset:0
    ds_read_b64_tr_b16 a[210:211], v14 offset:4096
    v_mfma_f32_16x16x32_bf16 v[104:107], a[168:171], a[72:75], v[104:107]
    s_waitcnt lgkmcnt(10)
    buffer_load_dwordx4 v49, s[20:23], s49 offen offset:3072 lds
    v_mfma_f32_16x16x32_bf16 v[104:107], a[172:175], a[76:79], v[104:107]
    s_waitcnt lgkmcnt(8)
    ds_read_b64_tr_b16 a[212:213], v14 offset:8192
    ds_read_b64_tr_b16 a[214:215], v14 offset:12288
    v_mfma_f32_16x16x32_bf16 v[104:107], a[176:179], a[80:83], v[104:107]
    s_waitcnt lgkmcnt(8)
    ds_read_b64_tr_b16 a[216:217], v14 offset:16384
    v_cvt_pk_bf16_f32 v228, v100, v101
    v_mfma_f32_16x16x32_bf16 v[104:107], a[180:183], a[84:87], v[104:107]
    s_waitcnt lgkmcnt(7)
    ds_read_b64_tr_b16 a[218:219], v14 offset:20480
    v_cvt_pk_bf16_f32 v229, v102, v103
    v_mfma_f32_16x16x32_bf16 v[104:107], a[184:187], a[88:91], v[104:107]
    s_waitcnt lgkmcnt(6)
    ds_read_b64_tr_b16 a[220:221], v14 offset:24576
    v_mov_b32 v253, 0
    v_mfma_f32_16x16x32_bf16 v[104:107], a[188:191], a[92:95], v[104:107]
    ds_read_b64_tr_b16 a[222:223], v14 offset:28672
    v_mfma_f32_16x16x32_bf16 v[108:111], a[188:191], a[124:127], v[108:111]
    ds_read_b64_tr_b16 a[224:225], v18 offset:0
    v_mfma_f32_16x16x32_bf16 v[108:111], a[184:187], a[120:123], v[108:111]
    ds_read_b64_tr_b16 a[226:227], v18 offset:4096
    v_mfma_f32_16x16x32_bf16 v[108:111], a[180:183], a[116:119], v[108:111]
    ds_read_b64_tr_b16 a[228:229], v18 offset:8192
    v_mfma_f32_16x16x32_bf16 v[108:111], a[176:179], a[112:115], v[108:111]
    ds_read_b64_tr_b16 a[230:231], v18 offset:12288
    v_mfma_f32_16x16x32_bf16 v[108:111], a[172:175], a[108:111], v[108:111]
    ds_read_b64_tr_b16 a[232:233], v18 offset:16384
    v_cvt_pk_bf16_f32 v226, v104, v105
    v_mfma_f32_16x16x32_bf16 v[108:111], a[168:171], a[104:107], v[108:111]
    s_add_u32 s38, s93, 512
    ds_read_b64_tr_b16 a[234:235], v18 offset:20480
    v_cvt_pk_bf16_f32 v227, v106, v107
    v_mfma_f32_16x16x32_bf16 v[108:111], a[164:167], a[100:103], v[108:111]
    buffer_store_dwordx4 v[224:227], v56, s[28:31], s38 offen sc1
    v_mfma_f32_16x16x32_bf16 v[108:111], a[160:163], a[96:99], v[108:111]
    s_waitcnt lgkmcnt(12)
    ds_read_b64_tr_b16 a[236:237], v18 offset:24576
    ds_read_b64_tr_b16 a[238:239], v18 offset:28672
    v_mfma_f32_16x16x32_bf16 v[112:115], a[208:211], a[64:67], v[112:115]
    s_waitcnt lgkmcnt(12)
    ds_read_b64_tr_b16 a[160:161], v15 offset:0
    v_mfma_f32_16x16x32_bf16 v[112:115], a[212:215], a[68:71], v[112:115]
    s_waitcnt lgkmcnt(11)
    ds_read_b64_tr_b16 a[162:163], v15 offset:4096
    v_mfma_f32_16x16x32_bf16 v[112:115], a[216:219], a[72:75], v[112:115]
    s_waitcnt lgkmcnt(10)
    ds_read_b64_tr_b16 a[164:165], v15 offset:8192
    v_mfma_f32_16x16x32_bf16 v[112:115], a[220:223], a[76:79], v[112:115]
    s_waitcnt lgkmcnt(9)
    ds_read_b64_tr_b16 a[166:167], v15 offset:12288
    v_mfma_f32_16x16x32_bf16 v[112:115], a[224:227], a[80:83], v[112:115]
    s_waitcnt lgkmcnt(8)
    ds_read_b64_tr_b16 a[168:169], v15 offset:16384
    v_cvt_pk_bf16_f32 v230, v108, v109
    v_mfma_f32_16x16x32_bf16 v[112:115], a[228:231], a[84:87], v[112:115]
    s_waitcnt lgkmcnt(7)
    s_add_u32 s38, s93, 164352
    ds_read_b64_tr_b16 a[170:171], v15 offset:20480
    v_cvt_pk_bf16_f32 v231, v110, v111
    v_mfma_f32_16x16x32_bf16 v[112:115], a[232:235], a[88:91], v[112:115]
    s_waitcnt lgkmcnt(6)
    buffer_store_dwordx4 v[228:231], v56, s[28:31], s38 offen sc1
    v_mfma_f32_16x16x32_bf16 v[112:115], a[236:239], a[92:95], v[112:115]
    ds_read_b64_tr_b16 a[172:173], v15 offset:24576
    ds_read_b64_tr_b16 a[174:175], v15 offset:28672
    v_mfma_f32_16x16x32_bf16 v[116:119], a[236:239], a[124:127], v[116:119]
    ds_read_b64_tr_b16 a[176:177], v19 offset:0
    v_mfma_f32_16x16x32_bf16 v[116:119], a[232:235], a[120:123], v[116:119]
    ds_read_b64_tr_b16 a[178:179], v19 offset:4096
    v_mfma_f32_16x16x32_bf16 v[116:119], a[228:231], a[116:119], v[116:119]
    ds_read_b64_tr_b16 a[180:181], v19 offset:8192
    v_mfma_f32_16x16x32_bf16 v[116:119], a[224:227], a[112:115], v[116:119]
    ds_read_b64_tr_b16 a[182:183], v19 offset:12288
    v_mfma_f32_16x16x32_bf16 v[116:119], a[220:223], a[108:111], v[116:119]
    ds_read_b64_tr_b16 a[184:185], v19 offset:16384
    v_cvt_pk_bf16_f32 v232, v112, v113
    v_mfma_f32_16x16x32_bf16 v[116:119], a[216:219], a[104:107], v[116:119]
    ds_read_b64_tr_b16 a[186:187], v19 offset:20480
    v_cvt_pk_bf16_f32 v233, v114, v115
    v_mfma_f32_16x16x32_bf16 v[116:119], a[212:215], a[100:103], v[116:119]
    ds_read_b64_tr_b16 a[188:189], v19 offset:24576
    v_mfma_f32_16x16x32_bf16 v[116:119], a[208:211], a[96:99], v[116:119]
    s_waitcnt lgkmcnt(13)
    ds_read_b64_tr_b16 a[190:191], v19 offset:28672
    s_waitcnt vmcnt(17)
    s_barrier
    v_mfma_f32_16x16x32_bf16 v[120:123], a[160:163], a[64:67], v[120:123]
    s_waitcnt lgkmcnt(12)
    ds_read_b64_tr_b16 a[208:209], v20 offset:0
    v_mfma_f32_16x16x32_bf16 v[120:123], a[164:167], a[68:71], v[120:123]
    s_waitcnt lgkmcnt(11)
    ds_read_b64_tr_b16 a[210:211], v20 offset:4096
    v_mfma_f32_16x16x32_bf16 v[120:123], a[168:171], a[72:75], v[120:123]
    s_waitcnt lgkmcnt(10)
    ds_read_b64_tr_b16 a[212:213], v20 offset:8192
    v_mfma_f32_16x16x32_bf16 v[120:123], a[172:175], a[76:79], v[120:123]
    s_waitcnt lgkmcnt(9)
    ds_read_b64_tr_b16 a[214:215], v20 offset:12288
    v_mfma_f32_16x16x32_bf16 v[120:123], a[176:179], a[80:83], v[120:123]
    s_waitcnt lgkmcnt(8)
    ds_read_b64_tr_b16 a[216:217], v20 offset:16384
    v_cvt_pk_bf16_f32 v236, v116, v117
    v_mfma_f32_16x16x32_bf16 v[120:123], a[180:183], a[84:87], v[120:123]
    s_waitcnt lgkmcnt(7)
    ds_read_b64_tr_b16 a[218:219], v20 offset:20480
    v_cvt_pk_bf16_f32 v237, v118, v119
    v_mfma_f32_16x16x32_bf16 v[120:123], a[184:187], a[88:91], v[120:123]
    s_waitcnt lgkmcnt(6)
    s_add_u32 s49, s7, 768
    ds_read_b64_tr_b16 a[220:221], v20 offset:24576
    v_mfma_f32_16x16x32_bf16 v[120:123], a[188:191], a[92:95], v[120:123]
    s_add_u32 m0, s42, 98304
    ds_read_b64_tr_b16 a[222:223], v20 offset:28672
    v_mfma_f32_16x16x32_bf16 v[124:127], a[188:191], a[124:127], v[124:127]
    buffer_load_dwordx4 v46, s[20:23], s49 offen lds
    v_mfma_f32_16x16x32_bf16 v[124:127], a[184:187], a[120:123], v[124:127]
    ds_read_b64_tr_b16 a[224:225], v24 offset:0
    ds_read_b64_tr_b16 a[226:227], v24 offset:4096
    v_mfma_f32_16x16x32_bf16 v[124:127], a[180:183], a[116:119], v[124:127]
    buffer_load_dwordx4 v47, s[20:23], s49 offen offset:1024 lds
    v_mfma_f32_16x16x32_bf16 v[124:127], a[176:179], a[112:115], v[124:127]
    ds_read_b64_tr_b16 a[228:229], v24 offset:8192
    ds_read_b64_tr_b16 a[230:231], v24 offset:12288
    v_mfma_f32_16x16x32_bf16 v[124:127], a[172:175], a[108:111], v[124:127]
    ds_read_b64_tr_b16 a[232:233], v24 offset:16384
    v_cvt_pk_bf16_f32 v234, v120, v121
    v_mfma_f32_16x16x32_bf16 v[124:127], a[168:171], a[104:107], v[124:127]
    s_add_u32 s38, s93, 640
    ds_read_b64_tr_b16 a[234:235], v24 offset:20480
    v_cvt_pk_bf16_f32 v235, v122, v123
    v_mfma_f32_16x16x32_bf16 v[124:127], a[164:167], a[100:103], v[124:127]
    buffer_store_dwordx4 v[232:235], v56, s[28:31], s38 offen sc1
    v_mfma_f32_16x16x32_bf16 v[124:127], a[160:163], a[96:99], v[124:127]
    s_waitcnt lgkmcnt(12)
    ds_read_b64_tr_b16 a[236:237], v24 offset:24576
    ds_read_b64_tr_b16 a[238:239], v24 offset:28672
    v_mfma_f32_16x16x32_bf16 v[64:67], a[208:211], v[128:131], 0
    s_waitcnt lgkmcnt(12)
    buffer_load_dwordx4 v48, s[20:23], s49 offen offset:2048 lds
    v_mfma_f32_16x16x32_bf16 v[64:67], a[212:215], v[144:147], v[64:67]
    s_waitcnt lgkmcnt(10)
    ds_read_b64_tr_b16 a[160:161], v21 offset:0
    ds_read_b64_tr_b16 a[162:163], v21 offset:4096
    v_mfma_f32_16x16x32_bf16 v[64:67], a[216:219], v[192:195], v[64:67]
    s_waitcnt lgkmcnt(10)
    buffer_load_dwordx4 v49, s[20:23], s49 offen offset:3072 lds
    v_mfma_f32_16x16x32_bf16 v[64:67], a[220:223], v[176:179], v[64:67]
    s_waitcnt lgkmcnt(8)
    ds_read_b64_tr_b16 a[164:165], v21 offset:8192
    ds_read_b64_tr_b16 a[166:167], v21 offset:12288
    v_mfma_f32_16x16x32_bf16 v[64:67], a[224:227], v[136:139], v[64:67]
    s_waitcnt lgkmcnt(8)
    ds_read_b64_tr_b16 a[168:169], v21 offset:16384
    v_cvt_pk_bf16_f32 v238, v124, v125
    v_mfma_f32_16x16x32_bf16 v[64:67], a[228:231], v[152:155], v[64:67]
    s_waitcnt lgkmcnt(7)
    s_add_u32 s38, s93, 164480
    ds_read_b64_tr_b16 a[170:171], v21 offset:20480
    v_cvt_pk_bf16_f32 v239, v126, v127
    v_mfma_f32_16x16x32_bf16 v[64:67], a[232:235], v[200:203], v[64:67]
    s_waitcnt lgkmcnt(6)
    s_add_u32 s49, s7, 74496
    buffer_store_dwordx4 v[236:239], v56, s[28:31], s38 offen sc1
    v_mfma_f32_16x16x32_bf16 v[64:67], a[236:239], v[184:187], v[64:67]
    s_add_u32 m0, s42, 114688
    ds_read_b64_tr_b16 a[172:173], v21 offset:24576
    ds_read_b64_tr_b16 a[174:175], v21 offset:28672
    v_mfma_f32_16x16x32_bf16 v[68:71], a[236:239], v[188:191], 0
Ltour0_10:
    s_cbranch_execz Lmain0
    buffer_load_dwordx4 v46, s[20:23], s49 offen lds
    v_mfma_f32_16x16x32_bf16 v[68:71], a[232:235], v[204:207], v[68:71]
    ds_read_b64_tr_b16 a[176:177], v25 offset:0
    ds_read_b64_tr_b16 a[178:179], v25 offset:4096
    v_mfma_f32_16x16x32_bf16 v[68:71], a[228:231], v[156:159], v[68:71]
    buffer_load_dwordx4 v47, s[20:23], s49 offen offset:1024 lds
    v_mfma_f32_16x16x32_bf16 v[68:71], a[224:227], v[140:143], v[68:71]
    ds_read_b64_tr_b16 a[180:181], v25 offset:8192
    ds_read_b64_tr_b16 a[182:183], v25 offset:12288
    v_mfma_f32_16x16x32_bf16 v[68:71], a[220:223], v[180:183], v[68:71]
    ds_read_b64_tr_b16 a[184:185], v25 offset:16384
    v_mfma_f32_16x16x32_bf16 v[68:71], a[216:219], v[196:199], v[68:71]
    ds_read_b64_tr_b16 a[186:187], v25 offset:20480
    v_mfma_f32_16x16x32_bf16 v[68:71], a[212:215], v[148:151], v[68:71]
    ds_read_b64_tr_b16 a[188:189], v25 offset:24576
    v_mfma_f32_16x16x32_bf16 v[68:71], a[208:211], v[132:135], v[68:71]
    s_waitcnt lgkmcnt(13)
    ds_read_b64_tr_b16 a[190:191], v25 offset:28672
    v_mfma_f32_16x16x32_bf16 v[72:75], a[160:163], v[128:131], 0
    s_waitcnt lgkmcnt(12)
    buffer_load_dwordx4 v48, s[20:23], s49 offen offset:2048 lds
    v_mfma_f32_16x16x32_bf16 v[72:75], a[164:167], v[144:147], v[72:75]
    s_waitcnt lgkmcnt(10)
    ds_read_b64_tr_b16 a[208:209], v22 offset:0
    ds_read_b64_tr_b16 a[210:211], v22 offset:4096
    v_mfma_f32_16x16x32_bf16 v[72:75], a[168:171], v[192:195], v[72:75]
    s_waitcnt lgkmcnt(10)
    buffer_load_dwordx4 v49, s[20:23], s49 offen offset:3072 lds
    v_mfma_f32_16x16x32_bf16 v[72:75], a[172:175], v[176:179], v[72:75]
    s_waitcnt lgkmcnt(8)
    ds_read_b64_tr_b16 a[212:213], v22 offset:8192
    ds_read_b64_tr_b16 a[214:215], v22 offset:12288
    v_mfma_f32_16x16x32_bf16 v[72:75], a[176:179], v[136:139], v[72:75]
    s_waitcnt lgkmcnt(8)
    ds_read_b64_tr_b16 a[216:217], v22 offset:16384
    v_mfma_f32_16x16x32_bf16 v[72:75], a[180:183], v[152:155], v[72:75]
    s_waitcnt lgkmcnt(7)
    ds_read_b64_tr_b16 a[218:219], v22 offset:20480
    v_mfma_f32_16x16x32_bf16 v[72:75], a[184:187], v[200:203], v[72:75]
    s_waitcnt lgkmcnt(6)
    ds_read_b64_tr_b16 a[220:221], v22 offset:24576
    v_mfma_f32_16x16x32_bf16 v[72:75], a[188:191], v[184:187], v[72:75]
    ds_read_b64_tr_b16 a[222:223], v22 offset:28672
    v_mfma_f32_16x16x32_bf16 v[76:79], a[188:191], v[188:191], 0
    ds_read_b64_tr_b16 a[224:225], v26 offset:0
    v_mfma_f32_16x16x32_bf16 v[76:79], a[184:187], v[204:207], v[76:79]
    ds_read_b64_tr_b16 a[226:227], v26 offset:4096
    v_mfma_f32_16x16x32_bf16 v[76:79], a[180:183], v[156:159], v[76:79]
    ds_read_b64_tr_b16 a[228:229], v26 offset:8192
    v_mfma_f32_16x16x32_bf16 v[76:79], a[176:179], v[140:143], v[76:79]
    ds_read_b64_tr_b16 a[230:231], v26 offset:12288
    v_mfma_f32_16x16x32_bf16 v[76:79], a[172:175], v[180:183], v[76:79]
    ds_read_b64_tr_b16 a[232:233], v26 offset:16384
    v_mfma_f32_16x16x32_bf16 v[76:79], a[168:171], v[196:199], v[76:79]
    ds_read_b64_tr_b16 a[234:235], v26 offset:20480
    v_mfma_f32_16x16x32_bf16 v[76:79], a[164:167], v[148:151], v[76:79]
    buffer_load_dword v63, v63, s[88:91], 0 offen sc1
    v_mfma_f32_16x16x32_bf16 v[76:79], a[160:163], v[132:135], v[76:79]
    s_waitcnt lgkmcnt(12)
    ds_read_b64_tr_b16 a[236:237], v26 offset:24576
    ds_read_b64_tr_b16 a[238:239], v26 offset:28672
    v_mfma_f32_16x16x32_bf16 v[80:83], a[208:211], v[128:131], 0
    s_waitcnt lgkmcnt(12)
    ds_read_b64_tr_b16 a[160:161], v23 offset:0
    v_mfma_f32_16x16x32_bf16 v[80:83], a[212:215], v[144:147], v[80:83]
    s_waitcnt lgkmcnt(11)
    ds_read_b64_tr_b16 a[162:163], v23 offset:4096
    v_mfma_f32_16x16x32_bf16 v[80:83], a[216:219], v[192:195], v[80:83]
    s_waitcnt lgkmcnt(10)
    ds_read_b64_tr_b16 a[164:165], v23 offset:8192
    v_mfma_f32_16x16x32_bf16 v[80:83], a[220:223], v[176:179], v[80:83]
    s_waitcnt lgkmcnt(9)
    ds_read_b64_tr_b16 a[166:167], v23 offset:12288
    v_mfma_f32_16x16x32_bf16 v[80:83], a[224:227], v[136:139], v[80:83]
    s_waitcnt lgkmcnt(8)
    ds_read_b64_tr_b16 a[168:169], v23 offset:16384
    v_mfma_f32_16x16x32_bf16 v[80:83], a[228:231], v[152:155], v[80:83]
    s_waitcnt lgkmcnt(7)
    ds_read_b64_tr_b16 a[170:171], v23 offset:20480
    v_mfma_f32_16x16x32_bf16 v[80:83], a[232:235], v[200:203], v[80:83]
    s_waitcnt lgkmcnt(6)
    ds_read_b64_tr_b16 a[172:173], v23 offset:24576
    v_mfma_f32_16x16x32_bf16 v[80:83], a[236:239], v[184:187], v[80:83]
    ds_read_b64_tr_b16 a[174:175], v23 offset:28672
    v_mfma_f32_16x16x32_bf16 v[84:87], a[236:239], v[188:191], 0
    ds_read_b64_tr_b16 a[176:177], v27 offset:0
    v_mfma_f32_16x16x32_bf16 v[84:87], a[232:235], v[204:207], v[84:87]
    ds_read_b64_tr_b16 a[178:179], v27 offset:4096
    v_mfma_f32_16x16x32_bf16 v[84:87], a[228:231], v[156:159], v[84:87]
    ds_read_b64_tr_b16 a[180:181], v27 offset:8192
    v_mfma_f32_16x16x32_bf16 v[84:87], a[224:227], v[140:143], v[84:87]
    ds_read_b64_tr_b16 a[182:183], v27 offset:12288
    v_mfma_f32_16x16x32_bf16 v[84:87], a[220:223], v[180:183], v[84:87]
    ds_read_b64_tr_b16 a[184:185], v27 offset:16384
    v_mfma_f32_16x16x32_bf16 v[84:87], a[216:219], v[196:199], v[84:87]
    ds_read_b64_tr_b16 a[186:187], v27 offset:20480
    v_mfma_f32_16x16x32_bf16 v[84:87], a[212:215], v[148:151], v[84:87]
    ds_read_b64_tr_b16 a[188:189], v27 offset:24576
    v_mfma_f32_16x16x32_bf16 v[84:87], a[208:211], v[132:135], v[84:87]
    s_waitcnt lgkmcnt(13)
    ds_read_b64_tr_b16 a[190:191], v27 offset:28672
    s_waitcnt vmcnt(13)
    s_barrier
    v_mfma_f32_16x16x32_bf16 v[88:91], a[160:163], v[128:131], 0
    s_waitcnt lgkmcnt(12)
    ds_read_b64_tr_b16 a[208:209], v12 offset:32768
    v_mfma_f32_16x16x32_bf16 v[88:91], a[164:167], v[144:147], v[88:91]
    s_waitcnt lgkmcnt(11)
    ds_read_b64_tr_b16 a[210:211], v12 offset:36864
    v_mfma_f32_16x16x32_bf16 v[88:91], a[168:171], v[192:195], v[88:91]
    s_waitcnt lgkmcnt(10)
    ds_read_b64_tr_b16 a[212:213], v12 offset:40960
    v_mfma_f32_16x16x32_bf16 v[88:91], a[172:175], v[176:179], v[88:91]
    s_waitcnt lgkmcnt(9)
    ds_read_b64_tr_b16 a[214:215], v12 offset:45056
    v_mfma_f32_16x16x32_bf16 v[88:91], a[176:179], v[136:139], v[88:91]
    s_waitcnt lgkmcnt(8)
    ds_read_b64_tr_b16 a[216:217], v12 offset:49152
    v_mfma_f32_16x16x32_bf16 v[88:91], a[180:183], v[152:155], v[88:91]
    s_waitcnt lgkmcnt(7)
    ds_read_b64_tr_b16 a[218:219], v12 offset:53248
    v_mfma_f32_16x16x32_bf16 v[88:91], a[184:187], v[200:203], v[88:91]
    s_waitcnt lgkmcnt(6)
    s_add_u32 s49, s46, 768
    ds_read_b64_tr_b16 a[220:221], v12 offset:57344
    v_mfma_f32_16x16x32_bf16 v[88:91], a[188:191], v[184:187], v[88:91]
    s_add_u32 m0, s42, 0
    ds_read_b64_tr_b16 a[222:223], v12 offset:61440
    v_mfma_f32_16x16x32_bf16 v[92:95], a[188:191], v[188:191], 0
    buffer_load_dwordx4 v46, s[20:23], s49 offen lds
    v_mfma_f32_16x16x32_bf16 v[92:95], a[184:187], v[204:207], v[92:95]
    ds_read_b64_tr_b16 a[224:225], v16 offset:32768
    ds_read_b64_tr_b16 a[226:227], v16 offset:36864
    v_mfma_f32_16x16x32_bf16 v[92:95], a[180:183], v[156:159], v[92:95]
    buffer_load_dwordx4 v47, s[20:23], s49 offen offset:1024 lds
    v_mfma_f32_16x16x32_bf16 v[92:95], a[176:179], v[140:143], v[92:95]
    ds_read_b64_tr_b16 a[228:229], v16 offset:40960
    ds_read_b64_tr_b16 a[230:231], v16 offset:45056
    v_mfma_f32_16x16x32_bf16 v[92:95], a[172:175], v[180:183], v[92:95]
    ds_read_b64_tr_b16 a[232:233], v16 offset:49152
    v_mfma_f32_16x16x32_bf16 v[92:95], a[168:171], v[196:199], v[92:95]
    ds_read_b64_tr_b16 a[234:235], v16 offset:53248
    v_mfma_f32_16x16x32_bf16 v[92:95], a[164:167], v[148:151], v[92:95]
    ds_read_b64_tr_b16 a[236:237], v16 offset:57344
    v_mfma_f32_16x16x32_bf16 v[92:95], a[160:163], v[132:135], v[92:95]
    s_waitcnt lgkmcnt(13)
    ds_read_b64_tr_b16 a[238:239], v16 offset:61440
    v_mfma_f32_16x16x32_bf16 v[64:67], a[208:211], a[64:67], v[64:67]
    s_waitcnt lgkmcnt(12)
    buffer_load_dwordx4 v48, s[20:23], s49 offen offset:2048 lds
    v_mfma_f32_16x16x32_bf16 v[64:67], a[212:215], a[68:71], v[64:67]
    s_waitcnt lgkmcnt(10)
    ds_read_b64_tr_b16 a[160:161], v13 offset:32768
    ds_read_b64_tr_b16 a[162:163], v13 offset:36864
    v_mfma_f32_16x16x32_bf16 v[64:67], a[216:219], a[72:75], v[64:67]
    s_waitcnt lgkmcnt(10)
    s_add_u32 s92, s92, 16
    buffer_load_dwordx4 v49, s[20:23], s49 offen offset:3072 lds
    v_mfma_f32_16x16x32_bf16 v[64:67], a[220:223], a[76:79], v[64:67]
    s_waitcnt lgkmcnt(8)
    s_waitcnt vmcnt(9)
    ds_read_b64_tr_b16 a[164:165], v13 offset:40960
    ds_read_b64_tr_b16 a[166:167], v13 offset:45056
    v_mfma_f32_16x16x32_bf16 v[64:67], a[224:227], a[80:83], v[64:67]
    s_waitcnt lgkmcnt(8)
    buffer_store_dword v10, v8, s[24:27], s92 offen sc1
    v_mfma_f32_16x16x32_bf16 v[64:67], a[228:231], a[84:87], v[64:67]
    s_waitcnt lgkmcnt(6)
    ds_read_b64_tr_b16 a[168:169], v13 offset:49152
    ds_read_b64_tr_b16 a[170:171], v13 offset:53248
    v_mfma_f32_16x16x32_bf16 v[64:67], a[232:235], a[88:91], v[64:67]
    s_waitcnt lgkmcnt(6)
    s_add_u32 s49, s46, 74496
    ds_read_b64_tr_b16 a[172:173], v13 offset:57344
    v_mfma_f32_16x16x32_bf16 v[64:67], a[236:239], a[92:95], v[64:67]
    s_add_u32 m0, s42, 16384
    ds_read_b64_tr_b16 a[174:175], v13 offset:61440
    v_mfma_f32_16x16x32_bf16 v[68:71], a[236:239], a[124:127], v[68:71]
    buffer_load_dwordx4 v46, s[20:23], s49 offen lds
    v_mfma_f32_16x16x32_bf16 v[68:71], a[232:235], a[120:123], v[68:71]
    ds_read_b64_tr_b16 a[176:177], v17 offset:32768
    ds_read_b64_tr_b16 a[178:179], v17 offset:36864
    v_mfma_f32_16x16x32_bf16 v[68:71], a[228:231], a[116:119], v[68:71]
    buffer_load_dwordx4 v47, s[20:23], s49 offen offset:1024 lds
    v_mfma_f32_16x16x32_bf16 v[68:71], a[224:227], a[112:115], v[68:71]
    ds_read_b64_tr_b16 a[180:181], v17 offset:40960
    ds_read_b64_tr_b16 a[182:183], v17 offset:45056
    v_mfma_f32_16x16x32_bf16 v[68:71], a[220:223], a[108:111], v[68:71]
    ds_read_b64_tr_b16 a[184:185], v17 offset:49152
    v_cvt_pk_bf16_f32 v224, v64, v65
    v_mfma_f32_16x16x32_bf16 v[68:71], a[216:219], a[104:107], v[68:71]
    ds_read_b64_tr_b16 a[186:187], v17 offset:53248
    v_cvt_pk_bf16_f32 v225, v66, v67
    v_mfma_f32_16x16x32_bf16 v[68:71], a[212:215], a[100:103], v[68:71]
    ds_read_b64_tr_b16 a[188:189], v17 offset:57344
    v_mfma_f32_16x16x32_bf16 v[68:71], a[208:211], a[96:99], v[68:71]
    s_waitcnt lgkmcnt(13)
    ds_read_b64_tr_b16 a[190:191], v17 offset:61440
    v_mfma_f32_16x16x32_bf16 v[72:75], a[160:163], a[64:67], v[72:75]
    s_waitcnt lgkmcnt(12)
    buffer_load_dwordx4 v48, s[20:23], s49 offen offset:2048 lds
    v_mfma_f32_16x16x32_bf16 v[72:75], a[164:167], a[68:71], v[72:75]
    s_waitcnt lgkmcnt(10)
    ds_read_b64_tr_b16 a[208:209], v14 offset:32768
    ds_read_b64_tr_b16 a[210:211], v14 offset:36864
    v_mfma_f32_16x16x32_bf16 v[72:75], a[168:171], a[72:75], v[72:75]
    s_waitcnt lgkmcnt(10)
    buffer_load_dwordx4 v49, s[20:23], s49 offen offset:3072 lds
    v_mfma_f32_16x16x32_bf16 v[72:75], a[172:175], a[76:79], v[72:75]
    s_waitcnt lgkmcnt(8)
    ds_read_b64_tr_b16 a[212:213], v14 offset:40960
    ds_read_b64_tr_b16 a[214:215], v14 offset:45056
    v_mfma_f32_16x16x32_bf16 v[72:75], a[176:179], a[80:83], v[72:75]
    s_waitcnt lgkmcnt(8)
    ds_read_b64_tr_b16 a[216:217], v14 offset:49152
    v_cvt_pk_bf16_f32 v228, v68, v69
    v_mfma_f32_16x16x32_bf16 v[72:75], a[180:183], a[84:87], v[72:75]
    s_waitcnt lgkmcnt(7)
    ds_read_b64_tr_b16 a[218:219], v14 offset:53248
    v_cvt_pk_bf16_f32 v229, v70, v71
    v_mfma_f32_16x16x32_bf16 v[72:75], a[184:187], a[88:91], v[72:75]
    s_waitcnt lgkmcnt(6)
    s_and_b32 s42, s2, 7
    ds_read_b64_tr_b16 a[220:221], v14 offset:57344
    v_mfma_f32_16x16x32_bf16 v[72:75], a[188:191], a[92:95], v[72:75]
    s_mov_b64 s[20:21], s[52:53]
    ds_read_b64_tr_b16 a[222:223], v14 offset:61440
    v_mfma_f32_16x16x32_bf16 v[76:79], a[188:191], a[124:127], v[76:79]
    ds_read_b64_tr_b16 a[224:225], v18 offset:32768
    s_waitcnt vmcnt(9)
    v_readfirstlane_b32 s37, v63
    v_mfma_f32_16x16x32_bf16 v[76:79], a[184:187], a[120:123], v[76:79]
    s_mov_b32 s22, 1152
    ds_read_b64_tr_b16 a[226:227], v18 offset:36864
    v_mfma_f32_16x16x32_bf16 v[76:79], a[180:183], a[116:119], v[76:79]
    s_mov_b32 s23, 0x20000
    ds_read_b64_tr_b16 a[228:229], v18 offset:40960
    s_cmp_lt_u32 s37, 256
    s_cbranch_scc1 Lattn_armwait
Lattn_armed:
    v_mfma_f32_16x16x32_bf16 v[76:79], a[176:179], a[112:115], v[76:79]
    ds_read_b64_tr_b16 a[230:231], v18 offset:45056
    v_mfma_f32_16x16x32_bf16 v[76:79], a[172:175], a[108:111], v[76:79]
    ds_read_b64_tr_b16 a[232:233], v18 offset:49152
    v_cvt_pk_bf16_f32 v226, v72, v73
    v_mfma_f32_16x16x32_bf16 v[76:79], a[168:171], a[104:107], v[76:79]
    s_add_u32 s38, s93, 1024
    ds_read_b64_tr_b16 a[234:235], v18 offset:53248
    v_cvt_pk_bf16_f32 v227, v74, v75
    v_mfma_f32_16x16x32_bf16 v[76:79], a[164:167], a[100:103], v[76:79]
    buffer_store_dwordx4 v[224:227], v56, s[28:31], s38 offen sc1
    v_mfma_f32_16x16x32_bf16 v[76:79], a[160:163], a[96:99], v[76:79]
    s_waitcnt lgkmcnt(12)
    s_mov_b32 s45, 18688
    ds_read_b64_tr_b16 a[236:237], v18 offset:57344
    ds_read_b64_tr_b16 a[238:239], v18 offset:61440
    v_mfma_f32_16x16x32_bf16 v[80:83], a[208:211], a[64:67], v[80:83]
    s_waitcnt lgkmcnt(12)
    buffer_load_dwordx4 v[160:163], v5, s[24:27], s45 offen offset:0 sc1
    v_mfma_f32_16x16x32_bf16 v[80:83], a[212:215], a[68:71], v[80:83]
    s_waitcnt lgkmcnt(10)
    ds_read_b64_tr_b16 a[160:161], v15 offset:32768
    ds_read_b64_tr_b16 a[162:163], v15 offset:36864
    v_mfma_f32_16x16x32_bf16 v[80:83], a[216:219], a[72:75], v[80:83]
    s_waitcnt lgkmcnt(10)
    buffer_load_dwordx4 v[164:167], v5, s[24:27], s45 offen offset:512 sc1
    v_mfma_f32_16x16x32_bf16 v[80:83], a[220:223], a[76:79], v[80:83]
    s_waitcnt lgkmcnt(8)
    ds_read_b64_tr_b16 a[164:165], v15 offset:40960
    ds_read_b64_tr_b16 a[166:167], v15 offset:45056
    v_mfma_f32_16x16x32_bf16 v[80:83], a[224:227], a[80:83], v[80:83]
    s_waitcnt lgkmcnt(8)
    ds_read_b64_tr_b16 a[168:169], v15 offset:49152
    v_cvt_pk_bf16_f32 v230, v76, v77
    v_mfma_f32_16x16x32_bf16 v[80:83], a[228:231], a[84:87], v[80:83]
    s_waitcnt lgkmcnt(7)
    s_add_u32 s38, s93, 164864
    ds_read_b64_tr_b16 a[170:171], v15 offset:53248
    v_cvt_pk_bf16_f32 v231, v78, v79
    v_mfma_f32_16x16x32_bf16 v[80:83], a[232:235], a[88:91], v[80:83]
    s_waitcnt lgkmcnt(6)
    buffer_store_dwordx4 v[228:231], v56, s[28:31], s38 offen sc1
    v_mfma_f32_16x16x32_bf16 v[80:83], a[236:239], a[92:95], v[80:83]
    ds_read_b64_tr_b16 a[172:173], v15 offset:57344
    ds_read_b64_tr_b16 a[174:175], v15 offset:61440
    v_mfma_f32_16x16x32_bf16 v[84:87], a[236:239], a[124:127], v[84:87]
    ds_read_b64_tr_b16 a[176:177], v19 offset:32768
    v_mfma_f32_16x16x32_bf16 v[84:87], a[232:235], a[120:123], v[84:87]
    ds_read_b64_tr_b16 a[178:179], v19 offset:36864
    v_mfma_f32_16x16x32_bf16 v[84:87], a[228:231], a[116:119], v[84:87]
    buffer_load_dwordx4 v[168:171], v59, s[24:27], s45 offen offset:1024 sc1
    v_mfma_f32_16x16x32_bf16 v[84:87], a[224:227], a[112:115], v[84:87]
    ds_read_b64_tr_b16 a[180:181], v19 offset:40960
    ds_read_b64_tr_b16 a[182:183], v19 offset:45056
    v_mfma_f32_16x16x32_bf16 v[84:87], a[220:223], a[108:111], v[84:87]
    ds_read_b64_tr_b16 a[184:185], v19 offset:49152
    v_cvt_pk_bf16_f32 v232, v80, v81
    v_mfma_f32_16x16x32_bf16 v[84:87], a[216:219], a[104:107], v[84:87]
    s_mov_b32 s45, 20992
    ds_read_b64_tr_b16 a[186:187], v19 offset:53248
    v_cvt_pk_bf16_f32 v233, v82, v83
    v_mfma_f32_16x16x32_bf16 v[84:87], a[212:215], a[100:103], v[84:87]
    buffer_load_dwordx4 v[172:175], v5, s[24:27], s45 offen offset:0 sc1
    v_mfma_f32_16x16x32_bf16 v[84:87], a[208:211], a[96:99], v[84:87]
    s_waitcnt lgkmcnt(12)
    ds_read_b64_tr_b16 a[188:189], v19 offset:57344
    ds_read_b64_tr_b16 a[190:191], v19 offset:61440
    s_barrier
    v_mfma_f32_16x16x32_bf16 v[88:91], a[160:163], a[64:67], v[88:91]
    s_waitcnt lgkmcnt(12)
    ds_read_b64_tr_b16 a[208:209], v20 offset:32768
    v_mfma_f32_16x16x32_bf16 v[88:91], a[164:167], a[68:71], v[88:91]
    s_waitcnt lgkmcnt(11)
    ds_read_b64_tr_b16 a[210:211], v20 offset:36864
    v_mfma_f32_16x16x32_bf16 v[88:91], a[168:171], a[72:75], v[88:91]
    s_waitcnt lgkmcnt(10)
    buffer_load_dwordx4 v[208:211], v5, s[24:27], s45 offen offset:512 sc1
    v_mfma_f32_16x16x32_bf16 v[88:91], a[172:175], a[76:79], v[88:91]
    s_waitcnt lgkmcnt(8)
    ds_read_b64_tr_b16 a[212:213], v20 offset:40960
    ds_read_b64_tr_b16 a[214:215], v20 offset:45056
    v_mfma_f32_16x16x32_bf16 v[88:91], a[176:179], a[80:83], v[88:91]
    s_waitcnt lgkmcnt(8)
    s_add_u32 s57, s59, 4096
    ds_read_b64_tr_b16 a[216:217], v20 offset:49152
    v_cvt_pk_bf16_f32 v236, v84, v85
    v_mfma_f32_16x16x32_bf16 v[88:91], a[180:183], a[84:87], v[88:91]
    s_waitcnt lgkmcnt(7)
    s_add_u32 m0, s6, -98304
    ds_read_b64_tr_b16 a[218:219], v20 offset:53248
    v_cvt_pk_bf16_f32 v237, v86, v87
    v_mfma_f32_16x16x32_bf16 v[88:91], a[184:187], a[88:91], v[88:91]
    s_waitcnt lgkmcnt(6)
    buffer_load_dwordx4 v255, s[84:87], s57 offen lds
    v_mfma_f32_16x16x32_bf16 v[88:91], a[188:191], a[92:95], v[88:91]
    ds_read_b64_tr_b16 a[220:221], v20 offset:57344
    ds_read_b64_tr_b16 a[222:223], v20 offset:61440
    v_mfma_f32_16x16x32_bf16 v[92:95], a[188:191], a[124:127], v[92:95]
    s_add_u32 s57, s59, 8192
    buffer_load_dwordx4 v[212:215], v59, s[24:27], s45 offen offset:1024 sc1
    v_mfma_f32_16x16x32_bf16 v[92:95], a[184:187], a[120:123], v[92:95]
    s_add_u32 m0, s6, -94208
    ds_read_b64_tr_b16 a[224:225], v24 offset:32768
    ds_read_b64_tr_b16 a[226:227], v24 offset:36864
    v_mfma_f32_16x16x32_bf16 v[92:95], a[180:183], a[116:119], v[92:95]
    buffer_load_dwordx4 v255, s[84:87], s57 offen lds
    v_mfma_f32_16x16x32_bf16 v[92:95], a[176:179], a[112:115], v[92:95]
    ds_read_b64_tr_b16 a[228:229], v24 offset:40960
    ds_read_b64_tr_b16 a[230:231], v24 offset:45056
    v_mfma_f32_16x16x32_bf16 v[92:95], a[172:175], a[108:111], v[92:95]
    ds_read_b64_tr_b16 a[232:233], v24 offset:49152
    v_cvt_pk_bf16_f32 v234, v88, v89
    v_mfma_f32_16x16x32_bf16 v[92:95], a[168:171], a[104:107], v[92:95]
    s_add_u32 s38, s93, 1152
    ds_read_b64_tr_b16 a[234:235], v24 offset:53248
    v_cvt_pk_bf16_f32 v235, v90, v91
    v_mfma_f32_16x16x32_bf16 v[92:95], a[164:167], a[100:103], v[92:95]
    buffer_store_dwordx4 v[232:235], v56, s[28:31], s38 offen sc1
    v_mfma_f32_16x16x32_bf16 v[92:95], a[160:163], a[96:99], v[92:95]
    s_waitcnt lgkmcnt(12)
    ds_read_b64_tr_b16 a[236:237], v24 offset:57344
    ds_read_b64_tr_b16 a[238:239], v24 offset:61440
    v_mfma_f32_16x16x32_bf16 v[96:99], a[208:211], v[128:131], 0
    s_waitcnt lgkmcnt(12)
    s_add_u32 s57, s59, 12288
    ds_read_b64_tr_b16 a[160:161], v21 offset:32768
    v_mfma_f32_16x16x32_bf16 v[96:99], a[212:215], v[144:147], v[96:99]
    s_waitcnt lgkmcnt(11)
    s_add_u32 m0, s6, -90112
    ds_read_b64_tr_b16 a[162:163], v21 offset:36864
    v_mfma_f32_16x16x32_bf16 v[96:99], a[216:219], v[192:195], v[96:99]
    s_waitcnt lgkmcnt(10)
    buffer_load_dwordx4 v255, s[84:87], s57 offen lds
    v_mfma_f32_16x16x32_bf16 v[96:99], a[220:223], v[176:179], v[96:99]
    s_waitcnt lgkmcnt(8)
    ds_read_b64_tr_b16 a[164:165], v21 offset:40960
    ds_read_b64_tr_b16 a[166:167], v21 offset:45056
    v_mfma_f32_16x16x32_bf16 v[96:99], a[224:227], v[136:139], v[96:99]
    s_waitcnt lgkmcnt(8)
    ds_read_b64_tr_b16 a[168:169], v21 offset:49152
    v_cvt_pk_bf16_f32 v238, v92, v93
    v_mfma_f32_16x16x32_bf16 v[96:99], a[228:231], v[152:155], v[96:99]
    s_waitcnt lgkmcnt(7)
    s_add_u32 s38, s93, 164992
    ds_read_b64_tr_b16 a[170:171], v21 offset:53248
    v_cvt_pk_bf16_f32 v239, v94, v95
    v_mfma_f32_16x16x32_bf16 v[96:99], a[232:235], v[200:203], v[96:99]
    s_waitcnt lgkmcnt(6)
    buffer_store_dwordx4 v[236:239], v56, s[28:31], s38 offen sc1
    v_mfma_f32_16x16x32_bf16 v[96:99], a[236:239], v[184:187], v[96:99]
    ds_read_b64_tr_b16 a[172:173], v21 offset:57344
    ds_read_b64_tr_b16 a[174:175], v21 offset:61440
    v_mfma_f32_16x16x32_bf16 v[100:103], a[236:239], v[188:191], 0
    s_add_u32 s57, s59, 16384
    buffer_load_dwordx2 v[92:93], v58, s[12:15], 0 offen offset:1024
    v_mfma_f32_16x16x32_bf16 v[100:103], a[232:235], v[204:207], v[100:103]
    s_add_u32 m0, s6, -86016
    ds_read_b64_tr_b16 a[176:177], v25 offset:32768
    ds_read_b64_tr_b16 a[178:179], v25 offset:36864
    v_mfma_f32_16x16x32_bf16 v[100:103], a[228:231], v[156:159], v[100:103]
    buffer_load_dwordx4 v255, s[84:87], s57 offen lds
    v_mfma_f32_16x16x32_bf16 v[100:103], a[224:227], v[140:143], v[100:103]
    ds_read_b64_tr_b16 a[180:181], v25 offset:40960
    ds_read_b64_tr_b16 a[182:183], v25 offset:45056
    v_mfma_f32_16x16x32_bf16 v[100:103], a[220:223], v[180:183], v[100:103]
    ds_read_b64_tr_b16 a[184:185], v25 offset:49152
    v_mfma_f32_16x16x32_bf16 v[100:103], a[216:219], v[196:199], v[100:103]
    ds_read_b64_tr_b16 a[186:187], v25 offset:53248
    v_mfma_f32_16x16x32_bf16 v[100:103], a[212:215], v[148:151], v[100:103]
    buffer_load_dwordx2 v[94:95], v58, s[12:15], 0 offen offset:1056
    v_mfma_f32_16x16x32_bf16 v[100:103], a[208:211], v[132:135], v[100:103]
    s_waitcnt lgkmcnt(12)
    ds_read_b64_tr_b16 a[188:189], v25 offset:57344
    ds_read_b64_tr_b16 a[190:191], v25 offset:61440
    v_mfma_f32_16x16x32_bf16 v[104:107], a[160:163], v[128:131], 0
    s_waitcnt lgkmcnt(12)
    s_add_u32 s57, s59, 20480
    ds_read_b64_tr_b16 a[208:209], v22 offset:32768
    v_mfma_f32_16x16x32_bf16 v[104:107], a[164:167], v[144:147], v[104:107]
    s_waitcnt lgkmcnt(11)
    s_add_u32 m0, s6, -81920
    ds_read_b64_tr_b16 a[210:211], v22 offset:36864
    v_mfma_f32_16x16x32_bf16 v[104:107], a[168:171], v[192:195], v[104:107]
    s_waitcnt lgkmcnt(10)
    buffer_load_dwordx4 v255, s[84:87], s57 offen lds
    v_mfma_f32_16x16x32_bf16 v[104:107], a[172:175], v[176:179], v[104:107]
    s_waitcnt lgkmcnt(8)
    s_mov_b32 s45, 19840
    ds_read_b64_tr_b16 a[212:213], v22 offset:40960
    ds_read_b64_tr_b16 a[214:215], v22 offset:45056
    v_mfma_f32_16x16x32_bf16 v[104:107], a[176:179], v[136:139], v[104:107]
    s_waitcnt lgkmcnt(8)
    s_add_u32 s57, s59, 24576
    buffer_load_dwordx4 v[64:67], v5, s[24:27], s45 offen offset:0 sc1
    v_mfma_f32_16x16x32_bf16 v[104:107], a[180:183], v[152:155], v[104:107]
    s_waitcnt lgkmcnt(6)
    s_add_u32 m0, s6, -77824
    ds_read_b64_tr_b16 a[216:217], v22 offset:49152
    ds_read_b64_tr_b16 a[218:219], v22 offset:53248
    v_mfma_f32_16x16x32_bf16 v[104:107], a[184:187], v[200:203], v[104:107]
    s_waitcnt lgkmcnt(6)
    buffer_load_dwordx4 v255, s[84:87], s57 offen lds
    v_mfma_f32_16x16x32_bf16 v[104:107], a[188:191], v[184:187], v[104:107]
    ds_read_b64_tr_b16 a[220:221], v22 offset:57344
    ds_read_b64_tr_b16 a[222:223], v22 offset:61440
    v_mfma_f32_16x16x32_bf16 v[108:111], a[188:191], v[188:191], 0
    s_add_u32 s57, s59, 28672
    ds_read_b64_tr_b16 a[224:225], v26 offset:32768
    v_mfma_f32_16x16x32_bf16 v[108:111], a[184:187], v[204:207], v[108:111]
    s_add_u32 m0, s6, -73728
    ds_read_b64_tr_b16 a[226:227], v26 offset:36864
    v_mfma_f32_16x16x32_bf16 v[108:111], a[180:183], v[156:159], v[108:111]
    buffer_load_dwordx4 v255, s[84:87], s57 offen lds
    v_mfma_f32_16x16x32_bf16 v[108:111], a[176:179], v[140:143], v[108:111]
    ds_read_b64_tr_b16 a[228:229], v26 offset:40960
    ds_read_b64_tr_b16 a[230:231], v26 offset:45056
    v_mfma_f32_16x16x32_bf16 v[108:111], a[172:175], v[180:183], v[108:111]
    s_add_u32 s57, s59, 32768
    buffer_load_dwordx4 v[68:71], v5, s[24:27], s45 offen offset:512 sc1
    v_mfma_f32_16x16x32_bf16 v[108:111], a[168:171], v[196:199], v[108:111]
    s_add_u32 m0, s6, -69632
    ds_read_b64_tr_b16 a[232:233], v26 offset:49152
    ds_read_b64_tr_b16 a[234:235], v26 offset:53248
    v_mfma_f32_16x16x32_bf16 v[108:111], a[164:167], v[148:151], v[108:111]
    buffer_load_dwordx4 v255, s[84:87], s57 offen lds
    v_mfma_f32_16x16x32_bf16 v[108:111], a[160:163], v[132:135], v[108:111]
    s_waitcnt lgkmcnt(12)
    ds_read_b64_tr_b16 a[236:237], v26 offset:57344
    ds_read_b64_tr_b16 a[238:239], v26 offset:61440
    v_mfma_f32_16x16x32_bf16 v[112:115], a[208:211], v[128:131], 0
    s_waitcnt lgkmcnt(12)
    ds_read_b64_tr_b16 a[160:161], v23 offset:32768
    v_mfma_f32_16x16x32_bf16 v[112:115], a[212:215], v[144:147], v[112:115]
    s_waitcnt lgkmcnt(11)
    ds_read_b64_tr_b16 a[162:163], v23 offset:36864
    v_mfma_f32_16x16x32_bf16 v[112:115], a[216:219], v[192:195], v[112:115]
    s_waitcnt lgkmcnt(10)
    ds_read_b64_tr_b16 a[164:165], v23 offset:40960
    v_mfma_f32_16x16x32_bf16 v[112:115], a[220:223], v[176:179], v[112:115]
    s_waitcnt lgkmcnt(9)
    ds_read_b64_tr_b16 a[166:167], v23 offset:45056
    v_mfma_f32_16x16x32_bf16 v[112:115], a[224:227], v[136:139], v[112:115]
    s_waitcnt lgkmcnt(8)
    buffer_load_dwordx4 v[72:75], v59, s[24:27], s45 offen offset:1024 sc1
    v_mfma_f32_16x16x32_bf16 v[112:115], a[228:231], v[152:155], v[112:115]
    s_waitcnt lgkmcnt(6)
    ds_read_b64_tr_b16 a[168:169], v23 offset:49152
    ds_read_b64_tr_b16 a[170:171], v23 offset:53248
    v_mfma_f32_16x16x32_bf16 v[112:115], a[232:235], v[200:203], v[112:115]
    s_waitcnt lgkmcnt(6)
    ds_read_b64_tr_b16 a[172:173], v23 offset:57344
    v_mfma_f32_16x16x32_bf16 v[112:115], a[236:239], v[184:187], v[112:115]
    ds_read_b64_tr_b16 a[174:175], v23 offset:61440
    v_mfma_f32_16x16x32_bf16 v[116:119], a[236:239], v[188:191], 0
    buffer_load_dwordx2 v[76:77], v3, s[20:23], 0 offen offset:0
    v_mfma_f32_16x16x32_bf16 v[116:119], a[232:235], v[204:207], v[116:119]
    ds_read_b64_tr_b16 a[176:177], v27 offset:32768
    ds_read_b64_tr_b16 a[178:179], v27 offset:36864
    v_mfma_f32_16x16x32_bf16 v[116:119], a[228:231], v[156:159], v[116:119]
    ds_read_b64_tr_b16 a[180:181], v27 offset:40960
    v_mfma_f32_16x16x32_bf16 v[116:119], a[224:227], v[140:143], v[116:119]
    ds_read_b64_tr_b16 a[182:183], v27 offset:45056
    v_mfma_f32_16x16x32_bf16 v[116:119], a[220:223], v[180:183], v[116:119]
    buffer_load_dwordx2 v[78:79], v3, s[20:23], 0 offen offset:32
    v_mfma_f32_16x16x32_bf16 v[116:119], a[216:219], v[196:199], v[116:119]
    ds_read_b64_tr_b16 a[184:185], v27 offset:49152
    ds_read_b64_tr_b16 a[186:187], v27 offset:53248
    v_mfma_f32_16x16x32_bf16 v[116:119], a[212:215], v[148:151], v[116:119]
    ds_read_b64_tr_b16 a[188:189], v27 offset:57344
    v_mfma_f32_16x16x32_bf16 v[116:119], a[208:211], v[132:135], v[116:119]
    ds_read_b64_tr_b16 a[190:191], v27 offset:61440
    s_waitcnt vmcnt(25)
    s_waitcnt lgkmcnt(0)
    s_barrier
    v_mfma_f32_16x16x32_bf16 v[120:123], a[160:163], v[128:131], 0
    ds_read_b64_tr_b16 a[208:209], v12 offset:0
    v_mfma_f32_16x16x32_bf16 v[120:123], a[164:167], v[144:147], v[120:123]
    ds_read_b64_tr_b16 a[210:211], v12 offset:4096
    v_mfma_f32_16x16x32_bf16 v[120:123], a[168:171], v[192:195], v[120:123]
    buffer_load_dwordx2 v[80:81], v3, s[20:23], 0 offen offset:512
    v_mfma_f32_16x16x32_bf16 v[120:123], a[172:175], v[176:179], v[120:123]
    s_add_u32 s39, s39, 16
    ds_read_b64_tr_b16 a[212:213], v12 offset:8192
    ds_read_b64_tr_b16 a[214:215], v12 offset:12288
    v_mfma_f32_16x16x32_bf16 v[120:123], a[176:179], v[136:139], v[120:123]
    buffer_load_dword v11, v9, s[24:27], s39 offen sc1
    v_mfma_f32_16x16x32_bf16 v[120:123], a[180:183], v[152:155], v[120:123]
    ds_read_b64_tr_b16 a[216:217], v12 offset:16384
    ds_read_b64_tr_b16 a[218:219], v12 offset:20480
    v_mfma_f32_16x16x32_bf16 v[120:123], a[184:187], v[200:203], v[120:123]
    ds_read_b64_tr_b16 a[220:221], v12 offset:24576
    v_mfma_f32_16x16x32_bf16 v[120:123], a[188:191], v[184:187], v[120:123]
    ds_read_b64_tr_b16 a[222:223], v12 offset:28672
    v_mfma_f32_16x16x32_bf16 v[124:127], a[188:191], v[188:191], 0
    buffer_load_dwordx2 v[82:83], v3, s[20:23], 0 offen offset:544
    v_mfma_f32_16x16x32_bf16 v[124:127], a[184:187], v[204:207], v[124:127]
    ds_read_b64_tr_b16 a[224:225], v16 offset:0
    ds_read_b64_tr_b16 a[226:227], v16 offset:4096
    v_mfma_f32_16x16x32_bf16 v[124:127], a[180:183], v[156:159], v[124:127]
    ds_read_b64_tr_b16 a[228:229], v16 offset:8192
    v_mfma_f32_16x16x32_bf16 v[124:127], a[176:179], v[140:143], v[124:127]
    ds_read_b64_tr_b16 a[230:231], v16 offset:12288
    v_mfma_f32_16x16x32_bf16 v[124:127], a[172:175], v[180:183], v[124:127]
    buffer_load_dwordx2 v[84:85], v55, s[20:23], 0 offen offset:1024
    v_mfma_f32_16x16x32_bf16 v[124:127], a[168:171], v[196:199], v[124:127]
    ds_read_b64_tr_b16 a[232:233], v16 offset:16384
    ds_read_b64_tr_b16 a[234:235], v16 offset:20480
    v_mfma_f32_16x16x32_bf16 v[124:127], a[164:167], v[148:151], v[124:127]
    ds_read_b64_tr_b16 a[236:237], v16 offset:24576
    v_mfma_f32_16x16x32_bf16 v[124:127], a[160:163], v[132:135], v[124:127]
    s_waitcnt lgkmcnt(13)
    ds_read_b64_tr_b16 a[238:239], v16 offset:28672
    v_mfma_f32_16x16x32_bf16 v[96:99], a[208:211], a[64:67], v[96:99]
    s_waitcnt lgkmcnt(12)
    buffer_load_dwordx2 v[86:87], v55, s[20:23], 0 offen offset:1056
    v_mfma_f32_16x16x32_bf16 v[96:99], a[212:215], a[68:71], v[96:99]
    s_waitcnt lgkmcnt(10)
    ds_read_b64_tr_b16 a[160:161], v13 offset:0
    ds_read_b64_tr_b16 a[162:163], v13 offset:4096
    v_mfma_f32_16x16x32_bf16 v[96:99], a[216:219], a[72:75], v[96:99]
    s_waitcnt lgkmcnt(10)
    ds_read_b64_tr_b16 a[164:165], v13 offset:8192
    v_mfma_f32_16x16x32_bf16 v[96:99], a[220:223], a[76:79], v[96:99]
    s_waitcnt lgkmcnt(9)
    ds_read_b64_tr_b16 a[166:167], v13 offset:12288
    v_mfma_f32_16x16x32_bf16 v[96:99], a[224:227], a[80:83], v[96:99]
    s_waitcnt lgkmcnt(8)
Ltour0_11:
    s_cbranch_execz Lmain0
    ds_read_b64_tr_b16 a[168:169], v13 offset:16384
    v_mfma_f32_16x16x32_bf16 v[96:99], a[228:231], a[84:87], v[96:99]
    s_waitcnt lgkmcnt(7)
    s_mov_b32 s45, 22144
    ds_read_b64_tr_b16 a[170:171], v13 offset:20480
    v_mfma_f32_16x16x32_bf16 v[96:99], a[232:235], a[88:91], v[96:99]
    s_waitcnt lgkmcnt(6)
    buffer_load_dwordx4 v[216:219], v5, s[24:27], s45 offen offset:0 sc1
    v_mfma_f32_16x16x32_bf16 v[96:99], a[236:239], a[92:95], v[96:99]
    ds_read_b64_tr_b16 a[172:173], v13 offset:24576
    ds_read_b64_tr_b16 a[174:175], v13 offset:28672
    v_mfma_f32_16x16x32_bf16 v[100:103], a[236:239], a[124:127], v[100:103]
    ds_read_b64_tr_b16 a[176:177], v17 offset:0
    v_mfma_f32_16x16x32_bf16 v[100:103], a[232:235], a[120:123], v[100:103]
    ds_read_b64_tr_b16 a[178:179], v17 offset:4096
    v_mfma_f32_16x16x32_bf16 v[100:103], a[228:231], a[116:119], v[100:103]
    buffer_load_dwordx4 v[220:223], v5, s[24:27], s45 offen offset:512 sc1
    v_mfma_f32_16x16x32_bf16 v[100:103], a[224:227], a[112:115], v[100:103]
    ds_read_b64_tr_b16 a[180:181], v17 offset:8192
    ds_read_b64_tr_b16 a[182:183], v17 offset:12288
    v_mfma_f32_16x16x32_bf16 v[100:103], a[220:223], a[108:111], v[100:103]
    ds_read_b64_tr_b16 a[184:185], v17 offset:16384
    v_cvt_pk_bf16_f32 v224, v96, v97
    v_mfma_f32_16x16x32_bf16 v[100:103], a[216:219], a[104:107], v[100:103]
    ds_read_b64_tr_b16 a[186:187], v17 offset:20480
    v_cvt_pk_bf16_f32 v225, v98, v99
    v_mfma_f32_16x16x32_bf16 v[100:103], a[212:215], a[100:103], v[100:103]
    ds_read_b64_tr_b16 a[188:189], v17 offset:24576
    v_mfma_f32_16x16x32_bf16 v[100:103], a[208:211], a[96:99], v[100:103]
    s_waitcnt lgkmcnt(13)
    ds_read_b64_tr_b16 a[190:191], v17 offset:28672
    v_mfma_f32_16x16x32_bf16 v[104:107], a[160:163], a[64:67], v[104:107]
    s_waitcnt lgkmcnt(12)
    buffer_load_dwordx4 v[88:91], v59, s[24:27], s45 offen offset:1024 sc1
    v_mfma_f32_16x16x32_bf16 v[104:107], a[164:167], a[68:71], v[104:107]
    s_waitcnt lgkmcnt(10)
    ds_read_b64_tr_b16 a[208:209], v14 offset:0
    ds_read_b64_tr_b16 a[210:211], v14 offset:4096
    v_mfma_f32_16x16x32_bf16 v[104:107], a[168:171], a[72:75], v[104:107]
    s_waitcnt lgkmcnt(10)
    ds_read_b64_tr_b16 a[212:213], v14 offset:8192
    v_mfma_f32_16x16x32_bf16 v[104:107], a[172:175], a[76:79], v[104:107]
    s_waitcnt lgkmcnt(9)
    ds_read_b64_tr_b16 a[214:215], v14 offset:12288
    v_mfma_f32_16x16x32_bf16 v[104:107], a[176:179], a[80:83], v[104:107]
    s_waitcnt lgkmcnt(8)
    ds_read_b64_tr_b16 a[216:217], v14 offset:16384
    v_cvt_pk_bf16_f32 v228, v100, v101
    v_mfma_f32_16x16x32_bf16 v[104:107], a[180:183], a[84:87], v[104:107]
    s_waitcnt lgkmcnt(7)
    ds_read_b64_tr_b16 a[218:219], v14 offset:20480
    v_cvt_pk_bf16_f32 v229, v102, v103
    v_mfma_f32_16x16x32_bf16 v[104:107], a[184:187], a[88:91], v[104:107]
    s_waitcnt lgkmcnt(6)
    ds_read_b64_tr_b16 a[220:221], v14 offset:24576
    v_mfma_f32_16x16x32_bf16 v[104:107], a[188:191], a[92:95], v[104:107]
    ds_read_b64_tr_b16 a[222:223], v14 offset:28672
    v_mfma_f32_16x16x32_bf16 v[108:111], a[188:191], a[124:127], v[108:111]
    ds_read_b64_tr_b16 a[224:225], v18 offset:0
    v_mfma_f32_16x16x32_bf16 v[108:111], a[184:187], a[120:123], v[108:111]
    ds_read_b64_tr_b16 a[226:227], v18 offset:4096
    v_mfma_f32_16x16x32_bf16 v[108:111], a[180:183], a[116:119], v[108:111]
    ds_read_b64_tr_b16 a[228:229], v18 offset:8192
    v_mfma_f32_16x16x32_bf16 v[108:111], a[176:179], a[112:115], v[108:111]
    ds_read_b64_tr_b16 a[230:231], v18 offset:12288
    v_mfma_f32_16x16x32_bf16 v[108:111], a[172:175], a[108:111], v[108:111]
    ds_read_b64_tr_b16 a[232:233], v18 offset:16384
    v_cvt_pk_bf16_f32 v226, v104, v105
    v_mfma_f32_16x16x32_bf16 v[108:111], a[168:171], a[104:107], v[108:111]
    s_add_u32 s38, s93, 1536
    ds_read_b64_tr_b16 a[234:235], v18 offset:20480
    v_cvt_pk_bf16_f32 v227, v106, v107
    v_mfma_f32_16x16x32_bf16 v[108:111], a[164:167], a[100:103], v[108:111]
    buffer_store_dwordx4 v[224:227], v56, s[28:31], s38 offen sc1
    v_mfma_f32_16x16x32_bf16 v[108:111], a[160:163], a[96:99], v[108:111]
    s_waitcnt lgkmcnt(12)
    ds_read_b64_tr_b16 a[236:237], v18 offset:24576
    ds_read_b64_tr_b16 a[238:239], v18 offset:28672
    v_mfma_f32_16x16x32_bf16 v[112:115], a[208:211], a[64:67], v[112:115]
    s_waitcnt lgkmcnt(12)
    ds_read_b64_tr_b16 a[160:161], v15 offset:0
    v_mfma_f32_16x16x32_bf16 v[112:115], a[212:215], a[68:71], v[112:115]
    s_waitcnt lgkmcnt(11)
    ds_read_b64_tr_b16 a[162:163], v15 offset:4096
    v_mfma_f32_16x16x32_bf16 v[112:115], a[216:219], a[72:75], v[112:115]
    s_waitcnt lgkmcnt(10)
    ds_read_b64_tr_b16 a[164:165], v15 offset:8192
    v_mfma_f32_16x16x32_bf16 v[112:115], a[220:223], a[76:79], v[112:115]
    s_waitcnt lgkmcnt(9)
    ds_read_b64_tr_b16 a[166:167], v15 offset:12288
    v_mfma_f32_16x16x32_bf16 v[112:115], a[224:227], a[80:83], v[112:115]
    s_waitcnt lgkmcnt(8)
    ds_read_b64_tr_b16 a[168:169], v15 offset:16384
    v_cvt_pk_bf16_f32 v230, v108, v109
    v_mfma_f32_16x16x32_bf16 v[112:115], a[228:231], a[84:87], v[112:115]
    s_waitcnt lgkmcnt(7)
    s_add_u32 s38, s93, 165376
    ds_read_b64_tr_b16 a[170:171], v15 offset:20480
    v_cvt_pk_bf16_f32 v231, v110, v111
    v_mfma_f32_16x16x32_bf16 v[112:115], a[232:235], a[88:91], v[112:115]
    s_waitcnt lgkmcnt(6)
    buffer_store_dwordx4 v[228:231], v56, s[28:31], s38 offen sc1
    v_mfma_f32_16x16x32_bf16 v[112:115], a[236:239], a[92:95], v[112:115]
    ds_read_b64_tr_b16 a[172:173], v15 offset:24576
    ds_read_b64_tr_b16 a[174:175], v15 offset:28672
    v_mfma_f32_16x16x32_bf16 v[116:119], a[236:239], a[124:127], v[116:119]
    ds_read_b64_tr_b16 a[176:177], v19 offset:0
    v_mfma_f32_16x16x32_bf16 v[116:119], a[232:235], a[120:123], v[116:119]
    ds_read_b64_tr_b16 a[178:179], v19 offset:4096
    v_mfma_f32_16x16x32_bf16 v[116:119], a[228:231], a[116:119], v[116:119]
    ds_read_b64_tr_b16 a[180:181], v19 offset:8192
    v_mfma_f32_16x16x32_bf16 v[116:119], a[224:227], a[112:115], v[116:119]
    ds_read_b64_tr_b16 a[182:183], v19 offset:12288
    v_mfma_f32_16x16x32_bf16 v[116:119], a[220:223], a[108:111], v[116:119]
    ds_read_b64_tr_b16 a[184:185], v19 offset:16384
    v_cvt_pk_bf16_f32 v232, v112, v113
    v_mfma_f32_16x16x32_bf16 v[116:119], a[216:219], a[104:107], v[116:119]
    ds_read_b64_tr_b16 a[186:187], v19 offset:20480
    v_cvt_pk_bf16_f32 v233, v114, v115
    v_mfma_f32_16x16x32_bf16 v[116:119], a[212:215], a[100:103], v[116:119]
    ds_read_b64_tr_b16 a[188:189], v19 offset:24576
    v_mfma_f32_16x16x32_bf16 v[116:119], a[208:211], a[96:99], v[116:119]
    s_waitcnt lgkmcnt(13)
    ds_read_b64_tr_b16 a[190:191], v19 offset:28672
    v_mfma_f32_16x16x32_bf16 v[120:123], a[160:163], a[64:67], v[120:123]
    s_waitcnt lgkmcnt(12)
    v_mfma_f32_16x16x32_bf16 v[120:123], a[164:167], a[68:71], v[120:123]
    s_waitcnt lgkmcnt(10)
    v_mfma_f32_16x16x32_bf16 v[120:123], a[168:171], a[72:75], v[120:123]
    s_waitcnt lgkmcnt(8)
    v_mfma_f32_16x16x32_bf16 v[120:123], a[172:175], a[76:79], v[120:123]
    s_waitcnt lgkmcnt(6)
    v_mfma_f32_16x16x32_bf16 v[120:123], a[176:179], a[80:83], v[120:123]
    s_waitcnt lgkmcnt(4)
    v_cvt_pk_bf16_f32 v236, v116, v117
    v_mfma_f32_16x16x32_bf16 v[120:123], a[180:183], a[84:87], v[120:123]
    s_waitcnt lgkmcnt(2)
    v_cvt_pk_bf16_f32 v237, v118, v119
    v_mfma_f32_16x16x32_bf16 v[120:123], a[184:187], a[88:91], v[120:123]
    s_waitcnt lgkmcnt(0)
    v_mfma_f32_16x16x32_bf16 v[120:123], a[188:191], a[92:95], v[120:123]
    v_mfma_f32_16x16x32_bf16 v[124:127], a[188:191], a[124:127], v[124:127]
    v_mfma_f32_16x16x32_bf16 v[124:127], a[184:187], a[120:123], v[124:127]
    v_mfma_f32_16x16x32_bf16 v[124:127], a[180:183], a[116:119], v[124:127]
    v_mfma_f32_16x16x32_bf16 v[124:127], a[176:179], a[112:115], v[124:127]
    v_mfma_f32_16x16x32_bf16 v[124:127], a[172:175], a[108:111], v[124:127]
    s_nop 2
    v_cvt_pk_bf16_f32 v234, v120, v121
    v_mfma_f32_16x16x32_bf16 v[124:127], a[168:171], a[104:107], v[124:127]
    s_add_u32 s38, s93, 1664
    v_cvt_pk_bf16_f32 v235, v122, v123
    v_mfma_f32_16x16x32_bf16 v[124:127], a[164:167], a[100:103], v[124:127]
    buffer_store_dwordx4 v[232:235], v56, s[28:31], s38 offen sc1
    v_mfma_f32_16x16x32_bf16 v[124:127], a[160:163], a[96:99], v[124:127]
    s_nop 7
    v_cvt_pk_bf16_f32 v238, v124, v125
    s_add_u32 s38, s93, 165504
    v_cvt_pk_bf16_f32 v239, v126, v127
    buffer_store_dwordx4 v[236:239], v56, s[28:31], s38 offen sc1
    s_add_u32 s92, s92, 16
    s_waitcnt vmcnt(35)
    v_lshlrev_b32 v96, 16, v160
    v_and_b32 v97, 0xffff0000, v160
    v_lshlrev_b32 v98, 16, v161
    v_and_b32 v99, 0xffff0000, v161
    v_lshlrev_b32 v100, 16, v162
    v_and_b32 v101, 0xffff0000, v162
    v_lshlrev_b32 v102, 16, v163
    v_and_b32 v103, 0xffff0000, v163
    s_waitcnt vmcnt(34)
    v_lshlrev_b32 v104, 16, v164
    v_and_b32 v105, 0xffff0000, v164
    v_lshlrev_b32 v106, 16, v165
    v_and_b32 v107, 0xffff0000, v165
    v_lshlrev_b32 v108, 16, v166
    v_and_b32 v109, 0xffff0000, v166
    v_lshlrev_b32 v110, 16, v167
    v_and_b32 v111, 0xffff0000, v167
    s_waitcnt vmcnt(32)
    v_lshlrev_b32 v112, 16, v168
    v_and_b32 v113, 0xffff0000, v168
    v_lshlrev_b32 v114, 16, v169
    v_and_b32 v115, 0xffff0000, v169
    v_lshlrev_b32 v116, 16, v170
    v_and_b32 v117, 0xffff0000, v170
    v_lshlrev_b32 v118, 16, v171
    v_and_b32 v119, 0xffff0000, v171
    s_waitcnt vmcnt(31)
    v_lshlrev_b32 v120, 16, v172
    v_and_b32 v121, 0xffff0000, v172
    v_lshlrev_b32 v122, 16, v173
    v_and_b32 v123, 0xffff0000, v173
    v_lshlrev_b32 v124, 16, v174
    v_and_b32 v125, 0xffff0000, v174
    v_lshlrev_b32 v126, 16, v175
    v_and_b32 v127, 0xffff0000, v175
    s_waitcnt vmcnt(30)
    v_lshlrev_b32 v128, 16, v208
    v_and_b32 v129, 0xffff0000, v208
    v_lshlrev_b32 v130, 16, v209
    v_and_b32 v131, 0xffff0000, v209
    v_lshlrev_b32 v132, 16, v210
    v_and_b32 v133, 0xffff0000, v210
    v_lshlrev_b32 v134, 16, v211
    v_and_b32 v135, 0xffff0000, v211
    s_waitcnt vmcnt(28)
    v_lshlrev_b32 v136, 16, v212
    v_and_b32 v137, 0xffff0000, v212
    v_lshlrev_b32 v138, 16, v213
    v_and_b32 v139, 0xffff0000, v213
    v_lshlrev_b32 v140, 16, v214
    v_and_b32 v141, 0xffff0000, v214
    v_lshlrev_b32 v142, 16, v215
    v_and_b32 v143, 0xffff0000, v215
    s_waitcnt vmcnt(19)
    v_lshlrev_b32 v144, 16, v64
    v_and_b32 v145, 0xffff0000, v64
    v_lshlrev_b32 v146, 16, v65
    v_and_b32 v147, 0xffff0000, v65
    v_lshlrev_b32 v148, 16, v66
    v_and_b32 v149, 0xffff0000, v66
    v_lshlrev_b32 v150, 16, v67
    v_and_b32 v151, 0xffff0000, v67
    s_waitcnt vmcnt(16)
    v_lshlrev_b32 v152, 16, v68
    v_and_b32 v153, 0xffff0000, v68
    v_lshlrev_b32 v154, 16, v69
    v_and_b32 v155, 0xffff0000, v69
    v_lshlrev_b32 v156, 16, v70
    v_and_b32 v157, 0xffff0000, v70
    v_lshlrev_b32 v158, 16, v71
    v_and_b32 v159, 0xffff0000, v71
    s_waitcnt vmcnt(14)
    v_lshlrev_b32 v160, 16, v72
    v_and_b32 v161, 0xffff0000, v72
    v_lshlrev_b32 v162, 16, v73
    v_and_b32 v163, 0xffff0000, v73
    v_lshlrev_b32 v164, 16, v74
    v_and_b32 v165, 0xffff0000, v74
    v_lshlrev_b32 v166, 16, v75
    v_and_b32 v167, 0xffff0000, v75
    s_waitcnt vmcnt(13)
    v_lshlrev_b32 v168, 16, v76
    v_and_b32 v169, 0xffff0000, v76
    v_lshlrev_b32 v170, 16, v77
    v_and_b32 v171, 0xffff0000, v77
    s_waitcnt vmcnt(12)
    v_lshlrev_b32 v172, 16, v78
    v_and_b32 v173, 0xffff0000, v78
    v_lshlrev_b32 v174, 16, v79
    v_and_b32 v175, 0xffff0000, v79
    s_waitcnt vmcnt(11)
    v_lshlrev_b32 v176, 16, v80
    v_and_b32 v177, 0xffff0000, v80
    v_lshlrev_b32 v178, 16, v81
    v_and_b32 v179, 0xffff0000, v81
    s_waitcnt vmcnt(9)
    v_lshlrev_b32 v180, 16, v82
    v_and_b32 v181, 0xffff0000, v82
    v_lshlrev_b32 v182, 16, v83
    v_and_b32 v183, 0xffff0000, v83
    s_waitcnt vmcnt(8)
    v_lshlrev_b32 v184, 16, v84
    v_and_b32 v185, 0xffff0000, v84
    v_lshlrev_b32 v186, 16, v85
    v_and_b32 v187, 0xffff0000, v85
    s_waitcnt vmcnt(7)
    v_lshlrev_b32 v188, 16, v86
    v_and_b32 v189, 0xffff0000, v86
    v_lshlrev_b32 v190, 16, v87
    v_and_b32 v191, 0xffff0000, v87
    s_waitcnt vmcnt(0)
    buffer_store_dword v10, v8, s[24:27], s92 offen sc1
    v_cmp_ne_u32 s[54:55], s95, v11
    s_cmp_lg_u64 s[54:55], 0
    s_cbranch_scc1 Ltail_spin1
Ltail_got1:
    s_add_u32 s56, s44, 16384
    buffer_load_dwordx4 a[0:3], v54, s[28:31], s56 offen offset:0 sc1
    buffer_load_dwordx4 a[4:7], v54, s[28:31], s56 offen offset:1024 sc1
    buffer_load_dwordx4 a[8:11], v54, s[28:31], s56 offen offset:2048 sc1
    buffer_load_dwordx4 a[12:15], v54, s[28:31], s56 offen offset:3072 sc1
    s_add_u32 s56, s44, 0
    buffer_load_dwordx4 a[16:19], v2, s[28:31], s56 offen offset:0 sc1
    s_add_u32 s56, s44, 4096
    buffer_load_dwordx4 a[20:23], v2, s[28:31], s56 offen offset:0 sc1
    s_add_u32 s56, s44, 8192
    buffer_load_dwordx4 a[24:27], v2, s[28:31], s56 offen offset:0 sc1
    s_add_u32 s56, s44, 12288
    buffer_load_dwordx4 a[28:31], v2, s[28:31], s56 offen offset:0 sc1
    ds_write_b128 v51, a[128:131] offset:0
    ds_write_b128 v51, a[132:135] offset:4096
    ds_write_b128 v51, a[136:139] offset:8192
    ds_write_b128 v51, a[140:143] offset:12288
    ds_write_b128 v51, a[144:147] offset:16384
    ds_write_b128 v51, a[148:151] offset:20480
    ds_write_b128 v51, a[152:155] offset:24576
    ds_write_b128 v51, a[156:159] offset:28672
    ds_write_b128 v51, a[240:243] offset:32768
    ds_write_b128 v255, a[244:247] offset:40960
    ds_write_b128 v255, a[248:251] offset:45056
    ds_write_b128 v255, a[252:255] offset:61440
    v_lshlrev_b32 v12, 16, v36
    v_and_b32 v13, 0xffff0000, v36
    v_lshlrev_b32 v14, 16, v37
    v_and_b32 v15, 0xffff0000, v37
    v_lshlrev_b32 v16, 16, v38
    v_and_b32 v17, 0xffff0000, v38
    v_lshlrev_b32 v18, 16, v39
    v_and_b32 v19, 0xffff0000, v39
    v_lshlrev_b32 v20, 16, v40
    v_and_b32 v21, 0xffff0000, v40
    v_lshlrev_b32 v22, 16, v41
    v_and_b32 v23, 0xffff0000, v41
    v_lshlrev_b32 v24, 16, v42
    v_and_b32 v25, 0xffff0000, v42
    v_lshlrev_b32 v26, 16, v43
    v_and_b32 v27, 0xffff0000, v43
    v_lshlrev_b32 v28, 16, v92
    v_and_b32 v29, 0xffff0000, v92
    v_lshlrev_b32 v30, 16, v93
    v_and_b32 v31, 0xffff0000, v93
    v_lshlrev_b32 v32, 16, v94
    v_and_b32 v33, 0xffff0000, v94
    v_lshlrev_b32 v34, 16, v95
    v_and_b32 v35, 0xffff0000, v95
    v_lshlrev_b32 v192, 16, v216
    v_and_b32 v193, 0xffff0000, v216
    v_lshlrev_b32 v194, 16, v217
    v_and_b32 v195, 0xffff0000, v217
    v_lshlrev_b32 v196, 16, v218
    v_and_b32 v197, 0xffff0000, v218
    v_lshlrev_b32 v198, 16, v219
    v_and_b32 v199, 0xffff0000, v219
    v_lshlrev_b32 v200, 16, v220
    v_and_b32 v201, 0xffff0000, v220
    v_lshlrev_b32 v202, 16, v221
    v_and_b32 v203, 0xffff0000, v221
    v_lshlrev_b32 v204, 16, v222
    v_and_b32 v205, 0xffff0000, v222
    v_lshlrev_b32 v206, 16, v223
    v_and_b32 v207, 0xffff0000, v223
    v_lshlrev_b32 v208, 16, v88
    v_and_b32 v209, 0xffff0000, v88
    v_lshlrev_b32 v210, 16, v89
    v_and_b32 v211, 0xffff0000, v89
    v_lshlrev_b32 v212, 16, v90
    v_and_b32 v213, 0xffff0000, v90
    v_lshlrev_b32 v214, 16, v91
    v_and_b32 v215, 0xffff0000, v91
    s_add_u32 s39, s39, 16
    buffer_load_dword v11, v9, s[24:27], s39 offen sc1
    s_add_u32 s56, s44, 0
    buffer_load_dwordx4 a[32:35], v2, s[28:31], s56 offen offset:512 sc1
    s_add_u32 s56, s44, 4096
    buffer_load_dwordx4 a[36:39], v2, s[28:31], s56 offen offset:512 sc1
    s_add_u32 s56, s44, 8192
    buffer_load_dwordx4 a[40:43], v2, s[28:31], s56 offen offset:512 sc1
    s_add_u32 s56, s44, 12288
    buffer_load_dwordx4 a[44:47], v2, s[28:31], s56 offen offset:512 sc1
    v_lshrrev_b32 v56, 2, v1
    v_and_b32 v57, 3, v1
    v_lshlrev_b32 v57, 3, v57
    s_and_b32 s36, s3, 1
    s_lshl_b32 s36, s36, 5
    v_lshl_add_u32 v61, v56, 6, v57
    v_add_u32 v61, s36, v61
    s_mov_b32 s36, 135168
    s_mov_b32 s37, 12288
    s_cmp_lt_u32 s3, 2
    s_cselect_b32 s36, 98304, s36
    s_cselect_b32 s37, 98304, s37
    v_add_u32 v94, s37, v61
    v_add_u32 v61, s36, v61
    v_mul_u32_u24 v95, 1152, v56
    s_lshl_b32 s36, s3, 7
    s_add_u32 s36, s36, 61440
    v_add3_u32 v95, v95, v57, s36
    s_waitcnt lgkmcnt(0)
    s_barrier
    ds_read_b64_tr_b16 a[96:97], v61 offset:0
    ds_read_b64_tr_b16 a[98:99], v61 offset:1024
    ds_read_b64_tr_b16 a[100:101], v61 offset:2048
    ds_read_b64_tr_b16 a[102:103], v61 offset:3072
    ds_read_b64_tr_b16 a[104:105], v61 offset:4096
    ds_read_b64_tr_b16 a[106:107], v61 offset:5120
    ds_read_b64_tr_b16 a[108:109], v61 offset:6144
    ds_read_b64_tr_b16 a[110:111], v61 offset:7168
    ds_read_b64_tr_b16 a[112:113], v61 offset:8192
    ds_read_b64_tr_b16 a[114:115], v61 offset:9216
    ds_read_b64_tr_b16 a[116:117], v61 offset:10240
    ds_read_b64_tr_b16 a[118:119], v61 offset:11264
    ds_read_b64_tr_b16 a[120:121], v61 offset:12288
    ds_read_b64_tr_b16 a[122:123], v61 offset:13312
    ds_read_b64_tr_b16 a[124:125], v61 offset:14336
    ds_read_b64_tr_b16 a[126:127], v61 offset:15360
    ds_read_b64_tr_b16 a[128:129], v61 offset:16384
    ds_read_b64_tr_b16 a[130:131], v61 offset:17408
    ds_read_b64_tr_b16 a[132:133], v61 offset:18432
    ds_read_b64_tr_b16 a[134:135], v61 offset:19456
    ds_read_b64_tr_b16 a[136:137], v61 offset:20480
    ds_read_b64_tr_b16 a[138:139], v61 offset:21504
    ds_read_b64_tr_b16 a[140:141], v61 offset:22528
    ds_read_b64_tr_b16 a[142:143], v61 offset:23552
    ds_read_b64_tr_b16 a[144:145], v61 offset:24576
    ds_read_b64_tr_b16 a[146:147], v61 offset:25600
    ds_read_b64_tr_b16 a[148:149], v61 offset:26624
    ds_read_b64_tr_b16 a[150:151], v61 offset:27648
    ds_read_b64_tr_b16 a[152:153], v94 offset:28672
    ds_read_b64_tr_b16 a[154:155], v94 offset:29696
    ds_read_b64_tr_b16 a[156:157], v94 offset:30720
    ds_read_b64_tr_b16 a[158:159], v94 offset:31744
    ds_read_b64_tr_b16 a[160:161], v94 offset:32768
    ds_read_b64_tr_b16 a[162:163], v94 offset:33792
    ds_read_b64_tr_b16 a[164:165], v94 offset:34816
    ds_read_b64_tr_b16 a[166:167], v94 offset:35840
    ds_read_b64_tr_b16 a[168:169], v95 offset:0
    ds_read_b64_tr_b16 a[170:171], v95 offset:18432
    ds_read_b64_tr_b16 a[172:173], v95 offset:32
    ds_read_b64_tr_b16 a[174:175], v95 offset:18464
    ds_read_b64_tr_b16 a[176:177], v95 offset:64
    ds_read_b64_tr_b16 a[178:179], v95 offset:18496
    ds_read_b64_tr_b16 a[180:181], v95 offset:96
    ds_read_b64_tr_b16 a[182:183], v95 offset:18528
    ds_read_b64_tr_b16 a[184:185], v95 offset:512
    ds_read_b64_tr_b16 a[186:187], v95 offset:18944
    ds_read_b64_tr_b16 a[188:189], v95 offset:544
    ds_read_b64_tr_b16 a[190:191], v95 offset:18976
    ds_read_b64_tr_b16 a[192:193], v95 offset:576
    ds_read_b64_tr_b16 a[194:195], v95 offset:19008
    ds_read_b64_tr_b16 a[196:197], v95 offset:608
    ds_read_b64_tr_b16 a[198:199], v95 offset:19040
    ds_read_b64_tr_b16 a[200:201], v95 offset:1024
    ds_read_b64_tr_b16 a[202:203], v95 offset:19456
    ds_read_b64_tr_b16 a[204:205], v95 offset:1056
    ds_read_b64_tr_b16 a[206:207], v95 offset:19488
    ds_read_b64_tr_b16 a[208:209], v95 offset:1088
    ds_read_b64_tr_b16 a[210:211], v95 offset:19520
    ds_read_b64_tr_b16 a[212:213], v95 offset:1120
    ds_read_b64_tr_b16 a[214:215], v95 offset:19552
    s_mov_b64 exec, 0
    s_cmp_eq_u32 s3, 0
    s_cbranch_scc1 Ltour1_0
    s_cmp_eq_u32 s3, 1
    s_cbranch_scc1 Ltour1_1
    s_cmp_eq_u32 s3, 2
    s_cbranch_scc1 Ltour1_2
    s_branch Ltour1_3
Lmain1:
    s_mov_b64 exec, -1
    v_pk_mul_f32 v[62:63], v[144:145], v[168:169]
    v_pk_mul_f32 v[168:169], v[168:169], v[120:121]
    v_pk_fma_f32 v[62:63], v[146:147], v[170:171], v[62:63]
    v_pk_mul_f32 v[170:171], v[170:171], v[122:123]
    v_pk_add_f32 v[88:89], v[168:169], v[170:171]
    v_pk_fma_f32 v[62:63], v[148:149], v[172:173], v[62:63]
    v_pk_mul_f32 v[172:173], v[172:173], v[124:125]
    v_pk_add_f32 v[88:89], v[88:89], v[172:173]
    v_pk_fma_f32 v[62:63], v[150:151], v[174:175], v[62:63]
    v_pk_mul_f32 v[174:175], v[174:175], v[126:127]
    v_pk_add_f32 v[88:89], v[88:89], v[174:175]
    v_pk_fma_f32 v[62:63], v[152:153], v[176:177], v[62:63]
    v_pk_mul_f32 v[176:177], v[176:177], v[128:129]
    v_pk_add_f32 v[88:89], v[88:89], v[176:177]
    v_pk_fma_f32 v[62:63], v[154:155], v[178:179], v[62:63]
    v_pk_mul_f32 v[178:179], v[178:179], v[130:131]
    v_pk_add_f32 v[88:89], v[88:89], v[178:179]
    v_pk_fma_f32 v[62:63], v[156:157], v[180:181], v[62:63]
    v_pk_mul_f32 v[180:181], v[180:181], v[132:133]
    v_pk_add_f32 v[88:89], v[88:89], v[180:181]
    v_pk_fma_f32 v[62:63], v[158:159], v[182:183], v[62:63]
    v_pk_mul_f32 v[182:183], v[182:183], v[134:135]
    v_pk_add_f32 v[88:89], v[88:89], v[182:183]
    v_pk_fma_f32 v[62:63], v[160:161], v[184:185], v[62:63]
    v_pk_mul_f32 v[184:185], v[184:185], v[136:137]
    v_pk_add_f32 v[88:89], v[88:89], v[184:185]
    v_pk_fma_f32 v[62:63], v[162:163], v[186:187], v[62:63]
    v_pk_mul_f32 v[186:187], v[186:187], v[138:139]
    v_pk_add_f32 v[88:89], v[88:89], v[186:187]
    v_pk_fma_f32 v[62:63], v[164:165], v[188:189], v[62:63]
    v_pk_mul_f32 v[188:189], v[188:189], v[140:141]
    v_pk_add_f32 v[88:89], v[88:89], v[188:189]
    v_pk_fma_f32 v[62:63], v[166:167], v[190:191], v[62:63]
    v_pk_mul_f32 v[190:191], v[190:191], v[142:143]
    v_pk_add_f32 v[88:89], v[88:89], v[190:191]
    v_add_f32 v91, v62, v63
    v_add_f32 v90, v88, v89
    s_nop 1
    v_add_f32_dpp v90, v90, v90 row_ror:8 row_mask:0xf bank_mask:0xf
    v_add_f32_dpp v91, v91, v91 row_ror:8 row_mask:0xf bank_mask:0xf
    s_nop 0
    v_add_f32_dpp v90, v90, v90 row_ror:4 row_mask:0xf bank_mask:0xf
    v_add_f32_dpp v91, v91, v91 row_ror:4 row_mask:0xf bank_mask:0xf
    s_nop 0
    v_add_f32_dpp v90, v90, v90 row_ror:2 row_mask:0xf bank_mask:0xf
    v_add_f32_dpp v91, v91, v91 row_ror:2 row_mask:0xf bank_mask:0xf
    s_nop 0
    v_add_f32_dpp v90, v90, v90 row_ror:1 row_mask:0xf bank_mask:0xf
    v_add_f32_dpp v91, v91, v91 row_ror:1 row_mask:0xf bank_mask:0xf
    v_mov_b32 v62, v90
    v_mov_b32 v63, v91
    s_nop 0
    v_permlane16_swap_b32 v90, v62
    v_permlane16_swap_b32 v91, v63
    v_add_f32 v90, v90, v62
    v_add_f32 v91, v91, v63
    v_lshlrev_b32 v92, 2, v7
    v_and_b32 v92, 28, v92
    v_sub_u32 v93, 2047, v7
    s_waitcnt vmcnt(12)
    v_mfma_f32_16x16x32_bf16 v[80:83], v[242:245], a[0:3], 0
    v_mfma_f32_16x16x32_bf16 v[84:87], v[240:243], a[0:3], 0
    s_waitcnt vmcnt(11)
    v_mfma_f32_16x16x32_bf16 v[80:83], v[242:245], a[4:7], v[80:83]
    v_mfma_f32_16x16x32_bf16 v[84:87], v[240:243], a[4:7], v[84:87]
    s_waitcnt vmcnt(10)
    v_mfma_f32_16x16x32_bf16 v[80:83], v[242:245], a[8:11], v[80:83]
    v_mfma_f32_16x16x32_bf16 v[84:87], v[240:243], a[8:11], v[84:87]
    s_waitcnt vmcnt(9)
    v_mfma_f32_16x16x32_bf16 v[80:83], v[242:245], a[12:15], v[80:83]
    v_mfma_f32_16x16x32_bf16 v[84:87], v[240:243], a[12:15], v[84:87]
    s_waitcnt vmcnt(8)
    s_nop 5
    v_mov_b32_dpp v80, v80 row_ror:8 row_mask:0x4 bank_mask:0xf
    v_mov_b32_dpp v81, v81 row_ror:8 row_mask:0x4 bank_mask:0xf
    v_mov_b32_dpp v82, v82 row_ror:8 row_mask:0x4 bank_mask:0xf
    v_mov_b32_dpp v83, v83 row_ror:8 row_mask:0x4 bank_mask:0xf
    v_mov_b32_dpp v84, v84 row_ror:8 row_mask:0x4 bank_mask:0xf
    v_mov_b32_dpp v85, v85 row_ror:8 row_mask:0x4 bank_mask:0xf
    v_mov_b32_dpp v86, v86 row_ror:8 row_mask:0x4 bank_mask:0xf
    v_mov_b32_dpp v87, v87 row_ror:8 row_mask:0x4 bank_mask:0xf
    v_pk_fma_f32 v[28:29], v[112:113], v[80:81], v[28:29]
    v_pk_fma_f32 v[30:31], v[114:115], v[82:83], v[30:31]
    v_pk_fma_f32 v[32:33], v[116:117], v[84:85], v[32:33]
    v_pk_fma_f32 v[34:35], v[118:119], v[86:87], v[34:35]
    v_cvt_pk_bf16_f32 v44, v28, v29
    v_cvt_pk_bf16_f32 v45, v30, v31
    v_cvt_pk_bf16_f32 v46, v32, v33
    v_cvt_pk_bf16_f32 v47, v34, v35
    v_lshlrev_b32 v28, 16, v44
    v_and_b32 v29, 0xffff0000, v44
    v_lshlrev_b32 v30, 16, v45
    v_and_b32 v31, 0xffff0000, v45
    v_lshlrev_b32 v32, 16, v46
    v_and_b32 v33, 0xffff0000, v46
    v_lshlrev_b32 v34, 16, v47
    v_and_b32 v35, 0xffff0000, v47
    v_mfma_f32_16x16x32_bf16 v[64:67], v[246:249], a[16:19], 0
    v_mfma_f32_16x16x32_bf16 v[68:71], v[244:247], a[16:19], 0
    s_waitcnt vmcnt(7)
    v_mfma_f32_16x16x32_bf16 v[64:67], v[246:249], a[20:23], v[64:67]
    v_mfma_f32_16x16x32_bf16 v[68:71], v[244:247], a[20:23], v[68:71]
    s_waitcnt vmcnt(6)
    v_mfma_f32_16x16x32_bf16 v[64:67], v[246:249], a[24:27], v[64:67]
    v_mfma_f32_16x16x32_bf16 v[68:71], v[244:247], a[24:27], v[68:71]
    s_waitcnt vmcnt(5)
    v_mfma_f32_16x16x32_bf16 v[64:67], v[246:249], a[28:31], v[64:67]
    v_mfma_f32_16x16x32_bf16 v[68:71], v[244:247], a[28:31], v[68:71]
    s_waitcnt vmcnt(4)
    v_cmp_ne_u32 s[54:55], s95, v11
    s_cmp_lg_u64 s[54:55], 0
    s_cbranch_scc1 Ltail_spin2
Ltail_got2:
    s_add_u32 s56, s44, 0
    buffer_load_dwordx4 a[48:51], v2, s[28:31], s56 offen offset:1024 sc1
    s_add_u32 s56, s44, 4096
    buffer_load_dwordx4 a[52:55], v2, s[28:31], s56 offen offset:1024 sc1
    s_add_u32 s56, s44, 8192
    buffer_load_dwordx4 a[56:59], v2, s[28:31], s56 offen offset:1024 sc1
    s_add_u32 s56, s44, 12288
    buffer_load_dwordx4 a[60:63], v2, s[28:31], s56 offen offset:1024 sc1
    s_add_u32 s56, s44, 0
    buffer_load_dwordx4 a[64:67], v2, s[28:31], s56 offen offset:1536 sc1
    s_add_u32 s56, s44, 4096
    buffer_load_dwordx4 a[68:71], v2, s[28:31], s56 offen offset:1536 sc1
    s_add_u32 s56, s44, 8192
    buffer_load_dwordx4 a[72:75], v2, s[28:31], s56 offen offset:1536 sc1
    s_add_u32 s56, s44, 12288
    buffer_load_dwordx4 a[76:79], v2, s[28:31], s56 offen offset:1536 sc1
    s_movk_i32 s48, 0x7ff
    s_waitcnt vmcnt(11)
    v_mfma_f32_16x16x32_bf16 v[64:67], v[250:253], a[32:35], v[64:67]
    v_mfma_f32_16x16x32_bf16 v[68:71], v[248:251], a[32:35], v[68:71]
    s_waitcnt vmcnt(10)
    v_mfma_f32_16x16x32_bf16 v[64:67], v[250:253], a[36:39], v[64:67]
    v_mfma_f32_16x16x32_bf16 v[68:71], v[248:251], a[36:39], v[68:71]
    s_waitcnt vmcnt(9)
    v_mfma_f32_16x16x32_bf16 v[64:67], v[250:253], a[40:43], v[64:67]
    v_mfma_f32_16x16x32_bf16 v[68:71], v[248:251], a[40:43], v[68:71]
    s_waitcnt vmcnt(8)
    v_mfma_f32_16x16x32_bf16 v[64:67], v[250:253], a[44:47], v[64:67]
    v_mfma_f32_16x16x32_bf16 v[68:71], v[248:251], a[44:47], v[68:71]
    s_waitcnt vmcnt(7)
    s_nop 5
    v_pk_fma_f32 v[12:13], v[96:97], v[64:65], v[12:13]
    v_pk_fma_f32 v[14:15], v[98:99], v[66:67], v[14:15]
    v_pk_fma_f32 v[16:17], v[100:101], v[68:69], v[16:17]
    v_pk_fma_f32 v[18:19], v[102:103], v[70:71], v[18:19]
    v_cvt_pk_bf16_f32 v36, v12, v13
    v_cvt_pk_bf16_f32 v37, v14, v15
    v_cvt_pk_bf16_f32 v38, v16, v17
    v_cvt_pk_bf16_f32 v39, v18, v19
    v_lshlrev_b32 v12, 16, v36
    v_and_b32 v13, 0xffff0000, v36
    v_lshlrev_b32 v14, 16, v37
    v_and_b32 v15, 0xffff0000, v37
    v_lshlrev_b32 v16, 16, v38
    v_and_b32 v17, 0xffff0000, v38
Ltour1_0:
    s_cbranch_execz Ltour1_4
    v_lshlrev_b32 v18, 16, v39
    v_and_b32 v19, 0xffff0000, v39
    v_pk_add_f32 v[88:89], v[12:13], v[14:15]
    v_pk_add_f32 v[62:63], v[16:17], v[18:19]
    v_pk_add_f32 v[88:89], v[88:89], v[62:63]
    v_add_f32 v88, v88, v89
    s_nop 1
    v_add_f32_dpp v88, v88, v88 row_ror:8 row_mask:0xf bank_mask:0xf
    s_nop 1
    v_add_f32_dpp v88, v88, v88 row_ror:4 row_mask:0xf bank_mask:0xf
    s_nop 1
    v_add_f32_dpp v88, v88, v88 row_ror:2 row_mask:0xf bank_mask:0xf
    s_nop 1
    v_add_f32_dpp v88, v88, v88 row_ror:1 row_mask:0xf bank_mask:0xf
    v_mov_b32 v62, v88
    s_nop 1
    v_permlane16_swap_b32 v88, v62
    s_nop 0
    v_add_f32 v88, v88, v62
    v_mul_f32 v88, 0x3b800000, v88
    v_pk_add_f32 v[232:233], v[28:29], v[88:89] op_sel_hi:[1,0] neg_lo:[0,1] neg_hi:[0,1]
    v_pk_add_f32 v[234:235], v[30:31], v[88:89] op_sel_hi:[1,0] neg_lo:[0,1] neg_hi:[0,1]
    v_pk_add_f32 v[236:237], v[32:33], v[88:89] op_sel_hi:[1,0] neg_lo:[0,1] neg_hi:[0,1]
    v_pk_add_f32 v[238:239], v[34:35], v[88:89] op_sel_hi:[1,0] neg_lo:[0,1] neg_hi:[0,1]
    v_pk_add_f32 v[48:49], v[232:233], v[234:235]
    v_pk_mul_f32 v[50:51], v[232:233], v[232:233]
    v_pk_mul_f32 v[52:53], v[232:233], v[184:185]
    v_pk_fma_f32 v[50:51], v[234:235], v[234:235], v[50:51]
    v_pk_fma_f32 v[52:53], v[234:235], v[186:187], v[52:53]
    v_pk_add_f32 v[48:49], v[48:49], v[236:237]
    v_pk_fma_f32 v[50:51], v[236:237], v[236:237], v[50:51]
    v_pk_fma_f32 v[52:53], v[236:237], v[188:189], v[52:53]
    v_pk_add_f32 v[48:49], v[48:49], v[238:239]
    v_pk_fma_f32 v[50:51], v[238:239], v[238:239], v[50:51]
    v_pk_fma_f32 v[52:53], v[238:239], v[190:191], v[52:53]
    v_cndmask_b32 v48, 0, v48, vcc
    v_cndmask_b32 v49, 0, v49, vcc
    v_cndmask_b32 v50, 0, v50, vcc
    v_cndmask_b32 v51, 0, v51, vcc
    v_pk_add_f32 v[216:217], v[12:13], v[88:89] op_sel_hi:[1,0] neg_lo:[0,1] neg_hi:[0,1]
    v_pk_add_f32 v[218:219], v[14:15], v[88:89] op_sel_hi:[1,0] neg_lo:[0,1] neg_hi:[0,1]
    v_pk_add_f32 v[220:221], v[16:17], v[88:89] op_sel_hi:[1,0] neg_lo:[0,1] neg_hi:[0,1]
    v_pk_add_f32 v[222:223], v[18:19], v[88:89] op_sel_hi:[1,0] neg_lo:[0,1] neg_hi:[0,1]
    v_pk_add_f32 v[48:49], v[48:49], v[216:217]
    v_pk_fma_f32 v[50:51], v[216:217], v[216:217], v[50:51]
    v_pk_fma_f32 v[52:53], v[216:217], v[168:169], v[52:53]
    v_pk_add_f32 v[48:49], v[48:49], v[218:219]
    v_pk_fma_f32 v[50:51], v[218:219], v[218:219], v[50:51]
    v_pk_fma_f32 v[52:53], v[218:219], v[170:171], v[52:53]
    v_pk_add_f32 v[48:49], v[48:49], v[220:221]
    v_pk_fma_f32 v[50:51], v[220:221], v[220:221], v[50:51]
    v_pk_fma_f32 v[52:53], v[220:221], v[172:173], v[52:53]
    v_pk_add_f32 v[48:49], v[48:49], v[222:223]
    v_pk_fma_f32 v[50:51], v[222:223], v[222:223], v[50:51]
    v_pk_fma_f32 v[52:53], v[222:223], v[174:175], v[52:53]
    v_mfma_f32_16x16x32_bf16 v[72:75], v[246:249], a[48:51], 0
    v_mfma_f32_16x16x32_bf16 v[76:79], v[244:247], a[48:51], 0
    s_waitcnt vmcnt(6)
    v_mfma_f32_16x16x32_bf16 v[72:75], v[246:249], a[52:55], v[72:75]
    v_mfma_f32_16x16x32_bf16 v[76:79], v[244:247], a[52:55], v[76:79]
    s_waitcnt vmcnt(5)
    v_mfma_f32_16x16x32_bf16 v[72:75], v[246:249], a[56:59], v[72:75]
    v_mfma_f32_16x16x32_bf16 v[76:79], v[244:247], a[56:59], v[76:79]
    s_waitcnt vmcnt(4)
    v_mfma_f32_16x16x32_bf16 v[72:75], v[246:249], a[60:63], v[72:75]
    v_mfma_f32_16x16x32_bf16 v[76:79], v[244:247], a[60:63], v[76:79]
    s_waitcnt vmcnt(3)
    v_mfma_f32_16x16x32_bf16 v[72:75], v[250:253], a[64:67], v[72:75]
    v_mfma_f32_16x16x32_bf16 v[76:79], v[248:251], a[64:67], v[76:79]
    s_waitcnt vmcnt(2)
    v_mfma_f32_16x16x32_bf16 v[72:75], v[250:253], a[68:71], v[72:75]
    v_mfma_f32_16x16x32_bf16 v[76:79], v[248:251], a[68:71], v[76:79]
    s_waitcnt vmcnt(1)
    v_mfma_f32_16x16x32_bf16 v[72:75], v[250:253], a[72:75], v[72:75]
    v_mfma_f32_16x16x32_bf16 v[76:79], v[248:251], a[72:75], v[76:79]
    s_waitcnt vmcnt(0)
    v_mfma_f32_16x16x32_bf16 v[72:75], v[250:253], a[76:79], v[72:75]
    v_mfma_f32_16x16x32_bf16 v[76:79], v[248:251], a[76:79], v[76:79]
    s_nop 6
    v_pk_fma_f32 v[20:21], v[104:105], v[72:73], v[20:21]
    v_pk_fma_f32 v[22:23], v[106:107], v[74:75], v[22:23]
    v_pk_fma_f32 v[24:25], v[108:109], v[76:77], v[24:25]
    v_pk_fma_f32 v[26:27], v[110:111], v[78:79], v[26:27]
    v_cvt_pk_bf16_f32 v40, v20, v21
    v_cvt_pk_bf16_f32 v41, v22, v23
    v_cvt_pk_bf16_f32 v42, v24, v25
    v_cvt_pk_bf16_f32 v43, v26, v27
    v_lshlrev_b32 v20, 16, v40
    v_and_b32 v21, 0xffff0000, v40
    v_lshlrev_b32 v22, 16, v41
    v_and_b32 v23, 0xffff0000, v41
    v_lshlrev_b32 v24, 16, v42
    v_and_b32 v25, 0xffff0000, v42
    v_lshlrev_b32 v26, 16, v43
    v_and_b32 v27, 0xffff0000, v43
    v_pk_add_f32 v[224:225], v[20:21], v[88:89] op_sel_hi:[1,0] neg_lo:[0,1] neg_hi:[0,1]
    v_pk_add_f32 v[226:227], v[22:23], v[88:89] op_sel_hi:[1,0] neg_lo:[0,1] neg_hi:[0,1]
    v_pk_add_f32 v[228:229], v[24:25], v[88:89] op_sel_hi:[1,0] neg_lo:[0,1] neg_hi:[0,1]
    v_pk_add_f32 v[230:231], v[26:27], v[88:89] op_sel_hi:[1,0] neg_lo:[0,1] neg_hi:[0,1]
    v_pk_add_f32 v[48:49], v[48:49], v[224:225]
    v_pk_fma_f32 v[50:51], v[224:225], v[224:225], v[50:51]
    v_pk_fma_f32 v[52:53], v[224:225], v[176:177], v[52:53]
    v_pk_add_f32 v[48:49], v[48:49], v[226:227]
    v_pk_fma_f32 v[50:51], v[226:227], v[226:227], v[50:51]
    v_pk_fma_f32 v[52:53], v[226:227], v[178:179], v[52:53]
    v_pk_add_f32 v[48:49], v[48:49], v[228:229]
    v_pk_fma_f32 v[50:51], v[228:229], v[228:229], v[50:51]
    v_pk_fma_f32 v[52:53], v[228:229], v[180:181], v[52:53]
    v_pk_add_f32 v[48:49], v[48:49], v[230:231]
    v_pk_fma_f32 v[50:51], v[230:231], v[230:231], v[50:51]
    v_pk_fma_f32 v[52:53], v[230:231], v[182:183], v[52:53]
    v_add_f32 v48, v48, v49
    v_add_f32 v50, v50, v51
    v_add_f32 v52, v52, v53
    v_add_f32_dpp v48, v48, v48 row_ror:8 row_mask:0xf bank_mask:0xf
    v_add_f32_dpp v50, v50, v50 row_ror:8 row_mask:0xf bank_mask:0xf
    v_add_f32_dpp v52, v52, v52 row_ror:8 row_mask:0xf bank_mask:0xf
    v_add_f32_dpp v48, v48, v48 row_ror:4 row_mask:0xf bank_mask:0xf
    v_add_f32_dpp v50, v50, v50 row_ror:4 row_mask:0xf bank_mask:0xf
    v_add_f32_dpp v52, v52, v52 row_ror:4 row_mask:0xf bank_mask:0xf
    v_add_f32_dpp v48, v48, v48 row_ror:2 row_mask:0xf bank_mask:0xf
    v_add_f32_dpp v50, v50, v50 row_ror:2 row_mask:0xf bank_mask:0xf
    v_add_f32_dpp v52, v52, v52 row_ror:2 row_mask:0xf bank_mask:0xf
    v_add_f32_dpp v48, v48, v48 row_ror:1 row_mask:0xf bank_mask:0xf
    v_add_f32_dpp v50, v50, v50 row_ror:1 row_mask:0xf bank_mask:0xf
    v_add_f32_dpp v52, v52, v52 row_ror:1 row_mask:0xf bank_mask:0xf
    v_mov_b32 v49, v48
    v_mov_b32 v51, v50
    v_mov_b32 v53, v52
    v_permlane16_swap_b32 v48, v49
    v_permlane16_swap_b32 v50, v51
    v_permlane16_swap_b32 v52, v53
    v_add_f32 v48, v48, v49
    v_add_f32 v50, v50, v51
    v_add_f32 v52, v52, v53
    v_mul_f32 v48, 0x3ae38e39, v48
    v_mul_f32 v50, 0x3ae38e39, v50
    v_fma_f32 v50, -v48, v48, v50
    v_add_f32 v48, v48, v88
    v_max_f32 v50, 0, v50
    v_cvt_pk_bf16_f32 v48, v48, v50
    v_and_b32 v50, 0xffff0000, v48
    v_lshlrev_b32 v48, 16, v48
    v_add_f32 v50, 0x3727c5ac, v50
    v_sub_f32 v48, v88, v48
    v_cvt_pk_bf16_f32 v50, v50, v50
    v_and_b32 v50, 0xffff0000, v50
    v_sqrt_f32 v50, v50
    v_fmac_f32 v52, v48, v90
    v_cvt_pk_bf16_f32 v50, v50, v50
    v_and_b32 v50, 0xffff0000, v50
    v_rcp_f32 v50, v50
    s_mov_b32 exec_lo, 1
    s_mov_b32 exec_hi, 1
    v_fma_f32 v52, v52, v50, v91
    v_ashrrev_i32 v62, 31, v52
    v_or_b32 v62, 0x80000000, v62
    v_xor_b32 v52, v62, v52
    v_min_u32 v52, 0xfffff000, v52
    v_bfi_b32 v52, s48, v93, v52
    ds_write_b32 v92, v52 offset:36864
    s_mov_b64 exec, -1
    v_mul_f32 v48, v48, v50
    s_waitcnt lgkmcnt(0)
    s_barrier
    v_mov_b32 v109, 36864
    ds_read_b128 v[96:99], v109
    ds_read_b128 v[100:103], v109 offset:16
    s_lshl_b32 s45, s2, 7
    s_add_u32 s45, s45, 9306112
    s_cmp_eq_u32 s3, 0
    s_cselect_b32 s45, s45, 2147483648
    s_waitcnt lgkmcnt(1)
    v_max_u32 v104, v96, v97
    v_min_u32 v105, v96, v97
    v_med3_u32 v105, v104, v105, v98
    v_max_u32 v104, v104, v98
    v_med3_u32 v105, v104, v105, v99
    v_max_u32 v104, v104, v99
    s_waitcnt lgkmcnt(0)
    v_med3_u32 v105, v104, v105, v100
    v_max_u32 v104, v104, v100
    v_med3_u32 v105, v104, v105, v101
    v_max_u32 v104, v104, v101
    v_med3_u32 v105, v104, v105, v102
    v_max_u32 v104, v104, v102
    v_med3_u32 v105, v104, v105, v103
    v_max_u32 v104, v104, v103
    buffer_store_dwordx2 v[104:105], v8, s[24:27], s45 offen sc1
    v_pk_fma_f32 v[216:217], v[216:217], v[50:51], v[48:49] op_sel_hi:[1,0,0]
    v_pk_fma_f32 v[218:219], v[218:219], v[50:51], v[48:49] op_sel_hi:[1,0,0]
    v_pk_fma_f32 v[220:221], v[220:221], v[50:51], v[48:49] op_sel_hi:[1,0,0]
    v_pk_fma_f32 v[222:223], v[222:223], v[50:51], v[48:49] op_sel_hi:[1,0,0]
    v_pk_fma_f32 v[224:225], v[224:225], v[50:51], v[48:49] op_sel_hi:[1,0,0]
    v_pk_fma_f32 v[226:227], v[226:227], v[50:51], v[48:49] op_sel_hi:[1,0,0]
    v_pk_fma_f32 v[228:229], v[228:229], v[50:51], v[48:49] op_sel_hi:[1,0,0]
    v_pk_fma_f32 v[230:231], v[230:231], v[50:51], v[48:49] op_sel_hi:[1,0,0]
    v_pk_fma_f32 v[232:233], v[232:233], v[50:51], v[48:49] op_sel_hi:[1,0,0]
    v_pk_fma_f32 v[234:235], v[234:235], v[50:51], v[48:49] op_sel_hi:[1,0,0]
    v_pk_fma_f32 v[236:237], v[236:237], v[50:51], v[48:49] op_sel_hi:[1,0,0]
    v_pk_fma_f32 v[238:239], v[238:239], v[50:51], v[48:49] op_sel_hi:[1,0,0]
    v_pk_fma_f32 v[216:217], v[216:217], v[120:121], v[144:145]
    v_pk_fma_f32 v[218:219], v[218:219], v[122:123], v[146:147]
    v_pk_fma_f32 v[220:221], v[220:221], v[124:125], v[148:149]
    v_pk_fma_f32 v[222:223], v[222:223], v[126:127], v[150:151]
    v_pk_fma_f32 v[224:225], v[224:225], v[128:129], v[152:153]
    v_pk_fma_f32 v[226:227], v[226:227], v[130:131], v[154:155]
    v_pk_fma_f32 v[228:229], v[228:229], v[132:133], v[156:157]
    v_pk_fma_f32 v[230:231], v[230:231], v[134:135], v[158:159]
    v_pk_fma_f32 v[232:233], v[232:233], v[136:137], v[160:161]
    v_pk_fma_f32 v[234:235], v[234:235], v[138:139], v[162:163]
    v_pk_fma_f32 v[236:237], v[236:237], v[140:141], v[164:165]
    v_pk_fma_f32 v[238:239], v[238:239], v[142:143], v[166:167]
    v_cvt_pk_bf16_f32 v64, v216, v217
    v_cvt_pk_bf16_f32 v65, v218, v219
    v_cvt_pk_bf16_f32 v66, v220, v221
    v_cvt_pk_bf16_f32 v67, v222, v223
    v_cvt_pk_bf16_f32 v68, v224, v225
    v_cvt_pk_bf16_f32 v69, v226, v227
    v_cvt_pk_bf16_f32 v70, v228, v229
    v_cvt_pk_bf16_f32 v71, v230, v231
    v_cvt_pk_bf16_f32 v72, v232, v233
    v_cvt_pk_bf16_f32 v73, v234, v235
    v_cvt_pk_bf16_f32 v74, v236, v237
    v_cvt_pk_bf16_f32 v75, v238, v239
    v_and_b32 v106, 0x7ff, v104
    v_and_b32 v107, 0x7ff, v105
    v_cmp_eq_u32 vcc, v106, v93
    v_cmp_eq_u32 s[36:37], v107, v93
    v_mov_b32 v106, 2147483648
    s_or_b64 vcc, vcc, s[36:37]
    s_mov_b32 s45, 2621440
    s_nop 0
    v_cndmask_b32 v6, v106, v6, vcc
    v_cndmask_b32 v60, v106, v60, vcc
    buffer_store_dwordx4 v[64:67], v6, s[24:27], s45 offen offset:0 sc1
    buffer_store_dwordx4 v[68:71], v6, s[24:27], s45 offen offset:512 sc1
    buffer_store_dwordx4 v[72:75], v60, s[24:27], s45 offen offset:1024 sc1
    s_cmp_ge_u32 s41, 18
    s_cbranch_scc1 Ltail_idle
    s_mov_b32 s36, 2622592
    buffer_store_dwordx4 v[36:39], v6, s[24:27], s36 offen offset:0 sc1
    buffer_store_dwordx4 v[40:43], v6, s[24:27], s36 offen offset:512 sc1
    buffer_store_dwordx4 v[44:47], v60, s[24:27], s36 offen offset:1024 sc1
    v_lshlrev_b32 v216, 16, v64
    v_and_b32 v217, 0xffff0000, v64
    v_lshlrev_b32 v218, 16, v65
    v_and_b32 v219, 0xffff0000, v65
    v_lshlrev_b32 v220, 16, v66
    v_and_b32 v221, 0xffff0000, v66
    v_lshlrev_b32 v222, 16, v67
    v_and_b32 v223, 0xffff0000, v67
    v_lshlrev_b32 v224, 16, v68
    v_and_b32 v225, 0xffff0000, v68
    v_lshlrev_b32 v226, 16, v69
    v_and_b32 v227, 0xffff0000, v69
    v_lshlrev_b32 v228, 16, v70
    v_and_b32 v229, 0xffff0000, v70
    v_lshlrev_b32 v230, 16, v71
    v_and_b32 v231, 0xffff0000, v71
    v_lshlrev_b32 v232, 16, v72
    v_and_b32 v233, 0xffff0000, v72
    v_lshlrev_b32 v234, 16, v73
    v_and_b32 v235, 0xffff0000, v73
    v_lshlrev_b32 v236, 16, v74
    v_and_b32 v237, 0xffff0000, v74
    v_lshlrev_b32 v238, 16, v75
    v_and_b32 v239, 0xffff0000, v75
    v_pk_mul_f32 v[192:193], v[192:193], v[216:217]
    v_pk_mul_f32 v[194:195], v[194:195], v[218:219]
    v_pk_mul_f32 v[196:197], v[196:197], v[220:221]
    v_pk_mul_f32 v[198:199], v[198:199], v[222:223]
    v_pk_mul_f32 v[200:201], v[200:201], v[224:225]
    v_pk_mul_f32 v[202:203], v[202:203], v[226:227]
    v_pk_mul_f32 v[204:205], v[204:205], v[228:229]
    v_pk_mul_f32 v[206:207], v[206:207], v[230:231]
    v_pk_mul_f32 v[208:209], v[208:209], v[232:233]
    v_pk_mul_f32 v[210:211], v[210:211], v[234:235]
    v_pk_mul_f32 v[212:213], v[212:213], v[236:237]
    v_pk_mul_f32 v[214:215], v[214:215], v[238:239]
    v_cvt_pk_bf16_f32 v144, v192, v193
    v_cvt_pk_bf16_f32 v145, v194, v195
    v_cvt_pk_bf16_f32 v146, v196, v197
    v_cvt_pk_bf16_f32 v147, v198, v199
    v_cvt_pk_bf16_f32 v148, v200, v201
    v_cvt_pk_bf16_f32 v149, v202, v203
    v_cvt_pk_bf16_f32 v150, v204, v205
    v_cvt_pk_bf16_f32 v151, v206, v207
    v_cvt_pk_bf16_f32 v152, v208, v209
    v_cvt_pk_bf16_f32 v153, v210, v211
    v_cvt_pk_bf16_f32 v154, v212, v213
    v_cvt_pk_bf16_f32 v155, v214, v215
    v_lshlrev_b32 v192, 16, v144
    v_and_b32 v193, 0xffff0000, v144
    v_lshlrev_b32 v194, 16, v145
    v_and_b32 v195, 0xffff0000, v145
    v_lshlrev_b32 v196, 16, v146
    v_and_b32 v197, 0xffff0000, v146
    v_lshlrev_b32 v198, 16, v147
    v_and_b32 v199, 0xffff0000, v147
    v_lshlrev_b32 v200, 16, v148
    v_and_b32 v201, 0xffff0000, v148
    v_lshlrev_b32 v202, 16, v149
    v_and_b32 v203, 0xffff0000, v149
    v_lshlrev_b32 v204, 16, v150
    v_and_b32 v205, 0xffff0000, v150
    v_lshlrev_b32 v206, 16, v151
    v_and_b32 v207, 0xffff0000, v151
    v_lshlrev_b32 v208, 16, v152
    v_and_b32 v209, 0xffff0000, v152
    v_lshlrev_b32 v210, 16, v153
    v_and_b32 v211, 0xffff0000, v153
    v_lshlrev_b32 v212, 16, v154
    v_and_b32 v213, 0xffff0000, v154
    v_lshlrev_b32 v214, 16, v155
    v_and_b32 v215, 0xffff0000, v155
    v_pk_add_f32 v[192:193], v[192:193], v[12:13]
    v_pk_add_f32 v[194:195], v[194:195], v[14:15]
    v_pk_add_f32 v[196:197], v[196:197], v[16:17]
    v_pk_add_f32 v[198:199], v[198:199], v[18:19]
    v_pk_add_f32 v[200:201], v[200:201], v[20:21]
    v_pk_add_f32 v[202:203], v[202:203], v[22:23]
    v_pk_add_f32 v[204:205], v[204:205], v[24:25]
    v_pk_add_f32 v[206:207], v[206:207], v[26:27]
    v_pk_add_f32 v[208:209], v[208:209], v[28:29]
    v_pk_add_f32 v[210:211], v[210:211], v[30:31]
    v_pk_add_f32 v[212:213], v[212:213], v[32:33]
    v_pk_add_f32 v[214:215], v[214:215], v[34:35]
    v_cvt_pk_bf16_f32 v156, v192, v193
    v_cvt_pk_bf16_f32 v157, v194, v195
    v_cvt_pk_bf16_f32 v158, v196, v197
    v_cvt_pk_bf16_f32 v159, v198, v199
    v_cvt_pk_bf16_f32 v160, v200, v201
    v_cvt_pk_bf16_f32 v161, v202, v203
    v_cvt_pk_bf16_f32 v162, v204, v205
    v_cvt_pk_bf16_f32 v163, v206, v207
    v_cvt_pk_bf16_f32 v164, v208, v209
    v_cvt_pk_bf16_f32 v165, v210, v211
    v_cvt_pk_bf16_f32 v166, v212, v213
    v_cvt_pk_bf16_f32 v167, v214, v215
    v_and_b32 v30, 2, v1
    v_cmp_ne_u32 vcc, 0, v30
    v_mul_u32_u24 v30, 1152, v7
    v_add_u32 v4, v30, v5
    v_add_u32 v58, v30, v59
    v_mov_b32_dpp v192, v158 quad_perm:[0,2,0,2] row_mask:0xf bank_mask:0xf
    v_mov_b32_dpp v193, v159 quad_perm:[0,2,0,2] row_mask:0xf bank_mask:0xf
    v_mov_b32_dpp v194, v158 quad_perm:[1,3,1,3] row_mask:0xf bank_mask:0xf
    v_mov_b32_dpp v195, v159 quad_perm:[1,3,1,3] row_mask:0xf bank_mask:0xf
    v_mov_b32_dpp v196, v162 quad_perm:[0,2,0,2] row_mask:0xf bank_mask:0xf
    v_mov_b32_dpp v197, v163 quad_perm:[0,2,0,2] row_mask:0xf bank_mask:0xf
    v_mov_b32_dpp v198, v162 quad_perm:[1,3,1,3] row_mask:0xf bank_mask:0xf
    v_mov_b32_dpp v199, v163 quad_perm:[1,3,1,3] row_mask:0xf bank_mask:0xf
    v_mov_b32_dpp v200, v166 quad_perm:[0,2,0,2] row_mask:0xf bank_mask:0xf
    v_mov_b32_dpp v201, v167 quad_perm:[0,2,0,2] row_mask:0xf bank_mask:0xf
    v_mov_b32_dpp v202, v166 quad_perm:[1,3,1,3] row_mask:0xf bank_mask:0xf
    v_mov_b32_dpp v203, v167 quad_perm:[1,3,1,3] row_mask:0xf bank_mask:0xf
    v_cndmask_b32_dpp v144, v156, v192, vcc quad_perm:[0,2,0,2] row_mask:0xf bank_mask:0xf
    v_cndmask_b32_dpp v145, v157, v193, vcc quad_perm:[0,2,0,2] row_mask:0xf bank_mask:0xf
    v_cndmask_b32_dpp v146, v156, v194, vcc quad_perm:[1,3,1,3] row_mask:0xf bank_mask:0xf
    v_cndmask_b32_dpp v147, v157, v195, vcc quad_perm:[1,3,1,3] row_mask:0xf bank_mask:0xf
    v_cndmask_b32_dpp v148, v160, v196, vcc quad_perm:[0,2,0,2] row_mask:0xf bank_mask:0xf
    v_cndmask_b32_dpp v149, v161, v197, vcc quad_perm:[0,2,0,2] row_mask:0xf bank_mask:0xf
    v_cndmask_b32_dpp v150, v160, v198, vcc quad_perm:[1,3,1,3] row_mask:0xf bank_mask:0xf
    v_cndmask_b32_dpp v151, v161, v199, vcc quad_perm:[1,3,1,3] row_mask:0xf bank_mask:0xf
    v_cndmask_b32_dpp v152, v164, v200, vcc quad_perm:[0,2,0,2] row_mask:0xf bank_mask:0xf
    v_cndmask_b32_dpp v153, v165, v201, vcc quad_perm:[0,2,0,2] row_mask:0xf bank_mask:0xf
    v_cndmask_b32_dpp v154, v164, v202, vcc quad_perm:[1,3,1,3] row_mask:0xf bank_mask:0xf
    v_cndmask_b32_dpp v155, v165, v203, vcc quad_perm:[1,3,1,3] row_mask:0xf bank_mask:0xf
    v_lshlrev_b32 v13, 4, v1
    v_add_u32 v13, 32768, v13
    s_lshl_b32 s44, s3, 10
    v_add_u32 v14, s44, v13
    v_and_b32 v13, 0xffffff1f, v13
    v_bfe_u32 v15, v1, 2, 2
    v_cmp_eq_u32 s[52:53], 0, v15
    v_cmp_eq_u32 s[54:55], 1, v15
    v_cmp_eq_u32 s[56:57], 2, v15
    v_cmp_eq_u32 s[58:59], 3, v15
    s_mul_i32 s43, s42, 18
    s_add_u32 s43, s43, s41
    s_lshl_b32 s43, s43, 9
    s_mul_i32 s44, s3, 73728
    s_add_u32 s43, s43, s44
    v_lshlrev_b32 v15, 3, v1
    s_cmp_lt_u32 s3, 2
    s_cselect_b32 s36, 0xbfb8aa3b, 0
    s_cselect_b32 s37, 1.0, 0
    v_mov_b32 v40, s36
    v_mov_b32 v41, s37
    v_and_b32 v10, 1, v1
    v_and_b32 v9, 48, v1
    s_mul_i32 s38, s3, 3072
    s_add_u32 s38, s38, 49152
    v_lshl_add_u32 v11, v10, 9, v9
    v_add_u32 v11, s38, v11
    v_lshrrev_b32 v10, 5, v1
    v_and_b32 v9, 31, v1
    v_lshlrev_b32 v9, 4, v9
    v_lshlrev_b32 v108, 7, v0
    s_mov_b32 s45, 9306112
    s_lshl_b32 s36, s3, 3
    v_mov_b32 v109, s36
    s_mov_b32 s48, 262144
Ltail_pollk:
    buffer_load_dwordx2 v[104:105], v108, s[24:27], s45 offen sc1
    s_sub_u32 s48, s48, 1
    s_cbranch_scc1 Ltail_gotk
    s_waitcnt vmcnt(0)
    v_max_u32 v106, v104, v105
    v_cmp_eq_u32 vcc, -1, v106
    s_cbranch_vccnz Ltail_pollk
Ltail_gotk:
    s_waitcnt vmcnt(0)
    v_mov_b32_dpp v106, v104 row_ror:1 row_mask:0xf bank_mask:0xf
    v_mov_b32_dpp v107, v105 row_ror:1 row_mask:0xf bank_mask:0xf
    v_min_u32 v110, v104, v106
    v_max_u32 v104, v104, v106
    v_max3_u32 v105, v110, v105, v107
    s_nop 0
    v_mov_b32_dpp v106, v104 row_ror:2 row_mask:0xf bank_mask:0xf
    v_mov_b32_dpp v107, v105 row_ror:2 row_mask:0xf bank_mask:0xf
    v_min_u32 v110, v104, v106
    v_max_u32 v104, v104, v106
    v_max3_u32 v105, v110, v105, v107
    s_nop 0
    v_mov_b32_dpp v106, v104 row_ror:4 row_mask:0xf bank_mask:0xf
    v_mov_b32_dpp v107, v105 row_ror:4 row_mask:0xf bank_mask:0xf
    v_min_u32 v110, v104, v106
    v_max_u32 v104, v104, v106
    v_max3_u32 v105, v110, v105, v107
    s_nop 0
    v_mov_b32_dpp v106, v104 row_ror:8 row_mask:0xf bank_mask:0xf
    v_mov_b32_dpp v107, v105 row_ror:8 row_mask:0xf bank_mask:0xf
    v_min_u32 v110, v104, v106
    v_max_u32 v104, v104, v106
    v_max3_u32 v105, v110, v105, v107
    v_mov_b32 v106, v104
    v_mov_b32 v107, v105
    s_nop 0
    v_permlane16_swap_b32 v104, v106
    v_permlane16_swap_b32 v105, v107
    v_min_u32 v110, v104, v106
    v_max_u32 v104, v104, v106
    v_max3_u32 v105, v110, v105, v107
    v_mov_b32 v106, v104
    v_mov_b32 v107, v105
    s_nop 0
    v_permlane32_swap_b32 v104, v106
    v_permlane32_swap_b32 v105, v107
    v_min_u32 v110, v104, v106
    v_max_u32 v104, v104, v106
    v_max3_u32 v105, v110, v105, v107
    ds_write_b64 v109, v[104:105] offset:36928
    v_mov_b32 v109, 36928
    s_waitcnt lgkmcnt(0)
    s_barrier
    ds_read_b128 v[96:99], v109
    ds_read_b128 v[100:103], v109 offset:16
    s_waitcnt lgkmcnt(1)
    v_max_u32 v104, v96, v97
    v_min_u32 v105, v96, v97
    v_med3_u32 v105, v104, v105, v98
    v_max_u32 v104, v104, v98
    v_med3_u32 v105, v104, v105, v99
    v_max_u32 v104, v104, v99
    s_waitcnt lgkmcnt(0)
    v_med3_u32 v105, v104, v105, v100
    v_max_u32 v104, v104, v100
    v_med3_u32 v105, v104, v105, v101
    v_max_u32 v104, v104, v101
    v_med3_u32 v105, v104, v105, v102
    v_max_u32 v104, v104, v102
    v_med3_u32 v105, v104, v105, v103
    v_max_u32 v104, v104, v103
    s_nop 0
    v_readfirstlane_b32 s92, v104
    v_readfirstlane_b32 s93, v105
    s_andn2_b32 s46, 0x7ff, s92
    s_andn2_b32 s47, 0x7ff, s93
    s_mul_i32 s44, s46, 2304
    s_mul_i32 s45, s47, 2304
    s_sub_u32 s45, s45, s44
    v_mad_i32_i24 v10, v10, s45, v9
    s_add_u32 s45, s44, 2621440
    v_add_u32 v10, s45, v10
    s_mov_b32 s48, 16384
Ltail_pollh:
    s_mov_b32 exec_lo, 0xffffff
    s_mov_b32 exec_hi, 0xffffff
    s_add_u32 m0, s38, 0
    s_nop 0
    buffer_load_dwordx4 v10, s[24:27], 0 offen offset:0 sc1 lds
    s_add_u32 m0, s38, 640
    s_nop 0
    buffer_load_dwordx4 v10, s[24:27], 0 offen offset:384 sc1 lds
    s_add_u32 m0, s38, 1280
    s_nop 0
    buffer_load_dwordx4 v10, s[24:27], 0 offen offset:768 sc1 lds
    s_mov_b64 exec, -1
    s_waitcnt vmcnt(0)
    ds_read_b128 a[0:3], v11 offset:0
    ds_read_b128 a[4:7], v11 offset:64
    ds_read_b128 a[8:11], v11 offset:128
    ds_read_b128 a[12:15], v11 offset:192
    ds_read_b128 a[16:19], v11 offset:256
    ds_read_b128 a[20:23], v11 offset:320
    ds_read_b128 a[24:27], v11 offset:1024
    ds_read_b128 a[28:31], v11 offset:1088
    ds_read_b128 a[32:35], v11 offset:1152
    ds_read_b128 a[36:39], v11 offset:1216
    ds_read_b128 a[40:43], v11 offset:1280
    ds_read_b128 a[44:47], v11 offset:1344
    ds_read_b128 a[48:51], v11 offset:2048
    ds_read_b128 a[52:55], v11 offset:2112
    ds_read_b128 a[56:59], v11 offset:2176
    ds_read_b128 a[60:63], v11 offset:2240
    ds_read_b128 a[64:67], v11 offset:2304
    ds_read_b128 a[68:71], v11 offset:2368
    s_waitcnt lgkmcnt(15)
    v_mfma_f32_16x16x32_bf16 v[16:19], a[96:99], a[0:3], 0
    v_mfma_f32_16x16x32_bf16 v[20:23], a[100:103], a[4:7], 0
    v_mfma_f32_16x16x32_bf16 v[16:19], a[104:107], a[8:11], v[16:19]
    s_waitcnt lgkmcnt(14)
    v_mfma_f32_16x16x32_bf16 v[20:23], a[108:111], a[12:15], v[20:23]
    s_waitcnt lgkmcnt(13)
    v_mfma_f32_16x16x32_bf16 v[16:19], a[112:115], a[16:19], v[16:19]
    s_waitcnt lgkmcnt(12)
    v_mfma_f32_16x16x32_bf16 v[20:23], a[116:119], a[20:23], v[20:23]
    s_waitcnt lgkmcnt(11)
    v_mfma_f32_16x16x32_bf16 v[16:19], a[120:123], a[24:27], v[16:19]
    s_waitcnt lgkmcnt(10)
    v_mfma_f32_16x16x32_bf16 v[20:23], a[124:127], a[28:31], v[20:23]
    s_waitcnt lgkmcnt(9)
    v_mfma_f32_16x16x32_bf16 v[16:19], a[128:131], a[32:35], v[16:19]
    s_waitcnt lgkmcnt(8)
    v_mfma_f32_16x16x32_bf16 v[20:23], a[132:135], a[36:39], v[20:23]
    s_waitcnt lgkmcnt(7)
    v_mfma_f32_16x16x32_bf16 v[16:19], a[136:139], a[40:43], v[16:19]
    s_waitcnt lgkmcnt(6)
    v_mfma_f32_16x16x32_bf16 v[20:23], a[140:143], a[44:47], v[20:23]
    s_waitcnt lgkmcnt(5)
    v_mfma_f32_16x16x32_bf16 v[16:19], a[144:147], a[48:51], v[16:19]
    s_waitcnt lgkmcnt(4)
    v_mfma_f32_16x16x32_bf16 v[20:23], a[148:151], a[52:55], v[20:23]
    s_waitcnt lgkmcnt(3)
    v_mfma_f32_16x16x32_bf16 v[16:19], a[152:155], a[56:59], v[16:19]
    s_waitcnt lgkmcnt(2)
    v_mfma_f32_16x16x32_bf16 v[20:23], a[156:159], a[60:63], v[20:23]
    s_waitcnt lgkmcnt(1)
    v_mfma_f32_16x16x32_bf16 v[16:19], a[160:163], a[64:67], v[16:19]
    s_waitcnt lgkmcnt(0)
    v_mfma_f32_16x16x32_bf16 v[20:23], a[164:167], a[68:71], v[20:23]
    s_sub_u32 s48, s48, 1
    s_nop 6
    v_pk_add_f32 v[16:17], v[16:17], v[20:21]
    v_pk_add_f32 v[18:19], v[18:19], v[22:23]
    s_cbranch_scc1 Ltail_goth
    v_cmp_u_f32 vcc, v16, v16
    s_and_b32 s36, vcc_lo, 3
    s_cbranch_scc1 Ltail_pollh
Ltail_goth:
    v_cvt_pk_bf16_f32 v32, v16, v17
    v_cvt_pk_bf16_f32 v33, v18, v19
    v_lshlrev_b32 v16, 16, v32
    v_and_b32 v17, 0xffff0000, v32
    v_lshlrev_b32 v18, 16, v33
    v_and_b32 v19, 0xffff0000, v33
    v_pk_mul_f32 v[32:33], v[16:17], v[40:41] op_sel_hi:[1,0]
    v_pk_mul_f32 v[34:35], v[18:19], v[40:41] op_sel_hi:[1,0]
    v_exp_f32 v32, v32
    v_exp_f32 v33, v33
    v_exp_f32 v34, v34
    v_exp_f32 v35, v35
    v_fma_f32 v32, v32, v41, 1.0
    v_fma_f32 v33, v33, v41, 1.0
    v_fma_f32 v34, v34, v41, 1.0
    v_fma_f32 v35, v35, v41, 1.0
    v_rcp_f32 v32, v32
    v_rcp_f32 v33, v33
    v_rcp_f32 v34, v34
    v_rcp_f32 v35, v35
    v_pk_mul_f32 v[16:17], v[16:17], v[32:33]
    v_pk_mul_f32 v[18:19], v[18:19], v[34:35]
    v_cvt_pk_bf16_f32 v32, v16, v17
    v_cvt_pk_bf16_f32 v33, v18, v19
    v_lshlrev_b32 v16, 16, v32
    v_and_b32 v17, 0xffff0000, v32
    v_lshlrev_b32 v18, 16, v33
    v_and_b32 v19, 0xffff0000, v33
    ds_write_b128 v14, v[16:19]
    s_waitcnt lgkmcnt(0)
    s_barrier
    ds_read_b128 v[16:19], v13 offset:0
    ds_read_b128 v[24:27], v13 offset:2048
    ds_read_b128 v[20:23], v13 offset:1024
    ds_read_b128 v[28:31], v13 offset:3072
    s_waitcnt lgkmcnt(2)
    v_pk_mul_f32 v[16:17], v[16:17], v[24:25]
    v_pk_mul_f32 v[18:19], v[18:19], v[26:27]
    v_cvt_pk_bf16_f32 v32, v16, v17
    v_cvt_pk_bf16_f32 v33, v18, v19
    s_waitcnt lgkmcnt(0)
    v_pk_mul_f32 v[20:21], v[20:21], v[28:29]
    v_pk_mul_f32 v[22:23], v[22:23], v[30:31]
    v_cvt_pk_bf16_f32 v34, v20, v21
    v_cvt_pk_bf16_f32 v35, v22, v23
    v_cndmask_b32 v64, 0, v32, s[52:53]
    v_cndmask_b32 v65, 0, v33, s[52:53]
    v_cndmask_b32 v66, 0, v34, s[52:53]
    v_cndmask_b32 v67, 0, v35, s[52:53]
    s_nop 1
    v_mfma_f32_16x16x32_bf16 v[16:19], v[64:67], a[168:171], 0
    v_cndmask_b32 v68, 0, v32, s[54:55]
    v_cndmask_b32 v69, 0, v33, s[54:55]
    v_mfma_f32_16x16x32_bf16 v[20:23], v[64:67], a[184:187], 0
    v_cndmask_b32 v70, 0, v34, s[54:55]
    v_cndmask_b32 v71, 0, v35, s[54:55]
    v_mfma_f32_16x16x32_bf16 v[24:27], v[64:67], a[200:203], 0
    s_nop 0
    v_mfma_f32_16x16x32_bf16 v[16:19], v[68:71], a[172:175], v[16:19]
Ltour1_1:
    s_cbranch_execz Lmain1
    v_cndmask_b32 v72, 0, v32, s[56:57]
    v_cndmask_b32 v73, 0, v33, s[56:57]
    v_mfma_f32_16x16x32_bf16 v[20:23], v[68:71], a[188:191], v[20:23]
    v_cndmask_b32 v74, 0, v34, s[56:57]
    v_cndmask_b32 v75, 0, v35, s[56:57]
    v_mfma_f32_16x16x32_bf16 v[24:27], v[68:71], a[204:207], v[24:27]
    s_nop 0
    v_mfma_f32_16x16x32_bf16 v[16:19], v[72:75], a[176:179], v[16:19]
    v_cndmask_b32 v76, 0, v32, s[58:59]
    v_cndmask_b32 v77, 0, v33, s[58:59]
    v_mfma_f32_16x16x32_bf16 v[20:23], v[72:75], a[192:195], v[20:23]
    v_cndmask_b32 v78, 0, v34, s[58:59]
    v_cndmask_b32 v79, 0, v35, s[58:59]
    v_mfma_f32_16x16x32_bf16 v[24:27], v[72:75], a[208:211], v[24:27]
    s_nop 0
    v_mfma_f32_16x16x32_bf16 v[16:19], v[76:79], a[180:183], v[16:19]
    v_mfma_f32_16x16x32_bf16 v[20:23], v[76:79], a[196:199], v[20:23]
    v_mfma_f32_16x16x32_bf16 v[24:27], v[76:79], a[212:215], v[24:27]
    s_nop 5
    v_min_u32 v16, -2, v16
    v_min_u32 v17, -2, v17
    buffer_store_dwordx2 v[16:17], v15, s[8:11], s43 offen sc1
    s_add_u32 s43, s43, 294912
    v_min_u32 v20, -2, v20
    v_min_u32 v21, -2, v21
    buffer_store_dwordx2 v[20:21], v15, s[8:11], s43 offen sc1
    s_add_u32 s43, s43, 294912
    v_min_u32 v24, -2, v24
    v_min_u32 v25, -2, v25
    buffer_store_dwordx2 v[24:25], v15, s[8:11], s43 offen sc1
    s_or_b32 s36, s2, s3
    s_cselect_b32 s37, -4, 24576
    s_add_u32 s36, s94, 1
    v_mov_b32 v106, s36
    buffer_store_dword v106, v8, s[24:27], s37 offen sc1
    v_cmp_ne_u32 vcc, s46, v7
    v_cmp_ne_u32 s[36:37], s47, v7
    v_mov_b32 v31, 2147483648
    s_and_b64 vcc, vcc, s[36:37]
    s_nop 1
    v_cndmask_b32 v30, v31, v58, vcc
    v_cndmask_b32 v31, v31, v4, vcc
    buffer_store_dwordx4 v[144:147], v31, s[16:19], 0 offen offset:0 nt
    buffer_store_dwordx4 v[148:151], v31, s[16:19], 0 offen offset:512 nt
    buffer_store_dwordx4 v[152:155], v30, s[16:19], 0 offen offset:1024 nt
    s_cmp_lt_u32 s41, 9
    s_cselect_b32 s36, s3, 0
    s_cmp_lg_u32 s36, 3
    s_cbranch_scc1 Ltail_done
    s_mul_i32 s43, s42, 9
    s_add_u32 s43, s43, s41
    v_bfe_u32 v8, v1, 2, 1
    v_cmp_eq_u32 vcc, 1, v8
    v_mov_b32 v9, s46
    v_mov_b32 v10, s47
    v_and_b32 v11, 3, v1
    v_cndmask_b32 v9, v9, v10, vcc
    s_lshr_b32 s44, s43, 2
    s_lshl_b32 s44, s44, 6
    s_and_b32 s45, s43, 1
    s_lshl_b32 s45, s45, 5
    s_add_u32 s44, s44, s45
    s_and_b32 s45, s43, 2
    s_lshl_b32 s45, s45, 2
    s_add_u32 s44, s44, s45
    v_lshrrev_b32 v12, 1, v11
    v_lshl_add_u32 v12, v12, 4, s44
    v_and_b32 v13, 1, v11
    v_lshl_add_u32 v12, v13, 2, v12
    v_mul_u32_u24 v13, 1152, v9
    v_lshl_add_u32 v14, v13, 1, v12
    v_add_u32 v15, 2621440, v14
    s_mov_b32 s45, 22144
    buffer_load_dword v18, v12, s[24:27], s45 offen sc1
    v_mov_b32 v19, s92
    v_mov_b32 v10, s93
    v_cndmask_b32 v19, v19, v10, vcc
    v_and_b32 v19, 0xfffff800, v19
    v_or_b32 v19, 0x400, v19
    v_ashrrev_i32 v10, 31, v19
    v_not_b32 v10, v10
    v_or_b32 v10, 0x80000000, v10
    v_xor_b32 v19, v19, v10
    s_lshl_b32 s45, s43, 4
    v_lshl_add_u32 v13, v11, 2, v13
    v_add_u32 v13, s45, v13
    v_lshrrev_b32 v14, 2, v1
    v_lshlrev_b32 v14, 9, v14
    v_lshl_add_u32 v14, v11, 4, v14
    s_lshr_b32 s44, s43, 3
    s_mul_i32 s44, s44, 73728
    s_and_b32 s45, s43, 7
    s_lshl_b32 s45, s45, 6
    s_add_u32 s44, s44, s45
    v_cmp_eq_u32 s[38:39], 1, v8
    v_cvt_pk_bf16_f32 v19, v19, v19
    v_and_b32 v19, 0xffff0000, v19
    v_mul_f32 v19, 0xbfb8aa3b, v19
    v_exp_f32 v19, v19
    s_waitcnt vmcnt(0)
    v_lshlrev_b32 v24, 16, v18
    v_and_b32 v25, 0xffff0000, v18
    v_add_f32 v19, 1.0, v19
    v_rcp_f32 v19, v19
    s_mov_b32 s48, 262144
    v_cvt_pk_bf16_f32 v19, v19, v19
    v_and_b32 v19, 0xffff0000, v19
Ltail_polly:
    s_add_u32 s45, s44, 0
    buffer_load_dwordx4 v[64:67], v14, s[8:11], s45 offen sc1
    s_add_u32 s45, s44, 8192
    buffer_load_dwordx4 v[68:71], v14, s[8:11], s45 offen sc1
    s_add_u32 s45, s44, 16384
    buffer_load_dwordx4 v[72:75], v14, s[8:11], s45 offen sc1
    s_add_u32 s45, s44, 24576
    buffer_load_dwordx4 v[76:79], v14, s[8:11], s45 offen sc1
    s_add_u32 s45, s44, 32768
    buffer_load_dwordx4 v[80:83], v14, s[8:11], s45 offen sc1
    s_add_u32 s45, s44, 40960
    buffer_load_dwordx4 v[84:87], v14, s[8:11], s45 offen sc1
    s_add_u32 s45, s44, 49152
    buffer_load_dwordx4 v[88:91], v14, s[8:11], s45 offen sc1
    s_add_u32 s45, s44, 57344
    buffer_load_dwordx4 v[92:95], v14, s[8:11], s45 offen sc1
    s_add_u32 s45, s44, 65536
    buffer_load_dwordx4 v[96:99], v14, s[8:11], s45 offen sc1
    s_mov_b32 s45, 1152
    buffer_load_dword v16, v15, s[24:27], s45 offen sc1
    buffer_load_dword v17, v15, s[24:27], 0 offen sc1
    s_sub_u32 s48, s48, 1
    s_cbranch_scc1 Ltail_goty
    s_waitcnt vmcnt(10)
    v_max3_u32 v26, v64, v65, v66
    s_waitcnt vmcnt(9)
    v_max3_u32 v26, v26, v67, v68
    v_max3_u32 v26, v26, v69, v70
    s_waitcnt vmcnt(8)
    v_max3_u32 v26, v26, v71, v72
    v_max3_u32 v26, v26, v73, v74
    s_waitcnt vmcnt(7)
    v_max3_u32 v26, v26, v75, v76
    v_max3_u32 v26, v26, v77, v78
    s_waitcnt vmcnt(6)
    v_max3_u32 v26, v26, v79, v80
    v_max3_u32 v26, v26, v81, v82
    s_waitcnt vmcnt(5)
    v_max3_u32 v26, v26, v83, v84
    v_max3_u32 v26, v26, v85, v86
    s_waitcnt vmcnt(4)
    v_max3_u32 v26, v26, v87, v88
    v_max3_u32 v26, v26, v89, v90
    s_waitcnt vmcnt(3)
    v_max3_u32 v26, v26, v91, v92
    v_max3_u32 v26, v26, v93, v94
    s_waitcnt vmcnt(2)
    v_max3_u32 v26, v26, v95, v96
    v_max3_u32 v26, v26, v97, v98
    v_max_u32 v26, v26, v99
    s_waitcnt vmcnt(0)
    v_max3_u32 v26, v26, v16, v17
    v_cmp_eq_u32 vcc, -1, v26
    s_cbranch_vccnz Ltail_polly
Ltail_goty:
    s_waitcnt vmcnt(0) lgkmcnt(0)
    v_lshlrev_b32 v20, 16, v16
    v_and_b32 v21, 0xffff0000, v16
    v_lshlrev_b32 v22, 16, v17
    v_and_b32 v23, 0xffff0000, v17
    v_pk_add_f32 v[64:65], v[64:65], v[68:69]
    v_pk_add_f32 v[66:67], v[66:67], v[70:71]
    v_pk_add_f32 v[64:65], v[64:65], v[72:73]
    v_pk_add_f32 v[66:67], v[66:67], v[74:75]
    v_pk_add_f32 v[64:65], v[64:65], v[76:77]
    v_pk_add_f32 v[66:67], v[66:67], v[78:79]
    v_pk_add_f32 v[64:65], v[64:65], v[80:81]
    v_pk_add_f32 v[66:67], v[66:67], v[82:83]
    v_pk_add_f32 v[64:65], v[64:65], v[84:85]
    v_pk_add_f32 v[66:67], v[66:67], v[86:87]
    v_pk_add_f32 v[64:65], v[64:65], v[88:89]
    v_pk_add_f32 v[66:67], v[66:67], v[90:91]
    v_pk_add_f32 v[64:65], v[64:65], v[92:93]
    v_pk_add_f32 v[66:67], v[66:67], v[94:95]
    v_pk_add_f32 v[64:65], v[64:65], v[96:97]
    v_pk_add_f32 v[66:67], v[66:67], v[98:99]
    s_nop 0
    v_add_f32_dpp v64, v64, v64 row_ror:4 row_mask:0xf bank_mask:0xf
    v_add_f32_dpp v65, v65, v65 row_ror:4 row_mask:0xf bank_mask:0xf
    v_add_f32_dpp v66, v66, v66 row_ror:4 row_mask:0xf bank_mask:0xf
    v_add_f32_dpp v67, v67, v67 row_ror:4 row_mask:0xf bank_mask:0xf
    v_add_f32_dpp v64, v64, v64 row_ror:8 row_mask:0xf bank_mask:0xf
    v_add_f32_dpp v65, v65, v65 row_ror:8 row_mask:0xf bank_mask:0xf
    v_add_f32_dpp v66, v66, v66 row_ror:8 row_mask:0xf bank_mask:0xf
    v_add_f32_dpp v67, v67, v67 row_ror:8 row_mask:0xf bank_mask:0xf
    v_mov_b32 v68, v64
    v_mov_b32 v69, v65
    v_mov_b32 v70, v66
    v_mov_b32 v71, v67
    v_permlane16_swap_b32 v64, v68
    v_permlane16_swap_b32 v65, v69
    v_permlane16_swap_b32 v66, v70
    v_permlane16_swap_b32 v67, v71
    v_add_f32 v64, v64, v68
    v_add_f32 v65, v65, v69
    v_add_f32 v66, v66, v70
    v_add_f32 v67, v67, v71
    v_mov_b32 v68, v64
    v_mov_b32 v69, v65
    v_mov_b32 v70, v66
    v_mov_b32 v71, v67
    v_permlane32_swap_b32 v64, v68
    v_permlane32_swap_b32 v65, v69
    v_permlane32_swap_b32 v66, v70
    v_permlane32_swap_b32 v67, v71
    v_add_f32 v64, v64, v68
    v_add_f32 v65, v65, v69
    v_add_f32 v66, v66, v70
    v_add_f32 v67, v67, v71
    v_cndmask_b32 v26, v64, v65, s[38:39]
    v_cndmask_b32 v27, v66, v67, s[38:39]
    v_cvt_pk_bf16_f32 v28, v26, v27
    v_lshlrev_b32 v26, 16, v28
    v_and_b32 v27, 0xffff0000, v28
    v_mul_f32 v26, v26, v19
    v_mul_f32 v27, v27, v19
    v_cvt_pk_bf16_f32 v28, v26, v27
    v_lshlrev_b32 v26, 16, v28
    v_and_b32 v27, 0xffff0000, v28
    v_pk_add_f32 v[26:27], v[26:27], v[22:23]
    v_cvt_pk_bf16_f32 v28, v26, v27
    v_lshlrev_b32 v26, 16, v28
    v_and_b32 v27, 0xffff0000, v28
    v_pk_mul_f32 v[26:27], v[26:27], v[24:25]
    v_cvt_pk_bf16_f32 v28, v26, v27
    v_lshlrev_b32 v26, 16, v28
    v_and_b32 v27, 0xffff0000, v28
    v_pk_add_f32 v[26:27], v[26:27], v[20:21]
    v_cvt_pk_bf16_f32 v28, v26, v27
    s_mov_b64 exec, 0xff
    buffer_store_dword v28, v13, s[16:19], 0 offen nt
    s_branch Ltail_done
Ltail_idle:
Ltour1_2:
    s_cbranch_execz Lmain1
    v_lshlrev_b32 v216, 16, v64
    v_and_b32 v217, 0xffff0000, v64
    v_lshlrev_b32 v218, 16, v65
    v_and_b32 v219, 0xffff0000, v65
    v_lshlrev_b32 v220, 16, v66
    v_and_b32 v221, 0xffff0000, v66
    v_lshlrev_b32 v222, 16, v67
    v_and_b32 v223, 0xffff0000, v67
    v_lshlrev_b32 v224, 16, v68
    v_and_b32 v225, 0xffff0000, v68
    v_lshlrev_b32 v226, 16, v69
    v_and_b32 v227, 0xffff0000, v69
    v_lshlrev_b32 v228, 16, v70
    v_and_b32 v229, 0xffff0000, v70
    v_lshlrev_b32 v230, 16, v71
    v_and_b32 v231, 0xffff0000, v71
    v_lshlrev_b32 v232, 16, v72
    v_and_b32 v233, 0xffff0000, v72
    v_lshlrev_b32 v234, 16, v73
    v_and_b32 v235, 0xffff0000, v73
    v_lshlrev_b32 v236, 16, v74
    v_and_b32 v237, 0xffff0000, v74
    v_lshlrev_b32 v238, 16, v75
    v_and_b32 v239, 0xffff0000, v75
    v_pk_mul_f32 v[192:193], v[192:193], v[216:217]
    v_pk_mul_f32 v[194:195], v[194:195], v[218:219]
    v_pk_mul_f32 v[196:197], v[196:197], v[220:221]
    v_pk_mul_f32 v[198:199], v[198:199], v[222:223]
    v_pk_mul_f32 v[200:201], v[200:201], v[224:225]
    v_pk_mul_f32 v[202:203], v[202:203], v[226:227]
    v_pk_mul_f32 v[204:205], v[204:205], v[228:229]
    v_pk_mul_f32 v[206:207], v[206:207], v[230:231]
    v_pk_mul_f32 v[208:209], v[208:209], v[232:233]
    v_pk_mul_f32 v[210:211], v[210:211], v[234:235]
    v_pk_mul_f32 v[212:213], v[212:213], v[236:237]
    v_pk_mul_f32 v[214:215], v[214:215], v[238:239]
    v_cvt_pk_bf16_f32 v144, v192, v193
    v_cvt_pk_bf16_f32 v145, v194, v195
    v_cvt_pk_bf16_f32 v146, v196, v197
    v_cvt_pk_bf16_f32 v147, v198, v199
    v_cvt_pk_bf16_f32 v148, v200, v201
    v_cvt_pk_bf16_f32 v149, v202, v203
    v_cvt_pk_bf16_f32 v150, v204, v205
    v_cvt_pk_bf16_f32 v151, v206, v207
    v_cvt_pk_bf16_f32 v152, v208, v209
    v_cvt_pk_bf16_f32 v153, v210, v211
    v_cvt_pk_bf16_f32 v154, v212, v213
    v_cvt_pk_bf16_f32 v155, v214, v215
    v_lshlrev_b32 v192, 16, v144
    v_and_b32 v193, 0xffff0000, v144
    v_lshlrev_b32 v194, 16, v145
    v_and_b32 v195, 0xffff0000, v145
    v_lshlrev_b32 v196, 16, v146
    v_and_b32 v197, 0xffff0000, v146
    v_lshlrev_b32 v198, 16, v147
    v_and_b32 v199, 0xffff0000, v147
    v_lshlrev_b32 v200, 16, v148
    v_and_b32 v201, 0xffff0000, v148
    v_lshlrev_b32 v202, 16, v149
    v_and_b32 v203, 0xffff0000, v149
    v_lshlrev_b32 v204, 16, v150
    v_and_b32 v205, 0xffff0000, v150
    v_lshlrev_b32 v206, 16, v151
    v_and_b32 v207, 0xffff0000, v151
    v_lshlrev_b32 v208, 16, v152
    v_and_b32 v209, 0xffff0000, v152
    v_lshlrev_b32 v210, 16, v153
    v_and_b32 v211, 0xffff0000, v153
    v_lshlrev_b32 v212, 16, v154
    v_and_b32 v213, 0xffff0000, v154
    v_lshlrev_b32 v214, 16, v155
    v_and_b32 v215, 0xffff0000, v155
    v_pk_add_f32 v[192:193], v[192:193], v[12:13]
    v_pk_add_f32 v[194:195], v[194:195], v[14:15]
    v_pk_add_f32 v[196:197], v[196:197], v[16:17]
    v_pk_add_f32 v[198:199], v[198:199], v[18:19]
    v_pk_add_f32 v[200:201], v[200:201], v[20:21]
    v_pk_add_f32 v[202:203], v[202:203], v[22:23]
    v_pk_add_f32 v[204:205], v[204:205], v[24:25]
    v_pk_add_f32 v[206:207], v[206:207], v[26:27]
    v_pk_add_f32 v[208:209], v[208:209], v[28:29]
    v_pk_add_f32 v[210:211], v[210:211], v[30:31]
    v_pk_add_f32 v[212:213], v[212:213], v[32:33]
    v_pk_add_f32 v[214:215], v[214:215], v[34:35]
    v_cvt_pk_bf16_f32 v156, v192, v193
    v_cvt_pk_bf16_f32 v157, v194, v195
    v_cvt_pk_bf16_f32 v158, v196, v197
    v_cvt_pk_bf16_f32 v159, v198, v199
    v_cvt_pk_bf16_f32 v160, v200, v201
    v_cvt_pk_bf16_f32 v161, v202, v203
    v_cvt_pk_bf16_f32 v162, v204, v205
    v_cvt_pk_bf16_f32 v163, v206, v207
    v_cvt_pk_bf16_f32 v164, v208, v209
    v_cvt_pk_bf16_f32 v165, v210, v211
    v_cvt_pk_bf16_f32 v166, v212, v213
    v_cvt_pk_bf16_f32 v167, v214, v215
    v_and_b32 v30, 2, v1
    v_cmp_ne_u32 vcc, 0, v30
    v_mul_u32_u24 v30, 1152, v7
    v_add_u32 v4, v30, v5
    v_add_u32 v58, v30, v59
    v_mov_b32_dpp v192, v158 quad_perm:[0,2,0,2] row_mask:0xf bank_mask:0xf
    v_mov_b32_dpp v193, v159 quad_perm:[0,2,0,2] row_mask:0xf bank_mask:0xf
    v_mov_b32_dpp v194, v158 quad_perm:[1,3,1,3] row_mask:0xf bank_mask:0xf
    v_mov_b32_dpp v195, v159 quad_perm:[1,3,1,3] row_mask:0xf bank_mask:0xf
    v_mov_b32_dpp v196, v162 quad_perm:[0,2,0,2] row_mask:0xf bank_mask:0xf
    v_mov_b32_dpp v197, v163 quad_perm:[0,2,0,2] row_mask:0xf bank_mask:0xf
    v_mov_b32_dpp v198, v162 quad_perm:[1,3,1,3] row_mask:0xf bank_mask:0xf
    v_mov_b32_dpp v199, v163 quad_perm:[1,3,1,3] row_mask:0xf bank_mask:0xf
    v_mov_b32_dpp v200, v166 quad_perm:[0,2,0,2] row_mask:0xf bank_mask:0xf
    v_mov_b32_dpp v201, v167 quad_perm:[0,2,0,2] row_mask:0xf bank_mask:0xf
    v_mov_b32_dpp v202, v166 quad_perm:[1,3,1,3] row_mask:0xf bank_mask:0xf
    v_mov_b32_dpp v203, v167 quad_perm:[1,3,1,3] row_mask:0xf bank_mask:0xf
    v_cndmask_b32_dpp v144, v156, v192, vcc quad_perm:[0,2,0,2] row_mask:0xf bank_mask:0xf
    v_cndmask_b32_dpp v145, v157, v193, vcc quad_perm:[0,2,0,2] row_mask:0xf bank_mask:0xf
    v_cndmask_b32_dpp v146, v156, v194, vcc quad_perm:[1,3,1,3] row_mask:0xf bank_mask:0xf
    v_cndmask_b32_dpp v147, v157, v195, vcc quad_perm:[1,3,1,3] row_mask:0xf bank_mask:0xf
    v_cndmask_b32_dpp v148, v160, v196, vcc quad_perm:[0,2,0,2] row_mask:0xf bank_mask:0xf
    v_cndmask_b32_dpp v149, v161, v197, vcc quad_perm:[0,2,0,2] row_mask:0xf bank_mask:0xf
    v_cndmask_b32_dpp v150, v160, v198, vcc quad_perm:[1,3,1,3] row_mask:0xf bank_mask:0xf
    v_cndmask_b32_dpp v151, v161, v199, vcc quad_perm:[1,3,1,3] row_mask:0xf bank_mask:0xf
    v_cndmask_b32_dpp v152, v164, v200, vcc quad_perm:[0,2,0,2] row_mask:0xf bank_mask:0xf
    v_cndmask_b32_dpp v153, v165, v201, vcc quad_perm:[0,2,0,2] row_mask:0xf bank_mask:0xf
    v_cndmask_b32_dpp v154, v164, v202, vcc quad_perm:[1,3,1,3] row_mask:0xf bank_mask:0xf
    v_cndmask_b32_dpp v155, v165, v203, vcc quad_perm:[1,3,1,3] row_mask:0xf bank_mask:0xf
    buffer_store_dwordx4 v[144:147], v4, s[16:19], 0 offen offset:0 sc1
    buffer_store_dwordx4 v[148:151], v4, s[16:19], 0 offen offset:512 sc1
    buffer_store_dwordx4 v[152:155], v58, s[16:19], 0 offen offset:1024 sc1
    s_waitcnt vmcnt(0)
    s_mov_b32 s36, 2622592
    buffer_store_dwordx4 v[36:39], v6, s[24:27], s36 offen offset:0 sc1
    buffer_store_dwordx4 v[40:43], v6, s[24:27], s36 offen offset:512 sc1
    buffer_store_dwordx4 v[44:47], v60, s[24:27], s36 offen offset:1024 sc1
Ltail_done:
    s_endpgm
Lattn_wb:
    buffer_wbl2 sc1
    s_waitcnt vmcnt(0)
    s_branch Lattn_wbdone
Lattn_xspin:
Ltour0_12:
    s_cbranch_execz Lmain0
    s_mov_b32 s37, 262144
Lattn_xloop:
    buffer_load_dword v11, v8, s[24:27], s54 offen offset:8 sc1
    s_waitcnt vmcnt(0)
    v_readfirstlane_b32 s36, v11
    s_sub_u32 s37, s37, 1
    s_cbranch_scc1 Lattn_xgot
    s_cmp_lg_u32 s36, s95
    s_cbranch_scc1 Lattn_xloop
    s_branch Lattn_xgot
Ltail_spin1:
Ltour1_3:
    s_cbranch_execz Lmain1
    s_mov_b32 s48, 262144
Ltail_spinl1:
    buffer_load_dword v11, v9, s[24:27], s39 offen sc1
    s_waitcnt vmcnt(0)
    v_cmp_ne_u32 s[54:55], s95, v11
    s_sub_u32 s48, s48, 1
    s_cbranch_scc1 Ltail_got1
    s_cmp_lg_u64 s[54:55], 0
    s_cbranch_scc1 Ltail_spinl1
    s_branch Ltail_got1
Ltail_spin2:
Ltour1_4:
    s_cbranch_execz Lmain1
    s_mov_b32 s48, 262144
Ltail_spinl2:
    buffer_load_dword v11, v9, s[24:27], s39 offen sc1
    s_waitcnt vmcnt(0)
    v_cmp_ne_u32 s[54:55], s95, v11
    s_sub_u32 s48, s48, 1
    s_cbranch_scc1 Ltail_got2
    s_cmp_lg_u64 s[54:55], 0
    s_cbranch_scc1 Ltail_spinl2
    s_branch Ltail_got2
Lattn_redo:
    s_load_dwordx2 s[16:17], s[0:1], 88
    v_xor_b32 v8, 64, v9
    v_xor_b32 v10, 64, v11
    s_waitcnt vmcnt(0) lgkmcnt(0)
    s_barrier
    v_mov_b32 v232, 0xff800000
    v_mov_b32 v233, 0xff800000
    v_mov_b32 v234, 0xff800000
    v_mov_b32 v235, 0xff800000
    s_mov_b32 s40, 0
    s_mov_b32 s48, -1
Lattn_redo_loop:
    s_add_u32 m0, s42, 0
    s_nop 0
    buffer_load_dwordx4 v36, s[8:11], s40 offen lds
    buffer_load_dwordx4 v37, s[8:11], s40 offen offset:1024 lds
    buffer_load_dwordx4 v38, s[8:11], s40 offen offset:2048 lds
    buffer_load_dwordx4 v39, s[8:11], s40 offen offset:3072 lds
    s_add_u32 s40, s40, 16384
    s_waitcnt vmcnt(0) lgkmcnt(0)
    s_barrier
    ds_read_b128 a[208:211], v8 offset:0
    ds_read_b128 a[212:215], v9 offset:0
    ds_read_b128 a[216:219], v10 offset:0
    ds_read_b128 a[220:223], v11 offset:0
    s_waitcnt lgkmcnt(3)
    v_mfma_f32_16x16x32_bf16 v[216:219], a[208:211], v[64:67], 0
    s_waitcnt lgkmcnt(2)
    v_mfma_f32_16x16x32_bf16 v[216:219], a[212:215], v[68:71], v[216:219]
    s_waitcnt lgkmcnt(1)
    v_mfma_f32_16x16x32_bf16 v[216:219], a[216:219], v[72:75], v[216:219]
    s_waitcnt lgkmcnt(0)
    v_mfma_f32_16x16x32_bf16 v[216:219], a[220:223], v[76:79], v[216:219]
    v_mfma_f32_16x16x32_bf16 v[220:223], a[208:211], v[80:83], 0
    v_mfma_f32_16x16x32_bf16 v[220:223], a[212:215], v[84:87], v[220:223]
    v_mfma_f32_16x16x32_bf16 v[220:223], a[216:219], v[88:91], v[220:223]
    v_mfma_f32_16x16x32_bf16 v[220:223], a[220:223], v[92:95], v[220:223]
    v_mfma_f32_16x16x32_bf16 v[224:227], a[208:211], v[96:99], 0
    v_mfma_f32_16x16x32_bf16 v[224:227], a[212:215], v[100:103], v[224:227]
    v_mfma_f32_16x16x32_bf16 v[224:227], a[216:219], v[104:107], v[224:227]
    v_mfma_f32_16x16x32_bf16 v[224:227], a[220:223], v[108:111], v[224:227]
    v_mfma_f32_16x16x32_bf16 v[228:231], a[208:211], v[112:115], 0
    v_mfma_f32_16x16x32_bf16 v[228:231], a[212:215], v[116:119], v[228:231]
    v_mfma_f32_16x16x32_bf16 v[228:231], a[216:219], v[120:123], v[228:231]
    v_mfma_f32_16x16x32_bf16 v[228:231], a[220:223], v[124:127], v[228:231]
    v_max3_f32 v232, v232, v216, v217
    v_max3_f32 v232, v232, v218, v219
    v_max3_f32 v233, v233, v220, v221
    v_max3_f32 v233, v233, v222, v223
    v_max3_f32 v234, v234, v224, v225
    v_max3_f32 v234, v234, v226, v227
    s_nop 1
    v_max3_f32 v235, v235, v228, v229
    v_max3_f32 v235, v235, v230, v231
    ds_read_b128 a[224:227], v8 offset:4096
    ds_read_b128 a[228:231], v9 offset:4096
    ds_read_b128 a[232:235], v10 offset:4096
    ds_read_b128 a[236:239], v11 offset:4096
    s_waitcnt lgkmcnt(3)
    v_mfma_f32_16x16x32_bf16 v[216:219], a[224:227], v[64:67], 0
    s_waitcnt lgkmcnt(2)
    v_mfma_f32_16x16x32_bf16 v[216:219], a[228:231], v[68:71], v[216:219]
    s_waitcnt lgkmcnt(1)
    v_mfma_f32_16x16x32_bf16 v[216:219], a[232:235], v[72:75], v[216:219]
    s_waitcnt lgkmcnt(0)
    v_mfma_f32_16x16x32_bf16 v[216:219], a[236:239], v[76:79], v[216:219]
    v_mfma_f32_16x16x32_bf16 v[220:223], a[224:227], v[80:83], 0
    v_mfma_f32_16x16x32_bf16 v[220:223], a[228:231], v[84:87], v[220:223]
    v_mfma_f32_16x16x32_bf16 v[220:223], a[232:235], v[88:91], v[220:223]
    v_mfma_f32_16x16x32_bf16 v[220:223], a[236:239], v[92:95], v[220:223]
    v_mfma_f32_16x16x32_bf16 v[224:227], a[224:227], v[96:99], 0
    v_mfma_f32_16x16x32_bf16 v[224:227], a[228:231], v[100:103], v[224:227]
    v_mfma_f32_16x16x32_bf16 v[224:227], a[232:235], v[104:107], v[224:227]
    v_mfma_f32_16x16x32_bf16 v[224:227], a[236:239], v[108:111], v[224:227]
    v_mfma_f32_16x16x32_bf16 v[228:231], a[224:227], v[112:115], 0
    v_mfma_f32_16x16x32_bf16 v[228:231], a[228:231], v[116:119], v[228:231]
    v_mfma_f32_16x16x32_bf16 v[228:231], a[232:235], v[120:123], v[228:231]
    v_mfma_f32_16x16x32_bf16 v[228:231], a[236:239], v[124:127], v[228:231]
    v_max3_f32 v232, v232, v216, v217
    v_max3_f32 v232, v232, v218, v219
    v_max3_f32 v233, v233, v220, v221
    v_max3_f32 v233, v233, v222, v223
    v_max3_f32 v234, v234, v224, v225
    v_max3_f32 v234, v234, v226, v227
    s_nop 1
    v_max3_f32 v235, v235, v228, v229
    v_max3_f32 v235, v235, v230, v231
    ds_read_b128 a[208:211], v8 offset:8192
    ds_read_b128 a[212:215], v9 offset:8192
    ds_read_b128 a[216:219], v10 offset:8192
    ds_read_b128 a[220:223], v11 offset:8192
    s_waitcnt lgkmcnt(3)
    v_mfma_f32_16x16x32_bf16 v[216:219], a[208:211], v[64:67], 0
    s_waitcnt lgkmcnt(2)
    v_mfma_f32_16x16x32_bf16 v[216:219], a[212:215], v[68:71], v[216:219]
    s_waitcnt lgkmcnt(1)
    v_mfma_f32_16x16x32_bf16 v[216:219], a[216:219], v[72:75], v[216:219]
    s_waitcnt lgkmcnt(0)
    v_mfma_f32_16x16x32_bf16 v[216:219], a[220:223], v[76:79], v[216:219]
    v_mfma_f32_16x16x32_bf16 v[220:223], a[208:211], v[80:83], 0
    v_mfma_f32_16x16x32_bf16 v[220:223], a[212:215], v[84:87], v[220:223]
    v_mfma_f32_16x16x32_bf16 v[220:223], a[216:219], v[88:91], v[220:223]
    v_mfma_f32_16x16x32_bf16 v[220:223], a[220:223], v[92:95], v[220:223]
    v_mfma_f32_16x16x32_bf16 v[224:227], a[208:211], v[96:99], 0
    v_mfma_f32_16x16x32_bf16 v[224:227], a[212:215], v[100:103], v[224:227]
    v_mfma_f32_16x16x32_bf16 v[224:227], a[216:219], v[104:107], v[224:227]
    v_mfma_f32_16x16x32_bf16 v[224:227], a[220:223], v[108:111], v[224:227]
    v_mfma_f32_16x16x32_bf16 v[228:231], a[208:211], v[112:115], 0
    v_mfma_f32_16x16x32_bf16 v[228:231], a[212:215], v[116:119], v[228:231]
    v_mfma_f32_16x16x32_bf16 v[228:231], a[216:219], v[120:123], v[228:231]
    v_mfma_f32_16x16x32_bf16 v[228:231], a[220:223], v[124:127], v[228:231]
    v_max3_f32 v232, v232, v216, v217
    v_max3_f32 v232, v232, v218, v219
    v_max3_f32 v233, v233, v220, v221
    v_max3_f32 v233, v233, v222, v223
    v_max3_f32 v234, v234, v224, v225
    v_max3_f32 v234, v234, v226, v227
    s_nop 1
    v_max3_f32 v235, v235, v228, v229
    v_max3_f32 v235, v235, v230, v231
    ds_read_b128 a[224:227], v8 offset:12288
    ds_read_b128 a[228:231], v9 offset:12288
    ds_read_b128 a[232:235], v10 offset:12288
    ds_read_b128 a[236:239], v11 offset:12288
    s_waitcnt lgkmcnt(3)
    v_mfma_f32_16x16x32_bf16 v[216:219], a[224:227], v[64:67], 0
    s_waitcnt lgkmcnt(2)
    v_mfma_f32_16x16x32_bf16 v[216:219], a[228:231], v[68:71], v[216:219]
    s_waitcnt lgkmcnt(1)
    v_mfma_f32_16x16x32_bf16 v[216:219], a[232:235], v[72:75], v[216:219]
    s_waitcnt lgkmcnt(0)
    v_mfma_f32_16x16x32_bf16 v[216:219], a[236:239], v[76:79], v[216:219]
    v_mfma_f32_16x16x32_bf16 v[220:223], a[224:227], v[80:83], 0
    v_mfma_f32_16x16x32_bf16 v[220:223], a[228:231], v[84:87], v[220:223]
    v_mfma_f32_16x16x32_bf16 v[220:223], a[232:235], v[88:91], v[220:223]
    v_mfma_f32_16x16x32_bf16 v[220:223], a[236:239], v[92:95], v[220:223]
    v_mfma_f32_16x16x32_bf16 v[224:227], a[224:227], v[96:99], 0
    v_mfma_f32_16x16x32_bf16 v[224:227], a[228:231], v[100:103], v[224:227]
    v_mfma_f32_16x16x32_bf16 v[224:227], a[232:235], v[104:107], v[224:227]
    v_mfma_f32_16x16x32_bf16 v[224:227], a[236:239], v[108:111], v[224:227]
    v_mfma_f32_16x16x32_bf16 v[228:231], a[224:227], v[112:115], 0
    v_mfma_f32_16x16x32_bf16 v[228:231], a[228:231], v[116:119], v[228:231]
    v_mfma_f32_16x16x32_bf16 v[228:231], a[232:235], v[120:123], v[228:231]
    v_mfma_f32_16x16x32_bf16 v[228:231], a[236:239], v[124:127], v[228:231]
    v_max3_f32 v232, v232, v216, v217
    v_max3_f32 v232, v232, v218, v219
    v_max3_f32 v233, v233, v220, v221
    v_max3_f32 v233, v233, v222, v223
    v_max3_f32 v234, v234, v224, v225
    v_max3_f32 v234, v234, v226, v227
    s_nop 1
    v_max3_f32 v235, v235, v228, v229
    v_max3_f32 v235, v235, v230, v231
    s_barrier
    s_cmp_lt_u32 s40, 524288
    s_cbranch_scc1 Lattn_redo_loop
    v_mov_b32 v236, v232
    v_mov_b32 v237, v233
    v_mov_b32 v238, v234
    v_mov_b32 v239, v235
    v_permlane16_swap_b32 v232, v236
    v_permlane16_swap_b32 v233, v237
    v_permlane16_swap_b32 v234, v238
    v_permlane16_swap_b32 v235, v239
    v_max_f32 v232, v232, v236
    v_max_f32 v233, v233, v237
    v_max_f32 v234, v234, v238
    v_max_f32 v235, v235, v239
    v_mov_b32 v236, v232
    v_mov_b32 v237, v233
    v_mov_b32 v238, v234
    v_mov_b32 v239, v235
    v_permlane32_swap_b32 v232, v236
    v_permlane32_swap_b32 v233, v237
    v_permlane32_swap_b32 v234, v238
    v_permlane32_swap_b32 v235, v239
    v_max_f32 v232, v232, v236
    v_max_f32 v233, v233, v237
    v_max_f32 v234, v234, v238
    v_max_f32 v235, v235, v239
    v_sub_f32 v192, 0, v232
    v_sub_f32 v193, 0, v232
    v_sub_f32 v194, 0, v232
    v_sub_f32 v195, 0, v232
    v_sub_f32 v196, 0, v233
    v_sub_f32 v197, 0, v233
    v_sub_f32 v198, 0, v233
    v_sub_f32 v199, 0, v233
    v_sub_f32 v200, 0, v234
    v_sub_f32 v201, 0, v234
    v_sub_f32 v202, 0, v234
    v_sub_f32 v203, 0, v234
    v_sub_f32 v204, 0, v235
    v_sub_f32 v205, 0, v235
    v_sub_f32 v206, 0, v235
    v_sub_f32 v207, 0, v235
    s_mov_b32 s40, 0
    s_mov_b32 s41, 0
    s_add_u32 m0, s42, 0
    s_nop 0
    buffer_load_dwordx4 v36, s[8:11], s40 offen lds
    buffer_load_dwordx4 v37, s[8:11], s40 offen offset:1024 lds
    buffer_load_dwordx4 v38, s[8:11], s40 offen offset:2048 lds
    buffer_load_dwordx4 v39, s[8:11], s40 offen offset:3072 lds
    s_add_u32 s40, s40, 16384
    s_add_u32 m0, s42, 16384
    s_nop 0
    buffer_load_dwordx4 v36, s[8:11], s40 offen lds
    buffer_load_dwordx4 v37, s[8:11], s40 offen offset:1024 lds
    buffer_load_dwordx4 v38, s[8:11], s40 offen offset:2048 lds
    buffer_load_dwordx4 v39, s[8:11], s40 offen offset:3072 lds
    s_add_u32 s40, s40, 16384
    s_add_u32 m0, s42, 32768
    s_nop 0
    buffer_load_dwordx4 v36, s[8:11], s40 offen lds
    buffer_load_dwordx4 v37, s[8:11], s40 offen offset:1024 lds
    buffer_load_dwordx4 v38, s[8:11], s40 offen offset:2048 lds
    buffer_load_dwordx4 v39, s[8:11], s40 offen offset:3072 lds
    s_add_u32 s40, s40, 16384
    s_add_u32 m0, s42, 65536
    s_nop 0
    buffer_load_dwordx4 v40, s[12:15], s41 offen lds
    buffer_load_dwordx4 v41, s[12:15], s41 offen offset:1024 lds
    buffer_load_dwordx4 v40, s[12:15], s41 offen offset:2048 lds
    buffer_load_dwordx4 v41, s[12:15], s41 offen offset:3072 lds
    s_add_u32 s41, s41, 16384
    s_add_u32 m0, s42, 81920
    s_nop 0
    buffer_load_dwordx4 v40, s[12:15], s41 offen lds
    buffer_load_dwordx4 v41, s[12:15], s41 offen offset:1024 lds
    buffer_load_dwordx4 v40, s[12:15], s41 offen offset:2048 lds
    buffer_load_dwordx4 v41, s[12:15], s41 offen offset:3072 lds
    s_add_u32 s41, s41, 16384
    v_accvgpr_write_b32 a0, 0
    v_accvgpr_write_b32 a1, 0
    v_accvgpr_write_b32 a2, 0
    v_accvgpr_write_b32 a3, 0
    v_accvgpr_write_b32 a4, 0
    v_accvgpr_write_b32 a5, 0
    v_accvgpr_write_b32 a6, 0
    v_accvgpr_write_b32 a7, 0
    v_accvgpr_write_b32 a8, 0
    v_accvgpr_write_b32 a9, 0
    v_accvgpr_write_b32 a10, 0
    v_accvgpr_write_b32 a11, 0
    v_accvgpr_write_b32 a12, 0
    v_accvgpr_write_b32 a13, 0
    v_accvgpr_write_b32 a14, 0
    v_accvgpr_write_b32 a15, 0
    v_accvgpr_write_b32 a16, 0
    v_accvgpr_write_b32 a17, 0
    v_accvgpr_write_b32 a18, 0
    v_accvgpr_write_b32 a19, 0
    v_accvgpr_write_b32 a20, 0
    v_accvgpr_write_b32 a21, 0
    v_accvgpr_write_b32 a22, 0
    v_accvgpr_write_b32 a23, 0
    v_accvgpr_write_b32 a24, 0
    v_accvgpr_write_b32 a25, 0
    v_accvgpr_write_b32 a26, 0
    v_accvgpr_write_b32 a27, 0
    v_accvgpr_write_b32 a28, 0
    v_accvgpr_write_b32 a29, 0
    v_accvgpr_write_b32 a30, 0
    v_accvgpr_write_b32 a31, 0
    v_accvgpr_write_b32 a32, 0
    v_accvgpr_write_b32 a33, 0
    v_accvgpr_write_b32 a34, 0
    v_accvgpr_write_b32 a35, 0
    v_accvgpr_write_b32 a36, 0
    v_accvgpr_write_b32 a37, 0
    v_accvgpr_write_b32 a38, 0
    v_accvgpr_write_b32 a39, 0
    v_accvgpr_write_b32 a40, 0
    v_accvgpr_write_b32 a41, 0
    v_accvgpr_write_b32 a42, 0
    v_accvgpr_write_b32 a43, 0
    v_accvgpr_write_b32 a44, 0
    v_accvgpr_write_b32 a45, 0
    v_accvgpr_write_b32 a46, 0
    v_accvgpr_write_b32 a47, 0
    v_accvgpr_write_b32 a48, 0
    v_accvgpr_write_b32 a49, 0
    v_accvgpr_write_b32 a50, 0
    v_accvgpr_write_b32 a51, 0
    v_accvgpr_write_b32 a52, 0
    v_accvgpr_write_b32 a53, 0
    v_accvgpr_write_b32 a54, 0
    v_accvgpr_write_b32 a55, 0
    v_accvgpr_write_b32 a56, 0
    v_accvgpr_write_b32 a57, 0
    v_accvgpr_write_b32 a58, 0
    v_accvgpr_write_b32 a59, 0
    v_accvgpr_write_b32 a60, 0
    v_accvgpr_write_b32 a61, 0
    v_accvgpr_write_b32 a62, 0
    v_accvgpr_write_b32 a63, 0
    v_accvgpr_write_b32 a64, 0
    v_accvgpr_write_b32 a65, 0
    v_accvgpr_write_b32 a66, 0
    v_accvgpr_write_b32 a67, 0
    v_accvgpr_write_b32 a68, 0
    v_accvgpr_write_b32 a69, 0
    v_accvgpr_write_b32 a70, 0
    v_accvgpr_write_b32 a71, 0
    v_accvgpr_write_b32 a72, 0
    v_accvgpr_write_b32 a73, 0
    v_accvgpr_write_b32 a74, 0
    v_accvgpr_write_b32 a75, 0
    v_accvgpr_write_b32 a76, 0
    v_accvgpr_write_b32 a77, 0
    v_accvgpr_write_b32 a78, 0
    v_accvgpr_write_b32 a79, 0
    v_accvgpr_write_b32 a80, 0
    v_accvgpr_write_b32 a81, 0
    v_accvgpr_write_b32 a82, 0
    v_accvgpr_write_b32 a83, 0
    v_accvgpr_write_b32 a84, 0
    v_accvgpr_write_b32 a85, 0
    v_accvgpr_write_b32 a86, 0
    v_accvgpr_write_b32 a87, 0
    v_accvgpr_write_b32 a88, 0
    v_accvgpr_write_b32 a89, 0
    v_accvgpr_write_b32 a90, 0
    v_accvgpr_write_b32 a91, 0
    v_accvgpr_write_b32 a92, 0
    v_accvgpr_write_b32 a93, 0
    v_accvgpr_write_b32 a94, 0
    v_accvgpr_write_b32 a95, 0
    v_accvgpr_write_b32 a96, 0
    v_accvgpr_write_b32 a97, 0
    v_accvgpr_write_b32 a98, 0
    v_accvgpr_write_b32 a99, 0
    v_accvgpr_write_b32 a100, 0
    v_accvgpr_write_b32 a101, 0
    v_accvgpr_write_b32 a102, 0
    v_accvgpr_write_b32 a103, 0
    v_accvgpr_write_b32 a104, 0
    v_accvgpr_write_b32 a105, 0
    v_accvgpr_write_b32 a106, 0
    v_accvgpr_write_b32 a107, 0
    v_accvgpr_write_b32 a108, 0
    v_accvgpr_write_b32 a109, 0
    v_accvgpr_write_b32 a110, 0
    v_accvgpr_write_b32 a111, 0
    v_accvgpr_write_b32 a112, 0
    v_accvgpr_write_b32 a113, 0
    v_accvgpr_write_b32 a114, 0
    v_accvgpr_write_b32 a115, 0
    v_accvgpr_write_b32 a116, 0
    v_accvgpr_write_b32 a117, 0
    v_accvgpr_write_b32 a118, 0
    v_accvgpr_write_b32 a119, 0
    v_accvgpr_write_b32 a120, 0
    v_accvgpr_write_b32 a121, 0
    v_accvgpr_write_b32 a122, 0
    v_accvgpr_write_b32 a123, 0
    v_accvgpr_write_b32 a124, 0
    v_accvgpr_write_b32 a125, 0
    v_accvgpr_write_b32 a126, 0
    v_accvgpr_write_b32 a127, 0
    v_accvgpr_write_b32 a192, 0
    v_accvgpr_write_b32 a193, 0
    v_accvgpr_write_b32 a194, 0
    v_accvgpr_write_b32 a195, 0
    v_accvgpr_write_b32 a196, 0
    v_accvgpr_write_b32 a197, 0
    v_accvgpr_write_b32 a198, 0
    v_accvgpr_write_b32 a199, 0
    v_accvgpr_write_b32 a200, 0
    v_accvgpr_write_b32 a201, 0
    v_accvgpr_write_b32 a202, 0
    v_accvgpr_write_b32 a203, 0
    v_accvgpr_write_b32 a204, 0
    v_accvgpr_write_b32 a205, 0
    v_accvgpr_write_b32 a206, 0
    v_accvgpr_write_b32 a207, 0
    s_waitcnt vmcnt(0) lgkmcnt(0)
    s_barrier
    ds_read_b128 a[208:211], v8 offset:0
    ds_read_b128 a[212:215], v9 offset:0
    ds_read_b128 a[216:219], v10 offset:0
    ds_read_b128 a[220:223], v11 offset:0
    ds_read_b128 a[224:227], v8 offset:4096
    s_waitcnt vmcnt(0) lgkmcnt(0)
    s_branch Lattn_stage0
Lattn_armwait:
    s_mov_b32 s36, 262144
Lattn_armloop:
    v_mov_b32 v63, 0
    buffer_load_dword v63, v63, s[88:91], 0 offen sc1
    s_waitcnt vmcnt(0)
    v_readfirstlane_b32 s37, v63
    s_sub_u32 s36, s36, 1
    s_cbranch_scc1 Lattn_armed
    s_cmp_lt_u32 s37, 256
    s_cbranch_scc1 Lattn_armloop
    s_branch Lattn_armed
Lattn_end:
    s_endpgm
.section .rodata,"a"
.p2align 6
.amdhsa_kernel adaLN_cond__gqa_block_cached__moe_arch_mod__prompt_kernel
  .amdhsa_next_free_vgpr 512
  .amdhsa_next_free_sgpr 102
  .amdhsa_accum_offset 256
  .amdhsa_group_segment_fixed_size 0
  .amdhsa_kernarg_size 120
  .amdhsa_user_sgpr_count 2
  .amdhsa_user_sgpr_kernarg_segment_ptr 1
  .amdhsa_system_sgpr_workgroup_id_x 1
  .amdhsa_float_denorm_mode_32 3
.end_amdhsa_kernel
```

```asm
; @launch grid=(256,1,1) block=(256,1,1) lds=163840
.amdgcn_target "amdgcn-amd-amdhsa--gfx950"
.text
.globl adaLN_cond__gqa_block_cached__moe_arch_mod__prompt_kernel
.p2align 8
.type adaLN_cond__gqa_block_cached__moe_arch_mod__prompt_kernel,@function
adaLN_cond__gqa_block_cached__moe_arch_mod__prompt_kernel:
    s_cmp_ge_u32 s2, 256
    s_cbranch_scc1 Lattn_end
    s_load_dwordx2 s[8:9], s[0:1], 80
    s_load_dwordx2 s[12:13], s[0:1], 88
    s_load_dwordx2 s[20:21], s[0:1], 0
    s_load_dwordx2 s[50:51], s[0:1], 112
    s_load_dwordx8 s[52:59], s[0:1], 8
    s_load_dwordx4 s[80:83], s[0:1], 56
    s_load_dwordx2 s[84:85], s[0:1], 72
    s_load_dwordx2 s[88:89], s[0:1], 104
    s_load_dwordx2 s[28:29], s[0:1], 48
    s_getpc_b64 s[32:33]
Lattn_pc:
    s_mov_b32 s34, Lattn_end-Lattn_pc
    s_mov_b32 s35, 0x20000
    s_lshr_b32 s6, s2, 3
    s_lshl_b32 s7, s6, 6
    v_lshrrev_b32 v3, 6, v0
    v_and_b32 v1, 63, v0
    v_lshrrev_b32 v2, 2, v0
    v_lshlrev_b32 v2, 11, v2
    v_readfirstlane_b32 s3, v3
    buffer_load_dword v240, v2, s[32:35], s7 offen
    s_and_b32 s7, s2, 7
    s_lshl_b32 s4, s7, 1
    s_and_b32 s5, s6, 1
    s_add_u32 s4, s4, s5
    s_lshr_b32 s5, s2, 4
    s_lshr_b32 s38, s6, 2
    s_lshl_b32 s38, s38, 3
    s_add_u32 s38, s38, s7
    s_cmp_lt_u32 s38, 18
    s_cselect_b32 s39, 0, 2147483648
    s_lshl_b32 s38, s38, 2
    s_and_b32 s36, s6, 3
    s_add_u32 s38, s38, s36
    s_mov_b32 s14, 3981312
    s_mul_i32 s92, s6, 124416
    s_lshl_b32 s36, s7, 7
    s_add_u32 s92, s92, s36
    s_cmp_lt_u32 s7, 2
    s_cselect_b32 s36, 53, 35
    v_lshrrev_b32 v2, 2, v0
    v_min_u32 v2, s36, v2
    v_mul_u32_u24 v3, 57, v2
    v_lshrrev_b32 v3, 10, v3
    v_mul_i32_i24 v3, -123392, v3
    v_mul_u32_u24 v2, 6912, v2
    v_add_u32 v72, v2, v3
    s_mov_b32 s15, 0x20000
    s_mov_b32 s10, 1152
    s_mov_b32 s11, 0x20000
    s_mov_b32 s22, 2359296
    s_mov_b32 s23, 0x20000
    v_and_b32 v64, 0xfe, v0
    v_mul_u32_u24 v65, 3456, v64
    v_and_b32 v2, 1, v0
    v_lshl_add_u32 v65, v2, 4, v65
    s_lshl_b32 s36, s38, 5
    s_or_b32 s36, s36, s39
    v_and_b32 v4, 31, v1
    v_lshrrev_b32 v5, 5, v1
    v_cmp_gt_u32 vcc, 24, v4
    v_mov_b32 v6, 2147483648
    s_lshl_b32 s7, s5, 4
    s_add_u32 s7, s7, s4
    s_lshl_b32 s7, s7, 2
    s_add_u32 s7, s7, s3
    v_cndmask_b32 v6, v6, 0, vcc
    s_mul_i32 s49, s7, 2304
    v_lshrrev_b32 v7, 2, v4
    v_lshl_add_u32 v7, v7, 6, v6
    v_and_b32 v2, 3, v4
    v_lshl_add_u32 v7, v2, 3, v7
    v_mul_u32_u24 v2, 1152, v5
    v_add_u32 v66, v7, v2
    s_waitcnt lgkmcnt(0)
    s_load_dword s94, s[50:51], 24576
    buffer_load_dword v241, v72, s[12:15], s92 offen
    buffer_load_ushort v80, v64, s[8:11], 0 offen offset:0
    buffer_load_ushort v81, v64, s[8:11], 0 offen offset:256
    buffer_load_ushort v82, v64, s[8:11], 0 offen offset:512
    buffer_load_ushort v83, v64, s[8:11], 0 offen offset:768
    buffer_load_ushort v84, v64, s[8:11], 0 offen offset:1024
    buffer_load_dwordx4 v[88:91], v65, s[12:15], s36 offen
    s_add_u32 s36, s36, 884736
    buffer_load_dwordx4 v[92:95], v65, s[12:15], s36 offen
    s_add_u32 s36, s36, 884736
    buffer_load_dwordx4 v[96:99], v65, s[12:15], s36 offen
    s_add_u32 s36, s36, 884736
    buffer_load_dwordx4 v[100:103], v65, s[12:15], s36 offen
    s_add_u32 s36, s36, 884736
    buffer_load_dwordx4 v[104:107], v65, s[12:15], s36 offen
    s_mov_b32 s16, s56
    s_mov_b32 s17, s57
    s_mov_b32 s18, 4718592
    s_mov_b32 s19, 0x20000
    s_lshl_b32 s44, s4, 9
    s_mul_i32 s36, s5, 131072
    s_add_u32 s36, s36, 0
    v_lshrrev_b32 v2, 2, v0
    v_min_u32 v2, 63, v2
    v_lshrrev_b32 v3, 2, v2
    v_and_b32 v2, 3, v2
    v_lshl_add_u32 v2, v2, 7, s36
    v_lshl_add_u32 v71, v3, 13, v2
    s_mul_i32 s36, s5, 163840
    s_add_u32 s36, s36, 2097152
    v_lshrrev_b32 v2, 1, v0
    v_min_u32 v2, 79, v2
    v_lshrrev_b32 v3, 2, v2
    v_and_b32 v2, 3, v2
    v_lshl_add_u32 v2, v2, 7, s36
    v_lshl_add_u32 v70, v3, 13, v2
    s_add_u32 s92, s49, 65536
    v_lshl_add_u32 v7, v5, 4, v6
    v_lshl_add_u32 v67, v4, 5, v7
    v_min_u32 v4, 23, v4
    v_lshlrev_b32 v68, 4, v4
    s_mov_b32 s24, s50
    s_mov_b32 s25, s51
    s_mov_b32 s26, 10485760
    s_mov_b32 s27, 0x20000
    s_mov_b32 s90, 256
    s_mov_b32 s91, 0x20000
    s_cmp_ge_u32 s38, 36
    s_cselect_b32 s93, 1.0, 0
    s_lshl_b32 s36, s38, 7
    v_lshl_add_u32 v69, v0, 3, s36
    v_cmp_gt_u32 s[36:37], 16, v0
    v_mov_b32 v2, 2147483648
    v_mov_b32 v3, s39
    v_cndmask_b32 v2, v2, v3, s[36:37]
    v_or_b32 v69, v69, v2
    s_mul_i32 s36, s5, 3072
    s_lshl_b32 s37, s5, 11
    v_lshrrev_b32 v120, 3, v0
    v_min_u32 v120, 23, v120
    v_lshl_add_u32 v120, v120, 7, s36
    v_lshrrev_b32 v121, 4, v0
    v_lshl_add_u32 v121, v121, 7, s37
    s_lshl_b32 s42, s3, 12
    v_lshrrev_b32 v2, 4, v1
    v_and_b32 v3, 15, v1
    v_lshrrev_b32 v5, 1, v3
    v_mul_u32_u24 v5, 2304, v5
    v_lshl_add_u32 v5, v2, 5, v5
    v_and_b32 v6, 1, v3
    v_lshl_add_u32 v51, v6, 4, v5
    s_lshl_b32 s6, s5, 2
    s_add_u32 s6, s6, s3
    s_mul_i32 s46, s6, 36864
    s_add_u32 s46, s46, 65536
    s_add_u32 s43, s46, 18432
    s_mul_i32 s45, s4, 294912
    s_lshl_b32 s7, s3, 4
    v_add_u32 v4, s7, v2
    v_lshlrev_b32 v5, 1, v2
    v_xor_b32 v5, v5, v3
    v_xor_b32 v6, 8, v5
    v_lshlrev_b32 v7, 13, v4
    v_lshl_add_u32 v42, v5, 4, v7
    v_lshl_add_u32 v43, v6, 4, v7
    v_add_u32 v44, 63488, v42
    v_add_u32 v45, 95232, v43
    v_add_u32 v43, 31744, v43
    s_lshl_b32 s7, s4, 19
    s_add_u32 s8, s52, s7
    s_addc_u32 s9, s53, 0
    s_mov_b32 s10, 524288
    s_mov_b32 s11, 0x20000
    s_add_u32 s12, s54, s7
    s_addc_u32 s13, s55, 0
    s_mov_b32 s14, 524288
    s_mov_b32 s15, 0x20000
    s_add_u32 s28, s50, 10485760
    s_addc_u32 s29, s51, 0
    s_mov_b32 s30, 37748736
    s_mov_b32 s31, 0x20000
    v_lshlrev_b32 v7, 8, v4
    v_lshl_add_u32 v40, v5, 4, v7
    v_lshl_add_u32 v41, v6, 4, v7
    v_xor_b32 v224, v3, v2
    v_lshl_add_u32 v36, v224, 4, v7
    v_xor_b32 v37, 64, v36
    v_xor_b32 v38, 128, v36
    v_xor_b32 v39, 192, v36
    v_lshrrev_b32 v7, 3, v5
    v_lshl_add_u32 v7, v7, 7, v4
    v_mul_u32_u24 v7, 1152, v7
    v_and_b32 v225, 7, v5
    v_lshl_add_u32 v46, v225, 4, v7
    v_lshrrev_b32 v7, 3, v6
    v_lshl_add_u32 v7, v7, 7, v4
    v_mul_u32_u24 v7, 1152, v7
    v_and_b32 v225, 7, v6
    v_lshl_add_u32 v47, v225, 4, v7
    v_add_u32 v48, 7168, v46
    v_add_u32 v49, 10752, v47
    v_add_u32 v47, 3584, v47
    v_lshlrev_b32 v7, 8, v3
    v_lshl_add_u32 v8, v224, 4, v7
    v_xor_b32 v9, 64, v8
    v_xor_b32 v10, 128, v8
    v_xor_b32 v11, 192, v8
    v_lshrrev_b32 v5, 2, v1
    v_and_b32 v6, 7, v5
    v_lshlrev_b32 v6, 5, v6
    v_lshl_add_u32 v6, v5, 8, v6
    v_and_b32 v7, 3, v1
    v_lshl_add_u32 v12, v7, 3, v6
    v_xor_b32 v13, 32, v12
    v_xor_b32 v14, 64, v12
    v_xor_b32 v15, 96, v12
    v_xor_b32 v16, 128, v12
    v_xor_b32 v17, 160, v12
    v_xor_b32 v18, 192, v12
    v_xor_b32 v19, 224, v12
    v_add_u32 v20, 65536, v12
    v_add_u32 v21, 65536, v13
    v_add_u32 v22, 65536, v14
    v_add_u32 v23, 65536, v15
    v_add_u32 v24, 65536, v16
    v_add_u32 v25, 65536, v17
    v_add_u32 v26, 65536, v18
    v_add_u32 v27, 65536, v19
    v_add_u32 v28, 131072, v12
    v_add_u32 v29, 131072, v13
    v_add_u32 v30, 131072, v14
    v_add_u32 v31, 131072, v15
    v_add_u32 v32, 131072, v16
    v_add_u32 v33, 131072, v17
    v_add_u32 v34, 131072, v18
    v_add_u32 v35, 131072, v19
    v_mov_b32 v52, 0x3f803f80
    v_mov_b32 v53, 0x3f803f80
    v_mov_b32 v54, 0x3f803f80
    v_mov_b32 v55, 0x3f803f80
    v_and_b32 v5, 1, v1
    v_mul_u32_u24 v5, 0xaaaa, v5
    v_add_u32 v5, 0x4444, v5
    v_lshl_add_u32 v50, v5, 16, v5
    v_lshrrev_b32 v5, 1, v3
    v_mul_u32_u24 v5, 20480, v5
    v_lshl_add_u32 v5, v2, 5, v5
    v_and_b32 v6, 1, v3
    v_lshl_add_u32 v56, v6, 4, v5
    s_mul_i32 s47, s6, 327680
    s_mov_b32 s32, s82
    s_mov_b32 s33, s83
    s_mov_b32 s34, 5308416
    s_mov_b32 s35, 0x20000
    s_mov_b32 s82, 5308416
    s_mov_b32 s83, 0x20000
    s_mov_b32 s86, 5308416
    s_mov_b32 s87, 0x20000
    s_lshr_b32 s7, s2, 3
    s_mul_i32 s7, s7, 18
    s_add_u32 s7, s7, s3
    s_and_b32 s36, s2, 7
    s_mul_i32 s37, s36, 576
    s_add_u32 s37, s37, s7
    s_mul_i32 s37, s37, 1152
    s_mul_i32 s7, s7, 9216
    s_mul_i32 s36, s36, 1152
    s_add_u32 s7, s7, s36
    v_min_u32 v5, 17, v1
    v_lshl_add_u32 v57, v5, 6, s7
    v_lshl_add_u32 v62, v5, 6, s37
    s_mov_b32 s40, 0
    s_mov_b32 s41, 0
    s_mov_b32 s48, 0
    s_waitcnt vmcnt(9)
    v_lshlrev_b32 v80, 16, v80
    s_waitcnt vmcnt(8)
    v_lshlrev_b32 v81, 16, v81
    s_waitcnt vmcnt(7)
    v_lshlrev_b32 v82, 16, v82
    s_waitcnt vmcnt(6)
    v_lshlrev_b32 v83, 16, v83
    s_waitcnt vmcnt(5)
    v_lshlrev_b32 v84, 16, v84
    v_mul_f32 v144, 0xbfb8aa3b, v80
    v_mul_f32 v148, 0xbfb8aa3b, v81
    v_mul_f32 v152, 0xbfb8aa3b, v82
    v_mul_f32 v156, 0xbfb8aa3b, v83
    v_mul_f32 v160, 0xbfb8aa3b, v84
    v_min_f32 v144, 0x42fc0000, v144
    v_min_f32 v148, 0x42fc0000, v148
    v_min_f32 v152, 0x42fc0000, v152
    v_min_f32 v156, 0x42fc0000, v156
    v_min_f32 v160, 0x42fc0000, v160
    v_exp_f32 v144, v144
    v_exp_f32 v148, v148
    v_exp_f32 v152, v152
    v_exp_f32 v156, v156
    v_exp_f32 v160, v160
    v_add_f32 v144, 1.0, v144
    v_add_f32 v148, 1.0, v148
    v_add_f32 v152, 1.0, v152
    v_add_f32 v156, 1.0, v156
    v_add_f32 v160, 1.0, v160
    v_rcp_f32 v145, v144
    v_rcp_f32 v149, v148
    v_rcp_f32 v153, v152
    v_rcp_f32 v157, v156
    v_rcp_f32 v161, v160
    v_mul_f32 v146, v80, v145
    v_mul_f32 v150, v81, v149
    v_mul_f32 v154, v82, v153
    v_mul_f32 v158, v83, v157
    v_mul_f32 v162, v84, v161
    v_fma_f32 v144, -v146, v144, v80
    v_fma_f32 v148, -v150, v148, v81
    v_fma_f32 v152, -v154, v152, v82
    v_fma_f32 v156, -v158, v156, v83
    v_fma_f32 v160, -v162, v160, v84
    v_fma_f32 v80, v144, v145, v146
    v_fma_f32 v81, v148, v149, v150
    v_fma_f32 v82, v152, v153, v154
    v_fma_f32 v83, v156, v157, v158
    v_fma_f32 v84, v160, v161, v162
    v_cvt_pk_bf16_f32 v80, v80, v80
    v_cvt_pk_bf16_f32 v81, v81, v81
    v_cvt_pk_bf16_f32 v82, v82, v82
    v_cvt_pk_bf16_f32 v83, v83, v83
    v_cvt_pk_bf16_f32 v84, v84, v84
    v_and_b32 v80, 0xffff0000, v80
    v_and_b32 v81, 0xffff0000, v81
    v_and_b32 v82, 0xffff0000, v82
    v_and_b32 v83, 0xffff0000, v83
    v_and_b32 v84, 0xffff0000, v84
    buffer_load_dwordx2 v[108:109], v66, s[20:23], s49 offen offset:0
    buffer_load_dwordx2 v[110:111], v66, s[20:23], s49 offen offset:32
    buffer_load_dwordx2 v[112:113], v66, s[20:23], s49 offen offset:384
    buffer_load_dwordx2 v[114:115], v66, s[20:23], s49 offen offset:416
    buffer_load_dwordx2 v[116:117], v66, s[20:23], s49 offen offset:768
    buffer_load_dwordx2 v[118:119], v66, s[20:23], s49 offen offset:800
    s_mov_b32 s20, s58
    s_mov_b32 s21, s59
    s_mov_b32 s22, 4718592
    s_mov_b32 s23, 0x20000
    s_waitcnt vmcnt(10)
    v_lshlrev_b32 v136, 16, v88
    v_and_b32 v137, 0xffff0000, v88
    v_lshlrev_b32 v138, 16, v89
    v_and_b32 v139, 0xffff0000, v89
    v_lshlrev_b32 v140, 16, v90
    v_and_b32 v141, 0xffff0000, v90
    v_lshlrev_b32 v142, 16, v91
    v_and_b32 v143, 0xffff0000, v91
    v_pk_mul_f32 v[128:129], v[136:137], v[80:81] op_sel:[0,0] op_sel_hi:[1,0]
    v_pk_mul_f32 v[130:131], v[138:139], v[80:81] op_sel:[0,0] op_sel_hi:[1,0]
    v_pk_mul_f32 v[132:133], v[140:141], v[80:81] op_sel:[0,0] op_sel_hi:[1,0]
    v_pk_mul_f32 v[134:135], v[142:143], v[80:81] op_sel:[0,0] op_sel_hi:[1,0]
    s_waitcnt vmcnt(9)
    v_lshlrev_b32 v136, 16, v92
    v_and_b32 v137, 0xffff0000, v92
    v_lshlrev_b32 v138, 16, v93
    v_and_b32 v139, 0xffff0000, v93
    v_lshlrev_b32 v140, 16, v94
    v_and_b32 v141, 0xffff0000, v94
    v_lshlrev_b32 v142, 16, v95
    v_and_b32 v143, 0xffff0000, v95
    v_pk_fma_f32 v[128:129], v[136:137], v[80:81], v[128:129] op_sel:[0,1,0] op_sel_hi:[1,1,1]
    v_pk_fma_f32 v[130:131], v[138:139], v[80:81], v[130:131] op_sel:[0,1,0] op_sel_hi:[1,1,1]
    v_pk_fma_f32 v[132:133], v[140:141], v[80:81], v[132:133] op_sel:[0,1,0] op_sel_hi:[1,1,1]
    v_pk_fma_f32 v[134:135], v[142:143], v[80:81], v[134:135] op_sel:[0,1,0] op_sel_hi:[1,1,1]
    s_waitcnt vmcnt(8)
    v_lshlrev_b32 v136, 16, v96
    v_and_b32 v137, 0xffff0000, v96
    v_lshlrev_b32 v138, 16, v97
    v_and_b32 v139, 0xffff0000, v97
    v_lshlrev_b32 v140, 16, v98
    v_and_b32 v141, 0xffff0000, v98
    v_lshlrev_b32 v142, 16, v99
    v_and_b32 v143, 0xffff0000, v99
    v_pk_fma_f32 v[128:129], v[136:137], v[82:83], v[128:129] op_sel:[0,0,0] op_sel_hi:[1,0,1]
    v_pk_fma_f32 v[130:131], v[138:139], v[82:83], v[130:131] op_sel:[0,0,0] op_sel_hi:[1,0,1]
    v_pk_fma_f32 v[132:133], v[140:141], v[82:83], v[132:133] op_sel:[0,0,0] op_sel_hi:[1,0,1]
    v_pk_fma_f32 v[134:135], v[142:143], v[82:83], v[134:135] op_sel:[0,0,0] op_sel_hi:[1,0,1]
    s_waitcnt vmcnt(7)
    v_lshlrev_b32 v136, 16, v100
    v_and_b32 v137, 0xffff0000, v100
    v_lshlrev_b32 v138, 16, v101
    v_and_b32 v139, 0xffff0000, v101
    v_lshlrev_b32 v140, 16, v102
    v_and_b32 v141, 0xffff0000, v102
    v_lshlrev_b32 v142, 16, v103
    v_and_b32 v143, 0xffff0000, v103
    v_pk_fma_f32 v[128:129], v[136:137], v[82:83], v[128:129] op_sel:[0,1,0] op_sel_hi:[1,1,1]
    v_pk_fma_f32 v[130:131], v[138:139], v[82:83], v[130:131] op_sel:[0,1,0] op_sel_hi:[1,1,1]
    v_pk_fma_f32 v[132:133], v[140:141], v[82:83], v[132:133] op_sel:[0,1,0] op_sel_hi:[1,1,1]
    v_pk_fma_f32 v[134:135], v[142:143], v[82:83], v[134:135] op_sel:[0,1,0] op_sel_hi:[1,1,1]
    s_waitcnt vmcnt(6)
    v_lshlrev_b32 v136, 16, v104
    v_and_b32 v137, 0xffff0000, v104
    v_lshlrev_b32 v138, 16, v105
    v_and_b32 v139, 0xffff0000, v105
    v_lshlrev_b32 v140, 16, v106
    v_and_b32 v141, 0xffff0000, v106
    v_lshlrev_b32 v142, 16, v107
    v_and_b32 v143, 0xffff0000, v107
    v_pk_fma_f32 v[128:129], v[136:137], v[84:85], v[128:129] op_sel:[0,0,0] op_sel_hi:[1,0,1]
    v_pk_fma_f32 v[130:131], v[138:139], v[84:85], v[130:131] op_sel:[0,0,0] op_sel_hi:[1,0,1]
    v_pk_fma_f32 v[132:133], v[140:141], v[84:85], v[132:133] op_sel:[0,0,0] op_sel_hi:[1,0,1]
    v_pk_fma_f32 v[134:135], v[142:143], v[84:85], v[134:135] op_sel:[0,0,0] op_sel_hi:[1,0,1]
    s_nop 0
    v_permlane32_swap_b32 v128, v132
    v_permlane32_swap_b32 v129, v133
    v_permlane32_swap_b32 v130, v134
    v_permlane32_swap_b32 v131, v135
    v_and_b32 v72, 1, v1
    v_pk_add_f32 v[128:129], v[128:129], v[132:133]
    v_pk_add_f32 v[130:131], v[130:131], v[134:135]
    v_lshlrev_b32 v72, 5, v72
    v_lshrrev_b32 v73, 4, v1
    v_permlane16_swap_b32 v128, v130
    v_permlane16_swap_b32 v129, v131
    v_lshl_add_u32 v72, v73, 3, v72
    v_pk_add_f32 v[128:129], v[128:129], v[130:131]
    s_lshl_b32 s36, s3, 6
    v_add_u32 v72, s36, v72
    v_add_f32_dpp v128, v128, v128 row_ror:2 row_mask:0xf bank_mask:0xf
    v_add_f32_dpp v129, v129, v129 row_ror:2 row_mask:0xf bank_mask:0xf
    s_nop 0
    v_add_f32_dpp v128, v128, v128 row_ror:4 row_mask:0xf bank_mask:0xf
    v_add_f32_dpp v129, v129, v129 row_ror:4 row_mask:0xf bank_mask:0xf
    s_nop 0
    v_add_f32_dpp v128, v128, v128 row_ror:8 row_mask:0xf bank_mask:0xf
    v_add_f32_dpp v129, v129, v129 row_ror:8 row_mask:0xf bank_mask:0xf
    ds_write_b64 v72, v[128:129] offset:0
    v_and_b32 v73, 7, v1
    v_lshlrev_b32 v73, 3, v73
    s_waitcnt lgkmcnt(0)
    s_barrier
    ds_read_b64 v[128:129], v73 offset:0
    ds_read_b64 v[130:131], v73 offset:64
    ds_read_b64 v[132:133], v73 offset:128
    ds_read_b64 v[134:135], v73 offset:192
    s_add_u32 s95, s94, 0x9e3779b9
    v_mov_b32 v137, s95
    s_mov_b32 s37, 32768
    s_waitcnt lgkmcnt(2)
    v_pk_add_f32 v[128:129], v[128:129], v[130:131]
    s_waitcnt lgkmcnt(0)
    v_pk_add_f32 v[132:133], v[132:133], v[134:135]
    v_pk_add_f32 v[128:129], v[128:129], v[132:133]
    v_cvt_pk_bf16_f32 v136, v128, v129
    v_lshlrev_b32 v128, 16, v136
    v_and_b32 v129, 0xffff0000, v136
    v_add_f32 v128, s93, v128
    v_add_f32 v129, s93, v129
    v_cvt_pk_bf16_f32 v136, v128, v129
    buffer_store_dwordx2 v[136:137], v69, s[24:27], s37 offen sc1
    s_mul_i32 s36, s3, 72
    v_add_u32 v122, s36, v1
    v_and_b32 v123, 7, v1
    s_add_u32 s36, s36, 64
    v_add_u32 v123, s36, v123
    s_movk_i32 s36, 1024
    v_and_b32 v76, 3, v122
    v_lshlrev_b32 v76, 4, v76
    v_lshrrev_b32 v122, 2, v122
    v_lshl_add_u32 v124, v122, 7, v76
    v_and_b32 v77, 1, v122
    v_lshl_add_u32 v76, v77, 3, v76
    v_lshrrev_b32 v122, 1, v122
    v_lshl_add_u32 v122, v122, 6, v76
    v_add_u32 v122, s36, v122
    v_and_b32 v76, 3, v123
    v_lshlrev_b32 v76, 4, v76
    v_lshrrev_b32 v123, 2, v123
    v_lshl_add_u32 v125, v123, 7, v76
    v_and_b32 v77, 1, v123
    v_lshl_add_u32 v76, v77, 3, v76
    v_lshrrev_b32 v123, 1, v123
    v_lshl_add_u32 v123, v123, 6, v76
    v_add_u32 v123, s36, v123
    s_mov_b64 exec, 0
    s_cmp_eq_u32 s3, 0
    s_cbranch_scc1 Ltour0_0
    s_cmp_eq_u32 s3, 1
    s_cbranch_scc1 Ltour0_1
    s_cmp_eq_u32 s3, 2
    s_cbranch_scc1 Ltour0_2
    s_branch Ltour0_3
.p2align 12
Lmain0:
    s_mov_b64 exec, -1
    s_waitcnt vmcnt(6)
    v_lshlrev_b32 v144, 16, v108
    v_and_b32 v145, 0xffff0000, v108
    v_lshlrev_b32 v146, 16, v109
    v_and_b32 v147, 0xffff0000, v109
    s_waitcnt vmcnt(5)
    v_lshlrev_b32 v148, 16, v110
    v_and_b32 v149, 0xffff0000, v110
    v_lshlrev_b32 v150, 16, v111
    v_and_b32 v151, 0xffff0000, v111
    s_waitcnt vmcnt(4)
    v_lshlrev_b32 v152, 16, v112
    v_and_b32 v153, 0xffff0000, v112
    v_lshlrev_b32 v154, 16, v113
    v_and_b32 v155, 0xffff0000, v113
    s_waitcnt vmcnt(3)
    v_lshlrev_b32 v156, 16, v114
    v_and_b32 v157, 0xffff0000, v114
    v_lshlrev_b32 v158, 16, v115
    v_and_b32 v159, 0xffff0000, v115
    s_waitcnt vmcnt(2)
    v_lshlrev_b32 v160, 16, v116
    v_and_b32 v161, 0xffff0000, v116
    v_lshlrev_b32 v162, 16, v117
    v_and_b32 v163, 0xffff0000, v117
    s_waitcnt vmcnt(1)
    v_lshlrev_b32 v164, 16, v118
    v_and_b32 v165, 0xffff0000, v118
    v_lshlrev_b32 v166, 16, v119
    v_and_b32 v167, 0xffff0000, v119
    buffer_load_dwordx4 v[88:91], v124, s[24:27], s37 offen sc1
    buffer_load_dwordx4 v[92:95], v125, s[24:27], s37 offen sc1
    buffer_load_dword v242, v71, s[16:19], s44 offen
    v_pk_add_f32 v[72:73], v[144:145], v[148:149]
    v_pk_add_f32 v[76:77], v[146:147], v[150:151]
    v_pk_add_f32 v[72:73], v[72:73], v[152:153]
    v_pk_add_f32 v[76:77], v[76:77], v[154:155]
    v_pk_add_f32 v[72:73], v[72:73], v[156:157]
    v_pk_add_f32 v[76:77], v[76:77], v[158:159]
    v_pk_add_f32 v[72:73], v[72:73], v[160:161]
    v_pk_add_f32 v[76:77], v[76:77], v[162:163]
    v_pk_add_f32 v[72:73], v[72:73], v[164:165]
    v_pk_add_f32 v[76:77], v[76:77], v[166:167]
    v_pk_add_f32 v[72:73], v[72:73], v[76:77]
    v_add_f32 v72, v72, v73
    s_nop 1
    v_add_f32_dpp v72, v72, v72 row_ror:8 row_mask:0xf bank_mask:0xf
    s_nop 1
    v_add_f32_dpp v72, v72, v72 row_ror:4 row_mask:0xf bank_mask:0xf
    s_nop 1
    v_add_f32_dpp v72, v72, v72 row_ror:2 row_mask:0xf bank_mask:0xf
    s_nop 1
    v_add_f32_dpp v72, v72, v72 row_ror:1 row_mask:0xf bank_mask:0xf
    v_mov_b32 v76, v72
    s_nop 1
    v_permlane16_swap_b32 v72, v76
    s_nop 0
    v_add_f32 v72, v72, v76
    v_mul_f32 v72, 0x3ae38e39, v72
    v_pk_add_f32 v[168:169], v[144:145], v[72:73] op_sel_hi:[1,0] neg_lo:[0,1] neg_hi:[0,1]
    v_pk_add_f32 v[170:171], v[146:147], v[72:73] op_sel_hi:[1,0] neg_lo:[0,1] neg_hi:[0,1]
    v_pk_add_f32 v[172:173], v[148:149], v[72:73] op_sel_hi:[1,0] neg_lo:[0,1] neg_hi:[0,1]
    v_pk_add_f32 v[174:175], v[150:151], v[72:73] op_sel_hi:[1,0] neg_lo:[0,1] neg_hi:[0,1]
    v_pk_add_f32 v[176:177], v[152:153], v[72:73] op_sel_hi:[1,0] neg_lo:[0,1] neg_hi:[0,1]
    v_pk_add_f32 v[178:179], v[154:155], v[72:73] op_sel_hi:[1,0] neg_lo:[0,1] neg_hi:[0,1]
    v_pk_add_f32 v[180:181], v[156:157], v[72:73] op_sel_hi:[1,0] neg_lo:[0,1] neg_hi:[0,1]
    v_pk_add_f32 v[182:183], v[158:159], v[72:73] op_sel_hi:[1,0] neg_lo:[0,1] neg_hi:[0,1]
    v_pk_add_f32 v[184:185], v[160:161], v[72:73] op_sel_hi:[1,0] neg_lo:[0,1] neg_hi:[0,1]
    v_pk_add_f32 v[186:187], v[162:163], v[72:73] op_sel_hi:[1,0] neg_lo:[0,1] neg_hi:[0,1]
    v_pk_add_f32 v[188:189], v[164:165], v[72:73] op_sel_hi:[1,0] neg_lo:[0,1] neg_hi:[0,1]
    v_pk_add_f32 v[190:191], v[166:167], v[72:73] op_sel_hi:[1,0] neg_lo:[0,1] neg_hi:[0,1]
    v_pk_mul_f32 v[74:75], v[168:169], v[168:169]
    v_pk_mul_f32 v[76:77], v[170:171], v[170:171]
    v_pk_fma_f32 v[74:75], v[172:173], v[172:173], v[74:75]
    v_pk_fma_f32 v[76:77], v[174:175], v[174:175], v[76:77]
    v_pk_fma_f32 v[74:75], v[176:177], v[176:177], v[74:75]
    v_pk_fma_f32 v[76:77], v[178:179], v[178:179], v[76:77]
    v_pk_fma_f32 v[74:75], v[180:181], v[180:181], v[74:75]
    v_pk_fma_f32 v[76:77], v[182:183], v[182:183], v[76:77]
    v_pk_fma_f32 v[74:75], v[184:185], v[184:185], v[74:75]
    v_pk_fma_f32 v[76:77], v[186:187], v[186:187], v[76:77]
    v_pk_fma_f32 v[74:75], v[188:189], v[188:189], v[74:75]
    v_pk_fma_f32 v[76:77], v[190:191], v[190:191], v[76:77]
    v_pk_add_f32 v[74:75], v[74:75], v[76:77]
    v_add_f32 v74, v74, v75
    v_cndmask_b32 v74, 0, v74, vcc
    s_nop 1
    v_add_f32_dpp v74, v74, v74 row_ror:8 row_mask:0xf bank_mask:0xf
    s_nop 1
    v_add_f32_dpp v74, v74, v74 row_ror:4 row_mask:0xf bank_mask:0xf
    s_nop 1
    v_add_f32_dpp v74, v74, v74 row_ror:2 row_mask:0xf bank_mask:0xf
    s_nop 1
    v_add_f32_dpp v74, v74, v74 row_ror:1 row_mask:0xf bank_mask:0xf
    v_mov_b32 v76, v74
    s_nop 1
    v_permlane16_swap_b32 v74, v76
    s_nop 0
    v_add_f32 v74, v74, v76
    v_mul_f32 v74, 0x3ae38e39, v74
    v_cvt_pk_bf16_f32 v76, v72, v74
    v_and_b32 v74, 0xffff0000, v76
    v_lshlrev_b32 v72, 16, v76
    v_add_f32 v74, 0x3727c5ac, v74
    v_cvt_pk_bf16_f32 v74, v74, v74
    v_and_b32 v74, 0xffff0000, v74
    v_sqrt_f32 v74, v74
    v_pk_add_f32 v[168:169], v[144:145], v[72:73] op_sel_hi:[1,0] neg_lo:[0,1] neg_hi:[0,1]
    v_pk_add_f32 v[170:171], v[146:147], v[72:73] op_sel_hi:[1,0] neg_lo:[0,1] neg_hi:[0,1]
    v_pk_add_f32 v[172:173], v[148:149], v[72:73] op_sel_hi:[1,0] neg_lo:[0,1] neg_hi:[0,1]
    v_pk_add_f32 v[174:175], v[150:151], v[72:73] op_sel_hi:[1,0] neg_lo:[0,1] neg_hi:[0,1]
    v_pk_add_f32 v[176:177], v[152:153], v[72:73] op_sel_hi:[1,0] neg_lo:[0,1] neg_hi:[0,1]
    v_pk_add_f32 v[178:179], v[154:155], v[72:73] op_sel_hi:[1,0] neg_lo:[0,1] neg_hi:[0,1]
    v_pk_add_f32 v[180:181], v[156:157], v[72:73] op_sel_hi:[1,0] neg_lo:[0,1] neg_hi:[0,1]
    v_pk_add_f32 v[182:183], v[158:159], v[72:73] op_sel_hi:[1,0] neg_lo:[0,1] neg_hi:[0,1]
    v_pk_add_f32 v[184:185], v[160:161], v[72:73] op_sel_hi:[1,0] neg_lo:[0,1] neg_hi:[0,1]
    v_pk_add_f32 v[186:187], v[162:163], v[72:73] op_sel_hi:[1,0] neg_lo:[0,1] neg_hi:[0,1]
    v_pk_add_f32 v[188:189], v[164:165], v[72:73] op_sel_hi:[1,0] neg_lo:[0,1] neg_hi:[0,1]
    v_pk_add_f32 v[190:191], v[166:167], v[72:73] op_sel_hi:[1,0] neg_lo:[0,1] neg_hi:[0,1]
    v_cvt_pk_bf16_f32 v74, v74, v74
    v_and_b32 v74, 0xffff0000, v74
    v_rcp_f32 v74, v74
    v_cvt_pk_bf16_f32 v108, v168, v169
    v_cvt_pk_bf16_f32 v109, v170, v171
    v_cvt_pk_bf16_f32 v110, v172, v173
    v_cvt_pk_bf16_f32 v111, v174, v175
    v_cvt_pk_bf16_f32 v112, v176, v177
    v_cvt_pk_bf16_f32 v113, v178, v179
    v_cvt_pk_bf16_f32 v114, v180, v181
    v_cvt_pk_bf16_f32 v115, v182, v183
    v_cvt_pk_bf16_f32 v116, v184, v185
    v_cvt_pk_bf16_f32 v117, v186, v187
    v_cvt_pk_bf16_f32 v118, v188, v189
    v_cvt_pk_bf16_f32 v119, v190, v191
    v_lshlrev_b32 v168, 16, v108
    v_and_b32 v169, 0xffff0000, v108
    v_lshlrev_b32 v170, 16, v109
    v_and_b32 v171, 0xffff0000, v109
    v_lshlrev_b32 v172, 16, v110
    v_and_b32 v173, 0xffff0000, v110
    v_lshlrev_b32 v174, 16, v111
    v_and_b32 v175, 0xffff0000, v111
    v_lshlrev_b32 v176, 16, v112
    v_and_b32 v177, 0xffff0000, v112
    v_lshlrev_b32 v178, 16, v113
    v_and_b32 v179, 0xffff0000, v113
    v_lshlrev_b32 v180, 16, v114
    v_and_b32 v181, 0xffff0000, v114
    v_lshlrev_b32 v182, 16, v115
    v_and_b32 v183, 0xffff0000, v115
    v_lshlrev_b32 v184, 16, v116
    v_and_b32 v185, 0xffff0000, v116
    v_lshlrev_b32 v186, 16, v117
    v_and_b32 v187, 0xffff0000, v117
    v_lshlrev_b32 v188, 16, v118
    v_and_b32 v189, 0xffff0000, v118
    v_lshlrev_b32 v190, 16, v119
    v_and_b32 v191, 0xffff0000, v119
    v_pk_mul_f32 v[168:169], v[168:169], v[74:75] op_sel_hi:[1,0]
    v_pk_mul_f32 v[170:171], v[170:171], v[74:75] op_sel_hi:[1,0]
    v_pk_mul_f32 v[172:173], v[172:173], v[74:75] op_sel_hi:[1,0]
    v_pk_mul_f32 v[174:175], v[174:175], v[74:75] op_sel_hi:[1,0]
    v_pk_mul_f32 v[176:177], v[176:177], v[74:75] op_sel_hi:[1,0]
    v_pk_mul_f32 v[178:179], v[178:179], v[74:75] op_sel_hi:[1,0]
    v_pk_mul_f32 v[180:181], v[180:181], v[74:75] op_sel_hi:[1,0]
    v_pk_mul_f32 v[182:183], v[182:183], v[74:75] op_sel_hi:[1,0]
    v_pk_mul_f32 v[184:185], v[184:185], v[74:75] op_sel_hi:[1,0]
    v_pk_mul_f32 v[186:187], v[186:187], v[74:75] op_sel_hi:[1,0]
    v_pk_mul_f32 v[188:189], v[188:189], v[74:75] op_sel_hi:[1,0]
    v_pk_mul_f32 v[190:191], v[190:191], v[74:75] op_sel_hi:[1,0]
    v_cvt_pk_bf16_f32 v108, v168, v169
    v_cvt_pk_bf16_f32 v109, v170, v171
    v_cvt_pk_bf16_f32 v110, v172, v173
    v_cvt_pk_bf16_f32 v111, v174, v175
    v_cvt_pk_bf16_f32 v112, v176, v177
    v_cvt_pk_bf16_f32 v113, v178, v179
    v_cvt_pk_bf16_f32 v114, v180, v181
    v_cvt_pk_bf16_f32 v115, v182, v183
    v_cvt_pk_bf16_f32 v116, v184, v185
    v_cvt_pk_bf16_f32 v117, v186, v187
    v_cvt_pk_bf16_f32 v118, v188, v189
    v_cvt_pk_bf16_f32 v119, v190, v191
    v_lshlrev_b32 v168, 16, v108
    v_and_b32 v169, 0xffff0000, v108
    v_lshlrev_b32 v170, 16, v109
    v_and_b32 v171, 0xffff0000, v109
    v_lshlrev_b32 v172, 16, v110
    v_and_b32 v173, 0xffff0000, v110
    v_lshlrev_b32 v174, 16, v111
    v_and_b32 v175, 0xffff0000, v111
    v_lshlrev_b32 v176, 16, v112
    v_and_b32 v177, 0xffff0000, v112
    v_lshlrev_b32 v178, 16, v113
    v_and_b32 v179, 0xffff0000, v113
    v_lshlrev_b32 v180, 16, v114
    v_and_b32 v181, 0xffff0000, v114
    v_lshlrev_b32 v182, 16, v115
    v_and_b32 v183, 0xffff0000, v115
    v_lshlrev_b32 v184, 16, v116
    v_and_b32 v185, 0xffff0000, v116
    v_lshlrev_b32 v186, 16, v117
    v_and_b32 v187, 0xffff0000, v117
    v_lshlrev_b32 v188, 16, v118
    v_and_b32 v189, 0xffff0000, v118
    v_lshlrev_b32 v190, 16, v119
    v_and_b32 v191, 0xffff0000, v119
    s_mov_b32 s38, 262144
    s_waitcnt vmcnt(2)
    v_xor_b32 v89, s95, v89
    v_xor_b32 v91, s95, v91
    s_waitcnt vmcnt(1)
    v_xor_b32 v93, s95, v93
    v_xor_b32 v95, s95, v95
    v_or3_b32 v89, v89, v91, v93
    v_or_b32 v89, v89, v95
    v_cmp_ne_u32 vcc, 0, v89
    s_cbranch_vccz Lhead_gotm
Lhead_pollm:
    buffer_load_dwordx4 v[88:91], v124, s[24:27], s37 offen sc1
    buffer_load_dwordx4 v[92:95], v125, s[24:27], s37 offen sc1
    s_waitcnt vmcnt(0)
    s_sub_u32 s38, s38, 1
    s_cbranch_scc1 Lhead_gotm
    v_xor_b32 v89, s95, v89
    v_xor_b32 v91, s95, v91
    v_xor_b32 v93, s95, v93
    v_xor_b32 v95, s95, v95
    v_or3_b32 v89, v89, v91, v93
    v_or_b32 v89, v89, v95
    v_cmp_ne_u32 vcc, 0, v89
    s_cbranch_vccnz Lhead_pollm
Lhead_gotm:
    ds_write2_b32 v122, v88, v90 offset0:0 offset1:1
    ds_write2_b32 v123, v92, v94 offset0:0 offset1:1
    s_waitcnt lgkmcnt(0)
    s_barrier
    ds_read_b128 v[144:147], v68 offset:2176
    ds_read_b128 v[156:159], v68 offset:1024
    ds_read_b128 v[148:151], v68 offset:2560
    ds_read_b128 v[160:163], v68 offset:1408
    ds_read_b128 v[152:155], v68 offset:2944
    ds_read_b128 v[164:167], v68 offset:1792
    s_waitcnt lgkmcnt(5)
    v_lshlrev_b32 v192, 16, v144
    v_and_b32 v193, 0xffff0000, v144
    v_lshlrev_b32 v194, 16, v145
    v_and_b32 v195, 0xffff0000, v145
    v_lshlrev_b32 v196, 16, v146
    v_and_b32 v197, 0xffff0000, v146
    v_lshlrev_b32 v198, 16, v147
    v_and_b32 v199, 0xffff0000, v147
    v_pk_mul_f32 v[168:169], v[168:169], v[192:193]
    v_pk_mul_f32 v[170:171], v[170:171], v[194:195]
    v_pk_mul_f32 v[172:173], v[172:173], v[196:197]
    v_pk_mul_f32 v[174:175], v[174:175], v[198:199]
    v_cvt_pk_bf16_f32 v108, v168, v169
    v_cvt_pk_bf16_f32 v109, v170, v171
    v_cvt_pk_bf16_f32 v110, v172, v173
    v_cvt_pk_bf16_f32 v111, v174, v175
    s_waitcnt lgkmcnt(4)
    v_lshlrev_b32 v216, 16, v156
    v_and_b32 v217, 0xffff0000, v156
    v_lshlrev_b32 v218, 16, v157
    v_and_b32 v219, 0xffff0000, v157
    v_lshlrev_b32 v220, 16, v158
    v_and_b32 v221, 0xffff0000, v158
    v_lshlrev_b32 v222, 16, v159
    v_and_b32 v223, 0xffff0000, v159
    v_lshlrev_b32 v168, 16, v108
    v_and_b32 v169, 0xffff0000, v108
    v_lshlrev_b32 v170, 16, v109
    v_and_b32 v171, 0xffff0000, v109
    v_lshlrev_b32 v172, 16, v110
    v_and_b32 v173, 0xffff0000, v110
    v_lshlrev_b32 v174, 16, v111
    v_and_b32 v175, 0xffff0000, v111
    v_pk_add_f32 v[168:169], v[168:169], v[216:217]
    v_pk_add_f32 v[170:171], v[170:171], v[218:219]
    v_pk_add_f32 v[172:173], v[172:173], v[220:221]
    v_pk_add_f32 v[174:175], v[174:175], v[222:223]
    v_cvt_pk_bf16_f32 v108, v168, v169
    v_cvt_pk_bf16_f32 v109, v170, v171
    v_cvt_pk_bf16_f32 v110, v172, v173
    v_cvt_pk_bf16_f32 v111, v174, v175
    buffer_store_dwordx4 v[108:111], v67, s[24:27], s92 offen offset:0 sc1
    s_waitcnt lgkmcnt(3)
    v_lshlrev_b32 v200, 16, v148
    v_and_b32 v201, 0xffff0000, v148
    v_lshlrev_b32 v202, 16, v149
    v_and_b32 v203, 0xffff0000, v149
    v_lshlrev_b32 v204, 16, v150
    v_and_b32 v205, 0xffff0000, v150
    v_lshlrev_b32 v206, 16, v151
    v_and_b32 v207, 0xffff0000, v151
    v_pk_mul_f32 v[176:177], v[176:177], v[200:201]
    v_pk_mul_f32 v[178:179], v[178:179], v[202:203]
    v_pk_mul_f32 v[180:181], v[180:181], v[204:205]
    v_pk_mul_f32 v[182:183], v[182:183], v[206:207]
    v_cvt_pk_bf16_f32 v112, v176, v177
    v_cvt_pk_bf16_f32 v113, v178, v179
    v_cvt_pk_bf16_f32 v114, v180, v181
    v_cvt_pk_bf16_f32 v115, v182, v183
    s_waitcnt lgkmcnt(2)
    v_lshlrev_b32 v224, 16, v160
    v_and_b32 v225, 0xffff0000, v160
    v_lshlrev_b32 v226, 16, v161
    v_and_b32 v227, 0xffff0000, v161
    v_lshlrev_b32 v228, 16, v162
    v_and_b32 v229, 0xffff0000, v162
    v_lshlrev_b32 v230, 16, v163
    v_and_b32 v231, 0xffff0000, v163
    v_lshlrev_b32 v176, 16, v112
    v_and_b32 v177, 0xffff0000, v112
    v_lshlrev_b32 v178, 16, v113
    v_and_b32 v179, 0xffff0000, v113
    v_lshlrev_b32 v180, 16, v114
    v_and_b32 v181, 0xffff0000, v114
    v_lshlrev_b32 v182, 16, v115
    v_and_b32 v183, 0xffff0000, v115
    v_pk_add_f32 v[176:177], v[176:177], v[224:225]
    v_pk_add_f32 v[178:179], v[178:179], v[226:227]
    v_pk_add_f32 v[180:181], v[180:181], v[228:229]
    v_pk_add_f32 v[182:183], v[182:183], v[230:231]
    v_cvt_pk_bf16_f32 v112, v176, v177
    v_cvt_pk_bf16_f32 v113, v178, v179
    v_cvt_pk_bf16_f32 v114, v180, v181
    v_cvt_pk_bf16_f32 v115, v182, v183
    buffer_store_dwordx4 v[112:115], v67, s[24:27], s92 offen offset:768 sc1
    s_waitcnt lgkmcnt(1)
    v_lshlrev_b32 v208, 16, v152
    v_and_b32 v209, 0xffff0000, v152
    v_lshlrev_b32 v210, 16, v153
    v_and_b32 v211, 0xffff0000, v153
    v_lshlrev_b32 v212, 16, v154
    v_and_b32 v213, 0xffff0000, v154
    v_lshlrev_b32 v214, 16, v155
    v_and_b32 v215, 0xffff0000, v155
    v_pk_mul_f32 v[184:185], v[184:185], v[208:209]
    v_pk_mul_f32 v[186:187], v[186:187], v[210:211]
    v_pk_mul_f32 v[188:189], v[188:189], v[212:213]
    v_pk_mul_f32 v[190:191], v[190:191], v[214:215]
    v_cvt_pk_bf16_f32 v116, v184, v185
    v_cvt_pk_bf16_f32 v117, v186, v187
    v_cvt_pk_bf16_f32 v118, v188, v189
    v_cvt_pk_bf16_f32 v119, v190, v191
    s_waitcnt lgkmcnt(0)
    v_lshlrev_b32 v232, 16, v164
    v_and_b32 v233, 0xffff0000, v164
    v_lshlrev_b32 v234, 16, v165
    v_and_b32 v235, 0xffff0000, v165
    v_lshlrev_b32 v236, 16, v166
    v_and_b32 v237, 0xffff0000, v166
    v_lshlrev_b32 v238, 16, v167
    v_and_b32 v239, 0xffff0000, v167
    v_lshlrev_b32 v184, 16, v116
    v_and_b32 v185, 0xffff0000, v116
    v_lshlrev_b32 v186, 16, v117
    v_and_b32 v187, 0xffff0000, v117
    v_lshlrev_b32 v188, 16, v118
    v_and_b32 v189, 0xffff0000, v118
    v_lshlrev_b32 v190, 16, v119
    v_and_b32 v191, 0xffff0000, v119
    v_pk_add_f32 v[184:185], v[184:185], v[232:233]
    v_pk_add_f32 v[186:187], v[186:187], v[234:235]
    v_pk_add_f32 v[188:189], v[188:189], v[236:237]
    v_pk_add_f32 v[190:191], v[190:191], v[238:239]
    v_cvt_pk_bf16_f32 v116, v184, v185
    v_cvt_pk_bf16_f32 v117, v186, v187
    v_cvt_pk_bf16_f32 v118, v188, v189
    v_cvt_pk_bf16_f32 v119, v190, v191
    buffer_store_dwordx4 v[116:119], v67, s[24:27], s92 offen offset:1536 sc1
    s_lshl_b32 s36, s5, 13
    s_add_u32 s36, s36, 8650752
    s_lshl_b32 s37, s4, 9
    s_add_u32 s37, s37, s36
    s_lshl_b32 s38, s3, 7
    s_add_u32 s37, s37, s38
    s_lshl_b32 s38, s3, 11
    s_add_u32 s36, s36, s38
    v_min_u32 v72, 1, v1
    v_lshlrev_b32 v72, 31, v72
    v_and_b32 v73, 15, v1
    v_lshlrev_b32 v73, 7, v73
    v_cmp_gt_u32 vcc, 162, v0
    v_mov_b32 v88, -1
    v_mov_b32 v89, -1
    v_mov_b32 v90, -1
    v_mov_b32 v91, -1
    s_mul_i32 s39, s2, 2592
    s_add_u32 s39, s39, 7864320
    v_lshl_add_u32 v74, v0, 4, s39
    s_lshl_b32 s39, s2, 7
    s_add_u32 s39, s39, 9306112
    v_mov_b32 v75, s39
    v_cndmask_b32 v74, v75, v74, vcc
    s_lshl_b32 s92, s5, 13
    s_add_u32 s92, s92, 8781824
    s_add_u32 s92, s92, s38
    s_lshl_b32 s38, s4, 7
    s_add_u32 s92, s92, s38
    s_getreg_b32 s38, hwreg(HW_REG_XCC_ID, 0, 4)
    s_lshl_b32 s38, s38, 28
    s_xor_b32 s38, s38, s95
    v_mov_b32 v76, s38
    v_mov_b32 v2, v80
    v_mov_b32 v3, v81
    v_mov_b32 v4, v82
    v_mov_b32 v5, v83
    v_mov_b32 v6, v84
    v_mov_b32 v7, v65
    v_and_b32 v126, 31, v1
    v_lshlrev_b32 v126, 2, v126
    s_add_u32 s49, s44, 0
    s_add_u32 m0, s42, 32768
    s_nop 0
    buffer_load_dwordx4 v42, s[16:19], s49 offen lds
    buffer_load_dwordx4 v43, s[16:19], s49 offen offset:1024 lds
    buffer_load_dwordx4 v44, s[16:19], s49 offen offset:2048 lds
    buffer_load_dwordx4 v45, s[16:19], s49 offen offset:3072 lds
    s_add_u32 s49, s44, 256
    s_add_u32 m0, s42, 49152
    s_nop 0
    buffer_load_dwordx4 v42, s[16:19], s49 offen lds
    buffer_load_dwordx4 v43, s[16:19], s49 offen offset:1024 lds
    buffer_load_dwordx4 v44, s[16:19], s49 offen offset:2048 lds
    buffer_load_dwordx4 v45, s[16:19], s49 offen offset:3072 lds
    s_waitcnt vmcnt(8)
    buffer_store_dword v137, v126, s[24:27], s37 offen sc1
    s_add_u32 s49, s44, 524288
    s_add_u32 m0, s42, 65536
    s_nop 0
    buffer_load_dwordx4 v42, s[16:19], s49 offen lds
    buffer_load_dwordx4 v43, s[16:19], s49 offen offset:1024 lds
    buffer_load_dwordx4 v44, s[16:19], s49 offen offset:2048 lds
    buffer_load_dwordx4 v45, s[16:19], s49 offen offset:3072 lds
    s_add_u32 s49, s44, 524544
    s_add_u32 m0, s42, 81920
    s_nop 0
    buffer_load_dwordx4 v42, s[16:19], s49 offen lds
    buffer_load_dwordx4 v43, s[16:19], s49 offen offset:1024 lds
    buffer_load_dwordx4 v44, s[16:19], s49 offen offset:2048 lds
    buffer_load_dwordx4 v45, s[16:19], s49 offen offset:3072 lds
    s_add_u32 s49, s44, 1048576
    s_add_u32 m0, s42, 98304
    s_nop 0
    buffer_load_dwordx4 v42, s[16:19], s49 offen lds
    buffer_load_dwordx4 v43, s[16:19], s49 offen offset:1024 lds
    buffer_load_dwordx4 v44, s[16:19], s49 offen offset:2048 lds
    buffer_load_dwordx4 v45, s[16:19], s49 offen offset:3072 lds
    s_add_u32 s49, s44, 1048832
    s_add_u32 m0, s42, 114688
    s_nop 0
    buffer_load_dwordx4 v42, s[16:19], s49 offen lds
    buffer_load_dwordx4 v43, s[16:19], s49 offen offset:1024 lds
    buffer_load_dwordx4 v44, s[16:19], s49 offen offset:2048 lds
    buffer_load_dwordx4 v45, s[16:19], s49 offen offset:3072 lds
    s_add_u32 s49, s44, 1572864
    s_add_u32 m0, s42, 131072
    s_nop 0
    buffer_load_dwordx4 v42, s[16:19], s49 offen lds
    buffer_load_dwordx4 v43, s[16:19], s49 offen offset:1024 lds
    buffer_load_dwordx4 v44, s[16:19], s49 offen offset:2048 lds
    buffer_load_dwordx4 v45, s[16:19], s49 offen offset:3072 lds
    s_add_u32 s49, s44, 1573120
    s_add_u32 m0, s42, 147456
    s_nop 0
    buffer_load_dwordx4 v42, s[16:19], s49 offen lds
    buffer_load_dwordx4 v43, s[16:19], s49 offen offset:1024 lds
    buffer_load_dwordx4 v44, s[16:19], s49 offen offset:2048 lds
    buffer_load_dwordx4 v45, s[16:19], s49 offen offset:3072 lds
    s_mov_b32 s38, 262144
Lhead_pollh:
    buffer_load_dword v75, v73, s[24:27], s36 offen sc1
    s_sub_u32 s38, s38, 1
    s_cbranch_scc1 Lhead_goth
    s_waitcnt vmcnt(0) lgkmcnt(0)
    v_cmp_ne_u32 vcc, s95, v75
    s_cbranch_vccnz Lhead_pollh
Lhead_goth:
    s_waitcnt vmcnt(0) lgkmcnt(0)
    buffer_load_dwordx4 a[0:3], v51, s[24:27], s46 offen offset:0 sc1
    buffer_load_dwordx4 a[8:11], v51, s[24:27], s46 offen offset:128 sc1
    buffer_load_dwordx4 a[4:7], v51, s[24:27], s43 offen offset:0 sc1
    buffer_load_dwordx4 a[12:15], v51, s[24:27], s43 offen offset:128 sc1
    s_barrier
    ds_read_b64_tr_b16 a[160:161], v12 offset:32768
    ds_read_b64_tr_b16 a[162:163], v12 offset:36864
    ds_read_b64_tr_b16 a[164:165], v12 offset:40960
    ds_read_b64_tr_b16 a[166:167], v12 offset:45056
    ds_read_b64_tr_b16 a[168:169], v13 offset:32768
    ds_read_b64_tr_b16 a[170:171], v13 offset:36864
    ds_read_b64_tr_b16 a[172:173], v13 offset:40960
    ds_read_b64_tr_b16 a[174:175], v13 offset:45056
    ds_read_b64_tr_b16 a[176:177], v14 offset:32768
    ds_read_b64_tr_b16 a[178:179], v14 offset:36864
    ds_read_b64_tr_b16 a[180:181], v14 offset:40960
    ds_read_b64_tr_b16 a[182:183], v14 offset:45056
    buffer_load_dwordx4 a[16:19], v51, s[24:27], s46 offen offset:256 sc1
    buffer_load_dwordx4 a[24:27], v51, s[24:27], s46 offen offset:384 sc1
    buffer_load_dwordx4 a[20:23], v51, s[24:27], s43 offen offset:256 sc1
    buffer_load_dwordx4 a[28:31], v51, s[24:27], s43 offen offset:384 sc1
    s_waitcnt lgkmcnt(10)
    s_waitcnt vmcnt(7)
    v_mfma_f32_16x16x32_bf16 v[128:131], a[160:163], a[0:3], 0
    s_waitcnt vmcnt(6)
    s_waitcnt lgkmcnt(8)
    ds_read_b64_tr_b16 a[184:185], v15 offset:32768
    v_mfma_f32_16x16x32_bf16 v[128:131], a[164:167], a[8:11], v[128:131]
    s_waitcnt vmcnt(4)
    ds_read_b64_tr_b16 a[186:187], v15 offset:36864
    v_mfma_f32_16x16x32_bf16 v[132:135], a[164:167], a[12:15], 0
    ds_read_b64_tr_b16 a[188:189], v15 offset:40960
    v_mfma_f32_16x16x32_bf16 v[132:135], a[160:163], a[4:7], v[132:135]
    s_waitcnt lgkmcnt(9)
    buffer_load_dwordx4 a[32:35], v51, s[24:27], s46 offen offset:512 sc1
    v_mfma_f32_16x16x32_bf16 v[140:143], a[168:171], a[4:7], 0
    s_waitcnt lgkmcnt(7)
    ds_read_b64_tr_b16 a[190:191], v15 offset:45056
    ds_read_b64_tr_b16 a[160:161], v16 offset:32768
    v_mfma_f32_16x16x32_bf16 v[140:143], a[172:175], a[12:15], v[140:143]
    ds_read_b64_tr_b16 a[162:163], v16 offset:36864
    v_mfma_f32_16x16x32_bf16 v[136:139], a[172:175], a[8:11], 0
    ds_read_b64_tr_b16 a[164:165], v16 offset:40960
    v_mfma_f32_16x16x32_bf16 v[136:139], a[168:171], a[0:3], v[136:139]
    s_waitcnt lgkmcnt(9)
    buffer_load_dwordx4 a[40:43], v51, s[24:27], s46 offen offset:640 sc1
    v_mfma_f32_16x16x32_bf16 v[144:147], a[176:179], a[0:3], 0
    s_waitcnt lgkmcnt(7)
    ds_read_b64_tr_b16 a[166:167], v16 offset:45056
    ds_read_b64_tr_b16 a[168:169], v17 offset:32768
    v_mfma_f32_16x16x32_bf16 v[144:147], a[180:183], a[8:11], v[144:147]
    ds_read_b64_tr_b16 a[170:171], v17 offset:36864
    v_mfma_f32_16x16x32_bf16 v[148:151], a[180:183], a[12:15], 0
    ds_read_b64_tr_b16 a[172:173], v17 offset:40960
    v_mfma_f32_16x16x32_bf16 v[148:151], a[176:179], a[4:7], v[148:151]
    s_waitcnt lgkmcnt(9)
    buffer_load_dwordx4 a[36:39], v51, s[24:27], s43 offen offset:512 sc1
    v_mfma_f32_16x16x32_bf16 v[156:159], a[184:187], a[4:7], 0
    s_waitcnt lgkmcnt(7)
    ds_read_b64_tr_b16 a[174:175], v17 offset:45056
    ds_read_b64_tr_b16 a[176:177], v18 offset:32768
    v_mfma_f32_16x16x32_bf16 v[156:159], a[188:191], a[12:15], v[156:159]
    ds_read_b64_tr_b16 a[178:179], v18 offset:36864
    v_mfma_f32_16x16x32_bf16 v[152:155], a[188:191], a[8:11], 0
    ds_read_b64_tr_b16 a[180:181], v18 offset:40960
    v_mfma_f32_16x16x32_bf16 v[152:155], a[184:187], a[0:3], v[152:155]
    s_waitcnt lgkmcnt(9)
    buffer_load_dwordx4 a[44:47], v51, s[24:27], s43 offen offset:640 sc1
    v_mfma_f32_16x16x32_bf16 v[160:163], a[160:163], a[0:3], 0
    s_waitcnt lgkmcnt(7)
    ds_read_b64_tr_b16 a[182:183], v18 offset:45056
    ds_read_b64_tr_b16 a[184:185], v19 offset:32768
    v_mfma_f32_16x16x32_bf16 v[160:163], a[164:167], a[8:11], v[160:163]
    ds_read_b64_tr_b16 a[186:187], v19 offset:36864
    v_mfma_f32_16x16x32_bf16 v[164:167], a[164:167], a[12:15], 0
    ds_read_b64_tr_b16 a[188:189], v19 offset:40960
    v_mfma_f32_16x16x32_bf16 v[164:167], a[160:163], a[4:7], v[164:167]
    s_waitcnt lgkmcnt(9)
    buffer_load_dword v77, v70, s[16:19], s44 offen
    v_mfma_f32_16x16x32_bf16 v[172:175], a[168:171], a[4:7], 0
    s_waitcnt lgkmcnt(7)
    ds_read_b64_tr_b16 a[190:191], v19 offset:45056
    ds_read_b64_tr_b16 a[160:161], v12 offset:49152
    v_mfma_f32_16x16x32_bf16 v[172:175], a[172:175], a[12:15], v[172:175]
    ds_read_b64_tr_b16 a[162:163], v12 offset:53248
    v_mfma_f32_16x16x32_bf16 v[168:171], a[172:175], a[8:11], 0
    ds_read_b64_tr_b16 a[164:165], v12 offset:57344
    v_mfma_f32_16x16x32_bf16 v[168:171], a[168:171], a[0:3], v[168:171]
    s_waitcnt lgkmcnt(9)
    ds_read_b64_tr_b16 a[166:167], v12 offset:61440
    v_mfma_f32_16x16x32_bf16 v[176:179], a[176:179], a[0:3], 0
    s_waitcnt lgkmcnt(8)
    ds_read_b64_tr_b16 a[168:169], v13 offset:49152
    v_mfma_f32_16x16x32_bf16 v[176:179], a[180:183], a[8:11], v[176:179]
    ds_read_b64_tr_b16 a[170:171], v13 offset:53248
    v_mfma_f32_16x16x32_bf16 v[180:183], a[180:183], a[12:15], 0
    ds_read_b64_tr_b16 a[172:173], v13 offset:57344
    v_mfma_f32_16x16x32_bf16 v[180:183], a[176:179], a[4:7], v[180:183]
    s_waitcnt lgkmcnt(9)
    ds_read_b64_tr_b16 a[174:175], v13 offset:61440
    v_mfma_f32_16x16x32_bf16 v[188:191], a[184:187], a[4:7], 0
    s_waitcnt lgkmcnt(8)
    ds_read_b64_tr_b16 a[176:177], v14 offset:49152
    v_mfma_f32_16x16x32_bf16 v[188:191], a[188:191], a[12:15], v[188:191]
    ds_read_b64_tr_b16 a[178:179], v14 offset:53248
    v_mfma_f32_16x16x32_bf16 v[184:187], a[188:191], a[8:11], 0
    ds_read_b64_tr_b16 a[180:181], v14 offset:57344
    v_mfma_f32_16x16x32_bf16 v[184:187], a[184:187], a[0:3], v[184:187]
    s_waitcnt lgkmcnt(9)
    ds_read_b64_tr_b16 a[182:183], v14 offset:61440
    v_mfma_f32_16x16x32_bf16 v[192:195], a[160:163], a[0:3], 0
    s_waitcnt lgkmcnt(8)
    ds_read_b64_tr_b16 a[184:185], v15 offset:49152
    v_mfma_f32_16x16x32_bf16 v[192:195], a[164:167], a[8:11], v[192:195]
    ds_read_b64_tr_b16 a[186:187], v15 offset:53248
    v_mfma_f32_16x16x32_bf16 v[196:199], a[164:167], a[12:15], 0
    ds_read_b64_tr_b16 a[188:189], v15 offset:57344
    v_mfma_f32_16x16x32_bf16 v[196:199], a[160:163], a[4:7], v[196:199]
    s_waitcnt lgkmcnt(9)
    ds_read_b64_tr_b16 a[190:191], v15 offset:61440
    v_mfma_f32_16x16x32_bf16 v[204:207], a[168:171], a[4:7], 0
    s_waitcnt lgkmcnt(8)
    ds_read_b64_tr_b16 a[160:161], v16 offset:49152
    v_mfma_f32_16x16x32_bf16 v[204:207], a[172:175], a[12:15], v[204:207]
    ds_read_b64_tr_b16 a[162:163], v16 offset:53248
    v_mfma_f32_16x16x32_bf16 v[200:203], a[172:175], a[8:11], 0
    ds_read_b64_tr_b16 a[164:165], v16 offset:57344
    v_mfma_f32_16x16x32_bf16 v[200:203], a[168:171], a[0:3], v[200:203]
    s_waitcnt lgkmcnt(9)
    ds_read_b64_tr_b16 a[166:167], v16 offset:61440
    v_mfma_f32_16x16x32_bf16 v[208:211], a[176:179], a[0:3], 0
    s_waitcnt lgkmcnt(8)
    ds_read_b64_tr_b16 a[168:169], v17 offset:49152
    v_mfma_f32_16x16x32_bf16 v[208:211], a[180:183], a[8:11], v[208:211]
    ds_read_b64_tr_b16 a[170:171], v17 offset:53248
    v_mfma_f32_16x16x32_bf16 v[212:215], a[180:183], a[12:15], 0
    ds_read_b64_tr_b16 a[172:173], v17 offset:57344
    v_mfma_f32_16x16x32_bf16 v[212:215], a[176:179], a[4:7], v[212:215]
    s_waitcnt lgkmcnt(9)
    ds_read_b64_tr_b16 a[174:175], v17 offset:61440
    v_mfma_f32_16x16x32_bf16 v[220:223], a[184:187], a[4:7], 0
    s_waitcnt lgkmcnt(8)
    ds_read_b64_tr_b16 a[176:177], v18 offset:49152
    v_mfma_f32_16x16x32_bf16 v[220:223], a[188:191], a[12:15], v[220:223]
Ltour0_0:
    s_cbranch_execz Ltour0_4
    ds_read_b64_tr_b16 a[178:179], v18 offset:53248
    v_mfma_f32_16x16x32_bf16 v[216:219], a[188:191], a[8:11], 0
    ds_read_b64_tr_b16 a[180:181], v18 offset:57344
    v_mfma_f32_16x16x32_bf16 v[216:219], a[184:187], a[0:3], v[216:219]
    s_waitcnt lgkmcnt(9)
    ds_read_b64_tr_b16 a[182:183], v18 offset:61440
    v_mfma_f32_16x16x32_bf16 v[224:227], a[160:163], a[0:3], 0
    s_waitcnt lgkmcnt(8)
    ds_read_b64_tr_b16 a[184:185], v19 offset:49152
    v_mfma_f32_16x16x32_bf16 v[224:227], a[164:167], a[8:11], v[224:227]
    ds_read_b64_tr_b16 a[186:187], v19 offset:53248
    v_mfma_f32_16x16x32_bf16 v[228:231], a[164:167], a[12:15], 0
    ds_read_b64_tr_b16 a[188:189], v19 offset:57344
    v_mfma_f32_16x16x32_bf16 v[228:231], a[160:163], a[4:7], v[228:231]
    s_waitcnt lgkmcnt(9)
    ds_read_b64_tr_b16 a[190:191], v19 offset:61440
    s_barrier
    v_mfma_f32_16x16x32_bf16 v[236:239], a[168:171], a[4:7], 0
    s_waitcnt lgkmcnt(8)
    ds_read_b64_tr_b16 a[160:161], v20 offset:0
    v_mfma_f32_16x16x32_bf16 v[236:239], a[172:175], a[12:15], v[236:239]
    ds_read_b64_tr_b16 a[162:163], v20 offset:4096
    v_mfma_f32_16x16x32_bf16 v[232:235], a[172:175], a[8:11], 0
    ds_read_b64_tr_b16 a[164:165], v20 offset:8192
    v_mfma_f32_16x16x32_bf16 v[232:235], a[168:171], a[0:3], v[232:235]
    s_waitcnt lgkmcnt(9)
    buffer_load_dwordx4 a[48:51], v51, s[24:27], s46 offen offset:768 sc1
    v_mfma_f32_16x16x32_bf16 v[240:243], a[176:179], a[0:3], 0
    s_waitcnt lgkmcnt(7)
    ds_read_b64_tr_b16 a[166:167], v20 offset:12288
    ds_read_b64_tr_b16 a[168:169], v21 offset:0
    v_mfma_f32_16x16x32_bf16 v[240:243], a[180:183], a[8:11], v[240:243]
    ds_read_b64_tr_b16 a[170:171], v21 offset:4096
    v_mfma_f32_16x16x32_bf16 v[244:247], a[180:183], a[12:15], 0
    ds_read_b64_tr_b16 a[172:173], v21 offset:8192
    v_mfma_f32_16x16x32_bf16 v[244:247], a[176:179], a[4:7], v[244:247]
    s_waitcnt lgkmcnt(9)
    buffer_load_dwordx4 a[56:59], v51, s[24:27], s46 offen offset:896 sc1
    v_mfma_f32_16x16x32_bf16 v[252:255], a[184:187], a[4:7], 0
    s_waitcnt lgkmcnt(7)
    ds_read_b64_tr_b16 a[174:175], v21 offset:12288
    ds_read_b64_tr_b16 a[176:177], v22 offset:0
    v_mfma_f32_16x16x32_bf16 v[252:255], a[188:191], a[12:15], v[252:255]
    ds_read_b64_tr_b16 a[178:179], v22 offset:4096
    v_mfma_f32_16x16x32_bf16 v[248:251], a[188:191], a[8:11], 0
    ds_read_b64_tr_b16 a[180:181], v22 offset:8192
    v_mfma_f32_16x16x32_bf16 v[248:251], a[184:187], a[0:3], v[248:251]
    s_waitcnt vmcnt(10)
    s_waitcnt lgkmcnt(9)
    buffer_load_dwordx4 a[52:55], v51, s[24:27], s43 offen offset:768 sc1
    v_mfma_f32_16x16x32_bf16 v[128:131], a[160:163], a[16:19], v[128:131]
    s_waitcnt vmcnt(10)
    s_waitcnt lgkmcnt(7)
    ds_read_b64_tr_b16 a[182:183], v22 offset:12288
    ds_read_b64_tr_b16 a[184:185], v23 offset:0
    v_mfma_f32_16x16x32_bf16 v[128:131], a[164:167], a[24:27], v[128:131]
    s_waitcnt vmcnt(8)
    ds_read_b64_tr_b16 a[186:187], v23 offset:4096
    v_mfma_f32_16x16x32_bf16 v[132:135], a[164:167], a[28:31], v[132:135]
    ds_read_b64_tr_b16 a[188:189], v23 offset:8192
    v_mfma_f32_16x16x32_bf16 v[132:135], a[160:163], a[20:23], v[132:135]
    s_waitcnt lgkmcnt(9)
    buffer_load_dwordx4 a[60:63], v51, s[24:27], s43 offen offset:896 sc1
    v_mfma_f32_16x16x32_bf16 v[140:143], a[168:171], a[20:23], v[140:143]
    s_waitcnt lgkmcnt(7)
    ds_read_b64_tr_b16 a[190:191], v23 offset:12288
    ds_read_b64_tr_b16 a[160:161], v24 offset:0
    v_mfma_f32_16x16x32_bf16 v[140:143], a[172:175], a[28:31], v[140:143]
    ds_read_b64_tr_b16 a[162:163], v24 offset:4096
    v_mfma_f32_16x16x32_bf16 v[136:139], a[172:175], a[24:27], v[136:139]
    ds_read_b64_tr_b16 a[164:165], v24 offset:8192
    v_mfma_f32_16x16x32_bf16 v[136:139], a[168:171], a[16:19], v[136:139]
    s_waitcnt lgkmcnt(9)
    buffer_load_dwordx4 a[64:67], v51, s[24:27], s46 offen offset:1024 sc1
    v_mfma_f32_16x16x32_bf16 v[144:147], a[176:179], a[16:19], v[144:147]
    s_waitcnt lgkmcnt(7)
    ds_read_b64_tr_b16 a[166:167], v24 offset:12288
    ds_read_b64_tr_b16 a[168:169], v25 offset:0
    v_mfma_f32_16x16x32_bf16 v[144:147], a[180:183], a[24:27], v[144:147]
    ds_read_b64_tr_b16 a[170:171], v25 offset:4096
    v_mfma_f32_16x16x32_bf16 v[148:151], a[180:183], a[28:31], v[148:151]
    ds_read_b64_tr_b16 a[172:173], v25 offset:8192
    v_mfma_f32_16x16x32_bf16 v[148:151], a[176:179], a[20:23], v[148:151]
    s_waitcnt lgkmcnt(9)
    buffer_load_dwordx4 a[72:75], v51, s[24:27], s46 offen offset:1152 sc1
    v_mfma_f32_16x16x32_bf16 v[156:159], a[184:187], a[20:23], v[156:159]
    s_waitcnt lgkmcnt(7)
    ds_read_b64_tr_b16 a[174:175], v25 offset:12288
    ds_read_b64_tr_b16 a[176:177], v26 offset:0
    v_mfma_f32_16x16x32_bf16 v[156:159], a[188:191], a[28:31], v[156:159]
    ds_read_b64_tr_b16 a[178:179], v26 offset:4096
    v_mfma_f32_16x16x32_bf16 v[152:155], a[188:191], a[24:27], v[152:155]
    ds_read_b64_tr_b16 a[180:181], v26 offset:8192
    v_mfma_f32_16x16x32_bf16 v[152:155], a[184:187], a[16:19], v[152:155]
    s_waitcnt lgkmcnt(9)
    buffer_load_dwordx4 a[68:71], v51, s[24:27], s43 offen offset:1024 sc1
    v_mfma_f32_16x16x32_bf16 v[160:163], a[160:163], a[16:19], v[160:163]
    s_waitcnt lgkmcnt(7)
    ds_read_b64_tr_b16 a[182:183], v26 offset:12288
    ds_read_b64_tr_b16 a[184:185], v27 offset:0
    v_mfma_f32_16x16x32_bf16 v[160:163], a[164:167], a[24:27], v[160:163]
    ds_read_b64_tr_b16 a[186:187], v27 offset:4096
    v_mfma_f32_16x16x32_bf16 v[164:167], a[164:167], a[28:31], v[164:167]
    ds_read_b64_tr_b16 a[188:189], v27 offset:8192
    v_mfma_f32_16x16x32_bf16 v[164:167], a[160:163], a[20:23], v[164:167]
    s_waitcnt lgkmcnt(9)
    buffer_load_dwordx4 a[76:79], v51, s[24:27], s43 offen offset:1152 sc1
    v_mfma_f32_16x16x32_bf16 v[172:175], a[168:171], a[20:23], v[172:175]
    s_waitcnt lgkmcnt(7)
    ds_read_b64_tr_b16 a[190:191], v27 offset:12288
    ds_read_b64_tr_b16 a[160:161], v20 offset:16384
    v_mfma_f32_16x16x32_bf16 v[172:175], a[172:175], a[28:31], v[172:175]
    ds_read_b64_tr_b16 a[162:163], v20 offset:20480
    v_mfma_f32_16x16x32_bf16 v[168:171], a[172:175], a[24:27], v[168:171]
    ds_read_b64_tr_b16 a[164:165], v20 offset:24576
    v_mfma_f32_16x16x32_bf16 v[168:171], a[168:171], a[16:19], v[168:171]
    s_waitcnt lgkmcnt(9)
    ds_read_b64_tr_b16 a[166:167], v20 offset:28672
    v_mfma_f32_16x16x32_bf16 v[176:179], a[176:179], a[16:19], v[176:179]
    s_waitcnt lgkmcnt(8)
    ds_read_b64_tr_b16 a[168:169], v21 offset:16384
    v_mfma_f32_16x16x32_bf16 v[176:179], a[180:183], a[24:27], v[176:179]
    ds_read_b64_tr_b16 a[170:171], v21 offset:20480
    v_mfma_f32_16x16x32_bf16 v[180:183], a[180:183], a[28:31], v[180:183]
    ds_read_b64_tr_b16 a[172:173], v21 offset:24576
    v_mfma_f32_16x16x32_bf16 v[180:183], a[176:179], a[20:23], v[180:183]
    s_waitcnt lgkmcnt(9)
    ds_read_b64_tr_b16 a[174:175], v21 offset:28672
    v_mfma_f32_16x16x32_bf16 v[188:191], a[184:187], a[20:23], v[188:191]
    s_waitcnt lgkmcnt(8)
    ds_read_b64_tr_b16 a[176:177], v22 offset:16384
    v_mfma_f32_16x16x32_bf16 v[188:191], a[188:191], a[28:31], v[188:191]
    ds_read_b64_tr_b16 a[178:179], v22 offset:20480
    v_mfma_f32_16x16x32_bf16 v[184:187], a[188:191], a[24:27], v[184:187]
    ds_read_b64_tr_b16 a[180:181], v22 offset:24576
    v_mfma_f32_16x16x32_bf16 v[184:187], a[184:187], a[16:19], v[184:187]
    s_waitcnt lgkmcnt(9)
    ds_read_b64_tr_b16 a[182:183], v22 offset:28672
    v_mfma_f32_16x16x32_bf16 v[192:195], a[160:163], a[16:19], v[192:195]
    s_waitcnt lgkmcnt(8)
    ds_read_b64_tr_b16 a[184:185], v23 offset:16384
    v_mfma_f32_16x16x32_bf16 v[192:195], a[164:167], a[24:27], v[192:195]
    ds_read_b64_tr_b16 a[186:187], v23 offset:20480
    v_mfma_f32_16x16x32_bf16 v[196:199], a[164:167], a[28:31], v[196:199]
    ds_read_b64_tr_b16 a[188:189], v23 offset:24576
    v_mfma_f32_16x16x32_bf16 v[196:199], a[160:163], a[20:23], v[196:199]
    s_waitcnt lgkmcnt(9)
    ds_read_b64_tr_b16 a[190:191], v23 offset:28672
    v_mfma_f32_16x16x32_bf16 v[204:207], a[168:171], a[20:23], v[204:207]
    s_waitcnt lgkmcnt(8)
    ds_read_b64_tr_b16 a[160:161], v24 offset:16384
    v_mfma_f32_16x16x32_bf16 v[204:207], a[172:175], a[28:31], v[204:207]
    ds_read_b64_tr_b16 a[162:163], v24 offset:20480
    v_mfma_f32_16x16x32_bf16 v[200:203], a[172:175], a[24:27], v[200:203]
    ds_read_b64_tr_b16 a[164:165], v24 offset:24576
    v_mfma_f32_16x16x32_bf16 v[200:203], a[168:171], a[16:19], v[200:203]
    s_waitcnt lgkmcnt(9)
    ds_read_b64_tr_b16 a[166:167], v24 offset:28672
    v_mfma_f32_16x16x32_bf16 v[208:211], a[176:179], a[16:19], v[208:211]
    s_waitcnt lgkmcnt(8)
    ds_read_b64_tr_b16 a[168:169], v25 offset:16384
    v_mfma_f32_16x16x32_bf16 v[208:211], a[180:183], a[24:27], v[208:211]
    ds_read_b64_tr_b16 a[170:171], v25 offset:20480
    v_mfma_f32_16x16x32_bf16 v[212:215], a[180:183], a[28:31], v[212:215]
    ds_read_b64_tr_b16 a[172:173], v25 offset:24576
    v_mfma_f32_16x16x32_bf16 v[212:215], a[176:179], a[20:23], v[212:215]
    s_waitcnt lgkmcnt(9)
    ds_read_b64_tr_b16 a[174:175], v25 offset:28672
    v_mfma_f32_16x16x32_bf16 v[220:223], a[184:187], a[20:23], v[220:223]
    s_waitcnt lgkmcnt(8)
    ds_read_b64_tr_b16 a[176:177], v26 offset:16384
    v_mfma_f32_16x16x32_bf16 v[220:223], a[188:191], a[28:31], v[220:223]
    ds_read_b64_tr_b16 a[178:179], v26 offset:20480
    v_mfma_f32_16x16x32_bf16 v[216:219], a[188:191], a[24:27], v[216:219]
    ds_read_b64_tr_b16 a[180:181], v26 offset:24576
    v_mfma_f32_16x16x32_bf16 v[216:219], a[184:187], a[16:19], v[216:219]
    s_waitcnt lgkmcnt(9)
    ds_read_b64_tr_b16 a[182:183], v26 offset:28672
    v_mfma_f32_16x16x32_bf16 v[224:227], a[160:163], a[16:19], v[224:227]
    s_waitcnt lgkmcnt(8)
    ds_read_b64_tr_b16 a[184:185], v27 offset:16384
    v_mfma_f32_16x16x32_bf16 v[224:227], a[164:167], a[24:27], v[224:227]
    ds_read_b64_tr_b16 a[186:187], v27 offset:20480
    v_mfma_f32_16x16x32_bf16 v[228:231], a[164:167], a[28:31], v[228:231]
    ds_read_b64_tr_b16 a[188:189], v27 offset:24576
    v_mfma_f32_16x16x32_bf16 v[228:231], a[160:163], a[20:23], v[228:231]
    s_waitcnt lgkmcnt(9)
    ds_read_b64_tr_b16 a[190:191], v27 offset:28672
    s_barrier
    v_mfma_f32_16x16x32_bf16 v[236:239], a[168:171], a[20:23], v[236:239]
    s_waitcnt lgkmcnt(8)
    ds_read_b64_tr_b16 a[160:161], v20 offset:32768
    v_mfma_f32_16x16x32_bf16 v[236:239], a[172:175], a[28:31], v[236:239]
    s_add_u32 s49, s44, 2097152
    ds_read_b64_tr_b16 a[162:163], v20 offset:36864
    v_mfma_f32_16x16x32_bf16 v[232:235], a[172:175], a[24:27], v[232:235]
    s_add_u32 m0, s42, 0
    ds_read_b64_tr_b16 a[164:165], v20 offset:40960
    v_mfma_f32_16x16x32_bf16 v[232:235], a[168:171], a[16:19], v[232:235]
    s_waitcnt lgkmcnt(9)
    buffer_load_dwordx4 v42, s[16:19], s49 offen lds
    v_mfma_f32_16x16x32_bf16 v[240:243], a[176:179], a[16:19], v[240:243]
    s_waitcnt lgkmcnt(7)
    ds_read_b64_tr_b16 a[166:167], v20 offset:45056
    ds_read_b64_tr_b16 a[168:169], v21 offset:32768
    v_mfma_f32_16x16x32_bf16 v[240:243], a[180:183], a[24:27], v[240:243]
    ds_read_b64_tr_b16 a[170:171], v21 offset:36864
    v_mfma_f32_16x16x32_bf16 v[244:247], a[180:183], a[28:31], v[244:247]
    ds_read_b64_tr_b16 a[172:173], v21 offset:40960
    v_mfma_f32_16x16x32_bf16 v[244:247], a[176:179], a[20:23], v[244:247]
    s_waitcnt lgkmcnt(9)
    buffer_load_dwordx4 v43, s[16:19], s49 offen offset:1024 lds
    v_mfma_f32_16x16x32_bf16 v[252:255], a[184:187], a[20:23], v[252:255]
    s_waitcnt lgkmcnt(7)
    ds_read_b64_tr_b16 a[174:175], v21 offset:45056
    ds_read_b64_tr_b16 a[176:177], v22 offset:32768
    v_mfma_f32_16x16x32_bf16 v[252:255], a[188:191], a[28:31], v[252:255]
    ds_read_b64_tr_b16 a[178:179], v22 offset:36864
    v_mfma_f32_16x16x32_bf16 v[248:251], a[188:191], a[24:27], v[248:251]
    ds_read_b64_tr_b16 a[180:181], v22 offset:40960
    v_mfma_f32_16x16x32_bf16 v[248:251], a[184:187], a[16:19], v[248:251]
    s_waitcnt vmcnt(14)
    s_waitcnt lgkmcnt(9)
    buffer_load_dwordx4 v44, s[16:19], s49 offen offset:2048 lds
    v_mfma_f32_16x16x32_bf16 v[128:131], a[160:163], a[32:35], v[128:131]
    s_waitcnt vmcnt(14)
    s_waitcnt lgkmcnt(7)
    ds_read_b64_tr_b16 a[182:183], v22 offset:45056
    ds_read_b64_tr_b16 a[184:185], v23 offset:32768
    v_mfma_f32_16x16x32_bf16 v[128:131], a[164:167], a[40:43], v[128:131]
    s_waitcnt vmcnt(12)
    ds_read_b64_tr_b16 a[186:187], v23 offset:36864
    v_mfma_f32_16x16x32_bf16 v[132:135], a[164:167], a[44:47], v[132:135]
    ds_read_b64_tr_b16 a[188:189], v23 offset:40960
    v_mfma_f32_16x16x32_bf16 v[132:135], a[160:163], a[36:39], v[132:135]
    s_waitcnt lgkmcnt(9)
    buffer_load_dwordx4 v45, s[16:19], s49 offen offset:3072 lds
    v_mfma_f32_16x16x32_bf16 v[140:143], a[168:171], a[36:39], v[140:143]
    s_waitcnt lgkmcnt(7)
    ds_read_b64_tr_b16 a[190:191], v23 offset:45056
    ds_read_b64_tr_b16 a[160:161], v24 offset:32768
    v_mfma_f32_16x16x32_bf16 v[140:143], a[172:175], a[44:47], v[140:143]
    s_add_u32 s49, s44, 2097408
    ds_read_b64_tr_b16 a[162:163], v24 offset:36864
    v_mfma_f32_16x16x32_bf16 v[136:139], a[172:175], a[40:43], v[136:139]
    s_add_u32 m0, s42, 16384
    ds_read_b64_tr_b16 a[164:165], v24 offset:40960
    v_mfma_f32_16x16x32_bf16 v[136:139], a[168:171], a[32:35], v[136:139]
    s_waitcnt lgkmcnt(9)
    buffer_load_dwordx4 v42, s[16:19], s49 offen lds
    v_mfma_f32_16x16x32_bf16 v[144:147], a[176:179], a[32:35], v[144:147]
    s_waitcnt lgkmcnt(7)
    ds_read_b64_tr_b16 a[166:167], v24 offset:45056
    ds_read_b64_tr_b16 a[168:169], v25 offset:32768
    v_mfma_f32_16x16x32_bf16 v[144:147], a[180:183], a[40:43], v[144:147]
    ds_read_b64_tr_b16 a[170:171], v25 offset:36864
    v_mfma_f32_16x16x32_bf16 v[148:151], a[180:183], a[44:47], v[148:151]
    ds_read_b64_tr_b16 a[172:173], v25 offset:40960
    v_mfma_f32_16x16x32_bf16 v[148:151], a[176:179], a[36:39], v[148:151]
    s_waitcnt lgkmcnt(9)
    buffer_load_dwordx4 v43, s[16:19], s49 offen offset:1024 lds
    v_mfma_f32_16x16x32_bf16 v[156:159], a[184:187], a[36:39], v[156:159]
    s_waitcnt lgkmcnt(7)
    ds_read_b64_tr_b16 a[174:175], v25 offset:45056
    ds_read_b64_tr_b16 a[176:177], v26 offset:32768
    v_mfma_f32_16x16x32_bf16 v[156:159], a[188:191], a[44:47], v[156:159]
    ds_read_b64_tr_b16 a[178:179], v26 offset:36864
    v_mfma_f32_16x16x32_bf16 v[152:155], a[188:191], a[40:43], v[152:155]
    ds_read_b64_tr_b16 a[180:181], v26 offset:40960
    v_mfma_f32_16x16x32_bf16 v[152:155], a[184:187], a[32:35], v[152:155]
    s_waitcnt lgkmcnt(9)
    buffer_load_dwordx4 v44, s[16:19], s49 offen offset:2048 lds
    v_mfma_f32_16x16x32_bf16 v[160:163], a[160:163], a[32:35], v[160:163]
    s_waitcnt lgkmcnt(7)
    ds_read_b64_tr_b16 a[182:183], v26 offset:45056
    ds_read_b64_tr_b16 a[184:185], v27 offset:32768
    v_mfma_f32_16x16x32_bf16 v[160:163], a[164:167], a[40:43], v[160:163]
    ds_read_b64_tr_b16 a[186:187], v27 offset:36864
    v_mfma_f32_16x16x32_bf16 v[164:167], a[164:167], a[44:47], v[164:167]
    ds_read_b64_tr_b16 a[188:189], v27 offset:40960
    v_mfma_f32_16x16x32_bf16 v[164:167], a[160:163], a[36:39], v[164:167]
    s_waitcnt lgkmcnt(9)
    buffer_load_dwordx4 v45, s[16:19], s49 offen offset:3072 lds
    v_mfma_f32_16x16x32_bf16 v[172:175], a[168:171], a[36:39], v[172:175]
    s_waitcnt lgkmcnt(7)
    ds_read_b64_tr_b16 a[190:191], v27 offset:45056
    ds_read_b64_tr_b16 a[160:161], v20 offset:49152
    v_mfma_f32_16x16x32_bf16 v[172:175], a[172:175], a[44:47], v[172:175]
    ds_read_b64_tr_b16 a[162:163], v20 offset:53248
    v_mfma_f32_16x16x32_bf16 v[168:171], a[172:175], a[40:43], v[168:171]
    ds_read_b64_tr_b16 a[164:165], v20 offset:57344
    v_mfma_f32_16x16x32_bf16 v[168:171], a[168:171], a[32:35], v[168:171]
    s_waitcnt lgkmcnt(9)
    buffer_load_dwordx4 a[80:83], v51, s[24:27], s46 offen offset:1280 sc1
    v_mfma_f32_16x16x32_bf16 v[176:179], a[176:179], a[32:35], v[176:179]
    s_waitcnt lgkmcnt(7)
    ds_read_b64_tr_b16 a[166:167], v20 offset:61440
    ds_read_b64_tr_b16 a[168:169], v21 offset:49152
    v_mfma_f32_16x16x32_bf16 v[176:179], a[180:183], a[40:43], v[176:179]
    ds_read_b64_tr_b16 a[170:171], v21 offset:53248
    v_mfma_f32_16x16x32_bf16 v[180:183], a[180:183], a[44:47], v[180:183]
    ds_read_b64_tr_b16 a[172:173], v21 offset:57344
    v_mfma_f32_16x16x32_bf16 v[180:183], a[176:179], a[36:39], v[180:183]
    s_waitcnt lgkmcnt(9)
    buffer_load_dwordx4 a[88:91], v51, s[24:27], s46 offen offset:1408 sc1
    v_mfma_f32_16x16x32_bf16 v[188:191], a[184:187], a[36:39], v[188:191]
    s_waitcnt lgkmcnt(7)
    ds_read_b64_tr_b16 a[174:175], v21 offset:61440
    ds_read_b64_tr_b16 a[176:177], v22 offset:49152
    v_mfma_f32_16x16x32_bf16 v[188:191], a[188:191], a[44:47], v[188:191]
    ds_read_b64_tr_b16 a[178:179], v22 offset:53248
    v_mfma_f32_16x16x32_bf16 v[184:187], a[188:191], a[40:43], v[184:187]
    ds_read_b64_tr_b16 a[180:181], v22 offset:57344
    v_mfma_f32_16x16x32_bf16 v[184:187], a[184:187], a[32:35], v[184:187]
    s_waitcnt lgkmcnt(9)
    buffer_load_dwordx4 a[84:87], v51, s[24:27], s43 offen offset:1280 sc1
    v_mfma_f32_16x16x32_bf16 v[192:195], a[160:163], a[32:35], v[192:195]
    s_waitcnt lgkmcnt(7)
    ds_read_b64_tr_b16 a[182:183], v22 offset:61440
    ds_read_b64_tr_b16 a[184:185], v23 offset:49152
    v_mfma_f32_16x16x32_bf16 v[192:195], a[164:167], a[40:43], v[192:195]
    ds_read_b64_tr_b16 a[186:187], v23 offset:53248
    v_mfma_f32_16x16x32_bf16 v[196:199], a[164:167], a[44:47], v[196:199]
    ds_read_b64_tr_b16 a[188:189], v23 offset:57344
    v_mfma_f32_16x16x32_bf16 v[196:199], a[160:163], a[36:39], v[196:199]
    s_waitcnt lgkmcnt(9)
    buffer_load_dwordx4 a[92:95], v51, s[24:27], s43 offen offset:1408 sc1
    v_mfma_f32_16x16x32_bf16 v[204:207], a[168:171], a[36:39], v[204:207]
    s_waitcnt lgkmcnt(7)
    ds_read_b64_tr_b16 a[190:191], v23 offset:61440
    ds_read_b64_tr_b16 a[160:161], v24 offset:49152
    v_mfma_f32_16x16x32_bf16 v[204:207], a[172:175], a[44:47], v[204:207]
    ds_read_b64_tr_b16 a[162:163], v24 offset:53248
    v_mfma_f32_16x16x32_bf16 v[200:203], a[172:175], a[40:43], v[200:203]
    ds_read_b64_tr_b16 a[164:165], v24 offset:57344
    v_mfma_f32_16x16x32_bf16 v[200:203], a[168:171], a[32:35], v[200:203]
    s_waitcnt lgkmcnt(9)
    ds_read_b64_tr_b16 a[166:167], v24 offset:61440
    v_mfma_f32_16x16x32_bf16 v[208:211], a[176:179], a[32:35], v[208:211]
    s_waitcnt lgkmcnt(8)
    ds_read_b64_tr_b16 a[168:169], v25 offset:49152
    v_mfma_f32_16x16x32_bf16 v[208:211], a[180:183], a[40:43], v[208:211]
    ds_read_b64_tr_b16 a[170:171], v25 offset:53248
    v_mfma_f32_16x16x32_bf16 v[212:215], a[180:183], a[44:47], v[212:215]
    ds_read_b64_tr_b16 a[172:173], v25 offset:57344
    v_mfma_f32_16x16x32_bf16 v[212:215], a[176:179], a[36:39], v[212:215]
    s_waitcnt lgkmcnt(9)
    ds_read_b64_tr_b16 a[174:175], v25 offset:61440
    v_mfma_f32_16x16x32_bf16 v[220:223], a[184:187], a[36:39], v[220:223]
    s_waitcnt lgkmcnt(8)
    ds_read_b64_tr_b16 a[176:177], v26 offset:49152
    v_mfma_f32_16x16x32_bf16 v[220:223], a[188:191], a[44:47], v[220:223]
    ds_read_b64_tr_b16 a[178:179], v26 offset:53248
    v_mfma_f32_16x16x32_bf16 v[216:219], a[188:191], a[40:43], v[216:219]
    ds_read_b64_tr_b16 a[180:181], v26 offset:57344
    v_mfma_f32_16x16x32_bf16 v[216:219], a[184:187], a[32:35], v[216:219]
    s_waitcnt lgkmcnt(9)
    ds_read_b64_tr_b16 a[182:183], v26 offset:61440
    v_mfma_f32_16x16x32_bf16 v[224:227], a[160:163], a[32:35], v[224:227]
    s_waitcnt lgkmcnt(8)
    ds_read_b64_tr_b16 a[184:185], v27 offset:49152
    v_mfma_f32_16x16x32_bf16 v[224:227], a[164:167], a[40:43], v[224:227]
    ds_read_b64_tr_b16 a[186:187], v27 offset:53248
    v_mfma_f32_16x16x32_bf16 v[228:231], a[164:167], a[44:47], v[228:231]
    ds_read_b64_tr_b16 a[188:189], v27 offset:57344
    v_mfma_f32_16x16x32_bf16 v[228:231], a[160:163], a[36:39], v[228:231]
    s_waitcnt lgkmcnt(9)
    ds_read_b64_tr_b16 a[190:191], v27 offset:61440
    s_barrier
    v_mfma_f32_16x16x32_bf16 v[236:239], a[168:171], a[36:39], v[236:239]
    s_waitcnt lgkmcnt(8)
    ds_read_b64_tr_b16 a[160:161], v28 offset:0
    v_mfma_f32_16x16x32_bf16 v[236:239], a[172:175], a[44:47], v[236:239]
    s_add_u32 s49, s44, 2621440
    ds_read_b64_tr_b16 a[162:163], v28 offset:4096
    v_mfma_f32_16x16x32_bf16 v[232:235], a[172:175], a[40:43], v[232:235]
    s_add_u32 m0, s42, 32768
    ds_read_b64_tr_b16 a[164:165], v28 offset:8192
    v_mfma_f32_16x16x32_bf16 v[232:235], a[168:171], a[32:35], v[232:235]
    s_waitcnt lgkmcnt(9)
    buffer_load_dwordx4 v42, s[16:19], s49 offen lds
    v_mfma_f32_16x16x32_bf16 v[240:243], a[176:179], a[32:35], v[240:243]
    s_waitcnt lgkmcnt(7)
    ds_read_b64_tr_b16 a[166:167], v28 offset:12288
    ds_read_b64_tr_b16 a[168:169], v29 offset:0
    v_mfma_f32_16x16x32_bf16 v[240:243], a[180:183], a[40:43], v[240:243]
    ds_read_b64_tr_b16 a[170:171], v29 offset:4096
    v_mfma_f32_16x16x32_bf16 v[244:247], a[180:183], a[44:47], v[244:247]
    ds_read_b64_tr_b16 a[172:173], v29 offset:8192
    v_mfma_f32_16x16x32_bf16 v[244:247], a[176:179], a[36:39], v[244:247]
    s_waitcnt lgkmcnt(9)
    buffer_load_dwordx4 v43, s[16:19], s49 offen offset:1024 lds
    v_mfma_f32_16x16x32_bf16 v[252:255], a[184:187], a[36:39], v[252:255]
    s_waitcnt lgkmcnt(7)
    ds_read_b64_tr_b16 a[174:175], v29 offset:12288
    ds_read_b64_tr_b16 a[176:177], v30 offset:0
    v_mfma_f32_16x16x32_bf16 v[252:255], a[188:191], a[44:47], v[252:255]
    ds_read_b64_tr_b16 a[178:179], v30 offset:4096
    v_mfma_f32_16x16x32_bf16 v[248:251], a[188:191], a[40:43], v[248:251]
    ds_read_b64_tr_b16 a[180:181], v30 offset:8192
    v_mfma_f32_16x16x32_bf16 v[248:251], a[184:187], a[32:35], v[248:251]
    s_waitcnt vmcnt(21)
    s_waitcnt lgkmcnt(9)
    buffer_load_dwordx4 v44, s[16:19], s49 offen offset:2048 lds
    v_mfma_f32_16x16x32_bf16 v[128:131], a[160:163], a[48:51], v[128:131]
    s_waitcnt vmcnt(21)
    s_waitcnt lgkmcnt(7)
    ds_read_b64_tr_b16 a[182:183], v30 offset:12288
    ds_read_b64_tr_b16 a[184:185], v31 offset:0
    v_mfma_f32_16x16x32_bf16 v[128:131], a[164:167], a[56:59], v[128:131]
    s_waitcnt vmcnt(19)
    ds_read_b64_tr_b16 a[186:187], v31 offset:4096
    v_mfma_f32_16x16x32_bf16 v[132:135], a[164:167], a[60:63], v[132:135]
    ds_read_b64_tr_b16 a[188:189], v31 offset:8192
    v_mfma_f32_16x16x32_bf16 v[132:135], a[160:163], a[52:55], v[132:135]
    s_waitcnt lgkmcnt(9)
    buffer_load_dwordx4 v45, s[16:19], s49 offen offset:3072 lds
    v_mfma_f32_16x16x32_bf16 v[140:143], a[168:171], a[52:55], v[140:143]
    s_waitcnt lgkmcnt(7)
    ds_read_b64_tr_b16 a[190:191], v31 offset:12288
    ds_read_b64_tr_b16 a[160:161], v32 offset:0
    v_mfma_f32_16x16x32_bf16 v[140:143], a[172:175], a[60:63], v[140:143]
    s_add_u32 s49, s44, 3145728
    ds_read_b64_tr_b16 a[162:163], v32 offset:4096
    v_mfma_f32_16x16x32_bf16 v[136:139], a[172:175], a[56:59], v[136:139]
    s_add_u32 m0, s42, 49152
    ds_read_b64_tr_b16 a[164:165], v32 offset:8192
    v_mfma_f32_16x16x32_bf16 v[136:139], a[168:171], a[48:51], v[136:139]
    s_waitcnt lgkmcnt(9)
    buffer_load_dwordx4 v42, s[16:19], s49 offen lds
    v_mfma_f32_16x16x32_bf16 v[144:147], a[176:179], a[48:51], v[144:147]
    s_waitcnt lgkmcnt(7)
    ds_read_b64_tr_b16 a[166:167], v32 offset:12288
    ds_read_b64_tr_b16 a[168:169], v33 offset:0
    v_mfma_f32_16x16x32_bf16 v[144:147], a[180:183], a[56:59], v[144:147]
    ds_read_b64_tr_b16 a[170:171], v33 offset:4096
    v_mfma_f32_16x16x32_bf16 v[148:151], a[180:183], a[60:63], v[148:151]
    ds_read_b64_tr_b16 a[172:173], v33 offset:8192
    v_mfma_f32_16x16x32_bf16 v[148:151], a[176:179], a[52:55], v[148:151]
    s_waitcnt lgkmcnt(9)
    buffer_load_dwordx4 v43, s[16:19], s49 offen offset:1024 lds
    v_mfma_f32_16x16x32_bf16 v[156:159], a[184:187], a[52:55], v[156:159]
    s_waitcnt lgkmcnt(7)
    ds_read_b64_tr_b16 a[174:175], v33 offset:12288
    ds_read_b64_tr_b16 a[176:177], v34 offset:0
    v_mfma_f32_16x16x32_bf16 v[156:159], a[188:191], a[60:63], v[156:159]
    ds_read_b64_tr_b16 a[178:179], v34 offset:4096
    v_mfma_f32_16x16x32_bf16 v[152:155], a[188:191], a[56:59], v[152:155]
    ds_read_b64_tr_b16 a[180:181], v34 offset:8192
    v_mfma_f32_16x16x32_bf16 v[152:155], a[184:187], a[48:51], v[152:155]
    s_waitcnt lgkmcnt(9)
    buffer_load_dwordx4 v44, s[16:19], s49 offen offset:2048 lds
    v_mfma_f32_16x16x32_bf16 v[160:163], a[160:163], a[48:51], v[160:163]
    s_waitcnt lgkmcnt(7)
    ds_read_b64_tr_b16 a[182:183], v34 offset:12288
    ds_read_b64_tr_b16 a[184:185], v35 offset:0
    v_mfma_f32_16x16x32_bf16 v[160:163], a[164:167], a[56:59], v[160:163]
    ds_read_b64_tr_b16 a[186:187], v35 offset:4096
    v_mfma_f32_16x16x32_bf16 v[164:167], a[164:167], a[60:63], v[164:167]
    ds_read_b64_tr_b16 a[188:189], v35 offset:8192
    v_mfma_f32_16x16x32_bf16 v[164:167], a[160:163], a[52:55], v[164:167]
    s_waitcnt lgkmcnt(9)
    buffer_load_dwordx4 v45, s[16:19], s49 offen offset:3072 lds
    v_mfma_f32_16x16x32_bf16 v[172:175], a[168:171], a[52:55], v[172:175]
    s_waitcnt lgkmcnt(7)
    ds_read_b64_tr_b16 a[190:191], v35 offset:12288
    ds_read_b64_tr_b16 a[160:161], v28 offset:16384
    v_mfma_f32_16x16x32_bf16 v[172:175], a[172:175], a[60:63], v[172:175]
    ds_read_b64_tr_b16 a[162:163], v28 offset:20480
    v_mfma_f32_16x16x32_bf16 v[168:171], a[172:175], a[56:59], v[168:171]
    ds_read_b64_tr_b16 a[164:165], v28 offset:24576
    v_mfma_f32_16x16x32_bf16 v[168:171], a[168:171], a[48:51], v[168:171]
    s_waitcnt lgkmcnt(9)
    buffer_load_dwordx4 a[96:99], v51, s[24:27], s46 offen offset:1536 sc1
    v_mfma_f32_16x16x32_bf16 v[176:179], a[176:179], a[48:51], v[176:179]
    s_waitcnt lgkmcnt(7)
    ds_read_b64_tr_b16 a[166:167], v28 offset:28672
    ds_read_b64_tr_b16 a[168:169], v29 offset:16384
    v_mfma_f32_16x16x32_bf16 v[176:179], a[180:183], a[56:59], v[176:179]
    ds_read_b64_tr_b16 a[170:171], v29 offset:20480
    v_mfma_f32_16x16x32_bf16 v[180:183], a[180:183], a[60:63], v[180:183]
    ds_read_b64_tr_b16 a[172:173], v29 offset:24576
    v_mfma_f32_16x16x32_bf16 v[180:183], a[176:179], a[52:55], v[180:183]
    s_waitcnt lgkmcnt(9)
    buffer_load_dwordx4 a[104:107], v51, s[24:27], s46 offen offset:1664 sc1
    v_mfma_f32_16x16x32_bf16 v[188:191], a[184:187], a[52:55], v[188:191]
    s_waitcnt lgkmcnt(7)
    ds_read_b64_tr_b16 a[174:175], v29 offset:28672
    ds_read_b64_tr_b16 a[176:177], v30 offset:16384
    v_mfma_f32_16x16x32_bf16 v[188:191], a[188:191], a[60:63], v[188:191]
    ds_read_b64_tr_b16 a[178:179], v30 offset:20480
    v_mfma_f32_16x16x32_bf16 v[184:187], a[188:191], a[56:59], v[184:187]
    ds_read_b64_tr_b16 a[180:181], v30 offset:24576
    v_mfma_f32_16x16x32_bf16 v[184:187], a[184:187], a[48:51], v[184:187]
    s_waitcnt lgkmcnt(9)
    buffer_load_dwordx4 a[100:103], v51, s[24:27], s43 offen offset:1536 sc1
    v_mfma_f32_16x16x32_bf16 v[192:195], a[160:163], a[48:51], v[192:195]
    s_waitcnt lgkmcnt(7)
    ds_read_b64_tr_b16 a[182:183], v30 offset:28672
    ds_read_b64_tr_b16 a[184:185], v31 offset:16384
    v_mfma_f32_16x16x32_bf16 v[192:195], a[164:167], a[56:59], v[192:195]
    ds_read_b64_tr_b16 a[186:187], v31 offset:20480
    v_mfma_f32_16x16x32_bf16 v[196:199], a[164:167], a[60:63], v[196:199]
    ds_read_b64_tr_b16 a[188:189], v31 offset:24576
    v_mfma_f32_16x16x32_bf16 v[196:199], a[160:163], a[52:55], v[196:199]
    s_waitcnt lgkmcnt(9)
    buffer_load_dwordx4 a[108:111], v51, s[24:27], s43 offen offset:1664 sc1
    v_mfma_f32_16x16x32_bf16 v[204:207], a[168:171], a[52:55], v[204:207]
    s_waitcnt lgkmcnt(7)
    ds_read_b64_tr_b16 a[190:191], v31 offset:28672
    ds_read_b64_tr_b16 a[160:161], v32 offset:16384
    v_mfma_f32_16x16x32_bf16 v[204:207], a[172:175], a[60:63], v[204:207]
    ds_read_b64_tr_b16 a[162:163], v32 offset:20480
    v_mfma_f32_16x16x32_bf16 v[200:203], a[172:175], a[56:59], v[200:203]
    ds_read_b64_tr_b16 a[164:165], v32 offset:24576
    v_mfma_f32_16x16x32_bf16 v[200:203], a[168:171], a[48:51], v[200:203]
    s_waitcnt lgkmcnt(9)
    ds_read_b64_tr_b16 a[166:167], v32 offset:28672
    v_mfma_f32_16x16x32_bf16 v[208:211], a[176:179], a[48:51], v[208:211]
    s_waitcnt lgkmcnt(8)
    ds_read_b64_tr_b16 a[168:169], v33 offset:16384
    v_mfma_f32_16x16x32_bf16 v[208:211], a[180:183], a[56:59], v[208:211]
    ds_read_b64_tr_b16 a[170:171], v33 offset:20480
    v_mfma_f32_16x16x32_bf16 v[212:215], a[180:183], a[60:63], v[212:215]
    ds_read_b64_tr_b16 a[172:173], v33 offset:24576
    v_mfma_f32_16x16x32_bf16 v[212:215], a[176:179], a[52:55], v[212:215]
    s_waitcnt lgkmcnt(9)
    ds_read_b64_tr_b16 a[174:175], v33 offset:28672
    v_mfma_f32_16x16x32_bf16 v[220:223], a[184:187], a[52:55], v[220:223]
    s_waitcnt lgkmcnt(8)
    ds_read_b64_tr_b16 a[176:177], v34 offset:16384
    v_mfma_f32_16x16x32_bf16 v[220:223], a[188:191], a[60:63], v[220:223]
    ds_read_b64_tr_b16 a[178:179], v34 offset:20480
    v_mfma_f32_16x16x32_bf16 v[216:219], a[188:191], a[56:59], v[216:219]
    ds_read_b64_tr_b16 a[180:181], v34 offset:24576
    v_mfma_f32_16x16x32_bf16 v[216:219], a[184:187], a[48:51], v[216:219]
    s_waitcnt lgkmcnt(9)
    ds_read_b64_tr_b16 a[182:183], v34 offset:28672
    v_mfma_f32_16x16x32_bf16 v[224:227], a[160:163], a[48:51], v[224:227]
    s_waitcnt lgkmcnt(8)
    ds_read_b64_tr_b16 a[184:185], v35 offset:16384
    v_mfma_f32_16x16x32_bf16 v[224:227], a[164:167], a[56:59], v[224:227]
    ds_read_b64_tr_b16 a[186:187], v35 offset:20480
    v_mfma_f32_16x16x32_bf16 v[228:231], a[164:167], a[60:63], v[228:231]
    ds_read_b64_tr_b16 a[188:189], v35 offset:24576
    v_mfma_f32_16x16x32_bf16 v[228:231], a[160:163], a[52:55], v[228:231]
    s_waitcnt lgkmcnt(9)
    ds_read_b64_tr_b16 a[190:191], v35 offset:28672
    s_waitcnt vmcnt(16)
    s_barrier
    v_mfma_f32_16x16x32_bf16 v[236:239], a[168:171], a[52:55], v[236:239]
    s_waitcnt lgkmcnt(8)
    ds_read_b64_tr_b16 a[160:161], v12 offset:0
    v_mfma_f32_16x16x32_bf16 v[236:239], a[172:175], a[60:63], v[236:239]
    s_add_u32 s49, s44, 3670016
    ds_read_b64_tr_b16 a[162:163], v12 offset:4096
    v_mfma_f32_16x16x32_bf16 v[232:235], a[172:175], a[56:59], v[232:235]
    s_add_u32 m0, s42, 65536
    ds_read_b64_tr_b16 a[164:165], v12 offset:8192
    v_mfma_f32_16x16x32_bf16 v[232:235], a[168:171], a[48:51], v[232:235]
    s_waitcnt lgkmcnt(9)
    buffer_load_dwordx4 v42, s[16:19], s49 offen lds
    v_mfma_f32_16x16x32_bf16 v[240:243], a[176:179], a[48:51], v[240:243]
    s_waitcnt lgkmcnt(7)
    ds_read_b64_tr_b16 a[166:167], v12 offset:12288
    ds_read_b64_tr_b16 a[168:169], v13 offset:0
    v_mfma_f32_16x16x32_bf16 v[240:243], a[180:183], a[56:59], v[240:243]
Ltour0_1:
    s_cbranch_execz Ltour0_5
    ds_read_b64_tr_b16 a[170:171], v13 offset:4096
    v_mfma_f32_16x16x32_bf16 v[244:247], a[180:183], a[60:63], v[244:247]
    ds_read_b64_tr_b16 a[172:173], v13 offset:8192
    v_mfma_f32_16x16x32_bf16 v[244:247], a[176:179], a[52:55], v[244:247]
    s_waitcnt lgkmcnt(9)
    buffer_load_dwordx4 v43, s[16:19], s49 offen offset:1024 lds
    v_mfma_f32_16x16x32_bf16 v[252:255], a[184:187], a[52:55], v[252:255]
    s_waitcnt lgkmcnt(7)
    ds_read_b64_tr_b16 a[174:175], v13 offset:12288
    ds_read_b64_tr_b16 a[176:177], v14 offset:0
    v_mfma_f32_16x16x32_bf16 v[252:255], a[188:191], a[60:63], v[252:255]
    ds_read_b64_tr_b16 a[178:179], v14 offset:4096
    v_mfma_f32_16x16x32_bf16 v[248:251], a[188:191], a[56:59], v[248:251]
    ds_read_b64_tr_b16 a[180:181], v14 offset:8192
    v_mfma_f32_16x16x32_bf16 v[248:251], a[184:187], a[48:51], v[248:251]
    s_waitcnt lgkmcnt(9)
    buffer_load_dwordx4 v44, s[16:19], s49 offen offset:2048 lds
    v_mfma_f32_16x16x32_bf16 v[128:131], a[160:163], a[64:67], v[128:131]
    s_waitcnt lgkmcnt(7)
    ds_read_b64_tr_b16 a[182:183], v14 offset:12288
    ds_read_b64_tr_b16 a[184:185], v15 offset:0
    v_mfma_f32_16x16x32_bf16 v[128:131], a[164:167], a[72:75], v[128:131]
    ds_read_b64_tr_b16 a[186:187], v15 offset:4096
    v_mfma_f32_16x16x32_bf16 v[132:135], a[164:167], a[76:79], v[132:135]
    ds_read_b64_tr_b16 a[188:189], v15 offset:8192
    v_mfma_f32_16x16x32_bf16 v[132:135], a[160:163], a[68:71], v[132:135]
    s_waitcnt lgkmcnt(9)
    buffer_load_dwordx4 v45, s[16:19], s49 offen offset:3072 lds
    v_mfma_f32_16x16x32_bf16 v[140:143], a[168:171], a[68:71], v[140:143]
    s_waitcnt lgkmcnt(7)
    ds_read_b64_tr_b16 a[190:191], v15 offset:12288
    ds_read_b64_tr_b16 a[160:161], v16 offset:0
    v_mfma_f32_16x16x32_bf16 v[140:143], a[172:175], a[76:79], v[140:143]
    s_add_u32 s49, s44, 4194304
    ds_read_b64_tr_b16 a[162:163], v16 offset:4096
    v_mfma_f32_16x16x32_bf16 v[136:139], a[172:175], a[72:75], v[136:139]
    s_add_u32 m0, s42, 81920
    ds_read_b64_tr_b16 a[164:165], v16 offset:8192
    v_mfma_f32_16x16x32_bf16 v[136:139], a[168:171], a[64:67], v[136:139]
    s_waitcnt lgkmcnt(9)
    buffer_load_dwordx4 v42, s[16:19], s49 offen lds
    v_mfma_f32_16x16x32_bf16 v[144:147], a[176:179], a[64:67], v[144:147]
    s_waitcnt lgkmcnt(7)
    ds_read_b64_tr_b16 a[166:167], v16 offset:12288
    ds_read_b64_tr_b16 a[168:169], v17 offset:0
    v_mfma_f32_16x16x32_bf16 v[144:147], a[180:183], a[72:75], v[144:147]
    ds_read_b64_tr_b16 a[170:171], v17 offset:4096
    v_mfma_f32_16x16x32_bf16 v[148:151], a[180:183], a[76:79], v[148:151]
    ds_read_b64_tr_b16 a[172:173], v17 offset:8192
    v_mfma_f32_16x16x32_bf16 v[148:151], a[176:179], a[68:71], v[148:151]
    s_waitcnt lgkmcnt(9)
    buffer_load_dwordx4 v43, s[16:19], s49 offen offset:1024 lds
    v_mfma_f32_16x16x32_bf16 v[156:159], a[184:187], a[68:71], v[156:159]
    s_waitcnt lgkmcnt(7)
    ds_read_b64_tr_b16 a[174:175], v17 offset:12288
    ds_read_b64_tr_b16 a[176:177], v18 offset:0
    v_mfma_f32_16x16x32_bf16 v[156:159], a[188:191], a[76:79], v[156:159]
    ds_read_b64_tr_b16 a[178:179], v18 offset:4096
    v_mfma_f32_16x16x32_bf16 v[152:155], a[188:191], a[72:75], v[152:155]
    ds_read_b64_tr_b16 a[180:181], v18 offset:8192
    v_mfma_f32_16x16x32_bf16 v[152:155], a[184:187], a[64:67], v[152:155]
    s_waitcnt lgkmcnt(9)
    buffer_load_dwordx4 v44, s[16:19], s49 offen offset:2048 lds
    v_mfma_f32_16x16x32_bf16 v[160:163], a[160:163], a[64:67], v[160:163]
    s_waitcnt lgkmcnt(7)
    ds_read_b64_tr_b16 a[182:183], v18 offset:12288
    ds_read_b64_tr_b16 a[184:185], v19 offset:0
    v_mfma_f32_16x16x32_bf16 v[160:163], a[164:167], a[72:75], v[160:163]
    ds_read_b64_tr_b16 a[186:187], v19 offset:4096
    v_mfma_f32_16x16x32_bf16 v[164:167], a[164:167], a[76:79], v[164:167]
    ds_read_b64_tr_b16 a[188:189], v19 offset:8192
    v_mfma_f32_16x16x32_bf16 v[164:167], a[160:163], a[68:71], v[164:167]
    s_waitcnt lgkmcnt(9)
    buffer_load_dwordx4 v45, s[16:19], s49 offen offset:3072 lds
    v_mfma_f32_16x16x32_bf16 v[172:175], a[168:171], a[68:71], v[172:175]
    s_waitcnt lgkmcnt(7)
    ds_read_b64_tr_b16 a[190:191], v19 offset:12288
    ds_read_b64_tr_b16 a[160:161], v12 offset:16384
    v_mfma_f32_16x16x32_bf16 v[172:175], a[172:175], a[76:79], v[172:175]
    ds_read_b64_tr_b16 a[162:163], v12 offset:20480
    v_mfma_f32_16x16x32_bf16 v[168:171], a[172:175], a[72:75], v[168:171]
    ds_read_b64_tr_b16 a[164:165], v12 offset:24576
    v_mfma_f32_16x16x32_bf16 v[168:171], a[168:171], a[64:67], v[168:171]
    s_waitcnt lgkmcnt(9)
    buffer_load_dwordx4 a[112:115], v51, s[24:27], s46 offen offset:1792 sc1
    v_mfma_f32_16x16x32_bf16 v[176:179], a[176:179], a[64:67], v[176:179]
    s_waitcnt lgkmcnt(7)
    ds_read_b64_tr_b16 a[166:167], v12 offset:28672
    ds_read_b64_tr_b16 a[168:169], v13 offset:16384
    v_mfma_f32_16x16x32_bf16 v[176:179], a[180:183], a[72:75], v[176:179]
    ds_read_b64_tr_b16 a[170:171], v13 offset:20480
    v_mfma_f32_16x16x32_bf16 v[180:183], a[180:183], a[76:79], v[180:183]
    ds_read_b64_tr_b16 a[172:173], v13 offset:24576
    v_mfma_f32_16x16x32_bf16 v[180:183], a[176:179], a[68:71], v[180:183]
    s_waitcnt lgkmcnt(9)
    buffer_load_dwordx4 a[120:123], v51, s[24:27], s46 offen offset:1920 sc1
    v_mfma_f32_16x16x32_bf16 v[188:191], a[184:187], a[68:71], v[188:191]
    s_waitcnt lgkmcnt(7)
    ds_read_b64_tr_b16 a[174:175], v13 offset:28672
    ds_read_b64_tr_b16 a[176:177], v14 offset:16384
    v_mfma_f32_16x16x32_bf16 v[188:191], a[188:191], a[76:79], v[188:191]
    ds_read_b64_tr_b16 a[178:179], v14 offset:20480
    v_mfma_f32_16x16x32_bf16 v[184:187], a[188:191], a[72:75], v[184:187]
    ds_read_b64_tr_b16 a[180:181], v14 offset:24576
    v_mfma_f32_16x16x32_bf16 v[184:187], a[184:187], a[64:67], v[184:187]
    s_waitcnt lgkmcnt(9)
    buffer_load_dwordx4 a[116:119], v51, s[24:27], s43 offen offset:1792 sc1
    v_mfma_f32_16x16x32_bf16 v[192:195], a[160:163], a[64:67], v[192:195]
    s_waitcnt lgkmcnt(7)
    ds_read_b64_tr_b16 a[182:183], v14 offset:28672
    ds_read_b64_tr_b16 a[184:185], v15 offset:16384
    v_mfma_f32_16x16x32_bf16 v[192:195], a[164:167], a[72:75], v[192:195]
    ds_read_b64_tr_b16 a[186:187], v15 offset:20480
    v_mfma_f32_16x16x32_bf16 v[196:199], a[164:167], a[76:79], v[196:199]
    ds_read_b64_tr_b16 a[188:189], v15 offset:24576
    v_mfma_f32_16x16x32_bf16 v[196:199], a[160:163], a[68:71], v[196:199]
    s_waitcnt lgkmcnt(9)
    buffer_load_dwordx4 a[124:127], v51, s[24:27], s43 offen offset:1920 sc1
    v_mfma_f32_16x16x32_bf16 v[204:207], a[168:171], a[68:71], v[204:207]
    s_waitcnt lgkmcnt(7)
    ds_read_b64_tr_b16 a[190:191], v15 offset:28672
    ds_read_b64_tr_b16 a[160:161], v16 offset:16384
    v_mfma_f32_16x16x32_bf16 v[204:207], a[172:175], a[76:79], v[204:207]
    ds_read_b64_tr_b16 a[162:163], v16 offset:20480
    v_mfma_f32_16x16x32_bf16 v[200:203], a[172:175], a[72:75], v[200:203]
    ds_read_b64_tr_b16 a[164:165], v16 offset:24576
    v_mfma_f32_16x16x32_bf16 v[200:203], a[168:171], a[64:67], v[200:203]
    s_waitcnt lgkmcnt(9)
    ds_read_b64_tr_b16 a[166:167], v16 offset:28672
    v_mfma_f32_16x16x32_bf16 v[208:211], a[176:179], a[64:67], v[208:211]
    s_waitcnt lgkmcnt(8)
    ds_read_b64_tr_b16 a[168:169], v17 offset:16384
    v_mfma_f32_16x16x32_bf16 v[208:211], a[180:183], a[72:75], v[208:211]
    ds_read_b64_tr_b16 a[170:171], v17 offset:20480
    v_mfma_f32_16x16x32_bf16 v[212:215], a[180:183], a[76:79], v[212:215]
    ds_read_b64_tr_b16 a[172:173], v17 offset:24576
    v_mfma_f32_16x16x32_bf16 v[212:215], a[176:179], a[68:71], v[212:215]
    s_waitcnt lgkmcnt(9)
    ds_read_b64_tr_b16 a[174:175], v17 offset:28672
    v_mfma_f32_16x16x32_bf16 v[220:223], a[184:187], a[68:71], v[220:223]
    s_waitcnt lgkmcnt(8)
    ds_read_b64_tr_b16 a[176:177], v18 offset:16384
    v_mfma_f32_16x16x32_bf16 v[220:223], a[188:191], a[76:79], v[220:223]
    ds_read_b64_tr_b16 a[178:179], v18 offset:20480
    v_mfma_f32_16x16x32_bf16 v[216:219], a[188:191], a[72:75], v[216:219]
    ds_read_b64_tr_b16 a[180:181], v18 offset:24576
    v_mfma_f32_16x16x32_bf16 v[216:219], a[184:187], a[64:67], v[216:219]
    s_waitcnt lgkmcnt(9)
    ds_read_b64_tr_b16 a[182:183], v18 offset:28672
    v_mfma_f32_16x16x32_bf16 v[224:227], a[160:163], a[64:67], v[224:227]
    s_waitcnt lgkmcnt(8)
    ds_read_b64_tr_b16 a[184:185], v19 offset:16384
    v_mfma_f32_16x16x32_bf16 v[224:227], a[164:167], a[72:75], v[224:227]
    ds_read_b64_tr_b16 a[186:187], v19 offset:20480
    v_mfma_f32_16x16x32_bf16 v[228:231], a[164:167], a[76:79], v[228:231]
    ds_read_b64_tr_b16 a[188:189], v19 offset:24576
    v_mfma_f32_16x16x32_bf16 v[228:231], a[160:163], a[68:71], v[228:231]
    s_waitcnt lgkmcnt(9)
    ds_read_b64_tr_b16 a[190:191], v19 offset:28672
    s_waitcnt vmcnt(16)
    s_barrier
    v_mfma_f32_16x16x32_bf16 v[236:239], a[168:171], a[68:71], v[236:239]
    s_waitcnt lgkmcnt(8)
    ds_read_b64_tr_b16 a[160:161], v12 offset:32768
    v_mfma_f32_16x16x32_bf16 v[236:239], a[172:175], a[76:79], v[236:239]
    s_add_u32 s49, s44, 2621696
    ds_read_b64_tr_b16 a[162:163], v12 offset:36864
    v_mfma_f32_16x16x32_bf16 v[232:235], a[172:175], a[72:75], v[232:235]
    s_add_u32 m0, s42, 98304
    ds_read_b64_tr_b16 a[164:165], v12 offset:40960
    v_mfma_f32_16x16x32_bf16 v[232:235], a[168:171], a[64:67], v[232:235]
    s_waitcnt lgkmcnt(9)
    buffer_load_dwordx4 v42, s[16:19], s49 offen lds
    v_mfma_f32_16x16x32_bf16 v[240:243], a[176:179], a[64:67], v[240:243]
    s_waitcnt lgkmcnt(7)
    ds_read_b64_tr_b16 a[166:167], v12 offset:45056
    ds_read_b64_tr_b16 a[168:169], v13 offset:32768
    v_mfma_f32_16x16x32_bf16 v[240:243], a[180:183], a[72:75], v[240:243]
    ds_read_b64_tr_b16 a[170:171], v13 offset:36864
    v_mfma_f32_16x16x32_bf16 v[244:247], a[180:183], a[76:79], v[244:247]
    ds_read_b64_tr_b16 a[172:173], v13 offset:40960
    v_mfma_f32_16x16x32_bf16 v[244:247], a[176:179], a[68:71], v[244:247]
    s_waitcnt lgkmcnt(9)
    buffer_load_dwordx4 v43, s[16:19], s49 offen offset:1024 lds
    v_mfma_f32_16x16x32_bf16 v[252:255], a[184:187], a[68:71], v[252:255]
    s_waitcnt lgkmcnt(7)
    ds_read_b64_tr_b16 a[174:175], v13 offset:45056
    ds_read_b64_tr_b16 a[176:177], v14 offset:32768
    v_mfma_f32_16x16x32_bf16 v[252:255], a[188:191], a[76:79], v[252:255]
    ds_read_b64_tr_b16 a[178:179], v14 offset:36864
    v_mfma_f32_16x16x32_bf16 v[248:251], a[188:191], a[72:75], v[248:251]
    ds_read_b64_tr_b16 a[180:181], v14 offset:40960
    v_mfma_f32_16x16x32_bf16 v[248:251], a[184:187], a[64:67], v[248:251]
    s_waitcnt lgkmcnt(9)
    buffer_load_dwordx4 v44, s[16:19], s49 offen offset:2048 lds
    v_mfma_f32_16x16x32_bf16 v[128:131], a[160:163], a[80:83], v[128:131]
    s_waitcnt lgkmcnt(7)
    ds_read_b64_tr_b16 a[182:183], v14 offset:45056
    ds_read_b64_tr_b16 a[184:185], v15 offset:32768
    v_mfma_f32_16x16x32_bf16 v[128:131], a[164:167], a[88:91], v[128:131]
    ds_read_b64_tr_b16 a[186:187], v15 offset:36864
    v_mfma_f32_16x16x32_bf16 v[132:135], a[164:167], a[92:95], v[132:135]
    ds_read_b64_tr_b16 a[188:189], v15 offset:40960
    v_mfma_f32_16x16x32_bf16 v[132:135], a[160:163], a[84:87], v[132:135]
    s_waitcnt lgkmcnt(9)
    buffer_load_dwordx4 v45, s[16:19], s49 offen offset:3072 lds
    v_mfma_f32_16x16x32_bf16 v[140:143], a[168:171], a[84:87], v[140:143]
    s_waitcnt lgkmcnt(7)
    ds_read_b64_tr_b16 a[190:191], v15 offset:45056
    ds_read_b64_tr_b16 a[160:161], v16 offset:32768
    v_mfma_f32_16x16x32_bf16 v[140:143], a[172:175], a[92:95], v[140:143]
    s_add_u32 s49, s44, 3145984
    ds_read_b64_tr_b16 a[162:163], v16 offset:36864
    v_mfma_f32_16x16x32_bf16 v[136:139], a[172:175], a[88:91], v[136:139]
    s_add_u32 m0, s42, 114688
    ds_read_b64_tr_b16 a[164:165], v16 offset:40960
    v_mfma_f32_16x16x32_bf16 v[136:139], a[168:171], a[80:83], v[136:139]
    s_waitcnt lgkmcnt(9)
    buffer_load_dwordx4 v42, s[16:19], s49 offen lds
    v_mfma_f32_16x16x32_bf16 v[144:147], a[176:179], a[80:83], v[144:147]
    s_waitcnt lgkmcnt(7)
    ds_read_b64_tr_b16 a[166:167], v16 offset:45056
    ds_read_b64_tr_b16 a[168:169], v17 offset:32768
    v_mfma_f32_16x16x32_bf16 v[144:147], a[180:183], a[88:91], v[144:147]
    ds_read_b64_tr_b16 a[170:171], v17 offset:36864
    v_mfma_f32_16x16x32_bf16 v[148:151], a[180:183], a[92:95], v[148:151]
    ds_read_b64_tr_b16 a[172:173], v17 offset:40960
    v_mfma_f32_16x16x32_bf16 v[148:151], a[176:179], a[84:87], v[148:151]
    s_waitcnt lgkmcnt(9)
    buffer_load_dwordx4 v43, s[16:19], s49 offen offset:1024 lds
    v_mfma_f32_16x16x32_bf16 v[156:159], a[184:187], a[84:87], v[156:159]
    s_waitcnt lgkmcnt(7)
    ds_read_b64_tr_b16 a[174:175], v17 offset:45056
    ds_read_b64_tr_b16 a[176:177], v18 offset:32768
    v_mfma_f32_16x16x32_bf16 v[156:159], a[188:191], a[92:95], v[156:159]
    ds_read_b64_tr_b16 a[178:179], v18 offset:36864
    v_mfma_f32_16x16x32_bf16 v[152:155], a[188:191], a[88:91], v[152:155]
    ds_read_b64_tr_b16 a[180:181], v18 offset:40960
    v_mfma_f32_16x16x32_bf16 v[152:155], a[184:187], a[80:83], v[152:155]
    s_waitcnt lgkmcnt(9)
    buffer_load_dwordx4 v44, s[16:19], s49 offen offset:2048 lds
    v_mfma_f32_16x16x32_bf16 v[160:163], a[160:163], a[80:83], v[160:163]
    s_waitcnt lgkmcnt(7)
    ds_read_b64_tr_b16 a[182:183], v18 offset:45056
    ds_read_b64_tr_b16 a[184:185], v19 offset:32768
    v_mfma_f32_16x16x32_bf16 v[160:163], a[164:167], a[88:91], v[160:163]
    ds_read_b64_tr_b16 a[186:187], v19 offset:36864
    v_mfma_f32_16x16x32_bf16 v[164:167], a[164:167], a[92:95], v[164:167]
    ds_read_b64_tr_b16 a[188:189], v19 offset:40960
    v_mfma_f32_16x16x32_bf16 v[164:167], a[160:163], a[84:87], v[164:167]
    s_waitcnt lgkmcnt(9)
    buffer_load_dwordx4 v45, s[16:19], s49 offen offset:3072 lds
    v_mfma_f32_16x16x32_bf16 v[172:175], a[168:171], a[84:87], v[172:175]
    s_waitcnt lgkmcnt(7)
    ds_read_b64_tr_b16 a[190:191], v19 offset:45056
    ds_read_b64_tr_b16 a[160:161], v12 offset:49152
    v_mfma_f32_16x16x32_bf16 v[172:175], a[172:175], a[92:95], v[172:175]
    ds_read_b64_tr_b16 a[162:163], v12 offset:53248
    v_mfma_f32_16x16x32_bf16 v[168:171], a[172:175], a[88:91], v[168:171]
    ds_read_b64_tr_b16 a[164:165], v12 offset:57344
    v_mfma_f32_16x16x32_bf16 v[168:171], a[168:171], a[80:83], v[168:171]
    s_waitcnt lgkmcnt(9)
    buffer_load_dwordx4 a[128:131], v51, s[24:27], s46 offen offset:2048 sc1
    v_mfma_f32_16x16x32_bf16 v[176:179], a[176:179], a[80:83], v[176:179]
    s_waitcnt lgkmcnt(7)
    ds_read_b64_tr_b16 a[166:167], v12 offset:61440
    ds_read_b64_tr_b16 a[168:169], v13 offset:49152
    v_mfma_f32_16x16x32_bf16 v[176:179], a[180:183], a[88:91], v[176:179]
    ds_read_b64_tr_b16 a[170:171], v13 offset:53248
    v_mfma_f32_16x16x32_bf16 v[180:183], a[180:183], a[92:95], v[180:183]
    ds_read_b64_tr_b16 a[172:173], v13 offset:57344
    v_mfma_f32_16x16x32_bf16 v[180:183], a[176:179], a[84:87], v[180:183]
    s_waitcnt lgkmcnt(9)
    buffer_load_dwordx4 a[136:139], v51, s[24:27], s46 offen offset:2176 sc1
    v_mfma_f32_16x16x32_bf16 v[188:191], a[184:187], a[84:87], v[188:191]
    s_waitcnt lgkmcnt(7)
    ds_read_b64_tr_b16 a[174:175], v13 offset:61440
    ds_read_b64_tr_b16 a[176:177], v14 offset:49152
    v_mfma_f32_16x16x32_bf16 v[188:191], a[188:191], a[92:95], v[188:191]
    ds_read_b64_tr_b16 a[178:179], v14 offset:53248
    v_mfma_f32_16x16x32_bf16 v[184:187], a[188:191], a[88:91], v[184:187]
    ds_read_b64_tr_b16 a[180:181], v14 offset:57344
    v_mfma_f32_16x16x32_bf16 v[184:187], a[184:187], a[80:83], v[184:187]
    s_waitcnt vmcnt(25)
    s_waitcnt lgkmcnt(9)
    buffer_load_dwordx4 a[132:135], v51, s[24:27], s43 offen offset:2048 sc1
    v_mfma_f32_16x16x32_bf16 v[128:131], a[160:163], a[96:99], v[128:131]
    s_waitcnt vmcnt(25)
    s_waitcnt lgkmcnt(7)
    ds_read_b64_tr_b16 a[182:183], v14 offset:61440
    ds_read_b64_tr_b16 a[184:185], v15 offset:49152
    v_mfma_f32_16x16x32_bf16 v[128:131], a[164:167], a[104:107], v[128:131]
    s_waitcnt vmcnt(23)
    ds_read_b64_tr_b16 a[186:187], v15 offset:53248
    v_mfma_f32_16x16x32_bf16 v[132:135], a[164:167], a[108:111], v[132:135]
    ds_read_b64_tr_b16 a[188:189], v15 offset:57344
    v_mfma_f32_16x16x32_bf16 v[132:135], a[160:163], a[100:103], v[132:135]
    s_waitcnt lgkmcnt(9)
    buffer_load_dwordx4 a[140:143], v51, s[24:27], s43 offen offset:2176 sc1
    v_mfma_f32_16x16x32_bf16 v[140:143], a[168:171], a[100:103], v[140:143]
    s_waitcnt lgkmcnt(7)
    ds_read_b64_tr_b16 a[190:191], v15 offset:61440
    ds_read_b64_tr_b16 a[160:161], v16 offset:49152
    v_mfma_f32_16x16x32_bf16 v[140:143], a[172:175], a[108:111], v[140:143]
    ds_read_b64_tr_b16 a[162:163], v16 offset:53248
    v_mfma_f32_16x16x32_bf16 v[136:139], a[172:175], a[104:107], v[136:139]
    ds_read_b64_tr_b16 a[164:165], v16 offset:57344
    v_mfma_f32_16x16x32_bf16 v[136:139], a[168:171], a[96:99], v[136:139]
    s_waitcnt lgkmcnt(9)
    ds_read_b64_tr_b16 a[166:167], v16 offset:61440
    v_mfma_f32_16x16x32_bf16 v[144:147], a[176:179], a[96:99], v[144:147]
    s_waitcnt lgkmcnt(8)
    ds_read_b64_tr_b16 a[168:169], v17 offset:49152
    v_mfma_f32_16x16x32_bf16 v[144:147], a[180:183], a[104:107], v[144:147]
    ds_read_b64_tr_b16 a[170:171], v17 offset:53248
    v_mfma_f32_16x16x32_bf16 v[148:151], a[180:183], a[108:111], v[148:151]
    ds_read_b64_tr_b16 a[172:173], v17 offset:57344
    v_mfma_f32_16x16x32_bf16 v[148:151], a[176:179], a[100:103], v[148:151]
    s_waitcnt lgkmcnt(9)
    ds_read_b64_tr_b16 a[174:175], v17 offset:61440
    v_mfma_f32_16x16x32_bf16 v[156:159], a[184:187], a[100:103], v[156:159]
    s_waitcnt lgkmcnt(8)
    ds_read_b64_tr_b16 a[176:177], v18 offset:49152
    v_mfma_f32_16x16x32_bf16 v[156:159], a[188:191], a[108:111], v[156:159]
    ds_read_b64_tr_b16 a[178:179], v18 offset:53248
    v_mfma_f32_16x16x32_bf16 v[152:155], a[188:191], a[104:107], v[152:155]
    ds_read_b64_tr_b16 a[180:181], v18 offset:57344
    v_mfma_f32_16x16x32_bf16 v[152:155], a[184:187], a[96:99], v[152:155]
    s_waitcnt lgkmcnt(9)
    ds_read_b64_tr_b16 a[182:183], v18 offset:61440
    v_mfma_f32_16x16x32_bf16 v[160:163], a[160:163], a[96:99], v[160:163]
    s_waitcnt lgkmcnt(8)
    ds_read_b64_tr_b16 a[184:185], v19 offset:49152
    v_mfma_f32_16x16x32_bf16 v[160:163], a[164:167], a[104:107], v[160:163]
    ds_read_b64_tr_b16 a[186:187], v19 offset:53248
    v_mfma_f32_16x16x32_bf16 v[164:167], a[164:167], a[108:111], v[164:167]
    ds_read_b64_tr_b16 a[188:189], v19 offset:57344
    v_mfma_f32_16x16x32_bf16 v[164:167], a[160:163], a[100:103], v[164:167]
    s_waitcnt lgkmcnt(9)
    ds_read_b64_tr_b16 a[190:191], v19 offset:61440
    s_waitcnt vmcnt(16)
    s_barrier
    v_mfma_f32_16x16x32_bf16 v[172:175], a[168:171], a[100:103], v[172:175]
    s_waitcnt lgkmcnt(8)
    ds_read_b64_tr_b16 a[160:161], v20 offset:0
    v_mfma_f32_16x16x32_bf16 v[172:175], a[172:175], a[108:111], v[172:175]
    s_add_u32 s49, s44, 3670272
    ds_read_b64_tr_b16 a[162:163], v20 offset:4096
    v_mfma_f32_16x16x32_bf16 v[168:171], a[172:175], a[104:107], v[168:171]
    s_add_u32 m0, s42, 131072
    ds_read_b64_tr_b16 a[164:165], v20 offset:8192
    v_mfma_f32_16x16x32_bf16 v[168:171], a[168:171], a[96:99], v[168:171]
    s_waitcnt lgkmcnt(9)
    buffer_load_dwordx4 v42, s[16:19], s49 offen lds
    v_mfma_f32_16x16x32_bf16 v[176:179], a[176:179], a[96:99], v[176:179]
    s_waitcnt lgkmcnt(7)
    ds_read_b64_tr_b16 a[166:167], v20 offset:12288
    ds_read_b64_tr_b16 a[168:169], v21 offset:0
    v_mfma_f32_16x16x32_bf16 v[176:179], a[180:183], a[104:107], v[176:179]
    ds_read_b64_tr_b16 a[170:171], v21 offset:4096
    v_mfma_f32_16x16x32_bf16 v[180:183], a[180:183], a[108:111], v[180:183]
    ds_read_b64_tr_b16 a[172:173], v21 offset:8192
    v_mfma_f32_16x16x32_bf16 v[180:183], a[176:179], a[100:103], v[180:183]
    s_waitcnt lgkmcnt(9)
    buffer_load_dwordx4 v43, s[16:19], s49 offen offset:1024 lds
    v_mfma_f32_16x16x32_bf16 v[188:191], a[184:187], a[100:103], v[188:191]
    s_waitcnt lgkmcnt(7)
    ds_read_b64_tr_b16 a[174:175], v21 offset:12288
    ds_read_b64_tr_b16 a[176:177], v22 offset:0
    v_mfma_f32_16x16x32_bf16 v[188:191], a[188:191], a[108:111], v[188:191]
    ds_read_b64_tr_b16 a[178:179], v22 offset:4096
    v_mfma_f32_16x16x32_bf16 v[184:187], a[188:191], a[104:107], v[184:187]
    ds_read_b64_tr_b16 a[180:181], v22 offset:8192
    v_mfma_f32_16x16x32_bf16 v[184:187], a[184:187], a[96:99], v[184:187]
    s_waitcnt vmcnt(17)
    s_waitcnt lgkmcnt(9)
    buffer_load_dwordx4 v44, s[16:19], s49 offen offset:2048 lds
    v_mfma_f32_16x16x32_bf16 v[128:131], a[160:163], a[112:115], v[128:131]
    s_waitcnt vmcnt(17)
    s_waitcnt lgkmcnt(7)
    ds_read_b64_tr_b16 a[182:183], v22 offset:12288
    ds_read_b64_tr_b16 a[184:185], v23 offset:0
    v_mfma_f32_16x16x32_bf16 v[128:131], a[164:167], a[120:123], v[128:131]
    s_waitcnt vmcnt(15)
    ds_read_b64_tr_b16 a[186:187], v23 offset:4096
    v_mfma_f32_16x16x32_bf16 v[132:135], a[164:167], a[124:127], v[132:135]
    ds_read_b64_tr_b16 a[188:189], v23 offset:8192
    v_mfma_f32_16x16x32_bf16 v[132:135], a[160:163], a[116:119], v[132:135]
    s_waitcnt lgkmcnt(9)
    buffer_load_dwordx4 v45, s[16:19], s49 offen offset:3072 lds
    v_mfma_f32_16x16x32_bf16 v[140:143], a[168:171], a[116:119], v[140:143]
    s_waitcnt lgkmcnt(7)
    ds_read_b64_tr_b16 a[190:191], v23 offset:12288
    ds_read_b64_tr_b16 a[160:161], v24 offset:0
    v_mfma_f32_16x16x32_bf16 v[140:143], a[172:175], a[124:127], v[140:143]
    s_add_u32 s49, s44, 4194560
    ds_read_b64_tr_b16 a[162:163], v24 offset:4096
    v_mfma_f32_16x16x32_bf16 v[136:139], a[172:175], a[120:123], v[136:139]
    s_add_u32 m0, s42, 147456
    ds_read_b64_tr_b16 a[164:165], v24 offset:8192
    v_mfma_f32_16x16x32_bf16 v[136:139], a[168:171], a[112:115], v[136:139]
    s_waitcnt lgkmcnt(9)
    buffer_load_dwordx4 v42, s[16:19], s49 offen lds
    v_mfma_f32_16x16x32_bf16 v[144:147], a[176:179], a[112:115], v[144:147]
    s_waitcnt lgkmcnt(7)
    ds_read_b64_tr_b16 a[166:167], v24 offset:12288
    ds_read_b64_tr_b16 a[168:169], v25 offset:0
    v_mfma_f32_16x16x32_bf16 v[144:147], a[180:183], a[120:123], v[144:147]
    ds_read_b64_tr_b16 a[170:171], v25 offset:4096
    v_mfma_f32_16x16x32_bf16 v[148:151], a[180:183], a[124:127], v[148:151]
    ds_read_b64_tr_b16 a[172:173], v25 offset:8192
    v_mfma_f32_16x16x32_bf16 v[148:151], a[176:179], a[116:119], v[148:151]
    s_waitcnt lgkmcnt(9)
    buffer_load_dwordx4 v43, s[16:19], s49 offen offset:1024 lds
    v_mfma_f32_16x16x32_bf16 v[156:159], a[184:187], a[116:119], v[156:159]
    s_waitcnt lgkmcnt(7)
    ds_read_b64_tr_b16 a[174:175], v25 offset:12288
    ds_read_b64_tr_b16 a[176:177], v26 offset:0
    v_mfma_f32_16x16x32_bf16 v[156:159], a[188:191], a[124:127], v[156:159]
    ds_read_b64_tr_b16 a[178:179], v26 offset:4096
    v_mfma_f32_16x16x32_bf16 v[152:155], a[188:191], a[120:123], v[152:155]
    ds_read_b64_tr_b16 a[180:181], v26 offset:8192
    v_mfma_f32_16x16x32_bf16 v[152:155], a[184:187], a[112:115], v[152:155]
    s_waitcnt lgkmcnt(9)
    buffer_load_dwordx4 v44, s[16:19], s49 offen offset:2048 lds
    v_mfma_f32_16x16x32_bf16 v[160:163], a[160:163], a[112:115], v[160:163]
    s_waitcnt lgkmcnt(7)
    ds_read_b64_tr_b16 a[182:183], v26 offset:12288
    ds_read_b64_tr_b16 a[184:185], v27 offset:0
    v_mfma_f32_16x16x32_bf16 v[160:163], a[164:167], a[120:123], v[160:163]
    ds_read_b64_tr_b16 a[186:187], v27 offset:4096
    v_mfma_f32_16x16x32_bf16 v[164:167], a[164:167], a[124:127], v[164:167]
    ds_read_b64_tr_b16 a[188:189], v27 offset:8192
    v_mfma_f32_16x16x32_bf16 v[164:167], a[160:163], a[116:119], v[164:167]
    s_waitcnt lgkmcnt(9)
    buffer_load_dwordx4 v45, s[16:19], s49 offen offset:3072 lds
    v_mfma_f32_16x16x32_bf16 v[172:175], a[168:171], a[116:119], v[172:175]
    s_waitcnt lgkmcnt(7)
    ds_read_b64_tr_b16 a[190:191], v27 offset:12288
    ds_read_b64_tr_b16 a[160:161], v20 offset:16384
    v_mfma_f32_16x16x32_bf16 v[172:175], a[172:175], a[124:127], v[172:175]
    ds_read_b64_tr_b16 a[162:163], v20 offset:20480
    v_mfma_f32_16x16x32_bf16 v[168:171], a[172:175], a[120:123], v[168:171]
    ds_read_b64_tr_b16 a[164:165], v20 offset:24576
    v_mfma_f32_16x16x32_bf16 v[168:171], a[168:171], a[112:115], v[168:171]
    s_waitcnt lgkmcnt(9)
    buffer_load_dword v78, v120, s[8:11], 0 offen
    v_mfma_f32_16x16x32_bf16 v[176:179], a[176:179], a[112:115], v[176:179]
    s_waitcnt lgkmcnt(7)
    ds_read_b64_tr_b16 a[166:167], v20 offset:28672
    ds_read_b64_tr_b16 a[168:169], v21 offset:16384
    v_mfma_f32_16x16x32_bf16 v[176:179], a[180:183], a[120:123], v[176:179]
    ds_read_b64_tr_b16 a[170:171], v21 offset:20480
    v_mfma_f32_16x16x32_bf16 v[180:183], a[180:183], a[124:127], v[180:183]
    ds_read_b64_tr_b16 a[172:173], v21 offset:24576
    v_mfma_f32_16x16x32_bf16 v[180:183], a[176:179], a[116:119], v[180:183]
    s_waitcnt lgkmcnt(9)
    buffer_load_dword v79, v121, s[12:15], 0 offen
    v_mfma_f32_16x16x32_bf16 v[188:191], a[184:187], a[116:119], v[188:191]
    s_waitcnt lgkmcnt(7)
    ds_read_b64_tr_b16 a[174:175], v21 offset:28672
    ds_read_b64_tr_b16 a[176:177], v22 offset:16384
    v_mfma_f32_16x16x32_bf16 v[188:191], a[188:191], a[124:127], v[188:191]
    ds_read_b64_tr_b16 a[178:179], v22 offset:20480
    v_mfma_f32_16x16x32_bf16 v[184:187], a[188:191], a[120:123], v[184:187]
    s_mov_b32 s36, 1040356334
    ds_read_b64_tr_b16 a[180:181], v22 offset:24576
    v_mfma_f32_16x16x32_bf16 v[184:187], a[184:187], a[112:115], v[184:187]
    s_waitcnt vmcnt(13)
    s_waitcnt lgkmcnt(9)
    buffer_store_dword v76, v72, s[24:27], s92 offen offset:12 sc1
    v_mfma_f32_16x16x32_bf16 v[128:131], a[160:163], a[128:131], v[128:131]
    s_waitcnt vmcnt(13)
    s_waitcnt lgkmcnt(7)
    ds_read_b64_tr_b16 a[182:183], v22 offset:28672
    ds_read_b64_tr_b16 a[184:185], v23 offset:16384
    v_mfma_f32_16x16x32_bf16 v[128:131], a[164:167], a[136:139], v[128:131]
    s_waitcnt vmcnt(11)
    ds_read_b64_tr_b16 a[186:187], v23 offset:20480
    v_mfma_f32_16x16x32_bf16 v[132:135], a[164:167], a[140:143], v[132:135]
    ds_read_b64_tr_b16 a[188:189], v23 offset:24576
    v_mfma_f32_16x16x32_bf16 v[132:135], a[160:163], a[132:135], v[132:135]
    s_waitcnt lgkmcnt(9)
    buffer_store_dwordx4 v[88:91], v74, s[24:27], 0 offen sc1
    v_mfma_f32_16x16x32_bf16 v[140:143], a[168:171], a[132:135], v[140:143]
    s_waitcnt lgkmcnt(7)
    ds_read_b64_tr_b16 a[190:191], v23 offset:28672
    ds_read_b64_tr_b16 a[160:161], v24 offset:16384
    v_mfma_f32_16x16x32_bf16 v[140:143], a[172:175], a[140:143], v[140:143]
    ds_read_b64_tr_b16 a[162:163], v24 offset:20480
    v_mfma_f32_16x16x32_bf16 v[136:139], a[172:175], a[136:139], v[136:139]
    ds_read_b64_tr_b16 a[164:165], v24 offset:24576
    v_mfma_f32_16x16x32_bf16 v[136:139], a[168:171], a[128:131], v[136:139]
    s_waitcnt lgkmcnt(9)
    ds_read_b64_tr_b16 a[166:167], v24 offset:28672
    v_mfma_f32_16x16x32_bf16 v[144:147], a[176:179], a[128:131], v[144:147]
    s_waitcnt lgkmcnt(8)
    ds_read_b64_tr_b16 a[168:169], v25 offset:16384
    v_mfma_f32_16x16x32_bf16 v[144:147], a[180:183], a[136:139], v[144:147]
    ds_read_b64_tr_b16 a[170:171], v25 offset:20480
    v_mfma_f32_16x16x32_bf16 v[148:151], a[180:183], a[140:143], v[148:151]
    ds_read_b64_tr_b16 a[172:173], v25 offset:24576
    v_mfma_f32_16x16x32_bf16 v[148:151], a[176:179], a[132:135], v[148:151]
    s_waitcnt lgkmcnt(9)
    ds_read_b64_tr_b16 a[174:175], v25 offset:28672
    v_mul_f32 v128, s36, v128
    v_mfma_f32_16x16x32_bf16 v[156:159], a[184:187], a[132:135], v[156:159]
    s_waitcnt lgkmcnt(8)
    ds_read_b64_tr_b16 a[176:177], v26 offset:16384
    v_mul_f32 v129, s36, v129
    v_mfma_f32_16x16x32_bf16 v[156:159], a[188:191], a[140:143], v[156:159]
    ds_read_b64_tr_b16 a[178:179], v26 offset:20480
    v_mul_f32 v130, s36, v130
    v_mfma_f32_16x16x32_bf16 v[152:155], a[188:191], a[136:139], v[152:155]
    ds_read_b64_tr_b16 a[180:181], v26 offset:24576
    v_mul_f32 v131, s36, v131
    v_mfma_f32_16x16x32_bf16 v[152:155], a[184:187], a[128:131], v[152:155]
    s_waitcnt lgkmcnt(9)
    ds_read_b64_tr_b16 a[182:183], v26 offset:28672
    v_mul_f32 v136, s36, v136
    v_mfma_f32_16x16x32_bf16 v[160:163], a[160:163], a[128:131], v[160:163]
    s_waitcnt lgkmcnt(8)
    ds_read_b64_tr_b16 a[184:185], v27 offset:16384
    v_mul_f32 v137, s36, v137
    v_mfma_f32_16x16x32_bf16 v[160:163], a[164:167], a[136:139], v[160:163]
    ds_read_b64_tr_b16 a[186:187], v27 offset:20480
    v_mul_f32 v138, s36, v138
    v_mfma_f32_16x16x32_bf16 v[164:167], a[164:167], a[140:143], v[164:167]
    ds_read_b64_tr_b16 a[188:189], v27 offset:24576
    v_mul_f32 v139, s36, v139
    v_mfma_f32_16x16x32_bf16 v[164:167], a[160:163], a[132:135], v[164:167]
    s_waitcnt lgkmcnt(9)
    ds_read_b64_tr_b16 a[190:191], v27 offset:28672
    v_mul_f32 v132, s36, v132
    s_barrier
    v_mfma_f32_16x16x32_bf16 v[172:175], a[168:171], a[132:135], v[172:175]
    s_waitcnt lgkmcnt(8)
    ds_read_b64_tr_b16 a[160:161], v20 offset:32768
    v_mul_f32 v133, s36, v133
    v_mfma_f32_16x16x32_bf16 v[172:175], a[172:175], a[140:143], v[172:175]
    ds_read_b64_tr_b16 a[162:163], v20 offset:36864
    v_mul_f32 v134, s36, v134
    v_mfma_f32_16x16x32_bf16 v[168:171], a[172:175], a[136:139], v[168:171]
    s_add_u32 m0, s42, 0
    ds_read_b64_tr_b16 a[164:165], v20 offset:40960
    v_mul_f32 v135, s36, v135
    v_mfma_f32_16x16x32_bf16 v[168:171], a[168:171], a[128:131], v[168:171]
    s_waitcnt lgkmcnt(9)
    buffer_load_dwordx4 v36, s[8:11], s40 offen lds
    v_mfma_f32_16x16x32_bf16 v[176:179], a[176:179], a[128:131], v[176:179]
    s_waitcnt lgkmcnt(7)
    ds_read_b64_tr_b16 a[166:167], v20 offset:45056
    ds_read_b64_tr_b16 a[168:169], v21 offset:32768
    v_mfma_f32_16x16x32_bf16 v[176:179], a[180:183], a[136:139], v[176:179]
    ds_read_b64_tr_b16 a[170:171], v21 offset:36864
    v_mul_f32 v140, s36, v140
    v_mfma_f32_16x16x32_bf16 v[180:183], a[180:183], a[140:143], v[180:183]
    ds_read_b64_tr_b16 a[172:173], v21 offset:40960
    v_mul_f32 v141, s36, v141
    v_mfma_f32_16x16x32_bf16 v[180:183], a[176:179], a[132:135], v[180:183]
    s_waitcnt lgkmcnt(9)
    buffer_load_dwordx4 v37, s[8:11], s40 offen offset:1024 lds
    v_mfma_f32_16x16x32_bf16 v[188:191], a[184:187], a[132:135], v[188:191]
    s_waitcnt lgkmcnt(7)
    ds_read_b64_tr_b16 a[174:175], v21 offset:45056
    ds_read_b64_tr_b16 a[176:177], v22 offset:32768
    v_mfma_f32_16x16x32_bf16 v[188:191], a[188:191], a[140:143], v[188:191]
    ds_read_b64_tr_b16 a[178:179], v22 offset:36864
    v_mul_f32 v142, s36, v142
    v_mfma_f32_16x16x32_bf16 v[184:187], a[188:191], a[136:139], v[184:187]
    ds_read_b64_tr_b16 a[180:181], v22 offset:40960
    v_mul_f32 v143, s36, v143
    v_mfma_f32_16x16x32_bf16 v[184:187], a[184:187], a[128:131], v[184:187]
    s_waitcnt lgkmcnt(9)
    buffer_load_dwordx4 v38, s[8:11], s40 offen offset:2048 lds
    v_mfma_f32_16x16x32_bf16 v[192:195], a[160:163], a[80:83], v[192:195]
    s_waitcnt lgkmcnt(7)
    ds_read_b64_tr_b16 a[182:183], v22 offset:45056
    ds_read_b64_tr_b16 a[184:185], v23 offset:32768
    v_mfma_f32_16x16x32_bf16 v[192:195], a[164:167], a[88:91], v[192:195]
Ltour0_2:
    s_cbranch_execz Ltour0_6
    ds_read_b64_tr_b16 a[186:187], v23 offset:36864
    v_cvt_pk_bf16_f32 v64, v128, v129
    v_mfma_f32_16x16x32_bf16 v[196:199], a[164:167], a[92:95], v[196:199]
    ds_read_b64_tr_b16 a[188:189], v23 offset:40960
    v_cvt_pk_bf16_f32 v65, v130, v131
    v_mfma_f32_16x16x32_bf16 v[196:199], a[160:163], a[84:87], v[196:199]
    s_waitcnt lgkmcnt(9)
    buffer_load_dwordx4 v39, s[8:11], s40 offen offset:3072 lds
    v_mfma_f32_16x16x32_bf16 v[204:207], a[168:171], a[84:87], v[204:207]
    s_waitcnt lgkmcnt(7)
    s_add_u32 s40, s40, 16384
    ds_read_b64_tr_b16 a[190:191], v23 offset:45056
    ds_read_b64_tr_b16 a[160:161], v24 offset:32768
    v_mfma_f32_16x16x32_bf16 v[204:207], a[172:175], a[92:95], v[204:207]
    ds_read_b64_tr_b16 a[162:163], v24 offset:36864
    v_cvt_pk_bf16_f32 v66, v136, v137
    v_mfma_f32_16x16x32_bf16 v[200:203], a[172:175], a[88:91], v[200:203]
    s_add_u32 m0, s42, 16384
    ds_read_b64_tr_b16 a[164:165], v24 offset:40960
    v_cvt_pk_bf16_f32 v67, v138, v139
    v_mfma_f32_16x16x32_bf16 v[200:203], a[168:171], a[80:83], v[200:203]
    s_waitcnt lgkmcnt(9)
    buffer_load_dwordx4 v36, s[8:11], s40 offen lds
    v_mfma_f32_16x16x32_bf16 v[208:211], a[176:179], a[80:83], v[208:211]
    s_waitcnt lgkmcnt(7)
    ds_read_b64_tr_b16 a[166:167], v24 offset:45056
    ds_read_b64_tr_b16 a[168:169], v25 offset:32768
    v_mfma_f32_16x16x32_bf16 v[208:211], a[180:183], a[88:91], v[208:211]
    ds_read_b64_tr_b16 a[170:171], v25 offset:36864
    v_cvt_pk_bf16_f32 v80, v132, v133
    v_mfma_f32_16x16x32_bf16 v[212:215], a[180:183], a[92:95], v[212:215]
    ds_read_b64_tr_b16 a[172:173], v25 offset:40960
    v_cvt_pk_bf16_f32 v81, v134, v135
    v_mfma_f32_16x16x32_bf16 v[212:215], a[176:179], a[84:87], v[212:215]
    s_waitcnt lgkmcnt(9)
    buffer_load_dwordx4 v37, s[8:11], s40 offen offset:1024 lds
    v_mfma_f32_16x16x32_bf16 v[220:223], a[184:187], a[84:87], v[220:223]
    s_waitcnt lgkmcnt(7)
    ds_read_b64_tr_b16 a[174:175], v25 offset:45056
    ds_read_b64_tr_b16 a[176:177], v26 offset:32768
    v_mfma_f32_16x16x32_bf16 v[220:223], a[188:191], a[92:95], v[220:223]
    ds_read_b64_tr_b16 a[178:179], v26 offset:36864
    v_cvt_pk_bf16_f32 v82, v140, v141
    v_mfma_f32_16x16x32_bf16 v[216:219], a[188:191], a[88:91], v[216:219]
    ds_read_b64_tr_b16 a[180:181], v26 offset:40960
    v_cvt_pk_bf16_f32 v83, v142, v143
    v_mfma_f32_16x16x32_bf16 v[216:219], a[184:187], a[80:83], v[216:219]
    s_waitcnt lgkmcnt(9)
    buffer_load_dwordx4 v38, s[8:11], s40 offen offset:2048 lds
    v_mfma_f32_16x16x32_bf16 v[224:227], a[160:163], a[80:83], v[224:227]
    s_waitcnt lgkmcnt(7)
    ds_read_b64_tr_b16 a[182:183], v26 offset:45056
    ds_read_b64_tr_b16 a[184:185], v27 offset:32768
    v_mfma_f32_16x16x32_bf16 v[224:227], a[164:167], a[88:91], v[224:227]
    ds_read_b64_tr_b16 a[186:187], v27 offset:36864
    v_permlane32_swap_b32 v64, v66
    v_mfma_f32_16x16x32_bf16 v[228:231], a[164:167], a[92:95], v[228:231]
    ds_read_b64_tr_b16 a[188:189], v27 offset:40960
    v_permlane32_swap_b32 v65, v67
    v_mfma_f32_16x16x32_bf16 v[228:231], a[160:163], a[84:87], v[228:231]
    s_waitcnt lgkmcnt(9)
    buffer_load_dwordx4 v39, s[8:11], s40 offen offset:3072 lds
    v_mfma_f32_16x16x32_bf16 v[236:239], a[168:171], a[84:87], v[236:239]
    s_waitcnt lgkmcnt(7)
    s_add_u32 s40, s40, 16384
    ds_read_b64_tr_b16 a[190:191], v27 offset:45056
    ds_read_b64_tr_b16 a[160:161], v20 offset:49152
    v_mfma_f32_16x16x32_bf16 v[236:239], a[172:175], a[92:95], v[236:239]
    ds_read_b64_tr_b16 a[162:163], v20 offset:53248
    v_permlane32_swap_b32 v80, v82
    v_mfma_f32_16x16x32_bf16 v[232:235], a[172:175], a[88:91], v[232:235]
    ds_read_b64_tr_b16 a[164:165], v20 offset:57344
    v_permlane32_swap_b32 v81, v83
    v_mfma_f32_16x16x32_bf16 v[232:235], a[168:171], a[80:83], v[232:235]
    s_waitcnt lgkmcnt(9)
    ds_read_b64_tr_b16 a[166:167], v20 offset:61440
    v_permlane16_swap_b32 v64, v66
    v_mfma_f32_16x16x32_bf16 v[240:243], a[176:179], a[80:83], v[240:243]
    s_waitcnt lgkmcnt(8)
    ds_read_b64_tr_b16 a[168:169], v21 offset:49152
    v_permlane16_swap_b32 v65, v67
    v_mfma_f32_16x16x32_bf16 v[240:243], a[180:183], a[88:91], v[240:243]
    ds_read_b64_tr_b16 a[170:171], v21 offset:53248
    v_permlane16_swap_b32 v80, v82
    v_mfma_f32_16x16x32_bf16 v[244:247], a[180:183], a[92:95], v[244:247]
    ds_read_b64_tr_b16 a[172:173], v21 offset:57344
    v_permlane16_swap_b32 v81, v83
    v_mfma_f32_16x16x32_bf16 v[244:247], a[176:179], a[84:87], v[244:247]
    s_waitcnt lgkmcnt(9)
    ds_read_b64_tr_b16 a[174:175], v21 offset:61440
    v_mul_f32 v144, s36, v144
    v_mfma_f32_16x16x32_bf16 v[252:255], a[184:187], a[84:87], v[252:255]
    s_waitcnt lgkmcnt(8)
    ds_read_b64_tr_b16 a[176:177], v22 offset:49152
    v_mul_f32 v145, s36, v145
    v_mfma_f32_16x16x32_bf16 v[252:255], a[188:191], a[92:95], v[252:255]
    ds_read_b64_tr_b16 a[178:179], v22 offset:53248
    v_mul_f32 v146, s36, v146
    v_mfma_f32_16x16x32_bf16 v[248:251], a[188:191], a[88:91], v[248:251]
    ds_read_b64_tr_b16 a[180:181], v22 offset:57344
    v_mul_f32 v147, s36, v147
    v_mfma_f32_16x16x32_bf16 v[248:251], a[184:187], a[80:83], v[248:251]
    s_waitcnt lgkmcnt(9)
    ds_read_b64_tr_b16 a[182:183], v22 offset:61440
    v_mul_f32 v152, s36, v152
    v_mfma_f32_16x16x32_bf16 v[192:195], a[160:163], a[96:99], v[192:195]
    s_waitcnt lgkmcnt(8)
    ds_read_b64_tr_b16 a[184:185], v23 offset:49152
    v_mul_f32 v153, s36, v153
    v_mfma_f32_16x16x32_bf16 v[192:195], a[164:167], a[104:107], v[192:195]
    ds_read_b64_tr_b16 a[186:187], v23 offset:53248
    v_mul_f32 v154, s36, v154
    v_mfma_f32_16x16x32_bf16 v[196:199], a[164:167], a[108:111], v[196:199]
    ds_read_b64_tr_b16 a[188:189], v23 offset:57344
    v_mul_f32 v155, s36, v155
    v_mfma_f32_16x16x32_bf16 v[196:199], a[160:163], a[100:103], v[196:199]
    s_waitcnt lgkmcnt(9)
    ds_read_b64_tr_b16 a[190:191], v23 offset:61440
    v_mul_f32 v148, s36, v148
    v_mfma_f32_16x16x32_bf16 v[204:207], a[168:171], a[100:103], v[204:207]
    s_waitcnt lgkmcnt(8)
    ds_read_b64_tr_b16 a[160:161], v24 offset:49152
    v_mul_f32 v149, s36, v149
    v_mfma_f32_16x16x32_bf16 v[204:207], a[172:175], a[108:111], v[204:207]
    ds_read_b64_tr_b16 a[162:163], v24 offset:53248
    v_mul_f32 v150, s36, v150
    v_mfma_f32_16x16x32_bf16 v[200:203], a[172:175], a[104:107], v[200:203]
    ds_read_b64_tr_b16 a[164:165], v24 offset:57344
    v_mul_f32 v151, s36, v151
    v_mfma_f32_16x16x32_bf16 v[200:203], a[168:171], a[96:99], v[200:203]
    s_waitcnt lgkmcnt(9)
    ds_read_b64_tr_b16 a[166:167], v24 offset:61440
    v_mul_f32 v156, s36, v156
    v_mfma_f32_16x16x32_bf16 v[208:211], a[176:179], a[96:99], v[208:211]
    s_waitcnt lgkmcnt(8)
    ds_read_b64_tr_b16 a[168:169], v25 offset:49152
    v_mul_f32 v157, s36, v157
    v_mfma_f32_16x16x32_bf16 v[208:211], a[180:183], a[104:107], v[208:211]
    ds_read_b64_tr_b16 a[170:171], v25 offset:53248
    v_mul_f32 v158, s36, v158
    v_mfma_f32_16x16x32_bf16 v[212:215], a[180:183], a[108:111], v[212:215]
    ds_read_b64_tr_b16 a[172:173], v25 offset:57344
    v_mul_f32 v159, s36, v159
    v_mfma_f32_16x16x32_bf16 v[212:215], a[176:179], a[100:103], v[212:215]
    s_waitcnt lgkmcnt(9)
    ds_read_b64_tr_b16 a[174:175], v25 offset:61440
    v_cvt_pk_bf16_f32 v68, v144, v145
    v_mfma_f32_16x16x32_bf16 v[220:223], a[184:187], a[100:103], v[220:223]
    s_waitcnt lgkmcnt(8)
    ds_read_b64_tr_b16 a[176:177], v26 offset:49152
    v_cvt_pk_bf16_f32 v69, v146, v147
    v_mfma_f32_16x16x32_bf16 v[220:223], a[188:191], a[108:111], v[220:223]
    ds_read_b64_tr_b16 a[178:179], v26 offset:53248
    v_cvt_pk_bf16_f32 v70, v152, v153
    v_mfma_f32_16x16x32_bf16 v[216:219], a[188:191], a[104:107], v[216:219]
    ds_read_b64_tr_b16 a[180:181], v26 offset:57344
    v_cvt_pk_bf16_f32 v71, v154, v155
    v_mfma_f32_16x16x32_bf16 v[216:219], a[184:187], a[96:99], v[216:219]
    s_waitcnt lgkmcnt(9)
    ds_read_b64_tr_b16 a[182:183], v26 offset:61440
    v_cvt_pk_bf16_f32 v84, v148, v149
    v_mfma_f32_16x16x32_bf16 v[224:227], a[160:163], a[96:99], v[224:227]
    s_waitcnt lgkmcnt(8)
    ds_read_b64_tr_b16 a[184:185], v27 offset:49152
    v_cvt_pk_bf16_f32 v85, v150, v151
    v_mfma_f32_16x16x32_bf16 v[224:227], a[164:167], a[104:107], v[224:227]
    ds_read_b64_tr_b16 a[186:187], v27 offset:53248
    v_cvt_pk_bf16_f32 v86, v156, v157
    v_mfma_f32_16x16x32_bf16 v[228:231], a[164:167], a[108:111], v[228:231]
    ds_read_b64_tr_b16 a[188:189], v27 offset:57344
    v_cvt_pk_bf16_f32 v87, v158, v159
    v_mfma_f32_16x16x32_bf16 v[228:231], a[160:163], a[100:103], v[228:231]
    s_waitcnt lgkmcnt(9)
    ds_read_b64_tr_b16 a[190:191], v27 offset:61440
    v_permlane32_swap_b32 v68, v70
    s_waitcnt vmcnt(12)
    s_barrier
    v_mfma_f32_16x16x32_bf16 v[236:239], a[168:171], a[100:103], v[236:239]
    s_waitcnt lgkmcnt(8)
    ds_read_b64_tr_b16 a[160:161], v28 offset:0
    v_permlane32_swap_b32 v69, v71
    v_mfma_f32_16x16x32_bf16 v[236:239], a[172:175], a[108:111], v[236:239]
    ds_read_b64_tr_b16 a[162:163], v28 offset:4096
    v_permlane32_swap_b32 v84, v86
    v_mfma_f32_16x16x32_bf16 v[232:235], a[172:175], a[104:107], v[232:235]
    s_add_u32 m0, s42, 32768
    ds_read_b64_tr_b16 a[164:165], v28 offset:8192
    v_permlane32_swap_b32 v85, v87
    v_mfma_f32_16x16x32_bf16 v[232:235], a[168:171], a[96:99], v[232:235]
    s_waitcnt lgkmcnt(9)
    buffer_load_dwordx4 v36, s[8:11], s40 offen lds
    v_mfma_f32_16x16x32_bf16 v[240:243], a[176:179], a[96:99], v[240:243]
    s_waitcnt lgkmcnt(7)
    ds_read_b64_tr_b16 a[166:167], v28 offset:12288
    ds_read_b64_tr_b16 a[168:169], v29 offset:0
    v_mfma_f32_16x16x32_bf16 v[240:243], a[180:183], a[104:107], v[240:243]
    ds_read_b64_tr_b16 a[170:171], v29 offset:4096
    v_permlane16_swap_b32 v68, v70
    v_mfma_f32_16x16x32_bf16 v[244:247], a[180:183], a[108:111], v[244:247]
    ds_read_b64_tr_b16 a[172:173], v29 offset:8192
    v_permlane16_swap_b32 v69, v71
    v_mfma_f32_16x16x32_bf16 v[244:247], a[176:179], a[100:103], v[244:247]
    s_waitcnt lgkmcnt(9)
    buffer_load_dwordx4 v37, s[8:11], s40 offen offset:1024 lds
    v_mfma_f32_16x16x32_bf16 v[252:255], a[184:187], a[100:103], v[252:255]
    s_waitcnt lgkmcnt(7)
    ds_read_b64_tr_b16 a[174:175], v29 offset:12288
    ds_read_b64_tr_b16 a[176:177], v30 offset:0
    v_mfma_f32_16x16x32_bf16 v[252:255], a[188:191], a[108:111], v[252:255]
    ds_read_b64_tr_b16 a[178:179], v30 offset:4096
    v_permlane16_swap_b32 v84, v86
    v_mfma_f32_16x16x32_bf16 v[248:251], a[188:191], a[104:107], v[248:251]
    ds_read_b64_tr_b16 a[180:181], v30 offset:8192
    v_permlane16_swap_b32 v85, v87
    v_mfma_f32_16x16x32_bf16 v[248:251], a[184:187], a[96:99], v[248:251]
    s_waitcnt lgkmcnt(9)
    buffer_load_dwordx4 v38, s[8:11], s40 offen offset:2048 lds
    v_mfma_f32_16x16x32_bf16 v[192:195], a[160:163], a[112:115], v[192:195]
    s_waitcnt lgkmcnt(7)
    ds_read_b64_tr_b16 a[182:183], v30 offset:12288
    ds_read_b64_tr_b16 a[184:185], v31 offset:0
    v_mfma_f32_16x16x32_bf16 v[192:195], a[164:167], a[120:123], v[192:195]
    ds_read_b64_tr_b16 a[186:187], v31 offset:4096
    v_mul_f32 v160, s36, v160
    v_mfma_f32_16x16x32_bf16 v[196:199], a[164:167], a[124:127], v[196:199]
    ds_read_b64_tr_b16 a[188:189], v31 offset:8192
    v_mul_f32 v161, s36, v161
    v_mfma_f32_16x16x32_bf16 v[196:199], a[160:163], a[116:119], v[196:199]
    s_waitcnt lgkmcnt(9)
    buffer_load_dwordx4 v39, s[8:11], s40 offen offset:3072 lds
    v_mfma_f32_16x16x32_bf16 v[204:207], a[168:171], a[116:119], v[204:207]
    s_waitcnt lgkmcnt(7)
    s_add_u32 s40, s40, 16384
    ds_read_b64_tr_b16 a[190:191], v31 offset:12288
    ds_read_b64_tr_b16 a[160:161], v32 offset:0
    v_mfma_f32_16x16x32_bf16 v[204:207], a[172:175], a[124:127], v[204:207]
    ds_read_b64_tr_b16 a[162:163], v32 offset:4096
    v_mul_f32 v162, s36, v162
    v_mfma_f32_16x16x32_bf16 v[200:203], a[172:175], a[120:123], v[200:203]
    s_add_u32 m0, s42, 65536
    ds_read_b64_tr_b16 a[164:165], v32 offset:8192
    v_mul_f32 v163, s36, v163
    v_mfma_f32_16x16x32_bf16 v[200:203], a[168:171], a[112:115], v[200:203]
    s_waitcnt lgkmcnt(9)
    buffer_load_dwordx4 v40, s[12:15], s41 offen lds
    v_mfma_f32_16x16x32_bf16 v[208:211], a[176:179], a[112:115], v[208:211]
    s_waitcnt lgkmcnt(7)
    ds_read_b64_tr_b16 a[166:167], v32 offset:12288
    ds_read_b64_tr_b16 a[168:169], v33 offset:0
    v_mfma_f32_16x16x32_bf16 v[208:211], a[180:183], a[120:123], v[208:211]
    ds_read_b64_tr_b16 a[170:171], v33 offset:4096
    v_mul_f32 v168, s36, v168
    v_mfma_f32_16x16x32_bf16 v[212:215], a[180:183], a[124:127], v[212:215]
    ds_read_b64_tr_b16 a[172:173], v33 offset:8192
    v_mul_f32 v169, s36, v169
    v_mfma_f32_16x16x32_bf16 v[212:215], a[176:179], a[116:119], v[212:215]
    s_waitcnt lgkmcnt(9)
    buffer_load_dwordx4 v41, s[12:15], s41 offen offset:1024 lds
    v_mfma_f32_16x16x32_bf16 v[220:223], a[184:187], a[116:119], v[220:223]
    s_waitcnt lgkmcnt(7)
    ds_read_b64_tr_b16 a[174:175], v33 offset:12288
    ds_read_b64_tr_b16 a[176:177], v34 offset:0
    v_mfma_f32_16x16x32_bf16 v[220:223], a[188:191], a[124:127], v[220:223]
    ds_read_b64_tr_b16 a[178:179], v34 offset:4096
    v_mul_f32 v170, s36, v170
    v_mfma_f32_16x16x32_bf16 v[216:219], a[188:191], a[120:123], v[216:219]
    ds_read_b64_tr_b16 a[180:181], v34 offset:8192
    v_mul_f32 v171, s36, v171
    v_mfma_f32_16x16x32_bf16 v[216:219], a[184:187], a[112:115], v[216:219]
    s_waitcnt lgkmcnt(9)
    buffer_load_dwordx4 v40, s[12:15], s41 offen offset:2048 lds
    v_mfma_f32_16x16x32_bf16 v[224:227], a[160:163], a[112:115], v[224:227]
    s_waitcnt lgkmcnt(7)
    ds_read_b64_tr_b16 a[182:183], v34 offset:12288
    ds_read_b64_tr_b16 a[184:185], v35 offset:0
    v_mfma_f32_16x16x32_bf16 v[224:227], a[164:167], a[120:123], v[224:227]
    ds_read_b64_tr_b16 a[186:187], v35 offset:4096
    v_mul_f32 v164, s36, v164
    v_mfma_f32_16x16x32_bf16 v[228:231], a[164:167], a[124:127], v[228:231]
    ds_read_b64_tr_b16 a[188:189], v35 offset:8192
    v_mul_f32 v165, s36, v165
    v_mfma_f32_16x16x32_bf16 v[228:231], a[160:163], a[116:119], v[228:231]
    s_waitcnt lgkmcnt(9)
    buffer_load_dwordx4 v41, s[12:15], s41 offen offset:3072 lds
    v_mfma_f32_16x16x32_bf16 v[236:239], a[168:171], a[116:119], v[236:239]
    s_waitcnt lgkmcnt(7)
    s_add_u32 s41, s41, 16384
    ds_read_b64_tr_b16 a[190:191], v35 offset:12288
    ds_read_b64_tr_b16 a[160:161], v28 offset:16384
    v_mfma_f32_16x16x32_bf16 v[236:239], a[172:175], a[124:127], v[236:239]
    ds_read_b64_tr_b16 a[162:163], v28 offset:20480
    v_mul_f32 v166, s36, v166
    v_mfma_f32_16x16x32_bf16 v[232:235], a[172:175], a[120:123], v[232:235]
    s_add_u32 m0, s42, 81920
    ds_read_b64_tr_b16 a[164:165], v28 offset:24576
    v_mul_f32 v167, s36, v167
    v_mfma_f32_16x16x32_bf16 v[232:235], a[168:171], a[112:115], v[232:235]
    s_waitcnt lgkmcnt(9)
    buffer_load_dwordx4 v40, s[12:15], s41 offen lds
    v_mfma_f32_16x16x32_bf16 v[240:243], a[176:179], a[112:115], v[240:243]
    s_waitcnt lgkmcnt(7)
    ds_read_b64_tr_b16 a[166:167], v28 offset:28672
    ds_read_b64_tr_b16 a[168:169], v29 offset:16384
    v_mfma_f32_16x16x32_bf16 v[240:243], a[180:183], a[120:123], v[240:243]
    ds_read_b64_tr_b16 a[170:171], v29 offset:20480
    v_mul_f32 v172, s36, v172
    v_mfma_f32_16x16x32_bf16 v[244:247], a[180:183], a[124:127], v[244:247]
    ds_read_b64_tr_b16 a[172:173], v29 offset:24576
    v_mul_f32 v173, s36, v173
    v_mfma_f32_16x16x32_bf16 v[244:247], a[176:179], a[116:119], v[244:247]
    s_waitcnt lgkmcnt(9)
    buffer_load_dwordx4 v41, s[12:15], s41 offen offset:1024 lds
    v_mfma_f32_16x16x32_bf16 v[252:255], a[184:187], a[116:119], v[252:255]
    s_waitcnt lgkmcnt(7)
    ds_read_b64_tr_b16 a[174:175], v29 offset:28672
    ds_read_b64_tr_b16 a[176:177], v30 offset:16384
    v_mfma_f32_16x16x32_bf16 v[252:255], a[188:191], a[124:127], v[252:255]
    ds_read_b64_tr_b16 a[178:179], v30 offset:20480
    v_mul_f32 v174, s36, v174
    v_mfma_f32_16x16x32_bf16 v[248:251], a[188:191], a[120:123], v[248:251]
    ds_read_b64_tr_b16 a[180:181], v30 offset:24576
    v_mul_f32 v175, s36, v175
    v_mfma_f32_16x16x32_bf16 v[248:251], a[184:187], a[112:115], v[248:251]
    s_waitcnt lgkmcnt(9)
    buffer_load_dwordx4 v40, s[12:15], s41 offen offset:2048 lds
    v_mfma_f32_16x16x32_bf16 v[192:195], a[160:163], a[128:131], v[192:195]
    s_waitcnt lgkmcnt(7)
    ds_read_b64_tr_b16 a[182:183], v30 offset:28672
    ds_read_b64_tr_b16 a[184:185], v31 offset:16384
    v_mfma_f32_16x16x32_bf16 v[192:195], a[164:167], a[136:139], v[192:195]
    ds_read_b64_tr_b16 a[186:187], v31 offset:20480
    v_cvt_pk_bf16_f32 v72, v160, v161
    v_mfma_f32_16x16x32_bf16 v[196:199], a[164:167], a[140:143], v[196:199]
    ds_read_b64_tr_b16 a[188:189], v31 offset:24576
    v_cvt_pk_bf16_f32 v73, v162, v163
    v_mfma_f32_16x16x32_bf16 v[196:199], a[160:163], a[132:135], v[196:199]
    s_waitcnt lgkmcnt(9)
    buffer_load_dwordx4 v41, s[12:15], s41 offen offset:3072 lds
    v_mfma_f32_16x16x32_bf16 v[204:207], a[168:171], a[132:135], v[204:207]
    s_waitcnt lgkmcnt(7)
    s_add_u32 s41, s41, 16384
    ds_read_b64_tr_b16 a[190:191], v31 offset:28672
    ds_read_b64_tr_b16 a[160:161], v32 offset:16384
    v_mfma_f32_16x16x32_bf16 v[204:207], a[172:175], a[140:143], v[204:207]
    ds_read_b64_tr_b16 a[162:163], v32 offset:20480
    v_cvt_pk_bf16_f32 v74, v168, v169
    v_mfma_f32_16x16x32_bf16 v[200:203], a[172:175], a[136:139], v[200:203]
    ds_read_b64_tr_b16 a[164:165], v32 offset:24576
    v_cvt_pk_bf16_f32 v75, v170, v171
    v_mfma_f32_16x16x32_bf16 v[200:203], a[168:171], a[128:131], v[200:203]
    s_waitcnt lgkmcnt(9)
    ds_read_b64_tr_b16 a[166:167], v32 offset:28672
    v_cvt_pk_bf16_f32 v88, v164, v165
    v_mfma_f32_16x16x32_bf16 v[208:211], a[176:179], a[128:131], v[208:211]
    s_waitcnt lgkmcnt(8)
    ds_read_b64_tr_b16 a[168:169], v33 offset:16384
    v_cvt_pk_bf16_f32 v89, v166, v167
    v_mfma_f32_16x16x32_bf16 v[208:211], a[180:183], a[136:139], v[208:211]
    ds_read_b64_tr_b16 a[170:171], v33 offset:20480
    v_cvt_pk_bf16_f32 v90, v172, v173
    v_mfma_f32_16x16x32_bf16 v[212:215], a[180:183], a[140:143], v[212:215]
    ds_read_b64_tr_b16 a[172:173], v33 offset:24576
    v_cvt_pk_bf16_f32 v91, v174, v175
    v_mfma_f32_16x16x32_bf16 v[212:215], a[176:179], a[132:135], v[212:215]
    s_waitcnt lgkmcnt(9)
    ds_read_b64_tr_b16 a[174:175], v33 offset:28672
    v_permlane32_swap_b32 v72, v74
    v_mfma_f32_16x16x32_bf16 v[220:223], a[184:187], a[132:135], v[220:223]
    s_waitcnt lgkmcnt(8)
    ds_read_b64_tr_b16 a[176:177], v34 offset:16384
    v_permlane32_swap_b32 v73, v75
    v_mfma_f32_16x16x32_bf16 v[220:223], a[188:191], a[140:143], v[220:223]
    ds_read_b64_tr_b16 a[178:179], v34 offset:20480
    v_permlane32_swap_b32 v88, v90
    v_mfma_f32_16x16x32_bf16 v[216:219], a[188:191], a[136:139], v[216:219]
    ds_read_b64_tr_b16 a[180:181], v34 offset:24576
    v_permlane32_swap_b32 v89, v91
    v_mfma_f32_16x16x32_bf16 v[216:219], a[184:187], a[128:131], v[216:219]
    s_waitcnt lgkmcnt(9)
    ds_read_b64_tr_b16 a[182:183], v34 offset:28672
    v_permlane16_swap_b32 v72, v74
    v_mfma_f32_16x16x32_bf16 v[224:227], a[160:163], a[128:131], v[224:227]
    s_waitcnt lgkmcnt(8)
    ds_read_b64_tr_b16 a[184:185], v35 offset:16384
    v_permlane16_swap_b32 v73, v75
    v_mfma_f32_16x16x32_bf16 v[224:227], a[164:167], a[136:139], v[224:227]
    ds_read_b64_tr_b16 a[186:187], v35 offset:20480
    v_permlane16_swap_b32 v88, v90
    v_mfma_f32_16x16x32_bf16 v[228:231], a[164:167], a[140:143], v[228:231]
    ds_read_b64_tr_b16 a[188:189], v35 offset:24576
    v_permlane16_swap_b32 v89, v91
    v_mfma_f32_16x16x32_bf16 v[228:231], a[160:163], a[132:135], v[228:231]
    s_waitcnt lgkmcnt(9)
    ds_read_b64_tr_b16 a[190:191], v35 offset:28672
    v_mul_f32 v176, s36, v176
    v_mfma_f32_16x16x32_bf16 v[236:239], a[168:171], a[132:135], v[236:239]
    s_waitcnt lgkmcnt(8)
    v_mul_f32 v177, s36, v177
    v_mul_f32 v178, s36, v178
    v_mfma_f32_16x16x32_bf16 v[236:239], a[172:175], a[140:143], v[236:239]
    v_mul_f32 v179, s36, v179
    v_mul_f32 v184, s36, v184
    v_mfma_f32_16x16x32_bf16 v[232:235], a[172:175], a[136:139], v[232:235]
    v_mul_f32 v185, s36, v185
    v_mul_f32 v186, s36, v186
    v_mfma_f32_16x16x32_bf16 v[232:235], a[168:171], a[128:131], v[232:235]
    s_waitcnt lgkmcnt(6)
    v_mul_f32 v187, s36, v187
    v_mul_f32 v180, s36, v180
    s_waitcnt vmcnt(16)
    s_barrier
    v_mfma_f32_16x16x32_bf16 v[240:243], a[176:179], a[128:131], v[240:243]
    s_waitcnt lgkmcnt(4)
    ds_read_b128 a[208:211], v8 offset:0
    v_mul_f32 v181, s36, v181
    v_mfma_f32_16x16x32_bf16 v[240:243], a[180:183], a[136:139], v[240:243]
    ds_read_b128 a[212:215], v9 offset:0
    v_mul_f32 v182, s36, v182
    v_mfma_f32_16x16x32_bf16 v[244:247], a[180:183], a[140:143], v[244:247]
    ds_read_b128 a[216:219], v10 offset:0
    v_mul_f32 v183, s36, v183
    v_mfma_f32_16x16x32_bf16 v[244:247], a[176:179], a[132:135], v[244:247]
    s_waitcnt lgkmcnt(5)
    ds_read_b128 a[220:223], v11 offset:0
    v_mul_f32 v188, s36, v188
    v_mfma_f32_16x16x32_bf16 v[252:255], a[184:187], a[132:135], v[252:255]
    s_waitcnt lgkmcnt(4)
    ds_read_b128 a[224:227], v8 offset:4096
    v_mul_f32 v189, s36, v189
    v_mfma_f32_16x16x32_bf16 v[252:255], a[188:191], a[140:143], v[252:255]
    v_mul_f32 v190, s36, v190
    v_mul_f32 v191, s36, v191
    v_mfma_f32_16x16x32_bf16 v[248:251], a[188:191], a[136:139], v[248:251]
    s_load_dwordx2 s[16:17], s[0:1], 88
    v_cvt_pk_bf16_f32 v76, v176, v177
    v_cvt_pk_bf16_f32 v77, v178, v179
    v_mfma_f32_16x16x32_bf16 v[248:251], a[184:187], a[128:131], v[248:251]
    v_cvt_pk_bf16_f32 v78, v184, v185
    v_cvt_pk_bf16_f32 v79, v186, v187
    v_cvt_pk_bf16_f32 v92, v180, v181
    v_cvt_pk_bf16_f32 v93, v182, v183
    v_cvt_pk_bf16_f32 v94, v188, v189
    v_cvt_pk_bf16_f32 v95, v190, v191
    v_permlane32_swap_b32 v76, v78
    v_permlane32_swap_b32 v77, v79
    v_permlane32_swap_b32 v92, v94
    v_permlane32_swap_b32 v93, v95
    v_permlane16_swap_b32 v76, v78
    v_permlane16_swap_b32 v77, v79
    v_permlane16_swap_b32 v92, v94
    v_permlane16_swap_b32 v93, v95
    s_mov_b32 s36, 1040356334
    s_mov_b32 s37, 1040356334
    v_mov_b32 v58, 0
    v_mov_b32 v59, 0
    v_mov_b32 v60, 0
    v_mov_b32 v61, 0
    v_pk_mul_f32 v[192:193], v[192:193], s[36:37]
    v_pk_mul_f32 v[194:195], v[194:195], s[36:37]
    v_pk_mul_f32 v[200:201], v[200:201], s[36:37]
    v_pk_mul_f32 v[202:203], v[202:203], s[36:37]
    v_pk_mul_f32 v[196:197], v[196:197], s[36:37]
    v_pk_mul_f32 v[198:199], v[198:199], s[36:37]
    v_pk_mul_f32 v[204:205], v[204:205], s[36:37]
    v_pk_mul_f32 v[206:207], v[206:207], s[36:37]
    v_mfma_f32_32x32x16_bf16 a[0:15], v[58:61], v[58:61], 0
    v_cvt_pk_bf16_f32 v96, v192, v193
    v_cvt_pk_bf16_f32 v97, v194, v195
    v_cvt_pk_bf16_f32 v98, v200, v201
    v_cvt_pk_bf16_f32 v99, v202, v203
    v_cvt_pk_bf16_f32 v112, v196, v197
    v_cvt_pk_bf16_f32 v113, v198, v199
    v_cvt_pk_bf16_f32 v114, v204, v205
    v_cvt_pk_bf16_f32 v115, v206, v207
    v_mfma_f32_32x32x16_bf16 a[16:31], v[58:61], v[58:61], 0
    v_permlane32_swap_b32 v96, v98
    v_permlane32_swap_b32 v97, v99
    v_permlane32_swap_b32 v112, v114
    v_permlane32_swap_b32 v113, v115
    v_permlane16_swap_b32 v96, v98
    v_permlane16_swap_b32 v97, v99
    v_permlane16_swap_b32 v112, v114
    v_permlane16_swap_b32 v113, v115
    v_pk_mul_f32 v[208:209], v[208:209], s[36:37]
    v_pk_mul_f32 v[210:211], v[210:211], s[36:37]
    v_pk_mul_f32 v[216:217], v[216:217], s[36:37]
    v_pk_mul_f32 v[218:219], v[218:219], s[36:37]
    v_pk_mul_f32 v[212:213], v[212:213], s[36:37]
    v_pk_mul_f32 v[214:215], v[214:215], s[36:37]
    v_pk_mul_f32 v[220:221], v[220:221], s[36:37]
    v_pk_mul_f32 v[222:223], v[222:223], s[36:37]
    v_mfma_f32_32x32x16_bf16 a[32:47], v[58:61], v[58:61], 0
    v_cvt_pk_bf16_f32 v100, v208, v209
    v_cvt_pk_bf16_f32 v101, v210, v211
    v_cvt_pk_bf16_f32 v102, v216, v217
    v_cvt_pk_bf16_f32 v103, v218, v219
    v_cvt_pk_bf16_f32 v116, v212, v213
    v_cvt_pk_bf16_f32 v117, v214, v215
    v_cvt_pk_bf16_f32 v118, v220, v221
    v_cvt_pk_bf16_f32 v119, v222, v223
    v_mfma_f32_32x32x16_bf16 a[48:63], v[58:61], v[58:61], 0
    v_permlane32_swap_b32 v100, v102
    v_permlane32_swap_b32 v101, v103
    v_permlane32_swap_b32 v116, v118
    v_permlane32_swap_b32 v117, v119
    v_permlane16_swap_b32 v100, v102
    v_permlane16_swap_b32 v101, v103
    v_permlane16_swap_b32 v116, v118
    v_permlane16_swap_b32 v117, v119
    v_pk_mul_f32 v[224:225], v[224:225], s[36:37]
    v_pk_mul_f32 v[226:227], v[226:227], s[36:37]
    v_pk_mul_f32 v[232:233], v[232:233], s[36:37]
    v_pk_mul_f32 v[234:235], v[234:235], s[36:37]
    v_pk_mul_f32 v[228:229], v[228:229], s[36:37]
    v_pk_mul_f32 v[230:231], v[230:231], s[36:37]
    v_pk_mul_f32 v[236:237], v[236:237], s[36:37]
    v_pk_mul_f32 v[238:239], v[238:239], s[36:37]
    v_mfma_f32_32x32x16_bf16 a[64:79], v[58:61], v[58:61], 0
    v_cvt_pk_bf16_f32 v104, v224, v225
    v_cvt_pk_bf16_f32 v105, v226, v227
    v_cvt_pk_bf16_f32 v106, v232, v233
    v_cvt_pk_bf16_f32 v107, v234, v235
    v_cvt_pk_bf16_f32 v120, v228, v229
    v_cvt_pk_bf16_f32 v121, v230, v231
    v_cvt_pk_bf16_f32 v122, v236, v237
    v_cvt_pk_bf16_f32 v123, v238, v239
    v_mfma_f32_32x32x16_bf16 a[80:95], v[58:61], v[58:61], 0
    v_permlane32_swap_b32 v104, v106
    v_permlane32_swap_b32 v105, v107
    v_permlane32_swap_b32 v120, v122
    v_permlane32_swap_b32 v121, v123
    v_permlane16_swap_b32 v104, v106
    v_permlane16_swap_b32 v105, v107
    v_permlane16_swap_b32 v120, v122
    v_permlane16_swap_b32 v121, v123
    v_pk_mul_f32 v[240:241], v[240:241], s[36:37]
    v_pk_mul_f32 v[242:243], v[242:243], s[36:37]
    v_pk_mul_f32 v[248:249], v[248:249], s[36:37]
    v_pk_mul_f32 v[250:251], v[250:251], s[36:37]
    v_pk_mul_f32 v[244:245], v[244:245], s[36:37]
    v_pk_mul_f32 v[246:247], v[246:247], s[36:37]
    v_pk_mul_f32 v[252:253], v[252:253], s[36:37]
    v_pk_mul_f32 v[254:255], v[254:255], s[36:37]
    v_mfma_f32_32x32x16_bf16 a[96:111], v[58:61], v[58:61], 0
    v_cvt_pk_bf16_f32 v108, v240, v241
    v_cvt_pk_bf16_f32 v109, v242, v243
    v_cvt_pk_bf16_f32 v110, v248, v249
    v_cvt_pk_bf16_f32 v111, v250, v251
    v_cvt_pk_bf16_f32 v124, v244, v245
    v_cvt_pk_bf16_f32 v125, v246, v247
    v_cvt_pk_bf16_f32 v126, v252, v253
    v_cvt_pk_bf16_f32 v127, v254, v255
    v_mfma_f32_32x32x16_bf16 a[112:127], v[58:61], v[58:61], 0
    v_permlane32_swap_b32 v108, v110
    v_permlane32_swap_b32 v109, v111
    v_permlane32_swap_b32 v124, v126
    v_permlane32_swap_b32 v125, v127
    v_permlane16_swap_b32 v108, v110
    v_permlane16_swap_b32 v109, v111
    v_permlane16_swap_b32 v124, v126
    v_permlane16_swap_b32 v125, v127
    s_waitcnt lgkmcnt(0)
    v_mfma_f32_16x16x32_bf16 v[216:219], a[208:211], v[64:67], 0
    v_mfma_f32_16x16x32_bf16 v[216:219], a[212:215], v[68:71], v[216:219]
    v_mfma_f32_16x16x32_bf16 v[216:219], a[216:219], v[72:75], v[216:219]
    v_mfma_f32_16x16x32_bf16 v[216:219], a[220:223], v[76:79], v[216:219]
    v_mfma_f32_16x16x32_bf16 v[220:223], a[208:211], v[80:83], 0
    v_mfma_f32_16x16x32_bf16 v[220:223], a[212:215], v[84:87], v[220:223]
    v_mfma_f32_16x16x32_bf16 v[220:223], a[216:219], v[88:91], v[220:223]
    v_mfma_f32_16x16x32_bf16 v[220:223], a[220:223], v[92:95], v[220:223]
    v_mfma_f32_16x16x32_bf16 v[224:227], a[208:211], v[96:99], 0
    v_mfma_f32_16x16x32_bf16 v[224:227], a[212:215], v[100:103], v[224:227]
    v_mfma_f32_16x16x32_bf16 v[224:227], a[216:219], v[104:107], v[224:227]
    v_mfma_f32_16x16x32_bf16 v[224:227], a[220:223], v[108:111], v[224:227]
    v_mfma_f32_16x16x32_bf16 v[228:231], a[208:211], v[112:115], 0
    v_mfma_f32_16x16x32_bf16 v[228:231], a[212:215], v[116:119], v[228:231]
    v_mfma_f32_16x16x32_bf16 v[228:231], a[216:219], v[120:123], v[228:231]
    v_mfma_f32_16x16x32_bf16 v[228:231], a[220:223], v[124:127], v[228:231]
    v_mfma_f32_32x32x16_bf16 a[192:207], v[58:61], v[58:61], 0
    v_max3_f32 v232, v216, v217, v218
    v_max_f32 v232, v232, v219
    v_max3_f32 v233, v220, v221, v222
    v_max_f32 v233, v233, v223
    v_max3_f32 v234, v224, v225, v226
    v_max_f32 v234, v234, v227
    s_nop 0
    v_max3_f32 v235, v228, v229, v230
    v_max_f32 v235, v235, v231
    v_mov_b32 v236, v232
    v_mov_b32 v237, v233
    v_mov_b32 v238, v234
    v_mov_b32 v239, v235
    v_permlane16_swap_b32 v232, v236
    v_permlane16_swap_b32 v233, v237
    v_permlane16_swap_b32 v234, v238
    v_permlane16_swap_b32 v235, v239
    v_max_f32 v232, v232, v236
    v_max_f32 v233, v233, v237
    v_max_f32 v234, v234, v238
    v_max_f32 v235, v235, v239
    v_mov_b32 v236, v232
    v_mov_b32 v237, v233
    v_mov_b32 v238, v234
    v_mov_b32 v239, v235
    v_permlane32_swap_b32 v232, v236
    v_permlane32_swap_b32 v233, v237
    v_permlane32_swap_b32 v234, v238
    v_permlane32_swap_b32 v235, v239
    v_max_f32 v232, v232, v236
    v_max_f32 v233, v233, v237
    v_max_f32 v234, v234, v238
    v_max_f32 v235, v235, v239
    v_sub_f32 v192, 3250585600, v232
    v_sub_f32 v193, 3250585600, v232
    v_sub_f32 v194, 3250585600, v232
    v_sub_f32 v195, 3250585600, v232
    v_sub_f32 v196, 3250585600, v233
    v_sub_f32 v197, 3250585600, v233
Ltour0_3:
    s_cbranch_execz Ltour0_7
    v_sub_f32 v198, 3250585600, v233
    v_sub_f32 v199, 3250585600, v233
    v_sub_f32 v200, 3250585600, v234
    v_sub_f32 v201, 3250585600, v234
    v_sub_f32 v202, 3250585600, v234
    v_sub_f32 v203, 3250585600, v234
    v_sub_f32 v204, 3250585600, v235
    v_sub_f32 v205, 3250585600, v235
    v_sub_f32 v206, 3250585600, v235
    v_sub_f32 v207, 3250585600, v235
Lattn_stage0:
    s_mov_b32 s43, 7
    v_mfma_f32_16x16x32_bf16 v[208:211], a[208:211], v[64:67], v[192:195]
    s_lshl_b32 s53, s5, 4
    v_lshrrev_b32 v51, 2, v0
    v_mul_u32_u24 v51, 9216, v51
    v_mfma_f32_16x16x32_bf16 v[208:211], a[212:215], v[68:71], v[208:211]
    s_add_u32 s53, s53, s4
    v_and_b32 v254, 3, v0
    v_lshl_add_u32 v254, v254, 4, v51
    v_mfma_f32_16x16x32_bf16 v[208:211], a[216:219], v[72:75], v[208:211]
    s_lshl_b32 s53, s53, 2
    v_lshlrev_b32 v255, 4, v0
    v_add_u32 v51, 98304, v255
    v_mfma_f32_16x16x32_bf16 v[208:211], a[220:223], v[76:79], v[208:211]
    s_add_u32 s53, s53, s3
    v_mov_b32 v224, 0
    v_mfma_f32_16x16x32_bf16 v[212:215], a[208:211], v[80:83], v[196:199]
    s_mul_i32 s53, s53, 4608
    ds_read_b128 a[228:231], v9 offset:4096
    v_mov_b32 v225, 0
    v_mfma_f32_16x16x32_bf16 v[212:215], a[212:215], v[84:87], v[212:215]
    s_add_u32 s53, s53, 2621440
    v_exp_f32 v208, v208
    v_mfma_f32_16x16x32_bf16 v[212:215], a[216:219], v[88:91], v[212:215]
    s_lshr_b32 s44, s2, 5
    v_exp_f32 v209, v209
    v_mfma_f32_16x16x32_bf16 v[212:215], a[220:223], v[92:95], v[212:215]
    s_lshl_b32 s44, s44, 3
    v_exp_f32 v210, v210
    v_exp_f32 v211, v211
    v_cvt_pk_bf16_f32 v128, v208, v209
    v_cvt_pk_bf16_f32 v129, v210, v211
    v_mfma_f32_16x16x32_bf16 v[208:211], a[208:211], v[96:99], v[200:203]
    s_and_b32 s37, s2, 7
    ds_read_b128 a[232:235], v10 offset:4096
    v_mov_b32 v226, 0
    v_mfma_f32_16x16x32_bf16 v[208:211], a[212:215], v[100:103], v[208:211]
    s_add_u32 s44, s44, s37
    v_exp_f32 v212, v212
    v_mfma_f32_16x16x32_bf16 v[208:211], a[216:219], v[104:107], v[208:211]
    s_lshl_b32 s44, s44, 2
    v_exp_f32 v213, v213
    v_mfma_f32_16x16x32_bf16 v[208:211], a[220:223], v[108:111], v[208:211]
    s_bfe_u32 s37, s2, 0x20003
    v_exp_f32 v214, v214
    v_exp_f32 v215, v215
    v_cvt_pk_bf16_f32 v136, v212, v213
    v_cvt_pk_bf16_f32 v137, v214, v215
    v_mfma_f32_16x16x32_bf16 v[212:215], a[208:211], v[112:115], v[204:207]
    s_add_u32 s44, s44, s37
    ds_read_b128 a[236:239], v11 offset:4096
    v_mov_b32 v227, 0
    v_mfma_f32_16x16x32_bf16 v[212:215], a[212:215], v[116:119], v[212:215]
    s_add_u32 s44, s44, 72
    v_exp_f32 v208, v208
    v_mfma_f32_16x16x32_bf16 v[212:215], a[216:219], v[120:123], v[212:215]
    s_cmp_lt_u32 s44, 216
    s_cselect_b32 s37, 0, 2147483648
    v_exp_f32 v209, v209
    v_mfma_f32_16x16x32_bf16 v[212:215], a[220:223], v[124:127], v[212:215]
    s_lshl_b32 s44, s44, 5
    v_exp_f32 v210, v210
    v_exp_f32 v211, v211
    v_cvt_pk_bf16_f32 v144, v208, v209
    v_cvt_pk_bf16_f32 v145, v210, v211
    v_mfma_f32_16x16x32_bf16 v[208:211], a[224:227], v[64:67], v[192:195]
    s_waitcnt lgkmcnt(2)
    s_or_b32 s44, s44, s37
    ds_read_b128 a[208:211], v8 offset:8192
    v_mov_b32 v228, 0
    v_mfma_f32_16x16x32_bf16 v[208:211], a[228:231], v[68:71], v[208:211]
    s_waitcnt lgkmcnt(2)
    s_mov_b32 s18, 3981312
    v_exp_f32 v212, v212
    v_mfma_f32_16x16x32_bf16 v[208:211], a[232:235], v[72:75], v[208:211]
    s_waitcnt lgkmcnt(1)
    s_lshr_b32 s6, s2, 3
    v_exp_f32 v213, v213
    v_mfma_f32_16x16x32_bf16 v[208:211], a[236:239], v[76:79], v[208:211]
    s_and_b32 s7, s2, 7
    v_exp_f32 v214, v214
    v_exp_f32 v215, v215
    v_cvt_pk_bf16_f32 v152, v212, v213
    v_cvt_pk_bf16_f32 v153, v214, v215
    v_mfma_f32_16x16x32_bf16 v[212:215], a[224:227], v[80:83], v[196:199]
    s_mul_i32 s7, s7, 18
    ds_read_b128 a[212:215], v9 offset:8192
    v_mov_b32 v229, 0
    v_mfma_f32_16x16x32_bf16 v[212:215], a[228:231], v[84:87], v[212:215]
    s_add_u32 s7, s7, s6
    v_exp_f32 v208, v208
    v_mfma_f32_16x16x32_bf16 v[212:215], a[232:235], v[88:91], v[212:215]
    s_lshl_b32 s58, s7, 6
    v_exp_f32 v209, v209
    v_mfma_f32_16x16x32_bf16 v[212:215], a[236:239], v[92:95], v[212:215]
    s_mul_i32 s59, s7, 36864
    v_exp_f32 v210, v210
    v_exp_f32 v211, v211
    v_cvt_pk_bf16_f32 v130, v208, v209
    v_cvt_pk_bf16_f32 v131, v210, v211
    v_mfma_f32_16x16x32_bf16 v[208:211], a[224:227], v[96:99], v[200:203]
    s_cmp_lt_u32 s6, 18
    s_cselect_b32 s7, 0, 2147483648
    ds_read_b128 a[216:219], v10 offset:8192
    v_mov_b32 v230, 0
    v_mfma_f32_16x16x32_bf16 v[208:211], a[228:231], v[100:103], v[208:211]
    s_or_b32 s58, s58, s7
    v_exp_f32 v212, v212
    v_mfma_f32_16x16x32_bf16 v[208:211], a[232:235], v[104:107], v[208:211]
    s_or_b32 s59, s59, s7
    v_exp_f32 v213, v213
    v_mfma_f32_16x16x32_bf16 v[208:211], a[236:239], v[108:111], v[208:211]
    s_and_b32 s7, s4, 1
    v_exp_f32 v214, v214
    v_exp_f32 v215, v215
    v_cvt_pk_bf16_f32 v138, v212, v213
    v_cvt_pk_bf16_f32 v139, v214, v215
    s_mov_b32 s39, 221184
    s_mov_b32 s38, 27648
    v_mfma_f32_16x16x32_bf16 v[212:215], a[224:227], v[112:115], v[204:207]
    s_lshl_b32 s6, s7, 7
    ds_read_b128 a[220:223], v11 offset:8192
    v_mov_b32 v231, 0
    v_mfma_f32_16x16x32_bf16 v[212:215], a[228:231], v[116:119], v[212:215]
    s_xor_b32 s36, s4, 1
    v_exp_f32 v208, v208
    v_mfma_f32_16x16x32_bf16 v[212:215], a[232:235], v[120:123], v[212:215]
    s_mul_i32 s36, s36, 294912
    v_exp_f32 v209, v209
    v_mfma_f32_16x16x32_bf16 v[212:215], a[236:239], v[124:127], v[212:215]
    s_waitcnt lgkmcnt(3)
    s_add_u32 s46, s36, s6
    v_exp_f32 v210, v210
    v_exp_f32 v211, v211
    v_cvt_pk_bf16_f32 v146, v208, v209
    v_cvt_pk_bf16_f32 v147, v210, v211
    v_mfma_f32_16x16x32_bf16 v[208:211], a[208:211], v[64:67], v[192:195]
    s_waitcnt lgkmcnt(2)
    s_lshl_b32 s36, s4, 8
    ds_read_b128 a[224:227], v8 offset:12288
    v_mov_b32 v248, -1
    v_mfma_f32_16x16x32_bf16 v[208:211], a[212:215], v[68:71], v[208:211]
    s_waitcnt lgkmcnt(2)
    s_add_u32 s56, s47, s36
    v_exp_f32 v212, v212
    v_mfma_f32_16x16x32_bf16 v[208:211], a[216:219], v[72:75], v[208:211]
    s_waitcnt lgkmcnt(1)
    s_lshr_b32 s36, s4, 1
    v_exp_f32 v213, v213
    v_mfma_f32_16x16x32_bf16 v[208:211], a[220:223], v[76:79], v[208:211]
    s_lshl_b32 s36, s36, 11
    v_exp_f32 v214, v214
    v_exp_f32 v215, v215
    v_cvt_pk_bf16_f32 v154, v212, v213
    v_cvt_pk_bf16_f32 v155, v214, v215
    v_mfma_f32_16x16x32_bf16 v[212:215], a[208:211], v[80:83], v[196:199]
    s_lshl_b32 s7, s7, 8
    ds_read_b128 a[228:231], v9 offset:12288
    v_mov_b32 v249, -1
    v_mfma_f32_16x16x32_bf16 v[212:215], a[212:215], v[84:87], v[212:215]
    s_add_u32 s36, s36, s7
    v_exp_f32 v208, v208
    v_mfma_f32_16x16x32_bf16 v[212:215], a[216:219], v[88:91], v[212:215]
    s_add_u32 s93, s47, s36
    v_exp_f32 v209, v209
    v_mfma_f32_16x16x32_bf16 v[212:215], a[220:223], v[92:95], v[212:215]
    s_lshr_b32 s36, s4, 1
    v_exp_f32 v210, v210
    v_exp_f32 v211, v211
    v_cvt_pk_bf16_f32 v132, v208, v209
    v_cvt_pk_bf16_f32 v133, v210, v211
    v_mfma_f32_16x16x32_bf16 v[208:211], a[208:211], v[96:99], v[200:203]
    s_lshl_b32 s36, s36, 4
    ds_read_b128 a[232:235], v10 offset:12288
    v_mov_b32 v250, -1
    v_mfma_f32_16x16x32_bf16 v[208:211], a[212:215], v[100:103], v[208:211]
    s_add_u32 s36, s36, s5
    v_exp_f32 v212, v212
    v_mfma_f32_16x16x32_bf16 v[208:211], a[216:219], v[104:107], v[208:211]
    s_lshl_b32 s36, s36, 9
    v_exp_f32 v213, v213
    v_mfma_f32_16x16x32_bf16 v[208:211], a[220:223], v[108:111], v[208:211]
    s_add_u32 s36, s36, s7
    v_exp_f32 v214, v214
    v_exp_f32 v215, v215
    v_cvt_pk_bf16_f32 v140, v212, v213
    v_cvt_pk_bf16_f32 v141, v214, v215
    s_waitcnt vmcnt(4)
    s_barrier
    v_mfma_f32_16x16x32_bf16 v[212:215], a[208:211], v[112:115], v[204:207]
    s_lshl_b32 s36, s36, 8
    ds_read_b128 a[236:239], v11 offset:12288
    v_mov_b32 v251, -1
    v_mfma_f32_16x16x32_bf16 v[212:215], a[212:215], v[116:119], v[212:215]
    s_add_u32 m0, s42, 49152
    s_add_u32 s55, s36, 20971520
    v_exp_f32 v208, v208
    v_mfma_f32_16x16x32_bf16 v[212:215], a[216:219], v[120:123], v[212:215]
    s_add_u32 s7, s45, s6
    v_exp_f32 v209, v209
    v_mfma_f32_16x16x32_bf16 v[212:215], a[220:223], v[124:127], v[212:215]
    s_waitcnt lgkmcnt(3)
    s_xor_b32 s54, s92, 128
    v_exp_f32 v210, v210
    v_exp_f32 v211, v211
    v_cvt_pk_bf16_f32 v148, v208, v209
    v_cvt_pk_bf16_f32 v149, v210, v211
    buffer_load_dwordx4 v36, s[8:11], s40 offen lds
    v_mfma_f32_16x16x32_bf16 v[208:211], a[224:227], v[64:67], v[192:195]
    s_waitcnt lgkmcnt(2)
    s_lshl_b32 s36, s3, 14
    ds_read_b128 a[208:211], v8 offset:16384
    v_min_u32 v232, 41, v1
    v_mfma_f32_16x16x32_bf16 v[208:211], a[228:231], v[68:71], v[208:211]
    s_waitcnt lgkmcnt(2)
    v_exp_f32 v212, v212
    v_mfma_f32_16x16x32_bf16 v[208:211], a[232:235], v[72:75], v[208:211]
    s_waitcnt lgkmcnt(1)
    v_exp_f32 v213, v213
    v_mfma_f32_16x16x32_bf16 v[208:211], a[236:239], v[76:79], v[208:211]
    v_exp_f32 v214, v214
    v_exp_f32 v215, v215
    v_cvt_pk_bf16_f32 v156, v212, v213
    v_cvt_pk_bf16_f32 v157, v214, v215
    v_mfma_f32_16x16x32_bf16 v[212:215], a[224:227], v[80:83], v[196:199]
    ds_read_b128 a[212:215], v9 offset:16384
    v_mfma_f32_16x16x32_bf16 v[212:215], a[228:231], v[84:87], v[212:215]
    s_nop 0
    v_exp_f32 v208, v208
    v_mfma_f32_16x16x32_bf16 v[212:215], a[232:235], v[88:91], v[212:215]
    v_exp_f32 v209, v209
    v_mfma_f32_16x16x32_bf16 v[212:215], a[236:239], v[92:95], v[212:215]
    v_exp_f32 v210, v210
    v_exp_f32 v211, v211
    ds_read_b64_tr_b16 a[160:161], v20 offset:0
    v_cvt_pk_bf16_f32 v134, v208, v209
    v_lshl_add_u32 v252, v1, 4, s36
    v_lshlrev_b32 v232, 4, v232
    s_mov_b32 s57, s58
    s_lshl_b32 s6, s3, 10
    s_add_u32 s6, s6, 135168
    s_lshr_b32 s37, s2, 3
    s_mul_i32 s37, s37, -129024
    s_add_u32 s37, s37, 4128768
    ds_read_b64_tr_b16 a[162:163], v20 offset:4096
    ds_read_b128 a[216:219], v10 offset:16384
    v_cvt_pk_bf16_f32 v135, v210, v211
    buffer_load_dwordx4 v37, s[8:11], s40 offen offset:1024 lds
    v_mfma_f32_16x16x32_bf16 v[208:211], a[224:227], v[96:99], v[200:203]
    v_mfma_f32_16x16x32_bf16 v[208:211], a[228:231], v[100:103], v[208:211]
    v_exp_f32 v212, v212
    v_mfma_f32_16x16x32_bf16 v[208:211], a[232:235], v[104:107], v[208:211]
    v_exp_f32 v213, v213
    v_mfma_f32_16x16x32_bf16 v[208:211], a[236:239], v[108:111], v[208:211]
    s_mov_b32 s52, s55
    v_exp_f32 v214, v214
    v_exp_f32 v215, v215
    ds_read_b64_tr_b16 a[164:165], v20 offset:8192
    v_cvt_pk_bf16_f32 v142, v212, v213
    ds_read_b64_tr_b16 a[166:167], v20 offset:12288
    v_min_u32 v237, 19, v1
    v_lshl_add_u32 v237, v237, 7, s36
    v_lshl_add_u32 v238, v1, 7, s36
    ds_read_b128 a[220:223], v11 offset:16384
    v_cvt_pk_bf16_f32 v143, v214, v215
    buffer_load_dword v217, v57, s[32:35], s37 offen
    v_mfma_f32_16x16x32_bf16 v[212:215], a[224:227], v[112:115], v[204:207]
    v_mfma_f32_16x16x32_bf16 v[212:215], a[228:231], v[116:119], v[212:215]
    v_exp_f32 v208, v208
    v_mfma_f32_16x16x32_bf16 v[212:215], a[232:235], v[120:123], v[212:215]
    s_mul_i32 s37, s5, 18432
    v_exp_f32 v209, v209
    v_mfma_f32_16x16x32_bf16 v[212:215], a[236:239], v[124:127], v[212:215]
    s_add_u32 s37, s37, s45
    v_exp_f32 v210, v210
    v_exp_f32 v211, v211
    ds_read_b64_tr_b16 a[168:169], v21 offset:0
    v_cvt_pk_bf16_f32 v150, v208, v209
    ds_read_b64_tr_b16 a[170:171], v21 offset:4096
    v_min_u32 v236, 143, v0
    v_lshl_add_u32 v236, v236, 7, s37
    v_mul_u32_u24 v235, 24, v0
    v_lshrrev_b32 v235, 8, v235
    v_lshl_add_u32 v235, v235, 7, s37
    ds_read_b128 a[224:227], v8 offset:20480
    v_cvt_pk_bf16_f32 v151, v210, v211
    s_waitcnt lgkmcnt(3)
    buffer_load_dwordx4 v38, s[8:11], s40 offen offset:2048 lds
    s_nop 0
    s_nop 0
    s_nop 0
    s_nop 0
    s_nop 0
    s_nop 0
Lattn_loop:
    v_mfma_f32_16x16x32_bf16 v[208:211], a[208:211], v[64:67], v[192:195]
    v_exp_f32 v212, v212
    v_mfma_f32_16x16x32_bf16 v[208:211], a[212:215], v[68:71], v[208:211]
    v_exp_f32 v213, v213
    v_mfma_f32_16x16x32_bf16 v[208:211], a[216:219], v[72:75], v[208:211]
    v_exp_f32 v214, v214
    v_mfma_f32_16x16x32_bf16 v[208:211], a[220:223], v[76:79], v[208:211]
    v_exp_f32 v215, v215
    v_mfma_f32_16x16x32_bf16 a[0:3], a[160:163], v[128:131], a[0:3]
    ds_read_b64_tr_b16 a[172:173], v21 offset:8192
    v_cvt_pk_bf16_f32 v158, v212, v213
    v_mfma_f32_16x16x32_bf16 a[0:3], a[164:167], v[132:135], a[0:3]
    ds_read_b64_tr_b16 a[174:175], v21 offset:12288
    v_mfma_f32_16x16x32_bf16 a[4:7], a[164:167], v[140:143], a[4:7]
    ds_read_b128 a[228:231], v9 offset:20480
    v_cvt_pk_bf16_f32 v159, v214, v215
    v_mfma_f32_16x16x32_bf16 a[4:7], a[160:163], v[136:139], a[4:7]
    v_mfma_f32_16x16x32_bf16 v[212:215], a[208:211], v[80:83], v[196:199]
    v_exp_f32 v208, v208
    v_mfma_f32_16x16x32_bf16 v[212:215], a[212:215], v[84:87], v[212:215]
    v_exp_f32 v209, v209
    v_mfma_f32_16x16x32_bf16 v[212:215], a[216:219], v[88:91], v[212:215]
    v_exp_f32 v210, v210
    v_mfma_f32_16x16x32_bf16 v[212:215], a[220:223], v[92:95], v[212:215]
    v_exp_f32 v211, v211
    v_mfma_f32_16x16x32_bf16 a[8:11], a[160:163], v[144:147], a[8:11]
    ds_read_b64_tr_b16 a[176:177], v22 offset:0
    v_cvt_pk_bf16_f32 v160, v208, v209
    v_mfma_f32_16x16x32_bf16 a[8:11], a[164:167], v[148:151], a[8:11]
    ds_read_b64_tr_b16 a[178:179], v22 offset:4096
    v_mfma_f32_16x16x32_bf16 a[12:15], a[164:167], v[156:159], a[12:15]
    ds_read_b128 a[232:235], v10 offset:20480
    v_cvt_pk_bf16_f32 v161, v210, v211
    v_mfma_f32_16x16x32_bf16 a[12:15], a[160:163], v[152:155], a[12:15]
    s_waitcnt lgkmcnt(3)
    buffer_load_dwordx4 v39, s[8:11], s40 offen offset:3072 lds
    v_mfma_f32_16x16x32_bf16 v[208:211], a[208:211], v[96:99], v[200:203]
    v_exp_f32 v212, v212
    v_mfma_f32_16x16x32_bf16 v[208:211], a[212:215], v[100:103], v[208:211]
    s_add_u32 s40, s40, 16384
    v_exp_f32 v213, v213
    v_mfma_f32_16x16x32_bf16 v[208:211], a[216:219], v[104:107], v[208:211]
    s_mov_b32 m0, s6
    v_exp_f32 v214, v214
    v_mfma_f32_16x16x32_bf16 v[208:211], a[220:223], v[108:111], v[208:211]
    v_exp_f32 v215, v215
    v_mfma_f32_16x16x32_bf16 a[16:19], a[168:171], v[128:131], a[16:19]
    ds_read_b64_tr_b16 a[180:181], v22 offset:8192
    v_cvt_pk_bf16_f32 v168, v212, v213
    v_mfma_f32_16x16x32_bf16 a[16:19], a[172:175], v[132:135], a[16:19]
    ds_read_b64_tr_b16 a[182:183], v22 offset:12288
    v_mfma_f32_16x16x32_bf16 a[20:23], a[172:175], v[140:143], a[20:23]
    ds_read_b128 a[236:239], v11 offset:20480
    v_cvt_pk_bf16_f32 v169, v214, v215
    v_mfma_f32_16x16x32_bf16 a[20:23], a[168:171], v[136:139], a[20:23]
    buffer_load_dwordx4 v254, s[32:35], s57 offen  lds
    v_smfmac_f32_16x16x64_bf16 a[192:195], v[52:55], v[128:135], v50
    v_mfma_f32_16x16x32_bf16 v[212:215], a[208:211], v[112:115], v[204:207]
    v_exp_f32 v208, v208
    v_mfma_f32_16x16x32_bf16 v[212:215], a[212:215], v[116:119], v[212:215]
    s_add_u32 m0, s42, 98304
    v_exp_f32 v209, v209
    v_mfma_f32_16x16x32_bf16 v[212:215], a[216:219], v[120:123], v[212:215]
    v_exp_f32 v210, v210
    v_mfma_f32_16x16x32_bf16 v[212:215], a[220:223], v[124:127], v[212:215]
    v_exp_f32 v211, v211
    v_mfma_f32_16x16x32_bf16 a[24:27], a[168:171], v[144:147], a[24:27]
    ds_read_b64_tr_b16 a[184:185], v23 offset:0
    v_cvt_pk_bf16_f32 v176, v208, v209
    v_mfma_f32_16x16x32_bf16 a[24:27], a[172:175], v[148:151], a[24:27]
    ds_read_b64_tr_b16 a[186:187], v23 offset:4096
    v_mfma_f32_16x16x32_bf16 a[28:31], a[172:175], v[156:159], a[28:31]
    ds_read_b128 a[208:211], v8 offset:24576
    v_cvt_pk_bf16_f32 v177, v210, v211
    v_mfma_f32_16x16x32_bf16 a[28:31], a[168:171], v[152:155], a[28:31]
    s_waitcnt lgkmcnt(3)
    buffer_load_dwordx4 v40, s[12:15], s41 offen lds
    v_mfma_f32_16x16x32_bf16 v[208:211], a[224:227], v[64:67], v[192:195]
    v_exp_f32 v212, v212
    v_mfma_f32_16x16x32_bf16 v[208:211], a[228:231], v[68:71], v[208:211]
    s_add_u32 s6, s6, 4096
    v_exp_f32 v213, v213
    v_mfma_f32_16x16x32_bf16 v[208:211], a[232:235], v[72:75], v[208:211]
    s_add_u32 s57, s57, 589824
    v_exp_f32 v214, v214
    v_mfma_f32_16x16x32_bf16 v[208:211], a[236:239], v[76:79], v[208:211]
    v_exp_f32 v215, v215
    v_mfma_f32_16x16x32_bf16 a[32:35], a[176:179], v[128:131], a[32:35]
    ds_read_b64_tr_b16 a[188:189], v23 offset:8192
    v_cvt_pk_bf16_f32 v184, v212, v213
    v_mfma_f32_16x16x32_bf16 a[32:35], a[180:183], v[132:135], a[32:35]
    ds_read_b64_tr_b16 a[190:191], v23 offset:12288
    v_mfma_f32_16x16x32_bf16 a[36:39], a[180:183], v[140:143], a[36:39]
    ds_read_b128 a[212:215], v9 offset:24576
    v_cvt_pk_bf16_f32 v185, v214, v215
    v_mfma_f32_16x16x32_bf16 a[36:39], a[176:179], v[136:139], a[36:39]
    v_smfmac_f32_16x16x64_bf16 a[196:199], v[52:55], v[136:143], v50
    v_mfma_f32_16x16x32_bf16 v[212:215], a[224:227], v[80:83], v[196:199]
    v_exp_f32 v208, v208
    v_mfma_f32_16x16x32_bf16 v[212:215], a[228:231], v[84:87], v[212:215]
    v_exp_f32 v209, v209
    v_mfma_f32_16x16x32_bf16 v[212:215], a[232:235], v[88:91], v[212:215]
    v_exp_f32 v210, v210
    v_mfma_f32_16x16x32_bf16 v[212:215], a[236:239], v[92:95], v[212:215]
    v_exp_f32 v211, v211
    v_mfma_f32_16x16x32_bf16 a[40:43], a[176:179], v[144:147], a[40:43]
    ds_read_b64_tr_b16 a[160:161], v24 offset:0
    v_cvt_pk_bf16_f32 v162, v208, v209
    v_mfma_f32_16x16x32_bf16 a[40:43], a[180:183], v[148:151], a[40:43]
    ds_read_b64_tr_b16 a[162:163], v24 offset:4096
    v_mfma_f32_16x16x32_bf16 a[44:47], a[180:183], v[156:159], a[44:47]
    ds_read_b128 a[216:219], v10 offset:24576
    v_cvt_pk_bf16_f32 v163, v210, v211
    v_mfma_f32_16x16x32_bf16 a[44:47], a[176:179], v[152:155], a[44:47]
    s_waitcnt lgkmcnt(3)
    buffer_load_dwordx4 v41, s[12:15], s41 offen offset:1024 lds
    v_mfma_f32_16x16x32_bf16 v[208:211], a[224:227], v[96:99], v[200:203]
    v_exp_f32 v212, v212
    v_mfma_f32_16x16x32_bf16 v[208:211], a[228:231], v[100:103], v[208:211]
    v_exp_f32 v213, v213
    v_mfma_f32_16x16x32_bf16 v[208:211], a[232:235], v[104:107], v[208:211]
    v_exp_f32 v214, v214
    v_mfma_f32_16x16x32_bf16 v[208:211], a[236:239], v[108:111], v[208:211]
    v_exp_f32 v215, v215
    v_mfma_f32_16x16x32_bf16 a[48:51], a[184:187], v[128:131], a[48:51]
    ds_read_b64_tr_b16 a[164:165], v24 offset:8192
    v_cvt_pk_bf16_f32 v170, v212, v213
    v_mfma_f32_16x16x32_bf16 a[48:51], a[188:191], v[132:135], a[48:51]
    ds_read_b64_tr_b16 a[166:167], v24 offset:12288
    v_mfma_f32_16x16x32_bf16 a[52:55], a[188:191], v[140:143], a[52:55]
    ds_read_b128 a[220:223], v11 offset:24576
    v_cvt_pk_bf16_f32 v171, v214, v215
    v_mfma_f32_16x16x32_bf16 a[52:55], a[184:187], v[136:139], a[52:55]
    v_smfmac_f32_16x16x64_bf16 a[200:203], v[52:55], v[144:151], v50
    v_mfma_f32_16x16x32_bf16 v[212:215], a[224:227], v[112:115], v[204:207]
    v_exp_f32 v208, v208
    v_mfma_f32_16x16x32_bf16 v[212:215], a[228:231], v[116:119], v[212:215]
    v_exp_f32 v209, v209
    v_mfma_f32_16x16x32_bf16 v[212:215], a[232:235], v[120:123], v[212:215]
    v_exp_f32 v210, v210
    v_mfma_f32_16x16x32_bf16 v[212:215], a[236:239], v[124:127], v[212:215]
    v_exp_f32 v211, v211
    v_mfma_f32_16x16x32_bf16 a[56:59], a[184:187], v[144:147], a[56:59]
    ds_read_b64_tr_b16 a[168:169], v25 offset:0
    v_cvt_pk_bf16_f32 v178, v208, v209
    v_mfma_f32_16x16x32_bf16 a[56:59], a[188:191], v[148:151], a[56:59]
    ds_read_b64_tr_b16 a[170:171], v25 offset:4096
    v_mfma_f32_16x16x32_bf16 a[60:63], a[188:191], v[156:159], a[60:63]
    ds_read_b128 a[224:227], v8 offset:28672
    v_cvt_pk_bf16_f32 v179, v210, v211
    v_mfma_f32_16x16x32_bf16 a[60:63], a[184:187], v[152:155], a[60:63]
    s_waitcnt lgkmcnt(3)
    buffer_load_dwordx4 v40, s[12:15], s41 offen offset:2048 lds
    v_mfma_f32_16x16x32_bf16 v[208:211], a[208:211], v[64:67], v[192:195]
    v_exp_f32 v212, v212
    v_mfma_f32_16x16x32_bf16 v[208:211], a[212:215], v[68:71], v[208:211]
    v_exp_f32 v213, v213
    v_mfma_f32_16x16x32_bf16 v[208:211], a[216:219], v[72:75], v[208:211]
    v_exp_f32 v214, v214
    v_mfma_f32_16x16x32_bf16 v[208:211], a[220:223], v[76:79], v[208:211]
    v_exp_f32 v215, v215
    v_mfma_f32_16x16x32_bf16 a[64:67], a[160:163], v[128:131], a[64:67]
    ds_read_b64_tr_b16 a[172:173], v25 offset:8192
    v_cvt_pk_bf16_f32 v186, v212, v213
    v_mfma_f32_16x16x32_bf16 a[64:67], a[164:167], v[132:135], a[64:67]
    ds_read_b64_tr_b16 a[174:175], v25 offset:12288
    v_mfma_f32_16x16x32_bf16 a[68:71], a[164:167], v[140:143], a[68:71]
    ds_read_b128 a[228:231], v9 offset:28672
    v_cvt_pk_bf16_f32 v187, v214, v215
    v_mfma_f32_16x16x32_bf16 a[68:71], a[160:163], v[136:139], a[68:71]
    v_smfmac_f32_16x16x64_bf16 a[204:207], v[52:55], v[152:159], v50
    v_mfma_f32_16x16x32_bf16 v[212:215], a[208:211], v[80:83], v[196:199]
    v_exp_f32 v208, v208
    v_mfma_f32_16x16x32_bf16 v[212:215], a[212:215], v[84:87], v[212:215]
    v_exp_f32 v209, v209
    v_mfma_f32_16x16x32_bf16 v[212:215], a[216:219], v[88:91], v[212:215]
    v_exp_f32 v210, v210
    v_mfma_f32_16x16x32_bf16 v[212:215], a[220:223], v[92:95], v[212:215]
    v_exp_f32 v211, v211
    v_mfma_f32_16x16x32_bf16 a[72:75], a[160:163], v[144:147], a[72:75]
    ds_read_b64_tr_b16 a[176:177], v26 offset:0
    v_cvt_pk_bf16_f32 v164, v208, v209
    v_mfma_f32_16x16x32_bf16 a[72:75], a[164:167], v[148:151], a[72:75]
    ds_read_b64_tr_b16 a[178:179], v26 offset:4096
    v_mfma_f32_16x16x32_bf16 a[76:79], a[164:167], v[156:159], a[76:79]
    ds_read_b128 a[232:235], v10 offset:28672
    v_cvt_pk_bf16_f32 v165, v210, v211
    v_mfma_f32_16x16x32_bf16 a[76:79], a[160:163], v[152:155], a[76:79]
    s_waitcnt lgkmcnt(3)
    buffer_load_dwordx4 v41, s[12:15], s41 offen offset:3072 lds
    v_mfma_f32_16x16x32_bf16 v[208:211], a[208:211], v[96:99], v[200:203]
    v_exp_f32 v212, v212
    v_mfma_f32_16x16x32_bf16 v[208:211], a[212:215], v[100:103], v[208:211]
    s_add_u32 s41, s41, 16384
    v_exp_f32 v213, v213
    v_mfma_f32_16x16x32_bf16 v[208:211], a[216:219], v[104:107], v[208:211]
    v_exp_f32 v214, v214
    v_mfma_f32_16x16x32_bf16 v[208:211], a[220:223], v[108:111], v[208:211]
    v_exp_f32 v215, v215
    v_mfma_f32_16x16x32_bf16 a[80:83], a[168:171], v[128:131], a[80:83]
    ds_read_b64_tr_b16 a[180:181], v26 offset:8192
    v_cvt_pk_bf16_f32 v172, v212, v213
    v_mfma_f32_16x16x32_bf16 a[80:83], a[172:175], v[132:135], a[80:83]
    ds_read_b64_tr_b16 a[182:183], v26 offset:12288
    v_mfma_f32_16x16x32_bf16 a[84:87], a[172:175], v[140:143], a[84:87]
    ds_read_b128 a[236:239], v11 offset:28672
    v_cvt_pk_bf16_f32 v173, v214, v215
    v_mfma_f32_16x16x32_bf16 a[84:87], a[168:171], v[136:139], a[84:87]
    s_waitcnt vmcnt(10)
    s_barrier
    v_mfma_f32_16x16x32_bf16 v[212:215], a[208:211], v[112:115], v[204:207]
    v_exp_f32 v208, v208
    v_mfma_f32_16x16x32_bf16 v[212:215], a[212:215], v[116:119], v[212:215]
    s_add_u32 m0, s42, 0
    v_exp_f32 v209, v209
    v_mfma_f32_16x16x32_bf16 v[212:215], a[216:219], v[120:123], v[212:215]
    v_exp_f32 v210, v210
    v_mfma_f32_16x16x32_bf16 v[212:215], a[220:223], v[124:127], v[212:215]
    v_exp_f32 v211, v211
    v_mfma_f32_16x16x32_bf16 a[88:91], a[168:171], v[144:147], a[88:91]
    ds_read_b64_tr_b16 a[184:185], v27 offset:0
    v_cvt_pk_bf16_f32 v180, v208, v209
    v_mfma_f32_16x16x32_bf16 a[88:91], a[172:175], v[148:151], a[88:91]
    ds_read_b64_tr_b16 a[186:187], v27 offset:4096
    v_mfma_f32_16x16x32_bf16 a[92:95], a[172:175], v[156:159], a[92:95]
    ds_read_b128 a[208:211], v8 offset:32768
    v_cvt_pk_bf16_f32 v181, v210, v211
    v_mfma_f32_16x16x32_bf16 a[92:95], a[168:171], v[152:155], a[92:95]
    s_waitcnt lgkmcnt(3)
    buffer_load_dwordx4 v36, s[8:11], s40 offen lds
    v_mfma_f32_16x16x32_bf16 v[208:211], a[224:227], v[64:67], v[192:195]
    v_exp_f32 v212, v212
    v_mfma_f32_16x16x32_bf16 v[208:211], a[228:231], v[68:71], v[208:211]
    v_exp_f32 v213, v213
    v_mfma_f32_16x16x32_bf16 v[208:211], a[232:235], v[72:75], v[208:211]
    v_exp_f32 v214, v214
    v_mfma_f32_16x16x32_bf16 v[208:211], a[236:239], v[76:79], v[208:211]
    v_exp_f32 v215, v215
    v_mfma_f32_16x16x32_bf16 a[96:99], a[176:179], v[128:131], a[96:99]
    ds_read_b64_tr_b16 a[188:189], v27 offset:8192
    v_cvt_pk_bf16_f32 v188, v212, v213
    v_mfma_f32_16x16x32_bf16 a[96:99], a[180:183], v[132:135], a[96:99]
    ds_read_b64_tr_b16 a[190:191], v27 offset:12288
    v_mfma_f32_16x16x32_bf16 a[100:103], a[180:183], v[140:143], a[100:103]
    ds_read_b128 a[212:215], v9 offset:32768
    v_cvt_pk_bf16_f32 v189, v214, v215
    v_mfma_f32_16x16x32_bf16 a[100:103], a[176:179], v[136:139], a[100:103]
    v_mfma_f32_16x16x32_bf16 v[212:215], a[224:227], v[80:83], v[196:199]
    v_exp_f32 v208, v208
    v_mfma_f32_16x16x32_bf16 v[212:215], a[228:231], v[84:87], v[212:215]
    v_exp_f32 v209, v209
    v_mfma_f32_16x16x32_bf16 v[212:215], a[232:235], v[88:91], v[212:215]
    v_exp_f32 v210, v210
    v_mfma_f32_16x16x32_bf16 v[212:215], a[236:239], v[92:95], v[212:215]
    v_exp_f32 v211, v211
    v_mfma_f32_16x16x32_bf16 a[104:107], a[176:179], v[144:147], a[104:107]
    ds_read_b64_tr_b16 a[160:161], v20 offset:16384
    v_cvt_pk_bf16_f32 v166, v208, v209
    v_mfma_f32_16x16x32_bf16 a[104:107], a[180:183], v[148:151], a[104:107]
    ds_read_b64_tr_b16 a[162:163], v20 offset:20480
    v_mfma_f32_16x16x32_bf16 a[108:111], a[180:183], v[156:159], a[108:111]
    ds_read_b128 a[216:219], v10 offset:32768
    v_cvt_pk_bf16_f32 v167, v210, v211
    v_mfma_f32_16x16x32_bf16 a[108:111], a[176:179], v[152:155], a[108:111]
    s_waitcnt lgkmcnt(3)
    buffer_load_dwordx4 v37, s[8:11], s40 offen offset:1024 lds
    v_mfma_f32_16x16x32_bf16 v[208:211], a[224:227], v[96:99], v[200:203]
    v_exp_f32 v212, v212
    v_mfma_f32_16x16x32_bf16 v[208:211], a[228:231], v[100:103], v[208:211]
    v_exp_f32 v213, v213
    v_mfma_f32_16x16x32_bf16 v[208:211], a[232:235], v[104:107], v[208:211]
    v_exp_f32 v214, v214
    v_mfma_f32_16x16x32_bf16 v[208:211], a[236:239], v[108:111], v[208:211]
    v_exp_f32 v215, v215
    v_mfma_f32_16x16x32_bf16 a[112:115], a[184:187], v[128:131], a[112:115]
    ds_read_b64_tr_b16 a[164:165], v20 offset:24576
    v_cvt_pk_bf16_f32 v174, v212, v213
    v_mfma_f32_16x16x32_bf16 a[112:115], a[188:191], v[132:135], a[112:115]
    ds_read_b64_tr_b16 a[166:167], v20 offset:28672
    v_mfma_f32_16x16x32_bf16 a[116:119], a[188:191], v[140:143], a[116:119]
    ds_read_b128 a[220:223], v11 offset:32768
    v_cvt_pk_bf16_f32 v175, v214, v215
    v_mfma_f32_16x16x32_bf16 a[116:119], a[184:187], v[136:139], a[116:119]
    buffer_load_dwordx4 v[240:243], v7, s[16:19], s44 offen
    v_mfma_f32_16x16x32_bf16 v[212:215], a[224:227], v[112:115], v[204:207]
    v_exp_f32 v208, v208
    v_mfma_f32_16x16x32_bf16 v[212:215], a[228:231], v[116:119], v[212:215]
    v_exp_f32 v209, v209
    v_mfma_f32_16x16x32_bf16 v[212:215], a[232:235], v[120:123], v[212:215]
    v_exp_f32 v210, v210
    v_mfma_f32_16x16x32_bf16 v[212:215], a[236:239], v[124:127], v[212:215]
    s_add_u32 s44, s44, 884736
    v_exp_f32 v211, v211
    v_mfma_f32_16x16x32_bf16 a[120:123], a[184:187], v[144:147], a[120:123]
    ds_read_b64_tr_b16 a[168:169], v21 offset:16384
    v_cvt_pk_bf16_f32 v182, v208, v209
    v_mfma_f32_16x16x32_bf16 a[120:123], a[188:191], v[148:151], a[120:123]
    ds_read_b64_tr_b16 a[170:171], v21 offset:20480
    v_mfma_f32_16x16x32_bf16 a[124:127], a[188:191], v[156:159], a[124:127]
    ds_read_b128 a[224:227], v8 offset:36864
    v_cvt_pk_bf16_f32 v183, v210, v211
    v_mfma_f32_16x16x32_bf16 a[124:127], a[184:187], v[152:155], a[124:127]
    s_waitcnt lgkmcnt(3)
    buffer_load_dwordx4 v38, s[8:11], s40 offen offset:2048 lds
    v_mfma_f32_16x16x32_bf16 v[208:211], a[208:211], v[64:67], v[192:195]
    v_exp_f32 v212, v212
    v_mfma_f32_16x16x32_bf16 v[208:211], a[212:215], v[68:71], v[208:211]
    v_exp_f32 v213, v213
    v_mfma_f32_16x16x32_bf16 v[208:211], a[216:219], v[72:75], v[208:211]
    v_exp_f32 v214, v214
    v_mfma_f32_16x16x32_bf16 v[208:211], a[220:223], v[76:79], v[208:211]
    v_exp_f32 v215, v215
    v_mfma_f32_16x16x32_bf16 a[0:3], a[160:163], v[160:163], a[0:3]
    ds_read_b64_tr_b16 a[172:173], v21 offset:24576
    v_cvt_pk_bf16_f32 v190, v212, v213
    v_mfma_f32_16x16x32_bf16 a[0:3], a[164:167], v[164:167], a[0:3]
Ltour0_4:
    s_cbranch_execz Ltour0_8
    ds_read_b64_tr_b16 a[174:175], v21 offset:28672
    v_mfma_f32_16x16x32_bf16 a[4:7], a[164:167], v[172:175], a[4:7]
    ds_read_b128 a[228:231], v9 offset:36864
    v_cvt_pk_bf16_f32 v191, v214, v215
    v_mfma_f32_16x16x32_bf16 a[4:7], a[160:163], v[168:171], a[4:7]
    v_mfma_f32_16x16x32_bf16 v[212:215], a[208:211], v[80:83], v[196:199]
    v_exp_f32 v208, v208
    v_mfma_f32_16x16x32_bf16 v[212:215], a[212:215], v[84:87], v[212:215]
    v_exp_f32 v209, v209
    v_mfma_f32_16x16x32_bf16 v[212:215], a[216:219], v[88:91], v[212:215]
    v_exp_f32 v210, v210
    v_mfma_f32_16x16x32_bf16 v[212:215], a[220:223], v[92:95], v[212:215]
    v_exp_f32 v211, v211
    v_mfma_f32_16x16x32_bf16 a[8:11], a[160:163], v[176:179], a[8:11]
    ds_read_b64_tr_b16 a[176:177], v22 offset:16384
    v_cvt_pk_bf16_f32 v128, v208, v209
    v_mfma_f32_16x16x32_bf16 a[8:11], a[164:167], v[180:183], a[8:11]
    ds_read_b64_tr_b16 a[178:179], v22 offset:20480
    v_mfma_f32_16x16x32_bf16 a[12:15], a[164:167], v[188:191], a[12:15]
    ds_read_b128 a[232:235], v10 offset:36864
    v_cvt_pk_bf16_f32 v129, v210, v211
    v_mfma_f32_16x16x32_bf16 a[12:15], a[160:163], v[184:187], a[12:15]
    s_waitcnt lgkmcnt(3)
    buffer_load_dwordx4 v39, s[8:11], s40 offen offset:3072 lds
    v_mfma_f32_16x16x32_bf16 v[208:211], a[208:211], v[96:99], v[200:203]
    v_exp_f32 v212, v212
    v_mfma_f32_16x16x32_bf16 v[208:211], a[212:215], v[100:103], v[208:211]
    s_add_u32 s40, s40, 16384
    v_exp_f32 v213, v213
    v_mfma_f32_16x16x32_bf16 v[208:211], a[216:219], v[104:107], v[208:211]
    v_exp_f32 v214, v214
    v_mfma_f32_16x16x32_bf16 v[208:211], a[220:223], v[108:111], v[208:211]
    v_exp_f32 v215, v215
    v_mfma_f32_16x16x32_bf16 a[16:19], a[168:171], v[160:163], a[16:19]
    ds_read_b64_tr_b16 a[180:181], v22 offset:24576
    v_cvt_pk_bf16_f32 v136, v212, v213
    v_mfma_f32_16x16x32_bf16 a[16:19], a[172:175], v[164:167], a[16:19]
    ds_read_b64_tr_b16 a[182:183], v22 offset:28672
    v_mfma_f32_16x16x32_bf16 a[20:23], a[172:175], v[172:175], a[20:23]
    ds_read_b128 a[236:239], v11 offset:36864
    v_cvt_pk_bf16_f32 v137, v214, v215
    v_mfma_f32_16x16x32_bf16 a[20:23], a[168:171], v[168:171], a[20:23]
    v_smfmac_f32_16x16x64_bf16 a[192:195], v[52:55], v[160:167], v50
    v_mfma_f32_16x16x32_bf16 v[212:215], a[208:211], v[112:115], v[204:207]
    v_exp_f32 v208, v208
    v_mfma_f32_16x16x32_bf16 v[212:215], a[212:215], v[116:119], v[212:215]
    s_add_u32 m0, s42, 114688
    v_exp_f32 v209, v209
    v_mfma_f32_16x16x32_bf16 v[212:215], a[216:219], v[120:123], v[212:215]
    v_exp_f32 v210, v210
    v_mfma_f32_16x16x32_bf16 v[212:215], a[220:223], v[124:127], v[212:215]
    v_exp_f32 v211, v211
    v_mfma_f32_16x16x32_bf16 a[24:27], a[168:171], v[176:179], a[24:27]
    ds_read_b64_tr_b16 a[184:185], v23 offset:16384
    v_cvt_pk_bf16_f32 v144, v208, v209
    v_mfma_f32_16x16x32_bf16 a[24:27], a[172:175], v[180:183], a[24:27]
    ds_read_b64_tr_b16 a[186:187], v23 offset:20480
    v_mfma_f32_16x16x32_bf16 a[28:31], a[172:175], v[188:191], a[28:31]
    ds_read_b128 a[208:211], v8 offset:40960
    v_cvt_pk_bf16_f32 v145, v210, v211
    v_mfma_f32_16x16x32_bf16 a[28:31], a[168:171], v[184:187], a[28:31]
    s_waitcnt lgkmcnt(3)
    buffer_load_dwordx4 v40, s[12:15], s41 offen lds
    v_mfma_f32_16x16x32_bf16 v[208:211], a[224:227], v[64:67], v[192:195]
    v_exp_f32 v212, v212
    v_mfma_f32_16x16x32_bf16 v[208:211], a[228:231], v[68:71], v[208:211]
    v_exp_f32 v213, v213
    v_mfma_f32_16x16x32_bf16 v[208:211], a[232:235], v[72:75], v[208:211]
    v_exp_f32 v214, v214
    v_mfma_f32_16x16x32_bf16 v[208:211], a[236:239], v[76:79], v[208:211]
    v_exp_f32 v215, v215
    v_mfma_f32_16x16x32_bf16 a[32:35], a[176:179], v[160:163], a[32:35]
    ds_read_b64_tr_b16 a[188:189], v23 offset:24576
    v_cvt_pk_bf16_f32 v152, v212, v213
    v_mfma_f32_16x16x32_bf16 a[32:35], a[180:183], v[164:167], a[32:35]
    ds_read_b64_tr_b16 a[190:191], v23 offset:28672
    v_mfma_f32_16x16x32_bf16 a[36:39], a[180:183], v[172:175], a[36:39]
    ds_read_b128 a[212:215], v9 offset:40960
    v_cvt_pk_bf16_f32 v153, v214, v215
    v_mfma_f32_16x16x32_bf16 a[36:39], a[176:179], v[168:171], a[36:39]
    v_smfmac_f32_16x16x64_bf16 a[196:199], v[52:55], v[168:175], v50
    v_mfma_f32_16x16x32_bf16 v[212:215], a[224:227], v[80:83], v[196:199]
    v_exp_f32 v208, v208
    v_mfma_f32_16x16x32_bf16 v[212:215], a[228:231], v[84:87], v[212:215]
    v_exp_f32 v209, v209
    v_mfma_f32_16x16x32_bf16 v[212:215], a[232:235], v[88:91], v[212:215]
    v_exp_f32 v210, v210
    v_mfma_f32_16x16x32_bf16 v[212:215], a[236:239], v[92:95], v[212:215]
    v_exp_f32 v211, v211
    v_mfma_f32_16x16x32_bf16 a[40:43], a[176:179], v[176:179], a[40:43]
    ds_read_b64_tr_b16 a[160:161], v24 offset:16384
    v_cvt_pk_bf16_f32 v130, v208, v209
    v_mfma_f32_16x16x32_bf16 a[40:43], a[180:183], v[180:183], a[40:43]
    ds_read_b64_tr_b16 a[162:163], v24 offset:20480
    v_mfma_f32_16x16x32_bf16 a[44:47], a[180:183], v[188:191], a[44:47]
    ds_read_b128 a[216:219], v10 offset:40960
    v_cvt_pk_bf16_f32 v131, v210, v211
    v_mfma_f32_16x16x32_bf16 a[44:47], a[176:179], v[184:187], a[44:47]
    s_waitcnt lgkmcnt(3)
    buffer_load_dwordx4 v41, s[12:15], s41 offen offset:1024 lds
    v_mfma_f32_16x16x32_bf16 v[208:211], a[224:227], v[96:99], v[200:203]
    v_exp_f32 v212, v212
    v_mfma_f32_16x16x32_bf16 v[208:211], a[228:231], v[100:103], v[208:211]
    v_exp_f32 v213, v213
    v_mfma_f32_16x16x32_bf16 v[208:211], a[232:235], v[104:107], v[208:211]
    v_exp_f32 v214, v214
    v_mfma_f32_16x16x32_bf16 v[208:211], a[236:239], v[108:111], v[208:211]
    v_exp_f32 v215, v215
    v_mfma_f32_16x16x32_bf16 a[48:51], a[184:187], v[160:163], a[48:51]
    ds_read_b64_tr_b16 a[164:165], v24 offset:24576
    v_cvt_pk_bf16_f32 v138, v212, v213
    v_mfma_f32_16x16x32_bf16 a[48:51], a[188:191], v[164:167], a[48:51]
    ds_read_b64_tr_b16 a[166:167], v24 offset:28672
    v_mfma_f32_16x16x32_bf16 a[52:55], a[188:191], v[172:175], a[52:55]
    ds_read_b128 a[220:223], v11 offset:40960
    v_cvt_pk_bf16_f32 v139, v214, v215
    v_mfma_f32_16x16x32_bf16 a[52:55], a[184:187], v[168:171], a[52:55]
    v_smfmac_f32_16x16x64_bf16 a[200:203], v[52:55], v[176:183], v50
    v_mfma_f32_16x16x32_bf16 v[212:215], a[224:227], v[112:115], v[204:207]
    v_exp_f32 v208, v208
    v_mfma_f32_16x16x32_bf16 v[212:215], a[228:231], v[116:119], v[212:215]
    v_exp_f32 v209, v209
    v_mfma_f32_16x16x32_bf16 v[212:215], a[232:235], v[120:123], v[212:215]
    v_exp_f32 v210, v210
    v_mfma_f32_16x16x32_bf16 v[212:215], a[236:239], v[124:127], v[212:215]
    v_exp_f32 v211, v211
    v_mfma_f32_16x16x32_bf16 a[56:59], a[184:187], v[176:179], a[56:59]
    ds_read_b64_tr_b16 a[168:169], v25 offset:16384
    v_cvt_pk_bf16_f32 v146, v208, v209
    v_mfma_f32_16x16x32_bf16 a[56:59], a[188:191], v[180:183], a[56:59]
    ds_read_b64_tr_b16 a[170:171], v25 offset:20480
    v_mfma_f32_16x16x32_bf16 a[60:63], a[188:191], v[188:191], a[60:63]
    ds_read_b128 a[224:227], v8 offset:45056
    v_cvt_pk_bf16_f32 v147, v210, v211
    v_mfma_f32_16x16x32_bf16 a[60:63], a[184:187], v[184:187], a[60:63]
    s_waitcnt lgkmcnt(3)
    buffer_load_dwordx4 v40, s[12:15], s41 offen offset:2048 lds
    v_mfma_f32_16x16x32_bf16 v[208:211], a[208:211], v[64:67], v[192:195]
    v_exp_f32 v212, v212
    v_mfma_f32_16x16x32_bf16 v[208:211], a[212:215], v[68:71], v[208:211]
    v_exp_f32 v213, v213
    v_mfma_f32_16x16x32_bf16 v[208:211], a[216:219], v[72:75], v[208:211]
    v_exp_f32 v214, v214
    v_mfma_f32_16x16x32_bf16 v[208:211], a[220:223], v[76:79], v[208:211]
    v_exp_f32 v215, v215
    v_mfma_f32_16x16x32_bf16 a[64:67], a[160:163], v[160:163], a[64:67]
    ds_read_b64_tr_b16 a[172:173], v25 offset:24576
    v_cvt_pk_bf16_f32 v154, v212, v213
    v_mfma_f32_16x16x32_bf16 a[64:67], a[164:167], v[164:167], a[64:67]
    ds_read_b64_tr_b16 a[174:175], v25 offset:28672
    v_mfma_f32_16x16x32_bf16 a[68:71], a[164:167], v[172:175], a[68:71]
    ds_read_b128 a[228:231], v9 offset:45056
    v_cvt_pk_bf16_f32 v155, v214, v215
    v_mfma_f32_16x16x32_bf16 a[68:71], a[160:163], v[168:171], a[68:71]
    v_smfmac_f32_16x16x64_bf16 a[204:207], v[52:55], v[184:191], v50
    v_mfma_f32_16x16x32_bf16 v[212:215], a[208:211], v[80:83], v[196:199]
    v_exp_f32 v208, v208
    v_mfma_f32_16x16x32_bf16 v[212:215], a[212:215], v[84:87], v[212:215]
    v_exp_f32 v209, v209
    v_mfma_f32_16x16x32_bf16 v[212:215], a[216:219], v[88:91], v[212:215]
    v_exp_f32 v210, v210
    v_mfma_f32_16x16x32_bf16 v[212:215], a[220:223], v[92:95], v[212:215]
    v_exp_f32 v211, v211
    v_mfma_f32_16x16x32_bf16 a[72:75], a[160:163], v[176:179], a[72:75]
    ds_read_b64_tr_b16 a[176:177], v26 offset:16384
    v_cvt_pk_bf16_f32 v132, v208, v209
    v_mfma_f32_16x16x32_bf16 a[72:75], a[164:167], v[180:183], a[72:75]
    ds_read_b64_tr_b16 a[178:179], v26 offset:20480
    v_mfma_f32_16x16x32_bf16 a[76:79], a[164:167], v[188:191], a[76:79]
    ds_read_b128 a[232:235], v10 offset:45056
    v_cvt_pk_bf16_f32 v133, v210, v211
    v_mfma_f32_16x16x32_bf16 a[76:79], a[160:163], v[184:187], a[76:79]
    s_waitcnt lgkmcnt(3)
    buffer_load_dwordx4 v41, s[12:15], s41 offen offset:3072 lds
    v_mfma_f32_16x16x32_bf16 v[208:211], a[208:211], v[96:99], v[200:203]
    v_exp_f32 v212, v212
    v_mfma_f32_16x16x32_bf16 v[208:211], a[212:215], v[100:103], v[208:211]
    s_add_u32 s41, s41, 16384
    v_exp_f32 v213, v213
    v_mfma_f32_16x16x32_bf16 v[208:211], a[216:219], v[104:107], v[208:211]
    v_exp_f32 v214, v214
    v_mfma_f32_16x16x32_bf16 v[208:211], a[220:223], v[108:111], v[208:211]
    v_exp_f32 v215, v215
    v_mfma_f32_16x16x32_bf16 a[80:83], a[168:171], v[160:163], a[80:83]
    ds_read_b64_tr_b16 a[180:181], v26 offset:24576
    v_cvt_pk_bf16_f32 v140, v212, v213
    v_mfma_f32_16x16x32_bf16 a[80:83], a[172:175], v[164:167], a[80:83]
    ds_read_b64_tr_b16 a[182:183], v26 offset:28672
    v_mfma_f32_16x16x32_bf16 a[84:87], a[172:175], v[172:175], a[84:87]
    ds_read_b128 a[236:239], v11 offset:45056
    v_cvt_pk_bf16_f32 v141, v214, v215
    v_mfma_f32_16x16x32_bf16 a[84:87], a[168:171], v[168:171], a[84:87]
    s_waitcnt vmcnt(9)
    s_barrier
    v_mfma_f32_16x16x32_bf16 v[212:215], a[208:211], v[112:115], v[204:207]
    v_exp_f32 v208, v208
    v_mfma_f32_16x16x32_bf16 v[212:215], a[212:215], v[116:119], v[212:215]
    s_add_u32 m0, s42, 16384
    v_exp_f32 v209, v209
    v_mfma_f32_16x16x32_bf16 v[212:215], a[216:219], v[120:123], v[212:215]
    v_exp_f32 v210, v210
    v_mfma_f32_16x16x32_bf16 v[212:215], a[220:223], v[124:127], v[212:215]
    v_exp_f32 v211, v211
    v_mfma_f32_16x16x32_bf16 a[88:91], a[168:171], v[176:179], a[88:91]
    ds_read_b64_tr_b16 a[184:185], v27 offset:16384
    v_cvt_pk_bf16_f32 v148, v208, v209
    v_mfma_f32_16x16x32_bf16 a[88:91], a[172:175], v[180:183], a[88:91]
    ds_read_b64_tr_b16 a[186:187], v27 offset:20480
    v_mfma_f32_16x16x32_bf16 a[92:95], a[172:175], v[188:191], a[92:95]
    ds_read_b128 a[208:211], v8 offset:49152
    v_cvt_pk_bf16_f32 v149, v210, v211
    v_mfma_f32_16x16x32_bf16 a[92:95], a[168:171], v[184:187], a[92:95]
    s_waitcnt lgkmcnt(3)
    buffer_load_dwordx4 v36, s[8:11], s40 offen lds
    v_mfma_f32_16x16x32_bf16 v[208:211], a[224:227], v[64:67], v[192:195]
    v_exp_f32 v212, v212
    v_mfma_f32_16x16x32_bf16 v[208:211], a[228:231], v[68:71], v[208:211]
    v_exp_f32 v213, v213
    v_mfma_f32_16x16x32_bf16 v[208:211], a[232:235], v[72:75], v[208:211]
    v_exp_f32 v214, v214
    v_mfma_f32_16x16x32_bf16 v[208:211], a[236:239], v[76:79], v[208:211]
    v_exp_f32 v215, v215
    v_mfma_f32_16x16x32_bf16 a[96:99], a[176:179], v[160:163], a[96:99]
    ds_read_b64_tr_b16 a[188:189], v27 offset:24576
    v_cvt_pk_bf16_f32 v156, v212, v213
    v_mfma_f32_16x16x32_bf16 a[96:99], a[180:183], v[164:167], a[96:99]
    ds_read_b64_tr_b16 a[190:191], v27 offset:28672
    v_mfma_f32_16x16x32_bf16 a[100:103], a[180:183], v[172:175], a[100:103]
    ds_read_b128 a[212:215], v9 offset:49152
    v_cvt_pk_bf16_f32 v157, v214, v215
    v_mfma_f32_16x16x32_bf16 a[100:103], a[176:179], v[168:171], a[100:103]
    buffer_load_dword v218, v57, s[80:83], s39 offen
    v_mfma_f32_16x16x32_bf16 v[212:215], a[224:227], v[80:83], v[196:199]
    v_exp_f32 v208, v208
    v_mfma_f32_16x16x32_bf16 v[212:215], a[228:231], v[84:87], v[212:215]
    v_exp_f32 v209, v209
    v_mfma_f32_16x16x32_bf16 v[212:215], a[232:235], v[88:91], v[212:215]
    v_exp_f32 v210, v210
    v_mfma_f32_16x16x32_bf16 v[212:215], a[236:239], v[92:95], v[212:215]
    v_exp_f32 v211, v211
    v_mfma_f32_16x16x32_bf16 a[104:107], a[176:179], v[176:179], a[104:107]
    ds_read_b64_tr_b16 a[160:161], v20 offset:32768
    v_cvt_pk_bf16_f32 v134, v208, v209
    v_mfma_f32_16x16x32_bf16 a[104:107], a[180:183], v[180:183], a[104:107]
    ds_read_b64_tr_b16 a[162:163], v20 offset:36864
    v_mfma_f32_16x16x32_bf16 a[108:111], a[180:183], v[188:191], a[108:111]
    ds_read_b128 a[216:219], v10 offset:49152
    v_cvt_pk_bf16_f32 v135, v210, v211
    v_mfma_f32_16x16x32_bf16 a[108:111], a[176:179], v[184:187], a[108:111]
    s_waitcnt lgkmcnt(3)
    buffer_load_dwordx4 v37, s[8:11], s40 offen offset:1024 lds
    v_mfma_f32_16x16x32_bf16 v[208:211], a[224:227], v[96:99], v[200:203]
    v_exp_f32 v212, v212
    v_mfma_f32_16x16x32_bf16 v[208:211], a[228:231], v[100:103], v[208:211]
    v_exp_f32 v213, v213
    v_mfma_f32_16x16x32_bf16 v[208:211], a[232:235], v[104:107], v[208:211]
    v_exp_f32 v214, v214
    v_mfma_f32_16x16x32_bf16 v[208:211], a[236:239], v[108:111], v[208:211]
    v_exp_f32 v215, v215
    v_mfma_f32_16x16x32_bf16 a[112:115], a[184:187], v[160:163], a[112:115]
    ds_read_b64_tr_b16 a[164:165], v20 offset:40960
    v_cvt_pk_bf16_f32 v142, v212, v213
    v_mfma_f32_16x16x32_bf16 a[112:115], a[188:191], v[164:167], a[112:115]
    ds_read_b64_tr_b16 a[166:167], v20 offset:45056
    v_mfma_f32_16x16x32_bf16 a[116:119], a[188:191], v[172:175], a[116:119]
    ds_read_b128 a[220:223], v11 offset:49152
    v_cvt_pk_bf16_f32 v143, v214, v215
    v_mfma_f32_16x16x32_bf16 a[116:119], a[184:187], v[168:171], a[116:119]
    buffer_store_dwordx4 v[248:251], v232, s[24:27], s53 offen sc1
    v_mfma_f32_16x16x32_bf16 v[212:215], a[224:227], v[112:115], v[204:207]
    v_exp_f32 v208, v208
    v_mfma_f32_16x16x32_bf16 v[212:215], a[228:231], v[116:119], v[212:215]
    v_exp_f32 v209, v209
    v_mfma_f32_16x16x32_bf16 v[212:215], a[232:235], v[120:123], v[212:215]
    v_exp_f32 v210, v210
    v_mfma_f32_16x16x32_bf16 v[212:215], a[236:239], v[124:127], v[212:215]
    s_add_u32 s53, s53, 656
    v_exp_f32 v211, v211
    v_mfma_f32_16x16x32_bf16 a[120:123], a[184:187], v[176:179], a[120:123]
    ds_read_b64_tr_b16 a[168:169], v21 offset:32768
    v_cvt_pk_bf16_f32 v150, v208, v209
    v_mfma_f32_16x16x32_bf16 a[120:123], a[188:191], v[180:183], a[120:123]
    ds_read_b64_tr_b16 a[170:171], v21 offset:36864
    v_mfma_f32_16x16x32_bf16 a[124:127], a[188:191], v[188:191], a[124:127]
    ds_read_b128 a[224:227], v8 offset:53248
    v_cvt_pk_bf16_f32 v151, v210, v211
    v_mfma_f32_16x16x32_bf16 a[124:127], a[184:187], v[184:187], a[124:127]
    s_waitcnt lgkmcnt(3)
    buffer_load_dwordx4 v38, s[8:11], s40 offen offset:2048 lds
    v_mfma_f32_16x16x32_bf16 v[208:211], a[208:211], v[64:67], v[192:195]
    v_exp_f32 v212, v212
    v_mfma_f32_16x16x32_bf16 v[208:211], a[212:215], v[68:71], v[208:211]
    v_exp_f32 v213, v213
    v_mfma_f32_16x16x32_bf16 v[208:211], a[216:219], v[72:75], v[208:211]
    v_exp_f32 v214, v214
    v_mfma_f32_16x16x32_bf16 v[208:211], a[220:223], v[76:79], v[208:211]
    v_exp_f32 v215, v215
    v_mfma_f32_16x16x32_bf16 a[0:3], a[160:163], v[128:131], a[0:3]
    ds_read_b64_tr_b16 a[172:173], v21 offset:40960
    v_cvt_pk_bf16_f32 v158, v212, v213
    v_mfma_f32_16x16x32_bf16 a[0:3], a[164:167], v[132:135], a[0:3]
    ds_read_b64_tr_b16 a[174:175], v21 offset:45056
    v_mfma_f32_16x16x32_bf16 a[4:7], a[164:167], v[140:143], a[4:7]
    ds_read_b128 a[228:231], v9 offset:53248
    v_cvt_pk_bf16_f32 v159, v214, v215
    v_mfma_f32_16x16x32_bf16 a[4:7], a[160:163], v[136:139], a[4:7]
    v_mfma_f32_16x16x32_bf16 v[212:215], a[208:211], v[80:83], v[196:199]
    v_exp_f32 v208, v208
    v_mfma_f32_16x16x32_bf16 v[212:215], a[212:215], v[84:87], v[212:215]
    v_exp_f32 v209, v209
    v_mfma_f32_16x16x32_bf16 v[212:215], a[216:219], v[88:91], v[212:215]
    v_exp_f32 v210, v210
    v_mfma_f32_16x16x32_bf16 v[212:215], a[220:223], v[92:95], v[212:215]
    v_exp_f32 v211, v211
    v_mfma_f32_16x16x32_bf16 a[8:11], a[160:163], v[144:147], a[8:11]
    ds_read_b64_tr_b16 a[176:177], v22 offset:32768
    v_cvt_pk_bf16_f32 v160, v208, v209
    v_mfma_f32_16x16x32_bf16 a[8:11], a[164:167], v[148:151], a[8:11]
    ds_read_b64_tr_b16 a[178:179], v22 offset:36864
    v_mfma_f32_16x16x32_bf16 a[12:15], a[164:167], v[156:159], a[12:15]
    ds_read_b128 a[232:235], v10 offset:53248
    v_cvt_pk_bf16_f32 v161, v210, v211
    v_mfma_f32_16x16x32_bf16 a[12:15], a[160:163], v[152:155], a[12:15]
    s_waitcnt lgkmcnt(3)
    buffer_load_dwordx4 v39, s[8:11], s40 offen offset:3072 lds
    v_mfma_f32_16x16x32_bf16 v[208:211], a[208:211], v[96:99], v[200:203]
    v_exp_f32 v212, v212
    v_mfma_f32_16x16x32_bf16 v[208:211], a[212:215], v[100:103], v[208:211]
    s_add_u32 s40, s40, 16384
    v_exp_f32 v213, v213
    v_mfma_f32_16x16x32_bf16 v[208:211], a[216:219], v[104:107], v[208:211]
    v_exp_f32 v214, v214
    v_mfma_f32_16x16x32_bf16 v[208:211], a[220:223], v[108:111], v[208:211]
    v_exp_f32 v215, v215
    v_mfma_f32_16x16x32_bf16 a[16:19], a[168:171], v[128:131], a[16:19]
    ds_read_b64_tr_b16 a[180:181], v22 offset:40960
    v_cvt_pk_bf16_f32 v168, v212, v213
    v_mfma_f32_16x16x32_bf16 a[16:19], a[172:175], v[132:135], a[16:19]
    ds_read_b64_tr_b16 a[182:183], v22 offset:45056
    v_mfma_f32_16x16x32_bf16 a[20:23], a[172:175], v[140:143], a[20:23]
    ds_read_b128 a[236:239], v11 offset:53248
    v_cvt_pk_bf16_f32 v169, v214, v215
    v_mfma_f32_16x16x32_bf16 a[20:23], a[168:171], v[136:139], a[20:23]
    v_smfmac_f32_16x16x64_bf16 a[192:195], v[52:55], v[128:135], v50
    v_mfma_f32_16x16x32_bf16 v[212:215], a[208:211], v[112:115], v[204:207]
    v_exp_f32 v208, v208
    v_mfma_f32_16x16x32_bf16 v[212:215], a[212:215], v[116:119], v[212:215]
    s_add_u32 m0, s42, 65536
    v_exp_f32 v209, v209
    v_mfma_f32_16x16x32_bf16 v[212:215], a[216:219], v[120:123], v[212:215]
    v_exp_f32 v210, v210
    v_mfma_f32_16x16x32_bf16 v[212:215], a[220:223], v[124:127], v[212:215]
    v_exp_f32 v211, v211
    v_mfma_f32_16x16x32_bf16 a[24:27], a[168:171], v[144:147], a[24:27]
    ds_read_b64_tr_b16 a[184:185], v23 offset:32768
    v_cvt_pk_bf16_f32 v176, v208, v209
    v_mfma_f32_16x16x32_bf16 a[24:27], a[172:175], v[148:151], a[24:27]
    ds_read_b64_tr_b16 a[186:187], v23 offset:36864
    v_mfma_f32_16x16x32_bf16 a[28:31], a[172:175], v[156:159], a[28:31]
    ds_read_b128 a[208:211], v8 offset:57344
    v_cvt_pk_bf16_f32 v177, v210, v211
    v_mfma_f32_16x16x32_bf16 a[28:31], a[168:171], v[152:155], a[28:31]
    s_waitcnt lgkmcnt(3)
    buffer_load_dwordx4 v40, s[12:15], s41 offen lds
    v_mfma_f32_16x16x32_bf16 v[208:211], a[224:227], v[64:67], v[192:195]
    v_exp_f32 v212, v212
    v_mfma_f32_16x16x32_bf16 v[208:211], a[228:231], v[68:71], v[208:211]
    v_exp_f32 v213, v213
    v_mfma_f32_16x16x32_bf16 v[208:211], a[232:235], v[72:75], v[208:211]
    v_exp_f32 v214, v214
    v_mfma_f32_16x16x32_bf16 v[208:211], a[236:239], v[76:79], v[208:211]
    v_exp_f32 v215, v215
    v_mfma_f32_16x16x32_bf16 a[32:35], a[176:179], v[128:131], a[32:35]
    ds_read_b64_tr_b16 a[188:189], v23 offset:40960
    v_cvt_pk_bf16_f32 v184, v212, v213
    v_mfma_f32_16x16x32_bf16 a[32:35], a[180:183], v[132:135], a[32:35]
    ds_read_b64_tr_b16 a[190:191], v23 offset:45056
    v_mfma_f32_16x16x32_bf16 a[36:39], a[180:183], v[140:143], a[36:39]
    ds_read_b128 a[212:215], v9 offset:57344
    v_cvt_pk_bf16_f32 v185, v214, v215
    v_mfma_f32_16x16x32_bf16 a[36:39], a[176:179], v[136:139], a[36:39]
    v_smfmac_f32_16x16x64_bf16 a[196:199], v[52:55], v[136:143], v50
    v_mfma_f32_16x16x32_bf16 v[212:215], a[224:227], v[80:83], v[196:199]
    v_exp_f32 v208, v208
    v_mfma_f32_16x16x32_bf16 v[212:215], a[228:231], v[84:87], v[212:215]
    v_exp_f32 v209, v209
    v_mfma_f32_16x16x32_bf16 v[212:215], a[232:235], v[88:91], v[212:215]
    v_exp_f32 v210, v210
    v_mfma_f32_16x16x32_bf16 v[212:215], a[236:239], v[92:95], v[212:215]
    v_exp_f32 v211, v211
    v_mfma_f32_16x16x32_bf16 a[40:43], a[176:179], v[144:147], a[40:43]
    ds_read_b64_tr_b16 a[160:161], v24 offset:32768
    v_cvt_pk_bf16_f32 v162, v208, v209
    v_mfma_f32_16x16x32_bf16 a[40:43], a[180:183], v[148:151], a[40:43]
    ds_read_b64_tr_b16 a[162:163], v24 offset:36864
    v_mfma_f32_16x16x32_bf16 a[44:47], a[180:183], v[156:159], a[44:47]
    ds_read_b128 a[216:219], v10 offset:57344
    v_cvt_pk_bf16_f32 v163, v210, v211
    v_mfma_f32_16x16x32_bf16 a[44:47], a[176:179], v[152:155], a[44:47]
    s_waitcnt lgkmcnt(3)
    buffer_load_dwordx4 v41, s[12:15], s41 offen offset:1024 lds
    v_mfma_f32_16x16x32_bf16 v[208:211], a[224:227], v[96:99], v[200:203]
    v_exp_f32 v212, v212
    v_mfma_f32_16x16x32_bf16 v[208:211], a[228:231], v[100:103], v[208:211]
    v_exp_f32 v213, v213
    v_mfma_f32_16x16x32_bf16 v[208:211], a[232:235], v[104:107], v[208:211]
    v_exp_f32 v214, v214
    v_mfma_f32_16x16x32_bf16 v[208:211], a[236:239], v[108:111], v[208:211]
    v_exp_f32 v215, v215
    v_mfma_f32_16x16x32_bf16 a[48:51], a[184:187], v[128:131], a[48:51]
    ds_read_b64_tr_b16 a[164:165], v24 offset:40960
    v_cvt_pk_bf16_f32 v170, v212, v213
    v_mfma_f32_16x16x32_bf16 a[48:51], a[188:191], v[132:135], a[48:51]
    ds_read_b64_tr_b16 a[166:167], v24 offset:45056
    v_mfma_f32_16x16x32_bf16 a[52:55], a[188:191], v[140:143], a[52:55]
    ds_read_b128 a[220:223], v11 offset:57344
    v_cvt_pk_bf16_f32 v171, v214, v215
    v_mfma_f32_16x16x32_bf16 a[52:55], a[184:187], v[136:139], a[52:55]
    v_smfmac_f32_16x16x64_bf16 a[200:203], v[52:55], v[144:151], v50
    v_mfma_f32_16x16x32_bf16 v[212:215], a[224:227], v[112:115], v[204:207]
    v_exp_f32 v208, v208
    v_mfma_f32_16x16x32_bf16 v[212:215], a[228:231], v[116:119], v[212:215]
    v_exp_f32 v209, v209
    v_mfma_f32_16x16x32_bf16 v[212:215], a[232:235], v[120:123], v[212:215]
    v_exp_f32 v210, v210
    v_mfma_f32_16x16x32_bf16 v[212:215], a[236:239], v[124:127], v[212:215]
    v_exp_f32 v211, v211
    v_mfma_f32_16x16x32_bf16 a[56:59], a[184:187], v[144:147], a[56:59]
    ds_read_b64_tr_b16 a[168:169], v25 offset:32768
    v_cvt_pk_bf16_f32 v178, v208, v209
    v_mfma_f32_16x16x32_bf16 a[56:59], a[188:191], v[148:151], a[56:59]
    ds_read_b64_tr_b16 a[170:171], v25 offset:36864
    v_mfma_f32_16x16x32_bf16 a[60:63], a[188:191], v[156:159], a[60:63]
    ds_read_b128 a[224:227], v8 offset:61440
    v_cvt_pk_bf16_f32 v179, v210, v211
    v_mfma_f32_16x16x32_bf16 a[60:63], a[184:187], v[152:155], a[60:63]
    s_waitcnt lgkmcnt(3)
    buffer_load_dwordx4 v40, s[12:15], s41 offen offset:2048 lds
    v_mfma_f32_16x16x32_bf16 v[208:211], a[208:211], v[64:67], v[192:195]
    v_exp_f32 v212, v212
    v_mfma_f32_16x16x32_bf16 v[208:211], a[212:215], v[68:71], v[208:211]
    v_exp_f32 v213, v213
    v_mfma_f32_16x16x32_bf16 v[208:211], a[216:219], v[72:75], v[208:211]
    v_exp_f32 v214, v214
    v_mfma_f32_16x16x32_bf16 v[208:211], a[220:223], v[76:79], v[208:211]
    v_exp_f32 v215, v215
    v_mfma_f32_16x16x32_bf16 a[64:67], a[160:163], v[128:131], a[64:67]
    ds_read_b64_tr_b16 a[172:173], v25 offset:40960
    v_cvt_pk_bf16_f32 v186, v212, v213
    v_mfma_f32_16x16x32_bf16 a[64:67], a[164:167], v[132:135], a[64:67]
    ds_read_b64_tr_b16 a[174:175], v25 offset:45056
    v_mfma_f32_16x16x32_bf16 a[68:71], a[164:167], v[140:143], a[68:71]
    ds_read_b128 a[228:231], v9 offset:61440
    v_cvt_pk_bf16_f32 v187, v214, v215
    v_mfma_f32_16x16x32_bf16 a[68:71], a[160:163], v[136:139], a[68:71]
    v_smfmac_f32_16x16x64_bf16 a[204:207], v[52:55], v[152:159], v50
    v_mfma_f32_16x16x32_bf16 v[212:215], a[208:211], v[80:83], v[196:199]
    v_exp_f32 v208, v208
    v_mfma_f32_16x16x32_bf16 v[212:215], a[212:215], v[84:87], v[212:215]
    v_exp_f32 v209, v209
    v_mfma_f32_16x16x32_bf16 v[212:215], a[216:219], v[88:91], v[212:215]
    v_exp_f32 v210, v210
    v_mfma_f32_16x16x32_bf16 v[212:215], a[220:223], v[92:95], v[212:215]
    v_exp_f32 v211, v211
    v_mfma_f32_16x16x32_bf16 a[72:75], a[160:163], v[144:147], a[72:75]
    ds_read_b64_tr_b16 a[176:177], v26 offset:32768
    v_cvt_pk_bf16_f32 v164, v208, v209
    v_mfma_f32_16x16x32_bf16 a[72:75], a[164:167], v[148:151], a[72:75]
    ds_read_b64_tr_b16 a[178:179], v26 offset:36864
    v_mfma_f32_16x16x32_bf16 a[76:79], a[164:167], v[156:159], a[76:79]
    ds_read_b128 a[232:235], v10 offset:61440
    v_cvt_pk_bf16_f32 v165, v210, v211
    v_mfma_f32_16x16x32_bf16 a[76:79], a[160:163], v[152:155], a[76:79]
    s_waitcnt lgkmcnt(3)
    buffer_load_dwordx4 v41, s[12:15], s41 offen offset:3072 lds
    v_mfma_f32_16x16x32_bf16 v[208:211], a[208:211], v[96:99], v[200:203]
    v_exp_f32 v212, v212
    v_mfma_f32_16x16x32_bf16 v[208:211], a[212:215], v[100:103], v[208:211]
    s_add_u32 s41, s41, 16384
    v_exp_f32 v213, v213
    v_mfma_f32_16x16x32_bf16 v[208:211], a[216:219], v[104:107], v[208:211]
    v_exp_f32 v214, v214
    v_mfma_f32_16x16x32_bf16 v[208:211], a[220:223], v[108:111], v[208:211]
    v_exp_f32 v215, v215
    v_mfma_f32_16x16x32_bf16 a[80:83], a[168:171], v[128:131], a[80:83]
    ds_read_b64_tr_b16 a[180:181], v26 offset:40960
    v_cvt_pk_bf16_f32 v172, v212, v213
    v_mfma_f32_16x16x32_bf16 a[80:83], a[172:175], v[132:135], a[80:83]
    ds_read_b64_tr_b16 a[182:183], v26 offset:45056
    v_mfma_f32_16x16x32_bf16 a[84:87], a[172:175], v[140:143], a[84:87]
    ds_read_b128 a[236:239], v11 offset:61440
    v_cvt_pk_bf16_f32 v173, v214, v215
    v_mfma_f32_16x16x32_bf16 a[84:87], a[168:171], v[136:139], a[84:87]
    s_waitcnt vmcnt(10)
    s_barrier
    v_mfma_f32_16x16x32_bf16 v[212:215], a[208:211], v[112:115], v[204:207]
    v_exp_f32 v208, v208
    v_mfma_f32_16x16x32_bf16 v[212:215], a[212:215], v[116:119], v[212:215]
    s_add_u32 m0, s42, 32768
    v_exp_f32 v209, v209
    v_mfma_f32_16x16x32_bf16 v[212:215], a[216:219], v[120:123], v[212:215]
    v_exp_f32 v210, v210
    v_mfma_f32_16x16x32_bf16 v[212:215], a[220:223], v[124:127], v[212:215]
    v_exp_f32 v211, v211
    v_mfma_f32_16x16x32_bf16 a[88:91], a[168:171], v[144:147], a[88:91]
    ds_read_b64_tr_b16 a[184:185], v27 offset:32768
    v_cvt_pk_bf16_f32 v180, v208, v209
    v_mfma_f32_16x16x32_bf16 a[88:91], a[172:175], v[148:151], a[88:91]
    ds_read_b64_tr_b16 a[186:187], v27 offset:36864
    v_mfma_f32_16x16x32_bf16 a[92:95], a[172:175], v[156:159], a[92:95]
    ds_read_b128 a[208:211], v8 offset:0
    v_cvt_pk_bf16_f32 v181, v210, v211
    v_mfma_f32_16x16x32_bf16 a[92:95], a[168:171], v[152:155], a[92:95]
    s_waitcnt lgkmcnt(3)
    buffer_load_dwordx4 v36, s[8:11], s40 offen lds
    v_mfma_f32_16x16x32_bf16 v[208:211], a[224:227], v[64:67], v[192:195]
    v_exp_f32 v212, v212
    v_mfma_f32_16x16x32_bf16 v[208:211], a[228:231], v[68:71], v[208:211]
    v_exp_f32 v213, v213
    v_mfma_f32_16x16x32_bf16 v[208:211], a[232:235], v[72:75], v[208:211]
    v_exp_f32 v214, v214
    v_mfma_f32_16x16x32_bf16 v[208:211], a[236:239], v[76:79], v[208:211]
    v_exp_f32 v215, v215
    v_mfma_f32_16x16x32_bf16 a[96:99], a[176:179], v[128:131], a[96:99]
    ds_read_b64_tr_b16 a[188:189], v27 offset:40960
    v_cvt_pk_bf16_f32 v188, v212, v213
    v_mfma_f32_16x16x32_bf16 a[96:99], a[180:183], v[132:135], a[96:99]
    ds_read_b64_tr_b16 a[190:191], v27 offset:45056
    v_mfma_f32_16x16x32_bf16 a[100:103], a[180:183], v[140:143], a[100:103]
    ds_read_b128 a[212:215], v9 offset:0
    v_cvt_pk_bf16_f32 v189, v214, v215
    v_mfma_f32_16x16x32_bf16 a[100:103], a[176:179], v[136:139], a[100:103]
    buffer_load_dword v219, v62, s[84:87], s38 offen
    v_mfma_f32_16x16x32_bf16 v[212:215], a[224:227], v[80:83], v[196:199]
    v_exp_f32 v208, v208
    v_mfma_f32_16x16x32_bf16 v[212:215], a[228:231], v[84:87], v[212:215]
    v_exp_f32 v209, v209
    v_mfma_f32_16x16x32_bf16 v[212:215], a[232:235], v[88:91], v[212:215]
    v_exp_f32 v210, v210
    v_mfma_f32_16x16x32_bf16 v[212:215], a[236:239], v[92:95], v[212:215]
    v_exp_f32 v211, v211
    v_mfma_f32_16x16x32_bf16 a[104:107], a[176:179], v[144:147], a[104:107]
    ds_read_b64_tr_b16 a[160:161], v20 offset:49152
    v_cvt_pk_bf16_f32 v166, v208, v209
    v_mfma_f32_16x16x32_bf16 a[104:107], a[180:183], v[148:151], a[104:107]
    ds_read_b64_tr_b16 a[162:163], v20 offset:53248
    v_mfma_f32_16x16x32_bf16 a[108:111], a[180:183], v[156:159], a[108:111]
    ds_read_b128 a[216:219], v10 offset:0
    v_cvt_pk_bf16_f32 v167, v210, v211
    v_mfma_f32_16x16x32_bf16 a[108:111], a[176:179], v[152:155], a[108:111]
    s_waitcnt lgkmcnt(3)
    buffer_load_dwordx4 v37, s[8:11], s40 offen offset:1024 lds
    v_mfma_f32_16x16x32_bf16 v[208:211], a[224:227], v[96:99], v[200:203]
    v_exp_f32 v212, v212
    v_mfma_f32_16x16x32_bf16 v[208:211], a[228:231], v[100:103], v[208:211]
    v_exp_f32 v213, v213
    v_mfma_f32_16x16x32_bf16 v[208:211], a[232:235], v[104:107], v[208:211]
    v_exp_f32 v214, v214
    v_mfma_f32_16x16x32_bf16 v[208:211], a[236:239], v[108:111], v[208:211]
    v_exp_f32 v215, v215
    v_mfma_f32_16x16x32_bf16 a[112:115], a[184:187], v[128:131], a[112:115]
    ds_read_b64_tr_b16 a[164:165], v20 offset:57344
    v_cvt_pk_bf16_f32 v174, v212, v213
    v_mfma_f32_16x16x32_bf16 a[112:115], a[188:191], v[132:135], a[112:115]
    ds_read_b64_tr_b16 a[166:167], v20 offset:61440
    v_mfma_f32_16x16x32_bf16 a[116:119], a[188:191], v[140:143], a[116:119]
    ds_read_b128 a[220:223], v11 offset:0
    v_cvt_pk_bf16_f32 v175, v214, v215
    v_mfma_f32_16x16x32_bf16 a[116:119], a[184:187], v[136:139], a[116:119]
    buffer_load_dword v221, v235, s[20:23], 0 offen
    v_mfma_f32_16x16x32_bf16 v[212:215], a[224:227], v[112:115], v[204:207]
    v_exp_f32 v208, v208
    v_mfma_f32_16x16x32_bf16 v[212:215], a[228:231], v[116:119], v[212:215]
    v_exp_f32 v209, v209
    v_mfma_f32_16x16x32_bf16 v[212:215], a[232:235], v[120:123], v[212:215]
    v_exp_f32 v210, v210
    v_mfma_f32_16x16x32_bf16 v[212:215], a[236:239], v[124:127], v[212:215]
    v_exp_f32 v211, v211
    v_mfma_f32_16x16x32_bf16 a[120:123], a[184:187], v[144:147], a[120:123]
    ds_read_b64_tr_b16 a[168:169], v21 offset:49152
    v_cvt_pk_bf16_f32 v182, v208, v209
    v_mfma_f32_16x16x32_bf16 a[120:123], a[188:191], v[148:151], a[120:123]
Ltour0_5:
    s_cbranch_execz Ltour0_9
    ds_read_b64_tr_b16 a[170:171], v21 offset:53248
    v_add_u32 v235, 2560, v235
    v_mfma_f32_16x16x32_bf16 a[124:127], a[188:191], v[156:159], a[124:127]
    ds_read_b128 a[224:227], v8 offset:4096
    v_cvt_pk_bf16_f32 v183, v210, v211
    v_mfma_f32_16x16x32_bf16 a[124:127], a[184:187], v[152:155], a[124:127]
    s_waitcnt lgkmcnt(3)
    buffer_load_dwordx4 v38, s[8:11], s40 offen offset:2048 lds
    v_mfma_f32_16x16x32_bf16 v[208:211], a[208:211], v[64:67], v[192:195]
    v_exp_f32 v212, v212
    v_mfma_f32_16x16x32_bf16 v[208:211], a[212:215], v[68:71], v[208:211]
    v_exp_f32 v213, v213
    v_mfma_f32_16x16x32_bf16 v[208:211], a[216:219], v[72:75], v[208:211]
    v_exp_f32 v214, v214
    v_mfma_f32_16x16x32_bf16 v[208:211], a[220:223], v[76:79], v[208:211]
    v_exp_f32 v215, v215
    v_mfma_f32_16x16x32_bf16 a[0:3], a[160:163], v[160:163], a[0:3]
    ds_read_b64_tr_b16 a[172:173], v21 offset:57344
    v_cvt_pk_bf16_f32 v190, v212, v213
    v_mfma_f32_16x16x32_bf16 a[0:3], a[164:167], v[164:167], a[0:3]
    ds_read_b64_tr_b16 a[174:175], v21 offset:61440
    v_lshlrev_b32 v244, 16, v240
    v_mfma_f32_16x16x32_bf16 a[4:7], a[164:167], v[172:175], a[4:7]
    ds_read_b128 a[228:231], v9 offset:4096
    v_cvt_pk_bf16_f32 v191, v214, v215
    v_mfma_f32_16x16x32_bf16 a[4:7], a[160:163], v[168:171], a[4:7]
    v_and_b32 v245, 0xffff0000, v240
    v_fmac_f32 v224, v2, v244
    v_mfma_f32_16x16x32_bf16 v[212:215], a[208:211], v[80:83], v[196:199]
    v_exp_f32 v208, v208
    v_mfma_f32_16x16x32_bf16 v[212:215], a[212:215], v[84:87], v[212:215]
    v_exp_f32 v209, v209
    v_mfma_f32_16x16x32_bf16 v[212:215], a[216:219], v[88:91], v[212:215]
    v_exp_f32 v210, v210
    v_mfma_f32_16x16x32_bf16 v[212:215], a[220:223], v[92:95], v[212:215]
    v_exp_f32 v211, v211
    v_mfma_f32_16x16x32_bf16 a[8:11], a[160:163], v[176:179], a[8:11]
    ds_read_b64_tr_b16 a[176:177], v22 offset:49152
    v_cvt_pk_bf16_f32 v128, v208, v209
    v_mfma_f32_16x16x32_bf16 a[8:11], a[164:167], v[180:183], a[8:11]
    ds_read_b64_tr_b16 a[178:179], v22 offset:53248
    v_fmac_f32 v225, v2, v245
    v_mfma_f32_16x16x32_bf16 a[12:15], a[164:167], v[188:191], a[12:15]
    ds_read_b128 a[232:235], v10 offset:4096
    v_cvt_pk_bf16_f32 v129, v210, v211
    v_mfma_f32_16x16x32_bf16 a[12:15], a[160:163], v[184:187], a[12:15]
    s_waitcnt lgkmcnt(3)
    buffer_load_dwordx4 v39, s[8:11], s40 offen offset:3072 lds
    v_mfma_f32_16x16x32_bf16 v[208:211], a[208:211], v[96:99], v[200:203]
    v_exp_f32 v212, v212
    v_mfma_f32_16x16x32_bf16 v[208:211], a[212:215], v[100:103], v[208:211]
    s_add_u32 s40, s40, 16384
    v_exp_f32 v213, v213
    v_mfma_f32_16x16x32_bf16 v[208:211], a[216:219], v[104:107], v[208:211]
    v_exp_f32 v214, v214
    v_mfma_f32_16x16x32_bf16 v[208:211], a[220:223], v[108:111], v[208:211]
    v_exp_f32 v215, v215
    v_mfma_f32_16x16x32_bf16 a[16:19], a[168:171], v[160:163], a[16:19]
    ds_read_b64_tr_b16 a[180:181], v22 offset:57344
    v_cvt_pk_bf16_f32 v136, v212, v213
    v_mfma_f32_16x16x32_bf16 a[16:19], a[172:175], v[164:167], a[16:19]
    ds_read_b64_tr_b16 a[182:183], v22 offset:61440
    v_lshlrev_b32 v246, 16, v241
    v_mfma_f32_16x16x32_bf16 a[20:23], a[172:175], v[172:175], a[20:23]
    ds_read_b128 a[236:239], v11 offset:4096
    v_cvt_pk_bf16_f32 v137, v214, v215
    v_mfma_f32_16x16x32_bf16 a[20:23], a[168:171], v[168:171], a[20:23]
    v_and_b32 v247, 0xffff0000, v241
    v_fmac_f32 v226, v2, v246
    v_smfmac_f32_16x16x64_bf16 a[192:195], v[52:55], v[160:167], v50
    v_mfma_f32_16x16x32_bf16 v[212:215], a[208:211], v[112:115], v[204:207]
    v_exp_f32 v208, v208
    v_mfma_f32_16x16x32_bf16 v[212:215], a[212:215], v[116:119], v[212:215]
    s_add_u32 m0, s42, 81920
    v_exp_f32 v209, v209
    v_mfma_f32_16x16x32_bf16 v[212:215], a[216:219], v[120:123], v[212:215]
    v_exp_f32 v210, v210
    v_mfma_f32_16x16x32_bf16 v[212:215], a[220:223], v[124:127], v[212:215]
    v_exp_f32 v211, v211
    v_mfma_f32_16x16x32_bf16 a[24:27], a[168:171], v[176:179], a[24:27]
    ds_read_b64_tr_b16 a[184:185], v23 offset:49152
    v_cvt_pk_bf16_f32 v144, v208, v209
    v_mfma_f32_16x16x32_bf16 a[24:27], a[172:175], v[180:183], a[24:27]
    ds_read_b64_tr_b16 a[186:187], v23 offset:53248
    v_fmac_f32 v227, v2, v247
    v_mfma_f32_16x16x32_bf16 a[28:31], a[172:175], v[188:191], a[28:31]
    ds_read_b128 a[208:211], v8 offset:8192
    v_cvt_pk_bf16_f32 v145, v210, v211
    v_mfma_f32_16x16x32_bf16 a[28:31], a[168:171], v[184:187], a[28:31]
    s_waitcnt lgkmcnt(3)
    buffer_load_dwordx4 v40, s[12:15], s41 offen lds
    v_mfma_f32_16x16x32_bf16 v[208:211], a[224:227], v[64:67], v[192:195]
    v_exp_f32 v212, v212
    v_mfma_f32_16x16x32_bf16 v[208:211], a[228:231], v[68:71], v[208:211]
    v_exp_f32 v213, v213
    v_mfma_f32_16x16x32_bf16 v[208:211], a[232:235], v[72:75], v[208:211]
    v_exp_f32 v214, v214
    v_mfma_f32_16x16x32_bf16 v[208:211], a[236:239], v[76:79], v[208:211]
    v_exp_f32 v215, v215
    v_mfma_f32_16x16x32_bf16 a[32:35], a[176:179], v[160:163], a[32:35]
    ds_read_b64_tr_b16 a[188:189], v23 offset:57344
    v_cvt_pk_bf16_f32 v152, v212, v213
    v_mfma_f32_16x16x32_bf16 a[32:35], a[180:183], v[164:167], a[32:35]
    ds_read_b64_tr_b16 a[190:191], v23 offset:61440
    v_lshlrev_b32 v244, 16, v242
    v_mfma_f32_16x16x32_bf16 a[36:39], a[180:183], v[172:175], a[36:39]
    ds_read_b128 a[212:215], v9 offset:8192
    v_cvt_pk_bf16_f32 v153, v214, v215
    v_mfma_f32_16x16x32_bf16 a[36:39], a[176:179], v[168:171], a[36:39]
    v_and_b32 v245, 0xffff0000, v242
    v_fmac_f32 v228, v2, v244
    v_smfmac_f32_16x16x64_bf16 a[196:199], v[52:55], v[168:175], v50
    v_mfma_f32_16x16x32_bf16 v[212:215], a[224:227], v[80:83], v[196:199]
    v_exp_f32 v208, v208
    v_mfma_f32_16x16x32_bf16 v[212:215], a[228:231], v[84:87], v[212:215]
    v_exp_f32 v209, v209
    v_mfma_f32_16x16x32_bf16 v[212:215], a[232:235], v[88:91], v[212:215]
    v_exp_f32 v210, v210
    v_mfma_f32_16x16x32_bf16 v[212:215], a[236:239], v[92:95], v[212:215]
    v_exp_f32 v211, v211
    v_mfma_f32_16x16x32_bf16 a[40:43], a[176:179], v[176:179], a[40:43]
    ds_read_b64_tr_b16 a[160:161], v24 offset:49152
    v_cvt_pk_bf16_f32 v130, v208, v209
    v_mfma_f32_16x16x32_bf16 a[40:43], a[180:183], v[180:183], a[40:43]
    ds_read_b64_tr_b16 a[162:163], v24 offset:53248
    v_fmac_f32 v229, v2, v245
    v_mfma_f32_16x16x32_bf16 a[44:47], a[180:183], v[188:191], a[44:47]
    ds_read_b128 a[216:219], v10 offset:8192
    v_cvt_pk_bf16_f32 v131, v210, v211
    v_mfma_f32_16x16x32_bf16 a[44:47], a[176:179], v[184:187], a[44:47]
    s_waitcnt lgkmcnt(3)
    buffer_load_dwordx4 v41, s[12:15], s41 offen offset:1024 lds
    v_mfma_f32_16x16x32_bf16 v[208:211], a[224:227], v[96:99], v[200:203]
    v_exp_f32 v212, v212
    v_mfma_f32_16x16x32_bf16 v[208:211], a[228:231], v[100:103], v[208:211]
    v_exp_f32 v213, v213
    v_mfma_f32_16x16x32_bf16 v[208:211], a[232:235], v[104:107], v[208:211]
    v_exp_f32 v214, v214
    v_mfma_f32_16x16x32_bf16 v[208:211], a[236:239], v[108:111], v[208:211]
    v_exp_f32 v215, v215
    v_mfma_f32_16x16x32_bf16 a[48:51], a[184:187], v[160:163], a[48:51]
    ds_read_b64_tr_b16 a[164:165], v24 offset:57344
    v_cvt_pk_bf16_f32 v138, v212, v213
    v_mfma_f32_16x16x32_bf16 a[48:51], a[188:191], v[164:167], a[48:51]
    ds_read_b64_tr_b16 a[166:167], v24 offset:61440
    v_lshlrev_b32 v246, 16, v243
    v_mfma_f32_16x16x32_bf16 a[52:55], a[188:191], v[172:175], a[52:55]
    ds_read_b128 a[220:223], v11 offset:8192
    v_cvt_pk_bf16_f32 v139, v214, v215
    v_mfma_f32_16x16x32_bf16 a[52:55], a[184:187], v[168:171], a[52:55]
    v_and_b32 v247, 0xffff0000, v243
    v_fmac_f32 v230, v2, v246
    v_smfmac_f32_16x16x64_bf16 a[200:203], v[52:55], v[176:183], v50
    v_mfma_f32_16x16x32_bf16 v[212:215], a[224:227], v[112:115], v[204:207]
    v_exp_f32 v208, v208
    v_mfma_f32_16x16x32_bf16 v[212:215], a[228:231], v[116:119], v[212:215]
    v_exp_f32 v209, v209
    v_mfma_f32_16x16x32_bf16 v[212:215], a[232:235], v[120:123], v[212:215]
    v_exp_f32 v210, v210
    v_mfma_f32_16x16x32_bf16 v[212:215], a[236:239], v[124:127], v[212:215]
    v_exp_f32 v211, v211
    v_mfma_f32_16x16x32_bf16 a[56:59], a[184:187], v[176:179], a[56:59]
    ds_read_b64_tr_b16 a[168:169], v25 offset:49152
    v_cvt_pk_bf16_f32 v146, v208, v209
    v_mfma_f32_16x16x32_bf16 a[56:59], a[188:191], v[180:183], a[56:59]
    ds_read_b64_tr_b16 a[170:171], v25 offset:53248
    v_fmac_f32 v231, v2, v247
    v_mfma_f32_16x16x32_bf16 a[60:63], a[188:191], v[188:191], a[60:63]
    ds_read_b128 a[224:227], v8 offset:12288
    v_cvt_pk_bf16_f32 v147, v210, v211
    v_mfma_f32_16x16x32_bf16 a[60:63], a[184:187], v[184:187], a[60:63]
    s_waitcnt lgkmcnt(3)
    buffer_load_dwordx4 v40, s[12:15], s41 offen offset:2048 lds
    v_mfma_f32_16x16x32_bf16 v[208:211], a[208:211], v[64:67], v[192:195]
    v_exp_f32 v212, v212
    v_mfma_f32_16x16x32_bf16 v[208:211], a[212:215], v[68:71], v[208:211]
    v_exp_f32 v213, v213
    v_mfma_f32_16x16x32_bf16 v[208:211], a[216:219], v[72:75], v[208:211]
    v_exp_f32 v214, v214
    v_mfma_f32_16x16x32_bf16 v[208:211], a[220:223], v[76:79], v[208:211]
    v_exp_f32 v215, v215
    v_mfma_f32_16x16x32_bf16 a[64:67], a[160:163], v[160:163], a[64:67]
    ds_read_b64_tr_b16 a[172:173], v25 offset:57344
    v_cvt_pk_bf16_f32 v154, v212, v213
    v_mfma_f32_16x16x32_bf16 a[64:67], a[164:167], v[164:167], a[64:67]
    ds_read_b64_tr_b16 a[174:175], v25 offset:61440
    v_mov_b32 v2, v3
    v_mfma_f32_16x16x32_bf16 a[68:71], a[164:167], v[172:175], a[68:71]
    ds_read_b128 a[228:231], v9 offset:12288
    v_cvt_pk_bf16_f32 v155, v214, v215
    v_mfma_f32_16x16x32_bf16 a[68:71], a[160:163], v[168:171], a[68:71]
    v_mov_b32 v3, v4
    v_mov_b32 v4, v5
    v_smfmac_f32_16x16x64_bf16 a[204:207], v[52:55], v[184:191], v50
    v_mfma_f32_16x16x32_bf16 v[212:215], a[208:211], v[80:83], v[196:199]
    v_exp_f32 v208, v208
    v_mfma_f32_16x16x32_bf16 v[212:215], a[212:215], v[84:87], v[212:215]
    v_exp_f32 v209, v209
    v_mfma_f32_16x16x32_bf16 v[212:215], a[216:219], v[88:91], v[212:215]
    v_exp_f32 v210, v210
    v_mfma_f32_16x16x32_bf16 v[212:215], a[220:223], v[92:95], v[212:215]
    v_exp_f32 v211, v211
    v_mfma_f32_16x16x32_bf16 a[72:75], a[160:163], v[176:179], a[72:75]
    ds_read_b64_tr_b16 a[176:177], v26 offset:49152
    v_cvt_pk_bf16_f32 v132, v208, v209
    v_mfma_f32_16x16x32_bf16 a[72:75], a[164:167], v[180:183], a[72:75]
    ds_read_b64_tr_b16 a[178:179], v26 offset:53248
    v_mov_b32 v5, v6
    v_mfma_f32_16x16x32_bf16 a[76:79], a[164:167], v[188:191], a[76:79]
    ds_read_b128 a[232:235], v10 offset:12288
    v_cvt_pk_bf16_f32 v133, v210, v211
    v_mfma_f32_16x16x32_bf16 a[76:79], a[160:163], v[184:187], a[76:79]
    s_waitcnt lgkmcnt(3)
    buffer_load_dwordx4 v41, s[12:15], s41 offen offset:3072 lds
    v_mfma_f32_16x16x32_bf16 v[208:211], a[208:211], v[96:99], v[200:203]
    v_exp_f32 v212, v212
    v_mfma_f32_16x16x32_bf16 v[208:211], a[212:215], v[100:103], v[208:211]
    s_add_u32 s41, s41, 16384
    v_exp_f32 v213, v213
    v_mfma_f32_16x16x32_bf16 v[208:211], a[216:219], v[104:107], v[208:211]
    v_exp_f32 v214, v214
    v_mfma_f32_16x16x32_bf16 v[208:211], a[220:223], v[108:111], v[208:211]
    v_exp_f32 v215, v215
    v_mfma_f32_16x16x32_bf16 a[80:83], a[168:171], v[160:163], a[80:83]
    ds_read_b64_tr_b16 a[180:181], v26 offset:57344
    v_cvt_pk_bf16_f32 v140, v212, v213
    v_mfma_f32_16x16x32_bf16 a[80:83], a[172:175], v[164:167], a[80:83]
    ds_read_b64_tr_b16 a[182:183], v26 offset:61440
    v_mfma_f32_16x16x32_bf16 a[84:87], a[172:175], v[172:175], a[84:87]
    ds_read_b128 a[236:239], v11 offset:12288
    v_cvt_pk_bf16_f32 v141, v214, v215
    v_mfma_f32_16x16x32_bf16 a[84:87], a[168:171], v[168:171], a[84:87]
    s_waitcnt vmcnt(10)
    s_barrier
    v_mfma_f32_16x16x32_bf16 v[212:215], a[208:211], v[112:115], v[204:207]
    v_exp_f32 v208, v208
    v_mfma_f32_16x16x32_bf16 v[212:215], a[212:215], v[116:119], v[212:215]
    s_add_u32 m0, s42, 49152
    v_exp_f32 v209, v209
    v_mfma_f32_16x16x32_bf16 v[212:215], a[216:219], v[120:123], v[212:215]
    v_exp_f32 v210, v210
    v_mfma_f32_16x16x32_bf16 v[212:215], a[220:223], v[124:127], v[212:215]
    v_exp_f32 v211, v211
    v_mfma_f32_16x16x32_bf16 a[88:91], a[168:171], v[176:179], a[88:91]
    ds_read_b64_tr_b16 a[184:185], v27 offset:49152
    v_cvt_pk_bf16_f32 v148, v208, v209
    v_mfma_f32_16x16x32_bf16 a[88:91], a[172:175], v[180:183], a[88:91]
    ds_read_b64_tr_b16 a[186:187], v27 offset:53248
    v_mfma_f32_16x16x32_bf16 a[92:95], a[172:175], v[188:191], a[92:95]
    ds_read_b128 a[208:211], v8 offset:16384
    v_cvt_pk_bf16_f32 v149, v210, v211
    v_mfma_f32_16x16x32_bf16 a[92:95], a[168:171], v[184:187], a[92:95]
    s_waitcnt lgkmcnt(3)
    buffer_load_dwordx4 v36, s[8:11], s40 offen lds
    v_mfma_f32_16x16x32_bf16 v[208:211], a[224:227], v[64:67], v[192:195]
    v_exp_f32 v212, v212
    v_mfma_f32_16x16x32_bf16 v[208:211], a[228:231], v[68:71], v[208:211]
    v_exp_f32 v213, v213
    v_mfma_f32_16x16x32_bf16 v[208:211], a[232:235], v[72:75], v[208:211]
    v_exp_f32 v214, v214
    v_mfma_f32_16x16x32_bf16 v[208:211], a[236:239], v[76:79], v[208:211]
    v_exp_f32 v215, v215
    v_mfma_f32_16x16x32_bf16 a[96:99], a[176:179], v[160:163], a[96:99]
    ds_read_b64_tr_b16 a[188:189], v27 offset:57344
    v_cvt_pk_bf16_f32 v156, v212, v213
    v_mfma_f32_16x16x32_bf16 a[96:99], a[180:183], v[164:167], a[96:99]
    ds_read_b64_tr_b16 a[190:191], v27 offset:61440
    v_mfma_f32_16x16x32_bf16 a[100:103], a[180:183], v[172:175], a[100:103]
    ds_read_b128 a[212:215], v9 offset:16384
    v_cvt_pk_bf16_f32 v157, v214, v215
    v_mfma_f32_16x16x32_bf16 a[100:103], a[176:179], v[168:171], a[100:103]
    buffer_load_dword v216, v237, s[28:31], s52 offen
    v_mfma_f32_16x16x32_bf16 v[212:215], a[224:227], v[80:83], v[196:199]
    v_exp_f32 v208, v208
    v_mfma_f32_16x16x32_bf16 v[212:215], a[228:231], v[84:87], v[212:215]
    s_sub_u32 s39, s39, 36864
    v_exp_f32 v209, v209
    v_mfma_f32_16x16x32_bf16 v[212:215], a[232:235], v[88:91], v[212:215]
    s_sub_u32 s38, s38, 4608
    v_exp_f32 v210, v210
    v_mfma_f32_16x16x32_bf16 v[212:215], a[236:239], v[92:95], v[212:215]
    s_add_u32 s52, s52, 2304
    v_exp_f32 v211, v211
    v_mfma_f32_16x16x32_bf16 a[104:107], a[176:179], v[176:179], a[104:107]
    ds_read_b64_tr_b16 a[160:161], v20 offset:0
    v_cvt_pk_bf16_f32 v134, v208, v209
    v_mfma_f32_16x16x32_bf16 a[104:107], a[180:183], v[180:183], a[104:107]
    ds_read_b64_tr_b16 a[162:163], v20 offset:4096
    v_mfma_f32_16x16x32_bf16 a[108:111], a[180:183], v[188:191], a[108:111]
    ds_read_b128 a[216:219], v10 offset:16384
    v_cvt_pk_bf16_f32 v135, v210, v211
    v_mfma_f32_16x16x32_bf16 a[108:111], a[176:179], v[184:187], a[108:111]
    s_waitcnt lgkmcnt(3)
    buffer_load_dwordx4 v37, s[8:11], s40 offen offset:1024 lds
    v_mfma_f32_16x16x32_bf16 v[208:211], a[224:227], v[96:99], v[200:203]
    v_exp_f32 v212, v212
    v_mfma_f32_16x16x32_bf16 v[208:211], a[228:231], v[100:103], v[208:211]
    v_exp_f32 v213, v213
    v_mfma_f32_16x16x32_bf16 v[208:211], a[232:235], v[104:107], v[208:211]
    v_exp_f32 v214, v214
    v_mfma_f32_16x16x32_bf16 v[208:211], a[236:239], v[108:111], v[208:211]
    v_exp_f32 v215, v215
    v_mfma_f32_16x16x32_bf16 a[112:115], a[184:187], v[160:163], a[112:115]
    ds_read_b64_tr_b16 a[164:165], v20 offset:8192
    v_cvt_pk_bf16_f32 v142, v212, v213
    v_mfma_f32_16x16x32_bf16 a[112:115], a[188:191], v[164:167], a[112:115]
    ds_read_b64_tr_b16 a[166:167], v20 offset:12288
    v_mfma_f32_16x16x32_bf16 a[116:119], a[188:191], v[172:175], a[116:119]
    ds_read_b128 a[220:223], v11 offset:16384
    v_cvt_pk_bf16_f32 v143, v214, v215
    v_mfma_f32_16x16x32_bf16 a[116:119], a[184:187], v[168:171], a[116:119]
    v_mfma_f32_16x16x32_bf16 v[212:215], a[224:227], v[112:115], v[204:207]
    v_exp_f32 v208, v208
    v_mfma_f32_16x16x32_bf16 v[212:215], a[228:231], v[116:119], v[212:215]
    v_exp_f32 v209, v209
    v_mfma_f32_16x16x32_bf16 v[212:215], a[232:235], v[120:123], v[212:215]
    v_exp_f32 v210, v210
    v_mfma_f32_16x16x32_bf16 v[212:215], a[236:239], v[124:127], v[212:215]
    v_exp_f32 v211, v211
    v_mfma_f32_16x16x32_bf16 a[120:123], a[184:187], v[176:179], a[120:123]
    ds_read_b64_tr_b16 a[168:169], v21 offset:0
    v_cvt_pk_bf16_f32 v150, v208, v209
    v_mfma_f32_16x16x32_bf16 a[120:123], a[188:191], v[180:183], a[120:123]
    ds_read_b64_tr_b16 a[170:171], v21 offset:4096
    v_mfma_f32_16x16x32_bf16 a[124:127], a[188:191], v[188:191], a[124:127]
    ds_read_b128 a[224:227], v8 offset:20480
    v_cvt_pk_bf16_f32 v151, v210, v211
    v_mfma_f32_16x16x32_bf16 a[124:127], a[184:187], v[184:187], a[124:127]
    s_waitcnt lgkmcnt(3)
    buffer_load_dwordx4 v38, s[8:11], s40 offen offset:2048 lds
    s_sub_u32 s43, s43, 1
    s_cmp_lg_u32 s43, 0
    s_cbranch_scc1 Lattn_loop
    v_mfma_f32_16x16x32_bf16 v[208:211], a[208:211], v[64:67], v[192:195]
    s_lshl_b32 s38, s3, 6
    v_exp_f32 v212, v212
    v_mfma_f32_16x16x32_bf16 v[208:211], a[212:215], v[68:71], v[208:211]
    s_add_u32 s38, s38, 131136
    v_exp_f32 v213, v213
    v_mfma_f32_16x16x32_bf16 v[208:211], a[216:219], v[72:75], v[208:211]
    v_exp_f32 v214, v214
    v_mfma_f32_16x16x32_bf16 v[208:211], a[220:223], v[76:79], v[208:211]
    s_add_u32 s57, s58, 0
    v_exp_f32 v215, v215
    v_mfma_f32_16x16x32_bf16 a[0:3], a[160:163], v[128:131], a[0:3]
    ds_read_b64_tr_b16 a[172:173], v21 offset:8192
    v_cvt_pk_bf16_f32 v158, v212, v213
    v_mfma_f32_16x16x32_bf16 a[0:3], a[164:167], v[132:135], a[0:3]
    ds_read_b64_tr_b16 a[174:175], v21 offset:12288
    v_permlane32_swap_b32 v224, v228
    v_mfma_f32_16x16x32_bf16 a[4:7], a[164:167], v[140:143], a[4:7]
    ds_read_b128 a[228:231], v9 offset:20480
    v_cvt_pk_bf16_f32 v159, v214, v215
    v_mfma_f32_16x16x32_bf16 a[4:7], a[160:163], v[136:139], a[4:7]
    buffer_load_dwordx4 a[128:131], v254, s[80:83], s57 offen
    v_mfma_f32_16x16x32_bf16 v[212:215], a[208:211], v[80:83], v[196:199]
    v_exp_f32 v208, v208
    v_mfma_f32_16x16x32_bf16 v[212:215], a[212:215], v[84:87], v[212:215]
    v_exp_f32 v209, v209
    v_mfma_f32_16x16x32_bf16 v[212:215], a[216:219], v[88:91], v[212:215]
    v_exp_f32 v210, v210
    v_mfma_f32_16x16x32_bf16 v[212:215], a[220:223], v[92:95], v[212:215]
    v_exp_f32 v211, v211
    v_mfma_f32_16x16x32_bf16 a[8:11], a[160:163], v[144:147], a[8:11]
    ds_read_b64_tr_b16 a[176:177], v22 offset:0
    v_cvt_pk_bf16_f32 v160, v208, v209
    v_mfma_f32_16x16x32_bf16 a[8:11], a[164:167], v[148:151], a[8:11]
    ds_read_b64_tr_b16 a[178:179], v22 offset:4096
    v_permlane32_swap_b32 v225, v229
    v_mfma_f32_16x16x32_bf16 a[12:15], a[164:167], v[156:159], a[12:15]
    ds_read_b128 a[232:235], v10 offset:20480
    v_cvt_pk_bf16_f32 v161, v210, v211
    v_mfma_f32_16x16x32_bf16 a[12:15], a[160:163], v[152:155], a[12:15]
    s_waitcnt lgkmcnt(3)
    buffer_load_dwordx4 v39, s[8:11], s40 offen offset:3072 lds
    v_mfma_f32_16x16x32_bf16 v[208:211], a[208:211], v[96:99], v[200:203]
    v_exp_f32 v212, v212
    v_mfma_f32_16x16x32_bf16 v[208:211], a[212:215], v[100:103], v[208:211]
    s_add_u32 s40, s40, 16384
    v_exp_f32 v213, v213
    v_mfma_f32_16x16x32_bf16 v[208:211], a[216:219], v[104:107], v[208:211]
    v_exp_f32 v214, v214
    v_mfma_f32_16x16x32_bf16 v[208:211], a[220:223], v[108:111], v[208:211]
    v_exp_f32 v215, v215
    v_mfma_f32_16x16x32_bf16 a[16:19], a[168:171], v[128:131], a[16:19]
    ds_read_b64_tr_b16 a[180:181], v22 offset:8192
    v_cvt_pk_bf16_f32 v168, v212, v213
    v_mfma_f32_16x16x32_bf16 a[16:19], a[172:175], v[132:135], a[16:19]
    ds_read_b64_tr_b16 a[182:183], v22 offset:12288
    v_permlane32_swap_b32 v226, v230
    v_mfma_f32_16x16x32_bf16 a[20:23], a[172:175], v[140:143], a[20:23]
    ds_read_b128 a[236:239], v11 offset:20480
    v_cvt_pk_bf16_f32 v169, v214, v215
    v_mfma_f32_16x16x32_bf16 a[20:23], a[168:171], v[136:139], a[20:23]
    v_permlane32_swap_b32 v227, v231
    v_add_f32 v224, v224, v228
    v_smfmac_f32_16x16x64_bf16 a[192:195], v[52:55], v[128:135], v50
    v_mfma_f32_16x16x32_bf16 v[212:215], a[208:211], v[112:115], v[204:207]
    v_exp_f32 v208, v208
    v_mfma_f32_16x16x32_bf16 v[212:215], a[212:215], v[116:119], v[212:215]
    s_add_u32 m0, s42, 98304
    v_exp_f32 v209, v209
    v_mfma_f32_16x16x32_bf16 v[212:215], a[216:219], v[120:123], v[212:215]
    v_exp_f32 v210, v210
    v_mfma_f32_16x16x32_bf16 v[212:215], a[220:223], v[124:127], v[212:215]
    v_exp_f32 v211, v211
    v_mfma_f32_16x16x32_bf16 a[24:27], a[168:171], v[144:147], a[24:27]
    ds_read_b64_tr_b16 a[184:185], v23 offset:0
    v_cvt_pk_bf16_f32 v176, v208, v209
    v_mfma_f32_16x16x32_bf16 a[24:27], a[172:175], v[148:151], a[24:27]
    ds_read_b64_tr_b16 a[186:187], v23 offset:4096
    v_add_f32 v225, v225, v229
    v_mfma_f32_16x16x32_bf16 a[28:31], a[172:175], v[156:159], a[28:31]
    ds_read_b128 a[208:211], v8 offset:24576
    v_cvt_pk_bf16_f32 v177, v210, v211
    v_mfma_f32_16x16x32_bf16 a[28:31], a[168:171], v[152:155], a[28:31]
    s_waitcnt lgkmcnt(3)
    buffer_load_dwordx4 v40, s[12:15], s41 offen lds
    v_mfma_f32_16x16x32_bf16 v[208:211], a[224:227], v[64:67], v[192:195]
    v_exp_f32 v212, v212
    v_mfma_f32_16x16x32_bf16 v[208:211], a[228:231], v[68:71], v[208:211]
    v_exp_f32 v213, v213
    v_mfma_f32_16x16x32_bf16 v[208:211], a[232:235], v[72:75], v[208:211]
    v_exp_f32 v214, v214
    v_mfma_f32_16x16x32_bf16 v[208:211], a[236:239], v[76:79], v[208:211]
    s_add_u32 s57, s58, 589824
    v_exp_f32 v215, v215
    v_mfma_f32_16x16x32_bf16 a[32:35], a[176:179], v[128:131], a[32:35]
    ds_read_b64_tr_b16 a[188:189], v23 offset:8192
    v_cvt_pk_bf16_f32 v184, v212, v213
    v_mfma_f32_16x16x32_bf16 a[32:35], a[180:183], v[132:135], a[32:35]
    ds_read_b64_tr_b16 a[190:191], v23 offset:12288
    v_add_f32 v226, v226, v230
    v_mfma_f32_16x16x32_bf16 a[36:39], a[180:183], v[140:143], a[36:39]
    ds_read_b128 a[212:215], v9 offset:24576
    v_cvt_pk_bf16_f32 v185, v214, v215
    v_mfma_f32_16x16x32_bf16 a[36:39], a[176:179], v[136:139], a[36:39]
    buffer_load_dwordx4 a[132:135], v254, s[80:83], s57 offen
    v_smfmac_f32_16x16x64_bf16 a[196:199], v[52:55], v[136:143], v50
    v_mfma_f32_16x16x32_bf16 v[212:215], a[224:227], v[80:83], v[196:199]
    v_exp_f32 v208, v208
    v_mfma_f32_16x16x32_bf16 v[212:215], a[228:231], v[84:87], v[212:215]
    v_exp_f32 v209, v209
    v_mfma_f32_16x16x32_bf16 v[212:215], a[232:235], v[88:91], v[212:215]
    v_exp_f32 v210, v210
    v_mfma_f32_16x16x32_bf16 v[212:215], a[236:239], v[92:95], v[212:215]
    v_exp_f32 v211, v211
    v_mfma_f32_16x16x32_bf16 a[40:43], a[176:179], v[144:147], a[40:43]
    ds_read_b64_tr_b16 a[160:161], v24 offset:0
    v_cvt_pk_bf16_f32 v162, v208, v209
    v_mfma_f32_16x16x32_bf16 a[40:43], a[180:183], v[148:151], a[40:43]
    ds_read_b64_tr_b16 a[162:163], v24 offset:4096
    v_add_f32 v227, v227, v231
    v_mfma_f32_16x16x32_bf16 a[44:47], a[180:183], v[156:159], a[44:47]
    ds_read_b128 a[216:219], v10 offset:24576
    v_cvt_pk_bf16_f32 v163, v210, v211
    v_mfma_f32_16x16x32_bf16 a[44:47], a[176:179], v[152:155], a[44:47]
    s_waitcnt lgkmcnt(3)
    buffer_load_dwordx4 v41, s[12:15], s41 offen offset:1024 lds
    v_mfma_f32_16x16x32_bf16 v[208:211], a[224:227], v[96:99], v[200:203]
    v_exp_f32 v212, v212
    v_mfma_f32_16x16x32_bf16 v[208:211], a[228:231], v[100:103], v[208:211]
    v_exp_f32 v213, v213
    v_mfma_f32_16x16x32_bf16 v[208:211], a[232:235], v[104:107], v[208:211]
    v_exp_f32 v214, v214
    v_mfma_f32_16x16x32_bf16 v[208:211], a[236:239], v[108:111], v[208:211]
    v_exp_f32 v215, v215
    v_mfma_f32_16x16x32_bf16 a[48:51], a[184:187], v[128:131], a[48:51]
    ds_read_b64_tr_b16 a[164:165], v24 offset:8192
    v_cvt_pk_bf16_f32 v170, v212, v213
    v_mfma_f32_16x16x32_bf16 a[48:51], a[188:191], v[132:135], a[48:51]
    ds_read_b64_tr_b16 a[166:167], v24 offset:12288
    v_and_b32 v244, 1, v1
    v_mfma_f32_16x16x32_bf16 a[52:55], a[188:191], v[140:143], a[52:55]
    ds_read_b128 a[220:223], v11 offset:24576
    v_cvt_pk_bf16_f32 v171, v214, v215
    v_mfma_f32_16x16x32_bf16 a[52:55], a[184:187], v[136:139], a[52:55]
    s_waitcnt vmcnt(15)
    buffer_load_dword v221, v236, s[20:23], 0 offen
    v_smfmac_f32_16x16x64_bf16 a[200:203], v[52:55], v[144:151], v50
    v_mfma_f32_16x16x32_bf16 v[212:215], a[224:227], v[112:115], v[204:207]
    v_exp_f32 v208, v208
    v_mfma_f32_16x16x32_bf16 v[212:215], a[228:231], v[116:119], v[212:215]
    v_exp_f32 v209, v209
    v_mfma_f32_16x16x32_bf16 v[212:215], a[232:235], v[120:123], v[212:215]
    v_exp_f32 v210, v210
    v_mfma_f32_16x16x32_bf16 v[212:215], a[236:239], v[124:127], v[212:215]
    v_exp_f32 v211, v211
    v_mfma_f32_16x16x32_bf16 a[56:59], a[184:187], v[144:147], a[56:59]
    ds_read_b64_tr_b16 a[168:169], v25 offset:0
    v_cvt_pk_bf16_f32 v178, v208, v209
    v_mfma_f32_16x16x32_bf16 a[56:59], a[188:191], v[148:151], a[56:59]
    ds_read_b64_tr_b16 a[170:171], v25 offset:4096
    v_permlane16_swap_b32 v224, v226
    v_mfma_f32_16x16x32_bf16 a[60:63], a[188:191], v[156:159], a[60:63]
    ds_read_b128 a[224:227], v8 offset:28672
    v_cvt_pk_bf16_f32 v179, v210, v211
    v_mfma_f32_16x16x32_bf16 a[60:63], a[184:187], v[152:155], a[60:63]
    s_waitcnt lgkmcnt(3)
    buffer_load_dwordx4 v40, s[12:15], s41 offen offset:2048 lds
    v_mfma_f32_16x16x32_bf16 v[208:211], a[208:211], v[64:67], v[192:195]
    v_exp_f32 v212, v212
    v_mfma_f32_16x16x32_bf16 v[208:211], a[212:215], v[68:71], v[208:211]
    v_exp_f32 v213, v213
    v_mfma_f32_16x16x32_bf16 v[208:211], a[216:219], v[72:75], v[208:211]
    v_exp_f32 v214, v214
    v_mfma_f32_16x16x32_bf16 v[208:211], a[220:223], v[76:79], v[208:211]
    s_add_u32 s57, s58, 1179648
    v_exp_f32 v215, v215
    v_mfma_f32_16x16x32_bf16 a[64:67], a[160:163], v[128:131], a[64:67]
    ds_read_b64_tr_b16 a[172:173], v25 offset:8192
    v_cvt_pk_bf16_f32 v186, v212, v213
    v_mfma_f32_16x16x32_bf16 a[64:67], a[164:167], v[132:135], a[64:67]
    ds_read_b64_tr_b16 a[174:175], v25 offset:12288
    v_permlane16_swap_b32 v225, v227
    v_mfma_f32_16x16x32_bf16 a[68:71], a[164:167], v[140:143], a[68:71]
    ds_read_b128 a[228:231], v9 offset:28672
    v_cvt_pk_bf16_f32 v187, v214, v215
    v_mfma_f32_16x16x32_bf16 a[68:71], a[160:163], v[136:139], a[68:71]
    buffer_load_dwordx4 a[136:139], v254, s[80:83], s57 offen
    v_smfmac_f32_16x16x64_bf16 a[204:207], v[52:55], v[152:159], v50
    v_mfma_f32_16x16x32_bf16 v[212:215], a[208:211], v[80:83], v[196:199]
    v_exp_f32 v208, v208
    v_mfma_f32_16x16x32_bf16 v[212:215], a[212:215], v[84:87], v[212:215]
    v_exp_f32 v209, v209
    v_mfma_f32_16x16x32_bf16 v[212:215], a[216:219], v[88:91], v[212:215]
    v_exp_f32 v210, v210
    v_mfma_f32_16x16x32_bf16 v[212:215], a[220:223], v[92:95], v[212:215]
    v_exp_f32 v211, v211
    v_mfma_f32_16x16x32_bf16 a[72:75], a[160:163], v[144:147], a[72:75]
    ds_read_b64_tr_b16 a[176:177], v26 offset:0
    v_cvt_pk_bf16_f32 v164, v208, v209
    v_mfma_f32_16x16x32_bf16 a[72:75], a[164:167], v[148:151], a[72:75]
    ds_read_b64_tr_b16 a[178:179], v26 offset:4096
    v_lshlrev_b32 v244, 5, v244
    v_mfma_f32_16x16x32_bf16 a[76:79], a[164:167], v[156:159], a[76:79]
    ds_read_b128 a[232:235], v10 offset:28672
    v_cvt_pk_bf16_f32 v165, v210, v211
    v_mfma_f32_16x16x32_bf16 a[76:79], a[160:163], v[152:155], a[76:79]
    s_waitcnt lgkmcnt(3)
    buffer_load_dwordx4 v41, s[12:15], s41 offen offset:3072 lds
    v_mfma_f32_16x16x32_bf16 v[208:211], a[208:211], v[96:99], v[200:203]
    v_exp_f32 v212, v212
    v_mfma_f32_16x16x32_bf16 v[208:211], a[212:215], v[100:103], v[208:211]
    s_add_u32 s41, s41, 16384
    v_exp_f32 v213, v213
    v_mfma_f32_16x16x32_bf16 v[208:211], a[216:219], v[104:107], v[208:211]
    v_exp_f32 v214, v214
    v_mfma_f32_16x16x32_bf16 v[208:211], a[220:223], v[108:111], v[208:211]
    v_exp_f32 v215, v215
    v_mfma_f32_16x16x32_bf16 a[80:83], a[168:171], v[128:131], a[80:83]
    ds_read_b64_tr_b16 a[180:181], v26 offset:8192
    v_cvt_pk_bf16_f32 v172, v212, v213
    v_mfma_f32_16x16x32_bf16 a[80:83], a[172:175], v[132:135], a[80:83]
    ds_read_b64_tr_b16 a[182:183], v26 offset:12288
    v_add_f32 v224, v224, v226
    v_mfma_f32_16x16x32_bf16 a[84:87], a[172:175], v[140:143], a[84:87]
    ds_read_b128 a[236:239], v11 offset:28672
    v_cvt_pk_bf16_f32 v173, v214, v215
    v_mfma_f32_16x16x32_bf16 a[84:87], a[168:171], v[136:139], a[84:87]
    s_waitcnt vmcnt(13)
    s_barrier
    v_mfma_f32_16x16x32_bf16 v[212:215], a[208:211], v[112:115], v[204:207]
    v_exp_f32 v208, v208
    v_mfma_f32_16x16x32_bf16 v[212:215], a[212:215], v[116:119], v[212:215]
    s_add_u32 s49, s45, 1024
    v_exp_f32 v209, v209
    v_mfma_f32_16x16x32_bf16 v[212:215], a[216:219], v[120:123], v[212:215]
    s_add_u32 m0, s42, 0
    v_exp_f32 v210, v210
    v_mfma_f32_16x16x32_bf16 v[212:215], a[220:223], v[124:127], v[212:215]
    v_exp_f32 v211, v211
    v_mfma_f32_16x16x32_bf16 a[88:91], a[168:171], v[144:147], a[88:91]
    ds_read_b64_tr_b16 a[184:185], v27 offset:0
    v_cvt_pk_bf16_f32 v180, v208, v209
    v_mfma_f32_16x16x32_bf16 a[88:91], a[172:175], v[148:151], a[88:91]
    ds_read_b64_tr_b16 a[186:187], v27 offset:4096
    v_add_f32 v225, v225, v227
    v_mfma_f32_16x16x32_bf16 a[92:95], a[172:175], v[156:159], a[92:95]
    ds_read_b128 a[208:211], v8 offset:32768
    v_cvt_pk_bf16_f32 v181, v210, v211
    v_mfma_f32_16x16x32_bf16 a[92:95], a[168:171], v[152:155], a[92:95]
    s_waitcnt lgkmcnt(3)
    buffer_load_dwordx4 v46, s[20:23], s49 offen lds
    v_mfma_f32_16x16x32_bf16 v[208:211], a[224:227], v[64:67], v[192:195]
    v_exp_f32 v212, v212
    v_mfma_f32_16x16x32_bf16 v[208:211], a[228:231], v[68:71], v[208:211]
    v_exp_f32 v213, v213
    v_mfma_f32_16x16x32_bf16 v[208:211], a[232:235], v[72:75], v[208:211]
    v_exp_f32 v214, v214
    v_mfma_f32_16x16x32_bf16 v[208:211], a[236:239], v[76:79], v[208:211]
    s_add_u32 s37, s55, 0
    v_exp_f32 v215, v215
    v_mfma_f32_16x16x32_bf16 a[96:99], a[176:179], v[128:131], a[96:99]
    ds_read_b64_tr_b16 a[188:189], v27 offset:8192
    v_cvt_pk_bf16_f32 v188, v212, v213
    v_mfma_f32_16x16x32_bf16 a[96:99], a[180:183], v[132:135], a[96:99]
    ds_read_b64_tr_b16 a[190:191], v27 offset:12288
    v_lshrrev_b32 v245, 4, v1
    v_mfma_f32_16x16x32_bf16 a[100:103], a[180:183], v[140:143], a[100:103]
Ltour0_6:
    s_cbranch_execz Ltour0_10
    ds_read_b128 a[212:215], v9 offset:32768
    v_cvt_pk_bf16_f32 v189, v214, v215
    v_mfma_f32_16x16x32_bf16 a[100:103], a[176:179], v[136:139], a[100:103]
    buffer_load_dword v239, v238, s[28:31], s37 offen
    v_mfma_f32_16x16x32_bf16 v[212:215], a[224:227], v[80:83], v[196:199]
    v_exp_f32 v208, v208
    v_mfma_f32_16x16x32_bf16 v[212:215], a[228:231], v[84:87], v[212:215]
    v_exp_f32 v209, v209
    v_mfma_f32_16x16x32_bf16 v[212:215], a[232:235], v[88:91], v[212:215]
    v_exp_f32 v210, v210
    v_mfma_f32_16x16x32_bf16 v[212:215], a[236:239], v[92:95], v[212:215]
    v_exp_f32 v211, v211
    v_mfma_f32_16x16x32_bf16 a[104:107], a[176:179], v[144:147], a[104:107]
    ds_read_b64_tr_b16 a[160:161], v20 offset:16384
    v_cvt_pk_bf16_f32 v166, v208, v209
    v_mfma_f32_16x16x32_bf16 a[104:107], a[180:183], v[148:151], a[104:107]
    ds_read_b64_tr_b16 a[162:163], v20 offset:20480
    v_lshl_add_u32 v244, v245, 3, v244
    v_mfma_f32_16x16x32_bf16 a[108:111], a[180:183], v[156:159], a[108:111]
    ds_read_b128 a[216:219], v10 offset:32768
    v_cvt_pk_bf16_f32 v167, v210, v211
    v_mfma_f32_16x16x32_bf16 a[108:111], a[176:179], v[152:155], a[108:111]
    s_waitcnt lgkmcnt(3)
    buffer_load_dwordx4 v47, s[20:23], s49 offen offset:1024 lds
    v_mfma_f32_16x16x32_bf16 v[208:211], a[224:227], v[96:99], v[200:203]
    v_exp_f32 v212, v212
    v_mfma_f32_16x16x32_bf16 v[208:211], a[228:231], v[100:103], v[208:211]
    v_exp_f32 v213, v213
    v_mfma_f32_16x16x32_bf16 v[208:211], a[232:235], v[104:107], v[208:211]
    v_exp_f32 v214, v214
    v_mfma_f32_16x16x32_bf16 v[208:211], a[236:239], v[108:111], v[208:211]
    s_add_u32 s57, s58, 1769472
    v_exp_f32 v215, v215
    v_mfma_f32_16x16x32_bf16 a[112:115], a[184:187], v[128:131], a[112:115]
    ds_read_b64_tr_b16 a[164:165], v20 offset:24576
    v_cvt_pk_bf16_f32 v174, v212, v213
    v_mfma_f32_16x16x32_bf16 a[112:115], a[188:191], v[132:135], a[112:115]
    ds_read_b64_tr_b16 a[166:167], v20 offset:28672
    v_mfma_f32_16x16x32_bf16 a[116:119], a[188:191], v[140:143], a[116:119]
    ds_read_b128 a[220:223], v11 offset:32768
    v_cvt_pk_bf16_f32 v175, v214, v215
    v_mfma_f32_16x16x32_bf16 a[116:119], a[184:187], v[136:139], a[116:119]
    buffer_load_dwordx4 a[140:143], v254, s[80:83], s57 offen
    v_mfma_f32_16x16x32_bf16 v[212:215], a[224:227], v[112:115], v[204:207]
    v_exp_f32 v208, v208
    v_mfma_f32_16x16x32_bf16 v[212:215], a[228:231], v[116:119], v[212:215]
    v_exp_f32 v209, v209
    v_mfma_f32_16x16x32_bf16 v[212:215], a[232:235], v[120:123], v[212:215]
    v_exp_f32 v210, v210
    v_mfma_f32_16x16x32_bf16 v[212:215], a[236:239], v[124:127], v[212:215]
    v_exp_f32 v211, v211
    v_mfma_f32_16x16x32_bf16 a[120:123], a[184:187], v[144:147], a[120:123]
    ds_read_b64_tr_b16 a[168:169], v21 offset:16384
    v_cvt_pk_bf16_f32 v182, v208, v209
    v_mfma_f32_16x16x32_bf16 a[120:123], a[188:191], v[148:151], a[120:123]
    ds_read_b64_tr_b16 a[170:171], v21 offset:20480
    v_mfma_f32_16x16x32_bf16 a[124:127], a[188:191], v[156:159], a[124:127]
    ds_read_b128 a[224:227], v8 offset:36864
    v_cvt_pk_bf16_f32 v183, v210, v211
    v_mfma_f32_16x16x32_bf16 a[124:127], a[184:187], v[152:155], a[124:127]
    s_waitcnt lgkmcnt(3)
    buffer_load_dwordx4 v48, s[20:23], s49 offen offset:2048 lds
    v_mfma_f32_16x16x32_bf16 v[208:211], a[208:211], v[64:67], v[192:195]
    v_exp_f32 v212, v212
    v_mfma_f32_16x16x32_bf16 v[208:211], a[212:215], v[68:71], v[208:211]
    v_exp_f32 v213, v213
    v_mfma_f32_16x16x32_bf16 v[208:211], a[216:219], v[72:75], v[208:211]
    v_exp_f32 v214, v214
    v_mfma_f32_16x16x32_bf16 v[208:211], a[220:223], v[76:79], v[208:211]
    s_add_u32 s57, s58, 2359296
    v_exp_f32 v215, v215
    v_mfma_f32_16x16x32_bf16 a[0:3], a[160:163], v[160:163], a[0:3]
    ds_read_b64_tr_b16 a[172:173], v21 offset:24576
    v_cvt_pk_bf16_f32 v190, v212, v213
    v_mfma_f32_16x16x32_bf16 a[0:3], a[164:167], v[164:167], a[0:3]
    ds_read_b64_tr_b16 a[174:175], v21 offset:28672
    v_mov_b32 v63, 0
    v_mfma_f32_16x16x32_bf16 a[4:7], a[164:167], v[172:175], a[4:7]
    ds_read_b128 a[228:231], v9 offset:36864
    v_cvt_pk_bf16_f32 v191, v214, v215
    v_mfma_f32_16x16x32_bf16 a[4:7], a[160:163], v[168:171], a[4:7]
    buffer_load_dwordx4 a[144:147], v254, s[80:83], s57 offen
    v_mfma_f32_16x16x32_bf16 v[212:215], a[208:211], v[80:83], v[196:199]
    v_exp_f32 v208, v208
    v_mfma_f32_16x16x32_bf16 v[212:215], a[212:215], v[84:87], v[212:215]
    v_exp_f32 v209, v209
    v_mfma_f32_16x16x32_bf16 v[212:215], a[216:219], v[88:91], v[212:215]
    v_exp_f32 v210, v210
    v_mfma_f32_16x16x32_bf16 v[212:215], a[220:223], v[92:95], v[212:215]
    v_exp_f32 v211, v211
    v_mfma_f32_16x16x32_bf16 a[8:11], a[160:163], v[176:179], a[8:11]
    ds_read_b64_tr_b16 a[176:177], v22 offset:16384
    v_cvt_pk_bf16_f32 v128, v208, v209
    v_mfma_f32_16x16x32_bf16 a[8:11], a[164:167], v[180:183], a[8:11]
    ds_read_b64_tr_b16 a[178:179], v22 offset:20480
    v_add_f32_dpp v224, v224, v224 row_ror:2 row_mask:0xf bank_mask:0xf
    v_mfma_f32_16x16x32_bf16 a[12:15], a[164:167], v[188:191], a[12:15]
    ds_read_b128 a[232:235], v10 offset:36864
    v_cvt_pk_bf16_f32 v129, v210, v211
    v_mfma_f32_16x16x32_bf16 a[12:15], a[160:163], v[184:187], a[12:15]
    s_waitcnt lgkmcnt(3)
    buffer_load_dwordx4 v49, s[20:23], s49 offen offset:3072 lds
    v_mfma_f32_16x16x32_bf16 v[208:211], a[208:211], v[96:99], v[200:203]
    s_lshr_b32 s39, s2, 5
    v_exp_f32 v212, v212
    v_mfma_f32_16x16x32_bf16 v[208:211], a[212:215], v[100:103], v[208:211]
    s_lshl_b32 s39, s39, 3
    v_exp_f32 v213, v213
    v_mfma_f32_16x16x32_bf16 v[208:211], a[216:219], v[104:107], v[208:211]
    s_and_b32 s43, s2, 7
    v_exp_f32 v214, v214
    v_mfma_f32_16x16x32_bf16 v[208:211], a[220:223], v[108:111], v[208:211]
    s_add_u32 s39, s39, s43
    v_exp_f32 v215, v215
    v_mfma_f32_16x16x32_bf16 a[16:19], a[168:171], v[160:163], a[16:19]
    ds_read_b64_tr_b16 a[180:181], v22 offset:24576
    v_cvt_pk_bf16_f32 v136, v212, v213
    v_mfma_f32_16x16x32_bf16 a[16:19], a[172:175], v[164:167], a[16:19]
    ds_read_b64_tr_b16 a[182:183], v22 offset:28672
    v_add_f32_dpp v225, v225, v225 row_ror:2 row_mask:0xf bank_mask:0xf
    v_mfma_f32_16x16x32_bf16 a[20:23], a[172:175], v[172:175], a[20:23]
    ds_read_b128 a[236:239], v11 offset:36864
    v_cvt_pk_bf16_f32 v137, v214, v215
    v_mfma_f32_16x16x32_bf16 a[20:23], a[168:171], v[168:171], a[20:23]
    buffer_load_dword v253, v63, s[24:27], s54 offen offset:12 sc1
    v_smfmac_f32_16x16x64_bf16 a[192:195], v[52:55], v[160:167], v50
    v_mfma_f32_16x16x32_bf16 v[212:215], a[208:211], v[112:115], v[204:207]
    s_lshl_b32 s39, s39, 2
    v_exp_f32 v208, v208
    v_mfma_f32_16x16x32_bf16 v[212:215], a[212:215], v[116:119], v[212:215]
    s_add_u32 m0, s42, 114688
    v_exp_f32 v209, v209
    v_mfma_f32_16x16x32_bf16 v[212:215], a[216:219], v[120:123], v[212:215]
    s_bfe_u32 s43, s2, 0x20003
    v_exp_f32 v210, v210
    v_mfma_f32_16x16x32_bf16 v[212:215], a[220:223], v[124:127], v[212:215]
    s_add_u32 s39, s39, s43
    v_exp_f32 v211, v211
    v_mfma_f32_16x16x32_bf16 a[24:27], a[168:171], v[176:179], a[24:27]
    ds_read_b64_tr_b16 a[184:185], v23 offset:16384
    v_cvt_pk_bf16_f32 v144, v208, v209
    v_mfma_f32_16x16x32_bf16 a[24:27], a[172:175], v[180:183], a[24:27]
    ds_read_b64_tr_b16 a[186:187], v23 offset:20480
    v_add_f32_dpp v224, v224, v224 row_ror:4 row_mask:0xf bank_mask:0xf
    v_mfma_f32_16x16x32_bf16 a[28:31], a[172:175], v[188:191], a[28:31]
    ds_read_b128 a[208:211], v8 offset:40960
    v_cvt_pk_bf16_f32 v145, v210, v211
    v_mfma_f32_16x16x32_bf16 a[28:31], a[168:171], v[184:187], a[28:31]
    s_waitcnt lgkmcnt(3)
    buffer_load_dwordx4 v40, s[12:15], s41 offen lds
    v_mfma_f32_16x16x32_bf16 v[208:211], a[224:227], v[64:67], v[192:195]
    s_add_u32 s39, s39, 72
    v_exp_f32 v212, v212
    v_mfma_f32_16x16x32_bf16 v[208:211], a[228:231], v[68:71], v[208:211]
    s_cmp_lt_u32 s39, 216
    s_cselect_b32 s43, 0, 2147483648
    v_exp_f32 v213, v213
    v_mfma_f32_16x16x32_bf16 v[208:211], a[232:235], v[72:75], v[208:211]
    s_or_b32 s43, s43, s48
    v_exp_f32 v214, v214
    v_mfma_f32_16x16x32_bf16 v[208:211], a[236:239], v[76:79], v[208:211]
    s_add_u32 s57, s58, 2949120
    v_exp_f32 v215, v215
    v_mfma_f32_16x16x32_bf16 a[32:35], a[176:179], v[160:163], a[32:35]
    ds_read_b64_tr_b16 a[188:189], v23 offset:24576
    v_cvt_pk_bf16_f32 v152, v212, v213
    v_mfma_f32_16x16x32_bf16 a[32:35], a[180:183], v[164:167], a[32:35]
    ds_read_b64_tr_b16 a[190:191], v23 offset:28672
    v_add_f32_dpp v225, v225, v225 row_ror:4 row_mask:0xf bank_mask:0xf
    v_mfma_f32_16x16x32_bf16 a[36:39], a[180:183], v[172:175], a[36:39]
    ds_read_b128 a[212:215], v9 offset:40960
    v_cvt_pk_bf16_f32 v153, v214, v215
    v_mfma_f32_16x16x32_bf16 a[36:39], a[176:179], v[168:171], a[36:39]
    buffer_load_dwordx4 a[148:151], v254, s[80:83], s57 offen
    v_smfmac_f32_16x16x64_bf16 a[196:199], v[52:55], v[168:175], v50
    v_mfma_f32_16x16x32_bf16 v[212:215], a[224:227], v[80:83], v[196:199]
    s_and_b32 s43, s43, 2147483648
    v_exp_f32 v208, v208
    v_mfma_f32_16x16x32_bf16 v[212:215], a[228:231], v[84:87], v[212:215]
    s_sub_u32 s36, s39, 144
    v_exp_f32 v209, v209
    v_mfma_f32_16x16x32_bf16 v[212:215], a[232:235], v[88:91], v[212:215]
    s_cmp_lt_u32 s36, 36
    s_cselect_b32 s36, 1.0, 0
    v_exp_f32 v210, v210
    v_mfma_f32_16x16x32_bf16 v[212:215], a[236:239], v[92:95], v[212:215]
    s_lshr_b32 s44, s39, 1
    v_exp_f32 v211, v211
    v_mfma_f32_16x16x32_bf16 a[40:43], a[176:179], v[176:179], a[40:43]
    ds_read_b64_tr_b16 a[160:161], v24 offset:16384
    v_cvt_pk_bf16_f32 v130, v208, v209
    v_mfma_f32_16x16x32_bf16 a[40:43], a[180:183], v[180:183], a[40:43]
    ds_read_b64_tr_b16 a[162:163], v24 offset:20480
    v_add_f32_dpp v224, v224, v224 row_ror:8 row_mask:0xf bank_mask:0xf
    v_mfma_f32_16x16x32_bf16 a[44:47], a[180:183], v[188:191], a[44:47]
    ds_read_b128 a[216:219], v10 offset:40960
    v_cvt_pk_bf16_f32 v131, v210, v211
    v_mfma_f32_16x16x32_bf16 a[44:47], a[176:179], v[184:187], a[44:47]
    s_waitcnt lgkmcnt(3)
    buffer_load_dwordx4 v41, s[12:15], s41 offen offset:1024 lds
    v_mfma_f32_16x16x32_bf16 v[208:211], a[224:227], v[96:99], v[200:203]
    s_lshl_b32 s44, s44, 6
    v_exp_f32 v212, v212
    v_mfma_f32_16x16x32_bf16 v[208:211], a[228:231], v[100:103], v[208:211]
    s_and_b32 s39, s39, 1
    v_exp_f32 v213, v213
    v_mfma_f32_16x16x32_bf16 v[208:211], a[232:235], v[104:107], v[208:211]
    s_lshl_b32 s39, s39, 3
    v_exp_f32 v214, v214
    v_mfma_f32_16x16x32_bf16 v[208:211], a[236:239], v[108:111], v[208:211]
    s_add_u32 s39, s39, s44
    v_exp_f32 v215, v215
    v_mfma_f32_16x16x32_bf16 a[48:51], a[184:187], v[160:163], a[48:51]
    ds_read_b64_tr_b16 a[164:165], v24 offset:24576
    v_cvt_pk_bf16_f32 v138, v212, v213
    v_mfma_f32_16x16x32_bf16 a[48:51], a[188:191], v[164:167], a[48:51]
    ds_read_b64_tr_b16 a[166:167], v24 offset:28672
    v_add_f32_dpp v225, v225, v225 row_ror:8 row_mask:0xf bank_mask:0xf
    v_mfma_f32_16x16x32_bf16 a[52:55], a[188:191], v[172:175], a[52:55]
    ds_read_b128 a[220:223], v11 offset:40960
    v_cvt_pk_bf16_f32 v139, v214, v215
    v_mfma_f32_16x16x32_bf16 a[52:55], a[184:187], v[168:171], a[52:55]
    v_add_u32 v244, s38, v244
    v_and_b32 v245, 7, v1
    v_smfmac_f32_16x16x64_bf16 a[200:203], v[52:55], v[176:183], v50
    v_mfma_f32_16x16x32_bf16 v[212:215], a[224:227], v[112:115], v[204:207]
    s_add_u32 s39, s39, 16384
    v_exp_f32 v208, v208
    v_mfma_f32_16x16x32_bf16 v[212:215], a[228:231], v[116:119], v[212:215]
    s_or_b32 s39, s39, s43
    v_exp_f32 v209, v209
    v_mfma_f32_16x16x32_bf16 v[212:215], a[232:235], v[120:123], v[212:215]
    v_exp_f32 v210, v210
    v_mfma_f32_16x16x32_bf16 v[212:215], a[236:239], v[124:127], v[212:215]
    v_exp_f32 v211, v211
    v_mfma_f32_16x16x32_bf16 a[56:59], a[184:187], v[176:179], a[56:59]
    ds_read_b64_tr_b16 a[168:169], v25 offset:16384
    v_cvt_pk_bf16_f32 v146, v208, v209
    v_mfma_f32_16x16x32_bf16 a[56:59], a[188:191], v[180:183], a[56:59]
    ds_read_b64_tr_b16 a[170:171], v25 offset:20480
    v_mfma_f32_16x16x32_bf16 a[60:63], a[188:191], v[188:191], a[60:63]
    ds_read_b128 a[224:227], v8 offset:45056
    v_cvt_pk_bf16_f32 v147, v210, v211
    v_mfma_f32_16x16x32_bf16 a[60:63], a[184:187], v[184:187], a[60:63]
    s_waitcnt lgkmcnt(3)
    buffer_load_dwordx4 v40, s[12:15], s41 offen offset:2048 lds
    v_mfma_f32_16x16x32_bf16 v[208:211], a[208:211], v[64:67], v[192:195]
    v_exp_f32 v212, v212
    v_mfma_f32_16x16x32_bf16 v[208:211], a[212:215], v[68:71], v[208:211]
    v_exp_f32 v213, v213
    v_mfma_f32_16x16x32_bf16 v[208:211], a[216:219], v[72:75], v[208:211]
    v_exp_f32 v214, v214
    v_mfma_f32_16x16x32_bf16 v[208:211], a[220:223], v[76:79], v[208:211]
    s_add_u32 s57, s58, 3538944
    v_exp_f32 v215, v215
    v_mfma_f32_16x16x32_bf16 a[64:67], a[160:163], v[160:163], a[64:67]
    ds_read_b64_tr_b16 a[172:173], v25 offset:24576
    v_cvt_pk_bf16_f32 v154, v212, v213
    v_mfma_f32_16x16x32_bf16 a[64:67], a[164:167], v[164:167], a[64:67]
    ds_read_b64_tr_b16 a[174:175], v25 offset:28672
    v_lshlrev_b32 v245, 3, v245
    v_mfma_f32_16x16x32_bf16 a[68:71], a[164:167], v[172:175], a[68:71]
    ds_read_b128 a[228:231], v9 offset:45056
    v_cvt_pk_bf16_f32 v155, v214, v215
    v_mfma_f32_16x16x32_bf16 a[68:71], a[160:163], v[168:171], a[68:71]
    buffer_load_dwordx4 a[152:155], v254, s[80:83], s57 offen
    v_smfmac_f32_16x16x64_bf16 a[204:207], v[52:55], v[184:191], v50
    ds_write_b64 v244, v[224:225]
    v_mfma_f32_16x16x32_bf16 v[212:215], a[208:211], v[80:83], v[196:199]
    v_exp_f32 v208, v208
    v_mfma_f32_16x16x32_bf16 v[212:215], a[212:215], v[84:87], v[212:215]
    v_exp_f32 v209, v209
    v_mfma_f32_16x16x32_bf16 v[212:215], a[216:219], v[88:91], v[212:215]
    v_exp_f32 v210, v210
    v_mfma_f32_16x16x32_bf16 v[212:215], a[220:223], v[92:95], v[212:215]
    v_exp_f32 v211, v211
    v_mfma_f32_16x16x32_bf16 a[72:75], a[160:163], v[176:179], a[72:75]
    ds_read_b64_tr_b16 a[176:177], v26 offset:16384
    v_cvt_pk_bf16_f32 v132, v208, v209
    v_mfma_f32_16x16x32_bf16 a[72:75], a[164:167], v[180:183], a[72:75]
    ds_read_b64_tr_b16 a[178:179], v26 offset:20480
    v_add_u32 v245, 131136, v245
    v_mfma_f32_16x16x32_bf16 a[76:79], a[164:167], v[188:191], a[76:79]
    ds_read_b128 a[232:235], v10 offset:45056
    v_cvt_pk_bf16_f32 v133, v210, v211
    v_mfma_f32_16x16x32_bf16 a[76:79], a[160:163], v[184:187], a[76:79]
    s_waitcnt lgkmcnt(3)
    buffer_load_dwordx4 v41, s[12:15], s41 offen offset:3072 lds
    v_mfma_f32_16x16x32_bf16 v[208:211], a[208:211], v[96:99], v[200:203]
    v_exp_f32 v212, v212
    v_mfma_f32_16x16x32_bf16 v[208:211], a[212:215], v[100:103], v[208:211]
    s_add_u32 s41, s41, 16384
    v_exp_f32 v213, v213
    v_mfma_f32_16x16x32_bf16 v[208:211], a[216:219], v[104:107], v[208:211]
    v_exp_f32 v214, v214
    v_mfma_f32_16x16x32_bf16 v[208:211], a[220:223], v[108:111], v[208:211]
    v_exp_f32 v215, v215
    v_mfma_f32_16x16x32_bf16 a[80:83], a[168:171], v[160:163], a[80:83]
    ds_read_b64_tr_b16 a[180:181], v26 offset:24576
    v_cvt_pk_bf16_f32 v140, v212, v213
    v_mfma_f32_16x16x32_bf16 a[80:83], a[172:175], v[164:167], a[80:83]
    ds_read_b64_tr_b16 a[182:183], v26 offset:28672
    v_mfma_f32_16x16x32_bf16 a[84:87], a[172:175], v[172:175], a[84:87]
    ds_read_b128 a[236:239], v11 offset:45056
    v_cvt_pk_bf16_f32 v141, v214, v215
    v_mfma_f32_16x16x32_bf16 a[84:87], a[168:171], v[168:171], a[84:87]
    s_waitcnt vmcnt(14)
    s_barrier
    v_mfma_f32_16x16x32_bf16 v[212:215], a[208:211], v[112:115], v[204:207]
    v_exp_f32 v208, v208
    v_mfma_f32_16x16x32_bf16 v[212:215], a[212:215], v[116:119], v[212:215]
    s_add_u32 s49, s45, 74752
    v_exp_f32 v209, v209
    v_mfma_f32_16x16x32_bf16 v[212:215], a[216:219], v[120:123], v[212:215]
    s_add_u32 m0, s42, 16384
    v_exp_f32 v210, v210
    v_mfma_f32_16x16x32_bf16 v[212:215], a[220:223], v[124:127], v[212:215]
    v_exp_f32 v211, v211
    v_mfma_f32_16x16x32_bf16 a[88:91], a[168:171], v[176:179], a[88:91]
    ds_read_b64_tr_b16 a[184:185], v27 offset:16384
    v_cvt_pk_bf16_f32 v148, v208, v209
    v_mfma_f32_16x16x32_bf16 a[88:91], a[172:175], v[180:183], a[88:91]
    ds_read_b64_tr_b16 a[186:187], v27 offset:20480
    ds_read_b64 v[224:225], v245 offset:0
    v_mfma_f32_16x16x32_bf16 a[92:95], a[172:175], v[188:191], a[92:95]
    ds_read_b128 a[208:211], v8 offset:49152
    v_cvt_pk_bf16_f32 v149, v210, v211
    v_mfma_f32_16x16x32_bf16 a[92:95], a[168:171], v[184:187], a[92:95]
    s_waitcnt lgkmcnt(3)
    buffer_load_dwordx4 v46, s[20:23], s49 offen lds
    v_mfma_f32_16x16x32_bf16 v[208:211], a[224:227], v[64:67], v[192:195]
    v_exp_f32 v212, v212
    v_mfma_f32_16x16x32_bf16 v[208:211], a[228:231], v[68:71], v[208:211]
    v_exp_f32 v213, v213
    v_mfma_f32_16x16x32_bf16 v[208:211], a[232:235], v[72:75], v[208:211]
    v_exp_f32 v214, v214
    v_mfma_f32_16x16x32_bf16 v[208:211], a[236:239], v[76:79], v[208:211]
    s_add_u32 s37, s55, 8192
    v_exp_f32 v215, v215
    v_mfma_f32_16x16x32_bf16 a[96:99], a[176:179], v[160:163], a[96:99]
    ds_read_b64_tr_b16 a[188:189], v27 offset:24576
    v_cvt_pk_bf16_f32 v156, v212, v213
    v_mfma_f32_16x16x32_bf16 a[96:99], a[180:183], v[164:167], a[96:99]
    ds_read_b64_tr_b16 a[190:191], v27 offset:28672
    ds_read_b64 v[226:227], v245 offset:64
    v_mfma_f32_16x16x32_bf16 a[100:103], a[180:183], v[172:175], a[100:103]
    ds_read_b128 a[212:215], v9 offset:49152
    v_cvt_pk_bf16_f32 v157, v214, v215
    v_mfma_f32_16x16x32_bf16 a[100:103], a[176:179], v[168:171], a[100:103]
    buffer_load_dword v234, v238, s[28:31], s37 offen
    v_mfma_f32_16x16x32_bf16 v[212:215], a[224:227], v[80:83], v[196:199]
    v_exp_f32 v208, v208
    v_mfma_f32_16x16x32_bf16 v[212:215], a[228:231], v[84:87], v[212:215]
    v_exp_f32 v209, v209
    v_mfma_f32_16x16x32_bf16 v[212:215], a[232:235], v[88:91], v[212:215]
    v_exp_f32 v210, v210
    v_mfma_f32_16x16x32_bf16 v[212:215], a[236:239], v[92:95], v[212:215]
    v_exp_f32 v211, v211
    v_mfma_f32_16x16x32_bf16 a[104:107], a[176:179], v[176:179], a[104:107]
    ds_read_b64_tr_b16 a[160:161], v20 offset:32768
    v_cvt_pk_bf16_f32 v134, v208, v209
    v_mfma_f32_16x16x32_bf16 a[104:107], a[180:183], v[180:183], a[104:107]
    ds_read_b64_tr_b16 a[162:163], v20 offset:36864
    ds_read_b64 v[228:229], v245 offset:128
    v_mfma_f32_16x16x32_bf16 a[108:111], a[180:183], v[188:191], a[108:111]
    ds_read_b128 a[216:219], v10 offset:49152
    v_cvt_pk_bf16_f32 v135, v210, v211
    v_mfma_f32_16x16x32_bf16 a[108:111], a[176:179], v[184:187], a[108:111]
    s_waitcnt lgkmcnt(3)
    buffer_load_dwordx4 v47, s[20:23], s49 offen offset:1024 lds
    v_mfma_f32_16x16x32_bf16 v[208:211], a[224:227], v[96:99], v[200:203]
    v_exp_f32 v212, v212
    v_mfma_f32_16x16x32_bf16 v[208:211], a[228:231], v[100:103], v[208:211]
    v_exp_f32 v213, v213
    v_mfma_f32_16x16x32_bf16 v[208:211], a[232:235], v[104:107], v[208:211]
    v_exp_f32 v214, v214
    v_mfma_f32_16x16x32_bf16 v[208:211], a[236:239], v[108:111], v[208:211]
    s_add_u32 s57, s58, 4128768
    v_exp_f32 v215, v215
    v_mfma_f32_16x16x32_bf16 a[112:115], a[184:187], v[160:163], a[112:115]
    ds_read_b64_tr_b16 a[164:165], v20 offset:40960
    v_cvt_pk_bf16_f32 v142, v212, v213
    v_mfma_f32_16x16x32_bf16 a[112:115], a[188:191], v[164:167], a[112:115]
    ds_read_b64_tr_b16 a[166:167], v20 offset:45056
    ds_read_b64 v[230:231], v245 offset:192
    v_mfma_f32_16x16x32_bf16 a[116:119], a[188:191], v[172:175], a[116:119]
    ds_read_b128 a[220:223], v11 offset:49152
    v_cvt_pk_bf16_f32 v143, v214, v215
    v_mfma_f32_16x16x32_bf16 a[116:119], a[184:187], v[168:171], a[116:119]
    buffer_load_dwordx4 a[156:159], v254, s[80:83], s57 offen
    v_mfma_f32_16x16x32_bf16 v[212:215], a[224:227], v[112:115], v[204:207]
    v_exp_f32 v208, v208
    v_mfma_f32_16x16x32_bf16 v[212:215], a[228:231], v[116:119], v[212:215]
    v_exp_f32 v209, v209
    v_mfma_f32_16x16x32_bf16 v[212:215], a[232:235], v[120:123], v[212:215]
    v_exp_f32 v210, v210
    v_mfma_f32_16x16x32_bf16 v[212:215], a[236:239], v[124:127], v[212:215]
    v_exp_f32 v211, v211
    v_mfma_f32_16x16x32_bf16 a[120:123], a[184:187], v[176:179], a[120:123]
    ds_read_b64_tr_b16 a[168:169], v21 offset:32768
    v_cvt_pk_bf16_f32 v150, v208, v209
    v_mfma_f32_16x16x32_bf16 a[120:123], a[188:191], v[180:183], a[120:123]
    ds_read_b64_tr_b16 a[170:171], v21 offset:36864
    v_mfma_f32_16x16x32_bf16 a[124:127], a[188:191], v[188:191], a[124:127]
    ds_read_b128 a[224:227], v8 offset:53248
    v_cvt_pk_bf16_f32 v151, v210, v211
    v_mfma_f32_16x16x32_bf16 a[124:127], a[184:187], v[184:187], a[124:127]
    s_waitcnt lgkmcnt(3)
    buffer_load_dwordx4 v48, s[20:23], s49 offen offset:2048 lds
    v_mfma_f32_16x16x32_bf16 v[208:211], a[208:211], v[64:67], v[192:195]
    v_exp_f32 v212, v212
    v_mfma_f32_16x16x32_bf16 v[208:211], a[212:215], v[68:71], v[208:211]
    v_exp_f32 v213, v213
    v_mfma_f32_16x16x32_bf16 v[208:211], a[216:219], v[72:75], v[208:211]
    v_exp_f32 v214, v214
    v_mfma_f32_16x16x32_bf16 v[208:211], a[220:223], v[76:79], v[208:211]
    s_add_u32 s57, s58, 4718592
    v_exp_f32 v215, v215
    v_mfma_f32_16x16x32_bf16 a[0:3], a[160:163], v[128:131], a[0:3]
    ds_read_b64_tr_b16 a[172:173], v21 offset:40960
    v_cvt_pk_bf16_f32 v158, v212, v213
    v_mfma_f32_16x16x32_bf16 a[0:3], a[164:167], v[132:135], a[0:3]
    ds_read_b64_tr_b16 a[174:175], v21 offset:45056
    v_add_f32 v224, v224, v228
    v_mfma_f32_16x16x32_bf16 a[4:7], a[164:167], v[140:143], a[4:7]
    ds_read_b128 a[228:231], v9 offset:53248
    v_cvt_pk_bf16_f32 v159, v214, v215
    v_mfma_f32_16x16x32_bf16 a[4:7], a[160:163], v[136:139], a[4:7]
    buffer_load_dwordx4 a[240:243], v254, s[80:83], s57 offen
    v_mfma_f32_16x16x32_bf16 v[212:215], a[208:211], v[80:83], v[196:199]
    v_exp_f32 v208, v208
    v_mfma_f32_16x16x32_bf16 v[212:215], a[212:215], v[84:87], v[212:215]
    v_exp_f32 v209, v209
    v_mfma_f32_16x16x32_bf16 v[212:215], a[216:219], v[88:91], v[212:215]
    v_exp_f32 v210, v210
    v_mfma_f32_16x16x32_bf16 v[212:215], a[220:223], v[92:95], v[212:215]
    v_exp_f32 v211, v211
    v_mfma_f32_16x16x32_bf16 a[8:11], a[160:163], v[144:147], a[8:11]
    ds_read_b64_tr_b16 a[176:177], v22 offset:32768
    v_cvt_pk_bf16_f32 v160, v208, v209
    v_mfma_f32_16x16x32_bf16 a[8:11], a[164:167], v[148:151], a[8:11]
    ds_read_b64_tr_b16 a[178:179], v22 offset:36864
    v_add_f32 v225, v225, v229
    v_mfma_f32_16x16x32_bf16 a[12:15], a[164:167], v[156:159], a[12:15]
    ds_read_b128 a[232:235], v10 offset:53248
    v_cvt_pk_bf16_f32 v161, v210, v211
    v_mfma_f32_16x16x32_bf16 a[12:15], a[160:163], v[152:155], a[12:15]
    s_waitcnt lgkmcnt(3)
    buffer_load_dwordx4 v49, s[20:23], s49 offen offset:3072 lds
    v_mfma_f32_16x16x32_bf16 v[208:211], a[208:211], v[96:99], v[200:203]
    v_exp_f32 v212, v212
    v_mfma_f32_16x16x32_bf16 v[208:211], a[212:215], v[100:103], v[208:211]
    v_exp_f32 v213, v213
    v_mfma_f32_16x16x32_bf16 v[208:211], a[216:219], v[104:107], v[208:211]
    v_exp_f32 v214, v214
    v_mfma_f32_16x16x32_bf16 v[208:211], a[220:223], v[108:111], v[208:211]
    v_exp_f32 v215, v215
    v_mfma_f32_16x16x32_bf16 a[16:19], a[168:171], v[128:131], a[16:19]
    ds_read_b64_tr_b16 a[180:181], v22 offset:40960
    v_cvt_pk_bf16_f32 v168, v212, v213
    v_mfma_f32_16x16x32_bf16 a[16:19], a[172:175], v[132:135], a[16:19]
    ds_read_b64_tr_b16 a[182:183], v22 offset:45056
    v_add_f32 v226, v226, v230
    v_mfma_f32_16x16x32_bf16 a[20:23], a[172:175], v[140:143], a[20:23]
    ds_read_b128 a[236:239], v11 offset:53248
    v_cvt_pk_bf16_f32 v169, v214, v215
    v_mfma_f32_16x16x32_bf16 a[20:23], a[168:171], v[136:139], a[20:23]
    v_add_f32 v227, v227, v231
    v_add_f32 v224, v224, v226
    v_smfmac_f32_16x16x64_bf16 a[192:195], v[52:55], v[128:135], v50
    v_mfma_f32_16x16x32_bf16 v[212:215], a[208:211], v[112:115], v[204:207]
    v_exp_f32 v208, v208
    v_mfma_f32_16x16x32_bf16 v[212:215], a[212:215], v[116:119], v[212:215]
    s_add_u32 s49, s7, 0
    v_exp_f32 v209, v209
    v_mfma_f32_16x16x32_bf16 v[212:215], a[216:219], v[120:123], v[212:215]
    s_add_u32 m0, s42, 65536
    v_exp_f32 v210, v210
    v_mfma_f32_16x16x32_bf16 v[212:215], a[220:223], v[124:127], v[212:215]
    v_exp_f32 v211, v211
    v_mfma_f32_16x16x32_bf16 a[24:27], a[168:171], v[144:147], a[24:27]
    ds_read_b64_tr_b16 a[184:185], v23 offset:32768
    v_cvt_pk_bf16_f32 v176, v208, v209
    v_mfma_f32_16x16x32_bf16 a[24:27], a[172:175], v[148:151], a[24:27]
    ds_read_b64_tr_b16 a[186:187], v23 offset:36864
    v_add_f32 v225, v225, v227
    v_mfma_f32_16x16x32_bf16 a[28:31], a[172:175], v[156:159], a[28:31]
    ds_read_b128 a[208:211], v8 offset:57344
    v_cvt_pk_bf16_f32 v177, v210, v211
    v_mfma_f32_16x16x32_bf16 a[28:31], a[168:171], v[152:155], a[28:31]
    s_waitcnt lgkmcnt(3)
    buffer_load_dwordx4 v46, s[20:23], s49 offen lds
    v_mfma_f32_16x16x32_bf16 v[208:211], a[224:227], v[64:67], v[192:195]
    v_exp_f32 v212, v212
    v_mfma_f32_16x16x32_bf16 v[208:211], a[228:231], v[68:71], v[208:211]
    v_exp_f32 v213, v213
    v_mfma_f32_16x16x32_bf16 v[208:211], a[232:235], v[72:75], v[208:211]
    v_exp_f32 v214, v214
    v_mfma_f32_16x16x32_bf16 v[208:211], a[236:239], v[76:79], v[208:211]
    s_add_u32 s57, s58, 4128768
    v_exp_f32 v215, v215
    v_mfma_f32_16x16x32_bf16 a[32:35], a[176:179], v[128:131], a[32:35]
    ds_read_b64_tr_b16 a[188:189], v23 offset:40960
    v_cvt_pk_bf16_f32 v184, v212, v213
    v_mfma_f32_16x16x32_bf16 a[32:35], a[180:183], v[132:135], a[32:35]
    ds_read_b64_tr_b16 a[190:191], v23 offset:45056
    v_cvt_pk_bf16_f32 v246, v224, v225
    v_mfma_f32_16x16x32_bf16 a[36:39], a[180:183], v[140:143], a[36:39]
    ds_read_b128 a[212:215], v9 offset:57344
    v_cvt_pk_bf16_f32 v185, v214, v215
    v_mfma_f32_16x16x32_bf16 a[36:39], a[176:179], v[136:139], a[36:39]
    buffer_load_dwordx4 a[244:247], v254, s[32:35], s57 offen
    v_smfmac_f32_16x16x64_bf16 a[196:199], v[52:55], v[136:143], v50
    v_lshrrev_b32 v222, 5, v0
    v_mfma_f32_16x16x32_bf16 v[212:215], a[224:227], v[80:83], v[196:199]
    s_getpc_b64 s[16:17]
Lattn_pc2:
    v_exp_f32 v208, v208
    v_mfma_f32_16x16x32_bf16 v[212:215], a[228:231], v[84:87], v[212:215]
    s_mov_b32 s18, Lattn_redo-Lattn_pc2
    v_exp_f32 v209, v209
    v_mfma_f32_16x16x32_bf16 v[212:215], a[232:235], v[88:91], v[212:215]
    s_lshr_b32 s37, s2, 3
    v_exp_f32 v210, v210
    v_mfma_f32_16x16x32_bf16 v[212:215], a[236:239], v[92:95], v[212:215]
    v_exp_f32 v211, v211
    v_mfma_f32_16x16x32_bf16 a[40:43], a[176:179], v[144:147], a[40:43]
    ds_read_b64_tr_b16 a[160:161], v24 offset:32768
    v_cvt_pk_bf16_f32 v162, v208, v209
    v_mfma_f32_16x16x32_bf16 a[40:43], a[180:183], v[148:151], a[40:43]
    ds_read_b64_tr_b16 a[162:163], v24 offset:36864
    v_lshlrev_b32 v222, 12, v222
    v_mfma_f32_16x16x32_bf16 a[44:47], a[180:183], v[156:159], a[44:47]
    ds_read_b128 a[216:219], v10 offset:57344
    v_cvt_pk_bf16_f32 v163, v210, v211
    v_mfma_f32_16x16x32_bf16 a[44:47], a[176:179], v[152:155], a[44:47]
    s_waitcnt lgkmcnt(3)
    buffer_load_dwordx4 v47, s[20:23], s49 offen offset:1024 lds
    v_mfma_f32_16x16x32_bf16 v[208:211], a[224:227], v[96:99], v[200:203]
    s_lshl_b32 s37, s37, 7
    v_exp_f32 v212, v212
    v_mfma_f32_16x16x32_bf16 v[208:211], a[228:231], v[100:103], v[208:211]
    v_exp_f32 v213, v213
    v_mfma_f32_16x16x32_bf16 v[208:211], a[232:235], v[104:107], v[208:211]
    v_exp_f32 v214, v214
    v_mfma_f32_16x16x32_bf16 v[208:211], a[236:239], v[108:111], v[208:211]
    v_exp_f32 v215, v215
    v_mfma_f32_16x16x32_bf16 a[48:51], a[184:187], v[128:131], a[48:51]
    ds_read_b64_tr_b16 a[164:165], v24 offset:40960
    v_cvt_pk_bf16_f32 v170, v212, v213
    v_mfma_f32_16x16x32_bf16 a[48:51], a[188:191], v[132:135], a[48:51]
    ds_read_b64_tr_b16 a[166:167], v24 offset:45056
    v_lshlrev_b32 v224, 16, v246
    v_mfma_f32_16x16x32_bf16 a[52:55], a[188:191], v[140:143], a[52:55]
    ds_read_b128 a[220:223], v11 offset:57344
    v_cvt_pk_bf16_f32 v171, v214, v215
    v_mfma_f32_16x16x32_bf16 a[52:55], a[184:187], v[136:139], a[52:55]
    buffer_load_dword v222, v222, s[16:19], s37 offen
    v_smfmac_f32_16x16x64_bf16 a[200:203], v[52:55], v[144:151], v50
    v_mfma_f32_16x16x32_bf16 v[212:215], a[224:227], v[112:115], v[204:207]
    v_exp_f32 v208, v208
    v_mfma_f32_16x16x32_bf16 v[212:215], a[228:231], v[116:119], v[212:215]
    v_exp_f32 v209, v209
    v_mfma_f32_16x16x32_bf16 v[212:215], a[232:235], v[120:123], v[212:215]
    v_exp_f32 v210, v210
    v_mfma_f32_16x16x32_bf16 v[212:215], a[236:239], v[124:127], v[212:215]
    v_exp_f32 v211, v211
    v_mfma_f32_16x16x32_bf16 a[56:59], a[184:187], v[144:147], a[56:59]
    ds_read_b64_tr_b16 a[168:169], v25 offset:32768
    v_cvt_pk_bf16_f32 v178, v208, v209
    v_mfma_f32_16x16x32_bf16 a[56:59], a[188:191], v[148:151], a[56:59]
    ds_read_b64_tr_b16 a[170:171], v25 offset:36864
    v_and_b32 v225, 0xffff0000, v246
    v_mfma_f32_16x16x32_bf16 a[60:63], a[188:191], v[156:159], a[60:63]
    ds_read_b128 a[224:227], v8 offset:61440
    v_cvt_pk_bf16_f32 v179, v210, v211
    v_mfma_f32_16x16x32_bf16 a[60:63], a[184:187], v[152:155], a[60:63]
    s_waitcnt lgkmcnt(3)
    buffer_load_dwordx4 v48, s[20:23], s49 offen offset:2048 lds
    v_mfma_f32_16x16x32_bf16 v[208:211], a[208:211], v[64:67], v[192:195]
    v_exp_f32 v212, v212
    v_mfma_f32_16x16x32_bf16 v[208:211], a[212:215], v[68:71], v[208:211]
    v_exp_f32 v213, v213
    v_mfma_f32_16x16x32_bf16 v[208:211], a[216:219], v[72:75], v[208:211]
    v_exp_f32 v214, v214
    v_mfma_f32_16x16x32_bf16 v[208:211], a[220:223], v[76:79], v[208:211]
    s_add_u32 s57, s58, 4718592
    v_exp_f32 v215, v215
    v_mfma_f32_16x16x32_bf16 a[64:67], a[160:163], v[128:131], a[64:67]
    ds_read_b64_tr_b16 a[172:173], v25 offset:40960
    v_cvt_pk_bf16_f32 v186, v212, v213
    v_mfma_f32_16x16x32_bf16 a[64:67], a[164:167], v[132:135], a[64:67]
Ltour0_7:
    s_cbranch_execz Ltour0_11
    ds_read_b64_tr_b16 a[174:175], v25 offset:45056
    v_add_f32 v224, s36, v224
    v_mfma_f32_16x16x32_bf16 a[68:71], a[164:167], v[140:143], a[68:71]
    ds_read_b128 a[228:231], v9 offset:61440
    v_cvt_pk_bf16_f32 v187, v214, v215
    v_mfma_f32_16x16x32_bf16 a[68:71], a[160:163], v[136:139], a[68:71]
    buffer_load_dwordx4 a[248:251], v254, s[32:35], s57 offen
    v_smfmac_f32_16x16x64_bf16 a[204:207], v[52:55], v[152:159], v50
    v_mfma_f32_16x16x32_bf16 v[212:215], a[208:211], v[80:83], v[196:199]
    v_exp_f32 v208, v208
    v_mfma_f32_16x16x32_bf16 v[212:215], a[212:215], v[84:87], v[212:215]
    v_exp_f32 v209, v209
    v_mfma_f32_16x16x32_bf16 v[212:215], a[216:219], v[88:91], v[212:215]
    v_exp_f32 v210, v210
    v_mfma_f32_16x16x32_bf16 v[212:215], a[220:223], v[92:95], v[212:215]
    v_exp_f32 v211, v211
    v_mfma_f32_16x16x32_bf16 a[72:75], a[160:163], v[144:147], a[72:75]
    ds_read_b64_tr_b16 a[176:177], v26 offset:32768
    v_cvt_pk_bf16_f32 v164, v208, v209
    v_mfma_f32_16x16x32_bf16 a[72:75], a[164:167], v[148:151], a[72:75]
    ds_read_b64_tr_b16 a[178:179], v26 offset:36864
    v_add_f32 v225, s36, v225
    v_mfma_f32_16x16x32_bf16 a[76:79], a[164:167], v[156:159], a[76:79]
    ds_read_b128 a[232:235], v10 offset:61440
    v_cvt_pk_bf16_f32 v165, v210, v211
    v_mfma_f32_16x16x32_bf16 a[76:79], a[160:163], v[152:155], a[76:79]
    s_waitcnt lgkmcnt(3)
    buffer_load_dwordx4 v49, s[20:23], s49 offen offset:3072 lds
    v_mfma_f32_16x16x32_bf16 v[208:211], a[208:211], v[96:99], v[200:203]
    v_exp_f32 v212, v212
    v_mfma_f32_16x16x32_bf16 v[208:211], a[212:215], v[100:103], v[208:211]
    v_exp_f32 v213, v213
    v_mfma_f32_16x16x32_bf16 v[208:211], a[216:219], v[104:107], v[208:211]
    v_exp_f32 v214, v214
    v_mfma_f32_16x16x32_bf16 v[208:211], a[220:223], v[108:111], v[208:211]
    v_exp_f32 v215, v215
    v_mfma_f32_16x16x32_bf16 a[80:83], a[168:171], v[128:131], a[80:83]
    ds_read_b64_tr_b16 a[180:181], v26 offset:40960
    v_cvt_pk_bf16_f32 v172, v212, v213
    v_mfma_f32_16x16x32_bf16 a[80:83], a[172:175], v[132:135], a[80:83]
    ds_read_b64_tr_b16 a[182:183], v26 offset:45056
    v_cvt_pk_bf16_f32 v246, v224, v225
    v_mfma_f32_16x16x32_bf16 a[84:87], a[172:175], v[140:143], a[84:87]
    ds_read_b128 a[236:239], v11 offset:61440
    v_cvt_pk_bf16_f32 v173, v214, v215
    v_mfma_f32_16x16x32_bf16 a[84:87], a[168:171], v[136:139], a[84:87]
    s_waitcnt vmcnt(14)
    s_barrier
    v_mfma_f32_16x16x32_bf16 v[212:215], a[208:211], v[112:115], v[204:207]
    v_exp_f32 v208, v208
    v_mfma_f32_16x16x32_bf16 v[212:215], a[212:215], v[116:119], v[212:215]
    s_add_u32 s49, s7, 73728
    v_exp_f32 v209, v209
    v_mfma_f32_16x16x32_bf16 v[212:215], a[216:219], v[120:123], v[212:215]
    s_add_u32 m0, s42, 81920
    v_exp_f32 v210, v210
    v_mfma_f32_16x16x32_bf16 v[212:215], a[220:223], v[124:127], v[212:215]
    v_exp_f32 v211, v211
    v_mfma_f32_16x16x32_bf16 a[88:91], a[168:171], v[144:147], a[88:91]
    ds_read_b64_tr_b16 a[184:185], v27 offset:32768
    v_cvt_pk_bf16_f32 v180, v208, v209
    v_mfma_f32_16x16x32_bf16 a[88:91], a[172:175], v[148:151], a[88:91]
    ds_read_b64_tr_b16 a[186:187], v27 offset:36864
    v_lshrrev_b32 v244, 1, v0
    v_mfma_f32_16x16x32_bf16 a[92:95], a[172:175], v[156:159], a[92:95]
    v_cvt_pk_bf16_f32 v181, v210, v211
    v_mfma_f32_16x16x32_bf16 a[92:95], a[168:171], v[152:155], a[92:95]
    s_waitcnt lgkmcnt(3)
    buffer_load_dwordx4 v46, s[20:23], s49 offen lds
    v_mfma_f32_16x16x32_bf16 v[208:211], a[224:227], v[64:67], v[192:195]
    v_exp_f32 v212, v212
    v_mfma_f32_16x16x32_bf16 v[208:211], a[228:231], v[68:71], v[208:211]
    v_exp_f32 v213, v213
    v_mfma_f32_16x16x32_bf16 v[208:211], a[232:235], v[72:75], v[208:211]
    s_waitcnt lgkmcnt(2)
    v_exp_f32 v214, v214
    v_mfma_f32_16x16x32_bf16 v[208:211], a[236:239], v[76:79], v[208:211]
    v_exp_f32 v215, v215
    v_mfma_f32_16x16x32_bf16 a[96:99], a[176:179], v[128:131], a[96:99]
    ds_read_b64_tr_b16 a[188:189], v27 offset:40960
    v_cvt_pk_bf16_f32 v188, v212, v213
    v_mfma_f32_16x16x32_bf16 a[96:99], a[180:183], v[132:135], a[96:99]
    ds_read_b64_tr_b16 a[190:191], v27 offset:45056
    v_lshlrev_b32 v244, 4, v244
    v_mfma_f32_16x16x32_bf16 a[100:103], a[180:183], v[140:143], a[100:103]
    v_cvt_pk_bf16_f32 v189, v214, v215
    v_mfma_f32_16x16x32_bf16 a[100:103], a[176:179], v[136:139], a[100:103]
    v_and_b32 v245, 1, v0
    v_lshl_add_u32 v244, v245, 2, v244
    v_mfma_f32_16x16x32_bf16 v[212:215], a[224:227], v[80:83], v[196:199]
    v_exp_f32 v208, v208
    v_mfma_f32_16x16x32_bf16 v[212:215], a[228:231], v[84:87], v[212:215]
    v_exp_f32 v209, v209
    v_mfma_f32_16x16x32_bf16 v[212:215], a[232:235], v[88:91], v[212:215]
    v_exp_f32 v210, v210
    v_mfma_f32_16x16x32_bf16 v[212:215], a[236:239], v[92:95], v[212:215]
    v_exp_f32 v211, v211
    v_mfma_f32_16x16x32_bf16 a[104:107], a[176:179], v[144:147], a[104:107]
    ds_read_b64_tr_b16 a[160:161], v20 offset:49152
    v_cvt_pk_bf16_f32 v166, v208, v209
    v_mfma_f32_16x16x32_bf16 a[104:107], a[180:183], v[148:151], a[104:107]
    ds_read_b64_tr_b16 a[162:163], v20 offset:53248
    v_lshrrev_b32 v245, 3, v0
    v_mfma_f32_16x16x32_bf16 a[108:111], a[180:183], v[156:159], a[108:111]
    v_cvt_pk_bf16_f32 v167, v210, v211
    v_mfma_f32_16x16x32_bf16 a[108:111], a[176:179], v[152:155], a[108:111]
    s_waitcnt lgkmcnt(3)
    buffer_load_dwordx4 v47, s[20:23], s49 offen offset:1024 lds
    v_mfma_f32_16x16x32_bf16 v[208:211], a[224:227], v[96:99], v[200:203]
    v_exp_f32 v212, v212
    v_mfma_f32_16x16x32_bf16 v[208:211], a[228:231], v[100:103], v[208:211]
    v_exp_f32 v213, v213
    v_mfma_f32_16x16x32_bf16 v[208:211], a[232:235], v[104:107], v[208:211]
    v_exp_f32 v214, v214
    v_mfma_f32_16x16x32_bf16 v[208:211], a[236:239], v[108:111], v[208:211]
    s_add_u32 s57, s59, 0
    v_exp_f32 v215, v215
    v_mfma_f32_16x16x32_bf16 a[112:115], a[184:187], v[128:131], a[112:115]
    s_waitcnt lgkmcnt(2)
    ds_read_b64_tr_b16 a[164:165], v20 offset:57344
    v_cvt_pk_bf16_f32 v174, v212, v213
    v_mfma_f32_16x16x32_bf16 a[112:115], a[188:191], v[132:135], a[112:115]
    ds_read_b64_tr_b16 a[166:167], v20 offset:61440
    v_min_u32 v245, 1, v245
    v_mfma_f32_16x16x32_bf16 a[116:119], a[188:191], v[140:143], a[116:119]
    v_cvt_pk_bf16_f32 v175, v214, v215
    v_mfma_f32_16x16x32_bf16 a[116:119], a[184:187], v[136:139], a[116:119]
    buffer_load_dwordx4 a[252:255], v255, s[84:87], s57 offen
    v_mfma_f32_16x16x32_bf16 v[212:215], a[224:227], v[112:115], v[204:207]
    v_exp_f32 v208, v208
    v_mfma_f32_16x16x32_bf16 v[212:215], a[228:231], v[116:119], v[212:215]
    v_exp_f32 v209, v209
    v_mfma_f32_16x16x32_bf16 v[212:215], a[232:235], v[120:123], v[212:215]
    v_exp_f32 v210, v210
    v_mfma_f32_16x16x32_bf16 v[212:215], a[236:239], v[124:127], v[212:215]
    v_exp_f32 v211, v211
    v_mfma_f32_16x16x32_bf16 a[120:123], a[184:187], v[144:147], a[120:123]
    ds_read_b64_tr_b16 a[168:169], v21 offset:49152
    v_cvt_pk_bf16_f32 v182, v208, v209
    v_mfma_f32_16x16x32_bf16 a[120:123], a[188:191], v[148:151], a[120:123]
    ds_read_b64_tr_b16 a[170:171], v21 offset:53248
    v_lshl_or_b32 v244, v245, 31, v244
    v_mfma_f32_16x16x32_bf16 a[124:127], a[188:191], v[156:159], a[124:127]
    v_cvt_pk_bf16_f32 v183, v210, v211
    v_mfma_f32_16x16x32_bf16 a[124:127], a[184:187], v[152:155], a[124:127]
    s_waitcnt lgkmcnt(3)
    buffer_load_dwordx4 v48, s[20:23], s49 offen offset:2048 lds
    v_smfmac_f32_16x16x64_bf16 a[192:195], v[52:55], v[160:167], v50
    v_exp_f32 v212, v212
    v_smfmac_f32_16x16x64_bf16 a[196:199], v[52:55], v[168:175], v50
    v_exp_f32 v213, v213
    v_smfmac_f32_16x16x64_bf16 a[200:203], v[52:55], v[176:183], v50
    v_exp_f32 v214, v214
    v_exp_f32 v215, v215
    v_mfma_f32_16x16x32_bf16 a[0:3], a[160:163], v[160:163], a[0:3]
    s_waitcnt lgkmcnt(2)
    ds_read_b64_tr_b16 a[172:173], v21 offset:57344
    v_cvt_pk_bf16_f32 v190, v212, v213
    v_mfma_f32_16x16x32_bf16 a[0:3], a[164:167], v[164:167], a[0:3]
    ds_read_b64_tr_b16 a[174:175], v21 offset:61440
    v_mfma_f32_16x16x32_bf16 a[4:7], a[164:167], v[172:175], a[4:7]
    v_cvt_pk_bf16_f32 v191, v214, v215
    v_mfma_f32_16x16x32_bf16 a[4:7], a[160:163], v[168:171], a[4:7]
    buffer_store_dword v246, v244, s[24:27], s39 offen sc1
    v_smfmac_f32_16x16x64_bf16 a[204:207], v[52:55], v[184:191], v50
    v_mfma_f32_16x16x32_bf16 a[8:11], a[160:163], v[176:179], a[8:11]
    ds_read_b64_tr_b16 a[176:177], v22 offset:49152
    v_mfma_f32_16x16x32_bf16 a[8:11], a[164:167], v[180:183], a[8:11]
    ds_read_b64_tr_b16 a[178:179], v22 offset:53248
    v_accvgpr_read_b32 v216, a192
    v_accvgpr_read_b32 v217, a193
    v_mfma_f32_16x16x32_bf16 a[12:15], a[164:167], v[188:191], a[12:15]
    v_accvgpr_read_b32 v218, a196
    v_accvgpr_read_b32 v219, a197
    v_mfma_f32_16x16x32_bf16 a[12:15], a[160:163], v[184:187], a[12:15]
    s_waitcnt lgkmcnt(4)
    buffer_load_dwordx4 v49, s[20:23], s49 offen offset:3072 lds
    v_accvgpr_read_b32 v220, a200
    v_accvgpr_read_b32 v221, a201
    v_mfma_f32_16x16x32_bf16 a[16:19], a[168:171], v[160:163], a[16:19]
    s_waitcnt lgkmcnt(2)
    ds_read_b64_tr_b16 a[180:181], v22 offset:57344
    s_waitcnt vmcnt(9)
    v_accvgpr_read_b32 v222, a204
    v_mfma_f32_16x16x32_bf16 a[16:19], a[172:175], v[164:167], a[16:19]
    ds_read_b64_tr_b16 a[182:183], v22 offset:61440
    v_accvgpr_read_b32 v223, a205
    v_add_f32 v58, v216, v217
    v_mfma_f32_16x16x32_bf16 a[20:23], a[172:175], v[172:175], a[20:23]
    v_add_f32 v59, v218, v219
    v_add_f32 v60, v220, v221
    v_mfma_f32_16x16x32_bf16 a[20:23], a[168:171], v[168:171], a[20:23]
    v_add_f32 v61, v222, v223
    v_add_f32 v216, v58, v59
    s_add_u32 s49, s7, 256
    s_add_u32 m0, s42, 32768
    v_mfma_f32_16x16x32_bf16 a[24:27], a[168:171], v[176:179], a[24:27]
    ds_read_b64_tr_b16 a[184:185], v23 offset:49152
    v_add_f32 v217, v60, v61
    v_mfma_f32_16x16x32_bf16 a[24:27], a[172:175], v[180:183], a[24:27]
    ds_read_b64_tr_b16 a[186:187], v23 offset:53248
    v_add_f32 v216, v216, v217
    v_cmp_ngt_f32 vcc, 1669332992, v216
    v_mfma_f32_16x16x32_bf16 a[28:31], a[172:175], v[188:191], a[28:31]
    v_rcp_f32 v58, v58
    v_rcp_f32 v59, v59
    v_mfma_f32_16x16x32_bf16 a[28:31], a[168:171], v[184:187], a[28:31]
    s_waitcnt lgkmcnt(4)
    buffer_load_dwordx4 v46, s[20:23], s49 offen lds
    v_rcp_f32 v60, v60
    v_rcp_f32 v61, v61
    v_mfma_f32_16x16x32_bf16 a[32:35], a[176:179], v[160:163], a[32:35]
    s_waitcnt lgkmcnt(2)
    ds_read_b64_tr_b16 a[188:189], v23 offset:57344
    v_mov_b32 v228, 131072
    v_mfma_f32_16x16x32_bf16 a[32:35], a[180:183], v[164:167], a[32:35]
    ds_read_b64_tr_b16 a[190:191], v23 offset:61440
    s_or_b32 s36, vcc_lo, vcc_hi
    v_mfma_f32_16x16x32_bf16 a[36:39], a[180:183], v[172:175], a[36:39]
    v_accvgpr_read_b32 v208, a0
    v_accvgpr_read_b32 v209, a1
    v_accvgpr_read_b32 v210, a2
    v_accvgpr_read_b32 v211, a3
    v_pk_mul_f32 v[208:209], v[208:209], v[58:59] op_sel:[0,0] op_sel_hi:[1,0]
    v_pk_mul_f32 v[210:211], v[210:211], v[58:59] op_sel:[0,0] op_sel_hi:[1,0]
    v_cvt_pk_bf16_f32 v128, v208, v209
    v_cvt_pk_bf16_f32 v129, v210, v211
    v_mfma_f32_16x16x32_bf16 a[36:39], a[176:179], v[168:171], a[36:39]
    v_accvgpr_read_b32 v212, a4
    v_accvgpr_read_b32 v213, a5
    v_accvgpr_read_b32 v214, a6
    v_accvgpr_read_b32 v215, a7
    v_pk_mul_f32 v[212:213], v[212:213], v[58:59] op_sel:[0,1] op_sel_hi:[1,1]
    v_pk_mul_f32 v[214:215], v[214:215], v[58:59] op_sel:[0,1] op_sel_hi:[1,1]
    v_cvt_pk_bf16_f32 v132, v212, v213
    v_cvt_pk_bf16_f32 v133, v214, v215
    v_mfma_f32_16x16x32_bf16 a[40:43], a[176:179], v[176:179], a[40:43]
    ds_read_b64_tr_b16 a[160:161], v24 offset:49152
    v_mov_b32 v218, s36
    v_mfma_f32_16x16x32_bf16 a[40:43], a[180:183], v[180:183], a[40:43]
    ds_read_b64_tr_b16 a[162:163], v24 offset:53248
    s_lshl_b32 s38, s3, 2
    v_mfma_f32_16x16x32_bf16 a[44:47], a[180:183], v[188:191], a[44:47]
    v_accvgpr_read_b32 v208, a8
    v_accvgpr_read_b32 v209, a9
    v_accvgpr_read_b32 v210, a10
    v_accvgpr_read_b32 v211, a11
    v_pk_mul_f32 v[208:209], v[208:209], v[60:61] op_sel:[0,0] op_sel_hi:[1,0]
    v_pk_mul_f32 v[210:211], v[210:211], v[60:61] op_sel:[0,0] op_sel_hi:[1,0]
    v_cvt_pk_bf16_f32 v136, v208, v209
    v_cvt_pk_bf16_f32 v137, v210, v211
    v_mfma_f32_16x16x32_bf16 a[44:47], a[176:179], v[184:187], a[44:47]
    s_waitcnt lgkmcnt(4)
    buffer_load_dwordx4 v47, s[20:23], s49 offen offset:1024 lds
    v_accvgpr_read_b32 v212, a12
    v_accvgpr_read_b32 v213, a13
    v_accvgpr_read_b32 v214, a14
    v_accvgpr_read_b32 v215, a15
    v_pk_mul_f32 v[212:213], v[212:213], v[60:61] op_sel:[0,1] op_sel_hi:[1,1]
    v_pk_mul_f32 v[214:215], v[214:215], v[60:61] op_sel:[0,1] op_sel_hi:[1,1]
    v_cvt_pk_bf16_f32 v140, v212, v213
    v_cvt_pk_bf16_f32 v141, v214, v215
    v_mfma_f32_16x16x32_bf16 a[48:51], a[184:187], v[160:163], a[48:51]
    s_waitcnt lgkmcnt(2)
    ds_read_b64_tr_b16 a[164:165], v24 offset:57344
    v_add_u32 v219, s38, v228
    v_mfma_f32_16x16x32_bf16 a[48:51], a[188:191], v[164:167], a[48:51]
    ds_read_b64_tr_b16 a[166:167], v24 offset:61440
    ds_write_b32 v219, v218
    v_mfma_f32_16x16x32_bf16 a[52:55], a[188:191], v[172:175], a[52:55]
    v_accvgpr_read_b32 v208, a16
    v_accvgpr_read_b32 v209, a17
    v_accvgpr_read_b32 v210, a18
    v_accvgpr_read_b32 v211, a19
    v_pk_mul_f32 v[208:209], v[208:209], v[58:59] op_sel:[0,0] op_sel_hi:[1,0]
    v_pk_mul_f32 v[210:211], v[210:211], v[58:59] op_sel:[0,0] op_sel_hi:[1,0]
    v_cvt_pk_bf16_f32 v130, v208, v209
    v_cvt_pk_bf16_f32 v131, v210, v211
    s_add_u32 s37, s55, 0
    buffer_store_dwordx4 v[128:131], v252, s[28:31], s37 offen offset:0
    v_mfma_f32_16x16x32_bf16 a[52:55], a[184:187], v[168:171], a[52:55]
    v_accvgpr_read_b32 v212, a20
    v_accvgpr_read_b32 v213, a21
    v_accvgpr_read_b32 v214, a22
    v_accvgpr_read_b32 v215, a23
    v_pk_mul_f32 v[212:213], v[212:213], v[58:59] op_sel:[0,1] op_sel_hi:[1,1]
    v_pk_mul_f32 v[214:215], v[214:215], v[58:59] op_sel:[0,1] op_sel_hi:[1,1]
    v_cvt_pk_bf16_f32 v134, v212, v213
    v_cvt_pk_bf16_f32 v135, v214, v215
    s_add_u32 s37, s55, 8192
    buffer_store_dwordx4 v[132:135], v252, s[28:31], s37 offen offset:0
    v_mfma_f32_16x16x32_bf16 a[56:59], a[184:187], v[176:179], a[56:59]
    ds_read_b64_tr_b16 a[168:169], v25 offset:49152
    v_min_u32 v240, 1, v0
    v_mfma_f32_16x16x32_bf16 a[56:59], a[188:191], v[180:183], a[56:59]
    ds_read_b64_tr_b16 a[170:171], v25 offset:53248
    v_mfma_f32_16x16x32_bf16 a[60:63], a[188:191], v[188:191], a[60:63]
    v_accvgpr_read_b32 v208, a24
    v_accvgpr_read_b32 v209, a25
    v_accvgpr_read_b32 v210, a26
    v_accvgpr_read_b32 v211, a27
    v_pk_mul_f32 v[208:209], v[208:209], v[60:61] op_sel:[0,0] op_sel_hi:[1,0]
    v_pk_mul_f32 v[210:211], v[210:211], v[60:61] op_sel:[0,0] op_sel_hi:[1,0]
    v_cvt_pk_bf16_f32 v138, v208, v209
    v_cvt_pk_bf16_f32 v139, v210, v211
    s_add_u32 s37, s55, 4096
    buffer_store_dwordx4 v[136:139], v252, s[28:31], s37 offen offset:0
    v_mfma_f32_16x16x32_bf16 a[60:63], a[184:187], v[184:187], a[60:63]
    s_waitcnt lgkmcnt(5)
    buffer_load_dwordx4 v48, s[20:23], s49 offen offset:2048 lds
    v_accvgpr_read_b32 v212, a28
    v_accvgpr_read_b32 v213, a29
    v_accvgpr_read_b32 v214, a30
    v_accvgpr_read_b32 v215, a31
    v_pk_mul_f32 v[212:213], v[212:213], v[60:61] op_sel:[0,1] op_sel_hi:[1,1]
    v_pk_mul_f32 v[214:215], v[214:215], v[60:61] op_sel:[0,1] op_sel_hi:[1,1]
    v_cvt_pk_bf16_f32 v142, v212, v213
    v_cvt_pk_bf16_f32 v143, v214, v215
    s_add_u32 s37, s55, 12288
    buffer_store_dwordx4 v[140:143], v252, s[28:31], s37 offen offset:0
    v_mfma_f32_16x16x32_bf16 a[64:67], a[160:163], v[160:163], a[64:67]
    s_waitcnt lgkmcnt(3)
    ds_read_b64_tr_b16 a[172:173], v25 offset:57344
    v_lshlrev_b32 v240, 31, v240
    v_mfma_f32_16x16x32_bf16 a[64:67], a[164:167], v[164:167], a[64:67]
    ds_read_b64_tr_b16 a[174:175], v25 offset:61440
    v_mfma_f32_16x16x32_bf16 a[68:71], a[164:167], v[172:175], a[68:71]
    v_accvgpr_read_b32 v208, a32
    v_accvgpr_read_b32 v209, a33
    v_accvgpr_read_b32 v210, a34
    v_accvgpr_read_b32 v211, a35
    v_pk_mul_f32 v[208:209], v[208:209], v[58:59] op_sel:[0,0] op_sel_hi:[1,0]
    v_pk_mul_f32 v[210:211], v[210:211], v[58:59] op_sel:[0,0] op_sel_hi:[1,0]
    v_cvt_pk_bf16_f32 v144, v208, v209
    v_cvt_pk_bf16_f32 v145, v210, v211
    v_mfma_f32_16x16x32_bf16 a[68:71], a[160:163], v[168:171], a[68:71]
    v_accvgpr_read_b32 v212, a36
    v_accvgpr_read_b32 v213, a37
    v_accvgpr_read_b32 v214, a38
    v_accvgpr_read_b32 v215, a39
    v_pk_mul_f32 v[212:213], v[212:213], v[58:59] op_sel:[0,1] op_sel_hi:[1,1]
    v_pk_mul_f32 v[214:215], v[214:215], v[58:59] op_sel:[0,1] op_sel_hi:[1,1]
    v_cvt_pk_bf16_f32 v148, v212, v213
    v_cvt_pk_bf16_f32 v149, v214, v215
    v_mfma_f32_16x16x32_bf16 a[72:75], a[160:163], v[176:179], a[72:75]
    ds_read_b64_tr_b16 a[176:177], v26 offset:49152
    v_mov_b32 v241, 1
    v_mfma_f32_16x16x32_bf16 a[72:75], a[164:167], v[180:183], a[72:75]
    ds_read_b64_tr_b16 a[178:179], v26 offset:53248
    v_mfma_f32_16x16x32_bf16 a[76:79], a[164:167], v[188:191], a[76:79]
    v_accvgpr_read_b32 v208, a40
    v_accvgpr_read_b32 v209, a41
    v_accvgpr_read_b32 v210, a42
    v_accvgpr_read_b32 v211, a43
    v_pk_mul_f32 v[208:209], v[208:209], v[60:61] op_sel:[0,0] op_sel_hi:[1,0]
    v_pk_mul_f32 v[210:211], v[210:211], v[60:61] op_sel:[0,0] op_sel_hi:[1,0]
    v_cvt_pk_bf16_f32 v152, v208, v209
    v_cvt_pk_bf16_f32 v153, v210, v211
    v_mfma_f32_16x16x32_bf16 a[76:79], a[160:163], v[184:187], a[76:79]
    s_waitcnt lgkmcnt(4)
    buffer_load_dwordx4 v49, s[20:23], s49 offen offset:3072 lds
    v_accvgpr_read_b32 v212, a44
    v_accvgpr_read_b32 v213, a45
    v_accvgpr_read_b32 v214, a46
    v_accvgpr_read_b32 v215, a47
    v_pk_mul_f32 v[212:213], v[212:213], v[60:61] op_sel:[0,1] op_sel_hi:[1,1]
    v_pk_mul_f32 v[214:215], v[214:215], v[60:61] op_sel:[0,1] op_sel_hi:[1,1]
    v_cvt_pk_bf16_f32 v156, v212, v213
    v_cvt_pk_bf16_f32 v157, v214, v215
    v_mfma_f32_16x16x32_bf16 a[80:83], a[168:171], v[160:163], a[80:83]
    s_waitcnt lgkmcnt(2)
    ds_read_b64_tr_b16 a[180:181], v26 offset:57344
    v_mfma_f32_16x16x32_bf16 a[80:83], a[172:175], v[164:167], a[80:83]
    ds_read_b64_tr_b16 a[182:183], v26 offset:61440
    v_mfma_f32_16x16x32_bf16 a[84:87], a[172:175], v[172:175], a[84:87]
    v_accvgpr_read_b32 v208, a48
    v_accvgpr_read_b32 v209, a49
    v_accvgpr_read_b32 v210, a50
    v_accvgpr_read_b32 v211, a51
    v_pk_mul_f32 v[208:209], v[208:209], v[58:59] op_sel:[0,0] op_sel_hi:[1,0]
    v_pk_mul_f32 v[210:211], v[210:211], v[58:59] op_sel:[0,0] op_sel_hi:[1,0]
    v_cvt_pk_bf16_f32 v146, v208, v209
    v_cvt_pk_bf16_f32 v147, v210, v211
    s_add_u32 s37, s55, 0
    buffer_store_dwordx4 v[144:147], v252, s[28:31], s37 offen offset:1024
    v_mfma_f32_16x16x32_bf16 a[84:87], a[168:171], v[168:171], a[84:87]
    v_accvgpr_read_b32 v212, a52
    v_accvgpr_read_b32 v213, a53
    v_accvgpr_read_b32 v214, a54
    v_accvgpr_read_b32 v215, a55
    v_pk_mul_f32 v[212:213], v[212:213], v[58:59] op_sel:[0,1] op_sel_hi:[1,1]
    v_pk_mul_f32 v[214:215], v[214:215], v[58:59] op_sel:[0,1] op_sel_hi:[1,1]
    v_cvt_pk_bf16_f32 v150, v212, v213
    v_cvt_pk_bf16_f32 v151, v214, v215
    s_add_u32 s37, s55, 8192
    buffer_store_dwordx4 v[148:151], v252, s[28:31], s37 offen offset:1024
    s_waitcnt vmcnt(23)
    s_barrier
    v_mfma_f32_16x16x32_bf16 a[88:91], a[168:171], v[176:179], a[88:91]
    ds_read_b64_tr_b16 a[184:185], v27 offset:49152
    v_mfma_f32_16x16x32_bf16 a[88:91], a[172:175], v[180:183], a[88:91]
    ds_read_b64_tr_b16 a[186:187], v27 offset:53248
    v_mfma_f32_16x16x32_bf16 a[92:95], a[172:175], v[188:191], a[92:95]
    ds_read_b128 v[224:227], v228
    v_accvgpr_read_b32 v208, a56
    v_accvgpr_read_b32 v209, a57
    v_accvgpr_read_b32 v210, a58
    v_accvgpr_read_b32 v211, a59
    v_pk_mul_f32 v[208:209], v[208:209], v[60:61] op_sel:[0,0] op_sel_hi:[1,0]
    v_pk_mul_f32 v[210:211], v[210:211], v[60:61] op_sel:[0,0] op_sel_hi:[1,0]
    v_cvt_pk_bf16_f32 v154, v208, v209
    v_cvt_pk_bf16_f32 v155, v210, v211
    s_add_u32 s37, s55, 4096
    buffer_store_dwordx4 v[152:155], v252, s[28:31], s37 offen offset:1024
    v_mfma_f32_16x16x32_bf16 a[92:95], a[168:171], v[184:187], a[92:95]
    s_waitcnt lgkmcnt(5)
    v_accvgpr_read_b32 v212, a60
    v_accvgpr_read_b32 v213, a61
    v_accvgpr_read_b32 v214, a62
    v_accvgpr_read_b32 v215, a63
    v_pk_mul_f32 v[212:213], v[212:213], v[60:61] op_sel:[0,1] op_sel_hi:[1,1]
    v_pk_mul_f32 v[214:215], v[214:215], v[60:61] op_sel:[0,1] op_sel_hi:[1,1]
    v_cvt_pk_bf16_f32 v158, v212, v213
    v_cvt_pk_bf16_f32 v159, v214, v215
    s_add_u32 s37, s55, 12288
    buffer_store_dwordx4 v[156:159], v252, s[28:31], s37 offen offset:1024
    s_add_u32 s49, s7, 73984
    v_mfma_f32_16x16x32_bf16 a[96:99], a[176:179], v[160:163], a[96:99]
    s_waitcnt lgkmcnt(3)
    s_add_u32 m0, s42, 49152
    ds_read_b64_tr_b16 a[188:189], v27 offset:57344
    v_mfma_f32_16x16x32_bf16 a[96:99], a[180:183], v[164:167], a[96:99]
    buffer_load_dwordx4 v46, s[20:23], s49 offen lds
    v_mfma_f32_16x16x32_bf16 a[100:103], a[180:183], v[172:175], a[100:103]
    ds_read_b64_tr_b16 a[190:191], v27 offset:61440
    v_accvgpr_read_b32 v208, a64
    v_accvgpr_read_b32 v209, a65
    v_accvgpr_read_b32 v210, a66
    v_accvgpr_read_b32 v211, a67
    v_pk_mul_f32 v[208:209], v[208:209], v[58:59] op_sel:[0,0] op_sel_hi:[1,0]
    v_pk_mul_f32 v[210:211], v[210:211], v[58:59] op_sel:[0,0] op_sel_hi:[1,0]
    v_cvt_pk_bf16_f32 v192, v208, v209
    v_cvt_pk_bf16_f32 v193, v210, v211
    v_mfma_f32_16x16x32_bf16 a[100:103], a[176:179], v[168:171], a[100:103]
    buffer_load_dwordx4 v47, s[20:23], s49 offen offset:1024 lds
    v_accvgpr_read_b32 v212, a68
    v_accvgpr_read_b32 v213, a69
    v_accvgpr_read_b32 v214, a70
    v_accvgpr_read_b32 v215, a71
    v_pk_mul_f32 v[212:213], v[212:213], v[58:59] op_sel:[0,1] op_sel_hi:[1,1]
    v_pk_mul_f32 v[214:215], v[214:215], v[58:59] op_sel:[0,1] op_sel_hi:[1,1]
    v_cvt_pk_bf16_f32 v196, v212, v213
    v_cvt_pk_bf16_f32 v197, v214, v215
    v_mfma_f32_16x16x32_bf16 a[104:107], a[176:179], v[176:179], a[104:107]
    v_mfma_f32_16x16x32_bf16 a[104:107], a[180:183], v[180:183], a[104:107]
    buffer_load_dwordx4 v48, s[20:23], s49 offen offset:2048 lds
    v_mfma_f32_16x16x32_bf16 a[108:111], a[180:183], v[188:191], a[108:111]
    v_accvgpr_read_b32 v208, a72
    v_accvgpr_read_b32 v209, a73
    v_accvgpr_read_b32 v210, a74
    v_accvgpr_read_b32 v211, a75
    v_pk_mul_f32 v[208:209], v[208:209], v[60:61] op_sel:[0,0] op_sel_hi:[1,0]
    v_pk_mul_f32 v[210:211], v[210:211], v[60:61] op_sel:[0,0] op_sel_hi:[1,0]
    v_cvt_pk_bf16_f32 v200, v208, v209
    v_cvt_pk_bf16_f32 v201, v210, v211
    v_mfma_f32_16x16x32_bf16 a[108:111], a[176:179], v[184:187], a[108:111]
    s_waitcnt lgkmcnt(3)
    buffer_load_dwordx4 v49, s[20:23], s49 offen offset:3072 lds
    v_accvgpr_read_b32 v212, a76
    v_accvgpr_read_b32 v213, a77
    v_accvgpr_read_b32 v214, a78
    v_accvgpr_read_b32 v215, a79
    v_pk_mul_f32 v[212:213], v[212:213], v[60:61] op_sel:[0,1] op_sel_hi:[1,1]
    v_pk_mul_f32 v[214:215], v[214:215], v[60:61] op_sel:[0,1] op_sel_hi:[1,1]
    v_cvt_pk_bf16_f32 v204, v212, v213
    v_cvt_pk_bf16_f32 v205, v214, v215
    s_add_u32 s49, s46, 0
    v_mfma_f32_16x16x32_bf16 a[112:115], a[184:187], v[160:163], a[112:115]
    s_waitcnt lgkmcnt(0)
    s_add_u32 m0, s42, 98304
    v_mfma_f32_16x16x32_bf16 a[112:115], a[188:191], v[164:167], a[112:115]
    buffer_load_dwordx4 v46, s[20:23], s49 offen lds
    v_mfma_f32_16x16x32_bf16 a[116:119], a[188:191], v[172:175], a[116:119]
    v_accvgpr_read_b32 v208, a80
    v_accvgpr_read_b32 v209, a81
    v_accvgpr_read_b32 v210, a82
    v_accvgpr_read_b32 v211, a83
    v_pk_mul_f32 v[208:209], v[208:209], v[58:59] op_sel:[0,0] op_sel_hi:[1,0]
    v_pk_mul_f32 v[210:211], v[210:211], v[58:59] op_sel:[0,0] op_sel_hi:[1,0]
    v_cvt_pk_bf16_f32 v194, v208, v209
    v_cvt_pk_bf16_f32 v195, v210, v211
    s_add_u32 s37, s55, 0
    buffer_store_dwordx4 v[192:195], v252, s[28:31], s37 offen offset:2048
    v_mfma_f32_16x16x32_bf16 a[116:119], a[184:187], v[168:171], a[116:119]
    buffer_load_dwordx4 v47, s[20:23], s49 offen offset:1024 lds
    v_accvgpr_read_b32 v212, a84
    v_accvgpr_read_b32 v213, a85
    v_accvgpr_read_b32 v214, a86
    v_accvgpr_read_b32 v215, a87
    v_pk_mul_f32 v[212:213], v[212:213], v[58:59] op_sel:[0,1] op_sel_hi:[1,1]
    v_pk_mul_f32 v[214:215], v[214:215], v[58:59] op_sel:[0,1] op_sel_hi:[1,1]
    v_cvt_pk_bf16_f32 v198, v212, v213
    v_cvt_pk_bf16_f32 v199, v214, v215
    s_add_u32 s37, s55, 8192
    buffer_store_dwordx4 v[196:199], v252, s[28:31], s37 offen offset:2048
    v_mfma_f32_16x16x32_bf16 a[120:123], a[184:187], v[176:179], a[120:123]
    v_mfma_f32_16x16x32_bf16 a[120:123], a[188:191], v[180:183], a[120:123]
    buffer_load_dwordx4 v48, s[20:23], s49 offen offset:2048 lds
    v_mfma_f32_16x16x32_bf16 a[124:127], a[188:191], v[188:191], a[124:127]
    v_accvgpr_read_b32 v208, a88
    v_accvgpr_read_b32 v209, a89
    v_accvgpr_read_b32 v210, a90
    v_accvgpr_read_b32 v211, a91
    v_pk_mul_f32 v[208:209], v[208:209], v[60:61] op_sel:[0,0] op_sel_hi:[1,0]
    v_pk_mul_f32 v[210:211], v[210:211], v[60:61] op_sel:[0,0] op_sel_hi:[1,0]
    v_cvt_pk_bf16_f32 v202, v208, v209
    v_cvt_pk_bf16_f32 v203, v210, v211
    s_add_u32 s37, s55, 4096
    buffer_store_dwordx4 v[200:203], v252, s[28:31], s37 offen offset:2048
    v_mfma_f32_16x16x32_bf16 a[124:127], a[184:187], v[184:187], a[124:127]
    buffer_load_dwordx4 v49, s[20:23], s49 offen offset:3072 lds
    v_accvgpr_read_b32 v212, a92
    v_accvgpr_read_b32 v213, a93
    v_accvgpr_read_b32 v214, a94
    v_accvgpr_read_b32 v215, a95
    v_pk_mul_f32 v[212:213], v[212:213], v[60:61] op_sel:[0,1] op_sel_hi:[1,1]
    v_pk_mul_f32 v[214:215], v[214:215], v[60:61] op_sel:[0,1] op_sel_hi:[1,1]
    v_cvt_pk_bf16_f32 v206, v212, v213
    v_cvt_pk_bf16_f32 v207, v214, v215
    s_add_u32 s37, s55, 12288
    buffer_store_dwordx4 v[204:207], v252, s[28:31], s37 offen offset:2048
    v_or3_b32 v224, v224, v225, v226
    v_or_b32 v224, v224, v227
    s_nop 0
    v_readfirstlane_b32 s36, v224
    v_readfirstlane_b32 s38, v253
    v_min_u32 v8, 1, v1
    v_lshlrev_b32 v8, 31, v8
    v_mov_b32 v10, s95
    s_getreg_b32 s39, hwreg(HW_REG_XCC_ID, 0, 4)
    s_lshl_b32 s39, s39, 28
    s_xor_b32 s39, s39, s95
    s_cmp_eq_u32 s38, s39
    s_cselect_b32 s53, 1, 0
    ds_read_b64_tr_b16 a[208:209], v12 offset:0
    ds_read_b64_tr_b16 a[210:211], v12 offset:4096
    ds_read_b64_tr_b16 a[212:213], v12 offset:8192
    ds_read_b64_tr_b16 a[214:215], v12 offset:12288
    ds_read_b64_tr_b16 a[216:217], v12 offset:16384
    ds_read_b64_tr_b16 a[218:219], v12 offset:20480
    ds_read_b64_tr_b16 a[220:221], v12 offset:24576
    ds_read_b64_tr_b16 a[222:223], v12 offset:28672
    ds_read_b64_tr_b16 a[224:225], v16 offset:0
    ds_read_b64_tr_b16 a[226:227], v16 offset:4096
    ds_read_b64_tr_b16 a[228:229], v16 offset:8192
    ds_read_b64_tr_b16 a[230:231], v16 offset:12288
    ds_read_b64_tr_b16 a[232:233], v16 offset:16384
    ds_read_b64_tr_b16 a[234:235], v16 offset:20480
    ds_read_b64_tr_b16 a[236:237], v16 offset:24576
    ds_read_b64_tr_b16 a[238:239], v16 offset:28672
    s_andn2_b32 s36, s36, s48
    s_cbranch_scc1 Lattn_redo
    v_accvgpr_read_b32 v208, a96
    v_accvgpr_read_b32 v209, a97
    v_accvgpr_read_b32 v210, a98
    v_accvgpr_read_b32 v211, a99
    v_pk_mul_f32 v[208:209], v[208:209], v[58:59] op_sel:[0,0] op_sel_hi:[1,0]
Ltour0_8:
    s_cbranch_execz Ltour0_12
    v_pk_mul_f32 v[210:211], v[210:211], v[58:59] op_sel:[0,0] op_sel_hi:[1,0]
    v_cvt_pk_bf16_f32 v176, v208, v209
    v_cvt_pk_bf16_f32 v177, v210, v211
    v_accvgpr_read_b32 v212, a100
    v_accvgpr_read_b32 v213, a101
    v_accvgpr_read_b32 v214, a102
    v_accvgpr_read_b32 v215, a103
    v_pk_mul_f32 v[212:213], v[212:213], v[58:59] op_sel:[0,1] op_sel_hi:[1,1]
    v_pk_mul_f32 v[214:215], v[214:215], v[58:59] op_sel:[0,1] op_sel_hi:[1,1]
    v_cvt_pk_bf16_f32 v180, v212, v213
    v_cvt_pk_bf16_f32 v181, v214, v215
    v_accvgpr_read_b32 v208, a104
    v_accvgpr_read_b32 v209, a105
    v_accvgpr_read_b32 v210, a106
    v_accvgpr_read_b32 v211, a107
    v_pk_mul_f32 v[208:209], v[208:209], v[60:61] op_sel:[0,0] op_sel_hi:[1,0]
    v_pk_mul_f32 v[210:211], v[210:211], v[60:61] op_sel:[0,0] op_sel_hi:[1,0]
    v_cvt_pk_bf16_f32 v184, v208, v209
    v_cvt_pk_bf16_f32 v185, v210, v211
    v_accvgpr_read_b32 v212, a108
    v_accvgpr_read_b32 v213, a109
    v_accvgpr_read_b32 v214, a110
    v_accvgpr_read_b32 v215, a111
    v_pk_mul_f32 v[212:213], v[212:213], v[60:61] op_sel:[0,1] op_sel_hi:[1,1]
    v_pk_mul_f32 v[214:215], v[214:215], v[60:61] op_sel:[0,1] op_sel_hi:[1,1]
    v_cvt_pk_bf16_f32 v188, v212, v213
    v_cvt_pk_bf16_f32 v189, v214, v215
    v_accvgpr_read_b32 v208, a112
    v_accvgpr_read_b32 v209, a113
    v_accvgpr_read_b32 v210, a114
    v_accvgpr_read_b32 v211, a115
    v_pk_mul_f32 v[208:209], v[208:209], v[58:59] op_sel:[0,0] op_sel_hi:[1,0]
    v_pk_mul_f32 v[210:211], v[210:211], v[58:59] op_sel:[0,0] op_sel_hi:[1,0]
    v_cvt_pk_bf16_f32 v178, v208, v209
    v_cvt_pk_bf16_f32 v179, v210, v211
    s_add_u32 s37, s55, 0
    buffer_store_dwordx4 v[176:179], v252, s[28:31], s37 offen offset:3072
    v_accvgpr_read_b32 v212, a116
    v_accvgpr_read_b32 v213, a117
    v_accvgpr_read_b32 v214, a118
    v_accvgpr_read_b32 v215, a119
    v_pk_mul_f32 v[212:213], v[212:213], v[58:59] op_sel:[0,1] op_sel_hi:[1,1]
    v_pk_mul_f32 v[214:215], v[214:215], v[58:59] op_sel:[0,1] op_sel_hi:[1,1]
    v_cvt_pk_bf16_f32 v182, v212, v213
    v_cvt_pk_bf16_f32 v183, v214, v215
    s_add_u32 s37, s55, 8192
    buffer_store_dwordx4 v[180:183], v252, s[28:31], s37 offen offset:3072
    v_accvgpr_read_b32 v208, a120
    v_accvgpr_read_b32 v209, a121
    v_accvgpr_read_b32 v210, a122
    v_accvgpr_read_b32 v211, a123
    v_pk_mul_f32 v[208:209], v[208:209], v[60:61] op_sel:[0,0] op_sel_hi:[1,0]
    v_pk_mul_f32 v[210:211], v[210:211], v[60:61] op_sel:[0,0] op_sel_hi:[1,0]
    v_cvt_pk_bf16_f32 v186, v208, v209
    v_cvt_pk_bf16_f32 v187, v210, v211
    s_add_u32 s37, s55, 4096
    buffer_store_dwordx4 v[184:187], v252, s[28:31], s37 offen offset:3072
    v_accvgpr_read_b32 v212, a124
    v_accvgpr_read_b32 v213, a125
    v_accvgpr_read_b32 v214, a126
    v_accvgpr_read_b32 v215, a127
    v_pk_mul_f32 v[212:213], v[212:213], v[60:61] op_sel:[0,1] op_sel_hi:[1,1]
    v_pk_mul_f32 v[214:215], v[214:215], v[60:61] op_sel:[0,1] op_sel_hi:[1,1]
    v_cvt_pk_bf16_f32 v190, v212, v213
    v_cvt_pk_bf16_f32 v191, v214, v215
    s_add_u32 s37, s55, 12288
    buffer_store_dwordx4 v[188:191], v252, s[28:31], s37 offen offset:3072
    s_waitcnt lgkmcnt(14)
    v_mfma_f32_16x16x32_bf16 v[96:99], a[208:211], v[128:131], 0
    s_waitcnt lgkmcnt(12)
    ds_read_b64_tr_b16 a[160:161], v13 offset:0
    v_mfma_f32_16x16x32_bf16 v[96:99], a[212:215], v[144:147], v[96:99]
    s_waitcnt lgkmcnt(11)
    ds_read_b64_tr_b16 a[162:163], v13 offset:4096
    v_mfma_f32_16x16x32_bf16 v[96:99], a[216:219], v[192:195], v[96:99]
    s_waitcnt lgkmcnt(10)
    ds_read_b64_tr_b16 a[164:165], v13 offset:8192
    v_mfma_f32_16x16x32_bf16 v[96:99], a[220:223], v[176:179], v[96:99]
    s_waitcnt lgkmcnt(9)
    ds_read_b64_tr_b16 a[166:167], v13 offset:12288
    v_mfma_f32_16x16x32_bf16 v[96:99], a[224:227], v[136:139], v[96:99]
    s_waitcnt lgkmcnt(8)
    ds_read_b64_tr_b16 a[168:169], v13 offset:16384
    v_mfma_f32_16x16x32_bf16 v[96:99], a[228:231], v[152:155], v[96:99]
    s_waitcnt lgkmcnt(7)
    ds_read_b64_tr_b16 a[170:171], v13 offset:20480
    v_mfma_f32_16x16x32_bf16 v[96:99], a[232:235], v[200:203], v[96:99]
    s_waitcnt lgkmcnt(6)
    ds_read_b64_tr_b16 a[172:173], v13 offset:24576
    v_mfma_f32_16x16x32_bf16 v[96:99], a[236:239], v[184:187], v[96:99]
    ds_read_b64_tr_b16 a[174:175], v13 offset:28672
    v_mfma_f32_16x16x32_bf16 v[100:103], a[236:239], v[188:191], 0
    ds_read_b64_tr_b16 a[176:177], v17 offset:0
    v_mfma_f32_16x16x32_bf16 v[100:103], a[232:235], v[204:207], v[100:103]
    ds_read_b64_tr_b16 a[178:179], v17 offset:4096
    v_mfma_f32_16x16x32_bf16 v[100:103], a[228:231], v[156:159], v[100:103]
    ds_read_b64_tr_b16 a[180:181], v17 offset:8192
    v_mfma_f32_16x16x32_bf16 v[100:103], a[224:227], v[140:143], v[100:103]
    ds_read_b64_tr_b16 a[182:183], v17 offset:12288
    v_mfma_f32_16x16x32_bf16 v[100:103], a[220:223], v[180:183], v[100:103]
    ds_read_b64_tr_b16 a[184:185], v17 offset:16384
    v_cvt_pk_bf16_f32 v224, v96, v97
    v_mfma_f32_16x16x32_bf16 v[100:103], a[216:219], v[196:199], v[100:103]
    ds_read_b64_tr_b16 a[186:187], v17 offset:20480
    v_cvt_pk_bf16_f32 v225, v98, v99
    v_mfma_f32_16x16x32_bf16 v[100:103], a[212:215], v[148:151], v[100:103]
    ds_read_b64_tr_b16 a[188:189], v17 offset:24576
    v_mfma_f32_16x16x32_bf16 v[100:103], a[208:211], v[132:135], v[100:103]
    s_waitcnt lgkmcnt(13)
    ds_read_b64_tr_b16 a[190:191], v17 offset:28672
    v_mfma_f32_16x16x32_bf16 v[104:107], a[160:163], v[128:131], 0
    s_waitcnt lgkmcnt(12)
    ds_read_b64_tr_b16 a[208:209], v14 offset:0
    v_mfma_f32_16x16x32_bf16 v[104:107], a[164:167], v[144:147], v[104:107]
    s_waitcnt lgkmcnt(11)
    ds_read_b64_tr_b16 a[210:211], v14 offset:4096
    v_mfma_f32_16x16x32_bf16 v[104:107], a[168:171], v[192:195], v[104:107]
    s_waitcnt lgkmcnt(10)
    ds_read_b64_tr_b16 a[212:213], v14 offset:8192
    v_mfma_f32_16x16x32_bf16 v[104:107], a[172:175], v[176:179], v[104:107]
    s_waitcnt lgkmcnt(9)
    ds_read_b64_tr_b16 a[214:215], v14 offset:12288
    v_mfma_f32_16x16x32_bf16 v[104:107], a[176:179], v[136:139], v[104:107]
    s_waitcnt lgkmcnt(8)
    ds_read_b64_tr_b16 a[216:217], v14 offset:16384
    v_cvt_pk_bf16_f32 v228, v100, v101
    v_mfma_f32_16x16x32_bf16 v[104:107], a[180:183], v[152:155], v[104:107]
    s_waitcnt lgkmcnt(7)
    ds_read_b64_tr_b16 a[218:219], v14 offset:20480
    v_cvt_pk_bf16_f32 v229, v102, v103
    v_mfma_f32_16x16x32_bf16 v[104:107], a[184:187], v[200:203], v[104:107]
    s_waitcnt lgkmcnt(6)
    ds_read_b64_tr_b16 a[220:221], v14 offset:24576
    v_mfma_f32_16x16x32_bf16 v[104:107], a[188:191], v[184:187], v[104:107]
    ds_read_b64_tr_b16 a[222:223], v14 offset:28672
    s_waitcnt vmcnt(0)
    s_cmp_eq_u32 s53, 0
    s_cbranch_scc1 Lattn_wb
Lattn_wbdone:
    v_mfma_f32_16x16x32_bf16 v[108:111], a[188:191], v[188:191], 0
    buffer_store_dword v10, v8, s[24:27], s92 offen offset:8 sc1
    v_mfma_f32_16x16x32_bf16 v[108:111], a[184:187], v[204:207], v[108:111]
    s_xor_b32 s55, s55, 65536
    ds_read_b64_tr_b16 a[224:225], v18 offset:0
    ds_read_b64_tr_b16 a[226:227], v18 offset:4096
    v_mfma_f32_16x16x32_bf16 v[108:111], a[180:183], v[156:159], v[108:111]
    buffer_atomic_add v241, v240, s[88:91], 0 offen sc1
    v_mfma_f32_16x16x32_bf16 v[108:111], a[176:179], v[140:143], v[108:111]
    ds_read_b64_tr_b16 a[228:229], v18 offset:8192
    ds_read_b64_tr_b16 a[230:231], v18 offset:12288
    s_load_dwordx2 s[12:13], s[0:1], 0
    v_mfma_f32_16x16x32_bf16 v[108:111], a[172:175], v[180:183], v[108:111]
    ds_read_b64_tr_b16 a[232:233], v18 offset:16384
    v_cvt_pk_bf16_f32 v226, v104, v105
    v_mfma_f32_16x16x32_bf16 v[108:111], a[168:171], v[196:199], v[108:111]
    s_add_u32 s38, s56, 16384
    ds_read_b64_tr_b16 a[234:235], v18 offset:20480
    v_cvt_pk_bf16_f32 v227, v106, v107
    s_load_dwordx2 s[16:17], s[0:1], 96
    v_mfma_f32_16x16x32_bf16 v[108:111], a[164:167], v[148:151], v[108:111]
    buffer_store_dwordx4 v[224:227], v56, s[28:31], s38 offen sc1
    v_mfma_f32_16x16x32_bf16 v[108:111], a[160:163], v[132:135], v[108:111]
    s_waitcnt lgkmcnt(12)
    ds_read_b64_tr_b16 a[236:237], v18 offset:24576
    ds_read_b64_tr_b16 a[238:239], v18 offset:28672
    s_load_dwordx2 s[52:53], s[0:1], 48
    v_mfma_f32_16x16x32_bf16 v[112:115], a[208:211], v[128:131], 0
    s_waitcnt lgkmcnt(12)
    ds_read_b64_tr_b16 a[160:161], v15 offset:0
    v_mfma_f32_16x16x32_bf16 v[112:115], a[212:215], v[144:147], v[112:115]
    s_waitcnt lgkmcnt(11)
    ds_read_b64_tr_b16 a[162:163], v15 offset:4096
    v_mfma_f32_16x16x32_bf16 v[112:115], a[216:219], v[192:195], v[112:115]
    s_waitcnt lgkmcnt(10)
    ds_read_b64_tr_b16 a[164:165], v15 offset:8192
    v_mfma_f32_16x16x32_bf16 v[112:115], a[220:223], v[176:179], v[112:115]
    s_waitcnt lgkmcnt(9)
    ds_read_b64_tr_b16 a[166:167], v15 offset:12288
    v_mfma_f32_16x16x32_bf16 v[112:115], a[224:227], v[136:139], v[112:115]
    s_waitcnt lgkmcnt(8)
    ds_read_b64_tr_b16 a[168:169], v15 offset:16384
    v_cvt_pk_bf16_f32 v230, v108, v109
    v_mfma_f32_16x16x32_bf16 v[112:115], a[228:231], v[152:155], v[112:115]
    s_waitcnt lgkmcnt(7)
    s_add_u32 s38, s56, 180224
    ds_read_b64_tr_b16 a[170:171], v15 offset:20480
    v_cvt_pk_bf16_f32 v231, v110, v111
    v_mfma_f32_16x16x32_bf16 v[112:115], a[232:235], v[200:203], v[112:115]
    s_waitcnt lgkmcnt(6)
    buffer_store_dwordx4 v[228:231], v56, s[28:31], s38 offen sc1
    v_mfma_f32_16x16x32_bf16 v[112:115], a[236:239], v[184:187], v[112:115]
    ds_read_b64_tr_b16 a[172:173], v15 offset:24576
    ds_read_b64_tr_b16 a[174:175], v15 offset:28672
    v_mfma_f32_16x16x32_bf16 v[116:119], a[236:239], v[188:191], 0
    ds_read_b64_tr_b16 a[176:177], v19 offset:0
    v_mfma_f32_16x16x32_bf16 v[116:119], a[232:235], v[204:207], v[116:119]
    ds_read_b64_tr_b16 a[178:179], v19 offset:4096
    v_mfma_f32_16x16x32_bf16 v[116:119], a[228:231], v[156:159], v[116:119]
    ds_read_b64_tr_b16 a[180:181], v19 offset:8192
    v_mfma_f32_16x16x32_bf16 v[116:119], a[224:227], v[140:143], v[116:119]
    ds_read_b64_tr_b16 a[182:183], v19 offset:12288
    v_mfma_f32_16x16x32_bf16 v[116:119], a[220:223], v[180:183], v[116:119]
    ds_read_b64_tr_b16 a[184:185], v19 offset:16384
    v_cvt_pk_bf16_f32 v232, v112, v113
    v_mfma_f32_16x16x32_bf16 v[116:119], a[216:219], v[196:199], v[116:119]
    ds_read_b64_tr_b16 a[186:187], v19 offset:20480
    v_cvt_pk_bf16_f32 v233, v114, v115
    v_mfma_f32_16x16x32_bf16 v[116:119], a[212:215], v[148:151], v[116:119]
    ds_read_b64_tr_b16 a[188:189], v19 offset:24576
    v_mfma_f32_16x16x32_bf16 v[116:119], a[208:211], v[132:135], v[116:119]
    s_waitcnt lgkmcnt(13)
    ds_read_b64_tr_b16 a[190:191], v19 offset:28672
    s_barrier
    v_mfma_f32_16x16x32_bf16 v[120:123], a[160:163], v[128:131], 0
    s_waitcnt lgkmcnt(12)
    buffer_load_dword v11, v8, s[24:27], s54 offen offset:8 sc1
    v_mfma_f32_16x16x32_bf16 v[120:123], a[164:167], v[144:147], v[120:123]
    s_waitcnt lgkmcnt(10)
    ds_read_b64_tr_b16 a[208:209], v20 offset:0
    ds_read_b64_tr_b16 a[210:211], v20 offset:4096
    v_mfma_f32_16x16x32_bf16 v[120:123], a[168:171], v[192:195], v[120:123]
    s_waitcnt lgkmcnt(10)
    ds_read_b64_tr_b16 a[212:213], v20 offset:8192
    v_mfma_f32_16x16x32_bf16 v[120:123], a[172:175], v[176:179], v[120:123]
    s_waitcnt lgkmcnt(9)
    ds_read_b64_tr_b16 a[214:215], v20 offset:12288
    v_mfma_f32_16x16x32_bf16 v[120:123], a[176:179], v[136:139], v[120:123]
    s_waitcnt lgkmcnt(8)
    ds_read_b64_tr_b16 a[216:217], v20 offset:16384
    v_cvt_pk_bf16_f32 v236, v116, v117
    v_mfma_f32_16x16x32_bf16 v[120:123], a[180:183], v[152:155], v[120:123]
    s_waitcnt lgkmcnt(7)
    ds_read_b64_tr_b16 a[218:219], v20 offset:20480
    v_cvt_pk_bf16_f32 v237, v118, v119
    v_mfma_f32_16x16x32_bf16 v[120:123], a[184:187], v[200:203], v[120:123]
    s_waitcnt lgkmcnt(6)
    s_add_u32 s49, s46, 73728
    ds_read_b64_tr_b16 a[220:221], v20 offset:24576
    v_mfma_f32_16x16x32_bf16 v[120:123], a[188:191], v[184:187], v[120:123]
    s_add_u32 m0, s42, 114688
    ds_read_b64_tr_b16 a[222:223], v20 offset:28672
    v_mfma_f32_16x16x32_bf16 v[124:127], a[188:191], v[188:191], 0
    buffer_load_dwordx4 v46, s[20:23], s49 offen lds
    v_mfma_f32_16x16x32_bf16 v[124:127], a[184:187], v[204:207], v[124:127]
    ds_read_b64_tr_b16 a[224:225], v24 offset:0
    ds_read_b64_tr_b16 a[226:227], v24 offset:4096
    v_mfma_f32_16x16x32_bf16 v[124:127], a[180:183], v[156:159], v[124:127]
    buffer_load_dwordx4 v47, s[20:23], s49 offen offset:1024 lds
    v_mfma_f32_16x16x32_bf16 v[124:127], a[176:179], v[140:143], v[124:127]
    ds_read_b64_tr_b16 a[228:229], v24 offset:8192
    ds_read_b64_tr_b16 a[230:231], v24 offset:12288
    v_mfma_f32_16x16x32_bf16 v[124:127], a[172:175], v[180:183], v[124:127]
    ds_read_b64_tr_b16 a[232:233], v24 offset:16384
    v_cvt_pk_bf16_f32 v234, v120, v121
    v_mfma_f32_16x16x32_bf16 v[124:127], a[168:171], v[196:199], v[124:127]
    s_add_u32 s38, s56, 16512
    ds_read_b64_tr_b16 a[234:235], v24 offset:20480
    v_cvt_pk_bf16_f32 v235, v122, v123
    v_mfma_f32_16x16x32_bf16 v[124:127], a[164:167], v[148:151], v[124:127]
    buffer_store_dwordx4 v[232:235], v56, s[28:31], s38 offen sc1
    v_mfma_f32_16x16x32_bf16 v[124:127], a[160:163], v[132:135], v[124:127]
    s_waitcnt lgkmcnt(12)
    ds_read_b64_tr_b16 a[236:237], v24 offset:24576
    ds_read_b64_tr_b16 a[238:239], v24 offset:28672
    v_mfma_f32_16x16x32_bf16 v[64:67], a[208:211], v[128:131], 0
    s_waitcnt lgkmcnt(12)
    buffer_load_dwordx4 v48, s[20:23], s49 offen offset:2048 lds
    v_mfma_f32_16x16x32_bf16 v[64:67], a[212:215], v[144:147], v[64:67]
    s_waitcnt lgkmcnt(10)
    ds_read_b64_tr_b16 a[160:161], v21 offset:0
    ds_read_b64_tr_b16 a[162:163], v21 offset:4096
    v_mfma_f32_16x16x32_bf16 v[64:67], a[216:219], v[192:195], v[64:67]
    s_waitcnt lgkmcnt(10)
    buffer_load_dwordx4 v49, s[20:23], s49 offen offset:3072 lds
    v_mfma_f32_16x16x32_bf16 v[64:67], a[220:223], v[176:179], v[64:67]
    s_waitcnt lgkmcnt(8)
    ds_read_b64_tr_b16 a[164:165], v21 offset:8192
    ds_read_b64_tr_b16 a[166:167], v21 offset:12288
    v_mfma_f32_16x16x32_bf16 v[64:67], a[224:227], v[136:139], v[64:67]
    s_waitcnt lgkmcnt(8)
    ds_read_b64_tr_b16 a[168:169], v21 offset:16384
    v_cvt_pk_bf16_f32 v238, v124, v125
    v_mfma_f32_16x16x32_bf16 v[64:67], a[228:231], v[152:155], v[64:67]
    s_waitcnt lgkmcnt(7)
    s_add_u32 s38, s56, 180352
    ds_read_b64_tr_b16 a[170:171], v21 offset:20480
    v_cvt_pk_bf16_f32 v239, v126, v127
    v_mfma_f32_16x16x32_bf16 v[64:67], a[232:235], v[200:203], v[64:67]
    s_waitcnt lgkmcnt(6)
    buffer_store_dwordx4 v[236:239], v56, s[28:31], s38 offen sc1
    v_mfma_f32_16x16x32_bf16 v[64:67], a[236:239], v[184:187], v[64:67]
    ds_read_b64_tr_b16 a[172:173], v21 offset:24576
    ds_read_b64_tr_b16 a[174:175], v21 offset:28672
    v_mfma_f32_16x16x32_bf16 v[68:71], a[236:239], v[188:191], 0
    s_lshl_b32 s40, s5, 4
    ds_read_b64_tr_b16 a[176:177], v25 offset:0
    v_mfma_f32_16x16x32_bf16 v[68:71], a[232:235], v[204:207], v[68:71]
    s_add_u32 s40, s40, s4
    ds_read_b64_tr_b16 a[178:179], v25 offset:4096
    v_and_b32 v240, 31, v1
    v_mfma_f32_16x16x32_bf16 v[68:71], a[228:231], v[156:159], v[68:71]
    ds_read_b64_tr_b16 a[180:181], v25 offset:8192
    v_lshrrev_b32 v241, 5, v1
    v_mfma_f32_16x16x32_bf16 v[68:71], a[224:227], v[140:143], v[68:71]
    ds_read_b64_tr_b16 a[182:183], v25 offset:12288
    v_cmp_gt_u32 vcc, 8, v240
    v_mfma_f32_16x16x32_bf16 v[68:71], a[220:223], v[180:183], v[68:71]
    ds_read_b64_tr_b16 a[184:185], v25 offset:16384
    v_mov_b32 v242, 2147483648
    v_mfma_f32_16x16x32_bf16 v[68:71], a[216:219], v[196:199], v[68:71]
    s_lshl_b32 s43, s40, 3
    ds_read_b64_tr_b16 a[186:187], v25 offset:20480
    v_mfma_f32_16x16x32_bf16 v[68:71], a[212:215], v[148:151], v[68:71]
    s_lshl_b32 s44, s3, 1
    ds_read_b64_tr_b16 a[188:189], v25 offset:24576
    v_mfma_f32_16x16x32_bf16 v[68:71], a[208:211], v[132:135], v[68:71]
    s_waitcnt lgkmcnt(13)
    s_add_u32 s43, s43, s44
    ds_read_b64_tr_b16 a[190:191], v25 offset:28672
    v_cndmask_b32 v242, v242, 0, vcc
    v_mfma_f32_16x16x32_bf16 v[72:75], a[160:163], v[128:131], 0
    s_waitcnt lgkmcnt(12)
    ds_read_b64_tr_b16 a[208:209], v22 offset:0
    v_add_u32 v7, s43, v241
    v_mfma_f32_16x16x32_bf16 v[72:75], a[164:167], v[144:147], v[72:75]
    s_waitcnt lgkmcnt(11)
    ds_read_b64_tr_b16 a[210:211], v22 offset:4096
    v_lshlrev_b32 v5, 4, v240
    v_mfma_f32_16x16x32_bf16 v[72:75], a[168:171], v[192:195], v[72:75]
    s_waitcnt lgkmcnt(10)
    ds_read_b64_tr_b16 a[212:213], v22 offset:8192
    v_lshlrev_b32 v243, 4, v241
    v_mfma_f32_16x16x32_bf16 v[72:75], a[172:175], v[176:179], v[72:75]
    s_waitcnt lgkmcnt(9)
    ds_read_b64_tr_b16 a[214:215], v22 offset:12288
    v_lshl_add_u32 v2, v240, 5, v243
    v_mfma_f32_16x16x32_bf16 v[72:75], a[176:179], v[136:139], v[72:75]
    s_waitcnt lgkmcnt(8)
    ds_read_b64_tr_b16 a[216:217], v22 offset:16384
    v_lshrrev_b32 v243, 4, v240
    v_mfma_f32_16x16x32_bf16 v[72:75], a[180:183], v[152:155], v[72:75]
    s_waitcnt lgkmcnt(7)
    ds_read_b64_tr_b16 a[218:219], v22 offset:20480
    v_mul_u32_u24 v243, 1536, v243
    v_mfma_f32_16x16x32_bf16 v[72:75], a[184:187], v[200:203], v[72:75]
    s_waitcnt lgkmcnt(6)
    ds_read_b64_tr_b16 a[220:221], v22 offset:24576
    v_add_u32 v2, v2, v243
    v_mfma_f32_16x16x32_bf16 v[72:75], a[188:191], v[184:187], v[72:75]
    s_mul_i32 s44, s43, 10240
    ds_read_b64_tr_b16 a[222:223], v22 offset:28672
    v_lshrrev_b32 v243, 2, v240
    v_mfma_f32_16x16x32_bf16 v[76:79], a[188:191], v[188:191], 0
    ds_read_b64_tr_b16 a[224:225], v26 offset:0
    v_lshlrev_b32 v243, 6, v243
    v_mfma_f32_16x16x32_bf16 v[76:79], a[184:187], v[204:207], v[76:79]
    ds_read_b64_tr_b16 a[226:227], v26 offset:4096
    v_and_b32 v241, 3, v240
    v_mfma_f32_16x16x32_bf16 v[76:79], a[180:183], v[156:159], v[76:79]
    ds_read_b64_tr_b16 a[228:229], v26 offset:8192
    v_lshl_add_u32 v3, v241, 3, v243
    v_mfma_f32_16x16x32_bf16 v[76:79], a[176:179], v[140:143], v[76:79]
    ds_read_b64_tr_b16 a[230:231], v26 offset:12288
    v_mul_u32_u24 v243, 1152, v7
    v_mfma_f32_16x16x32_bf16 v[76:79], a[172:175], v[180:183], v[76:79]
    ds_read_b64_tr_b16 a[232:233], v26 offset:16384
    v_add_u32 v4, v243, v3
    v_mfma_f32_16x16x32_bf16 v[76:79], a[168:171], v[196:199], v[76:79]
    ds_read_b64_tr_b16 a[234:235], v26 offset:20480
    v_lshl_add_u32 v6, v243, 1, v5
    v_mfma_f32_16x16x32_bf16 v[76:79], a[164:167], v[148:151], v[76:79]
    ds_read_b64_tr_b16 a[236:237], v26 offset:24576
    v_or_b32 v55, v3, v242
    v_mfma_f32_16x16x32_bf16 v[76:79], a[160:163], v[132:135], v[76:79]
    s_waitcnt lgkmcnt(13)
    ds_read_b64_tr_b16 a[238:239], v26 offset:28672
    v_or_b32 v58, v4, v242
    v_mfma_f32_16x16x32_bf16 v[80:83], a[208:211], v[128:131], 0
    s_waitcnt lgkmcnt(12)
    ds_read_b64_tr_b16 a[160:161], v23 offset:0
    v_or_b32 v59, v5, v242
    v_mfma_f32_16x16x32_bf16 v[80:83], a[212:215], v[144:147], v[80:83]
    s_waitcnt lgkmcnt(11)
    ds_read_b64_tr_b16 a[162:163], v23 offset:4096
    v_or_b32 v60, v6, v242
    v_mfma_f32_16x16x32_bf16 v[80:83], a[216:219], v[192:195], v[80:83]
    s_waitcnt lgkmcnt(10)
    ds_read_b64_tr_b16 a[164:165], v23 offset:8192
    s_waitcnt vmcnt(6)
    v_readfirstlane_b32 s36, v11
    v_mfma_f32_16x16x32_bf16 v[80:83], a[220:223], v[176:179], v[80:83]
    s_waitcnt lgkmcnt(9)
    ds_read_b64_tr_b16 a[166:167], v23 offset:12288
    v_lshrrev_b32 v243, 4, v1
    v_mfma_f32_16x16x32_bf16 v[80:83], a[224:227], v[136:139], v[80:83]
    ds_read_b64_tr_b16 a[168:169], v23 offset:16384
    v_lshlrev_b32 v243, 8, v243
    s_cmp_lg_u32 s36, s95
    s_cbranch_scc1 Lattn_xspin
Lattn_xgot:
    s_waitcnt lgkmcnt(9)
    v_mfma_f32_16x16x32_bf16 v[80:83], a[228:231], v[152:155], v[80:83]
    s_waitcnt lgkmcnt(7)
    ds_read_b64_tr_b16 a[170:171], v23 offset:20480
    v_and_b32 v241, 7, v1
    v_mfma_f32_16x16x32_bf16 v[80:83], a[232:235], v[200:203], v[80:83]
    s_waitcnt lgkmcnt(6)
    ds_read_b64_tr_b16 a[172:173], v23 offset:24576
    v_lshl_add_u32 v243, v241, 5, v243
    v_mfma_f32_16x16x32_bf16 v[80:83], a[236:239], v[184:187], v[80:83]
    s_add_u32 s37, s55, 0
    ds_read_b64_tr_b16 a[174:175], v23 offset:28672
    v_and_b32 v241, 8, v1
    v_mfma_f32_16x16x32_bf16 v[84:87], a[236:239], v[188:191], 0
    buffer_load_dwordx4 a[64:67], v252, s[28:31], s37 offen offset:0 sc1
    v_mfma_f32_16x16x32_bf16 v[84:87], a[232:235], v[204:207], v[84:87]
    ds_read_b64_tr_b16 a[176:177], v27 offset:0
    ds_read_b64_tr_b16 a[178:179], v27 offset:4096
    v_mfma_f32_16x16x32_bf16 v[84:87], a[228:231], v[156:159], v[84:87]
    buffer_load_dwordx4 a[68:71], v252, s[28:31], s37 offen offset:1024 sc1
    v_mfma_f32_16x16x32_bf16 v[84:87], a[224:227], v[140:143], v[84:87]
    ds_read_b64_tr_b16 a[180:181], v27 offset:8192
    ds_read_b64_tr_b16 a[182:183], v27 offset:12288
    v_mfma_f32_16x16x32_bf16 v[84:87], a[220:223], v[180:183], v[84:87]
    ds_read_b64_tr_b16 a[184:185], v27 offset:16384
    v_lshl_add_u32 v54, v241, 1, v243
    v_mfma_f32_16x16x32_bf16 v[84:87], a[216:219], v[196:199], v[84:87]
    s_lshr_b32 s41, s2, 3
    ds_read_b64_tr_b16 a[186:187], v27 offset:20480
    v_mfma_f32_16x16x32_bf16 v[84:87], a[212:215], v[148:151], v[84:87]
    buffer_load_dwordx4 a[72:75], v252, s[28:31], s37 offen offset:2048 sc1
    v_mfma_f32_16x16x32_bf16 v[84:87], a[208:211], v[132:135], v[84:87]
    s_waitcnt lgkmcnt(12)
    s_mov_b32 s14, 2359296
    ds_read_b64_tr_b16 a[188:189], v27 offset:24576
    ds_read_b64_tr_b16 a[190:191], v27 offset:28672
    s_barrier
    v_mfma_f32_16x16x32_bf16 v[88:91], a[160:163], v[128:131], 0
    s_waitcnt lgkmcnt(12)
    s_mov_b32 s15, 0x20000
    ds_read_b64_tr_b16 a[208:209], v12 offset:32768
    v_mfma_f32_16x16x32_bf16 v[88:91], a[164:167], v[144:147], v[88:91]
    s_waitcnt lgkmcnt(11)
    s_mov_b32 s18, 2359296
    ds_read_b64_tr_b16 a[210:211], v12 offset:36864
    v_mfma_f32_16x16x32_bf16 v[88:91], a[168:171], v[192:195], v[88:91]
    s_waitcnt lgkmcnt(10)
    buffer_load_dwordx4 a[76:79], v252, s[28:31], s37 offen offset:3072 sc1
    v_mfma_f32_16x16x32_bf16 v[88:91], a[172:175], v[176:179], v[88:91]
    s_waitcnt lgkmcnt(8)
    s_mov_b32 s19, 0x20000
    ds_read_b64_tr_b16 a[212:213], v12 offset:40960
    ds_read_b64_tr_b16 a[214:215], v12 offset:45056
    v_mfma_f32_16x16x32_bf16 v[88:91], a[176:179], v[136:139], v[88:91]
    s_waitcnt lgkmcnt(8)
    s_add_u32 s8, s50, 7864320
    s_addc_u32 s9, s51, 0
    ds_read_b64_tr_b16 a[216:217], v12 offset:49152
    v_mfma_f32_16x16x32_bf16 v[88:91], a[180:183], v[152:155], v[88:91]
    s_waitcnt lgkmcnt(7)
    s_add_u32 s37, s55, 4096
    ds_read_b64_tr_b16 a[218:219], v12 offset:53248
    v_mfma_f32_16x16x32_bf16 v[88:91], a[184:187], v[200:203], v[88:91]
    s_waitcnt lgkmcnt(6)
    s_add_u32 s49, s46, 256
    buffer_load_dwordx4 a[80:83], v252, s[28:31], s37 offen offset:0 sc1
    v_mfma_f32_16x16x32_bf16 v[88:91], a[188:191], v[184:187], v[88:91]
    s_add_u32 m0, s42, 0
    ds_read_b64_tr_b16 a[220:221], v12 offset:57344
    ds_read_b64_tr_b16 a[222:223], v12 offset:61440
    v_mfma_f32_16x16x32_bf16 v[92:95], a[188:191], v[188:191], 0
    buffer_load_dwordx4 v46, s[20:23], s49 offen lds
    v_mfma_f32_16x16x32_bf16 v[92:95], a[184:187], v[204:207], v[92:95]
    s_mov_b32 s10, 663552
    ds_read_b64_tr_b16 a[224:225], v16 offset:32768
    ds_read_b64_tr_b16 a[226:227], v16 offset:36864
    v_mfma_f32_16x16x32_bf16 v[92:95], a[180:183], v[156:159], v[92:95]
    buffer_load_dwordx4 v47, s[20:23], s49 offen offset:1024 lds
    v_mfma_f32_16x16x32_bf16 v[92:95], a[176:179], v[140:143], v[92:95]
    s_mov_b32 s11, 0x20000
    ds_read_b64_tr_b16 a[228:229], v16 offset:40960
    ds_read_b64_tr_b16 a[230:231], v16 offset:45056
    v_mfma_f32_16x16x32_bf16 v[92:95], a[172:175], v[180:183], v[92:95]
    buffer_load_dwordx4 a[84:87], v252, s[28:31], s37 offen offset:1024 sc1
    v_mfma_f32_16x16x32_bf16 v[92:95], a[168:171], v[196:199], v[92:95]
    s_lshl_b32 s39, s5, 13
    ds_read_b64_tr_b16 a[232:233], v16 offset:49152
    ds_read_b64_tr_b16 a[234:235], v16 offset:53248
    v_mfma_f32_16x16x32_bf16 v[92:95], a[164:167], v[148:151], v[92:95]
    s_add_u32 s39, s39, 8781824
    ds_read_b64_tr_b16 a[236:237], v16 offset:57344
    v_mfma_f32_16x16x32_bf16 v[92:95], a[160:163], v[132:135], v[92:95]
    s_waitcnt lgkmcnt(13)
    s_lshr_b32 s45, s4, 2
    ds_read_b64_tr_b16 a[238:239], v16 offset:61440
    v_mfma_f32_16x16x32_bf16 v[96:99], a[208:211], v[128:131], 0
    s_waitcnt lgkmcnt(12)
    buffer_load_dwordx4 v48, s[20:23], s49 offen offset:2048 lds
    v_mfma_f32_16x16x32_bf16 v[96:99], a[212:215], v[144:147], v[96:99]
    s_waitcnt lgkmcnt(10)
    s_lshl_b32 s45, s45, 11
    ds_read_b64_tr_b16 a[160:161], v13 offset:32768
    ds_read_b64_tr_b16 a[162:163], v13 offset:36864
    v_mfma_f32_16x16x32_bf16 v[96:99], a[216:219], v[192:195], v[96:99]
    s_waitcnt lgkmcnt(10)
    buffer_load_dwordx4 v49, s[20:23], s49 offen offset:3072 lds
    v_mfma_f32_16x16x32_bf16 v[96:99], a[220:223], v[176:179], v[96:99]
    s_waitcnt lgkmcnt(8)
    s_add_u32 s39, s39, s45
    ds_read_b64_tr_b16 a[164:165], v13 offset:40960
    ds_read_b64_tr_b16 a[166:167], v13 offset:45056
    v_mfma_f32_16x16x32_bf16 v[96:99], a[224:227], v[136:139], v[96:99]
    s_waitcnt lgkmcnt(8)
    buffer_load_dwordx4 a[88:91], v252, s[28:31], s37 offen offset:2048 sc1
    v_mfma_f32_16x16x32_bf16 v[96:99], a[228:231], v[152:155], v[96:99]
    s_waitcnt lgkmcnt(6)
    ds_read_b64_tr_b16 a[168:169], v13 offset:49152
    ds_read_b64_tr_b16 a[170:171], v13 offset:53248
    v_mfma_f32_16x16x32_bf16 v[96:99], a[232:235], v[200:203], v[96:99]
    s_waitcnt lgkmcnt(6)
    s_add_u32 s49, s46, 73984
    ds_read_b64_tr_b16 a[172:173], v13 offset:57344
    v_and_b32 v9, 15, v1
    v_mfma_f32_16x16x32_bf16 v[96:99], a[236:239], v[184:187], v[96:99]
    s_add_u32 m0, s42, 16384
    ds_read_b64_tr_b16 a[174:175], v13 offset:61440
    v_lshlrev_b32 v9, 7, v9
    v_mfma_f32_16x16x32_bf16 v[100:103], a[236:239], v[188:191], 0
    buffer_load_dwordx4 v46, s[20:23], s49 offen lds
    v_mfma_f32_16x16x32_bf16 v[100:103], a[232:235], v[204:207], v[100:103]
    ds_read_b64_tr_b16 a[176:177], v17 offset:32768
    ds_read_b64_tr_b16 a[178:179], v17 offset:36864
    v_mfma_f32_16x16x32_bf16 v[100:103], a[228:231], v[156:159], v[100:103]
    buffer_load_dwordx4 v47, s[20:23], s49 offen offset:1024 lds
    v_mfma_f32_16x16x32_bf16 v[100:103], a[224:227], v[140:143], v[100:103]
    ds_read_b64_tr_b16 a[180:181], v17 offset:40960
    ds_read_b64_tr_b16 a[182:183], v17 offset:45056
    v_mfma_f32_16x16x32_bf16 v[100:103], a[220:223], v[180:183], v[100:103]
    buffer_load_dwordx4 a[92:95], v252, s[28:31], s37 offen offset:3072 sc1
    v_mfma_f32_16x16x32_bf16 v[100:103], a[216:219], v[196:199], v[100:103]
    ds_read_b64_tr_b16 a[184:185], v17 offset:49152
    ds_read_b64_tr_b16 a[186:187], v17 offset:53248
    v_mfma_f32_16x16x32_bf16 v[100:103], a[212:215], v[148:151], v[100:103]
    ds_read_b64_tr_b16 a[188:189], v17 offset:57344
    v_mfma_f32_16x16x32_bf16 v[100:103], a[208:211], v[132:135], v[100:103]
    s_waitcnt lgkmcnt(13)
    ds_read_b64_tr_b16 a[190:191], v17 offset:61440
    v_mfma_f32_16x16x32_bf16 v[104:107], a[160:163], v[128:131], 0
    s_waitcnt lgkmcnt(12)
    buffer_load_dwordx4 v48, s[20:23], s49 offen offset:2048 lds
    v_mfma_f32_16x16x32_bf16 v[104:107], a[164:167], v[144:147], v[104:107]
    s_waitcnt lgkmcnt(10)
    ds_read_b64_tr_b16 a[208:209], v14 offset:32768
    ds_read_b64_tr_b16 a[210:211], v14 offset:36864
    v_mfma_f32_16x16x32_bf16 v[104:107], a[168:171], v[192:195], v[104:107]
    s_waitcnt lgkmcnt(10)
    buffer_load_dwordx4 v49, s[20:23], s49 offen offset:3072 lds
    v_mfma_f32_16x16x32_bf16 v[104:107], a[172:175], v[176:179], v[104:107]
    s_waitcnt lgkmcnt(8)
    s_add_u32 s37, s55, 8192
    ds_read_b64_tr_b16 a[212:213], v14 offset:40960
    ds_read_b64_tr_b16 a[214:215], v14 offset:45056
    v_mfma_f32_16x16x32_bf16 v[104:107], a[176:179], v[136:139], v[104:107]
    s_waitcnt lgkmcnt(8)
    buffer_load_dwordx4 a[96:99], v252, s[28:31], s37 offen offset:0 sc1
    v_mfma_f32_16x16x32_bf16 v[104:107], a[180:183], v[152:155], v[104:107]
    s_waitcnt lgkmcnt(6)
    ds_read_b64_tr_b16 a[216:217], v14 offset:49152
    ds_read_b64_tr_b16 a[218:219], v14 offset:53248
    v_mfma_f32_16x16x32_bf16 v[104:107], a[184:187], v[200:203], v[104:107]
    s_waitcnt lgkmcnt(6)
    buffer_load_dwordx4 a[100:103], v252, s[28:31], s37 offen offset:1024 sc1
    v_mfma_f32_16x16x32_bf16 v[104:107], a[188:191], v[184:187], v[104:107]
Ltour0_9:
    s_cbranch_execz Lmain0
    ds_read_b64_tr_b16 a[220:221], v14 offset:57344
    ds_read_b64_tr_b16 a[222:223], v14 offset:61440
    v_mfma_f32_16x16x32_bf16 v[108:111], a[188:191], v[188:191], 0
    ds_read_b64_tr_b16 a[224:225], v18 offset:32768
    v_mfma_f32_16x16x32_bf16 v[108:111], a[184:187], v[204:207], v[108:111]
    ds_read_b64_tr_b16 a[226:227], v18 offset:36864
    v_mfma_f32_16x16x32_bf16 v[108:111], a[180:183], v[156:159], v[108:111]
    buffer_load_dwordx4 a[104:107], v252, s[28:31], s37 offen offset:2048 sc1
    v_mfma_f32_16x16x32_bf16 v[108:111], a[176:179], v[140:143], v[108:111]
    ds_read_b64_tr_b16 a[228:229], v18 offset:40960
    ds_read_b64_tr_b16 a[230:231], v18 offset:45056
    v_mfma_f32_16x16x32_bf16 v[108:111], a[172:175], v[180:183], v[108:111]
    ds_read_b64_tr_b16 a[232:233], v18 offset:49152
    v_mfma_f32_16x16x32_bf16 v[108:111], a[168:171], v[196:199], v[108:111]
    ds_read_b64_tr_b16 a[234:235], v18 offset:53248
    v_mfma_f32_16x16x32_bf16 v[108:111], a[164:167], v[148:151], v[108:111]
    buffer_load_dwordx4 a[108:111], v252, s[28:31], s37 offen offset:3072 sc1
    v_mfma_f32_16x16x32_bf16 v[108:111], a[160:163], v[132:135], v[108:111]
    s_waitcnt lgkmcnt(12)
    ds_read_b64_tr_b16 a[236:237], v18 offset:57344
    ds_read_b64_tr_b16 a[238:239], v18 offset:61440
    v_mfma_f32_16x16x32_bf16 v[112:115], a[208:211], v[128:131], 0
    s_waitcnt lgkmcnt(12)
    ds_read_b64_tr_b16 a[160:161], v15 offset:32768
    v_mfma_f32_16x16x32_bf16 v[112:115], a[212:215], v[144:147], v[112:115]
    s_waitcnt lgkmcnt(11)
    s_add_u32 s37, s55, 12288
    ds_read_b64_tr_b16 a[162:163], v15 offset:36864
    v_mfma_f32_16x16x32_bf16 v[112:115], a[216:219], v[192:195], v[112:115]
    s_waitcnt lgkmcnt(10)
    buffer_load_dwordx4 a[112:115], v252, s[28:31], s37 offen offset:0 sc1
    v_mfma_f32_16x16x32_bf16 v[112:115], a[220:223], v[176:179], v[112:115]
    s_waitcnt lgkmcnt(8)
    ds_read_b64_tr_b16 a[164:165], v15 offset:40960
    ds_read_b64_tr_b16 a[166:167], v15 offset:45056
    v_mfma_f32_16x16x32_bf16 v[112:115], a[224:227], v[136:139], v[112:115]
    s_waitcnt lgkmcnt(8)
    buffer_load_dwordx4 a[116:119], v252, s[28:31], s37 offen offset:1024 sc1
    v_mfma_f32_16x16x32_bf16 v[112:115], a[228:231], v[152:155], v[112:115]
    s_waitcnt lgkmcnt(6)
    ds_read_b64_tr_b16 a[168:169], v15 offset:49152
    ds_read_b64_tr_b16 a[170:171], v15 offset:53248
    v_mfma_f32_16x16x32_bf16 v[112:115], a[232:235], v[200:203], v[112:115]
    s_waitcnt lgkmcnt(6)
    ds_read_b64_tr_b16 a[172:173], v15 offset:57344
    v_mfma_f32_16x16x32_bf16 v[112:115], a[236:239], v[184:187], v[112:115]
    ds_read_b64_tr_b16 a[174:175], v15 offset:61440
    v_mfma_f32_16x16x32_bf16 v[116:119], a[236:239], v[188:191], 0
    buffer_load_dwordx4 a[120:123], v252, s[28:31], s37 offen offset:2048 sc1
    v_mfma_f32_16x16x32_bf16 v[116:119], a[232:235], v[204:207], v[116:119]
    ds_read_b64_tr_b16 a[176:177], v19 offset:32768
    ds_read_b64_tr_b16 a[178:179], v19 offset:36864
    v_mfma_f32_16x16x32_bf16 v[116:119], a[228:231], v[156:159], v[116:119]
    ds_read_b64_tr_b16 a[180:181], v19 offset:40960
    v_mfma_f32_16x16x32_bf16 v[116:119], a[224:227], v[140:143], v[116:119]
    ds_read_b64_tr_b16 a[182:183], v19 offset:45056
    v_mfma_f32_16x16x32_bf16 v[116:119], a[220:223], v[180:183], v[116:119]
    buffer_load_dwordx4 a[124:127], v252, s[28:31], s37 offen offset:3072 sc1
    v_mfma_f32_16x16x32_bf16 v[116:119], a[216:219], v[196:199], v[116:119]
    ds_read_b64_tr_b16 a[184:185], v19 offset:49152
    ds_read_b64_tr_b16 a[186:187], v19 offset:53248
    v_mfma_f32_16x16x32_bf16 v[116:119], a[212:215], v[148:151], v[116:119]
    ds_read_b64_tr_b16 a[188:189], v19 offset:57344
    v_mfma_f32_16x16x32_bf16 v[116:119], a[208:211], v[132:135], v[116:119]
    ds_read_b64_tr_b16 a[190:191], v19 offset:61440
    s_waitcnt vmcnt(25)
    s_waitcnt lgkmcnt(0)
    s_barrier
    v_mfma_f32_16x16x32_bf16 v[120:123], a[160:163], v[128:131], 0
    ds_read_b64_tr_b16 a[208:209], v20 offset:32768
    v_mfma_f32_16x16x32_bf16 v[120:123], a[164:167], v[144:147], v[120:123]
    ds_read_b64_tr_b16 a[210:211], v20 offset:36864
    v_mfma_f32_16x16x32_bf16 v[120:123], a[168:171], v[192:195], v[120:123]
    ds_read_b64_tr_b16 a[212:213], v20 offset:40960
    v_mfma_f32_16x16x32_bf16 v[120:123], a[172:175], v[176:179], v[120:123]
    ds_read_b64_tr_b16 a[214:215], v20 offset:45056
    v_mfma_f32_16x16x32_bf16 v[120:123], a[176:179], v[136:139], v[120:123]
    ds_read_b64_tr_b16 a[216:217], v20 offset:49152
    v_mfma_f32_16x16x32_bf16 v[120:123], a[180:183], v[152:155], v[120:123]
    ds_read_b64_tr_b16 a[218:219], v20 offset:53248
    v_mfma_f32_16x16x32_bf16 v[120:123], a[184:187], v[200:203], v[120:123]
    s_add_u32 s49, s7, 512
    ds_read_b64_tr_b16 a[220:221], v20 offset:57344
    v_mfma_f32_16x16x32_bf16 v[120:123], a[188:191], v[184:187], v[120:123]
    s_add_u32 m0, s42, 65536
    ds_read_b64_tr_b16 a[222:223], v20 offset:61440
    v_mfma_f32_16x16x32_bf16 v[124:127], a[188:191], v[188:191], 0
    buffer_load_dwordx4 v46, s[20:23], s49 offen lds
    v_mfma_f32_16x16x32_bf16 v[124:127], a[184:187], v[204:207], v[124:127]
    ds_read_b64_tr_b16 a[224:225], v24 offset:32768
    ds_read_b64_tr_b16 a[226:227], v24 offset:36864
    v_mfma_f32_16x16x32_bf16 v[124:127], a[180:183], v[156:159], v[124:127]
    buffer_load_dwordx4 v47, s[20:23], s49 offen offset:1024 lds
    v_mfma_f32_16x16x32_bf16 v[124:127], a[176:179], v[140:143], v[124:127]
    ds_read_b64_tr_b16 a[228:229], v24 offset:40960
    ds_read_b64_tr_b16 a[230:231], v24 offset:45056
    v_mfma_f32_16x16x32_bf16 v[124:127], a[172:175], v[180:183], v[124:127]
    ds_read_b64_tr_b16 a[232:233], v24 offset:49152
    v_mfma_f32_16x16x32_bf16 v[124:127], a[168:171], v[196:199], v[124:127]
    ds_read_b64_tr_b16 a[234:235], v24 offset:53248
    v_mfma_f32_16x16x32_bf16 v[124:127], a[164:167], v[148:151], v[124:127]
    ds_read_b64_tr_b16 a[236:237], v24 offset:57344
    v_lshrrev_b32 v240, 4, v1
    v_mfma_f32_16x16x32_bf16 v[124:127], a[160:163], v[132:135], v[124:127]
    s_waitcnt vmcnt(25)
    s_waitcnt lgkmcnt(13)
    ds_read_b64_tr_b16 a[238:239], v24 offset:61440
    v_and_b32 v240, 2, v240
    v_mfma_f32_16x16x32_bf16 v[64:67], a[208:211], a[64:67], v[64:67]
    s_waitcnt vmcnt(24)
    s_waitcnt lgkmcnt(12)
    buffer_load_dwordx4 v48, s[20:23], s49 offen offset:2048 lds
    v_mfma_f32_16x16x32_bf16 v[64:67], a[212:215], a[68:71], v[64:67]
    s_waitcnt vmcnt(24)
    s_waitcnt lgkmcnt(10)
    ds_read_b64_tr_b16 a[160:161], v21 offset:32768
    ds_read_b64_tr_b16 a[162:163], v21 offset:36864
    v_mfma_f32_16x16x32_bf16 v[64:67], a[216:219], a[72:75], v[64:67]
    s_waitcnt vmcnt(23)
    s_waitcnt lgkmcnt(10)
    buffer_load_dwordx4 v49, s[20:23], s49 offen offset:3072 lds
    v_mfma_f32_16x16x32_bf16 v[64:67], a[220:223], a[76:79], v[64:67]
    s_waitcnt vmcnt(23)
    s_waitcnt lgkmcnt(8)
    ds_read_b64_tr_b16 a[164:165], v21 offset:40960
    ds_read_b64_tr_b16 a[166:167], v21 offset:45056
    v_mfma_f32_16x16x32_bf16 v[64:67], a[224:227], a[80:83], v[64:67]
    s_waitcnt vmcnt(20)
    s_waitcnt lgkmcnt(8)
    ds_read_b64_tr_b16 a[168:169], v21 offset:49152
    v_bfe_u32 v241, v1, 2, 2
    v_mfma_f32_16x16x32_bf16 v[64:67], a[228:231], a[84:87], v[64:67]
    s_waitcnt vmcnt(17)
    s_waitcnt lgkmcnt(7)
    ds_read_b64_tr_b16 a[170:171], v21 offset:53248
    v_cmp_eq_u32 s[54:55], v240, v241
    v_mfma_f32_16x16x32_bf16 v[64:67], a[232:235], a[88:91], v[64:67]
    s_waitcnt vmcnt(14)
    s_waitcnt lgkmcnt(6)
    s_add_u32 s49, s7, 74240
    ds_read_b64_tr_b16 a[172:173], v21 offset:57344
    v_or_b32 v240, 1, v240
    v_mfma_f32_16x16x32_bf16 v[64:67], a[236:239], a[92:95], v[64:67]
    s_waitcnt vmcnt(4)
    s_add_u32 m0, s42, 81920
    ds_read_b64_tr_b16 a[174:175], v21 offset:61440
    v_cmp_eq_u32 s[36:37], v240, v241
    v_mfma_f32_16x16x32_bf16 v[68:71], a[236:239], a[124:127], v[68:71]
    buffer_load_dwordx4 v46, s[20:23], s49 offen lds
    v_mfma_f32_16x16x32_bf16 v[68:71], a[232:235], a[120:123], v[68:71]
    ds_read_b64_tr_b16 a[176:177], v25 offset:32768
    ds_read_b64_tr_b16 a[178:179], v25 offset:36864
    v_mfma_f32_16x16x32_bf16 v[68:71], a[228:231], a[116:119], v[68:71]
    buffer_load_dwordx4 v47, s[20:23], s49 offen offset:1024 lds
    v_mfma_f32_16x16x32_bf16 v[68:71], a[224:227], a[112:115], v[68:71]
    ds_read_b64_tr_b16 a[180:181], v25 offset:40960
    ds_read_b64_tr_b16 a[182:183], v25 offset:45056
    v_mfma_f32_16x16x32_bf16 v[68:71], a[220:223], a[108:111], v[68:71]
    ds_read_b64_tr_b16 a[184:185], v25 offset:49152
    v_cvt_pk_bf16_f32 v224, v64, v65
    v_mfma_f32_16x16x32_bf16 v[68:71], a[216:219], a[104:107], v[68:71]
    ds_read_b64_tr_b16 a[186:187], v25 offset:53248
    v_cvt_pk_bf16_f32 v225, v66, v67
    v_mfma_f32_16x16x32_bf16 v[68:71], a[212:215], a[100:103], v[68:71]
    buffer_load_dwordx2 v[36:37], v4, s[12:15], 0 offen offset:0
    v_mfma_f32_16x16x32_bf16 v[68:71], a[208:211], a[96:99], v[68:71]
    s_waitcnt lgkmcnt(12)
    ds_read_b64_tr_b16 a[188:189], v25 offset:57344
    ds_read_b64_tr_b16 a[190:191], v25 offset:61440
    v_mfma_f32_16x16x32_bf16 v[72:75], a[160:163], a[64:67], v[72:75]
    s_waitcnt lgkmcnt(12)
    buffer_load_dwordx4 v48, s[20:23], s49 offen offset:2048 lds
    v_mfma_f32_16x16x32_bf16 v[72:75], a[164:167], a[68:71], v[72:75]
    s_waitcnt lgkmcnt(10)
    ds_read_b64_tr_b16 a[208:209], v22 offset:32768
    ds_read_b64_tr_b16 a[210:211], v22 offset:36864
    v_mfma_f32_16x16x32_bf16 v[72:75], a[168:171], a[72:75], v[72:75]
    s_waitcnt lgkmcnt(10)
    buffer_load_dwordx4 v49, s[20:23], s49 offen offset:3072 lds
    v_mfma_f32_16x16x32_bf16 v[72:75], a[172:175], a[76:79], v[72:75]
    s_waitcnt lgkmcnt(8)
    ds_read_b64_tr_b16 a[212:213], v22 offset:40960
    ds_read_b64_tr_b16 a[214:215], v22 offset:45056
    v_mfma_f32_16x16x32_bf16 v[72:75], a[176:179], a[80:83], v[72:75]
    s_waitcnt lgkmcnt(8)
    ds_read_b64_tr_b16 a[216:217], v22 offset:49152
    v_cvt_pk_bf16_f32 v228, v68, v69
    v_mfma_f32_16x16x32_bf16 v[72:75], a[180:183], a[84:87], v[72:75]
    s_waitcnt lgkmcnt(7)
    ds_read_b64_tr_b16 a[218:219], v22 offset:53248
    v_cvt_pk_bf16_f32 v229, v70, v71
    v_mfma_f32_16x16x32_bf16 v[72:75], a[184:187], a[88:91], v[72:75]
    s_waitcnt lgkmcnt(6)
    ds_read_b64_tr_b16 a[220:221], v22 offset:57344
    v_and_b32 v240, 1, v1
    v_mfma_f32_16x16x32_bf16 v[72:75], a[188:191], a[92:95], v[72:75]
    ds_read_b64_tr_b16 a[222:223], v22 offset:61440
    v_lshlrev_b32 v240, 4, v240
    v_mfma_f32_16x16x32_bf16 v[76:79], a[188:191], a[124:127], v[76:79]
    buffer_load_dwordx2 v[38:39], v4, s[12:15], 0 offen offset:32
    v_mfma_f32_16x16x32_bf16 v[76:79], a[184:187], a[120:123], v[76:79]
    ds_read_b64_tr_b16 a[224:225], v26 offset:32768
    ds_read_b64_tr_b16 a[226:227], v26 offset:36864
    v_mfma_f32_16x16x32_bf16 v[76:79], a[180:183], a[116:119], v[76:79]
    ds_read_b64_tr_b16 a[228:229], v26 offset:40960
    v_mov_b32 v241, 0x3f80
    v_mfma_f32_16x16x32_bf16 v[76:79], a[176:179], a[112:115], v[76:79]
    ds_read_b64_tr_b16 a[230:231], v26 offset:45056
    v_lshlrev_b32 v240, v240, v241
    v_mfma_f32_16x16x32_bf16 v[76:79], a[172:175], a[108:111], v[76:79]
    ds_read_b64_tr_b16 a[232:233], v26 offset:49152
    v_cvt_pk_bf16_f32 v226, v72, v73
    v_mfma_f32_16x16x32_bf16 v[76:79], a[168:171], a[104:107], v[76:79]
    s_add_u32 s38, s93, 0
    ds_read_b64_tr_b16 a[234:235], v26 offset:53248
    v_cvt_pk_bf16_f32 v227, v74, v75
    v_mfma_f32_16x16x32_bf16 v[76:79], a[164:167], a[100:103], v[76:79]
    buffer_store_dwordx4 v[224:227], v56, s[28:31], s38 offen sc1
    v_mfma_f32_16x16x32_bf16 v[76:79], a[160:163], a[96:99], v[76:79]
    s_waitcnt lgkmcnt(12)
    ds_read_b64_tr_b16 a[236:237], v26 offset:57344
    ds_read_b64_tr_b16 a[238:239], v26 offset:61440
    v_mfma_f32_16x16x32_bf16 v[80:83], a[208:211], a[64:67], v[80:83]
    s_waitcnt lgkmcnt(12)
    ds_read_b64_tr_b16 a[160:161], v23 offset:32768
    v_bfe_i32 v241, v1, 1, 1
    v_mfma_f32_16x16x32_bf16 v[80:83], a[212:215], a[68:71], v[80:83]
    s_waitcnt lgkmcnt(11)
    ds_read_b64_tr_b16 a[162:163], v23 offset:36864
    v_and_b32 v243, v240, v241
    v_mfma_f32_16x16x32_bf16 v[80:83], a[216:219], a[72:75], v[80:83]
    s_waitcnt lgkmcnt(10)
    buffer_load_dwordx2 v[40:41], v4, s[12:15], 0 offen offset:512
    v_mfma_f32_16x16x32_bf16 v[80:83], a[220:223], a[76:79], v[80:83]
    s_waitcnt lgkmcnt(8)
    ds_read_b64_tr_b16 a[164:165], v23 offset:40960
    ds_read_b64_tr_b16 a[166:167], v23 offset:45056
    v_mfma_f32_16x16x32_bf16 v[80:83], a[224:227], a[80:83], v[80:83]
    s_waitcnt lgkmcnt(8)
    ds_read_b64_tr_b16 a[168:169], v23 offset:49152
    v_cvt_pk_bf16_f32 v230, v76, v77
    v_mfma_f32_16x16x32_bf16 v[80:83], a[228:231], a[84:87], v[80:83]
    s_waitcnt lgkmcnt(7)
    s_add_u32 s38, s93, 163840
    ds_read_b64_tr_b16 a[170:171], v23 offset:53248
    v_cvt_pk_bf16_f32 v231, v78, v79
    v_mfma_f32_16x16x32_bf16 v[80:83], a[232:235], a[88:91], v[80:83]
    s_waitcnt lgkmcnt(6)
    buffer_store_dwordx4 v[228:231], v56, s[28:31], s38 offen sc1
    v_mfma_f32_16x16x32_bf16 v[80:83], a[236:239], a[92:95], v[80:83]
    ds_read_b64_tr_b16 a[172:173], v23 offset:57344
    ds_read_b64_tr_b16 a[174:175], v23 offset:61440
    v_mfma_f32_16x16x32_bf16 v[84:87], a[236:239], a[124:127], v[84:87]
    ds_read_b64_tr_b16 a[176:177], v27 offset:32768
    v_xor_b32 v242, v240, v243
    v_mfma_f32_16x16x32_bf16 v[84:87], a[232:235], a[120:123], v[84:87]
    ds_read_b64_tr_b16 a[178:179], v27 offset:36864
    v_cndmask_b32 v246, 0, v242, s[54:55]
    v_mfma_f32_16x16x32_bf16 v[84:87], a[228:231], a[116:119], v[84:87]
    ds_read_b64_tr_b16 a[180:181], v27 offset:40960
    v_cndmask_b32 v247, 0, v243, s[54:55]
    v_mfma_f32_16x16x32_bf16 v[84:87], a[224:227], a[112:115], v[84:87]
    ds_read_b64_tr_b16 a[182:183], v27 offset:45056
    v_cndmask_b32 v250, 0, v242, s[36:37]
    v_mfma_f32_16x16x32_bf16 v[84:87], a[220:223], a[108:111], v[84:87]
    ds_read_b64_tr_b16 a[184:185], v27 offset:49152
    v_cvt_pk_bf16_f32 v232, v80, v81
    v_mfma_f32_16x16x32_bf16 v[84:87], a[216:219], a[104:107], v[84:87]
    ds_read_b64_tr_b16 a[186:187], v27 offset:53248
    v_cvt_pk_bf16_f32 v233, v82, v83
    v_mfma_f32_16x16x32_bf16 v[84:87], a[212:215], a[100:103], v[84:87]
    buffer_load_dwordx2 v[42:43], v4, s[12:15], 0 offen offset:544
    v_mfma_f32_16x16x32_bf16 v[84:87], a[208:211], a[96:99], v[84:87]
    s_waitcnt lgkmcnt(12)
    ds_read_b64_tr_b16 a[188:189], v27 offset:57344
    ds_read_b64_tr_b16 a[190:191], v27 offset:61440
    s_barrier
    v_mfma_f32_16x16x32_bf16 v[88:91], a[160:163], a[64:67], v[88:91]
    s_waitcnt lgkmcnt(12)
    ds_read_b64_tr_b16 a[208:209], v12 offset:0
    v_cndmask_b32 v251, 0, v243, s[36:37]
    v_mfma_f32_16x16x32_bf16 v[88:91], a[164:167], a[68:71], v[88:91]
    s_waitcnt lgkmcnt(11)
    ds_read_b64_tr_b16 a[210:211], v12 offset:4096
    v_mov_b32 v240, 0
    v_mfma_f32_16x16x32_bf16 v[88:91], a[168:171], a[72:75], v[88:91]
    s_waitcnt lgkmcnt(10)
    ds_read_b64_tr_b16 a[212:213], v12 offset:8192
    v_mov_b32 v241, 0
    v_mfma_f32_16x16x32_bf16 v[88:91], a[172:175], a[76:79], v[88:91]
    s_waitcnt lgkmcnt(9)
    ds_read_b64_tr_b16 a[214:215], v12 offset:12288
    v_mov_b32 v244, 0
    v_mfma_f32_16x16x32_bf16 v[88:91], a[176:179], a[80:83], v[88:91]
    s_waitcnt lgkmcnt(8)
    ds_read_b64_tr_b16 a[216:217], v12 offset:16384
    v_cvt_pk_bf16_f32 v236, v84, v85
    v_mfma_f32_16x16x32_bf16 v[88:91], a[180:183], a[84:87], v[88:91]
    s_waitcnt lgkmcnt(7)
    ds_read_b64_tr_b16 a[218:219], v12 offset:20480
    v_cvt_pk_bf16_f32 v237, v86, v87
    v_mfma_f32_16x16x32_bf16 v[88:91], a[184:187], a[88:91], v[88:91]
    s_waitcnt lgkmcnt(6)
    s_add_u32 s49, s46, 512
    ds_read_b64_tr_b16 a[220:221], v12 offset:24576
    v_mov_b32 v245, 0
    v_mfma_f32_16x16x32_bf16 v[88:91], a[188:191], a[92:95], v[88:91]
    s_add_u32 m0, s42, 32768
    ds_read_b64_tr_b16 a[222:223], v12 offset:28672
    v_mov_b32 v248, 0
    v_mfma_f32_16x16x32_bf16 v[92:95], a[188:191], a[124:127], v[92:95]
    buffer_load_dwordx4 v46, s[20:23], s49 offen lds
    v_mfma_f32_16x16x32_bf16 v[92:95], a[184:187], a[120:123], v[92:95]
    ds_read_b64_tr_b16 a[224:225], v16 offset:0
    ds_read_b64_tr_b16 a[226:227], v16 offset:4096
    v_mfma_f32_16x16x32_bf16 v[92:95], a[180:183], a[116:119], v[92:95]
    buffer_load_dwordx4 v47, s[20:23], s49 offen offset:1024 lds
    v_mfma_f32_16x16x32_bf16 v[92:95], a[176:179], a[112:115], v[92:95]
    ds_read_b64_tr_b16 a[228:229], v16 offset:8192
    ds_read_b64_tr_b16 a[230:231], v16 offset:12288
    v_mfma_f32_16x16x32_bf16 v[92:95], a[172:175], a[108:111], v[92:95]
    ds_read_b64_tr_b16 a[232:233], v16 offset:16384
    v_cvt_pk_bf16_f32 v234, v88, v89
    v_mfma_f32_16x16x32_bf16 v[92:95], a[168:171], a[104:107], v[92:95]
    s_add_u32 s38, s93, 128
    ds_read_b64_tr_b16 a[234:235], v16 offset:20480
    v_cvt_pk_bf16_f32 v235, v90, v91
    v_mfma_f32_16x16x32_bf16 v[92:95], a[164:167], a[100:103], v[92:95]
    buffer_store_dwordx4 v[232:235], v56, s[28:31], s38 offen sc1
    v_mfma_f32_16x16x32_bf16 v[92:95], a[160:163], a[96:99], v[92:95]
    s_waitcnt lgkmcnt(12)
    ds_read_b64_tr_b16 a[236:237], v16 offset:24576
    ds_read_b64_tr_b16 a[238:239], v16 offset:28672
    v_mfma_f32_16x16x32_bf16 v[96:99], a[208:211], a[64:67], v[96:99]
    s_waitcnt lgkmcnt(12)
    buffer_load_dwordx4 v48, s[20:23], s49 offen offset:2048 lds
    v_mfma_f32_16x16x32_bf16 v[96:99], a[212:215], a[68:71], v[96:99]
    s_waitcnt lgkmcnt(10)
    ds_read_b64_tr_b16 a[160:161], v13 offset:0
    ds_read_b64_tr_b16 a[162:163], v13 offset:4096
    v_mfma_f32_16x16x32_bf16 v[96:99], a[216:219], a[72:75], v[96:99]
    s_waitcnt lgkmcnt(10)
    buffer_load_dwordx4 v49, s[20:23], s49 offen offset:3072 lds
    v_mfma_f32_16x16x32_bf16 v[96:99], a[220:223], a[76:79], v[96:99]
    s_waitcnt lgkmcnt(8)
    ds_read_b64_tr_b16 a[164:165], v13 offset:8192
    ds_read_b64_tr_b16 a[166:167], v13 offset:12288
    v_mfma_f32_16x16x32_bf16 v[96:99], a[224:227], a[80:83], v[96:99]
    s_waitcnt lgkmcnt(8)
    ds_read_b64_tr_b16 a[168:169], v13 offset:16384
    v_cvt_pk_bf16_f32 v238, v92, v93
    v_mfma_f32_16x16x32_bf16 v[96:99], a[228:231], a[84:87], v[96:99]
    s_waitcnt lgkmcnt(7)
    s_add_u32 s38, s93, 163968
    ds_read_b64_tr_b16 a[170:171], v13 offset:20480
    v_cvt_pk_bf16_f32 v239, v94, v95
    v_mfma_f32_16x16x32_bf16 v[96:99], a[232:235], a[88:91], v[96:99]
    s_waitcnt lgkmcnt(6)
    s_add_u32 s49, s46, 74240
    buffer_store_dwordx4 v[236:239], v56, s[28:31], s38 offen sc1
    v_mfma_f32_16x16x32_bf16 v[96:99], a[236:239], a[92:95], v[96:99]
    s_add_u32 m0, s42, 49152
    ds_read_b64_tr_b16 a[172:173], v13 offset:24576
    ds_read_b64_tr_b16 a[174:175], v13 offset:28672
    v_mfma_f32_16x16x32_bf16 v[100:103], a[236:239], a[124:127], v[100:103]
    buffer_load_dwordx4 v46, s[20:23], s49 offen lds
    v_mfma_f32_16x16x32_bf16 v[100:103], a[232:235], a[120:123], v[100:103]
    ds_read_b64_tr_b16 a[176:177], v17 offset:0
    ds_read_b64_tr_b16 a[178:179], v17 offset:4096
    v_mfma_f32_16x16x32_bf16 v[100:103], a[228:231], a[116:119], v[100:103]
    buffer_load_dwordx4 v47, s[20:23], s49 offen offset:1024 lds
    v_mfma_f32_16x16x32_bf16 v[100:103], a[224:227], a[112:115], v[100:103]
    ds_read_b64_tr_b16 a[180:181], v17 offset:8192
    ds_read_b64_tr_b16 a[182:183], v17 offset:12288
    v_mfma_f32_16x16x32_bf16 v[100:103], a[220:223], a[108:111], v[100:103]
    ds_read_b64_tr_b16 a[184:185], v17 offset:16384
    v_cvt_pk_bf16_f32 v224, v96, v97
    v_mfma_f32_16x16x32_bf16 v[100:103], a[216:219], a[104:107], v[100:103]
    ds_read_b64_tr_b16 a[186:187], v17 offset:20480
    v_cvt_pk_bf16_f32 v225, v98, v99
    v_mfma_f32_16x16x32_bf16 v[100:103], a[212:215], a[100:103], v[100:103]
    ds_read_b64_tr_b16 a[188:189], v17 offset:24576
    v_mov_b32 v249, 0
    v_mfma_f32_16x16x32_bf16 v[100:103], a[208:211], a[96:99], v[100:103]
    s_waitcnt lgkmcnt(13)
    ds_read_b64_tr_b16 a[190:191], v17 offset:28672
    v_mov_b32 v252, 0
    v_mfma_f32_16x16x32_bf16 v[104:107], a[160:163], a[64:67], v[104:107]
    s_waitcnt lgkmcnt(12)
    buffer_load_dwordx4 v48, s[20:23], s49 offen offset:2048 lds
    v_mfma_f32_16x16x32_bf16 v[104:107], a[164:167], a[68:71], v[104:107]
    s_waitcnt lgkmcnt(10)
    ds_read_b64_tr_b16 a[208:209], v14 offset:0
    ds_read_b64_tr_b16 a[210:211], v14 offset:4096
    v_mfma_f32_16x16x32_bf16 v[104:107], a[168:171], a[72:75], v[104:107]
    s_waitcnt lgkmcnt(10)
    buffer_load_dwordx4 v49, s[20:23], s49 offen offset:3072 lds
    v_mfma_f32_16x16x32_bf16 v[104:107], a[172:175], a[76:79], v[104:107]
    s_waitcnt lgkmcnt(8)
    ds_read_b64_tr_b16 a[212:213], v14 offset:8192
    ds_read_b64_tr_b16 a[214:215], v14 offset:12288
    v_mfma_f32_16x16x32_bf16 v[104:107], a[176:179], a[80:83], v[104:107]
    s_waitcnt lgkmcnt(8)
    ds_read_b64_tr_b16 a[216:217], v14 offset:16384
    v_cvt_pk_bf16_f32 v228, v100, v101
    v_mfma_f32_16x16x32_bf16 v[104:107], a[180:183], a[84:87], v[104:107]
    s_waitcnt lgkmcnt(7)
    ds_read_b64_tr_b16 a[218:219], v14 offset:20480
    v_cvt_pk_bf16_f32 v229, v102, v103
    v_mfma_f32_16x16x32_bf16 v[104:107], a[184:187], a[88:91], v[104:107]
    s_waitcnt lgkmcnt(6)
    ds_read_b64_tr_b16 a[220:221], v14 offset:24576
    v_mov_b32 v253, 0
    v_mfma_f32_16x16x32_bf16 v[104:107], a[188:191], a[92:95], v[104:107]
    ds_read_b64_tr_b16 a[222:223], v14 offset:28672
    v_mfma_f32_16x16x32_bf16 v[108:111], a[188:191], a[124:127], v[108:111]
    ds_read_b64_tr_b16 a[224:225], v18 offset:0
    v_mfma_f32_16x16x32_bf16 v[108:111], a[184:187], a[120:123], v[108:111]
    ds_read_b64_tr_b16 a[226:227], v18 offset:4096
    v_mfma_f32_16x16x32_bf16 v[108:111], a[180:183], a[116:119], v[108:111]
    ds_read_b64_tr_b16 a[228:229], v18 offset:8192
    v_mfma_f32_16x16x32_bf16 v[108:111], a[176:179], a[112:115], v[108:111]
    ds_read_b64_tr_b16 a[230:231], v18 offset:12288
    v_mfma_f32_16x16x32_bf16 v[108:111], a[172:175], a[108:111], v[108:111]
    ds_read_b64_tr_b16 a[232:233], v18 offset:16384
    v_cvt_pk_bf16_f32 v226, v104, v105
    v_mfma_f32_16x16x32_bf16 v[108:111], a[168:171], a[104:107], v[108:111]
    s_add_u32 s38, s93, 512
    ds_read_b64_tr_b16 a[234:235], v18 offset:20480
    v_cvt_pk_bf16_f32 v227, v106, v107
    v_mfma_f32_16x16x32_bf16 v[108:111], a[164:167], a[100:103], v[108:111]
    buffer_store_dwordx4 v[224:227], v56, s[28:31], s38 offen sc1
    v_mfma_f32_16x16x32_bf16 v[108:111], a[160:163], a[96:99], v[108:111]
    s_waitcnt lgkmcnt(12)
    ds_read_b64_tr_b16 a[236:237], v18 offset:24576
    ds_read_b64_tr_b16 a[238:239], v18 offset:28672
    v_mfma_f32_16x16x32_bf16 v[112:115], a[208:211], a[64:67], v[112:115]
    s_waitcnt lgkmcnt(12)
    ds_read_b64_tr_b16 a[160:161], v15 offset:0
    v_mfma_f32_16x16x32_bf16 v[112:115], a[212:215], a[68:71], v[112:115]
    s_waitcnt lgkmcnt(11)
    ds_read_b64_tr_b16 a[162:163], v15 offset:4096
    v_mfma_f32_16x16x32_bf16 v[112:115], a[216:219], a[72:75], v[112:115]
    s_waitcnt lgkmcnt(10)
    ds_read_b64_tr_b16 a[164:165], v15 offset:8192
    v_mfma_f32_16x16x32_bf16 v[112:115], a[220:223], a[76:79], v[112:115]
    s_waitcnt lgkmcnt(9)
    ds_read_b64_tr_b16 a[166:167], v15 offset:12288
    v_mfma_f32_16x16x32_bf16 v[112:115], a[224:227], a[80:83], v[112:115]
    s_waitcnt lgkmcnt(8)
    ds_read_b64_tr_b16 a[168:169], v15 offset:16384
    v_cvt_pk_bf16_f32 v230, v108, v109
    v_mfma_f32_16x16x32_bf16 v[112:115], a[228:231], a[84:87], v[112:115]
    s_waitcnt lgkmcnt(7)
    s_add_u32 s38, s93, 164352
    ds_read_b64_tr_b16 a[170:171], v15 offset:20480
    v_cvt_pk_bf16_f32 v231, v110, v111
    v_mfma_f32_16x16x32_bf16 v[112:115], a[232:235], a[88:91], v[112:115]
    s_waitcnt lgkmcnt(6)
    buffer_store_dwordx4 v[228:231], v56, s[28:31], s38 offen sc1
    v_mfma_f32_16x16x32_bf16 v[112:115], a[236:239], a[92:95], v[112:115]
    ds_read_b64_tr_b16 a[172:173], v15 offset:24576
    ds_read_b64_tr_b16 a[174:175], v15 offset:28672
    v_mfma_f32_16x16x32_bf16 v[116:119], a[236:239], a[124:127], v[116:119]
    ds_read_b64_tr_b16 a[176:177], v19 offset:0
    v_mfma_f32_16x16x32_bf16 v[116:119], a[232:235], a[120:123], v[116:119]
    ds_read_b64_tr_b16 a[178:179], v19 offset:4096
    v_mfma_f32_16x16x32_bf16 v[116:119], a[228:231], a[116:119], v[116:119]
    ds_read_b64_tr_b16 a[180:181], v19 offset:8192
    v_mfma_f32_16x16x32_bf16 v[116:119], a[224:227], a[112:115], v[116:119]
    ds_read_b64_tr_b16 a[182:183], v19 offset:12288
    v_mfma_f32_16x16x32_bf16 v[116:119], a[220:223], a[108:111], v[116:119]
    ds_read_b64_tr_b16 a[184:185], v19 offset:16384
    v_cvt_pk_bf16_f32 v232, v112, v113
    v_mfma_f32_16x16x32_bf16 v[116:119], a[216:219], a[104:107], v[116:119]
    ds_read_b64_tr_b16 a[186:187], v19 offset:20480
    v_cvt_pk_bf16_f32 v233, v114, v115
    v_mfma_f32_16x16x32_bf16 v[116:119], a[212:215], a[100:103], v[116:119]
    ds_read_b64_tr_b16 a[188:189], v19 offset:24576
    v_mfma_f32_16x16x32_bf16 v[116:119], a[208:211], a[96:99], v[116:119]
    s_waitcnt lgkmcnt(13)
    ds_read_b64_tr_b16 a[190:191], v19 offset:28672
    s_waitcnt vmcnt(17)
    s_barrier
    v_mfma_f32_16x16x32_bf16 v[120:123], a[160:163], a[64:67], v[120:123]
    s_waitcnt lgkmcnt(12)
    ds_read_b64_tr_b16 a[208:209], v20 offset:0
    v_mfma_f32_16x16x32_bf16 v[120:123], a[164:167], a[68:71], v[120:123]
    s_waitcnt lgkmcnt(11)
    ds_read_b64_tr_b16 a[210:211], v20 offset:4096
    v_mfma_f32_16x16x32_bf16 v[120:123], a[168:171], a[72:75], v[120:123]
    s_waitcnt lgkmcnt(10)
    ds_read_b64_tr_b16 a[212:213], v20 offset:8192
    v_mfma_f32_16x16x32_bf16 v[120:123], a[172:175], a[76:79], v[120:123]
    s_waitcnt lgkmcnt(9)
    ds_read_b64_tr_b16 a[214:215], v20 offset:12288
    v_mfma_f32_16x16x32_bf16 v[120:123], a[176:179], a[80:83], v[120:123]
    s_waitcnt lgkmcnt(8)
    ds_read_b64_tr_b16 a[216:217], v20 offset:16384
    v_cvt_pk_bf16_f32 v236, v116, v117
    v_mfma_f32_16x16x32_bf16 v[120:123], a[180:183], a[84:87], v[120:123]
    s_waitcnt lgkmcnt(7)
    ds_read_b64_tr_b16 a[218:219], v20 offset:20480
    v_cvt_pk_bf16_f32 v237, v118, v119
    v_mfma_f32_16x16x32_bf16 v[120:123], a[184:187], a[88:91], v[120:123]
    s_waitcnt lgkmcnt(6)
    s_add_u32 s49, s7, 768
    ds_read_b64_tr_b16 a[220:221], v20 offset:24576
    v_mfma_f32_16x16x32_bf16 v[120:123], a[188:191], a[92:95], v[120:123]
    s_add_u32 m0, s42, 98304
    ds_read_b64_tr_b16 a[222:223], v20 offset:28672
    v_mfma_f32_16x16x32_bf16 v[124:127], a[188:191], a[124:127], v[124:127]
    buffer_load_dwordx4 v46, s[20:23], s49 offen lds
    v_mfma_f32_16x16x32_bf16 v[124:127], a[184:187], a[120:123], v[124:127]
    ds_read_b64_tr_b16 a[224:225], v24 offset:0
    ds_read_b64_tr_b16 a[226:227], v24 offset:4096
    v_mfma_f32_16x16x32_bf16 v[124:127], a[180:183], a[116:119], v[124:127]
    buffer_load_dwordx4 v47, s[20:23], s49 offen offset:1024 lds
    v_mfma_f32_16x16x32_bf16 v[124:127], a[176:179], a[112:115], v[124:127]
    ds_read_b64_tr_b16 a[228:229], v24 offset:8192
    ds_read_b64_tr_b16 a[230:231], v24 offset:12288
    v_mfma_f32_16x16x32_bf16 v[124:127], a[172:175], a[108:111], v[124:127]
    ds_read_b64_tr_b16 a[232:233], v24 offset:16384
    v_cvt_pk_bf16_f32 v234, v120, v121
    v_mfma_f32_16x16x32_bf16 v[124:127], a[168:171], a[104:107], v[124:127]
    s_add_u32 s38, s93, 640
    ds_read_b64_tr_b16 a[234:235], v24 offset:20480
    v_cvt_pk_bf16_f32 v235, v122, v123
    v_mfma_f32_16x16x32_bf16 v[124:127], a[164:167], a[100:103], v[124:127]
    buffer_store_dwordx4 v[232:235], v56, s[28:31], s38 offen sc1
    v_mfma_f32_16x16x32_bf16 v[124:127], a[160:163], a[96:99], v[124:127]
    s_waitcnt lgkmcnt(12)
    ds_read_b64_tr_b16 a[236:237], v24 offset:24576
    ds_read_b64_tr_b16 a[238:239], v24 offset:28672
    v_mfma_f32_16x16x32_bf16 v[64:67], a[208:211], v[128:131], 0
    s_waitcnt lgkmcnt(12)
    buffer_load_dwordx4 v48, s[20:23], s49 offen offset:2048 lds
    v_mfma_f32_16x16x32_bf16 v[64:67], a[212:215], v[144:147], v[64:67]
    s_waitcnt lgkmcnt(10)
    ds_read_b64_tr_b16 a[160:161], v21 offset:0
    ds_read_b64_tr_b16 a[162:163], v21 offset:4096
    v_mfma_f32_16x16x32_bf16 v[64:67], a[216:219], v[192:195], v[64:67]
    s_waitcnt lgkmcnt(10)
    buffer_load_dwordx4 v49, s[20:23], s49 offen offset:3072 lds
    v_mfma_f32_16x16x32_bf16 v[64:67], a[220:223], v[176:179], v[64:67]
    s_waitcnt lgkmcnt(8)
    ds_read_b64_tr_b16 a[164:165], v21 offset:8192
    ds_read_b64_tr_b16 a[166:167], v21 offset:12288
    v_mfma_f32_16x16x32_bf16 v[64:67], a[224:227], v[136:139], v[64:67]
    s_waitcnt lgkmcnt(8)
    ds_read_b64_tr_b16 a[168:169], v21 offset:16384
    v_cvt_pk_bf16_f32 v238, v124, v125
    v_mfma_f32_16x16x32_bf16 v[64:67], a[228:231], v[152:155], v[64:67]
    s_waitcnt lgkmcnt(7)
    s_add_u32 s38, s93, 164480
    ds_read_b64_tr_b16 a[170:171], v21 offset:20480
    v_cvt_pk_bf16_f32 v239, v126, v127
    v_mfma_f32_16x16x32_bf16 v[64:67], a[232:235], v[200:203], v[64:67]
    s_waitcnt lgkmcnt(6)
    s_add_u32 s49, s7, 74496
    buffer_store_dwordx4 v[236:239], v56, s[28:31], s38 offen sc1
    v_mfma_f32_16x16x32_bf16 v[64:67], a[236:239], v[184:187], v[64:67]
    s_add_u32 m0, s42, 114688
    ds_read_b64_tr_b16 a[172:173], v21 offset:24576
    ds_read_b64_tr_b16 a[174:175], v21 offset:28672
    v_mfma_f32_16x16x32_bf16 v[68:71], a[236:239], v[188:191], 0
Ltour0_10:
    s_cbranch_execz Lmain0
    buffer_load_dwordx4 v46, s[20:23], s49 offen lds
    v_mfma_f32_16x16x32_bf16 v[68:71], a[232:235], v[204:207], v[68:71]
    ds_read_b64_tr_b16 a[176:177], v25 offset:0
    ds_read_b64_tr_b16 a[178:179], v25 offset:4096
    v_mfma_f32_16x16x32_bf16 v[68:71], a[228:231], v[156:159], v[68:71]
    buffer_load_dwordx4 v47, s[20:23], s49 offen offset:1024 lds
    v_mfma_f32_16x16x32_bf16 v[68:71], a[224:227], v[140:143], v[68:71]
    ds_read_b64_tr_b16 a[180:181], v25 offset:8192
    ds_read_b64_tr_b16 a[182:183], v25 offset:12288
    v_mfma_f32_16x16x32_bf16 v[68:71], a[220:223], v[180:183], v[68:71]
    ds_read_b64_tr_b16 a[184:185], v25 offset:16384
    v_mfma_f32_16x16x32_bf16 v[68:71], a[216:219], v[196:199], v[68:71]
    ds_read_b64_tr_b16 a[186:187], v25 offset:20480
    v_mfma_f32_16x16x32_bf16 v[68:71], a[212:215], v[148:151], v[68:71]
    ds_read_b64_tr_b16 a[188:189], v25 offset:24576
    v_mfma_f32_16x16x32_bf16 v[68:71], a[208:211], v[132:135], v[68:71]
    s_waitcnt lgkmcnt(13)
    ds_read_b64_tr_b16 a[190:191], v25 offset:28672
    v_mfma_f32_16x16x32_bf16 v[72:75], a[160:163], v[128:131], 0
    s_waitcnt lgkmcnt(12)
    buffer_load_dwordx4 v48, s[20:23], s49 offen offset:2048 lds
    v_mfma_f32_16x16x32_bf16 v[72:75], a[164:167], v[144:147], v[72:75]
    s_waitcnt lgkmcnt(10)
    ds_read_b64_tr_b16 a[208:209], v22 offset:0
    ds_read_b64_tr_b16 a[210:211], v22 offset:4096
    v_mfma_f32_16x16x32_bf16 v[72:75], a[168:171], v[192:195], v[72:75]
    s_waitcnt lgkmcnt(10)
    buffer_load_dwordx4 v49, s[20:23], s49 offen offset:3072 lds
    v_mfma_f32_16x16x32_bf16 v[72:75], a[172:175], v[176:179], v[72:75]
    s_waitcnt lgkmcnt(8)
    ds_read_b64_tr_b16 a[212:213], v22 offset:8192
    ds_read_b64_tr_b16 a[214:215], v22 offset:12288
    v_mfma_f32_16x16x32_bf16 v[72:75], a[176:179], v[136:139], v[72:75]
    s_waitcnt lgkmcnt(8)
    ds_read_b64_tr_b16 a[216:217], v22 offset:16384
    v_mfma_f32_16x16x32_bf16 v[72:75], a[180:183], v[152:155], v[72:75]
    s_waitcnt lgkmcnt(7)
    ds_read_b64_tr_b16 a[218:219], v22 offset:20480
    v_mfma_f32_16x16x32_bf16 v[72:75], a[184:187], v[200:203], v[72:75]
    s_waitcnt lgkmcnt(6)
    ds_read_b64_tr_b16 a[220:221], v22 offset:24576
    v_mfma_f32_16x16x32_bf16 v[72:75], a[188:191], v[184:187], v[72:75]
    ds_read_b64_tr_b16 a[222:223], v22 offset:28672
    v_mfma_f32_16x16x32_bf16 v[76:79], a[188:191], v[188:191], 0
    ds_read_b64_tr_b16 a[224:225], v26 offset:0
    v_mfma_f32_16x16x32_bf16 v[76:79], a[184:187], v[204:207], v[76:79]
    ds_read_b64_tr_b16 a[226:227], v26 offset:4096
    v_mfma_f32_16x16x32_bf16 v[76:79], a[180:183], v[156:159], v[76:79]
    ds_read_b64_tr_b16 a[228:229], v26 offset:8192
    v_mfma_f32_16x16x32_bf16 v[76:79], a[176:179], v[140:143], v[76:79]
    ds_read_b64_tr_b16 a[230:231], v26 offset:12288
    v_mfma_f32_16x16x32_bf16 v[76:79], a[172:175], v[180:183], v[76:79]
    ds_read_b64_tr_b16 a[232:233], v26 offset:16384
    v_mfma_f32_16x16x32_bf16 v[76:79], a[168:171], v[196:199], v[76:79]
    ds_read_b64_tr_b16 a[234:235], v26 offset:20480
    v_mfma_f32_16x16x32_bf16 v[76:79], a[164:167], v[148:151], v[76:79]
    buffer_load_dword v63, v63, s[88:91], 0 offen sc1
    v_mfma_f32_16x16x32_bf16 v[76:79], a[160:163], v[132:135], v[76:79]
    s_waitcnt lgkmcnt(12)
    ds_read_b64_tr_b16 a[236:237], v26 offset:24576
    ds_read_b64_tr_b16 a[238:239], v26 offset:28672
    v_mfma_f32_16x16x32_bf16 v[80:83], a[208:211], v[128:131], 0
    s_waitcnt lgkmcnt(12)
    ds_read_b64_tr_b16 a[160:161], v23 offset:0
    v_mfma_f32_16x16x32_bf16 v[80:83], a[212:215], v[144:147], v[80:83]
    s_waitcnt lgkmcnt(11)
    ds_read_b64_tr_b16 a[162:163], v23 offset:4096
    v_mfma_f32_16x16x32_bf16 v[80:83], a[216:219], v[192:195], v[80:83]
    s_waitcnt lgkmcnt(10)
    ds_read_b64_tr_b16 a[164:165], v23 offset:8192
    v_mfma_f32_16x16x32_bf16 v[80:83], a[220:223], v[176:179], v[80:83]
    s_waitcnt lgkmcnt(9)
    ds_read_b64_tr_b16 a[166:167], v23 offset:12288
    v_mfma_f32_16x16x32_bf16 v[80:83], a[224:227], v[136:139], v[80:83]
    s_waitcnt lgkmcnt(8)
    ds_read_b64_tr_b16 a[168:169], v23 offset:16384
    v_mfma_f32_16x16x32_bf16 v[80:83], a[228:231], v[152:155], v[80:83]
    s_waitcnt lgkmcnt(7)
    ds_read_b64_tr_b16 a[170:171], v23 offset:20480
    v_mfma_f32_16x16x32_bf16 v[80:83], a[232:235], v[200:203], v[80:83]
    s_waitcnt lgkmcnt(6)
    ds_read_b64_tr_b16 a[172:173], v23 offset:24576
    v_mfma_f32_16x16x32_bf16 v[80:83], a[236:239], v[184:187], v[80:83]
    ds_read_b64_tr_b16 a[174:175], v23 offset:28672
    v_mfma_f32_16x16x32_bf16 v[84:87], a[236:239], v[188:191], 0
    ds_read_b64_tr_b16 a[176:177], v27 offset:0
    v_mfma_f32_16x16x32_bf16 v[84:87], a[232:235], v[204:207], v[84:87]
    ds_read_b64_tr_b16 a[178:179], v27 offset:4096
    v_mfma_f32_16x16x32_bf16 v[84:87], a[228:231], v[156:159], v[84:87]
    ds_read_b64_tr_b16 a[180:181], v27 offset:8192
    v_mfma_f32_16x16x32_bf16 v[84:87], a[224:227], v[140:143], v[84:87]
    ds_read_b64_tr_b16 a[182:183], v27 offset:12288
    v_mfma_f32_16x16x32_bf16 v[84:87], a[220:223], v[180:183], v[84:87]
    ds_read_b64_tr_b16 a[184:185], v27 offset:16384
    v_mfma_f32_16x16x32_bf16 v[84:87], a[216:219], v[196:199], v[84:87]
    ds_read_b64_tr_b16 a[186:187], v27 offset:20480
    v_mfma_f32_16x16x32_bf16 v[84:87], a[212:215], v[148:151], v[84:87]
    ds_read_b64_tr_b16 a[188:189], v27 offset:24576
    v_mfma_f32_16x16x32_bf16 v[84:87], a[208:211], v[132:135], v[84:87]
    s_waitcnt lgkmcnt(13)
    ds_read_b64_tr_b16 a[190:191], v27 offset:28672
    s_waitcnt vmcnt(13)
    s_barrier
    v_mfma_f32_16x16x32_bf16 v[88:91], a[160:163], v[128:131], 0
    s_waitcnt lgkmcnt(12)
    ds_read_b64_tr_b16 a[208:209], v12 offset:32768
    v_mfma_f32_16x16x32_bf16 v[88:91], a[164:167], v[144:147], v[88:91]
    s_waitcnt lgkmcnt(11)
    ds_read_b64_tr_b16 a[210:211], v12 offset:36864
    v_mfma_f32_16x16x32_bf16 v[88:91], a[168:171], v[192:195], v[88:91]
    s_waitcnt lgkmcnt(10)
    ds_read_b64_tr_b16 a[212:213], v12 offset:40960
    v_mfma_f32_16x16x32_bf16 v[88:91], a[172:175], v[176:179], v[88:91]
    s_waitcnt lgkmcnt(9)
    ds_read_b64_tr_b16 a[214:215], v12 offset:45056
    v_mfma_f32_16x16x32_bf16 v[88:91], a[176:179], v[136:139], v[88:91]
    s_waitcnt lgkmcnt(8)
    ds_read_b64_tr_b16 a[216:217], v12 offset:49152
    v_mfma_f32_16x16x32_bf16 v[88:91], a[180:183], v[152:155], v[88:91]
    s_waitcnt lgkmcnt(7)
    ds_read_b64_tr_b16 a[218:219], v12 offset:53248
    v_mfma_f32_16x16x32_bf16 v[88:91], a[184:187], v[200:203], v[88:91]
    s_waitcnt lgkmcnt(6)
    s_add_u32 s49, s46, 768
    ds_read_b64_tr_b16 a[220:221], v12 offset:57344
    v_mfma_f32_16x16x32_bf16 v[88:91], a[188:191], v[184:187], v[88:91]
    s_add_u32 m0, s42, 0
    ds_read_b64_tr_b16 a[222:223], v12 offset:61440
    v_mfma_f32_16x16x32_bf16 v[92:95], a[188:191], v[188:191], 0
    buffer_load_dwordx4 v46, s[20:23], s49 offen lds
    v_mfma_f32_16x16x32_bf16 v[92:95], a[184:187], v[204:207], v[92:95]
    ds_read_b64_tr_b16 a[224:225], v16 offset:32768
    ds_read_b64_tr_b16 a[226:227], v16 offset:36864
    v_mfma_f32_16x16x32_bf16 v[92:95], a[180:183], v[156:159], v[92:95]
    buffer_load_dwordx4 v47, s[20:23], s49 offen offset:1024 lds
    v_mfma_f32_16x16x32_bf16 v[92:95], a[176:179], v[140:143], v[92:95]
    ds_read_b64_tr_b16 a[228:229], v16 offset:40960
    ds_read_b64_tr_b16 a[230:231], v16 offset:45056
    v_mfma_f32_16x16x32_bf16 v[92:95], a[172:175], v[180:183], v[92:95]
    ds_read_b64_tr_b16 a[232:233], v16 offset:49152
    v_mfma_f32_16x16x32_bf16 v[92:95], a[168:171], v[196:199], v[92:95]
    ds_read_b64_tr_b16 a[234:235], v16 offset:53248
    v_mfma_f32_16x16x32_bf16 v[92:95], a[164:167], v[148:151], v[92:95]
    ds_read_b64_tr_b16 a[236:237], v16 offset:57344
    v_mfma_f32_16x16x32_bf16 v[92:95], a[160:163], v[132:135], v[92:95]
    s_waitcnt lgkmcnt(13)
    ds_read_b64_tr_b16 a[238:239], v16 offset:61440
    v_mfma_f32_16x16x32_bf16 v[64:67], a[208:211], a[64:67], v[64:67]
    s_waitcnt lgkmcnt(12)
    buffer_load_dwordx4 v48, s[20:23], s49 offen offset:2048 lds
    v_mfma_f32_16x16x32_bf16 v[64:67], a[212:215], a[68:71], v[64:67]
    s_waitcnt lgkmcnt(10)
    ds_read_b64_tr_b16 a[160:161], v13 offset:32768
    ds_read_b64_tr_b16 a[162:163], v13 offset:36864
    v_mfma_f32_16x16x32_bf16 v[64:67], a[216:219], a[72:75], v[64:67]
    s_waitcnt lgkmcnt(10)
    s_add_u32 s92, s92, 16
    buffer_load_dwordx4 v49, s[20:23], s49 offen offset:3072 lds
    v_mfma_f32_16x16x32_bf16 v[64:67], a[220:223], a[76:79], v[64:67]
    s_waitcnt lgkmcnt(8)
    s_waitcnt vmcnt(9)
    ds_read_b64_tr_b16 a[164:165], v13 offset:40960
    ds_read_b64_tr_b16 a[166:167], v13 offset:45056
    v_mfma_f32_16x16x32_bf16 v[64:67], a[224:227], a[80:83], v[64:67]
    s_waitcnt lgkmcnt(8)
    buffer_store_dword v10, v8, s[24:27], s92 offen sc1
    v_mfma_f32_16x16x32_bf16 v[64:67], a[228:231], a[84:87], v[64:67]
    s_waitcnt lgkmcnt(6)
    ds_read_b64_tr_b16 a[168:169], v13 offset:49152
    ds_read_b64_tr_b16 a[170:171], v13 offset:53248
    v_mfma_f32_16x16x32_bf16 v[64:67], a[232:235], a[88:91], v[64:67]
    s_waitcnt lgkmcnt(6)
    s_add_u32 s49, s46, 74496
    ds_read_b64_tr_b16 a[172:173], v13 offset:57344
    v_mfma_f32_16x16x32_bf16 v[64:67], a[236:239], a[92:95], v[64:67]
    s_add_u32 m0, s42, 16384
    ds_read_b64_tr_b16 a[174:175], v13 offset:61440
    v_mfma_f32_16x16x32_bf16 v[68:71], a[236:239], a[124:127], v[68:71]
    buffer_load_dwordx4 v46, s[20:23], s49 offen lds
    v_mfma_f32_16x16x32_bf16 v[68:71], a[232:235], a[120:123], v[68:71]
    ds_read_b64_tr_b16 a[176:177], v17 offset:32768
    ds_read_b64_tr_b16 a[178:179], v17 offset:36864
    v_mfma_f32_16x16x32_bf16 v[68:71], a[228:231], a[116:119], v[68:71]
    buffer_load_dwordx4 v47, s[20:23], s49 offen offset:1024 lds
    v_mfma_f32_16x16x32_bf16 v[68:71], a[224:227], a[112:115], v[68:71]
    ds_read_b64_tr_b16 a[180:181], v17 offset:40960
    ds_read_b64_tr_b16 a[182:183], v17 offset:45056
    v_mfma_f32_16x16x32_bf16 v[68:71], a[220:223], a[108:111], v[68:71]
    ds_read_b64_tr_b16 a[184:185], v17 offset:49152
    v_cvt_pk_bf16_f32 v224, v64, v65
    v_mfma_f32_16x16x32_bf16 v[68:71], a[216:219], a[104:107], v[68:71]
    ds_read_b64_tr_b16 a[186:187], v17 offset:53248
    v_cvt_pk_bf16_f32 v225, v66, v67
    v_mfma_f32_16x16x32_bf16 v[68:71], a[212:215], a[100:103], v[68:71]
    ds_read_b64_tr_b16 a[188:189], v17 offset:57344
    v_mfma_f32_16x16x32_bf16 v[68:71], a[208:211], a[96:99], v[68:71]
    s_waitcnt lgkmcnt(13)
    ds_read_b64_tr_b16 a[190:191], v17 offset:61440
    v_mfma_f32_16x16x32_bf16 v[72:75], a[160:163], a[64:67], v[72:75]
    s_waitcnt lgkmcnt(12)
    buffer_load_dwordx4 v48, s[20:23], s49 offen offset:2048 lds
    v_mfma_f32_16x16x32_bf16 v[72:75], a[164:167], a[68:71], v[72:75]
    s_waitcnt lgkmcnt(10)
    ds_read_b64_tr_b16 a[208:209], v14 offset:32768
    ds_read_b64_tr_b16 a[210:211], v14 offset:36864
    v_mfma_f32_16x16x32_bf16 v[72:75], a[168:171], a[72:75], v[72:75]
    s_waitcnt lgkmcnt(10)
    buffer_load_dwordx4 v49, s[20:23], s49 offen offset:3072 lds
    v_mfma_f32_16x16x32_bf16 v[72:75], a[172:175], a[76:79], v[72:75]
    s_waitcnt lgkmcnt(8)
    ds_read_b64_tr_b16 a[212:213], v14 offset:40960
    ds_read_b64_tr_b16 a[214:215], v14 offset:45056
    v_mfma_f32_16x16x32_bf16 v[72:75], a[176:179], a[80:83], v[72:75]
    s_waitcnt lgkmcnt(8)
    ds_read_b64_tr_b16 a[216:217], v14 offset:49152
    v_cvt_pk_bf16_f32 v228, v68, v69
    v_mfma_f32_16x16x32_bf16 v[72:75], a[180:183], a[84:87], v[72:75]
    s_waitcnt lgkmcnt(7)
    ds_read_b64_tr_b16 a[218:219], v14 offset:53248
    v_cvt_pk_bf16_f32 v229, v70, v71
    v_mfma_f32_16x16x32_bf16 v[72:75], a[184:187], a[88:91], v[72:75]
    s_waitcnt lgkmcnt(6)
    s_and_b32 s42, s2, 7
    ds_read_b64_tr_b16 a[220:221], v14 offset:57344
    v_mfma_f32_16x16x32_bf16 v[72:75], a[188:191], a[92:95], v[72:75]
    s_mov_b64 s[20:21], s[52:53]
    ds_read_b64_tr_b16 a[222:223], v14 offset:61440
    v_mfma_f32_16x16x32_bf16 v[76:79], a[188:191], a[124:127], v[76:79]
    ds_read_b64_tr_b16 a[224:225], v18 offset:32768
    s_waitcnt vmcnt(9)
    v_readfirstlane_b32 s37, v63
    v_mfma_f32_16x16x32_bf16 v[76:79], a[184:187], a[120:123], v[76:79]
    s_mov_b32 s22, 1152
    ds_read_b64_tr_b16 a[226:227], v18 offset:36864
    v_mfma_f32_16x16x32_bf16 v[76:79], a[180:183], a[116:119], v[76:79]
    s_mov_b32 s23, 0x20000
    ds_read_b64_tr_b16 a[228:229], v18 offset:40960
    s_cmp_lt_u32 s37, 256
    s_cbranch_scc1 Lattn_armwait
Lattn_armed:
    v_mfma_f32_16x16x32_bf16 v[76:79], a[176:179], a[112:115], v[76:79]
    ds_read_b64_tr_b16 a[230:231], v18 offset:45056
    v_mfma_f32_16x16x32_bf16 v[76:79], a[172:175], a[108:111], v[76:79]
    ds_read_b64_tr_b16 a[232:233], v18 offset:49152
    v_cvt_pk_bf16_f32 v226, v72, v73
    v_mfma_f32_16x16x32_bf16 v[76:79], a[168:171], a[104:107], v[76:79]
    s_add_u32 s38, s93, 1024
    ds_read_b64_tr_b16 a[234:235], v18 offset:53248
    v_cvt_pk_bf16_f32 v227, v74, v75
    v_mfma_f32_16x16x32_bf16 v[76:79], a[164:167], a[100:103], v[76:79]
    buffer_store_dwordx4 v[224:227], v56, s[28:31], s38 offen sc1
    v_mfma_f32_16x16x32_bf16 v[76:79], a[160:163], a[96:99], v[76:79]
    s_waitcnt lgkmcnt(12)
    s_mov_b32 s45, 18688
    ds_read_b64_tr_b16 a[236:237], v18 offset:57344
    ds_read_b64_tr_b16 a[238:239], v18 offset:61440
    v_mfma_f32_16x16x32_bf16 v[80:83], a[208:211], a[64:67], v[80:83]
    s_waitcnt lgkmcnt(12)
    buffer_load_dwordx4 v[160:163], v5, s[24:27], s45 offen offset:0 sc1
    v_mfma_f32_16x16x32_bf16 v[80:83], a[212:215], a[68:71], v[80:83]
    s_waitcnt lgkmcnt(10)
    ds_read_b64_tr_b16 a[160:161], v15 offset:32768
    ds_read_b64_tr_b16 a[162:163], v15 offset:36864
    v_mfma_f32_16x16x32_bf16 v[80:83], a[216:219], a[72:75], v[80:83]
    s_waitcnt lgkmcnt(10)
    buffer_load_dwordx4 v[164:167], v5, s[24:27], s45 offen offset:512 sc1
    v_mfma_f32_16x16x32_bf16 v[80:83], a[220:223], a[76:79], v[80:83]
    s_waitcnt lgkmcnt(8)
    ds_read_b64_tr_b16 a[164:165], v15 offset:40960
    ds_read_b64_tr_b16 a[166:167], v15 offset:45056
    v_mfma_f32_16x16x32_bf16 v[80:83], a[224:227], a[80:83], v[80:83]
    s_waitcnt lgkmcnt(8)
    ds_read_b64_tr_b16 a[168:169], v15 offset:49152
    v_cvt_pk_bf16_f32 v230, v76, v77
    v_mfma_f32_16x16x32_bf16 v[80:83], a[228:231], a[84:87], v[80:83]
    s_waitcnt lgkmcnt(7)
    s_add_u32 s38, s93, 164864
    ds_read_b64_tr_b16 a[170:171], v15 offset:53248
    v_cvt_pk_bf16_f32 v231, v78, v79
    v_mfma_f32_16x16x32_bf16 v[80:83], a[232:235], a[88:91], v[80:83]
    s_waitcnt lgkmcnt(6)
    buffer_store_dwordx4 v[228:231], v56, s[28:31], s38 offen sc1
    v_mfma_f32_16x16x32_bf16 v[80:83], a[236:239], a[92:95], v[80:83]
    ds_read_b64_tr_b16 a[172:173], v15 offset:57344
    ds_read_b64_tr_b16 a[174:175], v15 offset:61440
    v_mfma_f32_16x16x32_bf16 v[84:87], a[236:239], a[124:127], v[84:87]
    ds_read_b64_tr_b16 a[176:177], v19 offset:32768
    v_mfma_f32_16x16x32_bf16 v[84:87], a[232:235], a[120:123], v[84:87]
    ds_read_b64_tr_b16 a[178:179], v19 offset:36864
    v_mfma_f32_16x16x32_bf16 v[84:87], a[228:231], a[116:119], v[84:87]
    buffer_load_dwordx4 v[168:171], v59, s[24:27], s45 offen offset:1024 sc1
    v_mfma_f32_16x16x32_bf16 v[84:87], a[224:227], a[112:115], v[84:87]
    ds_read_b64_tr_b16 a[180:181], v19 offset:40960
    ds_read_b64_tr_b16 a[182:183], v19 offset:45056
    v_mfma_f32_16x16x32_bf16 v[84:87], a[220:223], a[108:111], v[84:87]
    ds_read_b64_tr_b16 a[184:185], v19 offset:49152
    v_cvt_pk_bf16_f32 v232, v80, v81
    v_mfma_f32_16x16x32_bf16 v[84:87], a[216:219], a[104:107], v[84:87]
    s_mov_b32 s45, 20992
    ds_read_b64_tr_b16 a[186:187], v19 offset:53248
    v_cvt_pk_bf16_f32 v233, v82, v83
    v_mfma_f32_16x16x32_bf16 v[84:87], a[212:215], a[100:103], v[84:87]
    buffer_load_dwordx4 v[172:175], v5, s[24:27], s45 offen offset:0 sc1
    v_mfma_f32_16x16x32_bf16 v[84:87], a[208:211], a[96:99], v[84:87]
    s_waitcnt lgkmcnt(12)
    ds_read_b64_tr_b16 a[188:189], v19 offset:57344
    ds_read_b64_tr_b16 a[190:191], v19 offset:61440
    s_barrier
    v_mfma_f32_16x16x32_bf16 v[88:91], a[160:163], a[64:67], v[88:91]
    s_waitcnt lgkmcnt(12)
    ds_read_b64_tr_b16 a[208:209], v20 offset:32768
    v_mfma_f32_16x16x32_bf16 v[88:91], a[164:167], a[68:71], v[88:91]
    s_waitcnt lgkmcnt(11)
    ds_read_b64_tr_b16 a[210:211], v20 offset:36864
    v_mfma_f32_16x16x32_bf16 v[88:91], a[168:171], a[72:75], v[88:91]
    s_waitcnt lgkmcnt(10)
    buffer_load_dwordx4 v[208:211], v5, s[24:27], s45 offen offset:512 sc1
    v_mfma_f32_16x16x32_bf16 v[88:91], a[172:175], a[76:79], v[88:91]
    s_waitcnt lgkmcnt(8)
    ds_read_b64_tr_b16 a[212:213], v20 offset:40960
    ds_read_b64_tr_b16 a[214:215], v20 offset:45056
    v_mfma_f32_16x16x32_bf16 v[88:91], a[176:179], a[80:83], v[88:91]
    s_waitcnt lgkmcnt(8)
    s_add_u32 s57, s59, 4096
    ds_read_b64_tr_b16 a[216:217], v20 offset:49152
    v_cvt_pk_bf16_f32 v236, v84, v85
    v_mfma_f32_16x16x32_bf16 v[88:91], a[180:183], a[84:87], v[88:91]
    s_waitcnt lgkmcnt(7)
    s_add_u32 m0, s6, -98304
    ds_read_b64_tr_b16 a[218:219], v20 offset:53248
    v_cvt_pk_bf16_f32 v237, v86, v87
    v_mfma_f32_16x16x32_bf16 v[88:91], a[184:187], a[88:91], v[88:91]
    s_waitcnt lgkmcnt(6)
    buffer_load_dwordx4 v255, s[84:87], s57 offen lds
    v_mfma_f32_16x16x32_bf16 v[88:91], a[188:191], a[92:95], v[88:91]
    ds_read_b64_tr_b16 a[220:221], v20 offset:57344
    ds_read_b64_tr_b16 a[222:223], v20 offset:61440
    v_mfma_f32_16x16x32_bf16 v[92:95], a[188:191], a[124:127], v[92:95]
    s_add_u32 s57, s59, 8192
    buffer_load_dwordx4 v[212:215], v59, s[24:27], s45 offen offset:1024 sc1
    v_mfma_f32_16x16x32_bf16 v[92:95], a[184:187], a[120:123], v[92:95]
    s_add_u32 m0, s6, -94208
    ds_read_b64_tr_b16 a[224:225], v24 offset:32768
    ds_read_b64_tr_b16 a[226:227], v24 offset:36864
    v_mfma_f32_16x16x32_bf16 v[92:95], a[180:183], a[116:119], v[92:95]
    buffer_load_dwordx4 v255, s[84:87], s57 offen lds
    v_mfma_f32_16x16x32_bf16 v[92:95], a[176:179], a[112:115], v[92:95]
    ds_read_b64_tr_b16 a[228:229], v24 offset:40960
    ds_read_b64_tr_b16 a[230:231], v24 offset:45056
    v_mfma_f32_16x16x32_bf16 v[92:95], a[172:175], a[108:111], v[92:95]
    ds_read_b64_tr_b16 a[232:233], v24 offset:49152
    v_cvt_pk_bf16_f32 v234, v88, v89
    v_mfma_f32_16x16x32_bf16 v[92:95], a[168:171], a[104:107], v[92:95]
    s_add_u32 s38, s93, 1152
    ds_read_b64_tr_b16 a[234:235], v24 offset:53248
    v_cvt_pk_bf16_f32 v235, v90, v91
    v_mfma_f32_16x16x32_bf16 v[92:95], a[164:167], a[100:103], v[92:95]
    buffer_store_dwordx4 v[232:235], v56, s[28:31], s38 offen sc1
    v_mfma_f32_16x16x32_bf16 v[92:95], a[160:163], a[96:99], v[92:95]
    s_waitcnt lgkmcnt(12)
    ds_read_b64_tr_b16 a[236:237], v24 offset:57344
    ds_read_b64_tr_b16 a[238:239], v24 offset:61440
    v_mfma_f32_16x16x32_bf16 v[96:99], a[208:211], v[128:131], 0
    s_waitcnt lgkmcnt(12)
    s_add_u32 s57, s59, 12288
    ds_read_b64_tr_b16 a[160:161], v21 offset:32768
    v_mfma_f32_16x16x32_bf16 v[96:99], a[212:215], v[144:147], v[96:99]
    s_waitcnt lgkmcnt(11)
    s_add_u32 m0, s6, -90112
    ds_read_b64_tr_b16 a[162:163], v21 offset:36864
    v_mfma_f32_16x16x32_bf16 v[96:99], a[216:219], v[192:195], v[96:99]
    s_waitcnt lgkmcnt(10)
    buffer_load_dwordx4 v255, s[84:87], s57 offen lds
    v_mfma_f32_16x16x32_bf16 v[96:99], a[220:223], v[176:179], v[96:99]
    s_waitcnt lgkmcnt(8)
    ds_read_b64_tr_b16 a[164:165], v21 offset:40960
    ds_read_b64_tr_b16 a[166:167], v21 offset:45056
    v_mfma_f32_16x16x32_bf16 v[96:99], a[224:227], v[136:139], v[96:99]
    s_waitcnt lgkmcnt(8)
    ds_read_b64_tr_b16 a[168:169], v21 offset:49152
    v_cvt_pk_bf16_f32 v238, v92, v93
    v_mfma_f32_16x16x32_bf16 v[96:99], a[228:231], v[152:155], v[96:99]
    s_waitcnt lgkmcnt(7)
    s_add_u32 s38, s93, 164992
    ds_read_b64_tr_b16 a[170:171], v21 offset:53248
    v_cvt_pk_bf16_f32 v239, v94, v95
    v_mfma_f32_16x16x32_bf16 v[96:99], a[232:235], v[200:203], v[96:99]
    s_waitcnt lgkmcnt(6)
    buffer_store_dwordx4 v[236:239], v56, s[28:31], s38 offen sc1
    v_mfma_f32_16x16x32_bf16 v[96:99], a[236:239], v[184:187], v[96:99]
    ds_read_b64_tr_b16 a[172:173], v21 offset:57344
    ds_read_b64_tr_b16 a[174:175], v21 offset:61440
    v_mfma_f32_16x16x32_bf16 v[100:103], a[236:239], v[188:191], 0
    s_add_u32 s57, s59, 16384
    buffer_load_dwordx2 v[92:93], v58, s[12:15], 0 offen offset:1024
    v_mfma_f32_16x16x32_bf16 v[100:103], a[232:235], v[204:207], v[100:103]
    s_add_u32 m0, s6, -86016
    ds_read_b64_tr_b16 a[176:177], v25 offset:32768
    ds_read_b64_tr_b16 a[178:179], v25 offset:36864
    v_mfma_f32_16x16x32_bf16 v[100:103], a[228:231], v[156:159], v[100:103]
    buffer_load_dwordx4 v255, s[84:87], s57 offen lds
    v_mfma_f32_16x16x32_bf16 v[100:103], a[224:227], v[140:143], v[100:103]
    ds_read_b64_tr_b16 a[180:181], v25 offset:40960
    ds_read_b64_tr_b16 a[182:183], v25 offset:45056
    v_mfma_f32_16x16x32_bf16 v[100:103], a[220:223], v[180:183], v[100:103]
    ds_read_b64_tr_b16 a[184:185], v25 offset:49152
    v_mfma_f32_16x16x32_bf16 v[100:103], a[216:219], v[196:199], v[100:103]
    ds_read_b64_tr_b16 a[186:187], v25 offset:53248
    v_mfma_f32_16x16x32_bf16 v[100:103], a[212:215], v[148:151], v[100:103]
    buffer_load_dwordx2 v[94:95], v58, s[12:15], 0 offen offset:1056
    v_mfma_f32_16x16x32_bf16 v[100:103], a[208:211], v[132:135], v[100:103]
    s_waitcnt lgkmcnt(12)
    ds_read_b64_tr_b16 a[188:189], v25 offset:57344
    ds_read_b64_tr_b16 a[190:191], v25 offset:61440
    v_mfma_f32_16x16x32_bf16 v[104:107], a[160:163], v[128:131], 0
    s_waitcnt lgkmcnt(12)
    s_add_u32 s57, s59, 20480
    ds_read_b64_tr_b16 a[208:209], v22 offset:32768
    v_mfma_f32_16x16x32_bf16 v[104:107], a[164:167], v[144:147], v[104:107]
    s_waitcnt lgkmcnt(11)
    s_add_u32 m0, s6, -81920
    ds_read_b64_tr_b16 a[210:211], v22 offset:36864
    v_mfma_f32_16x16x32_bf16 v[104:107], a[168:171], v[192:195], v[104:107]
    s_waitcnt lgkmcnt(10)
    buffer_load_dwordx4 v255, s[84:87], s57 offen lds
    v_mfma_f32_16x16x32_bf16 v[104:107], a[172:175], v[176:179], v[104:107]
    s_waitcnt lgkmcnt(8)
    s_mov_b32 s45, 19840
    ds_read_b64_tr_b16 a[212:213], v22 offset:40960
    ds_read_b64_tr_b16 a[214:215], v22 offset:45056
    v_mfma_f32_16x16x32_bf16 v[104:107], a[176:179], v[136:139], v[104:107]
    s_waitcnt lgkmcnt(8)
    s_add_u32 s57, s59, 24576
    buffer_load_dwordx4 v[64:67], v5, s[24:27], s45 offen offset:0 sc1
    v_mfma_f32_16x16x32_bf16 v[104:107], a[180:183], v[152:155], v[104:107]
    s_waitcnt lgkmcnt(6)
    s_add_u32 m0, s6, -77824
    ds_read_b64_tr_b16 a[216:217], v22 offset:49152
    ds_read_b64_tr_b16 a[218:219], v22 offset:53248
    v_mfma_f32_16x16x32_bf16 v[104:107], a[184:187], v[200:203], v[104:107]
    s_waitcnt lgkmcnt(6)
    buffer_load_dwordx4 v255, s[84:87], s57 offen lds
    v_mfma_f32_16x16x32_bf16 v[104:107], a[188:191], v[184:187], v[104:107]
    ds_read_b64_tr_b16 a[220:221], v22 offset:57344
    ds_read_b64_tr_b16 a[222:223], v22 offset:61440
    v_mfma_f32_16x16x32_bf16 v[108:111], a[188:191], v[188:191], 0
    s_add_u32 s57, s59, 28672
    ds_read_b64_tr_b16 a[224:225], v26 offset:32768
    v_mfma_f32_16x16x32_bf16 v[108:111], a[184:187], v[204:207], v[108:111]
    s_add_u32 m0, s6, -73728
    ds_read_b64_tr_b16 a[226:227], v26 offset:36864
    v_mfma_f32_16x16x32_bf16 v[108:111], a[180:183], v[156:159], v[108:111]
    buffer_load_dwordx4 v255, s[84:87], s57 offen lds
    v_mfma_f32_16x16x32_bf16 v[108:111], a[176:179], v[140:143], v[108:111]
    ds_read_b64_tr_b16 a[228:229], v26 offset:40960
    ds_read_b64_tr_b16 a[230:231], v26 offset:45056
    v_mfma_f32_16x16x32_bf16 v[108:111], a[172:175], v[180:183], v[108:111]
    s_add_u32 s57, s59, 32768
    buffer_load_dwordx4 v[68:71], v5, s[24:27], s45 offen offset:512 sc1
    v_mfma_f32_16x16x32_bf16 v[108:111], a[168:171], v[196:199], v[108:111]
    s_add_u32 m0, s6, -69632
    ds_read_b64_tr_b16 a[232:233], v26 offset:49152
    ds_read_b64_tr_b16 a[234:235], v26 offset:53248
    v_mfma_f32_16x16x32_bf16 v[108:111], a[164:167], v[148:151], v[108:111]
    buffer_load_dwordx4 v255, s[84:87], s57 offen lds
    v_mfma_f32_16x16x32_bf16 v[108:111], a[160:163], v[132:135], v[108:111]
    s_waitcnt lgkmcnt(12)
    ds_read_b64_tr_b16 a[236:237], v26 offset:57344
    ds_read_b64_tr_b16 a[238:239], v26 offset:61440
    v_mfma_f32_16x16x32_bf16 v[112:115], a[208:211], v[128:131], 0
    s_waitcnt lgkmcnt(12)
    ds_read_b64_tr_b16 a[160:161], v23 offset:32768
    v_mfma_f32_16x16x32_bf16 v[112:115], a[212:215], v[144:147], v[112:115]
    s_waitcnt lgkmcnt(11)
    ds_read_b64_tr_b16 a[162:163], v23 offset:36864
    v_mfma_f32_16x16x32_bf16 v[112:115], a[216:219], v[192:195], v[112:115]
    s_waitcnt lgkmcnt(10)
    ds_read_b64_tr_b16 a[164:165], v23 offset:40960
    v_mfma_f32_16x16x32_bf16 v[112:115], a[220:223], v[176:179], v[112:115]
    s_waitcnt lgkmcnt(9)
    ds_read_b64_tr_b16 a[166:167], v23 offset:45056
    v_mfma_f32_16x16x32_bf16 v[112:115], a[224:227], v[136:139], v[112:115]
    s_waitcnt lgkmcnt(8)
    buffer_load_dwordx4 v[72:75], v59, s[24:27], s45 offen offset:1024 sc1
    v_mfma_f32_16x16x32_bf16 v[112:115], a[228:231], v[152:155], v[112:115]
    s_waitcnt lgkmcnt(6)
    ds_read_b64_tr_b16 a[168:169], v23 offset:49152
    ds_read_b64_tr_b16 a[170:171], v23 offset:53248
    v_mfma_f32_16x16x32_bf16 v[112:115], a[232:235], v[200:203], v[112:115]
    s_waitcnt lgkmcnt(6)
    ds_read_b64_tr_b16 a[172:173], v23 offset:57344
    v_mfma_f32_16x16x32_bf16 v[112:115], a[236:239], v[184:187], v[112:115]
    ds_read_b64_tr_b16 a[174:175], v23 offset:61440
    v_mfma_f32_16x16x32_bf16 v[116:119], a[236:239], v[188:191], 0
    buffer_load_dwordx2 v[76:77], v3, s[20:23], 0 offen offset:0
    v_mfma_f32_16x16x32_bf16 v[116:119], a[232:235], v[204:207], v[116:119]
    ds_read_b64_tr_b16 a[176:177], v27 offset:32768
    ds_read_b64_tr_b16 a[178:179], v27 offset:36864
    v_mfma_f32_16x16x32_bf16 v[116:119], a[228:231], v[156:159], v[116:119]
    ds_read_b64_tr_b16 a[180:181], v27 offset:40960
    v_mfma_f32_16x16x32_bf16 v[116:119], a[224:227], v[140:143], v[116:119]
    ds_read_b64_tr_b16 a[182:183], v27 offset:45056
    v_mfma_f32_16x16x32_bf16 v[116:119], a[220:223], v[180:183], v[116:119]
    buffer_load_dwordx2 v[78:79], v3, s[20:23], 0 offen offset:32
    v_mfma_f32_16x16x32_bf16 v[116:119], a[216:219], v[196:199], v[116:119]
    ds_read_b64_tr_b16 a[184:185], v27 offset:49152
    ds_read_b64_tr_b16 a[186:187], v27 offset:53248
    v_mfma_f32_16x16x32_bf16 v[116:119], a[212:215], v[148:151], v[116:119]
    ds_read_b64_tr_b16 a[188:189], v27 offset:57344
    v_mfma_f32_16x16x32_bf16 v[116:119], a[208:211], v[132:135], v[116:119]
    ds_read_b64_tr_b16 a[190:191], v27 offset:61440
    s_waitcnt vmcnt(25)
    s_waitcnt lgkmcnt(0)
    s_barrier
    v_mfma_f32_16x16x32_bf16 v[120:123], a[160:163], v[128:131], 0
    ds_read_b64_tr_b16 a[208:209], v12 offset:0
    v_mfma_f32_16x16x32_bf16 v[120:123], a[164:167], v[144:147], v[120:123]
    ds_read_b64_tr_b16 a[210:211], v12 offset:4096
    v_mfma_f32_16x16x32_bf16 v[120:123], a[168:171], v[192:195], v[120:123]
    buffer_load_dwordx2 v[80:81], v3, s[20:23], 0 offen offset:512
    v_mfma_f32_16x16x32_bf16 v[120:123], a[172:175], v[176:179], v[120:123]
    s_add_u32 s39, s39, 16
    ds_read_b64_tr_b16 a[212:213], v12 offset:8192
    ds_read_b64_tr_b16 a[214:215], v12 offset:12288
    v_mfma_f32_16x16x32_bf16 v[120:123], a[176:179], v[136:139], v[120:123]
    buffer_load_dword v11, v9, s[24:27], s39 offen sc1
    v_mfma_f32_16x16x32_bf16 v[120:123], a[180:183], v[152:155], v[120:123]
    ds_read_b64_tr_b16 a[216:217], v12 offset:16384
    ds_read_b64_tr_b16 a[218:219], v12 offset:20480
    v_mfma_f32_16x16x32_bf16 v[120:123], a[184:187], v[200:203], v[120:123]
    ds_read_b64_tr_b16 a[220:221], v12 offset:24576
    v_mfma_f32_16x16x32_bf16 v[120:123], a[188:191], v[184:187], v[120:123]
    ds_read_b64_tr_b16 a[222:223], v12 offset:28672
    v_mfma_f32_16x16x32_bf16 v[124:127], a[188:191], v[188:191], 0
    buffer_load_dwordx2 v[82:83], v3, s[20:23], 0 offen offset:544
    v_mfma_f32_16x16x32_bf16 v[124:127], a[184:187], v[204:207], v[124:127]
    ds_read_b64_tr_b16 a[224:225], v16 offset:0
    ds_read_b64_tr_b16 a[226:227], v16 offset:4096
    v_mfma_f32_16x16x32_bf16 v[124:127], a[180:183], v[156:159], v[124:127]
    ds_read_b64_tr_b16 a[228:229], v16 offset:8192
    v_mfma_f32_16x16x32_bf16 v[124:127], a[176:179], v[140:143], v[124:127]
    ds_read_b64_tr_b16 a[230:231], v16 offset:12288
    v_mfma_f32_16x16x32_bf16 v[124:127], a[172:175], v[180:183], v[124:127]
    buffer_load_dwordx2 v[84:85], v55, s[20:23], 0 offen offset:1024
    v_mfma_f32_16x16x32_bf16 v[124:127], a[168:171], v[196:199], v[124:127]
    ds_read_b64_tr_b16 a[232:233], v16 offset:16384
    ds_read_b64_tr_b16 a[234:235], v16 offset:20480
    v_mfma_f32_16x16x32_bf16 v[124:127], a[164:167], v[148:151], v[124:127]
    ds_read_b64_tr_b16 a[236:237], v16 offset:24576
    v_mfma_f32_16x16x32_bf16 v[124:127], a[160:163], v[132:135], v[124:127]
    s_waitcnt lgkmcnt(13)
    ds_read_b64_tr_b16 a[238:239], v16 offset:28672
    v_mfma_f32_16x16x32_bf16 v[96:99], a[208:211], a[64:67], v[96:99]
    s_waitcnt lgkmcnt(12)
    buffer_load_dwordx2 v[86:87], v55, s[20:23], 0 offen offset:1056
    v_mfma_f32_16x16x32_bf16 v[96:99], a[212:215], a[68:71], v[96:99]
    s_waitcnt lgkmcnt(10)
    ds_read_b64_tr_b16 a[160:161], v13 offset:0
    ds_read_b64_tr_b16 a[162:163], v13 offset:4096
    v_mfma_f32_16x16x32_bf16 v[96:99], a[216:219], a[72:75], v[96:99]
    s_waitcnt lgkmcnt(10)
    ds_read_b64_tr_b16 a[164:165], v13 offset:8192
    v_mfma_f32_16x16x32_bf16 v[96:99], a[220:223], a[76:79], v[96:99]
    s_waitcnt lgkmcnt(9)
    ds_read_b64_tr_b16 a[166:167], v13 offset:12288
    v_mfma_f32_16x16x32_bf16 v[96:99], a[224:227], a[80:83], v[96:99]
    s_waitcnt lgkmcnt(8)
Ltour0_11:
    s_cbranch_execz Lmain0
    ds_read_b64_tr_b16 a[168:169], v13 offset:16384
    v_mfma_f32_16x16x32_bf16 v[96:99], a[228:231], a[84:87], v[96:99]
    s_waitcnt lgkmcnt(7)
    s_mov_b32 s45, 22144
    ds_read_b64_tr_b16 a[170:171], v13 offset:20480
    v_mfma_f32_16x16x32_bf16 v[96:99], a[232:235], a[88:91], v[96:99]
    s_waitcnt lgkmcnt(6)
    buffer_load_dwordx4 v[216:219], v5, s[24:27], s45 offen offset:0 sc1
    v_mfma_f32_16x16x32_bf16 v[96:99], a[236:239], a[92:95], v[96:99]
    ds_read_b64_tr_b16 a[172:173], v13 offset:24576
    ds_read_b64_tr_b16 a[174:175], v13 offset:28672
    v_mfma_f32_16x16x32_bf16 v[100:103], a[236:239], a[124:127], v[100:103]
    ds_read_b64_tr_b16 a[176:177], v17 offset:0
    v_mfma_f32_16x16x32_bf16 v[100:103], a[232:235], a[120:123], v[100:103]
    ds_read_b64_tr_b16 a[178:179], v17 offset:4096
    v_mfma_f32_16x16x32_bf16 v[100:103], a[228:231], a[116:119], v[100:103]
    buffer_load_dwordx4 v[220:223], v5, s[24:27], s45 offen offset:512 sc1
    v_mfma_f32_16x16x32_bf16 v[100:103], a[224:227], a[112:115], v[100:103]
    ds_read_b64_tr_b16 a[180:181], v17 offset:8192
    ds_read_b64_tr_b16 a[182:183], v17 offset:12288
    v_mfma_f32_16x16x32_bf16 v[100:103], a[220:223], a[108:111], v[100:103]
    ds_read_b64_tr_b16 a[184:185], v17 offset:16384
    v_cvt_pk_bf16_f32 v224, v96, v97
    v_mfma_f32_16x16x32_bf16 v[100:103], a[216:219], a[104:107], v[100:103]
    ds_read_b64_tr_b16 a[186:187], v17 offset:20480
    v_cvt_pk_bf16_f32 v225, v98, v99
    v_mfma_f32_16x16x32_bf16 v[100:103], a[212:215], a[100:103], v[100:103]
    ds_read_b64_tr_b16 a[188:189], v17 offset:24576
    v_mfma_f32_16x16x32_bf16 v[100:103], a[208:211], a[96:99], v[100:103]
    s_waitcnt lgkmcnt(13)
    ds_read_b64_tr_b16 a[190:191], v17 offset:28672
    v_mfma_f32_16x16x32_bf16 v[104:107], a[160:163], a[64:67], v[104:107]
    s_waitcnt lgkmcnt(12)
    buffer_load_dwordx4 v[88:91], v59, s[24:27], s45 offen offset:1024 sc1
    v_mfma_f32_16x16x32_bf16 v[104:107], a[164:167], a[68:71], v[104:107]
    s_waitcnt lgkmcnt(10)
    ds_read_b64_tr_b16 a[208:209], v14 offset:0
    ds_read_b64_tr_b16 a[210:211], v14 offset:4096
    v_mfma_f32_16x16x32_bf16 v[104:107], a[168:171], a[72:75], v[104:107]
    s_waitcnt lgkmcnt(10)
    ds_read_b64_tr_b16 a[212:213], v14 offset:8192
    v_mfma_f32_16x16x32_bf16 v[104:107], a[172:175], a[76:79], v[104:107]
    s_waitcnt lgkmcnt(9)
    ds_read_b64_tr_b16 a[214:215], v14 offset:12288
    v_mfma_f32_16x16x32_bf16 v[104:107], a[176:179], a[80:83], v[104:107]
    s_waitcnt lgkmcnt(8)
    ds_read_b64_tr_b16 a[216:217], v14 offset:16384
    v_cvt_pk_bf16_f32 v228, v100, v101
    v_mfma_f32_16x16x32_bf16 v[104:107], a[180:183], a[84:87], v[104:107]
    s_waitcnt lgkmcnt(7)
    ds_read_b64_tr_b16 a[218:219], v14 offset:20480
    v_cvt_pk_bf16_f32 v229, v102, v103
    v_mfma_f32_16x16x32_bf16 v[104:107], a[184:187], a[88:91], v[104:107]
    s_waitcnt lgkmcnt(6)
    ds_read_b64_tr_b16 a[220:221], v14 offset:24576
    v_mfma_f32_16x16x32_bf16 v[104:107], a[188:191], a[92:95], v[104:107]
    ds_read_b64_tr_b16 a[222:223], v14 offset:28672
    v_mfma_f32_16x16x32_bf16 v[108:111], a[188:191], a[124:127], v[108:111]
    ds_read_b64_tr_b16 a[224:225], v18 offset:0
    v_mfma_f32_16x16x32_bf16 v[108:111], a[184:187], a[120:123], v[108:111]
    ds_read_b64_tr_b16 a[226:227], v18 offset:4096
    v_mfma_f32_16x16x32_bf16 v[108:111], a[180:183], a[116:119], v[108:111]
    ds_read_b64_tr_b16 a[228:229], v18 offset:8192
    v_mfma_f32_16x16x32_bf16 v[108:111], a[176:179], a[112:115], v[108:111]
    ds_read_b64_tr_b16 a[230:231], v18 offset:12288
    v_mfma_f32_16x16x32_bf16 v[108:111], a[172:175], a[108:111], v[108:111]
    ds_read_b64_tr_b16 a[232:233], v18 offset:16384
    v_cvt_pk_bf16_f32 v226, v104, v105
    v_mfma_f32_16x16x32_bf16 v[108:111], a[168:171], a[104:107], v[108:111]
    s_add_u32 s38, s93, 1536
    ds_read_b64_tr_b16 a[234:235], v18 offset:20480
    v_cvt_pk_bf16_f32 v227, v106, v107
    v_mfma_f32_16x16x32_bf16 v[108:111], a[164:167], a[100:103], v[108:111]
    buffer_store_dwordx4 v[224:227], v56, s[28:31], s38 offen sc1
    v_mfma_f32_16x16x32_bf16 v[108:111], a[160:163], a[96:99], v[108:111]
    s_waitcnt lgkmcnt(12)
    ds_read_b64_tr_b16 a[236:237], v18 offset:24576
    ds_read_b64_tr_b16 a[238:239], v18 offset:28672
    v_mfma_f32_16x16x32_bf16 v[112:115], a[208:211], a[64:67], v[112:115]
    s_waitcnt lgkmcnt(12)
    ds_read_b64_tr_b16 a[160:161], v15 offset:0
    v_mfma_f32_16x16x32_bf16 v[112:115], a[212:215], a[68:71], v[112:115]
    s_waitcnt lgkmcnt(11)
    ds_read_b64_tr_b16 a[162:163], v15 offset:4096
    v_mfma_f32_16x16x32_bf16 v[112:115], a[216:219], a[72:75], v[112:115]
    s_waitcnt lgkmcnt(10)
    ds_read_b64_tr_b16 a[164:165], v15 offset:8192
    v_mfma_f32_16x16x32_bf16 v[112:115], a[220:223], a[76:79], v[112:115]
    s_waitcnt lgkmcnt(9)
    ds_read_b64_tr_b16 a[166:167], v15 offset:12288
    v_mfma_f32_16x16x32_bf16 v[112:115], a[224:227], a[80:83], v[112:115]
    s_waitcnt lgkmcnt(8)
    ds_read_b64_tr_b16 a[168:169], v15 offset:16384
    v_cvt_pk_bf16_f32 v230, v108, v109
    v_mfma_f32_16x16x32_bf16 v[112:115], a[228:231], a[84:87], v[112:115]
    s_waitcnt lgkmcnt(7)
    s_add_u32 s38, s93, 165376
    ds_read_b64_tr_b16 a[170:171], v15 offset:20480
    v_cvt_pk_bf16_f32 v231, v110, v111
    v_mfma_f32_16x16x32_bf16 v[112:115], a[232:235], a[88:91], v[112:115]
    s_waitcnt lgkmcnt(6)
    buffer_store_dwordx4 v[228:231], v56, s[28:31], s38 offen sc1
    v_mfma_f32_16x16x32_bf16 v[112:115], a[236:239], a[92:95], v[112:115]
    ds_read_b64_tr_b16 a[172:173], v15 offset:24576
    ds_read_b64_tr_b16 a[174:175], v15 offset:28672
    v_mfma_f32_16x16x32_bf16 v[116:119], a[236:239], a[124:127], v[116:119]
    ds_read_b64_tr_b16 a[176:177], v19 offset:0
    v_mfma_f32_16x16x32_bf16 v[116:119], a[232:235], a[120:123], v[116:119]
    ds_read_b64_tr_b16 a[178:179], v19 offset:4096
    v_mfma_f32_16x16x32_bf16 v[116:119], a[228:231], a[116:119], v[116:119]
    ds_read_b64_tr_b16 a[180:181], v19 offset:8192
    v_mfma_f32_16x16x32_bf16 v[116:119], a[224:227], a[112:115], v[116:119]
    ds_read_b64_tr_b16 a[182:183], v19 offset:12288
    v_mfma_f32_16x16x32_bf16 v[116:119], a[220:223], a[108:111], v[116:119]
    ds_read_b64_tr_b16 a[184:185], v19 offset:16384
    v_cvt_pk_bf16_f32 v232, v112, v113
    v_mfma_f32_16x16x32_bf16 v[116:119], a[216:219], a[104:107], v[116:119]
    ds_read_b64_tr_b16 a[186:187], v19 offset:20480
    v_cvt_pk_bf16_f32 v233, v114, v115
    v_mfma_f32_16x16x32_bf16 v[116:119], a[212:215], a[100:103], v[116:119]
    ds_read_b64_tr_b16 a[188:189], v19 offset:24576
    v_mfma_f32_16x16x32_bf16 v[116:119], a[208:211], a[96:99], v[116:119]
    s_waitcnt lgkmcnt(13)
    ds_read_b64_tr_b16 a[190:191], v19 offset:28672
    v_mfma_f32_16x16x32_bf16 v[120:123], a[160:163], a[64:67], v[120:123]
    s_waitcnt lgkmcnt(12)
    v_mfma_f32_16x16x32_bf16 v[120:123], a[164:167], a[68:71], v[120:123]
    s_waitcnt lgkmcnt(10)
    v_mfma_f32_16x16x32_bf16 v[120:123], a[168:171], a[72:75], v[120:123]
    s_waitcnt lgkmcnt(8)
    v_mfma_f32_16x16x32_bf16 v[120:123], a[172:175], a[76:79], v[120:123]
    s_waitcnt lgkmcnt(6)
    v_mfma_f32_16x16x32_bf16 v[120:123], a[176:179], a[80:83], v[120:123]
    s_waitcnt lgkmcnt(4)
    v_cvt_pk_bf16_f32 v236, v116, v117
    v_mfma_f32_16x16x32_bf16 v[120:123], a[180:183], a[84:87], v[120:123]
    s_waitcnt lgkmcnt(2)
    v_cvt_pk_bf16_f32 v237, v118, v119
    v_mfma_f32_16x16x32_bf16 v[120:123], a[184:187], a[88:91], v[120:123]
    s_waitcnt lgkmcnt(0)
    v_mfma_f32_16x16x32_bf16 v[120:123], a[188:191], a[92:95], v[120:123]
    v_mfma_f32_16x16x32_bf16 v[124:127], a[188:191], a[124:127], v[124:127]
    v_mfma_f32_16x16x32_bf16 v[124:127], a[184:187], a[120:123], v[124:127]
    v_mfma_f32_16x16x32_bf16 v[124:127], a[180:183], a[116:119], v[124:127]
    v_mfma_f32_16x16x32_bf16 v[124:127], a[176:179], a[112:115], v[124:127]
    v_mfma_f32_16x16x32_bf16 v[124:127], a[172:175], a[108:111], v[124:127]
    s_nop 2
    v_cvt_pk_bf16_f32 v234, v120, v121
    v_mfma_f32_16x16x32_bf16 v[124:127], a[168:171], a[104:107], v[124:127]
    s_add_u32 s38, s93, 1664
    v_cvt_pk_bf16_f32 v235, v122, v123
    v_mfma_f32_16x16x32_bf16 v[124:127], a[164:167], a[100:103], v[124:127]
    buffer_store_dwordx4 v[232:235], v56, s[28:31], s38 offen sc1
    v_mfma_f32_16x16x32_bf16 v[124:127], a[160:163], a[96:99], v[124:127]
    s_nop 7
    v_cvt_pk_bf16_f32 v238, v124, v125
    s_add_u32 s38, s93, 165504
    v_cvt_pk_bf16_f32 v239, v126, v127
    buffer_store_dwordx4 v[236:239], v56, s[28:31], s38 offen sc1
    s_add_u32 s92, s92, 16
    s_waitcnt vmcnt(35)
    v_lshlrev_b32 v96, 16, v160
    v_and_b32 v97, 0xffff0000, v160
    v_lshlrev_b32 v98, 16, v161
    v_and_b32 v99, 0xffff0000, v161
    v_lshlrev_b32 v100, 16, v162
    v_and_b32 v101, 0xffff0000, v162
    v_lshlrev_b32 v102, 16, v163
    v_and_b32 v103, 0xffff0000, v163
    s_waitcnt vmcnt(34)
    v_lshlrev_b32 v104, 16, v164
    v_and_b32 v105, 0xffff0000, v164
    v_lshlrev_b32 v106, 16, v165
    v_and_b32 v107, 0xffff0000, v165
    v_lshlrev_b32 v108, 16, v166
    v_and_b32 v109, 0xffff0000, v166
    v_lshlrev_b32 v110, 16, v167
    v_and_b32 v111, 0xffff0000, v167
    s_waitcnt vmcnt(32)
    v_lshlrev_b32 v112, 16, v168
    v_and_b32 v113, 0xffff0000, v168
    v_lshlrev_b32 v114, 16, v169
    v_and_b32 v115, 0xffff0000, v169
    v_lshlrev_b32 v116, 16, v170
    v_and_b32 v117, 0xffff0000, v170
    v_lshlrev_b32 v118, 16, v171
    v_and_b32 v119, 0xffff0000, v171
    s_waitcnt vmcnt(31)
    v_lshlrev_b32 v120, 16, v172
    v_and_b32 v121, 0xffff0000, v172
    v_lshlrev_b32 v122, 16, v173
    v_and_b32 v123, 0xffff0000, v173
    v_lshlrev_b32 v124, 16, v174
    v_and_b32 v125, 0xffff0000, v174
    v_lshlrev_b32 v126, 16, v175
    v_and_b32 v127, 0xffff0000, v175
    s_waitcnt vmcnt(30)
    v_lshlrev_b32 v128, 16, v208
    v_and_b32 v129, 0xffff0000, v208
    v_lshlrev_b32 v130, 16, v209
    v_and_b32 v131, 0xffff0000, v209
    v_lshlrev_b32 v132, 16, v210
    v_and_b32 v133, 0xffff0000, v210
    v_lshlrev_b32 v134, 16, v211
    v_and_b32 v135, 0xffff0000, v211
    s_waitcnt vmcnt(28)
    v_lshlrev_b32 v136, 16, v212
    v_and_b32 v137, 0xffff0000, v212
    v_lshlrev_b32 v138, 16, v213
    v_and_b32 v139, 0xffff0000, v213
    v_lshlrev_b32 v140, 16, v214
    v_and_b32 v141, 0xffff0000, v214
    v_lshlrev_b32 v142, 16, v215
    v_and_b32 v143, 0xffff0000, v215
    s_waitcnt vmcnt(19)
    v_lshlrev_b32 v144, 16, v64
    v_and_b32 v145, 0xffff0000, v64
    v_lshlrev_b32 v146, 16, v65
    v_and_b32 v147, 0xffff0000, v65
    v_lshlrev_b32 v148, 16, v66
    v_and_b32 v149, 0xffff0000, v66
    v_lshlrev_b32 v150, 16, v67
    v_and_b32 v151, 0xffff0000, v67
    s_waitcnt vmcnt(16)
    v_lshlrev_b32 v152, 16, v68
    v_and_b32 v153, 0xffff0000, v68
    v_lshlrev_b32 v154, 16, v69
    v_and_b32 v155, 0xffff0000, v69
    v_lshlrev_b32 v156, 16, v70
    v_and_b32 v157, 0xffff0000, v70
    v_lshlrev_b32 v158, 16, v71
    v_and_b32 v159, 0xffff0000, v71
    s_waitcnt vmcnt(14)
    v_lshlrev_b32 v160, 16, v72
    v_and_b32 v161, 0xffff0000, v72
    v_lshlrev_b32 v162, 16, v73
    v_and_b32 v163, 0xffff0000, v73
    v_lshlrev_b32 v164, 16, v74
    v_and_b32 v165, 0xffff0000, v74
    v_lshlrev_b32 v166, 16, v75
    v_and_b32 v167, 0xffff0000, v75
    s_waitcnt vmcnt(13)
    v_lshlrev_b32 v168, 16, v76
    v_and_b32 v169, 0xffff0000, v76
    v_lshlrev_b32 v170, 16, v77
    v_and_b32 v171, 0xffff0000, v77
    s_waitcnt vmcnt(12)
    v_lshlrev_b32 v172, 16, v78
    v_and_b32 v173, 0xffff0000, v78
    v_lshlrev_b32 v174, 16, v79
    v_and_b32 v175, 0xffff0000, v79
    s_waitcnt vmcnt(11)
    v_lshlrev_b32 v176, 16, v80
    v_and_b32 v177, 0xffff0000, v80
    v_lshlrev_b32 v178, 16, v81
    v_and_b32 v179, 0xffff0000, v81
    s_waitcnt vmcnt(9)
    v_lshlrev_b32 v180, 16, v82
    v_and_b32 v181, 0xffff0000, v82
    v_lshlrev_b32 v182, 16, v83
    v_and_b32 v183, 0xffff0000, v83
    s_waitcnt vmcnt(8)
    v_lshlrev_b32 v184, 16, v84
    v_and_b32 v185, 0xffff0000, v84
    v_lshlrev_b32 v186, 16, v85
    v_and_b32 v187, 0xffff0000, v85
    s_waitcnt vmcnt(7)
    v_lshlrev_b32 v188, 16, v86
    v_and_b32 v189, 0xffff0000, v86
    v_lshlrev_b32 v190, 16, v87
    v_and_b32 v191, 0xffff0000, v87
    s_waitcnt vmcnt(0)
    buffer_store_dword v10, v8, s[24:27], s92 offen sc1
    v_cmp_ne_u32 s[54:55], s95, v11
    s_cmp_lg_u64 s[54:55], 0
    s_cbranch_scc1 Ltail_spin1
Ltail_got1:
    s_add_u32 s56, s44, 16384
    buffer_load_dwordx4 a[0:3], v54, s[28:31], s56 offen offset:0 sc1
    buffer_load_dwordx4 a[4:7], v54, s[28:31], s56 offen offset:1024 sc1
    buffer_load_dwordx4 a[8:11], v54, s[28:31], s56 offen offset:2048 sc1
    buffer_load_dwordx4 a[12:15], v54, s[28:31], s56 offen offset:3072 sc1
    s_add_u32 s56, s44, 0
    buffer_load_dwordx4 a[16:19], v2, s[28:31], s56 offen offset:0 sc1
    s_add_u32 s56, s44, 4096
    buffer_load_dwordx4 a[20:23], v2, s[28:31], s56 offen offset:0 sc1
    s_add_u32 s56, s44, 8192
    buffer_load_dwordx4 a[24:27], v2, s[28:31], s56 offen offset:0 sc1
    s_add_u32 s56, s44, 12288
    buffer_load_dwordx4 a[28:31], v2, s[28:31], s56 offen offset:0 sc1
    ds_write_b128 v51, a[128:131] offset:0
    ds_write_b128 v51, a[132:135] offset:4096
    ds_write_b128 v51, a[136:139] offset:8192
    ds_write_b128 v51, a[140:143] offset:12288
    ds_write_b128 v51, a[144:147] offset:16384
    ds_write_b128 v51, a[148:151] offset:20480
    ds_write_b128 v51, a[152:155] offset:24576
    ds_write_b128 v51, a[156:159] offset:28672
    ds_write_b128 v51, a[240:243] offset:32768
    ds_write_b128 v255, a[244:247] offset:40960
    ds_write_b128 v255, a[248:251] offset:45056
    ds_write_b128 v255, a[252:255] offset:61440
    v_lshlrev_b32 v12, 16, v36
    v_and_b32 v13, 0xffff0000, v36
    v_lshlrev_b32 v14, 16, v37
    v_and_b32 v15, 0xffff0000, v37
    v_lshlrev_b32 v16, 16, v38
    v_and_b32 v17, 0xffff0000, v38
    v_lshlrev_b32 v18, 16, v39
    v_and_b32 v19, 0xffff0000, v39
    v_lshlrev_b32 v20, 16, v40
    v_and_b32 v21, 0xffff0000, v40
    v_lshlrev_b32 v22, 16, v41
    v_and_b32 v23, 0xffff0000, v41
    v_lshlrev_b32 v24, 16, v42
    v_and_b32 v25, 0xffff0000, v42
    v_lshlrev_b32 v26, 16, v43
    v_and_b32 v27, 0xffff0000, v43
    v_lshlrev_b32 v28, 16, v92
    v_and_b32 v29, 0xffff0000, v92
    v_lshlrev_b32 v30, 16, v93
    v_and_b32 v31, 0xffff0000, v93
    v_lshlrev_b32 v32, 16, v94
    v_and_b32 v33, 0xffff0000, v94
    v_lshlrev_b32 v34, 16, v95
    v_and_b32 v35, 0xffff0000, v95
    v_lshlrev_b32 v192, 16, v216
    v_and_b32 v193, 0xffff0000, v216
    v_lshlrev_b32 v194, 16, v217
    v_and_b32 v195, 0xffff0000, v217
    v_lshlrev_b32 v196, 16, v218
    v_and_b32 v197, 0xffff0000, v218
    v_lshlrev_b32 v198, 16, v219
    v_and_b32 v199, 0xffff0000, v219
    v_lshlrev_b32 v200, 16, v220
    v_and_b32 v201, 0xffff0000, v220
    v_lshlrev_b32 v202, 16, v221
    v_and_b32 v203, 0xffff0000, v221
    v_lshlrev_b32 v204, 16, v222
    v_and_b32 v205, 0xffff0000, v222
    v_lshlrev_b32 v206, 16, v223
    v_and_b32 v207, 0xffff0000, v223
    v_lshlrev_b32 v208, 16, v88
    v_and_b32 v209, 0xffff0000, v88
    v_lshlrev_b32 v210, 16, v89
    v_and_b32 v211, 0xffff0000, v89
    v_lshlrev_b32 v212, 16, v90
    v_and_b32 v213, 0xffff0000, v90
    v_lshlrev_b32 v214, 16, v91
    v_and_b32 v215, 0xffff0000, v91
    s_add_u32 s39, s39, 16
    buffer_load_dword v11, v9, s[24:27], s39 offen sc1
    s_add_u32 s56, s44, 0
    buffer_load_dwordx4 a[32:35], v2, s[28:31], s56 offen offset:512 sc1
    s_add_u32 s56, s44, 4096
    buffer_load_dwordx4 a[36:39], v2, s[28:31], s56 offen offset:512 sc1
    s_add_u32 s56, s44, 8192
    buffer_load_dwordx4 a[40:43], v2, s[28:31], s56 offen offset:512 sc1
    s_add_u32 s56, s44, 12288
    buffer_load_dwordx4 a[44:47], v2, s[28:31], s56 offen offset:512 sc1
    v_lshrrev_b32 v56, 2, v1
    v_and_b32 v57, 3, v1
    v_lshlrev_b32 v57, 3, v57
    s_and_b32 s36, s3, 1
    s_lshl_b32 s36, s36, 5
    v_lshl_add_u32 v61, v56, 6, v57
    v_add_u32 v61, s36, v61
    s_mov_b32 s36, 135168
    s_mov_b32 s37, 12288
    s_cmp_lt_u32 s3, 2
    s_cselect_b32 s36, 98304, s36
    s_cselect_b32 s37, 98304, s37
    v_add_u32 v94, s37, v61
    v_add_u32 v61, s36, v61
    v_mul_u32_u24 v95, 1152, v56
    s_lshl_b32 s36, s3, 7
    s_add_u32 s36, s36, 61440
    v_add3_u32 v95, v95, v57, s36
    s_waitcnt lgkmcnt(0)
    s_barrier
    ds_read_b64_tr_b16 a[96:97], v61 offset:0
    ds_read_b64_tr_b16 a[98:99], v61 offset:1024
    ds_read_b64_tr_b16 a[100:101], v61 offset:2048
    ds_read_b64_tr_b16 a[102:103], v61 offset:3072
    ds_read_b64_tr_b16 a[104:105], v61 offset:4096
    ds_read_b64_tr_b16 a[106:107], v61 offset:5120
    ds_read_b64_tr_b16 a[108:109], v61 offset:6144
    ds_read_b64_tr_b16 a[110:111], v61 offset:7168
    ds_read_b64_tr_b16 a[112:113], v61 offset:8192
    ds_read_b64_tr_b16 a[114:115], v61 offset:9216
    ds_read_b64_tr_b16 a[116:117], v61 offset:10240
    ds_read_b64_tr_b16 a[118:119], v61 offset:11264
    ds_read_b64_tr_b16 a[120:121], v61 offset:12288
    ds_read_b64_tr_b16 a[122:123], v61 offset:13312
    ds_read_b64_tr_b16 a[124:125], v61 offset:14336
    ds_read_b64_tr_b16 a[126:127], v61 offset:15360
    ds_read_b64_tr_b16 a[128:129], v61 offset:16384
    ds_read_b64_tr_b16 a[130:131], v61 offset:17408
    ds_read_b64_tr_b16 a[132:133], v61 offset:18432
    ds_read_b64_tr_b16 a[134:135], v61 offset:19456
    ds_read_b64_tr_b16 a[136:137], v61 offset:20480
    ds_read_b64_tr_b16 a[138:139], v61 offset:21504
    ds_read_b64_tr_b16 a[140:141], v61 offset:22528
    ds_read_b64_tr_b16 a[142:143], v61 offset:23552
    ds_read_b64_tr_b16 a[144:145], v61 offset:24576
    ds_read_b64_tr_b16 a[146:147], v61 offset:25600
    ds_read_b64_tr_b16 a[148:149], v61 offset:26624
    ds_read_b64_tr_b16 a[150:151], v61 offset:27648
    ds_read_b64_tr_b16 a[152:153], v94 offset:28672
    ds_read_b64_tr_b16 a[154:155], v94 offset:29696
    ds_read_b64_tr_b16 a[156:157], v94 offset:30720
    ds_read_b64_tr_b16 a[158:159], v94 offset:31744
    ds_read_b64_tr_b16 a[160:161], v94 offset:32768
    ds_read_b64_tr_b16 a[162:163], v94 offset:33792
    ds_read_b64_tr_b16 a[164:165], v94 offset:34816
    ds_read_b64_tr_b16 a[166:167], v94 offset:35840
    ds_read_b64_tr_b16 a[168:169], v95 offset:0
    ds_read_b64_tr_b16 a[170:171], v95 offset:18432
    ds_read_b64_tr_b16 a[172:173], v95 offset:32
    ds_read_b64_tr_b16 a[174:175], v95 offset:18464
    ds_read_b64_tr_b16 a[176:177], v95 offset:64
    ds_read_b64_tr_b16 a[178:179], v95 offset:18496
    ds_read_b64_tr_b16 a[180:181], v95 offset:96
    ds_read_b64_tr_b16 a[182:183], v95 offset:18528
    ds_read_b64_tr_b16 a[184:185], v95 offset:512
    ds_read_b64_tr_b16 a[186:187], v95 offset:18944
    ds_read_b64_tr_b16 a[188:189], v95 offset:544
    ds_read_b64_tr_b16 a[190:191], v95 offset:18976
    ds_read_b64_tr_b16 a[192:193], v95 offset:576
    ds_read_b64_tr_b16 a[194:195], v95 offset:19008
    ds_read_b64_tr_b16 a[196:197], v95 offset:608
    ds_read_b64_tr_b16 a[198:199], v95 offset:19040
    ds_read_b64_tr_b16 a[200:201], v95 offset:1024
    ds_read_b64_tr_b16 a[202:203], v95 offset:19456
    ds_read_b64_tr_b16 a[204:205], v95 offset:1056
    ds_read_b64_tr_b16 a[206:207], v95 offset:19488
    ds_read_b64_tr_b16 a[208:209], v95 offset:1088
    ds_read_b64_tr_b16 a[210:211], v95 offset:19520
    ds_read_b64_tr_b16 a[212:213], v95 offset:1120
    ds_read_b64_tr_b16 a[214:215], v95 offset:19552
    s_mov_b64 exec, 0
    s_cmp_eq_u32 s3, 0
    s_cbranch_scc1 Ltour1_0
    s_cmp_eq_u32 s3, 1
    s_cbranch_scc1 Ltour1_1
    s_cmp_eq_u32 s3, 2
    s_cbranch_scc1 Ltour1_2
    s_branch Ltour1_3
Lmain1:
    s_mov_b64 exec, -1
    v_pk_mul_f32 v[62:63], v[144:145], v[168:169]
    v_pk_mul_f32 v[168:169], v[168:169], v[120:121]
    v_pk_fma_f32 v[62:63], v[146:147], v[170:171], v[62:63]
    v_pk_mul_f32 v[170:171], v[170:171], v[122:123]
    v_pk_add_f32 v[88:89], v[168:169], v[170:171]
    v_pk_fma_f32 v[62:63], v[148:149], v[172:173], v[62:63]
    v_pk_mul_f32 v[172:173], v[172:173], v[124:125]
    v_pk_add_f32 v[88:89], v[88:89], v[172:173]
    v_pk_fma_f32 v[62:63], v[150:151], v[174:175], v[62:63]
    v_pk_mul_f32 v[174:175], v[174:175], v[126:127]
    v_pk_add_f32 v[88:89], v[88:89], v[174:175]
    v_pk_fma_f32 v[62:63], v[152:153], v[176:177], v[62:63]
    v_pk_mul_f32 v[176:177], v[176:177], v[128:129]
    v_pk_add_f32 v[88:89], v[88:89], v[176:177]
    v_pk_fma_f32 v[62:63], v[154:155], v[178:179], v[62:63]
    v_pk_mul_f32 v[178:179], v[178:179], v[130:131]
    v_pk_add_f32 v[88:89], v[88:89], v[178:179]
    v_pk_fma_f32 v[62:63], v[156:157], v[180:181], v[62:63]
    v_pk_mul_f32 v[180:181], v[180:181], v[132:133]
    v_pk_add_f32 v[88:89], v[88:89], v[180:181]
    v_pk_fma_f32 v[62:63], v[158:159], v[182:183], v[62:63]
    v_pk_mul_f32 v[182:183], v[182:183], v[134:135]
    v_pk_add_f32 v[88:89], v[88:89], v[182:183]
    v_pk_fma_f32 v[62:63], v[160:161], v[184:185], v[62:63]
    v_pk_mul_f32 v[184:185], v[184:185], v[136:137]
    v_pk_add_f32 v[88:89], v[88:89], v[184:185]
    v_pk_fma_f32 v[62:63], v[162:163], v[186:187], v[62:63]
    v_pk_mul_f32 v[186:187], v[186:187], v[138:139]
    v_pk_add_f32 v[88:89], v[88:89], v[186:187]
    v_pk_fma_f32 v[62:63], v[164:165], v[188:189], v[62:63]
    v_pk_mul_f32 v[188:189], v[188:189], v[140:141]
    v_pk_add_f32 v[88:89], v[88:89], v[188:189]
    v_pk_fma_f32 v[62:63], v[166:167], v[190:191], v[62:63]
    v_pk_mul_f32 v[190:191], v[190:191], v[142:143]
    v_pk_add_f32 v[88:89], v[88:89], v[190:191]
    v_add_f32 v91, v62, v63
    v_add_f32 v90, v88, v89
    s_nop 1
    v_add_f32_dpp v90, v90, v90 row_ror:8 row_mask:0xf bank_mask:0xf
    v_add_f32_dpp v91, v91, v91 row_ror:8 row_mask:0xf bank_mask:0xf
    s_nop 0
    v_add_f32_dpp v90, v90, v90 row_ror:4 row_mask:0xf bank_mask:0xf
    v_add_f32_dpp v91, v91, v91 row_ror:4 row_mask:0xf bank_mask:0xf
    s_nop 0
    v_add_f32_dpp v90, v90, v90 row_ror:2 row_mask:0xf bank_mask:0xf
    v_add_f32_dpp v91, v91, v91 row_ror:2 row_mask:0xf bank_mask:0xf
    s_nop 0
    v_add_f32_dpp v90, v90, v90 row_ror:1 row_mask:0xf bank_mask:0xf
    v_add_f32_dpp v91, v91, v91 row_ror:1 row_mask:0xf bank_mask:0xf
    v_mov_b32 v62, v90
    v_mov_b32 v63, v91
    s_nop 0
    v_permlane16_swap_b32 v90, v62
    v_permlane16_swap_b32 v91, v63
    v_add_f32 v90, v90, v62
    v_add_f32 v91, v91, v63
    v_lshlrev_b32 v92, 2, v7
    v_and_b32 v92, 28, v92
    v_sub_u32 v93, 2047, v7
    s_waitcnt vmcnt(12)
    v_mfma_f32_16x16x32_bf16 v[80:83], v[242:245], a[0:3], 0
    v_mfma_f32_16x16x32_bf16 v[84:87], v[240:243], a[0:3], 0
    s_waitcnt vmcnt(11)
    v_mfma_f32_16x16x32_bf16 v[80:83], v[242:245], a[4:7], v[80:83]
    v_mfma_f32_16x16x32_bf16 v[84:87], v[240:243], a[4:7], v[84:87]
    s_waitcnt vmcnt(10)
    v_mfma_f32_16x16x32_bf16 v[80:83], v[242:245], a[8:11], v[80:83]
    v_mfma_f32_16x16x32_bf16 v[84:87], v[240:243], a[8:11], v[84:87]
    s_waitcnt vmcnt(9)
    v_mfma_f32_16x16x32_bf16 v[80:83], v[242:245], a[12:15], v[80:83]
    v_mfma_f32_16x16x32_bf16 v[84:87], v[240:243], a[12:15], v[84:87]
    s_waitcnt vmcnt(8)
    s_nop 5
    v_mov_b32_dpp v80, v80 row_ror:8 row_mask:0x4 bank_mask:0xf
    v_mov_b32_dpp v81, v81 row_ror:8 row_mask:0x4 bank_mask:0xf
    v_mov_b32_dpp v82, v82 row_ror:8 row_mask:0x4 bank_mask:0xf
    v_mov_b32_dpp v83, v83 row_ror:8 row_mask:0x4 bank_mask:0xf
    v_mov_b32_dpp v84, v84 row_ror:8 row_mask:0x4 bank_mask:0xf
    v_mov_b32_dpp v85, v85 row_ror:8 row_mask:0x4 bank_mask:0xf
    v_mov_b32_dpp v86, v86 row_ror:8 row_mask:0x4 bank_mask:0xf
    v_mov_b32_dpp v87, v87 row_ror:8 row_mask:0x4 bank_mask:0xf
    v_pk_fma_f32 v[28:29], v[112:113], v[80:81], v[28:29]
    v_pk_fma_f32 v[30:31], v[114:115], v[82:83], v[30:31]
    v_pk_fma_f32 v[32:33], v[116:117], v[84:85], v[32:33]
    v_pk_fma_f32 v[34:35], v[118:119], v[86:87], v[34:35]
    v_cvt_pk_bf16_f32 v44, v28, v29
    v_cvt_pk_bf16_f32 v45, v30, v31
    v_cvt_pk_bf16_f32 v46, v32, v33
    v_cvt_pk_bf16_f32 v47, v34, v35
    v_lshlrev_b32 v28, 16, v44
    v_and_b32 v29, 0xffff0000, v44
    v_lshlrev_b32 v30, 16, v45
    v_and_b32 v31, 0xffff0000, v45
    v_lshlrev_b32 v32, 16, v46
    v_and_b32 v33, 0xffff0000, v46
    v_lshlrev_b32 v34, 16, v47
    v_and_b32 v35, 0xffff0000, v47
    v_mfma_f32_16x16x32_bf16 v[64:67], v[246:249], a[16:19], 0
    v_mfma_f32_16x16x32_bf16 v[68:71], v[244:247], a[16:19], 0
    s_waitcnt vmcnt(7)
    v_mfma_f32_16x16x32_bf16 v[64:67], v[246:249], a[20:23], v[64:67]
    v_mfma_f32_16x16x32_bf16 v[68:71], v[244:247], a[20:23], v[68:71]
    s_waitcnt vmcnt(6)
    v_mfma_f32_16x16x32_bf16 v[64:67], v[246:249], a[24:27], v[64:67]
    v_mfma_f32_16x16x32_bf16 v[68:71], v[244:247], a[24:27], v[68:71]
    s_waitcnt vmcnt(5)
    v_mfma_f32_16x16x32_bf16 v[64:67], v[246:249], a[28:31], v[64:67]
    v_mfma_f32_16x16x32_bf16 v[68:71], v[244:247], a[28:31], v[68:71]
    s_waitcnt vmcnt(4)
    v_cmp_ne_u32 s[54:55], s95, v11
    s_cmp_lg_u64 s[54:55], 0
    s_cbranch_scc1 Ltail_spin2
Ltail_got2:
    s_add_u32 s56, s44, 0
    buffer_load_dwordx4 a[48:51], v2, s[28:31], s56 offen offset:1024 sc1
    s_add_u32 s56, s44, 4096
    buffer_load_dwordx4 a[52:55], v2, s[28:31], s56 offen offset:1024 sc1
    s_add_u32 s56, s44, 8192
    buffer_load_dwordx4 a[56:59], v2, s[28:31], s56 offen offset:1024 sc1
    s_add_u32 s56, s44, 12288
    buffer_load_dwordx4 a[60:63], v2, s[28:31], s56 offen offset:1024 sc1
    s_add_u32 s56, s44, 0
    buffer_load_dwordx4 a[64:67], v2, s[28:31], s56 offen offset:1536 sc1
    s_add_u32 s56, s44, 4096
    buffer_load_dwordx4 a[68:71], v2, s[28:31], s56 offen offset:1536 sc1
    s_add_u32 s56, s44, 8192
    buffer_load_dwordx4 a[72:75], v2, s[28:31], s56 offen offset:1536 sc1
    s_add_u32 s56, s44, 12288
    buffer_load_dwordx4 a[76:79], v2, s[28:31], s56 offen offset:1536 sc1
    s_movk_i32 s48, 0x7ff
    s_waitcnt vmcnt(11)
    v_mfma_f32_16x16x32_bf16 v[64:67], v[250:253], a[32:35], v[64:67]
    v_mfma_f32_16x16x32_bf16 v[68:71], v[248:251], a[32:35], v[68:71]
    s_waitcnt vmcnt(10)
    v_mfma_f32_16x16x32_bf16 v[64:67], v[250:253], a[36:39], v[64:67]
    v_mfma_f32_16x16x32_bf16 v[68:71], v[248:251], a[36:39], v[68:71]
    s_waitcnt vmcnt(9)
    v_mfma_f32_16x16x32_bf16 v[64:67], v[250:253], a[40:43], v[64:67]
    v_mfma_f32_16x16x32_bf16 v[68:71], v[248:251], a[40:43], v[68:71]
    s_waitcnt vmcnt(8)
    v_mfma_f32_16x16x32_bf16 v[64:67], v[250:253], a[44:47], v[64:67]
    v_mfma_f32_16x16x32_bf16 v[68:71], v[248:251], a[44:47], v[68:71]
    s_waitcnt vmcnt(7)
    s_nop 5
    v_pk_fma_f32 v[12:13], v[96:97], v[64:65], v[12:13]
    v_pk_fma_f32 v[14:15], v[98:99], v[66:67], v[14:15]
    v_pk_fma_f32 v[16:17], v[100:101], v[68:69], v[16:17]
    v_pk_fma_f32 v[18:19], v[102:103], v[70:71], v[18:19]
    v_cvt_pk_bf16_f32 v36, v12, v13
    v_cvt_pk_bf16_f32 v37, v14, v15
    v_cvt_pk_bf16_f32 v38, v16, v17
    v_cvt_pk_bf16_f32 v39, v18, v19
    v_lshlrev_b32 v12, 16, v36
    v_and_b32 v13, 0xffff0000, v36
    v_lshlrev_b32 v14, 16, v37
    v_and_b32 v15, 0xffff0000, v37
    v_lshlrev_b32 v16, 16, v38
    v_and_b32 v17, 0xffff0000, v38
Ltour1_0:
    s_cbranch_execz Ltour1_4
    v_lshlrev_b32 v18, 16, v39
    v_and_b32 v19, 0xffff0000, v39
    v_pk_add_f32 v[88:89], v[12:13], v[14:15]
    v_pk_add_f32 v[62:63], v[16:17], v[18:19]
    v_pk_add_f32 v[88:89], v[88:89], v[62:63]
    v_add_f32 v88, v88, v89
    s_nop 1
    v_add_f32_dpp v88, v88, v88 row_ror:8 row_mask:0xf bank_mask:0xf
    s_nop 1
    v_add_f32_dpp v88, v88, v88 row_ror:4 row_mask:0xf bank_mask:0xf
    s_nop 1
    v_add_f32_dpp v88, v88, v88 row_ror:2 row_mask:0xf bank_mask:0xf
    s_nop 1
    v_add_f32_dpp v88, v88, v88 row_ror:1 row_mask:0xf bank_mask:0xf
    v_mov_b32 v62, v88
    s_nop 1
    v_permlane16_swap_b32 v88, v62
    s_nop 0
    v_add_f32 v88, v88, v62
    v_mul_f32 v88, 0x3b800000, v88
    v_pk_add_f32 v[232:233], v[28:29], v[88:89] op_sel_hi:[1,0] neg_lo:[0,1] neg_hi:[0,1]
    v_pk_add_f32 v[234:235], v[30:31], v[88:89] op_sel_hi:[1,0] neg_lo:[0,1] neg_hi:[0,1]
    v_pk_add_f32 v[236:237], v[32:33], v[88:89] op_sel_hi:[1,0] neg_lo:[0,1] neg_hi:[0,1]
    v_pk_add_f32 v[238:239], v[34:35], v[88:89] op_sel_hi:[1,0] neg_lo:[0,1] neg_hi:[0,1]
    v_pk_add_f32 v[48:49], v[232:233], v[234:235]
    v_pk_mul_f32 v[50:51], v[232:233], v[232:233]
    v_pk_mul_f32 v[52:53], v[232:233], v[184:185]
    v_pk_fma_f32 v[50:51], v[234:235], v[234:235], v[50:51]
    v_pk_fma_f32 v[52:53], v[234:235], v[186:187], v[52:53]
    v_pk_add_f32 v[48:49], v[48:49], v[236:237]
    v_pk_fma_f32 v[50:51], v[236:237], v[236:237], v[50:51]
    v_pk_fma_f32 v[52:53], v[236:237], v[188:189], v[52:53]
    v_pk_add_f32 v[48:49], v[48:49], v[238:239]
    v_pk_fma_f32 v[50:51], v[238:239], v[238:239], v[50:51]
    v_pk_fma_f32 v[52:53], v[238:239], v[190:191], v[52:53]
    v_cndmask_b32 v48, 0, v48, vcc
    v_cndmask_b32 v49, 0, v49, vcc
    v_cndmask_b32 v50, 0, v50, vcc
    v_cndmask_b32 v51, 0, v51, vcc
    v_pk_add_f32 v[216:217], v[12:13], v[88:89] op_sel_hi:[1,0] neg_lo:[0,1] neg_hi:[0,1]
    v_pk_add_f32 v[218:219], v[14:15], v[88:89] op_sel_hi:[1,0] neg_lo:[0,1] neg_hi:[0,1]
    v_pk_add_f32 v[220:221], v[16:17], v[88:89] op_sel_hi:[1,0] neg_lo:[0,1] neg_hi:[0,1]
    v_pk_add_f32 v[222:223], v[18:19], v[88:89] op_sel_hi:[1,0] neg_lo:[0,1] neg_hi:[0,1]
    v_pk_add_f32 v[48:49], v[48:49], v[216:217]
    v_pk_fma_f32 v[50:51], v[216:217], v[216:217], v[50:51]
    v_pk_fma_f32 v[52:53], v[216:217], v[168:169], v[52:53]
    v_pk_add_f32 v[48:49], v[48:49], v[218:219]
    v_pk_fma_f32 v[50:51], v[218:219], v[218:219], v[50:51]
    v_pk_fma_f32 v[52:53], v[218:219], v[170:171], v[52:53]
    v_pk_add_f32 v[48:49], v[48:49], v[220:221]
    v_pk_fma_f32 v[50:51], v[220:221], v[220:221], v[50:51]
    v_pk_fma_f32 v[52:53], v[220:221], v[172:173], v[52:53]
    v_pk_add_f32 v[48:49], v[48:49], v[222:223]
    v_pk_fma_f32 v[50:51], v[222:223], v[222:223], v[50:51]
    v_pk_fma_f32 v[52:53], v[222:223], v[174:175], v[52:53]
    v_mfma_f32_16x16x32_bf16 v[72:75], v[246:249], a[48:51], 0
    v_mfma_f32_16x16x32_bf16 v[76:79], v[244:247], a[48:51], 0
    s_waitcnt vmcnt(6)
    v_mfma_f32_16x16x32_bf16 v[72:75], v[246:249], a[52:55], v[72:75]
    v_mfma_f32_16x16x32_bf16 v[76:79], v[244:247], a[52:55], v[76:79]
    s_waitcnt vmcnt(5)
    v_mfma_f32_16x16x32_bf16 v[72:75], v[246:249], a[56:59], v[72:75]
    v_mfma_f32_16x16x32_bf16 v[76:79], v[244:247], a[56:59], v[76:79]
    s_waitcnt vmcnt(4)
    v_mfma_f32_16x16x32_bf16 v[72:75], v[246:249], a[60:63], v[72:75]
    v_mfma_f32_16x16x32_bf16 v[76:79], v[244:247], a[60:63], v[76:79]
    s_waitcnt vmcnt(3)
    v_mfma_f32_16x16x32_bf16 v[72:75], v[250:253], a[64:67], v[72:75]
    v_mfma_f32_16x16x32_bf16 v[76:79], v[248:251], a[64:67], v[76:79]
    s_waitcnt vmcnt(2)
    v_mfma_f32_16x16x32_bf16 v[72:75], v[250:253], a[68:71], v[72:75]
    v_mfma_f32_16x16x32_bf16 v[76:79], v[248:251], a[68:71], v[76:79]
    s_waitcnt vmcnt(1)
    v_mfma_f32_16x16x32_bf16 v[72:75], v[250:253], a[72:75], v[72:75]
    v_mfma_f32_16x16x32_bf16 v[76:79], v[248:251], a[72:75], v[76:79]
    s_waitcnt vmcnt(0)
    v_mfma_f32_16x16x32_bf16 v[72:75], v[250:253], a[76:79], v[72:75]
    v_mfma_f32_16x16x32_bf16 v[76:79], v[248:251], a[76:79], v[76:79]
    s_nop 6
    v_pk_fma_f32 v[20:21], v[104:105], v[72:73], v[20:21]
    v_pk_fma_f32 v[22:23], v[106:107], v[74:75], v[22:23]
    v_pk_fma_f32 v[24:25], v[108:109], v[76:77], v[24:25]
    v_pk_fma_f32 v[26:27], v[110:111], v[78:79], v[26:27]
    v_cvt_pk_bf16_f32 v40, v20, v21
    v_cvt_pk_bf16_f32 v41, v22, v23
    v_cvt_pk_bf16_f32 v42, v24, v25
    v_cvt_pk_bf16_f32 v43, v26, v27
    v_lshlrev_b32 v20, 16, v40
    v_and_b32 v21, 0xffff0000, v40
    v_lshlrev_b32 v22, 16, v41
    v_and_b32 v23, 0xffff0000, v41
    v_lshlrev_b32 v24, 16, v42
    v_and_b32 v25, 0xffff0000, v42
    v_lshlrev_b32 v26, 16, v43
    v_and_b32 v27, 0xffff0000, v43
    v_pk_add_f32 v[224:225], v[20:21], v[88:89] op_sel_hi:[1,0] neg_lo:[0,1] neg_hi:[0,1]
    v_pk_add_f32 v[226:227], v[22:23], v[88:89] op_sel_hi:[1,0] neg_lo:[0,1] neg_hi:[0,1]
    v_pk_add_f32 v[228:229], v[24:25], v[88:89] op_sel_hi:[1,0] neg_lo:[0,1] neg_hi:[0,1]
    v_pk_add_f32 v[230:231], v[26:27], v[88:89] op_sel_hi:[1,0] neg_lo:[0,1] neg_hi:[0,1]
    v_pk_add_f32 v[48:49], v[48:49], v[224:225]
    v_pk_fma_f32 v[50:51], v[224:225], v[224:225], v[50:51]
    v_pk_fma_f32 v[52:53], v[224:225], v[176:177], v[52:53]
    v_pk_add_f32 v[48:49], v[48:49], v[226:227]
    v_pk_fma_f32 v[50:51], v[226:227], v[226:227], v[50:51]
    v_pk_fma_f32 v[52:53], v[226:227], v[178:179], v[52:53]
    v_pk_add_f32 v[48:49], v[48:49], v[228:229]
    v_pk_fma_f32 v[50:51], v[228:229], v[228:229], v[50:51]
    v_pk_fma_f32 v[52:53], v[228:229], v[180:181], v[52:53]
    v_pk_add_f32 v[48:49], v[48:49], v[230:231]
    v_pk_fma_f32 v[50:51], v[230:231], v[230:231], v[50:51]
    v_pk_fma_f32 v[52:53], v[230:231], v[182:183], v[52:53]
    v_add_f32 v48, v48, v49
    v_add_f32 v50, v50, v51
    v_add_f32 v52, v52, v53
    v_add_f32_dpp v48, v48, v48 row_ror:8 row_mask:0xf bank_mask:0xf
    v_add_f32_dpp v50, v50, v50 row_ror:8 row_mask:0xf bank_mask:0xf
    v_add_f32_dpp v52, v52, v52 row_ror:8 row_mask:0xf bank_mask:0xf
    v_add_f32_dpp v48, v48, v48 row_ror:4 row_mask:0xf bank_mask:0xf
    v_add_f32_dpp v50, v50, v50 row_ror:4 row_mask:0xf bank_mask:0xf
    v_add_f32_dpp v52, v52, v52 row_ror:4 row_mask:0xf bank_mask:0xf
    v_add_f32_dpp v48, v48, v48 row_ror:2 row_mask:0xf bank_mask:0xf
    v_add_f32_dpp v50, v50, v50 row_ror:2 row_mask:0xf bank_mask:0xf
    v_add_f32_dpp v52, v52, v52 row_ror:2 row_mask:0xf bank_mask:0xf
    v_add_f32_dpp v48, v48, v48 row_ror:1 row_mask:0xf bank_mask:0xf
    v_add_f32_dpp v50, v50, v50 row_ror:1 row_mask:0xf bank_mask:0xf
    v_add_f32_dpp v52, v52, v52 row_ror:1 row_mask:0xf bank_mask:0xf
    v_mov_b32 v49, v48
    v_mov_b32 v51, v50
    v_mov_b32 v53, v52
    v_permlane16_swap_b32 v48, v49
    v_permlane16_swap_b32 v50, v51
    v_permlane16_swap_b32 v52, v53
    v_add_f32 v48, v48, v49
    v_add_f32 v50, v50, v51
    v_add_f32 v52, v52, v53
    v_mul_f32 v48, 0x3ae38e39, v48
    v_mul_f32 v50, 0x3ae38e39, v50
    v_fma_f32 v50, -v48, v48, v50
    v_add_f32 v48, v48, v88
    v_max_f32 v50, 0, v50
    v_cvt_pk_bf16_f32 v48, v48, v50
    v_and_b32 v50, 0xffff0000, v48
    v_lshlrev_b32 v48, 16, v48
    v_add_f32 v50, 0x3727c5ac, v50
    v_sub_f32 v48, v88, v48
    v_cvt_pk_bf16_f32 v50, v50, v50
    v_and_b32 v50, 0xffff0000, v50
    v_sqrt_f32 v50, v50
    v_fmac_f32 v52, v48, v90
    v_cvt_pk_bf16_f32 v50, v50, v50
    v_and_b32 v50, 0xffff0000, v50
    v_rcp_f32 v50, v50
    s_mov_b32 exec_lo, 1
    s_mov_b32 exec_hi, 1
    v_fma_f32 v52, v52, v50, v91
    v_ashrrev_i32 v62, 31, v52
    v_or_b32 v62, 0x80000000, v62
    v_xor_b32 v52, v62, v52
    v_min_u32 v52, 0xfffff000, v52
    v_bfi_b32 v52, s48, v93, v52
    ds_write_b32 v92, v52 offset:36864
    s_mov_b64 exec, -1
    v_mul_f32 v48, v48, v50
    s_waitcnt lgkmcnt(0)
    s_barrier
    v_mov_b32 v109, 36864
    ds_read_b128 v[96:99], v109
    ds_read_b128 v[100:103], v109 offset:16
    s_lshl_b32 s45, s2, 7
    s_add_u32 s45, s45, 9306112
    s_cmp_eq_u32 s3, 0
    s_cselect_b32 s45, s45, 2147483648
    s_waitcnt lgkmcnt(1)
    v_max_u32 v104, v96, v97
    v_min_u32 v105, v96, v97
    v_med3_u32 v105, v104, v105, v98
    v_max_u32 v104, v104, v98
    v_med3_u32 v105, v104, v105, v99
    v_max_u32 v104, v104, v99
    s_waitcnt lgkmcnt(0)
    v_med3_u32 v105, v104, v105, v100
    v_max_u32 v104, v104, v100
    v_med3_u32 v105, v104, v105, v101
    v_max_u32 v104, v104, v101
    v_med3_u32 v105, v104, v105, v102
    v_max_u32 v104, v104, v102
    v_med3_u32 v105, v104, v105, v103
    v_max_u32 v104, v104, v103
    buffer_store_dwordx2 v[104:105], v8, s[24:27], s45 offen sc1
    v_pk_fma_f32 v[216:217], v[216:217], v[50:51], v[48:49] op_sel_hi:[1,0,0]
    v_pk_fma_f32 v[218:219], v[218:219], v[50:51], v[48:49] op_sel_hi:[1,0,0]
    v_pk_fma_f32 v[220:221], v[220:221], v[50:51], v[48:49] op_sel_hi:[1,0,0]
    v_pk_fma_f32 v[222:223], v[222:223], v[50:51], v[48:49] op_sel_hi:[1,0,0]
    v_pk_fma_f32 v[224:225], v[224:225], v[50:51], v[48:49] op_sel_hi:[1,0,0]
    v_pk_fma_f32 v[226:227], v[226:227], v[50:51], v[48:49] op_sel_hi:[1,0,0]
    v_pk_fma_f32 v[228:229], v[228:229], v[50:51], v[48:49] op_sel_hi:[1,0,0]
    v_pk_fma_f32 v[230:231], v[230:231], v[50:51], v[48:49] op_sel_hi:[1,0,0]
    v_pk_fma_f32 v[232:233], v[232:233], v[50:51], v[48:49] op_sel_hi:[1,0,0]
    v_pk_fma_f32 v[234:235], v[234:235], v[50:51], v[48:49] op_sel_hi:[1,0,0]
    v_pk_fma_f32 v[236:237], v[236:237], v[50:51], v[48:49] op_sel_hi:[1,0,0]
    v_pk_fma_f32 v[238:239], v[238:239], v[50:51], v[48:49] op_sel_hi:[1,0,0]
    v_pk_fma_f32 v[216:217], v[216:217], v[120:121], v[144:145]
    v_pk_fma_f32 v[218:219], v[218:219], v[122:123], v[146:147]
    v_pk_fma_f32 v[220:221], v[220:221], v[124:125], v[148:149]
    v_pk_fma_f32 v[222:223], v[222:223], v[126:127], v[150:151]
    v_pk_fma_f32 v[224:225], v[224:225], v[128:129], v[152:153]
    v_pk_fma_f32 v[226:227], v[226:227], v[130:131], v[154:155]
    v_pk_fma_f32 v[228:229], v[228:229], v[132:133], v[156:157]
    v_pk_fma_f32 v[230:231], v[230:231], v[134:135], v[158:159]
    v_pk_fma_f32 v[232:233], v[232:233], v[136:137], v[160:161]
    v_pk_fma_f32 v[234:235], v[234:235], v[138:139], v[162:163]
    v_pk_fma_f32 v[236:237], v[236:237], v[140:141], v[164:165]
    v_pk_fma_f32 v[238:239], v[238:239], v[142:143], v[166:167]
    v_cvt_pk_bf16_f32 v64, v216, v217
    v_cvt_pk_bf16_f32 v65, v218, v219
    v_cvt_pk_bf16_f32 v66, v220, v221
    v_cvt_pk_bf16_f32 v67, v222, v223
    v_cvt_pk_bf16_f32 v68, v224, v225
    v_cvt_pk_bf16_f32 v69, v226, v227
    v_cvt_pk_bf16_f32 v70, v228, v229
    v_cvt_pk_bf16_f32 v71, v230, v231
    v_cvt_pk_bf16_f32 v72, v232, v233
    v_cvt_pk_bf16_f32 v73, v234, v235
    v_cvt_pk_bf16_f32 v74, v236, v237
    v_cvt_pk_bf16_f32 v75, v238, v239
    v_and_b32 v106, 0x7ff, v104
    v_and_b32 v107, 0x7ff, v105
    v_cmp_eq_u32 vcc, v106, v93
    v_cmp_eq_u32 s[36:37], v107, v93
    v_mov_b32 v106, 2147483648
    s_or_b64 vcc, vcc, s[36:37]
    s_mov_b32 s45, 2621440
    s_nop 0
    v_cndmask_b32 v6, v106, v6, vcc
    v_cndmask_b32 v60, v106, v60, vcc
    buffer_store_dwordx4 v[64:67], v6, s[24:27], s45 offen offset:0 sc1
    buffer_store_dwordx4 v[68:71], v6, s[24:27], s45 offen offset:512 sc1
    buffer_store_dwordx4 v[72:75], v60, s[24:27], s45 offen offset:1024 sc1
    s_cmp_ge_u32 s41, 18
    s_cbranch_scc1 Ltail_idle
    s_mov_b32 s36, 2622592
    buffer_store_dwordx4 v[36:39], v6, s[24:27], s36 offen offset:0 sc1
    buffer_store_dwordx4 v[40:43], v6, s[24:27], s36 offen offset:512 sc1
    buffer_store_dwordx4 v[44:47], v60, s[24:27], s36 offen offset:1024 sc1
    v_lshlrev_b32 v216, 16, v64
    v_and_b32 v217, 0xffff0000, v64
    v_lshlrev_b32 v218, 16, v65
    v_and_b32 v219, 0xffff0000, v65
    v_lshlrev_b32 v220, 16, v66
    v_and_b32 v221, 0xffff0000, v66
    v_lshlrev_b32 v222, 16, v67
    v_and_b32 v223, 0xffff0000, v67
    v_lshlrev_b32 v224, 16, v68
    v_and_b32 v225, 0xffff0000, v68
    v_lshlrev_b32 v226, 16, v69
    v_and_b32 v227, 0xffff0000, v69
    v_lshlrev_b32 v228, 16, v70
    v_and_b32 v229, 0xffff0000, v70
    v_lshlrev_b32 v230, 16, v71
    v_and_b32 v231, 0xffff0000, v71
    v_lshlrev_b32 v232, 16, v72
    v_and_b32 v233, 0xffff0000, v72
    v_lshlrev_b32 v234, 16, v73
    v_and_b32 v235, 0xffff0000, v73
    v_lshlrev_b32 v236, 16, v74
    v_and_b32 v237, 0xffff0000, v74
    v_lshlrev_b32 v238, 16, v75
    v_and_b32 v239, 0xffff0000, v75
    v_pk_mul_f32 v[192:193], v[192:193], v[216:217]
    v_pk_mul_f32 v[194:195], v[194:195], v[218:219]
    v_pk_mul_f32 v[196:197], v[196:197], v[220:221]
    v_pk_mul_f32 v[198:199], v[198:199], v[222:223]
    v_pk_mul_f32 v[200:201], v[200:201], v[224:225]
    v_pk_mul_f32 v[202:203], v[202:203], v[226:227]
    v_pk_mul_f32 v[204:205], v[204:205], v[228:229]
    v_pk_mul_f32 v[206:207], v[206:207], v[230:231]
    v_pk_mul_f32 v[208:209], v[208:209], v[232:233]
    v_pk_mul_f32 v[210:211], v[210:211], v[234:235]
    v_pk_mul_f32 v[212:213], v[212:213], v[236:237]
    v_pk_mul_f32 v[214:215], v[214:215], v[238:239]
    v_cvt_pk_bf16_f32 v144, v192, v193
    v_cvt_pk_bf16_f32 v145, v194, v195
    v_cvt_pk_bf16_f32 v146, v196, v197
    v_cvt_pk_bf16_f32 v147, v198, v199
    v_cvt_pk_bf16_f32 v148, v200, v201
    v_cvt_pk_bf16_f32 v149, v202, v203
    v_cvt_pk_bf16_f32 v150, v204, v205
    v_cvt_pk_bf16_f32 v151, v206, v207
    v_cvt_pk_bf16_f32 v152, v208, v209
    v_cvt_pk_bf16_f32 v153, v210, v211
    v_cvt_pk_bf16_f32 v154, v212, v213
    v_cvt_pk_bf16_f32 v155, v214, v215
    v_lshlrev_b32 v192, 16, v144
    v_and_b32 v193, 0xffff0000, v144
    v_lshlrev_b32 v194, 16, v145
    v_and_b32 v195, 0xffff0000, v145
    v_lshlrev_b32 v196, 16, v146
    v_and_b32 v197, 0xffff0000, v146
    v_lshlrev_b32 v198, 16, v147
    v_and_b32 v199, 0xffff0000, v147
    v_lshlrev_b32 v200, 16, v148
    v_and_b32 v201, 0xffff0000, v148
    v_lshlrev_b32 v202, 16, v149
    v_and_b32 v203, 0xffff0000, v149
    v_lshlrev_b32 v204, 16, v150
    v_and_b32 v205, 0xffff0000, v150
    v_lshlrev_b32 v206, 16, v151
    v_and_b32 v207, 0xffff0000, v151
    v_lshlrev_b32 v208, 16, v152
    v_and_b32 v209, 0xffff0000, v152
    v_lshlrev_b32 v210, 16, v153
    v_and_b32 v211, 0xffff0000, v153
    v_lshlrev_b32 v212, 16, v154
    v_and_b32 v213, 0xffff0000, v154
    v_lshlrev_b32 v214, 16, v155
    v_and_b32 v215, 0xffff0000, v155
    v_pk_add_f32 v[192:193], v[192:193], v[12:13]
    v_pk_add_f32 v[194:195], v[194:195], v[14:15]
    v_pk_add_f32 v[196:197], v[196:197], v[16:17]
    v_pk_add_f32 v[198:199], v[198:199], v[18:19]
    v_pk_add_f32 v[200:201], v[200:201], v[20:21]
    v_pk_add_f32 v[202:203], v[202:203], v[22:23]
    v_pk_add_f32 v[204:205], v[204:205], v[24:25]
    v_pk_add_f32 v[206:207], v[206:207], v[26:27]
    v_pk_add_f32 v[208:209], v[208:209], v[28:29]
    v_pk_add_f32 v[210:211], v[210:211], v[30:31]
    v_pk_add_f32 v[212:213], v[212:213], v[32:33]
    v_pk_add_f32 v[214:215], v[214:215], v[34:35]
    v_cvt_pk_bf16_f32 v156, v192, v193
    v_cvt_pk_bf16_f32 v157, v194, v195
    v_cvt_pk_bf16_f32 v158, v196, v197
    v_cvt_pk_bf16_f32 v159, v198, v199
    v_cvt_pk_bf16_f32 v160, v200, v201
    v_cvt_pk_bf16_f32 v161, v202, v203
    v_cvt_pk_bf16_f32 v162, v204, v205
    v_cvt_pk_bf16_f32 v163, v206, v207
    v_cvt_pk_bf16_f32 v164, v208, v209
    v_cvt_pk_bf16_f32 v165, v210, v211
    v_cvt_pk_bf16_f32 v166, v212, v213
    v_cvt_pk_bf16_f32 v167, v214, v215
    v_and_b32 v30, 2, v1
    v_cmp_ne_u32 vcc, 0, v30
    v_mul_u32_u24 v30, 1152, v7
    v_add_u32 v4, v30, v5
    v_add_u32 v58, v30, v59
    v_mov_b32_dpp v192, v158 quad_perm:[0,2,0,2] row_mask:0xf bank_mask:0xf
    v_mov_b32_dpp v193, v159 quad_perm:[0,2,0,2] row_mask:0xf bank_mask:0xf
    v_mov_b32_dpp v194, v158 quad_perm:[1,3,1,3] row_mask:0xf bank_mask:0xf
    v_mov_b32_dpp v195, v159 quad_perm:[1,3,1,3] row_mask:0xf bank_mask:0xf
    v_mov_b32_dpp v196, v162 quad_perm:[0,2,0,2] row_mask:0xf bank_mask:0xf
    v_mov_b32_dpp v197, v163 quad_perm:[0,2,0,2] row_mask:0xf bank_mask:0xf
    v_mov_b32_dpp v198, v162 quad_perm:[1,3,1,3] row_mask:0xf bank_mask:0xf
    v_mov_b32_dpp v199, v163 quad_perm:[1,3,1,3] row_mask:0xf bank_mask:0xf
    v_mov_b32_dpp v200, v166 quad_perm:[0,2,0,2] row_mask:0xf bank_mask:0xf
    v_mov_b32_dpp v201, v167 quad_perm:[0,2,0,2] row_mask:0xf bank_mask:0xf
    v_mov_b32_dpp v202, v166 quad_perm:[1,3,1,3] row_mask:0xf bank_mask:0xf
    v_mov_b32_dpp v203, v167 quad_perm:[1,3,1,3] row_mask:0xf bank_mask:0xf
    v_cndmask_b32_dpp v144, v156, v192, vcc quad_perm:[0,2,0,2] row_mask:0xf bank_mask:0xf
    v_cndmask_b32_dpp v145, v157, v193, vcc quad_perm:[0,2,0,2] row_mask:0xf bank_mask:0xf
    v_cndmask_b32_dpp v146, v156, v194, vcc quad_perm:[1,3,1,3] row_mask:0xf bank_mask:0xf
    v_cndmask_b32_dpp v147, v157, v195, vcc quad_perm:[1,3,1,3] row_mask:0xf bank_mask:0xf
    v_cndmask_b32_dpp v148, v160, v196, vcc quad_perm:[0,2,0,2] row_mask:0xf bank_mask:0xf
    v_cndmask_b32_dpp v149, v161, v197, vcc quad_perm:[0,2,0,2] row_mask:0xf bank_mask:0xf
    v_cndmask_b32_dpp v150, v160, v198, vcc quad_perm:[1,3,1,3] row_mask:0xf bank_mask:0xf
    v_cndmask_b32_dpp v151, v161, v199, vcc quad_perm:[1,3,1,3] row_mask:0xf bank_mask:0xf
    v_cndmask_b32_dpp v152, v164, v200, vcc quad_perm:[0,2,0,2] row_mask:0xf bank_mask:0xf
    v_cndmask_b32_dpp v153, v165, v201, vcc quad_perm:[0,2,0,2] row_mask:0xf bank_mask:0xf
    v_cndmask_b32_dpp v154, v164, v202, vcc quad_perm:[1,3,1,3] row_mask:0xf bank_mask:0xf
    v_cndmask_b32_dpp v155, v165, v203, vcc quad_perm:[1,3,1,3] row_mask:0xf bank_mask:0xf
    v_lshlrev_b32 v13, 4, v1
    v_add_u32 v13, 32768, v13
    s_lshl_b32 s44, s3, 10
    v_add_u32 v14, s44, v13
    v_and_b32 v13, 0xffffff1f, v13
    v_bfe_u32 v15, v1, 2, 2
    v_cmp_eq_u32 s[52:53], 0, v15
    v_cmp_eq_u32 s[54:55], 1, v15
    v_cmp_eq_u32 s[56:57], 2, v15
    v_cmp_eq_u32 s[58:59], 3, v15
    s_mul_i32 s43, s42, 18
    s_add_u32 s43, s43, s41
    s_lshl_b32 s43, s43, 9
    s_mul_i32 s44, s3, 73728
    s_add_u32 s43, s43, s44
    v_lshlrev_b32 v15, 3, v1
    s_cmp_lt_u32 s3, 2
    s_cselect_b32 s36, 0xbfb8aa3b, 0
    s_cselect_b32 s37, 1.0, 0
    v_mov_b32 v40, s36
    v_mov_b32 v41, s37
    v_and_b32 v10, 1, v1
    v_and_b32 v9, 48, v1
    s_mul_i32 s38, s3, 3072
    s_add_u32 s38, s38, 49152
    v_lshl_add_u32 v11, v10, 9, v9
    v_add_u32 v11, s38, v11
    v_lshrrev_b32 v10, 5, v1
    v_and_b32 v9, 31, v1
    v_lshlrev_b32 v9, 4, v9
    v_lshlrev_b32 v108, 7, v0
    s_mov_b32 s45, 9306112
    s_lshl_b32 s36, s3, 3
    v_mov_b32 v109, s36
    s_mov_b32 s48, 262144
Ltail_pollk:
    buffer_load_dwordx2 v[104:105], v108, s[24:27], s45 offen sc1
    s_sub_u32 s48, s48, 1
    s_cbranch_scc1 Ltail_gotk
    s_waitcnt vmcnt(0)
    v_max_u32 v106, v104, v105
    v_cmp_eq_u32 vcc, -1, v106
    s_cbranch_vccnz Ltail_pollk
Ltail_gotk:
    s_waitcnt vmcnt(0)
    v_mov_b32_dpp v106, v104 row_ror:1 row_mask:0xf bank_mask:0xf
    v_mov_b32_dpp v107, v105 row_ror:1 row_mask:0xf bank_mask:0xf
    v_min_u32 v110, v104, v106
    v_max_u32 v104, v104, v106
    v_max3_u32 v105, v110, v105, v107
    s_nop 0
    v_mov_b32_dpp v106, v104 row_ror:2 row_mask:0xf bank_mask:0xf
    v_mov_b32_dpp v107, v105 row_ror:2 row_mask:0xf bank_mask:0xf
    v_min_u32 v110, v104, v106
    v_max_u32 v104, v104, v106
    v_max3_u32 v105, v110, v105, v107
    s_nop 0
    v_mov_b32_dpp v106, v104 row_ror:4 row_mask:0xf bank_mask:0xf
    v_mov_b32_dpp v107, v105 row_ror:4 row_mask:0xf bank_mask:0xf
    v_min_u32 v110, v104, v106
    v_max_u32 v104, v104, v106
    v_max3_u32 v105, v110, v105, v107
    s_nop 0
    v_mov_b32_dpp v106, v104 row_ror:8 row_mask:0xf bank_mask:0xf
    v_mov_b32_dpp v107, v105 row_ror:8 row_mask:0xf bank_mask:0xf
    v_min_u32 v110, v104, v106
    v_max_u32 v104, v104, v106
    v_max3_u32 v105, v110, v105, v107
    v_mov_b32 v106, v104
    v_mov_b32 v107, v105
    s_nop 0
    v_permlane16_swap_b32 v104, v106
    v_permlane16_swap_b32 v105, v107
    v_min_u32 v110, v104, v106
    v_max_u32 v104, v104, v106
    v_max3_u32 v105, v110, v105, v107
    v_mov_b32 v106, v104
    v_mov_b32 v107, v105
    s_nop 0
    v_permlane32_swap_b32 v104, v106
    v_permlane32_swap_b32 v105, v107
    v_min_u32 v110, v104, v106
    v_max_u32 v104, v104, v106
    v_max3_u32 v105, v110, v105, v107
    ds_write_b64 v109, v[104:105] offset:36928
    v_mov_b32 v109, 36928
    s_waitcnt lgkmcnt(0)
    s_barrier
    ds_read_b128 v[96:99], v109
    ds_read_b128 v[100:103], v109 offset:16
    s_waitcnt lgkmcnt(1)
    v_max_u32 v104, v96, v97
    v_min_u32 v105, v96, v97
    v_med3_u32 v105, v104, v105, v98
    v_max_u32 v104, v104, v98
    v_med3_u32 v105, v104, v105, v99
    v_max_u32 v104, v104, v99
    s_waitcnt lgkmcnt(0)
    v_med3_u32 v105, v104, v105, v100
    v_max_u32 v104, v104, v100
    v_med3_u32 v105, v104, v105, v101
    v_max_u32 v104, v104, v101
    v_med3_u32 v105, v104, v105, v102
    v_max_u32 v104, v104, v102
    v_med3_u32 v105, v104, v105, v103
    v_max_u32 v104, v104, v103
    s_nop 0
    v_readfirstlane_b32 s92, v104
    v_readfirstlane_b32 s93, v105
    s_andn2_b32 s46, 0x7ff, s92
    s_andn2_b32 s47, 0x7ff, s93
    s_mul_i32 s44, s46, 2304
    s_mul_i32 s45, s47, 2304
    s_sub_u32 s45, s45, s44
    v_mad_i32_i24 v10, v10, s45, v9
    s_add_u32 s45, s44, 2621440
    v_add_u32 v10, s45, v10
    s_mov_b32 s48, 16384
Ltail_pollh:
    s_mov_b32 exec_lo, 0xffffff
    s_mov_b32 exec_hi, 0xffffff
    s_add_u32 m0, s38, 0
    s_nop 0
    buffer_load_dwordx4 v10, s[24:27], 0 offen offset:0 sc1 lds
    s_add_u32 m0, s38, 640
    s_nop 0
    buffer_load_dwordx4 v10, s[24:27], 0 offen offset:384 sc1 lds
    s_add_u32 m0, s38, 1280
    s_nop 0
    buffer_load_dwordx4 v10, s[24:27], 0 offen offset:768 sc1 lds
    s_mov_b64 exec, -1
    s_waitcnt vmcnt(0)
    ds_read_b128 a[0:3], v11 offset:0
    ds_read_b128 a[4:7], v11 offset:64
    ds_read_b128 a[8:11], v11 offset:128
    ds_read_b128 a[12:15], v11 offset:192
    ds_read_b128 a[16:19], v11 offset:256
    ds_read_b128 a[20:23], v11 offset:320
    ds_read_b128 a[24:27], v11 offset:1024
    ds_read_b128 a[28:31], v11 offset:1088
    ds_read_b128 a[32:35], v11 offset:1152
    ds_read_b128 a[36:39], v11 offset:1216
    ds_read_b128 a[40:43], v11 offset:1280
    ds_read_b128 a[44:47], v11 offset:1344
    ds_read_b128 a[48:51], v11 offset:2048
    ds_read_b128 a[52:55], v11 offset:2112
    ds_read_b128 a[56:59], v11 offset:2176
    ds_read_b128 a[60:63], v11 offset:2240
    ds_read_b128 a[64:67], v11 offset:2304
    ds_read_b128 a[68:71], v11 offset:2368
    s_waitcnt lgkmcnt(15)
    v_mfma_f32_16x16x32_bf16 v[16:19], a[96:99], a[0:3], 0
    v_mfma_f32_16x16x32_bf16 v[20:23], a[100:103], a[4:7], 0
    v_mfma_f32_16x16x32_bf16 v[16:19], a[104:107], a[8:11], v[16:19]
    s_waitcnt lgkmcnt(14)
    v_mfma_f32_16x16x32_bf16 v[20:23], a[108:111], a[12:15], v[20:23]
    s_waitcnt lgkmcnt(13)
    v_mfma_f32_16x16x32_bf16 v[16:19], a[112:115], a[16:19], v[16:19]
    s_waitcnt lgkmcnt(12)
    v_mfma_f32_16x16x32_bf16 v[20:23], a[116:119], a[20:23], v[20:23]
    s_waitcnt lgkmcnt(11)
    v_mfma_f32_16x16x32_bf16 v[16:19], a[120:123], a[24:27], v[16:19]
    s_waitcnt lgkmcnt(10)
    v_mfma_f32_16x16x32_bf16 v[20:23], a[124:127], a[28:31], v[20:23]
    s_waitcnt lgkmcnt(9)
    v_mfma_f32_16x16x32_bf16 v[16:19], a[128:131], a[32:35], v[16:19]
    s_waitcnt lgkmcnt(8)
    v_mfma_f32_16x16x32_bf16 v[20:23], a[132:135], a[36:39], v[20:23]
    s_waitcnt lgkmcnt(7)
    v_mfma_f32_16x16x32_bf16 v[16:19], a[136:139], a[40:43], v[16:19]
    s_waitcnt lgkmcnt(6)
    v_mfma_f32_16x16x32_bf16 v[20:23], a[140:143], a[44:47], v[20:23]
    s_waitcnt lgkmcnt(5)
    v_mfma_f32_16x16x32_bf16 v[16:19], a[144:147], a[48:51], v[16:19]
    s_waitcnt lgkmcnt(4)
    v_mfma_f32_16x16x32_bf16 v[20:23], a[148:151], a[52:55], v[20:23]
    s_waitcnt lgkmcnt(3)
    v_mfma_f32_16x16x32_bf16 v[16:19], a[152:155], a[56:59], v[16:19]
    s_waitcnt lgkmcnt(2)
    v_mfma_f32_16x16x32_bf16 v[20:23], a[156:159], a[60:63], v[20:23]
    s_waitcnt lgkmcnt(1)
    v_mfma_f32_16x16x32_bf16 v[16:19], a[160:163], a[64:67], v[16:19]
    s_waitcnt lgkmcnt(0)
    v_mfma_f32_16x16x32_bf16 v[20:23], a[164:167], a[68:71], v[20:23]
    s_sub_u32 s48, s48, 1
    s_nop 6
    v_pk_add_f32 v[16:17], v[16:17], v[20:21]
    v_pk_add_f32 v[18:19], v[18:19], v[22:23]
    s_cbranch_scc1 Ltail_goth
    v_cmp_u_f32 vcc, v16, v16
    s_and_b32 s36, vcc_lo, 3
    s_cbranch_scc1 Ltail_pollh
Ltail_goth:
    v_cvt_pk_bf16_f32 v32, v16, v17
    v_cvt_pk_bf16_f32 v33, v18, v19
    v_lshlrev_b32 v16, 16, v32
    v_and_b32 v17, 0xffff0000, v32
    v_lshlrev_b32 v18, 16, v33
    v_and_b32 v19, 0xffff0000, v33
    v_pk_mul_f32 v[32:33], v[16:17], v[40:41] op_sel_hi:[1,0]
    v_pk_mul_f32 v[34:35], v[18:19], v[40:41] op_sel_hi:[1,0]
    v_exp_f32 v32, v32
    v_exp_f32 v33, v33
    v_exp_f32 v34, v34
    v_exp_f32 v35, v35
    v_fma_f32 v32, v32, v41, 1.0
    v_fma_f32 v33, v33, v41, 1.0
    v_fma_f32 v34, v34, v41, 1.0
    v_fma_f32 v35, v35, v41, 1.0
    v_rcp_f32 v32, v32
    v_rcp_f32 v33, v33
    v_rcp_f32 v34, v34
    v_rcp_f32 v35, v35
    v_pk_mul_f32 v[16:17], v[16:17], v[32:33]
    v_pk_mul_f32 v[18:19], v[18:19], v[34:35]
    v_cvt_pk_bf16_f32 v32, v16, v17
    v_cvt_pk_bf16_f32 v33, v18, v19
    v_lshlrev_b32 v16, 16, v32
    v_and_b32 v17, 0xffff0000, v32
    v_lshlrev_b32 v18, 16, v33
    v_and_b32 v19, 0xffff0000, v33
    ds_write_b128 v14, v[16:19]
    s_waitcnt lgkmcnt(0)
    s_barrier
    ds_read_b128 v[16:19], v13 offset:0
    ds_read_b128 v[24:27], v13 offset:2048
    ds_read_b128 v[20:23], v13 offset:1024
    ds_read_b128 v[28:31], v13 offset:3072
    s_waitcnt lgkmcnt(2)
    v_pk_mul_f32 v[16:17], v[16:17], v[24:25]
    v_pk_mul_f32 v[18:19], v[18:19], v[26:27]
    v_cvt_pk_bf16_f32 v32, v16, v17
    v_cvt_pk_bf16_f32 v33, v18, v19
    s_waitcnt lgkmcnt(0)
    v_pk_mul_f32 v[20:21], v[20:21], v[28:29]
    v_pk_mul_f32 v[22:23], v[22:23], v[30:31]
    v_cvt_pk_bf16_f32 v34, v20, v21
    v_cvt_pk_bf16_f32 v35, v22, v23
    v_cndmask_b32 v64, 0, v32, s[52:53]
    v_cndmask_b32 v65, 0, v33, s[52:53]
    v_cndmask_b32 v66, 0, v34, s[52:53]
    v_cndmask_b32 v67, 0, v35, s[52:53]
    s_nop 1
    v_mfma_f32_16x16x32_bf16 v[16:19], v[64:67], a[168:171], 0
    v_cndmask_b32 v68, 0, v32, s[54:55]
    v_cndmask_b32 v69, 0, v33, s[54:55]
    v_mfma_f32_16x16x32_bf16 v[20:23], v[64:67], a[184:187], 0
    v_cndmask_b32 v70, 0, v34, s[54:55]
    v_cndmask_b32 v71, 0, v35, s[54:55]
    v_mfma_f32_16x16x32_bf16 v[24:27], v[64:67], a[200:203], 0
    s_nop 0
    v_mfma_f32_16x16x32_bf16 v[16:19], v[68:71], a[172:175], v[16:19]
Ltour1_1:
    s_cbranch_execz Lmain1
    v_cndmask_b32 v72, 0, v32, s[56:57]
    v_cndmask_b32 v73, 0, v33, s[56:57]
    v_mfma_f32_16x16x32_bf16 v[20:23], v[68:71], a[188:191], v[20:23]
    v_cndmask_b32 v74, 0, v34, s[56:57]
    v_cndmask_b32 v75, 0, v35, s[56:57]
    v_mfma_f32_16x16x32_bf16 v[24:27], v[68:71], a[204:207], v[24:27]
    s_nop 0
    v_mfma_f32_16x16x32_bf16 v[16:19], v[72:75], a[176:179], v[16:19]
    v_cndmask_b32 v76, 0, v32, s[58:59]
    v_cndmask_b32 v77, 0, v33, s[58:59]
    v_mfma_f32_16x16x32_bf16 v[20:23], v[72:75], a[192:195], v[20:23]
    v_cndmask_b32 v78, 0, v34, s[58:59]
    v_cndmask_b32 v79, 0, v35, s[58:59]
    v_mfma_f32_16x16x32_bf16 v[24:27], v[72:75], a[208:211], v[24:27]
    s_nop 0
    v_mfma_f32_16x16x32_bf16 v[16:19], v[76:79], a[180:183], v[16:19]
    v_mfma_f32_16x16x32_bf16 v[20:23], v[76:79], a[196:199], v[20:23]
    v_mfma_f32_16x16x32_bf16 v[24:27], v[76:79], a[212:215], v[24:27]
    s_nop 5
    v_min_u32 v16, -2, v16
    v_min_u32 v17, -2, v17
    buffer_store_dwordx2 v[16:17], v15, s[8:11], s43 offen sc1
    s_add_u32 s43, s43, 294912
    v_min_u32 v20, -2, v20
    v_min_u32 v21, -2, v21
    buffer_store_dwordx2 v[20:21], v15, s[8:11], s43 offen sc1
    s_add_u32 s43, s43, 294912
    v_min_u32 v24, -2, v24
    v_min_u32 v25, -2, v25
    buffer_store_dwordx2 v[24:25], v15, s[8:11], s43 offen sc1
    s_or_b32 s36, s2, s3
    s_cselect_b32 s37, -4, 24576
    s_add_u32 s36, s94, 1
    v_mov_b32 v106, s36
    buffer_store_dword v106, v8, s[24:27], s37 offen sc1
    v_cmp_ne_u32 vcc, s46, v7
    v_cmp_ne_u32 s[36:37], s47, v7
    v_mov_b32 v31, 2147483648
    s_and_b64 vcc, vcc, s[36:37]
    s_nop 1
    v_cndmask_b32 v30, v31, v58, vcc
    v_cndmask_b32 v31, v31, v4, vcc
    buffer_store_dwordx4 v[144:147], v31, s[16:19], 0 offen offset:0 nt
    buffer_store_dwordx4 v[148:151], v31, s[16:19], 0 offen offset:512 nt
    buffer_store_dwordx4 v[152:155], v30, s[16:19], 0 offen offset:1024 nt
    s_cmp_lt_u32 s41, 9
    s_cselect_b32 s36, s3, 0
    s_cmp_lg_u32 s36, 3
    s_cbranch_scc1 Ltail_done
    s_mul_i32 s43, s42, 9
    s_add_u32 s43, s43, s41
    v_bfe_u32 v8, v1, 2, 1
    v_cmp_eq_u32 vcc, 1, v8
    v_mov_b32 v9, s46
    v_mov_b32 v10, s47
    v_and_b32 v11, 3, v1
    v_cndmask_b32 v9, v9, v10, vcc
    s_lshr_b32 s44, s43, 2
    s_lshl_b32 s44, s44, 6
    s_and_b32 s45, s43, 1
    s_lshl_b32 s45, s45, 5
    s_add_u32 s44, s44, s45
    s_and_b32 s45, s43, 2
    s_lshl_b32 s45, s45, 2
    s_add_u32 s44, s44, s45
    v_lshrrev_b32 v12, 1, v11
    v_lshl_add_u32 v12, v12, 4, s44
    v_and_b32 v13, 1, v11
    v_lshl_add_u32 v12, v13, 2, v12
    v_mul_u32_u24 v13, 1152, v9
    v_lshl_add_u32 v14, v13, 1, v12
    v_add_u32 v15, 2621440, v14
    s_mov_b32 s45, 22144
    buffer_load_dword v18, v12, s[24:27], s45 offen sc1
    v_mov_b32 v19, s92
    v_mov_b32 v10, s93
    v_cndmask_b32 v19, v19, v10, vcc
    v_and_b32 v19, 0xfffff800, v19
    v_or_b32 v19, 0x400, v19
    v_ashrrev_i32 v10, 31, v19
    v_not_b32 v10, v10
    v_or_b32 v10, 0x80000000, v10
    v_xor_b32 v19, v19, v10
    s_lshl_b32 s45, s43, 4
    v_lshl_add_u32 v13, v11, 2, v13
    v_add_u32 v13, s45, v13
    v_lshrrev_b32 v14, 2, v1
    v_lshlrev_b32 v14, 9, v14
    v_lshl_add_u32 v14, v11, 4, v14
    s_lshr_b32 s44, s43, 3
    s_mul_i32 s44, s44, 73728
    s_and_b32 s45, s43, 7
    s_lshl_b32 s45, s45, 6
    s_add_u32 s44, s44, s45
    v_cmp_eq_u32 s[38:39], 1, v8
    v_cvt_pk_bf16_f32 v19, v19, v19
    v_and_b32 v19, 0xffff0000, v19
    v_mul_f32 v19, 0xbfb8aa3b, v19
    v_exp_f32 v19, v19
    s_waitcnt vmcnt(0)
    v_lshlrev_b32 v24, 16, v18
    v_and_b32 v25, 0xffff0000, v18
    v_add_f32 v19, 1.0, v19
    v_rcp_f32 v19, v19
    s_mov_b32 s48, 262144
    v_cvt_pk_bf16_f32 v19, v19, v19
    v_and_b32 v19, 0xffff0000, v19
Ltail_polly:
    s_add_u32 s45, s44, 0
    buffer_load_dwordx4 v[64:67], v14, s[8:11], s45 offen sc1
    s_add_u32 s45, s44, 8192
    buffer_load_dwordx4 v[68:71], v14, s[8:11], s45 offen sc1
    s_add_u32 s45, s44, 16384
    buffer_load_dwordx4 v[72:75], v14, s[8:11], s45 offen sc1
    s_add_u32 s45, s44, 24576
    buffer_load_dwordx4 v[76:79], v14, s[8:11], s45 offen sc1
    s_add_u32 s45, s44, 32768
    buffer_load_dwordx4 v[80:83], v14, s[8:11], s45 offen sc1
    s_add_u32 s45, s44, 40960
    buffer_load_dwordx4 v[84:87], v14, s[8:11], s45 offen sc1
    s_add_u32 s45, s44, 49152
    buffer_load_dwordx4 v[88:91], v14, s[8:11], s45 offen sc1
    s_add_u32 s45, s44, 57344
    buffer_load_dwordx4 v[92:95], v14, s[8:11], s45 offen sc1
    s_add_u32 s45, s44, 65536
    buffer_load_dwordx4 v[96:99], v14, s[8:11], s45 offen sc1
    s_mov_b32 s45, 1152
    buffer_load_dword v16, v15, s[24:27], s45 offen sc1
    buffer_load_dword v17, v15, s[24:27], 0 offen sc1
    s_sub_u32 s48, s48, 1
    s_cbranch_scc1 Ltail_goty
    s_waitcnt vmcnt(10)
    v_max3_u32 v26, v64, v65, v66
    s_waitcnt vmcnt(9)
    v_max3_u32 v26, v26, v67, v68
    v_max3_u32 v26, v26, v69, v70
    s_waitcnt vmcnt(8)
    v_max3_u32 v26, v26, v71, v72
    v_max3_u32 v26, v26, v73, v74
    s_waitcnt vmcnt(7)
    v_max3_u32 v26, v26, v75, v76
    v_max3_u32 v26, v26, v77, v78
    s_waitcnt vmcnt(6)
    v_max3_u32 v26, v26, v79, v80
    v_max3_u32 v26, v26, v81, v82
    s_waitcnt vmcnt(5)
    v_max3_u32 v26, v26, v83, v84
    v_max3_u32 v26, v26, v85, v86
    s_waitcnt vmcnt(4)
    v_max3_u32 v26, v26, v87, v88
    v_max3_u32 v26, v26, v89, v90
    s_waitcnt vmcnt(3)
    v_max3_u32 v26, v26, v91, v92
    v_max3_u32 v26, v26, v93, v94
    s_waitcnt vmcnt(2)
    v_max3_u32 v26, v26, v95, v96
    v_max3_u32 v26, v26, v97, v98
    v_max_u32 v26, v26, v99
    s_waitcnt vmcnt(0)
    v_max3_u32 v26, v26, v16, v17
    v_cmp_eq_u32 vcc, -1, v26
    s_cbranch_vccnz Ltail_polly
Ltail_goty:
    s_waitcnt vmcnt(0) lgkmcnt(0)
    v_lshlrev_b32 v20, 16, v16
    v_and_b32 v21, 0xffff0000, v16
    v_lshlrev_b32 v22, 16, v17
    v_and_b32 v23, 0xffff0000, v17
    v_pk_add_f32 v[64:65], v[64:65], v[68:69]
    v_pk_add_f32 v[66:67], v[66:67], v[70:71]
    v_pk_add_f32 v[64:65], v[64:65], v[72:73]
    v_pk_add_f32 v[66:67], v[66:67], v[74:75]
    v_pk_add_f32 v[64:65], v[64:65], v[76:77]
    v_pk_add_f32 v[66:67], v[66:67], v[78:79]
    v_pk_add_f32 v[64:65], v[64:65], v[80:81]
    v_pk_add_f32 v[66:67], v[66:67], v[82:83]
    v_pk_add_f32 v[64:65], v[64:65], v[84:85]
    v_pk_add_f32 v[66:67], v[66:67], v[86:87]
    v_pk_add_f32 v[64:65], v[64:65], v[88:89]
    v_pk_add_f32 v[66:67], v[66:67], v[90:91]
    v_pk_add_f32 v[64:65], v[64:65], v[92:93]
    v_pk_add_f32 v[66:67], v[66:67], v[94:95]
    v_pk_add_f32 v[64:65], v[64:65], v[96:97]
    v_pk_add_f32 v[66:67], v[66:67], v[98:99]
    s_nop 0
    v_add_f32_dpp v64, v64, v64 row_ror:4 row_mask:0xf bank_mask:0xf
    v_add_f32_dpp v65, v65, v65 row_ror:4 row_mask:0xf bank_mask:0xf
    v_add_f32_dpp v66, v66, v66 row_ror:4 row_mask:0xf bank_mask:0xf
    v_add_f32_dpp v67, v67, v67 row_ror:4 row_mask:0xf bank_mask:0xf
    v_add_f32_dpp v64, v64, v64 row_ror:8 row_mask:0xf bank_mask:0xf
    v_add_f32_dpp v65, v65, v65 row_ror:8 row_mask:0xf bank_mask:0xf
    v_add_f32_dpp v66, v66, v66 row_ror:8 row_mask:0xf bank_mask:0xf
    v_add_f32_dpp v67, v67, v67 row_ror:8 row_mask:0xf bank_mask:0xf
    v_mov_b32 v68, v64
    v_mov_b32 v69, v65
    v_mov_b32 v70, v66
    v_mov_b32 v71, v67
    v_permlane16_swap_b32 v64, v68
    v_permlane16_swap_b32 v65, v69
    v_permlane16_swap_b32 v66, v70
    v_permlane16_swap_b32 v67, v71
    v_add_f32 v64, v64, v68
    v_add_f32 v65, v65, v69
    v_add_f32 v66, v66, v70
    v_add_f32 v67, v67, v71
    v_mov_b32 v68, v64
    v_mov_b32 v69, v65
    v_mov_b32 v70, v66
    v_mov_b32 v71, v67
    v_permlane32_swap_b32 v64, v68
    v_permlane32_swap_b32 v65, v69
    v_permlane32_swap_b32 v66, v70
    v_permlane32_swap_b32 v67, v71
    v_add_f32 v64, v64, v68
    v_add_f32 v65, v65, v69
    v_add_f32 v66, v66, v70
    v_add_f32 v67, v67, v71
    v_cndmask_b32 v26, v64, v65, s[38:39]
    v_cndmask_b32 v27, v66, v67, s[38:39]
    v_cvt_pk_bf16_f32 v28, v26, v27
    v_lshlrev_b32 v26, 16, v28
    v_and_b32 v27, 0xffff0000, v28
    v_mul_f32 v26, v26, v19
    v_mul_f32 v27, v27, v19
    v_cvt_pk_bf16_f32 v28, v26, v27
    v_lshlrev_b32 v26, 16, v28
    v_and_b32 v27, 0xffff0000, v28
    v_pk_add_f32 v[26:27], v[26:27], v[22:23]
    v_cvt_pk_bf16_f32 v28, v26, v27
    v_lshlrev_b32 v26, 16, v28
    v_and_b32 v27, 0xffff0000, v28
    v_pk_mul_f32 v[26:27], v[26:27], v[24:25]
    v_cvt_pk_bf16_f32 v28, v26, v27
    v_lshlrev_b32 v26, 16, v28
    v_and_b32 v27, 0xffff0000, v28
    v_pk_add_f32 v[26:27], v[26:27], v[20:21]
    v_cvt_pk_bf16_f32 v28, v26, v27
    s_mov_b64 exec, 0xff
    buffer_store_dword v28, v13, s[16:19], 0 offen nt
    s_branch Ltail_done
Ltail_idle:
Ltour1_2:
    s_cbranch_execz Lmain1
    v_lshlrev_b32 v216, 16, v64
    v_and_b32 v217, 0xffff0000, v64
    v_lshlrev_b32 v218, 16, v65
    v_and_b32 v219, 0xffff0000, v65
    v_lshlrev_b32 v220, 16, v66
    v_and_b32 v221, 0xffff0000, v66
    v_lshlrev_b32 v222, 16, v67
    v_and_b32 v223, 0xffff0000, v67
    v_lshlrev_b32 v224, 16, v68
    v_and_b32 v225, 0xffff0000, v68
    v_lshlrev_b32 v226, 16, v69
    v_and_b32 v227, 0xffff0000, v69
    v_lshlrev_b32 v228, 16, v70
    v_and_b32 v229, 0xffff0000, v70
    v_lshlrev_b32 v230, 16, v71
    v_and_b32 v231, 0xffff0000, v71
    v_lshlrev_b32 v232, 16, v72
    v_and_b32 v233, 0xffff0000, v72
    v_lshlrev_b32 v234, 16, v73
    v_and_b32 v235, 0xffff0000, v73
    v_lshlrev_b32 v236, 16, v74
    v_and_b32 v237, 0xffff0000, v74
    v_lshlrev_b32 v238, 16, v75
    v_and_b32 v239, 0xffff0000, v75
    v_pk_mul_f32 v[192:193], v[192:193], v[216:217]
    v_pk_mul_f32 v[194:195], v[194:195], v[218:219]
    v_pk_mul_f32 v[196:197], v[196:197], v[220:221]
    v_pk_mul_f32 v[198:199], v[198:199], v[222:223]
    v_pk_mul_f32 v[200:201], v[200:201], v[224:225]
    v_pk_mul_f32 v[202:203], v[202:203], v[226:227]
    v_pk_mul_f32 v[204:205], v[204:205], v[228:229]
    v_pk_mul_f32 v[206:207], v[206:207], v[230:231]
    v_pk_mul_f32 v[208:209], v[208:209], v[232:233]
    v_pk_mul_f32 v[210:211], v[210:211], v[234:235]
    v_pk_mul_f32 v[212:213], v[212:213], v[236:237]
    v_pk_mul_f32 v[214:215], v[214:215], v[238:239]
    v_cvt_pk_bf16_f32 v144, v192, v193
    v_cvt_pk_bf16_f32 v145, v194, v195
    v_cvt_pk_bf16_f32 v146, v196, v197
    v_cvt_pk_bf16_f32 v147, v198, v199
    v_cvt_pk_bf16_f32 v148, v200, v201
    v_cvt_pk_bf16_f32 v149, v202, v203
    v_cvt_pk_bf16_f32 v150, v204, v205
    v_cvt_pk_bf16_f32 v151, v206, v207
    v_cvt_pk_bf16_f32 v152, v208, v209
    v_cvt_pk_bf16_f32 v153, v210, v211
    v_cvt_pk_bf16_f32 v154, v212, v213
    v_cvt_pk_bf16_f32 v155, v214, v215
    v_lshlrev_b32 v192, 16, v144
    v_and_b32 v193, 0xffff0000, v144
    v_lshlrev_b32 v194, 16, v145
    v_and_b32 v195, 0xffff0000, v145
    v_lshlrev_b32 v196, 16, v146
    v_and_b32 v197, 0xffff0000, v146
    v_lshlrev_b32 v198, 16, v147
    v_and_b32 v199, 0xffff0000, v147
    v_lshlrev_b32 v200, 16, v148
    v_and_b32 v201, 0xffff0000, v148
    v_lshlrev_b32 v202, 16, v149
    v_and_b32 v203, 0xffff0000, v149
    v_lshlrev_b32 v204, 16, v150
    v_and_b32 v205, 0xffff0000, v150
    v_lshlrev_b32 v206, 16, v151
    v_and_b32 v207, 0xffff0000, v151
    v_lshlrev_b32 v208, 16, v152
    v_and_b32 v209, 0xffff0000, v152
    v_lshlrev_b32 v210, 16, v153
    v_and_b32 v211, 0xffff0000, v153
    v_lshlrev_b32 v212, 16, v154
    v_and_b32 v213, 0xffff0000, v154
    v_lshlrev_b32 v214, 16, v155
    v_and_b32 v215, 0xffff0000, v155
    v_pk_add_f32 v[192:193], v[192:193], v[12:13]
    v_pk_add_f32 v[194:195], v[194:195], v[14:15]
    v_pk_add_f32 v[196:197], v[196:197], v[16:17]
    v_pk_add_f32 v[198:199], v[198:199], v[18:19]
    v_pk_add_f32 v[200:201], v[200:201], v[20:21]
    v_pk_add_f32 v[202:203], v[202:203], v[22:23]
    v_pk_add_f32 v[204:205], v[204:205], v[24:25]
    v_pk_add_f32 v[206:207], v[206:207], v[26:27]
    v_pk_add_f32 v[208:209], v[208:209], v[28:29]
    v_pk_add_f32 v[210:211], v[210:211], v[30:31]
    v_pk_add_f32 v[212:213], v[212:213], v[32:33]
    v_pk_add_f32 v[214:215], v[214:215], v[34:35]
    v_cvt_pk_bf16_f32 v156, v192, v193
    v_cvt_pk_bf16_f32 v157, v194, v195
    v_cvt_pk_bf16_f32 v158, v196, v197
    v_cvt_pk_bf16_f32 v159, v198, v199
    v_cvt_pk_bf16_f32 v160, v200, v201
    v_cvt_pk_bf16_f32 v161, v202, v203
    v_cvt_pk_bf16_f32 v162, v204, v205
    v_cvt_pk_bf16_f32 v163, v206, v207
    v_cvt_pk_bf16_f32 v164, v208, v209
    v_cvt_pk_bf16_f32 v165, v210, v211
    v_cvt_pk_bf16_f32 v166, v212, v213
    v_cvt_pk_bf16_f32 v167, v214, v215
    v_and_b32 v30, 2, v1
    v_cmp_ne_u32 vcc, 0, v30
    v_mul_u32_u24 v30, 1152, v7
    v_add_u32 v4, v30, v5
    v_add_u32 v58, v30, v59
    v_mov_b32_dpp v192, v158 quad_perm:[0,2,0,2] row_mask:0xf bank_mask:0xf
    v_mov_b32_dpp v193, v159 quad_perm:[0,2,0,2] row_mask:0xf bank_mask:0xf
    v_mov_b32_dpp v194, v158 quad_perm:[1,3,1,3] row_mask:0xf bank_mask:0xf
    v_mov_b32_dpp v195, v159 quad_perm:[1,3,1,3] row_mask:0xf bank_mask:0xf
    v_mov_b32_dpp v196, v162 quad_perm:[0,2,0,2] row_mask:0xf bank_mask:0xf
    v_mov_b32_dpp v197, v163 quad_perm:[0,2,0,2] row_mask:0xf bank_mask:0xf
    v_mov_b32_dpp v198, v162 quad_perm:[1,3,1,3] row_mask:0xf bank_mask:0xf
    v_mov_b32_dpp v199, v163 quad_perm:[1,3,1,3] row_mask:0xf bank_mask:0xf
    v_mov_b32_dpp v200, v166 quad_perm:[0,2,0,2] row_mask:0xf bank_mask:0xf
    v_mov_b32_dpp v201, v167 quad_perm:[0,2,0,2] row_mask:0xf bank_mask:0xf
    v_mov_b32_dpp v202, v166 quad_perm:[1,3,1,3] row_mask:0xf bank_mask:0xf
    v_mov_b32_dpp v203, v167 quad_perm:[1,3,1,3] row_mask:0xf bank_mask:0xf
    v_cndmask_b32_dpp v144, v156, v192, vcc quad_perm:[0,2,0,2] row_mask:0xf bank_mask:0xf
    v_cndmask_b32_dpp v145, v157, v193, vcc quad_perm:[0,2,0,2] row_mask:0xf bank_mask:0xf
    v_cndmask_b32_dpp v146, v156, v194, vcc quad_perm:[1,3,1,3] row_mask:0xf bank_mask:0xf
    v_cndmask_b32_dpp v147, v157, v195, vcc quad_perm:[1,3,1,3] row_mask:0xf bank_mask:0xf
    v_cndmask_b32_dpp v148, v160, v196, vcc quad_perm:[0,2,0,2] row_mask:0xf bank_mask:0xf
    v_cndmask_b32_dpp v149, v161, v197, vcc quad_perm:[0,2,0,2] row_mask:0xf bank_mask:0xf
    v_cndmask_b32_dpp v150, v160, v198, vcc quad_perm:[1,3,1,3] row_mask:0xf bank_mask:0xf
    v_cndmask_b32_dpp v151, v161, v199, vcc quad_perm:[1,3,1,3] row_mask:0xf bank_mask:0xf
    v_cndmask_b32_dpp v152, v164, v200, vcc quad_perm:[0,2,0,2] row_mask:0xf bank_mask:0xf
    v_cndmask_b32_dpp v153, v165, v201, vcc quad_perm:[0,2,0,2] row_mask:0xf bank_mask:0xf
    v_cndmask_b32_dpp v154, v164, v202, vcc quad_perm:[1,3,1,3] row_mask:0xf bank_mask:0xf
    v_cndmask_b32_dpp v155, v165, v203, vcc quad_perm:[1,3,1,3] row_mask:0xf bank_mask:0xf
    buffer_store_dwordx4 v[144:147], v4, s[16:19], 0 offen offset:0 sc1
    buffer_store_dwordx4 v[148:151], v4, s[16:19], 0 offen offset:512 sc1
    buffer_store_dwordx4 v[152:155], v58, s[16:19], 0 offen offset:1024 sc1
    s_waitcnt vmcnt(0)
    s_mov_b32 s36, 2622592
    buffer_store_dwordx4 v[36:39], v6, s[24:27], s36 offen offset:0 sc1
    buffer_store_dwordx4 v[40:43], v6, s[24:27], s36 offen offset:512 sc1
    buffer_store_dwordx4 v[44:47], v60, s[24:27], s36 offen offset:1024 sc1
Ltail_done:
    s_endpgm
Lattn_wb:
    buffer_wbl2 sc1
    s_waitcnt vmcnt(0)
    s_branch Lattn_wbdone
Lattn_xspin:
Ltour0_12:
    s_cbranch_execz Lmain0
    s_mov_b32 s37, 262144
Lattn_xloop:
    buffer_load_dword v11, v8, s[24:27], s54 offen offset:8 sc1
    s_waitcnt vmcnt(0)
    v_readfirstlane_b32 s36, v11
    s_sub_u32 s37, s37, 1
    s_cbranch_scc1 Lattn_xgot
    s_cmp_lg_u32 s36, s95
    s_cbranch_scc1 Lattn_xloop
    s_branch Lattn_xgot
Ltail_spin1:
Ltour1_3:
    s_cbranch_execz Lmain1
    s_mov_b32 s48, 262144
Ltail_spinl1:
    buffer_load_dword v11, v9, s[24:27], s39 offen sc1
    s_waitcnt vmcnt(0)
    v_cmp_ne_u32 s[54:55], s95, v11
    s_sub_u32 s48, s48, 1
    s_cbranch_scc1 Ltail_got1
    s_cmp_lg_u64 s[54:55], 0
    s_cbranch_scc1 Ltail_spinl1
    s_branch Ltail_got1
Ltail_spin2:
Ltour1_4:
    s_cbranch_execz Lmain1
    s_mov_b32 s48, 262144
Ltail_spinl2:
    buffer_load_dword v11, v9, s[24:27], s39 offen sc1
    s_waitcnt vmcnt(0)
    v_cmp_ne_u32 s[54:55], s95, v11
    s_sub_u32 s48, s48, 1
    s_cbranch_scc1 Ltail_got2
    s_cmp_lg_u64 s[54:55], 0
    s_cbranch_scc1 Ltail_spinl2
    s_branch Ltail_got2
Lattn_redo:
    s_load_dwordx2 s[16:17], s[0:1], 88
    v_xor_b32 v8, 64, v9
    v_xor_b32 v10, 64, v11
    s_waitcnt vmcnt(0) lgkmcnt(0)
    s_barrier
    v_mov_b32 v232, 0xff800000
    v_mov_b32 v233, 0xff800000
    v_mov_b32 v234, 0xff800000
    v_mov_b32 v235, 0xff800000
    s_mov_b32 s40, 0
    s_mov_b32 s48, -1
Lattn_redo_loop:
    s_add_u32 m0, s42, 0
    s_nop 0
    buffer_load_dwordx4 v36, s[8:11], s40 offen lds
    buffer_load_dwordx4 v37, s[8:11], s40 offen offset:1024 lds
    buffer_load_dwordx4 v38, s[8:11], s40 offen offset:2048 lds
    buffer_load_dwordx4 v39, s[8:11], s40 offen offset:3072 lds
    s_add_u32 s40, s40, 16384
    s_waitcnt vmcnt(0) lgkmcnt(0)
    s_barrier
    ds_read_b128 a[208:211], v8 offset:0
    ds_read_b128 a[212:215], v9 offset:0
    ds_read_b128 a[216:219], v10 offset:0
    ds_read_b128 a[220:223], v11 offset:0
    s_waitcnt lgkmcnt(3)
    v_mfma_f32_16x16x32_bf16 v[216:219], a[208:211], v[64:67], 0
    s_waitcnt lgkmcnt(2)
    v_mfma_f32_16x16x32_bf16 v[216:219], a[212:215], v[68:71], v[216:219]
    s_waitcnt lgkmcnt(1)
    v_mfma_f32_16x16x32_bf16 v[216:219], a[216:219], v[72:75], v[216:219]
    s_waitcnt lgkmcnt(0)
    v_mfma_f32_16x16x32_bf16 v[216:219], a[220:223], v[76:79], v[216:219]
    v_mfma_f32_16x16x32_bf16 v[220:223], a[208:211], v[80:83], 0
    v_mfma_f32_16x16x32_bf16 v[220:223], a[212:215], v[84:87], v[220:223]
    v_mfma_f32_16x16x32_bf16 v[220:223], a[216:219], v[88:91], v[220:223]
    v_mfma_f32_16x16x32_bf16 v[220:223], a[220:223], v[92:95], v[220:223]
    v_mfma_f32_16x16x32_bf16 v[224:227], a[208:211], v[96:99], 0
    v_mfma_f32_16x16x32_bf16 v[224:227], a[212:215], v[100:103], v[224:227]
    v_mfma_f32_16x16x32_bf16 v[224:227], a[216:219], v[104:107], v[224:227]
    v_mfma_f32_16x16x32_bf16 v[224:227], a[220:223], v[108:111], v[224:227]
    v_mfma_f32_16x16x32_bf16 v[228:231], a[208:211], v[112:115], 0
    v_mfma_f32_16x16x32_bf16 v[228:231], a[212:215], v[116:119], v[228:231]
    v_mfma_f32_16x16x32_bf16 v[228:231], a[216:219], v[120:123], v[228:231]
    v_mfma_f32_16x16x32_bf16 v[228:231], a[220:223], v[124:127], v[228:231]
    v_max3_f32 v232, v232, v216, v217
    v_max3_f32 v232, v232, v218, v219
    v_max3_f32 v233, v233, v220, v221
    v_max3_f32 v233, v233, v222, v223
    v_max3_f32 v234, v234, v224, v225
    v_max3_f32 v234, v234, v226, v227
    s_nop 1
    v_max3_f32 v235, v235, v228, v229
    v_max3_f32 v235, v235, v230, v231
    ds_read_b128 a[224:227], v8 offset:4096
    ds_read_b128 a[228:231], v9 offset:4096
    ds_read_b128 a[232:235], v10 offset:4096
    ds_read_b128 a[236:239], v11 offset:4096
    s_waitcnt lgkmcnt(3)
    v_mfma_f32_16x16x32_bf16 v[216:219], a[224:227], v[64:67], 0
    s_waitcnt lgkmcnt(2)
    v_mfma_f32_16x16x32_bf16 v[216:219], a[228:231], v[68:71], v[216:219]
    s_waitcnt lgkmcnt(1)
    v_mfma_f32_16x16x32_bf16 v[216:219], a[232:235], v[72:75], v[216:219]
    s_waitcnt lgkmcnt(0)
    v_mfma_f32_16x16x32_bf16 v[216:219], a[236:239], v[76:79], v[216:219]
    v_mfma_f32_16x16x32_bf16 v[220:223], a[224:227], v[80:83], 0
    v_mfma_f32_16x16x32_bf16 v[220:223], a[228:231], v[84:87], v[220:223]
    v_mfma_f32_16x16x32_bf16 v[220:223], a[232:235], v[88:91], v[220:223]
    v_mfma_f32_16x16x32_bf16 v[220:223], a[236:239], v[92:95], v[220:223]
    v_mfma_f32_16x16x32_bf16 v[224:227], a[224:227], v[96:99], 0
    v_mfma_f32_16x16x32_bf16 v[224:227], a[228:231], v[100:103], v[224:227]
    v_mfma_f32_16x16x32_bf16 v[224:227], a[232:235], v[104:107], v[224:227]
    v_mfma_f32_16x16x32_bf16 v[224:227], a[236:239], v[108:111], v[224:227]
    v_mfma_f32_16x16x32_bf16 v[228:231], a[224:227], v[112:115], 0
    v_mfma_f32_16x16x32_bf16 v[228:231], a[228:231], v[116:119], v[228:231]
    v_mfma_f32_16x16x32_bf16 v[228:231], a[232:235], v[120:123], v[228:231]
    v_mfma_f32_16x16x32_bf16 v[228:231], a[236:239], v[124:127], v[228:231]
    v_max3_f32 v232, v232, v216, v217
    v_max3_f32 v232, v232, v218, v219
    v_max3_f32 v233, v233, v220, v221
    v_max3_f32 v233, v233, v222, v223
    v_max3_f32 v234, v234, v224, v225
    v_max3_f32 v234, v234, v226, v227
    s_nop 1
    v_max3_f32 v235, v235, v228, v229
    v_max3_f32 v235, v235, v230, v231
    ds_read_b128 a[208:211], v8 offset:8192
    ds_read_b128 a[212:215], v9 offset:8192
    ds_read_b128 a[216:219], v10 offset:8192
    ds_read_b128 a[220:223], v11 offset:8192
    s_waitcnt lgkmcnt(3)
    v_mfma_f32_16x16x32_bf16 v[216:219], a[208:211], v[64:67], 0
    s_waitcnt lgkmcnt(2)
    v_mfma_f32_16x16x32_bf16 v[216:219], a[212:215], v[68:71], v[216:219]
    s_waitcnt lgkmcnt(1)
    v_mfma_f32_16x16x32_bf16 v[216:219], a[216:219], v[72:75], v[216:219]
    s_waitcnt lgkmcnt(0)
    v_mfma_f32_16x16x32_bf16 v[216:219], a[220:223], v[76:79], v[216:219]
    v_mfma_f32_16x16x32_bf16 v[220:223], a[208:211], v[80:83], 0
    v_mfma_f32_16x16x32_bf16 v[220:223], a[212:215], v[84:87], v[220:223]
    v_mfma_f32_16x16x32_bf16 v[220:223], a[216:219], v[88:91], v[220:223]
    v_mfma_f32_16x16x32_bf16 v[220:223], a[220:223], v[92:95], v[220:223]
    v_mfma_f32_16x16x32_bf16 v[224:227], a[208:211], v[96:99], 0
    v_mfma_f32_16x16x32_bf16 v[224:227], a[212:215], v[100:103], v[224:227]
    v_mfma_f32_16x16x32_bf16 v[224:227], a[216:219], v[104:107], v[224:227]
    v_mfma_f32_16x16x32_bf16 v[224:227], a[220:223], v[108:111], v[224:227]
    v_mfma_f32_16x16x32_bf16 v[228:231], a[208:211], v[112:115], 0
    v_mfma_f32_16x16x32_bf16 v[228:231], a[212:215], v[116:119], v[228:231]
    v_mfma_f32_16x16x32_bf16 v[228:231], a[216:219], v[120:123], v[228:231]
    v_mfma_f32_16x16x32_bf16 v[228:231], a[220:223], v[124:127], v[228:231]
    v_max3_f32 v232, v232, v216, v217
    v_max3_f32 v232, v232, v218, v219
    v_max3_f32 v233, v233, v220, v221
    v_max3_f32 v233, v233, v222, v223
    v_max3_f32 v234, v234, v224, v225
    v_max3_f32 v234, v234, v226, v227
    s_nop 1
    v_max3_f32 v235, v235, v228, v229
    v_max3_f32 v235, v235, v230, v231
    ds_read_b128 a[224:227], v8 offset:12288
    ds_read_b128 a[228:231], v9 offset:12288
    ds_read_b128 a[232:235], v10 offset:12288
    ds_read_b128 a[236:239], v11 offset:12288
    s_waitcnt lgkmcnt(3)
    v_mfma_f32_16x16x32_bf16 v[216:219], a[224:227], v[64:67], 0
    s_waitcnt lgkmcnt(2)
    v_mfma_f32_16x16x32_bf16 v[216:219], a[228:231], v[68:71], v[216:219]
    s_waitcnt lgkmcnt(1)
    v_mfma_f32_16x16x32_bf16 v[216:219], a[232:235], v[72:75], v[216:219]
    s_waitcnt lgkmcnt(0)
    v_mfma_f32_16x16x32_bf16 v[216:219], a[236:239], v[76:79], v[216:219]
    v_mfma_f32_16x16x32_bf16 v[220:223], a[224:227], v[80:83], 0
    v_mfma_f32_16x16x32_bf16 v[220:223], a[228:231], v[84:87], v[220:223]
    v_mfma_f32_16x16x32_bf16 v[220:223], a[232:235], v[88:91], v[220:223]
    v_mfma_f32_16x16x32_bf16 v[220:223], a[236:239], v[92:95], v[220:223]
    v_mfma_f32_16x16x32_bf16 v[224:227], a[224:227], v[96:99], 0
    v_mfma_f32_16x16x32_bf16 v[224:227], a[228:231], v[100:103], v[224:227]
    v_mfma_f32_16x16x32_bf16 v[224:227], a[232:235], v[104:107], v[224:227]
    v_mfma_f32_16x16x32_bf16 v[224:227], a[236:239], v[108:111], v[224:227]
    v_mfma_f32_16x16x32_bf16 v[228:231], a[224:227], v[112:115], 0
    v_mfma_f32_16x16x32_bf16 v[228:231], a[228:231], v[116:119], v[228:231]
    v_mfma_f32_16x16x32_bf16 v[228:231], a[232:235], v[120:123], v[228:231]
    v_mfma_f32_16x16x32_bf16 v[228:231], a[236:239], v[124:127], v[228:231]
    v_max3_f32 v232, v232, v216, v217
    v_max3_f32 v232, v232, v218, v219
    v_max3_f32 v233, v233, v220, v221
    v_max3_f32 v233, v233, v222, v223
    v_max3_f32 v234, v234, v224, v225
    v_max3_f32 v234, v234, v226, v227
    s_nop 1
    v_max3_f32 v235, v235, v228, v229
    v_max3_f32 v235, v235, v230, v231
    s_barrier
    s_cmp_lt_u32 s40, 524288
    s_cbranch_scc1 Lattn_redo_loop
    v_mov_b32 v236, v232
    v_mov_b32 v237, v233
    v_mov_b32 v238, v234
    v_mov_b32 v239, v235
    v_permlane16_swap_b32 v232, v236
    v_permlane16_swap_b32 v233, v237
    v_permlane16_swap_b32 v234, v238
    v_permlane16_swap_b32 v235, v239
    v_max_f32 v232, v232, v236
    v_max_f32 v233, v233, v237
    v_max_f32 v234, v234, v238
    v_max_f32 v235, v235, v239
    v_mov_b32 v236, v232
    v_mov_b32 v237, v233
    v_mov_b32 v238, v234
    v_mov_b32 v239, v235
    v_permlane32_swap_b32 v232, v236
    v_permlane32_swap_b32 v233, v237
    v_permlane32_swap_b32 v234, v238
    v_permlane32_swap_b32 v235, v239
    v_max_f32 v232, v232, v236
    v_max_f32 v233, v233, v237
    v_max_f32 v234, v234, v238
    v_max_f32 v235, v235, v239
    v_sub_f32 v192, 0, v232
    v_sub_f32 v193, 0, v232
    v_sub_f32 v194, 0, v232
    v_sub_f32 v195, 0, v232
    v_sub_f32 v196, 0, v233
    v_sub_f32 v197, 0, v233
    v_sub_f32 v198, 0, v233
    v_sub_f32 v199, 0, v233
    v_sub_f32 v200, 0, v234
    v_sub_f32 v201, 0, v234
    v_sub_f32 v202, 0, v234
    v_sub_f32 v203, 0, v234
    v_sub_f32 v204, 0, v235
    v_sub_f32 v205, 0, v235
    v_sub_f32 v206, 0, v235
    v_sub_f32 v207, 0, v235
    s_mov_b32 s40, 0
    s_mov_b32 s41, 0
    s_add_u32 m0, s42, 0
    s_nop 0
    buffer_load_dwordx4 v36, s[8:11], s40 offen lds
    buffer_load_dwordx4 v37, s[8:11], s40 offen offset:1024 lds
    buffer_load_dwordx4 v38, s[8:11], s40 offen offset:2048 lds
    buffer_load_dwordx4 v39, s[8:11], s40 offen offset:3072 lds
    s_add_u32 s40, s40, 16384
    s_add_u32 m0, s42, 16384
    s_nop 0
    buffer_load_dwordx4 v36, s[8:11], s40 offen lds
    buffer_load_dwordx4 v37, s[8:11], s40 offen offset:1024 lds
    buffer_load_dwordx4 v38, s[8:11], s40 offen offset:2048 lds
    buffer_load_dwordx4 v39, s[8:11], s40 offen offset:3072 lds
    s_add_u32 s40, s40, 16384
    s_add_u32 m0, s42, 32768
    s_nop 0
    buffer_load_dwordx4 v36, s[8:11], s40 offen lds
    buffer_load_dwordx4 v37, s[8:11], s40 offen offset:1024 lds
    buffer_load_dwordx4 v38, s[8:11], s40 offen offset:2048 lds
    buffer_load_dwordx4 v39, s[8:11], s40 offen offset:3072 lds
    s_add_u32 s40, s40, 16384
    s_add_u32 m0, s42, 65536
    s_nop 0
    buffer_load_dwordx4 v40, s[12:15], s41 offen lds
    buffer_load_dwordx4 v41, s[12:15], s41 offen offset:1024 lds
    buffer_load_dwordx4 v40, s[12:15], s41 offen offset:2048 lds
    buffer_load_dwordx4 v41, s[12:15], s41 offen offset:3072 lds
    s_add_u32 s41, s41, 16384
    s_add_u32 m0, s42, 81920
    s_nop 0
    buffer_load_dwordx4 v40, s[12:15], s41 offen lds
    buffer_load_dwordx4 v41, s[12:15], s41 offen offset:1024 lds
    buffer_load_dwordx4 v40, s[12:15], s41 offen offset:2048 lds
    buffer_load_dwordx4 v41, s[12:15], s41 offen offset:3072 lds
    s_add_u32 s41, s41, 16384
    v_accvgpr_write_b32 a0, 0
    v_accvgpr_write_b32 a1, 0
    v_accvgpr_write_b32 a2, 0
    v_accvgpr_write_b32 a3, 0
    v_accvgpr_write_b32 a4, 0
    v_accvgpr_write_b32 a5, 0
    v_accvgpr_write_b32 a6, 0
    v_accvgpr_write_b32 a7, 0
    v_accvgpr_write_b32 a8, 0
    v_accvgpr_write_b32 a9, 0
    v_accvgpr_write_b32 a10, 0
    v_accvgpr_write_b32 a11, 0
    v_accvgpr_write_b32 a12, 0
    v_accvgpr_write_b32 a13, 0
    v_accvgpr_write_b32 a14, 0
    v_accvgpr_write_b32 a15, 0
    v_accvgpr_write_b32 a16, 0
    v_accvgpr_write_b32 a17, 0
    v_accvgpr_write_b32 a18, 0
    v_accvgpr_write_b32 a19, 0
    v_accvgpr_write_b32 a20, 0
    v_accvgpr_write_b32 a21, 0
    v_accvgpr_write_b32 a22, 0
    v_accvgpr_write_b32 a23, 0
    v_accvgpr_write_b32 a24, 0
    v_accvgpr_write_b32 a25, 0
    v_accvgpr_write_b32 a26, 0
    v_accvgpr_write_b32 a27, 0
    v_accvgpr_write_b32 a28, 0
    v_accvgpr_write_b32 a29, 0
    v_accvgpr_write_b32 a30, 0
    v_accvgpr_write_b32 a31, 0
    v_accvgpr_write_b32 a32, 0
    v_accvgpr_write_b32 a33, 0
    v_accvgpr_write_b32 a34, 0
    v_accvgpr_write_b32 a35, 0
    v_accvgpr_write_b32 a36, 0
    v_accvgpr_write_b32 a37, 0
    v_accvgpr_write_b32 a38, 0
    v_accvgpr_write_b32 a39, 0
    v_accvgpr_write_b32 a40, 0
    v_accvgpr_write_b32 a41, 0
    v_accvgpr_write_b32 a42, 0
    v_accvgpr_write_b32 a43, 0
    v_accvgpr_write_b32 a44, 0
    v_accvgpr_write_b32 a45, 0
    v_accvgpr_write_b32 a46, 0
    v_accvgpr_write_b32 a47, 0
    v_accvgpr_write_b32 a48, 0
    v_accvgpr_write_b32 a49, 0
    v_accvgpr_write_b32 a50, 0
    v_accvgpr_write_b32 a51, 0
    v_accvgpr_write_b32 a52, 0
    v_accvgpr_write_b32 a53, 0
    v_accvgpr_write_b32 a54, 0
    v_accvgpr_write_b32 a55, 0
    v_accvgpr_write_b32 a56, 0
    v_accvgpr_write_b32 a57, 0
    v_accvgpr_write_b32 a58, 0
    v_accvgpr_write_b32 a59, 0
    v_accvgpr_write_b32 a60, 0
    v_accvgpr_write_b32 a61, 0
    v_accvgpr_write_b32 a62, 0
    v_accvgpr_write_b32 a63, 0
    v_accvgpr_write_b32 a64, 0
    v_accvgpr_write_b32 a65, 0
    v_accvgpr_write_b32 a66, 0
    v_accvgpr_write_b32 a67, 0
    v_accvgpr_write_b32 a68, 0
    v_accvgpr_write_b32 a69, 0
    v_accvgpr_write_b32 a70, 0
    v_accvgpr_write_b32 a71, 0
    v_accvgpr_write_b32 a72, 0
    v_accvgpr_write_b32 a73, 0
    v_accvgpr_write_b32 a74, 0
    v_accvgpr_write_b32 a75, 0
    v_accvgpr_write_b32 a76, 0
    v_accvgpr_write_b32 a77, 0
    v_accvgpr_write_b32 a78, 0
    v_accvgpr_write_b32 a79, 0
    v_accvgpr_write_b32 a80, 0
    v_accvgpr_write_b32 a81, 0
    v_accvgpr_write_b32 a82, 0
    v_accvgpr_write_b32 a83, 0
    v_accvgpr_write_b32 a84, 0
    v_accvgpr_write_b32 a85, 0
    v_accvgpr_write_b32 a86, 0
    v_accvgpr_write_b32 a87, 0
    v_accvgpr_write_b32 a88, 0
    v_accvgpr_write_b32 a89, 0
    v_accvgpr_write_b32 a90, 0
    v_accvgpr_write_b32 a91, 0
    v_accvgpr_write_b32 a92, 0
    v_accvgpr_write_b32 a93, 0
    v_accvgpr_write_b32 a94, 0
    v_accvgpr_write_b32 a95, 0
    v_accvgpr_write_b32 a96, 0
    v_accvgpr_write_b32 a97, 0
    v_accvgpr_write_b32 a98, 0
    v_accvgpr_write_b32 a99, 0
    v_accvgpr_write_b32 a100, 0
    v_accvgpr_write_b32 a101, 0
    v_accvgpr_write_b32 a102, 0
    v_accvgpr_write_b32 a103, 0
    v_accvgpr_write_b32 a104, 0
    v_accvgpr_write_b32 a105, 0
    v_accvgpr_write_b32 a106, 0
    v_accvgpr_write_b32 a107, 0
    v_accvgpr_write_b32 a108, 0
    v_accvgpr_write_b32 a109, 0
    v_accvgpr_write_b32 a110, 0
    v_accvgpr_write_b32 a111, 0
    v_accvgpr_write_b32 a112, 0
    v_accvgpr_write_b32 a113, 0
    v_accvgpr_write_b32 a114, 0
    v_accvgpr_write_b32 a115, 0
    v_accvgpr_write_b32 a116, 0
    v_accvgpr_write_b32 a117, 0
    v_accvgpr_write_b32 a118, 0
    v_accvgpr_write_b32 a119, 0
    v_accvgpr_write_b32 a120, 0
    v_accvgpr_write_b32 a121, 0
    v_accvgpr_write_b32 a122, 0
    v_accvgpr_write_b32 a123, 0
    v_accvgpr_write_b32 a124, 0
    v_accvgpr_write_b32 a125, 0
    v_accvgpr_write_b32 a126, 0
    v_accvgpr_write_b32 a127, 0
    v_accvgpr_write_b32 a192, 0
    v_accvgpr_write_b32 a193, 0
    v_accvgpr_write_b32 a194, 0
    v_accvgpr_write_b32 a195, 0
    v_accvgpr_write_b32 a196, 0
    v_accvgpr_write_b32 a197, 0
    v_accvgpr_write_b32 a198, 0
    v_accvgpr_write_b32 a199, 0
    v_accvgpr_write_b32 a200, 0
    v_accvgpr_write_b32 a201, 0
    v_accvgpr_write_b32 a202, 0
    v_accvgpr_write_b32 a203, 0
    v_accvgpr_write_b32 a204, 0
    v_accvgpr_write_b32 a205, 0
    v_accvgpr_write_b32 a206, 0
    v_accvgpr_write_b32 a207, 0
    s_waitcnt vmcnt(0) lgkmcnt(0)
    s_barrier
    ds_read_b128 a[208:211], v8 offset:0
    ds_read_b128 a[212:215], v9 offset:0
    ds_read_b128 a[216:219], v10 offset:0
    ds_read_b128 a[220:223], v11 offset:0
    ds_read_b128 a[224:227], v8 offset:4096
    s_waitcnt vmcnt(0) lgkmcnt(0)
    s_branch Lattn_stage0
Lattn_armwait:
    s_mov_b32 s36, 262144
Lattn_armloop:
    v_mov_b32 v63, 0
    buffer_load_dword v63, v63, s[88:91], 0 offen sc1
    s_waitcnt vmcnt(0)
    v_readfirstlane_b32 s37, v63
    s_sub_u32 s36, s36, 1
    s_cbranch_scc1 Lattn_armed
    s_cmp_lt_u32 s37, 256
    s_cbranch_scc1 Lattn_armloop
    s_branch Lattn_armed
Lattn_end:
    s_endpgm
.section .rodata,"a"
.p2align 6
.amdhsa_kernel adaLN_cond__gqa_block_cached__moe_arch_mod__prompt_kernel
  .amdhsa_next_free_vgpr 512
  .amdhsa_next_free_sgpr 102
  .amdhsa_accum_offset 256
  .amdhsa_group_segment_fixed_size 0
  .amdhsa_kernarg_size 120
  .amdhsa_user_sgpr_count 2
  .amdhsa_user_sgpr_kernarg_segment_ptr 1
  .amdhsa_system_sgpr_workgroup_id_x 1
  .amdhsa_float_denorm_mode_32 3
.end_amdhsa_kernel
```

```asm
; @launch grid=(256,1,1) block=(256,1,1) lds=163840
.amdgcn_target "amdgcn-amd-amdhsa--gfx950"
.text
.globl adaLN_cond__gqa_block_cached__moe_arch_mod__prompt_kernel
.p2align 8
.type adaLN_cond__gqa_block_cached__moe_arch_mod__prompt_kernel,@function
adaLN_cond__gqa_block_cached__moe_arch_mod__prompt_kernel:
    s_cmp_ge_u32 s2, 256
    s_cbranch_scc1 Lattn_end
    s_load_dwordx2 s[8:9], s[0:1], 80
    s_load_dwordx2 s[12:13], s[0:1], 88
    s_load_dwordx2 s[20:21], s[0:1], 0
    s_load_dwordx2 s[50:51], s[0:1], 112
    s_load_dwordx8 s[52:59], s[0:1], 8
    s_load_dwordx4 s[80:83], s[0:1], 56
    s_load_dwordx2 s[84:85], s[0:1], 72
    s_load_dwordx2 s[88:89], s[0:1], 104
    s_load_dwordx2 s[28:29], s[0:1], 48
    s_getpc_b64 s[32:33]
Lattn_pc:
    s_mov_b32 s34, Lattn_end-Lattn_pc
    s_mov_b32 s35, 0x20000
    s_lshr_b32 s6, s2, 3
    s_lshl_b32 s7, s6, 6
    v_lshrrev_b32 v3, 6, v0
    v_and_b32 v1, 63, v0
    v_lshrrev_b32 v2, 2, v0
    v_lshlrev_b32 v2, 11, v2
    v_readfirstlane_b32 s3, v3
    buffer_load_dword v240, v2, s[32:35], s7 offen
    s_and_b32 s7, s2, 7
    s_lshl_b32 s4, s7, 1
    s_and_b32 s5, s6, 1
    s_add_u32 s4, s4, s5
    s_lshr_b32 s5, s2, 4
    s_lshr_b32 s38, s6, 2
    s_lshl_b32 s38, s38, 3
    s_add_u32 s38, s38, s7
    s_cmp_lt_u32 s38, 18
    s_cselect_b32 s39, 0, 2147483648
    s_lshl_b32 s38, s38, 2
    s_and_b32 s36, s6, 3
    s_add_u32 s38, s38, s36
    s_mov_b32 s14, 3981312
    s_mul_i32 s92, s6, 124416
    s_lshl_b32 s36, s7, 7
    s_add_u32 s92, s92, s36
    s_cmp_lt_u32 s7, 2
    s_cselect_b32 s36, 53, 35
    v_lshrrev_b32 v2, 2, v0
    v_min_u32 v2, s36, v2
    v_mul_u32_u24 v3, 57, v2
    v_lshrrev_b32 v3, 10, v3
    v_mul_i32_i24 v3, -123392, v3
    v_mul_u32_u24 v2, 6912, v2
    v_add_u32 v72, v2, v3
    s_mov_b32 s15, 0x20000
    s_mov_b32 s10, 1152
    s_mov_b32 s11, 0x20000
    s_mov_b32 s22, 2359296
    s_mov_b32 s23, 0x20000
    v_and_b32 v64, 0xfe, v0
    v_mul_u32_u24 v65, 3456, v64
    v_and_b32 v2, 1, v0
    v_lshl_add_u32 v65, v2, 4, v65
    s_lshl_b32 s36, s38, 5
    s_or_b32 s36, s36, s39
    v_and_b32 v4, 31, v1
    v_lshrrev_b32 v5, 5, v1
    v_cmp_gt_u32 vcc, 24, v4
    v_mov_b32 v6, 2147483648
    s_lshl_b32 s7, s5, 4
    s_add_u32 s7, s7, s4
    s_lshl_b32 s7, s7, 2
    s_add_u32 s7, s7, s3
    v_cndmask_b32 v6, v6, 0, vcc
    s_mul_i32 s49, s7, 2304
    v_lshrrev_b32 v7, 2, v4
    v_lshl_add_u32 v7, v7, 6, v6
    v_and_b32 v2, 3, v4
    v_lshl_add_u32 v7, v2, 3, v7
    v_mul_u32_u24 v2, 1152, v5
    v_add_u32 v66, v7, v2
    s_waitcnt lgkmcnt(0)
    s_load_dword s94, s[50:51], 24576
    buffer_load_dword v241, v72, s[12:15], s92 offen
    buffer_load_ushort v80, v64, s[8:11], 0 offen offset:0
    buffer_load_ushort v81, v64, s[8:11], 0 offen offset:256
    buffer_load_ushort v82, v64, s[8:11], 0 offen offset:512
    buffer_load_ushort v83, v64, s[8:11], 0 offen offset:768
    buffer_load_ushort v84, v64, s[8:11], 0 offen offset:1024
    buffer_load_dwordx4 v[88:91], v65, s[12:15], s36 offen
    s_add_u32 s36, s36, 884736
    buffer_load_dwordx4 v[92:95], v65, s[12:15], s36 offen
    s_add_u32 s36, s36, 884736
    buffer_load_dwordx4 v[96:99], v65, s[12:15], s36 offen
    s_add_u32 s36, s36, 884736
    buffer_load_dwordx4 v[100:103], v65, s[12:15], s36 offen
    s_add_u32 s36, s36, 884736
    buffer_load_dwordx4 v[104:107], v65, s[12:15], s36 offen
    s_mov_b32 s16, s56
    s_mov_b32 s17, s57
    s_mov_b32 s18, 4718592
    s_mov_b32 s19, 0x20000
    s_lshl_b32 s44, s4, 9
    s_mul_i32 s36, s5, 131072
    s_add_u32 s36, s36, 0
    v_lshrrev_b32 v2, 2, v0
    v_min_u32 v2, 63, v2
    v_lshrrev_b32 v3, 2, v2
    v_and_b32 v2, 3, v2
    v_lshl_add_u32 v2, v2, 7, s36
    v_lshl_add_u32 v71, v3, 13, v2
    s_mul_i32 s36, s5, 163840
    s_add_u32 s36, s36, 2097152
    v_lshrrev_b32 v2, 1, v0
    v_min_u32 v2, 79, v2
    v_lshrrev_b32 v3, 2, v2
    v_and_b32 v2, 3, v2
    v_lshl_add_u32 v2, v2, 7, s36
    v_lshl_add_u32 v70, v3, 13, v2
    s_add_u32 s92, s49, 65536
    v_lshl_add_u32 v7, v5, 4, v6
    v_lshl_add_u32 v67, v4, 5, v7
    v_min_u32 v4, 23, v4
    v_lshlrev_b32 v68, 4, v4
    s_mov_b32 s24, s50
    s_mov_b32 s25, s51
    s_mov_b32 s26, 10485760
    s_mov_b32 s27, 0x20000
    s_mov_b32 s90, 256
    s_mov_b32 s91, 0x20000
    s_cmp_ge_u32 s38, 36
    s_cselect_b32 s93, 1.0, 0
    s_lshl_b32 s36, s38, 7
    v_lshl_add_u32 v69, v0, 3, s36
    v_cmp_gt_u32 s[36:37], 16, v0
    v_mov_b32 v2, 2147483648
    v_mov_b32 v3, s39
    v_cndmask_b32 v2, v2, v3, s[36:37]
    v_or_b32 v69, v69, v2
    s_mul_i32 s36, s5, 3072
    s_lshl_b32 s37, s5, 11
    v_lshrrev_b32 v120, 3, v0
    v_min_u32 v120, 23, v120
    v_lshl_add_u32 v120, v120, 7, s36
    v_lshrrev_b32 v121, 4, v0
    v_lshl_add_u32 v121, v121, 7, s37
    s_lshl_b32 s42, s3, 12
    v_lshrrev_b32 v2, 4, v1
    v_and_b32 v3, 15, v1
    v_lshrrev_b32 v5, 1, v3
    v_mul_u32_u24 v5, 2304, v5
    v_lshl_add_u32 v5, v2, 5, v5
    v_and_b32 v6, 1, v3
    v_lshl_add_u32 v51, v6, 4, v5
    s_lshl_b32 s6, s5, 2
    s_add_u32 s6, s6, s3
    s_mul_i32 s46, s6, 36864
    s_add_u32 s46, s46, 65536
    s_add_u32 s43, s46, 18432
    s_mul_i32 s45, s4, 294912
    s_lshl_b32 s7, s3, 4
    v_add_u32 v4, s7, v2
    v_lshlrev_b32 v5, 1, v2
    v_xor_b32 v5, v5, v3
    v_xor_b32 v6, 8, v5
    v_lshlrev_b32 v7, 13, v4
    v_lshl_add_u32 v42, v5, 4, v7
    v_lshl_add_u32 v43, v6, 4, v7
    v_add_u32 v44, 63488, v42
    v_add_u32 v45, 95232, v43
    v_add_u32 v43, 31744, v43
    s_lshl_b32 s7, s4, 19
    s_add_u32 s8, s52, s7
    s_addc_u32 s9, s53, 0
    s_mov_b32 s10, 524288
    s_mov_b32 s11, 0x20000
    s_add_u32 s12, s54, s7
    s_addc_u32 s13, s55, 0
    s_mov_b32 s14, 524288
    s_mov_b32 s15, 0x20000
    s_add_u32 s28, s50, 10485760
    s_addc_u32 s29, s51, 0
    s_mov_b32 s30, 37879808
    s_mov_b32 s31, 0x20000
    v_lshlrev_b32 v7, 8, v4
    v_lshl_add_u32 v40, v5, 4, v7
    v_lshl_add_u32 v41, v6, 4, v7
    v_xor_b32 v224, v3, v2
    v_lshl_add_u32 v36, v224, 4, v7
    v_xor_b32 v37, 64, v36
    v_xor_b32 v38, 128, v36
    v_xor_b32 v39, 192, v36
    v_lshrrev_b32 v7, 3, v5
    v_lshl_add_u32 v7, v7, 7, v4
    v_mul_u32_u24 v7, 1152, v7
    v_and_b32 v225, 7, v5
    v_lshl_add_u32 v46, v225, 4, v7
    v_lshrrev_b32 v7, 3, v6
    v_lshl_add_u32 v7, v7, 7, v4
    v_mul_u32_u24 v7, 1152, v7
    v_and_b32 v225, 7, v6
    v_lshl_add_u32 v47, v225, 4, v7
    v_add_u32 v48, 7168, v46
    v_add_u32 v49, 10752, v47
    v_add_u32 v47, 3584, v47
    v_lshlrev_b32 v7, 8, v3
    v_lshl_add_u32 v8, v224, 4, v7
    v_xor_b32 v9, 64, v8
    v_xor_b32 v10, 128, v8
    v_xor_b32 v11, 192, v8
    v_lshrrev_b32 v5, 2, v1
    v_and_b32 v6, 7, v5
    v_lshlrev_b32 v6, 5, v6
    v_lshl_add_u32 v6, v5, 8, v6
    v_and_b32 v7, 3, v1
    v_lshl_add_u32 v12, v7, 3, v6
    v_xor_b32 v13, 32, v12
    v_xor_b32 v14, 64, v12
    v_xor_b32 v15, 96, v12
    v_xor_b32 v16, 128, v12
    v_xor_b32 v17, 160, v12
    v_xor_b32 v18, 192, v12
    v_xor_b32 v19, 224, v12
    v_add_u32 v20, 65536, v12
    v_add_u32 v21, 65536, v13
    v_add_u32 v22, 65536, v14
    v_add_u32 v23, 65536, v15
    v_add_u32 v24, 65536, v16
    v_add_u32 v25, 65536, v17
    v_add_u32 v26, 65536, v18
    v_add_u32 v27, 65536, v19
    v_add_u32 v28, 131072, v12
    v_add_u32 v29, 131072, v13
    v_add_u32 v30, 131072, v14
    v_add_u32 v31, 131072, v15
    v_add_u32 v32, 131072, v16
    v_add_u32 v33, 131072, v17
    v_add_u32 v34, 131072, v18
    v_add_u32 v35, 131072, v19
    v_mov_b32 v52, 0x3f803f80
    v_mov_b32 v53, 0x3f803f80
    v_mov_b32 v54, 0x3f803f80
    v_mov_b32 v55, 0x3f803f80
    v_and_b32 v5, 1, v1
    v_mul_u32_u24 v5, 0xaaaa, v5
    v_add_u32 v5, 0x4444, v5
    v_lshl_add_u32 v50, v5, 16, v5
    v_lshrrev_b32 v5, 1, v3
    v_mul_u32_u24 v5, 20608, v5
    v_lshl_add_u32 v5, v2, 5, v5
    v_and_b32 v6, 1, v3
    v_lshl_add_u32 v56, v6, 4, v5
    s_mul_i32 s47, s6, 329728
    s_mov_b32 s32, s82
    s_mov_b32 s33, s83
    s_mov_b32 s34, 5308416
    s_mov_b32 s35, 0x20000
    s_mov_b32 s82, 5308416
    s_mov_b32 s83, 0x20000
    s_mov_b32 s86, 5308416
    s_mov_b32 s87, 0x20000
    s_lshr_b32 s7, s2, 3
    s_mul_i32 s7, s7, 18
    s_add_u32 s7, s7, s3
    s_and_b32 s36, s2, 7
    s_mul_i32 s37, s36, 576
    s_add_u32 s37, s37, s7
    s_mul_i32 s37, s37, 1152
    s_mul_i32 s7, s7, 9216
    s_mul_i32 s36, s36, 1152
    s_add_u32 s7, s7, s36
    v_min_u32 v5, 17, v1
    v_lshl_add_u32 v57, v5, 6, s7
    v_lshl_add_u32 v62, v5, 6, s37
    s_mov_b32 s40, 0
    s_mov_b32 s41, 0
    s_mov_b32 s48, 0
    s_waitcnt vmcnt(9)
    v_lshlrev_b32 v80, 16, v80
    s_waitcnt vmcnt(8)
    v_lshlrev_b32 v81, 16, v81
    s_waitcnt vmcnt(7)
    v_lshlrev_b32 v82, 16, v82
    s_waitcnt vmcnt(6)
    v_lshlrev_b32 v83, 16, v83
    s_waitcnt vmcnt(5)
    v_lshlrev_b32 v84, 16, v84
    v_mul_f32 v144, 0xbfb8aa3b, v80
    v_mul_f32 v148, 0xbfb8aa3b, v81
    v_mul_f32 v152, 0xbfb8aa3b, v82
    v_mul_f32 v156, 0xbfb8aa3b, v83
    v_mul_f32 v160, 0xbfb8aa3b, v84
    v_min_f32 v144, 0x42fc0000, v144
    v_min_f32 v148, 0x42fc0000, v148
    v_min_f32 v152, 0x42fc0000, v152
    v_min_f32 v156, 0x42fc0000, v156
    v_min_f32 v160, 0x42fc0000, v160
    v_exp_f32 v144, v144
    v_exp_f32 v148, v148
    v_exp_f32 v152, v152
    v_exp_f32 v156, v156
    v_exp_f32 v160, v160
    v_add_f32 v144, 1.0, v144
    v_add_f32 v148, 1.0, v148
    v_add_f32 v152, 1.0, v152
    v_add_f32 v156, 1.0, v156
    v_add_f32 v160, 1.0, v160
    v_rcp_f32 v145, v144
    v_rcp_f32 v149, v148
    v_rcp_f32 v153, v152
    v_rcp_f32 v157, v156
    v_rcp_f32 v161, v160
    v_mul_f32 v146, v80, v145
    v_mul_f32 v150, v81, v149
    v_mul_f32 v154, v82, v153
    v_mul_f32 v158, v83, v157
    v_mul_f32 v162, v84, v161
    v_fma_f32 v144, -v146, v144, v80
    v_fma_f32 v148, -v150, v148, v81
    v_fma_f32 v152, -v154, v152, v82
    v_fma_f32 v156, -v158, v156, v83
    v_fma_f32 v160, -v162, v160, v84
    v_fma_f32 v80, v144, v145, v146
    v_fma_f32 v81, v148, v149, v150
    v_fma_f32 v82, v152, v153, v154
    v_fma_f32 v83, v156, v157, v158
    v_fma_f32 v84, v160, v161, v162
    v_cvt_pk_bf16_f32 v80, v80, v80
    v_cvt_pk_bf16_f32 v81, v81, v81
    v_cvt_pk_bf16_f32 v82, v82, v82
    v_cvt_pk_bf16_f32 v83, v83, v83
    v_cvt_pk_bf16_f32 v84, v84, v84
    v_and_b32 v80, 0xffff0000, v80
    v_and_b32 v81, 0xffff0000, v81
    v_and_b32 v82, 0xffff0000, v82
    v_and_b32 v83, 0xffff0000, v83
    v_and_b32 v84, 0xffff0000, v84
    buffer_load_dwordx2 v[108:109], v66, s[20:23], s49 offen offset:0
    buffer_load_dwordx2 v[110:111], v66, s[20:23], s49 offen offset:32
    buffer_load_dwordx2 v[112:113], v66, s[20:23], s49 offen offset:384
    buffer_load_dwordx2 v[114:115], v66, s[20:23], s49 offen offset:416
    buffer_load_dwordx2 v[116:117], v66, s[20:23], s49 offen offset:768
    buffer_load_dwordx2 v[118:119], v66, s[20:23], s49 offen offset:800
    s_mov_b32 s20, s58
    s_mov_b32 s21, s59
    s_mov_b32 s22, 4718592
    s_mov_b32 s23, 0x20000
    s_waitcnt vmcnt(10)
    v_lshlrev_b32 v136, 16, v88
    v_and_b32 v137, 0xffff0000, v88
    v_lshlrev_b32 v138, 16, v89
    v_and_b32 v139, 0xffff0000, v89
    v_lshlrev_b32 v140, 16, v90
    v_and_b32 v141, 0xffff0000, v90
    v_lshlrev_b32 v142, 16, v91
    v_and_b32 v143, 0xffff0000, v91
    v_pk_mul_f32 v[128:129], v[136:137], v[80:81] op_sel:[0,0] op_sel_hi:[1,0]
    v_pk_mul_f32 v[130:131], v[138:139], v[80:81] op_sel:[0,0] op_sel_hi:[1,0]
    v_pk_mul_f32 v[132:133], v[140:141], v[80:81] op_sel:[0,0] op_sel_hi:[1,0]
    v_pk_mul_f32 v[134:135], v[142:143], v[80:81] op_sel:[0,0] op_sel_hi:[1,0]
    s_waitcnt vmcnt(9)
    v_lshlrev_b32 v136, 16, v92
    v_and_b32 v137, 0xffff0000, v92
    v_lshlrev_b32 v138, 16, v93
    v_and_b32 v139, 0xffff0000, v93
    v_lshlrev_b32 v140, 16, v94
    v_and_b32 v141, 0xffff0000, v94
    v_lshlrev_b32 v142, 16, v95
    v_and_b32 v143, 0xffff0000, v95
    v_pk_fma_f32 v[128:129], v[136:137], v[80:81], v[128:129] op_sel:[0,1,0] op_sel_hi:[1,1,1]
    v_pk_fma_f32 v[130:131], v[138:139], v[80:81], v[130:131] op_sel:[0,1,0] op_sel_hi:[1,1,1]
    v_pk_fma_f32 v[132:133], v[140:141], v[80:81], v[132:133] op_sel:[0,1,0] op_sel_hi:[1,1,1]
    v_pk_fma_f32 v[134:135], v[142:143], v[80:81], v[134:135] op_sel:[0,1,0] op_sel_hi:[1,1,1]
    s_waitcnt vmcnt(8)
    v_lshlrev_b32 v136, 16, v96
    v_and_b32 v137, 0xffff0000, v96
    v_lshlrev_b32 v138, 16, v97
    v_and_b32 v139, 0xffff0000, v97
    v_lshlrev_b32 v140, 16, v98
    v_and_b32 v141, 0xffff0000, v98
    v_lshlrev_b32 v142, 16, v99
    v_and_b32 v143, 0xffff0000, v99
    v_pk_fma_f32 v[128:129], v[136:137], v[82:83], v[128:129] op_sel:[0,0,0] op_sel_hi:[1,0,1]
    v_pk_fma_f32 v[130:131], v[138:139], v[82:83], v[130:131] op_sel:[0,0,0] op_sel_hi:[1,0,1]
    v_pk_fma_f32 v[132:133], v[140:141], v[82:83], v[132:133] op_sel:[0,0,0] op_sel_hi:[1,0,1]
    v_pk_fma_f32 v[134:135], v[142:143], v[82:83], v[134:135] op_sel:[0,0,0] op_sel_hi:[1,0,1]
    s_waitcnt vmcnt(7)
    v_lshlrev_b32 v136, 16, v100
    v_and_b32 v137, 0xffff0000, v100
    v_lshlrev_b32 v138, 16, v101
    v_and_b32 v139, 0xffff0000, v101
    v_lshlrev_b32 v140, 16, v102
    v_and_b32 v141, 0xffff0000, v102
    v_lshlrev_b32 v142, 16, v103
    v_and_b32 v143, 0xffff0000, v103
    v_pk_fma_f32 v[128:129], v[136:137], v[82:83], v[128:129] op_sel:[0,1,0] op_sel_hi:[1,1,1]
    v_pk_fma_f32 v[130:131], v[138:139], v[82:83], v[130:131] op_sel:[0,1,0] op_sel_hi:[1,1,1]
    v_pk_fma_f32 v[132:133], v[140:141], v[82:83], v[132:133] op_sel:[0,1,0] op_sel_hi:[1,1,1]
    v_pk_fma_f32 v[134:135], v[142:143], v[82:83], v[134:135] op_sel:[0,1,0] op_sel_hi:[1,1,1]
    s_waitcnt vmcnt(6)
    v_lshlrev_b32 v136, 16, v104
    v_and_b32 v137, 0xffff0000, v104
    v_lshlrev_b32 v138, 16, v105
    v_and_b32 v139, 0xffff0000, v105
    v_lshlrev_b32 v140, 16, v106
    v_and_b32 v141, 0xffff0000, v106
    v_lshlrev_b32 v142, 16, v107
    v_and_b32 v143, 0xffff0000, v107
    v_pk_fma_f32 v[128:129], v[136:137], v[84:85], v[128:129] op_sel:[0,0,0] op_sel_hi:[1,0,1]
    v_pk_fma_f32 v[130:131], v[138:139], v[84:85], v[130:131] op_sel:[0,0,0] op_sel_hi:[1,0,1]
    v_pk_fma_f32 v[132:133], v[140:141], v[84:85], v[132:133] op_sel:[0,0,0] op_sel_hi:[1,0,1]
    v_pk_fma_f32 v[134:135], v[142:143], v[84:85], v[134:135] op_sel:[0,0,0] op_sel_hi:[1,0,1]
    s_nop 0
    v_permlane32_swap_b32 v128, v132
    v_permlane32_swap_b32 v129, v133
    v_permlane32_swap_b32 v130, v134
    v_permlane32_swap_b32 v131, v135
    v_and_b32 v72, 1, v1
    v_pk_add_f32 v[128:129], v[128:129], v[132:133]
    v_pk_add_f32 v[130:131], v[130:131], v[134:135]
    v_lshlrev_b32 v72, 5, v72
    v_lshrrev_b32 v73, 4, v1
    v_permlane16_swap_b32 v128, v130
    v_permlane16_swap_b32 v129, v131
    v_lshl_add_u32 v72, v73, 3, v72
    v_pk_add_f32 v[128:129], v[128:129], v[130:131]
    s_lshl_b32 s36, s3, 6
    v_add_u32 v72, s36, v72
    v_add_f32_dpp v128, v128, v128 row_ror:2 row_mask:0xf bank_mask:0xf
    v_add_f32_dpp v129, v129, v129 row_ror:2 row_mask:0xf bank_mask:0xf
    s_nop 0
    v_add_f32_dpp v128, v128, v128 row_ror:4 row_mask:0xf bank_mask:0xf
    v_add_f32_dpp v129, v129, v129 row_ror:4 row_mask:0xf bank_mask:0xf
    s_nop 0
    v_add_f32_dpp v128, v128, v128 row_ror:8 row_mask:0xf bank_mask:0xf
    v_add_f32_dpp v129, v129, v129 row_ror:8 row_mask:0xf bank_mask:0xf
    ds_write_b64 v72, v[128:129] offset:0
    v_and_b32 v73, 7, v1
    v_lshlrev_b32 v73, 3, v73
    s_waitcnt lgkmcnt(0)
    s_barrier
    ds_read_b64 v[128:129], v73 offset:0
    ds_read_b64 v[130:131], v73 offset:64
    ds_read_b64 v[132:133], v73 offset:128
    ds_read_b64 v[134:135], v73 offset:192
    s_add_u32 s95, s94, 0x9e3779b9
    v_mov_b32 v137, s95
    s_mov_b32 s37, 32768
    s_waitcnt lgkmcnt(2)
    v_pk_add_f32 v[128:129], v[128:129], v[130:131]
    s_waitcnt lgkmcnt(0)
    v_pk_add_f32 v[132:133], v[132:133], v[134:135]
    v_pk_add_f32 v[128:129], v[128:129], v[132:133]
    v_cvt_pk_bf16_f32 v136, v128, v129
    v_lshlrev_b32 v128, 16, v136
    v_and_b32 v129, 0xffff0000, v136
    v_add_f32 v128, s93, v128
    v_add_f32 v129, s93, v129
    v_cvt_pk_bf16_f32 v136, v128, v129
    buffer_store_dwordx2 v[136:137], v69, s[24:27], s37 offen sc1
    s_mul_i32 s36, s3, 72
    v_add_u32 v122, s36, v1
    v_and_b32 v123, 7, v1
    s_add_u32 s36, s36, 64
    v_add_u32 v123, s36, v123
    s_movk_i32 s36, 1024
    v_and_b32 v76, 3, v122
    v_lshlrev_b32 v76, 4, v76
    v_lshrrev_b32 v122, 2, v122
    v_lshl_add_u32 v124, v122, 7, v76
    v_and_b32 v77, 1, v122
    v_lshl_add_u32 v76, v77, 3, v76
    v_lshrrev_b32 v122, 1, v122
    v_lshl_add_u32 v122, v122, 6, v76
    v_add_u32 v122, s36, v122
    v_and_b32 v76, 3, v123
    v_lshlrev_b32 v76, 4, v76
    v_lshrrev_b32 v123, 2, v123
    v_lshl_add_u32 v125, v123, 7, v76
    v_and_b32 v77, 1, v123
    v_lshl_add_u32 v76, v77, 3, v76
    v_lshrrev_b32 v123, 1, v123
    v_lshl_add_u32 v123, v123, 6, v76
    v_add_u32 v123, s36, v123
    s_mov_b64 exec, 0
    s_cmp_eq_u32 s3, 0
    s_cbranch_scc1 Ltour0_0
    s_cmp_eq_u32 s3, 1
    s_cbranch_scc1 Ltour0_1
    s_cmp_eq_u32 s3, 2
    s_cbranch_scc1 Ltour0_2
    s_branch Ltour0_3
.p2align 12
Lmain0:
    s_mov_b64 exec, -1
    s_waitcnt vmcnt(6)
    v_lshlrev_b32 v144, 16, v108
    v_and_b32 v145, 0xffff0000, v108
    v_lshlrev_b32 v146, 16, v109
    v_and_b32 v147, 0xffff0000, v109
    s_waitcnt vmcnt(5)
    v_lshlrev_b32 v148, 16, v110
    v_and_b32 v149, 0xffff0000, v110
    v_lshlrev_b32 v150, 16, v111
    v_and_b32 v151, 0xffff0000, v111
    s_waitcnt vmcnt(4)
    v_lshlrev_b32 v152, 16, v112
    v_and_b32 v153, 0xffff0000, v112
    v_lshlrev_b32 v154, 16, v113
    v_and_b32 v155, 0xffff0000, v113
    s_waitcnt vmcnt(3)
    v_lshlrev_b32 v156, 16, v114
    v_and_b32 v157, 0xffff0000, v114
    v_lshlrev_b32 v158, 16, v115
    v_and_b32 v159, 0xffff0000, v115
    s_waitcnt vmcnt(2)
    v_lshlrev_b32 v160, 16, v116
    v_and_b32 v161, 0xffff0000, v116
    v_lshlrev_b32 v162, 16, v117
    v_and_b32 v163, 0xffff0000, v117
    s_waitcnt vmcnt(1)
    v_lshlrev_b32 v164, 16, v118
    v_and_b32 v165, 0xffff0000, v118
    v_lshlrev_b32 v166, 16, v119
    v_and_b32 v167, 0xffff0000, v119
    buffer_load_dwordx4 v[88:91], v124, s[24:27], s37 offen sc1
    buffer_load_dwordx4 v[92:95], v125, s[24:27], s37 offen sc1
    buffer_load_dword v242, v71, s[16:19], s44 offen
    v_pk_add_f32 v[72:73], v[144:145], v[148:149]
    v_pk_add_f32 v[76:77], v[146:147], v[150:151]
    v_pk_add_f32 v[72:73], v[72:73], v[152:153]
    v_pk_add_f32 v[76:77], v[76:77], v[154:155]
    v_pk_add_f32 v[72:73], v[72:73], v[156:157]
    v_pk_add_f32 v[76:77], v[76:77], v[158:159]
    v_pk_add_f32 v[72:73], v[72:73], v[160:161]
    v_pk_add_f32 v[76:77], v[76:77], v[162:163]
    v_pk_add_f32 v[72:73], v[72:73], v[164:165]
    v_pk_add_f32 v[76:77], v[76:77], v[166:167]
    v_pk_add_f32 v[72:73], v[72:73], v[76:77]
    v_add_f32 v72, v72, v73
    s_nop 1
    v_add_f32_dpp v72, v72, v72 row_ror:8 row_mask:0xf bank_mask:0xf
    s_nop 1
    v_add_f32_dpp v72, v72, v72 row_ror:4 row_mask:0xf bank_mask:0xf
    s_nop 1
    v_add_f32_dpp v72, v72, v72 row_ror:2 row_mask:0xf bank_mask:0xf
    s_nop 1
    v_add_f32_dpp v72, v72, v72 row_ror:1 row_mask:0xf bank_mask:0xf
    v_mov_b32 v76, v72
    s_nop 1
    v_permlane16_swap_b32 v72, v76
    s_nop 0
    v_add_f32 v72, v72, v76
    v_mul_f32 v72, 0x3ae38e39, v72
    v_pk_add_f32 v[168:169], v[144:145], v[72:73] op_sel_hi:[1,0] neg_lo:[0,1] neg_hi:[0,1]
    v_pk_add_f32 v[170:171], v[146:147], v[72:73] op_sel_hi:[1,0] neg_lo:[0,1] neg_hi:[0,1]
    v_pk_add_f32 v[172:173], v[148:149], v[72:73] op_sel_hi:[1,0] neg_lo:[0,1] neg_hi:[0,1]
    v_pk_add_f32 v[174:175], v[150:151], v[72:73] op_sel_hi:[1,0] neg_lo:[0,1] neg_hi:[0,1]
    v_pk_add_f32 v[176:177], v[152:153], v[72:73] op_sel_hi:[1,0] neg_lo:[0,1] neg_hi:[0,1]
    v_pk_add_f32 v[178:179], v[154:155], v[72:73] op_sel_hi:[1,0] neg_lo:[0,1] neg_hi:[0,1]
    v_pk_add_f32 v[180:181], v[156:157], v[72:73] op_sel_hi:[1,0] neg_lo:[0,1] neg_hi:[0,1]
    v_pk_add_f32 v[182:183], v[158:159], v[72:73] op_sel_hi:[1,0] neg_lo:[0,1] neg_hi:[0,1]
    v_pk_add_f32 v[184:185], v[160:161], v[72:73] op_sel_hi:[1,0] neg_lo:[0,1] neg_hi:[0,1]
    v_pk_add_f32 v[186:187], v[162:163], v[72:73] op_sel_hi:[1,0] neg_lo:[0,1] neg_hi:[0,1]
    v_pk_add_f32 v[188:189], v[164:165], v[72:73] op_sel_hi:[1,0] neg_lo:[0,1] neg_hi:[0,1]
    v_pk_add_f32 v[190:191], v[166:167], v[72:73] op_sel_hi:[1,0] neg_lo:[0,1] neg_hi:[0,1]
    v_pk_mul_f32 v[74:75], v[168:169], v[168:169]
    v_pk_mul_f32 v[76:77], v[170:171], v[170:171]
    v_pk_fma_f32 v[74:75], v[172:173], v[172:173], v[74:75]
    v_pk_fma_f32 v[76:77], v[174:175], v[174:175], v[76:77]
    v_pk_fma_f32 v[74:75], v[176:177], v[176:177], v[74:75]
    v_pk_fma_f32 v[76:77], v[178:179], v[178:179], v[76:77]
    v_pk_fma_f32 v[74:75], v[180:181], v[180:181], v[74:75]
    v_pk_fma_f32 v[76:77], v[182:183], v[182:183], v[76:77]
    v_pk_fma_f32 v[74:75], v[184:185], v[184:185], v[74:75]
    v_pk_fma_f32 v[76:77], v[186:187], v[186:187], v[76:77]
    v_pk_fma_f32 v[74:75], v[188:189], v[188:189], v[74:75]
    v_pk_fma_f32 v[76:77], v[190:191], v[190:191], v[76:77]
    v_pk_add_f32 v[74:75], v[74:75], v[76:77]
    v_add_f32 v74, v74, v75
    v_cndmask_b32 v74, 0, v74, vcc
    s_nop 1
    v_add_f32_dpp v74, v74, v74 row_ror:8 row_mask:0xf bank_mask:0xf
    s_nop 1
    v_add_f32_dpp v74, v74, v74 row_ror:4 row_mask:0xf bank_mask:0xf
    s_nop 1
    v_add_f32_dpp v74, v74, v74 row_ror:2 row_mask:0xf bank_mask:0xf
    s_nop 1
    v_add_f32_dpp v74, v74, v74 row_ror:1 row_mask:0xf bank_mask:0xf
    v_mov_b32 v76, v74
    s_nop 1
    v_permlane16_swap_b32 v74, v76
    s_nop 0
    v_add_f32 v74, v74, v76
    v_mul_f32 v74, 0x3ae38e39, v74
    v_cvt_pk_bf16_f32 v76, v72, v74
    v_and_b32 v74, 0xffff0000, v76
    v_lshlrev_b32 v72, 16, v76
    v_add_f32 v74, 0x3727c5ac, v74
    v_cvt_pk_bf16_f32 v74, v74, v74
    v_and_b32 v74, 0xffff0000, v74
    v_sqrt_f32 v74, v74
    v_pk_add_f32 v[168:169], v[144:145], v[72:73] op_sel_hi:[1,0] neg_lo:[0,1] neg_hi:[0,1]
    v_pk_add_f32 v[170:171], v[146:147], v[72:73] op_sel_hi:[1,0] neg_lo:[0,1] neg_hi:[0,1]
    v_pk_add_f32 v[172:173], v[148:149], v[72:73] op_sel_hi:[1,0] neg_lo:[0,1] neg_hi:[0,1]
    v_pk_add_f32 v[174:175], v[150:151], v[72:73] op_sel_hi:[1,0] neg_lo:[0,1] neg_hi:[0,1]
    v_pk_add_f32 v[176:177], v[152:153], v[72:73] op_sel_hi:[1,0] neg_lo:[0,1] neg_hi:[0,1]
    v_pk_add_f32 v[178:179], v[154:155], v[72:73] op_sel_hi:[1,0] neg_lo:[0,1] neg_hi:[0,1]
    v_pk_add_f32 v[180:181], v[156:157], v[72:73] op_sel_hi:[1,0] neg_lo:[0,1] neg_hi:[0,1]
    v_pk_add_f32 v[182:183], v[158:159], v[72:73] op_sel_hi:[1,0] neg_lo:[0,1] neg_hi:[0,1]
    v_pk_add_f32 v[184:185], v[160:161], v[72:73] op_sel_hi:[1,0] neg_lo:[0,1] neg_hi:[0,1]
    v_pk_add_f32 v[186:187], v[162:163], v[72:73] op_sel_hi:[1,0] neg_lo:[0,1] neg_hi:[0,1]
    v_pk_add_f32 v[188:189], v[164:165], v[72:73] op_sel_hi:[1,0] neg_lo:[0,1] neg_hi:[0,1]
    v_pk_add_f32 v[190:191], v[166:167], v[72:73] op_sel_hi:[1,0] neg_lo:[0,1] neg_hi:[0,1]
    v_cvt_pk_bf16_f32 v74, v74, v74
    v_and_b32 v74, 0xffff0000, v74
    v_rcp_f32 v74, v74
    v_cvt_pk_bf16_f32 v108, v168, v169
    v_cvt_pk_bf16_f32 v109, v170, v171
    v_cvt_pk_bf16_f32 v110, v172, v173
    v_cvt_pk_bf16_f32 v111, v174, v175
    v_cvt_pk_bf16_f32 v112, v176, v177
    v_cvt_pk_bf16_f32 v113, v178, v179
    v_cvt_pk_bf16_f32 v114, v180, v181
    v_cvt_pk_bf16_f32 v115, v182, v183
    v_cvt_pk_bf16_f32 v116, v184, v185
    v_cvt_pk_bf16_f32 v117, v186, v187
    v_cvt_pk_bf16_f32 v118, v188, v189
    v_cvt_pk_bf16_f32 v119, v190, v191
    v_lshlrev_b32 v168, 16, v108
    v_and_b32 v169, 0xffff0000, v108
    v_lshlrev_b32 v170, 16, v109
    v_and_b32 v171, 0xffff0000, v109
    v_lshlrev_b32 v172, 16, v110
    v_and_b32 v173, 0xffff0000, v110
    v_lshlrev_b32 v174, 16, v111
    v_and_b32 v175, 0xffff0000, v111
    v_lshlrev_b32 v176, 16, v112
    v_and_b32 v177, 0xffff0000, v112
    v_lshlrev_b32 v178, 16, v113
    v_and_b32 v179, 0xffff0000, v113
    v_lshlrev_b32 v180, 16, v114
    v_and_b32 v181, 0xffff0000, v114
    v_lshlrev_b32 v182, 16, v115
    v_and_b32 v183, 0xffff0000, v115
    v_lshlrev_b32 v184, 16, v116
    v_and_b32 v185, 0xffff0000, v116
    v_lshlrev_b32 v186, 16, v117
    v_and_b32 v187, 0xffff0000, v117
    v_lshlrev_b32 v188, 16, v118
    v_and_b32 v189, 0xffff0000, v118
    v_lshlrev_b32 v190, 16, v119
    v_and_b32 v191, 0xffff0000, v119
    v_pk_mul_f32 v[168:169], v[168:169], v[74:75] op_sel_hi:[1,0]
    v_pk_mul_f32 v[170:171], v[170:171], v[74:75] op_sel_hi:[1,0]
    v_pk_mul_f32 v[172:173], v[172:173], v[74:75] op_sel_hi:[1,0]
    v_pk_mul_f32 v[174:175], v[174:175], v[74:75] op_sel_hi:[1,0]
    v_pk_mul_f32 v[176:177], v[176:177], v[74:75] op_sel_hi:[1,0]
    v_pk_mul_f32 v[178:179], v[178:179], v[74:75] op_sel_hi:[1,0]
    v_pk_mul_f32 v[180:181], v[180:181], v[74:75] op_sel_hi:[1,0]
    v_pk_mul_f32 v[182:183], v[182:183], v[74:75] op_sel_hi:[1,0]
    v_pk_mul_f32 v[184:185], v[184:185], v[74:75] op_sel_hi:[1,0]
    v_pk_mul_f32 v[186:187], v[186:187], v[74:75] op_sel_hi:[1,0]
    v_pk_mul_f32 v[188:189], v[188:189], v[74:75] op_sel_hi:[1,0]
    v_pk_mul_f32 v[190:191], v[190:191], v[74:75] op_sel_hi:[1,0]
    v_cvt_pk_bf16_f32 v108, v168, v169
    v_cvt_pk_bf16_f32 v109, v170, v171
    v_cvt_pk_bf16_f32 v110, v172, v173
    v_cvt_pk_bf16_f32 v111, v174, v175
    v_cvt_pk_bf16_f32 v112, v176, v177
    v_cvt_pk_bf16_f32 v113, v178, v179
    v_cvt_pk_bf16_f32 v114, v180, v181
    v_cvt_pk_bf16_f32 v115, v182, v183
    v_cvt_pk_bf16_f32 v116, v184, v185
    v_cvt_pk_bf16_f32 v117, v186, v187
    v_cvt_pk_bf16_f32 v118, v188, v189
    v_cvt_pk_bf16_f32 v119, v190, v191
    v_lshlrev_b32 v168, 16, v108
    v_and_b32 v169, 0xffff0000, v108
    v_lshlrev_b32 v170, 16, v109
    v_and_b32 v171, 0xffff0000, v109
    v_lshlrev_b32 v172, 16, v110
    v_and_b32 v173, 0xffff0000, v110
    v_lshlrev_b32 v174, 16, v111
    v_and_b32 v175, 0xffff0000, v111
    v_lshlrev_b32 v176, 16, v112
    v_and_b32 v177, 0xffff0000, v112
    v_lshlrev_b32 v178, 16, v113
    v_and_b32 v179, 0xffff0000, v113
    v_lshlrev_b32 v180, 16, v114
    v_and_b32 v181, 0xffff0000, v114
    v_lshlrev_b32 v182, 16, v115
    v_and_b32 v183, 0xffff0000, v115
    v_lshlrev_b32 v184, 16, v116
    v_and_b32 v185, 0xffff0000, v116
    v_lshlrev_b32 v186, 16, v117
    v_and_b32 v187, 0xffff0000, v117
    v_lshlrev_b32 v188, 16, v118
    v_and_b32 v189, 0xffff0000, v118
    v_lshlrev_b32 v190, 16, v119
    v_and_b32 v191, 0xffff0000, v119
    s_mov_b32 s38, 262144
    s_waitcnt vmcnt(2)
    v_xor_b32 v89, s95, v89
    v_xor_b32 v91, s95, v91
    s_waitcnt vmcnt(1)
    v_xor_b32 v93, s95, v93
    v_xor_b32 v95, s95, v95
    v_or3_b32 v89, v89, v91, v93
    v_or_b32 v89, v89, v95
    v_cmp_ne_u32 vcc, 0, v89
    s_cbranch_vccz Lhead_gotm
Lhead_pollm:
    buffer_load_dwordx4 v[88:91], v124, s[24:27], s37 offen sc1
    buffer_load_dwordx4 v[92:95], v125, s[24:27], s37 offen sc1
    s_waitcnt vmcnt(0)
    s_sub_u32 s38, s38, 1
    s_cbranch_scc1 Lhead_gotm
    v_xor_b32 v89, s95, v89
    v_xor_b32 v91, s95, v91
    v_xor_b32 v93, s95, v93
    v_xor_b32 v95, s95, v95
    v_or3_b32 v89, v89, v91, v93
    v_or_b32 v89, v89, v95
    v_cmp_ne_u32 vcc, 0, v89
    s_cbranch_vccnz Lhead_pollm
Lhead_gotm:
    ds_write2_b32 v122, v88, v90 offset0:0 offset1:1
    ds_write2_b32 v123, v92, v94 offset0:0 offset1:1
    s_waitcnt lgkmcnt(0)
    s_barrier
    ds_read_b128 v[144:147], v68 offset:2176
    ds_read_b128 v[156:159], v68 offset:1024
    ds_read_b128 v[148:151], v68 offset:2560
    ds_read_b128 v[160:163], v68 offset:1408
    ds_read_b128 v[152:155], v68 offset:2944
    ds_read_b128 v[164:167], v68 offset:1792
    s_waitcnt lgkmcnt(5)
    v_lshlrev_b32 v192, 16, v144
    v_and_b32 v193, 0xffff0000, v144
    v_lshlrev_b32 v194, 16, v145
    v_and_b32 v195, 0xffff0000, v145
    v_lshlrev_b32 v196, 16, v146
    v_and_b32 v197, 0xffff0000, v146
    v_lshlrev_b32 v198, 16, v147
    v_and_b32 v199, 0xffff0000, v147
    v_pk_mul_f32 v[168:169], v[168:169], v[192:193]
    v_pk_mul_f32 v[170:171], v[170:171], v[194:195]
    v_pk_mul_f32 v[172:173], v[172:173], v[196:197]
    v_pk_mul_f32 v[174:175], v[174:175], v[198:199]
    v_cvt_pk_bf16_f32 v108, v168, v169
    v_cvt_pk_bf16_f32 v109, v170, v171
    v_cvt_pk_bf16_f32 v110, v172, v173
    v_cvt_pk_bf16_f32 v111, v174, v175
    s_waitcnt lgkmcnt(4)
    v_lshlrev_b32 v216, 16, v156
    v_and_b32 v217, 0xffff0000, v156
    v_lshlrev_b32 v218, 16, v157
    v_and_b32 v219, 0xffff0000, v157
    v_lshlrev_b32 v220, 16, v158
    v_and_b32 v221, 0xffff0000, v158
    v_lshlrev_b32 v222, 16, v159
    v_and_b32 v223, 0xffff0000, v159
    v_lshlrev_b32 v168, 16, v108
    v_and_b32 v169, 0xffff0000, v108
    v_lshlrev_b32 v170, 16, v109
    v_and_b32 v171, 0xffff0000, v109
    v_lshlrev_b32 v172, 16, v110
    v_and_b32 v173, 0xffff0000, v110
    v_lshlrev_b32 v174, 16, v111
    v_and_b32 v175, 0xffff0000, v111
    v_pk_add_f32 v[168:169], v[168:169], v[216:217]
    v_pk_add_f32 v[170:171], v[170:171], v[218:219]
    v_pk_add_f32 v[172:173], v[172:173], v[220:221]
    v_pk_add_f32 v[174:175], v[174:175], v[222:223]
    v_cvt_pk_bf16_f32 v108, v168, v169
    v_cvt_pk_bf16_f32 v109, v170, v171
    v_cvt_pk_bf16_f32 v110, v172, v173
    v_cvt_pk_bf16_f32 v111, v174, v175
    buffer_store_dwordx4 v[108:111], v67, s[24:27], s92 offen offset:0 sc1
    s_waitcnt lgkmcnt(3)
    v_lshlrev_b32 v200, 16, v148
    v_and_b32 v201, 0xffff0000, v148
    v_lshlrev_b32 v202, 16, v149
    v_and_b32 v203, 0xffff0000, v149
    v_lshlrev_b32 v204, 16, v150
    v_and_b32 v205, 0xffff0000, v150
    v_lshlrev_b32 v206, 16, v151
    v_and_b32 v207, 0xffff0000, v151
    v_pk_mul_f32 v[176:177], v[176:177], v[200:201]
    v_pk_mul_f32 v[178:179], v[178:179], v[202:203]
    v_pk_mul_f32 v[180:181], v[180:181], v[204:205]
    v_pk_mul_f32 v[182:183], v[182:183], v[206:207]
    v_cvt_pk_bf16_f32 v112, v176, v177
    v_cvt_pk_bf16_f32 v113, v178, v179
    v_cvt_pk_bf16_f32 v114, v180, v181
    v_cvt_pk_bf16_f32 v115, v182, v183
    s_waitcnt lgkmcnt(2)
    v_lshlrev_b32 v224, 16, v160
    v_and_b32 v225, 0xffff0000, v160
    v_lshlrev_b32 v226, 16, v161
    v_and_b32 v227, 0xffff0000, v161
    v_lshlrev_b32 v228, 16, v162
    v_and_b32 v229, 0xffff0000, v162
    v_lshlrev_b32 v230, 16, v163
    v_and_b32 v231, 0xffff0000, v163
    v_lshlrev_b32 v176, 16, v112
    v_and_b32 v177, 0xffff0000, v112
    v_lshlrev_b32 v178, 16, v113
    v_and_b32 v179, 0xffff0000, v113
    v_lshlrev_b32 v180, 16, v114
    v_and_b32 v181, 0xffff0000, v114
    v_lshlrev_b32 v182, 16, v115
    v_and_b32 v183, 0xffff0000, v115
    v_pk_add_f32 v[176:177], v[176:177], v[224:225]
    v_pk_add_f32 v[178:179], v[178:179], v[226:227]
    v_pk_add_f32 v[180:181], v[180:181], v[228:229]
    v_pk_add_f32 v[182:183], v[182:183], v[230:231]
    v_cvt_pk_bf16_f32 v112, v176, v177
    v_cvt_pk_bf16_f32 v113, v178, v179
    v_cvt_pk_bf16_f32 v114, v180, v181
    v_cvt_pk_bf16_f32 v115, v182, v183
    buffer_store_dwordx4 v[112:115], v67, s[24:27], s92 offen offset:768 sc1
    s_waitcnt lgkmcnt(1)
    v_lshlrev_b32 v208, 16, v152
    v_and_b32 v209, 0xffff0000, v152
    v_lshlrev_b32 v210, 16, v153
    v_and_b32 v211, 0xffff0000, v153
    v_lshlrev_b32 v212, 16, v154
    v_and_b32 v213, 0xffff0000, v154
    v_lshlrev_b32 v214, 16, v155
    v_and_b32 v215, 0xffff0000, v155
    v_pk_mul_f32 v[184:185], v[184:185], v[208:209]
    v_pk_mul_f32 v[186:187], v[186:187], v[210:211]
    v_pk_mul_f32 v[188:189], v[188:189], v[212:213]
    v_pk_mul_f32 v[190:191], v[190:191], v[214:215]
    v_cvt_pk_bf16_f32 v116, v184, v185
    v_cvt_pk_bf16_f32 v117, v186, v187
    v_cvt_pk_bf16_f32 v118, v188, v189
    v_cvt_pk_bf16_f32 v119, v190, v191
    s_waitcnt lgkmcnt(0)
    v_lshlrev_b32 v232, 16, v164
    v_and_b32 v233, 0xffff0000, v164
    v_lshlrev_b32 v234, 16, v165
    v_and_b32 v235, 0xffff0000, v165
    v_lshlrev_b32 v236, 16, v166
    v_and_b32 v237, 0xffff0000, v166
    v_lshlrev_b32 v238, 16, v167
    v_and_b32 v239, 0xffff0000, v167
    v_lshlrev_b32 v184, 16, v116
    v_and_b32 v185, 0xffff0000, v116
    v_lshlrev_b32 v186, 16, v117
    v_and_b32 v187, 0xffff0000, v117
    v_lshlrev_b32 v188, 16, v118
    v_and_b32 v189, 0xffff0000, v118
    v_lshlrev_b32 v190, 16, v119
    v_and_b32 v191, 0xffff0000, v119
    v_pk_add_f32 v[184:185], v[184:185], v[232:233]
    v_pk_add_f32 v[186:187], v[186:187], v[234:235]
    v_pk_add_f32 v[188:189], v[188:189], v[236:237]
    v_pk_add_f32 v[190:191], v[190:191], v[238:239]
    v_cvt_pk_bf16_f32 v116, v184, v185
    v_cvt_pk_bf16_f32 v117, v186, v187
    v_cvt_pk_bf16_f32 v118, v188, v189
    v_cvt_pk_bf16_f32 v119, v190, v191
    buffer_store_dwordx4 v[116:119], v67, s[24:27], s92 offen offset:1536 sc1
    s_lshl_b32 s36, s5, 13
    s_add_u32 s36, s36, 8650752
    s_lshl_b32 s37, s4, 9
    s_add_u32 s37, s37, s36
    s_lshl_b32 s38, s3, 7
    s_add_u32 s37, s37, s38
    s_lshl_b32 s38, s3, 11
    s_add_u32 s36, s36, s38
    v_min_u32 v72, 1, v1
    v_lshlrev_b32 v72, 31, v72
    v_and_b32 v73, 15, v1
    v_lshlrev_b32 v73, 7, v73
    v_cmp_gt_u32 vcc, 162, v0
    v_mov_b32 v88, -1
    v_mov_b32 v89, -1
    v_mov_b32 v90, -1
    v_mov_b32 v91, -1
    s_mul_i32 s39, s2, 2592
    s_add_u32 s39, s39, 7864320
    v_lshl_add_u32 v74, v0, 4, s39
    s_lshl_b32 s39, s2, 7
    s_add_u32 s39, s39, 9306112
    v_mov_b32 v75, s39
    v_cndmask_b32 v74, v75, v74, vcc
    s_lshl_b32 s92, s5, 13
    s_add_u32 s92, s92, 8781824
    s_add_u32 s92, s92, s38
    s_lshl_b32 s38, s4, 7
    s_add_u32 s92, s92, s38
    s_getreg_b32 s38, hwreg(HW_REG_XCC_ID, 0, 4)
    s_lshl_b32 s38, s38, 28
    s_xor_b32 s38, s38, s95
    v_mov_b32 v76, s38
    v_mov_b32 v2, v80
    v_mov_b32 v3, v81
    v_mov_b32 v4, v82
    v_mov_b32 v5, v83
    v_mov_b32 v6, v84
    v_mov_b32 v7, v65
    v_and_b32 v126, 31, v1
    v_lshlrev_b32 v126, 2, v126
    s_add_u32 s49, s44, 0
    s_add_u32 m0, s42, 32768
    s_nop 0
    buffer_load_dwordx4 v42, s[16:19], s49 offen lds
    buffer_load_dwordx4 v43, s[16:19], s49 offen offset:1024 lds
    buffer_load_dwordx4 v44, s[16:19], s49 offen offset:2048 lds
    buffer_load_dwordx4 v45, s[16:19], s49 offen offset:3072 lds
    s_add_u32 s49, s44, 256
    s_add_u32 m0, s42, 49152
    s_nop 0
    buffer_load_dwordx4 v42, s[16:19], s49 offen lds
    buffer_load_dwordx4 v43, s[16:19], s49 offen offset:1024 lds
    buffer_load_dwordx4 v44, s[16:19], s49 offen offset:2048 lds
    buffer_load_dwordx4 v45, s[16:19], s49 offen offset:3072 lds
    s_waitcnt vmcnt(8)
    buffer_store_dword v137, v126, s[24:27], s37 offen sc1
    s_add_u32 s49, s44, 524288
    s_add_u32 m0, s42, 65536
    s_nop 0
    buffer_load_dwordx4 v42, s[16:19], s49 offen lds
    buffer_load_dwordx4 v43, s[16:19], s49 offen offset:1024 lds
    buffer_load_dwordx4 v44, s[16:19], s49 offen offset:2048 lds
    buffer_load_dwordx4 v45, s[16:19], s49 offen offset:3072 lds
    s_add_u32 s49, s44, 524544
    s_add_u32 m0, s42, 81920
    s_nop 0
    buffer_load_dwordx4 v42, s[16:19], s49 offen lds
    buffer_load_dwordx4 v43, s[16:19], s49 offen offset:1024 lds
    buffer_load_dwordx4 v44, s[16:19], s49 offen offset:2048 lds
    buffer_load_dwordx4 v45, s[16:19], s49 offen offset:3072 lds
    s_add_u32 s49, s44, 1048576
    s_add_u32 m0, s42, 98304
    s_nop 0
    buffer_load_dwordx4 v42, s[16:19], s49 offen lds
    buffer_load_dwordx4 v43, s[16:19], s49 offen offset:1024 lds
    buffer_load_dwordx4 v44, s[16:19], s49 offen offset:2048 lds
    buffer_load_dwordx4 v45, s[16:19], s49 offen offset:3072 lds
    s_add_u32 s49, s44, 1048832
    s_add_u32 m0, s42, 114688
    s_nop 0
    buffer_load_dwordx4 v42, s[16:19], s49 offen lds
    buffer_load_dwordx4 v43, s[16:19], s49 offen offset:1024 lds
    buffer_load_dwordx4 v44, s[16:19], s49 offen offset:2048 lds
    buffer_load_dwordx4 v45, s[16:19], s49 offen offset:3072 lds
    s_add_u32 s49, s44, 1572864
    s_add_u32 m0, s42, 131072
    s_nop 0
    buffer_load_dwordx4 v42, s[16:19], s49 offen lds
    buffer_load_dwordx4 v43, s[16:19], s49 offen offset:1024 lds
    buffer_load_dwordx4 v44, s[16:19], s49 offen offset:2048 lds
    buffer_load_dwordx4 v45, s[16:19], s49 offen offset:3072 lds
    s_add_u32 s49, s44, 1573120
    s_add_u32 m0, s42, 147456
    s_nop 0
    buffer_load_dwordx4 v42, s[16:19], s49 offen lds
    buffer_load_dwordx4 v43, s[16:19], s49 offen offset:1024 lds
    buffer_load_dwordx4 v44, s[16:19], s49 offen offset:2048 lds
    buffer_load_dwordx4 v45, s[16:19], s49 offen offset:3072 lds
    s_mov_b32 s38, 262144
Lhead_pollh:
    buffer_load_dword v75, v73, s[24:27], s36 offen sc1
    s_sub_u32 s38, s38, 1
    s_cbranch_scc1 Lhead_goth
    s_waitcnt vmcnt(0) lgkmcnt(0)
    v_cmp_ne_u32 vcc, s95, v75
    s_cbranch_vccnz Lhead_pollh
Lhead_goth:
    s_waitcnt vmcnt(0) lgkmcnt(0)
    buffer_load_dwordx4 a[0:3], v51, s[24:27], s46 offen offset:0 sc1
    buffer_load_dwordx4 a[8:11], v51, s[24:27], s46 offen offset:128 sc1
    buffer_load_dwordx4 a[4:7], v51, s[24:27], s43 offen offset:0 sc1
    buffer_load_dwordx4 a[12:15], v51, s[24:27], s43 offen offset:128 sc1
    s_barrier
    ds_read_b64_tr_b16 a[160:161], v12 offset:32768
    ds_read_b64_tr_b16 a[162:163], v12 offset:36864
    ds_read_b64_tr_b16 a[164:165], v12 offset:40960
    ds_read_b64_tr_b16 a[166:167], v12 offset:45056
    ds_read_b64_tr_b16 a[168:169], v13 offset:32768
    ds_read_b64_tr_b16 a[170:171], v13 offset:36864
    ds_read_b64_tr_b16 a[172:173], v13 offset:40960
    ds_read_b64_tr_b16 a[174:175], v13 offset:45056
    ds_read_b64_tr_b16 a[176:177], v14 offset:32768
    ds_read_b64_tr_b16 a[178:179], v14 offset:36864
    ds_read_b64_tr_b16 a[180:181], v14 offset:40960
    ds_read_b64_tr_b16 a[182:183], v14 offset:45056
    buffer_load_dwordx4 a[16:19], v51, s[24:27], s46 offen offset:256 sc1
    buffer_load_dwordx4 a[24:27], v51, s[24:27], s46 offen offset:384 sc1
    buffer_load_dwordx4 a[20:23], v51, s[24:27], s43 offen offset:256 sc1
    buffer_load_dwordx4 a[28:31], v51, s[24:27], s43 offen offset:384 sc1
    s_waitcnt lgkmcnt(10)
    s_waitcnt vmcnt(7)
    v_mfma_f32_16x16x32_bf16 v[128:131], a[160:163], a[0:3], 0
    s_waitcnt vmcnt(6)
    s_waitcnt lgkmcnt(8)
    ds_read_b64_tr_b16 a[184:185], v15 offset:32768
    v_mfma_f32_16x16x32_bf16 v[128:131], a[164:167], a[8:11], v[128:131]
    s_waitcnt vmcnt(4)
    ds_read_b64_tr_b16 a[186:187], v15 offset:36864
    v_mfma_f32_16x16x32_bf16 v[132:135], a[164:167], a[12:15], 0
    ds_read_b64_tr_b16 a[188:189], v15 offset:40960
    v_mfma_f32_16x16x32_bf16 v[132:135], a[160:163], a[4:7], v[132:135]
    s_waitcnt lgkmcnt(9)
    buffer_load_dwordx4 a[32:35], v51, s[24:27], s46 offen offset:512 sc1
    v_mfma_f32_16x16x32_bf16 v[140:143], a[168:171], a[4:7], 0
    s_waitcnt lgkmcnt(7)
    ds_read_b64_tr_b16 a[190:191], v15 offset:45056
    ds_read_b64_tr_b16 a[160:161], v16 offset:32768
    v_mfma_f32_16x16x32_bf16 v[140:143], a[172:175], a[12:15], v[140:143]
    ds_read_b64_tr_b16 a[162:163], v16 offset:36864
    v_mfma_f32_16x16x32_bf16 v[136:139], a[172:175], a[8:11], 0
    ds_read_b64_tr_b16 a[164:165], v16 offset:40960
    v_mfma_f32_16x16x32_bf16 v[136:139], a[168:171], a[0:3], v[136:139]
    s_waitcnt lgkmcnt(9)
    buffer_load_dwordx4 a[40:43], v51, s[24:27], s46 offen offset:640 sc1
    v_mfma_f32_16x16x32_bf16 v[144:147], a[176:179], a[0:3], 0
    s_waitcnt lgkmcnt(7)
    ds_read_b64_tr_b16 a[166:167], v16 offset:45056
    ds_read_b64_tr_b16 a[168:169], v17 offset:32768
    v_mfma_f32_16x16x32_bf16 v[144:147], a[180:183], a[8:11], v[144:147]
    ds_read_b64_tr_b16 a[170:171], v17 offset:36864
    v_mfma_f32_16x16x32_bf16 v[148:151], a[180:183], a[12:15], 0
    ds_read_b64_tr_b16 a[172:173], v17 offset:40960
    v_mfma_f32_16x16x32_bf16 v[148:151], a[176:179], a[4:7], v[148:151]
    s_waitcnt lgkmcnt(9)
    buffer_load_dwordx4 a[36:39], v51, s[24:27], s43 offen offset:512 sc1
    v_mfma_f32_16x16x32_bf16 v[156:159], a[184:187], a[4:7], 0
    s_waitcnt lgkmcnt(7)
    ds_read_b64_tr_b16 a[174:175], v17 offset:45056
    ds_read_b64_tr_b16 a[176:177], v18 offset:32768
    v_mfma_f32_16x16x32_bf16 v[156:159], a[188:191], a[12:15], v[156:159]
    ds_read_b64_tr_b16 a[178:179], v18 offset:36864
    v_mfma_f32_16x16x32_bf16 v[152:155], a[188:191], a[8:11], 0
    ds_read_b64_tr_b16 a[180:181], v18 offset:40960
    v_mfma_f32_16x16x32_bf16 v[152:155], a[184:187], a[0:3], v[152:155]
    s_waitcnt lgkmcnt(9)
    buffer_load_dwordx4 a[44:47], v51, s[24:27], s43 offen offset:640 sc1
    v_mfma_f32_16x16x32_bf16 v[160:163], a[160:163], a[0:3], 0
    s_waitcnt lgkmcnt(7)
    ds_read_b64_tr_b16 a[182:183], v18 offset:45056
    ds_read_b64_tr_b16 a[184:185], v19 offset:32768
    v_mfma_f32_16x16x32_bf16 v[160:163], a[164:167], a[8:11], v[160:163]
    ds_read_b64_tr_b16 a[186:187], v19 offset:36864
    v_mfma_f32_16x16x32_bf16 v[164:167], a[164:167], a[12:15], 0
    ds_read_b64_tr_b16 a[188:189], v19 offset:40960
    v_mfma_f32_16x16x32_bf16 v[164:167], a[160:163], a[4:7], v[164:167]
    s_waitcnt lgkmcnt(9)
    buffer_load_dword v77, v70, s[16:19], s44 offen
    v_mfma_f32_16x16x32_bf16 v[172:175], a[168:171], a[4:7], 0
    s_waitcnt lgkmcnt(7)
    ds_read_b64_tr_b16 a[190:191], v19 offset:45056
    ds_read_b64_tr_b16 a[160:161], v12 offset:49152
    v_mfma_f32_16x16x32_bf16 v[172:175], a[172:175], a[12:15], v[172:175]
    ds_read_b64_tr_b16 a[162:163], v12 offset:53248
    v_mfma_f32_16x16x32_bf16 v[168:171], a[172:175], a[8:11], 0
    ds_read_b64_tr_b16 a[164:165], v12 offset:57344
    v_mfma_f32_16x16x32_bf16 v[168:171], a[168:171], a[0:3], v[168:171]
    s_waitcnt lgkmcnt(9)
    ds_read_b64_tr_b16 a[166:167], v12 offset:61440
    v_mfma_f32_16x16x32_bf16 v[176:179], a[176:179], a[0:3], 0
    s_waitcnt lgkmcnt(8)
    ds_read_b64_tr_b16 a[168:169], v13 offset:49152
    v_mfma_f32_16x16x32_bf16 v[176:179], a[180:183], a[8:11], v[176:179]
    ds_read_b64_tr_b16 a[170:171], v13 offset:53248
    v_mfma_f32_16x16x32_bf16 v[180:183], a[180:183], a[12:15], 0
    ds_read_b64_tr_b16 a[172:173], v13 offset:57344
    v_mfma_f32_16x16x32_bf16 v[180:183], a[176:179], a[4:7], v[180:183]
    s_waitcnt lgkmcnt(9)
    ds_read_b64_tr_b16 a[174:175], v13 offset:61440
    v_mfma_f32_16x16x32_bf16 v[188:191], a[184:187], a[4:7], 0
    s_waitcnt lgkmcnt(8)
    ds_read_b64_tr_b16 a[176:177], v14 offset:49152
    v_mfma_f32_16x16x32_bf16 v[188:191], a[188:191], a[12:15], v[188:191]
    ds_read_b64_tr_b16 a[178:179], v14 offset:53248
    v_mfma_f32_16x16x32_bf16 v[184:187], a[188:191], a[8:11], 0
    ds_read_b64_tr_b16 a[180:181], v14 offset:57344
    v_mfma_f32_16x16x32_bf16 v[184:187], a[184:187], a[0:3], v[184:187]
    s_waitcnt lgkmcnt(9)
    ds_read_b64_tr_b16 a[182:183], v14 offset:61440
    v_mfma_f32_16x16x32_bf16 v[192:195], a[160:163], a[0:3], 0
    s_waitcnt lgkmcnt(8)
    ds_read_b64_tr_b16 a[184:185], v15 offset:49152
    v_mfma_f32_16x16x32_bf16 v[192:195], a[164:167], a[8:11], v[192:195]
    ds_read_b64_tr_b16 a[186:187], v15 offset:53248
    v_mfma_f32_16x16x32_bf16 v[196:199], a[164:167], a[12:15], 0
    ds_read_b64_tr_b16 a[188:189], v15 offset:57344
    v_mfma_f32_16x16x32_bf16 v[196:199], a[160:163], a[4:7], v[196:199]
    s_waitcnt lgkmcnt(9)
    ds_read_b64_tr_b16 a[190:191], v15 offset:61440
    v_mfma_f32_16x16x32_bf16 v[204:207], a[168:171], a[4:7], 0
    s_waitcnt lgkmcnt(8)
    ds_read_b64_tr_b16 a[160:161], v16 offset:49152
    v_mfma_f32_16x16x32_bf16 v[204:207], a[172:175], a[12:15], v[204:207]
    ds_read_b64_tr_b16 a[162:163], v16 offset:53248
    v_mfma_f32_16x16x32_bf16 v[200:203], a[172:175], a[8:11], 0
    ds_read_b64_tr_b16 a[164:165], v16 offset:57344
    v_mfma_f32_16x16x32_bf16 v[200:203], a[168:171], a[0:3], v[200:203]
    s_waitcnt lgkmcnt(9)
    ds_read_b64_tr_b16 a[166:167], v16 offset:61440
    v_mfma_f32_16x16x32_bf16 v[208:211], a[176:179], a[0:3], 0
    s_waitcnt lgkmcnt(8)
    ds_read_b64_tr_b16 a[168:169], v17 offset:49152
    v_mfma_f32_16x16x32_bf16 v[208:211], a[180:183], a[8:11], v[208:211]
    ds_read_b64_tr_b16 a[170:171], v17 offset:53248
    v_mfma_f32_16x16x32_bf16 v[212:215], a[180:183], a[12:15], 0
    ds_read_b64_tr_b16 a[172:173], v17 offset:57344
    v_mfma_f32_16x16x32_bf16 v[212:215], a[176:179], a[4:7], v[212:215]
    s_waitcnt lgkmcnt(9)
    ds_read_b64_tr_b16 a[174:175], v17 offset:61440
    v_mfma_f32_16x16x32_bf16 v[220:223], a[184:187], a[4:7], 0
    s_waitcnt lgkmcnt(8)
    ds_read_b64_tr_b16 a[176:177], v18 offset:49152
    v_mfma_f32_16x16x32_bf16 v[220:223], a[188:191], a[12:15], v[220:223]
Ltour0_0:
    s_cbranch_execz Ltour0_4
    ds_read_b64_tr_b16 a[178:179], v18 offset:53248
    v_mfma_f32_16x16x32_bf16 v[216:219], a[188:191], a[8:11], 0
    ds_read_b64_tr_b16 a[180:181], v18 offset:57344
    v_mfma_f32_16x16x32_bf16 v[216:219], a[184:187], a[0:3], v[216:219]
    s_waitcnt lgkmcnt(9)
    ds_read_b64_tr_b16 a[182:183], v18 offset:61440
    v_mfma_f32_16x16x32_bf16 v[224:227], a[160:163], a[0:3], 0
    s_waitcnt lgkmcnt(8)
    ds_read_b64_tr_b16 a[184:185], v19 offset:49152
    v_mfma_f32_16x16x32_bf16 v[224:227], a[164:167], a[8:11], v[224:227]
    ds_read_b64_tr_b16 a[186:187], v19 offset:53248
    v_mfma_f32_16x16x32_bf16 v[228:231], a[164:167], a[12:15], 0
    ds_read_b64_tr_b16 a[188:189], v19 offset:57344
    v_mfma_f32_16x16x32_bf16 v[228:231], a[160:163], a[4:7], v[228:231]
    s_waitcnt lgkmcnt(9)
    ds_read_b64_tr_b16 a[190:191], v19 offset:61440
    s_barrier
    v_mfma_f32_16x16x32_bf16 v[236:239], a[168:171], a[4:7], 0
    s_waitcnt lgkmcnt(8)
    ds_read_b64_tr_b16 a[160:161], v20 offset:0
    v_mfma_f32_16x16x32_bf16 v[236:239], a[172:175], a[12:15], v[236:239]
    ds_read_b64_tr_b16 a[162:163], v20 offset:4096
    v_mfma_f32_16x16x32_bf16 v[232:235], a[172:175], a[8:11], 0
    ds_read_b64_tr_b16 a[164:165], v20 offset:8192
    v_mfma_f32_16x16x32_bf16 v[232:235], a[168:171], a[0:3], v[232:235]
    s_waitcnt lgkmcnt(9)
    buffer_load_dwordx4 a[48:51], v51, s[24:27], s46 offen offset:768 sc1
    v_mfma_f32_16x16x32_bf16 v[240:243], a[176:179], a[0:3], 0
    s_waitcnt lgkmcnt(7)
    ds_read_b64_tr_b16 a[166:167], v20 offset:12288
    ds_read_b64_tr_b16 a[168:169], v21 offset:0
    v_mfma_f32_16x16x32_bf16 v[240:243], a[180:183], a[8:11], v[240:243]
    ds_read_b64_tr_b16 a[170:171], v21 offset:4096
    v_mfma_f32_16x16x32_bf16 v[244:247], a[180:183], a[12:15], 0
    ds_read_b64_tr_b16 a[172:173], v21 offset:8192
    v_mfma_f32_16x16x32_bf16 v[244:247], a[176:179], a[4:7], v[244:247]
    s_waitcnt lgkmcnt(9)
    buffer_load_dwordx4 a[56:59], v51, s[24:27], s46 offen offset:896 sc1
    v_mfma_f32_16x16x32_bf16 v[252:255], a[184:187], a[4:7], 0
    s_waitcnt lgkmcnt(7)
    ds_read_b64_tr_b16 a[174:175], v21 offset:12288
    ds_read_b64_tr_b16 a[176:177], v22 offset:0
    v_mfma_f32_16x16x32_bf16 v[252:255], a[188:191], a[12:15], v[252:255]
    ds_read_b64_tr_b16 a[178:179], v22 offset:4096
    v_mfma_f32_16x16x32_bf16 v[248:251], a[188:191], a[8:11], 0
    ds_read_b64_tr_b16 a[180:181], v22 offset:8192
    v_mfma_f32_16x16x32_bf16 v[248:251], a[184:187], a[0:3], v[248:251]
    s_waitcnt vmcnt(10)
    s_waitcnt lgkmcnt(9)
    buffer_load_dwordx4 a[52:55], v51, s[24:27], s43 offen offset:768 sc1
    v_mfma_f32_16x16x32_bf16 v[128:131], a[160:163], a[16:19], v[128:131]
    s_waitcnt vmcnt(10)
    s_waitcnt lgkmcnt(7)
    ds_read_b64_tr_b16 a[182:183], v22 offset:12288
    ds_read_b64_tr_b16 a[184:185], v23 offset:0
    v_mfma_f32_16x16x32_bf16 v[128:131], a[164:167], a[24:27], v[128:131]
    s_waitcnt vmcnt(8)
    ds_read_b64_tr_b16 a[186:187], v23 offset:4096
    v_mfma_f32_16x16x32_bf16 v[132:135], a[164:167], a[28:31], v[132:135]
    ds_read_b64_tr_b16 a[188:189], v23 offset:8192
    v_mfma_f32_16x16x32_bf16 v[132:135], a[160:163], a[20:23], v[132:135]
    s_waitcnt lgkmcnt(9)
    buffer_load_dwordx4 a[60:63], v51, s[24:27], s43 offen offset:896 sc1
    v_mfma_f32_16x16x32_bf16 v[140:143], a[168:171], a[20:23], v[140:143]
    s_waitcnt lgkmcnt(7)
    ds_read_b64_tr_b16 a[190:191], v23 offset:12288
    ds_read_b64_tr_b16 a[160:161], v24 offset:0
    v_mfma_f32_16x16x32_bf16 v[140:143], a[172:175], a[28:31], v[140:143]
    ds_read_b64_tr_b16 a[162:163], v24 offset:4096
    v_mfma_f32_16x16x32_bf16 v[136:139], a[172:175], a[24:27], v[136:139]
    ds_read_b64_tr_b16 a[164:165], v24 offset:8192
    v_mfma_f32_16x16x32_bf16 v[136:139], a[168:171], a[16:19], v[136:139]
    s_waitcnt lgkmcnt(9)
    buffer_load_dwordx4 a[64:67], v51, s[24:27], s46 offen offset:1024 sc1
    v_mfma_f32_16x16x32_bf16 v[144:147], a[176:179], a[16:19], v[144:147]
    s_waitcnt lgkmcnt(7)
    ds_read_b64_tr_b16 a[166:167], v24 offset:12288
    ds_read_b64_tr_b16 a[168:169], v25 offset:0
    v_mfma_f32_16x16x32_bf16 v[144:147], a[180:183], a[24:27], v[144:147]
    ds_read_b64_tr_b16 a[170:171], v25 offset:4096
    v_mfma_f32_16x16x32_bf16 v[148:151], a[180:183], a[28:31], v[148:151]
    ds_read_b64_tr_b16 a[172:173], v25 offset:8192
    v_mfma_f32_16x16x32_bf16 v[148:151], a[176:179], a[20:23], v[148:151]
    s_waitcnt lgkmcnt(9)
    buffer_load_dwordx4 a[72:75], v51, s[24:27], s46 offen offset:1152 sc1
    v_mfma_f32_16x16x32_bf16 v[156:159], a[184:187], a[20:23], v[156:159]
    s_waitcnt lgkmcnt(7)
    ds_read_b64_tr_b16 a[174:175], v25 offset:12288
    ds_read_b64_tr_b16 a[176:177], v26 offset:0
    v_mfma_f32_16x16x32_bf16 v[156:159], a[188:191], a[28:31], v[156:159]
    ds_read_b64_tr_b16 a[178:179], v26 offset:4096
    v_mfma_f32_16x16x32_bf16 v[152:155], a[188:191], a[24:27], v[152:155]
    ds_read_b64_tr_b16 a[180:181], v26 offset:8192
    v_mfma_f32_16x16x32_bf16 v[152:155], a[184:187], a[16:19], v[152:155]
    s_waitcnt lgkmcnt(9)
    buffer_load_dwordx4 a[68:71], v51, s[24:27], s43 offen offset:1024 sc1
    v_mfma_f32_16x16x32_bf16 v[160:163], a[160:163], a[16:19], v[160:163]
    s_waitcnt lgkmcnt(7)
    ds_read_b64_tr_b16 a[182:183], v26 offset:12288
    ds_read_b64_tr_b16 a[184:185], v27 offset:0
    v_mfma_f32_16x16x32_bf16 v[160:163], a[164:167], a[24:27], v[160:163]
    ds_read_b64_tr_b16 a[186:187], v27 offset:4096
    v_mfma_f32_16x16x32_bf16 v[164:167], a[164:167], a[28:31], v[164:167]
    ds_read_b64_tr_b16 a[188:189], v27 offset:8192
    v_mfma_f32_16x16x32_bf16 v[164:167], a[160:163], a[20:23], v[164:167]
    s_waitcnt lgkmcnt(9)
    buffer_load_dwordx4 a[76:79], v51, s[24:27], s43 offen offset:1152 sc1
    v_mfma_f32_16x16x32_bf16 v[172:175], a[168:171], a[20:23], v[172:175]
    s_waitcnt lgkmcnt(7)
    ds_read_b64_tr_b16 a[190:191], v27 offset:12288
    ds_read_b64_tr_b16 a[160:161], v20 offset:16384
    v_mfma_f32_16x16x32_bf16 v[172:175], a[172:175], a[28:31], v[172:175]
    ds_read_b64_tr_b16 a[162:163], v20 offset:20480
    v_mfma_f32_16x16x32_bf16 v[168:171], a[172:175], a[24:27], v[168:171]
    ds_read_b64_tr_b16 a[164:165], v20 offset:24576
    v_mfma_f32_16x16x32_bf16 v[168:171], a[168:171], a[16:19], v[168:171]
    s_waitcnt lgkmcnt(9)
    ds_read_b64_tr_b16 a[166:167], v20 offset:28672
    v_mfma_f32_16x16x32_bf16 v[176:179], a[176:179], a[16:19], v[176:179]
    s_waitcnt lgkmcnt(8)
    ds_read_b64_tr_b16 a[168:169], v21 offset:16384
    v_mfma_f32_16x16x32_bf16 v[176:179], a[180:183], a[24:27], v[176:179]
    ds_read_b64_tr_b16 a[170:171], v21 offset:20480
    v_mfma_f32_16x16x32_bf16 v[180:183], a[180:183], a[28:31], v[180:183]
    ds_read_b64_tr_b16 a[172:173], v21 offset:24576
    v_mfma_f32_16x16x32_bf16 v[180:183], a[176:179], a[20:23], v[180:183]
    s_waitcnt lgkmcnt(9)
    ds_read_b64_tr_b16 a[174:175], v21 offset:28672
    v_mfma_f32_16x16x32_bf16 v[188:191], a[184:187], a[20:23], v[188:191]
    s_waitcnt lgkmcnt(8)
    ds_read_b64_tr_b16 a[176:177], v22 offset:16384
    v_mfma_f32_16x16x32_bf16 v[188:191], a[188:191], a[28:31], v[188:191]
    ds_read_b64_tr_b16 a[178:179], v22 offset:20480
    v_mfma_f32_16x16x32_bf16 v[184:187], a[188:191], a[24:27], v[184:187]
    ds_read_b64_tr_b16 a[180:181], v22 offset:24576
    v_mfma_f32_16x16x32_bf16 v[184:187], a[184:187], a[16:19], v[184:187]
    s_waitcnt lgkmcnt(9)
    ds_read_b64_tr_b16 a[182:183], v22 offset:28672
    v_mfma_f32_16x16x32_bf16 v[192:195], a[160:163], a[16:19], v[192:195]
    s_waitcnt lgkmcnt(8)
    ds_read_b64_tr_b16 a[184:185], v23 offset:16384
    v_mfma_f32_16x16x32_bf16 v[192:195], a[164:167], a[24:27], v[192:195]
    ds_read_b64_tr_b16 a[186:187], v23 offset:20480
    v_mfma_f32_16x16x32_bf16 v[196:199], a[164:167], a[28:31], v[196:199]
    ds_read_b64_tr_b16 a[188:189], v23 offset:24576
    v_mfma_f32_16x16x32_bf16 v[196:199], a[160:163], a[20:23], v[196:199]
    s_waitcnt lgkmcnt(9)
    ds_read_b64_tr_b16 a[190:191], v23 offset:28672
    v_mfma_f32_16x16x32_bf16 v[204:207], a[168:171], a[20:23], v[204:207]
    s_waitcnt lgkmcnt(8)
    ds_read_b64_tr_b16 a[160:161], v24 offset:16384
    v_mfma_f32_16x16x32_bf16 v[204:207], a[172:175], a[28:31], v[204:207]
    ds_read_b64_tr_b16 a[162:163], v24 offset:20480
    v_mfma_f32_16x16x32_bf16 v[200:203], a[172:175], a[24:27], v[200:203]
    ds_read_b64_tr_b16 a[164:165], v24 offset:24576
    v_mfma_f32_16x16x32_bf16 v[200:203], a[168:171], a[16:19], v[200:203]
    s_waitcnt lgkmcnt(9)
    ds_read_b64_tr_b16 a[166:167], v24 offset:28672
    v_mfma_f32_16x16x32_bf16 v[208:211], a[176:179], a[16:19], v[208:211]
    s_waitcnt lgkmcnt(8)
    ds_read_b64_tr_b16 a[168:169], v25 offset:16384
    v_mfma_f32_16x16x32_bf16 v[208:211], a[180:183], a[24:27], v[208:211]
    ds_read_b64_tr_b16 a[170:171], v25 offset:20480
    v_mfma_f32_16x16x32_bf16 v[212:215], a[180:183], a[28:31], v[212:215]
    ds_read_b64_tr_b16 a[172:173], v25 offset:24576
    v_mfma_f32_16x16x32_bf16 v[212:215], a[176:179], a[20:23], v[212:215]
    s_waitcnt lgkmcnt(9)
    ds_read_b64_tr_b16 a[174:175], v25 offset:28672
    v_mfma_f32_16x16x32_bf16 v[220:223], a[184:187], a[20:23], v[220:223]
    s_waitcnt lgkmcnt(8)
    ds_read_b64_tr_b16 a[176:177], v26 offset:16384
    v_mfma_f32_16x16x32_bf16 v[220:223], a[188:191], a[28:31], v[220:223]
    ds_read_b64_tr_b16 a[178:179], v26 offset:20480
    v_mfma_f32_16x16x32_bf16 v[216:219], a[188:191], a[24:27], v[216:219]
    ds_read_b64_tr_b16 a[180:181], v26 offset:24576
    v_mfma_f32_16x16x32_bf16 v[216:219], a[184:187], a[16:19], v[216:219]
    s_waitcnt lgkmcnt(9)
    ds_read_b64_tr_b16 a[182:183], v26 offset:28672
    v_mfma_f32_16x16x32_bf16 v[224:227], a[160:163], a[16:19], v[224:227]
    s_waitcnt lgkmcnt(8)
    ds_read_b64_tr_b16 a[184:185], v27 offset:16384
    v_mfma_f32_16x16x32_bf16 v[224:227], a[164:167], a[24:27], v[224:227]
    ds_read_b64_tr_b16 a[186:187], v27 offset:20480
    v_mfma_f32_16x16x32_bf16 v[228:231], a[164:167], a[28:31], v[228:231]
    ds_read_b64_tr_b16 a[188:189], v27 offset:24576
    v_mfma_f32_16x16x32_bf16 v[228:231], a[160:163], a[20:23], v[228:231]
    s_waitcnt lgkmcnt(9)
    ds_read_b64_tr_b16 a[190:191], v27 offset:28672
    s_barrier
    v_mfma_f32_16x16x32_bf16 v[236:239], a[168:171], a[20:23], v[236:239]
    s_waitcnt lgkmcnt(8)
    ds_read_b64_tr_b16 a[160:161], v20 offset:32768
    v_mfma_f32_16x16x32_bf16 v[236:239], a[172:175], a[28:31], v[236:239]
    s_add_u32 s49, s44, 2097152
    ds_read_b64_tr_b16 a[162:163], v20 offset:36864
    v_mfma_f32_16x16x32_bf16 v[232:235], a[172:175], a[24:27], v[232:235]
    s_add_u32 m0, s42, 0
    ds_read_b64_tr_b16 a[164:165], v20 offset:40960
    v_mfma_f32_16x16x32_bf16 v[232:235], a[168:171], a[16:19], v[232:235]
    s_waitcnt lgkmcnt(9)
    buffer_load_dwordx4 v42, s[16:19], s49 offen lds
    v_mfma_f32_16x16x32_bf16 v[240:243], a[176:179], a[16:19], v[240:243]
    s_waitcnt lgkmcnt(7)
    ds_read_b64_tr_b16 a[166:167], v20 offset:45056
    ds_read_b64_tr_b16 a[168:169], v21 offset:32768
    v_mfma_f32_16x16x32_bf16 v[240:243], a[180:183], a[24:27], v[240:243]
    ds_read_b64_tr_b16 a[170:171], v21 offset:36864
    v_mfma_f32_16x16x32_bf16 v[244:247], a[180:183], a[28:31], v[244:247]
    ds_read_b64_tr_b16 a[172:173], v21 offset:40960
    v_mfma_f32_16x16x32_bf16 v[244:247], a[176:179], a[20:23], v[244:247]
    s_waitcnt lgkmcnt(9)
    buffer_load_dwordx4 v43, s[16:19], s49 offen offset:1024 lds
    v_mfma_f32_16x16x32_bf16 v[252:255], a[184:187], a[20:23], v[252:255]
    s_waitcnt lgkmcnt(7)
    ds_read_b64_tr_b16 a[174:175], v21 offset:45056
    ds_read_b64_tr_b16 a[176:177], v22 offset:32768
    v_mfma_f32_16x16x32_bf16 v[252:255], a[188:191], a[28:31], v[252:255]
    ds_read_b64_tr_b16 a[178:179], v22 offset:36864
    v_mfma_f32_16x16x32_bf16 v[248:251], a[188:191], a[24:27], v[248:251]
    ds_read_b64_tr_b16 a[180:181], v22 offset:40960
    v_mfma_f32_16x16x32_bf16 v[248:251], a[184:187], a[16:19], v[248:251]
    s_waitcnt vmcnt(14)
    s_waitcnt lgkmcnt(9)
    buffer_load_dwordx4 v44, s[16:19], s49 offen offset:2048 lds
    v_mfma_f32_16x16x32_bf16 v[128:131], a[160:163], a[32:35], v[128:131]
    s_waitcnt vmcnt(14)
    s_waitcnt lgkmcnt(7)
    ds_read_b64_tr_b16 a[182:183], v22 offset:45056
    ds_read_b64_tr_b16 a[184:185], v23 offset:32768
    v_mfma_f32_16x16x32_bf16 v[128:131], a[164:167], a[40:43], v[128:131]
    s_waitcnt vmcnt(12)
    ds_read_b64_tr_b16 a[186:187], v23 offset:36864
    v_mfma_f32_16x16x32_bf16 v[132:135], a[164:167], a[44:47], v[132:135]
    ds_read_b64_tr_b16 a[188:189], v23 offset:40960
    v_mfma_f32_16x16x32_bf16 v[132:135], a[160:163], a[36:39], v[132:135]
    s_waitcnt lgkmcnt(9)
    buffer_load_dwordx4 v45, s[16:19], s49 offen offset:3072 lds
    v_mfma_f32_16x16x32_bf16 v[140:143], a[168:171], a[36:39], v[140:143]
    s_waitcnt lgkmcnt(7)
    ds_read_b64_tr_b16 a[190:191], v23 offset:45056
    ds_read_b64_tr_b16 a[160:161], v24 offset:32768
    v_mfma_f32_16x16x32_bf16 v[140:143], a[172:175], a[44:47], v[140:143]
    s_add_u32 s49, s44, 2097408
    ds_read_b64_tr_b16 a[162:163], v24 offset:36864
    v_mfma_f32_16x16x32_bf16 v[136:139], a[172:175], a[40:43], v[136:139]
    s_add_u32 m0, s42, 16384
    ds_read_b64_tr_b16 a[164:165], v24 offset:40960
    v_mfma_f32_16x16x32_bf16 v[136:139], a[168:171], a[32:35], v[136:139]
    s_waitcnt lgkmcnt(9)
    buffer_load_dwordx4 v42, s[16:19], s49 offen lds
    v_mfma_f32_16x16x32_bf16 v[144:147], a[176:179], a[32:35], v[144:147]
    s_waitcnt lgkmcnt(7)
    ds_read_b64_tr_b16 a[166:167], v24 offset:45056
    ds_read_b64_tr_b16 a[168:169], v25 offset:32768
    v_mfma_f32_16x16x32_bf16 v[144:147], a[180:183], a[40:43], v[144:147]
    ds_read_b64_tr_b16 a[170:171], v25 offset:36864
    v_mfma_f32_16x16x32_bf16 v[148:151], a[180:183], a[44:47], v[148:151]
    ds_read_b64_tr_b16 a[172:173], v25 offset:40960
    v_mfma_f32_16x16x32_bf16 v[148:151], a[176:179], a[36:39], v[148:151]
    s_waitcnt lgkmcnt(9)
    buffer_load_dwordx4 v43, s[16:19], s49 offen offset:1024 lds
    v_mfma_f32_16x16x32_bf16 v[156:159], a[184:187], a[36:39], v[156:159]
    s_waitcnt lgkmcnt(7)
    ds_read_b64_tr_b16 a[174:175], v25 offset:45056
    ds_read_b64_tr_b16 a[176:177], v26 offset:32768
    v_mfma_f32_16x16x32_bf16 v[156:159], a[188:191], a[44:47], v[156:159]
    ds_read_b64_tr_b16 a[178:179], v26 offset:36864
    v_mfma_f32_16x16x32_bf16 v[152:155], a[188:191], a[40:43], v[152:155]
    ds_read_b64_tr_b16 a[180:181], v26 offset:40960
    v_mfma_f32_16x16x32_bf16 v[152:155], a[184:187], a[32:35], v[152:155]
    s_waitcnt lgkmcnt(9)
    buffer_load_dwordx4 v44, s[16:19], s49 offen offset:2048 lds
    v_mfma_f32_16x16x32_bf16 v[160:163], a[160:163], a[32:35], v[160:163]
    s_waitcnt lgkmcnt(7)
    ds_read_b64_tr_b16 a[182:183], v26 offset:45056
    ds_read_b64_tr_b16 a[184:185], v27 offset:32768
    v_mfma_f32_16x16x32_bf16 v[160:163], a[164:167], a[40:43], v[160:163]
    ds_read_b64_tr_b16 a[186:187], v27 offset:36864
    v_mfma_f32_16x16x32_bf16 v[164:167], a[164:167], a[44:47], v[164:167]
    ds_read_b64_tr_b16 a[188:189], v27 offset:40960
    v_mfma_f32_16x16x32_bf16 v[164:167], a[160:163], a[36:39], v[164:167]
    s_waitcnt lgkmcnt(9)
    buffer_load_dwordx4 v45, s[16:19], s49 offen offset:3072 lds
    v_mfma_f32_16x16x32_bf16 v[172:175], a[168:171], a[36:39], v[172:175]
    s_waitcnt lgkmcnt(7)
    ds_read_b64_tr_b16 a[190:191], v27 offset:45056
    ds_read_b64_tr_b16 a[160:161], v20 offset:49152
    v_mfma_f32_16x16x32_bf16 v[172:175], a[172:175], a[44:47], v[172:175]
    ds_read_b64_tr_b16 a[162:163], v20 offset:53248
    v_mfma_f32_16x16x32_bf16 v[168:171], a[172:175], a[40:43], v[168:171]
    ds_read_b64_tr_b16 a[164:165], v20 offset:57344
    v_mfma_f32_16x16x32_bf16 v[168:171], a[168:171], a[32:35], v[168:171]
    s_waitcnt lgkmcnt(9)
    buffer_load_dwordx4 a[80:83], v51, s[24:27], s46 offen offset:1280 sc1
    v_mfma_f32_16x16x32_bf16 v[176:179], a[176:179], a[32:35], v[176:179]
    s_waitcnt lgkmcnt(7)
    ds_read_b64_tr_b16 a[166:167], v20 offset:61440
    ds_read_b64_tr_b16 a[168:169], v21 offset:49152
    v_mfma_f32_16x16x32_bf16 v[176:179], a[180:183], a[40:43], v[176:179]
    ds_read_b64_tr_b16 a[170:171], v21 offset:53248
    v_mfma_f32_16x16x32_bf16 v[180:183], a[180:183], a[44:47], v[180:183]
    ds_read_b64_tr_b16 a[172:173], v21 offset:57344
    v_mfma_f32_16x16x32_bf16 v[180:183], a[176:179], a[36:39], v[180:183]
    s_waitcnt lgkmcnt(9)
    buffer_load_dwordx4 a[88:91], v51, s[24:27], s46 offen offset:1408 sc1
    v_mfma_f32_16x16x32_bf16 v[188:191], a[184:187], a[36:39], v[188:191]
    s_waitcnt lgkmcnt(7)
    ds_read_b64_tr_b16 a[174:175], v21 offset:61440
    ds_read_b64_tr_b16 a[176:177], v22 offset:49152
    v_mfma_f32_16x16x32_bf16 v[188:191], a[188:191], a[44:47], v[188:191]
    ds_read_b64_tr_b16 a[178:179], v22 offset:53248
    v_mfma_f32_16x16x32_bf16 v[184:187], a[188:191], a[40:43], v[184:187]
    ds_read_b64_tr_b16 a[180:181], v22 offset:57344
    v_mfma_f32_16x16x32_bf16 v[184:187], a[184:187], a[32:35], v[184:187]
    s_waitcnt lgkmcnt(9)
    buffer_load_dwordx4 a[84:87], v51, s[24:27], s43 offen offset:1280 sc1
    v_mfma_f32_16x16x32_bf16 v[192:195], a[160:163], a[32:35], v[192:195]
    s_waitcnt lgkmcnt(7)
    ds_read_b64_tr_b16 a[182:183], v22 offset:61440
    ds_read_b64_tr_b16 a[184:185], v23 offset:49152
    v_mfma_f32_16x16x32_bf16 v[192:195], a[164:167], a[40:43], v[192:195]
    ds_read_b64_tr_b16 a[186:187], v23 offset:53248
    v_mfma_f32_16x16x32_bf16 v[196:199], a[164:167], a[44:47], v[196:199]
    ds_read_b64_tr_b16 a[188:189], v23 offset:57344
    v_mfma_f32_16x16x32_bf16 v[196:199], a[160:163], a[36:39], v[196:199]
    s_waitcnt lgkmcnt(9)
    buffer_load_dwordx4 a[92:95], v51, s[24:27], s43 offen offset:1408 sc1
    v_mfma_f32_16x16x32_bf16 v[204:207], a[168:171], a[36:39], v[204:207]
    s_waitcnt lgkmcnt(7)
    ds_read_b64_tr_b16 a[190:191], v23 offset:61440
    ds_read_b64_tr_b16 a[160:161], v24 offset:49152
    v_mfma_f32_16x16x32_bf16 v[204:207], a[172:175], a[44:47], v[204:207]
    ds_read_b64_tr_b16 a[162:163], v24 offset:53248
    v_mfma_f32_16x16x32_bf16 v[200:203], a[172:175], a[40:43], v[200:203]
    ds_read_b64_tr_b16 a[164:165], v24 offset:57344
    v_mfma_f32_16x16x32_bf16 v[200:203], a[168:171], a[32:35], v[200:203]
    s_waitcnt lgkmcnt(9)
    ds_read_b64_tr_b16 a[166:167], v24 offset:61440
    v_mfma_f32_16x16x32_bf16 v[208:211], a[176:179], a[32:35], v[208:211]
    s_waitcnt lgkmcnt(8)
    ds_read_b64_tr_b16 a[168:169], v25 offset:49152
    v_mfma_f32_16x16x32_bf16 v[208:211], a[180:183], a[40:43], v[208:211]
    ds_read_b64_tr_b16 a[170:171], v25 offset:53248
    v_mfma_f32_16x16x32_bf16 v[212:215], a[180:183], a[44:47], v[212:215]
    ds_read_b64_tr_b16 a[172:173], v25 offset:57344
    v_mfma_f32_16x16x32_bf16 v[212:215], a[176:179], a[36:39], v[212:215]
    s_waitcnt lgkmcnt(9)
    ds_read_b64_tr_b16 a[174:175], v25 offset:61440
    v_mfma_f32_16x16x32_bf16 v[220:223], a[184:187], a[36:39], v[220:223]
    s_waitcnt lgkmcnt(8)
    ds_read_b64_tr_b16 a[176:177], v26 offset:49152
    v_mfma_f32_16x16x32_bf16 v[220:223], a[188:191], a[44:47], v[220:223]
    ds_read_b64_tr_b16 a[178:179], v26 offset:53248
    v_mfma_f32_16x16x32_bf16 v[216:219], a[188:191], a[40:43], v[216:219]
    ds_read_b64_tr_b16 a[180:181], v26 offset:57344
    v_mfma_f32_16x16x32_bf16 v[216:219], a[184:187], a[32:35], v[216:219]
    s_waitcnt lgkmcnt(9)
    ds_read_b64_tr_b16 a[182:183], v26 offset:61440
    v_mfma_f32_16x16x32_bf16 v[224:227], a[160:163], a[32:35], v[224:227]
    s_waitcnt lgkmcnt(8)
    ds_read_b64_tr_b16 a[184:185], v27 offset:49152
    v_mfma_f32_16x16x32_bf16 v[224:227], a[164:167], a[40:43], v[224:227]
    ds_read_b64_tr_b16 a[186:187], v27 offset:53248
    v_mfma_f32_16x16x32_bf16 v[228:231], a[164:167], a[44:47], v[228:231]
    ds_read_b64_tr_b16 a[188:189], v27 offset:57344
    v_mfma_f32_16x16x32_bf16 v[228:231], a[160:163], a[36:39], v[228:231]
    s_waitcnt lgkmcnt(9)
    ds_read_b64_tr_b16 a[190:191], v27 offset:61440
    s_barrier
    v_mfma_f32_16x16x32_bf16 v[236:239], a[168:171], a[36:39], v[236:239]
    s_waitcnt lgkmcnt(8)
    ds_read_b64_tr_b16 a[160:161], v28 offset:0
    v_mfma_f32_16x16x32_bf16 v[236:239], a[172:175], a[44:47], v[236:239]
    s_add_u32 s49, s44, 2621440
    ds_read_b64_tr_b16 a[162:163], v28 offset:4096
    v_mfma_f32_16x16x32_bf16 v[232:235], a[172:175], a[40:43], v[232:235]
    s_add_u32 m0, s42, 32768
    ds_read_b64_tr_b16 a[164:165], v28 offset:8192
    v_mfma_f32_16x16x32_bf16 v[232:235], a[168:171], a[32:35], v[232:235]
    s_waitcnt lgkmcnt(9)
    buffer_load_dwordx4 v42, s[16:19], s49 offen lds
    v_mfma_f32_16x16x32_bf16 v[240:243], a[176:179], a[32:35], v[240:243]
    s_waitcnt lgkmcnt(7)
    ds_read_b64_tr_b16 a[166:167], v28 offset:12288
    ds_read_b64_tr_b16 a[168:169], v29 offset:0
    v_mfma_f32_16x16x32_bf16 v[240:243], a[180:183], a[40:43], v[240:243]
    ds_read_b64_tr_b16 a[170:171], v29 offset:4096
    v_mfma_f32_16x16x32_bf16 v[244:247], a[180:183], a[44:47], v[244:247]
    ds_read_b64_tr_b16 a[172:173], v29 offset:8192
    v_mfma_f32_16x16x32_bf16 v[244:247], a[176:179], a[36:39], v[244:247]
    s_waitcnt lgkmcnt(9)
    buffer_load_dwordx4 v43, s[16:19], s49 offen offset:1024 lds
    v_mfma_f32_16x16x32_bf16 v[252:255], a[184:187], a[36:39], v[252:255]
    s_waitcnt lgkmcnt(7)
    ds_read_b64_tr_b16 a[174:175], v29 offset:12288
    ds_read_b64_tr_b16 a[176:177], v30 offset:0
    v_mfma_f32_16x16x32_bf16 v[252:255], a[188:191], a[44:47], v[252:255]
    ds_read_b64_tr_b16 a[178:179], v30 offset:4096
    v_mfma_f32_16x16x32_bf16 v[248:251], a[188:191], a[40:43], v[248:251]
    ds_read_b64_tr_b16 a[180:181], v30 offset:8192
    v_mfma_f32_16x16x32_bf16 v[248:251], a[184:187], a[32:35], v[248:251]
    s_waitcnt vmcnt(21)
    s_waitcnt lgkmcnt(9)
    buffer_load_dwordx4 v44, s[16:19], s49 offen offset:2048 lds
    v_mfma_f32_16x16x32_bf16 v[128:131], a[160:163], a[48:51], v[128:131]
    s_waitcnt vmcnt(21)
    s_waitcnt lgkmcnt(7)
    ds_read_b64_tr_b16 a[182:183], v30 offset:12288
    ds_read_b64_tr_b16 a[184:185], v31 offset:0
    v_mfma_f32_16x16x32_bf16 v[128:131], a[164:167], a[56:59], v[128:131]
    s_waitcnt vmcnt(19)
    ds_read_b64_tr_b16 a[186:187], v31 offset:4096
    v_mfma_f32_16x16x32_bf16 v[132:135], a[164:167], a[60:63], v[132:135]
    ds_read_b64_tr_b16 a[188:189], v31 offset:8192
    v_mfma_f32_16x16x32_bf16 v[132:135], a[160:163], a[52:55], v[132:135]
    s_waitcnt lgkmcnt(9)
    buffer_load_dwordx4 v45, s[16:19], s49 offen offset:3072 lds
    v_mfma_f32_16x16x32_bf16 v[140:143], a[168:171], a[52:55], v[140:143]
    s_waitcnt lgkmcnt(7)
    ds_read_b64_tr_b16 a[190:191], v31 offset:12288
    ds_read_b64_tr_b16 a[160:161], v32 offset:0
    v_mfma_f32_16x16x32_bf16 v[140:143], a[172:175], a[60:63], v[140:143]
    s_add_u32 s49, s44, 3145728
    ds_read_b64_tr_b16 a[162:163], v32 offset:4096
    v_mfma_f32_16x16x32_bf16 v[136:139], a[172:175], a[56:59], v[136:139]
    s_add_u32 m0, s42, 49152
    ds_read_b64_tr_b16 a[164:165], v32 offset:8192
    v_mfma_f32_16x16x32_bf16 v[136:139], a[168:171], a[48:51], v[136:139]
    s_waitcnt lgkmcnt(9)
    buffer_load_dwordx4 v42, s[16:19], s49 offen lds
    v_mfma_f32_16x16x32_bf16 v[144:147], a[176:179], a[48:51], v[144:147]
    s_waitcnt lgkmcnt(7)
    ds_read_b64_tr_b16 a[166:167], v32 offset:12288
    ds_read_b64_tr_b16 a[168:169], v33 offset:0
    v_mfma_f32_16x16x32_bf16 v[144:147], a[180:183], a[56:59], v[144:147]
    ds_read_b64_tr_b16 a[170:171], v33 offset:4096
    v_mfma_f32_16x16x32_bf16 v[148:151], a[180:183], a[60:63], v[148:151]
    ds_read_b64_tr_b16 a[172:173], v33 offset:8192
    v_mfma_f32_16x16x32_bf16 v[148:151], a[176:179], a[52:55], v[148:151]
    s_waitcnt lgkmcnt(9)
    buffer_load_dwordx4 v43, s[16:19], s49 offen offset:1024 lds
    v_mfma_f32_16x16x32_bf16 v[156:159], a[184:187], a[52:55], v[156:159]
    s_waitcnt lgkmcnt(7)
    ds_read_b64_tr_b16 a[174:175], v33 offset:12288
    ds_read_b64_tr_b16 a[176:177], v34 offset:0
    v_mfma_f32_16x16x32_bf16 v[156:159], a[188:191], a[60:63], v[156:159]
    ds_read_b64_tr_b16 a[178:179], v34 offset:4096
    v_mfma_f32_16x16x32_bf16 v[152:155], a[188:191], a[56:59], v[152:155]
    ds_read_b64_tr_b16 a[180:181], v34 offset:8192
    v_mfma_f32_16x16x32_bf16 v[152:155], a[184:187], a[48:51], v[152:155]
    s_waitcnt lgkmcnt(9)
    buffer_load_dwordx4 v44, s[16:19], s49 offen offset:2048 lds
    v_mfma_f32_16x16x32_bf16 v[160:163], a[160:163], a[48:51], v[160:163]
    s_waitcnt lgkmcnt(7)
    ds_read_b64_tr_b16 a[182:183], v34 offset:12288
    ds_read_b64_tr_b16 a[184:185], v35 offset:0
    v_mfma_f32_16x16x32_bf16 v[160:163], a[164:167], a[56:59], v[160:163]
    ds_read_b64_tr_b16 a[186:187], v35 offset:4096
    v_mfma_f32_16x16x32_bf16 v[164:167], a[164:167], a[60:63], v[164:167]
    ds_read_b64_tr_b16 a[188:189], v35 offset:8192
    v_mfma_f32_16x16x32_bf16 v[164:167], a[160:163], a[52:55], v[164:167]
    s_waitcnt lgkmcnt(9)
    buffer_load_dwordx4 v45, s[16:19], s49 offen offset:3072 lds
    v_mfma_f32_16x16x32_bf16 v[172:175], a[168:171], a[52:55], v[172:175]
    s_waitcnt lgkmcnt(7)
    ds_read_b64_tr_b16 a[190:191], v35 offset:12288
    ds_read_b64_tr_b16 a[160:161], v28 offset:16384
    v_mfma_f32_16x16x32_bf16 v[172:175], a[172:175], a[60:63], v[172:175]
    ds_read_b64_tr_b16 a[162:163], v28 offset:20480
    v_mfma_f32_16x16x32_bf16 v[168:171], a[172:175], a[56:59], v[168:171]
    ds_read_b64_tr_b16 a[164:165], v28 offset:24576
    v_mfma_f32_16x16x32_bf16 v[168:171], a[168:171], a[48:51], v[168:171]
    s_waitcnt lgkmcnt(9)
    buffer_load_dwordx4 a[96:99], v51, s[24:27], s46 offen offset:1536 sc1
    v_mfma_f32_16x16x32_bf16 v[176:179], a[176:179], a[48:51], v[176:179]
    s_waitcnt lgkmcnt(7)
    ds_read_b64_tr_b16 a[166:167], v28 offset:28672
    ds_read_b64_tr_b16 a[168:169], v29 offset:16384
    v_mfma_f32_16x16x32_bf16 v[176:179], a[180:183], a[56:59], v[176:179]
    ds_read_b64_tr_b16 a[170:171], v29 offset:20480
    v_mfma_f32_16x16x32_bf16 v[180:183], a[180:183], a[60:63], v[180:183]
    ds_read_b64_tr_b16 a[172:173], v29 offset:24576
    v_mfma_f32_16x16x32_bf16 v[180:183], a[176:179], a[52:55], v[180:183]
    s_waitcnt lgkmcnt(9)
    buffer_load_dwordx4 a[104:107], v51, s[24:27], s46 offen offset:1664 sc1
    v_mfma_f32_16x16x32_bf16 v[188:191], a[184:187], a[52:55], v[188:191]
    s_waitcnt lgkmcnt(7)
    ds_read_b64_tr_b16 a[174:175], v29 offset:28672
    ds_read_b64_tr_b16 a[176:177], v30 offset:16384
    v_mfma_f32_16x16x32_bf16 v[188:191], a[188:191], a[60:63], v[188:191]
    ds_read_b64_tr_b16 a[178:179], v30 offset:20480
    v_mfma_f32_16x16x32_bf16 v[184:187], a[188:191], a[56:59], v[184:187]
    ds_read_b64_tr_b16 a[180:181], v30 offset:24576
    v_mfma_f32_16x16x32_bf16 v[184:187], a[184:187], a[48:51], v[184:187]
    s_waitcnt lgkmcnt(9)
    buffer_load_dwordx4 a[100:103], v51, s[24:27], s43 offen offset:1536 sc1
    v_mfma_f32_16x16x32_bf16 v[192:195], a[160:163], a[48:51], v[192:195]
    s_waitcnt lgkmcnt(7)
    ds_read_b64_tr_b16 a[182:183], v30 offset:28672
    ds_read_b64_tr_b16 a[184:185], v31 offset:16384
    v_mfma_f32_16x16x32_bf16 v[192:195], a[164:167], a[56:59], v[192:195]
    ds_read_b64_tr_b16 a[186:187], v31 offset:20480
    v_mfma_f32_16x16x32_bf16 v[196:199], a[164:167], a[60:63], v[196:199]
    ds_read_b64_tr_b16 a[188:189], v31 offset:24576
    v_mfma_f32_16x16x32_bf16 v[196:199], a[160:163], a[52:55], v[196:199]
    s_waitcnt lgkmcnt(9)
    buffer_load_dwordx4 a[108:111], v51, s[24:27], s43 offen offset:1664 sc1
    v_mfma_f32_16x16x32_bf16 v[204:207], a[168:171], a[52:55], v[204:207]
    s_waitcnt lgkmcnt(7)
    ds_read_b64_tr_b16 a[190:191], v31 offset:28672
    ds_read_b64_tr_b16 a[160:161], v32 offset:16384
    v_mfma_f32_16x16x32_bf16 v[204:207], a[172:175], a[60:63], v[204:207]
    ds_read_b64_tr_b16 a[162:163], v32 offset:20480
    v_mfma_f32_16x16x32_bf16 v[200:203], a[172:175], a[56:59], v[200:203]
    ds_read_b64_tr_b16 a[164:165], v32 offset:24576
    v_mfma_f32_16x16x32_bf16 v[200:203], a[168:171], a[48:51], v[200:203]
    s_waitcnt lgkmcnt(9)
    ds_read_b64_tr_b16 a[166:167], v32 offset:28672
    v_mfma_f32_16x16x32_bf16 v[208:211], a[176:179], a[48:51], v[208:211]
    s_waitcnt lgkmcnt(8)
    ds_read_b64_tr_b16 a[168:169], v33 offset:16384
    v_mfma_f32_16x16x32_bf16 v[208:211], a[180:183], a[56:59], v[208:211]
    ds_read_b64_tr_b16 a[170:171], v33 offset:20480
    v_mfma_f32_16x16x32_bf16 v[212:215], a[180:183], a[60:63], v[212:215]
    ds_read_b64_tr_b16 a[172:173], v33 offset:24576
    v_mfma_f32_16x16x32_bf16 v[212:215], a[176:179], a[52:55], v[212:215]
    s_waitcnt lgkmcnt(9)
    ds_read_b64_tr_b16 a[174:175], v33 offset:28672
    v_mfma_f32_16x16x32_bf16 v[220:223], a[184:187], a[52:55], v[220:223]
    s_waitcnt lgkmcnt(8)
    ds_read_b64_tr_b16 a[176:177], v34 offset:16384
    v_mfma_f32_16x16x32_bf16 v[220:223], a[188:191], a[60:63], v[220:223]
    ds_read_b64_tr_b16 a[178:179], v34 offset:20480
    v_mfma_f32_16x16x32_bf16 v[216:219], a[188:191], a[56:59], v[216:219]
    ds_read_b64_tr_b16 a[180:181], v34 offset:24576
    v_mfma_f32_16x16x32_bf16 v[216:219], a[184:187], a[48:51], v[216:219]
    s_waitcnt lgkmcnt(9)
    ds_read_b64_tr_b16 a[182:183], v34 offset:28672
    v_mfma_f32_16x16x32_bf16 v[224:227], a[160:163], a[48:51], v[224:227]
    s_waitcnt lgkmcnt(8)
    ds_read_b64_tr_b16 a[184:185], v35 offset:16384
    v_mfma_f32_16x16x32_bf16 v[224:227], a[164:167], a[56:59], v[224:227]
    ds_read_b64_tr_b16 a[186:187], v35 offset:20480
    v_mfma_f32_16x16x32_bf16 v[228:231], a[164:167], a[60:63], v[228:231]
    ds_read_b64_tr_b16 a[188:189], v35 offset:24576
    v_mfma_f32_16x16x32_bf16 v[228:231], a[160:163], a[52:55], v[228:231]
    s_waitcnt lgkmcnt(9)
    ds_read_b64_tr_b16 a[190:191], v35 offset:28672
    s_waitcnt vmcnt(16)
    s_barrier
    v_mfma_f32_16x16x32_bf16 v[236:239], a[168:171], a[52:55], v[236:239]
    s_waitcnt lgkmcnt(8)
    ds_read_b64_tr_b16 a[160:161], v12 offset:0
    v_mfma_f32_16x16x32_bf16 v[236:239], a[172:175], a[60:63], v[236:239]
    s_add_u32 s49, s44, 3670016
    ds_read_b64_tr_b16 a[162:163], v12 offset:4096
    v_mfma_f32_16x16x32_bf16 v[232:235], a[172:175], a[56:59], v[232:235]
    s_add_u32 m0, s42, 65536
    ds_read_b64_tr_b16 a[164:165], v12 offset:8192
    v_mfma_f32_16x16x32_bf16 v[232:235], a[168:171], a[48:51], v[232:235]
    s_waitcnt lgkmcnt(9)
    buffer_load_dwordx4 v42, s[16:19], s49 offen lds
    v_mfma_f32_16x16x32_bf16 v[240:243], a[176:179], a[48:51], v[240:243]
    s_waitcnt lgkmcnt(7)
    ds_read_b64_tr_b16 a[166:167], v12 offset:12288
    ds_read_b64_tr_b16 a[168:169], v13 offset:0
    v_mfma_f32_16x16x32_bf16 v[240:243], a[180:183], a[56:59], v[240:243]
Ltour0_1:
    s_cbranch_execz Ltour0_5
    ds_read_b64_tr_b16 a[170:171], v13 offset:4096
    v_mfma_f32_16x16x32_bf16 v[244:247], a[180:183], a[60:63], v[244:247]
    ds_read_b64_tr_b16 a[172:173], v13 offset:8192
    v_mfma_f32_16x16x32_bf16 v[244:247], a[176:179], a[52:55], v[244:247]
    s_waitcnt lgkmcnt(9)
    buffer_load_dwordx4 v43, s[16:19], s49 offen offset:1024 lds
    v_mfma_f32_16x16x32_bf16 v[252:255], a[184:187], a[52:55], v[252:255]
    s_waitcnt lgkmcnt(7)
    ds_read_b64_tr_b16 a[174:175], v13 offset:12288
    ds_read_b64_tr_b16 a[176:177], v14 offset:0
    v_mfma_f32_16x16x32_bf16 v[252:255], a[188:191], a[60:63], v[252:255]
    ds_read_b64_tr_b16 a[178:179], v14 offset:4096
    v_mfma_f32_16x16x32_bf16 v[248:251], a[188:191], a[56:59], v[248:251]
    ds_read_b64_tr_b16 a[180:181], v14 offset:8192
    v_mfma_f32_16x16x32_bf16 v[248:251], a[184:187], a[48:51], v[248:251]
    s_waitcnt lgkmcnt(9)
    buffer_load_dwordx4 v44, s[16:19], s49 offen offset:2048 lds
    v_mfma_f32_16x16x32_bf16 v[128:131], a[160:163], a[64:67], v[128:131]
    s_waitcnt lgkmcnt(7)
    ds_read_b64_tr_b16 a[182:183], v14 offset:12288
    ds_read_b64_tr_b16 a[184:185], v15 offset:0
    v_mfma_f32_16x16x32_bf16 v[128:131], a[164:167], a[72:75], v[128:131]
    ds_read_b64_tr_b16 a[186:187], v15 offset:4096
    v_mfma_f32_16x16x32_bf16 v[132:135], a[164:167], a[76:79], v[132:135]
    ds_read_b64_tr_b16 a[188:189], v15 offset:8192
    v_mfma_f32_16x16x32_bf16 v[132:135], a[160:163], a[68:71], v[132:135]
    s_waitcnt lgkmcnt(9)
    buffer_load_dwordx4 v45, s[16:19], s49 offen offset:3072 lds
    v_mfma_f32_16x16x32_bf16 v[140:143], a[168:171], a[68:71], v[140:143]
    s_waitcnt lgkmcnt(7)
    ds_read_b64_tr_b16 a[190:191], v15 offset:12288
    ds_read_b64_tr_b16 a[160:161], v16 offset:0
    v_mfma_f32_16x16x32_bf16 v[140:143], a[172:175], a[76:79], v[140:143]
    s_add_u32 s49, s44, 4194304
    ds_read_b64_tr_b16 a[162:163], v16 offset:4096
    v_mfma_f32_16x16x32_bf16 v[136:139], a[172:175], a[72:75], v[136:139]
    s_add_u32 m0, s42, 81920
    ds_read_b64_tr_b16 a[164:165], v16 offset:8192
    v_mfma_f32_16x16x32_bf16 v[136:139], a[168:171], a[64:67], v[136:139]
    s_waitcnt lgkmcnt(9)
    buffer_load_dwordx4 v42, s[16:19], s49 offen lds
    v_mfma_f32_16x16x32_bf16 v[144:147], a[176:179], a[64:67], v[144:147]
    s_waitcnt lgkmcnt(7)
    ds_read_b64_tr_b16 a[166:167], v16 offset:12288
    ds_read_b64_tr_b16 a[168:169], v17 offset:0
    v_mfma_f32_16x16x32_bf16 v[144:147], a[180:183], a[72:75], v[144:147]
    ds_read_b64_tr_b16 a[170:171], v17 offset:4096
    v_mfma_f32_16x16x32_bf16 v[148:151], a[180:183], a[76:79], v[148:151]
    ds_read_b64_tr_b16 a[172:173], v17 offset:8192
    v_mfma_f32_16x16x32_bf16 v[148:151], a[176:179], a[68:71], v[148:151]
    s_waitcnt lgkmcnt(9)
    buffer_load_dwordx4 v43, s[16:19], s49 offen offset:1024 lds
    v_mfma_f32_16x16x32_bf16 v[156:159], a[184:187], a[68:71], v[156:159]
    s_waitcnt lgkmcnt(7)
    ds_read_b64_tr_b16 a[174:175], v17 offset:12288
    ds_read_b64_tr_b16 a[176:177], v18 offset:0
    v_mfma_f32_16x16x32_bf16 v[156:159], a[188:191], a[76:79], v[156:159]
    ds_read_b64_tr_b16 a[178:179], v18 offset:4096
    v_mfma_f32_16x16x32_bf16 v[152:155], a[188:191], a[72:75], v[152:155]
    ds_read_b64_tr_b16 a[180:181], v18 offset:8192
    v_mfma_f32_16x16x32_bf16 v[152:155], a[184:187], a[64:67], v[152:155]
    s_waitcnt lgkmcnt(9)
    buffer_load_dwordx4 v44, s[16:19], s49 offen offset:2048 lds
    v_mfma_f32_16x16x32_bf16 v[160:163], a[160:163], a[64:67], v[160:163]
    s_waitcnt lgkmcnt(7)
    ds_read_b64_tr_b16 a[182:183], v18 offset:12288
    ds_read_b64_tr_b16 a[184:185], v19 offset:0
    v_mfma_f32_16x16x32_bf16 v[160:163], a[164:167], a[72:75], v[160:163]
    ds_read_b64_tr_b16 a[186:187], v19 offset:4096
    v_mfma_f32_16x16x32_bf16 v[164:167], a[164:167], a[76:79], v[164:167]
    ds_read_b64_tr_b16 a[188:189], v19 offset:8192
    v_mfma_f32_16x16x32_bf16 v[164:167], a[160:163], a[68:71], v[164:167]
    s_waitcnt lgkmcnt(9)
    buffer_load_dwordx4 v45, s[16:19], s49 offen offset:3072 lds
    v_mfma_f32_16x16x32_bf16 v[172:175], a[168:171], a[68:71], v[172:175]
    s_waitcnt lgkmcnt(7)
    ds_read_b64_tr_b16 a[190:191], v19 offset:12288
    ds_read_b64_tr_b16 a[160:161], v12 offset:16384
    v_mfma_f32_16x16x32_bf16 v[172:175], a[172:175], a[76:79], v[172:175]
    ds_read_b64_tr_b16 a[162:163], v12 offset:20480
    v_mfma_f32_16x16x32_bf16 v[168:171], a[172:175], a[72:75], v[168:171]
    ds_read_b64_tr_b16 a[164:165], v12 offset:24576
    v_mfma_f32_16x16x32_bf16 v[168:171], a[168:171], a[64:67], v[168:171]
    s_waitcnt lgkmcnt(9)
    buffer_load_dwordx4 a[112:115], v51, s[24:27], s46 offen offset:1792 sc1
    v_mfma_f32_16x16x32_bf16 v[176:179], a[176:179], a[64:67], v[176:179]
    s_waitcnt lgkmcnt(7)
    ds_read_b64_tr_b16 a[166:167], v12 offset:28672
    ds_read_b64_tr_b16 a[168:169], v13 offset:16384
    v_mfma_f32_16x16x32_bf16 v[176:179], a[180:183], a[72:75], v[176:179]
    ds_read_b64_tr_b16 a[170:171], v13 offset:20480
    v_mfma_f32_16x16x32_bf16 v[180:183], a[180:183], a[76:79], v[180:183]
    ds_read_b64_tr_b16 a[172:173], v13 offset:24576
    v_mfma_f32_16x16x32_bf16 v[180:183], a[176:179], a[68:71], v[180:183]
    s_waitcnt lgkmcnt(9)
    buffer_load_dwordx4 a[120:123], v51, s[24:27], s46 offen offset:1920 sc1
    v_mfma_f32_16x16x32_bf16 v[188:191], a[184:187], a[68:71], v[188:191]
    s_waitcnt lgkmcnt(7)
    ds_read_b64_tr_b16 a[174:175], v13 offset:28672
    ds_read_b64_tr_b16 a[176:177], v14 offset:16384
    v_mfma_f32_16x16x32_bf16 v[188:191], a[188:191], a[76:79], v[188:191]
    ds_read_b64_tr_b16 a[178:179], v14 offset:20480
    v_mfma_f32_16x16x32_bf16 v[184:187], a[188:191], a[72:75], v[184:187]
    ds_read_b64_tr_b16 a[180:181], v14 offset:24576
    v_mfma_f32_16x16x32_bf16 v[184:187], a[184:187], a[64:67], v[184:187]
    s_waitcnt lgkmcnt(9)
    buffer_load_dwordx4 a[116:119], v51, s[24:27], s43 offen offset:1792 sc1
    v_mfma_f32_16x16x32_bf16 v[192:195], a[160:163], a[64:67], v[192:195]
    s_waitcnt lgkmcnt(7)
    ds_read_b64_tr_b16 a[182:183], v14 offset:28672
    ds_read_b64_tr_b16 a[184:185], v15 offset:16384
    v_mfma_f32_16x16x32_bf16 v[192:195], a[164:167], a[72:75], v[192:195]
    ds_read_b64_tr_b16 a[186:187], v15 offset:20480
    v_mfma_f32_16x16x32_bf16 v[196:199], a[164:167], a[76:79], v[196:199]
    ds_read_b64_tr_b16 a[188:189], v15 offset:24576
    v_mfma_f32_16x16x32_bf16 v[196:199], a[160:163], a[68:71], v[196:199]
    s_waitcnt lgkmcnt(9)
    buffer_load_dwordx4 a[124:127], v51, s[24:27], s43 offen offset:1920 sc1
    v_mfma_f32_16x16x32_bf16 v[204:207], a[168:171], a[68:71], v[204:207]
    s_waitcnt lgkmcnt(7)
    ds_read_b64_tr_b16 a[190:191], v15 offset:28672
    ds_read_b64_tr_b16 a[160:161], v16 offset:16384
    v_mfma_f32_16x16x32_bf16 v[204:207], a[172:175], a[76:79], v[204:207]
    ds_read_b64_tr_b16 a[162:163], v16 offset:20480
    v_mfma_f32_16x16x32_bf16 v[200:203], a[172:175], a[72:75], v[200:203]
    ds_read_b64_tr_b16 a[164:165], v16 offset:24576
    v_mfma_f32_16x16x32_bf16 v[200:203], a[168:171], a[64:67], v[200:203]
    s_waitcnt lgkmcnt(9)
    ds_read_b64_tr_b16 a[166:167], v16 offset:28672
    v_mfma_f32_16x16x32_bf16 v[208:211], a[176:179], a[64:67], v[208:211]
    s_waitcnt lgkmcnt(8)
    ds_read_b64_tr_b16 a[168:169], v17 offset:16384
    v_mfma_f32_16x16x32_bf16 v[208:211], a[180:183], a[72:75], v[208:211]
    ds_read_b64_tr_b16 a[170:171], v17 offset:20480
    v_mfma_f32_16x16x32_bf16 v[212:215], a[180:183], a[76:79], v[212:215]
    ds_read_b64_tr_b16 a[172:173], v17 offset:24576
    v_mfma_f32_16x16x32_bf16 v[212:215], a[176:179], a[68:71], v[212:215]
    s_waitcnt lgkmcnt(9)
    ds_read_b64_tr_b16 a[174:175], v17 offset:28672
    v_mfma_f32_16x16x32_bf16 v[220:223], a[184:187], a[68:71], v[220:223]
    s_waitcnt lgkmcnt(8)
    ds_read_b64_tr_b16 a[176:177], v18 offset:16384
    v_mfma_f32_16x16x32_bf16 v[220:223], a[188:191], a[76:79], v[220:223]
    ds_read_b64_tr_b16 a[178:179], v18 offset:20480
    v_mfma_f32_16x16x32_bf16 v[216:219], a[188:191], a[72:75], v[216:219]
    ds_read_b64_tr_b16 a[180:181], v18 offset:24576
    v_mfma_f32_16x16x32_bf16 v[216:219], a[184:187], a[64:67], v[216:219]
    s_waitcnt lgkmcnt(9)
    ds_read_b64_tr_b16 a[182:183], v18 offset:28672
    v_mfma_f32_16x16x32_bf16 v[224:227], a[160:163], a[64:67], v[224:227]
    s_waitcnt lgkmcnt(8)
    ds_read_b64_tr_b16 a[184:185], v19 offset:16384
    v_mfma_f32_16x16x32_bf16 v[224:227], a[164:167], a[72:75], v[224:227]
    ds_read_b64_tr_b16 a[186:187], v19 offset:20480
    v_mfma_f32_16x16x32_bf16 v[228:231], a[164:167], a[76:79], v[228:231]
    ds_read_b64_tr_b16 a[188:189], v19 offset:24576
    v_mfma_f32_16x16x32_bf16 v[228:231], a[160:163], a[68:71], v[228:231]
    s_waitcnt lgkmcnt(9)
    ds_read_b64_tr_b16 a[190:191], v19 offset:28672
    s_waitcnt vmcnt(16)
    s_barrier
    v_mfma_f32_16x16x32_bf16 v[236:239], a[168:171], a[68:71], v[236:239]
    s_waitcnt lgkmcnt(8)
    ds_read_b64_tr_b16 a[160:161], v12 offset:32768
    v_mfma_f32_16x16x32_bf16 v[236:239], a[172:175], a[76:79], v[236:239]
    s_add_u32 s49, s44, 2621696
    ds_read_b64_tr_b16 a[162:163], v12 offset:36864
    v_mfma_f32_16x16x32_bf16 v[232:235], a[172:175], a[72:75], v[232:235]
    s_add_u32 m0, s42, 98304
    ds_read_b64_tr_b16 a[164:165], v12 offset:40960
    v_mfma_f32_16x16x32_bf16 v[232:235], a[168:171], a[64:67], v[232:235]
    s_waitcnt lgkmcnt(9)
    buffer_load_dwordx4 v42, s[16:19], s49 offen lds
    v_mfma_f32_16x16x32_bf16 v[240:243], a[176:179], a[64:67], v[240:243]
    s_waitcnt lgkmcnt(7)
    ds_read_b64_tr_b16 a[166:167], v12 offset:45056
    ds_read_b64_tr_b16 a[168:169], v13 offset:32768
    v_mfma_f32_16x16x32_bf16 v[240:243], a[180:183], a[72:75], v[240:243]
    ds_read_b64_tr_b16 a[170:171], v13 offset:36864
    v_mfma_f32_16x16x32_bf16 v[244:247], a[180:183], a[76:79], v[244:247]
    ds_read_b64_tr_b16 a[172:173], v13 offset:40960
    v_mfma_f32_16x16x32_bf16 v[244:247], a[176:179], a[68:71], v[244:247]
    s_waitcnt lgkmcnt(9)
    buffer_load_dwordx4 v43, s[16:19], s49 offen offset:1024 lds
    v_mfma_f32_16x16x32_bf16 v[252:255], a[184:187], a[68:71], v[252:255]
    s_waitcnt lgkmcnt(7)
    ds_read_b64_tr_b16 a[174:175], v13 offset:45056
    ds_read_b64_tr_b16 a[176:177], v14 offset:32768
    v_mfma_f32_16x16x32_bf16 v[252:255], a[188:191], a[76:79], v[252:255]
    ds_read_b64_tr_b16 a[178:179], v14 offset:36864
    v_mfma_f32_16x16x32_bf16 v[248:251], a[188:191], a[72:75], v[248:251]
    ds_read_b64_tr_b16 a[180:181], v14 offset:40960
    v_mfma_f32_16x16x32_bf16 v[248:251], a[184:187], a[64:67], v[248:251]
    s_waitcnt lgkmcnt(9)
    buffer_load_dwordx4 v44, s[16:19], s49 offen offset:2048 lds
    v_mfma_f32_16x16x32_bf16 v[128:131], a[160:163], a[80:83], v[128:131]
    s_waitcnt lgkmcnt(7)
    ds_read_b64_tr_b16 a[182:183], v14 offset:45056
    ds_read_b64_tr_b16 a[184:185], v15 offset:32768
    v_mfma_f32_16x16x32_bf16 v[128:131], a[164:167], a[88:91], v[128:131]
    ds_read_b64_tr_b16 a[186:187], v15 offset:36864
    v_mfma_f32_16x16x32_bf16 v[132:135], a[164:167], a[92:95], v[132:135]
    ds_read_b64_tr_b16 a[188:189], v15 offset:40960
    v_mfma_f32_16x16x32_bf16 v[132:135], a[160:163], a[84:87], v[132:135]
    s_waitcnt lgkmcnt(9)
    buffer_load_dwordx4 v45, s[16:19], s49 offen offset:3072 lds
    v_mfma_f32_16x16x32_bf16 v[140:143], a[168:171], a[84:87], v[140:143]
    s_waitcnt lgkmcnt(7)
    ds_read_b64_tr_b16 a[190:191], v15 offset:45056
    ds_read_b64_tr_b16 a[160:161], v16 offset:32768
    v_mfma_f32_16x16x32_bf16 v[140:143], a[172:175], a[92:95], v[140:143]
    s_add_u32 s49, s44, 3145984
    ds_read_b64_tr_b16 a[162:163], v16 offset:36864
    v_mfma_f32_16x16x32_bf16 v[136:139], a[172:175], a[88:91], v[136:139]
    s_add_u32 m0, s42, 114688
    ds_read_b64_tr_b16 a[164:165], v16 offset:40960
    v_mfma_f32_16x16x32_bf16 v[136:139], a[168:171], a[80:83], v[136:139]
    s_waitcnt lgkmcnt(9)
    buffer_load_dwordx4 v42, s[16:19], s49 offen lds
    v_mfma_f32_16x16x32_bf16 v[144:147], a[176:179], a[80:83], v[144:147]
    s_waitcnt lgkmcnt(7)
    ds_read_b64_tr_b16 a[166:167], v16 offset:45056
    ds_read_b64_tr_b16 a[168:169], v17 offset:32768
    v_mfma_f32_16x16x32_bf16 v[144:147], a[180:183], a[88:91], v[144:147]
    ds_read_b64_tr_b16 a[170:171], v17 offset:36864
    v_mfma_f32_16x16x32_bf16 v[148:151], a[180:183], a[92:95], v[148:151]
    ds_read_b64_tr_b16 a[172:173], v17 offset:40960
    v_mfma_f32_16x16x32_bf16 v[148:151], a[176:179], a[84:87], v[148:151]
    s_waitcnt lgkmcnt(9)
    buffer_load_dwordx4 v43, s[16:19], s49 offen offset:1024 lds
    v_mfma_f32_16x16x32_bf16 v[156:159], a[184:187], a[84:87], v[156:159]
    s_waitcnt lgkmcnt(7)
    ds_read_b64_tr_b16 a[174:175], v17 offset:45056
    ds_read_b64_tr_b16 a[176:177], v18 offset:32768
    v_mfma_f32_16x16x32_bf16 v[156:159], a[188:191], a[92:95], v[156:159]
    ds_read_b64_tr_b16 a[178:179], v18 offset:36864
    v_mfma_f32_16x16x32_bf16 v[152:155], a[188:191], a[88:91], v[152:155]
    ds_read_b64_tr_b16 a[180:181], v18 offset:40960
    v_mfma_f32_16x16x32_bf16 v[152:155], a[184:187], a[80:83], v[152:155]
    s_waitcnt lgkmcnt(9)
    buffer_load_dwordx4 v44, s[16:19], s49 offen offset:2048 lds
    v_mfma_f32_16x16x32_bf16 v[160:163], a[160:163], a[80:83], v[160:163]
    s_waitcnt lgkmcnt(7)
    ds_read_b64_tr_b16 a[182:183], v18 offset:45056
    ds_read_b64_tr_b16 a[184:185], v19 offset:32768
    v_mfma_f32_16x16x32_bf16 v[160:163], a[164:167], a[88:91], v[160:163]
    ds_read_b64_tr_b16 a[186:187], v19 offset:36864
    v_mfma_f32_16x16x32_bf16 v[164:167], a[164:167], a[92:95], v[164:167]
    ds_read_b64_tr_b16 a[188:189], v19 offset:40960
    v_mfma_f32_16x16x32_bf16 v[164:167], a[160:163], a[84:87], v[164:167]
    s_waitcnt lgkmcnt(9)
    buffer_load_dwordx4 v45, s[16:19], s49 offen offset:3072 lds
    v_mfma_f32_16x16x32_bf16 v[172:175], a[168:171], a[84:87], v[172:175]
    s_waitcnt lgkmcnt(7)
    ds_read_b64_tr_b16 a[190:191], v19 offset:45056
    ds_read_b64_tr_b16 a[160:161], v12 offset:49152
    v_mfma_f32_16x16x32_bf16 v[172:175], a[172:175], a[92:95], v[172:175]
    ds_read_b64_tr_b16 a[162:163], v12 offset:53248
    v_mfma_f32_16x16x32_bf16 v[168:171], a[172:175], a[88:91], v[168:171]
    ds_read_b64_tr_b16 a[164:165], v12 offset:57344
    v_mfma_f32_16x16x32_bf16 v[168:171], a[168:171], a[80:83], v[168:171]
    s_waitcnt lgkmcnt(9)
    buffer_load_dwordx4 a[128:131], v51, s[24:27], s46 offen offset:2048 sc1
    v_mfma_f32_16x16x32_bf16 v[176:179], a[176:179], a[80:83], v[176:179]
    s_waitcnt lgkmcnt(7)
    ds_read_b64_tr_b16 a[166:167], v12 offset:61440
    ds_read_b64_tr_b16 a[168:169], v13 offset:49152
    v_mfma_f32_16x16x32_bf16 v[176:179], a[180:183], a[88:91], v[176:179]
    ds_read_b64_tr_b16 a[170:171], v13 offset:53248
    v_mfma_f32_16x16x32_bf16 v[180:183], a[180:183], a[92:95], v[180:183]
    ds_read_b64_tr_b16 a[172:173], v13 offset:57344
    v_mfma_f32_16x16x32_bf16 v[180:183], a[176:179], a[84:87], v[180:183]
    s_waitcnt lgkmcnt(9)
    buffer_load_dwordx4 a[136:139], v51, s[24:27], s46 offen offset:2176 sc1
    v_mfma_f32_16x16x32_bf16 v[188:191], a[184:187], a[84:87], v[188:191]
    s_waitcnt lgkmcnt(7)
    ds_read_b64_tr_b16 a[174:175], v13 offset:61440
    ds_read_b64_tr_b16 a[176:177], v14 offset:49152
    v_mfma_f32_16x16x32_bf16 v[188:191], a[188:191], a[92:95], v[188:191]
    ds_read_b64_tr_b16 a[178:179], v14 offset:53248
    v_mfma_f32_16x16x32_bf16 v[184:187], a[188:191], a[88:91], v[184:187]
    ds_read_b64_tr_b16 a[180:181], v14 offset:57344
    v_mfma_f32_16x16x32_bf16 v[184:187], a[184:187], a[80:83], v[184:187]
    s_waitcnt vmcnt(25)
    s_waitcnt lgkmcnt(9)
    buffer_load_dwordx4 a[132:135], v51, s[24:27], s43 offen offset:2048 sc1
    v_mfma_f32_16x16x32_bf16 v[128:131], a[160:163], a[96:99], v[128:131]
    s_waitcnt vmcnt(25)
    s_waitcnt lgkmcnt(7)
    ds_read_b64_tr_b16 a[182:183], v14 offset:61440
    ds_read_b64_tr_b16 a[184:185], v15 offset:49152
    v_mfma_f32_16x16x32_bf16 v[128:131], a[164:167], a[104:107], v[128:131]
    s_waitcnt vmcnt(23)
    ds_read_b64_tr_b16 a[186:187], v15 offset:53248
    v_mfma_f32_16x16x32_bf16 v[132:135], a[164:167], a[108:111], v[132:135]
    ds_read_b64_tr_b16 a[188:189], v15 offset:57344
    v_mfma_f32_16x16x32_bf16 v[132:135], a[160:163], a[100:103], v[132:135]
    s_waitcnt lgkmcnt(9)
    buffer_load_dwordx4 a[140:143], v51, s[24:27], s43 offen offset:2176 sc1
    v_mfma_f32_16x16x32_bf16 v[140:143], a[168:171], a[100:103], v[140:143]
    s_waitcnt lgkmcnt(7)
    ds_read_b64_tr_b16 a[190:191], v15 offset:61440
    ds_read_b64_tr_b16 a[160:161], v16 offset:49152
    v_mfma_f32_16x16x32_bf16 v[140:143], a[172:175], a[108:111], v[140:143]
    ds_read_b64_tr_b16 a[162:163], v16 offset:53248
    v_mfma_f32_16x16x32_bf16 v[136:139], a[172:175], a[104:107], v[136:139]
    ds_read_b64_tr_b16 a[164:165], v16 offset:57344
    v_mfma_f32_16x16x32_bf16 v[136:139], a[168:171], a[96:99], v[136:139]
    s_waitcnt lgkmcnt(9)
    ds_read_b64_tr_b16 a[166:167], v16 offset:61440
    v_mfma_f32_16x16x32_bf16 v[144:147], a[176:179], a[96:99], v[144:147]
    s_waitcnt lgkmcnt(8)
    ds_read_b64_tr_b16 a[168:169], v17 offset:49152
    v_mfma_f32_16x16x32_bf16 v[144:147], a[180:183], a[104:107], v[144:147]
    ds_read_b64_tr_b16 a[170:171], v17 offset:53248
    v_mfma_f32_16x16x32_bf16 v[148:151], a[180:183], a[108:111], v[148:151]
    ds_read_b64_tr_b16 a[172:173], v17 offset:57344
    v_mfma_f32_16x16x32_bf16 v[148:151], a[176:179], a[100:103], v[148:151]
    s_waitcnt lgkmcnt(9)
    ds_read_b64_tr_b16 a[174:175], v17 offset:61440
    v_mfma_f32_16x16x32_bf16 v[156:159], a[184:187], a[100:103], v[156:159]
    s_waitcnt lgkmcnt(8)
    ds_read_b64_tr_b16 a[176:177], v18 offset:49152
    v_mfma_f32_16x16x32_bf16 v[156:159], a[188:191], a[108:111], v[156:159]
    ds_read_b64_tr_b16 a[178:179], v18 offset:53248
    v_mfma_f32_16x16x32_bf16 v[152:155], a[188:191], a[104:107], v[152:155]
    ds_read_b64_tr_b16 a[180:181], v18 offset:57344
    v_mfma_f32_16x16x32_bf16 v[152:155], a[184:187], a[96:99], v[152:155]
    s_waitcnt lgkmcnt(9)
    ds_read_b64_tr_b16 a[182:183], v18 offset:61440
    v_mfma_f32_16x16x32_bf16 v[160:163], a[160:163], a[96:99], v[160:163]
    s_waitcnt lgkmcnt(8)
    ds_read_b64_tr_b16 a[184:185], v19 offset:49152
    v_mfma_f32_16x16x32_bf16 v[160:163], a[164:167], a[104:107], v[160:163]
    ds_read_b64_tr_b16 a[186:187], v19 offset:53248
    v_mfma_f32_16x16x32_bf16 v[164:167], a[164:167], a[108:111], v[164:167]
    ds_read_b64_tr_b16 a[188:189], v19 offset:57344
    v_mfma_f32_16x16x32_bf16 v[164:167], a[160:163], a[100:103], v[164:167]
    s_waitcnt lgkmcnt(9)
    ds_read_b64_tr_b16 a[190:191], v19 offset:61440
    s_waitcnt vmcnt(16)
    s_barrier
    v_mfma_f32_16x16x32_bf16 v[172:175], a[168:171], a[100:103], v[172:175]
    s_waitcnt lgkmcnt(8)
    ds_read_b64_tr_b16 a[160:161], v20 offset:0
    v_mfma_f32_16x16x32_bf16 v[172:175], a[172:175], a[108:111], v[172:175]
    s_add_u32 s49, s44, 3670272
    ds_read_b64_tr_b16 a[162:163], v20 offset:4096
    v_mfma_f32_16x16x32_bf16 v[168:171], a[172:175], a[104:107], v[168:171]
    s_add_u32 m0, s42, 131072
    ds_read_b64_tr_b16 a[164:165], v20 offset:8192
    v_mfma_f32_16x16x32_bf16 v[168:171], a[168:171], a[96:99], v[168:171]
    s_waitcnt lgkmcnt(9)
    buffer_load_dwordx4 v42, s[16:19], s49 offen lds
    v_mfma_f32_16x16x32_bf16 v[176:179], a[176:179], a[96:99], v[176:179]
    s_waitcnt lgkmcnt(7)
    ds_read_b64_tr_b16 a[166:167], v20 offset:12288
    ds_read_b64_tr_b16 a[168:169], v21 offset:0
    v_mfma_f32_16x16x32_bf16 v[176:179], a[180:183], a[104:107], v[176:179]
    ds_read_b64_tr_b16 a[170:171], v21 offset:4096
    v_mfma_f32_16x16x32_bf16 v[180:183], a[180:183], a[108:111], v[180:183]
    ds_read_b64_tr_b16 a[172:173], v21 offset:8192
    v_mfma_f32_16x16x32_bf16 v[180:183], a[176:179], a[100:103], v[180:183]
    s_waitcnt lgkmcnt(9)
    buffer_load_dwordx4 v43, s[16:19], s49 offen offset:1024 lds
    v_mfma_f32_16x16x32_bf16 v[188:191], a[184:187], a[100:103], v[188:191]
    s_waitcnt lgkmcnt(7)
    ds_read_b64_tr_b16 a[174:175], v21 offset:12288
    ds_read_b64_tr_b16 a[176:177], v22 offset:0
    v_mfma_f32_16x16x32_bf16 v[188:191], a[188:191], a[108:111], v[188:191]
    ds_read_b64_tr_b16 a[178:179], v22 offset:4096
    v_mfma_f32_16x16x32_bf16 v[184:187], a[188:191], a[104:107], v[184:187]
    ds_read_b64_tr_b16 a[180:181], v22 offset:8192
    v_mfma_f32_16x16x32_bf16 v[184:187], a[184:187], a[96:99], v[184:187]
    s_waitcnt vmcnt(17)
    s_waitcnt lgkmcnt(9)
    buffer_load_dwordx4 v44, s[16:19], s49 offen offset:2048 lds
    v_mfma_f32_16x16x32_bf16 v[128:131], a[160:163], a[112:115], v[128:131]
    s_waitcnt vmcnt(17)
    s_waitcnt lgkmcnt(7)
    ds_read_b64_tr_b16 a[182:183], v22 offset:12288
    ds_read_b64_tr_b16 a[184:185], v23 offset:0
    v_mfma_f32_16x16x32_bf16 v[128:131], a[164:167], a[120:123], v[128:131]
    s_waitcnt vmcnt(15)
    ds_read_b64_tr_b16 a[186:187], v23 offset:4096
    v_mfma_f32_16x16x32_bf16 v[132:135], a[164:167], a[124:127], v[132:135]
    ds_read_b64_tr_b16 a[188:189], v23 offset:8192
    v_mfma_f32_16x16x32_bf16 v[132:135], a[160:163], a[116:119], v[132:135]
    s_waitcnt lgkmcnt(9)
    buffer_load_dwordx4 v45, s[16:19], s49 offen offset:3072 lds
    v_mfma_f32_16x16x32_bf16 v[140:143], a[168:171], a[116:119], v[140:143]
    s_waitcnt lgkmcnt(7)
    ds_read_b64_tr_b16 a[190:191], v23 offset:12288
    ds_read_b64_tr_b16 a[160:161], v24 offset:0
    v_mfma_f32_16x16x32_bf16 v[140:143], a[172:175], a[124:127], v[140:143]
    s_add_u32 s49, s44, 4194560
    ds_read_b64_tr_b16 a[162:163], v24 offset:4096
    v_mfma_f32_16x16x32_bf16 v[136:139], a[172:175], a[120:123], v[136:139]
    s_add_u32 m0, s42, 147456
    ds_read_b64_tr_b16 a[164:165], v24 offset:8192
    v_mfma_f32_16x16x32_bf16 v[136:139], a[168:171], a[112:115], v[136:139]
    s_waitcnt lgkmcnt(9)
    buffer_load_dwordx4 v42, s[16:19], s49 offen lds
    v_mfma_f32_16x16x32_bf16 v[144:147], a[176:179], a[112:115], v[144:147]
    s_waitcnt lgkmcnt(7)
    ds_read_b64_tr_b16 a[166:167], v24 offset:12288
    ds_read_b64_tr_b16 a[168:169], v25 offset:0
    v_mfma_f32_16x16x32_bf16 v[144:147], a[180:183], a[120:123], v[144:147]
    ds_read_b64_tr_b16 a[170:171], v25 offset:4096
    v_mfma_f32_16x16x32_bf16 v[148:151], a[180:183], a[124:127], v[148:151]
    ds_read_b64_tr_b16 a[172:173], v25 offset:8192
    v_mfma_f32_16x16x32_bf16 v[148:151], a[176:179], a[116:119], v[148:151]
    s_waitcnt lgkmcnt(9)
    buffer_load_dwordx4 v43, s[16:19], s49 offen offset:1024 lds
    v_mfma_f32_16x16x32_bf16 v[156:159], a[184:187], a[116:119], v[156:159]
    s_waitcnt lgkmcnt(7)
    ds_read_b64_tr_b16 a[174:175], v25 offset:12288
    ds_read_b64_tr_b16 a[176:177], v26 offset:0
    v_mfma_f32_16x16x32_bf16 v[156:159], a[188:191], a[124:127], v[156:159]
    ds_read_b64_tr_b16 a[178:179], v26 offset:4096
    v_mfma_f32_16x16x32_bf16 v[152:155], a[188:191], a[120:123], v[152:155]
    ds_read_b64_tr_b16 a[180:181], v26 offset:8192
    v_mfma_f32_16x16x32_bf16 v[152:155], a[184:187], a[112:115], v[152:155]
    s_waitcnt lgkmcnt(9)
    buffer_load_dwordx4 v44, s[16:19], s49 offen offset:2048 lds
    v_mfma_f32_16x16x32_bf16 v[160:163], a[160:163], a[112:115], v[160:163]
    s_waitcnt lgkmcnt(7)
    ds_read_b64_tr_b16 a[182:183], v26 offset:12288
    ds_read_b64_tr_b16 a[184:185], v27 offset:0
    v_mfma_f32_16x16x32_bf16 v[160:163], a[164:167], a[120:123], v[160:163]
    ds_read_b64_tr_b16 a[186:187], v27 offset:4096
    v_mfma_f32_16x16x32_bf16 v[164:167], a[164:167], a[124:127], v[164:167]
    ds_read_b64_tr_b16 a[188:189], v27 offset:8192
    v_mfma_f32_16x16x32_bf16 v[164:167], a[160:163], a[116:119], v[164:167]
    s_waitcnt lgkmcnt(9)
    buffer_load_dwordx4 v45, s[16:19], s49 offen offset:3072 lds
    v_mfma_f32_16x16x32_bf16 v[172:175], a[168:171], a[116:119], v[172:175]
    s_waitcnt lgkmcnt(7)
    ds_read_b64_tr_b16 a[190:191], v27 offset:12288
    ds_read_b64_tr_b16 a[160:161], v20 offset:16384
    v_mfma_f32_16x16x32_bf16 v[172:175], a[172:175], a[124:127], v[172:175]
    ds_read_b64_tr_b16 a[162:163], v20 offset:20480
    v_mfma_f32_16x16x32_bf16 v[168:171], a[172:175], a[120:123], v[168:171]
    ds_read_b64_tr_b16 a[164:165], v20 offset:24576
    v_mfma_f32_16x16x32_bf16 v[168:171], a[168:171], a[112:115], v[168:171]
    s_waitcnt lgkmcnt(9)
    buffer_load_dword v78, v120, s[8:11], 0 offen
    v_mfma_f32_16x16x32_bf16 v[176:179], a[176:179], a[112:115], v[176:179]
    s_waitcnt lgkmcnt(7)
    ds_read_b64_tr_b16 a[166:167], v20 offset:28672
    ds_read_b64_tr_b16 a[168:169], v21 offset:16384
    v_mfma_f32_16x16x32_bf16 v[176:179], a[180:183], a[120:123], v[176:179]
    ds_read_b64_tr_b16 a[170:171], v21 offset:20480
    v_mfma_f32_16x16x32_bf16 v[180:183], a[180:183], a[124:127], v[180:183]
    ds_read_b64_tr_b16 a[172:173], v21 offset:24576
    v_mfma_f32_16x16x32_bf16 v[180:183], a[176:179], a[116:119], v[180:183]
    s_waitcnt lgkmcnt(9)
    buffer_load_dword v79, v121, s[12:15], 0 offen
    v_mfma_f32_16x16x32_bf16 v[188:191], a[184:187], a[116:119], v[188:191]
    s_waitcnt lgkmcnt(7)
    ds_read_b64_tr_b16 a[174:175], v21 offset:28672
    ds_read_b64_tr_b16 a[176:177], v22 offset:16384
    v_mfma_f32_16x16x32_bf16 v[188:191], a[188:191], a[124:127], v[188:191]
    ds_read_b64_tr_b16 a[178:179], v22 offset:20480
    v_mfma_f32_16x16x32_bf16 v[184:187], a[188:191], a[120:123], v[184:187]
    s_mov_b32 s36, 1040356334
    ds_read_b64_tr_b16 a[180:181], v22 offset:24576
    v_mfma_f32_16x16x32_bf16 v[184:187], a[184:187], a[112:115], v[184:187]
    s_waitcnt vmcnt(13)
    s_waitcnt lgkmcnt(9)
    buffer_store_dword v76, v72, s[24:27], s92 offen offset:12 sc1
    v_mfma_f32_16x16x32_bf16 v[128:131], a[160:163], a[128:131], v[128:131]
    s_waitcnt vmcnt(13)
    s_waitcnt lgkmcnt(7)
    ds_read_b64_tr_b16 a[182:183], v22 offset:28672
    ds_read_b64_tr_b16 a[184:185], v23 offset:16384
    v_mfma_f32_16x16x32_bf16 v[128:131], a[164:167], a[136:139], v[128:131]
    s_waitcnt vmcnt(11)
    ds_read_b64_tr_b16 a[186:187], v23 offset:20480
    v_mfma_f32_16x16x32_bf16 v[132:135], a[164:167], a[140:143], v[132:135]
    ds_read_b64_tr_b16 a[188:189], v23 offset:24576
    v_mfma_f32_16x16x32_bf16 v[132:135], a[160:163], a[132:135], v[132:135]
    s_waitcnt lgkmcnt(9)
    buffer_store_dwordx4 v[88:91], v74, s[24:27], 0 offen sc1
    v_mfma_f32_16x16x32_bf16 v[140:143], a[168:171], a[132:135], v[140:143]
    s_waitcnt lgkmcnt(7)
    ds_read_b64_tr_b16 a[190:191], v23 offset:28672
    ds_read_b64_tr_b16 a[160:161], v24 offset:16384
    v_mfma_f32_16x16x32_bf16 v[140:143], a[172:175], a[140:143], v[140:143]
    ds_read_b64_tr_b16 a[162:163], v24 offset:20480
    v_mfma_f32_16x16x32_bf16 v[136:139], a[172:175], a[136:139], v[136:139]
    ds_read_b64_tr_b16 a[164:165], v24 offset:24576
    v_mfma_f32_16x16x32_bf16 v[136:139], a[168:171], a[128:131], v[136:139]
    s_waitcnt lgkmcnt(9)
    ds_read_b64_tr_b16 a[166:167], v24 offset:28672
    v_mfma_f32_16x16x32_bf16 v[144:147], a[176:179], a[128:131], v[144:147]
    s_waitcnt lgkmcnt(8)
    ds_read_b64_tr_b16 a[168:169], v25 offset:16384
    v_mfma_f32_16x16x32_bf16 v[144:147], a[180:183], a[136:139], v[144:147]
    ds_read_b64_tr_b16 a[170:171], v25 offset:20480
    v_mfma_f32_16x16x32_bf16 v[148:151], a[180:183], a[140:143], v[148:151]
    ds_read_b64_tr_b16 a[172:173], v25 offset:24576
    v_mfma_f32_16x16x32_bf16 v[148:151], a[176:179], a[132:135], v[148:151]
    s_waitcnt lgkmcnt(9)
    ds_read_b64_tr_b16 a[174:175], v25 offset:28672
    v_mul_f32 v128, s36, v128
    v_mfma_f32_16x16x32_bf16 v[156:159], a[184:187], a[132:135], v[156:159]
    s_waitcnt lgkmcnt(8)
    ds_read_b64_tr_b16 a[176:177], v26 offset:16384
    v_mul_f32 v129, s36, v129
    v_mfma_f32_16x16x32_bf16 v[156:159], a[188:191], a[140:143], v[156:159]
    ds_read_b64_tr_b16 a[178:179], v26 offset:20480
    v_mul_f32 v130, s36, v130
    v_mfma_f32_16x16x32_bf16 v[152:155], a[188:191], a[136:139], v[152:155]
    ds_read_b64_tr_b16 a[180:181], v26 offset:24576
    v_mul_f32 v131, s36, v131
    v_mfma_f32_16x16x32_bf16 v[152:155], a[184:187], a[128:131], v[152:155]
    s_waitcnt lgkmcnt(9)
    ds_read_b64_tr_b16 a[182:183], v26 offset:28672
    v_mul_f32 v136, s36, v136
    v_mfma_f32_16x16x32_bf16 v[160:163], a[160:163], a[128:131], v[160:163]
    s_waitcnt lgkmcnt(8)
    ds_read_b64_tr_b16 a[184:185], v27 offset:16384
    v_mul_f32 v137, s36, v137
    v_mfma_f32_16x16x32_bf16 v[160:163], a[164:167], a[136:139], v[160:163]
    ds_read_b64_tr_b16 a[186:187], v27 offset:20480
    v_mul_f32 v138, s36, v138
    v_mfma_f32_16x16x32_bf16 v[164:167], a[164:167], a[140:143], v[164:167]
    ds_read_b64_tr_b16 a[188:189], v27 offset:24576
    v_mul_f32 v139, s36, v139
    v_mfma_f32_16x16x32_bf16 v[164:167], a[160:163], a[132:135], v[164:167]
    s_waitcnt lgkmcnt(9)
    ds_read_b64_tr_b16 a[190:191], v27 offset:28672
    v_mul_f32 v132, s36, v132
    s_barrier
    v_mfma_f32_16x16x32_bf16 v[172:175], a[168:171], a[132:135], v[172:175]
    s_waitcnt lgkmcnt(8)
    ds_read_b64_tr_b16 a[160:161], v20 offset:32768
    v_mul_f32 v133, s36, v133
    v_mfma_f32_16x16x32_bf16 v[172:175], a[172:175], a[140:143], v[172:175]
    ds_read_b64_tr_b16 a[162:163], v20 offset:36864
    v_mul_f32 v134, s36, v134
    v_mfma_f32_16x16x32_bf16 v[168:171], a[172:175], a[136:139], v[168:171]
    s_add_u32 m0, s42, 0
    ds_read_b64_tr_b16 a[164:165], v20 offset:40960
    v_mul_f32 v135, s36, v135
    v_mfma_f32_16x16x32_bf16 v[168:171], a[168:171], a[128:131], v[168:171]
    s_waitcnt lgkmcnt(9)
    buffer_load_dwordx4 v36, s[8:11], s40 offen lds
    v_mfma_f32_16x16x32_bf16 v[176:179], a[176:179], a[128:131], v[176:179]
    s_waitcnt lgkmcnt(7)
    ds_read_b64_tr_b16 a[166:167], v20 offset:45056
    ds_read_b64_tr_b16 a[168:169], v21 offset:32768
    v_mfma_f32_16x16x32_bf16 v[176:179], a[180:183], a[136:139], v[176:179]
    ds_read_b64_tr_b16 a[170:171], v21 offset:36864
    v_mul_f32 v140, s36, v140
    v_mfma_f32_16x16x32_bf16 v[180:183], a[180:183], a[140:143], v[180:183]
    ds_read_b64_tr_b16 a[172:173], v21 offset:40960
    v_mul_f32 v141, s36, v141
    v_mfma_f32_16x16x32_bf16 v[180:183], a[176:179], a[132:135], v[180:183]
    s_waitcnt lgkmcnt(9)
    buffer_load_dwordx4 v37, s[8:11], s40 offen offset:1024 lds
    v_mfma_f32_16x16x32_bf16 v[188:191], a[184:187], a[132:135], v[188:191]
    s_waitcnt lgkmcnt(7)
    ds_read_b64_tr_b16 a[174:175], v21 offset:45056
    ds_read_b64_tr_b16 a[176:177], v22 offset:32768
    v_mfma_f32_16x16x32_bf16 v[188:191], a[188:191], a[140:143], v[188:191]
    ds_read_b64_tr_b16 a[178:179], v22 offset:36864
    v_mul_f32 v142, s36, v142
    v_mfma_f32_16x16x32_bf16 v[184:187], a[188:191], a[136:139], v[184:187]
    ds_read_b64_tr_b16 a[180:181], v22 offset:40960
    v_mul_f32 v143, s36, v143
    v_mfma_f32_16x16x32_bf16 v[184:187], a[184:187], a[128:131], v[184:187]
    s_waitcnt lgkmcnt(9)
    buffer_load_dwordx4 v38, s[8:11], s40 offen offset:2048 lds
    v_mfma_f32_16x16x32_bf16 v[192:195], a[160:163], a[80:83], v[192:195]
    s_waitcnt lgkmcnt(7)
    ds_read_b64_tr_b16 a[182:183], v22 offset:45056
    ds_read_b64_tr_b16 a[184:185], v23 offset:32768
    v_mfma_f32_16x16x32_bf16 v[192:195], a[164:167], a[88:91], v[192:195]
Ltour0_2:
    s_cbranch_execz Ltour0_6
    ds_read_b64_tr_b16 a[186:187], v23 offset:36864
    v_cvt_pk_bf16_f32 v64, v128, v129
    v_mfma_f32_16x16x32_bf16 v[196:199], a[164:167], a[92:95], v[196:199]
    ds_read_b64_tr_b16 a[188:189], v23 offset:40960
    v_cvt_pk_bf16_f32 v65, v130, v131
    v_mfma_f32_16x16x32_bf16 v[196:199], a[160:163], a[84:87], v[196:199]
    s_waitcnt lgkmcnt(9)
    buffer_load_dwordx4 v39, s[8:11], s40 offen offset:3072 lds
    v_mfma_f32_16x16x32_bf16 v[204:207], a[168:171], a[84:87], v[204:207]
    s_waitcnt lgkmcnt(7)
    s_add_u32 s40, s40, 16384
    ds_read_b64_tr_b16 a[190:191], v23 offset:45056
    ds_read_b64_tr_b16 a[160:161], v24 offset:32768
    v_mfma_f32_16x16x32_bf16 v[204:207], a[172:175], a[92:95], v[204:207]
    ds_read_b64_tr_b16 a[162:163], v24 offset:36864
    v_cvt_pk_bf16_f32 v66, v136, v137
    v_mfma_f32_16x16x32_bf16 v[200:203], a[172:175], a[88:91], v[200:203]
    s_add_u32 m0, s42, 16384
    ds_read_b64_tr_b16 a[164:165], v24 offset:40960
    v_cvt_pk_bf16_f32 v67, v138, v139
    v_mfma_f32_16x16x32_bf16 v[200:203], a[168:171], a[80:83], v[200:203]
    s_waitcnt lgkmcnt(9)
    buffer_load_dwordx4 v36, s[8:11], s40 offen lds
    v_mfma_f32_16x16x32_bf16 v[208:211], a[176:179], a[80:83], v[208:211]
    s_waitcnt lgkmcnt(7)
    ds_read_b64_tr_b16 a[166:167], v24 offset:45056
    ds_read_b64_tr_b16 a[168:169], v25 offset:32768
    v_mfma_f32_16x16x32_bf16 v[208:211], a[180:183], a[88:91], v[208:211]
    ds_read_b64_tr_b16 a[170:171], v25 offset:36864
    v_cvt_pk_bf16_f32 v80, v132, v133
    v_mfma_f32_16x16x32_bf16 v[212:215], a[180:183], a[92:95], v[212:215]
    ds_read_b64_tr_b16 a[172:173], v25 offset:40960
    v_cvt_pk_bf16_f32 v81, v134, v135
    v_mfma_f32_16x16x32_bf16 v[212:215], a[176:179], a[84:87], v[212:215]
    s_waitcnt lgkmcnt(9)
    buffer_load_dwordx4 v37, s[8:11], s40 offen offset:1024 lds
    v_mfma_f32_16x16x32_bf16 v[220:223], a[184:187], a[84:87], v[220:223]
    s_waitcnt lgkmcnt(7)
    ds_read_b64_tr_b16 a[174:175], v25 offset:45056
    ds_read_b64_tr_b16 a[176:177], v26 offset:32768
    v_mfma_f32_16x16x32_bf16 v[220:223], a[188:191], a[92:95], v[220:223]
    ds_read_b64_tr_b16 a[178:179], v26 offset:36864
    v_cvt_pk_bf16_f32 v82, v140, v141
    v_mfma_f32_16x16x32_bf16 v[216:219], a[188:191], a[88:91], v[216:219]
    ds_read_b64_tr_b16 a[180:181], v26 offset:40960
    v_cvt_pk_bf16_f32 v83, v142, v143
    v_mfma_f32_16x16x32_bf16 v[216:219], a[184:187], a[80:83], v[216:219]
    s_waitcnt lgkmcnt(9)
    buffer_load_dwordx4 v38, s[8:11], s40 offen offset:2048 lds
    v_mfma_f32_16x16x32_bf16 v[224:227], a[160:163], a[80:83], v[224:227]
    s_waitcnt lgkmcnt(7)
    ds_read_b64_tr_b16 a[182:183], v26 offset:45056
    ds_read_b64_tr_b16 a[184:185], v27 offset:32768
    v_mfma_f32_16x16x32_bf16 v[224:227], a[164:167], a[88:91], v[224:227]
    ds_read_b64_tr_b16 a[186:187], v27 offset:36864
    v_permlane32_swap_b32 v64, v66
    v_mfma_f32_16x16x32_bf16 v[228:231], a[164:167], a[92:95], v[228:231]
    ds_read_b64_tr_b16 a[188:189], v27 offset:40960
    v_permlane32_swap_b32 v65, v67
    v_mfma_f32_16x16x32_bf16 v[228:231], a[160:163], a[84:87], v[228:231]
    s_waitcnt lgkmcnt(9)
    buffer_load_dwordx4 v39, s[8:11], s40 offen offset:3072 lds
    v_mfma_f32_16x16x32_bf16 v[236:239], a[168:171], a[84:87], v[236:239]
    s_waitcnt lgkmcnt(7)
    s_add_u32 s40, s40, 16384
    ds_read_b64_tr_b16 a[190:191], v27 offset:45056
    ds_read_b64_tr_b16 a[160:161], v20 offset:49152
    v_mfma_f32_16x16x32_bf16 v[236:239], a[172:175], a[92:95], v[236:239]
    ds_read_b64_tr_b16 a[162:163], v20 offset:53248
    v_permlane32_swap_b32 v80, v82
    v_mfma_f32_16x16x32_bf16 v[232:235], a[172:175], a[88:91], v[232:235]
    ds_read_b64_tr_b16 a[164:165], v20 offset:57344
    v_permlane32_swap_b32 v81, v83
    v_mfma_f32_16x16x32_bf16 v[232:235], a[168:171], a[80:83], v[232:235]
    s_waitcnt lgkmcnt(9)
    ds_read_b64_tr_b16 a[166:167], v20 offset:61440
    v_permlane16_swap_b32 v64, v66
    v_mfma_f32_16x16x32_bf16 v[240:243], a[176:179], a[80:83], v[240:243]
    s_waitcnt lgkmcnt(8)
    ds_read_b64_tr_b16 a[168:169], v21 offset:49152
    v_permlane16_swap_b32 v65, v67
    v_mfma_f32_16x16x32_bf16 v[240:243], a[180:183], a[88:91], v[240:243]
    ds_read_b64_tr_b16 a[170:171], v21 offset:53248
    v_permlane16_swap_b32 v80, v82
    v_mfma_f32_16x16x32_bf16 v[244:247], a[180:183], a[92:95], v[244:247]
    ds_read_b64_tr_b16 a[172:173], v21 offset:57344
    v_permlane16_swap_b32 v81, v83
    v_mfma_f32_16x16x32_bf16 v[244:247], a[176:179], a[84:87], v[244:247]
    s_waitcnt lgkmcnt(9)
    ds_read_b64_tr_b16 a[174:175], v21 offset:61440
    v_mul_f32 v144, s36, v144
    v_mfma_f32_16x16x32_bf16 v[252:255], a[184:187], a[84:87], v[252:255]
    s_waitcnt lgkmcnt(8)
    ds_read_b64_tr_b16 a[176:177], v22 offset:49152
    v_mul_f32 v145, s36, v145
    v_mfma_f32_16x16x32_bf16 v[252:255], a[188:191], a[92:95], v[252:255]
    ds_read_b64_tr_b16 a[178:179], v22 offset:53248
    v_mul_f32 v146, s36, v146
    v_mfma_f32_16x16x32_bf16 v[248:251], a[188:191], a[88:91], v[248:251]
    ds_read_b64_tr_b16 a[180:181], v22 offset:57344
    v_mul_f32 v147, s36, v147
    v_mfma_f32_16x16x32_bf16 v[248:251], a[184:187], a[80:83], v[248:251]
    s_waitcnt lgkmcnt(9)
    ds_read_b64_tr_b16 a[182:183], v22 offset:61440
    v_mul_f32 v152, s36, v152
    v_mfma_f32_16x16x32_bf16 v[192:195], a[160:163], a[96:99], v[192:195]
    s_waitcnt lgkmcnt(8)
    ds_read_b64_tr_b16 a[184:185], v23 offset:49152
    v_mul_f32 v153, s36, v153
    v_mfma_f32_16x16x32_bf16 v[192:195], a[164:167], a[104:107], v[192:195]
    ds_read_b64_tr_b16 a[186:187], v23 offset:53248
    v_mul_f32 v154, s36, v154
    v_mfma_f32_16x16x32_bf16 v[196:199], a[164:167], a[108:111], v[196:199]
    ds_read_b64_tr_b16 a[188:189], v23 offset:57344
    v_mul_f32 v155, s36, v155
    v_mfma_f32_16x16x32_bf16 v[196:199], a[160:163], a[100:103], v[196:199]
    s_waitcnt lgkmcnt(9)
    ds_read_b64_tr_b16 a[190:191], v23 offset:61440
    v_mul_f32 v148, s36, v148
    v_mfma_f32_16x16x32_bf16 v[204:207], a[168:171], a[100:103], v[204:207]
    s_waitcnt lgkmcnt(8)
    ds_read_b64_tr_b16 a[160:161], v24 offset:49152
    v_mul_f32 v149, s36, v149
    v_mfma_f32_16x16x32_bf16 v[204:207], a[172:175], a[108:111], v[204:207]
    ds_read_b64_tr_b16 a[162:163], v24 offset:53248
    v_mul_f32 v150, s36, v150
    v_mfma_f32_16x16x32_bf16 v[200:203], a[172:175], a[104:107], v[200:203]
    ds_read_b64_tr_b16 a[164:165], v24 offset:57344
    v_mul_f32 v151, s36, v151
    v_mfma_f32_16x16x32_bf16 v[200:203], a[168:171], a[96:99], v[200:203]
    s_waitcnt lgkmcnt(9)
    ds_read_b64_tr_b16 a[166:167], v24 offset:61440
    v_mul_f32 v156, s36, v156
    v_mfma_f32_16x16x32_bf16 v[208:211], a[176:179], a[96:99], v[208:211]
    s_waitcnt lgkmcnt(8)
    ds_read_b64_tr_b16 a[168:169], v25 offset:49152
    v_mul_f32 v157, s36, v157
    v_mfma_f32_16x16x32_bf16 v[208:211], a[180:183], a[104:107], v[208:211]
    ds_read_b64_tr_b16 a[170:171], v25 offset:53248
    v_mul_f32 v158, s36, v158
    v_mfma_f32_16x16x32_bf16 v[212:215], a[180:183], a[108:111], v[212:215]
    ds_read_b64_tr_b16 a[172:173], v25 offset:57344
    v_mul_f32 v159, s36, v159
    v_mfma_f32_16x16x32_bf16 v[212:215], a[176:179], a[100:103], v[212:215]
    s_waitcnt lgkmcnt(9)
    ds_read_b64_tr_b16 a[174:175], v25 offset:61440
    v_cvt_pk_bf16_f32 v68, v144, v145
    v_mfma_f32_16x16x32_bf16 v[220:223], a[184:187], a[100:103], v[220:223]
    s_waitcnt lgkmcnt(8)
    ds_read_b64_tr_b16 a[176:177], v26 offset:49152
    v_cvt_pk_bf16_f32 v69, v146, v147
    v_mfma_f32_16x16x32_bf16 v[220:223], a[188:191], a[108:111], v[220:223]
    ds_read_b64_tr_b16 a[178:179], v26 offset:53248
    v_cvt_pk_bf16_f32 v70, v152, v153
    v_mfma_f32_16x16x32_bf16 v[216:219], a[188:191], a[104:107], v[216:219]
    ds_read_b64_tr_b16 a[180:181], v26 offset:57344
    v_cvt_pk_bf16_f32 v71, v154, v155
    v_mfma_f32_16x16x32_bf16 v[216:219], a[184:187], a[96:99], v[216:219]
    s_waitcnt lgkmcnt(9)
    ds_read_b64_tr_b16 a[182:183], v26 offset:61440
    v_cvt_pk_bf16_f32 v84, v148, v149
    v_mfma_f32_16x16x32_bf16 v[224:227], a[160:163], a[96:99], v[224:227]
    s_waitcnt lgkmcnt(8)
    ds_read_b64_tr_b16 a[184:185], v27 offset:49152
    v_cvt_pk_bf16_f32 v85, v150, v151
    v_mfma_f32_16x16x32_bf16 v[224:227], a[164:167], a[104:107], v[224:227]
    ds_read_b64_tr_b16 a[186:187], v27 offset:53248
    v_cvt_pk_bf16_f32 v86, v156, v157
    v_mfma_f32_16x16x32_bf16 v[228:231], a[164:167], a[108:111], v[228:231]
    ds_read_b64_tr_b16 a[188:189], v27 offset:57344
    v_cvt_pk_bf16_f32 v87, v158, v159
    v_mfma_f32_16x16x32_bf16 v[228:231], a[160:163], a[100:103], v[228:231]
    s_waitcnt lgkmcnt(9)
    ds_read_b64_tr_b16 a[190:191], v27 offset:61440
    v_permlane32_swap_b32 v68, v70
    s_waitcnt vmcnt(12)
    s_barrier
    v_mfma_f32_16x16x32_bf16 v[236:239], a[168:171], a[100:103], v[236:239]
    s_waitcnt lgkmcnt(8)
    ds_read_b64_tr_b16 a[160:161], v28 offset:0
    v_permlane32_swap_b32 v69, v71
    v_mfma_f32_16x16x32_bf16 v[236:239], a[172:175], a[108:111], v[236:239]
    ds_read_b64_tr_b16 a[162:163], v28 offset:4096
    v_permlane32_swap_b32 v84, v86
    v_mfma_f32_16x16x32_bf16 v[232:235], a[172:175], a[104:107], v[232:235]
    s_add_u32 m0, s42, 32768
    ds_read_b64_tr_b16 a[164:165], v28 offset:8192
    v_permlane32_swap_b32 v85, v87
    v_mfma_f32_16x16x32_bf16 v[232:235], a[168:171], a[96:99], v[232:235]
    s_waitcnt lgkmcnt(9)
    buffer_load_dwordx4 v36, s[8:11], s40 offen lds
    v_mfma_f32_16x16x32_bf16 v[240:243], a[176:179], a[96:99], v[240:243]
    s_waitcnt lgkmcnt(7)
    ds_read_b64_tr_b16 a[166:167], v28 offset:12288
    ds_read_b64_tr_b16 a[168:169], v29 offset:0
    v_mfma_f32_16x16x32_bf16 v[240:243], a[180:183], a[104:107], v[240:243]
    ds_read_b64_tr_b16 a[170:171], v29 offset:4096
    v_permlane16_swap_b32 v68, v70
    v_mfma_f32_16x16x32_bf16 v[244:247], a[180:183], a[108:111], v[244:247]
    ds_read_b64_tr_b16 a[172:173], v29 offset:8192
    v_permlane16_swap_b32 v69, v71
    v_mfma_f32_16x16x32_bf16 v[244:247], a[176:179], a[100:103], v[244:247]
    s_waitcnt lgkmcnt(9)
    buffer_load_dwordx4 v37, s[8:11], s40 offen offset:1024 lds
    v_mfma_f32_16x16x32_bf16 v[252:255], a[184:187], a[100:103], v[252:255]
    s_waitcnt lgkmcnt(7)
    ds_read_b64_tr_b16 a[174:175], v29 offset:12288
    ds_read_b64_tr_b16 a[176:177], v30 offset:0
    v_mfma_f32_16x16x32_bf16 v[252:255], a[188:191], a[108:111], v[252:255]
    ds_read_b64_tr_b16 a[178:179], v30 offset:4096
    v_permlane16_swap_b32 v84, v86
    v_mfma_f32_16x16x32_bf16 v[248:251], a[188:191], a[104:107], v[248:251]
    ds_read_b64_tr_b16 a[180:181], v30 offset:8192
    v_permlane16_swap_b32 v85, v87
    v_mfma_f32_16x16x32_bf16 v[248:251], a[184:187], a[96:99], v[248:251]
    s_waitcnt lgkmcnt(9)
    buffer_load_dwordx4 v38, s[8:11], s40 offen offset:2048 lds
    v_mfma_f32_16x16x32_bf16 v[192:195], a[160:163], a[112:115], v[192:195]
    s_waitcnt lgkmcnt(7)
    ds_read_b64_tr_b16 a[182:183], v30 offset:12288
    ds_read_b64_tr_b16 a[184:185], v31 offset:0
    v_mfma_f32_16x16x32_bf16 v[192:195], a[164:167], a[120:123], v[192:195]
    ds_read_b64_tr_b16 a[186:187], v31 offset:4096
    v_mul_f32 v160, s36, v160
    v_mfma_f32_16x16x32_bf16 v[196:199], a[164:167], a[124:127], v[196:199]
    ds_read_b64_tr_b16 a[188:189], v31 offset:8192
    v_mul_f32 v161, s36, v161
    v_mfma_f32_16x16x32_bf16 v[196:199], a[160:163], a[116:119], v[196:199]
    s_waitcnt lgkmcnt(9)
    buffer_load_dwordx4 v39, s[8:11], s40 offen offset:3072 lds
    v_mfma_f32_16x16x32_bf16 v[204:207], a[168:171], a[116:119], v[204:207]
    s_waitcnt lgkmcnt(7)
    s_add_u32 s40, s40, 16384
    ds_read_b64_tr_b16 a[190:191], v31 offset:12288
    ds_read_b64_tr_b16 a[160:161], v32 offset:0
    v_mfma_f32_16x16x32_bf16 v[204:207], a[172:175], a[124:127], v[204:207]
    ds_read_b64_tr_b16 a[162:163], v32 offset:4096
    v_mul_f32 v162, s36, v162
    v_mfma_f32_16x16x32_bf16 v[200:203], a[172:175], a[120:123], v[200:203]
    s_add_u32 m0, s42, 65536
    ds_read_b64_tr_b16 a[164:165], v32 offset:8192
    v_mul_f32 v163, s36, v163
    v_mfma_f32_16x16x32_bf16 v[200:203], a[168:171], a[112:115], v[200:203]
    s_waitcnt lgkmcnt(9)
    buffer_load_dwordx4 v40, s[12:15], s41 offen lds
    v_mfma_f32_16x16x32_bf16 v[208:211], a[176:179], a[112:115], v[208:211]
    s_waitcnt lgkmcnt(7)
    ds_read_b64_tr_b16 a[166:167], v32 offset:12288
    ds_read_b64_tr_b16 a[168:169], v33 offset:0
    v_mfma_f32_16x16x32_bf16 v[208:211], a[180:183], a[120:123], v[208:211]
    ds_read_b64_tr_b16 a[170:171], v33 offset:4096
    v_mul_f32 v168, s36, v168
    v_mfma_f32_16x16x32_bf16 v[212:215], a[180:183], a[124:127], v[212:215]
    ds_read_b64_tr_b16 a[172:173], v33 offset:8192
    v_mul_f32 v169, s36, v169
    v_mfma_f32_16x16x32_bf16 v[212:215], a[176:179], a[116:119], v[212:215]
    s_waitcnt lgkmcnt(9)
    buffer_load_dwordx4 v41, s[12:15], s41 offen offset:1024 lds
    v_mfma_f32_16x16x32_bf16 v[220:223], a[184:187], a[116:119], v[220:223]
    s_waitcnt lgkmcnt(7)
    ds_read_b64_tr_b16 a[174:175], v33 offset:12288
    ds_read_b64_tr_b16 a[176:177], v34 offset:0
    v_mfma_f32_16x16x32_bf16 v[220:223], a[188:191], a[124:127], v[220:223]
    ds_read_b64_tr_b16 a[178:179], v34 offset:4096
    v_mul_f32 v170, s36, v170
    v_mfma_f32_16x16x32_bf16 v[216:219], a[188:191], a[120:123], v[216:219]
    ds_read_b64_tr_b16 a[180:181], v34 offset:8192
    v_mul_f32 v171, s36, v171
    v_mfma_f32_16x16x32_bf16 v[216:219], a[184:187], a[112:115], v[216:219]
    s_waitcnt lgkmcnt(9)
    buffer_load_dwordx4 v40, s[12:15], s41 offen offset:2048 lds
    v_mfma_f32_16x16x32_bf16 v[224:227], a[160:163], a[112:115], v[224:227]
    s_waitcnt lgkmcnt(7)
    ds_read_b64_tr_b16 a[182:183], v34 offset:12288
    ds_read_b64_tr_b16 a[184:185], v35 offset:0
    v_mfma_f32_16x16x32_bf16 v[224:227], a[164:167], a[120:123], v[224:227]
    ds_read_b64_tr_b16 a[186:187], v35 offset:4096
    v_mul_f32 v164, s36, v164
    v_mfma_f32_16x16x32_bf16 v[228:231], a[164:167], a[124:127], v[228:231]
    ds_read_b64_tr_b16 a[188:189], v35 offset:8192
    v_mul_f32 v165, s36, v165
    v_mfma_f32_16x16x32_bf16 v[228:231], a[160:163], a[116:119], v[228:231]
    s_waitcnt lgkmcnt(9)
    buffer_load_dwordx4 v41, s[12:15], s41 offen offset:3072 lds
    v_mfma_f32_16x16x32_bf16 v[236:239], a[168:171], a[116:119], v[236:239]
    s_waitcnt lgkmcnt(7)
    s_add_u32 s41, s41, 16384
    ds_read_b64_tr_b16 a[190:191], v35 offset:12288
    ds_read_b64_tr_b16 a[160:161], v28 offset:16384
    v_mfma_f32_16x16x32_bf16 v[236:239], a[172:175], a[124:127], v[236:239]
    ds_read_b64_tr_b16 a[162:163], v28 offset:20480
    v_mul_f32 v166, s36, v166
    v_mfma_f32_16x16x32_bf16 v[232:235], a[172:175], a[120:123], v[232:235]
    s_add_u32 m0, s42, 81920
    ds_read_b64_tr_b16 a[164:165], v28 offset:24576
    v_mul_f32 v167, s36, v167
    v_mfma_f32_16x16x32_bf16 v[232:235], a[168:171], a[112:115], v[232:235]
    s_waitcnt lgkmcnt(9)
    buffer_load_dwordx4 v40, s[12:15], s41 offen lds
    v_mfma_f32_16x16x32_bf16 v[240:243], a[176:179], a[112:115], v[240:243]
    s_waitcnt lgkmcnt(7)
    ds_read_b64_tr_b16 a[166:167], v28 offset:28672
    ds_read_b64_tr_b16 a[168:169], v29 offset:16384
    v_mfma_f32_16x16x32_bf16 v[240:243], a[180:183], a[120:123], v[240:243]
    ds_read_b64_tr_b16 a[170:171], v29 offset:20480
    v_mul_f32 v172, s36, v172
    v_mfma_f32_16x16x32_bf16 v[244:247], a[180:183], a[124:127], v[244:247]
    ds_read_b64_tr_b16 a[172:173], v29 offset:24576
    v_mul_f32 v173, s36, v173
    v_mfma_f32_16x16x32_bf16 v[244:247], a[176:179], a[116:119], v[244:247]
    s_waitcnt lgkmcnt(9)
    buffer_load_dwordx4 v41, s[12:15], s41 offen offset:1024 lds
    v_mfma_f32_16x16x32_bf16 v[252:255], a[184:187], a[116:119], v[252:255]
    s_waitcnt lgkmcnt(7)
    ds_read_b64_tr_b16 a[174:175], v29 offset:28672
    ds_read_b64_tr_b16 a[176:177], v30 offset:16384
    v_mfma_f32_16x16x32_bf16 v[252:255], a[188:191], a[124:127], v[252:255]
    ds_read_b64_tr_b16 a[178:179], v30 offset:20480
    v_mul_f32 v174, s36, v174
    v_mfma_f32_16x16x32_bf16 v[248:251], a[188:191], a[120:123], v[248:251]
    ds_read_b64_tr_b16 a[180:181], v30 offset:24576
    v_mul_f32 v175, s36, v175
    v_mfma_f32_16x16x32_bf16 v[248:251], a[184:187], a[112:115], v[248:251]
    s_waitcnt lgkmcnt(9)
    buffer_load_dwordx4 v40, s[12:15], s41 offen offset:2048 lds
    v_mfma_f32_16x16x32_bf16 v[192:195], a[160:163], a[128:131], v[192:195]
    s_waitcnt lgkmcnt(7)
    ds_read_b64_tr_b16 a[182:183], v30 offset:28672
    ds_read_b64_tr_b16 a[184:185], v31 offset:16384
    v_mfma_f32_16x16x32_bf16 v[192:195], a[164:167], a[136:139], v[192:195]
    ds_read_b64_tr_b16 a[186:187], v31 offset:20480
    v_cvt_pk_bf16_f32 v72, v160, v161
    v_mfma_f32_16x16x32_bf16 v[196:199], a[164:167], a[140:143], v[196:199]
    ds_read_b64_tr_b16 a[188:189], v31 offset:24576
    v_cvt_pk_bf16_f32 v73, v162, v163
    v_mfma_f32_16x16x32_bf16 v[196:199], a[160:163], a[132:135], v[196:199]
    s_waitcnt lgkmcnt(9)
    buffer_load_dwordx4 v41, s[12:15], s41 offen offset:3072 lds
    v_mfma_f32_16x16x32_bf16 v[204:207], a[168:171], a[132:135], v[204:207]
    s_waitcnt lgkmcnt(7)
    s_add_u32 s41, s41, 16384
    ds_read_b64_tr_b16 a[190:191], v31 offset:28672
    ds_read_b64_tr_b16 a[160:161], v32 offset:16384
    v_mfma_f32_16x16x32_bf16 v[204:207], a[172:175], a[140:143], v[204:207]
    ds_read_b64_tr_b16 a[162:163], v32 offset:20480
    v_cvt_pk_bf16_f32 v74, v168, v169
    v_mfma_f32_16x16x32_bf16 v[200:203], a[172:175], a[136:139], v[200:203]
    ds_read_b64_tr_b16 a[164:165], v32 offset:24576
    v_cvt_pk_bf16_f32 v75, v170, v171
    v_mfma_f32_16x16x32_bf16 v[200:203], a[168:171], a[128:131], v[200:203]
    s_waitcnt lgkmcnt(9)
    ds_read_b64_tr_b16 a[166:167], v32 offset:28672
    v_cvt_pk_bf16_f32 v88, v164, v165
    v_mfma_f32_16x16x32_bf16 v[208:211], a[176:179], a[128:131], v[208:211]
    s_waitcnt lgkmcnt(8)
    ds_read_b64_tr_b16 a[168:169], v33 offset:16384
    v_cvt_pk_bf16_f32 v89, v166, v167
    v_mfma_f32_16x16x32_bf16 v[208:211], a[180:183], a[136:139], v[208:211]
    ds_read_b64_tr_b16 a[170:171], v33 offset:20480
    v_cvt_pk_bf16_f32 v90, v172, v173
    v_mfma_f32_16x16x32_bf16 v[212:215], a[180:183], a[140:143], v[212:215]
    ds_read_b64_tr_b16 a[172:173], v33 offset:24576
    v_cvt_pk_bf16_f32 v91, v174, v175
    v_mfma_f32_16x16x32_bf16 v[212:215], a[176:179], a[132:135], v[212:215]
    s_waitcnt lgkmcnt(9)
    ds_read_b64_tr_b16 a[174:175], v33 offset:28672
    v_permlane32_swap_b32 v72, v74
    v_mfma_f32_16x16x32_bf16 v[220:223], a[184:187], a[132:135], v[220:223]
    s_waitcnt lgkmcnt(8)
    ds_read_b64_tr_b16 a[176:177], v34 offset:16384
    v_permlane32_swap_b32 v73, v75
    v_mfma_f32_16x16x32_bf16 v[220:223], a[188:191], a[140:143], v[220:223]
    ds_read_b64_tr_b16 a[178:179], v34 offset:20480
    v_permlane32_swap_b32 v88, v90
    v_mfma_f32_16x16x32_bf16 v[216:219], a[188:191], a[136:139], v[216:219]
    ds_read_b64_tr_b16 a[180:181], v34 offset:24576
    v_permlane32_swap_b32 v89, v91
    v_mfma_f32_16x16x32_bf16 v[216:219], a[184:187], a[128:131], v[216:219]
    s_waitcnt lgkmcnt(9)
    ds_read_b64_tr_b16 a[182:183], v34 offset:28672
    v_permlane16_swap_b32 v72, v74
    v_mfma_f32_16x16x32_bf16 v[224:227], a[160:163], a[128:131], v[224:227]
    s_waitcnt lgkmcnt(8)
    ds_read_b64_tr_b16 a[184:185], v35 offset:16384
    v_permlane16_swap_b32 v73, v75
    v_mfma_f32_16x16x32_bf16 v[224:227], a[164:167], a[136:139], v[224:227]
    ds_read_b64_tr_b16 a[186:187], v35 offset:20480
    v_permlane16_swap_b32 v88, v90
    v_mfma_f32_16x16x32_bf16 v[228:231], a[164:167], a[140:143], v[228:231]
    ds_read_b64_tr_b16 a[188:189], v35 offset:24576
    v_permlane16_swap_b32 v89, v91
    v_mfma_f32_16x16x32_bf16 v[228:231], a[160:163], a[132:135], v[228:231]
    s_waitcnt lgkmcnt(9)
    ds_read_b64_tr_b16 a[190:191], v35 offset:28672
    v_mul_f32 v176, s36, v176
    v_mfma_f32_16x16x32_bf16 v[236:239], a[168:171], a[132:135], v[236:239]
    s_waitcnt lgkmcnt(8)
    v_mul_f32 v177, s36, v177
    v_mul_f32 v178, s36, v178
    v_mfma_f32_16x16x32_bf16 v[236:239], a[172:175], a[140:143], v[236:239]
    v_mul_f32 v179, s36, v179
    v_mul_f32 v184, s36, v184
    v_mfma_f32_16x16x32_bf16 v[232:235], a[172:175], a[136:139], v[232:235]
    v_mul_f32 v185, s36, v185
    v_mul_f32 v186, s36, v186
    v_mfma_f32_16x16x32_bf16 v[232:235], a[168:171], a[128:131], v[232:235]
    s_waitcnt lgkmcnt(6)
    v_mul_f32 v187, s36, v187
    v_mul_f32 v180, s36, v180
    s_waitcnt vmcnt(16)
    s_barrier
    v_mfma_f32_16x16x32_bf16 v[240:243], a[176:179], a[128:131], v[240:243]
    s_waitcnt lgkmcnt(4)
    ds_read_b128 a[208:211], v8 offset:0
    v_mul_f32 v181, s36, v181
    v_mfma_f32_16x16x32_bf16 v[240:243], a[180:183], a[136:139], v[240:243]
    ds_read_b128 a[212:215], v9 offset:0
    v_mul_f32 v182, s36, v182
    v_mfma_f32_16x16x32_bf16 v[244:247], a[180:183], a[140:143], v[244:247]
    ds_read_b128 a[216:219], v10 offset:0
    v_mul_f32 v183, s36, v183
    v_mfma_f32_16x16x32_bf16 v[244:247], a[176:179], a[132:135], v[244:247]
    s_waitcnt lgkmcnt(5)
    ds_read_b128 a[220:223], v11 offset:0
    v_mul_f32 v188, s36, v188
    v_mfma_f32_16x16x32_bf16 v[252:255], a[184:187], a[132:135], v[252:255]
    s_waitcnt lgkmcnt(4)
    ds_read_b128 a[224:227], v8 offset:4096
    v_mul_f32 v189, s36, v189
    v_mfma_f32_16x16x32_bf16 v[252:255], a[188:191], a[140:143], v[252:255]
    v_mul_f32 v190, s36, v190
    v_mul_f32 v191, s36, v191
    v_mfma_f32_16x16x32_bf16 v[248:251], a[188:191], a[136:139], v[248:251]
    s_load_dwordx2 s[16:17], s[0:1], 88
    v_cvt_pk_bf16_f32 v76, v176, v177
    v_cvt_pk_bf16_f32 v77, v178, v179
    v_mfma_f32_16x16x32_bf16 v[248:251], a[184:187], a[128:131], v[248:251]
    v_cvt_pk_bf16_f32 v78, v184, v185
    v_cvt_pk_bf16_f32 v79, v186, v187
    v_cvt_pk_bf16_f32 v92, v180, v181
    v_cvt_pk_bf16_f32 v93, v182, v183
    v_cvt_pk_bf16_f32 v94, v188, v189
    v_cvt_pk_bf16_f32 v95, v190, v191
    v_permlane32_swap_b32 v76, v78
    v_permlane32_swap_b32 v77, v79
    v_permlane32_swap_b32 v92, v94
    v_permlane32_swap_b32 v93, v95
    v_permlane16_swap_b32 v76, v78
    v_permlane16_swap_b32 v77, v79
    v_permlane16_swap_b32 v92, v94
    v_permlane16_swap_b32 v93, v95
    s_mov_b32 s36, 1040356334
    s_mov_b32 s37, 1040356334
    v_mov_b32 v58, 0
    v_mov_b32 v59, 0
    v_mov_b32 v60, 0
    v_mov_b32 v61, 0
    v_pk_mul_f32 v[192:193], v[192:193], s[36:37]
    v_pk_mul_f32 v[194:195], v[194:195], s[36:37]
    v_pk_mul_f32 v[200:201], v[200:201], s[36:37]
    v_pk_mul_f32 v[202:203], v[202:203], s[36:37]
    v_pk_mul_f32 v[196:197], v[196:197], s[36:37]
    v_pk_mul_f32 v[198:199], v[198:199], s[36:37]
    v_pk_mul_f32 v[204:205], v[204:205], s[36:37]
    v_pk_mul_f32 v[206:207], v[206:207], s[36:37]
    v_mfma_f32_32x32x16_bf16 a[0:15], v[58:61], v[58:61], 0
    v_cvt_pk_bf16_f32 v96, v192, v193
    v_cvt_pk_bf16_f32 v97, v194, v195
    v_cvt_pk_bf16_f32 v98, v200, v201
    v_cvt_pk_bf16_f32 v99, v202, v203
    v_cvt_pk_bf16_f32 v112, v196, v197
    v_cvt_pk_bf16_f32 v113, v198, v199
    v_cvt_pk_bf16_f32 v114, v204, v205
    v_cvt_pk_bf16_f32 v115, v206, v207
    v_mfma_f32_32x32x16_bf16 a[16:31], v[58:61], v[58:61], 0
    v_permlane32_swap_b32 v96, v98
    v_permlane32_swap_b32 v97, v99
    v_permlane32_swap_b32 v112, v114
    v_permlane32_swap_b32 v113, v115
    v_permlane16_swap_b32 v96, v98
    v_permlane16_swap_b32 v97, v99
    v_permlane16_swap_b32 v112, v114
    v_permlane16_swap_b32 v113, v115
    v_pk_mul_f32 v[208:209], v[208:209], s[36:37]
    v_pk_mul_f32 v[210:211], v[210:211], s[36:37]
    v_pk_mul_f32 v[216:217], v[216:217], s[36:37]
    v_pk_mul_f32 v[218:219], v[218:219], s[36:37]
    v_pk_mul_f32 v[212:213], v[212:213], s[36:37]
    v_pk_mul_f32 v[214:215], v[214:215], s[36:37]
    v_pk_mul_f32 v[220:221], v[220:221], s[36:37]
    v_pk_mul_f32 v[222:223], v[222:223], s[36:37]
    v_mfma_f32_32x32x16_bf16 a[32:47], v[58:61], v[58:61], 0
    v_cvt_pk_bf16_f32 v100, v208, v209
    v_cvt_pk_bf16_f32 v101, v210, v211
    v_cvt_pk_bf16_f32 v102, v216, v217
    v_cvt_pk_bf16_f32 v103, v218, v219
    v_cvt_pk_bf16_f32 v116, v212, v213
    v_cvt_pk_bf16_f32 v117, v214, v215
    v_cvt_pk_bf16_f32 v118, v220, v221
    v_cvt_pk_bf16_f32 v119, v222, v223
    v_mfma_f32_32x32x16_bf16 a[48:63], v[58:61], v[58:61], 0
    v_permlane32_swap_b32 v100, v102
    v_permlane32_swap_b32 v101, v103
    v_permlane32_swap_b32 v116, v118
    v_permlane32_swap_b32 v117, v119
    v_permlane16_swap_b32 v100, v102
    v_permlane16_swap_b32 v101, v103
    v_permlane16_swap_b32 v116, v118
    v_permlane16_swap_b32 v117, v119
    v_pk_mul_f32 v[224:225], v[224:225], s[36:37]
    v_pk_mul_f32 v[226:227], v[226:227], s[36:37]
    v_pk_mul_f32 v[232:233], v[232:233], s[36:37]
    v_pk_mul_f32 v[234:235], v[234:235], s[36:37]
    v_pk_mul_f32 v[228:229], v[228:229], s[36:37]
    v_pk_mul_f32 v[230:231], v[230:231], s[36:37]
    v_pk_mul_f32 v[236:237], v[236:237], s[36:37]
    v_pk_mul_f32 v[238:239], v[238:239], s[36:37]
    v_mfma_f32_32x32x16_bf16 a[64:79], v[58:61], v[58:61], 0
    v_cvt_pk_bf16_f32 v104, v224, v225
    v_cvt_pk_bf16_f32 v105, v226, v227
    v_cvt_pk_bf16_f32 v106, v232, v233
    v_cvt_pk_bf16_f32 v107, v234, v235
    v_cvt_pk_bf16_f32 v120, v228, v229
    v_cvt_pk_bf16_f32 v121, v230, v231
    v_cvt_pk_bf16_f32 v122, v236, v237
    v_cvt_pk_bf16_f32 v123, v238, v239
    v_mfma_f32_32x32x16_bf16 a[80:95], v[58:61], v[58:61], 0
    v_permlane32_swap_b32 v104, v106
    v_permlane32_swap_b32 v105, v107
    v_permlane32_swap_b32 v120, v122
    v_permlane32_swap_b32 v121, v123
    v_permlane16_swap_b32 v104, v106
    v_permlane16_swap_b32 v105, v107
    v_permlane16_swap_b32 v120, v122
    v_permlane16_swap_b32 v121, v123
    v_pk_mul_f32 v[240:241], v[240:241], s[36:37]
    v_pk_mul_f32 v[242:243], v[242:243], s[36:37]
    v_pk_mul_f32 v[248:249], v[248:249], s[36:37]
    v_pk_mul_f32 v[250:251], v[250:251], s[36:37]
    v_pk_mul_f32 v[244:245], v[244:245], s[36:37]
    v_pk_mul_f32 v[246:247], v[246:247], s[36:37]
    v_pk_mul_f32 v[252:253], v[252:253], s[36:37]
    v_pk_mul_f32 v[254:255], v[254:255], s[36:37]
    v_mfma_f32_32x32x16_bf16 a[96:111], v[58:61], v[58:61], 0
    v_cvt_pk_bf16_f32 v108, v240, v241
    v_cvt_pk_bf16_f32 v109, v242, v243
    v_cvt_pk_bf16_f32 v110, v248, v249
    v_cvt_pk_bf16_f32 v111, v250, v251
    v_cvt_pk_bf16_f32 v124, v244, v245
    v_cvt_pk_bf16_f32 v125, v246, v247
    v_cvt_pk_bf16_f32 v126, v252, v253
    v_cvt_pk_bf16_f32 v127, v254, v255
    v_mfma_f32_32x32x16_bf16 a[112:127], v[58:61], v[58:61], 0
    v_permlane32_swap_b32 v108, v110
    v_permlane32_swap_b32 v109, v111
    v_permlane32_swap_b32 v124, v126
    v_permlane32_swap_b32 v125, v127
    v_permlane16_swap_b32 v108, v110
    v_permlane16_swap_b32 v109, v111
    v_permlane16_swap_b32 v124, v126
    v_permlane16_swap_b32 v125, v127
    s_waitcnt lgkmcnt(0)
    v_mfma_f32_16x16x32_bf16 v[216:219], a[208:211], v[64:67], 0
    v_mfma_f32_16x16x32_bf16 v[216:219], a[212:215], v[68:71], v[216:219]
    v_mfma_f32_16x16x32_bf16 v[216:219], a[216:219], v[72:75], v[216:219]
    v_mfma_f32_16x16x32_bf16 v[216:219], a[220:223], v[76:79], v[216:219]
    v_mfma_f32_16x16x32_bf16 v[220:223], a[208:211], v[80:83], 0
    v_mfma_f32_16x16x32_bf16 v[220:223], a[212:215], v[84:87], v[220:223]
    v_mfma_f32_16x16x32_bf16 v[220:223], a[216:219], v[88:91], v[220:223]
    v_mfma_f32_16x16x32_bf16 v[220:223], a[220:223], v[92:95], v[220:223]
    v_mfma_f32_16x16x32_bf16 v[224:227], a[208:211], v[96:99], 0
    v_mfma_f32_16x16x32_bf16 v[224:227], a[212:215], v[100:103], v[224:227]
    v_mfma_f32_16x16x32_bf16 v[224:227], a[216:219], v[104:107], v[224:227]
    v_mfma_f32_16x16x32_bf16 v[224:227], a[220:223], v[108:111], v[224:227]
    v_mfma_f32_16x16x32_bf16 v[228:231], a[208:211], v[112:115], 0
    v_mfma_f32_16x16x32_bf16 v[228:231], a[212:215], v[116:119], v[228:231]
    v_mfma_f32_16x16x32_bf16 v[228:231], a[216:219], v[120:123], v[228:231]
    v_mfma_f32_16x16x32_bf16 v[228:231], a[220:223], v[124:127], v[228:231]
    v_mfma_f32_32x32x16_bf16 a[192:207], v[58:61], v[58:61], 0
    v_max3_f32 v232, v216, v217, v218
    v_max_f32 v232, v232, v219
    v_max3_f32 v233, v220, v221, v222
    v_max_f32 v233, v233, v223
    v_max3_f32 v234, v224, v225, v226
    v_max_f32 v234, v234, v227
    s_nop 0
    v_max3_f32 v235, v228, v229, v230
    v_max_f32 v235, v235, v231
    v_mov_b32 v236, v232
    v_mov_b32 v237, v233
    v_mov_b32 v238, v234
    v_mov_b32 v239, v235
    v_permlane16_swap_b32 v232, v236
    v_permlane16_swap_b32 v233, v237
    v_permlane16_swap_b32 v234, v238
    v_permlane16_swap_b32 v235, v239
    v_max_f32 v232, v232, v236
    v_max_f32 v233, v233, v237
    v_max_f32 v234, v234, v238
    v_max_f32 v235, v235, v239
    v_mov_b32 v236, v232
    v_mov_b32 v237, v233
    v_mov_b32 v238, v234
    v_mov_b32 v239, v235
    v_permlane32_swap_b32 v232, v236
    v_permlane32_swap_b32 v233, v237
    v_permlane32_swap_b32 v234, v238
    v_permlane32_swap_b32 v235, v239
    v_max_f32 v232, v232, v236
    v_max_f32 v233, v233, v237
    v_max_f32 v234, v234, v238
    v_max_f32 v235, v235, v239
    v_sub_f32 v192, 3250585600, v232
    v_sub_f32 v193, 3250585600, v232
    v_sub_f32 v194, 3250585600, v232
    v_sub_f32 v195, 3250585600, v232
    v_sub_f32 v196, 3250585600, v233
    v_sub_f32 v197, 3250585600, v233
Ltour0_3:
    s_cbranch_execz Ltour0_7
    v_sub_f32 v198, 3250585600, v233
    v_sub_f32 v199, 3250585600, v233
    v_sub_f32 v200, 3250585600, v234
    v_sub_f32 v201, 3250585600, v234
    v_sub_f32 v202, 3250585600, v234
    v_sub_f32 v203, 3250585600, v234
    v_sub_f32 v204, 3250585600, v235
    v_sub_f32 v205, 3250585600, v235
    v_sub_f32 v206, 3250585600, v235
    v_sub_f32 v207, 3250585600, v235
Lattn_stage0:
    s_mov_b32 s43, 7
    v_mfma_f32_16x16x32_bf16 v[208:211], a[208:211], v[64:67], v[192:195]
    s_lshl_b32 s53, s5, 4
    v_lshrrev_b32 v51, 2, v0
    v_mul_u32_u24 v51, 9216, v51
    v_mfma_f32_16x16x32_bf16 v[208:211], a[212:215], v[68:71], v[208:211]
    s_add_u32 s53, s53, s4
    v_and_b32 v254, 3, v0
    v_lshl_add_u32 v254, v254, 4, v51
    v_mfma_f32_16x16x32_bf16 v[208:211], a[216:219], v[72:75], v[208:211]
    s_lshl_b32 s53, s53, 2
    v_lshlrev_b32 v255, 4, v0
    v_add_u32 v51, 98304, v255
    v_mfma_f32_16x16x32_bf16 v[208:211], a[220:223], v[76:79], v[208:211]
    s_add_u32 s53, s53, s3
    v_mov_b32 v224, 0
    v_mfma_f32_16x16x32_bf16 v[212:215], a[208:211], v[80:83], v[196:199]
    s_mul_i32 s53, s53, 4608
    ds_read_b128 a[228:231], v9 offset:4096
    v_mov_b32 v225, 0
    v_mfma_f32_16x16x32_bf16 v[212:215], a[212:215], v[84:87], v[212:215]
    s_add_u32 s53, s53, 2621440
    v_exp_f32 v208, v208
    v_mfma_f32_16x16x32_bf16 v[212:215], a[216:219], v[88:91], v[212:215]
    s_lshr_b32 s44, s2, 5
    v_exp_f32 v209, v209
    v_mfma_f32_16x16x32_bf16 v[212:215], a[220:223], v[92:95], v[212:215]
    s_lshl_b32 s44, s44, 3
    v_exp_f32 v210, v210
    v_exp_f32 v211, v211
    v_cvt_pk_bf16_f32 v128, v208, v209
    v_cvt_pk_bf16_f32 v129, v210, v211
    v_mfma_f32_16x16x32_bf16 v[208:211], a[208:211], v[96:99], v[200:203]
    s_and_b32 s37, s2, 7
    ds_read_b128 a[232:235], v10 offset:4096
    v_mov_b32 v226, 0
    v_mfma_f32_16x16x32_bf16 v[208:211], a[212:215], v[100:103], v[208:211]
    s_add_u32 s44, s44, s37
    v_exp_f32 v212, v212
    v_mfma_f32_16x16x32_bf16 v[208:211], a[216:219], v[104:107], v[208:211]
    s_lshl_b32 s44, s44, 2
    v_exp_f32 v213, v213
    v_mfma_f32_16x16x32_bf16 v[208:211], a[220:223], v[108:111], v[208:211]
    s_bfe_u32 s37, s2, 0x20003
    v_exp_f32 v214, v214
    v_exp_f32 v215, v215
    v_cvt_pk_bf16_f32 v136, v212, v213
    v_cvt_pk_bf16_f32 v137, v214, v215
    v_mfma_f32_16x16x32_bf16 v[212:215], a[208:211], v[112:115], v[204:207]
    s_add_u32 s44, s44, s37
    ds_read_b128 a[236:239], v11 offset:4096
    v_mov_b32 v227, 0
    v_mfma_f32_16x16x32_bf16 v[212:215], a[212:215], v[116:119], v[212:215]
    s_add_u32 s44, s44, 72
    v_exp_f32 v208, v208
    v_mfma_f32_16x16x32_bf16 v[212:215], a[216:219], v[120:123], v[212:215]
    s_cmp_lt_u32 s44, 216
    s_cselect_b32 s37, 0, 2147483648
    v_exp_f32 v209, v209
    v_mfma_f32_16x16x32_bf16 v[212:215], a[220:223], v[124:127], v[212:215]
    s_lshl_b32 s44, s44, 5
    v_exp_f32 v210, v210
    v_exp_f32 v211, v211
    v_cvt_pk_bf16_f32 v144, v208, v209
    v_cvt_pk_bf16_f32 v145, v210, v211
    v_mfma_f32_16x16x32_bf16 v[208:211], a[224:227], v[64:67], v[192:195]
    s_waitcnt lgkmcnt(2)
    s_or_b32 s44, s44, s37
    ds_read_b128 a[208:211], v8 offset:8192
    v_mov_b32 v228, 0
    v_mfma_f32_16x16x32_bf16 v[208:211], a[228:231], v[68:71], v[208:211]
    s_waitcnt lgkmcnt(2)
    s_mov_b32 s18, 3981312
    v_exp_f32 v212, v212
    v_mfma_f32_16x16x32_bf16 v[208:211], a[232:235], v[72:75], v[208:211]
    s_waitcnt lgkmcnt(1)
    s_lshr_b32 s6, s2, 3
    v_exp_f32 v213, v213
    v_mfma_f32_16x16x32_bf16 v[208:211], a[236:239], v[76:79], v[208:211]
    s_and_b32 s7, s2, 7
    v_exp_f32 v214, v214
    v_exp_f32 v215, v215
    v_cvt_pk_bf16_f32 v152, v212, v213
    v_cvt_pk_bf16_f32 v153, v214, v215
    v_mfma_f32_16x16x32_bf16 v[212:215], a[224:227], v[80:83], v[196:199]
    s_mul_i32 s7, s7, 18
    ds_read_b128 a[212:215], v9 offset:8192
    v_mov_b32 v229, 0
    v_mfma_f32_16x16x32_bf16 v[212:215], a[228:231], v[84:87], v[212:215]
    s_add_u32 s7, s7, s6
    v_exp_f32 v208, v208
    v_mfma_f32_16x16x32_bf16 v[212:215], a[232:235], v[88:91], v[212:215]
    s_lshl_b32 s58, s7, 6
    v_exp_f32 v209, v209
    v_mfma_f32_16x16x32_bf16 v[212:215], a[236:239], v[92:95], v[212:215]
    s_mul_i32 s59, s7, 36864
    v_exp_f32 v210, v210
    v_exp_f32 v211, v211
    v_cvt_pk_bf16_f32 v130, v208, v209
    v_cvt_pk_bf16_f32 v131, v210, v211
    v_mfma_f32_16x16x32_bf16 v[208:211], a[224:227], v[96:99], v[200:203]
    s_cmp_lt_u32 s6, 18
    s_cselect_b32 s7, 0, 2147483648
    ds_read_b128 a[216:219], v10 offset:8192
    v_mov_b32 v230, 0
    v_mfma_f32_16x16x32_bf16 v[208:211], a[228:231], v[100:103], v[208:211]
    s_or_b32 s58, s58, s7
    v_exp_f32 v212, v212
    v_mfma_f32_16x16x32_bf16 v[208:211], a[232:235], v[104:107], v[208:211]
    s_or_b32 s59, s59, s7
    v_exp_f32 v213, v213
    v_mfma_f32_16x16x32_bf16 v[208:211], a[236:239], v[108:111], v[208:211]
    s_and_b32 s7, s4, 1
    v_exp_f32 v214, v214
    v_exp_f32 v215, v215
    v_cvt_pk_bf16_f32 v138, v212, v213
    v_cvt_pk_bf16_f32 v139, v214, v215
    s_mov_b32 s39, 221184
    s_mov_b32 s38, 27648
    v_mfma_f32_16x16x32_bf16 v[212:215], a[224:227], v[112:115], v[204:207]
    s_lshl_b32 s6, s7, 7
    ds_read_b128 a[220:223], v11 offset:8192
    v_mov_b32 v231, 0
    v_mfma_f32_16x16x32_bf16 v[212:215], a[228:231], v[116:119], v[212:215]
    s_xor_b32 s36, s4, 1
    v_exp_f32 v208, v208
    v_mfma_f32_16x16x32_bf16 v[212:215], a[232:235], v[120:123], v[212:215]
    s_mul_i32 s36, s36, 294912
    v_exp_f32 v209, v209
    v_mfma_f32_16x16x32_bf16 v[212:215], a[236:239], v[124:127], v[212:215]
    s_waitcnt lgkmcnt(3)
    s_add_u32 s46, s36, s6
    v_exp_f32 v210, v210
    v_exp_f32 v211, v211
    v_cvt_pk_bf16_f32 v146, v208, v209
    v_cvt_pk_bf16_f32 v147, v210, v211
    v_mfma_f32_16x16x32_bf16 v[208:211], a[208:211], v[64:67], v[192:195]
    s_waitcnt lgkmcnt(2)
    s_lshl_b32 s36, s4, 8
    ds_read_b128 a[224:227], v8 offset:12288
    v_mov_b32 v248, -1
    v_mfma_f32_16x16x32_bf16 v[208:211], a[212:215], v[68:71], v[208:211]
    s_waitcnt lgkmcnt(2)
    s_add_u32 s56, s47, s36
    v_exp_f32 v212, v212
    v_mfma_f32_16x16x32_bf16 v[208:211], a[216:219], v[72:75], v[208:211]
    s_waitcnt lgkmcnt(1)
    s_lshr_b32 s36, s4, 1
    v_exp_f32 v213, v213
    v_mfma_f32_16x16x32_bf16 v[208:211], a[220:223], v[76:79], v[208:211]
    s_lshl_b32 s36, s36, 11
    v_exp_f32 v214, v214
    v_exp_f32 v215, v215
    v_cvt_pk_bf16_f32 v154, v212, v213
    v_cvt_pk_bf16_f32 v155, v214, v215
    v_mfma_f32_16x16x32_bf16 v[212:215], a[208:211], v[80:83], v[196:199]
    s_lshl_b32 s7, s7, 8
    ds_read_b128 a[228:231], v9 offset:12288
    v_mov_b32 v249, -1
    v_mfma_f32_16x16x32_bf16 v[212:215], a[212:215], v[84:87], v[212:215]
    s_add_u32 s36, s36, s7
    v_exp_f32 v208, v208
    v_mfma_f32_16x16x32_bf16 v[212:215], a[216:219], v[88:91], v[212:215]
    s_add_u32 s93, s47, s36
    v_exp_f32 v209, v209
    v_mfma_f32_16x16x32_bf16 v[212:215], a[220:223], v[92:95], v[212:215]
    s_lshr_b32 s36, s4, 1
    v_exp_f32 v210, v210
    v_exp_f32 v211, v211
    v_cvt_pk_bf16_f32 v132, v208, v209
    v_cvt_pk_bf16_f32 v133, v210, v211
    v_mfma_f32_16x16x32_bf16 v[208:211], a[208:211], v[96:99], v[200:203]
    s_lshl_b32 s36, s36, 4
    ds_read_b128 a[232:235], v10 offset:12288
    v_mov_b32 v250, -1
    v_mfma_f32_16x16x32_bf16 v[208:211], a[212:215], v[100:103], v[208:211]
    s_add_u32 s36, s36, s5
    v_exp_f32 v212, v212
    v_mfma_f32_16x16x32_bf16 v[208:211], a[216:219], v[104:107], v[208:211]
    s_lshl_b32 s36, s36, 9
    v_exp_f32 v213, v213
    v_mfma_f32_16x16x32_bf16 v[208:211], a[220:223], v[108:111], v[208:211]
    s_add_u32 s36, s36, s7
    v_exp_f32 v214, v214
    v_exp_f32 v215, v215
    v_cvt_pk_bf16_f32 v140, v212, v213
    v_cvt_pk_bf16_f32 v141, v214, v215
    s_waitcnt vmcnt(4)
    s_barrier
    v_mfma_f32_16x16x32_bf16 v[212:215], a[208:211], v[112:115], v[204:207]
    s_lshl_b32 s36, s36, 8
    ds_read_b128 a[236:239], v11 offset:12288
    v_mov_b32 v251, -1
    v_mfma_f32_16x16x32_bf16 v[212:215], a[212:215], v[116:119], v[212:215]
    s_add_u32 m0, s42, 49152
    s_add_u32 s55, s36, 21102592
    v_exp_f32 v208, v208
    v_mfma_f32_16x16x32_bf16 v[212:215], a[216:219], v[120:123], v[212:215]
    s_add_u32 s7, s45, s6
    v_exp_f32 v209, v209
    v_mfma_f32_16x16x32_bf16 v[212:215], a[220:223], v[124:127], v[212:215]
    s_waitcnt lgkmcnt(3)
    s_xor_b32 s54, s92, 128
    v_exp_f32 v210, v210
    v_exp_f32 v211, v211
    v_cvt_pk_bf16_f32 v148, v208, v209
    v_cvt_pk_bf16_f32 v149, v210, v211
    buffer_load_dwordx4 v36, s[8:11], s40 offen lds
    v_mfma_f32_16x16x32_bf16 v[208:211], a[224:227], v[64:67], v[192:195]
    s_waitcnt lgkmcnt(2)
    s_lshl_b32 s36, s3, 14
    ds_read_b128 a[208:211], v8 offset:16384
    v_min_u32 v232, 41, v1
    v_mfma_f32_16x16x32_bf16 v[208:211], a[228:231], v[68:71], v[208:211]
    s_waitcnt lgkmcnt(2)
    v_exp_f32 v212, v212
    v_mfma_f32_16x16x32_bf16 v[208:211], a[232:235], v[72:75], v[208:211]
    s_waitcnt lgkmcnt(1)
    v_exp_f32 v213, v213
    v_mfma_f32_16x16x32_bf16 v[208:211], a[236:239], v[76:79], v[208:211]
    v_exp_f32 v214, v214
    v_exp_f32 v215, v215
    v_cvt_pk_bf16_f32 v156, v212, v213
    v_cvt_pk_bf16_f32 v157, v214, v215
    v_mfma_f32_16x16x32_bf16 v[212:215], a[224:227], v[80:83], v[196:199]
    ds_read_b128 a[212:215], v9 offset:16384
    v_mfma_f32_16x16x32_bf16 v[212:215], a[228:231], v[84:87], v[212:215]
    s_nop 0
    v_exp_f32 v208, v208
    v_mfma_f32_16x16x32_bf16 v[212:215], a[232:235], v[88:91], v[212:215]
    v_exp_f32 v209, v209
    v_mfma_f32_16x16x32_bf16 v[212:215], a[236:239], v[92:95], v[212:215]
    v_exp_f32 v210, v210
    v_exp_f32 v211, v211
    ds_read_b64_tr_b16 a[160:161], v20 offset:0
    v_cvt_pk_bf16_f32 v134, v208, v209
    v_lshl_add_u32 v252, v1, 4, s36
    v_lshlrev_b32 v232, 4, v232
    s_mov_b32 s57, s58
    s_lshl_b32 s6, s3, 10
    s_add_u32 s6, s6, 135168
    s_lshr_b32 s37, s2, 3
    s_mul_i32 s37, s37, -129024
    s_add_u32 s37, s37, 4128768
    ds_read_b64_tr_b16 a[162:163], v20 offset:4096
    ds_read_b128 a[216:219], v10 offset:16384
    v_cvt_pk_bf16_f32 v135, v210, v211
    buffer_load_dwordx4 v37, s[8:11], s40 offen offset:1024 lds
    v_mfma_f32_16x16x32_bf16 v[208:211], a[224:227], v[96:99], v[200:203]
    v_mfma_f32_16x16x32_bf16 v[208:211], a[228:231], v[100:103], v[208:211]
    v_exp_f32 v212, v212
    v_mfma_f32_16x16x32_bf16 v[208:211], a[232:235], v[104:107], v[208:211]
    v_exp_f32 v213, v213
    v_mfma_f32_16x16x32_bf16 v[208:211], a[236:239], v[108:111], v[208:211]
    s_mov_b32 s52, s55
    v_exp_f32 v214, v214
    v_exp_f32 v215, v215
    ds_read_b64_tr_b16 a[164:165], v20 offset:8192
    v_cvt_pk_bf16_f32 v142, v212, v213
    ds_read_b64_tr_b16 a[166:167], v20 offset:12288
    v_min_u32 v237, 19, v1
    v_lshl_add_u32 v237, v237, 7, s36
    v_lshl_add_u32 v238, v1, 7, s36
    ds_read_b128 a[220:223], v11 offset:16384
    v_cvt_pk_bf16_f32 v143, v214, v215
    buffer_load_dword v217, v57, s[32:35], s37 offen
    v_mfma_f32_16x16x32_bf16 v[212:215], a[224:227], v[112:115], v[204:207]
    v_mfma_f32_16x16x32_bf16 v[212:215], a[228:231], v[116:119], v[212:215]
    v_exp_f32 v208, v208
    v_mfma_f32_16x16x32_bf16 v[212:215], a[232:235], v[120:123], v[212:215]
    s_mul_i32 s37, s5, 18432
    v_exp_f32 v209, v209
    v_mfma_f32_16x16x32_bf16 v[212:215], a[236:239], v[124:127], v[212:215]
    s_add_u32 s37, s37, s45
    v_exp_f32 v210, v210
    v_exp_f32 v211, v211
    ds_read_b64_tr_b16 a[168:169], v21 offset:0
    v_cvt_pk_bf16_f32 v150, v208, v209
    ds_read_b64_tr_b16 a[170:171], v21 offset:4096
    v_min_u32 v236, 143, v0
    v_lshl_add_u32 v236, v236, 7, s37
    v_mul_u32_u24 v235, 24, v0
    v_lshrrev_b32 v235, 8, v235
    v_lshl_add_u32 v235, v235, 7, s37
    ds_read_b128 a[224:227], v8 offset:20480
    v_cvt_pk_bf16_f32 v151, v210, v211
    s_waitcnt lgkmcnt(3)
    buffer_load_dwordx4 v38, s[8:11], s40 offen offset:2048 lds
    s_nop 0
    s_nop 0
    s_nop 0
    s_nop 0
    s_nop 0
    s_nop 0
Lattn_loop:
    v_mfma_f32_16x16x32_bf16 v[208:211], a[208:211], v[64:67], v[192:195]
    v_exp_f32 v212, v212
    v_mfma_f32_16x16x32_bf16 v[208:211], a[212:215], v[68:71], v[208:211]
    v_exp_f32 v213, v213
    v_mfma_f32_16x16x32_bf16 v[208:211], a[216:219], v[72:75], v[208:211]
    v_exp_f32 v214, v214
    v_mfma_f32_16x16x32_bf16 v[208:211], a[220:223], v[76:79], v[208:211]
    v_exp_f32 v215, v215
    v_mfma_f32_16x16x32_bf16 a[0:3], a[160:163], v[128:131], a[0:3]
    ds_read_b64_tr_b16 a[172:173], v21 offset:8192
    v_cvt_pk_bf16_f32 v158, v212, v213
    v_mfma_f32_16x16x32_bf16 a[0:3], a[164:167], v[132:135], a[0:3]
    ds_read_b64_tr_b16 a[174:175], v21 offset:12288
    v_mfma_f32_16x16x32_bf16 a[4:7], a[164:167], v[140:143], a[4:7]
    ds_read_b128 a[228:231], v9 offset:20480
    v_cvt_pk_bf16_f32 v159, v214, v215
    v_mfma_f32_16x16x32_bf16 a[4:7], a[160:163], v[136:139], a[4:7]
    v_mfma_f32_16x16x32_bf16 v[212:215], a[208:211], v[80:83], v[196:199]
    v_exp_f32 v208, v208
    v_mfma_f32_16x16x32_bf16 v[212:215], a[212:215], v[84:87], v[212:215]
    v_exp_f32 v209, v209
    v_mfma_f32_16x16x32_bf16 v[212:215], a[216:219], v[88:91], v[212:215]
    v_exp_f32 v210, v210
    v_mfma_f32_16x16x32_bf16 v[212:215], a[220:223], v[92:95], v[212:215]
    v_exp_f32 v211, v211
    v_mfma_f32_16x16x32_bf16 a[8:11], a[160:163], v[144:147], a[8:11]
    ds_read_b64_tr_b16 a[176:177], v22 offset:0
    v_cvt_pk_bf16_f32 v160, v208, v209
    v_mfma_f32_16x16x32_bf16 a[8:11], a[164:167], v[148:151], a[8:11]
    ds_read_b64_tr_b16 a[178:179], v22 offset:4096
    v_mfma_f32_16x16x32_bf16 a[12:15], a[164:167], v[156:159], a[12:15]
    ds_read_b128 a[232:235], v10 offset:20480
    v_cvt_pk_bf16_f32 v161, v210, v211
    v_mfma_f32_16x16x32_bf16 a[12:15], a[160:163], v[152:155], a[12:15]
    s_waitcnt lgkmcnt(3)
    buffer_load_dwordx4 v39, s[8:11], s40 offen offset:3072 lds
    v_mfma_f32_16x16x32_bf16 v[208:211], a[208:211], v[96:99], v[200:203]
    v_exp_f32 v212, v212
    v_mfma_f32_16x16x32_bf16 v[208:211], a[212:215], v[100:103], v[208:211]
    s_add_u32 s40, s40, 16384
    v_exp_f32 v213, v213
    v_mfma_f32_16x16x32_bf16 v[208:211], a[216:219], v[104:107], v[208:211]
    s_mov_b32 m0, s6
    v_exp_f32 v214, v214
    v_mfma_f32_16x16x32_bf16 v[208:211], a[220:223], v[108:111], v[208:211]
    v_exp_f32 v215, v215
    v_mfma_f32_16x16x32_bf16 a[16:19], a[168:171], v[128:131], a[16:19]
    ds_read_b64_tr_b16 a[180:181], v22 offset:8192
    v_cvt_pk_bf16_f32 v168, v212, v213
    v_mfma_f32_16x16x32_bf16 a[16:19], a[172:175], v[132:135], a[16:19]
    ds_read_b64_tr_b16 a[182:183], v22 offset:12288
    v_mfma_f32_16x16x32_bf16 a[20:23], a[172:175], v[140:143], a[20:23]
    ds_read_b128 a[236:239], v11 offset:20480
    v_cvt_pk_bf16_f32 v169, v214, v215
    v_mfma_f32_16x16x32_bf16 a[20:23], a[168:171], v[136:139], a[20:23]
    buffer_load_dwordx4 v254, s[32:35], s57 offen  lds
    v_smfmac_f32_16x16x64_bf16 a[192:195], v[52:55], v[128:135], v50
    v_mfma_f32_16x16x32_bf16 v[212:215], a[208:211], v[112:115], v[204:207]
    v_exp_f32 v208, v208
    v_mfma_f32_16x16x32_bf16 v[212:215], a[212:215], v[116:119], v[212:215]
    s_add_u32 m0, s42, 98304
    v_exp_f32 v209, v209
    v_mfma_f32_16x16x32_bf16 v[212:215], a[216:219], v[120:123], v[212:215]
    v_exp_f32 v210, v210
    v_mfma_f32_16x16x32_bf16 v[212:215], a[220:223], v[124:127], v[212:215]
    v_exp_f32 v211, v211
    v_mfma_f32_16x16x32_bf16 a[24:27], a[168:171], v[144:147], a[24:27]
    ds_read_b64_tr_b16 a[184:185], v23 offset:0
    v_cvt_pk_bf16_f32 v176, v208, v209
    v_mfma_f32_16x16x32_bf16 a[24:27], a[172:175], v[148:151], a[24:27]
    ds_read_b64_tr_b16 a[186:187], v23 offset:4096
    v_mfma_f32_16x16x32_bf16 a[28:31], a[172:175], v[156:159], a[28:31]
    ds_read_b128 a[208:211], v8 offset:24576
    v_cvt_pk_bf16_f32 v177, v210, v211
    v_mfma_f32_16x16x32_bf16 a[28:31], a[168:171], v[152:155], a[28:31]
    s_waitcnt lgkmcnt(3)
    buffer_load_dwordx4 v40, s[12:15], s41 offen lds
    v_mfma_f32_16x16x32_bf16 v[208:211], a[224:227], v[64:67], v[192:195]
    v_exp_f32 v212, v212
    v_mfma_f32_16x16x32_bf16 v[208:211], a[228:231], v[68:71], v[208:211]
    s_add_u32 s6, s6, 4096
    v_exp_f32 v213, v213
    v_mfma_f32_16x16x32_bf16 v[208:211], a[232:235], v[72:75], v[208:211]
    s_add_u32 s57, s57, 589824
    v_exp_f32 v214, v214
    v_mfma_f32_16x16x32_bf16 v[208:211], a[236:239], v[76:79], v[208:211]
    v_exp_f32 v215, v215
    v_mfma_f32_16x16x32_bf16 a[32:35], a[176:179], v[128:131], a[32:35]
    ds_read_b64_tr_b16 a[188:189], v23 offset:8192
    v_cvt_pk_bf16_f32 v184, v212, v213
    v_mfma_f32_16x16x32_bf16 a[32:35], a[180:183], v[132:135], a[32:35]
    ds_read_b64_tr_b16 a[190:191], v23 offset:12288
    v_mfma_f32_16x16x32_bf16 a[36:39], a[180:183], v[140:143], a[36:39]
    ds_read_b128 a[212:215], v9 offset:24576
    v_cvt_pk_bf16_f32 v185, v214, v215
    v_mfma_f32_16x16x32_bf16 a[36:39], a[176:179], v[136:139], a[36:39]
    v_smfmac_f32_16x16x64_bf16 a[196:199], v[52:55], v[136:143], v50
    v_mfma_f32_16x16x32_bf16 v[212:215], a[224:227], v[80:83], v[196:199]
    v_exp_f32 v208, v208
    v_mfma_f32_16x16x32_bf16 v[212:215], a[228:231], v[84:87], v[212:215]
    v_exp_f32 v209, v209
    v_mfma_f32_16x16x32_bf16 v[212:215], a[232:235], v[88:91], v[212:215]
    v_exp_f32 v210, v210
    v_mfma_f32_16x16x32_bf16 v[212:215], a[236:239], v[92:95], v[212:215]
    v_exp_f32 v211, v211
    v_mfma_f32_16x16x32_bf16 a[40:43], a[176:179], v[144:147], a[40:43]
    ds_read_b64_tr_b16 a[160:161], v24 offset:0
    v_cvt_pk_bf16_f32 v162, v208, v209
    v_mfma_f32_16x16x32_bf16 a[40:43], a[180:183], v[148:151], a[40:43]
    ds_read_b64_tr_b16 a[162:163], v24 offset:4096
    v_mfma_f32_16x16x32_bf16 a[44:47], a[180:183], v[156:159], a[44:47]
    ds_read_b128 a[216:219], v10 offset:24576
    v_cvt_pk_bf16_f32 v163, v210, v211
    v_mfma_f32_16x16x32_bf16 a[44:47], a[176:179], v[152:155], a[44:47]
    s_waitcnt lgkmcnt(3)
    buffer_load_dwordx4 v41, s[12:15], s41 offen offset:1024 lds
    v_mfma_f32_16x16x32_bf16 v[208:211], a[224:227], v[96:99], v[200:203]
    v_exp_f32 v212, v212
    v_mfma_f32_16x16x32_bf16 v[208:211], a[228:231], v[100:103], v[208:211]
    v_exp_f32 v213, v213
    v_mfma_f32_16x16x32_bf16 v[208:211], a[232:235], v[104:107], v[208:211]
    v_exp_f32 v214, v214
    v_mfma_f32_16x16x32_bf16 v[208:211], a[236:239], v[108:111], v[208:211]
    v_exp_f32 v215, v215
    v_mfma_f32_16x16x32_bf16 a[48:51], a[184:187], v[128:131], a[48:51]
    ds_read_b64_tr_b16 a[164:165], v24 offset:8192
    v_cvt_pk_bf16_f32 v170, v212, v213
    v_mfma_f32_16x16x32_bf16 a[48:51], a[188:191], v[132:135], a[48:51]
    ds_read_b64_tr_b16 a[166:167], v24 offset:12288
    v_mfma_f32_16x16x32_bf16 a[52:55], a[188:191], v[140:143], a[52:55]
    ds_read_b128 a[220:223], v11 offset:24576
    v_cvt_pk_bf16_f32 v171, v214, v215
    v_mfma_f32_16x16x32_bf16 a[52:55], a[184:187], v[136:139], a[52:55]
    v_smfmac_f32_16x16x64_bf16 a[200:203], v[52:55], v[144:151], v50
    v_mfma_f32_16x16x32_bf16 v[212:215], a[224:227], v[112:115], v[204:207]
    v_exp_f32 v208, v208
    v_mfma_f32_16x16x32_bf16 v[212:215], a[228:231], v[116:119], v[212:215]
    v_exp_f32 v209, v209
    v_mfma_f32_16x16x32_bf16 v[212:215], a[232:235], v[120:123], v[212:215]
    v_exp_f32 v210, v210
    v_mfma_f32_16x16x32_bf16 v[212:215], a[236:239], v[124:127], v[212:215]
    v_exp_f32 v211, v211
    v_mfma_f32_16x16x32_bf16 a[56:59], a[184:187], v[144:147], a[56:59]
    ds_read_b64_tr_b16 a[168:169], v25 offset:0
    v_cvt_pk_bf16_f32 v178, v208, v209
    v_mfma_f32_16x16x32_bf16 a[56:59], a[188:191], v[148:151], a[56:59]
    ds_read_b64_tr_b16 a[170:171], v25 offset:4096
    v_mfma_f32_16x16x32_bf16 a[60:63], a[188:191], v[156:159], a[60:63]
    ds_read_b128 a[224:227], v8 offset:28672
    v_cvt_pk_bf16_f32 v179, v210, v211
    v_mfma_f32_16x16x32_bf16 a[60:63], a[184:187], v[152:155], a[60:63]
    s_waitcnt lgkmcnt(3)
    buffer_load_dwordx4 v40, s[12:15], s41 offen offset:2048 lds
    v_mfma_f32_16x16x32_bf16 v[208:211], a[208:211], v[64:67], v[192:195]
    v_exp_f32 v212, v212
    v_mfma_f32_16x16x32_bf16 v[208:211], a[212:215], v[68:71], v[208:211]
    v_exp_f32 v213, v213
    v_mfma_f32_16x16x32_bf16 v[208:211], a[216:219], v[72:75], v[208:211]
    v_exp_f32 v214, v214
    v_mfma_f32_16x16x32_bf16 v[208:211], a[220:223], v[76:79], v[208:211]
    v_exp_f32 v215, v215
    v_mfma_f32_16x16x32_bf16 a[64:67], a[160:163], v[128:131], a[64:67]
    ds_read_b64_tr_b16 a[172:173], v25 offset:8192
    v_cvt_pk_bf16_f32 v186, v212, v213
    v_mfma_f32_16x16x32_bf16 a[64:67], a[164:167], v[132:135], a[64:67]
    ds_read_b64_tr_b16 a[174:175], v25 offset:12288
    v_mfma_f32_16x16x32_bf16 a[68:71], a[164:167], v[140:143], a[68:71]
    ds_read_b128 a[228:231], v9 offset:28672
    v_cvt_pk_bf16_f32 v187, v214, v215
    v_mfma_f32_16x16x32_bf16 a[68:71], a[160:163], v[136:139], a[68:71]
    v_smfmac_f32_16x16x64_bf16 a[204:207], v[52:55], v[152:159], v50
    v_mfma_f32_16x16x32_bf16 v[212:215], a[208:211], v[80:83], v[196:199]
    v_exp_f32 v208, v208
    v_mfma_f32_16x16x32_bf16 v[212:215], a[212:215], v[84:87], v[212:215]
    v_exp_f32 v209, v209
    v_mfma_f32_16x16x32_bf16 v[212:215], a[216:219], v[88:91], v[212:215]
    v_exp_f32 v210, v210
    v_mfma_f32_16x16x32_bf16 v[212:215], a[220:223], v[92:95], v[212:215]
    v_exp_f32 v211, v211
    v_mfma_f32_16x16x32_bf16 a[72:75], a[160:163], v[144:147], a[72:75]
    ds_read_b64_tr_b16 a[176:177], v26 offset:0
    v_cvt_pk_bf16_f32 v164, v208, v209
    v_mfma_f32_16x16x32_bf16 a[72:75], a[164:167], v[148:151], a[72:75]
    ds_read_b64_tr_b16 a[178:179], v26 offset:4096
    v_mfma_f32_16x16x32_bf16 a[76:79], a[164:167], v[156:159], a[76:79]
    ds_read_b128 a[232:235], v10 offset:28672
    v_cvt_pk_bf16_f32 v165, v210, v211
    v_mfma_f32_16x16x32_bf16 a[76:79], a[160:163], v[152:155], a[76:79]
    s_waitcnt lgkmcnt(3)
    buffer_load_dwordx4 v41, s[12:15], s41 offen offset:3072 lds
    v_mfma_f32_16x16x32_bf16 v[208:211], a[208:211], v[96:99], v[200:203]
    v_exp_f32 v212, v212
    v_mfma_f32_16x16x32_bf16 v[208:211], a[212:215], v[100:103], v[208:211]
    s_add_u32 s41, s41, 16384
    v_exp_f32 v213, v213
    v_mfma_f32_16x16x32_bf16 v[208:211], a[216:219], v[104:107], v[208:211]
    v_exp_f32 v214, v214
    v_mfma_f32_16x16x32_bf16 v[208:211], a[220:223], v[108:111], v[208:211]
    v_exp_f32 v215, v215
    v_mfma_f32_16x16x32_bf16 a[80:83], a[168:171], v[128:131], a[80:83]
    ds_read_b64_tr_b16 a[180:181], v26 offset:8192
    v_cvt_pk_bf16_f32 v172, v212, v213
    v_mfma_f32_16x16x32_bf16 a[80:83], a[172:175], v[132:135], a[80:83]
    ds_read_b64_tr_b16 a[182:183], v26 offset:12288
    v_mfma_f32_16x16x32_bf16 a[84:87], a[172:175], v[140:143], a[84:87]
    ds_read_b128 a[236:239], v11 offset:28672
    v_cvt_pk_bf16_f32 v173, v214, v215
    v_mfma_f32_16x16x32_bf16 a[84:87], a[168:171], v[136:139], a[84:87]
    s_waitcnt vmcnt(10)
    s_barrier
    v_mfma_f32_16x16x32_bf16 v[212:215], a[208:211], v[112:115], v[204:207]
    v_exp_f32 v208, v208
    v_mfma_f32_16x16x32_bf16 v[212:215], a[212:215], v[116:119], v[212:215]
    s_add_u32 m0, s42, 0
    v_exp_f32 v209, v209
    v_mfma_f32_16x16x32_bf16 v[212:215], a[216:219], v[120:123], v[212:215]
    v_exp_f32 v210, v210
    v_mfma_f32_16x16x32_bf16 v[212:215], a[220:223], v[124:127], v[212:215]
    v_exp_f32 v211, v211
    v_mfma_f32_16x16x32_bf16 a[88:91], a[168:171], v[144:147], a[88:91]
    ds_read_b64_tr_b16 a[184:185], v27 offset:0
    v_cvt_pk_bf16_f32 v180, v208, v209
    v_mfma_f32_16x16x32_bf16 a[88:91], a[172:175], v[148:151], a[88:91]
    ds_read_b64_tr_b16 a[186:187], v27 offset:4096
    v_mfma_f32_16x16x32_bf16 a[92:95], a[172:175], v[156:159], a[92:95]
    ds_read_b128 a[208:211], v8 offset:32768
    v_cvt_pk_bf16_f32 v181, v210, v211
    v_mfma_f32_16x16x32_bf16 a[92:95], a[168:171], v[152:155], a[92:95]
    s_waitcnt lgkmcnt(3)
    buffer_load_dwordx4 v36, s[8:11], s40 offen lds
    v_mfma_f32_16x16x32_bf16 v[208:211], a[224:227], v[64:67], v[192:195]
    v_exp_f32 v212, v212
    v_mfma_f32_16x16x32_bf16 v[208:211], a[228:231], v[68:71], v[208:211]
    v_exp_f32 v213, v213
    v_mfma_f32_16x16x32_bf16 v[208:211], a[232:235], v[72:75], v[208:211]
    v_exp_f32 v214, v214
    v_mfma_f32_16x16x32_bf16 v[208:211], a[236:239], v[76:79], v[208:211]
    v_exp_f32 v215, v215
    v_mfma_f32_16x16x32_bf16 a[96:99], a[176:179], v[128:131], a[96:99]
    ds_read_b64_tr_b16 a[188:189], v27 offset:8192
    v_cvt_pk_bf16_f32 v188, v212, v213
    v_mfma_f32_16x16x32_bf16 a[96:99], a[180:183], v[132:135], a[96:99]
    ds_read_b64_tr_b16 a[190:191], v27 offset:12288
    v_mfma_f32_16x16x32_bf16 a[100:103], a[180:183], v[140:143], a[100:103]
    ds_read_b128 a[212:215], v9 offset:32768
    v_cvt_pk_bf16_f32 v189, v214, v215
    v_mfma_f32_16x16x32_bf16 a[100:103], a[176:179], v[136:139], a[100:103]
    v_mfma_f32_16x16x32_bf16 v[212:215], a[224:227], v[80:83], v[196:199]
    v_exp_f32 v208, v208
    v_mfma_f32_16x16x32_bf16 v[212:215], a[228:231], v[84:87], v[212:215]
    v_exp_f32 v209, v209
    v_mfma_f32_16x16x32_bf16 v[212:215], a[232:235], v[88:91], v[212:215]
    v_exp_f32 v210, v210
    v_mfma_f32_16x16x32_bf16 v[212:215], a[236:239], v[92:95], v[212:215]
    v_exp_f32 v211, v211
    v_mfma_f32_16x16x32_bf16 a[104:107], a[176:179], v[144:147], a[104:107]
    ds_read_b64_tr_b16 a[160:161], v20 offset:16384
    v_cvt_pk_bf16_f32 v166, v208, v209
    v_mfma_f32_16x16x32_bf16 a[104:107], a[180:183], v[148:151], a[104:107]
    ds_read_b64_tr_b16 a[162:163], v20 offset:20480
    v_mfma_f32_16x16x32_bf16 a[108:111], a[180:183], v[156:159], a[108:111]
    ds_read_b128 a[216:219], v10 offset:32768
    v_cvt_pk_bf16_f32 v167, v210, v211
    v_mfma_f32_16x16x32_bf16 a[108:111], a[176:179], v[152:155], a[108:111]
    s_waitcnt lgkmcnt(3)
    buffer_load_dwordx4 v37, s[8:11], s40 offen offset:1024 lds
    v_mfma_f32_16x16x32_bf16 v[208:211], a[224:227], v[96:99], v[200:203]
    v_exp_f32 v212, v212
    v_mfma_f32_16x16x32_bf16 v[208:211], a[228:231], v[100:103], v[208:211]
    v_exp_f32 v213, v213
    v_mfma_f32_16x16x32_bf16 v[208:211], a[232:235], v[104:107], v[208:211]
    v_exp_f32 v214, v214
    v_mfma_f32_16x16x32_bf16 v[208:211], a[236:239], v[108:111], v[208:211]
    v_exp_f32 v215, v215
    v_mfma_f32_16x16x32_bf16 a[112:115], a[184:187], v[128:131], a[112:115]
    ds_read_b64_tr_b16 a[164:165], v20 offset:24576
    v_cvt_pk_bf16_f32 v174, v212, v213
    v_mfma_f32_16x16x32_bf16 a[112:115], a[188:191], v[132:135], a[112:115]
    ds_read_b64_tr_b16 a[166:167], v20 offset:28672
    v_mfma_f32_16x16x32_bf16 a[116:119], a[188:191], v[140:143], a[116:119]
    ds_read_b128 a[220:223], v11 offset:32768
    v_cvt_pk_bf16_f32 v175, v214, v215
    v_mfma_f32_16x16x32_bf16 a[116:119], a[184:187], v[136:139], a[116:119]
    buffer_load_dwordx4 v[240:243], v7, s[16:19], s44 offen
    v_mfma_f32_16x16x32_bf16 v[212:215], a[224:227], v[112:115], v[204:207]
    v_exp_f32 v208, v208
    v_mfma_f32_16x16x32_bf16 v[212:215], a[228:231], v[116:119], v[212:215]
    v_exp_f32 v209, v209
    v_mfma_f32_16x16x32_bf16 v[212:215], a[232:235], v[120:123], v[212:215]
    v_exp_f32 v210, v210
    v_mfma_f32_16x16x32_bf16 v[212:215], a[236:239], v[124:127], v[212:215]
    s_add_u32 s44, s44, 884736
    v_exp_f32 v211, v211
    v_mfma_f32_16x16x32_bf16 a[120:123], a[184:187], v[144:147], a[120:123]
    ds_read_b64_tr_b16 a[168:169], v21 offset:16384
    v_cvt_pk_bf16_f32 v182, v208, v209
    v_mfma_f32_16x16x32_bf16 a[120:123], a[188:191], v[148:151], a[120:123]
    ds_read_b64_tr_b16 a[170:171], v21 offset:20480
    v_mfma_f32_16x16x32_bf16 a[124:127], a[188:191], v[156:159], a[124:127]
    ds_read_b128 a[224:227], v8 offset:36864
    v_cvt_pk_bf16_f32 v183, v210, v211
    v_mfma_f32_16x16x32_bf16 a[124:127], a[184:187], v[152:155], a[124:127]
    s_waitcnt lgkmcnt(3)
    buffer_load_dwordx4 v38, s[8:11], s40 offen offset:2048 lds
    v_mfma_f32_16x16x32_bf16 v[208:211], a[208:211], v[64:67], v[192:195]
    v_exp_f32 v212, v212
    v_mfma_f32_16x16x32_bf16 v[208:211], a[212:215], v[68:71], v[208:211]
    v_exp_f32 v213, v213
    v_mfma_f32_16x16x32_bf16 v[208:211], a[216:219], v[72:75], v[208:211]
    v_exp_f32 v214, v214
    v_mfma_f32_16x16x32_bf16 v[208:211], a[220:223], v[76:79], v[208:211]
    v_exp_f32 v215, v215
    v_mfma_f32_16x16x32_bf16 a[0:3], a[160:163], v[160:163], a[0:3]
    ds_read_b64_tr_b16 a[172:173], v21 offset:24576
    v_cvt_pk_bf16_f32 v190, v212, v213
    v_mfma_f32_16x16x32_bf16 a[0:3], a[164:167], v[164:167], a[0:3]
Ltour0_4:
    s_cbranch_execz Ltour0_8
    ds_read_b64_tr_b16 a[174:175], v21 offset:28672
    v_mfma_f32_16x16x32_bf16 a[4:7], a[164:167], v[172:175], a[4:7]
    ds_read_b128 a[228:231], v9 offset:36864
    v_cvt_pk_bf16_f32 v191, v214, v215
    v_mfma_f32_16x16x32_bf16 a[4:7], a[160:163], v[168:171], a[4:7]
    v_mfma_f32_16x16x32_bf16 v[212:215], a[208:211], v[80:83], v[196:199]
    v_exp_f32 v208, v208
    v_mfma_f32_16x16x32_bf16 v[212:215], a[212:215], v[84:87], v[212:215]
    v_exp_f32 v209, v209
    v_mfma_f32_16x16x32_bf16 v[212:215], a[216:219], v[88:91], v[212:215]
    v_exp_f32 v210, v210
    v_mfma_f32_16x16x32_bf16 v[212:215], a[220:223], v[92:95], v[212:215]
    v_exp_f32 v211, v211
    v_mfma_f32_16x16x32_bf16 a[8:11], a[160:163], v[176:179], a[8:11]
    ds_read_b64_tr_b16 a[176:177], v22 offset:16384
    v_cvt_pk_bf16_f32 v128, v208, v209
    v_mfma_f32_16x16x32_bf16 a[8:11], a[164:167], v[180:183], a[8:11]
    ds_read_b64_tr_b16 a[178:179], v22 offset:20480
    v_mfma_f32_16x16x32_bf16 a[12:15], a[164:167], v[188:191], a[12:15]
    ds_read_b128 a[232:235], v10 offset:36864
    v_cvt_pk_bf16_f32 v129, v210, v211
    v_mfma_f32_16x16x32_bf16 a[12:15], a[160:163], v[184:187], a[12:15]
    s_waitcnt lgkmcnt(3)
    buffer_load_dwordx4 v39, s[8:11], s40 offen offset:3072 lds
    v_mfma_f32_16x16x32_bf16 v[208:211], a[208:211], v[96:99], v[200:203]
    v_exp_f32 v212, v212
    v_mfma_f32_16x16x32_bf16 v[208:211], a[212:215], v[100:103], v[208:211]
    s_add_u32 s40, s40, 16384
    v_exp_f32 v213, v213
    v_mfma_f32_16x16x32_bf16 v[208:211], a[216:219], v[104:107], v[208:211]
    v_exp_f32 v214, v214
    v_mfma_f32_16x16x32_bf16 v[208:211], a[220:223], v[108:111], v[208:211]
    v_exp_f32 v215, v215
    v_mfma_f32_16x16x32_bf16 a[16:19], a[168:171], v[160:163], a[16:19]
    ds_read_b64_tr_b16 a[180:181], v22 offset:24576
    v_cvt_pk_bf16_f32 v136, v212, v213
    v_mfma_f32_16x16x32_bf16 a[16:19], a[172:175], v[164:167], a[16:19]
    ds_read_b64_tr_b16 a[182:183], v22 offset:28672
    v_mfma_f32_16x16x32_bf16 a[20:23], a[172:175], v[172:175], a[20:23]
    ds_read_b128 a[236:239], v11 offset:36864
    v_cvt_pk_bf16_f32 v137, v214, v215
    v_mfma_f32_16x16x32_bf16 a[20:23], a[168:171], v[168:171], a[20:23]
    v_smfmac_f32_16x16x64_bf16 a[192:195], v[52:55], v[160:167], v50
    v_mfma_f32_16x16x32_bf16 v[212:215], a[208:211], v[112:115], v[204:207]
    v_exp_f32 v208, v208
    v_mfma_f32_16x16x32_bf16 v[212:215], a[212:215], v[116:119], v[212:215]
    s_add_u32 m0, s42, 114688
    v_exp_f32 v209, v209
    v_mfma_f32_16x16x32_bf16 v[212:215], a[216:219], v[120:123], v[212:215]
    v_exp_f32 v210, v210
    v_mfma_f32_16x16x32_bf16 v[212:215], a[220:223], v[124:127], v[212:215]
    v_exp_f32 v211, v211
    v_mfma_f32_16x16x32_bf16 a[24:27], a[168:171], v[176:179], a[24:27]
    ds_read_b64_tr_b16 a[184:185], v23 offset:16384
    v_cvt_pk_bf16_f32 v144, v208, v209
    v_mfma_f32_16x16x32_bf16 a[24:27], a[172:175], v[180:183], a[24:27]
    ds_read_b64_tr_b16 a[186:187], v23 offset:20480
    v_mfma_f32_16x16x32_bf16 a[28:31], a[172:175], v[188:191], a[28:31]
    ds_read_b128 a[208:211], v8 offset:40960
    v_cvt_pk_bf16_f32 v145, v210, v211
    v_mfma_f32_16x16x32_bf16 a[28:31], a[168:171], v[184:187], a[28:31]
    s_waitcnt lgkmcnt(3)
    buffer_load_dwordx4 v40, s[12:15], s41 offen lds
    v_mfma_f32_16x16x32_bf16 v[208:211], a[224:227], v[64:67], v[192:195]
    v_exp_f32 v212, v212
    v_mfma_f32_16x16x32_bf16 v[208:211], a[228:231], v[68:71], v[208:211]
    v_exp_f32 v213, v213
    v_mfma_f32_16x16x32_bf16 v[208:211], a[232:235], v[72:75], v[208:211]
    v_exp_f32 v214, v214
    v_mfma_f32_16x16x32_bf16 v[208:211], a[236:239], v[76:79], v[208:211]
    v_exp_f32 v215, v215
    v_mfma_f32_16x16x32_bf16 a[32:35], a[176:179], v[160:163], a[32:35]
    ds_read_b64_tr_b16 a[188:189], v23 offset:24576
    v_cvt_pk_bf16_f32 v152, v212, v213
    v_mfma_f32_16x16x32_bf16 a[32:35], a[180:183], v[164:167], a[32:35]
    ds_read_b64_tr_b16 a[190:191], v23 offset:28672
    v_mfma_f32_16x16x32_bf16 a[36:39], a[180:183], v[172:175], a[36:39]
    ds_read_b128 a[212:215], v9 offset:40960
    v_cvt_pk_bf16_f32 v153, v214, v215
    v_mfma_f32_16x16x32_bf16 a[36:39], a[176:179], v[168:171], a[36:39]
    v_smfmac_f32_16x16x64_bf16 a[196:199], v[52:55], v[168:175], v50
    v_mfma_f32_16x16x32_bf16 v[212:215], a[224:227], v[80:83], v[196:199]
    v_exp_f32 v208, v208
    v_mfma_f32_16x16x32_bf16 v[212:215], a[228:231], v[84:87], v[212:215]
    v_exp_f32 v209, v209
    v_mfma_f32_16x16x32_bf16 v[212:215], a[232:235], v[88:91], v[212:215]
    v_exp_f32 v210, v210
    v_mfma_f32_16x16x32_bf16 v[212:215], a[236:239], v[92:95], v[212:215]
    v_exp_f32 v211, v211
    v_mfma_f32_16x16x32_bf16 a[40:43], a[176:179], v[176:179], a[40:43]
    ds_read_b64_tr_b16 a[160:161], v24 offset:16384
    v_cvt_pk_bf16_f32 v130, v208, v209
    v_mfma_f32_16x16x32_bf16 a[40:43], a[180:183], v[180:183], a[40:43]
    ds_read_b64_tr_b16 a[162:163], v24 offset:20480
    v_mfma_f32_16x16x32_bf16 a[44:47], a[180:183], v[188:191], a[44:47]
    ds_read_b128 a[216:219], v10 offset:40960
    v_cvt_pk_bf16_f32 v131, v210, v211
    v_mfma_f32_16x16x32_bf16 a[44:47], a[176:179], v[184:187], a[44:47]
    s_waitcnt lgkmcnt(3)
    buffer_load_dwordx4 v41, s[12:15], s41 offen offset:1024 lds
    v_mfma_f32_16x16x32_bf16 v[208:211], a[224:227], v[96:99], v[200:203]
    v_exp_f32 v212, v212
    v_mfma_f32_16x16x32_bf16 v[208:211], a[228:231], v[100:103], v[208:211]
    v_exp_f32 v213, v213
    v_mfma_f32_16x16x32_bf16 v[208:211], a[232:235], v[104:107], v[208:211]
    v_exp_f32 v214, v214
    v_mfma_f32_16x16x32_bf16 v[208:211], a[236:239], v[108:111], v[208:211]
    v_exp_f32 v215, v215
    v_mfma_f32_16x16x32_bf16 a[48:51], a[184:187], v[160:163], a[48:51]
    ds_read_b64_tr_b16 a[164:165], v24 offset:24576
    v_cvt_pk_bf16_f32 v138, v212, v213
    v_mfma_f32_16x16x32_bf16 a[48:51], a[188:191], v[164:167], a[48:51]
    ds_read_b64_tr_b16 a[166:167], v24 offset:28672
    v_mfma_f32_16x16x32_bf16 a[52:55], a[188:191], v[172:175], a[52:55]
    ds_read_b128 a[220:223], v11 offset:40960
    v_cvt_pk_bf16_f32 v139, v214, v215
    v_mfma_f32_16x16x32_bf16 a[52:55], a[184:187], v[168:171], a[52:55]
    v_smfmac_f32_16x16x64_bf16 a[200:203], v[52:55], v[176:183], v50
    v_mfma_f32_16x16x32_bf16 v[212:215], a[224:227], v[112:115], v[204:207]
    v_exp_f32 v208, v208
    v_mfma_f32_16x16x32_bf16 v[212:215], a[228:231], v[116:119], v[212:215]
    v_exp_f32 v209, v209
    v_mfma_f32_16x16x32_bf16 v[212:215], a[232:235], v[120:123], v[212:215]
    v_exp_f32 v210, v210
    v_mfma_f32_16x16x32_bf16 v[212:215], a[236:239], v[124:127], v[212:215]
    v_exp_f32 v211, v211
    v_mfma_f32_16x16x32_bf16 a[56:59], a[184:187], v[176:179], a[56:59]
    ds_read_b64_tr_b16 a[168:169], v25 offset:16384
    v_cvt_pk_bf16_f32 v146, v208, v209
    v_mfma_f32_16x16x32_bf16 a[56:59], a[188:191], v[180:183], a[56:59]
    ds_read_b64_tr_b16 a[170:171], v25 offset:20480
    v_mfma_f32_16x16x32_bf16 a[60:63], a[188:191], v[188:191], a[60:63]
    ds_read_b128 a[224:227], v8 offset:45056
    v_cvt_pk_bf16_f32 v147, v210, v211
    v_mfma_f32_16x16x32_bf16 a[60:63], a[184:187], v[184:187], a[60:63]
    s_waitcnt lgkmcnt(3)
    buffer_load_dwordx4 v40, s[12:15], s41 offen offset:2048 lds
    v_mfma_f32_16x16x32_bf16 v[208:211], a[208:211], v[64:67], v[192:195]
    v_exp_f32 v212, v212
    v_mfma_f32_16x16x32_bf16 v[208:211], a[212:215], v[68:71], v[208:211]
    v_exp_f32 v213, v213
    v_mfma_f32_16x16x32_bf16 v[208:211], a[216:219], v[72:75], v[208:211]
    v_exp_f32 v214, v214
    v_mfma_f32_16x16x32_bf16 v[208:211], a[220:223], v[76:79], v[208:211]
    v_exp_f32 v215, v215
    v_mfma_f32_16x16x32_bf16 a[64:67], a[160:163], v[160:163], a[64:67]
    ds_read_b64_tr_b16 a[172:173], v25 offset:24576
    v_cvt_pk_bf16_f32 v154, v212, v213
    v_mfma_f32_16x16x32_bf16 a[64:67], a[164:167], v[164:167], a[64:67]
    ds_read_b64_tr_b16 a[174:175], v25 offset:28672
    v_mfma_f32_16x16x32_bf16 a[68:71], a[164:167], v[172:175], a[68:71]
    ds_read_b128 a[228:231], v9 offset:45056
    v_cvt_pk_bf16_f32 v155, v214, v215
    v_mfma_f32_16x16x32_bf16 a[68:71], a[160:163], v[168:171], a[68:71]
    v_smfmac_f32_16x16x64_bf16 a[204:207], v[52:55], v[184:191], v50
    v_mfma_f32_16x16x32_bf16 v[212:215], a[208:211], v[80:83], v[196:199]
    v_exp_f32 v208, v208
    v_mfma_f32_16x16x32_bf16 v[212:215], a[212:215], v[84:87], v[212:215]
    v_exp_f32 v209, v209
    v_mfma_f32_16x16x32_bf16 v[212:215], a[216:219], v[88:91], v[212:215]
    v_exp_f32 v210, v210
    v_mfma_f32_16x16x32_bf16 v[212:215], a[220:223], v[92:95], v[212:215]
    v_exp_f32 v211, v211
    v_mfma_f32_16x16x32_bf16 a[72:75], a[160:163], v[176:179], a[72:75]
    ds_read_b64_tr_b16 a[176:177], v26 offset:16384
    v_cvt_pk_bf16_f32 v132, v208, v209
    v_mfma_f32_16x16x32_bf16 a[72:75], a[164:167], v[180:183], a[72:75]
    ds_read_b64_tr_b16 a[178:179], v26 offset:20480
    v_mfma_f32_16x16x32_bf16 a[76:79], a[164:167], v[188:191], a[76:79]
    ds_read_b128 a[232:235], v10 offset:45056
    v_cvt_pk_bf16_f32 v133, v210, v211
    v_mfma_f32_16x16x32_bf16 a[76:79], a[160:163], v[184:187], a[76:79]
    s_waitcnt lgkmcnt(3)
    buffer_load_dwordx4 v41, s[12:15], s41 offen offset:3072 lds
    v_mfma_f32_16x16x32_bf16 v[208:211], a[208:211], v[96:99], v[200:203]
    v_exp_f32 v212, v212
    v_mfma_f32_16x16x32_bf16 v[208:211], a[212:215], v[100:103], v[208:211]
    s_add_u32 s41, s41, 16384
    v_exp_f32 v213, v213
    v_mfma_f32_16x16x32_bf16 v[208:211], a[216:219], v[104:107], v[208:211]
    v_exp_f32 v214, v214
    v_mfma_f32_16x16x32_bf16 v[208:211], a[220:223], v[108:111], v[208:211]
    v_exp_f32 v215, v215
    v_mfma_f32_16x16x32_bf16 a[80:83], a[168:171], v[160:163], a[80:83]
    ds_read_b64_tr_b16 a[180:181], v26 offset:24576
    v_cvt_pk_bf16_f32 v140, v212, v213
    v_mfma_f32_16x16x32_bf16 a[80:83], a[172:175], v[164:167], a[80:83]
    ds_read_b64_tr_b16 a[182:183], v26 offset:28672
    v_mfma_f32_16x16x32_bf16 a[84:87], a[172:175], v[172:175], a[84:87]
    ds_read_b128 a[236:239], v11 offset:45056
    v_cvt_pk_bf16_f32 v141, v214, v215
    v_mfma_f32_16x16x32_bf16 a[84:87], a[168:171], v[168:171], a[84:87]
    s_waitcnt vmcnt(9)
    s_barrier
    v_mfma_f32_16x16x32_bf16 v[212:215], a[208:211], v[112:115], v[204:207]
    v_exp_f32 v208, v208
    v_mfma_f32_16x16x32_bf16 v[212:215], a[212:215], v[116:119], v[212:215]
    s_add_u32 m0, s42, 16384
    v_exp_f32 v209, v209
    v_mfma_f32_16x16x32_bf16 v[212:215], a[216:219], v[120:123], v[212:215]
    v_exp_f32 v210, v210
    v_mfma_f32_16x16x32_bf16 v[212:215], a[220:223], v[124:127], v[212:215]
    v_exp_f32 v211, v211
    v_mfma_f32_16x16x32_bf16 a[88:91], a[168:171], v[176:179], a[88:91]
    ds_read_b64_tr_b16 a[184:185], v27 offset:16384
    v_cvt_pk_bf16_f32 v148, v208, v209
    v_mfma_f32_16x16x32_bf16 a[88:91], a[172:175], v[180:183], a[88:91]
    ds_read_b64_tr_b16 a[186:187], v27 offset:20480
    v_mfma_f32_16x16x32_bf16 a[92:95], a[172:175], v[188:191], a[92:95]
    ds_read_b128 a[208:211], v8 offset:49152
    v_cvt_pk_bf16_f32 v149, v210, v211
    v_mfma_f32_16x16x32_bf16 a[92:95], a[168:171], v[184:187], a[92:95]
    s_waitcnt lgkmcnt(3)
    buffer_load_dwordx4 v36, s[8:11], s40 offen lds
    v_mfma_f32_16x16x32_bf16 v[208:211], a[224:227], v[64:67], v[192:195]
    v_exp_f32 v212, v212
    v_mfma_f32_16x16x32_bf16 v[208:211], a[228:231], v[68:71], v[208:211]
    v_exp_f32 v213, v213
    v_mfma_f32_16x16x32_bf16 v[208:211], a[232:235], v[72:75], v[208:211]
    v_exp_f32 v214, v214
    v_mfma_f32_16x16x32_bf16 v[208:211], a[236:239], v[76:79], v[208:211]
    v_exp_f32 v215, v215
    v_mfma_f32_16x16x32_bf16 a[96:99], a[176:179], v[160:163], a[96:99]
    ds_read_b64_tr_b16 a[188:189], v27 offset:24576
    v_cvt_pk_bf16_f32 v156, v212, v213
    v_mfma_f32_16x16x32_bf16 a[96:99], a[180:183], v[164:167], a[96:99]
    ds_read_b64_tr_b16 a[190:191], v27 offset:28672
    v_mfma_f32_16x16x32_bf16 a[100:103], a[180:183], v[172:175], a[100:103]
    ds_read_b128 a[212:215], v9 offset:49152
    v_cvt_pk_bf16_f32 v157, v214, v215
    v_mfma_f32_16x16x32_bf16 a[100:103], a[176:179], v[168:171], a[100:103]
    buffer_load_dword v218, v57, s[80:83], s39 offen
    v_mfma_f32_16x16x32_bf16 v[212:215], a[224:227], v[80:83], v[196:199]
    v_exp_f32 v208, v208
    v_mfma_f32_16x16x32_bf16 v[212:215], a[228:231], v[84:87], v[212:215]
    v_exp_f32 v209, v209
    v_mfma_f32_16x16x32_bf16 v[212:215], a[232:235], v[88:91], v[212:215]
    v_exp_f32 v210, v210
    v_mfma_f32_16x16x32_bf16 v[212:215], a[236:239], v[92:95], v[212:215]
    v_exp_f32 v211, v211
    v_mfma_f32_16x16x32_bf16 a[104:107], a[176:179], v[176:179], a[104:107]
    ds_read_b64_tr_b16 a[160:161], v20 offset:32768
    v_cvt_pk_bf16_f32 v134, v208, v209
    v_mfma_f32_16x16x32_bf16 a[104:107], a[180:183], v[180:183], a[104:107]
    ds_read_b64_tr_b16 a[162:163], v20 offset:36864
    v_mfma_f32_16x16x32_bf16 a[108:111], a[180:183], v[188:191], a[108:111]
    ds_read_b128 a[216:219], v10 offset:49152
    v_cvt_pk_bf16_f32 v135, v210, v211
    v_mfma_f32_16x16x32_bf16 a[108:111], a[176:179], v[184:187], a[108:111]
    s_waitcnt lgkmcnt(3)
    buffer_load_dwordx4 v37, s[8:11], s40 offen offset:1024 lds
    v_mfma_f32_16x16x32_bf16 v[208:211], a[224:227], v[96:99], v[200:203]
    v_exp_f32 v212, v212
    v_mfma_f32_16x16x32_bf16 v[208:211], a[228:231], v[100:103], v[208:211]
    v_exp_f32 v213, v213
    v_mfma_f32_16x16x32_bf16 v[208:211], a[232:235], v[104:107], v[208:211]
    v_exp_f32 v214, v214
    v_mfma_f32_16x16x32_bf16 v[208:211], a[236:239], v[108:111], v[208:211]
    v_exp_f32 v215, v215
    v_mfma_f32_16x16x32_bf16 a[112:115], a[184:187], v[160:163], a[112:115]
    ds_read_b64_tr_b16 a[164:165], v20 offset:40960
    v_cvt_pk_bf16_f32 v142, v212, v213
    v_mfma_f32_16x16x32_bf16 a[112:115], a[188:191], v[164:167], a[112:115]
    ds_read_b64_tr_b16 a[166:167], v20 offset:45056
    v_mfma_f32_16x16x32_bf16 a[116:119], a[188:191], v[172:175], a[116:119]
    ds_read_b128 a[220:223], v11 offset:49152
    v_cvt_pk_bf16_f32 v143, v214, v215
    v_mfma_f32_16x16x32_bf16 a[116:119], a[184:187], v[168:171], a[116:119]
    buffer_store_dwordx4 v[248:251], v232, s[24:27], s53 offen sc1
    v_mfma_f32_16x16x32_bf16 v[212:215], a[224:227], v[112:115], v[204:207]
    v_exp_f32 v208, v208
    v_mfma_f32_16x16x32_bf16 v[212:215], a[228:231], v[116:119], v[212:215]
    v_exp_f32 v209, v209
    v_mfma_f32_16x16x32_bf16 v[212:215], a[232:235], v[120:123], v[212:215]
    v_exp_f32 v210, v210
    v_mfma_f32_16x16x32_bf16 v[212:215], a[236:239], v[124:127], v[212:215]
    s_add_u32 s53, s53, 656
    v_exp_f32 v211, v211
    v_mfma_f32_16x16x32_bf16 a[120:123], a[184:187], v[176:179], a[120:123]
    ds_read_b64_tr_b16 a[168:169], v21 offset:32768
    v_cvt_pk_bf16_f32 v150, v208, v209
    v_mfma_f32_16x16x32_bf16 a[120:123], a[188:191], v[180:183], a[120:123]
    ds_read_b64_tr_b16 a[170:171], v21 offset:36864
    v_mfma_f32_16x16x32_bf16 a[124:127], a[188:191], v[188:191], a[124:127]
    ds_read_b128 a[224:227], v8 offset:53248
    v_cvt_pk_bf16_f32 v151, v210, v211
    v_mfma_f32_16x16x32_bf16 a[124:127], a[184:187], v[184:187], a[124:127]
    s_waitcnt lgkmcnt(3)
    buffer_load_dwordx4 v38, s[8:11], s40 offen offset:2048 lds
    v_mfma_f32_16x16x32_bf16 v[208:211], a[208:211], v[64:67], v[192:195]
    v_exp_f32 v212, v212
    v_mfma_f32_16x16x32_bf16 v[208:211], a[212:215], v[68:71], v[208:211]
    v_exp_f32 v213, v213
    v_mfma_f32_16x16x32_bf16 v[208:211], a[216:219], v[72:75], v[208:211]
    v_exp_f32 v214, v214
    v_mfma_f32_16x16x32_bf16 v[208:211], a[220:223], v[76:79], v[208:211]
    v_exp_f32 v215, v215
    v_mfma_f32_16x16x32_bf16 a[0:3], a[160:163], v[128:131], a[0:3]
    ds_read_b64_tr_b16 a[172:173], v21 offset:40960
    v_cvt_pk_bf16_f32 v158, v212, v213
    v_mfma_f32_16x16x32_bf16 a[0:3], a[164:167], v[132:135], a[0:3]
    ds_read_b64_tr_b16 a[174:175], v21 offset:45056
    v_mfma_f32_16x16x32_bf16 a[4:7], a[164:167], v[140:143], a[4:7]
    ds_read_b128 a[228:231], v9 offset:53248
    v_cvt_pk_bf16_f32 v159, v214, v215
    v_mfma_f32_16x16x32_bf16 a[4:7], a[160:163], v[136:139], a[4:7]
    v_mfma_f32_16x16x32_bf16 v[212:215], a[208:211], v[80:83], v[196:199]
    v_exp_f32 v208, v208
    v_mfma_f32_16x16x32_bf16 v[212:215], a[212:215], v[84:87], v[212:215]
    v_exp_f32 v209, v209
    v_mfma_f32_16x16x32_bf16 v[212:215], a[216:219], v[88:91], v[212:215]
    v_exp_f32 v210, v210
    v_mfma_f32_16x16x32_bf16 v[212:215], a[220:223], v[92:95], v[212:215]
    v_exp_f32 v211, v211
    v_mfma_f32_16x16x32_bf16 a[8:11], a[160:163], v[144:147], a[8:11]
    ds_read_b64_tr_b16 a[176:177], v22 offset:32768
    v_cvt_pk_bf16_f32 v160, v208, v209
    v_mfma_f32_16x16x32_bf16 a[8:11], a[164:167], v[148:151], a[8:11]
    ds_read_b64_tr_b16 a[178:179], v22 offset:36864
    v_mfma_f32_16x16x32_bf16 a[12:15], a[164:167], v[156:159], a[12:15]
    ds_read_b128 a[232:235], v10 offset:53248
    v_cvt_pk_bf16_f32 v161, v210, v211
    v_mfma_f32_16x16x32_bf16 a[12:15], a[160:163], v[152:155], a[12:15]
    s_waitcnt lgkmcnt(3)
    buffer_load_dwordx4 v39, s[8:11], s40 offen offset:3072 lds
    v_mfma_f32_16x16x32_bf16 v[208:211], a[208:211], v[96:99], v[200:203]
    v_exp_f32 v212, v212
    v_mfma_f32_16x16x32_bf16 v[208:211], a[212:215], v[100:103], v[208:211]
    s_add_u32 s40, s40, 16384
    v_exp_f32 v213, v213
    v_mfma_f32_16x16x32_bf16 v[208:211], a[216:219], v[104:107], v[208:211]
    v_exp_f32 v214, v214
    v_mfma_f32_16x16x32_bf16 v[208:211], a[220:223], v[108:111], v[208:211]
    v_exp_f32 v215, v215
    v_mfma_f32_16x16x32_bf16 a[16:19], a[168:171], v[128:131], a[16:19]
    ds_read_b64_tr_b16 a[180:181], v22 offset:40960
    v_cvt_pk_bf16_f32 v168, v212, v213
    v_mfma_f32_16x16x32_bf16 a[16:19], a[172:175], v[132:135], a[16:19]
    ds_read_b64_tr_b16 a[182:183], v22 offset:45056
    v_mfma_f32_16x16x32_bf16 a[20:23], a[172:175], v[140:143], a[20:23]
    ds_read_b128 a[236:239], v11 offset:53248
    v_cvt_pk_bf16_f32 v169, v214, v215
    v_mfma_f32_16x16x32_bf16 a[20:23], a[168:171], v[136:139], a[20:23]
    v_smfmac_f32_16x16x64_bf16 a[192:195], v[52:55], v[128:135], v50
    v_mfma_f32_16x16x32_bf16 v[212:215], a[208:211], v[112:115], v[204:207]
    v_exp_f32 v208, v208
    v_mfma_f32_16x16x32_bf16 v[212:215], a[212:215], v[116:119], v[212:215]
    s_add_u32 m0, s42, 65536
    v_exp_f32 v209, v209
    v_mfma_f32_16x16x32_bf16 v[212:215], a[216:219], v[120:123], v[212:215]
    v_exp_f32 v210, v210
    v_mfma_f32_16x16x32_bf16 v[212:215], a[220:223], v[124:127], v[212:215]
    v_exp_f32 v211, v211
    v_mfma_f32_16x16x32_bf16 a[24:27], a[168:171], v[144:147], a[24:27]
    ds_read_b64_tr_b16 a[184:185], v23 offset:32768
    v_cvt_pk_bf16_f32 v176, v208, v209
    v_mfma_f32_16x16x32_bf16 a[24:27], a[172:175], v[148:151], a[24:27]
    ds_read_b64_tr_b16 a[186:187], v23 offset:36864
    v_mfma_f32_16x16x32_bf16 a[28:31], a[172:175], v[156:159], a[28:31]
    ds_read_b128 a[208:211], v8 offset:57344
    v_cvt_pk_bf16_f32 v177, v210, v211
    v_mfma_f32_16x16x32_bf16 a[28:31], a[168:171], v[152:155], a[28:31]
    s_waitcnt lgkmcnt(3)
    buffer_load_dwordx4 v40, s[12:15], s41 offen lds
    v_mfma_f32_16x16x32_bf16 v[208:211], a[224:227], v[64:67], v[192:195]
    v_exp_f32 v212, v212
    v_mfma_f32_16x16x32_bf16 v[208:211], a[228:231], v[68:71], v[208:211]
    v_exp_f32 v213, v213
    v_mfma_f32_16x16x32_bf16 v[208:211], a[232:235], v[72:75], v[208:211]
    v_exp_f32 v214, v214
    v_mfma_f32_16x16x32_bf16 v[208:211], a[236:239], v[76:79], v[208:211]
    v_exp_f32 v215, v215
    v_mfma_f32_16x16x32_bf16 a[32:35], a[176:179], v[128:131], a[32:35]
    ds_read_b64_tr_b16 a[188:189], v23 offset:40960
    v_cvt_pk_bf16_f32 v184, v212, v213
    v_mfma_f32_16x16x32_bf16 a[32:35], a[180:183], v[132:135], a[32:35]
    ds_read_b64_tr_b16 a[190:191], v23 offset:45056
    v_mfma_f32_16x16x32_bf16 a[36:39], a[180:183], v[140:143], a[36:39]
    ds_read_b128 a[212:215], v9 offset:57344
    v_cvt_pk_bf16_f32 v185, v214, v215
    v_mfma_f32_16x16x32_bf16 a[36:39], a[176:179], v[136:139], a[36:39]
    v_smfmac_f32_16x16x64_bf16 a[196:199], v[52:55], v[136:143], v50
    v_mfma_f32_16x16x32_bf16 v[212:215], a[224:227], v[80:83], v[196:199]
    v_exp_f32 v208, v208
    v_mfma_f32_16x16x32_bf16 v[212:215], a[228:231], v[84:87], v[212:215]
    v_exp_f32 v209, v209
    v_mfma_f32_16x16x32_bf16 v[212:215], a[232:235], v[88:91], v[212:215]
    v_exp_f32 v210, v210
    v_mfma_f32_16x16x32_bf16 v[212:215], a[236:239], v[92:95], v[212:215]
    v_exp_f32 v211, v211
    v_mfma_f32_16x16x32_bf16 a[40:43], a[176:179], v[144:147], a[40:43]
    ds_read_b64_tr_b16 a[160:161], v24 offset:32768
    v_cvt_pk_bf16_f32 v162, v208, v209
    v_mfma_f32_16x16x32_bf16 a[40:43], a[180:183], v[148:151], a[40:43]
    ds_read_b64_tr_b16 a[162:163], v24 offset:36864
    v_mfma_f32_16x16x32_bf16 a[44:47], a[180:183], v[156:159], a[44:47]
    ds_read_b128 a[216:219], v10 offset:57344
    v_cvt_pk_bf16_f32 v163, v210, v211
    v_mfma_f32_16x16x32_bf16 a[44:47], a[176:179], v[152:155], a[44:47]
    s_waitcnt lgkmcnt(3)
    buffer_load_dwordx4 v41, s[12:15], s41 offen offset:1024 lds
    v_mfma_f32_16x16x32_bf16 v[208:211], a[224:227], v[96:99], v[200:203]
    v_exp_f32 v212, v212
    v_mfma_f32_16x16x32_bf16 v[208:211], a[228:231], v[100:103], v[208:211]
    v_exp_f32 v213, v213
    v_mfma_f32_16x16x32_bf16 v[208:211], a[232:235], v[104:107], v[208:211]
    v_exp_f32 v214, v214
    v_mfma_f32_16x16x32_bf16 v[208:211], a[236:239], v[108:111], v[208:211]
    v_exp_f32 v215, v215
    v_mfma_f32_16x16x32_bf16 a[48:51], a[184:187], v[128:131], a[48:51]
    ds_read_b64_tr_b16 a[164:165], v24 offset:40960
    v_cvt_pk_bf16_f32 v170, v212, v213
    v_mfma_f32_16x16x32_bf16 a[48:51], a[188:191], v[132:135], a[48:51]
    ds_read_b64_tr_b16 a[166:167], v24 offset:45056
    v_mfma_f32_16x16x32_bf16 a[52:55], a[188:191], v[140:143], a[52:55]
    ds_read_b128 a[220:223], v11 offset:57344
    v_cvt_pk_bf16_f32 v171, v214, v215
    v_mfma_f32_16x16x32_bf16 a[52:55], a[184:187], v[136:139], a[52:55]
    v_smfmac_f32_16x16x64_bf16 a[200:203], v[52:55], v[144:151], v50
    v_mfma_f32_16x16x32_bf16 v[212:215], a[224:227], v[112:115], v[204:207]
    v_exp_f32 v208, v208
    v_mfma_f32_16x16x32_bf16 v[212:215], a[228:231], v[116:119], v[212:215]
    v_exp_f32 v209, v209
    v_mfma_f32_16x16x32_bf16 v[212:215], a[232:235], v[120:123], v[212:215]
    v_exp_f32 v210, v210
    v_mfma_f32_16x16x32_bf16 v[212:215], a[236:239], v[124:127], v[212:215]
    v_exp_f32 v211, v211
    v_mfma_f32_16x16x32_bf16 a[56:59], a[184:187], v[144:147], a[56:59]
    ds_read_b64_tr_b16 a[168:169], v25 offset:32768
    v_cvt_pk_bf16_f32 v178, v208, v209
    v_mfma_f32_16x16x32_bf16 a[56:59], a[188:191], v[148:151], a[56:59]
    ds_read_b64_tr_b16 a[170:171], v25 offset:36864
    v_mfma_f32_16x16x32_bf16 a[60:63], a[188:191], v[156:159], a[60:63]
    ds_read_b128 a[224:227], v8 offset:61440
    v_cvt_pk_bf16_f32 v179, v210, v211
    v_mfma_f32_16x16x32_bf16 a[60:63], a[184:187], v[152:155], a[60:63]
    s_waitcnt lgkmcnt(3)
    buffer_load_dwordx4 v40, s[12:15], s41 offen offset:2048 lds
    v_mfma_f32_16x16x32_bf16 v[208:211], a[208:211], v[64:67], v[192:195]
    v_exp_f32 v212, v212
    v_mfma_f32_16x16x32_bf16 v[208:211], a[212:215], v[68:71], v[208:211]
    v_exp_f32 v213, v213
    v_mfma_f32_16x16x32_bf16 v[208:211], a[216:219], v[72:75], v[208:211]
    v_exp_f32 v214, v214
    v_mfma_f32_16x16x32_bf16 v[208:211], a[220:223], v[76:79], v[208:211]
    v_exp_f32 v215, v215
    v_mfma_f32_16x16x32_bf16 a[64:67], a[160:163], v[128:131], a[64:67]
    ds_read_b64_tr_b16 a[172:173], v25 offset:40960
    v_cvt_pk_bf16_f32 v186, v212, v213
    v_mfma_f32_16x16x32_bf16 a[64:67], a[164:167], v[132:135], a[64:67]
    ds_read_b64_tr_b16 a[174:175], v25 offset:45056
    v_mfma_f32_16x16x32_bf16 a[68:71], a[164:167], v[140:143], a[68:71]
    ds_read_b128 a[228:231], v9 offset:61440
    v_cvt_pk_bf16_f32 v187, v214, v215
    v_mfma_f32_16x16x32_bf16 a[68:71], a[160:163], v[136:139], a[68:71]
    v_smfmac_f32_16x16x64_bf16 a[204:207], v[52:55], v[152:159], v50
    v_mfma_f32_16x16x32_bf16 v[212:215], a[208:211], v[80:83], v[196:199]
    v_exp_f32 v208, v208
    v_mfma_f32_16x16x32_bf16 v[212:215], a[212:215], v[84:87], v[212:215]
    v_exp_f32 v209, v209
    v_mfma_f32_16x16x32_bf16 v[212:215], a[216:219], v[88:91], v[212:215]
    v_exp_f32 v210, v210
    v_mfma_f32_16x16x32_bf16 v[212:215], a[220:223], v[92:95], v[212:215]
    v_exp_f32 v211, v211
    v_mfma_f32_16x16x32_bf16 a[72:75], a[160:163], v[144:147], a[72:75]
    ds_read_b64_tr_b16 a[176:177], v26 offset:32768
    v_cvt_pk_bf16_f32 v164, v208, v209
    v_mfma_f32_16x16x32_bf16 a[72:75], a[164:167], v[148:151], a[72:75]
    ds_read_b64_tr_b16 a[178:179], v26 offset:36864
    v_mfma_f32_16x16x32_bf16 a[76:79], a[164:167], v[156:159], a[76:79]
    ds_read_b128 a[232:235], v10 offset:61440
    v_cvt_pk_bf16_f32 v165, v210, v211
    v_mfma_f32_16x16x32_bf16 a[76:79], a[160:163], v[152:155], a[76:79]
    s_waitcnt lgkmcnt(3)
    buffer_load_dwordx4 v41, s[12:15], s41 offen offset:3072 lds
    v_mfma_f32_16x16x32_bf16 v[208:211], a[208:211], v[96:99], v[200:203]
    v_exp_f32 v212, v212
    v_mfma_f32_16x16x32_bf16 v[208:211], a[212:215], v[100:103], v[208:211]
    s_add_u32 s41, s41, 16384
    v_exp_f32 v213, v213
    v_mfma_f32_16x16x32_bf16 v[208:211], a[216:219], v[104:107], v[208:211]
    v_exp_f32 v214, v214
    v_mfma_f32_16x16x32_bf16 v[208:211], a[220:223], v[108:111], v[208:211]
    v_exp_f32 v215, v215
    v_mfma_f32_16x16x32_bf16 a[80:83], a[168:171], v[128:131], a[80:83]
    ds_read_b64_tr_b16 a[180:181], v26 offset:40960
    v_cvt_pk_bf16_f32 v172, v212, v213
    v_mfma_f32_16x16x32_bf16 a[80:83], a[172:175], v[132:135], a[80:83]
    ds_read_b64_tr_b16 a[182:183], v26 offset:45056
    v_mfma_f32_16x16x32_bf16 a[84:87], a[172:175], v[140:143], a[84:87]
    ds_read_b128 a[236:239], v11 offset:61440
    v_cvt_pk_bf16_f32 v173, v214, v215
    v_mfma_f32_16x16x32_bf16 a[84:87], a[168:171], v[136:139], a[84:87]
    s_waitcnt vmcnt(10)
    s_barrier
    v_mfma_f32_16x16x32_bf16 v[212:215], a[208:211], v[112:115], v[204:207]
    v_exp_f32 v208, v208
    v_mfma_f32_16x16x32_bf16 v[212:215], a[212:215], v[116:119], v[212:215]
    s_add_u32 m0, s42, 32768
    v_exp_f32 v209, v209
    v_mfma_f32_16x16x32_bf16 v[212:215], a[216:219], v[120:123], v[212:215]
    v_exp_f32 v210, v210
    v_mfma_f32_16x16x32_bf16 v[212:215], a[220:223], v[124:127], v[212:215]
    v_exp_f32 v211, v211
    v_mfma_f32_16x16x32_bf16 a[88:91], a[168:171], v[144:147], a[88:91]
    ds_read_b64_tr_b16 a[184:185], v27 offset:32768
    v_cvt_pk_bf16_f32 v180, v208, v209
    v_mfma_f32_16x16x32_bf16 a[88:91], a[172:175], v[148:151], a[88:91]
    ds_read_b64_tr_b16 a[186:187], v27 offset:36864
    v_mfma_f32_16x16x32_bf16 a[92:95], a[172:175], v[156:159], a[92:95]
    ds_read_b128 a[208:211], v8 offset:0
    v_cvt_pk_bf16_f32 v181, v210, v211
    v_mfma_f32_16x16x32_bf16 a[92:95], a[168:171], v[152:155], a[92:95]
    s_waitcnt lgkmcnt(3)
    buffer_load_dwordx4 v36, s[8:11], s40 offen lds
    v_mfma_f32_16x16x32_bf16 v[208:211], a[224:227], v[64:67], v[192:195]
    v_exp_f32 v212, v212
    v_mfma_f32_16x16x32_bf16 v[208:211], a[228:231], v[68:71], v[208:211]
    v_exp_f32 v213, v213
    v_mfma_f32_16x16x32_bf16 v[208:211], a[232:235], v[72:75], v[208:211]
    v_exp_f32 v214, v214
    v_mfma_f32_16x16x32_bf16 v[208:211], a[236:239], v[76:79], v[208:211]
    v_exp_f32 v215, v215
    v_mfma_f32_16x16x32_bf16 a[96:99], a[176:179], v[128:131], a[96:99]
    ds_read_b64_tr_b16 a[188:189], v27 offset:40960
    v_cvt_pk_bf16_f32 v188, v212, v213
    v_mfma_f32_16x16x32_bf16 a[96:99], a[180:183], v[132:135], a[96:99]
    ds_read_b64_tr_b16 a[190:191], v27 offset:45056
    v_mfma_f32_16x16x32_bf16 a[100:103], a[180:183], v[140:143], a[100:103]
    ds_read_b128 a[212:215], v9 offset:0
    v_cvt_pk_bf16_f32 v189, v214, v215
    v_mfma_f32_16x16x32_bf16 a[100:103], a[176:179], v[136:139], a[100:103]
    buffer_load_dword v219, v62, s[84:87], s38 offen
    v_mfma_f32_16x16x32_bf16 v[212:215], a[224:227], v[80:83], v[196:199]
    v_exp_f32 v208, v208
    v_mfma_f32_16x16x32_bf16 v[212:215], a[228:231], v[84:87], v[212:215]
    v_exp_f32 v209, v209
    v_mfma_f32_16x16x32_bf16 v[212:215], a[232:235], v[88:91], v[212:215]
    v_exp_f32 v210, v210
    v_mfma_f32_16x16x32_bf16 v[212:215], a[236:239], v[92:95], v[212:215]
    v_exp_f32 v211, v211
    v_mfma_f32_16x16x32_bf16 a[104:107], a[176:179], v[144:147], a[104:107]
    ds_read_b64_tr_b16 a[160:161], v20 offset:49152
    v_cvt_pk_bf16_f32 v166, v208, v209
    v_mfma_f32_16x16x32_bf16 a[104:107], a[180:183], v[148:151], a[104:107]
    ds_read_b64_tr_b16 a[162:163], v20 offset:53248
    v_mfma_f32_16x16x32_bf16 a[108:111], a[180:183], v[156:159], a[108:111]
    ds_read_b128 a[216:219], v10 offset:0
    v_cvt_pk_bf16_f32 v167, v210, v211
    v_mfma_f32_16x16x32_bf16 a[108:111], a[176:179], v[152:155], a[108:111]
    s_waitcnt lgkmcnt(3)
    buffer_load_dwordx4 v37, s[8:11], s40 offen offset:1024 lds
    v_mfma_f32_16x16x32_bf16 v[208:211], a[224:227], v[96:99], v[200:203]
    v_exp_f32 v212, v212
    v_mfma_f32_16x16x32_bf16 v[208:211], a[228:231], v[100:103], v[208:211]
    v_exp_f32 v213, v213
    v_mfma_f32_16x16x32_bf16 v[208:211], a[232:235], v[104:107], v[208:211]
    v_exp_f32 v214, v214
    v_mfma_f32_16x16x32_bf16 v[208:211], a[236:239], v[108:111], v[208:211]
    v_exp_f32 v215, v215
    v_mfma_f32_16x16x32_bf16 a[112:115], a[184:187], v[128:131], a[112:115]
    ds_read_b64_tr_b16 a[164:165], v20 offset:57344
    v_cvt_pk_bf16_f32 v174, v212, v213
    v_mfma_f32_16x16x32_bf16 a[112:115], a[188:191], v[132:135], a[112:115]
    ds_read_b64_tr_b16 a[166:167], v20 offset:61440
    v_mfma_f32_16x16x32_bf16 a[116:119], a[188:191], v[140:143], a[116:119]
    ds_read_b128 a[220:223], v11 offset:0
    v_cvt_pk_bf16_f32 v175, v214, v215
    v_mfma_f32_16x16x32_bf16 a[116:119], a[184:187], v[136:139], a[116:119]
    buffer_load_dword v221, v235, s[20:23], 0 offen
    v_mfma_f32_16x16x32_bf16 v[212:215], a[224:227], v[112:115], v[204:207]
    v_exp_f32 v208, v208
    v_mfma_f32_16x16x32_bf16 v[212:215], a[228:231], v[116:119], v[212:215]
    v_exp_f32 v209, v209
    v_mfma_f32_16x16x32_bf16 v[212:215], a[232:235], v[120:123], v[212:215]
    v_exp_f32 v210, v210
    v_mfma_f32_16x16x32_bf16 v[212:215], a[236:239], v[124:127], v[212:215]
    v_exp_f32 v211, v211
    v_mfma_f32_16x16x32_bf16 a[120:123], a[184:187], v[144:147], a[120:123]
    ds_read_b64_tr_b16 a[168:169], v21 offset:49152
    v_cvt_pk_bf16_f32 v182, v208, v209
    v_mfma_f32_16x16x32_bf16 a[120:123], a[188:191], v[148:151], a[120:123]
Ltour0_5:
    s_cbranch_execz Ltour0_9
    ds_read_b64_tr_b16 a[170:171], v21 offset:53248
    v_add_u32 v235, 2560, v235
    v_mfma_f32_16x16x32_bf16 a[124:127], a[188:191], v[156:159], a[124:127]
    ds_read_b128 a[224:227], v8 offset:4096
    v_cvt_pk_bf16_f32 v183, v210, v211
    v_mfma_f32_16x16x32_bf16 a[124:127], a[184:187], v[152:155], a[124:127]
    s_waitcnt lgkmcnt(3)
    buffer_load_dwordx4 v38, s[8:11], s40 offen offset:2048 lds
    v_mfma_f32_16x16x32_bf16 v[208:211], a[208:211], v[64:67], v[192:195]
    v_exp_f32 v212, v212
    v_mfma_f32_16x16x32_bf16 v[208:211], a[212:215], v[68:71], v[208:211]
    v_exp_f32 v213, v213
    v_mfma_f32_16x16x32_bf16 v[208:211], a[216:219], v[72:75], v[208:211]
    v_exp_f32 v214, v214
    v_mfma_f32_16x16x32_bf16 v[208:211], a[220:223], v[76:79], v[208:211]
    v_exp_f32 v215, v215
    v_mfma_f32_16x16x32_bf16 a[0:3], a[160:163], v[160:163], a[0:3]
    ds_read_b64_tr_b16 a[172:173], v21 offset:57344
    v_cvt_pk_bf16_f32 v190, v212, v213
    v_mfma_f32_16x16x32_bf16 a[0:3], a[164:167], v[164:167], a[0:3]
    ds_read_b64_tr_b16 a[174:175], v21 offset:61440
    v_lshlrev_b32 v244, 16, v240
    v_mfma_f32_16x16x32_bf16 a[4:7], a[164:167], v[172:175], a[4:7]
    ds_read_b128 a[228:231], v9 offset:4096
    v_cvt_pk_bf16_f32 v191, v214, v215
    v_mfma_f32_16x16x32_bf16 a[4:7], a[160:163], v[168:171], a[4:7]
    v_and_b32 v245, 0xffff0000, v240
    v_fmac_f32 v224, v2, v244
    v_mfma_f32_16x16x32_bf16 v[212:215], a[208:211], v[80:83], v[196:199]
    v_exp_f32 v208, v208
    v_mfma_f32_16x16x32_bf16 v[212:215], a[212:215], v[84:87], v[212:215]
    v_exp_f32 v209, v209
    v_mfma_f32_16x16x32_bf16 v[212:215], a[216:219], v[88:91], v[212:215]
    v_exp_f32 v210, v210
    v_mfma_f32_16x16x32_bf16 v[212:215], a[220:223], v[92:95], v[212:215]
    v_exp_f32 v211, v211
    v_mfma_f32_16x16x32_bf16 a[8:11], a[160:163], v[176:179], a[8:11]
    ds_read_b64_tr_b16 a[176:177], v22 offset:49152
    v_cvt_pk_bf16_f32 v128, v208, v209
    v_mfma_f32_16x16x32_bf16 a[8:11], a[164:167], v[180:183], a[8:11]
    ds_read_b64_tr_b16 a[178:179], v22 offset:53248
    v_fmac_f32 v225, v2, v245
    v_mfma_f32_16x16x32_bf16 a[12:15], a[164:167], v[188:191], a[12:15]
    ds_read_b128 a[232:235], v10 offset:4096
    v_cvt_pk_bf16_f32 v129, v210, v211
    v_mfma_f32_16x16x32_bf16 a[12:15], a[160:163], v[184:187], a[12:15]
    s_waitcnt lgkmcnt(3)
    buffer_load_dwordx4 v39, s[8:11], s40 offen offset:3072 lds
    v_mfma_f32_16x16x32_bf16 v[208:211], a[208:211], v[96:99], v[200:203]
    v_exp_f32 v212, v212
    v_mfma_f32_16x16x32_bf16 v[208:211], a[212:215], v[100:103], v[208:211]
    s_add_u32 s40, s40, 16384
    v_exp_f32 v213, v213
    v_mfma_f32_16x16x32_bf16 v[208:211], a[216:219], v[104:107], v[208:211]
    v_exp_f32 v214, v214
    v_mfma_f32_16x16x32_bf16 v[208:211], a[220:223], v[108:111], v[208:211]
    v_exp_f32 v215, v215
    v_mfma_f32_16x16x32_bf16 a[16:19], a[168:171], v[160:163], a[16:19]
    ds_read_b64_tr_b16 a[180:181], v22 offset:57344
    v_cvt_pk_bf16_f32 v136, v212, v213
    v_mfma_f32_16x16x32_bf16 a[16:19], a[172:175], v[164:167], a[16:19]
    ds_read_b64_tr_b16 a[182:183], v22 offset:61440
    v_lshlrev_b32 v246, 16, v241
    v_mfma_f32_16x16x32_bf16 a[20:23], a[172:175], v[172:175], a[20:23]
    ds_read_b128 a[236:239], v11 offset:4096
    v_cvt_pk_bf16_f32 v137, v214, v215
    v_mfma_f32_16x16x32_bf16 a[20:23], a[168:171], v[168:171], a[20:23]
    v_and_b32 v247, 0xffff0000, v241
    v_fmac_f32 v226, v2, v246
    v_smfmac_f32_16x16x64_bf16 a[192:195], v[52:55], v[160:167], v50
    v_mfma_f32_16x16x32_bf16 v[212:215], a[208:211], v[112:115], v[204:207]
    v_exp_f32 v208, v208
    v_mfma_f32_16x16x32_bf16 v[212:215], a[212:215], v[116:119], v[212:215]
    s_add_u32 m0, s42, 81920
    v_exp_f32 v209, v209
    v_mfma_f32_16x16x32_bf16 v[212:215], a[216:219], v[120:123], v[212:215]
    v_exp_f32 v210, v210
    v_mfma_f32_16x16x32_bf16 v[212:215], a[220:223], v[124:127], v[212:215]
    v_exp_f32 v211, v211
    v_mfma_f32_16x16x32_bf16 a[24:27], a[168:171], v[176:179], a[24:27]
    ds_read_b64_tr_b16 a[184:185], v23 offset:49152
    v_cvt_pk_bf16_f32 v144, v208, v209
    v_mfma_f32_16x16x32_bf16 a[24:27], a[172:175], v[180:183], a[24:27]
    ds_read_b64_tr_b16 a[186:187], v23 offset:53248
    v_fmac_f32 v227, v2, v247
    v_mfma_f32_16x16x32_bf16 a[28:31], a[172:175], v[188:191], a[28:31]
    ds_read_b128 a[208:211], v8 offset:8192
    v_cvt_pk_bf16_f32 v145, v210, v211
    v_mfma_f32_16x16x32_bf16 a[28:31], a[168:171], v[184:187], a[28:31]
    s_waitcnt lgkmcnt(3)
    buffer_load_dwordx4 v40, s[12:15], s41 offen lds
    v_mfma_f32_16x16x32_bf16 v[208:211], a[224:227], v[64:67], v[192:195]
    v_exp_f32 v212, v212
    v_mfma_f32_16x16x32_bf16 v[208:211], a[228:231], v[68:71], v[208:211]
    v_exp_f32 v213, v213
    v_mfma_f32_16x16x32_bf16 v[208:211], a[232:235], v[72:75], v[208:211]
    v_exp_f32 v214, v214
    v_mfma_f32_16x16x32_bf16 v[208:211], a[236:239], v[76:79], v[208:211]
    v_exp_f32 v215, v215
    v_mfma_f32_16x16x32_bf16 a[32:35], a[176:179], v[160:163], a[32:35]
    ds_read_b64_tr_b16 a[188:189], v23 offset:57344
    v_cvt_pk_bf16_f32 v152, v212, v213
    v_mfma_f32_16x16x32_bf16 a[32:35], a[180:183], v[164:167], a[32:35]
    ds_read_b64_tr_b16 a[190:191], v23 offset:61440
    v_lshlrev_b32 v244, 16, v242
    v_mfma_f32_16x16x32_bf16 a[36:39], a[180:183], v[172:175], a[36:39]
    ds_read_b128 a[212:215], v9 offset:8192
    v_cvt_pk_bf16_f32 v153, v214, v215
    v_mfma_f32_16x16x32_bf16 a[36:39], a[176:179], v[168:171], a[36:39]
    v_and_b32 v245, 0xffff0000, v242
    v_fmac_f32 v228, v2, v244
    v_smfmac_f32_16x16x64_bf16 a[196:199], v[52:55], v[168:175], v50
    v_mfma_f32_16x16x32_bf16 v[212:215], a[224:227], v[80:83], v[196:199]
    v_exp_f32 v208, v208
    v_mfma_f32_16x16x32_bf16 v[212:215], a[228:231], v[84:87], v[212:215]
    v_exp_f32 v209, v209
    v_mfma_f32_16x16x32_bf16 v[212:215], a[232:235], v[88:91], v[212:215]
    v_exp_f32 v210, v210
    v_mfma_f32_16x16x32_bf16 v[212:215], a[236:239], v[92:95], v[212:215]
    v_exp_f32 v211, v211
    v_mfma_f32_16x16x32_bf16 a[40:43], a[176:179], v[176:179], a[40:43]
    ds_read_b64_tr_b16 a[160:161], v24 offset:49152
    v_cvt_pk_bf16_f32 v130, v208, v209
    v_mfma_f32_16x16x32_bf16 a[40:43], a[180:183], v[180:183], a[40:43]
    ds_read_b64_tr_b16 a[162:163], v24 offset:53248
    v_fmac_f32 v229, v2, v245
    v_mfma_f32_16x16x32_bf16 a[44:47], a[180:183], v[188:191], a[44:47]
    ds_read_b128 a[216:219], v10 offset:8192
    v_cvt_pk_bf16_f32 v131, v210, v211
    v_mfma_f32_16x16x32_bf16 a[44:47], a[176:179], v[184:187], a[44:47]
    s_waitcnt lgkmcnt(3)
    buffer_load_dwordx4 v41, s[12:15], s41 offen offset:1024 lds
    v_mfma_f32_16x16x32_bf16 v[208:211], a[224:227], v[96:99], v[200:203]
    v_exp_f32 v212, v212
    v_mfma_f32_16x16x32_bf16 v[208:211], a[228:231], v[100:103], v[208:211]
    v_exp_f32 v213, v213
    v_mfma_f32_16x16x32_bf16 v[208:211], a[232:235], v[104:107], v[208:211]
    v_exp_f32 v214, v214
    v_mfma_f32_16x16x32_bf16 v[208:211], a[236:239], v[108:111], v[208:211]
    v_exp_f32 v215, v215
    v_mfma_f32_16x16x32_bf16 a[48:51], a[184:187], v[160:163], a[48:51]
    ds_read_b64_tr_b16 a[164:165], v24 offset:57344
    v_cvt_pk_bf16_f32 v138, v212, v213
    v_mfma_f32_16x16x32_bf16 a[48:51], a[188:191], v[164:167], a[48:51]
    ds_read_b64_tr_b16 a[166:167], v24 offset:61440
    v_lshlrev_b32 v246, 16, v243
    v_mfma_f32_16x16x32_bf16 a[52:55], a[188:191], v[172:175], a[52:55]
    ds_read_b128 a[220:223], v11 offset:8192
    v_cvt_pk_bf16_f32 v139, v214, v215
    v_mfma_f32_16x16x32_bf16 a[52:55], a[184:187], v[168:171], a[52:55]
    v_and_b32 v247, 0xffff0000, v243
    v_fmac_f32 v230, v2, v246
    v_smfmac_f32_16x16x64_bf16 a[200:203], v[52:55], v[176:183], v50
    v_mfma_f32_16x16x32_bf16 v[212:215], a[224:227], v[112:115], v[204:207]
    v_exp_f32 v208, v208
    v_mfma_f32_16x16x32_bf16 v[212:215], a[228:231], v[116:119], v[212:215]
    v_exp_f32 v209, v209
    v_mfma_f32_16x16x32_bf16 v[212:215], a[232:235], v[120:123], v[212:215]
    v_exp_f32 v210, v210
    v_mfma_f32_16x16x32_bf16 v[212:215], a[236:239], v[124:127], v[212:215]
    v_exp_f32 v211, v211
    v_mfma_f32_16x16x32_bf16 a[56:59], a[184:187], v[176:179], a[56:59]
    ds_read_b64_tr_b16 a[168:169], v25 offset:49152
    v_cvt_pk_bf16_f32 v146, v208, v209
    v_mfma_f32_16x16x32_bf16 a[56:59], a[188:191], v[180:183], a[56:59]
    ds_read_b64_tr_b16 a[170:171], v25 offset:53248
    v_fmac_f32 v231, v2, v247
    v_mfma_f32_16x16x32_bf16 a[60:63], a[188:191], v[188:191], a[60:63]
    ds_read_b128 a[224:227], v8 offset:12288
    v_cvt_pk_bf16_f32 v147, v210, v211
    v_mfma_f32_16x16x32_bf16 a[60:63], a[184:187], v[184:187], a[60:63]
    s_waitcnt lgkmcnt(3)
    buffer_load_dwordx4 v40, s[12:15], s41 offen offset:2048 lds
    v_mfma_f32_16x16x32_bf16 v[208:211], a[208:211], v[64:67], v[192:195]
    v_exp_f32 v212, v212
    v_mfma_f32_16x16x32_bf16 v[208:211], a[212:215], v[68:71], v[208:211]
    v_exp_f32 v213, v213
    v_mfma_f32_16x16x32_bf16 v[208:211], a[216:219], v[72:75], v[208:211]
    v_exp_f32 v214, v214
    v_mfma_f32_16x16x32_bf16 v[208:211], a[220:223], v[76:79], v[208:211]
    v_exp_f32 v215, v215
    v_mfma_f32_16x16x32_bf16 a[64:67], a[160:163], v[160:163], a[64:67]
    ds_read_b64_tr_b16 a[172:173], v25 offset:57344
    v_cvt_pk_bf16_f32 v154, v212, v213
    v_mfma_f32_16x16x32_bf16 a[64:67], a[164:167], v[164:167], a[64:67]
    ds_read_b64_tr_b16 a[174:175], v25 offset:61440
    v_mov_b32 v2, v3
    v_mfma_f32_16x16x32_bf16 a[68:71], a[164:167], v[172:175], a[68:71]
    ds_read_b128 a[228:231], v9 offset:12288
    v_cvt_pk_bf16_f32 v155, v214, v215
    v_mfma_f32_16x16x32_bf16 a[68:71], a[160:163], v[168:171], a[68:71]
    v_mov_b32 v3, v4
    v_mov_b32 v4, v5
    v_smfmac_f32_16x16x64_bf16 a[204:207], v[52:55], v[184:191], v50
    v_mfma_f32_16x16x32_bf16 v[212:215], a[208:211], v[80:83], v[196:199]
    v_exp_f32 v208, v208
    v_mfma_f32_16x16x32_bf16 v[212:215], a[212:215], v[84:87], v[212:215]
    v_exp_f32 v209, v209
    v_mfma_f32_16x16x32_bf16 v[212:215], a[216:219], v[88:91], v[212:215]
    v_exp_f32 v210, v210
    v_mfma_f32_16x16x32_bf16 v[212:215], a[220:223], v[92:95], v[212:215]
    v_exp_f32 v211, v211
    v_mfma_f32_16x16x32_bf16 a[72:75], a[160:163], v[176:179], a[72:75]
    ds_read_b64_tr_b16 a[176:177], v26 offset:49152
    v_cvt_pk_bf16_f32 v132, v208, v209
    v_mfma_f32_16x16x32_bf16 a[72:75], a[164:167], v[180:183], a[72:75]
    ds_read_b64_tr_b16 a[178:179], v26 offset:53248
    v_mov_b32 v5, v6
    v_mfma_f32_16x16x32_bf16 a[76:79], a[164:167], v[188:191], a[76:79]
    ds_read_b128 a[232:235], v10 offset:12288
    v_cvt_pk_bf16_f32 v133, v210, v211
    v_mfma_f32_16x16x32_bf16 a[76:79], a[160:163], v[184:187], a[76:79]
    s_waitcnt lgkmcnt(3)
    buffer_load_dwordx4 v41, s[12:15], s41 offen offset:3072 lds
    v_mfma_f32_16x16x32_bf16 v[208:211], a[208:211], v[96:99], v[200:203]
    v_exp_f32 v212, v212
    v_mfma_f32_16x16x32_bf16 v[208:211], a[212:215], v[100:103], v[208:211]
    s_add_u32 s41, s41, 16384
    v_exp_f32 v213, v213
    v_mfma_f32_16x16x32_bf16 v[208:211], a[216:219], v[104:107], v[208:211]
    v_exp_f32 v214, v214
    v_mfma_f32_16x16x32_bf16 v[208:211], a[220:223], v[108:111], v[208:211]
    v_exp_f32 v215, v215
    v_mfma_f32_16x16x32_bf16 a[80:83], a[168:171], v[160:163], a[80:83]
    ds_read_b64_tr_b16 a[180:181], v26 offset:57344
    v_cvt_pk_bf16_f32 v140, v212, v213
    v_mfma_f32_16x16x32_bf16 a[80:83], a[172:175], v[164:167], a[80:83]
    ds_read_b64_tr_b16 a[182:183], v26 offset:61440
    v_mfma_f32_16x16x32_bf16 a[84:87], a[172:175], v[172:175], a[84:87]
    ds_read_b128 a[236:239], v11 offset:12288
    v_cvt_pk_bf16_f32 v141, v214, v215
    v_mfma_f32_16x16x32_bf16 a[84:87], a[168:171], v[168:171], a[84:87]
    s_waitcnt vmcnt(10)
    s_barrier
    v_mfma_f32_16x16x32_bf16 v[212:215], a[208:211], v[112:115], v[204:207]
    v_exp_f32 v208, v208
    v_mfma_f32_16x16x32_bf16 v[212:215], a[212:215], v[116:119], v[212:215]
    s_add_u32 m0, s42, 49152
    v_exp_f32 v209, v209
    v_mfma_f32_16x16x32_bf16 v[212:215], a[216:219], v[120:123], v[212:215]
    v_exp_f32 v210, v210
    v_mfma_f32_16x16x32_bf16 v[212:215], a[220:223], v[124:127], v[212:215]
    v_exp_f32 v211, v211
    v_mfma_f32_16x16x32_bf16 a[88:91], a[168:171], v[176:179], a[88:91]
    ds_read_b64_tr_b16 a[184:185], v27 offset:49152
    v_cvt_pk_bf16_f32 v148, v208, v209
    v_mfma_f32_16x16x32_bf16 a[88:91], a[172:175], v[180:183], a[88:91]
    ds_read_b64_tr_b16 a[186:187], v27 offset:53248
    v_mfma_f32_16x16x32_bf16 a[92:95], a[172:175], v[188:191], a[92:95]
    ds_read_b128 a[208:211], v8 offset:16384
    v_cvt_pk_bf16_f32 v149, v210, v211
    v_mfma_f32_16x16x32_bf16 a[92:95], a[168:171], v[184:187], a[92:95]
    s_waitcnt lgkmcnt(3)
    buffer_load_dwordx4 v36, s[8:11], s40 offen lds
    v_mfma_f32_16x16x32_bf16 v[208:211], a[224:227], v[64:67], v[192:195]
    v_exp_f32 v212, v212
    v_mfma_f32_16x16x32_bf16 v[208:211], a[228:231], v[68:71], v[208:211]
    v_exp_f32 v213, v213
    v_mfma_f32_16x16x32_bf16 v[208:211], a[232:235], v[72:75], v[208:211]
    v_exp_f32 v214, v214
    v_mfma_f32_16x16x32_bf16 v[208:211], a[236:239], v[76:79], v[208:211]
    v_exp_f32 v215, v215
    v_mfma_f32_16x16x32_bf16 a[96:99], a[176:179], v[160:163], a[96:99]
    ds_read_b64_tr_b16 a[188:189], v27 offset:57344
    v_cvt_pk_bf16_f32 v156, v212, v213
    v_mfma_f32_16x16x32_bf16 a[96:99], a[180:183], v[164:167], a[96:99]
    ds_read_b64_tr_b16 a[190:191], v27 offset:61440
    v_mfma_f32_16x16x32_bf16 a[100:103], a[180:183], v[172:175], a[100:103]
    ds_read_b128 a[212:215], v9 offset:16384
    v_cvt_pk_bf16_f32 v157, v214, v215
    v_mfma_f32_16x16x32_bf16 a[100:103], a[176:179], v[168:171], a[100:103]
    buffer_load_dword v216, v237, s[28:31], s52 offen
    v_mfma_f32_16x16x32_bf16 v[212:215], a[224:227], v[80:83], v[196:199]
    v_exp_f32 v208, v208
    v_mfma_f32_16x16x32_bf16 v[212:215], a[228:231], v[84:87], v[212:215]
    s_sub_u32 s39, s39, 36864
    v_exp_f32 v209, v209
    v_mfma_f32_16x16x32_bf16 v[212:215], a[232:235], v[88:91], v[212:215]
    s_sub_u32 s38, s38, 4608
    v_exp_f32 v210, v210
    v_mfma_f32_16x16x32_bf16 v[212:215], a[236:239], v[92:95], v[212:215]
    s_add_u32 s52, s52, 2304
    v_exp_f32 v211, v211
    v_mfma_f32_16x16x32_bf16 a[104:107], a[176:179], v[176:179], a[104:107]
    ds_read_b64_tr_b16 a[160:161], v20 offset:0
    v_cvt_pk_bf16_f32 v134, v208, v209
    v_mfma_f32_16x16x32_bf16 a[104:107], a[180:183], v[180:183], a[104:107]
    ds_read_b64_tr_b16 a[162:163], v20 offset:4096
    v_mfma_f32_16x16x32_bf16 a[108:111], a[180:183], v[188:191], a[108:111]
    ds_read_b128 a[216:219], v10 offset:16384
    v_cvt_pk_bf16_f32 v135, v210, v211
    v_mfma_f32_16x16x32_bf16 a[108:111], a[176:179], v[184:187], a[108:111]
    s_waitcnt lgkmcnt(3)
    buffer_load_dwordx4 v37, s[8:11], s40 offen offset:1024 lds
    v_mfma_f32_16x16x32_bf16 v[208:211], a[224:227], v[96:99], v[200:203]
    v_exp_f32 v212, v212
    v_mfma_f32_16x16x32_bf16 v[208:211], a[228:231], v[100:103], v[208:211]
    v_exp_f32 v213, v213
    v_mfma_f32_16x16x32_bf16 v[208:211], a[232:235], v[104:107], v[208:211]
    v_exp_f32 v214, v214
    v_mfma_f32_16x16x32_bf16 v[208:211], a[236:239], v[108:111], v[208:211]
    v_exp_f32 v215, v215
    v_mfma_f32_16x16x32_bf16 a[112:115], a[184:187], v[160:163], a[112:115]
    ds_read_b64_tr_b16 a[164:165], v20 offset:8192
    v_cvt_pk_bf16_f32 v142, v212, v213
    v_mfma_f32_16x16x32_bf16 a[112:115], a[188:191], v[164:167], a[112:115]
    ds_read_b64_tr_b16 a[166:167], v20 offset:12288
    v_mfma_f32_16x16x32_bf16 a[116:119], a[188:191], v[172:175], a[116:119]
    ds_read_b128 a[220:223], v11 offset:16384
    v_cvt_pk_bf16_f32 v143, v214, v215
    v_mfma_f32_16x16x32_bf16 a[116:119], a[184:187], v[168:171], a[116:119]
    v_mfma_f32_16x16x32_bf16 v[212:215], a[224:227], v[112:115], v[204:207]
    v_exp_f32 v208, v208
    v_mfma_f32_16x16x32_bf16 v[212:215], a[228:231], v[116:119], v[212:215]
    v_exp_f32 v209, v209
    v_mfma_f32_16x16x32_bf16 v[212:215], a[232:235], v[120:123], v[212:215]
    v_exp_f32 v210, v210
    v_mfma_f32_16x16x32_bf16 v[212:215], a[236:239], v[124:127], v[212:215]
    v_exp_f32 v211, v211
    v_mfma_f32_16x16x32_bf16 a[120:123], a[184:187], v[176:179], a[120:123]
    ds_read_b64_tr_b16 a[168:169], v21 offset:0
    v_cvt_pk_bf16_f32 v150, v208, v209
    v_mfma_f32_16x16x32_bf16 a[120:123], a[188:191], v[180:183], a[120:123]
    ds_read_b64_tr_b16 a[170:171], v21 offset:4096
    v_mfma_f32_16x16x32_bf16 a[124:127], a[188:191], v[188:191], a[124:127]
    ds_read_b128 a[224:227], v8 offset:20480
    v_cvt_pk_bf16_f32 v151, v210, v211
    v_mfma_f32_16x16x32_bf16 a[124:127], a[184:187], v[184:187], a[124:127]
    s_waitcnt lgkmcnt(3)
    buffer_load_dwordx4 v38, s[8:11], s40 offen offset:2048 lds
    s_sub_u32 s43, s43, 1
    s_cmp_lg_u32 s43, 0
    s_cbranch_scc1 Lattn_loop
    v_mfma_f32_16x16x32_bf16 v[208:211], a[208:211], v[64:67], v[192:195]
    s_lshl_b32 s38, s3, 6
    v_exp_f32 v212, v212
    v_mfma_f32_16x16x32_bf16 v[208:211], a[212:215], v[68:71], v[208:211]
    s_add_u32 s38, s38, 131136
    v_exp_f32 v213, v213
    v_mfma_f32_16x16x32_bf16 v[208:211], a[216:219], v[72:75], v[208:211]
    v_exp_f32 v214, v214
    v_mfma_f32_16x16x32_bf16 v[208:211], a[220:223], v[76:79], v[208:211]
    s_add_u32 s57, s58, 0
    v_exp_f32 v215, v215
    v_mfma_f32_16x16x32_bf16 a[0:3], a[160:163], v[128:131], a[0:3]
    ds_read_b64_tr_b16 a[172:173], v21 offset:8192
    v_cvt_pk_bf16_f32 v158, v212, v213
    v_mfma_f32_16x16x32_bf16 a[0:3], a[164:167], v[132:135], a[0:3]
    ds_read_b64_tr_b16 a[174:175], v21 offset:12288
    v_permlane32_swap_b32 v224, v228
    v_mfma_f32_16x16x32_bf16 a[4:7], a[164:167], v[140:143], a[4:7]
    ds_read_b128 a[228:231], v9 offset:20480
    v_cvt_pk_bf16_f32 v159, v214, v215
    v_mfma_f32_16x16x32_bf16 a[4:7], a[160:163], v[136:139], a[4:7]
    buffer_load_dwordx4 a[128:131], v254, s[80:83], s57 offen
    v_mfma_f32_16x16x32_bf16 v[212:215], a[208:211], v[80:83], v[196:199]
    v_exp_f32 v208, v208
    v_mfma_f32_16x16x32_bf16 v[212:215], a[212:215], v[84:87], v[212:215]
    v_exp_f32 v209, v209
    v_mfma_f32_16x16x32_bf16 v[212:215], a[216:219], v[88:91], v[212:215]
    v_exp_f32 v210, v210
    v_mfma_f32_16x16x32_bf16 v[212:215], a[220:223], v[92:95], v[212:215]
    v_exp_f32 v211, v211
    v_mfma_f32_16x16x32_bf16 a[8:11], a[160:163], v[144:147], a[8:11]
    ds_read_b64_tr_b16 a[176:177], v22 offset:0
    v_cvt_pk_bf16_f32 v160, v208, v209
    v_mfma_f32_16x16x32_bf16 a[8:11], a[164:167], v[148:151], a[8:11]
    ds_read_b64_tr_b16 a[178:179], v22 offset:4096
    v_permlane32_swap_b32 v225, v229
    v_mfma_f32_16x16x32_bf16 a[12:15], a[164:167], v[156:159], a[12:15]
    ds_read_b128 a[232:235], v10 offset:20480
    v_cvt_pk_bf16_f32 v161, v210, v211
    v_mfma_f32_16x16x32_bf16 a[12:15], a[160:163], v[152:155], a[12:15]
    s_waitcnt lgkmcnt(3)
    buffer_load_dwordx4 v39, s[8:11], s40 offen offset:3072 lds
    v_mfma_f32_16x16x32_bf16 v[208:211], a[208:211], v[96:99], v[200:203]
    v_exp_f32 v212, v212
    v_mfma_f32_16x16x32_bf16 v[208:211], a[212:215], v[100:103], v[208:211]
    s_add_u32 s40, s40, 16384
    v_exp_f32 v213, v213
    v_mfma_f32_16x16x32_bf16 v[208:211], a[216:219], v[104:107], v[208:211]
    v_exp_f32 v214, v214
    v_mfma_f32_16x16x32_bf16 v[208:211], a[220:223], v[108:111], v[208:211]
    v_exp_f32 v215, v215
    v_mfma_f32_16x16x32_bf16 a[16:19], a[168:171], v[128:131], a[16:19]
    ds_read_b64_tr_b16 a[180:181], v22 offset:8192
    v_cvt_pk_bf16_f32 v168, v212, v213
    v_mfma_f32_16x16x32_bf16 a[16:19], a[172:175], v[132:135], a[16:19]
    ds_read_b64_tr_b16 a[182:183], v22 offset:12288
    v_permlane32_swap_b32 v226, v230
    v_mfma_f32_16x16x32_bf16 a[20:23], a[172:175], v[140:143], a[20:23]
    ds_read_b128 a[236:239], v11 offset:20480
    v_cvt_pk_bf16_f32 v169, v214, v215
    v_mfma_f32_16x16x32_bf16 a[20:23], a[168:171], v[136:139], a[20:23]
    v_permlane32_swap_b32 v227, v231
    v_add_f32 v224, v224, v228
    v_smfmac_f32_16x16x64_bf16 a[192:195], v[52:55], v[128:135], v50
    v_mfma_f32_16x16x32_bf16 v[212:215], a[208:211], v[112:115], v[204:207]
    v_exp_f32 v208, v208
    v_mfma_f32_16x16x32_bf16 v[212:215], a[212:215], v[116:119], v[212:215]
    s_add_u32 m0, s42, 98304
    v_exp_f32 v209, v209
    v_mfma_f32_16x16x32_bf16 v[212:215], a[216:219], v[120:123], v[212:215]
    v_exp_f32 v210, v210
    v_mfma_f32_16x16x32_bf16 v[212:215], a[220:223], v[124:127], v[212:215]
    v_exp_f32 v211, v211
    v_mfma_f32_16x16x32_bf16 a[24:27], a[168:171], v[144:147], a[24:27]
    ds_read_b64_tr_b16 a[184:185], v23 offset:0
    v_cvt_pk_bf16_f32 v176, v208, v209
    v_mfma_f32_16x16x32_bf16 a[24:27], a[172:175], v[148:151], a[24:27]
    ds_read_b64_tr_b16 a[186:187], v23 offset:4096
    v_add_f32 v225, v225, v229
    v_mfma_f32_16x16x32_bf16 a[28:31], a[172:175], v[156:159], a[28:31]
    ds_read_b128 a[208:211], v8 offset:24576
    v_cvt_pk_bf16_f32 v177, v210, v211
    v_mfma_f32_16x16x32_bf16 a[28:31], a[168:171], v[152:155], a[28:31]
    s_waitcnt lgkmcnt(3)
    buffer_load_dwordx4 v40, s[12:15], s41 offen lds
    v_mfma_f32_16x16x32_bf16 v[208:211], a[224:227], v[64:67], v[192:195]
    v_exp_f32 v212, v212
    v_mfma_f32_16x16x32_bf16 v[208:211], a[228:231], v[68:71], v[208:211]
    v_exp_f32 v213, v213
    v_mfma_f32_16x16x32_bf16 v[208:211], a[232:235], v[72:75], v[208:211]
    v_exp_f32 v214, v214
    v_mfma_f32_16x16x32_bf16 v[208:211], a[236:239], v[76:79], v[208:211]
    s_add_u32 s57, s58, 589824
    v_exp_f32 v215, v215
    v_mfma_f32_16x16x32_bf16 a[32:35], a[176:179], v[128:131], a[32:35]
    ds_read_b64_tr_b16 a[188:189], v23 offset:8192
    v_cvt_pk_bf16_f32 v184, v212, v213
    v_mfma_f32_16x16x32_bf16 a[32:35], a[180:183], v[132:135], a[32:35]
    ds_read_b64_tr_b16 a[190:191], v23 offset:12288
    v_add_f32 v226, v226, v230
    v_mfma_f32_16x16x32_bf16 a[36:39], a[180:183], v[140:143], a[36:39]
    ds_read_b128 a[212:215], v9 offset:24576
    v_cvt_pk_bf16_f32 v185, v214, v215
    v_mfma_f32_16x16x32_bf16 a[36:39], a[176:179], v[136:139], a[36:39]
    buffer_load_dwordx4 a[132:135], v254, s[80:83], s57 offen
    v_smfmac_f32_16x16x64_bf16 a[196:199], v[52:55], v[136:143], v50
    v_mfma_f32_16x16x32_bf16 v[212:215], a[224:227], v[80:83], v[196:199]
    v_exp_f32 v208, v208
    v_mfma_f32_16x16x32_bf16 v[212:215], a[228:231], v[84:87], v[212:215]
    v_exp_f32 v209, v209
    v_mfma_f32_16x16x32_bf16 v[212:215], a[232:235], v[88:91], v[212:215]
    v_exp_f32 v210, v210
    v_mfma_f32_16x16x32_bf16 v[212:215], a[236:239], v[92:95], v[212:215]
    v_exp_f32 v211, v211
    v_mfma_f32_16x16x32_bf16 a[40:43], a[176:179], v[144:147], a[40:43]
    ds_read_b64_tr_b16 a[160:161], v24 offset:0
    v_cvt_pk_bf16_f32 v162, v208, v209
    v_mfma_f32_16x16x32_bf16 a[40:43], a[180:183], v[148:151], a[40:43]
    ds_read_b64_tr_b16 a[162:163], v24 offset:4096
    v_add_f32 v227, v227, v231
    v_mfma_f32_16x16x32_bf16 a[44:47], a[180:183], v[156:159], a[44:47]
    ds_read_b128 a[216:219], v10 offset:24576
    v_cvt_pk_bf16_f32 v163, v210, v211
    v_mfma_f32_16x16x32_bf16 a[44:47], a[176:179], v[152:155], a[44:47]
    s_waitcnt lgkmcnt(3)
    buffer_load_dwordx4 v41, s[12:15], s41 offen offset:1024 lds
    v_mfma_f32_16x16x32_bf16 v[208:211], a[224:227], v[96:99], v[200:203]
    v_exp_f32 v212, v212
    v_mfma_f32_16x16x32_bf16 v[208:211], a[228:231], v[100:103], v[208:211]
    v_exp_f32 v213, v213
    v_mfma_f32_16x16x32_bf16 v[208:211], a[232:235], v[104:107], v[208:211]
    v_exp_f32 v214, v214
    v_mfma_f32_16x16x32_bf16 v[208:211], a[236:239], v[108:111], v[208:211]
    v_exp_f32 v215, v215
    v_mfma_f32_16x16x32_bf16 a[48:51], a[184:187], v[128:131], a[48:51]
    ds_read_b64_tr_b16 a[164:165], v24 offset:8192
    v_cvt_pk_bf16_f32 v170, v212, v213
    v_mfma_f32_16x16x32_bf16 a[48:51], a[188:191], v[132:135], a[48:51]
    ds_read_b64_tr_b16 a[166:167], v24 offset:12288
    v_and_b32 v244, 1, v1
    v_mfma_f32_16x16x32_bf16 a[52:55], a[188:191], v[140:143], a[52:55]
    ds_read_b128 a[220:223], v11 offset:24576
    v_cvt_pk_bf16_f32 v171, v214, v215
    v_mfma_f32_16x16x32_bf16 a[52:55], a[184:187], v[136:139], a[52:55]
    s_waitcnt vmcnt(15)
    buffer_load_dword v221, v236, s[20:23], 0 offen
    v_smfmac_f32_16x16x64_bf16 a[200:203], v[52:55], v[144:151], v50
    v_mfma_f32_16x16x32_bf16 v[212:215], a[224:227], v[112:115], v[204:207]
    v_exp_f32 v208, v208
    v_mfma_f32_16x16x32_bf16 v[212:215], a[228:231], v[116:119], v[212:215]
    v_exp_f32 v209, v209
    v_mfma_f32_16x16x32_bf16 v[212:215], a[232:235], v[120:123], v[212:215]
    v_exp_f32 v210, v210
    v_mfma_f32_16x16x32_bf16 v[212:215], a[236:239], v[124:127], v[212:215]
    v_exp_f32 v211, v211
    v_mfma_f32_16x16x32_bf16 a[56:59], a[184:187], v[144:147], a[56:59]
    ds_read_b64_tr_b16 a[168:169], v25 offset:0
    v_cvt_pk_bf16_f32 v178, v208, v209
    v_mfma_f32_16x16x32_bf16 a[56:59], a[188:191], v[148:151], a[56:59]
    ds_read_b64_tr_b16 a[170:171], v25 offset:4096
    v_permlane16_swap_b32 v224, v226
    v_mfma_f32_16x16x32_bf16 a[60:63], a[188:191], v[156:159], a[60:63]
    ds_read_b128 a[224:227], v8 offset:28672
    v_cvt_pk_bf16_f32 v179, v210, v211
    v_mfma_f32_16x16x32_bf16 a[60:63], a[184:187], v[152:155], a[60:63]
    s_waitcnt lgkmcnt(3)
    buffer_load_dwordx4 v40, s[12:15], s41 offen offset:2048 lds
    v_mfma_f32_16x16x32_bf16 v[208:211], a[208:211], v[64:67], v[192:195]
    v_exp_f32 v212, v212
    v_mfma_f32_16x16x32_bf16 v[208:211], a[212:215], v[68:71], v[208:211]
    v_exp_f32 v213, v213
    v_mfma_f32_16x16x32_bf16 v[208:211], a[216:219], v[72:75], v[208:211]
    v_exp_f32 v214, v214
    v_mfma_f32_16x16x32_bf16 v[208:211], a[220:223], v[76:79], v[208:211]
    s_add_u32 s57, s58, 1179648
    v_exp_f32 v215, v215
    v_mfma_f32_16x16x32_bf16 a[64:67], a[160:163], v[128:131], a[64:67]
    ds_read_b64_tr_b16 a[172:173], v25 offset:8192
    v_cvt_pk_bf16_f32 v186, v212, v213
    v_mfma_f32_16x16x32_bf16 a[64:67], a[164:167], v[132:135], a[64:67]
    ds_read_b64_tr_b16 a[174:175], v25 offset:12288
    v_permlane16_swap_b32 v225, v227
    v_mfma_f32_16x16x32_bf16 a[68:71], a[164:167], v[140:143], a[68:71]
    ds_read_b128 a[228:231], v9 offset:28672
    v_cvt_pk_bf16_f32 v187, v214, v215
    v_mfma_f32_16x16x32_bf16 a[68:71], a[160:163], v[136:139], a[68:71]
    buffer_load_dwordx4 a[136:139], v254, s[80:83], s57 offen
    v_smfmac_f32_16x16x64_bf16 a[204:207], v[52:55], v[152:159], v50
    v_mfma_f32_16x16x32_bf16 v[212:215], a[208:211], v[80:83], v[196:199]
    v_exp_f32 v208, v208
    v_mfma_f32_16x16x32_bf16 v[212:215], a[212:215], v[84:87], v[212:215]
    v_exp_f32 v209, v209
    v_mfma_f32_16x16x32_bf16 v[212:215], a[216:219], v[88:91], v[212:215]
    v_exp_f32 v210, v210
    v_mfma_f32_16x16x32_bf16 v[212:215], a[220:223], v[92:95], v[212:215]
    v_exp_f32 v211, v211
    v_mfma_f32_16x16x32_bf16 a[72:75], a[160:163], v[144:147], a[72:75]
    ds_read_b64_tr_b16 a[176:177], v26 offset:0
    v_cvt_pk_bf16_f32 v164, v208, v209
    v_mfma_f32_16x16x32_bf16 a[72:75], a[164:167], v[148:151], a[72:75]
    ds_read_b64_tr_b16 a[178:179], v26 offset:4096
    v_lshlrev_b32 v244, 5, v244
    v_mfma_f32_16x16x32_bf16 a[76:79], a[164:167], v[156:159], a[76:79]
    ds_read_b128 a[232:235], v10 offset:28672
    v_cvt_pk_bf16_f32 v165, v210, v211
    v_mfma_f32_16x16x32_bf16 a[76:79], a[160:163], v[152:155], a[76:79]
    s_waitcnt lgkmcnt(3)
    buffer_load_dwordx4 v41, s[12:15], s41 offen offset:3072 lds
    v_mfma_f32_16x16x32_bf16 v[208:211], a[208:211], v[96:99], v[200:203]
    v_exp_f32 v212, v212
    v_mfma_f32_16x16x32_bf16 v[208:211], a[212:215], v[100:103], v[208:211]
    s_add_u32 s41, s41, 16384
    v_exp_f32 v213, v213
    v_mfma_f32_16x16x32_bf16 v[208:211], a[216:219], v[104:107], v[208:211]
    v_exp_f32 v214, v214
    v_mfma_f32_16x16x32_bf16 v[208:211], a[220:223], v[108:111], v[208:211]
    v_exp_f32 v215, v215
    v_mfma_f32_16x16x32_bf16 a[80:83], a[168:171], v[128:131], a[80:83]
    ds_read_b64_tr_b16 a[180:181], v26 offset:8192
    v_cvt_pk_bf16_f32 v172, v212, v213
    v_mfma_f32_16x16x32_bf16 a[80:83], a[172:175], v[132:135], a[80:83]
    ds_read_b64_tr_b16 a[182:183], v26 offset:12288
    v_add_f32 v224, v224, v226
    v_mfma_f32_16x16x32_bf16 a[84:87], a[172:175], v[140:143], a[84:87]
    ds_read_b128 a[236:239], v11 offset:28672
    v_cvt_pk_bf16_f32 v173, v214, v215
    v_mfma_f32_16x16x32_bf16 a[84:87], a[168:171], v[136:139], a[84:87]
    s_waitcnt vmcnt(13)
    s_barrier
    v_mfma_f32_16x16x32_bf16 v[212:215], a[208:211], v[112:115], v[204:207]
    v_exp_f32 v208, v208
    v_mfma_f32_16x16x32_bf16 v[212:215], a[212:215], v[116:119], v[212:215]
    s_add_u32 s49, s45, 1024
    v_exp_f32 v209, v209
    v_mfma_f32_16x16x32_bf16 v[212:215], a[216:219], v[120:123], v[212:215]
    s_add_u32 m0, s42, 0
    v_exp_f32 v210, v210
    v_mfma_f32_16x16x32_bf16 v[212:215], a[220:223], v[124:127], v[212:215]
    v_exp_f32 v211, v211
    v_mfma_f32_16x16x32_bf16 a[88:91], a[168:171], v[144:147], a[88:91]
    ds_read_b64_tr_b16 a[184:185], v27 offset:0
    v_cvt_pk_bf16_f32 v180, v208, v209
    v_mfma_f32_16x16x32_bf16 a[88:91], a[172:175], v[148:151], a[88:91]
    ds_read_b64_tr_b16 a[186:187], v27 offset:4096
    v_add_f32 v225, v225, v227
    v_mfma_f32_16x16x32_bf16 a[92:95], a[172:175], v[156:159], a[92:95]
    ds_read_b128 a[208:211], v8 offset:32768
    v_cvt_pk_bf16_f32 v181, v210, v211
    v_mfma_f32_16x16x32_bf16 a[92:95], a[168:171], v[152:155], a[92:95]
    s_waitcnt lgkmcnt(3)
    buffer_load_dwordx4 v46, s[20:23], s49 offen lds
    v_mfma_f32_16x16x32_bf16 v[208:211], a[224:227], v[64:67], v[192:195]
    v_exp_f32 v212, v212
    v_mfma_f32_16x16x32_bf16 v[208:211], a[228:231], v[68:71], v[208:211]
    v_exp_f32 v213, v213
    v_mfma_f32_16x16x32_bf16 v[208:211], a[232:235], v[72:75], v[208:211]
    v_exp_f32 v214, v214
    v_mfma_f32_16x16x32_bf16 v[208:211], a[236:239], v[76:79], v[208:211]
    s_add_u32 s37, s55, 0
    v_exp_f32 v215, v215
    v_mfma_f32_16x16x32_bf16 a[96:99], a[176:179], v[128:131], a[96:99]
    ds_read_b64_tr_b16 a[188:189], v27 offset:8192
    v_cvt_pk_bf16_f32 v188, v212, v213
    v_mfma_f32_16x16x32_bf16 a[96:99], a[180:183], v[132:135], a[96:99]
    ds_read_b64_tr_b16 a[190:191], v27 offset:12288
    v_lshrrev_b32 v245, 4, v1
    v_mfma_f32_16x16x32_bf16 a[100:103], a[180:183], v[140:143], a[100:103]
Ltour0_6:
    s_cbranch_execz Ltour0_10
    ds_read_b128 a[212:215], v9 offset:32768
    v_cvt_pk_bf16_f32 v189, v214, v215
    v_mfma_f32_16x16x32_bf16 a[100:103], a[176:179], v[136:139], a[100:103]
    buffer_load_dword v239, v238, s[28:31], s37 offen
    v_mfma_f32_16x16x32_bf16 v[212:215], a[224:227], v[80:83], v[196:199]
    v_exp_f32 v208, v208
    v_mfma_f32_16x16x32_bf16 v[212:215], a[228:231], v[84:87], v[212:215]
    v_exp_f32 v209, v209
    v_mfma_f32_16x16x32_bf16 v[212:215], a[232:235], v[88:91], v[212:215]
    v_exp_f32 v210, v210
    v_mfma_f32_16x16x32_bf16 v[212:215], a[236:239], v[92:95], v[212:215]
    v_exp_f32 v211, v211
    v_mfma_f32_16x16x32_bf16 a[104:107], a[176:179], v[144:147], a[104:107]
    ds_read_b64_tr_b16 a[160:161], v20 offset:16384
    v_cvt_pk_bf16_f32 v166, v208, v209
    v_mfma_f32_16x16x32_bf16 a[104:107], a[180:183], v[148:151], a[104:107]
    ds_read_b64_tr_b16 a[162:163], v20 offset:20480
    v_lshl_add_u32 v244, v245, 3, v244
    v_mfma_f32_16x16x32_bf16 a[108:111], a[180:183], v[156:159], a[108:111]
    ds_read_b128 a[216:219], v10 offset:32768
    v_cvt_pk_bf16_f32 v167, v210, v211
    v_mfma_f32_16x16x32_bf16 a[108:111], a[176:179], v[152:155], a[108:111]
    s_waitcnt lgkmcnt(3)
    buffer_load_dwordx4 v47, s[20:23], s49 offen offset:1024 lds
    v_mfma_f32_16x16x32_bf16 v[208:211], a[224:227], v[96:99], v[200:203]
    v_exp_f32 v212, v212
    v_mfma_f32_16x16x32_bf16 v[208:211], a[228:231], v[100:103], v[208:211]
    v_exp_f32 v213, v213
    v_mfma_f32_16x16x32_bf16 v[208:211], a[232:235], v[104:107], v[208:211]
    v_exp_f32 v214, v214
    v_mfma_f32_16x16x32_bf16 v[208:211], a[236:239], v[108:111], v[208:211]
    s_add_u32 s57, s58, 1769472
    v_exp_f32 v215, v215
    v_mfma_f32_16x16x32_bf16 a[112:115], a[184:187], v[128:131], a[112:115]
    ds_read_b64_tr_b16 a[164:165], v20 offset:24576
    v_cvt_pk_bf16_f32 v174, v212, v213
    v_mfma_f32_16x16x32_bf16 a[112:115], a[188:191], v[132:135], a[112:115]
    ds_read_b64_tr_b16 a[166:167], v20 offset:28672
    v_mfma_f32_16x16x32_bf16 a[116:119], a[188:191], v[140:143], a[116:119]
    ds_read_b128 a[220:223], v11 offset:32768
    v_cvt_pk_bf16_f32 v175, v214, v215
    v_mfma_f32_16x16x32_bf16 a[116:119], a[184:187], v[136:139], a[116:119]
    buffer_load_dwordx4 a[140:143], v254, s[80:83], s57 offen
    v_mfma_f32_16x16x32_bf16 v[212:215], a[224:227], v[112:115], v[204:207]
    v_exp_f32 v208, v208
    v_mfma_f32_16x16x32_bf16 v[212:215], a[228:231], v[116:119], v[212:215]
    v_exp_f32 v209, v209
    v_mfma_f32_16x16x32_bf16 v[212:215], a[232:235], v[120:123], v[212:215]
    v_exp_f32 v210, v210
    v_mfma_f32_16x16x32_bf16 v[212:215], a[236:239], v[124:127], v[212:215]
    v_exp_f32 v211, v211
    v_mfma_f32_16x16x32_bf16 a[120:123], a[184:187], v[144:147], a[120:123]
    ds_read_b64_tr_b16 a[168:169], v21 offset:16384
    v_cvt_pk_bf16_f32 v182, v208, v209
    v_mfma_f32_16x16x32_bf16 a[120:123], a[188:191], v[148:151], a[120:123]
    ds_read_b64_tr_b16 a[170:171], v21 offset:20480
    v_mfma_f32_16x16x32_bf16 a[124:127], a[188:191], v[156:159], a[124:127]
    ds_read_b128 a[224:227], v8 offset:36864
    v_cvt_pk_bf16_f32 v183, v210, v211
    v_mfma_f32_16x16x32_bf16 a[124:127], a[184:187], v[152:155], a[124:127]
    s_waitcnt lgkmcnt(3)
    buffer_load_dwordx4 v48, s[20:23], s49 offen offset:2048 lds
    v_mfma_f32_16x16x32_bf16 v[208:211], a[208:211], v[64:67], v[192:195]
    v_exp_f32 v212, v212
    v_mfma_f32_16x16x32_bf16 v[208:211], a[212:215], v[68:71], v[208:211]
    v_exp_f32 v213, v213
    v_mfma_f32_16x16x32_bf16 v[208:211], a[216:219], v[72:75], v[208:211]
    v_exp_f32 v214, v214
    v_mfma_f32_16x16x32_bf16 v[208:211], a[220:223], v[76:79], v[208:211]
    s_add_u32 s57, s58, 2359296
    v_exp_f32 v215, v215
    v_mfma_f32_16x16x32_bf16 a[0:3], a[160:163], v[160:163], a[0:3]
    ds_read_b64_tr_b16 a[172:173], v21 offset:24576
    v_cvt_pk_bf16_f32 v190, v212, v213
    v_mfma_f32_16x16x32_bf16 a[0:3], a[164:167], v[164:167], a[0:3]
    ds_read_b64_tr_b16 a[174:175], v21 offset:28672
    v_mov_b32 v63, 0
    v_mfma_f32_16x16x32_bf16 a[4:7], a[164:167], v[172:175], a[4:7]
    ds_read_b128 a[228:231], v9 offset:36864
    v_cvt_pk_bf16_f32 v191, v214, v215
    v_mfma_f32_16x16x32_bf16 a[4:7], a[160:163], v[168:171], a[4:7]
    buffer_load_dwordx4 a[144:147], v254, s[80:83], s57 offen
    v_mfma_f32_16x16x32_bf16 v[212:215], a[208:211], v[80:83], v[196:199]
    v_exp_f32 v208, v208
    v_mfma_f32_16x16x32_bf16 v[212:215], a[212:215], v[84:87], v[212:215]
    v_exp_f32 v209, v209
    v_mfma_f32_16x16x32_bf16 v[212:215], a[216:219], v[88:91], v[212:215]
    v_exp_f32 v210, v210
    v_mfma_f32_16x16x32_bf16 v[212:215], a[220:223], v[92:95], v[212:215]
    v_exp_f32 v211, v211
    v_mfma_f32_16x16x32_bf16 a[8:11], a[160:163], v[176:179], a[8:11]
    ds_read_b64_tr_b16 a[176:177], v22 offset:16384
    v_cvt_pk_bf16_f32 v128, v208, v209
    v_mfma_f32_16x16x32_bf16 a[8:11], a[164:167], v[180:183], a[8:11]
    ds_read_b64_tr_b16 a[178:179], v22 offset:20480
    v_add_f32_dpp v224, v224, v224 row_ror:2 row_mask:0xf bank_mask:0xf
    v_mfma_f32_16x16x32_bf16 a[12:15], a[164:167], v[188:191], a[12:15]
    ds_read_b128 a[232:235], v10 offset:36864
    v_cvt_pk_bf16_f32 v129, v210, v211
    v_mfma_f32_16x16x32_bf16 a[12:15], a[160:163], v[184:187], a[12:15]
    s_waitcnt lgkmcnt(3)
    buffer_load_dwordx4 v49, s[20:23], s49 offen offset:3072 lds
    v_mfma_f32_16x16x32_bf16 v[208:211], a[208:211], v[96:99], v[200:203]
    s_lshr_b32 s39, s2, 5
    v_exp_f32 v212, v212
    v_mfma_f32_16x16x32_bf16 v[208:211], a[212:215], v[100:103], v[208:211]
    s_lshl_b32 s39, s39, 3
    v_exp_f32 v213, v213
    v_mfma_f32_16x16x32_bf16 v[208:211], a[216:219], v[104:107], v[208:211]
    s_and_b32 s43, s2, 7
    v_exp_f32 v214, v214
    v_mfma_f32_16x16x32_bf16 v[208:211], a[220:223], v[108:111], v[208:211]
    s_add_u32 s39, s39, s43
    v_exp_f32 v215, v215
    v_mfma_f32_16x16x32_bf16 a[16:19], a[168:171], v[160:163], a[16:19]
    ds_read_b64_tr_b16 a[180:181], v22 offset:24576
    v_cvt_pk_bf16_f32 v136, v212, v213
    v_mfma_f32_16x16x32_bf16 a[16:19], a[172:175], v[164:167], a[16:19]
    ds_read_b64_tr_b16 a[182:183], v22 offset:28672
    v_add_f32_dpp v225, v225, v225 row_ror:2 row_mask:0xf bank_mask:0xf
    v_mfma_f32_16x16x32_bf16 a[20:23], a[172:175], v[172:175], a[20:23]
    ds_read_b128 a[236:239], v11 offset:36864
    v_cvt_pk_bf16_f32 v137, v214, v215
    v_mfma_f32_16x16x32_bf16 a[20:23], a[168:171], v[168:171], a[20:23]
    buffer_load_dword v253, v63, s[24:27], s54 offen offset:12 sc1
    v_smfmac_f32_16x16x64_bf16 a[192:195], v[52:55], v[160:167], v50
    v_mfma_f32_16x16x32_bf16 v[212:215], a[208:211], v[112:115], v[204:207]
    s_lshl_b32 s39, s39, 2
    v_exp_f32 v208, v208
    v_mfma_f32_16x16x32_bf16 v[212:215], a[212:215], v[116:119], v[212:215]
    s_add_u32 m0, s42, 114688
    v_exp_f32 v209, v209
    v_mfma_f32_16x16x32_bf16 v[212:215], a[216:219], v[120:123], v[212:215]
    s_bfe_u32 s43, s2, 0x20003
    v_exp_f32 v210, v210
    v_mfma_f32_16x16x32_bf16 v[212:215], a[220:223], v[124:127], v[212:215]
    s_add_u32 s39, s39, s43
    v_exp_f32 v211, v211
    v_mfma_f32_16x16x32_bf16 a[24:27], a[168:171], v[176:179], a[24:27]
    ds_read_b64_tr_b16 a[184:185], v23 offset:16384
    v_cvt_pk_bf16_f32 v144, v208, v209
    v_mfma_f32_16x16x32_bf16 a[24:27], a[172:175], v[180:183], a[24:27]
    ds_read_b64_tr_b16 a[186:187], v23 offset:20480
    v_add_f32_dpp v224, v224, v224 row_ror:4 row_mask:0xf bank_mask:0xf
    v_mfma_f32_16x16x32_bf16 a[28:31], a[172:175], v[188:191], a[28:31]
    ds_read_b128 a[208:211], v8 offset:40960
    v_cvt_pk_bf16_f32 v145, v210, v211
    v_mfma_f32_16x16x32_bf16 a[28:31], a[168:171], v[184:187], a[28:31]
    s_waitcnt lgkmcnt(3)
    buffer_load_dwordx4 v40, s[12:15], s41 offen lds
    v_mfma_f32_16x16x32_bf16 v[208:211], a[224:227], v[64:67], v[192:195]
    s_add_u32 s39, s39, 72
    v_exp_f32 v212, v212
    v_mfma_f32_16x16x32_bf16 v[208:211], a[228:231], v[68:71], v[208:211]
    s_cmp_lt_u32 s39, 216
    s_cselect_b32 s43, 0, 2147483648
    v_exp_f32 v213, v213
    v_mfma_f32_16x16x32_bf16 v[208:211], a[232:235], v[72:75], v[208:211]
    s_or_b32 s43, s43, s48
    v_exp_f32 v214, v214
    v_mfma_f32_16x16x32_bf16 v[208:211], a[236:239], v[76:79], v[208:211]
    s_add_u32 s57, s58, 2949120
    v_exp_f32 v215, v215
    v_mfma_f32_16x16x32_bf16 a[32:35], a[176:179], v[160:163], a[32:35]
    ds_read_b64_tr_b16 a[188:189], v23 offset:24576
    v_cvt_pk_bf16_f32 v152, v212, v213
    v_mfma_f32_16x16x32_bf16 a[32:35], a[180:183], v[164:167], a[32:35]
    ds_read_b64_tr_b16 a[190:191], v23 offset:28672
    v_add_f32_dpp v225, v225, v225 row_ror:4 row_mask:0xf bank_mask:0xf
    v_mfma_f32_16x16x32_bf16 a[36:39], a[180:183], v[172:175], a[36:39]
    ds_read_b128 a[212:215], v9 offset:40960
    v_cvt_pk_bf16_f32 v153, v214, v215
    v_mfma_f32_16x16x32_bf16 a[36:39], a[176:179], v[168:171], a[36:39]
    buffer_load_dwordx4 a[148:151], v254, s[80:83], s57 offen
    v_smfmac_f32_16x16x64_bf16 a[196:199], v[52:55], v[168:175], v50
    v_mfma_f32_16x16x32_bf16 v[212:215], a[224:227], v[80:83], v[196:199]
    s_and_b32 s43, s43, 2147483648
    v_exp_f32 v208, v208
    v_mfma_f32_16x16x32_bf16 v[212:215], a[228:231], v[84:87], v[212:215]
    s_sub_u32 s36, s39, 144
    v_exp_f32 v209, v209
    v_mfma_f32_16x16x32_bf16 v[212:215], a[232:235], v[88:91], v[212:215]
    s_cmp_lt_u32 s36, 36
    s_cselect_b32 s36, 1.0, 0
    v_exp_f32 v210, v210
    v_mfma_f32_16x16x32_bf16 v[212:215], a[236:239], v[92:95], v[212:215]
    s_lshr_b32 s44, s39, 1
    v_exp_f32 v211, v211
    v_mfma_f32_16x16x32_bf16 a[40:43], a[176:179], v[176:179], a[40:43]
    ds_read_b64_tr_b16 a[160:161], v24 offset:16384
    v_cvt_pk_bf16_f32 v130, v208, v209
    v_mfma_f32_16x16x32_bf16 a[40:43], a[180:183], v[180:183], a[40:43]
    ds_read_b64_tr_b16 a[162:163], v24 offset:20480
    v_add_f32_dpp v224, v224, v224 row_ror:8 row_mask:0xf bank_mask:0xf
    v_mfma_f32_16x16x32_bf16 a[44:47], a[180:183], v[188:191], a[44:47]
    ds_read_b128 a[216:219], v10 offset:40960
    v_cvt_pk_bf16_f32 v131, v210, v211
    v_mfma_f32_16x16x32_bf16 a[44:47], a[176:179], v[184:187], a[44:47]
    s_waitcnt lgkmcnt(3)
    buffer_load_dwordx4 v41, s[12:15], s41 offen offset:1024 lds
    v_mfma_f32_16x16x32_bf16 v[208:211], a[224:227], v[96:99], v[200:203]
    s_lshl_b32 s44, s44, 6
    v_exp_f32 v212, v212
    v_mfma_f32_16x16x32_bf16 v[208:211], a[228:231], v[100:103], v[208:211]
    s_and_b32 s39, s39, 1
    v_exp_f32 v213, v213
    v_mfma_f32_16x16x32_bf16 v[208:211], a[232:235], v[104:107], v[208:211]
    s_lshl_b32 s39, s39, 3
    v_exp_f32 v214, v214
    v_mfma_f32_16x16x32_bf16 v[208:211], a[236:239], v[108:111], v[208:211]
    s_add_u32 s39, s39, s44
    v_exp_f32 v215, v215
    v_mfma_f32_16x16x32_bf16 a[48:51], a[184:187], v[160:163], a[48:51]
    ds_read_b64_tr_b16 a[164:165], v24 offset:24576
    v_cvt_pk_bf16_f32 v138, v212, v213
    v_mfma_f32_16x16x32_bf16 a[48:51], a[188:191], v[164:167], a[48:51]
    ds_read_b64_tr_b16 a[166:167], v24 offset:28672
    v_add_f32_dpp v225, v225, v225 row_ror:8 row_mask:0xf bank_mask:0xf
    v_mfma_f32_16x16x32_bf16 a[52:55], a[188:191], v[172:175], a[52:55]
    ds_read_b128 a[220:223], v11 offset:40960
    v_cvt_pk_bf16_f32 v139, v214, v215
    v_mfma_f32_16x16x32_bf16 a[52:55], a[184:187], v[168:171], a[52:55]
    v_add_u32 v244, s38, v244
    v_and_b32 v245, 7, v1
    v_smfmac_f32_16x16x64_bf16 a[200:203], v[52:55], v[176:183], v50
    v_mfma_f32_16x16x32_bf16 v[212:215], a[224:227], v[112:115], v[204:207]
    s_add_u32 s39, s39, 16384
    v_exp_f32 v208, v208
    v_mfma_f32_16x16x32_bf16 v[212:215], a[228:231], v[116:119], v[212:215]
    s_or_b32 s39, s39, s43
    v_exp_f32 v209, v209
    v_mfma_f32_16x16x32_bf16 v[212:215], a[232:235], v[120:123], v[212:215]
    v_exp_f32 v210, v210
    v_mfma_f32_16x16x32_bf16 v[212:215], a[236:239], v[124:127], v[212:215]
    v_exp_f32 v211, v211
    v_mfma_f32_16x16x32_bf16 a[56:59], a[184:187], v[176:179], a[56:59]
    ds_read_b64_tr_b16 a[168:169], v25 offset:16384
    v_cvt_pk_bf16_f32 v146, v208, v209
    v_mfma_f32_16x16x32_bf16 a[56:59], a[188:191], v[180:183], a[56:59]
    ds_read_b64_tr_b16 a[170:171], v25 offset:20480
    v_mfma_f32_16x16x32_bf16 a[60:63], a[188:191], v[188:191], a[60:63]
    ds_read_b128 a[224:227], v8 offset:45056
    v_cvt_pk_bf16_f32 v147, v210, v211
    v_mfma_f32_16x16x32_bf16 a[60:63], a[184:187], v[184:187], a[60:63]
    s_waitcnt lgkmcnt(3)
    buffer_load_dwordx4 v40, s[12:15], s41 offen offset:2048 lds
    v_mfma_f32_16x16x32_bf16 v[208:211], a[208:211], v[64:67], v[192:195]
    v_exp_f32 v212, v212
    v_mfma_f32_16x16x32_bf16 v[208:211], a[212:215], v[68:71], v[208:211]
    v_exp_f32 v213, v213
    v_mfma_f32_16x16x32_bf16 v[208:211], a[216:219], v[72:75], v[208:211]
    v_exp_f32 v214, v214
    v_mfma_f32_16x16x32_bf16 v[208:211], a[220:223], v[76:79], v[208:211]
    s_add_u32 s57, s58, 3538944
    v_exp_f32 v215, v215
    v_mfma_f32_16x16x32_bf16 a[64:67], a[160:163], v[160:163], a[64:67]
    ds_read_b64_tr_b16 a[172:173], v25 offset:24576
    v_cvt_pk_bf16_f32 v154, v212, v213
    v_mfma_f32_16x16x32_bf16 a[64:67], a[164:167], v[164:167], a[64:67]
    ds_read_b64_tr_b16 a[174:175], v25 offset:28672
    v_lshlrev_b32 v245, 3, v245
    v_mfma_f32_16x16x32_bf16 a[68:71], a[164:167], v[172:175], a[68:71]
    ds_read_b128 a[228:231], v9 offset:45056
    v_cvt_pk_bf16_f32 v155, v214, v215
    v_mfma_f32_16x16x32_bf16 a[68:71], a[160:163], v[168:171], a[68:71]
    buffer_load_dwordx4 a[152:155], v254, s[80:83], s57 offen
    v_smfmac_f32_16x16x64_bf16 a[204:207], v[52:55], v[184:191], v50
    ds_write_b64 v244, v[224:225]
    v_mfma_f32_16x16x32_bf16 v[212:215], a[208:211], v[80:83], v[196:199]
    v_exp_f32 v208, v208
    v_mfma_f32_16x16x32_bf16 v[212:215], a[212:215], v[84:87], v[212:215]
    v_exp_f32 v209, v209
    v_mfma_f32_16x16x32_bf16 v[212:215], a[216:219], v[88:91], v[212:215]
    v_exp_f32 v210, v210
    v_mfma_f32_16x16x32_bf16 v[212:215], a[220:223], v[92:95], v[212:215]
    v_exp_f32 v211, v211
    v_mfma_f32_16x16x32_bf16 a[72:75], a[160:163], v[176:179], a[72:75]
    ds_read_b64_tr_b16 a[176:177], v26 offset:16384
    v_cvt_pk_bf16_f32 v132, v208, v209
    v_mfma_f32_16x16x32_bf16 a[72:75], a[164:167], v[180:183], a[72:75]
    ds_read_b64_tr_b16 a[178:179], v26 offset:20480
    v_add_u32 v245, 131136, v245
    v_mfma_f32_16x16x32_bf16 a[76:79], a[164:167], v[188:191], a[76:79]
    ds_read_b128 a[232:235], v10 offset:45056
    v_cvt_pk_bf16_f32 v133, v210, v211
    v_mfma_f32_16x16x32_bf16 a[76:79], a[160:163], v[184:187], a[76:79]
    s_waitcnt lgkmcnt(3)
    buffer_load_dwordx4 v41, s[12:15], s41 offen offset:3072 lds
    v_mfma_f32_16x16x32_bf16 v[208:211], a[208:211], v[96:99], v[200:203]
    v_exp_f32 v212, v212
    v_mfma_f32_16x16x32_bf16 v[208:211], a[212:215], v[100:103], v[208:211]
    s_add_u32 s41, s41, 16384
    v_exp_f32 v213, v213
    v_mfma_f32_16x16x32_bf16 v[208:211], a[216:219], v[104:107], v[208:211]
    v_exp_f32 v214, v214
    v_mfma_f32_16x16x32_bf16 v[208:211], a[220:223], v[108:111], v[208:211]
    v_exp_f32 v215, v215
    v_mfma_f32_16x16x32_bf16 a[80:83], a[168:171], v[160:163], a[80:83]
    ds_read_b64_tr_b16 a[180:181], v26 offset:24576
    v_cvt_pk_bf16_f32 v140, v212, v213
    v_mfma_f32_16x16x32_bf16 a[80:83], a[172:175], v[164:167], a[80:83]
    ds_read_b64_tr_b16 a[182:183], v26 offset:28672
    v_mfma_f32_16x16x32_bf16 a[84:87], a[172:175], v[172:175], a[84:87]
    ds_read_b128 a[236:239], v11 offset:45056
    v_cvt_pk_bf16_f32 v141, v214, v215
    v_mfma_f32_16x16x32_bf16 a[84:87], a[168:171], v[168:171], a[84:87]
    s_waitcnt vmcnt(14)
    s_barrier
    v_mfma_f32_16x16x32_bf16 v[212:215], a[208:211], v[112:115], v[204:207]
    v_exp_f32 v208, v208
    v_mfma_f32_16x16x32_bf16 v[212:215], a[212:215], v[116:119], v[212:215]
    s_add_u32 s49, s45, 74752
    v_exp_f32 v209, v209
    v_mfma_f32_16x16x32_bf16 v[212:215], a[216:219], v[120:123], v[212:215]
    s_add_u32 m0, s42, 16384
    v_exp_f32 v210, v210
    v_mfma_f32_16x16x32_bf16 v[212:215], a[220:223], v[124:127], v[212:215]
    v_exp_f32 v211, v211
    v_mfma_f32_16x16x32_bf16 a[88:91], a[168:171], v[176:179], a[88:91]
    ds_read_b64_tr_b16 a[184:185], v27 offset:16384
    v_cvt_pk_bf16_f32 v148, v208, v209
    v_mfma_f32_16x16x32_bf16 a[88:91], a[172:175], v[180:183], a[88:91]
    ds_read_b64_tr_b16 a[186:187], v27 offset:20480
    ds_read_b64 v[224:225], v245 offset:0
    v_mfma_f32_16x16x32_bf16 a[92:95], a[172:175], v[188:191], a[92:95]
    ds_read_b128 a[208:211], v8 offset:49152
    v_cvt_pk_bf16_f32 v149, v210, v211
    v_mfma_f32_16x16x32_bf16 a[92:95], a[168:171], v[184:187], a[92:95]
    s_waitcnt lgkmcnt(3)
    buffer_load_dwordx4 v46, s[20:23], s49 offen lds
    v_mfma_f32_16x16x32_bf16 v[208:211], a[224:227], v[64:67], v[192:195]
    v_exp_f32 v212, v212
    v_mfma_f32_16x16x32_bf16 v[208:211], a[228:231], v[68:71], v[208:211]
    v_exp_f32 v213, v213
    v_mfma_f32_16x16x32_bf16 v[208:211], a[232:235], v[72:75], v[208:211]
    v_exp_f32 v214, v214
    v_mfma_f32_16x16x32_bf16 v[208:211], a[236:239], v[76:79], v[208:211]
    s_add_u32 s37, s55, 8192
    v_exp_f32 v215, v215
    v_mfma_f32_16x16x32_bf16 a[96:99], a[176:179], v[160:163], a[96:99]
    ds_read_b64_tr_b16 a[188:189], v27 offset:24576
    v_cvt_pk_bf16_f32 v156, v212, v213
    v_mfma_f32_16x16x32_bf16 a[96:99], a[180:183], v[164:167], a[96:99]
    ds_read_b64_tr_b16 a[190:191], v27 offset:28672
    ds_read_b64 v[226:227], v245 offset:64
    v_mfma_f32_16x16x32_bf16 a[100:103], a[180:183], v[172:175], a[100:103]
    ds_read_b128 a[212:215], v9 offset:49152
    v_cvt_pk_bf16_f32 v157, v214, v215
    v_mfma_f32_16x16x32_bf16 a[100:103], a[176:179], v[168:171], a[100:103]
    buffer_load_dword v234, v238, s[28:31], s37 offen
    v_mfma_f32_16x16x32_bf16 v[212:215], a[224:227], v[80:83], v[196:199]
    v_exp_f32 v208, v208
    v_mfma_f32_16x16x32_bf16 v[212:215], a[228:231], v[84:87], v[212:215]
    v_exp_f32 v209, v209
    v_mfma_f32_16x16x32_bf16 v[212:215], a[232:235], v[88:91], v[212:215]
    v_exp_f32 v210, v210
    v_mfma_f32_16x16x32_bf16 v[212:215], a[236:239], v[92:95], v[212:215]
    v_exp_f32 v211, v211
    v_mfma_f32_16x16x32_bf16 a[104:107], a[176:179], v[176:179], a[104:107]
    ds_read_b64_tr_b16 a[160:161], v20 offset:32768
    v_cvt_pk_bf16_f32 v134, v208, v209
    v_mfma_f32_16x16x32_bf16 a[104:107], a[180:183], v[180:183], a[104:107]
    ds_read_b64_tr_b16 a[162:163], v20 offset:36864
    ds_read_b64 v[228:229], v245 offset:128
    v_mfma_f32_16x16x32_bf16 a[108:111], a[180:183], v[188:191], a[108:111]
    ds_read_b128 a[216:219], v10 offset:49152
    v_cvt_pk_bf16_f32 v135, v210, v211
    v_mfma_f32_16x16x32_bf16 a[108:111], a[176:179], v[184:187], a[108:111]
    s_waitcnt lgkmcnt(3)
    buffer_load_dwordx4 v47, s[20:23], s49 offen offset:1024 lds
    v_mfma_f32_16x16x32_bf16 v[208:211], a[224:227], v[96:99], v[200:203]
    v_exp_f32 v212, v212
    v_mfma_f32_16x16x32_bf16 v[208:211], a[228:231], v[100:103], v[208:211]
    v_exp_f32 v213, v213
    v_mfma_f32_16x16x32_bf16 v[208:211], a[232:235], v[104:107], v[208:211]
    v_exp_f32 v214, v214
    v_mfma_f32_16x16x32_bf16 v[208:211], a[236:239], v[108:111], v[208:211]
    s_add_u32 s57, s58, 4128768
    v_exp_f32 v215, v215
    v_mfma_f32_16x16x32_bf16 a[112:115], a[184:187], v[160:163], a[112:115]
    ds_read_b64_tr_b16 a[164:165], v20 offset:40960
    v_cvt_pk_bf16_f32 v142, v212, v213
    v_mfma_f32_16x16x32_bf16 a[112:115], a[188:191], v[164:167], a[112:115]
    ds_read_b64_tr_b16 a[166:167], v20 offset:45056
    ds_read_b64 v[230:231], v245 offset:192
    v_mfma_f32_16x16x32_bf16 a[116:119], a[188:191], v[172:175], a[116:119]
    ds_read_b128 a[220:223], v11 offset:49152
    v_cvt_pk_bf16_f32 v143, v214, v215
    v_mfma_f32_16x16x32_bf16 a[116:119], a[184:187], v[168:171], a[116:119]
    buffer_load_dwordx4 a[156:159], v254, s[80:83], s57 offen
    v_mfma_f32_16x16x32_bf16 v[212:215], a[224:227], v[112:115], v[204:207]
    v_exp_f32 v208, v208
    v_mfma_f32_16x16x32_bf16 v[212:215], a[228:231], v[116:119], v[212:215]
    v_exp_f32 v209, v209
    v_mfma_f32_16x16x32_bf16 v[212:215], a[232:235], v[120:123], v[212:215]
    v_exp_f32 v210, v210
    v_mfma_f32_16x16x32_bf16 v[212:215], a[236:239], v[124:127], v[212:215]
    v_exp_f32 v211, v211
    v_mfma_f32_16x16x32_bf16 a[120:123], a[184:187], v[176:179], a[120:123]
    ds_read_b64_tr_b16 a[168:169], v21 offset:32768
    v_cvt_pk_bf16_f32 v150, v208, v209
    v_mfma_f32_16x16x32_bf16 a[120:123], a[188:191], v[180:183], a[120:123]
    ds_read_b64_tr_b16 a[170:171], v21 offset:36864
    v_mfma_f32_16x16x32_bf16 a[124:127], a[188:191], v[188:191], a[124:127]
    ds_read_b128 a[224:227], v8 offset:53248
    v_cvt_pk_bf16_f32 v151, v210, v211
    v_mfma_f32_16x16x32_bf16 a[124:127], a[184:187], v[184:187], a[124:127]
    s_waitcnt lgkmcnt(3)
    buffer_load_dwordx4 v48, s[20:23], s49 offen offset:2048 lds
    v_mfma_f32_16x16x32_bf16 v[208:211], a[208:211], v[64:67], v[192:195]
    v_exp_f32 v212, v212
    v_mfma_f32_16x16x32_bf16 v[208:211], a[212:215], v[68:71], v[208:211]
    v_exp_f32 v213, v213
    v_mfma_f32_16x16x32_bf16 v[208:211], a[216:219], v[72:75], v[208:211]
    v_exp_f32 v214, v214
    v_mfma_f32_16x16x32_bf16 v[208:211], a[220:223], v[76:79], v[208:211]
    s_add_u32 s57, s58, 4718592
    v_exp_f32 v215, v215
    v_mfma_f32_16x16x32_bf16 a[0:3], a[160:163], v[128:131], a[0:3]
    ds_read_b64_tr_b16 a[172:173], v21 offset:40960
    v_cvt_pk_bf16_f32 v158, v212, v213
    v_mfma_f32_16x16x32_bf16 a[0:3], a[164:167], v[132:135], a[0:3]
    ds_read_b64_tr_b16 a[174:175], v21 offset:45056
    v_add_f32 v224, v224, v228
    v_mfma_f32_16x16x32_bf16 a[4:7], a[164:167], v[140:143], a[4:7]
    ds_read_b128 a[228:231], v9 offset:53248
    v_cvt_pk_bf16_f32 v159, v214, v215
    v_mfma_f32_16x16x32_bf16 a[4:7], a[160:163], v[136:139], a[4:7]
    buffer_load_dwordx4 a[240:243], v254, s[80:83], s57 offen
    v_mfma_f32_16x16x32_bf16 v[212:215], a[208:211], v[80:83], v[196:199]
    v_exp_f32 v208, v208
    v_mfma_f32_16x16x32_bf16 v[212:215], a[212:215], v[84:87], v[212:215]
    v_exp_f32 v209, v209
    v_mfma_f32_16x16x32_bf16 v[212:215], a[216:219], v[88:91], v[212:215]
    v_exp_f32 v210, v210
    v_mfma_f32_16x16x32_bf16 v[212:215], a[220:223], v[92:95], v[212:215]
    v_exp_f32 v211, v211
    v_mfma_f32_16x16x32_bf16 a[8:11], a[160:163], v[144:147], a[8:11]
    ds_read_b64_tr_b16 a[176:177], v22 offset:32768
    v_cvt_pk_bf16_f32 v160, v208, v209
    v_mfma_f32_16x16x32_bf16 a[8:11], a[164:167], v[148:151], a[8:11]
    ds_read_b64_tr_b16 a[178:179], v22 offset:36864
    v_add_f32 v225, v225, v229
    v_mfma_f32_16x16x32_bf16 a[12:15], a[164:167], v[156:159], a[12:15]
    ds_read_b128 a[232:235], v10 offset:53248
    v_cvt_pk_bf16_f32 v161, v210, v211
    v_mfma_f32_16x16x32_bf16 a[12:15], a[160:163], v[152:155], a[12:15]
    s_waitcnt lgkmcnt(3)
    buffer_load_dwordx4 v49, s[20:23], s49 offen offset:3072 lds
    v_mfma_f32_16x16x32_bf16 v[208:211], a[208:211], v[96:99], v[200:203]
    v_exp_f32 v212, v212
    v_mfma_f32_16x16x32_bf16 v[208:211], a[212:215], v[100:103], v[208:211]
    v_exp_f32 v213, v213
    v_mfma_f32_16x16x32_bf16 v[208:211], a[216:219], v[104:107], v[208:211]
    v_exp_f32 v214, v214
    v_mfma_f32_16x16x32_bf16 v[208:211], a[220:223], v[108:111], v[208:211]
    v_exp_f32 v215, v215
    v_mfma_f32_16x16x32_bf16 a[16:19], a[168:171], v[128:131], a[16:19]
    ds_read_b64_tr_b16 a[180:181], v22 offset:40960
    v_cvt_pk_bf16_f32 v168, v212, v213
    v_mfma_f32_16x16x32_bf16 a[16:19], a[172:175], v[132:135], a[16:19]
    ds_read_b64_tr_b16 a[182:183], v22 offset:45056
    v_add_f32 v226, v226, v230
    v_mfma_f32_16x16x32_bf16 a[20:23], a[172:175], v[140:143], a[20:23]
    ds_read_b128 a[236:239], v11 offset:53248
    v_cvt_pk_bf16_f32 v169, v214, v215
    v_mfma_f32_16x16x32_bf16 a[20:23], a[168:171], v[136:139], a[20:23]
    v_add_f32 v227, v227, v231
    v_add_f32 v224, v224, v226
    v_smfmac_f32_16x16x64_bf16 a[192:195], v[52:55], v[128:135], v50
    v_mfma_f32_16x16x32_bf16 v[212:215], a[208:211], v[112:115], v[204:207]
    v_exp_f32 v208, v208
    v_mfma_f32_16x16x32_bf16 v[212:215], a[212:215], v[116:119], v[212:215]
    s_add_u32 s49, s7, 0
    v_exp_f32 v209, v209
    v_mfma_f32_16x16x32_bf16 v[212:215], a[216:219], v[120:123], v[212:215]
    s_add_u32 m0, s42, 65536
    v_exp_f32 v210, v210
    v_mfma_f32_16x16x32_bf16 v[212:215], a[220:223], v[124:127], v[212:215]
    v_exp_f32 v211, v211
    v_mfma_f32_16x16x32_bf16 a[24:27], a[168:171], v[144:147], a[24:27]
    ds_read_b64_tr_b16 a[184:185], v23 offset:32768
    v_cvt_pk_bf16_f32 v176, v208, v209
    v_mfma_f32_16x16x32_bf16 a[24:27], a[172:175], v[148:151], a[24:27]
    ds_read_b64_tr_b16 a[186:187], v23 offset:36864
    v_add_f32 v225, v225, v227
    v_mfma_f32_16x16x32_bf16 a[28:31], a[172:175], v[156:159], a[28:31]
    ds_read_b128 a[208:211], v8 offset:57344
    v_cvt_pk_bf16_f32 v177, v210, v211
    v_mfma_f32_16x16x32_bf16 a[28:31], a[168:171], v[152:155], a[28:31]
    s_waitcnt lgkmcnt(3)
    buffer_load_dwordx4 v46, s[20:23], s49 offen lds
    v_mfma_f32_16x16x32_bf16 v[208:211], a[224:227], v[64:67], v[192:195]
    v_exp_f32 v212, v212
    v_mfma_f32_16x16x32_bf16 v[208:211], a[228:231], v[68:71], v[208:211]
    v_exp_f32 v213, v213
    v_mfma_f32_16x16x32_bf16 v[208:211], a[232:235], v[72:75], v[208:211]
    v_exp_f32 v214, v214
    v_mfma_f32_16x16x32_bf16 v[208:211], a[236:239], v[76:79], v[208:211]
    s_add_u32 s57, s58, 4128768
    v_exp_f32 v215, v215
    v_mfma_f32_16x16x32_bf16 a[32:35], a[176:179], v[128:131], a[32:35]
    ds_read_b64_tr_b16 a[188:189], v23 offset:40960
    v_cvt_pk_bf16_f32 v184, v212, v213
    v_mfma_f32_16x16x32_bf16 a[32:35], a[180:183], v[132:135], a[32:35]
    ds_read_b64_tr_b16 a[190:191], v23 offset:45056
    v_cvt_pk_bf16_f32 v246, v224, v225
    v_mfma_f32_16x16x32_bf16 a[36:39], a[180:183], v[140:143], a[36:39]
    ds_read_b128 a[212:215], v9 offset:57344
    v_cvt_pk_bf16_f32 v185, v214, v215
    v_mfma_f32_16x16x32_bf16 a[36:39], a[176:179], v[136:139], a[36:39]
    buffer_load_dwordx4 a[244:247], v254, s[32:35], s57 offen
    v_smfmac_f32_16x16x64_bf16 a[196:199], v[52:55], v[136:143], v50
    v_lshrrev_b32 v222, 5, v0
    v_mfma_f32_16x16x32_bf16 v[212:215], a[224:227], v[80:83], v[196:199]
    s_getpc_b64 s[16:17]
Lattn_pc2:
    v_exp_f32 v208, v208
    v_mfma_f32_16x16x32_bf16 v[212:215], a[228:231], v[84:87], v[212:215]
    s_mov_b32 s18, Lattn_redo-Lattn_pc2
    v_exp_f32 v209, v209
    v_mfma_f32_16x16x32_bf16 v[212:215], a[232:235], v[88:91], v[212:215]
    s_lshr_b32 s37, s2, 3
    v_exp_f32 v210, v210
    v_mfma_f32_16x16x32_bf16 v[212:215], a[236:239], v[92:95], v[212:215]
    v_exp_f32 v211, v211
    v_mfma_f32_16x16x32_bf16 a[40:43], a[176:179], v[144:147], a[40:43]
    ds_read_b64_tr_b16 a[160:161], v24 offset:32768
    v_cvt_pk_bf16_f32 v162, v208, v209
    v_mfma_f32_16x16x32_bf16 a[40:43], a[180:183], v[148:151], a[40:43]
    ds_read_b64_tr_b16 a[162:163], v24 offset:36864
    v_lshlrev_b32 v222, 12, v222
    v_mfma_f32_16x16x32_bf16 a[44:47], a[180:183], v[156:159], a[44:47]
    ds_read_b128 a[216:219], v10 offset:57344
    v_cvt_pk_bf16_f32 v163, v210, v211
    v_mfma_f32_16x16x32_bf16 a[44:47], a[176:179], v[152:155], a[44:47]
    s_waitcnt lgkmcnt(3)
    buffer_load_dwordx4 v47, s[20:23], s49 offen offset:1024 lds
    v_mfma_f32_16x16x32_bf16 v[208:211], a[224:227], v[96:99], v[200:203]
    s_lshl_b32 s37, s37, 7
    v_exp_f32 v212, v212
    v_mfma_f32_16x16x32_bf16 v[208:211], a[228:231], v[100:103], v[208:211]
    v_exp_f32 v213, v213
    v_mfma_f32_16x16x32_bf16 v[208:211], a[232:235], v[104:107], v[208:211]
    v_exp_f32 v214, v214
    v_mfma_f32_16x16x32_bf16 v[208:211], a[236:239], v[108:111], v[208:211]
    v_exp_f32 v215, v215
    v_mfma_f32_16x16x32_bf16 a[48:51], a[184:187], v[128:131], a[48:51]
    ds_read_b64_tr_b16 a[164:165], v24 offset:40960
    v_cvt_pk_bf16_f32 v170, v212, v213
    v_mfma_f32_16x16x32_bf16 a[48:51], a[188:191], v[132:135], a[48:51]
    ds_read_b64_tr_b16 a[166:167], v24 offset:45056
    v_lshlrev_b32 v224, 16, v246
    v_mfma_f32_16x16x32_bf16 a[52:55], a[188:191], v[140:143], a[52:55]
    ds_read_b128 a[220:223], v11 offset:57344
    v_cvt_pk_bf16_f32 v171, v214, v215
    v_mfma_f32_16x16x32_bf16 a[52:55], a[184:187], v[136:139], a[52:55]
    buffer_load_dword v222, v222, s[16:19], s37 offen
    v_smfmac_f32_16x16x64_bf16 a[200:203], v[52:55], v[144:151], v50
    v_mfma_f32_16x16x32_bf16 v[212:215], a[224:227], v[112:115], v[204:207]
    v_exp_f32 v208, v208
    v_mfma_f32_16x16x32_bf16 v[212:215], a[228:231], v[116:119], v[212:215]
    v_exp_f32 v209, v209
    v_mfma_f32_16x16x32_bf16 v[212:215], a[232:235], v[120:123], v[212:215]
    v_exp_f32 v210, v210
    v_mfma_f32_16x16x32_bf16 v[212:215], a[236:239], v[124:127], v[212:215]
    v_exp_f32 v211, v211
    v_mfma_f32_16x16x32_bf16 a[56:59], a[184:187], v[144:147], a[56:59]
    ds_read_b64_tr_b16 a[168:169], v25 offset:32768
    v_cvt_pk_bf16_f32 v178, v208, v209
    v_mfma_f32_16x16x32_bf16 a[56:59], a[188:191], v[148:151], a[56:59]
    ds_read_b64_tr_b16 a[170:171], v25 offset:36864
    v_and_b32 v225, 0xffff0000, v246
    v_mfma_f32_16x16x32_bf16 a[60:63], a[188:191], v[156:159], a[60:63]
    ds_read_b128 a[224:227], v8 offset:61440
    v_cvt_pk_bf16_f32 v179, v210, v211
    v_mfma_f32_16x16x32_bf16 a[60:63], a[184:187], v[152:155], a[60:63]
    s_waitcnt lgkmcnt(3)
    buffer_load_dwordx4 v48, s[20:23], s49 offen offset:2048 lds
    v_mfma_f32_16x16x32_bf16 v[208:211], a[208:211], v[64:67], v[192:195]
    v_exp_f32 v212, v212
    v_mfma_f32_16x16x32_bf16 v[208:211], a[212:215], v[68:71], v[208:211]
    v_exp_f32 v213, v213
    v_mfma_f32_16x16x32_bf16 v[208:211], a[216:219], v[72:75], v[208:211]
    v_exp_f32 v214, v214
    v_mfma_f32_16x16x32_bf16 v[208:211], a[220:223], v[76:79], v[208:211]
    s_add_u32 s57, s58, 4718592
    v_exp_f32 v215, v215
    v_mfma_f32_16x16x32_bf16 a[64:67], a[160:163], v[128:131], a[64:67]
    ds_read_b64_tr_b16 a[172:173], v25 offset:40960
    v_cvt_pk_bf16_f32 v186, v212, v213
    v_mfma_f32_16x16x32_bf16 a[64:67], a[164:167], v[132:135], a[64:67]
Ltour0_7:
    s_cbranch_execz Ltour0_11
    ds_read_b64_tr_b16 a[174:175], v25 offset:45056
    v_add_f32 v224, s36, v224
    v_mfma_f32_16x16x32_bf16 a[68:71], a[164:167], v[140:143], a[68:71]
    ds_read_b128 a[228:231], v9 offset:61440
    v_cvt_pk_bf16_f32 v187, v214, v215
    v_mfma_f32_16x16x32_bf16 a[68:71], a[160:163], v[136:139], a[68:71]
    buffer_load_dwordx4 a[248:251], v254, s[32:35], s57 offen
    v_smfmac_f32_16x16x64_bf16 a[204:207], v[52:55], v[152:159], v50
    v_mfma_f32_16x16x32_bf16 v[212:215], a[208:211], v[80:83], v[196:199]
    v_exp_f32 v208, v208
    v_mfma_f32_16x16x32_bf16 v[212:215], a[212:215], v[84:87], v[212:215]
    v_exp_f32 v209, v209
    v_mfma_f32_16x16x32_bf16 v[212:215], a[216:219], v[88:91], v[212:215]
    v_exp_f32 v210, v210
    v_mfma_f32_16x16x32_bf16 v[212:215], a[220:223], v[92:95], v[212:215]
    v_exp_f32 v211, v211
    v_mfma_f32_16x16x32_bf16 a[72:75], a[160:163], v[144:147], a[72:75]
    ds_read_b64_tr_b16 a[176:177], v26 offset:32768
    v_cvt_pk_bf16_f32 v164, v208, v209
    v_mfma_f32_16x16x32_bf16 a[72:75], a[164:167], v[148:151], a[72:75]
    ds_read_b64_tr_b16 a[178:179], v26 offset:36864
    v_add_f32 v225, s36, v225
    v_mfma_f32_16x16x32_bf16 a[76:79], a[164:167], v[156:159], a[76:79]
    ds_read_b128 a[232:235], v10 offset:61440
    v_cvt_pk_bf16_f32 v165, v210, v211
    v_mfma_f32_16x16x32_bf16 a[76:79], a[160:163], v[152:155], a[76:79]
    s_waitcnt lgkmcnt(3)
    buffer_load_dwordx4 v49, s[20:23], s49 offen offset:3072 lds
    v_mfma_f32_16x16x32_bf16 v[208:211], a[208:211], v[96:99], v[200:203]
    v_exp_f32 v212, v212
    v_mfma_f32_16x16x32_bf16 v[208:211], a[212:215], v[100:103], v[208:211]
    v_exp_f32 v213, v213
    v_mfma_f32_16x16x32_bf16 v[208:211], a[216:219], v[104:107], v[208:211]
    v_exp_f32 v214, v214
    v_mfma_f32_16x16x32_bf16 v[208:211], a[220:223], v[108:111], v[208:211]
    v_exp_f32 v215, v215
    v_mfma_f32_16x16x32_bf16 a[80:83], a[168:171], v[128:131], a[80:83]
    ds_read_b64_tr_b16 a[180:181], v26 offset:40960
    v_cvt_pk_bf16_f32 v172, v212, v213
    v_mfma_f32_16x16x32_bf16 a[80:83], a[172:175], v[132:135], a[80:83]
    ds_read_b64_tr_b16 a[182:183], v26 offset:45056
    v_cvt_pk_bf16_f32 v246, v224, v225
    v_mfma_f32_16x16x32_bf16 a[84:87], a[172:175], v[140:143], a[84:87]
    ds_read_b128 a[236:239], v11 offset:61440
    v_cvt_pk_bf16_f32 v173, v214, v215
    v_mfma_f32_16x16x32_bf16 a[84:87], a[168:171], v[136:139], a[84:87]
    s_waitcnt vmcnt(14)
    s_barrier
    v_mfma_f32_16x16x32_bf16 v[212:215], a[208:211], v[112:115], v[204:207]
    v_exp_f32 v208, v208
    v_mfma_f32_16x16x32_bf16 v[212:215], a[212:215], v[116:119], v[212:215]
    s_add_u32 s49, s7, 73728
    v_exp_f32 v209, v209
    v_mfma_f32_16x16x32_bf16 v[212:215], a[216:219], v[120:123], v[212:215]
    s_add_u32 m0, s42, 81920
    v_exp_f32 v210, v210
    v_mfma_f32_16x16x32_bf16 v[212:215], a[220:223], v[124:127], v[212:215]
    v_exp_f32 v211, v211
    v_mfma_f32_16x16x32_bf16 a[88:91], a[168:171], v[144:147], a[88:91]
    ds_read_b64_tr_b16 a[184:185], v27 offset:32768
    v_cvt_pk_bf16_f32 v180, v208, v209
    v_mfma_f32_16x16x32_bf16 a[88:91], a[172:175], v[148:151], a[88:91]
    ds_read_b64_tr_b16 a[186:187], v27 offset:36864
    v_lshrrev_b32 v244, 1, v0
    v_mfma_f32_16x16x32_bf16 a[92:95], a[172:175], v[156:159], a[92:95]
    v_cvt_pk_bf16_f32 v181, v210, v211
    v_mfma_f32_16x16x32_bf16 a[92:95], a[168:171], v[152:155], a[92:95]
    s_waitcnt lgkmcnt(3)
    buffer_load_dwordx4 v46, s[20:23], s49 offen lds
    v_mfma_f32_16x16x32_bf16 v[208:211], a[224:227], v[64:67], v[192:195]
    v_exp_f32 v212, v212
    v_mfma_f32_16x16x32_bf16 v[208:211], a[228:231], v[68:71], v[208:211]
    v_exp_f32 v213, v213
    v_mfma_f32_16x16x32_bf16 v[208:211], a[232:235], v[72:75], v[208:211]
    s_waitcnt lgkmcnt(2)
    v_exp_f32 v214, v214
    v_mfma_f32_16x16x32_bf16 v[208:211], a[236:239], v[76:79], v[208:211]
    v_exp_f32 v215, v215
    v_mfma_f32_16x16x32_bf16 a[96:99], a[176:179], v[128:131], a[96:99]
    ds_read_b64_tr_b16 a[188:189], v27 offset:40960
    v_cvt_pk_bf16_f32 v188, v212, v213
    v_mfma_f32_16x16x32_bf16 a[96:99], a[180:183], v[132:135], a[96:99]
    ds_read_b64_tr_b16 a[190:191], v27 offset:45056
    v_lshlrev_b32 v244, 4, v244
    v_mfma_f32_16x16x32_bf16 a[100:103], a[180:183], v[140:143], a[100:103]
    v_cvt_pk_bf16_f32 v189, v214, v215
    v_mfma_f32_16x16x32_bf16 a[100:103], a[176:179], v[136:139], a[100:103]
    v_and_b32 v245, 1, v0
    v_lshl_add_u32 v244, v245, 2, v244
    v_mfma_f32_16x16x32_bf16 v[212:215], a[224:227], v[80:83], v[196:199]
    v_exp_f32 v208, v208
    v_mfma_f32_16x16x32_bf16 v[212:215], a[228:231], v[84:87], v[212:215]
    v_exp_f32 v209, v209
    v_mfma_f32_16x16x32_bf16 v[212:215], a[232:235], v[88:91], v[212:215]
    v_exp_f32 v210, v210
    v_mfma_f32_16x16x32_bf16 v[212:215], a[236:239], v[92:95], v[212:215]
    v_exp_f32 v211, v211
    v_mfma_f32_16x16x32_bf16 a[104:107], a[176:179], v[144:147], a[104:107]
    ds_read_b64_tr_b16 a[160:161], v20 offset:49152
    v_cvt_pk_bf16_f32 v166, v208, v209
    v_mfma_f32_16x16x32_bf16 a[104:107], a[180:183], v[148:151], a[104:107]
    ds_read_b64_tr_b16 a[162:163], v20 offset:53248
    v_lshrrev_b32 v245, 3, v0
    v_mfma_f32_16x16x32_bf16 a[108:111], a[180:183], v[156:159], a[108:111]
    v_cvt_pk_bf16_f32 v167, v210, v211
    v_mfma_f32_16x16x32_bf16 a[108:111], a[176:179], v[152:155], a[108:111]
    s_waitcnt lgkmcnt(3)
    buffer_load_dwordx4 v47, s[20:23], s49 offen offset:1024 lds
    v_mfma_f32_16x16x32_bf16 v[208:211], a[224:227], v[96:99], v[200:203]
    v_exp_f32 v212, v212
    v_mfma_f32_16x16x32_bf16 v[208:211], a[228:231], v[100:103], v[208:211]
    v_exp_f32 v213, v213
    v_mfma_f32_16x16x32_bf16 v[208:211], a[232:235], v[104:107], v[208:211]
    v_exp_f32 v214, v214
    v_mfma_f32_16x16x32_bf16 v[208:211], a[236:239], v[108:111], v[208:211]
    s_add_u32 s57, s59, 0
    v_exp_f32 v215, v215
    v_mfma_f32_16x16x32_bf16 a[112:115], a[184:187], v[128:131], a[112:115]
    s_waitcnt lgkmcnt(2)
    ds_read_b64_tr_b16 a[164:165], v20 offset:57344
    v_cvt_pk_bf16_f32 v174, v212, v213
    v_mfma_f32_16x16x32_bf16 a[112:115], a[188:191], v[132:135], a[112:115]
    ds_read_b64_tr_b16 a[166:167], v20 offset:61440
    v_min_u32 v245, 1, v245
    v_mfma_f32_16x16x32_bf16 a[116:119], a[188:191], v[140:143], a[116:119]
    v_cvt_pk_bf16_f32 v175, v214, v215
    v_mfma_f32_16x16x32_bf16 a[116:119], a[184:187], v[136:139], a[116:119]
    buffer_load_dwordx4 a[252:255], v255, s[84:87], s57 offen
    v_mfma_f32_16x16x32_bf16 v[212:215], a[224:227], v[112:115], v[204:207]
    v_exp_f32 v208, v208
    v_mfma_f32_16x16x32_bf16 v[212:215], a[228:231], v[116:119], v[212:215]
    v_exp_f32 v209, v209
    v_mfma_f32_16x16x32_bf16 v[212:215], a[232:235], v[120:123], v[212:215]
    v_exp_f32 v210, v210
    v_mfma_f32_16x16x32_bf16 v[212:215], a[236:239], v[124:127], v[212:215]
    v_exp_f32 v211, v211
    v_mfma_f32_16x16x32_bf16 a[120:123], a[184:187], v[144:147], a[120:123]
    ds_read_b64_tr_b16 a[168:169], v21 offset:49152
    v_cvt_pk_bf16_f32 v182, v208, v209
    v_mfma_f32_16x16x32_bf16 a[120:123], a[188:191], v[148:151], a[120:123]
    ds_read_b64_tr_b16 a[170:171], v21 offset:53248
    v_lshl_or_b32 v244, v245, 31, v244
    v_mfma_f32_16x16x32_bf16 a[124:127], a[188:191], v[156:159], a[124:127]
    v_cvt_pk_bf16_f32 v183, v210, v211
    v_mfma_f32_16x16x32_bf16 a[124:127], a[184:187], v[152:155], a[124:127]
    s_waitcnt lgkmcnt(3)
    buffer_load_dwordx4 v48, s[20:23], s49 offen offset:2048 lds
    v_smfmac_f32_16x16x64_bf16 a[192:195], v[52:55], v[160:167], v50
    v_exp_f32 v212, v212
    v_smfmac_f32_16x16x64_bf16 a[196:199], v[52:55], v[168:175], v50
    v_exp_f32 v213, v213
    v_smfmac_f32_16x16x64_bf16 a[200:203], v[52:55], v[176:183], v50
    v_exp_f32 v214, v214
    v_exp_f32 v215, v215
    v_mfma_f32_16x16x32_bf16 a[0:3], a[160:163], v[160:163], a[0:3]
    s_waitcnt lgkmcnt(2)
    ds_read_b64_tr_b16 a[172:173], v21 offset:57344
    v_cvt_pk_bf16_f32 v190, v212, v213
    v_mfma_f32_16x16x32_bf16 a[0:3], a[164:167], v[164:167], a[0:3]
    ds_read_b64_tr_b16 a[174:175], v21 offset:61440
    v_mfma_f32_16x16x32_bf16 a[4:7], a[164:167], v[172:175], a[4:7]
    v_cvt_pk_bf16_f32 v191, v214, v215
    v_mfma_f32_16x16x32_bf16 a[4:7], a[160:163], v[168:171], a[4:7]
    buffer_store_dword v246, v244, s[24:27], s39 offen sc1
    v_smfmac_f32_16x16x64_bf16 a[204:207], v[52:55], v[184:191], v50
    v_mfma_f32_16x16x32_bf16 a[8:11], a[160:163], v[176:179], a[8:11]
    ds_read_b64_tr_b16 a[176:177], v22 offset:49152
    v_mfma_f32_16x16x32_bf16 a[8:11], a[164:167], v[180:183], a[8:11]
    ds_read_b64_tr_b16 a[178:179], v22 offset:53248
    v_accvgpr_read_b32 v216, a192
    v_accvgpr_read_b32 v217, a193
    v_mfma_f32_16x16x32_bf16 a[12:15], a[164:167], v[188:191], a[12:15]
    v_accvgpr_read_b32 v218, a196
    v_accvgpr_read_b32 v219, a197
    v_mfma_f32_16x16x32_bf16 a[12:15], a[160:163], v[184:187], a[12:15]
    s_waitcnt lgkmcnt(4)
    buffer_load_dwordx4 v49, s[20:23], s49 offen offset:3072 lds
    v_accvgpr_read_b32 v220, a200
    v_accvgpr_read_b32 v221, a201
    v_mfma_f32_16x16x32_bf16 a[16:19], a[168:171], v[160:163], a[16:19]
    s_waitcnt lgkmcnt(2)
    ds_read_b64_tr_b16 a[180:181], v22 offset:57344
    s_waitcnt vmcnt(9)
    v_accvgpr_read_b32 v222, a204
    v_mfma_f32_16x16x32_bf16 a[16:19], a[172:175], v[164:167], a[16:19]
    ds_read_b64_tr_b16 a[182:183], v22 offset:61440
    v_accvgpr_read_b32 v223, a205
    v_add_f32 v58, v216, v217
    v_mfma_f32_16x16x32_bf16 a[20:23], a[172:175], v[172:175], a[20:23]
    v_add_f32 v59, v218, v219
    v_add_f32 v60, v220, v221
    v_mfma_f32_16x16x32_bf16 a[20:23], a[168:171], v[168:171], a[20:23]
    v_add_f32 v61, v222, v223
    v_add_f32 v216, v58, v59
    s_add_u32 s49, s7, 256
    s_add_u32 m0, s42, 32768
    v_mfma_f32_16x16x32_bf16 a[24:27], a[168:171], v[176:179], a[24:27]
    ds_read_b64_tr_b16 a[184:185], v23 offset:49152
    v_add_f32 v217, v60, v61
    v_mfma_f32_16x16x32_bf16 a[24:27], a[172:175], v[180:183], a[24:27]
    ds_read_b64_tr_b16 a[186:187], v23 offset:53248
    v_add_f32 v216, v216, v217
    v_cmp_ngt_f32 vcc, 1669332992, v216
    v_mfma_f32_16x16x32_bf16 a[28:31], a[172:175], v[188:191], a[28:31]
    v_rcp_f32 v58, v58
    v_rcp_f32 v59, v59
    v_mfma_f32_16x16x32_bf16 a[28:31], a[168:171], v[184:187], a[28:31]
    s_waitcnt lgkmcnt(4)
    buffer_load_dwordx4 v46, s[20:23], s49 offen lds
    v_rcp_f32 v60, v60
    v_rcp_f32 v61, v61
    v_mfma_f32_16x16x32_bf16 a[32:35], a[176:179], v[160:163], a[32:35]
    s_waitcnt lgkmcnt(2)
    ds_read_b64_tr_b16 a[188:189], v23 offset:57344
    v_mov_b32 v228, 131072
    v_mfma_f32_16x16x32_bf16 a[32:35], a[180:183], v[164:167], a[32:35]
    ds_read_b64_tr_b16 a[190:191], v23 offset:61440
    s_or_b32 s36, vcc_lo, vcc_hi
    v_mfma_f32_16x16x32_bf16 a[36:39], a[180:183], v[172:175], a[36:39]
    v_accvgpr_read_b32 v208, a0
    v_accvgpr_read_b32 v209, a1
    v_accvgpr_read_b32 v210, a2
    v_accvgpr_read_b32 v211, a3
    v_pk_mul_f32 v[208:209], v[208:209], v[58:59] op_sel:[0,0] op_sel_hi:[1,0]
    v_pk_mul_f32 v[210:211], v[210:211], v[58:59] op_sel:[0,0] op_sel_hi:[1,0]
    v_cvt_pk_bf16_f32 v128, v208, v209
    v_cvt_pk_bf16_f32 v129, v210, v211
    v_mfma_f32_16x16x32_bf16 a[36:39], a[176:179], v[168:171], a[36:39]
    v_accvgpr_read_b32 v212, a4
    v_accvgpr_read_b32 v213, a5
    v_accvgpr_read_b32 v214, a6
    v_accvgpr_read_b32 v215, a7
    v_pk_mul_f32 v[212:213], v[212:213], v[58:59] op_sel:[0,1] op_sel_hi:[1,1]
    v_pk_mul_f32 v[214:215], v[214:215], v[58:59] op_sel:[0,1] op_sel_hi:[1,1]
    v_cvt_pk_bf16_f32 v132, v212, v213
    v_cvt_pk_bf16_f32 v133, v214, v215
    v_mfma_f32_16x16x32_bf16 a[40:43], a[176:179], v[176:179], a[40:43]
    ds_read_b64_tr_b16 a[160:161], v24 offset:49152
    v_mov_b32 v218, s36
    v_mfma_f32_16x16x32_bf16 a[40:43], a[180:183], v[180:183], a[40:43]
    ds_read_b64_tr_b16 a[162:163], v24 offset:53248
    s_lshl_b32 s38, s3, 2
    v_mfma_f32_16x16x32_bf16 a[44:47], a[180:183], v[188:191], a[44:47]
    v_accvgpr_read_b32 v208, a8
    v_accvgpr_read_b32 v209, a9
    v_accvgpr_read_b32 v210, a10
    v_accvgpr_read_b32 v211, a11
    v_pk_mul_f32 v[208:209], v[208:209], v[60:61] op_sel:[0,0] op_sel_hi:[1,0]
    v_pk_mul_f32 v[210:211], v[210:211], v[60:61] op_sel:[0,0] op_sel_hi:[1,0]
    v_cvt_pk_bf16_f32 v136, v208, v209
    v_cvt_pk_bf16_f32 v137, v210, v211
    v_mfma_f32_16x16x32_bf16 a[44:47], a[176:179], v[184:187], a[44:47]
    s_waitcnt lgkmcnt(4)
    buffer_load_dwordx4 v47, s[20:23], s49 offen offset:1024 lds
    v_accvgpr_read_b32 v212, a12
    v_accvgpr_read_b32 v213, a13
    v_accvgpr_read_b32 v214, a14
    v_accvgpr_read_b32 v215, a15
    v_pk_mul_f32 v[212:213], v[212:213], v[60:61] op_sel:[0,1] op_sel_hi:[1,1]
    v_pk_mul_f32 v[214:215], v[214:215], v[60:61] op_sel:[0,1] op_sel_hi:[1,1]
    v_cvt_pk_bf16_f32 v140, v212, v213
    v_cvt_pk_bf16_f32 v141, v214, v215
    v_mfma_f32_16x16x32_bf16 a[48:51], a[184:187], v[160:163], a[48:51]
    s_waitcnt lgkmcnt(2)
    ds_read_b64_tr_b16 a[164:165], v24 offset:57344
    v_add_u32 v219, s38, v228
    v_mfma_f32_16x16x32_bf16 a[48:51], a[188:191], v[164:167], a[48:51]
    ds_read_b64_tr_b16 a[166:167], v24 offset:61440
    ds_write_b32 v219, v218
    v_mfma_f32_16x16x32_bf16 a[52:55], a[188:191], v[172:175], a[52:55]
    v_accvgpr_read_b32 v208, a16
    v_accvgpr_read_b32 v209, a17
    v_accvgpr_read_b32 v210, a18
    v_accvgpr_read_b32 v211, a19
    v_pk_mul_f32 v[208:209], v[208:209], v[58:59] op_sel:[0,0] op_sel_hi:[1,0]
    v_pk_mul_f32 v[210:211], v[210:211], v[58:59] op_sel:[0,0] op_sel_hi:[1,0]
    v_cvt_pk_bf16_f32 v130, v208, v209
    v_cvt_pk_bf16_f32 v131, v210, v211
    s_add_u32 s37, s55, 0
    buffer_store_dwordx4 v[128:131], v252, s[28:31], s37 offen offset:0
    v_mfma_f32_16x16x32_bf16 a[52:55], a[184:187], v[168:171], a[52:55]
    v_accvgpr_read_b32 v212, a20
    v_accvgpr_read_b32 v213, a21
    v_accvgpr_read_b32 v214, a22
    v_accvgpr_read_b32 v215, a23
    v_pk_mul_f32 v[212:213], v[212:213], v[58:59] op_sel:[0,1] op_sel_hi:[1,1]
    v_pk_mul_f32 v[214:215], v[214:215], v[58:59] op_sel:[0,1] op_sel_hi:[1,1]
    v_cvt_pk_bf16_f32 v134, v212, v213
    v_cvt_pk_bf16_f32 v135, v214, v215
    s_add_u32 s37, s55, 0
    buffer_store_dwordx4 v[132:135], v252, s[28:31], s37 offen offset:1024
    v_mfma_f32_16x16x32_bf16 a[56:59], a[184:187], v[176:179], a[56:59]
    ds_read_b64_tr_b16 a[168:169], v25 offset:49152
    v_min_u32 v240, 1, v0
    v_mfma_f32_16x16x32_bf16 a[56:59], a[188:191], v[180:183], a[56:59]
    ds_read_b64_tr_b16 a[170:171], v25 offset:53248
    v_mfma_f32_16x16x32_bf16 a[60:63], a[188:191], v[188:191], a[60:63]
    v_accvgpr_read_b32 v208, a24
    v_accvgpr_read_b32 v209, a25
    v_accvgpr_read_b32 v210, a26
    v_accvgpr_read_b32 v211, a27
    v_pk_mul_f32 v[208:209], v[208:209], v[60:61] op_sel:[0,0] op_sel_hi:[1,0]
    v_pk_mul_f32 v[210:211], v[210:211], v[60:61] op_sel:[0,0] op_sel_hi:[1,0]
    v_cvt_pk_bf16_f32 v138, v208, v209
    v_cvt_pk_bf16_f32 v139, v210, v211
    s_add_u32 s37, s55, 0
    buffer_store_dwordx4 v[136:139], v252, s[28:31], s37 offen offset:2048
    v_mfma_f32_16x16x32_bf16 a[60:63], a[184:187], v[184:187], a[60:63]
    s_waitcnt lgkmcnt(5)
    buffer_load_dwordx4 v48, s[20:23], s49 offen offset:2048 lds
    v_accvgpr_read_b32 v212, a28
    v_accvgpr_read_b32 v213, a29
    v_accvgpr_read_b32 v214, a30
    v_accvgpr_read_b32 v215, a31
    v_pk_mul_f32 v[212:213], v[212:213], v[60:61] op_sel:[0,1] op_sel_hi:[1,1]
    v_pk_mul_f32 v[214:215], v[214:215], v[60:61] op_sel:[0,1] op_sel_hi:[1,1]
    v_cvt_pk_bf16_f32 v142, v212, v213
    v_cvt_pk_bf16_f32 v143, v214, v215
    s_add_u32 s37, s55, 0
    buffer_store_dwordx4 v[140:143], v252, s[28:31], s37 offen offset:3072
    v_mfma_f32_16x16x32_bf16 a[64:67], a[160:163], v[160:163], a[64:67]
    s_waitcnt lgkmcnt(3)
    ds_read_b64_tr_b16 a[172:173], v25 offset:57344
    v_lshlrev_b32 v240, 31, v240
    v_mfma_f32_16x16x32_bf16 a[64:67], a[164:167], v[164:167], a[64:67]
    ds_read_b64_tr_b16 a[174:175], v25 offset:61440
    v_mfma_f32_16x16x32_bf16 a[68:71], a[164:167], v[172:175], a[68:71]
    v_accvgpr_read_b32 v208, a32
    v_accvgpr_read_b32 v209, a33
    v_accvgpr_read_b32 v210, a34
    v_accvgpr_read_b32 v211, a35
    v_pk_mul_f32 v[208:209], v[208:209], v[58:59] op_sel:[0,0] op_sel_hi:[1,0]
    v_pk_mul_f32 v[210:211], v[210:211], v[58:59] op_sel:[0,0] op_sel_hi:[1,0]
    v_cvt_pk_bf16_f32 v144, v208, v209
    v_cvt_pk_bf16_f32 v145, v210, v211
    v_mfma_f32_16x16x32_bf16 a[68:71], a[160:163], v[168:171], a[68:71]
    v_accvgpr_read_b32 v212, a36
    v_accvgpr_read_b32 v213, a37
    v_accvgpr_read_b32 v214, a38
    v_accvgpr_read_b32 v215, a39
    v_pk_mul_f32 v[212:213], v[212:213], v[58:59] op_sel:[0,1] op_sel_hi:[1,1]
    v_pk_mul_f32 v[214:215], v[214:215], v[58:59] op_sel:[0,1] op_sel_hi:[1,1]
    v_cvt_pk_bf16_f32 v148, v212, v213
    v_cvt_pk_bf16_f32 v149, v214, v215
    v_mfma_f32_16x16x32_bf16 a[72:75], a[160:163], v[176:179], a[72:75]
    ds_read_b64_tr_b16 a[176:177], v26 offset:49152
    v_mov_b32 v241, 1
    v_mfma_f32_16x16x32_bf16 a[72:75], a[164:167], v[180:183], a[72:75]
    ds_read_b64_tr_b16 a[178:179], v26 offset:53248
    v_mfma_f32_16x16x32_bf16 a[76:79], a[164:167], v[188:191], a[76:79]
    v_accvgpr_read_b32 v208, a40
    v_accvgpr_read_b32 v209, a41
    v_accvgpr_read_b32 v210, a42
    v_accvgpr_read_b32 v211, a43
    v_pk_mul_f32 v[208:209], v[208:209], v[60:61] op_sel:[0,0] op_sel_hi:[1,0]
    v_pk_mul_f32 v[210:211], v[210:211], v[60:61] op_sel:[0,0] op_sel_hi:[1,0]
    v_cvt_pk_bf16_f32 v152, v208, v209
    v_cvt_pk_bf16_f32 v153, v210, v211
    v_mfma_f32_16x16x32_bf16 a[76:79], a[160:163], v[184:187], a[76:79]
    s_waitcnt lgkmcnt(4)
    buffer_load_dwordx4 v49, s[20:23], s49 offen offset:3072 lds
    v_accvgpr_read_b32 v212, a44
    v_accvgpr_read_b32 v213, a45
    v_accvgpr_read_b32 v214, a46
    v_accvgpr_read_b32 v215, a47
    v_pk_mul_f32 v[212:213], v[212:213], v[60:61] op_sel:[0,1] op_sel_hi:[1,1]
    v_pk_mul_f32 v[214:215], v[214:215], v[60:61] op_sel:[0,1] op_sel_hi:[1,1]
    v_cvt_pk_bf16_f32 v156, v212, v213
    v_cvt_pk_bf16_f32 v157, v214, v215
    v_mfma_f32_16x16x32_bf16 a[80:83], a[168:171], v[160:163], a[80:83]
    s_waitcnt lgkmcnt(2)
    ds_read_b64_tr_b16 a[180:181], v26 offset:57344
    v_mfma_f32_16x16x32_bf16 a[80:83], a[172:175], v[164:167], a[80:83]
    ds_read_b64_tr_b16 a[182:183], v26 offset:61440
    v_mfma_f32_16x16x32_bf16 a[84:87], a[172:175], v[172:175], a[84:87]
    v_accvgpr_read_b32 v208, a48
    v_accvgpr_read_b32 v209, a49
    v_accvgpr_read_b32 v210, a50
    v_accvgpr_read_b32 v211, a51
    v_pk_mul_f32 v[208:209], v[208:209], v[58:59] op_sel:[0,0] op_sel_hi:[1,0]
    v_pk_mul_f32 v[210:211], v[210:211], v[58:59] op_sel:[0,0] op_sel_hi:[1,0]
    v_cvt_pk_bf16_f32 v146, v208, v209
    v_cvt_pk_bf16_f32 v147, v210, v211
    s_add_u32 s37, s55, 4096
    buffer_store_dwordx4 v[144:147], v252, s[28:31], s37 offen offset:0
    v_mfma_f32_16x16x32_bf16 a[84:87], a[168:171], v[168:171], a[84:87]
    v_accvgpr_read_b32 v212, a52
    v_accvgpr_read_b32 v213, a53
    v_accvgpr_read_b32 v214, a54
    v_accvgpr_read_b32 v215, a55
    v_pk_mul_f32 v[212:213], v[212:213], v[58:59] op_sel:[0,1] op_sel_hi:[1,1]
    v_pk_mul_f32 v[214:215], v[214:215], v[58:59] op_sel:[0,1] op_sel_hi:[1,1]
    v_cvt_pk_bf16_f32 v150, v212, v213
    v_cvt_pk_bf16_f32 v151, v214, v215
    s_add_u32 s37, s55, 4096
    buffer_store_dwordx4 v[148:151], v252, s[28:31], s37 offen offset:1024
    s_waitcnt vmcnt(23)
    s_barrier
    v_mfma_f32_16x16x32_bf16 a[88:91], a[168:171], v[176:179], a[88:91]
    ds_read_b64_tr_b16 a[184:185], v27 offset:49152
    v_mfma_f32_16x16x32_bf16 a[88:91], a[172:175], v[180:183], a[88:91]
    ds_read_b64_tr_b16 a[186:187], v27 offset:53248
    v_mfma_f32_16x16x32_bf16 a[92:95], a[172:175], v[188:191], a[92:95]
    ds_read_b128 v[224:227], v228
    v_accvgpr_read_b32 v208, a56
    v_accvgpr_read_b32 v209, a57
    v_accvgpr_read_b32 v210, a58
    v_accvgpr_read_b32 v211, a59
    v_pk_mul_f32 v[208:209], v[208:209], v[60:61] op_sel:[0,0] op_sel_hi:[1,0]
    v_pk_mul_f32 v[210:211], v[210:211], v[60:61] op_sel:[0,0] op_sel_hi:[1,0]
    v_cvt_pk_bf16_f32 v154, v208, v209
    v_cvt_pk_bf16_f32 v155, v210, v211
    s_add_u32 s37, s55, 4096
    buffer_store_dwordx4 v[152:155], v252, s[28:31], s37 offen offset:2048
    v_mfma_f32_16x16x32_bf16 a[92:95], a[168:171], v[184:187], a[92:95]
    s_waitcnt lgkmcnt(5)
    v_accvgpr_read_b32 v212, a60
    v_accvgpr_read_b32 v213, a61
    v_accvgpr_read_b32 v214, a62
    v_accvgpr_read_b32 v215, a63
    v_pk_mul_f32 v[212:213], v[212:213], v[60:61] op_sel:[0,1] op_sel_hi:[1,1]
    v_pk_mul_f32 v[214:215], v[214:215], v[60:61] op_sel:[0,1] op_sel_hi:[1,1]
    v_cvt_pk_bf16_f32 v158, v212, v213
    v_cvt_pk_bf16_f32 v159, v214, v215
    s_add_u32 s37, s55, 4096
    buffer_store_dwordx4 v[156:159], v252, s[28:31], s37 offen offset:3072
    s_add_u32 s49, s7, 73984
    v_mfma_f32_16x16x32_bf16 a[96:99], a[176:179], v[160:163], a[96:99]
    s_waitcnt lgkmcnt(3)
    s_add_u32 m0, s42, 49152
    ds_read_b64_tr_b16 a[188:189], v27 offset:57344
    v_mfma_f32_16x16x32_bf16 a[96:99], a[180:183], v[164:167], a[96:99]
    buffer_load_dwordx4 v46, s[20:23], s49 offen lds
    v_mfma_f32_16x16x32_bf16 a[100:103], a[180:183], v[172:175], a[100:103]
    ds_read_b64_tr_b16 a[190:191], v27 offset:61440
    v_accvgpr_read_b32 v208, a64
    v_accvgpr_read_b32 v209, a65
    v_accvgpr_read_b32 v210, a66
    v_accvgpr_read_b32 v211, a67
    v_pk_mul_f32 v[208:209], v[208:209], v[58:59] op_sel:[0,0] op_sel_hi:[1,0]
    v_pk_mul_f32 v[210:211], v[210:211], v[58:59] op_sel:[0,0] op_sel_hi:[1,0]
    v_cvt_pk_bf16_f32 v192, v208, v209
    v_cvt_pk_bf16_f32 v193, v210, v211
    v_mfma_f32_16x16x32_bf16 a[100:103], a[176:179], v[168:171], a[100:103]
    buffer_load_dwordx4 v47, s[20:23], s49 offen offset:1024 lds
    v_accvgpr_read_b32 v212, a68
    v_accvgpr_read_b32 v213, a69
    v_accvgpr_read_b32 v214, a70
    v_accvgpr_read_b32 v215, a71
    v_pk_mul_f32 v[212:213], v[212:213], v[58:59] op_sel:[0,1] op_sel_hi:[1,1]
    v_pk_mul_f32 v[214:215], v[214:215], v[58:59] op_sel:[0,1] op_sel_hi:[1,1]
    v_cvt_pk_bf16_f32 v196, v212, v213
    v_cvt_pk_bf16_f32 v197, v214, v215
    v_mfma_f32_16x16x32_bf16 a[104:107], a[176:179], v[176:179], a[104:107]
    v_mfma_f32_16x16x32_bf16 a[104:107], a[180:183], v[180:183], a[104:107]
    buffer_load_dwordx4 v48, s[20:23], s49 offen offset:2048 lds
    v_mfma_f32_16x16x32_bf16 a[108:111], a[180:183], v[188:191], a[108:111]
    v_accvgpr_read_b32 v208, a72
    v_accvgpr_read_b32 v209, a73
    v_accvgpr_read_b32 v210, a74
    v_accvgpr_read_b32 v211, a75
    v_pk_mul_f32 v[208:209], v[208:209], v[60:61] op_sel:[0,0] op_sel_hi:[1,0]
    v_pk_mul_f32 v[210:211], v[210:211], v[60:61] op_sel:[0,0] op_sel_hi:[1,0]
    v_cvt_pk_bf16_f32 v200, v208, v209
    v_cvt_pk_bf16_f32 v201, v210, v211
    v_mfma_f32_16x16x32_bf16 a[108:111], a[176:179], v[184:187], a[108:111]
    s_waitcnt lgkmcnt(3)
    buffer_load_dwordx4 v49, s[20:23], s49 offen offset:3072 lds
    v_accvgpr_read_b32 v212, a76
    v_accvgpr_read_b32 v213, a77
    v_accvgpr_read_b32 v214, a78
    v_accvgpr_read_b32 v215, a79
    v_pk_mul_f32 v[212:213], v[212:213], v[60:61] op_sel:[0,1] op_sel_hi:[1,1]
    v_pk_mul_f32 v[214:215], v[214:215], v[60:61] op_sel:[0,1] op_sel_hi:[1,1]
    v_cvt_pk_bf16_f32 v204, v212, v213
    v_cvt_pk_bf16_f32 v205, v214, v215
    s_add_u32 s49, s46, 0
    v_mfma_f32_16x16x32_bf16 a[112:115], a[184:187], v[160:163], a[112:115]
    s_waitcnt lgkmcnt(0)
    s_add_u32 m0, s42, 98304
    v_mfma_f32_16x16x32_bf16 a[112:115], a[188:191], v[164:167], a[112:115]
    buffer_load_dwordx4 v46, s[20:23], s49 offen lds
    v_mfma_f32_16x16x32_bf16 a[116:119], a[188:191], v[172:175], a[116:119]
    v_accvgpr_read_b32 v208, a80
    v_accvgpr_read_b32 v209, a81
    v_accvgpr_read_b32 v210, a82
    v_accvgpr_read_b32 v211, a83
    v_pk_mul_f32 v[208:209], v[208:209], v[58:59] op_sel:[0,0] op_sel_hi:[1,0]
    v_pk_mul_f32 v[210:211], v[210:211], v[58:59] op_sel:[0,0] op_sel_hi:[1,0]
    v_cvt_pk_bf16_f32 v194, v208, v209
    v_cvt_pk_bf16_f32 v195, v210, v211
    s_add_u32 s37, s55, 8192
    buffer_store_dwordx4 v[192:195], v252, s[28:31], s37 offen offset:0
    v_mfma_f32_16x16x32_bf16 a[116:119], a[184:187], v[168:171], a[116:119]
    buffer_load_dwordx4 v47, s[20:23], s49 offen offset:1024 lds
    v_accvgpr_read_b32 v212, a84
    v_accvgpr_read_b32 v213, a85
    v_accvgpr_read_b32 v214, a86
    v_accvgpr_read_b32 v215, a87
    v_pk_mul_f32 v[212:213], v[212:213], v[58:59] op_sel:[0,1] op_sel_hi:[1,1]
    v_pk_mul_f32 v[214:215], v[214:215], v[58:59] op_sel:[0,1] op_sel_hi:[1,1]
    v_cvt_pk_bf16_f32 v198, v212, v213
    v_cvt_pk_bf16_f32 v199, v214, v215
    s_add_u32 s37, s55, 8192
    buffer_store_dwordx4 v[196:199], v252, s[28:31], s37 offen offset:1024
    v_mfma_f32_16x16x32_bf16 a[120:123], a[184:187], v[176:179], a[120:123]
    v_mfma_f32_16x16x32_bf16 a[120:123], a[188:191], v[180:183], a[120:123]
    buffer_load_dwordx4 v48, s[20:23], s49 offen offset:2048 lds
    v_mfma_f32_16x16x32_bf16 a[124:127], a[188:191], v[188:191], a[124:127]
    v_accvgpr_read_b32 v208, a88
    v_accvgpr_read_b32 v209, a89
    v_accvgpr_read_b32 v210, a90
    v_accvgpr_read_b32 v211, a91
    v_pk_mul_f32 v[208:209], v[208:209], v[60:61] op_sel:[0,0] op_sel_hi:[1,0]
    v_pk_mul_f32 v[210:211], v[210:211], v[60:61] op_sel:[0,0] op_sel_hi:[1,0]
    v_cvt_pk_bf16_f32 v202, v208, v209
    v_cvt_pk_bf16_f32 v203, v210, v211
    s_add_u32 s37, s55, 8192
    buffer_store_dwordx4 v[200:203], v252, s[28:31], s37 offen offset:2048
    v_mfma_f32_16x16x32_bf16 a[124:127], a[184:187], v[184:187], a[124:127]
    buffer_load_dwordx4 v49, s[20:23], s49 offen offset:3072 lds
    v_accvgpr_read_b32 v212, a92
    v_accvgpr_read_b32 v213, a93
    v_accvgpr_read_b32 v214, a94
    v_accvgpr_read_b32 v215, a95
    v_pk_mul_f32 v[212:213], v[212:213], v[60:61] op_sel:[0,1] op_sel_hi:[1,1]
    v_pk_mul_f32 v[214:215], v[214:215], v[60:61] op_sel:[0,1] op_sel_hi:[1,1]
    v_cvt_pk_bf16_f32 v206, v212, v213
    v_cvt_pk_bf16_f32 v207, v214, v215
    s_add_u32 s37, s55, 8192
    buffer_store_dwordx4 v[204:207], v252, s[28:31], s37 offen offset:3072
    v_or3_b32 v224, v224, v225, v226
    v_or_b32 v224, v224, v227
    s_nop 0
    v_readfirstlane_b32 s36, v224
    v_readfirstlane_b32 s38, v253
    v_min_u32 v8, 1, v1
    v_lshlrev_b32 v8, 31, v8
    v_mov_b32 v10, s95
    s_getreg_b32 s39, hwreg(HW_REG_XCC_ID, 0, 4)
    s_lshl_b32 s39, s39, 28
    s_xor_b32 s39, s39, s95
    s_cmp_eq_u32 s38, s39
    s_cselect_b32 s53, 1, 0
    ds_read_b64_tr_b16 a[208:209], v12 offset:0
    ds_read_b64_tr_b16 a[210:211], v12 offset:4096
    ds_read_b64_tr_b16 a[212:213], v12 offset:8192
    ds_read_b64_tr_b16 a[214:215], v12 offset:12288
    ds_read_b64_tr_b16 a[216:217], v12 offset:16384
    ds_read_b64_tr_b16 a[218:219], v12 offset:20480
    ds_read_b64_tr_b16 a[220:221], v12 offset:24576
    ds_read_b64_tr_b16 a[222:223], v12 offset:28672
    ds_read_b64_tr_b16 a[224:225], v16 offset:0
    ds_read_b64_tr_b16 a[226:227], v16 offset:4096
    ds_read_b64_tr_b16 a[228:229], v16 offset:8192
    ds_read_b64_tr_b16 a[230:231], v16 offset:12288
    ds_read_b64_tr_b16 a[232:233], v16 offset:16384
    ds_read_b64_tr_b16 a[234:235], v16 offset:20480
    ds_read_b64_tr_b16 a[236:237], v16 offset:24576
    ds_read_b64_tr_b16 a[238:239], v16 offset:28672
    s_andn2_b32 s36, s36, s48
    s_cbranch_scc1 Lattn_redo
    v_accvgpr_read_b32 v208, a96
    v_accvgpr_read_b32 v209, a97
    v_accvgpr_read_b32 v210, a98
    v_accvgpr_read_b32 v211, a99
    v_pk_mul_f32 v[208:209], v[208:209], v[58:59] op_sel:[0,0] op_sel_hi:[1,0]
Ltour0_8:
    s_cbranch_execz Ltour0_12
    v_pk_mul_f32 v[210:211], v[210:211], v[58:59] op_sel:[0,0] op_sel_hi:[1,0]
    v_cvt_pk_bf16_f32 v176, v208, v209
    v_cvt_pk_bf16_f32 v177, v210, v211
    v_accvgpr_read_b32 v212, a100
    v_accvgpr_read_b32 v213, a101
    v_accvgpr_read_b32 v214, a102
    v_accvgpr_read_b32 v215, a103
    v_pk_mul_f32 v[212:213], v[212:213], v[58:59] op_sel:[0,1] op_sel_hi:[1,1]
    v_pk_mul_f32 v[214:215], v[214:215], v[58:59] op_sel:[0,1] op_sel_hi:[1,1]
    v_cvt_pk_bf16_f32 v180, v212, v213
    v_cvt_pk_bf16_f32 v181, v214, v215
    v_accvgpr_read_b32 v208, a104
    v_accvgpr_read_b32 v209, a105
    v_accvgpr_read_b32 v210, a106
    v_accvgpr_read_b32 v211, a107
    v_pk_mul_f32 v[208:209], v[208:209], v[60:61] op_sel:[0,0] op_sel_hi:[1,0]
    v_pk_mul_f32 v[210:211], v[210:211], v[60:61] op_sel:[0,0] op_sel_hi:[1,0]
    v_cvt_pk_bf16_f32 v184, v208, v209
    v_cvt_pk_bf16_f32 v185, v210, v211
    v_accvgpr_read_b32 v212, a108
    v_accvgpr_read_b32 v213, a109
    v_accvgpr_read_b32 v214, a110
    v_accvgpr_read_b32 v215, a111
    v_pk_mul_f32 v[212:213], v[212:213], v[60:61] op_sel:[0,1] op_sel_hi:[1,1]
    v_pk_mul_f32 v[214:215], v[214:215], v[60:61] op_sel:[0,1] op_sel_hi:[1,1]
    v_cvt_pk_bf16_f32 v188, v212, v213
    v_cvt_pk_bf16_f32 v189, v214, v215
    v_accvgpr_read_b32 v208, a112
    v_accvgpr_read_b32 v209, a113
    v_accvgpr_read_b32 v210, a114
    v_accvgpr_read_b32 v211, a115
    v_pk_mul_f32 v[208:209], v[208:209], v[58:59] op_sel:[0,0] op_sel_hi:[1,0]
    v_pk_mul_f32 v[210:211], v[210:211], v[58:59] op_sel:[0,0] op_sel_hi:[1,0]
    v_cvt_pk_bf16_f32 v178, v208, v209
    v_cvt_pk_bf16_f32 v179, v210, v211
    s_add_u32 s37, s55, 12288
    buffer_store_dwordx4 v[176:179], v252, s[28:31], s37 offen offset:0
    v_accvgpr_read_b32 v212, a116
    v_accvgpr_read_b32 v213, a117
    v_accvgpr_read_b32 v214, a118
    v_accvgpr_read_b32 v215, a119
    v_pk_mul_f32 v[212:213], v[212:213], v[58:59] op_sel:[0,1] op_sel_hi:[1,1]
    v_pk_mul_f32 v[214:215], v[214:215], v[58:59] op_sel:[0,1] op_sel_hi:[1,1]
    v_cvt_pk_bf16_f32 v182, v212, v213
    v_cvt_pk_bf16_f32 v183, v214, v215
    s_add_u32 s37, s55, 12288
    buffer_store_dwordx4 v[180:183], v252, s[28:31], s37 offen offset:1024
    v_accvgpr_read_b32 v208, a120
    v_accvgpr_read_b32 v209, a121
    v_accvgpr_read_b32 v210, a122
    v_accvgpr_read_b32 v211, a123
    v_pk_mul_f32 v[208:209], v[208:209], v[60:61] op_sel:[0,0] op_sel_hi:[1,0]
    v_pk_mul_f32 v[210:211], v[210:211], v[60:61] op_sel:[0,0] op_sel_hi:[1,0]
    v_cvt_pk_bf16_f32 v186, v208, v209
    v_cvt_pk_bf16_f32 v187, v210, v211
    s_add_u32 s37, s55, 12288
    buffer_store_dwordx4 v[184:187], v252, s[28:31], s37 offen offset:2048
    v_accvgpr_read_b32 v212, a124
    v_accvgpr_read_b32 v213, a125
    v_accvgpr_read_b32 v214, a126
    v_accvgpr_read_b32 v215, a127
    v_pk_mul_f32 v[212:213], v[212:213], v[60:61] op_sel:[0,1] op_sel_hi:[1,1]
    v_pk_mul_f32 v[214:215], v[214:215], v[60:61] op_sel:[0,1] op_sel_hi:[1,1]
    v_cvt_pk_bf16_f32 v190, v212, v213
    v_cvt_pk_bf16_f32 v191, v214, v215
    s_add_u32 s37, s55, 12288
    buffer_store_dwordx4 v[188:191], v252, s[28:31], s37 offen offset:3072
    s_waitcnt lgkmcnt(14)
    v_mfma_f32_16x16x32_bf16 v[96:99], a[208:211], v[128:131], 0
    s_waitcnt lgkmcnt(12)
    ds_read_b64_tr_b16 a[160:161], v13 offset:0
    v_mfma_f32_16x16x32_bf16 v[96:99], a[212:215], v[144:147], v[96:99]
    s_waitcnt lgkmcnt(11)
    ds_read_b64_tr_b16 a[162:163], v13 offset:4096
    v_mfma_f32_16x16x32_bf16 v[96:99], a[216:219], v[192:195], v[96:99]
    s_waitcnt lgkmcnt(10)
    ds_read_b64_tr_b16 a[164:165], v13 offset:8192
    v_mfma_f32_16x16x32_bf16 v[96:99], a[220:223], v[176:179], v[96:99]
    s_waitcnt lgkmcnt(9)
    ds_read_b64_tr_b16 a[166:167], v13 offset:12288
    v_mfma_f32_16x16x32_bf16 v[96:99], a[224:227], v[136:139], v[96:99]
    s_waitcnt lgkmcnt(8)
    ds_read_b64_tr_b16 a[168:169], v13 offset:16384
    v_mfma_f32_16x16x32_bf16 v[96:99], a[228:231], v[152:155], v[96:99]
    s_waitcnt lgkmcnt(7)
    ds_read_b64_tr_b16 a[170:171], v13 offset:20480
    v_mfma_f32_16x16x32_bf16 v[96:99], a[232:235], v[200:203], v[96:99]
    s_waitcnt lgkmcnt(6)
    ds_read_b64_tr_b16 a[172:173], v13 offset:24576
    v_mfma_f32_16x16x32_bf16 v[96:99], a[236:239], v[184:187], v[96:99]
    ds_read_b64_tr_b16 a[174:175], v13 offset:28672
    v_mfma_f32_16x16x32_bf16 v[100:103], a[236:239], v[188:191], 0
    ds_read_b64_tr_b16 a[176:177], v17 offset:0
    v_mfma_f32_16x16x32_bf16 v[100:103], a[232:235], v[204:207], v[100:103]
    ds_read_b64_tr_b16 a[178:179], v17 offset:4096
    v_mfma_f32_16x16x32_bf16 v[100:103], a[228:231], v[156:159], v[100:103]
    ds_read_b64_tr_b16 a[180:181], v17 offset:8192
    v_mfma_f32_16x16x32_bf16 v[100:103], a[224:227], v[140:143], v[100:103]
    ds_read_b64_tr_b16 a[182:183], v17 offset:12288
    v_mfma_f32_16x16x32_bf16 v[100:103], a[220:223], v[180:183], v[100:103]
    ds_read_b64_tr_b16 a[184:185], v17 offset:16384
    v_cvt_pk_bf16_f32 v224, v96, v97
    v_mfma_f32_16x16x32_bf16 v[100:103], a[216:219], v[196:199], v[100:103]
    ds_read_b64_tr_b16 a[186:187], v17 offset:20480
    v_cvt_pk_bf16_f32 v225, v98, v99
    v_mfma_f32_16x16x32_bf16 v[100:103], a[212:215], v[148:151], v[100:103]
    ds_read_b64_tr_b16 a[188:189], v17 offset:24576
    v_mfma_f32_16x16x32_bf16 v[100:103], a[208:211], v[132:135], v[100:103]
    s_waitcnt lgkmcnt(13)
    ds_read_b64_tr_b16 a[190:191], v17 offset:28672
    v_mfma_f32_16x16x32_bf16 v[104:107], a[160:163], v[128:131], 0
    s_waitcnt lgkmcnt(12)
    ds_read_b64_tr_b16 a[208:209], v14 offset:0
    v_mfma_f32_16x16x32_bf16 v[104:107], a[164:167], v[144:147], v[104:107]
    s_waitcnt lgkmcnt(11)
    ds_read_b64_tr_b16 a[210:211], v14 offset:4096
    v_mfma_f32_16x16x32_bf16 v[104:107], a[168:171], v[192:195], v[104:107]
    s_waitcnt lgkmcnt(10)
    ds_read_b64_tr_b16 a[212:213], v14 offset:8192
    v_mfma_f32_16x16x32_bf16 v[104:107], a[172:175], v[176:179], v[104:107]
    s_waitcnt lgkmcnt(9)
    ds_read_b64_tr_b16 a[214:215], v14 offset:12288
    v_mfma_f32_16x16x32_bf16 v[104:107], a[176:179], v[136:139], v[104:107]
    s_waitcnt lgkmcnt(8)
    ds_read_b64_tr_b16 a[216:217], v14 offset:16384
    v_cvt_pk_bf16_f32 v228, v100, v101
    v_mfma_f32_16x16x32_bf16 v[104:107], a[180:183], v[152:155], v[104:107]
    s_waitcnt lgkmcnt(7)
    ds_read_b64_tr_b16 a[218:219], v14 offset:20480
    v_cvt_pk_bf16_f32 v229, v102, v103
    v_mfma_f32_16x16x32_bf16 v[104:107], a[184:187], v[200:203], v[104:107]
    s_waitcnt lgkmcnt(6)
    ds_read_b64_tr_b16 a[220:221], v14 offset:24576
    v_mfma_f32_16x16x32_bf16 v[104:107], a[188:191], v[184:187], v[104:107]
    ds_read_b64_tr_b16 a[222:223], v14 offset:28672
    s_waitcnt vmcnt(0)
    s_cmp_eq_u32 s53, 0
    s_cbranch_scc1 Lattn_wb
Lattn_wbdone:
    v_mfma_f32_16x16x32_bf16 v[108:111], a[188:191], v[188:191], 0
    buffer_store_dword v10, v8, s[24:27], s92 offen offset:8 sc1
    v_mfma_f32_16x16x32_bf16 v[108:111], a[184:187], v[204:207], v[108:111]
    s_xor_b32 s55, s55, 65536
    ds_read_b64_tr_b16 a[224:225], v18 offset:0
    ds_read_b64_tr_b16 a[226:227], v18 offset:4096
    v_mfma_f32_16x16x32_bf16 v[108:111], a[180:183], v[156:159], v[108:111]
    buffer_atomic_add v241, v240, s[88:91], 0 offen sc1
    v_mfma_f32_16x16x32_bf16 v[108:111], a[176:179], v[140:143], v[108:111]
    ds_read_b64_tr_b16 a[228:229], v18 offset:8192
    ds_read_b64_tr_b16 a[230:231], v18 offset:12288
    s_load_dwordx2 s[12:13], s[0:1], 0
    v_mfma_f32_16x16x32_bf16 v[108:111], a[172:175], v[180:183], v[108:111]
    ds_read_b64_tr_b16 a[232:233], v18 offset:16384
    v_cvt_pk_bf16_f32 v226, v104, v105
    v_mfma_f32_16x16x32_bf16 v[108:111], a[168:171], v[196:199], v[108:111]
    s_add_u32 s38, s56, 16384
    ds_read_b64_tr_b16 a[234:235], v18 offset:20480
    v_cvt_pk_bf16_f32 v227, v106, v107
    s_load_dwordx2 s[16:17], s[0:1], 96
    v_mfma_f32_16x16x32_bf16 v[108:111], a[164:167], v[148:151], v[108:111]
    buffer_store_dwordx4 v[224:227], v56, s[28:31], s38 offen sc1
    v_mfma_f32_16x16x32_bf16 v[108:111], a[160:163], v[132:135], v[108:111]
    s_waitcnt lgkmcnt(12)
    ds_read_b64_tr_b16 a[236:237], v18 offset:24576
    ds_read_b64_tr_b16 a[238:239], v18 offset:28672
    s_load_dwordx2 s[52:53], s[0:1], 48
    v_mfma_f32_16x16x32_bf16 v[112:115], a[208:211], v[128:131], 0
    s_waitcnt lgkmcnt(12)
    ds_read_b64_tr_b16 a[160:161], v15 offset:0
    v_mfma_f32_16x16x32_bf16 v[112:115], a[212:215], v[144:147], v[112:115]
    s_waitcnt lgkmcnt(11)
    ds_read_b64_tr_b16 a[162:163], v15 offset:4096
    v_mfma_f32_16x16x32_bf16 v[112:115], a[216:219], v[192:195], v[112:115]
    s_waitcnt lgkmcnt(10)
    ds_read_b64_tr_b16 a[164:165], v15 offset:8192
    v_mfma_f32_16x16x32_bf16 v[112:115], a[220:223], v[176:179], v[112:115]
    s_waitcnt lgkmcnt(9)
    ds_read_b64_tr_b16 a[166:167], v15 offset:12288
    v_mfma_f32_16x16x32_bf16 v[112:115], a[224:227], v[136:139], v[112:115]
    s_waitcnt lgkmcnt(8)
    ds_read_b64_tr_b16 a[168:169], v15 offset:16384
    v_cvt_pk_bf16_f32 v230, v108, v109
    v_mfma_f32_16x16x32_bf16 v[112:115], a[228:231], v[152:155], v[112:115]
    s_waitcnt lgkmcnt(7)
    s_add_u32 s38, s56, 181248
    ds_read_b64_tr_b16 a[170:171], v15 offset:20480
    v_cvt_pk_bf16_f32 v231, v110, v111
    v_mfma_f32_16x16x32_bf16 v[112:115], a[232:235], v[200:203], v[112:115]
    s_waitcnt lgkmcnt(6)
    buffer_store_dwordx4 v[228:231], v56, s[28:31], s38 offen sc1
    v_mfma_f32_16x16x32_bf16 v[112:115], a[236:239], v[184:187], v[112:115]
    ds_read_b64_tr_b16 a[172:173], v15 offset:24576
    ds_read_b64_tr_b16 a[174:175], v15 offset:28672
    v_mfma_f32_16x16x32_bf16 v[116:119], a[236:239], v[188:191], 0
    ds_read_b64_tr_b16 a[176:177], v19 offset:0
    v_mfma_f32_16x16x32_bf16 v[116:119], a[232:235], v[204:207], v[116:119]
    ds_read_b64_tr_b16 a[178:179], v19 offset:4096
    v_mfma_f32_16x16x32_bf16 v[116:119], a[228:231], v[156:159], v[116:119]
    ds_read_b64_tr_b16 a[180:181], v19 offset:8192
    v_mfma_f32_16x16x32_bf16 v[116:119], a[224:227], v[140:143], v[116:119]
    ds_read_b64_tr_b16 a[182:183], v19 offset:12288
    v_mfma_f32_16x16x32_bf16 v[116:119], a[220:223], v[180:183], v[116:119]
    ds_read_b64_tr_b16 a[184:185], v19 offset:16384
    v_cvt_pk_bf16_f32 v232, v112, v113
    v_mfma_f32_16x16x32_bf16 v[116:119], a[216:219], v[196:199], v[116:119]
    ds_read_b64_tr_b16 a[186:187], v19 offset:20480
    v_cvt_pk_bf16_f32 v233, v114, v115
    v_mfma_f32_16x16x32_bf16 v[116:119], a[212:215], v[148:151], v[116:119]
    ds_read_b64_tr_b16 a[188:189], v19 offset:24576
    v_mfma_f32_16x16x32_bf16 v[116:119], a[208:211], v[132:135], v[116:119]
    s_waitcnt lgkmcnt(13)
    ds_read_b64_tr_b16 a[190:191], v19 offset:28672
    s_barrier
    v_mfma_f32_16x16x32_bf16 v[120:123], a[160:163], v[128:131], 0
    s_waitcnt lgkmcnt(12)
    buffer_load_dword v11, v8, s[24:27], s54 offen offset:8 sc1
    v_mfma_f32_16x16x32_bf16 v[120:123], a[164:167], v[144:147], v[120:123]
    s_waitcnt lgkmcnt(10)
    ds_read_b64_tr_b16 a[208:209], v20 offset:0
    ds_read_b64_tr_b16 a[210:211], v20 offset:4096
    v_mfma_f32_16x16x32_bf16 v[120:123], a[168:171], v[192:195], v[120:123]
    s_waitcnt lgkmcnt(10)
    ds_read_b64_tr_b16 a[212:213], v20 offset:8192
    v_mfma_f32_16x16x32_bf16 v[120:123], a[172:175], v[176:179], v[120:123]
    s_waitcnt lgkmcnt(9)
    ds_read_b64_tr_b16 a[214:215], v20 offset:12288
    v_mfma_f32_16x16x32_bf16 v[120:123], a[176:179], v[136:139], v[120:123]
    s_waitcnt lgkmcnt(8)
    ds_read_b64_tr_b16 a[216:217], v20 offset:16384
    v_cvt_pk_bf16_f32 v236, v116, v117
    v_mfma_f32_16x16x32_bf16 v[120:123], a[180:183], v[152:155], v[120:123]
    s_waitcnt lgkmcnt(7)
    ds_read_b64_tr_b16 a[218:219], v20 offset:20480
    v_cvt_pk_bf16_f32 v237, v118, v119
    v_mfma_f32_16x16x32_bf16 v[120:123], a[184:187], v[200:203], v[120:123]
    s_waitcnt lgkmcnt(6)
    s_add_u32 s49, s46, 73728
    ds_read_b64_tr_b16 a[220:221], v20 offset:24576
    v_mfma_f32_16x16x32_bf16 v[120:123], a[188:191], v[184:187], v[120:123]
    s_add_u32 m0, s42, 114688
    ds_read_b64_tr_b16 a[222:223], v20 offset:28672
    v_mfma_f32_16x16x32_bf16 v[124:127], a[188:191], v[188:191], 0
    buffer_load_dwordx4 v46, s[20:23], s49 offen lds
    v_mfma_f32_16x16x32_bf16 v[124:127], a[184:187], v[204:207], v[124:127]
    ds_read_b64_tr_b16 a[224:225], v24 offset:0
    ds_read_b64_tr_b16 a[226:227], v24 offset:4096
    v_mfma_f32_16x16x32_bf16 v[124:127], a[180:183], v[156:159], v[124:127]
    buffer_load_dwordx4 v47, s[20:23], s49 offen offset:1024 lds
    v_mfma_f32_16x16x32_bf16 v[124:127], a[176:179], v[140:143], v[124:127]
    ds_read_b64_tr_b16 a[228:229], v24 offset:8192
    ds_read_b64_tr_b16 a[230:231], v24 offset:12288
    v_mfma_f32_16x16x32_bf16 v[124:127], a[172:175], v[180:183], v[124:127]
    ds_read_b64_tr_b16 a[232:233], v24 offset:16384
    v_cvt_pk_bf16_f32 v234, v120, v121
    v_mfma_f32_16x16x32_bf16 v[124:127], a[168:171], v[196:199], v[124:127]
    s_add_u32 s38, s56, 16512
    ds_read_b64_tr_b16 a[234:235], v24 offset:20480
    v_cvt_pk_bf16_f32 v235, v122, v123
    v_mfma_f32_16x16x32_bf16 v[124:127], a[164:167], v[148:151], v[124:127]
    buffer_store_dwordx4 v[232:235], v56, s[28:31], s38 offen sc1
    v_mfma_f32_16x16x32_bf16 v[124:127], a[160:163], v[132:135], v[124:127]
    s_waitcnt lgkmcnt(12)
    ds_read_b64_tr_b16 a[236:237], v24 offset:24576
    ds_read_b64_tr_b16 a[238:239], v24 offset:28672
    v_mfma_f32_16x16x32_bf16 v[64:67], a[208:211], v[128:131], 0
    s_waitcnt lgkmcnt(12)
    buffer_load_dwordx4 v48, s[20:23], s49 offen offset:2048 lds
    v_mfma_f32_16x16x32_bf16 v[64:67], a[212:215], v[144:147], v[64:67]
    s_waitcnt lgkmcnt(10)
    ds_read_b64_tr_b16 a[160:161], v21 offset:0
    ds_read_b64_tr_b16 a[162:163], v21 offset:4096
    v_mfma_f32_16x16x32_bf16 v[64:67], a[216:219], v[192:195], v[64:67]
    s_waitcnt lgkmcnt(10)
    buffer_load_dwordx4 v49, s[20:23], s49 offen offset:3072 lds
    v_mfma_f32_16x16x32_bf16 v[64:67], a[220:223], v[176:179], v[64:67]
    s_waitcnt lgkmcnt(8)
    ds_read_b64_tr_b16 a[164:165], v21 offset:8192
    ds_read_b64_tr_b16 a[166:167], v21 offset:12288
    v_mfma_f32_16x16x32_bf16 v[64:67], a[224:227], v[136:139], v[64:67]
    s_waitcnt lgkmcnt(8)
    ds_read_b64_tr_b16 a[168:169], v21 offset:16384
    v_cvt_pk_bf16_f32 v238, v124, v125
    v_mfma_f32_16x16x32_bf16 v[64:67], a[228:231], v[152:155], v[64:67]
    s_waitcnt lgkmcnt(7)
    s_add_u32 s38, s56, 181376
    ds_read_b64_tr_b16 a[170:171], v21 offset:20480
    v_cvt_pk_bf16_f32 v239, v126, v127
    v_mfma_f32_16x16x32_bf16 v[64:67], a[232:235], v[200:203], v[64:67]
    s_waitcnt lgkmcnt(6)
    buffer_store_dwordx4 v[236:239], v56, s[28:31], s38 offen sc1
    v_mfma_f32_16x16x32_bf16 v[64:67], a[236:239], v[184:187], v[64:67]
    ds_read_b64_tr_b16 a[172:173], v21 offset:24576
    ds_read_b64_tr_b16 a[174:175], v21 offset:28672
    v_mfma_f32_16x16x32_bf16 v[68:71], a[236:239], v[188:191], 0
    s_lshl_b32 s40, s5, 4
    ds_read_b64_tr_b16 a[176:177], v25 offset:0
    v_mfma_f32_16x16x32_bf16 v[68:71], a[232:235], v[204:207], v[68:71]
    s_add_u32 s40, s40, s4
    ds_read_b64_tr_b16 a[178:179], v25 offset:4096
    v_and_b32 v240, 31, v1
    v_mfma_f32_16x16x32_bf16 v[68:71], a[228:231], v[156:159], v[68:71]
    ds_read_b64_tr_b16 a[180:181], v25 offset:8192
    v_lshrrev_b32 v241, 5, v1
    v_mfma_f32_16x16x32_bf16 v[68:71], a[224:227], v[140:143], v[68:71]
    ds_read_b64_tr_b16 a[182:183], v25 offset:12288
    v_cmp_gt_u32 vcc, 8, v240
    v_mfma_f32_16x16x32_bf16 v[68:71], a[220:223], v[180:183], v[68:71]
    ds_read_b64_tr_b16 a[184:185], v25 offset:16384
    v_mov_b32 v242, 2147483648
    v_mfma_f32_16x16x32_bf16 v[68:71], a[216:219], v[196:199], v[68:71]
    s_lshl_b32 s43, s40, 3
    ds_read_b64_tr_b16 a[186:187], v25 offset:20480
    v_mfma_f32_16x16x32_bf16 v[68:71], a[212:215], v[148:151], v[68:71]
    s_lshl_b32 s44, s3, 1
    ds_read_b64_tr_b16 a[188:189], v25 offset:24576
    v_mfma_f32_16x16x32_bf16 v[68:71], a[208:211], v[132:135], v[68:71]
    s_waitcnt lgkmcnt(13)
    s_add_u32 s43, s43, s44
    ds_read_b64_tr_b16 a[190:191], v25 offset:28672
    v_cndmask_b32 v242, v242, 0, vcc
    v_mfma_f32_16x16x32_bf16 v[72:75], a[160:163], v[128:131], 0
    s_waitcnt lgkmcnt(12)
    ds_read_b64_tr_b16 a[208:209], v22 offset:0
    v_add_u32 v7, s43, v241
    v_mfma_f32_16x16x32_bf16 v[72:75], a[164:167], v[144:147], v[72:75]
    s_waitcnt lgkmcnt(11)
    ds_read_b64_tr_b16 a[210:211], v22 offset:4096
    v_lshlrev_b32 v5, 4, v240
    v_mfma_f32_16x16x32_bf16 v[72:75], a[168:171], v[192:195], v[72:75]
    s_waitcnt lgkmcnt(10)
    ds_read_b64_tr_b16 a[212:213], v22 offset:8192
    v_lshlrev_b32 v243, 4, v241
    v_mfma_f32_16x16x32_bf16 v[72:75], a[172:175], v[176:179], v[72:75]
    s_waitcnt lgkmcnt(9)
    ds_read_b64_tr_b16 a[214:215], v22 offset:12288
    v_lshl_add_u32 v2, v240, 5, v243
    v_mfma_f32_16x16x32_bf16 v[72:75], a[176:179], v[136:139], v[72:75]
    s_waitcnt lgkmcnt(8)
    ds_read_b64_tr_b16 a[216:217], v22 offset:16384
    v_lshrrev_b32 v243, 4, v240
    v_mfma_f32_16x16x32_bf16 v[72:75], a[180:183], v[152:155], v[72:75]
    s_waitcnt lgkmcnt(7)
    ds_read_b64_tr_b16 a[218:219], v22 offset:20480
    v_mul_u32_u24 v243, 1536, v243
    v_mfma_f32_16x16x32_bf16 v[72:75], a[184:187], v[200:203], v[72:75]
    s_waitcnt lgkmcnt(6)
    ds_read_b64_tr_b16 a[220:221], v22 offset:24576
    v_add_u32 v2, v2, v243
    v_mfma_f32_16x16x32_bf16 v[72:75], a[188:191], v[184:187], v[72:75]
    s_mul_i32 s44, s43, 10304
    ds_read_b64_tr_b16 a[222:223], v22 offset:28672
    v_lshrrev_b32 v243, 2, v240
    v_mfma_f32_16x16x32_bf16 v[76:79], a[188:191], v[188:191], 0
    ds_read_b64_tr_b16 a[224:225], v26 offset:0
    v_lshlrev_b32 v243, 6, v243
    v_mfma_f32_16x16x32_bf16 v[76:79], a[184:187], v[204:207], v[76:79]
    ds_read_b64_tr_b16 a[226:227], v26 offset:4096
    v_and_b32 v241, 3, v240
    v_mfma_f32_16x16x32_bf16 v[76:79], a[180:183], v[156:159], v[76:79]
    ds_read_b64_tr_b16 a[228:229], v26 offset:8192
    v_lshl_add_u32 v3, v241, 3, v243
    v_mfma_f32_16x16x32_bf16 v[76:79], a[176:179], v[140:143], v[76:79]
    ds_read_b64_tr_b16 a[230:231], v26 offset:12288
    v_mul_u32_u24 v243, 1152, v7
    v_mfma_f32_16x16x32_bf16 v[76:79], a[172:175], v[180:183], v[76:79]
    ds_read_b64_tr_b16 a[232:233], v26 offset:16384
    v_add_u32 v4, v243, v3
    v_mfma_f32_16x16x32_bf16 v[76:79], a[168:171], v[196:199], v[76:79]
    ds_read_b64_tr_b16 a[234:235], v26 offset:20480
    v_lshl_add_u32 v6, v243, 1, v5
    v_mfma_f32_16x16x32_bf16 v[76:79], a[164:167], v[148:151], v[76:79]
    ds_read_b64_tr_b16 a[236:237], v26 offset:24576
    v_or_b32 v55, v3, v242
    v_mfma_f32_16x16x32_bf16 v[76:79], a[160:163], v[132:135], v[76:79]
    s_waitcnt lgkmcnt(13)
    ds_read_b64_tr_b16 a[238:239], v26 offset:28672
    v_or_b32 v58, v4, v242
    v_mfma_f32_16x16x32_bf16 v[80:83], a[208:211], v[128:131], 0
    s_waitcnt lgkmcnt(12)
    ds_read_b64_tr_b16 a[160:161], v23 offset:0
    v_or_b32 v59, v5, v242
    v_mfma_f32_16x16x32_bf16 v[80:83], a[212:215], v[144:147], v[80:83]
    s_waitcnt lgkmcnt(11)
    ds_read_b64_tr_b16 a[162:163], v23 offset:4096
    v_or_b32 v60, v6, v242
    v_mfma_f32_16x16x32_bf16 v[80:83], a[216:219], v[192:195], v[80:83]
    s_waitcnt lgkmcnt(10)
    ds_read_b64_tr_b16 a[164:165], v23 offset:8192
    s_waitcnt vmcnt(6)
    v_readfirstlane_b32 s36, v11
    v_mfma_f32_16x16x32_bf16 v[80:83], a[220:223], v[176:179], v[80:83]
    s_waitcnt lgkmcnt(9)
    ds_read_b64_tr_b16 a[166:167], v23 offset:12288
    v_lshrrev_b32 v243, 4, v1
    v_mfma_f32_16x16x32_bf16 v[80:83], a[224:227], v[136:139], v[80:83]
    ds_read_b64_tr_b16 a[168:169], v23 offset:16384
    v_lshlrev_b32 v243, 8, v243
    s_cmp_lg_u32 s36, s95
    s_cbranch_scc1 Lattn_xspin
Lattn_xgot:
    s_waitcnt lgkmcnt(9)
    v_mfma_f32_16x16x32_bf16 v[80:83], a[228:231], v[152:155], v[80:83]
    s_waitcnt lgkmcnt(7)
    ds_read_b64_tr_b16 a[170:171], v23 offset:20480
    v_and_b32 v241, 7, v1
    v_mfma_f32_16x16x32_bf16 v[80:83], a[232:235], v[200:203], v[80:83]
    s_waitcnt lgkmcnt(6)
    ds_read_b64_tr_b16 a[172:173], v23 offset:24576
    v_lshl_add_u32 v243, v241, 5, v243
    v_mfma_f32_16x16x32_bf16 v[80:83], a[236:239], v[184:187], v[80:83]
    s_add_u32 s37, s55, 0
    ds_read_b64_tr_b16 a[174:175], v23 offset:28672
    v_and_b32 v241, 8, v1
    v_mfma_f32_16x16x32_bf16 v[84:87], a[236:239], v[188:191], 0
    buffer_load_dwordx4 a[64:67], v252, s[28:31], s37 offen offset:0 sc1
    v_mfma_f32_16x16x32_bf16 v[84:87], a[232:235], v[204:207], v[84:87]
    ds_read_b64_tr_b16 a[176:177], v27 offset:0
    ds_read_b64_tr_b16 a[178:179], v27 offset:4096
    v_mfma_f32_16x16x32_bf16 v[84:87], a[228:231], v[156:159], v[84:87]
    buffer_load_dwordx4 a[96:99], v252, s[28:31], s37 offen offset:1024 sc1
    v_mfma_f32_16x16x32_bf16 v[84:87], a[224:227], v[140:143], v[84:87]
    ds_read_b64_tr_b16 a[180:181], v27 offset:8192
    ds_read_b64_tr_b16 a[182:183], v27 offset:12288
    v_mfma_f32_16x16x32_bf16 v[84:87], a[220:223], v[180:183], v[84:87]
    ds_read_b64_tr_b16 a[184:185], v27 offset:16384
    v_lshl_add_u32 v54, v241, 1, v243
    v_mfma_f32_16x16x32_bf16 v[84:87], a[216:219], v[196:199], v[84:87]
    s_lshr_b32 s41, s2, 3
    ds_read_b64_tr_b16 a[186:187], v27 offset:20480
    v_mfma_f32_16x16x32_bf16 v[84:87], a[212:215], v[148:151], v[84:87]
    buffer_load_dwordx4 a[80:83], v252, s[28:31], s37 offen offset:2048 sc1
    v_mfma_f32_16x16x32_bf16 v[84:87], a[208:211], v[132:135], v[84:87]
    s_waitcnt lgkmcnt(12)
    s_mov_b32 s14, 2359296
    ds_read_b64_tr_b16 a[188:189], v27 offset:24576
    ds_read_b64_tr_b16 a[190:191], v27 offset:28672
    s_barrier
    v_mfma_f32_16x16x32_bf16 v[88:91], a[160:163], v[128:131], 0
    s_waitcnt lgkmcnt(12)
    s_mov_b32 s15, 0x20000
    ds_read_b64_tr_b16 a[208:209], v12 offset:32768
    v_mfma_f32_16x16x32_bf16 v[88:91], a[164:167], v[144:147], v[88:91]
    s_waitcnt lgkmcnt(11)
    s_mov_b32 s18, 2359296
    ds_read_b64_tr_b16 a[210:211], v12 offset:36864
    v_mfma_f32_16x16x32_bf16 v[88:91], a[168:171], v[192:195], v[88:91]
    s_waitcnt lgkmcnt(10)
    buffer_load_dwordx4 a[112:115], v252, s[28:31], s37 offen offset:3072 sc1
    v_mfma_f32_16x16x32_bf16 v[88:91], a[172:175], v[176:179], v[88:91]
    s_waitcnt lgkmcnt(8)
    s_mov_b32 s19, 0x20000
    ds_read_b64_tr_b16 a[212:213], v12 offset:40960
    ds_read_b64_tr_b16 a[214:215], v12 offset:45056
    v_mfma_f32_16x16x32_bf16 v[88:91], a[176:179], v[136:139], v[88:91]
    s_waitcnt lgkmcnt(8)
    s_add_u32 s8, s50, 7864320
    s_addc_u32 s9, s51, 0
    ds_read_b64_tr_b16 a[216:217], v12 offset:49152
    v_mfma_f32_16x16x32_bf16 v[88:91], a[180:183], v[152:155], v[88:91]
    s_waitcnt lgkmcnt(7)
    s_add_u32 s37, s55, 4096
    ds_read_b64_tr_b16 a[218:219], v12 offset:53248
    v_mfma_f32_16x16x32_bf16 v[88:91], a[184:187], v[200:203], v[88:91]
    s_waitcnt lgkmcnt(6)
    s_add_u32 s49, s46, 256
    buffer_load_dwordx4 a[68:71], v252, s[28:31], s37 offen offset:0 sc1
    v_mfma_f32_16x16x32_bf16 v[88:91], a[188:191], v[184:187], v[88:91]
    s_add_u32 m0, s42, 0
    ds_read_b64_tr_b16 a[220:221], v12 offset:57344
    ds_read_b64_tr_b16 a[222:223], v12 offset:61440
    v_mfma_f32_16x16x32_bf16 v[92:95], a[188:191], v[188:191], 0
    buffer_load_dwordx4 v46, s[20:23], s49 offen lds
    v_mfma_f32_16x16x32_bf16 v[92:95], a[184:187], v[204:207], v[92:95]
    s_mov_b32 s10, 663552
    ds_read_b64_tr_b16 a[224:225], v16 offset:32768
    ds_read_b64_tr_b16 a[226:227], v16 offset:36864
    v_mfma_f32_16x16x32_bf16 v[92:95], a[180:183], v[156:159], v[92:95]
    buffer_load_dwordx4 v47, s[20:23], s49 offen offset:1024 lds
    v_mfma_f32_16x16x32_bf16 v[92:95], a[176:179], v[140:143], v[92:95]
    s_mov_b32 s11, 0x20000
    ds_read_b64_tr_b16 a[228:229], v16 offset:40960
    ds_read_b64_tr_b16 a[230:231], v16 offset:45056
    v_mfma_f32_16x16x32_bf16 v[92:95], a[172:175], v[180:183], v[92:95]
    buffer_load_dwordx4 a[100:103], v252, s[28:31], s37 offen offset:1024 sc1
    v_mfma_f32_16x16x32_bf16 v[92:95], a[168:171], v[196:199], v[92:95]
    s_lshl_b32 s39, s5, 13
    ds_read_b64_tr_b16 a[232:233], v16 offset:49152
    ds_read_b64_tr_b16 a[234:235], v16 offset:53248
    v_mfma_f32_16x16x32_bf16 v[92:95], a[164:167], v[148:151], v[92:95]
    s_add_u32 s39, s39, 8781824
    ds_read_b64_tr_b16 a[236:237], v16 offset:57344
    v_mfma_f32_16x16x32_bf16 v[92:95], a[160:163], v[132:135], v[92:95]
    s_waitcnt lgkmcnt(13)
    s_lshr_b32 s45, s4, 2
    ds_read_b64_tr_b16 a[238:239], v16 offset:61440
    v_mfma_f32_16x16x32_bf16 v[96:99], a[208:211], v[128:131], 0
    s_waitcnt lgkmcnt(12)
    buffer_load_dwordx4 v48, s[20:23], s49 offen offset:2048 lds
    v_mfma_f32_16x16x32_bf16 v[96:99], a[212:215], v[144:147], v[96:99]
    s_waitcnt lgkmcnt(10)
    s_lshl_b32 s45, s45, 11
    ds_read_b64_tr_b16 a[160:161], v13 offset:32768
    ds_read_b64_tr_b16 a[162:163], v13 offset:36864
    v_mfma_f32_16x16x32_bf16 v[96:99], a[216:219], v[192:195], v[96:99]
    s_waitcnt lgkmcnt(10)
    buffer_load_dwordx4 v49, s[20:23], s49 offen offset:3072 lds
    v_mfma_f32_16x16x32_bf16 v[96:99], a[220:223], v[176:179], v[96:99]
    s_waitcnt lgkmcnt(8)
    s_add_u32 s39, s39, s45
    ds_read_b64_tr_b16 a[164:165], v13 offset:40960
    ds_read_b64_tr_b16 a[166:167], v13 offset:45056
    v_mfma_f32_16x16x32_bf16 v[96:99], a[224:227], v[136:139], v[96:99]
    s_waitcnt lgkmcnt(8)
    buffer_load_dwordx4 a[84:87], v252, s[28:31], s37 offen offset:2048 sc1
    v_mfma_f32_16x16x32_bf16 v[96:99], a[228:231], v[152:155], v[96:99]
    s_waitcnt lgkmcnt(6)
    ds_read_b64_tr_b16 a[168:169], v13 offset:49152
    ds_read_b64_tr_b16 a[170:171], v13 offset:53248
    v_mfma_f32_16x16x32_bf16 v[96:99], a[232:235], v[200:203], v[96:99]
    s_waitcnt lgkmcnt(6)
    s_add_u32 s49, s46, 73984
    ds_read_b64_tr_b16 a[172:173], v13 offset:57344
    v_and_b32 v9, 15, v1
    v_mfma_f32_16x16x32_bf16 v[96:99], a[236:239], v[184:187], v[96:99]
    s_add_u32 m0, s42, 16384
    ds_read_b64_tr_b16 a[174:175], v13 offset:61440
    v_lshlrev_b32 v9, 7, v9
    v_mfma_f32_16x16x32_bf16 v[100:103], a[236:239], v[188:191], 0
    buffer_load_dwordx4 v46, s[20:23], s49 offen lds
    v_mfma_f32_16x16x32_bf16 v[100:103], a[232:235], v[204:207], v[100:103]
    ds_read_b64_tr_b16 a[176:177], v17 offset:32768
    ds_read_b64_tr_b16 a[178:179], v17 offset:36864
    v_mfma_f32_16x16x32_bf16 v[100:103], a[228:231], v[156:159], v[100:103]
    buffer_load_dwordx4 v47, s[20:23], s49 offen offset:1024 lds
    v_mfma_f32_16x16x32_bf16 v[100:103], a[224:227], v[140:143], v[100:103]
    ds_read_b64_tr_b16 a[180:181], v17 offset:40960
    ds_read_b64_tr_b16 a[182:183], v17 offset:45056
    v_mfma_f32_16x16x32_bf16 v[100:103], a[220:223], v[180:183], v[100:103]
    buffer_load_dwordx4 a[116:119], v252, s[28:31], s37 offen offset:3072 sc1
    v_mfma_f32_16x16x32_bf16 v[100:103], a[216:219], v[196:199], v[100:103]
    ds_read_b64_tr_b16 a[184:185], v17 offset:49152
    ds_read_b64_tr_b16 a[186:187], v17 offset:53248
    v_mfma_f32_16x16x32_bf16 v[100:103], a[212:215], v[148:151], v[100:103]
    ds_read_b64_tr_b16 a[188:189], v17 offset:57344
    v_mfma_f32_16x16x32_bf16 v[100:103], a[208:211], v[132:135], v[100:103]
    s_waitcnt lgkmcnt(13)
    ds_read_b64_tr_b16 a[190:191], v17 offset:61440
    v_mfma_f32_16x16x32_bf16 v[104:107], a[160:163], v[128:131], 0
    s_waitcnt lgkmcnt(12)
    buffer_load_dwordx4 v48, s[20:23], s49 offen offset:2048 lds
    v_mfma_f32_16x16x32_bf16 v[104:107], a[164:167], v[144:147], v[104:107]
    s_waitcnt lgkmcnt(10)
    ds_read_b64_tr_b16 a[208:209], v14 offset:32768
    ds_read_b64_tr_b16 a[210:211], v14 offset:36864
    v_mfma_f32_16x16x32_bf16 v[104:107], a[168:171], v[192:195], v[104:107]
    s_waitcnt lgkmcnt(10)
    buffer_load_dwordx4 v49, s[20:23], s49 offen offset:3072 lds
    v_mfma_f32_16x16x32_bf16 v[104:107], a[172:175], v[176:179], v[104:107]
    s_waitcnt lgkmcnt(8)
    s_add_u32 s37, s55, 8192
    ds_read_b64_tr_b16 a[212:213], v14 offset:40960
    ds_read_b64_tr_b16 a[214:215], v14 offset:45056
    v_mfma_f32_16x16x32_bf16 v[104:107], a[176:179], v[136:139], v[104:107]
    s_waitcnt lgkmcnt(8)
    buffer_load_dwordx4 a[72:75], v252, s[28:31], s37 offen offset:0 sc1
    v_mfma_f32_16x16x32_bf16 v[104:107], a[180:183], v[152:155], v[104:107]
    s_waitcnt lgkmcnt(6)
    ds_read_b64_tr_b16 a[216:217], v14 offset:49152
    ds_read_b64_tr_b16 a[218:219], v14 offset:53248
    v_mfma_f32_16x16x32_bf16 v[104:107], a[184:187], v[200:203], v[104:107]
    s_waitcnt lgkmcnt(6)
    buffer_load_dwordx4 a[104:107], v252, s[28:31], s37 offen offset:1024 sc1
    v_mfma_f32_16x16x32_bf16 v[104:107], a[188:191], v[184:187], v[104:107]
Ltour0_9:
    s_cbranch_execz Lmain0
    ds_read_b64_tr_b16 a[220:221], v14 offset:57344
    ds_read_b64_tr_b16 a[222:223], v14 offset:61440
    v_mfma_f32_16x16x32_bf16 v[108:111], a[188:191], v[188:191], 0
    ds_read_b64_tr_b16 a[224:225], v18 offset:32768
    v_mfma_f32_16x16x32_bf16 v[108:111], a[184:187], v[204:207], v[108:111]
    ds_read_b64_tr_b16 a[226:227], v18 offset:36864
    v_mfma_f32_16x16x32_bf16 v[108:111], a[180:183], v[156:159], v[108:111]
    buffer_load_dwordx4 a[88:91], v252, s[28:31], s37 offen offset:2048 sc1
    v_mfma_f32_16x16x32_bf16 v[108:111], a[176:179], v[140:143], v[108:111]
    ds_read_b64_tr_b16 a[228:229], v18 offset:40960
    ds_read_b64_tr_b16 a[230:231], v18 offset:45056
    v_mfma_f32_16x16x32_bf16 v[108:111], a[172:175], v[180:183], v[108:111]
    ds_read_b64_tr_b16 a[232:233], v18 offset:49152
    v_mfma_f32_16x16x32_bf16 v[108:111], a[168:171], v[196:199], v[108:111]
    ds_read_b64_tr_b16 a[234:235], v18 offset:53248
    v_mfma_f32_16x16x32_bf16 v[108:111], a[164:167], v[148:151], v[108:111]
    buffer_load_dwordx4 a[120:123], v252, s[28:31], s37 offen offset:3072 sc1
    v_mfma_f32_16x16x32_bf16 v[108:111], a[160:163], v[132:135], v[108:111]
    s_waitcnt lgkmcnt(12)
    ds_read_b64_tr_b16 a[236:237], v18 offset:57344
    ds_read_b64_tr_b16 a[238:239], v18 offset:61440
    v_mfma_f32_16x16x32_bf16 v[112:115], a[208:211], v[128:131], 0
    s_waitcnt lgkmcnt(12)
    ds_read_b64_tr_b16 a[160:161], v15 offset:32768
    v_mfma_f32_16x16x32_bf16 v[112:115], a[212:215], v[144:147], v[112:115]
    s_waitcnt lgkmcnt(11)
    s_add_u32 s37, s55, 12288
    ds_read_b64_tr_b16 a[162:163], v15 offset:36864
    v_mfma_f32_16x16x32_bf16 v[112:115], a[216:219], v[192:195], v[112:115]
    s_waitcnt lgkmcnt(10)
    buffer_load_dwordx4 a[76:79], v252, s[28:31], s37 offen offset:0 sc1
    v_mfma_f32_16x16x32_bf16 v[112:115], a[220:223], v[176:179], v[112:115]
    s_waitcnt lgkmcnt(8)
    ds_read_b64_tr_b16 a[164:165], v15 offset:40960
    ds_read_b64_tr_b16 a[166:167], v15 offset:45056
    v_mfma_f32_16x16x32_bf16 v[112:115], a[224:227], v[136:139], v[112:115]
    s_waitcnt lgkmcnt(8)
    buffer_load_dwordx4 a[108:111], v252, s[28:31], s37 offen offset:1024 sc1
    v_mfma_f32_16x16x32_bf16 v[112:115], a[228:231], v[152:155], v[112:115]
    s_waitcnt lgkmcnt(6)
    ds_read_b64_tr_b16 a[168:169], v15 offset:49152
    ds_read_b64_tr_b16 a[170:171], v15 offset:53248
    v_mfma_f32_16x16x32_bf16 v[112:115], a[232:235], v[200:203], v[112:115]
    s_waitcnt lgkmcnt(6)
    ds_read_b64_tr_b16 a[172:173], v15 offset:57344
    v_mfma_f32_16x16x32_bf16 v[112:115], a[236:239], v[184:187], v[112:115]
    ds_read_b64_tr_b16 a[174:175], v15 offset:61440
    v_mfma_f32_16x16x32_bf16 v[116:119], a[236:239], v[188:191], 0
    buffer_load_dwordx4 a[92:95], v252, s[28:31], s37 offen offset:2048 sc1
    v_mfma_f32_16x16x32_bf16 v[116:119], a[232:235], v[204:207], v[116:119]
    ds_read_b64_tr_b16 a[176:177], v19 offset:32768
    ds_read_b64_tr_b16 a[178:179], v19 offset:36864
    v_mfma_f32_16x16x32_bf16 v[116:119], a[228:231], v[156:159], v[116:119]
    ds_read_b64_tr_b16 a[180:181], v19 offset:40960
    v_mfma_f32_16x16x32_bf16 v[116:119], a[224:227], v[140:143], v[116:119]
    ds_read_b64_tr_b16 a[182:183], v19 offset:45056
    v_mfma_f32_16x16x32_bf16 v[116:119], a[220:223], v[180:183], v[116:119]
    buffer_load_dwordx4 a[124:127], v252, s[28:31], s37 offen offset:3072 sc1
    v_mfma_f32_16x16x32_bf16 v[116:119], a[216:219], v[196:199], v[116:119]
    ds_read_b64_tr_b16 a[184:185], v19 offset:49152
    ds_read_b64_tr_b16 a[186:187], v19 offset:53248
    v_mfma_f32_16x16x32_bf16 v[116:119], a[212:215], v[148:151], v[116:119]
    ds_read_b64_tr_b16 a[188:189], v19 offset:57344
    v_mfma_f32_16x16x32_bf16 v[116:119], a[208:211], v[132:135], v[116:119]
    ds_read_b64_tr_b16 a[190:191], v19 offset:61440
    s_waitcnt vmcnt(25)
    s_waitcnt lgkmcnt(0)
    s_barrier
    v_mfma_f32_16x16x32_bf16 v[120:123], a[160:163], v[128:131], 0
    ds_read_b64_tr_b16 a[208:209], v20 offset:32768
    v_mfma_f32_16x16x32_bf16 v[120:123], a[164:167], v[144:147], v[120:123]
    ds_read_b64_tr_b16 a[210:211], v20 offset:36864
    v_mfma_f32_16x16x32_bf16 v[120:123], a[168:171], v[192:195], v[120:123]
    ds_read_b64_tr_b16 a[212:213], v20 offset:40960
    v_mfma_f32_16x16x32_bf16 v[120:123], a[172:175], v[176:179], v[120:123]
    ds_read_b64_tr_b16 a[214:215], v20 offset:45056
    v_mfma_f32_16x16x32_bf16 v[120:123], a[176:179], v[136:139], v[120:123]
    ds_read_b64_tr_b16 a[216:217], v20 offset:49152
    v_mfma_f32_16x16x32_bf16 v[120:123], a[180:183], v[152:155], v[120:123]
    ds_read_b64_tr_b16 a[218:219], v20 offset:53248
    v_mfma_f32_16x16x32_bf16 v[120:123], a[184:187], v[200:203], v[120:123]
    s_add_u32 s49, s7, 512
    ds_read_b64_tr_b16 a[220:221], v20 offset:57344
    v_mfma_f32_16x16x32_bf16 v[120:123], a[188:191], v[184:187], v[120:123]
    s_add_u32 m0, s42, 65536
    ds_read_b64_tr_b16 a[222:223], v20 offset:61440
    v_mfma_f32_16x16x32_bf16 v[124:127], a[188:191], v[188:191], 0
    buffer_load_dwordx4 v46, s[20:23], s49 offen lds
    v_mfma_f32_16x16x32_bf16 v[124:127], a[184:187], v[204:207], v[124:127]
    ds_read_b64_tr_b16 a[224:225], v24 offset:32768
    ds_read_b64_tr_b16 a[226:227], v24 offset:36864
    v_mfma_f32_16x16x32_bf16 v[124:127], a[180:183], v[156:159], v[124:127]
    buffer_load_dwordx4 v47, s[20:23], s49 offen offset:1024 lds
    v_mfma_f32_16x16x32_bf16 v[124:127], a[176:179], v[140:143], v[124:127]
    ds_read_b64_tr_b16 a[228:229], v24 offset:40960
    ds_read_b64_tr_b16 a[230:231], v24 offset:45056
    v_mfma_f32_16x16x32_bf16 v[124:127], a[172:175], v[180:183], v[124:127]
    ds_read_b64_tr_b16 a[232:233], v24 offset:49152
    v_mfma_f32_16x16x32_bf16 v[124:127], a[168:171], v[196:199], v[124:127]
    ds_read_b64_tr_b16 a[234:235], v24 offset:53248
    v_mfma_f32_16x16x32_bf16 v[124:127], a[164:167], v[148:151], v[124:127]
    ds_read_b64_tr_b16 a[236:237], v24 offset:57344
    v_lshrrev_b32 v240, 4, v1
    v_mfma_f32_16x16x32_bf16 v[124:127], a[160:163], v[132:135], v[124:127]
    s_waitcnt vmcnt(25)
    s_waitcnt lgkmcnt(13)
    ds_read_b64_tr_b16 a[238:239], v24 offset:61440
    v_and_b32 v240, 2, v240
    v_mfma_f32_16x16x32_bf16 v[64:67], a[208:211], a[64:67], v[64:67]
    s_waitcnt vmcnt(21)
    s_waitcnt lgkmcnt(12)
    buffer_load_dwordx4 v48, s[20:23], s49 offen offset:2048 lds
    v_mfma_f32_16x16x32_bf16 v[64:67], a[212:215], a[68:71], v[64:67]
    s_waitcnt vmcnt(10)
    s_waitcnt lgkmcnt(10)
    ds_read_b64_tr_b16 a[160:161], v21 offset:32768
    ds_read_b64_tr_b16 a[162:163], v21 offset:36864
    v_mfma_f32_16x16x32_bf16 v[64:67], a[216:219], a[72:75], v[64:67]
    s_waitcnt vmcnt(6)
    s_waitcnt lgkmcnt(10)
    buffer_load_dwordx4 v49, s[20:23], s49 offen offset:3072 lds
    v_mfma_f32_16x16x32_bf16 v[64:67], a[220:223], a[76:79], v[64:67]
    s_waitcnt lgkmcnt(8)
    ds_read_b64_tr_b16 a[164:165], v21 offset:40960
    ds_read_b64_tr_b16 a[166:167], v21 offset:45056
    v_mfma_f32_16x16x32_bf16 v[64:67], a[224:227], a[80:83], v[64:67]
    s_waitcnt lgkmcnt(8)
    ds_read_b64_tr_b16 a[168:169], v21 offset:49152
    v_bfe_u32 v241, v1, 2, 2
    v_mfma_f32_16x16x32_bf16 v[64:67], a[228:231], a[84:87], v[64:67]
    s_waitcnt lgkmcnt(7)
    ds_read_b64_tr_b16 a[170:171], v21 offset:53248
    v_cmp_eq_u32 s[54:55], v240, v241
    v_mfma_f32_16x16x32_bf16 v[64:67], a[232:235], a[88:91], v[64:67]
    s_waitcnt vmcnt(5)
    s_waitcnt lgkmcnt(6)
    s_add_u32 s49, s7, 74240
    ds_read_b64_tr_b16 a[172:173], v21 offset:57344
    v_or_b32 v240, 1, v240
    v_mfma_f32_16x16x32_bf16 v[64:67], a[236:239], a[92:95], v[64:67]
    s_waitcnt vmcnt(4)
    s_add_u32 m0, s42, 81920
    ds_read_b64_tr_b16 a[174:175], v21 offset:61440
    v_cmp_eq_u32 s[36:37], v240, v241
    v_mfma_f32_16x16x32_bf16 v[68:71], a[236:239], a[124:127], v[68:71]
    buffer_load_dwordx4 v46, s[20:23], s49 offen lds
    v_mfma_f32_16x16x32_bf16 v[68:71], a[232:235], a[120:123], v[68:71]
    ds_read_b64_tr_b16 a[176:177], v25 offset:32768
    ds_read_b64_tr_b16 a[178:179], v25 offset:36864
    v_mfma_f32_16x16x32_bf16 v[68:71], a[228:231], a[116:119], v[68:71]
    buffer_load_dwordx4 v47, s[20:23], s49 offen offset:1024 lds
    v_mfma_f32_16x16x32_bf16 v[68:71], a[224:227], a[112:115], v[68:71]
    ds_read_b64_tr_b16 a[180:181], v25 offset:40960
    ds_read_b64_tr_b16 a[182:183], v25 offset:45056
    v_mfma_f32_16x16x32_bf16 v[68:71], a[220:223], a[108:111], v[68:71]
    ds_read_b64_tr_b16 a[184:185], v25 offset:49152
    v_cvt_pk_bf16_f32 v224, v64, v65
    v_mfma_f32_16x16x32_bf16 v[68:71], a[216:219], a[104:107], v[68:71]
    ds_read_b64_tr_b16 a[186:187], v25 offset:53248
    v_cvt_pk_bf16_f32 v225, v66, v67
    v_mfma_f32_16x16x32_bf16 v[68:71], a[212:215], a[100:103], v[68:71]
    buffer_load_dwordx2 v[36:37], v4, s[12:15], 0 offen offset:0
    v_mfma_f32_16x16x32_bf16 v[68:71], a[208:211], a[96:99], v[68:71]
    s_waitcnt lgkmcnt(12)
    ds_read_b64_tr_b16 a[188:189], v25 offset:57344
    ds_read_b64_tr_b16 a[190:191], v25 offset:61440
    v_mfma_f32_16x16x32_bf16 v[72:75], a[160:163], a[64:67], v[72:75]
    s_waitcnt lgkmcnt(12)
    buffer_load_dwordx4 v48, s[20:23], s49 offen offset:2048 lds
    v_mfma_f32_16x16x32_bf16 v[72:75], a[164:167], a[68:71], v[72:75]
    s_waitcnt lgkmcnt(10)
    ds_read_b64_tr_b16 a[208:209], v22 offset:32768
    ds_read_b64_tr_b16 a[210:211], v22 offset:36864
    v_mfma_f32_16x16x32_bf16 v[72:75], a[168:171], a[72:75], v[72:75]
    s_waitcnt lgkmcnt(10)
    buffer_load_dwordx4 v49, s[20:23], s49 offen offset:3072 lds
    v_mfma_f32_16x16x32_bf16 v[72:75], a[172:175], a[76:79], v[72:75]
    s_waitcnt lgkmcnt(8)
    ds_read_b64_tr_b16 a[212:213], v22 offset:40960
    ds_read_b64_tr_b16 a[214:215], v22 offset:45056
    v_mfma_f32_16x16x32_bf16 v[72:75], a[176:179], a[80:83], v[72:75]
    s_waitcnt lgkmcnt(8)
    ds_read_b64_tr_b16 a[216:217], v22 offset:49152
    v_cvt_pk_bf16_f32 v228, v68, v69
    v_mfma_f32_16x16x32_bf16 v[72:75], a[180:183], a[84:87], v[72:75]
    s_waitcnt lgkmcnt(7)
    ds_read_b64_tr_b16 a[218:219], v22 offset:53248
    v_cvt_pk_bf16_f32 v229, v70, v71
    v_mfma_f32_16x16x32_bf16 v[72:75], a[184:187], a[88:91], v[72:75]
    s_waitcnt lgkmcnt(6)
    ds_read_b64_tr_b16 a[220:221], v22 offset:57344
    v_and_b32 v240, 1, v1
    v_mfma_f32_16x16x32_bf16 v[72:75], a[188:191], a[92:95], v[72:75]
    ds_read_b64_tr_b16 a[222:223], v22 offset:61440
    v_lshlrev_b32 v240, 4, v240
    v_mfma_f32_16x16x32_bf16 v[76:79], a[188:191], a[124:127], v[76:79]
    buffer_load_dwordx2 v[38:39], v4, s[12:15], 0 offen offset:32
    v_mfma_f32_16x16x32_bf16 v[76:79], a[184:187], a[120:123], v[76:79]
    ds_read_b64_tr_b16 a[224:225], v26 offset:32768
    ds_read_b64_tr_b16 a[226:227], v26 offset:36864
    v_mfma_f32_16x16x32_bf16 v[76:79], a[180:183], a[116:119], v[76:79]
    ds_read_b64_tr_b16 a[228:229], v26 offset:40960
    v_mov_b32 v241, 0x3f80
    v_mfma_f32_16x16x32_bf16 v[76:79], a[176:179], a[112:115], v[76:79]
    ds_read_b64_tr_b16 a[230:231], v26 offset:45056
    v_lshlrev_b32 v240, v240, v241
    v_mfma_f32_16x16x32_bf16 v[76:79], a[172:175], a[108:111], v[76:79]
    ds_read_b64_tr_b16 a[232:233], v26 offset:49152
    v_cvt_pk_bf16_f32 v226, v72, v73
    v_mfma_f32_16x16x32_bf16 v[76:79], a[168:171], a[104:107], v[76:79]
    s_add_u32 s38, s93, 0
    ds_read_b64_tr_b16 a[234:235], v26 offset:53248
    v_cvt_pk_bf16_f32 v227, v74, v75
    v_mfma_f32_16x16x32_bf16 v[76:79], a[164:167], a[100:103], v[76:79]
    buffer_store_dwordx4 v[224:227], v56, s[28:31], s38 offen sc1
    v_mfma_f32_16x16x32_bf16 v[76:79], a[160:163], a[96:99], v[76:79]
    s_waitcnt lgkmcnt(12)
    ds_read_b64_tr_b16 a[236:237], v26 offset:57344
    ds_read_b64_tr_b16 a[238:239], v26 offset:61440
    v_mfma_f32_16x16x32_bf16 v[80:83], a[208:211], a[64:67], v[80:83]
    s_waitcnt lgkmcnt(12)
    ds_read_b64_tr_b16 a[160:161], v23 offset:32768
    v_bfe_i32 v241, v1, 1, 1
    v_mfma_f32_16x16x32_bf16 v[80:83], a[212:215], a[68:71], v[80:83]
    s_waitcnt lgkmcnt(11)
    ds_read_b64_tr_b16 a[162:163], v23 offset:36864
    v_and_b32 v243, v240, v241
    v_mfma_f32_16x16x32_bf16 v[80:83], a[216:219], a[72:75], v[80:83]
    s_waitcnt lgkmcnt(10)
    buffer_load_dwordx2 v[40:41], v4, s[12:15], 0 offen offset:512
    v_mfma_f32_16x16x32_bf16 v[80:83], a[220:223], a[76:79], v[80:83]
    s_waitcnt lgkmcnt(8)
    ds_read_b64_tr_b16 a[164:165], v23 offset:40960
    ds_read_b64_tr_b16 a[166:167], v23 offset:45056
    v_mfma_f32_16x16x32_bf16 v[80:83], a[224:227], a[80:83], v[80:83]
    s_waitcnt lgkmcnt(8)
    ds_read_b64_tr_b16 a[168:169], v23 offset:49152
    v_cvt_pk_bf16_f32 v230, v76, v77
    v_mfma_f32_16x16x32_bf16 v[80:83], a[228:231], a[84:87], v[80:83]
    s_waitcnt lgkmcnt(7)
    s_add_u32 s38, s93, 164864
    ds_read_b64_tr_b16 a[170:171], v23 offset:53248
    v_cvt_pk_bf16_f32 v231, v78, v79
    v_mfma_f32_16x16x32_bf16 v[80:83], a[232:235], a[88:91], v[80:83]
    s_waitcnt lgkmcnt(6)
    buffer_store_dwordx4 v[228:231], v56, s[28:31], s38 offen sc1
    v_mfma_f32_16x16x32_bf16 v[80:83], a[236:239], a[92:95], v[80:83]
    ds_read_b64_tr_b16 a[172:173], v23 offset:57344
    ds_read_b64_tr_b16 a[174:175], v23 offset:61440
    v_mfma_f32_16x16x32_bf16 v[84:87], a[236:239], a[124:127], v[84:87]
    ds_read_b64_tr_b16 a[176:177], v27 offset:32768
    v_xor_b32 v242, v240, v243
    v_mfma_f32_16x16x32_bf16 v[84:87], a[232:235], a[120:123], v[84:87]
    ds_read_b64_tr_b16 a[178:179], v27 offset:36864
    v_cndmask_b32 v246, 0, v242, s[54:55]
    v_mfma_f32_16x16x32_bf16 v[84:87], a[228:231], a[116:119], v[84:87]
    ds_read_b64_tr_b16 a[180:181], v27 offset:40960
    v_cndmask_b32 v247, 0, v243, s[54:55]
    v_mfma_f32_16x16x32_bf16 v[84:87], a[224:227], a[112:115], v[84:87]
    ds_read_b64_tr_b16 a[182:183], v27 offset:45056
    v_cndmask_b32 v250, 0, v242, s[36:37]
    v_mfma_f32_16x16x32_bf16 v[84:87], a[220:223], a[108:111], v[84:87]
    ds_read_b64_tr_b16 a[184:185], v27 offset:49152
    v_cvt_pk_bf16_f32 v232, v80, v81
    v_mfma_f32_16x16x32_bf16 v[84:87], a[216:219], a[104:107], v[84:87]
    ds_read_b64_tr_b16 a[186:187], v27 offset:53248
    v_cvt_pk_bf16_f32 v233, v82, v83
    v_mfma_f32_16x16x32_bf16 v[84:87], a[212:215], a[100:103], v[84:87]
    buffer_load_dwordx2 v[42:43], v4, s[12:15], 0 offen offset:544
    v_mfma_f32_16x16x32_bf16 v[84:87], a[208:211], a[96:99], v[84:87]
    s_waitcnt lgkmcnt(12)
    ds_read_b64_tr_b16 a[188:189], v27 offset:57344
    ds_read_b64_tr_b16 a[190:191], v27 offset:61440
    s_barrier
    v_mfma_f32_16x16x32_bf16 v[88:91], a[160:163], a[64:67], v[88:91]
    s_waitcnt lgkmcnt(12)
    ds_read_b64_tr_b16 a[208:209], v12 offset:0
    v_cndmask_b32 v251, 0, v243, s[36:37]
    v_mfma_f32_16x16x32_bf16 v[88:91], a[164:167], a[68:71], v[88:91]
    s_waitcnt lgkmcnt(11)
    ds_read_b64_tr_b16 a[210:211], v12 offset:4096
    v_mov_b32 v240, 0
    v_mfma_f32_16x16x32_bf16 v[88:91], a[168:171], a[72:75], v[88:91]
    s_waitcnt lgkmcnt(10)
    ds_read_b64_tr_b16 a[212:213], v12 offset:8192
    v_mov_b32 v241, 0
    v_mfma_f32_16x16x32_bf16 v[88:91], a[172:175], a[76:79], v[88:91]
    s_waitcnt lgkmcnt(9)
    ds_read_b64_tr_b16 a[214:215], v12 offset:12288
    v_mov_b32 v244, 0
    v_mfma_f32_16x16x32_bf16 v[88:91], a[176:179], a[80:83], v[88:91]
    s_waitcnt lgkmcnt(8)
    ds_read_b64_tr_b16 a[216:217], v12 offset:16384
    v_cvt_pk_bf16_f32 v236, v84, v85
    v_mfma_f32_16x16x32_bf16 v[88:91], a[180:183], a[84:87], v[88:91]
    s_waitcnt lgkmcnt(7)
    ds_read_b64_tr_b16 a[218:219], v12 offset:20480
    v_cvt_pk_bf16_f32 v237, v86, v87
    v_mfma_f32_16x16x32_bf16 v[88:91], a[184:187], a[88:91], v[88:91]
    s_waitcnt lgkmcnt(6)
    s_add_u32 s49, s46, 512
    ds_read_b64_tr_b16 a[220:221], v12 offset:24576
    v_mov_b32 v245, 0
    v_mfma_f32_16x16x32_bf16 v[88:91], a[188:191], a[92:95], v[88:91]
    s_add_u32 m0, s42, 32768
    ds_read_b64_tr_b16 a[222:223], v12 offset:28672
    v_mov_b32 v248, 0
    v_mfma_f32_16x16x32_bf16 v[92:95], a[188:191], a[124:127], v[92:95]
    buffer_load_dwordx4 v46, s[20:23], s49 offen lds
    v_mfma_f32_16x16x32_bf16 v[92:95], a[184:187], a[120:123], v[92:95]
    ds_read_b64_tr_b16 a[224:225], v16 offset:0
    ds_read_b64_tr_b16 a[226:227], v16 offset:4096
    v_mfma_f32_16x16x32_bf16 v[92:95], a[180:183], a[116:119], v[92:95]
    buffer_load_dwordx4 v47, s[20:23], s49 offen offset:1024 lds
    v_mfma_f32_16x16x32_bf16 v[92:95], a[176:179], a[112:115], v[92:95]
    ds_read_b64_tr_b16 a[228:229], v16 offset:8192
    ds_read_b64_tr_b16 a[230:231], v16 offset:12288
    v_mfma_f32_16x16x32_bf16 v[92:95], a[172:175], a[108:111], v[92:95]
    ds_read_b64_tr_b16 a[232:233], v16 offset:16384
    v_cvt_pk_bf16_f32 v234, v88, v89
    v_mfma_f32_16x16x32_bf16 v[92:95], a[168:171], a[104:107], v[92:95]
    s_add_u32 s38, s93, 128
    ds_read_b64_tr_b16 a[234:235], v16 offset:20480
    v_cvt_pk_bf16_f32 v235, v90, v91
    v_mfma_f32_16x16x32_bf16 v[92:95], a[164:167], a[100:103], v[92:95]
    buffer_store_dwordx4 v[232:235], v56, s[28:31], s38 offen sc1
    v_mfma_f32_16x16x32_bf16 v[92:95], a[160:163], a[96:99], v[92:95]
    s_waitcnt lgkmcnt(12)
    ds_read_b64_tr_b16 a[236:237], v16 offset:24576
    ds_read_b64_tr_b16 a[238:239], v16 offset:28672
    v_mfma_f32_16x16x32_bf16 v[96:99], a[208:211], a[64:67], v[96:99]
    s_waitcnt lgkmcnt(12)
    buffer_load_dwordx4 v48, s[20:23], s49 offen offset:2048 lds
    v_mfma_f32_16x16x32_bf16 v[96:99], a[212:215], a[68:71], v[96:99]
    s_waitcnt lgkmcnt(10)
    ds_read_b64_tr_b16 a[160:161], v13 offset:0
    ds_read_b64_tr_b16 a[162:163], v13 offset:4096
    v_mfma_f32_16x16x32_bf16 v[96:99], a[216:219], a[72:75], v[96:99]
    s_waitcnt lgkmcnt(10)
    buffer_load_dwordx4 v49, s[20:23], s49 offen offset:3072 lds
    v_mfma_f32_16x16x32_bf16 v[96:99], a[220:223], a[76:79], v[96:99]
    s_waitcnt lgkmcnt(8)
    ds_read_b64_tr_b16 a[164:165], v13 offset:8192
    ds_read_b64_tr_b16 a[166:167], v13 offset:12288
    v_mfma_f32_16x16x32_bf16 v[96:99], a[224:227], a[80:83], v[96:99]
    s_waitcnt lgkmcnt(8)
    ds_read_b64_tr_b16 a[168:169], v13 offset:16384
    v_cvt_pk_bf16_f32 v238, v92, v93
    v_mfma_f32_16x16x32_bf16 v[96:99], a[228:231], a[84:87], v[96:99]
    s_waitcnt lgkmcnt(7)
    s_add_u32 s38, s93, 164992
    ds_read_b64_tr_b16 a[170:171], v13 offset:20480
    v_cvt_pk_bf16_f32 v239, v94, v95
    v_mfma_f32_16x16x32_bf16 v[96:99], a[232:235], a[88:91], v[96:99]
    s_waitcnt lgkmcnt(6)
    s_add_u32 s49, s46, 74240
    buffer_store_dwordx4 v[236:239], v56, s[28:31], s38 offen sc1
    v_mfma_f32_16x16x32_bf16 v[96:99], a[236:239], a[92:95], v[96:99]
    s_add_u32 m0, s42, 49152
    ds_read_b64_tr_b16 a[172:173], v13 offset:24576
    ds_read_b64_tr_b16 a[174:175], v13 offset:28672
    v_mfma_f32_16x16x32_bf16 v[100:103], a[236:239], a[124:127], v[100:103]
    buffer_load_dwordx4 v46, s[20:23], s49 offen lds
    v_mfma_f32_16x16x32_bf16 v[100:103], a[232:235], a[120:123], v[100:103]
    ds_read_b64_tr_b16 a[176:177], v17 offset:0
    ds_read_b64_tr_b16 a[178:179], v17 offset:4096
    v_mfma_f32_16x16x32_bf16 v[100:103], a[228:231], a[116:119], v[100:103]
    buffer_load_dwordx4 v47, s[20:23], s49 offen offset:1024 lds
    v_mfma_f32_16x16x32_bf16 v[100:103], a[224:227], a[112:115], v[100:103]
    ds_read_b64_tr_b16 a[180:181], v17 offset:8192
    ds_read_b64_tr_b16 a[182:183], v17 offset:12288
    v_mfma_f32_16x16x32_bf16 v[100:103], a[220:223], a[108:111], v[100:103]
    ds_read_b64_tr_b16 a[184:185], v17 offset:16384
    v_cvt_pk_bf16_f32 v224, v96, v97
    v_mfma_f32_16x16x32_bf16 v[100:103], a[216:219], a[104:107], v[100:103]
    ds_read_b64_tr_b16 a[186:187], v17 offset:20480
    v_cvt_pk_bf16_f32 v225, v98, v99
    v_mfma_f32_16x16x32_bf16 v[100:103], a[212:215], a[100:103], v[100:103]
    ds_read_b64_tr_b16 a[188:189], v17 offset:24576
    v_mov_b32 v249, 0
    v_mfma_f32_16x16x32_bf16 v[100:103], a[208:211], a[96:99], v[100:103]
    s_waitcnt lgkmcnt(13)
    ds_read_b64_tr_b16 a[190:191], v17 offset:28672
    v_mov_b32 v252, 0
    v_mfma_f32_16x16x32_bf16 v[104:107], a[160:163], a[64:67], v[104:107]
    s_waitcnt lgkmcnt(12)
    buffer_load_dwordx4 v48, s[20:23], s49 offen offset:2048 lds
    v_mfma_f32_16x16x32_bf16 v[104:107], a[164:167], a[68:71], v[104:107]
    s_waitcnt lgkmcnt(10)
    ds_read_b64_tr_b16 a[208:209], v14 offset:0
    ds_read_b64_tr_b16 a[210:211], v14 offset:4096
    v_mfma_f32_16x16x32_bf16 v[104:107], a[168:171], a[72:75], v[104:107]
    s_waitcnt lgkmcnt(10)
    buffer_load_dwordx4 v49, s[20:23], s49 offen offset:3072 lds
    v_mfma_f32_16x16x32_bf16 v[104:107], a[172:175], a[76:79], v[104:107]
    s_waitcnt lgkmcnt(8)
    ds_read_b64_tr_b16 a[212:213], v14 offset:8192
    ds_read_b64_tr_b16 a[214:215], v14 offset:12288
    v_mfma_f32_16x16x32_bf16 v[104:107], a[176:179], a[80:83], v[104:107]
    s_waitcnt lgkmcnt(8)
    ds_read_b64_tr_b16 a[216:217], v14 offset:16384
    v_cvt_pk_bf16_f32 v228, v100, v101
    v_mfma_f32_16x16x32_bf16 v[104:107], a[180:183], a[84:87], v[104:107]
    s_waitcnt lgkmcnt(7)
    ds_read_b64_tr_b16 a[218:219], v14 offset:20480
    v_cvt_pk_bf16_f32 v229, v102, v103
    v_mfma_f32_16x16x32_bf16 v[104:107], a[184:187], a[88:91], v[104:107]
    s_waitcnt lgkmcnt(6)
    ds_read_b64_tr_b16 a[220:221], v14 offset:24576
    v_mov_b32 v253, 0
    v_mfma_f32_16x16x32_bf16 v[104:107], a[188:191], a[92:95], v[104:107]
    ds_read_b64_tr_b16 a[222:223], v14 offset:28672
    v_mfma_f32_16x16x32_bf16 v[108:111], a[188:191], a[124:127], v[108:111]
    ds_read_b64_tr_b16 a[224:225], v18 offset:0
    v_mfma_f32_16x16x32_bf16 v[108:111], a[184:187], a[120:123], v[108:111]
    ds_read_b64_tr_b16 a[226:227], v18 offset:4096
    v_mfma_f32_16x16x32_bf16 v[108:111], a[180:183], a[116:119], v[108:111]
    ds_read_b64_tr_b16 a[228:229], v18 offset:8192
    v_mfma_f32_16x16x32_bf16 v[108:111], a[176:179], a[112:115], v[108:111]
    ds_read_b64_tr_b16 a[230:231], v18 offset:12288
    v_mfma_f32_16x16x32_bf16 v[108:111], a[172:175], a[108:111], v[108:111]
    ds_read_b64_tr_b16 a[232:233], v18 offset:16384
    v_cvt_pk_bf16_f32 v226, v104, v105
    v_mfma_f32_16x16x32_bf16 v[108:111], a[168:171], a[104:107], v[108:111]
    s_add_u32 s38, s93, 512
    ds_read_b64_tr_b16 a[234:235], v18 offset:20480
    v_cvt_pk_bf16_f32 v227, v106, v107
    v_mfma_f32_16x16x32_bf16 v[108:111], a[164:167], a[100:103], v[108:111]
    buffer_store_dwordx4 v[224:227], v56, s[28:31], s38 offen sc1
    v_mfma_f32_16x16x32_bf16 v[108:111], a[160:163], a[96:99], v[108:111]
    s_waitcnt lgkmcnt(12)
    ds_read_b64_tr_b16 a[236:237], v18 offset:24576
    ds_read_b64_tr_b16 a[238:239], v18 offset:28672
    v_mfma_f32_16x16x32_bf16 v[112:115], a[208:211], a[64:67], v[112:115]
    s_waitcnt lgkmcnt(12)
    ds_read_b64_tr_b16 a[160:161], v15 offset:0
    v_mfma_f32_16x16x32_bf16 v[112:115], a[212:215], a[68:71], v[112:115]
    s_waitcnt lgkmcnt(11)
    ds_read_b64_tr_b16 a[162:163], v15 offset:4096
    v_mfma_f32_16x16x32_bf16 v[112:115], a[216:219], a[72:75], v[112:115]
    s_waitcnt lgkmcnt(10)
    ds_read_b64_tr_b16 a[164:165], v15 offset:8192
    v_mfma_f32_16x16x32_bf16 v[112:115], a[220:223], a[76:79], v[112:115]
    s_waitcnt lgkmcnt(9)
    ds_read_b64_tr_b16 a[166:167], v15 offset:12288
    v_mfma_f32_16x16x32_bf16 v[112:115], a[224:227], a[80:83], v[112:115]
    s_waitcnt lgkmcnt(8)
    ds_read_b64_tr_b16 a[168:169], v15 offset:16384
    v_cvt_pk_bf16_f32 v230, v108, v109
    v_mfma_f32_16x16x32_bf16 v[112:115], a[228:231], a[84:87], v[112:115]
    s_waitcnt lgkmcnt(7)
    s_add_u32 s38, s93, 165376
    ds_read_b64_tr_b16 a[170:171], v15 offset:20480
    v_cvt_pk_bf16_f32 v231, v110, v111
    v_mfma_f32_16x16x32_bf16 v[112:115], a[232:235], a[88:91], v[112:115]
    s_waitcnt lgkmcnt(6)
    buffer_store_dwordx4 v[228:231], v56, s[28:31], s38 offen sc1
    v_mfma_f32_16x16x32_bf16 v[112:115], a[236:239], a[92:95], v[112:115]
    ds_read_b64_tr_b16 a[172:173], v15 offset:24576
    ds_read_b64_tr_b16 a[174:175], v15 offset:28672
    v_mfma_f32_16x16x32_bf16 v[116:119], a[236:239], a[124:127], v[116:119]
    ds_read_b64_tr_b16 a[176:177], v19 offset:0
    v_mfma_f32_16x16x32_bf16 v[116:119], a[232:235], a[120:123], v[116:119]
    ds_read_b64_tr_b16 a[178:179], v19 offset:4096
    v_mfma_f32_16x16x32_bf16 v[116:119], a[228:231], a[116:119], v[116:119]
    ds_read_b64_tr_b16 a[180:181], v19 offset:8192
    v_mfma_f32_16x16x32_bf16 v[116:119], a[224:227], a[112:115], v[116:119]
    ds_read_b64_tr_b16 a[182:183], v19 offset:12288
    v_mfma_f32_16x16x32_bf16 v[116:119], a[220:223], a[108:111], v[116:119]
    ds_read_b64_tr_b16 a[184:185], v19 offset:16384
    v_cvt_pk_bf16_f32 v232, v112, v113
    v_mfma_f32_16x16x32_bf16 v[116:119], a[216:219], a[104:107], v[116:119]
    ds_read_b64_tr_b16 a[186:187], v19 offset:20480
    v_cvt_pk_bf16_f32 v233, v114, v115
    v_mfma_f32_16x16x32_bf16 v[116:119], a[212:215], a[100:103], v[116:119]
    ds_read_b64_tr_b16 a[188:189], v19 offset:24576
    v_mfma_f32_16x16x32_bf16 v[116:119], a[208:211], a[96:99], v[116:119]
    s_waitcnt lgkmcnt(13)
    ds_read_b64_tr_b16 a[190:191], v19 offset:28672
    s_waitcnt vmcnt(17)
    s_barrier
    v_mfma_f32_16x16x32_bf16 v[120:123], a[160:163], a[64:67], v[120:123]
    s_waitcnt lgkmcnt(12)
    ds_read_b64_tr_b16 a[208:209], v20 offset:0
    v_mfma_f32_16x16x32_bf16 v[120:123], a[164:167], a[68:71], v[120:123]
    s_waitcnt lgkmcnt(11)
    ds_read_b64_tr_b16 a[210:211], v20 offset:4096
    v_mfma_f32_16x16x32_bf16 v[120:123], a[168:171], a[72:75], v[120:123]
    s_waitcnt lgkmcnt(10)
    ds_read_b64_tr_b16 a[212:213], v20 offset:8192
    v_mfma_f32_16x16x32_bf16 v[120:123], a[172:175], a[76:79], v[120:123]
    s_waitcnt lgkmcnt(9)
    ds_read_b64_tr_b16 a[214:215], v20 offset:12288
    v_mfma_f32_16x16x32_bf16 v[120:123], a[176:179], a[80:83], v[120:123]
    s_waitcnt lgkmcnt(8)
    ds_read_b64_tr_b16 a[216:217], v20 offset:16384
    v_cvt_pk_bf16_f32 v236, v116, v117
    v_mfma_f32_16x16x32_bf16 v[120:123], a[180:183], a[84:87], v[120:123]
    s_waitcnt lgkmcnt(7)
    ds_read_b64_tr_b16 a[218:219], v20 offset:20480
    v_cvt_pk_bf16_f32 v237, v118, v119
    v_mfma_f32_16x16x32_bf16 v[120:123], a[184:187], a[88:91], v[120:123]
    s_waitcnt lgkmcnt(6)
    s_add_u32 s49, s7, 768
    ds_read_b64_tr_b16 a[220:221], v20 offset:24576
    v_mfma_f32_16x16x32_bf16 v[120:123], a[188:191], a[92:95], v[120:123]
    s_add_u32 m0, s42, 98304
    ds_read_b64_tr_b16 a[222:223], v20 offset:28672
    v_mfma_f32_16x16x32_bf16 v[124:127], a[188:191], a[124:127], v[124:127]
    buffer_load_dwordx4 v46, s[20:23], s49 offen lds
    v_mfma_f32_16x16x32_bf16 v[124:127], a[184:187], a[120:123], v[124:127]
    ds_read_b64_tr_b16 a[224:225], v24 offset:0
    ds_read_b64_tr_b16 a[226:227], v24 offset:4096
    v_mfma_f32_16x16x32_bf16 v[124:127], a[180:183], a[116:119], v[124:127]
    buffer_load_dwordx4 v47, s[20:23], s49 offen offset:1024 lds
    v_mfma_f32_16x16x32_bf16 v[124:127], a[176:179], a[112:115], v[124:127]
    ds_read_b64_tr_b16 a[228:229], v24 offset:8192
    ds_read_b64_tr_b16 a[230:231], v24 offset:12288
    v_mfma_f32_16x16x32_bf16 v[124:127], a[172:175], a[108:111], v[124:127]
    ds_read_b64_tr_b16 a[232:233], v24 offset:16384
    v_cvt_pk_bf16_f32 v234, v120, v121
    v_mfma_f32_16x16x32_bf16 v[124:127], a[168:171], a[104:107], v[124:127]
    s_add_u32 s38, s93, 640
    ds_read_b64_tr_b16 a[234:235], v24 offset:20480
    v_cvt_pk_bf16_f32 v235, v122, v123
    v_mfma_f32_16x16x32_bf16 v[124:127], a[164:167], a[100:103], v[124:127]
    buffer_store_dwordx4 v[232:235], v56, s[28:31], s38 offen sc1
    v_mfma_f32_16x16x32_bf16 v[124:127], a[160:163], a[96:99], v[124:127]
    s_waitcnt lgkmcnt(12)
    ds_read_b64_tr_b16 a[236:237], v24 offset:24576
    ds_read_b64_tr_b16 a[238:239], v24 offset:28672
    v_mfma_f32_16x16x32_bf16 v[64:67], a[208:211], v[128:131], 0
    s_waitcnt lgkmcnt(12)
    buffer_load_dwordx4 v48, s[20:23], s49 offen offset:2048 lds
    v_mfma_f32_16x16x32_bf16 v[64:67], a[212:215], v[144:147], v[64:67]
    s_waitcnt lgkmcnt(10)
    ds_read_b64_tr_b16 a[160:161], v21 offset:0
    ds_read_b64_tr_b16 a[162:163], v21 offset:4096
    v_mfma_f32_16x16x32_bf16 v[64:67], a[216:219], v[192:195], v[64:67]
    s_waitcnt lgkmcnt(10)
    buffer_load_dwordx4 v49, s[20:23], s49 offen offset:3072 lds
    v_mfma_f32_16x16x32_bf16 v[64:67], a[220:223], v[176:179], v[64:67]
    s_waitcnt lgkmcnt(8)
    ds_read_b64_tr_b16 a[164:165], v21 offset:8192
    ds_read_b64_tr_b16 a[166:167], v21 offset:12288
    v_mfma_f32_16x16x32_bf16 v[64:67], a[224:227], v[136:139], v[64:67]
    s_waitcnt lgkmcnt(8)
    ds_read_b64_tr_b16 a[168:169], v21 offset:16384
    v_cvt_pk_bf16_f32 v238, v124, v125
    v_mfma_f32_16x16x32_bf16 v[64:67], a[228:231], v[152:155], v[64:67]
    s_waitcnt lgkmcnt(7)
    s_add_u32 s38, s93, 165504
    ds_read_b64_tr_b16 a[170:171], v21 offset:20480
    v_cvt_pk_bf16_f32 v239, v126, v127
    v_mfma_f32_16x16x32_bf16 v[64:67], a[232:235], v[200:203], v[64:67]
    s_waitcnt lgkmcnt(6)
    s_add_u32 s49, s7, 74496
    buffer_store_dwordx4 v[236:239], v56, s[28:31], s38 offen sc1
    v_mfma_f32_16x16x32_bf16 v[64:67], a[236:239], v[184:187], v[64:67]
    s_add_u32 m0, s42, 114688
    ds_read_b64_tr_b16 a[172:173], v21 offset:24576
    ds_read_b64_tr_b16 a[174:175], v21 offset:28672
    v_mfma_f32_16x16x32_bf16 v[68:71], a[236:239], v[188:191], 0
    buffer_load_dwordx4 v46, s[20:23], s49 offen lds
    v_mfma_f32_16x16x32_bf16 v[68:71], a[232:235], v[204:207], v[68:71]
Ltour0_10:
    s_cbranch_execz Lmain0
    ds_read_b64_tr_b16 a[176:177], v25 offset:0
    ds_read_b64_tr_b16 a[178:179], v25 offset:4096
    v_mfma_f32_16x16x32_bf16 v[68:71], a[228:231], v[156:159], v[68:71]
    buffer_load_dwordx4 v47, s[20:23], s49 offen offset:1024 lds
    v_mfma_f32_16x16x32_bf16 v[68:71], a[224:227], v[140:143], v[68:71]
    ds_read_b64_tr_b16 a[180:181], v25 offset:8192
    ds_read_b64_tr_b16 a[182:183], v25 offset:12288
    v_mfma_f32_16x16x32_bf16 v[68:71], a[220:223], v[180:183], v[68:71]
    ds_read_b64_tr_b16 a[184:185], v25 offset:16384
    v_mfma_f32_16x16x32_bf16 v[68:71], a[216:219], v[196:199], v[68:71]
    ds_read_b64_tr_b16 a[186:187], v25 offset:20480
    v_mfma_f32_16x16x32_bf16 v[68:71], a[212:215], v[148:151], v[68:71]
    ds_read_b64_tr_b16 a[188:189], v25 offset:24576
    v_mfma_f32_16x16x32_bf16 v[68:71], a[208:211], v[132:135], v[68:71]
    s_waitcnt lgkmcnt(13)
    ds_read_b64_tr_b16 a[190:191], v25 offset:28672
    v_mfma_f32_16x16x32_bf16 v[72:75], a[160:163], v[128:131], 0
    s_waitcnt lgkmcnt(12)
    buffer_load_dwordx4 v48, s[20:23], s49 offen offset:2048 lds
    v_mfma_f32_16x16x32_bf16 v[72:75], a[164:167], v[144:147], v[72:75]
    s_waitcnt lgkmcnt(10)
    ds_read_b64_tr_b16 a[208:209], v22 offset:0
    ds_read_b64_tr_b16 a[210:211], v22 offset:4096
    v_mfma_f32_16x16x32_bf16 v[72:75], a[168:171], v[192:195], v[72:75]
    s_waitcnt lgkmcnt(10)
    buffer_load_dwordx4 v49, s[20:23], s49 offen offset:3072 lds
    v_mfma_f32_16x16x32_bf16 v[72:75], a[172:175], v[176:179], v[72:75]
    s_waitcnt lgkmcnt(8)
    ds_read_b64_tr_b16 a[212:213], v22 offset:8192
    ds_read_b64_tr_b16 a[214:215], v22 offset:12288
    v_mfma_f32_16x16x32_bf16 v[72:75], a[176:179], v[136:139], v[72:75]
    s_waitcnt lgkmcnt(8)
    ds_read_b64_tr_b16 a[216:217], v22 offset:16384
    v_mfma_f32_16x16x32_bf16 v[72:75], a[180:183], v[152:155], v[72:75]
    s_waitcnt lgkmcnt(7)
    ds_read_b64_tr_b16 a[218:219], v22 offset:20480
    v_mfma_f32_16x16x32_bf16 v[72:75], a[184:187], v[200:203], v[72:75]
    s_waitcnt lgkmcnt(6)
    ds_read_b64_tr_b16 a[220:221], v22 offset:24576
    v_mfma_f32_16x16x32_bf16 v[72:75], a[188:191], v[184:187], v[72:75]
    ds_read_b64_tr_b16 a[222:223], v22 offset:28672
    v_mfma_f32_16x16x32_bf16 v[76:79], a[188:191], v[188:191], 0
    ds_read_b64_tr_b16 a[224:225], v26 offset:0
    v_mfma_f32_16x16x32_bf16 v[76:79], a[184:187], v[204:207], v[76:79]
    ds_read_b64_tr_b16 a[226:227], v26 offset:4096
    v_mfma_f32_16x16x32_bf16 v[76:79], a[180:183], v[156:159], v[76:79]
    ds_read_b64_tr_b16 a[228:229], v26 offset:8192
    v_mfma_f32_16x16x32_bf16 v[76:79], a[176:179], v[140:143], v[76:79]
    ds_read_b64_tr_b16 a[230:231], v26 offset:12288
    v_mfma_f32_16x16x32_bf16 v[76:79], a[172:175], v[180:183], v[76:79]
    ds_read_b64_tr_b16 a[232:233], v26 offset:16384
    v_mfma_f32_16x16x32_bf16 v[76:79], a[168:171], v[196:199], v[76:79]
    ds_read_b64_tr_b16 a[234:235], v26 offset:20480
    v_mfma_f32_16x16x32_bf16 v[76:79], a[164:167], v[148:151], v[76:79]
    buffer_load_dword v63, v63, s[88:91], 0 offen sc1
    v_mfma_f32_16x16x32_bf16 v[76:79], a[160:163], v[132:135], v[76:79]
    s_waitcnt lgkmcnt(12)
    ds_read_b64_tr_b16 a[236:237], v26 offset:24576
    ds_read_b64_tr_b16 a[238:239], v26 offset:28672
    v_mfma_f32_16x16x32_bf16 v[80:83], a[208:211], v[128:131], 0
    s_waitcnt lgkmcnt(12)
    ds_read_b64_tr_b16 a[160:161], v23 offset:0
    v_mfma_f32_16x16x32_bf16 v[80:83], a[212:215], v[144:147], v[80:83]
    s_waitcnt lgkmcnt(11)
    ds_read_b64_tr_b16 a[162:163], v23 offset:4096
    v_mfma_f32_16x16x32_bf16 v[80:83], a[216:219], v[192:195], v[80:83]
    s_waitcnt lgkmcnt(10)
    ds_read_b64_tr_b16 a[164:165], v23 offset:8192
    v_mfma_f32_16x16x32_bf16 v[80:83], a[220:223], v[176:179], v[80:83]
    s_waitcnt lgkmcnt(9)
    ds_read_b64_tr_b16 a[166:167], v23 offset:12288
    v_mfma_f32_16x16x32_bf16 v[80:83], a[224:227], v[136:139], v[80:83]
    s_waitcnt lgkmcnt(8)
    ds_read_b64_tr_b16 a[168:169], v23 offset:16384
    v_mfma_f32_16x16x32_bf16 v[80:83], a[228:231], v[152:155], v[80:83]
    s_waitcnt lgkmcnt(7)
    ds_read_b64_tr_b16 a[170:171], v23 offset:20480
    v_mfma_f32_16x16x32_bf16 v[80:83], a[232:235], v[200:203], v[80:83]
    s_waitcnt lgkmcnt(6)
    ds_read_b64_tr_b16 a[172:173], v23 offset:24576
    v_mfma_f32_16x16x32_bf16 v[80:83], a[236:239], v[184:187], v[80:83]
    ds_read_b64_tr_b16 a[174:175], v23 offset:28672
    v_mfma_f32_16x16x32_bf16 v[84:87], a[236:239], v[188:191], 0
    ds_read_b64_tr_b16 a[176:177], v27 offset:0
    v_mfma_f32_16x16x32_bf16 v[84:87], a[232:235], v[204:207], v[84:87]
    ds_read_b64_tr_b16 a[178:179], v27 offset:4096
    v_mfma_f32_16x16x32_bf16 v[84:87], a[228:231], v[156:159], v[84:87]
    ds_read_b64_tr_b16 a[180:181], v27 offset:8192
    v_mfma_f32_16x16x32_bf16 v[84:87], a[224:227], v[140:143], v[84:87]
    ds_read_b64_tr_b16 a[182:183], v27 offset:12288
    v_mfma_f32_16x16x32_bf16 v[84:87], a[220:223], v[180:183], v[84:87]
    ds_read_b64_tr_b16 a[184:185], v27 offset:16384
    v_mfma_f32_16x16x32_bf16 v[84:87], a[216:219], v[196:199], v[84:87]
    ds_read_b64_tr_b16 a[186:187], v27 offset:20480
    v_mfma_f32_16x16x32_bf16 v[84:87], a[212:215], v[148:151], v[84:87]
    ds_read_b64_tr_b16 a[188:189], v27 offset:24576
    v_mfma_f32_16x16x32_bf16 v[84:87], a[208:211], v[132:135], v[84:87]
    s_waitcnt lgkmcnt(13)
    ds_read_b64_tr_b16 a[190:191], v27 offset:28672
    s_waitcnt vmcnt(13)
    s_barrier
    v_mfma_f32_16x16x32_bf16 v[88:91], a[160:163], v[128:131], 0
    s_waitcnt lgkmcnt(12)
    ds_read_b64_tr_b16 a[208:209], v12 offset:32768
    v_mfma_f32_16x16x32_bf16 v[88:91], a[164:167], v[144:147], v[88:91]
    s_waitcnt lgkmcnt(11)
    ds_read_b64_tr_b16 a[210:211], v12 offset:36864
    v_mfma_f32_16x16x32_bf16 v[88:91], a[168:171], v[192:195], v[88:91]
    s_waitcnt lgkmcnt(10)
    ds_read_b64_tr_b16 a[212:213], v12 offset:40960
    v_mfma_f32_16x16x32_bf16 v[88:91], a[172:175], v[176:179], v[88:91]
    s_waitcnt lgkmcnt(9)
    ds_read_b64_tr_b16 a[214:215], v12 offset:45056
    v_mfma_f32_16x16x32_bf16 v[88:91], a[176:179], v[136:139], v[88:91]
    s_waitcnt lgkmcnt(8)
    ds_read_b64_tr_b16 a[216:217], v12 offset:49152
    v_mfma_f32_16x16x32_bf16 v[88:91], a[180:183], v[152:155], v[88:91]
    s_waitcnt lgkmcnt(7)
    ds_read_b64_tr_b16 a[218:219], v12 offset:53248
    v_mfma_f32_16x16x32_bf16 v[88:91], a[184:187], v[200:203], v[88:91]
    s_waitcnt lgkmcnt(6)
    s_add_u32 s49, s46, 768
    ds_read_b64_tr_b16 a[220:221], v12 offset:57344
    v_mfma_f32_16x16x32_bf16 v[88:91], a[188:191], v[184:187], v[88:91]
    s_add_u32 m0, s42, 0
    ds_read_b64_tr_b16 a[222:223], v12 offset:61440
    v_mfma_f32_16x16x32_bf16 v[92:95], a[188:191], v[188:191], 0
    buffer_load_dwordx4 v46, s[20:23], s49 offen lds
    v_mfma_f32_16x16x32_bf16 v[92:95], a[184:187], v[204:207], v[92:95]
    ds_read_b64_tr_b16 a[224:225], v16 offset:32768
    ds_read_b64_tr_b16 a[226:227], v16 offset:36864
    v_mfma_f32_16x16x32_bf16 v[92:95], a[180:183], v[156:159], v[92:95]
    buffer_load_dwordx4 v47, s[20:23], s49 offen offset:1024 lds
    v_mfma_f32_16x16x32_bf16 v[92:95], a[176:179], v[140:143], v[92:95]
    ds_read_b64_tr_b16 a[228:229], v16 offset:40960
    ds_read_b64_tr_b16 a[230:231], v16 offset:45056
    v_mfma_f32_16x16x32_bf16 v[92:95], a[172:175], v[180:183], v[92:95]
    ds_read_b64_tr_b16 a[232:233], v16 offset:49152
    v_mfma_f32_16x16x32_bf16 v[92:95], a[168:171], v[196:199], v[92:95]
    ds_read_b64_tr_b16 a[234:235], v16 offset:53248
    v_mfma_f32_16x16x32_bf16 v[92:95], a[164:167], v[148:151], v[92:95]
    ds_read_b64_tr_b16 a[236:237], v16 offset:57344
    v_mfma_f32_16x16x32_bf16 v[92:95], a[160:163], v[132:135], v[92:95]
    s_waitcnt lgkmcnt(13)
    ds_read_b64_tr_b16 a[238:239], v16 offset:61440
    v_mfma_f32_16x16x32_bf16 v[64:67], a[208:211], a[64:67], v[64:67]
    s_waitcnt lgkmcnt(12)
    buffer_load_dwordx4 v48, s[20:23], s49 offen offset:2048 lds
    v_mfma_f32_16x16x32_bf16 v[64:67], a[212:215], a[68:71], v[64:67]
    s_waitcnt lgkmcnt(10)
    ds_read_b64_tr_b16 a[160:161], v13 offset:32768
    ds_read_b64_tr_b16 a[162:163], v13 offset:36864
    v_mfma_f32_16x16x32_bf16 v[64:67], a[216:219], a[72:75], v[64:67]
    s_waitcnt lgkmcnt(10)
    s_add_u32 s92, s92, 16
    buffer_load_dwordx4 v49, s[20:23], s49 offen offset:3072 lds
    v_mfma_f32_16x16x32_bf16 v[64:67], a[220:223], a[76:79], v[64:67]
    s_waitcnt lgkmcnt(8)
    s_waitcnt vmcnt(9)
    ds_read_b64_tr_b16 a[164:165], v13 offset:40960
    ds_read_b64_tr_b16 a[166:167], v13 offset:45056
    v_mfma_f32_16x16x32_bf16 v[64:67], a[224:227], a[80:83], v[64:67]
    s_waitcnt lgkmcnt(8)
    buffer_store_dword v10, v8, s[24:27], s92 offen sc1
    v_mfma_f32_16x16x32_bf16 v[64:67], a[228:231], a[84:87], v[64:67]
    s_waitcnt lgkmcnt(6)
    ds_read_b64_tr_b16 a[168:169], v13 offset:49152
    ds_read_b64_tr_b16 a[170:171], v13 offset:53248
    v_mfma_f32_16x16x32_bf16 v[64:67], a[232:235], a[88:91], v[64:67]
    s_waitcnt lgkmcnt(6)
    s_add_u32 s49, s46, 74496
    ds_read_b64_tr_b16 a[172:173], v13 offset:57344
    v_mfma_f32_16x16x32_bf16 v[64:67], a[236:239], a[92:95], v[64:67]
    s_add_u32 m0, s42, 16384
    ds_read_b64_tr_b16 a[174:175], v13 offset:61440
    v_mfma_f32_16x16x32_bf16 v[68:71], a[236:239], a[124:127], v[68:71]
    buffer_load_dwordx4 v46, s[20:23], s49 offen lds
    v_mfma_f32_16x16x32_bf16 v[68:71], a[232:235], a[120:123], v[68:71]
    ds_read_b64_tr_b16 a[176:177], v17 offset:32768
    ds_read_b64_tr_b16 a[178:179], v17 offset:36864
    v_mfma_f32_16x16x32_bf16 v[68:71], a[228:231], a[116:119], v[68:71]
    buffer_load_dwordx4 v47, s[20:23], s49 offen offset:1024 lds
    v_mfma_f32_16x16x32_bf16 v[68:71], a[224:227], a[112:115], v[68:71]
    ds_read_b64_tr_b16 a[180:181], v17 offset:40960
    ds_read_b64_tr_b16 a[182:183], v17 offset:45056
    v_mfma_f32_16x16x32_bf16 v[68:71], a[220:223], a[108:111], v[68:71]
    ds_read_b64_tr_b16 a[184:185], v17 offset:49152
    v_cvt_pk_bf16_f32 v224, v64, v65
    v_mfma_f32_16x16x32_bf16 v[68:71], a[216:219], a[104:107], v[68:71]
    ds_read_b64_tr_b16 a[186:187], v17 offset:53248
    v_cvt_pk_bf16_f32 v225, v66, v67
    v_mfma_f32_16x16x32_bf16 v[68:71], a[212:215], a[100:103], v[68:71]
    ds_read_b64_tr_b16 a[188:189], v17 offset:57344
    v_mfma_f32_16x16x32_bf16 v[68:71], a[208:211], a[96:99], v[68:71]
    s_waitcnt lgkmcnt(13)
    ds_read_b64_tr_b16 a[190:191], v17 offset:61440
    v_mfma_f32_16x16x32_bf16 v[72:75], a[160:163], a[64:67], v[72:75]
    s_waitcnt lgkmcnt(12)
    buffer_load_dwordx4 v48, s[20:23], s49 offen offset:2048 lds
    v_mfma_f32_16x16x32_bf16 v[72:75], a[164:167], a[68:71], v[72:75]
    s_waitcnt lgkmcnt(10)
    ds_read_b64_tr_b16 a[208:209], v14 offset:32768
    ds_read_b64_tr_b16 a[210:211], v14 offset:36864
    v_mfma_f32_16x16x32_bf16 v[72:75], a[168:171], a[72:75], v[72:75]
    s_waitcnt lgkmcnt(10)
    buffer_load_dwordx4 v49, s[20:23], s49 offen offset:3072 lds
    v_mfma_f32_16x16x32_bf16 v[72:75], a[172:175], a[76:79], v[72:75]
    s_waitcnt lgkmcnt(8)
    ds_read_b64_tr_b16 a[212:213], v14 offset:40960
    ds_read_b64_tr_b16 a[214:215], v14 offset:45056
    v_mfma_f32_16x16x32_bf16 v[72:75], a[176:179], a[80:83], v[72:75]
    s_waitcnt lgkmcnt(8)
    ds_read_b64_tr_b16 a[216:217], v14 offset:49152
    v_cvt_pk_bf16_f32 v228, v68, v69
    v_mfma_f32_16x16x32_bf16 v[72:75], a[180:183], a[84:87], v[72:75]
    s_waitcnt lgkmcnt(7)
    ds_read_b64_tr_b16 a[218:219], v14 offset:53248
    v_cvt_pk_bf16_f32 v229, v70, v71
    v_mfma_f32_16x16x32_bf16 v[72:75], a[184:187], a[88:91], v[72:75]
    s_waitcnt lgkmcnt(6)
    s_and_b32 s42, s2, 7
    ds_read_b64_tr_b16 a[220:221], v14 offset:57344
    v_mfma_f32_16x16x32_bf16 v[72:75], a[188:191], a[92:95], v[72:75]
    s_mov_b64 s[20:21], s[52:53]
    ds_read_b64_tr_b16 a[222:223], v14 offset:61440
    v_mfma_f32_16x16x32_bf16 v[76:79], a[188:191], a[124:127], v[76:79]
    ds_read_b64_tr_b16 a[224:225], v18 offset:32768
    s_waitcnt vmcnt(9)
    v_readfirstlane_b32 s37, v63
    v_mfma_f32_16x16x32_bf16 v[76:79], a[184:187], a[120:123], v[76:79]
    s_mov_b32 s22, 1152
    ds_read_b64_tr_b16 a[226:227], v18 offset:36864
    v_mfma_f32_16x16x32_bf16 v[76:79], a[180:183], a[116:119], v[76:79]
    s_mov_b32 s23, 0x20000
    ds_read_b64_tr_b16 a[228:229], v18 offset:40960
    s_cmp_lt_u32 s37, 256
    s_cbranch_scc1 Lattn_armwait
Lattn_armed:
    v_mfma_f32_16x16x32_bf16 v[76:79], a[176:179], a[112:115], v[76:79]
    ds_read_b64_tr_b16 a[230:231], v18 offset:45056
    v_mfma_f32_16x16x32_bf16 v[76:79], a[172:175], a[108:111], v[76:79]
    ds_read_b64_tr_b16 a[232:233], v18 offset:49152
    v_cvt_pk_bf16_f32 v226, v72, v73
    v_mfma_f32_16x16x32_bf16 v[76:79], a[168:171], a[104:107], v[76:79]
    s_add_u32 s38, s93, 1024
    ds_read_b64_tr_b16 a[234:235], v18 offset:53248
    v_cvt_pk_bf16_f32 v227, v74, v75
    v_mfma_f32_16x16x32_bf16 v[76:79], a[164:167], a[100:103], v[76:79]
    buffer_store_dwordx4 v[224:227], v56, s[28:31], s38 offen sc1
    v_mfma_f32_16x16x32_bf16 v[76:79], a[160:163], a[96:99], v[76:79]
    s_waitcnt lgkmcnt(12)
    s_mov_b32 s45, 18688
    ds_read_b64_tr_b16 a[236:237], v18 offset:57344
    ds_read_b64_tr_b16 a[238:239], v18 offset:61440
    v_mfma_f32_16x16x32_bf16 v[80:83], a[208:211], a[64:67], v[80:83]
    s_waitcnt lgkmcnt(12)
    buffer_load_dwordx4 v[160:163], v5, s[24:27], s45 offen offset:0 sc1
    v_mfma_f32_16x16x32_bf16 v[80:83], a[212:215], a[68:71], v[80:83]
    s_waitcnt lgkmcnt(10)
    ds_read_b64_tr_b16 a[160:161], v15 offset:32768
    ds_read_b64_tr_b16 a[162:163], v15 offset:36864
    v_mfma_f32_16x16x32_bf16 v[80:83], a[216:219], a[72:75], v[80:83]
    s_waitcnt lgkmcnt(10)
    buffer_load_dwordx4 v[164:167], v5, s[24:27], s45 offen offset:512 sc1
    v_mfma_f32_16x16x32_bf16 v[80:83], a[220:223], a[76:79], v[80:83]
    s_waitcnt lgkmcnt(8)
    ds_read_b64_tr_b16 a[164:165], v15 offset:40960
    ds_read_b64_tr_b16 a[166:167], v15 offset:45056
    v_mfma_f32_16x16x32_bf16 v[80:83], a[224:227], a[80:83], v[80:83]
    s_waitcnt lgkmcnt(8)
    ds_read_b64_tr_b16 a[168:169], v15 offset:49152
    v_cvt_pk_bf16_f32 v230, v76, v77
    v_mfma_f32_16x16x32_bf16 v[80:83], a[228:231], a[84:87], v[80:83]
    s_waitcnt lgkmcnt(7)
    s_add_u32 s38, s93, 165888
    ds_read_b64_tr_b16 a[170:171], v15 offset:53248
    v_cvt_pk_bf16_f32 v231, v78, v79
    v_mfma_f32_16x16x32_bf16 v[80:83], a[232:235], a[88:91], v[80:83]
    s_waitcnt lgkmcnt(6)
    buffer_store_dwordx4 v[228:231], v56, s[28:31], s38 offen sc1
    v_mfma_f32_16x16x32_bf16 v[80:83], a[236:239], a[92:95], v[80:83]
    ds_read_b64_tr_b16 a[172:173], v15 offset:57344
    ds_read_b64_tr_b16 a[174:175], v15 offset:61440
    v_mfma_f32_16x16x32_bf16 v[84:87], a[236:239], a[124:127], v[84:87]
    ds_read_b64_tr_b16 a[176:177], v19 offset:32768
    v_mfma_f32_16x16x32_bf16 v[84:87], a[232:235], a[120:123], v[84:87]
    ds_read_b64_tr_b16 a[178:179], v19 offset:36864
    v_mfma_f32_16x16x32_bf16 v[84:87], a[228:231], a[116:119], v[84:87]
    buffer_load_dwordx4 v[168:171], v59, s[24:27], s45 offen offset:1024 sc1
    v_mfma_f32_16x16x32_bf16 v[84:87], a[224:227], a[112:115], v[84:87]
    ds_read_b64_tr_b16 a[180:181], v19 offset:40960
    ds_read_b64_tr_b16 a[182:183], v19 offset:45056
    v_mfma_f32_16x16x32_bf16 v[84:87], a[220:223], a[108:111], v[84:87]
    ds_read_b64_tr_b16 a[184:185], v19 offset:49152
    v_cvt_pk_bf16_f32 v232, v80, v81
    v_mfma_f32_16x16x32_bf16 v[84:87], a[216:219], a[104:107], v[84:87]
    s_mov_b32 s45, 20992
    ds_read_b64_tr_b16 a[186:187], v19 offset:53248
    v_cvt_pk_bf16_f32 v233, v82, v83
    v_mfma_f32_16x16x32_bf16 v[84:87], a[212:215], a[100:103], v[84:87]
    buffer_load_dwordx4 v[172:175], v5, s[24:27], s45 offen offset:0 sc1
    v_mfma_f32_16x16x32_bf16 v[84:87], a[208:211], a[96:99], v[84:87]
    s_waitcnt lgkmcnt(12)
    ds_read_b64_tr_b16 a[188:189], v19 offset:57344
    ds_read_b64_tr_b16 a[190:191], v19 offset:61440
    s_barrier
    v_mfma_f32_16x16x32_bf16 v[88:91], a[160:163], a[64:67], v[88:91]
    s_waitcnt lgkmcnt(12)
    ds_read_b64_tr_b16 a[208:209], v20 offset:32768
    v_mfma_f32_16x16x32_bf16 v[88:91], a[164:167], a[68:71], v[88:91]
    s_waitcnt lgkmcnt(11)
    ds_read_b64_tr_b16 a[210:211], v20 offset:36864
    v_mfma_f32_16x16x32_bf16 v[88:91], a[168:171], a[72:75], v[88:91]
    s_waitcnt lgkmcnt(10)
    buffer_load_dwordx4 v[208:211], v5, s[24:27], s45 offen offset:512 sc1
    v_mfma_f32_16x16x32_bf16 v[88:91], a[172:175], a[76:79], v[88:91]
    s_waitcnt lgkmcnt(8)
    ds_read_b64_tr_b16 a[212:213], v20 offset:40960
    ds_read_b64_tr_b16 a[214:215], v20 offset:45056
    v_mfma_f32_16x16x32_bf16 v[88:91], a[176:179], a[80:83], v[88:91]
    s_waitcnt lgkmcnt(8)
    s_add_u32 s57, s59, 4096
    ds_read_b64_tr_b16 a[216:217], v20 offset:49152
    v_cvt_pk_bf16_f32 v236, v84, v85
    v_mfma_f32_16x16x32_bf16 v[88:91], a[180:183], a[84:87], v[88:91]
    s_waitcnt lgkmcnt(7)
    s_add_u32 m0, s6, -98304
    ds_read_b64_tr_b16 a[218:219], v20 offset:53248
    v_cvt_pk_bf16_f32 v237, v86, v87
    v_mfma_f32_16x16x32_bf16 v[88:91], a[184:187], a[88:91], v[88:91]
    s_waitcnt lgkmcnt(6)
    buffer_load_dwordx4 v255, s[84:87], s57 offen lds
    v_mfma_f32_16x16x32_bf16 v[88:91], a[188:191], a[92:95], v[88:91]
    ds_read_b64_tr_b16 a[220:221], v20 offset:57344
    ds_read_b64_tr_b16 a[222:223], v20 offset:61440
    v_mfma_f32_16x16x32_bf16 v[92:95], a[188:191], a[124:127], v[92:95]
    s_add_u32 s57, s59, 8192
    buffer_load_dwordx4 v[212:215], v59, s[24:27], s45 offen offset:1024 sc1
    v_mfma_f32_16x16x32_bf16 v[92:95], a[184:187], a[120:123], v[92:95]
    s_add_u32 m0, s6, -94208
    ds_read_b64_tr_b16 a[224:225], v24 offset:32768
    ds_read_b64_tr_b16 a[226:227], v24 offset:36864
    v_mfma_f32_16x16x32_bf16 v[92:95], a[180:183], a[116:119], v[92:95]
    buffer_load_dwordx4 v255, s[84:87], s57 offen lds
    v_mfma_f32_16x16x32_bf16 v[92:95], a[176:179], a[112:115], v[92:95]
    ds_read_b64_tr_b16 a[228:229], v24 offset:40960
    ds_read_b64_tr_b16 a[230:231], v24 offset:45056
    v_mfma_f32_16x16x32_bf16 v[92:95], a[172:175], a[108:111], v[92:95]
    ds_read_b64_tr_b16 a[232:233], v24 offset:49152
    v_cvt_pk_bf16_f32 v234, v88, v89
    v_mfma_f32_16x16x32_bf16 v[92:95], a[168:171], a[104:107], v[92:95]
    s_add_u32 s38, s93, 1152
    ds_read_b64_tr_b16 a[234:235], v24 offset:53248
    v_cvt_pk_bf16_f32 v235, v90, v91
    v_mfma_f32_16x16x32_bf16 v[92:95], a[164:167], a[100:103], v[92:95]
    buffer_store_dwordx4 v[232:235], v56, s[28:31], s38 offen sc1
    v_mfma_f32_16x16x32_bf16 v[92:95], a[160:163], a[96:99], v[92:95]
    s_waitcnt lgkmcnt(12)
    ds_read_b64_tr_b16 a[236:237], v24 offset:57344
    ds_read_b64_tr_b16 a[238:239], v24 offset:61440
    v_mfma_f32_16x16x32_bf16 v[96:99], a[208:211], v[128:131], 0
    s_waitcnt lgkmcnt(12)
    s_add_u32 s57, s59, 12288
    ds_read_b64_tr_b16 a[160:161], v21 offset:32768
    v_mfma_f32_16x16x32_bf16 v[96:99], a[212:215], v[144:147], v[96:99]
    s_waitcnt lgkmcnt(11)
    s_add_u32 m0, s6, -90112
    ds_read_b64_tr_b16 a[162:163], v21 offset:36864
    v_mfma_f32_16x16x32_bf16 v[96:99], a[216:219], v[192:195], v[96:99]
    s_waitcnt lgkmcnt(10)
    buffer_load_dwordx4 v255, s[84:87], s57 offen lds
    v_mfma_f32_16x16x32_bf16 v[96:99], a[220:223], v[176:179], v[96:99]
    s_waitcnt lgkmcnt(8)
    ds_read_b64_tr_b16 a[164:165], v21 offset:40960
    ds_read_b64_tr_b16 a[166:167], v21 offset:45056
    v_mfma_f32_16x16x32_bf16 v[96:99], a[224:227], v[136:139], v[96:99]
    s_waitcnt lgkmcnt(8)
    ds_read_b64_tr_b16 a[168:169], v21 offset:49152
    v_cvt_pk_bf16_f32 v238, v92, v93
    v_mfma_f32_16x16x32_bf16 v[96:99], a[228:231], v[152:155], v[96:99]
    s_waitcnt lgkmcnt(7)
    s_add_u32 s38, s93, 166016
    ds_read_b64_tr_b16 a[170:171], v21 offset:53248
    v_cvt_pk_bf16_f32 v239, v94, v95
    v_mfma_f32_16x16x32_bf16 v[96:99], a[232:235], v[200:203], v[96:99]
    s_waitcnt lgkmcnt(6)
    buffer_store_dwordx4 v[236:239], v56, s[28:31], s38 offen sc1
    v_mfma_f32_16x16x32_bf16 v[96:99], a[236:239], v[184:187], v[96:99]
    ds_read_b64_tr_b16 a[172:173], v21 offset:57344
    ds_read_b64_tr_b16 a[174:175], v21 offset:61440
    v_mfma_f32_16x16x32_bf16 v[100:103], a[236:239], v[188:191], 0
    s_add_u32 s57, s59, 16384
    buffer_load_dwordx2 v[92:93], v58, s[12:15], 0 offen offset:1024
    v_mfma_f32_16x16x32_bf16 v[100:103], a[232:235], v[204:207], v[100:103]
    s_add_u32 m0, s6, -86016
    ds_read_b64_tr_b16 a[176:177], v25 offset:32768
    ds_read_b64_tr_b16 a[178:179], v25 offset:36864
    v_mfma_f32_16x16x32_bf16 v[100:103], a[228:231], v[156:159], v[100:103]
    buffer_load_dwordx4 v255, s[84:87], s57 offen lds
    v_mfma_f32_16x16x32_bf16 v[100:103], a[224:227], v[140:143], v[100:103]
    ds_read_b64_tr_b16 a[180:181], v25 offset:40960
    ds_read_b64_tr_b16 a[182:183], v25 offset:45056
    v_mfma_f32_16x16x32_bf16 v[100:103], a[220:223], v[180:183], v[100:103]
    ds_read_b64_tr_b16 a[184:185], v25 offset:49152
    v_mfma_f32_16x16x32_bf16 v[100:103], a[216:219], v[196:199], v[100:103]
    ds_read_b64_tr_b16 a[186:187], v25 offset:53248
    v_mfma_f32_16x16x32_bf16 v[100:103], a[212:215], v[148:151], v[100:103]
    buffer_load_dwordx2 v[94:95], v58, s[12:15], 0 offen offset:1056
    v_mfma_f32_16x16x32_bf16 v[100:103], a[208:211], v[132:135], v[100:103]
    s_waitcnt lgkmcnt(12)
    ds_read_b64_tr_b16 a[188:189], v25 offset:57344
    ds_read_b64_tr_b16 a[190:191], v25 offset:61440
    v_mfma_f32_16x16x32_bf16 v[104:107], a[160:163], v[128:131], 0
    s_waitcnt lgkmcnt(12)
    s_add_u32 s57, s59, 20480
    ds_read_b64_tr_b16 a[208:209], v22 offset:32768
    v_mfma_f32_16x16x32_bf16 v[104:107], a[164:167], v[144:147], v[104:107]
    s_waitcnt lgkmcnt(11)
    s_add_u32 m0, s6, -81920
    ds_read_b64_tr_b16 a[210:211], v22 offset:36864
    v_mfma_f32_16x16x32_bf16 v[104:107], a[168:171], v[192:195], v[104:107]
    s_waitcnt lgkmcnt(10)
    buffer_load_dwordx4 v255, s[84:87], s57 offen lds
    v_mfma_f32_16x16x32_bf16 v[104:107], a[172:175], v[176:179], v[104:107]
    s_waitcnt lgkmcnt(8)
    s_mov_b32 s45, 19840
    ds_read_b64_tr_b16 a[212:213], v22 offset:40960
    ds_read_b64_tr_b16 a[214:215], v22 offset:45056
    v_mfma_f32_16x16x32_bf16 v[104:107], a[176:179], v[136:139], v[104:107]
    s_waitcnt lgkmcnt(8)
    s_add_u32 s57, s59, 24576
    buffer_load_dwordx4 v[64:67], v5, s[24:27], s45 offen offset:0 sc1
    v_mfma_f32_16x16x32_bf16 v[104:107], a[180:183], v[152:155], v[104:107]
    s_waitcnt lgkmcnt(6)
    s_add_u32 m0, s6, -77824
    ds_read_b64_tr_b16 a[216:217], v22 offset:49152
    ds_read_b64_tr_b16 a[218:219], v22 offset:53248
    v_mfma_f32_16x16x32_bf16 v[104:107], a[184:187], v[200:203], v[104:107]
    s_waitcnt lgkmcnt(6)
    buffer_load_dwordx4 v255, s[84:87], s57 offen lds
    v_mfma_f32_16x16x32_bf16 v[104:107], a[188:191], v[184:187], v[104:107]
    ds_read_b64_tr_b16 a[220:221], v22 offset:57344
    ds_read_b64_tr_b16 a[222:223], v22 offset:61440
    v_mfma_f32_16x16x32_bf16 v[108:111], a[188:191], v[188:191], 0
    s_add_u32 s57, s59, 28672
    ds_read_b64_tr_b16 a[224:225], v26 offset:32768
    v_mfma_f32_16x16x32_bf16 v[108:111], a[184:187], v[204:207], v[108:111]
    s_add_u32 m0, s6, -73728
    ds_read_b64_tr_b16 a[226:227], v26 offset:36864
    v_mfma_f32_16x16x32_bf16 v[108:111], a[180:183], v[156:159], v[108:111]
    buffer_load_dwordx4 v255, s[84:87], s57 offen lds
    v_mfma_f32_16x16x32_bf16 v[108:111], a[176:179], v[140:143], v[108:111]
    ds_read_b64_tr_b16 a[228:229], v26 offset:40960
    ds_read_b64_tr_b16 a[230:231], v26 offset:45056
    v_mfma_f32_16x16x32_bf16 v[108:111], a[172:175], v[180:183], v[108:111]
    s_add_u32 s57, s59, 32768
    buffer_load_dwordx4 v[68:71], v5, s[24:27], s45 offen offset:512 sc1
    v_mfma_f32_16x16x32_bf16 v[108:111], a[168:171], v[196:199], v[108:111]
    s_add_u32 m0, s6, -69632
    ds_read_b64_tr_b16 a[232:233], v26 offset:49152
    ds_read_b64_tr_b16 a[234:235], v26 offset:53248
    v_mfma_f32_16x16x32_bf16 v[108:111], a[164:167], v[148:151], v[108:111]
    buffer_load_dwordx4 v255, s[84:87], s57 offen lds
    v_mfma_f32_16x16x32_bf16 v[108:111], a[160:163], v[132:135], v[108:111]
    s_waitcnt lgkmcnt(12)
    ds_read_b64_tr_b16 a[236:237], v26 offset:57344
    ds_read_b64_tr_b16 a[238:239], v26 offset:61440
    v_mfma_f32_16x16x32_bf16 v[112:115], a[208:211], v[128:131], 0
    s_waitcnt lgkmcnt(12)
    ds_read_b64_tr_b16 a[160:161], v23 offset:32768
    v_mfma_f32_16x16x32_bf16 v[112:115], a[212:215], v[144:147], v[112:115]
    s_waitcnt lgkmcnt(11)
    ds_read_b64_tr_b16 a[162:163], v23 offset:36864
    v_mfma_f32_16x16x32_bf16 v[112:115], a[216:219], v[192:195], v[112:115]
    s_waitcnt lgkmcnt(10)
    ds_read_b64_tr_b16 a[164:165], v23 offset:40960
    v_mfma_f32_16x16x32_bf16 v[112:115], a[220:223], v[176:179], v[112:115]
    s_waitcnt lgkmcnt(9)
    ds_read_b64_tr_b16 a[166:167], v23 offset:45056
    v_mfma_f32_16x16x32_bf16 v[112:115], a[224:227], v[136:139], v[112:115]
    s_waitcnt lgkmcnt(8)
    buffer_load_dwordx4 v[72:75], v59, s[24:27], s45 offen offset:1024 sc1
    v_mfma_f32_16x16x32_bf16 v[112:115], a[228:231], v[152:155], v[112:115]
    s_waitcnt lgkmcnt(6)
    ds_read_b64_tr_b16 a[168:169], v23 offset:49152
    ds_read_b64_tr_b16 a[170:171], v23 offset:53248
    v_mfma_f32_16x16x32_bf16 v[112:115], a[232:235], v[200:203], v[112:115]
    s_waitcnt lgkmcnt(6)
    ds_read_b64_tr_b16 a[172:173], v23 offset:57344
    v_mfma_f32_16x16x32_bf16 v[112:115], a[236:239], v[184:187], v[112:115]
    ds_read_b64_tr_b16 a[174:175], v23 offset:61440
    v_mfma_f32_16x16x32_bf16 v[116:119], a[236:239], v[188:191], 0
    buffer_load_dwordx2 v[76:77], v3, s[20:23], 0 offen offset:0
    v_mfma_f32_16x16x32_bf16 v[116:119], a[232:235], v[204:207], v[116:119]
    ds_read_b64_tr_b16 a[176:177], v27 offset:32768
    ds_read_b64_tr_b16 a[178:179], v27 offset:36864
    v_mfma_f32_16x16x32_bf16 v[116:119], a[228:231], v[156:159], v[116:119]
    ds_read_b64_tr_b16 a[180:181], v27 offset:40960
    v_mfma_f32_16x16x32_bf16 v[116:119], a[224:227], v[140:143], v[116:119]
    ds_read_b64_tr_b16 a[182:183], v27 offset:45056
    v_mfma_f32_16x16x32_bf16 v[116:119], a[220:223], v[180:183], v[116:119]
    buffer_load_dwordx2 v[78:79], v3, s[20:23], 0 offen offset:32
    v_mfma_f32_16x16x32_bf16 v[116:119], a[216:219], v[196:199], v[116:119]
    ds_read_b64_tr_b16 a[184:185], v27 offset:49152
    ds_read_b64_tr_b16 a[186:187], v27 offset:53248
    v_mfma_f32_16x16x32_bf16 v[116:119], a[212:215], v[148:151], v[116:119]
    ds_read_b64_tr_b16 a[188:189], v27 offset:57344
    v_mfma_f32_16x16x32_bf16 v[116:119], a[208:211], v[132:135], v[116:119]
    ds_read_b64_tr_b16 a[190:191], v27 offset:61440
    s_waitcnt vmcnt(25)
    s_waitcnt lgkmcnt(0)
    s_barrier
    v_mfma_f32_16x16x32_bf16 v[120:123], a[160:163], v[128:131], 0
    ds_read_b64_tr_b16 a[208:209], v12 offset:0
    v_mfma_f32_16x16x32_bf16 v[120:123], a[164:167], v[144:147], v[120:123]
    ds_read_b64_tr_b16 a[210:211], v12 offset:4096
    v_mfma_f32_16x16x32_bf16 v[120:123], a[168:171], v[192:195], v[120:123]
    buffer_load_dwordx2 v[80:81], v3, s[20:23], 0 offen offset:512
    v_mfma_f32_16x16x32_bf16 v[120:123], a[172:175], v[176:179], v[120:123]
    s_add_u32 s39, s39, 16
    ds_read_b64_tr_b16 a[212:213], v12 offset:8192
    ds_read_b64_tr_b16 a[214:215], v12 offset:12288
    v_mfma_f32_16x16x32_bf16 v[120:123], a[176:179], v[136:139], v[120:123]
    buffer_load_dword v11, v9, s[24:27], s39 offen sc1
    v_mfma_f32_16x16x32_bf16 v[120:123], a[180:183], v[152:155], v[120:123]
    ds_read_b64_tr_b16 a[216:217], v12 offset:16384
    ds_read_b64_tr_b16 a[218:219], v12 offset:20480
    v_mfma_f32_16x16x32_bf16 v[120:123], a[184:187], v[200:203], v[120:123]
    ds_read_b64_tr_b16 a[220:221], v12 offset:24576
    v_mfma_f32_16x16x32_bf16 v[120:123], a[188:191], v[184:187], v[120:123]
    ds_read_b64_tr_b16 a[222:223], v12 offset:28672
    v_mfma_f32_16x16x32_bf16 v[124:127], a[188:191], v[188:191], 0
    buffer_load_dwordx2 v[82:83], v3, s[20:23], 0 offen offset:544
    v_mfma_f32_16x16x32_bf16 v[124:127], a[184:187], v[204:207], v[124:127]
    ds_read_b64_tr_b16 a[224:225], v16 offset:0
    ds_read_b64_tr_b16 a[226:227], v16 offset:4096
    v_mfma_f32_16x16x32_bf16 v[124:127], a[180:183], v[156:159], v[124:127]
    ds_read_b64_tr_b16 a[228:229], v16 offset:8192
    v_mfma_f32_16x16x32_bf16 v[124:127], a[176:179], v[140:143], v[124:127]
    ds_read_b64_tr_b16 a[230:231], v16 offset:12288
    v_mfma_f32_16x16x32_bf16 v[124:127], a[172:175], v[180:183], v[124:127]
    buffer_load_dwordx2 v[84:85], v55, s[20:23], 0 offen offset:1024
    v_mfma_f32_16x16x32_bf16 v[124:127], a[168:171], v[196:199], v[124:127]
    ds_read_b64_tr_b16 a[232:233], v16 offset:16384
    ds_read_b64_tr_b16 a[234:235], v16 offset:20480
    v_mfma_f32_16x16x32_bf16 v[124:127], a[164:167], v[148:151], v[124:127]
    ds_read_b64_tr_b16 a[236:237], v16 offset:24576
    v_mfma_f32_16x16x32_bf16 v[124:127], a[160:163], v[132:135], v[124:127]
    s_waitcnt lgkmcnt(13)
    ds_read_b64_tr_b16 a[238:239], v16 offset:28672
    v_mfma_f32_16x16x32_bf16 v[96:99], a[208:211], a[64:67], v[96:99]
    s_waitcnt lgkmcnt(12)
    buffer_load_dwordx2 v[86:87], v55, s[20:23], 0 offen offset:1056
    v_mfma_f32_16x16x32_bf16 v[96:99], a[212:215], a[68:71], v[96:99]
    s_waitcnt lgkmcnt(10)
    ds_read_b64_tr_b16 a[160:161], v13 offset:0
    ds_read_b64_tr_b16 a[162:163], v13 offset:4096
    v_mfma_f32_16x16x32_bf16 v[96:99], a[216:219], a[72:75], v[96:99]
    s_waitcnt lgkmcnt(10)
    ds_read_b64_tr_b16 a[164:165], v13 offset:8192
    v_mfma_f32_16x16x32_bf16 v[96:99], a[220:223], a[76:79], v[96:99]
    s_waitcnt lgkmcnt(9)
    ds_read_b64_tr_b16 a[166:167], v13 offset:12288
    v_mfma_f32_16x16x32_bf16 v[96:99], a[224:227], a[80:83], v[96:99]
    s_waitcnt lgkmcnt(8)
    ds_read_b64_tr_b16 a[168:169], v13 offset:16384
    v_mfma_f32_16x16x32_bf16 v[96:99], a[228:231], a[84:87], v[96:99]
Ltour0_11:
    s_cbranch_execz Lmain0
    s_waitcnt lgkmcnt(7)
    s_mov_b32 s45, 22144
    ds_read_b64_tr_b16 a[170:171], v13 offset:20480
    v_mfma_f32_16x16x32_bf16 v[96:99], a[232:235], a[88:91], v[96:99]
    s_waitcnt lgkmcnt(6)
    buffer_load_dwordx4 v[216:219], v5, s[24:27], s45 offen offset:0 sc1
    v_mfma_f32_16x16x32_bf16 v[96:99], a[236:239], a[92:95], v[96:99]
    ds_read_b64_tr_b16 a[172:173], v13 offset:24576
    ds_read_b64_tr_b16 a[174:175], v13 offset:28672
    v_mfma_f32_16x16x32_bf16 v[100:103], a[236:239], a[124:127], v[100:103]
    ds_read_b64_tr_b16 a[176:177], v17 offset:0
    v_mfma_f32_16x16x32_bf16 v[100:103], a[232:235], a[120:123], v[100:103]
    ds_read_b64_tr_b16 a[178:179], v17 offset:4096
    v_mfma_f32_16x16x32_bf16 v[100:103], a[228:231], a[116:119], v[100:103]
    buffer_load_dwordx4 v[220:223], v5, s[24:27], s45 offen offset:512 sc1
    v_mfma_f32_16x16x32_bf16 v[100:103], a[224:227], a[112:115], v[100:103]
    ds_read_b64_tr_b16 a[180:181], v17 offset:8192
    ds_read_b64_tr_b16 a[182:183], v17 offset:12288
    v_mfma_f32_16x16x32_bf16 v[100:103], a[220:223], a[108:111], v[100:103]
    ds_read_b64_tr_b16 a[184:185], v17 offset:16384
    v_cvt_pk_bf16_f32 v224, v96, v97
    v_mfma_f32_16x16x32_bf16 v[100:103], a[216:219], a[104:107], v[100:103]
    ds_read_b64_tr_b16 a[186:187], v17 offset:20480
    v_cvt_pk_bf16_f32 v225, v98, v99
    v_mfma_f32_16x16x32_bf16 v[100:103], a[212:215], a[100:103], v[100:103]
    ds_read_b64_tr_b16 a[188:189], v17 offset:24576
    v_mfma_f32_16x16x32_bf16 v[100:103], a[208:211], a[96:99], v[100:103]
    s_waitcnt lgkmcnt(13)
    ds_read_b64_tr_b16 a[190:191], v17 offset:28672
    v_mfma_f32_16x16x32_bf16 v[104:107], a[160:163], a[64:67], v[104:107]
    s_waitcnt lgkmcnt(12)
    buffer_load_dwordx4 v[88:91], v59, s[24:27], s45 offen offset:1024 sc1
    v_mfma_f32_16x16x32_bf16 v[104:107], a[164:167], a[68:71], v[104:107]
    s_waitcnt lgkmcnt(10)
    ds_read_b64_tr_b16 a[208:209], v14 offset:0
    ds_read_b64_tr_b16 a[210:211], v14 offset:4096
    v_mfma_f32_16x16x32_bf16 v[104:107], a[168:171], a[72:75], v[104:107]
    s_waitcnt lgkmcnt(10)
    ds_read_b64_tr_b16 a[212:213], v14 offset:8192
    v_mfma_f32_16x16x32_bf16 v[104:107], a[172:175], a[76:79], v[104:107]
    s_waitcnt lgkmcnt(9)
    ds_read_b64_tr_b16 a[214:215], v14 offset:12288
    v_mfma_f32_16x16x32_bf16 v[104:107], a[176:179], a[80:83], v[104:107]
    s_waitcnt lgkmcnt(8)
    ds_read_b64_tr_b16 a[216:217], v14 offset:16384
    v_cvt_pk_bf16_f32 v228, v100, v101
    v_mfma_f32_16x16x32_bf16 v[104:107], a[180:183], a[84:87], v[104:107]
    s_waitcnt lgkmcnt(7)
    ds_read_b64_tr_b16 a[218:219], v14 offset:20480
    v_cvt_pk_bf16_f32 v229, v102, v103
    v_mfma_f32_16x16x32_bf16 v[104:107], a[184:187], a[88:91], v[104:107]
    s_waitcnt lgkmcnt(6)
    ds_read_b64_tr_b16 a[220:221], v14 offset:24576
    v_mfma_f32_16x16x32_bf16 v[104:107], a[188:191], a[92:95], v[104:107]
    ds_read_b64_tr_b16 a[222:223], v14 offset:28672
    v_mfma_f32_16x16x32_bf16 v[108:111], a[188:191], a[124:127], v[108:111]
    ds_read_b64_tr_b16 a[224:225], v18 offset:0
    v_mfma_f32_16x16x32_bf16 v[108:111], a[184:187], a[120:123], v[108:111]
    ds_read_b64_tr_b16 a[226:227], v18 offset:4096
    v_mfma_f32_16x16x32_bf16 v[108:111], a[180:183], a[116:119], v[108:111]
    ds_read_b64_tr_b16 a[228:229], v18 offset:8192
    v_mfma_f32_16x16x32_bf16 v[108:111], a[176:179], a[112:115], v[108:111]
    ds_read_b64_tr_b16 a[230:231], v18 offset:12288
    v_mfma_f32_16x16x32_bf16 v[108:111], a[172:175], a[108:111], v[108:111]
    ds_read_b64_tr_b16 a[232:233], v18 offset:16384
    v_cvt_pk_bf16_f32 v226, v104, v105
    v_mfma_f32_16x16x32_bf16 v[108:111], a[168:171], a[104:107], v[108:111]
    s_add_u32 s38, s93, 1536
    ds_read_b64_tr_b16 a[234:235], v18 offset:20480
    v_cvt_pk_bf16_f32 v227, v106, v107
    v_mfma_f32_16x16x32_bf16 v[108:111], a[164:167], a[100:103], v[108:111]
    buffer_store_dwordx4 v[224:227], v56, s[28:31], s38 offen sc1
    v_mfma_f32_16x16x32_bf16 v[108:111], a[160:163], a[96:99], v[108:111]
    s_waitcnt lgkmcnt(12)
    ds_read_b64_tr_b16 a[236:237], v18 offset:24576
    ds_read_b64_tr_b16 a[238:239], v18 offset:28672
    v_mfma_f32_16x16x32_bf16 v[112:115], a[208:211], a[64:67], v[112:115]
    s_waitcnt lgkmcnt(12)
    ds_read_b64_tr_b16 a[160:161], v15 offset:0
    v_mfma_f32_16x16x32_bf16 v[112:115], a[212:215], a[68:71], v[112:115]
    s_waitcnt lgkmcnt(11)
    ds_read_b64_tr_b16 a[162:163], v15 offset:4096
    v_mfma_f32_16x16x32_bf16 v[112:115], a[216:219], a[72:75], v[112:115]
    s_waitcnt lgkmcnt(10)
    ds_read_b64_tr_b16 a[164:165], v15 offset:8192
    v_mfma_f32_16x16x32_bf16 v[112:115], a[220:223], a[76:79], v[112:115]
    s_waitcnt lgkmcnt(9)
    ds_read_b64_tr_b16 a[166:167], v15 offset:12288
    v_mfma_f32_16x16x32_bf16 v[112:115], a[224:227], a[80:83], v[112:115]
    s_waitcnt lgkmcnt(8)
    ds_read_b64_tr_b16 a[168:169], v15 offset:16384
    v_cvt_pk_bf16_f32 v230, v108, v109
    v_mfma_f32_16x16x32_bf16 v[112:115], a[228:231], a[84:87], v[112:115]
    s_waitcnt lgkmcnt(7)
    s_add_u32 s38, s93, 166400
    ds_read_b64_tr_b16 a[170:171], v15 offset:20480
    v_cvt_pk_bf16_f32 v231, v110, v111
    v_mfma_f32_16x16x32_bf16 v[112:115], a[232:235], a[88:91], v[112:115]
    s_waitcnt lgkmcnt(6)
    buffer_store_dwordx4 v[228:231], v56, s[28:31], s38 offen sc1
    v_mfma_f32_16x16x32_bf16 v[112:115], a[236:239], a[92:95], v[112:115]
    ds_read_b64_tr_b16 a[172:173], v15 offset:24576
    ds_read_b64_tr_b16 a[174:175], v15 offset:28672
    v_mfma_f32_16x16x32_bf16 v[116:119], a[236:239], a[124:127], v[116:119]
    ds_read_b64_tr_b16 a[176:177], v19 offset:0
    v_mfma_f32_16x16x32_bf16 v[116:119], a[232:235], a[120:123], v[116:119]
    ds_read_b64_tr_b16 a[178:179], v19 offset:4096
    v_mfma_f32_16x16x32_bf16 v[116:119], a[228:231], a[116:119], v[116:119]
    ds_read_b64_tr_b16 a[180:181], v19 offset:8192
    v_mfma_f32_16x16x32_bf16 v[116:119], a[224:227], a[112:115], v[116:119]
    ds_read_b64_tr_b16 a[182:183], v19 offset:12288
    v_mfma_f32_16x16x32_bf16 v[116:119], a[220:223], a[108:111], v[116:119]
    ds_read_b64_tr_b16 a[184:185], v19 offset:16384
    v_cvt_pk_bf16_f32 v232, v112, v113
    v_mfma_f32_16x16x32_bf16 v[116:119], a[216:219], a[104:107], v[116:119]
    ds_read_b64_tr_b16 a[186:187], v19 offset:20480
    v_cvt_pk_bf16_f32 v233, v114, v115
    v_mfma_f32_16x16x32_bf16 v[116:119], a[212:215], a[100:103], v[116:119]
    ds_read_b64_tr_b16 a[188:189], v19 offset:24576
    v_mfma_f32_16x16x32_bf16 v[116:119], a[208:211], a[96:99], v[116:119]
    s_waitcnt lgkmcnt(13)
    ds_read_b64_tr_b16 a[190:191], v19 offset:28672
    v_mfma_f32_16x16x32_bf16 v[120:123], a[160:163], a[64:67], v[120:123]
    s_waitcnt lgkmcnt(12)
    v_mfma_f32_16x16x32_bf16 v[120:123], a[164:167], a[68:71], v[120:123]
    s_waitcnt lgkmcnt(10)
    v_mfma_f32_16x16x32_bf16 v[120:123], a[168:171], a[72:75], v[120:123]
    s_waitcnt lgkmcnt(8)
    v_mfma_f32_16x16x32_bf16 v[120:123], a[172:175], a[76:79], v[120:123]
    s_waitcnt lgkmcnt(6)
    v_mfma_f32_16x16x32_bf16 v[120:123], a[176:179], a[80:83], v[120:123]
    s_waitcnt lgkmcnt(4)
    v_cvt_pk_bf16_f32 v236, v116, v117
    v_mfma_f32_16x16x32_bf16 v[120:123], a[180:183], a[84:87], v[120:123]
    s_waitcnt lgkmcnt(2)
    v_cvt_pk_bf16_f32 v237, v118, v119
    v_mfma_f32_16x16x32_bf16 v[120:123], a[184:187], a[88:91], v[120:123]
    s_waitcnt lgkmcnt(0)
    v_mfma_f32_16x16x32_bf16 v[120:123], a[188:191], a[92:95], v[120:123]
    v_mfma_f32_16x16x32_bf16 v[124:127], a[188:191], a[124:127], v[124:127]
    v_mfma_f32_16x16x32_bf16 v[124:127], a[184:187], a[120:123], v[124:127]
    v_mfma_f32_16x16x32_bf16 v[124:127], a[180:183], a[116:119], v[124:127]
    v_mfma_f32_16x16x32_bf16 v[124:127], a[176:179], a[112:115], v[124:127]
    v_mfma_f32_16x16x32_bf16 v[124:127], a[172:175], a[108:111], v[124:127]
    s_nop 2
    v_cvt_pk_bf16_f32 v234, v120, v121
    v_mfma_f32_16x16x32_bf16 v[124:127], a[168:171], a[104:107], v[124:127]
    s_add_u32 s38, s93, 1664
    v_cvt_pk_bf16_f32 v235, v122, v123
    v_mfma_f32_16x16x32_bf16 v[124:127], a[164:167], a[100:103], v[124:127]
    buffer_store_dwordx4 v[232:235], v56, s[28:31], s38 offen sc1
    v_mfma_f32_16x16x32_bf16 v[124:127], a[160:163], a[96:99], v[124:127]
    s_nop 7
    v_cvt_pk_bf16_f32 v238, v124, v125
    s_add_u32 s38, s93, 166528
    v_cvt_pk_bf16_f32 v239, v126, v127
    buffer_store_dwordx4 v[236:239], v56, s[28:31], s38 offen sc1
    s_add_u32 s92, s92, 16
    s_waitcnt vmcnt(35)
    v_lshlrev_b32 v96, 16, v160
    v_and_b32 v97, 0xffff0000, v160
    v_lshlrev_b32 v98, 16, v161
    v_and_b32 v99, 0xffff0000, v161
    v_lshlrev_b32 v100, 16, v162
    v_and_b32 v101, 0xffff0000, v162
    v_lshlrev_b32 v102, 16, v163
    v_and_b32 v103, 0xffff0000, v163
    s_waitcnt vmcnt(34)
    v_lshlrev_b32 v104, 16, v164
    v_and_b32 v105, 0xffff0000, v164
    v_lshlrev_b32 v106, 16, v165
    v_and_b32 v107, 0xffff0000, v165
    v_lshlrev_b32 v108, 16, v166
    v_and_b32 v109, 0xffff0000, v166
    v_lshlrev_b32 v110, 16, v167
    v_and_b32 v111, 0xffff0000, v167
    s_waitcnt vmcnt(32)
    v_lshlrev_b32 v112, 16, v168
    v_and_b32 v113, 0xffff0000, v168
    v_lshlrev_b32 v114, 16, v169
    v_and_b32 v115, 0xffff0000, v169
    v_lshlrev_b32 v116, 16, v170
    v_and_b32 v117, 0xffff0000, v170
    v_lshlrev_b32 v118, 16, v171
    v_and_b32 v119, 0xffff0000, v171
    s_waitcnt vmcnt(31)
    v_lshlrev_b32 v120, 16, v172
    v_and_b32 v121, 0xffff0000, v172
    v_lshlrev_b32 v122, 16, v173
    v_and_b32 v123, 0xffff0000, v173
    v_lshlrev_b32 v124, 16, v174
    v_and_b32 v125, 0xffff0000, v174
    v_lshlrev_b32 v126, 16, v175
    v_and_b32 v127, 0xffff0000, v175
    s_waitcnt vmcnt(30)
    v_lshlrev_b32 v128, 16, v208
    v_and_b32 v129, 0xffff0000, v208
    v_lshlrev_b32 v130, 16, v209
    v_and_b32 v131, 0xffff0000, v209
    v_lshlrev_b32 v132, 16, v210
    v_and_b32 v133, 0xffff0000, v210
    v_lshlrev_b32 v134, 16, v211
    v_and_b32 v135, 0xffff0000, v211
    s_waitcnt vmcnt(28)
    v_lshlrev_b32 v136, 16, v212
    v_and_b32 v137, 0xffff0000, v212
    v_lshlrev_b32 v138, 16, v213
    v_and_b32 v139, 0xffff0000, v213
    v_lshlrev_b32 v140, 16, v214
    v_and_b32 v141, 0xffff0000, v214
    v_lshlrev_b32 v142, 16, v215
    v_and_b32 v143, 0xffff0000, v215
    s_waitcnt vmcnt(19)
    v_lshlrev_b32 v144, 16, v64
    v_and_b32 v145, 0xffff0000, v64
    v_lshlrev_b32 v146, 16, v65
    v_and_b32 v147, 0xffff0000, v65
    v_lshlrev_b32 v148, 16, v66
    v_and_b32 v149, 0xffff0000, v66
    v_lshlrev_b32 v150, 16, v67
    v_and_b32 v151, 0xffff0000, v67
    s_waitcnt vmcnt(16)
    v_lshlrev_b32 v152, 16, v68
    v_and_b32 v153, 0xffff0000, v68
    v_lshlrev_b32 v154, 16, v69
    v_and_b32 v155, 0xffff0000, v69
    v_lshlrev_b32 v156, 16, v70
    v_and_b32 v157, 0xffff0000, v70
    v_lshlrev_b32 v158, 16, v71
    v_and_b32 v159, 0xffff0000, v71
    s_waitcnt vmcnt(14)
    v_lshlrev_b32 v160, 16, v72
    v_and_b32 v161, 0xffff0000, v72
    v_lshlrev_b32 v162, 16, v73
    v_and_b32 v163, 0xffff0000, v73
    v_lshlrev_b32 v164, 16, v74
    v_and_b32 v165, 0xffff0000, v74
    v_lshlrev_b32 v166, 16, v75
    v_and_b32 v167, 0xffff0000, v75
    s_waitcnt vmcnt(13)
    v_lshlrev_b32 v168, 16, v76
    v_and_b32 v169, 0xffff0000, v76
    v_lshlrev_b32 v170, 16, v77
    v_and_b32 v171, 0xffff0000, v77
    s_waitcnt vmcnt(12)
    v_lshlrev_b32 v172, 16, v78
    v_and_b32 v173, 0xffff0000, v78
    v_lshlrev_b32 v174, 16, v79
    v_and_b32 v175, 0xffff0000, v79
    s_waitcnt vmcnt(11)
    v_lshlrev_b32 v176, 16, v80
    v_and_b32 v177, 0xffff0000, v80
    v_lshlrev_b32 v178, 16, v81
    v_and_b32 v179, 0xffff0000, v81
    s_waitcnt vmcnt(9)
    v_lshlrev_b32 v180, 16, v82
    v_and_b32 v181, 0xffff0000, v82
    v_lshlrev_b32 v182, 16, v83
    v_and_b32 v183, 0xffff0000, v83
    s_waitcnt vmcnt(8)
    v_lshlrev_b32 v184, 16, v84
    v_and_b32 v185, 0xffff0000, v84
    v_lshlrev_b32 v186, 16, v85
    v_and_b32 v187, 0xffff0000, v85
    s_waitcnt vmcnt(7)
    v_lshlrev_b32 v188, 16, v86
    v_and_b32 v189, 0xffff0000, v86
    v_lshlrev_b32 v190, 16, v87
    v_and_b32 v191, 0xffff0000, v87
    s_waitcnt vmcnt(0)
    buffer_store_dword v10, v8, s[24:27], s92 offen sc1
    v_cmp_ne_u32 s[54:55], s95, v11
    s_cmp_lg_u64 s[54:55], 0
    s_cbranch_scc1 Ltail_spin1
Ltail_got1:
    s_add_u32 s56, s44, 16384
    buffer_load_dwordx4 a[0:3], v54, s[28:31], s56 offen offset:0 sc1
    buffer_load_dwordx4 a[4:7], v54, s[28:31], s56 offen offset:1024 sc1
    buffer_load_dwordx4 a[8:11], v54, s[28:31], s56 offen offset:2048 sc1
    buffer_load_dwordx4 a[12:15], v54, s[28:31], s56 offen offset:3072 sc1
    s_add_u32 s56, s44, 0
    buffer_load_dwordx4 a[16:19], v2, s[28:31], s56 offen offset:0 sc1
    s_add_u32 s56, s44, 4096
    buffer_load_dwordx4 a[20:23], v2, s[28:31], s56 offen offset:0 sc1
    s_add_u32 s56, s44, 8192
    buffer_load_dwordx4 a[24:27], v2, s[28:31], s56 offen offset:0 sc1
    s_add_u32 s56, s44, 12288
    buffer_load_dwordx4 a[28:31], v2, s[28:31], s56 offen offset:0 sc1
    ds_write_b128 v51, a[128:131] offset:0
    ds_write_b128 v51, a[132:135] offset:4096
    ds_write_b128 v51, a[136:139] offset:8192
    ds_write_b128 v51, a[140:143] offset:12288
    ds_write_b128 v51, a[144:147] offset:16384
    ds_write_b128 v51, a[148:151] offset:20480
    ds_write_b128 v51, a[152:155] offset:24576
    ds_write_b128 v51, a[156:159] offset:28672
    ds_write_b128 v51, a[240:243] offset:32768
    ds_write_b128 v255, a[244:247] offset:40960
    ds_write_b128 v255, a[248:251] offset:45056
    ds_write_b128 v255, a[252:255] offset:61440
    v_lshlrev_b32 v12, 16, v36
    v_and_b32 v13, 0xffff0000, v36
    v_lshlrev_b32 v14, 16, v37
    v_and_b32 v15, 0xffff0000, v37
    v_lshlrev_b32 v16, 16, v38
    v_and_b32 v17, 0xffff0000, v38
    v_lshlrev_b32 v18, 16, v39
    v_and_b32 v19, 0xffff0000, v39
    v_lshlrev_b32 v20, 16, v40
    v_and_b32 v21, 0xffff0000, v40
    v_lshlrev_b32 v22, 16, v41
    v_and_b32 v23, 0xffff0000, v41
    v_lshlrev_b32 v24, 16, v42
    v_and_b32 v25, 0xffff0000, v42
    v_lshlrev_b32 v26, 16, v43
    v_and_b32 v27, 0xffff0000, v43
    v_lshlrev_b32 v28, 16, v92
    v_and_b32 v29, 0xffff0000, v92
    v_lshlrev_b32 v30, 16, v93
    v_and_b32 v31, 0xffff0000, v93
    v_lshlrev_b32 v32, 16, v94
    v_and_b32 v33, 0xffff0000, v94
    v_lshlrev_b32 v34, 16, v95
    v_and_b32 v35, 0xffff0000, v95
    v_lshlrev_b32 v192, 16, v216
    v_and_b32 v193, 0xffff0000, v216
    v_lshlrev_b32 v194, 16, v217
    v_and_b32 v195, 0xffff0000, v217
    v_lshlrev_b32 v196, 16, v218
    v_and_b32 v197, 0xffff0000, v218
    v_lshlrev_b32 v198, 16, v219
    v_and_b32 v199, 0xffff0000, v219
    v_lshlrev_b32 v200, 16, v220
    v_and_b32 v201, 0xffff0000, v220
    v_lshlrev_b32 v202, 16, v221
    v_and_b32 v203, 0xffff0000, v221
    v_lshlrev_b32 v204, 16, v222
    v_and_b32 v205, 0xffff0000, v222
    v_lshlrev_b32 v206, 16, v223
    v_and_b32 v207, 0xffff0000, v223
    v_lshlrev_b32 v208, 16, v88
    v_and_b32 v209, 0xffff0000, v88
    v_lshlrev_b32 v210, 16, v89
    v_and_b32 v211, 0xffff0000, v89
    v_lshlrev_b32 v212, 16, v90
    v_and_b32 v213, 0xffff0000, v90
    v_lshlrev_b32 v214, 16, v91
    v_and_b32 v215, 0xffff0000, v91
    s_add_u32 s39, s39, 16
    buffer_load_dword v11, v9, s[24:27], s39 offen sc1
    s_add_u32 s56, s44, 0
    buffer_load_dwordx4 a[32:35], v2, s[28:31], s56 offen offset:512 sc1
    s_add_u32 s56, s44, 4096
    buffer_load_dwordx4 a[36:39], v2, s[28:31], s56 offen offset:512 sc1
    s_add_u32 s56, s44, 8192
    buffer_load_dwordx4 a[40:43], v2, s[28:31], s56 offen offset:512 sc1
    s_add_u32 s56, s44, 12288
    buffer_load_dwordx4 a[44:47], v2, s[28:31], s56 offen offset:512 sc1
    v_lshrrev_b32 v56, 2, v1
    v_and_b32 v57, 3, v1
    v_lshlrev_b32 v57, 3, v57
    s_and_b32 s36, s3, 1
    s_lshl_b32 s36, s36, 5
    v_lshl_add_u32 v61, v56, 6, v57
    v_add_u32 v61, s36, v61
    s_mov_b32 s36, 135168
    s_mov_b32 s37, 12288
    s_cmp_lt_u32 s3, 2
    s_cselect_b32 s36, 98304, s36
    s_cselect_b32 s37, 98304, s37
    v_add_u32 v94, s37, v61
    v_add_u32 v61, s36, v61
    v_mul_u32_u24 v95, 1152, v56
    s_lshl_b32 s36, s3, 7
    s_add_u32 s36, s36, 61440
    v_add3_u32 v95, v95, v57, s36
    s_waitcnt lgkmcnt(0)
    s_barrier
    ds_read_b64_tr_b16 a[96:97], v61 offset:0
    ds_read_b64_tr_b16 a[98:99], v61 offset:1024
    ds_read_b64_tr_b16 a[100:101], v61 offset:2048
    ds_read_b64_tr_b16 a[102:103], v61 offset:3072
    ds_read_b64_tr_b16 a[104:105], v61 offset:4096
    ds_read_b64_tr_b16 a[106:107], v61 offset:5120
    ds_read_b64_tr_b16 a[108:109], v61 offset:6144
    ds_read_b64_tr_b16 a[110:111], v61 offset:7168
    ds_read_b64_tr_b16 a[112:113], v61 offset:8192
    ds_read_b64_tr_b16 a[114:115], v61 offset:9216
    ds_read_b64_tr_b16 a[116:117], v61 offset:10240
    ds_read_b64_tr_b16 a[118:119], v61 offset:11264
    ds_read_b64_tr_b16 a[120:121], v61 offset:12288
    ds_read_b64_tr_b16 a[122:123], v61 offset:13312
    ds_read_b64_tr_b16 a[124:125], v61 offset:14336
    ds_read_b64_tr_b16 a[126:127], v61 offset:15360
    ds_read_b64_tr_b16 a[128:129], v61 offset:16384
    ds_read_b64_tr_b16 a[130:131], v61 offset:17408
    ds_read_b64_tr_b16 a[132:133], v61 offset:18432
    ds_read_b64_tr_b16 a[134:135], v61 offset:19456
    ds_read_b64_tr_b16 a[136:137], v61 offset:20480
    ds_read_b64_tr_b16 a[138:139], v61 offset:21504
    ds_read_b64_tr_b16 a[140:141], v61 offset:22528
    ds_read_b64_tr_b16 a[142:143], v61 offset:23552
    ds_read_b64_tr_b16 a[144:145], v61 offset:24576
    ds_read_b64_tr_b16 a[146:147], v61 offset:25600
    ds_read_b64_tr_b16 a[148:149], v61 offset:26624
    ds_read_b64_tr_b16 a[150:151], v61 offset:27648
    ds_read_b64_tr_b16 a[152:153], v94 offset:28672
    ds_read_b64_tr_b16 a[154:155], v94 offset:29696
    ds_read_b64_tr_b16 a[156:157], v94 offset:30720
    ds_read_b64_tr_b16 a[158:159], v94 offset:31744
    ds_read_b64_tr_b16 a[160:161], v94 offset:32768
    ds_read_b64_tr_b16 a[162:163], v94 offset:33792
    ds_read_b64_tr_b16 a[164:165], v94 offset:34816
    ds_read_b64_tr_b16 a[166:167], v94 offset:35840
    ds_read_b64_tr_b16 a[168:169], v95 offset:0
    ds_read_b64_tr_b16 a[170:171], v95 offset:18432
    ds_read_b64_tr_b16 a[172:173], v95 offset:32
    ds_read_b64_tr_b16 a[174:175], v95 offset:18464
    ds_read_b64_tr_b16 a[176:177], v95 offset:64
    ds_read_b64_tr_b16 a[178:179], v95 offset:18496
    ds_read_b64_tr_b16 a[180:181], v95 offset:96
    ds_read_b64_tr_b16 a[182:183], v95 offset:18528
    ds_read_b64_tr_b16 a[184:185], v95 offset:512
    ds_read_b64_tr_b16 a[186:187], v95 offset:18944
    ds_read_b64_tr_b16 a[188:189], v95 offset:544
    ds_read_b64_tr_b16 a[190:191], v95 offset:18976
    ds_read_b64_tr_b16 a[192:193], v95 offset:576
    ds_read_b64_tr_b16 a[194:195], v95 offset:19008
    ds_read_b64_tr_b16 a[196:197], v95 offset:608
    ds_read_b64_tr_b16 a[198:199], v95 offset:19040
    ds_read_b64_tr_b16 a[200:201], v95 offset:1024
    ds_read_b64_tr_b16 a[202:203], v95 offset:19456
    ds_read_b64_tr_b16 a[204:205], v95 offset:1056
    ds_read_b64_tr_b16 a[206:207], v95 offset:19488
    ds_read_b64_tr_b16 a[208:209], v95 offset:1088
    ds_read_b64_tr_b16 a[210:211], v95 offset:19520
    ds_read_b64_tr_b16 a[212:213], v95 offset:1120
    ds_read_b64_tr_b16 a[214:215], v95 offset:19552
    s_mov_b64 exec, 0
    s_cmp_eq_u32 s3, 0
    s_cbranch_scc1 Ltour1_0
    s_cmp_eq_u32 s3, 1
    s_cbranch_scc1 Ltour1_1
    s_cmp_eq_u32 s3, 2
    s_cbranch_scc1 Ltour1_2
    s_branch Ltour1_3
Lmain1:
    s_mov_b64 exec, -1
    v_pk_mul_f32 v[62:63], v[144:145], v[168:169]
    v_pk_mul_f32 v[168:169], v[168:169], v[120:121]
    v_pk_fma_f32 v[62:63], v[146:147], v[170:171], v[62:63]
    v_pk_mul_f32 v[170:171], v[170:171], v[122:123]
    v_pk_add_f32 v[88:89], v[168:169], v[170:171]
    v_pk_fma_f32 v[62:63], v[148:149], v[172:173], v[62:63]
    v_pk_mul_f32 v[172:173], v[172:173], v[124:125]
    v_pk_add_f32 v[88:89], v[88:89], v[172:173]
    v_pk_fma_f32 v[62:63], v[150:151], v[174:175], v[62:63]
    v_pk_mul_f32 v[174:175], v[174:175], v[126:127]
    v_pk_add_f32 v[88:89], v[88:89], v[174:175]
    v_pk_fma_f32 v[62:63], v[152:153], v[176:177], v[62:63]
    v_pk_mul_f32 v[176:177], v[176:177], v[128:129]
    v_pk_add_f32 v[88:89], v[88:89], v[176:177]
    v_pk_fma_f32 v[62:63], v[154:155], v[178:179], v[62:63]
    v_pk_mul_f32 v[178:179], v[178:179], v[130:131]
    v_pk_add_f32 v[88:89], v[88:89], v[178:179]
    v_pk_fma_f32 v[62:63], v[156:157], v[180:181], v[62:63]
    v_pk_mul_f32 v[180:181], v[180:181], v[132:133]
    v_pk_add_f32 v[88:89], v[88:89], v[180:181]
    v_pk_fma_f32 v[62:63], v[158:159], v[182:183], v[62:63]
    v_pk_mul_f32 v[182:183], v[182:183], v[134:135]
    v_pk_add_f32 v[88:89], v[88:89], v[182:183]
    v_pk_fma_f32 v[62:63], v[160:161], v[184:185], v[62:63]
    v_pk_mul_f32 v[184:185], v[184:185], v[136:137]
    v_pk_add_f32 v[88:89], v[88:89], v[184:185]
    v_pk_fma_f32 v[62:63], v[162:163], v[186:187], v[62:63]
    v_pk_mul_f32 v[186:187], v[186:187], v[138:139]
    v_pk_add_f32 v[88:89], v[88:89], v[186:187]
    v_pk_fma_f32 v[62:63], v[164:165], v[188:189], v[62:63]
    v_pk_mul_f32 v[188:189], v[188:189], v[140:141]
    v_pk_add_f32 v[88:89], v[88:89], v[188:189]
    v_pk_fma_f32 v[62:63], v[166:167], v[190:191], v[62:63]
    v_pk_mul_f32 v[190:191], v[190:191], v[142:143]
    v_pk_add_f32 v[88:89], v[88:89], v[190:191]
    v_add_f32 v91, v62, v63
    v_add_f32 v90, v88, v89
    s_nop 1
    v_add_f32_dpp v90, v90, v90 row_ror:8 row_mask:0xf bank_mask:0xf
    v_add_f32_dpp v91, v91, v91 row_ror:8 row_mask:0xf bank_mask:0xf
    s_nop 0
    v_add_f32_dpp v90, v90, v90 row_ror:4 row_mask:0xf bank_mask:0xf
    v_add_f32_dpp v91, v91, v91 row_ror:4 row_mask:0xf bank_mask:0xf
    s_nop 0
    v_add_f32_dpp v90, v90, v90 row_ror:2 row_mask:0xf bank_mask:0xf
    v_add_f32_dpp v91, v91, v91 row_ror:2 row_mask:0xf bank_mask:0xf
    s_nop 0
    v_add_f32_dpp v90, v90, v90 row_ror:1 row_mask:0xf bank_mask:0xf
    v_add_f32_dpp v91, v91, v91 row_ror:1 row_mask:0xf bank_mask:0xf
    v_mov_b32 v62, v90
    v_mov_b32 v63, v91
    s_nop 0
    v_permlane16_swap_b32 v90, v62
    v_permlane16_swap_b32 v91, v63
    v_add_f32 v90, v90, v62
    v_add_f32 v91, v91, v63
    v_lshlrev_b32 v92, 2, v7
    v_and_b32 v92, 28, v92
    v_sub_u32 v93, 2047, v7
    s_waitcnt vmcnt(12)
    v_mfma_f32_16x16x32_bf16 v[80:83], v[242:245], a[0:3], 0
    v_mfma_f32_16x16x32_bf16 v[84:87], v[240:243], a[0:3], 0
    s_waitcnt vmcnt(11)
    v_mfma_f32_16x16x32_bf16 v[80:83], v[242:245], a[4:7], v[80:83]
    v_mfma_f32_16x16x32_bf16 v[84:87], v[240:243], a[4:7], v[84:87]
    s_waitcnt vmcnt(10)
    v_mfma_f32_16x16x32_bf16 v[80:83], v[242:245], a[8:11], v[80:83]
    v_mfma_f32_16x16x32_bf16 v[84:87], v[240:243], a[8:11], v[84:87]
    s_waitcnt vmcnt(9)
    v_mfma_f32_16x16x32_bf16 v[80:83], v[242:245], a[12:15], v[80:83]
    v_mfma_f32_16x16x32_bf16 v[84:87], v[240:243], a[12:15], v[84:87]
    s_waitcnt vmcnt(8)
    s_nop 5
    v_mov_b32_dpp v80, v80 row_ror:8 row_mask:0x4 bank_mask:0xf
    v_mov_b32_dpp v81, v81 row_ror:8 row_mask:0x4 bank_mask:0xf
    v_mov_b32_dpp v82, v82 row_ror:8 row_mask:0x4 bank_mask:0xf
    v_mov_b32_dpp v83, v83 row_ror:8 row_mask:0x4 bank_mask:0xf
    v_mov_b32_dpp v84, v84 row_ror:8 row_mask:0x4 bank_mask:0xf
    v_mov_b32_dpp v85, v85 row_ror:8 row_mask:0x4 bank_mask:0xf
    v_mov_b32_dpp v86, v86 row_ror:8 row_mask:0x4 bank_mask:0xf
    v_mov_b32_dpp v87, v87 row_ror:8 row_mask:0x4 bank_mask:0xf
    v_pk_fma_f32 v[28:29], v[112:113], v[80:81], v[28:29]
    v_pk_fma_f32 v[30:31], v[114:115], v[82:83], v[30:31]
    v_pk_fma_f32 v[32:33], v[116:117], v[84:85], v[32:33]
    v_pk_fma_f32 v[34:35], v[118:119], v[86:87], v[34:35]
    v_cvt_pk_bf16_f32 v44, v28, v29
    v_cvt_pk_bf16_f32 v45, v30, v31
    v_cvt_pk_bf16_f32 v46, v32, v33
    v_cvt_pk_bf16_f32 v47, v34, v35
    v_lshlrev_b32 v28, 16, v44
    v_and_b32 v29, 0xffff0000, v44
    v_lshlrev_b32 v30, 16, v45
    v_and_b32 v31, 0xffff0000, v45
    v_lshlrev_b32 v32, 16, v46
    v_and_b32 v33, 0xffff0000, v46
    v_lshlrev_b32 v34, 16, v47
    v_and_b32 v35, 0xffff0000, v47
    v_mfma_f32_16x16x32_bf16 v[64:67], v[246:249], a[16:19], 0
    v_mfma_f32_16x16x32_bf16 v[68:71], v[244:247], a[16:19], 0
    s_waitcnt vmcnt(7)
    v_mfma_f32_16x16x32_bf16 v[64:67], v[246:249], a[20:23], v[64:67]
    v_mfma_f32_16x16x32_bf16 v[68:71], v[244:247], a[20:23], v[68:71]
    s_waitcnt vmcnt(6)
    v_mfma_f32_16x16x32_bf16 v[64:67], v[246:249], a[24:27], v[64:67]
    v_mfma_f32_16x16x32_bf16 v[68:71], v[244:247], a[24:27], v[68:71]
    s_waitcnt vmcnt(5)
    v_mfma_f32_16x16x32_bf16 v[64:67], v[246:249], a[28:31], v[64:67]
    v_mfma_f32_16x16x32_bf16 v[68:71], v[244:247], a[28:31], v[68:71]
    s_waitcnt vmcnt(4)
    v_cmp_ne_u32 s[54:55], s95, v11
    s_cmp_lg_u64 s[54:55], 0
    s_cbranch_scc1 Ltail_spin2
Ltail_got2:
    s_add_u32 s56, s44, 0
    buffer_load_dwordx4 a[48:51], v2, s[28:31], s56 offen offset:1024 sc1
    s_add_u32 s56, s44, 4096
    buffer_load_dwordx4 a[52:55], v2, s[28:31], s56 offen offset:1024 sc1
    s_add_u32 s56, s44, 8192
    buffer_load_dwordx4 a[56:59], v2, s[28:31], s56 offen offset:1024 sc1
    s_add_u32 s56, s44, 12288
    buffer_load_dwordx4 a[60:63], v2, s[28:31], s56 offen offset:1024 sc1
    s_add_u32 s56, s44, 0
    buffer_load_dwordx4 a[64:67], v2, s[28:31], s56 offen offset:1536 sc1
    s_add_u32 s56, s44, 4096
    buffer_load_dwordx4 a[68:71], v2, s[28:31], s56 offen offset:1536 sc1
    s_add_u32 s56, s44, 8192
    buffer_load_dwordx4 a[72:75], v2, s[28:31], s56 offen offset:1536 sc1
    s_add_u32 s56, s44, 12288
    buffer_load_dwordx4 a[76:79], v2, s[28:31], s56 offen offset:1536 sc1
    s_movk_i32 s48, 0x7ff
    s_waitcnt vmcnt(11)
    v_mfma_f32_16x16x32_bf16 v[64:67], v[250:253], a[32:35], v[64:67]
    v_mfma_f32_16x16x32_bf16 v[68:71], v[248:251], a[32:35], v[68:71]
    s_waitcnt vmcnt(10)
    v_mfma_f32_16x16x32_bf16 v[64:67], v[250:253], a[36:39], v[64:67]
    v_mfma_f32_16x16x32_bf16 v[68:71], v[248:251], a[36:39], v[68:71]
    s_waitcnt vmcnt(9)
    v_mfma_f32_16x16x32_bf16 v[64:67], v[250:253], a[40:43], v[64:67]
    v_mfma_f32_16x16x32_bf16 v[68:71], v[248:251], a[40:43], v[68:71]
    s_waitcnt vmcnt(8)
    v_mfma_f32_16x16x32_bf16 v[64:67], v[250:253], a[44:47], v[64:67]
    v_mfma_f32_16x16x32_bf16 v[68:71], v[248:251], a[44:47], v[68:71]
    s_waitcnt vmcnt(7)
    s_nop 5
    v_pk_fma_f32 v[12:13], v[96:97], v[64:65], v[12:13]
    v_pk_fma_f32 v[14:15], v[98:99], v[66:67], v[14:15]
    v_pk_fma_f32 v[16:17], v[100:101], v[68:69], v[16:17]
    v_pk_fma_f32 v[18:19], v[102:103], v[70:71], v[18:19]
    v_cvt_pk_bf16_f32 v36, v12, v13
    v_cvt_pk_bf16_f32 v37, v14, v15
    v_cvt_pk_bf16_f32 v38, v16, v17
    v_cvt_pk_bf16_f32 v39, v18, v19
    v_lshlrev_b32 v12, 16, v36
    v_and_b32 v13, 0xffff0000, v36
    v_lshlrev_b32 v14, 16, v37
    v_and_b32 v15, 0xffff0000, v37
    v_lshlrev_b32 v16, 16, v38
    v_and_b32 v17, 0xffff0000, v38
    v_lshlrev_b32 v18, 16, v39
    v_and_b32 v19, 0xffff0000, v39
Ltour1_0:
    s_cbranch_execz Ltour1_4
    v_pk_add_f32 v[88:89], v[12:13], v[14:15]
    v_pk_add_f32 v[62:63], v[16:17], v[18:19]
    v_pk_add_f32 v[88:89], v[88:89], v[62:63]
    v_add_f32 v88, v88, v89
    s_nop 1
    v_add_f32_dpp v88, v88, v88 row_ror:8 row_mask:0xf bank_mask:0xf
    s_nop 1
    v_add_f32_dpp v88, v88, v88 row_ror:4 row_mask:0xf bank_mask:0xf
    s_nop 1
    v_add_f32_dpp v88, v88, v88 row_ror:2 row_mask:0xf bank_mask:0xf
    s_nop 1
    v_add_f32_dpp v88, v88, v88 row_ror:1 row_mask:0xf bank_mask:0xf
    v_mov_b32 v62, v88
    s_nop 1
    v_permlane16_swap_b32 v88, v62
    s_nop 0
    v_add_f32 v88, v88, v62
    v_mul_f32 v88, 0x3b800000, v88
    v_pk_add_f32 v[232:233], v[28:29], v[88:89] op_sel_hi:[1,0] neg_lo:[0,1] neg_hi:[0,1]
    v_pk_add_f32 v[234:235], v[30:31], v[88:89] op_sel_hi:[1,0] neg_lo:[0,1] neg_hi:[0,1]
    v_pk_add_f32 v[236:237], v[32:33], v[88:89] op_sel_hi:[1,0] neg_lo:[0,1] neg_hi:[0,1]
    v_pk_add_f32 v[238:239], v[34:35], v[88:89] op_sel_hi:[1,0] neg_lo:[0,1] neg_hi:[0,1]
    v_pk_add_f32 v[48:49], v[232:233], v[234:235]
    v_pk_mul_f32 v[50:51], v[232:233], v[232:233]
    v_pk_mul_f32 v[52:53], v[232:233], v[184:185]
    v_pk_fma_f32 v[50:51], v[234:235], v[234:235], v[50:51]
    v_pk_fma_f32 v[52:53], v[234:235], v[186:187], v[52:53]
    v_pk_add_f32 v[48:49], v[48:49], v[236:237]
    v_pk_fma_f32 v[50:51], v[236:237], v[236:237], v[50:51]
    v_pk_fma_f32 v[52:53], v[236:237], v[188:189], v[52:53]
    v_pk_add_f32 v[48:49], v[48:49], v[238:239]
    v_pk_fma_f32 v[50:51], v[238:239], v[238:239], v[50:51]
    v_pk_fma_f32 v[52:53], v[238:239], v[190:191], v[52:53]
    v_cndmask_b32 v48, 0, v48, vcc
    v_cndmask_b32 v49, 0, v49, vcc
    v_cndmask_b32 v50, 0, v50, vcc
    v_cndmask_b32 v51, 0, v51, vcc
    v_pk_add_f32 v[216:217], v[12:13], v[88:89] op_sel_hi:[1,0] neg_lo:[0,1] neg_hi:[0,1]
    v_pk_add_f32 v[218:219], v[14:15], v[88:89] op_sel_hi:[1,0] neg_lo:[0,1] neg_hi:[0,1]
    v_pk_add_f32 v[220:221], v[16:17], v[88:89] op_sel_hi:[1,0] neg_lo:[0,1] neg_hi:[0,1]
    v_pk_add_f32 v[222:223], v[18:19], v[88:89] op_sel_hi:[1,0] neg_lo:[0,1] neg_hi:[0,1]
    v_pk_add_f32 v[48:49], v[48:49], v[216:217]
    v_pk_fma_f32 v[50:51], v[216:217], v[216:217], v[50:51]
    v_pk_fma_f32 v[52:53], v[216:217], v[168:169], v[52:53]
    v_pk_add_f32 v[48:49], v[48:49], v[218:219]
    v_pk_fma_f32 v[50:51], v[218:219], v[218:219], v[50:51]
    v_pk_fma_f32 v[52:53], v[218:219], v[170:171], v[52:53]
    v_pk_add_f32 v[48:49], v[48:49], v[220:221]
    v_pk_fma_f32 v[50:51], v[220:221], v[220:221], v[50:51]
    v_pk_fma_f32 v[52:53], v[220:221], v[172:173], v[52:53]
    v_pk_add_f32 v[48:49], v[48:49], v[222:223]
    v_pk_fma_f32 v[50:51], v[222:223], v[222:223], v[50:51]
    v_pk_fma_f32 v[52:53], v[222:223], v[174:175], v[52:53]
    v_mfma_f32_16x16x32_bf16 v[72:75], v[246:249], a[48:51], 0
    v_mfma_f32_16x16x32_bf16 v[76:79], v[244:247], a[48:51], 0
    s_waitcnt vmcnt(6)
    v_mfma_f32_16x16x32_bf16 v[72:75], v[246:249], a[52:55], v[72:75]
    v_mfma_f32_16x16x32_bf16 v[76:79], v[244:247], a[52:55], v[76:79]
    s_waitcnt vmcnt(5)
    v_mfma_f32_16x16x32_bf16 v[72:75], v[246:249], a[56:59], v[72:75]
    v_mfma_f32_16x16x32_bf16 v[76:79], v[244:247], a[56:59], v[76:79]
    s_waitcnt vmcnt(4)
    v_mfma_f32_16x16x32_bf16 v[72:75], v[246:249], a[60:63], v[72:75]
    v_mfma_f32_16x16x32_bf16 v[76:79], v[244:247], a[60:63], v[76:79]
    s_waitcnt vmcnt(3)
    v_mfma_f32_16x16x32_bf16 v[72:75], v[250:253], a[64:67], v[72:75]
    v_mfma_f32_16x16x32_bf16 v[76:79], v[248:251], a[64:67], v[76:79]
    s_waitcnt vmcnt(2)
    v_mfma_f32_16x16x32_bf16 v[72:75], v[250:253], a[68:71], v[72:75]
    v_mfma_f32_16x16x32_bf16 v[76:79], v[248:251], a[68:71], v[76:79]
    s_waitcnt vmcnt(1)
    v_mfma_f32_16x16x32_bf16 v[72:75], v[250:253], a[72:75], v[72:75]
    v_mfma_f32_16x16x32_bf16 v[76:79], v[248:251], a[72:75], v[76:79]
    s_waitcnt vmcnt(0)
    v_mfma_f32_16x16x32_bf16 v[72:75], v[250:253], a[76:79], v[72:75]
    v_mfma_f32_16x16x32_bf16 v[76:79], v[248:251], a[76:79], v[76:79]
    s_nop 6
    v_pk_fma_f32 v[20:21], v[104:105], v[72:73], v[20:21]
    v_pk_fma_f32 v[22:23], v[106:107], v[74:75], v[22:23]
    v_pk_fma_f32 v[24:25], v[108:109], v[76:77], v[24:25]
    v_pk_fma_f32 v[26:27], v[110:111], v[78:79], v[26:27]
    v_cvt_pk_bf16_f32 v40, v20, v21
    v_cvt_pk_bf16_f32 v41, v22, v23
    v_cvt_pk_bf16_f32 v42, v24, v25
    v_cvt_pk_bf16_f32 v43, v26, v27
    v_lshlrev_b32 v20, 16, v40
    v_and_b32 v21, 0xffff0000, v40
    v_lshlrev_b32 v22, 16, v41
    v_and_b32 v23, 0xffff0000, v41
    v_lshlrev_b32 v24, 16, v42
    v_and_b32 v25, 0xffff0000, v42
    v_lshlrev_b32 v26, 16, v43
    v_and_b32 v27, 0xffff0000, v43
    v_pk_add_f32 v[224:225], v[20:21], v[88:89] op_sel_hi:[1,0] neg_lo:[0,1] neg_hi:[0,1]
    v_pk_add_f32 v[226:227], v[22:23], v[88:89] op_sel_hi:[1,0] neg_lo:[0,1] neg_hi:[0,1]
    v_pk_add_f32 v[228:229], v[24:25], v[88:89] op_sel_hi:[1,0] neg_lo:[0,1] neg_hi:[0,1]
    v_pk_add_f32 v[230:231], v[26:27], v[88:89] op_sel_hi:[1,0] neg_lo:[0,1] neg_hi:[0,1]
    v_pk_add_f32 v[48:49], v[48:49], v[224:225]
    v_pk_fma_f32 v[50:51], v[224:225], v[224:225], v[50:51]
    v_pk_fma_f32 v[52:53], v[224:225], v[176:177], v[52:53]
    v_pk_add_f32 v[48:49], v[48:49], v[226:227]
    v_pk_fma_f32 v[50:51], v[226:227], v[226:227], v[50:51]
    v_pk_fma_f32 v[52:53], v[226:227], v[178:179], v[52:53]
    v_pk_add_f32 v[48:49], v[48:49], v[228:229]
    v_pk_fma_f32 v[50:51], v[228:229], v[228:229], v[50:51]
    v_pk_fma_f32 v[52:53], v[228:229], v[180:181], v[52:53]
    v_pk_add_f32 v[48:49], v[48:49], v[230:231]
    v_pk_fma_f32 v[50:51], v[230:231], v[230:231], v[50:51]
    v_pk_fma_f32 v[52:53], v[230:231], v[182:183], v[52:53]
    v_add_f32 v48, v48, v49
    v_add_f32 v50, v50, v51
    v_add_f32 v52, v52, v53
    v_add_f32_dpp v48, v48, v48 row_ror:8 row_mask:0xf bank_mask:0xf
    v_add_f32_dpp v50, v50, v50 row_ror:8 row_mask:0xf bank_mask:0xf
    v_add_f32_dpp v52, v52, v52 row_ror:8 row_mask:0xf bank_mask:0xf
    v_add_f32_dpp v48, v48, v48 row_ror:4 row_mask:0xf bank_mask:0xf
    v_add_f32_dpp v50, v50, v50 row_ror:4 row_mask:0xf bank_mask:0xf
    v_add_f32_dpp v52, v52, v52 row_ror:4 row_mask:0xf bank_mask:0xf
    v_add_f32_dpp v48, v48, v48 row_ror:2 row_mask:0xf bank_mask:0xf
    v_add_f32_dpp v50, v50, v50 row_ror:2 row_mask:0xf bank_mask:0xf
    v_add_f32_dpp v52, v52, v52 row_ror:2 row_mask:0xf bank_mask:0xf
    v_add_f32_dpp v48, v48, v48 row_ror:1 row_mask:0xf bank_mask:0xf
    v_add_f32_dpp v50, v50, v50 row_ror:1 row_mask:0xf bank_mask:0xf
    v_add_f32_dpp v52, v52, v52 row_ror:1 row_mask:0xf bank_mask:0xf
    v_mov_b32 v49, v48
    v_mov_b32 v51, v50
    v_mov_b32 v53, v52
    v_permlane16_swap_b32 v48, v49
    v_permlane16_swap_b32 v50, v51
    v_permlane16_swap_b32 v52, v53
    v_add_f32 v48, v48, v49
    v_add_f32 v50, v50, v51
    v_add_f32 v52, v52, v53
    v_mul_f32 v48, 0x3ae38e39, v48
    v_mul_f32 v50, 0x3ae38e39, v50
    v_fma_f32 v50, -v48, v48, v50
    v_add_f32 v48, v48, v88
    v_max_f32 v50, 0, v50
    v_cvt_pk_bf16_f32 v48, v48, v50
    v_and_b32 v50, 0xffff0000, v48
    v_lshlrev_b32 v48, 16, v48
    v_add_f32 v50, 0x3727c5ac, v50
    v_sub_f32 v48, v88, v48
    v_cvt_pk_bf16_f32 v50, v50, v50
    v_and_b32 v50, 0xffff0000, v50
    v_sqrt_f32 v50, v50
    v_fmac_f32 v52, v48, v90
    v_cvt_pk_bf16_f32 v50, v50, v50
    v_and_b32 v50, 0xffff0000, v50
    v_rcp_f32 v50, v50
    s_mov_b32 exec_lo, 1
    s_mov_b32 exec_hi, 1
    v_fma_f32 v52, v52, v50, v91
    v_ashrrev_i32 v62, 31, v52
    v_or_b32 v62, 0x80000000, v62
    v_xor_b32 v52, v62, v52
    v_min_u32 v52, 0xfffff000, v52
    v_bfi_b32 v52, s48, v93, v52
    ds_write_b32 v92, v52 offset:36864
    s_mov_b64 exec, -1
    v_mul_f32 v48, v48, v50
    s_waitcnt lgkmcnt(0)
    s_barrier
    v_mov_b32 v109, 36864
    ds_read_b128 v[96:99], v109
    ds_read_b128 v[100:103], v109 offset:16
    s_lshl_b32 s45, s2, 7
    s_add_u32 s45, s45, 9306112
    s_cmp_eq_u32 s3, 0
    s_cselect_b32 s45, s45, 2147483648
    s_waitcnt lgkmcnt(1)
    v_max_u32 v104, v96, v97
    v_min_u32 v105, v96, v97
    v_med3_u32 v105, v104, v105, v98
    v_max_u32 v104, v104, v98
    v_med3_u32 v105, v104, v105, v99
    v_max_u32 v104, v104, v99
    s_waitcnt lgkmcnt(0)
    v_med3_u32 v105, v104, v105, v100
    v_max_u32 v104, v104, v100
    v_med3_u32 v105, v104, v105, v101
    v_max_u32 v104, v104, v101
    v_med3_u32 v105, v104, v105, v102
    v_max_u32 v104, v104, v102
    v_med3_u32 v105, v104, v105, v103
    v_max_u32 v104, v104, v103
    buffer_store_dwordx2 v[104:105], v8, s[24:27], s45 offen sc1
    v_pk_fma_f32 v[216:217], v[216:217], v[50:51], v[48:49] op_sel_hi:[1,0,0]
    v_pk_fma_f32 v[218:219], v[218:219], v[50:51], v[48:49] op_sel_hi:[1,0,0]
    v_pk_fma_f32 v[220:221], v[220:221], v[50:51], v[48:49] op_sel_hi:[1,0,0]
    v_pk_fma_f32 v[222:223], v[222:223], v[50:51], v[48:49] op_sel_hi:[1,0,0]
    v_pk_fma_f32 v[224:225], v[224:225], v[50:51], v[48:49] op_sel_hi:[1,0,0]
    v_pk_fma_f32 v[226:227], v[226:227], v[50:51], v[48:49] op_sel_hi:[1,0,0]
    v_pk_fma_f32 v[228:229], v[228:229], v[50:51], v[48:49] op_sel_hi:[1,0,0]
    v_pk_fma_f32 v[230:231], v[230:231], v[50:51], v[48:49] op_sel_hi:[1,0,0]
    v_pk_fma_f32 v[232:233], v[232:233], v[50:51], v[48:49] op_sel_hi:[1,0,0]
    v_pk_fma_f32 v[234:235], v[234:235], v[50:51], v[48:49] op_sel_hi:[1,0,0]
    v_pk_fma_f32 v[236:237], v[236:237], v[50:51], v[48:49] op_sel_hi:[1,0,0]
    v_pk_fma_f32 v[238:239], v[238:239], v[50:51], v[48:49] op_sel_hi:[1,0,0]
    v_pk_fma_f32 v[216:217], v[216:217], v[120:121], v[144:145]
    v_pk_fma_f32 v[218:219], v[218:219], v[122:123], v[146:147]
    v_pk_fma_f32 v[220:221], v[220:221], v[124:125], v[148:149]
    v_pk_fma_f32 v[222:223], v[222:223], v[126:127], v[150:151]
    v_pk_fma_f32 v[224:225], v[224:225], v[128:129], v[152:153]
    v_pk_fma_f32 v[226:227], v[226:227], v[130:131], v[154:155]
    v_pk_fma_f32 v[228:229], v[228:229], v[132:133], v[156:157]
    v_pk_fma_f32 v[230:231], v[230:231], v[134:135], v[158:159]
    v_pk_fma_f32 v[232:233], v[232:233], v[136:137], v[160:161]
    v_pk_fma_f32 v[234:235], v[234:235], v[138:139], v[162:163]
    v_pk_fma_f32 v[236:237], v[236:237], v[140:141], v[164:165]
    v_pk_fma_f32 v[238:239], v[238:239], v[142:143], v[166:167]
    v_cvt_pk_bf16_f32 v64, v216, v217
    v_cvt_pk_bf16_f32 v65, v218, v219
    v_cvt_pk_bf16_f32 v66, v220, v221
    v_cvt_pk_bf16_f32 v67, v222, v223
    v_cvt_pk_bf16_f32 v68, v224, v225
    v_cvt_pk_bf16_f32 v69, v226, v227
    v_cvt_pk_bf16_f32 v70, v228, v229
    v_cvt_pk_bf16_f32 v71, v230, v231
    v_cvt_pk_bf16_f32 v72, v232, v233
    v_cvt_pk_bf16_f32 v73, v234, v235
    v_cvt_pk_bf16_f32 v74, v236, v237
    v_cvt_pk_bf16_f32 v75, v238, v239
    v_and_b32 v106, 0x7ff, v104
    v_and_b32 v107, 0x7ff, v105
    v_cmp_eq_u32 vcc, v106, v93
    v_cmp_eq_u32 s[36:37], v107, v93
    v_mov_b32 v106, 2147483648
    s_or_b64 vcc, vcc, s[36:37]
    s_mov_b32 s45, 2621440
    s_nop 0
    v_cndmask_b32 v6, v106, v6, vcc
    v_cndmask_b32 v60, v106, v60, vcc
    buffer_store_dwordx4 v[64:67], v6, s[24:27], s45 offen offset:0 sc1
    buffer_store_dwordx4 v[68:71], v6, s[24:27], s45 offen offset:512 sc1
    buffer_store_dwordx4 v[72:75], v60, s[24:27], s45 offen offset:1024 sc1
    s_cmp_ge_u32 s41, 18
    s_cbranch_scc1 Ltail_idle
    s_mov_b32 s36, 2622592
    buffer_store_dwordx4 v[36:39], v6, s[24:27], s36 offen offset:0 sc1
    buffer_store_dwordx4 v[40:43], v6, s[24:27], s36 offen offset:512 sc1
    buffer_store_dwordx4 v[44:47], v60, s[24:27], s36 offen offset:1024 sc1
    v_lshlrev_b32 v216, 16, v64
    v_and_b32 v217, 0xffff0000, v64
    v_lshlrev_b32 v218, 16, v65
    v_and_b32 v219, 0xffff0000, v65
    v_lshlrev_b32 v220, 16, v66
    v_and_b32 v221, 0xffff0000, v66
    v_lshlrev_b32 v222, 16, v67
    v_and_b32 v223, 0xffff0000, v67
    v_lshlrev_b32 v224, 16, v68
    v_and_b32 v225, 0xffff0000, v68
    v_lshlrev_b32 v226, 16, v69
    v_and_b32 v227, 0xffff0000, v69
    v_lshlrev_b32 v228, 16, v70
    v_and_b32 v229, 0xffff0000, v70
    v_lshlrev_b32 v230, 16, v71
    v_and_b32 v231, 0xffff0000, v71
    v_lshlrev_b32 v232, 16, v72
    v_and_b32 v233, 0xffff0000, v72
    v_lshlrev_b32 v234, 16, v73
    v_and_b32 v235, 0xffff0000, v73
    v_lshlrev_b32 v236, 16, v74
    v_and_b32 v237, 0xffff0000, v74
    v_lshlrev_b32 v238, 16, v75
    v_and_b32 v239, 0xffff0000, v75
    v_pk_mul_f32 v[192:193], v[192:193], v[216:217]
    v_pk_mul_f32 v[194:195], v[194:195], v[218:219]
    v_pk_mul_f32 v[196:197], v[196:197], v[220:221]
    v_pk_mul_f32 v[198:199], v[198:199], v[222:223]
    v_pk_mul_f32 v[200:201], v[200:201], v[224:225]
    v_pk_mul_f32 v[202:203], v[202:203], v[226:227]
    v_pk_mul_f32 v[204:205], v[204:205], v[228:229]
    v_pk_mul_f32 v[206:207], v[206:207], v[230:231]
    v_pk_mul_f32 v[208:209], v[208:209], v[232:233]
    v_pk_mul_f32 v[210:211], v[210:211], v[234:235]
    v_pk_mul_f32 v[212:213], v[212:213], v[236:237]
    v_pk_mul_f32 v[214:215], v[214:215], v[238:239]
    v_cvt_pk_bf16_f32 v144, v192, v193
    v_cvt_pk_bf16_f32 v145, v194, v195
    v_cvt_pk_bf16_f32 v146, v196, v197
    v_cvt_pk_bf16_f32 v147, v198, v199
    v_cvt_pk_bf16_f32 v148, v200, v201
    v_cvt_pk_bf16_f32 v149, v202, v203
    v_cvt_pk_bf16_f32 v150, v204, v205
    v_cvt_pk_bf16_f32 v151, v206, v207
    v_cvt_pk_bf16_f32 v152, v208, v209
    v_cvt_pk_bf16_f32 v153, v210, v211
    v_cvt_pk_bf16_f32 v154, v212, v213
    v_cvt_pk_bf16_f32 v155, v214, v215
    v_lshlrev_b32 v192, 16, v144
    v_and_b32 v193, 0xffff0000, v144
    v_lshlrev_b32 v194, 16, v145
    v_and_b32 v195, 0xffff0000, v145
    v_lshlrev_b32 v196, 16, v146
    v_and_b32 v197, 0xffff0000, v146
    v_lshlrev_b32 v198, 16, v147
    v_and_b32 v199, 0xffff0000, v147
    v_lshlrev_b32 v200, 16, v148
    v_and_b32 v201, 0xffff0000, v148
    v_lshlrev_b32 v202, 16, v149
    v_and_b32 v203, 0xffff0000, v149
    v_lshlrev_b32 v204, 16, v150
    v_and_b32 v205, 0xffff0000, v150
    v_lshlrev_b32 v206, 16, v151
    v_and_b32 v207, 0xffff0000, v151
    v_lshlrev_b32 v208, 16, v152
    v_and_b32 v209, 0xffff0000, v152
    v_lshlrev_b32 v210, 16, v153
    v_and_b32 v211, 0xffff0000, v153
    v_lshlrev_b32 v212, 16, v154
    v_and_b32 v213, 0xffff0000, v154
    v_lshlrev_b32 v214, 16, v155
    v_and_b32 v215, 0xffff0000, v155
    v_pk_add_f32 v[192:193], v[192:193], v[12:13]
    v_pk_add_f32 v[194:195], v[194:195], v[14:15]
    v_pk_add_f32 v[196:197], v[196:197], v[16:17]
    v_pk_add_f32 v[198:199], v[198:199], v[18:19]
    v_pk_add_f32 v[200:201], v[200:201], v[20:21]
    v_pk_add_f32 v[202:203], v[202:203], v[22:23]
    v_pk_add_f32 v[204:205], v[204:205], v[24:25]
    v_pk_add_f32 v[206:207], v[206:207], v[26:27]
    v_pk_add_f32 v[208:209], v[208:209], v[28:29]
    v_pk_add_f32 v[210:211], v[210:211], v[30:31]
    v_pk_add_f32 v[212:213], v[212:213], v[32:33]
    v_pk_add_f32 v[214:215], v[214:215], v[34:35]
    v_cvt_pk_bf16_f32 v156, v192, v193
    v_cvt_pk_bf16_f32 v157, v194, v195
    v_cvt_pk_bf16_f32 v158, v196, v197
    v_cvt_pk_bf16_f32 v159, v198, v199
    v_cvt_pk_bf16_f32 v160, v200, v201
    v_cvt_pk_bf16_f32 v161, v202, v203
    v_cvt_pk_bf16_f32 v162, v204, v205
    v_cvt_pk_bf16_f32 v163, v206, v207
    v_cvt_pk_bf16_f32 v164, v208, v209
    v_cvt_pk_bf16_f32 v165, v210, v211
    v_cvt_pk_bf16_f32 v166, v212, v213
    v_cvt_pk_bf16_f32 v167, v214, v215
    v_and_b32 v30, 2, v1
    v_cmp_ne_u32 vcc, 0, v30
    v_mul_u32_u24 v30, 1152, v7
    v_add_u32 v4, v30, v5
    v_add_u32 v58, v30, v59
    v_mov_b32_dpp v192, v158 quad_perm:[0,2,0,2] row_mask:0xf bank_mask:0xf
    v_mov_b32_dpp v193, v159 quad_perm:[0,2,0,2] row_mask:0xf bank_mask:0xf
    v_mov_b32_dpp v194, v158 quad_perm:[1,3,1,3] row_mask:0xf bank_mask:0xf
    v_mov_b32_dpp v195, v159 quad_perm:[1,3,1,3] row_mask:0xf bank_mask:0xf
    v_mov_b32_dpp v196, v162 quad_perm:[0,2,0,2] row_mask:0xf bank_mask:0xf
    v_mov_b32_dpp v197, v163 quad_perm:[0,2,0,2] row_mask:0xf bank_mask:0xf
    v_mov_b32_dpp v198, v162 quad_perm:[1,3,1,3] row_mask:0xf bank_mask:0xf
    v_mov_b32_dpp v199, v163 quad_perm:[1,3,1,3] row_mask:0xf bank_mask:0xf
    v_mov_b32_dpp v200, v166 quad_perm:[0,2,0,2] row_mask:0xf bank_mask:0xf
    v_mov_b32_dpp v201, v167 quad_perm:[0,2,0,2] row_mask:0xf bank_mask:0xf
    v_mov_b32_dpp v202, v166 quad_perm:[1,3,1,3] row_mask:0xf bank_mask:0xf
    v_mov_b32_dpp v203, v167 quad_perm:[1,3,1,3] row_mask:0xf bank_mask:0xf
    v_cndmask_b32_dpp v144, v156, v192, vcc quad_perm:[0,2,0,2] row_mask:0xf bank_mask:0xf
    v_cndmask_b32_dpp v145, v157, v193, vcc quad_perm:[0,2,0,2] row_mask:0xf bank_mask:0xf
    v_cndmask_b32_dpp v146, v156, v194, vcc quad_perm:[1,3,1,3] row_mask:0xf bank_mask:0xf
    v_cndmask_b32_dpp v147, v157, v195, vcc quad_perm:[1,3,1,3] row_mask:0xf bank_mask:0xf
    v_cndmask_b32_dpp v148, v160, v196, vcc quad_perm:[0,2,0,2] row_mask:0xf bank_mask:0xf
    v_cndmask_b32_dpp v149, v161, v197, vcc quad_perm:[0,2,0,2] row_mask:0xf bank_mask:0xf
    v_cndmask_b32_dpp v150, v160, v198, vcc quad_perm:[1,3,1,3] row_mask:0xf bank_mask:0xf
    v_cndmask_b32_dpp v151, v161, v199, vcc quad_perm:[1,3,1,3] row_mask:0xf bank_mask:0xf
    v_cndmask_b32_dpp v152, v164, v200, vcc quad_perm:[0,2,0,2] row_mask:0xf bank_mask:0xf
    v_cndmask_b32_dpp v153, v165, v201, vcc quad_perm:[0,2,0,2] row_mask:0xf bank_mask:0xf
    v_cndmask_b32_dpp v154, v164, v202, vcc quad_perm:[1,3,1,3] row_mask:0xf bank_mask:0xf
    v_cndmask_b32_dpp v155, v165, v203, vcc quad_perm:[1,3,1,3] row_mask:0xf bank_mask:0xf
    v_lshlrev_b32 v13, 4, v1
    v_add_u32 v13, 32768, v13
    s_lshl_b32 s44, s3, 10
    v_add_u32 v14, s44, v13
    v_and_b32 v13, 0xffffff1f, v13
    v_bfe_u32 v15, v1, 2, 2
    v_cmp_eq_u32 s[52:53], 0, v15
    v_cmp_eq_u32 s[54:55], 1, v15
    v_cmp_eq_u32 s[56:57], 2, v15
    v_cmp_eq_u32 s[58:59], 3, v15
    s_mul_i32 s43, s42, 18
    s_add_u32 s43, s43, s41
    s_lshl_b32 s43, s43, 9
    s_mul_i32 s44, s3, 73728
    s_add_u32 s43, s43, s44
    v_lshlrev_b32 v15, 3, v1
    s_cmp_lt_u32 s3, 2
    s_cselect_b32 s36, 0xbfb8aa3b, 0
    s_cselect_b32 s37, 1.0, 0
    v_mov_b32 v40, s36
    v_mov_b32 v41, s37
    v_and_b32 v10, 1, v1
    v_and_b32 v9, 48, v1
    s_mul_i32 s38, s3, 3072
    s_add_u32 s38, s38, 49152
    v_lshl_add_u32 v11, v10, 9, v9
    v_add_u32 v11, s38, v11
    v_lshrrev_b32 v10, 5, v1
    v_and_b32 v9, 31, v1
    v_lshlrev_b32 v9, 4, v9
    v_lshlrev_b32 v108, 7, v0
    s_mov_b32 s45, 9306112
    s_lshl_b32 s36, s3, 3
    v_mov_b32 v109, s36
    s_mov_b32 s48, 262144
Ltail_pollk:
    buffer_load_dwordx2 v[104:105], v108, s[24:27], s45 offen sc1
    s_sub_u32 s48, s48, 1
    s_cbranch_scc1 Ltail_gotk
    s_waitcnt vmcnt(0)
    v_max_u32 v106, v104, v105
    v_cmp_eq_u32 vcc, -1, v106
    s_cbranch_vccnz Ltail_pollk
Ltail_gotk:
    s_waitcnt vmcnt(0)
    v_mov_b32_dpp v106, v104 row_ror:1 row_mask:0xf bank_mask:0xf
    v_mov_b32_dpp v107, v105 row_ror:1 row_mask:0xf bank_mask:0xf
    v_min_u32 v110, v104, v106
    v_max_u32 v104, v104, v106
    v_max3_u32 v105, v110, v105, v107
    s_nop 0
    v_mov_b32_dpp v106, v104 row_ror:2 row_mask:0xf bank_mask:0xf
    v_mov_b32_dpp v107, v105 row_ror:2 row_mask:0xf bank_mask:0xf
    v_min_u32 v110, v104, v106
    v_max_u32 v104, v104, v106
    v_max3_u32 v105, v110, v105, v107
    s_nop 0
    v_mov_b32_dpp v106, v104 row_ror:4 row_mask:0xf bank_mask:0xf
    v_mov_b32_dpp v107, v105 row_ror:4 row_mask:0xf bank_mask:0xf
    v_min_u32 v110, v104, v106
    v_max_u32 v104, v104, v106
    v_max3_u32 v105, v110, v105, v107
    s_nop 0
    v_mov_b32_dpp v106, v104 row_ror:8 row_mask:0xf bank_mask:0xf
    v_mov_b32_dpp v107, v105 row_ror:8 row_mask:0xf bank_mask:0xf
    v_min_u32 v110, v104, v106
    v_max_u32 v104, v104, v106
    v_max3_u32 v105, v110, v105, v107
    v_mov_b32 v106, v104
    v_mov_b32 v107, v105
    s_nop 0
    v_permlane16_swap_b32 v104, v106
    v_permlane16_swap_b32 v105, v107
    v_min_u32 v110, v104, v106
    v_max_u32 v104, v104, v106
    v_max3_u32 v105, v110, v105, v107
    v_mov_b32 v106, v104
    v_mov_b32 v107, v105
    s_nop 0
    v_permlane32_swap_b32 v104, v106
    v_permlane32_swap_b32 v105, v107
    v_min_u32 v110, v104, v106
    v_max_u32 v104, v104, v106
    v_max3_u32 v105, v110, v105, v107
    ds_write_b64 v109, v[104:105] offset:36928
    v_mov_b32 v109, 36928
    s_waitcnt lgkmcnt(0)
    s_barrier
    ds_read_b128 v[96:99], v109
    ds_read_b128 v[100:103], v109 offset:16
    s_waitcnt lgkmcnt(1)
    v_max_u32 v104, v96, v97
    v_min_u32 v105, v96, v97
    v_med3_u32 v105, v104, v105, v98
    v_max_u32 v104, v104, v98
    v_med3_u32 v105, v104, v105, v99
    v_max_u32 v104, v104, v99
    s_waitcnt lgkmcnt(0)
    v_med3_u32 v105, v104, v105, v100
    v_max_u32 v104, v104, v100
    v_med3_u32 v105, v104, v105, v101
    v_max_u32 v104, v104, v101
    v_med3_u32 v105, v104, v105, v102
    v_max_u32 v104, v104, v102
    v_med3_u32 v105, v104, v105, v103
    v_max_u32 v104, v104, v103
    s_nop 0
    v_readfirstlane_b32 s92, v104
    v_readfirstlane_b32 s93, v105
    s_andn2_b32 s46, 0x7ff, s92
    s_andn2_b32 s47, 0x7ff, s93
    s_mul_i32 s44, s46, 2304
    s_mul_i32 s45, s47, 2304
    s_sub_u32 s45, s45, s44
    v_mad_i32_i24 v10, v10, s45, v9
    s_add_u32 s45, s44, 2621440
    v_add_u32 v10, s45, v10
    s_mov_b32 s48, 16384
Ltail_pollh:
    s_mov_b32 exec_lo, 0xffffff
    s_mov_b32 exec_hi, 0xffffff
    s_add_u32 m0, s38, 0
    s_nop 0
    buffer_load_dwordx4 v10, s[24:27], 0 offen offset:0 sc1 lds
    s_add_u32 m0, s38, 640
    s_nop 0
    buffer_load_dwordx4 v10, s[24:27], 0 offen offset:384 sc1 lds
    s_add_u32 m0, s38, 1280
    s_nop 0
    buffer_load_dwordx4 v10, s[24:27], 0 offen offset:768 sc1 lds
    s_mov_b64 exec, -1
    s_waitcnt vmcnt(0)
    ds_read_b128 a[0:3], v11 offset:0
    ds_read_b128 a[4:7], v11 offset:64
    ds_read_b128 a[8:11], v11 offset:128
    ds_read_b128 a[12:15], v11 offset:192
    ds_read_b128 a[16:19], v11 offset:256
    ds_read_b128 a[20:23], v11 offset:320
    ds_read_b128 a[24:27], v11 offset:1024
    ds_read_b128 a[28:31], v11 offset:1088
    ds_read_b128 a[32:35], v11 offset:1152
    ds_read_b128 a[36:39], v11 offset:1216
    ds_read_b128 a[40:43], v11 offset:1280
    ds_read_b128 a[44:47], v11 offset:1344
    ds_read_b128 a[48:51], v11 offset:2048
    ds_read_b128 a[52:55], v11 offset:2112
    ds_read_b128 a[56:59], v11 offset:2176
    ds_read_b128 a[60:63], v11 offset:2240
    ds_read_b128 a[64:67], v11 offset:2304
    ds_read_b128 a[68:71], v11 offset:2368
    s_waitcnt lgkmcnt(15)
    v_mfma_f32_16x16x32_bf16 v[16:19], a[96:99], a[0:3], 0
    v_mfma_f32_16x16x32_bf16 v[20:23], a[100:103], a[4:7], 0
    v_mfma_f32_16x16x32_bf16 v[16:19], a[104:107], a[8:11], v[16:19]
    s_waitcnt lgkmcnt(14)
    v_mfma_f32_16x16x32_bf16 v[20:23], a[108:111], a[12:15], v[20:23]
    s_waitcnt lgkmcnt(13)
    v_mfma_f32_16x16x32_bf16 v[16:19], a[112:115], a[16:19], v[16:19]
    s_waitcnt lgkmcnt(12)
    v_mfma_f32_16x16x32_bf16 v[20:23], a[116:119], a[20:23], v[20:23]
    s_waitcnt lgkmcnt(11)
    v_mfma_f32_16x16x32_bf16 v[16:19], a[120:123], a[24:27], v[16:19]
    s_waitcnt lgkmcnt(10)
    v_mfma_f32_16x16x32_bf16 v[20:23], a[124:127], a[28:31], v[20:23]
    s_waitcnt lgkmcnt(9)
    v_mfma_f32_16x16x32_bf16 v[16:19], a[128:131], a[32:35], v[16:19]
    s_waitcnt lgkmcnt(8)
    v_mfma_f32_16x16x32_bf16 v[20:23], a[132:135], a[36:39], v[20:23]
    s_waitcnt lgkmcnt(7)
    v_mfma_f32_16x16x32_bf16 v[16:19], a[136:139], a[40:43], v[16:19]
    s_waitcnt lgkmcnt(6)
    v_mfma_f32_16x16x32_bf16 v[20:23], a[140:143], a[44:47], v[20:23]
    s_waitcnt lgkmcnt(5)
    v_mfma_f32_16x16x32_bf16 v[16:19], a[144:147], a[48:51], v[16:19]
    s_waitcnt lgkmcnt(4)
    v_mfma_f32_16x16x32_bf16 v[20:23], a[148:151], a[52:55], v[20:23]
    s_waitcnt lgkmcnt(3)
    v_mfma_f32_16x16x32_bf16 v[16:19], a[152:155], a[56:59], v[16:19]
    s_waitcnt lgkmcnt(2)
    v_mfma_f32_16x16x32_bf16 v[20:23], a[156:159], a[60:63], v[20:23]
    s_waitcnt lgkmcnt(1)
    v_mfma_f32_16x16x32_bf16 v[16:19], a[160:163], a[64:67], v[16:19]
    s_waitcnt lgkmcnt(0)
    v_mfma_f32_16x16x32_bf16 v[20:23], a[164:167], a[68:71], v[20:23]
    s_sub_u32 s48, s48, 1
    s_nop 6
    v_pk_add_f32 v[16:17], v[16:17], v[20:21]
    v_pk_add_f32 v[18:19], v[18:19], v[22:23]
    s_cbranch_scc1 Ltail_goth
    v_cmp_u_f32 vcc, v16, v16
    s_and_b32 s36, vcc_lo, 3
    s_cbranch_scc1 Ltail_pollh
Ltail_goth:
    v_cvt_pk_bf16_f32 v32, v16, v17
    v_cvt_pk_bf16_f32 v33, v18, v19
    v_lshlrev_b32 v16, 16, v32
    v_and_b32 v17, 0xffff0000, v32
    v_lshlrev_b32 v18, 16, v33
    v_and_b32 v19, 0xffff0000, v33
    v_pk_mul_f32 v[32:33], v[16:17], v[40:41] op_sel_hi:[1,0]
    v_pk_mul_f32 v[34:35], v[18:19], v[40:41] op_sel_hi:[1,0]
    v_exp_f32 v32, v32
    v_exp_f32 v33, v33
    v_exp_f32 v34, v34
    v_exp_f32 v35, v35
    v_fma_f32 v32, v32, v41, 1.0
    v_fma_f32 v33, v33, v41, 1.0
    v_fma_f32 v34, v34, v41, 1.0
    v_fma_f32 v35, v35, v41, 1.0
    v_rcp_f32 v32, v32
    v_rcp_f32 v33, v33
    v_rcp_f32 v34, v34
    v_rcp_f32 v35, v35
    v_pk_mul_f32 v[16:17], v[16:17], v[32:33]
    v_pk_mul_f32 v[18:19], v[18:19], v[34:35]
    v_cvt_pk_bf16_f32 v32, v16, v17
    v_cvt_pk_bf16_f32 v33, v18, v19
    v_lshlrev_b32 v16, 16, v32
    v_and_b32 v17, 0xffff0000, v32
    v_lshlrev_b32 v18, 16, v33
    v_and_b32 v19, 0xffff0000, v33
    ds_write_b128 v14, v[16:19]
    s_waitcnt lgkmcnt(0)
    s_barrier
    ds_read_b128 v[16:19], v13 offset:0
    ds_read_b128 v[24:27], v13 offset:2048
    ds_read_b128 v[20:23], v13 offset:1024
    ds_read_b128 v[28:31], v13 offset:3072
    s_waitcnt lgkmcnt(2)
    v_pk_mul_f32 v[16:17], v[16:17], v[24:25]
    v_pk_mul_f32 v[18:19], v[18:19], v[26:27]
    v_cvt_pk_bf16_f32 v32, v16, v17
    v_cvt_pk_bf16_f32 v33, v18, v19
    s_waitcnt lgkmcnt(0)
    v_pk_mul_f32 v[20:21], v[20:21], v[28:29]
    v_pk_mul_f32 v[22:23], v[22:23], v[30:31]
    v_cvt_pk_bf16_f32 v34, v20, v21
    v_cvt_pk_bf16_f32 v35, v22, v23
    v_cndmask_b32 v64, 0, v32, s[52:53]
    v_cndmask_b32 v65, 0, v33, s[52:53]
    v_cndmask_b32 v66, 0, v34, s[52:53]
    v_cndmask_b32 v67, 0, v35, s[52:53]
    s_nop 1
    v_mfma_f32_16x16x32_bf16 v[16:19], v[64:67], a[168:171], 0
    v_cndmask_b32 v68, 0, v32, s[54:55]
    v_cndmask_b32 v69, 0, v33, s[54:55]
    v_mfma_f32_16x16x32_bf16 v[20:23], v[64:67], a[184:187], 0
    v_cndmask_b32 v70, 0, v34, s[54:55]
    v_cndmask_b32 v71, 0, v35, s[54:55]
    v_mfma_f32_16x16x32_bf16 v[24:27], v[64:67], a[200:203], 0
    s_nop 0
    v_mfma_f32_16x16x32_bf16 v[16:19], v[68:71], a[172:175], v[16:19]
Ltour1_1:
    s_cbranch_execz Lmain1
    v_cndmask_b32 v72, 0, v32, s[56:57]
    v_cndmask_b32 v73, 0, v33, s[56:57]
    v_mfma_f32_16x16x32_bf16 v[20:23], v[68:71], a[188:191], v[20:23]
    v_cndmask_b32 v74, 0, v34, s[56:57]
    v_cndmask_b32 v75, 0, v35, s[56:57]
    v_mfma_f32_16x16x32_bf16 v[24:27], v[68:71], a[204:207], v[24:27]
    s_nop 0
    v_mfma_f32_16x16x32_bf16 v[16:19], v[72:75], a[176:179], v[16:19]
    v_cndmask_b32 v76, 0, v32, s[58:59]
    v_cndmask_b32 v77, 0, v33, s[58:59]
    v_mfma_f32_16x16x32_bf16 v[20:23], v[72:75], a[192:195], v[20:23]
    v_cndmask_b32 v78, 0, v34, s[58:59]
    v_cndmask_b32 v79, 0, v35, s[58:59]
    v_mfma_f32_16x16x32_bf16 v[24:27], v[72:75], a[208:211], v[24:27]
    s_nop 0
    v_mfma_f32_16x16x32_bf16 v[16:19], v[76:79], a[180:183], v[16:19]
    v_mfma_f32_16x16x32_bf16 v[20:23], v[76:79], a[196:199], v[20:23]
    v_mfma_f32_16x16x32_bf16 v[24:27], v[76:79], a[212:215], v[24:27]
    s_nop 5
    v_min_u32 v16, -2, v16
    v_min_u32 v17, -2, v17
    buffer_store_dwordx2 v[16:17], v15, s[8:11], s43 offen sc1
    s_add_u32 s43, s43, 294912
    v_min_u32 v20, -2, v20
    v_min_u32 v21, -2, v21
    buffer_store_dwordx2 v[20:21], v15, s[8:11], s43 offen sc1
    s_add_u32 s43, s43, 294912
    v_min_u32 v24, -2, v24
    v_min_u32 v25, -2, v25
    buffer_store_dwordx2 v[24:25], v15, s[8:11], s43 offen sc1
    s_or_b32 s36, s2, s3
    s_cselect_b32 s37, -4, 24576
    s_add_u32 s36, s94, 1
    v_mov_b32 v106, s36
    buffer_store_dword v106, v8, s[24:27], s37 offen sc1
    v_cmp_ne_u32 vcc, s46, v7
    v_cmp_ne_u32 s[36:37], s47, v7
    v_mov_b32 v31, 2147483648
    s_and_b64 vcc, vcc, s[36:37]
    s_nop 1
    v_cndmask_b32 v30, v31, v58, vcc
    v_cndmask_b32 v31, v31, v4, vcc
    buffer_store_dwordx4 v[144:147], v31, s[16:19], 0 offen offset:0 nt
    buffer_store_dwordx4 v[148:151], v31, s[16:19], 0 offen offset:512 nt
    buffer_store_dwordx4 v[152:155], v30, s[16:19], 0 offen offset:1024 nt
    s_cmp_lt_u32 s41, 9
    s_cselect_b32 s36, s3, 0
    s_cmp_lg_u32 s36, 3
    s_cbranch_scc1 Ltail_done
    s_mul_i32 s43, s42, 9
    s_add_u32 s43, s43, s41
    v_bfe_u32 v8, v1, 2, 1
    v_cmp_eq_u32 vcc, 1, v8
    v_mov_b32 v9, s46
    v_mov_b32 v10, s47
    v_and_b32 v11, 3, v1
    v_cndmask_b32 v9, v9, v10, vcc
    s_lshr_b32 s44, s43, 2
    s_lshl_b32 s44, s44, 6
    s_and_b32 s45, s43, 1
    s_lshl_b32 s45, s45, 5
    s_add_u32 s44, s44, s45
    s_and_b32 s45, s43, 2
    s_lshl_b32 s45, s45, 2
    s_add_u32 s44, s44, s45
    v_lshrrev_b32 v12, 1, v11
    v_lshl_add_u32 v12, v12, 4, s44
    v_and_b32 v13, 1, v11
    v_lshl_add_u32 v12, v13, 2, v12
    v_mul_u32_u24 v13, 1152, v9
    v_lshl_add_u32 v14, v13, 1, v12
    v_add_u32 v15, 2621440, v14
    s_mov_b32 s45, 22144
    buffer_load_dword v18, v12, s[24:27], s45 offen sc1
    v_mov_b32 v19, s92
    v_mov_b32 v10, s93
    v_cndmask_b32 v19, v19, v10, vcc
    v_and_b32 v19, 0xfffff800, v19
    v_or_b32 v19, 0x400, v19
    v_ashrrev_i32 v10, 31, v19
    v_not_b32 v10, v10
    v_or_b32 v10, 0x80000000, v10
    v_xor_b32 v19, v19, v10
    s_lshl_b32 s45, s43, 4
    v_lshl_add_u32 v13, v11, 2, v13
    v_add_u32 v13, s45, v13
    v_lshrrev_b32 v14, 2, v1
    v_lshlrev_b32 v14, 9, v14
    v_lshl_add_u32 v14, v11, 4, v14
    s_lshr_b32 s44, s43, 3
    s_mul_i32 s44, s44, 73728
    s_and_b32 s45, s43, 7
    s_lshl_b32 s45, s45, 6
    s_add_u32 s44, s44, s45
    v_cmp_eq_u32 s[38:39], 1, v8
    v_cvt_pk_bf16_f32 v19, v19, v19
    v_and_b32 v19, 0xffff0000, v19
    v_mul_f32 v19, 0xbfb8aa3b, v19
    v_exp_f32 v19, v19
    s_waitcnt vmcnt(0)
    v_lshlrev_b32 v24, 16, v18
    v_and_b32 v25, 0xffff0000, v18
    v_add_f32 v19, 1.0, v19
    v_rcp_f32 v19, v19
    s_mov_b32 s48, 262144
    v_cvt_pk_bf16_f32 v19, v19, v19
    v_and_b32 v19, 0xffff0000, v19
Ltail_polly:
    s_add_u32 s45, s44, 0
    buffer_load_dwordx4 v[64:67], v14, s[8:11], s45 offen sc1
    s_add_u32 s45, s44, 8192
    buffer_load_dwordx4 v[68:71], v14, s[8:11], s45 offen sc1
    s_add_u32 s45, s44, 16384
    buffer_load_dwordx4 v[72:75], v14, s[8:11], s45 offen sc1
    s_add_u32 s45, s44, 24576
    buffer_load_dwordx4 v[76:79], v14, s[8:11], s45 offen sc1
    s_add_u32 s45, s44, 32768
    buffer_load_dwordx4 v[80:83], v14, s[8:11], s45 offen sc1
    s_add_u32 s45, s44, 40960
    buffer_load_dwordx4 v[84:87], v14, s[8:11], s45 offen sc1
    s_add_u32 s45, s44, 49152
    buffer_load_dwordx4 v[88:91], v14, s[8:11], s45 offen sc1
    s_add_u32 s45, s44, 57344
    buffer_load_dwordx4 v[92:95], v14, s[8:11], s45 offen sc1
    s_add_u32 s45, s44, 65536
    buffer_load_dwordx4 v[96:99], v14, s[8:11], s45 offen sc1
    s_mov_b32 s45, 1152
    buffer_load_dword v16, v15, s[24:27], s45 offen sc1
    buffer_load_dword v17, v15, s[24:27], 0 offen sc1
    s_sub_u32 s48, s48, 1
    s_cbranch_scc1 Ltail_goty
    s_waitcnt vmcnt(10)
    v_max3_u32 v26, v64, v65, v66
    s_waitcnt vmcnt(9)
    v_max3_u32 v26, v26, v67, v68
    v_max3_u32 v26, v26, v69, v70
    s_waitcnt vmcnt(8)
    v_max3_u32 v26, v26, v71, v72
    v_max3_u32 v26, v26, v73, v74
    s_waitcnt vmcnt(7)
    v_max3_u32 v26, v26, v75, v76
    v_max3_u32 v26, v26, v77, v78
    s_waitcnt vmcnt(6)
    v_max3_u32 v26, v26, v79, v80
    v_max3_u32 v26, v26, v81, v82
    s_waitcnt vmcnt(5)
    v_max3_u32 v26, v26, v83, v84
    v_max3_u32 v26, v26, v85, v86
    s_waitcnt vmcnt(4)
    v_max3_u32 v26, v26, v87, v88
    v_max3_u32 v26, v26, v89, v90
    s_waitcnt vmcnt(3)
    v_max3_u32 v26, v26, v91, v92
    v_max3_u32 v26, v26, v93, v94
    s_waitcnt vmcnt(2)
    v_max3_u32 v26, v26, v95, v96
    v_max3_u32 v26, v26, v97, v98
    v_max_u32 v26, v26, v99
    s_waitcnt vmcnt(0)
    v_max3_u32 v26, v26, v16, v17
    v_cmp_eq_u32 vcc, -1, v26
    s_cbranch_vccnz Ltail_polly
Ltail_goty:
    s_waitcnt vmcnt(0) lgkmcnt(0)
    v_lshlrev_b32 v20, 16, v16
    v_and_b32 v21, 0xffff0000, v16
    v_lshlrev_b32 v22, 16, v17
    v_and_b32 v23, 0xffff0000, v17
    v_pk_add_f32 v[64:65], v[64:65], v[68:69]
    v_pk_add_f32 v[66:67], v[66:67], v[70:71]
    v_pk_add_f32 v[64:65], v[64:65], v[72:73]
    v_pk_add_f32 v[66:67], v[66:67], v[74:75]
    v_pk_add_f32 v[64:65], v[64:65], v[76:77]
    v_pk_add_f32 v[66:67], v[66:67], v[78:79]
    v_pk_add_f32 v[64:65], v[64:65], v[80:81]
    v_pk_add_f32 v[66:67], v[66:67], v[82:83]
    v_pk_add_f32 v[64:65], v[64:65], v[84:85]
    v_pk_add_f32 v[66:67], v[66:67], v[86:87]
    v_pk_add_f32 v[64:65], v[64:65], v[88:89]
    v_pk_add_f32 v[66:67], v[66:67], v[90:91]
    v_pk_add_f32 v[64:65], v[64:65], v[92:93]
    v_pk_add_f32 v[66:67], v[66:67], v[94:95]
    v_pk_add_f32 v[64:65], v[64:65], v[96:97]
    v_pk_add_f32 v[66:67], v[66:67], v[98:99]
    s_nop 0
    v_add_f32_dpp v64, v64, v64 row_ror:4 row_mask:0xf bank_mask:0xf
    v_add_f32_dpp v65, v65, v65 row_ror:4 row_mask:0xf bank_mask:0xf
    v_add_f32_dpp v66, v66, v66 row_ror:4 row_mask:0xf bank_mask:0xf
    v_add_f32_dpp v67, v67, v67 row_ror:4 row_mask:0xf bank_mask:0xf
    v_add_f32_dpp v64, v64, v64 row_ror:8 row_mask:0xf bank_mask:0xf
    v_add_f32_dpp v65, v65, v65 row_ror:8 row_mask:0xf bank_mask:0xf
    v_add_f32_dpp v66, v66, v66 row_ror:8 row_mask:0xf bank_mask:0xf
    v_add_f32_dpp v67, v67, v67 row_ror:8 row_mask:0xf bank_mask:0xf
    v_mov_b32 v68, v64
    v_mov_b32 v69, v65
    v_mov_b32 v70, v66
    v_mov_b32 v71, v67
    v_permlane16_swap_b32 v64, v68
    v_permlane16_swap_b32 v65, v69
    v_permlane16_swap_b32 v66, v70
    v_permlane16_swap_b32 v67, v71
    v_add_f32 v64, v64, v68
    v_add_f32 v65, v65, v69
    v_add_f32 v66, v66, v70
    v_add_f32 v67, v67, v71
    v_mov_b32 v68, v64
    v_mov_b32 v69, v65
    v_mov_b32 v70, v66
    v_mov_b32 v71, v67
    v_permlane32_swap_b32 v64, v68
    v_permlane32_swap_b32 v65, v69
    v_permlane32_swap_b32 v66, v70
    v_permlane32_swap_b32 v67, v71
    v_add_f32 v64, v64, v68
    v_add_f32 v65, v65, v69
    v_add_f32 v66, v66, v70
    v_add_f32 v67, v67, v71
    v_cndmask_b32 v26, v64, v65, s[38:39]
    v_cndmask_b32 v27, v66, v67, s[38:39]
    v_cvt_pk_bf16_f32 v28, v26, v27
    v_lshlrev_b32 v26, 16, v28
    v_and_b32 v27, 0xffff0000, v28
    v_mul_f32 v26, v26, v19
    v_mul_f32 v27, v27, v19
    v_cvt_pk_bf16_f32 v28, v26, v27
    v_lshlrev_b32 v26, 16, v28
    v_and_b32 v27, 0xffff0000, v28
    v_pk_add_f32 v[26:27], v[26:27], v[22:23]
    v_cvt_pk_bf16_f32 v28, v26, v27
    v_lshlrev_b32 v26, 16, v28
    v_and_b32 v27, 0xffff0000, v28
    v_pk_mul_f32 v[26:27], v[26:27], v[24:25]
    v_cvt_pk_bf16_f32 v28, v26, v27
    v_lshlrev_b32 v26, 16, v28
    v_and_b32 v27, 0xffff0000, v28
    v_pk_add_f32 v[26:27], v[26:27], v[20:21]
    v_cvt_pk_bf16_f32 v28, v26, v27
    s_mov_b64 exec, 0xff
    buffer_store_dword v28, v13, s[16:19], 0 offen nt
    s_branch Ltail_done
Ltail_idle:
Ltour1_2:
    s_cbranch_execz Lmain1
    v_lshlrev_b32 v216, 16, v64
    v_and_b32 v217, 0xffff0000, v64
    v_lshlrev_b32 v218, 16, v65
    v_and_b32 v219, 0xffff0000, v65
    v_lshlrev_b32 v220, 16, v66
    v_and_b32 v221, 0xffff0000, v66
    v_lshlrev_b32 v222, 16, v67
    v_and_b32 v223, 0xffff0000, v67
    v_lshlrev_b32 v224, 16, v68
    v_and_b32 v225, 0xffff0000, v68
    v_lshlrev_b32 v226, 16, v69
    v_and_b32 v227, 0xffff0000, v69
    v_lshlrev_b32 v228, 16, v70
    v_and_b32 v229, 0xffff0000, v70
    v_lshlrev_b32 v230, 16, v71
    v_and_b32 v231, 0xffff0000, v71
    v_lshlrev_b32 v232, 16, v72
    v_and_b32 v233, 0xffff0000, v72
    v_lshlrev_b32 v234, 16, v73
    v_and_b32 v235, 0xffff0000, v73
    v_lshlrev_b32 v236, 16, v74
    v_and_b32 v237, 0xffff0000, v74
    v_lshlrev_b32 v238, 16, v75
    v_and_b32 v239, 0xffff0000, v75
    v_pk_mul_f32 v[192:193], v[192:193], v[216:217]
    v_pk_mul_f32 v[194:195], v[194:195], v[218:219]
    v_pk_mul_f32 v[196:197], v[196:197], v[220:221]
    v_pk_mul_f32 v[198:199], v[198:199], v[222:223]
    v_pk_mul_f32 v[200:201], v[200:201], v[224:225]
    v_pk_mul_f32 v[202:203], v[202:203], v[226:227]
    v_pk_mul_f32 v[204:205], v[204:205], v[228:229]
    v_pk_mul_f32 v[206:207], v[206:207], v[230:231]
    v_pk_mul_f32 v[208:209], v[208:209], v[232:233]
    v_pk_mul_f32 v[210:211], v[210:211], v[234:235]
    v_pk_mul_f32 v[212:213], v[212:213], v[236:237]
    v_pk_mul_f32 v[214:215], v[214:215], v[238:239]
    v_cvt_pk_bf16_f32 v144, v192, v193
    v_cvt_pk_bf16_f32 v145, v194, v195
    v_cvt_pk_bf16_f32 v146, v196, v197
    v_cvt_pk_bf16_f32 v147, v198, v199
    v_cvt_pk_bf16_f32 v148, v200, v201
    v_cvt_pk_bf16_f32 v149, v202, v203
    v_cvt_pk_bf16_f32 v150, v204, v205
    v_cvt_pk_bf16_f32 v151, v206, v207
    v_cvt_pk_bf16_f32 v152, v208, v209
    v_cvt_pk_bf16_f32 v153, v210, v211
    v_cvt_pk_bf16_f32 v154, v212, v213
    v_cvt_pk_bf16_f32 v155, v214, v215
    v_lshlrev_b32 v192, 16, v144
    v_and_b32 v193, 0xffff0000, v144
    v_lshlrev_b32 v194, 16, v145
    v_and_b32 v195, 0xffff0000, v145
    v_lshlrev_b32 v196, 16, v146
    v_and_b32 v197, 0xffff0000, v146
    v_lshlrev_b32 v198, 16, v147
    v_and_b32 v199, 0xffff0000, v147
    v_lshlrev_b32 v200, 16, v148
    v_and_b32 v201, 0xffff0000, v148
    v_lshlrev_b32 v202, 16, v149
    v_and_b32 v203, 0xffff0000, v149
    v_lshlrev_b32 v204, 16, v150
    v_and_b32 v205, 0xffff0000, v150
    v_lshlrev_b32 v206, 16, v151
    v_and_b32 v207, 0xffff0000, v151
    v_lshlrev_b32 v208, 16, v152
    v_and_b32 v209, 0xffff0000, v152
    v_lshlrev_b32 v210, 16, v153
    v_and_b32 v211, 0xffff0000, v153
    v_lshlrev_b32 v212, 16, v154
    v_and_b32 v213, 0xffff0000, v154
    v_lshlrev_b32 v214, 16, v155
    v_and_b32 v215, 0xffff0000, v155
    v_pk_add_f32 v[192:193], v[192:193], v[12:13]
    v_pk_add_f32 v[194:195], v[194:195], v[14:15]
    v_pk_add_f32 v[196:197], v[196:197], v[16:17]
    v_pk_add_f32 v[198:199], v[198:199], v[18:19]
    v_pk_add_f32 v[200:201], v[200:201], v[20:21]
    v_pk_add_f32 v[202:203], v[202:203], v[22:23]
    v_pk_add_f32 v[204:205], v[204:205], v[24:25]
    v_pk_add_f32 v[206:207], v[206:207], v[26:27]
    v_pk_add_f32 v[208:209], v[208:209], v[28:29]
    v_pk_add_f32 v[210:211], v[210:211], v[30:31]
    v_pk_add_f32 v[212:213], v[212:213], v[32:33]
    v_pk_add_f32 v[214:215], v[214:215], v[34:35]
    v_cvt_pk_bf16_f32 v156, v192, v193
    v_cvt_pk_bf16_f32 v157, v194, v195
    v_cvt_pk_bf16_f32 v158, v196, v197
    v_cvt_pk_bf16_f32 v159, v198, v199
    v_cvt_pk_bf16_f32 v160, v200, v201
    v_cvt_pk_bf16_f32 v161, v202, v203
    v_cvt_pk_bf16_f32 v162, v204, v205
    v_cvt_pk_bf16_f32 v163, v206, v207
    v_cvt_pk_bf16_f32 v164, v208, v209
    v_cvt_pk_bf16_f32 v165, v210, v211
    v_cvt_pk_bf16_f32 v166, v212, v213
    v_cvt_pk_bf16_f32 v167, v214, v215
    v_and_b32 v30, 2, v1
    v_cmp_ne_u32 vcc, 0, v30
    v_mul_u32_u24 v30, 1152, v7
    v_add_u32 v4, v30, v5
    v_add_u32 v58, v30, v59
    v_mov_b32_dpp v192, v158 quad_perm:[0,2,0,2] row_mask:0xf bank_mask:0xf
    v_mov_b32_dpp v193, v159 quad_perm:[0,2,0,2] row_mask:0xf bank_mask:0xf
    v_mov_b32_dpp v194, v158 quad_perm:[1,3,1,3] row_mask:0xf bank_mask:0xf
    v_mov_b32_dpp v195, v159 quad_perm:[1,3,1,3] row_mask:0xf bank_mask:0xf
    v_mov_b32_dpp v196, v162 quad_perm:[0,2,0,2] row_mask:0xf bank_mask:0xf
    v_mov_b32_dpp v197, v163 quad_perm:[0,2,0,2] row_mask:0xf bank_mask:0xf
    v_mov_b32_dpp v198, v162 quad_perm:[1,3,1,3] row_mask:0xf bank_mask:0xf
    v_mov_b32_dpp v199, v163 quad_perm:[1,3,1,3] row_mask:0xf bank_mask:0xf
    v_mov_b32_dpp v200, v166 quad_perm:[0,2,0,2] row_mask:0xf bank_mask:0xf
    v_mov_b32_dpp v201, v167 quad_perm:[0,2,0,2] row_mask:0xf bank_mask:0xf
    v_mov_b32_dpp v202, v166 quad_perm:[1,3,1,3] row_mask:0xf bank_mask:0xf
    v_mov_b32_dpp v203, v167 quad_perm:[1,3,1,3] row_mask:0xf bank_mask:0xf
    v_cndmask_b32_dpp v144, v156, v192, vcc quad_perm:[0,2,0,2] row_mask:0xf bank_mask:0xf
    v_cndmask_b32_dpp v145, v157, v193, vcc quad_perm:[0,2,0,2] row_mask:0xf bank_mask:0xf
    v_cndmask_b32_dpp v146, v156, v194, vcc quad_perm:[1,3,1,3] row_mask:0xf bank_mask:0xf
    v_cndmask_b32_dpp v147, v157, v195, vcc quad_perm:[1,3,1,3] row_mask:0xf bank_mask:0xf
    v_cndmask_b32_dpp v148, v160, v196, vcc quad_perm:[0,2,0,2] row_mask:0xf bank_mask:0xf
    v_cndmask_b32_dpp v149, v161, v197, vcc quad_perm:[0,2,0,2] row_mask:0xf bank_mask:0xf
    v_cndmask_b32_dpp v150, v160, v198, vcc quad_perm:[1,3,1,3] row_mask:0xf bank_mask:0xf
    v_cndmask_b32_dpp v151, v161, v199, vcc quad_perm:[1,3,1,3] row_mask:0xf bank_mask:0xf
    v_cndmask_b32_dpp v152, v164, v200, vcc quad_perm:[0,2,0,2] row_mask:0xf bank_mask:0xf
    v_cndmask_b32_dpp v153, v165, v201, vcc quad_perm:[0,2,0,2] row_mask:0xf bank_mask:0xf
    v_cndmask_b32_dpp v154, v164, v202, vcc quad_perm:[1,3,1,3] row_mask:0xf bank_mask:0xf
    v_cndmask_b32_dpp v155, v165, v203, vcc quad_perm:[1,3,1,3] row_mask:0xf bank_mask:0xf
    buffer_store_dwordx4 v[144:147], v4, s[16:19], 0 offen offset:0 sc1
    buffer_store_dwordx4 v[148:151], v4, s[16:19], 0 offen offset:512 sc1
    buffer_store_dwordx4 v[152:155], v58, s[16:19], 0 offen offset:1024 sc1
    s_waitcnt vmcnt(0)
    s_mov_b32 s36, 2622592
    buffer_store_dwordx4 v[36:39], v6, s[24:27], s36 offen offset:0 sc1
    buffer_store_dwordx4 v[40:43], v6, s[24:27], s36 offen offset:512 sc1
    buffer_store_dwordx4 v[44:47], v60, s[24:27], s36 offen offset:1024 sc1
Ltail_done:
    s_endpgm
Lattn_wb:
    buffer_wbl2 sc1
    s_waitcnt vmcnt(0)
    s_branch Lattn_wbdone
Lattn_xspin:
Ltour0_12:
    s_cbranch_execz Lmain0
    s_mov_b32 s37, 262144
Lattn_xloop:
    buffer_load_dword v11, v8, s[24:27], s54 offen offset:8 sc1
    s_waitcnt vmcnt(0)
    v_readfirstlane_b32 s36, v11
    s_sub_u32 s37, s37, 1
    s_cbranch_scc1 Lattn_xgot
    s_cmp_lg_u32 s36, s95
    s_cbranch_scc1 Lattn_xloop
    s_branch Lattn_xgot
Ltail_spin1:
Ltour1_3:
    s_cbranch_execz Lmain1
    s_mov_b32 s48, 262144
Ltail_spinl1:
    buffer_load_dword v11, v9, s[24:27], s39 offen sc1
    s_waitcnt vmcnt(0)
    v_cmp_ne_u32 s[54:55], s95, v11
    s_sub_u32 s48, s48, 1
    s_cbranch_scc1 Ltail_got1
    s_cmp_lg_u64 s[54:55], 0
    s_cbranch_scc1 Ltail_spinl1
    s_branch Ltail_got1
Ltail_spin2:
Ltour1_4:
    s_cbranch_execz Lmain1
    s_mov_b32 s48, 262144
Ltail_spinl2:
    buffer_load_dword v11, v9, s[24:27], s39 offen sc1
    s_waitcnt vmcnt(0)
    v_cmp_ne_u32 s[54:55], s95, v11
    s_sub_u32 s48, s48, 1
    s_cbranch_scc1 Ltail_got2
    s_cmp_lg_u64 s[54:55], 0
    s_cbranch_scc1 Ltail_spinl2
    s_branch Ltail_got2
Lattn_redo:
    s_load_dwordx2 s[16:17], s[0:1], 88
    v_xor_b32 v8, 64, v9
    v_xor_b32 v10, 64, v11
    s_waitcnt vmcnt(0) lgkmcnt(0)
    s_barrier
    v_mov_b32 v232, 0xff800000
    v_mov_b32 v233, 0xff800000
    v_mov_b32 v234, 0xff800000
    v_mov_b32 v235, 0xff800000
    s_mov_b32 s40, 0
    s_mov_b32 s48, -1
Lattn_redo_loop:
    s_add_u32 m0, s42, 0
    s_nop 0
    buffer_load_dwordx4 v36, s[8:11], s40 offen lds
    buffer_load_dwordx4 v37, s[8:11], s40 offen offset:1024 lds
    buffer_load_dwordx4 v38, s[8:11], s40 offen offset:2048 lds
    buffer_load_dwordx4 v39, s[8:11], s40 offen offset:3072 lds
    s_add_u32 s40, s40, 16384
    s_waitcnt vmcnt(0) lgkmcnt(0)
    s_barrier
    ds_read_b128 a[208:211], v8 offset:0
    ds_read_b128 a[212:215], v9 offset:0
    ds_read_b128 a[216:219], v10 offset:0
    ds_read_b128 a[220:223], v11 offset:0
    s_waitcnt lgkmcnt(3)
    v_mfma_f32_16x16x32_bf16 v[216:219], a[208:211], v[64:67], 0
    s_waitcnt lgkmcnt(2)
    v_mfma_f32_16x16x32_bf16 v[216:219], a[212:215], v[68:71], v[216:219]
    s_waitcnt lgkmcnt(1)
    v_mfma_f32_16x16x32_bf16 v[216:219], a[216:219], v[72:75], v[216:219]
    s_waitcnt lgkmcnt(0)
    v_mfma_f32_16x16x32_bf16 v[216:219], a[220:223], v[76:79], v[216:219]
    v_mfma_f32_16x16x32_bf16 v[220:223], a[208:211], v[80:83], 0
    v_mfma_f32_16x16x32_bf16 v[220:223], a[212:215], v[84:87], v[220:223]
    v_mfma_f32_16x16x32_bf16 v[220:223], a[216:219], v[88:91], v[220:223]
    v_mfma_f32_16x16x32_bf16 v[220:223], a[220:223], v[92:95], v[220:223]
    v_mfma_f32_16x16x32_bf16 v[224:227], a[208:211], v[96:99], 0
    v_mfma_f32_16x16x32_bf16 v[224:227], a[212:215], v[100:103], v[224:227]
    v_mfma_f32_16x16x32_bf16 v[224:227], a[216:219], v[104:107], v[224:227]
    v_mfma_f32_16x16x32_bf16 v[224:227], a[220:223], v[108:111], v[224:227]
    v_mfma_f32_16x16x32_bf16 v[228:231], a[208:211], v[112:115], 0
    v_mfma_f32_16x16x32_bf16 v[228:231], a[212:215], v[116:119], v[228:231]
    v_mfma_f32_16x16x32_bf16 v[228:231], a[216:219], v[120:123], v[228:231]
    v_mfma_f32_16x16x32_bf16 v[228:231], a[220:223], v[124:127], v[228:231]
    v_max3_f32 v232, v232, v216, v217
    v_max3_f32 v232, v232, v218, v219
    v_max3_f32 v233, v233, v220, v221
    v_max3_f32 v233, v233, v222, v223
    v_max3_f32 v234, v234, v224, v225
    v_max3_f32 v234, v234, v226, v227
    s_nop 1
    v_max3_f32 v235, v235, v228, v229
    v_max3_f32 v235, v235, v230, v231
    ds_read_b128 a[224:227], v8 offset:4096
    ds_read_b128 a[228:231], v9 offset:4096
    ds_read_b128 a[232:235], v10 offset:4096
    ds_read_b128 a[236:239], v11 offset:4096
    s_waitcnt lgkmcnt(3)
    v_mfma_f32_16x16x32_bf16 v[216:219], a[224:227], v[64:67], 0
    s_waitcnt lgkmcnt(2)
    v_mfma_f32_16x16x32_bf16 v[216:219], a[228:231], v[68:71], v[216:219]
    s_waitcnt lgkmcnt(1)
    v_mfma_f32_16x16x32_bf16 v[216:219], a[232:235], v[72:75], v[216:219]
    s_waitcnt lgkmcnt(0)
    v_mfma_f32_16x16x32_bf16 v[216:219], a[236:239], v[76:79], v[216:219]
    v_mfma_f32_16x16x32_bf16 v[220:223], a[224:227], v[80:83], 0
    v_mfma_f32_16x16x32_bf16 v[220:223], a[228:231], v[84:87], v[220:223]
    v_mfma_f32_16x16x32_bf16 v[220:223], a[232:235], v[88:91], v[220:223]
    v_mfma_f32_16x16x32_bf16 v[220:223], a[236:239], v[92:95], v[220:223]
    v_mfma_f32_16x16x32_bf16 v[224:227], a[224:227], v[96:99], 0
    v_mfma_f32_16x16x32_bf16 v[224:227], a[228:231], v[100:103], v[224:227]
    v_mfma_f32_16x16x32_bf16 v[224:227], a[232:235], v[104:107], v[224:227]
    v_mfma_f32_16x16x32_bf16 v[224:227], a[236:239], v[108:111], v[224:227]
    v_mfma_f32_16x16x32_bf16 v[228:231], a[224:227], v[112:115], 0
    v_mfma_f32_16x16x32_bf16 v[228:231], a[228:231], v[116:119], v[228:231]
    v_mfma_f32_16x16x32_bf16 v[228:231], a[232:235], v[120:123], v[228:231]
    v_mfma_f32_16x16x32_bf16 v[228:231], a[236:239], v[124:127], v[228:231]
    v_max3_f32 v232, v232, v216, v217
    v_max3_f32 v232, v232, v218, v219
    v_max3_f32 v233, v233, v220, v221
    v_max3_f32 v233, v233, v222, v223
    v_max3_f32 v234, v234, v224, v225
    v_max3_f32 v234, v234, v226, v227
    s_nop 1
    v_max3_f32 v235, v235, v228, v229
    v_max3_f32 v235, v235, v230, v231
    ds_read_b128 a[208:211], v8 offset:8192
    ds_read_b128 a[212:215], v9 offset:8192
    ds_read_b128 a[216:219], v10 offset:8192
    ds_read_b128 a[220:223], v11 offset:8192
    s_waitcnt lgkmcnt(3)
    v_mfma_f32_16x16x32_bf16 v[216:219], a[208:211], v[64:67], 0
    s_waitcnt lgkmcnt(2)
    v_mfma_f32_16x16x32_bf16 v[216:219], a[212:215], v[68:71], v[216:219]
    s_waitcnt lgkmcnt(1)
    v_mfma_f32_16x16x32_bf16 v[216:219], a[216:219], v[72:75], v[216:219]
    s_waitcnt lgkmcnt(0)
    v_mfma_f32_16x16x32_bf16 v[216:219], a[220:223], v[76:79], v[216:219]
    v_mfma_f32_16x16x32_bf16 v[220:223], a[208:211], v[80:83], 0
    v_mfma_f32_16x16x32_bf16 v[220:223], a[212:215], v[84:87], v[220:223]
    v_mfma_f32_16x16x32_bf16 v[220:223], a[216:219], v[88:91], v[220:223]
    v_mfma_f32_16x16x32_bf16 v[220:223], a[220:223], v[92:95], v[220:223]
    v_mfma_f32_16x16x32_bf16 v[224:227], a[208:211], v[96:99], 0
    v_mfma_f32_16x16x32_bf16 v[224:227], a[212:215], v[100:103], v[224:227]
    v_mfma_f32_16x16x32_bf16 v[224:227], a[216:219], v[104:107], v[224:227]
    v_mfma_f32_16x16x32_bf16 v[224:227], a[220:223], v[108:111], v[224:227]
    v_mfma_f32_16x16x32_bf16 v[228:231], a[208:211], v[112:115], 0
    v_mfma_f32_16x16x32_bf16 v[228:231], a[212:215], v[116:119], v[228:231]
    v_mfma_f32_16x16x32_bf16 v[228:231], a[216:219], v[120:123], v[228:231]
    v_mfma_f32_16x16x32_bf16 v[228:231], a[220:223], v[124:127], v[228:231]
    v_max3_f32 v232, v232, v216, v217
    v_max3_f32 v232, v232, v218, v219
    v_max3_f32 v233, v233, v220, v221
    v_max3_f32 v233, v233, v222, v223
    v_max3_f32 v234, v234, v224, v225
    v_max3_f32 v234, v234, v226, v227
    s_nop 1
    v_max3_f32 v235, v235, v228, v229
    v_max3_f32 v235, v235, v230, v231
    ds_read_b128 a[224:227], v8 offset:12288
    ds_read_b128 a[228:231], v9 offset:12288
    ds_read_b128 a[232:235], v10 offset:12288
    ds_read_b128 a[236:239], v11 offset:12288
    s_waitcnt lgkmcnt(3)
    v_mfma_f32_16x16x32_bf16 v[216:219], a[224:227], v[64:67], 0
    s_waitcnt lgkmcnt(2)
    v_mfma_f32_16x16x32_bf16 v[216:219], a[228:231], v[68:71], v[216:219]
    s_waitcnt lgkmcnt(1)
    v_mfma_f32_16x16x32_bf16 v[216:219], a[232:235], v[72:75], v[216:219]
    s_waitcnt lgkmcnt(0)
    v_mfma_f32_16x16x32_bf16 v[216:219], a[236:239], v[76:79], v[216:219]
    v_mfma_f32_16x16x32_bf16 v[220:223], a[224:227], v[80:83], 0
    v_mfma_f32_16x16x32_bf16 v[220:223], a[228:231], v[84:87], v[220:223]
    v_mfma_f32_16x16x32_bf16 v[220:223], a[232:235], v[88:91], v[220:223]
    v_mfma_f32_16x16x32_bf16 v[220:223], a[236:239], v[92:95], v[220:223]
    v_mfma_f32_16x16x32_bf16 v[224:227], a[224:227], v[96:99], 0
    v_mfma_f32_16x16x32_bf16 v[224:227], a[228:231], v[100:103], v[224:227]
    v_mfma_f32_16x16x32_bf16 v[224:227], a[232:235], v[104:107], v[224:227]
    v_mfma_f32_16x16x32_bf16 v[224:227], a[236:239], v[108:111], v[224:227]
    v_mfma_f32_16x16x32_bf16 v[228:231], a[224:227], v[112:115], 0
    v_mfma_f32_16x16x32_bf16 v[228:231], a[228:231], v[116:119], v[228:231]
    v_mfma_f32_16x16x32_bf16 v[228:231], a[232:235], v[120:123], v[228:231]
    v_mfma_f32_16x16x32_bf16 v[228:231], a[236:239], v[124:127], v[228:231]
    v_max3_f32 v232, v232, v216, v217
    v_max3_f32 v232, v232, v218, v219
    v_max3_f32 v233, v233, v220, v221
    v_max3_f32 v233, v233, v222, v223
    v_max3_f32 v234, v234, v224, v225
    v_max3_f32 v234, v234, v226, v227
    s_nop 1
    v_max3_f32 v235, v235, v228, v229
    v_max3_f32 v235, v235, v230, v231
    s_barrier
    s_cmp_lt_u32 s40, 524288
    s_cbranch_scc1 Lattn_redo_loop
    v_mov_b32 v236, v232
    v_mov_b32 v237, v233
    v_mov_b32 v238, v234
    v_mov_b32 v239, v235
    v_permlane16_swap_b32 v232, v236
    v_permlane16_swap_b32 v233, v237
    v_permlane16_swap_b32 v234, v238
    v_permlane16_swap_b32 v235, v239
    v_max_f32 v232, v232, v236
    v_max_f32 v233, v233, v237
    v_max_f32 v234, v234, v238
    v_max_f32 v235, v235, v239
    v_mov_b32 v236, v232
    v_mov_b32 v237, v233
    v_mov_b32 v238, v234
    v_mov_b32 v239, v235
    v_permlane32_swap_b32 v232, v236
    v_permlane32_swap_b32 v233, v237
    v_permlane32_swap_b32 v234, v238
    v_permlane32_swap_b32 v235, v239
    v_max_f32 v232, v232, v236
    v_max_f32 v233, v233, v237
    v_max_f32 v234, v234, v238
    v_max_f32 v235, v235, v239
    v_sub_f32 v192, 0, v232
    v_sub_f32 v193, 0, v232
    v_sub_f32 v194, 0, v232
    v_sub_f32 v195, 0, v232
    v_sub_f32 v196, 0, v233
    v_sub_f32 v197, 0, v233
    v_sub_f32 v198, 0, v233
    v_sub_f32 v199, 0, v233
    v_sub_f32 v200, 0, v234
    v_sub_f32 v201, 0, v234
    v_sub_f32 v202, 0, v234
    v_sub_f32 v203, 0, v234
    v_sub_f32 v204, 0, v235
    v_sub_f32 v205, 0, v235
    v_sub_f32 v206, 0, v235
    v_sub_f32 v207, 0, v235
    s_mov_b32 s40, 0
    s_mov_b32 s41, 0
    s_add_u32 m0, s42, 0
    s_nop 0
    buffer_load_dwordx4 v36, s[8:11], s40 offen lds
    buffer_load_dwordx4 v37, s[8:11], s40 offen offset:1024 lds
    buffer_load_dwordx4 v38, s[8:11], s40 offen offset:2048 lds
    buffer_load_dwordx4 v39, s[8:11], s40 offen offset:3072 lds
    s_add_u32 s40, s40, 16384
    s_add_u32 m0, s42, 16384
    s_nop 0
    buffer_load_dwordx4 v36, s[8:11], s40 offen lds
    buffer_load_dwordx4 v37, s[8:11], s40 offen offset:1024 lds
    buffer_load_dwordx4 v38, s[8:11], s40 offen offset:2048 lds
    buffer_load_dwordx4 v39, s[8:11], s40 offen offset:3072 lds
    s_add_u32 s40, s40, 16384
    s_add_u32 m0, s42, 32768
    s_nop 0
    buffer_load_dwordx4 v36, s[8:11], s40 offen lds
    buffer_load_dwordx4 v37, s[8:11], s40 offen offset:1024 lds
    buffer_load_dwordx4 v38, s[8:11], s40 offen offset:2048 lds
    buffer_load_dwordx4 v39, s[8:11], s40 offen offset:3072 lds
    s_add_u32 s40, s40, 16384
    s_add_u32 m0, s42, 65536
    s_nop 0
    buffer_load_dwordx4 v40, s[12:15], s41 offen lds
    buffer_load_dwordx4 v41, s[12:15], s41 offen offset:1024 lds
    buffer_load_dwordx4 v40, s[12:15], s41 offen offset:2048 lds
    buffer_load_dwordx4 v41, s[12:15], s41 offen offset:3072 lds
    s_add_u32 s41, s41, 16384
    s_add_u32 m0, s42, 81920
    s_nop 0
    buffer_load_dwordx4 v40, s[12:15], s41 offen lds
    buffer_load_dwordx4 v41, s[12:15], s41 offen offset:1024 lds
    buffer_load_dwordx4 v40, s[12:15], s41 offen offset:2048 lds
    buffer_load_dwordx4 v41, s[12:15], s41 offen offset:3072 lds
    s_add_u32 s41, s41, 16384
    v_accvgpr_write_b32 a0, 0
    v_accvgpr_write_b32 a1, 0
    v_accvgpr_write_b32 a2, 0
    v_accvgpr_write_b32 a3, 0
    v_accvgpr_write_b32 a4, 0
    v_accvgpr_write_b32 a5, 0
    v_accvgpr_write_b32 a6, 0
    v_accvgpr_write_b32 a7, 0
    v_accvgpr_write_b32 a8, 0
    v_accvgpr_write_b32 a9, 0
    v_accvgpr_write_b32 a10, 0
    v_accvgpr_write_b32 a11, 0
    v_accvgpr_write_b32 a12, 0
    v_accvgpr_write_b32 a13, 0
    v_accvgpr_write_b32 a14, 0
    v_accvgpr_write_b32 a15, 0
    v_accvgpr_write_b32 a16, 0
    v_accvgpr_write_b32 a17, 0
    v_accvgpr_write_b32 a18, 0
    v_accvgpr_write_b32 a19, 0
    v_accvgpr_write_b32 a20, 0
    v_accvgpr_write_b32 a21, 0
    v_accvgpr_write_b32 a22, 0
    v_accvgpr_write_b32 a23, 0
    v_accvgpr_write_b32 a24, 0
    v_accvgpr_write_b32 a25, 0
    v_accvgpr_write_b32 a26, 0
    v_accvgpr_write_b32 a27, 0
    v_accvgpr_write_b32 a28, 0
    v_accvgpr_write_b32 a29, 0
    v_accvgpr_write_b32 a30, 0
    v_accvgpr_write_b32 a31, 0
    v_accvgpr_write_b32 a32, 0
    v_accvgpr_write_b32 a33, 0
    v_accvgpr_write_b32 a34, 0
    v_accvgpr_write_b32 a35, 0
    v_accvgpr_write_b32 a36, 0
    v_accvgpr_write_b32 a37, 0
    v_accvgpr_write_b32 a38, 0
    v_accvgpr_write_b32 a39, 0
    v_accvgpr_write_b32 a40, 0
    v_accvgpr_write_b32 a41, 0
    v_accvgpr_write_b32 a42, 0
    v_accvgpr_write_b32 a43, 0
    v_accvgpr_write_b32 a44, 0
    v_accvgpr_write_b32 a45, 0
    v_accvgpr_write_b32 a46, 0
    v_accvgpr_write_b32 a47, 0
    v_accvgpr_write_b32 a48, 0
    v_accvgpr_write_b32 a49, 0
    v_accvgpr_write_b32 a50, 0
    v_accvgpr_write_b32 a51, 0
    v_accvgpr_write_b32 a52, 0
    v_accvgpr_write_b32 a53, 0
    v_accvgpr_write_b32 a54, 0
    v_accvgpr_write_b32 a55, 0
    v_accvgpr_write_b32 a56, 0
    v_accvgpr_write_b32 a57, 0
    v_accvgpr_write_b32 a58, 0
    v_accvgpr_write_b32 a59, 0
    v_accvgpr_write_b32 a60, 0
    v_accvgpr_write_b32 a61, 0
    v_accvgpr_write_b32 a62, 0
    v_accvgpr_write_b32 a63, 0
    v_accvgpr_write_b32 a64, 0
    v_accvgpr_write_b32 a65, 0
    v_accvgpr_write_b32 a66, 0
    v_accvgpr_write_b32 a67, 0
    v_accvgpr_write_b32 a68, 0
    v_accvgpr_write_b32 a69, 0
    v_accvgpr_write_b32 a70, 0
    v_accvgpr_write_b32 a71, 0
    v_accvgpr_write_b32 a72, 0
    v_accvgpr_write_b32 a73, 0
    v_accvgpr_write_b32 a74, 0
    v_accvgpr_write_b32 a75, 0
    v_accvgpr_write_b32 a76, 0
    v_accvgpr_write_b32 a77, 0
    v_accvgpr_write_b32 a78, 0
    v_accvgpr_write_b32 a79, 0
    v_accvgpr_write_b32 a80, 0
    v_accvgpr_write_b32 a81, 0
    v_accvgpr_write_b32 a82, 0
    v_accvgpr_write_b32 a83, 0
    v_accvgpr_write_b32 a84, 0
    v_accvgpr_write_b32 a85, 0
    v_accvgpr_write_b32 a86, 0
    v_accvgpr_write_b32 a87, 0
    v_accvgpr_write_b32 a88, 0
    v_accvgpr_write_b32 a89, 0
    v_accvgpr_write_b32 a90, 0
    v_accvgpr_write_b32 a91, 0
    v_accvgpr_write_b32 a92, 0
    v_accvgpr_write_b32 a93, 0
    v_accvgpr_write_b32 a94, 0
    v_accvgpr_write_b32 a95, 0
    v_accvgpr_write_b32 a96, 0
    v_accvgpr_write_b32 a97, 0
    v_accvgpr_write_b32 a98, 0
    v_accvgpr_write_b32 a99, 0
    v_accvgpr_write_b32 a100, 0
    v_accvgpr_write_b32 a101, 0
    v_accvgpr_write_b32 a102, 0
    v_accvgpr_write_b32 a103, 0
    v_accvgpr_write_b32 a104, 0
    v_accvgpr_write_b32 a105, 0
    v_accvgpr_write_b32 a106, 0
    v_accvgpr_write_b32 a107, 0
    v_accvgpr_write_b32 a108, 0
    v_accvgpr_write_b32 a109, 0
    v_accvgpr_write_b32 a110, 0
    v_accvgpr_write_b32 a111, 0
    v_accvgpr_write_b32 a112, 0
    v_accvgpr_write_b32 a113, 0
    v_accvgpr_write_b32 a114, 0
    v_accvgpr_write_b32 a115, 0
    v_accvgpr_write_b32 a116, 0
    v_accvgpr_write_b32 a117, 0
    v_accvgpr_write_b32 a118, 0
    v_accvgpr_write_b32 a119, 0
    v_accvgpr_write_b32 a120, 0
    v_accvgpr_write_b32 a121, 0
    v_accvgpr_write_b32 a122, 0
    v_accvgpr_write_b32 a123, 0
    v_accvgpr_write_b32 a124, 0
    v_accvgpr_write_b32 a125, 0
    v_accvgpr_write_b32 a126, 0
    v_accvgpr_write_b32 a127, 0
    v_accvgpr_write_b32 a192, 0
    v_accvgpr_write_b32 a193, 0
    v_accvgpr_write_b32 a194, 0
    v_accvgpr_write_b32 a195, 0
    v_accvgpr_write_b32 a196, 0
    v_accvgpr_write_b32 a197, 0
    v_accvgpr_write_b32 a198, 0
    v_accvgpr_write_b32 a199, 0
    v_accvgpr_write_b32 a200, 0
    v_accvgpr_write_b32 a201, 0
    v_accvgpr_write_b32 a202, 0
    v_accvgpr_write_b32 a203, 0
    v_accvgpr_write_b32 a204, 0
    v_accvgpr_write_b32 a205, 0
    v_accvgpr_write_b32 a206, 0
    v_accvgpr_write_b32 a207, 0
    s_waitcnt vmcnt(0) lgkmcnt(0)
    s_barrier
    ds_read_b128 a[208:211], v8 offset:0
    ds_read_b128 a[212:215], v9 offset:0
    ds_read_b128 a[216:219], v10 offset:0
    ds_read_b128 a[220:223], v11 offset:0
    ds_read_b128 a[224:227], v8 offset:4096
    s_waitcnt vmcnt(0) lgkmcnt(0)
    s_branch Lattn_stage0
Lattn_armwait:
    s_mov_b32 s36, 262144
Lattn_armloop:
    v_mov_b32 v63, 0
    buffer_load_dword v63, v63, s[88:91], 0 offen sc1
    s_waitcnt vmcnt(0)
    v_readfirstlane_b32 s37, v63
    s_sub_u32 s36, s36, 1
    s_cbranch_scc1 Lattn_armed
    s_cmp_lt_u32 s37, 256
    s_cbranch_scc1 Lattn_armloop
    s_branch Lattn_armed
Lattn_end:
    s_endpgm
.section .rodata,"a"
.p2align 6
.amdhsa_kernel adaLN_cond__gqa_block_cached__moe_arch_mod__prompt_kernel
  .amdhsa_next_free_vgpr 512
  .amdhsa_next_free_sgpr 102
  .amdhsa_accum_offset 256
  .amdhsa_group_segment_fixed_size 0
  .amdhsa_kernarg_size 120
  .amdhsa_user_sgpr_count 2
  .amdhsa_user_sgpr_kernarg_segment_ptr 1
  .amdhsa_system_sgpr_workgroup_id_x 1
  .amdhsa_float_denorm_mode_32 3
.end_amdhsa_kernel
```

```asm
; @launch grid=(256,1,1) block=(256,1,1) lds=163840
.amdgcn_target "amdgcn-amd-amdhsa--gfx950"
.text
.globl adaLN_cond__gqa_block_cached__moe_arch_mod__prompt_kernel
.p2align 8
.type adaLN_cond__gqa_block_cached__moe_arch_mod__prompt_kernel,@function
adaLN_cond__gqa_block_cached__moe_arch_mod__prompt_kernel:
    s_cmp_ge_u32 s2, 256
    s_cbranch_scc1 Lattn_end
    s_load_dwordx2 s[8:9], s[0:1], 80
    s_load_dwordx2 s[12:13], s[0:1], 88
    s_load_dwordx2 s[20:21], s[0:1], 0
    s_load_dwordx2 s[50:51], s[0:1], 112
    s_load_dwordx8 s[52:59], s[0:1], 8
    s_load_dwordx8 s[80:87], s[0:1], 56
    s_load_dwordx2 s[88:89], s[0:1], 104
    s_getpc_b64 s[32:33]
Lattn_pc:
    s_mov_b32 s34, Lattn_end-Lattn_pc
    s_mov_b32 s35, 0x20000
    s_lshr_b32 s6, s2, 3
    s_lshl_b32 s7, s6, 6
    v_lshrrev_b32 v3, 6, v0
    v_and_b32 v1, 63, v0
    v_lshrrev_b32 v2, 2, v0
    v_lshlrev_b32 v2, 11, v2
    v_readfirstlane_b32 s3, v3
    buffer_load_dword v240, v2, s[32:35], s7 offen
    s_and_b32 s7, s2, 7
    s_lshl_b32 s4, s7, 1
    s_and_b32 s5, s6, 1
    s_add_u32 s4, s4, s5
    s_lshr_b32 s5, s2, 4
    s_lshr_b32 s38, s6, 2
    s_lshl_b32 s38, s38, 3
    s_add_u32 s38, s38, s7
    s_cmp_lt_u32 s38, 18
    s_cselect_b32 s39, 0, 2147483648
    s_lshl_b32 s38, s38, 2
    s_and_b32 s36, s6, 3
    s_add_u32 s38, s38, s36
    s_mov_b32 s14, 3981312
    s_mul_i32 s92, s6, 124416
    s_lshl_b32 s36, s7, 7
    s_add_u32 s92, s92, s36
    s_cmp_lt_u32 s7, 2
    s_cselect_b32 s36, 53, 35
    v_lshrrev_b32 v2, 2, v0
    v_min_u32 v2, s36, v2
    v_mul_u32_u24 v3, 57, v2
    v_lshrrev_b32 v3, 10, v3
    v_mul_i32_i24 v3, -123392, v3
    v_mul_u32_u24 v2, 6912, v2
    v_add_u32 v72, v2, v3
    s_mov_b32 s15, 0x20000
    s_mov_b32 s10, 1152
    s_mov_b32 s11, 0x20000
    s_mov_b32 s22, 2359296
    s_mov_b32 s23, 0x20000
    v_and_b32 v64, 0xfe, v0
    v_mul_u32_u24 v65, 3456, v64
    v_and_b32 v2, 1, v0
    v_lshl_add_u32 v65, v2, 4, v65
    s_lshl_b32 s36, s38, 5
    s_or_b32 s36, s36, s39
    s_waitcnt lgkmcnt(0)
    s_load_dword s94, s[50:51], 24576
    buffer_load_dword v241, v72, s[12:15], s92 offen
    buffer_load_ushort v80, v64, s[8:11], 0 offen offset:0
    buffer_load_ushort v81, v64, s[8:11], 0 offen offset:256
    buffer_load_ushort v82, v64, s[8:11], 0 offen offset:512
    buffer_load_ushort v83, v64, s[8:11], 0 offen offset:768
    buffer_load_ushort v84, v64, s[8:11], 0 offen offset:1024
    buffer_load_dwordx4 v[88:91], v65, s[12:15], s36 offen
    s_add_u32 s36, s36, 884736
    buffer_load_dwordx4 v[92:95], v65, s[12:15], s36 offen
    s_add_u32 s36, s36, 884736
    buffer_load_dwordx4 v[96:99], v65, s[12:15], s36 offen
    s_add_u32 s36, s36, 884736
    buffer_load_dwordx4 v[100:103], v65, s[12:15], s36 offen
    s_add_u32 s36, s36, 884736
    buffer_load_dwordx4 v[104:107], v65, s[12:15], s36 offen
    v_and_b32 v4, 31, v1
    v_lshrrev_b32 v5, 5, v1
    v_cmp_gt_u32 vcc, 24, v4
    v_mov_b32 v6, 2147483648
    s_lshl_b32 s7, s5, 4
    s_add_u32 s7, s7, s4
    s_lshl_b32 s7, s7, 2
    s_add_u32 s7, s7, s3
    v_cndmask_b32 v6, v6, 0, vcc
    s_mul_i32 s49, s7, 2304
    v_lshrrev_b32 v7, 2, v4
    v_lshl_add_u32 v7, v7, 6, v6
    v_and_b32 v2, 3, v4
    v_lshl_add_u32 v7, v2, 3, v7
    v_mul_u32_u24 v2, 1152, v5
    v_add_u32 v66, v7, v2
    s_mov_b32 s16, s56
    s_mov_b32 s17, s57
    s_mov_b32 s18, 4718592
    s_mov_b32 s19, 0x20000
    s_lshl_b32 s44, s4, 9
    s_mul_i32 s36, s5, 131072
    s_add_u32 s36, s36, 0
    v_lshrrev_b32 v2, 2, v0
    v_min_u32 v2, 63, v2
    v_lshrrev_b32 v3, 2, v2
    v_and_b32 v2, 3, v2
    v_lshl_add_u32 v2, v2, 7, s36
    v_lshl_add_u32 v71, v3, 13, v2
    s_mul_i32 s36, s5, 163840
    s_add_u32 s36, s36, 2097152
    v_lshrrev_b32 v2, 1, v0
    v_min_u32 v2, 79, v2
    v_lshrrev_b32 v3, 2, v2
    v_and_b32 v2, 3, v2
    v_lshl_add_u32 v2, v2, 7, s36
    v_lshl_add_u32 v70, v3, 13, v2
    s_add_u32 s92, s49, 65536
    v_lshl_add_u32 v7, v5, 4, v6
    v_lshl_add_u32 v67, v4, 5, v7
    v_min_u32 v4, 23, v4
    v_lshlrev_b32 v68, 4, v4
    s_mov_b32 s24, s50
    s_mov_b32 s25, s51
    s_mov_b32 s26, 10485760
    s_mov_b32 s27, 0x20000
    s_mov_b32 s90, 256
    s_mov_b32 s91, 0x20000
    s_cmp_ge_u32 s38, 36
    s_cselect_b32 s93, 1.0, 0
    s_lshl_b32 s36, s38, 7
    v_lshl_add_u32 v69, v0, 3, s36
    v_cmp_gt_u32 s[36:37], 16, v0
    v_mov_b32 v2, 2147483648
    v_mov_b32 v3, s39
    v_cndmask_b32 v2, v2, v3, s[36:37]
    v_or_b32 v69, v69, v2
    s_mul_i32 s36, s5, 3072
    s_lshl_b32 s37, s5, 11
    v_lshrrev_b32 v120, 3, v0
    v_min_u32 v120, 23, v120
    v_lshl_add_u32 v120, v120, 7, s36
    v_lshrrev_b32 v121, 4, v0
    v_lshl_add_u32 v121, v121, 7, s37
    s_lshl_b32 s42, s3, 12
    v_lshrrev_b32 v2, 4, v1
    v_and_b32 v3, 15, v1
    v_lshrrev_b32 v5, 1, v3
    v_mul_u32_u24 v5, 2304, v5
    v_lshl_add_u32 v5, v2, 5, v5
    v_and_b32 v6, 1, v3
    v_lshl_add_u32 v51, v6, 4, v5
    s_lshl_b32 s6, s5, 2
    s_add_u32 s6, s6, s3
    s_mul_i32 s46, s6, 36864
    s_add_u32 s46, s46, 65536
    s_add_u32 s43, s46, 18432
    s_mul_i32 s45, s4, 294912
    s_lshl_b32 s7, s3, 4
    v_add_u32 v4, s7, v2
    v_lshlrev_b32 v5, 1, v2
    v_xor_b32 v5, v5, v3
    v_xor_b32 v6, 8, v5
    v_lshlrev_b32 v7, 13, v4
    v_lshl_add_u32 v42, v5, 4, v7
    v_lshl_add_u32 v43, v6, 4, v7
    v_add_u32 v44, 63488, v42
    v_add_u32 v45, 95232, v43
    v_add_u32 v43, 31744, v43
    s_lshl_b32 s7, s4, 19
    s_add_u32 s8, s52, s7
    s_addc_u32 s9, s53, 0
    s_mov_b32 s10, 524288
    s_mov_b32 s11, 0x20000
    s_add_u32 s12, s54, s7
    s_addc_u32 s13, s55, 0
    s_mov_b32 s14, 524288
    s_mov_b32 s15, 0x20000
    s_add_u32 s28, s50, 10485760
    s_addc_u32 s29, s51, 0
    s_mov_b32 s30, 37879808
    s_mov_b32 s31, 0x20000
    v_lshlrev_b32 v7, 8, v4
    v_lshl_add_u32 v40, v5, 4, v7
    v_lshl_add_u32 v41, v6, 4, v7
    v_xor_b32 v224, v3, v2
    v_lshl_add_u32 v36, v224, 4, v7
    v_xor_b32 v37, 64, v36
    v_xor_b32 v38, 128, v36
    v_xor_b32 v39, 192, v36
    v_lshrrev_b32 v7, 3, v5
    v_lshl_add_u32 v7, v7, 7, v4
    v_mul_u32_u24 v7, 1152, v7
    v_and_b32 v225, 7, v5
    v_lshl_add_u32 v46, v225, 4, v7
    v_lshrrev_b32 v7, 3, v6
    v_lshl_add_u32 v7, v7, 7, v4
    v_mul_u32_u24 v7, 1152, v7
    v_and_b32 v225, 7, v6
    v_lshl_add_u32 v47, v225, 4, v7
    v_add_u32 v48, 7168, v46
    v_add_u32 v49, 10752, v47
    v_add_u32 v47, 3584, v47
    v_lshlrev_b32 v7, 8, v3
    v_lshl_add_u32 v8, v224, 4, v7
    v_xor_b32 v9, 64, v8
    v_xor_b32 v10, 128, v8
    v_xor_b32 v11, 192, v8
    v_lshrrev_b32 v5, 2, v1
    v_and_b32 v6, 7, v5
    v_lshlrev_b32 v6, 5, v6
    v_lshl_add_u32 v6, v5, 8, v6
    v_and_b32 v7, 3, v1
    v_lshl_add_u32 v12, v7, 3, v6
    v_xor_b32 v13, 32, v12
    v_xor_b32 v14, 64, v12
    v_xor_b32 v15, 96, v12
    v_xor_b32 v16, 128, v12
    v_xor_b32 v17, 160, v12
    v_xor_b32 v18, 192, v12
    v_xor_b32 v19, 224, v12
    v_add_u32 v20, 65536, v12
    v_add_u32 v21, 65536, v13
    v_add_u32 v22, 65536, v14
    v_add_u32 v23, 65536, v15
    v_add_u32 v24, 65536, v16
    v_add_u32 v25, 65536, v17
    v_add_u32 v26, 65536, v18
    v_add_u32 v27, 65536, v19
    v_add_u32 v28, 131072, v12
    v_add_u32 v29, 131072, v13
    v_add_u32 v30, 131072, v14
    v_add_u32 v31, 131072, v15
    v_add_u32 v32, 131072, v16
    v_add_u32 v33, 131072, v17
    v_add_u32 v34, 131072, v18
    v_add_u32 v35, 131072, v19
    v_mov_b32 v52, 0x3f803f80
    v_mov_b32 v53, 0x3f803f80
    v_mov_b32 v54, 0x3f803f80
    v_mov_b32 v55, 0x3f803f80
    v_and_b32 v5, 1, v1
    v_mul_u32_u24 v5, 0xaaaa, v5
    v_add_u32 v5, 0x4444, v5
    v_lshl_add_u32 v50, v5, 16, v5
    v_lshrrev_b32 v5, 1, v3
    v_mul_u32_u24 v5, 20608, v5
    v_lshl_add_u32 v5, v2, 5, v5
    v_and_b32 v6, 1, v3
    v_lshl_add_u32 v56, v6, 4, v5
    s_mul_i32 s47, s6, 329728
    s_mov_b32 s32, s82
    s_mov_b32 s33, s83
    s_mov_b32 s34, 5308416
    s_mov_b32 s35, 0x20000
    s_mov_b32 s82, 5308416
    s_mov_b32 s83, 0x20000
    s_mov_b32 s86, 5308416
    s_mov_b32 s87, 0x20000
    s_lshr_b32 s7, s2, 3
    s_mul_i32 s7, s7, 18
    s_add_u32 s7, s7, s3
    s_and_b32 s36, s2, 7
    s_mul_i32 s37, s36, 576
    s_add_u32 s37, s37, s7
    s_mul_i32 s37, s37, 1152
    s_mul_i32 s7, s7, 9216
    s_mul_i32 s36, s36, 1152
    s_add_u32 s7, s7, s36
    v_min_u32 v5, 17, v1
    v_lshl_add_u32 v57, v5, 6, s7
    v_lshl_add_u32 v62, v5, 6, s37
    s_mov_b32 s40, 0
    s_mov_b32 s41, 0
    s_mov_b32 s48, 0
    s_waitcnt vmcnt(9)
    v_lshlrev_b32 v80, 16, v80
    s_waitcnt vmcnt(8)
    v_lshlrev_b32 v81, 16, v81
    s_waitcnt vmcnt(7)
    v_lshlrev_b32 v82, 16, v82
    s_waitcnt vmcnt(6)
    v_lshlrev_b32 v83, 16, v83
    s_waitcnt vmcnt(5)
    v_lshlrev_b32 v84, 16, v84
    v_mul_f32 v144, 0xbfb8aa3b, v80
    v_mul_f32 v148, 0xbfb8aa3b, v81
    v_mul_f32 v152, 0xbfb8aa3b, v82
    v_mul_f32 v156, 0xbfb8aa3b, v83
    v_mul_f32 v160, 0xbfb8aa3b, v84
    v_min_f32 v144, 0x42fc0000, v144
    v_min_f32 v148, 0x42fc0000, v148
    v_min_f32 v152, 0x42fc0000, v152
    v_min_f32 v156, 0x42fc0000, v156
    v_min_f32 v160, 0x42fc0000, v160
    v_exp_f32 v144, v144
    v_exp_f32 v148, v148
    v_exp_f32 v152, v152
    v_exp_f32 v156, v156
    v_exp_f32 v160, v160
    v_add_f32 v144, 1.0, v144
    v_add_f32 v148, 1.0, v148
    v_add_f32 v152, 1.0, v152
    v_add_f32 v156, 1.0, v156
    v_add_f32 v160, 1.0, v160
    v_rcp_f32 v145, v144
    v_rcp_f32 v149, v148
    v_rcp_f32 v153, v152
    v_rcp_f32 v157, v156
    v_rcp_f32 v161, v160
    v_mul_f32 v146, v80, v145
    v_mul_f32 v150, v81, v149
    v_mul_f32 v154, v82, v153
    v_mul_f32 v158, v83, v157
    v_mul_f32 v162, v84, v161
    v_fma_f32 v144, -v146, v144, v80
    v_fma_f32 v148, -v150, v148, v81
    v_fma_f32 v152, -v154, v152, v82
    v_fma_f32 v156, -v158, v156, v83
    v_fma_f32 v160, -v162, v160, v84
    v_fma_f32 v80, v144, v145, v146
    v_fma_f32 v81, v148, v149, v150
    v_fma_f32 v82, v152, v153, v154
    v_fma_f32 v83, v156, v157, v158
    v_fma_f32 v84, v160, v161, v162
    v_cvt_pk_bf16_f32 v80, v80, v80
    v_cvt_pk_bf16_f32 v81, v81, v81
    v_cvt_pk_bf16_f32 v82, v82, v82
    v_cvt_pk_bf16_f32 v83, v83, v83
    v_cvt_pk_bf16_f32 v84, v84, v84
    v_and_b32 v80, 0xffff0000, v80
    v_and_b32 v81, 0xffff0000, v81
    v_and_b32 v82, 0xffff0000, v82
    v_and_b32 v83, 0xffff0000, v83
    v_and_b32 v84, 0xffff0000, v84
    buffer_load_dwordx2 v[108:109], v66, s[20:23], s49 offen offset:0
    buffer_load_dwordx2 v[110:111], v66, s[20:23], s49 offen offset:32
    buffer_load_dwordx2 v[112:113], v66, s[20:23], s49 offen offset:384
    buffer_load_dwordx2 v[114:115], v66, s[20:23], s49 offen offset:416
    buffer_load_dwordx2 v[116:117], v66, s[20:23], s49 offen offset:768
    buffer_load_dwordx2 v[118:119], v66, s[20:23], s49 offen offset:800
    s_mov_b32 s20, s58
    s_mov_b32 s21, s59
    s_mov_b32 s22, 4718592
    s_mov_b32 s23, 0x20000
    s_waitcnt vmcnt(10)
    v_lshlrev_b32 v136, 16, v88
    v_and_b32 v137, 0xffff0000, v88
    v_lshlrev_b32 v138, 16, v89
    v_and_b32 v139, 0xffff0000, v89
    v_lshlrev_b32 v140, 16, v90
    v_and_b32 v141, 0xffff0000, v90
    v_lshlrev_b32 v142, 16, v91
    v_and_b32 v143, 0xffff0000, v91
    v_pk_mul_f32 v[128:129], v[136:137], v[80:81] op_sel:[0,0] op_sel_hi:[1,0]
    v_pk_mul_f32 v[130:131], v[138:139], v[80:81] op_sel:[0,0] op_sel_hi:[1,0]
    v_pk_mul_f32 v[132:133], v[140:141], v[80:81] op_sel:[0,0] op_sel_hi:[1,0]
    v_pk_mul_f32 v[134:135], v[142:143], v[80:81] op_sel:[0,0] op_sel_hi:[1,0]
    s_waitcnt vmcnt(9)
    v_lshlrev_b32 v136, 16, v92
    v_and_b32 v137, 0xffff0000, v92
    v_lshlrev_b32 v138, 16, v93
    v_and_b32 v139, 0xffff0000, v93
    v_lshlrev_b32 v140, 16, v94
    v_and_b32 v141, 0xffff0000, v94
    v_lshlrev_b32 v142, 16, v95
    v_and_b32 v143, 0xffff0000, v95
    v_pk_fma_f32 v[128:129], v[136:137], v[80:81], v[128:129] op_sel:[0,1,0] op_sel_hi:[1,1,1]
    v_pk_fma_f32 v[130:131], v[138:139], v[80:81], v[130:131] op_sel:[0,1,0] op_sel_hi:[1,1,1]
    v_pk_fma_f32 v[132:133], v[140:141], v[80:81], v[132:133] op_sel:[0,1,0] op_sel_hi:[1,1,1]
    v_pk_fma_f32 v[134:135], v[142:143], v[80:81], v[134:135] op_sel:[0,1,0] op_sel_hi:[1,1,1]
    s_waitcnt vmcnt(8)
    v_lshlrev_b32 v136, 16, v96
    v_and_b32 v137, 0xffff0000, v96
    v_lshlrev_b32 v138, 16, v97
    v_and_b32 v139, 0xffff0000, v97
    v_lshlrev_b32 v140, 16, v98
    v_and_b32 v141, 0xffff0000, v98
    v_lshlrev_b32 v142, 16, v99
    v_and_b32 v143, 0xffff0000, v99
    v_pk_fma_f32 v[128:129], v[136:137], v[82:83], v[128:129] op_sel:[0,0,0] op_sel_hi:[1,0,1]
    v_pk_fma_f32 v[130:131], v[138:139], v[82:83], v[130:131] op_sel:[0,0,0] op_sel_hi:[1,0,1]
    v_pk_fma_f32 v[132:133], v[140:141], v[82:83], v[132:133] op_sel:[0,0,0] op_sel_hi:[1,0,1]
    v_pk_fma_f32 v[134:135], v[142:143], v[82:83], v[134:135] op_sel:[0,0,0] op_sel_hi:[1,0,1]
    s_waitcnt vmcnt(7)
    v_lshlrev_b32 v136, 16, v100
    v_and_b32 v137, 0xffff0000, v100
    v_lshlrev_b32 v138, 16, v101
    v_and_b32 v139, 0xffff0000, v101
    v_lshlrev_b32 v140, 16, v102
    v_and_b32 v141, 0xffff0000, v102
    v_lshlrev_b32 v142, 16, v103
    v_and_b32 v143, 0xffff0000, v103
    v_pk_fma_f32 v[128:129], v[136:137], v[82:83], v[128:129] op_sel:[0,1,0] op_sel_hi:[1,1,1]
    v_pk_fma_f32 v[130:131], v[138:139], v[82:83], v[130:131] op_sel:[0,1,0] op_sel_hi:[1,1,1]
    v_pk_fma_f32 v[132:133], v[140:141], v[82:83], v[132:133] op_sel:[0,1,0] op_sel_hi:[1,1,1]
    v_pk_fma_f32 v[134:135], v[142:143], v[82:83], v[134:135] op_sel:[0,1,0] op_sel_hi:[1,1,1]
    s_waitcnt vmcnt(6)
    v_lshlrev_b32 v136, 16, v104
    v_and_b32 v137, 0xffff0000, v104
    v_lshlrev_b32 v138, 16, v105
    v_and_b32 v139, 0xffff0000, v105
    v_lshlrev_b32 v140, 16, v106
    v_and_b32 v141, 0xffff0000, v106
    v_lshlrev_b32 v142, 16, v107
    v_and_b32 v143, 0xffff0000, v107
    v_pk_fma_f32 v[128:129], v[136:137], v[84:85], v[128:129] op_sel:[0,0,0] op_sel_hi:[1,0,1]
    v_pk_fma_f32 v[130:131], v[138:139], v[84:85], v[130:131] op_sel:[0,0,0] op_sel_hi:[1,0,1]
    v_pk_fma_f32 v[132:133], v[140:141], v[84:85], v[132:133] op_sel:[0,0,0] op_sel_hi:[1,0,1]
    v_pk_fma_f32 v[134:135], v[142:143], v[84:85], v[134:135] op_sel:[0,0,0] op_sel_hi:[1,0,1]
    s_nop 0
    v_permlane32_swap_b32 v128, v132
    v_permlane32_swap_b32 v129, v133
    v_permlane32_swap_b32 v130, v134
    v_permlane32_swap_b32 v131, v135
    v_and_b32 v72, 1, v1
    v_pk_add_f32 v[128:129], v[128:129], v[132:133]
    v_pk_add_f32 v[130:131], v[130:131], v[134:135]
    v_lshlrev_b32 v72, 5, v72
    v_lshrrev_b32 v73, 4, v1
    v_permlane16_swap_b32 v128, v130
    v_permlane16_swap_b32 v129, v131
    v_lshl_add_u32 v72, v73, 3, v72
    v_pk_add_f32 v[128:129], v[128:129], v[130:131]
    s_lshl_b32 s36, s3, 6
    v_add_u32 v72, s36, v72
    v_add_f32_dpp v128, v128, v128 row_ror:2 row_mask:0xf bank_mask:0xf
    v_add_f32_dpp v129, v129, v129 row_ror:2 row_mask:0xf bank_mask:0xf
    s_nop 0
    v_add_f32_dpp v128, v128, v128 row_ror:4 row_mask:0xf bank_mask:0xf
    v_add_f32_dpp v129, v129, v129 row_ror:4 row_mask:0xf bank_mask:0xf
    s_nop 0
    v_add_f32_dpp v128, v128, v128 row_ror:8 row_mask:0xf bank_mask:0xf
    v_add_f32_dpp v129, v129, v129 row_ror:8 row_mask:0xf bank_mask:0xf
    ds_write_b64 v72, v[128:129] offset:0
    v_and_b32 v73, 7, v1
    v_lshlrev_b32 v73, 3, v73
    s_waitcnt lgkmcnt(0)
    s_barrier
    ds_read_b64 v[128:129], v73 offset:0
    ds_read_b64 v[130:131], v73 offset:64
    ds_read_b64 v[132:133], v73 offset:128
    ds_read_b64 v[134:135], v73 offset:192
    s_add_u32 s95, s94, 0x9e3779b9
    v_mov_b32 v137, s95
    s_mov_b32 s37, 32768
    s_waitcnt lgkmcnt(2)
    v_pk_add_f32 v[128:129], v[128:129], v[130:131]
    s_waitcnt lgkmcnt(0)
    v_pk_add_f32 v[132:133], v[132:133], v[134:135]
    v_pk_add_f32 v[128:129], v[128:129], v[132:133]
    v_cvt_pk_bf16_f32 v136, v128, v129
    v_lshlrev_b32 v128, 16, v136
    v_and_b32 v129, 0xffff0000, v136
    v_add_f32 v128, s93, v128
    v_add_f32 v129, s93, v129
    v_cvt_pk_bf16_f32 v136, v128, v129
    buffer_store_dwordx2 v[136:137], v69, s[24:27], s37 offen sc1
    s_mul_i32 s36, s3, 72
    v_add_u32 v122, s36, v1
    v_and_b32 v123, 7, v1
    s_add_u32 s36, s36, 64
    v_add_u32 v123, s36, v123
    s_movk_i32 s36, 1024
    v_and_b32 v76, 3, v122
    v_lshlrev_b32 v76, 4, v76
    v_lshrrev_b32 v122, 2, v122
    v_lshl_add_u32 v124, v122, 7, v76
    v_and_b32 v77, 1, v122
    v_lshl_add_u32 v76, v77, 3, v76
    v_lshrrev_b32 v122, 1, v122
    v_lshl_add_u32 v122, v122, 6, v76
    v_add_u32 v122, s36, v122
    v_and_b32 v76, 3, v123
    v_lshlrev_b32 v76, 4, v76
    v_lshrrev_b32 v123, 2, v123
    v_lshl_add_u32 v125, v123, 7, v76
    v_and_b32 v77, 1, v123
    v_lshl_add_u32 v76, v77, 3, v76
    v_lshrrev_b32 v123, 1, v123
    v_lshl_add_u32 v123, v123, 6, v76
    v_add_u32 v123, s36, v123
    s_mov_b64 exec, 0
    s_cmp_eq_u32 s3, 0
    s_cbranch_scc1 Ltour0_0
    s_cmp_eq_u32 s3, 1
    s_cbranch_scc1 Ltour0_1
    s_cmp_eq_u32 s3, 2
    s_cbranch_scc1 Ltour0_2
    s_branch Ltour0_3
.p2align 12
Lmain0:
    s_mov_b64 exec, -1
    s_waitcnt vmcnt(6)
    v_lshlrev_b32 v144, 16, v108
    v_and_b32 v145, 0xffff0000, v108
    v_lshlrev_b32 v146, 16, v109
    v_and_b32 v147, 0xffff0000, v109
    s_waitcnt vmcnt(5)
    v_lshlrev_b32 v148, 16, v110
    v_and_b32 v149, 0xffff0000, v110
    v_lshlrev_b32 v150, 16, v111
    v_and_b32 v151, 0xffff0000, v111
    s_waitcnt vmcnt(4)
    v_lshlrev_b32 v152, 16, v112
    v_and_b32 v153, 0xffff0000, v112
    v_lshlrev_b32 v154, 16, v113
    v_and_b32 v155, 0xffff0000, v113
    s_waitcnt vmcnt(3)
    v_lshlrev_b32 v156, 16, v114
    v_and_b32 v157, 0xffff0000, v114
    v_lshlrev_b32 v158, 16, v115
    v_and_b32 v159, 0xffff0000, v115
    s_waitcnt vmcnt(2)
    v_lshlrev_b32 v160, 16, v116
    v_and_b32 v161, 0xffff0000, v116
    v_lshlrev_b32 v162, 16, v117
    v_and_b32 v163, 0xffff0000, v117
    s_waitcnt vmcnt(1)
    v_lshlrev_b32 v164, 16, v118
    v_and_b32 v165, 0xffff0000, v118
    v_lshlrev_b32 v166, 16, v119
    v_and_b32 v167, 0xffff0000, v119
    buffer_load_dwordx4 v[88:91], v124, s[24:27], s37 offen sc1
    buffer_load_dwordx4 v[92:95], v125, s[24:27], s37 offen sc1
    buffer_load_dword v242, v71, s[16:19], s44 offen
    v_pk_add_f32 v[72:73], v[144:145], v[148:149]
    v_pk_add_f32 v[76:77], v[146:147], v[150:151]
    v_pk_add_f32 v[72:73], v[72:73], v[152:153]
    v_pk_add_f32 v[76:77], v[76:77], v[154:155]
    v_pk_add_f32 v[72:73], v[72:73], v[156:157]
    v_pk_add_f32 v[76:77], v[76:77], v[158:159]
    v_pk_add_f32 v[72:73], v[72:73], v[160:161]
    v_pk_add_f32 v[76:77], v[76:77], v[162:163]
    v_pk_add_f32 v[72:73], v[72:73], v[164:165]
    v_pk_add_f32 v[76:77], v[76:77], v[166:167]
    v_pk_add_f32 v[72:73], v[72:73], v[76:77]
    v_add_f32 v72, v72, v73
    s_nop 1
    v_add_f32_dpp v72, v72, v72 row_ror:8 row_mask:0xf bank_mask:0xf
    s_nop 1
    v_add_f32_dpp v72, v72, v72 row_ror:4 row_mask:0xf bank_mask:0xf
    s_nop 1
    v_add_f32_dpp v72, v72, v72 row_ror:2 row_mask:0xf bank_mask:0xf
    s_nop 1
    v_add_f32_dpp v72, v72, v72 row_ror:1 row_mask:0xf bank_mask:0xf
    v_mov_b32 v76, v72
    s_nop 1
    v_permlane16_swap_b32 v72, v76
    s_nop 0
    v_add_f32 v72, v72, v76
    v_mul_f32 v72, 0x3ae38e39, v72
    v_pk_add_f32 v[168:169], v[144:145], v[72:73] op_sel_hi:[1,0] neg_lo:[0,1] neg_hi:[0,1]
    v_pk_add_f32 v[170:171], v[146:147], v[72:73] op_sel_hi:[1,0] neg_lo:[0,1] neg_hi:[0,1]
    v_pk_add_f32 v[172:173], v[148:149], v[72:73] op_sel_hi:[1,0] neg_lo:[0,1] neg_hi:[0,1]
    v_pk_add_f32 v[174:175], v[150:151], v[72:73] op_sel_hi:[1,0] neg_lo:[0,1] neg_hi:[0,1]
    v_pk_add_f32 v[176:177], v[152:153], v[72:73] op_sel_hi:[1,0] neg_lo:[0,1] neg_hi:[0,1]
    v_pk_add_f32 v[178:179], v[154:155], v[72:73] op_sel_hi:[1,0] neg_lo:[0,1] neg_hi:[0,1]
    v_pk_add_f32 v[180:181], v[156:157], v[72:73] op_sel_hi:[1,0] neg_lo:[0,1] neg_hi:[0,1]
    v_pk_add_f32 v[182:183], v[158:159], v[72:73] op_sel_hi:[1,0] neg_lo:[0,1] neg_hi:[0,1]
    v_pk_add_f32 v[184:185], v[160:161], v[72:73] op_sel_hi:[1,0] neg_lo:[0,1] neg_hi:[0,1]
    v_pk_add_f32 v[186:187], v[162:163], v[72:73] op_sel_hi:[1,0] neg_lo:[0,1] neg_hi:[0,1]
    v_pk_add_f32 v[188:189], v[164:165], v[72:73] op_sel_hi:[1,0] neg_lo:[0,1] neg_hi:[0,1]
    v_pk_add_f32 v[190:191], v[166:167], v[72:73] op_sel_hi:[1,0] neg_lo:[0,1] neg_hi:[0,1]
    v_pk_mul_f32 v[74:75], v[168:169], v[168:169]
    v_pk_mul_f32 v[76:77], v[170:171], v[170:171]
    v_pk_fma_f32 v[74:75], v[172:173], v[172:173], v[74:75]
    v_pk_fma_f32 v[76:77], v[174:175], v[174:175], v[76:77]
    v_pk_fma_f32 v[74:75], v[176:177], v[176:177], v[74:75]
    v_pk_fma_f32 v[76:77], v[178:179], v[178:179], v[76:77]
    v_pk_fma_f32 v[74:75], v[180:181], v[180:181], v[74:75]
    v_pk_fma_f32 v[76:77], v[182:183], v[182:183], v[76:77]
    v_pk_fma_f32 v[74:75], v[184:185], v[184:185], v[74:75]
    v_pk_fma_f32 v[76:77], v[186:187], v[186:187], v[76:77]
    v_pk_fma_f32 v[74:75], v[188:189], v[188:189], v[74:75]
    v_pk_fma_f32 v[76:77], v[190:191], v[190:191], v[76:77]
    v_pk_add_f32 v[74:75], v[74:75], v[76:77]
    v_add_f32 v74, v74, v75
    v_cndmask_b32 v74, 0, v74, vcc
    s_nop 1
    v_add_f32_dpp v74, v74, v74 row_ror:8 row_mask:0xf bank_mask:0xf
    s_nop 1
    v_add_f32_dpp v74, v74, v74 row_ror:4 row_mask:0xf bank_mask:0xf
    s_nop 1
    v_add_f32_dpp v74, v74, v74 row_ror:2 row_mask:0xf bank_mask:0xf
    s_nop 1
    v_add_f32_dpp v74, v74, v74 row_ror:1 row_mask:0xf bank_mask:0xf
    v_mov_b32 v76, v74
    s_nop 1
    v_permlane16_swap_b32 v74, v76
    s_nop 0
    v_add_f32 v74, v74, v76
    v_mul_f32 v74, 0x3ae38e39, v74
    v_cvt_pk_bf16_f32 v76, v72, v74
    v_and_b32 v74, 0xffff0000, v76
    v_lshlrev_b32 v72, 16, v76
    v_add_f32 v74, 0x3727c5ac, v74
    v_cvt_pk_bf16_f32 v74, v74, v74
    v_and_b32 v74, 0xffff0000, v74
    v_sqrt_f32 v74, v74
    v_pk_add_f32 v[168:169], v[144:145], v[72:73] op_sel_hi:[1,0] neg_lo:[0,1] neg_hi:[0,1]
    v_pk_add_f32 v[170:171], v[146:147], v[72:73] op_sel_hi:[1,0] neg_lo:[0,1] neg_hi:[0,1]
    v_pk_add_f32 v[172:173], v[148:149], v[72:73] op_sel_hi:[1,0] neg_lo:[0,1] neg_hi:[0,1]
    v_pk_add_f32 v[174:175], v[150:151], v[72:73] op_sel_hi:[1,0] neg_lo:[0,1] neg_hi:[0,1]
    v_pk_add_f32 v[176:177], v[152:153], v[72:73] op_sel_hi:[1,0] neg_lo:[0,1] neg_hi:[0,1]
    v_pk_add_f32 v[178:179], v[154:155], v[72:73] op_sel_hi:[1,0] neg_lo:[0,1] neg_hi:[0,1]
    v_pk_add_f32 v[180:181], v[156:157], v[72:73] op_sel_hi:[1,0] neg_lo:[0,1] neg_hi:[0,1]
    v_pk_add_f32 v[182:183], v[158:159], v[72:73] op_sel_hi:[1,0] neg_lo:[0,1] neg_hi:[0,1]
    v_pk_add_f32 v[184:185], v[160:161], v[72:73] op_sel_hi:[1,0] neg_lo:[0,1] neg_hi:[0,1]
    v_pk_add_f32 v[186:187], v[162:163], v[72:73] op_sel_hi:[1,0] neg_lo:[0,1] neg_hi:[0,1]
    v_pk_add_f32 v[188:189], v[164:165], v[72:73] op_sel_hi:[1,0] neg_lo:[0,1] neg_hi:[0,1]
    v_pk_add_f32 v[190:191], v[166:167], v[72:73] op_sel_hi:[1,0] neg_lo:[0,1] neg_hi:[0,1]
    v_cvt_pk_bf16_f32 v74, v74, v74
    v_and_b32 v74, 0xffff0000, v74
    v_rcp_f32 v74, v74
    v_cvt_pk_bf16_f32 v108, v168, v169
    v_cvt_pk_bf16_f32 v109, v170, v171
    v_cvt_pk_bf16_f32 v110, v172, v173
    v_cvt_pk_bf16_f32 v111, v174, v175
    v_cvt_pk_bf16_f32 v112, v176, v177
    v_cvt_pk_bf16_f32 v113, v178, v179
    v_cvt_pk_bf16_f32 v114, v180, v181
    v_cvt_pk_bf16_f32 v115, v182, v183
    v_cvt_pk_bf16_f32 v116, v184, v185
    v_cvt_pk_bf16_f32 v117, v186, v187
    v_cvt_pk_bf16_f32 v118, v188, v189
    v_cvt_pk_bf16_f32 v119, v190, v191
    v_lshlrev_b32 v168, 16, v108
    v_and_b32 v169, 0xffff0000, v108
    v_lshlrev_b32 v170, 16, v109
    v_and_b32 v171, 0xffff0000, v109
    v_lshlrev_b32 v172, 16, v110
    v_and_b32 v173, 0xffff0000, v110
    v_lshlrev_b32 v174, 16, v111
    v_and_b32 v175, 0xffff0000, v111
    v_lshlrev_b32 v176, 16, v112
    v_and_b32 v177, 0xffff0000, v112
    v_lshlrev_b32 v178, 16, v113
    v_and_b32 v179, 0xffff0000, v113
    v_lshlrev_b32 v180, 16, v114
    v_and_b32 v181, 0xffff0000, v114
    v_lshlrev_b32 v182, 16, v115
    v_and_b32 v183, 0xffff0000, v115
    v_lshlrev_b32 v184, 16, v116
    v_and_b32 v185, 0xffff0000, v116
    v_lshlrev_b32 v186, 16, v117
    v_and_b32 v187, 0xffff0000, v117
    v_lshlrev_b32 v188, 16, v118
    v_and_b32 v189, 0xffff0000, v118
    v_lshlrev_b32 v190, 16, v119
    v_and_b32 v191, 0xffff0000, v119
    v_pk_mul_f32 v[168:169], v[168:169], v[74:75] op_sel_hi:[1,0]
    v_pk_mul_f32 v[170:171], v[170:171], v[74:75] op_sel_hi:[1,0]
    v_pk_mul_f32 v[172:173], v[172:173], v[74:75] op_sel_hi:[1,0]
    v_pk_mul_f32 v[174:175], v[174:175], v[74:75] op_sel_hi:[1,0]
    v_pk_mul_f32 v[176:177], v[176:177], v[74:75] op_sel_hi:[1,0]
    v_pk_mul_f32 v[178:179], v[178:179], v[74:75] op_sel_hi:[1,0]
    v_pk_mul_f32 v[180:181], v[180:181], v[74:75] op_sel_hi:[1,0]
    v_pk_mul_f32 v[182:183], v[182:183], v[74:75] op_sel_hi:[1,0]
    v_pk_mul_f32 v[184:185], v[184:185], v[74:75] op_sel_hi:[1,0]
    v_pk_mul_f32 v[186:187], v[186:187], v[74:75] op_sel_hi:[1,0]
    v_pk_mul_f32 v[188:189], v[188:189], v[74:75] op_sel_hi:[1,0]
    v_pk_mul_f32 v[190:191], v[190:191], v[74:75] op_sel_hi:[1,0]
    v_cvt_pk_bf16_f32 v108, v168, v169
    v_cvt_pk_bf16_f32 v109, v170, v171
    v_cvt_pk_bf16_f32 v110, v172, v173
    v_cvt_pk_bf16_f32 v111, v174, v175
    v_cvt_pk_bf16_f32 v112, v176, v177
    v_cvt_pk_bf16_f32 v113, v178, v179
    v_cvt_pk_bf16_f32 v114, v180, v181
    v_cvt_pk_bf16_f32 v115, v182, v183
    v_cvt_pk_bf16_f32 v116, v184, v185
    v_cvt_pk_bf16_f32 v117, v186, v187
    v_cvt_pk_bf16_f32 v118, v188, v189
    v_cvt_pk_bf16_f32 v119, v190, v191
    v_lshlrev_b32 v168, 16, v108
    v_and_b32 v169, 0xffff0000, v108
    v_lshlrev_b32 v170, 16, v109
    v_and_b32 v171, 0xffff0000, v109
    v_lshlrev_b32 v172, 16, v110
    v_and_b32 v173, 0xffff0000, v110
    v_lshlrev_b32 v174, 16, v111
    v_and_b32 v175, 0xffff0000, v111
    v_lshlrev_b32 v176, 16, v112
    v_and_b32 v177, 0xffff0000, v112
    v_lshlrev_b32 v178, 16, v113
    v_and_b32 v179, 0xffff0000, v113
    v_lshlrev_b32 v180, 16, v114
    v_and_b32 v181, 0xffff0000, v114
    v_lshlrev_b32 v182, 16, v115
    v_and_b32 v183, 0xffff0000, v115
    v_lshlrev_b32 v184, 16, v116
    v_and_b32 v185, 0xffff0000, v116
    v_lshlrev_b32 v186, 16, v117
    v_and_b32 v187, 0xffff0000, v117
    v_lshlrev_b32 v188, 16, v118
    v_and_b32 v189, 0xffff0000, v118
    v_lshlrev_b32 v190, 16, v119
    v_and_b32 v191, 0xffff0000, v119
    s_mov_b32 s38, 262144
    s_waitcnt vmcnt(2)
    v_xor_b32 v89, s95, v89
    v_xor_b32 v91, s95, v91
    s_waitcnt vmcnt(1)
    v_xor_b32 v93, s95, v93
    v_xor_b32 v95, s95, v95
    v_or3_b32 v89, v89, v91, v93
    v_or_b32 v89, v89, v95
    v_cmp_ne_u32 vcc, 0, v89
    s_cbranch_vccz Lhead_gotm
Lhead_pollm:
    buffer_load_dwordx4 v[88:91], v124, s[24:27], s37 offen sc1
    buffer_load_dwordx4 v[92:95], v125, s[24:27], s37 offen sc1
    s_waitcnt vmcnt(0)
    s_sub_u32 s38, s38, 1
    s_cbranch_scc1 Lhead_gotm
    v_xor_b32 v89, s95, v89
    v_xor_b32 v91, s95, v91
    v_xor_b32 v93, s95, v93
    v_xor_b32 v95, s95, v95
    v_or3_b32 v89, v89, v91, v93
    v_or_b32 v89, v89, v95
    v_cmp_ne_u32 vcc, 0, v89
    s_cbranch_vccnz Lhead_pollm
Lhead_gotm:
    ds_write2_b32 v122, v88, v90 offset0:0 offset1:1
    ds_write2_b32 v123, v92, v94 offset0:0 offset1:1
    s_waitcnt lgkmcnt(0)
    s_barrier
    ds_read_b128 v[144:147], v68 offset:2176
    ds_read_b128 v[156:159], v68 offset:1024
    ds_read_b128 v[148:151], v68 offset:2560
    ds_read_b128 v[160:163], v68 offset:1408
    ds_read_b128 v[152:155], v68 offset:2944
    ds_read_b128 v[164:167], v68 offset:1792
    s_waitcnt lgkmcnt(5)
    v_lshlrev_b32 v192, 16, v144
    v_and_b32 v193, 0xffff0000, v144
    v_lshlrev_b32 v194, 16, v145
    v_and_b32 v195, 0xffff0000, v145
    v_lshlrev_b32 v196, 16, v146
    v_and_b32 v197, 0xffff0000, v146
    v_lshlrev_b32 v198, 16, v147
    v_and_b32 v199, 0xffff0000, v147
    v_pk_mul_f32 v[168:169], v[168:169], v[192:193]
    v_pk_mul_f32 v[170:171], v[170:171], v[194:195]
    v_pk_mul_f32 v[172:173], v[172:173], v[196:197]
    v_pk_mul_f32 v[174:175], v[174:175], v[198:199]
    v_cvt_pk_bf16_f32 v108, v168, v169
    v_cvt_pk_bf16_f32 v109, v170, v171
    v_cvt_pk_bf16_f32 v110, v172, v173
    v_cvt_pk_bf16_f32 v111, v174, v175
    s_waitcnt lgkmcnt(4)
    v_lshlrev_b32 v216, 16, v156
    v_and_b32 v217, 0xffff0000, v156
    v_lshlrev_b32 v218, 16, v157
    v_and_b32 v219, 0xffff0000, v157
    v_lshlrev_b32 v220, 16, v158
    v_and_b32 v221, 0xffff0000, v158
    v_lshlrev_b32 v222, 16, v159
    v_and_b32 v223, 0xffff0000, v159
    v_lshlrev_b32 v168, 16, v108
    v_and_b32 v169, 0xffff0000, v108
    v_lshlrev_b32 v170, 16, v109
    v_and_b32 v171, 0xffff0000, v109
    v_lshlrev_b32 v172, 16, v110
    v_and_b32 v173, 0xffff0000, v110
    v_lshlrev_b32 v174, 16, v111
    v_and_b32 v175, 0xffff0000, v111
    v_pk_add_f32 v[168:169], v[168:169], v[216:217]
    v_pk_add_f32 v[170:171], v[170:171], v[218:219]
    v_pk_add_f32 v[172:173], v[172:173], v[220:221]
    v_pk_add_f32 v[174:175], v[174:175], v[222:223]
    v_cvt_pk_bf16_f32 v108, v168, v169
    v_cvt_pk_bf16_f32 v109, v170, v171
    v_cvt_pk_bf16_f32 v110, v172, v173
    v_cvt_pk_bf16_f32 v111, v174, v175
    buffer_store_dwordx4 v[108:111], v67, s[24:27], s92 offen offset:0 sc1
    s_waitcnt lgkmcnt(3)
    v_lshlrev_b32 v200, 16, v148
    v_and_b32 v201, 0xffff0000, v148
    v_lshlrev_b32 v202, 16, v149
    v_and_b32 v203, 0xffff0000, v149
    v_lshlrev_b32 v204, 16, v150
    v_and_b32 v205, 0xffff0000, v150
    v_lshlrev_b32 v206, 16, v151
    v_and_b32 v207, 0xffff0000, v151
    v_pk_mul_f32 v[176:177], v[176:177], v[200:201]
    v_pk_mul_f32 v[178:179], v[178:179], v[202:203]
    v_pk_mul_f32 v[180:181], v[180:181], v[204:205]
    v_pk_mul_f32 v[182:183], v[182:183], v[206:207]
    v_cvt_pk_bf16_f32 v112, v176, v177
    v_cvt_pk_bf16_f32 v113, v178, v179
    v_cvt_pk_bf16_f32 v114, v180, v181
    v_cvt_pk_bf16_f32 v115, v182, v183
    s_waitcnt lgkmcnt(2)
    v_lshlrev_b32 v224, 16, v160
    v_and_b32 v225, 0xffff0000, v160
    v_lshlrev_b32 v226, 16, v161
    v_and_b32 v227, 0xffff0000, v161
    v_lshlrev_b32 v228, 16, v162
    v_and_b32 v229, 0xffff0000, v162
    v_lshlrev_b32 v230, 16, v163
    v_and_b32 v231, 0xffff0000, v163
    v_lshlrev_b32 v176, 16, v112
    v_and_b32 v177, 0xffff0000, v112
    v_lshlrev_b32 v178, 16, v113
    v_and_b32 v179, 0xffff0000, v113
    v_lshlrev_b32 v180, 16, v114
    v_and_b32 v181, 0xffff0000, v114
    v_lshlrev_b32 v182, 16, v115
    v_and_b32 v183, 0xffff0000, v115
    v_pk_add_f32 v[176:177], v[176:177], v[224:225]
    v_pk_add_f32 v[178:179], v[178:179], v[226:227]
    v_pk_add_f32 v[180:181], v[180:181], v[228:229]
    v_pk_add_f32 v[182:183], v[182:183], v[230:231]
    v_cvt_pk_bf16_f32 v112, v176, v177
    v_cvt_pk_bf16_f32 v113, v178, v179
    v_cvt_pk_bf16_f32 v114, v180, v181
    v_cvt_pk_bf16_f32 v115, v182, v183
    buffer_store_dwordx4 v[112:115], v67, s[24:27], s92 offen offset:768 sc1
    s_waitcnt lgkmcnt(1)
    v_lshlrev_b32 v208, 16, v152
    v_and_b32 v209, 0xffff0000, v152
    v_lshlrev_b32 v210, 16, v153
    v_and_b32 v211, 0xffff0000, v153
    v_lshlrev_b32 v212, 16, v154
    v_and_b32 v213, 0xffff0000, v154
    v_lshlrev_b32 v214, 16, v155
    v_and_b32 v215, 0xffff0000, v155
    v_pk_mul_f32 v[184:185], v[184:185], v[208:209]
    v_pk_mul_f32 v[186:187], v[186:187], v[210:211]
    v_pk_mul_f32 v[188:189], v[188:189], v[212:213]
    v_pk_mul_f32 v[190:191], v[190:191], v[214:215]
    v_cvt_pk_bf16_f32 v116, v184, v185
    v_cvt_pk_bf16_f32 v117, v186, v187
    v_cvt_pk_bf16_f32 v118, v188, v189
    v_cvt_pk_bf16_f32 v119, v190, v191
    s_waitcnt lgkmcnt(0)
    v_lshlrev_b32 v232, 16, v164
    v_and_b32 v233, 0xffff0000, v164
    v_lshlrev_b32 v234, 16, v165
    v_and_b32 v235, 0xffff0000, v165
    v_lshlrev_b32 v236, 16, v166
    v_and_b32 v237, 0xffff0000, v166
    v_lshlrev_b32 v238, 16, v167
    v_and_b32 v239, 0xffff0000, v167
    v_lshlrev_b32 v184, 16, v116
    v_and_b32 v185, 0xffff0000, v116
    v_lshlrev_b32 v186, 16, v117
    v_and_b32 v187, 0xffff0000, v117
    v_lshlrev_b32 v188, 16, v118
    v_and_b32 v189, 0xffff0000, v118
    v_lshlrev_b32 v190, 16, v119
    v_and_b32 v191, 0xffff0000, v119
    v_pk_add_f32 v[184:185], v[184:185], v[232:233]
    v_pk_add_f32 v[186:187], v[186:187], v[234:235]
    v_pk_add_f32 v[188:189], v[188:189], v[236:237]
    v_pk_add_f32 v[190:191], v[190:191], v[238:239]
    v_cvt_pk_bf16_f32 v116, v184, v185
    v_cvt_pk_bf16_f32 v117, v186, v187
    v_cvt_pk_bf16_f32 v118, v188, v189
    v_cvt_pk_bf16_f32 v119, v190, v191
    buffer_store_dwordx4 v[116:119], v67, s[24:27], s92 offen offset:1536 sc1
    s_lshl_b32 s36, s5, 13
    s_add_u32 s36, s36, 8650752
    s_lshl_b32 s37, s4, 9
    s_add_u32 s37, s37, s36
    s_lshl_b32 s38, s3, 7
    s_add_u32 s37, s37, s38
    s_lshl_b32 s38, s3, 11
    s_add_u32 s36, s36, s38
    v_min_u32 v72, 1, v1
    v_lshlrev_b32 v72, 31, v72
    v_and_b32 v73, 15, v1
    v_lshlrev_b32 v73, 7, v73
    v_cmp_gt_u32 vcc, 162, v0
    v_mov_b32 v88, -1
    v_mov_b32 v89, -1
    v_mov_b32 v90, -1
    v_mov_b32 v91, -1
    s_mul_i32 s39, s2, 2592
    s_add_u32 s39, s39, 7864320
    v_lshl_add_u32 v74, v0, 4, s39
    s_lshl_b32 s39, s2, 7
    s_add_u32 s39, s39, 9306112
    v_mov_b32 v75, s39
    v_cndmask_b32 v74, v75, v74, vcc
    s_lshl_b32 s92, s5, 13
    s_add_u32 s92, s92, 8781824
    s_add_u32 s92, s92, s38
    s_lshl_b32 s38, s4, 7
    s_add_u32 s92, s92, s38
    s_getreg_b32 s38, hwreg(HW_REG_XCC_ID, 0, 4)
    s_lshl_b32 s38, s38, 28
    s_xor_b32 s38, s38, s95
    v_mov_b32 v76, s38
    v_mov_b32 v2, v80
    v_mov_b32 v3, v81
    v_mov_b32 v4, v82
    v_mov_b32 v5, v83
    v_mov_b32 v6, v84
    v_mov_b32 v7, v65
    v_and_b32 v126, 31, v1
    v_lshlrev_b32 v126, 2, v126
    s_add_u32 s49, s44, 0
    s_add_u32 m0, s42, 32768
    s_nop 0
    buffer_load_dwordx4 v42, s[16:19], s49 offen lds
    buffer_load_dwordx4 v43, s[16:19], s49 offen offset:1024 lds
    buffer_load_dwordx4 v44, s[16:19], s49 offen offset:2048 lds
    buffer_load_dwordx4 v45, s[16:19], s49 offen offset:3072 lds
    s_add_u32 s49, s44, 256
    s_add_u32 m0, s42, 49152
    s_nop 0
    buffer_load_dwordx4 v42, s[16:19], s49 offen lds
    buffer_load_dwordx4 v43, s[16:19], s49 offen offset:1024 lds
    buffer_load_dwordx4 v44, s[16:19], s49 offen offset:2048 lds
    buffer_load_dwordx4 v45, s[16:19], s49 offen offset:3072 lds
    s_waitcnt vmcnt(8)
    buffer_store_dword v137, v126, s[24:27], s37 offen sc1
    s_add_u32 s49, s44, 524288
    s_add_u32 m0, s42, 65536
    s_nop 0
    buffer_load_dwordx4 v42, s[16:19], s49 offen lds
    buffer_load_dwordx4 v43, s[16:19], s49 offen offset:1024 lds
    buffer_load_dwordx4 v44, s[16:19], s49 offen offset:2048 lds
    buffer_load_dwordx4 v45, s[16:19], s49 offen offset:3072 lds
    s_add_u32 s49, s44, 524544
    s_add_u32 m0, s42, 81920
    s_nop 0
    buffer_load_dwordx4 v42, s[16:19], s49 offen lds
    buffer_load_dwordx4 v43, s[16:19], s49 offen offset:1024 lds
    buffer_load_dwordx4 v44, s[16:19], s49 offen offset:2048 lds
    buffer_load_dwordx4 v45, s[16:19], s49 offen offset:3072 lds
    s_add_u32 s49, s44, 1048576
    s_add_u32 m0, s42, 98304
    s_nop 0
    buffer_load_dwordx4 v42, s[16:19], s49 offen lds
    buffer_load_dwordx4 v43, s[16:19], s49 offen offset:1024 lds
    buffer_load_dwordx4 v44, s[16:19], s49 offen offset:2048 lds
    buffer_load_dwordx4 v45, s[16:19], s49 offen offset:3072 lds
    s_add_u32 s49, s44, 1048832
    s_add_u32 m0, s42, 114688
    s_nop 0
    buffer_load_dwordx4 v42, s[16:19], s49 offen lds
    buffer_load_dwordx4 v43, s[16:19], s49 offen offset:1024 lds
    buffer_load_dwordx4 v44, s[16:19], s49 offen offset:2048 lds
    buffer_load_dwordx4 v45, s[16:19], s49 offen offset:3072 lds
    s_add_u32 s49, s44, 1572864
    s_add_u32 m0, s42, 131072
    s_nop 0
    buffer_load_dwordx4 v42, s[16:19], s49 offen lds
    buffer_load_dwordx4 v43, s[16:19], s49 offen offset:1024 lds
    buffer_load_dwordx4 v44, s[16:19], s49 offen offset:2048 lds
    buffer_load_dwordx4 v45, s[16:19], s49 offen offset:3072 lds
    s_add_u32 s49, s44, 1573120
    s_add_u32 m0, s42, 147456
    s_nop 0
    buffer_load_dwordx4 v42, s[16:19], s49 offen lds
    buffer_load_dwordx4 v43, s[16:19], s49 offen offset:1024 lds
    buffer_load_dwordx4 v44, s[16:19], s49 offen offset:2048 lds
    buffer_load_dwordx4 v45, s[16:19], s49 offen offset:3072 lds
    s_mov_b32 s38, 262144
Lhead_pollh:
    buffer_load_dword v75, v73, s[24:27], s36 offen sc1
    s_sub_u32 s38, s38, 1
    s_cbranch_scc1 Lhead_goth
    s_waitcnt vmcnt(0) lgkmcnt(0)
    v_cmp_ne_u32 vcc, s95, v75
    s_cbranch_vccnz Lhead_pollh
Lhead_goth:
    s_waitcnt vmcnt(0) lgkmcnt(0)
    buffer_load_dwordx4 a[0:3], v51, s[24:27], s46 offen offset:0 sc1
    buffer_load_dwordx4 a[8:11], v51, s[24:27], s46 offen offset:128 sc1
    buffer_load_dwordx4 a[4:7], v51, s[24:27], s43 offen offset:0 sc1
    buffer_load_dwordx4 a[12:15], v51, s[24:27], s43 offen offset:128 sc1
    s_barrier
    ds_read_b64_tr_b16 a[160:161], v12 offset:32768
    ds_read_b64_tr_b16 a[162:163], v12 offset:36864
    ds_read_b64_tr_b16 a[164:165], v12 offset:40960
    ds_read_b64_tr_b16 a[166:167], v12 offset:45056
    ds_read_b64_tr_b16 a[168:169], v13 offset:32768
    ds_read_b64_tr_b16 a[170:171], v13 offset:36864
    ds_read_b64_tr_b16 a[172:173], v13 offset:40960
    ds_read_b64_tr_b16 a[174:175], v13 offset:45056
    ds_read_b64_tr_b16 a[176:177], v14 offset:32768
    ds_read_b64_tr_b16 a[178:179], v14 offset:36864
    ds_read_b64_tr_b16 a[180:181], v14 offset:40960
    ds_read_b64_tr_b16 a[182:183], v14 offset:45056
    buffer_load_dwordx4 a[16:19], v51, s[24:27], s46 offen offset:256 sc1
    buffer_load_dwordx4 a[24:27], v51, s[24:27], s46 offen offset:384 sc1
    buffer_load_dwordx4 a[20:23], v51, s[24:27], s43 offen offset:256 sc1
    buffer_load_dwordx4 a[28:31], v51, s[24:27], s43 offen offset:384 sc1
    s_waitcnt lgkmcnt(10)
    s_waitcnt vmcnt(7)
    v_mfma_f32_16x16x32_bf16 v[128:131], a[160:163], a[0:3], 0
    s_waitcnt vmcnt(6)
    s_waitcnt lgkmcnt(8)
    ds_read_b64_tr_b16 a[184:185], v15 offset:32768
    v_mfma_f32_16x16x32_bf16 v[128:131], a[164:167], a[8:11], v[128:131]
    s_waitcnt vmcnt(4)
    ds_read_b64_tr_b16 a[186:187], v15 offset:36864
    v_mfma_f32_16x16x32_bf16 v[132:135], a[164:167], a[12:15], 0
    ds_read_b64_tr_b16 a[188:189], v15 offset:40960
    v_mfma_f32_16x16x32_bf16 v[132:135], a[160:163], a[4:7], v[132:135]
    s_waitcnt lgkmcnt(9)
    buffer_load_dwordx4 a[32:35], v51, s[24:27], s46 offen offset:512 sc1
    v_mfma_f32_16x16x32_bf16 v[140:143], a[168:171], a[4:7], 0
    s_waitcnt lgkmcnt(7)
    ds_read_b64_tr_b16 a[190:191], v15 offset:45056
    ds_read_b64_tr_b16 a[160:161], v16 offset:32768
    v_mfma_f32_16x16x32_bf16 v[140:143], a[172:175], a[12:15], v[140:143]
    ds_read_b64_tr_b16 a[162:163], v16 offset:36864
    v_mfma_f32_16x16x32_bf16 v[136:139], a[172:175], a[8:11], 0
    ds_read_b64_tr_b16 a[164:165], v16 offset:40960
    v_mfma_f32_16x16x32_bf16 v[136:139], a[168:171], a[0:3], v[136:139]
    s_waitcnt lgkmcnt(9)
    buffer_load_dwordx4 a[40:43], v51, s[24:27], s46 offen offset:640 sc1
    v_mfma_f32_16x16x32_bf16 v[144:147], a[176:179], a[0:3], 0
    s_waitcnt lgkmcnt(7)
    ds_read_b64_tr_b16 a[166:167], v16 offset:45056
    ds_read_b64_tr_b16 a[168:169], v17 offset:32768
    v_mfma_f32_16x16x32_bf16 v[144:147], a[180:183], a[8:11], v[144:147]
    ds_read_b64_tr_b16 a[170:171], v17 offset:36864
    v_mfma_f32_16x16x32_bf16 v[148:151], a[180:183], a[12:15], 0
    ds_read_b64_tr_b16 a[172:173], v17 offset:40960
    v_mfma_f32_16x16x32_bf16 v[148:151], a[176:179], a[4:7], v[148:151]
    s_waitcnt lgkmcnt(9)
    buffer_load_dwordx4 a[36:39], v51, s[24:27], s43 offen offset:512 sc1
    v_mfma_f32_16x16x32_bf16 v[156:159], a[184:187], a[4:7], 0
    s_waitcnt lgkmcnt(7)
    ds_read_b64_tr_b16 a[174:175], v17 offset:45056
    ds_read_b64_tr_b16 a[176:177], v18 offset:32768
    v_mfma_f32_16x16x32_bf16 v[156:159], a[188:191], a[12:15], v[156:159]
    ds_read_b64_tr_b16 a[178:179], v18 offset:36864
    v_mfma_f32_16x16x32_bf16 v[152:155], a[188:191], a[8:11], 0
    ds_read_b64_tr_b16 a[180:181], v18 offset:40960
    v_mfma_f32_16x16x32_bf16 v[152:155], a[184:187], a[0:3], v[152:155]
    s_waitcnt lgkmcnt(9)
    buffer_load_dwordx4 a[44:47], v51, s[24:27], s43 offen offset:640 sc1
    v_mfma_f32_16x16x32_bf16 v[160:163], a[160:163], a[0:3], 0
    s_waitcnt lgkmcnt(7)
    ds_read_b64_tr_b16 a[182:183], v18 offset:45056
    ds_read_b64_tr_b16 a[184:185], v19 offset:32768
    v_mfma_f32_16x16x32_bf16 v[160:163], a[164:167], a[8:11], v[160:163]
    ds_read_b64_tr_b16 a[186:187], v19 offset:36864
    v_mfma_f32_16x16x32_bf16 v[164:167], a[164:167], a[12:15], 0
    ds_read_b64_tr_b16 a[188:189], v19 offset:40960
    v_mfma_f32_16x16x32_bf16 v[164:167], a[160:163], a[4:7], v[164:167]
    s_waitcnt lgkmcnt(9)
    buffer_load_dword v77, v70, s[16:19], s44 offen
    v_mfma_f32_16x16x32_bf16 v[172:175], a[168:171], a[4:7], 0
    s_waitcnt lgkmcnt(7)
    ds_read_b64_tr_b16 a[190:191], v19 offset:45056
    ds_read_b64_tr_b16 a[160:161], v12 offset:49152
    v_mfma_f32_16x16x32_bf16 v[172:175], a[172:175], a[12:15], v[172:175]
    ds_read_b64_tr_b16 a[162:163], v12 offset:53248
    v_mfma_f32_16x16x32_bf16 v[168:171], a[172:175], a[8:11], 0
    ds_read_b64_tr_b16 a[164:165], v12 offset:57344
    v_mfma_f32_16x16x32_bf16 v[168:171], a[168:171], a[0:3], v[168:171]
    s_waitcnt lgkmcnt(9)
    ds_read_b64_tr_b16 a[166:167], v12 offset:61440
    v_mfma_f32_16x16x32_bf16 v[176:179], a[176:179], a[0:3], 0
    s_waitcnt lgkmcnt(8)
    ds_read_b64_tr_b16 a[168:169], v13 offset:49152
    v_mfma_f32_16x16x32_bf16 v[176:179], a[180:183], a[8:11], v[176:179]
    ds_read_b64_tr_b16 a[170:171], v13 offset:53248
    v_mfma_f32_16x16x32_bf16 v[180:183], a[180:183], a[12:15], 0
    ds_read_b64_tr_b16 a[172:173], v13 offset:57344
    v_mfma_f32_16x16x32_bf16 v[180:183], a[176:179], a[4:7], v[180:183]
    s_waitcnt lgkmcnt(9)
    ds_read_b64_tr_b16 a[174:175], v13 offset:61440
    v_mfma_f32_16x16x32_bf16 v[188:191], a[184:187], a[4:7], 0
    s_waitcnt lgkmcnt(8)
    ds_read_b64_tr_b16 a[176:177], v14 offset:49152
    v_mfma_f32_16x16x32_bf16 v[188:191], a[188:191], a[12:15], v[188:191]
    ds_read_b64_tr_b16 a[178:179], v14 offset:53248
    v_mfma_f32_16x16x32_bf16 v[184:187], a[188:191], a[8:11], 0
    ds_read_b64_tr_b16 a[180:181], v14 offset:57344
    v_mfma_f32_16x16x32_bf16 v[184:187], a[184:187], a[0:3], v[184:187]
    s_waitcnt lgkmcnt(9)
    ds_read_b64_tr_b16 a[182:183], v14 offset:61440
    v_mfma_f32_16x16x32_bf16 v[192:195], a[160:163], a[0:3], 0
    s_waitcnt lgkmcnt(8)
    ds_read_b64_tr_b16 a[184:185], v15 offset:49152
    v_mfma_f32_16x16x32_bf16 v[192:195], a[164:167], a[8:11], v[192:195]
    ds_read_b64_tr_b16 a[186:187], v15 offset:53248
    v_mfma_f32_16x16x32_bf16 v[196:199], a[164:167], a[12:15], 0
    ds_read_b64_tr_b16 a[188:189], v15 offset:57344
    v_mfma_f32_16x16x32_bf16 v[196:199], a[160:163], a[4:7], v[196:199]
    s_waitcnt lgkmcnt(9)
    ds_read_b64_tr_b16 a[190:191], v15 offset:61440
    v_mfma_f32_16x16x32_bf16 v[204:207], a[168:171], a[4:7], 0
    s_waitcnt lgkmcnt(8)
    ds_read_b64_tr_b16 a[160:161], v16 offset:49152
    v_mfma_f32_16x16x32_bf16 v[204:207], a[172:175], a[12:15], v[204:207]
    ds_read_b64_tr_b16 a[162:163], v16 offset:53248
    v_mfma_f32_16x16x32_bf16 v[200:203], a[172:175], a[8:11], 0
    ds_read_b64_tr_b16 a[164:165], v16 offset:57344
    v_mfma_f32_16x16x32_bf16 v[200:203], a[168:171], a[0:3], v[200:203]
    s_waitcnt lgkmcnt(9)
    ds_read_b64_tr_b16 a[166:167], v16 offset:61440
    v_mfma_f32_16x16x32_bf16 v[208:211], a[176:179], a[0:3], 0
    s_waitcnt lgkmcnt(8)
    ds_read_b64_tr_b16 a[168:169], v17 offset:49152
    v_mfma_f32_16x16x32_bf16 v[208:211], a[180:183], a[8:11], v[208:211]
    ds_read_b64_tr_b16 a[170:171], v17 offset:53248
    v_mfma_f32_16x16x32_bf16 v[212:215], a[180:183], a[12:15], 0
    ds_read_b64_tr_b16 a[172:173], v17 offset:57344
    v_mfma_f32_16x16x32_bf16 v[212:215], a[176:179], a[4:7], v[212:215]
    s_waitcnt lgkmcnt(9)
    ds_read_b64_tr_b16 a[174:175], v17 offset:61440
    v_mfma_f32_16x16x32_bf16 v[220:223], a[184:187], a[4:7], 0
    s_waitcnt lgkmcnt(8)
    ds_read_b64_tr_b16 a[176:177], v18 offset:49152
    v_mfma_f32_16x16x32_bf16 v[220:223], a[188:191], a[12:15], v[220:223]
Ltour0_0:
    s_cbranch_execz Ltour0_4
    ds_read_b64_tr_b16 a[178:179], v18 offset:53248
    v_mfma_f32_16x16x32_bf16 v[216:219], a[188:191], a[8:11], 0
    ds_read_b64_tr_b16 a[180:181], v18 offset:57344
    v_mfma_f32_16x16x32_bf16 v[216:219], a[184:187], a[0:3], v[216:219]
    s_waitcnt lgkmcnt(9)
    ds_read_b64_tr_b16 a[182:183], v18 offset:61440
    v_mfma_f32_16x16x32_bf16 v[224:227], a[160:163], a[0:3], 0
    s_waitcnt lgkmcnt(8)
    ds_read_b64_tr_b16 a[184:185], v19 offset:49152
    v_mfma_f32_16x16x32_bf16 v[224:227], a[164:167], a[8:11], v[224:227]
    ds_read_b64_tr_b16 a[186:187], v19 offset:53248
    v_mfma_f32_16x16x32_bf16 v[228:231], a[164:167], a[12:15], 0
    ds_read_b64_tr_b16 a[188:189], v19 offset:57344
    v_mfma_f32_16x16x32_bf16 v[228:231], a[160:163], a[4:7], v[228:231]
    s_waitcnt lgkmcnt(9)
    ds_read_b64_tr_b16 a[190:191], v19 offset:61440
    s_barrier
    v_mfma_f32_16x16x32_bf16 v[236:239], a[168:171], a[4:7], 0
    s_waitcnt lgkmcnt(8)
    ds_read_b64_tr_b16 a[160:161], v20 offset:0
    v_mfma_f32_16x16x32_bf16 v[236:239], a[172:175], a[12:15], v[236:239]
    ds_read_b64_tr_b16 a[162:163], v20 offset:4096
    v_mfma_f32_16x16x32_bf16 v[232:235], a[172:175], a[8:11], 0
    ds_read_b64_tr_b16 a[164:165], v20 offset:8192
    v_mfma_f32_16x16x32_bf16 v[232:235], a[168:171], a[0:3], v[232:235]
    s_waitcnt lgkmcnt(9)
    buffer_load_dwordx4 a[48:51], v51, s[24:27], s46 offen offset:768 sc1
    v_mfma_f32_16x16x32_bf16 v[240:243], a[176:179], a[0:3], 0
    s_waitcnt lgkmcnt(7)
    ds_read_b64_tr_b16 a[166:167], v20 offset:12288
    ds_read_b64_tr_b16 a[168:169], v21 offset:0
    v_mfma_f32_16x16x32_bf16 v[240:243], a[180:183], a[8:11], v[240:243]
    ds_read_b64_tr_b16 a[170:171], v21 offset:4096
    v_mfma_f32_16x16x32_bf16 v[244:247], a[180:183], a[12:15], 0
    ds_read_b64_tr_b16 a[172:173], v21 offset:8192
    v_mfma_f32_16x16x32_bf16 v[244:247], a[176:179], a[4:7], v[244:247]
    s_waitcnt lgkmcnt(9)
    buffer_load_dwordx4 a[56:59], v51, s[24:27], s46 offen offset:896 sc1
    v_mfma_f32_16x16x32_bf16 v[252:255], a[184:187], a[4:7], 0
    s_waitcnt lgkmcnt(7)
    ds_read_b64_tr_b16 a[174:175], v21 offset:12288
    ds_read_b64_tr_b16 a[176:177], v22 offset:0
    v_mfma_f32_16x16x32_bf16 v[252:255], a[188:191], a[12:15], v[252:255]
    ds_read_b64_tr_b16 a[178:179], v22 offset:4096
    v_mfma_f32_16x16x32_bf16 v[248:251], a[188:191], a[8:11], 0
    ds_read_b64_tr_b16 a[180:181], v22 offset:8192
    v_mfma_f32_16x16x32_bf16 v[248:251], a[184:187], a[0:3], v[248:251]
    s_waitcnt vmcnt(10)
    s_waitcnt lgkmcnt(9)
    buffer_load_dwordx4 a[52:55], v51, s[24:27], s43 offen offset:768 sc1
    v_mfma_f32_16x16x32_bf16 v[128:131], a[160:163], a[16:19], v[128:131]
    s_waitcnt vmcnt(10)
    s_waitcnt lgkmcnt(7)
    ds_read_b64_tr_b16 a[182:183], v22 offset:12288
    ds_read_b64_tr_b16 a[184:185], v23 offset:0
    v_mfma_f32_16x16x32_bf16 v[128:131], a[164:167], a[24:27], v[128:131]
    s_waitcnt vmcnt(8)
    ds_read_b64_tr_b16 a[186:187], v23 offset:4096
    v_mfma_f32_16x16x32_bf16 v[132:135], a[164:167], a[28:31], v[132:135]
    ds_read_b64_tr_b16 a[188:189], v23 offset:8192
    v_mfma_f32_16x16x32_bf16 v[132:135], a[160:163], a[20:23], v[132:135]
    s_waitcnt lgkmcnt(9)
    buffer_load_dwordx4 a[60:63], v51, s[24:27], s43 offen offset:896 sc1
    v_mfma_f32_16x16x32_bf16 v[140:143], a[168:171], a[20:23], v[140:143]
    s_waitcnt lgkmcnt(7)
    ds_read_b64_tr_b16 a[190:191], v23 offset:12288
    ds_read_b64_tr_b16 a[160:161], v24 offset:0
    v_mfma_f32_16x16x32_bf16 v[140:143], a[172:175], a[28:31], v[140:143]
    ds_read_b64_tr_b16 a[162:163], v24 offset:4096
    v_mfma_f32_16x16x32_bf16 v[136:139], a[172:175], a[24:27], v[136:139]
    ds_read_b64_tr_b16 a[164:165], v24 offset:8192
    v_mfma_f32_16x16x32_bf16 v[136:139], a[168:171], a[16:19], v[136:139]
    s_waitcnt lgkmcnt(9)
    buffer_load_dwordx4 a[64:67], v51, s[24:27], s46 offen offset:1024 sc1
    v_mfma_f32_16x16x32_bf16 v[144:147], a[176:179], a[16:19], v[144:147]
    s_waitcnt lgkmcnt(7)
    ds_read_b64_tr_b16 a[166:167], v24 offset:12288
    ds_read_b64_tr_b16 a[168:169], v25 offset:0
    v_mfma_f32_16x16x32_bf16 v[144:147], a[180:183], a[24:27], v[144:147]
    ds_read_b64_tr_b16 a[170:171], v25 offset:4096
    v_mfma_f32_16x16x32_bf16 v[148:151], a[180:183], a[28:31], v[148:151]
    ds_read_b64_tr_b16 a[172:173], v25 offset:8192
    v_mfma_f32_16x16x32_bf16 v[148:151], a[176:179], a[20:23], v[148:151]
    s_waitcnt lgkmcnt(9)
    buffer_load_dwordx4 a[72:75], v51, s[24:27], s46 offen offset:1152 sc1
    v_mfma_f32_16x16x32_bf16 v[156:159], a[184:187], a[20:23], v[156:159]
    s_waitcnt lgkmcnt(7)
    ds_read_b64_tr_b16 a[174:175], v25 offset:12288
    ds_read_b64_tr_b16 a[176:177], v26 offset:0
    v_mfma_f32_16x16x32_bf16 v[156:159], a[188:191], a[28:31], v[156:159]
    ds_read_b64_tr_b16 a[178:179], v26 offset:4096
    v_mfma_f32_16x16x32_bf16 v[152:155], a[188:191], a[24:27], v[152:155]
    ds_read_b64_tr_b16 a[180:181], v26 offset:8192
    v_mfma_f32_16x16x32_bf16 v[152:155], a[184:187], a[16:19], v[152:155]
    s_waitcnt lgkmcnt(9)
    buffer_load_dwordx4 a[68:71], v51, s[24:27], s43 offen offset:1024 sc1
    v_mfma_f32_16x16x32_bf16 v[160:163], a[160:163], a[16:19], v[160:163]
    s_waitcnt lgkmcnt(7)
    ds_read_b64_tr_b16 a[182:183], v26 offset:12288
    ds_read_b64_tr_b16 a[184:185], v27 offset:0
    v_mfma_f32_16x16x32_bf16 v[160:163], a[164:167], a[24:27], v[160:163]
    ds_read_b64_tr_b16 a[186:187], v27 offset:4096
    v_mfma_f32_16x16x32_bf16 v[164:167], a[164:167], a[28:31], v[164:167]
    ds_read_b64_tr_b16 a[188:189], v27 offset:8192
    v_mfma_f32_16x16x32_bf16 v[164:167], a[160:163], a[20:23], v[164:167]
    s_waitcnt lgkmcnt(9)
    buffer_load_dwordx4 a[76:79], v51, s[24:27], s43 offen offset:1152 sc1
    v_mfma_f32_16x16x32_bf16 v[172:175], a[168:171], a[20:23], v[172:175]
    s_waitcnt lgkmcnt(7)
    ds_read_b64_tr_b16 a[190:191], v27 offset:12288
    ds_read_b64_tr_b16 a[160:161], v20 offset:16384
    v_mfma_f32_16x16x32_bf16 v[172:175], a[172:175], a[28:31], v[172:175]
    ds_read_b64_tr_b16 a[162:163], v20 offset:20480
    v_mfma_f32_16x16x32_bf16 v[168:171], a[172:175], a[24:27], v[168:171]
    ds_read_b64_tr_b16 a[164:165], v20 offset:24576
    v_mfma_f32_16x16x32_bf16 v[168:171], a[168:171], a[16:19], v[168:171]
    s_waitcnt lgkmcnt(9)
    ds_read_b64_tr_b16 a[166:167], v20 offset:28672
    v_mfma_f32_16x16x32_bf16 v[176:179], a[176:179], a[16:19], v[176:179]
    s_waitcnt lgkmcnt(8)
    ds_read_b64_tr_b16 a[168:169], v21 offset:16384
    v_mfma_f32_16x16x32_bf16 v[176:179], a[180:183], a[24:27], v[176:179]
    ds_read_b64_tr_b16 a[170:171], v21 offset:20480
    v_mfma_f32_16x16x32_bf16 v[180:183], a[180:183], a[28:31], v[180:183]
    ds_read_b64_tr_b16 a[172:173], v21 offset:24576
    v_mfma_f32_16x16x32_bf16 v[180:183], a[176:179], a[20:23], v[180:183]
    s_waitcnt lgkmcnt(9)
    ds_read_b64_tr_b16 a[174:175], v21 offset:28672
    v_mfma_f32_16x16x32_bf16 v[188:191], a[184:187], a[20:23], v[188:191]
    s_waitcnt lgkmcnt(8)
    ds_read_b64_tr_b16 a[176:177], v22 offset:16384
    v_mfma_f32_16x16x32_bf16 v[188:191], a[188:191], a[28:31], v[188:191]
    ds_read_b64_tr_b16 a[178:179], v22 offset:20480
    v_mfma_f32_16x16x32_bf16 v[184:187], a[188:191], a[24:27], v[184:187]
    ds_read_b64_tr_b16 a[180:181], v22 offset:24576
    v_mfma_f32_16x16x32_bf16 v[184:187], a[184:187], a[16:19], v[184:187]
    s_waitcnt lgkmcnt(9)
    ds_read_b64_tr_b16 a[182:183], v22 offset:28672
    v_mfma_f32_16x16x32_bf16 v[192:195], a[160:163], a[16:19], v[192:195]
    s_waitcnt lgkmcnt(8)
    ds_read_b64_tr_b16 a[184:185], v23 offset:16384
    v_mfma_f32_16x16x32_bf16 v[192:195], a[164:167], a[24:27], v[192:195]
    ds_read_b64_tr_b16 a[186:187], v23 offset:20480
    v_mfma_f32_16x16x32_bf16 v[196:199], a[164:167], a[28:31], v[196:199]
    ds_read_b64_tr_b16 a[188:189], v23 offset:24576
    v_mfma_f32_16x16x32_bf16 v[196:199], a[160:163], a[20:23], v[196:199]
    s_waitcnt lgkmcnt(9)
    ds_read_b64_tr_b16 a[190:191], v23 offset:28672
    v_mfma_f32_16x16x32_bf16 v[204:207], a[168:171], a[20:23], v[204:207]
    s_waitcnt lgkmcnt(8)
    ds_read_b64_tr_b16 a[160:161], v24 offset:16384
    v_mfma_f32_16x16x32_bf16 v[204:207], a[172:175], a[28:31], v[204:207]
    ds_read_b64_tr_b16 a[162:163], v24 offset:20480
    v_mfma_f32_16x16x32_bf16 v[200:203], a[172:175], a[24:27], v[200:203]
    ds_read_b64_tr_b16 a[164:165], v24 offset:24576
    v_mfma_f32_16x16x32_bf16 v[200:203], a[168:171], a[16:19], v[200:203]
    s_waitcnt lgkmcnt(9)
    ds_read_b64_tr_b16 a[166:167], v24 offset:28672
    v_mfma_f32_16x16x32_bf16 v[208:211], a[176:179], a[16:19], v[208:211]
    s_waitcnt lgkmcnt(8)
    ds_read_b64_tr_b16 a[168:169], v25 offset:16384
    v_mfma_f32_16x16x32_bf16 v[208:211], a[180:183], a[24:27], v[208:211]
    ds_read_b64_tr_b16 a[170:171], v25 offset:20480
    v_mfma_f32_16x16x32_bf16 v[212:215], a[180:183], a[28:31], v[212:215]
    ds_read_b64_tr_b16 a[172:173], v25 offset:24576
    v_mfma_f32_16x16x32_bf16 v[212:215], a[176:179], a[20:23], v[212:215]
    s_waitcnt lgkmcnt(9)
    ds_read_b64_tr_b16 a[174:175], v25 offset:28672
    v_mfma_f32_16x16x32_bf16 v[220:223], a[184:187], a[20:23], v[220:223]
    s_waitcnt lgkmcnt(8)
    ds_read_b64_tr_b16 a[176:177], v26 offset:16384
    v_mfma_f32_16x16x32_bf16 v[220:223], a[188:191], a[28:31], v[220:223]
    ds_read_b64_tr_b16 a[178:179], v26 offset:20480
    v_mfma_f32_16x16x32_bf16 v[216:219], a[188:191], a[24:27], v[216:219]
    ds_read_b64_tr_b16 a[180:181], v26 offset:24576
    v_mfma_f32_16x16x32_bf16 v[216:219], a[184:187], a[16:19], v[216:219]
    s_waitcnt lgkmcnt(9)
    ds_read_b64_tr_b16 a[182:183], v26 offset:28672
    v_mfma_f32_16x16x32_bf16 v[224:227], a[160:163], a[16:19], v[224:227]
    s_waitcnt lgkmcnt(8)
    ds_read_b64_tr_b16 a[184:185], v27 offset:16384
    v_mfma_f32_16x16x32_bf16 v[224:227], a[164:167], a[24:27], v[224:227]
    ds_read_b64_tr_b16 a[186:187], v27 offset:20480
    v_mfma_f32_16x16x32_bf16 v[228:231], a[164:167], a[28:31], v[228:231]
    ds_read_b64_tr_b16 a[188:189], v27 offset:24576
    v_mfma_f32_16x16x32_bf16 v[228:231], a[160:163], a[20:23], v[228:231]
    s_waitcnt lgkmcnt(9)
    ds_read_b64_tr_b16 a[190:191], v27 offset:28672
    s_barrier
    v_mfma_f32_16x16x32_bf16 v[236:239], a[168:171], a[20:23], v[236:239]
    s_waitcnt lgkmcnt(8)
    ds_read_b64_tr_b16 a[160:161], v20 offset:32768
    v_mfma_f32_16x16x32_bf16 v[236:239], a[172:175], a[28:31], v[236:239]
    s_add_u32 s49, s44, 2097152
    ds_read_b64_tr_b16 a[162:163], v20 offset:36864
    v_mfma_f32_16x16x32_bf16 v[232:235], a[172:175], a[24:27], v[232:235]
    s_add_u32 m0, s42, 0
    ds_read_b64_tr_b16 a[164:165], v20 offset:40960
    v_mfma_f32_16x16x32_bf16 v[232:235], a[168:171], a[16:19], v[232:235]
    s_waitcnt lgkmcnt(9)
    buffer_load_dwordx4 v42, s[16:19], s49 offen lds
    v_mfma_f32_16x16x32_bf16 v[240:243], a[176:179], a[16:19], v[240:243]
    s_waitcnt lgkmcnt(7)
    ds_read_b64_tr_b16 a[166:167], v20 offset:45056
    ds_read_b64_tr_b16 a[168:169], v21 offset:32768
    v_mfma_f32_16x16x32_bf16 v[240:243], a[180:183], a[24:27], v[240:243]
    ds_read_b64_tr_b16 a[170:171], v21 offset:36864
    v_mfma_f32_16x16x32_bf16 v[244:247], a[180:183], a[28:31], v[244:247]
    ds_read_b64_tr_b16 a[172:173], v21 offset:40960
    v_mfma_f32_16x16x32_bf16 v[244:247], a[176:179], a[20:23], v[244:247]
    s_waitcnt lgkmcnt(9)
    buffer_load_dwordx4 v43, s[16:19], s49 offen offset:1024 lds
    v_mfma_f32_16x16x32_bf16 v[252:255], a[184:187], a[20:23], v[252:255]
    s_waitcnt lgkmcnt(7)
    ds_read_b64_tr_b16 a[174:175], v21 offset:45056
    ds_read_b64_tr_b16 a[176:177], v22 offset:32768
    v_mfma_f32_16x16x32_bf16 v[252:255], a[188:191], a[28:31], v[252:255]
    ds_read_b64_tr_b16 a[178:179], v22 offset:36864
    v_mfma_f32_16x16x32_bf16 v[248:251], a[188:191], a[24:27], v[248:251]
    ds_read_b64_tr_b16 a[180:181], v22 offset:40960
    v_mfma_f32_16x16x32_bf16 v[248:251], a[184:187], a[16:19], v[248:251]
    s_waitcnt vmcnt(14)
    s_waitcnt lgkmcnt(9)
    buffer_load_dwordx4 v44, s[16:19], s49 offen offset:2048 lds
    v_mfma_f32_16x16x32_bf16 v[128:131], a[160:163], a[32:35], v[128:131]
    s_waitcnt vmcnt(14)
    s_waitcnt lgkmcnt(7)
    ds_read_b64_tr_b16 a[182:183], v22 offset:45056
    ds_read_b64_tr_b16 a[184:185], v23 offset:32768
    v_mfma_f32_16x16x32_bf16 v[128:131], a[164:167], a[40:43], v[128:131]
    s_waitcnt vmcnt(12)
    ds_read_b64_tr_b16 a[186:187], v23 offset:36864
    v_mfma_f32_16x16x32_bf16 v[132:135], a[164:167], a[44:47], v[132:135]
    ds_read_b64_tr_b16 a[188:189], v23 offset:40960
    v_mfma_f32_16x16x32_bf16 v[132:135], a[160:163], a[36:39], v[132:135]
    s_waitcnt lgkmcnt(9)
    buffer_load_dwordx4 v45, s[16:19], s49 offen offset:3072 lds
    v_mfma_f32_16x16x32_bf16 v[140:143], a[168:171], a[36:39], v[140:143]
    s_waitcnt lgkmcnt(7)
    ds_read_b64_tr_b16 a[190:191], v23 offset:45056
    ds_read_b64_tr_b16 a[160:161], v24 offset:32768
    v_mfma_f32_16x16x32_bf16 v[140:143], a[172:175], a[44:47], v[140:143]
    s_add_u32 s49, s44, 2097408
    ds_read_b64_tr_b16 a[162:163], v24 offset:36864
    v_mfma_f32_16x16x32_bf16 v[136:139], a[172:175], a[40:43], v[136:139]
    s_add_u32 m0, s42, 16384
    ds_read_b64_tr_b16 a[164:165], v24 offset:40960
    v_mfma_f32_16x16x32_bf16 v[136:139], a[168:171], a[32:35], v[136:139]
    s_waitcnt lgkmcnt(9)
    buffer_load_dwordx4 v42, s[16:19], s49 offen lds
    v_mfma_f32_16x16x32_bf16 v[144:147], a[176:179], a[32:35], v[144:147]
    s_waitcnt lgkmcnt(7)
    ds_read_b64_tr_b16 a[166:167], v24 offset:45056
    ds_read_b64_tr_b16 a[168:169], v25 offset:32768
    v_mfma_f32_16x16x32_bf16 v[144:147], a[180:183], a[40:43], v[144:147]
    ds_read_b64_tr_b16 a[170:171], v25 offset:36864
    v_mfma_f32_16x16x32_bf16 v[148:151], a[180:183], a[44:47], v[148:151]
    ds_read_b64_tr_b16 a[172:173], v25 offset:40960
    v_mfma_f32_16x16x32_bf16 v[148:151], a[176:179], a[36:39], v[148:151]
    s_waitcnt lgkmcnt(9)
    buffer_load_dwordx4 v43, s[16:19], s49 offen offset:1024 lds
    v_mfma_f32_16x16x32_bf16 v[156:159], a[184:187], a[36:39], v[156:159]
    s_waitcnt lgkmcnt(7)
    ds_read_b64_tr_b16 a[174:175], v25 offset:45056
    ds_read_b64_tr_b16 a[176:177], v26 offset:32768
    v_mfma_f32_16x16x32_bf16 v[156:159], a[188:191], a[44:47], v[156:159]
    ds_read_b64_tr_b16 a[178:179], v26 offset:36864
    v_mfma_f32_16x16x32_bf16 v[152:155], a[188:191], a[40:43], v[152:155]
    ds_read_b64_tr_b16 a[180:181], v26 offset:40960
    v_mfma_f32_16x16x32_bf16 v[152:155], a[184:187], a[32:35], v[152:155]
    s_waitcnt lgkmcnt(9)
    buffer_load_dwordx4 v44, s[16:19], s49 offen offset:2048 lds
    v_mfma_f32_16x16x32_bf16 v[160:163], a[160:163], a[32:35], v[160:163]
    s_waitcnt lgkmcnt(7)
    ds_read_b64_tr_b16 a[182:183], v26 offset:45056
    ds_read_b64_tr_b16 a[184:185], v27 offset:32768
    v_mfma_f32_16x16x32_bf16 v[160:163], a[164:167], a[40:43], v[160:163]
    ds_read_b64_tr_b16 a[186:187], v27 offset:36864
    v_mfma_f32_16x16x32_bf16 v[164:167], a[164:167], a[44:47], v[164:167]
    ds_read_b64_tr_b16 a[188:189], v27 offset:40960
    v_mfma_f32_16x16x32_bf16 v[164:167], a[160:163], a[36:39], v[164:167]
    s_waitcnt lgkmcnt(9)
    buffer_load_dwordx4 v45, s[16:19], s49 offen offset:3072 lds
    v_mfma_f32_16x16x32_bf16 v[172:175], a[168:171], a[36:39], v[172:175]
    s_waitcnt lgkmcnt(7)
    ds_read_b64_tr_b16 a[190:191], v27 offset:45056
    ds_read_b64_tr_b16 a[160:161], v20 offset:49152
    v_mfma_f32_16x16x32_bf16 v[172:175], a[172:175], a[44:47], v[172:175]
    ds_read_b64_tr_b16 a[162:163], v20 offset:53248
    v_mfma_f32_16x16x32_bf16 v[168:171], a[172:175], a[40:43], v[168:171]
    ds_read_b64_tr_b16 a[164:165], v20 offset:57344
    v_mfma_f32_16x16x32_bf16 v[168:171], a[168:171], a[32:35], v[168:171]
    s_waitcnt lgkmcnt(9)
    buffer_load_dwordx4 a[80:83], v51, s[24:27], s46 offen offset:1280 sc1
    v_mfma_f32_16x16x32_bf16 v[176:179], a[176:179], a[32:35], v[176:179]
    s_waitcnt lgkmcnt(7)
    ds_read_b64_tr_b16 a[166:167], v20 offset:61440
    ds_read_b64_tr_b16 a[168:169], v21 offset:49152
    v_mfma_f32_16x16x32_bf16 v[176:179], a[180:183], a[40:43], v[176:179]
    ds_read_b64_tr_b16 a[170:171], v21 offset:53248
    v_mfma_f32_16x16x32_bf16 v[180:183], a[180:183], a[44:47], v[180:183]
    ds_read_b64_tr_b16 a[172:173], v21 offset:57344
    v_mfma_f32_16x16x32_bf16 v[180:183], a[176:179], a[36:39], v[180:183]
    s_waitcnt lgkmcnt(9)
    buffer_load_dwordx4 a[88:91], v51, s[24:27], s46 offen offset:1408 sc1
    v_mfma_f32_16x16x32_bf16 v[188:191], a[184:187], a[36:39], v[188:191]
    s_waitcnt lgkmcnt(7)
    ds_read_b64_tr_b16 a[174:175], v21 offset:61440
    ds_read_b64_tr_b16 a[176:177], v22 offset:49152
    v_mfma_f32_16x16x32_bf16 v[188:191], a[188:191], a[44:47], v[188:191]
    ds_read_b64_tr_b16 a[178:179], v22 offset:53248
    v_mfma_f32_16x16x32_bf16 v[184:187], a[188:191], a[40:43], v[184:187]
    ds_read_b64_tr_b16 a[180:181], v22 offset:57344
    v_mfma_f32_16x16x32_bf16 v[184:187], a[184:187], a[32:35], v[184:187]
    s_waitcnt lgkmcnt(9)
    buffer_load_dwordx4 a[84:87], v51, s[24:27], s43 offen offset:1280 sc1
    v_mfma_f32_16x16x32_bf16 v[192:195], a[160:163], a[32:35], v[192:195]
    s_waitcnt lgkmcnt(7)
    ds_read_b64_tr_b16 a[182:183], v22 offset:61440
    ds_read_b64_tr_b16 a[184:185], v23 offset:49152
    v_mfma_f32_16x16x32_bf16 v[192:195], a[164:167], a[40:43], v[192:195]
    ds_read_b64_tr_b16 a[186:187], v23 offset:53248
    v_mfma_f32_16x16x32_bf16 v[196:199], a[164:167], a[44:47], v[196:199]
    ds_read_b64_tr_b16 a[188:189], v23 offset:57344
    v_mfma_f32_16x16x32_bf16 v[196:199], a[160:163], a[36:39], v[196:199]
    s_waitcnt lgkmcnt(9)
    buffer_load_dwordx4 a[92:95], v51, s[24:27], s43 offen offset:1408 sc1
    v_mfma_f32_16x16x32_bf16 v[204:207], a[168:171], a[36:39], v[204:207]
    s_waitcnt lgkmcnt(7)
    ds_read_b64_tr_b16 a[190:191], v23 offset:61440
    ds_read_b64_tr_b16 a[160:161], v24 offset:49152
    v_mfma_f32_16x16x32_bf16 v[204:207], a[172:175], a[44:47], v[204:207]
    ds_read_b64_tr_b16 a[162:163], v24 offset:53248
    v_mfma_f32_16x16x32_bf16 v[200:203], a[172:175], a[40:43], v[200:203]
    ds_read_b64_tr_b16 a[164:165], v24 offset:57344
    v_mfma_f32_16x16x32_bf16 v[200:203], a[168:171], a[32:35], v[200:203]
    s_waitcnt lgkmcnt(9)
    ds_read_b64_tr_b16 a[166:167], v24 offset:61440
    v_mfma_f32_16x16x32_bf16 v[208:211], a[176:179], a[32:35], v[208:211]
    s_waitcnt lgkmcnt(8)
    ds_read_b64_tr_b16 a[168:169], v25 offset:49152
    v_mfma_f32_16x16x32_bf16 v[208:211], a[180:183], a[40:43], v[208:211]
    ds_read_b64_tr_b16 a[170:171], v25 offset:53248
    v_mfma_f32_16x16x32_bf16 v[212:215], a[180:183], a[44:47], v[212:215]
    ds_read_b64_tr_b16 a[172:173], v25 offset:57344
    v_mfma_f32_16x16x32_bf16 v[212:215], a[176:179], a[36:39], v[212:215]
    s_waitcnt lgkmcnt(9)
    ds_read_b64_tr_b16 a[174:175], v25 offset:61440
    v_mfma_f32_16x16x32_bf16 v[220:223], a[184:187], a[36:39], v[220:223]
    s_waitcnt lgkmcnt(8)
    ds_read_b64_tr_b16 a[176:177], v26 offset:49152
    v_mfma_f32_16x16x32_bf16 v[220:223], a[188:191], a[44:47], v[220:223]
    ds_read_b64_tr_b16 a[178:179], v26 offset:53248
    v_mfma_f32_16x16x32_bf16 v[216:219], a[188:191], a[40:43], v[216:219]
    ds_read_b64_tr_b16 a[180:181], v26 offset:57344
    v_mfma_f32_16x16x32_bf16 v[216:219], a[184:187], a[32:35], v[216:219]
    s_waitcnt lgkmcnt(9)
    ds_read_b64_tr_b16 a[182:183], v26 offset:61440
    v_mfma_f32_16x16x32_bf16 v[224:227], a[160:163], a[32:35], v[224:227]
    s_waitcnt lgkmcnt(8)
    ds_read_b64_tr_b16 a[184:185], v27 offset:49152
    v_mfma_f32_16x16x32_bf16 v[224:227], a[164:167], a[40:43], v[224:227]
    ds_read_b64_tr_b16 a[186:187], v27 offset:53248
    v_mfma_f32_16x16x32_bf16 v[228:231], a[164:167], a[44:47], v[228:231]
    ds_read_b64_tr_b16 a[188:189], v27 offset:57344
    v_mfma_f32_16x16x32_bf16 v[228:231], a[160:163], a[36:39], v[228:231]
    s_waitcnt lgkmcnt(9)
    ds_read_b64_tr_b16 a[190:191], v27 offset:61440
    s_barrier
    v_mfma_f32_16x16x32_bf16 v[236:239], a[168:171], a[36:39], v[236:239]
    s_waitcnt lgkmcnt(8)
    ds_read_b64_tr_b16 a[160:161], v28 offset:0
    v_mfma_f32_16x16x32_bf16 v[236:239], a[172:175], a[44:47], v[236:239]
    s_add_u32 s49, s44, 2621440
    ds_read_b64_tr_b16 a[162:163], v28 offset:4096
    v_mfma_f32_16x16x32_bf16 v[232:235], a[172:175], a[40:43], v[232:235]
    s_add_u32 m0, s42, 32768
    ds_read_b64_tr_b16 a[164:165], v28 offset:8192
    v_mfma_f32_16x16x32_bf16 v[232:235], a[168:171], a[32:35], v[232:235]
    s_waitcnt lgkmcnt(9)
    buffer_load_dwordx4 v42, s[16:19], s49 offen lds
    v_mfma_f32_16x16x32_bf16 v[240:243], a[176:179], a[32:35], v[240:243]
    s_waitcnt lgkmcnt(7)
    ds_read_b64_tr_b16 a[166:167], v28 offset:12288
    ds_read_b64_tr_b16 a[168:169], v29 offset:0
    v_mfma_f32_16x16x32_bf16 v[240:243], a[180:183], a[40:43], v[240:243]
    ds_read_b64_tr_b16 a[170:171], v29 offset:4096
    v_mfma_f32_16x16x32_bf16 v[244:247], a[180:183], a[44:47], v[244:247]
    ds_read_b64_tr_b16 a[172:173], v29 offset:8192
    v_mfma_f32_16x16x32_bf16 v[244:247], a[176:179], a[36:39], v[244:247]
    s_waitcnt lgkmcnt(9)
    buffer_load_dwordx4 v43, s[16:19], s49 offen offset:1024 lds
    v_mfma_f32_16x16x32_bf16 v[252:255], a[184:187], a[36:39], v[252:255]
    s_waitcnt lgkmcnt(7)
    ds_read_b64_tr_b16 a[174:175], v29 offset:12288
    ds_read_b64_tr_b16 a[176:177], v30 offset:0
    v_mfma_f32_16x16x32_bf16 v[252:255], a[188:191], a[44:47], v[252:255]
    ds_read_b64_tr_b16 a[178:179], v30 offset:4096
    v_mfma_f32_16x16x32_bf16 v[248:251], a[188:191], a[40:43], v[248:251]
    ds_read_b64_tr_b16 a[180:181], v30 offset:8192
    v_mfma_f32_16x16x32_bf16 v[248:251], a[184:187], a[32:35], v[248:251]
    s_waitcnt vmcnt(21)
    s_waitcnt lgkmcnt(9)
    buffer_load_dwordx4 v44, s[16:19], s49 offen offset:2048 lds
    v_mfma_f32_16x16x32_bf16 v[128:131], a[160:163], a[48:51], v[128:131]
    s_waitcnt vmcnt(21)
    s_waitcnt lgkmcnt(7)
    ds_read_b64_tr_b16 a[182:183], v30 offset:12288
    ds_read_b64_tr_b16 a[184:185], v31 offset:0
    v_mfma_f32_16x16x32_bf16 v[128:131], a[164:167], a[56:59], v[128:131]
    s_waitcnt vmcnt(19)
    ds_read_b64_tr_b16 a[186:187], v31 offset:4096
    v_mfma_f32_16x16x32_bf16 v[132:135], a[164:167], a[60:63], v[132:135]
    ds_read_b64_tr_b16 a[188:189], v31 offset:8192
    v_mfma_f32_16x16x32_bf16 v[132:135], a[160:163], a[52:55], v[132:135]
    s_waitcnt lgkmcnt(9)
    buffer_load_dwordx4 v45, s[16:19], s49 offen offset:3072 lds
    v_mfma_f32_16x16x32_bf16 v[140:143], a[168:171], a[52:55], v[140:143]
    s_waitcnt lgkmcnt(7)
    ds_read_b64_tr_b16 a[190:191], v31 offset:12288
    ds_read_b64_tr_b16 a[160:161], v32 offset:0
    v_mfma_f32_16x16x32_bf16 v[140:143], a[172:175], a[60:63], v[140:143]
    s_add_u32 s49, s44, 3145728
    ds_read_b64_tr_b16 a[162:163], v32 offset:4096
    v_mfma_f32_16x16x32_bf16 v[136:139], a[172:175], a[56:59], v[136:139]
    s_add_u32 m0, s42, 49152
    ds_read_b64_tr_b16 a[164:165], v32 offset:8192
    v_mfma_f32_16x16x32_bf16 v[136:139], a[168:171], a[48:51], v[136:139]
    s_waitcnt lgkmcnt(9)
    buffer_load_dwordx4 v42, s[16:19], s49 offen lds
    v_mfma_f32_16x16x32_bf16 v[144:147], a[176:179], a[48:51], v[144:147]
    s_waitcnt lgkmcnt(7)
    ds_read_b64_tr_b16 a[166:167], v32 offset:12288
    ds_read_b64_tr_b16 a[168:169], v33 offset:0
    v_mfma_f32_16x16x32_bf16 v[144:147], a[180:183], a[56:59], v[144:147]
    ds_read_b64_tr_b16 a[170:171], v33 offset:4096
    v_mfma_f32_16x16x32_bf16 v[148:151], a[180:183], a[60:63], v[148:151]
    ds_read_b64_tr_b16 a[172:173], v33 offset:8192
    v_mfma_f32_16x16x32_bf16 v[148:151], a[176:179], a[52:55], v[148:151]
    s_waitcnt lgkmcnt(9)
    buffer_load_dwordx4 v43, s[16:19], s49 offen offset:1024 lds
    v_mfma_f32_16x16x32_bf16 v[156:159], a[184:187], a[52:55], v[156:159]
    s_waitcnt lgkmcnt(7)
    ds_read_b64_tr_b16 a[174:175], v33 offset:12288
    ds_read_b64_tr_b16 a[176:177], v34 offset:0
    v_mfma_f32_16x16x32_bf16 v[156:159], a[188:191], a[60:63], v[156:159]
    ds_read_b64_tr_b16 a[178:179], v34 offset:4096
    v_mfma_f32_16x16x32_bf16 v[152:155], a[188:191], a[56:59], v[152:155]
    ds_read_b64_tr_b16 a[180:181], v34 offset:8192
    v_mfma_f32_16x16x32_bf16 v[152:155], a[184:187], a[48:51], v[152:155]
    s_waitcnt lgkmcnt(9)
    buffer_load_dwordx4 v44, s[16:19], s49 offen offset:2048 lds
    v_mfma_f32_16x16x32_bf16 v[160:163], a[160:163], a[48:51], v[160:163]
    s_waitcnt lgkmcnt(7)
    ds_read_b64_tr_b16 a[182:183], v34 offset:12288
    ds_read_b64_tr_b16 a[184:185], v35 offset:0
    v_mfma_f32_16x16x32_bf16 v[160:163], a[164:167], a[56:59], v[160:163]
    ds_read_b64_tr_b16 a[186:187], v35 offset:4096
    v_mfma_f32_16x16x32_bf16 v[164:167], a[164:167], a[60:63], v[164:167]
    ds_read_b64_tr_b16 a[188:189], v35 offset:8192
    v_mfma_f32_16x16x32_bf16 v[164:167], a[160:163], a[52:55], v[164:167]
    s_waitcnt lgkmcnt(9)
    buffer_load_dwordx4 v45, s[16:19], s49 offen offset:3072 lds
    v_mfma_f32_16x16x32_bf16 v[172:175], a[168:171], a[52:55], v[172:175]
    s_waitcnt lgkmcnt(7)
    ds_read_b64_tr_b16 a[190:191], v35 offset:12288
    ds_read_b64_tr_b16 a[160:161], v28 offset:16384
    v_mfma_f32_16x16x32_bf16 v[172:175], a[172:175], a[60:63], v[172:175]
    ds_read_b64_tr_b16 a[162:163], v28 offset:20480
    v_mfma_f32_16x16x32_bf16 v[168:171], a[172:175], a[56:59], v[168:171]
    ds_read_b64_tr_b16 a[164:165], v28 offset:24576
    v_mfma_f32_16x16x32_bf16 v[168:171], a[168:171], a[48:51], v[168:171]
    s_waitcnt lgkmcnt(9)
    buffer_load_dwordx4 a[96:99], v51, s[24:27], s46 offen offset:1536 sc1
    v_mfma_f32_16x16x32_bf16 v[176:179], a[176:179], a[48:51], v[176:179]
    s_waitcnt lgkmcnt(7)
    ds_read_b64_tr_b16 a[166:167], v28 offset:28672
    ds_read_b64_tr_b16 a[168:169], v29 offset:16384
    v_mfma_f32_16x16x32_bf16 v[176:179], a[180:183], a[56:59], v[176:179]
    ds_read_b64_tr_b16 a[170:171], v29 offset:20480
    v_mfma_f32_16x16x32_bf16 v[180:183], a[180:183], a[60:63], v[180:183]
    ds_read_b64_tr_b16 a[172:173], v29 offset:24576
    v_mfma_f32_16x16x32_bf16 v[180:183], a[176:179], a[52:55], v[180:183]
    s_waitcnt lgkmcnt(9)
    buffer_load_dwordx4 a[104:107], v51, s[24:27], s46 offen offset:1664 sc1
    v_mfma_f32_16x16x32_bf16 v[188:191], a[184:187], a[52:55], v[188:191]
    s_waitcnt lgkmcnt(7)
    ds_read_b64_tr_b16 a[174:175], v29 offset:28672
    ds_read_b64_tr_b16 a[176:177], v30 offset:16384
    v_mfma_f32_16x16x32_bf16 v[188:191], a[188:191], a[60:63], v[188:191]
    ds_read_b64_tr_b16 a[178:179], v30 offset:20480
    v_mfma_f32_16x16x32_bf16 v[184:187], a[188:191], a[56:59], v[184:187]
    ds_read_b64_tr_b16 a[180:181], v30 offset:24576
    v_mfma_f32_16x16x32_bf16 v[184:187], a[184:187], a[48:51], v[184:187]
    s_waitcnt lgkmcnt(9)
    buffer_load_dwordx4 a[100:103], v51, s[24:27], s43 offen offset:1536 sc1
    v_mfma_f32_16x16x32_bf16 v[192:195], a[160:163], a[48:51], v[192:195]
    s_waitcnt lgkmcnt(7)
    ds_read_b64_tr_b16 a[182:183], v30 offset:28672
    ds_read_b64_tr_b16 a[184:185], v31 offset:16384
    v_mfma_f32_16x16x32_bf16 v[192:195], a[164:167], a[56:59], v[192:195]
    ds_read_b64_tr_b16 a[186:187], v31 offset:20480
    v_mfma_f32_16x16x32_bf16 v[196:199], a[164:167], a[60:63], v[196:199]
    ds_read_b64_tr_b16 a[188:189], v31 offset:24576
    v_mfma_f32_16x16x32_bf16 v[196:199], a[160:163], a[52:55], v[196:199]
    s_waitcnt lgkmcnt(9)
    buffer_load_dwordx4 a[108:111], v51, s[24:27], s43 offen offset:1664 sc1
    v_mfma_f32_16x16x32_bf16 v[204:207], a[168:171], a[52:55], v[204:207]
    s_waitcnt lgkmcnt(7)
    ds_read_b64_tr_b16 a[190:191], v31 offset:28672
    ds_read_b64_tr_b16 a[160:161], v32 offset:16384
    v_mfma_f32_16x16x32_bf16 v[204:207], a[172:175], a[60:63], v[204:207]
    ds_read_b64_tr_b16 a[162:163], v32 offset:20480
    v_mfma_f32_16x16x32_bf16 v[200:203], a[172:175], a[56:59], v[200:203]
    ds_read_b64_tr_b16 a[164:165], v32 offset:24576
    v_mfma_f32_16x16x32_bf16 v[200:203], a[168:171], a[48:51], v[200:203]
    s_waitcnt lgkmcnt(9)
    ds_read_b64_tr_b16 a[166:167], v32 offset:28672
    v_mfma_f32_16x16x32_bf16 v[208:211], a[176:179], a[48:51], v[208:211]
    s_waitcnt lgkmcnt(8)
    ds_read_b64_tr_b16 a[168:169], v33 offset:16384
    v_mfma_f32_16x16x32_bf16 v[208:211], a[180:183], a[56:59], v[208:211]
    ds_read_b64_tr_b16 a[170:171], v33 offset:20480
    v_mfma_f32_16x16x32_bf16 v[212:215], a[180:183], a[60:63], v[212:215]
    ds_read_b64_tr_b16 a[172:173], v33 offset:24576
    v_mfma_f32_16x16x32_bf16 v[212:215], a[176:179], a[52:55], v[212:215]
    s_waitcnt lgkmcnt(9)
    ds_read_b64_tr_b16 a[174:175], v33 offset:28672
    v_mfma_f32_16x16x32_bf16 v[220:223], a[184:187], a[52:55], v[220:223]
    s_waitcnt lgkmcnt(8)
    ds_read_b64_tr_b16 a[176:177], v34 offset:16384
    v_mfma_f32_16x16x32_bf16 v[220:223], a[188:191], a[60:63], v[220:223]
    ds_read_b64_tr_b16 a[178:179], v34 offset:20480
    v_mfma_f32_16x16x32_bf16 v[216:219], a[188:191], a[56:59], v[216:219]
    ds_read_b64_tr_b16 a[180:181], v34 offset:24576
    v_mfma_f32_16x16x32_bf16 v[216:219], a[184:187], a[48:51], v[216:219]
    s_waitcnt lgkmcnt(9)
    ds_read_b64_tr_b16 a[182:183], v34 offset:28672
    v_mfma_f32_16x16x32_bf16 v[224:227], a[160:163], a[48:51], v[224:227]
    s_waitcnt lgkmcnt(8)
    ds_read_b64_tr_b16 a[184:185], v35 offset:16384
    v_mfma_f32_16x16x32_bf16 v[224:227], a[164:167], a[56:59], v[224:227]
    ds_read_b64_tr_b16 a[186:187], v35 offset:20480
    v_mfma_f32_16x16x32_bf16 v[228:231], a[164:167], a[60:63], v[228:231]
    ds_read_b64_tr_b16 a[188:189], v35 offset:24576
    v_mfma_f32_16x16x32_bf16 v[228:231], a[160:163], a[52:55], v[228:231]
    s_waitcnt lgkmcnt(9)
    ds_read_b64_tr_b16 a[190:191], v35 offset:28672
    s_waitcnt vmcnt(16)
    s_barrier
    v_mfma_f32_16x16x32_bf16 v[236:239], a[168:171], a[52:55], v[236:239]
    s_waitcnt lgkmcnt(8)
    ds_read_b64_tr_b16 a[160:161], v12 offset:0
    v_mfma_f32_16x16x32_bf16 v[236:239], a[172:175], a[60:63], v[236:239]
    s_add_u32 s49, s44, 3670016
    ds_read_b64_tr_b16 a[162:163], v12 offset:4096
    v_mfma_f32_16x16x32_bf16 v[232:235], a[172:175], a[56:59], v[232:235]
    s_add_u32 m0, s42, 65536
    ds_read_b64_tr_b16 a[164:165], v12 offset:8192
    v_mfma_f32_16x16x32_bf16 v[232:235], a[168:171], a[48:51], v[232:235]
    s_waitcnt lgkmcnt(9)
    buffer_load_dwordx4 v42, s[16:19], s49 offen lds
    v_mfma_f32_16x16x32_bf16 v[240:243], a[176:179], a[48:51], v[240:243]
    s_waitcnt lgkmcnt(7)
    ds_read_b64_tr_b16 a[166:167], v12 offset:12288
    ds_read_b64_tr_b16 a[168:169], v13 offset:0
    v_mfma_f32_16x16x32_bf16 v[240:243], a[180:183], a[56:59], v[240:243]
Ltour0_1:
    s_cbranch_execz Ltour0_5
    ds_read_b64_tr_b16 a[170:171], v13 offset:4096
    v_mfma_f32_16x16x32_bf16 v[244:247], a[180:183], a[60:63], v[244:247]
    ds_read_b64_tr_b16 a[172:173], v13 offset:8192
    v_mfma_f32_16x16x32_bf16 v[244:247], a[176:179], a[52:55], v[244:247]
    s_waitcnt lgkmcnt(9)
    buffer_load_dwordx4 v43, s[16:19], s49 offen offset:1024 lds
    v_mfma_f32_16x16x32_bf16 v[252:255], a[184:187], a[52:55], v[252:255]
    s_waitcnt lgkmcnt(7)
    ds_read_b64_tr_b16 a[174:175], v13 offset:12288
    ds_read_b64_tr_b16 a[176:177], v14 offset:0
    v_mfma_f32_16x16x32_bf16 v[252:255], a[188:191], a[60:63], v[252:255]
    ds_read_b64_tr_b16 a[178:179], v14 offset:4096
    v_mfma_f32_16x16x32_bf16 v[248:251], a[188:191], a[56:59], v[248:251]
    ds_read_b64_tr_b16 a[180:181], v14 offset:8192
    v_mfma_f32_16x16x32_bf16 v[248:251], a[184:187], a[48:51], v[248:251]
    s_waitcnt lgkmcnt(9)
    buffer_load_dwordx4 v44, s[16:19], s49 offen offset:2048 lds
    v_mfma_f32_16x16x32_bf16 v[128:131], a[160:163], a[64:67], v[128:131]
    s_waitcnt lgkmcnt(7)
    ds_read_b64_tr_b16 a[182:183], v14 offset:12288
    ds_read_b64_tr_b16 a[184:185], v15 offset:0
    v_mfma_f32_16x16x32_bf16 v[128:131], a[164:167], a[72:75], v[128:131]
    ds_read_b64_tr_b16 a[186:187], v15 offset:4096
    v_mfma_f32_16x16x32_bf16 v[132:135], a[164:167], a[76:79], v[132:135]
    ds_read_b64_tr_b16 a[188:189], v15 offset:8192
    v_mfma_f32_16x16x32_bf16 v[132:135], a[160:163], a[68:71], v[132:135]
    s_waitcnt lgkmcnt(9)
    buffer_load_dwordx4 v45, s[16:19], s49 offen offset:3072 lds
    v_mfma_f32_16x16x32_bf16 v[140:143], a[168:171], a[68:71], v[140:143]
    s_waitcnt lgkmcnt(7)
    ds_read_b64_tr_b16 a[190:191], v15 offset:12288
    ds_read_b64_tr_b16 a[160:161], v16 offset:0
    v_mfma_f32_16x16x32_bf16 v[140:143], a[172:175], a[76:79], v[140:143]
    s_add_u32 s49, s44, 4194304
    ds_read_b64_tr_b16 a[162:163], v16 offset:4096
    v_mfma_f32_16x16x32_bf16 v[136:139], a[172:175], a[72:75], v[136:139]
    s_add_u32 m0, s42, 81920
    ds_read_b64_tr_b16 a[164:165], v16 offset:8192
    v_mfma_f32_16x16x32_bf16 v[136:139], a[168:171], a[64:67], v[136:139]
    s_waitcnt lgkmcnt(9)
    buffer_load_dwordx4 v42, s[16:19], s49 offen lds
    v_mfma_f32_16x16x32_bf16 v[144:147], a[176:179], a[64:67], v[144:147]
    s_waitcnt lgkmcnt(7)
    ds_read_b64_tr_b16 a[166:167], v16 offset:12288
    ds_read_b64_tr_b16 a[168:169], v17 offset:0
    v_mfma_f32_16x16x32_bf16 v[144:147], a[180:183], a[72:75], v[144:147]
    ds_read_b64_tr_b16 a[170:171], v17 offset:4096
    v_mfma_f32_16x16x32_bf16 v[148:151], a[180:183], a[76:79], v[148:151]
    ds_read_b64_tr_b16 a[172:173], v17 offset:8192
    v_mfma_f32_16x16x32_bf16 v[148:151], a[176:179], a[68:71], v[148:151]
    s_waitcnt lgkmcnt(9)
    buffer_load_dwordx4 v43, s[16:19], s49 offen offset:1024 lds
    v_mfma_f32_16x16x32_bf16 v[156:159], a[184:187], a[68:71], v[156:159]
    s_waitcnt lgkmcnt(7)
    ds_read_b64_tr_b16 a[174:175], v17 offset:12288
    ds_read_b64_tr_b16 a[176:177], v18 offset:0
    v_mfma_f32_16x16x32_bf16 v[156:159], a[188:191], a[76:79], v[156:159]
    ds_read_b64_tr_b16 a[178:179], v18 offset:4096
    v_mfma_f32_16x16x32_bf16 v[152:155], a[188:191], a[72:75], v[152:155]
    ds_read_b64_tr_b16 a[180:181], v18 offset:8192
    v_mfma_f32_16x16x32_bf16 v[152:155], a[184:187], a[64:67], v[152:155]
    s_waitcnt lgkmcnt(9)
    buffer_load_dwordx4 v44, s[16:19], s49 offen offset:2048 lds
    v_mfma_f32_16x16x32_bf16 v[160:163], a[160:163], a[64:67], v[160:163]
    s_waitcnt lgkmcnt(7)
    ds_read_b64_tr_b16 a[182:183], v18 offset:12288
    ds_read_b64_tr_b16 a[184:185], v19 offset:0
    v_mfma_f32_16x16x32_bf16 v[160:163], a[164:167], a[72:75], v[160:163]
    ds_read_b64_tr_b16 a[186:187], v19 offset:4096
    v_mfma_f32_16x16x32_bf16 v[164:167], a[164:167], a[76:79], v[164:167]
    ds_read_b64_tr_b16 a[188:189], v19 offset:8192
    v_mfma_f32_16x16x32_bf16 v[164:167], a[160:163], a[68:71], v[164:167]
    s_waitcnt lgkmcnt(9)
    buffer_load_dwordx4 v45, s[16:19], s49 offen offset:3072 lds
    v_mfma_f32_16x16x32_bf16 v[172:175], a[168:171], a[68:71], v[172:175]
    s_waitcnt lgkmcnt(7)
    ds_read_b64_tr_b16 a[190:191], v19 offset:12288
    ds_read_b64_tr_b16 a[160:161], v12 offset:16384
    v_mfma_f32_16x16x32_bf16 v[172:175], a[172:175], a[76:79], v[172:175]
    ds_read_b64_tr_b16 a[162:163], v12 offset:20480
    v_mfma_f32_16x16x32_bf16 v[168:171], a[172:175], a[72:75], v[168:171]
    ds_read_b64_tr_b16 a[164:165], v12 offset:24576
    v_mfma_f32_16x16x32_bf16 v[168:171], a[168:171], a[64:67], v[168:171]
    s_waitcnt lgkmcnt(9)
    buffer_load_dwordx4 a[112:115], v51, s[24:27], s46 offen offset:1792 sc1
    v_mfma_f32_16x16x32_bf16 v[176:179], a[176:179], a[64:67], v[176:179]
    s_waitcnt lgkmcnt(7)
    ds_read_b64_tr_b16 a[166:167], v12 offset:28672
    ds_read_b64_tr_b16 a[168:169], v13 offset:16384
    v_mfma_f32_16x16x32_bf16 v[176:179], a[180:183], a[72:75], v[176:179]
    ds_read_b64_tr_b16 a[170:171], v13 offset:20480
    v_mfma_f32_16x16x32_bf16 v[180:183], a[180:183], a[76:79], v[180:183]
    ds_read_b64_tr_b16 a[172:173], v13 offset:24576
    v_mfma_f32_16x16x32_bf16 v[180:183], a[176:179], a[68:71], v[180:183]
    s_waitcnt lgkmcnt(9)
    buffer_load_dwordx4 a[120:123], v51, s[24:27], s46 offen offset:1920 sc1
    v_mfma_f32_16x16x32_bf16 v[188:191], a[184:187], a[68:71], v[188:191]
    s_waitcnt lgkmcnt(7)
    ds_read_b64_tr_b16 a[174:175], v13 offset:28672
    ds_read_b64_tr_b16 a[176:177], v14 offset:16384
    v_mfma_f32_16x16x32_bf16 v[188:191], a[188:191], a[76:79], v[188:191]
    ds_read_b64_tr_b16 a[178:179], v14 offset:20480
    v_mfma_f32_16x16x32_bf16 v[184:187], a[188:191], a[72:75], v[184:187]
    ds_read_b64_tr_b16 a[180:181], v14 offset:24576
    v_mfma_f32_16x16x32_bf16 v[184:187], a[184:187], a[64:67], v[184:187]
    s_waitcnt lgkmcnt(9)
    buffer_load_dwordx4 a[116:119], v51, s[24:27], s43 offen offset:1792 sc1
    v_mfma_f32_16x16x32_bf16 v[192:195], a[160:163], a[64:67], v[192:195]
    s_waitcnt lgkmcnt(7)
    ds_read_b64_tr_b16 a[182:183], v14 offset:28672
    ds_read_b64_tr_b16 a[184:185], v15 offset:16384
    v_mfma_f32_16x16x32_bf16 v[192:195], a[164:167], a[72:75], v[192:195]
    ds_read_b64_tr_b16 a[186:187], v15 offset:20480
    v_mfma_f32_16x16x32_bf16 v[196:199], a[164:167], a[76:79], v[196:199]
    ds_read_b64_tr_b16 a[188:189], v15 offset:24576
    v_mfma_f32_16x16x32_bf16 v[196:199], a[160:163], a[68:71], v[196:199]
    s_waitcnt lgkmcnt(9)
    buffer_load_dwordx4 a[124:127], v51, s[24:27], s43 offen offset:1920 sc1
    v_mfma_f32_16x16x32_bf16 v[204:207], a[168:171], a[68:71], v[204:207]
    s_waitcnt lgkmcnt(7)
    ds_read_b64_tr_b16 a[190:191], v15 offset:28672
    ds_read_b64_tr_b16 a[160:161], v16 offset:16384
    v_mfma_f32_16x16x32_bf16 v[204:207], a[172:175], a[76:79], v[204:207]
    ds_read_b64_tr_b16 a[162:163], v16 offset:20480
    v_mfma_f32_16x16x32_bf16 v[200:203], a[172:175], a[72:75], v[200:203]
    ds_read_b64_tr_b16 a[164:165], v16 offset:24576
    v_mfma_f32_16x16x32_bf16 v[200:203], a[168:171], a[64:67], v[200:203]
    s_waitcnt lgkmcnt(9)
    ds_read_b64_tr_b16 a[166:167], v16 offset:28672
    v_mfma_f32_16x16x32_bf16 v[208:211], a[176:179], a[64:67], v[208:211]
    s_waitcnt lgkmcnt(8)
    ds_read_b64_tr_b16 a[168:169], v17 offset:16384
    v_mfma_f32_16x16x32_bf16 v[208:211], a[180:183], a[72:75], v[208:211]
    ds_read_b64_tr_b16 a[170:171], v17 offset:20480
    v_mfma_f32_16x16x32_bf16 v[212:215], a[180:183], a[76:79], v[212:215]
    ds_read_b64_tr_b16 a[172:173], v17 offset:24576
    v_mfma_f32_16x16x32_bf16 v[212:215], a[176:179], a[68:71], v[212:215]
    s_waitcnt lgkmcnt(9)
    ds_read_b64_tr_b16 a[174:175], v17 offset:28672
    v_mfma_f32_16x16x32_bf16 v[220:223], a[184:187], a[68:71], v[220:223]
    s_waitcnt lgkmcnt(8)
    ds_read_b64_tr_b16 a[176:177], v18 offset:16384
    v_mfma_f32_16x16x32_bf16 v[220:223], a[188:191], a[76:79], v[220:223]
    ds_read_b64_tr_b16 a[178:179], v18 offset:20480
    v_mfma_f32_16x16x32_bf16 v[216:219], a[188:191], a[72:75], v[216:219]
    ds_read_b64_tr_b16 a[180:181], v18 offset:24576
    v_mfma_f32_16x16x32_bf16 v[216:219], a[184:187], a[64:67], v[216:219]
    s_waitcnt lgkmcnt(9)
    ds_read_b64_tr_b16 a[182:183], v18 offset:28672
    v_mfma_f32_16x16x32_bf16 v[224:227], a[160:163], a[64:67], v[224:227]
    s_waitcnt lgkmcnt(8)
    ds_read_b64_tr_b16 a[184:185], v19 offset:16384
    v_mfma_f32_16x16x32_bf16 v[224:227], a[164:167], a[72:75], v[224:227]
    ds_read_b64_tr_b16 a[186:187], v19 offset:20480
    v_mfma_f32_16x16x32_bf16 v[228:231], a[164:167], a[76:79], v[228:231]
    ds_read_b64_tr_b16 a[188:189], v19 offset:24576
    v_mfma_f32_16x16x32_bf16 v[228:231], a[160:163], a[68:71], v[228:231]
    s_waitcnt lgkmcnt(9)
    ds_read_b64_tr_b16 a[190:191], v19 offset:28672
    s_waitcnt vmcnt(16)
    s_barrier
    v_mfma_f32_16x16x32_bf16 v[236:239], a[168:171], a[68:71], v[236:239]
    s_waitcnt lgkmcnt(8)
    ds_read_b64_tr_b16 a[160:161], v12 offset:32768
    v_mfma_f32_16x16x32_bf16 v[236:239], a[172:175], a[76:79], v[236:239]
    s_add_u32 s49, s44, 2621696
    ds_read_b64_tr_b16 a[162:163], v12 offset:36864
    v_mfma_f32_16x16x32_bf16 v[232:235], a[172:175], a[72:75], v[232:235]
    s_add_u32 m0, s42, 98304
    ds_read_b64_tr_b16 a[164:165], v12 offset:40960
    v_mfma_f32_16x16x32_bf16 v[232:235], a[168:171], a[64:67], v[232:235]
    s_waitcnt lgkmcnt(9)
    buffer_load_dwordx4 v42, s[16:19], s49 offen lds
    v_mfma_f32_16x16x32_bf16 v[240:243], a[176:179], a[64:67], v[240:243]
    s_waitcnt lgkmcnt(7)
    ds_read_b64_tr_b16 a[166:167], v12 offset:45056
    ds_read_b64_tr_b16 a[168:169], v13 offset:32768
    v_mfma_f32_16x16x32_bf16 v[240:243], a[180:183], a[72:75], v[240:243]
    ds_read_b64_tr_b16 a[170:171], v13 offset:36864
    v_mfma_f32_16x16x32_bf16 v[244:247], a[180:183], a[76:79], v[244:247]
    ds_read_b64_tr_b16 a[172:173], v13 offset:40960
    v_mfma_f32_16x16x32_bf16 v[244:247], a[176:179], a[68:71], v[244:247]
    s_waitcnt lgkmcnt(9)
    buffer_load_dwordx4 v43, s[16:19], s49 offen offset:1024 lds
    v_mfma_f32_16x16x32_bf16 v[252:255], a[184:187], a[68:71], v[252:255]
    s_waitcnt lgkmcnt(7)
    ds_read_b64_tr_b16 a[174:175], v13 offset:45056
    ds_read_b64_tr_b16 a[176:177], v14 offset:32768
    v_mfma_f32_16x16x32_bf16 v[252:255], a[188:191], a[76:79], v[252:255]
    ds_read_b64_tr_b16 a[178:179], v14 offset:36864
    v_mfma_f32_16x16x32_bf16 v[248:251], a[188:191], a[72:75], v[248:251]
    ds_read_b64_tr_b16 a[180:181], v14 offset:40960
    v_mfma_f32_16x16x32_bf16 v[248:251], a[184:187], a[64:67], v[248:251]
    s_waitcnt lgkmcnt(9)
    buffer_load_dwordx4 v44, s[16:19], s49 offen offset:2048 lds
    v_mfma_f32_16x16x32_bf16 v[128:131], a[160:163], a[80:83], v[128:131]
    s_waitcnt lgkmcnt(7)
    ds_read_b64_tr_b16 a[182:183], v14 offset:45056
    ds_read_b64_tr_b16 a[184:185], v15 offset:32768
    v_mfma_f32_16x16x32_bf16 v[128:131], a[164:167], a[88:91], v[128:131]
    ds_read_b64_tr_b16 a[186:187], v15 offset:36864
    v_mfma_f32_16x16x32_bf16 v[132:135], a[164:167], a[92:95], v[132:135]
    ds_read_b64_tr_b16 a[188:189], v15 offset:40960
    v_mfma_f32_16x16x32_bf16 v[132:135], a[160:163], a[84:87], v[132:135]
    s_waitcnt lgkmcnt(9)
    buffer_load_dwordx4 v45, s[16:19], s49 offen offset:3072 lds
    v_mfma_f32_16x16x32_bf16 v[140:143], a[168:171], a[84:87], v[140:143]
    s_waitcnt lgkmcnt(7)
    ds_read_b64_tr_b16 a[190:191], v15 offset:45056
    ds_read_b64_tr_b16 a[160:161], v16 offset:32768
    v_mfma_f32_16x16x32_bf16 v[140:143], a[172:175], a[92:95], v[140:143]
    s_add_u32 s49, s44, 3145984
    ds_read_b64_tr_b16 a[162:163], v16 offset:36864
    v_mfma_f32_16x16x32_bf16 v[136:139], a[172:175], a[88:91], v[136:139]
    s_add_u32 m0, s42, 114688
    ds_read_b64_tr_b16 a[164:165], v16 offset:40960
    v_mfma_f32_16x16x32_bf16 v[136:139], a[168:171], a[80:83], v[136:139]
    s_waitcnt lgkmcnt(9)
    buffer_load_dwordx4 v42, s[16:19], s49 offen lds
    v_mfma_f32_16x16x32_bf16 v[144:147], a[176:179], a[80:83], v[144:147]
    s_waitcnt lgkmcnt(7)
    ds_read_b64_tr_b16 a[166:167], v16 offset:45056
    ds_read_b64_tr_b16 a[168:169], v17 offset:32768
    v_mfma_f32_16x16x32_bf16 v[144:147], a[180:183], a[88:91], v[144:147]
    ds_read_b64_tr_b16 a[170:171], v17 offset:36864
    v_mfma_f32_16x16x32_bf16 v[148:151], a[180:183], a[92:95], v[148:151]
    ds_read_b64_tr_b16 a[172:173], v17 offset:40960
    v_mfma_f32_16x16x32_bf16 v[148:151], a[176:179], a[84:87], v[148:151]
    s_waitcnt lgkmcnt(9)
    buffer_load_dwordx4 v43, s[16:19], s49 offen offset:1024 lds
    v_mfma_f32_16x16x32_bf16 v[156:159], a[184:187], a[84:87], v[156:159]
    s_waitcnt lgkmcnt(7)
    ds_read_b64_tr_b16 a[174:175], v17 offset:45056
    ds_read_b64_tr_b16 a[176:177], v18 offset:32768
    v_mfma_f32_16x16x32_bf16 v[156:159], a[188:191], a[92:95], v[156:159]
    ds_read_b64_tr_b16 a[178:179], v18 offset:36864
    v_mfma_f32_16x16x32_bf16 v[152:155], a[188:191], a[88:91], v[152:155]
    ds_read_b64_tr_b16 a[180:181], v18 offset:40960
    v_mfma_f32_16x16x32_bf16 v[152:155], a[184:187], a[80:83], v[152:155]
    s_waitcnt lgkmcnt(9)
    buffer_load_dwordx4 v44, s[16:19], s49 offen offset:2048 lds
    v_mfma_f32_16x16x32_bf16 v[160:163], a[160:163], a[80:83], v[160:163]
    s_waitcnt lgkmcnt(7)
    ds_read_b64_tr_b16 a[182:183], v18 offset:45056
    ds_read_b64_tr_b16 a[184:185], v19 offset:32768
    v_mfma_f32_16x16x32_bf16 v[160:163], a[164:167], a[88:91], v[160:163]
    ds_read_b64_tr_b16 a[186:187], v19 offset:36864
    v_mfma_f32_16x16x32_bf16 v[164:167], a[164:167], a[92:95], v[164:167]
    ds_read_b64_tr_b16 a[188:189], v19 offset:40960
    v_mfma_f32_16x16x32_bf16 v[164:167], a[160:163], a[84:87], v[164:167]
    s_waitcnt lgkmcnt(9)
    buffer_load_dwordx4 v45, s[16:19], s49 offen offset:3072 lds
    v_mfma_f32_16x16x32_bf16 v[172:175], a[168:171], a[84:87], v[172:175]
    s_waitcnt lgkmcnt(7)
    ds_read_b64_tr_b16 a[190:191], v19 offset:45056
    ds_read_b64_tr_b16 a[160:161], v12 offset:49152
    v_mfma_f32_16x16x32_bf16 v[172:175], a[172:175], a[92:95], v[172:175]
    ds_read_b64_tr_b16 a[162:163], v12 offset:53248
    v_mfma_f32_16x16x32_bf16 v[168:171], a[172:175], a[88:91], v[168:171]
    ds_read_b64_tr_b16 a[164:165], v12 offset:57344
    v_mfma_f32_16x16x32_bf16 v[168:171], a[168:171], a[80:83], v[168:171]
    s_waitcnt lgkmcnt(9)
    buffer_load_dwordx4 a[128:131], v51, s[24:27], s46 offen offset:2048 sc1
    v_mfma_f32_16x16x32_bf16 v[176:179], a[176:179], a[80:83], v[176:179]
    s_waitcnt lgkmcnt(7)
    ds_read_b64_tr_b16 a[166:167], v12 offset:61440
    ds_read_b64_tr_b16 a[168:169], v13 offset:49152
    v_mfma_f32_16x16x32_bf16 v[176:179], a[180:183], a[88:91], v[176:179]
    ds_read_b64_tr_b16 a[170:171], v13 offset:53248
    v_mfma_f32_16x16x32_bf16 v[180:183], a[180:183], a[92:95], v[180:183]
    ds_read_b64_tr_b16 a[172:173], v13 offset:57344
    v_mfma_f32_16x16x32_bf16 v[180:183], a[176:179], a[84:87], v[180:183]
    s_waitcnt lgkmcnt(9)
    buffer_load_dwordx4 a[136:139], v51, s[24:27], s46 offen offset:2176 sc1
    v_mfma_f32_16x16x32_bf16 v[188:191], a[184:187], a[84:87], v[188:191]
    s_waitcnt lgkmcnt(7)
    ds_read_b64_tr_b16 a[174:175], v13 offset:61440
    ds_read_b64_tr_b16 a[176:177], v14 offset:49152
    v_mfma_f32_16x16x32_bf16 v[188:191], a[188:191], a[92:95], v[188:191]
    ds_read_b64_tr_b16 a[178:179], v14 offset:53248
    v_mfma_f32_16x16x32_bf16 v[184:187], a[188:191], a[88:91], v[184:187]
    ds_read_b64_tr_b16 a[180:181], v14 offset:57344
    v_mfma_f32_16x16x32_bf16 v[184:187], a[184:187], a[80:83], v[184:187]
    s_waitcnt vmcnt(25)
    s_waitcnt lgkmcnt(9)
    buffer_load_dwordx4 a[132:135], v51, s[24:27], s43 offen offset:2048 sc1
    v_mfma_f32_16x16x32_bf16 v[128:131], a[160:163], a[96:99], v[128:131]
    s_waitcnt vmcnt(25)
    s_waitcnt lgkmcnt(7)
    ds_read_b64_tr_b16 a[182:183], v14 offset:61440
    ds_read_b64_tr_b16 a[184:185], v15 offset:49152
    v_mfma_f32_16x16x32_bf16 v[128:131], a[164:167], a[104:107], v[128:131]
    s_waitcnt vmcnt(23)
    ds_read_b64_tr_b16 a[186:187], v15 offset:53248
    v_mfma_f32_16x16x32_bf16 v[132:135], a[164:167], a[108:111], v[132:135]
    ds_read_b64_tr_b16 a[188:189], v15 offset:57344
    v_mfma_f32_16x16x32_bf16 v[132:135], a[160:163], a[100:103], v[132:135]
    s_waitcnt lgkmcnt(9)
    buffer_load_dwordx4 a[140:143], v51, s[24:27], s43 offen offset:2176 sc1
    v_mfma_f32_16x16x32_bf16 v[140:143], a[168:171], a[100:103], v[140:143]
    s_waitcnt lgkmcnt(7)
    ds_read_b64_tr_b16 a[190:191], v15 offset:61440
    ds_read_b64_tr_b16 a[160:161], v16 offset:49152
    v_mfma_f32_16x16x32_bf16 v[140:143], a[172:175], a[108:111], v[140:143]
    ds_read_b64_tr_b16 a[162:163], v16 offset:53248
    v_mfma_f32_16x16x32_bf16 v[136:139], a[172:175], a[104:107], v[136:139]
    ds_read_b64_tr_b16 a[164:165], v16 offset:57344
    v_mfma_f32_16x16x32_bf16 v[136:139], a[168:171], a[96:99], v[136:139]
    s_waitcnt lgkmcnt(9)
    ds_read_b64_tr_b16 a[166:167], v16 offset:61440
    v_mfma_f32_16x16x32_bf16 v[144:147], a[176:179], a[96:99], v[144:147]
    s_waitcnt lgkmcnt(8)
    ds_read_b64_tr_b16 a[168:169], v17 offset:49152
    v_mfma_f32_16x16x32_bf16 v[144:147], a[180:183], a[104:107], v[144:147]
    ds_read_b64_tr_b16 a[170:171], v17 offset:53248
    v_mfma_f32_16x16x32_bf16 v[148:151], a[180:183], a[108:111], v[148:151]
    ds_read_b64_tr_b16 a[172:173], v17 offset:57344
    v_mfma_f32_16x16x32_bf16 v[148:151], a[176:179], a[100:103], v[148:151]
    s_waitcnt lgkmcnt(9)
    ds_read_b64_tr_b16 a[174:175], v17 offset:61440
    v_mfma_f32_16x16x32_bf16 v[156:159], a[184:187], a[100:103], v[156:159]
    s_waitcnt lgkmcnt(8)
    ds_read_b64_tr_b16 a[176:177], v18 offset:49152
    v_mfma_f32_16x16x32_bf16 v[156:159], a[188:191], a[108:111], v[156:159]
    ds_read_b64_tr_b16 a[178:179], v18 offset:53248
    v_mfma_f32_16x16x32_bf16 v[152:155], a[188:191], a[104:107], v[152:155]
    ds_read_b64_tr_b16 a[180:181], v18 offset:57344
    v_mfma_f32_16x16x32_bf16 v[152:155], a[184:187], a[96:99], v[152:155]
    s_waitcnt lgkmcnt(9)
    ds_read_b64_tr_b16 a[182:183], v18 offset:61440
    v_mfma_f32_16x16x32_bf16 v[160:163], a[160:163], a[96:99], v[160:163]
    s_waitcnt lgkmcnt(8)
    ds_read_b64_tr_b16 a[184:185], v19 offset:49152
    v_mfma_f32_16x16x32_bf16 v[160:163], a[164:167], a[104:107], v[160:163]
    ds_read_b64_tr_b16 a[186:187], v19 offset:53248
    v_mfma_f32_16x16x32_bf16 v[164:167], a[164:167], a[108:111], v[164:167]
    ds_read_b64_tr_b16 a[188:189], v19 offset:57344
    v_mfma_f32_16x16x32_bf16 v[164:167], a[160:163], a[100:103], v[164:167]
    s_waitcnt lgkmcnt(9)
    ds_read_b64_tr_b16 a[190:191], v19 offset:61440
    s_waitcnt vmcnt(16)
    s_barrier
    v_mfma_f32_16x16x32_bf16 v[172:175], a[168:171], a[100:103], v[172:175]
    s_waitcnt lgkmcnt(8)
    ds_read_b64_tr_b16 a[160:161], v20 offset:0
    v_mfma_f32_16x16x32_bf16 v[172:175], a[172:175], a[108:111], v[172:175]
    s_add_u32 s49, s44, 3670272
    ds_read_b64_tr_b16 a[162:163], v20 offset:4096
    v_mfma_f32_16x16x32_bf16 v[168:171], a[172:175], a[104:107], v[168:171]
    s_add_u32 m0, s42, 131072
    ds_read_b64_tr_b16 a[164:165], v20 offset:8192
    v_mfma_f32_16x16x32_bf16 v[168:171], a[168:171], a[96:99], v[168:171]
    s_waitcnt lgkmcnt(9)
    buffer_load_dwordx4 v42, s[16:19], s49 offen lds
    v_mfma_f32_16x16x32_bf16 v[176:179], a[176:179], a[96:99], v[176:179]
    s_waitcnt lgkmcnt(7)
    ds_read_b64_tr_b16 a[166:167], v20 offset:12288
    ds_read_b64_tr_b16 a[168:169], v21 offset:0
    v_mfma_f32_16x16x32_bf16 v[176:179], a[180:183], a[104:107], v[176:179]
    ds_read_b64_tr_b16 a[170:171], v21 offset:4096
    v_mfma_f32_16x16x32_bf16 v[180:183], a[180:183], a[108:111], v[180:183]
    ds_read_b64_tr_b16 a[172:173], v21 offset:8192
    v_mfma_f32_16x16x32_bf16 v[180:183], a[176:179], a[100:103], v[180:183]
    s_waitcnt lgkmcnt(9)
    buffer_load_dwordx4 v43, s[16:19], s49 offen offset:1024 lds
    v_mfma_f32_16x16x32_bf16 v[188:191], a[184:187], a[100:103], v[188:191]
    s_waitcnt lgkmcnt(7)
    ds_read_b64_tr_b16 a[174:175], v21 offset:12288
    ds_read_b64_tr_b16 a[176:177], v22 offset:0
    v_mfma_f32_16x16x32_bf16 v[188:191], a[188:191], a[108:111], v[188:191]
    ds_read_b64_tr_b16 a[178:179], v22 offset:4096
    v_mfma_f32_16x16x32_bf16 v[184:187], a[188:191], a[104:107], v[184:187]
    ds_read_b64_tr_b16 a[180:181], v22 offset:8192
    v_mfma_f32_16x16x32_bf16 v[184:187], a[184:187], a[96:99], v[184:187]
    s_waitcnt vmcnt(17)
    s_waitcnt lgkmcnt(9)
    buffer_load_dwordx4 v44, s[16:19], s49 offen offset:2048 lds
    v_mfma_f32_16x16x32_bf16 v[128:131], a[160:163], a[112:115], v[128:131]
    s_waitcnt vmcnt(17)
    s_waitcnt lgkmcnt(7)
    ds_read_b64_tr_b16 a[182:183], v22 offset:12288
    ds_read_b64_tr_b16 a[184:185], v23 offset:0
    v_mfma_f32_16x16x32_bf16 v[128:131], a[164:167], a[120:123], v[128:131]
    s_waitcnt vmcnt(15)
    ds_read_b64_tr_b16 a[186:187], v23 offset:4096
    v_mfma_f32_16x16x32_bf16 v[132:135], a[164:167], a[124:127], v[132:135]
    ds_read_b64_tr_b16 a[188:189], v23 offset:8192
    v_mfma_f32_16x16x32_bf16 v[132:135], a[160:163], a[116:119], v[132:135]
    s_waitcnt lgkmcnt(9)
    buffer_load_dwordx4 v45, s[16:19], s49 offen offset:3072 lds
    v_mfma_f32_16x16x32_bf16 v[140:143], a[168:171], a[116:119], v[140:143]
    s_waitcnt lgkmcnt(7)
    ds_read_b64_tr_b16 a[190:191], v23 offset:12288
    ds_read_b64_tr_b16 a[160:161], v24 offset:0
    v_mfma_f32_16x16x32_bf16 v[140:143], a[172:175], a[124:127], v[140:143]
    s_add_u32 s49, s44, 4194560
    ds_read_b64_tr_b16 a[162:163], v24 offset:4096
    v_mfma_f32_16x16x32_bf16 v[136:139], a[172:175], a[120:123], v[136:139]
    s_add_u32 m0, s42, 147456
    ds_read_b64_tr_b16 a[164:165], v24 offset:8192
    v_mfma_f32_16x16x32_bf16 v[136:139], a[168:171], a[112:115], v[136:139]
    s_waitcnt lgkmcnt(9)
    buffer_load_dwordx4 v42, s[16:19], s49 offen lds
    v_mfma_f32_16x16x32_bf16 v[144:147], a[176:179], a[112:115], v[144:147]
    s_waitcnt lgkmcnt(7)
    ds_read_b64_tr_b16 a[166:167], v24 offset:12288
    ds_read_b64_tr_b16 a[168:169], v25 offset:0
    v_mfma_f32_16x16x32_bf16 v[144:147], a[180:183], a[120:123], v[144:147]
    ds_read_b64_tr_b16 a[170:171], v25 offset:4096
    v_mfma_f32_16x16x32_bf16 v[148:151], a[180:183], a[124:127], v[148:151]
    ds_read_b64_tr_b16 a[172:173], v25 offset:8192
    v_mfma_f32_16x16x32_bf16 v[148:151], a[176:179], a[116:119], v[148:151]
    s_waitcnt lgkmcnt(9)
    buffer_load_dwordx4 v43, s[16:19], s49 offen offset:1024 lds
    v_mfma_f32_16x16x32_bf16 v[156:159], a[184:187], a[116:119], v[156:159]
    s_waitcnt lgkmcnt(7)
    ds_read_b64_tr_b16 a[174:175], v25 offset:12288
    ds_read_b64_tr_b16 a[176:177], v26 offset:0
    v_mfma_f32_16x16x32_bf16 v[156:159], a[188:191], a[124:127], v[156:159]
    ds_read_b64_tr_b16 a[178:179], v26 offset:4096
    v_mfma_f32_16x16x32_bf16 v[152:155], a[188:191], a[120:123], v[152:155]
    ds_read_b64_tr_b16 a[180:181], v26 offset:8192
    v_mfma_f32_16x16x32_bf16 v[152:155], a[184:187], a[112:115], v[152:155]
    s_waitcnt lgkmcnt(9)
    buffer_load_dwordx4 v44, s[16:19], s49 offen offset:2048 lds
    v_mfma_f32_16x16x32_bf16 v[160:163], a[160:163], a[112:115], v[160:163]
    s_waitcnt lgkmcnt(7)
    ds_read_b64_tr_b16 a[182:183], v26 offset:12288
    ds_read_b64_tr_b16 a[184:185], v27 offset:0
    v_mfma_f32_16x16x32_bf16 v[160:163], a[164:167], a[120:123], v[160:163]
    ds_read_b64_tr_b16 a[186:187], v27 offset:4096
    v_mfma_f32_16x16x32_bf16 v[164:167], a[164:167], a[124:127], v[164:167]
    ds_read_b64_tr_b16 a[188:189], v27 offset:8192
    v_mfma_f32_16x16x32_bf16 v[164:167], a[160:163], a[116:119], v[164:167]
    s_waitcnt lgkmcnt(9)
    buffer_load_dwordx4 v45, s[16:19], s49 offen offset:3072 lds
    v_mfma_f32_16x16x32_bf16 v[172:175], a[168:171], a[116:119], v[172:175]
    s_waitcnt lgkmcnt(7)
    ds_read_b64_tr_b16 a[190:191], v27 offset:12288
    ds_read_b64_tr_b16 a[160:161], v20 offset:16384
    v_mfma_f32_16x16x32_bf16 v[172:175], a[172:175], a[124:127], v[172:175]
    ds_read_b64_tr_b16 a[162:163], v20 offset:20480
    v_mfma_f32_16x16x32_bf16 v[168:171], a[172:175], a[120:123], v[168:171]
    ds_read_b64_tr_b16 a[164:165], v20 offset:24576
    v_mfma_f32_16x16x32_bf16 v[168:171], a[168:171], a[112:115], v[168:171]
    s_waitcnt lgkmcnt(9)
    buffer_load_dword v78, v120, s[8:11], 0 offen
    v_mfma_f32_16x16x32_bf16 v[176:179], a[176:179], a[112:115], v[176:179]
    s_waitcnt lgkmcnt(7)
    ds_read_b64_tr_b16 a[166:167], v20 offset:28672
    ds_read_b64_tr_b16 a[168:169], v21 offset:16384
    v_mfma_f32_16x16x32_bf16 v[176:179], a[180:183], a[120:123], v[176:179]
    ds_read_b64_tr_b16 a[170:171], v21 offset:20480
    v_mfma_f32_16x16x32_bf16 v[180:183], a[180:183], a[124:127], v[180:183]
    ds_read_b64_tr_b16 a[172:173], v21 offset:24576
    v_mfma_f32_16x16x32_bf16 v[180:183], a[176:179], a[116:119], v[180:183]
    s_waitcnt lgkmcnt(9)
    buffer_load_dword v79, v121, s[12:15], 0 offen
    v_mfma_f32_16x16x32_bf16 v[188:191], a[184:187], a[116:119], v[188:191]
    s_waitcnt lgkmcnt(7)
    ds_read_b64_tr_b16 a[174:175], v21 offset:28672
    ds_read_b64_tr_b16 a[176:177], v22 offset:16384
    v_mfma_f32_16x16x32_bf16 v[188:191], a[188:191], a[124:127], v[188:191]
    ds_read_b64_tr_b16 a[178:179], v22 offset:20480
    v_mfma_f32_16x16x32_bf16 v[184:187], a[188:191], a[120:123], v[184:187]
    s_mov_b32 s36, 1040356334
    ds_read_b64_tr_b16 a[180:181], v22 offset:24576
    v_mfma_f32_16x16x32_bf16 v[184:187], a[184:187], a[112:115], v[184:187]
    s_waitcnt vmcnt(13)
    s_waitcnt lgkmcnt(9)
    buffer_store_dword v76, v72, s[24:27], s92 offen offset:12 sc1
    v_mfma_f32_16x16x32_bf16 v[128:131], a[160:163], a[128:131], v[128:131]
    s_waitcnt vmcnt(13)
    s_waitcnt lgkmcnt(7)
    ds_read_b64_tr_b16 a[182:183], v22 offset:28672
    ds_read_b64_tr_b16 a[184:185], v23 offset:16384
    v_mfma_f32_16x16x32_bf16 v[128:131], a[164:167], a[136:139], v[128:131]
    s_waitcnt vmcnt(11)
    ds_read_b64_tr_b16 a[186:187], v23 offset:20480
    v_mfma_f32_16x16x32_bf16 v[132:135], a[164:167], a[140:143], v[132:135]
    ds_read_b64_tr_b16 a[188:189], v23 offset:24576
    v_mfma_f32_16x16x32_bf16 v[132:135], a[160:163], a[132:135], v[132:135]
    s_waitcnt lgkmcnt(9)
    buffer_store_dwordx4 v[88:91], v74, s[24:27], 0 offen sc1
    v_mfma_f32_16x16x32_bf16 v[140:143], a[168:171], a[132:135], v[140:143]
    s_waitcnt lgkmcnt(7)
    ds_read_b64_tr_b16 a[190:191], v23 offset:28672
    ds_read_b64_tr_b16 a[160:161], v24 offset:16384
    v_mfma_f32_16x16x32_bf16 v[140:143], a[172:175], a[140:143], v[140:143]
    ds_read_b64_tr_b16 a[162:163], v24 offset:20480
    v_mfma_f32_16x16x32_bf16 v[136:139], a[172:175], a[136:139], v[136:139]
    ds_read_b64_tr_b16 a[164:165], v24 offset:24576
    v_mfma_f32_16x16x32_bf16 v[136:139], a[168:171], a[128:131], v[136:139]
    s_waitcnt lgkmcnt(9)
    ds_read_b64_tr_b16 a[166:167], v24 offset:28672
    v_mfma_f32_16x16x32_bf16 v[144:147], a[176:179], a[128:131], v[144:147]
    s_waitcnt lgkmcnt(8)
    ds_read_b64_tr_b16 a[168:169], v25 offset:16384
    v_mfma_f32_16x16x32_bf16 v[144:147], a[180:183], a[136:139], v[144:147]
    ds_read_b64_tr_b16 a[170:171], v25 offset:20480
    v_mfma_f32_16x16x32_bf16 v[148:151], a[180:183], a[140:143], v[148:151]
    ds_read_b64_tr_b16 a[172:173], v25 offset:24576
    v_mfma_f32_16x16x32_bf16 v[148:151], a[176:179], a[132:135], v[148:151]
    s_waitcnt lgkmcnt(9)
    ds_read_b64_tr_b16 a[174:175], v25 offset:28672
    v_mul_f32 v128, s36, v128
    v_mfma_f32_16x16x32_bf16 v[156:159], a[184:187], a[132:135], v[156:159]
    s_waitcnt lgkmcnt(8)
    ds_read_b64_tr_b16 a[176:177], v26 offset:16384
    v_mul_f32 v129, s36, v129
    v_mfma_f32_16x16x32_bf16 v[156:159], a[188:191], a[140:143], v[156:159]
    ds_read_b64_tr_b16 a[178:179], v26 offset:20480
    v_mul_f32 v130, s36, v130
    v_mfma_f32_16x16x32_bf16 v[152:155], a[188:191], a[136:139], v[152:155]
    ds_read_b64_tr_b16 a[180:181], v26 offset:24576
    v_mul_f32 v131, s36, v131
    v_mfma_f32_16x16x32_bf16 v[152:155], a[184:187], a[128:131], v[152:155]
    s_waitcnt lgkmcnt(9)
    ds_read_b64_tr_b16 a[182:183], v26 offset:28672
    v_mul_f32 v136, s36, v136
    v_mfma_f32_16x16x32_bf16 v[160:163], a[160:163], a[128:131], v[160:163]
    s_waitcnt lgkmcnt(8)
    ds_read_b64_tr_b16 a[184:185], v27 offset:16384
    v_mul_f32 v137, s36, v137
    v_mfma_f32_16x16x32_bf16 v[160:163], a[164:167], a[136:139], v[160:163]
    ds_read_b64_tr_b16 a[186:187], v27 offset:20480
    v_mul_f32 v138, s36, v138
    v_mfma_f32_16x16x32_bf16 v[164:167], a[164:167], a[140:143], v[164:167]
    ds_read_b64_tr_b16 a[188:189], v27 offset:24576
    v_mul_f32 v139, s36, v139
    v_mfma_f32_16x16x32_bf16 v[164:167], a[160:163], a[132:135], v[164:167]
    s_waitcnt lgkmcnt(9)
    ds_read_b64_tr_b16 a[190:191], v27 offset:28672
    v_mul_f32 v132, s36, v132
    s_barrier
    v_mfma_f32_16x16x32_bf16 v[172:175], a[168:171], a[132:135], v[172:175]
    s_waitcnt lgkmcnt(8)
    ds_read_b64_tr_b16 a[160:161], v20 offset:32768
    v_mul_f32 v133, s36, v133
    v_mfma_f32_16x16x32_bf16 v[172:175], a[172:175], a[140:143], v[172:175]
    ds_read_b64_tr_b16 a[162:163], v20 offset:36864
    v_mul_f32 v134, s36, v134
    v_mfma_f32_16x16x32_bf16 v[168:171], a[172:175], a[136:139], v[168:171]
    s_add_u32 m0, s42, 0
    ds_read_b64_tr_b16 a[164:165], v20 offset:40960
    v_mul_f32 v135, s36, v135
    v_mfma_f32_16x16x32_bf16 v[168:171], a[168:171], a[128:131], v[168:171]
    s_waitcnt lgkmcnt(9)
    buffer_load_dwordx4 v36, s[8:11], s40 offen lds
    v_mfma_f32_16x16x32_bf16 v[176:179], a[176:179], a[128:131], v[176:179]
    s_waitcnt lgkmcnt(7)
    ds_read_b64_tr_b16 a[166:167], v20 offset:45056
    ds_read_b64_tr_b16 a[168:169], v21 offset:32768
    v_mfma_f32_16x16x32_bf16 v[176:179], a[180:183], a[136:139], v[176:179]
    ds_read_b64_tr_b16 a[170:171], v21 offset:36864
    v_mul_f32 v140, s36, v140
    v_mfma_f32_16x16x32_bf16 v[180:183], a[180:183], a[140:143], v[180:183]
    ds_read_b64_tr_b16 a[172:173], v21 offset:40960
    v_mul_f32 v141, s36, v141
    v_mfma_f32_16x16x32_bf16 v[180:183], a[176:179], a[132:135], v[180:183]
    s_waitcnt lgkmcnt(9)
    buffer_load_dwordx4 v37, s[8:11], s40 offen offset:1024 lds
    v_mfma_f32_16x16x32_bf16 v[188:191], a[184:187], a[132:135], v[188:191]
    s_waitcnt lgkmcnt(7)
    ds_read_b64_tr_b16 a[174:175], v21 offset:45056
    ds_read_b64_tr_b16 a[176:177], v22 offset:32768
    v_mfma_f32_16x16x32_bf16 v[188:191], a[188:191], a[140:143], v[188:191]
    ds_read_b64_tr_b16 a[178:179], v22 offset:36864
    v_mul_f32 v142, s36, v142
    v_mfma_f32_16x16x32_bf16 v[184:187], a[188:191], a[136:139], v[184:187]
    ds_read_b64_tr_b16 a[180:181], v22 offset:40960
    v_mul_f32 v143, s36, v143
    v_mfma_f32_16x16x32_bf16 v[184:187], a[184:187], a[128:131], v[184:187]
    s_waitcnt lgkmcnt(9)
    buffer_load_dwordx4 v38, s[8:11], s40 offen offset:2048 lds
    v_mfma_f32_16x16x32_bf16 v[192:195], a[160:163], a[80:83], v[192:195]
    s_waitcnt lgkmcnt(7)
    ds_read_b64_tr_b16 a[182:183], v22 offset:45056
    ds_read_b64_tr_b16 a[184:185], v23 offset:32768
    v_mfma_f32_16x16x32_bf16 v[192:195], a[164:167], a[88:91], v[192:195]
Ltour0_2:
    s_cbranch_execz Ltour0_6
    ds_read_b64_tr_b16 a[186:187], v23 offset:36864
    v_cvt_pk_bf16_f32 v64, v128, v129
    v_mfma_f32_16x16x32_bf16 v[196:199], a[164:167], a[92:95], v[196:199]
    ds_read_b64_tr_b16 a[188:189], v23 offset:40960
    v_cvt_pk_bf16_f32 v65, v130, v131
    v_mfma_f32_16x16x32_bf16 v[196:199], a[160:163], a[84:87], v[196:199]
    s_waitcnt lgkmcnt(9)
    buffer_load_dwordx4 v39, s[8:11], s40 offen offset:3072 lds
    v_mfma_f32_16x16x32_bf16 v[204:207], a[168:171], a[84:87], v[204:207]
    s_waitcnt lgkmcnt(7)
    s_add_u32 s40, s40, 16384
    ds_read_b64_tr_b16 a[190:191], v23 offset:45056
    ds_read_b64_tr_b16 a[160:161], v24 offset:32768
    v_mfma_f32_16x16x32_bf16 v[204:207], a[172:175], a[92:95], v[204:207]
    ds_read_b64_tr_b16 a[162:163], v24 offset:36864
    v_cvt_pk_bf16_f32 v66, v136, v137
    v_mfma_f32_16x16x32_bf16 v[200:203], a[172:175], a[88:91], v[200:203]
    s_add_u32 m0, s42, 16384
    ds_read_b64_tr_b16 a[164:165], v24 offset:40960
    v_cvt_pk_bf16_f32 v67, v138, v139
    v_mfma_f32_16x16x32_bf16 v[200:203], a[168:171], a[80:83], v[200:203]
    s_waitcnt lgkmcnt(9)
    buffer_load_dwordx4 v36, s[8:11], s40 offen lds
    v_mfma_f32_16x16x32_bf16 v[208:211], a[176:179], a[80:83], v[208:211]
    s_waitcnt lgkmcnt(7)
    ds_read_b64_tr_b16 a[166:167], v24 offset:45056
    ds_read_b64_tr_b16 a[168:169], v25 offset:32768
    v_mfma_f32_16x16x32_bf16 v[208:211], a[180:183], a[88:91], v[208:211]
    ds_read_b64_tr_b16 a[170:171], v25 offset:36864
    v_cvt_pk_bf16_f32 v80, v132, v133
    v_mfma_f32_16x16x32_bf16 v[212:215], a[180:183], a[92:95], v[212:215]
    ds_read_b64_tr_b16 a[172:173], v25 offset:40960
    v_cvt_pk_bf16_f32 v81, v134, v135
    v_mfma_f32_16x16x32_bf16 v[212:215], a[176:179], a[84:87], v[212:215]
    s_waitcnt lgkmcnt(9)
    buffer_load_dwordx4 v37, s[8:11], s40 offen offset:1024 lds
    v_mfma_f32_16x16x32_bf16 v[220:223], a[184:187], a[84:87], v[220:223]
    s_waitcnt lgkmcnt(7)
    ds_read_b64_tr_b16 a[174:175], v25 offset:45056
    ds_read_b64_tr_b16 a[176:177], v26 offset:32768
    v_mfma_f32_16x16x32_bf16 v[220:223], a[188:191], a[92:95], v[220:223]
    ds_read_b64_tr_b16 a[178:179], v26 offset:36864
    v_cvt_pk_bf16_f32 v82, v140, v141
    v_mfma_f32_16x16x32_bf16 v[216:219], a[188:191], a[88:91], v[216:219]
    ds_read_b64_tr_b16 a[180:181], v26 offset:40960
    v_cvt_pk_bf16_f32 v83, v142, v143
    v_mfma_f32_16x16x32_bf16 v[216:219], a[184:187], a[80:83], v[216:219]
    s_waitcnt lgkmcnt(9)
    buffer_load_dwordx4 v38, s[8:11], s40 offen offset:2048 lds
    v_mfma_f32_16x16x32_bf16 v[224:227], a[160:163], a[80:83], v[224:227]
    s_waitcnt lgkmcnt(7)
    ds_read_b64_tr_b16 a[182:183], v26 offset:45056
    ds_read_b64_tr_b16 a[184:185], v27 offset:32768
    v_mfma_f32_16x16x32_bf16 v[224:227], a[164:167], a[88:91], v[224:227]
    ds_read_b64_tr_b16 a[186:187], v27 offset:36864
    v_permlane32_swap_b32 v64, v66
    v_mfma_f32_16x16x32_bf16 v[228:231], a[164:167], a[92:95], v[228:231]
    ds_read_b64_tr_b16 a[188:189], v27 offset:40960
    v_permlane32_swap_b32 v65, v67
    v_mfma_f32_16x16x32_bf16 v[228:231], a[160:163], a[84:87], v[228:231]
    s_waitcnt lgkmcnt(9)
    buffer_load_dwordx4 v39, s[8:11], s40 offen offset:3072 lds
    v_mfma_f32_16x16x32_bf16 v[236:239], a[168:171], a[84:87], v[236:239]
    s_waitcnt lgkmcnt(7)
    s_add_u32 s40, s40, 16384
    ds_read_b64_tr_b16 a[190:191], v27 offset:45056
    ds_read_b64_tr_b16 a[160:161], v20 offset:49152
    v_mfma_f32_16x16x32_bf16 v[236:239], a[172:175], a[92:95], v[236:239]
    ds_read_b64_tr_b16 a[162:163], v20 offset:53248
    v_permlane32_swap_b32 v80, v82
    v_mfma_f32_16x16x32_bf16 v[232:235], a[172:175], a[88:91], v[232:235]
    ds_read_b64_tr_b16 a[164:165], v20 offset:57344
    v_permlane32_swap_b32 v81, v83
    v_mfma_f32_16x16x32_bf16 v[232:235], a[168:171], a[80:83], v[232:235]
    s_waitcnt lgkmcnt(9)
    ds_read_b64_tr_b16 a[166:167], v20 offset:61440
    v_permlane16_swap_b32 v64, v66
    v_mfma_f32_16x16x32_bf16 v[240:243], a[176:179], a[80:83], v[240:243]
    s_waitcnt lgkmcnt(8)
    ds_read_b64_tr_b16 a[168:169], v21 offset:49152
    v_permlane16_swap_b32 v65, v67
    v_mfma_f32_16x16x32_bf16 v[240:243], a[180:183], a[88:91], v[240:243]
    ds_read_b64_tr_b16 a[170:171], v21 offset:53248
    v_permlane16_swap_b32 v80, v82
    v_mfma_f32_16x16x32_bf16 v[244:247], a[180:183], a[92:95], v[244:247]
    ds_read_b64_tr_b16 a[172:173], v21 offset:57344
    v_permlane16_swap_b32 v81, v83
    v_mfma_f32_16x16x32_bf16 v[244:247], a[176:179], a[84:87], v[244:247]
    s_waitcnt lgkmcnt(9)
    ds_read_b64_tr_b16 a[174:175], v21 offset:61440
    v_mul_f32 v144, s36, v144
    v_mfma_f32_16x16x32_bf16 v[252:255], a[184:187], a[84:87], v[252:255]
    s_waitcnt lgkmcnt(8)
    ds_read_b64_tr_b16 a[176:177], v22 offset:49152
    v_mul_f32 v145, s36, v145
    v_mfma_f32_16x16x32_bf16 v[252:255], a[188:191], a[92:95], v[252:255]
    ds_read_b64_tr_b16 a[178:179], v22 offset:53248
    v_mul_f32 v146, s36, v146
    v_mfma_f32_16x16x32_bf16 v[248:251], a[188:191], a[88:91], v[248:251]
    ds_read_b64_tr_b16 a[180:181], v22 offset:57344
    v_mul_f32 v147, s36, v147
    v_mfma_f32_16x16x32_bf16 v[248:251], a[184:187], a[80:83], v[248:251]
    s_waitcnt lgkmcnt(9)
    ds_read_b64_tr_b16 a[182:183], v22 offset:61440
    v_mul_f32 v152, s36, v152
    v_mfma_f32_16x16x32_bf16 v[192:195], a[160:163], a[96:99], v[192:195]
    s_waitcnt lgkmcnt(8)
    ds_read_b64_tr_b16 a[184:185], v23 offset:49152
    v_mul_f32 v153, s36, v153
    v_mfma_f32_16x16x32_bf16 v[192:195], a[164:167], a[104:107], v[192:195]
    ds_read_b64_tr_b16 a[186:187], v23 offset:53248
    v_mul_f32 v154, s36, v154
    v_mfma_f32_16x16x32_bf16 v[196:199], a[164:167], a[108:111], v[196:199]
    ds_read_b64_tr_b16 a[188:189], v23 offset:57344
    v_mul_f32 v155, s36, v155
    v_mfma_f32_16x16x32_bf16 v[196:199], a[160:163], a[100:103], v[196:199]
    s_waitcnt lgkmcnt(9)
    ds_read_b64_tr_b16 a[190:191], v23 offset:61440
    v_mul_f32 v148, s36, v148
    v_mfma_f32_16x16x32_bf16 v[204:207], a[168:171], a[100:103], v[204:207]
    s_waitcnt lgkmcnt(8)
    ds_read_b64_tr_b16 a[160:161], v24 offset:49152
    v_mul_f32 v149, s36, v149
    v_mfma_f32_16x16x32_bf16 v[204:207], a[172:175], a[108:111], v[204:207]
    ds_read_b64_tr_b16 a[162:163], v24 offset:53248
    v_mul_f32 v150, s36, v150
    v_mfma_f32_16x16x32_bf16 v[200:203], a[172:175], a[104:107], v[200:203]
    ds_read_b64_tr_b16 a[164:165], v24 offset:57344
    v_mul_f32 v151, s36, v151
    v_mfma_f32_16x16x32_bf16 v[200:203], a[168:171], a[96:99], v[200:203]
    s_waitcnt lgkmcnt(9)
    ds_read_b64_tr_b16 a[166:167], v24 offset:61440
    v_mul_f32 v156, s36, v156
    v_mfma_f32_16x16x32_bf16 v[208:211], a[176:179], a[96:99], v[208:211]
    s_waitcnt lgkmcnt(8)
    ds_read_b64_tr_b16 a[168:169], v25 offset:49152
    v_mul_f32 v157, s36, v157
    v_mfma_f32_16x16x32_bf16 v[208:211], a[180:183], a[104:107], v[208:211]
    ds_read_b64_tr_b16 a[170:171], v25 offset:53248
    v_mul_f32 v158, s36, v158
    v_mfma_f32_16x16x32_bf16 v[212:215], a[180:183], a[108:111], v[212:215]
    ds_read_b64_tr_b16 a[172:173], v25 offset:57344
    v_mul_f32 v159, s36, v159
    v_mfma_f32_16x16x32_bf16 v[212:215], a[176:179], a[100:103], v[212:215]
    s_waitcnt lgkmcnt(9)
    ds_read_b64_tr_b16 a[174:175], v25 offset:61440
    v_cvt_pk_bf16_f32 v68, v144, v145
    v_mfma_f32_16x16x32_bf16 v[220:223], a[184:187], a[100:103], v[220:223]
    s_waitcnt lgkmcnt(8)
    ds_read_b64_tr_b16 a[176:177], v26 offset:49152
    v_cvt_pk_bf16_f32 v69, v146, v147
    v_mfma_f32_16x16x32_bf16 v[220:223], a[188:191], a[108:111], v[220:223]
    ds_read_b64_tr_b16 a[178:179], v26 offset:53248
    v_cvt_pk_bf16_f32 v70, v152, v153
    v_mfma_f32_16x16x32_bf16 v[216:219], a[188:191], a[104:107], v[216:219]
    ds_read_b64_tr_b16 a[180:181], v26 offset:57344
    v_cvt_pk_bf16_f32 v71, v154, v155
    v_mfma_f32_16x16x32_bf16 v[216:219], a[184:187], a[96:99], v[216:219]
    s_waitcnt lgkmcnt(9)
    ds_read_b64_tr_b16 a[182:183], v26 offset:61440
    v_cvt_pk_bf16_f32 v84, v148, v149
    v_mfma_f32_16x16x32_bf16 v[224:227], a[160:163], a[96:99], v[224:227]
    s_waitcnt lgkmcnt(8)
    ds_read_b64_tr_b16 a[184:185], v27 offset:49152
    v_cvt_pk_bf16_f32 v85, v150, v151
    v_mfma_f32_16x16x32_bf16 v[224:227], a[164:167], a[104:107], v[224:227]
    ds_read_b64_tr_b16 a[186:187], v27 offset:53248
    v_cvt_pk_bf16_f32 v86, v156, v157
    v_mfma_f32_16x16x32_bf16 v[228:231], a[164:167], a[108:111], v[228:231]
    ds_read_b64_tr_b16 a[188:189], v27 offset:57344
    v_cvt_pk_bf16_f32 v87, v158, v159
    v_mfma_f32_16x16x32_bf16 v[228:231], a[160:163], a[100:103], v[228:231]
    s_waitcnt lgkmcnt(9)
    ds_read_b64_tr_b16 a[190:191], v27 offset:61440
    v_permlane32_swap_b32 v68, v70
    s_waitcnt vmcnt(12)
    s_barrier
    v_mfma_f32_16x16x32_bf16 v[236:239], a[168:171], a[100:103], v[236:239]
    s_waitcnt lgkmcnt(8)
    ds_read_b64_tr_b16 a[160:161], v28 offset:0
    v_permlane32_swap_b32 v69, v71
    v_mfma_f32_16x16x32_bf16 v[236:239], a[172:175], a[108:111], v[236:239]
    ds_read_b64_tr_b16 a[162:163], v28 offset:4096
    v_permlane32_swap_b32 v84, v86
    v_mfma_f32_16x16x32_bf16 v[232:235], a[172:175], a[104:107], v[232:235]
    s_add_u32 m0, s42, 32768
    ds_read_b64_tr_b16 a[164:165], v28 offset:8192
    v_permlane32_swap_b32 v85, v87
    v_mfma_f32_16x16x32_bf16 v[232:235], a[168:171], a[96:99], v[232:235]
    s_waitcnt lgkmcnt(9)
    buffer_load_dwordx4 v36, s[8:11], s40 offen lds
    v_mfma_f32_16x16x32_bf16 v[240:243], a[176:179], a[96:99], v[240:243]
    s_waitcnt lgkmcnt(7)
    ds_read_b64_tr_b16 a[166:167], v28 offset:12288
    ds_read_b64_tr_b16 a[168:169], v29 offset:0
    v_mfma_f32_16x16x32_bf16 v[240:243], a[180:183], a[104:107], v[240:243]
    ds_read_b64_tr_b16 a[170:171], v29 offset:4096
    v_permlane16_swap_b32 v68, v70
    v_mfma_f32_16x16x32_bf16 v[244:247], a[180:183], a[108:111], v[244:247]
    ds_read_b64_tr_b16 a[172:173], v29 offset:8192
    v_permlane16_swap_b32 v69, v71
    v_mfma_f32_16x16x32_bf16 v[244:247], a[176:179], a[100:103], v[244:247]
    s_waitcnt lgkmcnt(9)
    buffer_load_dwordx4 v37, s[8:11], s40 offen offset:1024 lds
    v_mfma_f32_16x16x32_bf16 v[252:255], a[184:187], a[100:103], v[252:255]
    s_waitcnt lgkmcnt(7)
    ds_read_b64_tr_b16 a[174:175], v29 offset:12288
    ds_read_b64_tr_b16 a[176:177], v30 offset:0
    v_mfma_f32_16x16x32_bf16 v[252:255], a[188:191], a[108:111], v[252:255]
    ds_read_b64_tr_b16 a[178:179], v30 offset:4096
    v_permlane16_swap_b32 v84, v86
    v_mfma_f32_16x16x32_bf16 v[248:251], a[188:191], a[104:107], v[248:251]
    ds_read_b64_tr_b16 a[180:181], v30 offset:8192
    v_permlane16_swap_b32 v85, v87
    v_mfma_f32_16x16x32_bf16 v[248:251], a[184:187], a[96:99], v[248:251]
    s_waitcnt lgkmcnt(9)
    buffer_load_dwordx4 v38, s[8:11], s40 offen offset:2048 lds
    v_mfma_f32_16x16x32_bf16 v[192:195], a[160:163], a[112:115], v[192:195]
    s_waitcnt lgkmcnt(7)
    ds_read_b64_tr_b16 a[182:183], v30 offset:12288
    ds_read_b64_tr_b16 a[184:185], v31 offset:0
    v_mfma_f32_16x16x32_bf16 v[192:195], a[164:167], a[120:123], v[192:195]
    ds_read_b64_tr_b16 a[186:187], v31 offset:4096
    v_mul_f32 v160, s36, v160
    v_mfma_f32_16x16x32_bf16 v[196:199], a[164:167], a[124:127], v[196:199]
    ds_read_b64_tr_b16 a[188:189], v31 offset:8192
    v_mul_f32 v161, s36, v161
    v_mfma_f32_16x16x32_bf16 v[196:199], a[160:163], a[116:119], v[196:199]
    s_waitcnt lgkmcnt(9)
    buffer_load_dwordx4 v39, s[8:11], s40 offen offset:3072 lds
    v_mfma_f32_16x16x32_bf16 v[204:207], a[168:171], a[116:119], v[204:207]
    s_waitcnt lgkmcnt(7)
    s_add_u32 s40, s40, 16384
    ds_read_b64_tr_b16 a[190:191], v31 offset:12288
    ds_read_b64_tr_b16 a[160:161], v32 offset:0
    v_mfma_f32_16x16x32_bf16 v[204:207], a[172:175], a[124:127], v[204:207]
    ds_read_b64_tr_b16 a[162:163], v32 offset:4096
    v_mul_f32 v162, s36, v162
    v_mfma_f32_16x16x32_bf16 v[200:203], a[172:175], a[120:123], v[200:203]
    s_add_u32 m0, s42, 65536
    ds_read_b64_tr_b16 a[164:165], v32 offset:8192
    v_mul_f32 v163, s36, v163
    v_mfma_f32_16x16x32_bf16 v[200:203], a[168:171], a[112:115], v[200:203]
    s_waitcnt lgkmcnt(9)
    buffer_load_dwordx4 v40, s[12:15], s41 offen lds
    v_mfma_f32_16x16x32_bf16 v[208:211], a[176:179], a[112:115], v[208:211]
    s_waitcnt lgkmcnt(7)
    ds_read_b64_tr_b16 a[166:167], v32 offset:12288
    ds_read_b64_tr_b16 a[168:169], v33 offset:0
    v_mfma_f32_16x16x32_bf16 v[208:211], a[180:183], a[120:123], v[208:211]
    ds_read_b64_tr_b16 a[170:171], v33 offset:4096
    v_mul_f32 v168, s36, v168
    v_mfma_f32_16x16x32_bf16 v[212:215], a[180:183], a[124:127], v[212:215]
    ds_read_b64_tr_b16 a[172:173], v33 offset:8192
    v_mul_f32 v169, s36, v169
    v_mfma_f32_16x16x32_bf16 v[212:215], a[176:179], a[116:119], v[212:215]
    s_waitcnt lgkmcnt(9)
    buffer_load_dwordx4 v41, s[12:15], s41 offen offset:1024 lds
    v_mfma_f32_16x16x32_bf16 v[220:223], a[184:187], a[116:119], v[220:223]
    s_waitcnt lgkmcnt(7)
    ds_read_b64_tr_b16 a[174:175], v33 offset:12288
    ds_read_b64_tr_b16 a[176:177], v34 offset:0
    v_mfma_f32_16x16x32_bf16 v[220:223], a[188:191], a[124:127], v[220:223]
    ds_read_b64_tr_b16 a[178:179], v34 offset:4096
    v_mul_f32 v170, s36, v170
    v_mfma_f32_16x16x32_bf16 v[216:219], a[188:191], a[120:123], v[216:219]
    ds_read_b64_tr_b16 a[180:181], v34 offset:8192
    v_mul_f32 v171, s36, v171
    v_mfma_f32_16x16x32_bf16 v[216:219], a[184:187], a[112:115], v[216:219]
    s_waitcnt lgkmcnt(9)
    buffer_load_dwordx4 v40, s[12:15], s41 offen offset:2048 lds
    v_mfma_f32_16x16x32_bf16 v[224:227], a[160:163], a[112:115], v[224:227]
    s_waitcnt lgkmcnt(7)
    ds_read_b64_tr_b16 a[182:183], v34 offset:12288
    ds_read_b64_tr_b16 a[184:185], v35 offset:0
    v_mfma_f32_16x16x32_bf16 v[224:227], a[164:167], a[120:123], v[224:227]
    ds_read_b64_tr_b16 a[186:187], v35 offset:4096
    v_mul_f32 v164, s36, v164
    v_mfma_f32_16x16x32_bf16 v[228:231], a[164:167], a[124:127], v[228:231]
    ds_read_b64_tr_b16 a[188:189], v35 offset:8192
    v_mul_f32 v165, s36, v165
    v_mfma_f32_16x16x32_bf16 v[228:231], a[160:163], a[116:119], v[228:231]
    s_waitcnt lgkmcnt(9)
    buffer_load_dwordx4 v41, s[12:15], s41 offen offset:3072 lds
    v_mfma_f32_16x16x32_bf16 v[236:239], a[168:171], a[116:119], v[236:239]
    s_waitcnt lgkmcnt(7)
    s_add_u32 s41, s41, 16384
    ds_read_b64_tr_b16 a[190:191], v35 offset:12288
    ds_read_b64_tr_b16 a[160:161], v28 offset:16384
    v_mfma_f32_16x16x32_bf16 v[236:239], a[172:175], a[124:127], v[236:239]
    ds_read_b64_tr_b16 a[162:163], v28 offset:20480
    v_mul_f32 v166, s36, v166
    v_mfma_f32_16x16x32_bf16 v[232:235], a[172:175], a[120:123], v[232:235]
    s_add_u32 m0, s42, 81920
    ds_read_b64_tr_b16 a[164:165], v28 offset:24576
    v_mul_f32 v167, s36, v167
    v_mfma_f32_16x16x32_bf16 v[232:235], a[168:171], a[112:115], v[232:235]
    s_waitcnt lgkmcnt(9)
    buffer_load_dwordx4 v40, s[12:15], s41 offen lds
    v_mfma_f32_16x16x32_bf16 v[240:243], a[176:179], a[112:115], v[240:243]
    s_waitcnt lgkmcnt(7)
    ds_read_b64_tr_b16 a[166:167], v28 offset:28672
    ds_read_b64_tr_b16 a[168:169], v29 offset:16384
    v_mfma_f32_16x16x32_bf16 v[240:243], a[180:183], a[120:123], v[240:243]
    ds_read_b64_tr_b16 a[170:171], v29 offset:20480
    v_mul_f32 v172, s36, v172
    v_mfma_f32_16x16x32_bf16 v[244:247], a[180:183], a[124:127], v[244:247]
    ds_read_b64_tr_b16 a[172:173], v29 offset:24576
    v_mul_f32 v173, s36, v173
    v_mfma_f32_16x16x32_bf16 v[244:247], a[176:179], a[116:119], v[244:247]
    s_waitcnt lgkmcnt(9)
    buffer_load_dwordx4 v41, s[12:15], s41 offen offset:1024 lds
    v_mfma_f32_16x16x32_bf16 v[252:255], a[184:187], a[116:119], v[252:255]
    s_waitcnt lgkmcnt(7)
    ds_read_b64_tr_b16 a[174:175], v29 offset:28672
    ds_read_b64_tr_b16 a[176:177], v30 offset:16384
    v_mfma_f32_16x16x32_bf16 v[252:255], a[188:191], a[124:127], v[252:255]
    ds_read_b64_tr_b16 a[178:179], v30 offset:20480
    v_mul_f32 v174, s36, v174
    v_mfma_f32_16x16x32_bf16 v[248:251], a[188:191], a[120:123], v[248:251]
    ds_read_b64_tr_b16 a[180:181], v30 offset:24576
    v_mul_f32 v175, s36, v175
    v_mfma_f32_16x16x32_bf16 v[248:251], a[184:187], a[112:115], v[248:251]
    s_waitcnt lgkmcnt(9)
    buffer_load_dwordx4 v40, s[12:15], s41 offen offset:2048 lds
    v_mfma_f32_16x16x32_bf16 v[192:195], a[160:163], a[128:131], v[192:195]
    s_waitcnt lgkmcnt(7)
    ds_read_b64_tr_b16 a[182:183], v30 offset:28672
    ds_read_b64_tr_b16 a[184:185], v31 offset:16384
    v_mfma_f32_16x16x32_bf16 v[192:195], a[164:167], a[136:139], v[192:195]
    ds_read_b64_tr_b16 a[186:187], v31 offset:20480
    v_cvt_pk_bf16_f32 v72, v160, v161
    v_mfma_f32_16x16x32_bf16 v[196:199], a[164:167], a[140:143], v[196:199]
    ds_read_b64_tr_b16 a[188:189], v31 offset:24576
    v_cvt_pk_bf16_f32 v73, v162, v163
    v_mfma_f32_16x16x32_bf16 v[196:199], a[160:163], a[132:135], v[196:199]
    s_waitcnt lgkmcnt(9)
    buffer_load_dwordx4 v41, s[12:15], s41 offen offset:3072 lds
    v_mfma_f32_16x16x32_bf16 v[204:207], a[168:171], a[132:135], v[204:207]
    s_waitcnt lgkmcnt(7)
    s_add_u32 s41, s41, 16384
    ds_read_b64_tr_b16 a[190:191], v31 offset:28672
    ds_read_b64_tr_b16 a[160:161], v32 offset:16384
    v_mfma_f32_16x16x32_bf16 v[204:207], a[172:175], a[140:143], v[204:207]
    ds_read_b64_tr_b16 a[162:163], v32 offset:20480
    v_cvt_pk_bf16_f32 v74, v168, v169
    v_mfma_f32_16x16x32_bf16 v[200:203], a[172:175], a[136:139], v[200:203]
    ds_read_b64_tr_b16 a[164:165], v32 offset:24576
    v_cvt_pk_bf16_f32 v75, v170, v171
    v_mfma_f32_16x16x32_bf16 v[200:203], a[168:171], a[128:131], v[200:203]
    s_waitcnt lgkmcnt(9)
    ds_read_b64_tr_b16 a[166:167], v32 offset:28672
    v_cvt_pk_bf16_f32 v88, v164, v165
    v_mfma_f32_16x16x32_bf16 v[208:211], a[176:179], a[128:131], v[208:211]
    s_waitcnt lgkmcnt(8)
    ds_read_b64_tr_b16 a[168:169], v33 offset:16384
    v_cvt_pk_bf16_f32 v89, v166, v167
    v_mfma_f32_16x16x32_bf16 v[208:211], a[180:183], a[136:139], v[208:211]
    ds_read_b64_tr_b16 a[170:171], v33 offset:20480
    v_cvt_pk_bf16_f32 v90, v172, v173
    v_mfma_f32_16x16x32_bf16 v[212:215], a[180:183], a[140:143], v[212:215]
    ds_read_b64_tr_b16 a[172:173], v33 offset:24576
    v_cvt_pk_bf16_f32 v91, v174, v175
    v_mfma_f32_16x16x32_bf16 v[212:215], a[176:179], a[132:135], v[212:215]
    s_waitcnt lgkmcnt(9)
    ds_read_b64_tr_b16 a[174:175], v33 offset:28672
    v_permlane32_swap_b32 v72, v74
    v_mfma_f32_16x16x32_bf16 v[220:223], a[184:187], a[132:135], v[220:223]
    s_waitcnt lgkmcnt(8)
    ds_read_b64_tr_b16 a[176:177], v34 offset:16384
    v_permlane32_swap_b32 v73, v75
    v_mfma_f32_16x16x32_bf16 v[220:223], a[188:191], a[140:143], v[220:223]
    ds_read_b64_tr_b16 a[178:179], v34 offset:20480
    v_permlane32_swap_b32 v88, v90
    v_mfma_f32_16x16x32_bf16 v[216:219], a[188:191], a[136:139], v[216:219]
    ds_read_b64_tr_b16 a[180:181], v34 offset:24576
    v_permlane32_swap_b32 v89, v91
    v_mfma_f32_16x16x32_bf16 v[216:219], a[184:187], a[128:131], v[216:219]
    s_waitcnt lgkmcnt(9)
    ds_read_b64_tr_b16 a[182:183], v34 offset:28672
    v_permlane16_swap_b32 v72, v74
    v_mfma_f32_16x16x32_bf16 v[224:227], a[160:163], a[128:131], v[224:227]
    s_waitcnt lgkmcnt(8)
    ds_read_b64_tr_b16 a[184:185], v35 offset:16384
    v_permlane16_swap_b32 v73, v75
    v_mfma_f32_16x16x32_bf16 v[224:227], a[164:167], a[136:139], v[224:227]
    ds_read_b64_tr_b16 a[186:187], v35 offset:20480
    v_permlane16_swap_b32 v88, v90
    v_mfma_f32_16x16x32_bf16 v[228:231], a[164:167], a[140:143], v[228:231]
    ds_read_b64_tr_b16 a[188:189], v35 offset:24576
    v_permlane16_swap_b32 v89, v91
    v_mfma_f32_16x16x32_bf16 v[228:231], a[160:163], a[132:135], v[228:231]
    s_waitcnt lgkmcnt(9)
    ds_read_b64_tr_b16 a[190:191], v35 offset:28672
    v_mul_f32 v176, s36, v176
    v_mfma_f32_16x16x32_bf16 v[236:239], a[168:171], a[132:135], v[236:239]
    s_waitcnt lgkmcnt(8)
    v_mul_f32 v177, s36, v177
    v_mul_f32 v178, s36, v178
    v_mfma_f32_16x16x32_bf16 v[236:239], a[172:175], a[140:143], v[236:239]
    v_mul_f32 v179, s36, v179
    v_mul_f32 v184, s36, v184
    v_mfma_f32_16x16x32_bf16 v[232:235], a[172:175], a[136:139], v[232:235]
    v_mul_f32 v185, s36, v185
    v_mul_f32 v186, s36, v186
    v_mfma_f32_16x16x32_bf16 v[232:235], a[168:171], a[128:131], v[232:235]
    s_waitcnt lgkmcnt(6)
    v_mul_f32 v187, s36, v187
    v_mul_f32 v180, s36, v180
    s_waitcnt vmcnt(16)
    s_barrier
    v_mfma_f32_16x16x32_bf16 v[240:243], a[176:179], a[128:131], v[240:243]
    s_waitcnt lgkmcnt(4)
    ds_read_b128 a[208:211], v8 offset:0
    v_mul_f32 v181, s36, v181
    v_mfma_f32_16x16x32_bf16 v[240:243], a[180:183], a[136:139], v[240:243]
    ds_read_b128 a[212:215], v9 offset:0
    v_mul_f32 v182, s36, v182
    v_mfma_f32_16x16x32_bf16 v[244:247], a[180:183], a[140:143], v[244:247]
    ds_read_b128 a[216:219], v10 offset:0
    v_mul_f32 v183, s36, v183
    v_mfma_f32_16x16x32_bf16 v[244:247], a[176:179], a[132:135], v[244:247]
    s_waitcnt lgkmcnt(5)
    ds_read_b128 a[220:223], v11 offset:0
    v_mul_f32 v188, s36, v188
    v_mfma_f32_16x16x32_bf16 v[252:255], a[184:187], a[132:135], v[252:255]
    s_waitcnt lgkmcnt(4)
    ds_read_b128 a[224:227], v8 offset:4096
    v_mul_f32 v189, s36, v189
    v_mfma_f32_16x16x32_bf16 v[252:255], a[188:191], a[140:143], v[252:255]
    v_mul_f32 v190, s36, v190
    v_mul_f32 v191, s36, v191
    v_mfma_f32_16x16x32_bf16 v[248:251], a[188:191], a[136:139], v[248:251]
    s_load_dwordx2 s[16:17], s[0:1], 88
    v_cvt_pk_bf16_f32 v76, v176, v177
    v_cvt_pk_bf16_f32 v77, v178, v179
    v_mfma_f32_16x16x32_bf16 v[248:251], a[184:187], a[128:131], v[248:251]
    v_cvt_pk_bf16_f32 v78, v184, v185
    v_cvt_pk_bf16_f32 v79, v186, v187
    v_cvt_pk_bf16_f32 v92, v180, v181
    v_cvt_pk_bf16_f32 v93, v182, v183
    v_cvt_pk_bf16_f32 v94, v188, v189
    v_cvt_pk_bf16_f32 v95, v190, v191
    v_permlane32_swap_b32 v76, v78
    v_permlane32_swap_b32 v77, v79
    v_permlane32_swap_b32 v92, v94
    v_permlane32_swap_b32 v93, v95
    v_permlane16_swap_b32 v76, v78
    v_permlane16_swap_b32 v77, v79
    v_permlane16_swap_b32 v92, v94
    v_permlane16_swap_b32 v93, v95
    s_mov_b32 s36, 1040356334
    s_mov_b32 s37, 1040356334
    v_mov_b32 v58, 0
    v_mov_b32 v59, 0
    v_mov_b32 v60, 0
    v_mov_b32 v61, 0
    v_pk_mul_f32 v[192:193], v[192:193], s[36:37]
    v_pk_mul_f32 v[194:195], v[194:195], s[36:37]
    v_pk_mul_f32 v[200:201], v[200:201], s[36:37]
    v_pk_mul_f32 v[202:203], v[202:203], s[36:37]
    v_pk_mul_f32 v[196:197], v[196:197], s[36:37]
    v_pk_mul_f32 v[198:199], v[198:199], s[36:37]
    v_pk_mul_f32 v[204:205], v[204:205], s[36:37]
    v_pk_mul_f32 v[206:207], v[206:207], s[36:37]
    v_mfma_f32_32x32x16_bf16 a[0:15], v[58:61], v[58:61], 0
    v_cvt_pk_bf16_f32 v96, v192, v193
    v_cvt_pk_bf16_f32 v97, v194, v195
    v_cvt_pk_bf16_f32 v98, v200, v201
    v_cvt_pk_bf16_f32 v99, v202, v203
    v_cvt_pk_bf16_f32 v112, v196, v197
    v_cvt_pk_bf16_f32 v113, v198, v199
    v_cvt_pk_bf16_f32 v114, v204, v205
    v_cvt_pk_bf16_f32 v115, v206, v207
    v_mfma_f32_32x32x16_bf16 a[16:31], v[58:61], v[58:61], 0
    v_permlane32_swap_b32 v96, v98
    v_permlane32_swap_b32 v97, v99
    v_permlane32_swap_b32 v112, v114
    v_permlane32_swap_b32 v113, v115
    v_permlane16_swap_b32 v96, v98
    v_permlane16_swap_b32 v97, v99
    v_permlane16_swap_b32 v112, v114
    v_permlane16_swap_b32 v113, v115
    v_pk_mul_f32 v[208:209], v[208:209], s[36:37]
    v_pk_mul_f32 v[210:211], v[210:211], s[36:37]
    v_pk_mul_f32 v[216:217], v[216:217], s[36:37]
    v_pk_mul_f32 v[218:219], v[218:219], s[36:37]
    v_pk_mul_f32 v[212:213], v[212:213], s[36:37]
    v_pk_mul_f32 v[214:215], v[214:215], s[36:37]
    v_pk_mul_f32 v[220:221], v[220:221], s[36:37]
    v_pk_mul_f32 v[222:223], v[222:223], s[36:37]
    v_mfma_f32_32x32x16_bf16 a[32:47], v[58:61], v[58:61], 0
    v_cvt_pk_bf16_f32 v100, v208, v209
    v_cvt_pk_bf16_f32 v101, v210, v211
    v_cvt_pk_bf16_f32 v102, v216, v217
    v_cvt_pk_bf16_f32 v103, v218, v219
    v_cvt_pk_bf16_f32 v116, v212, v213
    v_cvt_pk_bf16_f32 v117, v214, v215
    v_cvt_pk_bf16_f32 v118, v220, v221
    v_cvt_pk_bf16_f32 v119, v222, v223
    v_mfma_f32_32x32x16_bf16 a[48:63], v[58:61], v[58:61], 0
    v_permlane32_swap_b32 v100, v102
    v_permlane32_swap_b32 v101, v103
    v_permlane32_swap_b32 v116, v118
    v_permlane32_swap_b32 v117, v119
    v_permlane16_swap_b32 v100, v102
    v_permlane16_swap_b32 v101, v103
    v_permlane16_swap_b32 v116, v118
    v_permlane16_swap_b32 v117, v119
    v_pk_mul_f32 v[224:225], v[224:225], s[36:37]
    v_pk_mul_f32 v[226:227], v[226:227], s[36:37]
    v_pk_mul_f32 v[232:233], v[232:233], s[36:37]
    v_pk_mul_f32 v[234:235], v[234:235], s[36:37]
    v_pk_mul_f32 v[228:229], v[228:229], s[36:37]
    v_pk_mul_f32 v[230:231], v[230:231], s[36:37]
    v_pk_mul_f32 v[236:237], v[236:237], s[36:37]
    v_pk_mul_f32 v[238:239], v[238:239], s[36:37]
    v_mfma_f32_32x32x16_bf16 a[64:79], v[58:61], v[58:61], 0
    v_cvt_pk_bf16_f32 v104, v224, v225
    v_cvt_pk_bf16_f32 v105, v226, v227
    v_cvt_pk_bf16_f32 v106, v232, v233
    v_cvt_pk_bf16_f32 v107, v234, v235
    v_cvt_pk_bf16_f32 v120, v228, v229
    v_cvt_pk_bf16_f32 v121, v230, v231
    v_cvt_pk_bf16_f32 v122, v236, v237
    v_cvt_pk_bf16_f32 v123, v238, v239
    v_mfma_f32_32x32x16_bf16 a[80:95], v[58:61], v[58:61], 0
    v_permlane32_swap_b32 v104, v106
    v_permlane32_swap_b32 v105, v107
    v_permlane32_swap_b32 v120, v122
    v_permlane32_swap_b32 v121, v123
    v_permlane16_swap_b32 v104, v106
    v_permlane16_swap_b32 v105, v107
    v_permlane16_swap_b32 v120, v122
    v_permlane16_swap_b32 v121, v123
    v_pk_mul_f32 v[240:241], v[240:241], s[36:37]
    v_pk_mul_f32 v[242:243], v[242:243], s[36:37]
    v_pk_mul_f32 v[248:249], v[248:249], s[36:37]
    v_pk_mul_f32 v[250:251], v[250:251], s[36:37]
    v_pk_mul_f32 v[244:245], v[244:245], s[36:37]
    v_pk_mul_f32 v[246:247], v[246:247], s[36:37]
    v_pk_mul_f32 v[252:253], v[252:253], s[36:37]
    v_pk_mul_f32 v[254:255], v[254:255], s[36:37]
    v_mfma_f32_32x32x16_bf16 a[96:111], v[58:61], v[58:61], 0
    v_cvt_pk_bf16_f32 v108, v240, v241
    v_cvt_pk_bf16_f32 v109, v242, v243
    v_cvt_pk_bf16_f32 v110, v248, v249
    v_cvt_pk_bf16_f32 v111, v250, v251
    v_cvt_pk_bf16_f32 v124, v244, v245
    v_cvt_pk_bf16_f32 v125, v246, v247
    v_cvt_pk_bf16_f32 v126, v252, v253
    v_cvt_pk_bf16_f32 v127, v254, v255
    v_mfma_f32_32x32x16_bf16 a[112:127], v[58:61], v[58:61], 0
    v_permlane32_swap_b32 v108, v110
    v_permlane32_swap_b32 v109, v111
    v_permlane32_swap_b32 v124, v126
    v_permlane32_swap_b32 v125, v127
    v_permlane16_swap_b32 v108, v110
    v_permlane16_swap_b32 v109, v111
    v_permlane16_swap_b32 v124, v126
    v_permlane16_swap_b32 v125, v127
    s_waitcnt lgkmcnt(0)
    v_mfma_f32_16x16x32_bf16 v[216:219], a[208:211], v[64:67], 0
    v_mfma_f32_16x16x32_bf16 v[216:219], a[212:215], v[68:71], v[216:219]
    v_mfma_f32_16x16x32_bf16 v[216:219], a[216:219], v[72:75], v[216:219]
    v_mfma_f32_16x16x32_bf16 v[216:219], a[220:223], v[76:79], v[216:219]
    v_mfma_f32_16x16x32_bf16 v[220:223], a[208:211], v[80:83], 0
    v_mfma_f32_16x16x32_bf16 v[220:223], a[212:215], v[84:87], v[220:223]
    v_mfma_f32_16x16x32_bf16 v[220:223], a[216:219], v[88:91], v[220:223]
    v_mfma_f32_16x16x32_bf16 v[220:223], a[220:223], v[92:95], v[220:223]
    v_mfma_f32_16x16x32_bf16 v[224:227], a[208:211], v[96:99], 0
    v_mfma_f32_16x16x32_bf16 v[224:227], a[212:215], v[100:103], v[224:227]
    v_mfma_f32_16x16x32_bf16 v[224:227], a[216:219], v[104:107], v[224:227]
    v_mfma_f32_16x16x32_bf16 v[224:227], a[220:223], v[108:111], v[224:227]
    v_mfma_f32_16x16x32_bf16 v[228:231], a[208:211], v[112:115], 0
    v_mfma_f32_16x16x32_bf16 v[228:231], a[212:215], v[116:119], v[228:231]
    v_mfma_f32_16x16x32_bf16 v[228:231], a[216:219], v[120:123], v[228:231]
    v_mfma_f32_16x16x32_bf16 v[228:231], a[220:223], v[124:127], v[228:231]
    v_mfma_f32_32x32x16_bf16 a[192:207], v[58:61], v[58:61], 0
    v_max3_f32 v232, v216, v217, v218
    v_max_f32 v232, v232, v219
    v_max3_f32 v233, v220, v221, v222
    v_max_f32 v233, v233, v223
    v_max3_f32 v234, v224, v225, v226
    v_max_f32 v234, v234, v227
    s_nop 0
    v_max3_f32 v235, v228, v229, v230
    v_max_f32 v235, v235, v231
    v_mov_b32 v236, v232
    v_mov_b32 v237, v233
    v_mov_b32 v238, v234
    v_mov_b32 v239, v235
    v_permlane16_swap_b32 v232, v236
    v_permlane16_swap_b32 v233, v237
    v_permlane16_swap_b32 v234, v238
    v_permlane16_swap_b32 v235, v239
    v_max_f32 v232, v232, v236
    v_max_f32 v233, v233, v237
    v_max_f32 v234, v234, v238
    v_max_f32 v235, v235, v239
    v_mov_b32 v236, v232
    v_mov_b32 v237, v233
    v_mov_b32 v238, v234
    v_mov_b32 v239, v235
    v_permlane32_swap_b32 v232, v236
    v_permlane32_swap_b32 v233, v237
    v_permlane32_swap_b32 v234, v238
    v_permlane32_swap_b32 v235, v239
    v_max_f32 v232, v232, v236
    v_max_f32 v233, v233, v237
    v_max_f32 v234, v234, v238
    v_max_f32 v235, v235, v239
    v_sub_f32 v192, 3250585600, v232
    v_sub_f32 v193, 3250585600, v232
    v_sub_f32 v194, 3250585600, v232
    v_sub_f32 v195, 3250585600, v232
    v_sub_f32 v196, 3250585600, v233
    v_sub_f32 v197, 3250585600, v233
Ltour0_3:
    s_cbranch_execz Ltour0_7
    v_sub_f32 v198, 3250585600, v233
    v_sub_f32 v199, 3250585600, v233
    v_sub_f32 v200, 3250585600, v234
    v_sub_f32 v201, 3250585600, v234
    v_sub_f32 v202, 3250585600, v234
    v_sub_f32 v203, 3250585600, v234
    v_sub_f32 v204, 3250585600, v235
    v_sub_f32 v205, 3250585600, v235
    v_sub_f32 v206, 3250585600, v235
    v_sub_f32 v207, 3250585600, v235
Lattn_stage0:
    s_mov_b32 s43, 7
    v_mfma_f32_16x16x32_bf16 v[208:211], a[208:211], v[64:67], v[192:195]
    s_lshl_b32 s53, s5, 4
    v_lshrrev_b32 v51, 2, v0
    v_mul_u32_u24 v51, 9216, v51
    v_mfma_f32_16x16x32_bf16 v[208:211], a[212:215], v[68:71], v[208:211]
    s_add_u32 s53, s53, s4
    v_and_b32 v254, 3, v0
    v_lshl_add_u32 v254, v254, 4, v51
    v_mfma_f32_16x16x32_bf16 v[208:211], a[216:219], v[72:75], v[208:211]
    s_lshl_b32 s53, s53, 2
    v_lshlrev_b32 v255, 4, v0
    v_add_u32 v51, 98304, v255
    v_mfma_f32_16x16x32_bf16 v[208:211], a[220:223], v[76:79], v[208:211]
    s_add_u32 s53, s53, s3
    v_mov_b32 v224, 0
    v_mfma_f32_16x16x32_bf16 v[212:215], a[208:211], v[80:83], v[196:199]
    s_mul_i32 s53, s53, 4608
    ds_read_b128 a[228:231], v9 offset:4096
    v_mov_b32 v225, 0
    v_mfma_f32_16x16x32_bf16 v[212:215], a[212:215], v[84:87], v[212:215]
    s_add_u32 s53, s53, 2621440
    v_exp_f32 v208, v208
    v_mfma_f32_16x16x32_bf16 v[212:215], a[216:219], v[88:91], v[212:215]
    s_lshr_b32 s44, s2, 5
    v_exp_f32 v209, v209
    v_mfma_f32_16x16x32_bf16 v[212:215], a[220:223], v[92:95], v[212:215]
    s_lshl_b32 s44, s44, 3
    v_exp_f32 v210, v210
    v_exp_f32 v211, v211
    v_cvt_pk_bf16_f32 v128, v208, v209
    v_cvt_pk_bf16_f32 v129, v210, v211
    v_mfma_f32_16x16x32_bf16 v[208:211], a[208:211], v[96:99], v[200:203]
    s_and_b32 s37, s2, 7
    ds_read_b128 a[232:235], v10 offset:4096
    v_mov_b32 v226, 0
    v_mfma_f32_16x16x32_bf16 v[208:211], a[212:215], v[100:103], v[208:211]
    s_add_u32 s44, s44, s37
    v_exp_f32 v212, v212
    v_mfma_f32_16x16x32_bf16 v[208:211], a[216:219], v[104:107], v[208:211]
    s_lshl_b32 s44, s44, 2
    v_exp_f32 v213, v213
    v_mfma_f32_16x16x32_bf16 v[208:211], a[220:223], v[108:111], v[208:211]
    s_bfe_u32 s37, s2, 0x20003
    v_exp_f32 v214, v214
    v_exp_f32 v215, v215
    v_cvt_pk_bf16_f32 v136, v212, v213
    v_cvt_pk_bf16_f32 v137, v214, v215
    v_mfma_f32_16x16x32_bf16 v[212:215], a[208:211], v[112:115], v[204:207]
    s_add_u32 s44, s44, s37
    ds_read_b128 a[236:239], v11 offset:4096
    v_mov_b32 v227, 0
    v_mfma_f32_16x16x32_bf16 v[212:215], a[212:215], v[116:119], v[212:215]
    s_add_u32 s44, s44, 72
    v_exp_f32 v208, v208
    v_mfma_f32_16x16x32_bf16 v[212:215], a[216:219], v[120:123], v[212:215]
    s_cmp_lt_u32 s44, 216
    s_cselect_b32 s37, 0, 2147483648
    v_exp_f32 v209, v209
    v_mfma_f32_16x16x32_bf16 v[212:215], a[220:223], v[124:127], v[212:215]
    s_lshl_b32 s44, s44, 5
    v_exp_f32 v210, v210
    v_exp_f32 v211, v211
    v_cvt_pk_bf16_f32 v144, v208, v209
    v_cvt_pk_bf16_f32 v145, v210, v211
    v_mfma_f32_16x16x32_bf16 v[208:211], a[224:227], v[64:67], v[192:195]
    s_waitcnt lgkmcnt(2)
    s_or_b32 s44, s44, s37
    ds_read_b128 a[208:211], v8 offset:8192
    v_mov_b32 v228, 0
    v_mfma_f32_16x16x32_bf16 v[208:211], a[228:231], v[68:71], v[208:211]
    s_waitcnt lgkmcnt(2)
    s_mov_b32 s18, 3981312
    v_exp_f32 v212, v212
    v_mfma_f32_16x16x32_bf16 v[208:211], a[232:235], v[72:75], v[208:211]
    s_waitcnt lgkmcnt(1)
    s_lshr_b32 s6, s2, 3
    v_exp_f32 v213, v213
    v_mfma_f32_16x16x32_bf16 v[208:211], a[236:239], v[76:79], v[208:211]
    s_and_b32 s7, s2, 7
    v_exp_f32 v214, v214
    v_exp_f32 v215, v215
    v_cvt_pk_bf16_f32 v152, v212, v213
    v_cvt_pk_bf16_f32 v153, v214, v215
    v_mfma_f32_16x16x32_bf16 v[212:215], a[224:227], v[80:83], v[196:199]
    s_mul_i32 s7, s7, 18
    ds_read_b128 a[212:215], v9 offset:8192
    v_mov_b32 v229, 0
    v_mfma_f32_16x16x32_bf16 v[212:215], a[228:231], v[84:87], v[212:215]
    s_add_u32 s7, s7, s6
    v_exp_f32 v208, v208
    v_mfma_f32_16x16x32_bf16 v[212:215], a[232:235], v[88:91], v[212:215]
    s_lshl_b32 s58, s7, 6
    v_exp_f32 v209, v209
    v_mfma_f32_16x16x32_bf16 v[212:215], a[236:239], v[92:95], v[212:215]
    s_mul_i32 s59, s7, 36864
    v_exp_f32 v210, v210
    v_exp_f32 v211, v211
    v_cvt_pk_bf16_f32 v130, v208, v209
    v_cvt_pk_bf16_f32 v131, v210, v211
    v_mfma_f32_16x16x32_bf16 v[208:211], a[224:227], v[96:99], v[200:203]
    s_cmp_lt_u32 s6, 18
    s_cselect_b32 s7, 0, 2147483648
    ds_read_b128 a[216:219], v10 offset:8192
    v_mov_b32 v230, 0
    v_mfma_f32_16x16x32_bf16 v[208:211], a[228:231], v[100:103], v[208:211]
    s_or_b32 s58, s58, s7
    v_exp_f32 v212, v212
    v_mfma_f32_16x16x32_bf16 v[208:211], a[232:235], v[104:107], v[208:211]
    s_or_b32 s59, s59, s7
    v_exp_f32 v213, v213
    v_mfma_f32_16x16x32_bf16 v[208:211], a[236:239], v[108:111], v[208:211]
    s_and_b32 s7, s4, 1
    v_exp_f32 v214, v214
    v_exp_f32 v215, v215
    v_cvt_pk_bf16_f32 v138, v212, v213
    v_cvt_pk_bf16_f32 v139, v214, v215
    s_mov_b32 s39, 221184
    s_mov_b32 s38, 27648
    v_mfma_f32_16x16x32_bf16 v[212:215], a[224:227], v[112:115], v[204:207]
    s_lshl_b32 s6, s7, 7
    ds_read_b128 a[220:223], v11 offset:8192
    v_mov_b32 v231, 0
    v_mfma_f32_16x16x32_bf16 v[212:215], a[228:231], v[116:119], v[212:215]
    s_xor_b32 s36, s4, 1
    v_exp_f32 v208, v208
    v_mfma_f32_16x16x32_bf16 v[212:215], a[232:235], v[120:123], v[212:215]
    s_mul_i32 s36, s36, 294912
    v_exp_f32 v209, v209
    v_mfma_f32_16x16x32_bf16 v[212:215], a[236:239], v[124:127], v[212:215]
    s_waitcnt lgkmcnt(3)
    s_add_u32 s46, s36, s6
    v_exp_f32 v210, v210
    v_exp_f32 v211, v211
    v_cvt_pk_bf16_f32 v146, v208, v209
    v_cvt_pk_bf16_f32 v147, v210, v211
    v_mfma_f32_16x16x32_bf16 v[208:211], a[208:211], v[64:67], v[192:195]
    s_waitcnt lgkmcnt(2)
    s_lshl_b32 s36, s4, 8
    ds_read_b128 a[224:227], v8 offset:12288
    v_mov_b32 v248, -1
    v_mfma_f32_16x16x32_bf16 v[208:211], a[212:215], v[68:71], v[208:211]
    s_waitcnt lgkmcnt(2)
    s_add_u32 s56, s47, s36
    v_exp_f32 v212, v212
    v_mfma_f32_16x16x32_bf16 v[208:211], a[216:219], v[72:75], v[208:211]
    s_waitcnt lgkmcnt(1)
    s_lshr_b32 s36, s4, 1
    v_exp_f32 v213, v213
    v_mfma_f32_16x16x32_bf16 v[208:211], a[220:223], v[76:79], v[208:211]
    s_lshl_b32 s36, s36, 11
    v_exp_f32 v214, v214
    v_exp_f32 v215, v215
    v_cvt_pk_bf16_f32 v154, v212, v213
    v_cvt_pk_bf16_f32 v155, v214, v215
    v_mfma_f32_16x16x32_bf16 v[212:215], a[208:211], v[80:83], v[196:199]
    s_lshl_b32 s7, s7, 8
    ds_read_b128 a[228:231], v9 offset:12288
    v_mov_b32 v249, -1
    v_mfma_f32_16x16x32_bf16 v[212:215], a[212:215], v[84:87], v[212:215]
    s_add_u32 s36, s36, s7
    v_exp_f32 v208, v208
    v_mfma_f32_16x16x32_bf16 v[212:215], a[216:219], v[88:91], v[212:215]
    s_add_u32 s93, s47, s36
    v_exp_f32 v209, v209
    v_mfma_f32_16x16x32_bf16 v[212:215], a[220:223], v[92:95], v[212:215]
    s_lshr_b32 s36, s4, 1
    v_exp_f32 v210, v210
    v_exp_f32 v211, v211
    v_cvt_pk_bf16_f32 v132, v208, v209
    v_cvt_pk_bf16_f32 v133, v210, v211
    v_mfma_f32_16x16x32_bf16 v[208:211], a[208:211], v[96:99], v[200:203]
    s_lshl_b32 s36, s36, 4
    ds_read_b128 a[232:235], v10 offset:12288
    v_mov_b32 v250, -1
    v_mfma_f32_16x16x32_bf16 v[208:211], a[212:215], v[100:103], v[208:211]
    s_add_u32 s36, s36, s5
    v_exp_f32 v212, v212
    v_mfma_f32_16x16x32_bf16 v[208:211], a[216:219], v[104:107], v[208:211]
    s_lshl_b32 s36, s36, 9
    v_exp_f32 v213, v213
    v_mfma_f32_16x16x32_bf16 v[208:211], a[220:223], v[108:111], v[208:211]
    s_add_u32 s36, s36, s7
    v_exp_f32 v214, v214
    v_exp_f32 v215, v215
    v_cvt_pk_bf16_f32 v140, v212, v213
    v_cvt_pk_bf16_f32 v141, v214, v215
    s_waitcnt vmcnt(4)
    s_barrier
    v_mfma_f32_16x16x32_bf16 v[212:215], a[208:211], v[112:115], v[204:207]
    s_lshl_b32 s36, s36, 8
    ds_read_b128 a[236:239], v11 offset:12288
    v_mov_b32 v251, -1
    v_mfma_f32_16x16x32_bf16 v[212:215], a[212:215], v[116:119], v[212:215]
    s_add_u32 m0, s42, 49152
    s_add_u32 s55, s36, 21102592
    v_exp_f32 v208, v208
    v_mfma_f32_16x16x32_bf16 v[212:215], a[216:219], v[120:123], v[212:215]
    s_add_u32 s7, s45, s6
    v_exp_f32 v209, v209
    v_mfma_f32_16x16x32_bf16 v[212:215], a[220:223], v[124:127], v[212:215]
    s_waitcnt lgkmcnt(3)
    s_xor_b32 s54, s92, 128
    v_exp_f32 v210, v210
    v_exp_f32 v211, v211
    v_cvt_pk_bf16_f32 v148, v208, v209
    v_cvt_pk_bf16_f32 v149, v210, v211
    buffer_load_dwordx4 v36, s[8:11], s40 offen lds
    v_mfma_f32_16x16x32_bf16 v[208:211], a[224:227], v[64:67], v[192:195]
    s_waitcnt lgkmcnt(2)
    s_lshl_b32 s36, s3, 14
    ds_read_b128 a[208:211], v8 offset:16384
    v_min_u32 v232, 41, v1
    v_mfma_f32_16x16x32_bf16 v[208:211], a[228:231], v[68:71], v[208:211]
    s_waitcnt lgkmcnt(2)
    v_exp_f32 v212, v212
    v_mfma_f32_16x16x32_bf16 v[208:211], a[232:235], v[72:75], v[208:211]
    s_waitcnt lgkmcnt(1)
    v_exp_f32 v213, v213
    v_mfma_f32_16x16x32_bf16 v[208:211], a[236:239], v[76:79], v[208:211]
    v_exp_f32 v214, v214
    v_exp_f32 v215, v215
    v_cvt_pk_bf16_f32 v156, v212, v213
    v_cvt_pk_bf16_f32 v157, v214, v215
    v_mfma_f32_16x16x32_bf16 v[212:215], a[224:227], v[80:83], v[196:199]
    ds_read_b128 a[212:215], v9 offset:16384
    v_mfma_f32_16x16x32_bf16 v[212:215], a[228:231], v[84:87], v[212:215]
    s_nop 0
    v_exp_f32 v208, v208
    v_mfma_f32_16x16x32_bf16 v[212:215], a[232:235], v[88:91], v[212:215]
    v_exp_f32 v209, v209
    v_mfma_f32_16x16x32_bf16 v[212:215], a[236:239], v[92:95], v[212:215]
    v_exp_f32 v210, v210
    v_exp_f32 v211, v211
    ds_read_b64_tr_b16 a[160:161], v20 offset:0
    v_cvt_pk_bf16_f32 v134, v208, v209
    v_lshl_add_u32 v252, v1, 4, s36
    v_lshlrev_b32 v232, 4, v232
    s_mov_b32 s57, s58
    s_lshl_b32 s6, s3, 10
    s_add_u32 s6, s6, 135168
    s_lshr_b32 s37, s2, 3
    s_mul_i32 s37, s37, -129024
    s_add_u32 s37, s37, 4128768
    ds_read_b64_tr_b16 a[162:163], v20 offset:4096
    ds_read_b128 a[216:219], v10 offset:16384
    v_cvt_pk_bf16_f32 v135, v210, v211
    buffer_load_dwordx4 v37, s[8:11], s40 offen offset:1024 lds
    v_mfma_f32_16x16x32_bf16 v[208:211], a[224:227], v[96:99], v[200:203]
    v_mfma_f32_16x16x32_bf16 v[208:211], a[228:231], v[100:103], v[208:211]
    v_exp_f32 v212, v212
    v_mfma_f32_16x16x32_bf16 v[208:211], a[232:235], v[104:107], v[208:211]
    v_exp_f32 v213, v213
    v_mfma_f32_16x16x32_bf16 v[208:211], a[236:239], v[108:111], v[208:211]
    s_mov_b32 s52, s55
    v_exp_f32 v214, v214
    v_exp_f32 v215, v215
    ds_read_b64_tr_b16 a[164:165], v20 offset:8192
    v_cvt_pk_bf16_f32 v142, v212, v213
    ds_read_b64_tr_b16 a[166:167], v20 offset:12288
    v_min_u32 v237, 19, v1
    v_lshl_add_u32 v237, v237, 7, s36
    v_lshl_add_u32 v238, v1, 7, s36
    ds_read_b128 a[220:223], v11 offset:16384
    v_cvt_pk_bf16_f32 v143, v214, v215
    buffer_load_dword v217, v57, s[32:35], s37 offen
    v_mfma_f32_16x16x32_bf16 v[212:215], a[224:227], v[112:115], v[204:207]
    v_mfma_f32_16x16x32_bf16 v[212:215], a[228:231], v[116:119], v[212:215]
    v_exp_f32 v208, v208
    v_mfma_f32_16x16x32_bf16 v[212:215], a[232:235], v[120:123], v[212:215]
    s_mul_i32 s37, s5, 18432
    v_exp_f32 v209, v209
    v_mfma_f32_16x16x32_bf16 v[212:215], a[236:239], v[124:127], v[212:215]
    s_add_u32 s37, s37, s45
    v_exp_f32 v210, v210
    v_exp_f32 v211, v211
    ds_read_b64_tr_b16 a[168:169], v21 offset:0
    v_cvt_pk_bf16_f32 v150, v208, v209
    ds_read_b64_tr_b16 a[170:171], v21 offset:4096
    v_min_u32 v236, 143, v0
    v_lshl_add_u32 v236, v236, 7, s37
    v_mul_u32_u24 v235, 24, v0
    v_lshrrev_b32 v235, 8, v235
    v_lshl_add_u32 v235, v235, 7, s37
    ds_read_b128 a[224:227], v8 offset:20480
    v_cvt_pk_bf16_f32 v151, v210, v211
    s_waitcnt lgkmcnt(3)
    buffer_load_dwordx4 v38, s[8:11], s40 offen offset:2048 lds
    s_nop 0
    s_nop 0
    s_nop 0
    s_nop 0
    s_nop 0
    s_nop 0
Lattn_loop:
    v_mfma_f32_16x16x32_bf16 v[208:211], a[208:211], v[64:67], v[192:195]
    v_exp_f32 v212, v212
    v_mfma_f32_16x16x32_bf16 v[208:211], a[212:215], v[68:71], v[208:211]
    v_exp_f32 v213, v213
    v_mfma_f32_16x16x32_bf16 v[208:211], a[216:219], v[72:75], v[208:211]
    v_exp_f32 v214, v214
    v_mfma_f32_16x16x32_bf16 v[208:211], a[220:223], v[76:79], v[208:211]
    v_exp_f32 v215, v215
    v_mfma_f32_16x16x32_bf16 a[0:3], a[160:163], v[128:131], a[0:3]
    ds_read_b64_tr_b16 a[172:173], v21 offset:8192
    v_cvt_pk_bf16_f32 v158, v212, v213
    v_mfma_f32_16x16x32_bf16 a[0:3], a[164:167], v[132:135], a[0:3]
    ds_read_b64_tr_b16 a[174:175], v21 offset:12288
    v_mfma_f32_16x16x32_bf16 a[4:7], a[164:167], v[140:143], a[4:7]
    ds_read_b128 a[228:231], v9 offset:20480
    v_cvt_pk_bf16_f32 v159, v214, v215
    v_mfma_f32_16x16x32_bf16 a[4:7], a[160:163], v[136:139], a[4:7]
    v_mfma_f32_16x16x32_bf16 v[212:215], a[208:211], v[80:83], v[196:199]
    v_exp_f32 v208, v208
    v_mfma_f32_16x16x32_bf16 v[212:215], a[212:215], v[84:87], v[212:215]
    v_exp_f32 v209, v209
    v_mfma_f32_16x16x32_bf16 v[212:215], a[216:219], v[88:91], v[212:215]
    v_exp_f32 v210, v210
    v_mfma_f32_16x16x32_bf16 v[212:215], a[220:223], v[92:95], v[212:215]
    v_exp_f32 v211, v211
    v_mfma_f32_16x16x32_bf16 a[8:11], a[160:163], v[144:147], a[8:11]
    ds_read_b64_tr_b16 a[176:177], v22 offset:0
    v_cvt_pk_bf16_f32 v160, v208, v209
    v_mfma_f32_16x16x32_bf16 a[8:11], a[164:167], v[148:151], a[8:11]
    ds_read_b64_tr_b16 a[178:179], v22 offset:4096
    v_mfma_f32_16x16x32_bf16 a[12:15], a[164:167], v[156:159], a[12:15]
    ds_read_b128 a[232:235], v10 offset:20480
    v_cvt_pk_bf16_f32 v161, v210, v211
    v_mfma_f32_16x16x32_bf16 a[12:15], a[160:163], v[152:155], a[12:15]
    s_waitcnt lgkmcnt(3)
    buffer_load_dwordx4 v39, s[8:11], s40 offen offset:3072 lds
    v_mfma_f32_16x16x32_bf16 v[208:211], a[208:211], v[96:99], v[200:203]
    v_exp_f32 v212, v212
    v_mfma_f32_16x16x32_bf16 v[208:211], a[212:215], v[100:103], v[208:211]
    s_add_u32 s40, s40, 16384
    v_exp_f32 v213, v213
    v_mfma_f32_16x16x32_bf16 v[208:211], a[216:219], v[104:107], v[208:211]
    s_mov_b32 m0, s6
    v_exp_f32 v214, v214
    v_mfma_f32_16x16x32_bf16 v[208:211], a[220:223], v[108:111], v[208:211]
    v_exp_f32 v215, v215
    v_mfma_f32_16x16x32_bf16 a[16:19], a[168:171], v[128:131], a[16:19]
    ds_read_b64_tr_b16 a[180:181], v22 offset:8192
    v_cvt_pk_bf16_f32 v168, v212, v213
    v_mfma_f32_16x16x32_bf16 a[16:19], a[172:175], v[132:135], a[16:19]
    ds_read_b64_tr_b16 a[182:183], v22 offset:12288
    v_mfma_f32_16x16x32_bf16 a[20:23], a[172:175], v[140:143], a[20:23]
    ds_read_b128 a[236:239], v11 offset:20480
    v_cvt_pk_bf16_f32 v169, v214, v215
    v_mfma_f32_16x16x32_bf16 a[20:23], a[168:171], v[136:139], a[20:23]
    buffer_load_dwordx4 v254, s[32:35], s57 offen  lds
    v_smfmac_f32_16x16x64_bf16 a[192:195], v[52:55], v[128:135], v50
    v_mfma_f32_16x16x32_bf16 v[212:215], a[208:211], v[112:115], v[204:207]
    v_exp_f32 v208, v208
    v_mfma_f32_16x16x32_bf16 v[212:215], a[212:215], v[116:119], v[212:215]
    s_add_u32 m0, s42, 98304
    v_exp_f32 v209, v209
    v_mfma_f32_16x16x32_bf16 v[212:215], a[216:219], v[120:123], v[212:215]
    v_exp_f32 v210, v210
    v_mfma_f32_16x16x32_bf16 v[212:215], a[220:223], v[124:127], v[212:215]
    v_exp_f32 v211, v211
    v_mfma_f32_16x16x32_bf16 a[24:27], a[168:171], v[144:147], a[24:27]
    ds_read_b64_tr_b16 a[184:185], v23 offset:0
    v_cvt_pk_bf16_f32 v176, v208, v209
    v_mfma_f32_16x16x32_bf16 a[24:27], a[172:175], v[148:151], a[24:27]
    ds_read_b64_tr_b16 a[186:187], v23 offset:4096
    v_mfma_f32_16x16x32_bf16 a[28:31], a[172:175], v[156:159], a[28:31]
    ds_read_b128 a[208:211], v8 offset:24576
    v_cvt_pk_bf16_f32 v177, v210, v211
    v_mfma_f32_16x16x32_bf16 a[28:31], a[168:171], v[152:155], a[28:31]
    s_waitcnt lgkmcnt(3)
    buffer_load_dwordx4 v40, s[12:15], s41 offen lds
    v_mfma_f32_16x16x32_bf16 v[208:211], a[224:227], v[64:67], v[192:195]
    v_exp_f32 v212, v212
    v_mfma_f32_16x16x32_bf16 v[208:211], a[228:231], v[68:71], v[208:211]
    s_add_u32 s6, s6, 4096
    v_exp_f32 v213, v213
    v_mfma_f32_16x16x32_bf16 v[208:211], a[232:235], v[72:75], v[208:211]
    s_add_u32 s57, s57, 589824
    v_exp_f32 v214, v214
    v_mfma_f32_16x16x32_bf16 v[208:211], a[236:239], v[76:79], v[208:211]
    v_exp_f32 v215, v215
    v_mfma_f32_16x16x32_bf16 a[32:35], a[176:179], v[128:131], a[32:35]
    ds_read_b64_tr_b16 a[188:189], v23 offset:8192
    v_cvt_pk_bf16_f32 v184, v212, v213
    v_mfma_f32_16x16x32_bf16 a[32:35], a[180:183], v[132:135], a[32:35]
    ds_read_b64_tr_b16 a[190:191], v23 offset:12288
    v_mfma_f32_16x16x32_bf16 a[36:39], a[180:183], v[140:143], a[36:39]
    ds_read_b128 a[212:215], v9 offset:24576
    v_cvt_pk_bf16_f32 v185, v214, v215
    v_mfma_f32_16x16x32_bf16 a[36:39], a[176:179], v[136:139], a[36:39]
    v_smfmac_f32_16x16x64_bf16 a[196:199], v[52:55], v[136:143], v50
    v_mfma_f32_16x16x32_bf16 v[212:215], a[224:227], v[80:83], v[196:199]
    v_exp_f32 v208, v208
    v_mfma_f32_16x16x32_bf16 v[212:215], a[228:231], v[84:87], v[212:215]
    v_exp_f32 v209, v209
    v_mfma_f32_16x16x32_bf16 v[212:215], a[232:235], v[88:91], v[212:215]
    v_exp_f32 v210, v210
    v_mfma_f32_16x16x32_bf16 v[212:215], a[236:239], v[92:95], v[212:215]
    v_exp_f32 v211, v211
    v_mfma_f32_16x16x32_bf16 a[40:43], a[176:179], v[144:147], a[40:43]
    ds_read_b64_tr_b16 a[160:161], v24 offset:0
    v_cvt_pk_bf16_f32 v162, v208, v209
    v_mfma_f32_16x16x32_bf16 a[40:43], a[180:183], v[148:151], a[40:43]
    ds_read_b64_tr_b16 a[162:163], v24 offset:4096
    v_mfma_f32_16x16x32_bf16 a[44:47], a[180:183], v[156:159], a[44:47]
    ds_read_b128 a[216:219], v10 offset:24576
    v_cvt_pk_bf16_f32 v163, v210, v211
    v_mfma_f32_16x16x32_bf16 a[44:47], a[176:179], v[152:155], a[44:47]
    s_waitcnt lgkmcnt(3)
    buffer_load_dwordx4 v41, s[12:15], s41 offen offset:1024 lds
    v_mfma_f32_16x16x32_bf16 v[208:211], a[224:227], v[96:99], v[200:203]
    v_exp_f32 v212, v212
    v_mfma_f32_16x16x32_bf16 v[208:211], a[228:231], v[100:103], v[208:211]
    v_exp_f32 v213, v213
    v_mfma_f32_16x16x32_bf16 v[208:211], a[232:235], v[104:107], v[208:211]
    v_exp_f32 v214, v214
    v_mfma_f32_16x16x32_bf16 v[208:211], a[236:239], v[108:111], v[208:211]
    v_exp_f32 v215, v215
    v_mfma_f32_16x16x32_bf16 a[48:51], a[184:187], v[128:131], a[48:51]
    ds_read_b64_tr_b16 a[164:165], v24 offset:8192
    v_cvt_pk_bf16_f32 v170, v212, v213
    v_mfma_f32_16x16x32_bf16 a[48:51], a[188:191], v[132:135], a[48:51]
    ds_read_b64_tr_b16 a[166:167], v24 offset:12288
    v_mfma_f32_16x16x32_bf16 a[52:55], a[188:191], v[140:143], a[52:55]
    ds_read_b128 a[220:223], v11 offset:24576
    v_cvt_pk_bf16_f32 v171, v214, v215
    v_mfma_f32_16x16x32_bf16 a[52:55], a[184:187], v[136:139], a[52:55]
    v_smfmac_f32_16x16x64_bf16 a[200:203], v[52:55], v[144:151], v50
    v_mfma_f32_16x16x32_bf16 v[212:215], a[224:227], v[112:115], v[204:207]
    v_exp_f32 v208, v208
    v_mfma_f32_16x16x32_bf16 v[212:215], a[228:231], v[116:119], v[212:215]
    v_exp_f32 v209, v209
    v_mfma_f32_16x16x32_bf16 v[212:215], a[232:235], v[120:123], v[212:215]
    v_exp_f32 v210, v210
    v_mfma_f32_16x16x32_bf16 v[212:215], a[236:239], v[124:127], v[212:215]
    v_exp_f32 v211, v211
    v_mfma_f32_16x16x32_bf16 a[56:59], a[184:187], v[144:147], a[56:59]
    ds_read_b64_tr_b16 a[168:169], v25 offset:0
    v_cvt_pk_bf16_f32 v178, v208, v209
    v_mfma_f32_16x16x32_bf16 a[56:59], a[188:191], v[148:151], a[56:59]
    ds_read_b64_tr_b16 a[170:171], v25 offset:4096
    v_mfma_f32_16x16x32_bf16 a[60:63], a[188:191], v[156:159], a[60:63]
    ds_read_b128 a[224:227], v8 offset:28672
    v_cvt_pk_bf16_f32 v179, v210, v211
    v_mfma_f32_16x16x32_bf16 a[60:63], a[184:187], v[152:155], a[60:63]
    s_waitcnt lgkmcnt(3)
    buffer_load_dwordx4 v40, s[12:15], s41 offen offset:2048 lds
    v_mfma_f32_16x16x32_bf16 v[208:211], a[208:211], v[64:67], v[192:195]
    v_exp_f32 v212, v212
    v_mfma_f32_16x16x32_bf16 v[208:211], a[212:215], v[68:71], v[208:211]
    v_exp_f32 v213, v213
    v_mfma_f32_16x16x32_bf16 v[208:211], a[216:219], v[72:75], v[208:211]
    v_exp_f32 v214, v214
    v_mfma_f32_16x16x32_bf16 v[208:211], a[220:223], v[76:79], v[208:211]
    v_exp_f32 v215, v215
    v_mfma_f32_16x16x32_bf16 a[64:67], a[160:163], v[128:131], a[64:67]
    ds_read_b64_tr_b16 a[172:173], v25 offset:8192
    v_cvt_pk_bf16_f32 v186, v212, v213
    v_mfma_f32_16x16x32_bf16 a[64:67], a[164:167], v[132:135], a[64:67]
    ds_read_b64_tr_b16 a[174:175], v25 offset:12288
    v_mfma_f32_16x16x32_bf16 a[68:71], a[164:167], v[140:143], a[68:71]
    ds_read_b128 a[228:231], v9 offset:28672
    v_cvt_pk_bf16_f32 v187, v214, v215
    v_mfma_f32_16x16x32_bf16 a[68:71], a[160:163], v[136:139], a[68:71]
    v_smfmac_f32_16x16x64_bf16 a[204:207], v[52:55], v[152:159], v50
    v_mfma_f32_16x16x32_bf16 v[212:215], a[208:211], v[80:83], v[196:199]
    v_exp_f32 v208, v208
    v_mfma_f32_16x16x32_bf16 v[212:215], a[212:215], v[84:87], v[212:215]
    v_exp_f32 v209, v209
    v_mfma_f32_16x16x32_bf16 v[212:215], a[216:219], v[88:91], v[212:215]
    v_exp_f32 v210, v210
    v_mfma_f32_16x16x32_bf16 v[212:215], a[220:223], v[92:95], v[212:215]
    v_exp_f32 v211, v211
    v_mfma_f32_16x16x32_bf16 a[72:75], a[160:163], v[144:147], a[72:75]
    ds_read_b64_tr_b16 a[176:177], v26 offset:0
    v_cvt_pk_bf16_f32 v164, v208, v209
    v_mfma_f32_16x16x32_bf16 a[72:75], a[164:167], v[148:151], a[72:75]
    ds_read_b64_tr_b16 a[178:179], v26 offset:4096
    v_mfma_f32_16x16x32_bf16 a[76:79], a[164:167], v[156:159], a[76:79]
    ds_read_b128 a[232:235], v10 offset:28672
    v_cvt_pk_bf16_f32 v165, v210, v211
    v_mfma_f32_16x16x32_bf16 a[76:79], a[160:163], v[152:155], a[76:79]
    s_waitcnt lgkmcnt(3)
    buffer_load_dwordx4 v41, s[12:15], s41 offen offset:3072 lds
    v_mfma_f32_16x16x32_bf16 v[208:211], a[208:211], v[96:99], v[200:203]
    v_exp_f32 v212, v212
    v_mfma_f32_16x16x32_bf16 v[208:211], a[212:215], v[100:103], v[208:211]
    s_add_u32 s41, s41, 16384
    v_exp_f32 v213, v213
    v_mfma_f32_16x16x32_bf16 v[208:211], a[216:219], v[104:107], v[208:211]
    v_exp_f32 v214, v214
    v_mfma_f32_16x16x32_bf16 v[208:211], a[220:223], v[108:111], v[208:211]
    v_exp_f32 v215, v215
    v_mfma_f32_16x16x32_bf16 a[80:83], a[168:171], v[128:131], a[80:83]
    ds_read_b64_tr_b16 a[180:181], v26 offset:8192
    v_cvt_pk_bf16_f32 v172, v212, v213
    v_mfma_f32_16x16x32_bf16 a[80:83], a[172:175], v[132:135], a[80:83]
    ds_read_b64_tr_b16 a[182:183], v26 offset:12288
    v_mfma_f32_16x16x32_bf16 a[84:87], a[172:175], v[140:143], a[84:87]
    ds_read_b128 a[236:239], v11 offset:28672
    v_cvt_pk_bf16_f32 v173, v214, v215
    v_mfma_f32_16x16x32_bf16 a[84:87], a[168:171], v[136:139], a[84:87]
    s_waitcnt vmcnt(10)
    s_barrier
    v_mfma_f32_16x16x32_bf16 v[212:215], a[208:211], v[112:115], v[204:207]
    v_exp_f32 v208, v208
    v_mfma_f32_16x16x32_bf16 v[212:215], a[212:215], v[116:119], v[212:215]
    s_add_u32 m0, s42, 0
    v_exp_f32 v209, v209
    v_mfma_f32_16x16x32_bf16 v[212:215], a[216:219], v[120:123], v[212:215]
    v_exp_f32 v210, v210
    v_mfma_f32_16x16x32_bf16 v[212:215], a[220:223], v[124:127], v[212:215]
    v_exp_f32 v211, v211
    v_mfma_f32_16x16x32_bf16 a[88:91], a[168:171], v[144:147], a[88:91]
    ds_read_b64_tr_b16 a[184:185], v27 offset:0
    v_cvt_pk_bf16_f32 v180, v208, v209
    v_mfma_f32_16x16x32_bf16 a[88:91], a[172:175], v[148:151], a[88:91]
    ds_read_b64_tr_b16 a[186:187], v27 offset:4096
    v_mfma_f32_16x16x32_bf16 a[92:95], a[172:175], v[156:159], a[92:95]
    ds_read_b128 a[208:211], v8 offset:32768
    v_cvt_pk_bf16_f32 v181, v210, v211
    v_mfma_f32_16x16x32_bf16 a[92:95], a[168:171], v[152:155], a[92:95]
    s_waitcnt lgkmcnt(3)
    buffer_load_dwordx4 v36, s[8:11], s40 offen lds
    v_mfma_f32_16x16x32_bf16 v[208:211], a[224:227], v[64:67], v[192:195]
    v_exp_f32 v212, v212
    v_mfma_f32_16x16x32_bf16 v[208:211], a[228:231], v[68:71], v[208:211]
    v_exp_f32 v213, v213
    v_mfma_f32_16x16x32_bf16 v[208:211], a[232:235], v[72:75], v[208:211]
    v_exp_f32 v214, v214
    v_mfma_f32_16x16x32_bf16 v[208:211], a[236:239], v[76:79], v[208:211]
    v_exp_f32 v215, v215
    v_mfma_f32_16x16x32_bf16 a[96:99], a[176:179], v[128:131], a[96:99]
    ds_read_b64_tr_b16 a[188:189], v27 offset:8192
    v_cvt_pk_bf16_f32 v188, v212, v213
    v_mfma_f32_16x16x32_bf16 a[96:99], a[180:183], v[132:135], a[96:99]
    ds_read_b64_tr_b16 a[190:191], v27 offset:12288
    v_mfma_f32_16x16x32_bf16 a[100:103], a[180:183], v[140:143], a[100:103]
    ds_read_b128 a[212:215], v9 offset:32768
    v_cvt_pk_bf16_f32 v189, v214, v215
    v_mfma_f32_16x16x32_bf16 a[100:103], a[176:179], v[136:139], a[100:103]
    v_mfma_f32_16x16x32_bf16 v[212:215], a[224:227], v[80:83], v[196:199]
    v_exp_f32 v208, v208
    v_mfma_f32_16x16x32_bf16 v[212:215], a[228:231], v[84:87], v[212:215]
    v_exp_f32 v209, v209
    v_mfma_f32_16x16x32_bf16 v[212:215], a[232:235], v[88:91], v[212:215]
    v_exp_f32 v210, v210
    v_mfma_f32_16x16x32_bf16 v[212:215], a[236:239], v[92:95], v[212:215]
    v_exp_f32 v211, v211
    v_mfma_f32_16x16x32_bf16 a[104:107], a[176:179], v[144:147], a[104:107]
    ds_read_b64_tr_b16 a[160:161], v20 offset:16384
    v_cvt_pk_bf16_f32 v166, v208, v209
    v_mfma_f32_16x16x32_bf16 a[104:107], a[180:183], v[148:151], a[104:107]
    ds_read_b64_tr_b16 a[162:163], v20 offset:20480
    v_mfma_f32_16x16x32_bf16 a[108:111], a[180:183], v[156:159], a[108:111]
    ds_read_b128 a[216:219], v10 offset:32768
    v_cvt_pk_bf16_f32 v167, v210, v211
    v_mfma_f32_16x16x32_bf16 a[108:111], a[176:179], v[152:155], a[108:111]
    s_waitcnt lgkmcnt(3)
    buffer_load_dwordx4 v37, s[8:11], s40 offen offset:1024 lds
    v_mfma_f32_16x16x32_bf16 v[208:211], a[224:227], v[96:99], v[200:203]
    v_exp_f32 v212, v212
    v_mfma_f32_16x16x32_bf16 v[208:211], a[228:231], v[100:103], v[208:211]
    v_exp_f32 v213, v213
    v_mfma_f32_16x16x32_bf16 v[208:211], a[232:235], v[104:107], v[208:211]
    v_exp_f32 v214, v214
    v_mfma_f32_16x16x32_bf16 v[208:211], a[236:239], v[108:111], v[208:211]
    v_exp_f32 v215, v215
    v_mfma_f32_16x16x32_bf16 a[112:115], a[184:187], v[128:131], a[112:115]
    ds_read_b64_tr_b16 a[164:165], v20 offset:24576
    v_cvt_pk_bf16_f32 v174, v212, v213
    v_mfma_f32_16x16x32_bf16 a[112:115], a[188:191], v[132:135], a[112:115]
    ds_read_b64_tr_b16 a[166:167], v20 offset:28672
    v_mfma_f32_16x16x32_bf16 a[116:119], a[188:191], v[140:143], a[116:119]
    ds_read_b128 a[220:223], v11 offset:32768
    v_cvt_pk_bf16_f32 v175, v214, v215
    v_mfma_f32_16x16x32_bf16 a[116:119], a[184:187], v[136:139], a[116:119]
    buffer_load_dwordx4 v[240:243], v7, s[16:19], s44 offen
    v_mfma_f32_16x16x32_bf16 v[212:215], a[224:227], v[112:115], v[204:207]
    v_exp_f32 v208, v208
    v_mfma_f32_16x16x32_bf16 v[212:215], a[228:231], v[116:119], v[212:215]
    v_exp_f32 v209, v209
    v_mfma_f32_16x16x32_bf16 v[212:215], a[232:235], v[120:123], v[212:215]
    v_exp_f32 v210, v210
    v_mfma_f32_16x16x32_bf16 v[212:215], a[236:239], v[124:127], v[212:215]
    s_add_u32 s44, s44, 884736
    v_exp_f32 v211, v211
    v_mfma_f32_16x16x32_bf16 a[120:123], a[184:187], v[144:147], a[120:123]
    ds_read_b64_tr_b16 a[168:169], v21 offset:16384
    v_cvt_pk_bf16_f32 v182, v208, v209
    v_mfma_f32_16x16x32_bf16 a[120:123], a[188:191], v[148:151], a[120:123]
    ds_read_b64_tr_b16 a[170:171], v21 offset:20480
    v_mfma_f32_16x16x32_bf16 a[124:127], a[188:191], v[156:159], a[124:127]
    ds_read_b128 a[224:227], v8 offset:36864
    v_cvt_pk_bf16_f32 v183, v210, v211
    v_mfma_f32_16x16x32_bf16 a[124:127], a[184:187], v[152:155], a[124:127]
    s_waitcnt lgkmcnt(3)
    buffer_load_dwordx4 v38, s[8:11], s40 offen offset:2048 lds
    v_mfma_f32_16x16x32_bf16 v[208:211], a[208:211], v[64:67], v[192:195]
    v_exp_f32 v212, v212
    v_mfma_f32_16x16x32_bf16 v[208:211], a[212:215], v[68:71], v[208:211]
    v_exp_f32 v213, v213
    v_mfma_f32_16x16x32_bf16 v[208:211], a[216:219], v[72:75], v[208:211]
    v_exp_f32 v214, v214
    v_mfma_f32_16x16x32_bf16 v[208:211], a[220:223], v[76:79], v[208:211]
    v_exp_f32 v215, v215
    v_mfma_f32_16x16x32_bf16 a[0:3], a[160:163], v[160:163], a[0:3]
    ds_read_b64_tr_b16 a[172:173], v21 offset:24576
    v_cvt_pk_bf16_f32 v190, v212, v213
    v_mfma_f32_16x16x32_bf16 a[0:3], a[164:167], v[164:167], a[0:3]
Ltour0_4:
    s_cbranch_execz Ltour0_8
    ds_read_b64_tr_b16 a[174:175], v21 offset:28672
    v_mfma_f32_16x16x32_bf16 a[4:7], a[164:167], v[172:175], a[4:7]
    ds_read_b128 a[228:231], v9 offset:36864
    v_cvt_pk_bf16_f32 v191, v214, v215
    v_mfma_f32_16x16x32_bf16 a[4:7], a[160:163], v[168:171], a[4:7]
    v_mfma_f32_16x16x32_bf16 v[212:215], a[208:211], v[80:83], v[196:199]
    v_exp_f32 v208, v208
    v_mfma_f32_16x16x32_bf16 v[212:215], a[212:215], v[84:87], v[212:215]
    v_exp_f32 v209, v209
    v_mfma_f32_16x16x32_bf16 v[212:215], a[216:219], v[88:91], v[212:215]
    v_exp_f32 v210, v210
    v_mfma_f32_16x16x32_bf16 v[212:215], a[220:223], v[92:95], v[212:215]
    v_exp_f32 v211, v211
    v_mfma_f32_16x16x32_bf16 a[8:11], a[160:163], v[176:179], a[8:11]
    ds_read_b64_tr_b16 a[176:177], v22 offset:16384
    v_cvt_pk_bf16_f32 v128, v208, v209
    v_mfma_f32_16x16x32_bf16 a[8:11], a[164:167], v[180:183], a[8:11]
    ds_read_b64_tr_b16 a[178:179], v22 offset:20480
    v_mfma_f32_16x16x32_bf16 a[12:15], a[164:167], v[188:191], a[12:15]
    ds_read_b128 a[232:235], v10 offset:36864
    v_cvt_pk_bf16_f32 v129, v210, v211
    v_mfma_f32_16x16x32_bf16 a[12:15], a[160:163], v[184:187], a[12:15]
    s_waitcnt lgkmcnt(3)
    buffer_load_dwordx4 v39, s[8:11], s40 offen offset:3072 lds
    v_mfma_f32_16x16x32_bf16 v[208:211], a[208:211], v[96:99], v[200:203]
    v_exp_f32 v212, v212
    v_mfma_f32_16x16x32_bf16 v[208:211], a[212:215], v[100:103], v[208:211]
    s_add_u32 s40, s40, 16384
    v_exp_f32 v213, v213
    v_mfma_f32_16x16x32_bf16 v[208:211], a[216:219], v[104:107], v[208:211]
    v_exp_f32 v214, v214
    v_mfma_f32_16x16x32_bf16 v[208:211], a[220:223], v[108:111], v[208:211]
    v_exp_f32 v215, v215
    v_mfma_f32_16x16x32_bf16 a[16:19], a[168:171], v[160:163], a[16:19]
    ds_read_b64_tr_b16 a[180:181], v22 offset:24576
    v_cvt_pk_bf16_f32 v136, v212, v213
    v_mfma_f32_16x16x32_bf16 a[16:19], a[172:175], v[164:167], a[16:19]
    ds_read_b64_tr_b16 a[182:183], v22 offset:28672
    v_mfma_f32_16x16x32_bf16 a[20:23], a[172:175], v[172:175], a[20:23]
    ds_read_b128 a[236:239], v11 offset:36864
    v_cvt_pk_bf16_f32 v137, v214, v215
    v_mfma_f32_16x16x32_bf16 a[20:23], a[168:171], v[168:171], a[20:23]
    v_smfmac_f32_16x16x64_bf16 a[192:195], v[52:55], v[160:167], v50
    v_mfma_f32_16x16x32_bf16 v[212:215], a[208:211], v[112:115], v[204:207]
    v_exp_f32 v208, v208
    v_mfma_f32_16x16x32_bf16 v[212:215], a[212:215], v[116:119], v[212:215]
    s_add_u32 m0, s42, 114688
    v_exp_f32 v209, v209
    v_mfma_f32_16x16x32_bf16 v[212:215], a[216:219], v[120:123], v[212:215]
    v_exp_f32 v210, v210
    v_mfma_f32_16x16x32_bf16 v[212:215], a[220:223], v[124:127], v[212:215]
    v_exp_f32 v211, v211
    v_mfma_f32_16x16x32_bf16 a[24:27], a[168:171], v[176:179], a[24:27]
    ds_read_b64_tr_b16 a[184:185], v23 offset:16384
    v_cvt_pk_bf16_f32 v144, v208, v209
    v_mfma_f32_16x16x32_bf16 a[24:27], a[172:175], v[180:183], a[24:27]
    ds_read_b64_tr_b16 a[186:187], v23 offset:20480
    v_mfma_f32_16x16x32_bf16 a[28:31], a[172:175], v[188:191], a[28:31]
    ds_read_b128 a[208:211], v8 offset:40960
    v_cvt_pk_bf16_f32 v145, v210, v211
    v_mfma_f32_16x16x32_bf16 a[28:31], a[168:171], v[184:187], a[28:31]
    s_waitcnt lgkmcnt(3)
    buffer_load_dwordx4 v40, s[12:15], s41 offen lds
    v_mfma_f32_16x16x32_bf16 v[208:211], a[224:227], v[64:67], v[192:195]
    v_exp_f32 v212, v212
    v_mfma_f32_16x16x32_bf16 v[208:211], a[228:231], v[68:71], v[208:211]
    v_exp_f32 v213, v213
    v_mfma_f32_16x16x32_bf16 v[208:211], a[232:235], v[72:75], v[208:211]
    v_exp_f32 v214, v214
    v_mfma_f32_16x16x32_bf16 v[208:211], a[236:239], v[76:79], v[208:211]
    v_exp_f32 v215, v215
    v_mfma_f32_16x16x32_bf16 a[32:35], a[176:179], v[160:163], a[32:35]
    ds_read_b64_tr_b16 a[188:189], v23 offset:24576
    v_cvt_pk_bf16_f32 v152, v212, v213
    v_mfma_f32_16x16x32_bf16 a[32:35], a[180:183], v[164:167], a[32:35]
    ds_read_b64_tr_b16 a[190:191], v23 offset:28672
    v_mfma_f32_16x16x32_bf16 a[36:39], a[180:183], v[172:175], a[36:39]
    ds_read_b128 a[212:215], v9 offset:40960
    v_cvt_pk_bf16_f32 v153, v214, v215
    v_mfma_f32_16x16x32_bf16 a[36:39], a[176:179], v[168:171], a[36:39]
    v_smfmac_f32_16x16x64_bf16 a[196:199], v[52:55], v[168:175], v50
    v_mfma_f32_16x16x32_bf16 v[212:215], a[224:227], v[80:83], v[196:199]
    v_exp_f32 v208, v208
    v_mfma_f32_16x16x32_bf16 v[212:215], a[228:231], v[84:87], v[212:215]
    v_exp_f32 v209, v209
    v_mfma_f32_16x16x32_bf16 v[212:215], a[232:235], v[88:91], v[212:215]
    v_exp_f32 v210, v210
    v_mfma_f32_16x16x32_bf16 v[212:215], a[236:239], v[92:95], v[212:215]
    v_exp_f32 v211, v211
    v_mfma_f32_16x16x32_bf16 a[40:43], a[176:179], v[176:179], a[40:43]
    ds_read_b64_tr_b16 a[160:161], v24 offset:16384
    v_cvt_pk_bf16_f32 v130, v208, v209
    v_mfma_f32_16x16x32_bf16 a[40:43], a[180:183], v[180:183], a[40:43]
    ds_read_b64_tr_b16 a[162:163], v24 offset:20480
    v_mfma_f32_16x16x32_bf16 a[44:47], a[180:183], v[188:191], a[44:47]
    ds_read_b128 a[216:219], v10 offset:40960
    v_cvt_pk_bf16_f32 v131, v210, v211
    v_mfma_f32_16x16x32_bf16 a[44:47], a[176:179], v[184:187], a[44:47]
    s_waitcnt lgkmcnt(3)
    buffer_load_dwordx4 v41, s[12:15], s41 offen offset:1024 lds
    v_mfma_f32_16x16x32_bf16 v[208:211], a[224:227], v[96:99], v[200:203]
    v_exp_f32 v212, v212
    v_mfma_f32_16x16x32_bf16 v[208:211], a[228:231], v[100:103], v[208:211]
    v_exp_f32 v213, v213
    v_mfma_f32_16x16x32_bf16 v[208:211], a[232:235], v[104:107], v[208:211]
    v_exp_f32 v214, v214
    v_mfma_f32_16x16x32_bf16 v[208:211], a[236:239], v[108:111], v[208:211]
    v_exp_f32 v215, v215
    v_mfma_f32_16x16x32_bf16 a[48:51], a[184:187], v[160:163], a[48:51]
    ds_read_b64_tr_b16 a[164:165], v24 offset:24576
    v_cvt_pk_bf16_f32 v138, v212, v213
    v_mfma_f32_16x16x32_bf16 a[48:51], a[188:191], v[164:167], a[48:51]
    ds_read_b64_tr_b16 a[166:167], v24 offset:28672
    v_mfma_f32_16x16x32_bf16 a[52:55], a[188:191], v[172:175], a[52:55]
    ds_read_b128 a[220:223], v11 offset:40960
    v_cvt_pk_bf16_f32 v139, v214, v215
    v_mfma_f32_16x16x32_bf16 a[52:55], a[184:187], v[168:171], a[52:55]
    v_smfmac_f32_16x16x64_bf16 a[200:203], v[52:55], v[176:183], v50
    v_mfma_f32_16x16x32_bf16 v[212:215], a[224:227], v[112:115], v[204:207]
    v_exp_f32 v208, v208
    v_mfma_f32_16x16x32_bf16 v[212:215], a[228:231], v[116:119], v[212:215]
    v_exp_f32 v209, v209
    v_mfma_f32_16x16x32_bf16 v[212:215], a[232:235], v[120:123], v[212:215]
    v_exp_f32 v210, v210
    v_mfma_f32_16x16x32_bf16 v[212:215], a[236:239], v[124:127], v[212:215]
    v_exp_f32 v211, v211
    v_mfma_f32_16x16x32_bf16 a[56:59], a[184:187], v[176:179], a[56:59]
    ds_read_b64_tr_b16 a[168:169], v25 offset:16384
    v_cvt_pk_bf16_f32 v146, v208, v209
    v_mfma_f32_16x16x32_bf16 a[56:59], a[188:191], v[180:183], a[56:59]
    ds_read_b64_tr_b16 a[170:171], v25 offset:20480
    v_mfma_f32_16x16x32_bf16 a[60:63], a[188:191], v[188:191], a[60:63]
    ds_read_b128 a[224:227], v8 offset:45056
    v_cvt_pk_bf16_f32 v147, v210, v211
    v_mfma_f32_16x16x32_bf16 a[60:63], a[184:187], v[184:187], a[60:63]
    s_waitcnt lgkmcnt(3)
    buffer_load_dwordx4 v40, s[12:15], s41 offen offset:2048 lds
    v_mfma_f32_16x16x32_bf16 v[208:211], a[208:211], v[64:67], v[192:195]
    v_exp_f32 v212, v212
    v_mfma_f32_16x16x32_bf16 v[208:211], a[212:215], v[68:71], v[208:211]
    v_exp_f32 v213, v213
    v_mfma_f32_16x16x32_bf16 v[208:211], a[216:219], v[72:75], v[208:211]
    v_exp_f32 v214, v214
    v_mfma_f32_16x16x32_bf16 v[208:211], a[220:223], v[76:79], v[208:211]
    v_exp_f32 v215, v215
    v_mfma_f32_16x16x32_bf16 a[64:67], a[160:163], v[160:163], a[64:67]
    ds_read_b64_tr_b16 a[172:173], v25 offset:24576
    v_cvt_pk_bf16_f32 v154, v212, v213
    v_mfma_f32_16x16x32_bf16 a[64:67], a[164:167], v[164:167], a[64:67]
    ds_read_b64_tr_b16 a[174:175], v25 offset:28672
    v_mfma_f32_16x16x32_bf16 a[68:71], a[164:167], v[172:175], a[68:71]
    ds_read_b128 a[228:231], v9 offset:45056
    v_cvt_pk_bf16_f32 v155, v214, v215
    v_mfma_f32_16x16x32_bf16 a[68:71], a[160:163], v[168:171], a[68:71]
    v_smfmac_f32_16x16x64_bf16 a[204:207], v[52:55], v[184:191], v50
    v_mfma_f32_16x16x32_bf16 v[212:215], a[208:211], v[80:83], v[196:199]
    v_exp_f32 v208, v208
    v_mfma_f32_16x16x32_bf16 v[212:215], a[212:215], v[84:87], v[212:215]
    v_exp_f32 v209, v209
    v_mfma_f32_16x16x32_bf16 v[212:215], a[216:219], v[88:91], v[212:215]
    v_exp_f32 v210, v210
    v_mfma_f32_16x16x32_bf16 v[212:215], a[220:223], v[92:95], v[212:215]
    v_exp_f32 v211, v211
    v_mfma_f32_16x16x32_bf16 a[72:75], a[160:163], v[176:179], a[72:75]
    ds_read_b64_tr_b16 a[176:177], v26 offset:16384
    v_cvt_pk_bf16_f32 v132, v208, v209
    v_mfma_f32_16x16x32_bf16 a[72:75], a[164:167], v[180:183], a[72:75]
    ds_read_b64_tr_b16 a[178:179], v26 offset:20480
    v_mfma_f32_16x16x32_bf16 a[76:79], a[164:167], v[188:191], a[76:79]
    ds_read_b128 a[232:235], v10 offset:45056
    v_cvt_pk_bf16_f32 v133, v210, v211
    v_mfma_f32_16x16x32_bf16 a[76:79], a[160:163], v[184:187], a[76:79]
    s_waitcnt lgkmcnt(3)
    buffer_load_dwordx4 v41, s[12:15], s41 offen offset:3072 lds
    v_mfma_f32_16x16x32_bf16 v[208:211], a[208:211], v[96:99], v[200:203]
    v_exp_f32 v212, v212
    v_mfma_f32_16x16x32_bf16 v[208:211], a[212:215], v[100:103], v[208:211]
    s_add_u32 s41, s41, 16384
    v_exp_f32 v213, v213
    v_mfma_f32_16x16x32_bf16 v[208:211], a[216:219], v[104:107], v[208:211]
    v_exp_f32 v214, v214
    v_mfma_f32_16x16x32_bf16 v[208:211], a[220:223], v[108:111], v[208:211]
    v_exp_f32 v215, v215
    v_mfma_f32_16x16x32_bf16 a[80:83], a[168:171], v[160:163], a[80:83]
    ds_read_b64_tr_b16 a[180:181], v26 offset:24576
    v_cvt_pk_bf16_f32 v140, v212, v213
    v_mfma_f32_16x16x32_bf16 a[80:83], a[172:175], v[164:167], a[80:83]
    ds_read_b64_tr_b16 a[182:183], v26 offset:28672
    v_mfma_f32_16x16x32_bf16 a[84:87], a[172:175], v[172:175], a[84:87]
    ds_read_b128 a[236:239], v11 offset:45056
    v_cvt_pk_bf16_f32 v141, v214, v215
    v_mfma_f32_16x16x32_bf16 a[84:87], a[168:171], v[168:171], a[84:87]
    s_waitcnt vmcnt(9)
    s_barrier
    v_mfma_f32_16x16x32_bf16 v[212:215], a[208:211], v[112:115], v[204:207]
    v_exp_f32 v208, v208
    v_mfma_f32_16x16x32_bf16 v[212:215], a[212:215], v[116:119], v[212:215]
    s_add_u32 m0, s42, 16384
    v_exp_f32 v209, v209
    v_mfma_f32_16x16x32_bf16 v[212:215], a[216:219], v[120:123], v[212:215]
    v_exp_f32 v210, v210
    v_mfma_f32_16x16x32_bf16 v[212:215], a[220:223], v[124:127], v[212:215]
    v_exp_f32 v211, v211
    v_mfma_f32_16x16x32_bf16 a[88:91], a[168:171], v[176:179], a[88:91]
    ds_read_b64_tr_b16 a[184:185], v27 offset:16384
    v_cvt_pk_bf16_f32 v148, v208, v209
    v_mfma_f32_16x16x32_bf16 a[88:91], a[172:175], v[180:183], a[88:91]
    ds_read_b64_tr_b16 a[186:187], v27 offset:20480
    v_mfma_f32_16x16x32_bf16 a[92:95], a[172:175], v[188:191], a[92:95]
    ds_read_b128 a[208:211], v8 offset:49152
    v_cvt_pk_bf16_f32 v149, v210, v211
    v_mfma_f32_16x16x32_bf16 a[92:95], a[168:171], v[184:187], a[92:95]
    s_waitcnt lgkmcnt(3)
    buffer_load_dwordx4 v36, s[8:11], s40 offen lds
    v_mfma_f32_16x16x32_bf16 v[208:211], a[224:227], v[64:67], v[192:195]
    v_exp_f32 v212, v212
    v_mfma_f32_16x16x32_bf16 v[208:211], a[228:231], v[68:71], v[208:211]
    v_exp_f32 v213, v213
    v_mfma_f32_16x16x32_bf16 v[208:211], a[232:235], v[72:75], v[208:211]
    v_exp_f32 v214, v214
    v_mfma_f32_16x16x32_bf16 v[208:211], a[236:239], v[76:79], v[208:211]
    v_exp_f32 v215, v215
    v_mfma_f32_16x16x32_bf16 a[96:99], a[176:179], v[160:163], a[96:99]
    ds_read_b64_tr_b16 a[188:189], v27 offset:24576
    v_cvt_pk_bf16_f32 v156, v212, v213
    v_mfma_f32_16x16x32_bf16 a[96:99], a[180:183], v[164:167], a[96:99]
    ds_read_b64_tr_b16 a[190:191], v27 offset:28672
    v_mfma_f32_16x16x32_bf16 a[100:103], a[180:183], v[172:175], a[100:103]
    ds_read_b128 a[212:215], v9 offset:49152
    v_cvt_pk_bf16_f32 v157, v214, v215
    v_mfma_f32_16x16x32_bf16 a[100:103], a[176:179], v[168:171], a[100:103]
    buffer_load_dword v218, v57, s[80:83], s39 offen
    v_mfma_f32_16x16x32_bf16 v[212:215], a[224:227], v[80:83], v[196:199]
    v_exp_f32 v208, v208
    v_mfma_f32_16x16x32_bf16 v[212:215], a[228:231], v[84:87], v[212:215]
    v_exp_f32 v209, v209
    v_mfma_f32_16x16x32_bf16 v[212:215], a[232:235], v[88:91], v[212:215]
    v_exp_f32 v210, v210
    v_mfma_f32_16x16x32_bf16 v[212:215], a[236:239], v[92:95], v[212:215]
    v_exp_f32 v211, v211
    v_mfma_f32_16x16x32_bf16 a[104:107], a[176:179], v[176:179], a[104:107]
    ds_read_b64_tr_b16 a[160:161], v20 offset:32768
    v_cvt_pk_bf16_f32 v134, v208, v209
    v_mfma_f32_16x16x32_bf16 a[104:107], a[180:183], v[180:183], a[104:107]
    ds_read_b64_tr_b16 a[162:163], v20 offset:36864
    v_mfma_f32_16x16x32_bf16 a[108:111], a[180:183], v[188:191], a[108:111]
    ds_read_b128 a[216:219], v10 offset:49152
    v_cvt_pk_bf16_f32 v135, v210, v211
    v_mfma_f32_16x16x32_bf16 a[108:111], a[176:179], v[184:187], a[108:111]
    s_waitcnt lgkmcnt(3)
    buffer_load_dwordx4 v37, s[8:11], s40 offen offset:1024 lds
    v_mfma_f32_16x16x32_bf16 v[208:211], a[224:227], v[96:99], v[200:203]
    v_exp_f32 v212, v212
    v_mfma_f32_16x16x32_bf16 v[208:211], a[228:231], v[100:103], v[208:211]
    v_exp_f32 v213, v213
    v_mfma_f32_16x16x32_bf16 v[208:211], a[232:235], v[104:107], v[208:211]
    v_exp_f32 v214, v214
    v_mfma_f32_16x16x32_bf16 v[208:211], a[236:239], v[108:111], v[208:211]
    v_exp_f32 v215, v215
    v_mfma_f32_16x16x32_bf16 a[112:115], a[184:187], v[160:163], a[112:115]
    ds_read_b64_tr_b16 a[164:165], v20 offset:40960
    v_cvt_pk_bf16_f32 v142, v212, v213
    v_mfma_f32_16x16x32_bf16 a[112:115], a[188:191], v[164:167], a[112:115]
    ds_read_b64_tr_b16 a[166:167], v20 offset:45056
    v_mfma_f32_16x16x32_bf16 a[116:119], a[188:191], v[172:175], a[116:119]
    ds_read_b128 a[220:223], v11 offset:49152
    v_cvt_pk_bf16_f32 v143, v214, v215
    v_mfma_f32_16x16x32_bf16 a[116:119], a[184:187], v[168:171], a[116:119]
    buffer_store_dwordx4 v[248:251], v232, s[24:27], s53 offen sc1
    v_mfma_f32_16x16x32_bf16 v[212:215], a[224:227], v[112:115], v[204:207]
    v_exp_f32 v208, v208
    v_mfma_f32_16x16x32_bf16 v[212:215], a[228:231], v[116:119], v[212:215]
    v_exp_f32 v209, v209
    v_mfma_f32_16x16x32_bf16 v[212:215], a[232:235], v[120:123], v[212:215]
    v_exp_f32 v210, v210
    v_mfma_f32_16x16x32_bf16 v[212:215], a[236:239], v[124:127], v[212:215]
    s_add_u32 s53, s53, 656
    v_exp_f32 v211, v211
    v_mfma_f32_16x16x32_bf16 a[120:123], a[184:187], v[176:179], a[120:123]
    ds_read_b64_tr_b16 a[168:169], v21 offset:32768
    v_cvt_pk_bf16_f32 v150, v208, v209
    v_mfma_f32_16x16x32_bf16 a[120:123], a[188:191], v[180:183], a[120:123]
    ds_read_b64_tr_b16 a[170:171], v21 offset:36864
    v_mfma_f32_16x16x32_bf16 a[124:127], a[188:191], v[188:191], a[124:127]
    ds_read_b128 a[224:227], v8 offset:53248
    v_cvt_pk_bf16_f32 v151, v210, v211
    v_mfma_f32_16x16x32_bf16 a[124:127], a[184:187], v[184:187], a[124:127]
    s_waitcnt lgkmcnt(3)
    buffer_load_dwordx4 v38, s[8:11], s40 offen offset:2048 lds
    v_mfma_f32_16x16x32_bf16 v[208:211], a[208:211], v[64:67], v[192:195]
    v_exp_f32 v212, v212
    v_mfma_f32_16x16x32_bf16 v[208:211], a[212:215], v[68:71], v[208:211]
    v_exp_f32 v213, v213
    v_mfma_f32_16x16x32_bf16 v[208:211], a[216:219], v[72:75], v[208:211]
    v_exp_f32 v214, v214
    v_mfma_f32_16x16x32_bf16 v[208:211], a[220:223], v[76:79], v[208:211]
    v_exp_f32 v215, v215
    v_mfma_f32_16x16x32_bf16 a[0:3], a[160:163], v[128:131], a[0:3]
    ds_read_b64_tr_b16 a[172:173], v21 offset:40960
    v_cvt_pk_bf16_f32 v158, v212, v213
    v_mfma_f32_16x16x32_bf16 a[0:3], a[164:167], v[132:135], a[0:3]
    ds_read_b64_tr_b16 a[174:175], v21 offset:45056
    v_mfma_f32_16x16x32_bf16 a[4:7], a[164:167], v[140:143], a[4:7]
    ds_read_b128 a[228:231], v9 offset:53248
    v_cvt_pk_bf16_f32 v159, v214, v215
    v_mfma_f32_16x16x32_bf16 a[4:7], a[160:163], v[136:139], a[4:7]
    v_mfma_f32_16x16x32_bf16 v[212:215], a[208:211], v[80:83], v[196:199]
    v_exp_f32 v208, v208
    v_mfma_f32_16x16x32_bf16 v[212:215], a[212:215], v[84:87], v[212:215]
    v_exp_f32 v209, v209
    v_mfma_f32_16x16x32_bf16 v[212:215], a[216:219], v[88:91], v[212:215]
    v_exp_f32 v210, v210
    v_mfma_f32_16x16x32_bf16 v[212:215], a[220:223], v[92:95], v[212:215]
    v_exp_f32 v211, v211
    v_mfma_f32_16x16x32_bf16 a[8:11], a[160:163], v[144:147], a[8:11]
    ds_read_b64_tr_b16 a[176:177], v22 offset:32768
    v_cvt_pk_bf16_f32 v160, v208, v209
    v_mfma_f32_16x16x32_bf16 a[8:11], a[164:167], v[148:151], a[8:11]
    ds_read_b64_tr_b16 a[178:179], v22 offset:36864
    v_mfma_f32_16x16x32_bf16 a[12:15], a[164:167], v[156:159], a[12:15]
    ds_read_b128 a[232:235], v10 offset:53248
    v_cvt_pk_bf16_f32 v161, v210, v211
    v_mfma_f32_16x16x32_bf16 a[12:15], a[160:163], v[152:155], a[12:15]
    s_waitcnt lgkmcnt(3)
    buffer_load_dwordx4 v39, s[8:11], s40 offen offset:3072 lds
    v_mfma_f32_16x16x32_bf16 v[208:211], a[208:211], v[96:99], v[200:203]
    v_exp_f32 v212, v212
    v_mfma_f32_16x16x32_bf16 v[208:211], a[212:215], v[100:103], v[208:211]
    s_add_u32 s40, s40, 16384
    v_exp_f32 v213, v213
    v_mfma_f32_16x16x32_bf16 v[208:211], a[216:219], v[104:107], v[208:211]
    v_exp_f32 v214, v214
    v_mfma_f32_16x16x32_bf16 v[208:211], a[220:223], v[108:111], v[208:211]
    v_exp_f32 v215, v215
    v_mfma_f32_16x16x32_bf16 a[16:19], a[168:171], v[128:131], a[16:19]
    ds_read_b64_tr_b16 a[180:181], v22 offset:40960
    v_cvt_pk_bf16_f32 v168, v212, v213
    v_mfma_f32_16x16x32_bf16 a[16:19], a[172:175], v[132:135], a[16:19]
    ds_read_b64_tr_b16 a[182:183], v22 offset:45056
    v_mfma_f32_16x16x32_bf16 a[20:23], a[172:175], v[140:143], a[20:23]
    ds_read_b128 a[236:239], v11 offset:53248
    v_cvt_pk_bf16_f32 v169, v214, v215
    v_mfma_f32_16x16x32_bf16 a[20:23], a[168:171], v[136:139], a[20:23]
    v_smfmac_f32_16x16x64_bf16 a[192:195], v[52:55], v[128:135], v50
    v_mfma_f32_16x16x32_bf16 v[212:215], a[208:211], v[112:115], v[204:207]
    v_exp_f32 v208, v208
    v_mfma_f32_16x16x32_bf16 v[212:215], a[212:215], v[116:119], v[212:215]
    s_add_u32 m0, s42, 65536
    v_exp_f32 v209, v209
    v_mfma_f32_16x16x32_bf16 v[212:215], a[216:219], v[120:123], v[212:215]
    v_exp_f32 v210, v210
    v_mfma_f32_16x16x32_bf16 v[212:215], a[220:223], v[124:127], v[212:215]
    v_exp_f32 v211, v211
    v_mfma_f32_16x16x32_bf16 a[24:27], a[168:171], v[144:147], a[24:27]
    ds_read_b64_tr_b16 a[184:185], v23 offset:32768
    v_cvt_pk_bf16_f32 v176, v208, v209
    v_mfma_f32_16x16x32_bf16 a[24:27], a[172:175], v[148:151], a[24:27]
    ds_read_b64_tr_b16 a[186:187], v23 offset:36864
    v_mfma_f32_16x16x32_bf16 a[28:31], a[172:175], v[156:159], a[28:31]
    ds_read_b128 a[208:211], v8 offset:57344
    v_cvt_pk_bf16_f32 v177, v210, v211
    v_mfma_f32_16x16x32_bf16 a[28:31], a[168:171], v[152:155], a[28:31]
    s_waitcnt lgkmcnt(3)
    buffer_load_dwordx4 v40, s[12:15], s41 offen lds
    v_mfma_f32_16x16x32_bf16 v[208:211], a[224:227], v[64:67], v[192:195]
    v_exp_f32 v212, v212
    v_mfma_f32_16x16x32_bf16 v[208:211], a[228:231], v[68:71], v[208:211]
    v_exp_f32 v213, v213
    v_mfma_f32_16x16x32_bf16 v[208:211], a[232:235], v[72:75], v[208:211]
    v_exp_f32 v214, v214
    v_mfma_f32_16x16x32_bf16 v[208:211], a[236:239], v[76:79], v[208:211]
    v_exp_f32 v215, v215
    v_mfma_f32_16x16x32_bf16 a[32:35], a[176:179], v[128:131], a[32:35]
    ds_read_b64_tr_b16 a[188:189], v23 offset:40960
    v_cvt_pk_bf16_f32 v184, v212, v213
    v_mfma_f32_16x16x32_bf16 a[32:35], a[180:183], v[132:135], a[32:35]
    ds_read_b64_tr_b16 a[190:191], v23 offset:45056
    v_mfma_f32_16x16x32_bf16 a[36:39], a[180:183], v[140:143], a[36:39]
    ds_read_b128 a[212:215], v9 offset:57344
    v_cvt_pk_bf16_f32 v185, v214, v215
    v_mfma_f32_16x16x32_bf16 a[36:39], a[176:179], v[136:139], a[36:39]
    v_smfmac_f32_16x16x64_bf16 a[196:199], v[52:55], v[136:143], v50
    v_mfma_f32_16x16x32_bf16 v[212:215], a[224:227], v[80:83], v[196:199]
    v_exp_f32 v208, v208
    v_mfma_f32_16x16x32_bf16 v[212:215], a[228:231], v[84:87], v[212:215]
    v_exp_f32 v209, v209
    v_mfma_f32_16x16x32_bf16 v[212:215], a[232:235], v[88:91], v[212:215]
    v_exp_f32 v210, v210
    v_mfma_f32_16x16x32_bf16 v[212:215], a[236:239], v[92:95], v[212:215]
    v_exp_f32 v211, v211
    v_mfma_f32_16x16x32_bf16 a[40:43], a[176:179], v[144:147], a[40:43]
    ds_read_b64_tr_b16 a[160:161], v24 offset:32768
    v_cvt_pk_bf16_f32 v162, v208, v209
    v_mfma_f32_16x16x32_bf16 a[40:43], a[180:183], v[148:151], a[40:43]
    ds_read_b64_tr_b16 a[162:163], v24 offset:36864
    v_mfma_f32_16x16x32_bf16 a[44:47], a[180:183], v[156:159], a[44:47]
    ds_read_b128 a[216:219], v10 offset:57344
    v_cvt_pk_bf16_f32 v163, v210, v211
    v_mfma_f32_16x16x32_bf16 a[44:47], a[176:179], v[152:155], a[44:47]
    s_waitcnt lgkmcnt(3)
    buffer_load_dwordx4 v41, s[12:15], s41 offen offset:1024 lds
    v_mfma_f32_16x16x32_bf16 v[208:211], a[224:227], v[96:99], v[200:203]
    v_exp_f32 v212, v212
    v_mfma_f32_16x16x32_bf16 v[208:211], a[228:231], v[100:103], v[208:211]
    v_exp_f32 v213, v213
    v_mfma_f32_16x16x32_bf16 v[208:211], a[232:235], v[104:107], v[208:211]
    v_exp_f32 v214, v214
    v_mfma_f32_16x16x32_bf16 v[208:211], a[236:239], v[108:111], v[208:211]
    v_exp_f32 v215, v215
    v_mfma_f32_16x16x32_bf16 a[48:51], a[184:187], v[128:131], a[48:51]
    ds_read_b64_tr_b16 a[164:165], v24 offset:40960
    v_cvt_pk_bf16_f32 v170, v212, v213
    v_mfma_f32_16x16x32_bf16 a[48:51], a[188:191], v[132:135], a[48:51]
    ds_read_b64_tr_b16 a[166:167], v24 offset:45056
    v_mfma_f32_16x16x32_bf16 a[52:55], a[188:191], v[140:143], a[52:55]
    ds_read_b128 a[220:223], v11 offset:57344
    v_cvt_pk_bf16_f32 v171, v214, v215
    v_mfma_f32_16x16x32_bf16 a[52:55], a[184:187], v[136:139], a[52:55]
    v_smfmac_f32_16x16x64_bf16 a[200:203], v[52:55], v[144:151], v50
    v_mfma_f32_16x16x32_bf16 v[212:215], a[224:227], v[112:115], v[204:207]
    v_exp_f32 v208, v208
    v_mfma_f32_16x16x32_bf16 v[212:215], a[228:231], v[116:119], v[212:215]
    v_exp_f32 v209, v209
    v_mfma_f32_16x16x32_bf16 v[212:215], a[232:235], v[120:123], v[212:215]
    v_exp_f32 v210, v210
    v_mfma_f32_16x16x32_bf16 v[212:215], a[236:239], v[124:127], v[212:215]
    v_exp_f32 v211, v211
    v_mfma_f32_16x16x32_bf16 a[56:59], a[184:187], v[144:147], a[56:59]
    ds_read_b64_tr_b16 a[168:169], v25 offset:32768
    v_cvt_pk_bf16_f32 v178, v208, v209
    v_mfma_f32_16x16x32_bf16 a[56:59], a[188:191], v[148:151], a[56:59]
    ds_read_b64_tr_b16 a[170:171], v25 offset:36864
    v_mfma_f32_16x16x32_bf16 a[60:63], a[188:191], v[156:159], a[60:63]
    ds_read_b128 a[224:227], v8 offset:61440
    v_cvt_pk_bf16_f32 v179, v210, v211
    v_mfma_f32_16x16x32_bf16 a[60:63], a[184:187], v[152:155], a[60:63]
    s_waitcnt lgkmcnt(3)
    buffer_load_dwordx4 v40, s[12:15], s41 offen offset:2048 lds
    v_mfma_f32_16x16x32_bf16 v[208:211], a[208:211], v[64:67], v[192:195]
    v_exp_f32 v212, v212
    v_mfma_f32_16x16x32_bf16 v[208:211], a[212:215], v[68:71], v[208:211]
    v_exp_f32 v213, v213
    v_mfma_f32_16x16x32_bf16 v[208:211], a[216:219], v[72:75], v[208:211]
    v_exp_f32 v214, v214
    v_mfma_f32_16x16x32_bf16 v[208:211], a[220:223], v[76:79], v[208:211]
    v_exp_f32 v215, v215
    v_mfma_f32_16x16x32_bf16 a[64:67], a[160:163], v[128:131], a[64:67]
    ds_read_b64_tr_b16 a[172:173], v25 offset:40960
    v_cvt_pk_bf16_f32 v186, v212, v213
    v_mfma_f32_16x16x32_bf16 a[64:67], a[164:167], v[132:135], a[64:67]
    ds_read_b64_tr_b16 a[174:175], v25 offset:45056
    v_mfma_f32_16x16x32_bf16 a[68:71], a[164:167], v[140:143], a[68:71]
    ds_read_b128 a[228:231], v9 offset:61440
    v_cvt_pk_bf16_f32 v187, v214, v215
    v_mfma_f32_16x16x32_bf16 a[68:71], a[160:163], v[136:139], a[68:71]
    v_smfmac_f32_16x16x64_bf16 a[204:207], v[52:55], v[152:159], v50
    v_mfma_f32_16x16x32_bf16 v[212:215], a[208:211], v[80:83], v[196:199]
    v_exp_f32 v208, v208
    v_mfma_f32_16x16x32_bf16 v[212:215], a[212:215], v[84:87], v[212:215]
    v_exp_f32 v209, v209
    v_mfma_f32_16x16x32_bf16 v[212:215], a[216:219], v[88:91], v[212:215]
    v_exp_f32 v210, v210
    v_mfma_f32_16x16x32_bf16 v[212:215], a[220:223], v[92:95], v[212:215]
    v_exp_f32 v211, v211
    v_mfma_f32_16x16x32_bf16 a[72:75], a[160:163], v[144:147], a[72:75]
    ds_read_b64_tr_b16 a[176:177], v26 offset:32768
    v_cvt_pk_bf16_f32 v164, v208, v209
    v_mfma_f32_16x16x32_bf16 a[72:75], a[164:167], v[148:151], a[72:75]
    ds_read_b64_tr_b16 a[178:179], v26 offset:36864
    v_mfma_f32_16x16x32_bf16 a[76:79], a[164:167], v[156:159], a[76:79]
    ds_read_b128 a[232:235], v10 offset:61440
    v_cvt_pk_bf16_f32 v165, v210, v211
    v_mfma_f32_16x16x32_bf16 a[76:79], a[160:163], v[152:155], a[76:79]
    s_waitcnt lgkmcnt(3)
    buffer_load_dwordx4 v41, s[12:15], s41 offen offset:3072 lds
    v_mfma_f32_16x16x32_bf16 v[208:211], a[208:211], v[96:99], v[200:203]
    v_exp_f32 v212, v212
    v_mfma_f32_16x16x32_bf16 v[208:211], a[212:215], v[100:103], v[208:211]
    s_add_u32 s41, s41, 16384
    v_exp_f32 v213, v213
    v_mfma_f32_16x16x32_bf16 v[208:211], a[216:219], v[104:107], v[208:211]
    v_exp_f32 v214, v214
    v_mfma_f32_16x16x32_bf16 v[208:211], a[220:223], v[108:111], v[208:211]
    v_exp_f32 v215, v215
    v_mfma_f32_16x16x32_bf16 a[80:83], a[168:171], v[128:131], a[80:83]
    ds_read_b64_tr_b16 a[180:181], v26 offset:40960
    v_cvt_pk_bf16_f32 v172, v212, v213
    v_mfma_f32_16x16x32_bf16 a[80:83], a[172:175], v[132:135], a[80:83]
    ds_read_b64_tr_b16 a[182:183], v26 offset:45056
    v_mfma_f32_16x16x32_bf16 a[84:87], a[172:175], v[140:143], a[84:87]
    ds_read_b128 a[236:239], v11 offset:61440
    v_cvt_pk_bf16_f32 v173, v214, v215
    v_mfma_f32_16x16x32_bf16 a[84:87], a[168:171], v[136:139], a[84:87]
    s_waitcnt vmcnt(10)
    s_barrier
    v_mfma_f32_16x16x32_bf16 v[212:215], a[208:211], v[112:115], v[204:207]
    v_exp_f32 v208, v208
    v_mfma_f32_16x16x32_bf16 v[212:215], a[212:215], v[116:119], v[212:215]
    s_add_u32 m0, s42, 32768
    v_exp_f32 v209, v209
    v_mfma_f32_16x16x32_bf16 v[212:215], a[216:219], v[120:123], v[212:215]
    v_exp_f32 v210, v210
    v_mfma_f32_16x16x32_bf16 v[212:215], a[220:223], v[124:127], v[212:215]
    v_exp_f32 v211, v211
    v_mfma_f32_16x16x32_bf16 a[88:91], a[168:171], v[144:147], a[88:91]
    ds_read_b64_tr_b16 a[184:185], v27 offset:32768
    v_cvt_pk_bf16_f32 v180, v208, v209
    v_mfma_f32_16x16x32_bf16 a[88:91], a[172:175], v[148:151], a[88:91]
    ds_read_b64_tr_b16 a[186:187], v27 offset:36864
    v_mfma_f32_16x16x32_bf16 a[92:95], a[172:175], v[156:159], a[92:95]
    ds_read_b128 a[208:211], v8 offset:0
    v_cvt_pk_bf16_f32 v181, v210, v211
    v_mfma_f32_16x16x32_bf16 a[92:95], a[168:171], v[152:155], a[92:95]
    s_waitcnt lgkmcnt(3)
    buffer_load_dwordx4 v36, s[8:11], s40 offen lds
    v_mfma_f32_16x16x32_bf16 v[208:211], a[224:227], v[64:67], v[192:195]
    v_exp_f32 v212, v212
    v_mfma_f32_16x16x32_bf16 v[208:211], a[228:231], v[68:71], v[208:211]
    v_exp_f32 v213, v213
    v_mfma_f32_16x16x32_bf16 v[208:211], a[232:235], v[72:75], v[208:211]
    v_exp_f32 v214, v214
    v_mfma_f32_16x16x32_bf16 v[208:211], a[236:239], v[76:79], v[208:211]
    v_exp_f32 v215, v215
    v_mfma_f32_16x16x32_bf16 a[96:99], a[176:179], v[128:131], a[96:99]
    ds_read_b64_tr_b16 a[188:189], v27 offset:40960
    v_cvt_pk_bf16_f32 v188, v212, v213
    v_mfma_f32_16x16x32_bf16 a[96:99], a[180:183], v[132:135], a[96:99]
    ds_read_b64_tr_b16 a[190:191], v27 offset:45056
    v_mfma_f32_16x16x32_bf16 a[100:103], a[180:183], v[140:143], a[100:103]
    ds_read_b128 a[212:215], v9 offset:0
    v_cvt_pk_bf16_f32 v189, v214, v215
    v_mfma_f32_16x16x32_bf16 a[100:103], a[176:179], v[136:139], a[100:103]
    buffer_load_dword v219, v62, s[84:87], s38 offen
    v_mfma_f32_16x16x32_bf16 v[212:215], a[224:227], v[80:83], v[196:199]
    v_exp_f32 v208, v208
    v_mfma_f32_16x16x32_bf16 v[212:215], a[228:231], v[84:87], v[212:215]
    v_exp_f32 v209, v209
    v_mfma_f32_16x16x32_bf16 v[212:215], a[232:235], v[88:91], v[212:215]
    v_exp_f32 v210, v210
    v_mfma_f32_16x16x32_bf16 v[212:215], a[236:239], v[92:95], v[212:215]
    v_exp_f32 v211, v211
    v_mfma_f32_16x16x32_bf16 a[104:107], a[176:179], v[144:147], a[104:107]
    ds_read_b64_tr_b16 a[160:161], v20 offset:49152
    v_cvt_pk_bf16_f32 v166, v208, v209
    v_mfma_f32_16x16x32_bf16 a[104:107], a[180:183], v[148:151], a[104:107]
    ds_read_b64_tr_b16 a[162:163], v20 offset:53248
    v_mfma_f32_16x16x32_bf16 a[108:111], a[180:183], v[156:159], a[108:111]
    ds_read_b128 a[216:219], v10 offset:0
    v_cvt_pk_bf16_f32 v167, v210, v211
    v_mfma_f32_16x16x32_bf16 a[108:111], a[176:179], v[152:155], a[108:111]
    s_waitcnt lgkmcnt(3)
    buffer_load_dwordx4 v37, s[8:11], s40 offen offset:1024 lds
    v_mfma_f32_16x16x32_bf16 v[208:211], a[224:227], v[96:99], v[200:203]
    v_exp_f32 v212, v212
    v_mfma_f32_16x16x32_bf16 v[208:211], a[228:231], v[100:103], v[208:211]
    v_exp_f32 v213, v213
    v_mfma_f32_16x16x32_bf16 v[208:211], a[232:235], v[104:107], v[208:211]
    v_exp_f32 v214, v214
    v_mfma_f32_16x16x32_bf16 v[208:211], a[236:239], v[108:111], v[208:211]
    v_exp_f32 v215, v215
    v_mfma_f32_16x16x32_bf16 a[112:115], a[184:187], v[128:131], a[112:115]
    ds_read_b64_tr_b16 a[164:165], v20 offset:57344
    v_cvt_pk_bf16_f32 v174, v212, v213
    v_mfma_f32_16x16x32_bf16 a[112:115], a[188:191], v[132:135], a[112:115]
    ds_read_b64_tr_b16 a[166:167], v20 offset:61440
    v_mfma_f32_16x16x32_bf16 a[116:119], a[188:191], v[140:143], a[116:119]
    ds_read_b128 a[220:223], v11 offset:0
    v_cvt_pk_bf16_f32 v175, v214, v215
    v_mfma_f32_16x16x32_bf16 a[116:119], a[184:187], v[136:139], a[116:119]
    buffer_load_dword v221, v235, s[20:23], 0 offen
    v_mfma_f32_16x16x32_bf16 v[212:215], a[224:227], v[112:115], v[204:207]
    v_exp_f32 v208, v208
    v_mfma_f32_16x16x32_bf16 v[212:215], a[228:231], v[116:119], v[212:215]
    v_exp_f32 v209, v209
    v_mfma_f32_16x16x32_bf16 v[212:215], a[232:235], v[120:123], v[212:215]
    v_exp_f32 v210, v210
    v_mfma_f32_16x16x32_bf16 v[212:215], a[236:239], v[124:127], v[212:215]
    v_exp_f32 v211, v211
    v_mfma_f32_16x16x32_bf16 a[120:123], a[184:187], v[144:147], a[120:123]
    ds_read_b64_tr_b16 a[168:169], v21 offset:49152
    v_cvt_pk_bf16_f32 v182, v208, v209
    v_mfma_f32_16x16x32_bf16 a[120:123], a[188:191], v[148:151], a[120:123]
Ltour0_5:
    s_cbranch_execz Ltour0_9
    ds_read_b64_tr_b16 a[170:171], v21 offset:53248
    v_add_u32 v235, 2560, v235
    v_mfma_f32_16x16x32_bf16 a[124:127], a[188:191], v[156:159], a[124:127]
    ds_read_b128 a[224:227], v8 offset:4096
    v_cvt_pk_bf16_f32 v183, v210, v211
    v_mfma_f32_16x16x32_bf16 a[124:127], a[184:187], v[152:155], a[124:127]
    s_waitcnt lgkmcnt(3)
    buffer_load_dwordx4 v38, s[8:11], s40 offen offset:2048 lds
    v_mfma_f32_16x16x32_bf16 v[208:211], a[208:211], v[64:67], v[192:195]
    v_exp_f32 v212, v212
    v_mfma_f32_16x16x32_bf16 v[208:211], a[212:215], v[68:71], v[208:211]
    v_exp_f32 v213, v213
    v_mfma_f32_16x16x32_bf16 v[208:211], a[216:219], v[72:75], v[208:211]
    v_exp_f32 v214, v214
    v_mfma_f32_16x16x32_bf16 v[208:211], a[220:223], v[76:79], v[208:211]
    v_exp_f32 v215, v215
    v_mfma_f32_16x16x32_bf16 a[0:3], a[160:163], v[160:163], a[0:3]
    ds_read_b64_tr_b16 a[172:173], v21 offset:57344
    v_cvt_pk_bf16_f32 v190, v212, v213
    v_mfma_f32_16x16x32_bf16 a[0:3], a[164:167], v[164:167], a[0:3]
    ds_read_b64_tr_b16 a[174:175], v21 offset:61440
    v_lshlrev_b32 v244, 16, v240
    v_mfma_f32_16x16x32_bf16 a[4:7], a[164:167], v[172:175], a[4:7]
    ds_read_b128 a[228:231], v9 offset:4096
    v_cvt_pk_bf16_f32 v191, v214, v215
    v_mfma_f32_16x16x32_bf16 a[4:7], a[160:163], v[168:171], a[4:7]
    v_and_b32 v245, 0xffff0000, v240
    v_fmac_f32 v224, v2, v244
    v_mfma_f32_16x16x32_bf16 v[212:215], a[208:211], v[80:83], v[196:199]
    v_exp_f32 v208, v208
    v_mfma_f32_16x16x32_bf16 v[212:215], a[212:215], v[84:87], v[212:215]
    v_exp_f32 v209, v209
    v_mfma_f32_16x16x32_bf16 v[212:215], a[216:219], v[88:91], v[212:215]
    v_exp_f32 v210, v210
    v_mfma_f32_16x16x32_bf16 v[212:215], a[220:223], v[92:95], v[212:215]
    v_exp_f32 v211, v211
    v_mfma_f32_16x16x32_bf16 a[8:11], a[160:163], v[176:179], a[8:11]
    ds_read_b64_tr_b16 a[176:177], v22 offset:49152
    v_cvt_pk_bf16_f32 v128, v208, v209
    v_mfma_f32_16x16x32_bf16 a[8:11], a[164:167], v[180:183], a[8:11]
    ds_read_b64_tr_b16 a[178:179], v22 offset:53248
    v_fmac_f32 v225, v2, v245
    v_mfma_f32_16x16x32_bf16 a[12:15], a[164:167], v[188:191], a[12:15]
    ds_read_b128 a[232:235], v10 offset:4096
    v_cvt_pk_bf16_f32 v129, v210, v211
    v_mfma_f32_16x16x32_bf16 a[12:15], a[160:163], v[184:187], a[12:15]
    s_waitcnt lgkmcnt(3)
    buffer_load_dwordx4 v39, s[8:11], s40 offen offset:3072 lds
    v_mfma_f32_16x16x32_bf16 v[208:211], a[208:211], v[96:99], v[200:203]
    v_exp_f32 v212, v212
    v_mfma_f32_16x16x32_bf16 v[208:211], a[212:215], v[100:103], v[208:211]
    s_add_u32 s40, s40, 16384
    v_exp_f32 v213, v213
    v_mfma_f32_16x16x32_bf16 v[208:211], a[216:219], v[104:107], v[208:211]
    v_exp_f32 v214, v214
    v_mfma_f32_16x16x32_bf16 v[208:211], a[220:223], v[108:111], v[208:211]
    v_exp_f32 v215, v215
    v_mfma_f32_16x16x32_bf16 a[16:19], a[168:171], v[160:163], a[16:19]
    ds_read_b64_tr_b16 a[180:181], v22 offset:57344
    v_cvt_pk_bf16_f32 v136, v212, v213
    v_mfma_f32_16x16x32_bf16 a[16:19], a[172:175], v[164:167], a[16:19]
    ds_read_b64_tr_b16 a[182:183], v22 offset:61440
    v_lshlrev_b32 v246, 16, v241
    v_mfma_f32_16x16x32_bf16 a[20:23], a[172:175], v[172:175], a[20:23]
    ds_read_b128 a[236:239], v11 offset:4096
    v_cvt_pk_bf16_f32 v137, v214, v215
    v_mfma_f32_16x16x32_bf16 a[20:23], a[168:171], v[168:171], a[20:23]
    v_and_b32 v247, 0xffff0000, v241
    v_fmac_f32 v226, v2, v246
    v_smfmac_f32_16x16x64_bf16 a[192:195], v[52:55], v[160:167], v50
    v_mfma_f32_16x16x32_bf16 v[212:215], a[208:211], v[112:115], v[204:207]
    v_exp_f32 v208, v208
    v_mfma_f32_16x16x32_bf16 v[212:215], a[212:215], v[116:119], v[212:215]
    s_add_u32 m0, s42, 81920
    v_exp_f32 v209, v209
    v_mfma_f32_16x16x32_bf16 v[212:215], a[216:219], v[120:123], v[212:215]
    v_exp_f32 v210, v210
    v_mfma_f32_16x16x32_bf16 v[212:215], a[220:223], v[124:127], v[212:215]
    v_exp_f32 v211, v211
    v_mfma_f32_16x16x32_bf16 a[24:27], a[168:171], v[176:179], a[24:27]
    ds_read_b64_tr_b16 a[184:185], v23 offset:49152
    v_cvt_pk_bf16_f32 v144, v208, v209
    v_mfma_f32_16x16x32_bf16 a[24:27], a[172:175], v[180:183], a[24:27]
    ds_read_b64_tr_b16 a[186:187], v23 offset:53248
    v_fmac_f32 v227, v2, v247
    v_mfma_f32_16x16x32_bf16 a[28:31], a[172:175], v[188:191], a[28:31]
    ds_read_b128 a[208:211], v8 offset:8192
    v_cvt_pk_bf16_f32 v145, v210, v211
    v_mfma_f32_16x16x32_bf16 a[28:31], a[168:171], v[184:187], a[28:31]
    s_waitcnt lgkmcnt(3)
    buffer_load_dwordx4 v40, s[12:15], s41 offen lds
    v_mfma_f32_16x16x32_bf16 v[208:211], a[224:227], v[64:67], v[192:195]
    v_exp_f32 v212, v212
    v_mfma_f32_16x16x32_bf16 v[208:211], a[228:231], v[68:71], v[208:211]
    v_exp_f32 v213, v213
    v_mfma_f32_16x16x32_bf16 v[208:211], a[232:235], v[72:75], v[208:211]
    v_exp_f32 v214, v214
    v_mfma_f32_16x16x32_bf16 v[208:211], a[236:239], v[76:79], v[208:211]
    v_exp_f32 v215, v215
    v_mfma_f32_16x16x32_bf16 a[32:35], a[176:179], v[160:163], a[32:35]
    ds_read_b64_tr_b16 a[188:189], v23 offset:57344
    v_cvt_pk_bf16_f32 v152, v212, v213
    v_mfma_f32_16x16x32_bf16 a[32:35], a[180:183], v[164:167], a[32:35]
    ds_read_b64_tr_b16 a[190:191], v23 offset:61440
    v_lshlrev_b32 v244, 16, v242
    v_mfma_f32_16x16x32_bf16 a[36:39], a[180:183], v[172:175], a[36:39]
    ds_read_b128 a[212:215], v9 offset:8192
    v_cvt_pk_bf16_f32 v153, v214, v215
    v_mfma_f32_16x16x32_bf16 a[36:39], a[176:179], v[168:171], a[36:39]
    v_and_b32 v245, 0xffff0000, v242
    v_fmac_f32 v228, v2, v244
    v_smfmac_f32_16x16x64_bf16 a[196:199], v[52:55], v[168:175], v50
    v_mfma_f32_16x16x32_bf16 v[212:215], a[224:227], v[80:83], v[196:199]
    v_exp_f32 v208, v208
    v_mfma_f32_16x16x32_bf16 v[212:215], a[228:231], v[84:87], v[212:215]
    v_exp_f32 v209, v209
    v_mfma_f32_16x16x32_bf16 v[212:215], a[232:235], v[88:91], v[212:215]
    v_exp_f32 v210, v210
    v_mfma_f32_16x16x32_bf16 v[212:215], a[236:239], v[92:95], v[212:215]
    v_exp_f32 v211, v211
    v_mfma_f32_16x16x32_bf16 a[40:43], a[176:179], v[176:179], a[40:43]
    ds_read_b64_tr_b16 a[160:161], v24 offset:49152
    v_cvt_pk_bf16_f32 v130, v208, v209
    v_mfma_f32_16x16x32_bf16 a[40:43], a[180:183], v[180:183], a[40:43]
    ds_read_b64_tr_b16 a[162:163], v24 offset:53248
    v_fmac_f32 v229, v2, v245
    v_mfma_f32_16x16x32_bf16 a[44:47], a[180:183], v[188:191], a[44:47]
    ds_read_b128 a[216:219], v10 offset:8192
    v_cvt_pk_bf16_f32 v131, v210, v211
    v_mfma_f32_16x16x32_bf16 a[44:47], a[176:179], v[184:187], a[44:47]
    s_waitcnt lgkmcnt(3)
    buffer_load_dwordx4 v41, s[12:15], s41 offen offset:1024 lds
    v_mfma_f32_16x16x32_bf16 v[208:211], a[224:227], v[96:99], v[200:203]
    v_exp_f32 v212, v212
    v_mfma_f32_16x16x32_bf16 v[208:211], a[228:231], v[100:103], v[208:211]
    v_exp_f32 v213, v213
    v_mfma_f32_16x16x32_bf16 v[208:211], a[232:235], v[104:107], v[208:211]
    v_exp_f32 v214, v214
    v_mfma_f32_16x16x32_bf16 v[208:211], a[236:239], v[108:111], v[208:211]
    v_exp_f32 v215, v215
    v_mfma_f32_16x16x32_bf16 a[48:51], a[184:187], v[160:163], a[48:51]
    ds_read_b64_tr_b16 a[164:165], v24 offset:57344
    v_cvt_pk_bf16_f32 v138, v212, v213
    v_mfma_f32_16x16x32_bf16 a[48:51], a[188:191], v[164:167], a[48:51]
    ds_read_b64_tr_b16 a[166:167], v24 offset:61440
    v_lshlrev_b32 v246, 16, v243
    v_mfma_f32_16x16x32_bf16 a[52:55], a[188:191], v[172:175], a[52:55]
    ds_read_b128 a[220:223], v11 offset:8192
    v_cvt_pk_bf16_f32 v139, v214, v215
    v_mfma_f32_16x16x32_bf16 a[52:55], a[184:187], v[168:171], a[52:55]
    v_and_b32 v247, 0xffff0000, v243
    v_fmac_f32 v230, v2, v246
    v_smfmac_f32_16x16x64_bf16 a[200:203], v[52:55], v[176:183], v50
    v_mfma_f32_16x16x32_bf16 v[212:215], a[224:227], v[112:115], v[204:207]
    v_exp_f32 v208, v208
    v_mfma_f32_16x16x32_bf16 v[212:215], a[228:231], v[116:119], v[212:215]
    v_exp_f32 v209, v209
    v_mfma_f32_16x16x32_bf16 v[212:215], a[232:235], v[120:123], v[212:215]
    v_exp_f32 v210, v210
    v_mfma_f32_16x16x32_bf16 v[212:215], a[236:239], v[124:127], v[212:215]
    v_exp_f32 v211, v211
    v_mfma_f32_16x16x32_bf16 a[56:59], a[184:187], v[176:179], a[56:59]
    ds_read_b64_tr_b16 a[168:169], v25 offset:49152
    v_cvt_pk_bf16_f32 v146, v208, v209
    v_mfma_f32_16x16x32_bf16 a[56:59], a[188:191], v[180:183], a[56:59]
    ds_read_b64_tr_b16 a[170:171], v25 offset:53248
    v_fmac_f32 v231, v2, v247
    v_mfma_f32_16x16x32_bf16 a[60:63], a[188:191], v[188:191], a[60:63]
    ds_read_b128 a[224:227], v8 offset:12288
    v_cvt_pk_bf16_f32 v147, v210, v211
    v_mfma_f32_16x16x32_bf16 a[60:63], a[184:187], v[184:187], a[60:63]
    s_waitcnt lgkmcnt(3)
    buffer_load_dwordx4 v40, s[12:15], s41 offen offset:2048 lds
    v_mfma_f32_16x16x32_bf16 v[208:211], a[208:211], v[64:67], v[192:195]
    v_exp_f32 v212, v212
    v_mfma_f32_16x16x32_bf16 v[208:211], a[212:215], v[68:71], v[208:211]
    v_exp_f32 v213, v213
    v_mfma_f32_16x16x32_bf16 v[208:211], a[216:219], v[72:75], v[208:211]
    v_exp_f32 v214, v214
    v_mfma_f32_16x16x32_bf16 v[208:211], a[220:223], v[76:79], v[208:211]
    v_exp_f32 v215, v215
    v_mfma_f32_16x16x32_bf16 a[64:67], a[160:163], v[160:163], a[64:67]
    ds_read_b64_tr_b16 a[172:173], v25 offset:57344
    v_cvt_pk_bf16_f32 v154, v212, v213
    v_mfma_f32_16x16x32_bf16 a[64:67], a[164:167], v[164:167], a[64:67]
    ds_read_b64_tr_b16 a[174:175], v25 offset:61440
    v_mov_b32 v2, v3
    v_mfma_f32_16x16x32_bf16 a[68:71], a[164:167], v[172:175], a[68:71]
    ds_read_b128 a[228:231], v9 offset:12288
    v_cvt_pk_bf16_f32 v155, v214, v215
    v_mfma_f32_16x16x32_bf16 a[68:71], a[160:163], v[168:171], a[68:71]
    v_mov_b32 v3, v4
    v_mov_b32 v4, v5
    v_smfmac_f32_16x16x64_bf16 a[204:207], v[52:55], v[184:191], v50
    v_mfma_f32_16x16x32_bf16 v[212:215], a[208:211], v[80:83], v[196:199]
    v_exp_f32 v208, v208
    v_mfma_f32_16x16x32_bf16 v[212:215], a[212:215], v[84:87], v[212:215]
    v_exp_f32 v209, v209
    v_mfma_f32_16x16x32_bf16 v[212:215], a[216:219], v[88:91], v[212:215]
    v_exp_f32 v210, v210
    v_mfma_f32_16x16x32_bf16 v[212:215], a[220:223], v[92:95], v[212:215]
    v_exp_f32 v211, v211
    v_mfma_f32_16x16x32_bf16 a[72:75], a[160:163], v[176:179], a[72:75]
    ds_read_b64_tr_b16 a[176:177], v26 offset:49152
    v_cvt_pk_bf16_f32 v132, v208, v209
    v_mfma_f32_16x16x32_bf16 a[72:75], a[164:167], v[180:183], a[72:75]
    ds_read_b64_tr_b16 a[178:179], v26 offset:53248
    v_mov_b32 v5, v6
    v_mfma_f32_16x16x32_bf16 a[76:79], a[164:167], v[188:191], a[76:79]
    ds_read_b128 a[232:235], v10 offset:12288
    v_cvt_pk_bf16_f32 v133, v210, v211
    v_mfma_f32_16x16x32_bf16 a[76:79], a[160:163], v[184:187], a[76:79]
    s_waitcnt lgkmcnt(3)
    buffer_load_dwordx4 v41, s[12:15], s41 offen offset:3072 lds
    v_mfma_f32_16x16x32_bf16 v[208:211], a[208:211], v[96:99], v[200:203]
    v_exp_f32 v212, v212
    v_mfma_f32_16x16x32_bf16 v[208:211], a[212:215], v[100:103], v[208:211]
    s_add_u32 s41, s41, 16384
    v_exp_f32 v213, v213
    v_mfma_f32_16x16x32_bf16 v[208:211], a[216:219], v[104:107], v[208:211]
    v_exp_f32 v214, v214
    v_mfma_f32_16x16x32_bf16 v[208:211], a[220:223], v[108:111], v[208:211]
    v_exp_f32 v215, v215
    v_mfma_f32_16x16x32_bf16 a[80:83], a[168:171], v[160:163], a[80:83]
    ds_read_b64_tr_b16 a[180:181], v26 offset:57344
    v_cvt_pk_bf16_f32 v140, v212, v213
    v_mfma_f32_16x16x32_bf16 a[80:83], a[172:175], v[164:167], a[80:83]
    ds_read_b64_tr_b16 a[182:183], v26 offset:61440
    v_mfma_f32_16x16x32_bf16 a[84:87], a[172:175], v[172:175], a[84:87]
    ds_read_b128 a[236:239], v11 offset:12288
    v_cvt_pk_bf16_f32 v141, v214, v215
    v_mfma_f32_16x16x32_bf16 a[84:87], a[168:171], v[168:171], a[84:87]
    s_waitcnt vmcnt(10)
    s_barrier
    v_mfma_f32_16x16x32_bf16 v[212:215], a[208:211], v[112:115], v[204:207]
    v_exp_f32 v208, v208
    v_mfma_f32_16x16x32_bf16 v[212:215], a[212:215], v[116:119], v[212:215]
    s_add_u32 m0, s42, 49152
    v_exp_f32 v209, v209
    v_mfma_f32_16x16x32_bf16 v[212:215], a[216:219], v[120:123], v[212:215]
    v_exp_f32 v210, v210
    v_mfma_f32_16x16x32_bf16 v[212:215], a[220:223], v[124:127], v[212:215]
    v_exp_f32 v211, v211
    v_mfma_f32_16x16x32_bf16 a[88:91], a[168:171], v[176:179], a[88:91]
    ds_read_b64_tr_b16 a[184:185], v27 offset:49152
    v_cvt_pk_bf16_f32 v148, v208, v209
    v_mfma_f32_16x16x32_bf16 a[88:91], a[172:175], v[180:183], a[88:91]
    ds_read_b64_tr_b16 a[186:187], v27 offset:53248
    v_mfma_f32_16x16x32_bf16 a[92:95], a[172:175], v[188:191], a[92:95]
    ds_read_b128 a[208:211], v8 offset:16384
    v_cvt_pk_bf16_f32 v149, v210, v211
    v_mfma_f32_16x16x32_bf16 a[92:95], a[168:171], v[184:187], a[92:95]
    s_waitcnt lgkmcnt(3)
    buffer_load_dwordx4 v36, s[8:11], s40 offen lds
    v_mfma_f32_16x16x32_bf16 v[208:211], a[224:227], v[64:67], v[192:195]
    v_exp_f32 v212, v212
    v_mfma_f32_16x16x32_bf16 v[208:211], a[228:231], v[68:71], v[208:211]
    v_exp_f32 v213, v213
    v_mfma_f32_16x16x32_bf16 v[208:211], a[232:235], v[72:75], v[208:211]
    v_exp_f32 v214, v214
    v_mfma_f32_16x16x32_bf16 v[208:211], a[236:239], v[76:79], v[208:211]
    v_exp_f32 v215, v215
    v_mfma_f32_16x16x32_bf16 a[96:99], a[176:179], v[160:163], a[96:99]
    ds_read_b64_tr_b16 a[188:189], v27 offset:57344
    v_cvt_pk_bf16_f32 v156, v212, v213
    v_mfma_f32_16x16x32_bf16 a[96:99], a[180:183], v[164:167], a[96:99]
    ds_read_b64_tr_b16 a[190:191], v27 offset:61440
    v_mfma_f32_16x16x32_bf16 a[100:103], a[180:183], v[172:175], a[100:103]
    ds_read_b128 a[212:215], v9 offset:16384
    v_cvt_pk_bf16_f32 v157, v214, v215
    v_mfma_f32_16x16x32_bf16 a[100:103], a[176:179], v[168:171], a[100:103]
    buffer_load_dword v216, v237, s[28:31], s52 offen
    v_mfma_f32_16x16x32_bf16 v[212:215], a[224:227], v[80:83], v[196:199]
    v_exp_f32 v208, v208
    v_mfma_f32_16x16x32_bf16 v[212:215], a[228:231], v[84:87], v[212:215]
    s_sub_u32 s39, s39, 36864
    v_exp_f32 v209, v209
    v_mfma_f32_16x16x32_bf16 v[212:215], a[232:235], v[88:91], v[212:215]
    s_sub_u32 s38, s38, 4608
    v_exp_f32 v210, v210
    v_mfma_f32_16x16x32_bf16 v[212:215], a[236:239], v[92:95], v[212:215]
    s_add_u32 s52, s52, 2304
    v_exp_f32 v211, v211
    v_mfma_f32_16x16x32_bf16 a[104:107], a[176:179], v[176:179], a[104:107]
    ds_read_b64_tr_b16 a[160:161], v20 offset:0
    v_cvt_pk_bf16_f32 v134, v208, v209
    v_mfma_f32_16x16x32_bf16 a[104:107], a[180:183], v[180:183], a[104:107]
    ds_read_b64_tr_b16 a[162:163], v20 offset:4096
    v_mfma_f32_16x16x32_bf16 a[108:111], a[180:183], v[188:191], a[108:111]
    ds_read_b128 a[216:219], v10 offset:16384
    v_cvt_pk_bf16_f32 v135, v210, v211
    v_mfma_f32_16x16x32_bf16 a[108:111], a[176:179], v[184:187], a[108:111]
    s_waitcnt lgkmcnt(3)
    buffer_load_dwordx4 v37, s[8:11], s40 offen offset:1024 lds
    v_mfma_f32_16x16x32_bf16 v[208:211], a[224:227], v[96:99], v[200:203]
    v_exp_f32 v212, v212
    v_mfma_f32_16x16x32_bf16 v[208:211], a[228:231], v[100:103], v[208:211]
    v_exp_f32 v213, v213
    v_mfma_f32_16x16x32_bf16 v[208:211], a[232:235], v[104:107], v[208:211]
    v_exp_f32 v214, v214
    v_mfma_f32_16x16x32_bf16 v[208:211], a[236:239], v[108:111], v[208:211]
    v_exp_f32 v215, v215
    v_mfma_f32_16x16x32_bf16 a[112:115], a[184:187], v[160:163], a[112:115]
    ds_read_b64_tr_b16 a[164:165], v20 offset:8192
    v_cvt_pk_bf16_f32 v142, v212, v213
    v_mfma_f32_16x16x32_bf16 a[112:115], a[188:191], v[164:167], a[112:115]
    ds_read_b64_tr_b16 a[166:167], v20 offset:12288
    v_mfma_f32_16x16x32_bf16 a[116:119], a[188:191], v[172:175], a[116:119]
    ds_read_b128 a[220:223], v11 offset:16384
    v_cvt_pk_bf16_f32 v143, v214, v215
    v_mfma_f32_16x16x32_bf16 a[116:119], a[184:187], v[168:171], a[116:119]
    v_mfma_f32_16x16x32_bf16 v[212:215], a[224:227], v[112:115], v[204:207]
    v_exp_f32 v208, v208
    v_mfma_f32_16x16x32_bf16 v[212:215], a[228:231], v[116:119], v[212:215]
    v_exp_f32 v209, v209
    v_mfma_f32_16x16x32_bf16 v[212:215], a[232:235], v[120:123], v[212:215]
    v_exp_f32 v210, v210
    v_mfma_f32_16x16x32_bf16 v[212:215], a[236:239], v[124:127], v[212:215]
    v_exp_f32 v211, v211
    v_mfma_f32_16x16x32_bf16 a[120:123], a[184:187], v[176:179], a[120:123]
    ds_read_b64_tr_b16 a[168:169], v21 offset:0
    v_cvt_pk_bf16_f32 v150, v208, v209
    v_mfma_f32_16x16x32_bf16 a[120:123], a[188:191], v[180:183], a[120:123]
    ds_read_b64_tr_b16 a[170:171], v21 offset:4096
    v_mfma_f32_16x16x32_bf16 a[124:127], a[188:191], v[188:191], a[124:127]
    ds_read_b128 a[224:227], v8 offset:20480
    v_cvt_pk_bf16_f32 v151, v210, v211
    v_mfma_f32_16x16x32_bf16 a[124:127], a[184:187], v[184:187], a[124:127]
    s_waitcnt lgkmcnt(3)
    buffer_load_dwordx4 v38, s[8:11], s40 offen offset:2048 lds
    s_sub_u32 s43, s43, 1
    s_cmp_lg_u32 s43, 0
    s_cbranch_scc1 Lattn_loop
    v_mfma_f32_16x16x32_bf16 v[208:211], a[208:211], v[64:67], v[192:195]
    s_lshl_b32 s38, s3, 6
    v_exp_f32 v212, v212
    v_mfma_f32_16x16x32_bf16 v[208:211], a[212:215], v[68:71], v[208:211]
    s_add_u32 s38, s38, 131136
    v_exp_f32 v213, v213
    v_mfma_f32_16x16x32_bf16 v[208:211], a[216:219], v[72:75], v[208:211]
    v_exp_f32 v214, v214
    v_mfma_f32_16x16x32_bf16 v[208:211], a[220:223], v[76:79], v[208:211]
    s_add_u32 s57, s58, 0
    v_exp_f32 v215, v215
    v_mfma_f32_16x16x32_bf16 a[0:3], a[160:163], v[128:131], a[0:3]
    ds_read_b64_tr_b16 a[172:173], v21 offset:8192
    v_cvt_pk_bf16_f32 v158, v212, v213
    v_mfma_f32_16x16x32_bf16 a[0:3], a[164:167], v[132:135], a[0:3]
    ds_read_b64_tr_b16 a[174:175], v21 offset:12288
    v_permlane32_swap_b32 v224, v228
    v_mfma_f32_16x16x32_bf16 a[4:7], a[164:167], v[140:143], a[4:7]
    ds_read_b128 a[228:231], v9 offset:20480
    v_cvt_pk_bf16_f32 v159, v214, v215
    v_mfma_f32_16x16x32_bf16 a[4:7], a[160:163], v[136:139], a[4:7]
    buffer_load_dwordx4 a[128:131], v254, s[80:83], s57 offen
    v_mfma_f32_16x16x32_bf16 v[212:215], a[208:211], v[80:83], v[196:199]
    v_exp_f32 v208, v208
    v_mfma_f32_16x16x32_bf16 v[212:215], a[212:215], v[84:87], v[212:215]
    v_exp_f32 v209, v209
    v_mfma_f32_16x16x32_bf16 v[212:215], a[216:219], v[88:91], v[212:215]
    v_exp_f32 v210, v210
    v_mfma_f32_16x16x32_bf16 v[212:215], a[220:223], v[92:95], v[212:215]
    v_exp_f32 v211, v211
    v_mfma_f32_16x16x32_bf16 a[8:11], a[160:163], v[144:147], a[8:11]
    ds_read_b64_tr_b16 a[176:177], v22 offset:0
    v_cvt_pk_bf16_f32 v160, v208, v209
    v_mfma_f32_16x16x32_bf16 a[8:11], a[164:167], v[148:151], a[8:11]
    ds_read_b64_tr_b16 a[178:179], v22 offset:4096
    v_permlane32_swap_b32 v225, v229
    v_mfma_f32_16x16x32_bf16 a[12:15], a[164:167], v[156:159], a[12:15]
    ds_read_b128 a[232:235], v10 offset:20480
    v_cvt_pk_bf16_f32 v161, v210, v211
    v_mfma_f32_16x16x32_bf16 a[12:15], a[160:163], v[152:155], a[12:15]
    s_waitcnt lgkmcnt(3)
    buffer_load_dwordx4 v39, s[8:11], s40 offen offset:3072 lds
    v_mfma_f32_16x16x32_bf16 v[208:211], a[208:211], v[96:99], v[200:203]
    v_exp_f32 v212, v212
    v_mfma_f32_16x16x32_bf16 v[208:211], a[212:215], v[100:103], v[208:211]
    s_add_u32 s40, s40, 16384
    v_exp_f32 v213, v213
    v_mfma_f32_16x16x32_bf16 v[208:211], a[216:219], v[104:107], v[208:211]
    v_exp_f32 v214, v214
    v_mfma_f32_16x16x32_bf16 v[208:211], a[220:223], v[108:111], v[208:211]
    v_exp_f32 v215, v215
    v_mfma_f32_16x16x32_bf16 a[16:19], a[168:171], v[128:131], a[16:19]
    ds_read_b64_tr_b16 a[180:181], v22 offset:8192
    v_cvt_pk_bf16_f32 v168, v212, v213
    v_mfma_f32_16x16x32_bf16 a[16:19], a[172:175], v[132:135], a[16:19]
    ds_read_b64_tr_b16 a[182:183], v22 offset:12288
    v_permlane32_swap_b32 v226, v230
    v_mfma_f32_16x16x32_bf16 a[20:23], a[172:175], v[140:143], a[20:23]
    ds_read_b128 a[236:239], v11 offset:20480
    v_cvt_pk_bf16_f32 v169, v214, v215
    v_mfma_f32_16x16x32_bf16 a[20:23], a[168:171], v[136:139], a[20:23]
    v_permlane32_swap_b32 v227, v231
    v_add_f32 v224, v224, v228
    v_smfmac_f32_16x16x64_bf16 a[192:195], v[52:55], v[128:135], v50
    v_mfma_f32_16x16x32_bf16 v[212:215], a[208:211], v[112:115], v[204:207]
    v_exp_f32 v208, v208
    v_mfma_f32_16x16x32_bf16 v[212:215], a[212:215], v[116:119], v[212:215]
    s_add_u32 m0, s42, 98304
    v_exp_f32 v209, v209
    v_mfma_f32_16x16x32_bf16 v[212:215], a[216:219], v[120:123], v[212:215]
    v_exp_f32 v210, v210
    v_mfma_f32_16x16x32_bf16 v[212:215], a[220:223], v[124:127], v[212:215]
    v_exp_f32 v211, v211
    v_mfma_f32_16x16x32_bf16 a[24:27], a[168:171], v[144:147], a[24:27]
    ds_read_b64_tr_b16 a[184:185], v23 offset:0
    v_cvt_pk_bf16_f32 v176, v208, v209
    v_mfma_f32_16x16x32_bf16 a[24:27], a[172:175], v[148:151], a[24:27]
    ds_read_b64_tr_b16 a[186:187], v23 offset:4096
    v_add_f32 v225, v225, v229
    v_mfma_f32_16x16x32_bf16 a[28:31], a[172:175], v[156:159], a[28:31]
    ds_read_b128 a[208:211], v8 offset:24576
    v_cvt_pk_bf16_f32 v177, v210, v211
    v_mfma_f32_16x16x32_bf16 a[28:31], a[168:171], v[152:155], a[28:31]
    s_waitcnt lgkmcnt(3)
    buffer_load_dwordx4 v40, s[12:15], s41 offen lds
    v_mfma_f32_16x16x32_bf16 v[208:211], a[224:227], v[64:67], v[192:195]
    v_exp_f32 v212, v212
    v_mfma_f32_16x16x32_bf16 v[208:211], a[228:231], v[68:71], v[208:211]
    v_exp_f32 v213, v213
    v_mfma_f32_16x16x32_bf16 v[208:211], a[232:235], v[72:75], v[208:211]
    v_exp_f32 v214, v214
    v_mfma_f32_16x16x32_bf16 v[208:211], a[236:239], v[76:79], v[208:211]
    s_add_u32 s57, s58, 589824
    v_exp_f32 v215, v215
    v_mfma_f32_16x16x32_bf16 a[32:35], a[176:179], v[128:131], a[32:35]
    ds_read_b64_tr_b16 a[188:189], v23 offset:8192
    v_cvt_pk_bf16_f32 v184, v212, v213
    v_mfma_f32_16x16x32_bf16 a[32:35], a[180:183], v[132:135], a[32:35]
    ds_read_b64_tr_b16 a[190:191], v23 offset:12288
    v_add_f32 v226, v226, v230
    v_mfma_f32_16x16x32_bf16 a[36:39], a[180:183], v[140:143], a[36:39]
    ds_read_b128 a[212:215], v9 offset:24576
    v_cvt_pk_bf16_f32 v185, v214, v215
    v_mfma_f32_16x16x32_bf16 a[36:39], a[176:179], v[136:139], a[36:39]
    buffer_load_dwordx4 a[132:135], v254, s[80:83], s57 offen
    v_smfmac_f32_16x16x64_bf16 a[196:199], v[52:55], v[136:143], v50
    v_mfma_f32_16x16x32_bf16 v[212:215], a[224:227], v[80:83], v[196:199]
    v_exp_f32 v208, v208
    v_mfma_f32_16x16x32_bf16 v[212:215], a[228:231], v[84:87], v[212:215]
    v_exp_f32 v209, v209
    v_mfma_f32_16x16x32_bf16 v[212:215], a[232:235], v[88:91], v[212:215]
    v_exp_f32 v210, v210
    v_mfma_f32_16x16x32_bf16 v[212:215], a[236:239], v[92:95], v[212:215]
    v_exp_f32 v211, v211
    v_mfma_f32_16x16x32_bf16 a[40:43], a[176:179], v[144:147], a[40:43]
    ds_read_b64_tr_b16 a[160:161], v24 offset:0
    v_cvt_pk_bf16_f32 v162, v208, v209
    v_mfma_f32_16x16x32_bf16 a[40:43], a[180:183], v[148:151], a[40:43]
    ds_read_b64_tr_b16 a[162:163], v24 offset:4096
    v_add_f32 v227, v227, v231
    v_mfma_f32_16x16x32_bf16 a[44:47], a[180:183], v[156:159], a[44:47]
    ds_read_b128 a[216:219], v10 offset:24576
    v_cvt_pk_bf16_f32 v163, v210, v211
    v_mfma_f32_16x16x32_bf16 a[44:47], a[176:179], v[152:155], a[44:47]
    s_waitcnt lgkmcnt(3)
    buffer_load_dwordx4 v41, s[12:15], s41 offen offset:1024 lds
    v_mfma_f32_16x16x32_bf16 v[208:211], a[224:227], v[96:99], v[200:203]
    v_exp_f32 v212, v212
    v_mfma_f32_16x16x32_bf16 v[208:211], a[228:231], v[100:103], v[208:211]
    v_exp_f32 v213, v213
    v_mfma_f32_16x16x32_bf16 v[208:211], a[232:235], v[104:107], v[208:211]
    v_exp_f32 v214, v214
    v_mfma_f32_16x16x32_bf16 v[208:211], a[236:239], v[108:111], v[208:211]
    v_exp_f32 v215, v215
    v_mfma_f32_16x16x32_bf16 a[48:51], a[184:187], v[128:131], a[48:51]
    ds_read_b64_tr_b16 a[164:165], v24 offset:8192
    v_cvt_pk_bf16_f32 v170, v212, v213
    v_mfma_f32_16x16x32_bf16 a[48:51], a[188:191], v[132:135], a[48:51]
    ds_read_b64_tr_b16 a[166:167], v24 offset:12288
    v_and_b32 v244, 1, v1
    v_mfma_f32_16x16x32_bf16 a[52:55], a[188:191], v[140:143], a[52:55]
    ds_read_b128 a[220:223], v11 offset:24576
    v_cvt_pk_bf16_f32 v171, v214, v215
    v_mfma_f32_16x16x32_bf16 a[52:55], a[184:187], v[136:139], a[52:55]
    s_waitcnt vmcnt(15)
    buffer_load_dword v221, v236, s[20:23], 0 offen
    v_smfmac_f32_16x16x64_bf16 a[200:203], v[52:55], v[144:151], v50
    v_mfma_f32_16x16x32_bf16 v[212:215], a[224:227], v[112:115], v[204:207]
    v_exp_f32 v208, v208
    v_mfma_f32_16x16x32_bf16 v[212:215], a[228:231], v[116:119], v[212:215]
    v_exp_f32 v209, v209
    v_mfma_f32_16x16x32_bf16 v[212:215], a[232:235], v[120:123], v[212:215]
    v_exp_f32 v210, v210
    v_mfma_f32_16x16x32_bf16 v[212:215], a[236:239], v[124:127], v[212:215]
    v_exp_f32 v211, v211
    v_mfma_f32_16x16x32_bf16 a[56:59], a[184:187], v[144:147], a[56:59]
    ds_read_b64_tr_b16 a[168:169], v25 offset:0
    v_cvt_pk_bf16_f32 v178, v208, v209
    v_mfma_f32_16x16x32_bf16 a[56:59], a[188:191], v[148:151], a[56:59]
    ds_read_b64_tr_b16 a[170:171], v25 offset:4096
    v_permlane16_swap_b32 v224, v226
    v_mfma_f32_16x16x32_bf16 a[60:63], a[188:191], v[156:159], a[60:63]
    ds_read_b128 a[224:227], v8 offset:28672
    v_cvt_pk_bf16_f32 v179, v210, v211
    v_mfma_f32_16x16x32_bf16 a[60:63], a[184:187], v[152:155], a[60:63]
    s_waitcnt lgkmcnt(3)
    buffer_load_dwordx4 v40, s[12:15], s41 offen offset:2048 lds
    v_mfma_f32_16x16x32_bf16 v[208:211], a[208:211], v[64:67], v[192:195]
    v_exp_f32 v212, v212
    v_mfma_f32_16x16x32_bf16 v[208:211], a[212:215], v[68:71], v[208:211]
    v_exp_f32 v213, v213
    v_mfma_f32_16x16x32_bf16 v[208:211], a[216:219], v[72:75], v[208:211]
    v_exp_f32 v214, v214
    v_mfma_f32_16x16x32_bf16 v[208:211], a[220:223], v[76:79], v[208:211]
    s_add_u32 s57, s58, 1179648
    v_exp_f32 v215, v215
    v_mfma_f32_16x16x32_bf16 a[64:67], a[160:163], v[128:131], a[64:67]
    ds_read_b64_tr_b16 a[172:173], v25 offset:8192
    v_cvt_pk_bf16_f32 v186, v212, v213
    v_mfma_f32_16x16x32_bf16 a[64:67], a[164:167], v[132:135], a[64:67]
    ds_read_b64_tr_b16 a[174:175], v25 offset:12288
    v_permlane16_swap_b32 v225, v227
    v_mfma_f32_16x16x32_bf16 a[68:71], a[164:167], v[140:143], a[68:71]
    ds_read_b128 a[228:231], v9 offset:28672
    v_cvt_pk_bf16_f32 v187, v214, v215
    v_mfma_f32_16x16x32_bf16 a[68:71], a[160:163], v[136:139], a[68:71]
    buffer_load_dwordx4 a[136:139], v254, s[80:83], s57 offen
    v_smfmac_f32_16x16x64_bf16 a[204:207], v[52:55], v[152:159], v50
    v_mfma_f32_16x16x32_bf16 v[212:215], a[208:211], v[80:83], v[196:199]
    v_exp_f32 v208, v208
    v_mfma_f32_16x16x32_bf16 v[212:215], a[212:215], v[84:87], v[212:215]
    v_exp_f32 v209, v209
    v_mfma_f32_16x16x32_bf16 v[212:215], a[216:219], v[88:91], v[212:215]
    v_exp_f32 v210, v210
    v_mfma_f32_16x16x32_bf16 v[212:215], a[220:223], v[92:95], v[212:215]
    v_exp_f32 v211, v211
    v_mfma_f32_16x16x32_bf16 a[72:75], a[160:163], v[144:147], a[72:75]
    ds_read_b64_tr_b16 a[176:177], v26 offset:0
    v_cvt_pk_bf16_f32 v164, v208, v209
    v_mfma_f32_16x16x32_bf16 a[72:75], a[164:167], v[148:151], a[72:75]
    ds_read_b64_tr_b16 a[178:179], v26 offset:4096
    v_lshlrev_b32 v244, 5, v244
    v_mfma_f32_16x16x32_bf16 a[76:79], a[164:167], v[156:159], a[76:79]
    ds_read_b128 a[232:235], v10 offset:28672
    v_cvt_pk_bf16_f32 v165, v210, v211
    v_mfma_f32_16x16x32_bf16 a[76:79], a[160:163], v[152:155], a[76:79]
    s_waitcnt lgkmcnt(3)
    buffer_load_dwordx4 v41, s[12:15], s41 offen offset:3072 lds
    v_mfma_f32_16x16x32_bf16 v[208:211], a[208:211], v[96:99], v[200:203]
    v_exp_f32 v212, v212
    v_mfma_f32_16x16x32_bf16 v[208:211], a[212:215], v[100:103], v[208:211]
    s_add_u32 s41, s41, 16384
    v_exp_f32 v213, v213
    v_mfma_f32_16x16x32_bf16 v[208:211], a[216:219], v[104:107], v[208:211]
    v_exp_f32 v214, v214
    v_mfma_f32_16x16x32_bf16 v[208:211], a[220:223], v[108:111], v[208:211]
    v_exp_f32 v215, v215
    v_mfma_f32_16x16x32_bf16 a[80:83], a[168:171], v[128:131], a[80:83]
    ds_read_b64_tr_b16 a[180:181], v26 offset:8192
    v_cvt_pk_bf16_f32 v172, v212, v213
    v_mfma_f32_16x16x32_bf16 a[80:83], a[172:175], v[132:135], a[80:83]
    ds_read_b64_tr_b16 a[182:183], v26 offset:12288
    v_add_f32 v224, v224, v226
    v_mfma_f32_16x16x32_bf16 a[84:87], a[172:175], v[140:143], a[84:87]
    ds_read_b128 a[236:239], v11 offset:28672
    v_cvt_pk_bf16_f32 v173, v214, v215
    v_mfma_f32_16x16x32_bf16 a[84:87], a[168:171], v[136:139], a[84:87]
    s_waitcnt vmcnt(13)
    s_barrier
    v_mfma_f32_16x16x32_bf16 v[212:215], a[208:211], v[112:115], v[204:207]
    v_exp_f32 v208, v208
    v_mfma_f32_16x16x32_bf16 v[212:215], a[212:215], v[116:119], v[212:215]
    s_add_u32 s49, s45, 1024
    v_exp_f32 v209, v209
    v_mfma_f32_16x16x32_bf16 v[212:215], a[216:219], v[120:123], v[212:215]
    s_add_u32 m0, s42, 0
    v_exp_f32 v210, v210
    v_mfma_f32_16x16x32_bf16 v[212:215], a[220:223], v[124:127], v[212:215]
    v_exp_f32 v211, v211
    v_mfma_f32_16x16x32_bf16 a[88:91], a[168:171], v[144:147], a[88:91]
    ds_read_b64_tr_b16 a[184:185], v27 offset:0
    v_cvt_pk_bf16_f32 v180, v208, v209
    v_mfma_f32_16x16x32_bf16 a[88:91], a[172:175], v[148:151], a[88:91]
    ds_read_b64_tr_b16 a[186:187], v27 offset:4096
    v_add_f32 v225, v225, v227
    v_mfma_f32_16x16x32_bf16 a[92:95], a[172:175], v[156:159], a[92:95]
    ds_read_b128 a[208:211], v8 offset:32768
    v_cvt_pk_bf16_f32 v181, v210, v211
    v_mfma_f32_16x16x32_bf16 a[92:95], a[168:171], v[152:155], a[92:95]
    s_waitcnt lgkmcnt(3)
    buffer_load_dwordx4 v46, s[20:23], s49 offen lds
    v_mfma_f32_16x16x32_bf16 v[208:211], a[224:227], v[64:67], v[192:195]
    v_exp_f32 v212, v212
    v_mfma_f32_16x16x32_bf16 v[208:211], a[228:231], v[68:71], v[208:211]
    v_exp_f32 v213, v213
    v_mfma_f32_16x16x32_bf16 v[208:211], a[232:235], v[72:75], v[208:211]
    v_exp_f32 v214, v214
    v_mfma_f32_16x16x32_bf16 v[208:211], a[236:239], v[76:79], v[208:211]
    s_add_u32 s37, s55, 0
    v_exp_f32 v215, v215
    v_mfma_f32_16x16x32_bf16 a[96:99], a[176:179], v[128:131], a[96:99]
    ds_read_b64_tr_b16 a[188:189], v27 offset:8192
    v_cvt_pk_bf16_f32 v188, v212, v213
    v_mfma_f32_16x16x32_bf16 a[96:99], a[180:183], v[132:135], a[96:99]
    ds_read_b64_tr_b16 a[190:191], v27 offset:12288
    v_lshrrev_b32 v245, 4, v1
    v_mfma_f32_16x16x32_bf16 a[100:103], a[180:183], v[140:143], a[100:103]
Ltour0_6:
    s_cbranch_execz Ltour0_10
    ds_read_b128 a[212:215], v9 offset:32768
    v_cvt_pk_bf16_f32 v189, v214, v215
    v_mfma_f32_16x16x32_bf16 a[100:103], a[176:179], v[136:139], a[100:103]
    buffer_load_dword v239, v238, s[28:31], s37 offen
    v_mfma_f32_16x16x32_bf16 v[212:215], a[224:227], v[80:83], v[196:199]
    v_exp_f32 v208, v208
    v_mfma_f32_16x16x32_bf16 v[212:215], a[228:231], v[84:87], v[212:215]
    v_exp_f32 v209, v209
    v_mfma_f32_16x16x32_bf16 v[212:215], a[232:235], v[88:91], v[212:215]
    v_exp_f32 v210, v210
    v_mfma_f32_16x16x32_bf16 v[212:215], a[236:239], v[92:95], v[212:215]
    v_exp_f32 v211, v211
    v_mfma_f32_16x16x32_bf16 a[104:107], a[176:179], v[144:147], a[104:107]
    ds_read_b64_tr_b16 a[160:161], v20 offset:16384
    v_cvt_pk_bf16_f32 v166, v208, v209
    v_mfma_f32_16x16x32_bf16 a[104:107], a[180:183], v[148:151], a[104:107]
    ds_read_b64_tr_b16 a[162:163], v20 offset:20480
    v_lshl_add_u32 v244, v245, 3, v244
    v_mfma_f32_16x16x32_bf16 a[108:111], a[180:183], v[156:159], a[108:111]
    ds_read_b128 a[216:219], v10 offset:32768
    v_cvt_pk_bf16_f32 v167, v210, v211
    v_mfma_f32_16x16x32_bf16 a[108:111], a[176:179], v[152:155], a[108:111]
    s_waitcnt lgkmcnt(3)
    buffer_load_dwordx4 v47, s[20:23], s49 offen offset:1024 lds
    v_mfma_f32_16x16x32_bf16 v[208:211], a[224:227], v[96:99], v[200:203]
    v_exp_f32 v212, v212
    v_mfma_f32_16x16x32_bf16 v[208:211], a[228:231], v[100:103], v[208:211]
    v_exp_f32 v213, v213
    v_mfma_f32_16x16x32_bf16 v[208:211], a[232:235], v[104:107], v[208:211]
    v_exp_f32 v214, v214
    v_mfma_f32_16x16x32_bf16 v[208:211], a[236:239], v[108:111], v[208:211]
    s_add_u32 s57, s58, 1769472
    v_exp_f32 v215, v215
    v_mfma_f32_16x16x32_bf16 a[112:115], a[184:187], v[128:131], a[112:115]
    ds_read_b64_tr_b16 a[164:165], v20 offset:24576
    v_cvt_pk_bf16_f32 v174, v212, v213
    v_mfma_f32_16x16x32_bf16 a[112:115], a[188:191], v[132:135], a[112:115]
    ds_read_b64_tr_b16 a[166:167], v20 offset:28672
    v_mfma_f32_16x16x32_bf16 a[116:119], a[188:191], v[140:143], a[116:119]
    ds_read_b128 a[220:223], v11 offset:32768
    v_cvt_pk_bf16_f32 v175, v214, v215
    v_mfma_f32_16x16x32_bf16 a[116:119], a[184:187], v[136:139], a[116:119]
    buffer_load_dwordx4 a[140:143], v254, s[80:83], s57 offen
    v_mfma_f32_16x16x32_bf16 v[212:215], a[224:227], v[112:115], v[204:207]
    v_exp_f32 v208, v208
    v_mfma_f32_16x16x32_bf16 v[212:215], a[228:231], v[116:119], v[212:215]
    v_exp_f32 v209, v209
    v_mfma_f32_16x16x32_bf16 v[212:215], a[232:235], v[120:123], v[212:215]
    v_exp_f32 v210, v210
    v_mfma_f32_16x16x32_bf16 v[212:215], a[236:239], v[124:127], v[212:215]
    v_exp_f32 v211, v211
    v_mfma_f32_16x16x32_bf16 a[120:123], a[184:187], v[144:147], a[120:123]
    ds_read_b64_tr_b16 a[168:169], v21 offset:16384
    v_cvt_pk_bf16_f32 v182, v208, v209
    v_mfma_f32_16x16x32_bf16 a[120:123], a[188:191], v[148:151], a[120:123]
    ds_read_b64_tr_b16 a[170:171], v21 offset:20480
    v_mfma_f32_16x16x32_bf16 a[124:127], a[188:191], v[156:159], a[124:127]
    ds_read_b128 a[224:227], v8 offset:36864
    v_cvt_pk_bf16_f32 v183, v210, v211
    v_mfma_f32_16x16x32_bf16 a[124:127], a[184:187], v[152:155], a[124:127]
    s_waitcnt lgkmcnt(3)
    buffer_load_dwordx4 v48, s[20:23], s49 offen offset:2048 lds
    v_mfma_f32_16x16x32_bf16 v[208:211], a[208:211], v[64:67], v[192:195]
    v_exp_f32 v212, v212
    v_mfma_f32_16x16x32_bf16 v[208:211], a[212:215], v[68:71], v[208:211]
    v_exp_f32 v213, v213
    v_mfma_f32_16x16x32_bf16 v[208:211], a[216:219], v[72:75], v[208:211]
    v_exp_f32 v214, v214
    v_mfma_f32_16x16x32_bf16 v[208:211], a[220:223], v[76:79], v[208:211]
    s_add_u32 s57, s58, 2359296
    v_exp_f32 v215, v215
    v_mfma_f32_16x16x32_bf16 a[0:3], a[160:163], v[160:163], a[0:3]
    ds_read_b64_tr_b16 a[172:173], v21 offset:24576
    v_cvt_pk_bf16_f32 v190, v212, v213
    v_mfma_f32_16x16x32_bf16 a[0:3], a[164:167], v[164:167], a[0:3]
    ds_read_b64_tr_b16 a[174:175], v21 offset:28672
    v_mov_b32 v63, 0
    v_mfma_f32_16x16x32_bf16 a[4:7], a[164:167], v[172:175], a[4:7]
    ds_read_b128 a[228:231], v9 offset:36864
    v_cvt_pk_bf16_f32 v191, v214, v215
    v_mfma_f32_16x16x32_bf16 a[4:7], a[160:163], v[168:171], a[4:7]
    buffer_load_dwordx4 a[144:147], v254, s[80:83], s57 offen
    v_mfma_f32_16x16x32_bf16 v[212:215], a[208:211], v[80:83], v[196:199]
    v_exp_f32 v208, v208
    v_mfma_f32_16x16x32_bf16 v[212:215], a[212:215], v[84:87], v[212:215]
    v_exp_f32 v209, v209
    v_mfma_f32_16x16x32_bf16 v[212:215], a[216:219], v[88:91], v[212:215]
    v_exp_f32 v210, v210
    v_mfma_f32_16x16x32_bf16 v[212:215], a[220:223], v[92:95], v[212:215]
    v_exp_f32 v211, v211
    v_mfma_f32_16x16x32_bf16 a[8:11], a[160:163], v[176:179], a[8:11]
    ds_read_b64_tr_b16 a[176:177], v22 offset:16384
    v_cvt_pk_bf16_f32 v128, v208, v209
    v_mfma_f32_16x16x32_bf16 a[8:11], a[164:167], v[180:183], a[8:11]
    ds_read_b64_tr_b16 a[178:179], v22 offset:20480
    v_add_f32_dpp v224, v224, v224 row_ror:2 row_mask:0xf bank_mask:0xf
    v_mfma_f32_16x16x32_bf16 a[12:15], a[164:167], v[188:191], a[12:15]
    ds_read_b128 a[232:235], v10 offset:36864
    v_cvt_pk_bf16_f32 v129, v210, v211
    v_mfma_f32_16x16x32_bf16 a[12:15], a[160:163], v[184:187], a[12:15]
    s_waitcnt lgkmcnt(3)
    buffer_load_dwordx4 v49, s[20:23], s49 offen offset:3072 lds
    v_mfma_f32_16x16x32_bf16 v[208:211], a[208:211], v[96:99], v[200:203]
    s_lshr_b32 s39, s2, 5
    v_exp_f32 v212, v212
    v_mfma_f32_16x16x32_bf16 v[208:211], a[212:215], v[100:103], v[208:211]
    s_lshl_b32 s39, s39, 3
    v_exp_f32 v213, v213
    v_mfma_f32_16x16x32_bf16 v[208:211], a[216:219], v[104:107], v[208:211]
    s_and_b32 s43, s2, 7
    v_exp_f32 v214, v214
    v_mfma_f32_16x16x32_bf16 v[208:211], a[220:223], v[108:111], v[208:211]
    s_add_u32 s39, s39, s43
    v_exp_f32 v215, v215
    v_mfma_f32_16x16x32_bf16 a[16:19], a[168:171], v[160:163], a[16:19]
    ds_read_b64_tr_b16 a[180:181], v22 offset:24576
    v_cvt_pk_bf16_f32 v136, v212, v213
    v_mfma_f32_16x16x32_bf16 a[16:19], a[172:175], v[164:167], a[16:19]
    ds_read_b64_tr_b16 a[182:183], v22 offset:28672
    v_add_f32_dpp v225, v225, v225 row_ror:2 row_mask:0xf bank_mask:0xf
    v_mfma_f32_16x16x32_bf16 a[20:23], a[172:175], v[172:175], a[20:23]
    ds_read_b128 a[236:239], v11 offset:36864
    v_cvt_pk_bf16_f32 v137, v214, v215
    v_mfma_f32_16x16x32_bf16 a[20:23], a[168:171], v[168:171], a[20:23]
    buffer_load_dword v253, v63, s[24:27], s54 offen offset:12 sc1
    v_smfmac_f32_16x16x64_bf16 a[192:195], v[52:55], v[160:167], v50
    v_mfma_f32_16x16x32_bf16 v[212:215], a[208:211], v[112:115], v[204:207]
    s_lshl_b32 s39, s39, 2
    v_exp_f32 v208, v208
    v_mfma_f32_16x16x32_bf16 v[212:215], a[212:215], v[116:119], v[212:215]
    s_add_u32 m0, s42, 114688
    v_exp_f32 v209, v209
    v_mfma_f32_16x16x32_bf16 v[212:215], a[216:219], v[120:123], v[212:215]
    s_bfe_u32 s43, s2, 0x20003
    v_exp_f32 v210, v210
    v_mfma_f32_16x16x32_bf16 v[212:215], a[220:223], v[124:127], v[212:215]
    s_add_u32 s39, s39, s43
    v_exp_f32 v211, v211
    v_mfma_f32_16x16x32_bf16 a[24:27], a[168:171], v[176:179], a[24:27]
    ds_read_b64_tr_b16 a[184:185], v23 offset:16384
    v_cvt_pk_bf16_f32 v144, v208, v209
    v_mfma_f32_16x16x32_bf16 a[24:27], a[172:175], v[180:183], a[24:27]
    ds_read_b64_tr_b16 a[186:187], v23 offset:20480
    v_add_f32_dpp v224, v224, v224 row_ror:4 row_mask:0xf bank_mask:0xf
    v_mfma_f32_16x16x32_bf16 a[28:31], a[172:175], v[188:191], a[28:31]
    ds_read_b128 a[208:211], v8 offset:40960
    v_cvt_pk_bf16_f32 v145, v210, v211
    v_mfma_f32_16x16x32_bf16 a[28:31], a[168:171], v[184:187], a[28:31]
    s_waitcnt lgkmcnt(3)
    buffer_load_dwordx4 v40, s[12:15], s41 offen lds
    v_mfma_f32_16x16x32_bf16 v[208:211], a[224:227], v[64:67], v[192:195]
    s_add_u32 s39, s39, 72
    v_exp_f32 v212, v212
    v_mfma_f32_16x16x32_bf16 v[208:211], a[228:231], v[68:71], v[208:211]
    s_cmp_lt_u32 s39, 216
    s_cselect_b32 s43, 0, 2147483648
    v_exp_f32 v213, v213
    v_mfma_f32_16x16x32_bf16 v[208:211], a[232:235], v[72:75], v[208:211]
    s_or_b32 s43, s43, s48
    v_exp_f32 v214, v214
    v_mfma_f32_16x16x32_bf16 v[208:211], a[236:239], v[76:79], v[208:211]
    s_add_u32 s57, s58, 2949120
    v_exp_f32 v215, v215
    v_mfma_f32_16x16x32_bf16 a[32:35], a[176:179], v[160:163], a[32:35]
    ds_read_b64_tr_b16 a[188:189], v23 offset:24576
    v_cvt_pk_bf16_f32 v152, v212, v213
    v_mfma_f32_16x16x32_bf16 a[32:35], a[180:183], v[164:167], a[32:35]
    ds_read_b64_tr_b16 a[190:191], v23 offset:28672
    v_add_f32_dpp v225, v225, v225 row_ror:4 row_mask:0xf bank_mask:0xf
    v_mfma_f32_16x16x32_bf16 a[36:39], a[180:183], v[172:175], a[36:39]
    ds_read_b128 a[212:215], v9 offset:40960
    v_cvt_pk_bf16_f32 v153, v214, v215
    v_mfma_f32_16x16x32_bf16 a[36:39], a[176:179], v[168:171], a[36:39]
    buffer_load_dwordx4 a[148:151], v254, s[80:83], s57 offen
    v_smfmac_f32_16x16x64_bf16 a[196:199], v[52:55], v[168:175], v50
    v_mfma_f32_16x16x32_bf16 v[212:215], a[224:227], v[80:83], v[196:199]
    s_and_b32 s43, s43, 2147483648
    v_exp_f32 v208, v208
    v_mfma_f32_16x16x32_bf16 v[212:215], a[228:231], v[84:87], v[212:215]
    s_sub_u32 s36, s39, 144
    v_exp_f32 v209, v209
    v_mfma_f32_16x16x32_bf16 v[212:215], a[232:235], v[88:91], v[212:215]
    s_cmp_lt_u32 s36, 36
    s_cselect_b32 s36, 1.0, 0
    v_exp_f32 v210, v210
    v_mfma_f32_16x16x32_bf16 v[212:215], a[236:239], v[92:95], v[212:215]
    s_lshr_b32 s44, s39, 1
    v_exp_f32 v211, v211
    v_mfma_f32_16x16x32_bf16 a[40:43], a[176:179], v[176:179], a[40:43]
    ds_read_b64_tr_b16 a[160:161], v24 offset:16384
    v_cvt_pk_bf16_f32 v130, v208, v209
    v_mfma_f32_16x16x32_bf16 a[40:43], a[180:183], v[180:183], a[40:43]
    ds_read_b64_tr_b16 a[162:163], v24 offset:20480
    v_add_f32_dpp v224, v224, v224 row_ror:8 row_mask:0xf bank_mask:0xf
    v_mfma_f32_16x16x32_bf16 a[44:47], a[180:183], v[188:191], a[44:47]
    ds_read_b128 a[216:219], v10 offset:40960
    v_cvt_pk_bf16_f32 v131, v210, v211
    v_mfma_f32_16x16x32_bf16 a[44:47], a[176:179], v[184:187], a[44:47]
    s_waitcnt lgkmcnt(3)
    buffer_load_dwordx4 v41, s[12:15], s41 offen offset:1024 lds
    v_mfma_f32_16x16x32_bf16 v[208:211], a[224:227], v[96:99], v[200:203]
    s_lshl_b32 s44, s44, 6
    v_exp_f32 v212, v212
    v_mfma_f32_16x16x32_bf16 v[208:211], a[228:231], v[100:103], v[208:211]
    s_and_b32 s39, s39, 1
    v_exp_f32 v213, v213
    v_mfma_f32_16x16x32_bf16 v[208:211], a[232:235], v[104:107], v[208:211]
    s_lshl_b32 s39, s39, 3
    v_exp_f32 v214, v214
    v_mfma_f32_16x16x32_bf16 v[208:211], a[236:239], v[108:111], v[208:211]
    s_add_u32 s39, s39, s44
    v_exp_f32 v215, v215
    v_mfma_f32_16x16x32_bf16 a[48:51], a[184:187], v[160:163], a[48:51]
    ds_read_b64_tr_b16 a[164:165], v24 offset:24576
    v_cvt_pk_bf16_f32 v138, v212, v213
    v_mfma_f32_16x16x32_bf16 a[48:51], a[188:191], v[164:167], a[48:51]
    ds_read_b64_tr_b16 a[166:167], v24 offset:28672
    v_add_f32_dpp v225, v225, v225 row_ror:8 row_mask:0xf bank_mask:0xf
    v_mfma_f32_16x16x32_bf16 a[52:55], a[188:191], v[172:175], a[52:55]
    ds_read_b128 a[220:223], v11 offset:40960
    v_cvt_pk_bf16_f32 v139, v214, v215
    v_mfma_f32_16x16x32_bf16 a[52:55], a[184:187], v[168:171], a[52:55]
    v_add_u32 v244, s38, v244
    v_and_b32 v245, 7, v1
    v_smfmac_f32_16x16x64_bf16 a[200:203], v[52:55], v[176:183], v50
    v_mfma_f32_16x16x32_bf16 v[212:215], a[224:227], v[112:115], v[204:207]
    s_add_u32 s39, s39, 16384
    v_exp_f32 v208, v208
    v_mfma_f32_16x16x32_bf16 v[212:215], a[228:231], v[116:119], v[212:215]
    s_or_b32 s39, s39, s43
    v_exp_f32 v209, v209
    v_mfma_f32_16x16x32_bf16 v[212:215], a[232:235], v[120:123], v[212:215]
    v_exp_f32 v210, v210
    v_mfma_f32_16x16x32_bf16 v[212:215], a[236:239], v[124:127], v[212:215]
    v_exp_f32 v211, v211
    v_mfma_f32_16x16x32_bf16 a[56:59], a[184:187], v[176:179], a[56:59]
    ds_read_b64_tr_b16 a[168:169], v25 offset:16384
    v_cvt_pk_bf16_f32 v146, v208, v209
    v_mfma_f32_16x16x32_bf16 a[56:59], a[188:191], v[180:183], a[56:59]
    ds_read_b64_tr_b16 a[170:171], v25 offset:20480
    v_mfma_f32_16x16x32_bf16 a[60:63], a[188:191], v[188:191], a[60:63]
    ds_read_b128 a[224:227], v8 offset:45056
    v_cvt_pk_bf16_f32 v147, v210, v211
    v_mfma_f32_16x16x32_bf16 a[60:63], a[184:187], v[184:187], a[60:63]
    s_waitcnt lgkmcnt(3)
    buffer_load_dwordx4 v40, s[12:15], s41 offen offset:2048 lds
    v_mfma_f32_16x16x32_bf16 v[208:211], a[208:211], v[64:67], v[192:195]
    v_exp_f32 v212, v212
    v_mfma_f32_16x16x32_bf16 v[208:211], a[212:215], v[68:71], v[208:211]
    v_exp_f32 v213, v213
    v_mfma_f32_16x16x32_bf16 v[208:211], a[216:219], v[72:75], v[208:211]
    v_exp_f32 v214, v214
    v_mfma_f32_16x16x32_bf16 v[208:211], a[220:223], v[76:79], v[208:211]
    s_add_u32 s57, s58, 3538944
    v_exp_f32 v215, v215
    v_mfma_f32_16x16x32_bf16 a[64:67], a[160:163], v[160:163], a[64:67]
    ds_read_b64_tr_b16 a[172:173], v25 offset:24576
    v_cvt_pk_bf16_f32 v154, v212, v213
    v_mfma_f32_16x16x32_bf16 a[64:67], a[164:167], v[164:167], a[64:67]
    ds_read_b64_tr_b16 a[174:175], v25 offset:28672
    v_lshlrev_b32 v245, 3, v245
    v_mfma_f32_16x16x32_bf16 a[68:71], a[164:167], v[172:175], a[68:71]
    ds_read_b128 a[228:231], v9 offset:45056
    v_cvt_pk_bf16_f32 v155, v214, v215
    v_mfma_f32_16x16x32_bf16 a[68:71], a[160:163], v[168:171], a[68:71]
    buffer_load_dwordx4 a[152:155], v254, s[80:83], s57 offen
    v_smfmac_f32_16x16x64_bf16 a[204:207], v[52:55], v[184:191], v50
    ds_write_b64 v244, v[224:225]
    v_mfma_f32_16x16x32_bf16 v[212:215], a[208:211], v[80:83], v[196:199]
    v_exp_f32 v208, v208
    v_mfma_f32_16x16x32_bf16 v[212:215], a[212:215], v[84:87], v[212:215]
    v_exp_f32 v209, v209
    v_mfma_f32_16x16x32_bf16 v[212:215], a[216:219], v[88:91], v[212:215]
    v_exp_f32 v210, v210
    v_mfma_f32_16x16x32_bf16 v[212:215], a[220:223], v[92:95], v[212:215]
    v_exp_f32 v211, v211
    v_mfma_f32_16x16x32_bf16 a[72:75], a[160:163], v[176:179], a[72:75]
    ds_read_b64_tr_b16 a[176:177], v26 offset:16384
    v_cvt_pk_bf16_f32 v132, v208, v209
    v_mfma_f32_16x16x32_bf16 a[72:75], a[164:167], v[180:183], a[72:75]
    ds_read_b64_tr_b16 a[178:179], v26 offset:20480
    v_add_u32 v245, 131136, v245
    v_mfma_f32_16x16x32_bf16 a[76:79], a[164:167], v[188:191], a[76:79]
    ds_read_b128 a[232:235], v10 offset:45056
    v_cvt_pk_bf16_f32 v133, v210, v211
    v_mfma_f32_16x16x32_bf16 a[76:79], a[160:163], v[184:187], a[76:79]
    s_waitcnt lgkmcnt(3)
    buffer_load_dwordx4 v41, s[12:15], s41 offen offset:3072 lds
    v_mfma_f32_16x16x32_bf16 v[208:211], a[208:211], v[96:99], v[200:203]
    v_exp_f32 v212, v212
    v_mfma_f32_16x16x32_bf16 v[208:211], a[212:215], v[100:103], v[208:211]
    s_add_u32 s41, s41, 16384
    v_exp_f32 v213, v213
    v_mfma_f32_16x16x32_bf16 v[208:211], a[216:219], v[104:107], v[208:211]
    v_exp_f32 v214, v214
    v_mfma_f32_16x16x32_bf16 v[208:211], a[220:223], v[108:111], v[208:211]
    v_exp_f32 v215, v215
    v_mfma_f32_16x16x32_bf16 a[80:83], a[168:171], v[160:163], a[80:83]
    ds_read_b64_tr_b16 a[180:181], v26 offset:24576
    v_cvt_pk_bf16_f32 v140, v212, v213
    v_mfma_f32_16x16x32_bf16 a[80:83], a[172:175], v[164:167], a[80:83]
    ds_read_b64_tr_b16 a[182:183], v26 offset:28672
    v_mfma_f32_16x16x32_bf16 a[84:87], a[172:175], v[172:175], a[84:87]
    ds_read_b128 a[236:239], v11 offset:45056
    v_cvt_pk_bf16_f32 v141, v214, v215
    v_mfma_f32_16x16x32_bf16 a[84:87], a[168:171], v[168:171], a[84:87]
    s_waitcnt vmcnt(14)
    s_barrier
    v_mfma_f32_16x16x32_bf16 v[212:215], a[208:211], v[112:115], v[204:207]
    v_exp_f32 v208, v208
    v_mfma_f32_16x16x32_bf16 v[212:215], a[212:215], v[116:119], v[212:215]
    s_add_u32 s49, s45, 74752
    v_exp_f32 v209, v209
    v_mfma_f32_16x16x32_bf16 v[212:215], a[216:219], v[120:123], v[212:215]
    s_add_u32 m0, s42, 16384
    v_exp_f32 v210, v210
    v_mfma_f32_16x16x32_bf16 v[212:215], a[220:223], v[124:127], v[212:215]
    v_exp_f32 v211, v211
    v_mfma_f32_16x16x32_bf16 a[88:91], a[168:171], v[176:179], a[88:91]
    ds_read_b64_tr_b16 a[184:185], v27 offset:16384
    v_cvt_pk_bf16_f32 v148, v208, v209
    v_mfma_f32_16x16x32_bf16 a[88:91], a[172:175], v[180:183], a[88:91]
    ds_read_b64_tr_b16 a[186:187], v27 offset:20480
    ds_read_b64 v[224:225], v245 offset:0
    v_mfma_f32_16x16x32_bf16 a[92:95], a[172:175], v[188:191], a[92:95]
    ds_read_b128 a[208:211], v8 offset:49152
    v_cvt_pk_bf16_f32 v149, v210, v211
    v_mfma_f32_16x16x32_bf16 a[92:95], a[168:171], v[184:187], a[92:95]
    s_waitcnt lgkmcnt(3)
    buffer_load_dwordx4 v46, s[20:23], s49 offen lds
    v_mfma_f32_16x16x32_bf16 v[208:211], a[224:227], v[64:67], v[192:195]
    v_exp_f32 v212, v212
    v_mfma_f32_16x16x32_bf16 v[208:211], a[228:231], v[68:71], v[208:211]
    v_exp_f32 v213, v213
    v_mfma_f32_16x16x32_bf16 v[208:211], a[232:235], v[72:75], v[208:211]
    v_exp_f32 v214, v214
    v_mfma_f32_16x16x32_bf16 v[208:211], a[236:239], v[76:79], v[208:211]
    s_add_u32 s37, s55, 8192
    v_exp_f32 v215, v215
    v_mfma_f32_16x16x32_bf16 a[96:99], a[176:179], v[160:163], a[96:99]
    ds_read_b64_tr_b16 a[188:189], v27 offset:24576
    v_cvt_pk_bf16_f32 v156, v212, v213
    v_mfma_f32_16x16x32_bf16 a[96:99], a[180:183], v[164:167], a[96:99]
    ds_read_b64_tr_b16 a[190:191], v27 offset:28672
    ds_read_b64 v[226:227], v245 offset:64
    v_mfma_f32_16x16x32_bf16 a[100:103], a[180:183], v[172:175], a[100:103]
    ds_read_b128 a[212:215], v9 offset:49152
    v_cvt_pk_bf16_f32 v157, v214, v215
    v_mfma_f32_16x16x32_bf16 a[100:103], a[176:179], v[168:171], a[100:103]
    buffer_load_dword v234, v238, s[28:31], s37 offen
    v_mfma_f32_16x16x32_bf16 v[212:215], a[224:227], v[80:83], v[196:199]
    v_exp_f32 v208, v208
    v_mfma_f32_16x16x32_bf16 v[212:215], a[228:231], v[84:87], v[212:215]
    v_exp_f32 v209, v209
    v_mfma_f32_16x16x32_bf16 v[212:215], a[232:235], v[88:91], v[212:215]
    v_exp_f32 v210, v210
    v_mfma_f32_16x16x32_bf16 v[212:215], a[236:239], v[92:95], v[212:215]
    v_exp_f32 v211, v211
    v_mfma_f32_16x16x32_bf16 a[104:107], a[176:179], v[176:179], a[104:107]
    ds_read_b64_tr_b16 a[160:161], v20 offset:32768
    v_cvt_pk_bf16_f32 v134, v208, v209
    v_mfma_f32_16x16x32_bf16 a[104:107], a[180:183], v[180:183], a[104:107]
    ds_read_b64_tr_b16 a[162:163], v20 offset:36864
    ds_read_b64 v[228:229], v245 offset:128
    v_mfma_f32_16x16x32_bf16 a[108:111], a[180:183], v[188:191], a[108:111]
    ds_read_b128 a[216:219], v10 offset:49152
    v_cvt_pk_bf16_f32 v135, v210, v211
    v_mfma_f32_16x16x32_bf16 a[108:111], a[176:179], v[184:187], a[108:111]
    s_waitcnt lgkmcnt(3)
    buffer_load_dwordx4 v47, s[20:23], s49 offen offset:1024 lds
    v_mfma_f32_16x16x32_bf16 v[208:211], a[224:227], v[96:99], v[200:203]
    v_exp_f32 v212, v212
    v_mfma_f32_16x16x32_bf16 v[208:211], a[228:231], v[100:103], v[208:211]
    v_exp_f32 v213, v213
    v_mfma_f32_16x16x32_bf16 v[208:211], a[232:235], v[104:107], v[208:211]
    v_exp_f32 v214, v214
    v_mfma_f32_16x16x32_bf16 v[208:211], a[236:239], v[108:111], v[208:211]
    s_add_u32 s57, s58, 4128768
    v_exp_f32 v215, v215
    v_mfma_f32_16x16x32_bf16 a[112:115], a[184:187], v[160:163], a[112:115]
    ds_read_b64_tr_b16 a[164:165], v20 offset:40960
    v_cvt_pk_bf16_f32 v142, v212, v213
    v_mfma_f32_16x16x32_bf16 a[112:115], a[188:191], v[164:167], a[112:115]
    ds_read_b64_tr_b16 a[166:167], v20 offset:45056
    ds_read_b64 v[230:231], v245 offset:192
    v_mfma_f32_16x16x32_bf16 a[116:119], a[188:191], v[172:175], a[116:119]
    ds_read_b128 a[220:223], v11 offset:49152
    v_cvt_pk_bf16_f32 v143, v214, v215
    v_mfma_f32_16x16x32_bf16 a[116:119], a[184:187], v[168:171], a[116:119]
    buffer_load_dwordx4 a[156:159], v254, s[80:83], s57 offen
    v_mfma_f32_16x16x32_bf16 v[212:215], a[224:227], v[112:115], v[204:207]
    v_exp_f32 v208, v208
    v_mfma_f32_16x16x32_bf16 v[212:215], a[228:231], v[116:119], v[212:215]
    v_exp_f32 v209, v209
    v_mfma_f32_16x16x32_bf16 v[212:215], a[232:235], v[120:123], v[212:215]
    v_exp_f32 v210, v210
    v_mfma_f32_16x16x32_bf16 v[212:215], a[236:239], v[124:127], v[212:215]
    v_exp_f32 v211, v211
    v_mfma_f32_16x16x32_bf16 a[120:123], a[184:187], v[176:179], a[120:123]
    ds_read_b64_tr_b16 a[168:169], v21 offset:32768
    v_cvt_pk_bf16_f32 v150, v208, v209
    v_mfma_f32_16x16x32_bf16 a[120:123], a[188:191], v[180:183], a[120:123]
    ds_read_b64_tr_b16 a[170:171], v21 offset:36864
    v_mfma_f32_16x16x32_bf16 a[124:127], a[188:191], v[188:191], a[124:127]
    ds_read_b128 a[224:227], v8 offset:53248
    v_cvt_pk_bf16_f32 v151, v210, v211
    v_mfma_f32_16x16x32_bf16 a[124:127], a[184:187], v[184:187], a[124:127]
    s_waitcnt lgkmcnt(3)
    buffer_load_dwordx4 v48, s[20:23], s49 offen offset:2048 lds
    v_mfma_f32_16x16x32_bf16 v[208:211], a[208:211], v[64:67], v[192:195]
    v_exp_f32 v212, v212
    v_mfma_f32_16x16x32_bf16 v[208:211], a[212:215], v[68:71], v[208:211]
    v_exp_f32 v213, v213
    v_mfma_f32_16x16x32_bf16 v[208:211], a[216:219], v[72:75], v[208:211]
    v_exp_f32 v214, v214
    v_mfma_f32_16x16x32_bf16 v[208:211], a[220:223], v[76:79], v[208:211]
    s_add_u32 s57, s58, 4718592
    v_exp_f32 v215, v215
    v_mfma_f32_16x16x32_bf16 a[0:3], a[160:163], v[128:131], a[0:3]
    ds_read_b64_tr_b16 a[172:173], v21 offset:40960
    v_cvt_pk_bf16_f32 v158, v212, v213
    v_mfma_f32_16x16x32_bf16 a[0:3], a[164:167], v[132:135], a[0:3]
    ds_read_b64_tr_b16 a[174:175], v21 offset:45056
    v_add_f32 v224, v224, v228
    v_mfma_f32_16x16x32_bf16 a[4:7], a[164:167], v[140:143], a[4:7]
    ds_read_b128 a[228:231], v9 offset:53248
    v_cvt_pk_bf16_f32 v159, v214, v215
    v_mfma_f32_16x16x32_bf16 a[4:7], a[160:163], v[136:139], a[4:7]
    buffer_load_dwordx4 a[240:243], v254, s[80:83], s57 offen
    v_mfma_f32_16x16x32_bf16 v[212:215], a[208:211], v[80:83], v[196:199]
    v_exp_f32 v208, v208
    v_mfma_f32_16x16x32_bf16 v[212:215], a[212:215], v[84:87], v[212:215]
    v_exp_f32 v209, v209
    v_mfma_f32_16x16x32_bf16 v[212:215], a[216:219], v[88:91], v[212:215]
    v_exp_f32 v210, v210
    v_mfma_f32_16x16x32_bf16 v[212:215], a[220:223], v[92:95], v[212:215]
    v_exp_f32 v211, v211
    v_mfma_f32_16x16x32_bf16 a[8:11], a[160:163], v[144:147], a[8:11]
    ds_read_b64_tr_b16 a[176:177], v22 offset:32768
    v_cvt_pk_bf16_f32 v160, v208, v209
    v_mfma_f32_16x16x32_bf16 a[8:11], a[164:167], v[148:151], a[8:11]
    ds_read_b64_tr_b16 a[178:179], v22 offset:36864
    v_add_f32 v225, v225, v229
    v_mfma_f32_16x16x32_bf16 a[12:15], a[164:167], v[156:159], a[12:15]
    ds_read_b128 a[232:235], v10 offset:53248
    v_cvt_pk_bf16_f32 v161, v210, v211
    v_mfma_f32_16x16x32_bf16 a[12:15], a[160:163], v[152:155], a[12:15]
    s_waitcnt lgkmcnt(3)
    buffer_load_dwordx4 v49, s[20:23], s49 offen offset:3072 lds
    v_mfma_f32_16x16x32_bf16 v[208:211], a[208:211], v[96:99], v[200:203]
    v_exp_f32 v212, v212
    v_mfma_f32_16x16x32_bf16 v[208:211], a[212:215], v[100:103], v[208:211]
    v_exp_f32 v213, v213
    v_mfma_f32_16x16x32_bf16 v[208:211], a[216:219], v[104:107], v[208:211]
    v_exp_f32 v214, v214
    v_mfma_f32_16x16x32_bf16 v[208:211], a[220:223], v[108:111], v[208:211]
    v_exp_f32 v215, v215
    v_mfma_f32_16x16x32_bf16 a[16:19], a[168:171], v[128:131], a[16:19]
    ds_read_b64_tr_b16 a[180:181], v22 offset:40960
    v_cvt_pk_bf16_f32 v168, v212, v213
    v_mfma_f32_16x16x32_bf16 a[16:19], a[172:175], v[132:135], a[16:19]
    ds_read_b64_tr_b16 a[182:183], v22 offset:45056
    v_add_f32 v226, v226, v230
    v_mfma_f32_16x16x32_bf16 a[20:23], a[172:175], v[140:143], a[20:23]
    ds_read_b128 a[236:239], v11 offset:53248
    v_cvt_pk_bf16_f32 v169, v214, v215
    v_mfma_f32_16x16x32_bf16 a[20:23], a[168:171], v[136:139], a[20:23]
    v_add_f32 v227, v227, v231
    v_add_f32 v224, v224, v226
    v_smfmac_f32_16x16x64_bf16 a[192:195], v[52:55], v[128:135], v50
    v_mfma_f32_16x16x32_bf16 v[212:215], a[208:211], v[112:115], v[204:207]
    v_exp_f32 v208, v208
    v_mfma_f32_16x16x32_bf16 v[212:215], a[212:215], v[116:119], v[212:215]
    s_add_u32 s49, s7, 0
    v_exp_f32 v209, v209
    v_mfma_f32_16x16x32_bf16 v[212:215], a[216:219], v[120:123], v[212:215]
    s_add_u32 m0, s42, 65536
    v_exp_f32 v210, v210
    v_mfma_f32_16x16x32_bf16 v[212:215], a[220:223], v[124:127], v[212:215]
    v_exp_f32 v211, v211
    v_mfma_f32_16x16x32_bf16 a[24:27], a[168:171], v[144:147], a[24:27]
    ds_read_b64_tr_b16 a[184:185], v23 offset:32768
    v_cvt_pk_bf16_f32 v176, v208, v209
    v_mfma_f32_16x16x32_bf16 a[24:27], a[172:175], v[148:151], a[24:27]
    ds_read_b64_tr_b16 a[186:187], v23 offset:36864
    v_add_f32 v225, v225, v227
    v_mfma_f32_16x16x32_bf16 a[28:31], a[172:175], v[156:159], a[28:31]
    ds_read_b128 a[208:211], v8 offset:57344
    v_cvt_pk_bf16_f32 v177, v210, v211
    v_mfma_f32_16x16x32_bf16 a[28:31], a[168:171], v[152:155], a[28:31]
    s_waitcnt lgkmcnt(3)
    buffer_load_dwordx4 v46, s[20:23], s49 offen lds
    v_mfma_f32_16x16x32_bf16 v[208:211], a[224:227], v[64:67], v[192:195]
    v_exp_f32 v212, v212
    v_mfma_f32_16x16x32_bf16 v[208:211], a[228:231], v[68:71], v[208:211]
    v_exp_f32 v213, v213
    v_mfma_f32_16x16x32_bf16 v[208:211], a[232:235], v[72:75], v[208:211]
    v_exp_f32 v214, v214
    v_mfma_f32_16x16x32_bf16 v[208:211], a[236:239], v[76:79], v[208:211]
    s_add_u32 s57, s58, 4128768
    v_exp_f32 v215, v215
    v_mfma_f32_16x16x32_bf16 a[32:35], a[176:179], v[128:131], a[32:35]
    ds_read_b64_tr_b16 a[188:189], v23 offset:40960
    v_cvt_pk_bf16_f32 v184, v212, v213
    v_mfma_f32_16x16x32_bf16 a[32:35], a[180:183], v[132:135], a[32:35]
    ds_read_b64_tr_b16 a[190:191], v23 offset:45056
    v_cvt_pk_bf16_f32 v246, v224, v225
    v_mfma_f32_16x16x32_bf16 a[36:39], a[180:183], v[140:143], a[36:39]
    ds_read_b128 a[212:215], v9 offset:57344
    v_cvt_pk_bf16_f32 v185, v214, v215
    v_mfma_f32_16x16x32_bf16 a[36:39], a[176:179], v[136:139], a[36:39]
    buffer_load_dwordx4 a[244:247], v254, s[32:35], s57 offen
    v_smfmac_f32_16x16x64_bf16 a[196:199], v[52:55], v[136:143], v50
    v_lshrrev_b32 v222, 5, v0
    v_mfma_f32_16x16x32_bf16 v[212:215], a[224:227], v[80:83], v[196:199]
    s_getpc_b64 s[16:17]
Lattn_pc2:
    v_exp_f32 v208, v208
    v_mfma_f32_16x16x32_bf16 v[212:215], a[228:231], v[84:87], v[212:215]
    s_mov_b32 s18, Lattn_redo-Lattn_pc2
    v_exp_f32 v209, v209
    v_mfma_f32_16x16x32_bf16 v[212:215], a[232:235], v[88:91], v[212:215]
    s_lshr_b32 s37, s2, 3
    v_exp_f32 v210, v210
    v_mfma_f32_16x16x32_bf16 v[212:215], a[236:239], v[92:95], v[212:215]
    v_exp_f32 v211, v211
    v_mfma_f32_16x16x32_bf16 a[40:43], a[176:179], v[144:147], a[40:43]
    ds_read_b64_tr_b16 a[160:161], v24 offset:32768
    v_cvt_pk_bf16_f32 v162, v208, v209
    v_mfma_f32_16x16x32_bf16 a[40:43], a[180:183], v[148:151], a[40:43]
    ds_read_b64_tr_b16 a[162:163], v24 offset:36864
    v_lshlrev_b32 v222, 12, v222
    v_mfma_f32_16x16x32_bf16 a[44:47], a[180:183], v[156:159], a[44:47]
    ds_read_b128 a[216:219], v10 offset:57344
    v_cvt_pk_bf16_f32 v163, v210, v211
    v_mfma_f32_16x16x32_bf16 a[44:47], a[176:179], v[152:155], a[44:47]
    s_waitcnt lgkmcnt(3)
    buffer_load_dwordx4 v47, s[20:23], s49 offen offset:1024 lds
    v_mfma_f32_16x16x32_bf16 v[208:211], a[224:227], v[96:99], v[200:203]
    s_lshl_b32 s37, s37, 7
    v_exp_f32 v212, v212
    v_mfma_f32_16x16x32_bf16 v[208:211], a[228:231], v[100:103], v[208:211]
    v_exp_f32 v213, v213
    v_mfma_f32_16x16x32_bf16 v[208:211], a[232:235], v[104:107], v[208:211]
    v_exp_f32 v214, v214
    v_mfma_f32_16x16x32_bf16 v[208:211], a[236:239], v[108:111], v[208:211]
    v_exp_f32 v215, v215
    v_mfma_f32_16x16x32_bf16 a[48:51], a[184:187], v[128:131], a[48:51]
    ds_read_b64_tr_b16 a[164:165], v24 offset:40960
    v_cvt_pk_bf16_f32 v170, v212, v213
    v_mfma_f32_16x16x32_bf16 a[48:51], a[188:191], v[132:135], a[48:51]
    ds_read_b64_tr_b16 a[166:167], v24 offset:45056
    v_lshlrev_b32 v224, 16, v246
    v_mfma_f32_16x16x32_bf16 a[52:55], a[188:191], v[140:143], a[52:55]
    ds_read_b128 a[220:223], v11 offset:57344
    v_cvt_pk_bf16_f32 v171, v214, v215
    v_mfma_f32_16x16x32_bf16 a[52:55], a[184:187], v[136:139], a[52:55]
    buffer_load_dword v222, v222, s[16:19], s37 offen
    v_smfmac_f32_16x16x64_bf16 a[200:203], v[52:55], v[144:151], v50
    v_mfma_f32_16x16x32_bf16 v[212:215], a[224:227], v[112:115], v[204:207]
    v_exp_f32 v208, v208
    v_mfma_f32_16x16x32_bf16 v[212:215], a[228:231], v[116:119], v[212:215]
    v_exp_f32 v209, v209
    v_mfma_f32_16x16x32_bf16 v[212:215], a[232:235], v[120:123], v[212:215]
    v_exp_f32 v210, v210
    v_mfma_f32_16x16x32_bf16 v[212:215], a[236:239], v[124:127], v[212:215]
    v_exp_f32 v211, v211
    v_mfma_f32_16x16x32_bf16 a[56:59], a[184:187], v[144:147], a[56:59]
    ds_read_b64_tr_b16 a[168:169], v25 offset:32768
    v_cvt_pk_bf16_f32 v178, v208, v209
    v_mfma_f32_16x16x32_bf16 a[56:59], a[188:191], v[148:151], a[56:59]
    ds_read_b64_tr_b16 a[170:171], v25 offset:36864
    v_and_b32 v225, 0xffff0000, v246
    v_mfma_f32_16x16x32_bf16 a[60:63], a[188:191], v[156:159], a[60:63]
    ds_read_b128 a[224:227], v8 offset:61440
    v_cvt_pk_bf16_f32 v179, v210, v211
    v_mfma_f32_16x16x32_bf16 a[60:63], a[184:187], v[152:155], a[60:63]
    s_waitcnt lgkmcnt(3)
    buffer_load_dwordx4 v48, s[20:23], s49 offen offset:2048 lds
    v_mfma_f32_16x16x32_bf16 v[208:211], a[208:211], v[64:67], v[192:195]
    v_exp_f32 v212, v212
    v_mfma_f32_16x16x32_bf16 v[208:211], a[212:215], v[68:71], v[208:211]
    v_exp_f32 v213, v213
    v_mfma_f32_16x16x32_bf16 v[208:211], a[216:219], v[72:75], v[208:211]
    v_exp_f32 v214, v214
    v_mfma_f32_16x16x32_bf16 v[208:211], a[220:223], v[76:79], v[208:211]
    s_add_u32 s57, s58, 4718592
    v_exp_f32 v215, v215
    v_mfma_f32_16x16x32_bf16 a[64:67], a[160:163], v[128:131], a[64:67]
    ds_read_b64_tr_b16 a[172:173], v25 offset:40960
    v_cvt_pk_bf16_f32 v186, v212, v213
    v_mfma_f32_16x16x32_bf16 a[64:67], a[164:167], v[132:135], a[64:67]
Ltour0_7:
    s_cbranch_execz Ltour0_11
    ds_read_b64_tr_b16 a[174:175], v25 offset:45056
    v_add_f32 v224, s36, v224
    v_mfma_f32_16x16x32_bf16 a[68:71], a[164:167], v[140:143], a[68:71]
    ds_read_b128 a[228:231], v9 offset:61440
    v_cvt_pk_bf16_f32 v187, v214, v215
    v_mfma_f32_16x16x32_bf16 a[68:71], a[160:163], v[136:139], a[68:71]
    buffer_load_dwordx4 a[248:251], v254, s[32:35], s57 offen
    v_smfmac_f32_16x16x64_bf16 a[204:207], v[52:55], v[152:159], v50
    v_mfma_f32_16x16x32_bf16 v[212:215], a[208:211], v[80:83], v[196:199]
    v_exp_f32 v208, v208
    v_mfma_f32_16x16x32_bf16 v[212:215], a[212:215], v[84:87], v[212:215]
    v_exp_f32 v209, v209
    v_mfma_f32_16x16x32_bf16 v[212:215], a[216:219], v[88:91], v[212:215]
    v_exp_f32 v210, v210
    v_mfma_f32_16x16x32_bf16 v[212:215], a[220:223], v[92:95], v[212:215]
    v_exp_f32 v211, v211
    v_mfma_f32_16x16x32_bf16 a[72:75], a[160:163], v[144:147], a[72:75]
    ds_read_b64_tr_b16 a[176:177], v26 offset:32768
    v_cvt_pk_bf16_f32 v164, v208, v209
    v_mfma_f32_16x16x32_bf16 a[72:75], a[164:167], v[148:151], a[72:75]
    ds_read_b64_tr_b16 a[178:179], v26 offset:36864
    v_add_f32 v225, s36, v225
    v_mfma_f32_16x16x32_bf16 a[76:79], a[164:167], v[156:159], a[76:79]
    ds_read_b128 a[232:235], v10 offset:61440
    v_cvt_pk_bf16_f32 v165, v210, v211
    v_mfma_f32_16x16x32_bf16 a[76:79], a[160:163], v[152:155], a[76:79]
    s_waitcnt lgkmcnt(3)
    buffer_load_dwordx4 v49, s[20:23], s49 offen offset:3072 lds
    v_mfma_f32_16x16x32_bf16 v[208:211], a[208:211], v[96:99], v[200:203]
    v_exp_f32 v212, v212
    v_mfma_f32_16x16x32_bf16 v[208:211], a[212:215], v[100:103], v[208:211]
    v_exp_f32 v213, v213
    v_mfma_f32_16x16x32_bf16 v[208:211], a[216:219], v[104:107], v[208:211]
    v_exp_f32 v214, v214
    v_mfma_f32_16x16x32_bf16 v[208:211], a[220:223], v[108:111], v[208:211]
    v_exp_f32 v215, v215
    v_mfma_f32_16x16x32_bf16 a[80:83], a[168:171], v[128:131], a[80:83]
    ds_read_b64_tr_b16 a[180:181], v26 offset:40960
    v_cvt_pk_bf16_f32 v172, v212, v213
    v_mfma_f32_16x16x32_bf16 a[80:83], a[172:175], v[132:135], a[80:83]
    ds_read_b64_tr_b16 a[182:183], v26 offset:45056
    v_cvt_pk_bf16_f32 v246, v224, v225
    v_mfma_f32_16x16x32_bf16 a[84:87], a[172:175], v[140:143], a[84:87]
    ds_read_b128 a[236:239], v11 offset:61440
    v_cvt_pk_bf16_f32 v173, v214, v215
    v_mfma_f32_16x16x32_bf16 a[84:87], a[168:171], v[136:139], a[84:87]
    s_waitcnt vmcnt(14)
    s_barrier
    v_mfma_f32_16x16x32_bf16 v[212:215], a[208:211], v[112:115], v[204:207]
    v_exp_f32 v208, v208
    v_mfma_f32_16x16x32_bf16 v[212:215], a[212:215], v[116:119], v[212:215]
    s_add_u32 s49, s7, 73728
    v_exp_f32 v209, v209
    v_mfma_f32_16x16x32_bf16 v[212:215], a[216:219], v[120:123], v[212:215]
    s_add_u32 m0, s42, 81920
    v_exp_f32 v210, v210
    v_mfma_f32_16x16x32_bf16 v[212:215], a[220:223], v[124:127], v[212:215]
    v_exp_f32 v211, v211
    v_mfma_f32_16x16x32_bf16 a[88:91], a[168:171], v[144:147], a[88:91]
    ds_read_b64_tr_b16 a[184:185], v27 offset:32768
    v_cvt_pk_bf16_f32 v180, v208, v209
    v_mfma_f32_16x16x32_bf16 a[88:91], a[172:175], v[148:151], a[88:91]
    ds_read_b64_tr_b16 a[186:187], v27 offset:36864
    v_lshrrev_b32 v244, 1, v0
    v_mfma_f32_16x16x32_bf16 a[92:95], a[172:175], v[156:159], a[92:95]
    v_cvt_pk_bf16_f32 v181, v210, v211
    v_mfma_f32_16x16x32_bf16 a[92:95], a[168:171], v[152:155], a[92:95]
    s_waitcnt lgkmcnt(3)
    buffer_load_dwordx4 v46, s[20:23], s49 offen lds
    v_mfma_f32_16x16x32_bf16 v[208:211], a[224:227], v[64:67], v[192:195]
    v_exp_f32 v212, v212
    v_mfma_f32_16x16x32_bf16 v[208:211], a[228:231], v[68:71], v[208:211]
    v_exp_f32 v213, v213
    v_mfma_f32_16x16x32_bf16 v[208:211], a[232:235], v[72:75], v[208:211]
    s_waitcnt lgkmcnt(2)
    v_exp_f32 v214, v214
    v_mfma_f32_16x16x32_bf16 v[208:211], a[236:239], v[76:79], v[208:211]
    v_exp_f32 v215, v215
    v_mfma_f32_16x16x32_bf16 a[96:99], a[176:179], v[128:131], a[96:99]
    ds_read_b64_tr_b16 a[188:189], v27 offset:40960
    v_cvt_pk_bf16_f32 v188, v212, v213
    v_mfma_f32_16x16x32_bf16 a[96:99], a[180:183], v[132:135], a[96:99]
    ds_read_b64_tr_b16 a[190:191], v27 offset:45056
    v_lshlrev_b32 v244, 4, v244
    v_mfma_f32_16x16x32_bf16 a[100:103], a[180:183], v[140:143], a[100:103]
    v_cvt_pk_bf16_f32 v189, v214, v215
    v_mfma_f32_16x16x32_bf16 a[100:103], a[176:179], v[136:139], a[100:103]
    v_and_b32 v245, 1, v0
    v_lshl_add_u32 v244, v245, 2, v244
    v_mfma_f32_16x16x32_bf16 v[212:215], a[224:227], v[80:83], v[196:199]
    v_exp_f32 v208, v208
    v_mfma_f32_16x16x32_bf16 v[212:215], a[228:231], v[84:87], v[212:215]
    v_exp_f32 v209, v209
    v_mfma_f32_16x16x32_bf16 v[212:215], a[232:235], v[88:91], v[212:215]
    v_exp_f32 v210, v210
    v_mfma_f32_16x16x32_bf16 v[212:215], a[236:239], v[92:95], v[212:215]
    v_exp_f32 v211, v211
    v_mfma_f32_16x16x32_bf16 a[104:107], a[176:179], v[144:147], a[104:107]
    ds_read_b64_tr_b16 a[160:161], v20 offset:49152
    v_cvt_pk_bf16_f32 v166, v208, v209
    v_mfma_f32_16x16x32_bf16 a[104:107], a[180:183], v[148:151], a[104:107]
    ds_read_b64_tr_b16 a[162:163], v20 offset:53248
    v_lshrrev_b32 v245, 3, v0
    v_mfma_f32_16x16x32_bf16 a[108:111], a[180:183], v[156:159], a[108:111]
    v_cvt_pk_bf16_f32 v167, v210, v211
    v_mfma_f32_16x16x32_bf16 a[108:111], a[176:179], v[152:155], a[108:111]
    s_waitcnt lgkmcnt(3)
    buffer_load_dwordx4 v47, s[20:23], s49 offen offset:1024 lds
    v_mfma_f32_16x16x32_bf16 v[208:211], a[224:227], v[96:99], v[200:203]
    v_exp_f32 v212, v212
    v_mfma_f32_16x16x32_bf16 v[208:211], a[228:231], v[100:103], v[208:211]
    v_exp_f32 v213, v213
    v_mfma_f32_16x16x32_bf16 v[208:211], a[232:235], v[104:107], v[208:211]
    v_exp_f32 v214, v214
    v_mfma_f32_16x16x32_bf16 v[208:211], a[236:239], v[108:111], v[208:211]
    s_add_u32 s57, s59, 0
    v_exp_f32 v215, v215
    v_mfma_f32_16x16x32_bf16 a[112:115], a[184:187], v[128:131], a[112:115]
    s_waitcnt lgkmcnt(2)
    ds_read_b64_tr_b16 a[164:165], v20 offset:57344
    v_cvt_pk_bf16_f32 v174, v212, v213
    v_mfma_f32_16x16x32_bf16 a[112:115], a[188:191], v[132:135], a[112:115]
    ds_read_b64_tr_b16 a[166:167], v20 offset:61440
    v_min_u32 v245, 1, v245
    v_mfma_f32_16x16x32_bf16 a[116:119], a[188:191], v[140:143], a[116:119]
    v_cvt_pk_bf16_f32 v175, v214, v215
    v_mfma_f32_16x16x32_bf16 a[116:119], a[184:187], v[136:139], a[116:119]
    buffer_load_dwordx4 a[252:255], v255, s[84:87], s57 offen
    v_mfma_f32_16x16x32_bf16 v[212:215], a[224:227], v[112:115], v[204:207]
    v_exp_f32 v208, v208
    v_mfma_f32_16x16x32_bf16 v[212:215], a[228:231], v[116:119], v[212:215]
    v_exp_f32 v209, v209
    v_mfma_f32_16x16x32_bf16 v[212:215], a[232:235], v[120:123], v[212:215]
    v_exp_f32 v210, v210
    v_mfma_f32_16x16x32_bf16 v[212:215], a[236:239], v[124:127], v[212:215]
    v_exp_f32 v211, v211
    v_mfma_f32_16x16x32_bf16 a[120:123], a[184:187], v[144:147], a[120:123]
    ds_read_b64_tr_b16 a[168:169], v21 offset:49152
    v_cvt_pk_bf16_f32 v182, v208, v209
    v_mfma_f32_16x16x32_bf16 a[120:123], a[188:191], v[148:151], a[120:123]
    ds_read_b64_tr_b16 a[170:171], v21 offset:53248
    v_lshl_or_b32 v244, v245, 31, v244
    v_mfma_f32_16x16x32_bf16 a[124:127], a[188:191], v[156:159], a[124:127]
    v_cvt_pk_bf16_f32 v183, v210, v211
    v_mfma_f32_16x16x32_bf16 a[124:127], a[184:187], v[152:155], a[124:127]
    s_waitcnt lgkmcnt(3)
    buffer_load_dwordx4 v48, s[20:23], s49 offen offset:2048 lds
    v_smfmac_f32_16x16x64_bf16 a[192:195], v[52:55], v[160:167], v50
    v_exp_f32 v212, v212
    v_smfmac_f32_16x16x64_bf16 a[196:199], v[52:55], v[168:175], v50
    v_exp_f32 v213, v213
    v_smfmac_f32_16x16x64_bf16 a[200:203], v[52:55], v[176:183], v50
    v_exp_f32 v214, v214
    v_exp_f32 v215, v215
    v_mfma_f32_16x16x32_bf16 a[0:3], a[160:163], v[160:163], a[0:3]
    s_waitcnt lgkmcnt(2)
    ds_read_b64_tr_b16 a[172:173], v21 offset:57344
    v_cvt_pk_bf16_f32 v190, v212, v213
    v_mfma_f32_16x16x32_bf16 a[0:3], a[164:167], v[164:167], a[0:3]
    ds_read_b64_tr_b16 a[174:175], v21 offset:61440
    v_mfma_f32_16x16x32_bf16 a[4:7], a[164:167], v[172:175], a[4:7]
    v_cvt_pk_bf16_f32 v191, v214, v215
    v_mfma_f32_16x16x32_bf16 a[4:7], a[160:163], v[168:171], a[4:7]
    buffer_store_dword v246, v244, s[24:27], s39 offen sc1
    v_smfmac_f32_16x16x64_bf16 a[204:207], v[52:55], v[184:191], v50
    v_mfma_f32_16x16x32_bf16 a[8:11], a[160:163], v[176:179], a[8:11]
    ds_read_b64_tr_b16 a[176:177], v22 offset:49152
    v_mfma_f32_16x16x32_bf16 a[8:11], a[164:167], v[180:183], a[8:11]
    ds_read_b64_tr_b16 a[178:179], v22 offset:53248
    v_accvgpr_read_b32 v216, a192
    v_accvgpr_read_b32 v217, a193
    v_mfma_f32_16x16x32_bf16 a[12:15], a[164:167], v[188:191], a[12:15]
    v_accvgpr_read_b32 v218, a196
    v_accvgpr_read_b32 v219, a197
    v_mfma_f32_16x16x32_bf16 a[12:15], a[160:163], v[184:187], a[12:15]
    s_waitcnt lgkmcnt(4)
    buffer_load_dwordx4 v49, s[20:23], s49 offen offset:3072 lds
    v_accvgpr_read_b32 v220, a200
    v_accvgpr_read_b32 v221, a201
    v_mfma_f32_16x16x32_bf16 a[16:19], a[168:171], v[160:163], a[16:19]
    s_waitcnt lgkmcnt(2)
    ds_read_b64_tr_b16 a[180:181], v22 offset:57344
    s_waitcnt vmcnt(9)
    v_accvgpr_read_b32 v222, a204
    v_mfma_f32_16x16x32_bf16 a[16:19], a[172:175], v[164:167], a[16:19]
    ds_read_b64_tr_b16 a[182:183], v22 offset:61440
    v_accvgpr_read_b32 v223, a205
    v_add_f32 v58, v216, v217
    v_mfma_f32_16x16x32_bf16 a[20:23], a[172:175], v[172:175], a[20:23]
    v_add_f32 v59, v218, v219
    v_add_f32 v60, v220, v221
    v_mfma_f32_16x16x32_bf16 a[20:23], a[168:171], v[168:171], a[20:23]
    v_add_f32 v61, v222, v223
    v_add_f32 v216, v58, v59
    s_add_u32 s49, s7, 256
    s_add_u32 m0, s42, 32768
    v_mfma_f32_16x16x32_bf16 a[24:27], a[168:171], v[176:179], a[24:27]
    ds_read_b64_tr_b16 a[184:185], v23 offset:49152
    v_add_f32 v217, v60, v61
    v_mfma_f32_16x16x32_bf16 a[24:27], a[172:175], v[180:183], a[24:27]
    ds_read_b64_tr_b16 a[186:187], v23 offset:53248
    v_add_f32 v216, v216, v217
    v_cmp_ngt_f32 vcc, 1669332992, v216
    v_mfma_f32_16x16x32_bf16 a[28:31], a[172:175], v[188:191], a[28:31]
    v_rcp_f32 v58, v58
    v_rcp_f32 v59, v59
    v_mfma_f32_16x16x32_bf16 a[28:31], a[168:171], v[184:187], a[28:31]
    s_waitcnt lgkmcnt(4)
    buffer_load_dwordx4 v46, s[20:23], s49 offen lds
    v_rcp_f32 v60, v60
    v_rcp_f32 v61, v61
    v_mfma_f32_16x16x32_bf16 a[32:35], a[176:179], v[160:163], a[32:35]
    s_waitcnt lgkmcnt(2)
    ds_read_b64_tr_b16 a[188:189], v23 offset:57344
    v_mov_b32 v228, 131072
    v_mfma_f32_16x16x32_bf16 a[32:35], a[180:183], v[164:167], a[32:35]
    ds_read_b64_tr_b16 a[190:191], v23 offset:61440
    s_or_b32 s36, vcc_lo, vcc_hi
    v_mfma_f32_16x16x32_bf16 a[36:39], a[180:183], v[172:175], a[36:39]
    v_accvgpr_read_b32 v208, a0
    v_accvgpr_read_b32 v209, a1
    v_accvgpr_read_b32 v210, a2
    v_accvgpr_read_b32 v211, a3
    v_pk_mul_f32 v[208:209], v[208:209], v[58:59] op_sel:[0,0] op_sel_hi:[1,0]
    v_pk_mul_f32 v[210:211], v[210:211], v[58:59] op_sel:[0,0] op_sel_hi:[1,0]
    v_cvt_pk_bf16_f32 v128, v208, v209
    v_cvt_pk_bf16_f32 v129, v210, v211
    v_mfma_f32_16x16x32_bf16 a[36:39], a[176:179], v[168:171], a[36:39]
    v_accvgpr_read_b32 v212, a4
    v_accvgpr_read_b32 v213, a5
    v_accvgpr_read_b32 v214, a6
    v_accvgpr_read_b32 v215, a7
    v_pk_mul_f32 v[212:213], v[212:213], v[58:59] op_sel:[0,1] op_sel_hi:[1,1]
    v_pk_mul_f32 v[214:215], v[214:215], v[58:59] op_sel:[0,1] op_sel_hi:[1,1]
    v_cvt_pk_bf16_f32 v132, v212, v213
    v_cvt_pk_bf16_f32 v133, v214, v215
    v_mfma_f32_16x16x32_bf16 a[40:43], a[176:179], v[176:179], a[40:43]
    ds_read_b64_tr_b16 a[160:161], v24 offset:49152
    v_mov_b32 v218, s36
    v_mfma_f32_16x16x32_bf16 a[40:43], a[180:183], v[180:183], a[40:43]
    ds_read_b64_tr_b16 a[162:163], v24 offset:53248
    s_lshl_b32 s38, s3, 2
    v_mfma_f32_16x16x32_bf16 a[44:47], a[180:183], v[188:191], a[44:47]
    v_accvgpr_read_b32 v208, a8
    v_accvgpr_read_b32 v209, a9
    v_accvgpr_read_b32 v210, a10
    v_accvgpr_read_b32 v211, a11
    v_pk_mul_f32 v[208:209], v[208:209], v[60:61] op_sel:[0,0] op_sel_hi:[1,0]
    v_pk_mul_f32 v[210:211], v[210:211], v[60:61] op_sel:[0,0] op_sel_hi:[1,0]
    v_cvt_pk_bf16_f32 v136, v208, v209
    v_cvt_pk_bf16_f32 v137, v210, v211
    v_mfma_f32_16x16x32_bf16 a[44:47], a[176:179], v[184:187], a[44:47]
    s_waitcnt lgkmcnt(4)
    buffer_load_dwordx4 v47, s[20:23], s49 offen offset:1024 lds
    v_accvgpr_read_b32 v212, a12
    v_accvgpr_read_b32 v213, a13
    v_accvgpr_read_b32 v214, a14
    v_accvgpr_read_b32 v215, a15
    v_pk_mul_f32 v[212:213], v[212:213], v[60:61] op_sel:[0,1] op_sel_hi:[1,1]
    v_pk_mul_f32 v[214:215], v[214:215], v[60:61] op_sel:[0,1] op_sel_hi:[1,1]
    v_cvt_pk_bf16_f32 v140, v212, v213
    v_cvt_pk_bf16_f32 v141, v214, v215
    v_mfma_f32_16x16x32_bf16 a[48:51], a[184:187], v[160:163], a[48:51]
    s_waitcnt lgkmcnt(2)
    ds_read_b64_tr_b16 a[164:165], v24 offset:57344
    v_add_u32 v219, s38, v228
    v_mfma_f32_16x16x32_bf16 a[48:51], a[188:191], v[164:167], a[48:51]
    ds_read_b64_tr_b16 a[166:167], v24 offset:61440
    ds_write_b32 v219, v218
    v_mfma_f32_16x16x32_bf16 a[52:55], a[188:191], v[172:175], a[52:55]
    v_accvgpr_read_b32 v208, a16
    v_accvgpr_read_b32 v209, a17
    v_accvgpr_read_b32 v210, a18
    v_accvgpr_read_b32 v211, a19
    v_pk_mul_f32 v[208:209], v[208:209], v[58:59] op_sel:[0,0] op_sel_hi:[1,0]
    v_pk_mul_f32 v[210:211], v[210:211], v[58:59] op_sel:[0,0] op_sel_hi:[1,0]
    v_cvt_pk_bf16_f32 v130, v208, v209
    v_cvt_pk_bf16_f32 v131, v210, v211
    s_add_u32 s37, s55, 0
    buffer_store_dwordx4 v[128:131], v252, s[28:31], s37 offen offset:0
    v_mfma_f32_16x16x32_bf16 a[52:55], a[184:187], v[168:171], a[52:55]
    v_accvgpr_read_b32 v212, a20
    v_accvgpr_read_b32 v213, a21
    v_accvgpr_read_b32 v214, a22
    v_accvgpr_read_b32 v215, a23
    v_pk_mul_f32 v[212:213], v[212:213], v[58:59] op_sel:[0,1] op_sel_hi:[1,1]
    v_pk_mul_f32 v[214:215], v[214:215], v[58:59] op_sel:[0,1] op_sel_hi:[1,1]
    v_cvt_pk_bf16_f32 v134, v212, v213
    v_cvt_pk_bf16_f32 v135, v214, v215
    s_add_u32 s37, s55, 0
    buffer_store_dwordx4 v[132:135], v252, s[28:31], s37 offen offset:1024
    v_mfma_f32_16x16x32_bf16 a[56:59], a[184:187], v[176:179], a[56:59]
    ds_read_b64_tr_b16 a[168:169], v25 offset:49152
    v_min_u32 v240, 1, v0
    v_mfma_f32_16x16x32_bf16 a[56:59], a[188:191], v[180:183], a[56:59]
    ds_read_b64_tr_b16 a[170:171], v25 offset:53248
    v_mfma_f32_16x16x32_bf16 a[60:63], a[188:191], v[188:191], a[60:63]
    v_accvgpr_read_b32 v208, a24
    v_accvgpr_read_b32 v209, a25
    v_accvgpr_read_b32 v210, a26
    v_accvgpr_read_b32 v211, a27
    v_pk_mul_f32 v[208:209], v[208:209], v[60:61] op_sel:[0,0] op_sel_hi:[1,0]
    v_pk_mul_f32 v[210:211], v[210:211], v[60:61] op_sel:[0,0] op_sel_hi:[1,0]
    v_cvt_pk_bf16_f32 v138, v208, v209
    v_cvt_pk_bf16_f32 v139, v210, v211
    s_add_u32 s37, s55, 0
    buffer_store_dwordx4 v[136:139], v252, s[28:31], s37 offen offset:2048
    v_mfma_f32_16x16x32_bf16 a[60:63], a[184:187], v[184:187], a[60:63]
    s_waitcnt lgkmcnt(5)
    buffer_load_dwordx4 v48, s[20:23], s49 offen offset:2048 lds
    v_accvgpr_read_b32 v212, a28
    v_accvgpr_read_b32 v213, a29
    v_accvgpr_read_b32 v214, a30
    v_accvgpr_read_b32 v215, a31
    v_pk_mul_f32 v[212:213], v[212:213], v[60:61] op_sel:[0,1] op_sel_hi:[1,1]
    v_pk_mul_f32 v[214:215], v[214:215], v[60:61] op_sel:[0,1] op_sel_hi:[1,1]
    v_cvt_pk_bf16_f32 v142, v212, v213
    v_cvt_pk_bf16_f32 v143, v214, v215
    s_add_u32 s37, s55, 0
    buffer_store_dwordx4 v[140:143], v252, s[28:31], s37 offen offset:3072
    v_mfma_f32_16x16x32_bf16 a[64:67], a[160:163], v[160:163], a[64:67]
    s_waitcnt lgkmcnt(3)
    ds_read_b64_tr_b16 a[172:173], v25 offset:57344
    v_lshlrev_b32 v240, 31, v240
    v_mfma_f32_16x16x32_bf16 a[64:67], a[164:167], v[164:167], a[64:67]
    ds_read_b64_tr_b16 a[174:175], v25 offset:61440
    v_mfma_f32_16x16x32_bf16 a[68:71], a[164:167], v[172:175], a[68:71]
    v_accvgpr_read_b32 v208, a32
    v_accvgpr_read_b32 v209, a33
    v_accvgpr_read_b32 v210, a34
    v_accvgpr_read_b32 v211, a35
    v_pk_mul_f32 v[208:209], v[208:209], v[58:59] op_sel:[0,0] op_sel_hi:[1,0]
    v_pk_mul_f32 v[210:211], v[210:211], v[58:59] op_sel:[0,0] op_sel_hi:[1,0]
    v_cvt_pk_bf16_f32 v144, v208, v209
    v_cvt_pk_bf16_f32 v145, v210, v211
    v_mfma_f32_16x16x32_bf16 a[68:71], a[160:163], v[168:171], a[68:71]
    v_accvgpr_read_b32 v212, a36
    v_accvgpr_read_b32 v213, a37
    v_accvgpr_read_b32 v214, a38
    v_accvgpr_read_b32 v215, a39
    v_pk_mul_f32 v[212:213], v[212:213], v[58:59] op_sel:[0,1] op_sel_hi:[1,1]
    v_pk_mul_f32 v[214:215], v[214:215], v[58:59] op_sel:[0,1] op_sel_hi:[1,1]
    v_cvt_pk_bf16_f32 v148, v212, v213
    v_cvt_pk_bf16_f32 v149, v214, v215
    v_mfma_f32_16x16x32_bf16 a[72:75], a[160:163], v[176:179], a[72:75]
    ds_read_b64_tr_b16 a[176:177], v26 offset:49152
    v_mov_b32 v241, 1
    v_mfma_f32_16x16x32_bf16 a[72:75], a[164:167], v[180:183], a[72:75]
    ds_read_b64_tr_b16 a[178:179], v26 offset:53248
    v_mfma_f32_16x16x32_bf16 a[76:79], a[164:167], v[188:191], a[76:79]
    v_accvgpr_read_b32 v208, a40
    v_accvgpr_read_b32 v209, a41
    v_accvgpr_read_b32 v210, a42
    v_accvgpr_read_b32 v211, a43
    v_pk_mul_f32 v[208:209], v[208:209], v[60:61] op_sel:[0,0] op_sel_hi:[1,0]
    v_pk_mul_f32 v[210:211], v[210:211], v[60:61] op_sel:[0,0] op_sel_hi:[1,0]
    v_cvt_pk_bf16_f32 v152, v208, v209
    v_cvt_pk_bf16_f32 v153, v210, v211
    v_mfma_f32_16x16x32_bf16 a[76:79], a[160:163], v[184:187], a[76:79]
    s_waitcnt lgkmcnt(4)
    buffer_load_dwordx4 v49, s[20:23], s49 offen offset:3072 lds
    v_accvgpr_read_b32 v212, a44
    v_accvgpr_read_b32 v213, a45
    v_accvgpr_read_b32 v214, a46
    v_accvgpr_read_b32 v215, a47
    v_pk_mul_f32 v[212:213], v[212:213], v[60:61] op_sel:[0,1] op_sel_hi:[1,1]
    v_pk_mul_f32 v[214:215], v[214:215], v[60:61] op_sel:[0,1] op_sel_hi:[1,1]
    v_cvt_pk_bf16_f32 v156, v212, v213
    v_cvt_pk_bf16_f32 v157, v214, v215
    v_mfma_f32_16x16x32_bf16 a[80:83], a[168:171], v[160:163], a[80:83]
    s_waitcnt lgkmcnt(2)
    ds_read_b64_tr_b16 a[180:181], v26 offset:57344
    v_mfma_f32_16x16x32_bf16 a[80:83], a[172:175], v[164:167], a[80:83]
    ds_read_b64_tr_b16 a[182:183], v26 offset:61440
    v_mfma_f32_16x16x32_bf16 a[84:87], a[172:175], v[172:175], a[84:87]
    v_accvgpr_read_b32 v208, a48
    v_accvgpr_read_b32 v209, a49
    v_accvgpr_read_b32 v210, a50
    v_accvgpr_read_b32 v211, a51
    v_pk_mul_f32 v[208:209], v[208:209], v[58:59] op_sel:[0,0] op_sel_hi:[1,0]
    v_pk_mul_f32 v[210:211], v[210:211], v[58:59] op_sel:[0,0] op_sel_hi:[1,0]
    v_cvt_pk_bf16_f32 v146, v208, v209
    v_cvt_pk_bf16_f32 v147, v210, v211
    s_add_u32 s37, s55, 4096
    buffer_store_dwordx4 v[144:147], v252, s[28:31], s37 offen offset:0
    v_mfma_f32_16x16x32_bf16 a[84:87], a[168:171], v[168:171], a[84:87]
    v_accvgpr_read_b32 v212, a52
    v_accvgpr_read_b32 v213, a53
    v_accvgpr_read_b32 v214, a54
    v_accvgpr_read_b32 v215, a55
    v_pk_mul_f32 v[212:213], v[212:213], v[58:59] op_sel:[0,1] op_sel_hi:[1,1]
    v_pk_mul_f32 v[214:215], v[214:215], v[58:59] op_sel:[0,1] op_sel_hi:[1,1]
    v_cvt_pk_bf16_f32 v150, v212, v213
    v_cvt_pk_bf16_f32 v151, v214, v215
    s_add_u32 s37, s55, 4096
    buffer_store_dwordx4 v[148:151], v252, s[28:31], s37 offen offset:1024
    s_waitcnt vmcnt(23)
    s_barrier
    v_mfma_f32_16x16x32_bf16 a[88:91], a[168:171], v[176:179], a[88:91]
    ds_read_b64_tr_b16 a[184:185], v27 offset:49152
    v_mfma_f32_16x16x32_bf16 a[88:91], a[172:175], v[180:183], a[88:91]
    ds_read_b64_tr_b16 a[186:187], v27 offset:53248
    v_mfma_f32_16x16x32_bf16 a[92:95], a[172:175], v[188:191], a[92:95]
    ds_read_b128 v[224:227], v228
    v_accvgpr_read_b32 v208, a56
    v_accvgpr_read_b32 v209, a57
    v_accvgpr_read_b32 v210, a58
    v_accvgpr_read_b32 v211, a59
    v_pk_mul_f32 v[208:209], v[208:209], v[60:61] op_sel:[0,0] op_sel_hi:[1,0]
    v_pk_mul_f32 v[210:211], v[210:211], v[60:61] op_sel:[0,0] op_sel_hi:[1,0]
    v_cvt_pk_bf16_f32 v154, v208, v209
    v_cvt_pk_bf16_f32 v155, v210, v211
    s_add_u32 s37, s55, 4096
    buffer_store_dwordx4 v[152:155], v252, s[28:31], s37 offen offset:2048
    v_mfma_f32_16x16x32_bf16 a[92:95], a[168:171], v[184:187], a[92:95]
    s_waitcnt lgkmcnt(5)
    v_accvgpr_read_b32 v212, a60
    v_accvgpr_read_b32 v213, a61
    v_accvgpr_read_b32 v214, a62
    v_accvgpr_read_b32 v215, a63
    v_pk_mul_f32 v[212:213], v[212:213], v[60:61] op_sel:[0,1] op_sel_hi:[1,1]
    v_pk_mul_f32 v[214:215], v[214:215], v[60:61] op_sel:[0,1] op_sel_hi:[1,1]
    v_cvt_pk_bf16_f32 v158, v212, v213
    v_cvt_pk_bf16_f32 v159, v214, v215
    s_add_u32 s37, s55, 4096
    buffer_store_dwordx4 v[156:159], v252, s[28:31], s37 offen offset:3072
    s_add_u32 s49, s7, 73984
    v_mfma_f32_16x16x32_bf16 a[96:99], a[176:179], v[160:163], a[96:99]
    s_waitcnt lgkmcnt(3)
    s_add_u32 m0, s42, 49152
    ds_read_b64_tr_b16 a[188:189], v27 offset:57344
    v_mfma_f32_16x16x32_bf16 a[96:99], a[180:183], v[164:167], a[96:99]
    buffer_load_dwordx4 v46, s[20:23], s49 offen lds
    v_mfma_f32_16x16x32_bf16 a[100:103], a[180:183], v[172:175], a[100:103]
    ds_read_b64_tr_b16 a[190:191], v27 offset:61440
    v_accvgpr_read_b32 v208, a64
    v_accvgpr_read_b32 v209, a65
    v_accvgpr_read_b32 v210, a66
    v_accvgpr_read_b32 v211, a67
    v_pk_mul_f32 v[208:209], v[208:209], v[58:59] op_sel:[0,0] op_sel_hi:[1,0]
    v_pk_mul_f32 v[210:211], v[210:211], v[58:59] op_sel:[0,0] op_sel_hi:[1,0]
    v_cvt_pk_bf16_f32 v192, v208, v209
    v_cvt_pk_bf16_f32 v193, v210, v211
    v_mfma_f32_16x16x32_bf16 a[100:103], a[176:179], v[168:171], a[100:103]
    buffer_load_dwordx4 v47, s[20:23], s49 offen offset:1024 lds
    v_accvgpr_read_b32 v212, a68
    v_accvgpr_read_b32 v213, a69
    v_accvgpr_read_b32 v214, a70
    v_accvgpr_read_b32 v215, a71
    v_pk_mul_f32 v[212:213], v[212:213], v[58:59] op_sel:[0,1] op_sel_hi:[1,1]
    v_pk_mul_f32 v[214:215], v[214:215], v[58:59] op_sel:[0,1] op_sel_hi:[1,1]
    v_cvt_pk_bf16_f32 v196, v212, v213
    v_cvt_pk_bf16_f32 v197, v214, v215
    v_mfma_f32_16x16x32_bf16 a[104:107], a[176:179], v[176:179], a[104:107]
    v_mfma_f32_16x16x32_bf16 a[104:107], a[180:183], v[180:183], a[104:107]
    buffer_load_dwordx4 v48, s[20:23], s49 offen offset:2048 lds
    v_mfma_f32_16x16x32_bf16 a[108:111], a[180:183], v[188:191], a[108:111]
    v_accvgpr_read_b32 v208, a72
    v_accvgpr_read_b32 v209, a73
    v_accvgpr_read_b32 v210, a74
    v_accvgpr_read_b32 v211, a75
    v_pk_mul_f32 v[208:209], v[208:209], v[60:61] op_sel:[0,0] op_sel_hi:[1,0]
    v_pk_mul_f32 v[210:211], v[210:211], v[60:61] op_sel:[0,0] op_sel_hi:[1,0]
    v_cvt_pk_bf16_f32 v200, v208, v209
    v_cvt_pk_bf16_f32 v201, v210, v211
    v_mfma_f32_16x16x32_bf16 a[108:111], a[176:179], v[184:187], a[108:111]
    s_waitcnt lgkmcnt(3)
    buffer_load_dwordx4 v49, s[20:23], s49 offen offset:3072 lds
    v_accvgpr_read_b32 v212, a76
    v_accvgpr_read_b32 v213, a77
    v_accvgpr_read_b32 v214, a78
    v_accvgpr_read_b32 v215, a79
    v_pk_mul_f32 v[212:213], v[212:213], v[60:61] op_sel:[0,1] op_sel_hi:[1,1]
    v_pk_mul_f32 v[214:215], v[214:215], v[60:61] op_sel:[0,1] op_sel_hi:[1,1]
    v_cvt_pk_bf16_f32 v204, v212, v213
    v_cvt_pk_bf16_f32 v205, v214, v215
    s_add_u32 s49, s46, 0
    v_mfma_f32_16x16x32_bf16 a[112:115], a[184:187], v[160:163], a[112:115]
    s_waitcnt lgkmcnt(0)
    s_add_u32 m0, s42, 98304
    v_mfma_f32_16x16x32_bf16 a[112:115], a[188:191], v[164:167], a[112:115]
    buffer_load_dwordx4 v46, s[20:23], s49 offen lds
    v_mfma_f32_16x16x32_bf16 a[116:119], a[188:191], v[172:175], a[116:119]
    v_accvgpr_read_b32 v208, a80
    v_accvgpr_read_b32 v209, a81
    v_accvgpr_read_b32 v210, a82
    v_accvgpr_read_b32 v211, a83
    v_pk_mul_f32 v[208:209], v[208:209], v[58:59] op_sel:[0,0] op_sel_hi:[1,0]
    v_pk_mul_f32 v[210:211], v[210:211], v[58:59] op_sel:[0,0] op_sel_hi:[1,0]
    v_cvt_pk_bf16_f32 v194, v208, v209
    v_cvt_pk_bf16_f32 v195, v210, v211
    s_add_u32 s37, s55, 8192
    buffer_store_dwordx4 v[192:195], v252, s[28:31], s37 offen offset:0
    v_mfma_f32_16x16x32_bf16 a[116:119], a[184:187], v[168:171], a[116:119]
    buffer_load_dwordx4 v47, s[20:23], s49 offen offset:1024 lds
    v_accvgpr_read_b32 v212, a84
    v_accvgpr_read_b32 v213, a85
    v_accvgpr_read_b32 v214, a86
    v_accvgpr_read_b32 v215, a87
    v_pk_mul_f32 v[212:213], v[212:213], v[58:59] op_sel:[0,1] op_sel_hi:[1,1]
    v_pk_mul_f32 v[214:215], v[214:215], v[58:59] op_sel:[0,1] op_sel_hi:[1,1]
    v_cvt_pk_bf16_f32 v198, v212, v213
    v_cvt_pk_bf16_f32 v199, v214, v215
    s_add_u32 s37, s55, 8192
    buffer_store_dwordx4 v[196:199], v252, s[28:31], s37 offen offset:1024
    v_mfma_f32_16x16x32_bf16 a[120:123], a[184:187], v[176:179], a[120:123]
    v_mfma_f32_16x16x32_bf16 a[120:123], a[188:191], v[180:183], a[120:123]
    buffer_load_dwordx4 v48, s[20:23], s49 offen offset:2048 lds
    v_mfma_f32_16x16x32_bf16 a[124:127], a[188:191], v[188:191], a[124:127]
    v_accvgpr_read_b32 v208, a88
    v_accvgpr_read_b32 v209, a89
    v_accvgpr_read_b32 v210, a90
    v_accvgpr_read_b32 v211, a91
    v_pk_mul_f32 v[208:209], v[208:209], v[60:61] op_sel:[0,0] op_sel_hi:[1,0]
    v_pk_mul_f32 v[210:211], v[210:211], v[60:61] op_sel:[0,0] op_sel_hi:[1,0]
    v_cvt_pk_bf16_f32 v202, v208, v209
    v_cvt_pk_bf16_f32 v203, v210, v211
    s_add_u32 s37, s55, 8192
    buffer_store_dwordx4 v[200:203], v252, s[28:31], s37 offen offset:2048
    v_mfma_f32_16x16x32_bf16 a[124:127], a[184:187], v[184:187], a[124:127]
    buffer_load_dwordx4 v49, s[20:23], s49 offen offset:3072 lds
    v_accvgpr_read_b32 v212, a92
    v_accvgpr_read_b32 v213, a93
    v_accvgpr_read_b32 v214, a94
    v_accvgpr_read_b32 v215, a95
    v_pk_mul_f32 v[212:213], v[212:213], v[60:61] op_sel:[0,1] op_sel_hi:[1,1]
    v_pk_mul_f32 v[214:215], v[214:215], v[60:61] op_sel:[0,1] op_sel_hi:[1,1]
    v_cvt_pk_bf16_f32 v206, v212, v213
    v_cvt_pk_bf16_f32 v207, v214, v215
    s_add_u32 s37, s55, 8192
    buffer_store_dwordx4 v[204:207], v252, s[28:31], s37 offen offset:3072
    v_or3_b32 v224, v224, v225, v226
    v_or_b32 v224, v224, v227
    s_nop 0
    v_readfirstlane_b32 s36, v224
    v_readfirstlane_b32 s38, v253
    v_min_u32 v8, 1, v1
    v_lshlrev_b32 v8, 31, v8
    v_mov_b32 v10, s95
    s_getreg_b32 s39, hwreg(HW_REG_XCC_ID, 0, 4)
    s_lshl_b32 s39, s39, 28
    s_xor_b32 s39, s39, s95
    s_cmp_eq_u32 s38, s39
    s_cselect_b32 s53, 1, 0
    ds_read_b64_tr_b16 a[208:209], v12 offset:0
    ds_read_b64_tr_b16 a[210:211], v12 offset:4096
    ds_read_b64_tr_b16 a[212:213], v12 offset:8192
    ds_read_b64_tr_b16 a[214:215], v12 offset:12288
    ds_read_b64_tr_b16 a[216:217], v12 offset:16384
    ds_read_b64_tr_b16 a[218:219], v12 offset:20480
    ds_read_b64_tr_b16 a[220:221], v12 offset:24576
    ds_read_b64_tr_b16 a[222:223], v12 offset:28672
    ds_read_b64_tr_b16 a[224:225], v16 offset:0
    ds_read_b64_tr_b16 a[226:227], v16 offset:4096
    ds_read_b64_tr_b16 a[228:229], v16 offset:8192
    ds_read_b64_tr_b16 a[230:231], v16 offset:12288
    ds_read_b64_tr_b16 a[232:233], v16 offset:16384
    ds_read_b64_tr_b16 a[234:235], v16 offset:20480
    ds_read_b64_tr_b16 a[236:237], v16 offset:24576
    ds_read_b64_tr_b16 a[238:239], v16 offset:28672
    s_andn2_b32 s36, s36, s48
    s_cbranch_scc1 Lattn_redo
    v_accvgpr_read_b32 v208, a96
    v_accvgpr_read_b32 v209, a97
    v_accvgpr_read_b32 v210, a98
    v_accvgpr_read_b32 v211, a99
    v_pk_mul_f32 v[208:209], v[208:209], v[58:59] op_sel:[0,0] op_sel_hi:[1,0]
Ltour0_8:
    s_cbranch_execz Ltour0_12
    v_pk_mul_f32 v[210:211], v[210:211], v[58:59] op_sel:[0,0] op_sel_hi:[1,0]
    v_cvt_pk_bf16_f32 v176, v208, v209
    v_cvt_pk_bf16_f32 v177, v210, v211
    v_accvgpr_read_b32 v212, a100
    v_accvgpr_read_b32 v213, a101
    v_accvgpr_read_b32 v214, a102
    v_accvgpr_read_b32 v215, a103
    v_pk_mul_f32 v[212:213], v[212:213], v[58:59] op_sel:[0,1] op_sel_hi:[1,1]
    v_pk_mul_f32 v[214:215], v[214:215], v[58:59] op_sel:[0,1] op_sel_hi:[1,1]
    v_cvt_pk_bf16_f32 v180, v212, v213
    v_cvt_pk_bf16_f32 v181, v214, v215
    v_accvgpr_read_b32 v208, a104
    v_accvgpr_read_b32 v209, a105
    v_accvgpr_read_b32 v210, a106
    v_accvgpr_read_b32 v211, a107
    v_pk_mul_f32 v[208:209], v[208:209], v[60:61] op_sel:[0,0] op_sel_hi:[1,0]
    v_pk_mul_f32 v[210:211], v[210:211], v[60:61] op_sel:[0,0] op_sel_hi:[1,0]
    v_cvt_pk_bf16_f32 v184, v208, v209
    v_cvt_pk_bf16_f32 v185, v210, v211
    v_accvgpr_read_b32 v212, a108
    v_accvgpr_read_b32 v213, a109
    v_accvgpr_read_b32 v214, a110
    v_accvgpr_read_b32 v215, a111
    v_pk_mul_f32 v[212:213], v[212:213], v[60:61] op_sel:[0,1] op_sel_hi:[1,1]
    v_pk_mul_f32 v[214:215], v[214:215], v[60:61] op_sel:[0,1] op_sel_hi:[1,1]
    v_cvt_pk_bf16_f32 v188, v212, v213
    v_cvt_pk_bf16_f32 v189, v214, v215
    v_accvgpr_read_b32 v208, a112
    v_accvgpr_read_b32 v209, a113
    v_accvgpr_read_b32 v210, a114
    v_accvgpr_read_b32 v211, a115
    v_pk_mul_f32 v[208:209], v[208:209], v[58:59] op_sel:[0,0] op_sel_hi:[1,0]
    v_pk_mul_f32 v[210:211], v[210:211], v[58:59] op_sel:[0,0] op_sel_hi:[1,0]
    v_cvt_pk_bf16_f32 v178, v208, v209
    v_cvt_pk_bf16_f32 v179, v210, v211
    s_add_u32 s37, s55, 12288
    buffer_store_dwordx4 v[176:179], v252, s[28:31], s37 offen offset:0
    v_accvgpr_read_b32 v212, a116
    v_accvgpr_read_b32 v213, a117
    v_accvgpr_read_b32 v214, a118
    v_accvgpr_read_b32 v215, a119
    v_pk_mul_f32 v[212:213], v[212:213], v[58:59] op_sel:[0,1] op_sel_hi:[1,1]
    v_pk_mul_f32 v[214:215], v[214:215], v[58:59] op_sel:[0,1] op_sel_hi:[1,1]
    v_cvt_pk_bf16_f32 v182, v212, v213
    v_cvt_pk_bf16_f32 v183, v214, v215
    s_add_u32 s37, s55, 12288
    buffer_store_dwordx4 v[180:183], v252, s[28:31], s37 offen offset:1024
    v_accvgpr_read_b32 v208, a120
    v_accvgpr_read_b32 v209, a121
    v_accvgpr_read_b32 v210, a122
    v_accvgpr_read_b32 v211, a123
    v_pk_mul_f32 v[208:209], v[208:209], v[60:61] op_sel:[0,0] op_sel_hi:[1,0]
    v_pk_mul_f32 v[210:211], v[210:211], v[60:61] op_sel:[0,0] op_sel_hi:[1,0]
    v_cvt_pk_bf16_f32 v186, v208, v209
    v_cvt_pk_bf16_f32 v187, v210, v211
    s_add_u32 s37, s55, 12288
    buffer_store_dwordx4 v[184:187], v252, s[28:31], s37 offen offset:2048
    v_accvgpr_read_b32 v212, a124
    v_accvgpr_read_b32 v213, a125
    v_accvgpr_read_b32 v214, a126
    v_accvgpr_read_b32 v215, a127
    v_pk_mul_f32 v[212:213], v[212:213], v[60:61] op_sel:[0,1] op_sel_hi:[1,1]
    v_pk_mul_f32 v[214:215], v[214:215], v[60:61] op_sel:[0,1] op_sel_hi:[1,1]
    v_cvt_pk_bf16_f32 v190, v212, v213
    v_cvt_pk_bf16_f32 v191, v214, v215
    s_add_u32 s37, s55, 12288
    buffer_store_dwordx4 v[188:191], v252, s[28:31], s37 offen offset:3072
    s_waitcnt lgkmcnt(14)
    v_mfma_f32_16x16x32_bf16 v[96:99], a[208:211], v[128:131], 0
    s_waitcnt lgkmcnt(12)
    ds_read_b64_tr_b16 a[160:161], v13 offset:0
    v_mfma_f32_16x16x32_bf16 v[96:99], a[212:215], v[144:147], v[96:99]
    s_waitcnt lgkmcnt(11)
    ds_read_b64_tr_b16 a[162:163], v13 offset:4096
    v_mfma_f32_16x16x32_bf16 v[96:99], a[216:219], v[192:195], v[96:99]
    s_waitcnt lgkmcnt(10)
    ds_read_b64_tr_b16 a[164:165], v13 offset:8192
    v_mfma_f32_16x16x32_bf16 v[96:99], a[220:223], v[176:179], v[96:99]
    s_waitcnt lgkmcnt(9)
    ds_read_b64_tr_b16 a[166:167], v13 offset:12288
    v_mfma_f32_16x16x32_bf16 v[96:99], a[224:227], v[136:139], v[96:99]
    s_waitcnt lgkmcnt(8)
    ds_read_b64_tr_b16 a[168:169], v13 offset:16384
    v_mfma_f32_16x16x32_bf16 v[96:99], a[228:231], v[152:155], v[96:99]
    s_waitcnt lgkmcnt(7)
    ds_read_b64_tr_b16 a[170:171], v13 offset:20480
    v_mfma_f32_16x16x32_bf16 v[96:99], a[232:235], v[200:203], v[96:99]
    s_waitcnt lgkmcnt(6)
    ds_read_b64_tr_b16 a[172:173], v13 offset:24576
    v_mfma_f32_16x16x32_bf16 v[96:99], a[236:239], v[184:187], v[96:99]
    ds_read_b64_tr_b16 a[174:175], v13 offset:28672
    v_mfma_f32_16x16x32_bf16 v[100:103], a[236:239], v[188:191], 0
    ds_read_b64_tr_b16 a[176:177], v17 offset:0
    v_mfma_f32_16x16x32_bf16 v[100:103], a[232:235], v[204:207], v[100:103]
    ds_read_b64_tr_b16 a[178:179], v17 offset:4096
    v_mfma_f32_16x16x32_bf16 v[100:103], a[228:231], v[156:159], v[100:103]
    ds_read_b64_tr_b16 a[180:181], v17 offset:8192
    v_mfma_f32_16x16x32_bf16 v[100:103], a[224:227], v[140:143], v[100:103]
    ds_read_b64_tr_b16 a[182:183], v17 offset:12288
    v_mfma_f32_16x16x32_bf16 v[100:103], a[220:223], v[180:183], v[100:103]
    ds_read_b64_tr_b16 a[184:185], v17 offset:16384
    v_cvt_pk_bf16_f32 v224, v96, v97
    v_mfma_f32_16x16x32_bf16 v[100:103], a[216:219], v[196:199], v[100:103]
    ds_read_b64_tr_b16 a[186:187], v17 offset:20480
    v_cvt_pk_bf16_f32 v225, v98, v99
    v_mfma_f32_16x16x32_bf16 v[100:103], a[212:215], v[148:151], v[100:103]
    ds_read_b64_tr_b16 a[188:189], v17 offset:24576
    v_mfma_f32_16x16x32_bf16 v[100:103], a[208:211], v[132:135], v[100:103]
    s_waitcnt lgkmcnt(13)
    ds_read_b64_tr_b16 a[190:191], v17 offset:28672
    v_mfma_f32_16x16x32_bf16 v[104:107], a[160:163], v[128:131], 0
    s_waitcnt lgkmcnt(12)
    ds_read_b64_tr_b16 a[208:209], v14 offset:0
    v_mfma_f32_16x16x32_bf16 v[104:107], a[164:167], v[144:147], v[104:107]
    s_waitcnt lgkmcnt(11)
    ds_read_b64_tr_b16 a[210:211], v14 offset:4096
    v_mfma_f32_16x16x32_bf16 v[104:107], a[168:171], v[192:195], v[104:107]
    s_waitcnt lgkmcnt(10)
    ds_read_b64_tr_b16 a[212:213], v14 offset:8192
    v_mfma_f32_16x16x32_bf16 v[104:107], a[172:175], v[176:179], v[104:107]
    s_waitcnt lgkmcnt(9)
    ds_read_b64_tr_b16 a[214:215], v14 offset:12288
    v_mfma_f32_16x16x32_bf16 v[104:107], a[176:179], v[136:139], v[104:107]
    s_waitcnt lgkmcnt(8)
    ds_read_b64_tr_b16 a[216:217], v14 offset:16384
    v_cvt_pk_bf16_f32 v228, v100, v101
    v_mfma_f32_16x16x32_bf16 v[104:107], a[180:183], v[152:155], v[104:107]
    s_waitcnt lgkmcnt(7)
    ds_read_b64_tr_b16 a[218:219], v14 offset:20480
    v_cvt_pk_bf16_f32 v229, v102, v103
    v_mfma_f32_16x16x32_bf16 v[104:107], a[184:187], v[200:203], v[104:107]
    s_waitcnt lgkmcnt(6)
    ds_read_b64_tr_b16 a[220:221], v14 offset:24576
    v_mfma_f32_16x16x32_bf16 v[104:107], a[188:191], v[184:187], v[104:107]
    ds_read_b64_tr_b16 a[222:223], v14 offset:28672
    s_waitcnt vmcnt(0)
    s_cmp_eq_u32 s53, 0
    s_cbranch_scc1 Lattn_wb
Lattn_wbdone:
    v_mfma_f32_16x16x32_bf16 v[108:111], a[188:191], v[188:191], 0
    buffer_store_dword v10, v8, s[24:27], s92 offen offset:8 sc1
    v_mfma_f32_16x16x32_bf16 v[108:111], a[184:187], v[204:207], v[108:111]
    s_xor_b32 s55, s55, 65536
    ds_read_b64_tr_b16 a[224:225], v18 offset:0
    ds_read_b64_tr_b16 a[226:227], v18 offset:4096
    v_mfma_f32_16x16x32_bf16 v[108:111], a[180:183], v[156:159], v[108:111]
    buffer_atomic_add v241, v240, s[88:91], 0 offen sc1
    v_mfma_f32_16x16x32_bf16 v[108:111], a[176:179], v[140:143], v[108:111]
    ds_read_b64_tr_b16 a[228:229], v18 offset:8192
    ds_read_b64_tr_b16 a[230:231], v18 offset:12288
    s_load_dwordx2 s[12:13], s[0:1], 0
    v_mfma_f32_16x16x32_bf16 v[108:111], a[172:175], v[180:183], v[108:111]
    ds_read_b64_tr_b16 a[232:233], v18 offset:16384
    v_cvt_pk_bf16_f32 v226, v104, v105
    v_mfma_f32_16x16x32_bf16 v[108:111], a[168:171], v[196:199], v[108:111]
    s_add_u32 s38, s56, 16384
    ds_read_b64_tr_b16 a[234:235], v18 offset:20480
    v_cvt_pk_bf16_f32 v227, v106, v107
    s_load_dwordx2 s[16:17], s[0:1], 96
    v_mfma_f32_16x16x32_bf16 v[108:111], a[164:167], v[148:151], v[108:111]
    buffer_store_dwordx4 v[224:227], v56, s[28:31], s38 offen sc1
    v_mfma_f32_16x16x32_bf16 v[108:111], a[160:163], v[132:135], v[108:111]
    s_waitcnt lgkmcnt(12)
    ds_read_b64_tr_b16 a[236:237], v18 offset:24576
    ds_read_b64_tr_b16 a[238:239], v18 offset:28672
    s_load_dwordx2 s[52:53], s[0:1], 48
    v_mfma_f32_16x16x32_bf16 v[112:115], a[208:211], v[128:131], 0
    s_waitcnt lgkmcnt(12)
    ds_read_b64_tr_b16 a[160:161], v15 offset:0
    v_mfma_f32_16x16x32_bf16 v[112:115], a[212:215], v[144:147], v[112:115]
    s_waitcnt lgkmcnt(11)
    ds_read_b64_tr_b16 a[162:163], v15 offset:4096
    v_mfma_f32_16x16x32_bf16 v[112:115], a[216:219], v[192:195], v[112:115]
    s_waitcnt lgkmcnt(10)
    ds_read_b64_tr_b16 a[164:165], v15 offset:8192
    v_mfma_f32_16x16x32_bf16 v[112:115], a[220:223], v[176:179], v[112:115]
    s_waitcnt lgkmcnt(9)
    ds_read_b64_tr_b16 a[166:167], v15 offset:12288
    v_mfma_f32_16x16x32_bf16 v[112:115], a[224:227], v[136:139], v[112:115]
    s_waitcnt lgkmcnt(8)
    ds_read_b64_tr_b16 a[168:169], v15 offset:16384
    v_cvt_pk_bf16_f32 v230, v108, v109
    v_mfma_f32_16x16x32_bf16 v[112:115], a[228:231], v[152:155], v[112:115]
    s_waitcnt lgkmcnt(7)
    s_add_u32 s38, s56, 181248
    ds_read_b64_tr_b16 a[170:171], v15 offset:20480
    v_cvt_pk_bf16_f32 v231, v110, v111
    v_mfma_f32_16x16x32_bf16 v[112:115], a[232:235], v[200:203], v[112:115]
    s_waitcnt lgkmcnt(6)
    buffer_store_dwordx4 v[228:231], v56, s[28:31], s38 offen sc1
    v_mfma_f32_16x16x32_bf16 v[112:115], a[236:239], v[184:187], v[112:115]
    ds_read_b64_tr_b16 a[172:173], v15 offset:24576
    ds_read_b64_tr_b16 a[174:175], v15 offset:28672
    v_mfma_f32_16x16x32_bf16 v[116:119], a[236:239], v[188:191], 0
    ds_read_b64_tr_b16 a[176:177], v19 offset:0
    v_mfma_f32_16x16x32_bf16 v[116:119], a[232:235], v[204:207], v[116:119]
    ds_read_b64_tr_b16 a[178:179], v19 offset:4096
    v_mfma_f32_16x16x32_bf16 v[116:119], a[228:231], v[156:159], v[116:119]
    ds_read_b64_tr_b16 a[180:181], v19 offset:8192
    v_mfma_f32_16x16x32_bf16 v[116:119], a[224:227], v[140:143], v[116:119]
    ds_read_b64_tr_b16 a[182:183], v19 offset:12288
    v_mfma_f32_16x16x32_bf16 v[116:119], a[220:223], v[180:183], v[116:119]
    ds_read_b64_tr_b16 a[184:185], v19 offset:16384
    v_cvt_pk_bf16_f32 v232, v112, v113
    v_mfma_f32_16x16x32_bf16 v[116:119], a[216:219], v[196:199], v[116:119]
    ds_read_b64_tr_b16 a[186:187], v19 offset:20480
    v_cvt_pk_bf16_f32 v233, v114, v115
    v_mfma_f32_16x16x32_bf16 v[116:119], a[212:215], v[148:151], v[116:119]
    ds_read_b64_tr_b16 a[188:189], v19 offset:24576
    v_mfma_f32_16x16x32_bf16 v[116:119], a[208:211], v[132:135], v[116:119]
    s_waitcnt lgkmcnt(13)
    ds_read_b64_tr_b16 a[190:191], v19 offset:28672
    s_barrier
    v_mfma_f32_16x16x32_bf16 v[120:123], a[160:163], v[128:131], 0
    s_waitcnt lgkmcnt(12)
    buffer_load_dword v11, v8, s[24:27], s54 offen offset:8 sc1
    v_mfma_f32_16x16x32_bf16 v[120:123], a[164:167], v[144:147], v[120:123]
    s_waitcnt lgkmcnt(10)
    ds_read_b64_tr_b16 a[208:209], v20 offset:0
    ds_read_b64_tr_b16 a[210:211], v20 offset:4096
    v_mfma_f32_16x16x32_bf16 v[120:123], a[168:171], v[192:195], v[120:123]
    s_waitcnt lgkmcnt(10)
    ds_read_b64_tr_b16 a[212:213], v20 offset:8192
    v_mfma_f32_16x16x32_bf16 v[120:123], a[172:175], v[176:179], v[120:123]
    s_waitcnt lgkmcnt(9)
    ds_read_b64_tr_b16 a[214:215], v20 offset:12288
    v_mfma_f32_16x16x32_bf16 v[120:123], a[176:179], v[136:139], v[120:123]
    s_waitcnt lgkmcnt(8)
    ds_read_b64_tr_b16 a[216:217], v20 offset:16384
    v_cvt_pk_bf16_f32 v236, v116, v117
    v_mfma_f32_16x16x32_bf16 v[120:123], a[180:183], v[152:155], v[120:123]
    s_waitcnt lgkmcnt(7)
    ds_read_b64_tr_b16 a[218:219], v20 offset:20480
    v_cvt_pk_bf16_f32 v237, v118, v119
    v_mfma_f32_16x16x32_bf16 v[120:123], a[184:187], v[200:203], v[120:123]
    s_waitcnt lgkmcnt(6)
    s_add_u32 s49, s46, 73728
    ds_read_b64_tr_b16 a[220:221], v20 offset:24576
    v_mfma_f32_16x16x32_bf16 v[120:123], a[188:191], v[184:187], v[120:123]
    s_add_u32 m0, s42, 114688
    ds_read_b64_tr_b16 a[222:223], v20 offset:28672
    v_mfma_f32_16x16x32_bf16 v[124:127], a[188:191], v[188:191], 0
    buffer_load_dwordx4 v46, s[20:23], s49 offen lds
    v_mfma_f32_16x16x32_bf16 v[124:127], a[184:187], v[204:207], v[124:127]
    ds_read_b64_tr_b16 a[224:225], v24 offset:0
    ds_read_b64_tr_b16 a[226:227], v24 offset:4096
    v_mfma_f32_16x16x32_bf16 v[124:127], a[180:183], v[156:159], v[124:127]
    buffer_load_dwordx4 v47, s[20:23], s49 offen offset:1024 lds
    v_mfma_f32_16x16x32_bf16 v[124:127], a[176:179], v[140:143], v[124:127]
    ds_read_b64_tr_b16 a[228:229], v24 offset:8192
    ds_read_b64_tr_b16 a[230:231], v24 offset:12288
    v_mfma_f32_16x16x32_bf16 v[124:127], a[172:175], v[180:183], v[124:127]
    ds_read_b64_tr_b16 a[232:233], v24 offset:16384
    v_cvt_pk_bf16_f32 v234, v120, v121
    v_mfma_f32_16x16x32_bf16 v[124:127], a[168:171], v[196:199], v[124:127]
    s_add_u32 s38, s56, 16512
    ds_read_b64_tr_b16 a[234:235], v24 offset:20480
    v_cvt_pk_bf16_f32 v235, v122, v123
    v_mfma_f32_16x16x32_bf16 v[124:127], a[164:167], v[148:151], v[124:127]
    buffer_store_dwordx4 v[232:235], v56, s[28:31], s38 offen sc1
    v_mfma_f32_16x16x32_bf16 v[124:127], a[160:163], v[132:135], v[124:127]
    s_waitcnt lgkmcnt(12)
    ds_read_b64_tr_b16 a[236:237], v24 offset:24576
    ds_read_b64_tr_b16 a[238:239], v24 offset:28672
    v_mfma_f32_16x16x32_bf16 v[64:67], a[208:211], v[128:131], 0
    s_waitcnt lgkmcnt(12)
    buffer_load_dwordx4 v48, s[20:23], s49 offen offset:2048 lds
    v_mfma_f32_16x16x32_bf16 v[64:67], a[212:215], v[144:147], v[64:67]
    s_waitcnt lgkmcnt(10)
    ds_read_b64_tr_b16 a[160:161], v21 offset:0
    ds_read_b64_tr_b16 a[162:163], v21 offset:4096
    v_mfma_f32_16x16x32_bf16 v[64:67], a[216:219], v[192:195], v[64:67]
    s_waitcnt lgkmcnt(10)
    buffer_load_dwordx4 v49, s[20:23], s49 offen offset:3072 lds
    v_mfma_f32_16x16x32_bf16 v[64:67], a[220:223], v[176:179], v[64:67]
    s_waitcnt lgkmcnt(8)
    ds_read_b64_tr_b16 a[164:165], v21 offset:8192
    ds_read_b64_tr_b16 a[166:167], v21 offset:12288
    v_mfma_f32_16x16x32_bf16 v[64:67], a[224:227], v[136:139], v[64:67]
    s_waitcnt lgkmcnt(8)
    ds_read_b64_tr_b16 a[168:169], v21 offset:16384
    v_cvt_pk_bf16_f32 v238, v124, v125
    v_mfma_f32_16x16x32_bf16 v[64:67], a[228:231], v[152:155], v[64:67]
    s_waitcnt lgkmcnt(7)
    s_add_u32 s38, s56, 181376
    ds_read_b64_tr_b16 a[170:171], v21 offset:20480
    v_cvt_pk_bf16_f32 v239, v126, v127
    v_mfma_f32_16x16x32_bf16 v[64:67], a[232:235], v[200:203], v[64:67]
    s_waitcnt lgkmcnt(6)
    buffer_store_dwordx4 v[236:239], v56, s[28:31], s38 offen sc1
    v_mfma_f32_16x16x32_bf16 v[64:67], a[236:239], v[184:187], v[64:67]
    ds_read_b64_tr_b16 a[172:173], v21 offset:24576
    ds_read_b64_tr_b16 a[174:175], v21 offset:28672
    v_mfma_f32_16x16x32_bf16 v[68:71], a[236:239], v[188:191], 0
    s_lshl_b32 s40, s5, 4
    ds_read_b64_tr_b16 a[176:177], v25 offset:0
    v_mfma_f32_16x16x32_bf16 v[68:71], a[232:235], v[204:207], v[68:71]
    s_add_u32 s40, s40, s4
    ds_read_b64_tr_b16 a[178:179], v25 offset:4096
    v_and_b32 v240, 31, v1
    v_mfma_f32_16x16x32_bf16 v[68:71], a[228:231], v[156:159], v[68:71]
    ds_read_b64_tr_b16 a[180:181], v25 offset:8192
    v_lshrrev_b32 v241, 5, v1
    v_mfma_f32_16x16x32_bf16 v[68:71], a[224:227], v[140:143], v[68:71]
    ds_read_b64_tr_b16 a[182:183], v25 offset:12288
    v_cmp_gt_u32 vcc, 8, v240
    v_mfma_f32_16x16x32_bf16 v[68:71], a[220:223], v[180:183], v[68:71]
    ds_read_b64_tr_b16 a[184:185], v25 offset:16384
    v_mov_b32 v242, 2147483648
    v_mfma_f32_16x16x32_bf16 v[68:71], a[216:219], v[196:199], v[68:71]
    s_lshl_b32 s43, s40, 3
    ds_read_b64_tr_b16 a[186:187], v25 offset:20480
    v_mfma_f32_16x16x32_bf16 v[68:71], a[212:215], v[148:151], v[68:71]
    s_lshl_b32 s44, s3, 1
    ds_read_b64_tr_b16 a[188:189], v25 offset:24576
    v_mfma_f32_16x16x32_bf16 v[68:71], a[208:211], v[132:135], v[68:71]
    s_waitcnt lgkmcnt(13)
    s_add_u32 s43, s43, s44
    ds_read_b64_tr_b16 a[190:191], v25 offset:28672
    v_cndmask_b32 v242, v242, 0, vcc
    v_mfma_f32_16x16x32_bf16 v[72:75], a[160:163], v[128:131], 0
    s_waitcnt lgkmcnt(12)
    ds_read_b64_tr_b16 a[208:209], v22 offset:0
    v_add_u32 v7, s43, v241
    v_mfma_f32_16x16x32_bf16 v[72:75], a[164:167], v[144:147], v[72:75]
    s_waitcnt lgkmcnt(11)
    ds_read_b64_tr_b16 a[210:211], v22 offset:4096
    v_lshlrev_b32 v5, 4, v240
    v_mfma_f32_16x16x32_bf16 v[72:75], a[168:171], v[192:195], v[72:75]
    s_waitcnt lgkmcnt(10)
    ds_read_b64_tr_b16 a[212:213], v22 offset:8192
    v_lshlrev_b32 v243, 4, v241
    v_mfma_f32_16x16x32_bf16 v[72:75], a[172:175], v[176:179], v[72:75]
    s_waitcnt lgkmcnt(9)
    ds_read_b64_tr_b16 a[214:215], v22 offset:12288
    v_lshl_add_u32 v2, v240, 5, v243
    v_mfma_f32_16x16x32_bf16 v[72:75], a[176:179], v[136:139], v[72:75]
    s_waitcnt lgkmcnt(8)
    ds_read_b64_tr_b16 a[216:217], v22 offset:16384
    v_lshrrev_b32 v243, 4, v240
    v_mfma_f32_16x16x32_bf16 v[72:75], a[180:183], v[152:155], v[72:75]
    s_waitcnt lgkmcnt(7)
    ds_read_b64_tr_b16 a[218:219], v22 offset:20480
    v_mul_u32_u24 v243, 1536, v243
    v_mfma_f32_16x16x32_bf16 v[72:75], a[184:187], v[200:203], v[72:75]
    s_waitcnt lgkmcnt(6)
    ds_read_b64_tr_b16 a[220:221], v22 offset:24576
    v_add_u32 v2, v2, v243
    v_mfma_f32_16x16x32_bf16 v[72:75], a[188:191], v[184:187], v[72:75]
    s_mul_i32 s44, s43, 10304
    ds_read_b64_tr_b16 a[222:223], v22 offset:28672
    v_lshrrev_b32 v243, 2, v240
    v_mfma_f32_16x16x32_bf16 v[76:79], a[188:191], v[188:191], 0
    ds_read_b64_tr_b16 a[224:225], v26 offset:0
    v_lshlrev_b32 v243, 6, v243
    v_mfma_f32_16x16x32_bf16 v[76:79], a[184:187], v[204:207], v[76:79]
    ds_read_b64_tr_b16 a[226:227], v26 offset:4096
    v_and_b32 v241, 3, v240
    v_mfma_f32_16x16x32_bf16 v[76:79], a[180:183], v[156:159], v[76:79]
    ds_read_b64_tr_b16 a[228:229], v26 offset:8192
    v_lshl_add_u32 v3, v241, 3, v243
    v_mfma_f32_16x16x32_bf16 v[76:79], a[176:179], v[140:143], v[76:79]
    ds_read_b64_tr_b16 a[230:231], v26 offset:12288
    v_mul_u32_u24 v243, 1152, v7
    v_mfma_f32_16x16x32_bf16 v[76:79], a[172:175], v[180:183], v[76:79]
    ds_read_b64_tr_b16 a[232:233], v26 offset:16384
    v_add_u32 v4, v243, v3
    v_mfma_f32_16x16x32_bf16 v[76:79], a[168:171], v[196:199], v[76:79]
    ds_read_b64_tr_b16 a[234:235], v26 offset:20480
    v_lshl_add_u32 v6, v243, 1, v5
    v_mfma_f32_16x16x32_bf16 v[76:79], a[164:167], v[148:151], v[76:79]
    ds_read_b64_tr_b16 a[236:237], v26 offset:24576
    v_or_b32 v55, v3, v242
    v_mfma_f32_16x16x32_bf16 v[76:79], a[160:163], v[132:135], v[76:79]
    s_waitcnt lgkmcnt(13)
    ds_read_b64_tr_b16 a[238:239], v26 offset:28672
    v_or_b32 v58, v4, v242
    v_mfma_f32_16x16x32_bf16 v[80:83], a[208:211], v[128:131], 0
    s_waitcnt lgkmcnt(12)
    ds_read_b64_tr_b16 a[160:161], v23 offset:0
    v_or_b32 v59, v5, v242
    v_mfma_f32_16x16x32_bf16 v[80:83], a[212:215], v[144:147], v[80:83]
    s_waitcnt lgkmcnt(11)
    ds_read_b64_tr_b16 a[162:163], v23 offset:4096
    v_or_b32 v60, v6, v242
    v_mfma_f32_16x16x32_bf16 v[80:83], a[216:219], v[192:195], v[80:83]
    s_waitcnt lgkmcnt(10)
    ds_read_b64_tr_b16 a[164:165], v23 offset:8192
    s_waitcnt vmcnt(6)
    v_readfirstlane_b32 s36, v11
    v_mfma_f32_16x16x32_bf16 v[80:83], a[220:223], v[176:179], v[80:83]
    s_waitcnt lgkmcnt(9)
    ds_read_b64_tr_b16 a[166:167], v23 offset:12288
    v_lshrrev_b32 v243, 4, v1
    v_mfma_f32_16x16x32_bf16 v[80:83], a[224:227], v[136:139], v[80:83]
    ds_read_b64_tr_b16 a[168:169], v23 offset:16384
    v_lshlrev_b32 v243, 8, v243
    s_cmp_lg_u32 s36, s95
    s_cbranch_scc1 Lattn_xspin
Lattn_xgot:
    s_waitcnt lgkmcnt(9)
    v_mfma_f32_16x16x32_bf16 v[80:83], a[228:231], v[152:155], v[80:83]
    s_waitcnt lgkmcnt(7)
    ds_read_b64_tr_b16 a[170:171], v23 offset:20480
    v_and_b32 v241, 7, v1
    v_mfma_f32_16x16x32_bf16 v[80:83], a[232:235], v[200:203], v[80:83]
    s_waitcnt lgkmcnt(6)
    ds_read_b64_tr_b16 a[172:173], v23 offset:24576
    v_lshl_add_u32 v243, v241, 5, v243
    v_mfma_f32_16x16x32_bf16 v[80:83], a[236:239], v[184:187], v[80:83]
    s_add_u32 s37, s55, 0
    ds_read_b64_tr_b16 a[174:175], v23 offset:28672
    v_and_b32 v241, 8, v1
    v_mfma_f32_16x16x32_bf16 v[84:87], a[236:239], v[188:191], 0
    buffer_load_dwordx4 a[64:67], v252, s[28:31], s37 offen offset:0 sc1
    v_mfma_f32_16x16x32_bf16 v[84:87], a[232:235], v[204:207], v[84:87]
    ds_read_b64_tr_b16 a[176:177], v27 offset:0
    ds_read_b64_tr_b16 a[178:179], v27 offset:4096
    v_mfma_f32_16x16x32_bf16 v[84:87], a[228:231], v[156:159], v[84:87]
    buffer_load_dwordx4 a[96:99], v252, s[28:31], s37 offen offset:1024 sc1
    v_mfma_f32_16x16x32_bf16 v[84:87], a[224:227], v[140:143], v[84:87]
    ds_read_b64_tr_b16 a[180:181], v27 offset:8192
    ds_read_b64_tr_b16 a[182:183], v27 offset:12288
    v_mfma_f32_16x16x32_bf16 v[84:87], a[220:223], v[180:183], v[84:87]
    ds_read_b64_tr_b16 a[184:185], v27 offset:16384
    v_lshl_add_u32 v54, v241, 1, v243
    v_mfma_f32_16x16x32_bf16 v[84:87], a[216:219], v[196:199], v[84:87]
    s_lshr_b32 s41, s2, 3
    ds_read_b64_tr_b16 a[186:187], v27 offset:20480
    v_mfma_f32_16x16x32_bf16 v[84:87], a[212:215], v[148:151], v[84:87]
    buffer_load_dwordx4 a[80:83], v252, s[28:31], s37 offen offset:2048 sc1
    v_mfma_f32_16x16x32_bf16 v[84:87], a[208:211], v[132:135], v[84:87]
    s_waitcnt lgkmcnt(12)
    s_mov_b32 s14, 2359296
    ds_read_b64_tr_b16 a[188:189], v27 offset:24576
    ds_read_b64_tr_b16 a[190:191], v27 offset:28672
    s_barrier
    v_mfma_f32_16x16x32_bf16 v[88:91], a[160:163], v[128:131], 0
    s_waitcnt lgkmcnt(12)
    s_mov_b32 s15, 0x20000
    ds_read_b64_tr_b16 a[208:209], v12 offset:32768
    v_mfma_f32_16x16x32_bf16 v[88:91], a[164:167], v[144:147], v[88:91]
    s_waitcnt lgkmcnt(11)
    s_mov_b32 s18, 2359296
    ds_read_b64_tr_b16 a[210:211], v12 offset:36864
    v_mfma_f32_16x16x32_bf16 v[88:91], a[168:171], v[192:195], v[88:91]
    s_waitcnt lgkmcnt(10)
    buffer_load_dwordx4 a[112:115], v252, s[28:31], s37 offen offset:3072 sc1
    v_mfma_f32_16x16x32_bf16 v[88:91], a[172:175], v[176:179], v[88:91]
    s_waitcnt lgkmcnt(8)
    s_mov_b32 s19, 0x20000
    ds_read_b64_tr_b16 a[212:213], v12 offset:40960
    ds_read_b64_tr_b16 a[214:215], v12 offset:45056
    v_mfma_f32_16x16x32_bf16 v[88:91], a[176:179], v[136:139], v[88:91]
    s_waitcnt lgkmcnt(8)
    s_add_u32 s8, s50, 7864320
    s_addc_u32 s9, s51, 0
    ds_read_b64_tr_b16 a[216:217], v12 offset:49152
    v_mfma_f32_16x16x32_bf16 v[88:91], a[180:183], v[152:155], v[88:91]
    s_waitcnt lgkmcnt(7)
    s_add_u32 s37, s55, 4096
    ds_read_b64_tr_b16 a[218:219], v12 offset:53248
    v_mfma_f32_16x16x32_bf16 v[88:91], a[184:187], v[200:203], v[88:91]
    s_waitcnt lgkmcnt(6)
    s_add_u32 s49, s46, 256
    buffer_load_dwordx4 a[68:71], v252, s[28:31], s37 offen offset:0 sc1
    v_mfma_f32_16x16x32_bf16 v[88:91], a[188:191], v[184:187], v[88:91]
    s_add_u32 m0, s42, 0
    ds_read_b64_tr_b16 a[220:221], v12 offset:57344
    ds_read_b64_tr_b16 a[222:223], v12 offset:61440
    v_mfma_f32_16x16x32_bf16 v[92:95], a[188:191], v[188:191], 0
    buffer_load_dwordx4 v46, s[20:23], s49 offen lds
    v_mfma_f32_16x16x32_bf16 v[92:95], a[184:187], v[204:207], v[92:95]
    s_mov_b32 s10, 663552
    ds_read_b64_tr_b16 a[224:225], v16 offset:32768
    ds_read_b64_tr_b16 a[226:227], v16 offset:36864
    v_mfma_f32_16x16x32_bf16 v[92:95], a[180:183], v[156:159], v[92:95]
    buffer_load_dwordx4 v47, s[20:23], s49 offen offset:1024 lds
    v_mfma_f32_16x16x32_bf16 v[92:95], a[176:179], v[140:143], v[92:95]
    s_mov_b32 s11, 0x20000
    ds_read_b64_tr_b16 a[228:229], v16 offset:40960
    ds_read_b64_tr_b16 a[230:231], v16 offset:45056
    v_mfma_f32_16x16x32_bf16 v[92:95], a[172:175], v[180:183], v[92:95]
    buffer_load_dwordx4 a[100:103], v252, s[28:31], s37 offen offset:1024 sc1
    v_mfma_f32_16x16x32_bf16 v[92:95], a[168:171], v[196:199], v[92:95]
    s_lshl_b32 s39, s5, 13
    ds_read_b64_tr_b16 a[232:233], v16 offset:49152
    ds_read_b64_tr_b16 a[234:235], v16 offset:53248
    v_mfma_f32_16x16x32_bf16 v[92:95], a[164:167], v[148:151], v[92:95]
    s_add_u32 s39, s39, 8781824
    ds_read_b64_tr_b16 a[236:237], v16 offset:57344
    v_mfma_f32_16x16x32_bf16 v[92:95], a[160:163], v[132:135], v[92:95]
    s_waitcnt lgkmcnt(13)
    s_lshr_b32 s45, s4, 2
    ds_read_b64_tr_b16 a[238:239], v16 offset:61440
    v_mfma_f32_16x16x32_bf16 v[96:99], a[208:211], v[128:131], 0
    s_waitcnt lgkmcnt(12)
    buffer_load_dwordx4 v48, s[20:23], s49 offen offset:2048 lds
    v_mfma_f32_16x16x32_bf16 v[96:99], a[212:215], v[144:147], v[96:99]
    s_waitcnt lgkmcnt(10)
    s_lshl_b32 s45, s45, 11
    ds_read_b64_tr_b16 a[160:161], v13 offset:32768
    ds_read_b64_tr_b16 a[162:163], v13 offset:36864
    v_mfma_f32_16x16x32_bf16 v[96:99], a[216:219], v[192:195], v[96:99]
    s_waitcnt lgkmcnt(10)
    buffer_load_dwordx4 v49, s[20:23], s49 offen offset:3072 lds
    v_mfma_f32_16x16x32_bf16 v[96:99], a[220:223], v[176:179], v[96:99]
    s_waitcnt lgkmcnt(8)
    s_add_u32 s39, s39, s45
    ds_read_b64_tr_b16 a[164:165], v13 offset:40960
    ds_read_b64_tr_b16 a[166:167], v13 offset:45056
    v_mfma_f32_16x16x32_bf16 v[96:99], a[224:227], v[136:139], v[96:99]
    s_waitcnt lgkmcnt(8)
    buffer_load_dwordx4 a[84:87], v252, s[28:31], s37 offen offset:2048 sc1
    v_mfma_f32_16x16x32_bf16 v[96:99], a[228:231], v[152:155], v[96:99]
    s_waitcnt lgkmcnt(6)
    ds_read_b64_tr_b16 a[168:169], v13 offset:49152
    ds_read_b64_tr_b16 a[170:171], v13 offset:53248
    v_mfma_f32_16x16x32_bf16 v[96:99], a[232:235], v[200:203], v[96:99]
    s_waitcnt lgkmcnt(6)
    s_add_u32 s49, s46, 73984
    ds_read_b64_tr_b16 a[172:173], v13 offset:57344
    v_and_b32 v9, 15, v1
    v_mfma_f32_16x16x32_bf16 v[96:99], a[236:239], v[184:187], v[96:99]
    s_add_u32 m0, s42, 16384
    ds_read_b64_tr_b16 a[174:175], v13 offset:61440
    v_lshlrev_b32 v9, 7, v9
    v_mfma_f32_16x16x32_bf16 v[100:103], a[236:239], v[188:191], 0
    buffer_load_dwordx4 v46, s[20:23], s49 offen lds
    v_mfma_f32_16x16x32_bf16 v[100:103], a[232:235], v[204:207], v[100:103]
    ds_read_b64_tr_b16 a[176:177], v17 offset:32768
    ds_read_b64_tr_b16 a[178:179], v17 offset:36864
    v_mfma_f32_16x16x32_bf16 v[100:103], a[228:231], v[156:159], v[100:103]
    buffer_load_dwordx4 v47, s[20:23], s49 offen offset:1024 lds
    v_mfma_f32_16x16x32_bf16 v[100:103], a[224:227], v[140:143], v[100:103]
    ds_read_b64_tr_b16 a[180:181], v17 offset:40960
    ds_read_b64_tr_b16 a[182:183], v17 offset:45056
    v_mfma_f32_16x16x32_bf16 v[100:103], a[220:223], v[180:183], v[100:103]
    buffer_load_dwordx4 a[116:119], v252, s[28:31], s37 offen offset:3072 sc1
    v_mfma_f32_16x16x32_bf16 v[100:103], a[216:219], v[196:199], v[100:103]
    ds_read_b64_tr_b16 a[184:185], v17 offset:49152
    ds_read_b64_tr_b16 a[186:187], v17 offset:53248
    v_mfma_f32_16x16x32_bf16 v[100:103], a[212:215], v[148:151], v[100:103]
    ds_read_b64_tr_b16 a[188:189], v17 offset:57344
    v_mfma_f32_16x16x32_bf16 v[100:103], a[208:211], v[132:135], v[100:103]
    s_waitcnt lgkmcnt(13)
    ds_read_b64_tr_b16 a[190:191], v17 offset:61440
    v_mfma_f32_16x16x32_bf16 v[104:107], a[160:163], v[128:131], 0
    s_waitcnt lgkmcnt(12)
    buffer_load_dwordx4 v48, s[20:23], s49 offen offset:2048 lds
    v_mfma_f32_16x16x32_bf16 v[104:107], a[164:167], v[144:147], v[104:107]
    s_waitcnt lgkmcnt(10)
    ds_read_b64_tr_b16 a[208:209], v14 offset:32768
    ds_read_b64_tr_b16 a[210:211], v14 offset:36864
    v_mfma_f32_16x16x32_bf16 v[104:107], a[168:171], v[192:195], v[104:107]
    s_waitcnt lgkmcnt(10)
    buffer_load_dwordx4 v49, s[20:23], s49 offen offset:3072 lds
    v_mfma_f32_16x16x32_bf16 v[104:107], a[172:175], v[176:179], v[104:107]
    s_waitcnt lgkmcnt(8)
    s_add_u32 s37, s55, 8192
    ds_read_b64_tr_b16 a[212:213], v14 offset:40960
    ds_read_b64_tr_b16 a[214:215], v14 offset:45056
    v_mfma_f32_16x16x32_bf16 v[104:107], a[176:179], v[136:139], v[104:107]
    s_waitcnt lgkmcnt(8)
    buffer_load_dwordx4 a[72:75], v252, s[28:31], s37 offen offset:0 sc1
    v_mfma_f32_16x16x32_bf16 v[104:107], a[180:183], v[152:155], v[104:107]
    s_waitcnt lgkmcnt(6)
    ds_read_b64_tr_b16 a[216:217], v14 offset:49152
    ds_read_b64_tr_b16 a[218:219], v14 offset:53248
    v_mfma_f32_16x16x32_bf16 v[104:107], a[184:187], v[200:203], v[104:107]
    s_waitcnt lgkmcnt(6)
    buffer_load_dwordx4 a[104:107], v252, s[28:31], s37 offen offset:1024 sc1
    v_mfma_f32_16x16x32_bf16 v[104:107], a[188:191], v[184:187], v[104:107]
Ltour0_9:
    s_cbranch_execz Lmain0
    ds_read_b64_tr_b16 a[220:221], v14 offset:57344
    ds_read_b64_tr_b16 a[222:223], v14 offset:61440
    v_mfma_f32_16x16x32_bf16 v[108:111], a[188:191], v[188:191], 0
    ds_read_b64_tr_b16 a[224:225], v18 offset:32768
    v_mfma_f32_16x16x32_bf16 v[108:111], a[184:187], v[204:207], v[108:111]
    ds_read_b64_tr_b16 a[226:227], v18 offset:36864
    v_mfma_f32_16x16x32_bf16 v[108:111], a[180:183], v[156:159], v[108:111]
    buffer_load_dwordx4 a[88:91], v252, s[28:31], s37 offen offset:2048 sc1
    v_mfma_f32_16x16x32_bf16 v[108:111], a[176:179], v[140:143], v[108:111]
    ds_read_b64_tr_b16 a[228:229], v18 offset:40960
    ds_read_b64_tr_b16 a[230:231], v18 offset:45056
    v_mfma_f32_16x16x32_bf16 v[108:111], a[172:175], v[180:183], v[108:111]
    ds_read_b64_tr_b16 a[232:233], v18 offset:49152
    v_mfma_f32_16x16x32_bf16 v[108:111], a[168:171], v[196:199], v[108:111]
    ds_read_b64_tr_b16 a[234:235], v18 offset:53248
    v_mfma_f32_16x16x32_bf16 v[108:111], a[164:167], v[148:151], v[108:111]
    buffer_load_dwordx4 a[120:123], v252, s[28:31], s37 offen offset:3072 sc1
    v_mfma_f32_16x16x32_bf16 v[108:111], a[160:163], v[132:135], v[108:111]
    s_waitcnt lgkmcnt(12)
    ds_read_b64_tr_b16 a[236:237], v18 offset:57344
    ds_read_b64_tr_b16 a[238:239], v18 offset:61440
    v_mfma_f32_16x16x32_bf16 v[112:115], a[208:211], v[128:131], 0
    s_waitcnt lgkmcnt(12)
    ds_read_b64_tr_b16 a[160:161], v15 offset:32768
    v_mfma_f32_16x16x32_bf16 v[112:115], a[212:215], v[144:147], v[112:115]
    s_waitcnt lgkmcnt(11)
    s_add_u32 s37, s55, 12288
    ds_read_b64_tr_b16 a[162:163], v15 offset:36864
    v_mfma_f32_16x16x32_bf16 v[112:115], a[216:219], v[192:195], v[112:115]
    s_waitcnt lgkmcnt(10)
    buffer_load_dwordx4 a[76:79], v252, s[28:31], s37 offen offset:0 sc1
    v_mfma_f32_16x16x32_bf16 v[112:115], a[220:223], v[176:179], v[112:115]
    s_waitcnt lgkmcnt(8)
    ds_read_b64_tr_b16 a[164:165], v15 offset:40960
    ds_read_b64_tr_b16 a[166:167], v15 offset:45056
    v_mfma_f32_16x16x32_bf16 v[112:115], a[224:227], v[136:139], v[112:115]
    s_waitcnt lgkmcnt(8)
    buffer_load_dwordx4 a[108:111], v252, s[28:31], s37 offen offset:1024 sc1
    v_mfma_f32_16x16x32_bf16 v[112:115], a[228:231], v[152:155], v[112:115]
    s_waitcnt lgkmcnt(6)
    ds_read_b64_tr_b16 a[168:169], v15 offset:49152
    ds_read_b64_tr_b16 a[170:171], v15 offset:53248
    v_mfma_f32_16x16x32_bf16 v[112:115], a[232:235], v[200:203], v[112:115]
    s_waitcnt lgkmcnt(6)
    ds_read_b64_tr_b16 a[172:173], v15 offset:57344
    v_mfma_f32_16x16x32_bf16 v[112:115], a[236:239], v[184:187], v[112:115]
    ds_read_b64_tr_b16 a[174:175], v15 offset:61440
    v_mfma_f32_16x16x32_bf16 v[116:119], a[236:239], v[188:191], 0
    buffer_load_dwordx4 a[92:95], v252, s[28:31], s37 offen offset:2048 sc1
    v_mfma_f32_16x16x32_bf16 v[116:119], a[232:235], v[204:207], v[116:119]
    ds_read_b64_tr_b16 a[176:177], v19 offset:32768
    ds_read_b64_tr_b16 a[178:179], v19 offset:36864
    v_mfma_f32_16x16x32_bf16 v[116:119], a[228:231], v[156:159], v[116:119]
    ds_read_b64_tr_b16 a[180:181], v19 offset:40960
    v_mfma_f32_16x16x32_bf16 v[116:119], a[224:227], v[140:143], v[116:119]
    ds_read_b64_tr_b16 a[182:183], v19 offset:45056
    v_mfma_f32_16x16x32_bf16 v[116:119], a[220:223], v[180:183], v[116:119]
    buffer_load_dwordx4 a[124:127], v252, s[28:31], s37 offen offset:3072 sc1
    v_mfma_f32_16x16x32_bf16 v[116:119], a[216:219], v[196:199], v[116:119]
    ds_read_b64_tr_b16 a[184:185], v19 offset:49152
    ds_read_b64_tr_b16 a[186:187], v19 offset:53248
    v_mfma_f32_16x16x32_bf16 v[116:119], a[212:215], v[148:151], v[116:119]
    ds_read_b64_tr_b16 a[188:189], v19 offset:57344
    v_mfma_f32_16x16x32_bf16 v[116:119], a[208:211], v[132:135], v[116:119]
    ds_read_b64_tr_b16 a[190:191], v19 offset:61440
    s_waitcnt vmcnt(25)
    s_waitcnt lgkmcnt(0)
    s_barrier
    v_mfma_f32_16x16x32_bf16 v[120:123], a[160:163], v[128:131], 0
    ds_read_b64_tr_b16 a[208:209], v20 offset:32768
    v_mfma_f32_16x16x32_bf16 v[120:123], a[164:167], v[144:147], v[120:123]
    ds_read_b64_tr_b16 a[210:211], v20 offset:36864
    v_mfma_f32_16x16x32_bf16 v[120:123], a[168:171], v[192:195], v[120:123]
    ds_read_b64_tr_b16 a[212:213], v20 offset:40960
    v_mfma_f32_16x16x32_bf16 v[120:123], a[172:175], v[176:179], v[120:123]
    ds_read_b64_tr_b16 a[214:215], v20 offset:45056
    v_mfma_f32_16x16x32_bf16 v[120:123], a[176:179], v[136:139], v[120:123]
    ds_read_b64_tr_b16 a[216:217], v20 offset:49152
    v_mfma_f32_16x16x32_bf16 v[120:123], a[180:183], v[152:155], v[120:123]
    ds_read_b64_tr_b16 a[218:219], v20 offset:53248
    v_mfma_f32_16x16x32_bf16 v[120:123], a[184:187], v[200:203], v[120:123]
    s_add_u32 s49, s7, 512
    ds_read_b64_tr_b16 a[220:221], v20 offset:57344
    v_mfma_f32_16x16x32_bf16 v[120:123], a[188:191], v[184:187], v[120:123]
    s_add_u32 m0, s42, 65536
    ds_read_b64_tr_b16 a[222:223], v20 offset:61440
    v_mfma_f32_16x16x32_bf16 v[124:127], a[188:191], v[188:191], 0
    buffer_load_dwordx4 v46, s[20:23], s49 offen lds
    v_mfma_f32_16x16x32_bf16 v[124:127], a[184:187], v[204:207], v[124:127]
    ds_read_b64_tr_b16 a[224:225], v24 offset:32768
    ds_read_b64_tr_b16 a[226:227], v24 offset:36864
    v_mfma_f32_16x16x32_bf16 v[124:127], a[180:183], v[156:159], v[124:127]
    buffer_load_dwordx4 v47, s[20:23], s49 offen offset:1024 lds
    v_mfma_f32_16x16x32_bf16 v[124:127], a[176:179], v[140:143], v[124:127]
    ds_read_b64_tr_b16 a[228:229], v24 offset:40960
    ds_read_b64_tr_b16 a[230:231], v24 offset:45056
    v_mfma_f32_16x16x32_bf16 v[124:127], a[172:175], v[180:183], v[124:127]
    ds_read_b64_tr_b16 a[232:233], v24 offset:49152
    v_mfma_f32_16x16x32_bf16 v[124:127], a[168:171], v[196:199], v[124:127]
    ds_read_b64_tr_b16 a[234:235], v24 offset:53248
    v_mfma_f32_16x16x32_bf16 v[124:127], a[164:167], v[148:151], v[124:127]
    ds_read_b64_tr_b16 a[236:237], v24 offset:57344
    v_lshrrev_b32 v240, 4, v1
    v_mfma_f32_16x16x32_bf16 v[124:127], a[160:163], v[132:135], v[124:127]
    s_waitcnt vmcnt(25)
    s_waitcnt lgkmcnt(13)
    ds_read_b64_tr_b16 a[238:239], v24 offset:61440
    v_and_b32 v240, 2, v240
    v_mfma_f32_16x16x32_bf16 v[64:67], a[208:211], a[64:67], v[64:67]
    s_waitcnt vmcnt(21)
    s_waitcnt lgkmcnt(12)
    buffer_load_dwordx4 v48, s[20:23], s49 offen offset:2048 lds
    v_mfma_f32_16x16x32_bf16 v[64:67], a[212:215], a[68:71], v[64:67]
    s_waitcnt vmcnt(10)
    s_waitcnt lgkmcnt(10)
    ds_read_b64_tr_b16 a[160:161], v21 offset:32768
    ds_read_b64_tr_b16 a[162:163], v21 offset:36864
    v_mfma_f32_16x16x32_bf16 v[64:67], a[216:219], a[72:75], v[64:67]
    s_waitcnt vmcnt(6)
    s_waitcnt lgkmcnt(10)
    buffer_load_dwordx4 v49, s[20:23], s49 offen offset:3072 lds
    v_mfma_f32_16x16x32_bf16 v[64:67], a[220:223], a[76:79], v[64:67]
    s_waitcnt lgkmcnt(8)
    ds_read_b64_tr_b16 a[164:165], v21 offset:40960
    ds_read_b64_tr_b16 a[166:167], v21 offset:45056
    v_mfma_f32_16x16x32_bf16 v[64:67], a[224:227], a[80:83], v[64:67]
    s_waitcnt lgkmcnt(8)
    ds_read_b64_tr_b16 a[168:169], v21 offset:49152
    v_bfe_u32 v241, v1, 2, 2
    v_mfma_f32_16x16x32_bf16 v[64:67], a[228:231], a[84:87], v[64:67]
    s_waitcnt lgkmcnt(7)
    ds_read_b64_tr_b16 a[170:171], v21 offset:53248
    v_cmp_eq_u32 s[54:55], v240, v241
    v_mfma_f32_16x16x32_bf16 v[64:67], a[232:235], a[88:91], v[64:67]
    s_waitcnt vmcnt(5)
    s_waitcnt lgkmcnt(6)
    s_add_u32 s49, s7, 74240
    ds_read_b64_tr_b16 a[172:173], v21 offset:57344
    v_or_b32 v240, 1, v240
    v_mfma_f32_16x16x32_bf16 v[64:67], a[236:239], a[92:95], v[64:67]
    s_waitcnt vmcnt(4)
    s_add_u32 m0, s42, 81920
    ds_read_b64_tr_b16 a[174:175], v21 offset:61440
    v_cmp_eq_u32 s[36:37], v240, v241
    v_mfma_f32_16x16x32_bf16 v[68:71], a[236:239], a[124:127], v[68:71]
    buffer_load_dwordx4 v46, s[20:23], s49 offen lds
    v_mfma_f32_16x16x32_bf16 v[68:71], a[232:235], a[120:123], v[68:71]
    ds_read_b64_tr_b16 a[176:177], v25 offset:32768
    ds_read_b64_tr_b16 a[178:179], v25 offset:36864
    v_mfma_f32_16x16x32_bf16 v[68:71], a[228:231], a[116:119], v[68:71]
    buffer_load_dwordx4 v47, s[20:23], s49 offen offset:1024 lds
    v_mfma_f32_16x16x32_bf16 v[68:71], a[224:227], a[112:115], v[68:71]
    ds_read_b64_tr_b16 a[180:181], v25 offset:40960
    ds_read_b64_tr_b16 a[182:183], v25 offset:45056
    v_mfma_f32_16x16x32_bf16 v[68:71], a[220:223], a[108:111], v[68:71]
    ds_read_b64_tr_b16 a[184:185], v25 offset:49152
    v_cvt_pk_bf16_f32 v224, v64, v65
    v_mfma_f32_16x16x32_bf16 v[68:71], a[216:219], a[104:107], v[68:71]
    ds_read_b64_tr_b16 a[186:187], v25 offset:53248
    v_cvt_pk_bf16_f32 v225, v66, v67
    v_mfma_f32_16x16x32_bf16 v[68:71], a[212:215], a[100:103], v[68:71]
    buffer_load_dwordx2 v[36:37], v4, s[12:15], 0 offen offset:0
    v_mfma_f32_16x16x32_bf16 v[68:71], a[208:211], a[96:99], v[68:71]
    s_waitcnt lgkmcnt(12)
    ds_read_b64_tr_b16 a[188:189], v25 offset:57344
    ds_read_b64_tr_b16 a[190:191], v25 offset:61440
    v_mfma_f32_16x16x32_bf16 v[72:75], a[160:163], a[64:67], v[72:75]
    s_waitcnt lgkmcnt(12)
    buffer_load_dwordx4 v48, s[20:23], s49 offen offset:2048 lds
    v_mfma_f32_16x16x32_bf16 v[72:75], a[164:167], a[68:71], v[72:75]
    s_waitcnt lgkmcnt(10)
    ds_read_b64_tr_b16 a[208:209], v22 offset:32768
    ds_read_b64_tr_b16 a[210:211], v22 offset:36864
    v_mfma_f32_16x16x32_bf16 v[72:75], a[168:171], a[72:75], v[72:75]
    s_waitcnt lgkmcnt(10)
    buffer_load_dwordx4 v49, s[20:23], s49 offen offset:3072 lds
    v_mfma_f32_16x16x32_bf16 v[72:75], a[172:175], a[76:79], v[72:75]
    s_waitcnt lgkmcnt(8)
    ds_read_b64_tr_b16 a[212:213], v22 offset:40960
    ds_read_b64_tr_b16 a[214:215], v22 offset:45056
    v_mfma_f32_16x16x32_bf16 v[72:75], a[176:179], a[80:83], v[72:75]
    s_waitcnt lgkmcnt(8)
    ds_read_b64_tr_b16 a[216:217], v22 offset:49152
    v_cvt_pk_bf16_f32 v228, v68, v69
    v_mfma_f32_16x16x32_bf16 v[72:75], a[180:183], a[84:87], v[72:75]
    s_waitcnt lgkmcnt(7)
    ds_read_b64_tr_b16 a[218:219], v22 offset:53248
    v_cvt_pk_bf16_f32 v229, v70, v71
    v_mfma_f32_16x16x32_bf16 v[72:75], a[184:187], a[88:91], v[72:75]
    s_waitcnt lgkmcnt(6)
    ds_read_b64_tr_b16 a[220:221], v22 offset:57344
    v_and_b32 v240, 1, v1
    v_mfma_f32_16x16x32_bf16 v[72:75], a[188:191], a[92:95], v[72:75]
    ds_read_b64_tr_b16 a[222:223], v22 offset:61440
    v_lshlrev_b32 v240, 4, v240
    v_mfma_f32_16x16x32_bf16 v[76:79], a[188:191], a[124:127], v[76:79]
    buffer_load_dwordx2 v[38:39], v4, s[12:15], 0 offen offset:32
    v_mfma_f32_16x16x32_bf16 v[76:79], a[184:187], a[120:123], v[76:79]
    ds_read_b64_tr_b16 a[224:225], v26 offset:32768
    ds_read_b64_tr_b16 a[226:227], v26 offset:36864
    v_mfma_f32_16x16x32_bf16 v[76:79], a[180:183], a[116:119], v[76:79]
    ds_read_b64_tr_b16 a[228:229], v26 offset:40960
    v_mov_b32 v241, 0x3f80
    v_mfma_f32_16x16x32_bf16 v[76:79], a[176:179], a[112:115], v[76:79]
    ds_read_b64_tr_b16 a[230:231], v26 offset:45056
    v_lshlrev_b32 v240, v240, v241
    v_mfma_f32_16x16x32_bf16 v[76:79], a[172:175], a[108:111], v[76:79]
    ds_read_b64_tr_b16 a[232:233], v26 offset:49152
    v_cvt_pk_bf16_f32 v226, v72, v73
    v_mfma_f32_16x16x32_bf16 v[76:79], a[168:171], a[104:107], v[76:79]
    s_add_u32 s38, s93, 0
    ds_read_b64_tr_b16 a[234:235], v26 offset:53248
    v_cvt_pk_bf16_f32 v227, v74, v75
    v_mfma_f32_16x16x32_bf16 v[76:79], a[164:167], a[100:103], v[76:79]
    buffer_store_dwordx4 v[224:227], v56, s[28:31], s38 offen sc1
    v_mfma_f32_16x16x32_bf16 v[76:79], a[160:163], a[96:99], v[76:79]
    s_waitcnt lgkmcnt(12)
    ds_read_b64_tr_b16 a[236:237], v26 offset:57344
    ds_read_b64_tr_b16 a[238:239], v26 offset:61440
    v_mfma_f32_16x16x32_bf16 v[80:83], a[208:211], a[64:67], v[80:83]
    s_waitcnt lgkmcnt(12)
    ds_read_b64_tr_b16 a[160:161], v23 offset:32768
    v_bfe_i32 v241, v1, 1, 1
    v_mfma_f32_16x16x32_bf16 v[80:83], a[212:215], a[68:71], v[80:83]
    s_waitcnt lgkmcnt(11)
    ds_read_b64_tr_b16 a[162:163], v23 offset:36864
    v_and_b32 v243, v240, v241
    v_mfma_f32_16x16x32_bf16 v[80:83], a[216:219], a[72:75], v[80:83]
    s_waitcnt lgkmcnt(10)
    buffer_load_dwordx2 v[40:41], v4, s[12:15], 0 offen offset:512
    v_mfma_f32_16x16x32_bf16 v[80:83], a[220:223], a[76:79], v[80:83]
    s_waitcnt lgkmcnt(8)
    ds_read_b64_tr_b16 a[164:165], v23 offset:40960
    ds_read_b64_tr_b16 a[166:167], v23 offset:45056
    v_mfma_f32_16x16x32_bf16 v[80:83], a[224:227], a[80:83], v[80:83]
    s_waitcnt lgkmcnt(8)
    ds_read_b64_tr_b16 a[168:169], v23 offset:49152
    v_cvt_pk_bf16_f32 v230, v76, v77
    v_mfma_f32_16x16x32_bf16 v[80:83], a[228:231], a[84:87], v[80:83]
    s_waitcnt lgkmcnt(7)
    s_add_u32 s38, s93, 164864
    ds_read_b64_tr_b16 a[170:171], v23 offset:53248
    v_cvt_pk_bf16_f32 v231, v78, v79
    v_mfma_f32_16x16x32_bf16 v[80:83], a[232:235], a[88:91], v[80:83]
    s_waitcnt lgkmcnt(6)
    buffer_store_dwordx4 v[228:231], v56, s[28:31], s38 offen sc1
    v_mfma_f32_16x16x32_bf16 v[80:83], a[236:239], a[92:95], v[80:83]
    ds_read_b64_tr_b16 a[172:173], v23 offset:57344
    ds_read_b64_tr_b16 a[174:175], v23 offset:61440
    v_mfma_f32_16x16x32_bf16 v[84:87], a[236:239], a[124:127], v[84:87]
    ds_read_b64_tr_b16 a[176:177], v27 offset:32768
    v_xor_b32 v242, v240, v243
    v_mfma_f32_16x16x32_bf16 v[84:87], a[232:235], a[120:123], v[84:87]
    ds_read_b64_tr_b16 a[178:179], v27 offset:36864
    v_cndmask_b32 v246, 0, v242, s[54:55]
    v_mfma_f32_16x16x32_bf16 v[84:87], a[228:231], a[116:119], v[84:87]
    ds_read_b64_tr_b16 a[180:181], v27 offset:40960
    v_cndmask_b32 v247, 0, v243, s[54:55]
    v_mfma_f32_16x16x32_bf16 v[84:87], a[224:227], a[112:115], v[84:87]
    ds_read_b64_tr_b16 a[182:183], v27 offset:45056
    v_cndmask_b32 v250, 0, v242, s[36:37]
    v_mfma_f32_16x16x32_bf16 v[84:87], a[220:223], a[108:111], v[84:87]
    ds_read_b64_tr_b16 a[184:185], v27 offset:49152
    v_cvt_pk_bf16_f32 v232, v80, v81
    v_mfma_f32_16x16x32_bf16 v[84:87], a[216:219], a[104:107], v[84:87]
    ds_read_b64_tr_b16 a[186:187], v27 offset:53248
    v_cvt_pk_bf16_f32 v233, v82, v83
    v_mfma_f32_16x16x32_bf16 v[84:87], a[212:215], a[100:103], v[84:87]
    buffer_load_dwordx2 v[42:43], v4, s[12:15], 0 offen offset:544
    v_mfma_f32_16x16x32_bf16 v[84:87], a[208:211], a[96:99], v[84:87]
    s_waitcnt lgkmcnt(12)
    ds_read_b64_tr_b16 a[188:189], v27 offset:57344
    ds_read_b64_tr_b16 a[190:191], v27 offset:61440
    s_barrier
    v_mfma_f32_16x16x32_bf16 v[88:91], a[160:163], a[64:67], v[88:91]
    s_waitcnt lgkmcnt(12)
    ds_read_b64_tr_b16 a[208:209], v12 offset:0
    v_cndmask_b32 v251, 0, v243, s[36:37]
    v_mfma_f32_16x16x32_bf16 v[88:91], a[164:167], a[68:71], v[88:91]
    s_waitcnt lgkmcnt(11)
    ds_read_b64_tr_b16 a[210:211], v12 offset:4096
    v_mov_b32 v240, 0
    v_mfma_f32_16x16x32_bf16 v[88:91], a[168:171], a[72:75], v[88:91]
    s_waitcnt lgkmcnt(10)
    ds_read_b64_tr_b16 a[212:213], v12 offset:8192
    v_mov_b32 v241, 0
    v_mfma_f32_16x16x32_bf16 v[88:91], a[172:175], a[76:79], v[88:91]
    s_waitcnt lgkmcnt(9)
    ds_read_b64_tr_b16 a[214:215], v12 offset:12288
    v_mov_b32 v244, 0
    v_mfma_f32_16x16x32_bf16 v[88:91], a[176:179], a[80:83], v[88:91]
    s_waitcnt lgkmcnt(8)
    ds_read_b64_tr_b16 a[216:217], v12 offset:16384
    v_cvt_pk_bf16_f32 v236, v84, v85
    v_mfma_f32_16x16x32_bf16 v[88:91], a[180:183], a[84:87], v[88:91]
    s_waitcnt lgkmcnt(7)
    ds_read_b64_tr_b16 a[218:219], v12 offset:20480
    v_cvt_pk_bf16_f32 v237, v86, v87
    v_mfma_f32_16x16x32_bf16 v[88:91], a[184:187], a[88:91], v[88:91]
    s_waitcnt lgkmcnt(6)
    s_add_u32 s49, s46, 512
    ds_read_b64_tr_b16 a[220:221], v12 offset:24576
    v_mov_b32 v245, 0
    v_mfma_f32_16x16x32_bf16 v[88:91], a[188:191], a[92:95], v[88:91]
    s_add_u32 m0, s42, 32768
    ds_read_b64_tr_b16 a[222:223], v12 offset:28672
    v_mov_b32 v248, 0
    v_mfma_f32_16x16x32_bf16 v[92:95], a[188:191], a[124:127], v[92:95]
    buffer_load_dwordx4 v46, s[20:23], s49 offen lds
    v_mfma_f32_16x16x32_bf16 v[92:95], a[184:187], a[120:123], v[92:95]
    ds_read_b64_tr_b16 a[224:225], v16 offset:0
    ds_read_b64_tr_b16 a[226:227], v16 offset:4096
    v_mfma_f32_16x16x32_bf16 v[92:95], a[180:183], a[116:119], v[92:95]
    buffer_load_dwordx4 v47, s[20:23], s49 offen offset:1024 lds
    v_mfma_f32_16x16x32_bf16 v[92:95], a[176:179], a[112:115], v[92:95]
    ds_read_b64_tr_b16 a[228:229], v16 offset:8192
    ds_read_b64_tr_b16 a[230:231], v16 offset:12288
    v_mfma_f32_16x16x32_bf16 v[92:95], a[172:175], a[108:111], v[92:95]
    ds_read_b64_tr_b16 a[232:233], v16 offset:16384
    v_cvt_pk_bf16_f32 v234, v88, v89
    v_mfma_f32_16x16x32_bf16 v[92:95], a[168:171], a[104:107], v[92:95]
    s_add_u32 s38, s93, 128
    ds_read_b64_tr_b16 a[234:235], v16 offset:20480
    v_cvt_pk_bf16_f32 v235, v90, v91
    v_mfma_f32_16x16x32_bf16 v[92:95], a[164:167], a[100:103], v[92:95]
    buffer_store_dwordx4 v[232:235], v56, s[28:31], s38 offen sc1
    v_mfma_f32_16x16x32_bf16 v[92:95], a[160:163], a[96:99], v[92:95]
    s_waitcnt lgkmcnt(12)
    ds_read_b64_tr_b16 a[236:237], v16 offset:24576
    ds_read_b64_tr_b16 a[238:239], v16 offset:28672
    v_mfma_f32_16x16x32_bf16 v[96:99], a[208:211], a[64:67], v[96:99]
    s_waitcnt lgkmcnt(12)
    buffer_load_dwordx4 v48, s[20:23], s49 offen offset:2048 lds
    v_mfma_f32_16x16x32_bf16 v[96:99], a[212:215], a[68:71], v[96:99]
    s_waitcnt lgkmcnt(10)
    ds_read_b64_tr_b16 a[160:161], v13 offset:0
    ds_read_b64_tr_b16 a[162:163], v13 offset:4096
    v_mfma_f32_16x16x32_bf16 v[96:99], a[216:219], a[72:75], v[96:99]
    s_waitcnt lgkmcnt(10)
    buffer_load_dwordx4 v49, s[20:23], s49 offen offset:3072 lds
    v_mfma_f32_16x16x32_bf16 v[96:99], a[220:223], a[76:79], v[96:99]
    s_waitcnt lgkmcnt(8)
    ds_read_b64_tr_b16 a[164:165], v13 offset:8192
    ds_read_b64_tr_b16 a[166:167], v13 offset:12288
    v_mfma_f32_16x16x32_bf16 v[96:99], a[224:227], a[80:83], v[96:99]
    s_waitcnt lgkmcnt(8)
    ds_read_b64_tr_b16 a[168:169], v13 offset:16384
    v_cvt_pk_bf16_f32 v238, v92, v93
    v_mfma_f32_16x16x32_bf16 v[96:99], a[228:231], a[84:87], v[96:99]
    s_waitcnt lgkmcnt(7)
    s_add_u32 s38, s93, 164992
    ds_read_b64_tr_b16 a[170:171], v13 offset:20480
    v_cvt_pk_bf16_f32 v239, v94, v95
    v_mfma_f32_16x16x32_bf16 v[96:99], a[232:235], a[88:91], v[96:99]
    s_waitcnt lgkmcnt(6)
    s_add_u32 s49, s46, 74240
    buffer_store_dwordx4 v[236:239], v56, s[28:31], s38 offen sc1
    v_mfma_f32_16x16x32_bf16 v[96:99], a[236:239], a[92:95], v[96:99]
    s_add_u32 m0, s42, 49152
    ds_read_b64_tr_b16 a[172:173], v13 offset:24576
    ds_read_b64_tr_b16 a[174:175], v13 offset:28672
    v_mfma_f32_16x16x32_bf16 v[100:103], a[236:239], a[124:127], v[100:103]
    buffer_load_dwordx4 v46, s[20:23], s49 offen lds
    v_mfma_f32_16x16x32_bf16 v[100:103], a[232:235], a[120:123], v[100:103]
    ds_read_b64_tr_b16 a[176:177], v17 offset:0
    ds_read_b64_tr_b16 a[178:179], v17 offset:4096
    v_mfma_f32_16x16x32_bf16 v[100:103], a[228:231], a[116:119], v[100:103]
    buffer_load_dwordx4 v47, s[20:23], s49 offen offset:1024 lds
    v_mfma_f32_16x16x32_bf16 v[100:103], a[224:227], a[112:115], v[100:103]
    ds_read_b64_tr_b16 a[180:181], v17 offset:8192
    ds_read_b64_tr_b16 a[182:183], v17 offset:12288
    v_mfma_f32_16x16x32_bf16 v[100:103], a[220:223], a[108:111], v[100:103]
    ds_read_b64_tr_b16 a[184:185], v17 offset:16384
    v_cvt_pk_bf16_f32 v224, v96, v97
    v_mfma_f32_16x16x32_bf16 v[100:103], a[216:219], a[104:107], v[100:103]
    ds_read_b64_tr_b16 a[186:187], v17 offset:20480
    v_cvt_pk_bf16_f32 v225, v98, v99
    v_mfma_f32_16x16x32_bf16 v[100:103], a[212:215], a[100:103], v[100:103]
    ds_read_b64_tr_b16 a[188:189], v17 offset:24576
    v_mov_b32 v249, 0
    v_mfma_f32_16x16x32_bf16 v[100:103], a[208:211], a[96:99], v[100:103]
    s_waitcnt lgkmcnt(13)
    ds_read_b64_tr_b16 a[190:191], v17 offset:28672
    v_mov_b32 v252, 0
    v_mfma_f32_16x16x32_bf16 v[104:107], a[160:163], a[64:67], v[104:107]
    s_waitcnt lgkmcnt(12)
    buffer_load_dwordx4 v48, s[20:23], s49 offen offset:2048 lds
    v_mfma_f32_16x16x32_bf16 v[104:107], a[164:167], a[68:71], v[104:107]
    s_waitcnt lgkmcnt(10)
    ds_read_b64_tr_b16 a[208:209], v14 offset:0
    ds_read_b64_tr_b16 a[210:211], v14 offset:4096
    v_mfma_f32_16x16x32_bf16 v[104:107], a[168:171], a[72:75], v[104:107]
    s_waitcnt lgkmcnt(10)
    buffer_load_dwordx4 v49, s[20:23], s49 offen offset:3072 lds
    v_mfma_f32_16x16x32_bf16 v[104:107], a[172:175], a[76:79], v[104:107]
    s_waitcnt lgkmcnt(8)
    ds_read_b64_tr_b16 a[212:213], v14 offset:8192
    ds_read_b64_tr_b16 a[214:215], v14 offset:12288
    v_mfma_f32_16x16x32_bf16 v[104:107], a[176:179], a[80:83], v[104:107]
    s_waitcnt lgkmcnt(8)
    ds_read_b64_tr_b16 a[216:217], v14 offset:16384
    v_cvt_pk_bf16_f32 v228, v100, v101
    v_mfma_f32_16x16x32_bf16 v[104:107], a[180:183], a[84:87], v[104:107]
    s_waitcnt lgkmcnt(7)
    ds_read_b64_tr_b16 a[218:219], v14 offset:20480
    v_cvt_pk_bf16_f32 v229, v102, v103
    v_mfma_f32_16x16x32_bf16 v[104:107], a[184:187], a[88:91], v[104:107]
    s_waitcnt lgkmcnt(6)
    ds_read_b64_tr_b16 a[220:221], v14 offset:24576
    v_mov_b32 v253, 0
    v_mfma_f32_16x16x32_bf16 v[104:107], a[188:191], a[92:95], v[104:107]
    ds_read_b64_tr_b16 a[222:223], v14 offset:28672
    v_mfma_f32_16x16x32_bf16 v[108:111], a[188:191], a[124:127], v[108:111]
    ds_read_b64_tr_b16 a[224:225], v18 offset:0
    v_mfma_f32_16x16x32_bf16 v[108:111], a[184:187], a[120:123], v[108:111]
    ds_read_b64_tr_b16 a[226:227], v18 offset:4096
    v_mfma_f32_16x16x32_bf16 v[108:111], a[180:183], a[116:119], v[108:111]
    ds_read_b64_tr_b16 a[228:229], v18 offset:8192
    v_mfma_f32_16x16x32_bf16 v[108:111], a[176:179], a[112:115], v[108:111]
    ds_read_b64_tr_b16 a[230:231], v18 offset:12288
    v_mfma_f32_16x16x32_bf16 v[108:111], a[172:175], a[108:111], v[108:111]
    ds_read_b64_tr_b16 a[232:233], v18 offset:16384
    v_cvt_pk_bf16_f32 v226, v104, v105
    v_mfma_f32_16x16x32_bf16 v[108:111], a[168:171], a[104:107], v[108:111]
    s_add_u32 s38, s93, 512
    ds_read_b64_tr_b16 a[234:235], v18 offset:20480
    v_cvt_pk_bf16_f32 v227, v106, v107
    v_mfma_f32_16x16x32_bf16 v[108:111], a[164:167], a[100:103], v[108:111]
    buffer_store_dwordx4 v[224:227], v56, s[28:31], s38 offen sc1
    v_mfma_f32_16x16x32_bf16 v[108:111], a[160:163], a[96:99], v[108:111]
    s_waitcnt lgkmcnt(12)
    ds_read_b64_tr_b16 a[236:237], v18 offset:24576
    ds_read_b64_tr_b16 a[238:239], v18 offset:28672
    v_mfma_f32_16x16x32_bf16 v[112:115], a[208:211], a[64:67], v[112:115]
    s_waitcnt lgkmcnt(12)
    ds_read_b64_tr_b16 a[160:161], v15 offset:0
    v_mfma_f32_16x16x32_bf16 v[112:115], a[212:215], a[68:71], v[112:115]
    s_waitcnt lgkmcnt(11)
    ds_read_b64_tr_b16 a[162:163], v15 offset:4096
    v_mfma_f32_16x16x32_bf16 v[112:115], a[216:219], a[72:75], v[112:115]
    s_waitcnt lgkmcnt(10)
    ds_read_b64_tr_b16 a[164:165], v15 offset:8192
    v_mfma_f32_16x16x32_bf16 v[112:115], a[220:223], a[76:79], v[112:115]
    s_waitcnt lgkmcnt(9)
    ds_read_b64_tr_b16 a[166:167], v15 offset:12288
    v_mfma_f32_16x16x32_bf16 v[112:115], a[224:227], a[80:83], v[112:115]
    s_waitcnt lgkmcnt(8)
    ds_read_b64_tr_b16 a[168:169], v15 offset:16384
    v_cvt_pk_bf16_f32 v230, v108, v109
    v_mfma_f32_16x16x32_bf16 v[112:115], a[228:231], a[84:87], v[112:115]
    s_waitcnt lgkmcnt(7)
    s_add_u32 s38, s93, 165376
    ds_read_b64_tr_b16 a[170:171], v15 offset:20480
    v_cvt_pk_bf16_f32 v231, v110, v111
    v_mfma_f32_16x16x32_bf16 v[112:115], a[232:235], a[88:91], v[112:115]
    s_waitcnt lgkmcnt(6)
    buffer_store_dwordx4 v[228:231], v56, s[28:31], s38 offen sc1
    v_mfma_f32_16x16x32_bf16 v[112:115], a[236:239], a[92:95], v[112:115]
    ds_read_b64_tr_b16 a[172:173], v15 offset:24576
    ds_read_b64_tr_b16 a[174:175], v15 offset:28672
    v_mfma_f32_16x16x32_bf16 v[116:119], a[236:239], a[124:127], v[116:119]
    ds_read_b64_tr_b16 a[176:177], v19 offset:0
    v_mfma_f32_16x16x32_bf16 v[116:119], a[232:235], a[120:123], v[116:119]
    ds_read_b64_tr_b16 a[178:179], v19 offset:4096
    v_mfma_f32_16x16x32_bf16 v[116:119], a[228:231], a[116:119], v[116:119]
    ds_read_b64_tr_b16 a[180:181], v19 offset:8192
    v_mfma_f32_16x16x32_bf16 v[116:119], a[224:227], a[112:115], v[116:119]
    ds_read_b64_tr_b16 a[182:183], v19 offset:12288
    v_mfma_f32_16x16x32_bf16 v[116:119], a[220:223], a[108:111], v[116:119]
    ds_read_b64_tr_b16 a[184:185], v19 offset:16384
    v_cvt_pk_bf16_f32 v232, v112, v113
    v_mfma_f32_16x16x32_bf16 v[116:119], a[216:219], a[104:107], v[116:119]
    ds_read_b64_tr_b16 a[186:187], v19 offset:20480
    v_cvt_pk_bf16_f32 v233, v114, v115
    v_mfma_f32_16x16x32_bf16 v[116:119], a[212:215], a[100:103], v[116:119]
    ds_read_b64_tr_b16 a[188:189], v19 offset:24576
    v_mfma_f32_16x16x32_bf16 v[116:119], a[208:211], a[96:99], v[116:119]
    s_waitcnt lgkmcnt(13)
    ds_read_b64_tr_b16 a[190:191], v19 offset:28672
    s_waitcnt vmcnt(17)
    s_barrier
    v_mfma_f32_16x16x32_bf16 v[120:123], a[160:163], a[64:67], v[120:123]
    s_waitcnt lgkmcnt(12)
    ds_read_b64_tr_b16 a[208:209], v20 offset:0
    v_mfma_f32_16x16x32_bf16 v[120:123], a[164:167], a[68:71], v[120:123]
    s_waitcnt lgkmcnt(11)
    ds_read_b64_tr_b16 a[210:211], v20 offset:4096
    v_mfma_f32_16x16x32_bf16 v[120:123], a[168:171], a[72:75], v[120:123]
    s_waitcnt lgkmcnt(10)
    ds_read_b64_tr_b16 a[212:213], v20 offset:8192
    v_mfma_f32_16x16x32_bf16 v[120:123], a[172:175], a[76:79], v[120:123]
    s_waitcnt lgkmcnt(9)
    ds_read_b64_tr_b16 a[214:215], v20 offset:12288
    v_mfma_f32_16x16x32_bf16 v[120:123], a[176:179], a[80:83], v[120:123]
    s_waitcnt lgkmcnt(8)
    ds_read_b64_tr_b16 a[216:217], v20 offset:16384
    v_cvt_pk_bf16_f32 v236, v116, v117
    v_mfma_f32_16x16x32_bf16 v[120:123], a[180:183], a[84:87], v[120:123]
    s_waitcnt lgkmcnt(7)
    ds_read_b64_tr_b16 a[218:219], v20 offset:20480
    v_cvt_pk_bf16_f32 v237, v118, v119
    v_mfma_f32_16x16x32_bf16 v[120:123], a[184:187], a[88:91], v[120:123]
    s_waitcnt lgkmcnt(6)
    s_add_u32 s49, s7, 768
    ds_read_b64_tr_b16 a[220:221], v20 offset:24576
    v_mfma_f32_16x16x32_bf16 v[120:123], a[188:191], a[92:95], v[120:123]
    s_add_u32 m0, s42, 98304
    ds_read_b64_tr_b16 a[222:223], v20 offset:28672
    v_mfma_f32_16x16x32_bf16 v[124:127], a[188:191], a[124:127], v[124:127]
    buffer_load_dwordx4 v46, s[20:23], s49 offen lds
    v_mfma_f32_16x16x32_bf16 v[124:127], a[184:187], a[120:123], v[124:127]
    ds_read_b64_tr_b16 a[224:225], v24 offset:0
    ds_read_b64_tr_b16 a[226:227], v24 offset:4096
    v_mfma_f32_16x16x32_bf16 v[124:127], a[180:183], a[116:119], v[124:127]
    buffer_load_dwordx4 v47, s[20:23], s49 offen offset:1024 lds
    v_mfma_f32_16x16x32_bf16 v[124:127], a[176:179], a[112:115], v[124:127]
    ds_read_b64_tr_b16 a[228:229], v24 offset:8192
    ds_read_b64_tr_b16 a[230:231], v24 offset:12288
    v_mfma_f32_16x16x32_bf16 v[124:127], a[172:175], a[108:111], v[124:127]
    ds_read_b64_tr_b16 a[232:233], v24 offset:16384
    v_cvt_pk_bf16_f32 v234, v120, v121
    v_mfma_f32_16x16x32_bf16 v[124:127], a[168:171], a[104:107], v[124:127]
    s_add_u32 s38, s93, 640
    ds_read_b64_tr_b16 a[234:235], v24 offset:20480
    v_cvt_pk_bf16_f32 v235, v122, v123
    v_mfma_f32_16x16x32_bf16 v[124:127], a[164:167], a[100:103], v[124:127]
    buffer_store_dwordx4 v[232:235], v56, s[28:31], s38 offen sc1
    v_mfma_f32_16x16x32_bf16 v[124:127], a[160:163], a[96:99], v[124:127]
    s_waitcnt lgkmcnt(12)
    ds_read_b64_tr_b16 a[236:237], v24 offset:24576
    ds_read_b64_tr_b16 a[238:239], v24 offset:28672
    v_mfma_f32_16x16x32_bf16 v[64:67], a[208:211], v[128:131], 0
    s_waitcnt lgkmcnt(12)
    buffer_load_dwordx4 v48, s[20:23], s49 offen offset:2048 lds
    v_mfma_f32_16x16x32_bf16 v[64:67], a[212:215], v[144:147], v[64:67]
    s_waitcnt lgkmcnt(10)
    ds_read_b64_tr_b16 a[160:161], v21 offset:0
    ds_read_b64_tr_b16 a[162:163], v21 offset:4096
    v_mfma_f32_16x16x32_bf16 v[64:67], a[216:219], v[192:195], v[64:67]
    s_waitcnt lgkmcnt(10)
    buffer_load_dwordx4 v49, s[20:23], s49 offen offset:3072 lds
    v_mfma_f32_16x16x32_bf16 v[64:67], a[220:223], v[176:179], v[64:67]
    s_waitcnt lgkmcnt(8)
    ds_read_b64_tr_b16 a[164:165], v21 offset:8192
    ds_read_b64_tr_b16 a[166:167], v21 offset:12288
    v_mfma_f32_16x16x32_bf16 v[64:67], a[224:227], v[136:139], v[64:67]
    s_waitcnt lgkmcnt(8)
    ds_read_b64_tr_b16 a[168:169], v21 offset:16384
    v_cvt_pk_bf16_f32 v238, v124, v125
    v_mfma_f32_16x16x32_bf16 v[64:67], a[228:231], v[152:155], v[64:67]
    s_waitcnt lgkmcnt(7)
    s_add_u32 s38, s93, 165504
    ds_read_b64_tr_b16 a[170:171], v21 offset:20480
    v_cvt_pk_bf16_f32 v239, v126, v127
    v_mfma_f32_16x16x32_bf16 v[64:67], a[232:235], v[200:203], v[64:67]
    s_waitcnt lgkmcnt(6)
    s_add_u32 s49, s7, 74496
    buffer_store_dwordx4 v[236:239], v56, s[28:31], s38 offen sc1
    v_mfma_f32_16x16x32_bf16 v[64:67], a[236:239], v[184:187], v[64:67]
    s_add_u32 m0, s42, 114688
    ds_read_b64_tr_b16 a[172:173], v21 offset:24576
    ds_read_b64_tr_b16 a[174:175], v21 offset:28672
    v_mfma_f32_16x16x32_bf16 v[68:71], a[236:239], v[188:191], 0
    buffer_load_dwordx4 v46, s[20:23], s49 offen lds
    v_mfma_f32_16x16x32_bf16 v[68:71], a[232:235], v[204:207], v[68:71]
Ltour0_10:
    s_cbranch_execz Lmain0
    ds_read_b64_tr_b16 a[176:177], v25 offset:0
    ds_read_b64_tr_b16 a[178:179], v25 offset:4096
    v_mfma_f32_16x16x32_bf16 v[68:71], a[228:231], v[156:159], v[68:71]
    buffer_load_dwordx4 v47, s[20:23], s49 offen offset:1024 lds
    v_mfma_f32_16x16x32_bf16 v[68:71], a[224:227], v[140:143], v[68:71]
    ds_read_b64_tr_b16 a[180:181], v25 offset:8192
    ds_read_b64_tr_b16 a[182:183], v25 offset:12288
    v_mfma_f32_16x16x32_bf16 v[68:71], a[220:223], v[180:183], v[68:71]
    ds_read_b64_tr_b16 a[184:185], v25 offset:16384
    v_mfma_f32_16x16x32_bf16 v[68:71], a[216:219], v[196:199], v[68:71]
    ds_read_b64_tr_b16 a[186:187], v25 offset:20480
    v_mfma_f32_16x16x32_bf16 v[68:71], a[212:215], v[148:151], v[68:71]
    ds_read_b64_tr_b16 a[188:189], v25 offset:24576
    v_mfma_f32_16x16x32_bf16 v[68:71], a[208:211], v[132:135], v[68:71]
    s_waitcnt lgkmcnt(13)
    ds_read_b64_tr_b16 a[190:191], v25 offset:28672
    v_mfma_f32_16x16x32_bf16 v[72:75], a[160:163], v[128:131], 0
    s_waitcnt lgkmcnt(12)
    buffer_load_dwordx4 v48, s[20:23], s49 offen offset:2048 lds
    v_mfma_f32_16x16x32_bf16 v[72:75], a[164:167], v[144:147], v[72:75]
    s_waitcnt lgkmcnt(10)
    ds_read_b64_tr_b16 a[208:209], v22 offset:0
    ds_read_b64_tr_b16 a[210:211], v22 offset:4096
    v_mfma_f32_16x16x32_bf16 v[72:75], a[168:171], v[192:195], v[72:75]
    s_waitcnt lgkmcnt(10)
    buffer_load_dwordx4 v49, s[20:23], s49 offen offset:3072 lds
    v_mfma_f32_16x16x32_bf16 v[72:75], a[172:175], v[176:179], v[72:75]
    s_waitcnt lgkmcnt(8)
    ds_read_b64_tr_b16 a[212:213], v22 offset:8192
    ds_read_b64_tr_b16 a[214:215], v22 offset:12288
    v_mfma_f32_16x16x32_bf16 v[72:75], a[176:179], v[136:139], v[72:75]
    s_waitcnt lgkmcnt(8)
    ds_read_b64_tr_b16 a[216:217], v22 offset:16384
    v_mfma_f32_16x16x32_bf16 v[72:75], a[180:183], v[152:155], v[72:75]
    s_waitcnt lgkmcnt(7)
    ds_read_b64_tr_b16 a[218:219], v22 offset:20480
    v_mfma_f32_16x16x32_bf16 v[72:75], a[184:187], v[200:203], v[72:75]
    s_waitcnt lgkmcnt(6)
    ds_read_b64_tr_b16 a[220:221], v22 offset:24576
    v_mfma_f32_16x16x32_bf16 v[72:75], a[188:191], v[184:187], v[72:75]
    ds_read_b64_tr_b16 a[222:223], v22 offset:28672
    v_mfma_f32_16x16x32_bf16 v[76:79], a[188:191], v[188:191], 0
    ds_read_b64_tr_b16 a[224:225], v26 offset:0
    v_mfma_f32_16x16x32_bf16 v[76:79], a[184:187], v[204:207], v[76:79]
    ds_read_b64_tr_b16 a[226:227], v26 offset:4096
    v_mfma_f32_16x16x32_bf16 v[76:79], a[180:183], v[156:159], v[76:79]
    ds_read_b64_tr_b16 a[228:229], v26 offset:8192
    v_mfma_f32_16x16x32_bf16 v[76:79], a[176:179], v[140:143], v[76:79]
    ds_read_b64_tr_b16 a[230:231], v26 offset:12288
    v_mfma_f32_16x16x32_bf16 v[76:79], a[172:175], v[180:183], v[76:79]
    ds_read_b64_tr_b16 a[232:233], v26 offset:16384
    v_mfma_f32_16x16x32_bf16 v[76:79], a[168:171], v[196:199], v[76:79]
    ds_read_b64_tr_b16 a[234:235], v26 offset:20480
    v_mfma_f32_16x16x32_bf16 v[76:79], a[164:167], v[148:151], v[76:79]
    buffer_load_dword v63, v63, s[88:91], 0 offen sc1
    v_mfma_f32_16x16x32_bf16 v[76:79], a[160:163], v[132:135], v[76:79]
    s_waitcnt lgkmcnt(12)
    ds_read_b64_tr_b16 a[236:237], v26 offset:24576
    ds_read_b64_tr_b16 a[238:239], v26 offset:28672
    v_mfma_f32_16x16x32_bf16 v[80:83], a[208:211], v[128:131], 0
    s_waitcnt lgkmcnt(12)
    ds_read_b64_tr_b16 a[160:161], v23 offset:0
    v_mfma_f32_16x16x32_bf16 v[80:83], a[212:215], v[144:147], v[80:83]
    s_waitcnt lgkmcnt(11)
    ds_read_b64_tr_b16 a[162:163], v23 offset:4096
    v_mfma_f32_16x16x32_bf16 v[80:83], a[216:219], v[192:195], v[80:83]
    s_waitcnt lgkmcnt(10)
    ds_read_b64_tr_b16 a[164:165], v23 offset:8192
    v_mfma_f32_16x16x32_bf16 v[80:83], a[220:223], v[176:179], v[80:83]
    s_waitcnt lgkmcnt(9)
    ds_read_b64_tr_b16 a[166:167], v23 offset:12288
    v_mfma_f32_16x16x32_bf16 v[80:83], a[224:227], v[136:139], v[80:83]
    s_waitcnt lgkmcnt(8)
    ds_read_b64_tr_b16 a[168:169], v23 offset:16384
    v_mfma_f32_16x16x32_bf16 v[80:83], a[228:231], v[152:155], v[80:83]
    s_waitcnt lgkmcnt(7)
    ds_read_b64_tr_b16 a[170:171], v23 offset:20480
    v_mfma_f32_16x16x32_bf16 v[80:83], a[232:235], v[200:203], v[80:83]
    s_waitcnt lgkmcnt(6)
    ds_read_b64_tr_b16 a[172:173], v23 offset:24576
    v_mfma_f32_16x16x32_bf16 v[80:83], a[236:239], v[184:187], v[80:83]
    ds_read_b64_tr_b16 a[174:175], v23 offset:28672
    v_mfma_f32_16x16x32_bf16 v[84:87], a[236:239], v[188:191], 0
    ds_read_b64_tr_b16 a[176:177], v27 offset:0
    v_mfma_f32_16x16x32_bf16 v[84:87], a[232:235], v[204:207], v[84:87]
    ds_read_b64_tr_b16 a[178:179], v27 offset:4096
    v_mfma_f32_16x16x32_bf16 v[84:87], a[228:231], v[156:159], v[84:87]
    ds_read_b64_tr_b16 a[180:181], v27 offset:8192
    v_mfma_f32_16x16x32_bf16 v[84:87], a[224:227], v[140:143], v[84:87]
    ds_read_b64_tr_b16 a[182:183], v27 offset:12288
    v_mfma_f32_16x16x32_bf16 v[84:87], a[220:223], v[180:183], v[84:87]
    ds_read_b64_tr_b16 a[184:185], v27 offset:16384
    v_mfma_f32_16x16x32_bf16 v[84:87], a[216:219], v[196:199], v[84:87]
    ds_read_b64_tr_b16 a[186:187], v27 offset:20480
    v_mfma_f32_16x16x32_bf16 v[84:87], a[212:215], v[148:151], v[84:87]
    ds_read_b64_tr_b16 a[188:189], v27 offset:24576
    v_mfma_f32_16x16x32_bf16 v[84:87], a[208:211], v[132:135], v[84:87]
    s_waitcnt lgkmcnt(13)
    ds_read_b64_tr_b16 a[190:191], v27 offset:28672
    s_waitcnt vmcnt(13)
    s_barrier
    v_mfma_f32_16x16x32_bf16 v[88:91], a[160:163], v[128:131], 0
    s_waitcnt lgkmcnt(12)
    ds_read_b64_tr_b16 a[208:209], v12 offset:32768
    v_mfma_f32_16x16x32_bf16 v[88:91], a[164:167], v[144:147], v[88:91]
    s_waitcnt lgkmcnt(11)
    ds_read_b64_tr_b16 a[210:211], v12 offset:36864
    v_mfma_f32_16x16x32_bf16 v[88:91], a[168:171], v[192:195], v[88:91]
    s_waitcnt lgkmcnt(10)
    ds_read_b64_tr_b16 a[212:213], v12 offset:40960
    v_mfma_f32_16x16x32_bf16 v[88:91], a[172:175], v[176:179], v[88:91]
    s_waitcnt lgkmcnt(9)
    ds_read_b64_tr_b16 a[214:215], v12 offset:45056
    v_mfma_f32_16x16x32_bf16 v[88:91], a[176:179], v[136:139], v[88:91]
    s_waitcnt lgkmcnt(8)
    ds_read_b64_tr_b16 a[216:217], v12 offset:49152
    v_mfma_f32_16x16x32_bf16 v[88:91], a[180:183], v[152:155], v[88:91]
    s_waitcnt lgkmcnt(7)
    ds_read_b64_tr_b16 a[218:219], v12 offset:53248
    v_mfma_f32_16x16x32_bf16 v[88:91], a[184:187], v[200:203], v[88:91]
    s_waitcnt lgkmcnt(6)
    s_add_u32 s49, s46, 768
    ds_read_b64_tr_b16 a[220:221], v12 offset:57344
    v_mfma_f32_16x16x32_bf16 v[88:91], a[188:191], v[184:187], v[88:91]
    s_add_u32 m0, s42, 0
    ds_read_b64_tr_b16 a[222:223], v12 offset:61440
    v_mfma_f32_16x16x32_bf16 v[92:95], a[188:191], v[188:191], 0
    buffer_load_dwordx4 v46, s[20:23], s49 offen lds
    v_mfma_f32_16x16x32_bf16 v[92:95], a[184:187], v[204:207], v[92:95]
    ds_read_b64_tr_b16 a[224:225], v16 offset:32768
    ds_read_b64_tr_b16 a[226:227], v16 offset:36864
    v_mfma_f32_16x16x32_bf16 v[92:95], a[180:183], v[156:159], v[92:95]
    buffer_load_dwordx4 v47, s[20:23], s49 offen offset:1024 lds
    v_mfma_f32_16x16x32_bf16 v[92:95], a[176:179], v[140:143], v[92:95]
    ds_read_b64_tr_b16 a[228:229], v16 offset:40960
    ds_read_b64_tr_b16 a[230:231], v16 offset:45056
    v_mfma_f32_16x16x32_bf16 v[92:95], a[172:175], v[180:183], v[92:95]
    ds_read_b64_tr_b16 a[232:233], v16 offset:49152
    v_mfma_f32_16x16x32_bf16 v[92:95], a[168:171], v[196:199], v[92:95]
    ds_read_b64_tr_b16 a[234:235], v16 offset:53248
    v_mfma_f32_16x16x32_bf16 v[92:95], a[164:167], v[148:151], v[92:95]
    ds_read_b64_tr_b16 a[236:237], v16 offset:57344
    v_mfma_f32_16x16x32_bf16 v[92:95], a[160:163], v[132:135], v[92:95]
    s_waitcnt lgkmcnt(13)
    ds_read_b64_tr_b16 a[238:239], v16 offset:61440
    v_mfma_f32_16x16x32_bf16 v[64:67], a[208:211], a[64:67], v[64:67]
    s_waitcnt lgkmcnt(12)
    buffer_load_dwordx4 v48, s[20:23], s49 offen offset:2048 lds
    v_mfma_f32_16x16x32_bf16 v[64:67], a[212:215], a[68:71], v[64:67]
    s_waitcnt lgkmcnt(10)
    ds_read_b64_tr_b16 a[160:161], v13 offset:32768
    ds_read_b64_tr_b16 a[162:163], v13 offset:36864
    v_mfma_f32_16x16x32_bf16 v[64:67], a[216:219], a[72:75], v[64:67]
    s_waitcnt lgkmcnt(10)
    s_add_u32 s92, s92, 16
    buffer_load_dwordx4 v49, s[20:23], s49 offen offset:3072 lds
    v_mfma_f32_16x16x32_bf16 v[64:67], a[220:223], a[76:79], v[64:67]
    s_waitcnt lgkmcnt(8)
    s_waitcnt vmcnt(9)
    ds_read_b64_tr_b16 a[164:165], v13 offset:40960
    ds_read_b64_tr_b16 a[166:167], v13 offset:45056
    v_mfma_f32_16x16x32_bf16 v[64:67], a[224:227], a[80:83], v[64:67]
    s_waitcnt lgkmcnt(8)
    buffer_store_dword v10, v8, s[24:27], s92 offen sc1
    v_mfma_f32_16x16x32_bf16 v[64:67], a[228:231], a[84:87], v[64:67]
    s_waitcnt lgkmcnt(6)
    ds_read_b64_tr_b16 a[168:169], v13 offset:49152
    ds_read_b64_tr_b16 a[170:171], v13 offset:53248
    v_mfma_f32_16x16x32_bf16 v[64:67], a[232:235], a[88:91], v[64:67]
    s_waitcnt lgkmcnt(6)
    s_add_u32 s49, s46, 74496
    ds_read_b64_tr_b16 a[172:173], v13 offset:57344
    v_mfma_f32_16x16x32_bf16 v[64:67], a[236:239], a[92:95], v[64:67]
    s_add_u32 m0, s42, 16384
    ds_read_b64_tr_b16 a[174:175], v13 offset:61440
    v_mfma_f32_16x16x32_bf16 v[68:71], a[236:239], a[124:127], v[68:71]
    buffer_load_dwordx4 v46, s[20:23], s49 offen lds
    v_mfma_f32_16x16x32_bf16 v[68:71], a[232:235], a[120:123], v[68:71]
    ds_read_b64_tr_b16 a[176:177], v17 offset:32768
    ds_read_b64_tr_b16 a[178:179], v17 offset:36864
    v_mfma_f32_16x16x32_bf16 v[68:71], a[228:231], a[116:119], v[68:71]
    buffer_load_dwordx4 v47, s[20:23], s49 offen offset:1024 lds
    v_mfma_f32_16x16x32_bf16 v[68:71], a[224:227], a[112:115], v[68:71]
    ds_read_b64_tr_b16 a[180:181], v17 offset:40960
    ds_read_b64_tr_b16 a[182:183], v17 offset:45056
    v_mfma_f32_16x16x32_bf16 v[68:71], a[220:223], a[108:111], v[68:71]
    ds_read_b64_tr_b16 a[184:185], v17 offset:49152
    v_cvt_pk_bf16_f32 v224, v64, v65
    v_mfma_f32_16x16x32_bf16 v[68:71], a[216:219], a[104:107], v[68:71]
    ds_read_b64_tr_b16 a[186:187], v17 offset:53248
    v_cvt_pk_bf16_f32 v225, v66, v67
    v_mfma_f32_16x16x32_bf16 v[68:71], a[212:215], a[100:103], v[68:71]
    ds_read_b64_tr_b16 a[188:189], v17 offset:57344
    v_mfma_f32_16x16x32_bf16 v[68:71], a[208:211], a[96:99], v[68:71]
    s_waitcnt lgkmcnt(13)
    ds_read_b64_tr_b16 a[190:191], v17 offset:61440
    v_mfma_f32_16x16x32_bf16 v[72:75], a[160:163], a[64:67], v[72:75]
    s_waitcnt lgkmcnt(12)
    buffer_load_dwordx4 v48, s[20:23], s49 offen offset:2048 lds
    v_mfma_f32_16x16x32_bf16 v[72:75], a[164:167], a[68:71], v[72:75]
    s_waitcnt lgkmcnt(10)
    ds_read_b64_tr_b16 a[208:209], v14 offset:32768
    ds_read_b64_tr_b16 a[210:211], v14 offset:36864
    v_mfma_f32_16x16x32_bf16 v[72:75], a[168:171], a[72:75], v[72:75]
    s_waitcnt lgkmcnt(10)
    buffer_load_dwordx4 v49, s[20:23], s49 offen offset:3072 lds
    v_mfma_f32_16x16x32_bf16 v[72:75], a[172:175], a[76:79], v[72:75]
    s_waitcnt lgkmcnt(8)
    ds_read_b64_tr_b16 a[212:213], v14 offset:40960
    ds_read_b64_tr_b16 a[214:215], v14 offset:45056
    v_mfma_f32_16x16x32_bf16 v[72:75], a[176:179], a[80:83], v[72:75]
    s_waitcnt lgkmcnt(8)
    ds_read_b64_tr_b16 a[216:217], v14 offset:49152
    v_cvt_pk_bf16_f32 v228, v68, v69
    v_mfma_f32_16x16x32_bf16 v[72:75], a[180:183], a[84:87], v[72:75]
    s_waitcnt lgkmcnt(7)
    ds_read_b64_tr_b16 a[218:219], v14 offset:53248
    v_cvt_pk_bf16_f32 v229, v70, v71
    v_mfma_f32_16x16x32_bf16 v[72:75], a[184:187], a[88:91], v[72:75]
    s_waitcnt lgkmcnt(6)
    s_and_b32 s42, s2, 7
    ds_read_b64_tr_b16 a[220:221], v14 offset:57344
    v_mfma_f32_16x16x32_bf16 v[72:75], a[188:191], a[92:95], v[72:75]
    s_mov_b64 s[20:21], s[52:53]
    ds_read_b64_tr_b16 a[222:223], v14 offset:61440
    v_mfma_f32_16x16x32_bf16 v[76:79], a[188:191], a[124:127], v[76:79]
    ds_read_b64_tr_b16 a[224:225], v18 offset:32768
    s_waitcnt vmcnt(9)
    v_readfirstlane_b32 s37, v63
    v_mfma_f32_16x16x32_bf16 v[76:79], a[184:187], a[120:123], v[76:79]
    s_mov_b32 s22, 1152
    ds_read_b64_tr_b16 a[226:227], v18 offset:36864
    v_mfma_f32_16x16x32_bf16 v[76:79], a[180:183], a[116:119], v[76:79]
    s_mov_b32 s23, 0x20000
    ds_read_b64_tr_b16 a[228:229], v18 offset:40960
    s_cmp_lt_u32 s37, 256
    s_cbranch_scc1 Lattn_armwait
Lattn_armed:
    v_mfma_f32_16x16x32_bf16 v[76:79], a[176:179], a[112:115], v[76:79]
    ds_read_b64_tr_b16 a[230:231], v18 offset:45056
    v_mfma_f32_16x16x32_bf16 v[76:79], a[172:175], a[108:111], v[76:79]
    ds_read_b64_tr_b16 a[232:233], v18 offset:49152
    v_cvt_pk_bf16_f32 v226, v72, v73
    v_mfma_f32_16x16x32_bf16 v[76:79], a[168:171], a[104:107], v[76:79]
    s_add_u32 s38, s93, 1024
    ds_read_b64_tr_b16 a[234:235], v18 offset:53248
    v_cvt_pk_bf16_f32 v227, v74, v75
    v_mfma_f32_16x16x32_bf16 v[76:79], a[164:167], a[100:103], v[76:79]
    buffer_store_dwordx4 v[224:227], v56, s[28:31], s38 offen sc1
    v_mfma_f32_16x16x32_bf16 v[76:79], a[160:163], a[96:99], v[76:79]
    s_waitcnt lgkmcnt(12)
    s_mov_b32 s45, 18688
    ds_read_b64_tr_b16 a[236:237], v18 offset:57344
    ds_read_b64_tr_b16 a[238:239], v18 offset:61440
    v_mfma_f32_16x16x32_bf16 v[80:83], a[208:211], a[64:67], v[80:83]
    s_waitcnt lgkmcnt(12)
    buffer_load_dwordx4 v[160:163], v5, s[24:27], s45 offen offset:0 sc1
    v_mfma_f32_16x16x32_bf16 v[80:83], a[212:215], a[68:71], v[80:83]
    s_waitcnt lgkmcnt(10)
    ds_read_b64_tr_b16 a[160:161], v15 offset:32768
    ds_read_b64_tr_b16 a[162:163], v15 offset:36864
    v_mfma_f32_16x16x32_bf16 v[80:83], a[216:219], a[72:75], v[80:83]
    s_waitcnt lgkmcnt(10)
    buffer_load_dwordx4 v[164:167], v5, s[24:27], s45 offen offset:512 sc1
    v_mfma_f32_16x16x32_bf16 v[80:83], a[220:223], a[76:79], v[80:83]
    s_waitcnt lgkmcnt(8)
    ds_read_b64_tr_b16 a[164:165], v15 offset:40960
    ds_read_b64_tr_b16 a[166:167], v15 offset:45056
    v_mfma_f32_16x16x32_bf16 v[80:83], a[224:227], a[80:83], v[80:83]
    s_waitcnt lgkmcnt(8)
    ds_read_b64_tr_b16 a[168:169], v15 offset:49152
    v_cvt_pk_bf16_f32 v230, v76, v77
    v_mfma_f32_16x16x32_bf16 v[80:83], a[228:231], a[84:87], v[80:83]
    s_waitcnt lgkmcnt(7)
    s_add_u32 s38, s93, 165888
    ds_read_b64_tr_b16 a[170:171], v15 offset:53248
    v_cvt_pk_bf16_f32 v231, v78, v79
    v_mfma_f32_16x16x32_bf16 v[80:83], a[232:235], a[88:91], v[80:83]
    s_waitcnt lgkmcnt(6)
    buffer_store_dwordx4 v[228:231], v56, s[28:31], s38 offen sc1
    v_mfma_f32_16x16x32_bf16 v[80:83], a[236:239], a[92:95], v[80:83]
    ds_read_b64_tr_b16 a[172:173], v15 offset:57344
    ds_read_b64_tr_b16 a[174:175], v15 offset:61440
    v_mfma_f32_16x16x32_bf16 v[84:87], a[236:239], a[124:127], v[84:87]
    ds_read_b64_tr_b16 a[176:177], v19 offset:32768
    v_mfma_f32_16x16x32_bf16 v[84:87], a[232:235], a[120:123], v[84:87]
    ds_read_b64_tr_b16 a[178:179], v19 offset:36864
    v_mfma_f32_16x16x32_bf16 v[84:87], a[228:231], a[116:119], v[84:87]
    buffer_load_dwordx4 v[168:171], v59, s[24:27], s45 offen offset:1024 sc1
    v_mfma_f32_16x16x32_bf16 v[84:87], a[224:227], a[112:115], v[84:87]
    ds_read_b64_tr_b16 a[180:181], v19 offset:40960
    ds_read_b64_tr_b16 a[182:183], v19 offset:45056
    v_mfma_f32_16x16x32_bf16 v[84:87], a[220:223], a[108:111], v[84:87]
    ds_read_b64_tr_b16 a[184:185], v19 offset:49152
    v_cvt_pk_bf16_f32 v232, v80, v81
    v_mfma_f32_16x16x32_bf16 v[84:87], a[216:219], a[104:107], v[84:87]
    s_mov_b32 s45, 20992
    ds_read_b64_tr_b16 a[186:187], v19 offset:53248
    v_cvt_pk_bf16_f32 v233, v82, v83
    v_mfma_f32_16x16x32_bf16 v[84:87], a[212:215], a[100:103], v[84:87]
    buffer_load_dwordx4 v[172:175], v5, s[24:27], s45 offen offset:0 sc1
    v_mfma_f32_16x16x32_bf16 v[84:87], a[208:211], a[96:99], v[84:87]
    s_waitcnt lgkmcnt(12)
    ds_read_b64_tr_b16 a[188:189], v19 offset:57344
    ds_read_b64_tr_b16 a[190:191], v19 offset:61440
    s_barrier
    v_mfma_f32_16x16x32_bf16 v[88:91], a[160:163], a[64:67], v[88:91]
    s_waitcnt lgkmcnt(12)
    ds_read_b64_tr_b16 a[208:209], v20 offset:32768
    v_mfma_f32_16x16x32_bf16 v[88:91], a[164:167], a[68:71], v[88:91]
    s_waitcnt lgkmcnt(11)
    ds_read_b64_tr_b16 a[210:211], v20 offset:36864
    v_mfma_f32_16x16x32_bf16 v[88:91], a[168:171], a[72:75], v[88:91]
    s_waitcnt lgkmcnt(10)
    buffer_load_dwordx4 v[208:211], v5, s[24:27], s45 offen offset:512 sc1
    v_mfma_f32_16x16x32_bf16 v[88:91], a[172:175], a[76:79], v[88:91]
    s_waitcnt lgkmcnt(8)
    ds_read_b64_tr_b16 a[212:213], v20 offset:40960
    ds_read_b64_tr_b16 a[214:215], v20 offset:45056
    v_mfma_f32_16x16x32_bf16 v[88:91], a[176:179], a[80:83], v[88:91]
    s_waitcnt lgkmcnt(8)
    s_add_u32 s57, s59, 4096
    ds_read_b64_tr_b16 a[216:217], v20 offset:49152
    v_cvt_pk_bf16_f32 v236, v84, v85
    v_mfma_f32_16x16x32_bf16 v[88:91], a[180:183], a[84:87], v[88:91]
    s_waitcnt lgkmcnt(7)
    s_add_u32 m0, s6, -98304
    ds_read_b64_tr_b16 a[218:219], v20 offset:53248
    v_cvt_pk_bf16_f32 v237, v86, v87
    v_mfma_f32_16x16x32_bf16 v[88:91], a[184:187], a[88:91], v[88:91]
    s_waitcnt lgkmcnt(6)
    buffer_load_dwordx4 v255, s[84:87], s57 offen lds
    v_mfma_f32_16x16x32_bf16 v[88:91], a[188:191], a[92:95], v[88:91]
    ds_read_b64_tr_b16 a[220:221], v20 offset:57344
    ds_read_b64_tr_b16 a[222:223], v20 offset:61440
    v_mfma_f32_16x16x32_bf16 v[92:95], a[188:191], a[124:127], v[92:95]
    s_add_u32 s57, s59, 8192
    buffer_load_dwordx4 v[212:215], v59, s[24:27], s45 offen offset:1024 sc1
    v_mfma_f32_16x16x32_bf16 v[92:95], a[184:187], a[120:123], v[92:95]
    s_add_u32 m0, s6, -94208
    ds_read_b64_tr_b16 a[224:225], v24 offset:32768
    ds_read_b64_tr_b16 a[226:227], v24 offset:36864
    v_mfma_f32_16x16x32_bf16 v[92:95], a[180:183], a[116:119], v[92:95]
    buffer_load_dwordx4 v255, s[84:87], s57 offen lds
    v_mfma_f32_16x16x32_bf16 v[92:95], a[176:179], a[112:115], v[92:95]
    ds_read_b64_tr_b16 a[228:229], v24 offset:40960
    ds_read_b64_tr_b16 a[230:231], v24 offset:45056
    v_mfma_f32_16x16x32_bf16 v[92:95], a[172:175], a[108:111], v[92:95]
    ds_read_b64_tr_b16 a[232:233], v24 offset:49152
    v_cvt_pk_bf16_f32 v234, v88, v89
    v_mfma_f32_16x16x32_bf16 v[92:95], a[168:171], a[104:107], v[92:95]
    s_add_u32 s38, s93, 1152
    ds_read_b64_tr_b16 a[234:235], v24 offset:53248
    v_cvt_pk_bf16_f32 v235, v90, v91
    v_mfma_f32_16x16x32_bf16 v[92:95], a[164:167], a[100:103], v[92:95]
    buffer_store_dwordx4 v[232:235], v56, s[28:31], s38 offen sc1
    v_mfma_f32_16x16x32_bf16 v[92:95], a[160:163], a[96:99], v[92:95]
    s_waitcnt lgkmcnt(12)
    ds_read_b64_tr_b16 a[236:237], v24 offset:57344
    ds_read_b64_tr_b16 a[238:239], v24 offset:61440
    v_mfma_f32_16x16x32_bf16 v[96:99], a[208:211], v[128:131], 0
    s_waitcnt lgkmcnt(12)
    s_add_u32 s57, s59, 12288
    ds_read_b64_tr_b16 a[160:161], v21 offset:32768
    v_mfma_f32_16x16x32_bf16 v[96:99], a[212:215], v[144:147], v[96:99]
    s_waitcnt lgkmcnt(11)
    s_add_u32 m0, s6, -90112
    ds_read_b64_tr_b16 a[162:163], v21 offset:36864
    v_mfma_f32_16x16x32_bf16 v[96:99], a[216:219], v[192:195], v[96:99]
    s_waitcnt lgkmcnt(10)
    buffer_load_dwordx4 v255, s[84:87], s57 offen lds
    v_mfma_f32_16x16x32_bf16 v[96:99], a[220:223], v[176:179], v[96:99]
    s_waitcnt lgkmcnt(8)
    ds_read_b64_tr_b16 a[164:165], v21 offset:40960
    ds_read_b64_tr_b16 a[166:167], v21 offset:45056
    v_mfma_f32_16x16x32_bf16 v[96:99], a[224:227], v[136:139], v[96:99]
    s_waitcnt lgkmcnt(8)
    ds_read_b64_tr_b16 a[168:169], v21 offset:49152
    v_cvt_pk_bf16_f32 v238, v92, v93
    v_mfma_f32_16x16x32_bf16 v[96:99], a[228:231], v[152:155], v[96:99]
    s_waitcnt lgkmcnt(7)
    s_add_u32 s38, s93, 166016
    ds_read_b64_tr_b16 a[170:171], v21 offset:53248
    v_cvt_pk_bf16_f32 v239, v94, v95
    v_mfma_f32_16x16x32_bf16 v[96:99], a[232:235], v[200:203], v[96:99]
    s_waitcnt lgkmcnt(6)
    buffer_store_dwordx4 v[236:239], v56, s[28:31], s38 offen sc1
    v_mfma_f32_16x16x32_bf16 v[96:99], a[236:239], v[184:187], v[96:99]
    ds_read_b64_tr_b16 a[172:173], v21 offset:57344
    ds_read_b64_tr_b16 a[174:175], v21 offset:61440
    v_mfma_f32_16x16x32_bf16 v[100:103], a[236:239], v[188:191], 0
    s_add_u32 s57, s59, 16384
    buffer_load_dwordx2 v[92:93], v58, s[12:15], 0 offen offset:1024
    v_mfma_f32_16x16x32_bf16 v[100:103], a[232:235], v[204:207], v[100:103]
    s_add_u32 m0, s6, -86016
    ds_read_b64_tr_b16 a[176:177], v25 offset:32768
    ds_read_b64_tr_b16 a[178:179], v25 offset:36864
    v_mfma_f32_16x16x32_bf16 v[100:103], a[228:231], v[156:159], v[100:103]
    buffer_load_dwordx4 v255, s[84:87], s57 offen lds
    v_mfma_f32_16x16x32_bf16 v[100:103], a[224:227], v[140:143], v[100:103]
    ds_read_b64_tr_b16 a[180:181], v25 offset:40960
    ds_read_b64_tr_b16 a[182:183], v25 offset:45056
    v_mfma_f32_16x16x32_bf16 v[100:103], a[220:223], v[180:183], v[100:103]
    ds_read_b64_tr_b16 a[184:185], v25 offset:49152
    v_mfma_f32_16x16x32_bf16 v[100:103], a[216:219], v[196:199], v[100:103]
    ds_read_b64_tr_b16 a[186:187], v25 offset:53248
    v_mfma_f32_16x16x32_bf16 v[100:103], a[212:215], v[148:151], v[100:103]
    buffer_load_dwordx2 v[94:95], v58, s[12:15], 0 offen offset:1056
    v_mfma_f32_16x16x32_bf16 v[100:103], a[208:211], v[132:135], v[100:103]
    s_waitcnt lgkmcnt(12)
    ds_read_b64_tr_b16 a[188:189], v25 offset:57344
    ds_read_b64_tr_b16 a[190:191], v25 offset:61440
    v_mfma_f32_16x16x32_bf16 v[104:107], a[160:163], v[128:131], 0
    s_waitcnt lgkmcnt(12)
    s_add_u32 s57, s59, 20480
    ds_read_b64_tr_b16 a[208:209], v22 offset:32768
    v_mfma_f32_16x16x32_bf16 v[104:107], a[164:167], v[144:147], v[104:107]
    s_waitcnt lgkmcnt(11)
    s_add_u32 m0, s6, -81920
    ds_read_b64_tr_b16 a[210:211], v22 offset:36864
    v_mfma_f32_16x16x32_bf16 v[104:107], a[168:171], v[192:195], v[104:107]
    s_waitcnt lgkmcnt(10)
    buffer_load_dwordx4 v255, s[84:87], s57 offen lds
    v_mfma_f32_16x16x32_bf16 v[104:107], a[172:175], v[176:179], v[104:107]
    s_waitcnt lgkmcnt(8)
    s_mov_b32 s45, 19840
    ds_read_b64_tr_b16 a[212:213], v22 offset:40960
    ds_read_b64_tr_b16 a[214:215], v22 offset:45056
    v_mfma_f32_16x16x32_bf16 v[104:107], a[176:179], v[136:139], v[104:107]
    s_waitcnt lgkmcnt(8)
    s_add_u32 s57, s59, 24576
    buffer_load_dwordx4 v[64:67], v5, s[24:27], s45 offen offset:0 sc1
    v_mfma_f32_16x16x32_bf16 v[104:107], a[180:183], v[152:155], v[104:107]
    s_waitcnt lgkmcnt(6)
    s_add_u32 m0, s6, -77824
    ds_read_b64_tr_b16 a[216:217], v22 offset:49152
    ds_read_b64_tr_b16 a[218:219], v22 offset:53248
    v_mfma_f32_16x16x32_bf16 v[104:107], a[184:187], v[200:203], v[104:107]
    s_waitcnt lgkmcnt(6)
    buffer_load_dwordx4 v255, s[84:87], s57 offen lds
    v_mfma_f32_16x16x32_bf16 v[104:107], a[188:191], v[184:187], v[104:107]
    ds_read_b64_tr_b16 a[220:221], v22 offset:57344
    ds_read_b64_tr_b16 a[222:223], v22 offset:61440
    v_mfma_f32_16x16x32_bf16 v[108:111], a[188:191], v[188:191], 0
    s_add_u32 s57, s59, 28672
    ds_read_b64_tr_b16 a[224:225], v26 offset:32768
    v_mfma_f32_16x16x32_bf16 v[108:111], a[184:187], v[204:207], v[108:111]
    s_add_u32 m0, s6, -73728
    ds_read_b64_tr_b16 a[226:227], v26 offset:36864
    v_mfma_f32_16x16x32_bf16 v[108:111], a[180:183], v[156:159], v[108:111]
    buffer_load_dwordx4 v255, s[84:87], s57 offen lds
    v_mfma_f32_16x16x32_bf16 v[108:111], a[176:179], v[140:143], v[108:111]
    ds_read_b64_tr_b16 a[228:229], v26 offset:40960
    ds_read_b64_tr_b16 a[230:231], v26 offset:45056
    v_mfma_f32_16x16x32_bf16 v[108:111], a[172:175], v[180:183], v[108:111]
    s_add_u32 s57, s59, 32768
    buffer_load_dwordx4 v[68:71], v5, s[24:27], s45 offen offset:512 sc1
    v_mfma_f32_16x16x32_bf16 v[108:111], a[168:171], v[196:199], v[108:111]
    s_add_u32 m0, s6, -69632
    ds_read_b64_tr_b16 a[232:233], v26 offset:49152
    ds_read_b64_tr_b16 a[234:235], v26 offset:53248
    v_mfma_f32_16x16x32_bf16 v[108:111], a[164:167], v[148:151], v[108:111]
    buffer_load_dwordx4 v255, s[84:87], s57 offen lds
    v_mfma_f32_16x16x32_bf16 v[108:111], a[160:163], v[132:135], v[108:111]
    s_waitcnt lgkmcnt(12)
    ds_read_b64_tr_b16 a[236:237], v26 offset:57344
    ds_read_b64_tr_b16 a[238:239], v26 offset:61440
    v_mfma_f32_16x16x32_bf16 v[112:115], a[208:211], v[128:131], 0
    s_waitcnt lgkmcnt(12)
    ds_read_b64_tr_b16 a[160:161], v23 offset:32768
    v_mfma_f32_16x16x32_bf16 v[112:115], a[212:215], v[144:147], v[112:115]
    s_waitcnt lgkmcnt(11)
    ds_read_b64_tr_b16 a[162:163], v23 offset:36864
    v_mfma_f32_16x16x32_bf16 v[112:115], a[216:219], v[192:195], v[112:115]
    s_waitcnt lgkmcnt(10)
    ds_read_b64_tr_b16 a[164:165], v23 offset:40960
    v_mfma_f32_16x16x32_bf16 v[112:115], a[220:223], v[176:179], v[112:115]
    s_waitcnt lgkmcnt(9)
    ds_read_b64_tr_b16 a[166:167], v23 offset:45056
    v_mfma_f32_16x16x32_bf16 v[112:115], a[224:227], v[136:139], v[112:115]
    s_waitcnt lgkmcnt(8)
    buffer_load_dwordx4 v[72:75], v59, s[24:27], s45 offen offset:1024 sc1
    v_mfma_f32_16x16x32_bf16 v[112:115], a[228:231], v[152:155], v[112:115]
    s_waitcnt lgkmcnt(6)
    ds_read_b64_tr_b16 a[168:169], v23 offset:49152
    ds_read_b64_tr_b16 a[170:171], v23 offset:53248
    v_mfma_f32_16x16x32_bf16 v[112:115], a[232:235], v[200:203], v[112:115]
    s_waitcnt lgkmcnt(6)
    ds_read_b64_tr_b16 a[172:173], v23 offset:57344
    v_mfma_f32_16x16x32_bf16 v[112:115], a[236:239], v[184:187], v[112:115]
    ds_read_b64_tr_b16 a[174:175], v23 offset:61440
    v_mfma_f32_16x16x32_bf16 v[116:119], a[236:239], v[188:191], 0
    buffer_load_dwordx2 v[76:77], v3, s[20:23], 0 offen offset:0
    v_mfma_f32_16x16x32_bf16 v[116:119], a[232:235], v[204:207], v[116:119]
    ds_read_b64_tr_b16 a[176:177], v27 offset:32768
    ds_read_b64_tr_b16 a[178:179], v27 offset:36864
    v_mfma_f32_16x16x32_bf16 v[116:119], a[228:231], v[156:159], v[116:119]
    ds_read_b64_tr_b16 a[180:181], v27 offset:40960
    v_mfma_f32_16x16x32_bf16 v[116:119], a[224:227], v[140:143], v[116:119]
    ds_read_b64_tr_b16 a[182:183], v27 offset:45056
    v_mfma_f32_16x16x32_bf16 v[116:119], a[220:223], v[180:183], v[116:119]
    buffer_load_dwordx2 v[78:79], v3, s[20:23], 0 offen offset:32
    v_mfma_f32_16x16x32_bf16 v[116:119], a[216:219], v[196:199], v[116:119]
    ds_read_b64_tr_b16 a[184:185], v27 offset:49152
    ds_read_b64_tr_b16 a[186:187], v27 offset:53248
    v_mfma_f32_16x16x32_bf16 v[116:119], a[212:215], v[148:151], v[116:119]
    ds_read_b64_tr_b16 a[188:189], v27 offset:57344
    v_mfma_f32_16x16x32_bf16 v[116:119], a[208:211], v[132:135], v[116:119]
    ds_read_b64_tr_b16 a[190:191], v27 offset:61440
    s_waitcnt vmcnt(25)
    s_waitcnt lgkmcnt(0)
    s_barrier
    v_mfma_f32_16x16x32_bf16 v[120:123], a[160:163], v[128:131], 0
    ds_read_b64_tr_b16 a[208:209], v12 offset:0
    v_mfma_f32_16x16x32_bf16 v[120:123], a[164:167], v[144:147], v[120:123]
    ds_read_b64_tr_b16 a[210:211], v12 offset:4096
    v_mfma_f32_16x16x32_bf16 v[120:123], a[168:171], v[192:195], v[120:123]
    buffer_load_dwordx2 v[80:81], v3, s[20:23], 0 offen offset:512
    v_mfma_f32_16x16x32_bf16 v[120:123], a[172:175], v[176:179], v[120:123]
    s_add_u32 s39, s39, 16
    ds_read_b64_tr_b16 a[212:213], v12 offset:8192
    ds_read_b64_tr_b16 a[214:215], v12 offset:12288
    v_mfma_f32_16x16x32_bf16 v[120:123], a[176:179], v[136:139], v[120:123]
    buffer_load_dword v11, v9, s[24:27], s39 offen sc1
    v_mfma_f32_16x16x32_bf16 v[120:123], a[180:183], v[152:155], v[120:123]
    ds_read_b64_tr_b16 a[216:217], v12 offset:16384
    ds_read_b64_tr_b16 a[218:219], v12 offset:20480
    v_mfma_f32_16x16x32_bf16 v[120:123], a[184:187], v[200:203], v[120:123]
    ds_read_b64_tr_b16 a[220:221], v12 offset:24576
    v_mfma_f32_16x16x32_bf16 v[120:123], a[188:191], v[184:187], v[120:123]
    ds_read_b64_tr_b16 a[222:223], v12 offset:28672
    v_mfma_f32_16x16x32_bf16 v[124:127], a[188:191], v[188:191], 0
    buffer_load_dwordx2 v[82:83], v3, s[20:23], 0 offen offset:544
    v_mfma_f32_16x16x32_bf16 v[124:127], a[184:187], v[204:207], v[124:127]
    ds_read_b64_tr_b16 a[224:225], v16 offset:0
    ds_read_b64_tr_b16 a[226:227], v16 offset:4096
    v_mfma_f32_16x16x32_bf16 v[124:127], a[180:183], v[156:159], v[124:127]
    ds_read_b64_tr_b16 a[228:229], v16 offset:8192
    v_mfma_f32_16x16x32_bf16 v[124:127], a[176:179], v[140:143], v[124:127]
    ds_read_b64_tr_b16 a[230:231], v16 offset:12288
    v_mfma_f32_16x16x32_bf16 v[124:127], a[172:175], v[180:183], v[124:127]
    buffer_load_dwordx2 v[84:85], v55, s[20:23], 0 offen offset:1024
    v_mfma_f32_16x16x32_bf16 v[124:127], a[168:171], v[196:199], v[124:127]
    ds_read_b64_tr_b16 a[232:233], v16 offset:16384
    ds_read_b64_tr_b16 a[234:235], v16 offset:20480
    v_mfma_f32_16x16x32_bf16 v[124:127], a[164:167], v[148:151], v[124:127]
    ds_read_b64_tr_b16 a[236:237], v16 offset:24576
    v_mfma_f32_16x16x32_bf16 v[124:127], a[160:163], v[132:135], v[124:127]
    s_waitcnt lgkmcnt(13)
    ds_read_b64_tr_b16 a[238:239], v16 offset:28672
    v_mfma_f32_16x16x32_bf16 v[96:99], a[208:211], a[64:67], v[96:99]
    s_waitcnt lgkmcnt(12)
    buffer_load_dwordx2 v[86:87], v55, s[20:23], 0 offen offset:1056
    v_mfma_f32_16x16x32_bf16 v[96:99], a[212:215], a[68:71], v[96:99]
    s_waitcnt lgkmcnt(10)
    ds_read_b64_tr_b16 a[160:161], v13 offset:0
    ds_read_b64_tr_b16 a[162:163], v13 offset:4096
    v_mfma_f32_16x16x32_bf16 v[96:99], a[216:219], a[72:75], v[96:99]
    s_waitcnt lgkmcnt(10)
    ds_read_b64_tr_b16 a[164:165], v13 offset:8192
    v_mfma_f32_16x16x32_bf16 v[96:99], a[220:223], a[76:79], v[96:99]
    s_waitcnt lgkmcnt(9)
    ds_read_b64_tr_b16 a[166:167], v13 offset:12288
    v_mfma_f32_16x16x32_bf16 v[96:99], a[224:227], a[80:83], v[96:99]
    s_waitcnt lgkmcnt(8)
    ds_read_b64_tr_b16 a[168:169], v13 offset:16384
    v_mfma_f32_16x16x32_bf16 v[96:99], a[228:231], a[84:87], v[96:99]
Ltour0_11:
    s_cbranch_execz Lmain0
    s_waitcnt lgkmcnt(7)
    s_mov_b32 s45, 22144
    ds_read_b64_tr_b16 a[170:171], v13 offset:20480
    v_mfma_f32_16x16x32_bf16 v[96:99], a[232:235], a[88:91], v[96:99]
    s_waitcnt lgkmcnt(6)
    buffer_load_dwordx4 v[216:219], v5, s[24:27], s45 offen offset:0 sc1
    v_mfma_f32_16x16x32_bf16 v[96:99], a[236:239], a[92:95], v[96:99]
    ds_read_b64_tr_b16 a[172:173], v13 offset:24576
    ds_read_b64_tr_b16 a[174:175], v13 offset:28672
    v_mfma_f32_16x16x32_bf16 v[100:103], a[236:239], a[124:127], v[100:103]
    ds_read_b64_tr_b16 a[176:177], v17 offset:0
    v_mfma_f32_16x16x32_bf16 v[100:103], a[232:235], a[120:123], v[100:103]
    ds_read_b64_tr_b16 a[178:179], v17 offset:4096
    v_mfma_f32_16x16x32_bf16 v[100:103], a[228:231], a[116:119], v[100:103]
    buffer_load_dwordx4 v[220:223], v5, s[24:27], s45 offen offset:512 sc1
    v_mfma_f32_16x16x32_bf16 v[100:103], a[224:227], a[112:115], v[100:103]
    ds_read_b64_tr_b16 a[180:181], v17 offset:8192
    ds_read_b64_tr_b16 a[182:183], v17 offset:12288
    v_mfma_f32_16x16x32_bf16 v[100:103], a[220:223], a[108:111], v[100:103]
    ds_read_b64_tr_b16 a[184:185], v17 offset:16384
    v_cvt_pk_bf16_f32 v224, v96, v97
    v_mfma_f32_16x16x32_bf16 v[100:103], a[216:219], a[104:107], v[100:103]
    ds_read_b64_tr_b16 a[186:187], v17 offset:20480
    v_cvt_pk_bf16_f32 v225, v98, v99
    v_mfma_f32_16x16x32_bf16 v[100:103], a[212:215], a[100:103], v[100:103]
    ds_read_b64_tr_b16 a[188:189], v17 offset:24576
    v_mfma_f32_16x16x32_bf16 v[100:103], a[208:211], a[96:99], v[100:103]
    s_waitcnt lgkmcnt(13)
    ds_read_b64_tr_b16 a[190:191], v17 offset:28672
    v_mfma_f32_16x16x32_bf16 v[104:107], a[160:163], a[64:67], v[104:107]
    s_waitcnt lgkmcnt(12)
    buffer_load_dwordx4 v[88:91], v59, s[24:27], s45 offen offset:1024 sc1
    v_mfma_f32_16x16x32_bf16 v[104:107], a[164:167], a[68:71], v[104:107]
    s_waitcnt lgkmcnt(10)
    ds_read_b64_tr_b16 a[208:209], v14 offset:0
    ds_read_b64_tr_b16 a[210:211], v14 offset:4096
    v_mfma_f32_16x16x32_bf16 v[104:107], a[168:171], a[72:75], v[104:107]
    s_waitcnt lgkmcnt(10)
    ds_read_b64_tr_b16 a[212:213], v14 offset:8192
    v_mfma_f32_16x16x32_bf16 v[104:107], a[172:175], a[76:79], v[104:107]
    s_waitcnt lgkmcnt(9)
    ds_read_b64_tr_b16 a[214:215], v14 offset:12288
    v_mfma_f32_16x16x32_bf16 v[104:107], a[176:179], a[80:83], v[104:107]
    s_waitcnt lgkmcnt(8)
    ds_read_b64_tr_b16 a[216:217], v14 offset:16384
    v_cvt_pk_bf16_f32 v228, v100, v101
    v_mfma_f32_16x16x32_bf16 v[104:107], a[180:183], a[84:87], v[104:107]
    s_waitcnt lgkmcnt(7)
    ds_read_b64_tr_b16 a[218:219], v14 offset:20480
    v_cvt_pk_bf16_f32 v229, v102, v103
    v_mfma_f32_16x16x32_bf16 v[104:107], a[184:187], a[88:91], v[104:107]
    s_waitcnt lgkmcnt(6)
    ds_read_b64_tr_b16 a[220:221], v14 offset:24576
    v_mfma_f32_16x16x32_bf16 v[104:107], a[188:191], a[92:95], v[104:107]
    ds_read_b64_tr_b16 a[222:223], v14 offset:28672
    v_mfma_f32_16x16x32_bf16 v[108:111], a[188:191], a[124:127], v[108:111]
    ds_read_b64_tr_b16 a[224:225], v18 offset:0
    v_mfma_f32_16x16x32_bf16 v[108:111], a[184:187], a[120:123], v[108:111]
    ds_read_b64_tr_b16 a[226:227], v18 offset:4096
    v_mfma_f32_16x16x32_bf16 v[108:111], a[180:183], a[116:119], v[108:111]
    ds_read_b64_tr_b16 a[228:229], v18 offset:8192
    v_mfma_f32_16x16x32_bf16 v[108:111], a[176:179], a[112:115], v[108:111]
    ds_read_b64_tr_b16 a[230:231], v18 offset:12288
    v_mfma_f32_16x16x32_bf16 v[108:111], a[172:175], a[108:111], v[108:111]
    ds_read_b64_tr_b16 a[232:233], v18 offset:16384
    v_cvt_pk_bf16_f32 v226, v104, v105
    v_mfma_f32_16x16x32_bf16 v[108:111], a[168:171], a[104:107], v[108:111]
    s_add_u32 s38, s93, 1536
    ds_read_b64_tr_b16 a[234:235], v18 offset:20480
    v_cvt_pk_bf16_f32 v227, v106, v107
    v_mfma_f32_16x16x32_bf16 v[108:111], a[164:167], a[100:103], v[108:111]
    buffer_store_dwordx4 v[224:227], v56, s[28:31], s38 offen sc1
    v_mfma_f32_16x16x32_bf16 v[108:111], a[160:163], a[96:99], v[108:111]
    s_waitcnt lgkmcnt(12)
    ds_read_b64_tr_b16 a[236:237], v18 offset:24576
    ds_read_b64_tr_b16 a[238:239], v18 offset:28672
    v_mfma_f32_16x16x32_bf16 v[112:115], a[208:211], a[64:67], v[112:115]
    s_waitcnt lgkmcnt(12)
    ds_read_b64_tr_b16 a[160:161], v15 offset:0
    v_mfma_f32_16x16x32_bf16 v[112:115], a[212:215], a[68:71], v[112:115]
    s_waitcnt lgkmcnt(11)
    ds_read_b64_tr_b16 a[162:163], v15 offset:4096
    v_mfma_f32_16x16x32_bf16 v[112:115], a[216:219], a[72:75], v[112:115]
    s_waitcnt lgkmcnt(10)
    ds_read_b64_tr_b16 a[164:165], v15 offset:8192
    v_mfma_f32_16x16x32_bf16 v[112:115], a[220:223], a[76:79], v[112:115]
    s_waitcnt lgkmcnt(9)
    ds_read_b64_tr_b16 a[166:167], v15 offset:12288
    v_mfma_f32_16x16x32_bf16 v[112:115], a[224:227], a[80:83], v[112:115]
    s_waitcnt lgkmcnt(8)
    ds_read_b64_tr_b16 a[168:169], v15 offset:16384
    v_cvt_pk_bf16_f32 v230, v108, v109
    v_mfma_f32_16x16x32_bf16 v[112:115], a[228:231], a[84:87], v[112:115]
    s_waitcnt lgkmcnt(7)
    s_add_u32 s38, s93, 166400
    ds_read_b64_tr_b16 a[170:171], v15 offset:20480
    v_cvt_pk_bf16_f32 v231, v110, v111
    v_mfma_f32_16x16x32_bf16 v[112:115], a[232:235], a[88:91], v[112:115]
    s_waitcnt lgkmcnt(6)
    buffer_store_dwordx4 v[228:231], v56, s[28:31], s38 offen sc1
    v_mfma_f32_16x16x32_bf16 v[112:115], a[236:239], a[92:95], v[112:115]
    ds_read_b64_tr_b16 a[172:173], v15 offset:24576
    ds_read_b64_tr_b16 a[174:175], v15 offset:28672
    v_mfma_f32_16x16x32_bf16 v[116:119], a[236:239], a[124:127], v[116:119]
    ds_read_b64_tr_b16 a[176:177], v19 offset:0
    v_mfma_f32_16x16x32_bf16 v[116:119], a[232:235], a[120:123], v[116:119]
    ds_read_b64_tr_b16 a[178:179], v19 offset:4096
    v_mfma_f32_16x16x32_bf16 v[116:119], a[228:231], a[116:119], v[116:119]
    ds_read_b64_tr_b16 a[180:181], v19 offset:8192
    v_mfma_f32_16x16x32_bf16 v[116:119], a[224:227], a[112:115], v[116:119]
    ds_read_b64_tr_b16 a[182:183], v19 offset:12288
    v_mfma_f32_16x16x32_bf16 v[116:119], a[220:223], a[108:111], v[116:119]
    ds_read_b64_tr_b16 a[184:185], v19 offset:16384
    v_cvt_pk_bf16_f32 v232, v112, v113
    v_mfma_f32_16x16x32_bf16 v[116:119], a[216:219], a[104:107], v[116:119]
    ds_read_b64_tr_b16 a[186:187], v19 offset:20480
    v_cvt_pk_bf16_f32 v233, v114, v115
    v_mfma_f32_16x16x32_bf16 v[116:119], a[212:215], a[100:103], v[116:119]
    ds_read_b64_tr_b16 a[188:189], v19 offset:24576
    v_mfma_f32_16x16x32_bf16 v[116:119], a[208:211], a[96:99], v[116:119]
    s_waitcnt lgkmcnt(13)
    ds_read_b64_tr_b16 a[190:191], v19 offset:28672
    v_mfma_f32_16x16x32_bf16 v[120:123], a[160:163], a[64:67], v[120:123]
    s_waitcnt lgkmcnt(12)
    v_mfma_f32_16x16x32_bf16 v[120:123], a[164:167], a[68:71], v[120:123]
    s_waitcnt lgkmcnt(10)
    v_mfma_f32_16x16x32_bf16 v[120:123], a[168:171], a[72:75], v[120:123]
    s_waitcnt lgkmcnt(8)
    v_mfma_f32_16x16x32_bf16 v[120:123], a[172:175], a[76:79], v[120:123]
    s_waitcnt lgkmcnt(6)
    v_mfma_f32_16x16x32_bf16 v[120:123], a[176:179], a[80:83], v[120:123]
    s_waitcnt lgkmcnt(4)
    v_cvt_pk_bf16_f32 v236, v116, v117
    v_mfma_f32_16x16x32_bf16 v[120:123], a[180:183], a[84:87], v[120:123]
    s_waitcnt lgkmcnt(2)
    v_cvt_pk_bf16_f32 v237, v118, v119
    v_mfma_f32_16x16x32_bf16 v[120:123], a[184:187], a[88:91], v[120:123]
    s_waitcnt lgkmcnt(0)
    v_mfma_f32_16x16x32_bf16 v[120:123], a[188:191], a[92:95], v[120:123]
    v_mfma_f32_16x16x32_bf16 v[124:127], a[188:191], a[124:127], v[124:127]
    v_mfma_f32_16x16x32_bf16 v[124:127], a[184:187], a[120:123], v[124:127]
    v_mfma_f32_16x16x32_bf16 v[124:127], a[180:183], a[116:119], v[124:127]
    v_mfma_f32_16x16x32_bf16 v[124:127], a[176:179], a[112:115], v[124:127]
    v_mfma_f32_16x16x32_bf16 v[124:127], a[172:175], a[108:111], v[124:127]
    s_nop 2
    v_cvt_pk_bf16_f32 v234, v120, v121
    v_mfma_f32_16x16x32_bf16 v[124:127], a[168:171], a[104:107], v[124:127]
    s_add_u32 s38, s93, 1664
    v_cvt_pk_bf16_f32 v235, v122, v123
    v_mfma_f32_16x16x32_bf16 v[124:127], a[164:167], a[100:103], v[124:127]
    buffer_store_dwordx4 v[232:235], v56, s[28:31], s38 offen sc1
    v_mfma_f32_16x16x32_bf16 v[124:127], a[160:163], a[96:99], v[124:127]
    s_nop 7
    v_cvt_pk_bf16_f32 v238, v124, v125
    s_add_u32 s38, s93, 166528
    v_cvt_pk_bf16_f32 v239, v126, v127
    buffer_store_dwordx4 v[236:239], v56, s[28:31], s38 offen sc1
    s_add_u32 s92, s92, 16
    s_waitcnt vmcnt(35)
    v_lshlrev_b32 v96, 16, v160
    v_and_b32 v97, 0xffff0000, v160
    v_lshlrev_b32 v98, 16, v161
    v_and_b32 v99, 0xffff0000, v161
    v_lshlrev_b32 v100, 16, v162
    v_and_b32 v101, 0xffff0000, v162
    v_lshlrev_b32 v102, 16, v163
    v_and_b32 v103, 0xffff0000, v163
    s_waitcnt vmcnt(34)
    v_lshlrev_b32 v104, 16, v164
    v_and_b32 v105, 0xffff0000, v164
    v_lshlrev_b32 v106, 16, v165
    v_and_b32 v107, 0xffff0000, v165
    v_lshlrev_b32 v108, 16, v166
    v_and_b32 v109, 0xffff0000, v166
    v_lshlrev_b32 v110, 16, v167
    v_and_b32 v111, 0xffff0000, v167
    s_waitcnt vmcnt(32)
    v_lshlrev_b32 v112, 16, v168
    v_and_b32 v113, 0xffff0000, v168
    v_lshlrev_b32 v114, 16, v169
    v_and_b32 v115, 0xffff0000, v169
    v_lshlrev_b32 v116, 16, v170
    v_and_b32 v117, 0xffff0000, v170
    v_lshlrev_b32 v118, 16, v171
    v_and_b32 v119, 0xffff0000, v171
    s_waitcnt vmcnt(31)
    v_lshlrev_b32 v120, 16, v172
    v_and_b32 v121, 0xffff0000, v172
    v_lshlrev_b32 v122, 16, v173
    v_and_b32 v123, 0xffff0000, v173
    v_lshlrev_b32 v124, 16, v174
    v_and_b32 v125, 0xffff0000, v174
    v_lshlrev_b32 v126, 16, v175
    v_and_b32 v127, 0xffff0000, v175
    s_waitcnt vmcnt(30)
    v_lshlrev_b32 v128, 16, v208
    v_and_b32 v129, 0xffff0000, v208
    v_lshlrev_b32 v130, 16, v209
    v_and_b32 v131, 0xffff0000, v209
    v_lshlrev_b32 v132, 16, v210
    v_and_b32 v133, 0xffff0000, v210
    v_lshlrev_b32 v134, 16, v211
    v_and_b32 v135, 0xffff0000, v211
    s_waitcnt vmcnt(28)
    v_lshlrev_b32 v136, 16, v212
    v_and_b32 v137, 0xffff0000, v212
    v_lshlrev_b32 v138, 16, v213
    v_and_b32 v139, 0xffff0000, v213
    v_lshlrev_b32 v140, 16, v214
    v_and_b32 v141, 0xffff0000, v214
    v_lshlrev_b32 v142, 16, v215
    v_and_b32 v143, 0xffff0000, v215
    s_waitcnt vmcnt(19)
    v_lshlrev_b32 v144, 16, v64
    v_and_b32 v145, 0xffff0000, v64
    v_lshlrev_b32 v146, 16, v65
    v_and_b32 v147, 0xffff0000, v65
    v_lshlrev_b32 v148, 16, v66
    v_and_b32 v149, 0xffff0000, v66
    v_lshlrev_b32 v150, 16, v67
    v_and_b32 v151, 0xffff0000, v67
    s_waitcnt vmcnt(16)
    v_lshlrev_b32 v152, 16, v68
    v_and_b32 v153, 0xffff0000, v68
    v_lshlrev_b32 v154, 16, v69
    v_and_b32 v155, 0xffff0000, v69
    v_lshlrev_b32 v156, 16, v70
    v_and_b32 v157, 0xffff0000, v70
    v_lshlrev_b32 v158, 16, v71
    v_and_b32 v159, 0xffff0000, v71
    s_waitcnt vmcnt(14)
    v_lshlrev_b32 v160, 16, v72
    v_and_b32 v161, 0xffff0000, v72
    v_lshlrev_b32 v162, 16, v73
    v_and_b32 v163, 0xffff0000, v73
    v_lshlrev_b32 v164, 16, v74
    v_and_b32 v165, 0xffff0000, v74
    v_lshlrev_b32 v166, 16, v75
    v_and_b32 v167, 0xffff0000, v75
    s_waitcnt vmcnt(13)
    v_lshlrev_b32 v168, 16, v76
    v_and_b32 v169, 0xffff0000, v76
    v_lshlrev_b32 v170, 16, v77
    v_and_b32 v171, 0xffff0000, v77
    s_waitcnt vmcnt(12)
    v_lshlrev_b32 v172, 16, v78
    v_and_b32 v173, 0xffff0000, v78
    v_lshlrev_b32 v174, 16, v79
    v_and_b32 v175, 0xffff0000, v79
    s_waitcnt vmcnt(11)
    v_lshlrev_b32 v176, 16, v80
    v_and_b32 v177, 0xffff0000, v80
    v_lshlrev_b32 v178, 16, v81
    v_and_b32 v179, 0xffff0000, v81
    s_waitcnt vmcnt(9)
    v_lshlrev_b32 v180, 16, v82
    v_and_b32 v181, 0xffff0000, v82
    v_lshlrev_b32 v182, 16, v83
    v_and_b32 v183, 0xffff0000, v83
    s_waitcnt vmcnt(8)
    v_lshlrev_b32 v184, 16, v84
    v_and_b32 v185, 0xffff0000, v84
    v_lshlrev_b32 v186, 16, v85
    v_and_b32 v187, 0xffff0000, v85
    s_waitcnt vmcnt(7)
    v_lshlrev_b32 v188, 16, v86
    v_and_b32 v189, 0xffff0000, v86
    v_lshlrev_b32 v190, 16, v87
    v_and_b32 v191, 0xffff0000, v87
    s_waitcnt vmcnt(0)
    buffer_store_dword v10, v8, s[24:27], s92 offen sc1
    v_cmp_ne_u32 s[54:55], s95, v11
    s_cmp_lg_u64 s[54:55], 0
    s_cbranch_scc1 Ltail_spin1
Ltail_got1:
    s_add_u32 s56, s44, 16384
    buffer_load_dwordx4 a[0:3], v54, s[28:31], s56 offen offset:0 sc1
    buffer_load_dwordx4 a[4:7], v54, s[28:31], s56 offen offset:1024 sc1
    buffer_load_dwordx4 a[8:11], v54, s[28:31], s56 offen offset:2048 sc1
    buffer_load_dwordx4 a[12:15], v54, s[28:31], s56 offen offset:3072 sc1
    s_add_u32 s56, s44, 0
    buffer_load_dwordx4 a[16:19], v2, s[28:31], s56 offen offset:0 sc1
    s_add_u32 s56, s44, 4096
    buffer_load_dwordx4 a[20:23], v2, s[28:31], s56 offen offset:0 sc1
    s_add_u32 s56, s44, 8192
    buffer_load_dwordx4 a[24:27], v2, s[28:31], s56 offen offset:0 sc1
    s_add_u32 s56, s44, 12288
    buffer_load_dwordx4 a[28:31], v2, s[28:31], s56 offen offset:0 sc1
    ds_write_b128 v51, a[128:131] offset:0
    ds_write_b128 v51, a[132:135] offset:4096
    ds_write_b128 v51, a[136:139] offset:8192
    ds_write_b128 v51, a[140:143] offset:12288
    ds_write_b128 v51, a[144:147] offset:16384
    ds_write_b128 v51, a[148:151] offset:20480
    ds_write_b128 v51, a[152:155] offset:24576
    ds_write_b128 v51, a[156:159] offset:28672
    ds_write_b128 v51, a[240:243] offset:32768
    ds_write_b128 v255, a[244:247] offset:40960
    ds_write_b128 v255, a[248:251] offset:45056
    ds_write_b128 v255, a[252:255] offset:61440
    v_lshlrev_b32 v12, 16, v36
    v_and_b32 v13, 0xffff0000, v36
    v_lshlrev_b32 v14, 16, v37
    v_and_b32 v15, 0xffff0000, v37
    v_lshlrev_b32 v16, 16, v38
    v_and_b32 v17, 0xffff0000, v38
    v_lshlrev_b32 v18, 16, v39
    v_and_b32 v19, 0xffff0000, v39
    v_lshlrev_b32 v20, 16, v40
    v_and_b32 v21, 0xffff0000, v40
    v_lshlrev_b32 v22, 16, v41
    v_and_b32 v23, 0xffff0000, v41
    v_lshlrev_b32 v24, 16, v42
    v_and_b32 v25, 0xffff0000, v42
    v_lshlrev_b32 v26, 16, v43
    v_and_b32 v27, 0xffff0000, v43
    v_lshlrev_b32 v28, 16, v92
    v_and_b32 v29, 0xffff0000, v92
    v_lshlrev_b32 v30, 16, v93
    v_and_b32 v31, 0xffff0000, v93
    v_lshlrev_b32 v32, 16, v94
    v_and_b32 v33, 0xffff0000, v94
    v_lshlrev_b32 v34, 16, v95
    v_and_b32 v35, 0xffff0000, v95
    v_lshlrev_b32 v192, 16, v216
    v_and_b32 v193, 0xffff0000, v216
    v_lshlrev_b32 v194, 16, v217
    v_and_b32 v195, 0xffff0000, v217
    v_lshlrev_b32 v196, 16, v218
    v_and_b32 v197, 0xffff0000, v218
    v_lshlrev_b32 v198, 16, v219
    v_and_b32 v199, 0xffff0000, v219
    v_lshlrev_b32 v200, 16, v220
    v_and_b32 v201, 0xffff0000, v220
    v_lshlrev_b32 v202, 16, v221
    v_and_b32 v203, 0xffff0000, v221
    v_lshlrev_b32 v204, 16, v222
    v_and_b32 v205, 0xffff0000, v222
    v_lshlrev_b32 v206, 16, v223
    v_and_b32 v207, 0xffff0000, v223
    v_lshlrev_b32 v208, 16, v88
    v_and_b32 v209, 0xffff0000, v88
    v_lshlrev_b32 v210, 16, v89
    v_and_b32 v211, 0xffff0000, v89
    v_lshlrev_b32 v212, 16, v90
    v_and_b32 v213, 0xffff0000, v90
    v_lshlrev_b32 v214, 16, v91
    v_and_b32 v215, 0xffff0000, v91
    s_add_u32 s39, s39, 16
    buffer_load_dword v11, v9, s[24:27], s39 offen sc1
    s_add_u32 s56, s44, 0
    buffer_load_dwordx4 a[32:35], v2, s[28:31], s56 offen offset:512 sc1
    s_add_u32 s56, s44, 4096
    buffer_load_dwordx4 a[36:39], v2, s[28:31], s56 offen offset:512 sc1
    s_add_u32 s56, s44, 8192
    buffer_load_dwordx4 a[40:43], v2, s[28:31], s56 offen offset:512 sc1
    s_add_u32 s56, s44, 12288
    buffer_load_dwordx4 a[44:47], v2, s[28:31], s56 offen offset:512 sc1
    v_lshrrev_b32 v56, 2, v1
    v_and_b32 v57, 3, v1
    v_lshlrev_b32 v57, 3, v57
    s_and_b32 s36, s3, 1
    s_lshl_b32 s36, s36, 5
    v_lshl_add_u32 v61, v56, 6, v57
    v_add_u32 v61, s36, v61
    s_mov_b32 s36, 135168
    s_mov_b32 s37, 12288
    s_cmp_lt_u32 s3, 2
    s_cselect_b32 s36, 98304, s36
    s_cselect_b32 s37, 98304, s37
    v_add_u32 v94, s37, v61
    v_add_u32 v61, s36, v61
    v_mul_u32_u24 v95, 1152, v56
    s_lshl_b32 s36, s3, 7
    s_add_u32 s36, s36, 61440
    v_add3_u32 v95, v95, v57, s36
    s_waitcnt lgkmcnt(0)
    s_barrier
    ds_read_b64_tr_b16 a[96:97], v61 offset:0
    ds_read_b64_tr_b16 a[98:99], v61 offset:1024
    ds_read_b64_tr_b16 a[100:101], v61 offset:2048
    ds_read_b64_tr_b16 a[102:103], v61 offset:3072
    ds_read_b64_tr_b16 a[104:105], v61 offset:4096
    ds_read_b64_tr_b16 a[106:107], v61 offset:5120
    ds_read_b64_tr_b16 a[108:109], v61 offset:6144
    ds_read_b64_tr_b16 a[110:111], v61 offset:7168
    ds_read_b64_tr_b16 a[112:113], v61 offset:8192
    ds_read_b64_tr_b16 a[114:115], v61 offset:9216
    ds_read_b64_tr_b16 a[116:117], v61 offset:10240
    ds_read_b64_tr_b16 a[118:119], v61 offset:11264
    ds_read_b64_tr_b16 a[120:121], v61 offset:12288
    ds_read_b64_tr_b16 a[122:123], v61 offset:13312
    ds_read_b64_tr_b16 a[124:125], v61 offset:14336
    ds_read_b64_tr_b16 a[126:127], v61 offset:15360
    ds_read_b64_tr_b16 a[128:129], v61 offset:16384
    ds_read_b64_tr_b16 a[130:131], v61 offset:17408
    ds_read_b64_tr_b16 a[132:133], v61 offset:18432
    ds_read_b64_tr_b16 a[134:135], v61 offset:19456
    ds_read_b64_tr_b16 a[136:137], v61 offset:20480
    ds_read_b64_tr_b16 a[138:139], v61 offset:21504
    ds_read_b64_tr_b16 a[140:141], v61 offset:22528
    ds_read_b64_tr_b16 a[142:143], v61 offset:23552
    ds_read_b64_tr_b16 a[144:145], v61 offset:24576
    ds_read_b64_tr_b16 a[146:147], v61 offset:25600
    ds_read_b64_tr_b16 a[148:149], v61 offset:26624
    ds_read_b64_tr_b16 a[150:151], v61 offset:27648
    ds_read_b64_tr_b16 a[152:153], v94 offset:28672
    ds_read_b64_tr_b16 a[154:155], v94 offset:29696
    ds_read_b64_tr_b16 a[156:157], v94 offset:30720
    ds_read_b64_tr_b16 a[158:159], v94 offset:31744
    ds_read_b64_tr_b16 a[160:161], v94 offset:32768
    ds_read_b64_tr_b16 a[162:163], v94 offset:33792
    ds_read_b64_tr_b16 a[164:165], v94 offset:34816
    ds_read_b64_tr_b16 a[166:167], v94 offset:35840
    ds_read_b64_tr_b16 a[168:169], v95 offset:0
    ds_read_b64_tr_b16 a[170:171], v95 offset:18432
    ds_read_b64_tr_b16 a[172:173], v95 offset:32
    ds_read_b64_tr_b16 a[174:175], v95 offset:18464
    ds_read_b64_tr_b16 a[176:177], v95 offset:64
    ds_read_b64_tr_b16 a[178:179], v95 offset:18496
    ds_read_b64_tr_b16 a[180:181], v95 offset:96
    ds_read_b64_tr_b16 a[182:183], v95 offset:18528
    ds_read_b64_tr_b16 a[184:185], v95 offset:512
    ds_read_b64_tr_b16 a[186:187], v95 offset:18944
    ds_read_b64_tr_b16 a[188:189], v95 offset:544
    ds_read_b64_tr_b16 a[190:191], v95 offset:18976
    ds_read_b64_tr_b16 a[192:193], v95 offset:576
    ds_read_b64_tr_b16 a[194:195], v95 offset:19008
    ds_read_b64_tr_b16 a[196:197], v95 offset:608
    ds_read_b64_tr_b16 a[198:199], v95 offset:19040
    ds_read_b64_tr_b16 a[200:201], v95 offset:1024
    ds_read_b64_tr_b16 a[202:203], v95 offset:19456
    ds_read_b64_tr_b16 a[204:205], v95 offset:1056
    ds_read_b64_tr_b16 a[206:207], v95 offset:19488
    ds_read_b64_tr_b16 a[208:209], v95 offset:1088
    ds_read_b64_tr_b16 a[210:211], v95 offset:19520
    ds_read_b64_tr_b16 a[212:213], v95 offset:1120
    ds_read_b64_tr_b16 a[214:215], v95 offset:19552
    s_mov_b64 exec, 0
    s_cmp_eq_u32 s3, 0
    s_cbranch_scc1 Ltour1_0
    s_cmp_eq_u32 s3, 1
    s_cbranch_scc1 Ltour1_1
    s_cmp_eq_u32 s3, 2
    s_cbranch_scc1 Ltour1_2
    s_branch Ltour1_3
Lmain1:
    s_mov_b64 exec, -1
    v_pk_mul_f32 v[62:63], v[144:145], v[168:169]
    v_pk_mul_f32 v[168:169], v[168:169], v[120:121]
    v_pk_fma_f32 v[62:63], v[146:147], v[170:171], v[62:63]
    v_pk_mul_f32 v[170:171], v[170:171], v[122:123]
    v_pk_add_f32 v[88:89], v[168:169], v[170:171]
    v_pk_fma_f32 v[62:63], v[148:149], v[172:173], v[62:63]
    v_pk_mul_f32 v[172:173], v[172:173], v[124:125]
    v_pk_add_f32 v[88:89], v[88:89], v[172:173]
    v_pk_fma_f32 v[62:63], v[150:151], v[174:175], v[62:63]
    v_pk_mul_f32 v[174:175], v[174:175], v[126:127]
    v_pk_add_f32 v[88:89], v[88:89], v[174:175]
    v_pk_fma_f32 v[62:63], v[152:153], v[176:177], v[62:63]
    v_pk_mul_f32 v[176:177], v[176:177], v[128:129]
    v_pk_add_f32 v[88:89], v[88:89], v[176:177]
    v_pk_fma_f32 v[62:63], v[154:155], v[178:179], v[62:63]
    v_pk_mul_f32 v[178:179], v[178:179], v[130:131]
    v_pk_add_f32 v[88:89], v[88:89], v[178:179]
    v_pk_fma_f32 v[62:63], v[156:157], v[180:181], v[62:63]
    v_pk_mul_f32 v[180:181], v[180:181], v[132:133]
    v_pk_add_f32 v[88:89], v[88:89], v[180:181]
    v_pk_fma_f32 v[62:63], v[158:159], v[182:183], v[62:63]
    v_pk_mul_f32 v[182:183], v[182:183], v[134:135]
    v_pk_add_f32 v[88:89], v[88:89], v[182:183]
    v_pk_fma_f32 v[62:63], v[160:161], v[184:185], v[62:63]
    v_pk_mul_f32 v[184:185], v[184:185], v[136:137]
    v_pk_add_f32 v[88:89], v[88:89], v[184:185]
    v_pk_fma_f32 v[62:63], v[162:163], v[186:187], v[62:63]
    v_pk_mul_f32 v[186:187], v[186:187], v[138:139]
    v_pk_add_f32 v[88:89], v[88:89], v[186:187]
    v_pk_fma_f32 v[62:63], v[164:165], v[188:189], v[62:63]
    v_pk_mul_f32 v[188:189], v[188:189], v[140:141]
    v_pk_add_f32 v[88:89], v[88:89], v[188:189]
    v_pk_fma_f32 v[62:63], v[166:167], v[190:191], v[62:63]
    v_pk_mul_f32 v[190:191], v[190:191], v[142:143]
    v_pk_add_f32 v[88:89], v[88:89], v[190:191]
    v_add_f32 v91, v62, v63
    v_add_f32 v90, v88, v89
    s_nop 1
    v_add_f32_dpp v90, v90, v90 row_ror:8 row_mask:0xf bank_mask:0xf
    v_add_f32_dpp v91, v91, v91 row_ror:8 row_mask:0xf bank_mask:0xf
    s_nop 0
    v_add_f32_dpp v90, v90, v90 row_ror:4 row_mask:0xf bank_mask:0xf
    v_add_f32_dpp v91, v91, v91 row_ror:4 row_mask:0xf bank_mask:0xf
    s_nop 0
    v_add_f32_dpp v90, v90, v90 row_ror:2 row_mask:0xf bank_mask:0xf
    v_add_f32_dpp v91, v91, v91 row_ror:2 row_mask:0xf bank_mask:0xf
    s_nop 0
    v_add_f32_dpp v90, v90, v90 row_ror:1 row_mask:0xf bank_mask:0xf
    v_add_f32_dpp v91, v91, v91 row_ror:1 row_mask:0xf bank_mask:0xf
    v_mov_b32 v62, v90
    v_mov_b32 v63, v91
    s_nop 0
    v_permlane16_swap_b32 v90, v62
    v_permlane16_swap_b32 v91, v63
    v_add_f32 v90, v90, v62
    v_add_f32 v91, v91, v63
    v_lshlrev_b32 v92, 2, v7
    v_and_b32 v92, 28, v92
    v_sub_u32 v93, 2047, v7
    s_waitcnt vmcnt(12)
    v_mfma_f32_16x16x32_bf16 v[80:83], v[242:245], a[0:3], 0
    v_mfma_f32_16x16x32_bf16 v[84:87], v[240:243], a[0:3], 0
    s_waitcnt vmcnt(11)
    v_mfma_f32_16x16x32_bf16 v[80:83], v[242:245], a[4:7], v[80:83]
    v_mfma_f32_16x16x32_bf16 v[84:87], v[240:243], a[4:7], v[84:87]
    s_waitcnt vmcnt(10)
    v_mfma_f32_16x16x32_bf16 v[80:83], v[242:245], a[8:11], v[80:83]
    v_mfma_f32_16x16x32_bf16 v[84:87], v[240:243], a[8:11], v[84:87]
    s_waitcnt vmcnt(9)
    v_mfma_f32_16x16x32_bf16 v[80:83], v[242:245], a[12:15], v[80:83]
    v_mfma_f32_16x16x32_bf16 v[84:87], v[240:243], a[12:15], v[84:87]
    s_waitcnt vmcnt(8)
    s_nop 5
    v_mov_b32_dpp v80, v80 row_ror:8 row_mask:0x4 bank_mask:0xf
    v_mov_b32_dpp v81, v81 row_ror:8 row_mask:0x4 bank_mask:0xf
    v_mov_b32_dpp v82, v82 row_ror:8 row_mask:0x4 bank_mask:0xf
    v_mov_b32_dpp v83, v83 row_ror:8 row_mask:0x4 bank_mask:0xf
    v_mov_b32_dpp v84, v84 row_ror:8 row_mask:0x4 bank_mask:0xf
    v_mov_b32_dpp v85, v85 row_ror:8 row_mask:0x4 bank_mask:0xf
    v_mov_b32_dpp v86, v86 row_ror:8 row_mask:0x4 bank_mask:0xf
    v_mov_b32_dpp v87, v87 row_ror:8 row_mask:0x4 bank_mask:0xf
    v_pk_fma_f32 v[28:29], v[112:113], v[80:81], v[28:29]
    v_pk_fma_f32 v[30:31], v[114:115], v[82:83], v[30:31]
    v_pk_fma_f32 v[32:33], v[116:117], v[84:85], v[32:33]
    v_pk_fma_f32 v[34:35], v[118:119], v[86:87], v[34:35]
    v_cvt_pk_bf16_f32 v44, v28, v29
    v_cvt_pk_bf16_f32 v45, v30, v31
    v_cvt_pk_bf16_f32 v46, v32, v33
    v_cvt_pk_bf16_f32 v47, v34, v35
    v_lshlrev_b32 v28, 16, v44
    v_and_b32 v29, 0xffff0000, v44
    v_lshlrev_b32 v30, 16, v45
    v_and_b32 v31, 0xffff0000, v45
    v_lshlrev_b32 v32, 16, v46
    v_and_b32 v33, 0xffff0000, v46
    v_lshlrev_b32 v34, 16, v47
    v_and_b32 v35, 0xffff0000, v47
    v_mfma_f32_16x16x32_bf16 v[64:67], v[246:249], a[16:19], 0
    v_mfma_f32_16x16x32_bf16 v[68:71], v[244:247], a[16:19], 0
    s_waitcnt vmcnt(7)
    v_mfma_f32_16x16x32_bf16 v[64:67], v[246:249], a[20:23], v[64:67]
    v_mfma_f32_16x16x32_bf16 v[68:71], v[244:247], a[20:23], v[68:71]
    s_waitcnt vmcnt(6)
    v_mfma_f32_16x16x32_bf16 v[64:67], v[246:249], a[24:27], v[64:67]
    v_mfma_f32_16x16x32_bf16 v[68:71], v[244:247], a[24:27], v[68:71]
    s_waitcnt vmcnt(5)
    v_mfma_f32_16x16x32_bf16 v[64:67], v[246:249], a[28:31], v[64:67]
    v_mfma_f32_16x16x32_bf16 v[68:71], v[244:247], a[28:31], v[68:71]
    s_waitcnt vmcnt(4)
    v_cmp_ne_u32 s[54:55], s95, v11
    s_cmp_lg_u64 s[54:55], 0
    s_cbranch_scc1 Ltail_spin2
Ltail_got2:
    s_add_u32 s56, s44, 0
    buffer_load_dwordx4 a[48:51], v2, s[28:31], s56 offen offset:1024 sc1
    s_add_u32 s56, s44, 4096
    buffer_load_dwordx4 a[52:55], v2, s[28:31], s56 offen offset:1024 sc1
    s_add_u32 s56, s44, 8192
    buffer_load_dwordx4 a[56:59], v2, s[28:31], s56 offen offset:1024 sc1
    s_add_u32 s56, s44, 12288
    buffer_load_dwordx4 a[60:63], v2, s[28:31], s56 offen offset:1024 sc1
    s_add_u32 s56, s44, 0
    buffer_load_dwordx4 a[64:67], v2, s[28:31], s56 offen offset:1536 sc1
    s_add_u32 s56, s44, 4096
    buffer_load_dwordx4 a[68:71], v2, s[28:31], s56 offen offset:1536 sc1
    s_add_u32 s56, s44, 8192
    buffer_load_dwordx4 a[72:75], v2, s[28:31], s56 offen offset:1536 sc1
    s_add_u32 s56, s44, 12288
    buffer_load_dwordx4 a[76:79], v2, s[28:31], s56 offen offset:1536 sc1
    s_movk_i32 s48, 0x7ff
    s_waitcnt vmcnt(11)
    v_mfma_f32_16x16x32_bf16 v[64:67], v[250:253], a[32:35], v[64:67]
    v_mfma_f32_16x16x32_bf16 v[68:71], v[248:251], a[32:35], v[68:71]
    s_waitcnt vmcnt(10)
    v_mfma_f32_16x16x32_bf16 v[64:67], v[250:253], a[36:39], v[64:67]
    v_mfma_f32_16x16x32_bf16 v[68:71], v[248:251], a[36:39], v[68:71]
    s_waitcnt vmcnt(9)
    v_mfma_f32_16x16x32_bf16 v[64:67], v[250:253], a[40:43], v[64:67]
    v_mfma_f32_16x16x32_bf16 v[68:71], v[248:251], a[40:43], v[68:71]
    s_waitcnt vmcnt(8)
    v_mfma_f32_16x16x32_bf16 v[64:67], v[250:253], a[44:47], v[64:67]
    v_mfma_f32_16x16x32_bf16 v[68:71], v[248:251], a[44:47], v[68:71]
    s_waitcnt vmcnt(7)
    s_nop 5
    v_pk_fma_f32 v[12:13], v[96:97], v[64:65], v[12:13]
    v_pk_fma_f32 v[14:15], v[98:99], v[66:67], v[14:15]
    v_pk_fma_f32 v[16:17], v[100:101], v[68:69], v[16:17]
    v_pk_fma_f32 v[18:19], v[102:103], v[70:71], v[18:19]
    v_cvt_pk_bf16_f32 v36, v12, v13
    v_cvt_pk_bf16_f32 v37, v14, v15
    v_cvt_pk_bf16_f32 v38, v16, v17
    v_cvt_pk_bf16_f32 v39, v18, v19
    v_lshlrev_b32 v12, 16, v36
    v_and_b32 v13, 0xffff0000, v36
    v_lshlrev_b32 v14, 16, v37
    v_and_b32 v15, 0xffff0000, v37
    v_lshlrev_b32 v16, 16, v38
    v_and_b32 v17, 0xffff0000, v38
    v_lshlrev_b32 v18, 16, v39
    v_and_b32 v19, 0xffff0000, v39
Ltour1_0:
    s_cbranch_execz Ltour1_4
    v_pk_add_f32 v[88:89], v[12:13], v[14:15]
    v_pk_add_f32 v[62:63], v[16:17], v[18:19]
    v_pk_add_f32 v[88:89], v[88:89], v[62:63]
    v_add_f32 v88, v88, v89
    s_nop 1
    v_add_f32_dpp v88, v88, v88 row_ror:8 row_mask:0xf bank_mask:0xf
    s_nop 1
    v_add_f32_dpp v88, v88, v88 row_ror:4 row_mask:0xf bank_mask:0xf
    s_nop 1
    v_add_f32_dpp v88, v88, v88 row_ror:2 row_mask:0xf bank_mask:0xf
    s_nop 1
    v_add_f32_dpp v88, v88, v88 row_ror:1 row_mask:0xf bank_mask:0xf
    v_mov_b32 v62, v88
    s_nop 1
    v_permlane16_swap_b32 v88, v62
    s_nop 0
    v_add_f32 v88, v88, v62
    v_mul_f32 v88, 0x3b800000, v88
    v_pk_add_f32 v[232:233], v[28:29], v[88:89] op_sel_hi:[1,0] neg_lo:[0,1] neg_hi:[0,1]
    v_pk_add_f32 v[234:235], v[30:31], v[88:89] op_sel_hi:[1,0] neg_lo:[0,1] neg_hi:[0,1]
    v_pk_add_f32 v[236:237], v[32:33], v[88:89] op_sel_hi:[1,0] neg_lo:[0,1] neg_hi:[0,1]
    v_pk_add_f32 v[238:239], v[34:35], v[88:89] op_sel_hi:[1,0] neg_lo:[0,1] neg_hi:[0,1]
    v_pk_add_f32 v[48:49], v[232:233], v[234:235]
    v_pk_mul_f32 v[50:51], v[232:233], v[232:233]
    v_pk_mul_f32 v[52:53], v[232:233], v[184:185]
    v_pk_fma_f32 v[50:51], v[234:235], v[234:235], v[50:51]
    v_pk_fma_f32 v[52:53], v[234:235], v[186:187], v[52:53]
    v_pk_add_f32 v[48:49], v[48:49], v[236:237]
    v_pk_fma_f32 v[50:51], v[236:237], v[236:237], v[50:51]
    v_pk_fma_f32 v[52:53], v[236:237], v[188:189], v[52:53]
    v_pk_add_f32 v[48:49], v[48:49], v[238:239]
    v_pk_fma_f32 v[50:51], v[238:239], v[238:239], v[50:51]
    v_pk_fma_f32 v[52:53], v[238:239], v[190:191], v[52:53]
    v_cndmask_b32 v48, 0, v48, vcc
    v_cndmask_b32 v49, 0, v49, vcc
    v_cndmask_b32 v50, 0, v50, vcc
    v_cndmask_b32 v51, 0, v51, vcc
    v_pk_add_f32 v[216:217], v[12:13], v[88:89] op_sel_hi:[1,0] neg_lo:[0,1] neg_hi:[0,1]
    v_pk_add_f32 v[218:219], v[14:15], v[88:89] op_sel_hi:[1,0] neg_lo:[0,1] neg_hi:[0,1]
    v_pk_add_f32 v[220:221], v[16:17], v[88:89] op_sel_hi:[1,0] neg_lo:[0,1] neg_hi:[0,1]
    v_pk_add_f32 v[222:223], v[18:19], v[88:89] op_sel_hi:[1,0] neg_lo:[0,1] neg_hi:[0,1]
    v_pk_add_f32 v[48:49], v[48:49], v[216:217]
    v_pk_fma_f32 v[50:51], v[216:217], v[216:217], v[50:51]
    v_pk_fma_f32 v[52:53], v[216:217], v[168:169], v[52:53]
    v_pk_add_f32 v[48:49], v[48:49], v[218:219]
    v_pk_fma_f32 v[50:51], v[218:219], v[218:219], v[50:51]
    v_pk_fma_f32 v[52:53], v[218:219], v[170:171], v[52:53]
    v_pk_add_f32 v[48:49], v[48:49], v[220:221]
    v_pk_fma_f32 v[50:51], v[220:221], v[220:221], v[50:51]
    v_pk_fma_f32 v[52:53], v[220:221], v[172:173], v[52:53]
    v_pk_add_f32 v[48:49], v[48:49], v[222:223]
    v_pk_fma_f32 v[50:51], v[222:223], v[222:223], v[50:51]
    v_pk_fma_f32 v[52:53], v[222:223], v[174:175], v[52:53]
    v_mfma_f32_16x16x32_bf16 v[72:75], v[246:249], a[48:51], 0
    v_mfma_f32_16x16x32_bf16 v[76:79], v[244:247], a[48:51], 0
    s_waitcnt vmcnt(6)
    v_mfma_f32_16x16x32_bf16 v[72:75], v[246:249], a[52:55], v[72:75]
    v_mfma_f32_16x16x32_bf16 v[76:79], v[244:247], a[52:55], v[76:79]
    s_waitcnt vmcnt(5)
    v_mfma_f32_16x16x32_bf16 v[72:75], v[246:249], a[56:59], v[72:75]
    v_mfma_f32_16x16x32_bf16 v[76:79], v[244:247], a[56:59], v[76:79]
    s_waitcnt vmcnt(4)
    v_mfma_f32_16x16x32_bf16 v[72:75], v[246:249], a[60:63], v[72:75]
    v_mfma_f32_16x16x32_bf16 v[76:79], v[244:247], a[60:63], v[76:79]
    s_waitcnt vmcnt(3)
    v_mfma_f32_16x16x32_bf16 v[72:75], v[250:253], a[64:67], v[72:75]
    v_mfma_f32_16x16x32_bf16 v[76:79], v[248:251], a[64:67], v[76:79]
    s_waitcnt vmcnt(2)
    v_mfma_f32_16x16x32_bf16 v[72:75], v[250:253], a[68:71], v[72:75]
    v_mfma_f32_16x16x32_bf16 v[76:79], v[248:251], a[68:71], v[76:79]
    s_waitcnt vmcnt(1)
    v_mfma_f32_16x16x32_bf16 v[72:75], v[250:253], a[72:75], v[72:75]
    v_mfma_f32_16x16x32_bf16 v[76:79], v[248:251], a[72:75], v[76:79]
    s_waitcnt vmcnt(0)
    v_mfma_f32_16x16x32_bf16 v[72:75], v[250:253], a[76:79], v[72:75]
    v_mfma_f32_16x16x32_bf16 v[76:79], v[248:251], a[76:79], v[76:79]
    s_nop 6
    v_pk_fma_f32 v[20:21], v[104:105], v[72:73], v[20:21]
    v_pk_fma_f32 v[22:23], v[106:107], v[74:75], v[22:23]
    v_pk_fma_f32 v[24:25], v[108:109], v[76:77], v[24:25]
    v_pk_fma_f32 v[26:27], v[110:111], v[78:79], v[26:27]
    v_cvt_pk_bf16_f32 v40, v20, v21
    v_cvt_pk_bf16_f32 v41, v22, v23
    v_cvt_pk_bf16_f32 v42, v24, v25
    v_cvt_pk_bf16_f32 v43, v26, v27
    v_lshlrev_b32 v20, 16, v40
    v_and_b32 v21, 0xffff0000, v40
    v_lshlrev_b32 v22, 16, v41
    v_and_b32 v23, 0xffff0000, v41
    v_lshlrev_b32 v24, 16, v42
    v_and_b32 v25, 0xffff0000, v42
    v_lshlrev_b32 v26, 16, v43
    v_and_b32 v27, 0xffff0000, v43
    v_pk_add_f32 v[224:225], v[20:21], v[88:89] op_sel_hi:[1,0] neg_lo:[0,1] neg_hi:[0,1]
    v_pk_add_f32 v[226:227], v[22:23], v[88:89] op_sel_hi:[1,0] neg_lo:[0,1] neg_hi:[0,1]
    v_pk_add_f32 v[228:229], v[24:25], v[88:89] op_sel_hi:[1,0] neg_lo:[0,1] neg_hi:[0,1]
    v_pk_add_f32 v[230:231], v[26:27], v[88:89] op_sel_hi:[1,0] neg_lo:[0,1] neg_hi:[0,1]
    v_pk_add_f32 v[48:49], v[48:49], v[224:225]
    v_pk_fma_f32 v[50:51], v[224:225], v[224:225], v[50:51]
    v_pk_fma_f32 v[52:53], v[224:225], v[176:177], v[52:53]
    v_pk_add_f32 v[48:49], v[48:49], v[226:227]
    v_pk_fma_f32 v[50:51], v[226:227], v[226:227], v[50:51]
    v_pk_fma_f32 v[52:53], v[226:227], v[178:179], v[52:53]
    v_pk_add_f32 v[48:49], v[48:49], v[228:229]
    v_pk_fma_f32 v[50:51], v[228:229], v[228:229], v[50:51]
    v_pk_fma_f32 v[52:53], v[228:229], v[180:181], v[52:53]
    v_pk_add_f32 v[48:49], v[48:49], v[230:231]
    v_pk_fma_f32 v[50:51], v[230:231], v[230:231], v[50:51]
    v_pk_fma_f32 v[52:53], v[230:231], v[182:183], v[52:53]
    v_add_f32 v48, v48, v49
    v_add_f32 v50, v50, v51
    v_add_f32 v52, v52, v53
    v_add_f32_dpp v48, v48, v48 row_ror:8 row_mask:0xf bank_mask:0xf
    v_add_f32_dpp v50, v50, v50 row_ror:8 row_mask:0xf bank_mask:0xf
    v_add_f32_dpp v52, v52, v52 row_ror:8 row_mask:0xf bank_mask:0xf
    v_add_f32_dpp v48, v48, v48 row_ror:4 row_mask:0xf bank_mask:0xf
    v_add_f32_dpp v50, v50, v50 row_ror:4 row_mask:0xf bank_mask:0xf
    v_add_f32_dpp v52, v52, v52 row_ror:4 row_mask:0xf bank_mask:0xf
    v_add_f32_dpp v48, v48, v48 row_ror:2 row_mask:0xf bank_mask:0xf
    v_add_f32_dpp v50, v50, v50 row_ror:2 row_mask:0xf bank_mask:0xf
    v_add_f32_dpp v52, v52, v52 row_ror:2 row_mask:0xf bank_mask:0xf
    v_add_f32_dpp v48, v48, v48 row_ror:1 row_mask:0xf bank_mask:0xf
    v_add_f32_dpp v50, v50, v50 row_ror:1 row_mask:0xf bank_mask:0xf
    v_add_f32_dpp v52, v52, v52 row_ror:1 row_mask:0xf bank_mask:0xf
    v_mov_b32 v49, v48
    v_mov_b32 v51, v50
    v_mov_b32 v53, v52
    v_permlane16_swap_b32 v48, v49
    v_permlane16_swap_b32 v50, v51
    v_permlane16_swap_b32 v52, v53
    v_add_f32 v48, v48, v49
    v_add_f32 v50, v50, v51
    v_add_f32 v52, v52, v53
    v_mul_f32 v48, 0x3ae38e39, v48
    v_mul_f32 v50, 0x3ae38e39, v50
    v_fma_f32 v50, -v48, v48, v50
    v_add_f32 v48, v48, v88
    v_max_f32 v50, 0, v50
    v_cvt_pk_bf16_f32 v48, v48, v50
    v_and_b32 v50, 0xffff0000, v48
    v_lshlrev_b32 v48, 16, v48
    v_add_f32 v50, 0x3727c5ac, v50
    v_sub_f32 v48, v88, v48
    v_cvt_pk_bf16_f32 v50, v50, v50
    v_and_b32 v50, 0xffff0000, v50
    v_sqrt_f32 v50, v50
    v_fmac_f32 v52, v48, v90
    v_cvt_pk_bf16_f32 v50, v50, v50
    v_and_b32 v50, 0xffff0000, v50
    v_rcp_f32 v50, v50
    s_mov_b32 exec_lo, 1
    s_mov_b32 exec_hi, 1
    v_fma_f32 v52, v52, v50, v91
    v_ashrrev_i32 v62, 31, v52
    v_or_b32 v62, 0x80000000, v62
    v_xor_b32 v52, v62, v52
    v_min_u32 v52, 0xfffff000, v52
    v_bfi_b32 v52, s48, v93, v52
    ds_write_b32 v92, v52 offset:36864
    s_mov_b64 exec, -1
    v_mul_f32 v48, v48, v50
    s_waitcnt lgkmcnt(0)
    s_barrier
    v_mov_b32 v109, 36864
    ds_read_b128 v[96:99], v109
    ds_read_b128 v[100:103], v109 offset:16
    s_lshl_b32 s45, s2, 7
    s_add_u32 s45, s45, 9306112
    s_cmp_eq_u32 s3, 0
    s_cselect_b32 s45, s45, 2147483648
    s_waitcnt lgkmcnt(1)
    v_max_u32 v104, v96, v97
    v_min_u32 v105, v96, v97
    v_med3_u32 v105, v104, v105, v98
    v_max_u32 v104, v104, v98
    v_med3_u32 v105, v104, v105, v99
    v_max_u32 v104, v104, v99
    s_waitcnt lgkmcnt(0)
    v_med3_u32 v105, v104, v105, v100
    v_max_u32 v104, v104, v100
    v_med3_u32 v105, v104, v105, v101
    v_max_u32 v104, v104, v101
    v_med3_u32 v105, v104, v105, v102
    v_max_u32 v104, v104, v102
    v_med3_u32 v105, v104, v105, v103
    v_max_u32 v104, v104, v103
    buffer_store_dwordx2 v[104:105], v8, s[24:27], s45 offen sc1
    v_pk_fma_f32 v[216:217], v[216:217], v[50:51], v[48:49] op_sel_hi:[1,0,0]
    v_pk_fma_f32 v[218:219], v[218:219], v[50:51], v[48:49] op_sel_hi:[1,0,0]
    v_pk_fma_f32 v[220:221], v[220:221], v[50:51], v[48:49] op_sel_hi:[1,0,0]
    v_pk_fma_f32 v[222:223], v[222:223], v[50:51], v[48:49] op_sel_hi:[1,0,0]
    v_pk_fma_f32 v[224:225], v[224:225], v[50:51], v[48:49] op_sel_hi:[1,0,0]
    v_pk_fma_f32 v[226:227], v[226:227], v[50:51], v[48:49] op_sel_hi:[1,0,0]
    v_pk_fma_f32 v[228:229], v[228:229], v[50:51], v[48:49] op_sel_hi:[1,0,0]
    v_pk_fma_f32 v[230:231], v[230:231], v[50:51], v[48:49] op_sel_hi:[1,0,0]
    v_pk_fma_f32 v[232:233], v[232:233], v[50:51], v[48:49] op_sel_hi:[1,0,0]
    v_pk_fma_f32 v[234:235], v[234:235], v[50:51], v[48:49] op_sel_hi:[1,0,0]
    v_pk_fma_f32 v[236:237], v[236:237], v[50:51], v[48:49] op_sel_hi:[1,0,0]
    v_pk_fma_f32 v[238:239], v[238:239], v[50:51], v[48:49] op_sel_hi:[1,0,0]
    v_pk_fma_f32 v[216:217], v[216:217], v[120:121], v[144:145]
    v_pk_fma_f32 v[218:219], v[218:219], v[122:123], v[146:147]
    v_pk_fma_f32 v[220:221], v[220:221], v[124:125], v[148:149]
    v_pk_fma_f32 v[222:223], v[222:223], v[126:127], v[150:151]
    v_pk_fma_f32 v[224:225], v[224:225], v[128:129], v[152:153]
    v_pk_fma_f32 v[226:227], v[226:227], v[130:131], v[154:155]
    v_pk_fma_f32 v[228:229], v[228:229], v[132:133], v[156:157]
    v_pk_fma_f32 v[230:231], v[230:231], v[134:135], v[158:159]
    v_pk_fma_f32 v[232:233], v[232:233], v[136:137], v[160:161]
    v_pk_fma_f32 v[234:235], v[234:235], v[138:139], v[162:163]
    v_pk_fma_f32 v[236:237], v[236:237], v[140:141], v[164:165]
    v_pk_fma_f32 v[238:239], v[238:239], v[142:143], v[166:167]
    v_cvt_pk_bf16_f32 v64, v216, v217
    v_cvt_pk_bf16_f32 v65, v218, v219
    v_cvt_pk_bf16_f32 v66, v220, v221
    v_cvt_pk_bf16_f32 v67, v222, v223
    v_cvt_pk_bf16_f32 v68, v224, v225
    v_cvt_pk_bf16_f32 v69, v226, v227
    v_cvt_pk_bf16_f32 v70, v228, v229
    v_cvt_pk_bf16_f32 v71, v230, v231
    v_cvt_pk_bf16_f32 v72, v232, v233
    v_cvt_pk_bf16_f32 v73, v234, v235
    v_cvt_pk_bf16_f32 v74, v236, v237
    v_cvt_pk_bf16_f32 v75, v238, v239
    v_and_b32 v106, 0x7ff, v104
    v_and_b32 v107, 0x7ff, v105
    v_cmp_eq_u32 vcc, v106, v93
    v_cmp_eq_u32 s[36:37], v107, v93
    v_mov_b32 v106, 2147483648
    s_or_b64 vcc, vcc, s[36:37]
    s_mov_b32 s45, 2621440
    s_nop 0
    v_cndmask_b32 v6, v106, v6, vcc
    v_cndmask_b32 v60, v106, v60, vcc
    buffer_store_dwordx4 v[64:67], v6, s[24:27], s45 offen offset:0 sc1
    buffer_store_dwordx4 v[68:71], v6, s[24:27], s45 offen offset:512 sc1
    buffer_store_dwordx4 v[72:75], v60, s[24:27], s45 offen offset:1024 sc1
    s_cmp_ge_u32 s41, 18
    s_cbranch_scc1 Ltail_idle
    s_mov_b32 s36, 2622592
    buffer_store_dwordx4 v[36:39], v6, s[24:27], s36 offen offset:0 sc1
    buffer_store_dwordx4 v[40:43], v6, s[24:27], s36 offen offset:512 sc1
    buffer_store_dwordx4 v[44:47], v60, s[24:27], s36 offen offset:1024 sc1
    v_lshlrev_b32 v216, 16, v64
    v_and_b32 v217, 0xffff0000, v64
    v_lshlrev_b32 v218, 16, v65
    v_and_b32 v219, 0xffff0000, v65
    v_lshlrev_b32 v220, 16, v66
    v_and_b32 v221, 0xffff0000, v66
    v_lshlrev_b32 v222, 16, v67
    v_and_b32 v223, 0xffff0000, v67
    v_lshlrev_b32 v224, 16, v68
    v_and_b32 v225, 0xffff0000, v68
    v_lshlrev_b32 v226, 16, v69
    v_and_b32 v227, 0xffff0000, v69
    v_lshlrev_b32 v228, 16, v70
    v_and_b32 v229, 0xffff0000, v70
    v_lshlrev_b32 v230, 16, v71
    v_and_b32 v231, 0xffff0000, v71
    v_lshlrev_b32 v232, 16, v72
    v_and_b32 v233, 0xffff0000, v72
    v_lshlrev_b32 v234, 16, v73
    v_and_b32 v235, 0xffff0000, v73
    v_lshlrev_b32 v236, 16, v74
    v_and_b32 v237, 0xffff0000, v74
    v_lshlrev_b32 v238, 16, v75
    v_and_b32 v239, 0xffff0000, v75
    v_pk_mul_f32 v[192:193], v[192:193], v[216:217]
    v_pk_mul_f32 v[194:195], v[194:195], v[218:219]
    v_pk_mul_f32 v[196:197], v[196:197], v[220:221]
    v_pk_mul_f32 v[198:199], v[198:199], v[222:223]
    v_pk_mul_f32 v[200:201], v[200:201], v[224:225]
    v_pk_mul_f32 v[202:203], v[202:203], v[226:227]
    v_pk_mul_f32 v[204:205], v[204:205], v[228:229]
    v_pk_mul_f32 v[206:207], v[206:207], v[230:231]
    v_pk_mul_f32 v[208:209], v[208:209], v[232:233]
    v_pk_mul_f32 v[210:211], v[210:211], v[234:235]
    v_pk_mul_f32 v[212:213], v[212:213], v[236:237]
    v_pk_mul_f32 v[214:215], v[214:215], v[238:239]
    v_cvt_pk_bf16_f32 v144, v192, v193
    v_cvt_pk_bf16_f32 v145, v194, v195
    v_cvt_pk_bf16_f32 v146, v196, v197
    v_cvt_pk_bf16_f32 v147, v198, v199
    v_cvt_pk_bf16_f32 v148, v200, v201
    v_cvt_pk_bf16_f32 v149, v202, v203
    v_cvt_pk_bf16_f32 v150, v204, v205
    v_cvt_pk_bf16_f32 v151, v206, v207
    v_cvt_pk_bf16_f32 v152, v208, v209
    v_cvt_pk_bf16_f32 v153, v210, v211
    v_cvt_pk_bf16_f32 v154, v212, v213
    v_cvt_pk_bf16_f32 v155, v214, v215
    v_lshlrev_b32 v192, 16, v144
    v_and_b32 v193, 0xffff0000, v144
    v_lshlrev_b32 v194, 16, v145
    v_and_b32 v195, 0xffff0000, v145
    v_lshlrev_b32 v196, 16, v146
    v_and_b32 v197, 0xffff0000, v146
    v_lshlrev_b32 v198, 16, v147
    v_and_b32 v199, 0xffff0000, v147
    v_lshlrev_b32 v200, 16, v148
    v_and_b32 v201, 0xffff0000, v148
    v_lshlrev_b32 v202, 16, v149
    v_and_b32 v203, 0xffff0000, v149
    v_lshlrev_b32 v204, 16, v150
    v_and_b32 v205, 0xffff0000, v150
    v_lshlrev_b32 v206, 16, v151
    v_and_b32 v207, 0xffff0000, v151
    v_lshlrev_b32 v208, 16, v152
    v_and_b32 v209, 0xffff0000, v152
    v_lshlrev_b32 v210, 16, v153
    v_and_b32 v211, 0xffff0000, v153
    v_lshlrev_b32 v212, 16, v154
    v_and_b32 v213, 0xffff0000, v154
    v_lshlrev_b32 v214, 16, v155
    v_and_b32 v215, 0xffff0000, v155
    v_pk_add_f32 v[192:193], v[192:193], v[12:13]
    v_pk_add_f32 v[194:195], v[194:195], v[14:15]
    v_pk_add_f32 v[196:197], v[196:197], v[16:17]
    v_pk_add_f32 v[198:199], v[198:199], v[18:19]
    v_pk_add_f32 v[200:201], v[200:201], v[20:21]
    v_pk_add_f32 v[202:203], v[202:203], v[22:23]
    v_pk_add_f32 v[204:205], v[204:205], v[24:25]
    v_pk_add_f32 v[206:207], v[206:207], v[26:27]
    v_pk_add_f32 v[208:209], v[208:209], v[28:29]
    v_pk_add_f32 v[210:211], v[210:211], v[30:31]
    v_pk_add_f32 v[212:213], v[212:213], v[32:33]
    v_pk_add_f32 v[214:215], v[214:215], v[34:35]
    v_cvt_pk_bf16_f32 v156, v192, v193
    v_cvt_pk_bf16_f32 v157, v194, v195
    v_cvt_pk_bf16_f32 v158, v196, v197
    v_cvt_pk_bf16_f32 v159, v198, v199
    v_cvt_pk_bf16_f32 v160, v200, v201
    v_cvt_pk_bf16_f32 v161, v202, v203
    v_cvt_pk_bf16_f32 v162, v204, v205
    v_cvt_pk_bf16_f32 v163, v206, v207
    v_cvt_pk_bf16_f32 v164, v208, v209
    v_cvt_pk_bf16_f32 v165, v210, v211
    v_cvt_pk_bf16_f32 v166, v212, v213
    v_cvt_pk_bf16_f32 v167, v214, v215
    v_and_b32 v30, 2, v1
    v_cmp_ne_u32 vcc, 0, v30
    v_mul_u32_u24 v30, 1152, v7
    v_add_u32 v4, v30, v5
    v_add_u32 v58, v30, v59
    v_mov_b32_dpp v192, v158 quad_perm:[0,2,0,2] row_mask:0xf bank_mask:0xf
    v_mov_b32_dpp v193, v159 quad_perm:[0,2,0,2] row_mask:0xf bank_mask:0xf
    v_mov_b32_dpp v194, v158 quad_perm:[1,3,1,3] row_mask:0xf bank_mask:0xf
    v_mov_b32_dpp v195, v159 quad_perm:[1,3,1,3] row_mask:0xf bank_mask:0xf
    v_mov_b32_dpp v196, v162 quad_perm:[0,2,0,2] row_mask:0xf bank_mask:0xf
    v_mov_b32_dpp v197, v163 quad_perm:[0,2,0,2] row_mask:0xf bank_mask:0xf
    v_mov_b32_dpp v198, v162 quad_perm:[1,3,1,3] row_mask:0xf bank_mask:0xf
    v_mov_b32_dpp v199, v163 quad_perm:[1,3,1,3] row_mask:0xf bank_mask:0xf
    v_mov_b32_dpp v200, v166 quad_perm:[0,2,0,2] row_mask:0xf bank_mask:0xf
    v_mov_b32_dpp v201, v167 quad_perm:[0,2,0,2] row_mask:0xf bank_mask:0xf
    v_mov_b32_dpp v202, v166 quad_perm:[1,3,1,3] row_mask:0xf bank_mask:0xf
    v_mov_b32_dpp v203, v167 quad_perm:[1,3,1,3] row_mask:0xf bank_mask:0xf
    v_cndmask_b32_dpp v144, v156, v192, vcc quad_perm:[0,2,0,2] row_mask:0xf bank_mask:0xf
    v_cndmask_b32_dpp v145, v157, v193, vcc quad_perm:[0,2,0,2] row_mask:0xf bank_mask:0xf
    v_cndmask_b32_dpp v146, v156, v194, vcc quad_perm:[1,3,1,3] row_mask:0xf bank_mask:0xf
    v_cndmask_b32_dpp v147, v157, v195, vcc quad_perm:[1,3,1,3] row_mask:0xf bank_mask:0xf
    v_cndmask_b32_dpp v148, v160, v196, vcc quad_perm:[0,2,0,2] row_mask:0xf bank_mask:0xf
    v_cndmask_b32_dpp v149, v161, v197, vcc quad_perm:[0,2,0,2] row_mask:0xf bank_mask:0xf
    v_cndmask_b32_dpp v150, v160, v198, vcc quad_perm:[1,3,1,3] row_mask:0xf bank_mask:0xf
    v_cndmask_b32_dpp v151, v161, v199, vcc quad_perm:[1,3,1,3] row_mask:0xf bank_mask:0xf
    v_cndmask_b32_dpp v152, v164, v200, vcc quad_perm:[0,2,0,2] row_mask:0xf bank_mask:0xf
    v_cndmask_b32_dpp v153, v165, v201, vcc quad_perm:[0,2,0,2] row_mask:0xf bank_mask:0xf
    v_cndmask_b32_dpp v154, v164, v202, vcc quad_perm:[1,3,1,3] row_mask:0xf bank_mask:0xf
    v_cndmask_b32_dpp v155, v165, v203, vcc quad_perm:[1,3,1,3] row_mask:0xf bank_mask:0xf
    v_lshlrev_b32 v13, 4, v1
    v_add_u32 v13, 32768, v13
    s_lshl_b32 s44, s3, 10
    v_add_u32 v14, s44, v13
    v_and_b32 v13, 0xffffff1f, v13
    v_bfe_u32 v15, v1, 2, 2
    v_cmp_eq_u32 s[52:53], 0, v15
    v_cmp_eq_u32 s[54:55], 1, v15
    v_cmp_eq_u32 s[56:57], 2, v15
    v_cmp_eq_u32 s[58:59], 3, v15
    s_mul_i32 s43, s42, 18
    s_add_u32 s43, s43, s41
    s_lshl_b32 s43, s43, 9
    s_mul_i32 s44, s3, 73728
    s_add_u32 s43, s43, s44
    v_lshlrev_b32 v15, 3, v1
    s_cmp_lt_u32 s3, 2
    s_cselect_b32 s36, 0xbfb8aa3b, 0
    s_cselect_b32 s37, 1.0, 0
    v_mov_b32 v40, s36
    v_mov_b32 v41, s37
    v_and_b32 v10, 1, v1
    v_and_b32 v9, 48, v1
    s_mul_i32 s38, s3, 3072
    s_add_u32 s38, s38, 49152
    v_lshl_add_u32 v11, v10, 9, v9
    v_add_u32 v11, s38, v11
    v_lshrrev_b32 v10, 5, v1
    v_and_b32 v9, 31, v1
    v_lshlrev_b32 v9, 4, v9
    v_lshlrev_b32 v108, 7, v0
    s_mov_b32 s45, 9306112
    s_lshl_b32 s36, s3, 3
    v_mov_b32 v109, s36
    s_mov_b32 s48, 262144
Ltail_pollk:
    buffer_load_dwordx2 v[104:105], v108, s[24:27], s45 offen sc1
    s_sub_u32 s48, s48, 1
    s_cbranch_scc1 Ltail_gotk
    s_waitcnt vmcnt(0)
    v_max_u32 v106, v104, v105
    v_cmp_eq_u32 vcc, -1, v106
    s_cbranch_vccnz Ltail_pollk
Ltail_gotk:
    s_waitcnt vmcnt(0)
    v_mov_b32_dpp v106, v104 row_ror:1 row_mask:0xf bank_mask:0xf
    v_mov_b32_dpp v107, v105 row_ror:1 row_mask:0xf bank_mask:0xf
    v_min_u32 v110, v104, v106
    v_max_u32 v104, v104, v106
    v_max3_u32 v105, v110, v105, v107
    s_nop 0
    v_mov_b32_dpp v106, v104 row_ror:2 row_mask:0xf bank_mask:0xf
    v_mov_b32_dpp v107, v105 row_ror:2 row_mask:0xf bank_mask:0xf
    v_min_u32 v110, v104, v106
    v_max_u32 v104, v104, v106
    v_max3_u32 v105, v110, v105, v107
    s_nop 0
    v_mov_b32_dpp v106, v104 row_ror:4 row_mask:0xf bank_mask:0xf
    v_mov_b32_dpp v107, v105 row_ror:4 row_mask:0xf bank_mask:0xf
    v_min_u32 v110, v104, v106
    v_max_u32 v104, v104, v106
    v_max3_u32 v105, v110, v105, v107
    s_nop 0
    v_mov_b32_dpp v106, v104 row_ror:8 row_mask:0xf bank_mask:0xf
    v_mov_b32_dpp v107, v105 row_ror:8 row_mask:0xf bank_mask:0xf
    v_min_u32 v110, v104, v106
    v_max_u32 v104, v104, v106
    v_max3_u32 v105, v110, v105, v107
    v_mov_b32 v106, v104
    v_mov_b32 v107, v105
    s_nop 0
    v_permlane16_swap_b32 v104, v106
    v_permlane16_swap_b32 v105, v107
    v_min_u32 v110, v104, v106
    v_max_u32 v104, v104, v106
    v_max3_u32 v105, v110, v105, v107
    v_mov_b32 v106, v104
    v_mov_b32 v107, v105
    s_nop 0
    v_permlane32_swap_b32 v104, v106
    v_permlane32_swap_b32 v105, v107
    v_min_u32 v110, v104, v106
    v_max_u32 v104, v104, v106
    v_max3_u32 v105, v110, v105, v107
    ds_write_b64 v109, v[104:105] offset:36928
    v_mov_b32 v109, 36928
    s_waitcnt lgkmcnt(0)
    s_barrier
    ds_read_b128 v[96:99], v109
    ds_read_b128 v[100:103], v109 offset:16
    s_waitcnt lgkmcnt(1)
    v_max_u32 v104, v96, v97
    v_min_u32 v105, v96, v97
    v_med3_u32 v105, v104, v105, v98
    v_max_u32 v104, v104, v98
    v_med3_u32 v105, v104, v105, v99
    v_max_u32 v104, v104, v99
    s_waitcnt lgkmcnt(0)
    v_med3_u32 v105, v104, v105, v100
    v_max_u32 v104, v104, v100
    v_med3_u32 v105, v104, v105, v101
    v_max_u32 v104, v104, v101
    v_med3_u32 v105, v104, v105, v102
    v_max_u32 v104, v104, v102
    v_med3_u32 v105, v104, v105, v103
    v_max_u32 v104, v104, v103
    s_nop 0
    v_readfirstlane_b32 s92, v104
    v_readfirstlane_b32 s93, v105
    s_andn2_b32 s46, 0x7ff, s92
    s_andn2_b32 s47, 0x7ff, s93
    s_mul_i32 s44, s46, 2304
    s_mul_i32 s45, s47, 2304
    s_sub_u32 s45, s45, s44
    v_mad_i32_i24 v10, v10, s45, v9
    s_add_u32 s45, s44, 2621440
    v_add_u32 v10, s45, v10
    s_mov_b32 s48, 16384
Ltail_pollh:
    s_mov_b32 exec_lo, 0xffffff
    s_mov_b32 exec_hi, 0xffffff
    s_add_u32 m0, s38, 0
    s_nop 0
    buffer_load_dwordx4 v10, s[24:27], 0 offen offset:0 sc1 lds
    s_add_u32 m0, s38, 640
    s_nop 0
    buffer_load_dwordx4 v10, s[24:27], 0 offen offset:384 sc1 lds
    s_add_u32 m0, s38, 1280
    s_nop 0
    buffer_load_dwordx4 v10, s[24:27], 0 offen offset:768 sc1 lds
    s_mov_b64 exec, -1
    s_waitcnt vmcnt(0)
    ds_read_b128 a[0:3], v11 offset:0
    ds_read_b128 a[4:7], v11 offset:64
    ds_read_b128 a[8:11], v11 offset:128
    ds_read_b128 a[12:15], v11 offset:192
    ds_read_b128 a[16:19], v11 offset:256
    ds_read_b128 a[20:23], v11 offset:320
    ds_read_b128 a[24:27], v11 offset:1024
    ds_read_b128 a[28:31], v11 offset:1088
    ds_read_b128 a[32:35], v11 offset:1152
    ds_read_b128 a[36:39], v11 offset:1216
    ds_read_b128 a[40:43], v11 offset:1280
    ds_read_b128 a[44:47], v11 offset:1344
    ds_read_b128 a[48:51], v11 offset:2048
    ds_read_b128 a[52:55], v11 offset:2112
    ds_read_b128 a[56:59], v11 offset:2176
    ds_read_b128 a[60:63], v11 offset:2240
    ds_read_b128 a[64:67], v11 offset:2304
    ds_read_b128 a[68:71], v11 offset:2368
    s_waitcnt lgkmcnt(15)
    v_mfma_f32_16x16x32_bf16 v[16:19], a[96:99], a[0:3], 0
    v_mfma_f32_16x16x32_bf16 v[20:23], a[100:103], a[4:7], 0
    v_mfma_f32_16x16x32_bf16 v[16:19], a[104:107], a[8:11], v[16:19]
    s_waitcnt lgkmcnt(14)
    v_mfma_f32_16x16x32_bf16 v[20:23], a[108:111], a[12:15], v[20:23]
    s_waitcnt lgkmcnt(13)
    v_mfma_f32_16x16x32_bf16 v[16:19], a[112:115], a[16:19], v[16:19]
    s_waitcnt lgkmcnt(12)
    v_mfma_f32_16x16x32_bf16 v[20:23], a[116:119], a[20:23], v[20:23]
    s_waitcnt lgkmcnt(11)
    v_mfma_f32_16x16x32_bf16 v[16:19], a[120:123], a[24:27], v[16:19]
    s_waitcnt lgkmcnt(10)
    v_mfma_f32_16x16x32_bf16 v[20:23], a[124:127], a[28:31], v[20:23]
    s_waitcnt lgkmcnt(9)
    v_mfma_f32_16x16x32_bf16 v[16:19], a[128:131], a[32:35], v[16:19]
    s_waitcnt lgkmcnt(8)
    v_mfma_f32_16x16x32_bf16 v[20:23], a[132:135], a[36:39], v[20:23]
    s_waitcnt lgkmcnt(7)
    v_mfma_f32_16x16x32_bf16 v[16:19], a[136:139], a[40:43], v[16:19]
    s_waitcnt lgkmcnt(6)
    v_mfma_f32_16x16x32_bf16 v[20:23], a[140:143], a[44:47], v[20:23]
    s_waitcnt lgkmcnt(5)
    v_mfma_f32_16x16x32_bf16 v[16:19], a[144:147], a[48:51], v[16:19]
    s_waitcnt lgkmcnt(4)
    v_mfma_f32_16x16x32_bf16 v[20:23], a[148:151], a[52:55], v[20:23]
    s_waitcnt lgkmcnt(3)
    v_mfma_f32_16x16x32_bf16 v[16:19], a[152:155], a[56:59], v[16:19]
    s_waitcnt lgkmcnt(2)
    v_mfma_f32_16x16x32_bf16 v[20:23], a[156:159], a[60:63], v[20:23]
    s_waitcnt lgkmcnt(1)
    v_mfma_f32_16x16x32_bf16 v[16:19], a[160:163], a[64:67], v[16:19]
    s_waitcnt lgkmcnt(0)
    v_mfma_f32_16x16x32_bf16 v[20:23], a[164:167], a[68:71], v[20:23]
    s_sub_u32 s48, s48, 1
    s_nop 6
    v_pk_add_f32 v[16:17], v[16:17], v[20:21]
    v_pk_add_f32 v[18:19], v[18:19], v[22:23]
    s_cbranch_scc1 Ltail_goth
    v_cmp_u_f32 vcc, v16, v16
    s_and_b32 s36, vcc_lo, 3
    s_cbranch_scc1 Ltail_pollh
Ltail_goth:
    v_cvt_pk_bf16_f32 v32, v16, v17
    v_cvt_pk_bf16_f32 v33, v18, v19
    v_lshlrev_b32 v16, 16, v32
    v_and_b32 v17, 0xffff0000, v32
    v_lshlrev_b32 v18, 16, v33
    v_and_b32 v19, 0xffff0000, v33
    v_pk_mul_f32 v[32:33], v[16:17], v[40:41] op_sel_hi:[1,0]
    v_pk_mul_f32 v[34:35], v[18:19], v[40:41] op_sel_hi:[1,0]
    v_exp_f32 v32, v32
    v_exp_f32 v33, v33
    v_exp_f32 v34, v34
    v_exp_f32 v35, v35
    v_fma_f32 v32, v32, v41, 1.0
    v_fma_f32 v33, v33, v41, 1.0
    v_fma_f32 v34, v34, v41, 1.0
    v_fma_f32 v35, v35, v41, 1.0
    v_rcp_f32 v32, v32
    v_rcp_f32 v33, v33
    v_rcp_f32 v34, v34
    v_rcp_f32 v35, v35
    v_pk_mul_f32 v[16:17], v[16:17], v[32:33]
    v_pk_mul_f32 v[18:19], v[18:19], v[34:35]
    v_cvt_pk_bf16_f32 v32, v16, v17
    v_cvt_pk_bf16_f32 v33, v18, v19
    v_lshlrev_b32 v16, 16, v32
    v_and_b32 v17, 0xffff0000, v32
    v_lshlrev_b32 v18, 16, v33
    v_and_b32 v19, 0xffff0000, v33
    ds_write_b128 v14, v[16:19]
    s_waitcnt lgkmcnt(0)
    s_barrier
    ds_read_b128 v[16:19], v13 offset:0
    ds_read_b128 v[24:27], v13 offset:2048
    ds_read_b128 v[20:23], v13 offset:1024
    ds_read_b128 v[28:31], v13 offset:3072
    s_waitcnt lgkmcnt(2)
    v_pk_mul_f32 v[16:17], v[16:17], v[24:25]
    v_pk_mul_f32 v[18:19], v[18:19], v[26:27]
    v_cvt_pk_bf16_f32 v32, v16, v17
    v_cvt_pk_bf16_f32 v33, v18, v19
    s_waitcnt lgkmcnt(0)
    v_pk_mul_f32 v[20:21], v[20:21], v[28:29]
    v_pk_mul_f32 v[22:23], v[22:23], v[30:31]
    v_cvt_pk_bf16_f32 v34, v20, v21
    v_cvt_pk_bf16_f32 v35, v22, v23
    v_cndmask_b32 v64, 0, v32, s[52:53]
    v_cndmask_b32 v65, 0, v33, s[52:53]
    v_cndmask_b32 v66, 0, v34, s[52:53]
    v_cndmask_b32 v67, 0, v35, s[52:53]
    s_nop 1
    v_mfma_f32_16x16x32_bf16 v[16:19], v[64:67], a[168:171], 0
    v_cndmask_b32 v68, 0, v32, s[54:55]
    v_cndmask_b32 v69, 0, v33, s[54:55]
    v_mfma_f32_16x16x32_bf16 v[20:23], v[64:67], a[184:187], 0
    v_cndmask_b32 v70, 0, v34, s[54:55]
    v_cndmask_b32 v71, 0, v35, s[54:55]
    v_mfma_f32_16x16x32_bf16 v[24:27], v[64:67], a[200:203], 0
    s_nop 0
    v_mfma_f32_16x16x32_bf16 v[16:19], v[68:71], a[172:175], v[16:19]
Ltour1_1:
    s_cbranch_execz Lmain1
    v_cndmask_b32 v72, 0, v32, s[56:57]
    v_cndmask_b32 v73, 0, v33, s[56:57]
    v_mfma_f32_16x16x32_bf16 v[20:23], v[68:71], a[188:191], v[20:23]
    v_cndmask_b32 v74, 0, v34, s[56:57]
    v_cndmask_b32 v75, 0, v35, s[56:57]
    v_mfma_f32_16x16x32_bf16 v[24:27], v[68:71], a[204:207], v[24:27]
    s_nop 0
    v_mfma_f32_16x16x32_bf16 v[16:19], v[72:75], a[176:179], v[16:19]
    v_cndmask_b32 v76, 0, v32, s[58:59]
    v_cndmask_b32 v77, 0, v33, s[58:59]
    v_mfma_f32_16x16x32_bf16 v[20:23], v[72:75], a[192:195], v[20:23]
    v_cndmask_b32 v78, 0, v34, s[58:59]
    v_cndmask_b32 v79, 0, v35, s[58:59]
    v_mfma_f32_16x16x32_bf16 v[24:27], v[72:75], a[208:211], v[24:27]
    s_nop 0
    v_mfma_f32_16x16x32_bf16 v[16:19], v[76:79], a[180:183], v[16:19]
    v_mfma_f32_16x16x32_bf16 v[20:23], v[76:79], a[196:199], v[20:23]
    v_mfma_f32_16x16x32_bf16 v[24:27], v[76:79], a[212:215], v[24:27]
    s_nop 5
    v_min_u32 v16, -2, v16
    v_min_u32 v17, -2, v17
    buffer_store_dwordx2 v[16:17], v15, s[8:11], s43 offen sc1
    s_add_u32 s43, s43, 294912
    v_min_u32 v20, -2, v20
    v_min_u32 v21, -2, v21
    buffer_store_dwordx2 v[20:21], v15, s[8:11], s43 offen sc1
    s_add_u32 s43, s43, 294912
    v_min_u32 v24, -2, v24
    v_min_u32 v25, -2, v25
    buffer_store_dwordx2 v[24:25], v15, s[8:11], s43 offen sc1
    s_or_b32 s36, s2, s3
    s_cselect_b32 s37, -4, 24576
    s_add_u32 s36, s94, 1
    v_mov_b32 v106, s36
    buffer_store_dword v106, v8, s[24:27], s37 offen sc1
    v_cmp_ne_u32 vcc, s46, v7
    v_cmp_ne_u32 s[36:37], s47, v7
    v_mov_b32 v31, 2147483648
    s_and_b64 vcc, vcc, s[36:37]
    s_nop 1
    v_cndmask_b32 v30, v31, v58, vcc
    v_cndmask_b32 v31, v31, v4, vcc
    buffer_store_dwordx4 v[144:147], v31, s[16:19], 0 offen offset:0 nt
    buffer_store_dwordx4 v[148:151], v31, s[16:19], 0 offen offset:512 nt
    buffer_store_dwordx4 v[152:155], v30, s[16:19], 0 offen offset:1024 nt
    s_cmp_lt_u32 s41, 9
    s_cselect_b32 s36, s3, 0
    s_cmp_lg_u32 s36, 3
    s_cbranch_scc1 Ltail_done
    s_mul_i32 s43, s42, 9
    s_add_u32 s43, s43, s41
    v_bfe_u32 v8, v1, 2, 1
    v_cmp_eq_u32 vcc, 1, v8
    v_mov_b32 v9, s46
    v_mov_b32 v10, s47
    v_and_b32 v11, 3, v1
    v_cndmask_b32 v9, v9, v10, vcc
    s_lshr_b32 s44, s43, 2
    s_lshl_b32 s44, s44, 6
    s_and_b32 s45, s43, 1
    s_lshl_b32 s45, s45, 5
    s_add_u32 s44, s44, s45
    s_and_b32 s45, s43, 2
    s_lshl_b32 s45, s45, 2
    s_add_u32 s44, s44, s45
    v_lshrrev_b32 v12, 1, v11
    v_lshl_add_u32 v12, v12, 4, s44
    v_and_b32 v13, 1, v11
    v_lshl_add_u32 v12, v13, 2, v12
    v_mul_u32_u24 v13, 1152, v9
    v_lshl_add_u32 v14, v13, 1, v12
    v_add_u32 v15, 2621440, v14
    s_mov_b32 s45, 22144
    buffer_load_dword v18, v12, s[24:27], s45 offen sc1
    v_mov_b32 v19, s92
    v_mov_b32 v10, s93
    v_cndmask_b32 v19, v19, v10, vcc
    v_and_b32 v19, 0xfffff800, v19
    v_or_b32 v19, 0x400, v19
    v_ashrrev_i32 v10, 31, v19
    v_not_b32 v10, v10
    v_or_b32 v10, 0x80000000, v10
    v_xor_b32 v19, v19, v10
    s_lshl_b32 s45, s43, 4
    v_lshl_add_u32 v13, v11, 2, v13
    v_add_u32 v13, s45, v13
    v_lshrrev_b32 v14, 2, v1
    v_lshlrev_b32 v14, 9, v14
    v_lshl_add_u32 v14, v11, 4, v14
    s_lshr_b32 s44, s43, 3
    s_mul_i32 s44, s44, 73728
    s_and_b32 s45, s43, 7
    s_lshl_b32 s45, s45, 6
    s_add_u32 s44, s44, s45
    v_cmp_eq_u32 s[38:39], 1, v8
    v_cvt_pk_bf16_f32 v19, v19, v19
    v_and_b32 v19, 0xffff0000, v19
    v_mul_f32 v19, 0xbfb8aa3b, v19
    v_exp_f32 v19, v19
    s_waitcnt vmcnt(0)
    v_lshlrev_b32 v24, 16, v18
    v_and_b32 v25, 0xffff0000, v18
    v_add_f32 v19, 1.0, v19
    v_rcp_f32 v19, v19
    s_mov_b32 s48, 262144
    v_cvt_pk_bf16_f32 v19, v19, v19
    v_and_b32 v19, 0xffff0000, v19
Ltail_polly:
    s_add_u32 s45, s44, 0
    buffer_load_dwordx4 v[64:67], v14, s[8:11], s45 offen sc1
    s_add_u32 s45, s44, 8192
    buffer_load_dwordx4 v[68:71], v14, s[8:11], s45 offen sc1
    s_add_u32 s45, s44, 16384
    buffer_load_dwordx4 v[72:75], v14, s[8:11], s45 offen sc1
    s_add_u32 s45, s44, 24576
    buffer_load_dwordx4 v[76:79], v14, s[8:11], s45 offen sc1
    s_add_u32 s45, s44, 32768
    buffer_load_dwordx4 v[80:83], v14, s[8:11], s45 offen sc1
    s_add_u32 s45, s44, 40960
    buffer_load_dwordx4 v[84:87], v14, s[8:11], s45 offen sc1
    s_add_u32 s45, s44, 49152
    buffer_load_dwordx4 v[88:91], v14, s[8:11], s45 offen sc1
    s_add_u32 s45, s44, 57344
    buffer_load_dwordx4 v[92:95], v14, s[8:11], s45 offen sc1
    s_add_u32 s45, s44, 65536
    buffer_load_dwordx4 v[96:99], v14, s[8:11], s45 offen sc1
    s_mov_b32 s45, 1152
    buffer_load_dword v16, v15, s[24:27], s45 offen sc1
    buffer_load_dword v17, v15, s[24:27], 0 offen sc1
    s_sub_u32 s48, s48, 1
    s_cbranch_scc1 Ltail_goty
    s_waitcnt vmcnt(10)
    v_max3_u32 v26, v64, v65, v66
    s_waitcnt vmcnt(9)
    v_max3_u32 v26, v26, v67, v68
    v_max3_u32 v26, v26, v69, v70
    s_waitcnt vmcnt(8)
    v_max3_u32 v26, v26, v71, v72
    v_max3_u32 v26, v26, v73, v74
    s_waitcnt vmcnt(7)
    v_max3_u32 v26, v26, v75, v76
    v_max3_u32 v26, v26, v77, v78
    s_waitcnt vmcnt(6)
    v_max3_u32 v26, v26, v79, v80
    v_max3_u32 v26, v26, v81, v82
    s_waitcnt vmcnt(5)
    v_max3_u32 v26, v26, v83, v84
    v_max3_u32 v26, v26, v85, v86
    s_waitcnt vmcnt(4)
    v_max3_u32 v26, v26, v87, v88
    v_max3_u32 v26, v26, v89, v90
    s_waitcnt vmcnt(3)
    v_max3_u32 v26, v26, v91, v92
    v_max3_u32 v26, v26, v93, v94
    s_waitcnt vmcnt(2)
    v_max3_u32 v26, v26, v95, v96
    v_max3_u32 v26, v26, v97, v98
    v_max_u32 v26, v26, v99
    s_waitcnt vmcnt(0)
    v_max3_u32 v26, v26, v16, v17
    v_cmp_eq_u32 vcc, -1, v26
    s_cbranch_vccnz Ltail_polly
Ltail_goty:
    s_waitcnt vmcnt(0) lgkmcnt(0)
    v_lshlrev_b32 v20, 16, v16
    v_and_b32 v21, 0xffff0000, v16
    v_lshlrev_b32 v22, 16, v17
    v_and_b32 v23, 0xffff0000, v17
    v_pk_add_f32 v[64:65], v[64:65], v[68:69]
    v_pk_add_f32 v[66:67], v[66:67], v[70:71]
    v_pk_add_f32 v[64:65], v[64:65], v[72:73]
    v_pk_add_f32 v[66:67], v[66:67], v[74:75]
    v_pk_add_f32 v[64:65], v[64:65], v[76:77]
    v_pk_add_f32 v[66:67], v[66:67], v[78:79]
    v_pk_add_f32 v[64:65], v[64:65], v[80:81]
    v_pk_add_f32 v[66:67], v[66:67], v[82:83]
    v_pk_add_f32 v[64:65], v[64:65], v[84:85]
    v_pk_add_f32 v[66:67], v[66:67], v[86:87]
    v_pk_add_f32 v[64:65], v[64:65], v[88:89]
    v_pk_add_f32 v[66:67], v[66:67], v[90:91]
    v_pk_add_f32 v[64:65], v[64:65], v[92:93]
    v_pk_add_f32 v[66:67], v[66:67], v[94:95]
    v_pk_add_f32 v[64:65], v[64:65], v[96:97]
    v_pk_add_f32 v[66:67], v[66:67], v[98:99]
    s_nop 0
    v_add_f32_dpp v64, v64, v64 row_ror:4 row_mask:0xf bank_mask:0xf
    v_add_f32_dpp v65, v65, v65 row_ror:4 row_mask:0xf bank_mask:0xf
    v_add_f32_dpp v66, v66, v66 row_ror:4 row_mask:0xf bank_mask:0xf
    v_add_f32_dpp v67, v67, v67 row_ror:4 row_mask:0xf bank_mask:0xf
    v_add_f32_dpp v64, v64, v64 row_ror:8 row_mask:0xf bank_mask:0xf
    v_add_f32_dpp v65, v65, v65 row_ror:8 row_mask:0xf bank_mask:0xf
    v_add_f32_dpp v66, v66, v66 row_ror:8 row_mask:0xf bank_mask:0xf
    v_add_f32_dpp v67, v67, v67 row_ror:8 row_mask:0xf bank_mask:0xf
    v_mov_b32 v68, v64
    v_mov_b32 v69, v65
    v_mov_b32 v70, v66
    v_mov_b32 v71, v67
    v_permlane16_swap_b32 v64, v68
    v_permlane16_swap_b32 v65, v69
    v_permlane16_swap_b32 v66, v70
    v_permlane16_swap_b32 v67, v71
    v_add_f32 v64, v64, v68
    v_add_f32 v65, v65, v69
    v_add_f32 v66, v66, v70
    v_add_f32 v67, v67, v71
    v_mov_b32 v68, v64
    v_mov_b32 v69, v65
    v_mov_b32 v70, v66
    v_mov_b32 v71, v67
    v_permlane32_swap_b32 v64, v68
    v_permlane32_swap_b32 v65, v69
    v_permlane32_swap_b32 v66, v70
    v_permlane32_swap_b32 v67, v71
    v_add_f32 v64, v64, v68
    v_add_f32 v65, v65, v69
    v_add_f32 v66, v66, v70
    v_add_f32 v67, v67, v71
    v_cndmask_b32 v26, v64, v65, s[38:39]
    v_cndmask_b32 v27, v66, v67, s[38:39]
    v_cvt_pk_bf16_f32 v28, v26, v27
    v_lshlrev_b32 v26, 16, v28
    v_and_b32 v27, 0xffff0000, v28
    v_mul_f32 v26, v26, v19
    v_mul_f32 v27, v27, v19
    v_cvt_pk_bf16_f32 v28, v26, v27
    v_lshlrev_b32 v26, 16, v28
    v_and_b32 v27, 0xffff0000, v28
    v_pk_add_f32 v[26:27], v[26:27], v[22:23]
    v_cvt_pk_bf16_f32 v28, v26, v27
    v_lshlrev_b32 v26, 16, v28
    v_and_b32 v27, 0xffff0000, v28
    v_pk_mul_f32 v[26:27], v[26:27], v[24:25]
    v_cvt_pk_bf16_f32 v28, v26, v27
    v_lshlrev_b32 v26, 16, v28
    v_and_b32 v27, 0xffff0000, v28
    v_pk_add_f32 v[26:27], v[26:27], v[20:21]
    v_cvt_pk_bf16_f32 v28, v26, v27
    s_mov_b64 exec, 0xff
    buffer_store_dword v28, v13, s[16:19], 0 offen nt
    s_branch Ltail_done
Ltail_idle:
Ltour1_2:
    s_cbranch_execz Lmain1
    v_lshlrev_b32 v216, 16, v64
    v_and_b32 v217, 0xffff0000, v64
    v_lshlrev_b32 v218, 16, v65
    v_and_b32 v219, 0xffff0000, v65
    v_lshlrev_b32 v220, 16, v66
    v_and_b32 v221, 0xffff0000, v66
    v_lshlrev_b32 v222, 16, v67
    v_and_b32 v223, 0xffff0000, v67
    v_lshlrev_b32 v224, 16, v68
    v_and_b32 v225, 0xffff0000, v68
    v_lshlrev_b32 v226, 16, v69
    v_and_b32 v227, 0xffff0000, v69
    v_lshlrev_b32 v228, 16, v70
    v_and_b32 v229, 0xffff0000, v70
    v_lshlrev_b32 v230, 16, v71
    v_and_b32 v231, 0xffff0000, v71
    v_lshlrev_b32 v232, 16, v72
    v_and_b32 v233, 0xffff0000, v72
    v_lshlrev_b32 v234, 16, v73
    v_and_b32 v235, 0xffff0000, v73
    v_lshlrev_b32 v236, 16, v74
    v_and_b32 v237, 0xffff0000, v74
    v_lshlrev_b32 v238, 16, v75
    v_and_b32 v239, 0xffff0000, v75
    v_pk_mul_f32 v[192:193], v[192:193], v[216:217]
    v_pk_mul_f32 v[194:195], v[194:195], v[218:219]
    v_pk_mul_f32 v[196:197], v[196:197], v[220:221]
    v_pk_mul_f32 v[198:199], v[198:199], v[222:223]
    v_pk_mul_f32 v[200:201], v[200:201], v[224:225]
    v_pk_mul_f32 v[202:203], v[202:203], v[226:227]
    v_pk_mul_f32 v[204:205], v[204:205], v[228:229]
    v_pk_mul_f32 v[206:207], v[206:207], v[230:231]
    v_pk_mul_f32 v[208:209], v[208:209], v[232:233]
    v_pk_mul_f32 v[210:211], v[210:211], v[234:235]
    v_pk_mul_f32 v[212:213], v[212:213], v[236:237]
    v_pk_mul_f32 v[214:215], v[214:215], v[238:239]
    v_cvt_pk_bf16_f32 v144, v192, v193
    v_cvt_pk_bf16_f32 v145, v194, v195
    v_cvt_pk_bf16_f32 v146, v196, v197
    v_cvt_pk_bf16_f32 v147, v198, v199
    v_cvt_pk_bf16_f32 v148, v200, v201
    v_cvt_pk_bf16_f32 v149, v202, v203
    v_cvt_pk_bf16_f32 v150, v204, v205
    v_cvt_pk_bf16_f32 v151, v206, v207
    v_cvt_pk_bf16_f32 v152, v208, v209
    v_cvt_pk_bf16_f32 v153, v210, v211
    v_cvt_pk_bf16_f32 v154, v212, v213
    v_cvt_pk_bf16_f32 v155, v214, v215
    v_lshlrev_b32 v192, 16, v144
    v_and_b32 v193, 0xffff0000, v144
    v_lshlrev_b32 v194, 16, v145
    v_and_b32 v195, 0xffff0000, v145
    v_lshlrev_b32 v196, 16, v146
    v_and_b32 v197, 0xffff0000, v146
    v_lshlrev_b32 v198, 16, v147
    v_and_b32 v199, 0xffff0000, v147
    v_lshlrev_b32 v200, 16, v148
    v_and_b32 v201, 0xffff0000, v148
    v_lshlrev_b32 v202, 16, v149
    v_and_b32 v203, 0xffff0000, v149
    v_lshlrev_b32 v204, 16, v150
    v_and_b32 v205, 0xffff0000, v150
    v_lshlrev_b32 v206, 16, v151
    v_and_b32 v207, 0xffff0000, v151
    v_lshlrev_b32 v208, 16, v152
    v_and_b32 v209, 0xffff0000, v152
    v_lshlrev_b32 v210, 16, v153
    v_and_b32 v211, 0xffff0000, v153
    v_lshlrev_b32 v212, 16, v154
    v_and_b32 v213, 0xffff0000, v154
    v_lshlrev_b32 v214, 16, v155
    v_and_b32 v215, 0xffff0000, v155
    v_pk_add_f32 v[192:193], v[192:193], v[12:13]
    v_pk_add_f32 v[194:195], v[194:195], v[14:15]
    v_pk_add_f32 v[196:197], v[196:197], v[16:17]
    v_pk_add_f32 v[198:199], v[198:199], v[18:19]
    v_pk_add_f32 v[200:201], v[200:201], v[20:21]
    v_pk_add_f32 v[202:203], v[202:203], v[22:23]
    v_pk_add_f32 v[204:205], v[204:205], v[24:25]
    v_pk_add_f32 v[206:207], v[206:207], v[26:27]
    v_pk_add_f32 v[208:209], v[208:209], v[28:29]
    v_pk_add_f32 v[210:211], v[210:211], v[30:31]
    v_pk_add_f32 v[212:213], v[212:213], v[32:33]
    v_pk_add_f32 v[214:215], v[214:215], v[34:35]
    v_cvt_pk_bf16_f32 v156, v192, v193
    v_cvt_pk_bf16_f32 v157, v194, v195
    v_cvt_pk_bf16_f32 v158, v196, v197
    v_cvt_pk_bf16_f32 v159, v198, v199
    v_cvt_pk_bf16_f32 v160, v200, v201
    v_cvt_pk_bf16_f32 v161, v202, v203
    v_cvt_pk_bf16_f32 v162, v204, v205
    v_cvt_pk_bf16_f32 v163, v206, v207
    v_cvt_pk_bf16_f32 v164, v208, v209
    v_cvt_pk_bf16_f32 v165, v210, v211
    v_cvt_pk_bf16_f32 v166, v212, v213
    v_cvt_pk_bf16_f32 v167, v214, v215
    v_and_b32 v30, 2, v1
    v_cmp_ne_u32 vcc, 0, v30
    v_mul_u32_u24 v30, 1152, v7
    v_add_u32 v4, v30, v5
    v_add_u32 v58, v30, v59
    v_mov_b32_dpp v192, v158 quad_perm:[0,2,0,2] row_mask:0xf bank_mask:0xf
    v_mov_b32_dpp v193, v159 quad_perm:[0,2,0,2] row_mask:0xf bank_mask:0xf
    v_mov_b32_dpp v194, v158 quad_perm:[1,3,1,3] row_mask:0xf bank_mask:0xf
    v_mov_b32_dpp v195, v159 quad_perm:[1,3,1,3] row_mask:0xf bank_mask:0xf
    v_mov_b32_dpp v196, v162 quad_perm:[0,2,0,2] row_mask:0xf bank_mask:0xf
    v_mov_b32_dpp v197, v163 quad_perm:[0,2,0,2] row_mask:0xf bank_mask:0xf
    v_mov_b32_dpp v198, v162 quad_perm:[1,3,1,3] row_mask:0xf bank_mask:0xf
    v_mov_b32_dpp v199, v163 quad_perm:[1,3,1,3] row_mask:0xf bank_mask:0xf
    v_mov_b32_dpp v200, v166 quad_perm:[0,2,0,2] row_mask:0xf bank_mask:0xf
    v_mov_b32_dpp v201, v167 quad_perm:[0,2,0,2] row_mask:0xf bank_mask:0xf
    v_mov_b32_dpp v202, v166 quad_perm:[1,3,1,3] row_mask:0xf bank_mask:0xf
    v_mov_b32_dpp v203, v167 quad_perm:[1,3,1,3] row_mask:0xf bank_mask:0xf
    v_cndmask_b32_dpp v144, v156, v192, vcc quad_perm:[0,2,0,2] row_mask:0xf bank_mask:0xf
    v_cndmask_b32_dpp v145, v157, v193, vcc quad_perm:[0,2,0,2] row_mask:0xf bank_mask:0xf
    v_cndmask_b32_dpp v146, v156, v194, vcc quad_perm:[1,3,1,3] row_mask:0xf bank_mask:0xf
    v_cndmask_b32_dpp v147, v157, v195, vcc quad_perm:[1,3,1,3] row_mask:0xf bank_mask:0xf
    v_cndmask_b32_dpp v148, v160, v196, vcc quad_perm:[0,2,0,2] row_mask:0xf bank_mask:0xf
    v_cndmask_b32_dpp v149, v161, v197, vcc quad_perm:[0,2,0,2] row_mask:0xf bank_mask:0xf
    v_cndmask_b32_dpp v150, v160, v198, vcc quad_perm:[1,3,1,3] row_mask:0xf bank_mask:0xf
    v_cndmask_b32_dpp v151, v161, v199, vcc quad_perm:[1,3,1,3] row_mask:0xf bank_mask:0xf
    v_cndmask_b32_dpp v152, v164, v200, vcc quad_perm:[0,2,0,2] row_mask:0xf bank_mask:0xf
    v_cndmask_b32_dpp v153, v165, v201, vcc quad_perm:[0,2,0,2] row_mask:0xf bank_mask:0xf
    v_cndmask_b32_dpp v154, v164, v202, vcc quad_perm:[1,3,1,3] row_mask:0xf bank_mask:0xf
    v_cndmask_b32_dpp v155, v165, v203, vcc quad_perm:[1,3,1,3] row_mask:0xf bank_mask:0xf
    buffer_store_dwordx4 v[144:147], v4, s[16:19], 0 offen offset:0 sc1
    buffer_store_dwordx4 v[148:151], v4, s[16:19], 0 offen offset:512 sc1
    buffer_store_dwordx4 v[152:155], v58, s[16:19], 0 offen offset:1024 sc1
    s_waitcnt vmcnt(0)
    s_mov_b32 s36, 2622592
    buffer_store_dwordx4 v[36:39], v6, s[24:27], s36 offen offset:0 sc1
    buffer_store_dwordx4 v[40:43], v6, s[24:27], s36 offen offset:512 sc1
    buffer_store_dwordx4 v[44:47], v60, s[24:27], s36 offen offset:1024 sc1
Ltail_done:
    s_endpgm
Lattn_wb:
    buffer_wbl2 sc1
    s_waitcnt vmcnt(0)
    s_branch Lattn_wbdone
Lattn_xspin:
Ltour0_12:
    s_cbranch_execz Lmain0
    s_mov_b32 s37, 262144
Lattn_xloop:
    buffer_load_dword v11, v8, s[24:27], s54 offen offset:8 sc1
    s_waitcnt vmcnt(0)
    v_readfirstlane_b32 s36, v11
    s_sub_u32 s37, s37, 1
    s_cbranch_scc1 Lattn_xgot
    s_cmp_lg_u32 s36, s95
    s_cbranch_scc1 Lattn_xloop
    s_branch Lattn_xgot
Ltail_spin1:
Ltour1_3:
    s_cbranch_execz Lmain1
    s_mov_b32 s48, 262144
Ltail_spinl1:
    buffer_load_dword v11, v9, s[24:27], s39 offen sc1
    s_waitcnt vmcnt(0)
    v_cmp_ne_u32 s[54:55], s95, v11
    s_sub_u32 s48, s48, 1
    s_cbranch_scc1 Ltail_got1
    s_cmp_lg_u64 s[54:55], 0
    s_cbranch_scc1 Ltail_spinl1
    s_branch Ltail_got1
Ltail_spin2:
Ltour1_4:
    s_cbranch_execz Lmain1
    s_mov_b32 s48, 262144
Ltail_spinl2:
    buffer_load_dword v11, v9, s[24:27], s39 offen sc1
    s_waitcnt vmcnt(0)
    v_cmp_ne_u32 s[54:55], s95, v11
    s_sub_u32 s48, s48, 1
    s_cbranch_scc1 Ltail_got2
    s_cmp_lg_u64 s[54:55], 0
    s_cbranch_scc1 Ltail_spinl2
    s_branch Ltail_got2
Lattn_redo:
    s_load_dwordx2 s[16:17], s[0:1], 88
    v_xor_b32 v8, 64, v9
    v_xor_b32 v10, 64, v11
    s_waitcnt vmcnt(0) lgkmcnt(0)
    s_barrier
    v_mov_b32 v232, 0xff800000
    v_mov_b32 v233, 0xff800000
    v_mov_b32 v234, 0xff800000
    v_mov_b32 v235, 0xff800000
    s_mov_b32 s40, 0
    s_mov_b32 s48, -1
Lattn_redo_loop:
    s_add_u32 m0, s42, 0
    s_nop 0
    buffer_load_dwordx4 v36, s[8:11], s40 offen lds
    buffer_load_dwordx4 v37, s[8:11], s40 offen offset:1024 lds
    buffer_load_dwordx4 v38, s[8:11], s40 offen offset:2048 lds
    buffer_load_dwordx4 v39, s[8:11], s40 offen offset:3072 lds
    s_add_u32 s40, s40, 16384
    s_waitcnt vmcnt(0) lgkmcnt(0)
    s_barrier
    ds_read_b128 a[208:211], v8 offset:0
    ds_read_b128 a[212:215], v9 offset:0
    ds_read_b128 a[216:219], v10 offset:0
    ds_read_b128 a[220:223], v11 offset:0
    s_waitcnt lgkmcnt(3)
    v_mfma_f32_16x16x32_bf16 v[216:219], a[208:211], v[64:67], 0
    s_waitcnt lgkmcnt(2)
    v_mfma_f32_16x16x32_bf16 v[216:219], a[212:215], v[68:71], v[216:219]
    s_waitcnt lgkmcnt(1)
    v_mfma_f32_16x16x32_bf16 v[216:219], a[216:219], v[72:75], v[216:219]
    s_waitcnt lgkmcnt(0)
    v_mfma_f32_16x16x32_bf16 v[216:219], a[220:223], v[76:79], v[216:219]
    v_mfma_f32_16x16x32_bf16 v[220:223], a[208:211], v[80:83], 0
    v_mfma_f32_16x16x32_bf16 v[220:223], a[212:215], v[84:87], v[220:223]
    v_mfma_f32_16x16x32_bf16 v[220:223], a[216:219], v[88:91], v[220:223]
    v_mfma_f32_16x16x32_bf16 v[220:223], a[220:223], v[92:95], v[220:223]
    v_mfma_f32_16x16x32_bf16 v[224:227], a[208:211], v[96:99], 0
    v_mfma_f32_16x16x32_bf16 v[224:227], a[212:215], v[100:103], v[224:227]
    v_mfma_f32_16x16x32_bf16 v[224:227], a[216:219], v[104:107], v[224:227]
    v_mfma_f32_16x16x32_bf16 v[224:227], a[220:223], v[108:111], v[224:227]
    v_mfma_f32_16x16x32_bf16 v[228:231], a[208:211], v[112:115], 0
    v_mfma_f32_16x16x32_bf16 v[228:231], a[212:215], v[116:119], v[228:231]
    v_mfma_f32_16x16x32_bf16 v[228:231], a[216:219], v[120:123], v[228:231]
    v_mfma_f32_16x16x32_bf16 v[228:231], a[220:223], v[124:127], v[228:231]
    v_max3_f32 v232, v232, v216, v217
    v_max3_f32 v232, v232, v218, v219
    v_max3_f32 v233, v233, v220, v221
    v_max3_f32 v233, v233, v222, v223
    v_max3_f32 v234, v234, v224, v225
    v_max3_f32 v234, v234, v226, v227
    s_nop 1
    v_max3_f32 v235, v235, v228, v229
    v_max3_f32 v235, v235, v230, v231
    ds_read_b128 a[224:227], v8 offset:4096
    ds_read_b128 a[228:231], v9 offset:4096
    ds_read_b128 a[232:235], v10 offset:4096
    ds_read_b128 a[236:239], v11 offset:4096
    s_waitcnt lgkmcnt(3)
    v_mfma_f32_16x16x32_bf16 v[216:219], a[224:227], v[64:67], 0
    s_waitcnt lgkmcnt(2)
    v_mfma_f32_16x16x32_bf16 v[216:219], a[228:231], v[68:71], v[216:219]
    s_waitcnt lgkmcnt(1)
    v_mfma_f32_16x16x32_bf16 v[216:219], a[232:235], v[72:75], v[216:219]
    s_waitcnt lgkmcnt(0)
    v_mfma_f32_16x16x32_bf16 v[216:219], a[236:239], v[76:79], v[216:219]
    v_mfma_f32_16x16x32_bf16 v[220:223], a[224:227], v[80:83], 0
    v_mfma_f32_16x16x32_bf16 v[220:223], a[228:231], v[84:87], v[220:223]
    v_mfma_f32_16x16x32_bf16 v[220:223], a[232:235], v[88:91], v[220:223]
    v_mfma_f32_16x16x32_bf16 v[220:223], a[236:239], v[92:95], v[220:223]
    v_mfma_f32_16x16x32_bf16 v[224:227], a[224:227], v[96:99], 0
    v_mfma_f32_16x16x32_bf16 v[224:227], a[228:231], v[100:103], v[224:227]
    v_mfma_f32_16x16x32_bf16 v[224:227], a[232:235], v[104:107], v[224:227]
    v_mfma_f32_16x16x32_bf16 v[224:227], a[236:239], v[108:111], v[224:227]
    v_mfma_f32_16x16x32_bf16 v[228:231], a[224:227], v[112:115], 0
    v_mfma_f32_16x16x32_bf16 v[228:231], a[228:231], v[116:119], v[228:231]
    v_mfma_f32_16x16x32_bf16 v[228:231], a[232:235], v[120:123], v[228:231]
    v_mfma_f32_16x16x32_bf16 v[228:231], a[236:239], v[124:127], v[228:231]
    v_max3_f32 v232, v232, v216, v217
    v_max3_f32 v232, v232, v218, v219
    v_max3_f32 v233, v233, v220, v221
    v_max3_f32 v233, v233, v222, v223
    v_max3_f32 v234, v234, v224, v225
    v_max3_f32 v234, v234, v226, v227
    s_nop 1
    v_max3_f32 v235, v235, v228, v229
    v_max3_f32 v235, v235, v230, v231
    ds_read_b128 a[208:211], v8 offset:8192
    ds_read_b128 a[212:215], v9 offset:8192
    ds_read_b128 a[216:219], v10 offset:8192
    ds_read_b128 a[220:223], v11 offset:8192
    s_waitcnt lgkmcnt(3)
    v_mfma_f32_16x16x32_bf16 v[216:219], a[208:211], v[64:67], 0
    s_waitcnt lgkmcnt(2)
    v_mfma_f32_16x16x32_bf16 v[216:219], a[212:215], v[68:71], v[216:219]
    s_waitcnt lgkmcnt(1)
    v_mfma_f32_16x16x32_bf16 v[216:219], a[216:219], v[72:75], v[216:219]
    s_waitcnt lgkmcnt(0)
    v_mfma_f32_16x16x32_bf16 v[216:219], a[220:223], v[76:79], v[216:219]
    v_mfma_f32_16x16x32_bf16 v[220:223], a[208:211], v[80:83], 0
    v_mfma_f32_16x16x32_bf16 v[220:223], a[212:215], v[84:87], v[220:223]
    v_mfma_f32_16x16x32_bf16 v[220:223], a[216:219], v[88:91], v[220:223]
    v_mfma_f32_16x16x32_bf16 v[220:223], a[220:223], v[92:95], v[220:223]
    v_mfma_f32_16x16x32_bf16 v[224:227], a[208:211], v[96:99], 0
    v_mfma_f32_16x16x32_bf16 v[224:227], a[212:215], v[100:103], v[224:227]
    v_mfma_f32_16x16x32_bf16 v[224:227], a[216:219], v[104:107], v[224:227]
    v_mfma_f32_16x16x32_bf16 v[224:227], a[220:223], v[108:111], v[224:227]
    v_mfma_f32_16x16x32_bf16 v[228:231], a[208:211], v[112:115], 0
    v_mfma_f32_16x16x32_bf16 v[228:231], a[212:215], v[116:119], v[228:231]
    v_mfma_f32_16x16x32_bf16 v[228:231], a[216:219], v[120:123], v[228:231]
    v_mfma_f32_16x16x32_bf16 v[228:231], a[220:223], v[124:127], v[228:231]
    v_max3_f32 v232, v232, v216, v217
    v_max3_f32 v232, v232, v218, v219
    v_max3_f32 v233, v233, v220, v221
    v_max3_f32 v233, v233, v222, v223
    v_max3_f32 v234, v234, v224, v225
    v_max3_f32 v234, v234, v226, v227
    s_nop 1
    v_max3_f32 v235, v235, v228, v229
    v_max3_f32 v235, v235, v230, v231
    ds_read_b128 a[224:227], v8 offset:12288
    ds_read_b128 a[228:231], v9 offset:12288
    ds_read_b128 a[232:235], v10 offset:12288
    ds_read_b128 a[236:239], v11 offset:12288
    s_waitcnt lgkmcnt(3)
    v_mfma_f32_16x16x32_bf16 v[216:219], a[224:227], v[64:67], 0
    s_waitcnt lgkmcnt(2)
    v_mfma_f32_16x16x32_bf16 v[216:219], a[228:231], v[68:71], v[216:219]
    s_waitcnt lgkmcnt(1)
    v_mfma_f32_16x16x32_bf16 v[216:219], a[232:235], v[72:75], v[216:219]
    s_waitcnt lgkmcnt(0)
    v_mfma_f32_16x16x32_bf16 v[216:219], a[236:239], v[76:79], v[216:219]
    v_mfma_f32_16x16x32_bf16 v[220:223], a[224:227], v[80:83], 0
    v_mfma_f32_16x16x32_bf16 v[220:223], a[228:231], v[84:87], v[220:223]
    v_mfma_f32_16x16x32_bf16 v[220:223], a[232:235], v[88:91], v[220:223]
    v_mfma_f32_16x16x32_bf16 v[220:223], a[236:239], v[92:95], v[220:223]
    v_mfma_f32_16x16x32_bf16 v[224:227], a[224:227], v[96:99], 0
    v_mfma_f32_16x16x32_bf16 v[224:227], a[228:231], v[100:103], v[224:227]
    v_mfma_f32_16x16x32_bf16 v[224:227], a[232:235], v[104:107], v[224:227]
    v_mfma_f32_16x16x32_bf16 v[224:227], a[236:239], v[108:111], v[224:227]
    v_mfma_f32_16x16x32_bf16 v[228:231], a[224:227], v[112:115], 0
    v_mfma_f32_16x16x32_bf16 v[228:231], a[228:231], v[116:119], v[228:231]
    v_mfma_f32_16x16x32_bf16 v[228:231], a[232:235], v[120:123], v[228:231]
    v_mfma_f32_16x16x32_bf16 v[228:231], a[236:239], v[124:127], v[228:231]
    v_max3_f32 v232, v232, v216, v217
    v_max3_f32 v232, v232, v218, v219
    v_max3_f32 v233, v233, v220, v221
    v_max3_f32 v233, v233, v222, v223
    v_max3_f32 v234, v234, v224, v225
    v_max3_f32 v234, v234, v226, v227
    s_nop 1
    v_max3_f32 v235, v235, v228, v229
    v_max3_f32 v235, v235, v230, v231
    s_barrier
    s_cmp_lt_u32 s40, 524288
    s_cbranch_scc1 Lattn_redo_loop
    v_mov_b32 v236, v232
    v_mov_b32 v237, v233
    v_mov_b32 v238, v234
    v_mov_b32 v239, v235
    v_permlane16_swap_b32 v232, v236
    v_permlane16_swap_b32 v233, v237
    v_permlane16_swap_b32 v234, v238
    v_permlane16_swap_b32 v235, v239
    v_max_f32 v232, v232, v236
    v_max_f32 v233, v233, v237
    v_max_f32 v234, v234, v238
    v_max_f32 v235, v235, v239
    v_mov_b32 v236, v232
    v_mov_b32 v237, v233
    v_mov_b32 v238, v234
    v_mov_b32 v239, v235
    v_permlane32_swap_b32 v232, v236
    v_permlane32_swap_b32 v233, v237
    v_permlane32_swap_b32 v234, v238
    v_permlane32_swap_b32 v235, v239
    v_max_f32 v232, v232, v236
    v_max_f32 v233, v233, v237
    v_max_f32 v234, v234, v238
    v_max_f32 v235, v235, v239
    v_sub_f32 v192, 0, v232
    v_sub_f32 v193, 0, v232
    v_sub_f32 v194, 0, v232
    v_sub_f32 v195, 0, v232
    v_sub_f32 v196, 0, v233
    v_sub_f32 v197, 0, v233
    v_sub_f32 v198, 0, v233
    v_sub_f32 v199, 0, v233
    v_sub_f32 v200, 0, v234
    v_sub_f32 v201, 0, v234
    v_sub_f32 v202, 0, v234
    v_sub_f32 v203, 0, v234
    v_sub_f32 v204, 0, v235
    v_sub_f32 v205, 0, v235
    v_sub_f32 v206, 0, v235
    v_sub_f32 v207, 0, v235
    s_mov_b32 s40, 0
    s_mov_b32 s41, 0
    s_add_u32 m0, s42, 0
    s_nop 0
    buffer_load_dwordx4 v36, s[8:11], s40 offen lds
    buffer_load_dwordx4 v37, s[8:11], s40 offen offset:1024 lds
    buffer_load_dwordx4 v38, s[8:11], s40 offen offset:2048 lds
    buffer_load_dwordx4 v39, s[8:11], s40 offen offset:3072 lds
    s_add_u32 s40, s40, 16384
    s_add_u32 m0, s42, 16384
    s_nop 0
    buffer_load_dwordx4 v36, s[8:11], s40 offen lds
    buffer_load_dwordx4 v37, s[8:11], s40 offen offset:1024 lds
    buffer_load_dwordx4 v38, s[8:11], s40 offen offset:2048 lds
    buffer_load_dwordx4 v39, s[8:11], s40 offen offset:3072 lds
    s_add_u32 s40, s40, 16384
    s_add_u32 m0, s42, 32768
    s_nop 0
    buffer_load_dwordx4 v36, s[8:11], s40 offen lds
    buffer_load_dwordx4 v37, s[8:11], s40 offen offset:1024 lds
    buffer_load_dwordx4 v38, s[8:11], s40 offen offset:2048 lds
    buffer_load_dwordx4 v39, s[8:11], s40 offen offset:3072 lds
    s_add_u32 s40, s40, 16384
    s_add_u32 m0, s42, 65536
    s_nop 0
    buffer_load_dwordx4 v40, s[12:15], s41 offen lds
    buffer_load_dwordx4 v41, s[12:15], s41 offen offset:1024 lds
    buffer_load_dwordx4 v40, s[12:15], s41 offen offset:2048 lds
    buffer_load_dwordx4 v41, s[12:15], s41 offen offset:3072 lds
    s_add_u32 s41, s41, 16384
    s_add_u32 m0, s42, 81920
    s_nop 0
    buffer_load_dwordx4 v40, s[12:15], s41 offen lds
    buffer_load_dwordx4 v41, s[12:15], s41 offen offset:1024 lds
    buffer_load_dwordx4 v40, s[12:15], s41 offen offset:2048 lds
    buffer_load_dwordx4 v41, s[12:15], s41 offen offset:3072 lds
    s_add_u32 s41, s41, 16384
    v_accvgpr_write_b32 a0, 0
    v_accvgpr_write_b32 a1, 0
    v_accvgpr_write_b32 a2, 0
    v_accvgpr_write_b32 a3, 0
    v_accvgpr_write_b32 a4, 0
    v_accvgpr_write_b32 a5, 0
    v_accvgpr_write_b32 a6, 0
    v_accvgpr_write_b32 a7, 0
    v_accvgpr_write_b32 a8, 0
    v_accvgpr_write_b32 a9, 0
    v_accvgpr_write_b32 a10, 0
    v_accvgpr_write_b32 a11, 0
    v_accvgpr_write_b32 a12, 0
    v_accvgpr_write_b32 a13, 0
    v_accvgpr_write_b32 a14, 0
    v_accvgpr_write_b32 a15, 0
    v_accvgpr_write_b32 a16, 0
    v_accvgpr_write_b32 a17, 0
    v_accvgpr_write_b32 a18, 0
    v_accvgpr_write_b32 a19, 0
    v_accvgpr_write_b32 a20, 0
    v_accvgpr_write_b32 a21, 0
    v_accvgpr_write_b32 a22, 0
    v_accvgpr_write_b32 a23, 0
    v_accvgpr_write_b32 a24, 0
    v_accvgpr_write_b32 a25, 0
    v_accvgpr_write_b32 a26, 0
    v_accvgpr_write_b32 a27, 0
    v_accvgpr_write_b32 a28, 0
    v_accvgpr_write_b32 a29, 0
    v_accvgpr_write_b32 a30, 0
    v_accvgpr_write_b32 a31, 0
    v_accvgpr_write_b32 a32, 0
    v_accvgpr_write_b32 a33, 0
    v_accvgpr_write_b32 a34, 0
    v_accvgpr_write_b32 a35, 0
    v_accvgpr_write_b32 a36, 0
    v_accvgpr_write_b32 a37, 0
    v_accvgpr_write_b32 a38, 0
    v_accvgpr_write_b32 a39, 0
    v_accvgpr_write_b32 a40, 0
    v_accvgpr_write_b32 a41, 0
    v_accvgpr_write_b32 a42, 0
    v_accvgpr_write_b32 a43, 0
    v_accvgpr_write_b32 a44, 0
    v_accvgpr_write_b32 a45, 0
    v_accvgpr_write_b32 a46, 0
    v_accvgpr_write_b32 a47, 0
    v_accvgpr_write_b32 a48, 0
    v_accvgpr_write_b32 a49, 0
    v_accvgpr_write_b32 a50, 0
    v_accvgpr_write_b32 a51, 0
    v_accvgpr_write_b32 a52, 0
    v_accvgpr_write_b32 a53, 0
    v_accvgpr_write_b32 a54, 0
    v_accvgpr_write_b32 a55, 0
    v_accvgpr_write_b32 a56, 0
    v_accvgpr_write_b32 a57, 0
    v_accvgpr_write_b32 a58, 0
    v_accvgpr_write_b32 a59, 0
    v_accvgpr_write_b32 a60, 0
    v_accvgpr_write_b32 a61, 0
    v_accvgpr_write_b32 a62, 0
    v_accvgpr_write_b32 a63, 0
    v_accvgpr_write_b32 a64, 0
    v_accvgpr_write_b32 a65, 0
    v_accvgpr_write_b32 a66, 0
    v_accvgpr_write_b32 a67, 0
    v_accvgpr_write_b32 a68, 0
    v_accvgpr_write_b32 a69, 0
    v_accvgpr_write_b32 a70, 0
    v_accvgpr_write_b32 a71, 0
    v_accvgpr_write_b32 a72, 0
    v_accvgpr_write_b32 a73, 0
    v_accvgpr_write_b32 a74, 0
    v_accvgpr_write_b32 a75, 0
    v_accvgpr_write_b32 a76, 0
    v_accvgpr_write_b32 a77, 0
    v_accvgpr_write_b32 a78, 0
    v_accvgpr_write_b32 a79, 0
    v_accvgpr_write_b32 a80, 0
    v_accvgpr_write_b32 a81, 0
    v_accvgpr_write_b32 a82, 0
    v_accvgpr_write_b32 a83, 0
    v_accvgpr_write_b32 a84, 0
    v_accvgpr_write_b32 a85, 0
    v_accvgpr_write_b32 a86, 0
    v_accvgpr_write_b32 a87, 0
    v_accvgpr_write_b32 a88, 0
    v_accvgpr_write_b32 a89, 0
    v_accvgpr_write_b32 a90, 0
    v_accvgpr_write_b32 a91, 0
    v_accvgpr_write_b32 a92, 0
    v_accvgpr_write_b32 a93, 0
    v_accvgpr_write_b32 a94, 0
    v_accvgpr_write_b32 a95, 0
    v_accvgpr_write_b32 a96, 0
    v_accvgpr_write_b32 a97, 0
    v_accvgpr_write_b32 a98, 0
    v_accvgpr_write_b32 a99, 0
    v_accvgpr_write_b32 a100, 0
    v_accvgpr_write_b32 a101, 0
    v_accvgpr_write_b32 a102, 0
    v_accvgpr_write_b32 a103, 0
    v_accvgpr_write_b32 a104, 0
    v_accvgpr_write_b32 a105, 0
    v_accvgpr_write_b32 a106, 0
    v_accvgpr_write_b32 a107, 0
    v_accvgpr_write_b32 a108, 0
    v_accvgpr_write_b32 a109, 0
    v_accvgpr_write_b32 a110, 0
    v_accvgpr_write_b32 a111, 0
    v_accvgpr_write_b32 a112, 0
    v_accvgpr_write_b32 a113, 0
    v_accvgpr_write_b32 a114, 0
    v_accvgpr_write_b32 a115, 0
    v_accvgpr_write_b32 a116, 0
    v_accvgpr_write_b32 a117, 0
    v_accvgpr_write_b32 a118, 0
    v_accvgpr_write_b32 a119, 0
    v_accvgpr_write_b32 a120, 0
    v_accvgpr_write_b32 a121, 0
    v_accvgpr_write_b32 a122, 0
    v_accvgpr_write_b32 a123, 0
    v_accvgpr_write_b32 a124, 0
    v_accvgpr_write_b32 a125, 0
    v_accvgpr_write_b32 a126, 0
    v_accvgpr_write_b32 a127, 0
    v_accvgpr_write_b32 a192, 0
    v_accvgpr_write_b32 a193, 0
    v_accvgpr_write_b32 a194, 0
    v_accvgpr_write_b32 a195, 0
    v_accvgpr_write_b32 a196, 0
    v_accvgpr_write_b32 a197, 0
    v_accvgpr_write_b32 a198, 0
    v_accvgpr_write_b32 a199, 0
    v_accvgpr_write_b32 a200, 0
    v_accvgpr_write_b32 a201, 0
    v_accvgpr_write_b32 a202, 0
    v_accvgpr_write_b32 a203, 0
    v_accvgpr_write_b32 a204, 0
    v_accvgpr_write_b32 a205, 0
    v_accvgpr_write_b32 a206, 0
    v_accvgpr_write_b32 a207, 0
    s_waitcnt vmcnt(0) lgkmcnt(0)
    s_barrier
    ds_read_b128 a[208:211], v8 offset:0
    ds_read_b128 a[212:215], v9 offset:0
    ds_read_b128 a[216:219], v10 offset:0
    ds_read_b128 a[220:223], v11 offset:0
    ds_read_b128 a[224:227], v8 offset:4096
    s_waitcnt vmcnt(0) lgkmcnt(0)
    s_branch Lattn_stage0
Lattn_armwait:
    s_mov_b32 s36, 262144
Lattn_armloop:
    v_mov_b32 v63, 0
    buffer_load_dword v63, v63, s[88:91], 0 offen sc1
    s_waitcnt vmcnt(0)
    v_readfirstlane_b32 s37, v63
    s_sub_u32 s36, s36, 1
    s_cbranch_scc1 Lattn_armed
    s_cmp_lt_u32 s37, 256
    s_cbranch_scc1 Lattn_armloop
    s_branch Lattn_armed
Lattn_end:
    s_endpgm
.section .rodata,"a"
.p2align 6
.amdhsa_kernel adaLN_cond__gqa_block_cached__moe_arch_mod__prompt_kernel
  .amdhsa_next_free_vgpr 512
  .amdhsa_next_free_sgpr 102
  .amdhsa_accum_offset 256
  .amdhsa_group_segment_fixed_size 0
  .amdhsa_kernarg_size 120
  .amdhsa_user_sgpr_count 2
  .amdhsa_user_sgpr_kernarg_segment_ptr 1
  .amdhsa_system_sgpr_workgroup_id_x 1
  .amdhsa_float_denorm_mode_32 3
.end_amdhsa_kernel
```

```asm
; @launch grid=(256,1,1) block=(256,1,1) lds=163840
.amdgcn_target "amdgcn-amd-amdhsa--gfx950"
.text
.globl adaLN_cond__gqa_block_cached__moe_arch_mod__prompt_kernel
.p2align 8
.type adaLN_cond__gqa_block_cached__moe_arch_mod__prompt_kernel,@function
adaLN_cond__gqa_block_cached__moe_arch_mod__prompt_kernel:
    s_cmp_ge_u32 s2, 256
    s_cbranch_scc1 Lattn_end
    s_load_dwordx2 s[8:9], s[0:1], 80
    s_load_dwordx2 s[12:13], s[0:1], 88
    s_load_dwordx2 s[20:21], s[0:1], 0
    s_load_dwordx2 s[50:51], s[0:1], 112
    s_load_dwordx8 s[52:59], s[0:1], 8
    s_load_dwordx8 s[80:87], s[0:1], 56
    s_load_dwordx2 s[88:89], s[0:1], 104
    s_getpc_b64 s[32:33]
Lattn_pc:
    s_mov_b32 s34, Lattn_end-Lattn_pc
    s_mov_b32 s35, 0x20000
    s_lshr_b32 s6, s2, 3
    s_lshl_b32 s7, s6, 6
    v_lshrrev_b32 v3, 6, v0
    v_and_b32 v1, 63, v0
    v_lshrrev_b32 v2, 2, v0
    v_lshlrev_b32 v2, 11, v2
    v_readfirstlane_b32 s3, v3
    buffer_load_dword v240, v2, s[32:35], s7 offen
    s_and_b32 s7, s2, 7
    s_lshl_b32 s4, s7, 1
    s_and_b32 s5, s6, 1
    s_add_u32 s4, s4, s5
    s_lshr_b32 s5, s2, 4
    s_lshr_b32 s38, s6, 2
    s_lshl_b32 s38, s38, 3
    s_add_u32 s38, s38, s7
    s_cmp_lt_u32 s38, 18
    s_cselect_b32 s39, 0, 2147483648
    s_lshl_b32 s38, s38, 2
    s_and_b32 s36, s6, 3
    s_add_u32 s38, s38, s36
    s_mov_b32 s14, 3981312
    s_mul_i32 s92, s6, 124416
    s_lshl_b32 s36, s7, 7
    s_add_u32 s92, s92, s36
    s_cmp_lt_u32 s7, 2
    s_cselect_b32 s36, 53, 35
    v_lshrrev_b32 v2, 2, v0
    v_min_u32 v2, s36, v2
    v_mul_u32_u24 v3, 57, v2
    v_lshrrev_b32 v3, 10, v3
    v_mul_i32_i24 v3, -123392, v3
    v_mul_u32_u24 v2, 6912, v2
    v_add_u32 v72, v2, v3
    s_mov_b32 s15, 0x20000
    s_mov_b32 s10, 1152
    s_mov_b32 s11, 0x20000
    s_mov_b32 s22, 2359296
    s_mov_b32 s23, 0x20000
    v_and_b32 v64, 0xfe, v0
    v_mul_u32_u24 v65, 3456, v64
    v_and_b32 v2, 1, v0
    v_lshl_add_u32 v65, v2, 4, v65
    s_lshl_b32 s36, s38, 5
    s_or_b32 s36, s36, s39
    s_waitcnt lgkmcnt(0)
    s_load_dword s94, s[50:51], 24576
    buffer_load_dword v241, v72, s[12:15], s92 offen
    buffer_load_ushort v80, v64, s[8:11], 0 offen offset:0
    buffer_load_ushort v81, v64, s[8:11], 0 offen offset:256
    buffer_load_ushort v82, v64, s[8:11], 0 offen offset:512
    buffer_load_ushort v83, v64, s[8:11], 0 offen offset:768
    buffer_load_ushort v84, v64, s[8:11], 0 offen offset:1024
    buffer_load_dwordx4 v[88:91], v65, s[12:15], s36 offen
    s_add_u32 s36, s36, 884736
    buffer_load_dwordx4 v[92:95], v65, s[12:15], s36 offen
    s_add_u32 s36, s36, 884736
    buffer_load_dwordx4 v[96:99], v65, s[12:15], s36 offen
    s_add_u32 s36, s36, 884736
    buffer_load_dwordx4 v[100:103], v65, s[12:15], s36 offen
    s_add_u32 s36, s36, 884736
    buffer_load_dwordx4 v[104:107], v65, s[12:15], s36 offen
    v_and_b32 v4, 31, v1
    v_lshrrev_b32 v5, 5, v1
    v_cmp_gt_u32 vcc, 24, v4
    v_mov_b32 v6, 2147483648
    s_lshl_b32 s7, s5, 4
    s_add_u32 s7, s7, s4
    s_lshl_b32 s7, s7, 2
    s_add_u32 s7, s7, s3
    v_cndmask_b32 v6, v6, 0, vcc
    s_mul_i32 s49, s7, 2304
    v_lshrrev_b32 v7, 2, v4
    v_lshl_add_u32 v7, v7, 6, v6
    v_and_b32 v2, 3, v4
    v_lshl_add_u32 v7, v2, 3, v7
    v_mul_u32_u24 v2, 1152, v5
    v_add_u32 v66, v7, v2
    s_mov_b32 s16, s56
    s_mov_b32 s17, s57
    s_mov_b32 s18, 4718592
    s_mov_b32 s19, 0x20000
    s_lshl_b32 s44, s4, 9
    s_mul_i32 s36, s5, 131072
    s_add_u32 s36, s36, 0
    v_lshrrev_b32 v2, 2, v0
    v_min_u32 v2, 63, v2
    v_lshrrev_b32 v3, 2, v2
    v_and_b32 v2, 3, v2
    v_lshl_add_u32 v2, v2, 7, s36
    v_lshl_add_u32 v71, v3, 13, v2
    s_mul_i32 s36, s5, 163840
    s_add_u32 s36, s36, 2097152
    v_lshrrev_b32 v2, 1, v0
    v_min_u32 v2, 79, v2
    v_lshrrev_b32 v3, 2, v2
    v_and_b32 v2, 3, v2
    v_lshl_add_u32 v2, v2, 7, s36
    v_lshl_add_u32 v70, v3, 13, v2
    s_add_u32 s92, s49, 65536
    v_lshl_add_u32 v7, v5, 4, v6
    v_lshl_add_u32 v67, v4, 5, v7
    v_min_u32 v4, 23, v4
    v_lshlrev_b32 v68, 4, v4
    s_mov_b32 s24, s50
    s_mov_b32 s25, s51
    s_mov_b32 s26, 10485760
    s_mov_b32 s27, 0x20000
    s_mov_b32 s90, 256
    s_mov_b32 s91, 0x20000
    s_cmp_ge_u32 s38, 36
    s_cselect_b32 s93, 1.0, 0
    s_lshl_b32 s36, s38, 7
    v_lshl_add_u32 v69, v0, 3, s36
    v_cmp_gt_u32 s[36:37], 16, v0
    v_mov_b32 v2, 2147483648
    v_mov_b32 v3, s39
    v_cndmask_b32 v2, v2, v3, s[36:37]
    v_or_b32 v69, v69, v2
    s_mul_i32 s36, s5, 3072
    s_lshl_b32 s37, s5, 11
    v_lshrrev_b32 v120, 3, v0
    v_min_u32 v120, 23, v120
    v_lshl_add_u32 v120, v120, 7, s36
    v_lshrrev_b32 v121, 4, v0
    v_lshl_add_u32 v121, v121, 7, s37
    s_lshl_b32 s42, s3, 12
    v_lshrrev_b32 v2, 4, v1
    v_and_b32 v3, 15, v1
    v_lshrrev_b32 v5, 1, v3
    v_mul_u32_u24 v5, 2304, v5
    v_lshl_add_u32 v5, v2, 5, v5
    v_and_b32 v6, 1, v3
    v_lshl_add_u32 v51, v6, 4, v5
    s_lshl_b32 s6, s5, 2
    s_add_u32 s6, s6, s3
    s_mul_i32 s46, s6, 36864
    s_add_u32 s46, s46, 65536
    s_add_u32 s43, s46, 18432
    s_mul_i32 s45, s4, 294912
    s_lshl_b32 s7, s3, 4
    v_add_u32 v4, s7, v2
    v_lshlrev_b32 v5, 1, v2
    v_xor_b32 v5, v5, v3
    v_xor_b32 v6, 8, v5
    v_lshlrev_b32 v7, 13, v4
    v_lshl_add_u32 v42, v5, 4, v7
    v_lshl_add_u32 v43, v6, 4, v7
    v_add_u32 v44, 63488, v42
    v_add_u32 v45, 95232, v43
    v_add_u32 v43, 31744, v43
    s_lshl_b32 s7, s4, 19
    s_add_u32 s8, s52, s7
    s_addc_u32 s9, s53, 0
    s_mov_b32 s10, 524288
    s_mov_b32 s11, 0x20000
    s_add_u32 s12, s54, s7
    s_addc_u32 s13, s55, 0
    s_mov_b32 s14, 524288
    s_mov_b32 s15, 0x20000
    s_add_u32 s28, s50, 10485760
    s_addc_u32 s29, s51, 0
    s_mov_b32 s30, 37879808
    s_mov_b32 s31, 0x20000
    v_lshlrev_b32 v7, 8, v4
    v_lshl_add_u32 v40, v5, 4, v7
    v_lshl_add_u32 v41, v6, 4, v7
    v_xor_b32 v224, v3, v2
    v_lshl_add_u32 v36, v224, 4, v7
    v_xor_b32 v37, 64, v36
    v_xor_b32 v38, 128, v36
    v_xor_b32 v39, 192, v36
    v_lshrrev_b32 v7, 3, v5
    v_lshl_add_u32 v7, v7, 7, v4
    v_mul_u32_u24 v7, 1152, v7
    v_and_b32 v225, 7, v5
    v_lshl_add_u32 v46, v225, 4, v7
    v_lshrrev_b32 v7, 3, v6
    v_lshl_add_u32 v7, v7, 7, v4
    v_mul_u32_u24 v7, 1152, v7
    v_and_b32 v225, 7, v6
    v_lshl_add_u32 v47, v225, 4, v7
    v_add_u32 v48, 7168, v46
    v_add_u32 v49, 10752, v47
    v_add_u32 v47, 3584, v47
    v_lshlrev_b32 v7, 8, v3
    v_lshl_add_u32 v8, v224, 4, v7
    v_xor_b32 v9, 64, v8
    v_xor_b32 v10, 128, v8
    v_xor_b32 v11, 192, v8
    v_lshrrev_b32 v5, 2, v1
    v_and_b32 v6, 7, v5
    v_lshlrev_b32 v6, 5, v6
    v_lshl_add_u32 v6, v5, 8, v6
    v_and_b32 v7, 3, v1
    v_lshl_add_u32 v12, v7, 3, v6
    v_xor_b32 v13, 32, v12
    v_xor_b32 v14, 64, v12
    v_xor_b32 v15, 96, v12
    v_xor_b32 v16, 128, v12
    v_xor_b32 v17, 160, v12
    v_xor_b32 v18, 192, v12
    v_xor_b32 v19, 224, v12
    v_add_u32 v20, 65536, v12
    v_add_u32 v21, 65536, v13
    v_add_u32 v22, 65536, v14
    v_add_u32 v23, 65536, v15
    v_add_u32 v24, 65536, v16
    v_add_u32 v25, 65536, v17
    v_add_u32 v26, 65536, v18
    v_add_u32 v27, 65536, v19
    v_add_u32 v28, 131072, v12
    v_add_u32 v29, 131072, v13
    v_add_u32 v30, 131072, v14
    v_add_u32 v31, 131072, v15
    v_add_u32 v32, 131072, v16
    v_add_u32 v33, 131072, v17
    v_add_u32 v34, 131072, v18
    v_add_u32 v35, 131072, v19
    v_mov_b32 v52, 0x3f803f80
    v_mov_b32 v53, 0x3f803f80
    v_mov_b32 v54, 0x3f803f80
    v_mov_b32 v55, 0x3f803f80
    v_and_b32 v5, 1, v1
    v_mul_u32_u24 v5, 0xaaaa, v5
    v_add_u32 v5, 0x4444, v5
    v_lshl_add_u32 v50, v5, 16, v5
    v_lshrrev_b32 v5, 1, v3
    v_mul_u32_u24 v5, 20608, v5
    v_lshl_add_u32 v5, v2, 5, v5
    v_and_b32 v6, 1, v3
    v_lshl_add_u32 v56, v6, 4, v5
    s_mul_i32 s47, s6, 329728
    s_mov_b32 s32, s82
    s_mov_b32 s33, s83
    s_mov_b32 s34, 5308416
    s_mov_b32 s35, 0x20000
    s_mov_b32 s82, 5308416
    s_mov_b32 s83, 0x20000
    s_mov_b32 s86, 5308416
    s_mov_b32 s87, 0x20000
    s_lshr_b32 s7, s2, 3
    s_mul_i32 s7, s7, 18
    s_add_u32 s7, s7, s3
    s_and_b32 s36, s2, 7
    s_mul_i32 s37, s36, 576
    s_add_u32 s37, s37, s7
    s_mul_i32 s37, s37, 1152
    s_mul_i32 s7, s7, 9216
    s_mul_i32 s36, s36, 1152
    s_add_u32 s7, s7, s36
    v_min_u32 v5, 17, v1
    v_lshl_add_u32 v57, v5, 6, s7
    v_lshl_add_u32 v62, v5, 6, s37
    s_mov_b32 s40, 0
    s_mov_b32 s41, 0
    s_mov_b32 s48, 0
    s_waitcnt vmcnt(9)
    v_lshlrev_b32 v80, 16, v80
    s_waitcnt vmcnt(8)
    v_lshlrev_b32 v81, 16, v81
    s_waitcnt vmcnt(7)
    v_lshlrev_b32 v82, 16, v82
    s_waitcnt vmcnt(6)
    v_lshlrev_b32 v83, 16, v83
    s_waitcnt vmcnt(5)
    v_lshlrev_b32 v84, 16, v84
    v_mul_f32 v144, 0xbfb8aa3b, v80
    v_mul_f32 v148, 0xbfb8aa3b, v81
    v_mul_f32 v152, 0xbfb8aa3b, v82
    v_mul_f32 v156, 0xbfb8aa3b, v83
    v_mul_f32 v160, 0xbfb8aa3b, v84
    v_min_f32 v144, 0x42fc0000, v144
    v_min_f32 v148, 0x42fc0000, v148
    v_min_f32 v152, 0x42fc0000, v152
    v_min_f32 v156, 0x42fc0000, v156
    v_min_f32 v160, 0x42fc0000, v160
    v_exp_f32 v144, v144
    v_exp_f32 v148, v148
    v_exp_f32 v152, v152
    v_exp_f32 v156, v156
    v_exp_f32 v160, v160
    v_add_f32 v144, 1.0, v144
    v_add_f32 v148, 1.0, v148
    v_add_f32 v152, 1.0, v152
    v_add_f32 v156, 1.0, v156
    v_add_f32 v160, 1.0, v160
    v_rcp_f32 v145, v144
    v_rcp_f32 v149, v148
    v_rcp_f32 v153, v152
    v_rcp_f32 v157, v156
    v_rcp_f32 v161, v160
    v_mul_f32 v146, v80, v145
    v_mul_f32 v150, v81, v149
    v_mul_f32 v154, v82, v153
    v_mul_f32 v158, v83, v157
    v_mul_f32 v162, v84, v161
    v_fma_f32 v144, -v146, v144, v80
    v_fma_f32 v148, -v150, v148, v81
    v_fma_f32 v152, -v154, v152, v82
    v_fma_f32 v156, -v158, v156, v83
    v_fma_f32 v160, -v162, v160, v84
    v_fma_f32 v80, v144, v145, v146
    v_fma_f32 v81, v148, v149, v150
    v_fma_f32 v82, v152, v153, v154
    v_fma_f32 v83, v156, v157, v158
    v_fma_f32 v84, v160, v161, v162
    v_cvt_pk_bf16_f32 v80, v80, v80
    v_cvt_pk_bf16_f32 v81, v81, v81
    v_cvt_pk_bf16_f32 v82, v82, v82
    v_cvt_pk_bf16_f32 v83, v83, v83
    v_cvt_pk_bf16_f32 v84, v84, v84
    v_and_b32 v80, 0xffff0000, v80
    v_and_b32 v81, 0xffff0000, v81
    v_and_b32 v82, 0xffff0000, v82
    v_and_b32 v83, 0xffff0000, v83
    v_and_b32 v84, 0xffff0000, v84
    buffer_load_dwordx2 v[108:109], v66, s[20:23], s49 offen offset:0
    buffer_load_dwordx2 v[110:111], v66, s[20:23], s49 offen offset:32
    buffer_load_dwordx2 v[112:113], v66, s[20:23], s49 offen offset:384
    buffer_load_dwordx2 v[114:115], v66, s[20:23], s49 offen offset:416
    buffer_load_dwordx2 v[116:117], v66, s[20:23], s49 offen offset:768
    buffer_load_dwordx2 v[118:119], v66, s[20:23], s49 offen offset:800
    s_mov_b32 s20, s58
    s_mov_b32 s21, s59
    s_mov_b32 s22, 4718592
    s_mov_b32 s23, 0x20000
    s_waitcnt vmcnt(10)
    v_lshlrev_b32 v136, 16, v88
    v_and_b32 v137, 0xffff0000, v88
    v_lshlrev_b32 v138, 16, v89
    v_and_b32 v139, 0xffff0000, v89
    v_lshlrev_b32 v140, 16, v90
    v_and_b32 v141, 0xffff0000, v90
    v_lshlrev_b32 v142, 16, v91
    v_and_b32 v143, 0xffff0000, v91
    v_pk_mul_f32 v[128:129], v[136:137], v[80:81] op_sel:[0,0] op_sel_hi:[1,0]
    v_pk_mul_f32 v[130:131], v[138:139], v[80:81] op_sel:[0,0] op_sel_hi:[1,0]
    v_pk_mul_f32 v[132:133], v[140:141], v[80:81] op_sel:[0,0] op_sel_hi:[1,0]
    v_pk_mul_f32 v[134:135], v[142:143], v[80:81] op_sel:[0,0] op_sel_hi:[1,0]
    s_waitcnt vmcnt(9)
    v_lshlrev_b32 v136, 16, v92
    v_and_b32 v137, 0xffff0000, v92
    v_lshlrev_b32 v138, 16, v93
    v_and_b32 v139, 0xffff0000, v93
    v_lshlrev_b32 v140, 16, v94
    v_and_b32 v141, 0xffff0000, v94
    v_lshlrev_b32 v142, 16, v95
    v_and_b32 v143, 0xffff0000, v95
    v_pk_fma_f32 v[128:129], v[136:137], v[80:81], v[128:129] op_sel:[0,1,0] op_sel_hi:[1,1,1]
    v_pk_fma_f32 v[130:131], v[138:139], v[80:81], v[130:131] op_sel:[0,1,0] op_sel_hi:[1,1,1]
    v_pk_fma_f32 v[132:133], v[140:141], v[80:81], v[132:133] op_sel:[0,1,0] op_sel_hi:[1,1,1]
    v_pk_fma_f32 v[134:135], v[142:143], v[80:81], v[134:135] op_sel:[0,1,0] op_sel_hi:[1,1,1]
    s_waitcnt vmcnt(8)
    v_lshlrev_b32 v136, 16, v96
    v_and_b32 v137, 0xffff0000, v96
    v_lshlrev_b32 v138, 16, v97
    v_and_b32 v139, 0xffff0000, v97
    v_lshlrev_b32 v140, 16, v98
    v_and_b32 v141, 0xffff0000, v98
    v_lshlrev_b32 v142, 16, v99
    v_and_b32 v143, 0xffff0000, v99
    v_pk_fma_f32 v[128:129], v[136:137], v[82:83], v[128:129] op_sel:[0,0,0] op_sel_hi:[1,0,1]
    v_pk_fma_f32 v[130:131], v[138:139], v[82:83], v[130:131] op_sel:[0,0,0] op_sel_hi:[1,0,1]
    v_pk_fma_f32 v[132:133], v[140:141], v[82:83], v[132:133] op_sel:[0,0,0] op_sel_hi:[1,0,1]
    v_pk_fma_f32 v[134:135], v[142:143], v[82:83], v[134:135] op_sel:[0,0,0] op_sel_hi:[1,0,1]
    s_waitcnt vmcnt(7)
    v_lshlrev_b32 v136, 16, v100
    v_and_b32 v137, 0xffff0000, v100
    v_lshlrev_b32 v138, 16, v101
    v_and_b32 v139, 0xffff0000, v101
    v_lshlrev_b32 v140, 16, v102
    v_and_b32 v141, 0xffff0000, v102
    v_lshlrev_b32 v142, 16, v103
    v_and_b32 v143, 0xffff0000, v103
    v_pk_fma_f32 v[128:129], v[136:137], v[82:83], v[128:129] op_sel:[0,1,0] op_sel_hi:[1,1,1]
    v_pk_fma_f32 v[130:131], v[138:139], v[82:83], v[130:131] op_sel:[0,1,0] op_sel_hi:[1,1,1]
    v_pk_fma_f32 v[132:133], v[140:141], v[82:83], v[132:133] op_sel:[0,1,0] op_sel_hi:[1,1,1]
    v_pk_fma_f32 v[134:135], v[142:143], v[82:83], v[134:135] op_sel:[0,1,0] op_sel_hi:[1,1,1]
    s_waitcnt vmcnt(6)
    v_lshlrev_b32 v136, 16, v104
    v_and_b32 v137, 0xffff0000, v104
    v_lshlrev_b32 v138, 16, v105
    v_and_b32 v139, 0xffff0000, v105
    v_lshlrev_b32 v140, 16, v106
    v_and_b32 v141, 0xffff0000, v106
    v_lshlrev_b32 v142, 16, v107
    v_and_b32 v143, 0xffff0000, v107
    v_pk_fma_f32 v[128:129], v[136:137], v[84:85], v[128:129] op_sel:[0,0,0] op_sel_hi:[1,0,1]
    v_pk_fma_f32 v[130:131], v[138:139], v[84:85], v[130:131] op_sel:[0,0,0] op_sel_hi:[1,0,1]
    v_pk_fma_f32 v[132:133], v[140:141], v[84:85], v[132:133] op_sel:[0,0,0] op_sel_hi:[1,0,1]
    v_pk_fma_f32 v[134:135], v[142:143], v[84:85], v[134:135] op_sel:[0,0,0] op_sel_hi:[1,0,1]
    s_nop 0
    v_permlane32_swap_b32 v128, v132
    v_permlane32_swap_b32 v129, v133
    v_permlane32_swap_b32 v130, v134
    v_permlane32_swap_b32 v131, v135
    v_and_b32 v72, 1, v1
    v_pk_add_f32 v[128:129], v[128:129], v[132:133]
    v_pk_add_f32 v[130:131], v[130:131], v[134:135]
    v_lshlrev_b32 v72, 5, v72
    v_lshrrev_b32 v73, 4, v1
    v_permlane16_swap_b32 v128, v130
    v_permlane16_swap_b32 v129, v131
    v_lshl_add_u32 v72, v73, 3, v72
    v_pk_add_f32 v[128:129], v[128:129], v[130:131]
    s_lshl_b32 s36, s3, 6
    v_add_u32 v72, s36, v72
    v_add_f32_dpp v128, v128, v128 row_ror:2 row_mask:0xf bank_mask:0xf
    v_add_f32_dpp v129, v129, v129 row_ror:2 row_mask:0xf bank_mask:0xf
    s_nop 0
    v_add_f32_dpp v128, v128, v128 row_ror:4 row_mask:0xf bank_mask:0xf
    v_add_f32_dpp v129, v129, v129 row_ror:4 row_mask:0xf bank_mask:0xf
    s_nop 0
    v_add_f32_dpp v128, v128, v128 row_ror:8 row_mask:0xf bank_mask:0xf
    v_add_f32_dpp v129, v129, v129 row_ror:8 row_mask:0xf bank_mask:0xf
    ds_write_b64 v72, v[128:129] offset:0
    v_and_b32 v73, 7, v1
    v_lshlrev_b32 v73, 3, v73
    s_waitcnt lgkmcnt(0)
    s_barrier
    ds_read_b64 v[128:129], v73 offset:0
    ds_read_b64 v[130:131], v73 offset:64
    ds_read_b64 v[132:133], v73 offset:128
    ds_read_b64 v[134:135], v73 offset:192
    s_add_u32 s95, s94, 0x9e3779b9
    v_mov_b32 v137, s95
    s_mov_b32 s37, 32768
    s_waitcnt lgkmcnt(2)
    v_pk_add_f32 v[128:129], v[128:129], v[130:131]
    s_waitcnt lgkmcnt(0)
    v_pk_add_f32 v[132:133], v[132:133], v[134:135]
    v_pk_add_f32 v[128:129], v[128:129], v[132:133]
    v_cvt_pk_bf16_f32 v136, v128, v129
    v_lshlrev_b32 v128, 16, v136
    v_and_b32 v129, 0xffff0000, v136
    v_add_f32 v128, s93, v128
    v_add_f32 v129, s93, v129
    v_cvt_pk_bf16_f32 v136, v128, v129
    buffer_store_dwordx2 v[136:137], v69, s[24:27], s37 offen sc1
    s_mul_i32 s36, s3, 72
    v_add_u32 v122, s36, v1
    v_and_b32 v123, 7, v1
    s_add_u32 s36, s36, 64
    v_add_u32 v123, s36, v123
    s_movk_i32 s36, 1024
    v_and_b32 v76, 3, v122
    v_lshlrev_b32 v76, 4, v76
    v_lshrrev_b32 v122, 2, v122
    v_lshl_add_u32 v124, v122, 7, v76
    v_and_b32 v77, 1, v122
    v_lshl_add_u32 v76, v77, 3, v76
    v_lshrrev_b32 v122, 1, v122
    v_lshl_add_u32 v122, v122, 6, v76
    v_add_u32 v122, s36, v122
    v_and_b32 v76, 3, v123
    v_lshlrev_b32 v76, 4, v76
    v_lshrrev_b32 v123, 2, v123
    v_lshl_add_u32 v125, v123, 7, v76
    v_and_b32 v77, 1, v123
    v_lshl_add_u32 v76, v77, 3, v76
    v_lshrrev_b32 v123, 1, v123
    v_lshl_add_u32 v123, v123, 6, v76
    v_add_u32 v123, s36, v123
    s_mov_b64 exec, 0
    s_cmp_eq_u32 s3, 0
    s_cbranch_scc1 Ltour0_0
    s_cmp_eq_u32 s3, 1
    s_cbranch_scc1 Ltour0_1
    s_cmp_eq_u32 s3, 2
    s_cbranch_scc1 Ltour0_2
    s_branch Ltour0_3
.p2align 12
Lmain0:
    s_mov_b64 exec, -1
    s_waitcnt vmcnt(6)
    v_lshlrev_b32 v144, 16, v108
    v_and_b32 v145, 0xffff0000, v108
    v_lshlrev_b32 v146, 16, v109
    v_and_b32 v147, 0xffff0000, v109
    s_waitcnt vmcnt(5)
    v_lshlrev_b32 v148, 16, v110
    v_and_b32 v149, 0xffff0000, v110
    v_lshlrev_b32 v150, 16, v111
    v_and_b32 v151, 0xffff0000, v111
    s_waitcnt vmcnt(4)
    v_lshlrev_b32 v152, 16, v112
    v_and_b32 v153, 0xffff0000, v112
    v_lshlrev_b32 v154, 16, v113
    v_and_b32 v155, 0xffff0000, v113
    s_waitcnt vmcnt(3)
    v_lshlrev_b32 v156, 16, v114
    v_and_b32 v157, 0xffff0000, v114
    v_lshlrev_b32 v158, 16, v115
    v_and_b32 v159, 0xffff0000, v115
    s_waitcnt vmcnt(2)
    v_lshlrev_b32 v160, 16, v116
    v_and_b32 v161, 0xffff0000, v116
    v_lshlrev_b32 v162, 16, v117
    v_and_b32 v163, 0xffff0000, v117
    s_waitcnt vmcnt(1)
    v_lshlrev_b32 v164, 16, v118
    v_and_b32 v165, 0xffff0000, v118
    v_lshlrev_b32 v166, 16, v119
    v_and_b32 v167, 0xffff0000, v119
    buffer_load_dword v242, v71, s[16:19], s44 offen
    v_pk_add_f32 v[72:73], v[144:145], v[148:149]
    v_pk_add_f32 v[76:77], v[146:147], v[150:151]
    v_pk_add_f32 v[72:73], v[72:73], v[152:153]
    v_pk_add_f32 v[76:77], v[76:77], v[154:155]
    v_pk_add_f32 v[72:73], v[72:73], v[156:157]
    v_pk_add_f32 v[76:77], v[76:77], v[158:159]
    v_pk_add_f32 v[72:73], v[72:73], v[160:161]
    v_pk_add_f32 v[76:77], v[76:77], v[162:163]
    v_pk_add_f32 v[72:73], v[72:73], v[164:165]
    v_pk_add_f32 v[76:77], v[76:77], v[166:167]
    v_pk_add_f32 v[72:73], v[72:73], v[76:77]
    v_add_f32 v72, v72, v73
    s_nop 1
    v_add_f32_dpp v72, v72, v72 row_ror:8 row_mask:0xf bank_mask:0xf
    s_nop 1
    v_add_f32_dpp v72, v72, v72 row_ror:4 row_mask:0xf bank_mask:0xf
    s_nop 1
    v_add_f32_dpp v72, v72, v72 row_ror:2 row_mask:0xf bank_mask:0xf
    s_nop 1
    v_add_f32_dpp v72, v72, v72 row_ror:1 row_mask:0xf bank_mask:0xf
    v_mov_b32 v76, v72
    s_nop 1
    v_permlane16_swap_b32 v72, v76
    s_nop 0
    v_add_f32 v72, v72, v76
    v_mul_f32 v72, 0x3ae38e39, v72
    v_pk_add_f32 v[168:169], v[144:145], v[72:73] op_sel_hi:[1,0] neg_lo:[0,1] neg_hi:[0,1]
    v_pk_add_f32 v[170:171], v[146:147], v[72:73] op_sel_hi:[1,0] neg_lo:[0,1] neg_hi:[0,1]
    v_pk_add_f32 v[172:173], v[148:149], v[72:73] op_sel_hi:[1,0] neg_lo:[0,1] neg_hi:[0,1]
    v_pk_add_f32 v[174:175], v[150:151], v[72:73] op_sel_hi:[1,0] neg_lo:[0,1] neg_hi:[0,1]
    v_pk_add_f32 v[176:177], v[152:153], v[72:73] op_sel_hi:[1,0] neg_lo:[0,1] neg_hi:[0,1]
    v_pk_add_f32 v[178:179], v[154:155], v[72:73] op_sel_hi:[1,0] neg_lo:[0,1] neg_hi:[0,1]
    v_pk_add_f32 v[180:181], v[156:157], v[72:73] op_sel_hi:[1,0] neg_lo:[0,1] neg_hi:[0,1]
    v_pk_add_f32 v[182:183], v[158:159], v[72:73] op_sel_hi:[1,0] neg_lo:[0,1] neg_hi:[0,1]
    v_pk_add_f32 v[184:185], v[160:161], v[72:73] op_sel_hi:[1,0] neg_lo:[0,1] neg_hi:[0,1]
    v_pk_add_f32 v[186:187], v[162:163], v[72:73] op_sel_hi:[1,0] neg_lo:[0,1] neg_hi:[0,1]
    v_pk_add_f32 v[188:189], v[164:165], v[72:73] op_sel_hi:[1,0] neg_lo:[0,1] neg_hi:[0,1]
    v_pk_add_f32 v[190:191], v[166:167], v[72:73] op_sel_hi:[1,0] neg_lo:[0,1] neg_hi:[0,1]
    v_pk_mul_f32 v[74:75], v[168:169], v[168:169]
    v_pk_mul_f32 v[76:77], v[170:171], v[170:171]
    v_pk_fma_f32 v[74:75], v[172:173], v[172:173], v[74:75]
    v_pk_fma_f32 v[76:77], v[174:175], v[174:175], v[76:77]
    v_pk_fma_f32 v[74:75], v[176:177], v[176:177], v[74:75]
    v_pk_fma_f32 v[76:77], v[178:179], v[178:179], v[76:77]
    v_pk_fma_f32 v[74:75], v[180:181], v[180:181], v[74:75]
    v_pk_fma_f32 v[76:77], v[182:183], v[182:183], v[76:77]
    v_pk_fma_f32 v[74:75], v[184:185], v[184:185], v[74:75]
    v_pk_fma_f32 v[76:77], v[186:187], v[186:187], v[76:77]
    v_pk_fma_f32 v[74:75], v[188:189], v[188:189], v[74:75]
    v_pk_fma_f32 v[76:77], v[190:191], v[190:191], v[76:77]
    v_pk_add_f32 v[74:75], v[74:75], v[76:77]
    v_add_f32 v74, v74, v75
    v_cndmask_b32 v74, 0, v74, vcc
    s_nop 1
    v_add_f32_dpp v74, v74, v74 row_ror:8 row_mask:0xf bank_mask:0xf
    s_nop 1
    v_add_f32_dpp v74, v74, v74 row_ror:4 row_mask:0xf bank_mask:0xf
    s_nop 1
    v_add_f32_dpp v74, v74, v74 row_ror:2 row_mask:0xf bank_mask:0xf
    s_nop 1
    v_add_f32_dpp v74, v74, v74 row_ror:1 row_mask:0xf bank_mask:0xf
    v_mov_b32 v76, v74
    s_nop 1
    v_permlane16_swap_b32 v74, v76
    s_nop 0
    v_add_f32 v74, v74, v76
    v_mul_f32 v74, 0x3ae38e39, v74
    v_cvt_pk_bf16_f32 v76, v72, v74
    v_and_b32 v74, 0xffff0000, v76
    v_lshlrev_b32 v72, 16, v76
    v_add_f32 v74, 0x3727c5ac, v74
    v_cvt_pk_bf16_f32 v74, v74, v74
    v_and_b32 v74, 0xffff0000, v74
    v_sqrt_f32 v74, v74
    v_pk_add_f32 v[168:169], v[144:145], v[72:73] op_sel_hi:[1,0] neg_lo:[0,1] neg_hi:[0,1]
    v_pk_add_f32 v[170:171], v[146:147], v[72:73] op_sel_hi:[1,0] neg_lo:[0,1] neg_hi:[0,1]
    v_pk_add_f32 v[172:173], v[148:149], v[72:73] op_sel_hi:[1,0] neg_lo:[0,1] neg_hi:[0,1]
    v_pk_add_f32 v[174:175], v[150:151], v[72:73] op_sel_hi:[1,0] neg_lo:[0,1] neg_hi:[0,1]
    v_pk_add_f32 v[176:177], v[152:153], v[72:73] op_sel_hi:[1,0] neg_lo:[0,1] neg_hi:[0,1]
    v_pk_add_f32 v[178:179], v[154:155], v[72:73] op_sel_hi:[1,0] neg_lo:[0,1] neg_hi:[0,1]
    v_pk_add_f32 v[180:181], v[156:157], v[72:73] op_sel_hi:[1,0] neg_lo:[0,1] neg_hi:[0,1]
    v_pk_add_f32 v[182:183], v[158:159], v[72:73] op_sel_hi:[1,0] neg_lo:[0,1] neg_hi:[0,1]
    v_pk_add_f32 v[184:185], v[160:161], v[72:73] op_sel_hi:[1,0] neg_lo:[0,1] neg_hi:[0,1]
    v_pk_add_f32 v[186:187], v[162:163], v[72:73] op_sel_hi:[1,0] neg_lo:[0,1] neg_hi:[0,1]
    v_pk_add_f32 v[188:189], v[164:165], v[72:73] op_sel_hi:[1,0] neg_lo:[0,1] neg_hi:[0,1]
    v_pk_add_f32 v[190:191], v[166:167], v[72:73] op_sel_hi:[1,0] neg_lo:[0,1] neg_hi:[0,1]
    v_cvt_pk_bf16_f32 v74, v74, v74
    v_and_b32 v74, 0xffff0000, v74
    v_rcp_f32 v74, v74
    v_cvt_pk_bf16_f32 v108, v168, v169
    v_cvt_pk_bf16_f32 v109, v170, v171
    v_cvt_pk_bf16_f32 v110, v172, v173
    v_cvt_pk_bf16_f32 v111, v174, v175
    v_cvt_pk_bf16_f32 v112, v176, v177
    v_cvt_pk_bf16_f32 v113, v178, v179
    v_cvt_pk_bf16_f32 v114, v180, v181
    v_cvt_pk_bf16_f32 v115, v182, v183
    v_cvt_pk_bf16_f32 v116, v184, v185
    v_cvt_pk_bf16_f32 v117, v186, v187
    v_cvt_pk_bf16_f32 v118, v188, v189
    v_cvt_pk_bf16_f32 v119, v190, v191
    v_lshlrev_b32 v168, 16, v108
    v_and_b32 v169, 0xffff0000, v108
    v_lshlrev_b32 v170, 16, v109
    v_and_b32 v171, 0xffff0000, v109
    v_lshlrev_b32 v172, 16, v110
    v_and_b32 v173, 0xffff0000, v110
    v_lshlrev_b32 v174, 16, v111
    v_and_b32 v175, 0xffff0000, v111
    v_lshlrev_b32 v176, 16, v112
    v_and_b32 v177, 0xffff0000, v112
    v_lshlrev_b32 v178, 16, v113
    v_and_b32 v179, 0xffff0000, v113
    v_lshlrev_b32 v180, 16, v114
    v_and_b32 v181, 0xffff0000, v114
    v_lshlrev_b32 v182, 16, v115
    v_and_b32 v183, 0xffff0000, v115
    v_lshlrev_b32 v184, 16, v116
    v_and_b32 v185, 0xffff0000, v116
    v_lshlrev_b32 v186, 16, v117
    v_and_b32 v187, 0xffff0000, v117
    v_lshlrev_b32 v188, 16, v118
    v_and_b32 v189, 0xffff0000, v118
    v_lshlrev_b32 v190, 16, v119
    v_and_b32 v191, 0xffff0000, v119
    v_pk_mul_f32 v[168:169], v[168:169], v[74:75] op_sel_hi:[1,0]
    v_pk_mul_f32 v[170:171], v[170:171], v[74:75] op_sel_hi:[1,0]
    v_pk_mul_f32 v[172:173], v[172:173], v[74:75] op_sel_hi:[1,0]
    v_pk_mul_f32 v[174:175], v[174:175], v[74:75] op_sel_hi:[1,0]
    v_pk_mul_f32 v[176:177], v[176:177], v[74:75] op_sel_hi:[1,0]
    v_pk_mul_f32 v[178:179], v[178:179], v[74:75] op_sel_hi:[1,0]
    v_pk_mul_f32 v[180:181], v[180:181], v[74:75] op_sel_hi:[1,0]
    v_pk_mul_f32 v[182:183], v[182:183], v[74:75] op_sel_hi:[1,0]
    v_pk_mul_f32 v[184:185], v[184:185], v[74:75] op_sel_hi:[1,0]
    v_pk_mul_f32 v[186:187], v[186:187], v[74:75] op_sel_hi:[1,0]
    v_pk_mul_f32 v[188:189], v[188:189], v[74:75] op_sel_hi:[1,0]
    v_pk_mul_f32 v[190:191], v[190:191], v[74:75] op_sel_hi:[1,0]
    v_cvt_pk_bf16_f32 v108, v168, v169
    v_cvt_pk_bf16_f32 v109, v170, v171
    v_cvt_pk_bf16_f32 v110, v172, v173
    v_cvt_pk_bf16_f32 v111, v174, v175
    v_cvt_pk_bf16_f32 v112, v176, v177
    v_cvt_pk_bf16_f32 v113, v178, v179
    v_cvt_pk_bf16_f32 v114, v180, v181
    v_cvt_pk_bf16_f32 v115, v182, v183
    v_cvt_pk_bf16_f32 v116, v184, v185
    v_cvt_pk_bf16_f32 v117, v186, v187
    v_cvt_pk_bf16_f32 v118, v188, v189
    v_cvt_pk_bf16_f32 v119, v190, v191
    v_lshlrev_b32 v168, 16, v108
    v_and_b32 v169, 0xffff0000, v108
    v_lshlrev_b32 v170, 16, v109
    v_and_b32 v171, 0xffff0000, v109
    v_lshlrev_b32 v172, 16, v110
    v_and_b32 v173, 0xffff0000, v110
    v_lshlrev_b32 v174, 16, v111
    v_and_b32 v175, 0xffff0000, v111
    v_lshlrev_b32 v176, 16, v112
    v_and_b32 v177, 0xffff0000, v112
    v_lshlrev_b32 v178, 16, v113
    v_and_b32 v179, 0xffff0000, v113
    v_lshlrev_b32 v180, 16, v114
    v_and_b32 v181, 0xffff0000, v114
    v_lshlrev_b32 v182, 16, v115
    v_and_b32 v183, 0xffff0000, v115
    v_lshlrev_b32 v184, 16, v116
    v_and_b32 v185, 0xffff0000, v116
    v_lshlrev_b32 v186, 16, v117
    v_and_b32 v187, 0xffff0000, v117
    v_lshlrev_b32 v188, 16, v118
    v_and_b32 v189, 0xffff0000, v118
    v_lshlrev_b32 v190, 16, v119
    v_and_b32 v191, 0xffff0000, v119
    s_mov_b32 s38, 262144
Lhead_pollm:
    buffer_load_dwordx4 v[88:91], v124, s[24:27], s37 offen sc1
    buffer_load_dwordx4 v[92:95], v125, s[24:27], s37 offen sc1
    s_waitcnt vmcnt(0)
    s_sub_u32 s38, s38, 1
    s_cbranch_scc1 Lhead_gotm
    v_xor_b32 v89, s95, v89
    v_xor_b32 v91, s95, v91
    v_xor_b32 v93, s95, v93
    v_xor_b32 v95, s95, v95
    v_or3_b32 v89, v89, v91, v93
    v_or_b32 v89, v89, v95
    v_cmp_ne_u32 vcc, 0, v89
    s_cbranch_vccnz Lhead_pollm
Lhead_gotm:
    ds_write2_b32 v122, v88, v90 offset0:0 offset1:1
    ds_write2_b32 v123, v92, v94 offset0:0 offset1:1
    s_waitcnt lgkmcnt(0)
    s_barrier
    ds_read_b128 v[144:147], v68 offset:2176
    ds_read_b128 v[156:159], v68 offset:1024
    ds_read_b128 v[148:151], v68 offset:2560
    ds_read_b128 v[160:163], v68 offset:1408
    ds_read_b128 v[152:155], v68 offset:2944
    ds_read_b128 v[164:167], v68 offset:1792
    s_waitcnt lgkmcnt(5)
    v_lshlrev_b32 v192, 16, v144
    v_and_b32 v193, 0xffff0000, v144
    v_lshlrev_b32 v194, 16, v145
    v_and_b32 v195, 0xffff0000, v145
    v_lshlrev_b32 v196, 16, v146
    v_and_b32 v197, 0xffff0000, v146
    v_lshlrev_b32 v198, 16, v147
    v_and_b32 v199, 0xffff0000, v147
    v_pk_mul_f32 v[168:169], v[168:169], v[192:193]
    v_pk_mul_f32 v[170:171], v[170:171], v[194:195]
    v_pk_mul_f32 v[172:173], v[172:173], v[196:197]
    v_pk_mul_f32 v[174:175], v[174:175], v[198:199]
    v_cvt_pk_bf16_f32 v108, v168, v169
    v_cvt_pk_bf16_f32 v109, v170, v171
    v_cvt_pk_bf16_f32 v110, v172, v173
    v_cvt_pk_bf16_f32 v111, v174, v175
    s_waitcnt lgkmcnt(4)
    v_lshlrev_b32 v216, 16, v156
    v_and_b32 v217, 0xffff0000, v156
    v_lshlrev_b32 v218, 16, v157
    v_and_b32 v219, 0xffff0000, v157
    v_lshlrev_b32 v220, 16, v158
    v_and_b32 v221, 0xffff0000, v158
    v_lshlrev_b32 v222, 16, v159
    v_and_b32 v223, 0xffff0000, v159
    v_lshlrev_b32 v168, 16, v108
    v_and_b32 v169, 0xffff0000, v108
    v_lshlrev_b32 v170, 16, v109
    v_and_b32 v171, 0xffff0000, v109
    v_lshlrev_b32 v172, 16, v110
    v_and_b32 v173, 0xffff0000, v110
    v_lshlrev_b32 v174, 16, v111
    v_and_b32 v175, 0xffff0000, v111
    v_pk_add_f32 v[168:169], v[168:169], v[216:217]
    v_pk_add_f32 v[170:171], v[170:171], v[218:219]
    v_pk_add_f32 v[172:173], v[172:173], v[220:221]
    v_pk_add_f32 v[174:175], v[174:175], v[222:223]
    v_cvt_pk_bf16_f32 v108, v168, v169
    v_cvt_pk_bf16_f32 v109, v170, v171
    v_cvt_pk_bf16_f32 v110, v172, v173
    v_cvt_pk_bf16_f32 v111, v174, v175
    buffer_store_dwordx4 v[108:111], v67, s[24:27], s92 offen offset:0 sc1
    s_waitcnt lgkmcnt(3)
    v_lshlrev_b32 v200, 16, v148
    v_and_b32 v201, 0xffff0000, v148
    v_lshlrev_b32 v202, 16, v149
    v_and_b32 v203, 0xffff0000, v149
    v_lshlrev_b32 v204, 16, v150
    v_and_b32 v205, 0xffff0000, v150
    v_lshlrev_b32 v206, 16, v151
    v_and_b32 v207, 0xffff0000, v151
    v_pk_mul_f32 v[176:177], v[176:177], v[200:201]
    v_pk_mul_f32 v[178:179], v[178:179], v[202:203]
    v_pk_mul_f32 v[180:181], v[180:181], v[204:205]
    v_pk_mul_f32 v[182:183], v[182:183], v[206:207]
    v_cvt_pk_bf16_f32 v112, v176, v177
    v_cvt_pk_bf16_f32 v113, v178, v179
    v_cvt_pk_bf16_f32 v114, v180, v181
    v_cvt_pk_bf16_f32 v115, v182, v183
    s_waitcnt lgkmcnt(2)
    v_lshlrev_b32 v224, 16, v160
    v_and_b32 v225, 0xffff0000, v160
    v_lshlrev_b32 v226, 16, v161
    v_and_b32 v227, 0xffff0000, v161
    v_lshlrev_b32 v228, 16, v162
    v_and_b32 v229, 0xffff0000, v162
    v_lshlrev_b32 v230, 16, v163
    v_and_b32 v231, 0xffff0000, v163
    v_lshlrev_b32 v176, 16, v112
    v_and_b32 v177, 0xffff0000, v112
    v_lshlrev_b32 v178, 16, v113
    v_and_b32 v179, 0xffff0000, v113
    v_lshlrev_b32 v180, 16, v114
    v_and_b32 v181, 0xffff0000, v114
    v_lshlrev_b32 v182, 16, v115
    v_and_b32 v183, 0xffff0000, v115
    v_pk_add_f32 v[176:177], v[176:177], v[224:225]
    v_pk_add_f32 v[178:179], v[178:179], v[226:227]
    v_pk_add_f32 v[180:181], v[180:181], v[228:229]
    v_pk_add_f32 v[182:183], v[182:183], v[230:231]
    v_cvt_pk_bf16_f32 v112, v176, v177
    v_cvt_pk_bf16_f32 v113, v178, v179
    v_cvt_pk_bf16_f32 v114, v180, v181
    v_cvt_pk_bf16_f32 v115, v182, v183
    buffer_store_dwordx4 v[112:115], v67, s[24:27], s92 offen offset:768 sc1
    s_waitcnt lgkmcnt(1)
    v_lshlrev_b32 v208, 16, v152
    v_and_b32 v209, 0xffff0000, v152
    v_lshlrev_b32 v210, 16, v153
    v_and_b32 v211, 0xffff0000, v153
    v_lshlrev_b32 v212, 16, v154
    v_and_b32 v213, 0xffff0000, v154
    v_lshlrev_b32 v214, 16, v155
    v_and_b32 v215, 0xffff0000, v155
    v_pk_mul_f32 v[184:185], v[184:185], v[208:209]
    v_pk_mul_f32 v[186:187], v[186:187], v[210:211]
    v_pk_mul_f32 v[188:189], v[188:189], v[212:213]
    v_pk_mul_f32 v[190:191], v[190:191], v[214:215]
    v_cvt_pk_bf16_f32 v116, v184, v185
    v_cvt_pk_bf16_f32 v117, v186, v187
    v_cvt_pk_bf16_f32 v118, v188, v189
    v_cvt_pk_bf16_f32 v119, v190, v191
    s_waitcnt lgkmcnt(0)
    v_lshlrev_b32 v232, 16, v164
    v_and_b32 v233, 0xffff0000, v164
    v_lshlrev_b32 v234, 16, v165
    v_and_b32 v235, 0xffff0000, v165
    v_lshlrev_b32 v236, 16, v166
    v_and_b32 v237, 0xffff0000, v166
    v_lshlrev_b32 v238, 16, v167
    v_and_b32 v239, 0xffff0000, v167
    v_lshlrev_b32 v184, 16, v116
    v_and_b32 v185, 0xffff0000, v116
    v_lshlrev_b32 v186, 16, v117
    v_and_b32 v187, 0xffff0000, v117
    v_lshlrev_b32 v188, 16, v118
    v_and_b32 v189, 0xffff0000, v118
    v_lshlrev_b32 v190, 16, v119
    v_and_b32 v191, 0xffff0000, v119
    v_pk_add_f32 v[184:185], v[184:185], v[232:233]
    v_pk_add_f32 v[186:187], v[186:187], v[234:235]
    v_pk_add_f32 v[188:189], v[188:189], v[236:237]
    v_pk_add_f32 v[190:191], v[190:191], v[238:239]
    v_cvt_pk_bf16_f32 v116, v184, v185
    v_cvt_pk_bf16_f32 v117, v186, v187
    v_cvt_pk_bf16_f32 v118, v188, v189
    v_cvt_pk_bf16_f32 v119, v190, v191
    buffer_store_dwordx4 v[116:119], v67, s[24:27], s92 offen offset:1536 sc1
    s_lshl_b32 s36, s5, 13
    s_add_u32 s36, s36, 8650752
    s_lshl_b32 s37, s4, 9
    s_add_u32 s37, s37, s36
    s_lshl_b32 s38, s3, 7
    s_add_u32 s37, s37, s38
    s_lshl_b32 s38, s3, 11
    s_add_u32 s36, s36, s38
    v_min_u32 v72, 1, v1
    v_lshlrev_b32 v72, 31, v72
    v_and_b32 v73, 15, v1
    v_lshlrev_b32 v73, 7, v73
    v_cmp_gt_u32 vcc, 162, v0
    v_mov_b32 v88, -1
    v_mov_b32 v89, -1
    v_mov_b32 v90, -1
    v_mov_b32 v91, -1
    s_mul_i32 s39, s2, 2592
    s_add_u32 s39, s39, 7864320
    v_lshl_add_u32 v74, v0, 4, s39
    s_lshl_b32 s39, s2, 7
    s_add_u32 s39, s39, 9306112
    v_mov_b32 v75, s39
    v_cndmask_b32 v74, v75, v74, vcc
    s_lshl_b32 s92, s5, 13
    s_add_u32 s92, s92, 8781824
    s_add_u32 s92, s92, s38
    s_lshl_b32 s38, s4, 7
    s_add_u32 s92, s92, s38
    s_getreg_b32 s38, hwreg(HW_REG_XCC_ID, 0, 4)
    s_lshl_b32 s38, s38, 28
    s_xor_b32 s38, s38, s95
    v_mov_b32 v76, s38
    v_mov_b32 v2, v80
    v_mov_b32 v3, v81
    v_mov_b32 v4, v82
    v_mov_b32 v5, v83
    v_mov_b32 v6, v84
    v_mov_b32 v7, v65
    v_and_b32 v126, 31, v1
    v_lshlrev_b32 v126, 2, v126
    s_add_u32 s49, s44, 0
    s_add_u32 m0, s42, 32768
    s_nop 0
    buffer_load_dwordx4 v42, s[16:19], s49 offen lds
    buffer_load_dwordx4 v43, s[16:19], s49 offen offset:1024 lds
    buffer_load_dwordx4 v44, s[16:19], s49 offen offset:2048 lds
    buffer_load_dwordx4 v45, s[16:19], s49 offen offset:3072 lds
    s_add_u32 s49, s44, 256
    s_add_u32 m0, s42, 49152
    s_nop 0
    buffer_load_dwordx4 v42, s[16:19], s49 offen lds
    buffer_load_dwordx4 v43, s[16:19], s49 offen offset:1024 lds
    buffer_load_dwordx4 v44, s[16:19], s49 offen offset:2048 lds
    buffer_load_dwordx4 v45, s[16:19], s49 offen offset:3072 lds
    s_waitcnt vmcnt(8)
    buffer_store_dword v137, v126, s[24:27], s37 offen sc1
    s_add_u32 s49, s44, 524288
    s_add_u32 m0, s42, 65536
    s_nop 0
    buffer_load_dwordx4 v42, s[16:19], s49 offen lds
    buffer_load_dwordx4 v43, s[16:19], s49 offen offset:1024 lds
    buffer_load_dwordx4 v44, s[16:19], s49 offen offset:2048 lds
    buffer_load_dwordx4 v45, s[16:19], s49 offen offset:3072 lds
    s_add_u32 s49, s44, 524544
    s_add_u32 m0, s42, 81920
    s_nop 0
    buffer_load_dwordx4 v42, s[16:19], s49 offen lds
    buffer_load_dwordx4 v43, s[16:19], s49 offen offset:1024 lds
    buffer_load_dwordx4 v44, s[16:19], s49 offen offset:2048 lds
    buffer_load_dwordx4 v45, s[16:19], s49 offen offset:3072 lds
    s_add_u32 s49, s44, 1048576
    s_add_u32 m0, s42, 98304
    s_nop 0
    buffer_load_dwordx4 v42, s[16:19], s49 offen lds
    buffer_load_dwordx4 v43, s[16:19], s49 offen offset:1024 lds
    buffer_load_dwordx4 v44, s[16:19], s49 offen offset:2048 lds
    buffer_load_dwordx4 v45, s[16:19], s49 offen offset:3072 lds
    s_add_u32 s49, s44, 1048832
    s_add_u32 m0, s42, 114688
    s_nop 0
    buffer_load_dwordx4 v42, s[16:19], s49 offen lds
    buffer_load_dwordx4 v43, s[16:19], s49 offen offset:1024 lds
    buffer_load_dwordx4 v44, s[16:19], s49 offen offset:2048 lds
    buffer_load_dwordx4 v45, s[16:19], s49 offen offset:3072 lds
    s_add_u32 s49, s44, 1572864
    s_add_u32 m0, s42, 131072
    s_nop 0
    buffer_load_dwordx4 v42, s[16:19], s49 offen lds
    buffer_load_dwordx4 v43, s[16:19], s49 offen offset:1024 lds
    buffer_load_dwordx4 v44, s[16:19], s49 offen offset:2048 lds
    buffer_load_dwordx4 v45, s[16:19], s49 offen offset:3072 lds
    s_add_u32 s49, s44, 1573120
    s_add_u32 m0, s42, 147456
    s_nop 0
    buffer_load_dwordx4 v42, s[16:19], s49 offen lds
    buffer_load_dwordx4 v43, s[16:19], s49 offen offset:1024 lds
    buffer_load_dwordx4 v44, s[16:19], s49 offen offset:2048 lds
    buffer_load_dwordx4 v45, s[16:19], s49 offen offset:3072 lds
    s_mov_b32 s38, 262144
Lhead_pollh:
    buffer_load_dword v75, v73, s[24:27], s36 offen sc1
    s_sub_u32 s38, s38, 1
    s_cbranch_scc1 Lhead_goth
    s_waitcnt vmcnt(0) lgkmcnt(0)
    v_cmp_ne_u32 vcc, s95, v75
    s_cbranch_vccnz Lhead_pollh
Lhead_goth:
    s_waitcnt vmcnt(0) lgkmcnt(0)
    buffer_load_dwordx4 a[0:3], v51, s[24:27], s46 offen offset:0 sc1
    buffer_load_dwordx4 a[8:11], v51, s[24:27], s46 offen offset:128 sc1
    buffer_load_dwordx4 a[4:7], v51, s[24:27], s43 offen offset:0 sc1
    buffer_load_dwordx4 a[12:15], v51, s[24:27], s43 offen offset:128 sc1
    s_barrier
    ds_read_b64_tr_b16 a[160:161], v12 offset:32768
    ds_read_b64_tr_b16 a[162:163], v12 offset:36864
    ds_read_b64_tr_b16 a[164:165], v12 offset:40960
    ds_read_b64_tr_b16 a[166:167], v12 offset:45056
    ds_read_b64_tr_b16 a[168:169], v13 offset:32768
    ds_read_b64_tr_b16 a[170:171], v13 offset:36864
    ds_read_b64_tr_b16 a[172:173], v13 offset:40960
    ds_read_b64_tr_b16 a[174:175], v13 offset:45056
    ds_read_b64_tr_b16 a[176:177], v14 offset:32768
    ds_read_b64_tr_b16 a[178:179], v14 offset:36864
    ds_read_b64_tr_b16 a[180:181], v14 offset:40960
    ds_read_b64_tr_b16 a[182:183], v14 offset:45056
    buffer_load_dwordx4 a[16:19], v51, s[24:27], s46 offen offset:256 sc1
    buffer_load_dwordx4 a[24:27], v51, s[24:27], s46 offen offset:384 sc1
    buffer_load_dwordx4 a[20:23], v51, s[24:27], s43 offen offset:256 sc1
    buffer_load_dwordx4 a[28:31], v51, s[24:27], s43 offen offset:384 sc1
    s_waitcnt lgkmcnt(10)
    s_waitcnt vmcnt(7)
    v_mfma_f32_16x16x32_bf16 v[128:131], a[160:163], a[0:3], 0
    s_waitcnt vmcnt(6)
    s_waitcnt lgkmcnt(8)
    ds_read_b64_tr_b16 a[184:185], v15 offset:32768
    v_mfma_f32_16x16x32_bf16 v[128:131], a[164:167], a[8:11], v[128:131]
    s_waitcnt vmcnt(4)
    ds_read_b64_tr_b16 a[186:187], v15 offset:36864
    v_mfma_f32_16x16x32_bf16 v[132:135], a[164:167], a[12:15], 0
    ds_read_b64_tr_b16 a[188:189], v15 offset:40960
    v_mfma_f32_16x16x32_bf16 v[132:135], a[160:163], a[4:7], v[132:135]
    s_waitcnt lgkmcnt(9)
    buffer_load_dwordx4 a[32:35], v51, s[24:27], s46 offen offset:512 sc1
    v_mfma_f32_16x16x32_bf16 v[140:143], a[168:171], a[4:7], 0
    s_waitcnt lgkmcnt(7)
    ds_read_b64_tr_b16 a[190:191], v15 offset:45056
    ds_read_b64_tr_b16 a[160:161], v16 offset:32768
    v_mfma_f32_16x16x32_bf16 v[140:143], a[172:175], a[12:15], v[140:143]
    ds_read_b64_tr_b16 a[162:163], v16 offset:36864
    v_mfma_f32_16x16x32_bf16 v[136:139], a[172:175], a[8:11], 0
    ds_read_b64_tr_b16 a[164:165], v16 offset:40960
    v_mfma_f32_16x16x32_bf16 v[136:139], a[168:171], a[0:3], v[136:139]
    s_waitcnt lgkmcnt(9)
    buffer_load_dwordx4 a[40:43], v51, s[24:27], s46 offen offset:640 sc1
    v_mfma_f32_16x16x32_bf16 v[144:147], a[176:179], a[0:3], 0
    s_waitcnt lgkmcnt(7)
    ds_read_b64_tr_b16 a[166:167], v16 offset:45056
    ds_read_b64_tr_b16 a[168:169], v17 offset:32768
    v_mfma_f32_16x16x32_bf16 v[144:147], a[180:183], a[8:11], v[144:147]
    ds_read_b64_tr_b16 a[170:171], v17 offset:36864
    v_mfma_f32_16x16x32_bf16 v[148:151], a[180:183], a[12:15], 0
    ds_read_b64_tr_b16 a[172:173], v17 offset:40960
    v_mfma_f32_16x16x32_bf16 v[148:151], a[176:179], a[4:7], v[148:151]
    s_waitcnt lgkmcnt(9)
    buffer_load_dwordx4 a[36:39], v51, s[24:27], s43 offen offset:512 sc1
    v_mfma_f32_16x16x32_bf16 v[156:159], a[184:187], a[4:7], 0
    s_waitcnt lgkmcnt(7)
    ds_read_b64_tr_b16 a[174:175], v17 offset:45056
    ds_read_b64_tr_b16 a[176:177], v18 offset:32768
    v_mfma_f32_16x16x32_bf16 v[156:159], a[188:191], a[12:15], v[156:159]
    ds_read_b64_tr_b16 a[178:179], v18 offset:36864
    v_mfma_f32_16x16x32_bf16 v[152:155], a[188:191], a[8:11], 0
    ds_read_b64_tr_b16 a[180:181], v18 offset:40960
    v_mfma_f32_16x16x32_bf16 v[152:155], a[184:187], a[0:3], v[152:155]
    s_waitcnt lgkmcnt(9)
    buffer_load_dwordx4 a[44:47], v51, s[24:27], s43 offen offset:640 sc1
    v_mfma_f32_16x16x32_bf16 v[160:163], a[160:163], a[0:3], 0
    s_waitcnt lgkmcnt(7)
    ds_read_b64_tr_b16 a[182:183], v18 offset:45056
    ds_read_b64_tr_b16 a[184:185], v19 offset:32768
    v_mfma_f32_16x16x32_bf16 v[160:163], a[164:167], a[8:11], v[160:163]
    ds_read_b64_tr_b16 a[186:187], v19 offset:36864
    v_mfma_f32_16x16x32_bf16 v[164:167], a[164:167], a[12:15], 0
    ds_read_b64_tr_b16 a[188:189], v19 offset:40960
    v_mfma_f32_16x16x32_bf16 v[164:167], a[160:163], a[4:7], v[164:167]
    s_waitcnt lgkmcnt(9)
    buffer_load_dword v77, v70, s[16:19], s44 offen
    v_mfma_f32_16x16x32_bf16 v[172:175], a[168:171], a[4:7], 0
    s_waitcnt lgkmcnt(7)
    ds_read_b64_tr_b16 a[190:191], v19 offset:45056
    ds_read_b64_tr_b16 a[160:161], v12 offset:49152
    v_mfma_f32_16x16x32_bf16 v[172:175], a[172:175], a[12:15], v[172:175]
    ds_read_b64_tr_b16 a[162:163], v12 offset:53248
    v_mfma_f32_16x16x32_bf16 v[168:171], a[172:175], a[8:11], 0
    ds_read_b64_tr_b16 a[164:165], v12 offset:57344
    v_mfma_f32_16x16x32_bf16 v[168:171], a[168:171], a[0:3], v[168:171]
    s_waitcnt lgkmcnt(9)
    ds_read_b64_tr_b16 a[166:167], v12 offset:61440
    v_mfma_f32_16x16x32_bf16 v[176:179], a[176:179], a[0:3], 0
    s_waitcnt lgkmcnt(8)
    ds_read_b64_tr_b16 a[168:169], v13 offset:49152
    v_mfma_f32_16x16x32_bf16 v[176:179], a[180:183], a[8:11], v[176:179]
    ds_read_b64_tr_b16 a[170:171], v13 offset:53248
    v_mfma_f32_16x16x32_bf16 v[180:183], a[180:183], a[12:15], 0
    ds_read_b64_tr_b16 a[172:173], v13 offset:57344
    v_mfma_f32_16x16x32_bf16 v[180:183], a[176:179], a[4:7], v[180:183]
    s_waitcnt lgkmcnt(9)
    ds_read_b64_tr_b16 a[174:175], v13 offset:61440
    v_mfma_f32_16x16x32_bf16 v[188:191], a[184:187], a[4:7], 0
    s_waitcnt lgkmcnt(8)
    ds_read_b64_tr_b16 a[176:177], v14 offset:49152
    v_mfma_f32_16x16x32_bf16 v[188:191], a[188:191], a[12:15], v[188:191]
    ds_read_b64_tr_b16 a[178:179], v14 offset:53248
    v_mfma_f32_16x16x32_bf16 v[184:187], a[188:191], a[8:11], 0
    ds_read_b64_tr_b16 a[180:181], v14 offset:57344
    v_mfma_f32_16x16x32_bf16 v[184:187], a[184:187], a[0:3], v[184:187]
    s_waitcnt lgkmcnt(9)
    ds_read_b64_tr_b16 a[182:183], v14 offset:61440
    v_mfma_f32_16x16x32_bf16 v[192:195], a[160:163], a[0:3], 0
    s_waitcnt lgkmcnt(8)
    ds_read_b64_tr_b16 a[184:185], v15 offset:49152
    v_mfma_f32_16x16x32_bf16 v[192:195], a[164:167], a[8:11], v[192:195]
    ds_read_b64_tr_b16 a[186:187], v15 offset:53248
    v_mfma_f32_16x16x32_bf16 v[196:199], a[164:167], a[12:15], 0
    ds_read_b64_tr_b16 a[188:189], v15 offset:57344
    v_mfma_f32_16x16x32_bf16 v[196:199], a[160:163], a[4:7], v[196:199]
    s_waitcnt lgkmcnt(9)
    ds_read_b64_tr_b16 a[190:191], v15 offset:61440
    v_mfma_f32_16x16x32_bf16 v[204:207], a[168:171], a[4:7], 0
    s_waitcnt lgkmcnt(8)
    ds_read_b64_tr_b16 a[160:161], v16 offset:49152
    v_mfma_f32_16x16x32_bf16 v[204:207], a[172:175], a[12:15], v[204:207]
    ds_read_b64_tr_b16 a[162:163], v16 offset:53248
    v_mfma_f32_16x16x32_bf16 v[200:203], a[172:175], a[8:11], 0
    ds_read_b64_tr_b16 a[164:165], v16 offset:57344
    v_mfma_f32_16x16x32_bf16 v[200:203], a[168:171], a[0:3], v[200:203]
    s_waitcnt lgkmcnt(9)
    ds_read_b64_tr_b16 a[166:167], v16 offset:61440
    v_mfma_f32_16x16x32_bf16 v[208:211], a[176:179], a[0:3], 0
    s_waitcnt lgkmcnt(8)
    ds_read_b64_tr_b16 a[168:169], v17 offset:49152
    v_mfma_f32_16x16x32_bf16 v[208:211], a[180:183], a[8:11], v[208:211]
    ds_read_b64_tr_b16 a[170:171], v17 offset:53248
    v_mfma_f32_16x16x32_bf16 v[212:215], a[180:183], a[12:15], 0
    ds_read_b64_tr_b16 a[172:173], v17 offset:57344
    v_mfma_f32_16x16x32_bf16 v[212:215], a[176:179], a[4:7], v[212:215]
    s_waitcnt lgkmcnt(9)
    ds_read_b64_tr_b16 a[174:175], v17 offset:61440
    v_mfma_f32_16x16x32_bf16 v[220:223], a[184:187], a[4:7], 0
    s_waitcnt lgkmcnt(8)
    ds_read_b64_tr_b16 a[176:177], v18 offset:49152
    v_mfma_f32_16x16x32_bf16 v[220:223], a[188:191], a[12:15], v[220:223]
    ds_read_b64_tr_b16 a[178:179], v18 offset:53248
    v_mfma_f32_16x16x32_bf16 v[216:219], a[188:191], a[8:11], 0
    ds_read_b64_tr_b16 a[180:181], v18 offset:57344
    v_mfma_f32_16x16x32_bf16 v[216:219], a[184:187], a[0:3], v[216:219]
    s_waitcnt lgkmcnt(9)
    ds_read_b64_tr_b16 a[182:183], v18 offset:61440
    v_mfma_f32_16x16x32_bf16 v[224:227], a[160:163], a[0:3], 0
    s_waitcnt lgkmcnt(8)
    ds_read_b64_tr_b16 a[184:185], v19 offset:49152
Ltour0_0:
    s_cbranch_execz Ltour0_4
    v_mfma_f32_16x16x32_bf16 v[224:227], a[164:167], a[8:11], v[224:227]
    ds_read_b64_tr_b16 a[186:187], v19 offset:53248
    v_mfma_f32_16x16x32_bf16 v[228:231], a[164:167], a[12:15], 0
    ds_read_b64_tr_b16 a[188:189], v19 offset:57344
    v_mfma_f32_16x16x32_bf16 v[228:231], a[160:163], a[4:7], v[228:231]
    s_waitcnt lgkmcnt(9)
    ds_read_b64_tr_b16 a[190:191], v19 offset:61440
    s_barrier
    v_mfma_f32_16x16x32_bf16 v[236:239], a[168:171], a[4:7], 0
    s_waitcnt lgkmcnt(8)
    ds_read_b64_tr_b16 a[160:161], v20 offset:0
    v_mfma_f32_16x16x32_bf16 v[236:239], a[172:175], a[12:15], v[236:239]
    ds_read_b64_tr_b16 a[162:163], v20 offset:4096
    v_mfma_f32_16x16x32_bf16 v[232:235], a[172:175], a[8:11], 0
    ds_read_b64_tr_b16 a[164:165], v20 offset:8192
    v_mfma_f32_16x16x32_bf16 v[232:235], a[168:171], a[0:3], v[232:235]
    s_waitcnt lgkmcnt(9)
    buffer_load_dwordx4 a[48:51], v51, s[24:27], s46 offen offset:768 sc1
    v_mfma_f32_16x16x32_bf16 v[240:243], a[176:179], a[0:3], 0
    s_waitcnt lgkmcnt(7)
    ds_read_b64_tr_b16 a[166:167], v20 offset:12288
    ds_read_b64_tr_b16 a[168:169], v21 offset:0
    v_mfma_f32_16x16x32_bf16 v[240:243], a[180:183], a[8:11], v[240:243]
    ds_read_b64_tr_b16 a[170:171], v21 offset:4096
    v_mfma_f32_16x16x32_bf16 v[244:247], a[180:183], a[12:15], 0
    ds_read_b64_tr_b16 a[172:173], v21 offset:8192
    v_mfma_f32_16x16x32_bf16 v[244:247], a[176:179], a[4:7], v[244:247]
    s_waitcnt lgkmcnt(9)
    buffer_load_dwordx4 a[56:59], v51, s[24:27], s46 offen offset:896 sc1
    v_mfma_f32_16x16x32_bf16 v[252:255], a[184:187], a[4:7], 0
    s_waitcnt lgkmcnt(7)
    ds_read_b64_tr_b16 a[174:175], v21 offset:12288
    ds_read_b64_tr_b16 a[176:177], v22 offset:0
    v_mfma_f32_16x16x32_bf16 v[252:255], a[188:191], a[12:15], v[252:255]
    ds_read_b64_tr_b16 a[178:179], v22 offset:4096
    v_mfma_f32_16x16x32_bf16 v[248:251], a[188:191], a[8:11], 0
    ds_read_b64_tr_b16 a[180:181], v22 offset:8192
    v_mfma_f32_16x16x32_bf16 v[248:251], a[184:187], a[0:3], v[248:251]
    s_waitcnt vmcnt(10)
    s_waitcnt lgkmcnt(9)
    buffer_load_dwordx4 a[52:55], v51, s[24:27], s43 offen offset:768 sc1
    v_mfma_f32_16x16x32_bf16 v[128:131], a[160:163], a[16:19], v[128:131]
    s_waitcnt vmcnt(10)
    s_waitcnt lgkmcnt(7)
    ds_read_b64_tr_b16 a[182:183], v22 offset:12288
    ds_read_b64_tr_b16 a[184:185], v23 offset:0
    v_mfma_f32_16x16x32_bf16 v[128:131], a[164:167], a[24:27], v[128:131]
    s_waitcnt vmcnt(8)
    ds_read_b64_tr_b16 a[186:187], v23 offset:4096
    v_mfma_f32_16x16x32_bf16 v[132:135], a[164:167], a[28:31], v[132:135]
    ds_read_b64_tr_b16 a[188:189], v23 offset:8192
    v_mfma_f32_16x16x32_bf16 v[132:135], a[160:163], a[20:23], v[132:135]
    s_waitcnt lgkmcnt(9)
    buffer_load_dwordx4 a[60:63], v51, s[24:27], s43 offen offset:896 sc1
    v_mfma_f32_16x16x32_bf16 v[140:143], a[168:171], a[20:23], v[140:143]
    s_waitcnt lgkmcnt(7)
    ds_read_b64_tr_b16 a[190:191], v23 offset:12288
    ds_read_b64_tr_b16 a[160:161], v24 offset:0
    v_mfma_f32_16x16x32_bf16 v[140:143], a[172:175], a[28:31], v[140:143]
    ds_read_b64_tr_b16 a[162:163], v24 offset:4096
    v_mfma_f32_16x16x32_bf16 v[136:139], a[172:175], a[24:27], v[136:139]
    ds_read_b64_tr_b16 a[164:165], v24 offset:8192
    v_mfma_f32_16x16x32_bf16 v[136:139], a[168:171], a[16:19], v[136:139]
    s_waitcnt lgkmcnt(9)
    buffer_load_dwordx4 a[64:67], v51, s[24:27], s46 offen offset:1024 sc1
    v_mfma_f32_16x16x32_bf16 v[144:147], a[176:179], a[16:19], v[144:147]
    s_waitcnt lgkmcnt(7)
    ds_read_b64_tr_b16 a[166:167], v24 offset:12288
    ds_read_b64_tr_b16 a[168:169], v25 offset:0
    v_mfma_f32_16x16x32_bf16 v[144:147], a[180:183], a[24:27], v[144:147]
    ds_read_b64_tr_b16 a[170:171], v25 offset:4096
    v_mfma_f32_16x16x32_bf16 v[148:151], a[180:183], a[28:31], v[148:151]
    ds_read_b64_tr_b16 a[172:173], v25 offset:8192
    v_mfma_f32_16x16x32_bf16 v[148:151], a[176:179], a[20:23], v[148:151]
    s_waitcnt lgkmcnt(9)
    buffer_load_dwordx4 a[72:75], v51, s[24:27], s46 offen offset:1152 sc1
    v_mfma_f32_16x16x32_bf16 v[156:159], a[184:187], a[20:23], v[156:159]
    s_waitcnt lgkmcnt(7)
    ds_read_b64_tr_b16 a[174:175], v25 offset:12288
    ds_read_b64_tr_b16 a[176:177], v26 offset:0
    v_mfma_f32_16x16x32_bf16 v[156:159], a[188:191], a[28:31], v[156:159]
    ds_read_b64_tr_b16 a[178:179], v26 offset:4096
    v_mfma_f32_16x16x32_bf16 v[152:155], a[188:191], a[24:27], v[152:155]
    ds_read_b64_tr_b16 a[180:181], v26 offset:8192
    v_mfma_f32_16x16x32_bf16 v[152:155], a[184:187], a[16:19], v[152:155]
    s_waitcnt lgkmcnt(9)
    buffer_load_dwordx4 a[68:71], v51, s[24:27], s43 offen offset:1024 sc1
    v_mfma_f32_16x16x32_bf16 v[160:163], a[160:163], a[16:19], v[160:163]
    s_waitcnt lgkmcnt(7)
    ds_read_b64_tr_b16 a[182:183], v26 offset:12288
    ds_read_b64_tr_b16 a[184:185], v27 offset:0
    v_mfma_f32_16x16x32_bf16 v[160:163], a[164:167], a[24:27], v[160:163]
    ds_read_b64_tr_b16 a[186:187], v27 offset:4096
    v_mfma_f32_16x16x32_bf16 v[164:167], a[164:167], a[28:31], v[164:167]
    ds_read_b64_tr_b16 a[188:189], v27 offset:8192
    v_mfma_f32_16x16x32_bf16 v[164:167], a[160:163], a[20:23], v[164:167]
    s_waitcnt lgkmcnt(9)
    buffer_load_dwordx4 a[76:79], v51, s[24:27], s43 offen offset:1152 sc1
    v_mfma_f32_16x16x32_bf16 v[172:175], a[168:171], a[20:23], v[172:175]
    s_waitcnt lgkmcnt(7)
    ds_read_b64_tr_b16 a[190:191], v27 offset:12288
    ds_read_b64_tr_b16 a[160:161], v20 offset:16384
    v_mfma_f32_16x16x32_bf16 v[172:175], a[172:175], a[28:31], v[172:175]
    ds_read_b64_tr_b16 a[162:163], v20 offset:20480
    v_mfma_f32_16x16x32_bf16 v[168:171], a[172:175], a[24:27], v[168:171]
    ds_read_b64_tr_b16 a[164:165], v20 offset:24576
    v_mfma_f32_16x16x32_bf16 v[168:171], a[168:171], a[16:19], v[168:171]
    s_waitcnt lgkmcnt(9)
    ds_read_b64_tr_b16 a[166:167], v20 offset:28672
    v_mfma_f32_16x16x32_bf16 v[176:179], a[176:179], a[16:19], v[176:179]
    s_waitcnt lgkmcnt(8)
    ds_read_b64_tr_b16 a[168:169], v21 offset:16384
    v_mfma_f32_16x16x32_bf16 v[176:179], a[180:183], a[24:27], v[176:179]
    ds_read_b64_tr_b16 a[170:171], v21 offset:20480
    v_mfma_f32_16x16x32_bf16 v[180:183], a[180:183], a[28:31], v[180:183]
    ds_read_b64_tr_b16 a[172:173], v21 offset:24576
    v_mfma_f32_16x16x32_bf16 v[180:183], a[176:179], a[20:23], v[180:183]
    s_waitcnt lgkmcnt(9)
    ds_read_b64_tr_b16 a[174:175], v21 offset:28672
    v_mfma_f32_16x16x32_bf16 v[188:191], a[184:187], a[20:23], v[188:191]
    s_waitcnt lgkmcnt(8)
    ds_read_b64_tr_b16 a[176:177], v22 offset:16384
    v_mfma_f32_16x16x32_bf16 v[188:191], a[188:191], a[28:31], v[188:191]
    ds_read_b64_tr_b16 a[178:179], v22 offset:20480
    v_mfma_f32_16x16x32_bf16 v[184:187], a[188:191], a[24:27], v[184:187]
    ds_read_b64_tr_b16 a[180:181], v22 offset:24576
    v_mfma_f32_16x16x32_bf16 v[184:187], a[184:187], a[16:19], v[184:187]
    s_waitcnt lgkmcnt(9)
    ds_read_b64_tr_b16 a[182:183], v22 offset:28672
    v_mfma_f32_16x16x32_bf16 v[192:195], a[160:163], a[16:19], v[192:195]
    s_waitcnt lgkmcnt(8)
    ds_read_b64_tr_b16 a[184:185], v23 offset:16384
    v_mfma_f32_16x16x32_bf16 v[192:195], a[164:167], a[24:27], v[192:195]
    ds_read_b64_tr_b16 a[186:187], v23 offset:20480
    v_mfma_f32_16x16x32_bf16 v[196:199], a[164:167], a[28:31], v[196:199]
    ds_read_b64_tr_b16 a[188:189], v23 offset:24576
    v_mfma_f32_16x16x32_bf16 v[196:199], a[160:163], a[20:23], v[196:199]
    s_waitcnt lgkmcnt(9)
    ds_read_b64_tr_b16 a[190:191], v23 offset:28672
    v_mfma_f32_16x16x32_bf16 v[204:207], a[168:171], a[20:23], v[204:207]
    s_waitcnt lgkmcnt(8)
    ds_read_b64_tr_b16 a[160:161], v24 offset:16384
    v_mfma_f32_16x16x32_bf16 v[204:207], a[172:175], a[28:31], v[204:207]
    ds_read_b64_tr_b16 a[162:163], v24 offset:20480
    v_mfma_f32_16x16x32_bf16 v[200:203], a[172:175], a[24:27], v[200:203]
    ds_read_b64_tr_b16 a[164:165], v24 offset:24576
    v_mfma_f32_16x16x32_bf16 v[200:203], a[168:171], a[16:19], v[200:203]
    s_waitcnt lgkmcnt(9)
    ds_read_b64_tr_b16 a[166:167], v24 offset:28672
    v_mfma_f32_16x16x32_bf16 v[208:211], a[176:179], a[16:19], v[208:211]
    s_waitcnt lgkmcnt(8)
    ds_read_b64_tr_b16 a[168:169], v25 offset:16384
    v_mfma_f32_16x16x32_bf16 v[208:211], a[180:183], a[24:27], v[208:211]
    ds_read_b64_tr_b16 a[170:171], v25 offset:20480
    v_mfma_f32_16x16x32_bf16 v[212:215], a[180:183], a[28:31], v[212:215]
    ds_read_b64_tr_b16 a[172:173], v25 offset:24576
    v_mfma_f32_16x16x32_bf16 v[212:215], a[176:179], a[20:23], v[212:215]
    s_waitcnt lgkmcnt(9)
    ds_read_b64_tr_b16 a[174:175], v25 offset:28672
    v_mfma_f32_16x16x32_bf16 v[220:223], a[184:187], a[20:23], v[220:223]
    s_waitcnt lgkmcnt(8)
    ds_read_b64_tr_b16 a[176:177], v26 offset:16384
    v_mfma_f32_16x16x32_bf16 v[220:223], a[188:191], a[28:31], v[220:223]
    ds_read_b64_tr_b16 a[178:179], v26 offset:20480
    v_mfma_f32_16x16x32_bf16 v[216:219], a[188:191], a[24:27], v[216:219]
    ds_read_b64_tr_b16 a[180:181], v26 offset:24576
    v_mfma_f32_16x16x32_bf16 v[216:219], a[184:187], a[16:19], v[216:219]
    s_waitcnt lgkmcnt(9)
    ds_read_b64_tr_b16 a[182:183], v26 offset:28672
    v_mfma_f32_16x16x32_bf16 v[224:227], a[160:163], a[16:19], v[224:227]
    s_waitcnt lgkmcnt(8)
    ds_read_b64_tr_b16 a[184:185], v27 offset:16384
    v_mfma_f32_16x16x32_bf16 v[224:227], a[164:167], a[24:27], v[224:227]
    ds_read_b64_tr_b16 a[186:187], v27 offset:20480
    v_mfma_f32_16x16x32_bf16 v[228:231], a[164:167], a[28:31], v[228:231]
    ds_read_b64_tr_b16 a[188:189], v27 offset:24576
    v_mfma_f32_16x16x32_bf16 v[228:231], a[160:163], a[20:23], v[228:231]
    s_waitcnt lgkmcnt(9)
    ds_read_b64_tr_b16 a[190:191], v27 offset:28672
    s_barrier
    v_mfma_f32_16x16x32_bf16 v[236:239], a[168:171], a[20:23], v[236:239]
    s_waitcnt lgkmcnt(8)
    ds_read_b64_tr_b16 a[160:161], v20 offset:32768
    v_mfma_f32_16x16x32_bf16 v[236:239], a[172:175], a[28:31], v[236:239]
    s_add_u32 s49, s44, 2097152
    ds_read_b64_tr_b16 a[162:163], v20 offset:36864
    v_mfma_f32_16x16x32_bf16 v[232:235], a[172:175], a[24:27], v[232:235]
    s_add_u32 m0, s42, 0
    ds_read_b64_tr_b16 a[164:165], v20 offset:40960
    v_mfma_f32_16x16x32_bf16 v[232:235], a[168:171], a[16:19], v[232:235]
    s_waitcnt lgkmcnt(9)
    buffer_load_dwordx4 v42, s[16:19], s49 offen lds
    v_mfma_f32_16x16x32_bf16 v[240:243], a[176:179], a[16:19], v[240:243]
    s_waitcnt lgkmcnt(7)
    ds_read_b64_tr_b16 a[166:167], v20 offset:45056
    ds_read_b64_tr_b16 a[168:169], v21 offset:32768
    v_mfma_f32_16x16x32_bf16 v[240:243], a[180:183], a[24:27], v[240:243]
    ds_read_b64_tr_b16 a[170:171], v21 offset:36864
    v_mfma_f32_16x16x32_bf16 v[244:247], a[180:183], a[28:31], v[244:247]
    ds_read_b64_tr_b16 a[172:173], v21 offset:40960
    v_mfma_f32_16x16x32_bf16 v[244:247], a[176:179], a[20:23], v[244:247]
    s_waitcnt lgkmcnt(9)
    buffer_load_dwordx4 v43, s[16:19], s49 offen offset:1024 lds
    v_mfma_f32_16x16x32_bf16 v[252:255], a[184:187], a[20:23], v[252:255]
    s_waitcnt lgkmcnt(7)
    ds_read_b64_tr_b16 a[174:175], v21 offset:45056
    ds_read_b64_tr_b16 a[176:177], v22 offset:32768
    v_mfma_f32_16x16x32_bf16 v[252:255], a[188:191], a[28:31], v[252:255]
    ds_read_b64_tr_b16 a[178:179], v22 offset:36864
    v_mfma_f32_16x16x32_bf16 v[248:251], a[188:191], a[24:27], v[248:251]
    ds_read_b64_tr_b16 a[180:181], v22 offset:40960
    v_mfma_f32_16x16x32_bf16 v[248:251], a[184:187], a[16:19], v[248:251]
    s_waitcnt vmcnt(14)
    s_waitcnt lgkmcnt(9)
    buffer_load_dwordx4 v44, s[16:19], s49 offen offset:2048 lds
    v_mfma_f32_16x16x32_bf16 v[128:131], a[160:163], a[32:35], v[128:131]
    s_waitcnt vmcnt(14)
    s_waitcnt lgkmcnt(7)
    ds_read_b64_tr_b16 a[182:183], v22 offset:45056
    ds_read_b64_tr_b16 a[184:185], v23 offset:32768
    v_mfma_f32_16x16x32_bf16 v[128:131], a[164:167], a[40:43], v[128:131]
    s_waitcnt vmcnt(12)
    ds_read_b64_tr_b16 a[186:187], v23 offset:36864
    v_mfma_f32_16x16x32_bf16 v[132:135], a[164:167], a[44:47], v[132:135]
    ds_read_b64_tr_b16 a[188:189], v23 offset:40960
    v_mfma_f32_16x16x32_bf16 v[132:135], a[160:163], a[36:39], v[132:135]
    s_waitcnt lgkmcnt(9)
    buffer_load_dwordx4 v45, s[16:19], s49 offen offset:3072 lds
    v_mfma_f32_16x16x32_bf16 v[140:143], a[168:171], a[36:39], v[140:143]
    s_waitcnt lgkmcnt(7)
    ds_read_b64_tr_b16 a[190:191], v23 offset:45056
    ds_read_b64_tr_b16 a[160:161], v24 offset:32768
    v_mfma_f32_16x16x32_bf16 v[140:143], a[172:175], a[44:47], v[140:143]
    s_add_u32 s49, s44, 2097408
    ds_read_b64_tr_b16 a[162:163], v24 offset:36864
    v_mfma_f32_16x16x32_bf16 v[136:139], a[172:175], a[40:43], v[136:139]
    s_add_u32 m0, s42, 16384
    ds_read_b64_tr_b16 a[164:165], v24 offset:40960
    v_mfma_f32_16x16x32_bf16 v[136:139], a[168:171], a[32:35], v[136:139]
    s_waitcnt lgkmcnt(9)
    buffer_load_dwordx4 v42, s[16:19], s49 offen lds
    v_mfma_f32_16x16x32_bf16 v[144:147], a[176:179], a[32:35], v[144:147]
    s_waitcnt lgkmcnt(7)
    ds_read_b64_tr_b16 a[166:167], v24 offset:45056
    ds_read_b64_tr_b16 a[168:169], v25 offset:32768
    v_mfma_f32_16x16x32_bf16 v[144:147], a[180:183], a[40:43], v[144:147]
    ds_read_b64_tr_b16 a[170:171], v25 offset:36864
    v_mfma_f32_16x16x32_bf16 v[148:151], a[180:183], a[44:47], v[148:151]
    ds_read_b64_tr_b16 a[172:173], v25 offset:40960
    v_mfma_f32_16x16x32_bf16 v[148:151], a[176:179], a[36:39], v[148:151]
    s_waitcnt lgkmcnt(9)
    buffer_load_dwordx4 v43, s[16:19], s49 offen offset:1024 lds
    v_mfma_f32_16x16x32_bf16 v[156:159], a[184:187], a[36:39], v[156:159]
    s_waitcnt lgkmcnt(7)
    ds_read_b64_tr_b16 a[174:175], v25 offset:45056
    ds_read_b64_tr_b16 a[176:177], v26 offset:32768
    v_mfma_f32_16x16x32_bf16 v[156:159], a[188:191], a[44:47], v[156:159]
    ds_read_b64_tr_b16 a[178:179], v26 offset:36864
    v_mfma_f32_16x16x32_bf16 v[152:155], a[188:191], a[40:43], v[152:155]
    ds_read_b64_tr_b16 a[180:181], v26 offset:40960
    v_mfma_f32_16x16x32_bf16 v[152:155], a[184:187], a[32:35], v[152:155]
    s_waitcnt lgkmcnt(9)
    buffer_load_dwordx4 v44, s[16:19], s49 offen offset:2048 lds
    v_mfma_f32_16x16x32_bf16 v[160:163], a[160:163], a[32:35], v[160:163]
    s_waitcnt lgkmcnt(7)
    ds_read_b64_tr_b16 a[182:183], v26 offset:45056
    ds_read_b64_tr_b16 a[184:185], v27 offset:32768
    v_mfma_f32_16x16x32_bf16 v[160:163], a[164:167], a[40:43], v[160:163]
    ds_read_b64_tr_b16 a[186:187], v27 offset:36864
    v_mfma_f32_16x16x32_bf16 v[164:167], a[164:167], a[44:47], v[164:167]
    ds_read_b64_tr_b16 a[188:189], v27 offset:40960
    v_mfma_f32_16x16x32_bf16 v[164:167], a[160:163], a[36:39], v[164:167]
    s_waitcnt lgkmcnt(9)
    buffer_load_dwordx4 v45, s[16:19], s49 offen offset:3072 lds
    v_mfma_f32_16x16x32_bf16 v[172:175], a[168:171], a[36:39], v[172:175]
    s_waitcnt lgkmcnt(7)
    ds_read_b64_tr_b16 a[190:191], v27 offset:45056
    ds_read_b64_tr_b16 a[160:161], v20 offset:49152
    v_mfma_f32_16x16x32_bf16 v[172:175], a[172:175], a[44:47], v[172:175]
    ds_read_b64_tr_b16 a[162:163], v20 offset:53248
    v_mfma_f32_16x16x32_bf16 v[168:171], a[172:175], a[40:43], v[168:171]
    ds_read_b64_tr_b16 a[164:165], v20 offset:57344
    v_mfma_f32_16x16x32_bf16 v[168:171], a[168:171], a[32:35], v[168:171]
    s_waitcnt lgkmcnt(9)
    buffer_load_dwordx4 a[80:83], v51, s[24:27], s46 offen offset:1280 sc1
    v_mfma_f32_16x16x32_bf16 v[176:179], a[176:179], a[32:35], v[176:179]
    s_waitcnt lgkmcnt(7)
    ds_read_b64_tr_b16 a[166:167], v20 offset:61440
    ds_read_b64_tr_b16 a[168:169], v21 offset:49152
    v_mfma_f32_16x16x32_bf16 v[176:179], a[180:183], a[40:43], v[176:179]
    ds_read_b64_tr_b16 a[170:171], v21 offset:53248
    v_mfma_f32_16x16x32_bf16 v[180:183], a[180:183], a[44:47], v[180:183]
    ds_read_b64_tr_b16 a[172:173], v21 offset:57344
    v_mfma_f32_16x16x32_bf16 v[180:183], a[176:179], a[36:39], v[180:183]
    s_waitcnt lgkmcnt(9)
    buffer_load_dwordx4 a[88:91], v51, s[24:27], s46 offen offset:1408 sc1
    v_mfma_f32_16x16x32_bf16 v[188:191], a[184:187], a[36:39], v[188:191]
    s_waitcnt lgkmcnt(7)
    ds_read_b64_tr_b16 a[174:175], v21 offset:61440
    ds_read_b64_tr_b16 a[176:177], v22 offset:49152
    v_mfma_f32_16x16x32_bf16 v[188:191], a[188:191], a[44:47], v[188:191]
    ds_read_b64_tr_b16 a[178:179], v22 offset:53248
    v_mfma_f32_16x16x32_bf16 v[184:187], a[188:191], a[40:43], v[184:187]
    ds_read_b64_tr_b16 a[180:181], v22 offset:57344
    v_mfma_f32_16x16x32_bf16 v[184:187], a[184:187], a[32:35], v[184:187]
    s_waitcnt lgkmcnt(9)
    buffer_load_dwordx4 a[84:87], v51, s[24:27], s43 offen offset:1280 sc1
    v_mfma_f32_16x16x32_bf16 v[192:195], a[160:163], a[32:35], v[192:195]
    s_waitcnt lgkmcnt(7)
    ds_read_b64_tr_b16 a[182:183], v22 offset:61440
    ds_read_b64_tr_b16 a[184:185], v23 offset:49152
    v_mfma_f32_16x16x32_bf16 v[192:195], a[164:167], a[40:43], v[192:195]
    ds_read_b64_tr_b16 a[186:187], v23 offset:53248
    v_mfma_f32_16x16x32_bf16 v[196:199], a[164:167], a[44:47], v[196:199]
    ds_read_b64_tr_b16 a[188:189], v23 offset:57344
    v_mfma_f32_16x16x32_bf16 v[196:199], a[160:163], a[36:39], v[196:199]
    s_waitcnt lgkmcnt(9)
    buffer_load_dwordx4 a[92:95], v51, s[24:27], s43 offen offset:1408 sc1
    v_mfma_f32_16x16x32_bf16 v[204:207], a[168:171], a[36:39], v[204:207]
    s_waitcnt lgkmcnt(7)
    ds_read_b64_tr_b16 a[190:191], v23 offset:61440
    ds_read_b64_tr_b16 a[160:161], v24 offset:49152
    v_mfma_f32_16x16x32_bf16 v[204:207], a[172:175], a[44:47], v[204:207]
    ds_read_b64_tr_b16 a[162:163], v24 offset:53248
    v_mfma_f32_16x16x32_bf16 v[200:203], a[172:175], a[40:43], v[200:203]
    ds_read_b64_tr_b16 a[164:165], v24 offset:57344
    v_mfma_f32_16x16x32_bf16 v[200:203], a[168:171], a[32:35], v[200:203]
    s_waitcnt lgkmcnt(9)
    ds_read_b64_tr_b16 a[166:167], v24 offset:61440
    v_mfma_f32_16x16x32_bf16 v[208:211], a[176:179], a[32:35], v[208:211]
    s_waitcnt lgkmcnt(8)
    ds_read_b64_tr_b16 a[168:169], v25 offset:49152
    v_mfma_f32_16x16x32_bf16 v[208:211], a[180:183], a[40:43], v[208:211]
    ds_read_b64_tr_b16 a[170:171], v25 offset:53248
    v_mfma_f32_16x16x32_bf16 v[212:215], a[180:183], a[44:47], v[212:215]
    ds_read_b64_tr_b16 a[172:173], v25 offset:57344
    v_mfma_f32_16x16x32_bf16 v[212:215], a[176:179], a[36:39], v[212:215]
    s_waitcnt lgkmcnt(9)
    ds_read_b64_tr_b16 a[174:175], v25 offset:61440
    v_mfma_f32_16x16x32_bf16 v[220:223], a[184:187], a[36:39], v[220:223]
    s_waitcnt lgkmcnt(8)
    ds_read_b64_tr_b16 a[176:177], v26 offset:49152
    v_mfma_f32_16x16x32_bf16 v[220:223], a[188:191], a[44:47], v[220:223]
    ds_read_b64_tr_b16 a[178:179], v26 offset:53248
    v_mfma_f32_16x16x32_bf16 v[216:219], a[188:191], a[40:43], v[216:219]
    ds_read_b64_tr_b16 a[180:181], v26 offset:57344
    v_mfma_f32_16x16x32_bf16 v[216:219], a[184:187], a[32:35], v[216:219]
    s_waitcnt lgkmcnt(9)
    ds_read_b64_tr_b16 a[182:183], v26 offset:61440
    v_mfma_f32_16x16x32_bf16 v[224:227], a[160:163], a[32:35], v[224:227]
    s_waitcnt lgkmcnt(8)
    ds_read_b64_tr_b16 a[184:185], v27 offset:49152
    v_mfma_f32_16x16x32_bf16 v[224:227], a[164:167], a[40:43], v[224:227]
    ds_read_b64_tr_b16 a[186:187], v27 offset:53248
    v_mfma_f32_16x16x32_bf16 v[228:231], a[164:167], a[44:47], v[228:231]
    ds_read_b64_tr_b16 a[188:189], v27 offset:57344
    v_mfma_f32_16x16x32_bf16 v[228:231], a[160:163], a[36:39], v[228:231]
    s_waitcnt lgkmcnt(9)
    ds_read_b64_tr_b16 a[190:191], v27 offset:61440
    s_barrier
    v_mfma_f32_16x16x32_bf16 v[236:239], a[168:171], a[36:39], v[236:239]
    s_waitcnt lgkmcnt(8)
    ds_read_b64_tr_b16 a[160:161], v28 offset:0
    v_mfma_f32_16x16x32_bf16 v[236:239], a[172:175], a[44:47], v[236:239]
    s_add_u32 s49, s44, 2621440
    ds_read_b64_tr_b16 a[162:163], v28 offset:4096
    v_mfma_f32_16x16x32_bf16 v[232:235], a[172:175], a[40:43], v[232:235]
    s_add_u32 m0, s42, 32768
    ds_read_b64_tr_b16 a[164:165], v28 offset:8192
    v_mfma_f32_16x16x32_bf16 v[232:235], a[168:171], a[32:35], v[232:235]
    s_waitcnt lgkmcnt(9)
    buffer_load_dwordx4 v42, s[16:19], s49 offen lds
    v_mfma_f32_16x16x32_bf16 v[240:243], a[176:179], a[32:35], v[240:243]
    s_waitcnt lgkmcnt(7)
    ds_read_b64_tr_b16 a[166:167], v28 offset:12288
    ds_read_b64_tr_b16 a[168:169], v29 offset:0
    v_mfma_f32_16x16x32_bf16 v[240:243], a[180:183], a[40:43], v[240:243]
    ds_read_b64_tr_b16 a[170:171], v29 offset:4096
    v_mfma_f32_16x16x32_bf16 v[244:247], a[180:183], a[44:47], v[244:247]
    ds_read_b64_tr_b16 a[172:173], v29 offset:8192
    v_mfma_f32_16x16x32_bf16 v[244:247], a[176:179], a[36:39], v[244:247]
    s_waitcnt lgkmcnt(9)
    buffer_load_dwordx4 v43, s[16:19], s49 offen offset:1024 lds
    v_mfma_f32_16x16x32_bf16 v[252:255], a[184:187], a[36:39], v[252:255]
    s_waitcnt lgkmcnt(7)
    ds_read_b64_tr_b16 a[174:175], v29 offset:12288
    ds_read_b64_tr_b16 a[176:177], v30 offset:0
    v_mfma_f32_16x16x32_bf16 v[252:255], a[188:191], a[44:47], v[252:255]
    ds_read_b64_tr_b16 a[178:179], v30 offset:4096
    v_mfma_f32_16x16x32_bf16 v[248:251], a[188:191], a[40:43], v[248:251]
    ds_read_b64_tr_b16 a[180:181], v30 offset:8192
    v_mfma_f32_16x16x32_bf16 v[248:251], a[184:187], a[32:35], v[248:251]
    s_waitcnt vmcnt(21)
    s_waitcnt lgkmcnt(9)
    buffer_load_dwordx4 v44, s[16:19], s49 offen offset:2048 lds
    v_mfma_f32_16x16x32_bf16 v[128:131], a[160:163], a[48:51], v[128:131]
    s_waitcnt vmcnt(21)
    s_waitcnt lgkmcnt(7)
    ds_read_b64_tr_b16 a[182:183], v30 offset:12288
    ds_read_b64_tr_b16 a[184:185], v31 offset:0
    v_mfma_f32_16x16x32_bf16 v[128:131], a[164:167], a[56:59], v[128:131]
    s_waitcnt vmcnt(19)
    ds_read_b64_tr_b16 a[186:187], v31 offset:4096
    v_mfma_f32_16x16x32_bf16 v[132:135], a[164:167], a[60:63], v[132:135]
    ds_read_b64_tr_b16 a[188:189], v31 offset:8192
    v_mfma_f32_16x16x32_bf16 v[132:135], a[160:163], a[52:55], v[132:135]
    s_waitcnt lgkmcnt(9)
    buffer_load_dwordx4 v45, s[16:19], s49 offen offset:3072 lds
    v_mfma_f32_16x16x32_bf16 v[140:143], a[168:171], a[52:55], v[140:143]
    s_waitcnt lgkmcnt(7)
    ds_read_b64_tr_b16 a[190:191], v31 offset:12288
    ds_read_b64_tr_b16 a[160:161], v32 offset:0
    v_mfma_f32_16x16x32_bf16 v[140:143], a[172:175], a[60:63], v[140:143]
    s_add_u32 s49, s44, 3145728
    ds_read_b64_tr_b16 a[162:163], v32 offset:4096
    v_mfma_f32_16x16x32_bf16 v[136:139], a[172:175], a[56:59], v[136:139]
    s_add_u32 m0, s42, 49152
    ds_read_b64_tr_b16 a[164:165], v32 offset:8192
    v_mfma_f32_16x16x32_bf16 v[136:139], a[168:171], a[48:51], v[136:139]
    s_waitcnt lgkmcnt(9)
    buffer_load_dwordx4 v42, s[16:19], s49 offen lds
    v_mfma_f32_16x16x32_bf16 v[144:147], a[176:179], a[48:51], v[144:147]
    s_waitcnt lgkmcnt(7)
    ds_read_b64_tr_b16 a[166:167], v32 offset:12288
    ds_read_b64_tr_b16 a[168:169], v33 offset:0
    v_mfma_f32_16x16x32_bf16 v[144:147], a[180:183], a[56:59], v[144:147]
    ds_read_b64_tr_b16 a[170:171], v33 offset:4096
    v_mfma_f32_16x16x32_bf16 v[148:151], a[180:183], a[60:63], v[148:151]
    ds_read_b64_tr_b16 a[172:173], v33 offset:8192
    v_mfma_f32_16x16x32_bf16 v[148:151], a[176:179], a[52:55], v[148:151]
    s_waitcnt lgkmcnt(9)
    buffer_load_dwordx4 v43, s[16:19], s49 offen offset:1024 lds
    v_mfma_f32_16x16x32_bf16 v[156:159], a[184:187], a[52:55], v[156:159]
    s_waitcnt lgkmcnt(7)
    ds_read_b64_tr_b16 a[174:175], v33 offset:12288
    ds_read_b64_tr_b16 a[176:177], v34 offset:0
    v_mfma_f32_16x16x32_bf16 v[156:159], a[188:191], a[60:63], v[156:159]
    ds_read_b64_tr_b16 a[178:179], v34 offset:4096
    v_mfma_f32_16x16x32_bf16 v[152:155], a[188:191], a[56:59], v[152:155]
    ds_read_b64_tr_b16 a[180:181], v34 offset:8192
    v_mfma_f32_16x16x32_bf16 v[152:155], a[184:187], a[48:51], v[152:155]
    s_waitcnt lgkmcnt(9)
    buffer_load_dwordx4 v44, s[16:19], s49 offen offset:2048 lds
    v_mfma_f32_16x16x32_bf16 v[160:163], a[160:163], a[48:51], v[160:163]
    s_waitcnt lgkmcnt(7)
    ds_read_b64_tr_b16 a[182:183], v34 offset:12288
    ds_read_b64_tr_b16 a[184:185], v35 offset:0
    v_mfma_f32_16x16x32_bf16 v[160:163], a[164:167], a[56:59], v[160:163]
    ds_read_b64_tr_b16 a[186:187], v35 offset:4096
    v_mfma_f32_16x16x32_bf16 v[164:167], a[164:167], a[60:63], v[164:167]
    ds_read_b64_tr_b16 a[188:189], v35 offset:8192
    v_mfma_f32_16x16x32_bf16 v[164:167], a[160:163], a[52:55], v[164:167]
    s_waitcnt lgkmcnt(9)
    buffer_load_dwordx4 v45, s[16:19], s49 offen offset:3072 lds
    v_mfma_f32_16x16x32_bf16 v[172:175], a[168:171], a[52:55], v[172:175]
    s_waitcnt lgkmcnt(7)
    ds_read_b64_tr_b16 a[190:191], v35 offset:12288
    ds_read_b64_tr_b16 a[160:161], v28 offset:16384
    v_mfma_f32_16x16x32_bf16 v[172:175], a[172:175], a[60:63], v[172:175]
    ds_read_b64_tr_b16 a[162:163], v28 offset:20480
    v_mfma_f32_16x16x32_bf16 v[168:171], a[172:175], a[56:59], v[168:171]
    ds_read_b64_tr_b16 a[164:165], v28 offset:24576
    v_mfma_f32_16x16x32_bf16 v[168:171], a[168:171], a[48:51], v[168:171]
    s_waitcnt lgkmcnt(9)
    buffer_load_dwordx4 a[96:99], v51, s[24:27], s46 offen offset:1536 sc1
    v_mfma_f32_16x16x32_bf16 v[176:179], a[176:179], a[48:51], v[176:179]
    s_waitcnt lgkmcnt(7)
    ds_read_b64_tr_b16 a[166:167], v28 offset:28672
    ds_read_b64_tr_b16 a[168:169], v29 offset:16384
    v_mfma_f32_16x16x32_bf16 v[176:179], a[180:183], a[56:59], v[176:179]
    ds_read_b64_tr_b16 a[170:171], v29 offset:20480
    v_mfma_f32_16x16x32_bf16 v[180:183], a[180:183], a[60:63], v[180:183]
    ds_read_b64_tr_b16 a[172:173], v29 offset:24576
    v_mfma_f32_16x16x32_bf16 v[180:183], a[176:179], a[52:55], v[180:183]
    s_waitcnt lgkmcnt(9)
    buffer_load_dwordx4 a[104:107], v51, s[24:27], s46 offen offset:1664 sc1
    v_mfma_f32_16x16x32_bf16 v[188:191], a[184:187], a[52:55], v[188:191]
    s_waitcnt lgkmcnt(7)
    ds_read_b64_tr_b16 a[174:175], v29 offset:28672
    ds_read_b64_tr_b16 a[176:177], v30 offset:16384
    v_mfma_f32_16x16x32_bf16 v[188:191], a[188:191], a[60:63], v[188:191]
    ds_read_b64_tr_b16 a[178:179], v30 offset:20480
    v_mfma_f32_16x16x32_bf16 v[184:187], a[188:191], a[56:59], v[184:187]
    ds_read_b64_tr_b16 a[180:181], v30 offset:24576
    v_mfma_f32_16x16x32_bf16 v[184:187], a[184:187], a[48:51], v[184:187]
    s_waitcnt lgkmcnt(9)
    buffer_load_dwordx4 a[100:103], v51, s[24:27], s43 offen offset:1536 sc1
    v_mfma_f32_16x16x32_bf16 v[192:195], a[160:163], a[48:51], v[192:195]
    s_waitcnt lgkmcnt(7)
    ds_read_b64_tr_b16 a[182:183], v30 offset:28672
    ds_read_b64_tr_b16 a[184:185], v31 offset:16384
    v_mfma_f32_16x16x32_bf16 v[192:195], a[164:167], a[56:59], v[192:195]
    ds_read_b64_tr_b16 a[186:187], v31 offset:20480
    v_mfma_f32_16x16x32_bf16 v[196:199], a[164:167], a[60:63], v[196:199]
    ds_read_b64_tr_b16 a[188:189], v31 offset:24576
    v_mfma_f32_16x16x32_bf16 v[196:199], a[160:163], a[52:55], v[196:199]
    s_waitcnt lgkmcnt(9)
    buffer_load_dwordx4 a[108:111], v51, s[24:27], s43 offen offset:1664 sc1
    v_mfma_f32_16x16x32_bf16 v[204:207], a[168:171], a[52:55], v[204:207]
    s_waitcnt lgkmcnt(7)
    ds_read_b64_tr_b16 a[190:191], v31 offset:28672
    ds_read_b64_tr_b16 a[160:161], v32 offset:16384
    v_mfma_f32_16x16x32_bf16 v[204:207], a[172:175], a[60:63], v[204:207]
    ds_read_b64_tr_b16 a[162:163], v32 offset:20480
    v_mfma_f32_16x16x32_bf16 v[200:203], a[172:175], a[56:59], v[200:203]
    ds_read_b64_tr_b16 a[164:165], v32 offset:24576
    v_mfma_f32_16x16x32_bf16 v[200:203], a[168:171], a[48:51], v[200:203]
    s_waitcnt lgkmcnt(9)
    ds_read_b64_tr_b16 a[166:167], v32 offset:28672
    v_mfma_f32_16x16x32_bf16 v[208:211], a[176:179], a[48:51], v[208:211]
    s_waitcnt lgkmcnt(8)
    ds_read_b64_tr_b16 a[168:169], v33 offset:16384
    v_mfma_f32_16x16x32_bf16 v[208:211], a[180:183], a[56:59], v[208:211]
    ds_read_b64_tr_b16 a[170:171], v33 offset:20480
    v_mfma_f32_16x16x32_bf16 v[212:215], a[180:183], a[60:63], v[212:215]
    ds_read_b64_tr_b16 a[172:173], v33 offset:24576
    v_mfma_f32_16x16x32_bf16 v[212:215], a[176:179], a[52:55], v[212:215]
    s_waitcnt lgkmcnt(9)
    ds_read_b64_tr_b16 a[174:175], v33 offset:28672
    v_mfma_f32_16x16x32_bf16 v[220:223], a[184:187], a[52:55], v[220:223]
    s_waitcnt lgkmcnt(8)
    ds_read_b64_tr_b16 a[176:177], v34 offset:16384
    v_mfma_f32_16x16x32_bf16 v[220:223], a[188:191], a[60:63], v[220:223]
    ds_read_b64_tr_b16 a[178:179], v34 offset:20480
    v_mfma_f32_16x16x32_bf16 v[216:219], a[188:191], a[56:59], v[216:219]
    ds_read_b64_tr_b16 a[180:181], v34 offset:24576
    v_mfma_f32_16x16x32_bf16 v[216:219], a[184:187], a[48:51], v[216:219]
    s_waitcnt lgkmcnt(9)
    ds_read_b64_tr_b16 a[182:183], v34 offset:28672
    v_mfma_f32_16x16x32_bf16 v[224:227], a[160:163], a[48:51], v[224:227]
    s_waitcnt lgkmcnt(8)
    ds_read_b64_tr_b16 a[184:185], v35 offset:16384
    v_mfma_f32_16x16x32_bf16 v[224:227], a[164:167], a[56:59], v[224:227]
    ds_read_b64_tr_b16 a[186:187], v35 offset:20480
    v_mfma_f32_16x16x32_bf16 v[228:231], a[164:167], a[60:63], v[228:231]
    ds_read_b64_tr_b16 a[188:189], v35 offset:24576
    v_mfma_f32_16x16x32_bf16 v[228:231], a[160:163], a[52:55], v[228:231]
    s_waitcnt lgkmcnt(9)
    ds_read_b64_tr_b16 a[190:191], v35 offset:28672
    s_waitcnt vmcnt(16)
    s_barrier
    v_mfma_f32_16x16x32_bf16 v[236:239], a[168:171], a[52:55], v[236:239]
    s_waitcnt lgkmcnt(8)
    ds_read_b64_tr_b16 a[160:161], v12 offset:0
    v_mfma_f32_16x16x32_bf16 v[236:239], a[172:175], a[60:63], v[236:239]
    s_add_u32 s49, s44, 3670016
    ds_read_b64_tr_b16 a[162:163], v12 offset:4096
    v_mfma_f32_16x16x32_bf16 v[232:235], a[172:175], a[56:59], v[232:235]
    s_add_u32 m0, s42, 65536
    ds_read_b64_tr_b16 a[164:165], v12 offset:8192
    v_mfma_f32_16x16x32_bf16 v[232:235], a[168:171], a[48:51], v[232:235]
    s_waitcnt lgkmcnt(9)
    buffer_load_dwordx4 v42, s[16:19], s49 offen lds
    v_mfma_f32_16x16x32_bf16 v[240:243], a[176:179], a[48:51], v[240:243]
    s_waitcnt lgkmcnt(7)
    ds_read_b64_tr_b16 a[166:167], v12 offset:12288
    ds_read_b64_tr_b16 a[168:169], v13 offset:0
    v_mfma_f32_16x16x32_bf16 v[240:243], a[180:183], a[56:59], v[240:243]
    ds_read_b64_tr_b16 a[170:171], v13 offset:4096
    v_mfma_f32_16x16x32_bf16 v[244:247], a[180:183], a[60:63], v[244:247]
    ds_read_b64_tr_b16 a[172:173], v13 offset:8192
    v_mfma_f32_16x16x32_bf16 v[244:247], a[176:179], a[52:55], v[244:247]
    s_waitcnt lgkmcnt(9)
    buffer_load_dwordx4 v43, s[16:19], s49 offen offset:1024 lds
    v_mfma_f32_16x16x32_bf16 v[252:255], a[184:187], a[52:55], v[252:255]
    s_waitcnt lgkmcnt(7)
    ds_read_b64_tr_b16 a[174:175], v13 offset:12288
    ds_read_b64_tr_b16 a[176:177], v14 offset:0
    v_mfma_f32_16x16x32_bf16 v[252:255], a[188:191], a[60:63], v[252:255]
Ltour0_1:
    s_cbranch_execz Ltour0_5
    ds_read_b64_tr_b16 a[178:179], v14 offset:4096
    v_mfma_f32_16x16x32_bf16 v[248:251], a[188:191], a[56:59], v[248:251]
    ds_read_b64_tr_b16 a[180:181], v14 offset:8192
    v_mfma_f32_16x16x32_bf16 v[248:251], a[184:187], a[48:51], v[248:251]
    s_waitcnt lgkmcnt(9)
    buffer_load_dwordx4 v44, s[16:19], s49 offen offset:2048 lds
    v_mfma_f32_16x16x32_bf16 v[128:131], a[160:163], a[64:67], v[128:131]
    s_waitcnt lgkmcnt(7)
    ds_read_b64_tr_b16 a[182:183], v14 offset:12288
    ds_read_b64_tr_b16 a[184:185], v15 offset:0
    v_mfma_f32_16x16x32_bf16 v[128:131], a[164:167], a[72:75], v[128:131]
    ds_read_b64_tr_b16 a[186:187], v15 offset:4096
    v_mfma_f32_16x16x32_bf16 v[132:135], a[164:167], a[76:79], v[132:135]
    ds_read_b64_tr_b16 a[188:189], v15 offset:8192
    v_mfma_f32_16x16x32_bf16 v[132:135], a[160:163], a[68:71], v[132:135]
    s_waitcnt lgkmcnt(9)
    buffer_load_dwordx4 v45, s[16:19], s49 offen offset:3072 lds
    v_mfma_f32_16x16x32_bf16 v[140:143], a[168:171], a[68:71], v[140:143]
    s_waitcnt lgkmcnt(7)
    ds_read_b64_tr_b16 a[190:191], v15 offset:12288
    ds_read_b64_tr_b16 a[160:161], v16 offset:0
    v_mfma_f32_16x16x32_bf16 v[140:143], a[172:175], a[76:79], v[140:143]
    s_add_u32 s49, s44, 4194304
    ds_read_b64_tr_b16 a[162:163], v16 offset:4096
    v_mfma_f32_16x16x32_bf16 v[136:139], a[172:175], a[72:75], v[136:139]
    s_add_u32 m0, s42, 81920
    ds_read_b64_tr_b16 a[164:165], v16 offset:8192
    v_mfma_f32_16x16x32_bf16 v[136:139], a[168:171], a[64:67], v[136:139]
    s_waitcnt lgkmcnt(9)
    buffer_load_dwordx4 v42, s[16:19], s49 offen lds
    v_mfma_f32_16x16x32_bf16 v[144:147], a[176:179], a[64:67], v[144:147]
    s_waitcnt lgkmcnt(7)
    ds_read_b64_tr_b16 a[166:167], v16 offset:12288
    ds_read_b64_tr_b16 a[168:169], v17 offset:0
    v_mfma_f32_16x16x32_bf16 v[144:147], a[180:183], a[72:75], v[144:147]
    ds_read_b64_tr_b16 a[170:171], v17 offset:4096
    v_mfma_f32_16x16x32_bf16 v[148:151], a[180:183], a[76:79], v[148:151]
    ds_read_b64_tr_b16 a[172:173], v17 offset:8192
    v_mfma_f32_16x16x32_bf16 v[148:151], a[176:179], a[68:71], v[148:151]
    s_waitcnt lgkmcnt(9)
    buffer_load_dwordx4 v43, s[16:19], s49 offen offset:1024 lds
    v_mfma_f32_16x16x32_bf16 v[156:159], a[184:187], a[68:71], v[156:159]
    s_waitcnt lgkmcnt(7)
    ds_read_b64_tr_b16 a[174:175], v17 offset:12288
    ds_read_b64_tr_b16 a[176:177], v18 offset:0
    v_mfma_f32_16x16x32_bf16 v[156:159], a[188:191], a[76:79], v[156:159]
    ds_read_b64_tr_b16 a[178:179], v18 offset:4096
    v_mfma_f32_16x16x32_bf16 v[152:155], a[188:191], a[72:75], v[152:155]
    ds_read_b64_tr_b16 a[180:181], v18 offset:8192
    v_mfma_f32_16x16x32_bf16 v[152:155], a[184:187], a[64:67], v[152:155]
    s_waitcnt lgkmcnt(9)
    buffer_load_dwordx4 v44, s[16:19], s49 offen offset:2048 lds
    v_mfma_f32_16x16x32_bf16 v[160:163], a[160:163], a[64:67], v[160:163]
    s_waitcnt lgkmcnt(7)
    ds_read_b64_tr_b16 a[182:183], v18 offset:12288
    ds_read_b64_tr_b16 a[184:185], v19 offset:0
    v_mfma_f32_16x16x32_bf16 v[160:163], a[164:167], a[72:75], v[160:163]
    ds_read_b64_tr_b16 a[186:187], v19 offset:4096
    v_mfma_f32_16x16x32_bf16 v[164:167], a[164:167], a[76:79], v[164:167]
    ds_read_b64_tr_b16 a[188:189], v19 offset:8192
    v_mfma_f32_16x16x32_bf16 v[164:167], a[160:163], a[68:71], v[164:167]
    s_waitcnt lgkmcnt(9)
    buffer_load_dwordx4 v45, s[16:19], s49 offen offset:3072 lds
    v_mfma_f32_16x16x32_bf16 v[172:175], a[168:171], a[68:71], v[172:175]
    s_waitcnt lgkmcnt(7)
    ds_read_b64_tr_b16 a[190:191], v19 offset:12288
    ds_read_b64_tr_b16 a[160:161], v12 offset:16384
    v_mfma_f32_16x16x32_bf16 v[172:175], a[172:175], a[76:79], v[172:175]
    ds_read_b64_tr_b16 a[162:163], v12 offset:20480
    v_mfma_f32_16x16x32_bf16 v[168:171], a[172:175], a[72:75], v[168:171]
    ds_read_b64_tr_b16 a[164:165], v12 offset:24576
    v_mfma_f32_16x16x32_bf16 v[168:171], a[168:171], a[64:67], v[168:171]
    s_waitcnt lgkmcnt(9)
    buffer_load_dwordx4 a[112:115], v51, s[24:27], s46 offen offset:1792 sc1
    v_mfma_f32_16x16x32_bf16 v[176:179], a[176:179], a[64:67], v[176:179]
    s_waitcnt lgkmcnt(7)
    ds_read_b64_tr_b16 a[166:167], v12 offset:28672
    ds_read_b64_tr_b16 a[168:169], v13 offset:16384
    v_mfma_f32_16x16x32_bf16 v[176:179], a[180:183], a[72:75], v[176:179]
    ds_read_b64_tr_b16 a[170:171], v13 offset:20480
    v_mfma_f32_16x16x32_bf16 v[180:183], a[180:183], a[76:79], v[180:183]
    ds_read_b64_tr_b16 a[172:173], v13 offset:24576
    v_mfma_f32_16x16x32_bf16 v[180:183], a[176:179], a[68:71], v[180:183]
    s_waitcnt lgkmcnt(9)
    buffer_load_dwordx4 a[120:123], v51, s[24:27], s46 offen offset:1920 sc1
    v_mfma_f32_16x16x32_bf16 v[188:191], a[184:187], a[68:71], v[188:191]
    s_waitcnt lgkmcnt(7)
    ds_read_b64_tr_b16 a[174:175], v13 offset:28672
    ds_read_b64_tr_b16 a[176:177], v14 offset:16384
    v_mfma_f32_16x16x32_bf16 v[188:191], a[188:191], a[76:79], v[188:191]
    ds_read_b64_tr_b16 a[178:179], v14 offset:20480
    v_mfma_f32_16x16x32_bf16 v[184:187], a[188:191], a[72:75], v[184:187]
    ds_read_b64_tr_b16 a[180:181], v14 offset:24576
    v_mfma_f32_16x16x32_bf16 v[184:187], a[184:187], a[64:67], v[184:187]
    s_waitcnt lgkmcnt(9)
    buffer_load_dwordx4 a[116:119], v51, s[24:27], s43 offen offset:1792 sc1
    v_mfma_f32_16x16x32_bf16 v[192:195], a[160:163], a[64:67], v[192:195]
    s_waitcnt lgkmcnt(7)
    ds_read_b64_tr_b16 a[182:183], v14 offset:28672
    ds_read_b64_tr_b16 a[184:185], v15 offset:16384
    v_mfma_f32_16x16x32_bf16 v[192:195], a[164:167], a[72:75], v[192:195]
    ds_read_b64_tr_b16 a[186:187], v15 offset:20480
    v_mfma_f32_16x16x32_bf16 v[196:199], a[164:167], a[76:79], v[196:199]
    ds_read_b64_tr_b16 a[188:189], v15 offset:24576
    v_mfma_f32_16x16x32_bf16 v[196:199], a[160:163], a[68:71], v[196:199]
    s_waitcnt lgkmcnt(9)
    buffer_load_dwordx4 a[124:127], v51, s[24:27], s43 offen offset:1920 sc1
    v_mfma_f32_16x16x32_bf16 v[204:207], a[168:171], a[68:71], v[204:207]
    s_waitcnt lgkmcnt(7)
    ds_read_b64_tr_b16 a[190:191], v15 offset:28672
    ds_read_b64_tr_b16 a[160:161], v16 offset:16384
    v_mfma_f32_16x16x32_bf16 v[204:207], a[172:175], a[76:79], v[204:207]
    ds_read_b64_tr_b16 a[162:163], v16 offset:20480
    v_mfma_f32_16x16x32_bf16 v[200:203], a[172:175], a[72:75], v[200:203]
    ds_read_b64_tr_b16 a[164:165], v16 offset:24576
    v_mfma_f32_16x16x32_bf16 v[200:203], a[168:171], a[64:67], v[200:203]
    s_waitcnt lgkmcnt(9)
    ds_read_b64_tr_b16 a[166:167], v16 offset:28672
    v_mfma_f32_16x16x32_bf16 v[208:211], a[176:179], a[64:67], v[208:211]
    s_waitcnt lgkmcnt(8)
    ds_read_b64_tr_b16 a[168:169], v17 offset:16384
    v_mfma_f32_16x16x32_bf16 v[208:211], a[180:183], a[72:75], v[208:211]
    ds_read_b64_tr_b16 a[170:171], v17 offset:20480
    v_mfma_f32_16x16x32_bf16 v[212:215], a[180:183], a[76:79], v[212:215]
    ds_read_b64_tr_b16 a[172:173], v17 offset:24576
    v_mfma_f32_16x16x32_bf16 v[212:215], a[176:179], a[68:71], v[212:215]
    s_waitcnt lgkmcnt(9)
    ds_read_b64_tr_b16 a[174:175], v17 offset:28672
    v_mfma_f32_16x16x32_bf16 v[220:223], a[184:187], a[68:71], v[220:223]
    s_waitcnt lgkmcnt(8)
    ds_read_b64_tr_b16 a[176:177], v18 offset:16384
    v_mfma_f32_16x16x32_bf16 v[220:223], a[188:191], a[76:79], v[220:223]
    ds_read_b64_tr_b16 a[178:179], v18 offset:20480
    v_mfma_f32_16x16x32_bf16 v[216:219], a[188:191], a[72:75], v[216:219]
    ds_read_b64_tr_b16 a[180:181], v18 offset:24576
    v_mfma_f32_16x16x32_bf16 v[216:219], a[184:187], a[64:67], v[216:219]
    s_waitcnt lgkmcnt(9)
    ds_read_b64_tr_b16 a[182:183], v18 offset:28672
    v_mfma_f32_16x16x32_bf16 v[224:227], a[160:163], a[64:67], v[224:227]
    s_waitcnt lgkmcnt(8)
    ds_read_b64_tr_b16 a[184:185], v19 offset:16384
    v_mfma_f32_16x16x32_bf16 v[224:227], a[164:167], a[72:75], v[224:227]
    ds_read_b64_tr_b16 a[186:187], v19 offset:20480
    v_mfma_f32_16x16x32_bf16 v[228:231], a[164:167], a[76:79], v[228:231]
    ds_read_b64_tr_b16 a[188:189], v19 offset:24576
    v_mfma_f32_16x16x32_bf16 v[228:231], a[160:163], a[68:71], v[228:231]
    s_waitcnt lgkmcnt(9)
    ds_read_b64_tr_b16 a[190:191], v19 offset:28672
    s_waitcnt vmcnt(16)
    s_barrier
    v_mfma_f32_16x16x32_bf16 v[236:239], a[168:171], a[68:71], v[236:239]
    s_waitcnt lgkmcnt(8)
    ds_read_b64_tr_b16 a[160:161], v12 offset:32768
    v_mfma_f32_16x16x32_bf16 v[236:239], a[172:175], a[76:79], v[236:239]
    s_add_u32 s49, s44, 2621696
    ds_read_b64_tr_b16 a[162:163], v12 offset:36864
    v_mfma_f32_16x16x32_bf16 v[232:235], a[172:175], a[72:75], v[232:235]
    s_add_u32 m0, s42, 98304
    ds_read_b64_tr_b16 a[164:165], v12 offset:40960
    v_mfma_f32_16x16x32_bf16 v[232:235], a[168:171], a[64:67], v[232:235]
    s_waitcnt lgkmcnt(9)
    buffer_load_dwordx4 v42, s[16:19], s49 offen lds
    v_mfma_f32_16x16x32_bf16 v[240:243], a[176:179], a[64:67], v[240:243]
    s_waitcnt lgkmcnt(7)
    ds_read_b64_tr_b16 a[166:167], v12 offset:45056
    ds_read_b64_tr_b16 a[168:169], v13 offset:32768
    v_mfma_f32_16x16x32_bf16 v[240:243], a[180:183], a[72:75], v[240:243]
    ds_read_b64_tr_b16 a[170:171], v13 offset:36864
    v_mfma_f32_16x16x32_bf16 v[244:247], a[180:183], a[76:79], v[244:247]
    ds_read_b64_tr_b16 a[172:173], v13 offset:40960
    v_mfma_f32_16x16x32_bf16 v[244:247], a[176:179], a[68:71], v[244:247]
    s_waitcnt lgkmcnt(9)
    buffer_load_dwordx4 v43, s[16:19], s49 offen offset:1024 lds
    v_mfma_f32_16x16x32_bf16 v[252:255], a[184:187], a[68:71], v[252:255]
    s_waitcnt lgkmcnt(7)
    ds_read_b64_tr_b16 a[174:175], v13 offset:45056
    ds_read_b64_tr_b16 a[176:177], v14 offset:32768
    v_mfma_f32_16x16x32_bf16 v[252:255], a[188:191], a[76:79], v[252:255]
    ds_read_b64_tr_b16 a[178:179], v14 offset:36864
    v_mfma_f32_16x16x32_bf16 v[248:251], a[188:191], a[72:75], v[248:251]
    ds_read_b64_tr_b16 a[180:181], v14 offset:40960
    v_mfma_f32_16x16x32_bf16 v[248:251], a[184:187], a[64:67], v[248:251]
    s_waitcnt lgkmcnt(9)
    buffer_load_dwordx4 v44, s[16:19], s49 offen offset:2048 lds
    v_mfma_f32_16x16x32_bf16 v[128:131], a[160:163], a[80:83], v[128:131]
    s_waitcnt lgkmcnt(7)
    ds_read_b64_tr_b16 a[182:183], v14 offset:45056
    ds_read_b64_tr_b16 a[184:185], v15 offset:32768
    v_mfma_f32_16x16x32_bf16 v[128:131], a[164:167], a[88:91], v[128:131]
    ds_read_b64_tr_b16 a[186:187], v15 offset:36864
    v_mfma_f32_16x16x32_bf16 v[132:135], a[164:167], a[92:95], v[132:135]
    ds_read_b64_tr_b16 a[188:189], v15 offset:40960
    v_mfma_f32_16x16x32_bf16 v[132:135], a[160:163], a[84:87], v[132:135]
    s_waitcnt lgkmcnt(9)
    buffer_load_dwordx4 v45, s[16:19], s49 offen offset:3072 lds
    v_mfma_f32_16x16x32_bf16 v[140:143], a[168:171], a[84:87], v[140:143]
    s_waitcnt lgkmcnt(7)
    ds_read_b64_tr_b16 a[190:191], v15 offset:45056
    ds_read_b64_tr_b16 a[160:161], v16 offset:32768
    v_mfma_f32_16x16x32_bf16 v[140:143], a[172:175], a[92:95], v[140:143]
    s_add_u32 s49, s44, 3145984
    ds_read_b64_tr_b16 a[162:163], v16 offset:36864
    v_mfma_f32_16x16x32_bf16 v[136:139], a[172:175], a[88:91], v[136:139]
    s_add_u32 m0, s42, 114688
    ds_read_b64_tr_b16 a[164:165], v16 offset:40960
    v_mfma_f32_16x16x32_bf16 v[136:139], a[168:171], a[80:83], v[136:139]
    s_waitcnt lgkmcnt(9)
    buffer_load_dwordx4 v42, s[16:19], s49 offen lds
    v_mfma_f32_16x16x32_bf16 v[144:147], a[176:179], a[80:83], v[144:147]
    s_waitcnt lgkmcnt(7)
    ds_read_b64_tr_b16 a[166:167], v16 offset:45056
    ds_read_b64_tr_b16 a[168:169], v17 offset:32768
    v_mfma_f32_16x16x32_bf16 v[144:147], a[180:183], a[88:91], v[144:147]
    ds_read_b64_tr_b16 a[170:171], v17 offset:36864
    v_mfma_f32_16x16x32_bf16 v[148:151], a[180:183], a[92:95], v[148:151]
    ds_read_b64_tr_b16 a[172:173], v17 offset:40960
    v_mfma_f32_16x16x32_bf16 v[148:151], a[176:179], a[84:87], v[148:151]
    s_waitcnt lgkmcnt(9)
    buffer_load_dwordx4 v43, s[16:19], s49 offen offset:1024 lds
    v_mfma_f32_16x16x32_bf16 v[156:159], a[184:187], a[84:87], v[156:159]
    s_waitcnt lgkmcnt(7)
    ds_read_b64_tr_b16 a[174:175], v17 offset:45056
    ds_read_b64_tr_b16 a[176:177], v18 offset:32768
    v_mfma_f32_16x16x32_bf16 v[156:159], a[188:191], a[92:95], v[156:159]
    ds_read_b64_tr_b16 a[178:179], v18 offset:36864
    v_mfma_f32_16x16x32_bf16 v[152:155], a[188:191], a[88:91], v[152:155]
    ds_read_b64_tr_b16 a[180:181], v18 offset:40960
    v_mfma_f32_16x16x32_bf16 v[152:155], a[184:187], a[80:83], v[152:155]
    s_waitcnt lgkmcnt(9)
    buffer_load_dwordx4 v44, s[16:19], s49 offen offset:2048 lds
    v_mfma_f32_16x16x32_bf16 v[160:163], a[160:163], a[80:83], v[160:163]
    s_waitcnt lgkmcnt(7)
    ds_read_b64_tr_b16 a[182:183], v18 offset:45056
    ds_read_b64_tr_b16 a[184:185], v19 offset:32768
    v_mfma_f32_16x16x32_bf16 v[160:163], a[164:167], a[88:91], v[160:163]
    ds_read_b64_tr_b16 a[186:187], v19 offset:36864
    v_mfma_f32_16x16x32_bf16 v[164:167], a[164:167], a[92:95], v[164:167]
    ds_read_b64_tr_b16 a[188:189], v19 offset:40960
    v_mfma_f32_16x16x32_bf16 v[164:167], a[160:163], a[84:87], v[164:167]
    s_waitcnt lgkmcnt(9)
    buffer_load_dwordx4 v45, s[16:19], s49 offen offset:3072 lds
    v_mfma_f32_16x16x32_bf16 v[172:175], a[168:171], a[84:87], v[172:175]
    s_waitcnt lgkmcnt(7)
    ds_read_b64_tr_b16 a[190:191], v19 offset:45056
    ds_read_b64_tr_b16 a[160:161], v12 offset:49152
    v_mfma_f32_16x16x32_bf16 v[172:175], a[172:175], a[92:95], v[172:175]
    ds_read_b64_tr_b16 a[162:163], v12 offset:53248
    v_mfma_f32_16x16x32_bf16 v[168:171], a[172:175], a[88:91], v[168:171]
    ds_read_b64_tr_b16 a[164:165], v12 offset:57344
    v_mfma_f32_16x16x32_bf16 v[168:171], a[168:171], a[80:83], v[168:171]
    s_waitcnt lgkmcnt(9)
    buffer_load_dwordx4 a[128:131], v51, s[24:27], s46 offen offset:2048 sc1
    v_mfma_f32_16x16x32_bf16 v[176:179], a[176:179], a[80:83], v[176:179]
    s_waitcnt lgkmcnt(7)
    ds_read_b64_tr_b16 a[166:167], v12 offset:61440
    ds_read_b64_tr_b16 a[168:169], v13 offset:49152
    v_mfma_f32_16x16x32_bf16 v[176:179], a[180:183], a[88:91], v[176:179]
    ds_read_b64_tr_b16 a[170:171], v13 offset:53248
    v_mfma_f32_16x16x32_bf16 v[180:183], a[180:183], a[92:95], v[180:183]
    ds_read_b64_tr_b16 a[172:173], v13 offset:57344
    v_mfma_f32_16x16x32_bf16 v[180:183], a[176:179], a[84:87], v[180:183]
    s_waitcnt lgkmcnt(9)
    buffer_load_dwordx4 a[136:139], v51, s[24:27], s46 offen offset:2176 sc1
    v_mfma_f32_16x16x32_bf16 v[188:191], a[184:187], a[84:87], v[188:191]
    s_waitcnt lgkmcnt(7)
    ds_read_b64_tr_b16 a[174:175], v13 offset:61440
    ds_read_b64_tr_b16 a[176:177], v14 offset:49152
    v_mfma_f32_16x16x32_bf16 v[188:191], a[188:191], a[92:95], v[188:191]
    ds_read_b64_tr_b16 a[178:179], v14 offset:53248
    v_mfma_f32_16x16x32_bf16 v[184:187], a[188:191], a[88:91], v[184:187]
    ds_read_b64_tr_b16 a[180:181], v14 offset:57344
    v_mfma_f32_16x16x32_bf16 v[184:187], a[184:187], a[80:83], v[184:187]
    s_waitcnt vmcnt(25)
    s_waitcnt lgkmcnt(9)
    buffer_load_dwordx4 a[132:135], v51, s[24:27], s43 offen offset:2048 sc1
    v_mfma_f32_16x16x32_bf16 v[128:131], a[160:163], a[96:99], v[128:131]
    s_waitcnt vmcnt(25)
    s_waitcnt lgkmcnt(7)
    ds_read_b64_tr_b16 a[182:183], v14 offset:61440
    ds_read_b64_tr_b16 a[184:185], v15 offset:49152
    v_mfma_f32_16x16x32_bf16 v[128:131], a[164:167], a[104:107], v[128:131]
    s_waitcnt vmcnt(23)
    ds_read_b64_tr_b16 a[186:187], v15 offset:53248
    v_mfma_f32_16x16x32_bf16 v[132:135], a[164:167], a[108:111], v[132:135]
    ds_read_b64_tr_b16 a[188:189], v15 offset:57344
    v_mfma_f32_16x16x32_bf16 v[132:135], a[160:163], a[100:103], v[132:135]
    s_waitcnt lgkmcnt(9)
    buffer_load_dwordx4 a[140:143], v51, s[24:27], s43 offen offset:2176 sc1
    v_mfma_f32_16x16x32_bf16 v[140:143], a[168:171], a[100:103], v[140:143]
    s_waitcnt lgkmcnt(7)
    ds_read_b64_tr_b16 a[190:191], v15 offset:61440
    ds_read_b64_tr_b16 a[160:161], v16 offset:49152
    v_mfma_f32_16x16x32_bf16 v[140:143], a[172:175], a[108:111], v[140:143]
    ds_read_b64_tr_b16 a[162:163], v16 offset:53248
    v_mfma_f32_16x16x32_bf16 v[136:139], a[172:175], a[104:107], v[136:139]
    ds_read_b64_tr_b16 a[164:165], v16 offset:57344
    v_mfma_f32_16x16x32_bf16 v[136:139], a[168:171], a[96:99], v[136:139]
    s_waitcnt lgkmcnt(9)
    ds_read_b64_tr_b16 a[166:167], v16 offset:61440
    v_mfma_f32_16x16x32_bf16 v[144:147], a[176:179], a[96:99], v[144:147]
    s_waitcnt lgkmcnt(8)
    ds_read_b64_tr_b16 a[168:169], v17 offset:49152
    v_mfma_f32_16x16x32_bf16 v[144:147], a[180:183], a[104:107], v[144:147]
    ds_read_b64_tr_b16 a[170:171], v17 offset:53248
    v_mfma_f32_16x16x32_bf16 v[148:151], a[180:183], a[108:111], v[148:151]
    ds_read_b64_tr_b16 a[172:173], v17 offset:57344
    v_mfma_f32_16x16x32_bf16 v[148:151], a[176:179], a[100:103], v[148:151]
    s_waitcnt lgkmcnt(9)
    ds_read_b64_tr_b16 a[174:175], v17 offset:61440
    v_mfma_f32_16x16x32_bf16 v[156:159], a[184:187], a[100:103], v[156:159]
    s_waitcnt lgkmcnt(8)
    ds_read_b64_tr_b16 a[176:177], v18 offset:49152
    v_mfma_f32_16x16x32_bf16 v[156:159], a[188:191], a[108:111], v[156:159]
    ds_read_b64_tr_b16 a[178:179], v18 offset:53248
    v_mfma_f32_16x16x32_bf16 v[152:155], a[188:191], a[104:107], v[152:155]
    ds_read_b64_tr_b16 a[180:181], v18 offset:57344
    v_mfma_f32_16x16x32_bf16 v[152:155], a[184:187], a[96:99], v[152:155]
    s_waitcnt lgkmcnt(9)
    ds_read_b64_tr_b16 a[182:183], v18 offset:61440
    v_mfma_f32_16x16x32_bf16 v[160:163], a[160:163], a[96:99], v[160:163]
    s_waitcnt lgkmcnt(8)
    ds_read_b64_tr_b16 a[184:185], v19 offset:49152
    v_mfma_f32_16x16x32_bf16 v[160:163], a[164:167], a[104:107], v[160:163]
    ds_read_b64_tr_b16 a[186:187], v19 offset:53248
    v_mfma_f32_16x16x32_bf16 v[164:167], a[164:167], a[108:111], v[164:167]
    ds_read_b64_tr_b16 a[188:189], v19 offset:57344
    v_mfma_f32_16x16x32_bf16 v[164:167], a[160:163], a[100:103], v[164:167]
    s_waitcnt lgkmcnt(9)
    ds_read_b64_tr_b16 a[190:191], v19 offset:61440
    s_waitcnt vmcnt(16)
    s_barrier
    v_mfma_f32_16x16x32_bf16 v[172:175], a[168:171], a[100:103], v[172:175]
    s_waitcnt lgkmcnt(8)
    ds_read_b64_tr_b16 a[160:161], v20 offset:0
    v_mfma_f32_16x16x32_bf16 v[172:175], a[172:175], a[108:111], v[172:175]
    s_add_u32 s49, s44, 3670272
    ds_read_b64_tr_b16 a[162:163], v20 offset:4096
    v_mfma_f32_16x16x32_bf16 v[168:171], a[172:175], a[104:107], v[168:171]
    s_add_u32 m0, s42, 131072
    ds_read_b64_tr_b16 a[164:165], v20 offset:8192
    v_mfma_f32_16x16x32_bf16 v[168:171], a[168:171], a[96:99], v[168:171]
    s_waitcnt lgkmcnt(9)
    buffer_load_dwordx4 v42, s[16:19], s49 offen lds
    v_mfma_f32_16x16x32_bf16 v[176:179], a[176:179], a[96:99], v[176:179]
    s_waitcnt lgkmcnt(7)
    ds_read_b64_tr_b16 a[166:167], v20 offset:12288
    ds_read_b64_tr_b16 a[168:169], v21 offset:0
    v_mfma_f32_16x16x32_bf16 v[176:179], a[180:183], a[104:107], v[176:179]
    ds_read_b64_tr_b16 a[170:171], v21 offset:4096
    v_mfma_f32_16x16x32_bf16 v[180:183], a[180:183], a[108:111], v[180:183]
    ds_read_b64_tr_b16 a[172:173], v21 offset:8192
    v_mfma_f32_16x16x32_bf16 v[180:183], a[176:179], a[100:103], v[180:183]
    s_waitcnt lgkmcnt(9)
    buffer_load_dwordx4 v43, s[16:19], s49 offen offset:1024 lds
    v_mfma_f32_16x16x32_bf16 v[188:191], a[184:187], a[100:103], v[188:191]
    s_waitcnt lgkmcnt(7)
    ds_read_b64_tr_b16 a[174:175], v21 offset:12288
    ds_read_b64_tr_b16 a[176:177], v22 offset:0
    v_mfma_f32_16x16x32_bf16 v[188:191], a[188:191], a[108:111], v[188:191]
    ds_read_b64_tr_b16 a[178:179], v22 offset:4096
    v_mfma_f32_16x16x32_bf16 v[184:187], a[188:191], a[104:107], v[184:187]
    ds_read_b64_tr_b16 a[180:181], v22 offset:8192
    v_mfma_f32_16x16x32_bf16 v[184:187], a[184:187], a[96:99], v[184:187]
    s_waitcnt vmcnt(17)
    s_waitcnt lgkmcnt(9)
    buffer_load_dwordx4 v44, s[16:19], s49 offen offset:2048 lds
    v_mfma_f32_16x16x32_bf16 v[128:131], a[160:163], a[112:115], v[128:131]
    s_waitcnt vmcnt(17)
    s_waitcnt lgkmcnt(7)
    ds_read_b64_tr_b16 a[182:183], v22 offset:12288
    ds_read_b64_tr_b16 a[184:185], v23 offset:0
    v_mfma_f32_16x16x32_bf16 v[128:131], a[164:167], a[120:123], v[128:131]
    s_waitcnt vmcnt(15)
    ds_read_b64_tr_b16 a[186:187], v23 offset:4096
    v_mfma_f32_16x16x32_bf16 v[132:135], a[164:167], a[124:127], v[132:135]
    ds_read_b64_tr_b16 a[188:189], v23 offset:8192
    v_mfma_f32_16x16x32_bf16 v[132:135], a[160:163], a[116:119], v[132:135]
    s_waitcnt lgkmcnt(9)
    buffer_load_dwordx4 v45, s[16:19], s49 offen offset:3072 lds
    v_mfma_f32_16x16x32_bf16 v[140:143], a[168:171], a[116:119], v[140:143]
    s_waitcnt lgkmcnt(7)
    ds_read_b64_tr_b16 a[190:191], v23 offset:12288
    ds_read_b64_tr_b16 a[160:161], v24 offset:0
    v_mfma_f32_16x16x32_bf16 v[140:143], a[172:175], a[124:127], v[140:143]
    s_add_u32 s49, s44, 4194560
    ds_read_b64_tr_b16 a[162:163], v24 offset:4096
    v_mfma_f32_16x16x32_bf16 v[136:139], a[172:175], a[120:123], v[136:139]
    s_add_u32 m0, s42, 147456
    ds_read_b64_tr_b16 a[164:165], v24 offset:8192
    v_mfma_f32_16x16x32_bf16 v[136:139], a[168:171], a[112:115], v[136:139]
    s_waitcnt lgkmcnt(9)
    buffer_load_dwordx4 v42, s[16:19], s49 offen lds
    v_mfma_f32_16x16x32_bf16 v[144:147], a[176:179], a[112:115], v[144:147]
    s_waitcnt lgkmcnt(7)
    ds_read_b64_tr_b16 a[166:167], v24 offset:12288
    ds_read_b64_tr_b16 a[168:169], v25 offset:0
    v_mfma_f32_16x16x32_bf16 v[144:147], a[180:183], a[120:123], v[144:147]
    ds_read_b64_tr_b16 a[170:171], v25 offset:4096
    v_mfma_f32_16x16x32_bf16 v[148:151], a[180:183], a[124:127], v[148:151]
    ds_read_b64_tr_b16 a[172:173], v25 offset:8192
    v_mfma_f32_16x16x32_bf16 v[148:151], a[176:179], a[116:119], v[148:151]
    s_waitcnt lgkmcnt(9)
    buffer_load_dwordx4 v43, s[16:19], s49 offen offset:1024 lds
    v_mfma_f32_16x16x32_bf16 v[156:159], a[184:187], a[116:119], v[156:159]
    s_waitcnt lgkmcnt(7)
    ds_read_b64_tr_b16 a[174:175], v25 offset:12288
    ds_read_b64_tr_b16 a[176:177], v26 offset:0
    v_mfma_f32_16x16x32_bf16 v[156:159], a[188:191], a[124:127], v[156:159]
    ds_read_b64_tr_b16 a[178:179], v26 offset:4096
    v_mfma_f32_16x16x32_bf16 v[152:155], a[188:191], a[120:123], v[152:155]
    ds_read_b64_tr_b16 a[180:181], v26 offset:8192
    v_mfma_f32_16x16x32_bf16 v[152:155], a[184:187], a[112:115], v[152:155]
    s_waitcnt lgkmcnt(9)
    buffer_load_dwordx4 v44, s[16:19], s49 offen offset:2048 lds
    v_mfma_f32_16x16x32_bf16 v[160:163], a[160:163], a[112:115], v[160:163]
    s_waitcnt lgkmcnt(7)
    ds_read_b64_tr_b16 a[182:183], v26 offset:12288
    ds_read_b64_tr_b16 a[184:185], v27 offset:0
    v_mfma_f32_16x16x32_bf16 v[160:163], a[164:167], a[120:123], v[160:163]
    ds_read_b64_tr_b16 a[186:187], v27 offset:4096
    v_mfma_f32_16x16x32_bf16 v[164:167], a[164:167], a[124:127], v[164:167]
    ds_read_b64_tr_b16 a[188:189], v27 offset:8192
    v_mfma_f32_16x16x32_bf16 v[164:167], a[160:163], a[116:119], v[164:167]
    s_waitcnt lgkmcnt(9)
    buffer_load_dwordx4 v45, s[16:19], s49 offen offset:3072 lds
    v_mfma_f32_16x16x32_bf16 v[172:175], a[168:171], a[116:119], v[172:175]
    s_waitcnt lgkmcnt(7)
    ds_read_b64_tr_b16 a[190:191], v27 offset:12288
    ds_read_b64_tr_b16 a[160:161], v20 offset:16384
    v_mfma_f32_16x16x32_bf16 v[172:175], a[172:175], a[124:127], v[172:175]
    ds_read_b64_tr_b16 a[162:163], v20 offset:20480
    v_mfma_f32_16x16x32_bf16 v[168:171], a[172:175], a[120:123], v[168:171]
    ds_read_b64_tr_b16 a[164:165], v20 offset:24576
    v_mfma_f32_16x16x32_bf16 v[168:171], a[168:171], a[112:115], v[168:171]
    s_waitcnt lgkmcnt(9)
    buffer_load_dword v78, v120, s[8:11], 0 offen
    v_mfma_f32_16x16x32_bf16 v[176:179], a[176:179], a[112:115], v[176:179]
    s_waitcnt lgkmcnt(7)
    ds_read_b64_tr_b16 a[166:167], v20 offset:28672
    ds_read_b64_tr_b16 a[168:169], v21 offset:16384
    v_mfma_f32_16x16x32_bf16 v[176:179], a[180:183], a[120:123], v[176:179]
    ds_read_b64_tr_b16 a[170:171], v21 offset:20480
    v_mfma_f32_16x16x32_bf16 v[180:183], a[180:183], a[124:127], v[180:183]
    ds_read_b64_tr_b16 a[172:173], v21 offset:24576
    v_mfma_f32_16x16x32_bf16 v[180:183], a[176:179], a[116:119], v[180:183]
    s_waitcnt lgkmcnt(9)
    buffer_load_dword v79, v121, s[12:15], 0 offen
    v_mfma_f32_16x16x32_bf16 v[188:191], a[184:187], a[116:119], v[188:191]
    s_waitcnt lgkmcnt(7)
    ds_read_b64_tr_b16 a[174:175], v21 offset:28672
    ds_read_b64_tr_b16 a[176:177], v22 offset:16384
    v_mfma_f32_16x16x32_bf16 v[188:191], a[188:191], a[124:127], v[188:191]
    ds_read_b64_tr_b16 a[178:179], v22 offset:20480
    v_mfma_f32_16x16x32_bf16 v[184:187], a[188:191], a[120:123], v[184:187]
    s_mov_b32 s36, 1040356334
    ds_read_b64_tr_b16 a[180:181], v22 offset:24576
    v_mfma_f32_16x16x32_bf16 v[184:187], a[184:187], a[112:115], v[184:187]
    s_waitcnt vmcnt(13)
    s_waitcnt lgkmcnt(9)
    buffer_store_dword v76, v72, s[24:27], s92 offen offset:12 sc1
    v_mfma_f32_16x16x32_bf16 v[128:131], a[160:163], a[128:131], v[128:131]
    s_waitcnt vmcnt(13)
    s_waitcnt lgkmcnt(7)
    ds_read_b64_tr_b16 a[182:183], v22 offset:28672
    ds_read_b64_tr_b16 a[184:185], v23 offset:16384
    v_mfma_f32_16x16x32_bf16 v[128:131], a[164:167], a[136:139], v[128:131]
    s_waitcnt vmcnt(11)
    ds_read_b64_tr_b16 a[186:187], v23 offset:20480
    v_mfma_f32_16x16x32_bf16 v[132:135], a[164:167], a[140:143], v[132:135]
    ds_read_b64_tr_b16 a[188:189], v23 offset:24576
    v_mfma_f32_16x16x32_bf16 v[132:135], a[160:163], a[132:135], v[132:135]
    s_waitcnt lgkmcnt(9)
    buffer_store_dwordx4 v[88:91], v74, s[24:27], 0 offen sc1
    v_mfma_f32_16x16x32_bf16 v[140:143], a[168:171], a[132:135], v[140:143]
    s_waitcnt lgkmcnt(7)
    ds_read_b64_tr_b16 a[190:191], v23 offset:28672
    ds_read_b64_tr_b16 a[160:161], v24 offset:16384
    v_mfma_f32_16x16x32_bf16 v[140:143], a[172:175], a[140:143], v[140:143]
    ds_read_b64_tr_b16 a[162:163], v24 offset:20480
    v_mfma_f32_16x16x32_bf16 v[136:139], a[172:175], a[136:139], v[136:139]
    ds_read_b64_tr_b16 a[164:165], v24 offset:24576
    v_mfma_f32_16x16x32_bf16 v[136:139], a[168:171], a[128:131], v[136:139]
    s_waitcnt lgkmcnt(9)
    ds_read_b64_tr_b16 a[166:167], v24 offset:28672
    v_mfma_f32_16x16x32_bf16 v[144:147], a[176:179], a[128:131], v[144:147]
    s_waitcnt lgkmcnt(8)
    ds_read_b64_tr_b16 a[168:169], v25 offset:16384
    v_mfma_f32_16x16x32_bf16 v[144:147], a[180:183], a[136:139], v[144:147]
    ds_read_b64_tr_b16 a[170:171], v25 offset:20480
    v_mfma_f32_16x16x32_bf16 v[148:151], a[180:183], a[140:143], v[148:151]
    ds_read_b64_tr_b16 a[172:173], v25 offset:24576
    v_mfma_f32_16x16x32_bf16 v[148:151], a[176:179], a[132:135], v[148:151]
    s_waitcnt lgkmcnt(9)
    ds_read_b64_tr_b16 a[174:175], v25 offset:28672
    v_mul_f32 v128, s36, v128
    v_mfma_f32_16x16x32_bf16 v[156:159], a[184:187], a[132:135], v[156:159]
    s_waitcnt lgkmcnt(8)
    ds_read_b64_tr_b16 a[176:177], v26 offset:16384
    v_mul_f32 v129, s36, v129
    v_mfma_f32_16x16x32_bf16 v[156:159], a[188:191], a[140:143], v[156:159]
    ds_read_b64_tr_b16 a[178:179], v26 offset:20480
    v_mul_f32 v130, s36, v130
    v_mfma_f32_16x16x32_bf16 v[152:155], a[188:191], a[136:139], v[152:155]
    ds_read_b64_tr_b16 a[180:181], v26 offset:24576
    v_mul_f32 v131, s36, v131
    v_mfma_f32_16x16x32_bf16 v[152:155], a[184:187], a[128:131], v[152:155]
    s_waitcnt lgkmcnt(9)
    ds_read_b64_tr_b16 a[182:183], v26 offset:28672
    v_mul_f32 v136, s36, v136
    v_mfma_f32_16x16x32_bf16 v[160:163], a[160:163], a[128:131], v[160:163]
    s_waitcnt lgkmcnt(8)
    ds_read_b64_tr_b16 a[184:185], v27 offset:16384
    v_mul_f32 v137, s36, v137
    v_mfma_f32_16x16x32_bf16 v[160:163], a[164:167], a[136:139], v[160:163]
    ds_read_b64_tr_b16 a[186:187], v27 offset:20480
    v_mul_f32 v138, s36, v138
    v_mfma_f32_16x16x32_bf16 v[164:167], a[164:167], a[140:143], v[164:167]
    ds_read_b64_tr_b16 a[188:189], v27 offset:24576
    v_mul_f32 v139, s36, v139
    v_mfma_f32_16x16x32_bf16 v[164:167], a[160:163], a[132:135], v[164:167]
    s_waitcnt lgkmcnt(9)
    ds_read_b64_tr_b16 a[190:191], v27 offset:28672
    v_mul_f32 v132, s36, v132
    s_barrier
    v_mfma_f32_16x16x32_bf16 v[172:175], a[168:171], a[132:135], v[172:175]
    s_waitcnt lgkmcnt(8)
    ds_read_b64_tr_b16 a[160:161], v20 offset:32768
    v_mul_f32 v133, s36, v133
    v_mfma_f32_16x16x32_bf16 v[172:175], a[172:175], a[140:143], v[172:175]
    ds_read_b64_tr_b16 a[162:163], v20 offset:36864
    v_mul_f32 v134, s36, v134
    v_mfma_f32_16x16x32_bf16 v[168:171], a[172:175], a[136:139], v[168:171]
    s_add_u32 m0, s42, 0
    ds_read_b64_tr_b16 a[164:165], v20 offset:40960
    v_mul_f32 v135, s36, v135
    v_mfma_f32_16x16x32_bf16 v[168:171], a[168:171], a[128:131], v[168:171]
    s_waitcnt lgkmcnt(9)
    buffer_load_dwordx4 v36, s[8:11], s40 offen lds
    v_mfma_f32_16x16x32_bf16 v[176:179], a[176:179], a[128:131], v[176:179]
    s_waitcnt lgkmcnt(7)
    ds_read_b64_tr_b16 a[166:167], v20 offset:45056
    ds_read_b64_tr_b16 a[168:169], v21 offset:32768
    v_mfma_f32_16x16x32_bf16 v[176:179], a[180:183], a[136:139], v[176:179]
    ds_read_b64_tr_b16 a[170:171], v21 offset:36864
    v_mul_f32 v140, s36, v140
    v_mfma_f32_16x16x32_bf16 v[180:183], a[180:183], a[140:143], v[180:183]
    ds_read_b64_tr_b16 a[172:173], v21 offset:40960
    v_mul_f32 v141, s36, v141
    v_mfma_f32_16x16x32_bf16 v[180:183], a[176:179], a[132:135], v[180:183]
    s_waitcnt lgkmcnt(9)
    buffer_load_dwordx4 v37, s[8:11], s40 offen offset:1024 lds
    v_mfma_f32_16x16x32_bf16 v[188:191], a[184:187], a[132:135], v[188:191]
    s_waitcnt lgkmcnt(7)
    ds_read_b64_tr_b16 a[174:175], v21 offset:45056
    ds_read_b64_tr_b16 a[176:177], v22 offset:32768
    v_mfma_f32_16x16x32_bf16 v[188:191], a[188:191], a[140:143], v[188:191]
    ds_read_b64_tr_b16 a[178:179], v22 offset:36864
    v_mul_f32 v142, s36, v142
    v_mfma_f32_16x16x32_bf16 v[184:187], a[188:191], a[136:139], v[184:187]
    ds_read_b64_tr_b16 a[180:181], v22 offset:40960
    v_mul_f32 v143, s36, v143
    v_mfma_f32_16x16x32_bf16 v[184:187], a[184:187], a[128:131], v[184:187]
    s_waitcnt lgkmcnt(9)
    buffer_load_dwordx4 v38, s[8:11], s40 offen offset:2048 lds
    v_mfma_f32_16x16x32_bf16 v[192:195], a[160:163], a[80:83], v[192:195]
    s_waitcnt lgkmcnt(7)
    ds_read_b64_tr_b16 a[182:183], v22 offset:45056
    ds_read_b64_tr_b16 a[184:185], v23 offset:32768
    v_mfma_f32_16x16x32_bf16 v[192:195], a[164:167], a[88:91], v[192:195]
    ds_read_b64_tr_b16 a[186:187], v23 offset:36864
    v_cvt_pk_bf16_f32 v64, v128, v129
    v_mfma_f32_16x16x32_bf16 v[196:199], a[164:167], a[92:95], v[196:199]
Ltour0_2:
    s_cbranch_execz Ltour0_6
    ds_read_b64_tr_b16 a[188:189], v23 offset:40960
    v_cvt_pk_bf16_f32 v65, v130, v131
    v_mfma_f32_16x16x32_bf16 v[196:199], a[160:163], a[84:87], v[196:199]
    s_waitcnt lgkmcnt(9)
    buffer_load_dwordx4 v39, s[8:11], s40 offen offset:3072 lds
    v_mfma_f32_16x16x32_bf16 v[204:207], a[168:171], a[84:87], v[204:207]
    s_waitcnt lgkmcnt(7)
    s_add_u32 s40, s40, 16384
    ds_read_b64_tr_b16 a[190:191], v23 offset:45056
    ds_read_b64_tr_b16 a[160:161], v24 offset:32768
    v_mfma_f32_16x16x32_bf16 v[204:207], a[172:175], a[92:95], v[204:207]
    ds_read_b64_tr_b16 a[162:163], v24 offset:36864
    v_cvt_pk_bf16_f32 v66, v136, v137
    v_mfma_f32_16x16x32_bf16 v[200:203], a[172:175], a[88:91], v[200:203]
    s_add_u32 m0, s42, 16384
    ds_read_b64_tr_b16 a[164:165], v24 offset:40960
    v_cvt_pk_bf16_f32 v67, v138, v139
    v_mfma_f32_16x16x32_bf16 v[200:203], a[168:171], a[80:83], v[200:203]
    s_waitcnt lgkmcnt(9)
    buffer_load_dwordx4 v36, s[8:11], s40 offen lds
    v_mfma_f32_16x16x32_bf16 v[208:211], a[176:179], a[80:83], v[208:211]
    s_waitcnt lgkmcnt(7)
    ds_read_b64_tr_b16 a[166:167], v24 offset:45056
    ds_read_b64_tr_b16 a[168:169], v25 offset:32768
    v_mfma_f32_16x16x32_bf16 v[208:211], a[180:183], a[88:91], v[208:211]
    ds_read_b64_tr_b16 a[170:171], v25 offset:36864
    v_cvt_pk_bf16_f32 v80, v132, v133
    v_mfma_f32_16x16x32_bf16 v[212:215], a[180:183], a[92:95], v[212:215]
    ds_read_b64_tr_b16 a[172:173], v25 offset:40960
    v_cvt_pk_bf16_f32 v81, v134, v135
    v_mfma_f32_16x16x32_bf16 v[212:215], a[176:179], a[84:87], v[212:215]
    s_waitcnt lgkmcnt(9)
    buffer_load_dwordx4 v37, s[8:11], s40 offen offset:1024 lds
    v_mfma_f32_16x16x32_bf16 v[220:223], a[184:187], a[84:87], v[220:223]
    s_waitcnt lgkmcnt(7)
    ds_read_b64_tr_b16 a[174:175], v25 offset:45056
    ds_read_b64_tr_b16 a[176:177], v26 offset:32768
    v_mfma_f32_16x16x32_bf16 v[220:223], a[188:191], a[92:95], v[220:223]
    ds_read_b64_tr_b16 a[178:179], v26 offset:36864
    v_cvt_pk_bf16_f32 v82, v140, v141
    v_mfma_f32_16x16x32_bf16 v[216:219], a[188:191], a[88:91], v[216:219]
    ds_read_b64_tr_b16 a[180:181], v26 offset:40960
    v_cvt_pk_bf16_f32 v83, v142, v143
    v_mfma_f32_16x16x32_bf16 v[216:219], a[184:187], a[80:83], v[216:219]
    s_waitcnt lgkmcnt(9)
    buffer_load_dwordx4 v38, s[8:11], s40 offen offset:2048 lds
    v_mfma_f32_16x16x32_bf16 v[224:227], a[160:163], a[80:83], v[224:227]
    s_waitcnt lgkmcnt(7)
    ds_read_b64_tr_b16 a[182:183], v26 offset:45056
    ds_read_b64_tr_b16 a[184:185], v27 offset:32768
    v_mfma_f32_16x16x32_bf16 v[224:227], a[164:167], a[88:91], v[224:227]
    ds_read_b64_tr_b16 a[186:187], v27 offset:36864
    v_permlane32_swap_b32 v64, v66
    v_mfma_f32_16x16x32_bf16 v[228:231], a[164:167], a[92:95], v[228:231]
    ds_read_b64_tr_b16 a[188:189], v27 offset:40960
    v_permlane32_swap_b32 v65, v67
    v_mfma_f32_16x16x32_bf16 v[228:231], a[160:163], a[84:87], v[228:231]
    s_waitcnt lgkmcnt(9)
    buffer_load_dwordx4 v39, s[8:11], s40 offen offset:3072 lds
    v_mfma_f32_16x16x32_bf16 v[236:239], a[168:171], a[84:87], v[236:239]
    s_waitcnt lgkmcnt(7)
    s_add_u32 s40, s40, 16384
    ds_read_b64_tr_b16 a[190:191], v27 offset:45056
    ds_read_b64_tr_b16 a[160:161], v20 offset:49152
    v_mfma_f32_16x16x32_bf16 v[236:239], a[172:175], a[92:95], v[236:239]
    ds_read_b64_tr_b16 a[162:163], v20 offset:53248
    v_permlane32_swap_b32 v80, v82
    v_mfma_f32_16x16x32_bf16 v[232:235], a[172:175], a[88:91], v[232:235]
    ds_read_b64_tr_b16 a[164:165], v20 offset:57344
    v_permlane32_swap_b32 v81, v83
    v_mfma_f32_16x16x32_bf16 v[232:235], a[168:171], a[80:83], v[232:235]
    s_waitcnt lgkmcnt(9)
    ds_read_b64_tr_b16 a[166:167], v20 offset:61440
    v_permlane16_swap_b32 v64, v66
    v_mfma_f32_16x16x32_bf16 v[240:243], a[176:179], a[80:83], v[240:243]
    s_waitcnt lgkmcnt(8)
    ds_read_b64_tr_b16 a[168:169], v21 offset:49152
    v_permlane16_swap_b32 v65, v67
    v_mfma_f32_16x16x32_bf16 v[240:243], a[180:183], a[88:91], v[240:243]
    ds_read_b64_tr_b16 a[170:171], v21 offset:53248
    v_permlane16_swap_b32 v80, v82
    v_mfma_f32_16x16x32_bf16 v[244:247], a[180:183], a[92:95], v[244:247]
    ds_read_b64_tr_b16 a[172:173], v21 offset:57344
    v_permlane16_swap_b32 v81, v83
    v_mfma_f32_16x16x32_bf16 v[244:247], a[176:179], a[84:87], v[244:247]
    s_waitcnt lgkmcnt(9)
    ds_read_b64_tr_b16 a[174:175], v21 offset:61440
    v_mul_f32 v144, s36, v144
    v_mfma_f32_16x16x32_bf16 v[252:255], a[184:187], a[84:87], v[252:255]
    s_waitcnt lgkmcnt(8)
    ds_read_b64_tr_b16 a[176:177], v22 offset:49152
    v_mul_f32 v145, s36, v145
    v_mfma_f32_16x16x32_bf16 v[252:255], a[188:191], a[92:95], v[252:255]
    ds_read_b64_tr_b16 a[178:179], v22 offset:53248
    v_mul_f32 v146, s36, v146
    v_mfma_f32_16x16x32_bf16 v[248:251], a[188:191], a[88:91], v[248:251]
    ds_read_b64_tr_b16 a[180:181], v22 offset:57344
    v_mul_f32 v147, s36, v147
    v_mfma_f32_16x16x32_bf16 v[248:251], a[184:187], a[80:83], v[248:251]
    s_waitcnt lgkmcnt(9)
    ds_read_b64_tr_b16 a[182:183], v22 offset:61440
    v_mul_f32 v152, s36, v152
    v_mfma_f32_16x16x32_bf16 v[192:195], a[160:163], a[96:99], v[192:195]
    s_waitcnt lgkmcnt(8)
    ds_read_b64_tr_b16 a[184:185], v23 offset:49152
    v_mul_f32 v153, s36, v153
    v_mfma_f32_16x16x32_bf16 v[192:195], a[164:167], a[104:107], v[192:195]
    ds_read_b64_tr_b16 a[186:187], v23 offset:53248
    v_mul_f32 v154, s36, v154
    v_mfma_f32_16x16x32_bf16 v[196:199], a[164:167], a[108:111], v[196:199]
    ds_read_b64_tr_b16 a[188:189], v23 offset:57344
    v_mul_f32 v155, s36, v155
    v_mfma_f32_16x16x32_bf16 v[196:199], a[160:163], a[100:103], v[196:199]
    s_waitcnt lgkmcnt(9)
    ds_read_b64_tr_b16 a[190:191], v23 offset:61440
    v_mul_f32 v148, s36, v148
    v_mfma_f32_16x16x32_bf16 v[204:207], a[168:171], a[100:103], v[204:207]
    s_waitcnt lgkmcnt(8)
    ds_read_b64_tr_b16 a[160:161], v24 offset:49152
    v_mul_f32 v149, s36, v149
    v_mfma_f32_16x16x32_bf16 v[204:207], a[172:175], a[108:111], v[204:207]
    ds_read_b64_tr_b16 a[162:163], v24 offset:53248
    v_mul_f32 v150, s36, v150
    v_mfma_f32_16x16x32_bf16 v[200:203], a[172:175], a[104:107], v[200:203]
    ds_read_b64_tr_b16 a[164:165], v24 offset:57344
    v_mul_f32 v151, s36, v151
    v_mfma_f32_16x16x32_bf16 v[200:203], a[168:171], a[96:99], v[200:203]
    s_waitcnt lgkmcnt(9)
    ds_read_b64_tr_b16 a[166:167], v24 offset:61440
    v_mul_f32 v156, s36, v156
    v_mfma_f32_16x16x32_bf16 v[208:211], a[176:179], a[96:99], v[208:211]
    s_waitcnt lgkmcnt(8)
    ds_read_b64_tr_b16 a[168:169], v25 offset:49152
    v_mul_f32 v157, s36, v157
    v_mfma_f32_16x16x32_bf16 v[208:211], a[180:183], a[104:107], v[208:211]
    ds_read_b64_tr_b16 a[170:171], v25 offset:53248
    v_mul_f32 v158, s36, v158
    v_mfma_f32_16x16x32_bf16 v[212:215], a[180:183], a[108:111], v[212:215]
    ds_read_b64_tr_b16 a[172:173], v25 offset:57344
    v_mul_f32 v159, s36, v159
    v_mfma_f32_16x16x32_bf16 v[212:215], a[176:179], a[100:103], v[212:215]
    s_waitcnt lgkmcnt(9)
    ds_read_b64_tr_b16 a[174:175], v25 offset:61440
    v_cvt_pk_bf16_f32 v68, v144, v145
    v_mfma_f32_16x16x32_bf16 v[220:223], a[184:187], a[100:103], v[220:223]
    s_waitcnt lgkmcnt(8)
    ds_read_b64_tr_b16 a[176:177], v26 offset:49152
    v_cvt_pk_bf16_f32 v69, v146, v147
    v_mfma_f32_16x16x32_bf16 v[220:223], a[188:191], a[108:111], v[220:223]
    ds_read_b64_tr_b16 a[178:179], v26 offset:53248
    v_cvt_pk_bf16_f32 v70, v152, v153
    v_mfma_f32_16x16x32_bf16 v[216:219], a[188:191], a[104:107], v[216:219]
    ds_read_b64_tr_b16 a[180:181], v26 offset:57344
    v_cvt_pk_bf16_f32 v71, v154, v155
    v_mfma_f32_16x16x32_bf16 v[216:219], a[184:187], a[96:99], v[216:219]
    s_waitcnt lgkmcnt(9)
    ds_read_b64_tr_b16 a[182:183], v26 offset:61440
    v_cvt_pk_bf16_f32 v84, v148, v149
    v_mfma_f32_16x16x32_bf16 v[224:227], a[160:163], a[96:99], v[224:227]
    s_waitcnt lgkmcnt(8)
    ds_read_b64_tr_b16 a[184:185], v27 offset:49152
    v_cvt_pk_bf16_f32 v85, v150, v151
    v_mfma_f32_16x16x32_bf16 v[224:227], a[164:167], a[104:107], v[224:227]
    ds_read_b64_tr_b16 a[186:187], v27 offset:53248
    v_cvt_pk_bf16_f32 v86, v156, v157
    v_mfma_f32_16x16x32_bf16 v[228:231], a[164:167], a[108:111], v[228:231]
    ds_read_b64_tr_b16 a[188:189], v27 offset:57344
    v_cvt_pk_bf16_f32 v87, v158, v159
    v_mfma_f32_16x16x32_bf16 v[228:231], a[160:163], a[100:103], v[228:231]
    s_waitcnt lgkmcnt(9)
    ds_read_b64_tr_b16 a[190:191], v27 offset:61440
    v_permlane32_swap_b32 v68, v70
    s_waitcnt vmcnt(12)
    s_barrier
    v_mfma_f32_16x16x32_bf16 v[236:239], a[168:171], a[100:103], v[236:239]
    s_waitcnt lgkmcnt(8)
    ds_read_b64_tr_b16 a[160:161], v28 offset:0
    v_permlane32_swap_b32 v69, v71
    v_mfma_f32_16x16x32_bf16 v[236:239], a[172:175], a[108:111], v[236:239]
    ds_read_b64_tr_b16 a[162:163], v28 offset:4096
    v_permlane32_swap_b32 v84, v86
    v_mfma_f32_16x16x32_bf16 v[232:235], a[172:175], a[104:107], v[232:235]
    s_add_u32 m0, s42, 32768
    ds_read_b64_tr_b16 a[164:165], v28 offset:8192
    v_permlane32_swap_b32 v85, v87
    v_mfma_f32_16x16x32_bf16 v[232:235], a[168:171], a[96:99], v[232:235]
    s_waitcnt lgkmcnt(9)
    buffer_load_dwordx4 v36, s[8:11], s40 offen lds
    v_mfma_f32_16x16x32_bf16 v[240:243], a[176:179], a[96:99], v[240:243]
    s_waitcnt lgkmcnt(7)
    ds_read_b64_tr_b16 a[166:167], v28 offset:12288
    ds_read_b64_tr_b16 a[168:169], v29 offset:0
    v_mfma_f32_16x16x32_bf16 v[240:243], a[180:183], a[104:107], v[240:243]
    ds_read_b64_tr_b16 a[170:171], v29 offset:4096
    v_permlane16_swap_b32 v68, v70
    v_mfma_f32_16x16x32_bf16 v[244:247], a[180:183], a[108:111], v[244:247]
    ds_read_b64_tr_b16 a[172:173], v29 offset:8192
    v_permlane16_swap_b32 v69, v71
    v_mfma_f32_16x16x32_bf16 v[244:247], a[176:179], a[100:103], v[244:247]
    s_waitcnt lgkmcnt(9)
    buffer_load_dwordx4 v37, s[8:11], s40 offen offset:1024 lds
    v_mfma_f32_16x16x32_bf16 v[252:255], a[184:187], a[100:103], v[252:255]
    s_waitcnt lgkmcnt(7)
    ds_read_b64_tr_b16 a[174:175], v29 offset:12288
    ds_read_b64_tr_b16 a[176:177], v30 offset:0
    v_mfma_f32_16x16x32_bf16 v[252:255], a[188:191], a[108:111], v[252:255]
    ds_read_b64_tr_b16 a[178:179], v30 offset:4096
    v_permlane16_swap_b32 v84, v86
    v_mfma_f32_16x16x32_bf16 v[248:251], a[188:191], a[104:107], v[248:251]
    ds_read_b64_tr_b16 a[180:181], v30 offset:8192
    v_permlane16_swap_b32 v85, v87
    v_mfma_f32_16x16x32_bf16 v[248:251], a[184:187], a[96:99], v[248:251]
    s_waitcnt lgkmcnt(9)
    buffer_load_dwordx4 v38, s[8:11], s40 offen offset:2048 lds
    v_mfma_f32_16x16x32_bf16 v[192:195], a[160:163], a[112:115], v[192:195]
    s_waitcnt lgkmcnt(7)
    ds_read_b64_tr_b16 a[182:183], v30 offset:12288
    ds_read_b64_tr_b16 a[184:185], v31 offset:0
    v_mfma_f32_16x16x32_bf16 v[192:195], a[164:167], a[120:123], v[192:195]
    ds_read_b64_tr_b16 a[186:187], v31 offset:4096
    v_mul_f32 v160, s36, v160
    v_mfma_f32_16x16x32_bf16 v[196:199], a[164:167], a[124:127], v[196:199]
    ds_read_b64_tr_b16 a[188:189], v31 offset:8192
    v_mul_f32 v161, s36, v161
    v_mfma_f32_16x16x32_bf16 v[196:199], a[160:163], a[116:119], v[196:199]
    s_waitcnt lgkmcnt(9)
    buffer_load_dwordx4 v39, s[8:11], s40 offen offset:3072 lds
    v_mfma_f32_16x16x32_bf16 v[204:207], a[168:171], a[116:119], v[204:207]
    s_waitcnt lgkmcnt(7)
    s_add_u32 s40, s40, 16384
    ds_read_b64_tr_b16 a[190:191], v31 offset:12288
    ds_read_b64_tr_b16 a[160:161], v32 offset:0
    v_mfma_f32_16x16x32_bf16 v[204:207], a[172:175], a[124:127], v[204:207]
    ds_read_b64_tr_b16 a[162:163], v32 offset:4096
    v_mul_f32 v162, s36, v162
    v_mfma_f32_16x16x32_bf16 v[200:203], a[172:175], a[120:123], v[200:203]
    s_add_u32 m0, s42, 65536
    ds_read_b64_tr_b16 a[164:165], v32 offset:8192
    v_mul_f32 v163, s36, v163
    v_mfma_f32_16x16x32_bf16 v[200:203], a[168:171], a[112:115], v[200:203]
    s_waitcnt lgkmcnt(9)
    buffer_load_dwordx4 v40, s[12:15], s41 offen lds
    v_mfma_f32_16x16x32_bf16 v[208:211], a[176:179], a[112:115], v[208:211]
    s_waitcnt lgkmcnt(7)
    ds_read_b64_tr_b16 a[166:167], v32 offset:12288
    ds_read_b64_tr_b16 a[168:169], v33 offset:0
    v_mfma_f32_16x16x32_bf16 v[208:211], a[180:183], a[120:123], v[208:211]
    ds_read_b64_tr_b16 a[170:171], v33 offset:4096
    v_mul_f32 v168, s36, v168
    v_mfma_f32_16x16x32_bf16 v[212:215], a[180:183], a[124:127], v[212:215]
    ds_read_b64_tr_b16 a[172:173], v33 offset:8192
    v_mul_f32 v169, s36, v169
    v_mfma_f32_16x16x32_bf16 v[212:215], a[176:179], a[116:119], v[212:215]
    s_waitcnt lgkmcnt(9)
    buffer_load_dwordx4 v41, s[12:15], s41 offen offset:1024 lds
    v_mfma_f32_16x16x32_bf16 v[220:223], a[184:187], a[116:119], v[220:223]
    s_waitcnt lgkmcnt(7)
    ds_read_b64_tr_b16 a[174:175], v33 offset:12288
    ds_read_b64_tr_b16 a[176:177], v34 offset:0
    v_mfma_f32_16x16x32_bf16 v[220:223], a[188:191], a[124:127], v[220:223]
    ds_read_b64_tr_b16 a[178:179], v34 offset:4096
    v_mul_f32 v170, s36, v170
    v_mfma_f32_16x16x32_bf16 v[216:219], a[188:191], a[120:123], v[216:219]
    ds_read_b64_tr_b16 a[180:181], v34 offset:8192
    v_mul_f32 v171, s36, v171
    v_mfma_f32_16x16x32_bf16 v[216:219], a[184:187], a[112:115], v[216:219]
    s_waitcnt lgkmcnt(9)
    buffer_load_dwordx4 v40, s[12:15], s41 offen offset:2048 lds
    v_mfma_f32_16x16x32_bf16 v[224:227], a[160:163], a[112:115], v[224:227]
    s_waitcnt lgkmcnt(7)
    ds_read_b64_tr_b16 a[182:183], v34 offset:12288
    ds_read_b64_tr_b16 a[184:185], v35 offset:0
    v_mfma_f32_16x16x32_bf16 v[224:227], a[164:167], a[120:123], v[224:227]
    ds_read_b64_tr_b16 a[186:187], v35 offset:4096
    v_mul_f32 v164, s36, v164
    v_mfma_f32_16x16x32_bf16 v[228:231], a[164:167], a[124:127], v[228:231]
    ds_read_b64_tr_b16 a[188:189], v35 offset:8192
    v_mul_f32 v165, s36, v165
    v_mfma_f32_16x16x32_bf16 v[228:231], a[160:163], a[116:119], v[228:231]
    s_waitcnt lgkmcnt(9)
    buffer_load_dwordx4 v41, s[12:15], s41 offen offset:3072 lds
    v_mfma_f32_16x16x32_bf16 v[236:239], a[168:171], a[116:119], v[236:239]
    s_waitcnt lgkmcnt(7)
    s_add_u32 s41, s41, 16384
    ds_read_b64_tr_b16 a[190:191], v35 offset:12288
    ds_read_b64_tr_b16 a[160:161], v28 offset:16384
    v_mfma_f32_16x16x32_bf16 v[236:239], a[172:175], a[124:127], v[236:239]
    ds_read_b64_tr_b16 a[162:163], v28 offset:20480
    v_mul_f32 v166, s36, v166
    v_mfma_f32_16x16x32_bf16 v[232:235], a[172:175], a[120:123], v[232:235]
    s_add_u32 m0, s42, 81920
    ds_read_b64_tr_b16 a[164:165], v28 offset:24576
    v_mul_f32 v167, s36, v167
    v_mfma_f32_16x16x32_bf16 v[232:235], a[168:171], a[112:115], v[232:235]
    s_waitcnt lgkmcnt(9)
    buffer_load_dwordx4 v40, s[12:15], s41 offen lds
    v_mfma_f32_16x16x32_bf16 v[240:243], a[176:179], a[112:115], v[240:243]
    s_waitcnt lgkmcnt(7)
    ds_read_b64_tr_b16 a[166:167], v28 offset:28672
    ds_read_b64_tr_b16 a[168:169], v29 offset:16384
    v_mfma_f32_16x16x32_bf16 v[240:243], a[180:183], a[120:123], v[240:243]
    ds_read_b64_tr_b16 a[170:171], v29 offset:20480
    v_mul_f32 v172, s36, v172
    v_mfma_f32_16x16x32_bf16 v[244:247], a[180:183], a[124:127], v[244:247]
    ds_read_b64_tr_b16 a[172:173], v29 offset:24576
    v_mul_f32 v173, s36, v173
    v_mfma_f32_16x16x32_bf16 v[244:247], a[176:179], a[116:119], v[244:247]
    s_waitcnt lgkmcnt(9)
    buffer_load_dwordx4 v41, s[12:15], s41 offen offset:1024 lds
    v_mfma_f32_16x16x32_bf16 v[252:255], a[184:187], a[116:119], v[252:255]
    s_waitcnt lgkmcnt(7)
    ds_read_b64_tr_b16 a[174:175], v29 offset:28672
    ds_read_b64_tr_b16 a[176:177], v30 offset:16384
    v_mfma_f32_16x16x32_bf16 v[252:255], a[188:191], a[124:127], v[252:255]
    ds_read_b64_tr_b16 a[178:179], v30 offset:20480
    v_mul_f32 v174, s36, v174
    v_mfma_f32_16x16x32_bf16 v[248:251], a[188:191], a[120:123], v[248:251]
    ds_read_b64_tr_b16 a[180:181], v30 offset:24576
    v_mul_f32 v175, s36, v175
    v_mfma_f32_16x16x32_bf16 v[248:251], a[184:187], a[112:115], v[248:251]
    s_waitcnt lgkmcnt(9)
    buffer_load_dwordx4 v40, s[12:15], s41 offen offset:2048 lds
    v_mfma_f32_16x16x32_bf16 v[192:195], a[160:163], a[128:131], v[192:195]
    s_waitcnt lgkmcnt(7)
    ds_read_b64_tr_b16 a[182:183], v30 offset:28672
    ds_read_b64_tr_b16 a[184:185], v31 offset:16384
    v_mfma_f32_16x16x32_bf16 v[192:195], a[164:167], a[136:139], v[192:195]
    ds_read_b64_tr_b16 a[186:187], v31 offset:20480
    v_cvt_pk_bf16_f32 v72, v160, v161
    v_mfma_f32_16x16x32_bf16 v[196:199], a[164:167], a[140:143], v[196:199]
    ds_read_b64_tr_b16 a[188:189], v31 offset:24576
    v_cvt_pk_bf16_f32 v73, v162, v163
    v_mfma_f32_16x16x32_bf16 v[196:199], a[160:163], a[132:135], v[196:199]
    s_waitcnt lgkmcnt(9)
    buffer_load_dwordx4 v41, s[12:15], s41 offen offset:3072 lds
    v_mfma_f32_16x16x32_bf16 v[204:207], a[168:171], a[132:135], v[204:207]
    s_waitcnt lgkmcnt(7)
    s_add_u32 s41, s41, 16384
    ds_read_b64_tr_b16 a[190:191], v31 offset:28672
    ds_read_b64_tr_b16 a[160:161], v32 offset:16384
    v_mfma_f32_16x16x32_bf16 v[204:207], a[172:175], a[140:143], v[204:207]
    ds_read_b64_tr_b16 a[162:163], v32 offset:20480
    v_cvt_pk_bf16_f32 v74, v168, v169
    v_mfma_f32_16x16x32_bf16 v[200:203], a[172:175], a[136:139], v[200:203]
    ds_read_b64_tr_b16 a[164:165], v32 offset:24576
    v_cvt_pk_bf16_f32 v75, v170, v171
    v_mfma_f32_16x16x32_bf16 v[200:203], a[168:171], a[128:131], v[200:203]
    s_waitcnt lgkmcnt(9)
    ds_read_b64_tr_b16 a[166:167], v32 offset:28672
    v_cvt_pk_bf16_f32 v88, v164, v165
    v_mfma_f32_16x16x32_bf16 v[208:211], a[176:179], a[128:131], v[208:211]
    s_waitcnt lgkmcnt(8)
    ds_read_b64_tr_b16 a[168:169], v33 offset:16384
    v_cvt_pk_bf16_f32 v89, v166, v167
    v_mfma_f32_16x16x32_bf16 v[208:211], a[180:183], a[136:139], v[208:211]
    ds_read_b64_tr_b16 a[170:171], v33 offset:20480
    v_cvt_pk_bf16_f32 v90, v172, v173
    v_mfma_f32_16x16x32_bf16 v[212:215], a[180:183], a[140:143], v[212:215]
    ds_read_b64_tr_b16 a[172:173], v33 offset:24576
    v_cvt_pk_bf16_f32 v91, v174, v175
    v_mfma_f32_16x16x32_bf16 v[212:215], a[176:179], a[132:135], v[212:215]
    s_waitcnt lgkmcnt(9)
    ds_read_b64_tr_b16 a[174:175], v33 offset:28672
    v_permlane32_swap_b32 v72, v74
    v_mfma_f32_16x16x32_bf16 v[220:223], a[184:187], a[132:135], v[220:223]
    s_waitcnt lgkmcnt(8)
    ds_read_b64_tr_b16 a[176:177], v34 offset:16384
    v_permlane32_swap_b32 v73, v75
    v_mfma_f32_16x16x32_bf16 v[220:223], a[188:191], a[140:143], v[220:223]
    ds_read_b64_tr_b16 a[178:179], v34 offset:20480
    v_permlane32_swap_b32 v88, v90
    v_mfma_f32_16x16x32_bf16 v[216:219], a[188:191], a[136:139], v[216:219]
    ds_read_b64_tr_b16 a[180:181], v34 offset:24576
    v_permlane32_swap_b32 v89, v91
    v_mfma_f32_16x16x32_bf16 v[216:219], a[184:187], a[128:131], v[216:219]
    s_waitcnt lgkmcnt(9)
    ds_read_b64_tr_b16 a[182:183], v34 offset:28672
    v_permlane16_swap_b32 v72, v74
    v_mfma_f32_16x16x32_bf16 v[224:227], a[160:163], a[128:131], v[224:227]
    s_waitcnt lgkmcnt(8)
    ds_read_b64_tr_b16 a[184:185], v35 offset:16384
    v_permlane16_swap_b32 v73, v75
    v_mfma_f32_16x16x32_bf16 v[224:227], a[164:167], a[136:139], v[224:227]
    ds_read_b64_tr_b16 a[186:187], v35 offset:20480
    v_permlane16_swap_b32 v88, v90
    v_mfma_f32_16x16x32_bf16 v[228:231], a[164:167], a[140:143], v[228:231]
    ds_read_b64_tr_b16 a[188:189], v35 offset:24576
    v_permlane16_swap_b32 v89, v91
    v_mfma_f32_16x16x32_bf16 v[228:231], a[160:163], a[132:135], v[228:231]
    s_waitcnt lgkmcnt(9)
    ds_read_b64_tr_b16 a[190:191], v35 offset:28672
    v_mul_f32 v176, s36, v176
    v_mfma_f32_16x16x32_bf16 v[236:239], a[168:171], a[132:135], v[236:239]
    s_waitcnt lgkmcnt(8)
    v_mul_f32 v177, s36, v177
    v_mul_f32 v178, s36, v178
    v_mfma_f32_16x16x32_bf16 v[236:239], a[172:175], a[140:143], v[236:239]
    v_mul_f32 v179, s36, v179
    v_mul_f32 v184, s36, v184
    v_mfma_f32_16x16x32_bf16 v[232:235], a[172:175], a[136:139], v[232:235]
    v_mul_f32 v185, s36, v185
    v_mul_f32 v186, s36, v186
    v_mfma_f32_16x16x32_bf16 v[232:235], a[168:171], a[128:131], v[232:235]
    s_waitcnt lgkmcnt(6)
    v_mul_f32 v187, s36, v187
    v_mul_f32 v180, s36, v180
    s_waitcnt vmcnt(16)
    s_barrier
    v_mfma_f32_16x16x32_bf16 v[240:243], a[176:179], a[128:131], v[240:243]
    s_waitcnt lgkmcnt(4)
    ds_read_b128 a[208:211], v8 offset:0
    v_mul_f32 v181, s36, v181
    v_mfma_f32_16x16x32_bf16 v[240:243], a[180:183], a[136:139], v[240:243]
    ds_read_b128 a[212:215], v9 offset:0
    v_mul_f32 v182, s36, v182
    v_mfma_f32_16x16x32_bf16 v[244:247], a[180:183], a[140:143], v[244:247]
    ds_read_b128 a[216:219], v10 offset:0
    v_mul_f32 v183, s36, v183
    v_mfma_f32_16x16x32_bf16 v[244:247], a[176:179], a[132:135], v[244:247]
    s_waitcnt lgkmcnt(5)
    ds_read_b128 a[220:223], v11 offset:0
    v_mul_f32 v188, s36, v188
    v_mfma_f32_16x16x32_bf16 v[252:255], a[184:187], a[132:135], v[252:255]
    s_waitcnt lgkmcnt(4)
    ds_read_b128 a[224:227], v8 offset:4096
    v_mul_f32 v189, s36, v189
    v_mfma_f32_16x16x32_bf16 v[252:255], a[188:191], a[140:143], v[252:255]
    v_mul_f32 v190, s36, v190
    v_mul_f32 v191, s36, v191
    v_mfma_f32_16x16x32_bf16 v[248:251], a[188:191], a[136:139], v[248:251]
    s_load_dwordx2 s[16:17], s[0:1], 88
    v_cvt_pk_bf16_f32 v76, v176, v177
    v_cvt_pk_bf16_f32 v77, v178, v179
    v_mfma_f32_16x16x32_bf16 v[248:251], a[184:187], a[128:131], v[248:251]
    v_cvt_pk_bf16_f32 v78, v184, v185
    v_cvt_pk_bf16_f32 v79, v186, v187
    v_cvt_pk_bf16_f32 v92, v180, v181
    v_cvt_pk_bf16_f32 v93, v182, v183
    v_cvt_pk_bf16_f32 v94, v188, v189
    v_cvt_pk_bf16_f32 v95, v190, v191
    v_permlane32_swap_b32 v76, v78
    v_permlane32_swap_b32 v77, v79
    v_permlane32_swap_b32 v92, v94
    v_permlane32_swap_b32 v93, v95
    v_permlane16_swap_b32 v76, v78
    v_permlane16_swap_b32 v77, v79
    v_permlane16_swap_b32 v92, v94
    v_permlane16_swap_b32 v93, v95
    s_mov_b32 s36, 1040356334
    s_mov_b32 s37, 1040356334
    v_mov_b32 v58, 0
    v_mov_b32 v59, 0
    v_mov_b32 v60, 0
    v_mov_b32 v61, 0
    v_pk_mul_f32 v[192:193], v[192:193], s[36:37]
    v_pk_mul_f32 v[194:195], v[194:195], s[36:37]
    v_pk_mul_f32 v[200:201], v[200:201], s[36:37]
    v_pk_mul_f32 v[202:203], v[202:203], s[36:37]
    v_pk_mul_f32 v[196:197], v[196:197], s[36:37]
    v_pk_mul_f32 v[198:199], v[198:199], s[36:37]
    v_pk_mul_f32 v[204:205], v[204:205], s[36:37]
    v_pk_mul_f32 v[206:207], v[206:207], s[36:37]
    v_mfma_f32_32x32x16_bf16 a[0:15], v[58:61], v[58:61], 0
    v_cvt_pk_bf16_f32 v96, v192, v193
    v_cvt_pk_bf16_f32 v97, v194, v195
    v_cvt_pk_bf16_f32 v98, v200, v201
    v_cvt_pk_bf16_f32 v99, v202, v203
    v_cvt_pk_bf16_f32 v112, v196, v197
    v_cvt_pk_bf16_f32 v113, v198, v199
    v_cvt_pk_bf16_f32 v114, v204, v205
    v_cvt_pk_bf16_f32 v115, v206, v207
    v_mfma_f32_32x32x16_bf16 a[16:31], v[58:61], v[58:61], 0
    v_permlane32_swap_b32 v96, v98
    v_permlane32_swap_b32 v97, v99
    v_permlane32_swap_b32 v112, v114
    v_permlane32_swap_b32 v113, v115
    v_permlane16_swap_b32 v96, v98
    v_permlane16_swap_b32 v97, v99
    v_permlane16_swap_b32 v112, v114
    v_permlane16_swap_b32 v113, v115
    v_pk_mul_f32 v[208:209], v[208:209], s[36:37]
    v_pk_mul_f32 v[210:211], v[210:211], s[36:37]
    v_pk_mul_f32 v[216:217], v[216:217], s[36:37]
    v_pk_mul_f32 v[218:219], v[218:219], s[36:37]
    v_pk_mul_f32 v[212:213], v[212:213], s[36:37]
    v_pk_mul_f32 v[214:215], v[214:215], s[36:37]
    v_pk_mul_f32 v[220:221], v[220:221], s[36:37]
    v_pk_mul_f32 v[222:223], v[222:223], s[36:37]
    v_mfma_f32_32x32x16_bf16 a[32:47], v[58:61], v[58:61], 0
    v_cvt_pk_bf16_f32 v100, v208, v209
    v_cvt_pk_bf16_f32 v101, v210, v211
    v_cvt_pk_bf16_f32 v102, v216, v217
    v_cvt_pk_bf16_f32 v103, v218, v219
    v_cvt_pk_bf16_f32 v116, v212, v213
    v_cvt_pk_bf16_f32 v117, v214, v215
    v_cvt_pk_bf16_f32 v118, v220, v221
    v_cvt_pk_bf16_f32 v119, v222, v223
    v_mfma_f32_32x32x16_bf16 a[48:63], v[58:61], v[58:61], 0
    v_permlane32_swap_b32 v100, v102
    v_permlane32_swap_b32 v101, v103
    v_permlane32_swap_b32 v116, v118
    v_permlane32_swap_b32 v117, v119
    v_permlane16_swap_b32 v100, v102
    v_permlane16_swap_b32 v101, v103
    v_permlane16_swap_b32 v116, v118
    v_permlane16_swap_b32 v117, v119
    v_pk_mul_f32 v[224:225], v[224:225], s[36:37]
    v_pk_mul_f32 v[226:227], v[226:227], s[36:37]
    v_pk_mul_f32 v[232:233], v[232:233], s[36:37]
    v_pk_mul_f32 v[234:235], v[234:235], s[36:37]
    v_pk_mul_f32 v[228:229], v[228:229], s[36:37]
    v_pk_mul_f32 v[230:231], v[230:231], s[36:37]
    v_pk_mul_f32 v[236:237], v[236:237], s[36:37]
    v_pk_mul_f32 v[238:239], v[238:239], s[36:37]
    v_mfma_f32_32x32x16_bf16 a[64:79], v[58:61], v[58:61], 0
    v_cvt_pk_bf16_f32 v104, v224, v225
    v_cvt_pk_bf16_f32 v105, v226, v227
    v_cvt_pk_bf16_f32 v106, v232, v233
    v_cvt_pk_bf16_f32 v107, v234, v235
    v_cvt_pk_bf16_f32 v120, v228, v229
    v_cvt_pk_bf16_f32 v121, v230, v231
    v_cvt_pk_bf16_f32 v122, v236, v237
    v_cvt_pk_bf16_f32 v123, v238, v239
    v_mfma_f32_32x32x16_bf16 a[80:95], v[58:61], v[58:61], 0
    v_permlane32_swap_b32 v104, v106
    v_permlane32_swap_b32 v105, v107
    v_permlane32_swap_b32 v120, v122
    v_permlane32_swap_b32 v121, v123
    v_permlane16_swap_b32 v104, v106
    v_permlane16_swap_b32 v105, v107
    v_permlane16_swap_b32 v120, v122
    v_permlane16_swap_b32 v121, v123
    v_pk_mul_f32 v[240:241], v[240:241], s[36:37]
    v_pk_mul_f32 v[242:243], v[242:243], s[36:37]
    v_pk_mul_f32 v[248:249], v[248:249], s[36:37]
    v_pk_mul_f32 v[250:251], v[250:251], s[36:37]
    v_pk_mul_f32 v[244:245], v[244:245], s[36:37]
    v_pk_mul_f32 v[246:247], v[246:247], s[36:37]
    v_pk_mul_f32 v[252:253], v[252:253], s[36:37]
    v_pk_mul_f32 v[254:255], v[254:255], s[36:37]
    v_mfma_f32_32x32x16_bf16 a[96:111], v[58:61], v[58:61], 0
    v_cvt_pk_bf16_f32 v108, v240, v241
    v_cvt_pk_bf16_f32 v109, v242, v243
    v_cvt_pk_bf16_f32 v110, v248, v249
    v_cvt_pk_bf16_f32 v111, v250, v251
    v_cvt_pk_bf16_f32 v124, v244, v245
    v_cvt_pk_bf16_f32 v125, v246, v247
    v_cvt_pk_bf16_f32 v126, v252, v253
    v_cvt_pk_bf16_f32 v127, v254, v255
    v_mfma_f32_32x32x16_bf16 a[112:127], v[58:61], v[58:61], 0
    v_permlane32_swap_b32 v108, v110
    v_permlane32_swap_b32 v109, v111
    v_permlane32_swap_b32 v124, v126
    v_permlane32_swap_b32 v125, v127
    v_permlane16_swap_b32 v108, v110
    v_permlane16_swap_b32 v109, v111
    v_permlane16_swap_b32 v124, v126
    v_permlane16_swap_b32 v125, v127
    s_waitcnt lgkmcnt(0)
    v_mfma_f32_16x16x32_bf16 v[216:219], a[208:211], v[64:67], 0
    v_mfma_f32_16x16x32_bf16 v[216:219], a[212:215], v[68:71], v[216:219]
    v_mfma_f32_16x16x32_bf16 v[216:219], a[216:219], v[72:75], v[216:219]
    v_mfma_f32_16x16x32_bf16 v[216:219], a[220:223], v[76:79], v[216:219]
    v_mfma_f32_16x16x32_bf16 v[220:223], a[208:211], v[80:83], 0
    v_mfma_f32_16x16x32_bf16 v[220:223], a[212:215], v[84:87], v[220:223]
    v_mfma_f32_16x16x32_bf16 v[220:223], a[216:219], v[88:91], v[220:223]
    v_mfma_f32_16x16x32_bf16 v[220:223], a[220:223], v[92:95], v[220:223]
    v_mfma_f32_16x16x32_bf16 v[224:227], a[208:211], v[96:99], 0
    v_mfma_f32_16x16x32_bf16 v[224:227], a[212:215], v[100:103], v[224:227]
    v_mfma_f32_16x16x32_bf16 v[224:227], a[216:219], v[104:107], v[224:227]
    v_mfma_f32_16x16x32_bf16 v[224:227], a[220:223], v[108:111], v[224:227]
    v_mfma_f32_16x16x32_bf16 v[228:231], a[208:211], v[112:115], 0
    v_mfma_f32_16x16x32_bf16 v[228:231], a[212:215], v[116:119], v[228:231]
    v_mfma_f32_16x16x32_bf16 v[228:231], a[216:219], v[120:123], v[228:231]
    v_mfma_f32_16x16x32_bf16 v[228:231], a[220:223], v[124:127], v[228:231]
    v_mfma_f32_32x32x16_bf16 a[192:207], v[58:61], v[58:61], 0
    v_max3_f32 v232, v216, v217, v218
    v_max_f32 v232, v232, v219
    v_max3_f32 v233, v220, v221, v222
    v_max_f32 v233, v233, v223
    v_max3_f32 v234, v224, v225, v226
    v_max_f32 v234, v234, v227
    s_nop 0
    v_max3_f32 v235, v228, v229, v230
    v_max_f32 v235, v235, v231
    v_mov_b32 v236, v232
    v_mov_b32 v237, v233
    v_mov_b32 v238, v234
    v_mov_b32 v239, v235
    v_permlane16_swap_b32 v232, v236
    v_permlane16_swap_b32 v233, v237
    v_permlane16_swap_b32 v234, v238
    v_permlane16_swap_b32 v235, v239
    v_max_f32 v232, v232, v236
    v_max_f32 v233, v233, v237
    v_max_f32 v234, v234, v238
    v_max_f32 v235, v235, v239
    v_mov_b32 v236, v232
    v_mov_b32 v237, v233
    v_mov_b32 v238, v234
    v_mov_b32 v239, v235
    v_permlane32_swap_b32 v232, v236
    v_permlane32_swap_b32 v233, v237
    v_permlane32_swap_b32 v234, v238
    v_permlane32_swap_b32 v235, v239
    v_max_f32 v232, v232, v236
    v_max_f32 v233, v233, v237
    v_max_f32 v234, v234, v238
    v_max_f32 v235, v235, v239
    v_sub_f32 v192, 3250585600, v232
    v_sub_f32 v193, 3250585600, v232
    v_sub_f32 v194, 3250585600, v232
    v_sub_f32 v195, 3250585600, v232
    v_sub_f32 v196, 3250585600, v233
    v_sub_f32 v197, 3250585600, v233
    v_sub_f32 v198, 3250585600, v233
    v_sub_f32 v199, 3250585600, v233
    v_sub_f32 v200, 3250585600, v234
    v_sub_f32 v201, 3250585600, v234
    v_sub_f32 v202, 3250585600, v234
    v_sub_f32 v203, 3250585600, v234
    v_sub_f32 v204, 3250585600, v235
Ltour0_3:
    s_cbranch_execz Ltour0_7
    v_sub_f32 v205, 3250585600, v235
    v_sub_f32 v206, 3250585600, v235
    v_sub_f32 v207, 3250585600, v235
Lattn_stage0:
    s_mov_b32 s43, 7
    v_mfma_f32_16x16x32_bf16 v[208:211], a[208:211], v[64:67], v[192:195]
    s_lshl_b32 s53, s5, 4
    v_lshrrev_b32 v51, 2, v0
    v_mul_u32_u24 v51, 9216, v51
    v_mfma_f32_16x16x32_bf16 v[208:211], a[212:215], v[68:71], v[208:211]
    s_add_u32 s53, s53, s4
    v_and_b32 v254, 3, v0
    v_lshl_add_u32 v254, v254, 4, v51
    v_mfma_f32_16x16x32_bf16 v[208:211], a[216:219], v[72:75], v[208:211]
    s_lshl_b32 s53, s53, 2
    v_lshlrev_b32 v255, 4, v0
    v_add_u32 v51, 98304, v255
    v_mfma_f32_16x16x32_bf16 v[208:211], a[220:223], v[76:79], v[208:211]
    s_add_u32 s53, s53, s3
    v_mov_b32 v224, 0
    v_mfma_f32_16x16x32_bf16 v[212:215], a[208:211], v[80:83], v[196:199]
    s_mul_i32 s53, s53, 4608
    ds_read_b128 a[228:231], v9 offset:4096
    v_mov_b32 v225, 0
    v_mfma_f32_16x16x32_bf16 v[212:215], a[212:215], v[84:87], v[212:215]
    s_add_u32 s53, s53, 2621440
    v_exp_f32 v208, v208
    v_mfma_f32_16x16x32_bf16 v[212:215], a[216:219], v[88:91], v[212:215]
    s_lshr_b32 s44, s2, 5
    v_exp_f32 v209, v209
    v_mfma_f32_16x16x32_bf16 v[212:215], a[220:223], v[92:95], v[212:215]
    s_lshl_b32 s44, s44, 3
    v_exp_f32 v210, v210
    v_exp_f32 v211, v211
    v_cvt_pk_bf16_f32 v128, v208, v209
    v_cvt_pk_bf16_f32 v129, v210, v211
    v_mfma_f32_16x16x32_bf16 v[208:211], a[208:211], v[96:99], v[200:203]
    s_and_b32 s37, s2, 7
    ds_read_b128 a[232:235], v10 offset:4096
    v_mov_b32 v226, 0
    v_mfma_f32_16x16x32_bf16 v[208:211], a[212:215], v[100:103], v[208:211]
    s_add_u32 s44, s44, s37
    v_exp_f32 v212, v212
    v_mfma_f32_16x16x32_bf16 v[208:211], a[216:219], v[104:107], v[208:211]
    s_lshl_b32 s44, s44, 2
    v_exp_f32 v213, v213
    v_mfma_f32_16x16x32_bf16 v[208:211], a[220:223], v[108:111], v[208:211]
    s_bfe_u32 s37, s2, 0x20003
    v_exp_f32 v214, v214
    v_exp_f32 v215, v215
    v_cvt_pk_bf16_f32 v136, v212, v213
    v_cvt_pk_bf16_f32 v137, v214, v215
    v_mfma_f32_16x16x32_bf16 v[212:215], a[208:211], v[112:115], v[204:207]
    s_add_u32 s44, s44, s37
    ds_read_b128 a[236:239], v11 offset:4096
    v_mov_b32 v227, 0
    v_mfma_f32_16x16x32_bf16 v[212:215], a[212:215], v[116:119], v[212:215]
    s_add_u32 s44, s44, 72
    v_exp_f32 v208, v208
    v_mfma_f32_16x16x32_bf16 v[212:215], a[216:219], v[120:123], v[212:215]
    s_cmp_lt_u32 s44, 216
    s_cselect_b32 s37, 0, 2147483648
    v_exp_f32 v209, v209
    v_mfma_f32_16x16x32_bf16 v[212:215], a[220:223], v[124:127], v[212:215]
    s_lshl_b32 s44, s44, 5
    v_exp_f32 v210, v210
    v_exp_f32 v211, v211
    v_cvt_pk_bf16_f32 v144, v208, v209
    v_cvt_pk_bf16_f32 v145, v210, v211
    v_mfma_f32_16x16x32_bf16 v[208:211], a[224:227], v[64:67], v[192:195]
    s_waitcnt lgkmcnt(2)
    s_or_b32 s44, s44, s37
    ds_read_b128 a[208:211], v8 offset:8192
    v_mov_b32 v228, 0
    v_mfma_f32_16x16x32_bf16 v[208:211], a[228:231], v[68:71], v[208:211]
    s_waitcnt lgkmcnt(2)
    s_mov_b32 s18, 3981312
    v_exp_f32 v212, v212
    v_mfma_f32_16x16x32_bf16 v[208:211], a[232:235], v[72:75], v[208:211]
    s_waitcnt lgkmcnt(1)
    s_lshr_b32 s6, s2, 3
    v_exp_f32 v213, v213
    v_mfma_f32_16x16x32_bf16 v[208:211], a[236:239], v[76:79], v[208:211]
    s_and_b32 s7, s2, 7
    v_exp_f32 v214, v214
    v_exp_f32 v215, v215
    v_cvt_pk_bf16_f32 v152, v212, v213
    v_cvt_pk_bf16_f32 v153, v214, v215
    v_mfma_f32_16x16x32_bf16 v[212:215], a[224:227], v[80:83], v[196:199]
    s_mul_i32 s7, s7, 18
    ds_read_b128 a[212:215], v9 offset:8192
    v_mov_b32 v229, 0
    v_mfma_f32_16x16x32_bf16 v[212:215], a[228:231], v[84:87], v[212:215]
    s_add_u32 s7, s7, s6
    v_exp_f32 v208, v208
    v_mfma_f32_16x16x32_bf16 v[212:215], a[232:235], v[88:91], v[212:215]
    s_lshl_b32 s58, s7, 6
    v_exp_f32 v209, v209
    v_mfma_f32_16x16x32_bf16 v[212:215], a[236:239], v[92:95], v[212:215]
    s_mul_i32 s59, s7, 36864
    v_exp_f32 v210, v210
    v_exp_f32 v211, v211
    v_cvt_pk_bf16_f32 v130, v208, v209
    v_cvt_pk_bf16_f32 v131, v210, v211
    v_mfma_f32_16x16x32_bf16 v[208:211], a[224:227], v[96:99], v[200:203]
    s_cmp_lt_u32 s6, 18
    s_cselect_b32 s7, 0, 2147483648
    ds_read_b128 a[216:219], v10 offset:8192
    v_mov_b32 v230, 0
    v_mfma_f32_16x16x32_bf16 v[208:211], a[228:231], v[100:103], v[208:211]
    s_or_b32 s58, s58, s7
    v_exp_f32 v212, v212
    v_mfma_f32_16x16x32_bf16 v[208:211], a[232:235], v[104:107], v[208:211]
    s_or_b32 s59, s59, s7
    v_exp_f32 v213, v213
    v_mfma_f32_16x16x32_bf16 v[208:211], a[236:239], v[108:111], v[208:211]
    s_and_b32 s7, s4, 1
    v_exp_f32 v214, v214
    v_exp_f32 v215, v215
    v_cvt_pk_bf16_f32 v138, v212, v213
    v_cvt_pk_bf16_f32 v139, v214, v215
    s_mov_b32 s39, 221184
    s_mov_b32 s38, 27648
    v_mfma_f32_16x16x32_bf16 v[212:215], a[224:227], v[112:115], v[204:207]
    s_lshl_b32 s6, s7, 7
    ds_read_b128 a[220:223], v11 offset:8192
    v_mov_b32 v231, 0
    v_mfma_f32_16x16x32_bf16 v[212:215], a[228:231], v[116:119], v[212:215]
    s_xor_b32 s36, s4, 1
    v_exp_f32 v208, v208
    v_mfma_f32_16x16x32_bf16 v[212:215], a[232:235], v[120:123], v[212:215]
    s_mul_i32 s36, s36, 294912
    v_exp_f32 v209, v209
    v_mfma_f32_16x16x32_bf16 v[212:215], a[236:239], v[124:127], v[212:215]
    s_waitcnt lgkmcnt(3)
    s_add_u32 s46, s36, s6
    v_exp_f32 v210, v210
    v_exp_f32 v211, v211
    v_cvt_pk_bf16_f32 v146, v208, v209
    v_cvt_pk_bf16_f32 v147, v210, v211
    v_mfma_f32_16x16x32_bf16 v[208:211], a[208:211], v[64:67], v[192:195]
    s_waitcnt lgkmcnt(2)
    s_lshl_b32 s36, s4, 8
    ds_read_b128 a[224:227], v8 offset:12288
    v_mov_b32 v248, -1
    v_mfma_f32_16x16x32_bf16 v[208:211], a[212:215], v[68:71], v[208:211]
    s_waitcnt lgkmcnt(2)
    s_add_u32 s56, s47, s36
    v_exp_f32 v212, v212
    v_mfma_f32_16x16x32_bf16 v[208:211], a[216:219], v[72:75], v[208:211]
    s_waitcnt lgkmcnt(1)
    s_lshr_b32 s36, s4, 1
    v_exp_f32 v213, v213
    v_mfma_f32_16x16x32_bf16 v[208:211], a[220:223], v[76:79], v[208:211]
    s_lshl_b32 s36, s36, 11
    v_exp_f32 v214, v214
    v_exp_f32 v215, v215
    v_cvt_pk_bf16_f32 v154, v212, v213
    v_cvt_pk_bf16_f32 v155, v214, v215
    v_mfma_f32_16x16x32_bf16 v[212:215], a[208:211], v[80:83], v[196:199]
    s_lshl_b32 s7, s7, 8
    ds_read_b128 a[228:231], v9 offset:12288
    v_mov_b32 v249, -1
    v_mfma_f32_16x16x32_bf16 v[212:215], a[212:215], v[84:87], v[212:215]
    s_add_u32 s36, s36, s7
    v_exp_f32 v208, v208
    v_mfma_f32_16x16x32_bf16 v[212:215], a[216:219], v[88:91], v[212:215]
    s_add_u32 s93, s47, s36
    v_exp_f32 v209, v209
    v_mfma_f32_16x16x32_bf16 v[212:215], a[220:223], v[92:95], v[212:215]
    s_lshr_b32 s36, s4, 1
    v_exp_f32 v210, v210
    v_exp_f32 v211, v211
    v_cvt_pk_bf16_f32 v132, v208, v209
    v_cvt_pk_bf16_f32 v133, v210, v211
    v_mfma_f32_16x16x32_bf16 v[208:211], a[208:211], v[96:99], v[200:203]
    s_lshl_b32 s36, s36, 4
    ds_read_b128 a[232:235], v10 offset:12288
    v_mov_b32 v250, -1
    v_mfma_f32_16x16x32_bf16 v[208:211], a[212:215], v[100:103], v[208:211]
    s_add_u32 s36, s36, s5
    v_exp_f32 v212, v212
    v_mfma_f32_16x16x32_bf16 v[208:211], a[216:219], v[104:107], v[208:211]
    s_lshl_b32 s36, s36, 9
    v_exp_f32 v213, v213
    v_mfma_f32_16x16x32_bf16 v[208:211], a[220:223], v[108:111], v[208:211]
    s_add_u32 s36, s36, s7
    v_exp_f32 v214, v214
    v_exp_f32 v215, v215
    v_cvt_pk_bf16_f32 v140, v212, v213
    v_cvt_pk_bf16_f32 v141, v214, v215
    s_waitcnt vmcnt(4)
    s_barrier
    v_mfma_f32_16x16x32_bf16 v[212:215], a[208:211], v[112:115], v[204:207]
    s_lshl_b32 s36, s36, 8
    ds_read_b128 a[236:239], v11 offset:12288
    v_mov_b32 v251, -1
    v_mfma_f32_16x16x32_bf16 v[212:215], a[212:215], v[116:119], v[212:215]
    s_add_u32 m0, s42, 49152
    s_add_u32 s55, s36, 21102592
    v_exp_f32 v208, v208
    v_mfma_f32_16x16x32_bf16 v[212:215], a[216:219], v[120:123], v[212:215]
    s_add_u32 s7, s45, s6
    v_exp_f32 v209, v209
    v_mfma_f32_16x16x32_bf16 v[212:215], a[220:223], v[124:127], v[212:215]
    s_waitcnt lgkmcnt(3)
    s_xor_b32 s54, s92, 128
    v_exp_f32 v210, v210
    v_exp_f32 v211, v211
    v_cvt_pk_bf16_f32 v148, v208, v209
    v_cvt_pk_bf16_f32 v149, v210, v211
    buffer_load_dwordx4 v36, s[8:11], s40 offen lds
    v_mfma_f32_16x16x32_bf16 v[208:211], a[224:227], v[64:67], v[192:195]
    s_waitcnt lgkmcnt(2)
    s_lshl_b32 s36, s3, 14
    ds_read_b128 a[208:211], v8 offset:16384
    v_min_u32 v232, 41, v1
    v_mfma_f32_16x16x32_bf16 v[208:211], a[228:231], v[68:71], v[208:211]
    s_waitcnt lgkmcnt(2)
    v_exp_f32 v212, v212
    v_mfma_f32_16x16x32_bf16 v[208:211], a[232:235], v[72:75], v[208:211]
    s_waitcnt lgkmcnt(1)
    v_exp_f32 v213, v213
    v_mfma_f32_16x16x32_bf16 v[208:211], a[236:239], v[76:79], v[208:211]
    v_exp_f32 v214, v214
    v_exp_f32 v215, v215
    v_cvt_pk_bf16_f32 v156, v212, v213
    v_cvt_pk_bf16_f32 v157, v214, v215
    v_mfma_f32_16x16x32_bf16 v[212:215], a[224:227], v[80:83], v[196:199]
    ds_read_b128 a[212:215], v9 offset:16384
    v_mfma_f32_16x16x32_bf16 v[212:215], a[228:231], v[84:87], v[212:215]
    s_nop 0
    v_exp_f32 v208, v208
    v_mfma_f32_16x16x32_bf16 v[212:215], a[232:235], v[88:91], v[212:215]
    v_exp_f32 v209, v209
    v_mfma_f32_16x16x32_bf16 v[212:215], a[236:239], v[92:95], v[212:215]
    v_exp_f32 v210, v210
    v_exp_f32 v211, v211
    ds_read_b64_tr_b16 a[160:161], v20 offset:0
    v_cvt_pk_bf16_f32 v134, v208, v209
    v_lshl_add_u32 v252, v1, 4, s36
    v_lshlrev_b32 v232, 4, v232
    s_mov_b32 s57, s58
    s_lshl_b32 s6, s3, 10
    s_add_u32 s6, s6, 135168
    s_lshr_b32 s37, s2, 3
    s_mul_i32 s37, s37, -129024
    s_add_u32 s37, s37, 4128768
    ds_read_b64_tr_b16 a[162:163], v20 offset:4096
    ds_read_b128 a[216:219], v10 offset:16384
    v_cvt_pk_bf16_f32 v135, v210, v211
    buffer_load_dwordx4 v37, s[8:11], s40 offen offset:1024 lds
    v_mfma_f32_16x16x32_bf16 v[208:211], a[224:227], v[96:99], v[200:203]
    v_mfma_f32_16x16x32_bf16 v[208:211], a[228:231], v[100:103], v[208:211]
    v_exp_f32 v212, v212
    v_mfma_f32_16x16x32_bf16 v[208:211], a[232:235], v[104:107], v[208:211]
    v_exp_f32 v213, v213
    v_mfma_f32_16x16x32_bf16 v[208:211], a[236:239], v[108:111], v[208:211]
    s_mov_b32 s52, s55
    v_exp_f32 v214, v214
    v_exp_f32 v215, v215
    ds_read_b64_tr_b16 a[164:165], v20 offset:8192
    v_cvt_pk_bf16_f32 v142, v212, v213
    ds_read_b64_tr_b16 a[166:167], v20 offset:12288
    v_min_u32 v237, 19, v1
    v_lshl_add_u32 v237, v237, 7, s36
    v_lshl_add_u32 v238, v1, 7, s36
    ds_read_b128 a[220:223], v11 offset:16384
    v_cvt_pk_bf16_f32 v143, v214, v215
    buffer_load_dword v217, v57, s[32:35], s37 offen
    v_mfma_f32_16x16x32_bf16 v[212:215], a[224:227], v[112:115], v[204:207]
    v_mfma_f32_16x16x32_bf16 v[212:215], a[228:231], v[116:119], v[212:215]
    v_exp_f32 v208, v208
    v_mfma_f32_16x16x32_bf16 v[212:215], a[232:235], v[120:123], v[212:215]
    s_mul_i32 s37, s5, 18432
    v_exp_f32 v209, v209
    v_mfma_f32_16x16x32_bf16 v[212:215], a[236:239], v[124:127], v[212:215]
    s_add_u32 s37, s37, s45
    v_exp_f32 v210, v210
    v_exp_f32 v211, v211
    ds_read_b64_tr_b16 a[168:169], v21 offset:0
    v_cvt_pk_bf16_f32 v150, v208, v209
    ds_read_b64_tr_b16 a[170:171], v21 offset:4096
    v_min_u32 v236, 143, v0
    v_lshl_add_u32 v236, v236, 7, s37
    v_mul_u32_u24 v235, 24, v0
    v_lshrrev_b32 v235, 8, v235
    v_lshl_add_u32 v235, v235, 7, s37
    ds_read_b128 a[224:227], v8 offset:20480
    v_cvt_pk_bf16_f32 v151, v210, v211
    s_waitcnt lgkmcnt(3)
    buffer_load_dwordx4 v38, s[8:11], s40 offen offset:2048 lds
    s_nop 0
    s_nop 0
    s_nop 0
    s_nop 0
    s_nop 0
Lattn_loop:
    v_mfma_f32_16x16x32_bf16 v[208:211], a[208:211], v[64:67], v[192:195]
    v_exp_f32 v212, v212
    v_mfma_f32_16x16x32_bf16 v[208:211], a[212:215], v[68:71], v[208:211]
    v_exp_f32 v213, v213
    v_mfma_f32_16x16x32_bf16 v[208:211], a[216:219], v[72:75], v[208:211]
    v_exp_f32 v214, v214
    v_mfma_f32_16x16x32_bf16 v[208:211], a[220:223], v[76:79], v[208:211]
    v_exp_f32 v215, v215
    v_mfma_f32_16x16x32_bf16 a[0:3], a[160:163], v[128:131], a[0:3]
    ds_read_b64_tr_b16 a[172:173], v21 offset:8192
    v_cvt_pk_bf16_f32 v158, v212, v213
    v_mfma_f32_16x16x32_bf16 a[0:3], a[164:167], v[132:135], a[0:3]
    ds_read_b64_tr_b16 a[174:175], v21 offset:12288
    v_mfma_f32_16x16x32_bf16 a[4:7], a[164:167], v[140:143], a[4:7]
    ds_read_b128 a[228:231], v9 offset:20480
    v_cvt_pk_bf16_f32 v159, v214, v215
    v_mfma_f32_16x16x32_bf16 a[4:7], a[160:163], v[136:139], a[4:7]
    v_mfma_f32_16x16x32_bf16 v[212:215], a[208:211], v[80:83], v[196:199]
    v_exp_f32 v208, v208
    v_mfma_f32_16x16x32_bf16 v[212:215], a[212:215], v[84:87], v[212:215]
    v_exp_f32 v209, v209
    v_mfma_f32_16x16x32_bf16 v[212:215], a[216:219], v[88:91], v[212:215]
    v_exp_f32 v210, v210
    v_mfma_f32_16x16x32_bf16 v[212:215], a[220:223], v[92:95], v[212:215]
    v_exp_f32 v211, v211
    v_mfma_f32_16x16x32_bf16 a[8:11], a[160:163], v[144:147], a[8:11]
    ds_read_b64_tr_b16 a[176:177], v22 offset:0
    v_cvt_pk_bf16_f32 v160, v208, v209
    v_mfma_f32_16x16x32_bf16 a[8:11], a[164:167], v[148:151], a[8:11]
    ds_read_b64_tr_b16 a[178:179], v22 offset:4096
    v_mfma_f32_16x16x32_bf16 a[12:15], a[164:167], v[156:159], a[12:15]
    ds_read_b128 a[232:235], v10 offset:20480
    v_cvt_pk_bf16_f32 v161, v210, v211
    v_mfma_f32_16x16x32_bf16 a[12:15], a[160:163], v[152:155], a[12:15]
    s_waitcnt lgkmcnt(3)
    buffer_load_dwordx4 v39, s[8:11], s40 offen offset:3072 lds
    v_mfma_f32_16x16x32_bf16 v[208:211], a[208:211], v[96:99], v[200:203]
    v_exp_f32 v212, v212
    v_mfma_f32_16x16x32_bf16 v[208:211], a[212:215], v[100:103], v[208:211]
    s_add_u32 s40, s40, 16384
    v_exp_f32 v213, v213
    v_mfma_f32_16x16x32_bf16 v[208:211], a[216:219], v[104:107], v[208:211]
    s_mov_b32 m0, s6
    v_exp_f32 v214, v214
    v_mfma_f32_16x16x32_bf16 v[208:211], a[220:223], v[108:111], v[208:211]
    v_exp_f32 v215, v215
    v_mfma_f32_16x16x32_bf16 a[16:19], a[168:171], v[128:131], a[16:19]
    ds_read_b64_tr_b16 a[180:181], v22 offset:8192
    v_cvt_pk_bf16_f32 v168, v212, v213
    v_mfma_f32_16x16x32_bf16 a[16:19], a[172:175], v[132:135], a[16:19]
    ds_read_b64_tr_b16 a[182:183], v22 offset:12288
    v_mfma_f32_16x16x32_bf16 a[20:23], a[172:175], v[140:143], a[20:23]
    ds_read_b128 a[236:239], v11 offset:20480
    v_cvt_pk_bf16_f32 v169, v214, v215
    v_mfma_f32_16x16x32_bf16 a[20:23], a[168:171], v[136:139], a[20:23]
    buffer_load_dwordx4 v254, s[32:35], s57 offen  lds
    v_smfmac_f32_16x16x64_bf16 a[192:195], v[52:55], v[128:135], v50
    v_mfma_f32_16x16x32_bf16 v[212:215], a[208:211], v[112:115], v[204:207]
    v_exp_f32 v208, v208
    v_mfma_f32_16x16x32_bf16 v[212:215], a[212:215], v[116:119], v[212:215]
    s_add_u32 m0, s42, 98304
    v_exp_f32 v209, v209
    v_mfma_f32_16x16x32_bf16 v[212:215], a[216:219], v[120:123], v[212:215]
    v_exp_f32 v210, v210
    v_mfma_f32_16x16x32_bf16 v[212:215], a[220:223], v[124:127], v[212:215]
    v_exp_f32 v211, v211
    v_mfma_f32_16x16x32_bf16 a[24:27], a[168:171], v[144:147], a[24:27]
    ds_read_b64_tr_b16 a[184:185], v23 offset:0
    v_cvt_pk_bf16_f32 v176, v208, v209
    v_mfma_f32_16x16x32_bf16 a[24:27], a[172:175], v[148:151], a[24:27]
    ds_read_b64_tr_b16 a[186:187], v23 offset:4096
    v_mfma_f32_16x16x32_bf16 a[28:31], a[172:175], v[156:159], a[28:31]
    ds_read_b128 a[208:211], v8 offset:24576
    v_cvt_pk_bf16_f32 v177, v210, v211
    v_mfma_f32_16x16x32_bf16 a[28:31], a[168:171], v[152:155], a[28:31]
    s_waitcnt lgkmcnt(3)
    buffer_load_dwordx4 v40, s[12:15], s41 offen lds
    v_mfma_f32_16x16x32_bf16 v[208:211], a[224:227], v[64:67], v[192:195]
    v_exp_f32 v212, v212
    v_mfma_f32_16x16x32_bf16 v[208:211], a[228:231], v[68:71], v[208:211]
    s_add_u32 s6, s6, 4096
    v_exp_f32 v213, v213
    v_mfma_f32_16x16x32_bf16 v[208:211], a[232:235], v[72:75], v[208:211]
    s_add_u32 s57, s57, 589824
    v_exp_f32 v214, v214
    v_mfma_f32_16x16x32_bf16 v[208:211], a[236:239], v[76:79], v[208:211]
    v_exp_f32 v215, v215
    v_mfma_f32_16x16x32_bf16 a[32:35], a[176:179], v[128:131], a[32:35]
    ds_read_b64_tr_b16 a[188:189], v23 offset:8192
    v_cvt_pk_bf16_f32 v184, v212, v213
    v_mfma_f32_16x16x32_bf16 a[32:35], a[180:183], v[132:135], a[32:35]
    ds_read_b64_tr_b16 a[190:191], v23 offset:12288
    v_mfma_f32_16x16x32_bf16 a[36:39], a[180:183], v[140:143], a[36:39]
    ds_read_b128 a[212:215], v9 offset:24576
    v_cvt_pk_bf16_f32 v185, v214, v215
    v_mfma_f32_16x16x32_bf16 a[36:39], a[176:179], v[136:139], a[36:39]
    v_smfmac_f32_16x16x64_bf16 a[196:199], v[52:55], v[136:143], v50
    v_mfma_f32_16x16x32_bf16 v[212:215], a[224:227], v[80:83], v[196:199]
    v_exp_f32 v208, v208
    v_mfma_f32_16x16x32_bf16 v[212:215], a[228:231], v[84:87], v[212:215]
    v_exp_f32 v209, v209
    v_mfma_f32_16x16x32_bf16 v[212:215], a[232:235], v[88:91], v[212:215]
    v_exp_f32 v210, v210
    v_mfma_f32_16x16x32_bf16 v[212:215], a[236:239], v[92:95], v[212:215]
    v_exp_f32 v211, v211
    v_mfma_f32_16x16x32_bf16 a[40:43], a[176:179], v[144:147], a[40:43]
    ds_read_b64_tr_b16 a[160:161], v24 offset:0
    v_cvt_pk_bf16_f32 v162, v208, v209
    v_mfma_f32_16x16x32_bf16 a[40:43], a[180:183], v[148:151], a[40:43]
    ds_read_b64_tr_b16 a[162:163], v24 offset:4096
    v_mfma_f32_16x16x32_bf16 a[44:47], a[180:183], v[156:159], a[44:47]
    ds_read_b128 a[216:219], v10 offset:24576
    v_cvt_pk_bf16_f32 v163, v210, v211
    v_mfma_f32_16x16x32_bf16 a[44:47], a[176:179], v[152:155], a[44:47]
    s_waitcnt lgkmcnt(3)
    buffer_load_dwordx4 v41, s[12:15], s41 offen offset:1024 lds
    v_mfma_f32_16x16x32_bf16 v[208:211], a[224:227], v[96:99], v[200:203]
    v_exp_f32 v212, v212
    v_mfma_f32_16x16x32_bf16 v[208:211], a[228:231], v[100:103], v[208:211]
    v_exp_f32 v213, v213
    v_mfma_f32_16x16x32_bf16 v[208:211], a[232:235], v[104:107], v[208:211]
    v_exp_f32 v214, v214
    v_mfma_f32_16x16x32_bf16 v[208:211], a[236:239], v[108:111], v[208:211]
    v_exp_f32 v215, v215
    v_mfma_f32_16x16x32_bf16 a[48:51], a[184:187], v[128:131], a[48:51]
    ds_read_b64_tr_b16 a[164:165], v24 offset:8192
    v_cvt_pk_bf16_f32 v170, v212, v213
    v_mfma_f32_16x16x32_bf16 a[48:51], a[188:191], v[132:135], a[48:51]
    ds_read_b64_tr_b16 a[166:167], v24 offset:12288
    v_mfma_f32_16x16x32_bf16 a[52:55], a[188:191], v[140:143], a[52:55]
    ds_read_b128 a[220:223], v11 offset:24576
    v_cvt_pk_bf16_f32 v171, v214, v215
    v_mfma_f32_16x16x32_bf16 a[52:55], a[184:187], v[136:139], a[52:55]
    v_smfmac_f32_16x16x64_bf16 a[200:203], v[52:55], v[144:151], v50
    v_mfma_f32_16x16x32_bf16 v[212:215], a[224:227], v[112:115], v[204:207]
    v_exp_f32 v208, v208
    v_mfma_f32_16x16x32_bf16 v[212:215], a[228:231], v[116:119], v[212:215]
    v_exp_f32 v209, v209
    v_mfma_f32_16x16x32_bf16 v[212:215], a[232:235], v[120:123], v[212:215]
    v_exp_f32 v210, v210
    v_mfma_f32_16x16x32_bf16 v[212:215], a[236:239], v[124:127], v[212:215]
    v_exp_f32 v211, v211
    v_mfma_f32_16x16x32_bf16 a[56:59], a[184:187], v[144:147], a[56:59]
    ds_read_b64_tr_b16 a[168:169], v25 offset:0
    v_cvt_pk_bf16_f32 v178, v208, v209
    v_mfma_f32_16x16x32_bf16 a[56:59], a[188:191], v[148:151], a[56:59]
    ds_read_b64_tr_b16 a[170:171], v25 offset:4096
    v_mfma_f32_16x16x32_bf16 a[60:63], a[188:191], v[156:159], a[60:63]
    ds_read_b128 a[224:227], v8 offset:28672
    v_cvt_pk_bf16_f32 v179, v210, v211
    v_mfma_f32_16x16x32_bf16 a[60:63], a[184:187], v[152:155], a[60:63]
    s_waitcnt lgkmcnt(3)
    buffer_load_dwordx4 v40, s[12:15], s41 offen offset:2048 lds
    v_mfma_f32_16x16x32_bf16 v[208:211], a[208:211], v[64:67], v[192:195]
    v_exp_f32 v212, v212
    v_mfma_f32_16x16x32_bf16 v[208:211], a[212:215], v[68:71], v[208:211]
    v_exp_f32 v213, v213
    v_mfma_f32_16x16x32_bf16 v[208:211], a[216:219], v[72:75], v[208:211]
    v_exp_f32 v214, v214
    v_mfma_f32_16x16x32_bf16 v[208:211], a[220:223], v[76:79], v[208:211]
    v_exp_f32 v215, v215
    v_mfma_f32_16x16x32_bf16 a[64:67], a[160:163], v[128:131], a[64:67]
    ds_read_b64_tr_b16 a[172:173], v25 offset:8192
    v_cvt_pk_bf16_f32 v186, v212, v213
    v_mfma_f32_16x16x32_bf16 a[64:67], a[164:167], v[132:135], a[64:67]
    ds_read_b64_tr_b16 a[174:175], v25 offset:12288
    v_mfma_f32_16x16x32_bf16 a[68:71], a[164:167], v[140:143], a[68:71]
    ds_read_b128 a[228:231], v9 offset:28672
    v_cvt_pk_bf16_f32 v187, v214, v215
    v_mfma_f32_16x16x32_bf16 a[68:71], a[160:163], v[136:139], a[68:71]
    v_smfmac_f32_16x16x64_bf16 a[204:207], v[52:55], v[152:159], v50
    v_mfma_f32_16x16x32_bf16 v[212:215], a[208:211], v[80:83], v[196:199]
    v_exp_f32 v208, v208
    v_mfma_f32_16x16x32_bf16 v[212:215], a[212:215], v[84:87], v[212:215]
    v_exp_f32 v209, v209
    v_mfma_f32_16x16x32_bf16 v[212:215], a[216:219], v[88:91], v[212:215]
    v_exp_f32 v210, v210
    v_mfma_f32_16x16x32_bf16 v[212:215], a[220:223], v[92:95], v[212:215]
    v_exp_f32 v211, v211
    v_mfma_f32_16x16x32_bf16 a[72:75], a[160:163], v[144:147], a[72:75]
    ds_read_b64_tr_b16 a[176:177], v26 offset:0
    v_cvt_pk_bf16_f32 v164, v208, v209
    v_mfma_f32_16x16x32_bf16 a[72:75], a[164:167], v[148:151], a[72:75]
    ds_read_b64_tr_b16 a[178:179], v26 offset:4096
    v_mfma_f32_16x16x32_bf16 a[76:79], a[164:167], v[156:159], a[76:79]
    ds_read_b128 a[232:235], v10 offset:28672
    v_cvt_pk_bf16_f32 v165, v210, v211
    v_mfma_f32_16x16x32_bf16 a[76:79], a[160:163], v[152:155], a[76:79]
    s_waitcnt lgkmcnt(3)
    buffer_load_dwordx4 v41, s[12:15], s41 offen offset:3072 lds
    v_mfma_f32_16x16x32_bf16 v[208:211], a[208:211], v[96:99], v[200:203]
    v_exp_f32 v212, v212
    v_mfma_f32_16x16x32_bf16 v[208:211], a[212:215], v[100:103], v[208:211]
    s_add_u32 s41, s41, 16384
    v_exp_f32 v213, v213
    v_mfma_f32_16x16x32_bf16 v[208:211], a[216:219], v[104:107], v[208:211]
    v_exp_f32 v214, v214
    v_mfma_f32_16x16x32_bf16 v[208:211], a[220:223], v[108:111], v[208:211]
    v_exp_f32 v215, v215
    v_mfma_f32_16x16x32_bf16 a[80:83], a[168:171], v[128:131], a[80:83]
    ds_read_b64_tr_b16 a[180:181], v26 offset:8192
    v_cvt_pk_bf16_f32 v172, v212, v213
    v_mfma_f32_16x16x32_bf16 a[80:83], a[172:175], v[132:135], a[80:83]
    ds_read_b64_tr_b16 a[182:183], v26 offset:12288
    v_mfma_f32_16x16x32_bf16 a[84:87], a[172:175], v[140:143], a[84:87]
    ds_read_b128 a[236:239], v11 offset:28672
    v_cvt_pk_bf16_f32 v173, v214, v215
    v_mfma_f32_16x16x32_bf16 a[84:87], a[168:171], v[136:139], a[84:87]
    s_waitcnt vmcnt(10)
    s_barrier
    v_mfma_f32_16x16x32_bf16 v[212:215], a[208:211], v[112:115], v[204:207]
    v_exp_f32 v208, v208
    v_mfma_f32_16x16x32_bf16 v[212:215], a[212:215], v[116:119], v[212:215]
    s_add_u32 m0, s42, 0
    v_exp_f32 v209, v209
    v_mfma_f32_16x16x32_bf16 v[212:215], a[216:219], v[120:123], v[212:215]
    v_exp_f32 v210, v210
    v_mfma_f32_16x16x32_bf16 v[212:215], a[220:223], v[124:127], v[212:215]
    v_exp_f32 v211, v211
    v_mfma_f32_16x16x32_bf16 a[88:91], a[168:171], v[144:147], a[88:91]
    ds_read_b64_tr_b16 a[184:185], v27 offset:0
    v_cvt_pk_bf16_f32 v180, v208, v209
    v_mfma_f32_16x16x32_bf16 a[88:91], a[172:175], v[148:151], a[88:91]
    ds_read_b64_tr_b16 a[186:187], v27 offset:4096
    v_mfma_f32_16x16x32_bf16 a[92:95], a[172:175], v[156:159], a[92:95]
    ds_read_b128 a[208:211], v8 offset:32768
    v_cvt_pk_bf16_f32 v181, v210, v211
    v_mfma_f32_16x16x32_bf16 a[92:95], a[168:171], v[152:155], a[92:95]
    s_waitcnt lgkmcnt(3)
    buffer_load_dwordx4 v36, s[8:11], s40 offen lds
    v_mfma_f32_16x16x32_bf16 v[208:211], a[224:227], v[64:67], v[192:195]
    v_exp_f32 v212, v212
    v_mfma_f32_16x16x32_bf16 v[208:211], a[228:231], v[68:71], v[208:211]
    v_exp_f32 v213, v213
    v_mfma_f32_16x16x32_bf16 v[208:211], a[232:235], v[72:75], v[208:211]
    v_exp_f32 v214, v214
    v_mfma_f32_16x16x32_bf16 v[208:211], a[236:239], v[76:79], v[208:211]
    v_exp_f32 v215, v215
    v_mfma_f32_16x16x32_bf16 a[96:99], a[176:179], v[128:131], a[96:99]
    ds_read_b64_tr_b16 a[188:189], v27 offset:8192
    v_cvt_pk_bf16_f32 v188, v212, v213
    v_mfma_f32_16x16x32_bf16 a[96:99], a[180:183], v[132:135], a[96:99]
    ds_read_b64_tr_b16 a[190:191], v27 offset:12288
    v_mfma_f32_16x16x32_bf16 a[100:103], a[180:183], v[140:143], a[100:103]
    ds_read_b128 a[212:215], v9 offset:32768
    v_cvt_pk_bf16_f32 v189, v214, v215
    v_mfma_f32_16x16x32_bf16 a[100:103], a[176:179], v[136:139], a[100:103]
    v_mfma_f32_16x16x32_bf16 v[212:215], a[224:227], v[80:83], v[196:199]
    v_exp_f32 v208, v208
    v_mfma_f32_16x16x32_bf16 v[212:215], a[228:231], v[84:87], v[212:215]
    v_exp_f32 v209, v209
    v_mfma_f32_16x16x32_bf16 v[212:215], a[232:235], v[88:91], v[212:215]
    v_exp_f32 v210, v210
    v_mfma_f32_16x16x32_bf16 v[212:215], a[236:239], v[92:95], v[212:215]
    v_exp_f32 v211, v211
    v_mfma_f32_16x16x32_bf16 a[104:107], a[176:179], v[144:147], a[104:107]
    ds_read_b64_tr_b16 a[160:161], v20 offset:16384
    v_cvt_pk_bf16_f32 v166, v208, v209
    v_mfma_f32_16x16x32_bf16 a[104:107], a[180:183], v[148:151], a[104:107]
    ds_read_b64_tr_b16 a[162:163], v20 offset:20480
    v_mfma_f32_16x16x32_bf16 a[108:111], a[180:183], v[156:159], a[108:111]
    ds_read_b128 a[216:219], v10 offset:32768
    v_cvt_pk_bf16_f32 v167, v210, v211
    v_mfma_f32_16x16x32_bf16 a[108:111], a[176:179], v[152:155], a[108:111]
    s_waitcnt lgkmcnt(3)
    buffer_load_dwordx4 v37, s[8:11], s40 offen offset:1024 lds
    v_mfma_f32_16x16x32_bf16 v[208:211], a[224:227], v[96:99], v[200:203]
    v_exp_f32 v212, v212
    v_mfma_f32_16x16x32_bf16 v[208:211], a[228:231], v[100:103], v[208:211]
    v_exp_f32 v213, v213
    v_mfma_f32_16x16x32_bf16 v[208:211], a[232:235], v[104:107], v[208:211]
    v_exp_f32 v214, v214
    v_mfma_f32_16x16x32_bf16 v[208:211], a[236:239], v[108:111], v[208:211]
    v_exp_f32 v215, v215
    v_mfma_f32_16x16x32_bf16 a[112:115], a[184:187], v[128:131], a[112:115]
    ds_read_b64_tr_b16 a[164:165], v20 offset:24576
    v_cvt_pk_bf16_f32 v174, v212, v213
    v_mfma_f32_16x16x32_bf16 a[112:115], a[188:191], v[132:135], a[112:115]
    ds_read_b64_tr_b16 a[166:167], v20 offset:28672
    v_mfma_f32_16x16x32_bf16 a[116:119], a[188:191], v[140:143], a[116:119]
    ds_read_b128 a[220:223], v11 offset:32768
    v_cvt_pk_bf16_f32 v175, v214, v215
    v_mfma_f32_16x16x32_bf16 a[116:119], a[184:187], v[136:139], a[116:119]
    buffer_load_dwordx4 v[240:243], v7, s[16:19], s44 offen
    v_mfma_f32_16x16x32_bf16 v[212:215], a[224:227], v[112:115], v[204:207]
    v_exp_f32 v208, v208
    v_mfma_f32_16x16x32_bf16 v[212:215], a[228:231], v[116:119], v[212:215]
    v_exp_f32 v209, v209
    v_mfma_f32_16x16x32_bf16 v[212:215], a[232:235], v[120:123], v[212:215]
    v_exp_f32 v210, v210
    v_mfma_f32_16x16x32_bf16 v[212:215], a[236:239], v[124:127], v[212:215]
    s_add_u32 s44, s44, 884736
    v_exp_f32 v211, v211
    v_mfma_f32_16x16x32_bf16 a[120:123], a[184:187], v[144:147], a[120:123]
    ds_read_b64_tr_b16 a[168:169], v21 offset:16384
    v_cvt_pk_bf16_f32 v182, v208, v209
    v_mfma_f32_16x16x32_bf16 a[120:123], a[188:191], v[148:151], a[120:123]
    ds_read_b64_tr_b16 a[170:171], v21 offset:20480
    v_mfma_f32_16x16x32_bf16 a[124:127], a[188:191], v[156:159], a[124:127]
    ds_read_b128 a[224:227], v8 offset:36864
    v_cvt_pk_bf16_f32 v183, v210, v211
    v_mfma_f32_16x16x32_bf16 a[124:127], a[184:187], v[152:155], a[124:127]
    s_waitcnt lgkmcnt(3)
    buffer_load_dwordx4 v38, s[8:11], s40 offen offset:2048 lds
    v_mfma_f32_16x16x32_bf16 v[208:211], a[208:211], v[64:67], v[192:195]
    v_exp_f32 v212, v212
    v_mfma_f32_16x16x32_bf16 v[208:211], a[212:215], v[68:71], v[208:211]
    v_exp_f32 v213, v213
    v_mfma_f32_16x16x32_bf16 v[208:211], a[216:219], v[72:75], v[208:211]
    v_exp_f32 v214, v214
    v_mfma_f32_16x16x32_bf16 v[208:211], a[220:223], v[76:79], v[208:211]
    v_exp_f32 v215, v215
    v_mfma_f32_16x16x32_bf16 a[0:3], a[160:163], v[160:163], a[0:3]
    ds_read_b64_tr_b16 a[172:173], v21 offset:24576
    v_cvt_pk_bf16_f32 v190, v212, v213
    v_mfma_f32_16x16x32_bf16 a[0:3], a[164:167], v[164:167], a[0:3]
    ds_read_b64_tr_b16 a[174:175], v21 offset:28672
    v_mfma_f32_16x16x32_bf16 a[4:7], a[164:167], v[172:175], a[4:7]
    ds_read_b128 a[228:231], v9 offset:36864
    v_cvt_pk_bf16_f32 v191, v214, v215
    v_mfma_f32_16x16x32_bf16 a[4:7], a[160:163], v[168:171], a[4:7]
    v_mfma_f32_16x16x32_bf16 v[212:215], a[208:211], v[80:83], v[196:199]
    v_exp_f32 v208, v208
    v_mfma_f32_16x16x32_bf16 v[212:215], a[212:215], v[84:87], v[212:215]
Ltour0_4:
    s_cbranch_execz Ltour0_8
    v_exp_f32 v209, v209
    v_mfma_f32_16x16x32_bf16 v[212:215], a[216:219], v[88:91], v[212:215]
    v_exp_f32 v210, v210
    v_mfma_f32_16x16x32_bf16 v[212:215], a[220:223], v[92:95], v[212:215]
    v_exp_f32 v211, v211
    v_mfma_f32_16x16x32_bf16 a[8:11], a[160:163], v[176:179], a[8:11]
    ds_read_b64_tr_b16 a[176:177], v22 offset:16384
    v_cvt_pk_bf16_f32 v128, v208, v209
    v_mfma_f32_16x16x32_bf16 a[8:11], a[164:167], v[180:183], a[8:11]
    ds_read_b64_tr_b16 a[178:179], v22 offset:20480
    v_mfma_f32_16x16x32_bf16 a[12:15], a[164:167], v[188:191], a[12:15]
    ds_read_b128 a[232:235], v10 offset:36864
    v_cvt_pk_bf16_f32 v129, v210, v211
    v_mfma_f32_16x16x32_bf16 a[12:15], a[160:163], v[184:187], a[12:15]
    s_waitcnt lgkmcnt(3)
    buffer_load_dwordx4 v39, s[8:11], s40 offen offset:3072 lds
    v_mfma_f32_16x16x32_bf16 v[208:211], a[208:211], v[96:99], v[200:203]
    v_exp_f32 v212, v212
    v_mfma_f32_16x16x32_bf16 v[208:211], a[212:215], v[100:103], v[208:211]
    s_add_u32 s40, s40, 16384
    v_exp_f32 v213, v213
    v_mfma_f32_16x16x32_bf16 v[208:211], a[216:219], v[104:107], v[208:211]
    v_exp_f32 v214, v214
    v_mfma_f32_16x16x32_bf16 v[208:211], a[220:223], v[108:111], v[208:211]
    v_exp_f32 v215, v215
    v_mfma_f32_16x16x32_bf16 a[16:19], a[168:171], v[160:163], a[16:19]
    ds_read_b64_tr_b16 a[180:181], v22 offset:24576
    v_cvt_pk_bf16_f32 v136, v212, v213
    v_mfma_f32_16x16x32_bf16 a[16:19], a[172:175], v[164:167], a[16:19]
    ds_read_b64_tr_b16 a[182:183], v22 offset:28672
    v_mfma_f32_16x16x32_bf16 a[20:23], a[172:175], v[172:175], a[20:23]
    ds_read_b128 a[236:239], v11 offset:36864
    v_cvt_pk_bf16_f32 v137, v214, v215
    v_mfma_f32_16x16x32_bf16 a[20:23], a[168:171], v[168:171], a[20:23]
    v_smfmac_f32_16x16x64_bf16 a[192:195], v[52:55], v[160:167], v50
    v_mfma_f32_16x16x32_bf16 v[212:215], a[208:211], v[112:115], v[204:207]
    v_exp_f32 v208, v208
    v_mfma_f32_16x16x32_bf16 v[212:215], a[212:215], v[116:119], v[212:215]
    s_add_u32 m0, s42, 114688
    v_exp_f32 v209, v209
    v_mfma_f32_16x16x32_bf16 v[212:215], a[216:219], v[120:123], v[212:215]
    v_exp_f32 v210, v210
    v_mfma_f32_16x16x32_bf16 v[212:215], a[220:223], v[124:127], v[212:215]
    v_exp_f32 v211, v211
    v_mfma_f32_16x16x32_bf16 a[24:27], a[168:171], v[176:179], a[24:27]
    ds_read_b64_tr_b16 a[184:185], v23 offset:16384
    v_cvt_pk_bf16_f32 v144, v208, v209
    v_mfma_f32_16x16x32_bf16 a[24:27], a[172:175], v[180:183], a[24:27]
    ds_read_b64_tr_b16 a[186:187], v23 offset:20480
    v_mfma_f32_16x16x32_bf16 a[28:31], a[172:175], v[188:191], a[28:31]
    ds_read_b128 a[208:211], v8 offset:40960
    v_cvt_pk_bf16_f32 v145, v210, v211
    v_mfma_f32_16x16x32_bf16 a[28:31], a[168:171], v[184:187], a[28:31]
    s_waitcnt lgkmcnt(3)
    buffer_load_dwordx4 v40, s[12:15], s41 offen lds
    v_mfma_f32_16x16x32_bf16 v[208:211], a[224:227], v[64:67], v[192:195]
    v_exp_f32 v212, v212
    v_mfma_f32_16x16x32_bf16 v[208:211], a[228:231], v[68:71], v[208:211]
    v_exp_f32 v213, v213
    v_mfma_f32_16x16x32_bf16 v[208:211], a[232:235], v[72:75], v[208:211]
    v_exp_f32 v214, v214
    v_mfma_f32_16x16x32_bf16 v[208:211], a[236:239], v[76:79], v[208:211]
    v_exp_f32 v215, v215
    v_mfma_f32_16x16x32_bf16 a[32:35], a[176:179], v[160:163], a[32:35]
    ds_read_b64_tr_b16 a[188:189], v23 offset:24576
    v_cvt_pk_bf16_f32 v152, v212, v213
    v_mfma_f32_16x16x32_bf16 a[32:35], a[180:183], v[164:167], a[32:35]
    ds_read_b64_tr_b16 a[190:191], v23 offset:28672
    v_mfma_f32_16x16x32_bf16 a[36:39], a[180:183], v[172:175], a[36:39]
    ds_read_b128 a[212:215], v9 offset:40960
    v_cvt_pk_bf16_f32 v153, v214, v215
    v_mfma_f32_16x16x32_bf16 a[36:39], a[176:179], v[168:171], a[36:39]
    v_smfmac_f32_16x16x64_bf16 a[196:199], v[52:55], v[168:175], v50
    v_mfma_f32_16x16x32_bf16 v[212:215], a[224:227], v[80:83], v[196:199]
    v_exp_f32 v208, v208
    v_mfma_f32_16x16x32_bf16 v[212:215], a[228:231], v[84:87], v[212:215]
    v_exp_f32 v209, v209
    v_mfma_f32_16x16x32_bf16 v[212:215], a[232:235], v[88:91], v[212:215]
    v_exp_f32 v210, v210
    v_mfma_f32_16x16x32_bf16 v[212:215], a[236:239], v[92:95], v[212:215]
    v_exp_f32 v211, v211
    v_mfma_f32_16x16x32_bf16 a[40:43], a[176:179], v[176:179], a[40:43]
    ds_read_b64_tr_b16 a[160:161], v24 offset:16384
    v_cvt_pk_bf16_f32 v130, v208, v209
    v_mfma_f32_16x16x32_bf16 a[40:43], a[180:183], v[180:183], a[40:43]
    ds_read_b64_tr_b16 a[162:163], v24 offset:20480
    v_mfma_f32_16x16x32_bf16 a[44:47], a[180:183], v[188:191], a[44:47]
    ds_read_b128 a[216:219], v10 offset:40960
    v_cvt_pk_bf16_f32 v131, v210, v211
    v_mfma_f32_16x16x32_bf16 a[44:47], a[176:179], v[184:187], a[44:47]
    s_waitcnt lgkmcnt(3)
    buffer_load_dwordx4 v41, s[12:15], s41 offen offset:1024 lds
    v_mfma_f32_16x16x32_bf16 v[208:211], a[224:227], v[96:99], v[200:203]
    v_exp_f32 v212, v212
    v_mfma_f32_16x16x32_bf16 v[208:211], a[228:231], v[100:103], v[208:211]
    v_exp_f32 v213, v213
    v_mfma_f32_16x16x32_bf16 v[208:211], a[232:235], v[104:107], v[208:211]
    v_exp_f32 v214, v214
    v_mfma_f32_16x16x32_bf16 v[208:211], a[236:239], v[108:111], v[208:211]
    v_exp_f32 v215, v215
    v_mfma_f32_16x16x32_bf16 a[48:51], a[184:187], v[160:163], a[48:51]
    ds_read_b64_tr_b16 a[164:165], v24 offset:24576
    v_cvt_pk_bf16_f32 v138, v212, v213
    v_mfma_f32_16x16x32_bf16 a[48:51], a[188:191], v[164:167], a[48:51]
    ds_read_b64_tr_b16 a[166:167], v24 offset:28672
    v_mfma_f32_16x16x32_bf16 a[52:55], a[188:191], v[172:175], a[52:55]
    ds_read_b128 a[220:223], v11 offset:40960
    v_cvt_pk_bf16_f32 v139, v214, v215
    v_mfma_f32_16x16x32_bf16 a[52:55], a[184:187], v[168:171], a[52:55]
    v_smfmac_f32_16x16x64_bf16 a[200:203], v[52:55], v[176:183], v50
    v_mfma_f32_16x16x32_bf16 v[212:215], a[224:227], v[112:115], v[204:207]
    v_exp_f32 v208, v208
    v_mfma_f32_16x16x32_bf16 v[212:215], a[228:231], v[116:119], v[212:215]
    v_exp_f32 v209, v209
    v_mfma_f32_16x16x32_bf16 v[212:215], a[232:235], v[120:123], v[212:215]
    v_exp_f32 v210, v210
    v_mfma_f32_16x16x32_bf16 v[212:215], a[236:239], v[124:127], v[212:215]
    v_exp_f32 v211, v211
    v_mfma_f32_16x16x32_bf16 a[56:59], a[184:187], v[176:179], a[56:59]
    ds_read_b64_tr_b16 a[168:169], v25 offset:16384
    v_cvt_pk_bf16_f32 v146, v208, v209
    v_mfma_f32_16x16x32_bf16 a[56:59], a[188:191], v[180:183], a[56:59]
    ds_read_b64_tr_b16 a[170:171], v25 offset:20480
    v_mfma_f32_16x16x32_bf16 a[60:63], a[188:191], v[188:191], a[60:63]
    ds_read_b128 a[224:227], v8 offset:45056
    v_cvt_pk_bf16_f32 v147, v210, v211
    v_mfma_f32_16x16x32_bf16 a[60:63], a[184:187], v[184:187], a[60:63]
    s_waitcnt lgkmcnt(3)
    buffer_load_dwordx4 v40, s[12:15], s41 offen offset:2048 lds
    v_mfma_f32_16x16x32_bf16 v[208:211], a[208:211], v[64:67], v[192:195]
    v_exp_f32 v212, v212
    v_mfma_f32_16x16x32_bf16 v[208:211], a[212:215], v[68:71], v[208:211]
    v_exp_f32 v213, v213
    v_mfma_f32_16x16x32_bf16 v[208:211], a[216:219], v[72:75], v[208:211]
    v_exp_f32 v214, v214
    v_mfma_f32_16x16x32_bf16 v[208:211], a[220:223], v[76:79], v[208:211]
    v_exp_f32 v215, v215
    v_mfma_f32_16x16x32_bf16 a[64:67], a[160:163], v[160:163], a[64:67]
    ds_read_b64_tr_b16 a[172:173], v25 offset:24576
    v_cvt_pk_bf16_f32 v154, v212, v213
    v_mfma_f32_16x16x32_bf16 a[64:67], a[164:167], v[164:167], a[64:67]
    ds_read_b64_tr_b16 a[174:175], v25 offset:28672
    v_mfma_f32_16x16x32_bf16 a[68:71], a[164:167], v[172:175], a[68:71]
    ds_read_b128 a[228:231], v9 offset:45056
    v_cvt_pk_bf16_f32 v155, v214, v215
    v_mfma_f32_16x16x32_bf16 a[68:71], a[160:163], v[168:171], a[68:71]
    v_smfmac_f32_16x16x64_bf16 a[204:207], v[52:55], v[184:191], v50
    v_mfma_f32_16x16x32_bf16 v[212:215], a[208:211], v[80:83], v[196:199]
    v_exp_f32 v208, v208
    v_mfma_f32_16x16x32_bf16 v[212:215], a[212:215], v[84:87], v[212:215]
    v_exp_f32 v209, v209
    v_mfma_f32_16x16x32_bf16 v[212:215], a[216:219], v[88:91], v[212:215]
    v_exp_f32 v210, v210
    v_mfma_f32_16x16x32_bf16 v[212:215], a[220:223], v[92:95], v[212:215]
    v_exp_f32 v211, v211
    v_mfma_f32_16x16x32_bf16 a[72:75], a[160:163], v[176:179], a[72:75]
    ds_read_b64_tr_b16 a[176:177], v26 offset:16384
    v_cvt_pk_bf16_f32 v132, v208, v209
    v_mfma_f32_16x16x32_bf16 a[72:75], a[164:167], v[180:183], a[72:75]
    ds_read_b64_tr_b16 a[178:179], v26 offset:20480
    v_mfma_f32_16x16x32_bf16 a[76:79], a[164:167], v[188:191], a[76:79]
    ds_read_b128 a[232:235], v10 offset:45056
    v_cvt_pk_bf16_f32 v133, v210, v211
    v_mfma_f32_16x16x32_bf16 a[76:79], a[160:163], v[184:187], a[76:79]
    s_waitcnt lgkmcnt(3)
    buffer_load_dwordx4 v41, s[12:15], s41 offen offset:3072 lds
    v_mfma_f32_16x16x32_bf16 v[208:211], a[208:211], v[96:99], v[200:203]
    v_exp_f32 v212, v212
    v_mfma_f32_16x16x32_bf16 v[208:211], a[212:215], v[100:103], v[208:211]
    s_add_u32 s41, s41, 16384
    v_exp_f32 v213, v213
    v_mfma_f32_16x16x32_bf16 v[208:211], a[216:219], v[104:107], v[208:211]
    v_exp_f32 v214, v214
    v_mfma_f32_16x16x32_bf16 v[208:211], a[220:223], v[108:111], v[208:211]
    v_exp_f32 v215, v215
    v_mfma_f32_16x16x32_bf16 a[80:83], a[168:171], v[160:163], a[80:83]
    ds_read_b64_tr_b16 a[180:181], v26 offset:24576
    v_cvt_pk_bf16_f32 v140, v212, v213
    v_mfma_f32_16x16x32_bf16 a[80:83], a[172:175], v[164:167], a[80:83]
    ds_read_b64_tr_b16 a[182:183], v26 offset:28672
    v_mfma_f32_16x16x32_bf16 a[84:87], a[172:175], v[172:175], a[84:87]
    ds_read_b128 a[236:239], v11 offset:45056
    v_cvt_pk_bf16_f32 v141, v214, v215
    v_mfma_f32_16x16x32_bf16 a[84:87], a[168:171], v[168:171], a[84:87]
    s_waitcnt vmcnt(9)
    s_barrier
    v_mfma_f32_16x16x32_bf16 v[212:215], a[208:211], v[112:115], v[204:207]
    v_exp_f32 v208, v208
    v_mfma_f32_16x16x32_bf16 v[212:215], a[212:215], v[116:119], v[212:215]
    s_add_u32 m0, s42, 16384
    v_exp_f32 v209, v209
    v_mfma_f32_16x16x32_bf16 v[212:215], a[216:219], v[120:123], v[212:215]
    v_exp_f32 v210, v210
    v_mfma_f32_16x16x32_bf16 v[212:215], a[220:223], v[124:127], v[212:215]
    v_exp_f32 v211, v211
    v_mfma_f32_16x16x32_bf16 a[88:91], a[168:171], v[176:179], a[88:91]
    ds_read_b64_tr_b16 a[184:185], v27 offset:16384
    v_cvt_pk_bf16_f32 v148, v208, v209
    v_mfma_f32_16x16x32_bf16 a[88:91], a[172:175], v[180:183], a[88:91]
    ds_read_b64_tr_b16 a[186:187], v27 offset:20480
    v_mfma_f32_16x16x32_bf16 a[92:95], a[172:175], v[188:191], a[92:95]
    ds_read_b128 a[208:211], v8 offset:49152
    v_cvt_pk_bf16_f32 v149, v210, v211
    v_mfma_f32_16x16x32_bf16 a[92:95], a[168:171], v[184:187], a[92:95]
    s_waitcnt lgkmcnt(3)
    buffer_load_dwordx4 v36, s[8:11], s40 offen lds
    v_mfma_f32_16x16x32_bf16 v[208:211], a[224:227], v[64:67], v[192:195]
    v_exp_f32 v212, v212
    v_mfma_f32_16x16x32_bf16 v[208:211], a[228:231], v[68:71], v[208:211]
    v_exp_f32 v213, v213
    v_mfma_f32_16x16x32_bf16 v[208:211], a[232:235], v[72:75], v[208:211]
    v_exp_f32 v214, v214
    v_mfma_f32_16x16x32_bf16 v[208:211], a[236:239], v[76:79], v[208:211]
    v_exp_f32 v215, v215
    v_mfma_f32_16x16x32_bf16 a[96:99], a[176:179], v[160:163], a[96:99]
    ds_read_b64_tr_b16 a[188:189], v27 offset:24576
    v_cvt_pk_bf16_f32 v156, v212, v213
    v_mfma_f32_16x16x32_bf16 a[96:99], a[180:183], v[164:167], a[96:99]
    ds_read_b64_tr_b16 a[190:191], v27 offset:28672
    v_mfma_f32_16x16x32_bf16 a[100:103], a[180:183], v[172:175], a[100:103]
    ds_read_b128 a[212:215], v9 offset:49152
    v_cvt_pk_bf16_f32 v157, v214, v215
    v_mfma_f32_16x16x32_bf16 a[100:103], a[176:179], v[168:171], a[100:103]
    buffer_load_dword v218, v57, s[80:83], s39 offen
    v_mfma_f32_16x16x32_bf16 v[212:215], a[224:227], v[80:83], v[196:199]
    v_exp_f32 v208, v208
    v_mfma_f32_16x16x32_bf16 v[212:215], a[228:231], v[84:87], v[212:215]
    v_exp_f32 v209, v209
    v_mfma_f32_16x16x32_bf16 v[212:215], a[232:235], v[88:91], v[212:215]
    v_exp_f32 v210, v210
    v_mfma_f32_16x16x32_bf16 v[212:215], a[236:239], v[92:95], v[212:215]
    v_exp_f32 v211, v211
    v_mfma_f32_16x16x32_bf16 a[104:107], a[176:179], v[176:179], a[104:107]
    ds_read_b64_tr_b16 a[160:161], v20 offset:32768
    v_cvt_pk_bf16_f32 v134, v208, v209
    v_mfma_f32_16x16x32_bf16 a[104:107], a[180:183], v[180:183], a[104:107]
    ds_read_b64_tr_b16 a[162:163], v20 offset:36864
    v_mfma_f32_16x16x32_bf16 a[108:111], a[180:183], v[188:191], a[108:111]
    ds_read_b128 a[216:219], v10 offset:49152
    v_cvt_pk_bf16_f32 v135, v210, v211
    v_mfma_f32_16x16x32_bf16 a[108:111], a[176:179], v[184:187], a[108:111]
    s_waitcnt lgkmcnt(3)
    buffer_load_dwordx4 v37, s[8:11], s40 offen offset:1024 lds
    v_mfma_f32_16x16x32_bf16 v[208:211], a[224:227], v[96:99], v[200:203]
    v_exp_f32 v212, v212
    v_mfma_f32_16x16x32_bf16 v[208:211], a[228:231], v[100:103], v[208:211]
    v_exp_f32 v213, v213
    v_mfma_f32_16x16x32_bf16 v[208:211], a[232:235], v[104:107], v[208:211]
    v_exp_f32 v214, v214
    v_mfma_f32_16x16x32_bf16 v[208:211], a[236:239], v[108:111], v[208:211]
    v_exp_f32 v215, v215
    v_mfma_f32_16x16x32_bf16 a[112:115], a[184:187], v[160:163], a[112:115]
    ds_read_b64_tr_b16 a[164:165], v20 offset:40960
    v_cvt_pk_bf16_f32 v142, v212, v213
    v_mfma_f32_16x16x32_bf16 a[112:115], a[188:191], v[164:167], a[112:115]
    ds_read_b64_tr_b16 a[166:167], v20 offset:45056
    v_mfma_f32_16x16x32_bf16 a[116:119], a[188:191], v[172:175], a[116:119]
    ds_read_b128 a[220:223], v11 offset:49152
    v_cvt_pk_bf16_f32 v143, v214, v215
    v_mfma_f32_16x16x32_bf16 a[116:119], a[184:187], v[168:171], a[116:119]
    buffer_store_dwordx4 v[248:251], v232, s[24:27], s53 offen sc1
    v_mfma_f32_16x16x32_bf16 v[212:215], a[224:227], v[112:115], v[204:207]
    v_exp_f32 v208, v208
    v_mfma_f32_16x16x32_bf16 v[212:215], a[228:231], v[116:119], v[212:215]
    v_exp_f32 v209, v209
    v_mfma_f32_16x16x32_bf16 v[212:215], a[232:235], v[120:123], v[212:215]
    v_exp_f32 v210, v210
    v_mfma_f32_16x16x32_bf16 v[212:215], a[236:239], v[124:127], v[212:215]
    s_add_u32 s53, s53, 656
    v_exp_f32 v211, v211
    v_mfma_f32_16x16x32_bf16 a[120:123], a[184:187], v[176:179], a[120:123]
    ds_read_b64_tr_b16 a[168:169], v21 offset:32768
    v_cvt_pk_bf16_f32 v150, v208, v209
    v_mfma_f32_16x16x32_bf16 a[120:123], a[188:191], v[180:183], a[120:123]
    ds_read_b64_tr_b16 a[170:171], v21 offset:36864
    v_mfma_f32_16x16x32_bf16 a[124:127], a[188:191], v[188:191], a[124:127]
    ds_read_b128 a[224:227], v8 offset:53248
    v_cvt_pk_bf16_f32 v151, v210, v211
    v_mfma_f32_16x16x32_bf16 a[124:127], a[184:187], v[184:187], a[124:127]
    s_waitcnt lgkmcnt(3)
    buffer_load_dwordx4 v38, s[8:11], s40 offen offset:2048 lds
    v_mfma_f32_16x16x32_bf16 v[208:211], a[208:211], v[64:67], v[192:195]
    v_exp_f32 v212, v212
    v_mfma_f32_16x16x32_bf16 v[208:211], a[212:215], v[68:71], v[208:211]
    v_exp_f32 v213, v213
    v_mfma_f32_16x16x32_bf16 v[208:211], a[216:219], v[72:75], v[208:211]
    v_exp_f32 v214, v214
    v_mfma_f32_16x16x32_bf16 v[208:211], a[220:223], v[76:79], v[208:211]
    v_exp_f32 v215, v215
    v_mfma_f32_16x16x32_bf16 a[0:3], a[160:163], v[128:131], a[0:3]
    ds_read_b64_tr_b16 a[172:173], v21 offset:40960
    v_cvt_pk_bf16_f32 v158, v212, v213
    v_mfma_f32_16x16x32_bf16 a[0:3], a[164:167], v[132:135], a[0:3]
    ds_read_b64_tr_b16 a[174:175], v21 offset:45056
    v_mfma_f32_16x16x32_bf16 a[4:7], a[164:167], v[140:143], a[4:7]
    ds_read_b128 a[228:231], v9 offset:53248
    v_cvt_pk_bf16_f32 v159, v214, v215
    v_mfma_f32_16x16x32_bf16 a[4:7], a[160:163], v[136:139], a[4:7]
    v_mfma_f32_16x16x32_bf16 v[212:215], a[208:211], v[80:83], v[196:199]
    v_exp_f32 v208, v208
    v_mfma_f32_16x16x32_bf16 v[212:215], a[212:215], v[84:87], v[212:215]
    v_exp_f32 v209, v209
    v_mfma_f32_16x16x32_bf16 v[212:215], a[216:219], v[88:91], v[212:215]
    v_exp_f32 v210, v210
    v_mfma_f32_16x16x32_bf16 v[212:215], a[220:223], v[92:95], v[212:215]
    v_exp_f32 v211, v211
    v_mfma_f32_16x16x32_bf16 a[8:11], a[160:163], v[144:147], a[8:11]
    ds_read_b64_tr_b16 a[176:177], v22 offset:32768
    v_cvt_pk_bf16_f32 v160, v208, v209
    v_mfma_f32_16x16x32_bf16 a[8:11], a[164:167], v[148:151], a[8:11]
    ds_read_b64_tr_b16 a[178:179], v22 offset:36864
    v_mfma_f32_16x16x32_bf16 a[12:15], a[164:167], v[156:159], a[12:15]
    ds_read_b128 a[232:235], v10 offset:53248
    v_cvt_pk_bf16_f32 v161, v210, v211
    v_mfma_f32_16x16x32_bf16 a[12:15], a[160:163], v[152:155], a[12:15]
    s_waitcnt lgkmcnt(3)
    buffer_load_dwordx4 v39, s[8:11], s40 offen offset:3072 lds
    v_mfma_f32_16x16x32_bf16 v[208:211], a[208:211], v[96:99], v[200:203]
    v_exp_f32 v212, v212
    v_mfma_f32_16x16x32_bf16 v[208:211], a[212:215], v[100:103], v[208:211]
    s_add_u32 s40, s40, 16384
    v_exp_f32 v213, v213
    v_mfma_f32_16x16x32_bf16 v[208:211], a[216:219], v[104:107], v[208:211]
    v_exp_f32 v214, v214
    v_mfma_f32_16x16x32_bf16 v[208:211], a[220:223], v[108:111], v[208:211]
    v_exp_f32 v215, v215
    v_mfma_f32_16x16x32_bf16 a[16:19], a[168:171], v[128:131], a[16:19]
    ds_read_b64_tr_b16 a[180:181], v22 offset:40960
    v_cvt_pk_bf16_f32 v168, v212, v213
    v_mfma_f32_16x16x32_bf16 a[16:19], a[172:175], v[132:135], a[16:19]
    ds_read_b64_tr_b16 a[182:183], v22 offset:45056
    v_mfma_f32_16x16x32_bf16 a[20:23], a[172:175], v[140:143], a[20:23]
    ds_read_b128 a[236:239], v11 offset:53248
    v_cvt_pk_bf16_f32 v169, v214, v215
    v_mfma_f32_16x16x32_bf16 a[20:23], a[168:171], v[136:139], a[20:23]
    v_smfmac_f32_16x16x64_bf16 a[192:195], v[52:55], v[128:135], v50
    v_mfma_f32_16x16x32_bf16 v[212:215], a[208:211], v[112:115], v[204:207]
    v_exp_f32 v208, v208
    v_mfma_f32_16x16x32_bf16 v[212:215], a[212:215], v[116:119], v[212:215]
    s_add_u32 m0, s42, 65536
    v_exp_f32 v209, v209
    v_mfma_f32_16x16x32_bf16 v[212:215], a[216:219], v[120:123], v[212:215]
    v_exp_f32 v210, v210
    v_mfma_f32_16x16x32_bf16 v[212:215], a[220:223], v[124:127], v[212:215]
    v_exp_f32 v211, v211
    v_mfma_f32_16x16x32_bf16 a[24:27], a[168:171], v[144:147], a[24:27]
    ds_read_b64_tr_b16 a[184:185], v23 offset:32768
    v_cvt_pk_bf16_f32 v176, v208, v209
    v_mfma_f32_16x16x32_bf16 a[24:27], a[172:175], v[148:151], a[24:27]
    ds_read_b64_tr_b16 a[186:187], v23 offset:36864
    v_mfma_f32_16x16x32_bf16 a[28:31], a[172:175], v[156:159], a[28:31]
    ds_read_b128 a[208:211], v8 offset:57344
    v_cvt_pk_bf16_f32 v177, v210, v211
    v_mfma_f32_16x16x32_bf16 a[28:31], a[168:171], v[152:155], a[28:31]
    s_waitcnt lgkmcnt(3)
    buffer_load_dwordx4 v40, s[12:15], s41 offen lds
    v_mfma_f32_16x16x32_bf16 v[208:211], a[224:227], v[64:67], v[192:195]
    v_exp_f32 v212, v212
    v_mfma_f32_16x16x32_bf16 v[208:211], a[228:231], v[68:71], v[208:211]
    v_exp_f32 v213, v213
    v_mfma_f32_16x16x32_bf16 v[208:211], a[232:235], v[72:75], v[208:211]
    v_exp_f32 v214, v214
    v_mfma_f32_16x16x32_bf16 v[208:211], a[236:239], v[76:79], v[208:211]
    v_exp_f32 v215, v215
    v_mfma_f32_16x16x32_bf16 a[32:35], a[176:179], v[128:131], a[32:35]
    ds_read_b64_tr_b16 a[188:189], v23 offset:40960
    v_cvt_pk_bf16_f32 v184, v212, v213
    v_mfma_f32_16x16x32_bf16 a[32:35], a[180:183], v[132:135], a[32:35]
    ds_read_b64_tr_b16 a[190:191], v23 offset:45056
    v_mfma_f32_16x16x32_bf16 a[36:39], a[180:183], v[140:143], a[36:39]
    ds_read_b128 a[212:215], v9 offset:57344
    v_cvt_pk_bf16_f32 v185, v214, v215
    v_mfma_f32_16x16x32_bf16 a[36:39], a[176:179], v[136:139], a[36:39]
    v_smfmac_f32_16x16x64_bf16 a[196:199], v[52:55], v[136:143], v50
    v_mfma_f32_16x16x32_bf16 v[212:215], a[224:227], v[80:83], v[196:199]
    v_exp_f32 v208, v208
    v_mfma_f32_16x16x32_bf16 v[212:215], a[228:231], v[84:87], v[212:215]
    v_exp_f32 v209, v209
    v_mfma_f32_16x16x32_bf16 v[212:215], a[232:235], v[88:91], v[212:215]
    v_exp_f32 v210, v210
    v_mfma_f32_16x16x32_bf16 v[212:215], a[236:239], v[92:95], v[212:215]
    v_exp_f32 v211, v211
    v_mfma_f32_16x16x32_bf16 a[40:43], a[176:179], v[144:147], a[40:43]
    ds_read_b64_tr_b16 a[160:161], v24 offset:32768
    v_cvt_pk_bf16_f32 v162, v208, v209
    v_mfma_f32_16x16x32_bf16 a[40:43], a[180:183], v[148:151], a[40:43]
    ds_read_b64_tr_b16 a[162:163], v24 offset:36864
    v_mfma_f32_16x16x32_bf16 a[44:47], a[180:183], v[156:159], a[44:47]
    ds_read_b128 a[216:219], v10 offset:57344
    v_cvt_pk_bf16_f32 v163, v210, v211
    v_mfma_f32_16x16x32_bf16 a[44:47], a[176:179], v[152:155], a[44:47]
    s_waitcnt lgkmcnt(3)
    buffer_load_dwordx4 v41, s[12:15], s41 offen offset:1024 lds
    v_mfma_f32_16x16x32_bf16 v[208:211], a[224:227], v[96:99], v[200:203]
    v_exp_f32 v212, v212
    v_mfma_f32_16x16x32_bf16 v[208:211], a[228:231], v[100:103], v[208:211]
    v_exp_f32 v213, v213
    v_mfma_f32_16x16x32_bf16 v[208:211], a[232:235], v[104:107], v[208:211]
    v_exp_f32 v214, v214
    v_mfma_f32_16x16x32_bf16 v[208:211], a[236:239], v[108:111], v[208:211]
    v_exp_f32 v215, v215
    v_mfma_f32_16x16x32_bf16 a[48:51], a[184:187], v[128:131], a[48:51]
    ds_read_b64_tr_b16 a[164:165], v24 offset:40960
    v_cvt_pk_bf16_f32 v170, v212, v213
    v_mfma_f32_16x16x32_bf16 a[48:51], a[188:191], v[132:135], a[48:51]
    ds_read_b64_tr_b16 a[166:167], v24 offset:45056
    v_mfma_f32_16x16x32_bf16 a[52:55], a[188:191], v[140:143], a[52:55]
    ds_read_b128 a[220:223], v11 offset:57344
    v_cvt_pk_bf16_f32 v171, v214, v215
    v_mfma_f32_16x16x32_bf16 a[52:55], a[184:187], v[136:139], a[52:55]
    v_smfmac_f32_16x16x64_bf16 a[200:203], v[52:55], v[144:151], v50
    v_mfma_f32_16x16x32_bf16 v[212:215], a[224:227], v[112:115], v[204:207]
    v_exp_f32 v208, v208
    v_mfma_f32_16x16x32_bf16 v[212:215], a[228:231], v[116:119], v[212:215]
    v_exp_f32 v209, v209
    v_mfma_f32_16x16x32_bf16 v[212:215], a[232:235], v[120:123], v[212:215]
    v_exp_f32 v210, v210
    v_mfma_f32_16x16x32_bf16 v[212:215], a[236:239], v[124:127], v[212:215]
    v_exp_f32 v211, v211
    v_mfma_f32_16x16x32_bf16 a[56:59], a[184:187], v[144:147], a[56:59]
    ds_read_b64_tr_b16 a[168:169], v25 offset:32768
    v_cvt_pk_bf16_f32 v178, v208, v209
    v_mfma_f32_16x16x32_bf16 a[56:59], a[188:191], v[148:151], a[56:59]
    ds_read_b64_tr_b16 a[170:171], v25 offset:36864
    v_mfma_f32_16x16x32_bf16 a[60:63], a[188:191], v[156:159], a[60:63]
    ds_read_b128 a[224:227], v8 offset:61440
    v_cvt_pk_bf16_f32 v179, v210, v211
    v_mfma_f32_16x16x32_bf16 a[60:63], a[184:187], v[152:155], a[60:63]
    s_waitcnt lgkmcnt(3)
    buffer_load_dwordx4 v40, s[12:15], s41 offen offset:2048 lds
    v_mfma_f32_16x16x32_bf16 v[208:211], a[208:211], v[64:67], v[192:195]
    v_exp_f32 v212, v212
    v_mfma_f32_16x16x32_bf16 v[208:211], a[212:215], v[68:71], v[208:211]
    v_exp_f32 v213, v213
    v_mfma_f32_16x16x32_bf16 v[208:211], a[216:219], v[72:75], v[208:211]
    v_exp_f32 v214, v214
    v_mfma_f32_16x16x32_bf16 v[208:211], a[220:223], v[76:79], v[208:211]
    v_exp_f32 v215, v215
    v_mfma_f32_16x16x32_bf16 a[64:67], a[160:163], v[128:131], a[64:67]
    ds_read_b64_tr_b16 a[172:173], v25 offset:40960
    v_cvt_pk_bf16_f32 v186, v212, v213
    v_mfma_f32_16x16x32_bf16 a[64:67], a[164:167], v[132:135], a[64:67]
    ds_read_b64_tr_b16 a[174:175], v25 offset:45056
    v_mfma_f32_16x16x32_bf16 a[68:71], a[164:167], v[140:143], a[68:71]
    ds_read_b128 a[228:231], v9 offset:61440
    v_cvt_pk_bf16_f32 v187, v214, v215
    v_mfma_f32_16x16x32_bf16 a[68:71], a[160:163], v[136:139], a[68:71]
    v_smfmac_f32_16x16x64_bf16 a[204:207], v[52:55], v[152:159], v50
    v_mfma_f32_16x16x32_bf16 v[212:215], a[208:211], v[80:83], v[196:199]
    v_exp_f32 v208, v208
    v_mfma_f32_16x16x32_bf16 v[212:215], a[212:215], v[84:87], v[212:215]
    v_exp_f32 v209, v209
    v_mfma_f32_16x16x32_bf16 v[212:215], a[216:219], v[88:91], v[212:215]
    v_exp_f32 v210, v210
    v_mfma_f32_16x16x32_bf16 v[212:215], a[220:223], v[92:95], v[212:215]
    v_exp_f32 v211, v211
    v_mfma_f32_16x16x32_bf16 a[72:75], a[160:163], v[144:147], a[72:75]
    ds_read_b64_tr_b16 a[176:177], v26 offset:32768
    v_cvt_pk_bf16_f32 v164, v208, v209
    v_mfma_f32_16x16x32_bf16 a[72:75], a[164:167], v[148:151], a[72:75]
    ds_read_b64_tr_b16 a[178:179], v26 offset:36864
    v_mfma_f32_16x16x32_bf16 a[76:79], a[164:167], v[156:159], a[76:79]
    ds_read_b128 a[232:235], v10 offset:61440
    v_cvt_pk_bf16_f32 v165, v210, v211
    v_mfma_f32_16x16x32_bf16 a[76:79], a[160:163], v[152:155], a[76:79]
    s_waitcnt lgkmcnt(3)
    buffer_load_dwordx4 v41, s[12:15], s41 offen offset:3072 lds
    v_mfma_f32_16x16x32_bf16 v[208:211], a[208:211], v[96:99], v[200:203]
    v_exp_f32 v212, v212
    v_mfma_f32_16x16x32_bf16 v[208:211], a[212:215], v[100:103], v[208:211]
    s_add_u32 s41, s41, 16384
    v_exp_f32 v213, v213
    v_mfma_f32_16x16x32_bf16 v[208:211], a[216:219], v[104:107], v[208:211]
    v_exp_f32 v214, v214
    v_mfma_f32_16x16x32_bf16 v[208:211], a[220:223], v[108:111], v[208:211]
    v_exp_f32 v215, v215
    v_mfma_f32_16x16x32_bf16 a[80:83], a[168:171], v[128:131], a[80:83]
    ds_read_b64_tr_b16 a[180:181], v26 offset:40960
    v_cvt_pk_bf16_f32 v172, v212, v213
    v_mfma_f32_16x16x32_bf16 a[80:83], a[172:175], v[132:135], a[80:83]
    ds_read_b64_tr_b16 a[182:183], v26 offset:45056
    v_mfma_f32_16x16x32_bf16 a[84:87], a[172:175], v[140:143], a[84:87]
    ds_read_b128 a[236:239], v11 offset:61440
    v_cvt_pk_bf16_f32 v173, v214, v215
    v_mfma_f32_16x16x32_bf16 a[84:87], a[168:171], v[136:139], a[84:87]
    s_waitcnt vmcnt(10)
    s_barrier
    v_mfma_f32_16x16x32_bf16 v[212:215], a[208:211], v[112:115], v[204:207]
    v_exp_f32 v208, v208
    v_mfma_f32_16x16x32_bf16 v[212:215], a[212:215], v[116:119], v[212:215]
    s_add_u32 m0, s42, 32768
    v_exp_f32 v209, v209
    v_mfma_f32_16x16x32_bf16 v[212:215], a[216:219], v[120:123], v[212:215]
    v_exp_f32 v210, v210
    v_mfma_f32_16x16x32_bf16 v[212:215], a[220:223], v[124:127], v[212:215]
    v_exp_f32 v211, v211
    v_mfma_f32_16x16x32_bf16 a[88:91], a[168:171], v[144:147], a[88:91]
    ds_read_b64_tr_b16 a[184:185], v27 offset:32768
    v_cvt_pk_bf16_f32 v180, v208, v209
    v_mfma_f32_16x16x32_bf16 a[88:91], a[172:175], v[148:151], a[88:91]
    ds_read_b64_tr_b16 a[186:187], v27 offset:36864
    v_mfma_f32_16x16x32_bf16 a[92:95], a[172:175], v[156:159], a[92:95]
    ds_read_b128 a[208:211], v8 offset:0
    v_cvt_pk_bf16_f32 v181, v210, v211
    v_mfma_f32_16x16x32_bf16 a[92:95], a[168:171], v[152:155], a[92:95]
    s_waitcnt lgkmcnt(3)
    buffer_load_dwordx4 v36, s[8:11], s40 offen lds
    v_mfma_f32_16x16x32_bf16 v[208:211], a[224:227], v[64:67], v[192:195]
    v_exp_f32 v212, v212
    v_mfma_f32_16x16x32_bf16 v[208:211], a[228:231], v[68:71], v[208:211]
    v_exp_f32 v213, v213
    v_mfma_f32_16x16x32_bf16 v[208:211], a[232:235], v[72:75], v[208:211]
    v_exp_f32 v214, v214
    v_mfma_f32_16x16x32_bf16 v[208:211], a[236:239], v[76:79], v[208:211]
    v_exp_f32 v215, v215
    v_mfma_f32_16x16x32_bf16 a[96:99], a[176:179], v[128:131], a[96:99]
    ds_read_b64_tr_b16 a[188:189], v27 offset:40960
    v_cvt_pk_bf16_f32 v188, v212, v213
    v_mfma_f32_16x16x32_bf16 a[96:99], a[180:183], v[132:135], a[96:99]
    ds_read_b64_tr_b16 a[190:191], v27 offset:45056
    v_mfma_f32_16x16x32_bf16 a[100:103], a[180:183], v[140:143], a[100:103]
    ds_read_b128 a[212:215], v9 offset:0
    v_cvt_pk_bf16_f32 v189, v214, v215
    v_mfma_f32_16x16x32_bf16 a[100:103], a[176:179], v[136:139], a[100:103]
    buffer_load_dword v219, v62, s[84:87], s38 offen
    v_mfma_f32_16x16x32_bf16 v[212:215], a[224:227], v[80:83], v[196:199]
    v_exp_f32 v208, v208
    v_mfma_f32_16x16x32_bf16 v[212:215], a[228:231], v[84:87], v[212:215]
    v_exp_f32 v209, v209
    v_mfma_f32_16x16x32_bf16 v[212:215], a[232:235], v[88:91], v[212:215]
    v_exp_f32 v210, v210
    v_mfma_f32_16x16x32_bf16 v[212:215], a[236:239], v[92:95], v[212:215]
    v_exp_f32 v211, v211
    v_mfma_f32_16x16x32_bf16 a[104:107], a[176:179], v[144:147], a[104:107]
    ds_read_b64_tr_b16 a[160:161], v20 offset:49152
    v_cvt_pk_bf16_f32 v166, v208, v209
    v_mfma_f32_16x16x32_bf16 a[104:107], a[180:183], v[148:151], a[104:107]
    ds_read_b64_tr_b16 a[162:163], v20 offset:53248
    v_mfma_f32_16x16x32_bf16 a[108:111], a[180:183], v[156:159], a[108:111]
    ds_read_b128 a[216:219], v10 offset:0
    v_cvt_pk_bf16_f32 v167, v210, v211
    v_mfma_f32_16x16x32_bf16 a[108:111], a[176:179], v[152:155], a[108:111]
    s_waitcnt lgkmcnt(3)
    buffer_load_dwordx4 v37, s[8:11], s40 offen offset:1024 lds
    v_mfma_f32_16x16x32_bf16 v[208:211], a[224:227], v[96:99], v[200:203]
    v_exp_f32 v212, v212
    v_mfma_f32_16x16x32_bf16 v[208:211], a[228:231], v[100:103], v[208:211]
    v_exp_f32 v213, v213
    v_mfma_f32_16x16x32_bf16 v[208:211], a[232:235], v[104:107], v[208:211]
    v_exp_f32 v214, v214
    v_mfma_f32_16x16x32_bf16 v[208:211], a[236:239], v[108:111], v[208:211]
    v_exp_f32 v215, v215
    v_mfma_f32_16x16x32_bf16 a[112:115], a[184:187], v[128:131], a[112:115]
    ds_read_b64_tr_b16 a[164:165], v20 offset:57344
    v_cvt_pk_bf16_f32 v174, v212, v213
    v_mfma_f32_16x16x32_bf16 a[112:115], a[188:191], v[132:135], a[112:115]
    ds_read_b64_tr_b16 a[166:167], v20 offset:61440
    v_mfma_f32_16x16x32_bf16 a[116:119], a[188:191], v[140:143], a[116:119]
    ds_read_b128 a[220:223], v11 offset:0
    v_cvt_pk_bf16_f32 v175, v214, v215
    v_mfma_f32_16x16x32_bf16 a[116:119], a[184:187], v[136:139], a[116:119]
    buffer_load_dword v221, v235, s[20:23], 0 offen
    v_mfma_f32_16x16x32_bf16 v[212:215], a[224:227], v[112:115], v[204:207]
    v_exp_f32 v208, v208
    v_mfma_f32_16x16x32_bf16 v[212:215], a[228:231], v[116:119], v[212:215]
    v_exp_f32 v209, v209
    v_mfma_f32_16x16x32_bf16 v[212:215], a[232:235], v[120:123], v[212:215]
    v_exp_f32 v210, v210
    v_mfma_f32_16x16x32_bf16 v[212:215], a[236:239], v[124:127], v[212:215]
    v_exp_f32 v211, v211
    v_mfma_f32_16x16x32_bf16 a[120:123], a[184:187], v[144:147], a[120:123]
    ds_read_b64_tr_b16 a[168:169], v21 offset:49152
    v_cvt_pk_bf16_f32 v182, v208, v209
    v_mfma_f32_16x16x32_bf16 a[120:123], a[188:191], v[148:151], a[120:123]
    ds_read_b64_tr_b16 a[170:171], v21 offset:53248
    v_add_u32 v235, 2560, v235
    v_mfma_f32_16x16x32_bf16 a[124:127], a[188:191], v[156:159], a[124:127]
    ds_read_b128 a[224:227], v8 offset:4096
    v_cvt_pk_bf16_f32 v183, v210, v211
    v_mfma_f32_16x16x32_bf16 a[124:127], a[184:187], v[152:155], a[124:127]
    s_waitcnt lgkmcnt(3)
    buffer_load_dwordx4 v38, s[8:11], s40 offen offset:2048 lds
    v_mfma_f32_16x16x32_bf16 v[208:211], a[208:211], v[64:67], v[192:195]
Ltour0_5:
    s_cbranch_execz Ltour0_9
    v_exp_f32 v212, v212
    v_mfma_f32_16x16x32_bf16 v[208:211], a[212:215], v[68:71], v[208:211]
    v_exp_f32 v213, v213
    v_mfma_f32_16x16x32_bf16 v[208:211], a[216:219], v[72:75], v[208:211]
    v_exp_f32 v214, v214
    v_mfma_f32_16x16x32_bf16 v[208:211], a[220:223], v[76:79], v[208:211]
    v_exp_f32 v215, v215
    v_mfma_f32_16x16x32_bf16 a[0:3], a[160:163], v[160:163], a[0:3]
    ds_read_b64_tr_b16 a[172:173], v21 offset:57344
    v_cvt_pk_bf16_f32 v190, v212, v213
    v_mfma_f32_16x16x32_bf16 a[0:3], a[164:167], v[164:167], a[0:3]
    ds_read_b64_tr_b16 a[174:175], v21 offset:61440
    v_lshlrev_b32 v244, 16, v240
    v_mfma_f32_16x16x32_bf16 a[4:7], a[164:167], v[172:175], a[4:7]
    ds_read_b128 a[228:231], v9 offset:4096
    v_cvt_pk_bf16_f32 v191, v214, v215
    v_mfma_f32_16x16x32_bf16 a[4:7], a[160:163], v[168:171], a[4:7]
    v_and_b32 v245, 0xffff0000, v240
    v_fmac_f32 v224, v2, v244
    v_mfma_f32_16x16x32_bf16 v[212:215], a[208:211], v[80:83], v[196:199]
    v_exp_f32 v208, v208
    v_mfma_f32_16x16x32_bf16 v[212:215], a[212:215], v[84:87], v[212:215]
    v_exp_f32 v209, v209
    v_mfma_f32_16x16x32_bf16 v[212:215], a[216:219], v[88:91], v[212:215]
    v_exp_f32 v210, v210
    v_mfma_f32_16x16x32_bf16 v[212:215], a[220:223], v[92:95], v[212:215]
    v_exp_f32 v211, v211
    v_mfma_f32_16x16x32_bf16 a[8:11], a[160:163], v[176:179], a[8:11]
    ds_read_b64_tr_b16 a[176:177], v22 offset:49152
    v_cvt_pk_bf16_f32 v128, v208, v209
    v_mfma_f32_16x16x32_bf16 a[8:11], a[164:167], v[180:183], a[8:11]
    ds_read_b64_tr_b16 a[178:179], v22 offset:53248
    v_fmac_f32 v225, v2, v245
    v_mfma_f32_16x16x32_bf16 a[12:15], a[164:167], v[188:191], a[12:15]
    ds_read_b128 a[232:235], v10 offset:4096
    v_cvt_pk_bf16_f32 v129, v210, v211
    v_mfma_f32_16x16x32_bf16 a[12:15], a[160:163], v[184:187], a[12:15]
    s_waitcnt lgkmcnt(3)
    buffer_load_dwordx4 v39, s[8:11], s40 offen offset:3072 lds
    v_mfma_f32_16x16x32_bf16 v[208:211], a[208:211], v[96:99], v[200:203]
    v_exp_f32 v212, v212
    v_mfma_f32_16x16x32_bf16 v[208:211], a[212:215], v[100:103], v[208:211]
    s_add_u32 s40, s40, 16384
    v_exp_f32 v213, v213
    v_mfma_f32_16x16x32_bf16 v[208:211], a[216:219], v[104:107], v[208:211]
    v_exp_f32 v214, v214
    v_mfma_f32_16x16x32_bf16 v[208:211], a[220:223], v[108:111], v[208:211]
    v_exp_f32 v215, v215
    v_mfma_f32_16x16x32_bf16 a[16:19], a[168:171], v[160:163], a[16:19]
    ds_read_b64_tr_b16 a[180:181], v22 offset:57344
    v_cvt_pk_bf16_f32 v136, v212, v213
    v_mfma_f32_16x16x32_bf16 a[16:19], a[172:175], v[164:167], a[16:19]
    ds_read_b64_tr_b16 a[182:183], v22 offset:61440
    v_lshlrev_b32 v246, 16, v241
    v_mfma_f32_16x16x32_bf16 a[20:23], a[172:175], v[172:175], a[20:23]
    ds_read_b128 a[236:239], v11 offset:4096
    v_cvt_pk_bf16_f32 v137, v214, v215
    v_mfma_f32_16x16x32_bf16 a[20:23], a[168:171], v[168:171], a[20:23]
    v_and_b32 v247, 0xffff0000, v241
    v_fmac_f32 v226, v2, v246
    v_smfmac_f32_16x16x64_bf16 a[192:195], v[52:55], v[160:167], v50
    v_mfma_f32_16x16x32_bf16 v[212:215], a[208:211], v[112:115], v[204:207]
    v_exp_f32 v208, v208
    v_mfma_f32_16x16x32_bf16 v[212:215], a[212:215], v[116:119], v[212:215]
    s_add_u32 m0, s42, 81920
    v_exp_f32 v209, v209
    v_mfma_f32_16x16x32_bf16 v[212:215], a[216:219], v[120:123], v[212:215]
    v_exp_f32 v210, v210
    v_mfma_f32_16x16x32_bf16 v[212:215], a[220:223], v[124:127], v[212:215]
    v_exp_f32 v211, v211
    v_mfma_f32_16x16x32_bf16 a[24:27], a[168:171], v[176:179], a[24:27]
    ds_read_b64_tr_b16 a[184:185], v23 offset:49152
    v_cvt_pk_bf16_f32 v144, v208, v209
    v_mfma_f32_16x16x32_bf16 a[24:27], a[172:175], v[180:183], a[24:27]
    ds_read_b64_tr_b16 a[186:187], v23 offset:53248
    v_fmac_f32 v227, v2, v247
    v_mfma_f32_16x16x32_bf16 a[28:31], a[172:175], v[188:191], a[28:31]
    ds_read_b128 a[208:211], v8 offset:8192
    v_cvt_pk_bf16_f32 v145, v210, v211
    v_mfma_f32_16x16x32_bf16 a[28:31], a[168:171], v[184:187], a[28:31]
    s_waitcnt lgkmcnt(3)
    buffer_load_dwordx4 v40, s[12:15], s41 offen lds
    v_mfma_f32_16x16x32_bf16 v[208:211], a[224:227], v[64:67], v[192:195]
    v_exp_f32 v212, v212
    v_mfma_f32_16x16x32_bf16 v[208:211], a[228:231], v[68:71], v[208:211]
    v_exp_f32 v213, v213
    v_mfma_f32_16x16x32_bf16 v[208:211], a[232:235], v[72:75], v[208:211]
    v_exp_f32 v214, v214
    v_mfma_f32_16x16x32_bf16 v[208:211], a[236:239], v[76:79], v[208:211]
    v_exp_f32 v215, v215
    v_mfma_f32_16x16x32_bf16 a[32:35], a[176:179], v[160:163], a[32:35]
    ds_read_b64_tr_b16 a[188:189], v23 offset:57344
    v_cvt_pk_bf16_f32 v152, v212, v213
    v_mfma_f32_16x16x32_bf16 a[32:35], a[180:183], v[164:167], a[32:35]
    ds_read_b64_tr_b16 a[190:191], v23 offset:61440
    v_lshlrev_b32 v244, 16, v242
    v_mfma_f32_16x16x32_bf16 a[36:39], a[180:183], v[172:175], a[36:39]
    ds_read_b128 a[212:215], v9 offset:8192
    v_cvt_pk_bf16_f32 v153, v214, v215
    v_mfma_f32_16x16x32_bf16 a[36:39], a[176:179], v[168:171], a[36:39]
    v_and_b32 v245, 0xffff0000, v242
    v_fmac_f32 v228, v2, v244
    v_smfmac_f32_16x16x64_bf16 a[196:199], v[52:55], v[168:175], v50
    v_mfma_f32_16x16x32_bf16 v[212:215], a[224:227], v[80:83], v[196:199]
    v_exp_f32 v208, v208
    v_mfma_f32_16x16x32_bf16 v[212:215], a[228:231], v[84:87], v[212:215]
    v_exp_f32 v209, v209
    v_mfma_f32_16x16x32_bf16 v[212:215], a[232:235], v[88:91], v[212:215]
    v_exp_f32 v210, v210
    v_mfma_f32_16x16x32_bf16 v[212:215], a[236:239], v[92:95], v[212:215]
    v_exp_f32 v211, v211
    v_mfma_f32_16x16x32_bf16 a[40:43], a[176:179], v[176:179], a[40:43]
    ds_read_b64_tr_b16 a[160:161], v24 offset:49152
    v_cvt_pk_bf16_f32 v130, v208, v209
    v_mfma_f32_16x16x32_bf16 a[40:43], a[180:183], v[180:183], a[40:43]
    ds_read_b64_tr_b16 a[162:163], v24 offset:53248
    v_fmac_f32 v229, v2, v245
    v_mfma_f32_16x16x32_bf16 a[44:47], a[180:183], v[188:191], a[44:47]
    ds_read_b128 a[216:219], v10 offset:8192
    v_cvt_pk_bf16_f32 v131, v210, v211
    v_mfma_f32_16x16x32_bf16 a[44:47], a[176:179], v[184:187], a[44:47]
    s_waitcnt lgkmcnt(3)
    buffer_load_dwordx4 v41, s[12:15], s41 offen offset:1024 lds
    v_mfma_f32_16x16x32_bf16 v[208:211], a[224:227], v[96:99], v[200:203]
    v_exp_f32 v212, v212
    v_mfma_f32_16x16x32_bf16 v[208:211], a[228:231], v[100:103], v[208:211]
    v_exp_f32 v213, v213
    v_mfma_f32_16x16x32_bf16 v[208:211], a[232:235], v[104:107], v[208:211]
    v_exp_f32 v214, v214
    v_mfma_f32_16x16x32_bf16 v[208:211], a[236:239], v[108:111], v[208:211]
    v_exp_f32 v215, v215
    v_mfma_f32_16x16x32_bf16 a[48:51], a[184:187], v[160:163], a[48:51]
    ds_read_b64_tr_b16 a[164:165], v24 offset:57344
    v_cvt_pk_bf16_f32 v138, v212, v213
    v_mfma_f32_16x16x32_bf16 a[48:51], a[188:191], v[164:167], a[48:51]
    ds_read_b64_tr_b16 a[166:167], v24 offset:61440
    v_lshlrev_b32 v246, 16, v243
    v_mfma_f32_16x16x32_bf16 a[52:55], a[188:191], v[172:175], a[52:55]
    ds_read_b128 a[220:223], v11 offset:8192
    v_cvt_pk_bf16_f32 v139, v214, v215
    v_mfma_f32_16x16x32_bf16 a[52:55], a[184:187], v[168:171], a[52:55]
    v_and_b32 v247, 0xffff0000, v243
    v_fmac_f32 v230, v2, v246
    v_smfmac_f32_16x16x64_bf16 a[200:203], v[52:55], v[176:183], v50
    v_mfma_f32_16x16x32_bf16 v[212:215], a[224:227], v[112:115], v[204:207]
    v_exp_f32 v208, v208
    v_mfma_f32_16x16x32_bf16 v[212:215], a[228:231], v[116:119], v[212:215]
    v_exp_f32 v209, v209
    v_mfma_f32_16x16x32_bf16 v[212:215], a[232:235], v[120:123], v[212:215]
    v_exp_f32 v210, v210
    v_mfma_f32_16x16x32_bf16 v[212:215], a[236:239], v[124:127], v[212:215]
    v_exp_f32 v211, v211
    v_mfma_f32_16x16x32_bf16 a[56:59], a[184:187], v[176:179], a[56:59]
    ds_read_b64_tr_b16 a[168:169], v25 offset:49152
    v_cvt_pk_bf16_f32 v146, v208, v209
    v_mfma_f32_16x16x32_bf16 a[56:59], a[188:191], v[180:183], a[56:59]
    ds_read_b64_tr_b16 a[170:171], v25 offset:53248
    v_fmac_f32 v231, v2, v247
    v_mfma_f32_16x16x32_bf16 a[60:63], a[188:191], v[188:191], a[60:63]
    ds_read_b128 a[224:227], v8 offset:12288
    v_cvt_pk_bf16_f32 v147, v210, v211
    v_mfma_f32_16x16x32_bf16 a[60:63], a[184:187], v[184:187], a[60:63]
    s_waitcnt lgkmcnt(3)
    buffer_load_dwordx4 v40, s[12:15], s41 offen offset:2048 lds
    v_mfma_f32_16x16x32_bf16 v[208:211], a[208:211], v[64:67], v[192:195]
    v_exp_f32 v212, v212
    v_mfma_f32_16x16x32_bf16 v[208:211], a[212:215], v[68:71], v[208:211]
    v_exp_f32 v213, v213
    v_mfma_f32_16x16x32_bf16 v[208:211], a[216:219], v[72:75], v[208:211]
    v_exp_f32 v214, v214
    v_mfma_f32_16x16x32_bf16 v[208:211], a[220:223], v[76:79], v[208:211]
    v_exp_f32 v215, v215
    v_mfma_f32_16x16x32_bf16 a[64:67], a[160:163], v[160:163], a[64:67]
    ds_read_b64_tr_b16 a[172:173], v25 offset:57344
    v_cvt_pk_bf16_f32 v154, v212, v213
    v_mfma_f32_16x16x32_bf16 a[64:67], a[164:167], v[164:167], a[64:67]
    ds_read_b64_tr_b16 a[174:175], v25 offset:61440
    v_mov_b32 v2, v3
    v_mfma_f32_16x16x32_bf16 a[68:71], a[164:167], v[172:175], a[68:71]
    ds_read_b128 a[228:231], v9 offset:12288
    v_cvt_pk_bf16_f32 v155, v214, v215
    v_mfma_f32_16x16x32_bf16 a[68:71], a[160:163], v[168:171], a[68:71]
    v_mov_b32 v3, v4
    v_mov_b32 v4, v5
    v_smfmac_f32_16x16x64_bf16 a[204:207], v[52:55], v[184:191], v50
    v_mfma_f32_16x16x32_bf16 v[212:215], a[208:211], v[80:83], v[196:199]
    v_exp_f32 v208, v208
    v_mfma_f32_16x16x32_bf16 v[212:215], a[212:215], v[84:87], v[212:215]
    v_exp_f32 v209, v209
    v_mfma_f32_16x16x32_bf16 v[212:215], a[216:219], v[88:91], v[212:215]
    v_exp_f32 v210, v210
    v_mfma_f32_16x16x32_bf16 v[212:215], a[220:223], v[92:95], v[212:215]
    v_exp_f32 v211, v211
    v_mfma_f32_16x16x32_bf16 a[72:75], a[160:163], v[176:179], a[72:75]
    ds_read_b64_tr_b16 a[176:177], v26 offset:49152
    v_cvt_pk_bf16_f32 v132, v208, v209
    v_mfma_f32_16x16x32_bf16 a[72:75], a[164:167], v[180:183], a[72:75]
    ds_read_b64_tr_b16 a[178:179], v26 offset:53248
    v_mov_b32 v5, v6
    v_mfma_f32_16x16x32_bf16 a[76:79], a[164:167], v[188:191], a[76:79]
    ds_read_b128 a[232:235], v10 offset:12288
    v_cvt_pk_bf16_f32 v133, v210, v211
    v_mfma_f32_16x16x32_bf16 a[76:79], a[160:163], v[184:187], a[76:79]
    s_waitcnt lgkmcnt(3)
    buffer_load_dwordx4 v41, s[12:15], s41 offen offset:3072 lds
    v_mfma_f32_16x16x32_bf16 v[208:211], a[208:211], v[96:99], v[200:203]
    v_exp_f32 v212, v212
    v_mfma_f32_16x16x32_bf16 v[208:211], a[212:215], v[100:103], v[208:211]
    s_add_u32 s41, s41, 16384
    v_exp_f32 v213, v213
    v_mfma_f32_16x16x32_bf16 v[208:211], a[216:219], v[104:107], v[208:211]
    v_exp_f32 v214, v214
    v_mfma_f32_16x16x32_bf16 v[208:211], a[220:223], v[108:111], v[208:211]
    v_exp_f32 v215, v215
    v_mfma_f32_16x16x32_bf16 a[80:83], a[168:171], v[160:163], a[80:83]
    ds_read_b64_tr_b16 a[180:181], v26 offset:57344
    v_cvt_pk_bf16_f32 v140, v212, v213
    v_mfma_f32_16x16x32_bf16 a[80:83], a[172:175], v[164:167], a[80:83]
    ds_read_b64_tr_b16 a[182:183], v26 offset:61440
    v_mfma_f32_16x16x32_bf16 a[84:87], a[172:175], v[172:175], a[84:87]
    ds_read_b128 a[236:239], v11 offset:12288
    v_cvt_pk_bf16_f32 v141, v214, v215
    v_mfma_f32_16x16x32_bf16 a[84:87], a[168:171], v[168:171], a[84:87]
    s_waitcnt vmcnt(10)
    s_barrier
    v_mfma_f32_16x16x32_bf16 v[212:215], a[208:211], v[112:115], v[204:207]
    v_exp_f32 v208, v208
    v_mfma_f32_16x16x32_bf16 v[212:215], a[212:215], v[116:119], v[212:215]
    s_add_u32 m0, s42, 49152
    v_exp_f32 v209, v209
    v_mfma_f32_16x16x32_bf16 v[212:215], a[216:219], v[120:123], v[212:215]
    v_exp_f32 v210, v210
    v_mfma_f32_16x16x32_bf16 v[212:215], a[220:223], v[124:127], v[212:215]
    v_exp_f32 v211, v211
    v_mfma_f32_16x16x32_bf16 a[88:91], a[168:171], v[176:179], a[88:91]
    ds_read_b64_tr_b16 a[184:185], v27 offset:49152
    v_cvt_pk_bf16_f32 v148, v208, v209
    v_mfma_f32_16x16x32_bf16 a[88:91], a[172:175], v[180:183], a[88:91]
    ds_read_b64_tr_b16 a[186:187], v27 offset:53248
    v_mfma_f32_16x16x32_bf16 a[92:95], a[172:175], v[188:191], a[92:95]
    ds_read_b128 a[208:211], v8 offset:16384
    v_cvt_pk_bf16_f32 v149, v210, v211
    v_mfma_f32_16x16x32_bf16 a[92:95], a[168:171], v[184:187], a[92:95]
    s_waitcnt lgkmcnt(3)
    buffer_load_dwordx4 v36, s[8:11], s40 offen lds
    v_mfma_f32_16x16x32_bf16 v[208:211], a[224:227], v[64:67], v[192:195]
    v_exp_f32 v212, v212
    v_mfma_f32_16x16x32_bf16 v[208:211], a[228:231], v[68:71], v[208:211]
    v_exp_f32 v213, v213
    v_mfma_f32_16x16x32_bf16 v[208:211], a[232:235], v[72:75], v[208:211]
    v_exp_f32 v214, v214
    v_mfma_f32_16x16x32_bf16 v[208:211], a[236:239], v[76:79], v[208:211]
    v_exp_f32 v215, v215
    v_mfma_f32_16x16x32_bf16 a[96:99], a[176:179], v[160:163], a[96:99]
    ds_read_b64_tr_b16 a[188:189], v27 offset:57344
    v_cvt_pk_bf16_f32 v156, v212, v213
    v_mfma_f32_16x16x32_bf16 a[96:99], a[180:183], v[164:167], a[96:99]
    ds_read_b64_tr_b16 a[190:191], v27 offset:61440
    v_mfma_f32_16x16x32_bf16 a[100:103], a[180:183], v[172:175], a[100:103]
    ds_read_b128 a[212:215], v9 offset:16384
    v_cvt_pk_bf16_f32 v157, v214, v215
    v_mfma_f32_16x16x32_bf16 a[100:103], a[176:179], v[168:171], a[100:103]
    buffer_load_dword v216, v237, s[28:31], s52 offen
    v_mfma_f32_16x16x32_bf16 v[212:215], a[224:227], v[80:83], v[196:199]
    v_exp_f32 v208, v208
    v_mfma_f32_16x16x32_bf16 v[212:215], a[228:231], v[84:87], v[212:215]
    s_sub_u32 s39, s39, 36864
    v_exp_f32 v209, v209
    v_mfma_f32_16x16x32_bf16 v[212:215], a[232:235], v[88:91], v[212:215]
    s_sub_u32 s38, s38, 4608
    v_exp_f32 v210, v210
    v_mfma_f32_16x16x32_bf16 v[212:215], a[236:239], v[92:95], v[212:215]
    s_add_u32 s52, s52, 2304
    v_exp_f32 v211, v211
    v_mfma_f32_16x16x32_bf16 a[104:107], a[176:179], v[176:179], a[104:107]
    ds_read_b64_tr_b16 a[160:161], v20 offset:0
    v_cvt_pk_bf16_f32 v134, v208, v209
    v_mfma_f32_16x16x32_bf16 a[104:107], a[180:183], v[180:183], a[104:107]
    ds_read_b64_tr_b16 a[162:163], v20 offset:4096
    v_mfma_f32_16x16x32_bf16 a[108:111], a[180:183], v[188:191], a[108:111]
    ds_read_b128 a[216:219], v10 offset:16384
    v_cvt_pk_bf16_f32 v135, v210, v211
    v_mfma_f32_16x16x32_bf16 a[108:111], a[176:179], v[184:187], a[108:111]
    s_waitcnt lgkmcnt(3)
    buffer_load_dwordx4 v37, s[8:11], s40 offen offset:1024 lds
    v_mfma_f32_16x16x32_bf16 v[208:211], a[224:227], v[96:99], v[200:203]
    v_exp_f32 v212, v212
    v_mfma_f32_16x16x32_bf16 v[208:211], a[228:231], v[100:103], v[208:211]
    v_exp_f32 v213, v213
    v_mfma_f32_16x16x32_bf16 v[208:211], a[232:235], v[104:107], v[208:211]
    v_exp_f32 v214, v214
    v_mfma_f32_16x16x32_bf16 v[208:211], a[236:239], v[108:111], v[208:211]
    v_exp_f32 v215, v215
    v_mfma_f32_16x16x32_bf16 a[112:115], a[184:187], v[160:163], a[112:115]
    ds_read_b64_tr_b16 a[164:165], v20 offset:8192
    v_cvt_pk_bf16_f32 v142, v212, v213
    v_mfma_f32_16x16x32_bf16 a[112:115], a[188:191], v[164:167], a[112:115]
    ds_read_b64_tr_b16 a[166:167], v20 offset:12288
    v_mfma_f32_16x16x32_bf16 a[116:119], a[188:191], v[172:175], a[116:119]
    ds_read_b128 a[220:223], v11 offset:16384
    v_cvt_pk_bf16_f32 v143, v214, v215
    v_mfma_f32_16x16x32_bf16 a[116:119], a[184:187], v[168:171], a[116:119]
    v_mfma_f32_16x16x32_bf16 v[212:215], a[224:227], v[112:115], v[204:207]
    v_exp_f32 v208, v208
    v_mfma_f32_16x16x32_bf16 v[212:215], a[228:231], v[116:119], v[212:215]
    v_exp_f32 v209, v209
    v_mfma_f32_16x16x32_bf16 v[212:215], a[232:235], v[120:123], v[212:215]
    v_exp_f32 v210, v210
    v_mfma_f32_16x16x32_bf16 v[212:215], a[236:239], v[124:127], v[212:215]
    v_exp_f32 v211, v211
    v_mfma_f32_16x16x32_bf16 a[120:123], a[184:187], v[176:179], a[120:123]
    ds_read_b64_tr_b16 a[168:169], v21 offset:0
    v_cvt_pk_bf16_f32 v150, v208, v209
    v_mfma_f32_16x16x32_bf16 a[120:123], a[188:191], v[180:183], a[120:123]
    ds_read_b64_tr_b16 a[170:171], v21 offset:4096
    v_mfma_f32_16x16x32_bf16 a[124:127], a[188:191], v[188:191], a[124:127]
    ds_read_b128 a[224:227], v8 offset:20480
    v_cvt_pk_bf16_f32 v151, v210, v211
    v_mfma_f32_16x16x32_bf16 a[124:127], a[184:187], v[184:187], a[124:127]
    s_waitcnt lgkmcnt(3)
    buffer_load_dwordx4 v38, s[8:11], s40 offen offset:2048 lds
    s_sub_u32 s43, s43, 1
    s_cmp_lg_u32 s43, 0
    s_cbranch_scc1 Lattn_loop
    v_mfma_f32_16x16x32_bf16 v[208:211], a[208:211], v[64:67], v[192:195]
    s_lshl_b32 s38, s3, 6
    v_exp_f32 v212, v212
    v_mfma_f32_16x16x32_bf16 v[208:211], a[212:215], v[68:71], v[208:211]
    s_add_u32 s38, s38, 131136
    v_exp_f32 v213, v213
    v_mfma_f32_16x16x32_bf16 v[208:211], a[216:219], v[72:75], v[208:211]
    v_exp_f32 v214, v214
    v_mfma_f32_16x16x32_bf16 v[208:211], a[220:223], v[76:79], v[208:211]
    s_add_u32 s57, s58, 0
    v_exp_f32 v215, v215
    v_mfma_f32_16x16x32_bf16 a[0:3], a[160:163], v[128:131], a[0:3]
    ds_read_b64_tr_b16 a[172:173], v21 offset:8192
    v_cvt_pk_bf16_f32 v158, v212, v213
    v_mfma_f32_16x16x32_bf16 a[0:3], a[164:167], v[132:135], a[0:3]
    ds_read_b64_tr_b16 a[174:175], v21 offset:12288
    v_permlane32_swap_b32 v224, v228
    v_mfma_f32_16x16x32_bf16 a[4:7], a[164:167], v[140:143], a[4:7]
    ds_read_b128 a[228:231], v9 offset:20480
    v_cvt_pk_bf16_f32 v159, v214, v215
    v_mfma_f32_16x16x32_bf16 a[4:7], a[160:163], v[136:139], a[4:7]
    buffer_load_dwordx4 a[128:131], v254, s[80:83], s57 offen
    v_mfma_f32_16x16x32_bf16 v[212:215], a[208:211], v[80:83], v[196:199]
    v_exp_f32 v208, v208
    v_mfma_f32_16x16x32_bf16 v[212:215], a[212:215], v[84:87], v[212:215]
    v_exp_f32 v209, v209
    v_mfma_f32_16x16x32_bf16 v[212:215], a[216:219], v[88:91], v[212:215]
    v_exp_f32 v210, v210
    v_mfma_f32_16x16x32_bf16 v[212:215], a[220:223], v[92:95], v[212:215]
    v_exp_f32 v211, v211
    v_mfma_f32_16x16x32_bf16 a[8:11], a[160:163], v[144:147], a[8:11]
    ds_read_b64_tr_b16 a[176:177], v22 offset:0
    v_cvt_pk_bf16_f32 v160, v208, v209
    v_mfma_f32_16x16x32_bf16 a[8:11], a[164:167], v[148:151], a[8:11]
    ds_read_b64_tr_b16 a[178:179], v22 offset:4096
    v_permlane32_swap_b32 v225, v229
    v_mfma_f32_16x16x32_bf16 a[12:15], a[164:167], v[156:159], a[12:15]
    ds_read_b128 a[232:235], v10 offset:20480
    v_cvt_pk_bf16_f32 v161, v210, v211
    v_mfma_f32_16x16x32_bf16 a[12:15], a[160:163], v[152:155], a[12:15]
    s_waitcnt lgkmcnt(3)
    buffer_load_dwordx4 v39, s[8:11], s40 offen offset:3072 lds
    v_mfma_f32_16x16x32_bf16 v[208:211], a[208:211], v[96:99], v[200:203]
    v_exp_f32 v212, v212
    v_mfma_f32_16x16x32_bf16 v[208:211], a[212:215], v[100:103], v[208:211]
    s_add_u32 s40, s40, 16384
    v_exp_f32 v213, v213
    v_mfma_f32_16x16x32_bf16 v[208:211], a[216:219], v[104:107], v[208:211]
    v_exp_f32 v214, v214
    v_mfma_f32_16x16x32_bf16 v[208:211], a[220:223], v[108:111], v[208:211]
    v_exp_f32 v215, v215
    v_mfma_f32_16x16x32_bf16 a[16:19], a[168:171], v[128:131], a[16:19]
    ds_read_b64_tr_b16 a[180:181], v22 offset:8192
    v_cvt_pk_bf16_f32 v168, v212, v213
    v_mfma_f32_16x16x32_bf16 a[16:19], a[172:175], v[132:135], a[16:19]
    ds_read_b64_tr_b16 a[182:183], v22 offset:12288
    v_permlane32_swap_b32 v226, v230
    v_mfma_f32_16x16x32_bf16 a[20:23], a[172:175], v[140:143], a[20:23]
    ds_read_b128 a[236:239], v11 offset:20480
    v_cvt_pk_bf16_f32 v169, v214, v215
    v_mfma_f32_16x16x32_bf16 a[20:23], a[168:171], v[136:139], a[20:23]
    v_permlane32_swap_b32 v227, v231
    v_add_f32 v224, v224, v228
    v_smfmac_f32_16x16x64_bf16 a[192:195], v[52:55], v[128:135], v50
    v_mfma_f32_16x16x32_bf16 v[212:215], a[208:211], v[112:115], v[204:207]
    v_exp_f32 v208, v208
    v_mfma_f32_16x16x32_bf16 v[212:215], a[212:215], v[116:119], v[212:215]
    s_add_u32 m0, s42, 98304
    v_exp_f32 v209, v209
    v_mfma_f32_16x16x32_bf16 v[212:215], a[216:219], v[120:123], v[212:215]
    v_exp_f32 v210, v210
    v_mfma_f32_16x16x32_bf16 v[212:215], a[220:223], v[124:127], v[212:215]
    v_exp_f32 v211, v211
    v_mfma_f32_16x16x32_bf16 a[24:27], a[168:171], v[144:147], a[24:27]
    ds_read_b64_tr_b16 a[184:185], v23 offset:0
    v_cvt_pk_bf16_f32 v176, v208, v209
    v_mfma_f32_16x16x32_bf16 a[24:27], a[172:175], v[148:151], a[24:27]
    ds_read_b64_tr_b16 a[186:187], v23 offset:4096
    v_add_f32 v225, v225, v229
    v_mfma_f32_16x16x32_bf16 a[28:31], a[172:175], v[156:159], a[28:31]
    ds_read_b128 a[208:211], v8 offset:24576
    v_cvt_pk_bf16_f32 v177, v210, v211
    v_mfma_f32_16x16x32_bf16 a[28:31], a[168:171], v[152:155], a[28:31]
    s_waitcnt lgkmcnt(3)
    buffer_load_dwordx4 v40, s[12:15], s41 offen lds
    v_mfma_f32_16x16x32_bf16 v[208:211], a[224:227], v[64:67], v[192:195]
    v_exp_f32 v212, v212
    v_mfma_f32_16x16x32_bf16 v[208:211], a[228:231], v[68:71], v[208:211]
    v_exp_f32 v213, v213
    v_mfma_f32_16x16x32_bf16 v[208:211], a[232:235], v[72:75], v[208:211]
    v_exp_f32 v214, v214
    v_mfma_f32_16x16x32_bf16 v[208:211], a[236:239], v[76:79], v[208:211]
    s_add_u32 s57, s58, 589824
    v_exp_f32 v215, v215
    v_mfma_f32_16x16x32_bf16 a[32:35], a[176:179], v[128:131], a[32:35]
    ds_read_b64_tr_b16 a[188:189], v23 offset:8192
    v_cvt_pk_bf16_f32 v184, v212, v213
    v_mfma_f32_16x16x32_bf16 a[32:35], a[180:183], v[132:135], a[32:35]
    ds_read_b64_tr_b16 a[190:191], v23 offset:12288
    v_add_f32 v226, v226, v230
    v_mfma_f32_16x16x32_bf16 a[36:39], a[180:183], v[140:143], a[36:39]
    ds_read_b128 a[212:215], v9 offset:24576
    v_cvt_pk_bf16_f32 v185, v214, v215
    v_mfma_f32_16x16x32_bf16 a[36:39], a[176:179], v[136:139], a[36:39]
    buffer_load_dwordx4 a[132:135], v254, s[80:83], s57 offen
    v_smfmac_f32_16x16x64_bf16 a[196:199], v[52:55], v[136:143], v50
    v_mfma_f32_16x16x32_bf16 v[212:215], a[224:227], v[80:83], v[196:199]
    v_exp_f32 v208, v208
    v_mfma_f32_16x16x32_bf16 v[212:215], a[228:231], v[84:87], v[212:215]
    v_exp_f32 v209, v209
    v_mfma_f32_16x16x32_bf16 v[212:215], a[232:235], v[88:91], v[212:215]
    v_exp_f32 v210, v210
    v_mfma_f32_16x16x32_bf16 v[212:215], a[236:239], v[92:95], v[212:215]
    v_exp_f32 v211, v211
    v_mfma_f32_16x16x32_bf16 a[40:43], a[176:179], v[144:147], a[40:43]
    ds_read_b64_tr_b16 a[160:161], v24 offset:0
    v_cvt_pk_bf16_f32 v162, v208, v209
    v_mfma_f32_16x16x32_bf16 a[40:43], a[180:183], v[148:151], a[40:43]
    ds_read_b64_tr_b16 a[162:163], v24 offset:4096
    v_add_f32 v227, v227, v231
    v_mfma_f32_16x16x32_bf16 a[44:47], a[180:183], v[156:159], a[44:47]
    ds_read_b128 a[216:219], v10 offset:24576
    v_cvt_pk_bf16_f32 v163, v210, v211
    v_mfma_f32_16x16x32_bf16 a[44:47], a[176:179], v[152:155], a[44:47]
    s_waitcnt lgkmcnt(3)
    buffer_load_dwordx4 v41, s[12:15], s41 offen offset:1024 lds
    v_mfma_f32_16x16x32_bf16 v[208:211], a[224:227], v[96:99], v[200:203]
    v_exp_f32 v212, v212
    v_mfma_f32_16x16x32_bf16 v[208:211], a[228:231], v[100:103], v[208:211]
    v_exp_f32 v213, v213
    v_mfma_f32_16x16x32_bf16 v[208:211], a[232:235], v[104:107], v[208:211]
    v_exp_f32 v214, v214
    v_mfma_f32_16x16x32_bf16 v[208:211], a[236:239], v[108:111], v[208:211]
    v_exp_f32 v215, v215
    v_mfma_f32_16x16x32_bf16 a[48:51], a[184:187], v[128:131], a[48:51]
    ds_read_b64_tr_b16 a[164:165], v24 offset:8192
    v_cvt_pk_bf16_f32 v170, v212, v213
    v_mfma_f32_16x16x32_bf16 a[48:51], a[188:191], v[132:135], a[48:51]
    ds_read_b64_tr_b16 a[166:167], v24 offset:12288
    v_and_b32 v244, 1, v1
    v_mfma_f32_16x16x32_bf16 a[52:55], a[188:191], v[140:143], a[52:55]
    ds_read_b128 a[220:223], v11 offset:24576
    v_cvt_pk_bf16_f32 v171, v214, v215
    v_mfma_f32_16x16x32_bf16 a[52:55], a[184:187], v[136:139], a[52:55]
    s_waitcnt vmcnt(15)
    buffer_load_dword v221, v236, s[20:23], 0 offen
    v_smfmac_f32_16x16x64_bf16 a[200:203], v[52:55], v[144:151], v50
    v_mfma_f32_16x16x32_bf16 v[212:215], a[224:227], v[112:115], v[204:207]
    v_exp_f32 v208, v208
    v_mfma_f32_16x16x32_bf16 v[212:215], a[228:231], v[116:119], v[212:215]
    v_exp_f32 v209, v209
    v_mfma_f32_16x16x32_bf16 v[212:215], a[232:235], v[120:123], v[212:215]
    v_exp_f32 v210, v210
    v_mfma_f32_16x16x32_bf16 v[212:215], a[236:239], v[124:127], v[212:215]
    v_exp_f32 v211, v211
    v_mfma_f32_16x16x32_bf16 a[56:59], a[184:187], v[144:147], a[56:59]
    ds_read_b64_tr_b16 a[168:169], v25 offset:0
    v_cvt_pk_bf16_f32 v178, v208, v209
    v_mfma_f32_16x16x32_bf16 a[56:59], a[188:191], v[148:151], a[56:59]
    ds_read_b64_tr_b16 a[170:171], v25 offset:4096
    v_permlane16_swap_b32 v224, v226
    v_mfma_f32_16x16x32_bf16 a[60:63], a[188:191], v[156:159], a[60:63]
    ds_read_b128 a[224:227], v8 offset:28672
    v_cvt_pk_bf16_f32 v179, v210, v211
    v_mfma_f32_16x16x32_bf16 a[60:63], a[184:187], v[152:155], a[60:63]
    s_waitcnt lgkmcnt(3)
    buffer_load_dwordx4 v40, s[12:15], s41 offen offset:2048 lds
    v_mfma_f32_16x16x32_bf16 v[208:211], a[208:211], v[64:67], v[192:195]
    v_exp_f32 v212, v212
    v_mfma_f32_16x16x32_bf16 v[208:211], a[212:215], v[68:71], v[208:211]
    v_exp_f32 v213, v213
    v_mfma_f32_16x16x32_bf16 v[208:211], a[216:219], v[72:75], v[208:211]
    v_exp_f32 v214, v214
    v_mfma_f32_16x16x32_bf16 v[208:211], a[220:223], v[76:79], v[208:211]
    s_add_u32 s57, s58, 1179648
    v_exp_f32 v215, v215
    v_mfma_f32_16x16x32_bf16 a[64:67], a[160:163], v[128:131], a[64:67]
    ds_read_b64_tr_b16 a[172:173], v25 offset:8192
    v_cvt_pk_bf16_f32 v186, v212, v213
    v_mfma_f32_16x16x32_bf16 a[64:67], a[164:167], v[132:135], a[64:67]
    ds_read_b64_tr_b16 a[174:175], v25 offset:12288
    v_permlane16_swap_b32 v225, v227
    v_mfma_f32_16x16x32_bf16 a[68:71], a[164:167], v[140:143], a[68:71]
    ds_read_b128 a[228:231], v9 offset:28672
    v_cvt_pk_bf16_f32 v187, v214, v215
    v_mfma_f32_16x16x32_bf16 a[68:71], a[160:163], v[136:139], a[68:71]
    buffer_load_dwordx4 a[136:139], v254, s[80:83], s57 offen
    v_smfmac_f32_16x16x64_bf16 a[204:207], v[52:55], v[152:159], v50
    v_mfma_f32_16x16x32_bf16 v[212:215], a[208:211], v[80:83], v[196:199]
    v_exp_f32 v208, v208
    v_mfma_f32_16x16x32_bf16 v[212:215], a[212:215], v[84:87], v[212:215]
    v_exp_f32 v209, v209
    v_mfma_f32_16x16x32_bf16 v[212:215], a[216:219], v[88:91], v[212:215]
    v_exp_f32 v210, v210
    v_mfma_f32_16x16x32_bf16 v[212:215], a[220:223], v[92:95], v[212:215]
    v_exp_f32 v211, v211
    v_mfma_f32_16x16x32_bf16 a[72:75], a[160:163], v[144:147], a[72:75]
    ds_read_b64_tr_b16 a[176:177], v26 offset:0
    v_cvt_pk_bf16_f32 v164, v208, v209
    v_mfma_f32_16x16x32_bf16 a[72:75], a[164:167], v[148:151], a[72:75]
    ds_read_b64_tr_b16 a[178:179], v26 offset:4096
    v_lshlrev_b32 v244, 5, v244
    v_mfma_f32_16x16x32_bf16 a[76:79], a[164:167], v[156:159], a[76:79]
    ds_read_b128 a[232:235], v10 offset:28672
    v_cvt_pk_bf16_f32 v165, v210, v211
    v_mfma_f32_16x16x32_bf16 a[76:79], a[160:163], v[152:155], a[76:79]
    s_waitcnt lgkmcnt(3)
    buffer_load_dwordx4 v41, s[12:15], s41 offen offset:3072 lds
    v_mfma_f32_16x16x32_bf16 v[208:211], a[208:211], v[96:99], v[200:203]
    v_exp_f32 v212, v212
    v_mfma_f32_16x16x32_bf16 v[208:211], a[212:215], v[100:103], v[208:211]
    s_add_u32 s41, s41, 16384
    v_exp_f32 v213, v213
    v_mfma_f32_16x16x32_bf16 v[208:211], a[216:219], v[104:107], v[208:211]
    v_exp_f32 v214, v214
    v_mfma_f32_16x16x32_bf16 v[208:211], a[220:223], v[108:111], v[208:211]
    v_exp_f32 v215, v215
    v_mfma_f32_16x16x32_bf16 a[80:83], a[168:171], v[128:131], a[80:83]
    ds_read_b64_tr_b16 a[180:181], v26 offset:8192
    v_cvt_pk_bf16_f32 v172, v212, v213
    v_mfma_f32_16x16x32_bf16 a[80:83], a[172:175], v[132:135], a[80:83]
    ds_read_b64_tr_b16 a[182:183], v26 offset:12288
    v_add_f32 v224, v224, v226
    v_mfma_f32_16x16x32_bf16 a[84:87], a[172:175], v[140:143], a[84:87]
    ds_read_b128 a[236:239], v11 offset:28672
    v_cvt_pk_bf16_f32 v173, v214, v215
    v_mfma_f32_16x16x32_bf16 a[84:87], a[168:171], v[136:139], a[84:87]
    s_waitcnt vmcnt(13)
    s_barrier
    v_mfma_f32_16x16x32_bf16 v[212:215], a[208:211], v[112:115], v[204:207]
    v_exp_f32 v208, v208
    v_mfma_f32_16x16x32_bf16 v[212:215], a[212:215], v[116:119], v[212:215]
    s_add_u32 s49, s45, 1024
    v_exp_f32 v209, v209
    v_mfma_f32_16x16x32_bf16 v[212:215], a[216:219], v[120:123], v[212:215]
    s_add_u32 m0, s42, 0
    v_exp_f32 v210, v210
    v_mfma_f32_16x16x32_bf16 v[212:215], a[220:223], v[124:127], v[212:215]
    v_exp_f32 v211, v211
    v_mfma_f32_16x16x32_bf16 a[88:91], a[168:171], v[144:147], a[88:91]
    ds_read_b64_tr_b16 a[184:185], v27 offset:0
    v_cvt_pk_bf16_f32 v180, v208, v209
    v_mfma_f32_16x16x32_bf16 a[88:91], a[172:175], v[148:151], a[88:91]
    ds_read_b64_tr_b16 a[186:187], v27 offset:4096
    v_add_f32 v225, v225, v227
    v_mfma_f32_16x16x32_bf16 a[92:95], a[172:175], v[156:159], a[92:95]
    ds_read_b128 a[208:211], v8 offset:32768
    v_cvt_pk_bf16_f32 v181, v210, v211
    v_mfma_f32_16x16x32_bf16 a[92:95], a[168:171], v[152:155], a[92:95]
    s_waitcnt lgkmcnt(3)
    buffer_load_dwordx4 v46, s[20:23], s49 offen lds
    v_mfma_f32_16x16x32_bf16 v[208:211], a[224:227], v[64:67], v[192:195]
    v_exp_f32 v212, v212
    v_mfma_f32_16x16x32_bf16 v[208:211], a[228:231], v[68:71], v[208:211]
    v_exp_f32 v213, v213
    v_mfma_f32_16x16x32_bf16 v[208:211], a[232:235], v[72:75], v[208:211]
    v_exp_f32 v214, v214
    v_mfma_f32_16x16x32_bf16 v[208:211], a[236:239], v[76:79], v[208:211]
    s_add_u32 s37, s55, 0
    v_exp_f32 v215, v215
    v_mfma_f32_16x16x32_bf16 a[96:99], a[176:179], v[128:131], a[96:99]
    ds_read_b64_tr_b16 a[188:189], v27 offset:8192
    v_cvt_pk_bf16_f32 v188, v212, v213
    v_mfma_f32_16x16x32_bf16 a[96:99], a[180:183], v[132:135], a[96:99]
    ds_read_b64_tr_b16 a[190:191], v27 offset:12288
    v_lshrrev_b32 v245, 4, v1
    v_mfma_f32_16x16x32_bf16 a[100:103], a[180:183], v[140:143], a[100:103]
    ds_read_b128 a[212:215], v9 offset:32768
    v_cvt_pk_bf16_f32 v189, v214, v215
    v_mfma_f32_16x16x32_bf16 a[100:103], a[176:179], v[136:139], a[100:103]
    buffer_load_dword v239, v238, s[28:31], s37 offen
    v_mfma_f32_16x16x32_bf16 v[212:215], a[224:227], v[80:83], v[196:199]
    v_exp_f32 v208, v208
    v_mfma_f32_16x16x32_bf16 v[212:215], a[228:231], v[84:87], v[212:215]
Ltour0_6:
    s_cbranch_execz Ltour0_10
    v_exp_f32 v209, v209
    v_mfma_f32_16x16x32_bf16 v[212:215], a[232:235], v[88:91], v[212:215]
    v_exp_f32 v210, v210
    v_mfma_f32_16x16x32_bf16 v[212:215], a[236:239], v[92:95], v[212:215]
    v_exp_f32 v211, v211
    v_mfma_f32_16x16x32_bf16 a[104:107], a[176:179], v[144:147], a[104:107]
    ds_read_b64_tr_b16 a[160:161], v20 offset:16384
    v_cvt_pk_bf16_f32 v166, v208, v209
    v_mfma_f32_16x16x32_bf16 a[104:107], a[180:183], v[148:151], a[104:107]
    ds_read_b64_tr_b16 a[162:163], v20 offset:20480
    v_lshl_add_u32 v244, v245, 3, v244
    v_mfma_f32_16x16x32_bf16 a[108:111], a[180:183], v[156:159], a[108:111]
    ds_read_b128 a[216:219], v10 offset:32768
    v_cvt_pk_bf16_f32 v167, v210, v211
    v_mfma_f32_16x16x32_bf16 a[108:111], a[176:179], v[152:155], a[108:111]
    s_waitcnt lgkmcnt(3)
    buffer_load_dwordx4 v47, s[20:23], s49 offen offset:1024 lds
    v_mfma_f32_16x16x32_bf16 v[208:211], a[224:227], v[96:99], v[200:203]
    v_exp_f32 v212, v212
    v_mfma_f32_16x16x32_bf16 v[208:211], a[228:231], v[100:103], v[208:211]
    v_exp_f32 v213, v213
    v_mfma_f32_16x16x32_bf16 v[208:211], a[232:235], v[104:107], v[208:211]
    v_exp_f32 v214, v214
    v_mfma_f32_16x16x32_bf16 v[208:211], a[236:239], v[108:111], v[208:211]
    s_add_u32 s57, s58, 1769472
    v_exp_f32 v215, v215
    v_mfma_f32_16x16x32_bf16 a[112:115], a[184:187], v[128:131], a[112:115]
    ds_read_b64_tr_b16 a[164:165], v20 offset:24576
    v_cvt_pk_bf16_f32 v174, v212, v213
    v_mfma_f32_16x16x32_bf16 a[112:115], a[188:191], v[132:135], a[112:115]
    ds_read_b64_tr_b16 a[166:167], v20 offset:28672
    v_mfma_f32_16x16x32_bf16 a[116:119], a[188:191], v[140:143], a[116:119]
    ds_read_b128 a[220:223], v11 offset:32768
    v_cvt_pk_bf16_f32 v175, v214, v215
    v_mfma_f32_16x16x32_bf16 a[116:119], a[184:187], v[136:139], a[116:119]
    buffer_load_dwordx4 a[140:143], v254, s[80:83], s57 offen
    v_mfma_f32_16x16x32_bf16 v[212:215], a[224:227], v[112:115], v[204:207]
    v_exp_f32 v208, v208
    v_mfma_f32_16x16x32_bf16 v[212:215], a[228:231], v[116:119], v[212:215]
    v_exp_f32 v209, v209
    v_mfma_f32_16x16x32_bf16 v[212:215], a[232:235], v[120:123], v[212:215]
    v_exp_f32 v210, v210
    v_mfma_f32_16x16x32_bf16 v[212:215], a[236:239], v[124:127], v[212:215]
    v_exp_f32 v211, v211
    v_mfma_f32_16x16x32_bf16 a[120:123], a[184:187], v[144:147], a[120:123]
    ds_read_b64_tr_b16 a[168:169], v21 offset:16384
    v_cvt_pk_bf16_f32 v182, v208, v209
    v_mfma_f32_16x16x32_bf16 a[120:123], a[188:191], v[148:151], a[120:123]
    ds_read_b64_tr_b16 a[170:171], v21 offset:20480
    v_mfma_f32_16x16x32_bf16 a[124:127], a[188:191], v[156:159], a[124:127]
    ds_read_b128 a[224:227], v8 offset:36864
    v_cvt_pk_bf16_f32 v183, v210, v211
    v_mfma_f32_16x16x32_bf16 a[124:127], a[184:187], v[152:155], a[124:127]
    s_waitcnt lgkmcnt(3)
    buffer_load_dwordx4 v48, s[20:23], s49 offen offset:2048 lds
    v_mfma_f32_16x16x32_bf16 v[208:211], a[208:211], v[64:67], v[192:195]
    v_exp_f32 v212, v212
    v_mfma_f32_16x16x32_bf16 v[208:211], a[212:215], v[68:71], v[208:211]
    v_exp_f32 v213, v213
    v_mfma_f32_16x16x32_bf16 v[208:211], a[216:219], v[72:75], v[208:211]
    v_exp_f32 v214, v214
    v_mfma_f32_16x16x32_bf16 v[208:211], a[220:223], v[76:79], v[208:211]
    s_add_u32 s57, s58, 2359296
    v_exp_f32 v215, v215
    v_mfma_f32_16x16x32_bf16 a[0:3], a[160:163], v[160:163], a[0:3]
    ds_read_b64_tr_b16 a[172:173], v21 offset:24576
    v_cvt_pk_bf16_f32 v190, v212, v213
    v_mfma_f32_16x16x32_bf16 a[0:3], a[164:167], v[164:167], a[0:3]
    ds_read_b64_tr_b16 a[174:175], v21 offset:28672
    v_mov_b32 v63, 0
    v_mfma_f32_16x16x32_bf16 a[4:7], a[164:167], v[172:175], a[4:7]
    ds_read_b128 a[228:231], v9 offset:36864
    v_cvt_pk_bf16_f32 v191, v214, v215
    v_mfma_f32_16x16x32_bf16 a[4:7], a[160:163], v[168:171], a[4:7]
    buffer_load_dwordx4 a[144:147], v254, s[80:83], s57 offen
    v_mfma_f32_16x16x32_bf16 v[212:215], a[208:211], v[80:83], v[196:199]
    v_exp_f32 v208, v208
    v_mfma_f32_16x16x32_bf16 v[212:215], a[212:215], v[84:87], v[212:215]
    v_exp_f32 v209, v209
    v_mfma_f32_16x16x32_bf16 v[212:215], a[216:219], v[88:91], v[212:215]
    v_exp_f32 v210, v210
    v_mfma_f32_16x16x32_bf16 v[212:215], a[220:223], v[92:95], v[212:215]
    v_exp_f32 v211, v211
    v_mfma_f32_16x16x32_bf16 a[8:11], a[160:163], v[176:179], a[8:11]
    ds_read_b64_tr_b16 a[176:177], v22 offset:16384
    v_cvt_pk_bf16_f32 v128, v208, v209
    v_mfma_f32_16x16x32_bf16 a[8:11], a[164:167], v[180:183], a[8:11]
    ds_read_b64_tr_b16 a[178:179], v22 offset:20480
    v_add_f32_dpp v224, v224, v224 row_ror:2 row_mask:0xf bank_mask:0xf
    v_mfma_f32_16x16x32_bf16 a[12:15], a[164:167], v[188:191], a[12:15]
    ds_read_b128 a[232:235], v10 offset:36864
    v_cvt_pk_bf16_f32 v129, v210, v211
    v_mfma_f32_16x16x32_bf16 a[12:15], a[160:163], v[184:187], a[12:15]
    s_waitcnt lgkmcnt(3)
    buffer_load_dwordx4 v49, s[20:23], s49 offen offset:3072 lds
    v_mfma_f32_16x16x32_bf16 v[208:211], a[208:211], v[96:99], v[200:203]
    s_lshr_b32 s39, s2, 5
    v_exp_f32 v212, v212
    v_mfma_f32_16x16x32_bf16 v[208:211], a[212:215], v[100:103], v[208:211]
    s_lshl_b32 s39, s39, 3
    v_exp_f32 v213, v213
    v_mfma_f32_16x16x32_bf16 v[208:211], a[216:219], v[104:107], v[208:211]
    s_and_b32 s43, s2, 7
    v_exp_f32 v214, v214
    v_mfma_f32_16x16x32_bf16 v[208:211], a[220:223], v[108:111], v[208:211]
    s_add_u32 s39, s39, s43
    v_exp_f32 v215, v215
    v_mfma_f32_16x16x32_bf16 a[16:19], a[168:171], v[160:163], a[16:19]
    ds_read_b64_tr_b16 a[180:181], v22 offset:24576
    v_cvt_pk_bf16_f32 v136, v212, v213
    v_mfma_f32_16x16x32_bf16 a[16:19], a[172:175], v[164:167], a[16:19]
    ds_read_b64_tr_b16 a[182:183], v22 offset:28672
    v_add_f32_dpp v225, v225, v225 row_ror:2 row_mask:0xf bank_mask:0xf
    v_mfma_f32_16x16x32_bf16 a[20:23], a[172:175], v[172:175], a[20:23]
    ds_read_b128 a[236:239], v11 offset:36864
    v_cvt_pk_bf16_f32 v137, v214, v215
    v_mfma_f32_16x16x32_bf16 a[20:23], a[168:171], v[168:171], a[20:23]
    buffer_load_dword v253, v63, s[24:27], s54 offen offset:12 sc1
    v_smfmac_f32_16x16x64_bf16 a[192:195], v[52:55], v[160:167], v50
    v_mfma_f32_16x16x32_bf16 v[212:215], a[208:211], v[112:115], v[204:207]
    s_lshl_b32 s39, s39, 2
    v_exp_f32 v208, v208
    v_mfma_f32_16x16x32_bf16 v[212:215], a[212:215], v[116:119], v[212:215]
    s_add_u32 m0, s42, 114688
    v_exp_f32 v209, v209
    v_mfma_f32_16x16x32_bf16 v[212:215], a[216:219], v[120:123], v[212:215]
    s_bfe_u32 s43, s2, 0x20003
    v_exp_f32 v210, v210
    v_mfma_f32_16x16x32_bf16 v[212:215], a[220:223], v[124:127], v[212:215]
    s_add_u32 s39, s39, s43
    v_exp_f32 v211, v211
    v_mfma_f32_16x16x32_bf16 a[24:27], a[168:171], v[176:179], a[24:27]
    ds_read_b64_tr_b16 a[184:185], v23 offset:16384
    v_cvt_pk_bf16_f32 v144, v208, v209
    v_mfma_f32_16x16x32_bf16 a[24:27], a[172:175], v[180:183], a[24:27]
    ds_read_b64_tr_b16 a[186:187], v23 offset:20480
    v_add_f32_dpp v224, v224, v224 row_ror:4 row_mask:0xf bank_mask:0xf
    v_mfma_f32_16x16x32_bf16 a[28:31], a[172:175], v[188:191], a[28:31]
    ds_read_b128 a[208:211], v8 offset:40960
    v_cvt_pk_bf16_f32 v145, v210, v211
    v_mfma_f32_16x16x32_bf16 a[28:31], a[168:171], v[184:187], a[28:31]
    s_waitcnt lgkmcnt(3)
    buffer_load_dwordx4 v40, s[12:15], s41 offen lds
    v_mfma_f32_16x16x32_bf16 v[208:211], a[224:227], v[64:67], v[192:195]
    s_add_u32 s39, s39, 72
    v_exp_f32 v212, v212
    v_mfma_f32_16x16x32_bf16 v[208:211], a[228:231], v[68:71], v[208:211]
    s_cmp_lt_u32 s39, 216
    s_cselect_b32 s43, 0, 2147483648
    v_exp_f32 v213, v213
    v_mfma_f32_16x16x32_bf16 v[208:211], a[232:235], v[72:75], v[208:211]
    s_or_b32 s43, s43, s48
    v_exp_f32 v214, v214
    v_mfma_f32_16x16x32_bf16 v[208:211], a[236:239], v[76:79], v[208:211]
    s_add_u32 s57, s58, 2949120
    v_exp_f32 v215, v215
    v_mfma_f32_16x16x32_bf16 a[32:35], a[176:179], v[160:163], a[32:35]
    ds_read_b64_tr_b16 a[188:189], v23 offset:24576
    v_cvt_pk_bf16_f32 v152, v212, v213
    v_mfma_f32_16x16x32_bf16 a[32:35], a[180:183], v[164:167], a[32:35]
    ds_read_b64_tr_b16 a[190:191], v23 offset:28672
    v_add_f32_dpp v225, v225, v225 row_ror:4 row_mask:0xf bank_mask:0xf
    v_mfma_f32_16x16x32_bf16 a[36:39], a[180:183], v[172:175], a[36:39]
    ds_read_b128 a[212:215], v9 offset:40960
    v_cvt_pk_bf16_f32 v153, v214, v215
    v_mfma_f32_16x16x32_bf16 a[36:39], a[176:179], v[168:171], a[36:39]
    buffer_load_dwordx4 a[148:151], v254, s[80:83], s57 offen
    v_smfmac_f32_16x16x64_bf16 a[196:199], v[52:55], v[168:175], v50
    v_mfma_f32_16x16x32_bf16 v[212:215], a[224:227], v[80:83], v[196:199]
    s_and_b32 s43, s43, 2147483648
    v_exp_f32 v208, v208
    v_mfma_f32_16x16x32_bf16 v[212:215], a[228:231], v[84:87], v[212:215]
    s_sub_u32 s36, s39, 144
    v_exp_f32 v209, v209
    v_mfma_f32_16x16x32_bf16 v[212:215], a[232:235], v[88:91], v[212:215]
    s_cmp_lt_u32 s36, 36
    s_cselect_b32 s36, 1.0, 0
    v_exp_f32 v210, v210
    v_mfma_f32_16x16x32_bf16 v[212:215], a[236:239], v[92:95], v[212:215]
    s_lshr_b32 s44, s39, 1
    v_exp_f32 v211, v211
    v_mfma_f32_16x16x32_bf16 a[40:43], a[176:179], v[176:179], a[40:43]
    ds_read_b64_tr_b16 a[160:161], v24 offset:16384
    v_cvt_pk_bf16_f32 v130, v208, v209
    v_mfma_f32_16x16x32_bf16 a[40:43], a[180:183], v[180:183], a[40:43]
    ds_read_b64_tr_b16 a[162:163], v24 offset:20480
    v_add_f32_dpp v224, v224, v224 row_ror:8 row_mask:0xf bank_mask:0xf
    v_mfma_f32_16x16x32_bf16 a[44:47], a[180:183], v[188:191], a[44:47]
    ds_read_b128 a[216:219], v10 offset:40960
    v_cvt_pk_bf16_f32 v131, v210, v211
    v_mfma_f32_16x16x32_bf16 a[44:47], a[176:179], v[184:187], a[44:47]
    s_waitcnt lgkmcnt(3)
    buffer_load_dwordx4 v41, s[12:15], s41 offen offset:1024 lds
    v_mfma_f32_16x16x32_bf16 v[208:211], a[224:227], v[96:99], v[200:203]
    s_lshl_b32 s44, s44, 6
    v_exp_f32 v212, v212
    v_mfma_f32_16x16x32_bf16 v[208:211], a[228:231], v[100:103], v[208:211]
    s_and_b32 s39, s39, 1
    v_exp_f32 v213, v213
    v_mfma_f32_16x16x32_bf16 v[208:211], a[232:235], v[104:107], v[208:211]
    s_lshl_b32 s39, s39, 3
    v_exp_f32 v214, v214
    v_mfma_f32_16x16x32_bf16 v[208:211], a[236:239], v[108:111], v[208:211]
    s_add_u32 s39, s39, s44
    v_exp_f32 v215, v215
    v_mfma_f32_16x16x32_bf16 a[48:51], a[184:187], v[160:163], a[48:51]
    ds_read_b64_tr_b16 a[164:165], v24 offset:24576
    v_cvt_pk_bf16_f32 v138, v212, v213
    v_mfma_f32_16x16x32_bf16 a[48:51], a[188:191], v[164:167], a[48:51]
    ds_read_b64_tr_b16 a[166:167], v24 offset:28672
    v_add_f32_dpp v225, v225, v225 row_ror:8 row_mask:0xf bank_mask:0xf
    v_mfma_f32_16x16x32_bf16 a[52:55], a[188:191], v[172:175], a[52:55]
    ds_read_b128 a[220:223], v11 offset:40960
    v_cvt_pk_bf16_f32 v139, v214, v215
    v_mfma_f32_16x16x32_bf16 a[52:55], a[184:187], v[168:171], a[52:55]
    v_add_u32 v244, s38, v244
    v_and_b32 v245, 7, v1
    v_smfmac_f32_16x16x64_bf16 a[200:203], v[52:55], v[176:183], v50
    v_mfma_f32_16x16x32_bf16 v[212:215], a[224:227], v[112:115], v[204:207]
    s_add_u32 s39, s39, 16384
    v_exp_f32 v208, v208
    v_mfma_f32_16x16x32_bf16 v[212:215], a[228:231], v[116:119], v[212:215]
    s_or_b32 s39, s39, s43
    v_exp_f32 v209, v209
    v_mfma_f32_16x16x32_bf16 v[212:215], a[232:235], v[120:123], v[212:215]
    v_exp_f32 v210, v210
    v_mfma_f32_16x16x32_bf16 v[212:215], a[236:239], v[124:127], v[212:215]
    v_exp_f32 v211, v211
    v_mfma_f32_16x16x32_bf16 a[56:59], a[184:187], v[176:179], a[56:59]
    ds_read_b64_tr_b16 a[168:169], v25 offset:16384
    v_cvt_pk_bf16_f32 v146, v208, v209
    v_mfma_f32_16x16x32_bf16 a[56:59], a[188:191], v[180:183], a[56:59]
    ds_read_b64_tr_b16 a[170:171], v25 offset:20480
    v_mfma_f32_16x16x32_bf16 a[60:63], a[188:191], v[188:191], a[60:63]
    ds_read_b128 a[224:227], v8 offset:45056
    v_cvt_pk_bf16_f32 v147, v210, v211
    v_mfma_f32_16x16x32_bf16 a[60:63], a[184:187], v[184:187], a[60:63]
    s_waitcnt lgkmcnt(3)
    buffer_load_dwordx4 v40, s[12:15], s41 offen offset:2048 lds
    v_mfma_f32_16x16x32_bf16 v[208:211], a[208:211], v[64:67], v[192:195]
    v_exp_f32 v212, v212
    v_mfma_f32_16x16x32_bf16 v[208:211], a[212:215], v[68:71], v[208:211]
    v_exp_f32 v213, v213
    v_mfma_f32_16x16x32_bf16 v[208:211], a[216:219], v[72:75], v[208:211]
    v_exp_f32 v214, v214
    v_mfma_f32_16x16x32_bf16 v[208:211], a[220:223], v[76:79], v[208:211]
    s_add_u32 s57, s58, 3538944
    v_exp_f32 v215, v215
    v_mfma_f32_16x16x32_bf16 a[64:67], a[160:163], v[160:163], a[64:67]
    ds_read_b64_tr_b16 a[172:173], v25 offset:24576
    v_cvt_pk_bf16_f32 v154, v212, v213
    v_mfma_f32_16x16x32_bf16 a[64:67], a[164:167], v[164:167], a[64:67]
    ds_read_b64_tr_b16 a[174:175], v25 offset:28672
    v_lshlrev_b32 v245, 3, v245
    v_mfma_f32_16x16x32_bf16 a[68:71], a[164:167], v[172:175], a[68:71]
    ds_read_b128 a[228:231], v9 offset:45056
    v_cvt_pk_bf16_f32 v155, v214, v215
    v_mfma_f32_16x16x32_bf16 a[68:71], a[160:163], v[168:171], a[68:71]
    buffer_load_dwordx4 a[152:155], v254, s[80:83], s57 offen
    v_smfmac_f32_16x16x64_bf16 a[204:207], v[52:55], v[184:191], v50
    ds_write_b64 v244, v[224:225]
    v_mfma_f32_16x16x32_bf16 v[212:215], a[208:211], v[80:83], v[196:199]
    v_exp_f32 v208, v208
    v_mfma_f32_16x16x32_bf16 v[212:215], a[212:215], v[84:87], v[212:215]
    v_exp_f32 v209, v209
    v_mfma_f32_16x16x32_bf16 v[212:215], a[216:219], v[88:91], v[212:215]
    v_exp_f32 v210, v210
    v_mfma_f32_16x16x32_bf16 v[212:215], a[220:223], v[92:95], v[212:215]
    v_exp_f32 v211, v211
    v_mfma_f32_16x16x32_bf16 a[72:75], a[160:163], v[176:179], a[72:75]
    ds_read_b64_tr_b16 a[176:177], v26 offset:16384
    v_cvt_pk_bf16_f32 v132, v208, v209
    v_mfma_f32_16x16x32_bf16 a[72:75], a[164:167], v[180:183], a[72:75]
    ds_read_b64_tr_b16 a[178:179], v26 offset:20480
    v_add_u32 v245, 131136, v245
    v_mfma_f32_16x16x32_bf16 a[76:79], a[164:167], v[188:191], a[76:79]
    ds_read_b128 a[232:235], v10 offset:45056
    v_cvt_pk_bf16_f32 v133, v210, v211
    v_mfma_f32_16x16x32_bf16 a[76:79], a[160:163], v[184:187], a[76:79]
    s_waitcnt lgkmcnt(3)
    buffer_load_dwordx4 v41, s[12:15], s41 offen offset:3072 lds
    v_mfma_f32_16x16x32_bf16 v[208:211], a[208:211], v[96:99], v[200:203]
    v_exp_f32 v212, v212
    v_mfma_f32_16x16x32_bf16 v[208:211], a[212:215], v[100:103], v[208:211]
    s_add_u32 s41, s41, 16384
    v_exp_f32 v213, v213
    v_mfma_f32_16x16x32_bf16 v[208:211], a[216:219], v[104:107], v[208:211]
    v_exp_f32 v214, v214
    v_mfma_f32_16x16x32_bf16 v[208:211], a[220:223], v[108:111], v[208:211]
    v_exp_f32 v215, v215
    v_mfma_f32_16x16x32_bf16 a[80:83], a[168:171], v[160:163], a[80:83]
    ds_read_b64_tr_b16 a[180:181], v26 offset:24576
    v_cvt_pk_bf16_f32 v140, v212, v213
    v_mfma_f32_16x16x32_bf16 a[80:83], a[172:175], v[164:167], a[80:83]
    ds_read_b64_tr_b16 a[182:183], v26 offset:28672
    v_mfma_f32_16x16x32_bf16 a[84:87], a[172:175], v[172:175], a[84:87]
    ds_read_b128 a[236:239], v11 offset:45056
    v_cvt_pk_bf16_f32 v141, v214, v215
    v_mfma_f32_16x16x32_bf16 a[84:87], a[168:171], v[168:171], a[84:87]
    s_waitcnt vmcnt(14)
    s_barrier
    v_mfma_f32_16x16x32_bf16 v[212:215], a[208:211], v[112:115], v[204:207]
    v_exp_f32 v208, v208
    v_mfma_f32_16x16x32_bf16 v[212:215], a[212:215], v[116:119], v[212:215]
    s_add_u32 s49, s45, 74752
    v_exp_f32 v209, v209
    v_mfma_f32_16x16x32_bf16 v[212:215], a[216:219], v[120:123], v[212:215]
    s_add_u32 m0, s42, 16384
    v_exp_f32 v210, v210
    v_mfma_f32_16x16x32_bf16 v[212:215], a[220:223], v[124:127], v[212:215]
    v_exp_f32 v211, v211
    v_mfma_f32_16x16x32_bf16 a[88:91], a[168:171], v[176:179], a[88:91]
    ds_read_b64_tr_b16 a[184:185], v27 offset:16384
    v_cvt_pk_bf16_f32 v148, v208, v209
    v_mfma_f32_16x16x32_bf16 a[88:91], a[172:175], v[180:183], a[88:91]
    ds_read_b64_tr_b16 a[186:187], v27 offset:20480
    ds_read_b64 v[224:225], v245 offset:0
    v_mfma_f32_16x16x32_bf16 a[92:95], a[172:175], v[188:191], a[92:95]
    ds_read_b128 a[208:211], v8 offset:49152
    v_cvt_pk_bf16_f32 v149, v210, v211
    v_mfma_f32_16x16x32_bf16 a[92:95], a[168:171], v[184:187], a[92:95]
    s_waitcnt lgkmcnt(3)
    buffer_load_dwordx4 v46, s[20:23], s49 offen lds
    v_mfma_f32_16x16x32_bf16 v[208:211], a[224:227], v[64:67], v[192:195]
    v_exp_f32 v212, v212
    v_mfma_f32_16x16x32_bf16 v[208:211], a[228:231], v[68:71], v[208:211]
    v_exp_f32 v213, v213
    v_mfma_f32_16x16x32_bf16 v[208:211], a[232:235], v[72:75], v[208:211]
    v_exp_f32 v214, v214
    v_mfma_f32_16x16x32_bf16 v[208:211], a[236:239], v[76:79], v[208:211]
    s_add_u32 s37, s55, 8192
    v_exp_f32 v215, v215
    v_mfma_f32_16x16x32_bf16 a[96:99], a[176:179], v[160:163], a[96:99]
    ds_read_b64_tr_b16 a[188:189], v27 offset:24576
    v_cvt_pk_bf16_f32 v156, v212, v213
    v_mfma_f32_16x16x32_bf16 a[96:99], a[180:183], v[164:167], a[96:99]
    ds_read_b64_tr_b16 a[190:191], v27 offset:28672
    ds_read_b64 v[226:227], v245 offset:64
    v_mfma_f32_16x16x32_bf16 a[100:103], a[180:183], v[172:175], a[100:103]
    ds_read_b128 a[212:215], v9 offset:49152
    v_cvt_pk_bf16_f32 v157, v214, v215
    v_mfma_f32_16x16x32_bf16 a[100:103], a[176:179], v[168:171], a[100:103]
    buffer_load_dword v234, v238, s[28:31], s37 offen
    v_mfma_f32_16x16x32_bf16 v[212:215], a[224:227], v[80:83], v[196:199]
    v_exp_f32 v208, v208
    v_mfma_f32_16x16x32_bf16 v[212:215], a[228:231], v[84:87], v[212:215]
    v_exp_f32 v209, v209
    v_mfma_f32_16x16x32_bf16 v[212:215], a[232:235], v[88:91], v[212:215]
    v_exp_f32 v210, v210
    v_mfma_f32_16x16x32_bf16 v[212:215], a[236:239], v[92:95], v[212:215]
    v_exp_f32 v211, v211
    v_mfma_f32_16x16x32_bf16 a[104:107], a[176:179], v[176:179], a[104:107]
    ds_read_b64_tr_b16 a[160:161], v20 offset:32768
    v_cvt_pk_bf16_f32 v134, v208, v209
    v_mfma_f32_16x16x32_bf16 a[104:107], a[180:183], v[180:183], a[104:107]
    ds_read_b64_tr_b16 a[162:163], v20 offset:36864
    ds_read_b64 v[228:229], v245 offset:128
    v_mfma_f32_16x16x32_bf16 a[108:111], a[180:183], v[188:191], a[108:111]
    ds_read_b128 a[216:219], v10 offset:49152
    v_cvt_pk_bf16_f32 v135, v210, v211
    v_mfma_f32_16x16x32_bf16 a[108:111], a[176:179], v[184:187], a[108:111]
    s_waitcnt lgkmcnt(3)
    buffer_load_dwordx4 v47, s[20:23], s49 offen offset:1024 lds
    v_mfma_f32_16x16x32_bf16 v[208:211], a[224:227], v[96:99], v[200:203]
    v_exp_f32 v212, v212
    v_mfma_f32_16x16x32_bf16 v[208:211], a[228:231], v[100:103], v[208:211]
    v_exp_f32 v213, v213
    v_mfma_f32_16x16x32_bf16 v[208:211], a[232:235], v[104:107], v[208:211]
    v_exp_f32 v214, v214
    v_mfma_f32_16x16x32_bf16 v[208:211], a[236:239], v[108:111], v[208:211]
    s_add_u32 s57, s58, 4128768
    v_exp_f32 v215, v215
    v_mfma_f32_16x16x32_bf16 a[112:115], a[184:187], v[160:163], a[112:115]
    ds_read_b64_tr_b16 a[164:165], v20 offset:40960
    v_cvt_pk_bf16_f32 v142, v212, v213
    v_mfma_f32_16x16x32_bf16 a[112:115], a[188:191], v[164:167], a[112:115]
    ds_read_b64_tr_b16 a[166:167], v20 offset:45056
    ds_read_b64 v[230:231], v245 offset:192
    v_mfma_f32_16x16x32_bf16 a[116:119], a[188:191], v[172:175], a[116:119]
    ds_read_b128 a[220:223], v11 offset:49152
    v_cvt_pk_bf16_f32 v143, v214, v215
    v_mfma_f32_16x16x32_bf16 a[116:119], a[184:187], v[168:171], a[116:119]
    buffer_load_dwordx4 a[156:159], v254, s[80:83], s57 offen
    v_mfma_f32_16x16x32_bf16 v[212:215], a[224:227], v[112:115], v[204:207]
    v_exp_f32 v208, v208
    v_mfma_f32_16x16x32_bf16 v[212:215], a[228:231], v[116:119], v[212:215]
    v_exp_f32 v209, v209
    v_mfma_f32_16x16x32_bf16 v[212:215], a[232:235], v[120:123], v[212:215]
    v_exp_f32 v210, v210
    v_mfma_f32_16x16x32_bf16 v[212:215], a[236:239], v[124:127], v[212:215]
    v_exp_f32 v211, v211
    v_mfma_f32_16x16x32_bf16 a[120:123], a[184:187], v[176:179], a[120:123]
    ds_read_b64_tr_b16 a[168:169], v21 offset:32768
    v_cvt_pk_bf16_f32 v150, v208, v209
    v_mfma_f32_16x16x32_bf16 a[120:123], a[188:191], v[180:183], a[120:123]
    ds_read_b64_tr_b16 a[170:171], v21 offset:36864
    v_mfma_f32_16x16x32_bf16 a[124:127], a[188:191], v[188:191], a[124:127]
    ds_read_b128 a[224:227], v8 offset:53248
    v_cvt_pk_bf16_f32 v151, v210, v211
    v_mfma_f32_16x16x32_bf16 a[124:127], a[184:187], v[184:187], a[124:127]
    s_waitcnt lgkmcnt(3)
    buffer_load_dwordx4 v48, s[20:23], s49 offen offset:2048 lds
    v_mfma_f32_16x16x32_bf16 v[208:211], a[208:211], v[64:67], v[192:195]
    v_exp_f32 v212, v212
    v_mfma_f32_16x16x32_bf16 v[208:211], a[212:215], v[68:71], v[208:211]
    v_exp_f32 v213, v213
    v_mfma_f32_16x16x32_bf16 v[208:211], a[216:219], v[72:75], v[208:211]
    v_exp_f32 v214, v214
    v_mfma_f32_16x16x32_bf16 v[208:211], a[220:223], v[76:79], v[208:211]
    s_add_u32 s57, s58, 4718592
    v_exp_f32 v215, v215
    v_mfma_f32_16x16x32_bf16 a[0:3], a[160:163], v[128:131], a[0:3]
    ds_read_b64_tr_b16 a[172:173], v21 offset:40960
    v_cvt_pk_bf16_f32 v158, v212, v213
    v_mfma_f32_16x16x32_bf16 a[0:3], a[164:167], v[132:135], a[0:3]
    ds_read_b64_tr_b16 a[174:175], v21 offset:45056
    v_add_f32 v224, v224, v228
    v_mfma_f32_16x16x32_bf16 a[4:7], a[164:167], v[140:143], a[4:7]
    ds_read_b128 a[228:231], v9 offset:53248
    v_cvt_pk_bf16_f32 v159, v214, v215
    v_mfma_f32_16x16x32_bf16 a[4:7], a[160:163], v[136:139], a[4:7]
    buffer_load_dwordx4 a[240:243], v254, s[80:83], s57 offen
    v_mfma_f32_16x16x32_bf16 v[212:215], a[208:211], v[80:83], v[196:199]
    v_exp_f32 v208, v208
    v_mfma_f32_16x16x32_bf16 v[212:215], a[212:215], v[84:87], v[212:215]
    v_exp_f32 v209, v209
    v_mfma_f32_16x16x32_bf16 v[212:215], a[216:219], v[88:91], v[212:215]
    v_exp_f32 v210, v210
    v_mfma_f32_16x16x32_bf16 v[212:215], a[220:223], v[92:95], v[212:215]
    v_exp_f32 v211, v211
    v_mfma_f32_16x16x32_bf16 a[8:11], a[160:163], v[144:147], a[8:11]
    ds_read_b64_tr_b16 a[176:177], v22 offset:32768
    v_cvt_pk_bf16_f32 v160, v208, v209
    v_mfma_f32_16x16x32_bf16 a[8:11], a[164:167], v[148:151], a[8:11]
    ds_read_b64_tr_b16 a[178:179], v22 offset:36864
    v_add_f32 v225, v225, v229
    v_mfma_f32_16x16x32_bf16 a[12:15], a[164:167], v[156:159], a[12:15]
    ds_read_b128 a[232:235], v10 offset:53248
    v_cvt_pk_bf16_f32 v161, v210, v211
    v_mfma_f32_16x16x32_bf16 a[12:15], a[160:163], v[152:155], a[12:15]
    s_waitcnt lgkmcnt(3)
    buffer_load_dwordx4 v49, s[20:23], s49 offen offset:3072 lds
    v_mfma_f32_16x16x32_bf16 v[208:211], a[208:211], v[96:99], v[200:203]
    v_exp_f32 v212, v212
    v_mfma_f32_16x16x32_bf16 v[208:211], a[212:215], v[100:103], v[208:211]
    v_exp_f32 v213, v213
    v_mfma_f32_16x16x32_bf16 v[208:211], a[216:219], v[104:107], v[208:211]
    v_exp_f32 v214, v214
    v_mfma_f32_16x16x32_bf16 v[208:211], a[220:223], v[108:111], v[208:211]
    v_exp_f32 v215, v215
    v_mfma_f32_16x16x32_bf16 a[16:19], a[168:171], v[128:131], a[16:19]
    ds_read_b64_tr_b16 a[180:181], v22 offset:40960
    v_cvt_pk_bf16_f32 v168, v212, v213
    v_mfma_f32_16x16x32_bf16 a[16:19], a[172:175], v[132:135], a[16:19]
    ds_read_b64_tr_b16 a[182:183], v22 offset:45056
    v_add_f32 v226, v226, v230
    v_mfma_f32_16x16x32_bf16 a[20:23], a[172:175], v[140:143], a[20:23]
    ds_read_b128 a[236:239], v11 offset:53248
    v_cvt_pk_bf16_f32 v169, v214, v215
    v_mfma_f32_16x16x32_bf16 a[20:23], a[168:171], v[136:139], a[20:23]
    v_add_f32 v227, v227, v231
    v_add_f32 v224, v224, v226
    v_smfmac_f32_16x16x64_bf16 a[192:195], v[52:55], v[128:135], v50
    v_mfma_f32_16x16x32_bf16 v[212:215], a[208:211], v[112:115], v[204:207]
    v_exp_f32 v208, v208
    v_mfma_f32_16x16x32_bf16 v[212:215], a[212:215], v[116:119], v[212:215]
    s_add_u32 s49, s7, 0
    v_exp_f32 v209, v209
    v_mfma_f32_16x16x32_bf16 v[212:215], a[216:219], v[120:123], v[212:215]
    s_add_u32 m0, s42, 65536
    v_exp_f32 v210, v210
    v_mfma_f32_16x16x32_bf16 v[212:215], a[220:223], v[124:127], v[212:215]
    v_exp_f32 v211, v211
    v_mfma_f32_16x16x32_bf16 a[24:27], a[168:171], v[144:147], a[24:27]
    ds_read_b64_tr_b16 a[184:185], v23 offset:32768
    v_cvt_pk_bf16_f32 v176, v208, v209
    v_mfma_f32_16x16x32_bf16 a[24:27], a[172:175], v[148:151], a[24:27]
    ds_read_b64_tr_b16 a[186:187], v23 offset:36864
    v_add_f32 v225, v225, v227
    v_mfma_f32_16x16x32_bf16 a[28:31], a[172:175], v[156:159], a[28:31]
    ds_read_b128 a[208:211], v8 offset:57344
    v_cvt_pk_bf16_f32 v177, v210, v211
    v_mfma_f32_16x16x32_bf16 a[28:31], a[168:171], v[152:155], a[28:31]
    s_waitcnt lgkmcnt(3)
    buffer_load_dwordx4 v46, s[20:23], s49 offen lds
    v_mfma_f32_16x16x32_bf16 v[208:211], a[224:227], v[64:67], v[192:195]
    v_exp_f32 v212, v212
    v_mfma_f32_16x16x32_bf16 v[208:211], a[228:231], v[68:71], v[208:211]
    v_exp_f32 v213, v213
    v_mfma_f32_16x16x32_bf16 v[208:211], a[232:235], v[72:75], v[208:211]
    v_exp_f32 v214, v214
    v_mfma_f32_16x16x32_bf16 v[208:211], a[236:239], v[76:79], v[208:211]
    s_add_u32 s57, s58, 4128768
    v_exp_f32 v215, v215
    v_mfma_f32_16x16x32_bf16 a[32:35], a[176:179], v[128:131], a[32:35]
    ds_read_b64_tr_b16 a[188:189], v23 offset:40960
    v_cvt_pk_bf16_f32 v184, v212, v213
    v_mfma_f32_16x16x32_bf16 a[32:35], a[180:183], v[132:135], a[32:35]
    ds_read_b64_tr_b16 a[190:191], v23 offset:45056
    v_cvt_pk_bf16_f32 v246, v224, v225
    v_mfma_f32_16x16x32_bf16 a[36:39], a[180:183], v[140:143], a[36:39]
    ds_read_b128 a[212:215], v9 offset:57344
    v_cvt_pk_bf16_f32 v185, v214, v215
    v_mfma_f32_16x16x32_bf16 a[36:39], a[176:179], v[136:139], a[36:39]
    buffer_load_dwordx4 a[244:247], v254, s[32:35], s57 offen
    v_smfmac_f32_16x16x64_bf16 a[196:199], v[52:55], v[136:143], v50
    v_lshrrev_b32 v222, 5, v0
    v_mfma_f32_16x16x32_bf16 v[212:215], a[224:227], v[80:83], v[196:199]
    s_getpc_b64 s[16:17]
Lattn_pc2:
    v_exp_f32 v208, v208
    v_mfma_f32_16x16x32_bf16 v[212:215], a[228:231], v[84:87], v[212:215]
    s_mov_b32 s18, Lattn_redo-Lattn_pc2
    v_exp_f32 v209, v209
    v_mfma_f32_16x16x32_bf16 v[212:215], a[232:235], v[88:91], v[212:215]
    s_lshr_b32 s37, s2, 3
    v_exp_f32 v210, v210
    v_mfma_f32_16x16x32_bf16 v[212:215], a[236:239], v[92:95], v[212:215]
    v_exp_f32 v211, v211
    v_mfma_f32_16x16x32_bf16 a[40:43], a[176:179], v[144:147], a[40:43]
    ds_read_b64_tr_b16 a[160:161], v24 offset:32768
    v_cvt_pk_bf16_f32 v162, v208, v209
    v_mfma_f32_16x16x32_bf16 a[40:43], a[180:183], v[148:151], a[40:43]
    ds_read_b64_tr_b16 a[162:163], v24 offset:36864
    v_lshlrev_b32 v222, 12, v222
    v_mfma_f32_16x16x32_bf16 a[44:47], a[180:183], v[156:159], a[44:47]
    ds_read_b128 a[216:219], v10 offset:57344
    v_cvt_pk_bf16_f32 v163, v210, v211
    v_mfma_f32_16x16x32_bf16 a[44:47], a[176:179], v[152:155], a[44:47]
    s_waitcnt lgkmcnt(3)
    buffer_load_dwordx4 v47, s[20:23], s49 offen offset:1024 lds
    v_mfma_f32_16x16x32_bf16 v[208:211], a[224:227], v[96:99], v[200:203]
    s_lshl_b32 s37, s37, 7
    v_exp_f32 v212, v212
    v_mfma_f32_16x16x32_bf16 v[208:211], a[228:231], v[100:103], v[208:211]
    v_exp_f32 v213, v213
    v_mfma_f32_16x16x32_bf16 v[208:211], a[232:235], v[104:107], v[208:211]
    v_exp_f32 v214, v214
    v_mfma_f32_16x16x32_bf16 v[208:211], a[236:239], v[108:111], v[208:211]
    v_exp_f32 v215, v215
    v_mfma_f32_16x16x32_bf16 a[48:51], a[184:187], v[128:131], a[48:51]
    ds_read_b64_tr_b16 a[164:165], v24 offset:40960
    v_cvt_pk_bf16_f32 v170, v212, v213
    v_mfma_f32_16x16x32_bf16 a[48:51], a[188:191], v[132:135], a[48:51]
    ds_read_b64_tr_b16 a[166:167], v24 offset:45056
    v_lshlrev_b32 v224, 16, v246
    v_mfma_f32_16x16x32_bf16 a[52:55], a[188:191], v[140:143], a[52:55]
    ds_read_b128 a[220:223], v11 offset:57344
    v_cvt_pk_bf16_f32 v171, v214, v215
    v_mfma_f32_16x16x32_bf16 a[52:55], a[184:187], v[136:139], a[52:55]
    buffer_load_dword v222, v222, s[16:19], s37 offen
    v_smfmac_f32_16x16x64_bf16 a[200:203], v[52:55], v[144:151], v50
    v_mfma_f32_16x16x32_bf16 v[212:215], a[224:227], v[112:115], v[204:207]
    v_exp_f32 v208, v208
    v_mfma_f32_16x16x32_bf16 v[212:215], a[228:231], v[116:119], v[212:215]
    v_exp_f32 v209, v209
    v_mfma_f32_16x16x32_bf16 v[212:215], a[232:235], v[120:123], v[212:215]
    v_exp_f32 v210, v210
    v_mfma_f32_16x16x32_bf16 v[212:215], a[236:239], v[124:127], v[212:215]
    v_exp_f32 v211, v211
    v_mfma_f32_16x16x32_bf16 a[56:59], a[184:187], v[144:147], a[56:59]
    ds_read_b64_tr_b16 a[168:169], v25 offset:32768
    v_cvt_pk_bf16_f32 v178, v208, v209
    v_mfma_f32_16x16x32_bf16 a[56:59], a[188:191], v[148:151], a[56:59]
    ds_read_b64_tr_b16 a[170:171], v25 offset:36864
    v_and_b32 v225, 0xffff0000, v246
    v_mfma_f32_16x16x32_bf16 a[60:63], a[188:191], v[156:159], a[60:63]
    ds_read_b128 a[224:227], v8 offset:61440
    v_cvt_pk_bf16_f32 v179, v210, v211
    v_mfma_f32_16x16x32_bf16 a[60:63], a[184:187], v[152:155], a[60:63]
    s_waitcnt lgkmcnt(3)
    buffer_load_dwordx4 v48, s[20:23], s49 offen offset:2048 lds
    v_mfma_f32_16x16x32_bf16 v[208:211], a[208:211], v[64:67], v[192:195]
    v_exp_f32 v212, v212
    v_mfma_f32_16x16x32_bf16 v[208:211], a[212:215], v[68:71], v[208:211]
    v_exp_f32 v213, v213
    v_mfma_f32_16x16x32_bf16 v[208:211], a[216:219], v[72:75], v[208:211]
    v_exp_f32 v214, v214
    v_mfma_f32_16x16x32_bf16 v[208:211], a[220:223], v[76:79], v[208:211]
    s_add_u32 s57, s58, 4718592
    v_exp_f32 v215, v215
    v_mfma_f32_16x16x32_bf16 a[64:67], a[160:163], v[128:131], a[64:67]
    ds_read_b64_tr_b16 a[172:173], v25 offset:40960
    v_cvt_pk_bf16_f32 v186, v212, v213
    v_mfma_f32_16x16x32_bf16 a[64:67], a[164:167], v[132:135], a[64:67]
    ds_read_b64_tr_b16 a[174:175], v25 offset:45056
    v_add_f32 v224, s36, v224
    v_mfma_f32_16x16x32_bf16 a[68:71], a[164:167], v[140:143], a[68:71]
    ds_read_b128 a[228:231], v9 offset:61440
    v_cvt_pk_bf16_f32 v187, v214, v215
    v_mfma_f32_16x16x32_bf16 a[68:71], a[160:163], v[136:139], a[68:71]
    buffer_load_dwordx4 a[248:251], v254, s[32:35], s57 offen
    v_smfmac_f32_16x16x64_bf16 a[204:207], v[52:55], v[152:159], v50
    v_mfma_f32_16x16x32_bf16 v[212:215], a[208:211], v[80:83], v[196:199]
Ltour0_7:
    s_cbranch_execz Ltour0_11
    v_exp_f32 v208, v208
    v_mfma_f32_16x16x32_bf16 v[212:215], a[212:215], v[84:87], v[212:215]
    v_exp_f32 v209, v209
    v_mfma_f32_16x16x32_bf16 v[212:215], a[216:219], v[88:91], v[212:215]
    v_exp_f32 v210, v210
    v_mfma_f32_16x16x32_bf16 v[212:215], a[220:223], v[92:95], v[212:215]
    v_exp_f32 v211, v211
    v_mfma_f32_16x16x32_bf16 a[72:75], a[160:163], v[144:147], a[72:75]
    ds_read_b64_tr_b16 a[176:177], v26 offset:32768
    v_cvt_pk_bf16_f32 v164, v208, v209
    v_mfma_f32_16x16x32_bf16 a[72:75], a[164:167], v[148:151], a[72:75]
    ds_read_b64_tr_b16 a[178:179], v26 offset:36864
    v_add_f32 v225, s36, v225
    v_mfma_f32_16x16x32_bf16 a[76:79], a[164:167], v[156:159], a[76:79]
    ds_read_b128 a[232:235], v10 offset:61440
    v_cvt_pk_bf16_f32 v165, v210, v211
    v_mfma_f32_16x16x32_bf16 a[76:79], a[160:163], v[152:155], a[76:79]
    s_waitcnt lgkmcnt(3)
    buffer_load_dwordx4 v49, s[20:23], s49 offen offset:3072 lds
    v_mfma_f32_16x16x32_bf16 v[208:211], a[208:211], v[96:99], v[200:203]
    v_exp_f32 v212, v212
    v_mfma_f32_16x16x32_bf16 v[208:211], a[212:215], v[100:103], v[208:211]
    v_exp_f32 v213, v213
    v_mfma_f32_16x16x32_bf16 v[208:211], a[216:219], v[104:107], v[208:211]
    v_exp_f32 v214, v214
    v_mfma_f32_16x16x32_bf16 v[208:211], a[220:223], v[108:111], v[208:211]
    v_exp_f32 v215, v215
    v_mfma_f32_16x16x32_bf16 a[80:83], a[168:171], v[128:131], a[80:83]
    ds_read_b64_tr_b16 a[180:181], v26 offset:40960
    v_cvt_pk_bf16_f32 v172, v212, v213
    v_mfma_f32_16x16x32_bf16 a[80:83], a[172:175], v[132:135], a[80:83]
    ds_read_b64_tr_b16 a[182:183], v26 offset:45056
    v_cvt_pk_bf16_f32 v246, v224, v225
    v_mfma_f32_16x16x32_bf16 a[84:87], a[172:175], v[140:143], a[84:87]
    ds_read_b128 a[236:239], v11 offset:61440
    v_cvt_pk_bf16_f32 v173, v214, v215
    v_mfma_f32_16x16x32_bf16 a[84:87], a[168:171], v[136:139], a[84:87]
    s_waitcnt vmcnt(14)
    s_barrier
    v_mfma_f32_16x16x32_bf16 v[212:215], a[208:211], v[112:115], v[204:207]
    v_exp_f32 v208, v208
    v_mfma_f32_16x16x32_bf16 v[212:215], a[212:215], v[116:119], v[212:215]
    s_add_u32 s49, s7, 73728
    v_exp_f32 v209, v209
    v_mfma_f32_16x16x32_bf16 v[212:215], a[216:219], v[120:123], v[212:215]
    s_add_u32 m0, s42, 81920
    v_exp_f32 v210, v210
    v_mfma_f32_16x16x32_bf16 v[212:215], a[220:223], v[124:127], v[212:215]
    v_exp_f32 v211, v211
    v_mfma_f32_16x16x32_bf16 a[88:91], a[168:171], v[144:147], a[88:91]
    ds_read_b64_tr_b16 a[184:185], v27 offset:32768
    v_cvt_pk_bf16_f32 v180, v208, v209
    v_mfma_f32_16x16x32_bf16 a[88:91], a[172:175], v[148:151], a[88:91]
    ds_read_b64_tr_b16 a[186:187], v27 offset:36864
    v_lshrrev_b32 v244, 1, v0
    v_mfma_f32_16x16x32_bf16 a[92:95], a[172:175], v[156:159], a[92:95]
    v_cvt_pk_bf16_f32 v181, v210, v211
    v_mfma_f32_16x16x32_bf16 a[92:95], a[168:171], v[152:155], a[92:95]
    s_waitcnt lgkmcnt(3)
    buffer_load_dwordx4 v46, s[20:23], s49 offen lds
    v_mfma_f32_16x16x32_bf16 v[208:211], a[224:227], v[64:67], v[192:195]
    v_exp_f32 v212, v212
    v_mfma_f32_16x16x32_bf16 v[208:211], a[228:231], v[68:71], v[208:211]
    v_exp_f32 v213, v213
    v_mfma_f32_16x16x32_bf16 v[208:211], a[232:235], v[72:75], v[208:211]
    s_waitcnt lgkmcnt(2)
    v_exp_f32 v214, v214
    v_mfma_f32_16x16x32_bf16 v[208:211], a[236:239], v[76:79], v[208:211]
    v_exp_f32 v215, v215
    v_mfma_f32_16x16x32_bf16 a[96:99], a[176:179], v[128:131], a[96:99]
    ds_read_b64_tr_b16 a[188:189], v27 offset:40960
    v_cvt_pk_bf16_f32 v188, v212, v213
    v_mfma_f32_16x16x32_bf16 a[96:99], a[180:183], v[132:135], a[96:99]
    ds_read_b64_tr_b16 a[190:191], v27 offset:45056
    v_lshlrev_b32 v244, 4, v244
    v_mfma_f32_16x16x32_bf16 a[100:103], a[180:183], v[140:143], a[100:103]
    v_cvt_pk_bf16_f32 v189, v214, v215
    v_mfma_f32_16x16x32_bf16 a[100:103], a[176:179], v[136:139], a[100:103]
    v_and_b32 v245, 1, v0
    v_lshl_add_u32 v244, v245, 2, v244
    v_mfma_f32_16x16x32_bf16 v[212:215], a[224:227], v[80:83], v[196:199]
    v_exp_f32 v208, v208
    v_mfma_f32_16x16x32_bf16 v[212:215], a[228:231], v[84:87], v[212:215]
    v_exp_f32 v209, v209
    v_mfma_f32_16x16x32_bf16 v[212:215], a[232:235], v[88:91], v[212:215]
    v_exp_f32 v210, v210
    v_mfma_f32_16x16x32_bf16 v[212:215], a[236:239], v[92:95], v[212:215]
    v_exp_f32 v211, v211
    v_mfma_f32_16x16x32_bf16 a[104:107], a[176:179], v[144:147], a[104:107]
    ds_read_b64_tr_b16 a[160:161], v20 offset:49152
    v_cvt_pk_bf16_f32 v166, v208, v209
    v_mfma_f32_16x16x32_bf16 a[104:107], a[180:183], v[148:151], a[104:107]
    ds_read_b64_tr_b16 a[162:163], v20 offset:53248
    v_lshrrev_b32 v245, 3, v0
    v_mfma_f32_16x16x32_bf16 a[108:111], a[180:183], v[156:159], a[108:111]
    v_cvt_pk_bf16_f32 v167, v210, v211
    v_mfma_f32_16x16x32_bf16 a[108:111], a[176:179], v[152:155], a[108:111]
    s_waitcnt lgkmcnt(3)
    buffer_load_dwordx4 v47, s[20:23], s49 offen offset:1024 lds
    v_mfma_f32_16x16x32_bf16 v[208:211], a[224:227], v[96:99], v[200:203]
    v_exp_f32 v212, v212
    v_mfma_f32_16x16x32_bf16 v[208:211], a[228:231], v[100:103], v[208:211]
    v_exp_f32 v213, v213
    v_mfma_f32_16x16x32_bf16 v[208:211], a[232:235], v[104:107], v[208:211]
    v_exp_f32 v214, v214
    v_mfma_f32_16x16x32_bf16 v[208:211], a[236:239], v[108:111], v[208:211]
    s_add_u32 s57, s59, 0
    v_exp_f32 v215, v215
    v_mfma_f32_16x16x32_bf16 a[112:115], a[184:187], v[128:131], a[112:115]
    s_waitcnt lgkmcnt(2)
    ds_read_b64_tr_b16 a[164:165], v20 offset:57344
    v_cvt_pk_bf16_f32 v174, v212, v213
    v_mfma_f32_16x16x32_bf16 a[112:115], a[188:191], v[132:135], a[112:115]
    ds_read_b64_tr_b16 a[166:167], v20 offset:61440
    v_min_u32 v245, 1, v245
    v_mfma_f32_16x16x32_bf16 a[116:119], a[188:191], v[140:143], a[116:119]
    v_cvt_pk_bf16_f32 v175, v214, v215
    v_mfma_f32_16x16x32_bf16 a[116:119], a[184:187], v[136:139], a[116:119]
    buffer_load_dwordx4 a[252:255], v255, s[84:87], s57 offen
    v_mfma_f32_16x16x32_bf16 v[212:215], a[224:227], v[112:115], v[204:207]
    v_exp_f32 v208, v208
    v_mfma_f32_16x16x32_bf16 v[212:215], a[228:231], v[116:119], v[212:215]
    v_exp_f32 v209, v209
    v_mfma_f32_16x16x32_bf16 v[212:215], a[232:235], v[120:123], v[212:215]
    v_exp_f32 v210, v210
    v_mfma_f32_16x16x32_bf16 v[212:215], a[236:239], v[124:127], v[212:215]
    v_exp_f32 v211, v211
    v_mfma_f32_16x16x32_bf16 a[120:123], a[184:187], v[144:147], a[120:123]
    ds_read_b64_tr_b16 a[168:169], v21 offset:49152
    v_cvt_pk_bf16_f32 v182, v208, v209
    v_mfma_f32_16x16x32_bf16 a[120:123], a[188:191], v[148:151], a[120:123]
    ds_read_b64_tr_b16 a[170:171], v21 offset:53248
    v_lshl_or_b32 v244, v245, 31, v244
    v_mfma_f32_16x16x32_bf16 a[124:127], a[188:191], v[156:159], a[124:127]
    v_cvt_pk_bf16_f32 v183, v210, v211
    v_mfma_f32_16x16x32_bf16 a[124:127], a[184:187], v[152:155], a[124:127]
    s_waitcnt lgkmcnt(3)
    buffer_load_dwordx4 v48, s[20:23], s49 offen offset:2048 lds
    v_smfmac_f32_16x16x64_bf16 a[192:195], v[52:55], v[160:167], v50
    v_exp_f32 v212, v212
    v_smfmac_f32_16x16x64_bf16 a[196:199], v[52:55], v[168:175], v50
    v_exp_f32 v213, v213
    v_smfmac_f32_16x16x64_bf16 a[200:203], v[52:55], v[176:183], v50
    v_exp_f32 v214, v214
    v_exp_f32 v215, v215
    v_mfma_f32_16x16x32_bf16 a[0:3], a[160:163], v[160:163], a[0:3]
    s_waitcnt lgkmcnt(2)
    ds_read_b64_tr_b16 a[172:173], v21 offset:57344
    v_cvt_pk_bf16_f32 v190, v212, v213
    v_mfma_f32_16x16x32_bf16 a[0:3], a[164:167], v[164:167], a[0:3]
    ds_read_b64_tr_b16 a[174:175], v21 offset:61440
    v_mfma_f32_16x16x32_bf16 a[4:7], a[164:167], v[172:175], a[4:7]
    v_cvt_pk_bf16_f32 v191, v214, v215
    v_mfma_f32_16x16x32_bf16 a[4:7], a[160:163], v[168:171], a[4:7]
    buffer_store_dword v246, v244, s[24:27], s39 offen sc1
    v_smfmac_f32_16x16x64_bf16 a[204:207], v[52:55], v[184:191], v50
    v_mfma_f32_16x16x32_bf16 a[8:11], a[160:163], v[176:179], a[8:11]
    ds_read_b64_tr_b16 a[176:177], v22 offset:49152
    v_mfma_f32_16x16x32_bf16 a[8:11], a[164:167], v[180:183], a[8:11]
    ds_read_b64_tr_b16 a[178:179], v22 offset:53248
    v_accvgpr_read_b32 v216, a192
    v_accvgpr_read_b32 v217, a193
    v_mfma_f32_16x16x32_bf16 a[12:15], a[164:167], v[188:191], a[12:15]
    v_accvgpr_read_b32 v218, a196
    v_accvgpr_read_b32 v219, a197
    v_mfma_f32_16x16x32_bf16 a[12:15], a[160:163], v[184:187], a[12:15]
    s_waitcnt lgkmcnt(4)
    buffer_load_dwordx4 v49, s[20:23], s49 offen offset:3072 lds
    v_accvgpr_read_b32 v220, a200
    v_accvgpr_read_b32 v221, a201
    v_mfma_f32_16x16x32_bf16 a[16:19], a[168:171], v[160:163], a[16:19]
    s_waitcnt lgkmcnt(2)
    ds_read_b64_tr_b16 a[180:181], v22 offset:57344
    s_waitcnt vmcnt(9)
    v_accvgpr_read_b32 v222, a204
    v_mfma_f32_16x16x32_bf16 a[16:19], a[172:175], v[164:167], a[16:19]
    ds_read_b64_tr_b16 a[182:183], v22 offset:61440
    v_accvgpr_read_b32 v223, a205
    v_add_f32 v58, v216, v217
    v_mfma_f32_16x16x32_bf16 a[20:23], a[172:175], v[172:175], a[20:23]
    v_add_f32 v59, v218, v219
    v_add_f32 v60, v220, v221
    v_mfma_f32_16x16x32_bf16 a[20:23], a[168:171], v[168:171], a[20:23]
    v_add_f32 v61, v222, v223
    v_add_f32 v216, v58, v59
    s_add_u32 s49, s7, 256
    s_add_u32 m0, s42, 32768
    v_mfma_f32_16x16x32_bf16 a[24:27], a[168:171], v[176:179], a[24:27]
    ds_read_b64_tr_b16 a[184:185], v23 offset:49152
    v_add_f32 v217, v60, v61
    v_mfma_f32_16x16x32_bf16 a[24:27], a[172:175], v[180:183], a[24:27]
    ds_read_b64_tr_b16 a[186:187], v23 offset:53248
    v_add_f32 v216, v216, v217
    v_cmp_ngt_f32 vcc, 1669332992, v216
    v_mfma_f32_16x16x32_bf16 a[28:31], a[172:175], v[188:191], a[28:31]
    v_rcp_f32 v58, v58
    v_rcp_f32 v59, v59
    v_mfma_f32_16x16x32_bf16 a[28:31], a[168:171], v[184:187], a[28:31]
    s_waitcnt lgkmcnt(4)
    buffer_load_dwordx4 v46, s[20:23], s49 offen lds
    v_rcp_f32 v60, v60
    v_rcp_f32 v61, v61
    v_mfma_f32_16x16x32_bf16 a[32:35], a[176:179], v[160:163], a[32:35]
    s_waitcnt lgkmcnt(2)
    ds_read_b64_tr_b16 a[188:189], v23 offset:57344
    v_mov_b32 v228, 131072
    v_mfma_f32_16x16x32_bf16 a[32:35], a[180:183], v[164:167], a[32:35]
    ds_read_b64_tr_b16 a[190:191], v23 offset:61440
    s_or_b32 s36, vcc_lo, vcc_hi
    v_mfma_f32_16x16x32_bf16 a[36:39], a[180:183], v[172:175], a[36:39]
    v_accvgpr_read_b32 v208, a0
    v_accvgpr_read_b32 v209, a1
    v_accvgpr_read_b32 v210, a2
    v_accvgpr_read_b32 v211, a3
    v_pk_mul_f32 v[208:209], v[208:209], v[58:59] op_sel:[0,0] op_sel_hi:[1,0]
    v_pk_mul_f32 v[210:211], v[210:211], v[58:59] op_sel:[0,0] op_sel_hi:[1,0]
    v_cvt_pk_bf16_f32 v128, v208, v209
    v_cvt_pk_bf16_f32 v129, v210, v211
    v_mfma_f32_16x16x32_bf16 a[36:39], a[176:179], v[168:171], a[36:39]
    v_accvgpr_read_b32 v212, a4
    v_accvgpr_read_b32 v213, a5
    v_accvgpr_read_b32 v214, a6
    v_accvgpr_read_b32 v215, a7
    v_pk_mul_f32 v[212:213], v[212:213], v[58:59] op_sel:[0,1] op_sel_hi:[1,1]
    v_pk_mul_f32 v[214:215], v[214:215], v[58:59] op_sel:[0,1] op_sel_hi:[1,1]
    v_cvt_pk_bf16_f32 v132, v212, v213
    v_cvt_pk_bf16_f32 v133, v214, v215
    v_mfma_f32_16x16x32_bf16 a[40:43], a[176:179], v[176:179], a[40:43]
    ds_read_b64_tr_b16 a[160:161], v24 offset:49152
    v_mov_b32 v218, s36
    v_mfma_f32_16x16x32_bf16 a[40:43], a[180:183], v[180:183], a[40:43]
    ds_read_b64_tr_b16 a[162:163], v24 offset:53248
    s_lshl_b32 s38, s3, 2
    v_mfma_f32_16x16x32_bf16 a[44:47], a[180:183], v[188:191], a[44:47]
    v_accvgpr_read_b32 v208, a8
    v_accvgpr_read_b32 v209, a9
    v_accvgpr_read_b32 v210, a10
    v_accvgpr_read_b32 v211, a11
    v_pk_mul_f32 v[208:209], v[208:209], v[60:61] op_sel:[0,0] op_sel_hi:[1,0]
    v_pk_mul_f32 v[210:211], v[210:211], v[60:61] op_sel:[0,0] op_sel_hi:[1,0]
    v_cvt_pk_bf16_f32 v136, v208, v209
    v_cvt_pk_bf16_f32 v137, v210, v211
    v_mfma_f32_16x16x32_bf16 a[44:47], a[176:179], v[184:187], a[44:47]
    s_waitcnt lgkmcnt(4)
    buffer_load_dwordx4 v47, s[20:23], s49 offen offset:1024 lds
    v_accvgpr_read_b32 v212, a12
    v_accvgpr_read_b32 v213, a13
    v_accvgpr_read_b32 v214, a14
    v_accvgpr_read_b32 v215, a15
    v_pk_mul_f32 v[212:213], v[212:213], v[60:61] op_sel:[0,1] op_sel_hi:[1,1]
    v_pk_mul_f32 v[214:215], v[214:215], v[60:61] op_sel:[0,1] op_sel_hi:[1,1]
    v_cvt_pk_bf16_f32 v140, v212, v213
    v_cvt_pk_bf16_f32 v141, v214, v215
    v_mfma_f32_16x16x32_bf16 a[48:51], a[184:187], v[160:163], a[48:51]
    s_waitcnt lgkmcnt(2)
    ds_read_b64_tr_b16 a[164:165], v24 offset:57344
    v_add_u32 v219, s38, v228
    v_mfma_f32_16x16x32_bf16 a[48:51], a[188:191], v[164:167], a[48:51]
    ds_read_b64_tr_b16 a[166:167], v24 offset:61440
    ds_write_b32 v219, v218
    v_mfma_f32_16x16x32_bf16 a[52:55], a[188:191], v[172:175], a[52:55]
    v_accvgpr_read_b32 v208, a16
    v_accvgpr_read_b32 v209, a17
    v_accvgpr_read_b32 v210, a18
    v_accvgpr_read_b32 v211, a19
    v_pk_mul_f32 v[208:209], v[208:209], v[58:59] op_sel:[0,0] op_sel_hi:[1,0]
    v_pk_mul_f32 v[210:211], v[210:211], v[58:59] op_sel:[0,0] op_sel_hi:[1,0]
    v_cvt_pk_bf16_f32 v130, v208, v209
    v_cvt_pk_bf16_f32 v131, v210, v211
    s_add_u32 s37, s55, 0
    buffer_store_dwordx4 v[128:131], v252, s[28:31], s37 offen offset:0
    v_mfma_f32_16x16x32_bf16 a[52:55], a[184:187], v[168:171], a[52:55]
    v_accvgpr_read_b32 v212, a20
    v_accvgpr_read_b32 v213, a21
    v_accvgpr_read_b32 v214, a22
    v_accvgpr_read_b32 v215, a23
    v_pk_mul_f32 v[212:213], v[212:213], v[58:59] op_sel:[0,1] op_sel_hi:[1,1]
    v_pk_mul_f32 v[214:215], v[214:215], v[58:59] op_sel:[0,1] op_sel_hi:[1,1]
    v_cvt_pk_bf16_f32 v134, v212, v213
    v_cvt_pk_bf16_f32 v135, v214, v215
    s_add_u32 s37, s55, 0
    buffer_store_dwordx4 v[132:135], v252, s[28:31], s37 offen offset:1024
    v_mfma_f32_16x16x32_bf16 a[56:59], a[184:187], v[176:179], a[56:59]
    ds_read_b64_tr_b16 a[168:169], v25 offset:49152
    v_min_u32 v240, 1, v0
    v_mfma_f32_16x16x32_bf16 a[56:59], a[188:191], v[180:183], a[56:59]
    ds_read_b64_tr_b16 a[170:171], v25 offset:53248
    v_mfma_f32_16x16x32_bf16 a[60:63], a[188:191], v[188:191], a[60:63]
    v_accvgpr_read_b32 v208, a24
    v_accvgpr_read_b32 v209, a25
    v_accvgpr_read_b32 v210, a26
    v_accvgpr_read_b32 v211, a27
    v_pk_mul_f32 v[208:209], v[208:209], v[60:61] op_sel:[0,0] op_sel_hi:[1,0]
    v_pk_mul_f32 v[210:211], v[210:211], v[60:61] op_sel:[0,0] op_sel_hi:[1,0]
    v_cvt_pk_bf16_f32 v138, v208, v209
    v_cvt_pk_bf16_f32 v139, v210, v211
    s_add_u32 s37, s55, 0
    buffer_store_dwordx4 v[136:139], v252, s[28:31], s37 offen offset:2048
    v_mfma_f32_16x16x32_bf16 a[60:63], a[184:187], v[184:187], a[60:63]
    s_waitcnt lgkmcnt(5)
    buffer_load_dwordx4 v48, s[20:23], s49 offen offset:2048 lds
    v_accvgpr_read_b32 v212, a28
    v_accvgpr_read_b32 v213, a29
    v_accvgpr_read_b32 v214, a30
    v_accvgpr_read_b32 v215, a31
    v_pk_mul_f32 v[212:213], v[212:213], v[60:61] op_sel:[0,1] op_sel_hi:[1,1]
    v_pk_mul_f32 v[214:215], v[214:215], v[60:61] op_sel:[0,1] op_sel_hi:[1,1]
    v_cvt_pk_bf16_f32 v142, v212, v213
    v_cvt_pk_bf16_f32 v143, v214, v215
    s_add_u32 s37, s55, 0
    buffer_store_dwordx4 v[140:143], v252, s[28:31], s37 offen offset:3072
    v_mfma_f32_16x16x32_bf16 a[64:67], a[160:163], v[160:163], a[64:67]
    s_waitcnt lgkmcnt(3)
    ds_read_b64_tr_b16 a[172:173], v25 offset:57344
    v_lshlrev_b32 v240, 31, v240
    v_mfma_f32_16x16x32_bf16 a[64:67], a[164:167], v[164:167], a[64:67]
    ds_read_b64_tr_b16 a[174:175], v25 offset:61440
    v_mfma_f32_16x16x32_bf16 a[68:71], a[164:167], v[172:175], a[68:71]
    v_accvgpr_read_b32 v208, a32
    v_accvgpr_read_b32 v209, a33
    v_accvgpr_read_b32 v210, a34
    v_accvgpr_read_b32 v211, a35
    v_pk_mul_f32 v[208:209], v[208:209], v[58:59] op_sel:[0,0] op_sel_hi:[1,0]
    v_pk_mul_f32 v[210:211], v[210:211], v[58:59] op_sel:[0,0] op_sel_hi:[1,0]
    v_cvt_pk_bf16_f32 v144, v208, v209
    v_cvt_pk_bf16_f32 v145, v210, v211
    v_mfma_f32_16x16x32_bf16 a[68:71], a[160:163], v[168:171], a[68:71]
    v_accvgpr_read_b32 v212, a36
    v_accvgpr_read_b32 v213, a37
    v_accvgpr_read_b32 v214, a38
    v_accvgpr_read_b32 v215, a39
    v_pk_mul_f32 v[212:213], v[212:213], v[58:59] op_sel:[0,1] op_sel_hi:[1,1]
    v_pk_mul_f32 v[214:215], v[214:215], v[58:59] op_sel:[0,1] op_sel_hi:[1,1]
    v_cvt_pk_bf16_f32 v148, v212, v213
    v_cvt_pk_bf16_f32 v149, v214, v215
    v_mfma_f32_16x16x32_bf16 a[72:75], a[160:163], v[176:179], a[72:75]
    ds_read_b64_tr_b16 a[176:177], v26 offset:49152
    v_mov_b32 v241, 1
    v_mfma_f32_16x16x32_bf16 a[72:75], a[164:167], v[180:183], a[72:75]
    ds_read_b64_tr_b16 a[178:179], v26 offset:53248
    v_mfma_f32_16x16x32_bf16 a[76:79], a[164:167], v[188:191], a[76:79]
    v_accvgpr_read_b32 v208, a40
    v_accvgpr_read_b32 v209, a41
    v_accvgpr_read_b32 v210, a42
    v_accvgpr_read_b32 v211, a43
    v_pk_mul_f32 v[208:209], v[208:209], v[60:61] op_sel:[0,0] op_sel_hi:[1,0]
    v_pk_mul_f32 v[210:211], v[210:211], v[60:61] op_sel:[0,0] op_sel_hi:[1,0]
    v_cvt_pk_bf16_f32 v152, v208, v209
    v_cvt_pk_bf16_f32 v153, v210, v211
    v_mfma_f32_16x16x32_bf16 a[76:79], a[160:163], v[184:187], a[76:79]
    s_waitcnt lgkmcnt(4)
    buffer_load_dwordx4 v49, s[20:23], s49 offen offset:3072 lds
    v_accvgpr_read_b32 v212, a44
    v_accvgpr_read_b32 v213, a45
    v_accvgpr_read_b32 v214, a46
    v_accvgpr_read_b32 v215, a47
    v_pk_mul_f32 v[212:213], v[212:213], v[60:61] op_sel:[0,1] op_sel_hi:[1,1]
    v_pk_mul_f32 v[214:215], v[214:215], v[60:61] op_sel:[0,1] op_sel_hi:[1,1]
    v_cvt_pk_bf16_f32 v156, v212, v213
    v_cvt_pk_bf16_f32 v157, v214, v215
    v_mfma_f32_16x16x32_bf16 a[80:83], a[168:171], v[160:163], a[80:83]
    s_waitcnt lgkmcnt(2)
    ds_read_b64_tr_b16 a[180:181], v26 offset:57344
    v_mfma_f32_16x16x32_bf16 a[80:83], a[172:175], v[164:167], a[80:83]
    ds_read_b64_tr_b16 a[182:183], v26 offset:61440
    v_mfma_f32_16x16x32_bf16 a[84:87], a[172:175], v[172:175], a[84:87]
    v_accvgpr_read_b32 v208, a48
    v_accvgpr_read_b32 v209, a49
    v_accvgpr_read_b32 v210, a50
    v_accvgpr_read_b32 v211, a51
    v_pk_mul_f32 v[208:209], v[208:209], v[58:59] op_sel:[0,0] op_sel_hi:[1,0]
    v_pk_mul_f32 v[210:211], v[210:211], v[58:59] op_sel:[0,0] op_sel_hi:[1,0]
    v_cvt_pk_bf16_f32 v146, v208, v209
    v_cvt_pk_bf16_f32 v147, v210, v211
    s_add_u32 s37, s55, 4096
    buffer_store_dwordx4 v[144:147], v252, s[28:31], s37 offen offset:0
    v_mfma_f32_16x16x32_bf16 a[84:87], a[168:171], v[168:171], a[84:87]
    v_accvgpr_read_b32 v212, a52
    v_accvgpr_read_b32 v213, a53
    v_accvgpr_read_b32 v214, a54
    v_accvgpr_read_b32 v215, a55
    v_pk_mul_f32 v[212:213], v[212:213], v[58:59] op_sel:[0,1] op_sel_hi:[1,1]
    v_pk_mul_f32 v[214:215], v[214:215], v[58:59] op_sel:[0,1] op_sel_hi:[1,1]
    v_cvt_pk_bf16_f32 v150, v212, v213
    v_cvt_pk_bf16_f32 v151, v214, v215
    s_add_u32 s37, s55, 4096
    buffer_store_dwordx4 v[148:151], v252, s[28:31], s37 offen offset:1024
    s_waitcnt vmcnt(23)
    s_barrier
    v_mfma_f32_16x16x32_bf16 a[88:91], a[168:171], v[176:179], a[88:91]
    ds_read_b64_tr_b16 a[184:185], v27 offset:49152
    v_mfma_f32_16x16x32_bf16 a[88:91], a[172:175], v[180:183], a[88:91]
    ds_read_b64_tr_b16 a[186:187], v27 offset:53248
    v_mfma_f32_16x16x32_bf16 a[92:95], a[172:175], v[188:191], a[92:95]
    ds_read_b128 v[224:227], v228
    v_accvgpr_read_b32 v208, a56
    v_accvgpr_read_b32 v209, a57
    v_accvgpr_read_b32 v210, a58
    v_accvgpr_read_b32 v211, a59
    v_pk_mul_f32 v[208:209], v[208:209], v[60:61] op_sel:[0,0] op_sel_hi:[1,0]
    v_pk_mul_f32 v[210:211], v[210:211], v[60:61] op_sel:[0,0] op_sel_hi:[1,0]
    v_cvt_pk_bf16_f32 v154, v208, v209
    v_cvt_pk_bf16_f32 v155, v210, v211
    s_add_u32 s37, s55, 4096
    buffer_store_dwordx4 v[152:155], v252, s[28:31], s37 offen offset:2048
    v_mfma_f32_16x16x32_bf16 a[92:95], a[168:171], v[184:187], a[92:95]
    s_waitcnt lgkmcnt(5)
    v_accvgpr_read_b32 v212, a60
    v_accvgpr_read_b32 v213, a61
    v_accvgpr_read_b32 v214, a62
    v_accvgpr_read_b32 v215, a63
    v_pk_mul_f32 v[212:213], v[212:213], v[60:61] op_sel:[0,1] op_sel_hi:[1,1]
    v_pk_mul_f32 v[214:215], v[214:215], v[60:61] op_sel:[0,1] op_sel_hi:[1,1]
    v_cvt_pk_bf16_f32 v158, v212, v213
    v_cvt_pk_bf16_f32 v159, v214, v215
    s_add_u32 s37, s55, 4096
    buffer_store_dwordx4 v[156:159], v252, s[28:31], s37 offen offset:3072
    s_add_u32 s49, s7, 73984
    v_mfma_f32_16x16x32_bf16 a[96:99], a[176:179], v[160:163], a[96:99]
    s_waitcnt lgkmcnt(3)
    s_add_u32 m0, s42, 49152
    ds_read_b64_tr_b16 a[188:189], v27 offset:57344
    v_mfma_f32_16x16x32_bf16 a[96:99], a[180:183], v[164:167], a[96:99]
    buffer_load_dwordx4 v46, s[20:23], s49 offen lds
    v_mfma_f32_16x16x32_bf16 a[100:103], a[180:183], v[172:175], a[100:103]
    ds_read_b64_tr_b16 a[190:191], v27 offset:61440
    v_accvgpr_read_b32 v208, a64
    v_accvgpr_read_b32 v209, a65
    v_accvgpr_read_b32 v210, a66
    v_accvgpr_read_b32 v211, a67
    v_pk_mul_f32 v[208:209], v[208:209], v[58:59] op_sel:[0,0] op_sel_hi:[1,0]
    v_pk_mul_f32 v[210:211], v[210:211], v[58:59] op_sel:[0,0] op_sel_hi:[1,0]
    v_cvt_pk_bf16_f32 v192, v208, v209
    v_cvt_pk_bf16_f32 v193, v210, v211
    v_mfma_f32_16x16x32_bf16 a[100:103], a[176:179], v[168:171], a[100:103]
    buffer_load_dwordx4 v47, s[20:23], s49 offen offset:1024 lds
    v_accvgpr_read_b32 v212, a68
    v_accvgpr_read_b32 v213, a69
    v_accvgpr_read_b32 v214, a70
    v_accvgpr_read_b32 v215, a71
    v_pk_mul_f32 v[212:213], v[212:213], v[58:59] op_sel:[0,1] op_sel_hi:[1,1]
    v_pk_mul_f32 v[214:215], v[214:215], v[58:59] op_sel:[0,1] op_sel_hi:[1,1]
    v_cvt_pk_bf16_f32 v196, v212, v213
    v_cvt_pk_bf16_f32 v197, v214, v215
    v_mfma_f32_16x16x32_bf16 a[104:107], a[176:179], v[176:179], a[104:107]
    v_mfma_f32_16x16x32_bf16 a[104:107], a[180:183], v[180:183], a[104:107]
    buffer_load_dwordx4 v48, s[20:23], s49 offen offset:2048 lds
    v_mfma_f32_16x16x32_bf16 a[108:111], a[180:183], v[188:191], a[108:111]
    v_accvgpr_read_b32 v208, a72
    v_accvgpr_read_b32 v209, a73
    v_accvgpr_read_b32 v210, a74
    v_accvgpr_read_b32 v211, a75
    v_pk_mul_f32 v[208:209], v[208:209], v[60:61] op_sel:[0,0] op_sel_hi:[1,0]
    v_pk_mul_f32 v[210:211], v[210:211], v[60:61] op_sel:[0,0] op_sel_hi:[1,0]
    v_cvt_pk_bf16_f32 v200, v208, v209
    v_cvt_pk_bf16_f32 v201, v210, v211
    v_mfma_f32_16x16x32_bf16 a[108:111], a[176:179], v[184:187], a[108:111]
    s_waitcnt lgkmcnt(3)
    buffer_load_dwordx4 v49, s[20:23], s49 offen offset:3072 lds
    v_accvgpr_read_b32 v212, a76
    v_accvgpr_read_b32 v213, a77
    v_accvgpr_read_b32 v214, a78
    v_accvgpr_read_b32 v215, a79
    v_pk_mul_f32 v[212:213], v[212:213], v[60:61] op_sel:[0,1] op_sel_hi:[1,1]
    v_pk_mul_f32 v[214:215], v[214:215], v[60:61] op_sel:[0,1] op_sel_hi:[1,1]
    v_cvt_pk_bf16_f32 v204, v212, v213
    v_cvt_pk_bf16_f32 v205, v214, v215
    s_add_u32 s49, s46, 0
    v_mfma_f32_16x16x32_bf16 a[112:115], a[184:187], v[160:163], a[112:115]
    s_waitcnt lgkmcnt(0)
    s_add_u32 m0, s42, 98304
    v_mfma_f32_16x16x32_bf16 a[112:115], a[188:191], v[164:167], a[112:115]
    buffer_load_dwordx4 v46, s[20:23], s49 offen lds
    v_mfma_f32_16x16x32_bf16 a[116:119], a[188:191], v[172:175], a[116:119]
    v_accvgpr_read_b32 v208, a80
    v_accvgpr_read_b32 v209, a81
    v_accvgpr_read_b32 v210, a82
    v_accvgpr_read_b32 v211, a83
    v_pk_mul_f32 v[208:209], v[208:209], v[58:59] op_sel:[0,0] op_sel_hi:[1,0]
    v_pk_mul_f32 v[210:211], v[210:211], v[58:59] op_sel:[0,0] op_sel_hi:[1,0]
    v_cvt_pk_bf16_f32 v194, v208, v209
    v_cvt_pk_bf16_f32 v195, v210, v211
    s_add_u32 s37, s55, 8192
    buffer_store_dwordx4 v[192:195], v252, s[28:31], s37 offen offset:0
    v_mfma_f32_16x16x32_bf16 a[116:119], a[184:187], v[168:171], a[116:119]
    buffer_load_dwordx4 v47, s[20:23], s49 offen offset:1024 lds
    v_accvgpr_read_b32 v212, a84
    v_accvgpr_read_b32 v213, a85
    v_accvgpr_read_b32 v214, a86
    v_accvgpr_read_b32 v215, a87
    v_pk_mul_f32 v[212:213], v[212:213], v[58:59] op_sel:[0,1] op_sel_hi:[1,1]
    v_pk_mul_f32 v[214:215], v[214:215], v[58:59] op_sel:[0,1] op_sel_hi:[1,1]
    v_cvt_pk_bf16_f32 v198, v212, v213
    v_cvt_pk_bf16_f32 v199, v214, v215
    s_add_u32 s37, s55, 8192
    buffer_store_dwordx4 v[196:199], v252, s[28:31], s37 offen offset:1024
    v_mfma_f32_16x16x32_bf16 a[120:123], a[184:187], v[176:179], a[120:123]
    v_mfma_f32_16x16x32_bf16 a[120:123], a[188:191], v[180:183], a[120:123]
    buffer_load_dwordx4 v48, s[20:23], s49 offen offset:2048 lds
    v_mfma_f32_16x16x32_bf16 a[124:127], a[188:191], v[188:191], a[124:127]
    v_accvgpr_read_b32 v208, a88
    v_accvgpr_read_b32 v209, a89
    v_accvgpr_read_b32 v210, a90
    v_accvgpr_read_b32 v211, a91
    v_pk_mul_f32 v[208:209], v[208:209], v[60:61] op_sel:[0,0] op_sel_hi:[1,0]
    v_pk_mul_f32 v[210:211], v[210:211], v[60:61] op_sel:[0,0] op_sel_hi:[1,0]
    v_cvt_pk_bf16_f32 v202, v208, v209
    v_cvt_pk_bf16_f32 v203, v210, v211
    s_add_u32 s37, s55, 8192
    buffer_store_dwordx4 v[200:203], v252, s[28:31], s37 offen offset:2048
    v_mfma_f32_16x16x32_bf16 a[124:127], a[184:187], v[184:187], a[124:127]
    buffer_load_dwordx4 v49, s[20:23], s49 offen offset:3072 lds
    v_accvgpr_read_b32 v212, a92
    v_accvgpr_read_b32 v213, a93
    v_accvgpr_read_b32 v214, a94
    v_accvgpr_read_b32 v215, a95
    v_pk_mul_f32 v[212:213], v[212:213], v[60:61] op_sel:[0,1] op_sel_hi:[1,1]
    v_pk_mul_f32 v[214:215], v[214:215], v[60:61] op_sel:[0,1] op_sel_hi:[1,1]
    v_cvt_pk_bf16_f32 v206, v212, v213
    v_cvt_pk_bf16_f32 v207, v214, v215
    s_add_u32 s37, s55, 8192
    buffer_store_dwordx4 v[204:207], v252, s[28:31], s37 offen offset:3072
    v_or3_b32 v224, v224, v225, v226
    v_or_b32 v224, v224, v227
    s_nop 0
    v_readfirstlane_b32 s36, v224
    v_readfirstlane_b32 s38, v253
    v_min_u32 v8, 1, v1
    v_lshlrev_b32 v8, 31, v8
    v_mov_b32 v10, s95
    s_getreg_b32 s39, hwreg(HW_REG_XCC_ID, 0, 4)
    s_lshl_b32 s39, s39, 28
    s_xor_b32 s39, s39, s95
    s_cmp_eq_u32 s38, s39
    s_cselect_b32 s53, 1, 0
    ds_read_b64_tr_b16 a[208:209], v12 offset:0
    ds_read_b64_tr_b16 a[210:211], v12 offset:4096
    ds_read_b64_tr_b16 a[212:213], v12 offset:8192
    ds_read_b64_tr_b16 a[214:215], v12 offset:12288
    ds_read_b64_tr_b16 a[216:217], v12 offset:16384
    ds_read_b64_tr_b16 a[218:219], v12 offset:20480
    ds_read_b64_tr_b16 a[220:221], v12 offset:24576
    ds_read_b64_tr_b16 a[222:223], v12 offset:28672
    ds_read_b64_tr_b16 a[224:225], v16 offset:0
    ds_read_b64_tr_b16 a[226:227], v16 offset:4096
    ds_read_b64_tr_b16 a[228:229], v16 offset:8192
    ds_read_b64_tr_b16 a[230:231], v16 offset:12288
    ds_read_b64_tr_b16 a[232:233], v16 offset:16384
    ds_read_b64_tr_b16 a[234:235], v16 offset:20480
    ds_read_b64_tr_b16 a[236:237], v16 offset:24576
    ds_read_b64_tr_b16 a[238:239], v16 offset:28672
    s_andn2_b32 s36, s36, s48
    s_cbranch_scc1 Lattn_redo
    v_accvgpr_read_b32 v208, a96
    v_accvgpr_read_b32 v209, a97
    v_accvgpr_read_b32 v210, a98
    v_accvgpr_read_b32 v211, a99
    v_pk_mul_f32 v[208:209], v[208:209], v[58:59] op_sel:[0,0] op_sel_hi:[1,0]
    v_pk_mul_f32 v[210:211], v[210:211], v[58:59] op_sel:[0,0] op_sel_hi:[1,0]
    v_cvt_pk_bf16_f32 v176, v208, v209
    v_cvt_pk_bf16_f32 v177, v210, v211
    v_accvgpr_read_b32 v212, a100
    v_accvgpr_read_b32 v213, a101
    v_accvgpr_read_b32 v214, a102
    v_accvgpr_read_b32 v215, a103
    v_pk_mul_f32 v[212:213], v[212:213], v[58:59] op_sel:[0,1] op_sel_hi:[1,1]
Ltour0_8:
    s_cbranch_execz Ltour0_12
    v_pk_mul_f32 v[214:215], v[214:215], v[58:59] op_sel:[0,1] op_sel_hi:[1,1]
    v_cvt_pk_bf16_f32 v180, v212, v213
    v_cvt_pk_bf16_f32 v181, v214, v215
    v_accvgpr_read_b32 v208, a104
    v_accvgpr_read_b32 v209, a105
    v_accvgpr_read_b32 v210, a106
    v_accvgpr_read_b32 v211, a107
    v_pk_mul_f32 v[208:209], v[208:209], v[60:61] op_sel:[0,0] op_sel_hi:[1,0]
    v_pk_mul_f32 v[210:211], v[210:211], v[60:61] op_sel:[0,0] op_sel_hi:[1,0]
    v_cvt_pk_bf16_f32 v184, v208, v209
    v_cvt_pk_bf16_f32 v185, v210, v211
    v_accvgpr_read_b32 v212, a108
    v_accvgpr_read_b32 v213, a109
    v_accvgpr_read_b32 v214, a110
    v_accvgpr_read_b32 v215, a111
    v_pk_mul_f32 v[212:213], v[212:213], v[60:61] op_sel:[0,1] op_sel_hi:[1,1]
    v_pk_mul_f32 v[214:215], v[214:215], v[60:61] op_sel:[0,1] op_sel_hi:[1,1]
    v_cvt_pk_bf16_f32 v188, v212, v213
    v_cvt_pk_bf16_f32 v189, v214, v215
    v_accvgpr_read_b32 v208, a112
    v_accvgpr_read_b32 v209, a113
    v_accvgpr_read_b32 v210, a114
    v_accvgpr_read_b32 v211, a115
    v_pk_mul_f32 v[208:209], v[208:209], v[58:59] op_sel:[0,0] op_sel_hi:[1,0]
    v_pk_mul_f32 v[210:211], v[210:211], v[58:59] op_sel:[0,0] op_sel_hi:[1,0]
    v_cvt_pk_bf16_f32 v178, v208, v209
    v_cvt_pk_bf16_f32 v179, v210, v211
    s_add_u32 s37, s55, 12288
    buffer_store_dwordx4 v[176:179], v252, s[28:31], s37 offen offset:0
    v_accvgpr_read_b32 v212, a116
    v_accvgpr_read_b32 v213, a117
    v_accvgpr_read_b32 v214, a118
    v_accvgpr_read_b32 v215, a119
    v_pk_mul_f32 v[212:213], v[212:213], v[58:59] op_sel:[0,1] op_sel_hi:[1,1]
    v_pk_mul_f32 v[214:215], v[214:215], v[58:59] op_sel:[0,1] op_sel_hi:[1,1]
    v_cvt_pk_bf16_f32 v182, v212, v213
    v_cvt_pk_bf16_f32 v183, v214, v215
    s_add_u32 s37, s55, 12288
    buffer_store_dwordx4 v[180:183], v252, s[28:31], s37 offen offset:1024
    v_accvgpr_read_b32 v208, a120
    v_accvgpr_read_b32 v209, a121
    v_accvgpr_read_b32 v210, a122
    v_accvgpr_read_b32 v211, a123
    v_pk_mul_f32 v[208:209], v[208:209], v[60:61] op_sel:[0,0] op_sel_hi:[1,0]
    v_pk_mul_f32 v[210:211], v[210:211], v[60:61] op_sel:[0,0] op_sel_hi:[1,0]
    v_cvt_pk_bf16_f32 v186, v208, v209
    v_cvt_pk_bf16_f32 v187, v210, v211
    s_add_u32 s37, s55, 12288
    buffer_store_dwordx4 v[184:187], v252, s[28:31], s37 offen offset:2048
    v_accvgpr_read_b32 v212, a124
    v_accvgpr_read_b32 v213, a125
    v_accvgpr_read_b32 v214, a126
    v_accvgpr_read_b32 v215, a127
    v_pk_mul_f32 v[212:213], v[212:213], v[60:61] op_sel:[0,1] op_sel_hi:[1,1]
    v_pk_mul_f32 v[214:215], v[214:215], v[60:61] op_sel:[0,1] op_sel_hi:[1,1]
    v_cvt_pk_bf16_f32 v190, v212, v213
    v_cvt_pk_bf16_f32 v191, v214, v215
    s_add_u32 s37, s55, 12288
    buffer_store_dwordx4 v[188:191], v252, s[28:31], s37 offen offset:3072
    s_waitcnt lgkmcnt(14)
    v_mfma_f32_16x16x32_bf16 v[96:99], a[208:211], v[128:131], 0
    s_waitcnt lgkmcnt(12)
    ds_read_b64_tr_b16 a[160:161], v13 offset:0
    v_mfma_f32_16x16x32_bf16 v[96:99], a[212:215], v[144:147], v[96:99]
    s_waitcnt lgkmcnt(11)
    ds_read_b64_tr_b16 a[162:163], v13 offset:4096
    v_mfma_f32_16x16x32_bf16 v[96:99], a[216:219], v[192:195], v[96:99]
    s_waitcnt lgkmcnt(10)
    ds_read_b64_tr_b16 a[164:165], v13 offset:8192
    v_mfma_f32_16x16x32_bf16 v[96:99], a[220:223], v[176:179], v[96:99]
    s_waitcnt lgkmcnt(9)
    ds_read_b64_tr_b16 a[166:167], v13 offset:12288
    v_mfma_f32_16x16x32_bf16 v[96:99], a[224:227], v[136:139], v[96:99]
    s_waitcnt lgkmcnt(8)
    ds_read_b64_tr_b16 a[168:169], v13 offset:16384
    v_mfma_f32_16x16x32_bf16 v[96:99], a[228:231], v[152:155], v[96:99]
    s_waitcnt lgkmcnt(7)
    ds_read_b64_tr_b16 a[170:171], v13 offset:20480
    v_mfma_f32_16x16x32_bf16 v[96:99], a[232:235], v[200:203], v[96:99]
    s_waitcnt lgkmcnt(6)
    ds_read_b64_tr_b16 a[172:173], v13 offset:24576
    v_mfma_f32_16x16x32_bf16 v[96:99], a[236:239], v[184:187], v[96:99]
    ds_read_b64_tr_b16 a[174:175], v13 offset:28672
    v_mfma_f32_16x16x32_bf16 v[100:103], a[236:239], v[188:191], 0
    ds_read_b64_tr_b16 a[176:177], v17 offset:0
    v_mfma_f32_16x16x32_bf16 v[100:103], a[232:235], v[204:207], v[100:103]
    ds_read_b64_tr_b16 a[178:179], v17 offset:4096
    v_mfma_f32_16x16x32_bf16 v[100:103], a[228:231], v[156:159], v[100:103]
    ds_read_b64_tr_b16 a[180:181], v17 offset:8192
    v_mfma_f32_16x16x32_bf16 v[100:103], a[224:227], v[140:143], v[100:103]
    ds_read_b64_tr_b16 a[182:183], v17 offset:12288
    v_mfma_f32_16x16x32_bf16 v[100:103], a[220:223], v[180:183], v[100:103]
    ds_read_b64_tr_b16 a[184:185], v17 offset:16384
    v_cvt_pk_bf16_f32 v224, v96, v97
    v_mfma_f32_16x16x32_bf16 v[100:103], a[216:219], v[196:199], v[100:103]
    ds_read_b64_tr_b16 a[186:187], v17 offset:20480
    v_cvt_pk_bf16_f32 v225, v98, v99
    v_mfma_f32_16x16x32_bf16 v[100:103], a[212:215], v[148:151], v[100:103]
    ds_read_b64_tr_b16 a[188:189], v17 offset:24576
    v_mfma_f32_16x16x32_bf16 v[100:103], a[208:211], v[132:135], v[100:103]
    s_waitcnt lgkmcnt(13)
    ds_read_b64_tr_b16 a[190:191], v17 offset:28672
    v_mfma_f32_16x16x32_bf16 v[104:107], a[160:163], v[128:131], 0
    s_waitcnt lgkmcnt(12)
    ds_read_b64_tr_b16 a[208:209], v14 offset:0
    v_mfma_f32_16x16x32_bf16 v[104:107], a[164:167], v[144:147], v[104:107]
    s_waitcnt lgkmcnt(11)
    ds_read_b64_tr_b16 a[210:211], v14 offset:4096
    v_mfma_f32_16x16x32_bf16 v[104:107], a[168:171], v[192:195], v[104:107]
    s_waitcnt lgkmcnt(10)
    ds_read_b64_tr_b16 a[212:213], v14 offset:8192
    v_mfma_f32_16x16x32_bf16 v[104:107], a[172:175], v[176:179], v[104:107]
    s_waitcnt lgkmcnt(9)
    ds_read_b64_tr_b16 a[214:215], v14 offset:12288
    v_mfma_f32_16x16x32_bf16 v[104:107], a[176:179], v[136:139], v[104:107]
    s_waitcnt lgkmcnt(8)
    ds_read_b64_tr_b16 a[216:217], v14 offset:16384
    v_cvt_pk_bf16_f32 v228, v100, v101
    v_mfma_f32_16x16x32_bf16 v[104:107], a[180:183], v[152:155], v[104:107]
    s_waitcnt lgkmcnt(7)
    ds_read_b64_tr_b16 a[218:219], v14 offset:20480
    v_cvt_pk_bf16_f32 v229, v102, v103
    v_mfma_f32_16x16x32_bf16 v[104:107], a[184:187], v[200:203], v[104:107]
    s_waitcnt lgkmcnt(6)
    ds_read_b64_tr_b16 a[220:221], v14 offset:24576
    v_mfma_f32_16x16x32_bf16 v[104:107], a[188:191], v[184:187], v[104:107]
    ds_read_b64_tr_b16 a[222:223], v14 offset:28672
    s_waitcnt vmcnt(0)
    s_cmp_eq_u32 s53, 0
    s_cbranch_scc1 Lattn_wb
Lattn_wbdone:
    v_mfma_f32_16x16x32_bf16 v[108:111], a[188:191], v[188:191], 0
    buffer_store_dword v10, v8, s[24:27], s92 offen offset:8 sc1
    v_mfma_f32_16x16x32_bf16 v[108:111], a[184:187], v[204:207], v[108:111]
    s_xor_b32 s55, s55, 65536
    ds_read_b64_tr_b16 a[224:225], v18 offset:0
    ds_read_b64_tr_b16 a[226:227], v18 offset:4096
    v_mfma_f32_16x16x32_bf16 v[108:111], a[180:183], v[156:159], v[108:111]
    buffer_atomic_add v241, v240, s[88:91], 0 offen sc1
    v_mfma_f32_16x16x32_bf16 v[108:111], a[176:179], v[140:143], v[108:111]
    ds_read_b64_tr_b16 a[228:229], v18 offset:8192
    ds_read_b64_tr_b16 a[230:231], v18 offset:12288
    s_load_dwordx2 s[12:13], s[0:1], 0
    v_mfma_f32_16x16x32_bf16 v[108:111], a[172:175], v[180:183], v[108:111]
    ds_read_b64_tr_b16 a[232:233], v18 offset:16384
    v_cvt_pk_bf16_f32 v226, v104, v105
    v_mfma_f32_16x16x32_bf16 v[108:111], a[168:171], v[196:199], v[108:111]
    s_add_u32 s38, s56, 16384
    ds_read_b64_tr_b16 a[234:235], v18 offset:20480
    v_cvt_pk_bf16_f32 v227, v106, v107
    s_load_dwordx2 s[16:17], s[0:1], 96
    v_mfma_f32_16x16x32_bf16 v[108:111], a[164:167], v[148:151], v[108:111]
    buffer_store_dwordx4 v[224:227], v56, s[28:31], s38 offen sc1
    v_mfma_f32_16x16x32_bf16 v[108:111], a[160:163], v[132:135], v[108:111]
    s_waitcnt lgkmcnt(12)
    ds_read_b64_tr_b16 a[236:237], v18 offset:24576
    ds_read_b64_tr_b16 a[238:239], v18 offset:28672
    s_load_dwordx2 s[52:53], s[0:1], 48
    v_mfma_f32_16x16x32_bf16 v[112:115], a[208:211], v[128:131], 0
    s_waitcnt lgkmcnt(12)
    ds_read_b64_tr_b16 a[160:161], v15 offset:0
    v_mfma_f32_16x16x32_bf16 v[112:115], a[212:215], v[144:147], v[112:115]
    s_waitcnt lgkmcnt(11)
    ds_read_b64_tr_b16 a[162:163], v15 offset:4096
    v_mfma_f32_16x16x32_bf16 v[112:115], a[216:219], v[192:195], v[112:115]
    s_waitcnt lgkmcnt(10)
    ds_read_b64_tr_b16 a[164:165], v15 offset:8192
    v_mfma_f32_16x16x32_bf16 v[112:115], a[220:223], v[176:179], v[112:115]
    s_waitcnt lgkmcnt(9)
    ds_read_b64_tr_b16 a[166:167], v15 offset:12288
    v_mfma_f32_16x16x32_bf16 v[112:115], a[224:227], v[136:139], v[112:115]
    s_waitcnt lgkmcnt(8)
    ds_read_b64_tr_b16 a[168:169], v15 offset:16384
    v_cvt_pk_bf16_f32 v230, v108, v109
    v_mfma_f32_16x16x32_bf16 v[112:115], a[228:231], v[152:155], v[112:115]
    s_waitcnt lgkmcnt(7)
    s_add_u32 s38, s56, 181248
    ds_read_b64_tr_b16 a[170:171], v15 offset:20480
    v_cvt_pk_bf16_f32 v231, v110, v111
    v_mfma_f32_16x16x32_bf16 v[112:115], a[232:235], v[200:203], v[112:115]
    s_waitcnt lgkmcnt(6)
    buffer_store_dwordx4 v[228:231], v56, s[28:31], s38 offen sc1
    v_mfma_f32_16x16x32_bf16 v[112:115], a[236:239], v[184:187], v[112:115]
    ds_read_b64_tr_b16 a[172:173], v15 offset:24576
    ds_read_b64_tr_b16 a[174:175], v15 offset:28672
    v_mfma_f32_16x16x32_bf16 v[116:119], a[236:239], v[188:191], 0
    ds_read_b64_tr_b16 a[176:177], v19 offset:0
    v_mfma_f32_16x16x32_bf16 v[116:119], a[232:235], v[204:207], v[116:119]
    ds_read_b64_tr_b16 a[178:179], v19 offset:4096
    v_mfma_f32_16x16x32_bf16 v[116:119], a[228:231], v[156:159], v[116:119]
    ds_read_b64_tr_b16 a[180:181], v19 offset:8192
    v_mfma_f32_16x16x32_bf16 v[116:119], a[224:227], v[140:143], v[116:119]
    ds_read_b64_tr_b16 a[182:183], v19 offset:12288
    v_mfma_f32_16x16x32_bf16 v[116:119], a[220:223], v[180:183], v[116:119]
    ds_read_b64_tr_b16 a[184:185], v19 offset:16384
    v_cvt_pk_bf16_f32 v232, v112, v113
    v_mfma_f32_16x16x32_bf16 v[116:119], a[216:219], v[196:199], v[116:119]
    ds_read_b64_tr_b16 a[186:187], v19 offset:20480
    v_cvt_pk_bf16_f32 v233, v114, v115
    v_mfma_f32_16x16x32_bf16 v[116:119], a[212:215], v[148:151], v[116:119]
    ds_read_b64_tr_b16 a[188:189], v19 offset:24576
    v_mfma_f32_16x16x32_bf16 v[116:119], a[208:211], v[132:135], v[116:119]
    s_waitcnt lgkmcnt(13)
    ds_read_b64_tr_b16 a[190:191], v19 offset:28672
    s_barrier
    v_mfma_f32_16x16x32_bf16 v[120:123], a[160:163], v[128:131], 0
    s_waitcnt lgkmcnt(12)
    buffer_load_dword v11, v8, s[24:27], s54 offen offset:8 sc1
    v_mfma_f32_16x16x32_bf16 v[120:123], a[164:167], v[144:147], v[120:123]
    s_waitcnt lgkmcnt(10)
    ds_read_b64_tr_b16 a[208:209], v20 offset:0
    ds_read_b64_tr_b16 a[210:211], v20 offset:4096
    v_mfma_f32_16x16x32_bf16 v[120:123], a[168:171], v[192:195], v[120:123]
    s_waitcnt lgkmcnt(10)
    ds_read_b64_tr_b16 a[212:213], v20 offset:8192
    v_mfma_f32_16x16x32_bf16 v[120:123], a[172:175], v[176:179], v[120:123]
    s_waitcnt lgkmcnt(9)
    ds_read_b64_tr_b16 a[214:215], v20 offset:12288
    v_mfma_f32_16x16x32_bf16 v[120:123], a[176:179], v[136:139], v[120:123]
    s_waitcnt lgkmcnt(8)
    ds_read_b64_tr_b16 a[216:217], v20 offset:16384
    v_cvt_pk_bf16_f32 v236, v116, v117
    v_mfma_f32_16x16x32_bf16 v[120:123], a[180:183], v[152:155], v[120:123]
    s_waitcnt lgkmcnt(7)
    ds_read_b64_tr_b16 a[218:219], v20 offset:20480
    v_cvt_pk_bf16_f32 v237, v118, v119
    v_mfma_f32_16x16x32_bf16 v[120:123], a[184:187], v[200:203], v[120:123]
    s_waitcnt lgkmcnt(6)
    s_add_u32 s49, s46, 73728
    ds_read_b64_tr_b16 a[220:221], v20 offset:24576
    v_mfma_f32_16x16x32_bf16 v[120:123], a[188:191], v[184:187], v[120:123]
    s_add_u32 m0, s42, 114688
    ds_read_b64_tr_b16 a[222:223], v20 offset:28672
    v_mfma_f32_16x16x32_bf16 v[124:127], a[188:191], v[188:191], 0
    buffer_load_dwordx4 v46, s[20:23], s49 offen lds
    v_mfma_f32_16x16x32_bf16 v[124:127], a[184:187], v[204:207], v[124:127]
    ds_read_b64_tr_b16 a[224:225], v24 offset:0
    ds_read_b64_tr_b16 a[226:227], v24 offset:4096
    v_mfma_f32_16x16x32_bf16 v[124:127], a[180:183], v[156:159], v[124:127]
    buffer_load_dwordx4 v47, s[20:23], s49 offen offset:1024 lds
    v_mfma_f32_16x16x32_bf16 v[124:127], a[176:179], v[140:143], v[124:127]
    ds_read_b64_tr_b16 a[228:229], v24 offset:8192
    ds_read_b64_tr_b16 a[230:231], v24 offset:12288
    v_mfma_f32_16x16x32_bf16 v[124:127], a[172:175], v[180:183], v[124:127]
    ds_read_b64_tr_b16 a[232:233], v24 offset:16384
    v_cvt_pk_bf16_f32 v234, v120, v121
    v_mfma_f32_16x16x32_bf16 v[124:127], a[168:171], v[196:199], v[124:127]
    s_add_u32 s38, s56, 16512
    ds_read_b64_tr_b16 a[234:235], v24 offset:20480
    v_cvt_pk_bf16_f32 v235, v122, v123
    v_mfma_f32_16x16x32_bf16 v[124:127], a[164:167], v[148:151], v[124:127]
    buffer_store_dwordx4 v[232:235], v56, s[28:31], s38 offen sc1
    v_mfma_f32_16x16x32_bf16 v[124:127], a[160:163], v[132:135], v[124:127]
    s_waitcnt lgkmcnt(12)
    ds_read_b64_tr_b16 a[236:237], v24 offset:24576
    ds_read_b64_tr_b16 a[238:239], v24 offset:28672
    v_mfma_f32_16x16x32_bf16 v[64:67], a[208:211], v[128:131], 0
    s_waitcnt lgkmcnt(12)
    buffer_load_dwordx4 v48, s[20:23], s49 offen offset:2048 lds
    v_mfma_f32_16x16x32_bf16 v[64:67], a[212:215], v[144:147], v[64:67]
    s_waitcnt lgkmcnt(10)
    ds_read_b64_tr_b16 a[160:161], v21 offset:0
    ds_read_b64_tr_b16 a[162:163], v21 offset:4096
    v_mfma_f32_16x16x32_bf16 v[64:67], a[216:219], v[192:195], v[64:67]
    s_waitcnt lgkmcnt(10)
    buffer_load_dwordx4 v49, s[20:23], s49 offen offset:3072 lds
    v_mfma_f32_16x16x32_bf16 v[64:67], a[220:223], v[176:179], v[64:67]
    s_waitcnt lgkmcnt(8)
    ds_read_b64_tr_b16 a[164:165], v21 offset:8192
    ds_read_b64_tr_b16 a[166:167], v21 offset:12288
    v_mfma_f32_16x16x32_bf16 v[64:67], a[224:227], v[136:139], v[64:67]
    s_waitcnt lgkmcnt(8)
    ds_read_b64_tr_b16 a[168:169], v21 offset:16384
    v_cvt_pk_bf16_f32 v238, v124, v125
    v_mfma_f32_16x16x32_bf16 v[64:67], a[228:231], v[152:155], v[64:67]
    s_waitcnt lgkmcnt(7)
    s_add_u32 s38, s56, 181376
    ds_read_b64_tr_b16 a[170:171], v21 offset:20480
    v_cvt_pk_bf16_f32 v239, v126, v127
    v_mfma_f32_16x16x32_bf16 v[64:67], a[232:235], v[200:203], v[64:67]
    s_waitcnt lgkmcnt(6)
    buffer_store_dwordx4 v[236:239], v56, s[28:31], s38 offen sc1
    v_mfma_f32_16x16x32_bf16 v[64:67], a[236:239], v[184:187], v[64:67]
    ds_read_b64_tr_b16 a[172:173], v21 offset:24576
    ds_read_b64_tr_b16 a[174:175], v21 offset:28672
    v_mfma_f32_16x16x32_bf16 v[68:71], a[236:239], v[188:191], 0
    s_lshl_b32 s40, s5, 4
    ds_read_b64_tr_b16 a[176:177], v25 offset:0
    v_mfma_f32_16x16x32_bf16 v[68:71], a[232:235], v[204:207], v[68:71]
    s_add_u32 s40, s40, s4
    ds_read_b64_tr_b16 a[178:179], v25 offset:4096
    v_and_b32 v240, 31, v1
    v_mfma_f32_16x16x32_bf16 v[68:71], a[228:231], v[156:159], v[68:71]
    ds_read_b64_tr_b16 a[180:181], v25 offset:8192
    v_lshrrev_b32 v241, 5, v1
    v_mfma_f32_16x16x32_bf16 v[68:71], a[224:227], v[140:143], v[68:71]
    ds_read_b64_tr_b16 a[182:183], v25 offset:12288
    v_cmp_gt_u32 vcc, 8, v240
    v_mfma_f32_16x16x32_bf16 v[68:71], a[220:223], v[180:183], v[68:71]
    ds_read_b64_tr_b16 a[184:185], v25 offset:16384
    v_mov_b32 v242, 2147483648
    v_mfma_f32_16x16x32_bf16 v[68:71], a[216:219], v[196:199], v[68:71]
    s_lshl_b32 s43, s40, 3
    ds_read_b64_tr_b16 a[186:187], v25 offset:20480
    v_mfma_f32_16x16x32_bf16 v[68:71], a[212:215], v[148:151], v[68:71]
    s_lshl_b32 s44, s3, 1
    ds_read_b64_tr_b16 a[188:189], v25 offset:24576
    v_mfma_f32_16x16x32_bf16 v[68:71], a[208:211], v[132:135], v[68:71]
    s_waitcnt lgkmcnt(13)
    s_add_u32 s43, s43, s44
    ds_read_b64_tr_b16 a[190:191], v25 offset:28672
    v_cndmask_b32 v242, v242, 0, vcc
    v_mfma_f32_16x16x32_bf16 v[72:75], a[160:163], v[128:131], 0
    s_waitcnt lgkmcnt(12)
    ds_read_b64_tr_b16 a[208:209], v22 offset:0
    v_add_u32 v7, s43, v241
    v_mfma_f32_16x16x32_bf16 v[72:75], a[164:167], v[144:147], v[72:75]
    s_waitcnt lgkmcnt(11)
    ds_read_b64_tr_b16 a[210:211], v22 offset:4096
    v_lshlrev_b32 v5, 4, v240
    v_mfma_f32_16x16x32_bf16 v[72:75], a[168:171], v[192:195], v[72:75]
    s_waitcnt lgkmcnt(10)
    ds_read_b64_tr_b16 a[212:213], v22 offset:8192
    v_lshlrev_b32 v243, 4, v241
    v_mfma_f32_16x16x32_bf16 v[72:75], a[172:175], v[176:179], v[72:75]
    s_waitcnt lgkmcnt(9)
    ds_read_b64_tr_b16 a[214:215], v22 offset:12288
    v_lshl_add_u32 v2, v240, 5, v243
    v_mfma_f32_16x16x32_bf16 v[72:75], a[176:179], v[136:139], v[72:75]
    s_waitcnt lgkmcnt(8)
    ds_read_b64_tr_b16 a[216:217], v22 offset:16384
    v_lshrrev_b32 v243, 4, v240
    v_mfma_f32_16x16x32_bf16 v[72:75], a[180:183], v[152:155], v[72:75]
    s_waitcnt lgkmcnt(7)
    ds_read_b64_tr_b16 a[218:219], v22 offset:20480
    v_mul_u32_u24 v243, 1536, v243
    v_mfma_f32_16x16x32_bf16 v[72:75], a[184:187], v[200:203], v[72:75]
    s_waitcnt lgkmcnt(6)
    ds_read_b64_tr_b16 a[220:221], v22 offset:24576
    v_add_u32 v2, v2, v243
    v_mfma_f32_16x16x32_bf16 v[72:75], a[188:191], v[184:187], v[72:75]
    s_mul_i32 s44, s43, 10304
    ds_read_b64_tr_b16 a[222:223], v22 offset:28672
    v_lshrrev_b32 v243, 2, v240
    v_mfma_f32_16x16x32_bf16 v[76:79], a[188:191], v[188:191], 0
    ds_read_b64_tr_b16 a[224:225], v26 offset:0
    v_lshlrev_b32 v243, 6, v243
    v_mfma_f32_16x16x32_bf16 v[76:79], a[184:187], v[204:207], v[76:79]
    ds_read_b64_tr_b16 a[226:227], v26 offset:4096
    v_and_b32 v241, 3, v240
    v_mfma_f32_16x16x32_bf16 v[76:79], a[180:183], v[156:159], v[76:79]
    ds_read_b64_tr_b16 a[228:229], v26 offset:8192
    v_lshl_add_u32 v3, v241, 3, v243
    v_mfma_f32_16x16x32_bf16 v[76:79], a[176:179], v[140:143], v[76:79]
    ds_read_b64_tr_b16 a[230:231], v26 offset:12288
    v_mul_u32_u24 v243, 1152, v7
    v_mfma_f32_16x16x32_bf16 v[76:79], a[172:175], v[180:183], v[76:79]
    ds_read_b64_tr_b16 a[232:233], v26 offset:16384
    v_add_u32 v4, v243, v3
    v_mfma_f32_16x16x32_bf16 v[76:79], a[168:171], v[196:199], v[76:79]
    ds_read_b64_tr_b16 a[234:235], v26 offset:20480
    v_lshl_add_u32 v6, v243, 1, v5
    v_mfma_f32_16x16x32_bf16 v[76:79], a[164:167], v[148:151], v[76:79]
    ds_read_b64_tr_b16 a[236:237], v26 offset:24576
    v_or_b32 v55, v3, v242
    v_mfma_f32_16x16x32_bf16 v[76:79], a[160:163], v[132:135], v[76:79]
    s_waitcnt lgkmcnt(13)
    ds_read_b64_tr_b16 a[238:239], v26 offset:28672
    v_or_b32 v58, v4, v242
    v_mfma_f32_16x16x32_bf16 v[80:83], a[208:211], v[128:131], 0
    s_waitcnt lgkmcnt(12)
    ds_read_b64_tr_b16 a[160:161], v23 offset:0
    v_or_b32 v59, v5, v242
    v_mfma_f32_16x16x32_bf16 v[80:83], a[212:215], v[144:147], v[80:83]
    s_waitcnt lgkmcnt(11)
    ds_read_b64_tr_b16 a[162:163], v23 offset:4096
    v_or_b32 v60, v6, v242
    v_mfma_f32_16x16x32_bf16 v[80:83], a[216:219], v[192:195], v[80:83]
    s_waitcnt lgkmcnt(10)
    ds_read_b64_tr_b16 a[164:165], v23 offset:8192
    s_waitcnt vmcnt(6)
    v_readfirstlane_b32 s36, v11
    v_mfma_f32_16x16x32_bf16 v[80:83], a[220:223], v[176:179], v[80:83]
    s_waitcnt lgkmcnt(9)
    ds_read_b64_tr_b16 a[166:167], v23 offset:12288
    v_lshrrev_b32 v243, 4, v1
    v_mfma_f32_16x16x32_bf16 v[80:83], a[224:227], v[136:139], v[80:83]
    ds_read_b64_tr_b16 a[168:169], v23 offset:16384
    v_lshlrev_b32 v243, 8, v243
    s_cmp_lg_u32 s36, s95
    s_cbranch_scc1 Lattn_xspin
Lattn_xgot:
    s_waitcnt lgkmcnt(9)
    v_mfma_f32_16x16x32_bf16 v[80:83], a[228:231], v[152:155], v[80:83]
    s_waitcnt lgkmcnt(7)
    ds_read_b64_tr_b16 a[170:171], v23 offset:20480
    v_and_b32 v241, 7, v1
    v_mfma_f32_16x16x32_bf16 v[80:83], a[232:235], v[200:203], v[80:83]
    s_waitcnt lgkmcnt(6)
    ds_read_b64_tr_b16 a[172:173], v23 offset:24576
    v_lshl_add_u32 v243, v241, 5, v243
    v_mfma_f32_16x16x32_bf16 v[80:83], a[236:239], v[184:187], v[80:83]
    s_add_u32 s37, s55, 0
    ds_read_b64_tr_b16 a[174:175], v23 offset:28672
    v_and_b32 v241, 8, v1
    v_mfma_f32_16x16x32_bf16 v[84:87], a[236:239], v[188:191], 0
    buffer_load_dwordx4 a[64:67], v252, s[28:31], s37 offen offset:0 sc1
    v_mfma_f32_16x16x32_bf16 v[84:87], a[232:235], v[204:207], v[84:87]
    ds_read_b64_tr_b16 a[176:177], v27 offset:0
    ds_read_b64_tr_b16 a[178:179], v27 offset:4096
    v_mfma_f32_16x16x32_bf16 v[84:87], a[228:231], v[156:159], v[84:87]
    buffer_load_dwordx4 a[96:99], v252, s[28:31], s37 offen offset:1024 sc1
    v_mfma_f32_16x16x32_bf16 v[84:87], a[224:227], v[140:143], v[84:87]
    ds_read_b64_tr_b16 a[180:181], v27 offset:8192
    ds_read_b64_tr_b16 a[182:183], v27 offset:12288
    v_mfma_f32_16x16x32_bf16 v[84:87], a[220:223], v[180:183], v[84:87]
    ds_read_b64_tr_b16 a[184:185], v27 offset:16384
    v_lshl_add_u32 v54, v241, 1, v243
    v_mfma_f32_16x16x32_bf16 v[84:87], a[216:219], v[196:199], v[84:87]
    s_lshr_b32 s41, s2, 3
    ds_read_b64_tr_b16 a[186:187], v27 offset:20480
    v_mfma_f32_16x16x32_bf16 v[84:87], a[212:215], v[148:151], v[84:87]
    buffer_load_dwordx4 a[80:83], v252, s[28:31], s37 offen offset:2048 sc1
    v_mfma_f32_16x16x32_bf16 v[84:87], a[208:211], v[132:135], v[84:87]
    s_waitcnt lgkmcnt(12)
    s_mov_b32 s14, 2359296
    ds_read_b64_tr_b16 a[188:189], v27 offset:24576
    ds_read_b64_tr_b16 a[190:191], v27 offset:28672
    s_barrier
    v_mfma_f32_16x16x32_bf16 v[88:91], a[160:163], v[128:131], 0
    s_waitcnt lgkmcnt(12)
    s_mov_b32 s15, 0x20000
    ds_read_b64_tr_b16 a[208:209], v12 offset:32768
    v_mfma_f32_16x16x32_bf16 v[88:91], a[164:167], v[144:147], v[88:91]
    s_waitcnt lgkmcnt(11)
    s_mov_b32 s18, 2359296
    ds_read_b64_tr_b16 a[210:211], v12 offset:36864
    v_mfma_f32_16x16x32_bf16 v[88:91], a[168:171], v[192:195], v[88:91]
    s_waitcnt lgkmcnt(10)
    buffer_load_dwordx4 a[112:115], v252, s[28:31], s37 offen offset:3072 sc1
    v_mfma_f32_16x16x32_bf16 v[88:91], a[172:175], v[176:179], v[88:91]
    s_waitcnt lgkmcnt(8)
    s_mov_b32 s19, 0x20000
    ds_read_b64_tr_b16 a[212:213], v12 offset:40960
    ds_read_b64_tr_b16 a[214:215], v12 offset:45056
    v_mfma_f32_16x16x32_bf16 v[88:91], a[176:179], v[136:139], v[88:91]
    s_waitcnt lgkmcnt(8)
    s_add_u32 s8, s50, 7864320
    s_addc_u32 s9, s51, 0
    ds_read_b64_tr_b16 a[216:217], v12 offset:49152
    v_mfma_f32_16x16x32_bf16 v[88:91], a[180:183], v[152:155], v[88:91]
    s_waitcnt lgkmcnt(7)
    s_add_u32 s37, s55, 4096
    ds_read_b64_tr_b16 a[218:219], v12 offset:53248
    v_mfma_f32_16x16x32_bf16 v[88:91], a[184:187], v[200:203], v[88:91]
    s_waitcnt lgkmcnt(6)
    s_add_u32 s49, s46, 256
    buffer_load_dwordx4 a[68:71], v252, s[28:31], s37 offen offset:0 sc1
    v_mfma_f32_16x16x32_bf16 v[88:91], a[188:191], v[184:187], v[88:91]
    s_add_u32 m0, s42, 0
    ds_read_b64_tr_b16 a[220:221], v12 offset:57344
    ds_read_b64_tr_b16 a[222:223], v12 offset:61440
    v_mfma_f32_16x16x32_bf16 v[92:95], a[188:191], v[188:191], 0
    buffer_load_dwordx4 v46, s[20:23], s49 offen lds
    v_mfma_f32_16x16x32_bf16 v[92:95], a[184:187], v[204:207], v[92:95]
    s_mov_b32 s10, 663552
    ds_read_b64_tr_b16 a[224:225], v16 offset:32768
    ds_read_b64_tr_b16 a[226:227], v16 offset:36864
    v_mfma_f32_16x16x32_bf16 v[92:95], a[180:183], v[156:159], v[92:95]
    buffer_load_dwordx4 v47, s[20:23], s49 offen offset:1024 lds
    v_mfma_f32_16x16x32_bf16 v[92:95], a[176:179], v[140:143], v[92:95]
    s_mov_b32 s11, 0x20000
    ds_read_b64_tr_b16 a[228:229], v16 offset:40960
    ds_read_b64_tr_b16 a[230:231], v16 offset:45056
    v_mfma_f32_16x16x32_bf16 v[92:95], a[172:175], v[180:183], v[92:95]
    buffer_load_dwordx4 a[100:103], v252, s[28:31], s37 offen offset:1024 sc1
    v_mfma_f32_16x16x32_bf16 v[92:95], a[168:171], v[196:199], v[92:95]
    s_lshl_b32 s39, s5, 13
    ds_read_b64_tr_b16 a[232:233], v16 offset:49152
    ds_read_b64_tr_b16 a[234:235], v16 offset:53248
    v_mfma_f32_16x16x32_bf16 v[92:95], a[164:167], v[148:151], v[92:95]
    s_add_u32 s39, s39, 8781824
    ds_read_b64_tr_b16 a[236:237], v16 offset:57344
    v_mfma_f32_16x16x32_bf16 v[92:95], a[160:163], v[132:135], v[92:95]
    s_waitcnt lgkmcnt(13)
    s_lshr_b32 s45, s4, 2
    ds_read_b64_tr_b16 a[238:239], v16 offset:61440
    v_mfma_f32_16x16x32_bf16 v[96:99], a[208:211], v[128:131], 0
    s_waitcnt lgkmcnt(12)
    buffer_load_dwordx4 v48, s[20:23], s49 offen offset:2048 lds
    v_mfma_f32_16x16x32_bf16 v[96:99], a[212:215], v[144:147], v[96:99]
    s_waitcnt lgkmcnt(10)
    s_lshl_b32 s45, s45, 11
    ds_read_b64_tr_b16 a[160:161], v13 offset:32768
    ds_read_b64_tr_b16 a[162:163], v13 offset:36864
    v_mfma_f32_16x16x32_bf16 v[96:99], a[216:219], v[192:195], v[96:99]
    s_waitcnt lgkmcnt(10)
    buffer_load_dwordx4 v49, s[20:23], s49 offen offset:3072 lds
    v_mfma_f32_16x16x32_bf16 v[96:99], a[220:223], v[176:179], v[96:99]
    s_waitcnt lgkmcnt(8)
    s_add_u32 s39, s39, s45
    ds_read_b64_tr_b16 a[164:165], v13 offset:40960
    ds_read_b64_tr_b16 a[166:167], v13 offset:45056
    v_mfma_f32_16x16x32_bf16 v[96:99], a[224:227], v[136:139], v[96:99]
    s_waitcnt lgkmcnt(8)
    buffer_load_dwordx4 a[84:87], v252, s[28:31], s37 offen offset:2048 sc1
    v_mfma_f32_16x16x32_bf16 v[96:99], a[228:231], v[152:155], v[96:99]
    s_waitcnt lgkmcnt(6)
    ds_read_b64_tr_b16 a[168:169], v13 offset:49152
    ds_read_b64_tr_b16 a[170:171], v13 offset:53248
    v_mfma_f32_16x16x32_bf16 v[96:99], a[232:235], v[200:203], v[96:99]
    s_waitcnt lgkmcnt(6)
    s_add_u32 s49, s46, 73984
    ds_read_b64_tr_b16 a[172:173], v13 offset:57344
    v_and_b32 v9, 15, v1
    v_mfma_f32_16x16x32_bf16 v[96:99], a[236:239], v[184:187], v[96:99]
    s_add_u32 m0, s42, 16384
    ds_read_b64_tr_b16 a[174:175], v13 offset:61440
    v_lshlrev_b32 v9, 7, v9
    v_mfma_f32_16x16x32_bf16 v[100:103], a[236:239], v[188:191], 0
    buffer_load_dwordx4 v46, s[20:23], s49 offen lds
    v_mfma_f32_16x16x32_bf16 v[100:103], a[232:235], v[204:207], v[100:103]
    ds_read_b64_tr_b16 a[176:177], v17 offset:32768
    ds_read_b64_tr_b16 a[178:179], v17 offset:36864
    v_mfma_f32_16x16x32_bf16 v[100:103], a[228:231], v[156:159], v[100:103]
    buffer_load_dwordx4 v47, s[20:23], s49 offen offset:1024 lds
    v_mfma_f32_16x16x32_bf16 v[100:103], a[224:227], v[140:143], v[100:103]
    ds_read_b64_tr_b16 a[180:181], v17 offset:40960
    ds_read_b64_tr_b16 a[182:183], v17 offset:45056
    v_mfma_f32_16x16x32_bf16 v[100:103], a[220:223], v[180:183], v[100:103]
    buffer_load_dwordx4 a[116:119], v252, s[28:31], s37 offen offset:3072 sc1
    v_mfma_f32_16x16x32_bf16 v[100:103], a[216:219], v[196:199], v[100:103]
    ds_read_b64_tr_b16 a[184:185], v17 offset:49152
    ds_read_b64_tr_b16 a[186:187], v17 offset:53248
    v_mfma_f32_16x16x32_bf16 v[100:103], a[212:215], v[148:151], v[100:103]
    ds_read_b64_tr_b16 a[188:189], v17 offset:57344
    v_mfma_f32_16x16x32_bf16 v[100:103], a[208:211], v[132:135], v[100:103]
    s_waitcnt lgkmcnt(13)
    ds_read_b64_tr_b16 a[190:191], v17 offset:61440
    v_mfma_f32_16x16x32_bf16 v[104:107], a[160:163], v[128:131], 0
    s_waitcnt lgkmcnt(12)
    buffer_load_dwordx4 v48, s[20:23], s49 offen offset:2048 lds
    v_mfma_f32_16x16x32_bf16 v[104:107], a[164:167], v[144:147], v[104:107]
    s_waitcnt lgkmcnt(10)
    ds_read_b64_tr_b16 a[208:209], v14 offset:32768
    ds_read_b64_tr_b16 a[210:211], v14 offset:36864
    v_mfma_f32_16x16x32_bf16 v[104:107], a[168:171], v[192:195], v[104:107]
    s_waitcnt lgkmcnt(10)
    buffer_load_dwordx4 v49, s[20:23], s49 offen offset:3072 lds
    v_mfma_f32_16x16x32_bf16 v[104:107], a[172:175], v[176:179], v[104:107]
    s_waitcnt lgkmcnt(8)
    s_add_u32 s37, s55, 8192
    ds_read_b64_tr_b16 a[212:213], v14 offset:40960
    ds_read_b64_tr_b16 a[214:215], v14 offset:45056
    v_mfma_f32_16x16x32_bf16 v[104:107], a[176:179], v[136:139], v[104:107]
    s_waitcnt lgkmcnt(8)
    buffer_load_dwordx4 a[72:75], v252, s[28:31], s37 offen offset:0 sc1
    v_mfma_f32_16x16x32_bf16 v[104:107], a[180:183], v[152:155], v[104:107]
    s_waitcnt lgkmcnt(6)
    ds_read_b64_tr_b16 a[216:217], v14 offset:49152
    ds_read_b64_tr_b16 a[218:219], v14 offset:53248
    v_mfma_f32_16x16x32_bf16 v[104:107], a[184:187], v[200:203], v[104:107]
    s_waitcnt lgkmcnt(6)
    buffer_load_dwordx4 a[104:107], v252, s[28:31], s37 offen offset:1024 sc1
    v_mfma_f32_16x16x32_bf16 v[104:107], a[188:191], v[184:187], v[104:107]
    ds_read_b64_tr_b16 a[220:221], v14 offset:57344
    ds_read_b64_tr_b16 a[222:223], v14 offset:61440
    v_mfma_f32_16x16x32_bf16 v[108:111], a[188:191], v[188:191], 0
    ds_read_b64_tr_b16 a[224:225], v18 offset:32768
    v_mfma_f32_16x16x32_bf16 v[108:111], a[184:187], v[204:207], v[108:111]
    ds_read_b64_tr_b16 a[226:227], v18 offset:36864
    v_mfma_f32_16x16x32_bf16 v[108:111], a[180:183], v[156:159], v[108:111]
Ltour0_9:
    s_cbranch_execz Lmain0
    buffer_load_dwordx4 a[88:91], v252, s[28:31], s37 offen offset:2048 sc1
    v_mfma_f32_16x16x32_bf16 v[108:111], a[176:179], v[140:143], v[108:111]
    ds_read_b64_tr_b16 a[228:229], v18 offset:40960
    ds_read_b64_tr_b16 a[230:231], v18 offset:45056
    v_mfma_f32_16x16x32_bf16 v[108:111], a[172:175], v[180:183], v[108:111]
    ds_read_b64_tr_b16 a[232:233], v18 offset:49152
    v_mfma_f32_16x16x32_bf16 v[108:111], a[168:171], v[196:199], v[108:111]
    ds_read_b64_tr_b16 a[234:235], v18 offset:53248
    v_mfma_f32_16x16x32_bf16 v[108:111], a[164:167], v[148:151], v[108:111]
    buffer_load_dwordx4 a[120:123], v252, s[28:31], s37 offen offset:3072 sc1
    v_mfma_f32_16x16x32_bf16 v[108:111], a[160:163], v[132:135], v[108:111]
    s_waitcnt lgkmcnt(12)
    ds_read_b64_tr_b16 a[236:237], v18 offset:57344
    ds_read_b64_tr_b16 a[238:239], v18 offset:61440
    v_mfma_f32_16x16x32_bf16 v[112:115], a[208:211], v[128:131], 0
    s_waitcnt lgkmcnt(12)
    ds_read_b64_tr_b16 a[160:161], v15 offset:32768
    v_mfma_f32_16x16x32_bf16 v[112:115], a[212:215], v[144:147], v[112:115]
    s_waitcnt lgkmcnt(11)
    s_add_u32 s37, s55, 12288
    ds_read_b64_tr_b16 a[162:163], v15 offset:36864
    v_mfma_f32_16x16x32_bf16 v[112:115], a[216:219], v[192:195], v[112:115]
    s_waitcnt lgkmcnt(10)
    buffer_load_dwordx4 a[76:79], v252, s[28:31], s37 offen offset:0 sc1
    v_mfma_f32_16x16x32_bf16 v[112:115], a[220:223], v[176:179], v[112:115]
    s_waitcnt lgkmcnt(8)
    ds_read_b64_tr_b16 a[164:165], v15 offset:40960
    ds_read_b64_tr_b16 a[166:167], v15 offset:45056
    v_mfma_f32_16x16x32_bf16 v[112:115], a[224:227], v[136:139], v[112:115]
    s_waitcnt lgkmcnt(8)
    buffer_load_dwordx4 a[108:111], v252, s[28:31], s37 offen offset:1024 sc1
    v_mfma_f32_16x16x32_bf16 v[112:115], a[228:231], v[152:155], v[112:115]
    s_waitcnt lgkmcnt(6)
    ds_read_b64_tr_b16 a[168:169], v15 offset:49152
    ds_read_b64_tr_b16 a[170:171], v15 offset:53248
    v_mfma_f32_16x16x32_bf16 v[112:115], a[232:235], v[200:203], v[112:115]
    s_waitcnt lgkmcnt(6)
    ds_read_b64_tr_b16 a[172:173], v15 offset:57344
    v_mfma_f32_16x16x32_bf16 v[112:115], a[236:239], v[184:187], v[112:115]
    ds_read_b64_tr_b16 a[174:175], v15 offset:61440
    v_mfma_f32_16x16x32_bf16 v[116:119], a[236:239], v[188:191], 0
    buffer_load_dwordx4 a[92:95], v252, s[28:31], s37 offen offset:2048 sc1
    v_mfma_f32_16x16x32_bf16 v[116:119], a[232:235], v[204:207], v[116:119]
    ds_read_b64_tr_b16 a[176:177], v19 offset:32768
    ds_read_b64_tr_b16 a[178:179], v19 offset:36864
    v_mfma_f32_16x16x32_bf16 v[116:119], a[228:231], v[156:159], v[116:119]
    ds_read_b64_tr_b16 a[180:181], v19 offset:40960
    v_mfma_f32_16x16x32_bf16 v[116:119], a[224:227], v[140:143], v[116:119]
    ds_read_b64_tr_b16 a[182:183], v19 offset:45056
    v_mfma_f32_16x16x32_bf16 v[116:119], a[220:223], v[180:183], v[116:119]
    buffer_load_dwordx4 a[124:127], v252, s[28:31], s37 offen offset:3072 sc1
    v_mfma_f32_16x16x32_bf16 v[116:119], a[216:219], v[196:199], v[116:119]
    ds_read_b64_tr_b16 a[184:185], v19 offset:49152
    ds_read_b64_tr_b16 a[186:187], v19 offset:53248
    v_mfma_f32_16x16x32_bf16 v[116:119], a[212:215], v[148:151], v[116:119]
    ds_read_b64_tr_b16 a[188:189], v19 offset:57344
    v_mfma_f32_16x16x32_bf16 v[116:119], a[208:211], v[132:135], v[116:119]
    ds_read_b64_tr_b16 a[190:191], v19 offset:61440
    s_waitcnt vmcnt(25)
    s_waitcnt lgkmcnt(0)
    s_barrier
    v_mfma_f32_16x16x32_bf16 v[120:123], a[160:163], v[128:131], 0
    ds_read_b64_tr_b16 a[208:209], v20 offset:32768
    v_mfma_f32_16x16x32_bf16 v[120:123], a[164:167], v[144:147], v[120:123]
    ds_read_b64_tr_b16 a[210:211], v20 offset:36864
    v_mfma_f32_16x16x32_bf16 v[120:123], a[168:171], v[192:195], v[120:123]
    ds_read_b64_tr_b16 a[212:213], v20 offset:40960
    v_mfma_f32_16x16x32_bf16 v[120:123], a[172:175], v[176:179], v[120:123]
    ds_read_b64_tr_b16 a[214:215], v20 offset:45056
    v_mfma_f32_16x16x32_bf16 v[120:123], a[176:179], v[136:139], v[120:123]
    ds_read_b64_tr_b16 a[216:217], v20 offset:49152
    v_mfma_f32_16x16x32_bf16 v[120:123], a[180:183], v[152:155], v[120:123]
    ds_read_b64_tr_b16 a[218:219], v20 offset:53248
    v_mfma_f32_16x16x32_bf16 v[120:123], a[184:187], v[200:203], v[120:123]
    s_add_u32 s49, s7, 512
    ds_read_b64_tr_b16 a[220:221], v20 offset:57344
    v_mfma_f32_16x16x32_bf16 v[120:123], a[188:191], v[184:187], v[120:123]
    s_add_u32 m0, s42, 65536
    ds_read_b64_tr_b16 a[222:223], v20 offset:61440
    v_mfma_f32_16x16x32_bf16 v[124:127], a[188:191], v[188:191], 0
    buffer_load_dwordx4 v46, s[20:23], s49 offen lds
    v_mfma_f32_16x16x32_bf16 v[124:127], a[184:187], v[204:207], v[124:127]
    ds_read_b64_tr_b16 a[224:225], v24 offset:32768
    ds_read_b64_tr_b16 a[226:227], v24 offset:36864
    v_mfma_f32_16x16x32_bf16 v[124:127], a[180:183], v[156:159], v[124:127]
    buffer_load_dwordx4 v47, s[20:23], s49 offen offset:1024 lds
    v_mfma_f32_16x16x32_bf16 v[124:127], a[176:179], v[140:143], v[124:127]
    ds_read_b64_tr_b16 a[228:229], v24 offset:40960
    ds_read_b64_tr_b16 a[230:231], v24 offset:45056
    v_mfma_f32_16x16x32_bf16 v[124:127], a[172:175], v[180:183], v[124:127]
    ds_read_b64_tr_b16 a[232:233], v24 offset:49152
    v_mfma_f32_16x16x32_bf16 v[124:127], a[168:171], v[196:199], v[124:127]
    ds_read_b64_tr_b16 a[234:235], v24 offset:53248
    v_mfma_f32_16x16x32_bf16 v[124:127], a[164:167], v[148:151], v[124:127]
    ds_read_b64_tr_b16 a[236:237], v24 offset:57344
    v_lshrrev_b32 v240, 4, v1
    v_mfma_f32_16x16x32_bf16 v[124:127], a[160:163], v[132:135], v[124:127]
    s_waitcnt vmcnt(25)
    s_waitcnt lgkmcnt(13)
    ds_read_b64_tr_b16 a[238:239], v24 offset:61440
    v_and_b32 v240, 2, v240
    v_mfma_f32_16x16x32_bf16 v[64:67], a[208:211], a[64:67], v[64:67]
    s_waitcnt vmcnt(21)
    s_waitcnt lgkmcnt(12)
    buffer_load_dwordx4 v48, s[20:23], s49 offen offset:2048 lds
    v_mfma_f32_16x16x32_bf16 v[64:67], a[212:215], a[68:71], v[64:67]
    s_waitcnt vmcnt(10)
    s_waitcnt lgkmcnt(10)
    ds_read_b64_tr_b16 a[160:161], v21 offset:32768
    ds_read_b64_tr_b16 a[162:163], v21 offset:36864
    v_mfma_f32_16x16x32_bf16 v[64:67], a[216:219], a[72:75], v[64:67]
    s_waitcnt vmcnt(6)
    s_waitcnt lgkmcnt(10)
    buffer_load_dwordx4 v49, s[20:23], s49 offen offset:3072 lds
    v_mfma_f32_16x16x32_bf16 v[64:67], a[220:223], a[76:79], v[64:67]
    s_waitcnt lgkmcnt(8)
    ds_read_b64_tr_b16 a[164:165], v21 offset:40960
    ds_read_b64_tr_b16 a[166:167], v21 offset:45056
    v_mfma_f32_16x16x32_bf16 v[64:67], a[224:227], a[80:83], v[64:67]
    s_waitcnt lgkmcnt(8)
    ds_read_b64_tr_b16 a[168:169], v21 offset:49152
    v_bfe_u32 v241, v1, 2, 2
    v_mfma_f32_16x16x32_bf16 v[64:67], a[228:231], a[84:87], v[64:67]
    s_waitcnt lgkmcnt(7)
    ds_read_b64_tr_b16 a[170:171], v21 offset:53248
    v_cmp_eq_u32 s[54:55], v240, v241
    v_mfma_f32_16x16x32_bf16 v[64:67], a[232:235], a[88:91], v[64:67]
    s_waitcnt vmcnt(5)
    s_waitcnt lgkmcnt(6)
    s_add_u32 s49, s7, 74240
    ds_read_b64_tr_b16 a[172:173], v21 offset:57344
    v_or_b32 v240, 1, v240
    v_mfma_f32_16x16x32_bf16 v[64:67], a[236:239], a[92:95], v[64:67]
    s_waitcnt vmcnt(4)
    s_add_u32 m0, s42, 81920
    ds_read_b64_tr_b16 a[174:175], v21 offset:61440
    v_cmp_eq_u32 s[36:37], v240, v241
    v_mfma_f32_16x16x32_bf16 v[68:71], a[236:239], a[124:127], v[68:71]
    buffer_load_dwordx4 v46, s[20:23], s49 offen lds
    v_mfma_f32_16x16x32_bf16 v[68:71], a[232:235], a[120:123], v[68:71]
    ds_read_b64_tr_b16 a[176:177], v25 offset:32768
    ds_read_b64_tr_b16 a[178:179], v25 offset:36864
    v_mfma_f32_16x16x32_bf16 v[68:71], a[228:231], a[116:119], v[68:71]
    buffer_load_dwordx4 v47, s[20:23], s49 offen offset:1024 lds
    v_mfma_f32_16x16x32_bf16 v[68:71], a[224:227], a[112:115], v[68:71]
    ds_read_b64_tr_b16 a[180:181], v25 offset:40960
    ds_read_b64_tr_b16 a[182:183], v25 offset:45056
    v_mfma_f32_16x16x32_bf16 v[68:71], a[220:223], a[108:111], v[68:71]
    ds_read_b64_tr_b16 a[184:185], v25 offset:49152
    v_cvt_pk_bf16_f32 v224, v64, v65
    v_mfma_f32_16x16x32_bf16 v[68:71], a[216:219], a[104:107], v[68:71]
    ds_read_b64_tr_b16 a[186:187], v25 offset:53248
    v_cvt_pk_bf16_f32 v225, v66, v67
    v_mfma_f32_16x16x32_bf16 v[68:71], a[212:215], a[100:103], v[68:71]
    buffer_load_dwordx2 v[36:37], v4, s[12:15], 0 offen offset:0
    v_mfma_f32_16x16x32_bf16 v[68:71], a[208:211], a[96:99], v[68:71]
    s_waitcnt lgkmcnt(12)
    ds_read_b64_tr_b16 a[188:189], v25 offset:57344
    ds_read_b64_tr_b16 a[190:191], v25 offset:61440
    v_mfma_f32_16x16x32_bf16 v[72:75], a[160:163], a[64:67], v[72:75]
    s_waitcnt lgkmcnt(12)
    buffer_load_dwordx4 v48, s[20:23], s49 offen offset:2048 lds
    v_mfma_f32_16x16x32_bf16 v[72:75], a[164:167], a[68:71], v[72:75]
    s_waitcnt lgkmcnt(10)
    ds_read_b64_tr_b16 a[208:209], v22 offset:32768
    ds_read_b64_tr_b16 a[210:211], v22 offset:36864
    v_mfma_f32_16x16x32_bf16 v[72:75], a[168:171], a[72:75], v[72:75]
    s_waitcnt lgkmcnt(10)
    buffer_load_dwordx4 v49, s[20:23], s49 offen offset:3072 lds
    v_mfma_f32_16x16x32_bf16 v[72:75], a[172:175], a[76:79], v[72:75]
    s_waitcnt lgkmcnt(8)
    ds_read_b64_tr_b16 a[212:213], v22 offset:40960
    ds_read_b64_tr_b16 a[214:215], v22 offset:45056
    v_mfma_f32_16x16x32_bf16 v[72:75], a[176:179], a[80:83], v[72:75]
    s_waitcnt lgkmcnt(8)
    ds_read_b64_tr_b16 a[216:217], v22 offset:49152
    v_cvt_pk_bf16_f32 v228, v68, v69
    v_mfma_f32_16x16x32_bf16 v[72:75], a[180:183], a[84:87], v[72:75]
    s_waitcnt lgkmcnt(7)
    ds_read_b64_tr_b16 a[218:219], v22 offset:53248
    v_cvt_pk_bf16_f32 v229, v70, v71
    v_mfma_f32_16x16x32_bf16 v[72:75], a[184:187], a[88:91], v[72:75]
    s_waitcnt lgkmcnt(6)
    ds_read_b64_tr_b16 a[220:221], v22 offset:57344
    v_and_b32 v240, 1, v1
    v_mfma_f32_16x16x32_bf16 v[72:75], a[188:191], a[92:95], v[72:75]
    ds_read_b64_tr_b16 a[222:223], v22 offset:61440
    v_lshlrev_b32 v240, 4, v240
    v_mfma_f32_16x16x32_bf16 v[76:79], a[188:191], a[124:127], v[76:79]
    buffer_load_dwordx2 v[38:39], v4, s[12:15], 0 offen offset:32
    v_mfma_f32_16x16x32_bf16 v[76:79], a[184:187], a[120:123], v[76:79]
    ds_read_b64_tr_b16 a[224:225], v26 offset:32768
    ds_read_b64_tr_b16 a[226:227], v26 offset:36864
    v_mfma_f32_16x16x32_bf16 v[76:79], a[180:183], a[116:119], v[76:79]
    ds_read_b64_tr_b16 a[228:229], v26 offset:40960
    v_mov_b32 v241, 0x3f80
    v_mfma_f32_16x16x32_bf16 v[76:79], a[176:179], a[112:115], v[76:79]
    ds_read_b64_tr_b16 a[230:231], v26 offset:45056
    v_lshlrev_b32 v240, v240, v241
    v_mfma_f32_16x16x32_bf16 v[76:79], a[172:175], a[108:111], v[76:79]
    ds_read_b64_tr_b16 a[232:233], v26 offset:49152
    v_cvt_pk_bf16_f32 v226, v72, v73
    v_mfma_f32_16x16x32_bf16 v[76:79], a[168:171], a[104:107], v[76:79]
    s_add_u32 s38, s93, 0
    ds_read_b64_tr_b16 a[234:235], v26 offset:53248
    v_cvt_pk_bf16_f32 v227, v74, v75
    v_mfma_f32_16x16x32_bf16 v[76:79], a[164:167], a[100:103], v[76:79]
    buffer_store_dwordx4 v[224:227], v56, s[28:31], s38 offen sc1
    v_mfma_f32_16x16x32_bf16 v[76:79], a[160:163], a[96:99], v[76:79]
    s_waitcnt lgkmcnt(12)
    ds_read_b64_tr_b16 a[236:237], v26 offset:57344
    ds_read_b64_tr_b16 a[238:239], v26 offset:61440
    v_mfma_f32_16x16x32_bf16 v[80:83], a[208:211], a[64:67], v[80:83]
    s_waitcnt lgkmcnt(12)
    ds_read_b64_tr_b16 a[160:161], v23 offset:32768
    v_bfe_i32 v241, v1, 1, 1
    v_mfma_f32_16x16x32_bf16 v[80:83], a[212:215], a[68:71], v[80:83]
    s_waitcnt lgkmcnt(11)
    ds_read_b64_tr_b16 a[162:163], v23 offset:36864
    v_and_b32 v243, v240, v241
    v_mfma_f32_16x16x32_bf16 v[80:83], a[216:219], a[72:75], v[80:83]
    s_waitcnt lgkmcnt(10)
    buffer_load_dwordx2 v[40:41], v4, s[12:15], 0 offen offset:512
    v_mfma_f32_16x16x32_bf16 v[80:83], a[220:223], a[76:79], v[80:83]
    s_waitcnt lgkmcnt(8)
    ds_read_b64_tr_b16 a[164:165], v23 offset:40960
    ds_read_b64_tr_b16 a[166:167], v23 offset:45056
    v_mfma_f32_16x16x32_bf16 v[80:83], a[224:227], a[80:83], v[80:83]
    s_waitcnt lgkmcnt(8)
    ds_read_b64_tr_b16 a[168:169], v23 offset:49152
    v_cvt_pk_bf16_f32 v230, v76, v77
    v_mfma_f32_16x16x32_bf16 v[80:83], a[228:231], a[84:87], v[80:83]
    s_waitcnt lgkmcnt(7)
    s_add_u32 s38, s93, 164864
    ds_read_b64_tr_b16 a[170:171], v23 offset:53248
    v_cvt_pk_bf16_f32 v231, v78, v79
    v_mfma_f32_16x16x32_bf16 v[80:83], a[232:235], a[88:91], v[80:83]
    s_waitcnt lgkmcnt(6)
    buffer_store_dwordx4 v[228:231], v56, s[28:31], s38 offen sc1
    v_mfma_f32_16x16x32_bf16 v[80:83], a[236:239], a[92:95], v[80:83]
    ds_read_b64_tr_b16 a[172:173], v23 offset:57344
    ds_read_b64_tr_b16 a[174:175], v23 offset:61440
    v_mfma_f32_16x16x32_bf16 v[84:87], a[236:239], a[124:127], v[84:87]
    ds_read_b64_tr_b16 a[176:177], v27 offset:32768
    v_xor_b32 v242, v240, v243
    v_mfma_f32_16x16x32_bf16 v[84:87], a[232:235], a[120:123], v[84:87]
    ds_read_b64_tr_b16 a[178:179], v27 offset:36864
    v_cndmask_b32 v246, 0, v242, s[54:55]
    v_mfma_f32_16x16x32_bf16 v[84:87], a[228:231], a[116:119], v[84:87]
    ds_read_b64_tr_b16 a[180:181], v27 offset:40960
    v_cndmask_b32 v247, 0, v243, s[54:55]
    v_mfma_f32_16x16x32_bf16 v[84:87], a[224:227], a[112:115], v[84:87]
    ds_read_b64_tr_b16 a[182:183], v27 offset:45056
    v_cndmask_b32 v250, 0, v242, s[36:37]
    v_mfma_f32_16x16x32_bf16 v[84:87], a[220:223], a[108:111], v[84:87]
    ds_read_b64_tr_b16 a[184:185], v27 offset:49152
    v_cvt_pk_bf16_f32 v232, v80, v81
    v_mfma_f32_16x16x32_bf16 v[84:87], a[216:219], a[104:107], v[84:87]
    ds_read_b64_tr_b16 a[186:187], v27 offset:53248
    v_cvt_pk_bf16_f32 v233, v82, v83
    v_mfma_f32_16x16x32_bf16 v[84:87], a[212:215], a[100:103], v[84:87]
    buffer_load_dwordx2 v[42:43], v4, s[12:15], 0 offen offset:544
    v_mfma_f32_16x16x32_bf16 v[84:87], a[208:211], a[96:99], v[84:87]
    s_waitcnt lgkmcnt(12)
    ds_read_b64_tr_b16 a[188:189], v27 offset:57344
    ds_read_b64_tr_b16 a[190:191], v27 offset:61440
    s_barrier
    v_mfma_f32_16x16x32_bf16 v[88:91], a[160:163], a[64:67], v[88:91]
    s_waitcnt lgkmcnt(12)
    ds_read_b64_tr_b16 a[208:209], v12 offset:0
    v_cndmask_b32 v251, 0, v243, s[36:37]
    v_mfma_f32_16x16x32_bf16 v[88:91], a[164:167], a[68:71], v[88:91]
    s_waitcnt lgkmcnt(11)
    ds_read_b64_tr_b16 a[210:211], v12 offset:4096
    v_mov_b32 v240, 0
    v_mfma_f32_16x16x32_bf16 v[88:91], a[168:171], a[72:75], v[88:91]
    s_waitcnt lgkmcnt(10)
    ds_read_b64_tr_b16 a[212:213], v12 offset:8192
    v_mov_b32 v241, 0
    v_mfma_f32_16x16x32_bf16 v[88:91], a[172:175], a[76:79], v[88:91]
    s_waitcnt lgkmcnt(9)
    ds_read_b64_tr_b16 a[214:215], v12 offset:12288
    v_mov_b32 v244, 0
    v_mfma_f32_16x16x32_bf16 v[88:91], a[176:179], a[80:83], v[88:91]
    s_waitcnt lgkmcnt(8)
    ds_read_b64_tr_b16 a[216:217], v12 offset:16384
    v_cvt_pk_bf16_f32 v236, v84, v85
    v_mfma_f32_16x16x32_bf16 v[88:91], a[180:183], a[84:87], v[88:91]
    s_waitcnt lgkmcnt(7)
    ds_read_b64_tr_b16 a[218:219], v12 offset:20480
    v_cvt_pk_bf16_f32 v237, v86, v87
    v_mfma_f32_16x16x32_bf16 v[88:91], a[184:187], a[88:91], v[88:91]
    s_waitcnt lgkmcnt(6)
    s_add_u32 s49, s46, 512
    ds_read_b64_tr_b16 a[220:221], v12 offset:24576
    v_mov_b32 v245, 0
    v_mfma_f32_16x16x32_bf16 v[88:91], a[188:191], a[92:95], v[88:91]
    s_add_u32 m0, s42, 32768
    ds_read_b64_tr_b16 a[222:223], v12 offset:28672
    v_mov_b32 v248, 0
    v_mfma_f32_16x16x32_bf16 v[92:95], a[188:191], a[124:127], v[92:95]
    buffer_load_dwordx4 v46, s[20:23], s49 offen lds
    v_mfma_f32_16x16x32_bf16 v[92:95], a[184:187], a[120:123], v[92:95]
    ds_read_b64_tr_b16 a[224:225], v16 offset:0
    ds_read_b64_tr_b16 a[226:227], v16 offset:4096
    v_mfma_f32_16x16x32_bf16 v[92:95], a[180:183], a[116:119], v[92:95]
    buffer_load_dwordx4 v47, s[20:23], s49 offen offset:1024 lds
    v_mfma_f32_16x16x32_bf16 v[92:95], a[176:179], a[112:115], v[92:95]
    ds_read_b64_tr_b16 a[228:229], v16 offset:8192
    ds_read_b64_tr_b16 a[230:231], v16 offset:12288
    v_mfma_f32_16x16x32_bf16 v[92:95], a[172:175], a[108:111], v[92:95]
    ds_read_b64_tr_b16 a[232:233], v16 offset:16384
    v_cvt_pk_bf16_f32 v234, v88, v89
    v_mfma_f32_16x16x32_bf16 v[92:95], a[168:171], a[104:107], v[92:95]
    s_add_u32 s38, s93, 128
    ds_read_b64_tr_b16 a[234:235], v16 offset:20480
    v_cvt_pk_bf16_f32 v235, v90, v91
    v_mfma_f32_16x16x32_bf16 v[92:95], a[164:167], a[100:103], v[92:95]
    buffer_store_dwordx4 v[232:235], v56, s[28:31], s38 offen sc1
    v_mfma_f32_16x16x32_bf16 v[92:95], a[160:163], a[96:99], v[92:95]
    s_waitcnt lgkmcnt(12)
    ds_read_b64_tr_b16 a[236:237], v16 offset:24576
    ds_read_b64_tr_b16 a[238:239], v16 offset:28672
    v_mfma_f32_16x16x32_bf16 v[96:99], a[208:211], a[64:67], v[96:99]
    s_waitcnt lgkmcnt(12)
    buffer_load_dwordx4 v48, s[20:23], s49 offen offset:2048 lds
    v_mfma_f32_16x16x32_bf16 v[96:99], a[212:215], a[68:71], v[96:99]
    s_waitcnt lgkmcnt(10)
    ds_read_b64_tr_b16 a[160:161], v13 offset:0
    ds_read_b64_tr_b16 a[162:163], v13 offset:4096
    v_mfma_f32_16x16x32_bf16 v[96:99], a[216:219], a[72:75], v[96:99]
    s_waitcnt lgkmcnt(10)
    buffer_load_dwordx4 v49, s[20:23], s49 offen offset:3072 lds
    v_mfma_f32_16x16x32_bf16 v[96:99], a[220:223], a[76:79], v[96:99]
    s_waitcnt lgkmcnt(8)
    ds_read_b64_tr_b16 a[164:165], v13 offset:8192
    ds_read_b64_tr_b16 a[166:167], v13 offset:12288
    v_mfma_f32_16x16x32_bf16 v[96:99], a[224:227], a[80:83], v[96:99]
    s_waitcnt lgkmcnt(8)
    ds_read_b64_tr_b16 a[168:169], v13 offset:16384
    v_cvt_pk_bf16_f32 v238, v92, v93
    v_mfma_f32_16x16x32_bf16 v[96:99], a[228:231], a[84:87], v[96:99]
    s_waitcnt lgkmcnt(7)
    s_add_u32 s38, s93, 164992
    ds_read_b64_tr_b16 a[170:171], v13 offset:20480
    v_cvt_pk_bf16_f32 v239, v94, v95
    v_mfma_f32_16x16x32_bf16 v[96:99], a[232:235], a[88:91], v[96:99]
    s_waitcnt lgkmcnt(6)
    s_add_u32 s49, s46, 74240
    buffer_store_dwordx4 v[236:239], v56, s[28:31], s38 offen sc1
    v_mfma_f32_16x16x32_bf16 v[96:99], a[236:239], a[92:95], v[96:99]
    s_add_u32 m0, s42, 49152
    ds_read_b64_tr_b16 a[172:173], v13 offset:24576
    ds_read_b64_tr_b16 a[174:175], v13 offset:28672
    v_mfma_f32_16x16x32_bf16 v[100:103], a[236:239], a[124:127], v[100:103]
    buffer_load_dwordx4 v46, s[20:23], s49 offen lds
    v_mfma_f32_16x16x32_bf16 v[100:103], a[232:235], a[120:123], v[100:103]
    ds_read_b64_tr_b16 a[176:177], v17 offset:0
    ds_read_b64_tr_b16 a[178:179], v17 offset:4096
    v_mfma_f32_16x16x32_bf16 v[100:103], a[228:231], a[116:119], v[100:103]
    buffer_load_dwordx4 v47, s[20:23], s49 offen offset:1024 lds
    v_mfma_f32_16x16x32_bf16 v[100:103], a[224:227], a[112:115], v[100:103]
    ds_read_b64_tr_b16 a[180:181], v17 offset:8192
    ds_read_b64_tr_b16 a[182:183], v17 offset:12288
    v_mfma_f32_16x16x32_bf16 v[100:103], a[220:223], a[108:111], v[100:103]
    ds_read_b64_tr_b16 a[184:185], v17 offset:16384
    v_cvt_pk_bf16_f32 v224, v96, v97
    v_mfma_f32_16x16x32_bf16 v[100:103], a[216:219], a[104:107], v[100:103]
    ds_read_b64_tr_b16 a[186:187], v17 offset:20480
    v_cvt_pk_bf16_f32 v225, v98, v99
    v_mfma_f32_16x16x32_bf16 v[100:103], a[212:215], a[100:103], v[100:103]
    ds_read_b64_tr_b16 a[188:189], v17 offset:24576
    v_mov_b32 v249, 0
    v_mfma_f32_16x16x32_bf16 v[100:103], a[208:211], a[96:99], v[100:103]
    s_waitcnt lgkmcnt(13)
    ds_read_b64_tr_b16 a[190:191], v17 offset:28672
    v_mov_b32 v252, 0
    v_mfma_f32_16x16x32_bf16 v[104:107], a[160:163], a[64:67], v[104:107]
    s_waitcnt lgkmcnt(12)
    buffer_load_dwordx4 v48, s[20:23], s49 offen offset:2048 lds
    v_mfma_f32_16x16x32_bf16 v[104:107], a[164:167], a[68:71], v[104:107]
    s_waitcnt lgkmcnt(10)
    ds_read_b64_tr_b16 a[208:209], v14 offset:0
    ds_read_b64_tr_b16 a[210:211], v14 offset:4096
    v_mfma_f32_16x16x32_bf16 v[104:107], a[168:171], a[72:75], v[104:107]
    s_waitcnt lgkmcnt(10)
    buffer_load_dwordx4 v49, s[20:23], s49 offen offset:3072 lds
    v_mfma_f32_16x16x32_bf16 v[104:107], a[172:175], a[76:79], v[104:107]
    s_waitcnt lgkmcnt(8)
    ds_read_b64_tr_b16 a[212:213], v14 offset:8192
    ds_read_b64_tr_b16 a[214:215], v14 offset:12288
    v_mfma_f32_16x16x32_bf16 v[104:107], a[176:179], a[80:83], v[104:107]
    s_waitcnt lgkmcnt(8)
    ds_read_b64_tr_b16 a[216:217], v14 offset:16384
    v_cvt_pk_bf16_f32 v228, v100, v101
    v_mfma_f32_16x16x32_bf16 v[104:107], a[180:183], a[84:87], v[104:107]
    s_waitcnt lgkmcnt(7)
    ds_read_b64_tr_b16 a[218:219], v14 offset:20480
    v_cvt_pk_bf16_f32 v229, v102, v103
    v_mfma_f32_16x16x32_bf16 v[104:107], a[184:187], a[88:91], v[104:107]
    s_waitcnt lgkmcnt(6)
    ds_read_b64_tr_b16 a[220:221], v14 offset:24576
    v_mov_b32 v253, 0
    v_mfma_f32_16x16x32_bf16 v[104:107], a[188:191], a[92:95], v[104:107]
    ds_read_b64_tr_b16 a[222:223], v14 offset:28672
    v_mfma_f32_16x16x32_bf16 v[108:111], a[188:191], a[124:127], v[108:111]
    ds_read_b64_tr_b16 a[224:225], v18 offset:0
    v_mfma_f32_16x16x32_bf16 v[108:111], a[184:187], a[120:123], v[108:111]
    ds_read_b64_tr_b16 a[226:227], v18 offset:4096
    v_mfma_f32_16x16x32_bf16 v[108:111], a[180:183], a[116:119], v[108:111]
    ds_read_b64_tr_b16 a[228:229], v18 offset:8192
    v_mfma_f32_16x16x32_bf16 v[108:111], a[176:179], a[112:115], v[108:111]
    ds_read_b64_tr_b16 a[230:231], v18 offset:12288
    v_mfma_f32_16x16x32_bf16 v[108:111], a[172:175], a[108:111], v[108:111]
    ds_read_b64_tr_b16 a[232:233], v18 offset:16384
    v_cvt_pk_bf16_f32 v226, v104, v105
    v_mfma_f32_16x16x32_bf16 v[108:111], a[168:171], a[104:107], v[108:111]
    s_add_u32 s38, s93, 512
    ds_read_b64_tr_b16 a[234:235], v18 offset:20480
    v_cvt_pk_bf16_f32 v227, v106, v107
    v_mfma_f32_16x16x32_bf16 v[108:111], a[164:167], a[100:103], v[108:111]
    buffer_store_dwordx4 v[224:227], v56, s[28:31], s38 offen sc1
    v_mfma_f32_16x16x32_bf16 v[108:111], a[160:163], a[96:99], v[108:111]
    s_waitcnt lgkmcnt(12)
    ds_read_b64_tr_b16 a[236:237], v18 offset:24576
    ds_read_b64_tr_b16 a[238:239], v18 offset:28672
    v_mfma_f32_16x16x32_bf16 v[112:115], a[208:211], a[64:67], v[112:115]
    s_waitcnt lgkmcnt(12)
    ds_read_b64_tr_b16 a[160:161], v15 offset:0
    v_mfma_f32_16x16x32_bf16 v[112:115], a[212:215], a[68:71], v[112:115]
    s_waitcnt lgkmcnt(11)
    ds_read_b64_tr_b16 a[162:163], v15 offset:4096
    v_mfma_f32_16x16x32_bf16 v[112:115], a[216:219], a[72:75], v[112:115]
    s_waitcnt lgkmcnt(10)
    ds_read_b64_tr_b16 a[164:165], v15 offset:8192
    v_mfma_f32_16x16x32_bf16 v[112:115], a[220:223], a[76:79], v[112:115]
    s_waitcnt lgkmcnt(9)
    ds_read_b64_tr_b16 a[166:167], v15 offset:12288
    v_mfma_f32_16x16x32_bf16 v[112:115], a[224:227], a[80:83], v[112:115]
    s_waitcnt lgkmcnt(8)
    ds_read_b64_tr_b16 a[168:169], v15 offset:16384
    v_cvt_pk_bf16_f32 v230, v108, v109
    v_mfma_f32_16x16x32_bf16 v[112:115], a[228:231], a[84:87], v[112:115]
    s_waitcnt lgkmcnt(7)
    s_add_u32 s38, s93, 165376
    ds_read_b64_tr_b16 a[170:171], v15 offset:20480
    v_cvt_pk_bf16_f32 v231, v110, v111
    v_mfma_f32_16x16x32_bf16 v[112:115], a[232:235], a[88:91], v[112:115]
    s_waitcnt lgkmcnt(6)
    buffer_store_dwordx4 v[228:231], v56, s[28:31], s38 offen sc1
    v_mfma_f32_16x16x32_bf16 v[112:115], a[236:239], a[92:95], v[112:115]
    ds_read_b64_tr_b16 a[172:173], v15 offset:24576
    ds_read_b64_tr_b16 a[174:175], v15 offset:28672
    v_mfma_f32_16x16x32_bf16 v[116:119], a[236:239], a[124:127], v[116:119]
    ds_read_b64_tr_b16 a[176:177], v19 offset:0
    v_mfma_f32_16x16x32_bf16 v[116:119], a[232:235], a[120:123], v[116:119]
    ds_read_b64_tr_b16 a[178:179], v19 offset:4096
    v_mfma_f32_16x16x32_bf16 v[116:119], a[228:231], a[116:119], v[116:119]
    ds_read_b64_tr_b16 a[180:181], v19 offset:8192
    v_mfma_f32_16x16x32_bf16 v[116:119], a[224:227], a[112:115], v[116:119]
    ds_read_b64_tr_b16 a[182:183], v19 offset:12288
    v_mfma_f32_16x16x32_bf16 v[116:119], a[220:223], a[108:111], v[116:119]
    ds_read_b64_tr_b16 a[184:185], v19 offset:16384
    v_cvt_pk_bf16_f32 v232, v112, v113
    v_mfma_f32_16x16x32_bf16 v[116:119], a[216:219], a[104:107], v[116:119]
    ds_read_b64_tr_b16 a[186:187], v19 offset:20480
    v_cvt_pk_bf16_f32 v233, v114, v115
    v_mfma_f32_16x16x32_bf16 v[116:119], a[212:215], a[100:103], v[116:119]
    ds_read_b64_tr_b16 a[188:189], v19 offset:24576
    v_mfma_f32_16x16x32_bf16 v[116:119], a[208:211], a[96:99], v[116:119]
    s_waitcnt lgkmcnt(13)
    ds_read_b64_tr_b16 a[190:191], v19 offset:28672
    s_waitcnt vmcnt(17)
    s_barrier
    v_mfma_f32_16x16x32_bf16 v[120:123], a[160:163], a[64:67], v[120:123]
    s_waitcnt lgkmcnt(12)
    ds_read_b64_tr_b16 a[208:209], v20 offset:0
    v_mfma_f32_16x16x32_bf16 v[120:123], a[164:167], a[68:71], v[120:123]
    s_waitcnt lgkmcnt(11)
    ds_read_b64_tr_b16 a[210:211], v20 offset:4096
    v_mfma_f32_16x16x32_bf16 v[120:123], a[168:171], a[72:75], v[120:123]
    s_waitcnt lgkmcnt(10)
    ds_read_b64_tr_b16 a[212:213], v20 offset:8192
    v_mfma_f32_16x16x32_bf16 v[120:123], a[172:175], a[76:79], v[120:123]
    s_waitcnt lgkmcnt(9)
    ds_read_b64_tr_b16 a[214:215], v20 offset:12288
    v_mfma_f32_16x16x32_bf16 v[120:123], a[176:179], a[80:83], v[120:123]
    s_waitcnt lgkmcnt(8)
    ds_read_b64_tr_b16 a[216:217], v20 offset:16384
    v_cvt_pk_bf16_f32 v236, v116, v117
    v_mfma_f32_16x16x32_bf16 v[120:123], a[180:183], a[84:87], v[120:123]
    s_waitcnt lgkmcnt(7)
    ds_read_b64_tr_b16 a[218:219], v20 offset:20480
    v_cvt_pk_bf16_f32 v237, v118, v119
    v_mfma_f32_16x16x32_bf16 v[120:123], a[184:187], a[88:91], v[120:123]
    s_waitcnt lgkmcnt(6)
    s_add_u32 s49, s7, 768
    ds_read_b64_tr_b16 a[220:221], v20 offset:24576
    v_mfma_f32_16x16x32_bf16 v[120:123], a[188:191], a[92:95], v[120:123]
    s_add_u32 m0, s42, 98304
    ds_read_b64_tr_b16 a[222:223], v20 offset:28672
    v_mfma_f32_16x16x32_bf16 v[124:127], a[188:191], a[124:127], v[124:127]
    buffer_load_dwordx4 v46, s[20:23], s49 offen lds
    v_mfma_f32_16x16x32_bf16 v[124:127], a[184:187], a[120:123], v[124:127]
    ds_read_b64_tr_b16 a[224:225], v24 offset:0
    ds_read_b64_tr_b16 a[226:227], v24 offset:4096
    v_mfma_f32_16x16x32_bf16 v[124:127], a[180:183], a[116:119], v[124:127]
    buffer_load_dwordx4 v47, s[20:23], s49 offen offset:1024 lds
    v_mfma_f32_16x16x32_bf16 v[124:127], a[176:179], a[112:115], v[124:127]
    ds_read_b64_tr_b16 a[228:229], v24 offset:8192
    ds_read_b64_tr_b16 a[230:231], v24 offset:12288
    v_mfma_f32_16x16x32_bf16 v[124:127], a[172:175], a[108:111], v[124:127]
    ds_read_b64_tr_b16 a[232:233], v24 offset:16384
    v_cvt_pk_bf16_f32 v234, v120, v121
    v_mfma_f32_16x16x32_bf16 v[124:127], a[168:171], a[104:107], v[124:127]
    s_add_u32 s38, s93, 640
    ds_read_b64_tr_b16 a[234:235], v24 offset:20480
    v_cvt_pk_bf16_f32 v235, v122, v123
    v_mfma_f32_16x16x32_bf16 v[124:127], a[164:167], a[100:103], v[124:127]
    buffer_store_dwordx4 v[232:235], v56, s[28:31], s38 offen sc1
    v_mfma_f32_16x16x32_bf16 v[124:127], a[160:163], a[96:99], v[124:127]
    s_waitcnt lgkmcnt(12)
    ds_read_b64_tr_b16 a[236:237], v24 offset:24576
    ds_read_b64_tr_b16 a[238:239], v24 offset:28672
    v_mfma_f32_16x16x32_bf16 v[64:67], a[208:211], v[128:131], 0
    s_waitcnt lgkmcnt(12)
    buffer_load_dwordx4 v48, s[20:23], s49 offen offset:2048 lds
    v_mfma_f32_16x16x32_bf16 v[64:67], a[212:215], v[144:147], v[64:67]
    s_waitcnt lgkmcnt(10)
    ds_read_b64_tr_b16 a[160:161], v21 offset:0
    ds_read_b64_tr_b16 a[162:163], v21 offset:4096
    v_mfma_f32_16x16x32_bf16 v[64:67], a[216:219], v[192:195], v[64:67]
    s_waitcnt lgkmcnt(10)
    buffer_load_dwordx4 v49, s[20:23], s49 offen offset:3072 lds
    v_mfma_f32_16x16x32_bf16 v[64:67], a[220:223], v[176:179], v[64:67]
    s_waitcnt lgkmcnt(8)
    ds_read_b64_tr_b16 a[164:165], v21 offset:8192
    ds_read_b64_tr_b16 a[166:167], v21 offset:12288
    v_mfma_f32_16x16x32_bf16 v[64:67], a[224:227], v[136:139], v[64:67]
    s_waitcnt lgkmcnt(8)
    ds_read_b64_tr_b16 a[168:169], v21 offset:16384
    v_cvt_pk_bf16_f32 v238, v124, v125
    v_mfma_f32_16x16x32_bf16 v[64:67], a[228:231], v[152:155], v[64:67]
    s_waitcnt lgkmcnt(7)
    s_add_u32 s38, s93, 165504
    ds_read_b64_tr_b16 a[170:171], v21 offset:20480
    v_cvt_pk_bf16_f32 v239, v126, v127
    v_mfma_f32_16x16x32_bf16 v[64:67], a[232:235], v[200:203], v[64:67]
    s_waitcnt lgkmcnt(6)
    s_add_u32 s49, s7, 74496
    buffer_store_dwordx4 v[236:239], v56, s[28:31], s38 offen sc1
    v_mfma_f32_16x16x32_bf16 v[64:67], a[236:239], v[184:187], v[64:67]
    s_add_u32 m0, s42, 114688
    ds_read_b64_tr_b16 a[172:173], v21 offset:24576
    ds_read_b64_tr_b16 a[174:175], v21 offset:28672
    v_mfma_f32_16x16x32_bf16 v[68:71], a[236:239], v[188:191], 0
    buffer_load_dwordx4 v46, s[20:23], s49 offen lds
    v_mfma_f32_16x16x32_bf16 v[68:71], a[232:235], v[204:207], v[68:71]
    ds_read_b64_tr_b16 a[176:177], v25 offset:0
    ds_read_b64_tr_b16 a[178:179], v25 offset:4096
    v_mfma_f32_16x16x32_bf16 v[68:71], a[228:231], v[156:159], v[68:71]
    buffer_load_dwordx4 v47, s[20:23], s49 offen offset:1024 lds
    v_mfma_f32_16x16x32_bf16 v[68:71], a[224:227], v[140:143], v[68:71]
    ds_read_b64_tr_b16 a[180:181], v25 offset:8192
    ds_read_b64_tr_b16 a[182:183], v25 offset:12288
    v_mfma_f32_16x16x32_bf16 v[68:71], a[220:223], v[180:183], v[68:71]
Ltour0_10:
    s_cbranch_execz Lmain0
    ds_read_b64_tr_b16 a[184:185], v25 offset:16384
    v_mfma_f32_16x16x32_bf16 v[68:71], a[216:219], v[196:199], v[68:71]
    ds_read_b64_tr_b16 a[186:187], v25 offset:20480
    v_mfma_f32_16x16x32_bf16 v[68:71], a[212:215], v[148:151], v[68:71]
    ds_read_b64_tr_b16 a[188:189], v25 offset:24576
    v_mfma_f32_16x16x32_bf16 v[68:71], a[208:211], v[132:135], v[68:71]
    s_waitcnt lgkmcnt(13)
    ds_read_b64_tr_b16 a[190:191], v25 offset:28672
    v_mfma_f32_16x16x32_bf16 v[72:75], a[160:163], v[128:131], 0
    s_waitcnt lgkmcnt(12)
    buffer_load_dwordx4 v48, s[20:23], s49 offen offset:2048 lds
    v_mfma_f32_16x16x32_bf16 v[72:75], a[164:167], v[144:147], v[72:75]
    s_waitcnt lgkmcnt(10)
    ds_read_b64_tr_b16 a[208:209], v22 offset:0
    ds_read_b64_tr_b16 a[210:211], v22 offset:4096
    v_mfma_f32_16x16x32_bf16 v[72:75], a[168:171], v[192:195], v[72:75]
    s_waitcnt lgkmcnt(10)
    buffer_load_dwordx4 v49, s[20:23], s49 offen offset:3072 lds
    v_mfma_f32_16x16x32_bf16 v[72:75], a[172:175], v[176:179], v[72:75]
    s_waitcnt lgkmcnt(8)
    ds_read_b64_tr_b16 a[212:213], v22 offset:8192
    ds_read_b64_tr_b16 a[214:215], v22 offset:12288
    v_mfma_f32_16x16x32_bf16 v[72:75], a[176:179], v[136:139], v[72:75]
    s_waitcnt lgkmcnt(8)
    ds_read_b64_tr_b16 a[216:217], v22 offset:16384
    v_mfma_f32_16x16x32_bf16 v[72:75], a[180:183], v[152:155], v[72:75]
    s_waitcnt lgkmcnt(7)
    ds_read_b64_tr_b16 a[218:219], v22 offset:20480
    v_mfma_f32_16x16x32_bf16 v[72:75], a[184:187], v[200:203], v[72:75]
    s_waitcnt lgkmcnt(6)
    ds_read_b64_tr_b16 a[220:221], v22 offset:24576
    v_mfma_f32_16x16x32_bf16 v[72:75], a[188:191], v[184:187], v[72:75]
    ds_read_b64_tr_b16 a[222:223], v22 offset:28672
    v_mfma_f32_16x16x32_bf16 v[76:79], a[188:191], v[188:191], 0
    ds_read_b64_tr_b16 a[224:225], v26 offset:0
    v_mfma_f32_16x16x32_bf16 v[76:79], a[184:187], v[204:207], v[76:79]
    ds_read_b64_tr_b16 a[226:227], v26 offset:4096
    v_mfma_f32_16x16x32_bf16 v[76:79], a[180:183], v[156:159], v[76:79]
    ds_read_b64_tr_b16 a[228:229], v26 offset:8192
    v_mfma_f32_16x16x32_bf16 v[76:79], a[176:179], v[140:143], v[76:79]
    ds_read_b64_tr_b16 a[230:231], v26 offset:12288
    v_mfma_f32_16x16x32_bf16 v[76:79], a[172:175], v[180:183], v[76:79]
    ds_read_b64_tr_b16 a[232:233], v26 offset:16384
    v_mfma_f32_16x16x32_bf16 v[76:79], a[168:171], v[196:199], v[76:79]
    ds_read_b64_tr_b16 a[234:235], v26 offset:20480
    v_mfma_f32_16x16x32_bf16 v[76:79], a[164:167], v[148:151], v[76:79]
    buffer_load_dword v63, v63, s[88:91], 0 offen sc1
    v_mfma_f32_16x16x32_bf16 v[76:79], a[160:163], v[132:135], v[76:79]
    s_waitcnt lgkmcnt(12)
    ds_read_b64_tr_b16 a[236:237], v26 offset:24576
    ds_read_b64_tr_b16 a[238:239], v26 offset:28672
    v_mfma_f32_16x16x32_bf16 v[80:83], a[208:211], v[128:131], 0
    s_waitcnt lgkmcnt(12)
    ds_read_b64_tr_b16 a[160:161], v23 offset:0
    v_mfma_f32_16x16x32_bf16 v[80:83], a[212:215], v[144:147], v[80:83]
    s_waitcnt lgkmcnt(11)
    ds_read_b64_tr_b16 a[162:163], v23 offset:4096
    v_mfma_f32_16x16x32_bf16 v[80:83], a[216:219], v[192:195], v[80:83]
    s_waitcnt lgkmcnt(10)
    ds_read_b64_tr_b16 a[164:165], v23 offset:8192
    v_mfma_f32_16x16x32_bf16 v[80:83], a[220:223], v[176:179], v[80:83]
    s_waitcnt lgkmcnt(9)
    ds_read_b64_tr_b16 a[166:167], v23 offset:12288
    v_mfma_f32_16x16x32_bf16 v[80:83], a[224:227], v[136:139], v[80:83]
    s_waitcnt lgkmcnt(8)
    ds_read_b64_tr_b16 a[168:169], v23 offset:16384
    v_mfma_f32_16x16x32_bf16 v[80:83], a[228:231], v[152:155], v[80:83]
    s_waitcnt lgkmcnt(7)
    ds_read_b64_tr_b16 a[170:171], v23 offset:20480
    v_mfma_f32_16x16x32_bf16 v[80:83], a[232:235], v[200:203], v[80:83]
    s_waitcnt lgkmcnt(6)
    ds_read_b64_tr_b16 a[172:173], v23 offset:24576
    v_mfma_f32_16x16x32_bf16 v[80:83], a[236:239], v[184:187], v[80:83]
    ds_read_b64_tr_b16 a[174:175], v23 offset:28672
    v_mfma_f32_16x16x32_bf16 v[84:87], a[236:239], v[188:191], 0
    ds_read_b64_tr_b16 a[176:177], v27 offset:0
    v_mfma_f32_16x16x32_bf16 v[84:87], a[232:235], v[204:207], v[84:87]
    ds_read_b64_tr_b16 a[178:179], v27 offset:4096
    v_mfma_f32_16x16x32_bf16 v[84:87], a[228:231], v[156:159], v[84:87]
    ds_read_b64_tr_b16 a[180:181], v27 offset:8192
    v_mfma_f32_16x16x32_bf16 v[84:87], a[224:227], v[140:143], v[84:87]
    ds_read_b64_tr_b16 a[182:183], v27 offset:12288
    v_mfma_f32_16x16x32_bf16 v[84:87], a[220:223], v[180:183], v[84:87]
    ds_read_b64_tr_b16 a[184:185], v27 offset:16384
    v_mfma_f32_16x16x32_bf16 v[84:87], a[216:219], v[196:199], v[84:87]
    ds_read_b64_tr_b16 a[186:187], v27 offset:20480
    v_mfma_f32_16x16x32_bf16 v[84:87], a[212:215], v[148:151], v[84:87]
    ds_read_b64_tr_b16 a[188:189], v27 offset:24576
    v_mfma_f32_16x16x32_bf16 v[84:87], a[208:211], v[132:135], v[84:87]
    s_waitcnt lgkmcnt(13)
    ds_read_b64_tr_b16 a[190:191], v27 offset:28672
    s_waitcnt vmcnt(13)
    s_barrier
    v_mfma_f32_16x16x32_bf16 v[88:91], a[160:163], v[128:131], 0
    s_waitcnt lgkmcnt(12)
    ds_read_b64_tr_b16 a[208:209], v12 offset:32768
    v_mfma_f32_16x16x32_bf16 v[88:91], a[164:167], v[144:147], v[88:91]
    s_waitcnt lgkmcnt(11)
    ds_read_b64_tr_b16 a[210:211], v12 offset:36864
    v_mfma_f32_16x16x32_bf16 v[88:91], a[168:171], v[192:195], v[88:91]
    s_waitcnt lgkmcnt(10)
    ds_read_b64_tr_b16 a[212:213], v12 offset:40960
    v_mfma_f32_16x16x32_bf16 v[88:91], a[172:175], v[176:179], v[88:91]
    s_waitcnt lgkmcnt(9)
    ds_read_b64_tr_b16 a[214:215], v12 offset:45056
    v_mfma_f32_16x16x32_bf16 v[88:91], a[176:179], v[136:139], v[88:91]
    s_waitcnt lgkmcnt(8)
    ds_read_b64_tr_b16 a[216:217], v12 offset:49152
    v_mfma_f32_16x16x32_bf16 v[88:91], a[180:183], v[152:155], v[88:91]
    s_waitcnt lgkmcnt(7)
    ds_read_b64_tr_b16 a[218:219], v12 offset:53248
    v_mfma_f32_16x16x32_bf16 v[88:91], a[184:187], v[200:203], v[88:91]
    s_waitcnt lgkmcnt(6)
    s_add_u32 s49, s46, 768
    ds_read_b64_tr_b16 a[220:221], v12 offset:57344
    v_mfma_f32_16x16x32_bf16 v[88:91], a[188:191], v[184:187], v[88:91]
    s_add_u32 m0, s42, 0
    ds_read_b64_tr_b16 a[222:223], v12 offset:61440
    v_mfma_f32_16x16x32_bf16 v[92:95], a[188:191], v[188:191], 0
    buffer_load_dwordx4 v46, s[20:23], s49 offen lds
    v_mfma_f32_16x16x32_bf16 v[92:95], a[184:187], v[204:207], v[92:95]
    ds_read_b64_tr_b16 a[224:225], v16 offset:32768
    ds_read_b64_tr_b16 a[226:227], v16 offset:36864
    v_mfma_f32_16x16x32_bf16 v[92:95], a[180:183], v[156:159], v[92:95]
    buffer_load_dwordx4 v47, s[20:23], s49 offen offset:1024 lds
    v_mfma_f32_16x16x32_bf16 v[92:95], a[176:179], v[140:143], v[92:95]
    ds_read_b64_tr_b16 a[228:229], v16 offset:40960
    ds_read_b64_tr_b16 a[230:231], v16 offset:45056
    v_mfma_f32_16x16x32_bf16 v[92:95], a[172:175], v[180:183], v[92:95]
    ds_read_b64_tr_b16 a[232:233], v16 offset:49152
    v_mfma_f32_16x16x32_bf16 v[92:95], a[168:171], v[196:199], v[92:95]
    ds_read_b64_tr_b16 a[234:235], v16 offset:53248
    v_mfma_f32_16x16x32_bf16 v[92:95], a[164:167], v[148:151], v[92:95]
    ds_read_b64_tr_b16 a[236:237], v16 offset:57344
    v_mfma_f32_16x16x32_bf16 v[92:95], a[160:163], v[132:135], v[92:95]
    s_waitcnt lgkmcnt(13)
    ds_read_b64_tr_b16 a[238:239], v16 offset:61440
    v_mfma_f32_16x16x32_bf16 v[64:67], a[208:211], a[64:67], v[64:67]
    s_waitcnt lgkmcnt(12)
    buffer_load_dwordx4 v48, s[20:23], s49 offen offset:2048 lds
    v_mfma_f32_16x16x32_bf16 v[64:67], a[212:215], a[68:71], v[64:67]
    s_waitcnt lgkmcnt(10)
    ds_read_b64_tr_b16 a[160:161], v13 offset:32768
    ds_read_b64_tr_b16 a[162:163], v13 offset:36864
    v_mfma_f32_16x16x32_bf16 v[64:67], a[216:219], a[72:75], v[64:67]
    s_waitcnt lgkmcnt(10)
    s_add_u32 s92, s92, 16
    buffer_load_dwordx4 v49, s[20:23], s49 offen offset:3072 lds
    v_mfma_f32_16x16x32_bf16 v[64:67], a[220:223], a[76:79], v[64:67]
    s_waitcnt lgkmcnt(8)
    s_waitcnt vmcnt(9)
    ds_read_b64_tr_b16 a[164:165], v13 offset:40960
    ds_read_b64_tr_b16 a[166:167], v13 offset:45056
    v_mfma_f32_16x16x32_bf16 v[64:67], a[224:227], a[80:83], v[64:67]
    s_waitcnt lgkmcnt(8)
    buffer_store_dword v10, v8, s[24:27], s92 offen sc1
    v_mfma_f32_16x16x32_bf16 v[64:67], a[228:231], a[84:87], v[64:67]
    s_waitcnt lgkmcnt(6)
    ds_read_b64_tr_b16 a[168:169], v13 offset:49152
    ds_read_b64_tr_b16 a[170:171], v13 offset:53248
    v_mfma_f32_16x16x32_bf16 v[64:67], a[232:235], a[88:91], v[64:67]
    s_waitcnt lgkmcnt(6)
    s_add_u32 s49, s46, 74496
    ds_read_b64_tr_b16 a[172:173], v13 offset:57344
    v_mfma_f32_16x16x32_bf16 v[64:67], a[236:239], a[92:95], v[64:67]
    s_add_u32 m0, s42, 16384
    ds_read_b64_tr_b16 a[174:175], v13 offset:61440
    v_mfma_f32_16x16x32_bf16 v[68:71], a[236:239], a[124:127], v[68:71]
    buffer_load_dwordx4 v46, s[20:23], s49 offen lds
    v_mfma_f32_16x16x32_bf16 v[68:71], a[232:235], a[120:123], v[68:71]
    ds_read_b64_tr_b16 a[176:177], v17 offset:32768
    ds_read_b64_tr_b16 a[178:179], v17 offset:36864
    v_mfma_f32_16x16x32_bf16 v[68:71], a[228:231], a[116:119], v[68:71]
    buffer_load_dwordx4 v47, s[20:23], s49 offen offset:1024 lds
    v_mfma_f32_16x16x32_bf16 v[68:71], a[224:227], a[112:115], v[68:71]
    ds_read_b64_tr_b16 a[180:181], v17 offset:40960
    ds_read_b64_tr_b16 a[182:183], v17 offset:45056
    v_mfma_f32_16x16x32_bf16 v[68:71], a[220:223], a[108:111], v[68:71]
    ds_read_b64_tr_b16 a[184:185], v17 offset:49152
    v_cvt_pk_bf16_f32 v224, v64, v65
    v_mfma_f32_16x16x32_bf16 v[68:71], a[216:219], a[104:107], v[68:71]
    ds_read_b64_tr_b16 a[186:187], v17 offset:53248
    v_cvt_pk_bf16_f32 v225, v66, v67
    v_mfma_f32_16x16x32_bf16 v[68:71], a[212:215], a[100:103], v[68:71]
    ds_read_b64_tr_b16 a[188:189], v17 offset:57344
    v_mfma_f32_16x16x32_bf16 v[68:71], a[208:211], a[96:99], v[68:71]
    s_waitcnt lgkmcnt(13)
    ds_read_b64_tr_b16 a[190:191], v17 offset:61440
    v_mfma_f32_16x16x32_bf16 v[72:75], a[160:163], a[64:67], v[72:75]
    s_waitcnt lgkmcnt(12)
    buffer_load_dwordx4 v48, s[20:23], s49 offen offset:2048 lds
    v_mfma_f32_16x16x32_bf16 v[72:75], a[164:167], a[68:71], v[72:75]
    s_waitcnt lgkmcnt(10)
    ds_read_b64_tr_b16 a[208:209], v14 offset:32768
    ds_read_b64_tr_b16 a[210:211], v14 offset:36864
    v_mfma_f32_16x16x32_bf16 v[72:75], a[168:171], a[72:75], v[72:75]
    s_waitcnt lgkmcnt(10)
    buffer_load_dwordx4 v49, s[20:23], s49 offen offset:3072 lds
    v_mfma_f32_16x16x32_bf16 v[72:75], a[172:175], a[76:79], v[72:75]
    s_waitcnt lgkmcnt(8)
    ds_read_b64_tr_b16 a[212:213], v14 offset:40960
    ds_read_b64_tr_b16 a[214:215], v14 offset:45056
    v_mfma_f32_16x16x32_bf16 v[72:75], a[176:179], a[80:83], v[72:75]
    s_waitcnt lgkmcnt(8)
    ds_read_b64_tr_b16 a[216:217], v14 offset:49152
    v_cvt_pk_bf16_f32 v228, v68, v69
    v_mfma_f32_16x16x32_bf16 v[72:75], a[180:183], a[84:87], v[72:75]
    s_waitcnt lgkmcnt(7)
    ds_read_b64_tr_b16 a[218:219], v14 offset:53248
    v_cvt_pk_bf16_f32 v229, v70, v71
    v_mfma_f32_16x16x32_bf16 v[72:75], a[184:187], a[88:91], v[72:75]
    s_waitcnt lgkmcnt(6)
    s_and_b32 s42, s2, 7
    ds_read_b64_tr_b16 a[220:221], v14 offset:57344
    v_mfma_f32_16x16x32_bf16 v[72:75], a[188:191], a[92:95], v[72:75]
    s_mov_b64 s[20:21], s[52:53]
    ds_read_b64_tr_b16 a[222:223], v14 offset:61440
    v_mfma_f32_16x16x32_bf16 v[76:79], a[188:191], a[124:127], v[76:79]
    ds_read_b64_tr_b16 a[224:225], v18 offset:32768
    s_waitcnt vmcnt(9)
    v_readfirstlane_b32 s37, v63
    v_mfma_f32_16x16x32_bf16 v[76:79], a[184:187], a[120:123], v[76:79]
    s_mov_b32 s22, 1152
    ds_read_b64_tr_b16 a[226:227], v18 offset:36864
    v_mfma_f32_16x16x32_bf16 v[76:79], a[180:183], a[116:119], v[76:79]
    s_mov_b32 s23, 0x20000
    ds_read_b64_tr_b16 a[228:229], v18 offset:40960
    s_cmp_lt_u32 s37, 256
    s_cbranch_scc1 Lattn_armwait
Lattn_armed:
    v_mfma_f32_16x16x32_bf16 v[76:79], a[176:179], a[112:115], v[76:79]
    ds_read_b64_tr_b16 a[230:231], v18 offset:45056
    v_mfma_f32_16x16x32_bf16 v[76:79], a[172:175], a[108:111], v[76:79]
    ds_read_b64_tr_b16 a[232:233], v18 offset:49152
    v_cvt_pk_bf16_f32 v226, v72, v73
    v_mfma_f32_16x16x32_bf16 v[76:79], a[168:171], a[104:107], v[76:79]
    s_add_u32 s38, s93, 1024
    ds_read_b64_tr_b16 a[234:235], v18 offset:53248
    v_cvt_pk_bf16_f32 v227, v74, v75
    v_mfma_f32_16x16x32_bf16 v[76:79], a[164:167], a[100:103], v[76:79]
    buffer_store_dwordx4 v[224:227], v56, s[28:31], s38 offen sc1
    v_mfma_f32_16x16x32_bf16 v[76:79], a[160:163], a[96:99], v[76:79]
    s_waitcnt lgkmcnt(12)
    s_mov_b32 s45, 18688
    ds_read_b64_tr_b16 a[236:237], v18 offset:57344
    ds_read_b64_tr_b16 a[238:239], v18 offset:61440
    v_mfma_f32_16x16x32_bf16 v[80:83], a[208:211], a[64:67], v[80:83]
    s_waitcnt lgkmcnt(12)
    buffer_load_dwordx4 v[160:163], v5, s[24:27], s45 offen offset:0 sc1
    v_mfma_f32_16x16x32_bf16 v[80:83], a[212:215], a[68:71], v[80:83]
    s_waitcnt lgkmcnt(10)
    ds_read_b64_tr_b16 a[160:161], v15 offset:32768
    ds_read_b64_tr_b16 a[162:163], v15 offset:36864
    v_mfma_f32_16x16x32_bf16 v[80:83], a[216:219], a[72:75], v[80:83]
    s_waitcnt lgkmcnt(10)
    buffer_load_dwordx4 v[164:167], v5, s[24:27], s45 offen offset:512 sc1
    v_mfma_f32_16x16x32_bf16 v[80:83], a[220:223], a[76:79], v[80:83]
    s_waitcnt lgkmcnt(8)
    ds_read_b64_tr_b16 a[164:165], v15 offset:40960
    ds_read_b64_tr_b16 a[166:167], v15 offset:45056
    v_mfma_f32_16x16x32_bf16 v[80:83], a[224:227], a[80:83], v[80:83]
    s_waitcnt lgkmcnt(8)
    ds_read_b64_tr_b16 a[168:169], v15 offset:49152
    v_cvt_pk_bf16_f32 v230, v76, v77
    v_mfma_f32_16x16x32_bf16 v[80:83], a[228:231], a[84:87], v[80:83]
    s_waitcnt lgkmcnt(7)
    s_add_u32 s38, s93, 165888
    ds_read_b64_tr_b16 a[170:171], v15 offset:53248
    v_cvt_pk_bf16_f32 v231, v78, v79
    v_mfma_f32_16x16x32_bf16 v[80:83], a[232:235], a[88:91], v[80:83]
    s_waitcnt lgkmcnt(6)
    buffer_store_dwordx4 v[228:231], v56, s[28:31], s38 offen sc1
    v_mfma_f32_16x16x32_bf16 v[80:83], a[236:239], a[92:95], v[80:83]
    ds_read_b64_tr_b16 a[172:173], v15 offset:57344
    ds_read_b64_tr_b16 a[174:175], v15 offset:61440
    v_mfma_f32_16x16x32_bf16 v[84:87], a[236:239], a[124:127], v[84:87]
    ds_read_b64_tr_b16 a[176:177], v19 offset:32768
    v_mfma_f32_16x16x32_bf16 v[84:87], a[232:235], a[120:123], v[84:87]
    ds_read_b64_tr_b16 a[178:179], v19 offset:36864
    v_mfma_f32_16x16x32_bf16 v[84:87], a[228:231], a[116:119], v[84:87]
    buffer_load_dwordx4 v[168:171], v59, s[24:27], s45 offen offset:1024 sc1
    v_mfma_f32_16x16x32_bf16 v[84:87], a[224:227], a[112:115], v[84:87]
    ds_read_b64_tr_b16 a[180:181], v19 offset:40960
    ds_read_b64_tr_b16 a[182:183], v19 offset:45056
    v_mfma_f32_16x16x32_bf16 v[84:87], a[220:223], a[108:111], v[84:87]
    ds_read_b64_tr_b16 a[184:185], v19 offset:49152
    v_cvt_pk_bf16_f32 v232, v80, v81
    v_mfma_f32_16x16x32_bf16 v[84:87], a[216:219], a[104:107], v[84:87]
    s_mov_b32 s45, 20992
    ds_read_b64_tr_b16 a[186:187], v19 offset:53248
    v_cvt_pk_bf16_f32 v233, v82, v83
    v_mfma_f32_16x16x32_bf16 v[84:87], a[212:215], a[100:103], v[84:87]
    buffer_load_dwordx4 v[172:175], v5, s[24:27], s45 offen offset:0 sc1
    v_mfma_f32_16x16x32_bf16 v[84:87], a[208:211], a[96:99], v[84:87]
    s_waitcnt lgkmcnt(12)
    ds_read_b64_tr_b16 a[188:189], v19 offset:57344
    ds_read_b64_tr_b16 a[190:191], v19 offset:61440
    s_barrier
    v_mfma_f32_16x16x32_bf16 v[88:91], a[160:163], a[64:67], v[88:91]
    s_waitcnt lgkmcnt(12)
    ds_read_b64_tr_b16 a[208:209], v20 offset:32768
    v_mfma_f32_16x16x32_bf16 v[88:91], a[164:167], a[68:71], v[88:91]
    s_waitcnt lgkmcnt(11)
    ds_read_b64_tr_b16 a[210:211], v20 offset:36864
    v_mfma_f32_16x16x32_bf16 v[88:91], a[168:171], a[72:75], v[88:91]
    s_waitcnt lgkmcnt(10)
    buffer_load_dwordx4 v[208:211], v5, s[24:27], s45 offen offset:512 sc1
    v_mfma_f32_16x16x32_bf16 v[88:91], a[172:175], a[76:79], v[88:91]
    s_waitcnt lgkmcnt(8)
    ds_read_b64_tr_b16 a[212:213], v20 offset:40960
    ds_read_b64_tr_b16 a[214:215], v20 offset:45056
    v_mfma_f32_16x16x32_bf16 v[88:91], a[176:179], a[80:83], v[88:91]
    s_waitcnt lgkmcnt(8)
    s_add_u32 s57, s59, 4096
    ds_read_b64_tr_b16 a[216:217], v20 offset:49152
    v_cvt_pk_bf16_f32 v236, v84, v85
    v_mfma_f32_16x16x32_bf16 v[88:91], a[180:183], a[84:87], v[88:91]
    s_waitcnt lgkmcnt(7)
    s_add_u32 m0, s6, -98304
    ds_read_b64_tr_b16 a[218:219], v20 offset:53248
    v_cvt_pk_bf16_f32 v237, v86, v87
    v_mfma_f32_16x16x32_bf16 v[88:91], a[184:187], a[88:91], v[88:91]
    s_waitcnt lgkmcnt(6)
    buffer_load_dwordx4 v255, s[84:87], s57 offen lds
    v_mfma_f32_16x16x32_bf16 v[88:91], a[188:191], a[92:95], v[88:91]
    ds_read_b64_tr_b16 a[220:221], v20 offset:57344
    ds_read_b64_tr_b16 a[222:223], v20 offset:61440
    v_mfma_f32_16x16x32_bf16 v[92:95], a[188:191], a[124:127], v[92:95]
    s_add_u32 s57, s59, 8192
    buffer_load_dwordx4 v[212:215], v59, s[24:27], s45 offen offset:1024 sc1
    v_mfma_f32_16x16x32_bf16 v[92:95], a[184:187], a[120:123], v[92:95]
    s_add_u32 m0, s6, -94208
    ds_read_b64_tr_b16 a[224:225], v24 offset:32768
    ds_read_b64_tr_b16 a[226:227], v24 offset:36864
    v_mfma_f32_16x16x32_bf16 v[92:95], a[180:183], a[116:119], v[92:95]
    buffer_load_dwordx4 v255, s[84:87], s57 offen lds
    v_mfma_f32_16x16x32_bf16 v[92:95], a[176:179], a[112:115], v[92:95]
    ds_read_b64_tr_b16 a[228:229], v24 offset:40960
    ds_read_b64_tr_b16 a[230:231], v24 offset:45056
    v_mfma_f32_16x16x32_bf16 v[92:95], a[172:175], a[108:111], v[92:95]
    ds_read_b64_tr_b16 a[232:233], v24 offset:49152
    v_cvt_pk_bf16_f32 v234, v88, v89
    v_mfma_f32_16x16x32_bf16 v[92:95], a[168:171], a[104:107], v[92:95]
    s_add_u32 s38, s93, 1152
    ds_read_b64_tr_b16 a[234:235], v24 offset:53248
    v_cvt_pk_bf16_f32 v235, v90, v91
    v_mfma_f32_16x16x32_bf16 v[92:95], a[164:167], a[100:103], v[92:95]
    buffer_store_dwordx4 v[232:235], v56, s[28:31], s38 offen sc1
    v_mfma_f32_16x16x32_bf16 v[92:95], a[160:163], a[96:99], v[92:95]
    s_waitcnt lgkmcnt(12)
    ds_read_b64_tr_b16 a[236:237], v24 offset:57344
    ds_read_b64_tr_b16 a[238:239], v24 offset:61440
    v_mfma_f32_16x16x32_bf16 v[96:99], a[208:211], v[128:131], 0
    s_waitcnt lgkmcnt(12)
    s_add_u32 s57, s59, 12288
    ds_read_b64_tr_b16 a[160:161], v21 offset:32768
    v_mfma_f32_16x16x32_bf16 v[96:99], a[212:215], v[144:147], v[96:99]
    s_waitcnt lgkmcnt(11)
    s_add_u32 m0, s6, -90112
    ds_read_b64_tr_b16 a[162:163], v21 offset:36864
    v_mfma_f32_16x16x32_bf16 v[96:99], a[216:219], v[192:195], v[96:99]
    s_waitcnt lgkmcnt(10)
    buffer_load_dwordx4 v255, s[84:87], s57 offen lds
    v_mfma_f32_16x16x32_bf16 v[96:99], a[220:223], v[176:179], v[96:99]
    s_waitcnt lgkmcnt(8)
    ds_read_b64_tr_b16 a[164:165], v21 offset:40960
    ds_read_b64_tr_b16 a[166:167], v21 offset:45056
    v_mfma_f32_16x16x32_bf16 v[96:99], a[224:227], v[136:139], v[96:99]
    s_waitcnt lgkmcnt(8)
    ds_read_b64_tr_b16 a[168:169], v21 offset:49152
    v_cvt_pk_bf16_f32 v238, v92, v93
    v_mfma_f32_16x16x32_bf16 v[96:99], a[228:231], v[152:155], v[96:99]
    s_waitcnt lgkmcnt(7)
    s_add_u32 s38, s93, 166016
    ds_read_b64_tr_b16 a[170:171], v21 offset:53248
    v_cvt_pk_bf16_f32 v239, v94, v95
    v_mfma_f32_16x16x32_bf16 v[96:99], a[232:235], v[200:203], v[96:99]
    s_waitcnt lgkmcnt(6)
    buffer_store_dwordx4 v[236:239], v56, s[28:31], s38 offen sc1
    v_mfma_f32_16x16x32_bf16 v[96:99], a[236:239], v[184:187], v[96:99]
    ds_read_b64_tr_b16 a[172:173], v21 offset:57344
    ds_read_b64_tr_b16 a[174:175], v21 offset:61440
    v_mfma_f32_16x16x32_bf16 v[100:103], a[236:239], v[188:191], 0
    s_add_u32 s57, s59, 16384
    buffer_load_dwordx2 v[92:93], v58, s[12:15], 0 offen offset:1024
    v_mfma_f32_16x16x32_bf16 v[100:103], a[232:235], v[204:207], v[100:103]
    s_add_u32 m0, s6, -86016
    ds_read_b64_tr_b16 a[176:177], v25 offset:32768
    ds_read_b64_tr_b16 a[178:179], v25 offset:36864
    v_mfma_f32_16x16x32_bf16 v[100:103], a[228:231], v[156:159], v[100:103]
    buffer_load_dwordx4 v255, s[84:87], s57 offen lds
    v_mfma_f32_16x16x32_bf16 v[100:103], a[224:227], v[140:143], v[100:103]
    ds_read_b64_tr_b16 a[180:181], v25 offset:40960
    ds_read_b64_tr_b16 a[182:183], v25 offset:45056
    v_mfma_f32_16x16x32_bf16 v[100:103], a[220:223], v[180:183], v[100:103]
    ds_read_b64_tr_b16 a[184:185], v25 offset:49152
    v_mfma_f32_16x16x32_bf16 v[100:103], a[216:219], v[196:199], v[100:103]
    ds_read_b64_tr_b16 a[186:187], v25 offset:53248
    v_mfma_f32_16x16x32_bf16 v[100:103], a[212:215], v[148:151], v[100:103]
    buffer_load_dwordx2 v[94:95], v58, s[12:15], 0 offen offset:1056
    v_mfma_f32_16x16x32_bf16 v[100:103], a[208:211], v[132:135], v[100:103]
    s_waitcnt lgkmcnt(12)
    ds_read_b64_tr_b16 a[188:189], v25 offset:57344
    ds_read_b64_tr_b16 a[190:191], v25 offset:61440
    v_mfma_f32_16x16x32_bf16 v[104:107], a[160:163], v[128:131], 0
    s_waitcnt lgkmcnt(12)
    s_add_u32 s57, s59, 20480
    ds_read_b64_tr_b16 a[208:209], v22 offset:32768
    v_mfma_f32_16x16x32_bf16 v[104:107], a[164:167], v[144:147], v[104:107]
    s_waitcnt lgkmcnt(11)
    s_add_u32 m0, s6, -81920
    ds_read_b64_tr_b16 a[210:211], v22 offset:36864
    v_mfma_f32_16x16x32_bf16 v[104:107], a[168:171], v[192:195], v[104:107]
    s_waitcnt lgkmcnt(10)
    buffer_load_dwordx4 v255, s[84:87], s57 offen lds
    v_mfma_f32_16x16x32_bf16 v[104:107], a[172:175], v[176:179], v[104:107]
    s_waitcnt lgkmcnt(8)
    s_mov_b32 s45, 19840
    ds_read_b64_tr_b16 a[212:213], v22 offset:40960
    ds_read_b64_tr_b16 a[214:215], v22 offset:45056
    v_mfma_f32_16x16x32_bf16 v[104:107], a[176:179], v[136:139], v[104:107]
    s_waitcnt lgkmcnt(8)
    s_add_u32 s57, s59, 24576
    buffer_load_dwordx4 v[64:67], v5, s[24:27], s45 offen offset:0 sc1
    v_mfma_f32_16x16x32_bf16 v[104:107], a[180:183], v[152:155], v[104:107]
    s_waitcnt lgkmcnt(6)
    s_add_u32 m0, s6, -77824
    ds_read_b64_tr_b16 a[216:217], v22 offset:49152
    ds_read_b64_tr_b16 a[218:219], v22 offset:53248
    v_mfma_f32_16x16x32_bf16 v[104:107], a[184:187], v[200:203], v[104:107]
    s_waitcnt lgkmcnt(6)
    buffer_load_dwordx4 v255, s[84:87], s57 offen lds
    v_mfma_f32_16x16x32_bf16 v[104:107], a[188:191], v[184:187], v[104:107]
    ds_read_b64_tr_b16 a[220:221], v22 offset:57344
    ds_read_b64_tr_b16 a[222:223], v22 offset:61440
    v_mfma_f32_16x16x32_bf16 v[108:111], a[188:191], v[188:191], 0
    s_add_u32 s57, s59, 28672
    ds_read_b64_tr_b16 a[224:225], v26 offset:32768
    v_mfma_f32_16x16x32_bf16 v[108:111], a[184:187], v[204:207], v[108:111]
    s_add_u32 m0, s6, -73728
    ds_read_b64_tr_b16 a[226:227], v26 offset:36864
    v_mfma_f32_16x16x32_bf16 v[108:111], a[180:183], v[156:159], v[108:111]
    buffer_load_dwordx4 v255, s[84:87], s57 offen lds
    v_mfma_f32_16x16x32_bf16 v[108:111], a[176:179], v[140:143], v[108:111]
    ds_read_b64_tr_b16 a[228:229], v26 offset:40960
    ds_read_b64_tr_b16 a[230:231], v26 offset:45056
    v_mfma_f32_16x16x32_bf16 v[108:111], a[172:175], v[180:183], v[108:111]
    s_add_u32 s57, s59, 32768
    buffer_load_dwordx4 v[68:71], v5, s[24:27], s45 offen offset:512 sc1
    v_mfma_f32_16x16x32_bf16 v[108:111], a[168:171], v[196:199], v[108:111]
    s_add_u32 m0, s6, -69632
    ds_read_b64_tr_b16 a[232:233], v26 offset:49152
    ds_read_b64_tr_b16 a[234:235], v26 offset:53248
    v_mfma_f32_16x16x32_bf16 v[108:111], a[164:167], v[148:151], v[108:111]
    buffer_load_dwordx4 v255, s[84:87], s57 offen lds
    v_mfma_f32_16x16x32_bf16 v[108:111], a[160:163], v[132:135], v[108:111]
    s_waitcnt lgkmcnt(12)
    ds_read_b64_tr_b16 a[236:237], v26 offset:57344
    ds_read_b64_tr_b16 a[238:239], v26 offset:61440
    v_mfma_f32_16x16x32_bf16 v[112:115], a[208:211], v[128:131], 0
    s_waitcnt lgkmcnt(12)
    ds_read_b64_tr_b16 a[160:161], v23 offset:32768
    v_mfma_f32_16x16x32_bf16 v[112:115], a[212:215], v[144:147], v[112:115]
    s_waitcnt lgkmcnt(11)
    ds_read_b64_tr_b16 a[162:163], v23 offset:36864
    v_mfma_f32_16x16x32_bf16 v[112:115], a[216:219], v[192:195], v[112:115]
    s_waitcnt lgkmcnt(10)
    ds_read_b64_tr_b16 a[164:165], v23 offset:40960
    v_mfma_f32_16x16x32_bf16 v[112:115], a[220:223], v[176:179], v[112:115]
    s_waitcnt lgkmcnt(9)
    ds_read_b64_tr_b16 a[166:167], v23 offset:45056
    v_mfma_f32_16x16x32_bf16 v[112:115], a[224:227], v[136:139], v[112:115]
    s_waitcnt lgkmcnt(8)
    buffer_load_dwordx4 v[72:75], v59, s[24:27], s45 offen offset:1024 sc1
    v_mfma_f32_16x16x32_bf16 v[112:115], a[228:231], v[152:155], v[112:115]
    s_waitcnt lgkmcnt(6)
    ds_read_b64_tr_b16 a[168:169], v23 offset:49152
    ds_read_b64_tr_b16 a[170:171], v23 offset:53248
    v_mfma_f32_16x16x32_bf16 v[112:115], a[232:235], v[200:203], v[112:115]
    s_waitcnt lgkmcnt(6)
    ds_read_b64_tr_b16 a[172:173], v23 offset:57344
    v_mfma_f32_16x16x32_bf16 v[112:115], a[236:239], v[184:187], v[112:115]
    ds_read_b64_tr_b16 a[174:175], v23 offset:61440
    v_mfma_f32_16x16x32_bf16 v[116:119], a[236:239], v[188:191], 0
    buffer_load_dwordx2 v[76:77], v3, s[20:23], 0 offen offset:0
    v_mfma_f32_16x16x32_bf16 v[116:119], a[232:235], v[204:207], v[116:119]
    ds_read_b64_tr_b16 a[176:177], v27 offset:32768
    ds_read_b64_tr_b16 a[178:179], v27 offset:36864
    v_mfma_f32_16x16x32_bf16 v[116:119], a[228:231], v[156:159], v[116:119]
    ds_read_b64_tr_b16 a[180:181], v27 offset:40960
    v_mfma_f32_16x16x32_bf16 v[116:119], a[224:227], v[140:143], v[116:119]
    ds_read_b64_tr_b16 a[182:183], v27 offset:45056
    v_mfma_f32_16x16x32_bf16 v[116:119], a[220:223], v[180:183], v[116:119]
    buffer_load_dwordx2 v[78:79], v3, s[20:23], 0 offen offset:32
    v_mfma_f32_16x16x32_bf16 v[116:119], a[216:219], v[196:199], v[116:119]
    ds_read_b64_tr_b16 a[184:185], v27 offset:49152
    ds_read_b64_tr_b16 a[186:187], v27 offset:53248
    v_mfma_f32_16x16x32_bf16 v[116:119], a[212:215], v[148:151], v[116:119]
    ds_read_b64_tr_b16 a[188:189], v27 offset:57344
    v_mfma_f32_16x16x32_bf16 v[116:119], a[208:211], v[132:135], v[116:119]
    ds_read_b64_tr_b16 a[190:191], v27 offset:61440
    s_waitcnt vmcnt(25)
    s_waitcnt lgkmcnt(0)
    s_barrier
    v_mfma_f32_16x16x32_bf16 v[120:123], a[160:163], v[128:131], 0
    ds_read_b64_tr_b16 a[208:209], v12 offset:0
    v_mfma_f32_16x16x32_bf16 v[120:123], a[164:167], v[144:147], v[120:123]
    ds_read_b64_tr_b16 a[210:211], v12 offset:4096
    v_mfma_f32_16x16x32_bf16 v[120:123], a[168:171], v[192:195], v[120:123]
    buffer_load_dwordx2 v[80:81], v3, s[20:23], 0 offen offset:512
    v_mfma_f32_16x16x32_bf16 v[120:123], a[172:175], v[176:179], v[120:123]
    s_add_u32 s39, s39, 16
    ds_read_b64_tr_b16 a[212:213], v12 offset:8192
    ds_read_b64_tr_b16 a[214:215], v12 offset:12288
    v_mfma_f32_16x16x32_bf16 v[120:123], a[176:179], v[136:139], v[120:123]
    buffer_load_dword v11, v9, s[24:27], s39 offen sc1
    v_mfma_f32_16x16x32_bf16 v[120:123], a[180:183], v[152:155], v[120:123]
    ds_read_b64_tr_b16 a[216:217], v12 offset:16384
    ds_read_b64_tr_b16 a[218:219], v12 offset:20480
    v_mfma_f32_16x16x32_bf16 v[120:123], a[184:187], v[200:203], v[120:123]
    ds_read_b64_tr_b16 a[220:221], v12 offset:24576
    v_mfma_f32_16x16x32_bf16 v[120:123], a[188:191], v[184:187], v[120:123]
    ds_read_b64_tr_b16 a[222:223], v12 offset:28672
    v_mfma_f32_16x16x32_bf16 v[124:127], a[188:191], v[188:191], 0
    buffer_load_dwordx2 v[82:83], v3, s[20:23], 0 offen offset:544
    v_mfma_f32_16x16x32_bf16 v[124:127], a[184:187], v[204:207], v[124:127]
    ds_read_b64_tr_b16 a[224:225], v16 offset:0
    ds_read_b64_tr_b16 a[226:227], v16 offset:4096
    v_mfma_f32_16x16x32_bf16 v[124:127], a[180:183], v[156:159], v[124:127]
    ds_read_b64_tr_b16 a[228:229], v16 offset:8192
    v_mfma_f32_16x16x32_bf16 v[124:127], a[176:179], v[140:143], v[124:127]
    ds_read_b64_tr_b16 a[230:231], v16 offset:12288
    v_mfma_f32_16x16x32_bf16 v[124:127], a[172:175], v[180:183], v[124:127]
    buffer_load_dwordx2 v[84:85], v55, s[20:23], 0 offen offset:1024
    v_mfma_f32_16x16x32_bf16 v[124:127], a[168:171], v[196:199], v[124:127]
    ds_read_b64_tr_b16 a[232:233], v16 offset:16384
    ds_read_b64_tr_b16 a[234:235], v16 offset:20480
    v_mfma_f32_16x16x32_bf16 v[124:127], a[164:167], v[148:151], v[124:127]
    ds_read_b64_tr_b16 a[236:237], v16 offset:24576
    v_mfma_f32_16x16x32_bf16 v[124:127], a[160:163], v[132:135], v[124:127]
    s_waitcnt lgkmcnt(13)
    ds_read_b64_tr_b16 a[238:239], v16 offset:28672
    v_mfma_f32_16x16x32_bf16 v[96:99], a[208:211], a[64:67], v[96:99]
    s_waitcnt lgkmcnt(12)
    buffer_load_dwordx2 v[86:87], v55, s[20:23], 0 offen offset:1056
    v_mfma_f32_16x16x32_bf16 v[96:99], a[212:215], a[68:71], v[96:99]
    s_waitcnt lgkmcnt(10)
    ds_read_b64_tr_b16 a[160:161], v13 offset:0
    ds_read_b64_tr_b16 a[162:163], v13 offset:4096
    v_mfma_f32_16x16x32_bf16 v[96:99], a[216:219], a[72:75], v[96:99]
    s_waitcnt lgkmcnt(10)
    ds_read_b64_tr_b16 a[164:165], v13 offset:8192
    v_mfma_f32_16x16x32_bf16 v[96:99], a[220:223], a[76:79], v[96:99]
    s_waitcnt lgkmcnt(9)
    ds_read_b64_tr_b16 a[166:167], v13 offset:12288
    v_mfma_f32_16x16x32_bf16 v[96:99], a[224:227], a[80:83], v[96:99]
    s_waitcnt lgkmcnt(8)
    ds_read_b64_tr_b16 a[168:169], v13 offset:16384
    v_mfma_f32_16x16x32_bf16 v[96:99], a[228:231], a[84:87], v[96:99]
    s_waitcnt lgkmcnt(7)
    s_mov_b32 s45, 22144
    ds_read_b64_tr_b16 a[170:171], v13 offset:20480
    v_mfma_f32_16x16x32_bf16 v[96:99], a[232:235], a[88:91], v[96:99]
    s_waitcnt lgkmcnt(6)
    buffer_load_dwordx4 v[216:219], v5, s[24:27], s45 offen offset:0 sc1
    v_mfma_f32_16x16x32_bf16 v[96:99], a[236:239], a[92:95], v[96:99]
Ltour0_11:
    s_cbranch_execz Lmain0
    ds_read_b64_tr_b16 a[172:173], v13 offset:24576
    ds_read_b64_tr_b16 a[174:175], v13 offset:28672
    v_mfma_f32_16x16x32_bf16 v[100:103], a[236:239], a[124:127], v[100:103]
    ds_read_b64_tr_b16 a[176:177], v17 offset:0
    v_mfma_f32_16x16x32_bf16 v[100:103], a[232:235], a[120:123], v[100:103]
    ds_read_b64_tr_b16 a[178:179], v17 offset:4096
    v_mfma_f32_16x16x32_bf16 v[100:103], a[228:231], a[116:119], v[100:103]
    buffer_load_dwordx4 v[220:223], v5, s[24:27], s45 offen offset:512 sc1
    v_mfma_f32_16x16x32_bf16 v[100:103], a[224:227], a[112:115], v[100:103]
    ds_read_b64_tr_b16 a[180:181], v17 offset:8192
    ds_read_b64_tr_b16 a[182:183], v17 offset:12288
    v_mfma_f32_16x16x32_bf16 v[100:103], a[220:223], a[108:111], v[100:103]
    ds_read_b64_tr_b16 a[184:185], v17 offset:16384
    v_cvt_pk_bf16_f32 v224, v96, v97
    v_mfma_f32_16x16x32_bf16 v[100:103], a[216:219], a[104:107], v[100:103]
    ds_read_b64_tr_b16 a[186:187], v17 offset:20480
    v_cvt_pk_bf16_f32 v225, v98, v99
    v_mfma_f32_16x16x32_bf16 v[100:103], a[212:215], a[100:103], v[100:103]
    ds_read_b64_tr_b16 a[188:189], v17 offset:24576
    v_mfma_f32_16x16x32_bf16 v[100:103], a[208:211], a[96:99], v[100:103]
    s_waitcnt lgkmcnt(13)
    ds_read_b64_tr_b16 a[190:191], v17 offset:28672
    v_mfma_f32_16x16x32_bf16 v[104:107], a[160:163], a[64:67], v[104:107]
    s_waitcnt lgkmcnt(12)
    buffer_load_dwordx4 v[88:91], v59, s[24:27], s45 offen offset:1024 sc1
    v_mfma_f32_16x16x32_bf16 v[104:107], a[164:167], a[68:71], v[104:107]
    s_waitcnt lgkmcnt(10)
    ds_read_b64_tr_b16 a[208:209], v14 offset:0
    ds_read_b64_tr_b16 a[210:211], v14 offset:4096
    v_mfma_f32_16x16x32_bf16 v[104:107], a[168:171], a[72:75], v[104:107]
    s_waitcnt lgkmcnt(10)
    ds_read_b64_tr_b16 a[212:213], v14 offset:8192
    v_mfma_f32_16x16x32_bf16 v[104:107], a[172:175], a[76:79], v[104:107]
    s_waitcnt lgkmcnt(9)
    ds_read_b64_tr_b16 a[214:215], v14 offset:12288
    v_mfma_f32_16x16x32_bf16 v[104:107], a[176:179], a[80:83], v[104:107]
    s_waitcnt lgkmcnt(8)
    ds_read_b64_tr_b16 a[216:217], v14 offset:16384
    v_cvt_pk_bf16_f32 v228, v100, v101
    v_mfma_f32_16x16x32_bf16 v[104:107], a[180:183], a[84:87], v[104:107]
    s_waitcnt lgkmcnt(7)
    ds_read_b64_tr_b16 a[218:219], v14 offset:20480
    v_cvt_pk_bf16_f32 v229, v102, v103
    v_mfma_f32_16x16x32_bf16 v[104:107], a[184:187], a[88:91], v[104:107]
    s_waitcnt lgkmcnt(6)
    ds_read_b64_tr_b16 a[220:221], v14 offset:24576
    v_mfma_f32_16x16x32_bf16 v[104:107], a[188:191], a[92:95], v[104:107]
    ds_read_b64_tr_b16 a[222:223], v14 offset:28672
    v_mfma_f32_16x16x32_bf16 v[108:111], a[188:191], a[124:127], v[108:111]
    ds_read_b64_tr_b16 a[224:225], v18 offset:0
    v_mfma_f32_16x16x32_bf16 v[108:111], a[184:187], a[120:123], v[108:111]
    ds_read_b64_tr_b16 a[226:227], v18 offset:4096
    v_mfma_f32_16x16x32_bf16 v[108:111], a[180:183], a[116:119], v[108:111]
    ds_read_b64_tr_b16 a[228:229], v18 offset:8192
    v_mfma_f32_16x16x32_bf16 v[108:111], a[176:179], a[112:115], v[108:111]
    ds_read_b64_tr_b16 a[230:231], v18 offset:12288
    v_mfma_f32_16x16x32_bf16 v[108:111], a[172:175], a[108:111], v[108:111]
    ds_read_b64_tr_b16 a[232:233], v18 offset:16384
    v_cvt_pk_bf16_f32 v226, v104, v105
    v_mfma_f32_16x16x32_bf16 v[108:111], a[168:171], a[104:107], v[108:111]
    s_add_u32 s38, s93, 1536
    ds_read_b64_tr_b16 a[234:235], v18 offset:20480
    v_cvt_pk_bf16_f32 v227, v106, v107
    v_mfma_f32_16x16x32_bf16 v[108:111], a[164:167], a[100:103], v[108:111]
    buffer_store_dwordx4 v[224:227], v56, s[28:31], s38 offen sc1
    v_mfma_f32_16x16x32_bf16 v[108:111], a[160:163], a[96:99], v[108:111]
    s_waitcnt lgkmcnt(12)
    ds_read_b64_tr_b16 a[236:237], v18 offset:24576
    ds_read_b64_tr_b16 a[238:239], v18 offset:28672
    v_mfma_f32_16x16x32_bf16 v[112:115], a[208:211], a[64:67], v[112:115]
    s_waitcnt lgkmcnt(12)
    ds_read_b64_tr_b16 a[160:161], v15 offset:0
    v_mfma_f32_16x16x32_bf16 v[112:115], a[212:215], a[68:71], v[112:115]
    s_waitcnt lgkmcnt(11)
    ds_read_b64_tr_b16 a[162:163], v15 offset:4096
    v_mfma_f32_16x16x32_bf16 v[112:115], a[216:219], a[72:75], v[112:115]
    s_waitcnt lgkmcnt(10)
    ds_read_b64_tr_b16 a[164:165], v15 offset:8192
    v_mfma_f32_16x16x32_bf16 v[112:115], a[220:223], a[76:79], v[112:115]
    s_waitcnt lgkmcnt(9)
    ds_read_b64_tr_b16 a[166:167], v15 offset:12288
    v_mfma_f32_16x16x32_bf16 v[112:115], a[224:227], a[80:83], v[112:115]
    s_waitcnt lgkmcnt(8)
    ds_read_b64_tr_b16 a[168:169], v15 offset:16384
    v_cvt_pk_bf16_f32 v230, v108, v109
    v_mfma_f32_16x16x32_bf16 v[112:115], a[228:231], a[84:87], v[112:115]
    s_waitcnt lgkmcnt(7)
    s_add_u32 s38, s93, 166400
    ds_read_b64_tr_b16 a[170:171], v15 offset:20480
    v_cvt_pk_bf16_f32 v231, v110, v111
    v_mfma_f32_16x16x32_bf16 v[112:115], a[232:235], a[88:91], v[112:115]
    s_waitcnt lgkmcnt(6)
    buffer_store_dwordx4 v[228:231], v56, s[28:31], s38 offen sc1
    v_mfma_f32_16x16x32_bf16 v[112:115], a[236:239], a[92:95], v[112:115]
    ds_read_b64_tr_b16 a[172:173], v15 offset:24576
    ds_read_b64_tr_b16 a[174:175], v15 offset:28672
    v_mfma_f32_16x16x32_bf16 v[116:119], a[236:239], a[124:127], v[116:119]
    ds_read_b64_tr_b16 a[176:177], v19 offset:0
    v_mfma_f32_16x16x32_bf16 v[116:119], a[232:235], a[120:123], v[116:119]
    ds_read_b64_tr_b16 a[178:179], v19 offset:4096
    v_mfma_f32_16x16x32_bf16 v[116:119], a[228:231], a[116:119], v[116:119]
    ds_read_b64_tr_b16 a[180:181], v19 offset:8192
    v_mfma_f32_16x16x32_bf16 v[116:119], a[224:227], a[112:115], v[116:119]
    ds_read_b64_tr_b16 a[182:183], v19 offset:12288
    v_mfma_f32_16x16x32_bf16 v[116:119], a[220:223], a[108:111], v[116:119]
    ds_read_b64_tr_b16 a[184:185], v19 offset:16384
    v_cvt_pk_bf16_f32 v232, v112, v113
    v_mfma_f32_16x16x32_bf16 v[116:119], a[216:219], a[104:107], v[116:119]
    ds_read_b64_tr_b16 a[186:187], v19 offset:20480
    v_cvt_pk_bf16_f32 v233, v114, v115
    v_mfma_f32_16x16x32_bf16 v[116:119], a[212:215], a[100:103], v[116:119]
    ds_read_b64_tr_b16 a[188:189], v19 offset:24576
    v_mfma_f32_16x16x32_bf16 v[116:119], a[208:211], a[96:99], v[116:119]
    s_waitcnt lgkmcnt(13)
    ds_read_b64_tr_b16 a[190:191], v19 offset:28672
    v_mfma_f32_16x16x32_bf16 v[120:123], a[160:163], a[64:67], v[120:123]
    s_waitcnt lgkmcnt(12)
    v_mfma_f32_16x16x32_bf16 v[120:123], a[164:167], a[68:71], v[120:123]
    s_waitcnt lgkmcnt(10)
    v_mfma_f32_16x16x32_bf16 v[120:123], a[168:171], a[72:75], v[120:123]
    s_waitcnt lgkmcnt(8)
    v_mfma_f32_16x16x32_bf16 v[120:123], a[172:175], a[76:79], v[120:123]
    s_waitcnt lgkmcnt(6)
    v_mfma_f32_16x16x32_bf16 v[120:123], a[176:179], a[80:83], v[120:123]
    s_waitcnt lgkmcnt(4)
    v_cvt_pk_bf16_f32 v236, v116, v117
    v_mfma_f32_16x16x32_bf16 v[120:123], a[180:183], a[84:87], v[120:123]
    s_waitcnt lgkmcnt(2)
    v_cvt_pk_bf16_f32 v237, v118, v119
    v_mfma_f32_16x16x32_bf16 v[120:123], a[184:187], a[88:91], v[120:123]
    s_waitcnt lgkmcnt(0)
    v_mfma_f32_16x16x32_bf16 v[120:123], a[188:191], a[92:95], v[120:123]
    v_mfma_f32_16x16x32_bf16 v[124:127], a[188:191], a[124:127], v[124:127]
    v_mfma_f32_16x16x32_bf16 v[124:127], a[184:187], a[120:123], v[124:127]
    v_mfma_f32_16x16x32_bf16 v[124:127], a[180:183], a[116:119], v[124:127]
    v_mfma_f32_16x16x32_bf16 v[124:127], a[176:179], a[112:115], v[124:127]
    v_mfma_f32_16x16x32_bf16 v[124:127], a[172:175], a[108:111], v[124:127]
    s_nop 2
    v_cvt_pk_bf16_f32 v234, v120, v121
    v_mfma_f32_16x16x32_bf16 v[124:127], a[168:171], a[104:107], v[124:127]
    s_add_u32 s38, s93, 1664
    v_cvt_pk_bf16_f32 v235, v122, v123
    v_mfma_f32_16x16x32_bf16 v[124:127], a[164:167], a[100:103], v[124:127]
    buffer_store_dwordx4 v[232:235], v56, s[28:31], s38 offen sc1
    v_mfma_f32_16x16x32_bf16 v[124:127], a[160:163], a[96:99], v[124:127]
    s_nop 7
    v_cvt_pk_bf16_f32 v238, v124, v125
    s_add_u32 s38, s93, 166528
    v_cvt_pk_bf16_f32 v239, v126, v127
    buffer_store_dwordx4 v[236:239], v56, s[28:31], s38 offen sc1
    s_add_u32 s92, s92, 16
    s_waitcnt vmcnt(35)
    v_lshlrev_b32 v96, 16, v160
    v_and_b32 v97, 0xffff0000, v160
    v_lshlrev_b32 v98, 16, v161
    v_and_b32 v99, 0xffff0000, v161
    v_lshlrev_b32 v100, 16, v162
    v_and_b32 v101, 0xffff0000, v162
    v_lshlrev_b32 v102, 16, v163
    v_and_b32 v103, 0xffff0000, v163
    s_waitcnt vmcnt(34)
    v_lshlrev_b32 v104, 16, v164
    v_and_b32 v105, 0xffff0000, v164
    v_lshlrev_b32 v106, 16, v165
    v_and_b32 v107, 0xffff0000, v165
    v_lshlrev_b32 v108, 16, v166
    v_and_b32 v109, 0xffff0000, v166
    v_lshlrev_b32 v110, 16, v167
    v_and_b32 v111, 0xffff0000, v167
    s_waitcnt vmcnt(32)
    v_lshlrev_b32 v112, 16, v168
    v_and_b32 v113, 0xffff0000, v168
    v_lshlrev_b32 v114, 16, v169
    v_and_b32 v115, 0xffff0000, v169
    v_lshlrev_b32 v116, 16, v170
    v_and_b32 v117, 0xffff0000, v170
    v_lshlrev_b32 v118, 16, v171
    v_and_b32 v119, 0xffff0000, v171
    s_waitcnt vmcnt(31)
    v_lshlrev_b32 v120, 16, v172
    v_and_b32 v121, 0xffff0000, v172
    v_lshlrev_b32 v122, 16, v173
    v_and_b32 v123, 0xffff0000, v173
    v_lshlrev_b32 v124, 16, v174
    v_and_b32 v125, 0xffff0000, v174
    v_lshlrev_b32 v126, 16, v175
    v_and_b32 v127, 0xffff0000, v175
    s_waitcnt vmcnt(30)
    v_lshlrev_b32 v128, 16, v208
    v_and_b32 v129, 0xffff0000, v208
    v_lshlrev_b32 v130, 16, v209
    v_and_b32 v131, 0xffff0000, v209
    v_lshlrev_b32 v132, 16, v210
    v_and_b32 v133, 0xffff0000, v210
    v_lshlrev_b32 v134, 16, v211
    v_and_b32 v135, 0xffff0000, v211
    s_waitcnt vmcnt(28)
    v_lshlrev_b32 v136, 16, v212
    v_and_b32 v137, 0xffff0000, v212
    v_lshlrev_b32 v138, 16, v213
    v_and_b32 v139, 0xffff0000, v213
    v_lshlrev_b32 v140, 16, v214
    v_and_b32 v141, 0xffff0000, v214
    v_lshlrev_b32 v142, 16, v215
    v_and_b32 v143, 0xffff0000, v215
    s_waitcnt vmcnt(19)
    v_lshlrev_b32 v144, 16, v64
    v_and_b32 v145, 0xffff0000, v64
    v_lshlrev_b32 v146, 16, v65
    v_and_b32 v147, 0xffff0000, v65
    v_lshlrev_b32 v148, 16, v66
    v_and_b32 v149, 0xffff0000, v66
    v_lshlrev_b32 v150, 16, v67
    v_and_b32 v151, 0xffff0000, v67
    s_waitcnt vmcnt(16)
    v_lshlrev_b32 v152, 16, v68
    v_and_b32 v153, 0xffff0000, v68
    v_lshlrev_b32 v154, 16, v69
    v_and_b32 v155, 0xffff0000, v69
    v_lshlrev_b32 v156, 16, v70
    v_and_b32 v157, 0xffff0000, v70
    v_lshlrev_b32 v158, 16, v71
    v_and_b32 v159, 0xffff0000, v71
    s_waitcnt vmcnt(14)
    v_lshlrev_b32 v160, 16, v72
    v_and_b32 v161, 0xffff0000, v72
    v_lshlrev_b32 v162, 16, v73
    v_and_b32 v163, 0xffff0000, v73
    v_lshlrev_b32 v164, 16, v74
    v_and_b32 v165, 0xffff0000, v74
    v_lshlrev_b32 v166, 16, v75
    v_and_b32 v167, 0xffff0000, v75
    s_waitcnt vmcnt(13)
    v_lshlrev_b32 v168, 16, v76
    v_and_b32 v169, 0xffff0000, v76
    v_lshlrev_b32 v170, 16, v77
    v_and_b32 v171, 0xffff0000, v77
    s_waitcnt vmcnt(12)
    v_lshlrev_b32 v172, 16, v78
    v_and_b32 v173, 0xffff0000, v78
    v_lshlrev_b32 v174, 16, v79
    v_and_b32 v175, 0xffff0000, v79
    s_waitcnt vmcnt(11)
    v_lshlrev_b32 v176, 16, v80
    v_and_b32 v177, 0xffff0000, v80
    v_lshlrev_b32 v178, 16, v81
    v_and_b32 v179, 0xffff0000, v81
    s_waitcnt vmcnt(9)
    v_lshlrev_b32 v180, 16, v82
    v_and_b32 v181, 0xffff0000, v82
    v_lshlrev_b32 v182, 16, v83
    v_and_b32 v183, 0xffff0000, v83
    s_waitcnt vmcnt(8)
    v_lshlrev_b32 v184, 16, v84
    v_and_b32 v185, 0xffff0000, v84
    v_lshlrev_b32 v186, 16, v85
    v_and_b32 v187, 0xffff0000, v85
    s_waitcnt vmcnt(7)
    v_lshlrev_b32 v188, 16, v86
    v_and_b32 v189, 0xffff0000, v86
    v_lshlrev_b32 v190, 16, v87
    v_and_b32 v191, 0xffff0000, v87
    s_waitcnt vmcnt(0)
    buffer_store_dword v10, v8, s[24:27], s92 offen sc1
    v_cmp_ne_u32 s[54:55], s95, v11
    s_cmp_lg_u64 s[54:55], 0
    s_cbranch_scc1 Ltail_spin1
Ltail_got1:
    s_add_u32 s56, s44, 16384
    buffer_load_dwordx4 a[0:3], v54, s[28:31], s56 offen offset:0 sc1
    buffer_load_dwordx4 a[4:7], v54, s[28:31], s56 offen offset:1024 sc1
    buffer_load_dwordx4 a[8:11], v54, s[28:31], s56 offen offset:2048 sc1
    buffer_load_dwordx4 a[12:15], v54, s[28:31], s56 offen offset:3072 sc1
    s_add_u32 s56, s44, 0
    buffer_load_dwordx4 a[16:19], v2, s[28:31], s56 offen offset:0 sc1
    s_add_u32 s56, s44, 4096
    buffer_load_dwordx4 a[20:23], v2, s[28:31], s56 offen offset:0 sc1
    s_add_u32 s56, s44, 8192
    buffer_load_dwordx4 a[24:27], v2, s[28:31], s56 offen offset:0 sc1
    s_add_u32 s56, s44, 12288
    buffer_load_dwordx4 a[28:31], v2, s[28:31], s56 offen offset:0 sc1
    ds_write_b128 v51, a[128:131] offset:0
    ds_write_b128 v51, a[132:135] offset:4096
    ds_write_b128 v51, a[136:139] offset:8192
    ds_write_b128 v51, a[140:143] offset:12288
    ds_write_b128 v51, a[144:147] offset:16384
    ds_write_b128 v51, a[148:151] offset:20480
    ds_write_b128 v51, a[152:155] offset:24576
    ds_write_b128 v51, a[156:159] offset:28672
    ds_write_b128 v51, a[240:243] offset:32768
    ds_write_b128 v255, a[244:247] offset:40960
    ds_write_b128 v255, a[248:251] offset:45056
    ds_write_b128 v255, a[252:255] offset:61440
    v_lshlrev_b32 v12, 16, v36
    v_and_b32 v13, 0xffff0000, v36
    v_lshlrev_b32 v14, 16, v37
    v_and_b32 v15, 0xffff0000, v37
    v_lshlrev_b32 v16, 16, v38
    v_and_b32 v17, 0xffff0000, v38
    v_lshlrev_b32 v18, 16, v39
    v_and_b32 v19, 0xffff0000, v39
    v_lshlrev_b32 v20, 16, v40
    v_and_b32 v21, 0xffff0000, v40
    v_lshlrev_b32 v22, 16, v41
    v_and_b32 v23, 0xffff0000, v41
    v_lshlrev_b32 v24, 16, v42
    v_and_b32 v25, 0xffff0000, v42
    v_lshlrev_b32 v26, 16, v43
    v_and_b32 v27, 0xffff0000, v43
    v_lshlrev_b32 v28, 16, v92
    v_and_b32 v29, 0xffff0000, v92
    v_lshlrev_b32 v30, 16, v93
    v_and_b32 v31, 0xffff0000, v93
    v_lshlrev_b32 v32, 16, v94
    v_and_b32 v33, 0xffff0000, v94
    v_lshlrev_b32 v34, 16, v95
    v_and_b32 v35, 0xffff0000, v95
    v_lshlrev_b32 v192, 16, v216
    v_and_b32 v193, 0xffff0000, v216
    v_lshlrev_b32 v194, 16, v217
    v_and_b32 v195, 0xffff0000, v217
    v_lshlrev_b32 v196, 16, v218
    v_and_b32 v197, 0xffff0000, v218
    v_lshlrev_b32 v198, 16, v219
    v_and_b32 v199, 0xffff0000, v219
    v_lshlrev_b32 v200, 16, v220
    v_and_b32 v201, 0xffff0000, v220
    v_lshlrev_b32 v202, 16, v221
    v_and_b32 v203, 0xffff0000, v221
    v_lshlrev_b32 v204, 16, v222
    v_and_b32 v205, 0xffff0000, v222
    v_lshlrev_b32 v206, 16, v223
    v_and_b32 v207, 0xffff0000, v223
    v_lshlrev_b32 v208, 16, v88
    v_and_b32 v209, 0xffff0000, v88
    v_lshlrev_b32 v210, 16, v89
    v_and_b32 v211, 0xffff0000, v89
    v_lshlrev_b32 v212, 16, v90
    v_and_b32 v213, 0xffff0000, v90
    v_lshlrev_b32 v214, 16, v91
    v_and_b32 v215, 0xffff0000, v91
    s_add_u32 s39, s39, 16
    buffer_load_dword v11, v9, s[24:27], s39 offen sc1
    s_add_u32 s56, s44, 0
    buffer_load_dwordx4 a[32:35], v2, s[28:31], s56 offen offset:512 sc1
    s_add_u32 s56, s44, 4096
    buffer_load_dwordx4 a[36:39], v2, s[28:31], s56 offen offset:512 sc1
    s_add_u32 s56, s44, 8192
    buffer_load_dwordx4 a[40:43], v2, s[28:31], s56 offen offset:512 sc1
    s_add_u32 s56, s44, 12288
    buffer_load_dwordx4 a[44:47], v2, s[28:31], s56 offen offset:512 sc1
    v_lshrrev_b32 v56, 2, v1
    v_and_b32 v57, 3, v1
    v_lshlrev_b32 v57, 3, v57
    s_and_b32 s36, s3, 1
    s_lshl_b32 s36, s36, 5
    v_lshl_add_u32 v61, v56, 6, v57
    v_add_u32 v61, s36, v61
    s_mov_b32 s36, 135168
    s_mov_b32 s37, 12288
    s_cmp_lt_u32 s3, 2
    s_cselect_b32 s36, 98304, s36
    s_cselect_b32 s37, 98304, s37
    v_add_u32 v94, s37, v61
    v_add_u32 v61, s36, v61
    v_mul_u32_u24 v95, 1152, v56
    s_lshl_b32 s36, s3, 7
    s_add_u32 s36, s36, 61440
    v_add3_u32 v95, v95, v57, s36
    s_waitcnt lgkmcnt(0)
    s_barrier
    ds_read_b64_tr_b16 a[96:97], v61 offset:0
    ds_read_b64_tr_b16 a[98:99], v61 offset:1024
    ds_read_b64_tr_b16 a[100:101], v61 offset:2048
    ds_read_b64_tr_b16 a[102:103], v61 offset:3072
    ds_read_b64_tr_b16 a[104:105], v61 offset:4096
    ds_read_b64_tr_b16 a[106:107], v61 offset:5120
    ds_read_b64_tr_b16 a[108:109], v61 offset:6144
    ds_read_b64_tr_b16 a[110:111], v61 offset:7168
    ds_read_b64_tr_b16 a[112:113], v61 offset:8192
    ds_read_b64_tr_b16 a[114:115], v61 offset:9216
    ds_read_b64_tr_b16 a[116:117], v61 offset:10240
    ds_read_b64_tr_b16 a[118:119], v61 offset:11264
    ds_read_b64_tr_b16 a[120:121], v61 offset:12288
    ds_read_b64_tr_b16 a[122:123], v61 offset:13312
    ds_read_b64_tr_b16 a[124:125], v61 offset:14336
    ds_read_b64_tr_b16 a[126:127], v61 offset:15360
    ds_read_b64_tr_b16 a[128:129], v61 offset:16384
    ds_read_b64_tr_b16 a[130:131], v61 offset:17408
    ds_read_b64_tr_b16 a[132:133], v61 offset:18432
    ds_read_b64_tr_b16 a[134:135], v61 offset:19456
    ds_read_b64_tr_b16 a[136:137], v61 offset:20480
    ds_read_b64_tr_b16 a[138:139], v61 offset:21504
    ds_read_b64_tr_b16 a[140:141], v61 offset:22528
    ds_read_b64_tr_b16 a[142:143], v61 offset:23552
    ds_read_b64_tr_b16 a[144:145], v61 offset:24576
    ds_read_b64_tr_b16 a[146:147], v61 offset:25600
    ds_read_b64_tr_b16 a[148:149], v61 offset:26624
    ds_read_b64_tr_b16 a[150:151], v61 offset:27648
    ds_read_b64_tr_b16 a[152:153], v94 offset:28672
    ds_read_b64_tr_b16 a[154:155], v94 offset:29696
    ds_read_b64_tr_b16 a[156:157], v94 offset:30720
    ds_read_b64_tr_b16 a[158:159], v94 offset:31744
    ds_read_b64_tr_b16 a[160:161], v94 offset:32768
    ds_read_b64_tr_b16 a[162:163], v94 offset:33792
    ds_read_b64_tr_b16 a[164:165], v94 offset:34816
    ds_read_b64_tr_b16 a[166:167], v94 offset:35840
    ds_read_b64_tr_b16 a[168:169], v95 offset:0
    ds_read_b64_tr_b16 a[170:171], v95 offset:18432
    ds_read_b64_tr_b16 a[172:173], v95 offset:32
    ds_read_b64_tr_b16 a[174:175], v95 offset:18464
    ds_read_b64_tr_b16 a[176:177], v95 offset:64
    ds_read_b64_tr_b16 a[178:179], v95 offset:18496
    ds_read_b64_tr_b16 a[180:181], v95 offset:96
    ds_read_b64_tr_b16 a[182:183], v95 offset:18528
    ds_read_b64_tr_b16 a[184:185], v95 offset:512
    ds_read_b64_tr_b16 a[186:187], v95 offset:18944
    ds_read_b64_tr_b16 a[188:189], v95 offset:544
    ds_read_b64_tr_b16 a[190:191], v95 offset:18976
    ds_read_b64_tr_b16 a[192:193], v95 offset:576
    ds_read_b64_tr_b16 a[194:195], v95 offset:19008
    ds_read_b64_tr_b16 a[196:197], v95 offset:608
    ds_read_b64_tr_b16 a[198:199], v95 offset:19040
    ds_read_b64_tr_b16 a[200:201], v95 offset:1024
    ds_read_b64_tr_b16 a[202:203], v95 offset:19456
    ds_read_b64_tr_b16 a[204:205], v95 offset:1056
    ds_read_b64_tr_b16 a[206:207], v95 offset:19488
    ds_read_b64_tr_b16 a[208:209], v95 offset:1088
    ds_read_b64_tr_b16 a[210:211], v95 offset:19520
    ds_read_b64_tr_b16 a[212:213], v95 offset:1120
    ds_read_b64_tr_b16 a[214:215], v95 offset:19552
    s_mov_b64 exec, 0
    s_cmp_eq_u32 s3, 0
    s_cbranch_scc1 Ltour1_0
    s_cmp_eq_u32 s3, 1
    s_cbranch_scc1 Ltour1_1
    s_cmp_eq_u32 s3, 2
    s_cbranch_scc1 Ltour1_2
    s_branch Ltour1_3
Lmain1:
    s_mov_b64 exec, -1
    v_pk_mul_f32 v[62:63], v[144:145], v[168:169]
    v_pk_mul_f32 v[168:169], v[168:169], v[120:121]
    v_pk_fma_f32 v[62:63], v[146:147], v[170:171], v[62:63]
    v_pk_mul_f32 v[170:171], v[170:171], v[122:123]
    v_pk_add_f32 v[88:89], v[168:169], v[170:171]
    v_pk_fma_f32 v[62:63], v[148:149], v[172:173], v[62:63]
    v_pk_mul_f32 v[172:173], v[172:173], v[124:125]
    v_pk_add_f32 v[88:89], v[88:89], v[172:173]
    v_pk_fma_f32 v[62:63], v[150:151], v[174:175], v[62:63]
    v_pk_mul_f32 v[174:175], v[174:175], v[126:127]
    v_pk_add_f32 v[88:89], v[88:89], v[174:175]
    v_pk_fma_f32 v[62:63], v[152:153], v[176:177], v[62:63]
    v_pk_mul_f32 v[176:177], v[176:177], v[128:129]
    v_pk_add_f32 v[88:89], v[88:89], v[176:177]
    v_pk_fma_f32 v[62:63], v[154:155], v[178:179], v[62:63]
    v_pk_mul_f32 v[178:179], v[178:179], v[130:131]
    v_pk_add_f32 v[88:89], v[88:89], v[178:179]
    v_pk_fma_f32 v[62:63], v[156:157], v[180:181], v[62:63]
    v_pk_mul_f32 v[180:181], v[180:181], v[132:133]
    v_pk_add_f32 v[88:89], v[88:89], v[180:181]
    v_pk_fma_f32 v[62:63], v[158:159], v[182:183], v[62:63]
    v_pk_mul_f32 v[182:183], v[182:183], v[134:135]
    v_pk_add_f32 v[88:89], v[88:89], v[182:183]
    v_pk_fma_f32 v[62:63], v[160:161], v[184:185], v[62:63]
    v_pk_mul_f32 v[184:185], v[184:185], v[136:137]
    v_pk_add_f32 v[88:89], v[88:89], v[184:185]
    v_pk_fma_f32 v[62:63], v[162:163], v[186:187], v[62:63]
    v_pk_mul_f32 v[186:187], v[186:187], v[138:139]
    v_pk_add_f32 v[88:89], v[88:89], v[186:187]
    v_pk_fma_f32 v[62:63], v[164:165], v[188:189], v[62:63]
    v_pk_mul_f32 v[188:189], v[188:189], v[140:141]
    v_pk_add_f32 v[88:89], v[88:89], v[188:189]
    v_pk_fma_f32 v[62:63], v[166:167], v[190:191], v[62:63]
    v_pk_mul_f32 v[190:191], v[190:191], v[142:143]
    v_pk_add_f32 v[88:89], v[88:89], v[190:191]
    v_add_f32 v91, v62, v63
    v_add_f32 v90, v88, v89
    s_nop 1
    v_add_f32_dpp v90, v90, v90 row_ror:8 row_mask:0xf bank_mask:0xf
    v_add_f32_dpp v91, v91, v91 row_ror:8 row_mask:0xf bank_mask:0xf
    s_nop 0
    v_add_f32_dpp v90, v90, v90 row_ror:4 row_mask:0xf bank_mask:0xf
    v_add_f32_dpp v91, v91, v91 row_ror:4 row_mask:0xf bank_mask:0xf
    s_nop 0
    v_add_f32_dpp v90, v90, v90 row_ror:2 row_mask:0xf bank_mask:0xf
    v_add_f32_dpp v91, v91, v91 row_ror:2 row_mask:0xf bank_mask:0xf
    s_nop 0
    v_add_f32_dpp v90, v90, v90 row_ror:1 row_mask:0xf bank_mask:0xf
    v_add_f32_dpp v91, v91, v91 row_ror:1 row_mask:0xf bank_mask:0xf
    v_mov_b32 v62, v90
    v_mov_b32 v63, v91
    s_nop 0
    v_permlane16_swap_b32 v90, v62
    v_permlane16_swap_b32 v91, v63
    v_add_f32 v90, v90, v62
    v_add_f32 v91, v91, v63
    v_lshlrev_b32 v92, 2, v7
    v_and_b32 v92, 28, v92
    v_sub_u32 v93, 2047, v7
    s_waitcnt vmcnt(12)
    v_mfma_f32_16x16x32_bf16 v[80:83], v[242:245], a[0:3], 0
    v_mfma_f32_16x16x32_bf16 v[84:87], v[240:243], a[0:3], 0
    s_waitcnt vmcnt(11)
    v_mfma_f32_16x16x32_bf16 v[80:83], v[242:245], a[4:7], v[80:83]
    v_mfma_f32_16x16x32_bf16 v[84:87], v[240:243], a[4:7], v[84:87]
    s_waitcnt vmcnt(10)
    v_mfma_f32_16x16x32_bf16 v[80:83], v[242:245], a[8:11], v[80:83]
    v_mfma_f32_16x16x32_bf16 v[84:87], v[240:243], a[8:11], v[84:87]
    s_waitcnt vmcnt(9)
    v_mfma_f32_16x16x32_bf16 v[80:83], v[242:245], a[12:15], v[80:83]
    v_mfma_f32_16x16x32_bf16 v[84:87], v[240:243], a[12:15], v[84:87]
    s_waitcnt vmcnt(8)
    s_nop 5
    v_mov_b32_dpp v80, v80 row_ror:8 row_mask:0x4 bank_mask:0xf
    v_mov_b32_dpp v81, v81 row_ror:8 row_mask:0x4 bank_mask:0xf
    v_mov_b32_dpp v82, v82 row_ror:8 row_mask:0x4 bank_mask:0xf
    v_mov_b32_dpp v83, v83 row_ror:8 row_mask:0x4 bank_mask:0xf
    v_mov_b32_dpp v84, v84 row_ror:8 row_mask:0x4 bank_mask:0xf
    v_mov_b32_dpp v85, v85 row_ror:8 row_mask:0x4 bank_mask:0xf
    v_mov_b32_dpp v86, v86 row_ror:8 row_mask:0x4 bank_mask:0xf
    v_mov_b32_dpp v87, v87 row_ror:8 row_mask:0x4 bank_mask:0xf
    v_pk_fma_f32 v[28:29], v[112:113], v[80:81], v[28:29]
    v_pk_fma_f32 v[30:31], v[114:115], v[82:83], v[30:31]
    v_pk_fma_f32 v[32:33], v[116:117], v[84:85], v[32:33]
    v_pk_fma_f32 v[34:35], v[118:119], v[86:87], v[34:35]
    v_cvt_pk_bf16_f32 v44, v28, v29
    v_cvt_pk_bf16_f32 v45, v30, v31
    v_cvt_pk_bf16_f32 v46, v32, v33
    v_cvt_pk_bf16_f32 v47, v34, v35
    v_lshlrev_b32 v28, 16, v44
    v_and_b32 v29, 0xffff0000, v44
    v_lshlrev_b32 v30, 16, v45
    v_and_b32 v31, 0xffff0000, v45
    v_lshlrev_b32 v32, 16, v46
    v_and_b32 v33, 0xffff0000, v46
    v_lshlrev_b32 v34, 16, v47
    v_and_b32 v35, 0xffff0000, v47
    v_mfma_f32_16x16x32_bf16 v[64:67], v[246:249], a[16:19], 0
    v_mfma_f32_16x16x32_bf16 v[68:71], v[244:247], a[16:19], 0
    s_waitcnt vmcnt(7)
    v_mfma_f32_16x16x32_bf16 v[64:67], v[246:249], a[20:23], v[64:67]
    v_mfma_f32_16x16x32_bf16 v[68:71], v[244:247], a[20:23], v[68:71]
    s_waitcnt vmcnt(6)
    v_mfma_f32_16x16x32_bf16 v[64:67], v[246:249], a[24:27], v[64:67]
    v_mfma_f32_16x16x32_bf16 v[68:71], v[244:247], a[24:27], v[68:71]
    s_waitcnt vmcnt(5)
    v_mfma_f32_16x16x32_bf16 v[64:67], v[246:249], a[28:31], v[64:67]
    v_mfma_f32_16x16x32_bf16 v[68:71], v[244:247], a[28:31], v[68:71]
    s_waitcnt vmcnt(4)
    v_cmp_ne_u32 s[54:55], s95, v11
    s_cmp_lg_u64 s[54:55], 0
    s_cbranch_scc1 Ltail_spin2
Ltail_got2:
    s_add_u32 s56, s44, 0
    buffer_load_dwordx4 a[48:51], v2, s[28:31], s56 offen offset:1024 sc1
    s_add_u32 s56, s44, 4096
    buffer_load_dwordx4 a[52:55], v2, s[28:31], s56 offen offset:1024 sc1
    s_add_u32 s56, s44, 8192
    buffer_load_dwordx4 a[56:59], v2, s[28:31], s56 offen offset:1024 sc1
    s_add_u32 s56, s44, 12288
    buffer_load_dwordx4 a[60:63], v2, s[28:31], s56 offen offset:1024 sc1
    s_add_u32 s56, s44, 0
    buffer_load_dwordx4 a[64:67], v2, s[28:31], s56 offen offset:1536 sc1
    s_add_u32 s56, s44, 4096
    buffer_load_dwordx4 a[68:71], v2, s[28:31], s56 offen offset:1536 sc1
    s_add_u32 s56, s44, 8192
    buffer_load_dwordx4 a[72:75], v2, s[28:31], s56 offen offset:1536 sc1
    s_add_u32 s56, s44, 12288
    buffer_load_dwordx4 a[76:79], v2, s[28:31], s56 offen offset:1536 sc1
    s_movk_i32 s48, 0x7ff
    s_waitcnt vmcnt(11)
    v_mfma_f32_16x16x32_bf16 v[64:67], v[250:253], a[32:35], v[64:67]
    v_mfma_f32_16x16x32_bf16 v[68:71], v[248:251], a[32:35], v[68:71]
    s_waitcnt vmcnt(10)
    v_mfma_f32_16x16x32_bf16 v[64:67], v[250:253], a[36:39], v[64:67]
    v_mfma_f32_16x16x32_bf16 v[68:71], v[248:251], a[36:39], v[68:71]
    s_waitcnt vmcnt(9)
    v_mfma_f32_16x16x32_bf16 v[64:67], v[250:253], a[40:43], v[64:67]
    v_mfma_f32_16x16x32_bf16 v[68:71], v[248:251], a[40:43], v[68:71]
    s_waitcnt vmcnt(8)
    v_mfma_f32_16x16x32_bf16 v[64:67], v[250:253], a[44:47], v[64:67]
    v_mfma_f32_16x16x32_bf16 v[68:71], v[248:251], a[44:47], v[68:71]
    s_waitcnt vmcnt(7)
    s_nop 5
    v_pk_fma_f32 v[12:13], v[96:97], v[64:65], v[12:13]
    v_pk_fma_f32 v[14:15], v[98:99], v[66:67], v[14:15]
    v_pk_fma_f32 v[16:17], v[100:101], v[68:69], v[16:17]
    v_pk_fma_f32 v[18:19], v[102:103], v[70:71], v[18:19]
    v_cvt_pk_bf16_f32 v36, v12, v13
    v_cvt_pk_bf16_f32 v37, v14, v15
    v_cvt_pk_bf16_f32 v38, v16, v17
    v_cvt_pk_bf16_f32 v39, v18, v19
    v_lshlrev_b32 v12, 16, v36
    v_and_b32 v13, 0xffff0000, v36
    v_lshlrev_b32 v14, 16, v37
    v_and_b32 v15, 0xffff0000, v37
    v_lshlrev_b32 v16, 16, v38
    v_and_b32 v17, 0xffff0000, v38
    v_lshlrev_b32 v18, 16, v39
    v_and_b32 v19, 0xffff0000, v39
    v_pk_add_f32 v[88:89], v[12:13], v[14:15]
    v_pk_add_f32 v[62:63], v[16:17], v[18:19]
    v_pk_add_f32 v[88:89], v[88:89], v[62:63]
    v_add_f32 v88, v88, v89
    s_nop 1
    v_add_f32_dpp v88, v88, v88 row_ror:8 row_mask:0xf bank_mask:0xf
    s_nop 1
    v_add_f32_dpp v88, v88, v88 row_ror:4 row_mask:0xf bank_mask:0xf
    s_nop 1
    v_add_f32_dpp v88, v88, v88 row_ror:2 row_mask:0xf bank_mask:0xf
Ltour1_0:
    s_cbranch_execz Ltour1_4
    s_nop 1
    v_add_f32_dpp v88, v88, v88 row_ror:1 row_mask:0xf bank_mask:0xf
    v_mov_b32 v62, v88
    s_nop 1
    v_permlane16_swap_b32 v88, v62
    s_nop 0
    v_add_f32 v88, v88, v62
    v_mul_f32 v88, 0x3b800000, v88
    v_pk_add_f32 v[232:233], v[28:29], v[88:89] op_sel_hi:[1,0] neg_lo:[0,1] neg_hi:[0,1]
    v_pk_add_f32 v[234:235], v[30:31], v[88:89] op_sel_hi:[1,0] neg_lo:[0,1] neg_hi:[0,1]
    v_pk_add_f32 v[236:237], v[32:33], v[88:89] op_sel_hi:[1,0] neg_lo:[0,1] neg_hi:[0,1]
    v_pk_add_f32 v[238:239], v[34:35], v[88:89] op_sel_hi:[1,0] neg_lo:[0,1] neg_hi:[0,1]
    v_pk_add_f32 v[48:49], v[232:233], v[234:235]
    v_pk_mul_f32 v[50:51], v[232:233], v[232:233]
    v_pk_mul_f32 v[52:53], v[232:233], v[184:185]
    v_pk_fma_f32 v[50:51], v[234:235], v[234:235], v[50:51]
    v_pk_fma_f32 v[52:53], v[234:235], v[186:187], v[52:53]
    v_pk_add_f32 v[48:49], v[48:49], v[236:237]
    v_pk_fma_f32 v[50:51], v[236:237], v[236:237], v[50:51]
    v_pk_fma_f32 v[52:53], v[236:237], v[188:189], v[52:53]
    v_pk_add_f32 v[48:49], v[48:49], v[238:239]
    v_pk_fma_f32 v[50:51], v[238:239], v[238:239], v[50:51]
    v_pk_fma_f32 v[52:53], v[238:239], v[190:191], v[52:53]
    v_cndmask_b32 v48, 0, v48, vcc
    v_cndmask_b32 v49, 0, v49, vcc
    v_cndmask_b32 v50, 0, v50, vcc
    v_cndmask_b32 v51, 0, v51, vcc
    v_pk_add_f32 v[216:217], v[12:13], v[88:89] op_sel_hi:[1,0] neg_lo:[0,1] neg_hi:[0,1]
    v_pk_add_f32 v[218:219], v[14:15], v[88:89] op_sel_hi:[1,0] neg_lo:[0,1] neg_hi:[0,1]
    v_pk_add_f32 v[220:221], v[16:17], v[88:89] op_sel_hi:[1,0] neg_lo:[0,1] neg_hi:[0,1]
    v_pk_add_f32 v[222:223], v[18:19], v[88:89] op_sel_hi:[1,0] neg_lo:[0,1] neg_hi:[0,1]
    v_pk_add_f32 v[48:49], v[48:49], v[216:217]
    v_pk_fma_f32 v[50:51], v[216:217], v[216:217], v[50:51]
    v_pk_fma_f32 v[52:53], v[216:217], v[168:169], v[52:53]
    v_pk_add_f32 v[48:49], v[48:49], v[218:219]
    v_pk_fma_f32 v[50:51], v[218:219], v[218:219], v[50:51]
    v_pk_fma_f32 v[52:53], v[218:219], v[170:171], v[52:53]
    v_pk_add_f32 v[48:49], v[48:49], v[220:221]
    v_pk_fma_f32 v[50:51], v[220:221], v[220:221], v[50:51]
    v_pk_fma_f32 v[52:53], v[220:221], v[172:173], v[52:53]
    v_pk_add_f32 v[48:49], v[48:49], v[222:223]
    v_pk_fma_f32 v[50:51], v[222:223], v[222:223], v[50:51]
    v_pk_fma_f32 v[52:53], v[222:223], v[174:175], v[52:53]
    v_mfma_f32_16x16x32_bf16 v[72:75], v[246:249], a[48:51], 0
    v_mfma_f32_16x16x32_bf16 v[76:79], v[244:247], a[48:51], 0
    s_waitcnt vmcnt(6)
    v_mfma_f32_16x16x32_bf16 v[72:75], v[246:249], a[52:55], v[72:75]
    v_mfma_f32_16x16x32_bf16 v[76:79], v[244:247], a[52:55], v[76:79]
    s_waitcnt vmcnt(5)
    v_mfma_f32_16x16x32_bf16 v[72:75], v[246:249], a[56:59], v[72:75]
    v_mfma_f32_16x16x32_bf16 v[76:79], v[244:247], a[56:59], v[76:79]
    s_waitcnt vmcnt(4)
    v_mfma_f32_16x16x32_bf16 v[72:75], v[246:249], a[60:63], v[72:75]
    v_mfma_f32_16x16x32_bf16 v[76:79], v[244:247], a[60:63], v[76:79]
    s_waitcnt vmcnt(3)
    v_mfma_f32_16x16x32_bf16 v[72:75], v[250:253], a[64:67], v[72:75]
    v_mfma_f32_16x16x32_bf16 v[76:79], v[248:251], a[64:67], v[76:79]
    s_waitcnt vmcnt(2)
    v_mfma_f32_16x16x32_bf16 v[72:75], v[250:253], a[68:71], v[72:75]
    v_mfma_f32_16x16x32_bf16 v[76:79], v[248:251], a[68:71], v[76:79]
    s_waitcnt vmcnt(1)
    v_mfma_f32_16x16x32_bf16 v[72:75], v[250:253], a[72:75], v[72:75]
    v_mfma_f32_16x16x32_bf16 v[76:79], v[248:251], a[72:75], v[76:79]
    s_waitcnt vmcnt(0)
    v_mfma_f32_16x16x32_bf16 v[72:75], v[250:253], a[76:79], v[72:75]
    v_mfma_f32_16x16x32_bf16 v[76:79], v[248:251], a[76:79], v[76:79]
    s_nop 6
    v_pk_fma_f32 v[20:21], v[104:105], v[72:73], v[20:21]
    v_pk_fma_f32 v[22:23], v[106:107], v[74:75], v[22:23]
    v_pk_fma_f32 v[24:25], v[108:109], v[76:77], v[24:25]
    v_pk_fma_f32 v[26:27], v[110:111], v[78:79], v[26:27]
    v_cvt_pk_bf16_f32 v40, v20, v21
    v_cvt_pk_bf16_f32 v41, v22, v23
    v_cvt_pk_bf16_f32 v42, v24, v25
    v_cvt_pk_bf16_f32 v43, v26, v27
    v_lshlrev_b32 v20, 16, v40
    v_and_b32 v21, 0xffff0000, v40
    v_lshlrev_b32 v22, 16, v41
    v_and_b32 v23, 0xffff0000, v41
    v_lshlrev_b32 v24, 16, v42
    v_and_b32 v25, 0xffff0000, v42
    v_lshlrev_b32 v26, 16, v43
    v_and_b32 v27, 0xffff0000, v43
    v_pk_add_f32 v[224:225], v[20:21], v[88:89] op_sel_hi:[1,0] neg_lo:[0,1] neg_hi:[0,1]
    v_pk_add_f32 v[226:227], v[22:23], v[88:89] op_sel_hi:[1,0] neg_lo:[0,1] neg_hi:[0,1]
    v_pk_add_f32 v[228:229], v[24:25], v[88:89] op_sel_hi:[1,0] neg_lo:[0,1] neg_hi:[0,1]
    v_pk_add_f32 v[230:231], v[26:27], v[88:89] op_sel_hi:[1,0] neg_lo:[0,1] neg_hi:[0,1]
    v_pk_add_f32 v[48:49], v[48:49], v[224:225]
    v_pk_fma_f32 v[50:51], v[224:225], v[224:225], v[50:51]
    v_pk_fma_f32 v[52:53], v[224:225], v[176:177], v[52:53]
    v_pk_add_f32 v[48:49], v[48:49], v[226:227]
    v_pk_fma_f32 v[50:51], v[226:227], v[226:227], v[50:51]
    v_pk_fma_f32 v[52:53], v[226:227], v[178:179], v[52:53]
    v_pk_add_f32 v[48:49], v[48:49], v[228:229]
    v_pk_fma_f32 v[50:51], v[228:229], v[228:229], v[50:51]
    v_pk_fma_f32 v[52:53], v[228:229], v[180:181], v[52:53]
    v_pk_add_f32 v[48:49], v[48:49], v[230:231]
    v_pk_fma_f32 v[50:51], v[230:231], v[230:231], v[50:51]
    v_pk_fma_f32 v[52:53], v[230:231], v[182:183], v[52:53]
    v_add_f32 v48, v48, v49
    v_add_f32 v50, v50, v51
    v_add_f32 v52, v52, v53
    v_add_f32_dpp v48, v48, v48 row_ror:8 row_mask:0xf bank_mask:0xf
    v_add_f32_dpp v50, v50, v50 row_ror:8 row_mask:0xf bank_mask:0xf
    v_add_f32_dpp v52, v52, v52 row_ror:8 row_mask:0xf bank_mask:0xf
    v_add_f32_dpp v48, v48, v48 row_ror:4 row_mask:0xf bank_mask:0xf
    v_add_f32_dpp v50, v50, v50 row_ror:4 row_mask:0xf bank_mask:0xf
    v_add_f32_dpp v52, v52, v52 row_ror:4 row_mask:0xf bank_mask:0xf
    v_add_f32_dpp v48, v48, v48 row_ror:2 row_mask:0xf bank_mask:0xf
    v_add_f32_dpp v50, v50, v50 row_ror:2 row_mask:0xf bank_mask:0xf
    v_add_f32_dpp v52, v52, v52 row_ror:2 row_mask:0xf bank_mask:0xf
    v_add_f32_dpp v48, v48, v48 row_ror:1 row_mask:0xf bank_mask:0xf
    v_add_f32_dpp v50, v50, v50 row_ror:1 row_mask:0xf bank_mask:0xf
    v_add_f32_dpp v52, v52, v52 row_ror:1 row_mask:0xf bank_mask:0xf
    v_mov_b32 v49, v48
    v_mov_b32 v51, v50
    v_mov_b32 v53, v52
    v_permlane16_swap_b32 v48, v49
    v_permlane16_swap_b32 v50, v51
    v_permlane16_swap_b32 v52, v53
    v_add_f32 v48, v48, v49
    v_add_f32 v50, v50, v51
    v_add_f32 v52, v52, v53
    v_mul_f32 v48, 0x3ae38e39, v48
    v_mul_f32 v50, 0x3ae38e39, v50
    v_fma_f32 v50, -v48, v48, v50
    v_add_f32 v48, v48, v88
    v_max_f32 v50, 0, v50
    v_cvt_pk_bf16_f32 v48, v48, v50
    v_and_b32 v50, 0xffff0000, v48
    v_lshlrev_b32 v48, 16, v48
    v_add_f32 v50, 0x3727c5ac, v50
    v_sub_f32 v48, v88, v48
    v_cvt_pk_bf16_f32 v50, v50, v50
    v_and_b32 v50, 0xffff0000, v50
    v_sqrt_f32 v50, v50
    v_fmac_f32 v52, v48, v90
    v_cvt_pk_bf16_f32 v50, v50, v50
    v_and_b32 v50, 0xffff0000, v50
    v_rcp_f32 v50, v50
    s_mov_b32 exec_lo, 1
    s_mov_b32 exec_hi, 1
    v_fma_f32 v52, v52, v50, v91
    v_ashrrev_i32 v62, 31, v52
    v_or_b32 v62, 0x80000000, v62
    v_xor_b32 v52, v62, v52
    v_min_u32 v52, 0xfffff000, v52
    v_bfi_b32 v52, s48, v93, v52
    ds_write_b32 v92, v52 offset:36864
    s_mov_b64 exec, -1
    v_mul_f32 v48, v48, v50
    s_waitcnt lgkmcnt(0)
    s_barrier
    v_mov_b32 v109, 36864
    ds_read_b128 v[96:99], v109
    ds_read_b128 v[100:103], v109 offset:16
    s_lshl_b32 s45, s2, 7
    s_add_u32 s45, s45, 9306112
    s_cmp_eq_u32 s3, 0
    s_cselect_b32 s45, s45, 2147483648
    s_waitcnt lgkmcnt(1)
    v_max_u32 v104, v96, v97
    v_min_u32 v105, v96, v97
    v_med3_u32 v105, v104, v105, v98
    v_max_u32 v104, v104, v98
    v_med3_u32 v105, v104, v105, v99
    v_max_u32 v104, v104, v99
    s_waitcnt lgkmcnt(0)
    v_med3_u32 v105, v104, v105, v100
    v_max_u32 v104, v104, v100
    v_med3_u32 v105, v104, v105, v101
    v_max_u32 v104, v104, v101
    v_med3_u32 v105, v104, v105, v102
    v_max_u32 v104, v104, v102
    v_med3_u32 v105, v104, v105, v103
    v_max_u32 v104, v104, v103
    buffer_store_dwordx2 v[104:105], v8, s[24:27], s45 offen sc1
    v_pk_fma_f32 v[216:217], v[216:217], v[50:51], v[48:49] op_sel_hi:[1,0,0]
    v_pk_fma_f32 v[218:219], v[218:219], v[50:51], v[48:49] op_sel_hi:[1,0,0]
    v_pk_fma_f32 v[220:221], v[220:221], v[50:51], v[48:49] op_sel_hi:[1,0,0]
    v_pk_fma_f32 v[222:223], v[222:223], v[50:51], v[48:49] op_sel_hi:[1,0,0]
    v_pk_fma_f32 v[224:225], v[224:225], v[50:51], v[48:49] op_sel_hi:[1,0,0]
    v_pk_fma_f32 v[226:227], v[226:227], v[50:51], v[48:49] op_sel_hi:[1,0,0]
    v_pk_fma_f32 v[228:229], v[228:229], v[50:51], v[48:49] op_sel_hi:[1,0,0]
    v_pk_fma_f32 v[230:231], v[230:231], v[50:51], v[48:49] op_sel_hi:[1,0,0]
    v_pk_fma_f32 v[232:233], v[232:233], v[50:51], v[48:49] op_sel_hi:[1,0,0]
    v_pk_fma_f32 v[234:235], v[234:235], v[50:51], v[48:49] op_sel_hi:[1,0,0]
    v_pk_fma_f32 v[236:237], v[236:237], v[50:51], v[48:49] op_sel_hi:[1,0,0]
    v_pk_fma_f32 v[238:239], v[238:239], v[50:51], v[48:49] op_sel_hi:[1,0,0]
    v_pk_fma_f32 v[216:217], v[216:217], v[120:121], v[144:145]
    v_pk_fma_f32 v[218:219], v[218:219], v[122:123], v[146:147]
    v_pk_fma_f32 v[220:221], v[220:221], v[124:125], v[148:149]
    v_pk_fma_f32 v[222:223], v[222:223], v[126:127], v[150:151]
    v_pk_fma_f32 v[224:225], v[224:225], v[128:129], v[152:153]
    v_pk_fma_f32 v[226:227], v[226:227], v[130:131], v[154:155]
    v_pk_fma_f32 v[228:229], v[228:229], v[132:133], v[156:157]
    v_pk_fma_f32 v[230:231], v[230:231], v[134:135], v[158:159]
    v_pk_fma_f32 v[232:233], v[232:233], v[136:137], v[160:161]
    v_pk_fma_f32 v[234:235], v[234:235], v[138:139], v[162:163]
    v_pk_fma_f32 v[236:237], v[236:237], v[140:141], v[164:165]
    v_pk_fma_f32 v[238:239], v[238:239], v[142:143], v[166:167]
    v_cvt_pk_bf16_f32 v64, v216, v217
    v_cvt_pk_bf16_f32 v65, v218, v219
    v_cvt_pk_bf16_f32 v66, v220, v221
    v_cvt_pk_bf16_f32 v67, v222, v223
    v_cvt_pk_bf16_f32 v68, v224, v225
    v_cvt_pk_bf16_f32 v69, v226, v227
    v_cvt_pk_bf16_f32 v70, v228, v229
    v_cvt_pk_bf16_f32 v71, v230, v231
    v_cvt_pk_bf16_f32 v72, v232, v233
    v_cvt_pk_bf16_f32 v73, v234, v235
    v_cvt_pk_bf16_f32 v74, v236, v237
    v_cvt_pk_bf16_f32 v75, v238, v239
    v_and_b32 v106, 0x7ff, v104
    v_and_b32 v107, 0x7ff, v105
    v_cmp_eq_u32 vcc, v106, v93
    v_cmp_eq_u32 s[36:37], v107, v93
    v_mov_b32 v106, 2147483648
    s_or_b64 vcc, vcc, s[36:37]
    s_mov_b32 s45, 2621440
    s_nop 0
    v_cndmask_b32 v6, v106, v6, vcc
    v_cndmask_b32 v60, v106, v60, vcc
    buffer_store_dwordx4 v[64:67], v6, s[24:27], s45 offen offset:0 sc1
    buffer_store_dwordx4 v[68:71], v6, s[24:27], s45 offen offset:512 sc1
    buffer_store_dwordx4 v[72:75], v60, s[24:27], s45 offen offset:1024 sc1
    s_cmp_ge_u32 s41, 18
    s_cbranch_scc1 Ltail_idle
    s_mov_b32 s36, 2622592
    buffer_store_dwordx4 v[36:39], v6, s[24:27], s36 offen offset:0 sc1
    buffer_store_dwordx4 v[40:43], v6, s[24:27], s36 offen offset:512 sc1
    buffer_store_dwordx4 v[44:47], v60, s[24:27], s36 offen offset:1024 sc1
    v_lshlrev_b32 v216, 16, v64
    v_and_b32 v217, 0xffff0000, v64
    v_lshlrev_b32 v218, 16, v65
    v_and_b32 v219, 0xffff0000, v65
    v_lshlrev_b32 v220, 16, v66
    v_and_b32 v221, 0xffff0000, v66
    v_lshlrev_b32 v222, 16, v67
    v_and_b32 v223, 0xffff0000, v67
    v_lshlrev_b32 v224, 16, v68
    v_and_b32 v225, 0xffff0000, v68
    v_lshlrev_b32 v226, 16, v69
    v_and_b32 v227, 0xffff0000, v69
    v_lshlrev_b32 v228, 16, v70
    v_and_b32 v229, 0xffff0000, v70
    v_lshlrev_b32 v230, 16, v71
    v_and_b32 v231, 0xffff0000, v71
    v_lshlrev_b32 v232, 16, v72
    v_and_b32 v233, 0xffff0000, v72
    v_lshlrev_b32 v234, 16, v73
    v_and_b32 v235, 0xffff0000, v73
    v_lshlrev_b32 v236, 16, v74
    v_and_b32 v237, 0xffff0000, v74
    v_lshlrev_b32 v238, 16, v75
    v_and_b32 v239, 0xffff0000, v75
    v_pk_mul_f32 v[192:193], v[192:193], v[216:217]
    v_pk_mul_f32 v[194:195], v[194:195], v[218:219]
    v_pk_mul_f32 v[196:197], v[196:197], v[220:221]
    v_pk_mul_f32 v[198:199], v[198:199], v[222:223]
    v_pk_mul_f32 v[200:201], v[200:201], v[224:225]
    v_pk_mul_f32 v[202:203], v[202:203], v[226:227]
    v_pk_mul_f32 v[204:205], v[204:205], v[228:229]
    v_pk_mul_f32 v[206:207], v[206:207], v[230:231]
    v_pk_mul_f32 v[208:209], v[208:209], v[232:233]
    v_pk_mul_f32 v[210:211], v[210:211], v[234:235]
    v_pk_mul_f32 v[212:213], v[212:213], v[236:237]
    v_pk_mul_f32 v[214:215], v[214:215], v[238:239]
    v_cvt_pk_bf16_f32 v144, v192, v193
    v_cvt_pk_bf16_f32 v145, v194, v195
    v_cvt_pk_bf16_f32 v146, v196, v197
    v_cvt_pk_bf16_f32 v147, v198, v199
    v_cvt_pk_bf16_f32 v148, v200, v201
    v_cvt_pk_bf16_f32 v149, v202, v203
    v_cvt_pk_bf16_f32 v150, v204, v205
    v_cvt_pk_bf16_f32 v151, v206, v207
    v_cvt_pk_bf16_f32 v152, v208, v209
    v_cvt_pk_bf16_f32 v153, v210, v211
    v_cvt_pk_bf16_f32 v154, v212, v213
    v_cvt_pk_bf16_f32 v155, v214, v215
    v_lshlrev_b32 v192, 16, v144
    v_and_b32 v193, 0xffff0000, v144
    v_lshlrev_b32 v194, 16, v145
    v_and_b32 v195, 0xffff0000, v145
    v_lshlrev_b32 v196, 16, v146
    v_and_b32 v197, 0xffff0000, v146
    v_lshlrev_b32 v198, 16, v147
    v_and_b32 v199, 0xffff0000, v147
    v_lshlrev_b32 v200, 16, v148
    v_and_b32 v201, 0xffff0000, v148
    v_lshlrev_b32 v202, 16, v149
    v_and_b32 v203, 0xffff0000, v149
    v_lshlrev_b32 v204, 16, v150
    v_and_b32 v205, 0xffff0000, v150
    v_lshlrev_b32 v206, 16, v151
    v_and_b32 v207, 0xffff0000, v151
    v_lshlrev_b32 v208, 16, v152
    v_and_b32 v209, 0xffff0000, v152
    v_lshlrev_b32 v210, 16, v153
    v_and_b32 v211, 0xffff0000, v153
    v_lshlrev_b32 v212, 16, v154
    v_and_b32 v213, 0xffff0000, v154
    v_lshlrev_b32 v214, 16, v155
    v_and_b32 v215, 0xffff0000, v155
    v_pk_add_f32 v[192:193], v[192:193], v[12:13]
    v_pk_add_f32 v[194:195], v[194:195], v[14:15]
    v_pk_add_f32 v[196:197], v[196:197], v[16:17]
    v_pk_add_f32 v[198:199], v[198:199], v[18:19]
    v_pk_add_f32 v[200:201], v[200:201], v[20:21]
    v_pk_add_f32 v[202:203], v[202:203], v[22:23]
    v_pk_add_f32 v[204:205], v[204:205], v[24:25]
    v_pk_add_f32 v[206:207], v[206:207], v[26:27]
    v_pk_add_f32 v[208:209], v[208:209], v[28:29]
    v_pk_add_f32 v[210:211], v[210:211], v[30:31]
    v_pk_add_f32 v[212:213], v[212:213], v[32:33]
    v_pk_add_f32 v[214:215], v[214:215], v[34:35]
    v_cvt_pk_bf16_f32 v156, v192, v193
    v_cvt_pk_bf16_f32 v157, v194, v195
    v_cvt_pk_bf16_f32 v158, v196, v197
    v_cvt_pk_bf16_f32 v159, v198, v199
    v_cvt_pk_bf16_f32 v160, v200, v201
    v_cvt_pk_bf16_f32 v161, v202, v203
    v_cvt_pk_bf16_f32 v162, v204, v205
    v_cvt_pk_bf16_f32 v163, v206, v207
    v_cvt_pk_bf16_f32 v164, v208, v209
    v_cvt_pk_bf16_f32 v165, v210, v211
    v_cvt_pk_bf16_f32 v166, v212, v213
    v_cvt_pk_bf16_f32 v167, v214, v215
    v_and_b32 v30, 2, v1
    v_cmp_ne_u32 vcc, 0, v30
    v_mul_u32_u24 v30, 1152, v7
    v_add_u32 v4, v30, v5
    v_add_u32 v58, v30, v59
    v_mov_b32_dpp v192, v158 quad_perm:[0,2,0,2] row_mask:0xf bank_mask:0xf
    v_mov_b32_dpp v193, v159 quad_perm:[0,2,0,2] row_mask:0xf bank_mask:0xf
    v_mov_b32_dpp v194, v158 quad_perm:[1,3,1,3] row_mask:0xf bank_mask:0xf
    v_mov_b32_dpp v195, v159 quad_perm:[1,3,1,3] row_mask:0xf bank_mask:0xf
    v_mov_b32_dpp v196, v162 quad_perm:[0,2,0,2] row_mask:0xf bank_mask:0xf
    v_mov_b32_dpp v197, v163 quad_perm:[0,2,0,2] row_mask:0xf bank_mask:0xf
    v_mov_b32_dpp v198, v162 quad_perm:[1,3,1,3] row_mask:0xf bank_mask:0xf
    v_mov_b32_dpp v199, v163 quad_perm:[1,3,1,3] row_mask:0xf bank_mask:0xf
    v_mov_b32_dpp v200, v166 quad_perm:[0,2,0,2] row_mask:0xf bank_mask:0xf
    v_mov_b32_dpp v201, v167 quad_perm:[0,2,0,2] row_mask:0xf bank_mask:0xf
    v_mov_b32_dpp v202, v166 quad_perm:[1,3,1,3] row_mask:0xf bank_mask:0xf
    v_mov_b32_dpp v203, v167 quad_perm:[1,3,1,3] row_mask:0xf bank_mask:0xf
    v_cndmask_b32_dpp v144, v156, v192, vcc quad_perm:[0,2,0,2] row_mask:0xf bank_mask:0xf
    v_cndmask_b32_dpp v145, v157, v193, vcc quad_perm:[0,2,0,2] row_mask:0xf bank_mask:0xf
    v_cndmask_b32_dpp v146, v156, v194, vcc quad_perm:[1,3,1,3] row_mask:0xf bank_mask:0xf
    v_cndmask_b32_dpp v147, v157, v195, vcc quad_perm:[1,3,1,3] row_mask:0xf bank_mask:0xf
    v_cndmask_b32_dpp v148, v160, v196, vcc quad_perm:[0,2,0,2] row_mask:0xf bank_mask:0xf
    v_cndmask_b32_dpp v149, v161, v197, vcc quad_perm:[0,2,0,2] row_mask:0xf bank_mask:0xf
    v_cndmask_b32_dpp v150, v160, v198, vcc quad_perm:[1,3,1,3] row_mask:0xf bank_mask:0xf
    v_cndmask_b32_dpp v151, v161, v199, vcc quad_perm:[1,3,1,3] row_mask:0xf bank_mask:0xf
    v_cndmask_b32_dpp v152, v164, v200, vcc quad_perm:[0,2,0,2] row_mask:0xf bank_mask:0xf
    v_cndmask_b32_dpp v153, v165, v201, vcc quad_perm:[0,2,0,2] row_mask:0xf bank_mask:0xf
    v_cndmask_b32_dpp v154, v164, v202, vcc quad_perm:[1,3,1,3] row_mask:0xf bank_mask:0xf
    v_cndmask_b32_dpp v155, v165, v203, vcc quad_perm:[1,3,1,3] row_mask:0xf bank_mask:0xf
    v_lshlrev_b32 v13, 4, v1
    v_add_u32 v13, 32768, v13
    s_lshl_b32 s44, s3, 10
    v_add_u32 v14, s44, v13
    v_and_b32 v13, 0xffffff1f, v13
    v_bfe_u32 v15, v1, 2, 2
    v_cmp_eq_u32 s[52:53], 0, v15
    v_cmp_eq_u32 s[54:55], 1, v15
    v_cmp_eq_u32 s[56:57], 2, v15
    v_cmp_eq_u32 s[58:59], 3, v15
    s_mul_i32 s43, s42, 18
    s_add_u32 s43, s43, s41
    s_lshl_b32 s43, s43, 9
    s_mul_i32 s44, s3, 73728
    s_add_u32 s43, s43, s44
    v_lshlrev_b32 v15, 3, v1
    s_cmp_lt_u32 s3, 2
    s_cselect_b32 s36, 0xbfb8aa3b, 0
    s_cselect_b32 s37, 1.0, 0
    v_mov_b32 v40, s36
    v_mov_b32 v41, s37
    v_and_b32 v10, 1, v1
    v_and_b32 v9, 48, v1
    s_mul_i32 s38, s3, 3072
    s_add_u32 s38, s38, 49152
    v_lshl_add_u32 v11, v10, 9, v9
    v_add_u32 v11, s38, v11
    v_lshrrev_b32 v10, 5, v1
    v_and_b32 v9, 31, v1
    v_lshlrev_b32 v9, 4, v9
    v_lshlrev_b32 v108, 7, v0
    s_mov_b32 s45, 9306112
    s_lshl_b32 s36, s3, 3
    v_mov_b32 v109, s36
    s_mov_b32 s48, 262144
Ltail_pollk:
    buffer_load_dwordx2 v[104:105], v108, s[24:27], s45 offen sc1
    s_sub_u32 s48, s48, 1
    s_cbranch_scc1 Ltail_gotk
    s_waitcnt vmcnt(0)
    v_max_u32 v106, v104, v105
    v_cmp_eq_u32 vcc, -1, v106
    s_cbranch_vccnz Ltail_pollk
Ltail_gotk:
    s_waitcnt vmcnt(0)
    v_mov_b32_dpp v106, v104 row_ror:1 row_mask:0xf bank_mask:0xf
    v_mov_b32_dpp v107, v105 row_ror:1 row_mask:0xf bank_mask:0xf
    v_min_u32 v110, v104, v106
    v_max_u32 v104, v104, v106
    v_max3_u32 v105, v110, v105, v107
    s_nop 0
    v_mov_b32_dpp v106, v104 row_ror:2 row_mask:0xf bank_mask:0xf
    v_mov_b32_dpp v107, v105 row_ror:2 row_mask:0xf bank_mask:0xf
    v_min_u32 v110, v104, v106
    v_max_u32 v104, v104, v106
    v_max3_u32 v105, v110, v105, v107
    s_nop 0
    v_mov_b32_dpp v106, v104 row_ror:4 row_mask:0xf bank_mask:0xf
    v_mov_b32_dpp v107, v105 row_ror:4 row_mask:0xf bank_mask:0xf
    v_min_u32 v110, v104, v106
    v_max_u32 v104, v104, v106
    v_max3_u32 v105, v110, v105, v107
    s_nop 0
    v_mov_b32_dpp v106, v104 row_ror:8 row_mask:0xf bank_mask:0xf
    v_mov_b32_dpp v107, v105 row_ror:8 row_mask:0xf bank_mask:0xf
    v_min_u32 v110, v104, v106
    v_max_u32 v104, v104, v106
    v_max3_u32 v105, v110, v105, v107
    v_mov_b32 v106, v104
    v_mov_b32 v107, v105
    s_nop 0
    v_permlane16_swap_b32 v104, v106
    v_permlane16_swap_b32 v105, v107
    v_min_u32 v110, v104, v106
    v_max_u32 v104, v104, v106
    v_max3_u32 v105, v110, v105, v107
    v_mov_b32 v106, v104
    v_mov_b32 v107, v105
    s_nop 0
    v_permlane32_swap_b32 v104, v106
    v_permlane32_swap_b32 v105, v107
    v_min_u32 v110, v104, v106
    v_max_u32 v104, v104, v106
    v_max3_u32 v105, v110, v105, v107
    ds_write_b64 v109, v[104:105] offset:36928
    v_mov_b32 v109, 36928
    s_waitcnt lgkmcnt(0)
    s_barrier
    ds_read_b128 v[96:99], v109
    ds_read_b128 v[100:103], v109 offset:16
    s_waitcnt lgkmcnt(1)
    v_max_u32 v104, v96, v97
    v_min_u32 v105, v96, v97
    v_med3_u32 v105, v104, v105, v98
    v_max_u32 v104, v104, v98
    v_med3_u32 v105, v104, v105, v99
    v_max_u32 v104, v104, v99
    s_waitcnt lgkmcnt(0)
    v_med3_u32 v105, v104, v105, v100
    v_max_u32 v104, v104, v100
    v_med3_u32 v105, v104, v105, v101
    v_max_u32 v104, v104, v101
    v_med3_u32 v105, v104, v105, v102
    v_max_u32 v104, v104, v102
    v_med3_u32 v105, v104, v105, v103
    v_max_u32 v104, v104, v103
    s_nop 0
    v_readfirstlane_b32 s92, v104
    v_readfirstlane_b32 s93, v105
    s_andn2_b32 s46, 0x7ff, s92
    s_andn2_b32 s47, 0x7ff, s93
    s_mul_i32 s44, s46, 2304
    s_mul_i32 s45, s47, 2304
    s_sub_u32 s45, s45, s44
    v_mad_i32_i24 v10, v10, s45, v9
    s_add_u32 s45, s44, 2621440
    v_add_u32 v10, s45, v10
    s_mov_b32 s48, 16384
Ltail_pollh:
    s_mov_b32 exec_lo, 0xffffff
    s_mov_b32 exec_hi, 0xffffff
    s_add_u32 m0, s38, 0
    s_nop 0
    buffer_load_dwordx4 v10, s[24:27], 0 offen offset:0 sc1 lds
    s_add_u32 m0, s38, 640
    s_nop 0
    buffer_load_dwordx4 v10, s[24:27], 0 offen offset:384 sc1 lds
    s_add_u32 m0, s38, 1280
    s_nop 0
    buffer_load_dwordx4 v10, s[24:27], 0 offen offset:768 sc1 lds
    s_mov_b64 exec, -1
    s_waitcnt vmcnt(0)
    ds_read_b128 a[0:3], v11 offset:0
    ds_read_b128 a[4:7], v11 offset:64
    ds_read_b128 a[8:11], v11 offset:128
    ds_read_b128 a[12:15], v11 offset:192
    ds_read_b128 a[16:19], v11 offset:256
    ds_read_b128 a[20:23], v11 offset:320
    ds_read_b128 a[24:27], v11 offset:1024
    ds_read_b128 a[28:31], v11 offset:1088
    ds_read_b128 a[32:35], v11 offset:1152
    ds_read_b128 a[36:39], v11 offset:1216
    ds_read_b128 a[40:43], v11 offset:1280
    ds_read_b128 a[44:47], v11 offset:1344
    ds_read_b128 a[48:51], v11 offset:2048
    ds_read_b128 a[52:55], v11 offset:2112
    ds_read_b128 a[56:59], v11 offset:2176
    ds_read_b128 a[60:63], v11 offset:2240
    ds_read_b128 a[64:67], v11 offset:2304
    ds_read_b128 a[68:71], v11 offset:2368
    s_waitcnt lgkmcnt(15)
    v_mfma_f32_16x16x32_bf16 v[16:19], a[96:99], a[0:3], 0
    v_mfma_f32_16x16x32_bf16 v[20:23], a[100:103], a[4:7], 0
    v_mfma_f32_16x16x32_bf16 v[16:19], a[104:107], a[8:11], v[16:19]
    s_waitcnt lgkmcnt(14)
    v_mfma_f32_16x16x32_bf16 v[20:23], a[108:111], a[12:15], v[20:23]
    s_waitcnt lgkmcnt(13)
    v_mfma_f32_16x16x32_bf16 v[16:19], a[112:115], a[16:19], v[16:19]
    s_waitcnt lgkmcnt(12)
    v_mfma_f32_16x16x32_bf16 v[20:23], a[116:119], a[20:23], v[20:23]
    s_waitcnt lgkmcnt(11)
    v_mfma_f32_16x16x32_bf16 v[16:19], a[120:123], a[24:27], v[16:19]
    s_waitcnt lgkmcnt(10)
    v_mfma_f32_16x16x32_bf16 v[20:23], a[124:127], a[28:31], v[20:23]
    s_waitcnt lgkmcnt(9)
    v_mfma_f32_16x16x32_bf16 v[16:19], a[128:131], a[32:35], v[16:19]
    s_waitcnt lgkmcnt(8)
    v_mfma_f32_16x16x32_bf16 v[20:23], a[132:135], a[36:39], v[20:23]
    s_waitcnt lgkmcnt(7)
    v_mfma_f32_16x16x32_bf16 v[16:19], a[136:139], a[40:43], v[16:19]
    s_waitcnt lgkmcnt(6)
    v_mfma_f32_16x16x32_bf16 v[20:23], a[140:143], a[44:47], v[20:23]
    s_waitcnt lgkmcnt(5)
    v_mfma_f32_16x16x32_bf16 v[16:19], a[144:147], a[48:51], v[16:19]
    s_waitcnt lgkmcnt(4)
    v_mfma_f32_16x16x32_bf16 v[20:23], a[148:151], a[52:55], v[20:23]
    s_waitcnt lgkmcnt(3)
    v_mfma_f32_16x16x32_bf16 v[16:19], a[152:155], a[56:59], v[16:19]
    s_waitcnt lgkmcnt(2)
    v_mfma_f32_16x16x32_bf16 v[20:23], a[156:159], a[60:63], v[20:23]
    s_waitcnt lgkmcnt(1)
    v_mfma_f32_16x16x32_bf16 v[16:19], a[160:163], a[64:67], v[16:19]
    s_waitcnt lgkmcnt(0)
    v_mfma_f32_16x16x32_bf16 v[20:23], a[164:167], a[68:71], v[20:23]
    s_sub_u32 s48, s48, 1
    s_nop 6
    v_pk_add_f32 v[16:17], v[16:17], v[20:21]
    v_pk_add_f32 v[18:19], v[18:19], v[22:23]
    s_cbranch_scc1 Ltail_goth
    v_cmp_u_f32 vcc, v16, v16
    s_and_b32 s36, vcc_lo, 3
    s_cbranch_scc1 Ltail_pollh
Ltail_goth:
    v_cvt_pk_bf16_f32 v32, v16, v17
    v_cvt_pk_bf16_f32 v33, v18, v19
    v_lshlrev_b32 v16, 16, v32
    v_and_b32 v17, 0xffff0000, v32
    v_lshlrev_b32 v18, 16, v33
    v_and_b32 v19, 0xffff0000, v33
    v_pk_mul_f32 v[32:33], v[16:17], v[40:41] op_sel_hi:[1,0]
    v_pk_mul_f32 v[34:35], v[18:19], v[40:41] op_sel_hi:[1,0]
    v_exp_f32 v32, v32
    v_exp_f32 v33, v33
    v_exp_f32 v34, v34
    v_exp_f32 v35, v35
    v_fma_f32 v32, v32, v41, 1.0
    v_fma_f32 v33, v33, v41, 1.0
    v_fma_f32 v34, v34, v41, 1.0
    v_fma_f32 v35, v35, v41, 1.0
    v_rcp_f32 v32, v32
    v_rcp_f32 v33, v33
    v_rcp_f32 v34, v34
    v_rcp_f32 v35, v35
    v_pk_mul_f32 v[16:17], v[16:17], v[32:33]
    v_pk_mul_f32 v[18:19], v[18:19], v[34:35]
    v_cvt_pk_bf16_f32 v32, v16, v17
    v_cvt_pk_bf16_f32 v33, v18, v19
    v_lshlrev_b32 v16, 16, v32
    v_and_b32 v17, 0xffff0000, v32
    v_lshlrev_b32 v18, 16, v33
    v_and_b32 v19, 0xffff0000, v33
    ds_write_b128 v14, v[16:19]
    s_waitcnt lgkmcnt(0)
    s_barrier
    ds_read_b128 v[16:19], v13 offset:0
    ds_read_b128 v[24:27], v13 offset:2048
    ds_read_b128 v[20:23], v13 offset:1024
    ds_read_b128 v[28:31], v13 offset:3072
    s_waitcnt lgkmcnt(2)
    v_pk_mul_f32 v[16:17], v[16:17], v[24:25]
    v_pk_mul_f32 v[18:19], v[18:19], v[26:27]
    v_cvt_pk_bf16_f32 v32, v16, v17
    v_cvt_pk_bf16_f32 v33, v18, v19
    s_waitcnt lgkmcnt(0)
    v_pk_mul_f32 v[20:21], v[20:21], v[28:29]
    v_pk_mul_f32 v[22:23], v[22:23], v[30:31]
    v_cvt_pk_bf16_f32 v34, v20, v21
    v_cvt_pk_bf16_f32 v35, v22, v23
    v_cndmask_b32 v64, 0, v32, s[52:53]
    v_cndmask_b32 v65, 0, v33, s[52:53]
    v_cndmask_b32 v66, 0, v34, s[52:53]
    v_cndmask_b32 v67, 0, v35, s[52:53]
    s_nop 1
    v_mfma_f32_16x16x32_bf16 v[16:19], v[64:67], a[168:171], 0
    v_cndmask_b32 v68, 0, v32, s[54:55]
    v_cndmask_b32 v69, 0, v33, s[54:55]
    v_mfma_f32_16x16x32_bf16 v[20:23], v[64:67], a[184:187], 0
    v_cndmask_b32 v70, 0, v34, s[54:55]
    v_cndmask_b32 v71, 0, v35, s[54:55]
    v_mfma_f32_16x16x32_bf16 v[24:27], v[64:67], a[200:203], 0
    s_nop 0
    v_mfma_f32_16x16x32_bf16 v[16:19], v[68:71], a[172:175], v[16:19]
    v_cndmask_b32 v72, 0, v32, s[56:57]
    v_cndmask_b32 v73, 0, v33, s[56:57]
    v_mfma_f32_16x16x32_bf16 v[20:23], v[68:71], a[188:191], v[20:23]
    v_cndmask_b32 v74, 0, v34, s[56:57]
    v_cndmask_b32 v75, 0, v35, s[56:57]
    v_mfma_f32_16x16x32_bf16 v[24:27], v[68:71], a[204:207], v[24:27]
    s_nop 0
    v_mfma_f32_16x16x32_bf16 v[16:19], v[72:75], a[176:179], v[16:19]
Ltour1_1:
    s_cbranch_execz Lmain1
    v_cndmask_b32 v76, 0, v32, s[58:59]
    v_cndmask_b32 v77, 0, v33, s[58:59]
    v_mfma_f32_16x16x32_bf16 v[20:23], v[72:75], a[192:195], v[20:23]
    v_cndmask_b32 v78, 0, v34, s[58:59]
    v_cndmask_b32 v79, 0, v35, s[58:59]
    v_mfma_f32_16x16x32_bf16 v[24:27], v[72:75], a[208:211], v[24:27]
    s_nop 0
    v_mfma_f32_16x16x32_bf16 v[16:19], v[76:79], a[180:183], v[16:19]
    v_mfma_f32_16x16x32_bf16 v[20:23], v[76:79], a[196:199], v[20:23]
    v_mfma_f32_16x16x32_bf16 v[24:27], v[76:79], a[212:215], v[24:27]
    s_nop 5
    v_min_u32 v16, -2, v16
    v_min_u32 v17, -2, v17
    buffer_store_dwordx2 v[16:17], v15, s[8:11], s43 offen sc1
    s_add_u32 s43, s43, 294912
    v_min_u32 v20, -2, v20
    v_min_u32 v21, -2, v21
    buffer_store_dwordx2 v[20:21], v15, s[8:11], s43 offen sc1
    s_add_u32 s43, s43, 294912
    v_min_u32 v24, -2, v24
    v_min_u32 v25, -2, v25
    buffer_store_dwordx2 v[24:25], v15, s[8:11], s43 offen sc1
    s_or_b32 s36, s2, s3
    s_cselect_b32 s37, -4, 24576
    s_add_u32 s36, s94, 1
    v_mov_b32 v106, s36
    buffer_store_dword v106, v8, s[24:27], s37 offen sc1
    v_cmp_ne_u32 vcc, s46, v7
    v_cmp_ne_u32 s[36:37], s47, v7
    v_mov_b32 v31, 2147483648
    s_and_b64 vcc, vcc, s[36:37]
    s_nop 1
    v_cndmask_b32 v30, v31, v58, vcc
    v_cndmask_b32 v31, v31, v4, vcc
    buffer_store_dwordx4 v[144:147], v31, s[16:19], 0 offen offset:0 nt
    buffer_store_dwordx4 v[148:151], v31, s[16:19], 0 offen offset:512 nt
    buffer_store_dwordx4 v[152:155], v30, s[16:19], 0 offen offset:1024 nt
    s_cmp_lt_u32 s41, 9
    s_cselect_b32 s36, s3, 0
    s_cmp_lg_u32 s36, 3
    s_cbranch_scc1 Ltail_done
    s_mul_i32 s43, s42, 9
    s_add_u32 s43, s43, s41
    v_bfe_u32 v8, v1, 2, 1
    v_cmp_eq_u32 vcc, 1, v8
    v_mov_b32 v9, s46
    v_mov_b32 v10, s47
    v_and_b32 v11, 3, v1
    v_cndmask_b32 v9, v9, v10, vcc
    s_lshr_b32 s44, s43, 2
    s_lshl_b32 s44, s44, 6
    s_and_b32 s45, s43, 1
    s_lshl_b32 s45, s45, 5
    s_add_u32 s44, s44, s45
    s_and_b32 s45, s43, 2
    s_lshl_b32 s45, s45, 2
    s_add_u32 s44, s44, s45
    v_lshrrev_b32 v12, 1, v11
    v_lshl_add_u32 v12, v12, 4, s44
    v_and_b32 v13, 1, v11
    v_lshl_add_u32 v12, v13, 2, v12
    v_mul_u32_u24 v13, 1152, v9
    v_lshl_add_u32 v14, v13, 1, v12
    v_add_u32 v15, 2621440, v14
    s_mov_b32 s45, 22144
    buffer_load_dword v18, v12, s[24:27], s45 offen sc1
    v_mov_b32 v19, s92
    v_mov_b32 v10, s93
    v_cndmask_b32 v19, v19, v10, vcc
    v_and_b32 v19, 0xfffff800, v19
    v_or_b32 v19, 0x400, v19
    v_ashrrev_i32 v10, 31, v19
    v_not_b32 v10, v10
    v_or_b32 v10, 0x80000000, v10
    v_xor_b32 v19, v19, v10
    s_lshl_b32 s45, s43, 4
    v_lshl_add_u32 v13, v11, 2, v13
    v_add_u32 v13, s45, v13
    v_lshrrev_b32 v14, 2, v1
    v_lshlrev_b32 v14, 9, v14
    v_lshl_add_u32 v14, v11, 4, v14
    s_lshr_b32 s44, s43, 3
    s_mul_i32 s44, s44, 73728
    s_and_b32 s45, s43, 7
    s_lshl_b32 s45, s45, 6
    s_add_u32 s44, s44, s45
    v_cmp_eq_u32 s[38:39], 1, v8
    v_cvt_pk_bf16_f32 v19, v19, v19
    v_and_b32 v19, 0xffff0000, v19
    v_mul_f32 v19, 0xbfb8aa3b, v19
    v_exp_f32 v19, v19
    s_waitcnt vmcnt(0)
    v_lshlrev_b32 v24, 16, v18
    v_and_b32 v25, 0xffff0000, v18
    v_add_f32 v19, 1.0, v19
    v_rcp_f32 v19, v19
    s_mov_b32 s48, 262144
    v_cvt_pk_bf16_f32 v19, v19, v19
    v_and_b32 v19, 0xffff0000, v19
Ltail_polly:
    s_add_u32 s45, s44, 0
    buffer_load_dwordx4 v[64:67], v14, s[8:11], s45 offen sc1
    s_add_u32 s45, s44, 8192
    buffer_load_dwordx4 v[68:71], v14, s[8:11], s45 offen sc1
    s_add_u32 s45, s44, 16384
    buffer_load_dwordx4 v[72:75], v14, s[8:11], s45 offen sc1
    s_add_u32 s45, s44, 24576
    buffer_load_dwordx4 v[76:79], v14, s[8:11], s45 offen sc1
    s_add_u32 s45, s44, 32768
    buffer_load_dwordx4 v[80:83], v14, s[8:11], s45 offen sc1
    s_add_u32 s45, s44, 40960
    buffer_load_dwordx4 v[84:87], v14, s[8:11], s45 offen sc1
    s_add_u32 s45, s44, 49152
    buffer_load_dwordx4 v[88:91], v14, s[8:11], s45 offen sc1
    s_add_u32 s45, s44, 57344
    buffer_load_dwordx4 v[92:95], v14, s[8:11], s45 offen sc1
    s_add_u32 s45, s44, 65536
    buffer_load_dwordx4 v[96:99], v14, s[8:11], s45 offen sc1
    s_mov_b32 s45, 1152
    buffer_load_dword v16, v15, s[24:27], s45 offen sc1
    buffer_load_dword v17, v15, s[24:27], 0 offen sc1
    s_sub_u32 s48, s48, 1
    s_cbranch_scc1 Ltail_goty
    s_waitcnt vmcnt(10)
    v_max3_u32 v26, v64, v65, v66
    s_waitcnt vmcnt(9)
    v_max3_u32 v26, v26, v67, v68
    v_max3_u32 v26, v26, v69, v70
    s_waitcnt vmcnt(8)
    v_max3_u32 v26, v26, v71, v72
    v_max3_u32 v26, v26, v73, v74
    s_waitcnt vmcnt(7)
    v_max3_u32 v26, v26, v75, v76
    v_max3_u32 v26, v26, v77, v78
    s_waitcnt vmcnt(6)
    v_max3_u32 v26, v26, v79, v80
    v_max3_u32 v26, v26, v81, v82
    s_waitcnt vmcnt(5)
    v_max3_u32 v26, v26, v83, v84
    v_max3_u32 v26, v26, v85, v86
    s_waitcnt vmcnt(4)
    v_max3_u32 v26, v26, v87, v88
    v_max3_u32 v26, v26, v89, v90
    s_waitcnt vmcnt(3)
    v_max3_u32 v26, v26, v91, v92
    v_max3_u32 v26, v26, v93, v94
    s_waitcnt vmcnt(2)
    v_max3_u32 v26, v26, v95, v96
    v_max3_u32 v26, v26, v97, v98
    v_max_u32 v26, v26, v99
    s_waitcnt vmcnt(0)
    v_max3_u32 v26, v26, v16, v17
    v_cmp_eq_u32 vcc, -1, v26
    s_cbranch_vccnz Ltail_polly
Ltail_goty:
    s_waitcnt vmcnt(0) lgkmcnt(0)
    v_lshlrev_b32 v20, 16, v16
    v_and_b32 v21, 0xffff0000, v16
    v_lshlrev_b32 v22, 16, v17
    v_and_b32 v23, 0xffff0000, v17
    v_pk_add_f32 v[64:65], v[64:65], v[68:69]
    v_pk_add_f32 v[66:67], v[66:67], v[70:71]
    v_pk_add_f32 v[64:65], v[64:65], v[72:73]
    v_pk_add_f32 v[66:67], v[66:67], v[74:75]
    v_pk_add_f32 v[64:65], v[64:65], v[76:77]
    v_pk_add_f32 v[66:67], v[66:67], v[78:79]
    v_pk_add_f32 v[64:65], v[64:65], v[80:81]
    v_pk_add_f32 v[66:67], v[66:67], v[82:83]
    v_pk_add_f32 v[64:65], v[64:65], v[84:85]
    v_pk_add_f32 v[66:67], v[66:67], v[86:87]
    v_pk_add_f32 v[64:65], v[64:65], v[88:89]
    v_pk_add_f32 v[66:67], v[66:67], v[90:91]
    v_pk_add_f32 v[64:65], v[64:65], v[92:93]
    v_pk_add_f32 v[66:67], v[66:67], v[94:95]
    v_pk_add_f32 v[64:65], v[64:65], v[96:97]
    v_pk_add_f32 v[66:67], v[66:67], v[98:99]
    s_nop 0
    v_add_f32_dpp v64, v64, v64 row_ror:4 row_mask:0xf bank_mask:0xf
    v_add_f32_dpp v65, v65, v65 row_ror:4 row_mask:0xf bank_mask:0xf
    v_add_f32_dpp v66, v66, v66 row_ror:4 row_mask:0xf bank_mask:0xf
    v_add_f32_dpp v67, v67, v67 row_ror:4 row_mask:0xf bank_mask:0xf
    v_add_f32_dpp v64, v64, v64 row_ror:8 row_mask:0xf bank_mask:0xf
    v_add_f32_dpp v65, v65, v65 row_ror:8 row_mask:0xf bank_mask:0xf
    v_add_f32_dpp v66, v66, v66 row_ror:8 row_mask:0xf bank_mask:0xf
    v_add_f32_dpp v67, v67, v67 row_ror:8 row_mask:0xf bank_mask:0xf
    v_mov_b32 v68, v64
    v_mov_b32 v69, v65
    v_mov_b32 v70, v66
    v_mov_b32 v71, v67
    v_permlane16_swap_b32 v64, v68
    v_permlane16_swap_b32 v65, v69
    v_permlane16_swap_b32 v66, v70
    v_permlane16_swap_b32 v67, v71
    v_add_f32 v64, v64, v68
    v_add_f32 v65, v65, v69
    v_add_f32 v66, v66, v70
    v_add_f32 v67, v67, v71
    v_mov_b32 v68, v64
    v_mov_b32 v69, v65
    v_mov_b32 v70, v66
    v_mov_b32 v71, v67
    v_permlane32_swap_b32 v64, v68
    v_permlane32_swap_b32 v65, v69
    v_permlane32_swap_b32 v66, v70
    v_permlane32_swap_b32 v67, v71
    v_add_f32 v64, v64, v68
    v_add_f32 v65, v65, v69
    v_add_f32 v66, v66, v70
    v_add_f32 v67, v67, v71
    v_cndmask_b32 v26, v64, v65, s[38:39]
    v_cndmask_b32 v27, v66, v67, s[38:39]
    v_cvt_pk_bf16_f32 v28, v26, v27
    v_lshlrev_b32 v26, 16, v28
    v_and_b32 v27, 0xffff0000, v28
    v_mul_f32 v26, v26, v19
    v_mul_f32 v27, v27, v19
    v_cvt_pk_bf16_f32 v28, v26, v27
    v_lshlrev_b32 v26, 16, v28
    v_and_b32 v27, 0xffff0000, v28
    v_pk_add_f32 v[26:27], v[26:27], v[22:23]
    v_cvt_pk_bf16_f32 v28, v26, v27
    v_lshlrev_b32 v26, 16, v28
    v_and_b32 v27, 0xffff0000, v28
    v_pk_mul_f32 v[26:27], v[26:27], v[24:25]
    v_cvt_pk_bf16_f32 v28, v26, v27
    v_lshlrev_b32 v26, 16, v28
    v_and_b32 v27, 0xffff0000, v28
    v_pk_add_f32 v[26:27], v[26:27], v[20:21]
    v_cvt_pk_bf16_f32 v28, v26, v27
    s_mov_b64 exec, 0xff
    buffer_store_dword v28, v13, s[16:19], 0 offen nt
    s_branch Ltail_done
Ltail_idle:
Ltour1_2:
    s_cbranch_execz Lmain1
    v_lshlrev_b32 v216, 16, v64
    v_and_b32 v217, 0xffff0000, v64
    v_lshlrev_b32 v218, 16, v65
    v_and_b32 v219, 0xffff0000, v65
    v_lshlrev_b32 v220, 16, v66
    v_and_b32 v221, 0xffff0000, v66
    v_lshlrev_b32 v222, 16, v67
    v_and_b32 v223, 0xffff0000, v67
    v_lshlrev_b32 v224, 16, v68
    v_and_b32 v225, 0xffff0000, v68
    v_lshlrev_b32 v226, 16, v69
    v_and_b32 v227, 0xffff0000, v69
    v_lshlrev_b32 v228, 16, v70
    v_and_b32 v229, 0xffff0000, v70
    v_lshlrev_b32 v230, 16, v71
    v_and_b32 v231, 0xffff0000, v71
    v_lshlrev_b32 v232, 16, v72
    v_and_b32 v233, 0xffff0000, v72
    v_lshlrev_b32 v234, 16, v73
    v_and_b32 v235, 0xffff0000, v73
    v_lshlrev_b32 v236, 16, v74
    v_and_b32 v237, 0xffff0000, v74
    v_lshlrev_b32 v238, 16, v75
    v_and_b32 v239, 0xffff0000, v75
    v_pk_mul_f32 v[192:193], v[192:193], v[216:217]
    v_pk_mul_f32 v[194:195], v[194:195], v[218:219]
    v_pk_mul_f32 v[196:197], v[196:197], v[220:221]
    v_pk_mul_f32 v[198:199], v[198:199], v[222:223]
    v_pk_mul_f32 v[200:201], v[200:201], v[224:225]
    v_pk_mul_f32 v[202:203], v[202:203], v[226:227]
    v_pk_mul_f32 v[204:205], v[204:205], v[228:229]
    v_pk_mul_f32 v[206:207], v[206:207], v[230:231]
    v_pk_mul_f32 v[208:209], v[208:209], v[232:233]
    v_pk_mul_f32 v[210:211], v[210:211], v[234:235]
    v_pk_mul_f32 v[212:213], v[212:213], v[236:237]
    v_pk_mul_f32 v[214:215], v[214:215], v[238:239]
    v_cvt_pk_bf16_f32 v144, v192, v193
    v_cvt_pk_bf16_f32 v145, v194, v195
    v_cvt_pk_bf16_f32 v146, v196, v197
    v_cvt_pk_bf16_f32 v147, v198, v199
    v_cvt_pk_bf16_f32 v148, v200, v201
    v_cvt_pk_bf16_f32 v149, v202, v203
    v_cvt_pk_bf16_f32 v150, v204, v205
    v_cvt_pk_bf16_f32 v151, v206, v207
    v_cvt_pk_bf16_f32 v152, v208, v209
    v_cvt_pk_bf16_f32 v153, v210, v211
    v_cvt_pk_bf16_f32 v154, v212, v213
    v_cvt_pk_bf16_f32 v155, v214, v215
    v_lshlrev_b32 v192, 16, v144
    v_and_b32 v193, 0xffff0000, v144
    v_lshlrev_b32 v194, 16, v145
    v_and_b32 v195, 0xffff0000, v145
    v_lshlrev_b32 v196, 16, v146
    v_and_b32 v197, 0xffff0000, v146
    v_lshlrev_b32 v198, 16, v147
    v_and_b32 v199, 0xffff0000, v147
    v_lshlrev_b32 v200, 16, v148
    v_and_b32 v201, 0xffff0000, v148
    v_lshlrev_b32 v202, 16, v149
    v_and_b32 v203, 0xffff0000, v149
    v_lshlrev_b32 v204, 16, v150
    v_and_b32 v205, 0xffff0000, v150
    v_lshlrev_b32 v206, 16, v151
    v_and_b32 v207, 0xffff0000, v151
    v_lshlrev_b32 v208, 16, v152
    v_and_b32 v209, 0xffff0000, v152
    v_lshlrev_b32 v210, 16, v153
    v_and_b32 v211, 0xffff0000, v153
    v_lshlrev_b32 v212, 16, v154
    v_and_b32 v213, 0xffff0000, v154
    v_lshlrev_b32 v214, 16, v155
    v_and_b32 v215, 0xffff0000, v155
    v_pk_add_f32 v[192:193], v[192:193], v[12:13]
    v_pk_add_f32 v[194:195], v[194:195], v[14:15]
    v_pk_add_f32 v[196:197], v[196:197], v[16:17]
    v_pk_add_f32 v[198:199], v[198:199], v[18:19]
    v_pk_add_f32 v[200:201], v[200:201], v[20:21]
    v_pk_add_f32 v[202:203], v[202:203], v[22:23]
    v_pk_add_f32 v[204:205], v[204:205], v[24:25]
    v_pk_add_f32 v[206:207], v[206:207], v[26:27]
    v_pk_add_f32 v[208:209], v[208:209], v[28:29]
    v_pk_add_f32 v[210:211], v[210:211], v[30:31]
    v_pk_add_f32 v[212:213], v[212:213], v[32:33]
    v_pk_add_f32 v[214:215], v[214:215], v[34:35]
    v_cvt_pk_bf16_f32 v156, v192, v193
    v_cvt_pk_bf16_f32 v157, v194, v195
    v_cvt_pk_bf16_f32 v158, v196, v197
    v_cvt_pk_bf16_f32 v159, v198, v199
    v_cvt_pk_bf16_f32 v160, v200, v201
    v_cvt_pk_bf16_f32 v161, v202, v203
    v_cvt_pk_bf16_f32 v162, v204, v205
    v_cvt_pk_bf16_f32 v163, v206, v207
    v_cvt_pk_bf16_f32 v164, v208, v209
    v_cvt_pk_bf16_f32 v165, v210, v211
    v_cvt_pk_bf16_f32 v166, v212, v213
    v_cvt_pk_bf16_f32 v167, v214, v215
    v_and_b32 v30, 2, v1
    v_cmp_ne_u32 vcc, 0, v30
    v_mul_u32_u24 v30, 1152, v7
    v_add_u32 v4, v30, v5
    v_add_u32 v58, v30, v59
    v_mov_b32_dpp v192, v158 quad_perm:[0,2,0,2] row_mask:0xf bank_mask:0xf
    v_mov_b32_dpp v193, v159 quad_perm:[0,2,0,2] row_mask:0xf bank_mask:0xf
    v_mov_b32_dpp v194, v158 quad_perm:[1,3,1,3] row_mask:0xf bank_mask:0xf
    v_mov_b32_dpp v195, v159 quad_perm:[1,3,1,3] row_mask:0xf bank_mask:0xf
    v_mov_b32_dpp v196, v162 quad_perm:[0,2,0,2] row_mask:0xf bank_mask:0xf
    v_mov_b32_dpp v197, v163 quad_perm:[0,2,0,2] row_mask:0xf bank_mask:0xf
    v_mov_b32_dpp v198, v162 quad_perm:[1,3,1,3] row_mask:0xf bank_mask:0xf
    v_mov_b32_dpp v199, v163 quad_perm:[1,3,1,3] row_mask:0xf bank_mask:0xf
    v_mov_b32_dpp v200, v166 quad_perm:[0,2,0,2] row_mask:0xf bank_mask:0xf
    v_mov_b32_dpp v201, v167 quad_perm:[0,2,0,2] row_mask:0xf bank_mask:0xf
    v_mov_b32_dpp v202, v166 quad_perm:[1,3,1,3] row_mask:0xf bank_mask:0xf
    v_mov_b32_dpp v203, v167 quad_perm:[1,3,1,3] row_mask:0xf bank_mask:0xf
    v_cndmask_b32_dpp v144, v156, v192, vcc quad_perm:[0,2,0,2] row_mask:0xf bank_mask:0xf
    v_cndmask_b32_dpp v145, v157, v193, vcc quad_perm:[0,2,0,2] row_mask:0xf bank_mask:0xf
    v_cndmask_b32_dpp v146, v156, v194, vcc quad_perm:[1,3,1,3] row_mask:0xf bank_mask:0xf
    v_cndmask_b32_dpp v147, v157, v195, vcc quad_perm:[1,3,1,3] row_mask:0xf bank_mask:0xf
    v_cndmask_b32_dpp v148, v160, v196, vcc quad_perm:[0,2,0,2] row_mask:0xf bank_mask:0xf
    v_cndmask_b32_dpp v149, v161, v197, vcc quad_perm:[0,2,0,2] row_mask:0xf bank_mask:0xf
    v_cndmask_b32_dpp v150, v160, v198, vcc quad_perm:[1,3,1,3] row_mask:0xf bank_mask:0xf
    v_cndmask_b32_dpp v151, v161, v199, vcc quad_perm:[1,3,1,3] row_mask:0xf bank_mask:0xf
    v_cndmask_b32_dpp v152, v164, v200, vcc quad_perm:[0,2,0,2] row_mask:0xf bank_mask:0xf
    v_cndmask_b32_dpp v153, v165, v201, vcc quad_perm:[0,2,0,2] row_mask:0xf bank_mask:0xf
    v_cndmask_b32_dpp v154, v164, v202, vcc quad_perm:[1,3,1,3] row_mask:0xf bank_mask:0xf
    v_cndmask_b32_dpp v155, v165, v203, vcc quad_perm:[1,3,1,3] row_mask:0xf bank_mask:0xf
    buffer_store_dwordx4 v[144:147], v4, s[16:19], 0 offen offset:0 sc1
    buffer_store_dwordx4 v[148:151], v4, s[16:19], 0 offen offset:512 sc1
    buffer_store_dwordx4 v[152:155], v58, s[16:19], 0 offen offset:1024 sc1
    s_waitcnt vmcnt(0)
    s_mov_b32 s36, 2622592
    buffer_store_dwordx4 v[36:39], v6, s[24:27], s36 offen offset:0 sc1
    buffer_store_dwordx4 v[40:43], v6, s[24:27], s36 offen offset:512 sc1
    buffer_store_dwordx4 v[44:47], v60, s[24:27], s36 offen offset:1024 sc1
Ltail_done:
    s_endpgm
Lattn_wb:
    buffer_wbl2 sc1
    s_waitcnt vmcnt(0)
    s_branch Lattn_wbdone
Lattn_xspin:
Ltour0_12:
    s_cbranch_execz Lmain0
    s_mov_b32 s37, 262144
Lattn_xloop:
    buffer_load_dword v11, v8, s[24:27], s54 offen offset:8 sc1
    s_waitcnt vmcnt(0)
    v_readfirstlane_b32 s36, v11
    s_sub_u32 s37, s37, 1
    s_cbranch_scc1 Lattn_xgot
    s_cmp_lg_u32 s36, s95
    s_cbranch_scc1 Lattn_xloop
    s_branch Lattn_xgot
Ltail_spin1:
Ltour1_3:
    s_cbranch_execz Lmain1
    s_mov_b32 s48, 262144
Ltail_spinl1:
    buffer_load_dword v11, v9, s[24:27], s39 offen sc1
    s_waitcnt vmcnt(0)
    v_cmp_ne_u32 s[54:55], s95, v11
    s_sub_u32 s48, s48, 1
    s_cbranch_scc1 Ltail_got1
    s_cmp_lg_u64 s[54:55], 0
    s_cbranch_scc1 Ltail_spinl1
    s_branch Ltail_got1
Ltail_spin2:
Ltour1_4:
    s_cbranch_execz Lmain1
    s_mov_b32 s48, 262144
Ltail_spinl2:
    buffer_load_dword v11, v9, s[24:27], s39 offen sc1
    s_waitcnt vmcnt(0)
    v_cmp_ne_u32 s[54:55], s95, v11
    s_sub_u32 s48, s48, 1
    s_cbranch_scc1 Ltail_got2
    s_cmp_lg_u64 s[54:55], 0
    s_cbranch_scc1 Ltail_spinl2
    s_branch Ltail_got2
Lattn_redo:
    s_load_dwordx2 s[16:17], s[0:1], 88
    v_xor_b32 v8, 64, v9
    v_xor_b32 v10, 64, v11
    s_waitcnt vmcnt(0) lgkmcnt(0)
    s_barrier
    v_mov_b32 v232, 0xff800000
    v_mov_b32 v233, 0xff800000
    v_mov_b32 v234, 0xff800000
    v_mov_b32 v235, 0xff800000
    s_mov_b32 s40, 0
    s_mov_b32 s48, -1
Lattn_redo_loop:
    s_add_u32 m0, s42, 0
    s_nop 0
    buffer_load_dwordx4 v36, s[8:11], s40 offen lds
    buffer_load_dwordx4 v37, s[8:11], s40 offen offset:1024 lds
    buffer_load_dwordx4 v38, s[8:11], s40 offen offset:2048 lds
    buffer_load_dwordx4 v39, s[8:11], s40 offen offset:3072 lds
    s_add_u32 s40, s40, 16384
    s_waitcnt vmcnt(0) lgkmcnt(0)
    s_barrier
    ds_read_b128 a[208:211], v8 offset:0
    ds_read_b128 a[212:215], v9 offset:0
    ds_read_b128 a[216:219], v10 offset:0
    ds_read_b128 a[220:223], v11 offset:0
    s_waitcnt lgkmcnt(3)
    v_mfma_f32_16x16x32_bf16 v[216:219], a[208:211], v[64:67], 0
    s_waitcnt lgkmcnt(2)
    v_mfma_f32_16x16x32_bf16 v[216:219], a[212:215], v[68:71], v[216:219]
    s_waitcnt lgkmcnt(1)
    v_mfma_f32_16x16x32_bf16 v[216:219], a[216:219], v[72:75], v[216:219]
    s_waitcnt lgkmcnt(0)
    v_mfma_f32_16x16x32_bf16 v[216:219], a[220:223], v[76:79], v[216:219]
    v_mfma_f32_16x16x32_bf16 v[220:223], a[208:211], v[80:83], 0
    v_mfma_f32_16x16x32_bf16 v[220:223], a[212:215], v[84:87], v[220:223]
    v_mfma_f32_16x16x32_bf16 v[220:223], a[216:219], v[88:91], v[220:223]
    v_mfma_f32_16x16x32_bf16 v[220:223], a[220:223], v[92:95], v[220:223]
    v_mfma_f32_16x16x32_bf16 v[224:227], a[208:211], v[96:99], 0
    v_mfma_f32_16x16x32_bf16 v[224:227], a[212:215], v[100:103], v[224:227]
    v_mfma_f32_16x16x32_bf16 v[224:227], a[216:219], v[104:107], v[224:227]
    v_mfma_f32_16x16x32_bf16 v[224:227], a[220:223], v[108:111], v[224:227]
    v_mfma_f32_16x16x32_bf16 v[228:231], a[208:211], v[112:115], 0
    v_mfma_f32_16x16x32_bf16 v[228:231], a[212:215], v[116:119], v[228:231]
    v_mfma_f32_16x16x32_bf16 v[228:231], a[216:219], v[120:123], v[228:231]
    v_mfma_f32_16x16x32_bf16 v[228:231], a[220:223], v[124:127], v[228:231]
    v_max3_f32 v232, v232, v216, v217
    v_max3_f32 v232, v232, v218, v219
    v_max3_f32 v233, v233, v220, v221
    v_max3_f32 v233, v233, v222, v223
    v_max3_f32 v234, v234, v224, v225
    v_max3_f32 v234, v234, v226, v227
    s_nop 1
    v_max3_f32 v235, v235, v228, v229
    v_max3_f32 v235, v235, v230, v231
    ds_read_b128 a[224:227], v8 offset:4096
    ds_read_b128 a[228:231], v9 offset:4096
    ds_read_b128 a[232:235], v10 offset:4096
    ds_read_b128 a[236:239], v11 offset:4096
    s_waitcnt lgkmcnt(3)
    v_mfma_f32_16x16x32_bf16 v[216:219], a[224:227], v[64:67], 0
    s_waitcnt lgkmcnt(2)
    v_mfma_f32_16x16x32_bf16 v[216:219], a[228:231], v[68:71], v[216:219]
    s_waitcnt lgkmcnt(1)
    v_mfma_f32_16x16x32_bf16 v[216:219], a[232:235], v[72:75], v[216:219]
    s_waitcnt lgkmcnt(0)
    v_mfma_f32_16x16x32_bf16 v[216:219], a[236:239], v[76:79], v[216:219]
    v_mfma_f32_16x16x32_bf16 v[220:223], a[224:227], v[80:83], 0
    v_mfma_f32_16x16x32_bf16 v[220:223], a[228:231], v[84:87], v[220:223]
    v_mfma_f32_16x16x32_bf16 v[220:223], a[232:235], v[88:91], v[220:223]
    v_mfma_f32_16x16x32_bf16 v[220:223], a[236:239], v[92:95], v[220:223]
    v_mfma_f32_16x16x32_bf16 v[224:227], a[224:227], v[96:99], 0
    v_mfma_f32_16x16x32_bf16 v[224:227], a[228:231], v[100:103], v[224:227]
    v_mfma_f32_16x16x32_bf16 v[224:227], a[232:235], v[104:107], v[224:227]
    v_mfma_f32_16x16x32_bf16 v[224:227], a[236:239], v[108:111], v[224:227]
    v_mfma_f32_16x16x32_bf16 v[228:231], a[224:227], v[112:115], 0
    v_mfma_f32_16x16x32_bf16 v[228:231], a[228:231], v[116:119], v[228:231]
    v_mfma_f32_16x16x32_bf16 v[228:231], a[232:235], v[120:123], v[228:231]
    v_mfma_f32_16x16x32_bf16 v[228:231], a[236:239], v[124:127], v[228:231]
    v_max3_f32 v232, v232, v216, v217
    v_max3_f32 v232, v232, v218, v219
    v_max3_f32 v233, v233, v220, v221
    v_max3_f32 v233, v233, v222, v223
    v_max3_f32 v234, v234, v224, v225
    v_max3_f32 v234, v234, v226, v227
    s_nop 1
    v_max3_f32 v235, v235, v228, v229
    v_max3_f32 v235, v235, v230, v231
    ds_read_b128 a[208:211], v8 offset:8192
    ds_read_b128 a[212:215], v9 offset:8192
    ds_read_b128 a[216:219], v10 offset:8192
    ds_read_b128 a[220:223], v11 offset:8192
    s_waitcnt lgkmcnt(3)
    v_mfma_f32_16x16x32_bf16 v[216:219], a[208:211], v[64:67], 0
    s_waitcnt lgkmcnt(2)
    v_mfma_f32_16x16x32_bf16 v[216:219], a[212:215], v[68:71], v[216:219]
    s_waitcnt lgkmcnt(1)
    v_mfma_f32_16x16x32_bf16 v[216:219], a[216:219], v[72:75], v[216:219]
    s_waitcnt lgkmcnt(0)
    v_mfma_f32_16x16x32_bf16 v[216:219], a[220:223], v[76:79], v[216:219]
    v_mfma_f32_16x16x32_bf16 v[220:223], a[208:211], v[80:83], 0
    v_mfma_f32_16x16x32_bf16 v[220:223], a[212:215], v[84:87], v[220:223]
    v_mfma_f32_16x16x32_bf16 v[220:223], a[216:219], v[88:91], v[220:223]
    v_mfma_f32_16x16x32_bf16 v[220:223], a[220:223], v[92:95], v[220:223]
    v_mfma_f32_16x16x32_bf16 v[224:227], a[208:211], v[96:99], 0
    v_mfma_f32_16x16x32_bf16 v[224:227], a[212:215], v[100:103], v[224:227]
    v_mfma_f32_16x16x32_bf16 v[224:227], a[216:219], v[104:107], v[224:227]
    v_mfma_f32_16x16x32_bf16 v[224:227], a[220:223], v[108:111], v[224:227]
    v_mfma_f32_16x16x32_bf16 v[228:231], a[208:211], v[112:115], 0
    v_mfma_f32_16x16x32_bf16 v[228:231], a[212:215], v[116:119], v[228:231]
    v_mfma_f32_16x16x32_bf16 v[228:231], a[216:219], v[120:123], v[228:231]
    v_mfma_f32_16x16x32_bf16 v[228:231], a[220:223], v[124:127], v[228:231]
    v_max3_f32 v232, v232, v216, v217
    v_max3_f32 v232, v232, v218, v219
    v_max3_f32 v233, v233, v220, v221
    v_max3_f32 v233, v233, v222, v223
    v_max3_f32 v234, v234, v224, v225
    v_max3_f32 v234, v234, v226, v227
    s_nop 1
    v_max3_f32 v235, v235, v228, v229
    v_max3_f32 v235, v235, v230, v231
    ds_read_b128 a[224:227], v8 offset:12288
    ds_read_b128 a[228:231], v9 offset:12288
    ds_read_b128 a[232:235], v10 offset:12288
    ds_read_b128 a[236:239], v11 offset:12288
    s_waitcnt lgkmcnt(3)
    v_mfma_f32_16x16x32_bf16 v[216:219], a[224:227], v[64:67], 0
    s_waitcnt lgkmcnt(2)
    v_mfma_f32_16x16x32_bf16 v[216:219], a[228:231], v[68:71], v[216:219]
    s_waitcnt lgkmcnt(1)
    v_mfma_f32_16x16x32_bf16 v[216:219], a[232:235], v[72:75], v[216:219]
    s_waitcnt lgkmcnt(0)
    v_mfma_f32_16x16x32_bf16 v[216:219], a[236:239], v[76:79], v[216:219]
    v_mfma_f32_16x16x32_bf16 v[220:223], a[224:227], v[80:83], 0
    v_mfma_f32_16x16x32_bf16 v[220:223], a[228:231], v[84:87], v[220:223]
    v_mfma_f32_16x16x32_bf16 v[220:223], a[232:235], v[88:91], v[220:223]
    v_mfma_f32_16x16x32_bf16 v[220:223], a[236:239], v[92:95], v[220:223]
    v_mfma_f32_16x16x32_bf16 v[224:227], a[224:227], v[96:99], 0
    v_mfma_f32_16x16x32_bf16 v[224:227], a[228:231], v[100:103], v[224:227]
    v_mfma_f32_16x16x32_bf16 v[224:227], a[232:235], v[104:107], v[224:227]
    v_mfma_f32_16x16x32_bf16 v[224:227], a[236:239], v[108:111], v[224:227]
    v_mfma_f32_16x16x32_bf16 v[228:231], a[224:227], v[112:115], 0
    v_mfma_f32_16x16x32_bf16 v[228:231], a[228:231], v[116:119], v[228:231]
    v_mfma_f32_16x16x32_bf16 v[228:231], a[232:235], v[120:123], v[228:231]
    v_mfma_f32_16x16x32_bf16 v[228:231], a[236:239], v[124:127], v[228:231]
    v_max3_f32 v232, v232, v216, v217
    v_max3_f32 v232, v232, v218, v219
    v_max3_f32 v233, v233, v220, v221
    v_max3_f32 v233, v233, v222, v223
    v_max3_f32 v234, v234, v224, v225
    v_max3_f32 v234, v234, v226, v227
    s_nop 1
    v_max3_f32 v235, v235, v228, v229
    v_max3_f32 v235, v235, v230, v231
    s_barrier
    s_cmp_lt_u32 s40, 524288
    s_cbranch_scc1 Lattn_redo_loop
    v_mov_b32 v236, v232
    v_mov_b32 v237, v233
    v_mov_b32 v238, v234
    v_mov_b32 v239, v235
    v_permlane16_swap_b32 v232, v236
    v_permlane16_swap_b32 v233, v237
    v_permlane16_swap_b32 v234, v238
    v_permlane16_swap_b32 v235, v239
    v_max_f32 v232, v232, v236
    v_max_f32 v233, v233, v237
    v_max_f32 v234, v234, v238
    v_max_f32 v235, v235, v239
    v_mov_b32 v236, v232
    v_mov_b32 v237, v233
    v_mov_b32 v238, v234
    v_mov_b32 v239, v235
    v_permlane32_swap_b32 v232, v236
    v_permlane32_swap_b32 v233, v237
    v_permlane32_swap_b32 v234, v238
    v_permlane32_swap_b32 v235, v239
    v_max_f32 v232, v232, v236
    v_max_f32 v233, v233, v237
    v_max_f32 v234, v234, v238
    v_max_f32 v235, v235, v239
    v_sub_f32 v192, 0, v232
    v_sub_f32 v193, 0, v232
    v_sub_f32 v194, 0, v232
    v_sub_f32 v195, 0, v232
    v_sub_f32 v196, 0, v233
    v_sub_f32 v197, 0, v233
    v_sub_f32 v198, 0, v233
    v_sub_f32 v199, 0, v233
    v_sub_f32 v200, 0, v234
    v_sub_f32 v201, 0, v234
    v_sub_f32 v202, 0, v234
    v_sub_f32 v203, 0, v234
    v_sub_f32 v204, 0, v235
    v_sub_f32 v205, 0, v235
    v_sub_f32 v206, 0, v235
    v_sub_f32 v207, 0, v235
    s_mov_b32 s40, 0
    s_mov_b32 s41, 0
    s_add_u32 m0, s42, 0
    s_nop 0
    buffer_load_dwordx4 v36, s[8:11], s40 offen lds
    buffer_load_dwordx4 v37, s[8:11], s40 offen offset:1024 lds
    buffer_load_dwordx4 v38, s[8:11], s40 offen offset:2048 lds
    buffer_load_dwordx4 v39, s[8:11], s40 offen offset:3072 lds
    s_add_u32 s40, s40, 16384
    s_add_u32 m0, s42, 16384
    s_nop 0
    buffer_load_dwordx4 v36, s[8:11], s40 offen lds
    buffer_load_dwordx4 v37, s[8:11], s40 offen offset:1024 lds
    buffer_load_dwordx4 v38, s[8:11], s40 offen offset:2048 lds
    buffer_load_dwordx4 v39, s[8:11], s40 offen offset:3072 lds
    s_add_u32 s40, s40, 16384
    s_add_u32 m0, s42, 32768
    s_nop 0
    buffer_load_dwordx4 v36, s[8:11], s40 offen lds
    buffer_load_dwordx4 v37, s[8:11], s40 offen offset:1024 lds
    buffer_load_dwordx4 v38, s[8:11], s40 offen offset:2048 lds
    buffer_load_dwordx4 v39, s[8:11], s40 offen offset:3072 lds
    s_add_u32 s40, s40, 16384
    s_add_u32 m0, s42, 65536
    s_nop 0
    buffer_load_dwordx4 v40, s[12:15], s41 offen lds
    buffer_load_dwordx4 v41, s[12:15], s41 offen offset:1024 lds
    buffer_load_dwordx4 v40, s[12:15], s41 offen offset:2048 lds
    buffer_load_dwordx4 v41, s[12:15], s41 offen offset:3072 lds
    s_add_u32 s41, s41, 16384
    s_add_u32 m0, s42, 81920
    s_nop 0
    buffer_load_dwordx4 v40, s[12:15], s41 offen lds
    buffer_load_dwordx4 v41, s[12:15], s41 offen offset:1024 lds
    buffer_load_dwordx4 v40, s[12:15], s41 offen offset:2048 lds
    buffer_load_dwordx4 v41, s[12:15], s41 offen offset:3072 lds
    s_add_u32 s41, s41, 16384
    v_accvgpr_write_b32 a0, 0
    v_accvgpr_write_b32 a1, 0
    v_accvgpr_write_b32 a2, 0
    v_accvgpr_write_b32 a3, 0
    v_accvgpr_write_b32 a4, 0
    v_accvgpr_write_b32 a5, 0
    v_accvgpr_write_b32 a6, 0
    v_accvgpr_write_b32 a7, 0
    v_accvgpr_write_b32 a8, 0
    v_accvgpr_write_b32 a9, 0
    v_accvgpr_write_b32 a10, 0
    v_accvgpr_write_b32 a11, 0
    v_accvgpr_write_b32 a12, 0
    v_accvgpr_write_b32 a13, 0
    v_accvgpr_write_b32 a14, 0
    v_accvgpr_write_b32 a15, 0
    v_accvgpr_write_b32 a16, 0
    v_accvgpr_write_b32 a17, 0
    v_accvgpr_write_b32 a18, 0
    v_accvgpr_write_b32 a19, 0
    v_accvgpr_write_b32 a20, 0
    v_accvgpr_write_b32 a21, 0
    v_accvgpr_write_b32 a22, 0
    v_accvgpr_write_b32 a23, 0
    v_accvgpr_write_b32 a24, 0
    v_accvgpr_write_b32 a25, 0
    v_accvgpr_write_b32 a26, 0
    v_accvgpr_write_b32 a27, 0
    v_accvgpr_write_b32 a28, 0
    v_accvgpr_write_b32 a29, 0
    v_accvgpr_write_b32 a30, 0
    v_accvgpr_write_b32 a31, 0
    v_accvgpr_write_b32 a32, 0
    v_accvgpr_write_b32 a33, 0
    v_accvgpr_write_b32 a34, 0
    v_accvgpr_write_b32 a35, 0
    v_accvgpr_write_b32 a36, 0
    v_accvgpr_write_b32 a37, 0
    v_accvgpr_write_b32 a38, 0
    v_accvgpr_write_b32 a39, 0
    v_accvgpr_write_b32 a40, 0
    v_accvgpr_write_b32 a41, 0
    v_accvgpr_write_b32 a42, 0
    v_accvgpr_write_b32 a43, 0
    v_accvgpr_write_b32 a44, 0
    v_accvgpr_write_b32 a45, 0
    v_accvgpr_write_b32 a46, 0
    v_accvgpr_write_b32 a47, 0
    v_accvgpr_write_b32 a48, 0
    v_accvgpr_write_b32 a49, 0
    v_accvgpr_write_b32 a50, 0
    v_accvgpr_write_b32 a51, 0
    v_accvgpr_write_b32 a52, 0
    v_accvgpr_write_b32 a53, 0
    v_accvgpr_write_b32 a54, 0
    v_accvgpr_write_b32 a55, 0
    v_accvgpr_write_b32 a56, 0
    v_accvgpr_write_b32 a57, 0
    v_accvgpr_write_b32 a58, 0
    v_accvgpr_write_b32 a59, 0
    v_accvgpr_write_b32 a60, 0
    v_accvgpr_write_b32 a61, 0
    v_accvgpr_write_b32 a62, 0
    v_accvgpr_write_b32 a63, 0
    v_accvgpr_write_b32 a64, 0
    v_accvgpr_write_b32 a65, 0
    v_accvgpr_write_b32 a66, 0
    v_accvgpr_write_b32 a67, 0
    v_accvgpr_write_b32 a68, 0
    v_accvgpr_write_b32 a69, 0
    v_accvgpr_write_b32 a70, 0
    v_accvgpr_write_b32 a71, 0
    v_accvgpr_write_b32 a72, 0
    v_accvgpr_write_b32 a73, 0
    v_accvgpr_write_b32 a74, 0
    v_accvgpr_write_b32 a75, 0
    v_accvgpr_write_b32 a76, 0
    v_accvgpr_write_b32 a77, 0
    v_accvgpr_write_b32 a78, 0
    v_accvgpr_write_b32 a79, 0
    v_accvgpr_write_b32 a80, 0
    v_accvgpr_write_b32 a81, 0
    v_accvgpr_write_b32 a82, 0
    v_accvgpr_write_b32 a83, 0
    v_accvgpr_write_b32 a84, 0
    v_accvgpr_write_b32 a85, 0
    v_accvgpr_write_b32 a86, 0
    v_accvgpr_write_b32 a87, 0
    v_accvgpr_write_b32 a88, 0
    v_accvgpr_write_b32 a89, 0
    v_accvgpr_write_b32 a90, 0
    v_accvgpr_write_b32 a91, 0
    v_accvgpr_write_b32 a92, 0
    v_accvgpr_write_b32 a93, 0
    v_accvgpr_write_b32 a94, 0
    v_accvgpr_write_b32 a95, 0
    v_accvgpr_write_b32 a96, 0
    v_accvgpr_write_b32 a97, 0
    v_accvgpr_write_b32 a98, 0
    v_accvgpr_write_b32 a99, 0
    v_accvgpr_write_b32 a100, 0
    v_accvgpr_write_b32 a101, 0
    v_accvgpr_write_b32 a102, 0
    v_accvgpr_write_b32 a103, 0
    v_accvgpr_write_b32 a104, 0
    v_accvgpr_write_b32 a105, 0
    v_accvgpr_write_b32 a106, 0
    v_accvgpr_write_b32 a107, 0
    v_accvgpr_write_b32 a108, 0
    v_accvgpr_write_b32 a109, 0
    v_accvgpr_write_b32 a110, 0
    v_accvgpr_write_b32 a111, 0
    v_accvgpr_write_b32 a112, 0
    v_accvgpr_write_b32 a113, 0
    v_accvgpr_write_b32 a114, 0
    v_accvgpr_write_b32 a115, 0
    v_accvgpr_write_b32 a116, 0
    v_accvgpr_write_b32 a117, 0
    v_accvgpr_write_b32 a118, 0
    v_accvgpr_write_b32 a119, 0
    v_accvgpr_write_b32 a120, 0
    v_accvgpr_write_b32 a121, 0
    v_accvgpr_write_b32 a122, 0
    v_accvgpr_write_b32 a123, 0
    v_accvgpr_write_b32 a124, 0
    v_accvgpr_write_b32 a125, 0
    v_accvgpr_write_b32 a126, 0
    v_accvgpr_write_b32 a127, 0
    v_accvgpr_write_b32 a192, 0
    v_accvgpr_write_b32 a193, 0
    v_accvgpr_write_b32 a194, 0
    v_accvgpr_write_b32 a195, 0
    v_accvgpr_write_b32 a196, 0
    v_accvgpr_write_b32 a197, 0
    v_accvgpr_write_b32 a198, 0
    v_accvgpr_write_b32 a199, 0
    v_accvgpr_write_b32 a200, 0
    v_accvgpr_write_b32 a201, 0
    v_accvgpr_write_b32 a202, 0
    v_accvgpr_write_b32 a203, 0
    v_accvgpr_write_b32 a204, 0
    v_accvgpr_write_b32 a205, 0
    v_accvgpr_write_b32 a206, 0
    v_accvgpr_write_b32 a207, 0
    s_waitcnt vmcnt(0) lgkmcnt(0)
    s_barrier
    ds_read_b128 a[208:211], v8 offset:0
    ds_read_b128 a[212:215], v9 offset:0
    ds_read_b128 a[216:219], v10 offset:0
    ds_read_b128 a[220:223], v11 offset:0
    ds_read_b128 a[224:227], v8 offset:4096
    s_waitcnt vmcnt(0) lgkmcnt(0)
    s_branch Lattn_stage0
Lattn_armwait:
    s_mov_b32 s36, 262144
Lattn_armloop:
    v_mov_b32 v63, 0
    buffer_load_dword v63, v63, s[88:91], 0 offen sc1
    s_waitcnt vmcnt(0)
    v_readfirstlane_b32 s37, v63
    s_sub_u32 s36, s36, 1
    s_cbranch_scc1 Lattn_armed
    s_cmp_lt_u32 s37, 256
    s_cbranch_scc1 Lattn_armloop
    s_branch Lattn_armed
Lattn_end:
    s_endpgm
.section .rodata,"a"
.p2align 6
.amdhsa_kernel adaLN_cond__gqa_block_cached__moe_arch_mod__prompt_kernel
  .amdhsa_next_free_vgpr 512
  .amdhsa_next_free_sgpr 102
  .amdhsa_accum_offset 256
  .amdhsa_group_segment_fixed_size 0
  .amdhsa_kernarg_size 120
  .amdhsa_user_sgpr_count 2
  .amdhsa_user_sgpr_kernarg_segment_ptr 1
  .amdhsa_system_sgpr_workgroup_id_x 1
  .amdhsa_float_denorm_mode_32 3
.end_amdhsa_kernel
```
